```python
import torch

def _softmax(x, axis=-1):
    return torch.softmax(x, dim=axis)

def _gelu(x):
    return torch.nn.functional.gelu(x, approximate='tanh')

def _silu(x):
    return torch.nn.functional.silu(x)

def _sigmoid(x):
    return torch.sigmoid(x)

def _layernorm(x, axis=-1, eps=1e-05):
    m = x.mean(dim=axis, keepdim=True)
    v = x.var(dim=axis, keepdim=True, unbiased=False)
    return (x - m) / torch.sqrt(v + eps)

def _scatter_add(tgt, idx, src, axis=0):
    return tgt.clone().index_add_(axis, idx, src)

def _segment_sum(src, seg, n):
    out = torch.zeros((n,) + src.shape[1:], dtype=src.dtype)
    return out.index_add_(0, seg, src)

def _pad(x, pw):
    flat = tuple((v for pair in reversed(pw) for v in pair))
    return torch.nn.functional.pad(x, flat)
kernel_name = 'interleave_layers__memory_aug_recurrent_mem_tr__softmax_full_mha__prompt'

def setup_inputs():

    _w = lambda a: (lambda t: t.to(torch.bfloat16) if t.is_floating_point() else t)(torch.as_tensor(a))

    def _A_setup():
        B, S, Dm = (1, 2048, 640)
        H, Dh = (32, 192)
        M, seg = (8, 32)
        seg = min(seg, S)
        S = S // seg * seg
        return {'x': _w((lambda *s: torch.randn(*s, dtype=torch.bfloat16) * 0.05)(B, S, Dm)), 'mem0': _w((lambda *s: torch.randn(*s, dtype=torch.bfloat16) * 0.8)(B, M, Dm)), 'Wq': _w((lambda *s: torch.randn(*s, dtype=torch.bfloat16) * 0.8)(Dm, H, Dh) * Dm ** (-0.5)), 'Wk': _w((lambda *s: torch.randn(*s, dtype=torch.bfloat16) * 0.8)(Dm, H, Dh) * Dm ** (-0.5)), 'Wv': _w((lambda *s: torch.randn(*s, dtype=torch.bfloat16) * 0.8)(Dm, H, Dh) * Dm ** (-0.5)), 'Wo': _w((lambda *s: torch.randn(*s, dtype=torch.bfloat16) * 0.8)(H, Dh, Dm) * (H * Dh) ** (-0.5)), 'seg_len': seg}
    _A_in = _A_setup()

    def _B_setup():
        B, S, D = (1, 2048, 640)
        return {'x': _w((lambda *s: torch.randn(*s, dtype=torch.bfloat16) * 0.05)(B, S, D)), 'wqkv': _w((lambda *s: torch.randn(*s, dtype=torch.bfloat16) * 0.05)(D, 3 * D)), 'wo': _w((lambda *s: torch.randn(*s, dtype=torch.bfloat16) * 0.05)(D, D))}
    _B_in = _B_setup()
    return {'A_x': _A_in['x'], 'A_mem0': _A_in['mem0'], 'A_Wq': _A_in['Wq'], 'A_Wk': _A_in['Wk'], 'A_Wv': _A_in['Wv'], 'A_Wo': _A_in['Wo'], 'A_seg_len': _A_in['seg_len'], 'B_x': _B_in['x'], 'B_wqkv': _B_in['wqkv'], 'B_wo': _B_in['wo']}

def reference(A_x, A_mem0, A_Wq, A_Wk, A_Wv, A_Wo, A_seg_len, B_x, B_wqkv, B_wo):

    def _A_ref(x, mem0, Wq, Wk, Wv, Wo, seg_len):
        B, S, Dm = x.shape
        H, Dh = (Wq.shape[1], Wq.shape[2])
        M = mem0.shape[1]
        scale = Dh ** (-0.5)
        n_seg = S // seg_len
        L = M + seg_len
        idx = torch.arange(L)
        mask = (idx[:, None] < M) | (idx[:, None] >= idx[None, :])
        mem = mem0
        outs = []
        for s in range(n_seg):
            xs = x[:, s * seg_len:(s + 1) * seg_len, :].clone()
            h = torch.concatenate([mem, xs], axis=1)
            q = torch.einsum('btd,dhe->bhte', h, Wq)
            k = torch.einsum('btd,dhe->bhte', h, Wk)
            v = torch.einsum('btd,dhe->bhte', h, Wv)
            scores = torch.einsum('bhqe,bhke->bhqk', q, k) * scale
            scores = torch.where(mask[None, None], scores, -1000000000.0)
            p = _softmax(scores, axis=-1)
            o = torch.einsum('bhqk,bhke->bhqe', p, v)
            o = torch.einsum('bhte,hed->btd', o, Wo)
            mem = o[:, :M, :].clone()
            outs.append(o[:, M:, :])
        return torch.concatenate(outs, axis=1)

    def _B_ref(x, wqkv, wo):
        B, S, D = x.shape
        H = 32
        Dh = D // H
        qkv = (lambda x, *d: x.permute(*d))((x @ wqkv).reshape(B, S, 3, H, Dh), 2, 0, 3, 1, 4)
        q, k, v = (qkv[0], qkv[1], qkv[2])
        scale = Dh ** (-0.5)
        scores = torch.einsum('bhqd,bhkd->bhqk', q, k) * scale
        p = _softmax(scores, axis=-1)
        o = torch.einsum('bhqk,bhkd->bhqd', p, v)
        return (lambda x, *d: x.permute(*d))(o, 0, 2, 1, 3).reshape(B, S, D) @ wo
    x = A_x
    x = x + _A_ref(_layernorm(x, axis=-1), A_mem0, A_Wq, A_Wk, A_Wv, A_Wo, A_seg_len)
    x = x + _B_ref(_layernorm(x, axis=-1), B_wqkv, B_wo)
    x = x + _A_ref(_layernorm(x, axis=-1), A_mem0, A_Wq, A_Wk, A_Wv, A_Wo, A_seg_len)
    x = x + _B_ref(_layernorm(x, axis=-1), B_wqkv, B_wo)
    return x
```

```asm
; @launch kernel=prep_kernel grid=(2240,1,1) block=(256,1,1) lds=0
; @launch kernel=ln1_kernel grid=(128,1,1) block=(256,1,1) lds=512
; @launch kernel=reca_kernel grid=(256,1,1) block=(256,1,1) lds=81920
; @launch kernel=attna_kernel grid=(512,1,1) block=(256,1,1) lds=0
; @launch kernel=outa1_kernel grid=(256,1,1) block=(256,1,1) lds=61440
; @launch kernel=qkvb_kernel grid=(256,1,1) block=(256,1,1) lds=82944
; @launch kernel=attnb_kernel grid=(256,1,1) block=(256,1,1) lds=0
; @launch kernel=outb1_kernel grid=(256,1,1) block=(256,1,1) lds=61440
; @launch kernel=ln2_kernel grid=(128,1,1) block=(256,1,1) lds=512
; @launch kernel=reca_kernel grid=(256,1,1) block=(256,1,1) lds=81920
; @launch kernel=attna_kernel grid=(512,1,1) block=(256,1,1) lds=0
; @launch kernel=outa2_kernel grid=(256,1,1) block=(256,1,1) lds=61440
; @launch kernel=qkvb_kernel grid=(256,1,1) block=(256,1,1) lds=82944
; @launch kernel=attnb_kernel grid=(256,1,1) block=(256,1,1) lds=0
; @launch kernel=outb2_kernel grid=(256,1,1) block=(256,1,1) lds=61440
.amdgcn_target "amdgcn-amd-amdhsa--gfx950"
.text
.globl prep_kernel
.p2align 8
.type prep_kernel,@function
prep_kernel:
  s_cmp_ge_u32 s2, 2240
  s_cbranch_scc1 prep_exit1
  s_load_dwordx2 s[12:13], s[0:1], 96
  s_load_dwordx4 s[16:19], s[0:1], 16
  s_load_dwordx4 s[20:23], s[0:1], 32
  s_load_dwordx4 s[24:27], s[0:1], 64
  v_lshrrev_b32 v6, 6, v0
  v_and_b32 v1, 63, v0
  s_nop 0
  v_readfirstlane_b32 s14, v6
  v_lshlrev_b32 v5, 4, v1
  s_lshl_b32 s15, s2, 2
  s_nop 1
  s_add_u32 s15, s15, s14
  s_waitcnt lgkmcnt(0)
  s_mov_b32 s4, s12
  s_mov_b32 s5, s13
  s_mov_b32 s6, 0x10000000
  s_mov_b32 s7, 0x20000
  s_mov_b32 s11, 0x20000
  v_and_b32 v2, 15, v1
  v_lshrrev_b32 v3, 4, v1
  s_cmp_ge_u32 s15, 5760
  s_cbranch_scc1 prep_s22
  s_mul_hi_u32 s31, s15, 2236963
  s_mul_i32 s32, s31, 1920
  s_sub_u32 s32, s15, s32
  s_mul_hi_u32 s33, s32, 214748365
  s_mul_i32 s34, s33, 20
  s_sub_u32 s34, s32, s34
  s_cmp_eq_u32 s31, 0
  s_cselect_b32 s8, s16, s18
  s_cselect_b32 s9, s17, s19
  s_cmp_eq_u32 s31, 2
  s_cselect_b32 s8, s20, s8
  s_cselect_b32 s9, s21, s9
  s_mov_b32 s10, 7864320
  s_mul_i32 s35, s31, 7864320
  s_add_u32 s35, s35, 6291456
  v_lshlrev_b32 v6, 3, v3
  s_lshl_b32 s36, s34, 5
  v_add_u32 v6, s36, v6
  s_mov_b32 s37, 12288
  v_mul_lo_u32 v4, v6, s37
  s_lshl_b32 s36, s33, 7
  v_lshl_add_u32 v4, v2, 1, v4
  v_add_u32 v4, s36, v4
  s_mov_b32 s29, 0
  buffer_load_ushort v16, v4, s[8:11], s29 offen
  s_mov_b32 s29, 12288
  buffer_load_ushort v17, v4, s[8:11], s29 offen
  s_mov_b32 s29, 24576
  buffer_load_ushort v18, v4, s[8:11], s29 offen
  s_mov_b32 s29, 36864
  buffer_load_ushort v19, v4, s[8:11], s29 offen
  s_mov_b32 s29, 49152
  buffer_load_ushort v20, v4, s[8:11], s29 offen
  s_mov_b32 s29, 61440
  buffer_load_ushort v21, v4, s[8:11], s29 offen
  s_mov_b32 s29, 73728
  buffer_load_ushort v22, v4, s[8:11], s29 offen
  s_mov_b32 s29, 86016
  buffer_load_ushort v23, v4, s[8:11], s29 offen
  s_mov_b32 s29, 32
  buffer_load_ushort v24, v4, s[8:11], s29 offen
  s_mov_b32 s29, 12320
  buffer_load_ushort v25, v4, s[8:11], s29 offen
  s_mov_b32 s29, 24608
  buffer_load_ushort v26, v4, s[8:11], s29 offen
  s_mov_b32 s29, 36896
  buffer_load_ushort v27, v4, s[8:11], s29 offen
  s_mov_b32 s29, 49184
  buffer_load_ushort v28, v4, s[8:11], s29 offen
  s_mov_b32 s29, 61472
  buffer_load_ushort v29, v4, s[8:11], s29 offen
  s_mov_b32 s29, 73760
  buffer_load_ushort v30, v4, s[8:11], s29 offen
  s_mov_b32 s29, 86048
  buffer_load_ushort v31, v4, s[8:11], s29 offen
  s_mov_b32 s29, 64
  buffer_load_ushort v32, v4, s[8:11], s29 offen
  s_mov_b32 s29, 12352
  buffer_load_ushort v33, v4, s[8:11], s29 offen
  s_mov_b32 s29, 24640
  buffer_load_ushort v34, v4, s[8:11], s29 offen
  s_mov_b32 s29, 36928
  buffer_load_ushort v35, v4, s[8:11], s29 offen
  s_mov_b32 s29, 49216
  buffer_load_ushort v36, v4, s[8:11], s29 offen
  s_mov_b32 s29, 61504
  buffer_load_ushort v37, v4, s[8:11], s29 offen
  s_mov_b32 s29, 73792
  buffer_load_ushort v38, v4, s[8:11], s29 offen
  s_mov_b32 s29, 86080
  buffer_load_ushort v39, v4, s[8:11], s29 offen
  s_mov_b32 s29, 96
  buffer_load_ushort v40, v4, s[8:11], s29 offen
  s_mov_b32 s29, 12384
  buffer_load_ushort v41, v4, s[8:11], s29 offen
  s_mov_b32 s29, 24672
  buffer_load_ushort v42, v4, s[8:11], s29 offen
  s_mov_b32 s29, 36960
  buffer_load_ushort v43, v4, s[8:11], s29 offen
  s_mov_b32 s29, 49248
  buffer_load_ushort v44, v4, s[8:11], s29 offen
  s_mov_b32 s29, 61536
  buffer_load_ushort v45, v4, s[8:11], s29 offen
  s_mov_b32 s29, 73824
  buffer_load_ushort v46, v4, s[8:11], s29 offen
  s_mov_b32 s29, 86112
  buffer_load_ushort v47, v4, s[8:11], s29 offen
  s_waitcnt vmcnt(24)
  v_lshl_or_b32 v48, v17, 16, v16
  v_lshl_or_b32 v49, v19, 16, v18
  v_lshl_or_b32 v50, v21, 16, v20
  v_lshl_or_b32 v51, v23, 16, v22
  s_lshl_b32 s30, s33, 2
  s_add_u32 s30, s30, 0
  s_mul_i32 s30, s30, 20
  s_add_u32 s30, s30, s34
  s_lshl_b32 s30, s30, 10
  s_add_u32 s30, s30, s35
  buffer_store_dwordx4 v[48:51], v5, s[4:7], s30 offen
  s_waitcnt vmcnt(17)
  v_lshl_or_b32 v52, v25, 16, v24
  v_lshl_or_b32 v53, v27, 16, v26
  v_lshl_or_b32 v54, v29, 16, v28
  v_lshl_or_b32 v55, v31, 16, v30
  s_lshl_b32 s30, s33, 2
  s_add_u32 s30, s30, 1
  s_mul_i32 s30, s30, 20
  s_add_u32 s30, s30, s34
  s_lshl_b32 s30, s30, 10
  s_add_u32 s30, s30, s35
  buffer_store_dwordx4 v[52:55], v5, s[4:7], s30 offen
  s_waitcnt vmcnt(10)
  v_lshl_or_b32 v56, v33, 16, v32
  v_lshl_or_b32 v57, v35, 16, v34
  v_lshl_or_b32 v58, v37, 16, v36
  v_lshl_or_b32 v59, v39, 16, v38
  s_lshl_b32 s30, s33, 2
  s_add_u32 s30, s30, 2
  s_mul_i32 s30, s30, 20
  s_add_u32 s30, s30, s34
  s_lshl_b32 s30, s30, 10
  s_add_u32 s30, s30, s35
  buffer_store_dwordx4 v[56:59], v5, s[4:7], s30 offen
  s_waitcnt vmcnt(3)
  v_lshl_or_b32 v60, v41, 16, v40
  v_lshl_or_b32 v61, v43, 16, v42
  v_lshl_or_b32 v62, v45, 16, v44
  v_lshl_or_b32 v63, v47, 16, v46
  s_lshl_b32 s30, s33, 2
  s_add_u32 s30, s30, 3
  s_mul_i32 s30, s30, 20
  s_add_u32 s30, s30, s34
  s_lshl_b32 s30, s30, 10
  s_add_u32 s30, s30, s35
  buffer_store_dwordx4 v[60:63], v5, s[4:7], s30 offen
  s_branch prep_exit1
prep_s22:
  s_sub_u32 s15, s15, 5760
  s_cmp_ge_u32 s15, 1920
  s_cbranch_scc1 prep_s33
  s_mul_hi_u32 s33, s15, 22369622
  s_mul_i32 s34, s33, 192
  s_sub_u32 s34, s15, s34
  s_mov_b32 s8, s22
  s_mov_b32 s9, s23
  s_mov_b32 s10, 7864320
  v_lshlrev_b32 v6, 2, v3
  s_lshl_b32 s36, s34, 5
  v_add_u32 v6, s36, v6
  v_mul_u32_u24 v4, 1280, v6
  v_lshrrev_b32 v6, 2, v2
  v_lshl_add_u32 v4, v6, 4, v4
  v_and_b32 v6, 3, v2
  v_lshl_add_u32 v4, v6, 1, v4
  s_lshl_b32 s36, s33, 7
  v_add_u32 v4, s36, v4
  s_mov_b32 s29, 0
  buffer_load_ushort v16, v4, s[8:11], s29 offen
  s_mov_b32 s29, 1280
  buffer_load_ushort v17, v4, s[8:11], s29 offen
  s_mov_b32 s29, 2560
  buffer_load_ushort v18, v4, s[8:11], s29 offen
  s_mov_b32 s29, 3840
  buffer_load_ushort v19, v4, s[8:11], s29 offen
  s_mov_b32 s29, 20480
  buffer_load_ushort v20, v4, s[8:11], s29 offen
  s_mov_b32 s29, 21760
  buffer_load_ushort v21, v4, s[8:11], s29 offen
  s_mov_b32 s29, 23040
  buffer_load_ushort v22, v4, s[8:11], s29 offen
  s_mov_b32 s29, 24320
  buffer_load_ushort v23, v4, s[8:11], s29 offen
  s_mov_b32 s29, 8
  buffer_load_ushort v24, v4, s[8:11], s29 offen
  s_mov_b32 s29, 1288
  buffer_load_ushort v25, v4, s[8:11], s29 offen
  s_mov_b32 s29, 2568
  buffer_load_ushort v26, v4, s[8:11], s29 offen
  s_mov_b32 s29, 3848
  buffer_load_ushort v27, v4, s[8:11], s29 offen
  s_mov_b32 s29, 20488
  buffer_load_ushort v28, v4, s[8:11], s29 offen
  s_mov_b32 s29, 21768
  buffer_load_ushort v29, v4, s[8:11], s29 offen
  s_mov_b32 s29, 23048
  buffer_load_ushort v30, v4, s[8:11], s29 offen
  s_mov_b32 s29, 24328
  buffer_load_ushort v31, v4, s[8:11], s29 offen
  s_mov_b32 s29, 64
  buffer_load_ushort v32, v4, s[8:11], s29 offen
  s_mov_b32 s29, 1344
  buffer_load_ushort v33, v4, s[8:11], s29 offen
  s_mov_b32 s29, 2624
  buffer_load_ushort v34, v4, s[8:11], s29 offen
  s_mov_b32 s29, 3904
  buffer_load_ushort v35, v4, s[8:11], s29 offen
  s_mov_b32 s29, 20544
  buffer_load_ushort v36, v4, s[8:11], s29 offen
  s_mov_b32 s29, 21824
  buffer_load_ushort v37, v4, s[8:11], s29 offen
  s_mov_b32 s29, 23104
  buffer_load_ushort v38, v4, s[8:11], s29 offen
  s_mov_b32 s29, 24384
  buffer_load_ushort v39, v4, s[8:11], s29 offen
  s_mov_b32 s29, 72
  buffer_load_ushort v40, v4, s[8:11], s29 offen
  s_mov_b32 s29, 1352
  buffer_load_ushort v41, v4, s[8:11], s29 offen
  s_mov_b32 s29, 2632
  buffer_load_ushort v42, v4, s[8:11], s29 offen
  s_mov_b32 s29, 3912
  buffer_load_ushort v43, v4, s[8:11], s29 offen
  s_mov_b32 s29, 20552
  buffer_load_ushort v44, v4, s[8:11], s29 offen
  s_mov_b32 s29, 21832
  buffer_load_ushort v45, v4, s[8:11], s29 offen
  s_mov_b32 s29, 23112
  buffer_load_ushort v46, v4, s[8:11], s29 offen
  s_mov_b32 s29, 24392
  buffer_load_ushort v47, v4, s[8:11], s29 offen
  s_waitcnt vmcnt(24)
  v_lshl_or_b32 v48, v17, 16, v16
  v_lshl_or_b32 v49, v19, 16, v18
  v_lshl_or_b32 v50, v21, 16, v20
  v_lshl_or_b32 v51, v23, 16, v22
  s_lshl_b32 s30, s33, 2
  s_add_u32 s30, s30, 0
  s_mul_i32 s30, s30, 192
  s_add_u32 s30, s30, s34
  s_lshl_b32 s30, s30, 10
  s_add_u32 s30, s30, 29884416
  buffer_store_dwordx4 v[48:51], v5, s[4:7], s30 offen
  s_waitcnt vmcnt(17)
  v_lshl_or_b32 v52, v25, 16, v24
  v_lshl_or_b32 v53, v27, 16, v26
  v_lshl_or_b32 v54, v29, 16, v28
  v_lshl_or_b32 v55, v31, 16, v30
  s_lshl_b32 s30, s33, 2
  s_add_u32 s30, s30, 1
  s_mul_i32 s30, s30, 192
  s_add_u32 s30, s30, s34
  s_lshl_b32 s30, s30, 10
  s_add_u32 s30, s30, 29884416
  buffer_store_dwordx4 v[52:55], v5, s[4:7], s30 offen
  s_waitcnt vmcnt(10)
  v_lshl_or_b32 v56, v33, 16, v32
  v_lshl_or_b32 v57, v35, 16, v34
  v_lshl_or_b32 v58, v37, 16, v36
  v_lshl_or_b32 v59, v39, 16, v38
  s_lshl_b32 s30, s33, 2
  s_add_u32 s30, s30, 2
  s_mul_i32 s30, s30, 192
  s_add_u32 s30, s30, s34
  s_lshl_b32 s30, s30, 10
  s_add_u32 s30, s30, 29884416
  buffer_store_dwordx4 v[56:59], v5, s[4:7], s30 offen
  s_waitcnt vmcnt(3)
  v_lshl_or_b32 v60, v41, 16, v40
  v_lshl_or_b32 v61, v43, 16, v42
  v_lshl_or_b32 v62, v45, 16, v44
  v_lshl_or_b32 v63, v47, 16, v46
  s_lshl_b32 s30, s33, 2
  s_add_u32 s30, s30, 3
  s_mul_i32 s30, s30, 192
  s_add_u32 s30, s30, s34
  s_lshl_b32 s30, s30, 10
  s_add_u32 s30, s30, 29884416
  buffer_store_dwordx4 v[60:63], v5, s[4:7], s30 offen
  s_branch prep_exit1
prep_s33:
  s_sub_u32 s15, s15, 1920
  s_cmp_ge_u32 s15, 960
  s_cbranch_scc1 prep_s44
  s_mul_hi_u32 s33, s15, 107374183
  s_mul_i32 s34, s33, 40
  s_sub_u32 s34, s15, s34
  s_mov_b32 s8, s24
  s_mov_b32 s9, s25
  s_mov_b32 s10, 2457600
  v_lshrrev_b32 v6, 5, v1
  v_lshlrev_b32 v6, 3, v6
  s_lshl_b32 s36, s34, 4
  v_add_u32 v6, s36, v6
  v_mul_u32_u24 v4, 3840, v6
  v_and_b32 v6, 31, v1
  v_lshl_add_u32 v4, v6, 1, v4
  s_mul_i32 s36, s33, 160
  v_add_u32 v4, s36, v4
  v_cmp_gt_u32 vcc, 20, v6
  v_mov_b32 v6, 0x80000000
  s_nop 0
  v_cndmask_b32 v4, v6, v4, vcc
  s_mov_b32 s29, 0
  buffer_load_ushort v16, v4, s[8:11], s29 offen
  s_mov_b32 s29, 3840
  buffer_load_ushort v17, v4, s[8:11], s29 offen
  s_mov_b32 s29, 7680
  buffer_load_ushort v18, v4, s[8:11], s29 offen
  s_mov_b32 s29, 11520
  buffer_load_ushort v19, v4, s[8:11], s29 offen
  s_mov_b32 s29, 15360
  buffer_load_ushort v20, v4, s[8:11], s29 offen
  s_mov_b32 s29, 19200
  buffer_load_ushort v21, v4, s[8:11], s29 offen
  s_mov_b32 s29, 23040
  buffer_load_ushort v22, v4, s[8:11], s29 offen
  s_mov_b32 s29, 26880
  buffer_load_ushort v23, v4, s[8:11], s29 offen
  s_mov_b32 s29, 40
  buffer_load_ushort v24, v4, s[8:11], s29 offen
  s_mov_b32 s29, 3880
  buffer_load_ushort v25, v4, s[8:11], s29 offen
  s_mov_b32 s29, 7720
  buffer_load_ushort v26, v4, s[8:11], s29 offen
  s_mov_b32 s29, 11560
  buffer_load_ushort v27, v4, s[8:11], s29 offen
  s_mov_b32 s29, 15400
  buffer_load_ushort v28, v4, s[8:11], s29 offen
  s_mov_b32 s29, 19240
  buffer_load_ushort v29, v4, s[8:11], s29 offen
  s_mov_b32 s29, 23080
  buffer_load_ushort v30, v4, s[8:11], s29 offen
  s_mov_b32 s29, 26920
  buffer_load_ushort v31, v4, s[8:11], s29 offen
  s_mov_b32 s29, 80
  buffer_load_ushort v32, v4, s[8:11], s29 offen
  s_mov_b32 s29, 3920
  buffer_load_ushort v33, v4, s[8:11], s29 offen
  s_mov_b32 s29, 7760
  buffer_load_ushort v34, v4, s[8:11], s29 offen
  s_mov_b32 s29, 11600
  buffer_load_ushort v35, v4, s[8:11], s29 offen
  s_mov_b32 s29, 15440
  buffer_load_ushort v36, v4, s[8:11], s29 offen
  s_mov_b32 s29, 19280
  buffer_load_ushort v37, v4, s[8:11], s29 offen
  s_mov_b32 s29, 23120
  buffer_load_ushort v38, v4, s[8:11], s29 offen
  s_mov_b32 s29, 26960
  buffer_load_ushort v39, v4, s[8:11], s29 offen
  s_mov_b32 s29, 120
  buffer_load_ushort v40, v4, s[8:11], s29 offen
  s_mov_b32 s29, 3960
  buffer_load_ushort v41, v4, s[8:11], s29 offen
  s_mov_b32 s29, 7800
  buffer_load_ushort v42, v4, s[8:11], s29 offen
  s_mov_b32 s29, 11640
  buffer_load_ushort v43, v4, s[8:11], s29 offen
  s_mov_b32 s29, 15480
  buffer_load_ushort v44, v4, s[8:11], s29 offen
  s_mov_b32 s29, 19320
  buffer_load_ushort v45, v4, s[8:11], s29 offen
  s_mov_b32 s29, 23160
  buffer_load_ushort v46, v4, s[8:11], s29 offen
  s_mov_b32 s29, 27000
  buffer_load_ushort v47, v4, s[8:11], s29 offen
  s_waitcnt vmcnt(24)
  v_lshl_or_b32 v48, v17, 16, v16
  v_lshl_or_b32 v49, v19, 16, v18
  v_lshl_or_b32 v50, v21, 16, v20
  v_lshl_or_b32 v51, v23, 16, v22
  s_lshl_b32 s30, s33, 2
  s_add_u32 s30, s30, 0
  s_mul_i32 s30, s30, 40
  s_add_u32 s30, s30, s34
  s_lshl_b32 s30, s30, 10
  s_add_u32 s30, s30, 156237824
  buffer_store_dwordx4 v[48:51], v5, s[4:7], s30 offen
  s_waitcnt vmcnt(17)
  v_lshl_or_b32 v52, v25, 16, v24
  v_lshl_or_b32 v53, v27, 16, v26
  v_lshl_or_b32 v54, v29, 16, v28
  v_lshl_or_b32 v55, v31, 16, v30
  s_lshl_b32 s30, s33, 2
  s_add_u32 s30, s30, 1
  s_mul_i32 s30, s30, 40
  s_add_u32 s30, s30, s34
  s_lshl_b32 s30, s30, 10
  s_add_u32 s30, s30, 156237824
  buffer_store_dwordx4 v[52:55], v5, s[4:7], s30 offen
  s_waitcnt vmcnt(10)
  v_lshl_or_b32 v56, v33, 16, v32
  v_lshl_or_b32 v57, v35, 16, v34
  v_lshl_or_b32 v58, v37, 16, v36
  v_lshl_or_b32 v59, v39, 16, v38
  s_lshl_b32 s30, s33, 2
  s_add_u32 s30, s30, 2
  s_mul_i32 s30, s30, 40
  s_add_u32 s30, s30, s34
  s_lshl_b32 s30, s30, 10
  s_add_u32 s30, s30, 156237824
  buffer_store_dwordx4 v[56:59], v5, s[4:7], s30 offen
  s_waitcnt vmcnt(3)
  v_lshl_or_b32 v60, v41, 16, v40
  v_lshl_or_b32 v61, v43, 16, v42
  v_lshl_or_b32 v62, v45, 16, v44
  v_lshl_or_b32 v63, v47, 16, v46
  s_lshl_b32 s30, s33, 2
  s_add_u32 s30, s30, 3
  s_mul_i32 s30, s30, 40
  s_add_u32 s30, s30, s34
  s_lshl_b32 s30, s30, 10
  s_add_u32 s30, s30, 156237824
  buffer_store_dwordx4 v[60:63], v5, s[4:7], s30 offen
  s_branch prep_exit1
prep_s44:
  s_sub_u32 s15, s15, 960
  s_mul_hi_u32 s33, s15, 134217728
  s_and_b32 s34, s15, 31
  s_lshr_b32 s33, s15, 5
  s_mov_b32 s8, s26
  s_mov_b32 s9, s27
  s_mov_b32 s10, 819200
  v_lshrrev_b32 v6, 1, v3
  v_lshlrev_b32 v6, 4, v6
  v_and_b32 v7, 1, v3
  v_lshl_add_u32 v6, v7, 2, v6
  v_mov_b32 v8, v6
  s_mul_i32 s36, s34, 20
  v_add_u32 v6, s36, v6
  v_mul_u32_u24 v4, 1280, v6
  v_lshrrev_b32 v6, 2, v2
  v_lshl_add_u32 v4, v6, 4, v4
  v_and_b32 v6, 3, v2
  v_lshl_add_u32 v4, v6, 1, v4
  s_lshl_b32 s36, s33, 7
  v_add_u32 v4, s36, v4
  v_mov_b32 v9, 0x80000000
  v_cmp_gt_u32 vcc, 17, v8
  s_nop 1
  v_cndmask_b32 v10, v9, v4, vcc
  v_cmp_gt_u32 vcc, 9, v8
  s_nop 1
  v_cndmask_b32 v11, v9, v4, vcc
  s_mov_b32 s29, 0
  buffer_load_ushort v16, v10, s[8:11], s29 offen
  s_mov_b32 s29, 1280
  buffer_load_ushort v17, v10, s[8:11], s29 offen
  s_mov_b32 s29, 2560
  buffer_load_ushort v18, v10, s[8:11], s29 offen
  s_mov_b32 s29, 3840
  buffer_load_ushort v19, v10, s[8:11], s29 offen
  s_mov_b32 s29, 10240
  buffer_load_ushort v20, v11, s[8:11], s29 offen
  s_mov_b32 s29, 11520
  buffer_load_ushort v21, v11, s[8:11], s29 offen
  s_mov_b32 s29, 12800
  buffer_load_ushort v22, v11, s[8:11], s29 offen
  s_mov_b32 s29, 14080
  buffer_load_ushort v23, v11, s[8:11], s29 offen
  s_mov_b32 s29, 8
  buffer_load_ushort v24, v10, s[8:11], s29 offen
  s_mov_b32 s29, 1288
  buffer_load_ushort v25, v10, s[8:11], s29 offen
  s_mov_b32 s29, 2568
  buffer_load_ushort v26, v10, s[8:11], s29 offen
  s_mov_b32 s29, 3848
  buffer_load_ushort v27, v10, s[8:11], s29 offen
  s_mov_b32 s29, 10248
  buffer_load_ushort v28, v11, s[8:11], s29 offen
  s_mov_b32 s29, 11528
  buffer_load_ushort v29, v11, s[8:11], s29 offen
  s_mov_b32 s29, 12808
  buffer_load_ushort v30, v11, s[8:11], s29 offen
  s_mov_b32 s29, 14088
  buffer_load_ushort v31, v11, s[8:11], s29 offen
  s_mov_b32 s29, 64
  buffer_load_ushort v32, v10, s[8:11], s29 offen
  s_mov_b32 s29, 1344
  buffer_load_ushort v33, v10, s[8:11], s29 offen
  s_mov_b32 s29, 2624
  buffer_load_ushort v34, v10, s[8:11], s29 offen
  s_mov_b32 s29, 3904
  buffer_load_ushort v35, v10, s[8:11], s29 offen
  s_mov_b32 s29, 10304
  buffer_load_ushort v36, v11, s[8:11], s29 offen
  s_mov_b32 s29, 11584
  buffer_load_ushort v37, v11, s[8:11], s29 offen
  s_mov_b32 s29, 12864
  buffer_load_ushort v38, v11, s[8:11], s29 offen
  s_mov_b32 s29, 14144
  buffer_load_ushort v39, v11, s[8:11], s29 offen
  s_mov_b32 s29, 72
  buffer_load_ushort v40, v10, s[8:11], s29 offen
  s_mov_b32 s29, 1352
  buffer_load_ushort v41, v10, s[8:11], s29 offen
  s_mov_b32 s29, 2632
  buffer_load_ushort v42, v10, s[8:11], s29 offen
  s_mov_b32 s29, 3912
  buffer_load_ushort v43, v10, s[8:11], s29 offen
  s_mov_b32 s29, 10312
  buffer_load_ushort v44, v11, s[8:11], s29 offen
  s_mov_b32 s29, 11592
  buffer_load_ushort v45, v11, s[8:11], s29 offen
  s_mov_b32 s29, 12872
  buffer_load_ushort v46, v11, s[8:11], s29 offen
  s_mov_b32 s29, 14152
  buffer_load_ushort v47, v11, s[8:11], s29 offen
  s_waitcnt vmcnt(24)
  v_lshl_or_b32 v48, v17, 16, v16
  v_lshl_or_b32 v49, v19, 16, v18
  v_lshl_or_b32 v50, v21, 16, v20
  v_lshl_or_b32 v51, v23, 16, v22
  s_lshl_b32 s30, s33, 2
  s_add_u32 s30, s30, 0
  s_lshl_b32 s30, s30, 5
  s_add_u32 s30, s30, s34
  s_lshl_b32 s30, s30, 10
  s_add_u32 s30, s30, 160169984
  buffer_store_dwordx4 v[48:51], v5, s[4:7], s30 offen
  s_waitcnt vmcnt(17)
  v_lshl_or_b32 v52, v25, 16, v24
  v_lshl_or_b32 v53, v27, 16, v26
  v_lshl_or_b32 v54, v29, 16, v28
  v_lshl_or_b32 v55, v31, 16, v30
  s_lshl_b32 s30, s33, 2
  s_add_u32 s30, s30, 1
  s_lshl_b32 s30, s30, 5
  s_add_u32 s30, s30, s34
  s_lshl_b32 s30, s30, 10
  s_add_u32 s30, s30, 160169984
  buffer_store_dwordx4 v[52:55], v5, s[4:7], s30 offen
  s_waitcnt vmcnt(10)
  v_lshl_or_b32 v56, v33, 16, v32
  v_lshl_or_b32 v57, v35, 16, v34
  v_lshl_or_b32 v58, v37, 16, v36
  v_lshl_or_b32 v59, v39, 16, v38
  s_lshl_b32 s30, s33, 2
  s_add_u32 s30, s30, 2
  s_lshl_b32 s30, s30, 5
  s_add_u32 s30, s30, s34
  s_lshl_b32 s30, s30, 10
  s_add_u32 s30, s30, 160169984
  buffer_store_dwordx4 v[56:59], v5, s[4:7], s30 offen
  s_waitcnt vmcnt(3)
  v_lshl_or_b32 v60, v41, 16, v40
  v_lshl_or_b32 v61, v43, 16, v42
  v_lshl_or_b32 v62, v45, 16, v44
  v_lshl_or_b32 v63, v47, 16, v46
  s_lshl_b32 s30, s33, 2
  s_add_u32 s30, s30, 3
  s_lshl_b32 s30, s30, 5
  s_add_u32 s30, s30, s34
  s_lshl_b32 s30, s30, 10
  s_add_u32 s30, s30, 160169984
  buffer_store_dwordx4 v[60:63], v5, s[4:7], s30 offen
prep_exit1:
  s_endpgm
.globl ln1_kernel
.p2align 8
.type ln1_kernel,@function
ln1_kernel:
  s_cmp_ge_u32 s2, 128
  s_cbranch_scc1 ln1_exit1
  s_load_dwordx2 s[12:13], s[0:1], 96
  s_load_dwordx2 s[14:15], s[0:1], 0
  v_lshrrev_b32 v2, 6, v0
  v_and_b32 v3, 63, v0
  s_nop 0
  v_readfirstlane_b32 s16, v2
  s_waitcnt lgkmcnt(0)
  s_mov_b32 s4, s12
  s_mov_b32 s5, s13
  s_mov_b32 s6, 0x10000000
  s_mov_b32 s7, 0x20000
  s_mov_b32 s8, s14
  s_mov_b32 s9, s15
  s_mov_b32 s10, 2621440
  s_mov_b32 s11, 0x20000
  s_mov_b32 s20, 0
  v_and_b32 v2, 15, v3
  v_lshrrev_b32 v4, 4, v3
  s_lshl_b32 s17, s2, 4
  v_add_u32 v1, s17, v2
  v_mul_u32_u24 v1, 1280, v1
  v_lshl_add_u32 v1, v4, 4, v1
  s_mul_i32 s17, s16, 320
  s_add_u32 s20, s20, s17
  buffer_load_dwordx4 v[8:11], v1, s[8:11], s20 offen offset:0
  buffer_load_dwordx4 v[12:15], v1, s[8:11], s20 offen offset:64
  buffer_load_dwordx4 v[16:19], v1, s[8:11], s20 offen offset:128
  buffer_load_dwordx4 v[20:23], v1, s[8:11], s20 offen offset:192
  buffer_load_dwordx4 v[24:27], v1, s[8:11], s20 offen offset:256
  v_lshlrev_b32 v5, 2, v2
  s_lshl_b32 s17, s16, 6
  v_add_u32 v1, s17, v5
  s_waitcnt vmcnt(0)
  v_lshlrev_b32 v28, 16, v8
  v_and_b32 v29, 0xffff0000, v8
  v_lshlrev_b32 v30, 16, v9
  v_and_b32 v31, 0xffff0000, v9
  v_lshlrev_b32 v32, 16, v10
  v_and_b32 v33, 0xffff0000, v10
  v_lshlrev_b32 v34, 16, v11
  v_and_b32 v35, 0xffff0000, v11
  v_lshlrev_b32 v36, 16, v12
  v_and_b32 v37, 0xffff0000, v12
  v_lshlrev_b32 v38, 16, v13
  v_and_b32 v39, 0xffff0000, v13
  v_lshlrev_b32 v40, 16, v14
  v_and_b32 v41, 0xffff0000, v14
  v_lshlrev_b32 v42, 16, v15
  v_and_b32 v43, 0xffff0000, v15
  v_lshlrev_b32 v44, 16, v16
  v_and_b32 v45, 0xffff0000, v16
  v_lshlrev_b32 v46, 16, v17
  v_and_b32 v47, 0xffff0000, v17
  v_lshlrev_b32 v48, 16, v18
  v_and_b32 v49, 0xffff0000, v18
  v_lshlrev_b32 v50, 16, v19
  v_and_b32 v51, 0xffff0000, v19
  v_lshlrev_b32 v52, 16, v20
  v_and_b32 v53, 0xffff0000, v20
  v_lshlrev_b32 v54, 16, v21
  v_and_b32 v55, 0xffff0000, v21
  v_lshlrev_b32 v56, 16, v22
  v_and_b32 v57, 0xffff0000, v22
  v_lshlrev_b32 v58, 16, v23
  v_and_b32 v59, 0xffff0000, v23
  v_lshlrev_b32 v60, 16, v24
  v_and_b32 v61, 0xffff0000, v24
  v_lshlrev_b32 v62, 16, v25
  v_and_b32 v63, 0xffff0000, v25
  v_lshlrev_b32 v64, 16, v26
  v_and_b32 v65, 0xffff0000, v26
  v_lshlrev_b32 v66, 16, v27
  v_and_b32 v67, 0xffff0000, v27
  v_pk_add_f32 v[6:7], v[28:29], v[30:31]
  v_pk_add_f32 v[6:7], v[6:7], v[32:33]
  v_pk_add_f32 v[6:7], v[6:7], v[34:35]
  v_pk_add_f32 v[6:7], v[6:7], v[36:37]
  v_pk_add_f32 v[6:7], v[6:7], v[38:39]
  v_pk_add_f32 v[6:7], v[6:7], v[40:41]
  v_pk_add_f32 v[6:7], v[6:7], v[42:43]
  v_pk_add_f32 v[6:7], v[6:7], v[44:45]
  v_pk_add_f32 v[6:7], v[6:7], v[46:47]
  v_pk_add_f32 v[6:7], v[6:7], v[48:49]
  v_pk_add_f32 v[6:7], v[6:7], v[50:51]
  v_pk_add_f32 v[6:7], v[6:7], v[52:53]
  v_pk_add_f32 v[6:7], v[6:7], v[54:55]
  v_pk_add_f32 v[6:7], v[6:7], v[56:57]
  v_pk_add_f32 v[6:7], v[6:7], v[58:59]
  v_pk_add_f32 v[6:7], v[6:7], v[60:61]
  v_pk_add_f32 v[6:7], v[6:7], v[62:63]
  v_pk_add_f32 v[6:7], v[6:7], v[64:65]
  v_pk_add_f32 v[6:7], v[6:7], v[66:67]
  v_add_f32 v4, v6, v7
  v_mov_b32 v2, v4
  s_nop 1
  v_permlane32_swap_b32 v4, v2
  v_add_f32 v4, v4, v2
  v_mov_b32 v2, v4
  s_nop 1
  v_permlane16_swap_b32 v4, v2
  v_add_f32 v4, v4, v2
  ds_write_b32 v1, v4 offset:0
  s_waitcnt lgkmcnt(0)
  s_barrier
  ds_read_b32 v4, v5 offset:0
  ds_read_b32 v2, v5 offset:64
  ds_read_b32 v3, v5 offset:128
  ds_read_b32 v6, v5 offset:192
  s_waitcnt lgkmcnt(0)
  v_add_f32 v4, v4, v2
  v_add_f32 v3, v3, v6
  v_add_f32 v4, v4, v3
  v_mul_f32 v4, 0x3acccccd, v4
  v_sub_f32 v28, v28, v4
  v_sub_f32 v29, v29, v4
  v_sub_f32 v30, v30, v4
  v_sub_f32 v31, v31, v4
  v_sub_f32 v32, v32, v4
  v_sub_f32 v33, v33, v4
  v_sub_f32 v34, v34, v4
  v_sub_f32 v35, v35, v4
  v_sub_f32 v36, v36, v4
  v_sub_f32 v37, v37, v4
  v_sub_f32 v38, v38, v4
  v_sub_f32 v39, v39, v4
  v_sub_f32 v40, v40, v4
  v_sub_f32 v41, v41, v4
  v_sub_f32 v42, v42, v4
  v_sub_f32 v43, v43, v4
  v_sub_f32 v44, v44, v4
  v_sub_f32 v45, v45, v4
  v_sub_f32 v46, v46, v4
  v_sub_f32 v47, v47, v4
  v_sub_f32 v48, v48, v4
  v_sub_f32 v49, v49, v4
  v_sub_f32 v50, v50, v4
  v_sub_f32 v51, v51, v4
  v_sub_f32 v52, v52, v4
  v_sub_f32 v53, v53, v4
  v_sub_f32 v54, v54, v4
  v_sub_f32 v55, v55, v4
  v_sub_f32 v56, v56, v4
  v_sub_f32 v57, v57, v4
  v_sub_f32 v58, v58, v4
  v_sub_f32 v59, v59, v4
  v_sub_f32 v60, v60, v4
  v_sub_f32 v61, v61, v4
  v_sub_f32 v62, v62, v4
  v_sub_f32 v63, v63, v4
  v_sub_f32 v64, v64, v4
  v_sub_f32 v65, v65, v4
  v_sub_f32 v66, v66, v4
  v_sub_f32 v67, v67, v4
  v_mul_f32 v6, v28, v28
  v_mul_f32 v7, v29, v29
  v_fmac_f32 v6, v30, v30
  v_fmac_f32 v7, v31, v31
  v_fmac_f32 v6, v32, v32
  v_fmac_f32 v7, v33, v33
  v_fmac_f32 v6, v34, v34
  v_fmac_f32 v7, v35, v35
  v_fmac_f32 v6, v36, v36
  v_fmac_f32 v7, v37, v37
  v_fmac_f32 v6, v38, v38
  v_fmac_f32 v7, v39, v39
  v_fmac_f32 v6, v40, v40
  v_fmac_f32 v7, v41, v41
  v_fmac_f32 v6, v42, v42
  v_fmac_f32 v7, v43, v43
  v_fmac_f32 v6, v44, v44
  v_fmac_f32 v7, v45, v45
  v_fmac_f32 v6, v46, v46
  v_fmac_f32 v7, v47, v47
  v_fmac_f32 v6, v48, v48
  v_fmac_f32 v7, v49, v49
  v_fmac_f32 v6, v50, v50
  v_fmac_f32 v7, v51, v51
  v_fmac_f32 v6, v52, v52
  v_fmac_f32 v7, v53, v53
  v_fmac_f32 v6, v54, v54
  v_fmac_f32 v7, v55, v55
  v_fmac_f32 v6, v56, v56
  v_fmac_f32 v7, v57, v57
  v_fmac_f32 v6, v58, v58
  v_fmac_f32 v7, v59, v59
  v_fmac_f32 v6, v60, v60
  v_fmac_f32 v7, v61, v61
  v_fmac_f32 v6, v62, v62
  v_fmac_f32 v7, v63, v63
  v_fmac_f32 v6, v64, v64
  v_fmac_f32 v7, v65, v65
  v_fmac_f32 v6, v66, v66
  v_fmac_f32 v7, v67, v67
  v_add_f32 v4, v6, v7
  v_mov_b32 v2, v4
  s_nop 1
  v_permlane32_swap_b32 v4, v2
  v_add_f32 v4, v4, v2
  v_mov_b32 v2, v4
  s_nop 1
  v_permlane16_swap_b32 v4, v2
  v_add_f32 v4, v4, v2
  ds_write_b32 v1, v4 offset:256
  s_waitcnt lgkmcnt(0)
  s_barrier
  ds_read_b32 v4, v5 offset:256
  ds_read_b32 v2, v5 offset:320
  ds_read_b32 v3, v5 offset:384
  ds_read_b32 v6, v5 offset:448
  s_waitcnt lgkmcnt(0)
  v_add_f32 v4, v4, v2
  v_add_f32 v3, v3, v6
  v_add_f32 v4, v4, v3
  v_mov_b32 v2, 0x3727c5ac
  v_fmac_f32 v2, 0x3acccccd, v4
  v_rsq_f32 v4, v2
  s_nop 0
  v_mul_f32 v28, v28, v4
  v_mul_f32 v29, v29, v4
  v_mul_f32 v30, v30, v4
  v_mul_f32 v31, v31, v4
  v_mul_f32 v32, v32, v4
  v_mul_f32 v33, v33, v4
  v_mul_f32 v34, v34, v4
  v_mul_f32 v35, v35, v4
  v_mul_f32 v36, v36, v4
  v_mul_f32 v37, v37, v4
  v_mul_f32 v38, v38, v4
  v_mul_f32 v39, v39, v4
  v_mul_f32 v40, v40, v4
  v_mul_f32 v41, v41, v4
  v_mul_f32 v42, v42, v4
  v_mul_f32 v43, v43, v4
  v_mul_f32 v44, v44, v4
  v_mul_f32 v45, v45, v4
  v_mul_f32 v46, v46, v4
  v_mul_f32 v47, v47, v4
  v_mul_f32 v48, v48, v4
  v_mul_f32 v49, v49, v4
  v_mul_f32 v50, v50, v4
  v_mul_f32 v51, v51, v4
  v_mul_f32 v52, v52, v4
  v_mul_f32 v53, v53, v4
  v_mul_f32 v54, v54, v4
  v_mul_f32 v55, v55, v4
  v_mul_f32 v56, v56, v4
  v_mul_f32 v57, v57, v4
  v_mul_f32 v58, v58, v4
  v_mul_f32 v59, v59, v4
  v_mul_f32 v60, v60, v4
  v_mul_f32 v61, v61, v4
  v_mul_f32 v62, v62, v4
  v_mul_f32 v63, v63, v4
  v_mul_f32 v64, v64, v4
  v_mul_f32 v65, v65, v4
  v_mul_f32 v66, v66, v4
  v_mul_f32 v67, v67, v4
  v_cvt_pk_bf16_f32 v8, v28, v29
  v_cvt_pk_bf16_f32 v9, v30, v31
  v_cvt_pk_bf16_f32 v10, v32, v33
  v_cvt_pk_bf16_f32 v11, v34, v35
  v_cvt_pk_bf16_f32 v12, v36, v37
  v_cvt_pk_bf16_f32 v13, v38, v39
  v_cvt_pk_bf16_f32 v14, v40, v41
  v_cvt_pk_bf16_f32 v15, v42, v43
  v_cvt_pk_bf16_f32 v16, v44, v45
  v_cvt_pk_bf16_f32 v17, v46, v47
  v_cvt_pk_bf16_f32 v18, v48, v49
  v_cvt_pk_bf16_f32 v19, v50, v51
  v_cvt_pk_bf16_f32 v20, v52, v53
  v_cvt_pk_bf16_f32 v21, v54, v55
  v_cvt_pk_bf16_f32 v22, v56, v57
  v_cvt_pk_bf16_f32 v23, v58, v59
  v_cvt_pk_bf16_f32 v24, v60, v61
  v_cvt_pk_bf16_f32 v25, v62, v63
  v_cvt_pk_bf16_f32 v26, v64, v65
  v_cvt_pk_bf16_f32 v27, v66, v67
  v_and_b32 v3, 63, v0
  v_lshlrev_b32 v1, 4, v3
  s_mul_i32 s17, s2, 20480
  s_mul_i32 s18, s16, 5120
  s_add_u32 s17, s17, s18
  s_add_u32 s17, s17, 153616384
  buffer_store_dwordx4 v[8:11], v1, s[4:7], s17 offen offset:0
  buffer_store_dwordx4 v[12:15], v1, s[4:7], s17 offen offset:1024
  buffer_store_dwordx4 v[16:19], v1, s[4:7], s17 offen offset:2048
  buffer_store_dwordx4 v[20:23], v1, s[4:7], s17 offen offset:3072
  s_add_u32 s17, s17, 4096
  buffer_store_dwordx4 v[24:27], v1, s[4:7], s17 offen offset:0
ln1_exit1:
  s_endpgm
.globl ln2_kernel
.p2align 8
.type ln2_kernel,@function
ln2_kernel:
  s_cmp_ge_u32 s2, 128
  s_cbranch_scc1 ln2_exit1
  s_load_dwordx2 s[12:13], s[0:1], 96
  s_load_dwordx2 s[14:15], s[0:1], 0
  v_lshrrev_b32 v2, 6, v0
  v_and_b32 v3, 63, v0
  s_nop 0
  v_readfirstlane_b32 s16, v2
  s_waitcnt lgkmcnt(0)
  s_mov_b32 s4, s12
  s_mov_b32 s5, s13
  s_mov_b32 s6, 0x10000000
  s_mov_b32 s7, 0x20000
  s_mov_b32 s8, s12
  s_mov_b32 s9, s13
  s_mov_b32 s10, 0x10000000
  s_mov_b32 s11, 0x20000
  s_mov_b32 s20, 150994944
  v_and_b32 v2, 15, v3
  v_lshrrev_b32 v4, 4, v3
  s_lshl_b32 s17, s2, 4
  v_add_u32 v1, s17, v2
  v_mul_u32_u24 v1, 1280, v1
  v_lshl_add_u32 v1, v4, 4, v1
  s_mul_i32 s17, s16, 320
  s_add_u32 s20, s20, s17
  buffer_load_dwordx4 v[8:11], v1, s[8:11], s20 offen offset:0
  buffer_load_dwordx4 v[12:15], v1, s[8:11], s20 offen offset:64
  buffer_load_dwordx4 v[16:19], v1, s[8:11], s20 offen offset:128
  buffer_load_dwordx4 v[20:23], v1, s[8:11], s20 offen offset:192
  buffer_load_dwordx4 v[24:27], v1, s[8:11], s20 offen offset:256
  v_lshlrev_b32 v5, 2, v2
  s_lshl_b32 s17, s16, 6
  v_add_u32 v1, s17, v5
  s_waitcnt vmcnt(0)
  v_lshlrev_b32 v28, 16, v8
  v_and_b32 v29, 0xffff0000, v8
  v_lshlrev_b32 v30, 16, v9
  v_and_b32 v31, 0xffff0000, v9
  v_lshlrev_b32 v32, 16, v10
  v_and_b32 v33, 0xffff0000, v10
  v_lshlrev_b32 v34, 16, v11
  v_and_b32 v35, 0xffff0000, v11
  v_lshlrev_b32 v36, 16, v12
  v_and_b32 v37, 0xffff0000, v12
  v_lshlrev_b32 v38, 16, v13
  v_and_b32 v39, 0xffff0000, v13
  v_lshlrev_b32 v40, 16, v14
  v_and_b32 v41, 0xffff0000, v14
  v_lshlrev_b32 v42, 16, v15
  v_and_b32 v43, 0xffff0000, v15
  v_lshlrev_b32 v44, 16, v16
  v_and_b32 v45, 0xffff0000, v16
  v_lshlrev_b32 v46, 16, v17
  v_and_b32 v47, 0xffff0000, v17
  v_lshlrev_b32 v48, 16, v18
  v_and_b32 v49, 0xffff0000, v18
  v_lshlrev_b32 v50, 16, v19
  v_and_b32 v51, 0xffff0000, v19
  v_lshlrev_b32 v52, 16, v20
  v_and_b32 v53, 0xffff0000, v20
  v_lshlrev_b32 v54, 16, v21
  v_and_b32 v55, 0xffff0000, v21
  v_lshlrev_b32 v56, 16, v22
  v_and_b32 v57, 0xffff0000, v22
  v_lshlrev_b32 v58, 16, v23
  v_and_b32 v59, 0xffff0000, v23
  v_lshlrev_b32 v60, 16, v24
  v_and_b32 v61, 0xffff0000, v24
  v_lshlrev_b32 v62, 16, v25
  v_and_b32 v63, 0xffff0000, v25
  v_lshlrev_b32 v64, 16, v26
  v_and_b32 v65, 0xffff0000, v26
  v_lshlrev_b32 v66, 16, v27
  v_and_b32 v67, 0xffff0000, v27
  v_pk_add_f32 v[6:7], v[28:29], v[30:31]
  v_pk_add_f32 v[6:7], v[6:7], v[32:33]
  v_pk_add_f32 v[6:7], v[6:7], v[34:35]
  v_pk_add_f32 v[6:7], v[6:7], v[36:37]
  v_pk_add_f32 v[6:7], v[6:7], v[38:39]
  v_pk_add_f32 v[6:7], v[6:7], v[40:41]
  v_pk_add_f32 v[6:7], v[6:7], v[42:43]
  v_pk_add_f32 v[6:7], v[6:7], v[44:45]
  v_pk_add_f32 v[6:7], v[6:7], v[46:47]
  v_pk_add_f32 v[6:7], v[6:7], v[48:49]
  v_pk_add_f32 v[6:7], v[6:7], v[50:51]
  v_pk_add_f32 v[6:7], v[6:7], v[52:53]
  v_pk_add_f32 v[6:7], v[6:7], v[54:55]
  v_pk_add_f32 v[6:7], v[6:7], v[56:57]
  v_pk_add_f32 v[6:7], v[6:7], v[58:59]
  v_pk_add_f32 v[6:7], v[6:7], v[60:61]
  v_pk_add_f32 v[6:7], v[6:7], v[62:63]
  v_pk_add_f32 v[6:7], v[6:7], v[64:65]
  v_pk_add_f32 v[6:7], v[6:7], v[66:67]
  v_add_f32 v4, v6, v7
  v_mov_b32 v2, v4
  s_nop 1
  v_permlane32_swap_b32 v4, v2
  v_add_f32 v4, v4, v2
  v_mov_b32 v2, v4
  s_nop 1
  v_permlane16_swap_b32 v4, v2
  v_add_f32 v4, v4, v2
  ds_write_b32 v1, v4 offset:0
  s_waitcnt lgkmcnt(0)
  s_barrier
  ds_read_b32 v4, v5 offset:0
  ds_read_b32 v2, v5 offset:64
  ds_read_b32 v3, v5 offset:128
  ds_read_b32 v6, v5 offset:192
  s_waitcnt lgkmcnt(0)
  v_add_f32 v4, v4, v2
  v_add_f32 v3, v3, v6
  v_add_f32 v4, v4, v3
  v_mul_f32 v4, 0x3acccccd, v4
  v_sub_f32 v28, v28, v4
  v_sub_f32 v29, v29, v4
  v_sub_f32 v30, v30, v4
  v_sub_f32 v31, v31, v4
  v_sub_f32 v32, v32, v4
  v_sub_f32 v33, v33, v4
  v_sub_f32 v34, v34, v4
  v_sub_f32 v35, v35, v4
  v_sub_f32 v36, v36, v4
  v_sub_f32 v37, v37, v4
  v_sub_f32 v38, v38, v4
  v_sub_f32 v39, v39, v4
  v_sub_f32 v40, v40, v4
  v_sub_f32 v41, v41, v4
  v_sub_f32 v42, v42, v4
  v_sub_f32 v43, v43, v4
  v_sub_f32 v44, v44, v4
  v_sub_f32 v45, v45, v4
  v_sub_f32 v46, v46, v4
  v_sub_f32 v47, v47, v4
  v_sub_f32 v48, v48, v4
  v_sub_f32 v49, v49, v4
  v_sub_f32 v50, v50, v4
  v_sub_f32 v51, v51, v4
  v_sub_f32 v52, v52, v4
  v_sub_f32 v53, v53, v4
  v_sub_f32 v54, v54, v4
  v_sub_f32 v55, v55, v4
  v_sub_f32 v56, v56, v4
  v_sub_f32 v57, v57, v4
  v_sub_f32 v58, v58, v4
  v_sub_f32 v59, v59, v4
  v_sub_f32 v60, v60, v4
  v_sub_f32 v61, v61, v4
  v_sub_f32 v62, v62, v4
  v_sub_f32 v63, v63, v4
  v_sub_f32 v64, v64, v4
  v_sub_f32 v65, v65, v4
  v_sub_f32 v66, v66, v4
  v_sub_f32 v67, v67, v4
  v_mul_f32 v6, v28, v28
  v_mul_f32 v7, v29, v29
  v_fmac_f32 v6, v30, v30
  v_fmac_f32 v7, v31, v31
  v_fmac_f32 v6, v32, v32
  v_fmac_f32 v7, v33, v33
  v_fmac_f32 v6, v34, v34
  v_fmac_f32 v7, v35, v35
  v_fmac_f32 v6, v36, v36
  v_fmac_f32 v7, v37, v37
  v_fmac_f32 v6, v38, v38
  v_fmac_f32 v7, v39, v39
  v_fmac_f32 v6, v40, v40
  v_fmac_f32 v7, v41, v41
  v_fmac_f32 v6, v42, v42
  v_fmac_f32 v7, v43, v43
  v_fmac_f32 v6, v44, v44
  v_fmac_f32 v7, v45, v45
  v_fmac_f32 v6, v46, v46
  v_fmac_f32 v7, v47, v47
  v_fmac_f32 v6, v48, v48
  v_fmac_f32 v7, v49, v49
  v_fmac_f32 v6, v50, v50
  v_fmac_f32 v7, v51, v51
  v_fmac_f32 v6, v52, v52
  v_fmac_f32 v7, v53, v53
  v_fmac_f32 v6, v54, v54
  v_fmac_f32 v7, v55, v55
  v_fmac_f32 v6, v56, v56
  v_fmac_f32 v7, v57, v57
  v_fmac_f32 v6, v58, v58
  v_fmac_f32 v7, v59, v59
  v_fmac_f32 v6, v60, v60
  v_fmac_f32 v7, v61, v61
  v_fmac_f32 v6, v62, v62
  v_fmac_f32 v7, v63, v63
  v_fmac_f32 v6, v64, v64
  v_fmac_f32 v7, v65, v65
  v_fmac_f32 v6, v66, v66
  v_fmac_f32 v7, v67, v67
  v_add_f32 v4, v6, v7
  v_mov_b32 v2, v4
  s_nop 1
  v_permlane32_swap_b32 v4, v2
  v_add_f32 v4, v4, v2
  v_mov_b32 v2, v4
  s_nop 1
  v_permlane16_swap_b32 v4, v2
  v_add_f32 v4, v4, v2
  ds_write_b32 v1, v4 offset:256
  s_waitcnt lgkmcnt(0)
  s_barrier
  ds_read_b32 v4, v5 offset:256
  ds_read_b32 v2, v5 offset:320
  ds_read_b32 v3, v5 offset:384
  ds_read_b32 v6, v5 offset:448
  s_waitcnt lgkmcnt(0)
  v_add_f32 v4, v4, v2
  v_add_f32 v3, v3, v6
  v_add_f32 v4, v4, v3
  v_mov_b32 v2, 0x3727c5ac
  v_fmac_f32 v2, 0x3acccccd, v4
  v_rsq_f32 v4, v2
  s_nop 0
  v_mul_f32 v28, v28, v4
  v_mul_f32 v29, v29, v4
  v_mul_f32 v30, v30, v4
  v_mul_f32 v31, v31, v4
  v_mul_f32 v32, v32, v4
  v_mul_f32 v33, v33, v4
  v_mul_f32 v34, v34, v4
  v_mul_f32 v35, v35, v4
  v_mul_f32 v36, v36, v4
  v_mul_f32 v37, v37, v4
  v_mul_f32 v38, v38, v4
  v_mul_f32 v39, v39, v4
  v_mul_f32 v40, v40, v4
  v_mul_f32 v41, v41, v4
  v_mul_f32 v42, v42, v4
  v_mul_f32 v43, v43, v4
  v_mul_f32 v44, v44, v4
  v_mul_f32 v45, v45, v4
  v_mul_f32 v46, v46, v4
  v_mul_f32 v47, v47, v4
  v_mul_f32 v48, v48, v4
  v_mul_f32 v49, v49, v4
  v_mul_f32 v50, v50, v4
  v_mul_f32 v51, v51, v4
  v_mul_f32 v52, v52, v4
  v_mul_f32 v53, v53, v4
  v_mul_f32 v54, v54, v4
  v_mul_f32 v55, v55, v4
  v_mul_f32 v56, v56, v4
  v_mul_f32 v57, v57, v4
  v_mul_f32 v58, v58, v4
  v_mul_f32 v59, v59, v4
  v_mul_f32 v60, v60, v4
  v_mul_f32 v61, v61, v4
  v_mul_f32 v62, v62, v4
  v_mul_f32 v63, v63, v4
  v_mul_f32 v64, v64, v4
  v_mul_f32 v65, v65, v4
  v_mul_f32 v66, v66, v4
  v_mul_f32 v67, v67, v4
  v_cvt_pk_bf16_f32 v8, v28, v29
  v_cvt_pk_bf16_f32 v9, v30, v31
  v_cvt_pk_bf16_f32 v10, v32, v33
  v_cvt_pk_bf16_f32 v11, v34, v35
  v_cvt_pk_bf16_f32 v12, v36, v37
  v_cvt_pk_bf16_f32 v13, v38, v39
  v_cvt_pk_bf16_f32 v14, v40, v41
  v_cvt_pk_bf16_f32 v15, v42, v43
  v_cvt_pk_bf16_f32 v16, v44, v45
  v_cvt_pk_bf16_f32 v17, v46, v47
  v_cvt_pk_bf16_f32 v18, v48, v49
  v_cvt_pk_bf16_f32 v19, v50, v51
  v_cvt_pk_bf16_f32 v20, v52, v53
  v_cvt_pk_bf16_f32 v21, v54, v55
  v_cvt_pk_bf16_f32 v22, v56, v57
  v_cvt_pk_bf16_f32 v23, v58, v59
  v_cvt_pk_bf16_f32 v24, v60, v61
  v_cvt_pk_bf16_f32 v25, v62, v63
  v_cvt_pk_bf16_f32 v26, v64, v65
  v_cvt_pk_bf16_f32 v27, v66, v67
  v_and_b32 v3, 63, v0
  v_lshlrev_b32 v1, 4, v3
  s_mul_i32 s17, s2, 20480
  s_mul_i32 s18, s16, 5120
  s_add_u32 s17, s17, s18
  s_add_u32 s17, s17, 153616384
  buffer_store_dwordx4 v[8:11], v1, s[4:7], s17 offen offset:0
  buffer_store_dwordx4 v[12:15], v1, s[4:7], s17 offen offset:1024
  buffer_store_dwordx4 v[16:19], v1, s[4:7], s17 offen offset:2048
  buffer_store_dwordx4 v[20:23], v1, s[4:7], s17 offen offset:3072
  s_add_u32 s17, s17, 4096
  buffer_store_dwordx4 v[24:27], v1, s[4:7], s17 offen offset:0
ln2_exit1:
  s_endpgm
.globl reca_kernel
.p2align 8
.type reca_kernel,@function
reca_kernel:
  s_cmp_ge_u32 s2, 256
  s_cbranch_scc1 reca_exit1
  s_load_dwordx2 s[48:49], s[0:1], 96
  s_load_dwordx2 s[50:51], s[0:1], 88
  s_load_dwordx2 s[52:53], s[0:1], 8
  s_getreg_b32 s13, hwreg(HW_REG_XCC_ID, 0, 3)
  v_lshrrev_b32 v28, 6, v0
  v_and_b32 v1, 63, v0
  s_nop 0
  v_readfirstlane_b32 s12, v28
  v_lshlrev_b32 v1, 4, v1
  s_mov_b32 s18, 0x100000
  s_waitcnt lgkmcnt(0)
  s_mov_b32 s4, s48
  s_mov_b32 s5, s49
  s_mov_b32 s6, 0x10000000
  s_mov_b32 s7, 0x20000
  s_mov_b32 s8, s50
  s_mov_b32 s9, s51
  s_mov_b32 s10, 256
  s_mov_b32 s11, 0x20000
  v_and_b32 v29, 63, v0
  v_add_u32 v2, 0x1000, v1
  v_add_u32 v3, 0x2000, v1
  v_mov_b32 v32, -1
  v_mov_b32 v33, -1
  v_mov_b32 v34, -1
  v_mov_b32 v35, -1
  s_sub_u32 s56, 0, s48
  s_and_b32 s56, s56, 0x1fffff
  s_add_u32 s56, s56, 2097152
  v_cmp_eq_u32 vcc, 0, v0
  s_lshl_b32 s34, s13, 2
  v_mov_b32 v30, s34
  v_mov_b32 v31, 0x80000000
  v_cndmask_b32 v30, v31, v30, vcc
  v_mov_b32 v44, 1
  buffer_atomic_add v44, v30, s[8:11], 0 offen sc0
  s_mul_i32 s34, s2, 6048
  s_add_u32 s34, s34, 0
  s_mul_i32 s35, s2, 6144
  s_add_u32 s35, s35, s56
  v_lshlrev_b32 v48, 4, v0
  v_add_u32 v49, 0x1000, v48
  v_mov_b32 v50, v49
  v_cmp_gt_u32 vcc, 122, v0
  s_nop 1
  v_cndmask_b32 v49, v31, v49, vcc
  v_cmp_gt_u32 vcc, 128, v0
  s_nop 1
  v_cndmask_b32 v50, v31, v50, vcc
  buffer_store_dwordx4 v[32:35], v48, s[4:7], s34 offen sc1
  buffer_store_dwordx4 v[32:35], v49, s[4:7], s34 offen sc1
  buffer_store_dwordx4 v[32:35], v48, s[4:7], s35 offen sc1
  buffer_store_dwordx4 v[32:35], v50, s[4:7], s35 offen sc1
  s_cmp_lg_u32 s12, 1
  s_cbranch_scc1 reca_noprobe3
  s_lshr_b32 s34, s2, 4
  s_lshl_b32 s34, s34, 14
  s_and_b32 s35, s2, 15
  s_lshl_b32 s35, s35, 9
  s_add_u32 s34, s34, s35
  s_add_u32 s34, s34, 1572864
  s_add_u32 s34, s34, s56
  v_and_b32 v28, 63, v0
  v_and_b32 v29, 3, v28
  v_lshlrev_b32 v29, 7, v29
  v_lshrrev_b32 v30, 2, v28
  v_lshl_add_u32 v29, v30, 13, v29
  v_cmp_gt_u32 vcc, 8, v28
  s_nop 1
  v_cndmask_b32 v29, v31, v29, vcc
  buffer_store_dword v32, v29, s[4:7], s34 offen sc1
  v_cmp_eq_u32 vcc, 0, v28
  v_mov_b32 v29, 0
  s_nop 0
  v_cndmask_b32 v29, v31, v29, vcc
  s_mov_b32 s20, 0
  s_mov_b32 s21, 0
  s_waitcnt vmcnt(0)
  s_add_u32 s35, s34, 0
  s_memtime s[58:59]
  s_waitcnt lgkmcnt(0)
  buffer_load_dword v30, v29, s[4:7], s35 offen sc1
  s_waitcnt vmcnt(0)
  s_memtime s[60:61]
  s_waitcnt lgkmcnt(0)
  s_sub_u32 s36, s60, s58
  s_add_u32 s20, s20, s36
  s_add_u32 s35, s34, 8192
  s_memtime s[58:59]
  s_waitcnt lgkmcnt(0)
  buffer_load_dword v30, v29, s[4:7], s35 offen sc1
  s_waitcnt vmcnt(0)
  s_memtime s[60:61]
  s_waitcnt lgkmcnt(0)
  s_sub_u32 s36, s60, s58
  s_add_u32 s21, s21, s36
  s_add_u32 s35, s34, 128
  s_memtime s[58:59]
  s_waitcnt lgkmcnt(0)
  buffer_load_dword v30, v29, s[4:7], s35 offen sc1
  s_waitcnt vmcnt(0)
  s_memtime s[60:61]
  s_waitcnt lgkmcnt(0)
  s_sub_u32 s36, s60, s58
  s_add_u32 s20, s20, s36
  s_add_u32 s35, s34, 8320
  s_memtime s[58:59]
  s_waitcnt lgkmcnt(0)
  buffer_load_dword v30, v29, s[4:7], s35 offen sc1
  s_waitcnt vmcnt(0)
  s_memtime s[60:61]
  s_waitcnt lgkmcnt(0)
  s_sub_u32 s36, s60, s58
  s_add_u32 s21, s21, s36
  s_cmp_lt_u32 s21, s20
  s_cselect_b32 s34, 1, 0
  s_lshr_b32 s35, s13, 2
  s_xor_b32 s34, s34, s35
  v_mov_b32 v29, 13316
  v_mov_b32 v30, s34
  ds_write_b32 v29, v30
  s_waitcnt lgkmcnt(0)
reca_noprobe3:
  s_waitcnt vmcnt(0)
  s_barrier
  s_cmp_lg_u32 s12, 0
  s_cbranch_scc1 reca_w0done4
  v_readfirstlane_b32 s14, v44
  v_cmp_eq_u32 vcc, 0, v0
  v_mov_b32 v30, 32
  s_nop 0
  v_cndmask_b32 v30, v31, v30, vcc
  v_mov_b32 v29, 13316
  ds_read_b32 v44, v29
  s_waitcnt lgkmcnt(0)
  v_lshlrev_b32 v44, 16, v44
  v_add_u32 v44, 1, v44
  buffer_atomic_add v44, v30, s[8:11], 0 offen
  v_lshlrev_b32 v30, 2, v0
reca_rdy5:
  buffer_load_dword v44, v30, s[8:11], 0 offen sc1
  s_waitcnt vmcnt(0)
  v_readlane_b32 s35, v44, 8
  s_nop 3
  s_and_b32 s34, s35, 0xffff
  s_cmp_eq_u32 s34, 256
  s_cbranch_scc1 reca_rdy5_ok
  s_sub_u32 s18, s18, 1
  s_cbranch_scc0 reca_rdy5
  s_mov_b32 s18, 0
reca_rdy5_ok:
  s_lshr_b32 s35, s35, 16
  s_cmp_gt_u32 s35, 128
  s_cselect_b32 s35, 1, 0
  s_lshr_b32 s34, s13, 2
  s_xor_b32 s35, s35, s34
  v_mov_b32 v30, 13312
  v_mov_b32 v44, s14
  v_mov_b32 v45, s35
  ds_write_b64 v30, v[44:45]
  s_waitcnt lgkmcnt(0)
reca_w0done4:
  s_barrier
  v_mov_b32 v30, 13312
  ds_read_b64 v[44:45], v30
  s_waitcnt lgkmcnt(0)
  v_readfirstlane_b32 s14, v44
  v_readfirstlane_b32 s57, v45
  s_nop 2
  s_cmp_ge_u32 s14, 24
  s_cbranch_scc1 reca_warm2
  s_mul_i32 s34, s14, 43
  s_lshr_b32 s34, s34, 8
  s_mul_i32 s35, s34, 6
  s_sub_u32 s16, s14, s35
  s_lshl_b32 s15, s13, 2
  s_add_u32 s15, s15, s34
  s_lshr_b32 s19, s12, 1
  v_and_b32 v29, 63, v0
  v_and_b32 v28, 15, v29
  v_lshrrev_b32 v30, 4, v29
  v_mov_b32 v31, 0x80000000
  s_mul_i32 s34, s12, 2560
  v_add_u32 v4, s34, v1
  v_and_b32 v44, 31, v29
  v_lshlrev_b32 v44, 4, v44
  s_add_u32 s34, s34, 2048
  v_add_u32 v5, s34, v44
  v_and_b32 v44, 7, v29
  v_lshlrev_b32 v44, 4, v44
  v_lshl_add_u32 v44, v30, 7, v44
  s_mul_i32 s34, s19, 5120
  v_add_u32 v6, s34, v44
  s_sub_u32 s34, 5120, s34
  v_add_u32 v7, s34, v44
  v_lshrrev_b32 v45, 3, v28
  v_lshl_add_u32 v12, v45, 9, v44
  v_add_u32 v13, 0x1000, v12
  v_add_u32 v14, 0x2000, v12
  v_cmp_gt_u32 s[54:55], 8, v28
  s_lshl_b32 s34, s16, 10
  s_lshl_b32 s35, s19, 7
  s_add_u32 s34, s34, s35
  s_and_b32 s35, s12, 1
  s_lshl_b32 s36, s35, 3
  s_add_u32 s34, s34, s36
  v_lshlrev_b32 v44, 4, v28
  v_lshl_add_u32 v45, v30, 8, v44
  v_add_u32 v45, s34, v45
  v_cndmask_b32 v8, v31, v45, s[54:55]
  v_lshl_add_u32 v44, v30, 7, v44
  v_add_u32 v45, s36, v44
  v_cndmask_b32 v9, v31, v45, s[54:55]
  s_lshl_b32 s34, s14, 9
  v_add_u32 v45, s34, v44
  v_cndmask_b32 v11, v31, v45, s[54:55]
  s_mul_i32 s34, s13, 49152
  s_lshr_b32 s35, s14, 3
  s_lshl_b32 s35, s35, 14
  s_add_u32 s34, s34, s35
  s_and_b32 s35, s14, 7
  s_lshl_b32 s35, s35, 10
  s_add_u32 s34, s34, s35
  s_lshl_b32 s35, s12, 9
  s_add_u32 s34, s34, s35
  v_add_u32 v45, s34, v44
  v_cndmask_b32 v15, v31, v45, s[54:55]
  v_lshlrev_b32 v45, 3, v29
  v_cmp_gt_u32 vcc, 32, v29
  s_nop 1
  v_cndmask_b32 v10, v31, v45, vcc
  s_sub_u32 s35, s14, 4
  s_cmp_lt_u32 s14, 20
  s_cselect_b32 s34, s14, s35
  s_lshr_b32 s35, s34, 3
  s_lshl_b32 s35, s35, 14
  s_and_b32 s34, s34, 7
  s_lshl_b32 s34, s34, 10
  s_add_u32 s34, s34, s35
  s_lshl_b32 s35, s57, 13
  s_add_u32 s34, s34, s35
  v_add_u32 v20, s34, v1
  v_add_u32 v21, 49152, v20
  v_add_u32 v22, 98304, v20
  v_add_u32 v23, 147456, v20
  v_add_u32 v24, 196608, v20
  v_add_u32 v25, 245760, v20
  v_add_u32 v26, 294912, v20
  v_add_u32 v27, 344064, v20
  v_lshrrev_b32 v44, 3, v29
  v_and_b32 v44, 3, v44
  v_lshlrev_b32 v44, 7, v44
  v_and_b32 v45, 7, v29
  v_lshl_add_u32 v44, v45, 4, v44
  v_lshrrev_b32 v45, 5, v29
  v_lshl_add_u32 v44, v45, 3, v44
  s_lshl_b32 s34, s14, 9
  s_cmp_lt_u32 s14, 20
  s_cselect_b32 s34, s34, 0x80000000
  v_add_u32 v16, s34, v44
  s_cmp_lt_u32 s14, 20
  s_cselect_b32 s34, 0, 0x80000000
  v_or_b32 v15, s34, v15
  v_add_u32 v232, 0x2000, v15
  v_cmp_eq_u32 vcc, 0, v29
  v_mov_b32 v45, 0
  s_nop 0
  v_cndmask_b32 v19, v31, v45, vcc
  s_lshl_b32 s34, s15, 1
  s_lshl_b32 s34, s34, 7
  s_add_u32 s34, s34, 1540096
  v_and_b32 v45, 1, v29
  v_lshlrev_b32 v45, 7, v45
  v_add_u32 v233, s34, v45
  s_lshl_b32 s34, s12, 10
  s_add_u32 s34, s34, 10240
  v_add_u32 v17, s34, v1
  v_mov_b32 v36, 0x3f803f80
  v_mov_b32 v37, 0x3f803f80
  v_mov_b32 v38, 0x3f803f80
  v_mov_b32 v39, 0x3f803f80
  v_mov_b32 v44, 0xf149f2ca
  v_cmp_gt_u32 vcc, 2, v30
  s_nop 1
  v_cndmask_b32 v40, 0, v44, vcc
  v_mov_b32 v41, v40
  v_mov_b32 v42, v40
  v_mov_b32 v43, v40
  s_mov_b32 s41, 0x3dd53b95
  s_mul_i32 s38, s13, 40960
  s_add_u32 s38, s38, 0
  s_mul_i32 s39, s15, 24576
  s_add_u32 s39, s39, 327680
  s_mul_i32 s40, s13, 49152
  s_add_u32 s40, s40, 1114112
  s_and_b32 s37, s12, 1
  s_mul_i32 s34, s15, 12
  s_lshl_b32 s35, s16, 1
  s_add_u32 s34, s34, s35
  s_add_u32 s34, s34, s37
  s_mul_i32 s34, s34, 20480
  s_mov_b32 s35, 14155776
  s_cmp_eq_u32 s19, 0
  s_cselect_b32 s35, 6291456, s35
  s_add_u32 s35, s35, s34
  s_mul_i32 s36, s19, 10240
  s_add_u32 s20, s35, s36
  s_sub_u32 s36, 10240, s36
  s_add_u32 s21, s35, s36
  s_add_u32 s22, s34, 22020096
  s_mul_i32 s36, s19, 10240
  s_add_u32 s22, s22, s36
  buffer_load_dwordx4 a[0:3], v1, s[4:7], s20 offen offset:0
  buffer_load_dwordx4 a[4:7], v1, s[4:7], s20 offen offset:1024
  buffer_load_dwordx4 a[8:11], v1, s[4:7], s20 offen offset:2048
  buffer_load_dwordx4 a[12:15], v1, s[4:7], s20 offen offset:3072
  buffer_load_dwordx4 a[16:19], v2, s[4:7], s20 offen offset:0
  buffer_load_dwordx4 a[20:23], v2, s[4:7], s20 offen offset:1024
  buffer_load_dwordx4 a[24:27], v2, s[4:7], s20 offen offset:2048
  buffer_load_dwordx4 a[28:31], v2, s[4:7], s20 offen offset:3072
  buffer_load_dwordx4 a[32:35], v3, s[4:7], s20 offen offset:0
  buffer_load_dwordx4 a[36:39], v3, s[4:7], s20 offen offset:1024
  buffer_load_dwordx4 a[40:43], v1, s[4:7], s21 offen offset:0
  buffer_load_dwordx4 a[44:47], v1, s[4:7], s21 offen offset:1024
  buffer_load_dwordx4 a[48:51], v1, s[4:7], s21 offen offset:2048
  buffer_load_dwordx4 a[52:55], v1, s[4:7], s21 offen offset:3072
  buffer_load_dwordx4 a[56:59], v2, s[4:7], s21 offen offset:0
  buffer_load_dwordx4 a[60:63], v2, s[4:7], s21 offen offset:1024
  buffer_load_dwordx4 a[64:67], v2, s[4:7], s21 offen offset:2048
  buffer_load_dwordx4 a[68:71], v2, s[4:7], s21 offen offset:3072
  buffer_load_dwordx4 a[72:75], v3, s[4:7], s21 offen offset:0
  buffer_load_dwordx4 a[76:79], v3, s[4:7], s21 offen offset:1024
  buffer_load_dwordx4 a[80:83], v1, s[4:7], s22 offen offset:0
  buffer_load_dwordx4 a[84:87], v1, s[4:7], s22 offen offset:1024
  buffer_load_dwordx4 a[88:91], v1, s[4:7], s22 offen offset:2048
  buffer_load_dwordx4 a[92:95], v1, s[4:7], s22 offen offset:3072
  buffer_load_dwordx4 a[96:99], v2, s[4:7], s22 offen offset:0
  buffer_load_dwordx4 a[100:103], v2, s[4:7], s22 offen offset:1024
  buffer_load_dwordx4 a[104:107], v2, s[4:7], s22 offen offset:2048
  buffer_load_dwordx4 a[108:111], v2, s[4:7], s22 offen offset:3072
  buffer_load_dwordx4 a[112:115], v3, s[4:7], s22 offen offset:0
  buffer_load_dwordx4 a[116:119], v3, s[4:7], s22 offen offset:1024
  s_cmp_ge_u32 s14, 20
  s_cbranch_scc1 reca_now26
  s_cmp_ge_u32 s12, 2
  s_cbranch_scc1 reca_now26
  s_lshl_b32 s34, s14, 1
  s_add_u32 s34, s34, s12
  s_mul_i32 s34, s34, 192
  s_mul_i32 s35, s13, 24
  s_add_u32 s34, s34, s35
  s_lshl_b32 s34, s34, 10
  s_add_u32 s34, s34, 29884416
  buffer_load_dwordx4 a[120:123], v1, s[4:7], s34 offen offset:0
  buffer_load_dwordx4 a[124:127], v1, s[4:7], s34 offen offset:1024
  buffer_load_dwordx4 a[128:131], v1, s[4:7], s34 offen offset:2048
  buffer_load_dwordx4 a[132:135], v1, s[4:7], s34 offen offset:3072
  buffer_load_dwordx4 a[136:139], v2, s[4:7], s34 offen offset:0
  buffer_load_dwordx4 a[140:143], v2, s[4:7], s34 offen offset:1024
  buffer_load_dwordx4 a[144:147], v2, s[4:7], s34 offen offset:2048
  buffer_load_dwordx4 a[148:151], v2, s[4:7], s34 offen offset:3072
  buffer_load_dwordx4 a[152:155], v3, s[4:7], s34 offen offset:0
  buffer_load_dwordx4 a[156:159], v3, s[4:7], s34 offen offset:1024
  buffer_load_dwordx4 a[160:163], v3, s[4:7], s34 offen offset:2048
  buffer_load_dwordx4 a[164:167], v3, s[4:7], s34 offen offset:3072
  s_add_u32 s34, s34, 12288
  buffer_load_dwordx4 a[168:171], v1, s[4:7], s34 offen offset:0
  buffer_load_dwordx4 a[172:175], v1, s[4:7], s34 offen offset:1024
  buffer_load_dwordx4 a[176:179], v1, s[4:7], s34 offen offset:2048
  buffer_load_dwordx4 a[180:183], v1, s[4:7], s34 offen offset:3072
  buffer_load_dwordx4 a[184:187], v2, s[4:7], s34 offen offset:0
  buffer_load_dwordx4 a[188:191], v2, s[4:7], s34 offen offset:1024
  buffer_load_dwordx4 a[192:195], v2, s[4:7], s34 offen offset:2048
  buffer_load_dwordx4 a[196:199], v2, s[4:7], s34 offen offset:3072
  buffer_load_dwordx4 a[200:203], v3, s[4:7], s34 offen offset:0
  buffer_load_dwordx4 a[204:207], v3, s[4:7], s34 offen offset:1024
  buffer_load_dwordx4 a[208:211], v3, s[4:7], s34 offen offset:2048
  buffer_load_dwordx4 a[212:215], v3, s[4:7], s34 offen offset:3072
reca_now26:
  s_mov_b32 s17, 0
  s_cmp_lg_u32 s12, 2
  s_cbranch_scc1 reca_nopf07
  s_add_u32 s37, s17, 1
reca_pf8:
  buffer_load_dword v28, v233, s[4:7], 0 offen sc1
  s_waitcnt vmcnt(0)
  v_cmp_gt_i32 vcc, s37, v28
  s_cbranch_vccz reca_pfok9
  s_sleep 1
  s_sub_u32 s18, s18, 1
  s_cbranch_scc0 reca_pf8
  s_mov_b32 s18, 0
reca_pfok9:
  s_lshl_b32 s34, s15, 6
  s_add_u32 s34, s34, s17
  s_mul_i32 s34, s34, 12288
  s_add_u32 s32, s34, 37748736
  s_lshl_b32 s35, s16, 11
  s_add_u32 s34, s34, s35
  s_add_u32 s33, s34, 62914560
  s_and_b32 s35, s17, 1
  s_mul_i32 s35, s35, 14336
  s_add_u32 s35, s35, 16384
  s_add_u32 m0, s35, 0
  s_nop 0
  buffer_load_dwordx4 v1, s[4:7], s32 offen offset:0 lds
  buffer_load_dwordx4 v1, s[4:7], s32 offen offset:1024 lds
  buffer_load_dwordx4 v1, s[4:7], s32 offen offset:2048 lds
  buffer_load_dwordx4 v1, s[4:7], s32 offen offset:3072 lds
  s_add_u32 s32, s32, 4096
  s_add_u32 m0, s35, 4096
  s_nop 0
  buffer_load_dwordx4 v1, s[4:7], s32 offen offset:0 lds
  buffer_load_dwordx4 v1, s[4:7], s32 offen offset:1024 lds
  buffer_load_dwordx4 v1, s[4:7], s32 offen offset:2048 lds
  buffer_load_dwordx4 v1, s[4:7], s32 offen offset:3072 lds
  s_add_u32 s32, s32, 4096
  s_add_u32 m0, s35, 8192
  s_nop 0
  buffer_load_dwordx4 v1, s[4:7], s32 offen offset:0 lds
  buffer_load_dwordx4 v1, s[4:7], s32 offen offset:1024 lds
  buffer_load_dwordx4 v1, s[4:7], s32 offen offset:2048 lds
  buffer_load_dwordx4 v1, s[4:7], s32 offen offset:3072 lds
  s_add_u32 m0, s35, 12288
  s_nop 0
  buffer_load_dwordx4 v1, s[4:7], s33 offen offset:0 lds
  buffer_load_dwordx4 v1, s[4:7], s33 offen offset:1024 lds
reca_nopf07:
  s_mov_b32 s8, s52
  s_mov_b32 s9, s53
  s_mov_b32 s10, 10240
  v_and_b32 v29, 63, v0
  v_and_b32 v44, 7, v29
  v_mul_u32_u24 v44, 1280, v44
  v_lshrrev_b32 v45, 3, v29
  v_and_b32 v45, 3, v45
  v_lshl_add_u32 v44, v45, 4, v44
  s_mul_i32 s34, s12, 320
  v_add_u32 v44, s34, v44
  v_add_u32 v46, 256, v44
  v_lshrrev_b32 v45, 5, v29
  v_lshl_add_u32 v44, v45, 6, v44
  buffer_load_dwordx4 v[128:131], v44, s[8:11], 0 offen
  buffer_load_dwordx4 v[132:135], v44, s[8:11], 0 offen offset:128
  buffer_load_dwordx4 v[136:139], v46, s[8:11], 0 offen
  s_waitcnt vmcnt(0)
  s_branch reca_gotmem11
reca_step10:
  s_and_b32 s34, s17, 3
  s_mul_i32 s20, s34, 10240
  s_add_u32 s20, s20, s38
  s_sleep 2
  buffer_load_dwordx4 v[128:131], v4, s[4:7], s20 offen sc1
  buffer_load_dwordx4 v[132:135], v4, s[4:7], s20 offen offset:1024 sc1
  buffer_load_dwordx4 v[136:139], v5, s[4:7], s20 offen sc1
  s_waitcnt vmcnt(2)
  v_max_u32 v29, v128, v130
  v_cmp_eq_u32 vcc, -1, v29
  s_cbranch_vccnz reca_retry12
reca_resume13:
  s_waitcnt vmcnt(1)
  v_max_u32 v29, v132, v134
  v_cmp_eq_u32 vcc, -1, v29
  ds_write_b128 v4, v[128:131]
  s_cbranch_vccnz reca_retry14
reca_resume15:
  s_waitcnt vmcnt(0)
  v_max_u32 v29, v136, v138
  v_cmp_eq_u32 vcc, -1, v29
  ds_write_b128 v4, v[132:135] offset:1024
  s_cbranch_vccnz reca_retry16
reca_resume17:
  ds_write_b128 v5, v[136:139]
  s_branch reca_gotmem218
reca_gotmem11:
  ds_write_b128 v4, v[128:131]
  ds_write_b128 v4, v[132:135] offset:1024
  ds_write_b128 v5, v[136:139]
reca_gotmem218:
  s_and_b32 s34, s17, 3
  s_mul_i32 s21, s34, 6144
  s_add_u32 s21, s21, s39
  s_mul_i32 s22, s34, 12288
  s_add_u32 s22, s22, s40
  s_mul_i32 s25, s34, 393216
  s_add_u32 s25, s25, s56
  s_add_u32 s35, s17, 1
  s_and_b32 s35, s35, 3
  s_mul_i32 s24, s35, 10240
  s_add_u32 s24, s24, s38
  s_waitcnt lgkmcnt(0)
  s_barrier
  ds_read_b128 v[128:131], v6 offset:0
  ds_read_b128 v[132:135], v6 offset:512
  ds_read_b128 v[136:139], v6 offset:1024
  ds_read_b128 v[140:143], v6 offset:1536
  ds_read_b128 v[144:147], v6 offset:2048
  ds_read_b128 v[148:151], v6 offset:2560
  ds_read_b128 v[152:155], v6 offset:3072
  ds_read_b128 v[156:159], v6 offset:3584
  ds_read_b128 v[160:163], v6 offset:4096
  ds_read_b128 v[164:167], v6 offset:4608
  ds_read_b128 v[168:171], v7 offset:0
  ds_read_b128 v[172:175], v7 offset:512
  ds_read_b128 v[176:179], v7 offset:1024
  s_waitcnt lgkmcnt(12)
  v_mfma_f32_16x16x32_bf16 v[44:47], a[0:3], v[128:131], 0
  ds_read_b128 v[180:183], v7 offset:1536
  s_waitcnt lgkmcnt(12)
  v_mfma_f32_16x16x32_bf16 v[44:47], a[4:7], v[132:135], v[44:47]
  ds_read_b128 v[184:187], v7 offset:2048
  s_waitcnt lgkmcnt(12)
  v_mfma_f32_16x16x32_bf16 v[44:47], a[8:11], v[136:139], v[44:47]
  ds_read_b128 v[188:191], v7 offset:2560
  s_waitcnt lgkmcnt(12)
  v_mfma_f32_16x16x32_bf16 v[44:47], a[12:15], v[140:143], v[44:47]
  ds_read_b128 v[192:195], v7 offset:3072
  s_waitcnt lgkmcnt(12)
  v_mfma_f32_16x16x32_bf16 v[44:47], a[16:19], v[144:147], v[44:47]
  ds_read_b128 v[196:199], v7 offset:3584
  s_waitcnt lgkmcnt(12)
  v_mfma_f32_16x16x32_bf16 v[44:47], a[20:23], v[148:151], v[44:47]
  ds_read_b128 v[200:203], v7 offset:4096
  s_waitcnt lgkmcnt(12)
  v_mfma_f32_16x16x32_bf16 v[44:47], a[24:27], v[152:155], v[44:47]
  ds_read_b128 v[204:207], v7 offset:4608
  s_waitcnt lgkmcnt(12)
  v_mfma_f32_16x16x32_bf16 v[44:47], a[28:31], v[156:159], v[44:47]
  s_waitcnt lgkmcnt(11)
  v_mfma_f32_16x16x32_bf16 v[44:47], a[32:35], v[160:163], v[44:47]
  s_waitcnt lgkmcnt(10)
  v_mfma_f32_16x16x32_bf16 v[44:47], a[36:39], v[164:167], v[44:47]
  s_waitcnt lgkmcnt(9)
  v_mfma_f32_16x16x32_bf16 v[44:47], a[40:43], v[168:171], v[44:47]
  s_waitcnt lgkmcnt(8)
  v_mfma_f32_16x16x32_bf16 v[44:47], a[44:47], v[172:175], v[44:47]
  s_waitcnt lgkmcnt(7)
  v_mfma_f32_16x16x32_bf16 v[44:47], a[48:51], v[176:179], v[44:47]
  s_waitcnt lgkmcnt(6)
  v_mfma_f32_16x16x32_bf16 v[44:47], a[52:55], v[180:183], v[44:47]
  s_waitcnt lgkmcnt(5)
  v_mfma_f32_16x16x32_bf16 v[44:47], a[56:59], v[184:187], v[44:47]
  s_waitcnt lgkmcnt(4)
  v_mfma_f32_16x16x32_bf16 v[44:47], a[60:63], v[188:191], v[44:47]
  s_waitcnt lgkmcnt(3)
  v_mfma_f32_16x16x32_bf16 v[44:47], a[64:67], v[192:195], v[44:47]
  s_waitcnt lgkmcnt(2)
  v_mfma_f32_16x16x32_bf16 v[44:47], a[68:71], v[196:199], v[44:47]
  s_waitcnt lgkmcnt(1)
  v_mfma_f32_16x16x32_bf16 v[44:47], a[72:75], v[200:203], v[44:47]
  s_waitcnt lgkmcnt(0)
  v_mfma_f32_16x16x32_bf16 v[44:47], a[76:79], v[204:207], v[44:47]
  v_mfma_f32_16x16x32_bf16 v[48:51], v[128:131], a[80:83], 0
  s_lshl_b32 s34, s17, 5
  s_add_u32 s34, s34, s15
  s_mul_i32 s34, s34, 3072
  s_lshl_b32 s35, s16, 9
  s_add_u32 s34, s34, s35
  s_add_u32 s30, s34, 113246208
  s_add_u32 s31, s34, 119537664
  v_cvt_pk_bf16_f32 v52, v44, v45
  v_cvt_pk_bf16_f32 v53, v46, v47
  buffer_store_dwordx2 v[52:53], v8, s[4:7], s21 offen
  v_mfma_f32_16x16x32_bf16 v[48:51], v[132:135], a[84:87], v[48:51]
  v_mfma_f32_16x16x32_bf16 v[48:51], v[136:139], a[88:91], v[48:51]
  v_mfma_f32_16x16x32_bf16 v[48:51], v[140:143], a[92:95], v[48:51]
  v_mfma_f32_16x16x32_bf16 v[48:51], v[144:147], a[96:99], v[48:51]
  v_mfma_f32_16x16x32_bf16 v[48:51], v[148:151], a[100:103], v[48:51]
  v_mfma_f32_16x16x32_bf16 v[48:51], v[152:155], a[104:107], v[48:51]
  v_mfma_f32_16x16x32_bf16 v[48:51], v[156:159], a[108:111], v[48:51]
  v_mfma_f32_16x16x32_bf16 v[48:51], v[160:163], a[112:115], v[48:51]
  v_mfma_f32_16x16x32_bf16 v[48:51], v[164:167], a[116:119], v[48:51]
  s_cmp_eq_u32 s12, 3
  s_cbranch_scc1 reca_spre21
  s_nop 5
  ds_write_b128 v17, v[48:51]
  s_cmp_lg_u32 s17, 63
  s_cbranch_scc1 reca_nokm22
  s_cmp_lg_u32 s12, 2
  s_cbranch_scc1 reca_nokm22
  buffer_store_dwordx2 v[52:53], v9, s[4:7], s30 offen
reca_nokm22:
  s_waitcnt lgkmcnt(0)
  s_branch reca_b220
reca_spre21:
  s_sleep 1
  buffer_load_dwordx4 v[208:211], v1, s[4:7], s21 offen offset:0 sc1
  buffer_load_dwordx4 v[212:215], v1, s[4:7], s21 offen offset:1024 sc1
  buffer_load_dwordx4 v[216:219], v1, s[4:7], s21 offen offset:2048 sc1
  buffer_load_dwordx4 v[220:223], v1, s[4:7], s21 offen offset:3072 sc1
  buffer_load_dwordx4 v[224:227], v2, s[4:7], s21 offen offset:0 sc1
  buffer_load_dwordx4 v[228:231], v2, s[4:7], s21 offen offset:1024 sc1
reca_b220:
  s_barrier
  s_add_u32 s34, s17, 2
  s_and_b32 s34, s34, 3
  s_mul_i32 s26, s34, 10240
  s_add_u32 s26, s26, s38
  s_mul_i32 s27, s34, 6144
  s_add_u32 s27, s27, s39
  s_mul_i32 s28, s34, 12288
  s_add_u32 s28, s28, s40
  s_mul_i32 s29, s34, 393216
  s_add_u32 s29, s29, s56
  s_cmp_eq_u32 s12, 3
  s_cbranch_scc1 reca_swave19
  s_cmp_eq_u32 s17, 63
  s_cbranch_scc1 reca_exit1
  s_barrier
  buffer_store_dwordx2 v[32:33], v8, s[4:7], s27 offen
  s_cmp_lg_u32 s12, 2
  s_cbranch_scc1 reca_w0127
  buffer_store_dwordx2 v[52:53], v9, s[4:7], s30 offen
  buffer_store_dwordx2 v[32:33], v16, s[4:7], s26 offen
  s_cmp_lg_u32 s14, 0
  s_cbranch_scc1 reca_noprog28
  v_mov_b32 v28, s17
  s_lshl_b32 s34, s13, 7
  s_add_u32 s34, s34, 1507328
  buffer_store_dword v28, v19, s[4:7], s34 offen
reca_noprog28:
  s_branch reca_b324
reca_w0127:
  s_branch reca_b324
reca_swave19:
  s_and_b32 s34, s17, 1
  s_mul_i32 s34, s34, 14336
  v_add_u32 v18, s34, v1
  ds_read_b128 v[56:59], v1 offset:10240
  ds_read_b128 v[60:63], v1 offset:11264
  ds_read_b128 v[64:67], v1 offset:12288
  ds_read_b128 v[128:131], v18 offset:16384
  ds_read_b128 v[152:155], v18 offset:22528
  ds_read_b128 v[132:135], v18 offset:17408
  ds_read_b128 v[156:159], v18 offset:23552
  ds_read_b128 v[136:139], v18 offset:18432
  ds_read_b128 v[160:163], v18 offset:24576
  ds_read_b128 v[140:143], v18 offset:19456
  ds_read_b128 v[164:167], v18 offset:25600
  ds_read_b128 v[144:147], v18 offset:20480
  ds_read_b128 v[168:171], v18 offset:26624
  ds_read_b128 v[148:151], v18 offset:21504
  s_waitcnt lgkmcnt(8)
  ds_read_b128 v[172:175], v18 offset:27648
  ds_read_b128 v[176:179], v18 offset:28672
  ds_read_b128 v[180:183], v18 offset:29696
  v_add_f32 v56, v56, v64
  v_add_f32 v60, v60, v48
  v_add_f32 v57, v57, v65
  v_add_f32 v61, v61, v49
  v_add_f32 v58, v58, v66
  v_add_f32 v62, v62, v50
  v_add_f32 v59, v59, v67
  v_add_f32 v63, v63, v51
  v_cvt_pk_bf16_f32 v68, v56, v57
  v_cvt_pk_bf16_f32 v69, v58, v59
  v_cvt_pk_bf16_f32 v70, v60, v61
  v_cvt_pk_bf16_f32 v71, v62, v63
  s_cmp_lg_u32 s17, 63
  s_cbranch_scc1 reca_vmst29
  buffer_store_dwordx2 v[52:53], v9, s[4:7], s30 offen
  buffer_store_dwordx2 v[68:69], v10, s[4:7], s31 offen
  buffer_store_dwordx2 v[70:71], v10, s[4:7], s31 offen offset:256
  s_branch reca_exit1
reca_vmst29:
  s_waitcnt lgkmcnt(0)
  s_waitcnt vmcnt(5)
  v_max_u32 v29, v208, v210
  v_cmp_eq_u32 vcc, -1, v29
  s_cbranch_vccnz reca_retry30
reca_resume31:
  s_waitcnt vmcnt(4)
  v_max_u32 v29, v212, v214
  v_cmp_eq_u32 vcc, -1, v29
  v_mfma_f32_16x16x32_bf16 v[72:75], v[208:211], v[208:211], v[40:43]
  v_mfma_f32_16x16x32_bf16 v[76:79], v[128:131], v[208:211], 0
  v_mfma_f32_16x16x32_bf16 v[80:83], v[152:155], v[208:211], 0
  s_cbranch_vccnz reca_retry32
reca_resume33:
  s_waitcnt vmcnt(3)
  v_max_u32 v29, v216, v218
  v_cmp_eq_u32 vcc, -1, v29
  v_mfma_f32_16x16x32_bf16 v[72:75], v[212:215], v[212:215], v[72:75]
  v_mfma_f32_16x16x32_bf16 v[76:79], v[132:135], v[212:215], v[76:79]
  v_mfma_f32_16x16x32_bf16 v[80:83], v[156:159], v[212:215], v[80:83]
  s_cbranch_vccnz reca_retry34
reca_resume35:
  s_waitcnt vmcnt(2)
  v_max_u32 v29, v220, v222
  v_cmp_eq_u32 vcc, -1, v29
  v_mfma_f32_16x16x32_bf16 v[72:75], v[216:219], v[216:219], v[72:75]
  v_mfma_f32_16x16x32_bf16 v[76:79], v[136:139], v[216:219], v[76:79]
  v_mfma_f32_16x16x32_bf16 v[80:83], v[160:163], v[216:219], v[80:83]
  s_cbranch_vccnz reca_retry36
reca_resume37:
  s_waitcnt vmcnt(1)
  v_max_u32 v29, v224, v226
  v_cmp_eq_u32 vcc, -1, v29
  v_mfma_f32_16x16x32_bf16 v[72:75], v[220:223], v[220:223], v[72:75]
  v_mfma_f32_16x16x32_bf16 v[76:79], v[140:143], v[220:223], v[76:79]
  v_mfma_f32_16x16x32_bf16 v[80:83], v[164:167], v[220:223], v[80:83]
  s_cbranch_vccnz reca_retry38
reca_resume39:
  s_waitcnt vmcnt(0)
  v_max_u32 v29, v228, v230
  v_cmp_eq_u32 vcc, -1, v29
  v_mfma_f32_16x16x32_bf16 v[72:75], v[224:227], v[224:227], v[72:75]
  v_mfma_f32_16x16x32_bf16 v[76:79], v[144:147], v[224:227], v[76:79]
  v_mfma_f32_16x16x32_bf16 v[80:83], v[168:171], v[224:227], v[80:83]
  s_cbranch_vccnz reca_retry40
reca_resume41:
  v_mfma_f32_16x16x32_bf16 v[72:75], v[228:231], v[228:231], v[72:75]
  v_mfma_f32_16x16x32_bf16 v[76:79], v[148:151], v[228:231], v[76:79]
  v_mfma_f32_16x16x32_bf16 v[80:83], v[172:175], v[228:231], v[80:83]
  s_barrier
  s_nop 4
  v_max3_f32 v28, v72, v73, v74
  v_max3_f32 v29, v76, v77, v78
  v_max3_f32 v28, v28, v75, v79
  v_max3_f32 v29, v29, v80, v81
  v_max3_f32 v28, v28, v82, v83
  v_max_f32 v28, v28, v29
  v_mov_b32 v29, v28
  s_nop 1
  v_permlane32_swap_b32 v28, v29
  v_max_f32 v28, v28, v29
  v_mov_b32 v29, v28
  s_nop 1
  v_permlane16_swap_b32 v28, v29
  v_max_f32 v28, v28, v29
  v_mul_f32 v28, s41, v28
  v_fma_f32 v72, v72, s41, -v28
  v_fma_f32 v73, v73, s41, -v28
  v_fma_f32 v74, v74, s41, -v28
  v_fma_f32 v75, v75, s41, -v28
  v_fma_f32 v76, v76, s41, -v28
  v_fma_f32 v77, v77, s41, -v28
  v_fma_f32 v78, v78, s41, -v28
  v_fma_f32 v79, v79, s41, -v28
  v_fma_f32 v80, v80, s41, -v28
  v_fma_f32 v81, v81, s41, -v28
  v_fma_f32 v82, v82, s41, -v28
  v_fma_f32 v83, v83, s41, -v28
  v_exp_f32 v72, v72
  v_exp_f32 v73, v73
  v_exp_f32 v74, v74
  v_exp_f32 v75, v75
  v_exp_f32 v76, v76
  v_exp_f32 v77, v77
  v_exp_f32 v78, v78
  v_exp_f32 v79, v79
  v_exp_f32 v80, v80
  v_exp_f32 v81, v81
  v_exp_f32 v82, v82
  v_exp_f32 v83, v83
  v_cvt_pk_bf16_f32 v84, v76, v77
  v_cvt_pk_bf16_f32 v85, v78, v79
  v_cvt_pk_bf16_f32 v86, v80, v81
  v_cvt_pk_bf16_f32 v87, v82, v83
  v_cvt_pk_bf16_f32 v88, v72, v73
  v_cvt_pk_bf16_f32 v89, v74, v75
  v_mfma_f32_16x16x32_bf16 v[100:103], v[36:39], v[84:87], 0
  v_mfma_f32_16x16x32_bf16 v[92:95], v[176:179], v[84:87], 0
  v_mfma_f32_16x16x32_bf16 v[96:99], v[180:183], v[84:87], 0
  v_mfma_f32_16x16x16_bf16 v[100:103], v[36:37], v[88:89], v[100:103]
  v_mfma_f32_16x16x16_bf16 v[92:95], v[68:69], v[88:89], v[92:95]
  v_mfma_f32_16x16x16_bf16 v[96:99], v[70:71], v[88:89], v[96:99]
  s_nop 5
  v_rcp_f32 v28, v100
  s_nop 0
  v_mul_f32 v92, v92, v28
  v_mul_f32 v93, v93, v28
  v_mul_f32 v94, v94, v28
  v_mul_f32 v95, v95, v28
  v_mul_f32 v96, v96, v28
  v_mul_f32 v97, v97, v28
  v_mul_f32 v98, v98, v28
  v_mul_f32 v99, v99, v28
  v_cvt_pk_bf16_f32 v104, v92, v93
  v_cvt_pk_bf16_f32 v105, v94, v95
  v_cvt_pk_bf16_f32 v106, v96, v97
  v_cvt_pk_bf16_f32 v107, v98, v99
  buffer_store_dwordx4 v[104:107], v11, s[4:7], s22 offen
reca_b324:
  s_barrier
  s_cmp_ge_u32 s12, 2
  s_cbranch_scc1 reca_notg242
  s_sleep 3
  buffer_load_dwordx4 v[128:131], v12, s[4:7], s22 offen offset:0 sc1
  buffer_load_dwordx4 v[132:135], v12, s[4:7], s22 offen offset:1024 sc1
  buffer_load_dwordx4 v[136:139], v12, s[4:7], s22 offen offset:2048 sc1
  buffer_load_dwordx4 v[140:143], v12, s[4:7], s22 offen offset:3072 sc1
  buffer_load_dwordx4 v[144:147], v13, s[4:7], s22 offen offset:0 sc1
  buffer_load_dwordx4 v[148:151], v13, s[4:7], s22 offen offset:1024 sc1
  buffer_load_dwordx4 v[152:155], v13, s[4:7], s22 offen offset:2048 sc1
  buffer_load_dwordx4 v[156:159], v13, s[4:7], s22 offen offset:3072 sc1
  buffer_load_dwordx4 v[160:163], v14, s[4:7], s22 offen offset:0 sc1
  buffer_load_dwordx4 v[164:167], v14, s[4:7], s22 offen offset:1024 sc1
  buffer_load_dwordx4 v[168:171], v14, s[4:7], s22 offen offset:2048 sc1
  buffer_load_dwordx4 v[172:175], v14, s[4:7], s22 offen offset:3072 sc1
  s_waitcnt vmcnt(11)
  v_cmp_eq_u32 vcc, -1, v128
  s_cbranch_vccnz reca_retry43
reca_resume44:
  s_waitcnt vmcnt(10)
  v_cmp_eq_u32 vcc, -1, v132
  v_mfma_f32_16x16x32_bf16 v[108:111], a[120:123], v[128:131], 0
  v_mfma_f32_16x16x32_bf16 v[112:115], a[124:127], v[128:131], 0
  s_cbranch_vccnz reca_retry45
reca_resume46:
  s_waitcnt vmcnt(9)
  v_cmp_eq_u32 vcc, -1, v136
  v_mfma_f32_16x16x32_bf16 v[108:111], a[128:131], v[132:135], v[108:111]
  v_mfma_f32_16x16x32_bf16 v[112:115], a[132:135], v[132:135], v[112:115]
  s_cbranch_vccnz reca_retry47
reca_resume48:
  s_waitcnt vmcnt(8)
  v_cmp_eq_u32 vcc, -1, v140
  v_mfma_f32_16x16x32_bf16 v[108:111], a[136:139], v[136:139], v[108:111]
  v_mfma_f32_16x16x32_bf16 v[112:115], a[140:143], v[136:139], v[112:115]
  s_cbranch_vccnz reca_retry49
reca_resume50:
  s_waitcnt vmcnt(7)
  v_cmp_eq_u32 vcc, -1, v144
  v_mfma_f32_16x16x32_bf16 v[108:111], a[144:147], v[140:143], v[108:111]
  v_mfma_f32_16x16x32_bf16 v[112:115], a[148:151], v[140:143], v[112:115]
  s_cbranch_vccnz reca_retry51
reca_resume52:
  s_waitcnt vmcnt(6)
  v_cmp_eq_u32 vcc, -1, v148
  v_mfma_f32_16x16x32_bf16 v[108:111], a[152:155], v[144:147], v[108:111]
  v_mfma_f32_16x16x32_bf16 v[112:115], a[156:159], v[144:147], v[112:115]
  s_cbranch_vccnz reca_retry53
reca_resume54:
  s_waitcnt vmcnt(5)
  v_cmp_eq_u32 vcc, -1, v152
  v_mfma_f32_16x16x32_bf16 v[108:111], a[160:163], v[148:151], v[108:111]
  v_mfma_f32_16x16x32_bf16 v[112:115], a[164:167], v[148:151], v[112:115]
  s_cbranch_vccnz reca_retry55
reca_resume56:
  s_waitcnt vmcnt(4)
  v_cmp_eq_u32 vcc, -1, v156
  v_mfma_f32_16x16x32_bf16 v[108:111], a[168:171], v[152:155], v[108:111]
  v_mfma_f32_16x16x32_bf16 v[112:115], a[172:175], v[152:155], v[112:115]
  s_cbranch_vccnz reca_retry57
reca_resume58:
  s_waitcnt vmcnt(3)
  v_cmp_eq_u32 vcc, -1, v160
  v_mfma_f32_16x16x32_bf16 v[108:111], a[176:179], v[156:159], v[108:111]
  v_mfma_f32_16x16x32_bf16 v[112:115], a[180:183], v[156:159], v[112:115]
  s_cbranch_vccnz reca_retry59
reca_resume60:
  s_waitcnt vmcnt(2)
  v_cmp_eq_u32 vcc, -1, v164
  v_mfma_f32_16x16x32_bf16 v[108:111], a[184:187], v[160:163], v[108:111]
  v_mfma_f32_16x16x32_bf16 v[112:115], a[188:191], v[160:163], v[112:115]
  s_cbranch_vccnz reca_retry61
reca_resume62:
  s_waitcnt vmcnt(1)
  v_cmp_eq_u32 vcc, -1, v168
  v_mfma_f32_16x16x32_bf16 v[108:111], a[192:195], v[164:167], v[108:111]
  v_mfma_f32_16x16x32_bf16 v[112:115], a[196:199], v[164:167], v[112:115]
  s_cbranch_vccnz reca_retry63
reca_resume64:
  s_waitcnt vmcnt(0)
  v_cmp_eq_u32 vcc, -1, v172
  v_mfma_f32_16x16x32_bf16 v[108:111], a[200:203], v[168:171], v[108:111]
  v_mfma_f32_16x16x32_bf16 v[112:115], a[204:207], v[168:171], v[112:115]
  s_cbranch_vccnz reca_retry65
reca_resume66:
  v_mfma_f32_16x16x32_bf16 v[108:111], a[208:211], v[172:175], v[108:111]
  v_mfma_f32_16x16x32_bf16 v[112:115], a[212:215], v[172:175], v[112:115]
  s_nop 7
  v_add_f32_dpp v116, v112, v108 row_ror:8 row_mask:0xf bank_mask:0xf
  v_add_f32_dpp v117, v113, v109 row_ror:8 row_mask:0xf bank_mask:0xf
  v_add_f32_dpp v118, v114, v110 row_ror:8 row_mask:0xf bank_mask:0xf
  v_add_f32_dpp v119, v115, v111 row_ror:8 row_mask:0xf bank_mask:0xf
  buffer_store_dwordx4 v[116:119], v15, s[4:7], s25 offen sc1
  buffer_store_dwordx4 v[116:119], v232, s[4:7], s25 offen sc1
  buffer_store_dwordx4 v[32:35], v15, s[4:7], s29 offen sc1
  buffer_store_dwordx4 v[32:35], v232, s[4:7], s29 offen sc1
  s_branch reca_b425
reca_notg242:
  s_cmp_lg_u32 s12, 3
  s_cbranch_scc1 reca_b425
  buffer_store_dwordx2 v[52:53], v9, s[4:7], s30 offen
  buffer_store_dwordx2 v[68:69], v10, s[4:7], s31 offen
  buffer_store_dwordx2 v[70:71], v10, s[4:7], s31 offen offset:256
  buffer_store_dwordx2 v[32:33], v8, s[4:7], s27 offen
  buffer_store_dwordx4 v[32:35], v11, s[4:7], s28 offen
reca_b425:
  s_barrier
  s_cmp_lg_u32 s12, 2
  s_cbranch_scc1 reca_not267
  s_sleep 8
  buffer_load_dwordx4 v[128:131], v20, s[4:7], s25 offen sc1
  buffer_load_dwordx4 v[132:135], v21, s[4:7], s25 offen sc1
  buffer_load_dwordx4 v[136:139], v22, s[4:7], s25 offen sc1
  buffer_load_dwordx4 v[140:143], v23, s[4:7], s25 offen sc1
  buffer_load_dwordx4 v[144:147], v24, s[4:7], s25 offen sc1
  buffer_load_dwordx4 v[148:151], v25, s[4:7], s25 offen sc1
  buffer_load_dwordx4 v[152:155], v26, s[4:7], s25 offen sc1
  buffer_load_dwordx4 v[156:159], v27, s[4:7], s25 offen sc1
  s_waitcnt vmcnt(7)
  v_cmp_eq_u32 vcc, -1, v128
  s_cbranch_vccnz reca_retry68
reca_resume69:
  s_waitcnt vmcnt(6)
  v_cmp_eq_u32 vcc, -1, v132
  s_cbranch_vccnz reca_retry70
reca_resume71:
  s_waitcnt vmcnt(5)
  v_cmp_eq_u32 vcc, -1, v136
  v_pk_add_f32 v[116:117], v[128:129], v[132:133]
  v_pk_add_f32 v[118:119], v[130:131], v[134:135]
  s_cbranch_vccnz reca_retry72
reca_resume73:
  s_waitcnt vmcnt(4)
  v_cmp_eq_u32 vcc, -1, v140
  v_pk_add_f32 v[116:117], v[116:117], v[136:137]
  v_pk_add_f32 v[118:119], v[118:119], v[138:139]
  s_cbranch_vccnz reca_retry74
reca_resume75:
  s_waitcnt vmcnt(3)
  v_cmp_eq_u32 vcc, -1, v144
  v_pk_add_f32 v[116:117], v[116:117], v[140:141]
  v_pk_add_f32 v[118:119], v[118:119], v[142:143]
  s_cbranch_vccnz reca_retry76
reca_resume77:
  s_waitcnt vmcnt(2)
  v_cmp_eq_u32 vcc, -1, v148
  v_pk_add_f32 v[116:117], v[116:117], v[144:145]
  v_pk_add_f32 v[118:119], v[118:119], v[146:147]
  s_cbranch_vccnz reca_retry78
reca_resume79:
  s_waitcnt vmcnt(1)
  v_cmp_eq_u32 vcc, -1, v152
  v_pk_add_f32 v[116:117], v[116:117], v[148:149]
  v_pk_add_f32 v[118:119], v[118:119], v[150:151]
  s_cbranch_vccnz reca_retry80
reca_resume81:
  s_waitcnt vmcnt(0)
  v_cmp_eq_u32 vcc, -1, v156
  v_pk_add_f32 v[116:117], v[116:117], v[152:153]
  v_pk_add_f32 v[118:119], v[118:119], v[154:155]
  s_cbranch_vccnz reca_retry82
reca_resume83:
  v_pk_add_f32 v[116:117], v[116:117], v[156:157]
  v_pk_add_f32 v[118:119], v[118:119], v[158:159]
  v_cvt_pk_bf16_f32 v132, v116, v117
  v_cvt_pk_bf16_f32 v133, v118, v119
  buffer_store_dwordx2 v[132:133], v16, s[4:7], s24 offen
  s_branch reca_b526
reca_not267:
  s_cmp_lg_u32 s12, 3
  s_cbranch_scc1 reca_b526
  s_add_u32 s36, s17, 1
  s_cmp_ge_u32 s36, 63
  s_cbranch_scc1 reca_b526
  s_add_u32 s37, s36, 1
reca_pf84:
  buffer_load_dword v28, v233, s[4:7], 0 offen sc1
  s_waitcnt vmcnt(0)
  v_cmp_gt_i32 vcc, s37, v28
  s_cbranch_vccz reca_pfok85
  s_sleep 1
  s_sub_u32 s18, s18, 1
  s_cbranch_scc0 reca_pf84
  s_mov_b32 s18, 0
reca_pfok85:
  s_lshl_b32 s34, s15, 6
  s_add_u32 s34, s34, s36
  s_mul_i32 s34, s34, 12288
  s_add_u32 s32, s34, 37748736
  s_lshl_b32 s35, s16, 11
  s_add_u32 s34, s34, s35
  s_add_u32 s33, s34, 62914560
  s_and_b32 s35, s36, 1
  s_mul_i32 s35, s35, 14336
  s_add_u32 s35, s35, 16384
  s_add_u32 m0, s35, 0
  s_nop 0
  buffer_load_dwordx4 v1, s[4:7], s32 offen offset:0 lds
  buffer_load_dwordx4 v1, s[4:7], s32 offen offset:1024 lds
  buffer_load_dwordx4 v1, s[4:7], s32 offen offset:2048 lds
  buffer_load_dwordx4 v1, s[4:7], s32 offen offset:3072 lds
  s_add_u32 s32, s32, 4096
  s_add_u32 m0, s35, 4096
  s_nop 0
  buffer_load_dwordx4 v1, s[4:7], s32 offen offset:0 lds
  buffer_load_dwordx4 v1, s[4:7], s32 offen offset:1024 lds
  buffer_load_dwordx4 v1, s[4:7], s32 offen offset:2048 lds
  buffer_load_dwordx4 v1, s[4:7], s32 offen offset:3072 lds
  s_add_u32 s32, s32, 4096
  s_add_u32 m0, s35, 8192
  s_nop 0
  buffer_load_dwordx4 v1, s[4:7], s32 offen offset:0 lds
  buffer_load_dwordx4 v1, s[4:7], s32 offen offset:1024 lds
  buffer_load_dwordx4 v1, s[4:7], s32 offen offset:2048 lds
  buffer_load_dwordx4 v1, s[4:7], s32 offen offset:3072 lds
  s_add_u32 m0, s35, 12288
  s_nop 0
  buffer_load_dwordx4 v1, s[4:7], s33 offen offset:0 lds
  buffer_load_dwordx4 v1, s[4:7], s33 offen offset:1024 lds
reca_b526:
  s_barrier
reca_next23:
  s_add_u32 s17, s17, 1
  s_branch reca_step10
reca_retry12:
  s_sub_u32 s18, s18, 1
  s_cbranch_scc1 reca_retry12_to
  buffer_load_dwordx4 v[128:131], v4, s[4:7], s20 offen sc1
  buffer_load_dwordx4 v[132:135], v4, s[4:7], s20 offen offset:1024 sc1
  buffer_load_dwordx4 v[136:139], v5, s[4:7], s20 offen sc1
  s_waitcnt vmcnt(2)
  v_max_u32 v29, v128, v130
  v_cmp_eq_u32 vcc, -1, v29
  s_cbranch_vccnz reca_retry12
  s_branch reca_resume13
reca_retry12_to:
  s_mov_b32 s18, 0
  s_waitcnt vmcnt(0)
  s_branch reca_resume13
reca_retry14:
  s_sub_u32 s18, s18, 1
  s_cbranch_scc1 reca_retry14_to
  buffer_load_dwordx4 v[132:135], v4, s[4:7], s20 offen offset:1024 sc1
  buffer_load_dwordx4 v[136:139], v5, s[4:7], s20 offen sc1
  s_waitcnt vmcnt(1)
  v_max_u32 v29, v132, v134
  v_cmp_eq_u32 vcc, -1, v29
  s_cbranch_vccnz reca_retry14
  s_branch reca_resume15
reca_retry14_to:
  s_mov_b32 s18, 0
  s_waitcnt vmcnt(0)
  s_branch reca_resume15
reca_retry16:
  s_sub_u32 s18, s18, 1
  s_cbranch_scc1 reca_retry16_to
  buffer_load_dwordx4 v[136:139], v5, s[4:7], s20 offen sc1
  s_waitcnt vmcnt(0)
  v_max_u32 v29, v136, v138
  v_cmp_eq_u32 vcc, -1, v29
  s_cbranch_vccnz reca_retry16
  s_branch reca_resume17
reca_retry16_to:
  s_mov_b32 s18, 0
  s_waitcnt vmcnt(0)
  s_branch reca_resume17
reca_retry30:
  s_sub_u32 s18, s18, 1
  s_cbranch_scc1 reca_retry30_to
  buffer_load_dwordx4 v[208:211], v1, s[4:7], s21 offen offset:0 sc1
  buffer_load_dwordx4 v[212:215], v1, s[4:7], s21 offen offset:1024 sc1
  buffer_load_dwordx4 v[216:219], v1, s[4:7], s21 offen offset:2048 sc1
  buffer_load_dwordx4 v[220:223], v1, s[4:7], s21 offen offset:3072 sc1
  buffer_load_dwordx4 v[224:227], v2, s[4:7], s21 offen offset:0 sc1
  buffer_load_dwordx4 v[228:231], v2, s[4:7], s21 offen offset:1024 sc1
  s_waitcnt vmcnt(5)
  v_max_u32 v29, v208, v210
  v_cmp_eq_u32 vcc, -1, v29
  s_cbranch_vccnz reca_retry30
  s_branch reca_resume31
reca_retry30_to:
  s_mov_b32 s18, 0
  s_waitcnt vmcnt(0)
  s_branch reca_resume31
reca_retry32:
  s_sub_u32 s18, s18, 1
  s_cbranch_scc1 reca_retry32_to
  buffer_load_dwordx4 v[212:215], v1, s[4:7], s21 offen offset:1024 sc1
  buffer_load_dwordx4 v[216:219], v1, s[4:7], s21 offen offset:2048 sc1
  buffer_load_dwordx4 v[220:223], v1, s[4:7], s21 offen offset:3072 sc1
  buffer_load_dwordx4 v[224:227], v2, s[4:7], s21 offen offset:0 sc1
  buffer_load_dwordx4 v[228:231], v2, s[4:7], s21 offen offset:1024 sc1
  s_waitcnt vmcnt(4)
  v_max_u32 v29, v212, v214
  v_cmp_eq_u32 vcc, -1, v29
  s_cbranch_vccnz reca_retry32
  s_branch reca_resume33
reca_retry32_to:
  s_mov_b32 s18, 0
  s_waitcnt vmcnt(0)
  s_branch reca_resume33
reca_retry34:
  s_sub_u32 s18, s18, 1
  s_cbranch_scc1 reca_retry34_to
  buffer_load_dwordx4 v[216:219], v1, s[4:7], s21 offen offset:2048 sc1
  buffer_load_dwordx4 v[220:223], v1, s[4:7], s21 offen offset:3072 sc1
  buffer_load_dwordx4 v[224:227], v2, s[4:7], s21 offen offset:0 sc1
  buffer_load_dwordx4 v[228:231], v2, s[4:7], s21 offen offset:1024 sc1
  s_waitcnt vmcnt(3)
  v_max_u32 v29, v216, v218
  v_cmp_eq_u32 vcc, -1, v29
  s_cbranch_vccnz reca_retry34
  s_branch reca_resume35
reca_retry34_to:
  s_mov_b32 s18, 0
  s_waitcnt vmcnt(0)
  s_branch reca_resume35
reca_retry36:
  s_sub_u32 s18, s18, 1
  s_cbranch_scc1 reca_retry36_to
  buffer_load_dwordx4 v[220:223], v1, s[4:7], s21 offen offset:3072 sc1
  buffer_load_dwordx4 v[224:227], v2, s[4:7], s21 offen offset:0 sc1
  buffer_load_dwordx4 v[228:231], v2, s[4:7], s21 offen offset:1024 sc1
  s_waitcnt vmcnt(2)
  v_max_u32 v29, v220, v222
  v_cmp_eq_u32 vcc, -1, v29
  s_cbranch_vccnz reca_retry36
  s_branch reca_resume37
reca_retry36_to:
  s_mov_b32 s18, 0
  s_waitcnt vmcnt(0)
  s_branch reca_resume37
reca_retry38:
  s_sub_u32 s18, s18, 1
  s_cbranch_scc1 reca_retry38_to
  buffer_load_dwordx4 v[224:227], v2, s[4:7], s21 offen offset:0 sc1
  buffer_load_dwordx4 v[228:231], v2, s[4:7], s21 offen offset:1024 sc1
  s_waitcnt vmcnt(1)
  v_max_u32 v29, v224, v226
  v_cmp_eq_u32 vcc, -1, v29
  s_cbranch_vccnz reca_retry38
  s_branch reca_resume39
reca_retry38_to:
  s_mov_b32 s18, 0
  s_waitcnt vmcnt(0)
  s_branch reca_resume39
reca_retry40:
  s_sub_u32 s18, s18, 1
  s_cbranch_scc1 reca_retry40_to
  buffer_load_dwordx4 v[228:231], v2, s[4:7], s21 offen offset:1024 sc1
  s_waitcnt vmcnt(0)
  v_max_u32 v29, v228, v230
  v_cmp_eq_u32 vcc, -1, v29
  s_cbranch_vccnz reca_retry40
  s_branch reca_resume41
reca_retry40_to:
  s_mov_b32 s18, 0
  s_waitcnt vmcnt(0)
  s_branch reca_resume41
reca_retry43:
  s_sub_u32 s18, s18, 1
  s_cbranch_scc1 reca_retry43_to
  buffer_load_dwordx4 v[128:131], v12, s[4:7], s22 offen offset:0 sc1
  buffer_load_dwordx4 v[132:135], v12, s[4:7], s22 offen offset:1024 sc1
  buffer_load_dwordx4 v[136:139], v12, s[4:7], s22 offen offset:2048 sc1
  buffer_load_dwordx4 v[140:143], v12, s[4:7], s22 offen offset:3072 sc1
  buffer_load_dwordx4 v[144:147], v13, s[4:7], s22 offen offset:0 sc1
  buffer_load_dwordx4 v[148:151], v13, s[4:7], s22 offen offset:1024 sc1
  buffer_load_dwordx4 v[152:155], v13, s[4:7], s22 offen offset:2048 sc1
  buffer_load_dwordx4 v[156:159], v13, s[4:7], s22 offen offset:3072 sc1
  buffer_load_dwordx4 v[160:163], v14, s[4:7], s22 offen offset:0 sc1
  buffer_load_dwordx4 v[164:167], v14, s[4:7], s22 offen offset:1024 sc1
  buffer_load_dwordx4 v[168:171], v14, s[4:7], s22 offen offset:2048 sc1
  buffer_load_dwordx4 v[172:175], v14, s[4:7], s22 offen offset:3072 sc1
  s_waitcnt vmcnt(11)
  v_cmp_eq_u32 vcc, -1, v128
  s_cbranch_vccnz reca_retry43
  s_branch reca_resume44
reca_retry43_to:
  s_mov_b32 s18, 0
  s_waitcnt vmcnt(0)
  s_branch reca_resume44
reca_retry45:
  s_sub_u32 s18, s18, 1
  s_cbranch_scc1 reca_retry45_to
  buffer_load_dwordx4 v[132:135], v12, s[4:7], s22 offen offset:1024 sc1
  buffer_load_dwordx4 v[136:139], v12, s[4:7], s22 offen offset:2048 sc1
  buffer_load_dwordx4 v[140:143], v12, s[4:7], s22 offen offset:3072 sc1
  buffer_load_dwordx4 v[144:147], v13, s[4:7], s22 offen offset:0 sc1
  buffer_load_dwordx4 v[148:151], v13, s[4:7], s22 offen offset:1024 sc1
  buffer_load_dwordx4 v[152:155], v13, s[4:7], s22 offen offset:2048 sc1
  buffer_load_dwordx4 v[156:159], v13, s[4:7], s22 offen offset:3072 sc1
  buffer_load_dwordx4 v[160:163], v14, s[4:7], s22 offen offset:0 sc1
  buffer_load_dwordx4 v[164:167], v14, s[4:7], s22 offen offset:1024 sc1
  buffer_load_dwordx4 v[168:171], v14, s[4:7], s22 offen offset:2048 sc1
  buffer_load_dwordx4 v[172:175], v14, s[4:7], s22 offen offset:3072 sc1
  s_waitcnt vmcnt(10)
  v_cmp_eq_u32 vcc, -1, v132
  s_cbranch_vccnz reca_retry45
  s_branch reca_resume46
reca_retry45_to:
  s_mov_b32 s18, 0
  s_waitcnt vmcnt(0)
  s_branch reca_resume46
reca_retry47:
  s_sub_u32 s18, s18, 1
  s_cbranch_scc1 reca_retry47_to
  buffer_load_dwordx4 v[136:139], v12, s[4:7], s22 offen offset:2048 sc1
  buffer_load_dwordx4 v[140:143], v12, s[4:7], s22 offen offset:3072 sc1
  buffer_load_dwordx4 v[144:147], v13, s[4:7], s22 offen offset:0 sc1
  buffer_load_dwordx4 v[148:151], v13, s[4:7], s22 offen offset:1024 sc1
  buffer_load_dwordx4 v[152:155], v13, s[4:7], s22 offen offset:2048 sc1
  buffer_load_dwordx4 v[156:159], v13, s[4:7], s22 offen offset:3072 sc1
  buffer_load_dwordx4 v[160:163], v14, s[4:7], s22 offen offset:0 sc1
  buffer_load_dwordx4 v[164:167], v14, s[4:7], s22 offen offset:1024 sc1
  buffer_load_dwordx4 v[168:171], v14, s[4:7], s22 offen offset:2048 sc1
  buffer_load_dwordx4 v[172:175], v14, s[4:7], s22 offen offset:3072 sc1
  s_waitcnt vmcnt(9)
  v_cmp_eq_u32 vcc, -1, v136
  s_cbranch_vccnz reca_retry47
  s_branch reca_resume48
reca_retry47_to:
  s_mov_b32 s18, 0
  s_waitcnt vmcnt(0)
  s_branch reca_resume48
reca_retry49:
  s_sub_u32 s18, s18, 1
  s_cbranch_scc1 reca_retry49_to
  buffer_load_dwordx4 v[140:143], v12, s[4:7], s22 offen offset:3072 sc1
  buffer_load_dwordx4 v[144:147], v13, s[4:7], s22 offen offset:0 sc1
  buffer_load_dwordx4 v[148:151], v13, s[4:7], s22 offen offset:1024 sc1
  buffer_load_dwordx4 v[152:155], v13, s[4:7], s22 offen offset:2048 sc1
  buffer_load_dwordx4 v[156:159], v13, s[4:7], s22 offen offset:3072 sc1
  buffer_load_dwordx4 v[160:163], v14, s[4:7], s22 offen offset:0 sc1
  buffer_load_dwordx4 v[164:167], v14, s[4:7], s22 offen offset:1024 sc1
  buffer_load_dwordx4 v[168:171], v14, s[4:7], s22 offen offset:2048 sc1
  buffer_load_dwordx4 v[172:175], v14, s[4:7], s22 offen offset:3072 sc1
  s_waitcnt vmcnt(8)
  v_cmp_eq_u32 vcc, -1, v140
  s_cbranch_vccnz reca_retry49
  s_branch reca_resume50
reca_retry49_to:
  s_mov_b32 s18, 0
  s_waitcnt vmcnt(0)
  s_branch reca_resume50
reca_retry51:
  s_sub_u32 s18, s18, 1
  s_cbranch_scc1 reca_retry51_to
  buffer_load_dwordx4 v[144:147], v13, s[4:7], s22 offen offset:0 sc1
  buffer_load_dwordx4 v[148:151], v13, s[4:7], s22 offen offset:1024 sc1
  buffer_load_dwordx4 v[152:155], v13, s[4:7], s22 offen offset:2048 sc1
  buffer_load_dwordx4 v[156:159], v13, s[4:7], s22 offen offset:3072 sc1
  buffer_load_dwordx4 v[160:163], v14, s[4:7], s22 offen offset:0 sc1
  buffer_load_dwordx4 v[164:167], v14, s[4:7], s22 offen offset:1024 sc1
  buffer_load_dwordx4 v[168:171], v14, s[4:7], s22 offen offset:2048 sc1
  buffer_load_dwordx4 v[172:175], v14, s[4:7], s22 offen offset:3072 sc1
  s_waitcnt vmcnt(7)
  v_cmp_eq_u32 vcc, -1, v144
  s_cbranch_vccnz reca_retry51
  s_branch reca_resume52
reca_retry51_to:
  s_mov_b32 s18, 0
  s_waitcnt vmcnt(0)
  s_branch reca_resume52
reca_retry53:
  s_sub_u32 s18, s18, 1
  s_cbranch_scc1 reca_retry53_to
  buffer_load_dwordx4 v[148:151], v13, s[4:7], s22 offen offset:1024 sc1
  buffer_load_dwordx4 v[152:155], v13, s[4:7], s22 offen offset:2048 sc1
  buffer_load_dwordx4 v[156:159], v13, s[4:7], s22 offen offset:3072 sc1
  buffer_load_dwordx4 v[160:163], v14, s[4:7], s22 offen offset:0 sc1
  buffer_load_dwordx4 v[164:167], v14, s[4:7], s22 offen offset:1024 sc1
  buffer_load_dwordx4 v[168:171], v14, s[4:7], s22 offen offset:2048 sc1
  buffer_load_dwordx4 v[172:175], v14, s[4:7], s22 offen offset:3072 sc1
  s_waitcnt vmcnt(6)
  v_cmp_eq_u32 vcc, -1, v148
  s_cbranch_vccnz reca_retry53
  s_branch reca_resume54
reca_retry53_to:
  s_mov_b32 s18, 0
  s_waitcnt vmcnt(0)
  s_branch reca_resume54
reca_retry55:
  s_sub_u32 s18, s18, 1
  s_cbranch_scc1 reca_retry55_to
  buffer_load_dwordx4 v[152:155], v13, s[4:7], s22 offen offset:2048 sc1
  buffer_load_dwordx4 v[156:159], v13, s[4:7], s22 offen offset:3072 sc1
  buffer_load_dwordx4 v[160:163], v14, s[4:7], s22 offen offset:0 sc1
  buffer_load_dwordx4 v[164:167], v14, s[4:7], s22 offen offset:1024 sc1
  buffer_load_dwordx4 v[168:171], v14, s[4:7], s22 offen offset:2048 sc1
  buffer_load_dwordx4 v[172:175], v14, s[4:7], s22 offen offset:3072 sc1
  s_waitcnt vmcnt(5)
  v_cmp_eq_u32 vcc, -1, v152
  s_cbranch_vccnz reca_retry55
  s_branch reca_resume56
reca_retry55_to:
  s_mov_b32 s18, 0
  s_waitcnt vmcnt(0)
  s_branch reca_resume56
reca_retry57:
  s_sub_u32 s18, s18, 1
  s_cbranch_scc1 reca_retry57_to
  buffer_load_dwordx4 v[156:159], v13, s[4:7], s22 offen offset:3072 sc1
  buffer_load_dwordx4 v[160:163], v14, s[4:7], s22 offen offset:0 sc1
  buffer_load_dwordx4 v[164:167], v14, s[4:7], s22 offen offset:1024 sc1
  buffer_load_dwordx4 v[168:171], v14, s[4:7], s22 offen offset:2048 sc1
  buffer_load_dwordx4 v[172:175], v14, s[4:7], s22 offen offset:3072 sc1
  s_waitcnt vmcnt(4)
  v_cmp_eq_u32 vcc, -1, v156
  s_cbranch_vccnz reca_retry57
  s_branch reca_resume58
reca_retry57_to:
  s_mov_b32 s18, 0
  s_waitcnt vmcnt(0)
  s_branch reca_resume58
reca_retry59:
  s_sub_u32 s18, s18, 1
  s_cbranch_scc1 reca_retry59_to
  buffer_load_dwordx4 v[160:163], v14, s[4:7], s22 offen offset:0 sc1
  buffer_load_dwordx4 v[164:167], v14, s[4:7], s22 offen offset:1024 sc1
  buffer_load_dwordx4 v[168:171], v14, s[4:7], s22 offen offset:2048 sc1
  buffer_load_dwordx4 v[172:175], v14, s[4:7], s22 offen offset:3072 sc1
  s_waitcnt vmcnt(3)
  v_cmp_eq_u32 vcc, -1, v160
  s_cbranch_vccnz reca_retry59
  s_branch reca_resume60
reca_retry59_to:
  s_mov_b32 s18, 0
  s_waitcnt vmcnt(0)
  s_branch reca_resume60
reca_retry61:
  s_sub_u32 s18, s18, 1
  s_cbranch_scc1 reca_retry61_to
  buffer_load_dwordx4 v[164:167], v14, s[4:7], s22 offen offset:1024 sc1
  buffer_load_dwordx4 v[168:171], v14, s[4:7], s22 offen offset:2048 sc1
  buffer_load_dwordx4 v[172:175], v14, s[4:7], s22 offen offset:3072 sc1
  s_waitcnt vmcnt(2)
  v_cmp_eq_u32 vcc, -1, v164
  s_cbranch_vccnz reca_retry61
  s_branch reca_resume62
reca_retry61_to:
  s_mov_b32 s18, 0
  s_waitcnt vmcnt(0)
  s_branch reca_resume62
reca_retry63:
  s_sub_u32 s18, s18, 1
  s_cbranch_scc1 reca_retry63_to
  buffer_load_dwordx4 v[168:171], v14, s[4:7], s22 offen offset:2048 sc1
  buffer_load_dwordx4 v[172:175], v14, s[4:7], s22 offen offset:3072 sc1
  s_waitcnt vmcnt(1)
  v_cmp_eq_u32 vcc, -1, v168
  s_cbranch_vccnz reca_retry63
  s_branch reca_resume64
reca_retry63_to:
  s_mov_b32 s18, 0
  s_waitcnt vmcnt(0)
  s_branch reca_resume64
reca_retry65:
  s_sub_u32 s18, s18, 1
  s_cbranch_scc1 reca_retry65_to
  buffer_load_dwordx4 v[172:175], v14, s[4:7], s22 offen offset:3072 sc1
  s_waitcnt vmcnt(0)
  v_cmp_eq_u32 vcc, -1, v172
  s_cbranch_vccnz reca_retry65
  s_branch reca_resume66
reca_retry65_to:
  s_mov_b32 s18, 0
  s_waitcnt vmcnt(0)
  s_branch reca_resume66
reca_retry68:
  s_sub_u32 s18, s18, 1
  s_cbranch_scc1 reca_retry68_to
  buffer_load_dwordx4 v[128:131], v20, s[4:7], s25 offen sc1
  buffer_load_dwordx4 v[132:135], v21, s[4:7], s25 offen sc1
  buffer_load_dwordx4 v[136:139], v22, s[4:7], s25 offen sc1
  buffer_load_dwordx4 v[140:143], v23, s[4:7], s25 offen sc1
  buffer_load_dwordx4 v[144:147], v24, s[4:7], s25 offen sc1
  buffer_load_dwordx4 v[148:151], v25, s[4:7], s25 offen sc1
  buffer_load_dwordx4 v[152:155], v26, s[4:7], s25 offen sc1
  buffer_load_dwordx4 v[156:159], v27, s[4:7], s25 offen sc1
  s_waitcnt vmcnt(7)
  v_cmp_eq_u32 vcc, -1, v128
  s_cbranch_vccnz reca_retry68
  s_branch reca_resume69
reca_retry68_to:
  s_mov_b32 s18, 0
  s_waitcnt vmcnt(0)
  s_branch reca_resume69
reca_retry70:
  s_sub_u32 s18, s18, 1
  s_cbranch_scc1 reca_retry70_to
  buffer_load_dwordx4 v[132:135], v21, s[4:7], s25 offen sc1
  buffer_load_dwordx4 v[136:139], v22, s[4:7], s25 offen sc1
  buffer_load_dwordx4 v[140:143], v23, s[4:7], s25 offen sc1
  buffer_load_dwordx4 v[144:147], v24, s[4:7], s25 offen sc1
  buffer_load_dwordx4 v[148:151], v25, s[4:7], s25 offen sc1
  buffer_load_dwordx4 v[152:155], v26, s[4:7], s25 offen sc1
  buffer_load_dwordx4 v[156:159], v27, s[4:7], s25 offen sc1
  s_waitcnt vmcnt(6)
  v_cmp_eq_u32 vcc, -1, v132
  s_cbranch_vccnz reca_retry70
  s_branch reca_resume71
reca_retry70_to:
  s_mov_b32 s18, 0
  s_waitcnt vmcnt(0)
  s_branch reca_resume71
reca_retry72:
  s_sub_u32 s18, s18, 1
  s_cbranch_scc1 reca_retry72_to
  buffer_load_dwordx4 v[136:139], v22, s[4:7], s25 offen sc1
  buffer_load_dwordx4 v[140:143], v23, s[4:7], s25 offen sc1
  buffer_load_dwordx4 v[144:147], v24, s[4:7], s25 offen sc1
  buffer_load_dwordx4 v[148:151], v25, s[4:7], s25 offen sc1
  buffer_load_dwordx4 v[152:155], v26, s[4:7], s25 offen sc1
  buffer_load_dwordx4 v[156:159], v27, s[4:7], s25 offen sc1
  s_waitcnt vmcnt(5)
  v_cmp_eq_u32 vcc, -1, v136
  s_cbranch_vccnz reca_retry72
  s_branch reca_resume73
reca_retry72_to:
  s_mov_b32 s18, 0
  s_waitcnt vmcnt(0)
  s_branch reca_resume73
reca_retry74:
  s_sub_u32 s18, s18, 1
  s_cbranch_scc1 reca_retry74_to
  buffer_load_dwordx4 v[140:143], v23, s[4:7], s25 offen sc1
  buffer_load_dwordx4 v[144:147], v24, s[4:7], s25 offen sc1
  buffer_load_dwordx4 v[148:151], v25, s[4:7], s25 offen sc1
  buffer_load_dwordx4 v[152:155], v26, s[4:7], s25 offen sc1
  buffer_load_dwordx4 v[156:159], v27, s[4:7], s25 offen sc1
  s_waitcnt vmcnt(4)
  v_cmp_eq_u32 vcc, -1, v140
  s_cbranch_vccnz reca_retry74
  s_branch reca_resume75
reca_retry74_to:
  s_mov_b32 s18, 0
  s_waitcnt vmcnt(0)
  s_branch reca_resume75
reca_retry76:
  s_sub_u32 s18, s18, 1
  s_cbranch_scc1 reca_retry76_to
  buffer_load_dwordx4 v[144:147], v24, s[4:7], s25 offen sc1
  buffer_load_dwordx4 v[148:151], v25, s[4:7], s25 offen sc1
  buffer_load_dwordx4 v[152:155], v26, s[4:7], s25 offen sc1
  buffer_load_dwordx4 v[156:159], v27, s[4:7], s25 offen sc1
  s_waitcnt vmcnt(3)
  v_cmp_eq_u32 vcc, -1, v144
  s_cbranch_vccnz reca_retry76
  s_branch reca_resume77
reca_retry76_to:
  s_mov_b32 s18, 0
  s_waitcnt vmcnt(0)
  s_branch reca_resume77
reca_retry78:
  s_sub_u32 s18, s18, 1
  s_cbranch_scc1 reca_retry78_to
  buffer_load_dwordx4 v[148:151], v25, s[4:7], s25 offen sc1
  buffer_load_dwordx4 v[152:155], v26, s[4:7], s25 offen sc1
  buffer_load_dwordx4 v[156:159], v27, s[4:7], s25 offen sc1
  s_waitcnt vmcnt(2)
  v_cmp_eq_u32 vcc, -1, v148
  s_cbranch_vccnz reca_retry78
  s_branch reca_resume79
reca_retry78_to:
  s_mov_b32 s18, 0
  s_waitcnt vmcnt(0)
  s_branch reca_resume79
reca_retry80:
  s_sub_u32 s18, s18, 1
  s_cbranch_scc1 reca_retry80_to
  buffer_load_dwordx4 v[152:155], v26, s[4:7], s25 offen sc1
  buffer_load_dwordx4 v[156:159], v27, s[4:7], s25 offen sc1
  s_waitcnt vmcnt(1)
  v_cmp_eq_u32 vcc, -1, v152
  s_cbranch_vccnz reca_retry80
  s_branch reca_resume81
reca_retry80_to:
  s_mov_b32 s18, 0
  s_waitcnt vmcnt(0)
  s_branch reca_resume81
reca_retry82:
  s_sub_u32 s18, s18, 1
  s_cbranch_scc1 reca_retry82_to
  buffer_load_dwordx4 v[156:159], v27, s[4:7], s25 offen sc1
  s_waitcnt vmcnt(0)
  v_cmp_eq_u32 vcc, -1, v156
  s_cbranch_vccnz reca_retry82
  s_branch reca_resume83
reca_retry82_to:
  s_mov_b32 s18, 0
  s_waitcnt vmcnt(0)
  s_branch reca_resume83
  s_branch reca_exit1
reca_warm2:
  s_nop 0
  s_cmp_ge_u32 s14, 32
  s_cbranch_scc1 reca_exit1
  s_sub_u32 s34, s14, 24
  s_lshr_b32 s35, s34, 1
  s_and_b32 s16, s34, 1
  s_lshl_b32 s15, s13, 2
  s_add_u32 s15, s15, s35
  s_lshl_b32 s24, s13, 3
  s_add_u32 s24, s24, s34
  s_lshl_b32 s24, s24, 7
  s_add_u32 s24, s24, 1540096
  s_lshl_b32 s25, s13, 7
  s_add_u32 s25, s25, 1507328
  v_and_b32 v5, 63, v0
  v_lshlrev_b32 v1, 4, v5
  v_mov_b32 v6, 0x80000000
  v_cmp_eq_u32 vcc, 0, v5
  v_mov_b32 v4, 0
  s_nop 0
  v_cndmask_b32 v4, v6, v4, vcc
  s_cmp_eq_u32 s12, 0
  s_cbranch_scc1 reca_pw0_86
  s_cmp_eq_u32 s12, 1
  s_cbranch_scc1 reca_pw1_87
  s_cmp_eq_u32 s12, 2
  s_cbranch_scc1 reca_pw2_88
  s_branch reca_pw3_89
reca_pw0_86:
  s_mul_i32 s34, s15, 12
  s_mul_i32 s35, s16, 6
  s_add_u32 s34, s34, s35
  s_add_u32 s34, s34, 0
  s_mul_i32 s34, s34, 20480
  s_add_u32 s34, s34, 14155776
  buffer_load_dwordx4 a[0:3], v1, s[4:7], s34 offen offset:0
  buffer_load_dwordx4 a[4:7], v1, s[4:7], s34 offen offset:1024
  buffer_load_dwordx4 a[8:11], v1, s[4:7], s34 offen offset:2048
  buffer_load_dwordx4 a[12:15], v1, s[4:7], s34 offen offset:3072
  s_add_u32 s34, s34, 4096
  buffer_load_dwordx4 a[16:19], v1, s[4:7], s34 offen offset:0
  buffer_load_dwordx4 a[20:23], v1, s[4:7], s34 offen offset:1024
  buffer_load_dwordx4 a[24:27], v1, s[4:7], s34 offen offset:2048
  buffer_load_dwordx4 a[28:31], v1, s[4:7], s34 offen offset:3072
  s_add_u32 s34, s34, 4096
  buffer_load_dwordx4 a[32:35], v1, s[4:7], s34 offen offset:0
  buffer_load_dwordx4 a[36:39], v1, s[4:7], s34 offen offset:1024
  buffer_load_dwordx4 a[40:43], v1, s[4:7], s34 offen offset:2048
  buffer_load_dwordx4 a[44:47], v1, s[4:7], s34 offen offset:3072
  s_add_u32 s34, s34, 4096
  buffer_load_dwordx4 a[48:51], v1, s[4:7], s34 offen offset:0
  buffer_load_dwordx4 a[52:55], v1, s[4:7], s34 offen offset:1024
  buffer_load_dwordx4 a[56:59], v1, s[4:7], s34 offen offset:2048
  buffer_load_dwordx4 a[60:63], v1, s[4:7], s34 offen offset:3072
  s_add_u32 s34, s34, 4096
  buffer_load_dwordx4 a[64:67], v1, s[4:7], s34 offen offset:0
  buffer_load_dwordx4 a[68:71], v1, s[4:7], s34 offen offset:1024
  buffer_load_dwordx4 a[72:75], v1, s[4:7], s34 offen offset:2048
  buffer_load_dwordx4 a[76:79], v1, s[4:7], s34 offen offset:3072
  s_mul_i32 s34, s15, 12
  s_mul_i32 s35, s16, 6
  s_add_u32 s34, s34, s35
  s_add_u32 s34, s34, 1
  s_mul_i32 s34, s34, 20480
  s_add_u32 s34, s34, 14155776
  buffer_load_dwordx4 a[80:83], v1, s[4:7], s34 offen offset:0
  buffer_load_dwordx4 a[84:87], v1, s[4:7], s34 offen offset:1024
  buffer_load_dwordx4 a[88:91], v1, s[4:7], s34 offen offset:2048
  buffer_load_dwordx4 a[92:95], v1, s[4:7], s34 offen offset:3072
  s_add_u32 s34, s34, 4096
  buffer_load_dwordx4 a[96:99], v1, s[4:7], s34 offen offset:0
  buffer_load_dwordx4 a[100:103], v1, s[4:7], s34 offen offset:1024
  buffer_load_dwordx4 a[104:107], v1, s[4:7], s34 offen offset:2048
  buffer_load_dwordx4 a[108:111], v1, s[4:7], s34 offen offset:3072
  s_add_u32 s34, s34, 4096
  buffer_load_dwordx4 a[112:115], v1, s[4:7], s34 offen offset:0
  buffer_load_dwordx4 a[116:119], v1, s[4:7], s34 offen offset:1024
  buffer_load_dwordx4 a[120:123], v1, s[4:7], s34 offen offset:2048
  buffer_load_dwordx4 a[124:127], v1, s[4:7], s34 offen offset:3072
  s_add_u32 s34, s34, 4096
  buffer_load_dwordx4 a[128:131], v1, s[4:7], s34 offen offset:0
  buffer_load_dwordx4 a[132:135], v1, s[4:7], s34 offen offset:1024
  buffer_load_dwordx4 a[136:139], v1, s[4:7], s34 offen offset:2048
  buffer_load_dwordx4 a[140:143], v1, s[4:7], s34 offen offset:3072
  s_add_u32 s34, s34, 4096
  buffer_load_dwordx4 a[144:147], v1, s[4:7], s34 offen offset:0
  buffer_load_dwordx4 a[148:151], v1, s[4:7], s34 offen offset:1024
  buffer_load_dwordx4 a[152:155], v1, s[4:7], s34 offen offset:2048
  buffer_load_dwordx4 a[156:159], v1, s[4:7], s34 offen offset:3072
  s_waitcnt vmcnt(20)
  s_mul_i32 s34, s15, 12
  s_mul_i32 s35, s16, 6
  s_add_u32 s34, s34, s35
  s_add_u32 s34, s34, 2
  s_mul_i32 s34, s34, 20480
  s_add_u32 s34, s34, 14155776
  buffer_load_dwordx4 a[160:163], v1, s[4:7], s34 offen offset:0
  buffer_load_dwordx4 a[164:167], v1, s[4:7], s34 offen offset:1024
  buffer_load_dwordx4 a[168:171], v1, s[4:7], s34 offen offset:2048
  buffer_load_dwordx4 a[172:175], v1, s[4:7], s34 offen offset:3072
  s_add_u32 s34, s34, 4096
  buffer_load_dwordx4 a[176:179], v1, s[4:7], s34 offen offset:0
  buffer_load_dwordx4 a[180:183], v1, s[4:7], s34 offen offset:1024
  buffer_load_dwordx4 a[184:187], v1, s[4:7], s34 offen offset:2048
  buffer_load_dwordx4 a[188:191], v1, s[4:7], s34 offen offset:3072
  s_add_u32 s34, s34, 4096
  buffer_load_dwordx4 a[192:195], v1, s[4:7], s34 offen offset:0
  buffer_load_dwordx4 a[196:199], v1, s[4:7], s34 offen offset:1024
  buffer_load_dwordx4 a[200:203], v1, s[4:7], s34 offen offset:2048
  buffer_load_dwordx4 a[204:207], v1, s[4:7], s34 offen offset:3072
  s_add_u32 s34, s34, 4096
  buffer_load_dwordx4 a[208:211], v1, s[4:7], s34 offen offset:0
  buffer_load_dwordx4 a[212:215], v1, s[4:7], s34 offen offset:1024
  buffer_load_dwordx4 a[216:219], v1, s[4:7], s34 offen offset:2048
  buffer_load_dwordx4 a[220:223], v1, s[4:7], s34 offen offset:3072
  s_add_u32 s34, s34, 4096
  buffer_load_dwordx4 a[224:227], v1, s[4:7], s34 offen offset:0
  buffer_load_dwordx4 a[228:231], v1, s[4:7], s34 offen offset:1024
  buffer_load_dwordx4 a[232:235], v1, s[4:7], s34 offen offset:2048
  buffer_load_dwordx4 a[236:239], v1, s[4:7], s34 offen offset:3072
  s_waitcnt vmcnt(20)
  s_mul_i32 s34, s15, 12
  s_mul_i32 s35, s16, 6
  s_add_u32 s34, s34, s35
  s_add_u32 s34, s34, 3
  s_mul_i32 s34, s34, 20480
  s_add_u32 s34, s34, 14155776
  buffer_load_dwordx4 v[96:99], v1, s[4:7], s34 offen offset:0
  buffer_load_dwordx4 v[100:103], v1, s[4:7], s34 offen offset:1024
  buffer_load_dwordx4 v[104:107], v1, s[4:7], s34 offen offset:2048
  buffer_load_dwordx4 v[108:111], v1, s[4:7], s34 offen offset:3072
  s_add_u32 s34, s34, 4096
  buffer_load_dwordx4 v[112:115], v1, s[4:7], s34 offen offset:0
  buffer_load_dwordx4 v[116:119], v1, s[4:7], s34 offen offset:1024
  buffer_load_dwordx4 v[120:123], v1, s[4:7], s34 offen offset:2048
  buffer_load_dwordx4 v[124:127], v1, s[4:7], s34 offen offset:3072
  s_add_u32 s34, s34, 4096
  buffer_load_dwordx4 v[128:131], v1, s[4:7], s34 offen offset:0
  buffer_load_dwordx4 v[132:135], v1, s[4:7], s34 offen offset:1024
  buffer_load_dwordx4 v[136:139], v1, s[4:7], s34 offen offset:2048
  buffer_load_dwordx4 v[140:143], v1, s[4:7], s34 offen offset:3072
  s_add_u32 s34, s34, 4096
  buffer_load_dwordx4 v[144:147], v1, s[4:7], s34 offen offset:0
  buffer_load_dwordx4 v[148:151], v1, s[4:7], s34 offen offset:1024
  buffer_load_dwordx4 v[152:155], v1, s[4:7], s34 offen offset:2048
  buffer_load_dwordx4 v[156:159], v1, s[4:7], s34 offen offset:3072
  s_add_u32 s34, s34, 4096
  buffer_load_dwordx4 v[160:163], v1, s[4:7], s34 offen offset:0
  buffer_load_dwordx4 v[164:167], v1, s[4:7], s34 offen offset:1024
  buffer_load_dwordx4 v[168:171], v1, s[4:7], s34 offen offset:2048
  buffer_load_dwordx4 v[172:175], v1, s[4:7], s34 offen offset:3072
  s_waitcnt vmcnt(20)
  s_mul_i32 s34, s15, 12
  s_mul_i32 s35, s16, 6
  s_add_u32 s34, s34, s35
  s_add_u32 s34, s34, 0
  s_mul_i32 s34, s34, 20480
  s_add_u32 s34, s34, 22020096
  buffer_load_dwordx4 v[176:179], v1, s[4:7], s34 offen offset:0
  buffer_load_dwordx4 v[180:183], v1, s[4:7], s34 offen offset:1024
  buffer_load_dwordx4 v[184:187], v1, s[4:7], s34 offen offset:2048
  buffer_load_dwordx4 v[188:191], v1, s[4:7], s34 offen offset:3072
  s_add_u32 s34, s34, 4096
  buffer_load_dwordx4 v[192:195], v1, s[4:7], s34 offen offset:0
  buffer_load_dwordx4 v[196:199], v1, s[4:7], s34 offen offset:1024
  buffer_load_dwordx4 v[200:203], v1, s[4:7], s34 offen offset:2048
  buffer_load_dwordx4 v[204:207], v1, s[4:7], s34 offen offset:3072
  s_add_u32 s34, s34, 4096
  buffer_load_dwordx4 v[208:211], v1, s[4:7], s34 offen offset:0
  buffer_load_dwordx4 v[212:215], v1, s[4:7], s34 offen offset:1024
  buffer_load_dwordx4 v[216:219], v1, s[4:7], s34 offen offset:2048
  buffer_load_dwordx4 v[220:223], v1, s[4:7], s34 offen offset:3072
  s_add_u32 s34, s34, 4096
  buffer_load_dwordx4 v[224:227], v1, s[4:7], s34 offen offset:0
  buffer_load_dwordx4 v[228:231], v1, s[4:7], s34 offen offset:1024
  buffer_load_dwordx4 v[232:235], v1, s[4:7], s34 offen offset:2048
  buffer_load_dwordx4 v[236:239], v1, s[4:7], s34 offen offset:3072
  s_add_u32 s34, s34, 4096
  buffer_load_dwordx4 v[240:243], v1, s[4:7], s34 offen offset:0
  buffer_load_dwordx4 v[244:247], v1, s[4:7], s34 offen offset:1024
  buffer_load_dwordx4 v[248:251], v1, s[4:7], s34 offen offset:2048
  buffer_load_dwordx4 v[252:255], v1, s[4:7], s34 offen offset:3072
  s_waitcnt vmcnt(20)
  s_mov_b32 s17, 0
  s_mov_b32 s26, 0
  s_mul_i32 s20, s17, 40960
  s_add_u32 s20, s20, 153616384
  s_add_u32 m0, s26, 0
  s_nop 0
  buffer_load_dwordx4 v1, s[4:7], s20 offen offset:0 lds
  buffer_load_dwordx4 v1, s[4:7], s20 offen offset:1024 lds
  buffer_load_dwordx4 v1, s[4:7], s20 offen offset:2048 lds
  buffer_load_dwordx4 v1, s[4:7], s20 offen offset:3072 lds
  s_add_u32 s20, s20, 4096
  s_add_u32 m0, s26, 4096
  s_nop 0
  buffer_load_dwordx4 v1, s[4:7], s20 offen offset:0 lds
  buffer_load_dwordx4 v1, s[4:7], s20 offen offset:1024 lds
  buffer_load_dwordx4 v1, s[4:7], s20 offen offset:2048 lds
  buffer_load_dwordx4 v1, s[4:7], s20 offen offset:3072 lds
  s_add_u32 s20, s20, 4096
  s_add_u32 m0, s26, 8192
  s_nop 0
  buffer_load_dwordx4 v1, s[4:7], s20 offen offset:0 lds
  buffer_load_dwordx4 v1, s[4:7], s20 offen offset:1024 lds
reca_ptop90:
  s_cmp_lt_u32 s17, 6
  s_cbranch_scc1 reca_pgo91
  s_sub_u32 s36, s17, 6
reca_ppoll92:
  buffer_load_dword v5, v4, s[4:7], s25 offen sc1
  s_waitcnt vmcnt(0)
  v_readfirstlane_b32 s34, v5
  s_nop 3
  s_cmp_ge_i32 s34, s36
  s_cbranch_scc1 reca_pgo91
  s_sleep 8
  s_sub_u32 s18, s18, 1
  s_cbranch_scc0 reca_ppoll92
  s_mov_b32 s18, 0
reca_pgo91:
  s_waitcnt vmcnt(0)
  s_barrier
  v_add_u32 v7, s26, v1
  s_xor_b32 s26, s26, 40960
  s_add_u32 s37, s17, 1
  s_cmp_ge_u32 s37, 64
  s_cbranch_scc1 reca_pnodma93
  s_mul_i32 s20, s37, 40960
  s_add_u32 s20, s20, 153616384
  s_add_u32 m0, s26, 0
  s_nop 0
  buffer_load_dwordx4 v1, s[4:7], s20 offen offset:0 lds
  buffer_load_dwordx4 v1, s[4:7], s20 offen offset:1024 lds
  buffer_load_dwordx4 v1, s[4:7], s20 offen offset:2048 lds
  buffer_load_dwordx4 v1, s[4:7], s20 offen offset:3072 lds
  s_add_u32 s20, s20, 4096
  s_add_u32 m0, s26, 4096
  s_nop 0
  buffer_load_dwordx4 v1, s[4:7], s20 offen offset:0 lds
  buffer_load_dwordx4 v1, s[4:7], s20 offen offset:1024 lds
  buffer_load_dwordx4 v1, s[4:7], s20 offen offset:2048 lds
  buffer_load_dwordx4 v1, s[4:7], s20 offen offset:3072 lds
  s_add_u32 s20, s20, 4096
  s_add_u32 m0, s26, 8192
  s_nop 0
  buffer_load_dwordx4 v1, s[4:7], s20 offen offset:0 lds
  buffer_load_dwordx4 v1, s[4:7], s20 offen offset:1024 lds
reca_pnodma93:
  s_lshl_b32 s34, s15, 6
  s_add_u32 s34, s34, s17
  s_mul_i32 s34, s34, 12288
  s_mul_i32 s35, s16, 3072
  s_add_u32 s35, s35, s34
  s_add_u32 s21, s35, 37748736
  s_add_u32 s22, s35, 88080384
  s_mul_i32 s35, s16, 6144
  s_add_u32 s35, s35, s34
  s_add_u32 s23, s35, 62914560
  ds_read_b128 v[48:51], v7 offset:0
  ds_read_b128 v[52:55], v7 offset:20480
  ds_read_b128 v[56:59], v7 offset:1024
  ds_read_b128 v[60:63], v7 offset:21504
  ds_read_b128 v[64:67], v7 offset:2048
  ds_read_b128 v[68:71], v7 offset:22528
  s_waitcnt lgkmcnt(4)
  v_mfma_f32_16x16x32_bf16 v[8:11], a[0:3], v[48:51], 0
  v_mfma_f32_16x16x32_bf16 v[12:15], a[0:3], v[52:55], 0
  v_mfma_f32_16x16x32_bf16 v[16:19], a[80:83], v[48:51], 0
  v_mfma_f32_16x16x32_bf16 v[20:23], a[80:83], v[52:55], 0
  v_mfma_f32_16x16x32_bf16 v[24:27], a[160:163], v[48:51], 0
  v_mfma_f32_16x16x32_bf16 v[28:31], a[160:163], v[52:55], 0
  v_mfma_f32_16x16x32_bf16 v[32:35], v[96:99], v[48:51], 0
  v_mfma_f32_16x16x32_bf16 v[36:39], v[96:99], v[52:55], 0
  v_mfma_f32_16x16x32_bf16 v[40:43], v[48:51], v[176:179], 0
  v_mfma_f32_16x16x32_bf16 v[44:47], v[52:55], v[176:179], 0
  ds_read_b128 v[48:51], v7 offset:3072
  ds_read_b128 v[52:55], v7 offset:23552
  s_waitcnt lgkmcnt(4)
  v_mfma_f32_16x16x32_bf16 v[8:11], a[4:7], v[56:59], v[8:11]
  v_mfma_f32_16x16x32_bf16 v[12:15], a[4:7], v[60:63], v[12:15]
  v_mfma_f32_16x16x32_bf16 v[16:19], a[84:87], v[56:59], v[16:19]
  v_mfma_f32_16x16x32_bf16 v[20:23], a[84:87], v[60:63], v[20:23]
  v_mfma_f32_16x16x32_bf16 v[24:27], a[164:167], v[56:59], v[24:27]
  v_mfma_f32_16x16x32_bf16 v[28:31], a[164:167], v[60:63], v[28:31]
  v_mfma_f32_16x16x32_bf16 v[32:35], v[100:103], v[56:59], v[32:35]
  v_mfma_f32_16x16x32_bf16 v[36:39], v[100:103], v[60:63], v[36:39]
  v_mfma_f32_16x16x32_bf16 v[40:43], v[56:59], v[180:183], v[40:43]
  v_mfma_f32_16x16x32_bf16 v[44:47], v[60:63], v[180:183], v[44:47]
  ds_read_b128 v[56:59], v7 offset:4096
  ds_read_b128 v[60:63], v7 offset:24576
  s_waitcnt lgkmcnt(4)
  v_mfma_f32_16x16x32_bf16 v[8:11], a[8:11], v[64:67], v[8:11]
  v_mfma_f32_16x16x32_bf16 v[12:15], a[8:11], v[68:71], v[12:15]
  v_mfma_f32_16x16x32_bf16 v[16:19], a[88:91], v[64:67], v[16:19]
  v_mfma_f32_16x16x32_bf16 v[20:23], a[88:91], v[68:71], v[20:23]
  v_mfma_f32_16x16x32_bf16 v[24:27], a[168:171], v[64:67], v[24:27]
  v_mfma_f32_16x16x32_bf16 v[28:31], a[168:171], v[68:71], v[28:31]
  v_mfma_f32_16x16x32_bf16 v[32:35], v[104:107], v[64:67], v[32:35]
  v_mfma_f32_16x16x32_bf16 v[36:39], v[104:107], v[68:71], v[36:39]
  v_mfma_f32_16x16x32_bf16 v[40:43], v[64:67], v[184:187], v[40:43]
  v_mfma_f32_16x16x32_bf16 v[44:47], v[68:71], v[184:187], v[44:47]
  ds_read_b128 v[64:67], v7 offset:5120
  ds_read_b128 v[68:71], v7 offset:25600
  s_waitcnt lgkmcnt(4)
  v_mfma_f32_16x16x32_bf16 v[8:11], a[12:15], v[48:51], v[8:11]
  v_mfma_f32_16x16x32_bf16 v[12:15], a[12:15], v[52:55], v[12:15]
  v_mfma_f32_16x16x32_bf16 v[16:19], a[92:95], v[48:51], v[16:19]
  v_mfma_f32_16x16x32_bf16 v[20:23], a[92:95], v[52:55], v[20:23]
  v_mfma_f32_16x16x32_bf16 v[24:27], a[172:175], v[48:51], v[24:27]
  v_mfma_f32_16x16x32_bf16 v[28:31], a[172:175], v[52:55], v[28:31]
  v_mfma_f32_16x16x32_bf16 v[32:35], v[108:111], v[48:51], v[32:35]
  v_mfma_f32_16x16x32_bf16 v[36:39], v[108:111], v[52:55], v[36:39]
  v_mfma_f32_16x16x32_bf16 v[40:43], v[48:51], v[188:191], v[40:43]
  v_mfma_f32_16x16x32_bf16 v[44:47], v[52:55], v[188:191], v[44:47]
  ds_read_b128 v[48:51], v7 offset:6144
  ds_read_b128 v[52:55], v7 offset:26624
  s_waitcnt lgkmcnt(4)
  v_mfma_f32_16x16x32_bf16 v[8:11], a[16:19], v[56:59], v[8:11]
  v_mfma_f32_16x16x32_bf16 v[12:15], a[16:19], v[60:63], v[12:15]
  v_mfma_f32_16x16x32_bf16 v[16:19], a[96:99], v[56:59], v[16:19]
  v_mfma_f32_16x16x32_bf16 v[20:23], a[96:99], v[60:63], v[20:23]
  v_mfma_f32_16x16x32_bf16 v[24:27], a[176:179], v[56:59], v[24:27]
  v_mfma_f32_16x16x32_bf16 v[28:31], a[176:179], v[60:63], v[28:31]
  v_mfma_f32_16x16x32_bf16 v[32:35], v[112:115], v[56:59], v[32:35]
  v_mfma_f32_16x16x32_bf16 v[36:39], v[112:115], v[60:63], v[36:39]
  v_mfma_f32_16x16x32_bf16 v[40:43], v[56:59], v[192:195], v[40:43]
  v_mfma_f32_16x16x32_bf16 v[44:47], v[60:63], v[192:195], v[44:47]
  ds_read_b128 v[56:59], v7 offset:7168
  ds_read_b128 v[60:63], v7 offset:27648
  s_waitcnt lgkmcnt(4)
  v_mfma_f32_16x16x32_bf16 v[8:11], a[20:23], v[64:67], v[8:11]
  v_mfma_f32_16x16x32_bf16 v[12:15], a[20:23], v[68:71], v[12:15]
  v_mfma_f32_16x16x32_bf16 v[16:19], a[100:103], v[64:67], v[16:19]
  v_mfma_f32_16x16x32_bf16 v[20:23], a[100:103], v[68:71], v[20:23]
  v_mfma_f32_16x16x32_bf16 v[24:27], a[180:183], v[64:67], v[24:27]
  v_mfma_f32_16x16x32_bf16 v[28:31], a[180:183], v[68:71], v[28:31]
  v_mfma_f32_16x16x32_bf16 v[32:35], v[116:119], v[64:67], v[32:35]
  v_mfma_f32_16x16x32_bf16 v[36:39], v[116:119], v[68:71], v[36:39]
  v_mfma_f32_16x16x32_bf16 v[40:43], v[64:67], v[196:199], v[40:43]
  v_mfma_f32_16x16x32_bf16 v[44:47], v[68:71], v[196:199], v[44:47]
  ds_read_b128 v[64:67], v7 offset:8192
  ds_read_b128 v[68:71], v7 offset:28672
  s_waitcnt lgkmcnt(4)
  v_mfma_f32_16x16x32_bf16 v[8:11], a[24:27], v[48:51], v[8:11]
  v_mfma_f32_16x16x32_bf16 v[12:15], a[24:27], v[52:55], v[12:15]
  v_mfma_f32_16x16x32_bf16 v[16:19], a[104:107], v[48:51], v[16:19]
  v_mfma_f32_16x16x32_bf16 v[20:23], a[104:107], v[52:55], v[20:23]
  v_mfma_f32_16x16x32_bf16 v[24:27], a[184:187], v[48:51], v[24:27]
  v_mfma_f32_16x16x32_bf16 v[28:31], a[184:187], v[52:55], v[28:31]
  v_mfma_f32_16x16x32_bf16 v[32:35], v[120:123], v[48:51], v[32:35]
  v_mfma_f32_16x16x32_bf16 v[36:39], v[120:123], v[52:55], v[36:39]
  v_mfma_f32_16x16x32_bf16 v[40:43], v[48:51], v[200:203], v[40:43]
  v_mfma_f32_16x16x32_bf16 v[44:47], v[52:55], v[200:203], v[44:47]
  ds_read_b128 v[48:51], v7 offset:9216
  ds_read_b128 v[52:55], v7 offset:29696
  s_waitcnt lgkmcnt(4)
  v_mfma_f32_16x16x32_bf16 v[8:11], a[28:31], v[56:59], v[8:11]
  v_mfma_f32_16x16x32_bf16 v[12:15], a[28:31], v[60:63], v[12:15]
  v_mfma_f32_16x16x32_bf16 v[16:19], a[108:111], v[56:59], v[16:19]
  v_mfma_f32_16x16x32_bf16 v[20:23], a[108:111], v[60:63], v[20:23]
  v_mfma_f32_16x16x32_bf16 v[24:27], a[188:191], v[56:59], v[24:27]
  v_mfma_f32_16x16x32_bf16 v[28:31], a[188:191], v[60:63], v[28:31]
  v_mfma_f32_16x16x32_bf16 v[32:35], v[124:127], v[56:59], v[32:35]
  v_mfma_f32_16x16x32_bf16 v[36:39], v[124:127], v[60:63], v[36:39]
  v_mfma_f32_16x16x32_bf16 v[40:43], v[56:59], v[204:207], v[40:43]
  v_mfma_f32_16x16x32_bf16 v[44:47], v[60:63], v[204:207], v[44:47]
  ds_read_b128 v[56:59], v7 offset:10240
  ds_read_b128 v[60:63], v7 offset:30720
  s_waitcnt lgkmcnt(4)
  v_mfma_f32_16x16x32_bf16 v[8:11], a[32:35], v[64:67], v[8:11]
  v_mfma_f32_16x16x32_bf16 v[12:15], a[32:35], v[68:71], v[12:15]
  v_mfma_f32_16x16x32_bf16 v[16:19], a[112:115], v[64:67], v[16:19]
  v_mfma_f32_16x16x32_bf16 v[20:23], a[112:115], v[68:71], v[20:23]
  v_mfma_f32_16x16x32_bf16 v[24:27], a[192:195], v[64:67], v[24:27]
  v_mfma_f32_16x16x32_bf16 v[28:31], a[192:195], v[68:71], v[28:31]
  v_mfma_f32_16x16x32_bf16 v[32:35], v[128:131], v[64:67], v[32:35]
  v_mfma_f32_16x16x32_bf16 v[36:39], v[128:131], v[68:71], v[36:39]
  v_mfma_f32_16x16x32_bf16 v[40:43], v[64:67], v[208:211], v[40:43]
  v_mfma_f32_16x16x32_bf16 v[44:47], v[68:71], v[208:211], v[44:47]
  ds_read_b128 v[64:67], v7 offset:11264
  ds_read_b128 v[68:71], v7 offset:31744
  s_waitcnt lgkmcnt(4)
  v_mfma_f32_16x16x32_bf16 v[8:11], a[36:39], v[48:51], v[8:11]
  v_mfma_f32_16x16x32_bf16 v[12:15], a[36:39], v[52:55], v[12:15]
  v_mfma_f32_16x16x32_bf16 v[16:19], a[116:119], v[48:51], v[16:19]
  v_mfma_f32_16x16x32_bf16 v[20:23], a[116:119], v[52:55], v[20:23]
  v_mfma_f32_16x16x32_bf16 v[24:27], a[196:199], v[48:51], v[24:27]
  v_mfma_f32_16x16x32_bf16 v[28:31], a[196:199], v[52:55], v[28:31]
  v_mfma_f32_16x16x32_bf16 v[32:35], v[132:135], v[48:51], v[32:35]
  v_mfma_f32_16x16x32_bf16 v[36:39], v[132:135], v[52:55], v[36:39]
  v_mfma_f32_16x16x32_bf16 v[40:43], v[48:51], v[212:215], v[40:43]
  v_mfma_f32_16x16x32_bf16 v[44:47], v[52:55], v[212:215], v[44:47]
  ds_read_b128 v[48:51], v7 offset:12288
  ds_read_b128 v[52:55], v7 offset:32768
  s_waitcnt lgkmcnt(4)
  v_mfma_f32_16x16x32_bf16 v[8:11], a[40:43], v[56:59], v[8:11]
  v_mfma_f32_16x16x32_bf16 v[12:15], a[40:43], v[60:63], v[12:15]
  v_mfma_f32_16x16x32_bf16 v[16:19], a[120:123], v[56:59], v[16:19]
  v_mfma_f32_16x16x32_bf16 v[20:23], a[120:123], v[60:63], v[20:23]
  v_mfma_f32_16x16x32_bf16 v[24:27], a[200:203], v[56:59], v[24:27]
  v_mfma_f32_16x16x32_bf16 v[28:31], a[200:203], v[60:63], v[28:31]
  v_mfma_f32_16x16x32_bf16 v[32:35], v[136:139], v[56:59], v[32:35]
  v_mfma_f32_16x16x32_bf16 v[36:39], v[136:139], v[60:63], v[36:39]
  v_mfma_f32_16x16x32_bf16 v[40:43], v[56:59], v[216:219], v[40:43]
  v_mfma_f32_16x16x32_bf16 v[44:47], v[60:63], v[216:219], v[44:47]
  ds_read_b128 v[56:59], v7 offset:13312
  ds_read_b128 v[60:63], v7 offset:33792
  s_waitcnt lgkmcnt(4)
  v_mfma_f32_16x16x32_bf16 v[8:11], a[44:47], v[64:67], v[8:11]
  v_mfma_f32_16x16x32_bf16 v[12:15], a[44:47], v[68:71], v[12:15]
  v_mfma_f32_16x16x32_bf16 v[16:19], a[124:127], v[64:67], v[16:19]
  v_mfma_f32_16x16x32_bf16 v[20:23], a[124:127], v[68:71], v[20:23]
  v_mfma_f32_16x16x32_bf16 v[24:27], a[204:207], v[64:67], v[24:27]
  v_mfma_f32_16x16x32_bf16 v[28:31], a[204:207], v[68:71], v[28:31]
  v_mfma_f32_16x16x32_bf16 v[32:35], v[140:143], v[64:67], v[32:35]
  v_mfma_f32_16x16x32_bf16 v[36:39], v[140:143], v[68:71], v[36:39]
  v_mfma_f32_16x16x32_bf16 v[40:43], v[64:67], v[220:223], v[40:43]
  v_mfma_f32_16x16x32_bf16 v[44:47], v[68:71], v[220:223], v[44:47]
  ds_read_b128 v[64:67], v7 offset:14336
  ds_read_b128 v[68:71], v7 offset:34816
  s_waitcnt lgkmcnt(4)
  v_mfma_f32_16x16x32_bf16 v[8:11], a[48:51], v[48:51], v[8:11]
  v_mfma_f32_16x16x32_bf16 v[12:15], a[48:51], v[52:55], v[12:15]
  v_mfma_f32_16x16x32_bf16 v[16:19], a[128:131], v[48:51], v[16:19]
  v_mfma_f32_16x16x32_bf16 v[20:23], a[128:131], v[52:55], v[20:23]
  v_mfma_f32_16x16x32_bf16 v[24:27], a[208:211], v[48:51], v[24:27]
  v_mfma_f32_16x16x32_bf16 v[28:31], a[208:211], v[52:55], v[28:31]
  v_mfma_f32_16x16x32_bf16 v[32:35], v[144:147], v[48:51], v[32:35]
  v_mfma_f32_16x16x32_bf16 v[36:39], v[144:147], v[52:55], v[36:39]
  v_mfma_f32_16x16x32_bf16 v[40:43], v[48:51], v[224:227], v[40:43]
  v_mfma_f32_16x16x32_bf16 v[44:47], v[52:55], v[224:227], v[44:47]
  ds_read_b128 v[48:51], v7 offset:15360
  ds_read_b128 v[52:55], v7 offset:35840
  s_waitcnt lgkmcnt(4)
  v_mfma_f32_16x16x32_bf16 v[8:11], a[52:55], v[56:59], v[8:11]
  v_mfma_f32_16x16x32_bf16 v[12:15], a[52:55], v[60:63], v[12:15]
  v_mfma_f32_16x16x32_bf16 v[16:19], a[132:135], v[56:59], v[16:19]
  v_mfma_f32_16x16x32_bf16 v[20:23], a[132:135], v[60:63], v[20:23]
  v_mfma_f32_16x16x32_bf16 v[24:27], a[212:215], v[56:59], v[24:27]
  v_mfma_f32_16x16x32_bf16 v[28:31], a[212:215], v[60:63], v[28:31]
  v_mfma_f32_16x16x32_bf16 v[32:35], v[148:151], v[56:59], v[32:35]
  v_mfma_f32_16x16x32_bf16 v[36:39], v[148:151], v[60:63], v[36:39]
  v_mfma_f32_16x16x32_bf16 v[40:43], v[56:59], v[228:231], v[40:43]
  v_mfma_f32_16x16x32_bf16 v[44:47], v[60:63], v[228:231], v[44:47]
  ds_read_b128 v[56:59], v7 offset:16384
  ds_read_b128 v[60:63], v7 offset:36864
  s_waitcnt lgkmcnt(4)
  v_mfma_f32_16x16x32_bf16 v[8:11], a[56:59], v[64:67], v[8:11]
  v_mfma_f32_16x16x32_bf16 v[12:15], a[56:59], v[68:71], v[12:15]
  v_mfma_f32_16x16x32_bf16 v[16:19], a[136:139], v[64:67], v[16:19]
  v_mfma_f32_16x16x32_bf16 v[20:23], a[136:139], v[68:71], v[20:23]
  v_mfma_f32_16x16x32_bf16 v[24:27], a[216:219], v[64:67], v[24:27]
  v_mfma_f32_16x16x32_bf16 v[28:31], a[216:219], v[68:71], v[28:31]
  v_mfma_f32_16x16x32_bf16 v[32:35], v[152:155], v[64:67], v[32:35]
  v_mfma_f32_16x16x32_bf16 v[36:39], v[152:155], v[68:71], v[36:39]
  v_mfma_f32_16x16x32_bf16 v[40:43], v[64:67], v[232:235], v[40:43]
  v_mfma_f32_16x16x32_bf16 v[44:47], v[68:71], v[232:235], v[44:47]
  ds_read_b128 v[64:67], v7 offset:17408
  ds_read_b128 v[68:71], v7 offset:37888
  s_waitcnt lgkmcnt(4)
  v_mfma_f32_16x16x32_bf16 v[8:11], a[60:63], v[48:51], v[8:11]
  v_mfma_f32_16x16x32_bf16 v[12:15], a[60:63], v[52:55], v[12:15]
  v_mfma_f32_16x16x32_bf16 v[16:19], a[140:143], v[48:51], v[16:19]
  v_mfma_f32_16x16x32_bf16 v[20:23], a[140:143], v[52:55], v[20:23]
  v_mfma_f32_16x16x32_bf16 v[24:27], a[220:223], v[48:51], v[24:27]
  v_mfma_f32_16x16x32_bf16 v[28:31], a[220:223], v[52:55], v[28:31]
  v_mfma_f32_16x16x32_bf16 v[32:35], v[156:159], v[48:51], v[32:35]
  v_mfma_f32_16x16x32_bf16 v[36:39], v[156:159], v[52:55], v[36:39]
  v_mfma_f32_16x16x32_bf16 v[40:43], v[48:51], v[236:239], v[40:43]
  v_mfma_f32_16x16x32_bf16 v[44:47], v[52:55], v[236:239], v[44:47]
  ds_read_b128 v[48:51], v7 offset:18432
  ds_read_b128 v[52:55], v7 offset:38912
  s_waitcnt lgkmcnt(4)
  v_mfma_f32_16x16x32_bf16 v[8:11], a[64:67], v[56:59], v[8:11]
  v_mfma_f32_16x16x32_bf16 v[12:15], a[64:67], v[60:63], v[12:15]
  v_mfma_f32_16x16x32_bf16 v[16:19], a[144:147], v[56:59], v[16:19]
  v_mfma_f32_16x16x32_bf16 v[20:23], a[144:147], v[60:63], v[20:23]
  v_mfma_f32_16x16x32_bf16 v[24:27], a[224:227], v[56:59], v[24:27]
  v_mfma_f32_16x16x32_bf16 v[28:31], a[224:227], v[60:63], v[28:31]
  v_mfma_f32_16x16x32_bf16 v[32:35], v[160:163], v[56:59], v[32:35]
  v_mfma_f32_16x16x32_bf16 v[36:39], v[160:163], v[60:63], v[36:39]
  v_mfma_f32_16x16x32_bf16 v[40:43], v[56:59], v[240:243], v[40:43]
  v_mfma_f32_16x16x32_bf16 v[44:47], v[60:63], v[240:243], v[44:47]
  ds_read_b128 v[56:59], v7 offset:19456
  ds_read_b128 v[60:63], v7 offset:39936
  s_waitcnt lgkmcnt(4)
  v_mfma_f32_16x16x32_bf16 v[8:11], a[68:71], v[64:67], v[8:11]
  v_mfma_f32_16x16x32_bf16 v[12:15], a[68:71], v[68:71], v[12:15]
  v_mfma_f32_16x16x32_bf16 v[16:19], a[148:151], v[64:67], v[16:19]
  v_mfma_f32_16x16x32_bf16 v[20:23], a[148:151], v[68:71], v[20:23]
  v_mfma_f32_16x16x32_bf16 v[24:27], a[228:231], v[64:67], v[24:27]
  v_mfma_f32_16x16x32_bf16 v[28:31], a[228:231], v[68:71], v[28:31]
  v_mfma_f32_16x16x32_bf16 v[32:35], v[164:167], v[64:67], v[32:35]
  v_mfma_f32_16x16x32_bf16 v[36:39], v[164:167], v[68:71], v[36:39]
  v_mfma_f32_16x16x32_bf16 v[40:43], v[64:67], v[244:247], v[40:43]
  v_mfma_f32_16x16x32_bf16 v[44:47], v[68:71], v[244:247], v[44:47]
  s_waitcnt lgkmcnt(2)
  v_mfma_f32_16x16x32_bf16 v[8:11], a[72:75], v[48:51], v[8:11]
  v_mfma_f32_16x16x32_bf16 v[12:15], a[72:75], v[52:55], v[12:15]
  v_mfma_f32_16x16x32_bf16 v[16:19], a[152:155], v[48:51], v[16:19]
  v_mfma_f32_16x16x32_bf16 v[20:23], a[152:155], v[52:55], v[20:23]
  v_mfma_f32_16x16x32_bf16 v[24:27], a[232:235], v[48:51], v[24:27]
  v_mfma_f32_16x16x32_bf16 v[28:31], a[232:235], v[52:55], v[28:31]
  v_mfma_f32_16x16x32_bf16 v[32:35], v[168:171], v[48:51], v[32:35]
  v_mfma_f32_16x16x32_bf16 v[36:39], v[168:171], v[52:55], v[36:39]
  v_mfma_f32_16x16x32_bf16 v[40:43], v[48:51], v[248:251], v[40:43]
  v_mfma_f32_16x16x32_bf16 v[44:47], v[52:55], v[248:251], v[44:47]
  s_waitcnt lgkmcnt(0)
  v_mfma_f32_16x16x32_bf16 v[8:11], a[76:79], v[56:59], v[8:11]
  v_mfma_f32_16x16x32_bf16 v[12:15], a[76:79], v[60:63], v[12:15]
  v_mfma_f32_16x16x32_bf16 v[16:19], a[156:159], v[56:59], v[16:19]
  v_mfma_f32_16x16x32_bf16 v[20:23], a[156:159], v[60:63], v[20:23]
  v_mfma_f32_16x16x32_bf16 v[24:27], a[236:239], v[56:59], v[24:27]
  v_mfma_f32_16x16x32_bf16 v[28:31], a[236:239], v[60:63], v[28:31]
  v_mfma_f32_16x16x32_bf16 v[32:35], v[172:175], v[56:59], v[32:35]
  v_mfma_f32_16x16x32_bf16 v[36:39], v[172:175], v[60:63], v[36:39]
  v_mfma_f32_16x16x32_bf16 v[40:43], v[56:59], v[252:255], v[40:43]
  v_mfma_f32_16x16x32_bf16 v[44:47], v[60:63], v[252:255], v[44:47]
  v_cvt_pk_bf16_f32 v72, v8, v9
  v_cvt_pk_bf16_f32 v73, v10, v11
  v_cvt_pk_bf16_f32 v74, v16, v17
  v_cvt_pk_bf16_f32 v75, v18, v19
  s_add_u32 s34, s21, 0
  buffer_store_dwordx4 v[72:75], v1, s[4:7], s34 offen
  v_cvt_pk_bf16_f32 v76, v12, v13
  v_cvt_pk_bf16_f32 v77, v14, v15
  v_cvt_pk_bf16_f32 v78, v20, v21
  v_cvt_pk_bf16_f32 v79, v22, v23
  s_add_u32 s34, s21, 6144
  buffer_store_dwordx4 v[76:79], v1, s[4:7], s34 offen
  v_cvt_pk_bf16_f32 v72, v24, v25
  v_cvt_pk_bf16_f32 v73, v26, v27
  v_cvt_pk_bf16_f32 v74, v32, v33
  v_cvt_pk_bf16_f32 v75, v34, v35
  s_add_u32 s34, s21, 1024
  buffer_store_dwordx4 v[72:75], v1, s[4:7], s34 offen
  v_cvt_pk_bf16_f32 v76, v28, v29
  v_cvt_pk_bf16_f32 v77, v30, v31
  v_cvt_pk_bf16_f32 v78, v36, v37
  v_cvt_pk_bf16_f32 v79, v38, v39
  s_add_u32 s34, s21, 7168
  buffer_store_dwordx4 v[76:79], v1, s[4:7], s34 offen
  v_cvt_pk_bf16_f32 v72, v40, v41
  v_cvt_pk_bf16_f32 v73, v42, v43
  v_cvt_pk_bf16_f32 v74, v44, v45
  v_cvt_pk_bf16_f32 v75, v46, v47
  s_add_u32 s34, s23, 0
  buffer_store_dwordx4 v[72:75], v1, s[4:7], s34 offen
  s_waitcnt vmcnt(0)
  s_barrier
  s_add_u32 s17, s17, 1
  v_mov_b32 v5, s17
  buffer_store_dword v5, v4, s[4:7], s24 offen
  s_cmp_lt_u32 s17, 64
  s_cbranch_scc1 reca_ptop90
  s_branch reca_exit1
reca_pw1_87:
  s_mul_i32 s34, s15, 12
  s_mul_i32 s35, s16, 6
  s_add_u32 s34, s34, s35
  s_add_u32 s34, s34, 4
  s_mul_i32 s34, s34, 20480
  s_add_u32 s34, s34, 14155776
  buffer_load_dwordx4 a[0:3], v1, s[4:7], s34 offen offset:0
  buffer_load_dwordx4 a[4:7], v1, s[4:7], s34 offen offset:1024
  buffer_load_dwordx4 a[8:11], v1, s[4:7], s34 offen offset:2048
  buffer_load_dwordx4 a[12:15], v1, s[4:7], s34 offen offset:3072
  s_add_u32 s34, s34, 4096
  buffer_load_dwordx4 a[16:19], v1, s[4:7], s34 offen offset:0
  buffer_load_dwordx4 a[20:23], v1, s[4:7], s34 offen offset:1024
  buffer_load_dwordx4 a[24:27], v1, s[4:7], s34 offen offset:2048
  buffer_load_dwordx4 a[28:31], v1, s[4:7], s34 offen offset:3072
  s_add_u32 s34, s34, 4096
  buffer_load_dwordx4 a[32:35], v1, s[4:7], s34 offen offset:0
  buffer_load_dwordx4 a[36:39], v1, s[4:7], s34 offen offset:1024
  buffer_load_dwordx4 a[40:43], v1, s[4:7], s34 offen offset:2048
  buffer_load_dwordx4 a[44:47], v1, s[4:7], s34 offen offset:3072
  s_add_u32 s34, s34, 4096
  buffer_load_dwordx4 a[48:51], v1, s[4:7], s34 offen offset:0
  buffer_load_dwordx4 a[52:55], v1, s[4:7], s34 offen offset:1024
  buffer_load_dwordx4 a[56:59], v1, s[4:7], s34 offen offset:2048
  buffer_load_dwordx4 a[60:63], v1, s[4:7], s34 offen offset:3072
  s_add_u32 s34, s34, 4096
  buffer_load_dwordx4 a[64:67], v1, s[4:7], s34 offen offset:0
  buffer_load_dwordx4 a[68:71], v1, s[4:7], s34 offen offset:1024
  buffer_load_dwordx4 a[72:75], v1, s[4:7], s34 offen offset:2048
  buffer_load_dwordx4 a[76:79], v1, s[4:7], s34 offen offset:3072
  s_mul_i32 s34, s15, 12
  s_mul_i32 s35, s16, 6
  s_add_u32 s34, s34, s35
  s_add_u32 s34, s34, 5
  s_mul_i32 s34, s34, 20480
  s_add_u32 s34, s34, 14155776
  buffer_load_dwordx4 a[80:83], v1, s[4:7], s34 offen offset:0
  buffer_load_dwordx4 a[84:87], v1, s[4:7], s34 offen offset:1024
  buffer_load_dwordx4 a[88:91], v1, s[4:7], s34 offen offset:2048
  buffer_load_dwordx4 a[92:95], v1, s[4:7], s34 offen offset:3072
  s_add_u32 s34, s34, 4096
  buffer_load_dwordx4 a[96:99], v1, s[4:7], s34 offen offset:0
  buffer_load_dwordx4 a[100:103], v1, s[4:7], s34 offen offset:1024
  buffer_load_dwordx4 a[104:107], v1, s[4:7], s34 offen offset:2048
  buffer_load_dwordx4 a[108:111], v1, s[4:7], s34 offen offset:3072
  s_add_u32 s34, s34, 4096
  buffer_load_dwordx4 a[112:115], v1, s[4:7], s34 offen offset:0
  buffer_load_dwordx4 a[116:119], v1, s[4:7], s34 offen offset:1024
  buffer_load_dwordx4 a[120:123], v1, s[4:7], s34 offen offset:2048
  buffer_load_dwordx4 a[124:127], v1, s[4:7], s34 offen offset:3072
  s_add_u32 s34, s34, 4096
  buffer_load_dwordx4 a[128:131], v1, s[4:7], s34 offen offset:0
  buffer_load_dwordx4 a[132:135], v1, s[4:7], s34 offen offset:1024
  buffer_load_dwordx4 a[136:139], v1, s[4:7], s34 offen offset:2048
  buffer_load_dwordx4 a[140:143], v1, s[4:7], s34 offen offset:3072
  s_add_u32 s34, s34, 4096
  buffer_load_dwordx4 a[144:147], v1, s[4:7], s34 offen offset:0
  buffer_load_dwordx4 a[148:151], v1, s[4:7], s34 offen offset:1024
  buffer_load_dwordx4 a[152:155], v1, s[4:7], s34 offen offset:2048
  buffer_load_dwordx4 a[156:159], v1, s[4:7], s34 offen offset:3072
  s_waitcnt vmcnt(20)
  s_mul_i32 s34, s15, 12
  s_mul_i32 s35, s16, 6
  s_add_u32 s34, s34, s35
  s_add_u32 s34, s34, 1
  s_mul_i32 s34, s34, 20480
  s_add_u32 s34, s34, 22020096
  buffer_load_dwordx4 a[160:163], v1, s[4:7], s34 offen offset:0
  buffer_load_dwordx4 a[164:167], v1, s[4:7], s34 offen offset:1024
  buffer_load_dwordx4 a[168:171], v1, s[4:7], s34 offen offset:2048
  buffer_load_dwordx4 a[172:175], v1, s[4:7], s34 offen offset:3072
  s_add_u32 s34, s34, 4096
  buffer_load_dwordx4 a[176:179], v1, s[4:7], s34 offen offset:0
  buffer_load_dwordx4 a[180:183], v1, s[4:7], s34 offen offset:1024
  buffer_load_dwordx4 a[184:187], v1, s[4:7], s34 offen offset:2048
  buffer_load_dwordx4 a[188:191], v1, s[4:7], s34 offen offset:3072
  s_add_u32 s34, s34, 4096
  buffer_load_dwordx4 a[192:195], v1, s[4:7], s34 offen offset:0
  buffer_load_dwordx4 a[196:199], v1, s[4:7], s34 offen offset:1024
  buffer_load_dwordx4 a[200:203], v1, s[4:7], s34 offen offset:2048
  buffer_load_dwordx4 a[204:207], v1, s[4:7], s34 offen offset:3072
  s_add_u32 s34, s34, 4096
  buffer_load_dwordx4 a[208:211], v1, s[4:7], s34 offen offset:0
  buffer_load_dwordx4 a[212:215], v1, s[4:7], s34 offen offset:1024
  buffer_load_dwordx4 a[216:219], v1, s[4:7], s34 offen offset:2048
  buffer_load_dwordx4 a[220:223], v1, s[4:7], s34 offen offset:3072
  s_add_u32 s34, s34, 4096
  buffer_load_dwordx4 a[224:227], v1, s[4:7], s34 offen offset:0
  buffer_load_dwordx4 a[228:231], v1, s[4:7], s34 offen offset:1024
  buffer_load_dwordx4 a[232:235], v1, s[4:7], s34 offen offset:2048
  buffer_load_dwordx4 a[236:239], v1, s[4:7], s34 offen offset:3072
  s_waitcnt vmcnt(20)
  s_mul_i32 s34, s15, 12
  s_mul_i32 s35, s16, 6
  s_add_u32 s34, s34, s35
  s_add_u32 s34, s34, 2
  s_mul_i32 s34, s34, 20480
  s_add_u32 s34, s34, 22020096
  buffer_load_dwordx4 v[96:99], v1, s[4:7], s34 offen offset:0
  buffer_load_dwordx4 v[100:103], v1, s[4:7], s34 offen offset:1024
  buffer_load_dwordx4 v[104:107], v1, s[4:7], s34 offen offset:2048
  buffer_load_dwordx4 v[108:111], v1, s[4:7], s34 offen offset:3072
  s_add_u32 s34, s34, 4096
  buffer_load_dwordx4 v[112:115], v1, s[4:7], s34 offen offset:0
  buffer_load_dwordx4 v[116:119], v1, s[4:7], s34 offen offset:1024
  buffer_load_dwordx4 v[120:123], v1, s[4:7], s34 offen offset:2048
  buffer_load_dwordx4 v[124:127], v1, s[4:7], s34 offen offset:3072
  s_add_u32 s34, s34, 4096
  buffer_load_dwordx4 v[128:131], v1, s[4:7], s34 offen offset:0
  buffer_load_dwordx4 v[132:135], v1, s[4:7], s34 offen offset:1024
  buffer_load_dwordx4 v[136:139], v1, s[4:7], s34 offen offset:2048
  buffer_load_dwordx4 v[140:143], v1, s[4:7], s34 offen offset:3072
  s_add_u32 s34, s34, 4096
  buffer_load_dwordx4 v[144:147], v1, s[4:7], s34 offen offset:0
  buffer_load_dwordx4 v[148:151], v1, s[4:7], s34 offen offset:1024
  buffer_load_dwordx4 v[152:155], v1, s[4:7], s34 offen offset:2048
  buffer_load_dwordx4 v[156:159], v1, s[4:7], s34 offen offset:3072
  s_add_u32 s34, s34, 4096
  buffer_load_dwordx4 v[160:163], v1, s[4:7], s34 offen offset:0
  buffer_load_dwordx4 v[164:167], v1, s[4:7], s34 offen offset:1024
  buffer_load_dwordx4 v[168:171], v1, s[4:7], s34 offen offset:2048
  buffer_load_dwordx4 v[172:175], v1, s[4:7], s34 offen offset:3072
  s_waitcnt vmcnt(20)
  s_mul_i32 s34, s15, 12
  s_mul_i32 s35, s16, 6
  s_add_u32 s34, s34, s35
  s_add_u32 s34, s34, 3
  s_mul_i32 s34, s34, 20480
  s_add_u32 s34, s34, 22020096
  buffer_load_dwordx4 v[176:179], v1, s[4:7], s34 offen offset:0
  buffer_load_dwordx4 v[180:183], v1, s[4:7], s34 offen offset:1024
  buffer_load_dwordx4 v[184:187], v1, s[4:7], s34 offen offset:2048
  buffer_load_dwordx4 v[188:191], v1, s[4:7], s34 offen offset:3072
  s_add_u32 s34, s34, 4096
  buffer_load_dwordx4 v[192:195], v1, s[4:7], s34 offen offset:0
  buffer_load_dwordx4 v[196:199], v1, s[4:7], s34 offen offset:1024
  buffer_load_dwordx4 v[200:203], v1, s[4:7], s34 offen offset:2048
  buffer_load_dwordx4 v[204:207], v1, s[4:7], s34 offen offset:3072
  s_add_u32 s34, s34, 4096
  buffer_load_dwordx4 v[208:211], v1, s[4:7], s34 offen offset:0
  buffer_load_dwordx4 v[212:215], v1, s[4:7], s34 offen offset:1024
  buffer_load_dwordx4 v[216:219], v1, s[4:7], s34 offen offset:2048
  buffer_load_dwordx4 v[220:223], v1, s[4:7], s34 offen offset:3072
  s_add_u32 s34, s34, 4096
  buffer_load_dwordx4 v[224:227], v1, s[4:7], s34 offen offset:0
  buffer_load_dwordx4 v[228:231], v1, s[4:7], s34 offen offset:1024
  buffer_load_dwordx4 v[232:235], v1, s[4:7], s34 offen offset:2048
  buffer_load_dwordx4 v[236:239], v1, s[4:7], s34 offen offset:3072
  s_add_u32 s34, s34, 4096
  buffer_load_dwordx4 v[240:243], v1, s[4:7], s34 offen offset:0
  buffer_load_dwordx4 v[244:247], v1, s[4:7], s34 offen offset:1024
  buffer_load_dwordx4 v[248:251], v1, s[4:7], s34 offen offset:2048
  buffer_load_dwordx4 v[252:255], v1, s[4:7], s34 offen offset:3072
  s_waitcnt vmcnt(20)
  s_mov_b32 s17, 0
  s_mov_b32 s26, 0
  s_mul_i32 s20, s17, 40960
  s_add_u32 s20, s20, 153626624
  s_add_u32 m0, s26, 10240
  s_nop 0
  buffer_load_dwordx4 v1, s[4:7], s20 offen offset:0 lds
  buffer_load_dwordx4 v1, s[4:7], s20 offen offset:1024 lds
  buffer_load_dwordx4 v1, s[4:7], s20 offen offset:2048 lds
  buffer_load_dwordx4 v1, s[4:7], s20 offen offset:3072 lds
  s_add_u32 s20, s20, 4096
  s_add_u32 m0, s26, 14336
  s_nop 0
  buffer_load_dwordx4 v1, s[4:7], s20 offen offset:0 lds
  buffer_load_dwordx4 v1, s[4:7], s20 offen offset:1024 lds
  buffer_load_dwordx4 v1, s[4:7], s20 offen offset:2048 lds
  buffer_load_dwordx4 v1, s[4:7], s20 offen offset:3072 lds
  s_add_u32 s20, s20, 4096
  s_add_u32 m0, s26, 18432
  s_nop 0
  buffer_load_dwordx4 v1, s[4:7], s20 offen offset:0 lds
  buffer_load_dwordx4 v1, s[4:7], s20 offen offset:1024 lds
reca_ptop94:
  s_cmp_lt_u32 s17, 6
  s_cbranch_scc1 reca_pgo95
  s_sub_u32 s36, s17, 6
reca_ppoll96:
  buffer_load_dword v5, v4, s[4:7], s25 offen sc1
  s_waitcnt vmcnt(0)
  v_readfirstlane_b32 s34, v5
  s_nop 3
  s_cmp_ge_i32 s34, s36
  s_cbranch_scc1 reca_pgo95
  s_sleep 8
  s_sub_u32 s18, s18, 1
  s_cbranch_scc0 reca_ppoll96
  s_mov_b32 s18, 0
reca_pgo95:
  s_waitcnt vmcnt(0)
  s_barrier
  v_add_u32 v7, s26, v1
  s_xor_b32 s26, s26, 40960
  s_add_u32 s37, s17, 1
  s_cmp_ge_u32 s37, 64
  s_cbranch_scc1 reca_pnodma97
  s_mul_i32 s20, s37, 40960
  s_add_u32 s20, s20, 153626624
  s_add_u32 m0, s26, 10240
  s_nop 0
  buffer_load_dwordx4 v1, s[4:7], s20 offen offset:0 lds
  buffer_load_dwordx4 v1, s[4:7], s20 offen offset:1024 lds
  buffer_load_dwordx4 v1, s[4:7], s20 offen offset:2048 lds
  buffer_load_dwordx4 v1, s[4:7], s20 offen offset:3072 lds
  s_add_u32 s20, s20, 4096
  s_add_u32 m0, s26, 14336
  s_nop 0
  buffer_load_dwordx4 v1, s[4:7], s20 offen offset:0 lds
  buffer_load_dwordx4 v1, s[4:7], s20 offen offset:1024 lds
  buffer_load_dwordx4 v1, s[4:7], s20 offen offset:2048 lds
  buffer_load_dwordx4 v1, s[4:7], s20 offen offset:3072 lds
  s_add_u32 s20, s20, 4096
  s_add_u32 m0, s26, 18432
  s_nop 0
  buffer_load_dwordx4 v1, s[4:7], s20 offen offset:0 lds
  buffer_load_dwordx4 v1, s[4:7], s20 offen offset:1024 lds
reca_pnodma97:
  s_lshl_b32 s34, s15, 6
  s_add_u32 s34, s34, s17
  s_mul_i32 s34, s34, 12288
  s_mul_i32 s35, s16, 3072
  s_add_u32 s35, s35, s34
  s_add_u32 s21, s35, 37748736
  s_add_u32 s22, s35, 88080384
  s_mul_i32 s35, s16, 6144
  s_add_u32 s35, s35, s34
  s_add_u32 s23, s35, 62914560
  ds_read_b128 v[48:51], v7 offset:0
  ds_read_b128 v[52:55], v7 offset:20480
  ds_read_b128 v[56:59], v7 offset:1024
  ds_read_b128 v[60:63], v7 offset:21504
  ds_read_b128 v[64:67], v7 offset:2048
  ds_read_b128 v[68:71], v7 offset:22528
  s_waitcnt lgkmcnt(4)
  v_mfma_f32_16x16x32_bf16 v[8:11], a[0:3], v[48:51], 0
  v_mfma_f32_16x16x32_bf16 v[12:15], a[0:3], v[52:55], 0
  v_mfma_f32_16x16x32_bf16 v[16:19], a[80:83], v[48:51], 0
  v_mfma_f32_16x16x32_bf16 v[20:23], a[80:83], v[52:55], 0
  v_mfma_f32_16x16x32_bf16 v[24:27], v[48:51], a[160:163], 0
  v_mfma_f32_16x16x32_bf16 v[28:31], v[52:55], a[160:163], 0
  v_mfma_f32_16x16x32_bf16 v[32:35], v[48:51], v[96:99], 0
  v_mfma_f32_16x16x32_bf16 v[36:39], v[52:55], v[96:99], 0
  v_mfma_f32_16x16x32_bf16 v[40:43], v[48:51], v[176:179], 0
  v_mfma_f32_16x16x32_bf16 v[44:47], v[52:55], v[176:179], 0
  ds_read_b128 v[48:51], v7 offset:3072
  ds_read_b128 v[52:55], v7 offset:23552
  s_waitcnt lgkmcnt(4)
  v_mfma_f32_16x16x32_bf16 v[8:11], a[4:7], v[56:59], v[8:11]
  v_mfma_f32_16x16x32_bf16 v[12:15], a[4:7], v[60:63], v[12:15]
  v_mfma_f32_16x16x32_bf16 v[16:19], a[84:87], v[56:59], v[16:19]
  v_mfma_f32_16x16x32_bf16 v[20:23], a[84:87], v[60:63], v[20:23]
  v_mfma_f32_16x16x32_bf16 v[24:27], v[56:59], a[164:167], v[24:27]
  v_mfma_f32_16x16x32_bf16 v[28:31], v[60:63], a[164:167], v[28:31]
  v_mfma_f32_16x16x32_bf16 v[32:35], v[56:59], v[100:103], v[32:35]
  v_mfma_f32_16x16x32_bf16 v[36:39], v[60:63], v[100:103], v[36:39]
  v_mfma_f32_16x16x32_bf16 v[40:43], v[56:59], v[180:183], v[40:43]
  v_mfma_f32_16x16x32_bf16 v[44:47], v[60:63], v[180:183], v[44:47]
  ds_read_b128 v[56:59], v7 offset:4096
  ds_read_b128 v[60:63], v7 offset:24576
  s_waitcnt lgkmcnt(4)
  v_mfma_f32_16x16x32_bf16 v[8:11], a[8:11], v[64:67], v[8:11]
  v_mfma_f32_16x16x32_bf16 v[12:15], a[8:11], v[68:71], v[12:15]
  v_mfma_f32_16x16x32_bf16 v[16:19], a[88:91], v[64:67], v[16:19]
  v_mfma_f32_16x16x32_bf16 v[20:23], a[88:91], v[68:71], v[20:23]
  v_mfma_f32_16x16x32_bf16 v[24:27], v[64:67], a[168:171], v[24:27]
  v_mfma_f32_16x16x32_bf16 v[28:31], v[68:71], a[168:171], v[28:31]
  v_mfma_f32_16x16x32_bf16 v[32:35], v[64:67], v[104:107], v[32:35]
  v_mfma_f32_16x16x32_bf16 v[36:39], v[68:71], v[104:107], v[36:39]
  v_mfma_f32_16x16x32_bf16 v[40:43], v[64:67], v[184:187], v[40:43]
  v_mfma_f32_16x16x32_bf16 v[44:47], v[68:71], v[184:187], v[44:47]
  ds_read_b128 v[64:67], v7 offset:5120
  ds_read_b128 v[68:71], v7 offset:25600
  s_waitcnt lgkmcnt(4)
  v_mfma_f32_16x16x32_bf16 v[8:11], a[12:15], v[48:51], v[8:11]
  v_mfma_f32_16x16x32_bf16 v[12:15], a[12:15], v[52:55], v[12:15]
  v_mfma_f32_16x16x32_bf16 v[16:19], a[92:95], v[48:51], v[16:19]
  v_mfma_f32_16x16x32_bf16 v[20:23], a[92:95], v[52:55], v[20:23]
  v_mfma_f32_16x16x32_bf16 v[24:27], v[48:51], a[172:175], v[24:27]
  v_mfma_f32_16x16x32_bf16 v[28:31], v[52:55], a[172:175], v[28:31]
  v_mfma_f32_16x16x32_bf16 v[32:35], v[48:51], v[108:111], v[32:35]
  v_mfma_f32_16x16x32_bf16 v[36:39], v[52:55], v[108:111], v[36:39]
  v_mfma_f32_16x16x32_bf16 v[40:43], v[48:51], v[188:191], v[40:43]
  v_mfma_f32_16x16x32_bf16 v[44:47], v[52:55], v[188:191], v[44:47]
  ds_read_b128 v[48:51], v7 offset:6144
  ds_read_b128 v[52:55], v7 offset:26624
  s_waitcnt lgkmcnt(4)
  v_mfma_f32_16x16x32_bf16 v[8:11], a[16:19], v[56:59], v[8:11]
  v_mfma_f32_16x16x32_bf16 v[12:15], a[16:19], v[60:63], v[12:15]
  v_mfma_f32_16x16x32_bf16 v[16:19], a[96:99], v[56:59], v[16:19]
  v_mfma_f32_16x16x32_bf16 v[20:23], a[96:99], v[60:63], v[20:23]
  v_mfma_f32_16x16x32_bf16 v[24:27], v[56:59], a[176:179], v[24:27]
  v_mfma_f32_16x16x32_bf16 v[28:31], v[60:63], a[176:179], v[28:31]
  v_mfma_f32_16x16x32_bf16 v[32:35], v[56:59], v[112:115], v[32:35]
  v_mfma_f32_16x16x32_bf16 v[36:39], v[60:63], v[112:115], v[36:39]
  v_mfma_f32_16x16x32_bf16 v[40:43], v[56:59], v[192:195], v[40:43]
  v_mfma_f32_16x16x32_bf16 v[44:47], v[60:63], v[192:195], v[44:47]
  ds_read_b128 v[56:59], v7 offset:7168
  ds_read_b128 v[60:63], v7 offset:27648
  s_waitcnt lgkmcnt(4)
  v_mfma_f32_16x16x32_bf16 v[8:11], a[20:23], v[64:67], v[8:11]
  v_mfma_f32_16x16x32_bf16 v[12:15], a[20:23], v[68:71], v[12:15]
  v_mfma_f32_16x16x32_bf16 v[16:19], a[100:103], v[64:67], v[16:19]
  v_mfma_f32_16x16x32_bf16 v[20:23], a[100:103], v[68:71], v[20:23]
  v_mfma_f32_16x16x32_bf16 v[24:27], v[64:67], a[180:183], v[24:27]
  v_mfma_f32_16x16x32_bf16 v[28:31], v[68:71], a[180:183], v[28:31]
  v_mfma_f32_16x16x32_bf16 v[32:35], v[64:67], v[116:119], v[32:35]
  v_mfma_f32_16x16x32_bf16 v[36:39], v[68:71], v[116:119], v[36:39]
  v_mfma_f32_16x16x32_bf16 v[40:43], v[64:67], v[196:199], v[40:43]
  v_mfma_f32_16x16x32_bf16 v[44:47], v[68:71], v[196:199], v[44:47]
  ds_read_b128 v[64:67], v7 offset:8192
  ds_read_b128 v[68:71], v7 offset:28672
  s_waitcnt lgkmcnt(4)
  v_mfma_f32_16x16x32_bf16 v[8:11], a[24:27], v[48:51], v[8:11]
  v_mfma_f32_16x16x32_bf16 v[12:15], a[24:27], v[52:55], v[12:15]
  v_mfma_f32_16x16x32_bf16 v[16:19], a[104:107], v[48:51], v[16:19]
  v_mfma_f32_16x16x32_bf16 v[20:23], a[104:107], v[52:55], v[20:23]
  v_mfma_f32_16x16x32_bf16 v[24:27], v[48:51], a[184:187], v[24:27]
  v_mfma_f32_16x16x32_bf16 v[28:31], v[52:55], a[184:187], v[28:31]
  v_mfma_f32_16x16x32_bf16 v[32:35], v[48:51], v[120:123], v[32:35]
  v_mfma_f32_16x16x32_bf16 v[36:39], v[52:55], v[120:123], v[36:39]
  v_mfma_f32_16x16x32_bf16 v[40:43], v[48:51], v[200:203], v[40:43]
  v_mfma_f32_16x16x32_bf16 v[44:47], v[52:55], v[200:203], v[44:47]
  ds_read_b128 v[48:51], v7 offset:9216
  ds_read_b128 v[52:55], v7 offset:29696
  s_waitcnt lgkmcnt(4)
  v_mfma_f32_16x16x32_bf16 v[8:11], a[28:31], v[56:59], v[8:11]
  v_mfma_f32_16x16x32_bf16 v[12:15], a[28:31], v[60:63], v[12:15]
  v_mfma_f32_16x16x32_bf16 v[16:19], a[108:111], v[56:59], v[16:19]
  v_mfma_f32_16x16x32_bf16 v[20:23], a[108:111], v[60:63], v[20:23]
  v_mfma_f32_16x16x32_bf16 v[24:27], v[56:59], a[188:191], v[24:27]
  v_mfma_f32_16x16x32_bf16 v[28:31], v[60:63], a[188:191], v[28:31]
  v_mfma_f32_16x16x32_bf16 v[32:35], v[56:59], v[124:127], v[32:35]
  v_mfma_f32_16x16x32_bf16 v[36:39], v[60:63], v[124:127], v[36:39]
  v_mfma_f32_16x16x32_bf16 v[40:43], v[56:59], v[204:207], v[40:43]
  v_mfma_f32_16x16x32_bf16 v[44:47], v[60:63], v[204:207], v[44:47]
  ds_read_b128 v[56:59], v7 offset:10240
  ds_read_b128 v[60:63], v7 offset:30720
  s_waitcnt lgkmcnt(4)
  v_mfma_f32_16x16x32_bf16 v[8:11], a[32:35], v[64:67], v[8:11]
  v_mfma_f32_16x16x32_bf16 v[12:15], a[32:35], v[68:71], v[12:15]
  v_mfma_f32_16x16x32_bf16 v[16:19], a[112:115], v[64:67], v[16:19]
  v_mfma_f32_16x16x32_bf16 v[20:23], a[112:115], v[68:71], v[20:23]
  v_mfma_f32_16x16x32_bf16 v[24:27], v[64:67], a[192:195], v[24:27]
  v_mfma_f32_16x16x32_bf16 v[28:31], v[68:71], a[192:195], v[28:31]
  v_mfma_f32_16x16x32_bf16 v[32:35], v[64:67], v[128:131], v[32:35]
  v_mfma_f32_16x16x32_bf16 v[36:39], v[68:71], v[128:131], v[36:39]
  v_mfma_f32_16x16x32_bf16 v[40:43], v[64:67], v[208:211], v[40:43]
  v_mfma_f32_16x16x32_bf16 v[44:47], v[68:71], v[208:211], v[44:47]
  ds_read_b128 v[64:67], v7 offset:11264
  ds_read_b128 v[68:71], v7 offset:31744
  s_waitcnt lgkmcnt(4)
  v_mfma_f32_16x16x32_bf16 v[8:11], a[36:39], v[48:51], v[8:11]
  v_mfma_f32_16x16x32_bf16 v[12:15], a[36:39], v[52:55], v[12:15]
  v_mfma_f32_16x16x32_bf16 v[16:19], a[116:119], v[48:51], v[16:19]
  v_mfma_f32_16x16x32_bf16 v[20:23], a[116:119], v[52:55], v[20:23]
  v_mfma_f32_16x16x32_bf16 v[24:27], v[48:51], a[196:199], v[24:27]
  v_mfma_f32_16x16x32_bf16 v[28:31], v[52:55], a[196:199], v[28:31]
  v_mfma_f32_16x16x32_bf16 v[32:35], v[48:51], v[132:135], v[32:35]
  v_mfma_f32_16x16x32_bf16 v[36:39], v[52:55], v[132:135], v[36:39]
  v_mfma_f32_16x16x32_bf16 v[40:43], v[48:51], v[212:215], v[40:43]
  v_mfma_f32_16x16x32_bf16 v[44:47], v[52:55], v[212:215], v[44:47]
  ds_read_b128 v[48:51], v7 offset:12288
  ds_read_b128 v[52:55], v7 offset:32768
  s_waitcnt lgkmcnt(4)
  v_mfma_f32_16x16x32_bf16 v[8:11], a[40:43], v[56:59], v[8:11]
  v_mfma_f32_16x16x32_bf16 v[12:15], a[40:43], v[60:63], v[12:15]
  v_mfma_f32_16x16x32_bf16 v[16:19], a[120:123], v[56:59], v[16:19]
  v_mfma_f32_16x16x32_bf16 v[20:23], a[120:123], v[60:63], v[20:23]
  v_mfma_f32_16x16x32_bf16 v[24:27], v[56:59], a[200:203], v[24:27]
  v_mfma_f32_16x16x32_bf16 v[28:31], v[60:63], a[200:203], v[28:31]
  v_mfma_f32_16x16x32_bf16 v[32:35], v[56:59], v[136:139], v[32:35]
  v_mfma_f32_16x16x32_bf16 v[36:39], v[60:63], v[136:139], v[36:39]
  v_mfma_f32_16x16x32_bf16 v[40:43], v[56:59], v[216:219], v[40:43]
  v_mfma_f32_16x16x32_bf16 v[44:47], v[60:63], v[216:219], v[44:47]
  ds_read_b128 v[56:59], v7 offset:13312
  ds_read_b128 v[60:63], v7 offset:33792
  s_waitcnt lgkmcnt(4)
  v_mfma_f32_16x16x32_bf16 v[8:11], a[44:47], v[64:67], v[8:11]
  v_mfma_f32_16x16x32_bf16 v[12:15], a[44:47], v[68:71], v[12:15]
  v_mfma_f32_16x16x32_bf16 v[16:19], a[124:127], v[64:67], v[16:19]
  v_mfma_f32_16x16x32_bf16 v[20:23], a[124:127], v[68:71], v[20:23]
  v_mfma_f32_16x16x32_bf16 v[24:27], v[64:67], a[204:207], v[24:27]
  v_mfma_f32_16x16x32_bf16 v[28:31], v[68:71], a[204:207], v[28:31]
  v_mfma_f32_16x16x32_bf16 v[32:35], v[64:67], v[140:143], v[32:35]
  v_mfma_f32_16x16x32_bf16 v[36:39], v[68:71], v[140:143], v[36:39]
  v_mfma_f32_16x16x32_bf16 v[40:43], v[64:67], v[220:223], v[40:43]
  v_mfma_f32_16x16x32_bf16 v[44:47], v[68:71], v[220:223], v[44:47]
  ds_read_b128 v[64:67], v7 offset:14336
  ds_read_b128 v[68:71], v7 offset:34816
  s_waitcnt lgkmcnt(4)
  v_mfma_f32_16x16x32_bf16 v[8:11], a[48:51], v[48:51], v[8:11]
  v_mfma_f32_16x16x32_bf16 v[12:15], a[48:51], v[52:55], v[12:15]
  v_mfma_f32_16x16x32_bf16 v[16:19], a[128:131], v[48:51], v[16:19]
  v_mfma_f32_16x16x32_bf16 v[20:23], a[128:131], v[52:55], v[20:23]
  v_mfma_f32_16x16x32_bf16 v[24:27], v[48:51], a[208:211], v[24:27]
  v_mfma_f32_16x16x32_bf16 v[28:31], v[52:55], a[208:211], v[28:31]
  v_mfma_f32_16x16x32_bf16 v[32:35], v[48:51], v[144:147], v[32:35]
  v_mfma_f32_16x16x32_bf16 v[36:39], v[52:55], v[144:147], v[36:39]
  v_mfma_f32_16x16x32_bf16 v[40:43], v[48:51], v[224:227], v[40:43]
  v_mfma_f32_16x16x32_bf16 v[44:47], v[52:55], v[224:227], v[44:47]
  ds_read_b128 v[48:51], v7 offset:15360
  ds_read_b128 v[52:55], v7 offset:35840
  s_waitcnt lgkmcnt(4)
  v_mfma_f32_16x16x32_bf16 v[8:11], a[52:55], v[56:59], v[8:11]
  v_mfma_f32_16x16x32_bf16 v[12:15], a[52:55], v[60:63], v[12:15]
  v_mfma_f32_16x16x32_bf16 v[16:19], a[132:135], v[56:59], v[16:19]
  v_mfma_f32_16x16x32_bf16 v[20:23], a[132:135], v[60:63], v[20:23]
  v_mfma_f32_16x16x32_bf16 v[24:27], v[56:59], a[212:215], v[24:27]
  v_mfma_f32_16x16x32_bf16 v[28:31], v[60:63], a[212:215], v[28:31]
  v_mfma_f32_16x16x32_bf16 v[32:35], v[56:59], v[148:151], v[32:35]
  v_mfma_f32_16x16x32_bf16 v[36:39], v[60:63], v[148:151], v[36:39]
  v_mfma_f32_16x16x32_bf16 v[40:43], v[56:59], v[228:231], v[40:43]
  v_mfma_f32_16x16x32_bf16 v[44:47], v[60:63], v[228:231], v[44:47]
  ds_read_b128 v[56:59], v7 offset:16384
  ds_read_b128 v[60:63], v7 offset:36864
  s_waitcnt lgkmcnt(4)
  v_mfma_f32_16x16x32_bf16 v[8:11], a[56:59], v[64:67], v[8:11]
  v_mfma_f32_16x16x32_bf16 v[12:15], a[56:59], v[68:71], v[12:15]
  v_mfma_f32_16x16x32_bf16 v[16:19], a[136:139], v[64:67], v[16:19]
  v_mfma_f32_16x16x32_bf16 v[20:23], a[136:139], v[68:71], v[20:23]
  v_mfma_f32_16x16x32_bf16 v[24:27], v[64:67], a[216:219], v[24:27]
  v_mfma_f32_16x16x32_bf16 v[28:31], v[68:71], a[216:219], v[28:31]
  v_mfma_f32_16x16x32_bf16 v[32:35], v[64:67], v[152:155], v[32:35]
  v_mfma_f32_16x16x32_bf16 v[36:39], v[68:71], v[152:155], v[36:39]
  v_mfma_f32_16x16x32_bf16 v[40:43], v[64:67], v[232:235], v[40:43]
  v_mfma_f32_16x16x32_bf16 v[44:47], v[68:71], v[232:235], v[44:47]
  ds_read_b128 v[64:67], v7 offset:17408
  ds_read_b128 v[68:71], v7 offset:37888
  s_waitcnt lgkmcnt(4)
  v_mfma_f32_16x16x32_bf16 v[8:11], a[60:63], v[48:51], v[8:11]
  v_mfma_f32_16x16x32_bf16 v[12:15], a[60:63], v[52:55], v[12:15]
  v_mfma_f32_16x16x32_bf16 v[16:19], a[140:143], v[48:51], v[16:19]
  v_mfma_f32_16x16x32_bf16 v[20:23], a[140:143], v[52:55], v[20:23]
  v_mfma_f32_16x16x32_bf16 v[24:27], v[48:51], a[220:223], v[24:27]
  v_mfma_f32_16x16x32_bf16 v[28:31], v[52:55], a[220:223], v[28:31]
  v_mfma_f32_16x16x32_bf16 v[32:35], v[48:51], v[156:159], v[32:35]
  v_mfma_f32_16x16x32_bf16 v[36:39], v[52:55], v[156:159], v[36:39]
  v_mfma_f32_16x16x32_bf16 v[40:43], v[48:51], v[236:239], v[40:43]
  v_mfma_f32_16x16x32_bf16 v[44:47], v[52:55], v[236:239], v[44:47]
  ds_read_b128 v[48:51], v7 offset:18432
  ds_read_b128 v[52:55], v7 offset:38912
  s_waitcnt lgkmcnt(4)
  v_mfma_f32_16x16x32_bf16 v[8:11], a[64:67], v[56:59], v[8:11]
  v_mfma_f32_16x16x32_bf16 v[12:15], a[64:67], v[60:63], v[12:15]
  v_mfma_f32_16x16x32_bf16 v[16:19], a[144:147], v[56:59], v[16:19]
  v_mfma_f32_16x16x32_bf16 v[20:23], a[144:147], v[60:63], v[20:23]
  v_mfma_f32_16x16x32_bf16 v[24:27], v[56:59], a[224:227], v[24:27]
  v_mfma_f32_16x16x32_bf16 v[28:31], v[60:63], a[224:227], v[28:31]
  v_mfma_f32_16x16x32_bf16 v[32:35], v[56:59], v[160:163], v[32:35]
  v_mfma_f32_16x16x32_bf16 v[36:39], v[60:63], v[160:163], v[36:39]
  v_mfma_f32_16x16x32_bf16 v[40:43], v[56:59], v[240:243], v[40:43]
  v_mfma_f32_16x16x32_bf16 v[44:47], v[60:63], v[240:243], v[44:47]
  ds_read_b128 v[56:59], v7 offset:19456
  ds_read_b128 v[60:63], v7 offset:39936
  s_waitcnt lgkmcnt(4)
  v_mfma_f32_16x16x32_bf16 v[8:11], a[68:71], v[64:67], v[8:11]
  v_mfma_f32_16x16x32_bf16 v[12:15], a[68:71], v[68:71], v[12:15]
  v_mfma_f32_16x16x32_bf16 v[16:19], a[148:151], v[64:67], v[16:19]
  v_mfma_f32_16x16x32_bf16 v[20:23], a[148:151], v[68:71], v[20:23]
  v_mfma_f32_16x16x32_bf16 v[24:27], v[64:67], a[228:231], v[24:27]
  v_mfma_f32_16x16x32_bf16 v[28:31], v[68:71], a[228:231], v[28:31]
  v_mfma_f32_16x16x32_bf16 v[32:35], v[64:67], v[164:167], v[32:35]
  v_mfma_f32_16x16x32_bf16 v[36:39], v[68:71], v[164:167], v[36:39]
  v_mfma_f32_16x16x32_bf16 v[40:43], v[64:67], v[244:247], v[40:43]
  v_mfma_f32_16x16x32_bf16 v[44:47], v[68:71], v[244:247], v[44:47]
  s_waitcnt lgkmcnt(2)
  v_mfma_f32_16x16x32_bf16 v[8:11], a[72:75], v[48:51], v[8:11]
  v_mfma_f32_16x16x32_bf16 v[12:15], a[72:75], v[52:55], v[12:15]
  v_mfma_f32_16x16x32_bf16 v[16:19], a[152:155], v[48:51], v[16:19]
  v_mfma_f32_16x16x32_bf16 v[20:23], a[152:155], v[52:55], v[20:23]
  v_mfma_f32_16x16x32_bf16 v[24:27], v[48:51], a[232:235], v[24:27]
  v_mfma_f32_16x16x32_bf16 v[28:31], v[52:55], a[232:235], v[28:31]
  v_mfma_f32_16x16x32_bf16 v[32:35], v[48:51], v[168:171], v[32:35]
  v_mfma_f32_16x16x32_bf16 v[36:39], v[52:55], v[168:171], v[36:39]
  v_mfma_f32_16x16x32_bf16 v[40:43], v[48:51], v[248:251], v[40:43]
  v_mfma_f32_16x16x32_bf16 v[44:47], v[52:55], v[248:251], v[44:47]
  s_waitcnt lgkmcnt(0)
  v_mfma_f32_16x16x32_bf16 v[8:11], a[76:79], v[56:59], v[8:11]
  v_mfma_f32_16x16x32_bf16 v[12:15], a[76:79], v[60:63], v[12:15]
  v_mfma_f32_16x16x32_bf16 v[16:19], a[156:159], v[56:59], v[16:19]
  v_mfma_f32_16x16x32_bf16 v[20:23], a[156:159], v[60:63], v[20:23]
  v_mfma_f32_16x16x32_bf16 v[24:27], v[56:59], a[236:239], v[24:27]
  v_mfma_f32_16x16x32_bf16 v[28:31], v[60:63], a[236:239], v[28:31]
  v_mfma_f32_16x16x32_bf16 v[32:35], v[56:59], v[172:175], v[32:35]
  v_mfma_f32_16x16x32_bf16 v[36:39], v[60:63], v[172:175], v[36:39]
  v_mfma_f32_16x16x32_bf16 v[40:43], v[56:59], v[252:255], v[40:43]
  v_mfma_f32_16x16x32_bf16 v[44:47], v[60:63], v[252:255], v[44:47]
  v_cvt_pk_bf16_f32 v72, v8, v9
  v_cvt_pk_bf16_f32 v73, v10, v11
  v_cvt_pk_bf16_f32 v74, v16, v17
  v_cvt_pk_bf16_f32 v75, v18, v19
  s_add_u32 s34, s21, 2048
  buffer_store_dwordx4 v[72:75], v1, s[4:7], s34 offen
  v_cvt_pk_bf16_f32 v76, v12, v13
  v_cvt_pk_bf16_f32 v77, v14, v15
  v_cvt_pk_bf16_f32 v78, v20, v21
  v_cvt_pk_bf16_f32 v79, v22, v23
  s_add_u32 s34, s21, 8192
  buffer_store_dwordx4 v[76:79], v1, s[4:7], s34 offen
  v_cvt_pk_bf16_f32 v72, v24, v25
  v_cvt_pk_bf16_f32 v73, v26, v27
  v_cvt_pk_bf16_f32 v74, v28, v29
  v_cvt_pk_bf16_f32 v75, v30, v31
  s_add_u32 s34, s23, 1024
  buffer_store_dwordx4 v[72:75], v1, s[4:7], s34 offen
  v_cvt_pk_bf16_f32 v76, v32, v33
  v_cvt_pk_bf16_f32 v77, v34, v35
  v_cvt_pk_bf16_f32 v78, v36, v37
  v_cvt_pk_bf16_f32 v79, v38, v39
  s_add_u32 s34, s23, 2048
  buffer_store_dwordx4 v[76:79], v1, s[4:7], s34 offen
  v_cvt_pk_bf16_f32 v72, v40, v41
  v_cvt_pk_bf16_f32 v73, v42, v43
  v_cvt_pk_bf16_f32 v74, v44, v45
  v_cvt_pk_bf16_f32 v75, v46, v47
  s_add_u32 s34, s23, 3072
  buffer_store_dwordx4 v[72:75], v1, s[4:7], s34 offen
  s_waitcnt vmcnt(0)
  s_barrier
  s_add_u32 s17, s17, 1
  s_cmp_lt_u32 s17, 64
  s_cbranch_scc1 reca_ptop94
  s_branch reca_exit1
reca_pw2_88:
  s_mul_i32 s34, s15, 12
  s_mul_i32 s35, s16, 6
  s_add_u32 s34, s34, s35
  s_add_u32 s34, s34, 0
  s_mul_i32 s34, s34, 20480
  s_add_u32 s34, s34, 6291456
  buffer_load_dwordx4 a[0:3], v1, s[4:7], s34 offen offset:0
  buffer_load_dwordx4 a[4:7], v1, s[4:7], s34 offen offset:1024
  buffer_load_dwordx4 a[8:11], v1, s[4:7], s34 offen offset:2048
  buffer_load_dwordx4 a[12:15], v1, s[4:7], s34 offen offset:3072
  s_add_u32 s34, s34, 4096
  buffer_load_dwordx4 a[16:19], v1, s[4:7], s34 offen offset:0
  buffer_load_dwordx4 a[20:23], v1, s[4:7], s34 offen offset:1024
  buffer_load_dwordx4 a[24:27], v1, s[4:7], s34 offen offset:2048
  buffer_load_dwordx4 a[28:31], v1, s[4:7], s34 offen offset:3072
  s_add_u32 s34, s34, 4096
  buffer_load_dwordx4 a[32:35], v1, s[4:7], s34 offen offset:0
  buffer_load_dwordx4 a[36:39], v1, s[4:7], s34 offen offset:1024
  buffer_load_dwordx4 a[40:43], v1, s[4:7], s34 offen offset:2048
  buffer_load_dwordx4 a[44:47], v1, s[4:7], s34 offen offset:3072
  s_add_u32 s34, s34, 4096
  buffer_load_dwordx4 a[48:51], v1, s[4:7], s34 offen offset:0
  buffer_load_dwordx4 a[52:55], v1, s[4:7], s34 offen offset:1024
  buffer_load_dwordx4 a[56:59], v1, s[4:7], s34 offen offset:2048
  buffer_load_dwordx4 a[60:63], v1, s[4:7], s34 offen offset:3072
  s_add_u32 s34, s34, 4096
  buffer_load_dwordx4 a[64:67], v1, s[4:7], s34 offen offset:0
  buffer_load_dwordx4 a[68:71], v1, s[4:7], s34 offen offset:1024
  buffer_load_dwordx4 a[72:75], v1, s[4:7], s34 offen offset:2048
  buffer_load_dwordx4 a[76:79], v1, s[4:7], s34 offen offset:3072
  s_mul_i32 s34, s15, 12
  s_mul_i32 s35, s16, 6
  s_add_u32 s34, s34, s35
  s_add_u32 s34, s34, 1
  s_mul_i32 s34, s34, 20480
  s_add_u32 s34, s34, 6291456
  buffer_load_dwordx4 a[80:83], v1, s[4:7], s34 offen offset:0
  buffer_load_dwordx4 a[84:87], v1, s[4:7], s34 offen offset:1024
  buffer_load_dwordx4 a[88:91], v1, s[4:7], s34 offen offset:2048
  buffer_load_dwordx4 a[92:95], v1, s[4:7], s34 offen offset:3072
  s_add_u32 s34, s34, 4096
  buffer_load_dwordx4 a[96:99], v1, s[4:7], s34 offen offset:0
  buffer_load_dwordx4 a[100:103], v1, s[4:7], s34 offen offset:1024
  buffer_load_dwordx4 a[104:107], v1, s[4:7], s34 offen offset:2048
  buffer_load_dwordx4 a[108:111], v1, s[4:7], s34 offen offset:3072
  s_add_u32 s34, s34, 4096
  buffer_load_dwordx4 a[112:115], v1, s[4:7], s34 offen offset:0
  buffer_load_dwordx4 a[116:119], v1, s[4:7], s34 offen offset:1024
  buffer_load_dwordx4 a[120:123], v1, s[4:7], s34 offen offset:2048
  buffer_load_dwordx4 a[124:127], v1, s[4:7], s34 offen offset:3072
  s_add_u32 s34, s34, 4096
  buffer_load_dwordx4 a[128:131], v1, s[4:7], s34 offen offset:0
  buffer_load_dwordx4 a[132:135], v1, s[4:7], s34 offen offset:1024
  buffer_load_dwordx4 a[136:139], v1, s[4:7], s34 offen offset:2048
  buffer_load_dwordx4 a[140:143], v1, s[4:7], s34 offen offset:3072
  s_add_u32 s34, s34, 4096
  buffer_load_dwordx4 a[144:147], v1, s[4:7], s34 offen offset:0
  buffer_load_dwordx4 a[148:151], v1, s[4:7], s34 offen offset:1024
  buffer_load_dwordx4 a[152:155], v1, s[4:7], s34 offen offset:2048
  buffer_load_dwordx4 a[156:159], v1, s[4:7], s34 offen offset:3072
  s_waitcnt vmcnt(20)
  s_mul_i32 s34, s15, 12
  s_mul_i32 s35, s16, 6
  s_add_u32 s34, s34, s35
  s_add_u32 s34, s34, 4
  s_mul_i32 s34, s34, 20480
  s_add_u32 s34, s34, 22020096
  buffer_load_dwordx4 a[160:163], v1, s[4:7], s34 offen offset:0
  buffer_load_dwordx4 a[164:167], v1, s[4:7], s34 offen offset:1024
  buffer_load_dwordx4 a[168:171], v1, s[4:7], s34 offen offset:2048
  buffer_load_dwordx4 a[172:175], v1, s[4:7], s34 offen offset:3072
  s_add_u32 s34, s34, 4096
  buffer_load_dwordx4 a[176:179], v1, s[4:7], s34 offen offset:0
  buffer_load_dwordx4 a[180:183], v1, s[4:7], s34 offen offset:1024
  buffer_load_dwordx4 a[184:187], v1, s[4:7], s34 offen offset:2048
  buffer_load_dwordx4 a[188:191], v1, s[4:7], s34 offen offset:3072
  s_add_u32 s34, s34, 4096
  buffer_load_dwordx4 a[192:195], v1, s[4:7], s34 offen offset:0
  buffer_load_dwordx4 a[196:199], v1, s[4:7], s34 offen offset:1024
  buffer_load_dwordx4 a[200:203], v1, s[4:7], s34 offen offset:2048
  buffer_load_dwordx4 a[204:207], v1, s[4:7], s34 offen offset:3072
  s_add_u32 s34, s34, 4096
  buffer_load_dwordx4 a[208:211], v1, s[4:7], s34 offen offset:0
  buffer_load_dwordx4 a[212:215], v1, s[4:7], s34 offen offset:1024
  buffer_load_dwordx4 a[216:219], v1, s[4:7], s34 offen offset:2048
  buffer_load_dwordx4 a[220:223], v1, s[4:7], s34 offen offset:3072
  s_add_u32 s34, s34, 4096
  buffer_load_dwordx4 a[224:227], v1, s[4:7], s34 offen offset:0
  buffer_load_dwordx4 a[228:231], v1, s[4:7], s34 offen offset:1024
  buffer_load_dwordx4 a[232:235], v1, s[4:7], s34 offen offset:2048
  buffer_load_dwordx4 a[236:239], v1, s[4:7], s34 offen offset:3072
  s_waitcnt vmcnt(20)
  s_mul_i32 s34, s15, 12
  s_mul_i32 s35, s16, 6
  s_add_u32 s34, s34, s35
  s_add_u32 s34, s34, 5
  s_mul_i32 s34, s34, 20480
  s_add_u32 s34, s34, 22020096
  buffer_load_dwordx4 v[96:99], v1, s[4:7], s34 offen offset:0
  buffer_load_dwordx4 v[100:103], v1, s[4:7], s34 offen offset:1024
  buffer_load_dwordx4 v[104:107], v1, s[4:7], s34 offen offset:2048
  buffer_load_dwordx4 v[108:111], v1, s[4:7], s34 offen offset:3072
  s_add_u32 s34, s34, 4096
  buffer_load_dwordx4 v[112:115], v1, s[4:7], s34 offen offset:0
  buffer_load_dwordx4 v[116:119], v1, s[4:7], s34 offen offset:1024
  buffer_load_dwordx4 v[120:123], v1, s[4:7], s34 offen offset:2048
  buffer_load_dwordx4 v[124:127], v1, s[4:7], s34 offen offset:3072
  s_add_u32 s34, s34, 4096
  buffer_load_dwordx4 v[128:131], v1, s[4:7], s34 offen offset:0
  buffer_load_dwordx4 v[132:135], v1, s[4:7], s34 offen offset:1024
  buffer_load_dwordx4 v[136:139], v1, s[4:7], s34 offen offset:2048
  buffer_load_dwordx4 v[140:143], v1, s[4:7], s34 offen offset:3072
  s_add_u32 s34, s34, 4096
  buffer_load_dwordx4 v[144:147], v1, s[4:7], s34 offen offset:0
  buffer_load_dwordx4 v[148:151], v1, s[4:7], s34 offen offset:1024
  buffer_load_dwordx4 v[152:155], v1, s[4:7], s34 offen offset:2048
  buffer_load_dwordx4 v[156:159], v1, s[4:7], s34 offen offset:3072
  s_add_u32 s34, s34, 4096
  buffer_load_dwordx4 v[160:163], v1, s[4:7], s34 offen offset:0
  buffer_load_dwordx4 v[164:167], v1, s[4:7], s34 offen offset:1024
  buffer_load_dwordx4 v[168:171], v1, s[4:7], s34 offen offset:2048
  buffer_load_dwordx4 v[172:175], v1, s[4:7], s34 offen offset:3072
  s_waitcnt vmcnt(20)
  s_mov_b32 s17, 0
  s_mov_b32 s26, 0
  s_mul_i32 s20, s17, 40960
  s_add_u32 s20, s20, 153636864
  s_add_u32 m0, s26, 20480
  s_nop 0
  buffer_load_dwordx4 v1, s[4:7], s20 offen offset:0 lds
  buffer_load_dwordx4 v1, s[4:7], s20 offen offset:1024 lds
  buffer_load_dwordx4 v1, s[4:7], s20 offen offset:2048 lds
  buffer_load_dwordx4 v1, s[4:7], s20 offen offset:3072 lds
  s_add_u32 s20, s20, 4096
  s_add_u32 m0, s26, 24576
  s_nop 0
  buffer_load_dwordx4 v1, s[4:7], s20 offen offset:0 lds
  buffer_load_dwordx4 v1, s[4:7], s20 offen offset:1024 lds
  buffer_load_dwordx4 v1, s[4:7], s20 offen offset:2048 lds
  buffer_load_dwordx4 v1, s[4:7], s20 offen offset:3072 lds
  s_add_u32 s20, s20, 4096
  s_add_u32 m0, s26, 28672
  s_nop 0
  buffer_load_dwordx4 v1, s[4:7], s20 offen offset:0 lds
  buffer_load_dwordx4 v1, s[4:7], s20 offen offset:1024 lds
reca_ptop98:
  s_cmp_lt_u32 s17, 6
  s_cbranch_scc1 reca_pgo99
  s_sub_u32 s36, s17, 6
reca_ppoll100:
  buffer_load_dword v5, v4, s[4:7], s25 offen sc1
  s_waitcnt vmcnt(0)
  v_readfirstlane_b32 s34, v5
  s_nop 3
  s_cmp_ge_i32 s34, s36
  s_cbranch_scc1 reca_pgo99
  s_sleep 8
  s_sub_u32 s18, s18, 1
  s_cbranch_scc0 reca_ppoll100
  s_mov_b32 s18, 0
reca_pgo99:
  s_waitcnt vmcnt(0)
  s_barrier
  v_add_u32 v7, s26, v1
  s_xor_b32 s26, s26, 40960
  s_add_u32 s37, s17, 1
  s_cmp_ge_u32 s37, 64
  s_cbranch_scc1 reca_pnodma101
  s_mul_i32 s20, s37, 40960
  s_add_u32 s20, s20, 153636864
  s_add_u32 m0, s26, 20480
  s_nop 0
  buffer_load_dwordx4 v1, s[4:7], s20 offen offset:0 lds
  buffer_load_dwordx4 v1, s[4:7], s20 offen offset:1024 lds
  buffer_load_dwordx4 v1, s[4:7], s20 offen offset:2048 lds
  buffer_load_dwordx4 v1, s[4:7], s20 offen offset:3072 lds
  s_add_u32 s20, s20, 4096
  s_add_u32 m0, s26, 24576
  s_nop 0
  buffer_load_dwordx4 v1, s[4:7], s20 offen offset:0 lds
  buffer_load_dwordx4 v1, s[4:7], s20 offen offset:1024 lds
  buffer_load_dwordx4 v1, s[4:7], s20 offen offset:2048 lds
  buffer_load_dwordx4 v1, s[4:7], s20 offen offset:3072 lds
  s_add_u32 s20, s20, 4096
  s_add_u32 m0, s26, 28672
  s_nop 0
  buffer_load_dwordx4 v1, s[4:7], s20 offen offset:0 lds
  buffer_load_dwordx4 v1, s[4:7], s20 offen offset:1024 lds
reca_pnodma101:
  s_lshl_b32 s34, s15, 6
  s_add_u32 s34, s34, s17
  s_mul_i32 s34, s34, 12288
  s_mul_i32 s35, s16, 3072
  s_add_u32 s35, s35, s34
  s_add_u32 s21, s35, 37748736
  s_add_u32 s22, s35, 88080384
  s_mul_i32 s35, s16, 6144
  s_add_u32 s35, s35, s34
  s_add_u32 s23, s35, 62914560
  ds_read_b128 v[48:51], v7 offset:0
  ds_read_b128 v[52:55], v7 offset:20480
  ds_read_b128 v[56:59], v7 offset:1024
  ds_read_b128 v[60:63], v7 offset:21504
  ds_read_b128 v[64:67], v7 offset:2048
  ds_read_b128 v[68:71], v7 offset:22528
  s_waitcnt lgkmcnt(4)
  v_mfma_f32_16x16x32_bf16 v[8:11], a[0:3], v[48:51], 0
  v_mfma_f32_16x16x32_bf16 v[12:15], a[0:3], v[52:55], 0
  v_mfma_f32_16x16x32_bf16 v[16:19], a[80:83], v[48:51], 0
  v_mfma_f32_16x16x32_bf16 v[20:23], a[80:83], v[52:55], 0
  v_mfma_f32_16x16x32_bf16 v[24:27], v[48:51], a[160:163], 0
  v_mfma_f32_16x16x32_bf16 v[28:31], v[52:55], a[160:163], 0
  v_mfma_f32_16x16x32_bf16 v[32:35], v[48:51], v[96:99], 0
  v_mfma_f32_16x16x32_bf16 v[36:39], v[52:55], v[96:99], 0
  ds_read_b128 v[48:51], v7 offset:3072
  ds_read_b128 v[52:55], v7 offset:23552
  s_waitcnt lgkmcnt(4)
  v_mfma_f32_16x16x32_bf16 v[8:11], a[4:7], v[56:59], v[8:11]
  v_mfma_f32_16x16x32_bf16 v[12:15], a[4:7], v[60:63], v[12:15]
  v_mfma_f32_16x16x32_bf16 v[16:19], a[84:87], v[56:59], v[16:19]
  v_mfma_f32_16x16x32_bf16 v[20:23], a[84:87], v[60:63], v[20:23]
  v_mfma_f32_16x16x32_bf16 v[24:27], v[56:59], a[164:167], v[24:27]
  v_mfma_f32_16x16x32_bf16 v[28:31], v[60:63], a[164:167], v[28:31]
  v_mfma_f32_16x16x32_bf16 v[32:35], v[56:59], v[100:103], v[32:35]
  v_mfma_f32_16x16x32_bf16 v[36:39], v[60:63], v[100:103], v[36:39]
  ds_read_b128 v[56:59], v7 offset:4096
  ds_read_b128 v[60:63], v7 offset:24576
  s_waitcnt lgkmcnt(4)
  v_mfma_f32_16x16x32_bf16 v[8:11], a[8:11], v[64:67], v[8:11]
  v_mfma_f32_16x16x32_bf16 v[12:15], a[8:11], v[68:71], v[12:15]
  v_mfma_f32_16x16x32_bf16 v[16:19], a[88:91], v[64:67], v[16:19]
  v_mfma_f32_16x16x32_bf16 v[20:23], a[88:91], v[68:71], v[20:23]
  v_mfma_f32_16x16x32_bf16 v[24:27], v[64:67], a[168:171], v[24:27]
  v_mfma_f32_16x16x32_bf16 v[28:31], v[68:71], a[168:171], v[28:31]
  v_mfma_f32_16x16x32_bf16 v[32:35], v[64:67], v[104:107], v[32:35]
  v_mfma_f32_16x16x32_bf16 v[36:39], v[68:71], v[104:107], v[36:39]
  ds_read_b128 v[64:67], v7 offset:5120
  ds_read_b128 v[68:71], v7 offset:25600
  s_waitcnt lgkmcnt(4)
  v_mfma_f32_16x16x32_bf16 v[8:11], a[12:15], v[48:51], v[8:11]
  v_mfma_f32_16x16x32_bf16 v[12:15], a[12:15], v[52:55], v[12:15]
  v_mfma_f32_16x16x32_bf16 v[16:19], a[92:95], v[48:51], v[16:19]
  v_mfma_f32_16x16x32_bf16 v[20:23], a[92:95], v[52:55], v[20:23]
  v_mfma_f32_16x16x32_bf16 v[24:27], v[48:51], a[172:175], v[24:27]
  v_mfma_f32_16x16x32_bf16 v[28:31], v[52:55], a[172:175], v[28:31]
  v_mfma_f32_16x16x32_bf16 v[32:35], v[48:51], v[108:111], v[32:35]
  v_mfma_f32_16x16x32_bf16 v[36:39], v[52:55], v[108:111], v[36:39]
  ds_read_b128 v[48:51], v7 offset:6144
  ds_read_b128 v[52:55], v7 offset:26624
  s_waitcnt lgkmcnt(4)
  v_mfma_f32_16x16x32_bf16 v[8:11], a[16:19], v[56:59], v[8:11]
  v_mfma_f32_16x16x32_bf16 v[12:15], a[16:19], v[60:63], v[12:15]
  v_mfma_f32_16x16x32_bf16 v[16:19], a[96:99], v[56:59], v[16:19]
  v_mfma_f32_16x16x32_bf16 v[20:23], a[96:99], v[60:63], v[20:23]
  v_mfma_f32_16x16x32_bf16 v[24:27], v[56:59], a[176:179], v[24:27]
  v_mfma_f32_16x16x32_bf16 v[28:31], v[60:63], a[176:179], v[28:31]
  v_mfma_f32_16x16x32_bf16 v[32:35], v[56:59], v[112:115], v[32:35]
  v_mfma_f32_16x16x32_bf16 v[36:39], v[60:63], v[112:115], v[36:39]
  ds_read_b128 v[56:59], v7 offset:7168
  ds_read_b128 v[60:63], v7 offset:27648
  s_waitcnt lgkmcnt(4)
  v_mfma_f32_16x16x32_bf16 v[8:11], a[20:23], v[64:67], v[8:11]
  v_mfma_f32_16x16x32_bf16 v[12:15], a[20:23], v[68:71], v[12:15]
  v_mfma_f32_16x16x32_bf16 v[16:19], a[100:103], v[64:67], v[16:19]
  v_mfma_f32_16x16x32_bf16 v[20:23], a[100:103], v[68:71], v[20:23]
  v_mfma_f32_16x16x32_bf16 v[24:27], v[64:67], a[180:183], v[24:27]
  v_mfma_f32_16x16x32_bf16 v[28:31], v[68:71], a[180:183], v[28:31]
  v_mfma_f32_16x16x32_bf16 v[32:35], v[64:67], v[116:119], v[32:35]
  v_mfma_f32_16x16x32_bf16 v[36:39], v[68:71], v[116:119], v[36:39]
  ds_read_b128 v[64:67], v7 offset:8192
  ds_read_b128 v[68:71], v7 offset:28672
  s_waitcnt lgkmcnt(4)
  v_mfma_f32_16x16x32_bf16 v[8:11], a[24:27], v[48:51], v[8:11]
  v_mfma_f32_16x16x32_bf16 v[12:15], a[24:27], v[52:55], v[12:15]
  v_mfma_f32_16x16x32_bf16 v[16:19], a[104:107], v[48:51], v[16:19]
  v_mfma_f32_16x16x32_bf16 v[20:23], a[104:107], v[52:55], v[20:23]
  v_mfma_f32_16x16x32_bf16 v[24:27], v[48:51], a[184:187], v[24:27]
  v_mfma_f32_16x16x32_bf16 v[28:31], v[52:55], a[184:187], v[28:31]
  v_mfma_f32_16x16x32_bf16 v[32:35], v[48:51], v[120:123], v[32:35]
  v_mfma_f32_16x16x32_bf16 v[36:39], v[52:55], v[120:123], v[36:39]
  ds_read_b128 v[48:51], v7 offset:9216
  ds_read_b128 v[52:55], v7 offset:29696
  s_waitcnt lgkmcnt(4)
  v_mfma_f32_16x16x32_bf16 v[8:11], a[28:31], v[56:59], v[8:11]
  v_mfma_f32_16x16x32_bf16 v[12:15], a[28:31], v[60:63], v[12:15]
  v_mfma_f32_16x16x32_bf16 v[16:19], a[108:111], v[56:59], v[16:19]
  v_mfma_f32_16x16x32_bf16 v[20:23], a[108:111], v[60:63], v[20:23]
  v_mfma_f32_16x16x32_bf16 v[24:27], v[56:59], a[188:191], v[24:27]
  v_mfma_f32_16x16x32_bf16 v[28:31], v[60:63], a[188:191], v[28:31]
  v_mfma_f32_16x16x32_bf16 v[32:35], v[56:59], v[124:127], v[32:35]
  v_mfma_f32_16x16x32_bf16 v[36:39], v[60:63], v[124:127], v[36:39]
  ds_read_b128 v[56:59], v7 offset:10240
  ds_read_b128 v[60:63], v7 offset:30720
  s_waitcnt lgkmcnt(4)
  v_mfma_f32_16x16x32_bf16 v[8:11], a[32:35], v[64:67], v[8:11]
  v_mfma_f32_16x16x32_bf16 v[12:15], a[32:35], v[68:71], v[12:15]
  v_mfma_f32_16x16x32_bf16 v[16:19], a[112:115], v[64:67], v[16:19]
  v_mfma_f32_16x16x32_bf16 v[20:23], a[112:115], v[68:71], v[20:23]
  v_mfma_f32_16x16x32_bf16 v[24:27], v[64:67], a[192:195], v[24:27]
  v_mfma_f32_16x16x32_bf16 v[28:31], v[68:71], a[192:195], v[28:31]
  v_mfma_f32_16x16x32_bf16 v[32:35], v[64:67], v[128:131], v[32:35]
  v_mfma_f32_16x16x32_bf16 v[36:39], v[68:71], v[128:131], v[36:39]
  ds_read_b128 v[64:67], v7 offset:11264
  ds_read_b128 v[68:71], v7 offset:31744
  s_waitcnt lgkmcnt(4)
  v_mfma_f32_16x16x32_bf16 v[8:11], a[36:39], v[48:51], v[8:11]
  v_mfma_f32_16x16x32_bf16 v[12:15], a[36:39], v[52:55], v[12:15]
  v_mfma_f32_16x16x32_bf16 v[16:19], a[116:119], v[48:51], v[16:19]
  v_mfma_f32_16x16x32_bf16 v[20:23], a[116:119], v[52:55], v[20:23]
  v_mfma_f32_16x16x32_bf16 v[24:27], v[48:51], a[196:199], v[24:27]
  v_mfma_f32_16x16x32_bf16 v[28:31], v[52:55], a[196:199], v[28:31]
  v_mfma_f32_16x16x32_bf16 v[32:35], v[48:51], v[132:135], v[32:35]
  v_mfma_f32_16x16x32_bf16 v[36:39], v[52:55], v[132:135], v[36:39]
  ds_read_b128 v[48:51], v7 offset:12288
  ds_read_b128 v[52:55], v7 offset:32768
  s_waitcnt lgkmcnt(4)
  v_mfma_f32_16x16x32_bf16 v[8:11], a[40:43], v[56:59], v[8:11]
  v_mfma_f32_16x16x32_bf16 v[12:15], a[40:43], v[60:63], v[12:15]
  v_mfma_f32_16x16x32_bf16 v[16:19], a[120:123], v[56:59], v[16:19]
  v_mfma_f32_16x16x32_bf16 v[20:23], a[120:123], v[60:63], v[20:23]
  v_mfma_f32_16x16x32_bf16 v[24:27], v[56:59], a[200:203], v[24:27]
  v_mfma_f32_16x16x32_bf16 v[28:31], v[60:63], a[200:203], v[28:31]
  v_mfma_f32_16x16x32_bf16 v[32:35], v[56:59], v[136:139], v[32:35]
  v_mfma_f32_16x16x32_bf16 v[36:39], v[60:63], v[136:139], v[36:39]
  ds_read_b128 v[56:59], v7 offset:13312
  ds_read_b128 v[60:63], v7 offset:33792
  s_waitcnt lgkmcnt(4)
  v_mfma_f32_16x16x32_bf16 v[8:11], a[44:47], v[64:67], v[8:11]
  v_mfma_f32_16x16x32_bf16 v[12:15], a[44:47], v[68:71], v[12:15]
  v_mfma_f32_16x16x32_bf16 v[16:19], a[124:127], v[64:67], v[16:19]
  v_mfma_f32_16x16x32_bf16 v[20:23], a[124:127], v[68:71], v[20:23]
  v_mfma_f32_16x16x32_bf16 v[24:27], v[64:67], a[204:207], v[24:27]
  v_mfma_f32_16x16x32_bf16 v[28:31], v[68:71], a[204:207], v[28:31]
  v_mfma_f32_16x16x32_bf16 v[32:35], v[64:67], v[140:143], v[32:35]
  v_mfma_f32_16x16x32_bf16 v[36:39], v[68:71], v[140:143], v[36:39]
  ds_read_b128 v[64:67], v7 offset:14336
  ds_read_b128 v[68:71], v7 offset:34816
  s_waitcnt lgkmcnt(4)
  v_mfma_f32_16x16x32_bf16 v[8:11], a[48:51], v[48:51], v[8:11]
  v_mfma_f32_16x16x32_bf16 v[12:15], a[48:51], v[52:55], v[12:15]
  v_mfma_f32_16x16x32_bf16 v[16:19], a[128:131], v[48:51], v[16:19]
  v_mfma_f32_16x16x32_bf16 v[20:23], a[128:131], v[52:55], v[20:23]
  v_mfma_f32_16x16x32_bf16 v[24:27], v[48:51], a[208:211], v[24:27]
  v_mfma_f32_16x16x32_bf16 v[28:31], v[52:55], a[208:211], v[28:31]
  v_mfma_f32_16x16x32_bf16 v[32:35], v[48:51], v[144:147], v[32:35]
  v_mfma_f32_16x16x32_bf16 v[36:39], v[52:55], v[144:147], v[36:39]
  ds_read_b128 v[48:51], v7 offset:15360
  ds_read_b128 v[52:55], v7 offset:35840
  s_waitcnt lgkmcnt(4)
  v_mfma_f32_16x16x32_bf16 v[8:11], a[52:55], v[56:59], v[8:11]
  v_mfma_f32_16x16x32_bf16 v[12:15], a[52:55], v[60:63], v[12:15]
  v_mfma_f32_16x16x32_bf16 v[16:19], a[132:135], v[56:59], v[16:19]
  v_mfma_f32_16x16x32_bf16 v[20:23], a[132:135], v[60:63], v[20:23]
  v_mfma_f32_16x16x32_bf16 v[24:27], v[56:59], a[212:215], v[24:27]
  v_mfma_f32_16x16x32_bf16 v[28:31], v[60:63], a[212:215], v[28:31]
  v_mfma_f32_16x16x32_bf16 v[32:35], v[56:59], v[148:151], v[32:35]
  v_mfma_f32_16x16x32_bf16 v[36:39], v[60:63], v[148:151], v[36:39]
  ds_read_b128 v[56:59], v7 offset:16384
  ds_read_b128 v[60:63], v7 offset:36864
  s_waitcnt lgkmcnt(4)
  v_mfma_f32_16x16x32_bf16 v[8:11], a[56:59], v[64:67], v[8:11]
  v_mfma_f32_16x16x32_bf16 v[12:15], a[56:59], v[68:71], v[12:15]
  v_mfma_f32_16x16x32_bf16 v[16:19], a[136:139], v[64:67], v[16:19]
  v_mfma_f32_16x16x32_bf16 v[20:23], a[136:139], v[68:71], v[20:23]
  v_mfma_f32_16x16x32_bf16 v[24:27], v[64:67], a[216:219], v[24:27]
  v_mfma_f32_16x16x32_bf16 v[28:31], v[68:71], a[216:219], v[28:31]
  v_mfma_f32_16x16x32_bf16 v[32:35], v[64:67], v[152:155], v[32:35]
  v_mfma_f32_16x16x32_bf16 v[36:39], v[68:71], v[152:155], v[36:39]
  ds_read_b128 v[64:67], v7 offset:17408
  ds_read_b128 v[68:71], v7 offset:37888
  s_waitcnt lgkmcnt(4)
  v_mfma_f32_16x16x32_bf16 v[8:11], a[60:63], v[48:51], v[8:11]
  v_mfma_f32_16x16x32_bf16 v[12:15], a[60:63], v[52:55], v[12:15]
  v_mfma_f32_16x16x32_bf16 v[16:19], a[140:143], v[48:51], v[16:19]
  v_mfma_f32_16x16x32_bf16 v[20:23], a[140:143], v[52:55], v[20:23]
  v_mfma_f32_16x16x32_bf16 v[24:27], v[48:51], a[220:223], v[24:27]
  v_mfma_f32_16x16x32_bf16 v[28:31], v[52:55], a[220:223], v[28:31]
  v_mfma_f32_16x16x32_bf16 v[32:35], v[48:51], v[156:159], v[32:35]
  v_mfma_f32_16x16x32_bf16 v[36:39], v[52:55], v[156:159], v[36:39]
  ds_read_b128 v[48:51], v7 offset:18432
  ds_read_b128 v[52:55], v7 offset:38912
  s_waitcnt lgkmcnt(4)
  v_mfma_f32_16x16x32_bf16 v[8:11], a[64:67], v[56:59], v[8:11]
  v_mfma_f32_16x16x32_bf16 v[12:15], a[64:67], v[60:63], v[12:15]
  v_mfma_f32_16x16x32_bf16 v[16:19], a[144:147], v[56:59], v[16:19]
  v_mfma_f32_16x16x32_bf16 v[20:23], a[144:147], v[60:63], v[20:23]
  v_mfma_f32_16x16x32_bf16 v[24:27], v[56:59], a[224:227], v[24:27]
  v_mfma_f32_16x16x32_bf16 v[28:31], v[60:63], a[224:227], v[28:31]
  v_mfma_f32_16x16x32_bf16 v[32:35], v[56:59], v[160:163], v[32:35]
  v_mfma_f32_16x16x32_bf16 v[36:39], v[60:63], v[160:163], v[36:39]
  ds_read_b128 v[56:59], v7 offset:19456
  ds_read_b128 v[60:63], v7 offset:39936
  s_waitcnt lgkmcnt(4)
  v_mfma_f32_16x16x32_bf16 v[8:11], a[68:71], v[64:67], v[8:11]
  v_mfma_f32_16x16x32_bf16 v[12:15], a[68:71], v[68:71], v[12:15]
  v_mfma_f32_16x16x32_bf16 v[16:19], a[148:151], v[64:67], v[16:19]
  v_mfma_f32_16x16x32_bf16 v[20:23], a[148:151], v[68:71], v[20:23]
  v_mfma_f32_16x16x32_bf16 v[24:27], v[64:67], a[228:231], v[24:27]
  v_mfma_f32_16x16x32_bf16 v[28:31], v[68:71], a[228:231], v[28:31]
  v_mfma_f32_16x16x32_bf16 v[32:35], v[64:67], v[164:167], v[32:35]
  v_mfma_f32_16x16x32_bf16 v[36:39], v[68:71], v[164:167], v[36:39]
  s_waitcnt lgkmcnt(2)
  v_mfma_f32_16x16x32_bf16 v[8:11], a[72:75], v[48:51], v[8:11]
  v_mfma_f32_16x16x32_bf16 v[12:15], a[72:75], v[52:55], v[12:15]
  v_mfma_f32_16x16x32_bf16 v[16:19], a[152:155], v[48:51], v[16:19]
  v_mfma_f32_16x16x32_bf16 v[20:23], a[152:155], v[52:55], v[20:23]
  v_mfma_f32_16x16x32_bf16 v[24:27], v[48:51], a[232:235], v[24:27]
  v_mfma_f32_16x16x32_bf16 v[28:31], v[52:55], a[232:235], v[28:31]
  v_mfma_f32_16x16x32_bf16 v[32:35], v[48:51], v[168:171], v[32:35]
  v_mfma_f32_16x16x32_bf16 v[36:39], v[52:55], v[168:171], v[36:39]
  s_waitcnt lgkmcnt(0)
  v_mfma_f32_16x16x32_bf16 v[8:11], a[76:79], v[56:59], v[8:11]
  v_mfma_f32_16x16x32_bf16 v[12:15], a[76:79], v[60:63], v[12:15]
  v_mfma_f32_16x16x32_bf16 v[16:19], a[156:159], v[56:59], v[16:19]
  v_mfma_f32_16x16x32_bf16 v[20:23], a[156:159], v[60:63], v[20:23]
  v_mfma_f32_16x16x32_bf16 v[24:27], v[56:59], a[236:239], v[24:27]
  v_mfma_f32_16x16x32_bf16 v[28:31], v[60:63], a[236:239], v[28:31]
  v_mfma_f32_16x16x32_bf16 v[32:35], v[56:59], v[172:175], v[32:35]
  v_mfma_f32_16x16x32_bf16 v[36:39], v[60:63], v[172:175], v[36:39]
  s_nop 0
  v_cvt_pk_bf16_f32 v72, v8, v9
  v_cvt_pk_bf16_f32 v73, v10, v11
  v_cvt_pk_bf16_f32 v74, v16, v17
  v_cvt_pk_bf16_f32 v75, v18, v19
  s_add_u32 s34, s22, 0
  buffer_store_dwordx4 v[72:75], v1, s[4:7], s34 offen
  v_cvt_pk_bf16_f32 v76, v12, v13
  v_cvt_pk_bf16_f32 v77, v14, v15
  v_cvt_pk_bf16_f32 v78, v20, v21
  v_cvt_pk_bf16_f32 v79, v22, v23
  s_add_u32 s34, s22, 6144
  buffer_store_dwordx4 v[76:79], v1, s[4:7], s34 offen
  v_cvt_pk_bf16_f32 v72, v24, v25
  v_cvt_pk_bf16_f32 v73, v26, v27
  v_cvt_pk_bf16_f32 v74, v28, v29
  v_cvt_pk_bf16_f32 v75, v30, v31
  s_add_u32 s34, s23, 4096
  buffer_store_dwordx4 v[72:75], v1, s[4:7], s34 offen
  v_cvt_pk_bf16_f32 v76, v32, v33
  v_cvt_pk_bf16_f32 v77, v34, v35
  v_cvt_pk_bf16_f32 v78, v36, v37
  v_cvt_pk_bf16_f32 v79, v38, v39
  s_add_u32 s34, s23, 5120
  buffer_store_dwordx4 v[76:79], v1, s[4:7], s34 offen
  s_waitcnt vmcnt(0)
  s_barrier
  s_add_u32 s17, s17, 1
  s_cmp_lt_u32 s17, 64
  s_cbranch_scc1 reca_ptop98
  s_branch reca_exit1
reca_pw3_89:
  s_mul_i32 s34, s15, 12
  s_mul_i32 s35, s16, 6
  s_add_u32 s34, s34, s35
  s_add_u32 s34, s34, 2
  s_mul_i32 s34, s34, 20480
  s_add_u32 s34, s34, 6291456
  buffer_load_dwordx4 a[0:3], v1, s[4:7], s34 offen offset:0
  buffer_load_dwordx4 a[4:7], v1, s[4:7], s34 offen offset:1024
  buffer_load_dwordx4 a[8:11], v1, s[4:7], s34 offen offset:2048
  buffer_load_dwordx4 a[12:15], v1, s[4:7], s34 offen offset:3072
  s_add_u32 s34, s34, 4096
  buffer_load_dwordx4 a[16:19], v1, s[4:7], s34 offen offset:0
  buffer_load_dwordx4 a[20:23], v1, s[4:7], s34 offen offset:1024
  buffer_load_dwordx4 a[24:27], v1, s[4:7], s34 offen offset:2048
  buffer_load_dwordx4 a[28:31], v1, s[4:7], s34 offen offset:3072
  s_add_u32 s34, s34, 4096
  buffer_load_dwordx4 a[32:35], v1, s[4:7], s34 offen offset:0
  buffer_load_dwordx4 a[36:39], v1, s[4:7], s34 offen offset:1024
  buffer_load_dwordx4 a[40:43], v1, s[4:7], s34 offen offset:2048
  buffer_load_dwordx4 a[44:47], v1, s[4:7], s34 offen offset:3072
  s_add_u32 s34, s34, 4096
  buffer_load_dwordx4 a[48:51], v1, s[4:7], s34 offen offset:0
  buffer_load_dwordx4 a[52:55], v1, s[4:7], s34 offen offset:1024
  buffer_load_dwordx4 a[56:59], v1, s[4:7], s34 offen offset:2048
  buffer_load_dwordx4 a[60:63], v1, s[4:7], s34 offen offset:3072
  s_add_u32 s34, s34, 4096
  buffer_load_dwordx4 a[64:67], v1, s[4:7], s34 offen offset:0
  buffer_load_dwordx4 a[68:71], v1, s[4:7], s34 offen offset:1024
  buffer_load_dwordx4 a[72:75], v1, s[4:7], s34 offen offset:2048
  buffer_load_dwordx4 a[76:79], v1, s[4:7], s34 offen offset:3072
  s_mul_i32 s34, s15, 12
  s_mul_i32 s35, s16, 6
  s_add_u32 s34, s34, s35
  s_add_u32 s34, s34, 3
  s_mul_i32 s34, s34, 20480
  s_add_u32 s34, s34, 6291456
  buffer_load_dwordx4 a[80:83], v1, s[4:7], s34 offen offset:0
  buffer_load_dwordx4 a[84:87], v1, s[4:7], s34 offen offset:1024
  buffer_load_dwordx4 a[88:91], v1, s[4:7], s34 offen offset:2048
  buffer_load_dwordx4 a[92:95], v1, s[4:7], s34 offen offset:3072
  s_add_u32 s34, s34, 4096
  buffer_load_dwordx4 a[96:99], v1, s[4:7], s34 offen offset:0
  buffer_load_dwordx4 a[100:103], v1, s[4:7], s34 offen offset:1024
  buffer_load_dwordx4 a[104:107], v1, s[4:7], s34 offen offset:2048
  buffer_load_dwordx4 a[108:111], v1, s[4:7], s34 offen offset:3072
  s_add_u32 s34, s34, 4096
  buffer_load_dwordx4 a[112:115], v1, s[4:7], s34 offen offset:0
  buffer_load_dwordx4 a[116:119], v1, s[4:7], s34 offen offset:1024
  buffer_load_dwordx4 a[120:123], v1, s[4:7], s34 offen offset:2048
  buffer_load_dwordx4 a[124:127], v1, s[4:7], s34 offen offset:3072
  s_add_u32 s34, s34, 4096
  buffer_load_dwordx4 a[128:131], v1, s[4:7], s34 offen offset:0
  buffer_load_dwordx4 a[132:135], v1, s[4:7], s34 offen offset:1024
  buffer_load_dwordx4 a[136:139], v1, s[4:7], s34 offen offset:2048
  buffer_load_dwordx4 a[140:143], v1, s[4:7], s34 offen offset:3072
  s_add_u32 s34, s34, 4096
  buffer_load_dwordx4 a[144:147], v1, s[4:7], s34 offen offset:0
  buffer_load_dwordx4 a[148:151], v1, s[4:7], s34 offen offset:1024
  buffer_load_dwordx4 a[152:155], v1, s[4:7], s34 offen offset:2048
  buffer_load_dwordx4 a[156:159], v1, s[4:7], s34 offen offset:3072
  s_waitcnt vmcnt(20)
  s_mul_i32 s34, s15, 12
  s_mul_i32 s35, s16, 6
  s_add_u32 s34, s34, s35
  s_add_u32 s34, s34, 4
  s_mul_i32 s34, s34, 20480
  s_add_u32 s34, s34, 6291456
  buffer_load_dwordx4 a[160:163], v1, s[4:7], s34 offen offset:0
  buffer_load_dwordx4 a[164:167], v1, s[4:7], s34 offen offset:1024
  buffer_load_dwordx4 a[168:171], v1, s[4:7], s34 offen offset:2048
  buffer_load_dwordx4 a[172:175], v1, s[4:7], s34 offen offset:3072
  s_add_u32 s34, s34, 4096
  buffer_load_dwordx4 a[176:179], v1, s[4:7], s34 offen offset:0
  buffer_load_dwordx4 a[180:183], v1, s[4:7], s34 offen offset:1024
  buffer_load_dwordx4 a[184:187], v1, s[4:7], s34 offen offset:2048
  buffer_load_dwordx4 a[188:191], v1, s[4:7], s34 offen offset:3072
  s_add_u32 s34, s34, 4096
  buffer_load_dwordx4 a[192:195], v1, s[4:7], s34 offen offset:0
  buffer_load_dwordx4 a[196:199], v1, s[4:7], s34 offen offset:1024
  buffer_load_dwordx4 a[200:203], v1, s[4:7], s34 offen offset:2048
  buffer_load_dwordx4 a[204:207], v1, s[4:7], s34 offen offset:3072
  s_add_u32 s34, s34, 4096
  buffer_load_dwordx4 a[208:211], v1, s[4:7], s34 offen offset:0
  buffer_load_dwordx4 a[212:215], v1, s[4:7], s34 offen offset:1024
  buffer_load_dwordx4 a[216:219], v1, s[4:7], s34 offen offset:2048
  buffer_load_dwordx4 a[220:223], v1, s[4:7], s34 offen offset:3072
  s_add_u32 s34, s34, 4096
  buffer_load_dwordx4 a[224:227], v1, s[4:7], s34 offen offset:0
  buffer_load_dwordx4 a[228:231], v1, s[4:7], s34 offen offset:1024
  buffer_load_dwordx4 a[232:235], v1, s[4:7], s34 offen offset:2048
  buffer_load_dwordx4 a[236:239], v1, s[4:7], s34 offen offset:3072
  s_waitcnt vmcnt(20)
  s_mul_i32 s34, s15, 12
  s_mul_i32 s35, s16, 6
  s_add_u32 s34, s34, s35
  s_add_u32 s34, s34, 5
  s_mul_i32 s34, s34, 20480
  s_add_u32 s34, s34, 6291456
  buffer_load_dwordx4 v[96:99], v1, s[4:7], s34 offen offset:0
  buffer_load_dwordx4 v[100:103], v1, s[4:7], s34 offen offset:1024
  buffer_load_dwordx4 v[104:107], v1, s[4:7], s34 offen offset:2048
  buffer_load_dwordx4 v[108:111], v1, s[4:7], s34 offen offset:3072
  s_add_u32 s34, s34, 4096
  buffer_load_dwordx4 v[112:115], v1, s[4:7], s34 offen offset:0
  buffer_load_dwordx4 v[116:119], v1, s[4:7], s34 offen offset:1024
  buffer_load_dwordx4 v[120:123], v1, s[4:7], s34 offen offset:2048
  buffer_load_dwordx4 v[124:127], v1, s[4:7], s34 offen offset:3072
  s_add_u32 s34, s34, 4096
  buffer_load_dwordx4 v[128:131], v1, s[4:7], s34 offen offset:0
  buffer_load_dwordx4 v[132:135], v1, s[4:7], s34 offen offset:1024
  buffer_load_dwordx4 v[136:139], v1, s[4:7], s34 offen offset:2048
  buffer_load_dwordx4 v[140:143], v1, s[4:7], s34 offen offset:3072
  s_add_u32 s34, s34, 4096
  buffer_load_dwordx4 v[144:147], v1, s[4:7], s34 offen offset:0
  buffer_load_dwordx4 v[148:151], v1, s[4:7], s34 offen offset:1024
  buffer_load_dwordx4 v[152:155], v1, s[4:7], s34 offen offset:2048
  buffer_load_dwordx4 v[156:159], v1, s[4:7], s34 offen offset:3072
  s_add_u32 s34, s34, 4096
  buffer_load_dwordx4 v[160:163], v1, s[4:7], s34 offen offset:0
  buffer_load_dwordx4 v[164:167], v1, s[4:7], s34 offen offset:1024
  buffer_load_dwordx4 v[168:171], v1, s[4:7], s34 offen offset:2048
  buffer_load_dwordx4 v[172:175], v1, s[4:7], s34 offen offset:3072
  s_waitcnt vmcnt(20)
  s_mov_b32 s17, 0
  s_mov_b32 s26, 0
  s_mul_i32 s20, s17, 40960
  s_add_u32 s20, s20, 153647104
  s_add_u32 m0, s26, 30720
  s_nop 0
  buffer_load_dwordx4 v1, s[4:7], s20 offen offset:0 lds
  buffer_load_dwordx4 v1, s[4:7], s20 offen offset:1024 lds
  buffer_load_dwordx4 v1, s[4:7], s20 offen offset:2048 lds
  buffer_load_dwordx4 v1, s[4:7], s20 offen offset:3072 lds
  s_add_u32 s20, s20, 4096
  s_add_u32 m0, s26, 34816
  s_nop 0
  buffer_load_dwordx4 v1, s[4:7], s20 offen offset:0 lds
  buffer_load_dwordx4 v1, s[4:7], s20 offen offset:1024 lds
  buffer_load_dwordx4 v1, s[4:7], s20 offen offset:2048 lds
  buffer_load_dwordx4 v1, s[4:7], s20 offen offset:3072 lds
  s_add_u32 s20, s20, 4096
  s_add_u32 m0, s26, 38912
  s_nop 0
  buffer_load_dwordx4 v1, s[4:7], s20 offen offset:0 lds
  buffer_load_dwordx4 v1, s[4:7], s20 offen offset:1024 lds
reca_ptop102:
  s_cmp_lt_u32 s17, 6
  s_cbranch_scc1 reca_pgo103
  s_sub_u32 s36, s17, 6
reca_ppoll104:
  buffer_load_dword v5, v4, s[4:7], s25 offen sc1
  s_waitcnt vmcnt(0)
  v_readfirstlane_b32 s34, v5
  s_nop 3
  s_cmp_ge_i32 s34, s36
  s_cbranch_scc1 reca_pgo103
  s_sleep 8
  s_sub_u32 s18, s18, 1
  s_cbranch_scc0 reca_ppoll104
  s_mov_b32 s18, 0
reca_pgo103:
  s_waitcnt vmcnt(0)
  s_barrier
  v_add_u32 v7, s26, v1
  s_xor_b32 s26, s26, 40960
  s_add_u32 s37, s17, 1
  s_cmp_ge_u32 s37, 64
  s_cbranch_scc1 reca_pnodma105
  s_mul_i32 s20, s37, 40960
  s_add_u32 s20, s20, 153647104
  s_add_u32 m0, s26, 30720
  s_nop 0
  buffer_load_dwordx4 v1, s[4:7], s20 offen offset:0 lds
  buffer_load_dwordx4 v1, s[4:7], s20 offen offset:1024 lds
  buffer_load_dwordx4 v1, s[4:7], s20 offen offset:2048 lds
  buffer_load_dwordx4 v1, s[4:7], s20 offen offset:3072 lds
  s_add_u32 s20, s20, 4096
  s_add_u32 m0, s26, 34816
  s_nop 0
  buffer_load_dwordx4 v1, s[4:7], s20 offen offset:0 lds
  buffer_load_dwordx4 v1, s[4:7], s20 offen offset:1024 lds
  buffer_load_dwordx4 v1, s[4:7], s20 offen offset:2048 lds
  buffer_load_dwordx4 v1, s[4:7], s20 offen offset:3072 lds
  s_add_u32 s20, s20, 4096
  s_add_u32 m0, s26, 38912
  s_nop 0
  buffer_load_dwordx4 v1, s[4:7], s20 offen offset:0 lds
  buffer_load_dwordx4 v1, s[4:7], s20 offen offset:1024 lds
reca_pnodma105:
  s_lshl_b32 s34, s15, 6
  s_add_u32 s34, s34, s17
  s_mul_i32 s34, s34, 12288
  s_mul_i32 s35, s16, 3072
  s_add_u32 s35, s35, s34
  s_add_u32 s21, s35, 37748736
  s_add_u32 s22, s35, 88080384
  s_mul_i32 s35, s16, 6144
  s_add_u32 s35, s35, s34
  s_add_u32 s23, s35, 62914560
  ds_read_b128 v[48:51], v7 offset:0
  ds_read_b128 v[52:55], v7 offset:20480
  ds_read_b128 v[56:59], v7 offset:1024
  ds_read_b128 v[60:63], v7 offset:21504
  ds_read_b128 v[64:67], v7 offset:2048
  ds_read_b128 v[68:71], v7 offset:22528
  s_waitcnt lgkmcnt(4)
  v_mfma_f32_16x16x32_bf16 v[8:11], a[0:3], v[48:51], 0
  v_mfma_f32_16x16x32_bf16 v[12:15], a[0:3], v[52:55], 0
  v_mfma_f32_16x16x32_bf16 v[16:19], a[80:83], v[48:51], 0
  v_mfma_f32_16x16x32_bf16 v[20:23], a[80:83], v[52:55], 0
  v_mfma_f32_16x16x32_bf16 v[24:27], a[160:163], v[48:51], 0
  v_mfma_f32_16x16x32_bf16 v[28:31], a[160:163], v[52:55], 0
  v_mfma_f32_16x16x32_bf16 v[32:35], v[96:99], v[48:51], 0
  v_mfma_f32_16x16x32_bf16 v[36:39], v[96:99], v[52:55], 0
  ds_read_b128 v[48:51], v7 offset:3072
  ds_read_b128 v[52:55], v7 offset:23552
  s_waitcnt lgkmcnt(4)
  v_mfma_f32_16x16x32_bf16 v[8:11], a[4:7], v[56:59], v[8:11]
  v_mfma_f32_16x16x32_bf16 v[12:15], a[4:7], v[60:63], v[12:15]
  v_mfma_f32_16x16x32_bf16 v[16:19], a[84:87], v[56:59], v[16:19]
  v_mfma_f32_16x16x32_bf16 v[20:23], a[84:87], v[60:63], v[20:23]
  v_mfma_f32_16x16x32_bf16 v[24:27], a[164:167], v[56:59], v[24:27]
  v_mfma_f32_16x16x32_bf16 v[28:31], a[164:167], v[60:63], v[28:31]
  v_mfma_f32_16x16x32_bf16 v[32:35], v[100:103], v[56:59], v[32:35]
  v_mfma_f32_16x16x32_bf16 v[36:39], v[100:103], v[60:63], v[36:39]
  ds_read_b128 v[56:59], v7 offset:4096
  ds_read_b128 v[60:63], v7 offset:24576
  s_waitcnt lgkmcnt(4)
  v_mfma_f32_16x16x32_bf16 v[8:11], a[8:11], v[64:67], v[8:11]
  v_mfma_f32_16x16x32_bf16 v[12:15], a[8:11], v[68:71], v[12:15]
  v_mfma_f32_16x16x32_bf16 v[16:19], a[88:91], v[64:67], v[16:19]
  v_mfma_f32_16x16x32_bf16 v[20:23], a[88:91], v[68:71], v[20:23]
  v_mfma_f32_16x16x32_bf16 v[24:27], a[168:171], v[64:67], v[24:27]
  v_mfma_f32_16x16x32_bf16 v[28:31], a[168:171], v[68:71], v[28:31]
  v_mfma_f32_16x16x32_bf16 v[32:35], v[104:107], v[64:67], v[32:35]
  v_mfma_f32_16x16x32_bf16 v[36:39], v[104:107], v[68:71], v[36:39]
  ds_read_b128 v[64:67], v7 offset:5120
  ds_read_b128 v[68:71], v7 offset:25600
  s_waitcnt lgkmcnt(4)
  v_mfma_f32_16x16x32_bf16 v[8:11], a[12:15], v[48:51], v[8:11]
  v_mfma_f32_16x16x32_bf16 v[12:15], a[12:15], v[52:55], v[12:15]
  v_mfma_f32_16x16x32_bf16 v[16:19], a[92:95], v[48:51], v[16:19]
  v_mfma_f32_16x16x32_bf16 v[20:23], a[92:95], v[52:55], v[20:23]
  v_mfma_f32_16x16x32_bf16 v[24:27], a[172:175], v[48:51], v[24:27]
  v_mfma_f32_16x16x32_bf16 v[28:31], a[172:175], v[52:55], v[28:31]
  v_mfma_f32_16x16x32_bf16 v[32:35], v[108:111], v[48:51], v[32:35]
  v_mfma_f32_16x16x32_bf16 v[36:39], v[108:111], v[52:55], v[36:39]
  ds_read_b128 v[48:51], v7 offset:6144
  ds_read_b128 v[52:55], v7 offset:26624
  s_waitcnt lgkmcnt(4)
  v_mfma_f32_16x16x32_bf16 v[8:11], a[16:19], v[56:59], v[8:11]
  v_mfma_f32_16x16x32_bf16 v[12:15], a[16:19], v[60:63], v[12:15]
  v_mfma_f32_16x16x32_bf16 v[16:19], a[96:99], v[56:59], v[16:19]
  v_mfma_f32_16x16x32_bf16 v[20:23], a[96:99], v[60:63], v[20:23]
  v_mfma_f32_16x16x32_bf16 v[24:27], a[176:179], v[56:59], v[24:27]
  v_mfma_f32_16x16x32_bf16 v[28:31], a[176:179], v[60:63], v[28:31]
  v_mfma_f32_16x16x32_bf16 v[32:35], v[112:115], v[56:59], v[32:35]
  v_mfma_f32_16x16x32_bf16 v[36:39], v[112:115], v[60:63], v[36:39]
  ds_read_b128 v[56:59], v7 offset:7168
  ds_read_b128 v[60:63], v7 offset:27648
  s_waitcnt lgkmcnt(4)
  v_mfma_f32_16x16x32_bf16 v[8:11], a[20:23], v[64:67], v[8:11]
  v_mfma_f32_16x16x32_bf16 v[12:15], a[20:23], v[68:71], v[12:15]
  v_mfma_f32_16x16x32_bf16 v[16:19], a[100:103], v[64:67], v[16:19]
  v_mfma_f32_16x16x32_bf16 v[20:23], a[100:103], v[68:71], v[20:23]
  v_mfma_f32_16x16x32_bf16 v[24:27], a[180:183], v[64:67], v[24:27]
  v_mfma_f32_16x16x32_bf16 v[28:31], a[180:183], v[68:71], v[28:31]
  v_mfma_f32_16x16x32_bf16 v[32:35], v[116:119], v[64:67], v[32:35]
  v_mfma_f32_16x16x32_bf16 v[36:39], v[116:119], v[68:71], v[36:39]
  ds_read_b128 v[64:67], v7 offset:8192
  ds_read_b128 v[68:71], v7 offset:28672
  s_waitcnt lgkmcnt(4)
  v_mfma_f32_16x16x32_bf16 v[8:11], a[24:27], v[48:51], v[8:11]
  v_mfma_f32_16x16x32_bf16 v[12:15], a[24:27], v[52:55], v[12:15]
  v_mfma_f32_16x16x32_bf16 v[16:19], a[104:107], v[48:51], v[16:19]
  v_mfma_f32_16x16x32_bf16 v[20:23], a[104:107], v[52:55], v[20:23]
  v_mfma_f32_16x16x32_bf16 v[24:27], a[184:187], v[48:51], v[24:27]
  v_mfma_f32_16x16x32_bf16 v[28:31], a[184:187], v[52:55], v[28:31]
  v_mfma_f32_16x16x32_bf16 v[32:35], v[120:123], v[48:51], v[32:35]
  v_mfma_f32_16x16x32_bf16 v[36:39], v[120:123], v[52:55], v[36:39]
  ds_read_b128 v[48:51], v7 offset:9216
  ds_read_b128 v[52:55], v7 offset:29696
  s_waitcnt lgkmcnt(4)
  v_mfma_f32_16x16x32_bf16 v[8:11], a[28:31], v[56:59], v[8:11]
  v_mfma_f32_16x16x32_bf16 v[12:15], a[28:31], v[60:63], v[12:15]
  v_mfma_f32_16x16x32_bf16 v[16:19], a[108:111], v[56:59], v[16:19]
  v_mfma_f32_16x16x32_bf16 v[20:23], a[108:111], v[60:63], v[20:23]
  v_mfma_f32_16x16x32_bf16 v[24:27], a[188:191], v[56:59], v[24:27]
  v_mfma_f32_16x16x32_bf16 v[28:31], a[188:191], v[60:63], v[28:31]
  v_mfma_f32_16x16x32_bf16 v[32:35], v[124:127], v[56:59], v[32:35]
  v_mfma_f32_16x16x32_bf16 v[36:39], v[124:127], v[60:63], v[36:39]
  ds_read_b128 v[56:59], v7 offset:10240
  ds_read_b128 v[60:63], v7 offset:30720
  s_waitcnt lgkmcnt(4)
  v_mfma_f32_16x16x32_bf16 v[8:11], a[32:35], v[64:67], v[8:11]
  v_mfma_f32_16x16x32_bf16 v[12:15], a[32:35], v[68:71], v[12:15]
  v_mfma_f32_16x16x32_bf16 v[16:19], a[112:115], v[64:67], v[16:19]
  v_mfma_f32_16x16x32_bf16 v[20:23], a[112:115], v[68:71], v[20:23]
  v_mfma_f32_16x16x32_bf16 v[24:27], a[192:195], v[64:67], v[24:27]
  v_mfma_f32_16x16x32_bf16 v[28:31], a[192:195], v[68:71], v[28:31]
  v_mfma_f32_16x16x32_bf16 v[32:35], v[128:131], v[64:67], v[32:35]
  v_mfma_f32_16x16x32_bf16 v[36:39], v[128:131], v[68:71], v[36:39]
  ds_read_b128 v[64:67], v7 offset:11264
  ds_read_b128 v[68:71], v7 offset:31744
  s_waitcnt lgkmcnt(4)
  v_mfma_f32_16x16x32_bf16 v[8:11], a[36:39], v[48:51], v[8:11]
  v_mfma_f32_16x16x32_bf16 v[12:15], a[36:39], v[52:55], v[12:15]
  v_mfma_f32_16x16x32_bf16 v[16:19], a[116:119], v[48:51], v[16:19]
  v_mfma_f32_16x16x32_bf16 v[20:23], a[116:119], v[52:55], v[20:23]
  v_mfma_f32_16x16x32_bf16 v[24:27], a[196:199], v[48:51], v[24:27]
  v_mfma_f32_16x16x32_bf16 v[28:31], a[196:199], v[52:55], v[28:31]
  v_mfma_f32_16x16x32_bf16 v[32:35], v[132:135], v[48:51], v[32:35]
  v_mfma_f32_16x16x32_bf16 v[36:39], v[132:135], v[52:55], v[36:39]
  ds_read_b128 v[48:51], v7 offset:12288
  ds_read_b128 v[52:55], v7 offset:32768
  s_waitcnt lgkmcnt(4)
  v_mfma_f32_16x16x32_bf16 v[8:11], a[40:43], v[56:59], v[8:11]
  v_mfma_f32_16x16x32_bf16 v[12:15], a[40:43], v[60:63], v[12:15]
  v_mfma_f32_16x16x32_bf16 v[16:19], a[120:123], v[56:59], v[16:19]
  v_mfma_f32_16x16x32_bf16 v[20:23], a[120:123], v[60:63], v[20:23]
  v_mfma_f32_16x16x32_bf16 v[24:27], a[200:203], v[56:59], v[24:27]
  v_mfma_f32_16x16x32_bf16 v[28:31], a[200:203], v[60:63], v[28:31]
  v_mfma_f32_16x16x32_bf16 v[32:35], v[136:139], v[56:59], v[32:35]
  v_mfma_f32_16x16x32_bf16 v[36:39], v[136:139], v[60:63], v[36:39]
  ds_read_b128 v[56:59], v7 offset:13312
  ds_read_b128 v[60:63], v7 offset:33792
  s_waitcnt lgkmcnt(4)
  v_mfma_f32_16x16x32_bf16 v[8:11], a[44:47], v[64:67], v[8:11]
  v_mfma_f32_16x16x32_bf16 v[12:15], a[44:47], v[68:71], v[12:15]
  v_mfma_f32_16x16x32_bf16 v[16:19], a[124:127], v[64:67], v[16:19]
  v_mfma_f32_16x16x32_bf16 v[20:23], a[124:127], v[68:71], v[20:23]
  v_mfma_f32_16x16x32_bf16 v[24:27], a[204:207], v[64:67], v[24:27]
  v_mfma_f32_16x16x32_bf16 v[28:31], a[204:207], v[68:71], v[28:31]
  v_mfma_f32_16x16x32_bf16 v[32:35], v[140:143], v[64:67], v[32:35]
  v_mfma_f32_16x16x32_bf16 v[36:39], v[140:143], v[68:71], v[36:39]
  ds_read_b128 v[64:67], v7 offset:14336
  ds_read_b128 v[68:71], v7 offset:34816
  s_waitcnt lgkmcnt(4)
  v_mfma_f32_16x16x32_bf16 v[8:11], a[48:51], v[48:51], v[8:11]
  v_mfma_f32_16x16x32_bf16 v[12:15], a[48:51], v[52:55], v[12:15]
  v_mfma_f32_16x16x32_bf16 v[16:19], a[128:131], v[48:51], v[16:19]
  v_mfma_f32_16x16x32_bf16 v[20:23], a[128:131], v[52:55], v[20:23]
  v_mfma_f32_16x16x32_bf16 v[24:27], a[208:211], v[48:51], v[24:27]
  v_mfma_f32_16x16x32_bf16 v[28:31], a[208:211], v[52:55], v[28:31]
  v_mfma_f32_16x16x32_bf16 v[32:35], v[144:147], v[48:51], v[32:35]
  v_mfma_f32_16x16x32_bf16 v[36:39], v[144:147], v[52:55], v[36:39]
  ds_read_b128 v[48:51], v7 offset:15360
  ds_read_b128 v[52:55], v7 offset:35840
  s_waitcnt lgkmcnt(4)
  v_mfma_f32_16x16x32_bf16 v[8:11], a[52:55], v[56:59], v[8:11]
  v_mfma_f32_16x16x32_bf16 v[12:15], a[52:55], v[60:63], v[12:15]
  v_mfma_f32_16x16x32_bf16 v[16:19], a[132:135], v[56:59], v[16:19]
  v_mfma_f32_16x16x32_bf16 v[20:23], a[132:135], v[60:63], v[20:23]
  v_mfma_f32_16x16x32_bf16 v[24:27], a[212:215], v[56:59], v[24:27]
  v_mfma_f32_16x16x32_bf16 v[28:31], a[212:215], v[60:63], v[28:31]
  v_mfma_f32_16x16x32_bf16 v[32:35], v[148:151], v[56:59], v[32:35]
  v_mfma_f32_16x16x32_bf16 v[36:39], v[148:151], v[60:63], v[36:39]
  ds_read_b128 v[56:59], v7 offset:16384
  ds_read_b128 v[60:63], v7 offset:36864
  s_waitcnt lgkmcnt(4)
  v_mfma_f32_16x16x32_bf16 v[8:11], a[56:59], v[64:67], v[8:11]
  v_mfma_f32_16x16x32_bf16 v[12:15], a[56:59], v[68:71], v[12:15]
  v_mfma_f32_16x16x32_bf16 v[16:19], a[136:139], v[64:67], v[16:19]
  v_mfma_f32_16x16x32_bf16 v[20:23], a[136:139], v[68:71], v[20:23]
  v_mfma_f32_16x16x32_bf16 v[24:27], a[216:219], v[64:67], v[24:27]
  v_mfma_f32_16x16x32_bf16 v[28:31], a[216:219], v[68:71], v[28:31]
  v_mfma_f32_16x16x32_bf16 v[32:35], v[152:155], v[64:67], v[32:35]
  v_mfma_f32_16x16x32_bf16 v[36:39], v[152:155], v[68:71], v[36:39]
  ds_read_b128 v[64:67], v7 offset:17408
  ds_read_b128 v[68:71], v7 offset:37888
  s_waitcnt lgkmcnt(4)
  v_mfma_f32_16x16x32_bf16 v[8:11], a[60:63], v[48:51], v[8:11]
  v_mfma_f32_16x16x32_bf16 v[12:15], a[60:63], v[52:55], v[12:15]
  v_mfma_f32_16x16x32_bf16 v[16:19], a[140:143], v[48:51], v[16:19]
  v_mfma_f32_16x16x32_bf16 v[20:23], a[140:143], v[52:55], v[20:23]
  v_mfma_f32_16x16x32_bf16 v[24:27], a[220:223], v[48:51], v[24:27]
  v_mfma_f32_16x16x32_bf16 v[28:31], a[220:223], v[52:55], v[28:31]
  v_mfma_f32_16x16x32_bf16 v[32:35], v[156:159], v[48:51], v[32:35]
  v_mfma_f32_16x16x32_bf16 v[36:39], v[156:159], v[52:55], v[36:39]
  ds_read_b128 v[48:51], v7 offset:18432
  ds_read_b128 v[52:55], v7 offset:38912
  s_waitcnt lgkmcnt(4)
  v_mfma_f32_16x16x32_bf16 v[8:11], a[64:67], v[56:59], v[8:11]
  v_mfma_f32_16x16x32_bf16 v[12:15], a[64:67], v[60:63], v[12:15]
  v_mfma_f32_16x16x32_bf16 v[16:19], a[144:147], v[56:59], v[16:19]
  v_mfma_f32_16x16x32_bf16 v[20:23], a[144:147], v[60:63], v[20:23]
  v_mfma_f32_16x16x32_bf16 v[24:27], a[224:227], v[56:59], v[24:27]
  v_mfma_f32_16x16x32_bf16 v[28:31], a[224:227], v[60:63], v[28:31]
  v_mfma_f32_16x16x32_bf16 v[32:35], v[160:163], v[56:59], v[32:35]
  v_mfma_f32_16x16x32_bf16 v[36:39], v[160:163], v[60:63], v[36:39]
  ds_read_b128 v[56:59], v7 offset:19456
  ds_read_b128 v[60:63], v7 offset:39936
  s_waitcnt lgkmcnt(4)
  v_mfma_f32_16x16x32_bf16 v[8:11], a[68:71], v[64:67], v[8:11]
  v_mfma_f32_16x16x32_bf16 v[12:15], a[68:71], v[68:71], v[12:15]
  v_mfma_f32_16x16x32_bf16 v[16:19], a[148:151], v[64:67], v[16:19]
  v_mfma_f32_16x16x32_bf16 v[20:23], a[148:151], v[68:71], v[20:23]
  v_mfma_f32_16x16x32_bf16 v[24:27], a[228:231], v[64:67], v[24:27]
  v_mfma_f32_16x16x32_bf16 v[28:31], a[228:231], v[68:71], v[28:31]
  v_mfma_f32_16x16x32_bf16 v[32:35], v[164:167], v[64:67], v[32:35]
  v_mfma_f32_16x16x32_bf16 v[36:39], v[164:167], v[68:71], v[36:39]
  s_waitcnt lgkmcnt(2)
  v_mfma_f32_16x16x32_bf16 v[8:11], a[72:75], v[48:51], v[8:11]
  v_mfma_f32_16x16x32_bf16 v[12:15], a[72:75], v[52:55], v[12:15]
  v_mfma_f32_16x16x32_bf16 v[16:19], a[152:155], v[48:51], v[16:19]
  v_mfma_f32_16x16x32_bf16 v[20:23], a[152:155], v[52:55], v[20:23]
  v_mfma_f32_16x16x32_bf16 v[24:27], a[232:235], v[48:51], v[24:27]
  v_mfma_f32_16x16x32_bf16 v[28:31], a[232:235], v[52:55], v[28:31]
  v_mfma_f32_16x16x32_bf16 v[32:35], v[168:171], v[48:51], v[32:35]
  v_mfma_f32_16x16x32_bf16 v[36:39], v[168:171], v[52:55], v[36:39]
  s_waitcnt lgkmcnt(0)
  v_mfma_f32_16x16x32_bf16 v[8:11], a[76:79], v[56:59], v[8:11]
  v_mfma_f32_16x16x32_bf16 v[12:15], a[76:79], v[60:63], v[12:15]
  v_mfma_f32_16x16x32_bf16 v[16:19], a[156:159], v[56:59], v[16:19]
  v_mfma_f32_16x16x32_bf16 v[20:23], a[156:159], v[60:63], v[20:23]
  v_mfma_f32_16x16x32_bf16 v[24:27], a[236:239], v[56:59], v[24:27]
  v_mfma_f32_16x16x32_bf16 v[28:31], a[236:239], v[60:63], v[28:31]
  v_mfma_f32_16x16x32_bf16 v[32:35], v[172:175], v[56:59], v[32:35]
  v_mfma_f32_16x16x32_bf16 v[36:39], v[172:175], v[60:63], v[36:39]
  s_nop 0
  v_cvt_pk_bf16_f32 v72, v8, v9
  v_cvt_pk_bf16_f32 v73, v10, v11
  v_cvt_pk_bf16_f32 v74, v16, v17
  v_cvt_pk_bf16_f32 v75, v18, v19
  s_add_u32 s34, s22, 1024
  buffer_store_dwordx4 v[72:75], v1, s[4:7], s34 offen
  v_cvt_pk_bf16_f32 v76, v12, v13
  v_cvt_pk_bf16_f32 v77, v14, v15
  v_cvt_pk_bf16_f32 v78, v20, v21
  v_cvt_pk_bf16_f32 v79, v22, v23
  s_add_u32 s34, s22, 7168
  buffer_store_dwordx4 v[76:79], v1, s[4:7], s34 offen
  v_cvt_pk_bf16_f32 v72, v24, v25
  v_cvt_pk_bf16_f32 v73, v26, v27
  v_cvt_pk_bf16_f32 v74, v32, v33
  v_cvt_pk_bf16_f32 v75, v34, v35
  s_add_u32 s34, s22, 2048
  buffer_store_dwordx4 v[72:75], v1, s[4:7], s34 offen
  v_cvt_pk_bf16_f32 v76, v28, v29
  v_cvt_pk_bf16_f32 v77, v30, v31
  v_cvt_pk_bf16_f32 v78, v36, v37
  v_cvt_pk_bf16_f32 v79, v38, v39
  s_add_u32 s34, s22, 8192
  buffer_store_dwordx4 v[76:79], v1, s[4:7], s34 offen
  s_waitcnt vmcnt(0)
  s_barrier
  s_add_u32 s17, s17, 1
  s_cmp_lt_u32 s17, 64
  s_cbranch_scc1 reca_ptop102
  s_branch reca_exit1
  s_branch reca_exit1
  s_cmp_ge_u32 s14, 32
  s_cbranch_scc1 reca_exit1
  s_sub_u32 s34, s14, 24
  s_lshr_b32 s35, s34, 1
  s_lshl_b32 s15, s13, 2
  s_add_u32 s15, s15, s35
  s_and_b32 s34, s34, 1
  s_mov_b32 s35, 62914560
  s_cmp_eq_u32 s34, 0
  s_cselect_b32 s35, 37748736, s35
  s_mul_i32 s34, s15, 786432
  s_add_u32 s20, s34, s35
  s_mul_i32 s34, s12, 3072
  s_add_u32 s20, s20, s34
  s_lshl_b32 s21, s13, 7
  s_add_u32 s21, s21, 1507328
  v_mov_b32 v29, 0
  s_mov_b32 s17, 0
reca_wtop106:
  s_cmp_lt_u32 s17, 3
  s_cbranch_scc1 reca_wgo108
  s_sub_u32 s36, s17, 3
reca_wpoll107:
  buffer_load_dword v28, v29, s[4:7], s21 offen sc1
  s_waitcnt vmcnt(0)
  v_readfirstlane_b32 s34, v28
  s_nop 3
  s_cmp_ge_i32 s34, s36
  s_cbranch_scc1 reca_wgo108
  s_sleep 4
  s_sub_u32 s18, s18, 1
  s_cbranch_scc0 reca_wpoll107
  s_mov_b32 s18, 0
reca_wgo108:
  buffer_load_dwordx4 v[128:131], v1, s[4:7], s20 offen offset:0
  buffer_load_dwordx4 v[132:135], v1, s[4:7], s20 offen offset:1024
  buffer_load_dwordx4 v[136:139], v1, s[4:7], s20 offen offset:2048
  s_add_u32 s20, s20, 12288
  s_add_u32 s17, s17, 1
  s_cmp_lt_u32 s17, 63
  s_waitcnt vmcnt(0)
  s_cbranch_scc1 reca_wtop106
reca_exit1:
  s_endpgm
.globl attna_kernel
.p2align 8
.type attna_kernel,@function
attna_kernel:
  s_cmp_ge_u32 s2, 512
  s_cbranch_scc1 attna_exit1
  s_load_dwordx2 s[8:9], s[0:1], 96
  v_lshrrev_b32 v6, 6, v0
  v_and_b32 v7, 63, v0
  s_nop 0
  v_readfirstlane_b32 s12, v6
  v_lshlrev_b32 v1, 4, v7
  v_add_u32 v2, 0x1000, v1
  v_add_u32 v3, 0x2000, v1
  s_and_b32 s13, s2, 7
  s_lshr_b32 s14, s2, 3
  s_and_b32 s15, s14, 3
  s_lshl_b32 s13, s13, 2
  s_add_u32 s15, s15, s13
  s_lshr_b32 s14, s14, 2
  s_lshl_b32 s14, s14, 2
  s_add_u32 s14, s14, s12
  s_waitcnt lgkmcnt(0)
  s_mov_b32 s4, s8
  s_mov_b32 s5, s9
  s_mov_b32 s6, 0x10000000
  s_mov_b32 s7, 0x20000
  s_lshl_b32 s16, s15, 6
  s_add_u32 s16, s16, s14
  s_mul_i32 s16, s16, 12288
  s_add_u32 s20, s16, 88080384
  s_add_u32 s21, s16, 37748736
  s_add_u32 s22, s16, 62914560
  s_lshl_b32 s17, s14, 5
  s_add_u32 s17, s17, s15
  s_mul_i32 s17, s17, 3072
  s_add_u32 s23, s17, 113246208
  s_add_u32 s24, s17, 119537664
  s_lshl_b32 s17, s14, 1
  s_mul_i32 s17, s17, 196608
  s_mul_i32 s18, s15, 6144
  s_add_u32 s17, s17, s18
  s_add_u32 s25, s17, 125829120
  s_add_u32 s26, s25, 196608
  s_mov_b32 s27, 0x3dd53b95
  v_and_b32 v6, 15, v7
  v_lshrrev_b32 v8, 4, v7
  v_mov_b32 v9, 0x80000000
  v_lshlrev_b32 v10, 4, v6
  v_lshl_add_u32 v10, v8, 7, v10
  v_cmp_gt_u32 vcc, 8, v6
  s_nop 1
  v_cndmask_b32 v4, v9, v10, vcc
  v_lshlrev_b32 v10, 3, v7
  v_cmp_gt_u32 vcc, 32, v7
  s_nop 1
  v_cndmask_b32 v5, v9, v10, vcc
  buffer_load_dwordx4 v[136:139], v1, s[4:7], s21 offen offset:0
  buffer_load_dwordx4 v[140:143], v1, s[4:7], s21 offen offset:1024
  buffer_load_dwordx4 v[144:147], v1, s[4:7], s21 offen offset:2048
  buffer_load_dwordx4 v[148:151], v1, s[4:7], s21 offen offset:3072
  buffer_load_dwordx4 v[152:155], v2, s[4:7], s21 offen offset:0
  buffer_load_dwordx4 v[156:159], v2, s[4:7], s21 offen offset:1024
  buffer_load_dwordx4 v[160:163], v2, s[4:7], s21 offen offset:2048
  buffer_load_dwordx4 v[164:167], v2, s[4:7], s21 offen offset:3072
  buffer_load_dwordx4 v[168:171], v3, s[4:7], s21 offen offset:0
  buffer_load_dwordx4 v[172:175], v3, s[4:7], s21 offen offset:1024
  buffer_load_dwordx4 v[176:179], v3, s[4:7], s21 offen offset:2048
  buffer_load_dwordx4 v[180:183], v3, s[4:7], s21 offen offset:3072
  buffer_load_dwordx4 v[184:187], v4, s[4:7], s23 offen offset:0
  buffer_load_dwordx4 v[188:191], v4, s[4:7], s23 offen offset:512
  buffer_load_dwordx4 v[192:195], v4, s[4:7], s23 offen offset:1024
  buffer_load_dwordx4 v[196:199], v4, s[4:7], s23 offen offset:1536
  buffer_load_dwordx4 v[200:203], v4, s[4:7], s23 offen offset:2048
  buffer_load_dwordx4 v[204:207], v4, s[4:7], s23 offen offset:2560
  buffer_load_dwordx4 v[88:91], v1, s[4:7], s20 offen offset:0
  buffer_load_dwordx4 v[92:95], v1, s[4:7], s20 offen offset:1024
  buffer_load_dwordx4 v[96:99], v1, s[4:7], s20 offen offset:2048
  buffer_load_dwordx4 v[100:103], v1, s[4:7], s20 offen offset:3072
  buffer_load_dwordx4 v[104:107], v2, s[4:7], s20 offen offset:0
  buffer_load_dwordx4 v[108:111], v2, s[4:7], s20 offen offset:1024
  buffer_load_dwordx4 v[112:115], v2, s[4:7], s20 offen offset:2048
  buffer_load_dwordx4 v[116:119], v2, s[4:7], s20 offen offset:3072
  buffer_load_dwordx4 v[120:123], v3, s[4:7], s20 offen offset:0
  buffer_load_dwordx4 v[124:127], v3, s[4:7], s20 offen offset:1024
  buffer_load_dwordx4 v[128:131], v3, s[4:7], s20 offen offset:2048
  buffer_load_dwordx4 v[132:135], v3, s[4:7], s20 offen offset:3072
  v_mov_b32 v10, 0xf149f2ca
  v_cmp_le_u32 vcc, 2, v8
  s_nop 1
  v_cndmask_b32 v12, 0, v10, vcc
  v_mov_b32 v13, v12
  v_mov_b32 v14, v12
  v_mov_b32 v15, v12
  v_lshlrev_b32 v11, 2, v8
  v_add_u32 v7, 0, v11
  v_cmp_gt_u32 vcc, v7, v6
  s_nop 1
  v_cndmask_b32 v16, 0, v10, vcc
  v_add_u32 v7, 1, v11
  v_cmp_gt_u32 vcc, v7, v6
  s_nop 1
  v_cndmask_b32 v17, 0, v10, vcc
  v_add_u32 v7, 2, v11
  v_cmp_gt_u32 vcc, v7, v6
  s_nop 1
  v_cndmask_b32 v18, 0, v10, vcc
  v_add_u32 v7, 3, v11
  v_cmp_gt_u32 vcc, v7, v6
  s_nop 1
  v_cndmask_b32 v19, 0, v10, vcc
  v_mov_b32 v20, 0x3f803f80
  v_mov_b32 v21, 0x3f803f80
  v_mov_b32 v22, 0x3f803f80
  v_mov_b32 v23, 0x3f803f80
  s_waitcnt vmcnt(0)
  v_mfma_f32_16x16x32_bf16 v[24:27], v[184:187], v[88:91], v[12:15]
  v_mfma_f32_16x16x32_bf16 v[28:31], v[136:139], v[88:91], v[16:19]
  v_mfma_f32_16x16x32_bf16 v[32:35], v[184:187], v[112:115], v[12:15]
  v_mfma_f32_16x16x32_bf16 v[36:39], v[136:139], v[112:115], 0
  v_mfma_f32_16x16x32_bf16 v[40:43], v[160:163], v[112:115], v[16:19]
  v_mfma_f32_16x16x32_bf16 v[24:27], v[188:191], v[92:95], v[24:27]
  v_mfma_f32_16x16x32_bf16 v[28:31], v[140:143], v[92:95], v[28:31]
  v_mfma_f32_16x16x32_bf16 v[32:35], v[188:191], v[116:119], v[32:35]
  v_mfma_f32_16x16x32_bf16 v[36:39], v[140:143], v[116:119], v[36:39]
  v_mfma_f32_16x16x32_bf16 v[40:43], v[164:167], v[116:119], v[40:43]
  v_mfma_f32_16x16x32_bf16 v[24:27], v[192:195], v[96:99], v[24:27]
  v_mfma_f32_16x16x32_bf16 v[28:31], v[144:147], v[96:99], v[28:31]
  v_mfma_f32_16x16x32_bf16 v[32:35], v[192:195], v[120:123], v[32:35]
  v_mfma_f32_16x16x32_bf16 v[36:39], v[144:147], v[120:123], v[36:39]
  v_mfma_f32_16x16x32_bf16 v[40:43], v[168:171], v[120:123], v[40:43]
  v_mfma_f32_16x16x32_bf16 v[24:27], v[196:199], v[100:103], v[24:27]
  v_mfma_f32_16x16x32_bf16 v[28:31], v[148:151], v[100:103], v[28:31]
  v_mfma_f32_16x16x32_bf16 v[32:35], v[196:199], v[124:127], v[32:35]
  v_mfma_f32_16x16x32_bf16 v[36:39], v[148:151], v[124:127], v[36:39]
  v_mfma_f32_16x16x32_bf16 v[40:43], v[172:175], v[124:127], v[40:43]
  v_mfma_f32_16x16x32_bf16 v[24:27], v[200:203], v[104:107], v[24:27]
  v_mfma_f32_16x16x32_bf16 v[28:31], v[152:155], v[104:107], v[28:31]
  v_mfma_f32_16x16x32_bf16 v[32:35], v[200:203], v[128:131], v[32:35]
  v_mfma_f32_16x16x32_bf16 v[36:39], v[152:155], v[128:131], v[36:39]
  v_mfma_f32_16x16x32_bf16 v[40:43], v[176:179], v[128:131], v[40:43]
  v_mfma_f32_16x16x32_bf16 v[24:27], v[204:207], v[108:111], v[24:27]
  v_mfma_f32_16x16x32_bf16 v[28:31], v[156:159], v[108:111], v[28:31]
  v_mfma_f32_16x16x32_bf16 v[32:35], v[204:207], v[132:135], v[32:35]
  v_mfma_f32_16x16x32_bf16 v[36:39], v[156:159], v[132:135], v[36:39]
  v_mfma_f32_16x16x32_bf16 v[40:43], v[180:183], v[132:135], v[40:43]
  s_nop 7
  buffer_load_dwordx4 v[88:91], v1, s[4:7], s22 offen offset:0
  buffer_load_dwordx4 v[92:95], v1, s[4:7], s22 offen offset:1024
  buffer_load_dwordx4 v[96:99], v1, s[4:7], s22 offen offset:2048
  buffer_load_dwordx4 v[100:103], v1, s[4:7], s22 offen offset:3072
  buffer_load_dwordx4 v[104:107], v2, s[4:7], s22 offen offset:0
  buffer_load_dwordx4 v[108:111], v2, s[4:7], s22 offen offset:1024
  buffer_load_dwordx4 v[112:115], v2, s[4:7], s22 offen offset:2048
  buffer_load_dwordx4 v[116:119], v2, s[4:7], s22 offen offset:3072
  buffer_load_dwordx4 v[120:123], v3, s[4:7], s22 offen offset:0
  buffer_load_dwordx4 v[124:127], v3, s[4:7], s22 offen offset:1024
  buffer_load_dwordx4 v[128:131], v3, s[4:7], s22 offen offset:2048
  buffer_load_dwordx4 v[132:135], v3, s[4:7], s22 offen offset:3072
  buffer_load_dwordx2 v[136:137], v5, s[4:7], s24 offen offset:0
  buffer_load_dwordx2 v[138:139], v5, s[4:7], s24 offen offset:256
  buffer_load_dwordx2 v[140:141], v5, s[4:7], s24 offen offset:512
  buffer_load_dwordx2 v[142:143], v5, s[4:7], s24 offen offset:768
  buffer_load_dwordx2 v[144:145], v5, s[4:7], s24 offen offset:1024
  buffer_load_dwordx2 v[146:147], v5, s[4:7], s24 offen offset:1280
  buffer_load_dwordx2 v[148:149], v5, s[4:7], s24 offen offset:1536
  buffer_load_dwordx2 v[150:151], v5, s[4:7], s24 offen offset:1792
  buffer_load_dwordx2 v[152:153], v5, s[4:7], s24 offen offset:2048
  buffer_load_dwordx2 v[154:155], v5, s[4:7], s24 offen offset:2304
  buffer_load_dwordx2 v[156:157], v5, s[4:7], s24 offen offset:2560
  buffer_load_dwordx2 v[158:159], v5, s[4:7], s24 offen offset:2816
  v_max3_f32 v6, v24, v25, v26
  v_max3_f32 v6, v6, v27, v28
  v_max3_f32 v6, v6, v29, v30
  v_max_f32 v6, v6, v31
  v_mov_b32 v7, v6
  s_nop 1
  v_permlane32_swap_b32 v6, v7
  v_max_f32 v6, v6, v7
  v_mov_b32 v7, v6
  s_nop 1
  v_permlane16_swap_b32 v6, v7
  v_max_f32 v6, v6, v7
  v_mul_f32 v6, s27, v6
  v_fma_f32 v24, v24, s27, -v6
  v_fma_f32 v25, v25, s27, -v6
  v_fma_f32 v26, v26, s27, -v6
  v_fma_f32 v27, v27, s27, -v6
  v_fma_f32 v28, v28, s27, -v6
  v_fma_f32 v29, v29, s27, -v6
  v_fma_f32 v30, v30, s27, -v6
  v_fma_f32 v31, v31, s27, -v6
  v_exp_f32 v24, v24
  v_exp_f32 v25, v25
  v_exp_f32 v26, v26
  v_exp_f32 v27, v27
  v_exp_f32 v28, v28
  v_exp_f32 v29, v29
  v_exp_f32 v30, v30
  v_exp_f32 v31, v31
  v_max3_f32 v8, v32, v33, v34
  v_max3_f32 v8, v8, v35, v36
  v_max3_f32 v8, v8, v37, v38
  v_max3_f32 v8, v8, v39, v40
  v_max3_f32 v8, v8, v41, v42
  v_max_f32 v8, v8, v43
  v_mov_b32 v10, v8
  s_nop 1
  v_permlane32_swap_b32 v8, v10
  v_max_f32 v8, v8, v10
  v_mov_b32 v10, v8
  s_nop 1
  v_permlane16_swap_b32 v8, v10
  v_max_f32 v8, v8, v10
  v_mul_f32 v8, s27, v8
  v_fma_f32 v32, v32, s27, -v8
  v_fma_f32 v33, v33, s27, -v8
  v_fma_f32 v34, v34, s27, -v8
  v_fma_f32 v35, v35, s27, -v8
  v_fma_f32 v36, v36, s27, -v8
  v_fma_f32 v37, v37, s27, -v8
  v_fma_f32 v38, v38, s27, -v8
  v_fma_f32 v39, v39, s27, -v8
  v_fma_f32 v40, v40, s27, -v8
  v_fma_f32 v41, v41, s27, -v8
  v_fma_f32 v42, v42, s27, -v8
  v_fma_f32 v43, v43, s27, -v8
  v_exp_f32 v32, v32
  v_exp_f32 v33, v33
  v_exp_f32 v34, v34
  v_exp_f32 v35, v35
  v_exp_f32 v36, v36
  v_exp_f32 v37, v37
  v_exp_f32 v38, v38
  v_exp_f32 v39, v39
  v_exp_f32 v40, v40
  v_exp_f32 v41, v41
  v_exp_f32 v42, v42
  v_exp_f32 v43, v43
  v_cvt_pk_bf16_f32 v44, v24, v25
  v_cvt_pk_bf16_f32 v45, v26, v27
  v_cvt_pk_bf16_f32 v46, v28, v29
  v_cvt_pk_bf16_f32 v47, v30, v31
  v_cvt_pk_bf16_f32 v48, v32, v33
  v_cvt_pk_bf16_f32 v49, v34, v35
  v_cvt_pk_bf16_f32 v50, v36, v37
  v_cvt_pk_bf16_f32 v51, v38, v39
  v_cvt_pk_bf16_f32 v52, v40, v41
  v_cvt_pk_bf16_f32 v53, v42, v43
  v_mfma_f32_16x16x16_bf16 v[56:59], v[20:21], v[44:45], 0
  v_mfma_f32_16x16x16_bf16 v[60:63], v[20:21], v[48:49], 0
  v_mfma_f32_16x16x16_bf16 v[56:59], v[20:21], v[46:47], v[56:59]
  v_mfma_f32_16x16x32_bf16 v[60:63], v[20:23], v[50:53], v[60:63]
  s_nop 6
  v_rcp_f32 v10, v56
  v_rcp_f32 v11, v60
  s_waitcnt vmcnt(0)
  v_mfma_f32_16x16x16_bf16 v[64:67], v[136:137], v[44:45], 0
  v_mfma_f32_16x16x16_bf16 v[68:71], v[136:137], v[48:49], 0
  v_mfma_f32_16x16x16_bf16 v[64:67], v[88:89], v[46:47], v[64:67]
  v_mfma_f32_16x16x32_bf16 v[68:71], v[88:91], v[50:53], v[68:71]
  v_mfma_f32_16x16x16_bf16 v[72:75], v[138:139], v[44:45], 0
  v_mfma_f32_16x16x16_bf16 v[76:79], v[138:139], v[48:49], 0
  v_mfma_f32_16x16x16_bf16 v[72:75], v[92:93], v[46:47], v[72:75]
  v_mfma_f32_16x16x32_bf16 v[76:79], v[92:95], v[50:53], v[76:79]
  s_nop 2
  v_mul_f32 v64, v64, v10
  v_mul_f32 v65, v65, v10
  v_mul_f32 v66, v66, v10
  v_mul_f32 v67, v67, v10
  v_cvt_pk_bf16_f32 v80, v64, v65
  v_cvt_pk_bf16_f32 v81, v66, v67
  v_mul_f32 v72, v72, v10
  v_mul_f32 v73, v73, v10
  v_mul_f32 v74, v74, v10
  v_mul_f32 v75, v75, v10
  v_cvt_pk_bf16_f32 v82, v72, v73
  v_cvt_pk_bf16_f32 v83, v74, v75
  buffer_store_dwordx4 v[80:83], v1, s[4:7], s25 offen offset:0
  v_mul_f32 v68, v68, v11
  v_mul_f32 v69, v69, v11
  v_mul_f32 v70, v70, v11
  v_mul_f32 v71, v71, v11
  v_cvt_pk_bf16_f32 v84, v68, v69
  v_cvt_pk_bf16_f32 v85, v70, v71
  v_mul_f32 v76, v76, v11
  v_mul_f32 v77, v77, v11
  v_mul_f32 v78, v78, v11
  v_mul_f32 v79, v79, v11
  v_cvt_pk_bf16_f32 v86, v76, v77
  v_cvt_pk_bf16_f32 v87, v78, v79
  buffer_store_dwordx4 v[84:87], v1, s[4:7], s26 offen offset:0
  v_mfma_f32_16x16x16_bf16 v[64:67], v[140:141], v[44:45], 0
  v_mfma_f32_16x16x16_bf16 v[68:71], v[140:141], v[48:49], 0
  v_mfma_f32_16x16x16_bf16 v[64:67], v[96:97], v[46:47], v[64:67]
  v_mfma_f32_16x16x32_bf16 v[68:71], v[96:99], v[50:53], v[68:71]
  v_mfma_f32_16x16x16_bf16 v[72:75], v[142:143], v[44:45], 0
  v_mfma_f32_16x16x16_bf16 v[76:79], v[142:143], v[48:49], 0
  v_mfma_f32_16x16x16_bf16 v[72:75], v[100:101], v[46:47], v[72:75]
  v_mfma_f32_16x16x32_bf16 v[76:79], v[100:103], v[50:53], v[76:79]
  s_nop 2
  v_mul_f32 v64, v64, v10
  v_mul_f32 v65, v65, v10
  v_mul_f32 v66, v66, v10
  v_mul_f32 v67, v67, v10
  v_cvt_pk_bf16_f32 v80, v64, v65
  v_cvt_pk_bf16_f32 v81, v66, v67
  v_mul_f32 v72, v72, v10
  v_mul_f32 v73, v73, v10
  v_mul_f32 v74, v74, v10
  v_mul_f32 v75, v75, v10
  v_cvt_pk_bf16_f32 v82, v72, v73
  v_cvt_pk_bf16_f32 v83, v74, v75
  buffer_store_dwordx4 v[80:83], v1, s[4:7], s25 offen offset:1024
  v_mul_f32 v68, v68, v11
  v_mul_f32 v69, v69, v11
  v_mul_f32 v70, v70, v11
  v_mul_f32 v71, v71, v11
  v_cvt_pk_bf16_f32 v84, v68, v69
  v_cvt_pk_bf16_f32 v85, v70, v71
  v_mul_f32 v76, v76, v11
  v_mul_f32 v77, v77, v11
  v_mul_f32 v78, v78, v11
  v_mul_f32 v79, v79, v11
  v_cvt_pk_bf16_f32 v86, v76, v77
  v_cvt_pk_bf16_f32 v87, v78, v79
  buffer_store_dwordx4 v[84:87], v1, s[4:7], s26 offen offset:1024
  v_mfma_f32_16x16x16_bf16 v[64:67], v[144:145], v[44:45], 0
  v_mfma_f32_16x16x16_bf16 v[68:71], v[144:145], v[48:49], 0
  v_mfma_f32_16x16x16_bf16 v[64:67], v[104:105], v[46:47], v[64:67]
  v_mfma_f32_16x16x32_bf16 v[68:71], v[104:107], v[50:53], v[68:71]
  v_mfma_f32_16x16x16_bf16 v[72:75], v[146:147], v[44:45], 0
  v_mfma_f32_16x16x16_bf16 v[76:79], v[146:147], v[48:49], 0
  v_mfma_f32_16x16x16_bf16 v[72:75], v[108:109], v[46:47], v[72:75]
  v_mfma_f32_16x16x32_bf16 v[76:79], v[108:111], v[50:53], v[76:79]
  s_nop 2
  v_mul_f32 v64, v64, v10
  v_mul_f32 v65, v65, v10
  v_mul_f32 v66, v66, v10
  v_mul_f32 v67, v67, v10
  v_cvt_pk_bf16_f32 v80, v64, v65
  v_cvt_pk_bf16_f32 v81, v66, v67
  v_mul_f32 v72, v72, v10
  v_mul_f32 v73, v73, v10
  v_mul_f32 v74, v74, v10
  v_mul_f32 v75, v75, v10
  v_cvt_pk_bf16_f32 v82, v72, v73
  v_cvt_pk_bf16_f32 v83, v74, v75
  buffer_store_dwordx4 v[80:83], v1, s[4:7], s25 offen offset:2048
  v_mul_f32 v68, v68, v11
  v_mul_f32 v69, v69, v11
  v_mul_f32 v70, v70, v11
  v_mul_f32 v71, v71, v11
  v_cvt_pk_bf16_f32 v84, v68, v69
  v_cvt_pk_bf16_f32 v85, v70, v71
  v_mul_f32 v76, v76, v11
  v_mul_f32 v77, v77, v11
  v_mul_f32 v78, v78, v11
  v_mul_f32 v79, v79, v11
  v_cvt_pk_bf16_f32 v86, v76, v77
  v_cvt_pk_bf16_f32 v87, v78, v79
  buffer_store_dwordx4 v[84:87], v1, s[4:7], s26 offen offset:2048
  v_mfma_f32_16x16x16_bf16 v[64:67], v[148:149], v[44:45], 0
  v_mfma_f32_16x16x16_bf16 v[68:71], v[148:149], v[48:49], 0
  v_mfma_f32_16x16x16_bf16 v[64:67], v[112:113], v[46:47], v[64:67]
  v_mfma_f32_16x16x32_bf16 v[68:71], v[112:115], v[50:53], v[68:71]
  v_mfma_f32_16x16x16_bf16 v[72:75], v[150:151], v[44:45], 0
  v_mfma_f32_16x16x16_bf16 v[76:79], v[150:151], v[48:49], 0
  v_mfma_f32_16x16x16_bf16 v[72:75], v[116:117], v[46:47], v[72:75]
  v_mfma_f32_16x16x32_bf16 v[76:79], v[116:119], v[50:53], v[76:79]
  s_nop 2
  v_mul_f32 v64, v64, v10
  v_mul_f32 v65, v65, v10
  v_mul_f32 v66, v66, v10
  v_mul_f32 v67, v67, v10
  v_cvt_pk_bf16_f32 v80, v64, v65
  v_cvt_pk_bf16_f32 v81, v66, v67
  v_mul_f32 v72, v72, v10
  v_mul_f32 v73, v73, v10
  v_mul_f32 v74, v74, v10
  v_mul_f32 v75, v75, v10
  v_cvt_pk_bf16_f32 v82, v72, v73
  v_cvt_pk_bf16_f32 v83, v74, v75
  buffer_store_dwordx4 v[80:83], v1, s[4:7], s25 offen offset:3072
  v_mul_f32 v68, v68, v11
  v_mul_f32 v69, v69, v11
  v_mul_f32 v70, v70, v11
  v_mul_f32 v71, v71, v11
  v_cvt_pk_bf16_f32 v84, v68, v69
  v_cvt_pk_bf16_f32 v85, v70, v71
  v_mul_f32 v76, v76, v11
  v_mul_f32 v77, v77, v11
  v_mul_f32 v78, v78, v11
  v_mul_f32 v79, v79, v11
  v_cvt_pk_bf16_f32 v86, v76, v77
  v_cvt_pk_bf16_f32 v87, v78, v79
  buffer_store_dwordx4 v[84:87], v1, s[4:7], s26 offen offset:3072
  v_mfma_f32_16x16x16_bf16 v[64:67], v[152:153], v[44:45], 0
  v_mfma_f32_16x16x16_bf16 v[68:71], v[152:153], v[48:49], 0
  v_mfma_f32_16x16x16_bf16 v[64:67], v[120:121], v[46:47], v[64:67]
  v_mfma_f32_16x16x32_bf16 v[68:71], v[120:123], v[50:53], v[68:71]
  v_mfma_f32_16x16x16_bf16 v[72:75], v[154:155], v[44:45], 0
  v_mfma_f32_16x16x16_bf16 v[76:79], v[154:155], v[48:49], 0
  v_mfma_f32_16x16x16_bf16 v[72:75], v[124:125], v[46:47], v[72:75]
  v_mfma_f32_16x16x32_bf16 v[76:79], v[124:127], v[50:53], v[76:79]
  s_nop 2
  v_mul_f32 v64, v64, v10
  v_mul_f32 v65, v65, v10
  v_mul_f32 v66, v66, v10
  v_mul_f32 v67, v67, v10
  v_cvt_pk_bf16_f32 v80, v64, v65
  v_cvt_pk_bf16_f32 v81, v66, v67
  v_mul_f32 v72, v72, v10
  v_mul_f32 v73, v73, v10
  v_mul_f32 v74, v74, v10
  v_mul_f32 v75, v75, v10
  v_cvt_pk_bf16_f32 v82, v72, v73
  v_cvt_pk_bf16_f32 v83, v74, v75
  buffer_store_dwordx4 v[80:83], v2, s[4:7], s25 offen offset:0
  v_mul_f32 v68, v68, v11
  v_mul_f32 v69, v69, v11
  v_mul_f32 v70, v70, v11
  v_mul_f32 v71, v71, v11
  v_cvt_pk_bf16_f32 v84, v68, v69
  v_cvt_pk_bf16_f32 v85, v70, v71
  v_mul_f32 v76, v76, v11
  v_mul_f32 v77, v77, v11
  v_mul_f32 v78, v78, v11
  v_mul_f32 v79, v79, v11
  v_cvt_pk_bf16_f32 v86, v76, v77
  v_cvt_pk_bf16_f32 v87, v78, v79
  buffer_store_dwordx4 v[84:87], v2, s[4:7], s26 offen offset:0
  v_mfma_f32_16x16x16_bf16 v[64:67], v[156:157], v[44:45], 0
  v_mfma_f32_16x16x16_bf16 v[68:71], v[156:157], v[48:49], 0
  v_mfma_f32_16x16x16_bf16 v[64:67], v[128:129], v[46:47], v[64:67]
  v_mfma_f32_16x16x32_bf16 v[68:71], v[128:131], v[50:53], v[68:71]
  v_mfma_f32_16x16x16_bf16 v[72:75], v[158:159], v[44:45], 0
  v_mfma_f32_16x16x16_bf16 v[76:79], v[158:159], v[48:49], 0
  v_mfma_f32_16x16x16_bf16 v[72:75], v[132:133], v[46:47], v[72:75]
  v_mfma_f32_16x16x32_bf16 v[76:79], v[132:135], v[50:53], v[76:79]
  s_nop 2
  v_mul_f32 v64, v64, v10
  v_mul_f32 v65, v65, v10
  v_mul_f32 v66, v66, v10
  v_mul_f32 v67, v67, v10
  v_cvt_pk_bf16_f32 v80, v64, v65
  v_cvt_pk_bf16_f32 v81, v66, v67
  v_mul_f32 v72, v72, v10
  v_mul_f32 v73, v73, v10
  v_mul_f32 v74, v74, v10
  v_mul_f32 v75, v75, v10
  v_cvt_pk_bf16_f32 v82, v72, v73
  v_cvt_pk_bf16_f32 v83, v74, v75
  buffer_store_dwordx4 v[80:83], v2, s[4:7], s25 offen offset:1024
  v_mul_f32 v68, v68, v11
  v_mul_f32 v69, v69, v11
  v_mul_f32 v70, v70, v11
  v_mul_f32 v71, v71, v11
  v_cvt_pk_bf16_f32 v84, v68, v69
  v_cvt_pk_bf16_f32 v85, v70, v71
  v_mul_f32 v76, v76, v11
  v_mul_f32 v77, v77, v11
  v_mul_f32 v78, v78, v11
  v_mul_f32 v79, v79, v11
  v_cvt_pk_bf16_f32 v86, v76, v77
  v_cvt_pk_bf16_f32 v87, v78, v79
  buffer_store_dwordx4 v[84:87], v2, s[4:7], s26 offen offset:1024
attna_exit1:
  s_endpgm
.globl outa1_kernel
.p2align 8
.type outa1_kernel,@function
outa1_kernel:
  s_cmp_ge_u32 s2, 256
  s_cbranch_scc1 outa1_exit1
  s_load_dwordx2 s[12:13], s[0:1], 96
  s_load_dwordx2 s[14:15], s[0:1], 0
  s_load_dwordx2 s[48:49], s[0:1], 80
  v_lshrrev_b32 v3, 6, v0
  v_and_b32 v4, 63, v0
  s_nop 0
  v_readfirstlane_b32 s16, v3
  v_lshlrev_b32 v1, 4, v4
  s_and_b32 s17, s2, 7
  s_lshl_b32 s17, s17, 2
  s_lshr_b32 s18, s2, 3
  s_and_b32 s19, s18, 3
  s_add_u32 s17, s17, s19
  s_lshr_b32 s18, s18, 2
  s_waitcnt lgkmcnt(0)
  s_mov_b32 s4, s12
  s_mov_b32 s5, s13
  s_mov_b32 s6, 0x10000000
  s_mov_b32 s7, 0x20000
  s_mov_b32 s8, s14
  s_mov_b32 s9, s15
  s_mov_b32 s10, 2621440
  s_mov_b32 s11, 0x20000
  s_mov_b32 s20, 0
  s_mov_b32 s52, s48
  s_mov_b32 s53, s49
  s_mov_b32 s54, 2621440
  s_mov_b32 s55, 0x20000
  s_mul_i32 s21, s18, 5
  s_mul_i32 s21, s21, 196608
  s_add_u32 s24, s21, 29884416
  s_add_u32 s25, s24, 196608
  s_add_u32 s26, s25, 196608
  s_add_u32 s27, s26, 196608
  s_add_u32 s28, s27, 196608
  s_lshl_b32 s21, s17, 2
  s_add_u32 s21, s21, s16
  s_mul_i32 s22, s21, 196608
  s_add_u32 s22, s22, 125829120
  s_lshl_b32 s23, s16, 10
  v_add_u32 v2, s23, v1
  s_mul_i32 s29, s16, 5120
  s_add_u32 m0, s29, 0
  s_nop 0
  buffer_load_dwordx4 v2, s[4:7], s24 offen lds
  s_add_u32 m0, s29, 1024
  s_nop 0
  buffer_load_dwordx4 v2, s[4:7], s25 offen lds
  s_add_u32 m0, s29, 2048
  s_nop 0
  buffer_load_dwordx4 v2, s[4:7], s26 offen lds
  s_add_u32 m0, s29, 3072
  s_nop 0
  buffer_load_dwordx4 v2, s[4:7], s27 offen lds
  s_add_u32 m0, s29, 4096
  s_nop 0
  buffer_load_dwordx4 v2, s[4:7], s28 offen lds
  buffer_load_dwordx4 v[32:35], v1, s[4:7], s22 offen offset:0
  buffer_load_dwordx4 v[36:39], v1, s[4:7], s22 offen offset:1024
  buffer_load_dwordx4 v[40:43], v1, s[4:7], s22 offen offset:2048
  buffer_load_dwordx4 v[44:47], v1, s[4:7], s22 offen offset:3072
  v_add_u32 v2, 0x1000, v2
  s_add_u32 s22, s22, 4096
  s_add_u32 m0, s29, 20480
  s_nop 0
  buffer_load_dwordx4 v2, s[4:7], s24 offen lds
  s_add_u32 m0, s29, 21504
  s_nop 0
  buffer_load_dwordx4 v2, s[4:7], s25 offen lds
  s_add_u32 m0, s29, 22528
  s_nop 0
  buffer_load_dwordx4 v2, s[4:7], s26 offen lds
  s_add_u32 m0, s29, 23552
  s_nop 0
  buffer_load_dwordx4 v2, s[4:7], s27 offen lds
  s_add_u32 m0, s29, 24576
  s_nop 0
  buffer_load_dwordx4 v2, s[4:7], s28 offen lds
  buffer_load_dwordx4 v[48:51], v1, s[4:7], s22 offen offset:0
  buffer_load_dwordx4 v[52:55], v1, s[4:7], s22 offen offset:1024
  buffer_load_dwordx4 v[56:59], v1, s[4:7], s22 offen offset:2048
  buffer_load_dwordx4 v[60:63], v1, s[4:7], s22 offen offset:3072
  v_add_u32 v2, 0x1000, v2
  s_add_u32 s22, s22, 4096
  s_waitcnt vmcnt(9)
  s_barrier
  s_add_u32 m0, s29, 40960
  s_nop 0
  buffer_load_dwordx4 v2, s[4:7], s24 offen lds
  s_add_u32 m0, s29, 41984
  s_nop 0
  buffer_load_dwordx4 v2, s[4:7], s25 offen lds
  s_add_u32 m0, s29, 43008
  s_nop 0
  buffer_load_dwordx4 v2, s[4:7], s26 offen lds
  s_add_u32 m0, s29, 44032
  s_nop 0
  buffer_load_dwordx4 v2, s[4:7], s27 offen lds
  s_add_u32 m0, s29, 45056
  s_nop 0
  buffer_load_dwordx4 v2, s[4:7], s28 offen lds
  buffer_load_dwordx4 v[64:67], v1, s[4:7], s22 offen offset:0
  buffer_load_dwordx4 v[68:71], v1, s[4:7], s22 offen offset:1024
  buffer_load_dwordx4 v[72:75], v1, s[4:7], s22 offen offset:2048
  buffer_load_dwordx4 v[76:79], v1, s[4:7], s22 offen offset:3072
  v_add_u32 v2, 0x1000, v2
  s_add_u32 s22, s22, 4096
  ds_read_b128 v[80:83], v1 offset:0
  ds_read_b128 v[84:87], v1 offset:1024
  ds_read_b128 v[88:91], v1 offset:2048
  ds_read_b128 v[92:95], v1 offset:3072
  ds_read_b128 v[96:99], v1 offset:4096
  ds_read_b128 v[100:103], v1 offset:5120
  ds_read_b128 v[104:107], v1 offset:6144
  ds_read_b128 v[108:111], v1 offset:7168
  ds_read_b128 v[112:115], v1 offset:8192
  ds_read_b128 v[116:119], v1 offset:9216
  s_waitcnt lgkmcnt(5)
  v_mfma_f32_16x16x32_bf16 v[8:11], v[80:83], v[32:35], 0
  v_mfma_f32_16x16x32_bf16 v[12:15], v[84:87], v[32:35], 0
  v_mfma_f32_16x16x32_bf16 v[16:19], v[88:91], v[32:35], 0
  v_mfma_f32_16x16x32_bf16 v[20:23], v[92:95], v[32:35], 0
  v_mfma_f32_16x16x32_bf16 v[24:27], v[96:99], v[32:35], 0
  ds_read_b128 v[80:83], v1 offset:10240
  ds_read_b128 v[84:87], v1 offset:11264
  ds_read_b128 v[88:91], v1 offset:12288
  ds_read_b128 v[92:95], v1 offset:13312
  ds_read_b128 v[96:99], v1 offset:14336
  s_waitcnt lgkmcnt(5)
  v_mfma_f32_16x16x32_bf16 v[8:11], v[100:103], v[36:39], v[8:11]
  v_mfma_f32_16x16x32_bf16 v[12:15], v[104:107], v[36:39], v[12:15]
  v_mfma_f32_16x16x32_bf16 v[16:19], v[108:111], v[36:39], v[16:19]
  v_mfma_f32_16x16x32_bf16 v[20:23], v[112:115], v[36:39], v[20:23]
  v_mfma_f32_16x16x32_bf16 v[24:27], v[116:119], v[36:39], v[24:27]
  ds_read_b128 v[100:103], v1 offset:15360
  ds_read_b128 v[104:107], v1 offset:16384
  ds_read_b128 v[108:111], v1 offset:17408
  ds_read_b128 v[112:115], v1 offset:18432
  ds_read_b128 v[116:119], v1 offset:19456
  s_waitcnt lgkmcnt(5)
  v_mfma_f32_16x16x32_bf16 v[8:11], v[80:83], v[40:43], v[8:11]
  v_mfma_f32_16x16x32_bf16 v[12:15], v[84:87], v[40:43], v[12:15]
  v_mfma_f32_16x16x32_bf16 v[16:19], v[88:91], v[40:43], v[16:19]
  v_mfma_f32_16x16x32_bf16 v[20:23], v[92:95], v[40:43], v[20:23]
  v_mfma_f32_16x16x32_bf16 v[24:27], v[96:99], v[40:43], v[24:27]
  s_waitcnt lgkmcnt(0)
  v_mfma_f32_16x16x32_bf16 v[8:11], v[100:103], v[44:47], v[8:11]
  v_mfma_f32_16x16x32_bf16 v[12:15], v[104:107], v[44:47], v[12:15]
  v_mfma_f32_16x16x32_bf16 v[16:19], v[108:111], v[44:47], v[16:19]
  v_mfma_f32_16x16x32_bf16 v[20:23], v[112:115], v[44:47], v[20:23]
  v_mfma_f32_16x16x32_bf16 v[24:27], v[116:119], v[44:47], v[24:27]
  s_mov_b32 s30, 0
outa1_loop2:
  s_waitcnt vmcnt(9)
  s_barrier
  s_add_u32 m0, s29, 0
  s_nop 0
  buffer_load_dwordx4 v2, s[4:7], s24 offen lds
  s_add_u32 m0, s29, 1024
  s_nop 0
  buffer_load_dwordx4 v2, s[4:7], s25 offen lds
  s_add_u32 m0, s29, 2048
  s_nop 0
  buffer_load_dwordx4 v2, s[4:7], s26 offen lds
  s_add_u32 m0, s29, 3072
  s_nop 0
  buffer_load_dwordx4 v2, s[4:7], s27 offen lds
  s_add_u32 m0, s29, 4096
  s_nop 0
  buffer_load_dwordx4 v2, s[4:7], s28 offen lds
  buffer_load_dwordx4 v[32:35], v1, s[4:7], s22 offen offset:0
  buffer_load_dwordx4 v[36:39], v1, s[4:7], s22 offen offset:1024
  buffer_load_dwordx4 v[40:43], v1, s[4:7], s22 offen offset:2048
  buffer_load_dwordx4 v[44:47], v1, s[4:7], s22 offen offset:3072
  v_add_u32 v2, 0x1000, v2
  s_add_u32 s22, s22, 4096
  ds_read_b128 v[80:83], v1 offset:20480
  ds_read_b128 v[84:87], v1 offset:21504
  ds_read_b128 v[88:91], v1 offset:22528
  ds_read_b128 v[92:95], v1 offset:23552
  ds_read_b128 v[96:99], v1 offset:24576
  ds_read_b128 v[100:103], v1 offset:25600
  ds_read_b128 v[104:107], v1 offset:26624
  ds_read_b128 v[108:111], v1 offset:27648
  ds_read_b128 v[112:115], v1 offset:28672
  ds_read_b128 v[116:119], v1 offset:29696
  s_waitcnt lgkmcnt(5)
  v_mfma_f32_16x16x32_bf16 v[8:11], v[80:83], v[48:51], v[8:11]
  v_mfma_f32_16x16x32_bf16 v[12:15], v[84:87], v[48:51], v[12:15]
  v_mfma_f32_16x16x32_bf16 v[16:19], v[88:91], v[48:51], v[16:19]
  v_mfma_f32_16x16x32_bf16 v[20:23], v[92:95], v[48:51], v[20:23]
  v_mfma_f32_16x16x32_bf16 v[24:27], v[96:99], v[48:51], v[24:27]
  ds_read_b128 v[80:83], v1 offset:30720
  ds_read_b128 v[84:87], v1 offset:31744
  ds_read_b128 v[88:91], v1 offset:32768
  ds_read_b128 v[92:95], v1 offset:33792
  ds_read_b128 v[96:99], v1 offset:34816
  s_waitcnt lgkmcnt(5)
  v_mfma_f32_16x16x32_bf16 v[8:11], v[100:103], v[52:55], v[8:11]
  v_mfma_f32_16x16x32_bf16 v[12:15], v[104:107], v[52:55], v[12:15]
  v_mfma_f32_16x16x32_bf16 v[16:19], v[108:111], v[52:55], v[16:19]
  v_mfma_f32_16x16x32_bf16 v[20:23], v[112:115], v[52:55], v[20:23]
  v_mfma_f32_16x16x32_bf16 v[24:27], v[116:119], v[52:55], v[24:27]
  ds_read_b128 v[100:103], v1 offset:35840
  ds_read_b128 v[104:107], v1 offset:36864
  ds_read_b128 v[108:111], v1 offset:37888
  ds_read_b128 v[112:115], v1 offset:38912
  ds_read_b128 v[116:119], v1 offset:39936
  s_waitcnt lgkmcnt(5)
  v_mfma_f32_16x16x32_bf16 v[8:11], v[80:83], v[56:59], v[8:11]
  v_mfma_f32_16x16x32_bf16 v[12:15], v[84:87], v[56:59], v[12:15]
  v_mfma_f32_16x16x32_bf16 v[16:19], v[88:91], v[56:59], v[16:19]
  v_mfma_f32_16x16x32_bf16 v[20:23], v[92:95], v[56:59], v[20:23]
  v_mfma_f32_16x16x32_bf16 v[24:27], v[96:99], v[56:59], v[24:27]
  s_waitcnt lgkmcnt(0)
  v_mfma_f32_16x16x32_bf16 v[8:11], v[100:103], v[60:63], v[8:11]
  v_mfma_f32_16x16x32_bf16 v[12:15], v[104:107], v[60:63], v[12:15]
  v_mfma_f32_16x16x32_bf16 v[16:19], v[108:111], v[60:63], v[16:19]
  v_mfma_f32_16x16x32_bf16 v[20:23], v[112:115], v[60:63], v[20:23]
  v_mfma_f32_16x16x32_bf16 v[24:27], v[116:119], v[60:63], v[24:27]
  s_waitcnt vmcnt(9)
  s_barrier
  s_add_u32 m0, s29, 20480
  s_nop 0
  buffer_load_dwordx4 v2, s[4:7], s24 offen lds
  s_add_u32 m0, s29, 21504
  s_nop 0
  buffer_load_dwordx4 v2, s[4:7], s25 offen lds
  s_add_u32 m0, s29, 22528
  s_nop 0
  buffer_load_dwordx4 v2, s[4:7], s26 offen lds
  s_add_u32 m0, s29, 23552
  s_nop 0
  buffer_load_dwordx4 v2, s[4:7], s27 offen lds
  s_add_u32 m0, s29, 24576
  s_nop 0
  buffer_load_dwordx4 v2, s[4:7], s28 offen lds
  buffer_load_dwordx4 v[48:51], v1, s[4:7], s22 offen offset:0
  buffer_load_dwordx4 v[52:55], v1, s[4:7], s22 offen offset:1024
  buffer_load_dwordx4 v[56:59], v1, s[4:7], s22 offen offset:2048
  buffer_load_dwordx4 v[60:63], v1, s[4:7], s22 offen offset:3072
  v_add_u32 v2, 0x1000, v2
  s_add_u32 s22, s22, 4096
  ds_read_b128 v[80:83], v1 offset:40960
  ds_read_b128 v[84:87], v1 offset:41984
  ds_read_b128 v[88:91], v1 offset:43008
  ds_read_b128 v[92:95], v1 offset:44032
  ds_read_b128 v[96:99], v1 offset:45056
  ds_read_b128 v[100:103], v1 offset:46080
  ds_read_b128 v[104:107], v1 offset:47104
  ds_read_b128 v[108:111], v1 offset:48128
  ds_read_b128 v[112:115], v1 offset:49152
  ds_read_b128 v[116:119], v1 offset:50176
  s_waitcnt lgkmcnt(5)
  v_mfma_f32_16x16x32_bf16 v[8:11], v[80:83], v[64:67], v[8:11]
  v_mfma_f32_16x16x32_bf16 v[12:15], v[84:87], v[64:67], v[12:15]
  v_mfma_f32_16x16x32_bf16 v[16:19], v[88:91], v[64:67], v[16:19]
  v_mfma_f32_16x16x32_bf16 v[20:23], v[92:95], v[64:67], v[20:23]
  v_mfma_f32_16x16x32_bf16 v[24:27], v[96:99], v[64:67], v[24:27]
  ds_read_b128 v[80:83], v1 offset:51200
  ds_read_b128 v[84:87], v1 offset:52224
  ds_read_b128 v[88:91], v1 offset:53248
  ds_read_b128 v[92:95], v1 offset:54272
  ds_read_b128 v[96:99], v1 offset:55296
  s_waitcnt lgkmcnt(5)
  v_mfma_f32_16x16x32_bf16 v[8:11], v[100:103], v[68:71], v[8:11]
  v_mfma_f32_16x16x32_bf16 v[12:15], v[104:107], v[68:71], v[12:15]
  v_mfma_f32_16x16x32_bf16 v[16:19], v[108:111], v[68:71], v[16:19]
  v_mfma_f32_16x16x32_bf16 v[20:23], v[112:115], v[68:71], v[20:23]
  v_mfma_f32_16x16x32_bf16 v[24:27], v[116:119], v[68:71], v[24:27]
  ds_read_b128 v[100:103], v1 offset:56320
  ds_read_b128 v[104:107], v1 offset:57344
  ds_read_b128 v[108:111], v1 offset:58368
  ds_read_b128 v[112:115], v1 offset:59392
  ds_read_b128 v[116:119], v1 offset:60416
  s_waitcnt lgkmcnt(5)
  v_mfma_f32_16x16x32_bf16 v[8:11], v[80:83], v[72:75], v[8:11]
  v_mfma_f32_16x16x32_bf16 v[12:15], v[84:87], v[72:75], v[12:15]
  v_mfma_f32_16x16x32_bf16 v[16:19], v[88:91], v[72:75], v[16:19]
  v_mfma_f32_16x16x32_bf16 v[20:23], v[92:95], v[72:75], v[20:23]
  v_mfma_f32_16x16x32_bf16 v[24:27], v[96:99], v[72:75], v[24:27]
  s_waitcnt lgkmcnt(0)
  v_mfma_f32_16x16x32_bf16 v[8:11], v[100:103], v[76:79], v[8:11]
  v_mfma_f32_16x16x32_bf16 v[12:15], v[104:107], v[76:79], v[12:15]
  v_mfma_f32_16x16x32_bf16 v[16:19], v[108:111], v[76:79], v[16:19]
  v_mfma_f32_16x16x32_bf16 v[20:23], v[112:115], v[76:79], v[20:23]
  v_mfma_f32_16x16x32_bf16 v[24:27], v[116:119], v[76:79], v[24:27]
  s_waitcnt vmcnt(9)
  s_barrier
  s_add_u32 m0, s29, 40960
  s_nop 0
  buffer_load_dwordx4 v2, s[4:7], s24 offen lds
  s_add_u32 m0, s29, 41984
  s_nop 0
  buffer_load_dwordx4 v2, s[4:7], s25 offen lds
  s_add_u32 m0, s29, 43008
  s_nop 0
  buffer_load_dwordx4 v2, s[4:7], s26 offen lds
  s_add_u32 m0, s29, 44032
  s_nop 0
  buffer_load_dwordx4 v2, s[4:7], s27 offen lds
  s_add_u32 m0, s29, 45056
  s_nop 0
  buffer_load_dwordx4 v2, s[4:7], s28 offen lds
  buffer_load_dwordx4 v[64:67], v1, s[4:7], s22 offen offset:0
  buffer_load_dwordx4 v[68:71], v1, s[4:7], s22 offen offset:1024
  buffer_load_dwordx4 v[72:75], v1, s[4:7], s22 offen offset:2048
  buffer_load_dwordx4 v[76:79], v1, s[4:7], s22 offen offset:3072
  v_add_u32 v2, 0x1000, v2
  s_add_u32 s22, s22, 4096
  ds_read_b128 v[80:83], v1 offset:0
  ds_read_b128 v[84:87], v1 offset:1024
  ds_read_b128 v[88:91], v1 offset:2048
  ds_read_b128 v[92:95], v1 offset:3072
  ds_read_b128 v[96:99], v1 offset:4096
  ds_read_b128 v[100:103], v1 offset:5120
  ds_read_b128 v[104:107], v1 offset:6144
  ds_read_b128 v[108:111], v1 offset:7168
  ds_read_b128 v[112:115], v1 offset:8192
  ds_read_b128 v[116:119], v1 offset:9216
  s_waitcnt lgkmcnt(5)
  v_mfma_f32_16x16x32_bf16 v[8:11], v[80:83], v[32:35], v[8:11]
  v_mfma_f32_16x16x32_bf16 v[12:15], v[84:87], v[32:35], v[12:15]
  v_mfma_f32_16x16x32_bf16 v[16:19], v[88:91], v[32:35], v[16:19]
  v_mfma_f32_16x16x32_bf16 v[20:23], v[92:95], v[32:35], v[20:23]
  v_mfma_f32_16x16x32_bf16 v[24:27], v[96:99], v[32:35], v[24:27]
  ds_read_b128 v[80:83], v1 offset:10240
  ds_read_b128 v[84:87], v1 offset:11264
  ds_read_b128 v[88:91], v1 offset:12288
  ds_read_b128 v[92:95], v1 offset:13312
  ds_read_b128 v[96:99], v1 offset:14336
  s_waitcnt lgkmcnt(5)
  v_mfma_f32_16x16x32_bf16 v[8:11], v[100:103], v[36:39], v[8:11]
  v_mfma_f32_16x16x32_bf16 v[12:15], v[104:107], v[36:39], v[12:15]
  v_mfma_f32_16x16x32_bf16 v[16:19], v[108:111], v[36:39], v[16:19]
  v_mfma_f32_16x16x32_bf16 v[20:23], v[112:115], v[36:39], v[20:23]
  v_mfma_f32_16x16x32_bf16 v[24:27], v[116:119], v[36:39], v[24:27]
  ds_read_b128 v[100:103], v1 offset:15360
  ds_read_b128 v[104:107], v1 offset:16384
  ds_read_b128 v[108:111], v1 offset:17408
  ds_read_b128 v[112:115], v1 offset:18432
  ds_read_b128 v[116:119], v1 offset:19456
  s_waitcnt lgkmcnt(5)
  v_mfma_f32_16x16x32_bf16 v[8:11], v[80:83], v[40:43], v[8:11]
  v_mfma_f32_16x16x32_bf16 v[12:15], v[84:87], v[40:43], v[12:15]
  v_mfma_f32_16x16x32_bf16 v[16:19], v[88:91], v[40:43], v[16:19]
  v_mfma_f32_16x16x32_bf16 v[20:23], v[92:95], v[40:43], v[20:23]
  v_mfma_f32_16x16x32_bf16 v[24:27], v[96:99], v[40:43], v[24:27]
  s_waitcnt lgkmcnt(0)
  v_mfma_f32_16x16x32_bf16 v[8:11], v[100:103], v[44:47], v[8:11]
  v_mfma_f32_16x16x32_bf16 v[12:15], v[104:107], v[44:47], v[12:15]
  v_mfma_f32_16x16x32_bf16 v[16:19], v[108:111], v[44:47], v[16:19]
  v_mfma_f32_16x16x32_bf16 v[20:23], v[112:115], v[44:47], v[20:23]
  v_mfma_f32_16x16x32_bf16 v[24:27], v[116:119], v[44:47], v[24:27]
  s_add_u32 s30, s30, 1
  s_cmp_lt_u32 s30, 15
  s_cbranch_scc1 outa1_loop2
  s_waitcnt vmcnt(9)
  s_barrier
  ds_read_b128 v[80:83], v1 offset:20480
  ds_read_b128 v[84:87], v1 offset:21504
  ds_read_b128 v[88:91], v1 offset:22528
  ds_read_b128 v[92:95], v1 offset:23552
  ds_read_b128 v[96:99], v1 offset:24576
  ds_read_b128 v[100:103], v1 offset:25600
  ds_read_b128 v[104:107], v1 offset:26624
  ds_read_b128 v[108:111], v1 offset:27648
  ds_read_b128 v[112:115], v1 offset:28672
  ds_read_b128 v[116:119], v1 offset:29696
  s_waitcnt lgkmcnt(5)
  v_mfma_f32_16x16x32_bf16 v[8:11], v[80:83], v[48:51], v[8:11]
  v_mfma_f32_16x16x32_bf16 v[12:15], v[84:87], v[48:51], v[12:15]
  v_mfma_f32_16x16x32_bf16 v[16:19], v[88:91], v[48:51], v[16:19]
  v_mfma_f32_16x16x32_bf16 v[20:23], v[92:95], v[48:51], v[20:23]
  v_mfma_f32_16x16x32_bf16 v[24:27], v[96:99], v[48:51], v[24:27]
  ds_read_b128 v[80:83], v1 offset:30720
  ds_read_b128 v[84:87], v1 offset:31744
  ds_read_b128 v[88:91], v1 offset:32768
  ds_read_b128 v[92:95], v1 offset:33792
  ds_read_b128 v[96:99], v1 offset:34816
  s_waitcnt lgkmcnt(5)
  v_mfma_f32_16x16x32_bf16 v[8:11], v[100:103], v[52:55], v[8:11]
  v_mfma_f32_16x16x32_bf16 v[12:15], v[104:107], v[52:55], v[12:15]
  v_mfma_f32_16x16x32_bf16 v[16:19], v[108:111], v[52:55], v[16:19]
  v_mfma_f32_16x16x32_bf16 v[20:23], v[112:115], v[52:55], v[20:23]
  v_mfma_f32_16x16x32_bf16 v[24:27], v[116:119], v[52:55], v[24:27]
  ds_read_b128 v[100:103], v1 offset:35840
  ds_read_b128 v[104:107], v1 offset:36864
  ds_read_b128 v[108:111], v1 offset:37888
  ds_read_b128 v[112:115], v1 offset:38912
  ds_read_b128 v[116:119], v1 offset:39936
  s_waitcnt lgkmcnt(5)
  v_mfma_f32_16x16x32_bf16 v[8:11], v[80:83], v[56:59], v[8:11]
  v_mfma_f32_16x16x32_bf16 v[12:15], v[84:87], v[56:59], v[12:15]
  v_mfma_f32_16x16x32_bf16 v[16:19], v[88:91], v[56:59], v[16:19]
  v_mfma_f32_16x16x32_bf16 v[20:23], v[92:95], v[56:59], v[20:23]
  v_mfma_f32_16x16x32_bf16 v[24:27], v[96:99], v[56:59], v[24:27]
  s_waitcnt lgkmcnt(0)
  v_mfma_f32_16x16x32_bf16 v[8:11], v[100:103], v[60:63], v[8:11]
  v_mfma_f32_16x16x32_bf16 v[12:15], v[104:107], v[60:63], v[12:15]
  v_mfma_f32_16x16x32_bf16 v[16:19], v[108:111], v[60:63], v[16:19]
  v_mfma_f32_16x16x32_bf16 v[20:23], v[112:115], v[60:63], v[20:23]
  v_mfma_f32_16x16x32_bf16 v[24:27], v[116:119], v[60:63], v[24:27]
  s_waitcnt vmcnt(0)
  s_barrier
  ds_read_b128 v[80:83], v1 offset:40960
  ds_read_b128 v[84:87], v1 offset:41984
  ds_read_b128 v[88:91], v1 offset:43008
  ds_read_b128 v[92:95], v1 offset:44032
  ds_read_b128 v[96:99], v1 offset:45056
  ds_read_b128 v[100:103], v1 offset:46080
  ds_read_b128 v[104:107], v1 offset:47104
  ds_read_b128 v[108:111], v1 offset:48128
  ds_read_b128 v[112:115], v1 offset:49152
  ds_read_b128 v[116:119], v1 offset:50176
  s_waitcnt lgkmcnt(5)
  v_mfma_f32_16x16x32_bf16 v[8:11], v[80:83], v[64:67], v[8:11]
  v_mfma_f32_16x16x32_bf16 v[12:15], v[84:87], v[64:67], v[12:15]
  v_mfma_f32_16x16x32_bf16 v[16:19], v[88:91], v[64:67], v[16:19]
  v_mfma_f32_16x16x32_bf16 v[20:23], v[92:95], v[64:67], v[20:23]
  v_mfma_f32_16x16x32_bf16 v[24:27], v[96:99], v[64:67], v[24:27]
  ds_read_b128 v[80:83], v1 offset:51200
  ds_read_b128 v[84:87], v1 offset:52224
  ds_read_b128 v[88:91], v1 offset:53248
  ds_read_b128 v[92:95], v1 offset:54272
  ds_read_b128 v[96:99], v1 offset:55296
  s_waitcnt lgkmcnt(5)
  v_mfma_f32_16x16x32_bf16 v[8:11], v[100:103], v[68:71], v[8:11]
  v_mfma_f32_16x16x32_bf16 v[12:15], v[104:107], v[68:71], v[12:15]
  v_mfma_f32_16x16x32_bf16 v[16:19], v[108:111], v[68:71], v[16:19]
  v_mfma_f32_16x16x32_bf16 v[20:23], v[112:115], v[68:71], v[20:23]
  v_mfma_f32_16x16x32_bf16 v[24:27], v[116:119], v[68:71], v[24:27]
  ds_read_b128 v[100:103], v1 offset:56320
  ds_read_b128 v[104:107], v1 offset:57344
  ds_read_b128 v[108:111], v1 offset:58368
  ds_read_b128 v[112:115], v1 offset:59392
  ds_read_b128 v[116:119], v1 offset:60416
  s_waitcnt lgkmcnt(5)
  v_mfma_f32_16x16x32_bf16 v[8:11], v[80:83], v[72:75], v[8:11]
  v_mfma_f32_16x16x32_bf16 v[12:15], v[84:87], v[72:75], v[12:15]
  v_mfma_f32_16x16x32_bf16 v[16:19], v[88:91], v[72:75], v[16:19]
  v_mfma_f32_16x16x32_bf16 v[20:23], v[92:95], v[72:75], v[20:23]
  v_mfma_f32_16x16x32_bf16 v[24:27], v[96:99], v[72:75], v[24:27]
  s_waitcnt lgkmcnt(0)
  v_mfma_f32_16x16x32_bf16 v[8:11], v[100:103], v[76:79], v[8:11]
  v_mfma_f32_16x16x32_bf16 v[12:15], v[104:107], v[76:79], v[12:15]
  v_mfma_f32_16x16x32_bf16 v[16:19], v[108:111], v[76:79], v[16:19]
  v_mfma_f32_16x16x32_bf16 v[20:23], v[112:115], v[76:79], v[20:23]
  v_mfma_f32_16x16x32_bf16 v[24:27], v[116:119], v[76:79], v[24:27]
  v_and_b32 v3, 63, v0
  v_and_b32 v4, 15, v3
  v_lshrrev_b32 v3, 4, v3
  s_lshl_b32 s21, s17, 6
  s_lshl_b32 s23, s16, 4
  s_add_u32 s21, s21, s23
  v_add_u32 v4, s21, v4
  v_mul_u32_u24 v6, 1280, v4
  v_lshl_add_u32 v6, v3, 4, v6
  s_mul_i32 s21, s18, 5
  s_add_u32 s23, s21, 0
  s_lshr_b32 s31, s23, 1
  s_lshl_b32 s31, s31, 6
  s_and_b32 s23, s23, 1
  s_lshl_b32 s23, s23, 3
  s_add_u32 s32, s31, s23
  s_add_u32 s40, s32, s20
  buffer_load_dwordx2 v[32:33], v6, s[8:11], s40 offen
  s_add_u32 s23, s21, 1
  s_lshr_b32 s31, s23, 1
  s_lshl_b32 s31, s31, 6
  s_and_b32 s23, s23, 1
  s_lshl_b32 s23, s23, 3
  s_add_u32 s33, s31, s23
  s_add_u32 s41, s33, s20
  buffer_load_dwordx2 v[34:35], v6, s[8:11], s41 offen
  s_add_u32 s23, s21, 2
  s_lshr_b32 s31, s23, 1
  s_lshl_b32 s31, s31, 6
  s_and_b32 s23, s23, 1
  s_lshl_b32 s23, s23, 3
  s_add_u32 s34, s31, s23
  s_add_u32 s42, s34, s20
  buffer_load_dwordx2 v[36:37], v6, s[8:11], s42 offen
  s_add_u32 s23, s21, 3
  s_lshr_b32 s31, s23, 1
  s_lshl_b32 s31, s31, 6
  s_and_b32 s23, s23, 1
  s_lshl_b32 s23, s23, 3
  s_add_u32 s35, s31, s23
  s_add_u32 s43, s35, s20
  buffer_load_dwordx2 v[38:39], v6, s[8:11], s43 offen
  s_add_u32 s23, s21, 4
  s_lshr_b32 s31, s23, 1
  s_lshl_b32 s31, s31, 6
  s_and_b32 s23, s23, 1
  s_lshl_b32 s23, s23, 3
  s_add_u32 s36, s31, s23
  s_add_u32 s44, s36, s20
  buffer_load_dwordx2 v[40:41], v6, s[8:11], s44 offen
  s_waitcnt vmcnt(0)
  v_cvt_pk_bf16_f32 v80, v8, v9
  v_cvt_pk_bf16_f32 v81, v10, v11
  v_lshlrev_b32 v8, 16, v80
  v_and_b32 v9, 0xffff0000, v80
  v_lshlrev_b32 v10, 16, v81
  v_and_b32 v11, 0xffff0000, v81
  v_lshlrev_b32 v82, 16, v32
  v_and_b32 v83, 0xffff0000, v32
  v_lshlrev_b32 v84, 16, v33
  v_and_b32 v85, 0xffff0000, v33
  v_add_f32 v8, v8, v82
  v_add_f32 v9, v9, v83
  v_add_f32 v10, v10, v84
  v_add_f32 v11, v11, v85
  v_cvt_pk_bf16_f32 v32, v8, v9
  v_cvt_pk_bf16_f32 v33, v10, v11
  s_add_u32 s23, s32, 150994944
  buffer_store_dwordx2 v[32:33], v6, s[4:7], s23 offen
  v_cvt_pk_bf16_f32 v80, v12, v13
  v_cvt_pk_bf16_f32 v81, v14, v15
  v_lshlrev_b32 v12, 16, v80
  v_and_b32 v13, 0xffff0000, v80
  v_lshlrev_b32 v14, 16, v81
  v_and_b32 v15, 0xffff0000, v81
  v_lshlrev_b32 v82, 16, v34
  v_and_b32 v83, 0xffff0000, v34
  v_lshlrev_b32 v84, 16, v35
  v_and_b32 v85, 0xffff0000, v35
  v_add_f32 v12, v12, v82
  v_add_f32 v13, v13, v83
  v_add_f32 v14, v14, v84
  v_add_f32 v15, v15, v85
  v_cvt_pk_bf16_f32 v34, v12, v13
  v_cvt_pk_bf16_f32 v35, v14, v15
  s_add_u32 s23, s33, 150994944
  buffer_store_dwordx2 v[34:35], v6, s[4:7], s23 offen
  v_cvt_pk_bf16_f32 v80, v16, v17
  v_cvt_pk_bf16_f32 v81, v18, v19
  v_lshlrev_b32 v16, 16, v80
  v_and_b32 v17, 0xffff0000, v80
  v_lshlrev_b32 v18, 16, v81
  v_and_b32 v19, 0xffff0000, v81
  v_lshlrev_b32 v82, 16, v36
  v_and_b32 v83, 0xffff0000, v36
  v_lshlrev_b32 v84, 16, v37
  v_and_b32 v85, 0xffff0000, v37
  v_add_f32 v16, v16, v82
  v_add_f32 v17, v17, v83
  v_add_f32 v18, v18, v84
  v_add_f32 v19, v19, v85
  v_cvt_pk_bf16_f32 v36, v16, v17
  v_cvt_pk_bf16_f32 v37, v18, v19
  s_add_u32 s23, s34, 150994944
  buffer_store_dwordx2 v[36:37], v6, s[4:7], s23 offen
  v_cvt_pk_bf16_f32 v80, v20, v21
  v_cvt_pk_bf16_f32 v81, v22, v23
  v_lshlrev_b32 v20, 16, v80
  v_and_b32 v21, 0xffff0000, v80
  v_lshlrev_b32 v22, 16, v81
  v_and_b32 v23, 0xffff0000, v81
  v_lshlrev_b32 v82, 16, v38
  v_and_b32 v83, 0xffff0000, v38
  v_lshlrev_b32 v84, 16, v39
  v_and_b32 v85, 0xffff0000, v39
  v_add_f32 v20, v20, v82
  v_add_f32 v21, v21, v83
  v_add_f32 v22, v22, v84
  v_add_f32 v23, v23, v85
  v_cvt_pk_bf16_f32 v38, v20, v21
  v_cvt_pk_bf16_f32 v39, v22, v23
  s_add_u32 s23, s35, 150994944
  buffer_store_dwordx2 v[38:39], v6, s[4:7], s23 offen
  v_cvt_pk_bf16_f32 v80, v24, v25
  v_cvt_pk_bf16_f32 v81, v26, v27
  v_lshlrev_b32 v24, 16, v80
  v_and_b32 v25, 0xffff0000, v80
  v_lshlrev_b32 v26, 16, v81
  v_and_b32 v27, 0xffff0000, v81
  v_lshlrev_b32 v82, 16, v40
  v_and_b32 v83, 0xffff0000, v40
  v_lshlrev_b32 v84, 16, v41
  v_and_b32 v85, 0xffff0000, v41
  v_add_f32 v24, v24, v82
  v_add_f32 v25, v25, v83
  v_add_f32 v26, v26, v84
  v_add_f32 v27, v27, v85
  v_cvt_pk_bf16_f32 v40, v24, v25
  v_cvt_pk_bf16_f32 v41, v26, v27
  s_add_u32 s23, s36, 150994944
  buffer_store_dwordx2 v[40:41], v6, s[4:7], s23 offen
outa1_exit1:
  s_endpgm
.globl outa2_kernel
.p2align 8
.type outa2_kernel,@function
outa2_kernel:
  s_cmp_ge_u32 s2, 256
  s_cbranch_scc1 outa2_exit1
  s_load_dwordx2 s[12:13], s[0:1], 96
  s_load_dwordx2 s[14:15], s[0:1], 0
  s_load_dwordx2 s[48:49], s[0:1], 80
  v_lshrrev_b32 v3, 6, v0
  v_and_b32 v4, 63, v0
  s_nop 0
  v_readfirstlane_b32 s16, v3
  v_lshlrev_b32 v1, 4, v4
  s_and_b32 s17, s2, 7
  s_lshl_b32 s17, s17, 2
  s_lshr_b32 s18, s2, 3
  s_and_b32 s19, s18, 3
  s_add_u32 s17, s17, s19
  s_lshr_b32 s18, s18, 2
  s_waitcnt lgkmcnt(0)
  s_mov_b32 s4, s12
  s_mov_b32 s5, s13
  s_mov_b32 s6, 0x10000000
  s_mov_b32 s7, 0x20000
  s_mov_b32 s8, s12
  s_mov_b32 s9, s13
  s_mov_b32 s10, 0x10000000
  s_mov_b32 s11, 0x20000
  s_mov_b32 s20, 150994944
  s_mov_b32 s52, s48
  s_mov_b32 s53, s49
  s_mov_b32 s54, 2621440
  s_mov_b32 s55, 0x20000
  s_mul_i32 s21, s18, 5
  s_mul_i32 s21, s21, 196608
  s_add_u32 s24, s21, 29884416
  s_add_u32 s25, s24, 196608
  s_add_u32 s26, s25, 196608
  s_add_u32 s27, s26, 196608
  s_add_u32 s28, s27, 196608
  s_lshl_b32 s21, s17, 2
  s_add_u32 s21, s21, s16
  s_mul_i32 s22, s21, 196608
  s_add_u32 s22, s22, 125829120
  s_lshl_b32 s23, s16, 10
  v_add_u32 v2, s23, v1
  s_mul_i32 s29, s16, 5120
  s_add_u32 m0, s29, 0
  s_nop 0
  buffer_load_dwordx4 v2, s[4:7], s24 offen lds
  s_add_u32 m0, s29, 1024
  s_nop 0
  buffer_load_dwordx4 v2, s[4:7], s25 offen lds
  s_add_u32 m0, s29, 2048
  s_nop 0
  buffer_load_dwordx4 v2, s[4:7], s26 offen lds
  s_add_u32 m0, s29, 3072
  s_nop 0
  buffer_load_dwordx4 v2, s[4:7], s27 offen lds
  s_add_u32 m0, s29, 4096
  s_nop 0
  buffer_load_dwordx4 v2, s[4:7], s28 offen lds
  buffer_load_dwordx4 v[32:35], v1, s[4:7], s22 offen offset:0
  buffer_load_dwordx4 v[36:39], v1, s[4:7], s22 offen offset:1024
  buffer_load_dwordx4 v[40:43], v1, s[4:7], s22 offen offset:2048
  buffer_load_dwordx4 v[44:47], v1, s[4:7], s22 offen offset:3072
  v_add_u32 v2, 0x1000, v2
  s_add_u32 s22, s22, 4096
  s_add_u32 m0, s29, 20480
  s_nop 0
  buffer_load_dwordx4 v2, s[4:7], s24 offen lds
  s_add_u32 m0, s29, 21504
  s_nop 0
  buffer_load_dwordx4 v2, s[4:7], s25 offen lds
  s_add_u32 m0, s29, 22528
  s_nop 0
  buffer_load_dwordx4 v2, s[4:7], s26 offen lds
  s_add_u32 m0, s29, 23552
  s_nop 0
  buffer_load_dwordx4 v2, s[4:7], s27 offen lds
  s_add_u32 m0, s29, 24576
  s_nop 0
  buffer_load_dwordx4 v2, s[4:7], s28 offen lds
  buffer_load_dwordx4 v[48:51], v1, s[4:7], s22 offen offset:0
  buffer_load_dwordx4 v[52:55], v1, s[4:7], s22 offen offset:1024
  buffer_load_dwordx4 v[56:59], v1, s[4:7], s22 offen offset:2048
  buffer_load_dwordx4 v[60:63], v1, s[4:7], s22 offen offset:3072
  v_add_u32 v2, 0x1000, v2
  s_add_u32 s22, s22, 4096
  s_waitcnt vmcnt(9)
  s_barrier
  s_add_u32 m0, s29, 40960
  s_nop 0
  buffer_load_dwordx4 v2, s[4:7], s24 offen lds
  s_add_u32 m0, s29, 41984
  s_nop 0
  buffer_load_dwordx4 v2, s[4:7], s25 offen lds
  s_add_u32 m0, s29, 43008
  s_nop 0
  buffer_load_dwordx4 v2, s[4:7], s26 offen lds
  s_add_u32 m0, s29, 44032
  s_nop 0
  buffer_load_dwordx4 v2, s[4:7], s27 offen lds
  s_add_u32 m0, s29, 45056
  s_nop 0
  buffer_load_dwordx4 v2, s[4:7], s28 offen lds
  buffer_load_dwordx4 v[64:67], v1, s[4:7], s22 offen offset:0
  buffer_load_dwordx4 v[68:71], v1, s[4:7], s22 offen offset:1024
  buffer_load_dwordx4 v[72:75], v1, s[4:7], s22 offen offset:2048
  buffer_load_dwordx4 v[76:79], v1, s[4:7], s22 offen offset:3072
  v_add_u32 v2, 0x1000, v2
  s_add_u32 s22, s22, 4096
  ds_read_b128 v[80:83], v1 offset:0
  ds_read_b128 v[84:87], v1 offset:1024
  ds_read_b128 v[88:91], v1 offset:2048
  ds_read_b128 v[92:95], v1 offset:3072
  ds_read_b128 v[96:99], v1 offset:4096
  ds_read_b128 v[100:103], v1 offset:5120
  ds_read_b128 v[104:107], v1 offset:6144
  ds_read_b128 v[108:111], v1 offset:7168
  ds_read_b128 v[112:115], v1 offset:8192
  ds_read_b128 v[116:119], v1 offset:9216
  s_waitcnt lgkmcnt(5)
  v_mfma_f32_16x16x32_bf16 v[8:11], v[80:83], v[32:35], 0
  v_mfma_f32_16x16x32_bf16 v[12:15], v[84:87], v[32:35], 0
  v_mfma_f32_16x16x32_bf16 v[16:19], v[88:91], v[32:35], 0
  v_mfma_f32_16x16x32_bf16 v[20:23], v[92:95], v[32:35], 0
  v_mfma_f32_16x16x32_bf16 v[24:27], v[96:99], v[32:35], 0
  ds_read_b128 v[80:83], v1 offset:10240
  ds_read_b128 v[84:87], v1 offset:11264
  ds_read_b128 v[88:91], v1 offset:12288
  ds_read_b128 v[92:95], v1 offset:13312
  ds_read_b128 v[96:99], v1 offset:14336
  s_waitcnt lgkmcnt(5)
  v_mfma_f32_16x16x32_bf16 v[8:11], v[100:103], v[36:39], v[8:11]
  v_mfma_f32_16x16x32_bf16 v[12:15], v[104:107], v[36:39], v[12:15]
  v_mfma_f32_16x16x32_bf16 v[16:19], v[108:111], v[36:39], v[16:19]
  v_mfma_f32_16x16x32_bf16 v[20:23], v[112:115], v[36:39], v[20:23]
  v_mfma_f32_16x16x32_bf16 v[24:27], v[116:119], v[36:39], v[24:27]
  ds_read_b128 v[100:103], v1 offset:15360
  ds_read_b128 v[104:107], v1 offset:16384
  ds_read_b128 v[108:111], v1 offset:17408
  ds_read_b128 v[112:115], v1 offset:18432
  ds_read_b128 v[116:119], v1 offset:19456
  s_waitcnt lgkmcnt(5)
  v_mfma_f32_16x16x32_bf16 v[8:11], v[80:83], v[40:43], v[8:11]
  v_mfma_f32_16x16x32_bf16 v[12:15], v[84:87], v[40:43], v[12:15]
  v_mfma_f32_16x16x32_bf16 v[16:19], v[88:91], v[40:43], v[16:19]
  v_mfma_f32_16x16x32_bf16 v[20:23], v[92:95], v[40:43], v[20:23]
  v_mfma_f32_16x16x32_bf16 v[24:27], v[96:99], v[40:43], v[24:27]
  s_waitcnt lgkmcnt(0)
  v_mfma_f32_16x16x32_bf16 v[8:11], v[100:103], v[44:47], v[8:11]
  v_mfma_f32_16x16x32_bf16 v[12:15], v[104:107], v[44:47], v[12:15]
  v_mfma_f32_16x16x32_bf16 v[16:19], v[108:111], v[44:47], v[16:19]
  v_mfma_f32_16x16x32_bf16 v[20:23], v[112:115], v[44:47], v[20:23]
  v_mfma_f32_16x16x32_bf16 v[24:27], v[116:119], v[44:47], v[24:27]
  s_mov_b32 s30, 0
outa2_loop2:
  s_waitcnt vmcnt(9)
  s_barrier
  s_add_u32 m0, s29, 0
  s_nop 0
  buffer_load_dwordx4 v2, s[4:7], s24 offen lds
  s_add_u32 m0, s29, 1024
  s_nop 0
  buffer_load_dwordx4 v2, s[4:7], s25 offen lds
  s_add_u32 m0, s29, 2048
  s_nop 0
  buffer_load_dwordx4 v2, s[4:7], s26 offen lds
  s_add_u32 m0, s29, 3072
  s_nop 0
  buffer_load_dwordx4 v2, s[4:7], s27 offen lds
  s_add_u32 m0, s29, 4096
  s_nop 0
  buffer_load_dwordx4 v2, s[4:7], s28 offen lds
  buffer_load_dwordx4 v[32:35], v1, s[4:7], s22 offen offset:0
  buffer_load_dwordx4 v[36:39], v1, s[4:7], s22 offen offset:1024
  buffer_load_dwordx4 v[40:43], v1, s[4:7], s22 offen offset:2048
  buffer_load_dwordx4 v[44:47], v1, s[4:7], s22 offen offset:3072
  v_add_u32 v2, 0x1000, v2
  s_add_u32 s22, s22, 4096
  ds_read_b128 v[80:83], v1 offset:20480
  ds_read_b128 v[84:87], v1 offset:21504
  ds_read_b128 v[88:91], v1 offset:22528
  ds_read_b128 v[92:95], v1 offset:23552
  ds_read_b128 v[96:99], v1 offset:24576
  ds_read_b128 v[100:103], v1 offset:25600
  ds_read_b128 v[104:107], v1 offset:26624
  ds_read_b128 v[108:111], v1 offset:27648
  ds_read_b128 v[112:115], v1 offset:28672
  ds_read_b128 v[116:119], v1 offset:29696
  s_waitcnt lgkmcnt(5)
  v_mfma_f32_16x16x32_bf16 v[8:11], v[80:83], v[48:51], v[8:11]
  v_mfma_f32_16x16x32_bf16 v[12:15], v[84:87], v[48:51], v[12:15]
  v_mfma_f32_16x16x32_bf16 v[16:19], v[88:91], v[48:51], v[16:19]
  v_mfma_f32_16x16x32_bf16 v[20:23], v[92:95], v[48:51], v[20:23]
  v_mfma_f32_16x16x32_bf16 v[24:27], v[96:99], v[48:51], v[24:27]
  ds_read_b128 v[80:83], v1 offset:30720
  ds_read_b128 v[84:87], v1 offset:31744
  ds_read_b128 v[88:91], v1 offset:32768
  ds_read_b128 v[92:95], v1 offset:33792
  ds_read_b128 v[96:99], v1 offset:34816
  s_waitcnt lgkmcnt(5)
  v_mfma_f32_16x16x32_bf16 v[8:11], v[100:103], v[52:55], v[8:11]
  v_mfma_f32_16x16x32_bf16 v[12:15], v[104:107], v[52:55], v[12:15]
  v_mfma_f32_16x16x32_bf16 v[16:19], v[108:111], v[52:55], v[16:19]
  v_mfma_f32_16x16x32_bf16 v[20:23], v[112:115], v[52:55], v[20:23]
  v_mfma_f32_16x16x32_bf16 v[24:27], v[116:119], v[52:55], v[24:27]
  ds_read_b128 v[100:103], v1 offset:35840
  ds_read_b128 v[104:107], v1 offset:36864
  ds_read_b128 v[108:111], v1 offset:37888
  ds_read_b128 v[112:115], v1 offset:38912
  ds_read_b128 v[116:119], v1 offset:39936
  s_waitcnt lgkmcnt(5)
  v_mfma_f32_16x16x32_bf16 v[8:11], v[80:83], v[56:59], v[8:11]
  v_mfma_f32_16x16x32_bf16 v[12:15], v[84:87], v[56:59], v[12:15]
  v_mfma_f32_16x16x32_bf16 v[16:19], v[88:91], v[56:59], v[16:19]
  v_mfma_f32_16x16x32_bf16 v[20:23], v[92:95], v[56:59], v[20:23]
  v_mfma_f32_16x16x32_bf16 v[24:27], v[96:99], v[56:59], v[24:27]
  s_waitcnt lgkmcnt(0)
  v_mfma_f32_16x16x32_bf16 v[8:11], v[100:103], v[60:63], v[8:11]
  v_mfma_f32_16x16x32_bf16 v[12:15], v[104:107], v[60:63], v[12:15]
  v_mfma_f32_16x16x32_bf16 v[16:19], v[108:111], v[60:63], v[16:19]
  v_mfma_f32_16x16x32_bf16 v[20:23], v[112:115], v[60:63], v[20:23]
  v_mfma_f32_16x16x32_bf16 v[24:27], v[116:119], v[60:63], v[24:27]
  s_waitcnt vmcnt(9)
  s_barrier
  s_add_u32 m0, s29, 20480
  s_nop 0
  buffer_load_dwordx4 v2, s[4:7], s24 offen lds
  s_add_u32 m0, s29, 21504
  s_nop 0
  buffer_load_dwordx4 v2, s[4:7], s25 offen lds
  s_add_u32 m0, s29, 22528
  s_nop 0
  buffer_load_dwordx4 v2, s[4:7], s26 offen lds
  s_add_u32 m0, s29, 23552
  s_nop 0
  buffer_load_dwordx4 v2, s[4:7], s27 offen lds
  s_add_u32 m0, s29, 24576
  s_nop 0
  buffer_load_dwordx4 v2, s[4:7], s28 offen lds
  buffer_load_dwordx4 v[48:51], v1, s[4:7], s22 offen offset:0
  buffer_load_dwordx4 v[52:55], v1, s[4:7], s22 offen offset:1024
  buffer_load_dwordx4 v[56:59], v1, s[4:7], s22 offen offset:2048
  buffer_load_dwordx4 v[60:63], v1, s[4:7], s22 offen offset:3072
  v_add_u32 v2, 0x1000, v2
  s_add_u32 s22, s22, 4096
  ds_read_b128 v[80:83], v1 offset:40960
  ds_read_b128 v[84:87], v1 offset:41984
  ds_read_b128 v[88:91], v1 offset:43008
  ds_read_b128 v[92:95], v1 offset:44032
  ds_read_b128 v[96:99], v1 offset:45056
  ds_read_b128 v[100:103], v1 offset:46080
  ds_read_b128 v[104:107], v1 offset:47104
  ds_read_b128 v[108:111], v1 offset:48128
  ds_read_b128 v[112:115], v1 offset:49152
  ds_read_b128 v[116:119], v1 offset:50176
  s_waitcnt lgkmcnt(5)
  v_mfma_f32_16x16x32_bf16 v[8:11], v[80:83], v[64:67], v[8:11]
  v_mfma_f32_16x16x32_bf16 v[12:15], v[84:87], v[64:67], v[12:15]
  v_mfma_f32_16x16x32_bf16 v[16:19], v[88:91], v[64:67], v[16:19]
  v_mfma_f32_16x16x32_bf16 v[20:23], v[92:95], v[64:67], v[20:23]
  v_mfma_f32_16x16x32_bf16 v[24:27], v[96:99], v[64:67], v[24:27]
  ds_read_b128 v[80:83], v1 offset:51200
  ds_read_b128 v[84:87], v1 offset:52224
  ds_read_b128 v[88:91], v1 offset:53248
  ds_read_b128 v[92:95], v1 offset:54272
  ds_read_b128 v[96:99], v1 offset:55296
  s_waitcnt lgkmcnt(5)
  v_mfma_f32_16x16x32_bf16 v[8:11], v[100:103], v[68:71], v[8:11]
  v_mfma_f32_16x16x32_bf16 v[12:15], v[104:107], v[68:71], v[12:15]
  v_mfma_f32_16x16x32_bf16 v[16:19], v[108:111], v[68:71], v[16:19]
  v_mfma_f32_16x16x32_bf16 v[20:23], v[112:115], v[68:71], v[20:23]
  v_mfma_f32_16x16x32_bf16 v[24:27], v[116:119], v[68:71], v[24:27]
  ds_read_b128 v[100:103], v1 offset:56320
  ds_read_b128 v[104:107], v1 offset:57344
  ds_read_b128 v[108:111], v1 offset:58368
  ds_read_b128 v[112:115], v1 offset:59392
  ds_read_b128 v[116:119], v1 offset:60416
  s_waitcnt lgkmcnt(5)
  v_mfma_f32_16x16x32_bf16 v[8:11], v[80:83], v[72:75], v[8:11]
  v_mfma_f32_16x16x32_bf16 v[12:15], v[84:87], v[72:75], v[12:15]
  v_mfma_f32_16x16x32_bf16 v[16:19], v[88:91], v[72:75], v[16:19]
  v_mfma_f32_16x16x32_bf16 v[20:23], v[92:95], v[72:75], v[20:23]
  v_mfma_f32_16x16x32_bf16 v[24:27], v[96:99], v[72:75], v[24:27]
  s_waitcnt lgkmcnt(0)
  v_mfma_f32_16x16x32_bf16 v[8:11], v[100:103], v[76:79], v[8:11]
  v_mfma_f32_16x16x32_bf16 v[12:15], v[104:107], v[76:79], v[12:15]
  v_mfma_f32_16x16x32_bf16 v[16:19], v[108:111], v[76:79], v[16:19]
  v_mfma_f32_16x16x32_bf16 v[20:23], v[112:115], v[76:79], v[20:23]
  v_mfma_f32_16x16x32_bf16 v[24:27], v[116:119], v[76:79], v[24:27]
  s_waitcnt vmcnt(9)
  s_barrier
  s_add_u32 m0, s29, 40960
  s_nop 0
  buffer_load_dwordx4 v2, s[4:7], s24 offen lds
  s_add_u32 m0, s29, 41984
  s_nop 0
  buffer_load_dwordx4 v2, s[4:7], s25 offen lds
  s_add_u32 m0, s29, 43008
  s_nop 0
  buffer_load_dwordx4 v2, s[4:7], s26 offen lds
  s_add_u32 m0, s29, 44032
  s_nop 0
  buffer_load_dwordx4 v2, s[4:7], s27 offen lds
  s_add_u32 m0, s29, 45056
  s_nop 0
  buffer_load_dwordx4 v2, s[4:7], s28 offen lds
  buffer_load_dwordx4 v[64:67], v1, s[4:7], s22 offen offset:0
  buffer_load_dwordx4 v[68:71], v1, s[4:7], s22 offen offset:1024
  buffer_load_dwordx4 v[72:75], v1, s[4:7], s22 offen offset:2048
  buffer_load_dwordx4 v[76:79], v1, s[4:7], s22 offen offset:3072
  v_add_u32 v2, 0x1000, v2
  s_add_u32 s22, s22, 4096
  ds_read_b128 v[80:83], v1 offset:0
  ds_read_b128 v[84:87], v1 offset:1024
  ds_read_b128 v[88:91], v1 offset:2048
  ds_read_b128 v[92:95], v1 offset:3072
  ds_read_b128 v[96:99], v1 offset:4096
  ds_read_b128 v[100:103], v1 offset:5120
  ds_read_b128 v[104:107], v1 offset:6144
  ds_read_b128 v[108:111], v1 offset:7168
  ds_read_b128 v[112:115], v1 offset:8192
  ds_read_b128 v[116:119], v1 offset:9216
  s_waitcnt lgkmcnt(5)
  v_mfma_f32_16x16x32_bf16 v[8:11], v[80:83], v[32:35], v[8:11]
  v_mfma_f32_16x16x32_bf16 v[12:15], v[84:87], v[32:35], v[12:15]
  v_mfma_f32_16x16x32_bf16 v[16:19], v[88:91], v[32:35], v[16:19]
  v_mfma_f32_16x16x32_bf16 v[20:23], v[92:95], v[32:35], v[20:23]
  v_mfma_f32_16x16x32_bf16 v[24:27], v[96:99], v[32:35], v[24:27]
  ds_read_b128 v[80:83], v1 offset:10240
  ds_read_b128 v[84:87], v1 offset:11264
  ds_read_b128 v[88:91], v1 offset:12288
  ds_read_b128 v[92:95], v1 offset:13312
  ds_read_b128 v[96:99], v1 offset:14336
  s_waitcnt lgkmcnt(5)
  v_mfma_f32_16x16x32_bf16 v[8:11], v[100:103], v[36:39], v[8:11]
  v_mfma_f32_16x16x32_bf16 v[12:15], v[104:107], v[36:39], v[12:15]
  v_mfma_f32_16x16x32_bf16 v[16:19], v[108:111], v[36:39], v[16:19]
  v_mfma_f32_16x16x32_bf16 v[20:23], v[112:115], v[36:39], v[20:23]
  v_mfma_f32_16x16x32_bf16 v[24:27], v[116:119], v[36:39], v[24:27]
  ds_read_b128 v[100:103], v1 offset:15360
  ds_read_b128 v[104:107], v1 offset:16384
  ds_read_b128 v[108:111], v1 offset:17408
  ds_read_b128 v[112:115], v1 offset:18432
  ds_read_b128 v[116:119], v1 offset:19456
  s_waitcnt lgkmcnt(5)
  v_mfma_f32_16x16x32_bf16 v[8:11], v[80:83], v[40:43], v[8:11]
  v_mfma_f32_16x16x32_bf16 v[12:15], v[84:87], v[40:43], v[12:15]
  v_mfma_f32_16x16x32_bf16 v[16:19], v[88:91], v[40:43], v[16:19]
  v_mfma_f32_16x16x32_bf16 v[20:23], v[92:95], v[40:43], v[20:23]
  v_mfma_f32_16x16x32_bf16 v[24:27], v[96:99], v[40:43], v[24:27]
  s_waitcnt lgkmcnt(0)
  v_mfma_f32_16x16x32_bf16 v[8:11], v[100:103], v[44:47], v[8:11]
  v_mfma_f32_16x16x32_bf16 v[12:15], v[104:107], v[44:47], v[12:15]
  v_mfma_f32_16x16x32_bf16 v[16:19], v[108:111], v[44:47], v[16:19]
  v_mfma_f32_16x16x32_bf16 v[20:23], v[112:115], v[44:47], v[20:23]
  v_mfma_f32_16x16x32_bf16 v[24:27], v[116:119], v[44:47], v[24:27]
  s_add_u32 s30, s30, 1
  s_cmp_lt_u32 s30, 15
  s_cbranch_scc1 outa2_loop2
  s_waitcnt vmcnt(9)
  s_barrier
  ds_read_b128 v[80:83], v1 offset:20480
  ds_read_b128 v[84:87], v1 offset:21504
  ds_read_b128 v[88:91], v1 offset:22528
  ds_read_b128 v[92:95], v1 offset:23552
  ds_read_b128 v[96:99], v1 offset:24576
  ds_read_b128 v[100:103], v1 offset:25600
  ds_read_b128 v[104:107], v1 offset:26624
  ds_read_b128 v[108:111], v1 offset:27648
  ds_read_b128 v[112:115], v1 offset:28672
  ds_read_b128 v[116:119], v1 offset:29696
  s_waitcnt lgkmcnt(5)
  v_mfma_f32_16x16x32_bf16 v[8:11], v[80:83], v[48:51], v[8:11]
  v_mfma_f32_16x16x32_bf16 v[12:15], v[84:87], v[48:51], v[12:15]
  v_mfma_f32_16x16x32_bf16 v[16:19], v[88:91], v[48:51], v[16:19]
  v_mfma_f32_16x16x32_bf16 v[20:23], v[92:95], v[48:51], v[20:23]
  v_mfma_f32_16x16x32_bf16 v[24:27], v[96:99], v[48:51], v[24:27]
  ds_read_b128 v[80:83], v1 offset:30720
  ds_read_b128 v[84:87], v1 offset:31744
  ds_read_b128 v[88:91], v1 offset:32768
  ds_read_b128 v[92:95], v1 offset:33792
  ds_read_b128 v[96:99], v1 offset:34816
  s_waitcnt lgkmcnt(5)
  v_mfma_f32_16x16x32_bf16 v[8:11], v[100:103], v[52:55], v[8:11]
  v_mfma_f32_16x16x32_bf16 v[12:15], v[104:107], v[52:55], v[12:15]
  v_mfma_f32_16x16x32_bf16 v[16:19], v[108:111], v[52:55], v[16:19]
  v_mfma_f32_16x16x32_bf16 v[20:23], v[112:115], v[52:55], v[20:23]
  v_mfma_f32_16x16x32_bf16 v[24:27], v[116:119], v[52:55], v[24:27]
  ds_read_b128 v[100:103], v1 offset:35840
  ds_read_b128 v[104:107], v1 offset:36864
  ds_read_b128 v[108:111], v1 offset:37888
  ds_read_b128 v[112:115], v1 offset:38912
  ds_read_b128 v[116:119], v1 offset:39936
  s_waitcnt lgkmcnt(5)
  v_mfma_f32_16x16x32_bf16 v[8:11], v[80:83], v[56:59], v[8:11]
  v_mfma_f32_16x16x32_bf16 v[12:15], v[84:87], v[56:59], v[12:15]
  v_mfma_f32_16x16x32_bf16 v[16:19], v[88:91], v[56:59], v[16:19]
  v_mfma_f32_16x16x32_bf16 v[20:23], v[92:95], v[56:59], v[20:23]
  v_mfma_f32_16x16x32_bf16 v[24:27], v[96:99], v[56:59], v[24:27]
  s_waitcnt lgkmcnt(0)
  v_mfma_f32_16x16x32_bf16 v[8:11], v[100:103], v[60:63], v[8:11]
  v_mfma_f32_16x16x32_bf16 v[12:15], v[104:107], v[60:63], v[12:15]
  v_mfma_f32_16x16x32_bf16 v[16:19], v[108:111], v[60:63], v[16:19]
  v_mfma_f32_16x16x32_bf16 v[20:23], v[112:115], v[60:63], v[20:23]
  v_mfma_f32_16x16x32_bf16 v[24:27], v[116:119], v[60:63], v[24:27]
  s_waitcnt vmcnt(0)
  s_barrier
  ds_read_b128 v[80:83], v1 offset:40960
  ds_read_b128 v[84:87], v1 offset:41984
  ds_read_b128 v[88:91], v1 offset:43008
  ds_read_b128 v[92:95], v1 offset:44032
  ds_read_b128 v[96:99], v1 offset:45056
  ds_read_b128 v[100:103], v1 offset:46080
  ds_read_b128 v[104:107], v1 offset:47104
  ds_read_b128 v[108:111], v1 offset:48128
  ds_read_b128 v[112:115], v1 offset:49152
  ds_read_b128 v[116:119], v1 offset:50176
  s_waitcnt lgkmcnt(5)
  v_mfma_f32_16x16x32_bf16 v[8:11], v[80:83], v[64:67], v[8:11]
  v_mfma_f32_16x16x32_bf16 v[12:15], v[84:87], v[64:67], v[12:15]
  v_mfma_f32_16x16x32_bf16 v[16:19], v[88:91], v[64:67], v[16:19]
  v_mfma_f32_16x16x32_bf16 v[20:23], v[92:95], v[64:67], v[20:23]
  v_mfma_f32_16x16x32_bf16 v[24:27], v[96:99], v[64:67], v[24:27]
  ds_read_b128 v[80:83], v1 offset:51200
  ds_read_b128 v[84:87], v1 offset:52224
  ds_read_b128 v[88:91], v1 offset:53248
  ds_read_b128 v[92:95], v1 offset:54272
  ds_read_b128 v[96:99], v1 offset:55296
  s_waitcnt lgkmcnt(5)
  v_mfma_f32_16x16x32_bf16 v[8:11], v[100:103], v[68:71], v[8:11]
  v_mfma_f32_16x16x32_bf16 v[12:15], v[104:107], v[68:71], v[12:15]
  v_mfma_f32_16x16x32_bf16 v[16:19], v[108:111], v[68:71], v[16:19]
  v_mfma_f32_16x16x32_bf16 v[20:23], v[112:115], v[68:71], v[20:23]
  v_mfma_f32_16x16x32_bf16 v[24:27], v[116:119], v[68:71], v[24:27]
  ds_read_b128 v[100:103], v1 offset:56320
  ds_read_b128 v[104:107], v1 offset:57344
  ds_read_b128 v[108:111], v1 offset:58368
  ds_read_b128 v[112:115], v1 offset:59392
  ds_read_b128 v[116:119], v1 offset:60416
  s_waitcnt lgkmcnt(5)
  v_mfma_f32_16x16x32_bf16 v[8:11], v[80:83], v[72:75], v[8:11]
  v_mfma_f32_16x16x32_bf16 v[12:15], v[84:87], v[72:75], v[12:15]
  v_mfma_f32_16x16x32_bf16 v[16:19], v[88:91], v[72:75], v[16:19]
  v_mfma_f32_16x16x32_bf16 v[20:23], v[92:95], v[72:75], v[20:23]
  v_mfma_f32_16x16x32_bf16 v[24:27], v[96:99], v[72:75], v[24:27]
  s_waitcnt lgkmcnt(0)
  v_mfma_f32_16x16x32_bf16 v[8:11], v[100:103], v[76:79], v[8:11]
  v_mfma_f32_16x16x32_bf16 v[12:15], v[104:107], v[76:79], v[12:15]
  v_mfma_f32_16x16x32_bf16 v[16:19], v[108:111], v[76:79], v[16:19]
  v_mfma_f32_16x16x32_bf16 v[20:23], v[112:115], v[76:79], v[20:23]
  v_mfma_f32_16x16x32_bf16 v[24:27], v[116:119], v[76:79], v[24:27]
  v_and_b32 v3, 63, v0
  v_and_b32 v4, 15, v3
  v_lshrrev_b32 v3, 4, v3
  s_lshl_b32 s21, s17, 6
  s_lshl_b32 s23, s16, 4
  s_add_u32 s21, s21, s23
  v_add_u32 v4, s21, v4
  v_mul_u32_u24 v6, 1280, v4
  v_lshl_add_u32 v6, v3, 4, v6
  s_mul_i32 s21, s18, 5
  s_add_u32 s23, s21, 0
  s_lshr_b32 s31, s23, 1
  s_lshl_b32 s31, s31, 6
  s_and_b32 s23, s23, 1
  s_lshl_b32 s23, s23, 3
  s_add_u32 s32, s31, s23
  s_add_u32 s40, s32, s20
  buffer_load_dwordx2 v[32:33], v6, s[8:11], s40 offen
  s_add_u32 s23, s21, 1
  s_lshr_b32 s31, s23, 1
  s_lshl_b32 s31, s31, 6
  s_and_b32 s23, s23, 1
  s_lshl_b32 s23, s23, 3
  s_add_u32 s33, s31, s23
  s_add_u32 s41, s33, s20
  buffer_load_dwordx2 v[34:35], v6, s[8:11], s41 offen
  s_add_u32 s23, s21, 2
  s_lshr_b32 s31, s23, 1
  s_lshl_b32 s31, s31, 6
  s_and_b32 s23, s23, 1
  s_lshl_b32 s23, s23, 3
  s_add_u32 s34, s31, s23
  s_add_u32 s42, s34, s20
  buffer_load_dwordx2 v[36:37], v6, s[8:11], s42 offen
  s_add_u32 s23, s21, 3
  s_lshr_b32 s31, s23, 1
  s_lshl_b32 s31, s31, 6
  s_and_b32 s23, s23, 1
  s_lshl_b32 s23, s23, 3
  s_add_u32 s35, s31, s23
  s_add_u32 s43, s35, s20
  buffer_load_dwordx2 v[38:39], v6, s[8:11], s43 offen
  s_add_u32 s23, s21, 4
  s_lshr_b32 s31, s23, 1
  s_lshl_b32 s31, s31, 6
  s_and_b32 s23, s23, 1
  s_lshl_b32 s23, s23, 3
  s_add_u32 s36, s31, s23
  s_add_u32 s44, s36, s20
  buffer_load_dwordx2 v[40:41], v6, s[8:11], s44 offen
  s_waitcnt vmcnt(0)
  v_cvt_pk_bf16_f32 v80, v8, v9
  v_cvt_pk_bf16_f32 v81, v10, v11
  v_lshlrev_b32 v8, 16, v80
  v_and_b32 v9, 0xffff0000, v80
  v_lshlrev_b32 v10, 16, v81
  v_and_b32 v11, 0xffff0000, v81
  v_lshlrev_b32 v82, 16, v32
  v_and_b32 v83, 0xffff0000, v32
  v_lshlrev_b32 v84, 16, v33
  v_and_b32 v85, 0xffff0000, v33
  v_add_f32 v8, v8, v82
  v_add_f32 v9, v9, v83
  v_add_f32 v10, v10, v84
  v_add_f32 v11, v11, v85
  v_cvt_pk_bf16_f32 v32, v8, v9
  v_cvt_pk_bf16_f32 v33, v10, v11
  s_add_u32 s23, s32, 150994944
  buffer_store_dwordx2 v[32:33], v6, s[4:7], s23 offen
  v_cvt_pk_bf16_f32 v80, v12, v13
  v_cvt_pk_bf16_f32 v81, v14, v15
  v_lshlrev_b32 v12, 16, v80
  v_and_b32 v13, 0xffff0000, v80
  v_lshlrev_b32 v14, 16, v81
  v_and_b32 v15, 0xffff0000, v81
  v_lshlrev_b32 v82, 16, v34
  v_and_b32 v83, 0xffff0000, v34
  v_lshlrev_b32 v84, 16, v35
  v_and_b32 v85, 0xffff0000, v35
  v_add_f32 v12, v12, v82
  v_add_f32 v13, v13, v83
  v_add_f32 v14, v14, v84
  v_add_f32 v15, v15, v85
  v_cvt_pk_bf16_f32 v34, v12, v13
  v_cvt_pk_bf16_f32 v35, v14, v15
  s_add_u32 s23, s33, 150994944
  buffer_store_dwordx2 v[34:35], v6, s[4:7], s23 offen
  v_cvt_pk_bf16_f32 v80, v16, v17
  v_cvt_pk_bf16_f32 v81, v18, v19
  v_lshlrev_b32 v16, 16, v80
  v_and_b32 v17, 0xffff0000, v80
  v_lshlrev_b32 v18, 16, v81
  v_and_b32 v19, 0xffff0000, v81
  v_lshlrev_b32 v82, 16, v36
  v_and_b32 v83, 0xffff0000, v36
  v_lshlrev_b32 v84, 16, v37
  v_and_b32 v85, 0xffff0000, v37
  v_add_f32 v16, v16, v82
  v_add_f32 v17, v17, v83
  v_add_f32 v18, v18, v84
  v_add_f32 v19, v19, v85
  v_cvt_pk_bf16_f32 v36, v16, v17
  v_cvt_pk_bf16_f32 v37, v18, v19
  s_add_u32 s23, s34, 150994944
  buffer_store_dwordx2 v[36:37], v6, s[4:7], s23 offen
  v_cvt_pk_bf16_f32 v80, v20, v21
  v_cvt_pk_bf16_f32 v81, v22, v23
  v_lshlrev_b32 v20, 16, v80
  v_and_b32 v21, 0xffff0000, v80
  v_lshlrev_b32 v22, 16, v81
  v_and_b32 v23, 0xffff0000, v81
  v_lshlrev_b32 v82, 16, v38
  v_and_b32 v83, 0xffff0000, v38
  v_lshlrev_b32 v84, 16, v39
  v_and_b32 v85, 0xffff0000, v39
  v_add_f32 v20, v20, v82
  v_add_f32 v21, v21, v83
  v_add_f32 v22, v22, v84
  v_add_f32 v23, v23, v85
  v_cvt_pk_bf16_f32 v38, v20, v21
  v_cvt_pk_bf16_f32 v39, v22, v23
  s_add_u32 s23, s35, 150994944
  buffer_store_dwordx2 v[38:39], v6, s[4:7], s23 offen
  v_cvt_pk_bf16_f32 v80, v24, v25
  v_cvt_pk_bf16_f32 v81, v26, v27
  v_lshlrev_b32 v24, 16, v80
  v_and_b32 v25, 0xffff0000, v80
  v_lshlrev_b32 v26, 16, v81
  v_and_b32 v27, 0xffff0000, v81
  v_lshlrev_b32 v82, 16, v40
  v_and_b32 v83, 0xffff0000, v40
  v_lshlrev_b32 v84, 16, v41
  v_and_b32 v85, 0xffff0000, v41
  v_add_f32 v24, v24, v82
  v_add_f32 v25, v25, v83
  v_add_f32 v26, v26, v84
  v_add_f32 v27, v27, v85
  v_cvt_pk_bf16_f32 v40, v24, v25
  v_cvt_pk_bf16_f32 v41, v26, v27
  s_add_u32 s23, s36, 150994944
  buffer_store_dwordx2 v[40:41], v6, s[4:7], s23 offen
outa2_exit1:
  s_endpgm
.globl qkvb_kernel
.p2align 8
.type qkvb_kernel,@function
qkvb_kernel:
  s_cmp_ge_u32 s2, 256
  s_cbranch_scc1 qkvb_exit1
  s_load_dwordx2 s[12:13], s[0:1], 96
  v_lshrrev_b32 v2, 6, v0
  v_and_b32 v3, 63, v0
  s_nop 0
  v_readfirstlane_b32 s16, v2
  v_lshlrev_b32 v8, 4, v3
  s_and_b32 s17, s2, 7
  s_lshr_b32 s18, s2, 3
  s_waitcnt lgkmcnt(0)
  s_mov_b32 s4, s12
  s_mov_b32 s5, s13
  s_mov_b32 s6, 0x10000000
  s_mov_b32 s7, 0x20000
  s_and_b32 s19, s16, 1
  s_lshr_b32 s20, s16, 1
  v_and_b32 v2, 31, v3
  v_lshrrev_b32 v4, 5, v3
  s_lshl_b32 s21, s18, 6
  s_lshl_b32 s22, s19, 5
  s_add_u32 s21, s21, s22
  v_add_u32 v1, s21, v2
  v_mul_u32_u24 v1, 1280, v1
  v_lshl_add_u32 v1, v4, 4, v1
  s_mul_i32 s21, s20, 640
  s_add_u32 s21, s21, 150994944
  buffer_load_dwordx4 v[16:19], v1, s[4:7], s21 offen offset:0
  buffer_load_dwordx4 v[20:23], v1, s[4:7], s21 offen offset:32
  buffer_load_dwordx4 v[24:27], v1, s[4:7], s21 offen offset:64
  buffer_load_dwordx4 v[28:31], v1, s[4:7], s21 offen offset:96
  buffer_load_dwordx4 v[32:35], v1, s[4:7], s21 offen offset:128
  buffer_load_dwordx4 v[36:39], v1, s[4:7], s21 offen offset:160
  buffer_load_dwordx4 v[40:43], v1, s[4:7], s21 offen offset:192
  buffer_load_dwordx4 v[44:47], v1, s[4:7], s21 offen offset:224
  buffer_load_dwordx4 v[48:51], v1, s[4:7], s21 offen offset:256
  buffer_load_dwordx4 v[52:55], v1, s[4:7], s21 offen offset:288
  buffer_load_dwordx4 v[56:59], v1, s[4:7], s21 offen offset:320
  buffer_load_dwordx4 v[60:63], v1, s[4:7], s21 offen offset:352
  buffer_load_dwordx4 v[64:67], v1, s[4:7], s21 offen offset:384
  buffer_load_dwordx4 v[68:71], v1, s[4:7], s21 offen offset:416
  buffer_load_dwordx4 v[72:75], v1, s[4:7], s21 offen offset:448
  buffer_load_dwordx4 v[76:79], v1, s[4:7], s21 offen offset:480
  buffer_load_dwordx4 v[80:83], v1, s[4:7], s21 offen offset:512
  buffer_load_dwordx4 v[84:87], v1, s[4:7], s21 offen offset:544
  buffer_load_dwordx4 v[88:91], v1, s[4:7], s21 offen offset:576
  buffer_load_dwordx4 v[92:95], v1, s[4:7], s21 offen offset:608
  s_lshl_b32 s23, s17, 2
  s_add_u32 s23, s23, s16
  s_mul_i32 s24, s23, 40960
  s_add_u32 s24, s24, 156237824
  s_add_u32 s25, s24, 1310720
  s_add_u32 s26, s25, 1310720
  s_lshl_b32 s21, s19, 7
  s_add_u32 s21, s21, 81920
  v_lshlrev_b32 v5, 2, v2
  v_add_u32 v5, s21, v5
  s_lshl_b32 s21, s20, 8
  v_add_u32 v1, s21, v5
  s_waitcnt vmcnt(0)
  v_lshlrev_b32 v96, 16, v16
  v_and_b32 v97, 0xffff0000, v16
  v_lshlrev_b32 v98, 16, v17
  v_and_b32 v99, 0xffff0000, v17
  v_lshlrev_b32 v100, 16, v18
  v_and_b32 v101, 0xffff0000, v18
  v_lshlrev_b32 v102, 16, v19
  v_and_b32 v103, 0xffff0000, v19
  v_lshlrev_b32 v104, 16, v20
  v_and_b32 v105, 0xffff0000, v20
  v_lshlrev_b32 v106, 16, v21
  v_and_b32 v107, 0xffff0000, v21
  v_lshlrev_b32 v108, 16, v22
  v_and_b32 v109, 0xffff0000, v22
  v_lshlrev_b32 v110, 16, v23
  v_and_b32 v111, 0xffff0000, v23
  v_lshlrev_b32 v112, 16, v24
  v_and_b32 v113, 0xffff0000, v24
  v_lshlrev_b32 v114, 16, v25
  v_and_b32 v115, 0xffff0000, v25
  v_lshlrev_b32 v116, 16, v26
  v_and_b32 v117, 0xffff0000, v26
  v_lshlrev_b32 v118, 16, v27
  v_and_b32 v119, 0xffff0000, v27
  v_lshlrev_b32 v120, 16, v28
  v_and_b32 v121, 0xffff0000, v28
  v_lshlrev_b32 v122, 16, v29
  v_and_b32 v123, 0xffff0000, v29
  v_lshlrev_b32 v124, 16, v30
  v_and_b32 v125, 0xffff0000, v30
  v_lshlrev_b32 v126, 16, v31
  v_and_b32 v127, 0xffff0000, v31
  v_lshlrev_b32 v128, 16, v32
  v_and_b32 v129, 0xffff0000, v32
  v_lshlrev_b32 v130, 16, v33
  v_and_b32 v131, 0xffff0000, v33
  v_lshlrev_b32 v132, 16, v34
  v_and_b32 v133, 0xffff0000, v34
  v_lshlrev_b32 v134, 16, v35
  v_and_b32 v135, 0xffff0000, v35
  v_lshlrev_b32 v136, 16, v36
  v_and_b32 v137, 0xffff0000, v36
  v_lshlrev_b32 v138, 16, v37
  v_and_b32 v139, 0xffff0000, v37
  v_lshlrev_b32 v140, 16, v38
  v_and_b32 v141, 0xffff0000, v38
  v_lshlrev_b32 v142, 16, v39
  v_and_b32 v143, 0xffff0000, v39
  v_lshlrev_b32 v144, 16, v40
  v_and_b32 v145, 0xffff0000, v40
  v_lshlrev_b32 v146, 16, v41
  v_and_b32 v147, 0xffff0000, v41
  v_lshlrev_b32 v148, 16, v42
  v_and_b32 v149, 0xffff0000, v42
  v_lshlrev_b32 v150, 16, v43
  v_and_b32 v151, 0xffff0000, v43
  v_lshlrev_b32 v152, 16, v44
  v_and_b32 v153, 0xffff0000, v44
  v_lshlrev_b32 v154, 16, v45
  v_and_b32 v155, 0xffff0000, v45
  v_lshlrev_b32 v156, 16, v46
  v_and_b32 v157, 0xffff0000, v46
  v_lshlrev_b32 v158, 16, v47
  v_and_b32 v159, 0xffff0000, v47
  v_lshlrev_b32 v160, 16, v48
  v_and_b32 v161, 0xffff0000, v48
  v_lshlrev_b32 v162, 16, v49
  v_and_b32 v163, 0xffff0000, v49
  v_lshlrev_b32 v164, 16, v50
  v_and_b32 v165, 0xffff0000, v50
  v_lshlrev_b32 v166, 16, v51
  v_and_b32 v167, 0xffff0000, v51
  v_lshlrev_b32 v168, 16, v52
  v_and_b32 v169, 0xffff0000, v52
  v_lshlrev_b32 v170, 16, v53
  v_and_b32 v171, 0xffff0000, v53
  v_lshlrev_b32 v172, 16, v54
  v_and_b32 v173, 0xffff0000, v54
  v_lshlrev_b32 v174, 16, v55
  v_and_b32 v175, 0xffff0000, v55
  v_lshlrev_b32 v176, 16, v56
  v_and_b32 v177, 0xffff0000, v56
  v_lshlrev_b32 v178, 16, v57
  v_and_b32 v179, 0xffff0000, v57
  v_lshlrev_b32 v180, 16, v58
  v_and_b32 v181, 0xffff0000, v58
  v_lshlrev_b32 v182, 16, v59
  v_and_b32 v183, 0xffff0000, v59
  v_lshlrev_b32 v184, 16, v60
  v_and_b32 v185, 0xffff0000, v60
  v_lshlrev_b32 v186, 16, v61
  v_and_b32 v187, 0xffff0000, v61
  v_lshlrev_b32 v188, 16, v62
  v_and_b32 v189, 0xffff0000, v62
  v_lshlrev_b32 v190, 16, v63
  v_and_b32 v191, 0xffff0000, v63
  v_lshlrev_b32 v192, 16, v64
  v_and_b32 v193, 0xffff0000, v64
  v_lshlrev_b32 v194, 16, v65
  v_and_b32 v195, 0xffff0000, v65
  v_lshlrev_b32 v196, 16, v66
  v_and_b32 v197, 0xffff0000, v66
  v_lshlrev_b32 v198, 16, v67
  v_and_b32 v199, 0xffff0000, v67
  v_lshlrev_b32 v200, 16, v68
  v_and_b32 v201, 0xffff0000, v68
  v_lshlrev_b32 v202, 16, v69
  v_and_b32 v203, 0xffff0000, v69
  v_lshlrev_b32 v204, 16, v70
  v_and_b32 v205, 0xffff0000, v70
  v_lshlrev_b32 v206, 16, v71
  v_and_b32 v207, 0xffff0000, v71
  v_lshlrev_b32 v208, 16, v72
  v_and_b32 v209, 0xffff0000, v72
  v_lshlrev_b32 v210, 16, v73
  v_and_b32 v211, 0xffff0000, v73
  v_lshlrev_b32 v212, 16, v74
  v_and_b32 v213, 0xffff0000, v74
  v_lshlrev_b32 v214, 16, v75
  v_and_b32 v215, 0xffff0000, v75
  v_lshlrev_b32 v216, 16, v76
  v_and_b32 v217, 0xffff0000, v76
  v_lshlrev_b32 v218, 16, v77
  v_and_b32 v219, 0xffff0000, v77
  v_lshlrev_b32 v220, 16, v78
  v_and_b32 v221, 0xffff0000, v78
  v_lshlrev_b32 v222, 16, v79
  v_and_b32 v223, 0xffff0000, v79
  v_lshlrev_b32 v224, 16, v80
  v_and_b32 v225, 0xffff0000, v80
  v_lshlrev_b32 v226, 16, v81
  v_and_b32 v227, 0xffff0000, v81
  v_lshlrev_b32 v228, 16, v82
  v_and_b32 v229, 0xffff0000, v82
  v_lshlrev_b32 v230, 16, v83
  v_and_b32 v231, 0xffff0000, v83
  v_lshlrev_b32 v232, 16, v84
  v_and_b32 v233, 0xffff0000, v84
  v_lshlrev_b32 v234, 16, v85
  v_and_b32 v235, 0xffff0000, v85
  v_lshlrev_b32 v236, 16, v86
  v_and_b32 v237, 0xffff0000, v86
  v_lshlrev_b32 v238, 16, v87
  v_and_b32 v239, 0xffff0000, v87
  v_lshlrev_b32 v240, 16, v88
  v_and_b32 v241, 0xffff0000, v88
  v_lshlrev_b32 v242, 16, v89
  v_and_b32 v243, 0xffff0000, v89
  v_lshlrev_b32 v244, 16, v90
  v_and_b32 v245, 0xffff0000, v90
  v_lshlrev_b32 v246, 16, v91
  v_and_b32 v247, 0xffff0000, v91
  v_lshlrev_b32 v248, 16, v92
  v_and_b32 v249, 0xffff0000, v92
  v_lshlrev_b32 v250, 16, v93
  v_and_b32 v251, 0xffff0000, v93
  v_lshlrev_b32 v252, 16, v94
  v_and_b32 v253, 0xffff0000, v94
  v_lshlrev_b32 v254, 16, v95
  v_and_b32 v255, 0xffff0000, v95
  v_pk_add_f32 v[6:7], v[96:97], v[98:99]
  v_pk_add_f32 v[6:7], v[6:7], v[100:101]
  v_pk_add_f32 v[6:7], v[6:7], v[102:103]
  v_pk_add_f32 v[6:7], v[6:7], v[104:105]
  v_pk_add_f32 v[6:7], v[6:7], v[106:107]
  v_pk_add_f32 v[6:7], v[6:7], v[108:109]
  v_pk_add_f32 v[6:7], v[6:7], v[110:111]
  v_pk_add_f32 v[6:7], v[6:7], v[112:113]
  v_pk_add_f32 v[6:7], v[6:7], v[114:115]
  v_pk_add_f32 v[6:7], v[6:7], v[116:117]
  v_pk_add_f32 v[6:7], v[6:7], v[118:119]
  v_pk_add_f32 v[6:7], v[6:7], v[120:121]
  v_pk_add_f32 v[6:7], v[6:7], v[122:123]
  v_pk_add_f32 v[6:7], v[6:7], v[124:125]
  v_pk_add_f32 v[6:7], v[6:7], v[126:127]
  v_pk_add_f32 v[6:7], v[6:7], v[128:129]
  v_pk_add_f32 v[6:7], v[6:7], v[130:131]
  v_pk_add_f32 v[6:7], v[6:7], v[132:133]
  v_pk_add_f32 v[6:7], v[6:7], v[134:135]
  v_pk_add_f32 v[6:7], v[6:7], v[136:137]
  v_pk_add_f32 v[6:7], v[6:7], v[138:139]
  v_pk_add_f32 v[6:7], v[6:7], v[140:141]
  v_pk_add_f32 v[6:7], v[6:7], v[142:143]
  v_pk_add_f32 v[6:7], v[6:7], v[144:145]
  v_pk_add_f32 v[6:7], v[6:7], v[146:147]
  v_pk_add_f32 v[6:7], v[6:7], v[148:149]
  v_pk_add_f32 v[6:7], v[6:7], v[150:151]
  v_pk_add_f32 v[6:7], v[6:7], v[152:153]
  v_pk_add_f32 v[6:7], v[6:7], v[154:155]
  v_pk_add_f32 v[6:7], v[6:7], v[156:157]
  v_pk_add_f32 v[6:7], v[6:7], v[158:159]
  v_pk_add_f32 v[6:7], v[6:7], v[160:161]
  v_pk_add_f32 v[6:7], v[6:7], v[162:163]
  v_pk_add_f32 v[6:7], v[6:7], v[164:165]
  v_pk_add_f32 v[6:7], v[6:7], v[166:167]
  v_pk_add_f32 v[6:7], v[6:7], v[168:169]
  v_pk_add_f32 v[6:7], v[6:7], v[170:171]
  v_pk_add_f32 v[6:7], v[6:7], v[172:173]
  v_pk_add_f32 v[6:7], v[6:7], v[174:175]
  v_pk_add_f32 v[6:7], v[6:7], v[176:177]
  v_pk_add_f32 v[6:7], v[6:7], v[178:179]
  v_pk_add_f32 v[6:7], v[6:7], v[180:181]
  v_pk_add_f32 v[6:7], v[6:7], v[182:183]
  v_pk_add_f32 v[6:7], v[6:7], v[184:185]
  v_pk_add_f32 v[6:7], v[6:7], v[186:187]
  v_pk_add_f32 v[6:7], v[6:7], v[188:189]
  v_pk_add_f32 v[6:7], v[6:7], v[190:191]
  v_pk_add_f32 v[6:7], v[6:7], v[192:193]
  v_pk_add_f32 v[6:7], v[6:7], v[194:195]
  v_pk_add_f32 v[6:7], v[6:7], v[196:197]
  v_pk_add_f32 v[6:7], v[6:7], v[198:199]
  v_pk_add_f32 v[6:7], v[6:7], v[200:201]
  v_pk_add_f32 v[6:7], v[6:7], v[202:203]
  v_pk_add_f32 v[6:7], v[6:7], v[204:205]
  v_pk_add_f32 v[6:7], v[6:7], v[206:207]
  v_pk_add_f32 v[6:7], v[6:7], v[208:209]
  v_pk_add_f32 v[6:7], v[6:7], v[210:211]
  v_pk_add_f32 v[6:7], v[6:7], v[212:213]
  v_pk_add_f32 v[6:7], v[6:7], v[214:215]
  v_pk_add_f32 v[6:7], v[6:7], v[216:217]
  v_pk_add_f32 v[6:7], v[6:7], v[218:219]
  v_pk_add_f32 v[6:7], v[6:7], v[220:221]
  v_pk_add_f32 v[6:7], v[6:7], v[222:223]
  v_pk_add_f32 v[6:7], v[6:7], v[224:225]
  v_pk_add_f32 v[6:7], v[6:7], v[226:227]
  v_pk_add_f32 v[6:7], v[6:7], v[228:229]
  v_pk_add_f32 v[6:7], v[6:7], v[230:231]
  v_pk_add_f32 v[6:7], v[6:7], v[232:233]
  v_pk_add_f32 v[6:7], v[6:7], v[234:235]
  v_pk_add_f32 v[6:7], v[6:7], v[236:237]
  v_pk_add_f32 v[6:7], v[6:7], v[238:239]
  v_pk_add_f32 v[6:7], v[6:7], v[240:241]
  v_pk_add_f32 v[6:7], v[6:7], v[242:243]
  v_pk_add_f32 v[6:7], v[6:7], v[244:245]
  v_pk_add_f32 v[6:7], v[6:7], v[246:247]
  v_pk_add_f32 v[6:7], v[6:7], v[248:249]
  v_pk_add_f32 v[6:7], v[6:7], v[250:251]
  v_pk_add_f32 v[6:7], v[6:7], v[252:253]
  v_pk_add_f32 v[6:7], v[6:7], v[254:255]
  v_add_f32 v4, v6, v7
  v_mov_b32 v2, v4
  s_nop 1
  v_permlane32_swap_b32 v4, v2
  v_add_f32 v4, v4, v2
  ds_write_b32 v1, v4 offset:0
  s_waitcnt lgkmcnt(0)
  s_barrier
  ds_read_b32 v4, v5 offset:0
  ds_read_b32 v2, v5 offset:256
  s_waitcnt lgkmcnt(0)
  v_add_f32 v4, v4, v2
  v_mul_f32 v4, 0x3acccccd, v4
  v_sub_f32 v96, v96, v4
  v_sub_f32 v97, v97, v4
  v_sub_f32 v98, v98, v4
  v_sub_f32 v99, v99, v4
  v_sub_f32 v100, v100, v4
  v_sub_f32 v101, v101, v4
  v_sub_f32 v102, v102, v4
  v_sub_f32 v103, v103, v4
  v_sub_f32 v104, v104, v4
  v_sub_f32 v105, v105, v4
  v_sub_f32 v106, v106, v4
  v_sub_f32 v107, v107, v4
  v_sub_f32 v108, v108, v4
  v_sub_f32 v109, v109, v4
  v_sub_f32 v110, v110, v4
  v_sub_f32 v111, v111, v4
  v_sub_f32 v112, v112, v4
  v_sub_f32 v113, v113, v4
  v_sub_f32 v114, v114, v4
  v_sub_f32 v115, v115, v4
  v_sub_f32 v116, v116, v4
  v_sub_f32 v117, v117, v4
  v_sub_f32 v118, v118, v4
  v_sub_f32 v119, v119, v4
  v_sub_f32 v120, v120, v4
  v_sub_f32 v121, v121, v4
  v_sub_f32 v122, v122, v4
  v_sub_f32 v123, v123, v4
  v_sub_f32 v124, v124, v4
  v_sub_f32 v125, v125, v4
  v_sub_f32 v126, v126, v4
  v_sub_f32 v127, v127, v4
  v_sub_f32 v128, v128, v4
  v_sub_f32 v129, v129, v4
  v_sub_f32 v130, v130, v4
  v_sub_f32 v131, v131, v4
  v_sub_f32 v132, v132, v4
  v_sub_f32 v133, v133, v4
  v_sub_f32 v134, v134, v4
  v_sub_f32 v135, v135, v4
  v_sub_f32 v136, v136, v4
  v_sub_f32 v137, v137, v4
  v_sub_f32 v138, v138, v4
  v_sub_f32 v139, v139, v4
  v_sub_f32 v140, v140, v4
  v_sub_f32 v141, v141, v4
  v_sub_f32 v142, v142, v4
  v_sub_f32 v143, v143, v4
  v_sub_f32 v144, v144, v4
  v_sub_f32 v145, v145, v4
  v_sub_f32 v146, v146, v4
  v_sub_f32 v147, v147, v4
  v_sub_f32 v148, v148, v4
  v_sub_f32 v149, v149, v4
  v_sub_f32 v150, v150, v4
  v_sub_f32 v151, v151, v4
  v_sub_f32 v152, v152, v4
  v_sub_f32 v153, v153, v4
  v_sub_f32 v154, v154, v4
  v_sub_f32 v155, v155, v4
  v_sub_f32 v156, v156, v4
  v_sub_f32 v157, v157, v4
  v_sub_f32 v158, v158, v4
  v_sub_f32 v159, v159, v4
  v_sub_f32 v160, v160, v4
  v_sub_f32 v161, v161, v4
  v_sub_f32 v162, v162, v4
  v_sub_f32 v163, v163, v4
  v_sub_f32 v164, v164, v4
  v_sub_f32 v165, v165, v4
  v_sub_f32 v166, v166, v4
  v_sub_f32 v167, v167, v4
  v_sub_f32 v168, v168, v4
  v_sub_f32 v169, v169, v4
  v_sub_f32 v170, v170, v4
  v_sub_f32 v171, v171, v4
  v_sub_f32 v172, v172, v4
  v_sub_f32 v173, v173, v4
  v_sub_f32 v174, v174, v4
  v_sub_f32 v175, v175, v4
  v_sub_f32 v176, v176, v4
  v_sub_f32 v177, v177, v4
  v_sub_f32 v178, v178, v4
  v_sub_f32 v179, v179, v4
  v_sub_f32 v180, v180, v4
  v_sub_f32 v181, v181, v4
  v_sub_f32 v182, v182, v4
  v_sub_f32 v183, v183, v4
  v_sub_f32 v184, v184, v4
  v_sub_f32 v185, v185, v4
  v_sub_f32 v186, v186, v4
  v_sub_f32 v187, v187, v4
  v_sub_f32 v188, v188, v4
  v_sub_f32 v189, v189, v4
  v_sub_f32 v190, v190, v4
  v_sub_f32 v191, v191, v4
  v_sub_f32 v192, v192, v4
  v_sub_f32 v193, v193, v4
  v_sub_f32 v194, v194, v4
  v_sub_f32 v195, v195, v4
  v_sub_f32 v196, v196, v4
  v_sub_f32 v197, v197, v4
  v_sub_f32 v198, v198, v4
  v_sub_f32 v199, v199, v4
  v_sub_f32 v200, v200, v4
  v_sub_f32 v201, v201, v4
  v_sub_f32 v202, v202, v4
  v_sub_f32 v203, v203, v4
  v_sub_f32 v204, v204, v4
  v_sub_f32 v205, v205, v4
  v_sub_f32 v206, v206, v4
  v_sub_f32 v207, v207, v4
  v_sub_f32 v208, v208, v4
  v_sub_f32 v209, v209, v4
  v_sub_f32 v210, v210, v4
  v_sub_f32 v211, v211, v4
  v_sub_f32 v212, v212, v4
  v_sub_f32 v213, v213, v4
  v_sub_f32 v214, v214, v4
  v_sub_f32 v215, v215, v4
  v_sub_f32 v216, v216, v4
  v_sub_f32 v217, v217, v4
  v_sub_f32 v218, v218, v4
  v_sub_f32 v219, v219, v4
  v_sub_f32 v220, v220, v4
  v_sub_f32 v221, v221, v4
  v_sub_f32 v222, v222, v4
  v_sub_f32 v223, v223, v4
  v_sub_f32 v224, v224, v4
  v_sub_f32 v225, v225, v4
  v_sub_f32 v226, v226, v4
  v_sub_f32 v227, v227, v4
  v_sub_f32 v228, v228, v4
  v_sub_f32 v229, v229, v4
  v_sub_f32 v230, v230, v4
  v_sub_f32 v231, v231, v4
  v_sub_f32 v232, v232, v4
  v_sub_f32 v233, v233, v4
  v_sub_f32 v234, v234, v4
  v_sub_f32 v235, v235, v4
  v_sub_f32 v236, v236, v4
  v_sub_f32 v237, v237, v4
  v_sub_f32 v238, v238, v4
  v_sub_f32 v239, v239, v4
  v_sub_f32 v240, v240, v4
  v_sub_f32 v241, v241, v4
  v_sub_f32 v242, v242, v4
  v_sub_f32 v243, v243, v4
  v_sub_f32 v244, v244, v4
  v_sub_f32 v245, v245, v4
  v_sub_f32 v246, v246, v4
  v_sub_f32 v247, v247, v4
  v_sub_f32 v248, v248, v4
  v_sub_f32 v249, v249, v4
  v_sub_f32 v250, v250, v4
  v_sub_f32 v251, v251, v4
  v_sub_f32 v252, v252, v4
  v_sub_f32 v253, v253, v4
  v_sub_f32 v254, v254, v4
  v_sub_f32 v255, v255, v4
  v_mul_f32 v6, v96, v96
  v_mul_f32 v7, v97, v97
  v_fmac_f32 v6, v98, v98
  v_fmac_f32 v7, v99, v99
  v_fmac_f32 v6, v100, v100
  v_fmac_f32 v7, v101, v101
  v_fmac_f32 v6, v102, v102
  v_fmac_f32 v7, v103, v103
  v_fmac_f32 v6, v104, v104
  v_fmac_f32 v7, v105, v105
  v_fmac_f32 v6, v106, v106
  v_fmac_f32 v7, v107, v107
  v_fmac_f32 v6, v108, v108
  v_fmac_f32 v7, v109, v109
  v_fmac_f32 v6, v110, v110
  v_fmac_f32 v7, v111, v111
  v_fmac_f32 v6, v112, v112
  v_fmac_f32 v7, v113, v113
  v_fmac_f32 v6, v114, v114
  v_fmac_f32 v7, v115, v115
  v_fmac_f32 v6, v116, v116
  v_fmac_f32 v7, v117, v117
  v_fmac_f32 v6, v118, v118
  v_fmac_f32 v7, v119, v119
  v_fmac_f32 v6, v120, v120
  v_fmac_f32 v7, v121, v121
  v_fmac_f32 v6, v122, v122
  v_fmac_f32 v7, v123, v123
  v_fmac_f32 v6, v124, v124
  v_fmac_f32 v7, v125, v125
  v_fmac_f32 v6, v126, v126
  v_fmac_f32 v7, v127, v127
  v_fmac_f32 v6, v128, v128
  v_fmac_f32 v7, v129, v129
  v_fmac_f32 v6, v130, v130
  v_fmac_f32 v7, v131, v131
  v_fmac_f32 v6, v132, v132
  v_fmac_f32 v7, v133, v133
  v_fmac_f32 v6, v134, v134
  v_fmac_f32 v7, v135, v135
  v_fmac_f32 v6, v136, v136
  v_fmac_f32 v7, v137, v137
  v_fmac_f32 v6, v138, v138
  v_fmac_f32 v7, v139, v139
  v_fmac_f32 v6, v140, v140
  v_fmac_f32 v7, v141, v141
  v_fmac_f32 v6, v142, v142
  v_fmac_f32 v7, v143, v143
  v_fmac_f32 v6, v144, v144
  v_fmac_f32 v7, v145, v145
  v_fmac_f32 v6, v146, v146
  v_fmac_f32 v7, v147, v147
  v_fmac_f32 v6, v148, v148
  v_fmac_f32 v7, v149, v149
  v_fmac_f32 v6, v150, v150
  v_fmac_f32 v7, v151, v151
  v_fmac_f32 v6, v152, v152
  v_fmac_f32 v7, v153, v153
  v_fmac_f32 v6, v154, v154
  v_fmac_f32 v7, v155, v155
  v_fmac_f32 v6, v156, v156
  v_fmac_f32 v7, v157, v157
  v_fmac_f32 v6, v158, v158
  v_fmac_f32 v7, v159, v159
  v_fmac_f32 v6, v160, v160
  v_fmac_f32 v7, v161, v161
  v_fmac_f32 v6, v162, v162
  v_fmac_f32 v7, v163, v163
  v_fmac_f32 v6, v164, v164
  v_fmac_f32 v7, v165, v165
  v_fmac_f32 v6, v166, v166
  v_fmac_f32 v7, v167, v167
  v_fmac_f32 v6, v168, v168
  v_fmac_f32 v7, v169, v169
  v_fmac_f32 v6, v170, v170
  v_fmac_f32 v7, v171, v171
  v_fmac_f32 v6, v172, v172
  v_fmac_f32 v7, v173, v173
  v_fmac_f32 v6, v174, v174
  v_fmac_f32 v7, v175, v175
  v_fmac_f32 v6, v176, v176
  v_fmac_f32 v7, v177, v177
  v_fmac_f32 v6, v178, v178
  v_fmac_f32 v7, v179, v179
  v_fmac_f32 v6, v180, v180
  v_fmac_f32 v7, v181, v181
  v_fmac_f32 v6, v182, v182
  v_fmac_f32 v7, v183, v183
  v_fmac_f32 v6, v184, v184
  v_fmac_f32 v7, v185, v185
  v_fmac_f32 v6, v186, v186
  v_fmac_f32 v7, v187, v187
  v_fmac_f32 v6, v188, v188
  v_fmac_f32 v7, v189, v189
  v_fmac_f32 v6, v190, v190
  v_fmac_f32 v7, v191, v191
  v_fmac_f32 v6, v192, v192
  v_fmac_f32 v7, v193, v193
  v_fmac_f32 v6, v194, v194
  v_fmac_f32 v7, v195, v195
  v_fmac_f32 v6, v196, v196
  v_fmac_f32 v7, v197, v197
  v_fmac_f32 v6, v198, v198
  v_fmac_f32 v7, v199, v199
  v_fmac_f32 v6, v200, v200
  v_fmac_f32 v7, v201, v201
  v_fmac_f32 v6, v202, v202
  v_fmac_f32 v7, v203, v203
  v_fmac_f32 v6, v204, v204
  v_fmac_f32 v7, v205, v205
  v_fmac_f32 v6, v206, v206
  v_fmac_f32 v7, v207, v207
  v_fmac_f32 v6, v208, v208
  v_fmac_f32 v7, v209, v209
  v_fmac_f32 v6, v210, v210
  v_fmac_f32 v7, v211, v211
  v_fmac_f32 v6, v212, v212
  v_fmac_f32 v7, v213, v213
  v_fmac_f32 v6, v214, v214
  v_fmac_f32 v7, v215, v215
  v_fmac_f32 v6, v216, v216
  v_fmac_f32 v7, v217, v217
  v_fmac_f32 v6, v218, v218
  v_fmac_f32 v7, v219, v219
  v_fmac_f32 v6, v220, v220
  v_fmac_f32 v7, v221, v221
  v_fmac_f32 v6, v222, v222
  v_fmac_f32 v7, v223, v223
  v_fmac_f32 v6, v224, v224
  v_fmac_f32 v7, v225, v225
  v_fmac_f32 v6, v226, v226
  v_fmac_f32 v7, v227, v227
  v_fmac_f32 v6, v228, v228
  v_fmac_f32 v7, v229, v229
  v_fmac_f32 v6, v230, v230
  v_fmac_f32 v7, v231, v231
  v_fmac_f32 v6, v232, v232
  v_fmac_f32 v7, v233, v233
  v_fmac_f32 v6, v234, v234
  v_fmac_f32 v7, v235, v235
  v_fmac_f32 v6, v236, v236
  v_fmac_f32 v7, v237, v237
  v_fmac_f32 v6, v238, v238
  v_fmac_f32 v7, v239, v239
  v_fmac_f32 v6, v240, v240
  v_fmac_f32 v7, v241, v241
  v_fmac_f32 v6, v242, v242
  v_fmac_f32 v7, v243, v243
  v_fmac_f32 v6, v244, v244
  v_fmac_f32 v7, v245, v245
  v_fmac_f32 v6, v246, v246
  v_fmac_f32 v7, v247, v247
  v_fmac_f32 v6, v248, v248
  v_fmac_f32 v7, v249, v249
  v_fmac_f32 v6, v250, v250
  v_fmac_f32 v7, v251, v251
  v_fmac_f32 v6, v252, v252
  v_fmac_f32 v7, v253, v253
  v_fmac_f32 v6, v254, v254
  v_fmac_f32 v7, v255, v255
  v_add_f32 v4, v6, v7
  v_mov_b32 v2, v4
  s_nop 1
  v_permlane32_swap_b32 v4, v2
  v_add_f32 v4, v4, v2
  ds_write_b32 v1, v4 offset:512
  s_waitcnt lgkmcnt(0)
  s_barrier
  ds_read_b32 v4, v5 offset:512
  ds_read_b32 v2, v5 offset:768
  s_waitcnt lgkmcnt(0)
  v_add_f32 v4, v4, v2
  v_mov_b32 v2, 0x3727c5ac
  v_fmac_f32 v2, 0x3acccccd, v4
  v_rsq_f32 v4, v2
  s_nop 0
  v_mul_f32 v96, v96, v4
  v_mul_f32 v97, v97, v4
  v_mul_f32 v98, v98, v4
  v_mul_f32 v99, v99, v4
  v_mul_f32 v100, v100, v4
  v_mul_f32 v101, v101, v4
  v_mul_f32 v102, v102, v4
  v_mul_f32 v103, v103, v4
  v_mul_f32 v104, v104, v4
  v_mul_f32 v105, v105, v4
  v_mul_f32 v106, v106, v4
  v_mul_f32 v107, v107, v4
  v_mul_f32 v108, v108, v4
  v_mul_f32 v109, v109, v4
  v_mul_f32 v110, v110, v4
  v_mul_f32 v111, v111, v4
  v_mul_f32 v112, v112, v4
  v_mul_f32 v113, v113, v4
  v_mul_f32 v114, v114, v4
  v_mul_f32 v115, v115, v4
  v_mul_f32 v116, v116, v4
  v_mul_f32 v117, v117, v4
  v_mul_f32 v118, v118, v4
  v_mul_f32 v119, v119, v4
  v_mul_f32 v120, v120, v4
  v_mul_f32 v121, v121, v4
  v_mul_f32 v122, v122, v4
  v_mul_f32 v123, v123, v4
  v_mul_f32 v124, v124, v4
  v_mul_f32 v125, v125, v4
  v_mul_f32 v126, v126, v4
  v_mul_f32 v127, v127, v4
  v_mul_f32 v128, v128, v4
  v_mul_f32 v129, v129, v4
  v_mul_f32 v130, v130, v4
  v_mul_f32 v131, v131, v4
  v_mul_f32 v132, v132, v4
  v_mul_f32 v133, v133, v4
  v_mul_f32 v134, v134, v4
  v_mul_f32 v135, v135, v4
  v_mul_f32 v136, v136, v4
  v_mul_f32 v137, v137, v4
  v_mul_f32 v138, v138, v4
  v_mul_f32 v139, v139, v4
  v_mul_f32 v140, v140, v4
  v_mul_f32 v141, v141, v4
  v_mul_f32 v142, v142, v4
  v_mul_f32 v143, v143, v4
  v_mul_f32 v144, v144, v4
  v_mul_f32 v145, v145, v4
  v_mul_f32 v146, v146, v4
  v_mul_f32 v147, v147, v4
  v_mul_f32 v148, v148, v4
  v_mul_f32 v149, v149, v4
  v_mul_f32 v150, v150, v4
  v_mul_f32 v151, v151, v4
  v_mul_f32 v152, v152, v4
  v_mul_f32 v153, v153, v4
  v_mul_f32 v154, v154, v4
  v_mul_f32 v155, v155, v4
  v_mul_f32 v156, v156, v4
  v_mul_f32 v157, v157, v4
  v_mul_f32 v158, v158, v4
  v_mul_f32 v159, v159, v4
  v_mul_f32 v160, v160, v4
  v_mul_f32 v161, v161, v4
  v_mul_f32 v162, v162, v4
  v_mul_f32 v163, v163, v4
  v_mul_f32 v164, v164, v4
  v_mul_f32 v165, v165, v4
  v_mul_f32 v166, v166, v4
  v_mul_f32 v167, v167, v4
  v_mul_f32 v168, v168, v4
  v_mul_f32 v169, v169, v4
  v_mul_f32 v170, v170, v4
  v_mul_f32 v171, v171, v4
  v_mul_f32 v172, v172, v4
  v_mul_f32 v173, v173, v4
  v_mul_f32 v174, v174, v4
  v_mul_f32 v175, v175, v4
  v_mul_f32 v176, v176, v4
  v_mul_f32 v177, v177, v4
  v_mul_f32 v178, v178, v4
  v_mul_f32 v179, v179, v4
  v_mul_f32 v180, v180, v4
  v_mul_f32 v181, v181, v4
  v_mul_f32 v182, v182, v4
  v_mul_f32 v183, v183, v4
  v_mul_f32 v184, v184, v4
  v_mul_f32 v185, v185, v4
  v_mul_f32 v186, v186, v4
  v_mul_f32 v187, v187, v4
  v_mul_f32 v188, v188, v4
  v_mul_f32 v189, v189, v4
  v_mul_f32 v190, v190, v4
  v_mul_f32 v191, v191, v4
  v_mul_f32 v192, v192, v4
  v_mul_f32 v193, v193, v4
  v_mul_f32 v194, v194, v4
  v_mul_f32 v195, v195, v4
  v_mul_f32 v196, v196, v4
  v_mul_f32 v197, v197, v4
  v_mul_f32 v198, v198, v4
  v_mul_f32 v199, v199, v4
  v_mul_f32 v200, v200, v4
  v_mul_f32 v201, v201, v4
  v_mul_f32 v202, v202, v4
  v_mul_f32 v203, v203, v4
  v_mul_f32 v204, v204, v4
  v_mul_f32 v205, v205, v4
  v_mul_f32 v206, v206, v4
  v_mul_f32 v207, v207, v4
  v_mul_f32 v208, v208, v4
  v_mul_f32 v209, v209, v4
  v_mul_f32 v210, v210, v4
  v_mul_f32 v211, v211, v4
  v_mul_f32 v212, v212, v4
  v_mul_f32 v213, v213, v4
  v_mul_f32 v214, v214, v4
  v_mul_f32 v215, v215, v4
  v_mul_f32 v216, v216, v4
  v_mul_f32 v217, v217, v4
  v_mul_f32 v218, v218, v4
  v_mul_f32 v219, v219, v4
  v_mul_f32 v220, v220, v4
  v_mul_f32 v221, v221, v4
  v_mul_f32 v222, v222, v4
  v_mul_f32 v223, v223, v4
  v_mul_f32 v224, v224, v4
  v_mul_f32 v225, v225, v4
  v_mul_f32 v226, v226, v4
  v_mul_f32 v227, v227, v4
  v_mul_f32 v228, v228, v4
  v_mul_f32 v229, v229, v4
  v_mul_f32 v230, v230, v4
  v_mul_f32 v231, v231, v4
  v_mul_f32 v232, v232, v4
  v_mul_f32 v233, v233, v4
  v_mul_f32 v234, v234, v4
  v_mul_f32 v235, v235, v4
  v_mul_f32 v236, v236, v4
  v_mul_f32 v237, v237, v4
  v_mul_f32 v238, v238, v4
  v_mul_f32 v239, v239, v4
  v_mul_f32 v240, v240, v4
  v_mul_f32 v241, v241, v4
  v_mul_f32 v242, v242, v4
  v_mul_f32 v243, v243, v4
  v_mul_f32 v244, v244, v4
  v_mul_f32 v245, v245, v4
  v_mul_f32 v246, v246, v4
  v_mul_f32 v247, v247, v4
  v_mul_f32 v248, v248, v4
  v_mul_f32 v249, v249, v4
  v_mul_f32 v250, v250, v4
  v_mul_f32 v251, v251, v4
  v_mul_f32 v252, v252, v4
  v_mul_f32 v253, v253, v4
  v_mul_f32 v254, v254, v4
  v_mul_f32 v255, v255, v4
  v_cvt_pk_bf16_f32 v16, v96, v97
  v_cvt_pk_bf16_f32 v17, v98, v99
  v_cvt_pk_bf16_f32 v18, v100, v101
  v_cvt_pk_bf16_f32 v19, v102, v103
  v_cvt_pk_bf16_f32 v20, v104, v105
  v_cvt_pk_bf16_f32 v21, v106, v107
  v_cvt_pk_bf16_f32 v22, v108, v109
  v_cvt_pk_bf16_f32 v23, v110, v111
  v_cvt_pk_bf16_f32 v24, v112, v113
  v_cvt_pk_bf16_f32 v25, v114, v115
  v_cvt_pk_bf16_f32 v26, v116, v117
  v_cvt_pk_bf16_f32 v27, v118, v119
  v_cvt_pk_bf16_f32 v28, v120, v121
  v_cvt_pk_bf16_f32 v29, v122, v123
  v_cvt_pk_bf16_f32 v30, v124, v125
  v_cvt_pk_bf16_f32 v31, v126, v127
  v_cvt_pk_bf16_f32 v32, v128, v129
  v_cvt_pk_bf16_f32 v33, v130, v131
  v_cvt_pk_bf16_f32 v34, v132, v133
  v_cvt_pk_bf16_f32 v35, v134, v135
  v_cvt_pk_bf16_f32 v36, v136, v137
  v_cvt_pk_bf16_f32 v37, v138, v139
  v_cvt_pk_bf16_f32 v38, v140, v141
  v_cvt_pk_bf16_f32 v39, v142, v143
  v_cvt_pk_bf16_f32 v40, v144, v145
  v_cvt_pk_bf16_f32 v41, v146, v147
  v_cvt_pk_bf16_f32 v42, v148, v149
  v_cvt_pk_bf16_f32 v43, v150, v151
  v_cvt_pk_bf16_f32 v44, v152, v153
  v_cvt_pk_bf16_f32 v45, v154, v155
  v_cvt_pk_bf16_f32 v46, v156, v157
  v_cvt_pk_bf16_f32 v47, v158, v159
  v_cvt_pk_bf16_f32 v48, v160, v161
  v_cvt_pk_bf16_f32 v49, v162, v163
  v_cvt_pk_bf16_f32 v50, v164, v165
  v_cvt_pk_bf16_f32 v51, v166, v167
  v_cvt_pk_bf16_f32 v52, v168, v169
  v_cvt_pk_bf16_f32 v53, v170, v171
  v_cvt_pk_bf16_f32 v54, v172, v173
  v_cvt_pk_bf16_f32 v55, v174, v175
  v_cvt_pk_bf16_f32 v56, v176, v177
  v_cvt_pk_bf16_f32 v57, v178, v179
  v_cvt_pk_bf16_f32 v58, v180, v181
  v_cvt_pk_bf16_f32 v59, v182, v183
  v_cvt_pk_bf16_f32 v60, v184, v185
  v_cvt_pk_bf16_f32 v61, v186, v187
  v_cvt_pk_bf16_f32 v62, v188, v189
  v_cvt_pk_bf16_f32 v63, v190, v191
  v_cvt_pk_bf16_f32 v64, v192, v193
  v_cvt_pk_bf16_f32 v65, v194, v195
  v_cvt_pk_bf16_f32 v66, v196, v197
  v_cvt_pk_bf16_f32 v67, v198, v199
  v_cvt_pk_bf16_f32 v68, v200, v201
  v_cvt_pk_bf16_f32 v69, v202, v203
  v_cvt_pk_bf16_f32 v70, v204, v205
  v_cvt_pk_bf16_f32 v71, v206, v207
  v_cvt_pk_bf16_f32 v72, v208, v209
  v_cvt_pk_bf16_f32 v73, v210, v211
  v_cvt_pk_bf16_f32 v74, v212, v213
  v_cvt_pk_bf16_f32 v75, v214, v215
  v_cvt_pk_bf16_f32 v76, v216, v217
  v_cvt_pk_bf16_f32 v77, v218, v219
  v_cvt_pk_bf16_f32 v78, v220, v221
  v_cvt_pk_bf16_f32 v79, v222, v223
  v_cvt_pk_bf16_f32 v80, v224, v225
  v_cvt_pk_bf16_f32 v81, v226, v227
  v_cvt_pk_bf16_f32 v82, v228, v229
  v_cvt_pk_bf16_f32 v83, v230, v231
  v_cvt_pk_bf16_f32 v84, v232, v233
  v_cvt_pk_bf16_f32 v85, v234, v235
  v_cvt_pk_bf16_f32 v86, v236, v237
  v_cvt_pk_bf16_f32 v87, v238, v239
  v_cvt_pk_bf16_f32 v88, v240, v241
  v_cvt_pk_bf16_f32 v89, v242, v243
  v_cvt_pk_bf16_f32 v90, v244, v245
  v_cvt_pk_bf16_f32 v91, v246, v247
  v_cvt_pk_bf16_f32 v92, v248, v249
  v_cvt_pk_bf16_f32 v93, v250, v251
  v_cvt_pk_bf16_f32 v94, v252, v253
  v_cvt_pk_bf16_f32 v95, v254, v255
  s_mul_i32 s21, s19, 40960
  s_mul_i32 s22, s20, 20480
  s_add_u32 s21, s21, s22
  v_add_u32 v1, s21, v8
  ds_write_b128 v1, v[16:19] offset:0
  ds_write_b128 v1, v[20:23] offset:1024
  ds_write_b128 v1, v[24:27] offset:2048
  ds_write_b128 v1, v[28:31] offset:3072
  ds_write_b128 v1, v[32:35] offset:4096
  ds_write_b128 v1, v[36:39] offset:5120
  ds_write_b128 v1, v[40:43] offset:6144
  ds_write_b128 v1, v[44:47] offset:7168
  ds_write_b128 v1, v[48:51] offset:8192
  ds_write_b128 v1, v[52:55] offset:9216
  ds_write_b128 v1, v[56:59] offset:10240
  ds_write_b128 v1, v[60:63] offset:11264
  ds_write_b128 v1, v[64:67] offset:12288
  ds_write_b128 v1, v[68:71] offset:13312
  ds_write_b128 v1, v[72:75] offset:14336
  ds_write_b128 v1, v[76:79] offset:15360
  ds_write_b128 v1, v[80:83] offset:16384
  ds_write_b128 v1, v[84:87] offset:17408
  ds_write_b128 v1, v[88:91] offset:18432
  ds_write_b128 v1, v[92:95] offset:19456
  v_add_u32 v9, 40960, v8
  s_waitcnt lgkmcnt(0)
  s_barrier
  buffer_load_dwordx4 v[192:195], v8, s[4:7], s24 offen offset:0
  buffer_load_dwordx4 v[196:199], v8, s[4:7], s25 offen offset:0
  buffer_load_dwordx4 v[200:203], v8, s[4:7], s26 offen offset:0
  buffer_load_dwordx4 v[204:207], v8, s[4:7], s24 offen offset:1024
  buffer_load_dwordx4 v[208:211], v8, s[4:7], s25 offen offset:1024
  buffer_load_dwordx4 v[212:215], v8, s[4:7], s26 offen offset:1024
  buffer_load_dwordx4 v[216:219], v8, s[4:7], s24 offen offset:2048
  buffer_load_dwordx4 v[220:223], v8, s[4:7], s25 offen offset:2048
  buffer_load_dwordx4 v[224:227], v8, s[4:7], s26 offen offset:2048
  ds_read_b128 v[16:19], v8 offset:0
  ds_read_b128 v[20:23], v9 offset:0
  ds_read_b128 v[24:27], v8 offset:1024
  ds_read_b128 v[28:31], v9 offset:1024
  buffer_load_dwordx4 v[228:231], v8, s[4:7], s24 offen offset:3072
  buffer_load_dwordx4 v[232:235], v8, s[4:7], s25 offen offset:3072
  buffer_load_dwordx4 v[236:239], v8, s[4:7], s26 offen offset:3072
  s_add_u32 s24, s24, 4096
  s_add_u32 s25, s25, 4096
  s_add_u32 s26, s26, 4096
  s_waitcnt vmcnt(9)
  ds_read_b128 v[32:35], v8 offset:2048
  ds_read_b128 v[36:39], v9 offset:2048
  s_waitcnt lgkmcnt(4)
  v_mfma_f32_32x32x16_bf16 v[96:111], v[192:195], v[16:19], 0
  v_mfma_f32_32x32x16_bf16 v[112:127], v[192:195], v[20:23], 0
  v_mfma_f32_32x32x16_bf16 v[128:143], v[196:199], v[16:19], 0
  v_mfma_f32_32x32x16_bf16 v[144:159], v[196:199], v[20:23], 0
  v_mfma_f32_32x32x16_bf16 v[160:175], v[16:19], v[200:203], 0
  v_mfma_f32_32x32x16_bf16 v[176:191], v[20:23], v[200:203], 0
  buffer_load_dwordx4 v[192:195], v8, s[4:7], s24 offen offset:0
  buffer_load_dwordx4 v[196:199], v8, s[4:7], s25 offen offset:0
  buffer_load_dwordx4 v[200:203], v8, s[4:7], s26 offen offset:0
  s_waitcnt vmcnt(9)
  ds_read_b128 v[16:19], v8 offset:3072
  ds_read_b128 v[20:23], v9 offset:3072
  s_waitcnt lgkmcnt(4)
  v_mfma_f32_32x32x16_bf16 v[96:111], v[204:207], v[24:27], v[96:111]
  v_mfma_f32_32x32x16_bf16 v[112:127], v[204:207], v[28:31], v[112:127]
  v_mfma_f32_32x32x16_bf16 v[128:143], v[208:211], v[24:27], v[128:143]
  v_mfma_f32_32x32x16_bf16 v[144:159], v[208:211], v[28:31], v[144:159]
  v_mfma_f32_32x32x16_bf16 v[160:175], v[24:27], v[212:215], v[160:175]
  v_mfma_f32_32x32x16_bf16 v[176:191], v[28:31], v[212:215], v[176:191]
  buffer_load_dwordx4 v[204:207], v8, s[4:7], s24 offen offset:1024
  buffer_load_dwordx4 v[208:211], v8, s[4:7], s25 offen offset:1024
  buffer_load_dwordx4 v[212:215], v8, s[4:7], s26 offen offset:1024
  s_waitcnt vmcnt(9)
  ds_read_b128 v[24:27], v8 offset:4096
  ds_read_b128 v[28:31], v9 offset:4096
  s_waitcnt lgkmcnt(4)
  v_mfma_f32_32x32x16_bf16 v[96:111], v[216:219], v[32:35], v[96:111]
  v_mfma_f32_32x32x16_bf16 v[112:127], v[216:219], v[36:39], v[112:127]
  v_mfma_f32_32x32x16_bf16 v[128:143], v[220:223], v[32:35], v[128:143]
  v_mfma_f32_32x32x16_bf16 v[144:159], v[220:223], v[36:39], v[144:159]
  v_mfma_f32_32x32x16_bf16 v[160:175], v[32:35], v[224:227], v[160:175]
  v_mfma_f32_32x32x16_bf16 v[176:191], v[36:39], v[224:227], v[176:191]
  buffer_load_dwordx4 v[216:219], v8, s[4:7], s24 offen offset:2048
  buffer_load_dwordx4 v[220:223], v8, s[4:7], s25 offen offset:2048
  buffer_load_dwordx4 v[224:227], v8, s[4:7], s26 offen offset:2048
  s_waitcnt vmcnt(9)
  ds_read_b128 v[32:35], v8 offset:5120
  ds_read_b128 v[36:39], v9 offset:5120
  s_waitcnt lgkmcnt(4)
  v_mfma_f32_32x32x16_bf16 v[96:111], v[228:231], v[16:19], v[96:111]
  v_mfma_f32_32x32x16_bf16 v[112:127], v[228:231], v[20:23], v[112:127]
  v_mfma_f32_32x32x16_bf16 v[128:143], v[232:235], v[16:19], v[128:143]
  v_mfma_f32_32x32x16_bf16 v[144:159], v[232:235], v[20:23], v[144:159]
  v_mfma_f32_32x32x16_bf16 v[160:175], v[16:19], v[236:239], v[160:175]
  v_mfma_f32_32x32x16_bf16 v[176:191], v[20:23], v[236:239], v[176:191]
  buffer_load_dwordx4 v[228:231], v8, s[4:7], s24 offen offset:3072
  buffer_load_dwordx4 v[232:235], v8, s[4:7], s25 offen offset:3072
  buffer_load_dwordx4 v[236:239], v8, s[4:7], s26 offen offset:3072
  s_add_u32 s24, s24, 4096
  s_add_u32 s25, s25, 4096
  s_add_u32 s26, s26, 4096
  s_waitcnt vmcnt(9)
  ds_read_b128 v[16:19], v8 offset:6144
  ds_read_b128 v[20:23], v9 offset:6144
  s_waitcnt lgkmcnt(4)
  v_mfma_f32_32x32x16_bf16 v[96:111], v[192:195], v[24:27], v[96:111]
  v_mfma_f32_32x32x16_bf16 v[112:127], v[192:195], v[28:31], v[112:127]
  v_mfma_f32_32x32x16_bf16 v[128:143], v[196:199], v[24:27], v[128:143]
  v_mfma_f32_32x32x16_bf16 v[144:159], v[196:199], v[28:31], v[144:159]
  v_mfma_f32_32x32x16_bf16 v[160:175], v[24:27], v[200:203], v[160:175]
  v_mfma_f32_32x32x16_bf16 v[176:191], v[28:31], v[200:203], v[176:191]
  buffer_load_dwordx4 v[192:195], v8, s[4:7], s24 offen offset:0
  buffer_load_dwordx4 v[196:199], v8, s[4:7], s25 offen offset:0
  buffer_load_dwordx4 v[200:203], v8, s[4:7], s26 offen offset:0
  s_waitcnt vmcnt(9)
  ds_read_b128 v[24:27], v8 offset:7168
  ds_read_b128 v[28:31], v9 offset:7168
  s_waitcnt lgkmcnt(4)
  v_mfma_f32_32x32x16_bf16 v[96:111], v[204:207], v[32:35], v[96:111]
  v_mfma_f32_32x32x16_bf16 v[112:127], v[204:207], v[36:39], v[112:127]
  v_mfma_f32_32x32x16_bf16 v[128:143], v[208:211], v[32:35], v[128:143]
  v_mfma_f32_32x32x16_bf16 v[144:159], v[208:211], v[36:39], v[144:159]
  v_mfma_f32_32x32x16_bf16 v[160:175], v[32:35], v[212:215], v[160:175]
  v_mfma_f32_32x32x16_bf16 v[176:191], v[36:39], v[212:215], v[176:191]
  buffer_load_dwordx4 v[204:207], v8, s[4:7], s24 offen offset:1024
  buffer_load_dwordx4 v[208:211], v8, s[4:7], s25 offen offset:1024
  buffer_load_dwordx4 v[212:215], v8, s[4:7], s26 offen offset:1024
  s_waitcnt vmcnt(9)
  ds_read_b128 v[32:35], v8 offset:8192
  ds_read_b128 v[36:39], v9 offset:8192
  s_waitcnt lgkmcnt(4)
  v_mfma_f32_32x32x16_bf16 v[96:111], v[216:219], v[16:19], v[96:111]
  v_mfma_f32_32x32x16_bf16 v[112:127], v[216:219], v[20:23], v[112:127]
  v_mfma_f32_32x32x16_bf16 v[128:143], v[220:223], v[16:19], v[128:143]
  v_mfma_f32_32x32x16_bf16 v[144:159], v[220:223], v[20:23], v[144:159]
  v_mfma_f32_32x32x16_bf16 v[160:175], v[16:19], v[224:227], v[160:175]
  v_mfma_f32_32x32x16_bf16 v[176:191], v[20:23], v[224:227], v[176:191]
  buffer_load_dwordx4 v[216:219], v8, s[4:7], s24 offen offset:2048
  buffer_load_dwordx4 v[220:223], v8, s[4:7], s25 offen offset:2048
  buffer_load_dwordx4 v[224:227], v8, s[4:7], s26 offen offset:2048
  s_waitcnt vmcnt(9)
  ds_read_b128 v[16:19], v8 offset:9216
  ds_read_b128 v[20:23], v9 offset:9216
  s_waitcnt lgkmcnt(4)
  v_mfma_f32_32x32x16_bf16 v[96:111], v[228:231], v[24:27], v[96:111]
  v_mfma_f32_32x32x16_bf16 v[112:127], v[228:231], v[28:31], v[112:127]
  v_mfma_f32_32x32x16_bf16 v[128:143], v[232:235], v[24:27], v[128:143]
  v_mfma_f32_32x32x16_bf16 v[144:159], v[232:235], v[28:31], v[144:159]
  v_mfma_f32_32x32x16_bf16 v[160:175], v[24:27], v[236:239], v[160:175]
  v_mfma_f32_32x32x16_bf16 v[176:191], v[28:31], v[236:239], v[176:191]
  buffer_load_dwordx4 v[228:231], v8, s[4:7], s24 offen offset:3072
  buffer_load_dwordx4 v[232:235], v8, s[4:7], s25 offen offset:3072
  buffer_load_dwordx4 v[236:239], v8, s[4:7], s26 offen offset:3072
  s_add_u32 s24, s24, 4096
  s_add_u32 s25, s25, 4096
  s_add_u32 s26, s26, 4096
  s_waitcnt vmcnt(9)
  ds_read_b128 v[24:27], v8 offset:10240
  ds_read_b128 v[28:31], v9 offset:10240
  s_waitcnt lgkmcnt(4)
  v_mfma_f32_32x32x16_bf16 v[96:111], v[192:195], v[32:35], v[96:111]
  v_mfma_f32_32x32x16_bf16 v[112:127], v[192:195], v[36:39], v[112:127]
  v_mfma_f32_32x32x16_bf16 v[128:143], v[196:199], v[32:35], v[128:143]
  v_mfma_f32_32x32x16_bf16 v[144:159], v[196:199], v[36:39], v[144:159]
  v_mfma_f32_32x32x16_bf16 v[160:175], v[32:35], v[200:203], v[160:175]
  v_mfma_f32_32x32x16_bf16 v[176:191], v[36:39], v[200:203], v[176:191]
  buffer_load_dwordx4 v[192:195], v8, s[4:7], s24 offen offset:0
  buffer_load_dwordx4 v[196:199], v8, s[4:7], s25 offen offset:0
  buffer_load_dwordx4 v[200:203], v8, s[4:7], s26 offen offset:0
  s_waitcnt vmcnt(9)
  ds_read_b128 v[32:35], v8 offset:11264
  ds_read_b128 v[36:39], v9 offset:11264
  s_waitcnt lgkmcnt(4)
  v_mfma_f32_32x32x16_bf16 v[96:111], v[204:207], v[16:19], v[96:111]
  v_mfma_f32_32x32x16_bf16 v[112:127], v[204:207], v[20:23], v[112:127]
  v_mfma_f32_32x32x16_bf16 v[128:143], v[208:211], v[16:19], v[128:143]
  v_mfma_f32_32x32x16_bf16 v[144:159], v[208:211], v[20:23], v[144:159]
  v_mfma_f32_32x32x16_bf16 v[160:175], v[16:19], v[212:215], v[160:175]
  v_mfma_f32_32x32x16_bf16 v[176:191], v[20:23], v[212:215], v[176:191]
  buffer_load_dwordx4 v[204:207], v8, s[4:7], s24 offen offset:1024
  buffer_load_dwordx4 v[208:211], v8, s[4:7], s25 offen offset:1024
  buffer_load_dwordx4 v[212:215], v8, s[4:7], s26 offen offset:1024
  s_waitcnt vmcnt(9)
  ds_read_b128 v[16:19], v8 offset:12288
  ds_read_b128 v[20:23], v9 offset:12288
  s_waitcnt lgkmcnt(4)
  v_mfma_f32_32x32x16_bf16 v[96:111], v[216:219], v[24:27], v[96:111]
  v_mfma_f32_32x32x16_bf16 v[112:127], v[216:219], v[28:31], v[112:127]
  v_mfma_f32_32x32x16_bf16 v[128:143], v[220:223], v[24:27], v[128:143]
  v_mfma_f32_32x32x16_bf16 v[144:159], v[220:223], v[28:31], v[144:159]
  v_mfma_f32_32x32x16_bf16 v[160:175], v[24:27], v[224:227], v[160:175]
  v_mfma_f32_32x32x16_bf16 v[176:191], v[28:31], v[224:227], v[176:191]
  buffer_load_dwordx4 v[216:219], v8, s[4:7], s24 offen offset:2048
  buffer_load_dwordx4 v[220:223], v8, s[4:7], s25 offen offset:2048
  buffer_load_dwordx4 v[224:227], v8, s[4:7], s26 offen offset:2048
  s_waitcnt vmcnt(9)
  ds_read_b128 v[24:27], v8 offset:13312
  ds_read_b128 v[28:31], v9 offset:13312
  s_waitcnt lgkmcnt(4)
  v_mfma_f32_32x32x16_bf16 v[96:111], v[228:231], v[32:35], v[96:111]
  v_mfma_f32_32x32x16_bf16 v[112:127], v[228:231], v[36:39], v[112:127]
  v_mfma_f32_32x32x16_bf16 v[128:143], v[232:235], v[32:35], v[128:143]
  v_mfma_f32_32x32x16_bf16 v[144:159], v[232:235], v[36:39], v[144:159]
  v_mfma_f32_32x32x16_bf16 v[160:175], v[32:35], v[236:239], v[160:175]
  v_mfma_f32_32x32x16_bf16 v[176:191], v[36:39], v[236:239], v[176:191]
  buffer_load_dwordx4 v[228:231], v8, s[4:7], s24 offen offset:3072
  buffer_load_dwordx4 v[232:235], v8, s[4:7], s25 offen offset:3072
  buffer_load_dwordx4 v[236:239], v8, s[4:7], s26 offen offset:3072
  s_add_u32 s24, s24, 4096
  s_add_u32 s25, s25, 4096
  s_add_u32 s26, s26, 4096
  s_waitcnt vmcnt(9)
  ds_read_b128 v[32:35], v8 offset:14336
  ds_read_b128 v[36:39], v9 offset:14336
  s_waitcnt lgkmcnt(4)
  v_mfma_f32_32x32x16_bf16 v[96:111], v[192:195], v[16:19], v[96:111]
  v_mfma_f32_32x32x16_bf16 v[112:127], v[192:195], v[20:23], v[112:127]
  v_mfma_f32_32x32x16_bf16 v[128:143], v[196:199], v[16:19], v[128:143]
  v_mfma_f32_32x32x16_bf16 v[144:159], v[196:199], v[20:23], v[144:159]
  v_mfma_f32_32x32x16_bf16 v[160:175], v[16:19], v[200:203], v[160:175]
  v_mfma_f32_32x32x16_bf16 v[176:191], v[20:23], v[200:203], v[176:191]
  buffer_load_dwordx4 v[192:195], v8, s[4:7], s24 offen offset:0
  buffer_load_dwordx4 v[196:199], v8, s[4:7], s25 offen offset:0
  buffer_load_dwordx4 v[200:203], v8, s[4:7], s26 offen offset:0
  s_waitcnt vmcnt(9)
  ds_read_b128 v[16:19], v8 offset:15360
  ds_read_b128 v[20:23], v9 offset:15360
  s_waitcnt lgkmcnt(4)
  v_mfma_f32_32x32x16_bf16 v[96:111], v[204:207], v[24:27], v[96:111]
  v_mfma_f32_32x32x16_bf16 v[112:127], v[204:207], v[28:31], v[112:127]
  v_mfma_f32_32x32x16_bf16 v[128:143], v[208:211], v[24:27], v[128:143]
  v_mfma_f32_32x32x16_bf16 v[144:159], v[208:211], v[28:31], v[144:159]
  v_mfma_f32_32x32x16_bf16 v[160:175], v[24:27], v[212:215], v[160:175]
  v_mfma_f32_32x32x16_bf16 v[176:191], v[28:31], v[212:215], v[176:191]
  buffer_load_dwordx4 v[204:207], v8, s[4:7], s24 offen offset:1024
  buffer_load_dwordx4 v[208:211], v8, s[4:7], s25 offen offset:1024
  buffer_load_dwordx4 v[212:215], v8, s[4:7], s26 offen offset:1024
  s_waitcnt vmcnt(9)
  ds_read_b128 v[24:27], v8 offset:16384
  ds_read_b128 v[28:31], v9 offset:16384
  s_waitcnt lgkmcnt(4)
  v_mfma_f32_32x32x16_bf16 v[96:111], v[216:219], v[32:35], v[96:111]
  v_mfma_f32_32x32x16_bf16 v[112:127], v[216:219], v[36:39], v[112:127]
  v_mfma_f32_32x32x16_bf16 v[128:143], v[220:223], v[32:35], v[128:143]
  v_mfma_f32_32x32x16_bf16 v[144:159], v[220:223], v[36:39], v[144:159]
  v_mfma_f32_32x32x16_bf16 v[160:175], v[32:35], v[224:227], v[160:175]
  v_mfma_f32_32x32x16_bf16 v[176:191], v[36:39], v[224:227], v[176:191]
  buffer_load_dwordx4 v[216:219], v8, s[4:7], s24 offen offset:2048
  buffer_load_dwordx4 v[220:223], v8, s[4:7], s25 offen offset:2048
  buffer_load_dwordx4 v[224:227], v8, s[4:7], s26 offen offset:2048
  s_waitcnt vmcnt(9)
  ds_read_b128 v[32:35], v8 offset:17408
  ds_read_b128 v[36:39], v9 offset:17408
  s_waitcnt lgkmcnt(4)
  v_mfma_f32_32x32x16_bf16 v[96:111], v[228:231], v[16:19], v[96:111]
  v_mfma_f32_32x32x16_bf16 v[112:127], v[228:231], v[20:23], v[112:127]
  v_mfma_f32_32x32x16_bf16 v[128:143], v[232:235], v[16:19], v[128:143]
  v_mfma_f32_32x32x16_bf16 v[144:159], v[232:235], v[20:23], v[144:159]
  v_mfma_f32_32x32x16_bf16 v[160:175], v[16:19], v[236:239], v[160:175]
  v_mfma_f32_32x32x16_bf16 v[176:191], v[20:23], v[236:239], v[176:191]
  buffer_load_dwordx4 v[228:231], v8, s[4:7], s24 offen offset:3072
  buffer_load_dwordx4 v[232:235], v8, s[4:7], s25 offen offset:3072
  buffer_load_dwordx4 v[236:239], v8, s[4:7], s26 offen offset:3072
  s_add_u32 s24, s24, 4096
  s_add_u32 s25, s25, 4096
  s_add_u32 s26, s26, 4096
  s_waitcnt vmcnt(9)
  ds_read_b128 v[16:19], v8 offset:18432
  ds_read_b128 v[20:23], v9 offset:18432
  s_waitcnt lgkmcnt(4)
  v_mfma_f32_32x32x16_bf16 v[96:111], v[192:195], v[24:27], v[96:111]
  v_mfma_f32_32x32x16_bf16 v[112:127], v[192:195], v[28:31], v[112:127]
  v_mfma_f32_32x32x16_bf16 v[128:143], v[196:199], v[24:27], v[128:143]
  v_mfma_f32_32x32x16_bf16 v[144:159], v[196:199], v[28:31], v[144:159]
  v_mfma_f32_32x32x16_bf16 v[160:175], v[24:27], v[200:203], v[160:175]
  v_mfma_f32_32x32x16_bf16 v[176:191], v[28:31], v[200:203], v[176:191]
  buffer_load_dwordx4 v[192:195], v8, s[4:7], s24 offen offset:0
  buffer_load_dwordx4 v[196:199], v8, s[4:7], s25 offen offset:0
  buffer_load_dwordx4 v[200:203], v8, s[4:7], s26 offen offset:0
  s_waitcnt vmcnt(9)
  ds_read_b128 v[24:27], v8 offset:19456
  ds_read_b128 v[28:31], v9 offset:19456
  s_waitcnt lgkmcnt(4)
  v_mfma_f32_32x32x16_bf16 v[96:111], v[204:207], v[32:35], v[96:111]
  v_mfma_f32_32x32x16_bf16 v[112:127], v[204:207], v[36:39], v[112:127]
  v_mfma_f32_32x32x16_bf16 v[128:143], v[208:211], v[32:35], v[128:143]
  v_mfma_f32_32x32x16_bf16 v[144:159], v[208:211], v[36:39], v[144:159]
  v_mfma_f32_32x32x16_bf16 v[160:175], v[32:35], v[212:215], v[160:175]
  v_mfma_f32_32x32x16_bf16 v[176:191], v[36:39], v[212:215], v[176:191]
  buffer_load_dwordx4 v[204:207], v8, s[4:7], s24 offen offset:1024
  buffer_load_dwordx4 v[208:211], v8, s[4:7], s25 offen offset:1024
  buffer_load_dwordx4 v[212:215], v8, s[4:7], s26 offen offset:1024
  s_waitcnt vmcnt(9)
  ds_read_b128 v[32:35], v8 offset:20480
  ds_read_b128 v[36:39], v9 offset:20480
  s_waitcnt lgkmcnt(4)
  v_mfma_f32_32x32x16_bf16 v[96:111], v[216:219], v[16:19], v[96:111]
  v_mfma_f32_32x32x16_bf16 v[112:127], v[216:219], v[20:23], v[112:127]
  v_mfma_f32_32x32x16_bf16 v[128:143], v[220:223], v[16:19], v[128:143]
  v_mfma_f32_32x32x16_bf16 v[144:159], v[220:223], v[20:23], v[144:159]
  v_mfma_f32_32x32x16_bf16 v[160:175], v[16:19], v[224:227], v[160:175]
  v_mfma_f32_32x32x16_bf16 v[176:191], v[20:23], v[224:227], v[176:191]
  buffer_load_dwordx4 v[216:219], v8, s[4:7], s24 offen offset:2048
  buffer_load_dwordx4 v[220:223], v8, s[4:7], s25 offen offset:2048
  buffer_load_dwordx4 v[224:227], v8, s[4:7], s26 offen offset:2048
  s_waitcnt vmcnt(9)
  ds_read_b128 v[16:19], v8 offset:21504
  ds_read_b128 v[20:23], v9 offset:21504
  s_waitcnt lgkmcnt(4)
  v_mfma_f32_32x32x16_bf16 v[96:111], v[228:231], v[24:27], v[96:111]
  v_mfma_f32_32x32x16_bf16 v[112:127], v[228:231], v[28:31], v[112:127]
  v_mfma_f32_32x32x16_bf16 v[128:143], v[232:235], v[24:27], v[128:143]
  v_mfma_f32_32x32x16_bf16 v[144:159], v[232:235], v[28:31], v[144:159]
  v_mfma_f32_32x32x16_bf16 v[160:175], v[24:27], v[236:239], v[160:175]
  v_mfma_f32_32x32x16_bf16 v[176:191], v[28:31], v[236:239], v[176:191]
  buffer_load_dwordx4 v[228:231], v8, s[4:7], s24 offen offset:3072
  buffer_load_dwordx4 v[232:235], v8, s[4:7], s25 offen offset:3072
  buffer_load_dwordx4 v[236:239], v8, s[4:7], s26 offen offset:3072
  s_add_u32 s24, s24, 4096
  s_add_u32 s25, s25, 4096
  s_add_u32 s26, s26, 4096
  s_waitcnt vmcnt(9)
  ds_read_b128 v[24:27], v8 offset:22528
  ds_read_b128 v[28:31], v9 offset:22528
  s_waitcnt lgkmcnt(4)
  v_mfma_f32_32x32x16_bf16 v[96:111], v[192:195], v[32:35], v[96:111]
  v_mfma_f32_32x32x16_bf16 v[112:127], v[192:195], v[36:39], v[112:127]
  v_mfma_f32_32x32x16_bf16 v[128:143], v[196:199], v[32:35], v[128:143]
  v_mfma_f32_32x32x16_bf16 v[144:159], v[196:199], v[36:39], v[144:159]
  v_mfma_f32_32x32x16_bf16 v[160:175], v[32:35], v[200:203], v[160:175]
  v_mfma_f32_32x32x16_bf16 v[176:191], v[36:39], v[200:203], v[176:191]
  buffer_load_dwordx4 v[192:195], v8, s[4:7], s24 offen offset:0
  buffer_load_dwordx4 v[196:199], v8, s[4:7], s25 offen offset:0
  buffer_load_dwordx4 v[200:203], v8, s[4:7], s26 offen offset:0
  s_waitcnt vmcnt(9)
  ds_read_b128 v[32:35], v8 offset:23552
  ds_read_b128 v[36:39], v9 offset:23552
  s_waitcnt lgkmcnt(4)
  v_mfma_f32_32x32x16_bf16 v[96:111], v[204:207], v[16:19], v[96:111]
  v_mfma_f32_32x32x16_bf16 v[112:127], v[204:207], v[20:23], v[112:127]
  v_mfma_f32_32x32x16_bf16 v[128:143], v[208:211], v[16:19], v[128:143]
  v_mfma_f32_32x32x16_bf16 v[144:159], v[208:211], v[20:23], v[144:159]
  v_mfma_f32_32x32x16_bf16 v[160:175], v[16:19], v[212:215], v[160:175]
  v_mfma_f32_32x32x16_bf16 v[176:191], v[20:23], v[212:215], v[176:191]
  buffer_load_dwordx4 v[204:207], v8, s[4:7], s24 offen offset:1024
  buffer_load_dwordx4 v[208:211], v8, s[4:7], s25 offen offset:1024
  buffer_load_dwordx4 v[212:215], v8, s[4:7], s26 offen offset:1024
  s_waitcnt vmcnt(9)
  ds_read_b128 v[16:19], v8 offset:24576
  ds_read_b128 v[20:23], v9 offset:24576
  s_waitcnt lgkmcnt(4)
  v_mfma_f32_32x32x16_bf16 v[96:111], v[216:219], v[24:27], v[96:111]
  v_mfma_f32_32x32x16_bf16 v[112:127], v[216:219], v[28:31], v[112:127]
  v_mfma_f32_32x32x16_bf16 v[128:143], v[220:223], v[24:27], v[128:143]
  v_mfma_f32_32x32x16_bf16 v[144:159], v[220:223], v[28:31], v[144:159]
  v_mfma_f32_32x32x16_bf16 v[160:175], v[24:27], v[224:227], v[160:175]
  v_mfma_f32_32x32x16_bf16 v[176:191], v[28:31], v[224:227], v[176:191]
  buffer_load_dwordx4 v[216:219], v8, s[4:7], s24 offen offset:2048
  buffer_load_dwordx4 v[220:223], v8, s[4:7], s25 offen offset:2048
  buffer_load_dwordx4 v[224:227], v8, s[4:7], s26 offen offset:2048
  s_waitcnt vmcnt(9)
  ds_read_b128 v[24:27], v8 offset:25600
  ds_read_b128 v[28:31], v9 offset:25600
  s_waitcnt lgkmcnt(4)
  v_mfma_f32_32x32x16_bf16 v[96:111], v[228:231], v[32:35], v[96:111]
  v_mfma_f32_32x32x16_bf16 v[112:127], v[228:231], v[36:39], v[112:127]
  v_mfma_f32_32x32x16_bf16 v[128:143], v[232:235], v[32:35], v[128:143]
  v_mfma_f32_32x32x16_bf16 v[144:159], v[232:235], v[36:39], v[144:159]
  v_mfma_f32_32x32x16_bf16 v[160:175], v[32:35], v[236:239], v[160:175]
  v_mfma_f32_32x32x16_bf16 v[176:191], v[36:39], v[236:239], v[176:191]
  buffer_load_dwordx4 v[228:231], v8, s[4:7], s24 offen offset:3072
  buffer_load_dwordx4 v[232:235], v8, s[4:7], s25 offen offset:3072
  buffer_load_dwordx4 v[236:239], v8, s[4:7], s26 offen offset:3072
  s_add_u32 s24, s24, 4096
  s_add_u32 s25, s25, 4096
  s_add_u32 s26, s26, 4096
  s_waitcnt vmcnt(9)
  ds_read_b128 v[32:35], v8 offset:26624
  ds_read_b128 v[36:39], v9 offset:26624
  s_waitcnt lgkmcnt(4)
  v_mfma_f32_32x32x16_bf16 v[96:111], v[192:195], v[16:19], v[96:111]
  v_mfma_f32_32x32x16_bf16 v[112:127], v[192:195], v[20:23], v[112:127]
  v_mfma_f32_32x32x16_bf16 v[128:143], v[196:199], v[16:19], v[128:143]
  v_mfma_f32_32x32x16_bf16 v[144:159], v[196:199], v[20:23], v[144:159]
  v_mfma_f32_32x32x16_bf16 v[160:175], v[16:19], v[200:203], v[160:175]
  v_mfma_f32_32x32x16_bf16 v[176:191], v[20:23], v[200:203], v[176:191]
  buffer_load_dwordx4 v[192:195], v8, s[4:7], s24 offen offset:0
  buffer_load_dwordx4 v[196:199], v8, s[4:7], s25 offen offset:0
  buffer_load_dwordx4 v[200:203], v8, s[4:7], s26 offen offset:0
  s_waitcnt vmcnt(9)
  ds_read_b128 v[16:19], v8 offset:27648
  ds_read_b128 v[20:23], v9 offset:27648
  s_waitcnt lgkmcnt(4)
  v_mfma_f32_32x32x16_bf16 v[96:111], v[204:207], v[24:27], v[96:111]
  v_mfma_f32_32x32x16_bf16 v[112:127], v[204:207], v[28:31], v[112:127]
  v_mfma_f32_32x32x16_bf16 v[128:143], v[208:211], v[24:27], v[128:143]
  v_mfma_f32_32x32x16_bf16 v[144:159], v[208:211], v[28:31], v[144:159]
  v_mfma_f32_32x32x16_bf16 v[160:175], v[24:27], v[212:215], v[160:175]
  v_mfma_f32_32x32x16_bf16 v[176:191], v[28:31], v[212:215], v[176:191]
  buffer_load_dwordx4 v[204:207], v8, s[4:7], s24 offen offset:1024
  buffer_load_dwordx4 v[208:211], v8, s[4:7], s25 offen offset:1024
  buffer_load_dwordx4 v[212:215], v8, s[4:7], s26 offen offset:1024
  s_waitcnt vmcnt(9)
  ds_read_b128 v[24:27], v8 offset:28672
  ds_read_b128 v[28:31], v9 offset:28672
  s_waitcnt lgkmcnt(4)
  v_mfma_f32_32x32x16_bf16 v[96:111], v[216:219], v[32:35], v[96:111]
  v_mfma_f32_32x32x16_bf16 v[112:127], v[216:219], v[36:39], v[112:127]
  v_mfma_f32_32x32x16_bf16 v[128:143], v[220:223], v[32:35], v[128:143]
  v_mfma_f32_32x32x16_bf16 v[144:159], v[220:223], v[36:39], v[144:159]
  v_mfma_f32_32x32x16_bf16 v[160:175], v[32:35], v[224:227], v[160:175]
  v_mfma_f32_32x32x16_bf16 v[176:191], v[36:39], v[224:227], v[176:191]
  buffer_load_dwordx4 v[216:219], v8, s[4:7], s24 offen offset:2048
  buffer_load_dwordx4 v[220:223], v8, s[4:7], s25 offen offset:2048
  buffer_load_dwordx4 v[224:227], v8, s[4:7], s26 offen offset:2048
  s_waitcnt vmcnt(9)
  ds_read_b128 v[32:35], v8 offset:29696
  ds_read_b128 v[36:39], v9 offset:29696
  s_waitcnt lgkmcnt(4)
  v_mfma_f32_32x32x16_bf16 v[96:111], v[228:231], v[16:19], v[96:111]
  v_mfma_f32_32x32x16_bf16 v[112:127], v[228:231], v[20:23], v[112:127]
  v_mfma_f32_32x32x16_bf16 v[128:143], v[232:235], v[16:19], v[128:143]
  v_mfma_f32_32x32x16_bf16 v[144:159], v[232:235], v[20:23], v[144:159]
  v_mfma_f32_32x32x16_bf16 v[160:175], v[16:19], v[236:239], v[160:175]
  v_mfma_f32_32x32x16_bf16 v[176:191], v[20:23], v[236:239], v[176:191]
  buffer_load_dwordx4 v[228:231], v8, s[4:7], s24 offen offset:3072
  buffer_load_dwordx4 v[232:235], v8, s[4:7], s25 offen offset:3072
  buffer_load_dwordx4 v[236:239], v8, s[4:7], s26 offen offset:3072
  s_add_u32 s24, s24, 4096
  s_add_u32 s25, s25, 4096
  s_add_u32 s26, s26, 4096
  s_waitcnt vmcnt(9)
  ds_read_b128 v[16:19], v8 offset:30720
  ds_read_b128 v[20:23], v9 offset:30720
  s_waitcnt lgkmcnt(4)
  v_mfma_f32_32x32x16_bf16 v[96:111], v[192:195], v[24:27], v[96:111]
  v_mfma_f32_32x32x16_bf16 v[112:127], v[192:195], v[28:31], v[112:127]
  v_mfma_f32_32x32x16_bf16 v[128:143], v[196:199], v[24:27], v[128:143]
  v_mfma_f32_32x32x16_bf16 v[144:159], v[196:199], v[28:31], v[144:159]
  v_mfma_f32_32x32x16_bf16 v[160:175], v[24:27], v[200:203], v[160:175]
  v_mfma_f32_32x32x16_bf16 v[176:191], v[28:31], v[200:203], v[176:191]
  buffer_load_dwordx4 v[192:195], v8, s[4:7], s24 offen offset:0
  buffer_load_dwordx4 v[196:199], v8, s[4:7], s25 offen offset:0
  buffer_load_dwordx4 v[200:203], v8, s[4:7], s26 offen offset:0
  s_waitcnt vmcnt(9)
  ds_read_b128 v[24:27], v8 offset:31744
  ds_read_b128 v[28:31], v9 offset:31744
  s_waitcnt lgkmcnt(4)
  v_mfma_f32_32x32x16_bf16 v[96:111], v[204:207], v[32:35], v[96:111]
  v_mfma_f32_32x32x16_bf16 v[112:127], v[204:207], v[36:39], v[112:127]
  v_mfma_f32_32x32x16_bf16 v[128:143], v[208:211], v[32:35], v[128:143]
  v_mfma_f32_32x32x16_bf16 v[144:159], v[208:211], v[36:39], v[144:159]
  v_mfma_f32_32x32x16_bf16 v[160:175], v[32:35], v[212:215], v[160:175]
  v_mfma_f32_32x32x16_bf16 v[176:191], v[36:39], v[212:215], v[176:191]
  buffer_load_dwordx4 v[204:207], v8, s[4:7], s24 offen offset:1024
  buffer_load_dwordx4 v[208:211], v8, s[4:7], s25 offen offset:1024
  buffer_load_dwordx4 v[212:215], v8, s[4:7], s26 offen offset:1024
  s_waitcnt vmcnt(9)
  ds_read_b128 v[32:35], v8 offset:32768
  ds_read_b128 v[36:39], v9 offset:32768
  s_waitcnt lgkmcnt(4)
  v_mfma_f32_32x32x16_bf16 v[96:111], v[216:219], v[16:19], v[96:111]
  v_mfma_f32_32x32x16_bf16 v[112:127], v[216:219], v[20:23], v[112:127]
  v_mfma_f32_32x32x16_bf16 v[128:143], v[220:223], v[16:19], v[128:143]
  v_mfma_f32_32x32x16_bf16 v[144:159], v[220:223], v[20:23], v[144:159]
  v_mfma_f32_32x32x16_bf16 v[160:175], v[16:19], v[224:227], v[160:175]
  v_mfma_f32_32x32x16_bf16 v[176:191], v[20:23], v[224:227], v[176:191]
  buffer_load_dwordx4 v[216:219], v8, s[4:7], s24 offen offset:2048
  buffer_load_dwordx4 v[220:223], v8, s[4:7], s25 offen offset:2048
  buffer_load_dwordx4 v[224:227], v8, s[4:7], s26 offen offset:2048
  s_waitcnt vmcnt(9)
  ds_read_b128 v[16:19], v8 offset:33792
  ds_read_b128 v[20:23], v9 offset:33792
  s_waitcnt lgkmcnt(4)
  v_mfma_f32_32x32x16_bf16 v[96:111], v[228:231], v[24:27], v[96:111]
  v_mfma_f32_32x32x16_bf16 v[112:127], v[228:231], v[28:31], v[112:127]
  v_mfma_f32_32x32x16_bf16 v[128:143], v[232:235], v[24:27], v[128:143]
  v_mfma_f32_32x32x16_bf16 v[144:159], v[232:235], v[28:31], v[144:159]
  v_mfma_f32_32x32x16_bf16 v[160:175], v[24:27], v[236:239], v[160:175]
  v_mfma_f32_32x32x16_bf16 v[176:191], v[28:31], v[236:239], v[176:191]
  buffer_load_dwordx4 v[228:231], v8, s[4:7], s24 offen offset:3072
  buffer_load_dwordx4 v[232:235], v8, s[4:7], s25 offen offset:3072
  buffer_load_dwordx4 v[236:239], v8, s[4:7], s26 offen offset:3072
  s_add_u32 s24, s24, 4096
  s_add_u32 s25, s25, 4096
  s_add_u32 s26, s26, 4096
  s_waitcnt vmcnt(9)
  ds_read_b128 v[24:27], v8 offset:34816
  ds_read_b128 v[28:31], v9 offset:34816
  s_waitcnt lgkmcnt(4)
  v_mfma_f32_32x32x16_bf16 v[96:111], v[192:195], v[32:35], v[96:111]
  v_mfma_f32_32x32x16_bf16 v[112:127], v[192:195], v[36:39], v[112:127]
  v_mfma_f32_32x32x16_bf16 v[128:143], v[196:199], v[32:35], v[128:143]
  v_mfma_f32_32x32x16_bf16 v[144:159], v[196:199], v[36:39], v[144:159]
  v_mfma_f32_32x32x16_bf16 v[160:175], v[32:35], v[200:203], v[160:175]
  v_mfma_f32_32x32x16_bf16 v[176:191], v[36:39], v[200:203], v[176:191]
  buffer_load_dwordx4 v[192:195], v8, s[4:7], s24 offen offset:0
  buffer_load_dwordx4 v[196:199], v8, s[4:7], s25 offen offset:0
  buffer_load_dwordx4 v[200:203], v8, s[4:7], s26 offen offset:0
  s_waitcnt vmcnt(9)
  ds_read_b128 v[32:35], v8 offset:35840
  ds_read_b128 v[36:39], v9 offset:35840
  s_waitcnt lgkmcnt(4)
  v_mfma_f32_32x32x16_bf16 v[96:111], v[204:207], v[16:19], v[96:111]
  v_mfma_f32_32x32x16_bf16 v[112:127], v[204:207], v[20:23], v[112:127]
  v_mfma_f32_32x32x16_bf16 v[128:143], v[208:211], v[16:19], v[128:143]
  v_mfma_f32_32x32x16_bf16 v[144:159], v[208:211], v[20:23], v[144:159]
  v_mfma_f32_32x32x16_bf16 v[160:175], v[16:19], v[212:215], v[160:175]
  v_mfma_f32_32x32x16_bf16 v[176:191], v[20:23], v[212:215], v[176:191]
  buffer_load_dwordx4 v[204:207], v8, s[4:7], s24 offen offset:1024
  buffer_load_dwordx4 v[208:211], v8, s[4:7], s25 offen offset:1024
  buffer_load_dwordx4 v[212:215], v8, s[4:7], s26 offen offset:1024
  s_waitcnt vmcnt(9)
  ds_read_b128 v[16:19], v8 offset:36864
  ds_read_b128 v[20:23], v9 offset:36864
  s_waitcnt lgkmcnt(4)
  v_mfma_f32_32x32x16_bf16 v[96:111], v[216:219], v[24:27], v[96:111]
  v_mfma_f32_32x32x16_bf16 v[112:127], v[216:219], v[28:31], v[112:127]
  v_mfma_f32_32x32x16_bf16 v[128:143], v[220:223], v[24:27], v[128:143]
  v_mfma_f32_32x32x16_bf16 v[144:159], v[220:223], v[28:31], v[144:159]
  v_mfma_f32_32x32x16_bf16 v[160:175], v[24:27], v[224:227], v[160:175]
  v_mfma_f32_32x32x16_bf16 v[176:191], v[28:31], v[224:227], v[176:191]
  buffer_load_dwordx4 v[216:219], v8, s[4:7], s24 offen offset:2048
  buffer_load_dwordx4 v[220:223], v8, s[4:7], s25 offen offset:2048
  buffer_load_dwordx4 v[224:227], v8, s[4:7], s26 offen offset:2048
  s_waitcnt vmcnt(9)
  ds_read_b128 v[24:27], v8 offset:37888
  ds_read_b128 v[28:31], v9 offset:37888
  s_waitcnt lgkmcnt(4)
  v_mfma_f32_32x32x16_bf16 v[96:111], v[228:231], v[32:35], v[96:111]
  v_mfma_f32_32x32x16_bf16 v[112:127], v[228:231], v[36:39], v[112:127]
  v_mfma_f32_32x32x16_bf16 v[128:143], v[232:235], v[32:35], v[128:143]
  v_mfma_f32_32x32x16_bf16 v[144:159], v[232:235], v[36:39], v[144:159]
  v_mfma_f32_32x32x16_bf16 v[160:175], v[32:35], v[236:239], v[160:175]
  v_mfma_f32_32x32x16_bf16 v[176:191], v[36:39], v[236:239], v[176:191]
  buffer_load_dwordx4 v[228:231], v8, s[4:7], s24 offen offset:3072
  buffer_load_dwordx4 v[232:235], v8, s[4:7], s25 offen offset:3072
  buffer_load_dwordx4 v[236:239], v8, s[4:7], s26 offen offset:3072
  s_add_u32 s24, s24, 4096
  s_add_u32 s25, s25, 4096
  s_add_u32 s26, s26, 4096
  s_waitcnt vmcnt(9)
  ds_read_b128 v[32:35], v8 offset:38912
  ds_read_b128 v[36:39], v9 offset:38912
  s_waitcnt lgkmcnt(4)
  v_mfma_f32_32x32x16_bf16 v[96:111], v[192:195], v[16:19], v[96:111]
  v_mfma_f32_32x32x16_bf16 v[112:127], v[192:195], v[20:23], v[112:127]
  v_mfma_f32_32x32x16_bf16 v[128:143], v[196:199], v[16:19], v[128:143]
  v_mfma_f32_32x32x16_bf16 v[144:159], v[196:199], v[20:23], v[144:159]
  v_mfma_f32_32x32x16_bf16 v[160:175], v[16:19], v[200:203], v[160:175]
  v_mfma_f32_32x32x16_bf16 v[176:191], v[20:23], v[200:203], v[176:191]
  s_waitcnt vmcnt(6)
  ds_read_b128 v[16:19], v8 offset:39936
  ds_read_b128 v[20:23], v9 offset:39936
  s_waitcnt lgkmcnt(4)
  v_mfma_f32_32x32x16_bf16 v[96:111], v[204:207], v[24:27], v[96:111]
  v_mfma_f32_32x32x16_bf16 v[112:127], v[204:207], v[28:31], v[112:127]
  v_mfma_f32_32x32x16_bf16 v[128:143], v[208:211], v[24:27], v[128:143]
  v_mfma_f32_32x32x16_bf16 v[144:159], v[208:211], v[28:31], v[144:159]
  v_mfma_f32_32x32x16_bf16 v[160:175], v[24:27], v[212:215], v[160:175]
  v_mfma_f32_32x32x16_bf16 v[176:191], v[28:31], v[212:215], v[176:191]
  s_waitcnt vmcnt(3)
  s_waitcnt lgkmcnt(2)
  v_mfma_f32_32x32x16_bf16 v[96:111], v[216:219], v[32:35], v[96:111]
  v_mfma_f32_32x32x16_bf16 v[112:127], v[216:219], v[36:39], v[112:127]
  v_mfma_f32_32x32x16_bf16 v[128:143], v[220:223], v[32:35], v[128:143]
  v_mfma_f32_32x32x16_bf16 v[144:159], v[220:223], v[36:39], v[144:159]
  v_mfma_f32_32x32x16_bf16 v[160:175], v[32:35], v[224:227], v[160:175]
  v_mfma_f32_32x32x16_bf16 v[176:191], v[36:39], v[224:227], v[176:191]
  s_waitcnt vmcnt(0)
  s_waitcnt lgkmcnt(0)
  v_mfma_f32_32x32x16_bf16 v[96:111], v[228:231], v[16:19], v[96:111]
  v_mfma_f32_32x32x16_bf16 v[112:127], v[228:231], v[20:23], v[112:127]
  v_mfma_f32_32x32x16_bf16 v[128:143], v[232:235], v[16:19], v[128:143]
  v_mfma_f32_32x32x16_bf16 v[144:159], v[232:235], v[20:23], v[144:159]
  v_mfma_f32_32x32x16_bf16 v[160:175], v[16:19], v[236:239], v[160:175]
  v_mfma_f32_32x32x16_bf16 v[176:191], v[20:23], v[236:239], v[176:191]
  s_lshl_b32 s21, s18, 1
  s_lshl_b32 s22, s23, 6
  s_add_u32 s21, s21, s22
  s_lshl_b32 s21, s21, 11
  s_add_u32 s27, s21, 161480704
  s_add_u32 s28, s21, 165675008
  s_add_u32 s29, s21, 169869312
  s_mov_b32 s30, 0x3ea52b5c
  v_and_b32 v2, 31, v0
  v_cmp_eq_u32 s[32:33], 20, v2
  v_mov_b32 v3, 0x3f803f80
  v_mul_f32 v96, s30, v96
  v_mul_f32 v97, s30, v97
  v_mul_f32 v98, s30, v98
  v_mul_f32 v99, s30, v99
  v_mul_f32 v100, s30, v100
  v_mul_f32 v101, s30, v101
  v_mul_f32 v102, s30, v102
  v_mul_f32 v103, s30, v103
  v_mul_f32 v104, s30, v104
  v_mul_f32 v105, s30, v105
  v_mul_f32 v106, s30, v106
  v_mul_f32 v107, s30, v107
  v_mul_f32 v108, s30, v108
  v_mul_f32 v109, s30, v109
  v_mul_f32 v110, s30, v110
  v_mul_f32 v111, s30, v111
  v_cvt_pk_bf16_f32 v16, v96, v97
  v_cvt_pk_bf16_f32 v17, v98, v99
  v_cvt_pk_bf16_f32 v18, v100, v101
  v_cvt_pk_bf16_f32 v19, v102, v103
  v_cvt_pk_bf16_f32 v20, v104, v105
  v_cvt_pk_bf16_f32 v21, v106, v107
  v_cvt_pk_bf16_f32 v22, v108, v109
  v_cvt_pk_bf16_f32 v23, v110, v111
  buffer_store_dwordx4 v[16:19], v8, s[4:7], s27 offen offset:0
  buffer_store_dwordx4 v[20:23], v8, s[4:7], s27 offen offset:1024
  v_mul_f32 v112, s30, v112
  v_mul_f32 v113, s30, v113
  v_mul_f32 v114, s30, v114
  v_mul_f32 v115, s30, v115
  v_mul_f32 v116, s30, v116
  v_mul_f32 v117, s30, v117
  v_mul_f32 v118, s30, v118
  v_mul_f32 v119, s30, v119
  v_mul_f32 v120, s30, v120
  v_mul_f32 v121, s30, v121
  v_mul_f32 v122, s30, v122
  v_mul_f32 v123, s30, v123
  v_mul_f32 v124, s30, v124
  v_mul_f32 v125, s30, v125
  v_mul_f32 v126, s30, v126
  v_mul_f32 v127, s30, v127
  v_cvt_pk_bf16_f32 v24, v112, v113
  v_cvt_pk_bf16_f32 v25, v114, v115
  v_cvt_pk_bf16_f32 v26, v116, v117
  v_cvt_pk_bf16_f32 v27, v118, v119
  v_cvt_pk_bf16_f32 v28, v120, v121
  v_cvt_pk_bf16_f32 v29, v122, v123
  v_cvt_pk_bf16_f32 v30, v124, v125
  v_cvt_pk_bf16_f32 v31, v126, v127
  buffer_store_dwordx4 v[24:27], v8, s[4:7], s27 offen offset:2048
  buffer_store_dwordx4 v[28:31], v8, s[4:7], s27 offen offset:3072
  v_cvt_pk_bf16_f32 v16, v128, v129
  v_cvt_pk_bf16_f32 v17, v130, v131
  v_cvt_pk_bf16_f32 v18, v132, v133
  v_cvt_pk_bf16_f32 v19, v134, v135
  v_cvt_pk_bf16_f32 v20, v136, v137
  v_cvt_pk_bf16_f32 v21, v138, v139
  v_cvt_pk_bf16_f32 v22, v140, v141
  v_cvt_pk_bf16_f32 v23, v142, v143
  buffer_store_dwordx4 v[16:19], v8, s[4:7], s28 offen offset:0
  buffer_store_dwordx4 v[20:23], v8, s[4:7], s28 offen offset:1024
  v_cvt_pk_bf16_f32 v24, v144, v145
  v_cvt_pk_bf16_f32 v25, v146, v147
  v_cvt_pk_bf16_f32 v26, v148, v149
  v_cvt_pk_bf16_f32 v27, v150, v151
  v_cvt_pk_bf16_f32 v28, v152, v153
  v_cvt_pk_bf16_f32 v29, v154, v155
  v_cvt_pk_bf16_f32 v30, v156, v157
  v_cvt_pk_bf16_f32 v31, v158, v159
  buffer_store_dwordx4 v[24:27], v8, s[4:7], s28 offen offset:2048
  buffer_store_dwordx4 v[28:31], v8, s[4:7], s28 offen offset:3072
  v_cvt_pk_bf16_f32 v16, v160, v161
  v_cvt_pk_bf16_f32 v17, v162, v163
  v_cvt_pk_bf16_f32 v18, v164, v165
  v_cvt_pk_bf16_f32 v19, v166, v167
  v_cvt_pk_bf16_f32 v20, v168, v169
  v_cvt_pk_bf16_f32 v21, v170, v171
  v_cvt_pk_bf16_f32 v22, v172, v173
  v_cvt_pk_bf16_f32 v23, v174, v175
  v_cndmask_b32 v16, v16, v3, s[32:33]
  v_cndmask_b32 v17, v17, v3, s[32:33]
  v_cndmask_b32 v18, v18, v3, s[32:33]
  v_cndmask_b32 v19, v19, v3, s[32:33]
  v_cndmask_b32 v20, v20, v3, s[32:33]
  v_cndmask_b32 v21, v21, v3, s[32:33]
  v_cndmask_b32 v22, v22, v3, s[32:33]
  v_cndmask_b32 v23, v23, v3, s[32:33]
  buffer_store_dwordx4 v[16:19], v8, s[4:7], s29 offen offset:0
  buffer_store_dwordx4 v[20:23], v8, s[4:7], s29 offen offset:1024
  v_cvt_pk_bf16_f32 v24, v176, v177
  v_cvt_pk_bf16_f32 v25, v178, v179
  v_cvt_pk_bf16_f32 v26, v180, v181
  v_cvt_pk_bf16_f32 v27, v182, v183
  v_cvt_pk_bf16_f32 v28, v184, v185
  v_cvt_pk_bf16_f32 v29, v186, v187
  v_cvt_pk_bf16_f32 v30, v188, v189
  v_cvt_pk_bf16_f32 v31, v190, v191
  v_cndmask_b32 v24, v24, v3, s[32:33]
  v_cndmask_b32 v25, v25, v3, s[32:33]
  v_cndmask_b32 v26, v26, v3, s[32:33]
  v_cndmask_b32 v27, v27, v3, s[32:33]
  v_cndmask_b32 v28, v28, v3, s[32:33]
  v_cndmask_b32 v29, v29, v3, s[32:33]
  v_cndmask_b32 v30, v30, v3, s[32:33]
  v_cndmask_b32 v31, v31, v3, s[32:33]
  buffer_store_dwordx4 v[24:27], v8, s[4:7], s29 offen offset:2048
  buffer_store_dwordx4 v[28:31], v8, s[4:7], s29 offen offset:3072
qkvb_exit1:
  s_endpgm
.globl attnb_kernel
.p2align 8
.type attnb_kernel,@function
attnb_kernel:
  s_cmp_ge_u32 s2, 256
  s_cbranch_scc1 attnb_exit1
  s_load_dwordx2 s[12:13], s[0:1], 96
  v_lshrrev_b32 v2, 6, v0
  v_and_b32 v3, 63, v0
  s_nop 0
  v_readfirstlane_b32 s16, v2
  v_lshlrev_b32 v1, 4, v3
  s_and_b32 s17, s2, 7
  s_lshl_b32 s17, s17, 2
  s_lshr_b32 s18, s2, 3
  s_and_b32 s19, s18, 3
  s_add_u32 s17, s17, s19
  s_lshr_b32 s18, s18, 2
  s_waitcnt lgkmcnt(0)
  s_mov_b32 s4, s12
  s_mov_b32 s5, s13
  s_mov_b32 s6, 0x10000000
  s_mov_b32 s7, 0x20000
  s_lshl_b32 s20, s17, 17
  s_add_u32 s21, s20, 165675008
  s_add_u32 s22, s20, 169869312
  s_lshl_b32 s23, s18, 3
  s_lshl_b32 s24, s16, 1
  s_add_u32 s23, s23, s24
  s_lshl_b32 s24, s23, 11
  s_add_u32 s24, s24, s20
  s_add_u32 s24, s24, 161480704
  buffer_load_dwordx4 v[8:11], v1, s[4:7], s24 offen offset:0
  buffer_load_dwordx4 v[12:15], v1, s[4:7], s24 offen offset:1024
  buffer_load_dwordx4 v[16:19], v1, s[4:7], s24 offen offset:2048
  buffer_load_dwordx4 v[20:23], v1, s[4:7], s24 offen offset:3072
  s_mov_b32 s25, s21
  s_mov_b32 s26, s22
  buffer_load_dwordx4 v[136:139], v1, s[4:7], s25 offen
  buffer_load_dwordx4 v[140:143], v1, s[4:7], s25 offen offset:1024
  buffer_load_dwordx4 v[144:147], v1, s[4:7], s26 offen
  buffer_load_dwordx4 v[148:151], v1, s[4:7], s26 offen offset:1024
  s_add_u32 s25, s25, 2048
  s_add_u32 s26, s26, 2048
  s_waitcnt vmcnt(0)
  v_mfma_f32_32x32x16_bf16 v[88:103], v[136:139], v[8:11], 0
  v_mfma_f32_32x32x16_bf16 v[88:103], v[140:143], v[12:15], v[88:103]
  v_mfma_f32_32x32x16_bf16 v[104:119], v[136:139], v[16:19], 0
  v_mfma_f32_32x32x16_bf16 v[104:119], v[140:143], v[20:23], v[104:119]
  s_nop 9
  v_max3_f32 v2, v88, v89, v90
  v_max3_f32 v2, v2, v91, v92
  v_max3_f32 v2, v2, v93, v94
  v_max3_f32 v2, v2, v95, v96
  v_max3_f32 v2, v2, v97, v98
  v_max3_f32 v2, v2, v99, v100
  v_max3_f32 v2, v2, v101, v102
  v_max_f32 v2, v2, v103
  v_mov_b32 v4, v2
  s_nop 1
  v_permlane32_swap_b32 v2, v4
  v_max_f32 v2, v2, v4
  v_sub_f32 v24, 0, v2
  v_sub_f32 v25, 0, v2
  v_sub_f32 v26, 0, v2
  v_sub_f32 v27, 0, v2
  v_sub_f32 v28, 0, v2
  v_sub_f32 v29, 0, v2
  v_sub_f32 v30, 0, v2
  v_sub_f32 v31, 0, v2
  v_sub_f32 v32, 0, v2
  v_sub_f32 v33, 0, v2
  v_sub_f32 v34, 0, v2
  v_sub_f32 v35, 0, v2
  v_sub_f32 v36, 0, v2
  v_sub_f32 v37, 0, v2
  v_sub_f32 v38, 0, v2
  v_sub_f32 v39, 0, v2
  v_max3_f32 v3, v104, v105, v106
  v_max3_f32 v3, v3, v107, v108
  v_max3_f32 v3, v3, v109, v110
  v_max3_f32 v3, v3, v111, v112
  v_max3_f32 v3, v3, v113, v114
  v_max3_f32 v3, v3, v115, v116
  v_max3_f32 v3, v3, v117, v118
  v_max_f32 v3, v3, v119
  v_mov_b32 v4, v3
  s_nop 1
  v_permlane32_swap_b32 v3, v4
  v_max_f32 v3, v3, v4
  v_sub_f32 v40, 0, v3
  v_sub_f32 v41, 0, v3
  v_sub_f32 v42, 0, v3
  v_sub_f32 v43, 0, v3
  v_sub_f32 v44, 0, v3
  v_sub_f32 v45, 0, v3
  v_sub_f32 v46, 0, v3
  v_sub_f32 v47, 0, v3
  v_sub_f32 v48, 0, v3
  v_sub_f32 v49, 0, v3
  v_sub_f32 v50, 0, v3
  v_sub_f32 v51, 0, v3
  v_sub_f32 v52, 0, v3
  v_sub_f32 v53, 0, v3
  v_sub_f32 v54, 0, v3
  v_sub_f32 v55, 0, v3
  s_mov_b32 s28, 0
attnb_main2:
  s_mov_b32 s25, s21
  s_mov_b32 s26, s22
  buffer_load_dwordx4 v[136:139], v1, s[4:7], s25 offen
  buffer_load_dwordx4 v[140:143], v1, s[4:7], s25 offen offset:1024
  buffer_load_dwordx4 v[144:147], v1, s[4:7], s26 offen
  buffer_load_dwordx4 v[148:151], v1, s[4:7], s26 offen offset:1024
  s_add_u32 s25, s25, 2048
  s_add_u32 s26, s26, 2048
  buffer_load_dwordx4 v[152:155], v1, s[4:7], s25 offen
  buffer_load_dwordx4 v[156:159], v1, s[4:7], s25 offen offset:1024
  buffer_load_dwordx4 v[160:163], v1, s[4:7], s26 offen
  buffer_load_dwordx4 v[164:167], v1, s[4:7], s26 offen offset:1024
  s_add_u32 s25, s25, 2048
  s_add_u32 s26, s26, 2048
  v_mov_b32 v56, 0
  v_mov_b32 v57, 0
  v_mov_b32 v58, 0
  v_mov_b32 v59, 0
  v_mov_b32 v60, 0
  v_mov_b32 v61, 0
  v_mov_b32 v62, 0
  v_mov_b32 v63, 0
  v_mov_b32 v64, 0
  v_mov_b32 v65, 0
  v_mov_b32 v66, 0
  v_mov_b32 v67, 0
  v_mov_b32 v68, 0
  v_mov_b32 v69, 0
  v_mov_b32 v70, 0
  v_mov_b32 v71, 0
  v_mov_b32 v72, 0
  v_mov_b32 v73, 0
  v_mov_b32 v74, 0
  v_mov_b32 v75, 0
  v_mov_b32 v76, 0
  v_mov_b32 v77, 0
  v_mov_b32 v78, 0
  v_mov_b32 v79, 0
  v_mov_b32 v80, 0
  v_mov_b32 v81, 0
  v_mov_b32 v82, 0
  v_mov_b32 v83, 0
  v_mov_b32 v84, 0
  v_mov_b32 v85, 0
  v_mov_b32 v86, 0
  v_mov_b32 v87, 0
  s_mov_b32 s27, 0
attnb_loop3:
  buffer_load_dwordx4 v[168:171], v1, s[4:7], s25 offen
  buffer_load_dwordx4 v[172:175], v1, s[4:7], s25 offen offset:1024
  buffer_load_dwordx4 v[176:179], v1, s[4:7], s26 offen
  buffer_load_dwordx4 v[180:183], v1, s[4:7], s26 offen offset:1024
  s_add_u32 s25, s25, 2048
  s_add_u32 s26, s26, 2048
  s_waitcnt vmcnt(8)
  v_mfma_f32_32x32x16_bf16 v[88:103], v[136:139], v[8:11], v[24:39]
  v_mfma_f32_32x32x16_bf16 v[88:103], v[140:143], v[12:15], v[88:103]
  v_mfma_f32_32x32x16_bf16 v[104:119], v[136:139], v[16:19], v[40:55]
  v_mfma_f32_32x32x16_bf16 v[104:119], v[140:143], v[20:23], v[104:119]
  s_nop 9
  v_exp_f32 v88, v88
  v_exp_f32 v89, v89
  v_exp_f32 v90, v90
  v_exp_f32 v91, v91
  v_exp_f32 v92, v92
  v_exp_f32 v93, v93
  v_exp_f32 v94, v94
  v_exp_f32 v95, v95
  v_exp_f32 v96, v96
  v_exp_f32 v97, v97
  v_exp_f32 v98, v98
  v_exp_f32 v99, v99
  v_exp_f32 v100, v100
  v_exp_f32 v101, v101
  v_exp_f32 v102, v102
  v_exp_f32 v103, v103
  v_cvt_pk_bf16_f32 v120, v88, v89
  v_cvt_pk_bf16_f32 v121, v90, v91
  v_cvt_pk_bf16_f32 v122, v92, v93
  v_cvt_pk_bf16_f32 v123, v94, v95
  v_cvt_pk_bf16_f32 v124, v96, v97
  v_cvt_pk_bf16_f32 v125, v98, v99
  v_cvt_pk_bf16_f32 v126, v100, v101
  v_cvt_pk_bf16_f32 v127, v102, v103
  v_mfma_f32_32x32x16_bf16 v[56:71], v[144:147], v[120:123], v[56:71]
  s_nop 0
  v_mfma_f32_32x32x16_bf16 v[56:71], v[148:151], v[124:127], v[56:71]
  v_exp_f32 v104, v104
  v_exp_f32 v105, v105
  v_exp_f32 v106, v106
  v_exp_f32 v107, v107
  v_exp_f32 v108, v108
  v_exp_f32 v109, v109
  v_exp_f32 v110, v110
  v_exp_f32 v111, v111
  v_exp_f32 v112, v112
  v_exp_f32 v113, v113
  v_exp_f32 v114, v114
  v_exp_f32 v115, v115
  v_exp_f32 v116, v116
  v_exp_f32 v117, v117
  v_exp_f32 v118, v118
  v_exp_f32 v119, v119
  v_cvt_pk_bf16_f32 v128, v104, v105
  v_cvt_pk_bf16_f32 v129, v106, v107
  v_cvt_pk_bf16_f32 v130, v108, v109
  v_cvt_pk_bf16_f32 v131, v110, v111
  v_cvt_pk_bf16_f32 v132, v112, v113
  v_cvt_pk_bf16_f32 v133, v114, v115
  v_cvt_pk_bf16_f32 v134, v116, v117
  v_cvt_pk_bf16_f32 v135, v118, v119
  v_mfma_f32_32x32x16_bf16 v[72:87], v[144:147], v[128:131], v[72:87]
  s_nop 0
  v_mfma_f32_32x32x16_bf16 v[72:87], v[148:151], v[132:135], v[72:87]
  buffer_load_dwordx4 v[136:139], v1, s[4:7], s25 offen
  buffer_load_dwordx4 v[140:143], v1, s[4:7], s25 offen offset:1024
  buffer_load_dwordx4 v[144:147], v1, s[4:7], s26 offen
  buffer_load_dwordx4 v[148:151], v1, s[4:7], s26 offen offset:1024
  s_add_u32 s25, s25, 2048
  s_add_u32 s26, s26, 2048
  s_waitcnt vmcnt(8)
  v_mfma_f32_32x32x16_bf16 v[88:103], v[152:155], v[8:11], v[24:39]
  v_mfma_f32_32x32x16_bf16 v[88:103], v[156:159], v[12:15], v[88:103]
  v_mfma_f32_32x32x16_bf16 v[104:119], v[152:155], v[16:19], v[40:55]
  v_mfma_f32_32x32x16_bf16 v[104:119], v[156:159], v[20:23], v[104:119]
  s_nop 9
  v_exp_f32 v88, v88
  v_exp_f32 v89, v89
  v_exp_f32 v90, v90
  v_exp_f32 v91, v91
  v_exp_f32 v92, v92
  v_exp_f32 v93, v93
  v_exp_f32 v94, v94
  v_exp_f32 v95, v95
  v_exp_f32 v96, v96
  v_exp_f32 v97, v97
  v_exp_f32 v98, v98
  v_exp_f32 v99, v99
  v_exp_f32 v100, v100
  v_exp_f32 v101, v101
  v_exp_f32 v102, v102
  v_exp_f32 v103, v103
  v_cvt_pk_bf16_f32 v120, v88, v89
  v_cvt_pk_bf16_f32 v121, v90, v91
  v_cvt_pk_bf16_f32 v122, v92, v93
  v_cvt_pk_bf16_f32 v123, v94, v95
  v_cvt_pk_bf16_f32 v124, v96, v97
  v_cvt_pk_bf16_f32 v125, v98, v99
  v_cvt_pk_bf16_f32 v126, v100, v101
  v_cvt_pk_bf16_f32 v127, v102, v103
  v_mfma_f32_32x32x16_bf16 v[56:71], v[160:163], v[120:123], v[56:71]
  s_nop 0
  v_mfma_f32_32x32x16_bf16 v[56:71], v[164:167], v[124:127], v[56:71]
  v_exp_f32 v104, v104
  v_exp_f32 v105, v105
  v_exp_f32 v106, v106
  v_exp_f32 v107, v107
  v_exp_f32 v108, v108
  v_exp_f32 v109, v109
  v_exp_f32 v110, v110
  v_exp_f32 v111, v111
  v_exp_f32 v112, v112
  v_exp_f32 v113, v113
  v_exp_f32 v114, v114
  v_exp_f32 v115, v115
  v_exp_f32 v116, v116
  v_exp_f32 v117, v117
  v_exp_f32 v118, v118
  v_exp_f32 v119, v119
  v_cvt_pk_bf16_f32 v128, v104, v105
  v_cvt_pk_bf16_f32 v129, v106, v107
  v_cvt_pk_bf16_f32 v130, v108, v109
  v_cvt_pk_bf16_f32 v131, v110, v111
  v_cvt_pk_bf16_f32 v132, v112, v113
  v_cvt_pk_bf16_f32 v133, v114, v115
  v_cvt_pk_bf16_f32 v134, v116, v117
  v_cvt_pk_bf16_f32 v135, v118, v119
  v_mfma_f32_32x32x16_bf16 v[72:87], v[160:163], v[128:131], v[72:87]
  s_nop 0
  v_mfma_f32_32x32x16_bf16 v[72:87], v[164:167], v[132:135], v[72:87]
  buffer_load_dwordx4 v[152:155], v1, s[4:7], s25 offen
  buffer_load_dwordx4 v[156:159], v1, s[4:7], s25 offen offset:1024
  buffer_load_dwordx4 v[160:163], v1, s[4:7], s26 offen
  buffer_load_dwordx4 v[164:167], v1, s[4:7], s26 offen offset:1024
  s_add_u32 s25, s25, 2048
  s_add_u32 s26, s26, 2048
  s_waitcnt vmcnt(8)
  v_mfma_f32_32x32x16_bf16 v[88:103], v[168:171], v[8:11], v[24:39]
  v_mfma_f32_32x32x16_bf16 v[88:103], v[172:175], v[12:15], v[88:103]
  v_mfma_f32_32x32x16_bf16 v[104:119], v[168:171], v[16:19], v[40:55]
  v_mfma_f32_32x32x16_bf16 v[104:119], v[172:175], v[20:23], v[104:119]
  s_nop 9
  v_exp_f32 v88, v88
  v_exp_f32 v89, v89
  v_exp_f32 v90, v90
  v_exp_f32 v91, v91
  v_exp_f32 v92, v92
  v_exp_f32 v93, v93
  v_exp_f32 v94, v94
  v_exp_f32 v95, v95
  v_exp_f32 v96, v96
  v_exp_f32 v97, v97
  v_exp_f32 v98, v98
  v_exp_f32 v99, v99
  v_exp_f32 v100, v100
  v_exp_f32 v101, v101
  v_exp_f32 v102, v102
  v_exp_f32 v103, v103
  v_cvt_pk_bf16_f32 v120, v88, v89
  v_cvt_pk_bf16_f32 v121, v90, v91
  v_cvt_pk_bf16_f32 v122, v92, v93
  v_cvt_pk_bf16_f32 v123, v94, v95
  v_cvt_pk_bf16_f32 v124, v96, v97
  v_cvt_pk_bf16_f32 v125, v98, v99
  v_cvt_pk_bf16_f32 v126, v100, v101
  v_cvt_pk_bf16_f32 v127, v102, v103
  v_mfma_f32_32x32x16_bf16 v[56:71], v[176:179], v[120:123], v[56:71]
  s_nop 0
  v_mfma_f32_32x32x16_bf16 v[56:71], v[180:183], v[124:127], v[56:71]
  v_exp_f32 v104, v104
  v_exp_f32 v105, v105
  v_exp_f32 v106, v106
  v_exp_f32 v107, v107
  v_exp_f32 v108, v108
  v_exp_f32 v109, v109
  v_exp_f32 v110, v110
  v_exp_f32 v111, v111
  v_exp_f32 v112, v112
  v_exp_f32 v113, v113
  v_exp_f32 v114, v114
  v_exp_f32 v115, v115
  v_exp_f32 v116, v116
  v_exp_f32 v117, v117
  v_exp_f32 v118, v118
  v_exp_f32 v119, v119
  v_cvt_pk_bf16_f32 v128, v104, v105
  v_cvt_pk_bf16_f32 v129, v106, v107
  v_cvt_pk_bf16_f32 v130, v108, v109
  v_cvt_pk_bf16_f32 v131, v110, v111
  v_cvt_pk_bf16_f32 v132, v112, v113
  v_cvt_pk_bf16_f32 v133, v114, v115
  v_cvt_pk_bf16_f32 v134, v116, v117
  v_cvt_pk_bf16_f32 v135, v118, v119
  v_mfma_f32_32x32x16_bf16 v[72:87], v[176:179], v[128:131], v[72:87]
  s_nop 0
  v_mfma_f32_32x32x16_bf16 v[72:87], v[180:183], v[132:135], v[72:87]
  s_add_u32 s27, s27, 1
  s_cmp_lt_u32 s27, 20
  s_cbranch_scc1 attnb_loop3
  buffer_load_dwordx4 v[168:171], v1, s[4:7], s25 offen
  buffer_load_dwordx4 v[172:175], v1, s[4:7], s25 offen offset:1024
  buffer_load_dwordx4 v[176:179], v1, s[4:7], s26 offen
  buffer_load_dwordx4 v[180:183], v1, s[4:7], s26 offen offset:1024
  s_add_u32 s25, s25, 2048
  s_add_u32 s26, s26, 2048
  s_waitcnt vmcnt(8)
  v_mfma_f32_32x32x16_bf16 v[88:103], v[136:139], v[8:11], v[24:39]
  v_mfma_f32_32x32x16_bf16 v[88:103], v[140:143], v[12:15], v[88:103]
  v_mfma_f32_32x32x16_bf16 v[104:119], v[136:139], v[16:19], v[40:55]
  v_mfma_f32_32x32x16_bf16 v[104:119], v[140:143], v[20:23], v[104:119]
  s_nop 9
  v_exp_f32 v88, v88
  v_exp_f32 v89, v89
  v_exp_f32 v90, v90
  v_exp_f32 v91, v91
  v_exp_f32 v92, v92
  v_exp_f32 v93, v93
  v_exp_f32 v94, v94
  v_exp_f32 v95, v95
  v_exp_f32 v96, v96
  v_exp_f32 v97, v97
  v_exp_f32 v98, v98
  v_exp_f32 v99, v99
  v_exp_f32 v100, v100
  v_exp_f32 v101, v101
  v_exp_f32 v102, v102
  v_exp_f32 v103, v103
  v_cvt_pk_bf16_f32 v120, v88, v89
  v_cvt_pk_bf16_f32 v121, v90, v91
  v_cvt_pk_bf16_f32 v122, v92, v93
  v_cvt_pk_bf16_f32 v123, v94, v95
  v_cvt_pk_bf16_f32 v124, v96, v97
  v_cvt_pk_bf16_f32 v125, v98, v99
  v_cvt_pk_bf16_f32 v126, v100, v101
  v_cvt_pk_bf16_f32 v127, v102, v103
  v_mfma_f32_32x32x16_bf16 v[56:71], v[144:147], v[120:123], v[56:71]
  s_nop 0
  v_mfma_f32_32x32x16_bf16 v[56:71], v[148:151], v[124:127], v[56:71]
  v_exp_f32 v104, v104
  v_exp_f32 v105, v105
  v_exp_f32 v106, v106
  v_exp_f32 v107, v107
  v_exp_f32 v108, v108
  v_exp_f32 v109, v109
  v_exp_f32 v110, v110
  v_exp_f32 v111, v111
  v_exp_f32 v112, v112
  v_exp_f32 v113, v113
  v_exp_f32 v114, v114
  v_exp_f32 v115, v115
  v_exp_f32 v116, v116
  v_exp_f32 v117, v117
  v_exp_f32 v118, v118
  v_exp_f32 v119, v119
  v_cvt_pk_bf16_f32 v128, v104, v105
  v_cvt_pk_bf16_f32 v129, v106, v107
  v_cvt_pk_bf16_f32 v130, v108, v109
  v_cvt_pk_bf16_f32 v131, v110, v111
  v_cvt_pk_bf16_f32 v132, v112, v113
  v_cvt_pk_bf16_f32 v133, v114, v115
  v_cvt_pk_bf16_f32 v134, v116, v117
  v_cvt_pk_bf16_f32 v135, v118, v119
  v_mfma_f32_32x32x16_bf16 v[72:87], v[144:147], v[128:131], v[72:87]
  s_nop 0
  v_mfma_f32_32x32x16_bf16 v[72:87], v[148:151], v[132:135], v[72:87]
  buffer_load_dwordx4 v[136:139], v1, s[4:7], s25 offen
  buffer_load_dwordx4 v[140:143], v1, s[4:7], s25 offen offset:1024
  buffer_load_dwordx4 v[144:147], v1, s[4:7], s26 offen
  buffer_load_dwordx4 v[148:151], v1, s[4:7], s26 offen offset:1024
  s_add_u32 s25, s25, 2048
  s_add_u32 s26, s26, 2048
  s_waitcnt vmcnt(8)
  v_mfma_f32_32x32x16_bf16 v[88:103], v[152:155], v[8:11], v[24:39]
  v_mfma_f32_32x32x16_bf16 v[88:103], v[156:159], v[12:15], v[88:103]
  v_mfma_f32_32x32x16_bf16 v[104:119], v[152:155], v[16:19], v[40:55]
  v_mfma_f32_32x32x16_bf16 v[104:119], v[156:159], v[20:23], v[104:119]
  s_nop 9
  v_exp_f32 v88, v88
  v_exp_f32 v89, v89
  v_exp_f32 v90, v90
  v_exp_f32 v91, v91
  v_exp_f32 v92, v92
  v_exp_f32 v93, v93
  v_exp_f32 v94, v94
  v_exp_f32 v95, v95
  v_exp_f32 v96, v96
  v_exp_f32 v97, v97
  v_exp_f32 v98, v98
  v_exp_f32 v99, v99
  v_exp_f32 v100, v100
  v_exp_f32 v101, v101
  v_exp_f32 v102, v102
  v_exp_f32 v103, v103
  v_cvt_pk_bf16_f32 v120, v88, v89
  v_cvt_pk_bf16_f32 v121, v90, v91
  v_cvt_pk_bf16_f32 v122, v92, v93
  v_cvt_pk_bf16_f32 v123, v94, v95
  v_cvt_pk_bf16_f32 v124, v96, v97
  v_cvt_pk_bf16_f32 v125, v98, v99
  v_cvt_pk_bf16_f32 v126, v100, v101
  v_cvt_pk_bf16_f32 v127, v102, v103
  v_mfma_f32_32x32x16_bf16 v[56:71], v[160:163], v[120:123], v[56:71]
  s_nop 0
  v_mfma_f32_32x32x16_bf16 v[56:71], v[164:167], v[124:127], v[56:71]
  v_exp_f32 v104, v104
  v_exp_f32 v105, v105
  v_exp_f32 v106, v106
  v_exp_f32 v107, v107
  v_exp_f32 v108, v108
  v_exp_f32 v109, v109
  v_exp_f32 v110, v110
  v_exp_f32 v111, v111
  v_exp_f32 v112, v112
  v_exp_f32 v113, v113
  v_exp_f32 v114, v114
  v_exp_f32 v115, v115
  v_exp_f32 v116, v116
  v_exp_f32 v117, v117
  v_exp_f32 v118, v118
  v_exp_f32 v119, v119
  v_cvt_pk_bf16_f32 v128, v104, v105
  v_cvt_pk_bf16_f32 v129, v106, v107
  v_cvt_pk_bf16_f32 v130, v108, v109
  v_cvt_pk_bf16_f32 v131, v110, v111
  v_cvt_pk_bf16_f32 v132, v112, v113
  v_cvt_pk_bf16_f32 v133, v114, v115
  v_cvt_pk_bf16_f32 v134, v116, v117
  v_cvt_pk_bf16_f32 v135, v118, v119
  v_mfma_f32_32x32x16_bf16 v[72:87], v[160:163], v[128:131], v[72:87]
  s_nop 0
  v_mfma_f32_32x32x16_bf16 v[72:87], v[164:167], v[132:135], v[72:87]
  s_waitcnt vmcnt(4)
  v_mfma_f32_32x32x16_bf16 v[88:103], v[168:171], v[8:11], v[24:39]
  v_mfma_f32_32x32x16_bf16 v[88:103], v[172:175], v[12:15], v[88:103]
  v_mfma_f32_32x32x16_bf16 v[104:119], v[168:171], v[16:19], v[40:55]
  v_mfma_f32_32x32x16_bf16 v[104:119], v[172:175], v[20:23], v[104:119]
  s_nop 9
  v_exp_f32 v88, v88
  v_exp_f32 v89, v89
  v_exp_f32 v90, v90
  v_exp_f32 v91, v91
  v_exp_f32 v92, v92
  v_exp_f32 v93, v93
  v_exp_f32 v94, v94
  v_exp_f32 v95, v95
  v_exp_f32 v96, v96
  v_exp_f32 v97, v97
  v_exp_f32 v98, v98
  v_exp_f32 v99, v99
  v_exp_f32 v100, v100
  v_exp_f32 v101, v101
  v_exp_f32 v102, v102
  v_exp_f32 v103, v103
  v_cvt_pk_bf16_f32 v120, v88, v89
  v_cvt_pk_bf16_f32 v121, v90, v91
  v_cvt_pk_bf16_f32 v122, v92, v93
  v_cvt_pk_bf16_f32 v123, v94, v95
  v_cvt_pk_bf16_f32 v124, v96, v97
  v_cvt_pk_bf16_f32 v125, v98, v99
  v_cvt_pk_bf16_f32 v126, v100, v101
  v_cvt_pk_bf16_f32 v127, v102, v103
  v_mfma_f32_32x32x16_bf16 v[56:71], v[176:179], v[120:123], v[56:71]
  s_nop 0
  v_mfma_f32_32x32x16_bf16 v[56:71], v[180:183], v[124:127], v[56:71]
  v_exp_f32 v104, v104
  v_exp_f32 v105, v105
  v_exp_f32 v106, v106
  v_exp_f32 v107, v107
  v_exp_f32 v108, v108
  v_exp_f32 v109, v109
  v_exp_f32 v110, v110
  v_exp_f32 v111, v111
  v_exp_f32 v112, v112
  v_exp_f32 v113, v113
  v_exp_f32 v114, v114
  v_exp_f32 v115, v115
  v_exp_f32 v116, v116
  v_exp_f32 v117, v117
  v_exp_f32 v118, v118
  v_exp_f32 v119, v119
  v_cvt_pk_bf16_f32 v128, v104, v105
  v_cvt_pk_bf16_f32 v129, v106, v107
  v_cvt_pk_bf16_f32 v130, v108, v109
  v_cvt_pk_bf16_f32 v131, v110, v111
  v_cvt_pk_bf16_f32 v132, v112, v113
  v_cvt_pk_bf16_f32 v133, v114, v115
  v_cvt_pk_bf16_f32 v134, v116, v117
  v_cvt_pk_bf16_f32 v135, v118, v119
  v_mfma_f32_32x32x16_bf16 v[72:87], v[176:179], v[128:131], v[72:87]
  s_nop 0
  v_mfma_f32_32x32x16_bf16 v[72:87], v[180:183], v[132:135], v[72:87]
  s_waitcnt vmcnt(0)
  v_mfma_f32_32x32x16_bf16 v[88:103], v[136:139], v[8:11], v[24:39]
  v_mfma_f32_32x32x16_bf16 v[88:103], v[140:143], v[12:15], v[88:103]
  v_mfma_f32_32x32x16_bf16 v[104:119], v[136:139], v[16:19], v[40:55]
  v_mfma_f32_32x32x16_bf16 v[104:119], v[140:143], v[20:23], v[104:119]
  s_nop 9
  v_exp_f32 v88, v88
  v_exp_f32 v89, v89
  v_exp_f32 v90, v90
  v_exp_f32 v91, v91
  v_exp_f32 v92, v92
  v_exp_f32 v93, v93
  v_exp_f32 v94, v94
  v_exp_f32 v95, v95
  v_exp_f32 v96, v96
  v_exp_f32 v97, v97
  v_exp_f32 v98, v98
  v_exp_f32 v99, v99
  v_exp_f32 v100, v100
  v_exp_f32 v101, v101
  v_exp_f32 v102, v102
  v_exp_f32 v103, v103
  v_cvt_pk_bf16_f32 v120, v88, v89
  v_cvt_pk_bf16_f32 v121, v90, v91
  v_cvt_pk_bf16_f32 v122, v92, v93
  v_cvt_pk_bf16_f32 v123, v94, v95
  v_cvt_pk_bf16_f32 v124, v96, v97
  v_cvt_pk_bf16_f32 v125, v98, v99
  v_cvt_pk_bf16_f32 v126, v100, v101
  v_cvt_pk_bf16_f32 v127, v102, v103
  v_mfma_f32_32x32x16_bf16 v[56:71], v[144:147], v[120:123], v[56:71]
  s_nop 0
  v_mfma_f32_32x32x16_bf16 v[56:71], v[148:151], v[124:127], v[56:71]
  v_exp_f32 v104, v104
  v_exp_f32 v105, v105
  v_exp_f32 v106, v106
  v_exp_f32 v107, v107
  v_exp_f32 v108, v108
  v_exp_f32 v109, v109
  v_exp_f32 v110, v110
  v_exp_f32 v111, v111
  v_exp_f32 v112, v112
  v_exp_f32 v113, v113
  v_exp_f32 v114, v114
  v_exp_f32 v115, v115
  v_exp_f32 v116, v116
  v_exp_f32 v117, v117
  v_exp_f32 v118, v118
  v_exp_f32 v119, v119
  v_cvt_pk_bf16_f32 v128, v104, v105
  v_cvt_pk_bf16_f32 v129, v106, v107
  v_cvt_pk_bf16_f32 v130, v108, v109
  v_cvt_pk_bf16_f32 v131, v110, v111
  v_cvt_pk_bf16_f32 v132, v112, v113
  v_cvt_pk_bf16_f32 v133, v114, v115
  v_cvt_pk_bf16_f32 v134, v116, v117
  v_cvt_pk_bf16_f32 v135, v118, v119
  v_mfma_f32_32x32x16_bf16 v[72:87], v[144:147], v[128:131], v[72:87]
  s_nop 0
  v_mfma_f32_32x32x16_bf16 v[72:87], v[148:151], v[132:135], v[72:87]
  v_mov_b32 v2, v64
  v_mov_b32 v4, v2
  s_nop 1
  v_permlane32_swap_b32 v4, v2
  s_nop 6
  v_mov_b32 v3, v80
  v_mov_b32 v4, v3
  s_nop 1
  v_permlane32_swap_b32 v4, v3
  s_cmp_eq_u32 s28, 1
  s_cbranch_scc1 attnb_done5
  v_max_f32 v4, v2, v3
  v_cmp_nge_f32 vcc, 0x53800000, v4
  v_cmp_u_f32 s[30:31], v2, v3
  s_nop 3
  s_or_b64 vcc, vcc, s[30:31]
  s_cbranch_vccz attnb_done5
  s_mov_b32 s25, s21
  s_mov_b32 s27, 0
  v_mov_b32 v120, 0xff800000
  v_mov_b32 v121, 0xff800000
attnb_fb4:
  buffer_load_dwordx4 v[136:139], v1, s[4:7], s25 offen
  buffer_load_dwordx4 v[140:143], v1, s[4:7], s25 offen offset:1024
  s_add_u32 s25, s25, 2048
  s_waitcnt vmcnt(0)
  v_mfma_f32_32x32x16_bf16 v[88:103], v[136:139], v[8:11], 0
  v_mfma_f32_32x32x16_bf16 v[88:103], v[140:143], v[12:15], v[88:103]
  v_mfma_f32_32x32x16_bf16 v[104:119], v[136:139], v[16:19], 0
  v_mfma_f32_32x32x16_bf16 v[104:119], v[140:143], v[20:23], v[104:119]
  s_nop 9
  v_max3_f32 v2, v88, v89, v90
  v_max3_f32 v2, v2, v91, v92
  v_max3_f32 v2, v2, v93, v94
  v_max3_f32 v2, v2, v95, v96
  v_max3_f32 v2, v2, v97, v98
  v_max3_f32 v2, v2, v99, v100
  v_max3_f32 v2, v2, v101, v102
  v_max_f32 v2, v2, v103
  v_max_f32 v120, v120, v2
  v_max3_f32 v3, v104, v105, v106
  v_max3_f32 v3, v3, v107, v108
  v_max3_f32 v3, v3, v109, v110
  v_max3_f32 v3, v3, v111, v112
  v_max3_f32 v3, v3, v113, v114
  v_max3_f32 v3, v3, v115, v116
  v_max3_f32 v3, v3, v117, v118
  v_max_f32 v3, v3, v119
  v_max_f32 v121, v121, v3
  s_add_u32 s27, s27, 1
  s_cmp_lt_u32 s27, 64
  s_cbranch_scc1 attnb_fb4
  v_mov_b32 v4, v120
  s_nop 1
  v_permlane32_swap_b32 v120, v4
  v_max_f32 v120, v120, v4
  v_sub_f32 v24, 0, v120
  v_sub_f32 v25, 0, v120
  v_sub_f32 v26, 0, v120
  v_sub_f32 v27, 0, v120
  v_sub_f32 v28, 0, v120
  v_sub_f32 v29, 0, v120
  v_sub_f32 v30, 0, v120
  v_sub_f32 v31, 0, v120
  v_sub_f32 v32, 0, v120
  v_sub_f32 v33, 0, v120
  v_sub_f32 v34, 0, v120
  v_sub_f32 v35, 0, v120
  v_sub_f32 v36, 0, v120
  v_sub_f32 v37, 0, v120
  v_sub_f32 v38, 0, v120
  v_sub_f32 v39, 0, v120
  v_mov_b32 v4, v121
  s_nop 1
  v_permlane32_swap_b32 v121, v4
  v_max_f32 v121, v121, v4
  v_sub_f32 v40, 0, v121
  v_sub_f32 v41, 0, v121
  v_sub_f32 v42, 0, v121
  v_sub_f32 v43, 0, v121
  v_sub_f32 v44, 0, v121
  v_sub_f32 v45, 0, v121
  v_sub_f32 v46, 0, v121
  v_sub_f32 v47, 0, v121
  v_sub_f32 v48, 0, v121
  v_sub_f32 v49, 0, v121
  v_sub_f32 v50, 0, v121
  v_sub_f32 v51, 0, v121
  v_sub_f32 v52, 0, v121
  v_sub_f32 v53, 0, v121
  v_sub_f32 v54, 0, v121
  v_sub_f32 v55, 0, v121
  s_mov_b32 s28, 1
  s_branch attnb_main2
attnb_done5:
  v_and_b32 v136, 63, v0
  v_and_b32 v137, 15, v136
  v_lshlrev_b32 v137, 4, v137
  v_lshrrev_b32 v138, 5, v136
  v_lshl_add_u32 v137, v138, 8, v137
  v_bfe_u32 v138, v136, 4, 1
  v_lshl_add_u32 v137, v138, 15, v137
  s_lshl_b32 s24, s23, 16
  s_lshl_b32 s25, s17, 10
  s_add_u32 s24, s24, s25
  s_add_u32 s24, s24, 174063616
  v_rcp_f32 v4, v2
  s_nop 0
  v_mul_f32 v56, v56, v4
  v_mul_f32 v57, v57, v4
  v_mul_f32 v58, v58, v4
  v_mul_f32 v59, v59, v4
  v_mul_f32 v60, v60, v4
  v_mul_f32 v61, v61, v4
  v_mul_f32 v62, v62, v4
  v_mul_f32 v63, v63, v4
  v_mul_f32 v64, v64, v4
  v_mul_f32 v65, v65, v4
  v_mul_f32 v66, v66, v4
  v_mul_f32 v67, v67, v4
  v_mul_f32 v68, v68, v4
  v_mul_f32 v69, v69, v4
  v_mul_f32 v70, v70, v4
  v_mul_f32 v71, v71, v4
  v_cvt_pk_bf16_f32 v120, v56, v57
  v_cvt_pk_bf16_f32 v121, v58, v59
  v_cvt_pk_bf16_f32 v122, v60, v61
  v_cvt_pk_bf16_f32 v123, v62, v63
  v_cvt_pk_bf16_f32 v124, v64, v65
  v_cvt_pk_bf16_f32 v125, v66, v67
  v_cvt_pk_bf16_f32 v126, v68, v69
  v_cvt_pk_bf16_f32 v127, v70, v71
  buffer_store_dwordx4 v[120:123], v137, s[4:7], s24 offen
  buffer_store_dwordx4 v[124:127], v137, s[4:7], s24 offen offset:512
  v_rcp_f32 v4, v3
  s_nop 0
  v_mul_f32 v72, v72, v4
  v_mul_f32 v73, v73, v4
  v_mul_f32 v74, v74, v4
  v_mul_f32 v75, v75, v4
  v_mul_f32 v76, v76, v4
  v_mul_f32 v77, v77, v4
  v_mul_f32 v78, v78, v4
  v_mul_f32 v79, v79, v4
  v_mul_f32 v80, v80, v4
  v_mul_f32 v81, v81, v4
  v_mul_f32 v82, v82, v4
  v_mul_f32 v83, v83, v4
  v_mul_f32 v84, v84, v4
  v_mul_f32 v85, v85, v4
  v_mul_f32 v86, v86, v4
  v_mul_f32 v87, v87, v4
  v_cvt_pk_bf16_f32 v128, v72, v73
  v_cvt_pk_bf16_f32 v129, v74, v75
  v_cvt_pk_bf16_f32 v130, v76, v77
  v_cvt_pk_bf16_f32 v131, v78, v79
  v_cvt_pk_bf16_f32 v132, v80, v81
  v_cvt_pk_bf16_f32 v133, v82, v83
  v_cvt_pk_bf16_f32 v134, v84, v85
  v_cvt_pk_bf16_f32 v135, v86, v87
  s_add_u32 s24, s24, 65536
  buffer_store_dwordx4 v[128:131], v137, s[4:7], s24 offen
  buffer_store_dwordx4 v[132:135], v137, s[4:7], s24 offen offset:512
attnb_exit1:
  s_endpgm
.globl outb1_kernel
.p2align 8
.type outb1_kernel,@function
outb1_kernel:
  s_cmp_ge_u32 s2, 256
  s_cbranch_scc1 outb1_exit1
  s_load_dwordx2 s[12:13], s[0:1], 96
  s_load_dwordx2 s[14:15], s[0:1], 0
  s_load_dwordx2 s[48:49], s[0:1], 80
  v_lshrrev_b32 v3, 6, v0
  v_and_b32 v4, 63, v0
  s_nop 0
  v_readfirstlane_b32 s16, v3
  v_lshlrev_b32 v1, 4, v4
  s_and_b32 s17, s2, 7
  s_lshl_b32 s17, s17, 2
  s_lshr_b32 s18, s2, 3
  s_and_b32 s19, s18, 3
  s_add_u32 s17, s17, s19
  s_lshr_b32 s18, s18, 2
  s_waitcnt lgkmcnt(0)
  s_mov_b32 s4, s12
  s_mov_b32 s5, s13
  s_mov_b32 s6, 0x10000000
  s_mov_b32 s7, 0x20000
  s_mov_b32 s8, s12
  s_mov_b32 s9, s13
  s_mov_b32 s10, 0x10000000
  s_mov_b32 s11, 0x20000
  s_mov_b32 s20, 150994944
  s_mov_b32 s52, s48
  s_mov_b32 s53, s49
  s_mov_b32 s54, 2621440
  s_mov_b32 s55, 0x20000
  s_mul_i32 s21, s18, 5
  s_mul_i32 s21, s21, 32768
  s_add_u32 s24, s21, 160169984
  s_add_u32 s25, s24, 32768
  s_add_u32 s26, s25, 32768
  s_add_u32 s27, s26, 32768
  s_add_u32 s28, s27, 32768
  s_lshl_b32 s21, s17, 2
  s_add_u32 s21, s21, s16
  s_mul_i32 s22, s21, 32768
  s_add_u32 s22, s22, 174063616
  s_lshl_b32 s23, s16, 10
  v_add_u32 v2, s23, v1
  s_mul_i32 s29, s16, 5120
  s_add_u32 m0, s29, 0
  s_nop 0
  buffer_load_dwordx4 v2, s[4:7], s24 offen lds
  s_add_u32 m0, s29, 1024
  s_nop 0
  buffer_load_dwordx4 v2, s[4:7], s25 offen lds
  s_add_u32 m0, s29, 2048
  s_nop 0
  buffer_load_dwordx4 v2, s[4:7], s26 offen lds
  s_add_u32 m0, s29, 3072
  s_nop 0
  buffer_load_dwordx4 v2, s[4:7], s27 offen lds
  s_add_u32 m0, s29, 4096
  s_nop 0
  buffer_load_dwordx4 v2, s[4:7], s28 offen lds
  buffer_load_dwordx4 v[32:35], v1, s[4:7], s22 offen offset:0
  buffer_load_dwordx4 v[36:39], v1, s[4:7], s22 offen offset:1024
  buffer_load_dwordx4 v[40:43], v1, s[4:7], s22 offen offset:2048
  buffer_load_dwordx4 v[44:47], v1, s[4:7], s22 offen offset:3072
  v_add_u32 v2, 0x1000, v2
  s_add_u32 s22, s22, 4096
  s_add_u32 m0, s29, 20480
  s_nop 0
  buffer_load_dwordx4 v2, s[4:7], s24 offen lds
  s_add_u32 m0, s29, 21504
  s_nop 0
  buffer_load_dwordx4 v2, s[4:7], s25 offen lds
  s_add_u32 m0, s29, 22528
  s_nop 0
  buffer_load_dwordx4 v2, s[4:7], s26 offen lds
  s_add_u32 m0, s29, 23552
  s_nop 0
  buffer_load_dwordx4 v2, s[4:7], s27 offen lds
  s_add_u32 m0, s29, 24576
  s_nop 0
  buffer_load_dwordx4 v2, s[4:7], s28 offen lds
  buffer_load_dwordx4 v[48:51], v1, s[4:7], s22 offen offset:0
  buffer_load_dwordx4 v[52:55], v1, s[4:7], s22 offen offset:1024
  buffer_load_dwordx4 v[56:59], v1, s[4:7], s22 offen offset:2048
  buffer_load_dwordx4 v[60:63], v1, s[4:7], s22 offen offset:3072
  v_add_u32 v2, 0x1000, v2
  s_add_u32 s22, s22, 4096
  s_waitcnt vmcnt(9)
  s_barrier
  s_add_u32 m0, s29, 40960
  s_nop 0
  buffer_load_dwordx4 v2, s[4:7], s24 offen lds
  s_add_u32 m0, s29, 41984
  s_nop 0
  buffer_load_dwordx4 v2, s[4:7], s25 offen lds
  s_add_u32 m0, s29, 43008
  s_nop 0
  buffer_load_dwordx4 v2, s[4:7], s26 offen lds
  s_add_u32 m0, s29, 44032
  s_nop 0
  buffer_load_dwordx4 v2, s[4:7], s27 offen lds
  s_add_u32 m0, s29, 45056
  s_nop 0
  buffer_load_dwordx4 v2, s[4:7], s28 offen lds
  buffer_load_dwordx4 v[64:67], v1, s[4:7], s22 offen offset:0
  buffer_load_dwordx4 v[68:71], v1, s[4:7], s22 offen offset:1024
  buffer_load_dwordx4 v[72:75], v1, s[4:7], s22 offen offset:2048
  buffer_load_dwordx4 v[76:79], v1, s[4:7], s22 offen offset:3072
  v_add_u32 v2, 0x1000, v2
  s_add_u32 s22, s22, 4096
  ds_read_b128 v[80:83], v1 offset:0
  ds_read_b128 v[84:87], v1 offset:1024
  ds_read_b128 v[88:91], v1 offset:2048
  ds_read_b128 v[92:95], v1 offset:3072
  ds_read_b128 v[96:99], v1 offset:4096
  ds_read_b128 v[100:103], v1 offset:5120
  ds_read_b128 v[104:107], v1 offset:6144
  ds_read_b128 v[108:111], v1 offset:7168
  ds_read_b128 v[112:115], v1 offset:8192
  ds_read_b128 v[116:119], v1 offset:9216
  s_waitcnt lgkmcnt(5)
  v_mfma_f32_16x16x32_bf16 v[8:11], v[80:83], v[32:35], 0
  v_mfma_f32_16x16x32_bf16 v[12:15], v[84:87], v[32:35], 0
  v_mfma_f32_16x16x32_bf16 v[16:19], v[88:91], v[32:35], 0
  v_mfma_f32_16x16x32_bf16 v[20:23], v[92:95], v[32:35], 0
  v_mfma_f32_16x16x32_bf16 v[24:27], v[96:99], v[32:35], 0
  ds_read_b128 v[80:83], v1 offset:10240
  ds_read_b128 v[84:87], v1 offset:11264
  ds_read_b128 v[88:91], v1 offset:12288
  ds_read_b128 v[92:95], v1 offset:13312
  ds_read_b128 v[96:99], v1 offset:14336
  s_waitcnt lgkmcnt(5)
  v_mfma_f32_16x16x32_bf16 v[8:11], v[100:103], v[36:39], v[8:11]
  v_mfma_f32_16x16x32_bf16 v[12:15], v[104:107], v[36:39], v[12:15]
  v_mfma_f32_16x16x32_bf16 v[16:19], v[108:111], v[36:39], v[16:19]
  v_mfma_f32_16x16x32_bf16 v[20:23], v[112:115], v[36:39], v[20:23]
  v_mfma_f32_16x16x32_bf16 v[24:27], v[116:119], v[36:39], v[24:27]
  ds_read_b128 v[100:103], v1 offset:15360
  ds_read_b128 v[104:107], v1 offset:16384
  ds_read_b128 v[108:111], v1 offset:17408
  ds_read_b128 v[112:115], v1 offset:18432
  ds_read_b128 v[116:119], v1 offset:19456
  s_waitcnt lgkmcnt(5)
  v_mfma_f32_16x16x32_bf16 v[8:11], v[80:83], v[40:43], v[8:11]
  v_mfma_f32_16x16x32_bf16 v[12:15], v[84:87], v[40:43], v[12:15]
  v_mfma_f32_16x16x32_bf16 v[16:19], v[88:91], v[40:43], v[16:19]
  v_mfma_f32_16x16x32_bf16 v[20:23], v[92:95], v[40:43], v[20:23]
  v_mfma_f32_16x16x32_bf16 v[24:27], v[96:99], v[40:43], v[24:27]
  s_waitcnt lgkmcnt(0)
  v_mfma_f32_16x16x32_bf16 v[8:11], v[100:103], v[44:47], v[8:11]
  v_mfma_f32_16x16x32_bf16 v[12:15], v[104:107], v[44:47], v[12:15]
  v_mfma_f32_16x16x32_bf16 v[16:19], v[108:111], v[44:47], v[16:19]
  v_mfma_f32_16x16x32_bf16 v[20:23], v[112:115], v[44:47], v[20:23]
  v_mfma_f32_16x16x32_bf16 v[24:27], v[116:119], v[44:47], v[24:27]
  s_mov_b32 s30, 0
outb1_loop2:
  s_waitcnt vmcnt(9)
  s_barrier
  s_add_u32 m0, s29, 0
  s_nop 0
  buffer_load_dwordx4 v2, s[4:7], s24 offen lds
  s_add_u32 m0, s29, 1024
  s_nop 0
  buffer_load_dwordx4 v2, s[4:7], s25 offen lds
  s_add_u32 m0, s29, 2048
  s_nop 0
  buffer_load_dwordx4 v2, s[4:7], s26 offen lds
  s_add_u32 m0, s29, 3072
  s_nop 0
  buffer_load_dwordx4 v2, s[4:7], s27 offen lds
  s_add_u32 m0, s29, 4096
  s_nop 0
  buffer_load_dwordx4 v2, s[4:7], s28 offen lds
  buffer_load_dwordx4 v[32:35], v1, s[4:7], s22 offen offset:0
  buffer_load_dwordx4 v[36:39], v1, s[4:7], s22 offen offset:1024
  buffer_load_dwordx4 v[40:43], v1, s[4:7], s22 offen offset:2048
  buffer_load_dwordx4 v[44:47], v1, s[4:7], s22 offen offset:3072
  v_add_u32 v2, 0x1000, v2
  s_add_u32 s22, s22, 4096
  ds_read_b128 v[80:83], v1 offset:20480
  ds_read_b128 v[84:87], v1 offset:21504
  ds_read_b128 v[88:91], v1 offset:22528
  ds_read_b128 v[92:95], v1 offset:23552
  ds_read_b128 v[96:99], v1 offset:24576
  ds_read_b128 v[100:103], v1 offset:25600
  ds_read_b128 v[104:107], v1 offset:26624
  ds_read_b128 v[108:111], v1 offset:27648
  ds_read_b128 v[112:115], v1 offset:28672
  ds_read_b128 v[116:119], v1 offset:29696
  s_waitcnt lgkmcnt(5)
  v_mfma_f32_16x16x32_bf16 v[8:11], v[80:83], v[48:51], v[8:11]
  v_mfma_f32_16x16x32_bf16 v[12:15], v[84:87], v[48:51], v[12:15]
  v_mfma_f32_16x16x32_bf16 v[16:19], v[88:91], v[48:51], v[16:19]
  v_mfma_f32_16x16x32_bf16 v[20:23], v[92:95], v[48:51], v[20:23]
  v_mfma_f32_16x16x32_bf16 v[24:27], v[96:99], v[48:51], v[24:27]
  ds_read_b128 v[80:83], v1 offset:30720
  ds_read_b128 v[84:87], v1 offset:31744
  ds_read_b128 v[88:91], v1 offset:32768
  ds_read_b128 v[92:95], v1 offset:33792
  ds_read_b128 v[96:99], v1 offset:34816
  s_waitcnt lgkmcnt(5)
  v_mfma_f32_16x16x32_bf16 v[8:11], v[100:103], v[52:55], v[8:11]
  v_mfma_f32_16x16x32_bf16 v[12:15], v[104:107], v[52:55], v[12:15]
  v_mfma_f32_16x16x32_bf16 v[16:19], v[108:111], v[52:55], v[16:19]
  v_mfma_f32_16x16x32_bf16 v[20:23], v[112:115], v[52:55], v[20:23]
  v_mfma_f32_16x16x32_bf16 v[24:27], v[116:119], v[52:55], v[24:27]
  ds_read_b128 v[100:103], v1 offset:35840
  ds_read_b128 v[104:107], v1 offset:36864
  ds_read_b128 v[108:111], v1 offset:37888
  ds_read_b128 v[112:115], v1 offset:38912
  ds_read_b128 v[116:119], v1 offset:39936
  s_waitcnt lgkmcnt(5)
  v_mfma_f32_16x16x32_bf16 v[8:11], v[80:83], v[56:59], v[8:11]
  v_mfma_f32_16x16x32_bf16 v[12:15], v[84:87], v[56:59], v[12:15]
  v_mfma_f32_16x16x32_bf16 v[16:19], v[88:91], v[56:59], v[16:19]
  v_mfma_f32_16x16x32_bf16 v[20:23], v[92:95], v[56:59], v[20:23]
  v_mfma_f32_16x16x32_bf16 v[24:27], v[96:99], v[56:59], v[24:27]
  s_waitcnt lgkmcnt(0)
  v_mfma_f32_16x16x32_bf16 v[8:11], v[100:103], v[60:63], v[8:11]
  v_mfma_f32_16x16x32_bf16 v[12:15], v[104:107], v[60:63], v[12:15]
  v_mfma_f32_16x16x32_bf16 v[16:19], v[108:111], v[60:63], v[16:19]
  v_mfma_f32_16x16x32_bf16 v[20:23], v[112:115], v[60:63], v[20:23]
  v_mfma_f32_16x16x32_bf16 v[24:27], v[116:119], v[60:63], v[24:27]
  s_waitcnt vmcnt(9)
  s_barrier
  s_add_u32 m0, s29, 20480
  s_nop 0
  buffer_load_dwordx4 v2, s[4:7], s24 offen lds
  s_add_u32 m0, s29, 21504
  s_nop 0
  buffer_load_dwordx4 v2, s[4:7], s25 offen lds
  s_add_u32 m0, s29, 22528
  s_nop 0
  buffer_load_dwordx4 v2, s[4:7], s26 offen lds
  s_add_u32 m0, s29, 23552
  s_nop 0
  buffer_load_dwordx4 v2, s[4:7], s27 offen lds
  s_add_u32 m0, s29, 24576
  s_nop 0
  buffer_load_dwordx4 v2, s[4:7], s28 offen lds
  buffer_load_dwordx4 v[48:51], v1, s[4:7], s22 offen offset:0
  buffer_load_dwordx4 v[52:55], v1, s[4:7], s22 offen offset:1024
  buffer_load_dwordx4 v[56:59], v1, s[4:7], s22 offen offset:2048
  buffer_load_dwordx4 v[60:63], v1, s[4:7], s22 offen offset:3072
  v_add_u32 v2, 0x1000, v2
  s_add_u32 s22, s22, 4096
  ds_read_b128 v[80:83], v1 offset:40960
  ds_read_b128 v[84:87], v1 offset:41984
  ds_read_b128 v[88:91], v1 offset:43008
  ds_read_b128 v[92:95], v1 offset:44032
  ds_read_b128 v[96:99], v1 offset:45056
  ds_read_b128 v[100:103], v1 offset:46080
  ds_read_b128 v[104:107], v1 offset:47104
  ds_read_b128 v[108:111], v1 offset:48128
  ds_read_b128 v[112:115], v1 offset:49152
  ds_read_b128 v[116:119], v1 offset:50176
  s_waitcnt lgkmcnt(5)
  v_mfma_f32_16x16x32_bf16 v[8:11], v[80:83], v[64:67], v[8:11]
  v_mfma_f32_16x16x32_bf16 v[12:15], v[84:87], v[64:67], v[12:15]
  v_mfma_f32_16x16x32_bf16 v[16:19], v[88:91], v[64:67], v[16:19]
  v_mfma_f32_16x16x32_bf16 v[20:23], v[92:95], v[64:67], v[20:23]
  v_mfma_f32_16x16x32_bf16 v[24:27], v[96:99], v[64:67], v[24:27]
  ds_read_b128 v[80:83], v1 offset:51200
  ds_read_b128 v[84:87], v1 offset:52224
  ds_read_b128 v[88:91], v1 offset:53248
  ds_read_b128 v[92:95], v1 offset:54272
  ds_read_b128 v[96:99], v1 offset:55296
  s_waitcnt lgkmcnt(5)
  v_mfma_f32_16x16x32_bf16 v[8:11], v[100:103], v[68:71], v[8:11]
  v_mfma_f32_16x16x32_bf16 v[12:15], v[104:107], v[68:71], v[12:15]
  v_mfma_f32_16x16x32_bf16 v[16:19], v[108:111], v[68:71], v[16:19]
  v_mfma_f32_16x16x32_bf16 v[20:23], v[112:115], v[68:71], v[20:23]
  v_mfma_f32_16x16x32_bf16 v[24:27], v[116:119], v[68:71], v[24:27]
  ds_read_b128 v[100:103], v1 offset:56320
  ds_read_b128 v[104:107], v1 offset:57344
  ds_read_b128 v[108:111], v1 offset:58368
  ds_read_b128 v[112:115], v1 offset:59392
  ds_read_b128 v[116:119], v1 offset:60416
  s_waitcnt lgkmcnt(5)
  v_mfma_f32_16x16x32_bf16 v[8:11], v[80:83], v[72:75], v[8:11]
  v_mfma_f32_16x16x32_bf16 v[12:15], v[84:87], v[72:75], v[12:15]
  v_mfma_f32_16x16x32_bf16 v[16:19], v[88:91], v[72:75], v[16:19]
  v_mfma_f32_16x16x32_bf16 v[20:23], v[92:95], v[72:75], v[20:23]
  v_mfma_f32_16x16x32_bf16 v[24:27], v[96:99], v[72:75], v[24:27]
  s_waitcnt lgkmcnt(0)
  v_mfma_f32_16x16x32_bf16 v[8:11], v[100:103], v[76:79], v[8:11]
  v_mfma_f32_16x16x32_bf16 v[12:15], v[104:107], v[76:79], v[12:15]
  v_mfma_f32_16x16x32_bf16 v[16:19], v[108:111], v[76:79], v[16:19]
  v_mfma_f32_16x16x32_bf16 v[20:23], v[112:115], v[76:79], v[20:23]
  v_mfma_f32_16x16x32_bf16 v[24:27], v[116:119], v[76:79], v[24:27]
  s_waitcnt vmcnt(9)
  s_barrier
  s_add_u32 m0, s29, 40960
  s_nop 0
  buffer_load_dwordx4 v2, s[4:7], s24 offen lds
  s_add_u32 m0, s29, 41984
  s_nop 0
  buffer_load_dwordx4 v2, s[4:7], s25 offen lds
  s_add_u32 m0, s29, 43008
  s_nop 0
  buffer_load_dwordx4 v2, s[4:7], s26 offen lds
  s_add_u32 m0, s29, 44032
  s_nop 0
  buffer_load_dwordx4 v2, s[4:7], s27 offen lds
  s_add_u32 m0, s29, 45056
  s_nop 0
  buffer_load_dwordx4 v2, s[4:7], s28 offen lds
  buffer_load_dwordx4 v[64:67], v1, s[4:7], s22 offen offset:0
  buffer_load_dwordx4 v[68:71], v1, s[4:7], s22 offen offset:1024
  buffer_load_dwordx4 v[72:75], v1, s[4:7], s22 offen offset:2048
  buffer_load_dwordx4 v[76:79], v1, s[4:7], s22 offen offset:3072
  v_add_u32 v2, 0x1000, v2
  s_add_u32 s22, s22, 4096
  ds_read_b128 v[80:83], v1 offset:0
  ds_read_b128 v[84:87], v1 offset:1024
  ds_read_b128 v[88:91], v1 offset:2048
  ds_read_b128 v[92:95], v1 offset:3072
  ds_read_b128 v[96:99], v1 offset:4096
  ds_read_b128 v[100:103], v1 offset:5120
  ds_read_b128 v[104:107], v1 offset:6144
  ds_read_b128 v[108:111], v1 offset:7168
  ds_read_b128 v[112:115], v1 offset:8192
  ds_read_b128 v[116:119], v1 offset:9216
  s_waitcnt lgkmcnt(5)
  v_mfma_f32_16x16x32_bf16 v[8:11], v[80:83], v[32:35], v[8:11]
  v_mfma_f32_16x16x32_bf16 v[12:15], v[84:87], v[32:35], v[12:15]
  v_mfma_f32_16x16x32_bf16 v[16:19], v[88:91], v[32:35], v[16:19]
  v_mfma_f32_16x16x32_bf16 v[20:23], v[92:95], v[32:35], v[20:23]
  v_mfma_f32_16x16x32_bf16 v[24:27], v[96:99], v[32:35], v[24:27]
  ds_read_b128 v[80:83], v1 offset:10240
  ds_read_b128 v[84:87], v1 offset:11264
  ds_read_b128 v[88:91], v1 offset:12288
  ds_read_b128 v[92:95], v1 offset:13312
  ds_read_b128 v[96:99], v1 offset:14336
  s_waitcnt lgkmcnt(5)
  v_mfma_f32_16x16x32_bf16 v[8:11], v[100:103], v[36:39], v[8:11]
  v_mfma_f32_16x16x32_bf16 v[12:15], v[104:107], v[36:39], v[12:15]
  v_mfma_f32_16x16x32_bf16 v[16:19], v[108:111], v[36:39], v[16:19]
  v_mfma_f32_16x16x32_bf16 v[20:23], v[112:115], v[36:39], v[20:23]
  v_mfma_f32_16x16x32_bf16 v[24:27], v[116:119], v[36:39], v[24:27]
  ds_read_b128 v[100:103], v1 offset:15360
  ds_read_b128 v[104:107], v1 offset:16384
  ds_read_b128 v[108:111], v1 offset:17408
  ds_read_b128 v[112:115], v1 offset:18432
  ds_read_b128 v[116:119], v1 offset:19456
  s_waitcnt lgkmcnt(5)
  v_mfma_f32_16x16x32_bf16 v[8:11], v[80:83], v[40:43], v[8:11]
  v_mfma_f32_16x16x32_bf16 v[12:15], v[84:87], v[40:43], v[12:15]
  v_mfma_f32_16x16x32_bf16 v[16:19], v[88:91], v[40:43], v[16:19]
  v_mfma_f32_16x16x32_bf16 v[20:23], v[92:95], v[40:43], v[20:23]
  v_mfma_f32_16x16x32_bf16 v[24:27], v[96:99], v[40:43], v[24:27]
  s_waitcnt lgkmcnt(0)
  v_mfma_f32_16x16x32_bf16 v[8:11], v[100:103], v[44:47], v[8:11]
  v_mfma_f32_16x16x32_bf16 v[12:15], v[104:107], v[44:47], v[12:15]
  v_mfma_f32_16x16x32_bf16 v[16:19], v[108:111], v[44:47], v[16:19]
  v_mfma_f32_16x16x32_bf16 v[20:23], v[112:115], v[44:47], v[20:23]
  v_mfma_f32_16x16x32_bf16 v[24:27], v[116:119], v[44:47], v[24:27]
  s_add_u32 s30, s30, 1
  s_cmp_lt_u32 s30, 1
  s_cbranch_scc1 outb1_loop2
  s_waitcnt vmcnt(9)
  s_barrier
  s_add_u32 m0, s29, 0
  s_nop 0
  buffer_load_dwordx4 v2, s[4:7], s24 offen lds
  s_add_u32 m0, s29, 1024
  s_nop 0
  buffer_load_dwordx4 v2, s[4:7], s25 offen lds
  s_add_u32 m0, s29, 2048
  s_nop 0
  buffer_load_dwordx4 v2, s[4:7], s26 offen lds
  s_add_u32 m0, s29, 3072
  s_nop 0
  buffer_load_dwordx4 v2, s[4:7], s27 offen lds
  s_add_u32 m0, s29, 4096
  s_nop 0
  buffer_load_dwordx4 v2, s[4:7], s28 offen lds
  buffer_load_dwordx4 v[32:35], v1, s[4:7], s22 offen offset:0
  buffer_load_dwordx4 v[36:39], v1, s[4:7], s22 offen offset:1024
  buffer_load_dwordx4 v[40:43], v1, s[4:7], s22 offen offset:2048
  buffer_load_dwordx4 v[44:47], v1, s[4:7], s22 offen offset:3072
  v_add_u32 v2, 0x1000, v2
  s_add_u32 s22, s22, 4096
  ds_read_b128 v[80:83], v1 offset:20480
  ds_read_b128 v[84:87], v1 offset:21504
  ds_read_b128 v[88:91], v1 offset:22528
  ds_read_b128 v[92:95], v1 offset:23552
  ds_read_b128 v[96:99], v1 offset:24576
  ds_read_b128 v[100:103], v1 offset:25600
  ds_read_b128 v[104:107], v1 offset:26624
  ds_read_b128 v[108:111], v1 offset:27648
  ds_read_b128 v[112:115], v1 offset:28672
  ds_read_b128 v[116:119], v1 offset:29696
  s_waitcnt lgkmcnt(5)
  v_mfma_f32_16x16x32_bf16 v[8:11], v[80:83], v[48:51], v[8:11]
  v_mfma_f32_16x16x32_bf16 v[12:15], v[84:87], v[48:51], v[12:15]
  v_mfma_f32_16x16x32_bf16 v[16:19], v[88:91], v[48:51], v[16:19]
  v_mfma_f32_16x16x32_bf16 v[20:23], v[92:95], v[48:51], v[20:23]
  v_mfma_f32_16x16x32_bf16 v[24:27], v[96:99], v[48:51], v[24:27]
  ds_read_b128 v[80:83], v1 offset:30720
  ds_read_b128 v[84:87], v1 offset:31744
  ds_read_b128 v[88:91], v1 offset:32768
  ds_read_b128 v[92:95], v1 offset:33792
  ds_read_b128 v[96:99], v1 offset:34816
  s_waitcnt lgkmcnt(5)
  v_mfma_f32_16x16x32_bf16 v[8:11], v[100:103], v[52:55], v[8:11]
  v_mfma_f32_16x16x32_bf16 v[12:15], v[104:107], v[52:55], v[12:15]
  v_mfma_f32_16x16x32_bf16 v[16:19], v[108:111], v[52:55], v[16:19]
  v_mfma_f32_16x16x32_bf16 v[20:23], v[112:115], v[52:55], v[20:23]
  v_mfma_f32_16x16x32_bf16 v[24:27], v[116:119], v[52:55], v[24:27]
  ds_read_b128 v[100:103], v1 offset:35840
  ds_read_b128 v[104:107], v1 offset:36864
  ds_read_b128 v[108:111], v1 offset:37888
  ds_read_b128 v[112:115], v1 offset:38912
  ds_read_b128 v[116:119], v1 offset:39936
  s_waitcnt lgkmcnt(5)
  v_mfma_f32_16x16x32_bf16 v[8:11], v[80:83], v[56:59], v[8:11]
  v_mfma_f32_16x16x32_bf16 v[12:15], v[84:87], v[56:59], v[12:15]
  v_mfma_f32_16x16x32_bf16 v[16:19], v[88:91], v[56:59], v[16:19]
  v_mfma_f32_16x16x32_bf16 v[20:23], v[92:95], v[56:59], v[20:23]
  v_mfma_f32_16x16x32_bf16 v[24:27], v[96:99], v[56:59], v[24:27]
  s_waitcnt lgkmcnt(0)
  v_mfma_f32_16x16x32_bf16 v[8:11], v[100:103], v[60:63], v[8:11]
  v_mfma_f32_16x16x32_bf16 v[12:15], v[104:107], v[60:63], v[12:15]
  v_mfma_f32_16x16x32_bf16 v[16:19], v[108:111], v[60:63], v[16:19]
  v_mfma_f32_16x16x32_bf16 v[20:23], v[112:115], v[60:63], v[20:23]
  v_mfma_f32_16x16x32_bf16 v[24:27], v[116:119], v[60:63], v[24:27]
  s_waitcnt vmcnt(9)
  s_barrier
  s_add_u32 m0, s29, 20480
  s_nop 0
  buffer_load_dwordx4 v2, s[4:7], s24 offen lds
  s_add_u32 m0, s29, 21504
  s_nop 0
  buffer_load_dwordx4 v2, s[4:7], s25 offen lds
  s_add_u32 m0, s29, 22528
  s_nop 0
  buffer_load_dwordx4 v2, s[4:7], s26 offen lds
  s_add_u32 m0, s29, 23552
  s_nop 0
  buffer_load_dwordx4 v2, s[4:7], s27 offen lds
  s_add_u32 m0, s29, 24576
  s_nop 0
  buffer_load_dwordx4 v2, s[4:7], s28 offen lds
  buffer_load_dwordx4 v[48:51], v1, s[4:7], s22 offen offset:0
  buffer_load_dwordx4 v[52:55], v1, s[4:7], s22 offen offset:1024
  buffer_load_dwordx4 v[56:59], v1, s[4:7], s22 offen offset:2048
  buffer_load_dwordx4 v[60:63], v1, s[4:7], s22 offen offset:3072
  v_add_u32 v2, 0x1000, v2
  s_add_u32 s22, s22, 4096
  ds_read_b128 v[80:83], v1 offset:40960
  ds_read_b128 v[84:87], v1 offset:41984
  ds_read_b128 v[88:91], v1 offset:43008
  ds_read_b128 v[92:95], v1 offset:44032
  ds_read_b128 v[96:99], v1 offset:45056
  ds_read_b128 v[100:103], v1 offset:46080
  ds_read_b128 v[104:107], v1 offset:47104
  ds_read_b128 v[108:111], v1 offset:48128
  ds_read_b128 v[112:115], v1 offset:49152
  ds_read_b128 v[116:119], v1 offset:50176
  s_waitcnt lgkmcnt(5)
  v_mfma_f32_16x16x32_bf16 v[8:11], v[80:83], v[64:67], v[8:11]
  v_mfma_f32_16x16x32_bf16 v[12:15], v[84:87], v[64:67], v[12:15]
  v_mfma_f32_16x16x32_bf16 v[16:19], v[88:91], v[64:67], v[16:19]
  v_mfma_f32_16x16x32_bf16 v[20:23], v[92:95], v[64:67], v[20:23]
  v_mfma_f32_16x16x32_bf16 v[24:27], v[96:99], v[64:67], v[24:27]
  ds_read_b128 v[80:83], v1 offset:51200
  ds_read_b128 v[84:87], v1 offset:52224
  ds_read_b128 v[88:91], v1 offset:53248
  ds_read_b128 v[92:95], v1 offset:54272
  ds_read_b128 v[96:99], v1 offset:55296
  s_waitcnt lgkmcnt(5)
  v_mfma_f32_16x16x32_bf16 v[8:11], v[100:103], v[68:71], v[8:11]
  v_mfma_f32_16x16x32_bf16 v[12:15], v[104:107], v[68:71], v[12:15]
  v_mfma_f32_16x16x32_bf16 v[16:19], v[108:111], v[68:71], v[16:19]
  v_mfma_f32_16x16x32_bf16 v[20:23], v[112:115], v[68:71], v[20:23]
  v_mfma_f32_16x16x32_bf16 v[24:27], v[116:119], v[68:71], v[24:27]
  ds_read_b128 v[100:103], v1 offset:56320
  ds_read_b128 v[104:107], v1 offset:57344
  ds_read_b128 v[108:111], v1 offset:58368
  ds_read_b128 v[112:115], v1 offset:59392
  ds_read_b128 v[116:119], v1 offset:60416
  s_waitcnt lgkmcnt(5)
  v_mfma_f32_16x16x32_bf16 v[8:11], v[80:83], v[72:75], v[8:11]
  v_mfma_f32_16x16x32_bf16 v[12:15], v[84:87], v[72:75], v[12:15]
  v_mfma_f32_16x16x32_bf16 v[16:19], v[88:91], v[72:75], v[16:19]
  v_mfma_f32_16x16x32_bf16 v[20:23], v[92:95], v[72:75], v[20:23]
  v_mfma_f32_16x16x32_bf16 v[24:27], v[96:99], v[72:75], v[24:27]
  s_waitcnt lgkmcnt(0)
  v_mfma_f32_16x16x32_bf16 v[8:11], v[100:103], v[76:79], v[8:11]
  v_mfma_f32_16x16x32_bf16 v[12:15], v[104:107], v[76:79], v[12:15]
  v_mfma_f32_16x16x32_bf16 v[16:19], v[108:111], v[76:79], v[16:19]
  v_mfma_f32_16x16x32_bf16 v[20:23], v[112:115], v[76:79], v[20:23]
  v_mfma_f32_16x16x32_bf16 v[24:27], v[116:119], v[76:79], v[24:27]
  s_waitcnt vmcnt(9)
  s_barrier
  ds_read_b128 v[80:83], v1 offset:0
  ds_read_b128 v[84:87], v1 offset:1024
  ds_read_b128 v[88:91], v1 offset:2048
  ds_read_b128 v[92:95], v1 offset:3072
  ds_read_b128 v[96:99], v1 offset:4096
  ds_read_b128 v[100:103], v1 offset:5120
  ds_read_b128 v[104:107], v1 offset:6144
  ds_read_b128 v[108:111], v1 offset:7168
  ds_read_b128 v[112:115], v1 offset:8192
  ds_read_b128 v[116:119], v1 offset:9216
  s_waitcnt lgkmcnt(5)
  v_mfma_f32_16x16x32_bf16 v[8:11], v[80:83], v[32:35], v[8:11]
  v_mfma_f32_16x16x32_bf16 v[12:15], v[84:87], v[32:35], v[12:15]
  v_mfma_f32_16x16x32_bf16 v[16:19], v[88:91], v[32:35], v[16:19]
  v_mfma_f32_16x16x32_bf16 v[20:23], v[92:95], v[32:35], v[20:23]
  v_mfma_f32_16x16x32_bf16 v[24:27], v[96:99], v[32:35], v[24:27]
  ds_read_b128 v[80:83], v1 offset:10240
  ds_read_b128 v[84:87], v1 offset:11264
  ds_read_b128 v[88:91], v1 offset:12288
  ds_read_b128 v[92:95], v1 offset:13312
  ds_read_b128 v[96:99], v1 offset:14336
  s_waitcnt lgkmcnt(5)
  v_mfma_f32_16x16x32_bf16 v[8:11], v[100:103], v[36:39], v[8:11]
  v_mfma_f32_16x16x32_bf16 v[12:15], v[104:107], v[36:39], v[12:15]
  v_mfma_f32_16x16x32_bf16 v[16:19], v[108:111], v[36:39], v[16:19]
  v_mfma_f32_16x16x32_bf16 v[20:23], v[112:115], v[36:39], v[20:23]
  v_mfma_f32_16x16x32_bf16 v[24:27], v[116:119], v[36:39], v[24:27]
  ds_read_b128 v[100:103], v1 offset:15360
  ds_read_b128 v[104:107], v1 offset:16384
  ds_read_b128 v[108:111], v1 offset:17408
  ds_read_b128 v[112:115], v1 offset:18432
  ds_read_b128 v[116:119], v1 offset:19456
  s_waitcnt lgkmcnt(5)
  v_mfma_f32_16x16x32_bf16 v[8:11], v[80:83], v[40:43], v[8:11]
  v_mfma_f32_16x16x32_bf16 v[12:15], v[84:87], v[40:43], v[12:15]
  v_mfma_f32_16x16x32_bf16 v[16:19], v[88:91], v[40:43], v[16:19]
  v_mfma_f32_16x16x32_bf16 v[20:23], v[92:95], v[40:43], v[20:23]
  v_mfma_f32_16x16x32_bf16 v[24:27], v[96:99], v[40:43], v[24:27]
  s_waitcnt lgkmcnt(0)
  v_mfma_f32_16x16x32_bf16 v[8:11], v[100:103], v[44:47], v[8:11]
  v_mfma_f32_16x16x32_bf16 v[12:15], v[104:107], v[44:47], v[12:15]
  v_mfma_f32_16x16x32_bf16 v[16:19], v[108:111], v[44:47], v[16:19]
  v_mfma_f32_16x16x32_bf16 v[20:23], v[112:115], v[44:47], v[20:23]
  v_mfma_f32_16x16x32_bf16 v[24:27], v[116:119], v[44:47], v[24:27]
  s_waitcnt vmcnt(0)
  s_barrier
  ds_read_b128 v[80:83], v1 offset:20480
  ds_read_b128 v[84:87], v1 offset:21504
  ds_read_b128 v[88:91], v1 offset:22528
  ds_read_b128 v[92:95], v1 offset:23552
  ds_read_b128 v[96:99], v1 offset:24576
  ds_read_b128 v[100:103], v1 offset:25600
  ds_read_b128 v[104:107], v1 offset:26624
  ds_read_b128 v[108:111], v1 offset:27648
  ds_read_b128 v[112:115], v1 offset:28672
  ds_read_b128 v[116:119], v1 offset:29696
  s_waitcnt lgkmcnt(5)
  v_mfma_f32_16x16x32_bf16 v[8:11], v[80:83], v[48:51], v[8:11]
  v_mfma_f32_16x16x32_bf16 v[12:15], v[84:87], v[48:51], v[12:15]
  v_mfma_f32_16x16x32_bf16 v[16:19], v[88:91], v[48:51], v[16:19]
  v_mfma_f32_16x16x32_bf16 v[20:23], v[92:95], v[48:51], v[20:23]
  v_mfma_f32_16x16x32_bf16 v[24:27], v[96:99], v[48:51], v[24:27]
  ds_read_b128 v[80:83], v1 offset:30720
  ds_read_b128 v[84:87], v1 offset:31744
  ds_read_b128 v[88:91], v1 offset:32768
  ds_read_b128 v[92:95], v1 offset:33792
  ds_read_b128 v[96:99], v1 offset:34816
  s_waitcnt lgkmcnt(5)
  v_mfma_f32_16x16x32_bf16 v[8:11], v[100:103], v[52:55], v[8:11]
  v_mfma_f32_16x16x32_bf16 v[12:15], v[104:107], v[52:55], v[12:15]
  v_mfma_f32_16x16x32_bf16 v[16:19], v[108:111], v[52:55], v[16:19]
  v_mfma_f32_16x16x32_bf16 v[20:23], v[112:115], v[52:55], v[20:23]
  v_mfma_f32_16x16x32_bf16 v[24:27], v[116:119], v[52:55], v[24:27]
  ds_read_b128 v[100:103], v1 offset:35840
  ds_read_b128 v[104:107], v1 offset:36864
  ds_read_b128 v[108:111], v1 offset:37888
  ds_read_b128 v[112:115], v1 offset:38912
  ds_read_b128 v[116:119], v1 offset:39936
  s_waitcnt lgkmcnt(5)
  v_mfma_f32_16x16x32_bf16 v[8:11], v[80:83], v[56:59], v[8:11]
  v_mfma_f32_16x16x32_bf16 v[12:15], v[84:87], v[56:59], v[12:15]
  v_mfma_f32_16x16x32_bf16 v[16:19], v[88:91], v[56:59], v[16:19]
  v_mfma_f32_16x16x32_bf16 v[20:23], v[92:95], v[56:59], v[20:23]
  v_mfma_f32_16x16x32_bf16 v[24:27], v[96:99], v[56:59], v[24:27]
  s_waitcnt lgkmcnt(0)
  v_mfma_f32_16x16x32_bf16 v[8:11], v[100:103], v[60:63], v[8:11]
  v_mfma_f32_16x16x32_bf16 v[12:15], v[104:107], v[60:63], v[12:15]
  v_mfma_f32_16x16x32_bf16 v[16:19], v[108:111], v[60:63], v[16:19]
  v_mfma_f32_16x16x32_bf16 v[20:23], v[112:115], v[60:63], v[20:23]
  v_mfma_f32_16x16x32_bf16 v[24:27], v[116:119], v[60:63], v[24:27]
  v_and_b32 v3, 63, v0
  v_and_b32 v4, 15, v3
  v_lshrrev_b32 v3, 4, v3
  s_lshl_b32 s21, s17, 6
  s_lshl_b32 s23, s16, 4
  s_add_u32 s21, s21, s23
  v_add_u32 v4, s21, v4
  v_mul_u32_u24 v6, 1280, v4
  v_lshl_add_u32 v6, v3, 4, v6
  s_mul_i32 s21, s18, 5
  s_add_u32 s23, s21, 0
  s_lshr_b32 s31, s23, 1
  s_lshl_b32 s31, s31, 6
  s_and_b32 s23, s23, 1
  s_lshl_b32 s23, s23, 3
  s_add_u32 s32, s31, s23
  s_add_u32 s40, s32, s20
  buffer_load_dwordx2 v[32:33], v6, s[8:11], s40 offen
  s_add_u32 s23, s21, 1
  s_lshr_b32 s31, s23, 1
  s_lshl_b32 s31, s31, 6
  s_and_b32 s23, s23, 1
  s_lshl_b32 s23, s23, 3
  s_add_u32 s33, s31, s23
  s_add_u32 s41, s33, s20
  buffer_load_dwordx2 v[34:35], v6, s[8:11], s41 offen
  s_add_u32 s23, s21, 2
  s_lshr_b32 s31, s23, 1
  s_lshl_b32 s31, s31, 6
  s_and_b32 s23, s23, 1
  s_lshl_b32 s23, s23, 3
  s_add_u32 s34, s31, s23
  s_add_u32 s42, s34, s20
  buffer_load_dwordx2 v[36:37], v6, s[8:11], s42 offen
  s_add_u32 s23, s21, 3
  s_lshr_b32 s31, s23, 1
  s_lshl_b32 s31, s31, 6
  s_and_b32 s23, s23, 1
  s_lshl_b32 s23, s23, 3
  s_add_u32 s35, s31, s23
  s_add_u32 s43, s35, s20
  buffer_load_dwordx2 v[38:39], v6, s[8:11], s43 offen
  s_add_u32 s23, s21, 4
  s_lshr_b32 s31, s23, 1
  s_lshl_b32 s31, s31, 6
  s_and_b32 s23, s23, 1
  s_lshl_b32 s23, s23, 3
  s_add_u32 s36, s31, s23
  s_add_u32 s44, s36, s20
  buffer_load_dwordx2 v[40:41], v6, s[8:11], s44 offen
  s_waitcnt vmcnt(0)
  v_cvt_pk_bf16_f32 v80, v8, v9
  v_cvt_pk_bf16_f32 v81, v10, v11
  v_lshlrev_b32 v8, 16, v80
  v_and_b32 v9, 0xffff0000, v80
  v_lshlrev_b32 v10, 16, v81
  v_and_b32 v11, 0xffff0000, v81
  v_lshlrev_b32 v82, 16, v32
  v_and_b32 v83, 0xffff0000, v32
  v_lshlrev_b32 v84, 16, v33
  v_and_b32 v85, 0xffff0000, v33
  v_add_f32 v8, v8, v82
  v_add_f32 v9, v9, v83
  v_add_f32 v10, v10, v84
  v_add_f32 v11, v11, v85
  v_cvt_pk_bf16_f32 v32, v8, v9
  v_cvt_pk_bf16_f32 v33, v10, v11
  s_add_u32 s23, s32, 150994944
  buffer_store_dwordx2 v[32:33], v6, s[4:7], s23 offen
  v_cvt_pk_bf16_f32 v80, v12, v13
  v_cvt_pk_bf16_f32 v81, v14, v15
  v_lshlrev_b32 v12, 16, v80
  v_and_b32 v13, 0xffff0000, v80
  v_lshlrev_b32 v14, 16, v81
  v_and_b32 v15, 0xffff0000, v81
  v_lshlrev_b32 v82, 16, v34
  v_and_b32 v83, 0xffff0000, v34
  v_lshlrev_b32 v84, 16, v35
  v_and_b32 v85, 0xffff0000, v35
  v_add_f32 v12, v12, v82
  v_add_f32 v13, v13, v83
  v_add_f32 v14, v14, v84
  v_add_f32 v15, v15, v85
  v_cvt_pk_bf16_f32 v34, v12, v13
  v_cvt_pk_bf16_f32 v35, v14, v15
  s_add_u32 s23, s33, 150994944
  buffer_store_dwordx2 v[34:35], v6, s[4:7], s23 offen
  v_cvt_pk_bf16_f32 v80, v16, v17
  v_cvt_pk_bf16_f32 v81, v18, v19
  v_lshlrev_b32 v16, 16, v80
  v_and_b32 v17, 0xffff0000, v80
  v_lshlrev_b32 v18, 16, v81
  v_and_b32 v19, 0xffff0000, v81
  v_lshlrev_b32 v82, 16, v36
  v_and_b32 v83, 0xffff0000, v36
  v_lshlrev_b32 v84, 16, v37
  v_and_b32 v85, 0xffff0000, v37
  v_add_f32 v16, v16, v82
  v_add_f32 v17, v17, v83
  v_add_f32 v18, v18, v84
  v_add_f32 v19, v19, v85
  v_cvt_pk_bf16_f32 v36, v16, v17
  v_cvt_pk_bf16_f32 v37, v18, v19
  s_add_u32 s23, s34, 150994944
  buffer_store_dwordx2 v[36:37], v6, s[4:7], s23 offen
  v_cvt_pk_bf16_f32 v80, v20, v21
  v_cvt_pk_bf16_f32 v81, v22, v23
  v_lshlrev_b32 v20, 16, v80
  v_and_b32 v21, 0xffff0000, v80
  v_lshlrev_b32 v22, 16, v81
  v_and_b32 v23, 0xffff0000, v81
  v_lshlrev_b32 v82, 16, v38
  v_and_b32 v83, 0xffff0000, v38
  v_lshlrev_b32 v84, 16, v39
  v_and_b32 v85, 0xffff0000, v39
  v_add_f32 v20, v20, v82
  v_add_f32 v21, v21, v83
  v_add_f32 v22, v22, v84
  v_add_f32 v23, v23, v85
  v_cvt_pk_bf16_f32 v38, v20, v21
  v_cvt_pk_bf16_f32 v39, v22, v23
  s_add_u32 s23, s35, 150994944
  buffer_store_dwordx2 v[38:39], v6, s[4:7], s23 offen
  v_cvt_pk_bf16_f32 v80, v24, v25
  v_cvt_pk_bf16_f32 v81, v26, v27
  v_lshlrev_b32 v24, 16, v80
  v_and_b32 v25, 0xffff0000, v80
  v_lshlrev_b32 v26, 16, v81
  v_and_b32 v27, 0xffff0000, v81
  v_lshlrev_b32 v82, 16, v40
  v_and_b32 v83, 0xffff0000, v40
  v_lshlrev_b32 v84, 16, v41
  v_and_b32 v85, 0xffff0000, v41
  v_add_f32 v24, v24, v82
  v_add_f32 v25, v25, v83
  v_add_f32 v26, v26, v84
  v_add_f32 v27, v27, v85
  v_cvt_pk_bf16_f32 v40, v24, v25
  v_cvt_pk_bf16_f32 v41, v26, v27
  s_add_u32 s23, s36, 150994944
  buffer_store_dwordx2 v[40:41], v6, s[4:7], s23 offen
outb1_exit1:
  s_endpgm
.globl outb2_kernel
.p2align 8
.type outb2_kernel,@function
outb2_kernel:
  s_cmp_ge_u32 s2, 256
  s_cbranch_scc1 outb2_exit1
  s_load_dwordx2 s[12:13], s[0:1], 96
  s_load_dwordx2 s[14:15], s[0:1], 0
  s_load_dwordx2 s[48:49], s[0:1], 80
  v_lshrrev_b32 v3, 6, v0
  v_and_b32 v4, 63, v0
  s_nop 0
  v_readfirstlane_b32 s16, v3
  v_lshlrev_b32 v1, 4, v4
  s_and_b32 s17, s2, 7
  s_lshl_b32 s17, s17, 2
  s_lshr_b32 s18, s2, 3
  s_and_b32 s19, s18, 3
  s_add_u32 s17, s17, s19
  s_lshr_b32 s18, s18, 2
  s_waitcnt lgkmcnt(0)
  s_mov_b32 s4, s12
  s_mov_b32 s5, s13
  s_mov_b32 s6, 0x10000000
  s_mov_b32 s7, 0x20000
  s_mov_b32 s8, s12
  s_mov_b32 s9, s13
  s_mov_b32 s10, 0x10000000
  s_mov_b32 s11, 0x20000
  s_mov_b32 s20, 150994944
  s_mov_b32 s52, s48
  s_mov_b32 s53, s49
  s_mov_b32 s54, 2621440
  s_mov_b32 s55, 0x20000
  s_mul_i32 s21, s18, 5
  s_mul_i32 s21, s21, 32768
  s_add_u32 s24, s21, 160169984
  s_add_u32 s25, s24, 32768
  s_add_u32 s26, s25, 32768
  s_add_u32 s27, s26, 32768
  s_add_u32 s28, s27, 32768
  s_lshl_b32 s21, s17, 2
  s_add_u32 s21, s21, s16
  s_mul_i32 s22, s21, 32768
  s_add_u32 s22, s22, 174063616
  s_lshl_b32 s23, s16, 10
  v_add_u32 v2, s23, v1
  s_mul_i32 s29, s16, 5120
  s_add_u32 m0, s29, 0
  s_nop 0
  buffer_load_dwordx4 v2, s[4:7], s24 offen lds
  s_add_u32 m0, s29, 1024
  s_nop 0
  buffer_load_dwordx4 v2, s[4:7], s25 offen lds
  s_add_u32 m0, s29, 2048
  s_nop 0
  buffer_load_dwordx4 v2, s[4:7], s26 offen lds
  s_add_u32 m0, s29, 3072
  s_nop 0
  buffer_load_dwordx4 v2, s[4:7], s27 offen lds
  s_add_u32 m0, s29, 4096
  s_nop 0
  buffer_load_dwordx4 v2, s[4:7], s28 offen lds
  buffer_load_dwordx4 v[32:35], v1, s[4:7], s22 offen offset:0
  buffer_load_dwordx4 v[36:39], v1, s[4:7], s22 offen offset:1024
  buffer_load_dwordx4 v[40:43], v1, s[4:7], s22 offen offset:2048
  buffer_load_dwordx4 v[44:47], v1, s[4:7], s22 offen offset:3072
  v_add_u32 v2, 0x1000, v2
  s_add_u32 s22, s22, 4096
  s_add_u32 m0, s29, 20480
  s_nop 0
  buffer_load_dwordx4 v2, s[4:7], s24 offen lds
  s_add_u32 m0, s29, 21504
  s_nop 0
  buffer_load_dwordx4 v2, s[4:7], s25 offen lds
  s_add_u32 m0, s29, 22528
  s_nop 0
  buffer_load_dwordx4 v2, s[4:7], s26 offen lds
  s_add_u32 m0, s29, 23552
  s_nop 0
  buffer_load_dwordx4 v2, s[4:7], s27 offen lds
  s_add_u32 m0, s29, 24576
  s_nop 0
  buffer_load_dwordx4 v2, s[4:7], s28 offen lds
  buffer_load_dwordx4 v[48:51], v1, s[4:7], s22 offen offset:0
  buffer_load_dwordx4 v[52:55], v1, s[4:7], s22 offen offset:1024
  buffer_load_dwordx4 v[56:59], v1, s[4:7], s22 offen offset:2048
  buffer_load_dwordx4 v[60:63], v1, s[4:7], s22 offen offset:3072
  v_add_u32 v2, 0x1000, v2
  s_add_u32 s22, s22, 4096
  s_waitcnt vmcnt(9)
  s_barrier
  s_add_u32 m0, s29, 40960
  s_nop 0
  buffer_load_dwordx4 v2, s[4:7], s24 offen lds
  s_add_u32 m0, s29, 41984
  s_nop 0
  buffer_load_dwordx4 v2, s[4:7], s25 offen lds
  s_add_u32 m0, s29, 43008
  s_nop 0
  buffer_load_dwordx4 v2, s[4:7], s26 offen lds
  s_add_u32 m0, s29, 44032
  s_nop 0
  buffer_load_dwordx4 v2, s[4:7], s27 offen lds
  s_add_u32 m0, s29, 45056
  s_nop 0
  buffer_load_dwordx4 v2, s[4:7], s28 offen lds
  buffer_load_dwordx4 v[64:67], v1, s[4:7], s22 offen offset:0
  buffer_load_dwordx4 v[68:71], v1, s[4:7], s22 offen offset:1024
  buffer_load_dwordx4 v[72:75], v1, s[4:7], s22 offen offset:2048
  buffer_load_dwordx4 v[76:79], v1, s[4:7], s22 offen offset:3072
  v_add_u32 v2, 0x1000, v2
  s_add_u32 s22, s22, 4096
  ds_read_b128 v[80:83], v1 offset:0
  ds_read_b128 v[84:87], v1 offset:1024
  ds_read_b128 v[88:91], v1 offset:2048
  ds_read_b128 v[92:95], v1 offset:3072
  ds_read_b128 v[96:99], v1 offset:4096
  ds_read_b128 v[100:103], v1 offset:5120
  ds_read_b128 v[104:107], v1 offset:6144
  ds_read_b128 v[108:111], v1 offset:7168
  ds_read_b128 v[112:115], v1 offset:8192
  ds_read_b128 v[116:119], v1 offset:9216
  s_waitcnt lgkmcnt(5)
  v_mfma_f32_16x16x32_bf16 v[8:11], v[80:83], v[32:35], 0
  v_mfma_f32_16x16x32_bf16 v[12:15], v[84:87], v[32:35], 0
  v_mfma_f32_16x16x32_bf16 v[16:19], v[88:91], v[32:35], 0
  v_mfma_f32_16x16x32_bf16 v[20:23], v[92:95], v[32:35], 0
  v_mfma_f32_16x16x32_bf16 v[24:27], v[96:99], v[32:35], 0
  ds_read_b128 v[80:83], v1 offset:10240
  ds_read_b128 v[84:87], v1 offset:11264
  ds_read_b128 v[88:91], v1 offset:12288
  ds_read_b128 v[92:95], v1 offset:13312
  ds_read_b128 v[96:99], v1 offset:14336
  s_waitcnt lgkmcnt(5)
  v_mfma_f32_16x16x32_bf16 v[8:11], v[100:103], v[36:39], v[8:11]
  v_mfma_f32_16x16x32_bf16 v[12:15], v[104:107], v[36:39], v[12:15]
  v_mfma_f32_16x16x32_bf16 v[16:19], v[108:111], v[36:39], v[16:19]
  v_mfma_f32_16x16x32_bf16 v[20:23], v[112:115], v[36:39], v[20:23]
  v_mfma_f32_16x16x32_bf16 v[24:27], v[116:119], v[36:39], v[24:27]
  ds_read_b128 v[100:103], v1 offset:15360
  ds_read_b128 v[104:107], v1 offset:16384
  ds_read_b128 v[108:111], v1 offset:17408
  ds_read_b128 v[112:115], v1 offset:18432
  ds_read_b128 v[116:119], v1 offset:19456
  s_waitcnt lgkmcnt(5)
  v_mfma_f32_16x16x32_bf16 v[8:11], v[80:83], v[40:43], v[8:11]
  v_mfma_f32_16x16x32_bf16 v[12:15], v[84:87], v[40:43], v[12:15]
  v_mfma_f32_16x16x32_bf16 v[16:19], v[88:91], v[40:43], v[16:19]
  v_mfma_f32_16x16x32_bf16 v[20:23], v[92:95], v[40:43], v[20:23]
  v_mfma_f32_16x16x32_bf16 v[24:27], v[96:99], v[40:43], v[24:27]
  s_waitcnt lgkmcnt(0)
  v_mfma_f32_16x16x32_bf16 v[8:11], v[100:103], v[44:47], v[8:11]
  v_mfma_f32_16x16x32_bf16 v[12:15], v[104:107], v[44:47], v[12:15]
  v_mfma_f32_16x16x32_bf16 v[16:19], v[108:111], v[44:47], v[16:19]
  v_mfma_f32_16x16x32_bf16 v[20:23], v[112:115], v[44:47], v[20:23]
  v_mfma_f32_16x16x32_bf16 v[24:27], v[116:119], v[44:47], v[24:27]
  s_mov_b32 s30, 0
outb2_loop2:
  s_waitcnt vmcnt(9)
  s_barrier
  s_add_u32 m0, s29, 0
  s_nop 0
  buffer_load_dwordx4 v2, s[4:7], s24 offen lds
  s_add_u32 m0, s29, 1024
  s_nop 0
  buffer_load_dwordx4 v2, s[4:7], s25 offen lds
  s_add_u32 m0, s29, 2048
  s_nop 0
  buffer_load_dwordx4 v2, s[4:7], s26 offen lds
  s_add_u32 m0, s29, 3072
  s_nop 0
  buffer_load_dwordx4 v2, s[4:7], s27 offen lds
  s_add_u32 m0, s29, 4096
  s_nop 0
  buffer_load_dwordx4 v2, s[4:7], s28 offen lds
  buffer_load_dwordx4 v[32:35], v1, s[4:7], s22 offen offset:0
  buffer_load_dwordx4 v[36:39], v1, s[4:7], s22 offen offset:1024
  buffer_load_dwordx4 v[40:43], v1, s[4:7], s22 offen offset:2048
  buffer_load_dwordx4 v[44:47], v1, s[4:7], s22 offen offset:3072
  v_add_u32 v2, 0x1000, v2
  s_add_u32 s22, s22, 4096
  ds_read_b128 v[80:83], v1 offset:20480
  ds_read_b128 v[84:87], v1 offset:21504
  ds_read_b128 v[88:91], v1 offset:22528
  ds_read_b128 v[92:95], v1 offset:23552
  ds_read_b128 v[96:99], v1 offset:24576
  ds_read_b128 v[100:103], v1 offset:25600
  ds_read_b128 v[104:107], v1 offset:26624
  ds_read_b128 v[108:111], v1 offset:27648
  ds_read_b128 v[112:115], v1 offset:28672
  ds_read_b128 v[116:119], v1 offset:29696
  s_waitcnt lgkmcnt(5)
  v_mfma_f32_16x16x32_bf16 v[8:11], v[80:83], v[48:51], v[8:11]
  v_mfma_f32_16x16x32_bf16 v[12:15], v[84:87], v[48:51], v[12:15]
  v_mfma_f32_16x16x32_bf16 v[16:19], v[88:91], v[48:51], v[16:19]
  v_mfma_f32_16x16x32_bf16 v[20:23], v[92:95], v[48:51], v[20:23]
  v_mfma_f32_16x16x32_bf16 v[24:27], v[96:99], v[48:51], v[24:27]
  ds_read_b128 v[80:83], v1 offset:30720
  ds_read_b128 v[84:87], v1 offset:31744
  ds_read_b128 v[88:91], v1 offset:32768
  ds_read_b128 v[92:95], v1 offset:33792
  ds_read_b128 v[96:99], v1 offset:34816
  s_waitcnt lgkmcnt(5)
  v_mfma_f32_16x16x32_bf16 v[8:11], v[100:103], v[52:55], v[8:11]
  v_mfma_f32_16x16x32_bf16 v[12:15], v[104:107], v[52:55], v[12:15]
  v_mfma_f32_16x16x32_bf16 v[16:19], v[108:111], v[52:55], v[16:19]
  v_mfma_f32_16x16x32_bf16 v[20:23], v[112:115], v[52:55], v[20:23]
  v_mfma_f32_16x16x32_bf16 v[24:27], v[116:119], v[52:55], v[24:27]
  ds_read_b128 v[100:103], v1 offset:35840
  ds_read_b128 v[104:107], v1 offset:36864
  ds_read_b128 v[108:111], v1 offset:37888
  ds_read_b128 v[112:115], v1 offset:38912
  ds_read_b128 v[116:119], v1 offset:39936
  s_waitcnt lgkmcnt(5)
  v_mfma_f32_16x16x32_bf16 v[8:11], v[80:83], v[56:59], v[8:11]
  v_mfma_f32_16x16x32_bf16 v[12:15], v[84:87], v[56:59], v[12:15]
  v_mfma_f32_16x16x32_bf16 v[16:19], v[88:91], v[56:59], v[16:19]
  v_mfma_f32_16x16x32_bf16 v[20:23], v[92:95], v[56:59], v[20:23]
  v_mfma_f32_16x16x32_bf16 v[24:27], v[96:99], v[56:59], v[24:27]
  s_waitcnt lgkmcnt(0)
  v_mfma_f32_16x16x32_bf16 v[8:11], v[100:103], v[60:63], v[8:11]
  v_mfma_f32_16x16x32_bf16 v[12:15], v[104:107], v[60:63], v[12:15]
  v_mfma_f32_16x16x32_bf16 v[16:19], v[108:111], v[60:63], v[16:19]
  v_mfma_f32_16x16x32_bf16 v[20:23], v[112:115], v[60:63], v[20:23]
  v_mfma_f32_16x16x32_bf16 v[24:27], v[116:119], v[60:63], v[24:27]
  s_waitcnt vmcnt(9)
  s_barrier
  s_add_u32 m0, s29, 20480
  s_nop 0
  buffer_load_dwordx4 v2, s[4:7], s24 offen lds
  s_add_u32 m0, s29, 21504
  s_nop 0
  buffer_load_dwordx4 v2, s[4:7], s25 offen lds
  s_add_u32 m0, s29, 22528
  s_nop 0
  buffer_load_dwordx4 v2, s[4:7], s26 offen lds
  s_add_u32 m0, s29, 23552
  s_nop 0
  buffer_load_dwordx4 v2, s[4:7], s27 offen lds
  s_add_u32 m0, s29, 24576
  s_nop 0
  buffer_load_dwordx4 v2, s[4:7], s28 offen lds
  buffer_load_dwordx4 v[48:51], v1, s[4:7], s22 offen offset:0
  buffer_load_dwordx4 v[52:55], v1, s[4:7], s22 offen offset:1024
  buffer_load_dwordx4 v[56:59], v1, s[4:7], s22 offen offset:2048
  buffer_load_dwordx4 v[60:63], v1, s[4:7], s22 offen offset:3072
  v_add_u32 v2, 0x1000, v2
  s_add_u32 s22, s22, 4096
  ds_read_b128 v[80:83], v1 offset:40960
  ds_read_b128 v[84:87], v1 offset:41984
  ds_read_b128 v[88:91], v1 offset:43008
  ds_read_b128 v[92:95], v1 offset:44032
  ds_read_b128 v[96:99], v1 offset:45056
  ds_read_b128 v[100:103], v1 offset:46080
  ds_read_b128 v[104:107], v1 offset:47104
  ds_read_b128 v[108:111], v1 offset:48128
  ds_read_b128 v[112:115], v1 offset:49152
  ds_read_b128 v[116:119], v1 offset:50176
  s_waitcnt lgkmcnt(5)
  v_mfma_f32_16x16x32_bf16 v[8:11], v[80:83], v[64:67], v[8:11]
  v_mfma_f32_16x16x32_bf16 v[12:15], v[84:87], v[64:67], v[12:15]
  v_mfma_f32_16x16x32_bf16 v[16:19], v[88:91], v[64:67], v[16:19]
  v_mfma_f32_16x16x32_bf16 v[20:23], v[92:95], v[64:67], v[20:23]
  v_mfma_f32_16x16x32_bf16 v[24:27], v[96:99], v[64:67], v[24:27]
  ds_read_b128 v[80:83], v1 offset:51200
  ds_read_b128 v[84:87], v1 offset:52224
  ds_read_b128 v[88:91], v1 offset:53248
  ds_read_b128 v[92:95], v1 offset:54272
  ds_read_b128 v[96:99], v1 offset:55296
  s_waitcnt lgkmcnt(5)
  v_mfma_f32_16x16x32_bf16 v[8:11], v[100:103], v[68:71], v[8:11]
  v_mfma_f32_16x16x32_bf16 v[12:15], v[104:107], v[68:71], v[12:15]
  v_mfma_f32_16x16x32_bf16 v[16:19], v[108:111], v[68:71], v[16:19]
  v_mfma_f32_16x16x32_bf16 v[20:23], v[112:115], v[68:71], v[20:23]
  v_mfma_f32_16x16x32_bf16 v[24:27], v[116:119], v[68:71], v[24:27]
  ds_read_b128 v[100:103], v1 offset:56320
  ds_read_b128 v[104:107], v1 offset:57344
  ds_read_b128 v[108:111], v1 offset:58368
  ds_read_b128 v[112:115], v1 offset:59392
  ds_read_b128 v[116:119], v1 offset:60416
  s_waitcnt lgkmcnt(5)
  v_mfma_f32_16x16x32_bf16 v[8:11], v[80:83], v[72:75], v[8:11]
  v_mfma_f32_16x16x32_bf16 v[12:15], v[84:87], v[72:75], v[12:15]
  v_mfma_f32_16x16x32_bf16 v[16:19], v[88:91], v[72:75], v[16:19]
  v_mfma_f32_16x16x32_bf16 v[20:23], v[92:95], v[72:75], v[20:23]
  v_mfma_f32_16x16x32_bf16 v[24:27], v[96:99], v[72:75], v[24:27]
  s_waitcnt lgkmcnt(0)
  v_mfma_f32_16x16x32_bf16 v[8:11], v[100:103], v[76:79], v[8:11]
  v_mfma_f32_16x16x32_bf16 v[12:15], v[104:107], v[76:79], v[12:15]
  v_mfma_f32_16x16x32_bf16 v[16:19], v[108:111], v[76:79], v[16:19]
  v_mfma_f32_16x16x32_bf16 v[20:23], v[112:115], v[76:79], v[20:23]
  v_mfma_f32_16x16x32_bf16 v[24:27], v[116:119], v[76:79], v[24:27]
  s_waitcnt vmcnt(9)
  s_barrier
  s_add_u32 m0, s29, 40960
  s_nop 0
  buffer_load_dwordx4 v2, s[4:7], s24 offen lds
  s_add_u32 m0, s29, 41984
  s_nop 0
  buffer_load_dwordx4 v2, s[4:7], s25 offen lds
  s_add_u32 m0, s29, 43008
  s_nop 0
  buffer_load_dwordx4 v2, s[4:7], s26 offen lds
  s_add_u32 m0, s29, 44032
  s_nop 0
  buffer_load_dwordx4 v2, s[4:7], s27 offen lds
  s_add_u32 m0, s29, 45056
  s_nop 0
  buffer_load_dwordx4 v2, s[4:7], s28 offen lds
  buffer_load_dwordx4 v[64:67], v1, s[4:7], s22 offen offset:0
  buffer_load_dwordx4 v[68:71], v1, s[4:7], s22 offen offset:1024
  buffer_load_dwordx4 v[72:75], v1, s[4:7], s22 offen offset:2048
  buffer_load_dwordx4 v[76:79], v1, s[4:7], s22 offen offset:3072
  v_add_u32 v2, 0x1000, v2
  s_add_u32 s22, s22, 4096
  ds_read_b128 v[80:83], v1 offset:0
  ds_read_b128 v[84:87], v1 offset:1024
  ds_read_b128 v[88:91], v1 offset:2048
  ds_read_b128 v[92:95], v1 offset:3072
  ds_read_b128 v[96:99], v1 offset:4096
  ds_read_b128 v[100:103], v1 offset:5120
  ds_read_b128 v[104:107], v1 offset:6144
  ds_read_b128 v[108:111], v1 offset:7168
  ds_read_b128 v[112:115], v1 offset:8192
  ds_read_b128 v[116:119], v1 offset:9216
  s_waitcnt lgkmcnt(5)
  v_mfma_f32_16x16x32_bf16 v[8:11], v[80:83], v[32:35], v[8:11]
  v_mfma_f32_16x16x32_bf16 v[12:15], v[84:87], v[32:35], v[12:15]
  v_mfma_f32_16x16x32_bf16 v[16:19], v[88:91], v[32:35], v[16:19]
  v_mfma_f32_16x16x32_bf16 v[20:23], v[92:95], v[32:35], v[20:23]
  v_mfma_f32_16x16x32_bf16 v[24:27], v[96:99], v[32:35], v[24:27]
  ds_read_b128 v[80:83], v1 offset:10240
  ds_read_b128 v[84:87], v1 offset:11264
  ds_read_b128 v[88:91], v1 offset:12288
  ds_read_b128 v[92:95], v1 offset:13312
  ds_read_b128 v[96:99], v1 offset:14336
  s_waitcnt lgkmcnt(5)
  v_mfma_f32_16x16x32_bf16 v[8:11], v[100:103], v[36:39], v[8:11]
  v_mfma_f32_16x16x32_bf16 v[12:15], v[104:107], v[36:39], v[12:15]
  v_mfma_f32_16x16x32_bf16 v[16:19], v[108:111], v[36:39], v[16:19]
  v_mfma_f32_16x16x32_bf16 v[20:23], v[112:115], v[36:39], v[20:23]
  v_mfma_f32_16x16x32_bf16 v[24:27], v[116:119], v[36:39], v[24:27]
  ds_read_b128 v[100:103], v1 offset:15360
  ds_read_b128 v[104:107], v1 offset:16384
  ds_read_b128 v[108:111], v1 offset:17408
  ds_read_b128 v[112:115], v1 offset:18432
  ds_read_b128 v[116:119], v1 offset:19456
  s_waitcnt lgkmcnt(5)
  v_mfma_f32_16x16x32_bf16 v[8:11], v[80:83], v[40:43], v[8:11]
  v_mfma_f32_16x16x32_bf16 v[12:15], v[84:87], v[40:43], v[12:15]
  v_mfma_f32_16x16x32_bf16 v[16:19], v[88:91], v[40:43], v[16:19]
  v_mfma_f32_16x16x32_bf16 v[20:23], v[92:95], v[40:43], v[20:23]
  v_mfma_f32_16x16x32_bf16 v[24:27], v[96:99], v[40:43], v[24:27]
  s_waitcnt lgkmcnt(0)
  v_mfma_f32_16x16x32_bf16 v[8:11], v[100:103], v[44:47], v[8:11]
  v_mfma_f32_16x16x32_bf16 v[12:15], v[104:107], v[44:47], v[12:15]
  v_mfma_f32_16x16x32_bf16 v[16:19], v[108:111], v[44:47], v[16:19]
  v_mfma_f32_16x16x32_bf16 v[20:23], v[112:115], v[44:47], v[20:23]
  v_mfma_f32_16x16x32_bf16 v[24:27], v[116:119], v[44:47], v[24:27]
  s_add_u32 s30, s30, 1
  s_cmp_lt_u32 s30, 1
  s_cbranch_scc1 outb2_loop2
  s_waitcnt vmcnt(9)
  s_barrier
  s_add_u32 m0, s29, 0
  s_nop 0
  buffer_load_dwordx4 v2, s[4:7], s24 offen lds
  s_add_u32 m0, s29, 1024
  s_nop 0
  buffer_load_dwordx4 v2, s[4:7], s25 offen lds
  s_add_u32 m0, s29, 2048
  s_nop 0
  buffer_load_dwordx4 v2, s[4:7], s26 offen lds
  s_add_u32 m0, s29, 3072
  s_nop 0
  buffer_load_dwordx4 v2, s[4:7], s27 offen lds
  s_add_u32 m0, s29, 4096
  s_nop 0
  buffer_load_dwordx4 v2, s[4:7], s28 offen lds
  buffer_load_dwordx4 v[32:35], v1, s[4:7], s22 offen offset:0
  buffer_load_dwordx4 v[36:39], v1, s[4:7], s22 offen offset:1024
  buffer_load_dwordx4 v[40:43], v1, s[4:7], s22 offen offset:2048
  buffer_load_dwordx4 v[44:47], v1, s[4:7], s22 offen offset:3072
  v_add_u32 v2, 0x1000, v2
  s_add_u32 s22, s22, 4096
  ds_read_b128 v[80:83], v1 offset:20480
  ds_read_b128 v[84:87], v1 offset:21504
  ds_read_b128 v[88:91], v1 offset:22528
  ds_read_b128 v[92:95], v1 offset:23552
  ds_read_b128 v[96:99], v1 offset:24576
  ds_read_b128 v[100:103], v1 offset:25600
  ds_read_b128 v[104:107], v1 offset:26624
  ds_read_b128 v[108:111], v1 offset:27648
  ds_read_b128 v[112:115], v1 offset:28672
  ds_read_b128 v[116:119], v1 offset:29696
  s_waitcnt lgkmcnt(5)
  v_mfma_f32_16x16x32_bf16 v[8:11], v[80:83], v[48:51], v[8:11]
  v_mfma_f32_16x16x32_bf16 v[12:15], v[84:87], v[48:51], v[12:15]
  v_mfma_f32_16x16x32_bf16 v[16:19], v[88:91], v[48:51], v[16:19]
  v_mfma_f32_16x16x32_bf16 v[20:23], v[92:95], v[48:51], v[20:23]
  v_mfma_f32_16x16x32_bf16 v[24:27], v[96:99], v[48:51], v[24:27]
  ds_read_b128 v[80:83], v1 offset:30720
  ds_read_b128 v[84:87], v1 offset:31744
  ds_read_b128 v[88:91], v1 offset:32768
  ds_read_b128 v[92:95], v1 offset:33792
  ds_read_b128 v[96:99], v1 offset:34816
  s_waitcnt lgkmcnt(5)
  v_mfma_f32_16x16x32_bf16 v[8:11], v[100:103], v[52:55], v[8:11]
  v_mfma_f32_16x16x32_bf16 v[12:15], v[104:107], v[52:55], v[12:15]
  v_mfma_f32_16x16x32_bf16 v[16:19], v[108:111], v[52:55], v[16:19]
  v_mfma_f32_16x16x32_bf16 v[20:23], v[112:115], v[52:55], v[20:23]
  v_mfma_f32_16x16x32_bf16 v[24:27], v[116:119], v[52:55], v[24:27]
  ds_read_b128 v[100:103], v1 offset:35840
  ds_read_b128 v[104:107], v1 offset:36864
  ds_read_b128 v[108:111], v1 offset:37888
  ds_read_b128 v[112:115], v1 offset:38912
  ds_read_b128 v[116:119], v1 offset:39936
  s_waitcnt lgkmcnt(5)
  v_mfma_f32_16x16x32_bf16 v[8:11], v[80:83], v[56:59], v[8:11]
  v_mfma_f32_16x16x32_bf16 v[12:15], v[84:87], v[56:59], v[12:15]
  v_mfma_f32_16x16x32_bf16 v[16:19], v[88:91], v[56:59], v[16:19]
  v_mfma_f32_16x16x32_bf16 v[20:23], v[92:95], v[56:59], v[20:23]
  v_mfma_f32_16x16x32_bf16 v[24:27], v[96:99], v[56:59], v[24:27]
  s_waitcnt lgkmcnt(0)
  v_mfma_f32_16x16x32_bf16 v[8:11], v[100:103], v[60:63], v[8:11]
  v_mfma_f32_16x16x32_bf16 v[12:15], v[104:107], v[60:63], v[12:15]
  v_mfma_f32_16x16x32_bf16 v[16:19], v[108:111], v[60:63], v[16:19]
  v_mfma_f32_16x16x32_bf16 v[20:23], v[112:115], v[60:63], v[20:23]
  v_mfma_f32_16x16x32_bf16 v[24:27], v[116:119], v[60:63], v[24:27]
  s_waitcnt vmcnt(9)
  s_barrier
  s_add_u32 m0, s29, 20480
  s_nop 0
  buffer_load_dwordx4 v2, s[4:7], s24 offen lds
  s_add_u32 m0, s29, 21504
  s_nop 0
  buffer_load_dwordx4 v2, s[4:7], s25 offen lds
  s_add_u32 m0, s29, 22528
  s_nop 0
  buffer_load_dwordx4 v2, s[4:7], s26 offen lds
  s_add_u32 m0, s29, 23552
  s_nop 0
  buffer_load_dwordx4 v2, s[4:7], s27 offen lds
  s_add_u32 m0, s29, 24576
  s_nop 0
  buffer_load_dwordx4 v2, s[4:7], s28 offen lds
  buffer_load_dwordx4 v[48:51], v1, s[4:7], s22 offen offset:0
  buffer_load_dwordx4 v[52:55], v1, s[4:7], s22 offen offset:1024
  buffer_load_dwordx4 v[56:59], v1, s[4:7], s22 offen offset:2048
  buffer_load_dwordx4 v[60:63], v1, s[4:7], s22 offen offset:3072
  v_add_u32 v2, 0x1000, v2
  s_add_u32 s22, s22, 4096
  ds_read_b128 v[80:83], v1 offset:40960
  ds_read_b128 v[84:87], v1 offset:41984
  ds_read_b128 v[88:91], v1 offset:43008
  ds_read_b128 v[92:95], v1 offset:44032
  ds_read_b128 v[96:99], v1 offset:45056
  ds_read_b128 v[100:103], v1 offset:46080
  ds_read_b128 v[104:107], v1 offset:47104
  ds_read_b128 v[108:111], v1 offset:48128
  ds_read_b128 v[112:115], v1 offset:49152
  ds_read_b128 v[116:119], v1 offset:50176
  s_waitcnt lgkmcnt(5)
  v_mfma_f32_16x16x32_bf16 v[8:11], v[80:83], v[64:67], v[8:11]
  v_mfma_f32_16x16x32_bf16 v[12:15], v[84:87], v[64:67], v[12:15]
  v_mfma_f32_16x16x32_bf16 v[16:19], v[88:91], v[64:67], v[16:19]
  v_mfma_f32_16x16x32_bf16 v[20:23], v[92:95], v[64:67], v[20:23]
  v_mfma_f32_16x16x32_bf16 v[24:27], v[96:99], v[64:67], v[24:27]
  ds_read_b128 v[80:83], v1 offset:51200
  ds_read_b128 v[84:87], v1 offset:52224
  ds_read_b128 v[88:91], v1 offset:53248
  ds_read_b128 v[92:95], v1 offset:54272
  ds_read_b128 v[96:99], v1 offset:55296
  s_waitcnt lgkmcnt(5)
  v_mfma_f32_16x16x32_bf16 v[8:11], v[100:103], v[68:71], v[8:11]
  v_mfma_f32_16x16x32_bf16 v[12:15], v[104:107], v[68:71], v[12:15]
  v_mfma_f32_16x16x32_bf16 v[16:19], v[108:111], v[68:71], v[16:19]
  v_mfma_f32_16x16x32_bf16 v[20:23], v[112:115], v[68:71], v[20:23]
  v_mfma_f32_16x16x32_bf16 v[24:27], v[116:119], v[68:71], v[24:27]
  ds_read_b128 v[100:103], v1 offset:56320
  ds_read_b128 v[104:107], v1 offset:57344
  ds_read_b128 v[108:111], v1 offset:58368
  ds_read_b128 v[112:115], v1 offset:59392
  ds_read_b128 v[116:119], v1 offset:60416
  s_waitcnt lgkmcnt(5)
  v_mfma_f32_16x16x32_bf16 v[8:11], v[80:83], v[72:75], v[8:11]
  v_mfma_f32_16x16x32_bf16 v[12:15], v[84:87], v[72:75], v[12:15]
  v_mfma_f32_16x16x32_bf16 v[16:19], v[88:91], v[72:75], v[16:19]
  v_mfma_f32_16x16x32_bf16 v[20:23], v[92:95], v[72:75], v[20:23]
  v_mfma_f32_16x16x32_bf16 v[24:27], v[96:99], v[72:75], v[24:27]
  s_waitcnt lgkmcnt(0)
  v_mfma_f32_16x16x32_bf16 v[8:11], v[100:103], v[76:79], v[8:11]
  v_mfma_f32_16x16x32_bf16 v[12:15], v[104:107], v[76:79], v[12:15]
  v_mfma_f32_16x16x32_bf16 v[16:19], v[108:111], v[76:79], v[16:19]
  v_mfma_f32_16x16x32_bf16 v[20:23], v[112:115], v[76:79], v[20:23]
  v_mfma_f32_16x16x32_bf16 v[24:27], v[116:119], v[76:79], v[24:27]
  s_waitcnt vmcnt(9)
  s_barrier
  ds_read_b128 v[80:83], v1 offset:0
  ds_read_b128 v[84:87], v1 offset:1024
  ds_read_b128 v[88:91], v1 offset:2048
  ds_read_b128 v[92:95], v1 offset:3072
  ds_read_b128 v[96:99], v1 offset:4096
  ds_read_b128 v[100:103], v1 offset:5120
  ds_read_b128 v[104:107], v1 offset:6144
  ds_read_b128 v[108:111], v1 offset:7168
  ds_read_b128 v[112:115], v1 offset:8192
  ds_read_b128 v[116:119], v1 offset:9216
  s_waitcnt lgkmcnt(5)
  v_mfma_f32_16x16x32_bf16 v[8:11], v[80:83], v[32:35], v[8:11]
  v_mfma_f32_16x16x32_bf16 v[12:15], v[84:87], v[32:35], v[12:15]
  v_mfma_f32_16x16x32_bf16 v[16:19], v[88:91], v[32:35], v[16:19]
  v_mfma_f32_16x16x32_bf16 v[20:23], v[92:95], v[32:35], v[20:23]
  v_mfma_f32_16x16x32_bf16 v[24:27], v[96:99], v[32:35], v[24:27]
  ds_read_b128 v[80:83], v1 offset:10240
  ds_read_b128 v[84:87], v1 offset:11264
  ds_read_b128 v[88:91], v1 offset:12288
  ds_read_b128 v[92:95], v1 offset:13312
  ds_read_b128 v[96:99], v1 offset:14336
  s_waitcnt lgkmcnt(5)
  v_mfma_f32_16x16x32_bf16 v[8:11], v[100:103], v[36:39], v[8:11]
  v_mfma_f32_16x16x32_bf16 v[12:15], v[104:107], v[36:39], v[12:15]
  v_mfma_f32_16x16x32_bf16 v[16:19], v[108:111], v[36:39], v[16:19]
  v_mfma_f32_16x16x32_bf16 v[20:23], v[112:115], v[36:39], v[20:23]
  v_mfma_f32_16x16x32_bf16 v[24:27], v[116:119], v[36:39], v[24:27]
  ds_read_b128 v[100:103], v1 offset:15360
  ds_read_b128 v[104:107], v1 offset:16384
  ds_read_b128 v[108:111], v1 offset:17408
  ds_read_b128 v[112:115], v1 offset:18432
  ds_read_b128 v[116:119], v1 offset:19456
  s_waitcnt lgkmcnt(5)
  v_mfma_f32_16x16x32_bf16 v[8:11], v[80:83], v[40:43], v[8:11]
  v_mfma_f32_16x16x32_bf16 v[12:15], v[84:87], v[40:43], v[12:15]
  v_mfma_f32_16x16x32_bf16 v[16:19], v[88:91], v[40:43], v[16:19]
  v_mfma_f32_16x16x32_bf16 v[20:23], v[92:95], v[40:43], v[20:23]
  v_mfma_f32_16x16x32_bf16 v[24:27], v[96:99], v[40:43], v[24:27]
  s_waitcnt lgkmcnt(0)
  v_mfma_f32_16x16x32_bf16 v[8:11], v[100:103], v[44:47], v[8:11]
  v_mfma_f32_16x16x32_bf16 v[12:15], v[104:107], v[44:47], v[12:15]
  v_mfma_f32_16x16x32_bf16 v[16:19], v[108:111], v[44:47], v[16:19]
  v_mfma_f32_16x16x32_bf16 v[20:23], v[112:115], v[44:47], v[20:23]
  v_mfma_f32_16x16x32_bf16 v[24:27], v[116:119], v[44:47], v[24:27]
  s_waitcnt vmcnt(0)
  s_barrier
  ds_read_b128 v[80:83], v1 offset:20480
  ds_read_b128 v[84:87], v1 offset:21504
  ds_read_b128 v[88:91], v1 offset:22528
  ds_read_b128 v[92:95], v1 offset:23552
  ds_read_b128 v[96:99], v1 offset:24576
  ds_read_b128 v[100:103], v1 offset:25600
  ds_read_b128 v[104:107], v1 offset:26624
  ds_read_b128 v[108:111], v1 offset:27648
  ds_read_b128 v[112:115], v1 offset:28672
  ds_read_b128 v[116:119], v1 offset:29696
  s_waitcnt lgkmcnt(5)
  v_mfma_f32_16x16x32_bf16 v[8:11], v[80:83], v[48:51], v[8:11]
  v_mfma_f32_16x16x32_bf16 v[12:15], v[84:87], v[48:51], v[12:15]
  v_mfma_f32_16x16x32_bf16 v[16:19], v[88:91], v[48:51], v[16:19]
  v_mfma_f32_16x16x32_bf16 v[20:23], v[92:95], v[48:51], v[20:23]
  v_mfma_f32_16x16x32_bf16 v[24:27], v[96:99], v[48:51], v[24:27]
  ds_read_b128 v[80:83], v1 offset:30720
  ds_read_b128 v[84:87], v1 offset:31744
  ds_read_b128 v[88:91], v1 offset:32768
  ds_read_b128 v[92:95], v1 offset:33792
  ds_read_b128 v[96:99], v1 offset:34816
  s_waitcnt lgkmcnt(5)
  v_mfma_f32_16x16x32_bf16 v[8:11], v[100:103], v[52:55], v[8:11]
  v_mfma_f32_16x16x32_bf16 v[12:15], v[104:107], v[52:55], v[12:15]
  v_mfma_f32_16x16x32_bf16 v[16:19], v[108:111], v[52:55], v[16:19]
  v_mfma_f32_16x16x32_bf16 v[20:23], v[112:115], v[52:55], v[20:23]
  v_mfma_f32_16x16x32_bf16 v[24:27], v[116:119], v[52:55], v[24:27]
  ds_read_b128 v[100:103], v1 offset:35840
  ds_read_b128 v[104:107], v1 offset:36864
  ds_read_b128 v[108:111], v1 offset:37888
  ds_read_b128 v[112:115], v1 offset:38912
  ds_read_b128 v[116:119], v1 offset:39936
  s_waitcnt lgkmcnt(5)
  v_mfma_f32_16x16x32_bf16 v[8:11], v[80:83], v[56:59], v[8:11]
  v_mfma_f32_16x16x32_bf16 v[12:15], v[84:87], v[56:59], v[12:15]
  v_mfma_f32_16x16x32_bf16 v[16:19], v[88:91], v[56:59], v[16:19]
  v_mfma_f32_16x16x32_bf16 v[20:23], v[92:95], v[56:59], v[20:23]
  v_mfma_f32_16x16x32_bf16 v[24:27], v[96:99], v[56:59], v[24:27]
  s_waitcnt lgkmcnt(0)
  v_mfma_f32_16x16x32_bf16 v[8:11], v[100:103], v[60:63], v[8:11]
  v_mfma_f32_16x16x32_bf16 v[12:15], v[104:107], v[60:63], v[12:15]
  v_mfma_f32_16x16x32_bf16 v[16:19], v[108:111], v[60:63], v[16:19]
  v_mfma_f32_16x16x32_bf16 v[20:23], v[112:115], v[60:63], v[20:23]
  v_mfma_f32_16x16x32_bf16 v[24:27], v[116:119], v[60:63], v[24:27]
  v_and_b32 v3, 63, v0
  v_and_b32 v4, 15, v3
  v_lshrrev_b32 v3, 4, v3
  s_lshl_b32 s21, s17, 6
  s_lshl_b32 s23, s16, 4
  s_add_u32 s21, s21, s23
  v_add_u32 v4, s21, v4
  v_mul_u32_u24 v6, 1280, v4
  v_lshl_add_u32 v6, v3, 4, v6
  s_mul_i32 s21, s18, 5
  s_add_u32 s23, s21, 0
  s_lshr_b32 s31, s23, 1
  s_lshl_b32 s31, s31, 6
  s_and_b32 s23, s23, 1
  s_lshl_b32 s23, s23, 3
  s_add_u32 s32, s31, s23
  s_add_u32 s40, s32, s20
  buffer_load_dwordx2 v[32:33], v6, s[8:11], s40 offen
  s_add_u32 s23, s21, 1
  s_lshr_b32 s31, s23, 1
  s_lshl_b32 s31, s31, 6
  s_and_b32 s23, s23, 1
  s_lshl_b32 s23, s23, 3
  s_add_u32 s33, s31, s23
  s_add_u32 s41, s33, s20
  buffer_load_dwordx2 v[34:35], v6, s[8:11], s41 offen
  s_add_u32 s23, s21, 2
  s_lshr_b32 s31, s23, 1
  s_lshl_b32 s31, s31, 6
  s_and_b32 s23, s23, 1
  s_lshl_b32 s23, s23, 3
  s_add_u32 s34, s31, s23
  s_add_u32 s42, s34, s20
  buffer_load_dwordx2 v[36:37], v6, s[8:11], s42 offen
  s_add_u32 s23, s21, 3
  s_lshr_b32 s31, s23, 1
  s_lshl_b32 s31, s31, 6
  s_and_b32 s23, s23, 1
  s_lshl_b32 s23, s23, 3
  s_add_u32 s35, s31, s23
  s_add_u32 s43, s35, s20
  buffer_load_dwordx2 v[38:39], v6, s[8:11], s43 offen
  s_add_u32 s23, s21, 4
  s_lshr_b32 s31, s23, 1
  s_lshl_b32 s31, s31, 6
  s_and_b32 s23, s23, 1
  s_lshl_b32 s23, s23, 3
  s_add_u32 s36, s31, s23
  s_add_u32 s44, s36, s20
  buffer_load_dwordx2 v[40:41], v6, s[8:11], s44 offen
  s_waitcnt vmcnt(0)
  v_cvt_pk_bf16_f32 v80, v8, v9
  v_cvt_pk_bf16_f32 v81, v10, v11
  v_lshlrev_b32 v8, 16, v80
  v_and_b32 v9, 0xffff0000, v80
  v_lshlrev_b32 v10, 16, v81
  v_and_b32 v11, 0xffff0000, v81
  v_lshlrev_b32 v82, 16, v32
  v_and_b32 v83, 0xffff0000, v32
  v_lshlrev_b32 v84, 16, v33
  v_and_b32 v85, 0xffff0000, v33
  v_add_f32 v8, v8, v82
  v_add_f32 v9, v9, v83
  v_add_f32 v10, v10, v84
  v_add_f32 v11, v11, v85
  v_cvt_pk_bf16_f32 v32, v8, v9
  v_cvt_pk_bf16_f32 v33, v10, v11
  buffer_store_dwordx2 v[32:33], v6, s[52:55], s32 offen
  v_cvt_pk_bf16_f32 v80, v12, v13
  v_cvt_pk_bf16_f32 v81, v14, v15
  v_lshlrev_b32 v12, 16, v80
  v_and_b32 v13, 0xffff0000, v80
  v_lshlrev_b32 v14, 16, v81
  v_and_b32 v15, 0xffff0000, v81
  v_lshlrev_b32 v82, 16, v34
  v_and_b32 v83, 0xffff0000, v34
  v_lshlrev_b32 v84, 16, v35
  v_and_b32 v85, 0xffff0000, v35
  v_add_f32 v12, v12, v82
  v_add_f32 v13, v13, v83
  v_add_f32 v14, v14, v84
  v_add_f32 v15, v15, v85
  v_cvt_pk_bf16_f32 v34, v12, v13
  v_cvt_pk_bf16_f32 v35, v14, v15
  buffer_store_dwordx2 v[34:35], v6, s[52:55], s33 offen
  v_cvt_pk_bf16_f32 v80, v16, v17
  v_cvt_pk_bf16_f32 v81, v18, v19
  v_lshlrev_b32 v16, 16, v80
  v_and_b32 v17, 0xffff0000, v80
  v_lshlrev_b32 v18, 16, v81
  v_and_b32 v19, 0xffff0000, v81
  v_lshlrev_b32 v82, 16, v36
  v_and_b32 v83, 0xffff0000, v36
  v_lshlrev_b32 v84, 16, v37
  v_and_b32 v85, 0xffff0000, v37
  v_add_f32 v16, v16, v82
  v_add_f32 v17, v17, v83
  v_add_f32 v18, v18, v84
  v_add_f32 v19, v19, v85
  v_cvt_pk_bf16_f32 v36, v16, v17
  v_cvt_pk_bf16_f32 v37, v18, v19
  buffer_store_dwordx2 v[36:37], v6, s[52:55], s34 offen
  v_cvt_pk_bf16_f32 v80, v20, v21
  v_cvt_pk_bf16_f32 v81, v22, v23
  v_lshlrev_b32 v20, 16, v80
  v_and_b32 v21, 0xffff0000, v80
  v_lshlrev_b32 v22, 16, v81
  v_and_b32 v23, 0xffff0000, v81
  v_lshlrev_b32 v82, 16, v38
  v_and_b32 v83, 0xffff0000, v38
  v_lshlrev_b32 v84, 16, v39
  v_and_b32 v85, 0xffff0000, v39
  v_add_f32 v20, v20, v82
  v_add_f32 v21, v21, v83
  v_add_f32 v22, v22, v84
  v_add_f32 v23, v23, v85
  v_cvt_pk_bf16_f32 v38, v20, v21
  v_cvt_pk_bf16_f32 v39, v22, v23
  buffer_store_dwordx2 v[38:39], v6, s[52:55], s35 offen
  v_cvt_pk_bf16_f32 v80, v24, v25
  v_cvt_pk_bf16_f32 v81, v26, v27
  v_lshlrev_b32 v24, 16, v80
  v_and_b32 v25, 0xffff0000, v80
  v_lshlrev_b32 v26, 16, v81
  v_and_b32 v27, 0xffff0000, v81
  v_lshlrev_b32 v82, 16, v40
  v_and_b32 v83, 0xffff0000, v40
  v_lshlrev_b32 v84, 16, v41
  v_and_b32 v85, 0xffff0000, v41
  v_add_f32 v24, v24, v82
  v_add_f32 v25, v25, v83
  v_add_f32 v26, v26, v84
  v_add_f32 v27, v27, v85
  v_cvt_pk_bf16_f32 v40, v24, v25
  v_cvt_pk_bf16_f32 v41, v26, v27
  buffer_store_dwordx2 v[40:41], v6, s[52:55], s36 offen
outb2_exit1:
  s_endpgm
.section .rodata,"a"
.p2align 6
.amdhsa_kernel prep_kernel
  .amdhsa_next_free_vgpr 64
  .amdhsa_next_free_sgpr 64
  .amdhsa_accum_offset 64
  .amdhsa_group_segment_fixed_size 0
  .amdhsa_kernarg_size 104
  .amdhsa_user_sgpr_count 2
  .amdhsa_user_sgpr_kernarg_segment_ptr 1
  .amdhsa_system_sgpr_workgroup_id_x 1
  .amdhsa_float_denorm_mode_32 3
.end_amdhsa_kernel
.p2align 6
.amdhsa_kernel ln1_kernel
  .amdhsa_next_free_vgpr 80
  .amdhsa_next_free_sgpr 32
  .amdhsa_accum_offset 80
  .amdhsa_group_segment_fixed_size 0
  .amdhsa_kernarg_size 104
  .amdhsa_user_sgpr_count 2
  .amdhsa_user_sgpr_kernarg_segment_ptr 1
  .amdhsa_system_sgpr_workgroup_id_x 1
  .amdhsa_float_denorm_mode_32 3
.end_amdhsa_kernel
.p2align 6
.amdhsa_kernel ln2_kernel
  .amdhsa_next_free_vgpr 80
  .amdhsa_next_free_sgpr 32
  .amdhsa_accum_offset 80
  .amdhsa_group_segment_fixed_size 0
  .amdhsa_kernarg_size 104
  .amdhsa_user_sgpr_count 2
  .amdhsa_user_sgpr_kernarg_segment_ptr 1
  .amdhsa_system_sgpr_workgroup_id_x 1
  .amdhsa_float_denorm_mode_32 3
.end_amdhsa_kernel
.p2align 6
.amdhsa_kernel reca_kernel
  .amdhsa_next_free_vgpr 512
  .amdhsa_next_free_sgpr 102
  .amdhsa_accum_offset 256
  .amdhsa_group_segment_fixed_size 0
  .amdhsa_kernarg_size 104
  .amdhsa_user_sgpr_count 2
  .amdhsa_user_sgpr_kernarg_segment_ptr 1
  .amdhsa_system_sgpr_workgroup_id_x 1
  .amdhsa_float_denorm_mode_32 3
.end_amdhsa_kernel
.p2align 6
.amdhsa_kernel attna_kernel
  .amdhsa_next_free_vgpr 248
  .amdhsa_next_free_sgpr 48
  .amdhsa_accum_offset 248
  .amdhsa_group_segment_fixed_size 0
  .amdhsa_kernarg_size 104
  .amdhsa_user_sgpr_count 2
  .amdhsa_user_sgpr_kernarg_segment_ptr 1
  .amdhsa_system_sgpr_workgroup_id_x 1
  .amdhsa_float_denorm_mode_32 3
.end_amdhsa_kernel
.p2align 6
.amdhsa_kernel outa1_kernel
  .amdhsa_next_free_vgpr 128
  .amdhsa_next_free_sgpr 64
  .amdhsa_accum_offset 128
  .amdhsa_group_segment_fixed_size 0
  .amdhsa_kernarg_size 104
  .amdhsa_user_sgpr_count 2
  .amdhsa_user_sgpr_kernarg_segment_ptr 1
  .amdhsa_system_sgpr_workgroup_id_x 1
  .amdhsa_float_denorm_mode_32 3
.end_amdhsa_kernel
.p2align 6
.amdhsa_kernel outa2_kernel
  .amdhsa_next_free_vgpr 128
  .amdhsa_next_free_sgpr 64
  .amdhsa_accum_offset 128
  .amdhsa_group_segment_fixed_size 0
  .amdhsa_kernarg_size 104
  .amdhsa_user_sgpr_count 2
  .amdhsa_user_sgpr_kernarg_segment_ptr 1
  .amdhsa_system_sgpr_workgroup_id_x 1
  .amdhsa_float_denorm_mode_32 3
.end_amdhsa_kernel
.p2align 6
.amdhsa_kernel qkvb_kernel
  .amdhsa_next_free_vgpr 256
  .amdhsa_next_free_sgpr 48
  .amdhsa_accum_offset 256
  .amdhsa_group_segment_fixed_size 0
  .amdhsa_kernarg_size 104
  .amdhsa_user_sgpr_count 2
  .amdhsa_user_sgpr_kernarg_segment_ptr 1
  .amdhsa_system_sgpr_workgroup_id_x 1
  .amdhsa_float_denorm_mode_32 3
.end_amdhsa_kernel
.p2align 6
.amdhsa_kernel attnb_kernel
  .amdhsa_next_free_vgpr 200
  .amdhsa_next_free_sgpr 48
  .amdhsa_accum_offset 200
  .amdhsa_group_segment_fixed_size 0
  .amdhsa_kernarg_size 104
  .amdhsa_user_sgpr_count 2
  .amdhsa_user_sgpr_kernarg_segment_ptr 1
  .amdhsa_system_sgpr_workgroup_id_x 1
  .amdhsa_float_denorm_mode_32 3
.end_amdhsa_kernel
.p2align 6
.amdhsa_kernel outb1_kernel
  .amdhsa_next_free_vgpr 128
  .amdhsa_next_free_sgpr 64
  .amdhsa_accum_offset 128
  .amdhsa_group_segment_fixed_size 0
  .amdhsa_kernarg_size 104
  .amdhsa_user_sgpr_count 2
  .amdhsa_user_sgpr_kernarg_segment_ptr 1
  .amdhsa_system_sgpr_workgroup_id_x 1
  .amdhsa_float_denorm_mode_32 3
.end_amdhsa_kernel
.p2align 6
.amdhsa_kernel outb2_kernel
  .amdhsa_next_free_vgpr 128
  .amdhsa_next_free_sgpr 64
  .amdhsa_accum_offset 128
  .amdhsa_group_segment_fixed_size 0
  .amdhsa_kernarg_size 104
  .amdhsa_user_sgpr_count 2
  .amdhsa_user_sgpr_kernarg_segment_ptr 1
  .amdhsa_system_sgpr_workgroup_id_x 1
  .amdhsa_float_denorm_mode_32 3
.end_amdhsa_kernel
```

```asm
; @launch kernel=prep_kernel grid=(2240,1,1) block=(256,1,1) lds=0
; @launch kernel=ln1_kernel grid=(128,1,1) block=(256,1,1) lds=512
; @launch kernel=reca_kernel grid=(256,1,1) block=(256,1,1) lds=81920
; @launch kernel=attna_kernel grid=(512,1,1) block=(256,1,1) lds=0
; @launch kernel=outa1_kernel grid=(256,1,1) block=(256,1,1) lds=61440
; @launch kernel=qkvb_kernel grid=(256,1,1) block=(256,1,1) lds=82944
; @launch kernel=attnb_kernel grid=(256,1,1) block=(256,1,1) lds=0
; @launch kernel=outb1_kernel grid=(256,1,1) block=(256,1,1) lds=61440
; @launch kernel=ln2_kernel grid=(128,1,1) block=(256,1,1) lds=512
; @launch kernel=reca_kernel grid=(256,1,1) block=(256,1,1) lds=81920
; @launch kernel=attna_kernel grid=(512,1,1) block=(256,1,1) lds=0
; @launch kernel=outa2_kernel grid=(256,1,1) block=(256,1,1) lds=61440
; @launch kernel=qkvb_kernel grid=(256,1,1) block=(256,1,1) lds=82944
; @launch kernel=attnb_kernel grid=(256,1,1) block=(256,1,1) lds=0
; @launch kernel=outb2_kernel grid=(256,1,1) block=(256,1,1) lds=61440
.amdgcn_target "amdgcn-amd-amdhsa--gfx950"
.text
.globl prep_kernel
.p2align 8
.type prep_kernel,@function
prep_kernel:
  s_cmp_ge_u32 s2, 2240
  s_cbranch_scc1 prep_exit1
  s_load_dwordx2 s[12:13], s[0:1], 96
  s_load_dwordx4 s[16:19], s[0:1], 16
  s_load_dwordx4 s[20:23], s[0:1], 32
  s_load_dwordx4 s[24:27], s[0:1], 64
  v_lshrrev_b32 v6, 6, v0
  v_and_b32 v1, 63, v0
  s_nop 0
  v_readfirstlane_b32 s14, v6
  v_lshlrev_b32 v5, 4, v1
  s_lshl_b32 s15, s2, 2
  s_nop 1
  s_add_u32 s15, s15, s14
  s_waitcnt lgkmcnt(0)
  s_mov_b32 s4, s12
  s_mov_b32 s5, s13
  s_mov_b32 s6, 0x10000000
  s_mov_b32 s7, 0x20000
  s_mov_b32 s11, 0x20000
  v_and_b32 v2, 15, v1
  v_lshrrev_b32 v3, 4, v1
  s_cmp_ge_u32 s15, 5760
  s_cbranch_scc1 prep_s22
  s_mul_hi_u32 s31, s15, 2236963
  s_mul_i32 s32, s31, 1920
  s_sub_u32 s32, s15, s32
  s_mul_hi_u32 s33, s32, 214748365
  s_mul_i32 s34, s33, 20
  s_sub_u32 s34, s32, s34
  s_cmp_eq_u32 s31, 0
  s_cselect_b32 s8, s16, s18
  s_cselect_b32 s9, s17, s19
  s_cmp_eq_u32 s31, 2
  s_cselect_b32 s8, s20, s8
  s_cselect_b32 s9, s21, s9
  s_mov_b32 s10, 7864320
  s_mul_i32 s35, s31, 7864320
  s_add_u32 s35, s35, 6291456
  v_lshlrev_b32 v6, 3, v3
  s_lshl_b32 s36, s34, 5
  v_add_u32 v6, s36, v6
  s_mov_b32 s37, 12288
  v_mul_lo_u32 v4, v6, s37
  s_lshl_b32 s36, s33, 7
  v_lshl_add_u32 v4, v2, 1, v4
  v_add_u32 v4, s36, v4
  s_mov_b32 s29, 0
  buffer_load_ushort v16, v4, s[8:11], s29 offen
  s_mov_b32 s29, 12288
  buffer_load_ushort v17, v4, s[8:11], s29 offen
  s_mov_b32 s29, 24576
  buffer_load_ushort v18, v4, s[8:11], s29 offen
  s_mov_b32 s29, 36864
  buffer_load_ushort v19, v4, s[8:11], s29 offen
  s_mov_b32 s29, 49152
  buffer_load_ushort v20, v4, s[8:11], s29 offen
  s_mov_b32 s29, 61440
  buffer_load_ushort v21, v4, s[8:11], s29 offen
  s_mov_b32 s29, 73728
  buffer_load_ushort v22, v4, s[8:11], s29 offen
  s_mov_b32 s29, 86016
  buffer_load_ushort v23, v4, s[8:11], s29 offen
  s_mov_b32 s29, 32
  buffer_load_ushort v24, v4, s[8:11], s29 offen
  s_mov_b32 s29, 12320
  buffer_load_ushort v25, v4, s[8:11], s29 offen
  s_mov_b32 s29, 24608
  buffer_load_ushort v26, v4, s[8:11], s29 offen
  s_mov_b32 s29, 36896
  buffer_load_ushort v27, v4, s[8:11], s29 offen
  s_mov_b32 s29, 49184
  buffer_load_ushort v28, v4, s[8:11], s29 offen
  s_mov_b32 s29, 61472
  buffer_load_ushort v29, v4, s[8:11], s29 offen
  s_mov_b32 s29, 73760
  buffer_load_ushort v30, v4, s[8:11], s29 offen
  s_mov_b32 s29, 86048
  buffer_load_ushort v31, v4, s[8:11], s29 offen
  s_mov_b32 s29, 64
  buffer_load_ushort v32, v4, s[8:11], s29 offen
  s_mov_b32 s29, 12352
  buffer_load_ushort v33, v4, s[8:11], s29 offen
  s_mov_b32 s29, 24640
  buffer_load_ushort v34, v4, s[8:11], s29 offen
  s_mov_b32 s29, 36928
  buffer_load_ushort v35, v4, s[8:11], s29 offen
  s_mov_b32 s29, 49216
  buffer_load_ushort v36, v4, s[8:11], s29 offen
  s_mov_b32 s29, 61504
  buffer_load_ushort v37, v4, s[8:11], s29 offen
  s_mov_b32 s29, 73792
  buffer_load_ushort v38, v4, s[8:11], s29 offen
  s_mov_b32 s29, 86080
  buffer_load_ushort v39, v4, s[8:11], s29 offen
  s_mov_b32 s29, 96
  buffer_load_ushort v40, v4, s[8:11], s29 offen
  s_mov_b32 s29, 12384
  buffer_load_ushort v41, v4, s[8:11], s29 offen
  s_mov_b32 s29, 24672
  buffer_load_ushort v42, v4, s[8:11], s29 offen
  s_mov_b32 s29, 36960
  buffer_load_ushort v43, v4, s[8:11], s29 offen
  s_mov_b32 s29, 49248
  buffer_load_ushort v44, v4, s[8:11], s29 offen
  s_mov_b32 s29, 61536
  buffer_load_ushort v45, v4, s[8:11], s29 offen
  s_mov_b32 s29, 73824
  buffer_load_ushort v46, v4, s[8:11], s29 offen
  s_mov_b32 s29, 86112
  buffer_load_ushort v47, v4, s[8:11], s29 offen
  s_waitcnt vmcnt(24)
  v_lshl_or_b32 v48, v17, 16, v16
  v_lshl_or_b32 v49, v19, 16, v18
  v_lshl_or_b32 v50, v21, 16, v20
  v_lshl_or_b32 v51, v23, 16, v22
  s_lshl_b32 s30, s33, 2
  s_add_u32 s30, s30, 0
  s_mul_i32 s30, s30, 20
  s_add_u32 s30, s30, s34
  s_lshl_b32 s30, s30, 10
  s_add_u32 s30, s30, s35
  buffer_store_dwordx4 v[48:51], v5, s[4:7], s30 offen
  s_waitcnt vmcnt(17)
  v_lshl_or_b32 v52, v25, 16, v24
  v_lshl_or_b32 v53, v27, 16, v26
  v_lshl_or_b32 v54, v29, 16, v28
  v_lshl_or_b32 v55, v31, 16, v30
  s_lshl_b32 s30, s33, 2
  s_add_u32 s30, s30, 1
  s_mul_i32 s30, s30, 20
  s_add_u32 s30, s30, s34
  s_lshl_b32 s30, s30, 10
  s_add_u32 s30, s30, s35
  buffer_store_dwordx4 v[52:55], v5, s[4:7], s30 offen
  s_waitcnt vmcnt(10)
  v_lshl_or_b32 v56, v33, 16, v32
  v_lshl_or_b32 v57, v35, 16, v34
  v_lshl_or_b32 v58, v37, 16, v36
  v_lshl_or_b32 v59, v39, 16, v38
  s_lshl_b32 s30, s33, 2
  s_add_u32 s30, s30, 2
  s_mul_i32 s30, s30, 20
  s_add_u32 s30, s30, s34
  s_lshl_b32 s30, s30, 10
  s_add_u32 s30, s30, s35
  buffer_store_dwordx4 v[56:59], v5, s[4:7], s30 offen
  s_waitcnt vmcnt(3)
  v_lshl_or_b32 v60, v41, 16, v40
  v_lshl_or_b32 v61, v43, 16, v42
  v_lshl_or_b32 v62, v45, 16, v44
  v_lshl_or_b32 v63, v47, 16, v46
  s_lshl_b32 s30, s33, 2
  s_add_u32 s30, s30, 3
  s_mul_i32 s30, s30, 20
  s_add_u32 s30, s30, s34
  s_lshl_b32 s30, s30, 10
  s_add_u32 s30, s30, s35
  buffer_store_dwordx4 v[60:63], v5, s[4:7], s30 offen
  s_branch prep_exit1
prep_s22:
  s_sub_u32 s15, s15, 5760
  s_cmp_ge_u32 s15, 1920
  s_cbranch_scc1 prep_s33
  s_mul_hi_u32 s33, s15, 22369622
  s_mul_i32 s34, s33, 192
  s_sub_u32 s34, s15, s34
  s_mov_b32 s8, s22
  s_mov_b32 s9, s23
  s_mov_b32 s10, 7864320
  v_lshlrev_b32 v6, 2, v3
  s_lshl_b32 s36, s34, 5
  v_add_u32 v6, s36, v6
  v_mul_u32_u24 v4, 1280, v6
  v_lshrrev_b32 v6, 2, v2
  v_lshl_add_u32 v4, v6, 4, v4
  v_and_b32 v6, 3, v2
  v_lshl_add_u32 v4, v6, 1, v4
  s_lshl_b32 s36, s33, 7
  v_add_u32 v4, s36, v4
  s_mov_b32 s29, 0
  buffer_load_ushort v16, v4, s[8:11], s29 offen
  s_mov_b32 s29, 1280
  buffer_load_ushort v17, v4, s[8:11], s29 offen
  s_mov_b32 s29, 2560
  buffer_load_ushort v18, v4, s[8:11], s29 offen
  s_mov_b32 s29, 3840
  buffer_load_ushort v19, v4, s[8:11], s29 offen
  s_mov_b32 s29, 20480
  buffer_load_ushort v20, v4, s[8:11], s29 offen
  s_mov_b32 s29, 21760
  buffer_load_ushort v21, v4, s[8:11], s29 offen
  s_mov_b32 s29, 23040
  buffer_load_ushort v22, v4, s[8:11], s29 offen
  s_mov_b32 s29, 24320
  buffer_load_ushort v23, v4, s[8:11], s29 offen
  s_mov_b32 s29, 8
  buffer_load_ushort v24, v4, s[8:11], s29 offen
  s_mov_b32 s29, 1288
  buffer_load_ushort v25, v4, s[8:11], s29 offen
  s_mov_b32 s29, 2568
  buffer_load_ushort v26, v4, s[8:11], s29 offen
  s_mov_b32 s29, 3848
  buffer_load_ushort v27, v4, s[8:11], s29 offen
  s_mov_b32 s29, 20488
  buffer_load_ushort v28, v4, s[8:11], s29 offen
  s_mov_b32 s29, 21768
  buffer_load_ushort v29, v4, s[8:11], s29 offen
  s_mov_b32 s29, 23048
  buffer_load_ushort v30, v4, s[8:11], s29 offen
  s_mov_b32 s29, 24328
  buffer_load_ushort v31, v4, s[8:11], s29 offen
  s_mov_b32 s29, 64
  buffer_load_ushort v32, v4, s[8:11], s29 offen
  s_mov_b32 s29, 1344
  buffer_load_ushort v33, v4, s[8:11], s29 offen
  s_mov_b32 s29, 2624
  buffer_load_ushort v34, v4, s[8:11], s29 offen
  s_mov_b32 s29, 3904
  buffer_load_ushort v35, v4, s[8:11], s29 offen
  s_mov_b32 s29, 20544
  buffer_load_ushort v36, v4, s[8:11], s29 offen
  s_mov_b32 s29, 21824
  buffer_load_ushort v37, v4, s[8:11], s29 offen
  s_mov_b32 s29, 23104
  buffer_load_ushort v38, v4, s[8:11], s29 offen
  s_mov_b32 s29, 24384
  buffer_load_ushort v39, v4, s[8:11], s29 offen
  s_mov_b32 s29, 72
  buffer_load_ushort v40, v4, s[8:11], s29 offen
  s_mov_b32 s29, 1352
  buffer_load_ushort v41, v4, s[8:11], s29 offen
  s_mov_b32 s29, 2632
  buffer_load_ushort v42, v4, s[8:11], s29 offen
  s_mov_b32 s29, 3912
  buffer_load_ushort v43, v4, s[8:11], s29 offen
  s_mov_b32 s29, 20552
  buffer_load_ushort v44, v4, s[8:11], s29 offen
  s_mov_b32 s29, 21832
  buffer_load_ushort v45, v4, s[8:11], s29 offen
  s_mov_b32 s29, 23112
  buffer_load_ushort v46, v4, s[8:11], s29 offen
  s_mov_b32 s29, 24392
  buffer_load_ushort v47, v4, s[8:11], s29 offen
  s_waitcnt vmcnt(24)
  v_lshl_or_b32 v48, v17, 16, v16
  v_lshl_or_b32 v49, v19, 16, v18
  v_lshl_or_b32 v50, v21, 16, v20
  v_lshl_or_b32 v51, v23, 16, v22
  s_lshl_b32 s30, s33, 2
  s_add_u32 s30, s30, 0
  s_mul_i32 s30, s30, 192
  s_add_u32 s30, s30, s34
  s_lshl_b32 s30, s30, 10
  s_add_u32 s30, s30, 29884416
  buffer_store_dwordx4 v[48:51], v5, s[4:7], s30 offen
  s_waitcnt vmcnt(17)
  v_lshl_or_b32 v52, v25, 16, v24
  v_lshl_or_b32 v53, v27, 16, v26
  v_lshl_or_b32 v54, v29, 16, v28
  v_lshl_or_b32 v55, v31, 16, v30
  s_lshl_b32 s30, s33, 2
  s_add_u32 s30, s30, 1
  s_mul_i32 s30, s30, 192
  s_add_u32 s30, s30, s34
  s_lshl_b32 s30, s30, 10
  s_add_u32 s30, s30, 29884416
  buffer_store_dwordx4 v[52:55], v5, s[4:7], s30 offen
  s_waitcnt vmcnt(10)
  v_lshl_or_b32 v56, v33, 16, v32
  v_lshl_or_b32 v57, v35, 16, v34
  v_lshl_or_b32 v58, v37, 16, v36
  v_lshl_or_b32 v59, v39, 16, v38
  s_lshl_b32 s30, s33, 2
  s_add_u32 s30, s30, 2
  s_mul_i32 s30, s30, 192
  s_add_u32 s30, s30, s34
  s_lshl_b32 s30, s30, 10
  s_add_u32 s30, s30, 29884416
  buffer_store_dwordx4 v[56:59], v5, s[4:7], s30 offen
  s_waitcnt vmcnt(3)
  v_lshl_or_b32 v60, v41, 16, v40
  v_lshl_or_b32 v61, v43, 16, v42
  v_lshl_or_b32 v62, v45, 16, v44
  v_lshl_or_b32 v63, v47, 16, v46
  s_lshl_b32 s30, s33, 2
  s_add_u32 s30, s30, 3
  s_mul_i32 s30, s30, 192
  s_add_u32 s30, s30, s34
  s_lshl_b32 s30, s30, 10
  s_add_u32 s30, s30, 29884416
  buffer_store_dwordx4 v[60:63], v5, s[4:7], s30 offen
  s_branch prep_exit1
prep_s33:
  s_sub_u32 s15, s15, 1920
  s_cmp_ge_u32 s15, 960
  s_cbranch_scc1 prep_s44
  s_mul_hi_u32 s33, s15, 107374183
  s_mul_i32 s34, s33, 40
  s_sub_u32 s34, s15, s34
  s_mov_b32 s8, s24
  s_mov_b32 s9, s25
  s_mov_b32 s10, 2457600
  v_lshrrev_b32 v6, 5, v1
  v_lshlrev_b32 v6, 3, v6
  s_lshl_b32 s36, s34, 4
  v_add_u32 v6, s36, v6
  v_mul_u32_u24 v4, 3840, v6
  v_and_b32 v6, 31, v1
  v_lshl_add_u32 v4, v6, 1, v4
  s_mul_i32 s36, s33, 160
  v_add_u32 v4, s36, v4
  v_cmp_gt_u32 vcc, 20, v6
  v_mov_b32 v6, 0x80000000
  s_nop 0
  v_cndmask_b32 v4, v6, v4, vcc
  s_mov_b32 s29, 0
  buffer_load_ushort v16, v4, s[8:11], s29 offen
  s_mov_b32 s29, 3840
  buffer_load_ushort v17, v4, s[8:11], s29 offen
  s_mov_b32 s29, 7680
  buffer_load_ushort v18, v4, s[8:11], s29 offen
  s_mov_b32 s29, 11520
  buffer_load_ushort v19, v4, s[8:11], s29 offen
  s_mov_b32 s29, 15360
  buffer_load_ushort v20, v4, s[8:11], s29 offen
  s_mov_b32 s29, 19200
  buffer_load_ushort v21, v4, s[8:11], s29 offen
  s_mov_b32 s29, 23040
  buffer_load_ushort v22, v4, s[8:11], s29 offen
  s_mov_b32 s29, 26880
  buffer_load_ushort v23, v4, s[8:11], s29 offen
  s_mov_b32 s29, 40
  buffer_load_ushort v24, v4, s[8:11], s29 offen
  s_mov_b32 s29, 3880
  buffer_load_ushort v25, v4, s[8:11], s29 offen
  s_mov_b32 s29, 7720
  buffer_load_ushort v26, v4, s[8:11], s29 offen
  s_mov_b32 s29, 11560
  buffer_load_ushort v27, v4, s[8:11], s29 offen
  s_mov_b32 s29, 15400
  buffer_load_ushort v28, v4, s[8:11], s29 offen
  s_mov_b32 s29, 19240
  buffer_load_ushort v29, v4, s[8:11], s29 offen
  s_mov_b32 s29, 23080
  buffer_load_ushort v30, v4, s[8:11], s29 offen
  s_mov_b32 s29, 26920
  buffer_load_ushort v31, v4, s[8:11], s29 offen
  s_mov_b32 s29, 80
  buffer_load_ushort v32, v4, s[8:11], s29 offen
  s_mov_b32 s29, 3920
  buffer_load_ushort v33, v4, s[8:11], s29 offen
  s_mov_b32 s29, 7760
  buffer_load_ushort v34, v4, s[8:11], s29 offen
  s_mov_b32 s29, 11600
  buffer_load_ushort v35, v4, s[8:11], s29 offen
  s_mov_b32 s29, 15440
  buffer_load_ushort v36, v4, s[8:11], s29 offen
  s_mov_b32 s29, 19280
  buffer_load_ushort v37, v4, s[8:11], s29 offen
  s_mov_b32 s29, 23120
  buffer_load_ushort v38, v4, s[8:11], s29 offen
  s_mov_b32 s29, 26960
  buffer_load_ushort v39, v4, s[8:11], s29 offen
  s_mov_b32 s29, 120
  buffer_load_ushort v40, v4, s[8:11], s29 offen
  s_mov_b32 s29, 3960
  buffer_load_ushort v41, v4, s[8:11], s29 offen
  s_mov_b32 s29, 7800
  buffer_load_ushort v42, v4, s[8:11], s29 offen
  s_mov_b32 s29, 11640
  buffer_load_ushort v43, v4, s[8:11], s29 offen
  s_mov_b32 s29, 15480
  buffer_load_ushort v44, v4, s[8:11], s29 offen
  s_mov_b32 s29, 19320
  buffer_load_ushort v45, v4, s[8:11], s29 offen
  s_mov_b32 s29, 23160
  buffer_load_ushort v46, v4, s[8:11], s29 offen
  s_mov_b32 s29, 27000
  buffer_load_ushort v47, v4, s[8:11], s29 offen
  s_waitcnt vmcnt(24)
  v_lshl_or_b32 v48, v17, 16, v16
  v_lshl_or_b32 v49, v19, 16, v18
  v_lshl_or_b32 v50, v21, 16, v20
  v_lshl_or_b32 v51, v23, 16, v22
  s_lshl_b32 s30, s33, 2
  s_add_u32 s30, s30, 0
  s_mul_i32 s30, s30, 40
  s_add_u32 s30, s30, s34
  s_lshl_b32 s30, s30, 10
  s_add_u32 s30, s30, 156237824
  buffer_store_dwordx4 v[48:51], v5, s[4:7], s30 offen
  s_waitcnt vmcnt(17)
  v_lshl_or_b32 v52, v25, 16, v24
  v_lshl_or_b32 v53, v27, 16, v26
  v_lshl_or_b32 v54, v29, 16, v28
  v_lshl_or_b32 v55, v31, 16, v30
  s_lshl_b32 s30, s33, 2
  s_add_u32 s30, s30, 1
  s_mul_i32 s30, s30, 40
  s_add_u32 s30, s30, s34
  s_lshl_b32 s30, s30, 10
  s_add_u32 s30, s30, 156237824
  buffer_store_dwordx4 v[52:55], v5, s[4:7], s30 offen
  s_waitcnt vmcnt(10)
  v_lshl_or_b32 v56, v33, 16, v32
  v_lshl_or_b32 v57, v35, 16, v34
  v_lshl_or_b32 v58, v37, 16, v36
  v_lshl_or_b32 v59, v39, 16, v38
  s_lshl_b32 s30, s33, 2
  s_add_u32 s30, s30, 2
  s_mul_i32 s30, s30, 40
  s_add_u32 s30, s30, s34
  s_lshl_b32 s30, s30, 10
  s_add_u32 s30, s30, 156237824
  buffer_store_dwordx4 v[56:59], v5, s[4:7], s30 offen
  s_waitcnt vmcnt(3)
  v_lshl_or_b32 v60, v41, 16, v40
  v_lshl_or_b32 v61, v43, 16, v42
  v_lshl_or_b32 v62, v45, 16, v44
  v_lshl_or_b32 v63, v47, 16, v46
  s_lshl_b32 s30, s33, 2
  s_add_u32 s30, s30, 3
  s_mul_i32 s30, s30, 40
  s_add_u32 s30, s30, s34
  s_lshl_b32 s30, s30, 10
  s_add_u32 s30, s30, 156237824
  buffer_store_dwordx4 v[60:63], v5, s[4:7], s30 offen
  s_branch prep_exit1
prep_s44:
  s_sub_u32 s15, s15, 960
  s_mul_hi_u32 s33, s15, 134217728
  s_and_b32 s34, s15, 31
  s_lshr_b32 s33, s15, 5
  s_mov_b32 s8, s26
  s_mov_b32 s9, s27
  s_mov_b32 s10, 819200
  v_lshrrev_b32 v6, 1, v3
  v_lshlrev_b32 v6, 4, v6
  v_and_b32 v7, 1, v3
  v_lshl_add_u32 v6, v7, 2, v6
  v_mov_b32 v8, v6
  s_mul_i32 s36, s34, 20
  v_add_u32 v6, s36, v6
  v_mul_u32_u24 v4, 1280, v6
  v_lshrrev_b32 v6, 2, v2
  v_lshl_add_u32 v4, v6, 4, v4
  v_and_b32 v6, 3, v2
  v_lshl_add_u32 v4, v6, 1, v4
  s_lshl_b32 s36, s33, 7
  v_add_u32 v4, s36, v4
  v_mov_b32 v9, 0x80000000
  v_cmp_gt_u32 vcc, 17, v8
  s_nop 1
  v_cndmask_b32 v10, v9, v4, vcc
  v_cmp_gt_u32 vcc, 9, v8
  s_nop 1
  v_cndmask_b32 v11, v9, v4, vcc
  s_mov_b32 s29, 0
  buffer_load_ushort v16, v10, s[8:11], s29 offen
  s_mov_b32 s29, 1280
  buffer_load_ushort v17, v10, s[8:11], s29 offen
  s_mov_b32 s29, 2560
  buffer_load_ushort v18, v10, s[8:11], s29 offen
  s_mov_b32 s29, 3840
  buffer_load_ushort v19, v10, s[8:11], s29 offen
  s_mov_b32 s29, 10240
  buffer_load_ushort v20, v11, s[8:11], s29 offen
  s_mov_b32 s29, 11520
  buffer_load_ushort v21, v11, s[8:11], s29 offen
  s_mov_b32 s29, 12800
  buffer_load_ushort v22, v11, s[8:11], s29 offen
  s_mov_b32 s29, 14080
  buffer_load_ushort v23, v11, s[8:11], s29 offen
  s_mov_b32 s29, 8
  buffer_load_ushort v24, v10, s[8:11], s29 offen
  s_mov_b32 s29, 1288
  buffer_load_ushort v25, v10, s[8:11], s29 offen
  s_mov_b32 s29, 2568
  buffer_load_ushort v26, v10, s[8:11], s29 offen
  s_mov_b32 s29, 3848
  buffer_load_ushort v27, v10, s[8:11], s29 offen
  s_mov_b32 s29, 10248
  buffer_load_ushort v28, v11, s[8:11], s29 offen
  s_mov_b32 s29, 11528
  buffer_load_ushort v29, v11, s[8:11], s29 offen
  s_mov_b32 s29, 12808
  buffer_load_ushort v30, v11, s[8:11], s29 offen
  s_mov_b32 s29, 14088
  buffer_load_ushort v31, v11, s[8:11], s29 offen
  s_mov_b32 s29, 64
  buffer_load_ushort v32, v10, s[8:11], s29 offen
  s_mov_b32 s29, 1344
  buffer_load_ushort v33, v10, s[8:11], s29 offen
  s_mov_b32 s29, 2624
  buffer_load_ushort v34, v10, s[8:11], s29 offen
  s_mov_b32 s29, 3904
  buffer_load_ushort v35, v10, s[8:11], s29 offen
  s_mov_b32 s29, 10304
  buffer_load_ushort v36, v11, s[8:11], s29 offen
  s_mov_b32 s29, 11584
  buffer_load_ushort v37, v11, s[8:11], s29 offen
  s_mov_b32 s29, 12864
  buffer_load_ushort v38, v11, s[8:11], s29 offen
  s_mov_b32 s29, 14144
  buffer_load_ushort v39, v11, s[8:11], s29 offen
  s_mov_b32 s29, 72
  buffer_load_ushort v40, v10, s[8:11], s29 offen
  s_mov_b32 s29, 1352
  buffer_load_ushort v41, v10, s[8:11], s29 offen
  s_mov_b32 s29, 2632
  buffer_load_ushort v42, v10, s[8:11], s29 offen
  s_mov_b32 s29, 3912
  buffer_load_ushort v43, v10, s[8:11], s29 offen
  s_mov_b32 s29, 10312
  buffer_load_ushort v44, v11, s[8:11], s29 offen
  s_mov_b32 s29, 11592
  buffer_load_ushort v45, v11, s[8:11], s29 offen
  s_mov_b32 s29, 12872
  buffer_load_ushort v46, v11, s[8:11], s29 offen
  s_mov_b32 s29, 14152
  buffer_load_ushort v47, v11, s[8:11], s29 offen
  s_waitcnt vmcnt(24)
  v_lshl_or_b32 v48, v17, 16, v16
  v_lshl_or_b32 v49, v19, 16, v18
  v_lshl_or_b32 v50, v21, 16, v20
  v_lshl_or_b32 v51, v23, 16, v22
  s_lshl_b32 s30, s33, 2
  s_add_u32 s30, s30, 0
  s_lshl_b32 s30, s30, 5
  s_add_u32 s30, s30, s34
  s_lshl_b32 s30, s30, 10
  s_add_u32 s30, s30, 160169984
  buffer_store_dwordx4 v[48:51], v5, s[4:7], s30 offen
  s_waitcnt vmcnt(17)
  v_lshl_or_b32 v52, v25, 16, v24
  v_lshl_or_b32 v53, v27, 16, v26
  v_lshl_or_b32 v54, v29, 16, v28
  v_lshl_or_b32 v55, v31, 16, v30
  s_lshl_b32 s30, s33, 2
  s_add_u32 s30, s30, 1
  s_lshl_b32 s30, s30, 5
  s_add_u32 s30, s30, s34
  s_lshl_b32 s30, s30, 10
  s_add_u32 s30, s30, 160169984
  buffer_store_dwordx4 v[52:55], v5, s[4:7], s30 offen
  s_waitcnt vmcnt(10)
  v_lshl_or_b32 v56, v33, 16, v32
  v_lshl_or_b32 v57, v35, 16, v34
  v_lshl_or_b32 v58, v37, 16, v36
  v_lshl_or_b32 v59, v39, 16, v38
  s_lshl_b32 s30, s33, 2
  s_add_u32 s30, s30, 2
  s_lshl_b32 s30, s30, 5
  s_add_u32 s30, s30, s34
  s_lshl_b32 s30, s30, 10
  s_add_u32 s30, s30, 160169984
  buffer_store_dwordx4 v[56:59], v5, s[4:7], s30 offen
  s_waitcnt vmcnt(3)
  v_lshl_or_b32 v60, v41, 16, v40
  v_lshl_or_b32 v61, v43, 16, v42
  v_lshl_or_b32 v62, v45, 16, v44
  v_lshl_or_b32 v63, v47, 16, v46
  s_lshl_b32 s30, s33, 2
  s_add_u32 s30, s30, 3
  s_lshl_b32 s30, s30, 5
  s_add_u32 s30, s30, s34
  s_lshl_b32 s30, s30, 10
  s_add_u32 s30, s30, 160169984
  buffer_store_dwordx4 v[60:63], v5, s[4:7], s30 offen
prep_exit1:
  s_endpgm
.globl ln1_kernel
.p2align 8
.type ln1_kernel,@function
ln1_kernel:
  s_cmp_ge_u32 s2, 128
  s_cbranch_scc1 ln1_exit1
  s_load_dwordx2 s[12:13], s[0:1], 96
  s_load_dwordx2 s[14:15], s[0:1], 0
  v_lshrrev_b32 v2, 6, v0
  v_and_b32 v3, 63, v0
  s_nop 0
  v_readfirstlane_b32 s16, v2
  s_waitcnt lgkmcnt(0)
  s_mov_b32 s4, s12
  s_mov_b32 s5, s13
  s_mov_b32 s6, 0x10000000
  s_mov_b32 s7, 0x20000
  s_mov_b32 s8, s14
  s_mov_b32 s9, s15
  s_mov_b32 s10, 2621440
  s_mov_b32 s11, 0x20000
  s_mov_b32 s20, 0
  v_and_b32 v2, 15, v3
  v_lshrrev_b32 v4, 4, v3
  s_lshl_b32 s17, s2, 4
  v_add_u32 v1, s17, v2
  v_mul_u32_u24 v1, 1280, v1
  v_lshl_add_u32 v1, v4, 4, v1
  s_mul_i32 s17, s16, 320
  s_add_u32 s20, s20, s17
  buffer_load_dwordx4 v[8:11], v1, s[8:11], s20 offen offset:0
  buffer_load_dwordx4 v[12:15], v1, s[8:11], s20 offen offset:64
  buffer_load_dwordx4 v[16:19], v1, s[8:11], s20 offen offset:128
  buffer_load_dwordx4 v[20:23], v1, s[8:11], s20 offen offset:192
  buffer_load_dwordx4 v[24:27], v1, s[8:11], s20 offen offset:256
  v_lshlrev_b32 v5, 2, v2
  s_lshl_b32 s17, s16, 6
  v_add_u32 v1, s17, v5
  s_waitcnt vmcnt(0)
  v_lshlrev_b32 v28, 16, v8
  v_and_b32 v29, 0xffff0000, v8
  v_lshlrev_b32 v30, 16, v9
  v_and_b32 v31, 0xffff0000, v9
  v_lshlrev_b32 v32, 16, v10
  v_and_b32 v33, 0xffff0000, v10
  v_lshlrev_b32 v34, 16, v11
  v_and_b32 v35, 0xffff0000, v11
  v_lshlrev_b32 v36, 16, v12
  v_and_b32 v37, 0xffff0000, v12
  v_lshlrev_b32 v38, 16, v13
  v_and_b32 v39, 0xffff0000, v13
  v_lshlrev_b32 v40, 16, v14
  v_and_b32 v41, 0xffff0000, v14
  v_lshlrev_b32 v42, 16, v15
  v_and_b32 v43, 0xffff0000, v15
  v_lshlrev_b32 v44, 16, v16
  v_and_b32 v45, 0xffff0000, v16
  v_lshlrev_b32 v46, 16, v17
  v_and_b32 v47, 0xffff0000, v17
  v_lshlrev_b32 v48, 16, v18
  v_and_b32 v49, 0xffff0000, v18
  v_lshlrev_b32 v50, 16, v19
  v_and_b32 v51, 0xffff0000, v19
  v_lshlrev_b32 v52, 16, v20
  v_and_b32 v53, 0xffff0000, v20
  v_lshlrev_b32 v54, 16, v21
  v_and_b32 v55, 0xffff0000, v21
  v_lshlrev_b32 v56, 16, v22
  v_and_b32 v57, 0xffff0000, v22
  v_lshlrev_b32 v58, 16, v23
  v_and_b32 v59, 0xffff0000, v23
  v_lshlrev_b32 v60, 16, v24
  v_and_b32 v61, 0xffff0000, v24
  v_lshlrev_b32 v62, 16, v25
  v_and_b32 v63, 0xffff0000, v25
  v_lshlrev_b32 v64, 16, v26
  v_and_b32 v65, 0xffff0000, v26
  v_lshlrev_b32 v66, 16, v27
  v_and_b32 v67, 0xffff0000, v27
  v_pk_add_f32 v[6:7], v[28:29], v[30:31]
  v_pk_add_f32 v[6:7], v[6:7], v[32:33]
  v_pk_add_f32 v[6:7], v[6:7], v[34:35]
  v_pk_add_f32 v[6:7], v[6:7], v[36:37]
  v_pk_add_f32 v[6:7], v[6:7], v[38:39]
  v_pk_add_f32 v[6:7], v[6:7], v[40:41]
  v_pk_add_f32 v[6:7], v[6:7], v[42:43]
  v_pk_add_f32 v[6:7], v[6:7], v[44:45]
  v_pk_add_f32 v[6:7], v[6:7], v[46:47]
  v_pk_add_f32 v[6:7], v[6:7], v[48:49]
  v_pk_add_f32 v[6:7], v[6:7], v[50:51]
  v_pk_add_f32 v[6:7], v[6:7], v[52:53]
  v_pk_add_f32 v[6:7], v[6:7], v[54:55]
  v_pk_add_f32 v[6:7], v[6:7], v[56:57]
  v_pk_add_f32 v[6:7], v[6:7], v[58:59]
  v_pk_add_f32 v[6:7], v[6:7], v[60:61]
  v_pk_add_f32 v[6:7], v[6:7], v[62:63]
  v_pk_add_f32 v[6:7], v[6:7], v[64:65]
  v_pk_add_f32 v[6:7], v[6:7], v[66:67]
  v_add_f32 v4, v6, v7
  v_mov_b32 v2, v4
  s_nop 1
  v_permlane32_swap_b32 v4, v2
  v_add_f32 v4, v4, v2
  v_mov_b32 v2, v4
  s_nop 1
  v_permlane16_swap_b32 v4, v2
  v_add_f32 v4, v4, v2
  ds_write_b32 v1, v4 offset:0
  s_waitcnt lgkmcnt(0)
  s_barrier
  ds_read_b32 v4, v5 offset:0
  ds_read_b32 v2, v5 offset:64
  ds_read_b32 v3, v5 offset:128
  ds_read_b32 v6, v5 offset:192
  s_waitcnt lgkmcnt(0)
  v_add_f32 v4, v4, v2
  v_add_f32 v3, v3, v6
  v_add_f32 v4, v4, v3
  v_mul_f32 v4, 0x3acccccd, v4
  v_sub_f32 v28, v28, v4
  v_sub_f32 v29, v29, v4
  v_sub_f32 v30, v30, v4
  v_sub_f32 v31, v31, v4
  v_sub_f32 v32, v32, v4
  v_sub_f32 v33, v33, v4
  v_sub_f32 v34, v34, v4
  v_sub_f32 v35, v35, v4
  v_sub_f32 v36, v36, v4
  v_sub_f32 v37, v37, v4
  v_sub_f32 v38, v38, v4
  v_sub_f32 v39, v39, v4
  v_sub_f32 v40, v40, v4
  v_sub_f32 v41, v41, v4
  v_sub_f32 v42, v42, v4
  v_sub_f32 v43, v43, v4
  v_sub_f32 v44, v44, v4
  v_sub_f32 v45, v45, v4
  v_sub_f32 v46, v46, v4
  v_sub_f32 v47, v47, v4
  v_sub_f32 v48, v48, v4
  v_sub_f32 v49, v49, v4
  v_sub_f32 v50, v50, v4
  v_sub_f32 v51, v51, v4
  v_sub_f32 v52, v52, v4
  v_sub_f32 v53, v53, v4
  v_sub_f32 v54, v54, v4
  v_sub_f32 v55, v55, v4
  v_sub_f32 v56, v56, v4
  v_sub_f32 v57, v57, v4
  v_sub_f32 v58, v58, v4
  v_sub_f32 v59, v59, v4
  v_sub_f32 v60, v60, v4
  v_sub_f32 v61, v61, v4
  v_sub_f32 v62, v62, v4
  v_sub_f32 v63, v63, v4
  v_sub_f32 v64, v64, v4
  v_sub_f32 v65, v65, v4
  v_sub_f32 v66, v66, v4
  v_sub_f32 v67, v67, v4
  v_mul_f32 v6, v28, v28
  v_mul_f32 v7, v29, v29
  v_fmac_f32 v6, v30, v30
  v_fmac_f32 v7, v31, v31
  v_fmac_f32 v6, v32, v32
  v_fmac_f32 v7, v33, v33
  v_fmac_f32 v6, v34, v34
  v_fmac_f32 v7, v35, v35
  v_fmac_f32 v6, v36, v36
  v_fmac_f32 v7, v37, v37
  v_fmac_f32 v6, v38, v38
  v_fmac_f32 v7, v39, v39
  v_fmac_f32 v6, v40, v40
  v_fmac_f32 v7, v41, v41
  v_fmac_f32 v6, v42, v42
  v_fmac_f32 v7, v43, v43
  v_fmac_f32 v6, v44, v44
  v_fmac_f32 v7, v45, v45
  v_fmac_f32 v6, v46, v46
  v_fmac_f32 v7, v47, v47
  v_fmac_f32 v6, v48, v48
  v_fmac_f32 v7, v49, v49
  v_fmac_f32 v6, v50, v50
  v_fmac_f32 v7, v51, v51
  v_fmac_f32 v6, v52, v52
  v_fmac_f32 v7, v53, v53
  v_fmac_f32 v6, v54, v54
  v_fmac_f32 v7, v55, v55
  v_fmac_f32 v6, v56, v56
  v_fmac_f32 v7, v57, v57
  v_fmac_f32 v6, v58, v58
  v_fmac_f32 v7, v59, v59
  v_fmac_f32 v6, v60, v60
  v_fmac_f32 v7, v61, v61
  v_fmac_f32 v6, v62, v62
  v_fmac_f32 v7, v63, v63
  v_fmac_f32 v6, v64, v64
  v_fmac_f32 v7, v65, v65
  v_fmac_f32 v6, v66, v66
  v_fmac_f32 v7, v67, v67
  v_add_f32 v4, v6, v7
  v_mov_b32 v2, v4
  s_nop 1
  v_permlane32_swap_b32 v4, v2
  v_add_f32 v4, v4, v2
  v_mov_b32 v2, v4
  s_nop 1
  v_permlane16_swap_b32 v4, v2
  v_add_f32 v4, v4, v2
  ds_write_b32 v1, v4 offset:256
  s_waitcnt lgkmcnt(0)
  s_barrier
  ds_read_b32 v4, v5 offset:256
  ds_read_b32 v2, v5 offset:320
  ds_read_b32 v3, v5 offset:384
  ds_read_b32 v6, v5 offset:448
  s_waitcnt lgkmcnt(0)
  v_add_f32 v4, v4, v2
  v_add_f32 v3, v3, v6
  v_add_f32 v4, v4, v3
  v_mov_b32 v2, 0x3727c5ac
  v_fmac_f32 v2, 0x3acccccd, v4
  v_rsq_f32 v4, v2
  s_nop 0
  v_mul_f32 v28, v28, v4
  v_mul_f32 v29, v29, v4
  v_mul_f32 v30, v30, v4
  v_mul_f32 v31, v31, v4
  v_mul_f32 v32, v32, v4
  v_mul_f32 v33, v33, v4
  v_mul_f32 v34, v34, v4
  v_mul_f32 v35, v35, v4
  v_mul_f32 v36, v36, v4
  v_mul_f32 v37, v37, v4
  v_mul_f32 v38, v38, v4
  v_mul_f32 v39, v39, v4
  v_mul_f32 v40, v40, v4
  v_mul_f32 v41, v41, v4
  v_mul_f32 v42, v42, v4
  v_mul_f32 v43, v43, v4
  v_mul_f32 v44, v44, v4
  v_mul_f32 v45, v45, v4
  v_mul_f32 v46, v46, v4
  v_mul_f32 v47, v47, v4
  v_mul_f32 v48, v48, v4
  v_mul_f32 v49, v49, v4
  v_mul_f32 v50, v50, v4
  v_mul_f32 v51, v51, v4
  v_mul_f32 v52, v52, v4
  v_mul_f32 v53, v53, v4
  v_mul_f32 v54, v54, v4
  v_mul_f32 v55, v55, v4
  v_mul_f32 v56, v56, v4
  v_mul_f32 v57, v57, v4
  v_mul_f32 v58, v58, v4
  v_mul_f32 v59, v59, v4
  v_mul_f32 v60, v60, v4
  v_mul_f32 v61, v61, v4
  v_mul_f32 v62, v62, v4
  v_mul_f32 v63, v63, v4
  v_mul_f32 v64, v64, v4
  v_mul_f32 v65, v65, v4
  v_mul_f32 v66, v66, v4
  v_mul_f32 v67, v67, v4
  v_cvt_pk_bf16_f32 v8, v28, v29
  v_cvt_pk_bf16_f32 v9, v30, v31
  v_cvt_pk_bf16_f32 v10, v32, v33
  v_cvt_pk_bf16_f32 v11, v34, v35
  v_cvt_pk_bf16_f32 v12, v36, v37
  v_cvt_pk_bf16_f32 v13, v38, v39
  v_cvt_pk_bf16_f32 v14, v40, v41
  v_cvt_pk_bf16_f32 v15, v42, v43
  v_cvt_pk_bf16_f32 v16, v44, v45
  v_cvt_pk_bf16_f32 v17, v46, v47
  v_cvt_pk_bf16_f32 v18, v48, v49
  v_cvt_pk_bf16_f32 v19, v50, v51
  v_cvt_pk_bf16_f32 v20, v52, v53
  v_cvt_pk_bf16_f32 v21, v54, v55
  v_cvt_pk_bf16_f32 v22, v56, v57
  v_cvt_pk_bf16_f32 v23, v58, v59
  v_cvt_pk_bf16_f32 v24, v60, v61
  v_cvt_pk_bf16_f32 v25, v62, v63
  v_cvt_pk_bf16_f32 v26, v64, v65
  v_cvt_pk_bf16_f32 v27, v66, v67
  v_and_b32 v3, 63, v0
  v_lshlrev_b32 v1, 4, v3
  s_mul_i32 s17, s2, 20480
  s_mul_i32 s18, s16, 5120
  s_add_u32 s17, s17, s18
  s_add_u32 s17, s17, 153616384
  buffer_store_dwordx4 v[8:11], v1, s[4:7], s17 offen offset:0
  buffer_store_dwordx4 v[12:15], v1, s[4:7], s17 offen offset:1024
  buffer_store_dwordx4 v[16:19], v1, s[4:7], s17 offen offset:2048
  buffer_store_dwordx4 v[20:23], v1, s[4:7], s17 offen offset:3072
  s_add_u32 s17, s17, 4096
  buffer_store_dwordx4 v[24:27], v1, s[4:7], s17 offen offset:0
  s_sub_u32 s21, 0, s12
  s_and_b32 s21, s21, 0x1fffff
  s_add_u32 s21, s21, 2097152
  v_mov_b32 v8, -1
  v_mov_b32 v9, -1
  v_mov_b32 v10, -1
  v_mov_b32 v11, -1
  v_lshlrev_b32 v12, 4, v0
  s_mul_i32 s22, s2, 12096
  s_add_u32 s22, s22, 0
  s_mul_i32 s23, s2, 12288
  s_add_u32 s23, s23, s21
  buffer_store_dwordx4 v[8:11], v12, s[4:7], s22 offen
  s_add_u32 s22, s22, 4096
  buffer_store_dwordx4 v[8:11], v12, s[4:7], s22 offen
  s_add_u32 s22, s22, 4096
  v_mov_b32 v13, 0x80000000
  v_cmp_gt_u32 vcc, 244, v0
  s_nop 1
  v_cndmask_b32 v13, v13, v12, vcc
  buffer_store_dwordx4 v[8:11], v13, s[4:7], s22 offen
  buffer_store_dwordx4 v[8:11], v12, s[4:7], s23 offen
  s_add_u32 s23, s23, 4096
  buffer_store_dwordx4 v[8:11], v12, s[4:7], s23 offen
  s_add_u32 s23, s23, 4096
  buffer_store_dwordx4 v[8:11], v12, s[4:7], s23 offen
  s_add_u32 s23, s23, 4096
  s_cmp_lg_u32 s16, 3
  s_cbranch_scc1 ln1_novote2
  s_load_dwordx2 s[24:25], s[0:1], 88
  s_getreg_b32 s26, hwreg(HW_REG_XCC_ID, 0, 3)
  s_lshr_b32 s22, s2, 4
  s_lshl_b32 s22, s22, 14
  s_and_b32 s23, s2, 15
  s_lshl_b32 s23, s23, 9
  s_add_u32 s22, s22, s23
  s_add_u32 s22, s22, 1572864
  s_add_u32 s22, s22, s21
  v_and_b32 v13, 63, v0
  v_and_b32 v14, 3, v13
  v_lshlrev_b32 v14, 7, v14
  v_lshrrev_b32 v15, 2, v13
  v_lshl_add_u32 v14, v15, 13, v14
  v_mov_b32 v16, 0x80000000
  v_cmp_gt_u32 vcc, 8, v13
  s_nop 1
  v_cndmask_b32 v14, v16, v14, vcc
  buffer_store_dword v8, v14, s[4:7], s22 offen sc1
  v_cmp_eq_u32 vcc, 0, v13
  v_mov_b32 v14, 0
  s_nop 0
  v_cndmask_b32 v14, v16, v14, vcc
  s_mov_b32 s27, 0
  s_mov_b32 s28, 0
  s_waitcnt vmcnt(0) lgkmcnt(0)
  s_add_u32 s23, s22, 0
  s_memtime s[18:19]
  s_waitcnt lgkmcnt(0)
  buffer_load_dword v15, v14, s[4:7], s23 offen sc1
  s_waitcnt vmcnt(0)
  s_memtime s[30:31]
  s_waitcnt lgkmcnt(0)
  s_sub_u32 s29, s30, s18
  s_add_u32 s27, s27, s29
  s_add_u32 s23, s22, 8192
  s_memtime s[18:19]
  s_waitcnt lgkmcnt(0)
  buffer_load_dword v15, v14, s[4:7], s23 offen sc1
  s_waitcnt vmcnt(0)
  s_memtime s[30:31]
  s_waitcnt lgkmcnt(0)
  s_sub_u32 s29, s30, s18
  s_add_u32 s28, s28, s29
  s_add_u32 s23, s22, 128
  s_memtime s[18:19]
  s_waitcnt lgkmcnt(0)
  buffer_load_dword v15, v14, s[4:7], s23 offen sc1
  s_waitcnt vmcnt(0)
  s_memtime s[30:31]
  s_waitcnt lgkmcnt(0)
  s_sub_u32 s29, s30, s18
  s_add_u32 s27, s27, s29
  s_add_u32 s23, s22, 8320
  s_memtime s[18:19]
  s_waitcnt lgkmcnt(0)
  buffer_load_dword v15, v14, s[4:7], s23 offen sc1
  s_waitcnt vmcnt(0)
  s_memtime s[30:31]
  s_waitcnt lgkmcnt(0)
  s_sub_u32 s29, s30, s18
  s_add_u32 s28, s28, s29
  s_cmp_lt_u32 s28, s27
  s_cselect_b32 s27, 1, 0
  s_lshr_b32 s26, s26, 2
  s_xor_b32 s27, s27, s26
  s_lshl_b32 s27, s27, 16
  s_add_u32 s27, s27, 1
  s_mov_b32 s8, s24
  s_mov_b32 s9, s25
  s_mov_b32 s10, 256
  s_mov_b32 s11, 0x20000
  v_mov_b32 v15, s27
  buffer_atomic_add v15, v14, s[8:11], 0 offen sc0
  s_waitcnt vmcnt(0)
  v_readfirstlane_b32 s28, v15
  s_nop 3
  s_add_u32 s28, s28, s27
  s_and_b32 s29, s28, 0xffff
  s_cmp_lg_u32 s29, 128
  s_cbranch_scc1 ln1_novote2
  s_lshr_b32 s28, s28, 16
  s_cmp_gt_u32 s28, 64
  s_cselect_b32 s28, 1, 0
  v_mov_b32 v15, s28
  s_mov_b32 s23, 1548288
  buffer_store_dword v15, v14, s[4:7], s23 offen
ln1_novote2:
ln1_exit1:
  s_endpgm
.globl ln2_kernel
.p2align 8
.type ln2_kernel,@function
ln2_kernel:
  s_cmp_ge_u32 s2, 128
  s_cbranch_scc1 ln2_exit1
  s_load_dwordx2 s[12:13], s[0:1], 96
  s_load_dwordx2 s[14:15], s[0:1], 0
  v_lshrrev_b32 v2, 6, v0
  v_and_b32 v3, 63, v0
  s_nop 0
  v_readfirstlane_b32 s16, v2
  s_waitcnt lgkmcnt(0)
  s_mov_b32 s4, s12
  s_mov_b32 s5, s13
  s_mov_b32 s6, 0x10000000
  s_mov_b32 s7, 0x20000
  s_mov_b32 s8, s12
  s_mov_b32 s9, s13
  s_mov_b32 s10, 0x10000000
  s_mov_b32 s11, 0x20000
  s_mov_b32 s20, 150994944
  v_and_b32 v2, 15, v3
  v_lshrrev_b32 v4, 4, v3
  s_lshl_b32 s17, s2, 4
  v_add_u32 v1, s17, v2
  v_mul_u32_u24 v1, 1280, v1
  v_lshl_add_u32 v1, v4, 4, v1
  s_mul_i32 s17, s16, 320
  s_add_u32 s20, s20, s17
  buffer_load_dwordx4 v[8:11], v1, s[8:11], s20 offen offset:0
  buffer_load_dwordx4 v[12:15], v1, s[8:11], s20 offen offset:64
  buffer_load_dwordx4 v[16:19], v1, s[8:11], s20 offen offset:128
  buffer_load_dwordx4 v[20:23], v1, s[8:11], s20 offen offset:192
  buffer_load_dwordx4 v[24:27], v1, s[8:11], s20 offen offset:256
  v_lshlrev_b32 v5, 2, v2
  s_lshl_b32 s17, s16, 6
  v_add_u32 v1, s17, v5
  s_waitcnt vmcnt(0)
  v_lshlrev_b32 v28, 16, v8
  v_and_b32 v29, 0xffff0000, v8
  v_lshlrev_b32 v30, 16, v9
  v_and_b32 v31, 0xffff0000, v9
  v_lshlrev_b32 v32, 16, v10
  v_and_b32 v33, 0xffff0000, v10
  v_lshlrev_b32 v34, 16, v11
  v_and_b32 v35, 0xffff0000, v11
  v_lshlrev_b32 v36, 16, v12
  v_and_b32 v37, 0xffff0000, v12
  v_lshlrev_b32 v38, 16, v13
  v_and_b32 v39, 0xffff0000, v13
  v_lshlrev_b32 v40, 16, v14
  v_and_b32 v41, 0xffff0000, v14
  v_lshlrev_b32 v42, 16, v15
  v_and_b32 v43, 0xffff0000, v15
  v_lshlrev_b32 v44, 16, v16
  v_and_b32 v45, 0xffff0000, v16
  v_lshlrev_b32 v46, 16, v17
  v_and_b32 v47, 0xffff0000, v17
  v_lshlrev_b32 v48, 16, v18
  v_and_b32 v49, 0xffff0000, v18
  v_lshlrev_b32 v50, 16, v19
  v_and_b32 v51, 0xffff0000, v19
  v_lshlrev_b32 v52, 16, v20
  v_and_b32 v53, 0xffff0000, v20
  v_lshlrev_b32 v54, 16, v21
  v_and_b32 v55, 0xffff0000, v21
  v_lshlrev_b32 v56, 16, v22
  v_and_b32 v57, 0xffff0000, v22
  v_lshlrev_b32 v58, 16, v23
  v_and_b32 v59, 0xffff0000, v23
  v_lshlrev_b32 v60, 16, v24
  v_and_b32 v61, 0xffff0000, v24
  v_lshlrev_b32 v62, 16, v25
  v_and_b32 v63, 0xffff0000, v25
  v_lshlrev_b32 v64, 16, v26
  v_and_b32 v65, 0xffff0000, v26
  v_lshlrev_b32 v66, 16, v27
  v_and_b32 v67, 0xffff0000, v27
  v_pk_add_f32 v[6:7], v[28:29], v[30:31]
  v_pk_add_f32 v[6:7], v[6:7], v[32:33]
  v_pk_add_f32 v[6:7], v[6:7], v[34:35]
  v_pk_add_f32 v[6:7], v[6:7], v[36:37]
  v_pk_add_f32 v[6:7], v[6:7], v[38:39]
  v_pk_add_f32 v[6:7], v[6:7], v[40:41]
  v_pk_add_f32 v[6:7], v[6:7], v[42:43]
  v_pk_add_f32 v[6:7], v[6:7], v[44:45]
  v_pk_add_f32 v[6:7], v[6:7], v[46:47]
  v_pk_add_f32 v[6:7], v[6:7], v[48:49]
  v_pk_add_f32 v[6:7], v[6:7], v[50:51]
  v_pk_add_f32 v[6:7], v[6:7], v[52:53]
  v_pk_add_f32 v[6:7], v[6:7], v[54:55]
  v_pk_add_f32 v[6:7], v[6:7], v[56:57]
  v_pk_add_f32 v[6:7], v[6:7], v[58:59]
  v_pk_add_f32 v[6:7], v[6:7], v[60:61]
  v_pk_add_f32 v[6:7], v[6:7], v[62:63]
  v_pk_add_f32 v[6:7], v[6:7], v[64:65]
  v_pk_add_f32 v[6:7], v[6:7], v[66:67]
  v_add_f32 v4, v6, v7
  v_mov_b32 v2, v4
  s_nop 1
  v_permlane32_swap_b32 v4, v2
  v_add_f32 v4, v4, v2
  v_mov_b32 v2, v4
  s_nop 1
  v_permlane16_swap_b32 v4, v2
  v_add_f32 v4, v4, v2
  ds_write_b32 v1, v4 offset:0
  s_waitcnt lgkmcnt(0)
  s_barrier
  ds_read_b32 v4, v5 offset:0
  ds_read_b32 v2, v5 offset:64
  ds_read_b32 v3, v5 offset:128
  ds_read_b32 v6, v5 offset:192
  s_waitcnt lgkmcnt(0)
  v_add_f32 v4, v4, v2
  v_add_f32 v3, v3, v6
  v_add_f32 v4, v4, v3
  v_mul_f32 v4, 0x3acccccd, v4
  v_sub_f32 v28, v28, v4
  v_sub_f32 v29, v29, v4
  v_sub_f32 v30, v30, v4
  v_sub_f32 v31, v31, v4
  v_sub_f32 v32, v32, v4
  v_sub_f32 v33, v33, v4
  v_sub_f32 v34, v34, v4
  v_sub_f32 v35, v35, v4
  v_sub_f32 v36, v36, v4
  v_sub_f32 v37, v37, v4
  v_sub_f32 v38, v38, v4
  v_sub_f32 v39, v39, v4
  v_sub_f32 v40, v40, v4
  v_sub_f32 v41, v41, v4
  v_sub_f32 v42, v42, v4
  v_sub_f32 v43, v43, v4
  v_sub_f32 v44, v44, v4
  v_sub_f32 v45, v45, v4
  v_sub_f32 v46, v46, v4
  v_sub_f32 v47, v47, v4
  v_sub_f32 v48, v48, v4
  v_sub_f32 v49, v49, v4
  v_sub_f32 v50, v50, v4
  v_sub_f32 v51, v51, v4
  v_sub_f32 v52, v52, v4
  v_sub_f32 v53, v53, v4
  v_sub_f32 v54, v54, v4
  v_sub_f32 v55, v55, v4
  v_sub_f32 v56, v56, v4
  v_sub_f32 v57, v57, v4
  v_sub_f32 v58, v58, v4
  v_sub_f32 v59, v59, v4
  v_sub_f32 v60, v60, v4
  v_sub_f32 v61, v61, v4
  v_sub_f32 v62, v62, v4
  v_sub_f32 v63, v63, v4
  v_sub_f32 v64, v64, v4
  v_sub_f32 v65, v65, v4
  v_sub_f32 v66, v66, v4
  v_sub_f32 v67, v67, v4
  v_mul_f32 v6, v28, v28
  v_mul_f32 v7, v29, v29
  v_fmac_f32 v6, v30, v30
  v_fmac_f32 v7, v31, v31
  v_fmac_f32 v6, v32, v32
  v_fmac_f32 v7, v33, v33
  v_fmac_f32 v6, v34, v34
  v_fmac_f32 v7, v35, v35
  v_fmac_f32 v6, v36, v36
  v_fmac_f32 v7, v37, v37
  v_fmac_f32 v6, v38, v38
  v_fmac_f32 v7, v39, v39
  v_fmac_f32 v6, v40, v40
  v_fmac_f32 v7, v41, v41
  v_fmac_f32 v6, v42, v42
  v_fmac_f32 v7, v43, v43
  v_fmac_f32 v6, v44, v44
  v_fmac_f32 v7, v45, v45
  v_fmac_f32 v6, v46, v46
  v_fmac_f32 v7, v47, v47
  v_fmac_f32 v6, v48, v48
  v_fmac_f32 v7, v49, v49
  v_fmac_f32 v6, v50, v50
  v_fmac_f32 v7, v51, v51
  v_fmac_f32 v6, v52, v52
  v_fmac_f32 v7, v53, v53
  v_fmac_f32 v6, v54, v54
  v_fmac_f32 v7, v55, v55
  v_fmac_f32 v6, v56, v56
  v_fmac_f32 v7, v57, v57
  v_fmac_f32 v6, v58, v58
  v_fmac_f32 v7, v59, v59
  v_fmac_f32 v6, v60, v60
  v_fmac_f32 v7, v61, v61
  v_fmac_f32 v6, v62, v62
  v_fmac_f32 v7, v63, v63
  v_fmac_f32 v6, v64, v64
  v_fmac_f32 v7, v65, v65
  v_fmac_f32 v6, v66, v66
  v_fmac_f32 v7, v67, v67
  v_add_f32 v4, v6, v7
  v_mov_b32 v2, v4
  s_nop 1
  v_permlane32_swap_b32 v4, v2
  v_add_f32 v4, v4, v2
  v_mov_b32 v2, v4
  s_nop 1
  v_permlane16_swap_b32 v4, v2
  v_add_f32 v4, v4, v2
  ds_write_b32 v1, v4 offset:256
  s_waitcnt lgkmcnt(0)
  s_barrier
  ds_read_b32 v4, v5 offset:256
  ds_read_b32 v2, v5 offset:320
  ds_read_b32 v3, v5 offset:384
  ds_read_b32 v6, v5 offset:448
  s_waitcnt lgkmcnt(0)
  v_add_f32 v4, v4, v2
  v_add_f32 v3, v3, v6
  v_add_f32 v4, v4, v3
  v_mov_b32 v2, 0x3727c5ac
  v_fmac_f32 v2, 0x3acccccd, v4
  v_rsq_f32 v4, v2
  s_nop 0
  v_mul_f32 v28, v28, v4
  v_mul_f32 v29, v29, v4
  v_mul_f32 v30, v30, v4
  v_mul_f32 v31, v31, v4
  v_mul_f32 v32, v32, v4
  v_mul_f32 v33, v33, v4
  v_mul_f32 v34, v34, v4
  v_mul_f32 v35, v35, v4
  v_mul_f32 v36, v36, v4
  v_mul_f32 v37, v37, v4
  v_mul_f32 v38, v38, v4
  v_mul_f32 v39, v39, v4
  v_mul_f32 v40, v40, v4
  v_mul_f32 v41, v41, v4
  v_mul_f32 v42, v42, v4
  v_mul_f32 v43, v43, v4
  v_mul_f32 v44, v44, v4
  v_mul_f32 v45, v45, v4
  v_mul_f32 v46, v46, v4
  v_mul_f32 v47, v47, v4
  v_mul_f32 v48, v48, v4
  v_mul_f32 v49, v49, v4
  v_mul_f32 v50, v50, v4
  v_mul_f32 v51, v51, v4
  v_mul_f32 v52, v52, v4
  v_mul_f32 v53, v53, v4
  v_mul_f32 v54, v54, v4
  v_mul_f32 v55, v55, v4
  v_mul_f32 v56, v56, v4
  v_mul_f32 v57, v57, v4
  v_mul_f32 v58, v58, v4
  v_mul_f32 v59, v59, v4
  v_mul_f32 v60, v60, v4
  v_mul_f32 v61, v61, v4
  v_mul_f32 v62, v62, v4
  v_mul_f32 v63, v63, v4
  v_mul_f32 v64, v64, v4
  v_mul_f32 v65, v65, v4
  v_mul_f32 v66, v66, v4
  v_mul_f32 v67, v67, v4
  v_cvt_pk_bf16_f32 v8, v28, v29
  v_cvt_pk_bf16_f32 v9, v30, v31
  v_cvt_pk_bf16_f32 v10, v32, v33
  v_cvt_pk_bf16_f32 v11, v34, v35
  v_cvt_pk_bf16_f32 v12, v36, v37
  v_cvt_pk_bf16_f32 v13, v38, v39
  v_cvt_pk_bf16_f32 v14, v40, v41
  v_cvt_pk_bf16_f32 v15, v42, v43
  v_cvt_pk_bf16_f32 v16, v44, v45
  v_cvt_pk_bf16_f32 v17, v46, v47
  v_cvt_pk_bf16_f32 v18, v48, v49
  v_cvt_pk_bf16_f32 v19, v50, v51
  v_cvt_pk_bf16_f32 v20, v52, v53
  v_cvt_pk_bf16_f32 v21, v54, v55
  v_cvt_pk_bf16_f32 v22, v56, v57
  v_cvt_pk_bf16_f32 v23, v58, v59
  v_cvt_pk_bf16_f32 v24, v60, v61
  v_cvt_pk_bf16_f32 v25, v62, v63
  v_cvt_pk_bf16_f32 v26, v64, v65
  v_cvt_pk_bf16_f32 v27, v66, v67
  v_and_b32 v3, 63, v0
  v_lshlrev_b32 v1, 4, v3
  s_mul_i32 s17, s2, 20480
  s_mul_i32 s18, s16, 5120
  s_add_u32 s17, s17, s18
  s_add_u32 s17, s17, 153616384
  buffer_store_dwordx4 v[8:11], v1, s[4:7], s17 offen offset:0
  buffer_store_dwordx4 v[12:15], v1, s[4:7], s17 offen offset:1024
  buffer_store_dwordx4 v[16:19], v1, s[4:7], s17 offen offset:2048
  buffer_store_dwordx4 v[20:23], v1, s[4:7], s17 offen offset:3072
  s_add_u32 s17, s17, 4096
  buffer_store_dwordx4 v[24:27], v1, s[4:7], s17 offen offset:0
  s_sub_u32 s21, 0, s12
  s_and_b32 s21, s21, 0x1fffff
  s_add_u32 s21, s21, 2097152
  v_mov_b32 v8, -1
  v_mov_b32 v9, -1
  v_mov_b32 v10, -1
  v_mov_b32 v11, -1
  v_lshlrev_b32 v12, 4, v0
  s_mul_i32 s22, s2, 12096
  s_add_u32 s22, s22, 0
  s_mul_i32 s23, s2, 12288
  s_add_u32 s23, s23, s21
  buffer_store_dwordx4 v[8:11], v12, s[4:7], s22 offen
  s_add_u32 s22, s22, 4096
  buffer_store_dwordx4 v[8:11], v12, s[4:7], s22 offen
  s_add_u32 s22, s22, 4096
  v_mov_b32 v13, 0x80000000
  v_cmp_gt_u32 vcc, 244, v0
  s_nop 1
  v_cndmask_b32 v13, v13, v12, vcc
  buffer_store_dwordx4 v[8:11], v13, s[4:7], s22 offen
  buffer_store_dwordx4 v[8:11], v12, s[4:7], s23 offen
  s_add_u32 s23, s23, 4096
  buffer_store_dwordx4 v[8:11], v12, s[4:7], s23 offen
  s_add_u32 s23, s23, 4096
  buffer_store_dwordx4 v[8:11], v12, s[4:7], s23 offen
  s_add_u32 s23, s23, 4096
  s_cmp_lg_u32 s16, 3
  s_cbranch_scc1 ln2_novote2
  s_load_dwordx2 s[24:25], s[0:1], 88
  s_getreg_b32 s26, hwreg(HW_REG_XCC_ID, 0, 3)
  s_lshr_b32 s22, s2, 4
  s_lshl_b32 s22, s22, 14
  s_and_b32 s23, s2, 15
  s_lshl_b32 s23, s23, 9
  s_add_u32 s22, s22, s23
  s_add_u32 s22, s22, 1572864
  s_add_u32 s22, s22, s21
  v_and_b32 v13, 63, v0
  v_and_b32 v14, 3, v13
  v_lshlrev_b32 v14, 7, v14
  v_lshrrev_b32 v15, 2, v13
  v_lshl_add_u32 v14, v15, 13, v14
  v_mov_b32 v16, 0x80000000
  v_cmp_gt_u32 vcc, 8, v13
  s_nop 1
  v_cndmask_b32 v14, v16, v14, vcc
  buffer_store_dword v8, v14, s[4:7], s22 offen sc1
  v_cmp_eq_u32 vcc, 0, v13
  v_mov_b32 v14, 0
  s_nop 0
  v_cndmask_b32 v14, v16, v14, vcc
  s_mov_b32 s27, 0
  s_mov_b32 s28, 0
  s_waitcnt vmcnt(0) lgkmcnt(0)
  s_add_u32 s23, s22, 0
  s_memtime s[18:19]
  s_waitcnt lgkmcnt(0)
  buffer_load_dword v15, v14, s[4:7], s23 offen sc1
  s_waitcnt vmcnt(0)
  s_memtime s[30:31]
  s_waitcnt lgkmcnt(0)
  s_sub_u32 s29, s30, s18
  s_add_u32 s27, s27, s29
  s_add_u32 s23, s22, 8192
  s_memtime s[18:19]
  s_waitcnt lgkmcnt(0)
  buffer_load_dword v15, v14, s[4:7], s23 offen sc1
  s_waitcnt vmcnt(0)
  s_memtime s[30:31]
  s_waitcnt lgkmcnt(0)
  s_sub_u32 s29, s30, s18
  s_add_u32 s28, s28, s29
  s_add_u32 s23, s22, 128
  s_memtime s[18:19]
  s_waitcnt lgkmcnt(0)
  buffer_load_dword v15, v14, s[4:7], s23 offen sc1
  s_waitcnt vmcnt(0)
  s_memtime s[30:31]
  s_waitcnt lgkmcnt(0)
  s_sub_u32 s29, s30, s18
  s_add_u32 s27, s27, s29
  s_add_u32 s23, s22, 8320
  s_memtime s[18:19]
  s_waitcnt lgkmcnt(0)
  buffer_load_dword v15, v14, s[4:7], s23 offen sc1
  s_waitcnt vmcnt(0)
  s_memtime s[30:31]
  s_waitcnt lgkmcnt(0)
  s_sub_u32 s29, s30, s18
  s_add_u32 s28, s28, s29
  s_cmp_lt_u32 s28, s27
  s_cselect_b32 s27, 1, 0
  s_lshr_b32 s26, s26, 2
  s_xor_b32 s27, s27, s26
  s_lshl_b32 s27, s27, 16
  s_add_u32 s27, s27, 1
  s_mov_b32 s8, s24
  s_mov_b32 s9, s25
  s_mov_b32 s10, 256
  s_mov_b32 s11, 0x20000
  v_mov_b32 v15, s27
  buffer_atomic_add v15, v14, s[8:11], 0 offen sc0
  s_waitcnt vmcnt(0)
  v_readfirstlane_b32 s28, v15
  s_nop 3
  s_add_u32 s28, s28, s27
  s_and_b32 s29, s28, 0xffff
  s_cmp_lg_u32 s29, 128
  s_cbranch_scc1 ln2_novote2
  s_lshr_b32 s28, s28, 16
  s_cmp_gt_u32 s28, 64
  s_cselect_b32 s28, 1, 0
  v_mov_b32 v15, s28
  s_mov_b32 s23, 1548288
  buffer_store_dword v15, v14, s[4:7], s23 offen
ln2_novote2:
ln2_exit1:
  s_endpgm
.globl reca_kernel
.p2align 8
.type reca_kernel,@function
reca_kernel:
  s_cmp_ge_u32 s2, 256
  s_cbranch_scc1 reca_exitb3
  s_load_dwordx2 s[48:49], s[0:1], 96
  s_load_dwordx2 s[50:51], s[0:1], 88
  s_load_dwordx2 s[52:53], s[0:1], 8
  s_getreg_b32 s42, hwreg(HW_REG_XCC_ID, 0, 3)
  v_lshrrev_b32 v28, 6, v0
  v_and_b32 v29, 63, v0
  s_and_b32 s13, s2, 7
  v_readfirstlane_b32 s12, v28
  v_lshlrev_b32 v1, 4, v29
  s_lshr_b32 s14, s2, 3
  s_mov_b32 s18, 0x100000
  s_waitcnt lgkmcnt(0)
  s_mov_b32 s34, 1548288
  s_load_dword s57, s[48:49], s34
  s_mov_b32 s4, s48
  s_mov_b32 s5, s49
  s_mov_b32 s6, 0x10000000
  s_mov_b32 s7, 0x20000
  s_mov_b32 s8, s50
  s_mov_b32 s9, s51
  s_mov_b32 s10, 256
  s_mov_b32 s11, 0x20000
  v_add_u32 v2, 0x1000, v1
  v_add_u32 v3, 0x2000, v1
  v_mov_b32 v31, 0x80000000
  s_lshl_b32 s34, s42, 3
  s_lshl_b64 s[36:37], 1, s34
  s_lshl_b32 s34, s13, 3
  v_cmp_eq_u32 vcc, 0, v0
  v_mov_b32 v30, s34
  s_nop 0
  v_cndmask_b32 v30, v31, v30, vcc
  v_mov_b32 v44, s36
  v_mov_b32 v45, s37
  buffer_atomic_add_x2 v[44:45], v30, s[8:11], 0 offen
  s_sub_u32 s56, 0, s48
  s_and_b32 s56, s56, 0x1fffff
  s_add_u32 s56, s56, 2097152
  s_waitcnt lgkmcnt(0)
  s_and_b32 s57, s57, 1
  s_lshr_b32 s34, s42, 2
  s_xor_b32 s57, s57, s34
  s_cmp_ge_u32 s14, 24
  s_cbranch_scc1 reca_proj2
  s_mul_i32 s34, s14, 43
  s_lshr_b32 s34, s34, 8
  s_mul_i32 s35, s34, 6
  s_sub_u32 s16, s14, s35
  s_lshl_b32 s15, s13, 2
  s_add_u32 s15, s15, s34
  s_lshr_b32 s19, s12, 1
  s_and_b32 s37, s12, 1
  s_mul_i32 s34, s15, 12
  s_lshl_b32 s35, s16, 1
  s_add_u32 s34, s34, s35
  s_add_u32 s34, s34, s37
  s_mul_i32 s34, s34, 20480
  s_mov_b32 s35, 14155776
  s_cmp_eq_u32 s19, 0
  s_cselect_b32 s35, 6291456, s35
  s_add_u32 s35, s35, s34
  s_mul_i32 s36, s19, 10240
  s_add_u32 s20, s35, s36
  s_sub_u32 s36, 10240, s36
  s_add_u32 s21, s35, s36
  s_add_u32 s22, s34, 22020096
  s_mul_i32 s36, s19, 10240
  s_add_u32 s22, s22, s36
  buffer_load_dwordx4 a[0:3], v1, s[4:7], s20 offen offset:0
  buffer_load_dwordx4 a[4:7], v1, s[4:7], s20 offen offset:1024
  buffer_load_dwordx4 a[8:11], v1, s[4:7], s20 offen offset:2048
  buffer_load_dwordx4 a[12:15], v1, s[4:7], s20 offen offset:3072
  buffer_load_dwordx4 a[16:19], v2, s[4:7], s20 offen offset:0
  buffer_load_dwordx4 a[20:23], v2, s[4:7], s20 offen offset:1024
  buffer_load_dwordx4 a[24:27], v2, s[4:7], s20 offen offset:2048
  buffer_load_dwordx4 a[28:31], v2, s[4:7], s20 offen offset:3072
  buffer_load_dwordx4 a[32:35], v3, s[4:7], s20 offen offset:0
  buffer_load_dwordx4 a[36:39], v3, s[4:7], s20 offen offset:1024
  buffer_load_dwordx4 a[40:43], v1, s[4:7], s21 offen offset:0
  buffer_load_dwordx4 a[44:47], v1, s[4:7], s21 offen offset:1024
  buffer_load_dwordx4 a[48:51], v1, s[4:7], s21 offen offset:2048
  buffer_load_dwordx4 a[52:55], v1, s[4:7], s21 offen offset:3072
  buffer_load_dwordx4 a[56:59], v2, s[4:7], s21 offen offset:0
  buffer_load_dwordx4 a[60:63], v2, s[4:7], s21 offen offset:1024
  buffer_load_dwordx4 a[64:67], v2, s[4:7], s21 offen offset:2048
  buffer_load_dwordx4 a[68:71], v2, s[4:7], s21 offen offset:3072
  buffer_load_dwordx4 a[72:75], v3, s[4:7], s21 offen offset:0
  buffer_load_dwordx4 a[76:79], v3, s[4:7], s21 offen offset:1024
  buffer_load_dwordx4 a[80:83], v1, s[4:7], s22 offen offset:0
  buffer_load_dwordx4 a[84:87], v1, s[4:7], s22 offen offset:1024
  buffer_load_dwordx4 a[88:91], v1, s[4:7], s22 offen offset:2048
  buffer_load_dwordx4 a[92:95], v1, s[4:7], s22 offen offset:3072
  buffer_load_dwordx4 a[96:99], v2, s[4:7], s22 offen offset:0
  buffer_load_dwordx4 a[100:103], v2, s[4:7], s22 offen offset:1024
  buffer_load_dwordx4 a[104:107], v2, s[4:7], s22 offen offset:2048
  buffer_load_dwordx4 a[108:111], v2, s[4:7], s22 offen offset:3072
  buffer_load_dwordx4 a[112:115], v3, s[4:7], s22 offen offset:0
  buffer_load_dwordx4 a[116:119], v3, s[4:7], s22 offen offset:1024
  s_cmp_ge_u32 s14, 20
  s_cbranch_scc1 reca_now24
  s_cmp_ge_u32 s12, 2
  s_cbranch_scc1 reca_now24
  s_lshl_b32 s34, s14, 1
  s_add_u32 s34, s34, s12
  s_mul_i32 s34, s34, 192
  s_mul_i32 s35, s13, 24
  s_add_u32 s34, s34, s35
  s_lshl_b32 s34, s34, 10
  s_add_u32 s34, s34, 29884416
  buffer_load_dwordx4 a[120:123], v1, s[4:7], s34 offen offset:0
  buffer_load_dwordx4 a[124:127], v1, s[4:7], s34 offen offset:1024
  buffer_load_dwordx4 a[128:131], v1, s[4:7], s34 offen offset:2048
  buffer_load_dwordx4 a[132:135], v1, s[4:7], s34 offen offset:3072
  buffer_load_dwordx4 a[136:139], v2, s[4:7], s34 offen offset:0
  buffer_load_dwordx4 a[140:143], v2, s[4:7], s34 offen offset:1024
  buffer_load_dwordx4 a[144:147], v2, s[4:7], s34 offen offset:2048
  buffer_load_dwordx4 a[148:151], v2, s[4:7], s34 offen offset:3072
  buffer_load_dwordx4 a[152:155], v3, s[4:7], s34 offen offset:0
  buffer_load_dwordx4 a[156:159], v3, s[4:7], s34 offen offset:1024
  buffer_load_dwordx4 a[160:163], v3, s[4:7], s34 offen offset:2048
  buffer_load_dwordx4 a[164:167], v3, s[4:7], s34 offen offset:3072
  s_add_u32 s34, s34, 12288
  buffer_load_dwordx4 a[168:171], v1, s[4:7], s34 offen offset:0
  buffer_load_dwordx4 a[172:175], v1, s[4:7], s34 offen offset:1024
  buffer_load_dwordx4 a[176:179], v1, s[4:7], s34 offen offset:2048
  buffer_load_dwordx4 a[180:183], v1, s[4:7], s34 offen offset:3072
  buffer_load_dwordx4 a[184:187], v2, s[4:7], s34 offen offset:0
  buffer_load_dwordx4 a[188:191], v2, s[4:7], s34 offen offset:1024
  buffer_load_dwordx4 a[192:195], v2, s[4:7], s34 offen offset:2048
  buffer_load_dwordx4 a[196:199], v2, s[4:7], s34 offen offset:3072
  buffer_load_dwordx4 a[200:203], v3, s[4:7], s34 offen offset:0
  buffer_load_dwordx4 a[204:207], v3, s[4:7], s34 offen offset:1024
  buffer_load_dwordx4 a[208:211], v3, s[4:7], s34 offen offset:2048
  buffer_load_dwordx4 a[212:215], v3, s[4:7], s34 offen offset:3072
reca_now24:
  v_and_b32 v29, 63, v0
  v_and_b32 v28, 15, v29
  v_lshrrev_b32 v30, 4, v29
  v_mov_b32 v32, -1
  v_mov_b32 v33, -1
  v_mov_b32 v34, -1
  v_mov_b32 v35, -1
  s_mul_i32 s34, s12, 2560
  v_add_u32 v4, s34, v1
  v_and_b32 v44, 31, v29
  v_lshlrev_b32 v44, 4, v44
  s_add_u32 s34, s34, 2048
  v_add_u32 v5, s34, v44
  v_and_b32 v44, 7, v29
  v_lshlrev_b32 v44, 4, v44
  v_lshl_add_u32 v44, v30, 7, v44
  s_mul_i32 s34, s19, 5120
  v_add_u32 v6, s34, v44
  s_sub_u32 s34, 5120, s34
  v_add_u32 v7, s34, v44
  v_lshrrev_b32 v45, 3, v28
  v_lshl_add_u32 v12, v45, 9, v44
  v_add_u32 v13, 0x1000, v12
  v_add_u32 v14, 0x2000, v12
  v_cmp_gt_u32 s[54:55], 8, v28
  s_lshl_b32 s34, s16, 10
  s_lshl_b32 s35, s19, 7
  s_add_u32 s34, s34, s35
  s_and_b32 s35, s12, 1
  s_lshl_b32 s36, s35, 3
  s_add_u32 s34, s34, s36
  v_lshlrev_b32 v44, 4, v28
  v_lshl_add_u32 v45, v30, 8, v44
  v_add_u32 v45, s34, v45
  v_cndmask_b32 v8, v31, v45, s[54:55]
  v_lshl_add_u32 v44, v30, 7, v44
  v_add_u32 v45, s36, v44
  v_cndmask_b32 v9, v31, v45, s[54:55]
  s_lshl_b32 s34, s14, 9
  v_add_u32 v45, s34, v44
  v_cndmask_b32 v11, v31, v45, s[54:55]
  s_mul_i32 s34, s13, 49152
  s_lshr_b32 s35, s14, 3
  s_lshl_b32 s35, s35, 14
  s_add_u32 s34, s34, s35
  s_and_b32 s35, s14, 7
  s_lshl_b32 s35, s35, 10
  s_add_u32 s34, s34, s35
  s_lshl_b32 s35, s12, 9
  s_add_u32 s34, s34, s35
  v_add_u32 v45, s34, v44
  v_cndmask_b32 v15, v31, v45, s[54:55]
  s_cmp_lt_u32 s14, 20
  s_cselect_b32 s34, 0, 0x80000000
  v_or_b32 v15, s34, v15
  v_add_u32 v232, 0x2000, v15
  v_lshlrev_b32 v45, 3, v29
  v_cmp_gt_u32 vcc, 32, v29
  s_nop 1
  v_cndmask_b32 v10, v31, v45, vcc
  s_sub_u32 s35, s14, 4
  s_cmp_lt_u32 s14, 20
  s_cselect_b32 s34, s14, s35
  s_lshr_b32 s35, s34, 3
  s_lshl_b32 s35, s35, 14
  s_and_b32 s34, s34, 7
  s_lshl_b32 s34, s34, 10
  s_add_u32 s34, s34, s35
  s_lshl_b32 s35, s57, 13
  s_add_u32 s34, s34, s35
  v_add_u32 v20, s34, v1
  v_add_u32 v21, 49152, v20
  v_add_u32 v22, 98304, v20
  v_add_u32 v23, 147456, v20
  v_add_u32 v24, 196608, v20
  v_add_u32 v25, 245760, v20
  v_add_u32 v26, 294912, v20
  v_add_u32 v27, 344064, v20
  v_lshrrev_b32 v44, 3, v29
  v_and_b32 v44, 3, v44
  v_lshlrev_b32 v44, 7, v44
  v_and_b32 v45, 7, v29
  v_lshl_add_u32 v44, v45, 4, v44
  v_lshrrev_b32 v45, 5, v29
  v_lshl_add_u32 v44, v45, 3, v44
  s_lshl_b32 s34, s14, 9
  s_cmp_lt_u32 s14, 20
  s_cselect_b32 s34, s34, 0x80000000
  v_add_u32 v16, s34, v44
  v_cmp_eq_u32 vcc, 0, v29
  v_mov_b32 v45, 0
  s_nop 0
  v_cndmask_b32 v19, v31, v45, vcc
  s_lshl_b32 s34, s15, 8
  s_add_u32 s34, s34, 1540096
  v_and_b32 v45, 1, v29
  v_lshlrev_b32 v45, 7, v45
  v_add_u32 v233, s34, v45
  s_lshl_b32 s34, s12, 10
  s_add_u32 s34, s34, 10240
  v_add_u32 v17, s34, v1
  v_mov_b32 v36, 0x3f803f80
  v_mov_b32 v37, 0x3f803f80
  v_mov_b32 v38, 0x3f803f80
  v_mov_b32 v39, 0x3f803f80
  v_mov_b32 v44, 0xf149f2ca
  v_cmp_gt_u32 vcc, 2, v30
  s_nop 1
  v_cndmask_b32 v40, 0, v44, vcc
  v_mov_b32 v41, v40
  v_mov_b32 v42, v40
  v_mov_b32 v43, v40
  s_mov_b32 s41, 0x3dd53b95
  s_mul_i32 s38, s13, 40960
  s_add_u32 s38, s38, 0
  s_mul_i32 s39, s15, 24576
  s_add_u32 s39, s39, 327680
  s_mul_i32 s40, s13, 49152
  s_add_u32 s40, s40, 1114112
  s_mov_b32 s60, s52
  s_mov_b32 s61, s53
  s_mov_b32 s62, 10240
  s_mov_b32 s63, 0x20000
  v_and_b32 v29, 63, v0
  v_and_b32 v44, 7, v29
  v_mul_u32_u24 v44, 1280, v44
  v_lshrrev_b32 v45, 3, v29
  v_and_b32 v45, 3, v45
  v_lshl_add_u32 v44, v45, 4, v44
  s_mul_i32 s34, s12, 320
  v_add_u32 v44, s34, v44
  v_add_u32 v46, 256, v44
  v_lshrrev_b32 v45, 5, v29
  v_lshl_add_u32 v44, v45, 6, v44
  buffer_load_dwordx4 v[128:131], v44, s[60:63], 0 offen
  buffer_load_dwordx4 v[132:135], v44, s[60:63], 0 offen offset:128
  buffer_load_dwordx4 v[136:139], v46, s[60:63], 0 offen
  s_lshl_b32 s34, s13, 3
  v_mov_b32 v30, s34
reca_cens5:
  buffer_load_dwordx2 v[28:29], v30, s[8:11], 0 offen sc1
  s_waitcnt vmcnt(0)
  v_readfirstlane_b32 s35, v28
  v_readfirstlane_b32 s36, v29
  v_sad_u8 v28, v28, 0, 0
  v_sad_u8 v28, v29, 0, v28
  s_nop 0
  v_readfirstlane_b32 s34, v28
  s_nop 3
  s_cmp_ge_u32 s34, 32
  s_cbranch_scc1 reca_censok6
  s_sleep 8
  s_sub_u32 s18, s18, 1
  s_cbranch_scc0 reca_cens5
  s_mov_b32 s18, 0
reca_censok6:
  s_lshl_b32 s34, s42, 3
  s_mov_b32 s37, s36
  s_mov_b32 s36, s35
  s_lshr_b64 s[36:37], s[36:37], s34
  s_and_b32 s36, s36, 0xff
  s_cmp_eq_u32 s36, 32
  s_cselect_b32 s43, 0, 1
  s_mov_b32 s17, 0
  s_cmp_lg_u32 s12, 2
  s_cbranch_scc1 reca_nopf07
  s_add_u32 s37, s17, 1
reca_pf8:
  buffer_load_dword v28, v233, s[4:7], 0 offen sc1
  s_waitcnt vmcnt(0)
  v_cmp_gt_i32 vcc, s37, v28
  s_cbranch_vccz reca_pfok9
  s_sleep 1
  s_sub_u32 s18, s18, 1
  s_cbranch_scc0 reca_pf8
  s_mov_b32 s18, 0
reca_pfok9:
  s_lshl_b32 s34, s15, 6
  s_add_u32 s34, s34, s17
  s_mul_i32 s34, s34, 12288
  s_add_u32 s32, s34, 37748736
  s_lshl_b32 s35, s16, 11
  s_add_u32 s34, s34, s35
  s_add_u32 s33, s34, 62914560
  s_and_b32 s35, s17, 1
  s_mul_i32 s35, s35, 14336
  s_add_u32 s35, s35, 16384
  s_add_u32 m0, s35, 0
  s_nop 0
  buffer_load_dwordx4 v1, s[4:7], s32 offen offset:0 sc1 lds
  buffer_load_dwordx4 v1, s[4:7], s32 offen offset:1024 sc1 lds
  buffer_load_dwordx4 v1, s[4:7], s32 offen offset:2048 sc1 lds
  buffer_load_dwordx4 v1, s[4:7], s32 offen offset:3072 sc1 lds
  s_add_u32 s32, s32, 4096
  s_add_u32 m0, s35, 4096
  s_nop 0
  buffer_load_dwordx4 v1, s[4:7], s32 offen offset:0 sc1 lds
  buffer_load_dwordx4 v1, s[4:7], s32 offen offset:1024 sc1 lds
  buffer_load_dwordx4 v1, s[4:7], s32 offen offset:2048 sc1 lds
  buffer_load_dwordx4 v1, s[4:7], s32 offen offset:3072 sc1 lds
  s_add_u32 s32, s32, 4096
  s_add_u32 m0, s35, 8192
  s_nop 0
  buffer_load_dwordx4 v1, s[4:7], s32 offen offset:0 sc1 lds
  buffer_load_dwordx4 v1, s[4:7], s32 offen offset:1024 sc1 lds
  buffer_load_dwordx4 v1, s[4:7], s32 offen offset:2048 sc1 lds
  buffer_load_dwordx4 v1, s[4:7], s32 offen offset:3072 sc1 lds
  s_add_u32 m0, s35, 12288
  s_nop 0
  buffer_load_dwordx4 v1, s[4:7], s33 offen offset:0 sc1 lds
  buffer_load_dwordx4 v1, s[4:7], s33 offen offset:1024 sc1 lds
  s_waitcnt vmcnt(0)
reca_nopf07:
  s_cmp_lg_u32 s43, 0
  s_cbranch_scc1 reca_slow10
  s_branch reca_gotmem12
reca_step11:
  s_and_b32 s34, s17, 3
  s_mul_i32 s20, s34, 10240
  s_add_u32 s20, s20, s38
  s_sleep 2
  buffer_load_dwordx4 v[128:131], v4, s[4:7], s20 offen sc1
  buffer_load_dwordx4 v[132:135], v4, s[4:7], s20 offen offset:1024 sc1
  buffer_load_dwordx4 v[136:139], v5, s[4:7], s20 offen sc1
  s_waitcnt vmcnt(2)
  v_max_u32 v29, v128, v130
  v_cmp_eq_u32 vcc, -1, v29
  s_cbranch_vccnz reca_retry14
reca_resume15:
  s_waitcnt vmcnt(1)
  v_max_u32 v29, v132, v134
  v_cmp_eq_u32 vcc, -1, v29
  ds_write_b128 v4, v[128:131]
  s_cbranch_vccnz reca_retry16
reca_resume17:
  s_waitcnt vmcnt(0)
  v_max_u32 v29, v136, v138
  v_cmp_eq_u32 vcc, -1, v29
  ds_write_b128 v4, v[132:135] offset:1024
  s_cbranch_vccnz reca_retry18
reca_resume19:
  ds_write_b128 v5, v[136:139]
  s_branch reca_gotmem213
reca_gotmem12:
  ds_write_b128 v4, v[128:131]
  ds_write_b128 v4, v[132:135] offset:1024
  ds_write_b128 v5, v[136:139]
reca_gotmem213:
  s_and_b32 s34, s17, 3
  s_mul_i32 s21, s34, 6144
  s_add_u32 s21, s21, s39
  s_mul_i32 s22, s34, 12288
  s_add_u32 s22, s22, s40
  s_mul_i32 s25, s34, 393216
  s_add_u32 s25, s25, s56
  s_add_u32 s35, s17, 1
  s_and_b32 s35, s35, 3
  s_mul_i32 s24, s35, 10240
  s_add_u32 s24, s24, s38
  s_waitcnt lgkmcnt(0)
  s_barrier
  ds_read_b128 v[128:131], v6 offset:0
  ds_read_b128 v[132:135], v6 offset:512
  ds_read_b128 v[136:139], v6 offset:1024
  ds_read_b128 v[140:143], v6 offset:1536
  ds_read_b128 v[144:147], v6 offset:2048
  ds_read_b128 v[148:151], v6 offset:2560
  ds_read_b128 v[152:155], v6 offset:3072
  ds_read_b128 v[156:159], v6 offset:3584
  ds_read_b128 v[160:163], v6 offset:4096
  ds_read_b128 v[164:167], v6 offset:4608
  ds_read_b128 v[168:171], v7 offset:0
  ds_read_b128 v[172:175], v7 offset:512
  ds_read_b128 v[176:179], v7 offset:1024
  s_waitcnt lgkmcnt(12)
  v_mfma_f32_16x16x32_bf16 v[44:47], a[0:3], v[128:131], 0
  ds_read_b128 v[180:183], v7 offset:1536
  s_waitcnt lgkmcnt(12)
  v_mfma_f32_16x16x32_bf16 v[44:47], a[4:7], v[132:135], v[44:47]
  ds_read_b128 v[184:187], v7 offset:2048
  s_waitcnt lgkmcnt(12)
  v_mfma_f32_16x16x32_bf16 v[44:47], a[8:11], v[136:139], v[44:47]
  ds_read_b128 v[188:191], v7 offset:2560
  s_waitcnt lgkmcnt(12)
  v_mfma_f32_16x16x32_bf16 v[44:47], a[12:15], v[140:143], v[44:47]
  ds_read_b128 v[192:195], v7 offset:3072
  s_waitcnt lgkmcnt(12)
  v_mfma_f32_16x16x32_bf16 v[44:47], a[16:19], v[144:147], v[44:47]
  ds_read_b128 v[196:199], v7 offset:3584
  s_waitcnt lgkmcnt(12)
  v_mfma_f32_16x16x32_bf16 v[44:47], a[20:23], v[148:151], v[44:47]
  ds_read_b128 v[200:203], v7 offset:4096
  s_waitcnt lgkmcnt(12)
  v_mfma_f32_16x16x32_bf16 v[44:47], a[24:27], v[152:155], v[44:47]
  ds_read_b128 v[204:207], v7 offset:4608
  s_waitcnt lgkmcnt(12)
  v_mfma_f32_16x16x32_bf16 v[44:47], a[28:31], v[156:159], v[44:47]
  s_waitcnt lgkmcnt(11)
  v_mfma_f32_16x16x32_bf16 v[44:47], a[32:35], v[160:163], v[44:47]
  s_waitcnt lgkmcnt(10)
  v_mfma_f32_16x16x32_bf16 v[44:47], a[36:39], v[164:167], v[44:47]
  s_waitcnt lgkmcnt(9)
  v_mfma_f32_16x16x32_bf16 v[44:47], a[40:43], v[168:171], v[44:47]
  s_waitcnt lgkmcnt(8)
  v_mfma_f32_16x16x32_bf16 v[44:47], a[44:47], v[172:175], v[44:47]
  s_waitcnt lgkmcnt(7)
  v_mfma_f32_16x16x32_bf16 v[44:47], a[48:51], v[176:179], v[44:47]
  s_waitcnt lgkmcnt(6)
  v_mfma_f32_16x16x32_bf16 v[44:47], a[52:55], v[180:183], v[44:47]
  s_waitcnt lgkmcnt(5)
  v_mfma_f32_16x16x32_bf16 v[44:47], a[56:59], v[184:187], v[44:47]
  s_waitcnt lgkmcnt(4)
  v_mfma_f32_16x16x32_bf16 v[44:47], a[60:63], v[188:191], v[44:47]
  s_waitcnt lgkmcnt(3)
  v_mfma_f32_16x16x32_bf16 v[44:47], a[64:67], v[192:195], v[44:47]
  s_waitcnt lgkmcnt(2)
  v_mfma_f32_16x16x32_bf16 v[44:47], a[68:71], v[196:199], v[44:47]
  s_waitcnt lgkmcnt(1)
  v_mfma_f32_16x16x32_bf16 v[44:47], a[72:75], v[200:203], v[44:47]
  s_waitcnt lgkmcnt(0)
  v_mfma_f32_16x16x32_bf16 v[44:47], a[76:79], v[204:207], v[44:47]
  v_mfma_f32_16x16x32_bf16 v[48:51], v[128:131], a[80:83], 0
  s_lshl_b32 s34, s17, 5
  s_add_u32 s34, s34, s15
  s_mul_i32 s34, s34, 3072
  s_lshl_b32 s35, s16, 9
  s_add_u32 s34, s34, s35
  s_add_u32 s30, s34, 113246208
  s_add_u32 s31, s34, 119537664
  v_cvt_pk_bf16_f32 v52, v44, v45
  v_cvt_pk_bf16_f32 v53, v46, v47
  buffer_store_dwordx2 v[52:53], v8, s[4:7], s21 offen
  v_mfma_f32_16x16x32_bf16 v[48:51], v[132:135], a[84:87], v[48:51]
  v_mfma_f32_16x16x32_bf16 v[48:51], v[136:139], a[88:91], v[48:51]
  v_mfma_f32_16x16x32_bf16 v[48:51], v[140:143], a[92:95], v[48:51]
  v_mfma_f32_16x16x32_bf16 v[48:51], v[144:147], a[96:99], v[48:51]
  v_mfma_f32_16x16x32_bf16 v[48:51], v[148:151], a[100:103], v[48:51]
  v_mfma_f32_16x16x32_bf16 v[48:51], v[152:155], a[104:107], v[48:51]
  v_mfma_f32_16x16x32_bf16 v[48:51], v[156:159], a[108:111], v[48:51]
  v_mfma_f32_16x16x32_bf16 v[48:51], v[160:163], a[112:115], v[48:51]
  v_mfma_f32_16x16x32_bf16 v[48:51], v[164:167], a[116:119], v[48:51]
  s_cmp_eq_u32 s12, 3
  s_cbranch_scc1 reca_spre22
  s_nop 5
  ds_write_b128 v17, v[48:51]
  s_cmp_lg_u32 s17, 63
  s_cbranch_scc1 reca_nokm23
  s_cmp_lg_u32 s12, 2
  s_cbranch_scc1 reca_nokm23
  buffer_store_dwordx2 v[52:53], v9, s[4:7], s30 offen
reca_nokm23:
  s_waitcnt lgkmcnt(0)
  s_branch reca_b221
reca_spre22:
  s_sleep 1
  buffer_load_dwordx4 v[208:211], v1, s[4:7], s21 offen offset:0 sc1
  buffer_load_dwordx4 v[212:215], v1, s[4:7], s21 offen offset:1024 sc1
  buffer_load_dwordx4 v[216:219], v1, s[4:7], s21 offen offset:2048 sc1
  buffer_load_dwordx4 v[220:223], v1, s[4:7], s21 offen offset:3072 sc1
  buffer_load_dwordx4 v[224:227], v2, s[4:7], s21 offen offset:0 sc1
  buffer_load_dwordx4 v[228:231], v2, s[4:7], s21 offen offset:1024 sc1
reca_b221:
  s_barrier
  s_add_u32 s34, s17, 2
  s_and_b32 s34, s34, 3
  s_mul_i32 s26, s34, 10240
  s_add_u32 s26, s26, s38
  s_mul_i32 s27, s34, 6144
  s_add_u32 s27, s27, s39
  s_mul_i32 s28, s34, 12288
  s_add_u32 s28, s28, s40
  s_mul_i32 s29, s34, 393216
  s_add_u32 s29, s29, s56
  s_cmp_eq_u32 s12, 3
  s_cbranch_scc1 reca_swave20
  s_cmp_eq_u32 s17, 63
  s_cbranch_scc1 reca_exit1
  s_barrier
  buffer_store_dwordx2 v[32:33], v8, s[4:7], s27 offen
  s_cmp_lg_u32 s12, 2
  s_cbranch_scc1 reca_b324
  buffer_store_dwordx2 v[52:53], v9, s[4:7], s30 offen
  buffer_store_dwordx2 v[32:33], v16, s[4:7], s26 offen
  s_cmp_lg_u32 s14, 0
  s_cbranch_scc1 reca_b324
  v_mov_b32 v28, s17
  s_lshl_b32 s34, s13, 7
  s_add_u32 s34, s34, 1507328
  buffer_store_dword v28, v19, s[4:7], s34 offen
  s_branch reca_b324
reca_swave20:
  s_and_b32 s34, s17, 1
  s_mul_i32 s34, s34, 14336
  v_add_u32 v18, s34, v1
  ds_read_b128 v[56:59], v1 offset:10240
  ds_read_b128 v[60:63], v1 offset:11264
  ds_read_b128 v[64:67], v1 offset:12288
  ds_read_b128 v[128:131], v18 offset:16384
  ds_read_b128 v[152:155], v18 offset:22528
  ds_read_b128 v[132:135], v18 offset:17408
  ds_read_b128 v[156:159], v18 offset:23552
  ds_read_b128 v[136:139], v18 offset:18432
  ds_read_b128 v[160:163], v18 offset:24576
  ds_read_b128 v[140:143], v18 offset:19456
  ds_read_b128 v[164:167], v18 offset:25600
  ds_read_b128 v[144:147], v18 offset:20480
  ds_read_b128 v[168:171], v18 offset:26624
  ds_read_b128 v[148:151], v18 offset:21504
  s_waitcnt lgkmcnt(8)
  ds_read_b128 v[172:175], v18 offset:27648
  ds_read_b128 v[176:179], v18 offset:28672
  ds_read_b128 v[180:183], v18 offset:29696
  v_add_f32 v56, v56, v64
  v_add_f32 v60, v60, v48
  v_add_f32 v57, v57, v65
  v_add_f32 v61, v61, v49
  v_add_f32 v58, v58, v66
  v_add_f32 v62, v62, v50
  v_add_f32 v59, v59, v67
  v_add_f32 v63, v63, v51
  v_cvt_pk_bf16_f32 v68, v56, v57
  v_cvt_pk_bf16_f32 v69, v58, v59
  v_cvt_pk_bf16_f32 v70, v60, v61
  v_cvt_pk_bf16_f32 v71, v62, v63
  s_cmp_lg_u32 s17, 63
  s_cbranch_scc1 reca_vmst28
  buffer_store_dwordx2 v[52:53], v9, s[4:7], s30 offen
  buffer_store_dwordx2 v[68:69], v10, s[4:7], s31 offen
  buffer_store_dwordx2 v[70:71], v10, s[4:7], s31 offen offset:256
  s_branch reca_exit1
reca_vmst28:
  s_waitcnt lgkmcnt(0)
  s_waitcnt vmcnt(5)
  v_max_u32 v29, v208, v210
  v_cmp_eq_u32 vcc, -1, v29
  s_cbranch_vccnz reca_retry29
reca_resume30:
  s_waitcnt vmcnt(4)
  v_max_u32 v29, v212, v214
  v_cmp_eq_u32 vcc, -1, v29
  v_mfma_f32_16x16x32_bf16 v[72:75], v[208:211], v[208:211], v[40:43]
  v_mfma_f32_16x16x32_bf16 v[76:79], v[128:131], v[208:211], 0
  v_mfma_f32_16x16x32_bf16 v[80:83], v[152:155], v[208:211], 0
  s_cbranch_vccnz reca_retry31
reca_resume32:
  s_waitcnt vmcnt(3)
  v_max_u32 v29, v216, v218
  v_cmp_eq_u32 vcc, -1, v29
  v_mfma_f32_16x16x32_bf16 v[72:75], v[212:215], v[212:215], v[72:75]
  v_mfma_f32_16x16x32_bf16 v[76:79], v[132:135], v[212:215], v[76:79]
  v_mfma_f32_16x16x32_bf16 v[80:83], v[156:159], v[212:215], v[80:83]
  s_cbranch_vccnz reca_retry33
reca_resume34:
  s_waitcnt vmcnt(2)
  v_max_u32 v29, v220, v222
  v_cmp_eq_u32 vcc, -1, v29
  v_mfma_f32_16x16x32_bf16 v[72:75], v[216:219], v[216:219], v[72:75]
  v_mfma_f32_16x16x32_bf16 v[76:79], v[136:139], v[216:219], v[76:79]
  v_mfma_f32_16x16x32_bf16 v[80:83], v[160:163], v[216:219], v[80:83]
  s_cbranch_vccnz reca_retry35
reca_resume36:
  s_waitcnt vmcnt(1)
  v_max_u32 v29, v224, v226
  v_cmp_eq_u32 vcc, -1, v29
  v_mfma_f32_16x16x32_bf16 v[72:75], v[220:223], v[220:223], v[72:75]
  v_mfma_f32_16x16x32_bf16 v[76:79], v[140:143], v[220:223], v[76:79]
  v_mfma_f32_16x16x32_bf16 v[80:83], v[164:167], v[220:223], v[80:83]
  s_cbranch_vccnz reca_retry37
reca_resume38:
  s_waitcnt vmcnt(0)
  v_max_u32 v29, v228, v230
  v_cmp_eq_u32 vcc, -1, v29
  v_mfma_f32_16x16x32_bf16 v[72:75], v[224:227], v[224:227], v[72:75]
  v_mfma_f32_16x16x32_bf16 v[76:79], v[144:147], v[224:227], v[76:79]
  v_mfma_f32_16x16x32_bf16 v[80:83], v[168:171], v[224:227], v[80:83]
  s_cbranch_vccnz reca_retry39
reca_resume40:
  v_mfma_f32_16x16x32_bf16 v[72:75], v[228:231], v[228:231], v[72:75]
  v_mfma_f32_16x16x32_bf16 v[76:79], v[148:151], v[228:231], v[76:79]
  v_mfma_f32_16x16x32_bf16 v[80:83], v[172:175], v[228:231], v[80:83]
  s_barrier
  s_nop 4
  v_max3_f32 v28, v72, v73, v74
  v_max3_f32 v29, v76, v77, v78
  v_max3_f32 v28, v28, v75, v79
  v_max3_f32 v29, v29, v80, v81
  v_max3_f32 v28, v28, v82, v83
  v_max_f32 v28, v28, v29
  v_mov_b32 v29, v28
  s_nop 1
  v_permlane32_swap_b32 v28, v29
  v_max_f32 v28, v28, v29
  v_mov_b32 v29, v28
  s_nop 1
  v_permlane16_swap_b32 v28, v29
  v_max_f32 v28, v28, v29
  v_mul_f32 v28, s41, v28
  v_fma_f32 v72, v72, s41, -v28
  v_fma_f32 v73, v73, s41, -v28
  v_fma_f32 v74, v74, s41, -v28
  v_fma_f32 v75, v75, s41, -v28
  v_fma_f32 v76, v76, s41, -v28
  v_fma_f32 v77, v77, s41, -v28
  v_fma_f32 v78, v78, s41, -v28
  v_fma_f32 v79, v79, s41, -v28
  v_fma_f32 v80, v80, s41, -v28
  v_fma_f32 v81, v81, s41, -v28
  v_fma_f32 v82, v82, s41, -v28
  v_fma_f32 v83, v83, s41, -v28
  v_exp_f32 v72, v72
  v_exp_f32 v73, v73
  v_exp_f32 v74, v74
  v_exp_f32 v75, v75
  v_exp_f32 v76, v76
  v_exp_f32 v77, v77
  v_exp_f32 v78, v78
  v_exp_f32 v79, v79
  v_exp_f32 v80, v80
  v_exp_f32 v81, v81
  v_exp_f32 v82, v82
  v_exp_f32 v83, v83
  v_cvt_pk_bf16_f32 v84, v76, v77
  v_cvt_pk_bf16_f32 v85, v78, v79
  v_cvt_pk_bf16_f32 v86, v80, v81
  v_cvt_pk_bf16_f32 v87, v82, v83
  v_cvt_pk_bf16_f32 v88, v72, v73
  v_cvt_pk_bf16_f32 v89, v74, v75
  v_mfma_f32_16x16x32_bf16 v[100:103], v[36:39], v[84:87], 0
  v_mfma_f32_16x16x32_bf16 v[92:95], v[176:179], v[84:87], 0
  v_mfma_f32_16x16x32_bf16 v[96:99], v[180:183], v[84:87], 0
  v_mfma_f32_16x16x16_bf16 v[100:103], v[36:37], v[88:89], v[100:103]
  v_mfma_f32_16x16x16_bf16 v[92:95], v[68:69], v[88:89], v[92:95]
  v_mfma_f32_16x16x16_bf16 v[96:99], v[70:71], v[88:89], v[96:99]
  s_nop 5
  v_rcp_f32 v28, v100
  s_nop 0
  v_mul_f32 v92, v92, v28
  v_mul_f32 v93, v93, v28
  v_mul_f32 v94, v94, v28
  v_mul_f32 v95, v95, v28
  v_mul_f32 v96, v96, v28
  v_mul_f32 v97, v97, v28
  v_mul_f32 v98, v98, v28
  v_mul_f32 v99, v99, v28
  v_cvt_pk_bf16_f32 v104, v92, v93
  v_cvt_pk_bf16_f32 v105, v94, v95
  v_cvt_pk_bf16_f32 v106, v96, v97
  v_cvt_pk_bf16_f32 v107, v98, v99
  buffer_store_dwordx4 v[104:107], v11, s[4:7], s22 offen
reca_b324:
  s_barrier
  s_cmp_ge_u32 s12, 2
  s_cbranch_scc1 reca_notg241
  s_sleep 3
  buffer_load_dwordx4 v[128:131], v12, s[4:7], s22 offen offset:0 sc1
  buffer_load_dwordx4 v[132:135], v12, s[4:7], s22 offen offset:1024 sc1
  buffer_load_dwordx4 v[136:139], v12, s[4:7], s22 offen offset:2048 sc1
  buffer_load_dwordx4 v[140:143], v12, s[4:7], s22 offen offset:3072 sc1
  buffer_load_dwordx4 v[144:147], v13, s[4:7], s22 offen offset:0 sc1
  buffer_load_dwordx4 v[148:151], v13, s[4:7], s22 offen offset:1024 sc1
  buffer_load_dwordx4 v[152:155], v13, s[4:7], s22 offen offset:2048 sc1
  buffer_load_dwordx4 v[156:159], v13, s[4:7], s22 offen offset:3072 sc1
  buffer_load_dwordx4 v[160:163], v14, s[4:7], s22 offen offset:0 sc1
  buffer_load_dwordx4 v[164:167], v14, s[4:7], s22 offen offset:1024 sc1
  buffer_load_dwordx4 v[168:171], v14, s[4:7], s22 offen offset:2048 sc1
  buffer_load_dwordx4 v[172:175], v14, s[4:7], s22 offen offset:3072 sc1
  s_waitcnt vmcnt(11)
  v_cmp_eq_u32 vcc, -1, v128
  s_cbranch_vccnz reca_retry42
reca_resume43:
  s_waitcnt vmcnt(10)
  v_cmp_eq_u32 vcc, -1, v132
  v_mfma_f32_16x16x32_bf16 v[108:111], a[120:123], v[128:131], 0
  v_mfma_f32_16x16x32_bf16 v[112:115], a[124:127], v[128:131], 0
  s_cbranch_vccnz reca_retry44
reca_resume45:
  s_waitcnt vmcnt(9)
  v_cmp_eq_u32 vcc, -1, v136
  v_mfma_f32_16x16x32_bf16 v[108:111], a[128:131], v[132:135], v[108:111]
  v_mfma_f32_16x16x32_bf16 v[112:115], a[132:135], v[132:135], v[112:115]
  s_cbranch_vccnz reca_retry46
reca_resume47:
  s_waitcnt vmcnt(8)
  v_cmp_eq_u32 vcc, -1, v140
  v_mfma_f32_16x16x32_bf16 v[108:111], a[136:139], v[136:139], v[108:111]
  v_mfma_f32_16x16x32_bf16 v[112:115], a[140:143], v[136:139], v[112:115]
  s_cbranch_vccnz reca_retry48
reca_resume49:
  s_waitcnt vmcnt(7)
  v_cmp_eq_u32 vcc, -1, v144
  v_mfma_f32_16x16x32_bf16 v[108:111], a[144:147], v[140:143], v[108:111]
  v_mfma_f32_16x16x32_bf16 v[112:115], a[148:151], v[140:143], v[112:115]
  s_cbranch_vccnz reca_retry50
reca_resume51:
  s_waitcnt vmcnt(6)
  v_cmp_eq_u32 vcc, -1, v148
  v_mfma_f32_16x16x32_bf16 v[108:111], a[152:155], v[144:147], v[108:111]
  v_mfma_f32_16x16x32_bf16 v[112:115], a[156:159], v[144:147], v[112:115]
  s_cbranch_vccnz reca_retry52
reca_resume53:
  s_waitcnt vmcnt(5)
  v_cmp_eq_u32 vcc, -1, v152
  v_mfma_f32_16x16x32_bf16 v[108:111], a[160:163], v[148:151], v[108:111]
  v_mfma_f32_16x16x32_bf16 v[112:115], a[164:167], v[148:151], v[112:115]
  s_cbranch_vccnz reca_retry54
reca_resume55:
  s_waitcnt vmcnt(4)
  v_cmp_eq_u32 vcc, -1, v156
  v_mfma_f32_16x16x32_bf16 v[108:111], a[168:171], v[152:155], v[108:111]
  v_mfma_f32_16x16x32_bf16 v[112:115], a[172:175], v[152:155], v[112:115]
  s_cbranch_vccnz reca_retry56
reca_resume57:
  s_waitcnt vmcnt(3)
  v_cmp_eq_u32 vcc, -1, v160
  v_mfma_f32_16x16x32_bf16 v[108:111], a[176:179], v[156:159], v[108:111]
  v_mfma_f32_16x16x32_bf16 v[112:115], a[180:183], v[156:159], v[112:115]
  s_cbranch_vccnz reca_retry58
reca_resume59:
  s_waitcnt vmcnt(2)
  v_cmp_eq_u32 vcc, -1, v164
  v_mfma_f32_16x16x32_bf16 v[108:111], a[184:187], v[160:163], v[108:111]
  v_mfma_f32_16x16x32_bf16 v[112:115], a[188:191], v[160:163], v[112:115]
  s_cbranch_vccnz reca_retry60
reca_resume61:
  s_waitcnt vmcnt(1)
  v_cmp_eq_u32 vcc, -1, v168
  v_mfma_f32_16x16x32_bf16 v[108:111], a[192:195], v[164:167], v[108:111]
  v_mfma_f32_16x16x32_bf16 v[112:115], a[196:199], v[164:167], v[112:115]
  s_cbranch_vccnz reca_retry62
reca_resume63:
  s_waitcnt vmcnt(0)
  v_cmp_eq_u32 vcc, -1, v172
  v_mfma_f32_16x16x32_bf16 v[108:111], a[200:203], v[168:171], v[108:111]
  v_mfma_f32_16x16x32_bf16 v[112:115], a[204:207], v[168:171], v[112:115]
  s_cbranch_vccnz reca_retry64
reca_resume65:
  v_mfma_f32_16x16x32_bf16 v[108:111], a[208:211], v[172:175], v[108:111]
  v_mfma_f32_16x16x32_bf16 v[112:115], a[212:215], v[172:175], v[112:115]
  s_nop 7
  v_add_f32_dpp v116, v112, v108 row_ror:8 row_mask:0xf bank_mask:0xf
  v_add_f32_dpp v117, v113, v109 row_ror:8 row_mask:0xf bank_mask:0xf
  v_add_f32_dpp v118, v114, v110 row_ror:8 row_mask:0xf bank_mask:0xf
  v_add_f32_dpp v119, v115, v111 row_ror:8 row_mask:0xf bank_mask:0xf
  buffer_store_dwordx4 v[116:119], v15, s[4:7], s25 offen sc1
  buffer_store_dwordx4 v[116:119], v232, s[4:7], s25 offen sc1
  buffer_store_dwordx4 v[32:35], v15, s[4:7], s29 offen sc1
  buffer_store_dwordx4 v[32:35], v232, s[4:7], s29 offen sc1
  s_branch reca_b425
reca_notg241:
  s_cmp_lg_u32 s12, 3
  s_cbranch_scc1 reca_b425
  buffer_store_dwordx2 v[32:33], v8, s[4:7], s27 offen
  buffer_store_dwordx4 v[32:35], v11, s[4:7], s28 offen
reca_b425:
  s_barrier
  s_cmp_lg_u32 s12, 2
  s_cbranch_scc1 reca_not266
  s_sleep 8
  buffer_load_dwordx4 v[128:131], v20, s[4:7], s25 offen sc1
  buffer_load_dwordx4 v[132:135], v21, s[4:7], s25 offen sc1
  buffer_load_dwordx4 v[136:139], v22, s[4:7], s25 offen sc1
  buffer_load_dwordx4 v[140:143], v23, s[4:7], s25 offen sc1
  buffer_load_dwordx4 v[144:147], v24, s[4:7], s25 offen sc1
  buffer_load_dwordx4 v[148:151], v25, s[4:7], s25 offen sc1
  buffer_load_dwordx4 v[152:155], v26, s[4:7], s25 offen sc1
  buffer_load_dwordx4 v[156:159], v27, s[4:7], s25 offen sc1
  s_waitcnt vmcnt(7)
  v_cmp_eq_u32 vcc, -1, v128
  s_cbranch_vccnz reca_retry67
reca_resume68:
  s_waitcnt vmcnt(6)
  v_cmp_eq_u32 vcc, -1, v132
  s_cbranch_vccnz reca_retry69
reca_resume70:
  s_waitcnt vmcnt(5)
  v_cmp_eq_u32 vcc, -1, v136
  v_pk_add_f32 v[116:117], v[128:129], v[132:133]
  v_pk_add_f32 v[118:119], v[130:131], v[134:135]
  s_cbranch_vccnz reca_retry71
reca_resume72:
  s_waitcnt vmcnt(4)
  v_cmp_eq_u32 vcc, -1, v140
  v_pk_add_f32 v[116:117], v[116:117], v[136:137]
  v_pk_add_f32 v[118:119], v[118:119], v[138:139]
  s_cbranch_vccnz reca_retry73
reca_resume74:
  s_waitcnt vmcnt(3)
  v_cmp_eq_u32 vcc, -1, v144
  v_pk_add_f32 v[116:117], v[116:117], v[140:141]
  v_pk_add_f32 v[118:119], v[118:119], v[142:143]
  s_cbranch_vccnz reca_retry75
reca_resume76:
  s_waitcnt vmcnt(2)
  v_cmp_eq_u32 vcc, -1, v148
  v_pk_add_f32 v[116:117], v[116:117], v[144:145]
  v_pk_add_f32 v[118:119], v[118:119], v[146:147]
  s_cbranch_vccnz reca_retry77
reca_resume78:
  s_waitcnt vmcnt(1)
  v_cmp_eq_u32 vcc, -1, v152
  v_pk_add_f32 v[116:117], v[116:117], v[148:149]
  v_pk_add_f32 v[118:119], v[118:119], v[150:151]
  s_cbranch_vccnz reca_retry79
reca_resume80:
  s_waitcnt vmcnt(0)
  v_cmp_eq_u32 vcc, -1, v156
  v_pk_add_f32 v[116:117], v[116:117], v[152:153]
  v_pk_add_f32 v[118:119], v[118:119], v[154:155]
  s_cbranch_vccnz reca_retry81
reca_resume82:
  v_pk_add_f32 v[116:117], v[116:117], v[156:157]
  v_pk_add_f32 v[118:119], v[118:119], v[158:159]
  v_cvt_pk_bf16_f32 v132, v116, v117
  v_cvt_pk_bf16_f32 v133, v118, v119
  buffer_store_dwordx2 v[132:133], v16, s[4:7], s24 offen
  s_branch reca_b526
reca_not266:
  s_cmp_lg_u32 s12, 3
  s_cbranch_scc1 reca_b526
  s_add_u32 s36, s17, 1
  s_cmp_ge_u32 s36, 63
  s_cbranch_scc1 reca_nopf83
  s_add_u32 s37, s36, 1
reca_pf84:
  buffer_load_dword v28, v233, s[4:7], 0 offen sc1
  s_waitcnt vmcnt(0)
  v_cmp_gt_i32 vcc, s37, v28
  s_cbranch_vccz reca_pfok85
  s_sleep 1
  s_sub_u32 s18, s18, 1
  s_cbranch_scc0 reca_pf84
  s_mov_b32 s18, 0
reca_pfok85:
  s_lshl_b32 s34, s15, 6
  s_add_u32 s34, s34, s36
  s_mul_i32 s34, s34, 12288
  s_add_u32 s32, s34, 37748736
  s_lshl_b32 s35, s16, 11
  s_add_u32 s34, s34, s35
  s_add_u32 s33, s34, 62914560
  s_and_b32 s35, s36, 1
  s_mul_i32 s35, s35, 14336
  s_add_u32 s35, s35, 16384
  s_add_u32 m0, s35, 0
  s_nop 0
  buffer_load_dwordx4 v1, s[4:7], s32 offen offset:0 sc1 lds
  buffer_load_dwordx4 v1, s[4:7], s32 offen offset:1024 sc1 lds
  buffer_load_dwordx4 v1, s[4:7], s32 offen offset:2048 sc1 lds
  buffer_load_dwordx4 v1, s[4:7], s32 offen offset:3072 sc1 lds
  s_add_u32 s32, s32, 4096
  s_add_u32 m0, s35, 4096
  s_nop 0
  buffer_load_dwordx4 v1, s[4:7], s32 offen offset:0 sc1 lds
  buffer_load_dwordx4 v1, s[4:7], s32 offen offset:1024 sc1 lds
  buffer_load_dwordx4 v1, s[4:7], s32 offen offset:2048 sc1 lds
  buffer_load_dwordx4 v1, s[4:7], s32 offen offset:3072 sc1 lds
  s_add_u32 s32, s32, 4096
  s_add_u32 m0, s35, 8192
  s_nop 0
  buffer_load_dwordx4 v1, s[4:7], s32 offen offset:0 sc1 lds
  buffer_load_dwordx4 v1, s[4:7], s32 offen offset:1024 sc1 lds
  buffer_load_dwordx4 v1, s[4:7], s32 offen offset:2048 sc1 lds
  buffer_load_dwordx4 v1, s[4:7], s32 offen offset:3072 sc1 lds
  s_add_u32 m0, s35, 12288
  s_nop 0
  buffer_load_dwordx4 v1, s[4:7], s33 offen offset:0 sc1 lds
  buffer_load_dwordx4 v1, s[4:7], s33 offen offset:1024 sc1 lds
reca_nopf83:
  buffer_store_dwordx2 v[52:53], v9, s[4:7], s30 offen
  buffer_store_dwordx2 v[68:69], v10, s[4:7], s31 offen
  buffer_store_dwordx2 v[70:71], v10, s[4:7], s31 offen offset:256
reca_b526:
  s_barrier
  s_add_u32 s17, s17, 1
  s_branch reca_step11
reca_retry14:
  s_sub_u32 s18, s18, 1
  s_cbranch_scc1 reca_retry14_to
  buffer_load_dwordx4 v[128:131], v4, s[4:7], s20 offen sc1
  buffer_load_dwordx4 v[132:135], v4, s[4:7], s20 offen offset:1024 sc1
  buffer_load_dwordx4 v[136:139], v5, s[4:7], s20 offen sc1
  s_waitcnt vmcnt(2)
  v_max_u32 v29, v128, v130
  v_cmp_eq_u32 vcc, -1, v29
  s_cbranch_vccnz reca_retry14
  s_branch reca_resume15
reca_retry14_to:
  s_mov_b32 s18, 0
  s_waitcnt vmcnt(0)
  s_branch reca_resume15
reca_retry16:
  s_sub_u32 s18, s18, 1
  s_cbranch_scc1 reca_retry16_to
  buffer_load_dwordx4 v[132:135], v4, s[4:7], s20 offen offset:1024 sc1
  buffer_load_dwordx4 v[136:139], v5, s[4:7], s20 offen sc1
  s_waitcnt vmcnt(1)
  v_max_u32 v29, v132, v134
  v_cmp_eq_u32 vcc, -1, v29
  s_cbranch_vccnz reca_retry16
  s_branch reca_resume17
reca_retry16_to:
  s_mov_b32 s18, 0
  s_waitcnt vmcnt(0)
  s_branch reca_resume17
reca_retry18:
  s_sub_u32 s18, s18, 1
  s_cbranch_scc1 reca_retry18_to
  buffer_load_dwordx4 v[136:139], v5, s[4:7], s20 offen sc1
  s_waitcnt vmcnt(0)
  v_max_u32 v29, v136, v138
  v_cmp_eq_u32 vcc, -1, v29
  s_cbranch_vccnz reca_retry18
  s_branch reca_resume19
reca_retry18_to:
  s_mov_b32 s18, 0
  s_waitcnt vmcnt(0)
  s_branch reca_resume19
reca_retry29:
  s_sub_u32 s18, s18, 1
  s_cbranch_scc1 reca_retry29_to
  buffer_load_dwordx4 v[208:211], v1, s[4:7], s21 offen offset:0 sc1
  buffer_load_dwordx4 v[212:215], v1, s[4:7], s21 offen offset:1024 sc1
  buffer_load_dwordx4 v[216:219], v1, s[4:7], s21 offen offset:2048 sc1
  buffer_load_dwordx4 v[220:223], v1, s[4:7], s21 offen offset:3072 sc1
  buffer_load_dwordx4 v[224:227], v2, s[4:7], s21 offen offset:0 sc1
  buffer_load_dwordx4 v[228:231], v2, s[4:7], s21 offen offset:1024 sc1
  s_waitcnt vmcnt(5)
  v_max_u32 v29, v208, v210
  v_cmp_eq_u32 vcc, -1, v29
  s_cbranch_vccnz reca_retry29
  s_branch reca_resume30
reca_retry29_to:
  s_mov_b32 s18, 0
  s_waitcnt vmcnt(0)
  s_branch reca_resume30
reca_retry31:
  s_sub_u32 s18, s18, 1
  s_cbranch_scc1 reca_retry31_to
  buffer_load_dwordx4 v[212:215], v1, s[4:7], s21 offen offset:1024 sc1
  buffer_load_dwordx4 v[216:219], v1, s[4:7], s21 offen offset:2048 sc1
  buffer_load_dwordx4 v[220:223], v1, s[4:7], s21 offen offset:3072 sc1
  buffer_load_dwordx4 v[224:227], v2, s[4:7], s21 offen offset:0 sc1
  buffer_load_dwordx4 v[228:231], v2, s[4:7], s21 offen offset:1024 sc1
  s_waitcnt vmcnt(4)
  v_max_u32 v29, v212, v214
  v_cmp_eq_u32 vcc, -1, v29
  s_cbranch_vccnz reca_retry31
  s_branch reca_resume32
reca_retry31_to:
  s_mov_b32 s18, 0
  s_waitcnt vmcnt(0)
  s_branch reca_resume32
reca_retry33:
  s_sub_u32 s18, s18, 1
  s_cbranch_scc1 reca_retry33_to
  buffer_load_dwordx4 v[216:219], v1, s[4:7], s21 offen offset:2048 sc1
  buffer_load_dwordx4 v[220:223], v1, s[4:7], s21 offen offset:3072 sc1
  buffer_load_dwordx4 v[224:227], v2, s[4:7], s21 offen offset:0 sc1
  buffer_load_dwordx4 v[228:231], v2, s[4:7], s21 offen offset:1024 sc1
  s_waitcnt vmcnt(3)
  v_max_u32 v29, v216, v218
  v_cmp_eq_u32 vcc, -1, v29
  s_cbranch_vccnz reca_retry33
  s_branch reca_resume34
reca_retry33_to:
  s_mov_b32 s18, 0
  s_waitcnt vmcnt(0)
  s_branch reca_resume34
reca_retry35:
  s_sub_u32 s18, s18, 1
  s_cbranch_scc1 reca_retry35_to
  buffer_load_dwordx4 v[220:223], v1, s[4:7], s21 offen offset:3072 sc1
  buffer_load_dwordx4 v[224:227], v2, s[4:7], s21 offen offset:0 sc1
  buffer_load_dwordx4 v[228:231], v2, s[4:7], s21 offen offset:1024 sc1
  s_waitcnt vmcnt(2)
  v_max_u32 v29, v220, v222
  v_cmp_eq_u32 vcc, -1, v29
  s_cbranch_vccnz reca_retry35
  s_branch reca_resume36
reca_retry35_to:
  s_mov_b32 s18, 0
  s_waitcnt vmcnt(0)
  s_branch reca_resume36
reca_retry37:
  s_sub_u32 s18, s18, 1
  s_cbranch_scc1 reca_retry37_to
  buffer_load_dwordx4 v[224:227], v2, s[4:7], s21 offen offset:0 sc1
  buffer_load_dwordx4 v[228:231], v2, s[4:7], s21 offen offset:1024 sc1
  s_waitcnt vmcnt(1)
  v_max_u32 v29, v224, v226
  v_cmp_eq_u32 vcc, -1, v29
  s_cbranch_vccnz reca_retry37
  s_branch reca_resume38
reca_retry37_to:
  s_mov_b32 s18, 0
  s_waitcnt vmcnt(0)
  s_branch reca_resume38
reca_retry39:
  s_sub_u32 s18, s18, 1
  s_cbranch_scc1 reca_retry39_to
  buffer_load_dwordx4 v[228:231], v2, s[4:7], s21 offen offset:1024 sc1
  s_waitcnt vmcnt(0)
  v_max_u32 v29, v228, v230
  v_cmp_eq_u32 vcc, -1, v29
  s_cbranch_vccnz reca_retry39
  s_branch reca_resume40
reca_retry39_to:
  s_mov_b32 s18, 0
  s_waitcnt vmcnt(0)
  s_branch reca_resume40
reca_retry42:
  s_sub_u32 s18, s18, 1
  s_cbranch_scc1 reca_retry42_to
  buffer_load_dwordx4 v[128:131], v12, s[4:7], s22 offen offset:0 sc1
  buffer_load_dwordx4 v[132:135], v12, s[4:7], s22 offen offset:1024 sc1
  buffer_load_dwordx4 v[136:139], v12, s[4:7], s22 offen offset:2048 sc1
  buffer_load_dwordx4 v[140:143], v12, s[4:7], s22 offen offset:3072 sc1
  buffer_load_dwordx4 v[144:147], v13, s[4:7], s22 offen offset:0 sc1
  buffer_load_dwordx4 v[148:151], v13, s[4:7], s22 offen offset:1024 sc1
  buffer_load_dwordx4 v[152:155], v13, s[4:7], s22 offen offset:2048 sc1
  buffer_load_dwordx4 v[156:159], v13, s[4:7], s22 offen offset:3072 sc1
  buffer_load_dwordx4 v[160:163], v14, s[4:7], s22 offen offset:0 sc1
  buffer_load_dwordx4 v[164:167], v14, s[4:7], s22 offen offset:1024 sc1
  buffer_load_dwordx4 v[168:171], v14, s[4:7], s22 offen offset:2048 sc1
  buffer_load_dwordx4 v[172:175], v14, s[4:7], s22 offen offset:3072 sc1
  s_waitcnt vmcnt(11)
  v_cmp_eq_u32 vcc, -1, v128
  s_cbranch_vccnz reca_retry42
  s_branch reca_resume43
reca_retry42_to:
  s_mov_b32 s18, 0
  s_waitcnt vmcnt(0)
  s_branch reca_resume43
reca_retry44:
  s_sub_u32 s18, s18, 1
  s_cbranch_scc1 reca_retry44_to
  buffer_load_dwordx4 v[132:135], v12, s[4:7], s22 offen offset:1024 sc1
  buffer_load_dwordx4 v[136:139], v12, s[4:7], s22 offen offset:2048 sc1
  buffer_load_dwordx4 v[140:143], v12, s[4:7], s22 offen offset:3072 sc1
  buffer_load_dwordx4 v[144:147], v13, s[4:7], s22 offen offset:0 sc1
  buffer_load_dwordx4 v[148:151], v13, s[4:7], s22 offen offset:1024 sc1
  buffer_load_dwordx4 v[152:155], v13, s[4:7], s22 offen offset:2048 sc1
  buffer_load_dwordx4 v[156:159], v13, s[4:7], s22 offen offset:3072 sc1
  buffer_load_dwordx4 v[160:163], v14, s[4:7], s22 offen offset:0 sc1
  buffer_load_dwordx4 v[164:167], v14, s[4:7], s22 offen offset:1024 sc1
  buffer_load_dwordx4 v[168:171], v14, s[4:7], s22 offen offset:2048 sc1
  buffer_load_dwordx4 v[172:175], v14, s[4:7], s22 offen offset:3072 sc1
  s_waitcnt vmcnt(10)
  v_cmp_eq_u32 vcc, -1, v132
  s_cbranch_vccnz reca_retry44
  s_branch reca_resume45
reca_retry44_to:
  s_mov_b32 s18, 0
  s_waitcnt vmcnt(0)
  s_branch reca_resume45
reca_retry46:
  s_sub_u32 s18, s18, 1
  s_cbranch_scc1 reca_retry46_to
  buffer_load_dwordx4 v[136:139], v12, s[4:7], s22 offen offset:2048 sc1
  buffer_load_dwordx4 v[140:143], v12, s[4:7], s22 offen offset:3072 sc1
  buffer_load_dwordx4 v[144:147], v13, s[4:7], s22 offen offset:0 sc1
  buffer_load_dwordx4 v[148:151], v13, s[4:7], s22 offen offset:1024 sc1
  buffer_load_dwordx4 v[152:155], v13, s[4:7], s22 offen offset:2048 sc1
  buffer_load_dwordx4 v[156:159], v13, s[4:7], s22 offen offset:3072 sc1
  buffer_load_dwordx4 v[160:163], v14, s[4:7], s22 offen offset:0 sc1
  buffer_load_dwordx4 v[164:167], v14, s[4:7], s22 offen offset:1024 sc1
  buffer_load_dwordx4 v[168:171], v14, s[4:7], s22 offen offset:2048 sc1
  buffer_load_dwordx4 v[172:175], v14, s[4:7], s22 offen offset:3072 sc1
  s_waitcnt vmcnt(9)
  v_cmp_eq_u32 vcc, -1, v136
  s_cbranch_vccnz reca_retry46
  s_branch reca_resume47
reca_retry46_to:
  s_mov_b32 s18, 0
  s_waitcnt vmcnt(0)
  s_branch reca_resume47
reca_retry48:
  s_sub_u32 s18, s18, 1
  s_cbranch_scc1 reca_retry48_to
  buffer_load_dwordx4 v[140:143], v12, s[4:7], s22 offen offset:3072 sc1
  buffer_load_dwordx4 v[144:147], v13, s[4:7], s22 offen offset:0 sc1
  buffer_load_dwordx4 v[148:151], v13, s[4:7], s22 offen offset:1024 sc1
  buffer_load_dwordx4 v[152:155], v13, s[4:7], s22 offen offset:2048 sc1
  buffer_load_dwordx4 v[156:159], v13, s[4:7], s22 offen offset:3072 sc1
  buffer_load_dwordx4 v[160:163], v14, s[4:7], s22 offen offset:0 sc1
  buffer_load_dwordx4 v[164:167], v14, s[4:7], s22 offen offset:1024 sc1
  buffer_load_dwordx4 v[168:171], v14, s[4:7], s22 offen offset:2048 sc1
  buffer_load_dwordx4 v[172:175], v14, s[4:7], s22 offen offset:3072 sc1
  s_waitcnt vmcnt(8)
  v_cmp_eq_u32 vcc, -1, v140
  s_cbranch_vccnz reca_retry48
  s_branch reca_resume49
reca_retry48_to:
  s_mov_b32 s18, 0
  s_waitcnt vmcnt(0)
  s_branch reca_resume49
reca_retry50:
  s_sub_u32 s18, s18, 1
  s_cbranch_scc1 reca_retry50_to
  buffer_load_dwordx4 v[144:147], v13, s[4:7], s22 offen offset:0 sc1
  buffer_load_dwordx4 v[148:151], v13, s[4:7], s22 offen offset:1024 sc1
  buffer_load_dwordx4 v[152:155], v13, s[4:7], s22 offen offset:2048 sc1
  buffer_load_dwordx4 v[156:159], v13, s[4:7], s22 offen offset:3072 sc1
  buffer_load_dwordx4 v[160:163], v14, s[4:7], s22 offen offset:0 sc1
  buffer_load_dwordx4 v[164:167], v14, s[4:7], s22 offen offset:1024 sc1
  buffer_load_dwordx4 v[168:171], v14, s[4:7], s22 offen offset:2048 sc1
  buffer_load_dwordx4 v[172:175], v14, s[4:7], s22 offen offset:3072 sc1
  s_waitcnt vmcnt(7)
  v_cmp_eq_u32 vcc, -1, v144
  s_cbranch_vccnz reca_retry50
  s_branch reca_resume51
reca_retry50_to:
  s_mov_b32 s18, 0
  s_waitcnt vmcnt(0)
  s_branch reca_resume51
reca_retry52:
  s_sub_u32 s18, s18, 1
  s_cbranch_scc1 reca_retry52_to
  buffer_load_dwordx4 v[148:151], v13, s[4:7], s22 offen offset:1024 sc1
  buffer_load_dwordx4 v[152:155], v13, s[4:7], s22 offen offset:2048 sc1
  buffer_load_dwordx4 v[156:159], v13, s[4:7], s22 offen offset:3072 sc1
  buffer_load_dwordx4 v[160:163], v14, s[4:7], s22 offen offset:0 sc1
  buffer_load_dwordx4 v[164:167], v14, s[4:7], s22 offen offset:1024 sc1
  buffer_load_dwordx4 v[168:171], v14, s[4:7], s22 offen offset:2048 sc1
  buffer_load_dwordx4 v[172:175], v14, s[4:7], s22 offen offset:3072 sc1
  s_waitcnt vmcnt(6)
  v_cmp_eq_u32 vcc, -1, v148
  s_cbranch_vccnz reca_retry52
  s_branch reca_resume53
reca_retry52_to:
  s_mov_b32 s18, 0
  s_waitcnt vmcnt(0)
  s_branch reca_resume53
reca_retry54:
  s_sub_u32 s18, s18, 1
  s_cbranch_scc1 reca_retry54_to
  buffer_load_dwordx4 v[152:155], v13, s[4:7], s22 offen offset:2048 sc1
  buffer_load_dwordx4 v[156:159], v13, s[4:7], s22 offen offset:3072 sc1
  buffer_load_dwordx4 v[160:163], v14, s[4:7], s22 offen offset:0 sc1
  buffer_load_dwordx4 v[164:167], v14, s[4:7], s22 offen offset:1024 sc1
  buffer_load_dwordx4 v[168:171], v14, s[4:7], s22 offen offset:2048 sc1
  buffer_load_dwordx4 v[172:175], v14, s[4:7], s22 offen offset:3072 sc1
  s_waitcnt vmcnt(5)
  v_cmp_eq_u32 vcc, -1, v152
  s_cbranch_vccnz reca_retry54
  s_branch reca_resume55
reca_retry54_to:
  s_mov_b32 s18, 0
  s_waitcnt vmcnt(0)
  s_branch reca_resume55
reca_retry56:
  s_sub_u32 s18, s18, 1
  s_cbranch_scc1 reca_retry56_to
  buffer_load_dwordx4 v[156:159], v13, s[4:7], s22 offen offset:3072 sc1
  buffer_load_dwordx4 v[160:163], v14, s[4:7], s22 offen offset:0 sc1
  buffer_load_dwordx4 v[164:167], v14, s[4:7], s22 offen offset:1024 sc1
  buffer_load_dwordx4 v[168:171], v14, s[4:7], s22 offen offset:2048 sc1
  buffer_load_dwordx4 v[172:175], v14, s[4:7], s22 offen offset:3072 sc1
  s_waitcnt vmcnt(4)
  v_cmp_eq_u32 vcc, -1, v156
  s_cbranch_vccnz reca_retry56
  s_branch reca_resume57
reca_retry56_to:
  s_mov_b32 s18, 0
  s_waitcnt vmcnt(0)
  s_branch reca_resume57
reca_retry58:
  s_sub_u32 s18, s18, 1
  s_cbranch_scc1 reca_retry58_to
  buffer_load_dwordx4 v[160:163], v14, s[4:7], s22 offen offset:0 sc1
  buffer_load_dwordx4 v[164:167], v14, s[4:7], s22 offen offset:1024 sc1
  buffer_load_dwordx4 v[168:171], v14, s[4:7], s22 offen offset:2048 sc1
  buffer_load_dwordx4 v[172:175], v14, s[4:7], s22 offen offset:3072 sc1
  s_waitcnt vmcnt(3)
  v_cmp_eq_u32 vcc, -1, v160
  s_cbranch_vccnz reca_retry58
  s_branch reca_resume59
reca_retry58_to:
  s_mov_b32 s18, 0
  s_waitcnt vmcnt(0)
  s_branch reca_resume59
reca_retry60:
  s_sub_u32 s18, s18, 1
  s_cbranch_scc1 reca_retry60_to
  buffer_load_dwordx4 v[164:167], v14, s[4:7], s22 offen offset:1024 sc1
  buffer_load_dwordx4 v[168:171], v14, s[4:7], s22 offen offset:2048 sc1
  buffer_load_dwordx4 v[172:175], v14, s[4:7], s22 offen offset:3072 sc1
  s_waitcnt vmcnt(2)
  v_cmp_eq_u32 vcc, -1, v164
  s_cbranch_vccnz reca_retry60
  s_branch reca_resume61
reca_retry60_to:
  s_mov_b32 s18, 0
  s_waitcnt vmcnt(0)
  s_branch reca_resume61
reca_retry62:
  s_sub_u32 s18, s18, 1
  s_cbranch_scc1 reca_retry62_to
  buffer_load_dwordx4 v[168:171], v14, s[4:7], s22 offen offset:2048 sc1
  buffer_load_dwordx4 v[172:175], v14, s[4:7], s22 offen offset:3072 sc1
  s_waitcnt vmcnt(1)
  v_cmp_eq_u32 vcc, -1, v168
  s_cbranch_vccnz reca_retry62
  s_branch reca_resume63
reca_retry62_to:
  s_mov_b32 s18, 0
  s_waitcnt vmcnt(0)
  s_branch reca_resume63
reca_retry64:
  s_sub_u32 s18, s18, 1
  s_cbranch_scc1 reca_retry64_to
  buffer_load_dwordx4 v[172:175], v14, s[4:7], s22 offen offset:3072 sc1
  s_waitcnt vmcnt(0)
  v_cmp_eq_u32 vcc, -1, v172
  s_cbranch_vccnz reca_retry64
  s_branch reca_resume65
reca_retry64_to:
  s_mov_b32 s18, 0
  s_waitcnt vmcnt(0)
  s_branch reca_resume65
reca_retry67:
  s_sub_u32 s18, s18, 1
  s_cbranch_scc1 reca_retry67_to
  buffer_load_dwordx4 v[128:131], v20, s[4:7], s25 offen sc1
  buffer_load_dwordx4 v[132:135], v21, s[4:7], s25 offen sc1
  buffer_load_dwordx4 v[136:139], v22, s[4:7], s25 offen sc1
  buffer_load_dwordx4 v[140:143], v23, s[4:7], s25 offen sc1
  buffer_load_dwordx4 v[144:147], v24, s[4:7], s25 offen sc1
  buffer_load_dwordx4 v[148:151], v25, s[4:7], s25 offen sc1
  buffer_load_dwordx4 v[152:155], v26, s[4:7], s25 offen sc1
  buffer_load_dwordx4 v[156:159], v27, s[4:7], s25 offen sc1
  s_waitcnt vmcnt(7)
  v_cmp_eq_u32 vcc, -1, v128
  s_cbranch_vccnz reca_retry67
  s_branch reca_resume68
reca_retry67_to:
  s_mov_b32 s18, 0
  s_waitcnt vmcnt(0)
  s_branch reca_resume68
reca_retry69:
  s_sub_u32 s18, s18, 1
  s_cbranch_scc1 reca_retry69_to
  buffer_load_dwordx4 v[132:135], v21, s[4:7], s25 offen sc1
  buffer_load_dwordx4 v[136:139], v22, s[4:7], s25 offen sc1
  buffer_load_dwordx4 v[140:143], v23, s[4:7], s25 offen sc1
  buffer_load_dwordx4 v[144:147], v24, s[4:7], s25 offen sc1
  buffer_load_dwordx4 v[148:151], v25, s[4:7], s25 offen sc1
  buffer_load_dwordx4 v[152:155], v26, s[4:7], s25 offen sc1
  buffer_load_dwordx4 v[156:159], v27, s[4:7], s25 offen sc1
  s_waitcnt vmcnt(6)
  v_cmp_eq_u32 vcc, -1, v132
  s_cbranch_vccnz reca_retry69
  s_branch reca_resume70
reca_retry69_to:
  s_mov_b32 s18, 0
  s_waitcnt vmcnt(0)
  s_branch reca_resume70
reca_retry71:
  s_sub_u32 s18, s18, 1
  s_cbranch_scc1 reca_retry71_to
  buffer_load_dwordx4 v[136:139], v22, s[4:7], s25 offen sc1
  buffer_load_dwordx4 v[140:143], v23, s[4:7], s25 offen sc1
  buffer_load_dwordx4 v[144:147], v24, s[4:7], s25 offen sc1
  buffer_load_dwordx4 v[148:151], v25, s[4:7], s25 offen sc1
  buffer_load_dwordx4 v[152:155], v26, s[4:7], s25 offen sc1
  buffer_load_dwordx4 v[156:159], v27, s[4:7], s25 offen sc1
  s_waitcnt vmcnt(5)
  v_cmp_eq_u32 vcc, -1, v136
  s_cbranch_vccnz reca_retry71
  s_branch reca_resume72
reca_retry71_to:
  s_mov_b32 s18, 0
  s_waitcnt vmcnt(0)
  s_branch reca_resume72
reca_retry73:
  s_sub_u32 s18, s18, 1
  s_cbranch_scc1 reca_retry73_to
  buffer_load_dwordx4 v[140:143], v23, s[4:7], s25 offen sc1
  buffer_load_dwordx4 v[144:147], v24, s[4:7], s25 offen sc1
  buffer_load_dwordx4 v[148:151], v25, s[4:7], s25 offen sc1
  buffer_load_dwordx4 v[152:155], v26, s[4:7], s25 offen sc1
  buffer_load_dwordx4 v[156:159], v27, s[4:7], s25 offen sc1
  s_waitcnt vmcnt(4)
  v_cmp_eq_u32 vcc, -1, v140
  s_cbranch_vccnz reca_retry73
  s_branch reca_resume74
reca_retry73_to:
  s_mov_b32 s18, 0
  s_waitcnt vmcnt(0)
  s_branch reca_resume74
reca_retry75:
  s_sub_u32 s18, s18, 1
  s_cbranch_scc1 reca_retry75_to
  buffer_load_dwordx4 v[144:147], v24, s[4:7], s25 offen sc1
  buffer_load_dwordx4 v[148:151], v25, s[4:7], s25 offen sc1
  buffer_load_dwordx4 v[152:155], v26, s[4:7], s25 offen sc1
  buffer_load_dwordx4 v[156:159], v27, s[4:7], s25 offen sc1
  s_waitcnt vmcnt(3)
  v_cmp_eq_u32 vcc, -1, v144
  s_cbranch_vccnz reca_retry75
  s_branch reca_resume76
reca_retry75_to:
  s_mov_b32 s18, 0
  s_waitcnt vmcnt(0)
  s_branch reca_resume76
reca_retry77:
  s_sub_u32 s18, s18, 1
  s_cbranch_scc1 reca_retry77_to
  buffer_load_dwordx4 v[148:151], v25, s[4:7], s25 offen sc1
  buffer_load_dwordx4 v[152:155], v26, s[4:7], s25 offen sc1
  buffer_load_dwordx4 v[156:159], v27, s[4:7], s25 offen sc1
  s_waitcnt vmcnt(2)
  v_cmp_eq_u32 vcc, -1, v148
  s_cbranch_vccnz reca_retry77
  s_branch reca_resume78
reca_retry77_to:
  s_mov_b32 s18, 0
  s_waitcnt vmcnt(0)
  s_branch reca_resume78
reca_retry79:
  s_sub_u32 s18, s18, 1
  s_cbranch_scc1 reca_retry79_to
  buffer_load_dwordx4 v[152:155], v26, s[4:7], s25 offen sc1
  buffer_load_dwordx4 v[156:159], v27, s[4:7], s25 offen sc1
  s_waitcnt vmcnt(1)
  v_cmp_eq_u32 vcc, -1, v152
  s_cbranch_vccnz reca_retry79
  s_branch reca_resume80
reca_retry79_to:
  s_mov_b32 s18, 0
  s_waitcnt vmcnt(0)
  s_branch reca_resume80
reca_retry81:
  s_sub_u32 s18, s18, 1
  s_cbranch_scc1 reca_retry81_to
  buffer_load_dwordx4 v[156:159], v27, s[4:7], s25 offen sc1
  s_waitcnt vmcnt(0)
  v_cmp_eq_u32 vcc, -1, v156
  s_cbranch_vccnz reca_retry81
  s_branch reca_resume82
reca_retry81_to:
  s_mov_b32 s18, 0
  s_waitcnt vmcnt(0)
  s_branch reca_resume82
reca_slow10:
  s_branch reca_gotmem87
reca_step86:
  s_and_b32 s34, s17, 3
  s_mul_i32 s20, s34, 10240
  s_add_u32 s20, s20, s38
  s_sleep 2
  buffer_load_dwordx4 v[128:131], v4, s[4:7], s20 offen sc1
  buffer_load_dwordx4 v[132:135], v4, s[4:7], s20 offen offset:1024 sc1
  buffer_load_dwordx4 v[136:139], v5, s[4:7], s20 offen sc1
  s_waitcnt vmcnt(2)
  v_max_u32 v29, v128, v130
  v_cmp_eq_u32 vcc, -1, v29
  s_cbranch_vccnz reca_retry89
reca_resume90:
  s_waitcnt vmcnt(1)
  v_max_u32 v29, v132, v134
  v_cmp_eq_u32 vcc, -1, v29
  ds_write_b128 v4, v[128:131]
  s_cbranch_vccnz reca_retry91
reca_resume92:
  s_waitcnt vmcnt(0)
  v_max_u32 v29, v136, v138
  v_cmp_eq_u32 vcc, -1, v29
  ds_write_b128 v4, v[132:135] offset:1024
  s_cbranch_vccnz reca_retry93
reca_resume94:
  ds_write_b128 v5, v[136:139]
  s_branch reca_gotmem288
reca_gotmem87:
  ds_write_b128 v4, v[128:131]
  ds_write_b128 v4, v[132:135] offset:1024
  ds_write_b128 v5, v[136:139]
reca_gotmem288:
  s_and_b32 s34, s17, 3
  s_mul_i32 s21, s34, 6144
  s_add_u32 s21, s21, s39
  s_mul_i32 s22, s34, 12288
  s_add_u32 s22, s22, s40
  s_mul_i32 s25, s34, 393216
  s_add_u32 s25, s25, s56
  s_add_u32 s35, s17, 1
  s_and_b32 s35, s35, 3
  s_mul_i32 s24, s35, 10240
  s_add_u32 s24, s24, s38
  s_waitcnt lgkmcnt(0)
  s_barrier
  ds_read_b128 v[128:131], v6 offset:0
  ds_read_b128 v[132:135], v6 offset:512
  ds_read_b128 v[136:139], v6 offset:1024
  ds_read_b128 v[140:143], v6 offset:1536
  ds_read_b128 v[144:147], v6 offset:2048
  ds_read_b128 v[148:151], v6 offset:2560
  ds_read_b128 v[152:155], v6 offset:3072
  ds_read_b128 v[156:159], v6 offset:3584
  ds_read_b128 v[160:163], v6 offset:4096
  ds_read_b128 v[164:167], v6 offset:4608
  ds_read_b128 v[168:171], v7 offset:0
  ds_read_b128 v[172:175], v7 offset:512
  ds_read_b128 v[176:179], v7 offset:1024
  s_waitcnt lgkmcnt(12)
  v_mfma_f32_16x16x32_bf16 v[44:47], a[0:3], v[128:131], 0
  ds_read_b128 v[180:183], v7 offset:1536
  s_waitcnt lgkmcnt(12)
  v_mfma_f32_16x16x32_bf16 v[44:47], a[4:7], v[132:135], v[44:47]
  ds_read_b128 v[184:187], v7 offset:2048
  s_waitcnt lgkmcnt(12)
  v_mfma_f32_16x16x32_bf16 v[44:47], a[8:11], v[136:139], v[44:47]
  ds_read_b128 v[188:191], v7 offset:2560
  s_waitcnt lgkmcnt(12)
  v_mfma_f32_16x16x32_bf16 v[44:47], a[12:15], v[140:143], v[44:47]
  ds_read_b128 v[192:195], v7 offset:3072
  s_waitcnt lgkmcnt(12)
  v_mfma_f32_16x16x32_bf16 v[44:47], a[16:19], v[144:147], v[44:47]
  ds_read_b128 v[196:199], v7 offset:3584
  s_waitcnt lgkmcnt(12)
  v_mfma_f32_16x16x32_bf16 v[44:47], a[20:23], v[148:151], v[44:47]
  ds_read_b128 v[200:203], v7 offset:4096
  s_waitcnt lgkmcnt(12)
  v_mfma_f32_16x16x32_bf16 v[44:47], a[24:27], v[152:155], v[44:47]
  ds_read_b128 v[204:207], v7 offset:4608
  s_waitcnt lgkmcnt(12)
  v_mfma_f32_16x16x32_bf16 v[44:47], a[28:31], v[156:159], v[44:47]
  s_waitcnt lgkmcnt(11)
  v_mfma_f32_16x16x32_bf16 v[44:47], a[32:35], v[160:163], v[44:47]
  s_waitcnt lgkmcnt(10)
  v_mfma_f32_16x16x32_bf16 v[44:47], a[36:39], v[164:167], v[44:47]
  s_waitcnt lgkmcnt(9)
  v_mfma_f32_16x16x32_bf16 v[44:47], a[40:43], v[168:171], v[44:47]
  s_waitcnt lgkmcnt(8)
  v_mfma_f32_16x16x32_bf16 v[44:47], a[44:47], v[172:175], v[44:47]
  s_waitcnt lgkmcnt(7)
  v_mfma_f32_16x16x32_bf16 v[44:47], a[48:51], v[176:179], v[44:47]
  s_waitcnt lgkmcnt(6)
  v_mfma_f32_16x16x32_bf16 v[44:47], a[52:55], v[180:183], v[44:47]
  s_waitcnt lgkmcnt(5)
  v_mfma_f32_16x16x32_bf16 v[44:47], a[56:59], v[184:187], v[44:47]
  s_waitcnt lgkmcnt(4)
  v_mfma_f32_16x16x32_bf16 v[44:47], a[60:63], v[188:191], v[44:47]
  s_waitcnt lgkmcnt(3)
  v_mfma_f32_16x16x32_bf16 v[44:47], a[64:67], v[192:195], v[44:47]
  s_waitcnt lgkmcnt(2)
  v_mfma_f32_16x16x32_bf16 v[44:47], a[68:71], v[196:199], v[44:47]
  s_waitcnt lgkmcnt(1)
  v_mfma_f32_16x16x32_bf16 v[44:47], a[72:75], v[200:203], v[44:47]
  s_waitcnt lgkmcnt(0)
  v_mfma_f32_16x16x32_bf16 v[44:47], a[76:79], v[204:207], v[44:47]
  v_mfma_f32_16x16x32_bf16 v[48:51], v[128:131], a[80:83], 0
  s_lshl_b32 s34, s17, 5
  s_add_u32 s34, s34, s15
  s_mul_i32 s34, s34, 3072
  s_lshl_b32 s35, s16, 9
  s_add_u32 s34, s34, s35
  s_add_u32 s30, s34, 113246208
  s_add_u32 s31, s34, 119537664
  v_cvt_pk_bf16_f32 v52, v44, v45
  v_cvt_pk_bf16_f32 v53, v46, v47
  buffer_store_dwordx2 v[52:53], v8, s[4:7], s21 offen sc1
  v_mfma_f32_16x16x32_bf16 v[48:51], v[132:135], a[84:87], v[48:51]
  v_mfma_f32_16x16x32_bf16 v[48:51], v[136:139], a[88:91], v[48:51]
  v_mfma_f32_16x16x32_bf16 v[48:51], v[140:143], a[92:95], v[48:51]
  v_mfma_f32_16x16x32_bf16 v[48:51], v[144:147], a[96:99], v[48:51]
  v_mfma_f32_16x16x32_bf16 v[48:51], v[148:151], a[100:103], v[48:51]
  v_mfma_f32_16x16x32_bf16 v[48:51], v[152:155], a[104:107], v[48:51]
  v_mfma_f32_16x16x32_bf16 v[48:51], v[156:159], a[108:111], v[48:51]
  v_mfma_f32_16x16x32_bf16 v[48:51], v[160:163], a[112:115], v[48:51]
  v_mfma_f32_16x16x32_bf16 v[48:51], v[164:167], a[116:119], v[48:51]
  s_cmp_eq_u32 s12, 3
  s_cbranch_scc1 reca_spre97
  s_nop 5
  ds_write_b128 v17, v[48:51]
  s_cmp_lg_u32 s17, 63
  s_cbranch_scc1 reca_nokm98
  s_cmp_lg_u32 s12, 2
  s_cbranch_scc1 reca_nokm98
  buffer_store_dwordx2 v[52:53], v9, s[4:7], s30 offen
reca_nokm98:
  s_waitcnt lgkmcnt(0)
  s_branch reca_b296
reca_spre97:
  s_sleep 1
  buffer_load_dwordx4 v[208:211], v1, s[4:7], s21 offen offset:0 sc1
  buffer_load_dwordx4 v[212:215], v1, s[4:7], s21 offen offset:1024 sc1
  buffer_load_dwordx4 v[216:219], v1, s[4:7], s21 offen offset:2048 sc1
  buffer_load_dwordx4 v[220:223], v1, s[4:7], s21 offen offset:3072 sc1
  buffer_load_dwordx4 v[224:227], v2, s[4:7], s21 offen offset:0 sc1
  buffer_load_dwordx4 v[228:231], v2, s[4:7], s21 offen offset:1024 sc1
reca_b296:
  s_barrier
  s_add_u32 s34, s17, 2
  s_and_b32 s34, s34, 3
  s_mul_i32 s26, s34, 10240
  s_add_u32 s26, s26, s38
  s_mul_i32 s27, s34, 6144
  s_add_u32 s27, s27, s39
  s_mul_i32 s28, s34, 12288
  s_add_u32 s28, s28, s40
  s_mul_i32 s29, s34, 393216
  s_add_u32 s29, s29, s56
  s_cmp_eq_u32 s12, 3
  s_cbranch_scc1 reca_swave95
  s_cmp_eq_u32 s17, 63
  s_cbranch_scc1 reca_exit1
  s_barrier
  buffer_store_dwordx2 v[32:33], v8, s[4:7], s27 offen sc1
  s_cmp_lg_u32 s12, 2
  s_cbranch_scc1 reca_b399
  buffer_store_dwordx2 v[52:53], v9, s[4:7], s30 offen
  buffer_store_dwordx2 v[32:33], v16, s[4:7], s26 offen sc1
  s_cmp_lg_u32 s14, 0
  s_cbranch_scc1 reca_b399
  v_mov_b32 v28, s17
  s_lshl_b32 s34, s13, 7
  s_add_u32 s34, s34, 1507328
  buffer_store_dword v28, v19, s[4:7], s34 offen sc1
  s_branch reca_b399
reca_swave95:
  s_and_b32 s34, s17, 1
  s_mul_i32 s34, s34, 14336
  v_add_u32 v18, s34, v1
  ds_read_b128 v[56:59], v1 offset:10240
  ds_read_b128 v[60:63], v1 offset:11264
  ds_read_b128 v[64:67], v1 offset:12288
  ds_read_b128 v[128:131], v18 offset:16384
  ds_read_b128 v[152:155], v18 offset:22528
  ds_read_b128 v[132:135], v18 offset:17408
  ds_read_b128 v[156:159], v18 offset:23552
  ds_read_b128 v[136:139], v18 offset:18432
  ds_read_b128 v[160:163], v18 offset:24576
  ds_read_b128 v[140:143], v18 offset:19456
  ds_read_b128 v[164:167], v18 offset:25600
  ds_read_b128 v[144:147], v18 offset:20480
  ds_read_b128 v[168:171], v18 offset:26624
  ds_read_b128 v[148:151], v18 offset:21504
  s_waitcnt lgkmcnt(8)
  ds_read_b128 v[172:175], v18 offset:27648
  ds_read_b128 v[176:179], v18 offset:28672
  ds_read_b128 v[180:183], v18 offset:29696
  v_add_f32 v56, v56, v64
  v_add_f32 v60, v60, v48
  v_add_f32 v57, v57, v65
  v_add_f32 v61, v61, v49
  v_add_f32 v58, v58, v66
  v_add_f32 v62, v62, v50
  v_add_f32 v59, v59, v67
  v_add_f32 v63, v63, v51
  v_cvt_pk_bf16_f32 v68, v56, v57
  v_cvt_pk_bf16_f32 v69, v58, v59
  v_cvt_pk_bf16_f32 v70, v60, v61
  v_cvt_pk_bf16_f32 v71, v62, v63
  s_cmp_lg_u32 s17, 63
  s_cbranch_scc1 reca_vmst103
  buffer_store_dwordx2 v[52:53], v9, s[4:7], s30 offen
  buffer_store_dwordx2 v[68:69], v10, s[4:7], s31 offen
  buffer_store_dwordx2 v[70:71], v10, s[4:7], s31 offen offset:256
  s_branch reca_exit1
reca_vmst103:
  s_waitcnt lgkmcnt(0)
  s_waitcnt vmcnt(5)
  v_max_u32 v29, v208, v210
  v_cmp_eq_u32 vcc, -1, v29
  s_cbranch_vccnz reca_retry104
reca_resume105:
  s_waitcnt vmcnt(4)
  v_max_u32 v29, v212, v214
  v_cmp_eq_u32 vcc, -1, v29
  v_mfma_f32_16x16x32_bf16 v[72:75], v[208:211], v[208:211], v[40:43]
  v_mfma_f32_16x16x32_bf16 v[76:79], v[128:131], v[208:211], 0
  v_mfma_f32_16x16x32_bf16 v[80:83], v[152:155], v[208:211], 0
  s_cbranch_vccnz reca_retry106
reca_resume107:
  s_waitcnt vmcnt(3)
  v_max_u32 v29, v216, v218
  v_cmp_eq_u32 vcc, -1, v29
  v_mfma_f32_16x16x32_bf16 v[72:75], v[212:215], v[212:215], v[72:75]
  v_mfma_f32_16x16x32_bf16 v[76:79], v[132:135], v[212:215], v[76:79]
  v_mfma_f32_16x16x32_bf16 v[80:83], v[156:159], v[212:215], v[80:83]
  s_cbranch_vccnz reca_retry108
reca_resume109:
  s_waitcnt vmcnt(2)
  v_max_u32 v29, v220, v222
  v_cmp_eq_u32 vcc, -1, v29
  v_mfma_f32_16x16x32_bf16 v[72:75], v[216:219], v[216:219], v[72:75]
  v_mfma_f32_16x16x32_bf16 v[76:79], v[136:139], v[216:219], v[76:79]
  v_mfma_f32_16x16x32_bf16 v[80:83], v[160:163], v[216:219], v[80:83]
  s_cbranch_vccnz reca_retry110
reca_resume111:
  s_waitcnt vmcnt(1)
  v_max_u32 v29, v224, v226
  v_cmp_eq_u32 vcc, -1, v29
  v_mfma_f32_16x16x32_bf16 v[72:75], v[220:223], v[220:223], v[72:75]
  v_mfma_f32_16x16x32_bf16 v[76:79], v[140:143], v[220:223], v[76:79]
  v_mfma_f32_16x16x32_bf16 v[80:83], v[164:167], v[220:223], v[80:83]
  s_cbranch_vccnz reca_retry112
reca_resume113:
  s_waitcnt vmcnt(0)
  v_max_u32 v29, v228, v230
  v_cmp_eq_u32 vcc, -1, v29
  v_mfma_f32_16x16x32_bf16 v[72:75], v[224:227], v[224:227], v[72:75]
  v_mfma_f32_16x16x32_bf16 v[76:79], v[144:147], v[224:227], v[76:79]
  v_mfma_f32_16x16x32_bf16 v[80:83], v[168:171], v[224:227], v[80:83]
  s_cbranch_vccnz reca_retry114
reca_resume115:
  v_mfma_f32_16x16x32_bf16 v[72:75], v[228:231], v[228:231], v[72:75]
  v_mfma_f32_16x16x32_bf16 v[76:79], v[148:151], v[228:231], v[76:79]
  v_mfma_f32_16x16x32_bf16 v[80:83], v[172:175], v[228:231], v[80:83]
  s_barrier
  s_nop 4
  v_max3_f32 v28, v72, v73, v74
  v_max3_f32 v29, v76, v77, v78
  v_max3_f32 v28, v28, v75, v79
  v_max3_f32 v29, v29, v80, v81
  v_max3_f32 v28, v28, v82, v83
  v_max_f32 v28, v28, v29
  v_mov_b32 v29, v28
  s_nop 1
  v_permlane32_swap_b32 v28, v29
  v_max_f32 v28, v28, v29
  v_mov_b32 v29, v28
  s_nop 1
  v_permlane16_swap_b32 v28, v29
  v_max_f32 v28, v28, v29
  v_mul_f32 v28, s41, v28
  v_fma_f32 v72, v72, s41, -v28
  v_fma_f32 v73, v73, s41, -v28
  v_fma_f32 v74, v74, s41, -v28
  v_fma_f32 v75, v75, s41, -v28
  v_fma_f32 v76, v76, s41, -v28
  v_fma_f32 v77, v77, s41, -v28
  v_fma_f32 v78, v78, s41, -v28
  v_fma_f32 v79, v79, s41, -v28
  v_fma_f32 v80, v80, s41, -v28
  v_fma_f32 v81, v81, s41, -v28
  v_fma_f32 v82, v82, s41, -v28
  v_fma_f32 v83, v83, s41, -v28
  v_exp_f32 v72, v72
  v_exp_f32 v73, v73
  v_exp_f32 v74, v74
  v_exp_f32 v75, v75
  v_exp_f32 v76, v76
  v_exp_f32 v77, v77
  v_exp_f32 v78, v78
  v_exp_f32 v79, v79
  v_exp_f32 v80, v80
  v_exp_f32 v81, v81
  v_exp_f32 v82, v82
  v_exp_f32 v83, v83
  v_cvt_pk_bf16_f32 v84, v76, v77
  v_cvt_pk_bf16_f32 v85, v78, v79
  v_cvt_pk_bf16_f32 v86, v80, v81
  v_cvt_pk_bf16_f32 v87, v82, v83
  v_cvt_pk_bf16_f32 v88, v72, v73
  v_cvt_pk_bf16_f32 v89, v74, v75
  v_mfma_f32_16x16x32_bf16 v[100:103], v[36:39], v[84:87], 0
  v_mfma_f32_16x16x32_bf16 v[92:95], v[176:179], v[84:87], 0
  v_mfma_f32_16x16x32_bf16 v[96:99], v[180:183], v[84:87], 0
  v_mfma_f32_16x16x16_bf16 v[100:103], v[36:37], v[88:89], v[100:103]
  v_mfma_f32_16x16x16_bf16 v[92:95], v[68:69], v[88:89], v[92:95]
  v_mfma_f32_16x16x16_bf16 v[96:99], v[70:71], v[88:89], v[96:99]
  s_nop 5
  v_rcp_f32 v28, v100
  s_nop 0
  v_mul_f32 v92, v92, v28
  v_mul_f32 v93, v93, v28
  v_mul_f32 v94, v94, v28
  v_mul_f32 v95, v95, v28
  v_mul_f32 v96, v96, v28
  v_mul_f32 v97, v97, v28
  v_mul_f32 v98, v98, v28
  v_mul_f32 v99, v99, v28
  v_cvt_pk_bf16_f32 v104, v92, v93
  v_cvt_pk_bf16_f32 v105, v94, v95
  v_cvt_pk_bf16_f32 v106, v96, v97
  v_cvt_pk_bf16_f32 v107, v98, v99
  buffer_store_dwordx4 v[104:107], v11, s[4:7], s22 offen sc1
reca_b399:
  s_barrier
  s_cmp_ge_u32 s12, 2
  s_cbranch_scc1 reca_notg2116
  s_sleep 3
  buffer_load_dwordx4 v[128:131], v12, s[4:7], s22 offen offset:0 sc1
  buffer_load_dwordx4 v[132:135], v12, s[4:7], s22 offen offset:1024 sc1
  buffer_load_dwordx4 v[136:139], v12, s[4:7], s22 offen offset:2048 sc1
  buffer_load_dwordx4 v[140:143], v12, s[4:7], s22 offen offset:3072 sc1
  buffer_load_dwordx4 v[144:147], v13, s[4:7], s22 offen offset:0 sc1
  buffer_load_dwordx4 v[148:151], v13, s[4:7], s22 offen offset:1024 sc1
  buffer_load_dwordx4 v[152:155], v13, s[4:7], s22 offen offset:2048 sc1
  buffer_load_dwordx4 v[156:159], v13, s[4:7], s22 offen offset:3072 sc1
  buffer_load_dwordx4 v[160:163], v14, s[4:7], s22 offen offset:0 sc1
  buffer_load_dwordx4 v[164:167], v14, s[4:7], s22 offen offset:1024 sc1
  buffer_load_dwordx4 v[168:171], v14, s[4:7], s22 offen offset:2048 sc1
  buffer_load_dwordx4 v[172:175], v14, s[4:7], s22 offen offset:3072 sc1
  s_waitcnt vmcnt(11)
  v_cmp_eq_u32 vcc, -1, v128
  s_cbranch_vccnz reca_retry117
reca_resume118:
  s_waitcnt vmcnt(10)
  v_cmp_eq_u32 vcc, -1, v132
  v_mfma_f32_16x16x32_bf16 v[108:111], a[120:123], v[128:131], 0
  v_mfma_f32_16x16x32_bf16 v[112:115], a[124:127], v[128:131], 0
  s_cbranch_vccnz reca_retry119
reca_resume120:
  s_waitcnt vmcnt(9)
  v_cmp_eq_u32 vcc, -1, v136
  v_mfma_f32_16x16x32_bf16 v[108:111], a[128:131], v[132:135], v[108:111]
  v_mfma_f32_16x16x32_bf16 v[112:115], a[132:135], v[132:135], v[112:115]
  s_cbranch_vccnz reca_retry121
reca_resume122:
  s_waitcnt vmcnt(8)
  v_cmp_eq_u32 vcc, -1, v140
  v_mfma_f32_16x16x32_bf16 v[108:111], a[136:139], v[136:139], v[108:111]
  v_mfma_f32_16x16x32_bf16 v[112:115], a[140:143], v[136:139], v[112:115]
  s_cbranch_vccnz reca_retry123
reca_resume124:
  s_waitcnt vmcnt(7)
  v_cmp_eq_u32 vcc, -1, v144
  v_mfma_f32_16x16x32_bf16 v[108:111], a[144:147], v[140:143], v[108:111]
  v_mfma_f32_16x16x32_bf16 v[112:115], a[148:151], v[140:143], v[112:115]
  s_cbranch_vccnz reca_retry125
reca_resume126:
  s_waitcnt vmcnt(6)
  v_cmp_eq_u32 vcc, -1, v148
  v_mfma_f32_16x16x32_bf16 v[108:111], a[152:155], v[144:147], v[108:111]
  v_mfma_f32_16x16x32_bf16 v[112:115], a[156:159], v[144:147], v[112:115]
  s_cbranch_vccnz reca_retry127
reca_resume128:
  s_waitcnt vmcnt(5)
  v_cmp_eq_u32 vcc, -1, v152
  v_mfma_f32_16x16x32_bf16 v[108:111], a[160:163], v[148:151], v[108:111]
  v_mfma_f32_16x16x32_bf16 v[112:115], a[164:167], v[148:151], v[112:115]
  s_cbranch_vccnz reca_retry129
reca_resume130:
  s_waitcnt vmcnt(4)
  v_cmp_eq_u32 vcc, -1, v156
  v_mfma_f32_16x16x32_bf16 v[108:111], a[168:171], v[152:155], v[108:111]
  v_mfma_f32_16x16x32_bf16 v[112:115], a[172:175], v[152:155], v[112:115]
  s_cbranch_vccnz reca_retry131
reca_resume132:
  s_waitcnt vmcnt(3)
  v_cmp_eq_u32 vcc, -1, v160
  v_mfma_f32_16x16x32_bf16 v[108:111], a[176:179], v[156:159], v[108:111]
  v_mfma_f32_16x16x32_bf16 v[112:115], a[180:183], v[156:159], v[112:115]
  s_cbranch_vccnz reca_retry133
reca_resume134:
  s_waitcnt vmcnt(2)
  v_cmp_eq_u32 vcc, -1, v164
  v_mfma_f32_16x16x32_bf16 v[108:111], a[184:187], v[160:163], v[108:111]
  v_mfma_f32_16x16x32_bf16 v[112:115], a[188:191], v[160:163], v[112:115]
  s_cbranch_vccnz reca_retry135
reca_resume136:
  s_waitcnt vmcnt(1)
  v_cmp_eq_u32 vcc, -1, v168
  v_mfma_f32_16x16x32_bf16 v[108:111], a[192:195], v[164:167], v[108:111]
  v_mfma_f32_16x16x32_bf16 v[112:115], a[196:199], v[164:167], v[112:115]
  s_cbranch_vccnz reca_retry137
reca_resume138:
  s_waitcnt vmcnt(0)
  v_cmp_eq_u32 vcc, -1, v172
  v_mfma_f32_16x16x32_bf16 v[108:111], a[200:203], v[168:171], v[108:111]
  v_mfma_f32_16x16x32_bf16 v[112:115], a[204:207], v[168:171], v[112:115]
  s_cbranch_vccnz reca_retry139
reca_resume140:
  v_mfma_f32_16x16x32_bf16 v[108:111], a[208:211], v[172:175], v[108:111]
  v_mfma_f32_16x16x32_bf16 v[112:115], a[212:215], v[172:175], v[112:115]
  s_nop 7
  v_add_f32_dpp v116, v112, v108 row_ror:8 row_mask:0xf bank_mask:0xf
  v_add_f32_dpp v117, v113, v109 row_ror:8 row_mask:0xf bank_mask:0xf
  v_add_f32_dpp v118, v114, v110 row_ror:8 row_mask:0xf bank_mask:0xf
  v_add_f32_dpp v119, v115, v111 row_ror:8 row_mask:0xf bank_mask:0xf
  buffer_store_dwordx4 v[116:119], v15, s[4:7], s25 offen sc1
  buffer_store_dwordx4 v[116:119], v232, s[4:7], s25 offen sc1
  buffer_store_dwordx4 v[32:35], v15, s[4:7], s29 offen sc1
  buffer_store_dwordx4 v[32:35], v232, s[4:7], s29 offen sc1
  s_branch reca_b4100
reca_notg2116:
  s_cmp_lg_u32 s12, 3
  s_cbranch_scc1 reca_b4100
  buffer_store_dwordx2 v[32:33], v8, s[4:7], s27 offen sc1
  buffer_store_dwordx4 v[32:35], v11, s[4:7], s28 offen sc1
reca_b4100:
  s_barrier
  s_cmp_lg_u32 s12, 2
  s_cbranch_scc1 reca_not2141
  s_sleep 8
  buffer_load_dwordx4 v[128:131], v20, s[4:7], s25 offen sc1
  buffer_load_dwordx4 v[132:135], v21, s[4:7], s25 offen sc1
  buffer_load_dwordx4 v[136:139], v22, s[4:7], s25 offen sc1
  buffer_load_dwordx4 v[140:143], v23, s[4:7], s25 offen sc1
  buffer_load_dwordx4 v[144:147], v24, s[4:7], s25 offen sc1
  buffer_load_dwordx4 v[148:151], v25, s[4:7], s25 offen sc1
  buffer_load_dwordx4 v[152:155], v26, s[4:7], s25 offen sc1
  buffer_load_dwordx4 v[156:159], v27, s[4:7], s25 offen sc1
  s_waitcnt vmcnt(7)
  v_cmp_eq_u32 vcc, -1, v128
  s_cbranch_vccnz reca_retry142
reca_resume143:
  s_waitcnt vmcnt(6)
  v_cmp_eq_u32 vcc, -1, v132
  s_cbranch_vccnz reca_retry144
reca_resume145:
  s_waitcnt vmcnt(5)
  v_cmp_eq_u32 vcc, -1, v136
  v_pk_add_f32 v[116:117], v[128:129], v[132:133]
  v_pk_add_f32 v[118:119], v[130:131], v[134:135]
  s_cbranch_vccnz reca_retry146
reca_resume147:
  s_waitcnt vmcnt(4)
  v_cmp_eq_u32 vcc, -1, v140
  v_pk_add_f32 v[116:117], v[116:117], v[136:137]
  v_pk_add_f32 v[118:119], v[118:119], v[138:139]
  s_cbranch_vccnz reca_retry148
reca_resume149:
  s_waitcnt vmcnt(3)
  v_cmp_eq_u32 vcc, -1, v144
  v_pk_add_f32 v[116:117], v[116:117], v[140:141]
  v_pk_add_f32 v[118:119], v[118:119], v[142:143]
  s_cbranch_vccnz reca_retry150
reca_resume151:
  s_waitcnt vmcnt(2)
  v_cmp_eq_u32 vcc, -1, v148
  v_pk_add_f32 v[116:117], v[116:117], v[144:145]
  v_pk_add_f32 v[118:119], v[118:119], v[146:147]
  s_cbranch_vccnz reca_retry152
reca_resume153:
  s_waitcnt vmcnt(1)
  v_cmp_eq_u32 vcc, -1, v152
  v_pk_add_f32 v[116:117], v[116:117], v[148:149]
  v_pk_add_f32 v[118:119], v[118:119], v[150:151]
  s_cbranch_vccnz reca_retry154
reca_resume155:
  s_waitcnt vmcnt(0)
  v_cmp_eq_u32 vcc, -1, v156
  v_pk_add_f32 v[116:117], v[116:117], v[152:153]
  v_pk_add_f32 v[118:119], v[118:119], v[154:155]
  s_cbranch_vccnz reca_retry156
reca_resume157:
  v_pk_add_f32 v[116:117], v[116:117], v[156:157]
  v_pk_add_f32 v[118:119], v[118:119], v[158:159]
  v_cvt_pk_bf16_f32 v132, v116, v117
  v_cvt_pk_bf16_f32 v133, v118, v119
  buffer_store_dwordx2 v[132:133], v16, s[4:7], s24 offen sc1
  s_branch reca_b5101
reca_not2141:
  s_cmp_lg_u32 s12, 3
  s_cbranch_scc1 reca_b5101
  s_add_u32 s36, s17, 1
  s_cmp_ge_u32 s36, 63
  s_cbranch_scc1 reca_nopf158
  s_add_u32 s37, s36, 1
reca_pf159:
  buffer_load_dword v28, v233, s[4:7], 0 offen sc1
  s_waitcnt vmcnt(0)
  v_cmp_gt_i32 vcc, s37, v28
  s_cbranch_vccz reca_pfok160
  s_sleep 1
  s_sub_u32 s18, s18, 1
  s_cbranch_scc0 reca_pf159
  s_mov_b32 s18, 0
reca_pfok160:
  s_lshl_b32 s34, s15, 6
  s_add_u32 s34, s34, s36
  s_mul_i32 s34, s34, 12288
  s_add_u32 s32, s34, 37748736
  s_lshl_b32 s35, s16, 11
  s_add_u32 s34, s34, s35
  s_add_u32 s33, s34, 62914560
  s_and_b32 s35, s36, 1
  s_mul_i32 s35, s35, 14336
  s_add_u32 s35, s35, 16384
  s_add_u32 m0, s35, 0
  s_nop 0
  buffer_load_dwordx4 v1, s[4:7], s32 offen offset:0 sc1 lds
  buffer_load_dwordx4 v1, s[4:7], s32 offen offset:1024 sc1 lds
  buffer_load_dwordx4 v1, s[4:7], s32 offen offset:2048 sc1 lds
  buffer_load_dwordx4 v1, s[4:7], s32 offen offset:3072 sc1 lds
  s_add_u32 s32, s32, 4096
  s_add_u32 m0, s35, 4096
  s_nop 0
  buffer_load_dwordx4 v1, s[4:7], s32 offen offset:0 sc1 lds
  buffer_load_dwordx4 v1, s[4:7], s32 offen offset:1024 sc1 lds
  buffer_load_dwordx4 v1, s[4:7], s32 offen offset:2048 sc1 lds
  buffer_load_dwordx4 v1, s[4:7], s32 offen offset:3072 sc1 lds
  s_add_u32 s32, s32, 4096
  s_add_u32 m0, s35, 8192
  s_nop 0
  buffer_load_dwordx4 v1, s[4:7], s32 offen offset:0 sc1 lds
  buffer_load_dwordx4 v1, s[4:7], s32 offen offset:1024 sc1 lds
  buffer_load_dwordx4 v1, s[4:7], s32 offen offset:2048 sc1 lds
  buffer_load_dwordx4 v1, s[4:7], s32 offen offset:3072 sc1 lds
  s_add_u32 m0, s35, 12288
  s_nop 0
  buffer_load_dwordx4 v1, s[4:7], s33 offen offset:0 sc1 lds
  buffer_load_dwordx4 v1, s[4:7], s33 offen offset:1024 sc1 lds
reca_nopf158:
  buffer_store_dwordx2 v[52:53], v9, s[4:7], s30 offen
  buffer_store_dwordx2 v[68:69], v10, s[4:7], s31 offen
  buffer_store_dwordx2 v[70:71], v10, s[4:7], s31 offen offset:256
reca_b5101:
  s_barrier
  s_add_u32 s17, s17, 1
  s_branch reca_step86
reca_retry89:
  s_sub_u32 s18, s18, 1
  s_cbranch_scc1 reca_retry89_to
  buffer_load_dwordx4 v[128:131], v4, s[4:7], s20 offen sc1
  buffer_load_dwordx4 v[132:135], v4, s[4:7], s20 offen offset:1024 sc1
  buffer_load_dwordx4 v[136:139], v5, s[4:7], s20 offen sc1
  s_waitcnt vmcnt(2)
  v_max_u32 v29, v128, v130
  v_cmp_eq_u32 vcc, -1, v29
  s_cbranch_vccnz reca_retry89
  s_branch reca_resume90
reca_retry89_to:
  s_mov_b32 s18, 0
  s_waitcnt vmcnt(0)
  s_branch reca_resume90
reca_retry91:
  s_sub_u32 s18, s18, 1
  s_cbranch_scc1 reca_retry91_to
  buffer_load_dwordx4 v[132:135], v4, s[4:7], s20 offen offset:1024 sc1
  buffer_load_dwordx4 v[136:139], v5, s[4:7], s20 offen sc1
  s_waitcnt vmcnt(1)
  v_max_u32 v29, v132, v134
  v_cmp_eq_u32 vcc, -1, v29
  s_cbranch_vccnz reca_retry91
  s_branch reca_resume92
reca_retry91_to:
  s_mov_b32 s18, 0
  s_waitcnt vmcnt(0)
  s_branch reca_resume92
reca_retry93:
  s_sub_u32 s18, s18, 1
  s_cbranch_scc1 reca_retry93_to
  buffer_load_dwordx4 v[136:139], v5, s[4:7], s20 offen sc1
  s_waitcnt vmcnt(0)
  v_max_u32 v29, v136, v138
  v_cmp_eq_u32 vcc, -1, v29
  s_cbranch_vccnz reca_retry93
  s_branch reca_resume94
reca_retry93_to:
  s_mov_b32 s18, 0
  s_waitcnt vmcnt(0)
  s_branch reca_resume94
reca_retry104:
  s_sub_u32 s18, s18, 1
  s_cbranch_scc1 reca_retry104_to
  buffer_load_dwordx4 v[208:211], v1, s[4:7], s21 offen offset:0 sc1
  buffer_load_dwordx4 v[212:215], v1, s[4:7], s21 offen offset:1024 sc1
  buffer_load_dwordx4 v[216:219], v1, s[4:7], s21 offen offset:2048 sc1
  buffer_load_dwordx4 v[220:223], v1, s[4:7], s21 offen offset:3072 sc1
  buffer_load_dwordx4 v[224:227], v2, s[4:7], s21 offen offset:0 sc1
  buffer_load_dwordx4 v[228:231], v2, s[4:7], s21 offen offset:1024 sc1
  s_waitcnt vmcnt(5)
  v_max_u32 v29, v208, v210
  v_cmp_eq_u32 vcc, -1, v29
  s_cbranch_vccnz reca_retry104
  s_branch reca_resume105
reca_retry104_to:
  s_mov_b32 s18, 0
  s_waitcnt vmcnt(0)
  s_branch reca_resume105
reca_retry106:
  s_sub_u32 s18, s18, 1
  s_cbranch_scc1 reca_retry106_to
  buffer_load_dwordx4 v[212:215], v1, s[4:7], s21 offen offset:1024 sc1
  buffer_load_dwordx4 v[216:219], v1, s[4:7], s21 offen offset:2048 sc1
  buffer_load_dwordx4 v[220:223], v1, s[4:7], s21 offen offset:3072 sc1
  buffer_load_dwordx4 v[224:227], v2, s[4:7], s21 offen offset:0 sc1
  buffer_load_dwordx4 v[228:231], v2, s[4:7], s21 offen offset:1024 sc1
  s_waitcnt vmcnt(4)
  v_max_u32 v29, v212, v214
  v_cmp_eq_u32 vcc, -1, v29
  s_cbranch_vccnz reca_retry106
  s_branch reca_resume107
reca_retry106_to:
  s_mov_b32 s18, 0
  s_waitcnt vmcnt(0)
  s_branch reca_resume107
reca_retry108:
  s_sub_u32 s18, s18, 1
  s_cbranch_scc1 reca_retry108_to
  buffer_load_dwordx4 v[216:219], v1, s[4:7], s21 offen offset:2048 sc1
  buffer_load_dwordx4 v[220:223], v1, s[4:7], s21 offen offset:3072 sc1
  buffer_load_dwordx4 v[224:227], v2, s[4:7], s21 offen offset:0 sc1
  buffer_load_dwordx4 v[228:231], v2, s[4:7], s21 offen offset:1024 sc1
  s_waitcnt vmcnt(3)
  v_max_u32 v29, v216, v218
  v_cmp_eq_u32 vcc, -1, v29
  s_cbranch_vccnz reca_retry108
  s_branch reca_resume109
reca_retry108_to:
  s_mov_b32 s18, 0
  s_waitcnt vmcnt(0)
  s_branch reca_resume109
reca_retry110:
  s_sub_u32 s18, s18, 1
  s_cbranch_scc1 reca_retry110_to
  buffer_load_dwordx4 v[220:223], v1, s[4:7], s21 offen offset:3072 sc1
  buffer_load_dwordx4 v[224:227], v2, s[4:7], s21 offen offset:0 sc1
  buffer_load_dwordx4 v[228:231], v2, s[4:7], s21 offen offset:1024 sc1
  s_waitcnt vmcnt(2)
  v_max_u32 v29, v220, v222
  v_cmp_eq_u32 vcc, -1, v29
  s_cbranch_vccnz reca_retry110
  s_branch reca_resume111
reca_retry110_to:
  s_mov_b32 s18, 0
  s_waitcnt vmcnt(0)
  s_branch reca_resume111
reca_retry112:
  s_sub_u32 s18, s18, 1
  s_cbranch_scc1 reca_retry112_to
  buffer_load_dwordx4 v[224:227], v2, s[4:7], s21 offen offset:0 sc1
  buffer_load_dwordx4 v[228:231], v2, s[4:7], s21 offen offset:1024 sc1
  s_waitcnt vmcnt(1)
  v_max_u32 v29, v224, v226
  v_cmp_eq_u32 vcc, -1, v29
  s_cbranch_vccnz reca_retry112
  s_branch reca_resume113
reca_retry112_to:
  s_mov_b32 s18, 0
  s_waitcnt vmcnt(0)
  s_branch reca_resume113
reca_retry114:
  s_sub_u32 s18, s18, 1
  s_cbranch_scc1 reca_retry114_to
  buffer_load_dwordx4 v[228:231], v2, s[4:7], s21 offen offset:1024 sc1
  s_waitcnt vmcnt(0)
  v_max_u32 v29, v228, v230
  v_cmp_eq_u32 vcc, -1, v29
  s_cbranch_vccnz reca_retry114
  s_branch reca_resume115
reca_retry114_to:
  s_mov_b32 s18, 0
  s_waitcnt vmcnt(0)
  s_branch reca_resume115
reca_retry117:
  s_sub_u32 s18, s18, 1
  s_cbranch_scc1 reca_retry117_to
  buffer_load_dwordx4 v[128:131], v12, s[4:7], s22 offen offset:0 sc1
  buffer_load_dwordx4 v[132:135], v12, s[4:7], s22 offen offset:1024 sc1
  buffer_load_dwordx4 v[136:139], v12, s[4:7], s22 offen offset:2048 sc1
  buffer_load_dwordx4 v[140:143], v12, s[4:7], s22 offen offset:3072 sc1
  buffer_load_dwordx4 v[144:147], v13, s[4:7], s22 offen offset:0 sc1
  buffer_load_dwordx4 v[148:151], v13, s[4:7], s22 offen offset:1024 sc1
  buffer_load_dwordx4 v[152:155], v13, s[4:7], s22 offen offset:2048 sc1
  buffer_load_dwordx4 v[156:159], v13, s[4:7], s22 offen offset:3072 sc1
  buffer_load_dwordx4 v[160:163], v14, s[4:7], s22 offen offset:0 sc1
  buffer_load_dwordx4 v[164:167], v14, s[4:7], s22 offen offset:1024 sc1
  buffer_load_dwordx4 v[168:171], v14, s[4:7], s22 offen offset:2048 sc1
  buffer_load_dwordx4 v[172:175], v14, s[4:7], s22 offen offset:3072 sc1
  s_waitcnt vmcnt(11)
  v_cmp_eq_u32 vcc, -1, v128
  s_cbranch_vccnz reca_retry117
  s_branch reca_resume118
reca_retry117_to:
  s_mov_b32 s18, 0
  s_waitcnt vmcnt(0)
  s_branch reca_resume118
reca_retry119:
  s_sub_u32 s18, s18, 1
  s_cbranch_scc1 reca_retry119_to
  buffer_load_dwordx4 v[132:135], v12, s[4:7], s22 offen offset:1024 sc1
  buffer_load_dwordx4 v[136:139], v12, s[4:7], s22 offen offset:2048 sc1
  buffer_load_dwordx4 v[140:143], v12, s[4:7], s22 offen offset:3072 sc1
  buffer_load_dwordx4 v[144:147], v13, s[4:7], s22 offen offset:0 sc1
  buffer_load_dwordx4 v[148:151], v13, s[4:7], s22 offen offset:1024 sc1
  buffer_load_dwordx4 v[152:155], v13, s[4:7], s22 offen offset:2048 sc1
  buffer_load_dwordx4 v[156:159], v13, s[4:7], s22 offen offset:3072 sc1
  buffer_load_dwordx4 v[160:163], v14, s[4:7], s22 offen offset:0 sc1
  buffer_load_dwordx4 v[164:167], v14, s[4:7], s22 offen offset:1024 sc1
  buffer_load_dwordx4 v[168:171], v14, s[4:7], s22 offen offset:2048 sc1
  buffer_load_dwordx4 v[172:175], v14, s[4:7], s22 offen offset:3072 sc1
  s_waitcnt vmcnt(10)
  v_cmp_eq_u32 vcc, -1, v132
  s_cbranch_vccnz reca_retry119
  s_branch reca_resume120
reca_retry119_to:
  s_mov_b32 s18, 0
  s_waitcnt vmcnt(0)
  s_branch reca_resume120
reca_retry121:
  s_sub_u32 s18, s18, 1
  s_cbranch_scc1 reca_retry121_to
  buffer_load_dwordx4 v[136:139], v12, s[4:7], s22 offen offset:2048 sc1
  buffer_load_dwordx4 v[140:143], v12, s[4:7], s22 offen offset:3072 sc1
  buffer_load_dwordx4 v[144:147], v13, s[4:7], s22 offen offset:0 sc1
  buffer_load_dwordx4 v[148:151], v13, s[4:7], s22 offen offset:1024 sc1
  buffer_load_dwordx4 v[152:155], v13, s[4:7], s22 offen offset:2048 sc1
  buffer_load_dwordx4 v[156:159], v13, s[4:7], s22 offen offset:3072 sc1
  buffer_load_dwordx4 v[160:163], v14, s[4:7], s22 offen offset:0 sc1
  buffer_load_dwordx4 v[164:167], v14, s[4:7], s22 offen offset:1024 sc1
  buffer_load_dwordx4 v[168:171], v14, s[4:7], s22 offen offset:2048 sc1
  buffer_load_dwordx4 v[172:175], v14, s[4:7], s22 offen offset:3072 sc1
  s_waitcnt vmcnt(9)
  v_cmp_eq_u32 vcc, -1, v136
  s_cbranch_vccnz reca_retry121
  s_branch reca_resume122
reca_retry121_to:
  s_mov_b32 s18, 0
  s_waitcnt vmcnt(0)
  s_branch reca_resume122
reca_retry123:
  s_sub_u32 s18, s18, 1
  s_cbranch_scc1 reca_retry123_to
  buffer_load_dwordx4 v[140:143], v12, s[4:7], s22 offen offset:3072 sc1
  buffer_load_dwordx4 v[144:147], v13, s[4:7], s22 offen offset:0 sc1
  buffer_load_dwordx4 v[148:151], v13, s[4:7], s22 offen offset:1024 sc1
  buffer_load_dwordx4 v[152:155], v13, s[4:7], s22 offen offset:2048 sc1
  buffer_load_dwordx4 v[156:159], v13, s[4:7], s22 offen offset:3072 sc1
  buffer_load_dwordx4 v[160:163], v14, s[4:7], s22 offen offset:0 sc1
  buffer_load_dwordx4 v[164:167], v14, s[4:7], s22 offen offset:1024 sc1
  buffer_load_dwordx4 v[168:171], v14, s[4:7], s22 offen offset:2048 sc1
  buffer_load_dwordx4 v[172:175], v14, s[4:7], s22 offen offset:3072 sc1
  s_waitcnt vmcnt(8)
  v_cmp_eq_u32 vcc, -1, v140
  s_cbranch_vccnz reca_retry123
  s_branch reca_resume124
reca_retry123_to:
  s_mov_b32 s18, 0
  s_waitcnt vmcnt(0)
  s_branch reca_resume124
reca_retry125:
  s_sub_u32 s18, s18, 1
  s_cbranch_scc1 reca_retry125_to
  buffer_load_dwordx4 v[144:147], v13, s[4:7], s22 offen offset:0 sc1
  buffer_load_dwordx4 v[148:151], v13, s[4:7], s22 offen offset:1024 sc1
  buffer_load_dwordx4 v[152:155], v13, s[4:7], s22 offen offset:2048 sc1
  buffer_load_dwordx4 v[156:159], v13, s[4:7], s22 offen offset:3072 sc1
  buffer_load_dwordx4 v[160:163], v14, s[4:7], s22 offen offset:0 sc1
  buffer_load_dwordx4 v[164:167], v14, s[4:7], s22 offen offset:1024 sc1
  buffer_load_dwordx4 v[168:171], v14, s[4:7], s22 offen offset:2048 sc1
  buffer_load_dwordx4 v[172:175], v14, s[4:7], s22 offen offset:3072 sc1
  s_waitcnt vmcnt(7)
  v_cmp_eq_u32 vcc, -1, v144
  s_cbranch_vccnz reca_retry125
  s_branch reca_resume126
reca_retry125_to:
  s_mov_b32 s18, 0
  s_waitcnt vmcnt(0)
  s_branch reca_resume126
reca_retry127:
  s_sub_u32 s18, s18, 1
  s_cbranch_scc1 reca_retry127_to
  buffer_load_dwordx4 v[148:151], v13, s[4:7], s22 offen offset:1024 sc1
  buffer_load_dwordx4 v[152:155], v13, s[4:7], s22 offen offset:2048 sc1
  buffer_load_dwordx4 v[156:159], v13, s[4:7], s22 offen offset:3072 sc1
  buffer_load_dwordx4 v[160:163], v14, s[4:7], s22 offen offset:0 sc1
  buffer_load_dwordx4 v[164:167], v14, s[4:7], s22 offen offset:1024 sc1
  buffer_load_dwordx4 v[168:171], v14, s[4:7], s22 offen offset:2048 sc1
  buffer_load_dwordx4 v[172:175], v14, s[4:7], s22 offen offset:3072 sc1
  s_waitcnt vmcnt(6)
  v_cmp_eq_u32 vcc, -1, v148
  s_cbranch_vccnz reca_retry127
  s_branch reca_resume128
reca_retry127_to:
  s_mov_b32 s18, 0
  s_waitcnt vmcnt(0)
  s_branch reca_resume128
reca_retry129:
  s_sub_u32 s18, s18, 1
  s_cbranch_scc1 reca_retry129_to
  buffer_load_dwordx4 v[152:155], v13, s[4:7], s22 offen offset:2048 sc1
  buffer_load_dwordx4 v[156:159], v13, s[4:7], s22 offen offset:3072 sc1
  buffer_load_dwordx4 v[160:163], v14, s[4:7], s22 offen offset:0 sc1
  buffer_load_dwordx4 v[164:167], v14, s[4:7], s22 offen offset:1024 sc1
  buffer_load_dwordx4 v[168:171], v14, s[4:7], s22 offen offset:2048 sc1
  buffer_load_dwordx4 v[172:175], v14, s[4:7], s22 offen offset:3072 sc1
  s_waitcnt vmcnt(5)
  v_cmp_eq_u32 vcc, -1, v152
  s_cbranch_vccnz reca_retry129
  s_branch reca_resume130
reca_retry129_to:
  s_mov_b32 s18, 0
  s_waitcnt vmcnt(0)
  s_branch reca_resume130
reca_retry131:
  s_sub_u32 s18, s18, 1
  s_cbranch_scc1 reca_retry131_to
  buffer_load_dwordx4 v[156:159], v13, s[4:7], s22 offen offset:3072 sc1
  buffer_load_dwordx4 v[160:163], v14, s[4:7], s22 offen offset:0 sc1
  buffer_load_dwordx4 v[164:167], v14, s[4:7], s22 offen offset:1024 sc1
  buffer_load_dwordx4 v[168:171], v14, s[4:7], s22 offen offset:2048 sc1
  buffer_load_dwordx4 v[172:175], v14, s[4:7], s22 offen offset:3072 sc1
  s_waitcnt vmcnt(4)
  v_cmp_eq_u32 vcc, -1, v156
  s_cbranch_vccnz reca_retry131
  s_branch reca_resume132
reca_retry131_to:
  s_mov_b32 s18, 0
  s_waitcnt vmcnt(0)
  s_branch reca_resume132
reca_retry133:
  s_sub_u32 s18, s18, 1
  s_cbranch_scc1 reca_retry133_to
  buffer_load_dwordx4 v[160:163], v14, s[4:7], s22 offen offset:0 sc1
  buffer_load_dwordx4 v[164:167], v14, s[4:7], s22 offen offset:1024 sc1
  buffer_load_dwordx4 v[168:171], v14, s[4:7], s22 offen offset:2048 sc1
  buffer_load_dwordx4 v[172:175], v14, s[4:7], s22 offen offset:3072 sc1
  s_waitcnt vmcnt(3)
  v_cmp_eq_u32 vcc, -1, v160
  s_cbranch_vccnz reca_retry133
  s_branch reca_resume134
reca_retry133_to:
  s_mov_b32 s18, 0
  s_waitcnt vmcnt(0)
  s_branch reca_resume134
reca_retry135:
  s_sub_u32 s18, s18, 1
  s_cbranch_scc1 reca_retry135_to
  buffer_load_dwordx4 v[164:167], v14, s[4:7], s22 offen offset:1024 sc1
  buffer_load_dwordx4 v[168:171], v14, s[4:7], s22 offen offset:2048 sc1
  buffer_load_dwordx4 v[172:175], v14, s[4:7], s22 offen offset:3072 sc1
  s_waitcnt vmcnt(2)
  v_cmp_eq_u32 vcc, -1, v164
  s_cbranch_vccnz reca_retry135
  s_branch reca_resume136
reca_retry135_to:
  s_mov_b32 s18, 0
  s_waitcnt vmcnt(0)
  s_branch reca_resume136
reca_retry137:
  s_sub_u32 s18, s18, 1
  s_cbranch_scc1 reca_retry137_to
  buffer_load_dwordx4 v[168:171], v14, s[4:7], s22 offen offset:2048 sc1
  buffer_load_dwordx4 v[172:175], v14, s[4:7], s22 offen offset:3072 sc1
  s_waitcnt vmcnt(1)
  v_cmp_eq_u32 vcc, -1, v168
  s_cbranch_vccnz reca_retry137
  s_branch reca_resume138
reca_retry137_to:
  s_mov_b32 s18, 0
  s_waitcnt vmcnt(0)
  s_branch reca_resume138
reca_retry139:
  s_sub_u32 s18, s18, 1
  s_cbranch_scc1 reca_retry139_to
  buffer_load_dwordx4 v[172:175], v14, s[4:7], s22 offen offset:3072 sc1
  s_waitcnt vmcnt(0)
  v_cmp_eq_u32 vcc, -1, v172
  s_cbranch_vccnz reca_retry139
  s_branch reca_resume140
reca_retry139_to:
  s_mov_b32 s18, 0
  s_waitcnt vmcnt(0)
  s_branch reca_resume140
reca_retry142:
  s_sub_u32 s18, s18, 1
  s_cbranch_scc1 reca_retry142_to
  buffer_load_dwordx4 v[128:131], v20, s[4:7], s25 offen sc1
  buffer_load_dwordx4 v[132:135], v21, s[4:7], s25 offen sc1
  buffer_load_dwordx4 v[136:139], v22, s[4:7], s25 offen sc1
  buffer_load_dwordx4 v[140:143], v23, s[4:7], s25 offen sc1
  buffer_load_dwordx4 v[144:147], v24, s[4:7], s25 offen sc1
  buffer_load_dwordx4 v[148:151], v25, s[4:7], s25 offen sc1
  buffer_load_dwordx4 v[152:155], v26, s[4:7], s25 offen sc1
  buffer_load_dwordx4 v[156:159], v27, s[4:7], s25 offen sc1
  s_waitcnt vmcnt(7)
  v_cmp_eq_u32 vcc, -1, v128
  s_cbranch_vccnz reca_retry142
  s_branch reca_resume143
reca_retry142_to:
  s_mov_b32 s18, 0
  s_waitcnt vmcnt(0)
  s_branch reca_resume143
reca_retry144:
  s_sub_u32 s18, s18, 1
  s_cbranch_scc1 reca_retry144_to
  buffer_load_dwordx4 v[132:135], v21, s[4:7], s25 offen sc1
  buffer_load_dwordx4 v[136:139], v22, s[4:7], s25 offen sc1
  buffer_load_dwordx4 v[140:143], v23, s[4:7], s25 offen sc1
  buffer_load_dwordx4 v[144:147], v24, s[4:7], s25 offen sc1
  buffer_load_dwordx4 v[148:151], v25, s[4:7], s25 offen sc1
  buffer_load_dwordx4 v[152:155], v26, s[4:7], s25 offen sc1
  buffer_load_dwordx4 v[156:159], v27, s[4:7], s25 offen sc1
  s_waitcnt vmcnt(6)
  v_cmp_eq_u32 vcc, -1, v132
  s_cbranch_vccnz reca_retry144
  s_branch reca_resume145
reca_retry144_to:
  s_mov_b32 s18, 0
  s_waitcnt vmcnt(0)
  s_branch reca_resume145
reca_retry146:
  s_sub_u32 s18, s18, 1
  s_cbranch_scc1 reca_retry146_to
  buffer_load_dwordx4 v[136:139], v22, s[4:7], s25 offen sc1
  buffer_load_dwordx4 v[140:143], v23, s[4:7], s25 offen sc1
  buffer_load_dwordx4 v[144:147], v24, s[4:7], s25 offen sc1
  buffer_load_dwordx4 v[148:151], v25, s[4:7], s25 offen sc1
  buffer_load_dwordx4 v[152:155], v26, s[4:7], s25 offen sc1
  buffer_load_dwordx4 v[156:159], v27, s[4:7], s25 offen sc1
  s_waitcnt vmcnt(5)
  v_cmp_eq_u32 vcc, -1, v136
  s_cbranch_vccnz reca_retry146
  s_branch reca_resume147
reca_retry146_to:
  s_mov_b32 s18, 0
  s_waitcnt vmcnt(0)
  s_branch reca_resume147
reca_retry148:
  s_sub_u32 s18, s18, 1
  s_cbranch_scc1 reca_retry148_to
  buffer_load_dwordx4 v[140:143], v23, s[4:7], s25 offen sc1
  buffer_load_dwordx4 v[144:147], v24, s[4:7], s25 offen sc1
  buffer_load_dwordx4 v[148:151], v25, s[4:7], s25 offen sc1
  buffer_load_dwordx4 v[152:155], v26, s[4:7], s25 offen sc1
  buffer_load_dwordx4 v[156:159], v27, s[4:7], s25 offen sc1
  s_waitcnt vmcnt(4)
  v_cmp_eq_u32 vcc, -1, v140
  s_cbranch_vccnz reca_retry148
  s_branch reca_resume149
reca_retry148_to:
  s_mov_b32 s18, 0
  s_waitcnt vmcnt(0)
  s_branch reca_resume149
reca_retry150:
  s_sub_u32 s18, s18, 1
  s_cbranch_scc1 reca_retry150_to
  buffer_load_dwordx4 v[144:147], v24, s[4:7], s25 offen sc1
  buffer_load_dwordx4 v[148:151], v25, s[4:7], s25 offen sc1
  buffer_load_dwordx4 v[152:155], v26, s[4:7], s25 offen sc1
  buffer_load_dwordx4 v[156:159], v27, s[4:7], s25 offen sc1
  s_waitcnt vmcnt(3)
  v_cmp_eq_u32 vcc, -1, v144
  s_cbranch_vccnz reca_retry150
  s_branch reca_resume151
reca_retry150_to:
  s_mov_b32 s18, 0
  s_waitcnt vmcnt(0)
  s_branch reca_resume151
reca_retry152:
  s_sub_u32 s18, s18, 1
  s_cbranch_scc1 reca_retry152_to
  buffer_load_dwordx4 v[148:151], v25, s[4:7], s25 offen sc1
  buffer_load_dwordx4 v[152:155], v26, s[4:7], s25 offen sc1
  buffer_load_dwordx4 v[156:159], v27, s[4:7], s25 offen sc1
  s_waitcnt vmcnt(2)
  v_cmp_eq_u32 vcc, -1, v148
  s_cbranch_vccnz reca_retry152
  s_branch reca_resume153
reca_retry152_to:
  s_mov_b32 s18, 0
  s_waitcnt vmcnt(0)
  s_branch reca_resume153
reca_retry154:
  s_sub_u32 s18, s18, 1
  s_cbranch_scc1 reca_retry154_to
  buffer_load_dwordx4 v[152:155], v26, s[4:7], s25 offen sc1
  buffer_load_dwordx4 v[156:159], v27, s[4:7], s25 offen sc1
  s_waitcnt vmcnt(1)
  v_cmp_eq_u32 vcc, -1, v152
  s_cbranch_vccnz reca_retry154
  s_branch reca_resume155
reca_retry154_to:
  s_mov_b32 s18, 0
  s_waitcnt vmcnt(0)
  s_branch reca_resume155
reca_retry156:
  s_sub_u32 s18, s18, 1
  s_cbranch_scc1 reca_retry156_to
  buffer_load_dwordx4 v[156:159], v27, s[4:7], s25 offen sc1
  s_waitcnt vmcnt(0)
  v_cmp_eq_u32 vcc, -1, v156
  s_cbranch_vccnz reca_retry156
  s_branch reca_resume157
reca_retry156_to:
  s_mov_b32 s18, 0
  s_waitcnt vmcnt(0)
  s_branch reca_resume157
reca_proj2:
  s_sub_u32 s34, s14, 24
  s_lshr_b32 s35, s34, 1
  s_and_b32 s16, s34, 1
  s_lshl_b32 s15, s13, 2
  s_add_u32 s15, s15, s35
  s_lshl_b32 s24, s13, 3
  s_add_u32 s24, s24, s34
  s_lshl_b32 s24, s24, 7
  s_add_u32 s24, s24, 1540096
  s_lshl_b32 s25, s13, 7
  s_add_u32 s25, s25, 1507328
  v_and_b32 v28, 63, v0
  v_lshlrev_b32 v1, 4, v28
  v_mov_b32 v29, 0x80000000
  v_cmp_eq_u32 vcc, 0, v28
  v_mov_b32 v4, 0
  s_nop 0
  v_cndmask_b32 v4, v29, v4, vcc
  s_cmp_eq_u32 s12, 0
  s_cbranch_scc1 reca_pw0_161
  s_cmp_eq_u32 s12, 1
  s_cbranch_scc1 reca_pw1_162
  s_cmp_eq_u32 s12, 2
  s_cbranch_scc1 reca_pw2_163
  s_branch reca_pw3_164
reca_pw0_161:
  s_mov_b32 s17, 0
  s_mov_b32 s26, 0
  s_mul_i32 s20, s17, 40960
  s_add_u32 s20, s20, 153616384
  s_add_u32 m0, s26, 0
  s_nop 0
  buffer_load_dwordx4 v1, s[4:7], s20 offen offset:0 lds
  buffer_load_dwordx4 v1, s[4:7], s20 offen offset:1024 lds
  buffer_load_dwordx4 v1, s[4:7], s20 offen offset:2048 lds
  buffer_load_dwordx4 v1, s[4:7], s20 offen offset:3072 lds
  s_add_u32 s20, s20, 4096
  s_add_u32 m0, s26, 4096
  s_nop 0
  buffer_load_dwordx4 v1, s[4:7], s20 offen offset:0 lds
  buffer_load_dwordx4 v1, s[4:7], s20 offen offset:1024 lds
  buffer_load_dwordx4 v1, s[4:7], s20 offen offset:2048 lds
  buffer_load_dwordx4 v1, s[4:7], s20 offen offset:3072 lds
  s_add_u32 s20, s20, 4096
  s_add_u32 m0, s26, 8192
  s_nop 0
  buffer_load_dwordx4 v1, s[4:7], s20 offen offset:0 lds
  buffer_load_dwordx4 v1, s[4:7], s20 offen offset:1024 lds
  s_lshl_b32 s34, s15, 6
  s_add_u32 s34, s34, s17
  s_mul_i32 s34, s34, 12288
  s_mul_i32 s35, s16, 3072
  s_add_u32 s35, s35, s34
  s_add_u32 s27, s35, 37748736
  s_mul_i32 s35, s16, 6144
  s_add_u32 s35, s35, s34
  s_add_u32 s28, s35, 62914560
  s_add_u32 s34, s27, 0
  buffer_load_dwordx4 v[16:19], v1, s[4:7], s34 offen sc1
  s_add_u32 s34, s27, 6144
  buffer_load_dwordx4 v[16:19], v1, s[4:7], s34 offen sc1
  s_add_u32 s34, s27, 1024
  buffer_load_dwordx4 v[16:19], v1, s[4:7], s34 offen sc1
  s_add_u32 s34, s27, 7168
  buffer_load_dwordx4 v[16:19], v1, s[4:7], s34 offen sc1
  s_add_u32 s34, s28, 0
  buffer_load_dwordx4 v[16:19], v1, s[4:7], s34 offen sc1
  s_mul_i32 s34, s15, 12
  s_mul_i32 s35, s16, 6
  s_add_u32 s34, s34, s35
  s_add_u32 s34, s34, 0
  s_mul_i32 s34, s34, 20480
  s_add_u32 s34, s34, 14155776
  buffer_load_dwordx4 a[0:3], v1, s[4:7], s34 offen offset:0
  buffer_load_dwordx4 a[4:7], v1, s[4:7], s34 offen offset:1024
  buffer_load_dwordx4 a[8:11], v1, s[4:7], s34 offen offset:2048
  buffer_load_dwordx4 a[12:15], v1, s[4:7], s34 offen offset:3072
  s_add_u32 s34, s34, 4096
  buffer_load_dwordx4 a[16:19], v1, s[4:7], s34 offen offset:0
  buffer_load_dwordx4 a[20:23], v1, s[4:7], s34 offen offset:1024
  buffer_load_dwordx4 a[24:27], v1, s[4:7], s34 offen offset:2048
  buffer_load_dwordx4 a[28:31], v1, s[4:7], s34 offen offset:3072
  s_add_u32 s34, s34, 4096
  buffer_load_dwordx4 a[32:35], v1, s[4:7], s34 offen offset:0
  buffer_load_dwordx4 a[36:39], v1, s[4:7], s34 offen offset:1024
  buffer_load_dwordx4 a[40:43], v1, s[4:7], s34 offen offset:2048
  buffer_load_dwordx4 a[44:47], v1, s[4:7], s34 offen offset:3072
  s_add_u32 s34, s34, 4096
  buffer_load_dwordx4 a[48:51], v1, s[4:7], s34 offen offset:0
  buffer_load_dwordx4 a[52:55], v1, s[4:7], s34 offen offset:1024
  buffer_load_dwordx4 a[56:59], v1, s[4:7], s34 offen offset:2048
  buffer_load_dwordx4 a[60:63], v1, s[4:7], s34 offen offset:3072
  s_add_u32 s34, s34, 4096
  buffer_load_dwordx4 a[64:67], v1, s[4:7], s34 offen offset:0
  buffer_load_dwordx4 a[68:71], v1, s[4:7], s34 offen offset:1024
  buffer_load_dwordx4 a[72:75], v1, s[4:7], s34 offen offset:2048
  buffer_load_dwordx4 a[76:79], v1, s[4:7], s34 offen offset:3072
  s_mul_i32 s34, s15, 12
  s_mul_i32 s35, s16, 6
  s_add_u32 s34, s34, s35
  s_add_u32 s34, s34, 1
  s_mul_i32 s34, s34, 20480
  s_add_u32 s34, s34, 14155776
  buffer_load_dwordx4 a[80:83], v1, s[4:7], s34 offen offset:0
  buffer_load_dwordx4 a[84:87], v1, s[4:7], s34 offen offset:1024
  buffer_load_dwordx4 a[88:91], v1, s[4:7], s34 offen offset:2048
  buffer_load_dwordx4 a[92:95], v1, s[4:7], s34 offen offset:3072
  s_add_u32 s34, s34, 4096
  buffer_load_dwordx4 a[96:99], v1, s[4:7], s34 offen offset:0
  buffer_load_dwordx4 a[100:103], v1, s[4:7], s34 offen offset:1024
  buffer_load_dwordx4 a[104:107], v1, s[4:7], s34 offen offset:2048
  buffer_load_dwordx4 a[108:111], v1, s[4:7], s34 offen offset:3072
  s_add_u32 s34, s34, 4096
  buffer_load_dwordx4 a[112:115], v1, s[4:7], s34 offen offset:0
  buffer_load_dwordx4 a[116:119], v1, s[4:7], s34 offen offset:1024
  buffer_load_dwordx4 a[120:123], v1, s[4:7], s34 offen offset:2048
  buffer_load_dwordx4 a[124:127], v1, s[4:7], s34 offen offset:3072
  s_add_u32 s34, s34, 4096
  buffer_load_dwordx4 a[128:131], v1, s[4:7], s34 offen offset:0
  buffer_load_dwordx4 a[132:135], v1, s[4:7], s34 offen offset:1024
  buffer_load_dwordx4 a[136:139], v1, s[4:7], s34 offen offset:2048
  buffer_load_dwordx4 a[140:143], v1, s[4:7], s34 offen offset:3072
  s_add_u32 s34, s34, 4096
  buffer_load_dwordx4 a[144:147], v1, s[4:7], s34 offen offset:0
  buffer_load_dwordx4 a[148:151], v1, s[4:7], s34 offen offset:1024
  buffer_load_dwordx4 a[152:155], v1, s[4:7], s34 offen offset:2048
  buffer_load_dwordx4 a[156:159], v1, s[4:7], s34 offen offset:3072
  s_waitcnt vmcnt(20)
  s_mul_i32 s34, s15, 12
  s_mul_i32 s35, s16, 6
  s_add_u32 s34, s34, s35
  s_add_u32 s34, s34, 2
  s_mul_i32 s34, s34, 20480
  s_add_u32 s34, s34, 14155776
  buffer_load_dwordx4 a[160:163], v1, s[4:7], s34 offen offset:0
  buffer_load_dwordx4 a[164:167], v1, s[4:7], s34 offen offset:1024
  buffer_load_dwordx4 a[168:171], v1, s[4:7], s34 offen offset:2048
  buffer_load_dwordx4 a[172:175], v1, s[4:7], s34 offen offset:3072
  s_add_u32 s34, s34, 4096
  buffer_load_dwordx4 a[176:179], v1, s[4:7], s34 offen offset:0
  buffer_load_dwordx4 a[180:183], v1, s[4:7], s34 offen offset:1024
  buffer_load_dwordx4 a[184:187], v1, s[4:7], s34 offen offset:2048
  buffer_load_dwordx4 a[188:191], v1, s[4:7], s34 offen offset:3072
  s_add_u32 s34, s34, 4096
  buffer_load_dwordx4 a[192:195], v1, s[4:7], s34 offen offset:0
  buffer_load_dwordx4 a[196:199], v1, s[4:7], s34 offen offset:1024
  buffer_load_dwordx4 a[200:203], v1, s[4:7], s34 offen offset:2048
  buffer_load_dwordx4 a[204:207], v1, s[4:7], s34 offen offset:3072
  s_add_u32 s34, s34, 4096
  buffer_load_dwordx4 a[208:211], v1, s[4:7], s34 offen offset:0
  buffer_load_dwordx4 a[212:215], v1, s[4:7], s34 offen offset:1024
  buffer_load_dwordx4 a[216:219], v1, s[4:7], s34 offen offset:2048
  buffer_load_dwordx4 a[220:223], v1, s[4:7], s34 offen offset:3072
  s_add_u32 s34, s34, 4096
  buffer_load_dwordx4 a[224:227], v1, s[4:7], s34 offen offset:0
  buffer_load_dwordx4 a[228:231], v1, s[4:7], s34 offen offset:1024
  buffer_load_dwordx4 a[232:235], v1, s[4:7], s34 offen offset:2048
  buffer_load_dwordx4 a[236:239], v1, s[4:7], s34 offen offset:3072
  s_waitcnt vmcnt(20)
  s_mul_i32 s34, s15, 12
  s_mul_i32 s35, s16, 6
  s_add_u32 s34, s34, s35
  s_add_u32 s34, s34, 3
  s_mul_i32 s34, s34, 20480
  s_add_u32 s34, s34, 14155776
  buffer_load_dwordx4 v[96:99], v1, s[4:7], s34 offen offset:0
  buffer_load_dwordx4 v[100:103], v1, s[4:7], s34 offen offset:1024
  buffer_load_dwordx4 v[104:107], v1, s[4:7], s34 offen offset:2048
  buffer_load_dwordx4 v[108:111], v1, s[4:7], s34 offen offset:3072
  s_add_u32 s34, s34, 4096
  buffer_load_dwordx4 v[112:115], v1, s[4:7], s34 offen offset:0
  buffer_load_dwordx4 v[116:119], v1, s[4:7], s34 offen offset:1024
  buffer_load_dwordx4 v[120:123], v1, s[4:7], s34 offen offset:2048
  buffer_load_dwordx4 v[124:127], v1, s[4:7], s34 offen offset:3072
  s_add_u32 s34, s34, 4096
  buffer_load_dwordx4 v[128:131], v1, s[4:7], s34 offen offset:0
  buffer_load_dwordx4 v[132:135], v1, s[4:7], s34 offen offset:1024
  buffer_load_dwordx4 v[136:139], v1, s[4:7], s34 offen offset:2048
  buffer_load_dwordx4 v[140:143], v1, s[4:7], s34 offen offset:3072
  s_add_u32 s34, s34, 4096
  buffer_load_dwordx4 v[144:147], v1, s[4:7], s34 offen offset:0
  buffer_load_dwordx4 v[148:151], v1, s[4:7], s34 offen offset:1024
  buffer_load_dwordx4 v[152:155], v1, s[4:7], s34 offen offset:2048
  buffer_load_dwordx4 v[156:159], v1, s[4:7], s34 offen offset:3072
  s_add_u32 s34, s34, 4096
  buffer_load_dwordx4 v[160:163], v1, s[4:7], s34 offen offset:0
  buffer_load_dwordx4 v[164:167], v1, s[4:7], s34 offen offset:1024
  buffer_load_dwordx4 v[168:171], v1, s[4:7], s34 offen offset:2048
  buffer_load_dwordx4 v[172:175], v1, s[4:7], s34 offen offset:3072
  s_waitcnt vmcnt(20)
  s_mul_i32 s34, s15, 12
  s_mul_i32 s35, s16, 6
  s_add_u32 s34, s34, s35
  s_add_u32 s34, s34, 0
  s_mul_i32 s34, s34, 20480
  s_add_u32 s34, s34, 22020096
  buffer_load_dwordx4 v[176:179], v1, s[4:7], s34 offen offset:0
  buffer_load_dwordx4 v[180:183], v1, s[4:7], s34 offen offset:1024
  buffer_load_dwordx4 v[184:187], v1, s[4:7], s34 offen offset:2048
  buffer_load_dwordx4 v[188:191], v1, s[4:7], s34 offen offset:3072
  s_add_u32 s34, s34, 4096
  buffer_load_dwordx4 v[192:195], v1, s[4:7], s34 offen offset:0
  buffer_load_dwordx4 v[196:199], v1, s[4:7], s34 offen offset:1024
  buffer_load_dwordx4 v[200:203], v1, s[4:7], s34 offen offset:2048
  buffer_load_dwordx4 v[204:207], v1, s[4:7], s34 offen offset:3072
  s_add_u32 s34, s34, 4096
  buffer_load_dwordx4 v[208:211], v1, s[4:7], s34 offen offset:0
  buffer_load_dwordx4 v[212:215], v1, s[4:7], s34 offen offset:1024
  buffer_load_dwordx4 v[216:219], v1, s[4:7], s34 offen offset:2048
  buffer_load_dwordx4 v[220:223], v1, s[4:7], s34 offen offset:3072
  s_add_u32 s34, s34, 4096
  buffer_load_dwordx4 v[224:227], v1, s[4:7], s34 offen offset:0
  buffer_load_dwordx4 v[228:231], v1, s[4:7], s34 offen offset:1024
  buffer_load_dwordx4 v[232:235], v1, s[4:7], s34 offen offset:2048
  buffer_load_dwordx4 v[236:239], v1, s[4:7], s34 offen offset:3072
  s_add_u32 s34, s34, 4096
  buffer_load_dwordx4 v[240:243], v1, s[4:7], s34 offen offset:0
  buffer_load_dwordx4 v[244:247], v1, s[4:7], s34 offen offset:1024
  buffer_load_dwordx4 v[248:251], v1, s[4:7], s34 offen offset:2048
  buffer_load_dwordx4 v[252:255], v1, s[4:7], s34 offen offset:3072
  s_waitcnt vmcnt(20)
  s_lshl_b32 s34, s13, 3
  v_mov_b32 v30, s34
reca_cens165:
  buffer_load_dwordx2 v[28:29], v30, s[8:11], 0 offen sc1
  s_waitcnt vmcnt(0)
  v_readfirstlane_b32 s35, v28
  v_readfirstlane_b32 s36, v29
  v_sad_u8 v28, v28, 0, 0
  v_sad_u8 v28, v29, 0, v28
  s_nop 0
  v_readfirstlane_b32 s34, v28
  s_nop 3
  s_cmp_ge_u32 s34, 32
  s_cbranch_scc1 reca_censok166
  s_sleep 8
  s_sub_u32 s18, s18, 1
  s_cbranch_scc0 reca_cens165
  s_mov_b32 s18, 0
reca_censok166:
  s_lshl_b32 s34, s42, 3
  s_mov_b32 s37, s36
  s_mov_b32 s36, s35
  s_lshr_b64 s[36:37], s[36:37], s34
  s_and_b32 s36, s36, 0xff
  s_cmp_eq_u32 s36, 32
  s_cselect_b32 s43, 0, 1
  s_cmp_lg_u32 s43, 0
  s_cbranch_scc1 reca_pslow167
reca_ptop168:
  s_cmp_lt_u32 s17, 6
  s_cbranch_scc1 reca_pgo169
  s_sub_u32 s36, s17, 6
reca_ppoll170:
  buffer_load_dword v28, v4, s[4:7], s25 offen sc1
  s_waitcnt vmcnt(0)
  v_readfirstlane_b32 s34, v28
  s_nop 3
  s_cmp_ge_i32 s34, s36
  s_cbranch_scc1 reca_pgo169
  s_sleep 8
  s_sub_u32 s18, s18, 1
  s_cbranch_scc0 reca_ppoll170
  s_mov_b32 s18, 0
reca_pgo169:
  s_waitcnt vmcnt(0)
  s_barrier
  v_add_u32 v7, s26, v1
  s_xor_b32 s26, s26, 40960
  s_add_u32 s37, s17, 1
  s_cmp_ge_u32 s37, 64
  s_cbranch_scc1 reca_pnodma171
  s_mul_i32 s20, s37, 40960
  s_add_u32 s20, s20, 153616384
  s_add_u32 m0, s26, 0
  s_nop 0
  buffer_load_dwordx4 v1, s[4:7], s20 offen offset:0 lds
  buffer_load_dwordx4 v1, s[4:7], s20 offen offset:1024 lds
  buffer_load_dwordx4 v1, s[4:7], s20 offen offset:2048 lds
  buffer_load_dwordx4 v1, s[4:7], s20 offen offset:3072 lds
  s_add_u32 s20, s20, 4096
  s_add_u32 m0, s26, 4096
  s_nop 0
  buffer_load_dwordx4 v1, s[4:7], s20 offen offset:0 lds
  buffer_load_dwordx4 v1, s[4:7], s20 offen offset:1024 lds
  buffer_load_dwordx4 v1, s[4:7], s20 offen offset:2048 lds
  buffer_load_dwordx4 v1, s[4:7], s20 offen offset:3072 lds
  s_add_u32 s20, s20, 4096
  s_add_u32 m0, s26, 8192
  s_nop 0
  buffer_load_dwordx4 v1, s[4:7], s20 offen offset:0 lds
  buffer_load_dwordx4 v1, s[4:7], s20 offen offset:1024 lds
  s_lshl_b32 s34, s15, 6
  s_add_u32 s34, s34, s37
  s_mul_i32 s34, s34, 12288
  s_mul_i32 s35, s16, 3072
  s_add_u32 s35, s35, s34
  s_add_u32 s27, s35, 37748736
  s_mul_i32 s35, s16, 6144
  s_add_u32 s35, s35, s34
  s_add_u32 s28, s35, 62914560
  s_add_u32 s34, s27, 0
  buffer_load_dwordx4 v[16:19], v1, s[4:7], s34 offen sc1
  s_add_u32 s34, s27, 6144
  buffer_load_dwordx4 v[16:19], v1, s[4:7], s34 offen sc1
  s_add_u32 s34, s27, 1024
  buffer_load_dwordx4 v[16:19], v1, s[4:7], s34 offen sc1
  s_add_u32 s34, s27, 7168
  buffer_load_dwordx4 v[16:19], v1, s[4:7], s34 offen sc1
  s_add_u32 s34, s28, 0
  buffer_load_dwordx4 v[16:19], v1, s[4:7], s34 offen sc1
reca_pnodma171:
  s_lshl_b32 s34, s15, 6
  s_add_u32 s34, s34, s17
  s_mul_i32 s34, s34, 12288
  s_mul_i32 s35, s16, 3072
  s_add_u32 s35, s35, s34
  s_add_u32 s21, s35, 37748736
  s_add_u32 s22, s35, 88080384
  s_mul_i32 s35, s16, 6144
  s_add_u32 s35, s35, s34
  s_add_u32 s23, s35, 62914560
  ds_read_b128 v[72:75], v7 offset:0
  ds_read_b128 v[76:79], v7 offset:20480
  ds_read_b128 v[80:83], v7 offset:1024
  ds_read_b128 v[84:87], v7 offset:21504
  ds_read_b128 v[88:91], v7 offset:2048
  ds_read_b128 v[92:95], v7 offset:22528
  s_waitcnt lgkmcnt(4)
  v_mfma_f32_16x16x32_bf16 v[32:35], a[0:3], v[72:75], 0
  v_mfma_f32_16x16x32_bf16 v[36:39], a[0:3], v[76:79], 0
  v_mfma_f32_16x16x32_bf16 v[40:43], a[80:83], v[72:75], 0
  v_mfma_f32_16x16x32_bf16 v[44:47], a[80:83], v[76:79], 0
  v_mfma_f32_16x16x32_bf16 v[48:51], a[160:163], v[72:75], 0
  v_mfma_f32_16x16x32_bf16 v[52:55], a[160:163], v[76:79], 0
  v_mfma_f32_16x16x32_bf16 v[56:59], v[96:99], v[72:75], 0
  v_mfma_f32_16x16x32_bf16 v[60:63], v[96:99], v[76:79], 0
  v_mfma_f32_16x16x32_bf16 v[64:67], v[72:75], v[176:179], 0
  v_mfma_f32_16x16x32_bf16 v[68:71], v[76:79], v[176:179], 0
  ds_read_b128 v[72:75], v7 offset:3072
  ds_read_b128 v[76:79], v7 offset:23552
  s_waitcnt lgkmcnt(4)
  v_mfma_f32_16x16x32_bf16 v[32:35], a[4:7], v[80:83], v[32:35]
  v_mfma_f32_16x16x32_bf16 v[36:39], a[4:7], v[84:87], v[36:39]
  v_mfma_f32_16x16x32_bf16 v[40:43], a[84:87], v[80:83], v[40:43]
  v_mfma_f32_16x16x32_bf16 v[44:47], a[84:87], v[84:87], v[44:47]
  v_mfma_f32_16x16x32_bf16 v[48:51], a[164:167], v[80:83], v[48:51]
  v_mfma_f32_16x16x32_bf16 v[52:55], a[164:167], v[84:87], v[52:55]
  v_mfma_f32_16x16x32_bf16 v[56:59], v[100:103], v[80:83], v[56:59]
  v_mfma_f32_16x16x32_bf16 v[60:63], v[100:103], v[84:87], v[60:63]
  v_mfma_f32_16x16x32_bf16 v[64:67], v[80:83], v[180:183], v[64:67]
  v_mfma_f32_16x16x32_bf16 v[68:71], v[84:87], v[180:183], v[68:71]
  ds_read_b128 v[80:83], v7 offset:4096
  ds_read_b128 v[84:87], v7 offset:24576
  s_waitcnt lgkmcnt(4)
  v_mfma_f32_16x16x32_bf16 v[32:35], a[8:11], v[88:91], v[32:35]
  v_mfma_f32_16x16x32_bf16 v[36:39], a[8:11], v[92:95], v[36:39]
  v_mfma_f32_16x16x32_bf16 v[40:43], a[88:91], v[88:91], v[40:43]
  v_mfma_f32_16x16x32_bf16 v[44:47], a[88:91], v[92:95], v[44:47]
  v_mfma_f32_16x16x32_bf16 v[48:51], a[168:171], v[88:91], v[48:51]
  v_mfma_f32_16x16x32_bf16 v[52:55], a[168:171], v[92:95], v[52:55]
  v_mfma_f32_16x16x32_bf16 v[56:59], v[104:107], v[88:91], v[56:59]
  v_mfma_f32_16x16x32_bf16 v[60:63], v[104:107], v[92:95], v[60:63]
  v_mfma_f32_16x16x32_bf16 v[64:67], v[88:91], v[184:187], v[64:67]
  v_mfma_f32_16x16x32_bf16 v[68:71], v[92:95], v[184:187], v[68:71]
  ds_read_b128 v[88:91], v7 offset:5120
  ds_read_b128 v[92:95], v7 offset:25600
  s_waitcnt lgkmcnt(4)
  v_mfma_f32_16x16x32_bf16 v[32:35], a[12:15], v[72:75], v[32:35]
  v_mfma_f32_16x16x32_bf16 v[36:39], a[12:15], v[76:79], v[36:39]
  v_mfma_f32_16x16x32_bf16 v[40:43], a[92:95], v[72:75], v[40:43]
  v_mfma_f32_16x16x32_bf16 v[44:47], a[92:95], v[76:79], v[44:47]
  v_mfma_f32_16x16x32_bf16 v[48:51], a[172:175], v[72:75], v[48:51]
  v_mfma_f32_16x16x32_bf16 v[52:55], a[172:175], v[76:79], v[52:55]
  v_mfma_f32_16x16x32_bf16 v[56:59], v[108:111], v[72:75], v[56:59]
  v_mfma_f32_16x16x32_bf16 v[60:63], v[108:111], v[76:79], v[60:63]
  v_mfma_f32_16x16x32_bf16 v[64:67], v[72:75], v[188:191], v[64:67]
  v_mfma_f32_16x16x32_bf16 v[68:71], v[76:79], v[188:191], v[68:71]
  ds_read_b128 v[72:75], v7 offset:6144
  ds_read_b128 v[76:79], v7 offset:26624
  s_waitcnt lgkmcnt(4)
  v_mfma_f32_16x16x32_bf16 v[32:35], a[16:19], v[80:83], v[32:35]
  v_mfma_f32_16x16x32_bf16 v[36:39], a[16:19], v[84:87], v[36:39]
  v_mfma_f32_16x16x32_bf16 v[40:43], a[96:99], v[80:83], v[40:43]
  v_mfma_f32_16x16x32_bf16 v[44:47], a[96:99], v[84:87], v[44:47]
  v_mfma_f32_16x16x32_bf16 v[48:51], a[176:179], v[80:83], v[48:51]
  v_mfma_f32_16x16x32_bf16 v[52:55], a[176:179], v[84:87], v[52:55]
  v_mfma_f32_16x16x32_bf16 v[56:59], v[112:115], v[80:83], v[56:59]
  v_mfma_f32_16x16x32_bf16 v[60:63], v[112:115], v[84:87], v[60:63]
  v_mfma_f32_16x16x32_bf16 v[64:67], v[80:83], v[192:195], v[64:67]
  v_mfma_f32_16x16x32_bf16 v[68:71], v[84:87], v[192:195], v[68:71]
  ds_read_b128 v[80:83], v7 offset:7168
  ds_read_b128 v[84:87], v7 offset:27648
  s_waitcnt lgkmcnt(4)
  v_mfma_f32_16x16x32_bf16 v[32:35], a[20:23], v[88:91], v[32:35]
  v_mfma_f32_16x16x32_bf16 v[36:39], a[20:23], v[92:95], v[36:39]
  v_mfma_f32_16x16x32_bf16 v[40:43], a[100:103], v[88:91], v[40:43]
  v_mfma_f32_16x16x32_bf16 v[44:47], a[100:103], v[92:95], v[44:47]
  v_mfma_f32_16x16x32_bf16 v[48:51], a[180:183], v[88:91], v[48:51]
  v_mfma_f32_16x16x32_bf16 v[52:55], a[180:183], v[92:95], v[52:55]
  v_mfma_f32_16x16x32_bf16 v[56:59], v[116:119], v[88:91], v[56:59]
  v_mfma_f32_16x16x32_bf16 v[60:63], v[116:119], v[92:95], v[60:63]
  v_mfma_f32_16x16x32_bf16 v[64:67], v[88:91], v[196:199], v[64:67]
  v_mfma_f32_16x16x32_bf16 v[68:71], v[92:95], v[196:199], v[68:71]
  ds_read_b128 v[88:91], v7 offset:8192
  ds_read_b128 v[92:95], v7 offset:28672
  s_waitcnt lgkmcnt(4)
  v_mfma_f32_16x16x32_bf16 v[32:35], a[24:27], v[72:75], v[32:35]
  v_mfma_f32_16x16x32_bf16 v[36:39], a[24:27], v[76:79], v[36:39]
  v_mfma_f32_16x16x32_bf16 v[40:43], a[104:107], v[72:75], v[40:43]
  v_mfma_f32_16x16x32_bf16 v[44:47], a[104:107], v[76:79], v[44:47]
  v_mfma_f32_16x16x32_bf16 v[48:51], a[184:187], v[72:75], v[48:51]
  v_mfma_f32_16x16x32_bf16 v[52:55], a[184:187], v[76:79], v[52:55]
  v_mfma_f32_16x16x32_bf16 v[56:59], v[120:123], v[72:75], v[56:59]
  v_mfma_f32_16x16x32_bf16 v[60:63], v[120:123], v[76:79], v[60:63]
  v_mfma_f32_16x16x32_bf16 v[64:67], v[72:75], v[200:203], v[64:67]
  v_mfma_f32_16x16x32_bf16 v[68:71], v[76:79], v[200:203], v[68:71]
  ds_read_b128 v[72:75], v7 offset:9216
  ds_read_b128 v[76:79], v7 offset:29696
  s_waitcnt lgkmcnt(4)
  v_mfma_f32_16x16x32_bf16 v[32:35], a[28:31], v[80:83], v[32:35]
  v_mfma_f32_16x16x32_bf16 v[36:39], a[28:31], v[84:87], v[36:39]
  v_mfma_f32_16x16x32_bf16 v[40:43], a[108:111], v[80:83], v[40:43]
  v_mfma_f32_16x16x32_bf16 v[44:47], a[108:111], v[84:87], v[44:47]
  v_mfma_f32_16x16x32_bf16 v[48:51], a[188:191], v[80:83], v[48:51]
  v_mfma_f32_16x16x32_bf16 v[52:55], a[188:191], v[84:87], v[52:55]
  v_mfma_f32_16x16x32_bf16 v[56:59], v[124:127], v[80:83], v[56:59]
  v_mfma_f32_16x16x32_bf16 v[60:63], v[124:127], v[84:87], v[60:63]
  v_mfma_f32_16x16x32_bf16 v[64:67], v[80:83], v[204:207], v[64:67]
  v_mfma_f32_16x16x32_bf16 v[68:71], v[84:87], v[204:207], v[68:71]
  ds_read_b128 v[80:83], v7 offset:10240
  ds_read_b128 v[84:87], v7 offset:30720
  s_waitcnt lgkmcnt(4)
  v_mfma_f32_16x16x32_bf16 v[32:35], a[32:35], v[88:91], v[32:35]
  v_mfma_f32_16x16x32_bf16 v[36:39], a[32:35], v[92:95], v[36:39]
  v_mfma_f32_16x16x32_bf16 v[40:43], a[112:115], v[88:91], v[40:43]
  v_mfma_f32_16x16x32_bf16 v[44:47], a[112:115], v[92:95], v[44:47]
  v_mfma_f32_16x16x32_bf16 v[48:51], a[192:195], v[88:91], v[48:51]
  v_mfma_f32_16x16x32_bf16 v[52:55], a[192:195], v[92:95], v[52:55]
  v_mfma_f32_16x16x32_bf16 v[56:59], v[128:131], v[88:91], v[56:59]
  v_mfma_f32_16x16x32_bf16 v[60:63], v[128:131], v[92:95], v[60:63]
  v_mfma_f32_16x16x32_bf16 v[64:67], v[88:91], v[208:211], v[64:67]
  v_mfma_f32_16x16x32_bf16 v[68:71], v[92:95], v[208:211], v[68:71]
  ds_read_b128 v[88:91], v7 offset:11264
  ds_read_b128 v[92:95], v7 offset:31744
  s_waitcnt lgkmcnt(4)
  v_mfma_f32_16x16x32_bf16 v[32:35], a[36:39], v[72:75], v[32:35]
  v_mfma_f32_16x16x32_bf16 v[36:39], a[36:39], v[76:79], v[36:39]
  v_mfma_f32_16x16x32_bf16 v[40:43], a[116:119], v[72:75], v[40:43]
  v_mfma_f32_16x16x32_bf16 v[44:47], a[116:119], v[76:79], v[44:47]
  v_mfma_f32_16x16x32_bf16 v[48:51], a[196:199], v[72:75], v[48:51]
  v_mfma_f32_16x16x32_bf16 v[52:55], a[196:199], v[76:79], v[52:55]
  v_mfma_f32_16x16x32_bf16 v[56:59], v[132:135], v[72:75], v[56:59]
  v_mfma_f32_16x16x32_bf16 v[60:63], v[132:135], v[76:79], v[60:63]
  v_mfma_f32_16x16x32_bf16 v[64:67], v[72:75], v[212:215], v[64:67]
  v_mfma_f32_16x16x32_bf16 v[68:71], v[76:79], v[212:215], v[68:71]
  ds_read_b128 v[72:75], v7 offset:12288
  ds_read_b128 v[76:79], v7 offset:32768
  s_waitcnt lgkmcnt(4)
  v_mfma_f32_16x16x32_bf16 v[32:35], a[40:43], v[80:83], v[32:35]
  v_mfma_f32_16x16x32_bf16 v[36:39], a[40:43], v[84:87], v[36:39]
  v_mfma_f32_16x16x32_bf16 v[40:43], a[120:123], v[80:83], v[40:43]
  v_mfma_f32_16x16x32_bf16 v[44:47], a[120:123], v[84:87], v[44:47]
  v_mfma_f32_16x16x32_bf16 v[48:51], a[200:203], v[80:83], v[48:51]
  v_mfma_f32_16x16x32_bf16 v[52:55], a[200:203], v[84:87], v[52:55]
  v_mfma_f32_16x16x32_bf16 v[56:59], v[136:139], v[80:83], v[56:59]
  v_mfma_f32_16x16x32_bf16 v[60:63], v[136:139], v[84:87], v[60:63]
  v_mfma_f32_16x16x32_bf16 v[64:67], v[80:83], v[216:219], v[64:67]
  v_mfma_f32_16x16x32_bf16 v[68:71], v[84:87], v[216:219], v[68:71]
  ds_read_b128 v[80:83], v7 offset:13312
  ds_read_b128 v[84:87], v7 offset:33792
  s_waitcnt lgkmcnt(4)
  v_mfma_f32_16x16x32_bf16 v[32:35], a[44:47], v[88:91], v[32:35]
  v_mfma_f32_16x16x32_bf16 v[36:39], a[44:47], v[92:95], v[36:39]
  v_mfma_f32_16x16x32_bf16 v[40:43], a[124:127], v[88:91], v[40:43]
  v_mfma_f32_16x16x32_bf16 v[44:47], a[124:127], v[92:95], v[44:47]
  v_mfma_f32_16x16x32_bf16 v[48:51], a[204:207], v[88:91], v[48:51]
  v_mfma_f32_16x16x32_bf16 v[52:55], a[204:207], v[92:95], v[52:55]
  v_mfma_f32_16x16x32_bf16 v[56:59], v[140:143], v[88:91], v[56:59]
  v_mfma_f32_16x16x32_bf16 v[60:63], v[140:143], v[92:95], v[60:63]
  v_mfma_f32_16x16x32_bf16 v[64:67], v[88:91], v[220:223], v[64:67]
  v_mfma_f32_16x16x32_bf16 v[68:71], v[92:95], v[220:223], v[68:71]
  ds_read_b128 v[88:91], v7 offset:14336
  ds_read_b128 v[92:95], v7 offset:34816
  s_waitcnt lgkmcnt(4)
  v_mfma_f32_16x16x32_bf16 v[32:35], a[48:51], v[72:75], v[32:35]
  v_mfma_f32_16x16x32_bf16 v[36:39], a[48:51], v[76:79], v[36:39]
  v_mfma_f32_16x16x32_bf16 v[40:43], a[128:131], v[72:75], v[40:43]
  v_mfma_f32_16x16x32_bf16 v[44:47], a[128:131], v[76:79], v[44:47]
  v_mfma_f32_16x16x32_bf16 v[48:51], a[208:211], v[72:75], v[48:51]
  v_mfma_f32_16x16x32_bf16 v[52:55], a[208:211], v[76:79], v[52:55]
  v_mfma_f32_16x16x32_bf16 v[56:59], v[144:147], v[72:75], v[56:59]
  v_mfma_f32_16x16x32_bf16 v[60:63], v[144:147], v[76:79], v[60:63]
  v_mfma_f32_16x16x32_bf16 v[64:67], v[72:75], v[224:227], v[64:67]
  v_mfma_f32_16x16x32_bf16 v[68:71], v[76:79], v[224:227], v[68:71]
  ds_read_b128 v[72:75], v7 offset:15360
  ds_read_b128 v[76:79], v7 offset:35840
  s_waitcnt lgkmcnt(4)
  v_mfma_f32_16x16x32_bf16 v[32:35], a[52:55], v[80:83], v[32:35]
  v_mfma_f32_16x16x32_bf16 v[36:39], a[52:55], v[84:87], v[36:39]
  v_mfma_f32_16x16x32_bf16 v[40:43], a[132:135], v[80:83], v[40:43]
  v_mfma_f32_16x16x32_bf16 v[44:47], a[132:135], v[84:87], v[44:47]
  v_mfma_f32_16x16x32_bf16 v[48:51], a[212:215], v[80:83], v[48:51]
  v_mfma_f32_16x16x32_bf16 v[52:55], a[212:215], v[84:87], v[52:55]
  v_mfma_f32_16x16x32_bf16 v[56:59], v[148:151], v[80:83], v[56:59]
  v_mfma_f32_16x16x32_bf16 v[60:63], v[148:151], v[84:87], v[60:63]
  v_mfma_f32_16x16x32_bf16 v[64:67], v[80:83], v[228:231], v[64:67]
  v_mfma_f32_16x16x32_bf16 v[68:71], v[84:87], v[228:231], v[68:71]
  ds_read_b128 v[80:83], v7 offset:16384
  ds_read_b128 v[84:87], v7 offset:36864
  s_waitcnt lgkmcnt(4)
  v_mfma_f32_16x16x32_bf16 v[32:35], a[56:59], v[88:91], v[32:35]
  v_mfma_f32_16x16x32_bf16 v[36:39], a[56:59], v[92:95], v[36:39]
  v_mfma_f32_16x16x32_bf16 v[40:43], a[136:139], v[88:91], v[40:43]
  v_mfma_f32_16x16x32_bf16 v[44:47], a[136:139], v[92:95], v[44:47]
  v_mfma_f32_16x16x32_bf16 v[48:51], a[216:219], v[88:91], v[48:51]
  v_mfma_f32_16x16x32_bf16 v[52:55], a[216:219], v[92:95], v[52:55]
  v_mfma_f32_16x16x32_bf16 v[56:59], v[152:155], v[88:91], v[56:59]
  v_mfma_f32_16x16x32_bf16 v[60:63], v[152:155], v[92:95], v[60:63]
  v_mfma_f32_16x16x32_bf16 v[64:67], v[88:91], v[232:235], v[64:67]
  v_mfma_f32_16x16x32_bf16 v[68:71], v[92:95], v[232:235], v[68:71]
  ds_read_b128 v[88:91], v7 offset:17408
  ds_read_b128 v[92:95], v7 offset:37888
  s_waitcnt lgkmcnt(4)
  v_mfma_f32_16x16x32_bf16 v[32:35], a[60:63], v[72:75], v[32:35]
  v_mfma_f32_16x16x32_bf16 v[36:39], a[60:63], v[76:79], v[36:39]
  v_mfma_f32_16x16x32_bf16 v[40:43], a[140:143], v[72:75], v[40:43]
  v_mfma_f32_16x16x32_bf16 v[44:47], a[140:143], v[76:79], v[44:47]
  v_mfma_f32_16x16x32_bf16 v[48:51], a[220:223], v[72:75], v[48:51]
  v_mfma_f32_16x16x32_bf16 v[52:55], a[220:223], v[76:79], v[52:55]
  v_mfma_f32_16x16x32_bf16 v[56:59], v[156:159], v[72:75], v[56:59]
  v_mfma_f32_16x16x32_bf16 v[60:63], v[156:159], v[76:79], v[60:63]
  v_mfma_f32_16x16x32_bf16 v[64:67], v[72:75], v[236:239], v[64:67]
  v_mfma_f32_16x16x32_bf16 v[68:71], v[76:79], v[236:239], v[68:71]
  ds_read_b128 v[72:75], v7 offset:18432
  ds_read_b128 v[76:79], v7 offset:38912
  s_waitcnt lgkmcnt(4)
  v_mfma_f32_16x16x32_bf16 v[32:35], a[64:67], v[80:83], v[32:35]
  v_mfma_f32_16x16x32_bf16 v[36:39], a[64:67], v[84:87], v[36:39]
  v_mfma_f32_16x16x32_bf16 v[40:43], a[144:147], v[80:83], v[40:43]
  v_mfma_f32_16x16x32_bf16 v[44:47], a[144:147], v[84:87], v[44:47]
  v_mfma_f32_16x16x32_bf16 v[48:51], a[224:227], v[80:83], v[48:51]
  v_mfma_f32_16x16x32_bf16 v[52:55], a[224:227], v[84:87], v[52:55]
  v_mfma_f32_16x16x32_bf16 v[56:59], v[160:163], v[80:83], v[56:59]
  v_mfma_f32_16x16x32_bf16 v[60:63], v[160:163], v[84:87], v[60:63]
  v_mfma_f32_16x16x32_bf16 v[64:67], v[80:83], v[240:243], v[64:67]
  v_mfma_f32_16x16x32_bf16 v[68:71], v[84:87], v[240:243], v[68:71]
  ds_read_b128 v[80:83], v7 offset:19456
  ds_read_b128 v[84:87], v7 offset:39936
  s_waitcnt lgkmcnt(4)
  v_mfma_f32_16x16x32_bf16 v[32:35], a[68:71], v[88:91], v[32:35]
  v_mfma_f32_16x16x32_bf16 v[36:39], a[68:71], v[92:95], v[36:39]
  v_mfma_f32_16x16x32_bf16 v[40:43], a[148:151], v[88:91], v[40:43]
  v_mfma_f32_16x16x32_bf16 v[44:47], a[148:151], v[92:95], v[44:47]
  v_mfma_f32_16x16x32_bf16 v[48:51], a[228:231], v[88:91], v[48:51]
  v_mfma_f32_16x16x32_bf16 v[52:55], a[228:231], v[92:95], v[52:55]
  v_mfma_f32_16x16x32_bf16 v[56:59], v[164:167], v[88:91], v[56:59]
  v_mfma_f32_16x16x32_bf16 v[60:63], v[164:167], v[92:95], v[60:63]
  v_mfma_f32_16x16x32_bf16 v[64:67], v[88:91], v[244:247], v[64:67]
  v_mfma_f32_16x16x32_bf16 v[68:71], v[92:95], v[244:247], v[68:71]
  s_waitcnt lgkmcnt(2)
  v_mfma_f32_16x16x32_bf16 v[32:35], a[72:75], v[72:75], v[32:35]
  v_mfma_f32_16x16x32_bf16 v[36:39], a[72:75], v[76:79], v[36:39]
  v_mfma_f32_16x16x32_bf16 v[40:43], a[152:155], v[72:75], v[40:43]
  v_mfma_f32_16x16x32_bf16 v[44:47], a[152:155], v[76:79], v[44:47]
  v_mfma_f32_16x16x32_bf16 v[48:51], a[232:235], v[72:75], v[48:51]
  v_mfma_f32_16x16x32_bf16 v[52:55], a[232:235], v[76:79], v[52:55]
  v_mfma_f32_16x16x32_bf16 v[56:59], v[168:171], v[72:75], v[56:59]
  v_mfma_f32_16x16x32_bf16 v[60:63], v[168:171], v[76:79], v[60:63]
  v_mfma_f32_16x16x32_bf16 v[64:67], v[72:75], v[248:251], v[64:67]
  v_mfma_f32_16x16x32_bf16 v[68:71], v[76:79], v[248:251], v[68:71]
  s_waitcnt lgkmcnt(0)
  v_mfma_f32_16x16x32_bf16 v[32:35], a[76:79], v[80:83], v[32:35]
  v_mfma_f32_16x16x32_bf16 v[36:39], a[76:79], v[84:87], v[36:39]
  v_mfma_f32_16x16x32_bf16 v[40:43], a[156:159], v[80:83], v[40:43]
  v_mfma_f32_16x16x32_bf16 v[44:47], a[156:159], v[84:87], v[44:47]
  v_mfma_f32_16x16x32_bf16 v[48:51], a[236:239], v[80:83], v[48:51]
  v_mfma_f32_16x16x32_bf16 v[52:55], a[236:239], v[84:87], v[52:55]
  v_mfma_f32_16x16x32_bf16 v[56:59], v[172:175], v[80:83], v[56:59]
  v_mfma_f32_16x16x32_bf16 v[60:63], v[172:175], v[84:87], v[60:63]
  v_mfma_f32_16x16x32_bf16 v[64:67], v[80:83], v[252:255], v[64:67]
  v_mfma_f32_16x16x32_bf16 v[68:71], v[84:87], v[252:255], v[68:71]
  v_cvt_pk_bf16_f32 v8, v32, v33
  v_cvt_pk_bf16_f32 v9, v34, v35
  v_cvt_pk_bf16_f32 v10, v40, v41
  v_cvt_pk_bf16_f32 v11, v42, v43
  s_add_u32 s34, s21, 0
  buffer_store_dwordx4 v[8:11], v1, s[4:7], s34 offen
  v_cvt_pk_bf16_f32 v12, v36, v37
  v_cvt_pk_bf16_f32 v13, v38, v39
  v_cvt_pk_bf16_f32 v14, v44, v45
  v_cvt_pk_bf16_f32 v15, v46, v47
  s_add_u32 s34, s21, 6144
  buffer_store_dwordx4 v[12:15], v1, s[4:7], s34 offen
  v_cvt_pk_bf16_f32 v8, v48, v49
  v_cvt_pk_bf16_f32 v9, v50, v51
  v_cvt_pk_bf16_f32 v10, v56, v57
  v_cvt_pk_bf16_f32 v11, v58, v59
  s_add_u32 s34, s21, 1024
  buffer_store_dwordx4 v[8:11], v1, s[4:7], s34 offen
  v_cvt_pk_bf16_f32 v12, v52, v53
  v_cvt_pk_bf16_f32 v13, v54, v55
  v_cvt_pk_bf16_f32 v14, v60, v61
  v_cvt_pk_bf16_f32 v15, v62, v63
  s_add_u32 s34, s21, 7168
  buffer_store_dwordx4 v[12:15], v1, s[4:7], s34 offen
  v_cvt_pk_bf16_f32 v8, v64, v65
  v_cvt_pk_bf16_f32 v9, v66, v67
  v_cvt_pk_bf16_f32 v10, v68, v69
  v_cvt_pk_bf16_f32 v11, v70, v71
  s_add_u32 s34, s23, 0
  buffer_store_dwordx4 v[8:11], v1, s[4:7], s34 offen
  s_waitcnt vmcnt(0)
  s_barrier
  s_add_u32 s17, s17, 1
  v_mov_b32 v28, s17
  buffer_store_dword v28, v4, s[4:7], s24 offen
  s_cmp_lt_u32 s17, 64
  s_cbranch_scc1 reca_ptop168
  s_branch reca_exit1
reca_pslow167:
reca_ptop173:
  s_cmp_lt_u32 s17, 6
  s_cbranch_scc1 reca_pgo174
  s_sub_u32 s36, s17, 6
reca_ppoll175:
  buffer_load_dword v28, v4, s[4:7], s25 offen sc1
  s_waitcnt vmcnt(0)
  v_readfirstlane_b32 s34, v28
  s_nop 3
  s_cmp_ge_i32 s34, s36
  s_cbranch_scc1 reca_pgo174
  s_sleep 8
  s_sub_u32 s18, s18, 1
  s_cbranch_scc0 reca_ppoll175
  s_mov_b32 s18, 0
reca_pgo174:
  s_waitcnt vmcnt(0)
  s_barrier
  v_add_u32 v7, s26, v1
  s_xor_b32 s26, s26, 40960
  s_add_u32 s37, s17, 1
  s_cmp_ge_u32 s37, 64
  s_cbranch_scc1 reca_pnodma176
  s_mul_i32 s20, s37, 40960
  s_add_u32 s20, s20, 153616384
  s_add_u32 m0, s26, 0
  s_nop 0
  buffer_load_dwordx4 v1, s[4:7], s20 offen offset:0 lds
  buffer_load_dwordx4 v1, s[4:7], s20 offen offset:1024 lds
  buffer_load_dwordx4 v1, s[4:7], s20 offen offset:2048 lds
  buffer_load_dwordx4 v1, s[4:7], s20 offen offset:3072 lds
  s_add_u32 s20, s20, 4096
  s_add_u32 m0, s26, 4096
  s_nop 0
  buffer_load_dwordx4 v1, s[4:7], s20 offen offset:0 lds
  buffer_load_dwordx4 v1, s[4:7], s20 offen offset:1024 lds
  buffer_load_dwordx4 v1, s[4:7], s20 offen offset:2048 lds
  buffer_load_dwordx4 v1, s[4:7], s20 offen offset:3072 lds
  s_add_u32 s20, s20, 4096
  s_add_u32 m0, s26, 8192
  s_nop 0
  buffer_load_dwordx4 v1, s[4:7], s20 offen offset:0 lds
  buffer_load_dwordx4 v1, s[4:7], s20 offen offset:1024 lds
  s_lshl_b32 s34, s15, 6
  s_add_u32 s34, s34, s37
  s_mul_i32 s34, s34, 12288
  s_mul_i32 s35, s16, 3072
  s_add_u32 s35, s35, s34
  s_add_u32 s27, s35, 37748736
  s_mul_i32 s35, s16, 6144
  s_add_u32 s35, s35, s34
  s_add_u32 s28, s35, 62914560
  s_add_u32 s34, s27, 0
  buffer_load_dwordx4 v[16:19], v1, s[4:7], s34 offen sc1
  s_add_u32 s34, s27, 6144
  buffer_load_dwordx4 v[16:19], v1, s[4:7], s34 offen sc1
  s_add_u32 s34, s27, 1024
  buffer_load_dwordx4 v[16:19], v1, s[4:7], s34 offen sc1
  s_add_u32 s34, s27, 7168
  buffer_load_dwordx4 v[16:19], v1, s[4:7], s34 offen sc1
  s_add_u32 s34, s28, 0
  buffer_load_dwordx4 v[16:19], v1, s[4:7], s34 offen sc1
reca_pnodma176:
  s_lshl_b32 s34, s15, 6
  s_add_u32 s34, s34, s17
  s_mul_i32 s34, s34, 12288
  s_mul_i32 s35, s16, 3072
  s_add_u32 s35, s35, s34
  s_add_u32 s21, s35, 37748736
  s_add_u32 s22, s35, 88080384
  s_mul_i32 s35, s16, 6144
  s_add_u32 s35, s35, s34
  s_add_u32 s23, s35, 62914560
  ds_read_b128 v[72:75], v7 offset:0
  ds_read_b128 v[76:79], v7 offset:20480
  ds_read_b128 v[80:83], v7 offset:1024
  ds_read_b128 v[84:87], v7 offset:21504
  ds_read_b128 v[88:91], v7 offset:2048
  ds_read_b128 v[92:95], v7 offset:22528
  s_waitcnt lgkmcnt(4)
  v_mfma_f32_16x16x32_bf16 v[32:35], a[0:3], v[72:75], 0
  v_mfma_f32_16x16x32_bf16 v[36:39], a[0:3], v[76:79], 0
  v_mfma_f32_16x16x32_bf16 v[40:43], a[80:83], v[72:75], 0
  v_mfma_f32_16x16x32_bf16 v[44:47], a[80:83], v[76:79], 0
  v_mfma_f32_16x16x32_bf16 v[48:51], a[160:163], v[72:75], 0
  v_mfma_f32_16x16x32_bf16 v[52:55], a[160:163], v[76:79], 0
  v_mfma_f32_16x16x32_bf16 v[56:59], v[96:99], v[72:75], 0
  v_mfma_f32_16x16x32_bf16 v[60:63], v[96:99], v[76:79], 0
  v_mfma_f32_16x16x32_bf16 v[64:67], v[72:75], v[176:179], 0
  v_mfma_f32_16x16x32_bf16 v[68:71], v[76:79], v[176:179], 0
  ds_read_b128 v[72:75], v7 offset:3072
  ds_read_b128 v[76:79], v7 offset:23552
  s_waitcnt lgkmcnt(4)
  v_mfma_f32_16x16x32_bf16 v[32:35], a[4:7], v[80:83], v[32:35]
  v_mfma_f32_16x16x32_bf16 v[36:39], a[4:7], v[84:87], v[36:39]
  v_mfma_f32_16x16x32_bf16 v[40:43], a[84:87], v[80:83], v[40:43]
  v_mfma_f32_16x16x32_bf16 v[44:47], a[84:87], v[84:87], v[44:47]
  v_mfma_f32_16x16x32_bf16 v[48:51], a[164:167], v[80:83], v[48:51]
  v_mfma_f32_16x16x32_bf16 v[52:55], a[164:167], v[84:87], v[52:55]
  v_mfma_f32_16x16x32_bf16 v[56:59], v[100:103], v[80:83], v[56:59]
  v_mfma_f32_16x16x32_bf16 v[60:63], v[100:103], v[84:87], v[60:63]
  v_mfma_f32_16x16x32_bf16 v[64:67], v[80:83], v[180:183], v[64:67]
  v_mfma_f32_16x16x32_bf16 v[68:71], v[84:87], v[180:183], v[68:71]
  ds_read_b128 v[80:83], v7 offset:4096
  ds_read_b128 v[84:87], v7 offset:24576
  s_waitcnt lgkmcnt(4)
  v_mfma_f32_16x16x32_bf16 v[32:35], a[8:11], v[88:91], v[32:35]
  v_mfma_f32_16x16x32_bf16 v[36:39], a[8:11], v[92:95], v[36:39]
  v_mfma_f32_16x16x32_bf16 v[40:43], a[88:91], v[88:91], v[40:43]
  v_mfma_f32_16x16x32_bf16 v[44:47], a[88:91], v[92:95], v[44:47]
  v_mfma_f32_16x16x32_bf16 v[48:51], a[168:171], v[88:91], v[48:51]
  v_mfma_f32_16x16x32_bf16 v[52:55], a[168:171], v[92:95], v[52:55]
  v_mfma_f32_16x16x32_bf16 v[56:59], v[104:107], v[88:91], v[56:59]
  v_mfma_f32_16x16x32_bf16 v[60:63], v[104:107], v[92:95], v[60:63]
  v_mfma_f32_16x16x32_bf16 v[64:67], v[88:91], v[184:187], v[64:67]
  v_mfma_f32_16x16x32_bf16 v[68:71], v[92:95], v[184:187], v[68:71]
  ds_read_b128 v[88:91], v7 offset:5120
  ds_read_b128 v[92:95], v7 offset:25600
  s_waitcnt lgkmcnt(4)
  v_mfma_f32_16x16x32_bf16 v[32:35], a[12:15], v[72:75], v[32:35]
  v_mfma_f32_16x16x32_bf16 v[36:39], a[12:15], v[76:79], v[36:39]
  v_mfma_f32_16x16x32_bf16 v[40:43], a[92:95], v[72:75], v[40:43]
  v_mfma_f32_16x16x32_bf16 v[44:47], a[92:95], v[76:79], v[44:47]
  v_mfma_f32_16x16x32_bf16 v[48:51], a[172:175], v[72:75], v[48:51]
  v_mfma_f32_16x16x32_bf16 v[52:55], a[172:175], v[76:79], v[52:55]
  v_mfma_f32_16x16x32_bf16 v[56:59], v[108:111], v[72:75], v[56:59]
  v_mfma_f32_16x16x32_bf16 v[60:63], v[108:111], v[76:79], v[60:63]
  v_mfma_f32_16x16x32_bf16 v[64:67], v[72:75], v[188:191], v[64:67]
  v_mfma_f32_16x16x32_bf16 v[68:71], v[76:79], v[188:191], v[68:71]
  ds_read_b128 v[72:75], v7 offset:6144
  ds_read_b128 v[76:79], v7 offset:26624
  s_waitcnt lgkmcnt(4)
  v_mfma_f32_16x16x32_bf16 v[32:35], a[16:19], v[80:83], v[32:35]
  v_mfma_f32_16x16x32_bf16 v[36:39], a[16:19], v[84:87], v[36:39]
  v_mfma_f32_16x16x32_bf16 v[40:43], a[96:99], v[80:83], v[40:43]
  v_mfma_f32_16x16x32_bf16 v[44:47], a[96:99], v[84:87], v[44:47]
  v_mfma_f32_16x16x32_bf16 v[48:51], a[176:179], v[80:83], v[48:51]
  v_mfma_f32_16x16x32_bf16 v[52:55], a[176:179], v[84:87], v[52:55]
  v_mfma_f32_16x16x32_bf16 v[56:59], v[112:115], v[80:83], v[56:59]
  v_mfma_f32_16x16x32_bf16 v[60:63], v[112:115], v[84:87], v[60:63]
  v_mfma_f32_16x16x32_bf16 v[64:67], v[80:83], v[192:195], v[64:67]
  v_mfma_f32_16x16x32_bf16 v[68:71], v[84:87], v[192:195], v[68:71]
  ds_read_b128 v[80:83], v7 offset:7168
  ds_read_b128 v[84:87], v7 offset:27648
  s_waitcnt lgkmcnt(4)
  v_mfma_f32_16x16x32_bf16 v[32:35], a[20:23], v[88:91], v[32:35]
  v_mfma_f32_16x16x32_bf16 v[36:39], a[20:23], v[92:95], v[36:39]
  v_mfma_f32_16x16x32_bf16 v[40:43], a[100:103], v[88:91], v[40:43]
  v_mfma_f32_16x16x32_bf16 v[44:47], a[100:103], v[92:95], v[44:47]
  v_mfma_f32_16x16x32_bf16 v[48:51], a[180:183], v[88:91], v[48:51]
  v_mfma_f32_16x16x32_bf16 v[52:55], a[180:183], v[92:95], v[52:55]
  v_mfma_f32_16x16x32_bf16 v[56:59], v[116:119], v[88:91], v[56:59]
  v_mfma_f32_16x16x32_bf16 v[60:63], v[116:119], v[92:95], v[60:63]
  v_mfma_f32_16x16x32_bf16 v[64:67], v[88:91], v[196:199], v[64:67]
  v_mfma_f32_16x16x32_bf16 v[68:71], v[92:95], v[196:199], v[68:71]
  ds_read_b128 v[88:91], v7 offset:8192
  ds_read_b128 v[92:95], v7 offset:28672
  s_waitcnt lgkmcnt(4)
  v_mfma_f32_16x16x32_bf16 v[32:35], a[24:27], v[72:75], v[32:35]
  v_mfma_f32_16x16x32_bf16 v[36:39], a[24:27], v[76:79], v[36:39]
  v_mfma_f32_16x16x32_bf16 v[40:43], a[104:107], v[72:75], v[40:43]
  v_mfma_f32_16x16x32_bf16 v[44:47], a[104:107], v[76:79], v[44:47]
  v_mfma_f32_16x16x32_bf16 v[48:51], a[184:187], v[72:75], v[48:51]
  v_mfma_f32_16x16x32_bf16 v[52:55], a[184:187], v[76:79], v[52:55]
  v_mfma_f32_16x16x32_bf16 v[56:59], v[120:123], v[72:75], v[56:59]
  v_mfma_f32_16x16x32_bf16 v[60:63], v[120:123], v[76:79], v[60:63]
  v_mfma_f32_16x16x32_bf16 v[64:67], v[72:75], v[200:203], v[64:67]
  v_mfma_f32_16x16x32_bf16 v[68:71], v[76:79], v[200:203], v[68:71]
  ds_read_b128 v[72:75], v7 offset:9216
  ds_read_b128 v[76:79], v7 offset:29696
  s_waitcnt lgkmcnt(4)
  v_mfma_f32_16x16x32_bf16 v[32:35], a[28:31], v[80:83], v[32:35]
  v_mfma_f32_16x16x32_bf16 v[36:39], a[28:31], v[84:87], v[36:39]
  v_mfma_f32_16x16x32_bf16 v[40:43], a[108:111], v[80:83], v[40:43]
  v_mfma_f32_16x16x32_bf16 v[44:47], a[108:111], v[84:87], v[44:47]
  v_mfma_f32_16x16x32_bf16 v[48:51], a[188:191], v[80:83], v[48:51]
  v_mfma_f32_16x16x32_bf16 v[52:55], a[188:191], v[84:87], v[52:55]
  v_mfma_f32_16x16x32_bf16 v[56:59], v[124:127], v[80:83], v[56:59]
  v_mfma_f32_16x16x32_bf16 v[60:63], v[124:127], v[84:87], v[60:63]
  v_mfma_f32_16x16x32_bf16 v[64:67], v[80:83], v[204:207], v[64:67]
  v_mfma_f32_16x16x32_bf16 v[68:71], v[84:87], v[204:207], v[68:71]
  ds_read_b128 v[80:83], v7 offset:10240
  ds_read_b128 v[84:87], v7 offset:30720
  s_waitcnt lgkmcnt(4)
  v_mfma_f32_16x16x32_bf16 v[32:35], a[32:35], v[88:91], v[32:35]
  v_mfma_f32_16x16x32_bf16 v[36:39], a[32:35], v[92:95], v[36:39]
  v_mfma_f32_16x16x32_bf16 v[40:43], a[112:115], v[88:91], v[40:43]
  v_mfma_f32_16x16x32_bf16 v[44:47], a[112:115], v[92:95], v[44:47]
  v_mfma_f32_16x16x32_bf16 v[48:51], a[192:195], v[88:91], v[48:51]
  v_mfma_f32_16x16x32_bf16 v[52:55], a[192:195], v[92:95], v[52:55]
  v_mfma_f32_16x16x32_bf16 v[56:59], v[128:131], v[88:91], v[56:59]
  v_mfma_f32_16x16x32_bf16 v[60:63], v[128:131], v[92:95], v[60:63]
  v_mfma_f32_16x16x32_bf16 v[64:67], v[88:91], v[208:211], v[64:67]
  v_mfma_f32_16x16x32_bf16 v[68:71], v[92:95], v[208:211], v[68:71]
  ds_read_b128 v[88:91], v7 offset:11264
  ds_read_b128 v[92:95], v7 offset:31744
  s_waitcnt lgkmcnt(4)
  v_mfma_f32_16x16x32_bf16 v[32:35], a[36:39], v[72:75], v[32:35]
  v_mfma_f32_16x16x32_bf16 v[36:39], a[36:39], v[76:79], v[36:39]
  v_mfma_f32_16x16x32_bf16 v[40:43], a[116:119], v[72:75], v[40:43]
  v_mfma_f32_16x16x32_bf16 v[44:47], a[116:119], v[76:79], v[44:47]
  v_mfma_f32_16x16x32_bf16 v[48:51], a[196:199], v[72:75], v[48:51]
  v_mfma_f32_16x16x32_bf16 v[52:55], a[196:199], v[76:79], v[52:55]
  v_mfma_f32_16x16x32_bf16 v[56:59], v[132:135], v[72:75], v[56:59]
  v_mfma_f32_16x16x32_bf16 v[60:63], v[132:135], v[76:79], v[60:63]
  v_mfma_f32_16x16x32_bf16 v[64:67], v[72:75], v[212:215], v[64:67]
  v_mfma_f32_16x16x32_bf16 v[68:71], v[76:79], v[212:215], v[68:71]
  ds_read_b128 v[72:75], v7 offset:12288
  ds_read_b128 v[76:79], v7 offset:32768
  s_waitcnt lgkmcnt(4)
  v_mfma_f32_16x16x32_bf16 v[32:35], a[40:43], v[80:83], v[32:35]
  v_mfma_f32_16x16x32_bf16 v[36:39], a[40:43], v[84:87], v[36:39]
  v_mfma_f32_16x16x32_bf16 v[40:43], a[120:123], v[80:83], v[40:43]
  v_mfma_f32_16x16x32_bf16 v[44:47], a[120:123], v[84:87], v[44:47]
  v_mfma_f32_16x16x32_bf16 v[48:51], a[200:203], v[80:83], v[48:51]
  v_mfma_f32_16x16x32_bf16 v[52:55], a[200:203], v[84:87], v[52:55]
  v_mfma_f32_16x16x32_bf16 v[56:59], v[136:139], v[80:83], v[56:59]
  v_mfma_f32_16x16x32_bf16 v[60:63], v[136:139], v[84:87], v[60:63]
  v_mfma_f32_16x16x32_bf16 v[64:67], v[80:83], v[216:219], v[64:67]
  v_mfma_f32_16x16x32_bf16 v[68:71], v[84:87], v[216:219], v[68:71]
  ds_read_b128 v[80:83], v7 offset:13312
  ds_read_b128 v[84:87], v7 offset:33792
  s_waitcnt lgkmcnt(4)
  v_mfma_f32_16x16x32_bf16 v[32:35], a[44:47], v[88:91], v[32:35]
  v_mfma_f32_16x16x32_bf16 v[36:39], a[44:47], v[92:95], v[36:39]
  v_mfma_f32_16x16x32_bf16 v[40:43], a[124:127], v[88:91], v[40:43]
  v_mfma_f32_16x16x32_bf16 v[44:47], a[124:127], v[92:95], v[44:47]
  v_mfma_f32_16x16x32_bf16 v[48:51], a[204:207], v[88:91], v[48:51]
  v_mfma_f32_16x16x32_bf16 v[52:55], a[204:207], v[92:95], v[52:55]
  v_mfma_f32_16x16x32_bf16 v[56:59], v[140:143], v[88:91], v[56:59]
  v_mfma_f32_16x16x32_bf16 v[60:63], v[140:143], v[92:95], v[60:63]
  v_mfma_f32_16x16x32_bf16 v[64:67], v[88:91], v[220:223], v[64:67]
  v_mfma_f32_16x16x32_bf16 v[68:71], v[92:95], v[220:223], v[68:71]
  ds_read_b128 v[88:91], v7 offset:14336
  ds_read_b128 v[92:95], v7 offset:34816
  s_waitcnt lgkmcnt(4)
  v_mfma_f32_16x16x32_bf16 v[32:35], a[48:51], v[72:75], v[32:35]
  v_mfma_f32_16x16x32_bf16 v[36:39], a[48:51], v[76:79], v[36:39]
  v_mfma_f32_16x16x32_bf16 v[40:43], a[128:131], v[72:75], v[40:43]
  v_mfma_f32_16x16x32_bf16 v[44:47], a[128:131], v[76:79], v[44:47]
  v_mfma_f32_16x16x32_bf16 v[48:51], a[208:211], v[72:75], v[48:51]
  v_mfma_f32_16x16x32_bf16 v[52:55], a[208:211], v[76:79], v[52:55]
  v_mfma_f32_16x16x32_bf16 v[56:59], v[144:147], v[72:75], v[56:59]
  v_mfma_f32_16x16x32_bf16 v[60:63], v[144:147], v[76:79], v[60:63]
  v_mfma_f32_16x16x32_bf16 v[64:67], v[72:75], v[224:227], v[64:67]
  v_mfma_f32_16x16x32_bf16 v[68:71], v[76:79], v[224:227], v[68:71]
  ds_read_b128 v[72:75], v7 offset:15360
  ds_read_b128 v[76:79], v7 offset:35840
  s_waitcnt lgkmcnt(4)
  v_mfma_f32_16x16x32_bf16 v[32:35], a[52:55], v[80:83], v[32:35]
  v_mfma_f32_16x16x32_bf16 v[36:39], a[52:55], v[84:87], v[36:39]
  v_mfma_f32_16x16x32_bf16 v[40:43], a[132:135], v[80:83], v[40:43]
  v_mfma_f32_16x16x32_bf16 v[44:47], a[132:135], v[84:87], v[44:47]
  v_mfma_f32_16x16x32_bf16 v[48:51], a[212:215], v[80:83], v[48:51]
  v_mfma_f32_16x16x32_bf16 v[52:55], a[212:215], v[84:87], v[52:55]
  v_mfma_f32_16x16x32_bf16 v[56:59], v[148:151], v[80:83], v[56:59]
  v_mfma_f32_16x16x32_bf16 v[60:63], v[148:151], v[84:87], v[60:63]
  v_mfma_f32_16x16x32_bf16 v[64:67], v[80:83], v[228:231], v[64:67]
  v_mfma_f32_16x16x32_bf16 v[68:71], v[84:87], v[228:231], v[68:71]
  ds_read_b128 v[80:83], v7 offset:16384
  ds_read_b128 v[84:87], v7 offset:36864
  s_waitcnt lgkmcnt(4)
  v_mfma_f32_16x16x32_bf16 v[32:35], a[56:59], v[88:91], v[32:35]
  v_mfma_f32_16x16x32_bf16 v[36:39], a[56:59], v[92:95], v[36:39]
  v_mfma_f32_16x16x32_bf16 v[40:43], a[136:139], v[88:91], v[40:43]
  v_mfma_f32_16x16x32_bf16 v[44:47], a[136:139], v[92:95], v[44:47]
  v_mfma_f32_16x16x32_bf16 v[48:51], a[216:219], v[88:91], v[48:51]
  v_mfma_f32_16x16x32_bf16 v[52:55], a[216:219], v[92:95], v[52:55]
  v_mfma_f32_16x16x32_bf16 v[56:59], v[152:155], v[88:91], v[56:59]
  v_mfma_f32_16x16x32_bf16 v[60:63], v[152:155], v[92:95], v[60:63]
  v_mfma_f32_16x16x32_bf16 v[64:67], v[88:91], v[232:235], v[64:67]
  v_mfma_f32_16x16x32_bf16 v[68:71], v[92:95], v[232:235], v[68:71]
  ds_read_b128 v[88:91], v7 offset:17408
  ds_read_b128 v[92:95], v7 offset:37888
  s_waitcnt lgkmcnt(4)
  v_mfma_f32_16x16x32_bf16 v[32:35], a[60:63], v[72:75], v[32:35]
  v_mfma_f32_16x16x32_bf16 v[36:39], a[60:63], v[76:79], v[36:39]
  v_mfma_f32_16x16x32_bf16 v[40:43], a[140:143], v[72:75], v[40:43]
  v_mfma_f32_16x16x32_bf16 v[44:47], a[140:143], v[76:79], v[44:47]
  v_mfma_f32_16x16x32_bf16 v[48:51], a[220:223], v[72:75], v[48:51]
  v_mfma_f32_16x16x32_bf16 v[52:55], a[220:223], v[76:79], v[52:55]
  v_mfma_f32_16x16x32_bf16 v[56:59], v[156:159], v[72:75], v[56:59]
  v_mfma_f32_16x16x32_bf16 v[60:63], v[156:159], v[76:79], v[60:63]
  v_mfma_f32_16x16x32_bf16 v[64:67], v[72:75], v[236:239], v[64:67]
  v_mfma_f32_16x16x32_bf16 v[68:71], v[76:79], v[236:239], v[68:71]
  ds_read_b128 v[72:75], v7 offset:18432
  ds_read_b128 v[76:79], v7 offset:38912
  s_waitcnt lgkmcnt(4)
  v_mfma_f32_16x16x32_bf16 v[32:35], a[64:67], v[80:83], v[32:35]
  v_mfma_f32_16x16x32_bf16 v[36:39], a[64:67], v[84:87], v[36:39]
  v_mfma_f32_16x16x32_bf16 v[40:43], a[144:147], v[80:83], v[40:43]
  v_mfma_f32_16x16x32_bf16 v[44:47], a[144:147], v[84:87], v[44:47]
  v_mfma_f32_16x16x32_bf16 v[48:51], a[224:227], v[80:83], v[48:51]
  v_mfma_f32_16x16x32_bf16 v[52:55], a[224:227], v[84:87], v[52:55]
  v_mfma_f32_16x16x32_bf16 v[56:59], v[160:163], v[80:83], v[56:59]
  v_mfma_f32_16x16x32_bf16 v[60:63], v[160:163], v[84:87], v[60:63]
  v_mfma_f32_16x16x32_bf16 v[64:67], v[80:83], v[240:243], v[64:67]
  v_mfma_f32_16x16x32_bf16 v[68:71], v[84:87], v[240:243], v[68:71]
  ds_read_b128 v[80:83], v7 offset:19456
  ds_read_b128 v[84:87], v7 offset:39936
  s_waitcnt lgkmcnt(4)
  v_mfma_f32_16x16x32_bf16 v[32:35], a[68:71], v[88:91], v[32:35]
  v_mfma_f32_16x16x32_bf16 v[36:39], a[68:71], v[92:95], v[36:39]
  v_mfma_f32_16x16x32_bf16 v[40:43], a[148:151], v[88:91], v[40:43]
  v_mfma_f32_16x16x32_bf16 v[44:47], a[148:151], v[92:95], v[44:47]
  v_mfma_f32_16x16x32_bf16 v[48:51], a[228:231], v[88:91], v[48:51]
  v_mfma_f32_16x16x32_bf16 v[52:55], a[228:231], v[92:95], v[52:55]
  v_mfma_f32_16x16x32_bf16 v[56:59], v[164:167], v[88:91], v[56:59]
  v_mfma_f32_16x16x32_bf16 v[60:63], v[164:167], v[92:95], v[60:63]
  v_mfma_f32_16x16x32_bf16 v[64:67], v[88:91], v[244:247], v[64:67]
  v_mfma_f32_16x16x32_bf16 v[68:71], v[92:95], v[244:247], v[68:71]
  s_waitcnt lgkmcnt(2)
  v_mfma_f32_16x16x32_bf16 v[32:35], a[72:75], v[72:75], v[32:35]
  v_mfma_f32_16x16x32_bf16 v[36:39], a[72:75], v[76:79], v[36:39]
  v_mfma_f32_16x16x32_bf16 v[40:43], a[152:155], v[72:75], v[40:43]
  v_mfma_f32_16x16x32_bf16 v[44:47], a[152:155], v[76:79], v[44:47]
  v_mfma_f32_16x16x32_bf16 v[48:51], a[232:235], v[72:75], v[48:51]
  v_mfma_f32_16x16x32_bf16 v[52:55], a[232:235], v[76:79], v[52:55]
  v_mfma_f32_16x16x32_bf16 v[56:59], v[168:171], v[72:75], v[56:59]
  v_mfma_f32_16x16x32_bf16 v[60:63], v[168:171], v[76:79], v[60:63]
  v_mfma_f32_16x16x32_bf16 v[64:67], v[72:75], v[248:251], v[64:67]
  v_mfma_f32_16x16x32_bf16 v[68:71], v[76:79], v[248:251], v[68:71]
  s_waitcnt lgkmcnt(0)
  v_mfma_f32_16x16x32_bf16 v[32:35], a[76:79], v[80:83], v[32:35]
  v_mfma_f32_16x16x32_bf16 v[36:39], a[76:79], v[84:87], v[36:39]
  v_mfma_f32_16x16x32_bf16 v[40:43], a[156:159], v[80:83], v[40:43]
  v_mfma_f32_16x16x32_bf16 v[44:47], a[156:159], v[84:87], v[44:47]
  v_mfma_f32_16x16x32_bf16 v[48:51], a[236:239], v[80:83], v[48:51]
  v_mfma_f32_16x16x32_bf16 v[52:55], a[236:239], v[84:87], v[52:55]
  v_mfma_f32_16x16x32_bf16 v[56:59], v[172:175], v[80:83], v[56:59]
  v_mfma_f32_16x16x32_bf16 v[60:63], v[172:175], v[84:87], v[60:63]
  v_mfma_f32_16x16x32_bf16 v[64:67], v[80:83], v[252:255], v[64:67]
  v_mfma_f32_16x16x32_bf16 v[68:71], v[84:87], v[252:255], v[68:71]
  v_cvt_pk_bf16_f32 v8, v32, v33
  v_cvt_pk_bf16_f32 v9, v34, v35
  v_cvt_pk_bf16_f32 v10, v40, v41
  v_cvt_pk_bf16_f32 v11, v42, v43
  s_add_u32 s34, s21, 0
  buffer_store_dwordx4 v[8:11], v1, s[4:7], s34 offen sc1
  v_cvt_pk_bf16_f32 v12, v36, v37
  v_cvt_pk_bf16_f32 v13, v38, v39
  v_cvt_pk_bf16_f32 v14, v44, v45
  v_cvt_pk_bf16_f32 v15, v46, v47
  s_add_u32 s34, s21, 6144
  buffer_store_dwordx4 v[12:15], v1, s[4:7], s34 offen sc1
  v_cvt_pk_bf16_f32 v8, v48, v49
  v_cvt_pk_bf16_f32 v9, v50, v51
  v_cvt_pk_bf16_f32 v10, v56, v57
  v_cvt_pk_bf16_f32 v11, v58, v59
  s_add_u32 s34, s21, 1024
  buffer_store_dwordx4 v[8:11], v1, s[4:7], s34 offen sc1
  v_cvt_pk_bf16_f32 v12, v52, v53
  v_cvt_pk_bf16_f32 v13, v54, v55
  v_cvt_pk_bf16_f32 v14, v60, v61
  v_cvt_pk_bf16_f32 v15, v62, v63
  s_add_u32 s34, s21, 7168
  buffer_store_dwordx4 v[12:15], v1, s[4:7], s34 offen sc1
  v_cvt_pk_bf16_f32 v8, v64, v65
  v_cvt_pk_bf16_f32 v9, v66, v67
  v_cvt_pk_bf16_f32 v10, v68, v69
  v_cvt_pk_bf16_f32 v11, v70, v71
  s_add_u32 s34, s23, 0
  buffer_store_dwordx4 v[8:11], v1, s[4:7], s34 offen sc1
  s_waitcnt vmcnt(0)
  s_barrier
  s_add_u32 s17, s17, 1
  v_mov_b32 v28, s17
  buffer_store_dword v28, v4, s[4:7], s24 offen sc1
  s_cmp_lt_u32 s17, 64
  s_cbranch_scc1 reca_ptop173
  s_branch reca_exit1
reca_pw1_162:
  s_mov_b32 s17, 0
  s_mov_b32 s26, 0
  s_mul_i32 s20, s17, 40960
  s_add_u32 s20, s20, 153626624
  s_add_u32 m0, s26, 10240
  s_nop 0
  buffer_load_dwordx4 v1, s[4:7], s20 offen offset:0 lds
  buffer_load_dwordx4 v1, s[4:7], s20 offen offset:1024 lds
  buffer_load_dwordx4 v1, s[4:7], s20 offen offset:2048 lds
  buffer_load_dwordx4 v1, s[4:7], s20 offen offset:3072 lds
  s_add_u32 s20, s20, 4096
  s_add_u32 m0, s26, 14336
  s_nop 0
  buffer_load_dwordx4 v1, s[4:7], s20 offen offset:0 lds
  buffer_load_dwordx4 v1, s[4:7], s20 offen offset:1024 lds
  buffer_load_dwordx4 v1, s[4:7], s20 offen offset:2048 lds
  buffer_load_dwordx4 v1, s[4:7], s20 offen offset:3072 lds
  s_add_u32 s20, s20, 4096
  s_add_u32 m0, s26, 18432
  s_nop 0
  buffer_load_dwordx4 v1, s[4:7], s20 offen offset:0 lds
  buffer_load_dwordx4 v1, s[4:7], s20 offen offset:1024 lds
  s_lshl_b32 s34, s15, 6
  s_add_u32 s34, s34, s17
  s_mul_i32 s34, s34, 12288
  s_mul_i32 s35, s16, 3072
  s_add_u32 s35, s35, s34
  s_add_u32 s27, s35, 37748736
  s_mul_i32 s35, s16, 6144
  s_add_u32 s35, s35, s34
  s_add_u32 s28, s35, 62914560
  s_add_u32 s34, s27, 2048
  buffer_load_dwordx4 v[16:19], v1, s[4:7], s34 offen sc1
  s_add_u32 s34, s27, 8192
  buffer_load_dwordx4 v[16:19], v1, s[4:7], s34 offen sc1
  s_add_u32 s34, s28, 1024
  buffer_load_dwordx4 v[16:19], v1, s[4:7], s34 offen sc1
  s_add_u32 s34, s28, 2048
  buffer_load_dwordx4 v[16:19], v1, s[4:7], s34 offen sc1
  s_add_u32 s34, s28, 3072
  buffer_load_dwordx4 v[16:19], v1, s[4:7], s34 offen sc1
  s_mul_i32 s34, s15, 12
  s_mul_i32 s35, s16, 6
  s_add_u32 s34, s34, s35
  s_add_u32 s34, s34, 4
  s_mul_i32 s34, s34, 20480
  s_add_u32 s34, s34, 14155776
  buffer_load_dwordx4 a[0:3], v1, s[4:7], s34 offen offset:0
  buffer_load_dwordx4 a[4:7], v1, s[4:7], s34 offen offset:1024
  buffer_load_dwordx4 a[8:11], v1, s[4:7], s34 offen offset:2048
  buffer_load_dwordx4 a[12:15], v1, s[4:7], s34 offen offset:3072
  s_add_u32 s34, s34, 4096
  buffer_load_dwordx4 a[16:19], v1, s[4:7], s34 offen offset:0
  buffer_load_dwordx4 a[20:23], v1, s[4:7], s34 offen offset:1024
  buffer_load_dwordx4 a[24:27], v1, s[4:7], s34 offen offset:2048
  buffer_load_dwordx4 a[28:31], v1, s[4:7], s34 offen offset:3072
  s_add_u32 s34, s34, 4096
  buffer_load_dwordx4 a[32:35], v1, s[4:7], s34 offen offset:0
  buffer_load_dwordx4 a[36:39], v1, s[4:7], s34 offen offset:1024
  buffer_load_dwordx4 a[40:43], v1, s[4:7], s34 offen offset:2048
  buffer_load_dwordx4 a[44:47], v1, s[4:7], s34 offen offset:3072
  s_add_u32 s34, s34, 4096
  buffer_load_dwordx4 a[48:51], v1, s[4:7], s34 offen offset:0
  buffer_load_dwordx4 a[52:55], v1, s[4:7], s34 offen offset:1024
  buffer_load_dwordx4 a[56:59], v1, s[4:7], s34 offen offset:2048
  buffer_load_dwordx4 a[60:63], v1, s[4:7], s34 offen offset:3072
  s_add_u32 s34, s34, 4096
  buffer_load_dwordx4 a[64:67], v1, s[4:7], s34 offen offset:0
  buffer_load_dwordx4 a[68:71], v1, s[4:7], s34 offen offset:1024
  buffer_load_dwordx4 a[72:75], v1, s[4:7], s34 offen offset:2048
  buffer_load_dwordx4 a[76:79], v1, s[4:7], s34 offen offset:3072
  s_mul_i32 s34, s15, 12
  s_mul_i32 s35, s16, 6
  s_add_u32 s34, s34, s35
  s_add_u32 s34, s34, 5
  s_mul_i32 s34, s34, 20480
  s_add_u32 s34, s34, 14155776
  buffer_load_dwordx4 a[80:83], v1, s[4:7], s34 offen offset:0
  buffer_load_dwordx4 a[84:87], v1, s[4:7], s34 offen offset:1024
  buffer_load_dwordx4 a[88:91], v1, s[4:7], s34 offen offset:2048
  buffer_load_dwordx4 a[92:95], v1, s[4:7], s34 offen offset:3072
  s_add_u32 s34, s34, 4096
  buffer_load_dwordx4 a[96:99], v1, s[4:7], s34 offen offset:0
  buffer_load_dwordx4 a[100:103], v1, s[4:7], s34 offen offset:1024
  buffer_load_dwordx4 a[104:107], v1, s[4:7], s34 offen offset:2048
  buffer_load_dwordx4 a[108:111], v1, s[4:7], s34 offen offset:3072
  s_add_u32 s34, s34, 4096
  buffer_load_dwordx4 a[112:115], v1, s[4:7], s34 offen offset:0
  buffer_load_dwordx4 a[116:119], v1, s[4:7], s34 offen offset:1024
  buffer_load_dwordx4 a[120:123], v1, s[4:7], s34 offen offset:2048
  buffer_load_dwordx4 a[124:127], v1, s[4:7], s34 offen offset:3072
  s_add_u32 s34, s34, 4096
  buffer_load_dwordx4 a[128:131], v1, s[4:7], s34 offen offset:0
  buffer_load_dwordx4 a[132:135], v1, s[4:7], s34 offen offset:1024
  buffer_load_dwordx4 a[136:139], v1, s[4:7], s34 offen offset:2048
  buffer_load_dwordx4 a[140:143], v1, s[4:7], s34 offen offset:3072
  s_add_u32 s34, s34, 4096
  buffer_load_dwordx4 a[144:147], v1, s[4:7], s34 offen offset:0
  buffer_load_dwordx4 a[148:151], v1, s[4:7], s34 offen offset:1024
  buffer_load_dwordx4 a[152:155], v1, s[4:7], s34 offen offset:2048
  buffer_load_dwordx4 a[156:159], v1, s[4:7], s34 offen offset:3072
  s_waitcnt vmcnt(20)
  s_mul_i32 s34, s15, 12
  s_mul_i32 s35, s16, 6
  s_add_u32 s34, s34, s35
  s_add_u32 s34, s34, 1
  s_mul_i32 s34, s34, 20480
  s_add_u32 s34, s34, 22020096
  buffer_load_dwordx4 a[160:163], v1, s[4:7], s34 offen offset:0
  buffer_load_dwordx4 a[164:167], v1, s[4:7], s34 offen offset:1024
  buffer_load_dwordx4 a[168:171], v1, s[4:7], s34 offen offset:2048
  buffer_load_dwordx4 a[172:175], v1, s[4:7], s34 offen offset:3072
  s_add_u32 s34, s34, 4096
  buffer_load_dwordx4 a[176:179], v1, s[4:7], s34 offen offset:0
  buffer_load_dwordx4 a[180:183], v1, s[4:7], s34 offen offset:1024
  buffer_load_dwordx4 a[184:187], v1, s[4:7], s34 offen offset:2048
  buffer_load_dwordx4 a[188:191], v1, s[4:7], s34 offen offset:3072
  s_add_u32 s34, s34, 4096
  buffer_load_dwordx4 a[192:195], v1, s[4:7], s34 offen offset:0
  buffer_load_dwordx4 a[196:199], v1, s[4:7], s34 offen offset:1024
  buffer_load_dwordx4 a[200:203], v1, s[4:7], s34 offen offset:2048
  buffer_load_dwordx4 a[204:207], v1, s[4:7], s34 offen offset:3072
  s_add_u32 s34, s34, 4096
  buffer_load_dwordx4 a[208:211], v1, s[4:7], s34 offen offset:0
  buffer_load_dwordx4 a[212:215], v1, s[4:7], s34 offen offset:1024
  buffer_load_dwordx4 a[216:219], v1, s[4:7], s34 offen offset:2048
  buffer_load_dwordx4 a[220:223], v1, s[4:7], s34 offen offset:3072
  s_add_u32 s34, s34, 4096
  buffer_load_dwordx4 a[224:227], v1, s[4:7], s34 offen offset:0
  buffer_load_dwordx4 a[228:231], v1, s[4:7], s34 offen offset:1024
  buffer_load_dwordx4 a[232:235], v1, s[4:7], s34 offen offset:2048
  buffer_load_dwordx4 a[236:239], v1, s[4:7], s34 offen offset:3072
  s_waitcnt vmcnt(20)
  s_mul_i32 s34, s15, 12
  s_mul_i32 s35, s16, 6
  s_add_u32 s34, s34, s35
  s_add_u32 s34, s34, 2
  s_mul_i32 s34, s34, 20480
  s_add_u32 s34, s34, 22020096
  buffer_load_dwordx4 v[96:99], v1, s[4:7], s34 offen offset:0
  buffer_load_dwordx4 v[100:103], v1, s[4:7], s34 offen offset:1024
  buffer_load_dwordx4 v[104:107], v1, s[4:7], s34 offen offset:2048
  buffer_load_dwordx4 v[108:111], v1, s[4:7], s34 offen offset:3072
  s_add_u32 s34, s34, 4096
  buffer_load_dwordx4 v[112:115], v1, s[4:7], s34 offen offset:0
  buffer_load_dwordx4 v[116:119], v1, s[4:7], s34 offen offset:1024
  buffer_load_dwordx4 v[120:123], v1, s[4:7], s34 offen offset:2048
  buffer_load_dwordx4 v[124:127], v1, s[4:7], s34 offen offset:3072
  s_add_u32 s34, s34, 4096
  buffer_load_dwordx4 v[128:131], v1, s[4:7], s34 offen offset:0
  buffer_load_dwordx4 v[132:135], v1, s[4:7], s34 offen offset:1024
  buffer_load_dwordx4 v[136:139], v1, s[4:7], s34 offen offset:2048
  buffer_load_dwordx4 v[140:143], v1, s[4:7], s34 offen offset:3072
  s_add_u32 s34, s34, 4096
  buffer_load_dwordx4 v[144:147], v1, s[4:7], s34 offen offset:0
  buffer_load_dwordx4 v[148:151], v1, s[4:7], s34 offen offset:1024
  buffer_load_dwordx4 v[152:155], v1, s[4:7], s34 offen offset:2048
  buffer_load_dwordx4 v[156:159], v1, s[4:7], s34 offen offset:3072
  s_add_u32 s34, s34, 4096
  buffer_load_dwordx4 v[160:163], v1, s[4:7], s34 offen offset:0
  buffer_load_dwordx4 v[164:167], v1, s[4:7], s34 offen offset:1024
  buffer_load_dwordx4 v[168:171], v1, s[4:7], s34 offen offset:2048
  buffer_load_dwordx4 v[172:175], v1, s[4:7], s34 offen offset:3072
  s_waitcnt vmcnt(20)
  s_mul_i32 s34, s15, 12
  s_mul_i32 s35, s16, 6
  s_add_u32 s34, s34, s35
  s_add_u32 s34, s34, 3
  s_mul_i32 s34, s34, 20480
  s_add_u32 s34, s34, 22020096
  buffer_load_dwordx4 v[176:179], v1, s[4:7], s34 offen offset:0
  buffer_load_dwordx4 v[180:183], v1, s[4:7], s34 offen offset:1024
  buffer_load_dwordx4 v[184:187], v1, s[4:7], s34 offen offset:2048
  buffer_load_dwordx4 v[188:191], v1, s[4:7], s34 offen offset:3072
  s_add_u32 s34, s34, 4096
  buffer_load_dwordx4 v[192:195], v1, s[4:7], s34 offen offset:0
  buffer_load_dwordx4 v[196:199], v1, s[4:7], s34 offen offset:1024
  buffer_load_dwordx4 v[200:203], v1, s[4:7], s34 offen offset:2048
  buffer_load_dwordx4 v[204:207], v1, s[4:7], s34 offen offset:3072
  s_add_u32 s34, s34, 4096
  buffer_load_dwordx4 v[208:211], v1, s[4:7], s34 offen offset:0
  buffer_load_dwordx4 v[212:215], v1, s[4:7], s34 offen offset:1024
  buffer_load_dwordx4 v[216:219], v1, s[4:7], s34 offen offset:2048
  buffer_load_dwordx4 v[220:223], v1, s[4:7], s34 offen offset:3072
  s_add_u32 s34, s34, 4096
  buffer_load_dwordx4 v[224:227], v1, s[4:7], s34 offen offset:0
  buffer_load_dwordx4 v[228:231], v1, s[4:7], s34 offen offset:1024
  buffer_load_dwordx4 v[232:235], v1, s[4:7], s34 offen offset:2048
  buffer_load_dwordx4 v[236:239], v1, s[4:7], s34 offen offset:3072
  s_add_u32 s34, s34, 4096
  buffer_load_dwordx4 v[240:243], v1, s[4:7], s34 offen offset:0
  buffer_load_dwordx4 v[244:247], v1, s[4:7], s34 offen offset:1024
  buffer_load_dwordx4 v[248:251], v1, s[4:7], s34 offen offset:2048
  buffer_load_dwordx4 v[252:255], v1, s[4:7], s34 offen offset:3072
  s_waitcnt vmcnt(20)
  s_lshl_b32 s34, s13, 3
  v_mov_b32 v30, s34
reca_cens178:
  buffer_load_dwordx2 v[28:29], v30, s[8:11], 0 offen sc1
  s_waitcnt vmcnt(0)
  v_readfirstlane_b32 s35, v28
  v_readfirstlane_b32 s36, v29
  v_sad_u8 v28, v28, 0, 0
  v_sad_u8 v28, v29, 0, v28
  s_nop 0
  v_readfirstlane_b32 s34, v28
  s_nop 3
  s_cmp_ge_u32 s34, 32
  s_cbranch_scc1 reca_censok179
  s_sleep 8
  s_sub_u32 s18, s18, 1
  s_cbranch_scc0 reca_cens178
  s_mov_b32 s18, 0
reca_censok179:
  s_lshl_b32 s34, s42, 3
  s_mov_b32 s37, s36
  s_mov_b32 s36, s35
  s_lshr_b64 s[36:37], s[36:37], s34
  s_and_b32 s36, s36, 0xff
  s_cmp_eq_u32 s36, 32
  s_cselect_b32 s43, 0, 1
  s_cmp_lg_u32 s43, 0
  s_cbranch_scc1 reca_pslow180
reca_ptop181:
  s_cmp_lt_u32 s17, 6
  s_cbranch_scc1 reca_pgo182
  s_sub_u32 s36, s17, 6
reca_ppoll183:
  buffer_load_dword v28, v4, s[4:7], s25 offen sc1
  s_waitcnt vmcnt(0)
  v_readfirstlane_b32 s34, v28
  s_nop 3
  s_cmp_ge_i32 s34, s36
  s_cbranch_scc1 reca_pgo182
  s_sleep 8
  s_sub_u32 s18, s18, 1
  s_cbranch_scc0 reca_ppoll183
  s_mov_b32 s18, 0
reca_pgo182:
  s_waitcnt vmcnt(0)
  s_barrier
  v_add_u32 v7, s26, v1
  s_xor_b32 s26, s26, 40960
  s_add_u32 s37, s17, 1
  s_cmp_ge_u32 s37, 64
  s_cbranch_scc1 reca_pnodma184
  s_mul_i32 s20, s37, 40960
  s_add_u32 s20, s20, 153626624
  s_add_u32 m0, s26, 10240
  s_nop 0
  buffer_load_dwordx4 v1, s[4:7], s20 offen offset:0 lds
  buffer_load_dwordx4 v1, s[4:7], s20 offen offset:1024 lds
  buffer_load_dwordx4 v1, s[4:7], s20 offen offset:2048 lds
  buffer_load_dwordx4 v1, s[4:7], s20 offen offset:3072 lds
  s_add_u32 s20, s20, 4096
  s_add_u32 m0, s26, 14336
  s_nop 0
  buffer_load_dwordx4 v1, s[4:7], s20 offen offset:0 lds
  buffer_load_dwordx4 v1, s[4:7], s20 offen offset:1024 lds
  buffer_load_dwordx4 v1, s[4:7], s20 offen offset:2048 lds
  buffer_load_dwordx4 v1, s[4:7], s20 offen offset:3072 lds
  s_add_u32 s20, s20, 4096
  s_add_u32 m0, s26, 18432
  s_nop 0
  buffer_load_dwordx4 v1, s[4:7], s20 offen offset:0 lds
  buffer_load_dwordx4 v1, s[4:7], s20 offen offset:1024 lds
  s_lshl_b32 s34, s15, 6
  s_add_u32 s34, s34, s37
  s_mul_i32 s34, s34, 12288
  s_mul_i32 s35, s16, 3072
  s_add_u32 s35, s35, s34
  s_add_u32 s27, s35, 37748736
  s_mul_i32 s35, s16, 6144
  s_add_u32 s35, s35, s34
  s_add_u32 s28, s35, 62914560
  s_add_u32 s34, s27, 2048
  buffer_load_dwordx4 v[16:19], v1, s[4:7], s34 offen sc1
  s_add_u32 s34, s27, 8192
  buffer_load_dwordx4 v[16:19], v1, s[4:7], s34 offen sc1
  s_add_u32 s34, s28, 1024
  buffer_load_dwordx4 v[16:19], v1, s[4:7], s34 offen sc1
  s_add_u32 s34, s28, 2048
  buffer_load_dwordx4 v[16:19], v1, s[4:7], s34 offen sc1
  s_add_u32 s34, s28, 3072
  buffer_load_dwordx4 v[16:19], v1, s[4:7], s34 offen sc1
reca_pnodma184:
  s_lshl_b32 s34, s15, 6
  s_add_u32 s34, s34, s17
  s_mul_i32 s34, s34, 12288
  s_mul_i32 s35, s16, 3072
  s_add_u32 s35, s35, s34
  s_add_u32 s21, s35, 37748736
  s_add_u32 s22, s35, 88080384
  s_mul_i32 s35, s16, 6144
  s_add_u32 s35, s35, s34
  s_add_u32 s23, s35, 62914560
  ds_read_b128 v[72:75], v7 offset:0
  ds_read_b128 v[76:79], v7 offset:20480
  ds_read_b128 v[80:83], v7 offset:1024
  ds_read_b128 v[84:87], v7 offset:21504
  ds_read_b128 v[88:91], v7 offset:2048
  ds_read_b128 v[92:95], v7 offset:22528
  s_waitcnt lgkmcnt(4)
  v_mfma_f32_16x16x32_bf16 v[32:35], a[0:3], v[72:75], 0
  v_mfma_f32_16x16x32_bf16 v[36:39], a[0:3], v[76:79], 0
  v_mfma_f32_16x16x32_bf16 v[40:43], a[80:83], v[72:75], 0
  v_mfma_f32_16x16x32_bf16 v[44:47], a[80:83], v[76:79], 0
  v_mfma_f32_16x16x32_bf16 v[48:51], v[72:75], a[160:163], 0
  v_mfma_f32_16x16x32_bf16 v[52:55], v[76:79], a[160:163], 0
  v_mfma_f32_16x16x32_bf16 v[56:59], v[72:75], v[96:99], 0
  v_mfma_f32_16x16x32_bf16 v[60:63], v[76:79], v[96:99], 0
  v_mfma_f32_16x16x32_bf16 v[64:67], v[72:75], v[176:179], 0
  v_mfma_f32_16x16x32_bf16 v[68:71], v[76:79], v[176:179], 0
  ds_read_b128 v[72:75], v7 offset:3072
  ds_read_b128 v[76:79], v7 offset:23552
  s_waitcnt lgkmcnt(4)
  v_mfma_f32_16x16x32_bf16 v[32:35], a[4:7], v[80:83], v[32:35]
  v_mfma_f32_16x16x32_bf16 v[36:39], a[4:7], v[84:87], v[36:39]
  v_mfma_f32_16x16x32_bf16 v[40:43], a[84:87], v[80:83], v[40:43]
  v_mfma_f32_16x16x32_bf16 v[44:47], a[84:87], v[84:87], v[44:47]
  v_mfma_f32_16x16x32_bf16 v[48:51], v[80:83], a[164:167], v[48:51]
  v_mfma_f32_16x16x32_bf16 v[52:55], v[84:87], a[164:167], v[52:55]
  v_mfma_f32_16x16x32_bf16 v[56:59], v[80:83], v[100:103], v[56:59]
  v_mfma_f32_16x16x32_bf16 v[60:63], v[84:87], v[100:103], v[60:63]
  v_mfma_f32_16x16x32_bf16 v[64:67], v[80:83], v[180:183], v[64:67]
  v_mfma_f32_16x16x32_bf16 v[68:71], v[84:87], v[180:183], v[68:71]
  ds_read_b128 v[80:83], v7 offset:4096
  ds_read_b128 v[84:87], v7 offset:24576
  s_waitcnt lgkmcnt(4)
  v_mfma_f32_16x16x32_bf16 v[32:35], a[8:11], v[88:91], v[32:35]
  v_mfma_f32_16x16x32_bf16 v[36:39], a[8:11], v[92:95], v[36:39]
  v_mfma_f32_16x16x32_bf16 v[40:43], a[88:91], v[88:91], v[40:43]
  v_mfma_f32_16x16x32_bf16 v[44:47], a[88:91], v[92:95], v[44:47]
  v_mfma_f32_16x16x32_bf16 v[48:51], v[88:91], a[168:171], v[48:51]
  v_mfma_f32_16x16x32_bf16 v[52:55], v[92:95], a[168:171], v[52:55]
  v_mfma_f32_16x16x32_bf16 v[56:59], v[88:91], v[104:107], v[56:59]
  v_mfma_f32_16x16x32_bf16 v[60:63], v[92:95], v[104:107], v[60:63]
  v_mfma_f32_16x16x32_bf16 v[64:67], v[88:91], v[184:187], v[64:67]
  v_mfma_f32_16x16x32_bf16 v[68:71], v[92:95], v[184:187], v[68:71]
  ds_read_b128 v[88:91], v7 offset:5120
  ds_read_b128 v[92:95], v7 offset:25600
  s_waitcnt lgkmcnt(4)
  v_mfma_f32_16x16x32_bf16 v[32:35], a[12:15], v[72:75], v[32:35]
  v_mfma_f32_16x16x32_bf16 v[36:39], a[12:15], v[76:79], v[36:39]
  v_mfma_f32_16x16x32_bf16 v[40:43], a[92:95], v[72:75], v[40:43]
  v_mfma_f32_16x16x32_bf16 v[44:47], a[92:95], v[76:79], v[44:47]
  v_mfma_f32_16x16x32_bf16 v[48:51], v[72:75], a[172:175], v[48:51]
  v_mfma_f32_16x16x32_bf16 v[52:55], v[76:79], a[172:175], v[52:55]
  v_mfma_f32_16x16x32_bf16 v[56:59], v[72:75], v[108:111], v[56:59]
  v_mfma_f32_16x16x32_bf16 v[60:63], v[76:79], v[108:111], v[60:63]
  v_mfma_f32_16x16x32_bf16 v[64:67], v[72:75], v[188:191], v[64:67]
  v_mfma_f32_16x16x32_bf16 v[68:71], v[76:79], v[188:191], v[68:71]
  ds_read_b128 v[72:75], v7 offset:6144
  ds_read_b128 v[76:79], v7 offset:26624
  s_waitcnt lgkmcnt(4)
  v_mfma_f32_16x16x32_bf16 v[32:35], a[16:19], v[80:83], v[32:35]
  v_mfma_f32_16x16x32_bf16 v[36:39], a[16:19], v[84:87], v[36:39]
  v_mfma_f32_16x16x32_bf16 v[40:43], a[96:99], v[80:83], v[40:43]
  v_mfma_f32_16x16x32_bf16 v[44:47], a[96:99], v[84:87], v[44:47]
  v_mfma_f32_16x16x32_bf16 v[48:51], v[80:83], a[176:179], v[48:51]
  v_mfma_f32_16x16x32_bf16 v[52:55], v[84:87], a[176:179], v[52:55]
  v_mfma_f32_16x16x32_bf16 v[56:59], v[80:83], v[112:115], v[56:59]
  v_mfma_f32_16x16x32_bf16 v[60:63], v[84:87], v[112:115], v[60:63]
  v_mfma_f32_16x16x32_bf16 v[64:67], v[80:83], v[192:195], v[64:67]
  v_mfma_f32_16x16x32_bf16 v[68:71], v[84:87], v[192:195], v[68:71]
  ds_read_b128 v[80:83], v7 offset:7168
  ds_read_b128 v[84:87], v7 offset:27648
  s_waitcnt lgkmcnt(4)
  v_mfma_f32_16x16x32_bf16 v[32:35], a[20:23], v[88:91], v[32:35]
  v_mfma_f32_16x16x32_bf16 v[36:39], a[20:23], v[92:95], v[36:39]
  v_mfma_f32_16x16x32_bf16 v[40:43], a[100:103], v[88:91], v[40:43]
  v_mfma_f32_16x16x32_bf16 v[44:47], a[100:103], v[92:95], v[44:47]
  v_mfma_f32_16x16x32_bf16 v[48:51], v[88:91], a[180:183], v[48:51]
  v_mfma_f32_16x16x32_bf16 v[52:55], v[92:95], a[180:183], v[52:55]
  v_mfma_f32_16x16x32_bf16 v[56:59], v[88:91], v[116:119], v[56:59]
  v_mfma_f32_16x16x32_bf16 v[60:63], v[92:95], v[116:119], v[60:63]
  v_mfma_f32_16x16x32_bf16 v[64:67], v[88:91], v[196:199], v[64:67]
  v_mfma_f32_16x16x32_bf16 v[68:71], v[92:95], v[196:199], v[68:71]
  ds_read_b128 v[88:91], v7 offset:8192
  ds_read_b128 v[92:95], v7 offset:28672
  s_waitcnt lgkmcnt(4)
  v_mfma_f32_16x16x32_bf16 v[32:35], a[24:27], v[72:75], v[32:35]
  v_mfma_f32_16x16x32_bf16 v[36:39], a[24:27], v[76:79], v[36:39]
  v_mfma_f32_16x16x32_bf16 v[40:43], a[104:107], v[72:75], v[40:43]
  v_mfma_f32_16x16x32_bf16 v[44:47], a[104:107], v[76:79], v[44:47]
  v_mfma_f32_16x16x32_bf16 v[48:51], v[72:75], a[184:187], v[48:51]
  v_mfma_f32_16x16x32_bf16 v[52:55], v[76:79], a[184:187], v[52:55]
  v_mfma_f32_16x16x32_bf16 v[56:59], v[72:75], v[120:123], v[56:59]
  v_mfma_f32_16x16x32_bf16 v[60:63], v[76:79], v[120:123], v[60:63]
  v_mfma_f32_16x16x32_bf16 v[64:67], v[72:75], v[200:203], v[64:67]
  v_mfma_f32_16x16x32_bf16 v[68:71], v[76:79], v[200:203], v[68:71]
  ds_read_b128 v[72:75], v7 offset:9216
  ds_read_b128 v[76:79], v7 offset:29696
  s_waitcnt lgkmcnt(4)
  v_mfma_f32_16x16x32_bf16 v[32:35], a[28:31], v[80:83], v[32:35]
  v_mfma_f32_16x16x32_bf16 v[36:39], a[28:31], v[84:87], v[36:39]
  v_mfma_f32_16x16x32_bf16 v[40:43], a[108:111], v[80:83], v[40:43]
  v_mfma_f32_16x16x32_bf16 v[44:47], a[108:111], v[84:87], v[44:47]
  v_mfma_f32_16x16x32_bf16 v[48:51], v[80:83], a[188:191], v[48:51]
  v_mfma_f32_16x16x32_bf16 v[52:55], v[84:87], a[188:191], v[52:55]
  v_mfma_f32_16x16x32_bf16 v[56:59], v[80:83], v[124:127], v[56:59]
  v_mfma_f32_16x16x32_bf16 v[60:63], v[84:87], v[124:127], v[60:63]
  v_mfma_f32_16x16x32_bf16 v[64:67], v[80:83], v[204:207], v[64:67]
  v_mfma_f32_16x16x32_bf16 v[68:71], v[84:87], v[204:207], v[68:71]
  ds_read_b128 v[80:83], v7 offset:10240
  ds_read_b128 v[84:87], v7 offset:30720
  s_waitcnt lgkmcnt(4)
  v_mfma_f32_16x16x32_bf16 v[32:35], a[32:35], v[88:91], v[32:35]
  v_mfma_f32_16x16x32_bf16 v[36:39], a[32:35], v[92:95], v[36:39]
  v_mfma_f32_16x16x32_bf16 v[40:43], a[112:115], v[88:91], v[40:43]
  v_mfma_f32_16x16x32_bf16 v[44:47], a[112:115], v[92:95], v[44:47]
  v_mfma_f32_16x16x32_bf16 v[48:51], v[88:91], a[192:195], v[48:51]
  v_mfma_f32_16x16x32_bf16 v[52:55], v[92:95], a[192:195], v[52:55]
  v_mfma_f32_16x16x32_bf16 v[56:59], v[88:91], v[128:131], v[56:59]
  v_mfma_f32_16x16x32_bf16 v[60:63], v[92:95], v[128:131], v[60:63]
  v_mfma_f32_16x16x32_bf16 v[64:67], v[88:91], v[208:211], v[64:67]
  v_mfma_f32_16x16x32_bf16 v[68:71], v[92:95], v[208:211], v[68:71]
  ds_read_b128 v[88:91], v7 offset:11264
  ds_read_b128 v[92:95], v7 offset:31744
  s_waitcnt lgkmcnt(4)
  v_mfma_f32_16x16x32_bf16 v[32:35], a[36:39], v[72:75], v[32:35]
  v_mfma_f32_16x16x32_bf16 v[36:39], a[36:39], v[76:79], v[36:39]
  v_mfma_f32_16x16x32_bf16 v[40:43], a[116:119], v[72:75], v[40:43]
  v_mfma_f32_16x16x32_bf16 v[44:47], a[116:119], v[76:79], v[44:47]
  v_mfma_f32_16x16x32_bf16 v[48:51], v[72:75], a[196:199], v[48:51]
  v_mfma_f32_16x16x32_bf16 v[52:55], v[76:79], a[196:199], v[52:55]
  v_mfma_f32_16x16x32_bf16 v[56:59], v[72:75], v[132:135], v[56:59]
  v_mfma_f32_16x16x32_bf16 v[60:63], v[76:79], v[132:135], v[60:63]
  v_mfma_f32_16x16x32_bf16 v[64:67], v[72:75], v[212:215], v[64:67]
  v_mfma_f32_16x16x32_bf16 v[68:71], v[76:79], v[212:215], v[68:71]
  ds_read_b128 v[72:75], v7 offset:12288
  ds_read_b128 v[76:79], v7 offset:32768
  s_waitcnt lgkmcnt(4)
  v_mfma_f32_16x16x32_bf16 v[32:35], a[40:43], v[80:83], v[32:35]
  v_mfma_f32_16x16x32_bf16 v[36:39], a[40:43], v[84:87], v[36:39]
  v_mfma_f32_16x16x32_bf16 v[40:43], a[120:123], v[80:83], v[40:43]
  v_mfma_f32_16x16x32_bf16 v[44:47], a[120:123], v[84:87], v[44:47]
  v_mfma_f32_16x16x32_bf16 v[48:51], v[80:83], a[200:203], v[48:51]
  v_mfma_f32_16x16x32_bf16 v[52:55], v[84:87], a[200:203], v[52:55]
  v_mfma_f32_16x16x32_bf16 v[56:59], v[80:83], v[136:139], v[56:59]
  v_mfma_f32_16x16x32_bf16 v[60:63], v[84:87], v[136:139], v[60:63]
  v_mfma_f32_16x16x32_bf16 v[64:67], v[80:83], v[216:219], v[64:67]
  v_mfma_f32_16x16x32_bf16 v[68:71], v[84:87], v[216:219], v[68:71]
  ds_read_b128 v[80:83], v7 offset:13312
  ds_read_b128 v[84:87], v7 offset:33792
  s_waitcnt lgkmcnt(4)
  v_mfma_f32_16x16x32_bf16 v[32:35], a[44:47], v[88:91], v[32:35]
  v_mfma_f32_16x16x32_bf16 v[36:39], a[44:47], v[92:95], v[36:39]
  v_mfma_f32_16x16x32_bf16 v[40:43], a[124:127], v[88:91], v[40:43]
  v_mfma_f32_16x16x32_bf16 v[44:47], a[124:127], v[92:95], v[44:47]
  v_mfma_f32_16x16x32_bf16 v[48:51], v[88:91], a[204:207], v[48:51]
  v_mfma_f32_16x16x32_bf16 v[52:55], v[92:95], a[204:207], v[52:55]
  v_mfma_f32_16x16x32_bf16 v[56:59], v[88:91], v[140:143], v[56:59]
  v_mfma_f32_16x16x32_bf16 v[60:63], v[92:95], v[140:143], v[60:63]
  v_mfma_f32_16x16x32_bf16 v[64:67], v[88:91], v[220:223], v[64:67]
  v_mfma_f32_16x16x32_bf16 v[68:71], v[92:95], v[220:223], v[68:71]
  ds_read_b128 v[88:91], v7 offset:14336
  ds_read_b128 v[92:95], v7 offset:34816
  s_waitcnt lgkmcnt(4)
  v_mfma_f32_16x16x32_bf16 v[32:35], a[48:51], v[72:75], v[32:35]
  v_mfma_f32_16x16x32_bf16 v[36:39], a[48:51], v[76:79], v[36:39]
  v_mfma_f32_16x16x32_bf16 v[40:43], a[128:131], v[72:75], v[40:43]
  v_mfma_f32_16x16x32_bf16 v[44:47], a[128:131], v[76:79], v[44:47]
  v_mfma_f32_16x16x32_bf16 v[48:51], v[72:75], a[208:211], v[48:51]
  v_mfma_f32_16x16x32_bf16 v[52:55], v[76:79], a[208:211], v[52:55]
  v_mfma_f32_16x16x32_bf16 v[56:59], v[72:75], v[144:147], v[56:59]
  v_mfma_f32_16x16x32_bf16 v[60:63], v[76:79], v[144:147], v[60:63]
  v_mfma_f32_16x16x32_bf16 v[64:67], v[72:75], v[224:227], v[64:67]
  v_mfma_f32_16x16x32_bf16 v[68:71], v[76:79], v[224:227], v[68:71]
  ds_read_b128 v[72:75], v7 offset:15360
  ds_read_b128 v[76:79], v7 offset:35840
  s_waitcnt lgkmcnt(4)
  v_mfma_f32_16x16x32_bf16 v[32:35], a[52:55], v[80:83], v[32:35]
  v_mfma_f32_16x16x32_bf16 v[36:39], a[52:55], v[84:87], v[36:39]
  v_mfma_f32_16x16x32_bf16 v[40:43], a[132:135], v[80:83], v[40:43]
  v_mfma_f32_16x16x32_bf16 v[44:47], a[132:135], v[84:87], v[44:47]
  v_mfma_f32_16x16x32_bf16 v[48:51], v[80:83], a[212:215], v[48:51]
  v_mfma_f32_16x16x32_bf16 v[52:55], v[84:87], a[212:215], v[52:55]
  v_mfma_f32_16x16x32_bf16 v[56:59], v[80:83], v[148:151], v[56:59]
  v_mfma_f32_16x16x32_bf16 v[60:63], v[84:87], v[148:151], v[60:63]
  v_mfma_f32_16x16x32_bf16 v[64:67], v[80:83], v[228:231], v[64:67]
  v_mfma_f32_16x16x32_bf16 v[68:71], v[84:87], v[228:231], v[68:71]
  ds_read_b128 v[80:83], v7 offset:16384
  ds_read_b128 v[84:87], v7 offset:36864
  s_waitcnt lgkmcnt(4)
  v_mfma_f32_16x16x32_bf16 v[32:35], a[56:59], v[88:91], v[32:35]
  v_mfma_f32_16x16x32_bf16 v[36:39], a[56:59], v[92:95], v[36:39]
  v_mfma_f32_16x16x32_bf16 v[40:43], a[136:139], v[88:91], v[40:43]
  v_mfma_f32_16x16x32_bf16 v[44:47], a[136:139], v[92:95], v[44:47]
  v_mfma_f32_16x16x32_bf16 v[48:51], v[88:91], a[216:219], v[48:51]
  v_mfma_f32_16x16x32_bf16 v[52:55], v[92:95], a[216:219], v[52:55]
  v_mfma_f32_16x16x32_bf16 v[56:59], v[88:91], v[152:155], v[56:59]
  v_mfma_f32_16x16x32_bf16 v[60:63], v[92:95], v[152:155], v[60:63]
  v_mfma_f32_16x16x32_bf16 v[64:67], v[88:91], v[232:235], v[64:67]
  v_mfma_f32_16x16x32_bf16 v[68:71], v[92:95], v[232:235], v[68:71]
  ds_read_b128 v[88:91], v7 offset:17408
  ds_read_b128 v[92:95], v7 offset:37888
  s_waitcnt lgkmcnt(4)
  v_mfma_f32_16x16x32_bf16 v[32:35], a[60:63], v[72:75], v[32:35]
  v_mfma_f32_16x16x32_bf16 v[36:39], a[60:63], v[76:79], v[36:39]
  v_mfma_f32_16x16x32_bf16 v[40:43], a[140:143], v[72:75], v[40:43]
  v_mfma_f32_16x16x32_bf16 v[44:47], a[140:143], v[76:79], v[44:47]
  v_mfma_f32_16x16x32_bf16 v[48:51], v[72:75], a[220:223], v[48:51]
  v_mfma_f32_16x16x32_bf16 v[52:55], v[76:79], a[220:223], v[52:55]
  v_mfma_f32_16x16x32_bf16 v[56:59], v[72:75], v[156:159], v[56:59]
  v_mfma_f32_16x16x32_bf16 v[60:63], v[76:79], v[156:159], v[60:63]
  v_mfma_f32_16x16x32_bf16 v[64:67], v[72:75], v[236:239], v[64:67]
  v_mfma_f32_16x16x32_bf16 v[68:71], v[76:79], v[236:239], v[68:71]
  ds_read_b128 v[72:75], v7 offset:18432
  ds_read_b128 v[76:79], v7 offset:38912
  s_waitcnt lgkmcnt(4)
  v_mfma_f32_16x16x32_bf16 v[32:35], a[64:67], v[80:83], v[32:35]
  v_mfma_f32_16x16x32_bf16 v[36:39], a[64:67], v[84:87], v[36:39]
  v_mfma_f32_16x16x32_bf16 v[40:43], a[144:147], v[80:83], v[40:43]
  v_mfma_f32_16x16x32_bf16 v[44:47], a[144:147], v[84:87], v[44:47]
  v_mfma_f32_16x16x32_bf16 v[48:51], v[80:83], a[224:227], v[48:51]
  v_mfma_f32_16x16x32_bf16 v[52:55], v[84:87], a[224:227], v[52:55]
  v_mfma_f32_16x16x32_bf16 v[56:59], v[80:83], v[160:163], v[56:59]
  v_mfma_f32_16x16x32_bf16 v[60:63], v[84:87], v[160:163], v[60:63]
  v_mfma_f32_16x16x32_bf16 v[64:67], v[80:83], v[240:243], v[64:67]
  v_mfma_f32_16x16x32_bf16 v[68:71], v[84:87], v[240:243], v[68:71]
  ds_read_b128 v[80:83], v7 offset:19456
  ds_read_b128 v[84:87], v7 offset:39936
  s_waitcnt lgkmcnt(4)
  v_mfma_f32_16x16x32_bf16 v[32:35], a[68:71], v[88:91], v[32:35]
  v_mfma_f32_16x16x32_bf16 v[36:39], a[68:71], v[92:95], v[36:39]
  v_mfma_f32_16x16x32_bf16 v[40:43], a[148:151], v[88:91], v[40:43]
  v_mfma_f32_16x16x32_bf16 v[44:47], a[148:151], v[92:95], v[44:47]
  v_mfma_f32_16x16x32_bf16 v[48:51], v[88:91], a[228:231], v[48:51]
  v_mfma_f32_16x16x32_bf16 v[52:55], v[92:95], a[228:231], v[52:55]
  v_mfma_f32_16x16x32_bf16 v[56:59], v[88:91], v[164:167], v[56:59]
  v_mfma_f32_16x16x32_bf16 v[60:63], v[92:95], v[164:167], v[60:63]
  v_mfma_f32_16x16x32_bf16 v[64:67], v[88:91], v[244:247], v[64:67]
  v_mfma_f32_16x16x32_bf16 v[68:71], v[92:95], v[244:247], v[68:71]
  s_waitcnt lgkmcnt(2)
  v_mfma_f32_16x16x32_bf16 v[32:35], a[72:75], v[72:75], v[32:35]
  v_mfma_f32_16x16x32_bf16 v[36:39], a[72:75], v[76:79], v[36:39]
  v_mfma_f32_16x16x32_bf16 v[40:43], a[152:155], v[72:75], v[40:43]
  v_mfma_f32_16x16x32_bf16 v[44:47], a[152:155], v[76:79], v[44:47]
  v_mfma_f32_16x16x32_bf16 v[48:51], v[72:75], a[232:235], v[48:51]
  v_mfma_f32_16x16x32_bf16 v[52:55], v[76:79], a[232:235], v[52:55]
  v_mfma_f32_16x16x32_bf16 v[56:59], v[72:75], v[168:171], v[56:59]
  v_mfma_f32_16x16x32_bf16 v[60:63], v[76:79], v[168:171], v[60:63]
  v_mfma_f32_16x16x32_bf16 v[64:67], v[72:75], v[248:251], v[64:67]
  v_mfma_f32_16x16x32_bf16 v[68:71], v[76:79], v[248:251], v[68:71]
  s_waitcnt lgkmcnt(0)
  v_mfma_f32_16x16x32_bf16 v[32:35], a[76:79], v[80:83], v[32:35]
  v_mfma_f32_16x16x32_bf16 v[36:39], a[76:79], v[84:87], v[36:39]
  v_mfma_f32_16x16x32_bf16 v[40:43], a[156:159], v[80:83], v[40:43]
  v_mfma_f32_16x16x32_bf16 v[44:47], a[156:159], v[84:87], v[44:47]
  v_mfma_f32_16x16x32_bf16 v[48:51], v[80:83], a[236:239], v[48:51]
  v_mfma_f32_16x16x32_bf16 v[52:55], v[84:87], a[236:239], v[52:55]
  v_mfma_f32_16x16x32_bf16 v[56:59], v[80:83], v[172:175], v[56:59]
  v_mfma_f32_16x16x32_bf16 v[60:63], v[84:87], v[172:175], v[60:63]
  v_mfma_f32_16x16x32_bf16 v[64:67], v[80:83], v[252:255], v[64:67]
  v_mfma_f32_16x16x32_bf16 v[68:71], v[84:87], v[252:255], v[68:71]
  v_cvt_pk_bf16_f32 v8, v32, v33
  v_cvt_pk_bf16_f32 v9, v34, v35
  v_cvt_pk_bf16_f32 v10, v40, v41
  v_cvt_pk_bf16_f32 v11, v42, v43
  s_add_u32 s34, s21, 2048
  buffer_store_dwordx4 v[8:11], v1, s[4:7], s34 offen
  v_cvt_pk_bf16_f32 v12, v36, v37
  v_cvt_pk_bf16_f32 v13, v38, v39
  v_cvt_pk_bf16_f32 v14, v44, v45
  v_cvt_pk_bf16_f32 v15, v46, v47
  s_add_u32 s34, s21, 8192
  buffer_store_dwordx4 v[12:15], v1, s[4:7], s34 offen
  v_cvt_pk_bf16_f32 v8, v48, v49
  v_cvt_pk_bf16_f32 v9, v50, v51
  v_cvt_pk_bf16_f32 v10, v52, v53
  v_cvt_pk_bf16_f32 v11, v54, v55
  s_add_u32 s34, s23, 1024
  buffer_store_dwordx4 v[8:11], v1, s[4:7], s34 offen
  v_cvt_pk_bf16_f32 v12, v56, v57
  v_cvt_pk_bf16_f32 v13, v58, v59
  v_cvt_pk_bf16_f32 v14, v60, v61
  v_cvt_pk_bf16_f32 v15, v62, v63
  s_add_u32 s34, s23, 2048
  buffer_store_dwordx4 v[12:15], v1, s[4:7], s34 offen
  v_cvt_pk_bf16_f32 v8, v64, v65
  v_cvt_pk_bf16_f32 v9, v66, v67
  v_cvt_pk_bf16_f32 v10, v68, v69
  v_cvt_pk_bf16_f32 v11, v70, v71
  s_add_u32 s34, s23, 3072
  buffer_store_dwordx4 v[8:11], v1, s[4:7], s34 offen
  s_waitcnt vmcnt(0)
  s_barrier
  s_add_u32 s17, s17, 1
  s_cmp_lt_u32 s17, 64
  s_cbranch_scc1 reca_ptop181
  s_branch reca_exit1
reca_pslow180:
reca_ptop186:
  s_cmp_lt_u32 s17, 6
  s_cbranch_scc1 reca_pgo187
  s_sub_u32 s36, s17, 6
reca_ppoll188:
  buffer_load_dword v28, v4, s[4:7], s25 offen sc1
  s_waitcnt vmcnt(0)
  v_readfirstlane_b32 s34, v28
  s_nop 3
  s_cmp_ge_i32 s34, s36
  s_cbranch_scc1 reca_pgo187
  s_sleep 8
  s_sub_u32 s18, s18, 1
  s_cbranch_scc0 reca_ppoll188
  s_mov_b32 s18, 0
reca_pgo187:
  s_waitcnt vmcnt(0)
  s_barrier
  v_add_u32 v7, s26, v1
  s_xor_b32 s26, s26, 40960
  s_add_u32 s37, s17, 1
  s_cmp_ge_u32 s37, 64
  s_cbranch_scc1 reca_pnodma189
  s_mul_i32 s20, s37, 40960
  s_add_u32 s20, s20, 153626624
  s_add_u32 m0, s26, 10240
  s_nop 0
  buffer_load_dwordx4 v1, s[4:7], s20 offen offset:0 lds
  buffer_load_dwordx4 v1, s[4:7], s20 offen offset:1024 lds
  buffer_load_dwordx4 v1, s[4:7], s20 offen offset:2048 lds
  buffer_load_dwordx4 v1, s[4:7], s20 offen offset:3072 lds
  s_add_u32 s20, s20, 4096
  s_add_u32 m0, s26, 14336
  s_nop 0
  buffer_load_dwordx4 v1, s[4:7], s20 offen offset:0 lds
  buffer_load_dwordx4 v1, s[4:7], s20 offen offset:1024 lds
  buffer_load_dwordx4 v1, s[4:7], s20 offen offset:2048 lds
  buffer_load_dwordx4 v1, s[4:7], s20 offen offset:3072 lds
  s_add_u32 s20, s20, 4096
  s_add_u32 m0, s26, 18432
  s_nop 0
  buffer_load_dwordx4 v1, s[4:7], s20 offen offset:0 lds
  buffer_load_dwordx4 v1, s[4:7], s20 offen offset:1024 lds
  s_lshl_b32 s34, s15, 6
  s_add_u32 s34, s34, s37
  s_mul_i32 s34, s34, 12288
  s_mul_i32 s35, s16, 3072
  s_add_u32 s35, s35, s34
  s_add_u32 s27, s35, 37748736
  s_mul_i32 s35, s16, 6144
  s_add_u32 s35, s35, s34
  s_add_u32 s28, s35, 62914560
  s_add_u32 s34, s27, 2048
  buffer_load_dwordx4 v[16:19], v1, s[4:7], s34 offen sc1
  s_add_u32 s34, s27, 8192
  buffer_load_dwordx4 v[16:19], v1, s[4:7], s34 offen sc1
  s_add_u32 s34, s28, 1024
  buffer_load_dwordx4 v[16:19], v1, s[4:7], s34 offen sc1
  s_add_u32 s34, s28, 2048
  buffer_load_dwordx4 v[16:19], v1, s[4:7], s34 offen sc1
  s_add_u32 s34, s28, 3072
  buffer_load_dwordx4 v[16:19], v1, s[4:7], s34 offen sc1
reca_pnodma189:
  s_lshl_b32 s34, s15, 6
  s_add_u32 s34, s34, s17
  s_mul_i32 s34, s34, 12288
  s_mul_i32 s35, s16, 3072
  s_add_u32 s35, s35, s34
  s_add_u32 s21, s35, 37748736
  s_add_u32 s22, s35, 88080384
  s_mul_i32 s35, s16, 6144
  s_add_u32 s35, s35, s34
  s_add_u32 s23, s35, 62914560
  ds_read_b128 v[72:75], v7 offset:0
  ds_read_b128 v[76:79], v7 offset:20480
  ds_read_b128 v[80:83], v7 offset:1024
  ds_read_b128 v[84:87], v7 offset:21504
  ds_read_b128 v[88:91], v7 offset:2048
  ds_read_b128 v[92:95], v7 offset:22528
  s_waitcnt lgkmcnt(4)
  v_mfma_f32_16x16x32_bf16 v[32:35], a[0:3], v[72:75], 0
  v_mfma_f32_16x16x32_bf16 v[36:39], a[0:3], v[76:79], 0
  v_mfma_f32_16x16x32_bf16 v[40:43], a[80:83], v[72:75], 0
  v_mfma_f32_16x16x32_bf16 v[44:47], a[80:83], v[76:79], 0
  v_mfma_f32_16x16x32_bf16 v[48:51], v[72:75], a[160:163], 0
  v_mfma_f32_16x16x32_bf16 v[52:55], v[76:79], a[160:163], 0
  v_mfma_f32_16x16x32_bf16 v[56:59], v[72:75], v[96:99], 0
  v_mfma_f32_16x16x32_bf16 v[60:63], v[76:79], v[96:99], 0
  v_mfma_f32_16x16x32_bf16 v[64:67], v[72:75], v[176:179], 0
  v_mfma_f32_16x16x32_bf16 v[68:71], v[76:79], v[176:179], 0
  ds_read_b128 v[72:75], v7 offset:3072
  ds_read_b128 v[76:79], v7 offset:23552
  s_waitcnt lgkmcnt(4)
  v_mfma_f32_16x16x32_bf16 v[32:35], a[4:7], v[80:83], v[32:35]
  v_mfma_f32_16x16x32_bf16 v[36:39], a[4:7], v[84:87], v[36:39]
  v_mfma_f32_16x16x32_bf16 v[40:43], a[84:87], v[80:83], v[40:43]
  v_mfma_f32_16x16x32_bf16 v[44:47], a[84:87], v[84:87], v[44:47]
  v_mfma_f32_16x16x32_bf16 v[48:51], v[80:83], a[164:167], v[48:51]
  v_mfma_f32_16x16x32_bf16 v[52:55], v[84:87], a[164:167], v[52:55]
  v_mfma_f32_16x16x32_bf16 v[56:59], v[80:83], v[100:103], v[56:59]
  v_mfma_f32_16x16x32_bf16 v[60:63], v[84:87], v[100:103], v[60:63]
  v_mfma_f32_16x16x32_bf16 v[64:67], v[80:83], v[180:183], v[64:67]
  v_mfma_f32_16x16x32_bf16 v[68:71], v[84:87], v[180:183], v[68:71]
  ds_read_b128 v[80:83], v7 offset:4096
  ds_read_b128 v[84:87], v7 offset:24576
  s_waitcnt lgkmcnt(4)
  v_mfma_f32_16x16x32_bf16 v[32:35], a[8:11], v[88:91], v[32:35]
  v_mfma_f32_16x16x32_bf16 v[36:39], a[8:11], v[92:95], v[36:39]
  v_mfma_f32_16x16x32_bf16 v[40:43], a[88:91], v[88:91], v[40:43]
  v_mfma_f32_16x16x32_bf16 v[44:47], a[88:91], v[92:95], v[44:47]
  v_mfma_f32_16x16x32_bf16 v[48:51], v[88:91], a[168:171], v[48:51]
  v_mfma_f32_16x16x32_bf16 v[52:55], v[92:95], a[168:171], v[52:55]
  v_mfma_f32_16x16x32_bf16 v[56:59], v[88:91], v[104:107], v[56:59]
  v_mfma_f32_16x16x32_bf16 v[60:63], v[92:95], v[104:107], v[60:63]
  v_mfma_f32_16x16x32_bf16 v[64:67], v[88:91], v[184:187], v[64:67]
  v_mfma_f32_16x16x32_bf16 v[68:71], v[92:95], v[184:187], v[68:71]
  ds_read_b128 v[88:91], v7 offset:5120
  ds_read_b128 v[92:95], v7 offset:25600
  s_waitcnt lgkmcnt(4)
  v_mfma_f32_16x16x32_bf16 v[32:35], a[12:15], v[72:75], v[32:35]
  v_mfma_f32_16x16x32_bf16 v[36:39], a[12:15], v[76:79], v[36:39]
  v_mfma_f32_16x16x32_bf16 v[40:43], a[92:95], v[72:75], v[40:43]
  v_mfma_f32_16x16x32_bf16 v[44:47], a[92:95], v[76:79], v[44:47]
  v_mfma_f32_16x16x32_bf16 v[48:51], v[72:75], a[172:175], v[48:51]
  v_mfma_f32_16x16x32_bf16 v[52:55], v[76:79], a[172:175], v[52:55]
  v_mfma_f32_16x16x32_bf16 v[56:59], v[72:75], v[108:111], v[56:59]
  v_mfma_f32_16x16x32_bf16 v[60:63], v[76:79], v[108:111], v[60:63]
  v_mfma_f32_16x16x32_bf16 v[64:67], v[72:75], v[188:191], v[64:67]
  v_mfma_f32_16x16x32_bf16 v[68:71], v[76:79], v[188:191], v[68:71]
  ds_read_b128 v[72:75], v7 offset:6144
  ds_read_b128 v[76:79], v7 offset:26624
  s_waitcnt lgkmcnt(4)
  v_mfma_f32_16x16x32_bf16 v[32:35], a[16:19], v[80:83], v[32:35]
  v_mfma_f32_16x16x32_bf16 v[36:39], a[16:19], v[84:87], v[36:39]
  v_mfma_f32_16x16x32_bf16 v[40:43], a[96:99], v[80:83], v[40:43]
  v_mfma_f32_16x16x32_bf16 v[44:47], a[96:99], v[84:87], v[44:47]
  v_mfma_f32_16x16x32_bf16 v[48:51], v[80:83], a[176:179], v[48:51]
  v_mfma_f32_16x16x32_bf16 v[52:55], v[84:87], a[176:179], v[52:55]
  v_mfma_f32_16x16x32_bf16 v[56:59], v[80:83], v[112:115], v[56:59]
  v_mfma_f32_16x16x32_bf16 v[60:63], v[84:87], v[112:115], v[60:63]
  v_mfma_f32_16x16x32_bf16 v[64:67], v[80:83], v[192:195], v[64:67]
  v_mfma_f32_16x16x32_bf16 v[68:71], v[84:87], v[192:195], v[68:71]
  ds_read_b128 v[80:83], v7 offset:7168
  ds_read_b128 v[84:87], v7 offset:27648
  s_waitcnt lgkmcnt(4)
  v_mfma_f32_16x16x32_bf16 v[32:35], a[20:23], v[88:91], v[32:35]
  v_mfma_f32_16x16x32_bf16 v[36:39], a[20:23], v[92:95], v[36:39]
  v_mfma_f32_16x16x32_bf16 v[40:43], a[100:103], v[88:91], v[40:43]
  v_mfma_f32_16x16x32_bf16 v[44:47], a[100:103], v[92:95], v[44:47]
  v_mfma_f32_16x16x32_bf16 v[48:51], v[88:91], a[180:183], v[48:51]
  v_mfma_f32_16x16x32_bf16 v[52:55], v[92:95], a[180:183], v[52:55]
  v_mfma_f32_16x16x32_bf16 v[56:59], v[88:91], v[116:119], v[56:59]
  v_mfma_f32_16x16x32_bf16 v[60:63], v[92:95], v[116:119], v[60:63]
  v_mfma_f32_16x16x32_bf16 v[64:67], v[88:91], v[196:199], v[64:67]
  v_mfma_f32_16x16x32_bf16 v[68:71], v[92:95], v[196:199], v[68:71]
  ds_read_b128 v[88:91], v7 offset:8192
  ds_read_b128 v[92:95], v7 offset:28672
  s_waitcnt lgkmcnt(4)
  v_mfma_f32_16x16x32_bf16 v[32:35], a[24:27], v[72:75], v[32:35]
  v_mfma_f32_16x16x32_bf16 v[36:39], a[24:27], v[76:79], v[36:39]
  v_mfma_f32_16x16x32_bf16 v[40:43], a[104:107], v[72:75], v[40:43]
  v_mfma_f32_16x16x32_bf16 v[44:47], a[104:107], v[76:79], v[44:47]
  v_mfma_f32_16x16x32_bf16 v[48:51], v[72:75], a[184:187], v[48:51]
  v_mfma_f32_16x16x32_bf16 v[52:55], v[76:79], a[184:187], v[52:55]
  v_mfma_f32_16x16x32_bf16 v[56:59], v[72:75], v[120:123], v[56:59]
  v_mfma_f32_16x16x32_bf16 v[60:63], v[76:79], v[120:123], v[60:63]
  v_mfma_f32_16x16x32_bf16 v[64:67], v[72:75], v[200:203], v[64:67]
  v_mfma_f32_16x16x32_bf16 v[68:71], v[76:79], v[200:203], v[68:71]
  ds_read_b128 v[72:75], v7 offset:9216
  ds_read_b128 v[76:79], v7 offset:29696
  s_waitcnt lgkmcnt(4)
  v_mfma_f32_16x16x32_bf16 v[32:35], a[28:31], v[80:83], v[32:35]
  v_mfma_f32_16x16x32_bf16 v[36:39], a[28:31], v[84:87], v[36:39]
  v_mfma_f32_16x16x32_bf16 v[40:43], a[108:111], v[80:83], v[40:43]
  v_mfma_f32_16x16x32_bf16 v[44:47], a[108:111], v[84:87], v[44:47]
  v_mfma_f32_16x16x32_bf16 v[48:51], v[80:83], a[188:191], v[48:51]
  v_mfma_f32_16x16x32_bf16 v[52:55], v[84:87], a[188:191], v[52:55]
  v_mfma_f32_16x16x32_bf16 v[56:59], v[80:83], v[124:127], v[56:59]
  v_mfma_f32_16x16x32_bf16 v[60:63], v[84:87], v[124:127], v[60:63]
  v_mfma_f32_16x16x32_bf16 v[64:67], v[80:83], v[204:207], v[64:67]
  v_mfma_f32_16x16x32_bf16 v[68:71], v[84:87], v[204:207], v[68:71]
  ds_read_b128 v[80:83], v7 offset:10240
  ds_read_b128 v[84:87], v7 offset:30720
  s_waitcnt lgkmcnt(4)
  v_mfma_f32_16x16x32_bf16 v[32:35], a[32:35], v[88:91], v[32:35]
  v_mfma_f32_16x16x32_bf16 v[36:39], a[32:35], v[92:95], v[36:39]
  v_mfma_f32_16x16x32_bf16 v[40:43], a[112:115], v[88:91], v[40:43]
  v_mfma_f32_16x16x32_bf16 v[44:47], a[112:115], v[92:95], v[44:47]
  v_mfma_f32_16x16x32_bf16 v[48:51], v[88:91], a[192:195], v[48:51]
  v_mfma_f32_16x16x32_bf16 v[52:55], v[92:95], a[192:195], v[52:55]
  v_mfma_f32_16x16x32_bf16 v[56:59], v[88:91], v[128:131], v[56:59]
  v_mfma_f32_16x16x32_bf16 v[60:63], v[92:95], v[128:131], v[60:63]
  v_mfma_f32_16x16x32_bf16 v[64:67], v[88:91], v[208:211], v[64:67]
  v_mfma_f32_16x16x32_bf16 v[68:71], v[92:95], v[208:211], v[68:71]
  ds_read_b128 v[88:91], v7 offset:11264
  ds_read_b128 v[92:95], v7 offset:31744
  s_waitcnt lgkmcnt(4)
  v_mfma_f32_16x16x32_bf16 v[32:35], a[36:39], v[72:75], v[32:35]
  v_mfma_f32_16x16x32_bf16 v[36:39], a[36:39], v[76:79], v[36:39]
  v_mfma_f32_16x16x32_bf16 v[40:43], a[116:119], v[72:75], v[40:43]
  v_mfma_f32_16x16x32_bf16 v[44:47], a[116:119], v[76:79], v[44:47]
  v_mfma_f32_16x16x32_bf16 v[48:51], v[72:75], a[196:199], v[48:51]
  v_mfma_f32_16x16x32_bf16 v[52:55], v[76:79], a[196:199], v[52:55]
  v_mfma_f32_16x16x32_bf16 v[56:59], v[72:75], v[132:135], v[56:59]
  v_mfma_f32_16x16x32_bf16 v[60:63], v[76:79], v[132:135], v[60:63]
  v_mfma_f32_16x16x32_bf16 v[64:67], v[72:75], v[212:215], v[64:67]
  v_mfma_f32_16x16x32_bf16 v[68:71], v[76:79], v[212:215], v[68:71]
  ds_read_b128 v[72:75], v7 offset:12288
  ds_read_b128 v[76:79], v7 offset:32768
  s_waitcnt lgkmcnt(4)
  v_mfma_f32_16x16x32_bf16 v[32:35], a[40:43], v[80:83], v[32:35]
  v_mfma_f32_16x16x32_bf16 v[36:39], a[40:43], v[84:87], v[36:39]
  v_mfma_f32_16x16x32_bf16 v[40:43], a[120:123], v[80:83], v[40:43]
  v_mfma_f32_16x16x32_bf16 v[44:47], a[120:123], v[84:87], v[44:47]
  v_mfma_f32_16x16x32_bf16 v[48:51], v[80:83], a[200:203], v[48:51]
  v_mfma_f32_16x16x32_bf16 v[52:55], v[84:87], a[200:203], v[52:55]
  v_mfma_f32_16x16x32_bf16 v[56:59], v[80:83], v[136:139], v[56:59]
  v_mfma_f32_16x16x32_bf16 v[60:63], v[84:87], v[136:139], v[60:63]
  v_mfma_f32_16x16x32_bf16 v[64:67], v[80:83], v[216:219], v[64:67]
  v_mfma_f32_16x16x32_bf16 v[68:71], v[84:87], v[216:219], v[68:71]
  ds_read_b128 v[80:83], v7 offset:13312
  ds_read_b128 v[84:87], v7 offset:33792
  s_waitcnt lgkmcnt(4)
  v_mfma_f32_16x16x32_bf16 v[32:35], a[44:47], v[88:91], v[32:35]
  v_mfma_f32_16x16x32_bf16 v[36:39], a[44:47], v[92:95], v[36:39]
  v_mfma_f32_16x16x32_bf16 v[40:43], a[124:127], v[88:91], v[40:43]
  v_mfma_f32_16x16x32_bf16 v[44:47], a[124:127], v[92:95], v[44:47]
  v_mfma_f32_16x16x32_bf16 v[48:51], v[88:91], a[204:207], v[48:51]
  v_mfma_f32_16x16x32_bf16 v[52:55], v[92:95], a[204:207], v[52:55]
  v_mfma_f32_16x16x32_bf16 v[56:59], v[88:91], v[140:143], v[56:59]
  v_mfma_f32_16x16x32_bf16 v[60:63], v[92:95], v[140:143], v[60:63]
  v_mfma_f32_16x16x32_bf16 v[64:67], v[88:91], v[220:223], v[64:67]
  v_mfma_f32_16x16x32_bf16 v[68:71], v[92:95], v[220:223], v[68:71]
  ds_read_b128 v[88:91], v7 offset:14336
  ds_read_b128 v[92:95], v7 offset:34816
  s_waitcnt lgkmcnt(4)
  v_mfma_f32_16x16x32_bf16 v[32:35], a[48:51], v[72:75], v[32:35]
  v_mfma_f32_16x16x32_bf16 v[36:39], a[48:51], v[76:79], v[36:39]
  v_mfma_f32_16x16x32_bf16 v[40:43], a[128:131], v[72:75], v[40:43]
  v_mfma_f32_16x16x32_bf16 v[44:47], a[128:131], v[76:79], v[44:47]
  v_mfma_f32_16x16x32_bf16 v[48:51], v[72:75], a[208:211], v[48:51]
  v_mfma_f32_16x16x32_bf16 v[52:55], v[76:79], a[208:211], v[52:55]
  v_mfma_f32_16x16x32_bf16 v[56:59], v[72:75], v[144:147], v[56:59]
  v_mfma_f32_16x16x32_bf16 v[60:63], v[76:79], v[144:147], v[60:63]
  v_mfma_f32_16x16x32_bf16 v[64:67], v[72:75], v[224:227], v[64:67]
  v_mfma_f32_16x16x32_bf16 v[68:71], v[76:79], v[224:227], v[68:71]
  ds_read_b128 v[72:75], v7 offset:15360
  ds_read_b128 v[76:79], v7 offset:35840
  s_waitcnt lgkmcnt(4)
  v_mfma_f32_16x16x32_bf16 v[32:35], a[52:55], v[80:83], v[32:35]
  v_mfma_f32_16x16x32_bf16 v[36:39], a[52:55], v[84:87], v[36:39]
  v_mfma_f32_16x16x32_bf16 v[40:43], a[132:135], v[80:83], v[40:43]
  v_mfma_f32_16x16x32_bf16 v[44:47], a[132:135], v[84:87], v[44:47]
  v_mfma_f32_16x16x32_bf16 v[48:51], v[80:83], a[212:215], v[48:51]
  v_mfma_f32_16x16x32_bf16 v[52:55], v[84:87], a[212:215], v[52:55]
  v_mfma_f32_16x16x32_bf16 v[56:59], v[80:83], v[148:151], v[56:59]
  v_mfma_f32_16x16x32_bf16 v[60:63], v[84:87], v[148:151], v[60:63]
  v_mfma_f32_16x16x32_bf16 v[64:67], v[80:83], v[228:231], v[64:67]
  v_mfma_f32_16x16x32_bf16 v[68:71], v[84:87], v[228:231], v[68:71]
  ds_read_b128 v[80:83], v7 offset:16384
  ds_read_b128 v[84:87], v7 offset:36864
  s_waitcnt lgkmcnt(4)
  v_mfma_f32_16x16x32_bf16 v[32:35], a[56:59], v[88:91], v[32:35]
  v_mfma_f32_16x16x32_bf16 v[36:39], a[56:59], v[92:95], v[36:39]
  v_mfma_f32_16x16x32_bf16 v[40:43], a[136:139], v[88:91], v[40:43]
  v_mfma_f32_16x16x32_bf16 v[44:47], a[136:139], v[92:95], v[44:47]
  v_mfma_f32_16x16x32_bf16 v[48:51], v[88:91], a[216:219], v[48:51]
  v_mfma_f32_16x16x32_bf16 v[52:55], v[92:95], a[216:219], v[52:55]
  v_mfma_f32_16x16x32_bf16 v[56:59], v[88:91], v[152:155], v[56:59]
  v_mfma_f32_16x16x32_bf16 v[60:63], v[92:95], v[152:155], v[60:63]
  v_mfma_f32_16x16x32_bf16 v[64:67], v[88:91], v[232:235], v[64:67]
  v_mfma_f32_16x16x32_bf16 v[68:71], v[92:95], v[232:235], v[68:71]
  ds_read_b128 v[88:91], v7 offset:17408
  ds_read_b128 v[92:95], v7 offset:37888
  s_waitcnt lgkmcnt(4)
  v_mfma_f32_16x16x32_bf16 v[32:35], a[60:63], v[72:75], v[32:35]
  v_mfma_f32_16x16x32_bf16 v[36:39], a[60:63], v[76:79], v[36:39]
  v_mfma_f32_16x16x32_bf16 v[40:43], a[140:143], v[72:75], v[40:43]
  v_mfma_f32_16x16x32_bf16 v[44:47], a[140:143], v[76:79], v[44:47]
  v_mfma_f32_16x16x32_bf16 v[48:51], v[72:75], a[220:223], v[48:51]
  v_mfma_f32_16x16x32_bf16 v[52:55], v[76:79], a[220:223], v[52:55]
  v_mfma_f32_16x16x32_bf16 v[56:59], v[72:75], v[156:159], v[56:59]
  v_mfma_f32_16x16x32_bf16 v[60:63], v[76:79], v[156:159], v[60:63]
  v_mfma_f32_16x16x32_bf16 v[64:67], v[72:75], v[236:239], v[64:67]
  v_mfma_f32_16x16x32_bf16 v[68:71], v[76:79], v[236:239], v[68:71]
  ds_read_b128 v[72:75], v7 offset:18432
  ds_read_b128 v[76:79], v7 offset:38912
  s_waitcnt lgkmcnt(4)
  v_mfma_f32_16x16x32_bf16 v[32:35], a[64:67], v[80:83], v[32:35]
  v_mfma_f32_16x16x32_bf16 v[36:39], a[64:67], v[84:87], v[36:39]
  v_mfma_f32_16x16x32_bf16 v[40:43], a[144:147], v[80:83], v[40:43]
  v_mfma_f32_16x16x32_bf16 v[44:47], a[144:147], v[84:87], v[44:47]
  v_mfma_f32_16x16x32_bf16 v[48:51], v[80:83], a[224:227], v[48:51]
  v_mfma_f32_16x16x32_bf16 v[52:55], v[84:87], a[224:227], v[52:55]
  v_mfma_f32_16x16x32_bf16 v[56:59], v[80:83], v[160:163], v[56:59]
  v_mfma_f32_16x16x32_bf16 v[60:63], v[84:87], v[160:163], v[60:63]
  v_mfma_f32_16x16x32_bf16 v[64:67], v[80:83], v[240:243], v[64:67]
  v_mfma_f32_16x16x32_bf16 v[68:71], v[84:87], v[240:243], v[68:71]
  ds_read_b128 v[80:83], v7 offset:19456
  ds_read_b128 v[84:87], v7 offset:39936
  s_waitcnt lgkmcnt(4)
  v_mfma_f32_16x16x32_bf16 v[32:35], a[68:71], v[88:91], v[32:35]
  v_mfma_f32_16x16x32_bf16 v[36:39], a[68:71], v[92:95], v[36:39]
  v_mfma_f32_16x16x32_bf16 v[40:43], a[148:151], v[88:91], v[40:43]
  v_mfma_f32_16x16x32_bf16 v[44:47], a[148:151], v[92:95], v[44:47]
  v_mfma_f32_16x16x32_bf16 v[48:51], v[88:91], a[228:231], v[48:51]
  v_mfma_f32_16x16x32_bf16 v[52:55], v[92:95], a[228:231], v[52:55]
  v_mfma_f32_16x16x32_bf16 v[56:59], v[88:91], v[164:167], v[56:59]
  v_mfma_f32_16x16x32_bf16 v[60:63], v[92:95], v[164:167], v[60:63]
  v_mfma_f32_16x16x32_bf16 v[64:67], v[88:91], v[244:247], v[64:67]
  v_mfma_f32_16x16x32_bf16 v[68:71], v[92:95], v[244:247], v[68:71]
  s_waitcnt lgkmcnt(2)
  v_mfma_f32_16x16x32_bf16 v[32:35], a[72:75], v[72:75], v[32:35]
  v_mfma_f32_16x16x32_bf16 v[36:39], a[72:75], v[76:79], v[36:39]
  v_mfma_f32_16x16x32_bf16 v[40:43], a[152:155], v[72:75], v[40:43]
  v_mfma_f32_16x16x32_bf16 v[44:47], a[152:155], v[76:79], v[44:47]
  v_mfma_f32_16x16x32_bf16 v[48:51], v[72:75], a[232:235], v[48:51]
  v_mfma_f32_16x16x32_bf16 v[52:55], v[76:79], a[232:235], v[52:55]
  v_mfma_f32_16x16x32_bf16 v[56:59], v[72:75], v[168:171], v[56:59]
  v_mfma_f32_16x16x32_bf16 v[60:63], v[76:79], v[168:171], v[60:63]
  v_mfma_f32_16x16x32_bf16 v[64:67], v[72:75], v[248:251], v[64:67]
  v_mfma_f32_16x16x32_bf16 v[68:71], v[76:79], v[248:251], v[68:71]
  s_waitcnt lgkmcnt(0)
  v_mfma_f32_16x16x32_bf16 v[32:35], a[76:79], v[80:83], v[32:35]
  v_mfma_f32_16x16x32_bf16 v[36:39], a[76:79], v[84:87], v[36:39]
  v_mfma_f32_16x16x32_bf16 v[40:43], a[156:159], v[80:83], v[40:43]
  v_mfma_f32_16x16x32_bf16 v[44:47], a[156:159], v[84:87], v[44:47]
  v_mfma_f32_16x16x32_bf16 v[48:51], v[80:83], a[236:239], v[48:51]
  v_mfma_f32_16x16x32_bf16 v[52:55], v[84:87], a[236:239], v[52:55]
  v_mfma_f32_16x16x32_bf16 v[56:59], v[80:83], v[172:175], v[56:59]
  v_mfma_f32_16x16x32_bf16 v[60:63], v[84:87], v[172:175], v[60:63]
  v_mfma_f32_16x16x32_bf16 v[64:67], v[80:83], v[252:255], v[64:67]
  v_mfma_f32_16x16x32_bf16 v[68:71], v[84:87], v[252:255], v[68:71]
  v_cvt_pk_bf16_f32 v8, v32, v33
  v_cvt_pk_bf16_f32 v9, v34, v35
  v_cvt_pk_bf16_f32 v10, v40, v41
  v_cvt_pk_bf16_f32 v11, v42, v43
  s_add_u32 s34, s21, 2048
  buffer_store_dwordx4 v[8:11], v1, s[4:7], s34 offen sc1
  v_cvt_pk_bf16_f32 v12, v36, v37
  v_cvt_pk_bf16_f32 v13, v38, v39
  v_cvt_pk_bf16_f32 v14, v44, v45
  v_cvt_pk_bf16_f32 v15, v46, v47
  s_add_u32 s34, s21, 8192
  buffer_store_dwordx4 v[12:15], v1, s[4:7], s34 offen sc1
  v_cvt_pk_bf16_f32 v8, v48, v49
  v_cvt_pk_bf16_f32 v9, v50, v51
  v_cvt_pk_bf16_f32 v10, v52, v53
  v_cvt_pk_bf16_f32 v11, v54, v55
  s_add_u32 s34, s23, 1024
  buffer_store_dwordx4 v[8:11], v1, s[4:7], s34 offen sc1
  v_cvt_pk_bf16_f32 v12, v56, v57
  v_cvt_pk_bf16_f32 v13, v58, v59
  v_cvt_pk_bf16_f32 v14, v60, v61
  v_cvt_pk_bf16_f32 v15, v62, v63
  s_add_u32 s34, s23, 2048
  buffer_store_dwordx4 v[12:15], v1, s[4:7], s34 offen sc1
  v_cvt_pk_bf16_f32 v8, v64, v65
  v_cvt_pk_bf16_f32 v9, v66, v67
  v_cvt_pk_bf16_f32 v10, v68, v69
  v_cvt_pk_bf16_f32 v11, v70, v71
  s_add_u32 s34, s23, 3072
  buffer_store_dwordx4 v[8:11], v1, s[4:7], s34 offen sc1
  s_waitcnt vmcnt(0)
  s_barrier
  s_add_u32 s17, s17, 1
  s_cmp_lt_u32 s17, 64
  s_cbranch_scc1 reca_ptop186
  s_branch reca_exit1
reca_pw2_163:
  s_mov_b32 s17, 0
  s_mov_b32 s26, 0
  s_mul_i32 s20, s17, 40960
  s_add_u32 s20, s20, 153636864
  s_add_u32 m0, s26, 20480
  s_nop 0
  buffer_load_dwordx4 v1, s[4:7], s20 offen offset:0 lds
  buffer_load_dwordx4 v1, s[4:7], s20 offen offset:1024 lds
  buffer_load_dwordx4 v1, s[4:7], s20 offen offset:2048 lds
  buffer_load_dwordx4 v1, s[4:7], s20 offen offset:3072 lds
  s_add_u32 s20, s20, 4096
  s_add_u32 m0, s26, 24576
  s_nop 0
  buffer_load_dwordx4 v1, s[4:7], s20 offen offset:0 lds
  buffer_load_dwordx4 v1, s[4:7], s20 offen offset:1024 lds
  buffer_load_dwordx4 v1, s[4:7], s20 offen offset:2048 lds
  buffer_load_dwordx4 v1, s[4:7], s20 offen offset:3072 lds
  s_add_u32 s20, s20, 4096
  s_add_u32 m0, s26, 28672
  s_nop 0
  buffer_load_dwordx4 v1, s[4:7], s20 offen offset:0 lds
  buffer_load_dwordx4 v1, s[4:7], s20 offen offset:1024 lds
  s_lshl_b32 s34, s15, 6
  s_add_u32 s34, s34, s17
  s_mul_i32 s34, s34, 12288
  s_mul_i32 s35, s16, 3072
  s_add_u32 s35, s35, s34
  s_add_u32 s27, s35, 37748736
  s_mul_i32 s35, s16, 6144
  s_add_u32 s35, s35, s34
  s_add_u32 s28, s35, 62914560
  s_add_u32 s34, s28, 4096
  buffer_load_dwordx4 v[16:19], v1, s[4:7], s34 offen sc1
  s_add_u32 s34, s28, 5120
  buffer_load_dwordx4 v[16:19], v1, s[4:7], s34 offen sc1
  s_mul_i32 s34, s15, 12
  s_mul_i32 s35, s16, 6
  s_add_u32 s34, s34, s35
  s_add_u32 s34, s34, 0
  s_mul_i32 s34, s34, 20480
  s_add_u32 s34, s34, 6291456
  buffer_load_dwordx4 a[0:3], v1, s[4:7], s34 offen offset:0
  buffer_load_dwordx4 a[4:7], v1, s[4:7], s34 offen offset:1024
  buffer_load_dwordx4 a[8:11], v1, s[4:7], s34 offen offset:2048
  buffer_load_dwordx4 a[12:15], v1, s[4:7], s34 offen offset:3072
  s_add_u32 s34, s34, 4096
  buffer_load_dwordx4 a[16:19], v1, s[4:7], s34 offen offset:0
  buffer_load_dwordx4 a[20:23], v1, s[4:7], s34 offen offset:1024
  buffer_load_dwordx4 a[24:27], v1, s[4:7], s34 offen offset:2048
  buffer_load_dwordx4 a[28:31], v1, s[4:7], s34 offen offset:3072
  s_add_u32 s34, s34, 4096
  buffer_load_dwordx4 a[32:35], v1, s[4:7], s34 offen offset:0
  buffer_load_dwordx4 a[36:39], v1, s[4:7], s34 offen offset:1024
  buffer_load_dwordx4 a[40:43], v1, s[4:7], s34 offen offset:2048
  buffer_load_dwordx4 a[44:47], v1, s[4:7], s34 offen offset:3072
  s_add_u32 s34, s34, 4096
  buffer_load_dwordx4 a[48:51], v1, s[4:7], s34 offen offset:0
  buffer_load_dwordx4 a[52:55], v1, s[4:7], s34 offen offset:1024
  buffer_load_dwordx4 a[56:59], v1, s[4:7], s34 offen offset:2048
  buffer_load_dwordx4 a[60:63], v1, s[4:7], s34 offen offset:3072
  s_add_u32 s34, s34, 4096
  buffer_load_dwordx4 a[64:67], v1, s[4:7], s34 offen offset:0
  buffer_load_dwordx4 a[68:71], v1, s[4:7], s34 offen offset:1024
  buffer_load_dwordx4 a[72:75], v1, s[4:7], s34 offen offset:2048
  buffer_load_dwordx4 a[76:79], v1, s[4:7], s34 offen offset:3072
  s_mul_i32 s34, s15, 12
  s_mul_i32 s35, s16, 6
  s_add_u32 s34, s34, s35
  s_add_u32 s34, s34, 1
  s_mul_i32 s34, s34, 20480
  s_add_u32 s34, s34, 6291456
  buffer_load_dwordx4 a[80:83], v1, s[4:7], s34 offen offset:0
  buffer_load_dwordx4 a[84:87], v1, s[4:7], s34 offen offset:1024
  buffer_load_dwordx4 a[88:91], v1, s[4:7], s34 offen offset:2048
  buffer_load_dwordx4 a[92:95], v1, s[4:7], s34 offen offset:3072
  s_add_u32 s34, s34, 4096
  buffer_load_dwordx4 a[96:99], v1, s[4:7], s34 offen offset:0
  buffer_load_dwordx4 a[100:103], v1, s[4:7], s34 offen offset:1024
  buffer_load_dwordx4 a[104:107], v1, s[4:7], s34 offen offset:2048
  buffer_load_dwordx4 a[108:111], v1, s[4:7], s34 offen offset:3072
  s_add_u32 s34, s34, 4096
  buffer_load_dwordx4 a[112:115], v1, s[4:7], s34 offen offset:0
  buffer_load_dwordx4 a[116:119], v1, s[4:7], s34 offen offset:1024
  buffer_load_dwordx4 a[120:123], v1, s[4:7], s34 offen offset:2048
  buffer_load_dwordx4 a[124:127], v1, s[4:7], s34 offen offset:3072
  s_add_u32 s34, s34, 4096
  buffer_load_dwordx4 a[128:131], v1, s[4:7], s34 offen offset:0
  buffer_load_dwordx4 a[132:135], v1, s[4:7], s34 offen offset:1024
  buffer_load_dwordx4 a[136:139], v1, s[4:7], s34 offen offset:2048
  buffer_load_dwordx4 a[140:143], v1, s[4:7], s34 offen offset:3072
  s_add_u32 s34, s34, 4096
  buffer_load_dwordx4 a[144:147], v1, s[4:7], s34 offen offset:0
  buffer_load_dwordx4 a[148:151], v1, s[4:7], s34 offen offset:1024
  buffer_load_dwordx4 a[152:155], v1, s[4:7], s34 offen offset:2048
  buffer_load_dwordx4 a[156:159], v1, s[4:7], s34 offen offset:3072
  s_waitcnt vmcnt(20)
  s_mul_i32 s34, s15, 12
  s_mul_i32 s35, s16, 6
  s_add_u32 s34, s34, s35
  s_add_u32 s34, s34, 4
  s_mul_i32 s34, s34, 20480
  s_add_u32 s34, s34, 22020096
  buffer_load_dwordx4 a[160:163], v1, s[4:7], s34 offen offset:0
  buffer_load_dwordx4 a[164:167], v1, s[4:7], s34 offen offset:1024
  buffer_load_dwordx4 a[168:171], v1, s[4:7], s34 offen offset:2048
  buffer_load_dwordx4 a[172:175], v1, s[4:7], s34 offen offset:3072
  s_add_u32 s34, s34, 4096
  buffer_load_dwordx4 a[176:179], v1, s[4:7], s34 offen offset:0
  buffer_load_dwordx4 a[180:183], v1, s[4:7], s34 offen offset:1024
  buffer_load_dwordx4 a[184:187], v1, s[4:7], s34 offen offset:2048
  buffer_load_dwordx4 a[188:191], v1, s[4:7], s34 offen offset:3072
  s_add_u32 s34, s34, 4096
  buffer_load_dwordx4 a[192:195], v1, s[4:7], s34 offen offset:0
  buffer_load_dwordx4 a[196:199], v1, s[4:7], s34 offen offset:1024
  buffer_load_dwordx4 a[200:203], v1, s[4:7], s34 offen offset:2048
  buffer_load_dwordx4 a[204:207], v1, s[4:7], s34 offen offset:3072
  s_add_u32 s34, s34, 4096
  buffer_load_dwordx4 a[208:211], v1, s[4:7], s34 offen offset:0
  buffer_load_dwordx4 a[212:215], v1, s[4:7], s34 offen offset:1024
  buffer_load_dwordx4 a[216:219], v1, s[4:7], s34 offen offset:2048
  buffer_load_dwordx4 a[220:223], v1, s[4:7], s34 offen offset:3072
  s_add_u32 s34, s34, 4096
  buffer_load_dwordx4 a[224:227], v1, s[4:7], s34 offen offset:0
  buffer_load_dwordx4 a[228:231], v1, s[4:7], s34 offen offset:1024
  buffer_load_dwordx4 a[232:235], v1, s[4:7], s34 offen offset:2048
  buffer_load_dwordx4 a[236:239], v1, s[4:7], s34 offen offset:3072
  s_waitcnt vmcnt(20)
  s_mul_i32 s34, s15, 12
  s_mul_i32 s35, s16, 6
  s_add_u32 s34, s34, s35
  s_add_u32 s34, s34, 5
  s_mul_i32 s34, s34, 20480
  s_add_u32 s34, s34, 22020096
  buffer_load_dwordx4 v[96:99], v1, s[4:7], s34 offen offset:0
  buffer_load_dwordx4 v[100:103], v1, s[4:7], s34 offen offset:1024
  buffer_load_dwordx4 v[104:107], v1, s[4:7], s34 offen offset:2048
  buffer_load_dwordx4 v[108:111], v1, s[4:7], s34 offen offset:3072
  s_add_u32 s34, s34, 4096
  buffer_load_dwordx4 v[112:115], v1, s[4:7], s34 offen offset:0
  buffer_load_dwordx4 v[116:119], v1, s[4:7], s34 offen offset:1024
  buffer_load_dwordx4 v[120:123], v1, s[4:7], s34 offen offset:2048
  buffer_load_dwordx4 v[124:127], v1, s[4:7], s34 offen offset:3072
  s_add_u32 s34, s34, 4096
  buffer_load_dwordx4 v[128:131], v1, s[4:7], s34 offen offset:0
  buffer_load_dwordx4 v[132:135], v1, s[4:7], s34 offen offset:1024
  buffer_load_dwordx4 v[136:139], v1, s[4:7], s34 offen offset:2048
  buffer_load_dwordx4 v[140:143], v1, s[4:7], s34 offen offset:3072
  s_add_u32 s34, s34, 4096
  buffer_load_dwordx4 v[144:147], v1, s[4:7], s34 offen offset:0
  buffer_load_dwordx4 v[148:151], v1, s[4:7], s34 offen offset:1024
  buffer_load_dwordx4 v[152:155], v1, s[4:7], s34 offen offset:2048
  buffer_load_dwordx4 v[156:159], v1, s[4:7], s34 offen offset:3072
  s_add_u32 s34, s34, 4096
  buffer_load_dwordx4 v[160:163], v1, s[4:7], s34 offen offset:0
  buffer_load_dwordx4 v[164:167], v1, s[4:7], s34 offen offset:1024
  buffer_load_dwordx4 v[168:171], v1, s[4:7], s34 offen offset:2048
  buffer_load_dwordx4 v[172:175], v1, s[4:7], s34 offen offset:3072
  s_waitcnt vmcnt(20)
  s_lshl_b32 s34, s13, 3
  v_mov_b32 v30, s34
reca_cens191:
  buffer_load_dwordx2 v[28:29], v30, s[8:11], 0 offen sc1
  s_waitcnt vmcnt(0)
  v_readfirstlane_b32 s35, v28
  v_readfirstlane_b32 s36, v29
  v_sad_u8 v28, v28, 0, 0
  v_sad_u8 v28, v29, 0, v28
  s_nop 0
  v_readfirstlane_b32 s34, v28
  s_nop 3
  s_cmp_ge_u32 s34, 32
  s_cbranch_scc1 reca_censok192
  s_sleep 8
  s_sub_u32 s18, s18, 1
  s_cbranch_scc0 reca_cens191
  s_mov_b32 s18, 0
reca_censok192:
  s_lshl_b32 s34, s42, 3
  s_mov_b32 s37, s36
  s_mov_b32 s36, s35
  s_lshr_b64 s[36:37], s[36:37], s34
  s_and_b32 s36, s36, 0xff
  s_cmp_eq_u32 s36, 32
  s_cselect_b32 s43, 0, 1
  s_cmp_lg_u32 s43, 0
  s_cbranch_scc1 reca_pslow193
reca_ptop194:
  s_cmp_lt_u32 s17, 6
  s_cbranch_scc1 reca_pgo195
  s_sub_u32 s36, s17, 6
reca_ppoll196:
  buffer_load_dword v28, v4, s[4:7], s25 offen sc1
  s_waitcnt vmcnt(0)
  v_readfirstlane_b32 s34, v28
  s_nop 3
  s_cmp_ge_i32 s34, s36
  s_cbranch_scc1 reca_pgo195
  s_sleep 8
  s_sub_u32 s18, s18, 1
  s_cbranch_scc0 reca_ppoll196
  s_mov_b32 s18, 0
reca_pgo195:
  s_waitcnt vmcnt(0)
  s_barrier
  v_add_u32 v7, s26, v1
  s_xor_b32 s26, s26, 40960
  s_add_u32 s37, s17, 1
  s_cmp_ge_u32 s37, 64
  s_cbranch_scc1 reca_pnodma197
  s_mul_i32 s20, s37, 40960
  s_add_u32 s20, s20, 153636864
  s_add_u32 m0, s26, 20480
  s_nop 0
  buffer_load_dwordx4 v1, s[4:7], s20 offen offset:0 lds
  buffer_load_dwordx4 v1, s[4:7], s20 offen offset:1024 lds
  buffer_load_dwordx4 v1, s[4:7], s20 offen offset:2048 lds
  buffer_load_dwordx4 v1, s[4:7], s20 offen offset:3072 lds
  s_add_u32 s20, s20, 4096
  s_add_u32 m0, s26, 24576
  s_nop 0
  buffer_load_dwordx4 v1, s[4:7], s20 offen offset:0 lds
  buffer_load_dwordx4 v1, s[4:7], s20 offen offset:1024 lds
  buffer_load_dwordx4 v1, s[4:7], s20 offen offset:2048 lds
  buffer_load_dwordx4 v1, s[4:7], s20 offen offset:3072 lds
  s_add_u32 s20, s20, 4096
  s_add_u32 m0, s26, 28672
  s_nop 0
  buffer_load_dwordx4 v1, s[4:7], s20 offen offset:0 lds
  buffer_load_dwordx4 v1, s[4:7], s20 offen offset:1024 lds
  s_lshl_b32 s34, s15, 6
  s_add_u32 s34, s34, s37
  s_mul_i32 s34, s34, 12288
  s_mul_i32 s35, s16, 3072
  s_add_u32 s35, s35, s34
  s_add_u32 s27, s35, 37748736
  s_mul_i32 s35, s16, 6144
  s_add_u32 s35, s35, s34
  s_add_u32 s28, s35, 62914560
  s_add_u32 s34, s28, 4096
  buffer_load_dwordx4 v[16:19], v1, s[4:7], s34 offen sc1
  s_add_u32 s34, s28, 5120
  buffer_load_dwordx4 v[16:19], v1, s[4:7], s34 offen sc1
reca_pnodma197:
  s_lshl_b32 s34, s15, 6
  s_add_u32 s34, s34, s17
  s_mul_i32 s34, s34, 12288
  s_mul_i32 s35, s16, 3072
  s_add_u32 s35, s35, s34
  s_add_u32 s21, s35, 37748736
  s_add_u32 s22, s35, 88080384
  s_mul_i32 s35, s16, 6144
  s_add_u32 s35, s35, s34
  s_add_u32 s23, s35, 62914560
  ds_read_b128 v[72:75], v7 offset:0
  ds_read_b128 v[76:79], v7 offset:20480
  ds_read_b128 v[80:83], v7 offset:1024
  ds_read_b128 v[84:87], v7 offset:21504
  ds_read_b128 v[88:91], v7 offset:2048
  ds_read_b128 v[92:95], v7 offset:22528
  s_waitcnt lgkmcnt(4)
  v_mfma_f32_16x16x32_bf16 v[32:35], a[0:3], v[72:75], 0
  v_mfma_f32_16x16x32_bf16 v[36:39], a[0:3], v[76:79], 0
  v_mfma_f32_16x16x32_bf16 v[40:43], a[80:83], v[72:75], 0
  v_mfma_f32_16x16x32_bf16 v[44:47], a[80:83], v[76:79], 0
  v_mfma_f32_16x16x32_bf16 v[48:51], v[72:75], a[160:163], 0
  v_mfma_f32_16x16x32_bf16 v[52:55], v[76:79], a[160:163], 0
  v_mfma_f32_16x16x32_bf16 v[56:59], v[72:75], v[96:99], 0
  v_mfma_f32_16x16x32_bf16 v[60:63], v[76:79], v[96:99], 0
  ds_read_b128 v[72:75], v7 offset:3072
  ds_read_b128 v[76:79], v7 offset:23552
  s_waitcnt lgkmcnt(4)
  v_mfma_f32_16x16x32_bf16 v[32:35], a[4:7], v[80:83], v[32:35]
  v_mfma_f32_16x16x32_bf16 v[36:39], a[4:7], v[84:87], v[36:39]
  v_mfma_f32_16x16x32_bf16 v[40:43], a[84:87], v[80:83], v[40:43]
  v_mfma_f32_16x16x32_bf16 v[44:47], a[84:87], v[84:87], v[44:47]
  v_mfma_f32_16x16x32_bf16 v[48:51], v[80:83], a[164:167], v[48:51]
  v_mfma_f32_16x16x32_bf16 v[52:55], v[84:87], a[164:167], v[52:55]
  v_mfma_f32_16x16x32_bf16 v[56:59], v[80:83], v[100:103], v[56:59]
  v_mfma_f32_16x16x32_bf16 v[60:63], v[84:87], v[100:103], v[60:63]
  ds_read_b128 v[80:83], v7 offset:4096
  ds_read_b128 v[84:87], v7 offset:24576
  s_waitcnt lgkmcnt(4)
  v_mfma_f32_16x16x32_bf16 v[32:35], a[8:11], v[88:91], v[32:35]
  v_mfma_f32_16x16x32_bf16 v[36:39], a[8:11], v[92:95], v[36:39]
  v_mfma_f32_16x16x32_bf16 v[40:43], a[88:91], v[88:91], v[40:43]
  v_mfma_f32_16x16x32_bf16 v[44:47], a[88:91], v[92:95], v[44:47]
  v_mfma_f32_16x16x32_bf16 v[48:51], v[88:91], a[168:171], v[48:51]
  v_mfma_f32_16x16x32_bf16 v[52:55], v[92:95], a[168:171], v[52:55]
  v_mfma_f32_16x16x32_bf16 v[56:59], v[88:91], v[104:107], v[56:59]
  v_mfma_f32_16x16x32_bf16 v[60:63], v[92:95], v[104:107], v[60:63]
  ds_read_b128 v[88:91], v7 offset:5120
  ds_read_b128 v[92:95], v7 offset:25600
  s_waitcnt lgkmcnt(4)
  v_mfma_f32_16x16x32_bf16 v[32:35], a[12:15], v[72:75], v[32:35]
  v_mfma_f32_16x16x32_bf16 v[36:39], a[12:15], v[76:79], v[36:39]
  v_mfma_f32_16x16x32_bf16 v[40:43], a[92:95], v[72:75], v[40:43]
  v_mfma_f32_16x16x32_bf16 v[44:47], a[92:95], v[76:79], v[44:47]
  v_mfma_f32_16x16x32_bf16 v[48:51], v[72:75], a[172:175], v[48:51]
  v_mfma_f32_16x16x32_bf16 v[52:55], v[76:79], a[172:175], v[52:55]
  v_mfma_f32_16x16x32_bf16 v[56:59], v[72:75], v[108:111], v[56:59]
  v_mfma_f32_16x16x32_bf16 v[60:63], v[76:79], v[108:111], v[60:63]
  ds_read_b128 v[72:75], v7 offset:6144
  ds_read_b128 v[76:79], v7 offset:26624
  s_waitcnt lgkmcnt(4)
  v_mfma_f32_16x16x32_bf16 v[32:35], a[16:19], v[80:83], v[32:35]
  v_mfma_f32_16x16x32_bf16 v[36:39], a[16:19], v[84:87], v[36:39]
  v_mfma_f32_16x16x32_bf16 v[40:43], a[96:99], v[80:83], v[40:43]
  v_mfma_f32_16x16x32_bf16 v[44:47], a[96:99], v[84:87], v[44:47]
  v_mfma_f32_16x16x32_bf16 v[48:51], v[80:83], a[176:179], v[48:51]
  v_mfma_f32_16x16x32_bf16 v[52:55], v[84:87], a[176:179], v[52:55]
  v_mfma_f32_16x16x32_bf16 v[56:59], v[80:83], v[112:115], v[56:59]
  v_mfma_f32_16x16x32_bf16 v[60:63], v[84:87], v[112:115], v[60:63]
  ds_read_b128 v[80:83], v7 offset:7168
  ds_read_b128 v[84:87], v7 offset:27648
  s_waitcnt lgkmcnt(4)
  v_mfma_f32_16x16x32_bf16 v[32:35], a[20:23], v[88:91], v[32:35]
  v_mfma_f32_16x16x32_bf16 v[36:39], a[20:23], v[92:95], v[36:39]
  v_mfma_f32_16x16x32_bf16 v[40:43], a[100:103], v[88:91], v[40:43]
  v_mfma_f32_16x16x32_bf16 v[44:47], a[100:103], v[92:95], v[44:47]
  v_mfma_f32_16x16x32_bf16 v[48:51], v[88:91], a[180:183], v[48:51]
  v_mfma_f32_16x16x32_bf16 v[52:55], v[92:95], a[180:183], v[52:55]
  v_mfma_f32_16x16x32_bf16 v[56:59], v[88:91], v[116:119], v[56:59]
  v_mfma_f32_16x16x32_bf16 v[60:63], v[92:95], v[116:119], v[60:63]
  ds_read_b128 v[88:91], v7 offset:8192
  ds_read_b128 v[92:95], v7 offset:28672
  s_waitcnt lgkmcnt(4)
  v_mfma_f32_16x16x32_bf16 v[32:35], a[24:27], v[72:75], v[32:35]
  v_mfma_f32_16x16x32_bf16 v[36:39], a[24:27], v[76:79], v[36:39]
  v_mfma_f32_16x16x32_bf16 v[40:43], a[104:107], v[72:75], v[40:43]
  v_mfma_f32_16x16x32_bf16 v[44:47], a[104:107], v[76:79], v[44:47]
  v_mfma_f32_16x16x32_bf16 v[48:51], v[72:75], a[184:187], v[48:51]
  v_mfma_f32_16x16x32_bf16 v[52:55], v[76:79], a[184:187], v[52:55]
  v_mfma_f32_16x16x32_bf16 v[56:59], v[72:75], v[120:123], v[56:59]
  v_mfma_f32_16x16x32_bf16 v[60:63], v[76:79], v[120:123], v[60:63]
  ds_read_b128 v[72:75], v7 offset:9216
  ds_read_b128 v[76:79], v7 offset:29696
  s_waitcnt lgkmcnt(4)
  v_mfma_f32_16x16x32_bf16 v[32:35], a[28:31], v[80:83], v[32:35]
  v_mfma_f32_16x16x32_bf16 v[36:39], a[28:31], v[84:87], v[36:39]
  v_mfma_f32_16x16x32_bf16 v[40:43], a[108:111], v[80:83], v[40:43]
  v_mfma_f32_16x16x32_bf16 v[44:47], a[108:111], v[84:87], v[44:47]
  v_mfma_f32_16x16x32_bf16 v[48:51], v[80:83], a[188:191], v[48:51]
  v_mfma_f32_16x16x32_bf16 v[52:55], v[84:87], a[188:191], v[52:55]
  v_mfma_f32_16x16x32_bf16 v[56:59], v[80:83], v[124:127], v[56:59]
  v_mfma_f32_16x16x32_bf16 v[60:63], v[84:87], v[124:127], v[60:63]
  ds_read_b128 v[80:83], v7 offset:10240
  ds_read_b128 v[84:87], v7 offset:30720
  s_waitcnt lgkmcnt(4)
  v_mfma_f32_16x16x32_bf16 v[32:35], a[32:35], v[88:91], v[32:35]
  v_mfma_f32_16x16x32_bf16 v[36:39], a[32:35], v[92:95], v[36:39]
  v_mfma_f32_16x16x32_bf16 v[40:43], a[112:115], v[88:91], v[40:43]
  v_mfma_f32_16x16x32_bf16 v[44:47], a[112:115], v[92:95], v[44:47]
  v_mfma_f32_16x16x32_bf16 v[48:51], v[88:91], a[192:195], v[48:51]
  v_mfma_f32_16x16x32_bf16 v[52:55], v[92:95], a[192:195], v[52:55]
  v_mfma_f32_16x16x32_bf16 v[56:59], v[88:91], v[128:131], v[56:59]
  v_mfma_f32_16x16x32_bf16 v[60:63], v[92:95], v[128:131], v[60:63]
  ds_read_b128 v[88:91], v7 offset:11264
  ds_read_b128 v[92:95], v7 offset:31744
  s_waitcnt lgkmcnt(4)
  v_mfma_f32_16x16x32_bf16 v[32:35], a[36:39], v[72:75], v[32:35]
  v_mfma_f32_16x16x32_bf16 v[36:39], a[36:39], v[76:79], v[36:39]
  v_mfma_f32_16x16x32_bf16 v[40:43], a[116:119], v[72:75], v[40:43]
  v_mfma_f32_16x16x32_bf16 v[44:47], a[116:119], v[76:79], v[44:47]
  v_mfma_f32_16x16x32_bf16 v[48:51], v[72:75], a[196:199], v[48:51]
  v_mfma_f32_16x16x32_bf16 v[52:55], v[76:79], a[196:199], v[52:55]
  v_mfma_f32_16x16x32_bf16 v[56:59], v[72:75], v[132:135], v[56:59]
  v_mfma_f32_16x16x32_bf16 v[60:63], v[76:79], v[132:135], v[60:63]
  ds_read_b128 v[72:75], v7 offset:12288
  ds_read_b128 v[76:79], v7 offset:32768
  s_waitcnt lgkmcnt(4)
  v_mfma_f32_16x16x32_bf16 v[32:35], a[40:43], v[80:83], v[32:35]
  v_mfma_f32_16x16x32_bf16 v[36:39], a[40:43], v[84:87], v[36:39]
  v_mfma_f32_16x16x32_bf16 v[40:43], a[120:123], v[80:83], v[40:43]
  v_mfma_f32_16x16x32_bf16 v[44:47], a[120:123], v[84:87], v[44:47]
  v_mfma_f32_16x16x32_bf16 v[48:51], v[80:83], a[200:203], v[48:51]
  v_mfma_f32_16x16x32_bf16 v[52:55], v[84:87], a[200:203], v[52:55]
  v_mfma_f32_16x16x32_bf16 v[56:59], v[80:83], v[136:139], v[56:59]
  v_mfma_f32_16x16x32_bf16 v[60:63], v[84:87], v[136:139], v[60:63]
  ds_read_b128 v[80:83], v7 offset:13312
  ds_read_b128 v[84:87], v7 offset:33792
  s_waitcnt lgkmcnt(4)
  v_mfma_f32_16x16x32_bf16 v[32:35], a[44:47], v[88:91], v[32:35]
  v_mfma_f32_16x16x32_bf16 v[36:39], a[44:47], v[92:95], v[36:39]
  v_mfma_f32_16x16x32_bf16 v[40:43], a[124:127], v[88:91], v[40:43]
  v_mfma_f32_16x16x32_bf16 v[44:47], a[124:127], v[92:95], v[44:47]
  v_mfma_f32_16x16x32_bf16 v[48:51], v[88:91], a[204:207], v[48:51]
  v_mfma_f32_16x16x32_bf16 v[52:55], v[92:95], a[204:207], v[52:55]
  v_mfma_f32_16x16x32_bf16 v[56:59], v[88:91], v[140:143], v[56:59]
  v_mfma_f32_16x16x32_bf16 v[60:63], v[92:95], v[140:143], v[60:63]
  ds_read_b128 v[88:91], v7 offset:14336
  ds_read_b128 v[92:95], v7 offset:34816
  s_waitcnt lgkmcnt(4)
  v_mfma_f32_16x16x32_bf16 v[32:35], a[48:51], v[72:75], v[32:35]
  v_mfma_f32_16x16x32_bf16 v[36:39], a[48:51], v[76:79], v[36:39]
  v_mfma_f32_16x16x32_bf16 v[40:43], a[128:131], v[72:75], v[40:43]
  v_mfma_f32_16x16x32_bf16 v[44:47], a[128:131], v[76:79], v[44:47]
  v_mfma_f32_16x16x32_bf16 v[48:51], v[72:75], a[208:211], v[48:51]
  v_mfma_f32_16x16x32_bf16 v[52:55], v[76:79], a[208:211], v[52:55]
  v_mfma_f32_16x16x32_bf16 v[56:59], v[72:75], v[144:147], v[56:59]
  v_mfma_f32_16x16x32_bf16 v[60:63], v[76:79], v[144:147], v[60:63]
  ds_read_b128 v[72:75], v7 offset:15360
  ds_read_b128 v[76:79], v7 offset:35840
  s_waitcnt lgkmcnt(4)
  v_mfma_f32_16x16x32_bf16 v[32:35], a[52:55], v[80:83], v[32:35]
  v_mfma_f32_16x16x32_bf16 v[36:39], a[52:55], v[84:87], v[36:39]
  v_mfma_f32_16x16x32_bf16 v[40:43], a[132:135], v[80:83], v[40:43]
  v_mfma_f32_16x16x32_bf16 v[44:47], a[132:135], v[84:87], v[44:47]
  v_mfma_f32_16x16x32_bf16 v[48:51], v[80:83], a[212:215], v[48:51]
  v_mfma_f32_16x16x32_bf16 v[52:55], v[84:87], a[212:215], v[52:55]
  v_mfma_f32_16x16x32_bf16 v[56:59], v[80:83], v[148:151], v[56:59]
  v_mfma_f32_16x16x32_bf16 v[60:63], v[84:87], v[148:151], v[60:63]
  ds_read_b128 v[80:83], v7 offset:16384
  ds_read_b128 v[84:87], v7 offset:36864
  s_waitcnt lgkmcnt(4)
  v_mfma_f32_16x16x32_bf16 v[32:35], a[56:59], v[88:91], v[32:35]
  v_mfma_f32_16x16x32_bf16 v[36:39], a[56:59], v[92:95], v[36:39]
  v_mfma_f32_16x16x32_bf16 v[40:43], a[136:139], v[88:91], v[40:43]
  v_mfma_f32_16x16x32_bf16 v[44:47], a[136:139], v[92:95], v[44:47]
  v_mfma_f32_16x16x32_bf16 v[48:51], v[88:91], a[216:219], v[48:51]
  v_mfma_f32_16x16x32_bf16 v[52:55], v[92:95], a[216:219], v[52:55]
  v_mfma_f32_16x16x32_bf16 v[56:59], v[88:91], v[152:155], v[56:59]
  v_mfma_f32_16x16x32_bf16 v[60:63], v[92:95], v[152:155], v[60:63]
  ds_read_b128 v[88:91], v7 offset:17408
  ds_read_b128 v[92:95], v7 offset:37888
  s_waitcnt lgkmcnt(4)
  v_mfma_f32_16x16x32_bf16 v[32:35], a[60:63], v[72:75], v[32:35]
  v_mfma_f32_16x16x32_bf16 v[36:39], a[60:63], v[76:79], v[36:39]
  v_mfma_f32_16x16x32_bf16 v[40:43], a[140:143], v[72:75], v[40:43]
  v_mfma_f32_16x16x32_bf16 v[44:47], a[140:143], v[76:79], v[44:47]
  v_mfma_f32_16x16x32_bf16 v[48:51], v[72:75], a[220:223], v[48:51]
  v_mfma_f32_16x16x32_bf16 v[52:55], v[76:79], a[220:223], v[52:55]
  v_mfma_f32_16x16x32_bf16 v[56:59], v[72:75], v[156:159], v[56:59]
  v_mfma_f32_16x16x32_bf16 v[60:63], v[76:79], v[156:159], v[60:63]
  ds_read_b128 v[72:75], v7 offset:18432
  ds_read_b128 v[76:79], v7 offset:38912
  s_waitcnt lgkmcnt(4)
  v_mfma_f32_16x16x32_bf16 v[32:35], a[64:67], v[80:83], v[32:35]
  v_mfma_f32_16x16x32_bf16 v[36:39], a[64:67], v[84:87], v[36:39]
  v_mfma_f32_16x16x32_bf16 v[40:43], a[144:147], v[80:83], v[40:43]
  v_mfma_f32_16x16x32_bf16 v[44:47], a[144:147], v[84:87], v[44:47]
  v_mfma_f32_16x16x32_bf16 v[48:51], v[80:83], a[224:227], v[48:51]
  v_mfma_f32_16x16x32_bf16 v[52:55], v[84:87], a[224:227], v[52:55]
  v_mfma_f32_16x16x32_bf16 v[56:59], v[80:83], v[160:163], v[56:59]
  v_mfma_f32_16x16x32_bf16 v[60:63], v[84:87], v[160:163], v[60:63]
  ds_read_b128 v[80:83], v7 offset:19456
  ds_read_b128 v[84:87], v7 offset:39936
  s_waitcnt lgkmcnt(4)
  v_mfma_f32_16x16x32_bf16 v[32:35], a[68:71], v[88:91], v[32:35]
  v_mfma_f32_16x16x32_bf16 v[36:39], a[68:71], v[92:95], v[36:39]
  v_mfma_f32_16x16x32_bf16 v[40:43], a[148:151], v[88:91], v[40:43]
  v_mfma_f32_16x16x32_bf16 v[44:47], a[148:151], v[92:95], v[44:47]
  v_mfma_f32_16x16x32_bf16 v[48:51], v[88:91], a[228:231], v[48:51]
  v_mfma_f32_16x16x32_bf16 v[52:55], v[92:95], a[228:231], v[52:55]
  v_mfma_f32_16x16x32_bf16 v[56:59], v[88:91], v[164:167], v[56:59]
  v_mfma_f32_16x16x32_bf16 v[60:63], v[92:95], v[164:167], v[60:63]
  s_waitcnt lgkmcnt(2)
  v_mfma_f32_16x16x32_bf16 v[32:35], a[72:75], v[72:75], v[32:35]
  v_mfma_f32_16x16x32_bf16 v[36:39], a[72:75], v[76:79], v[36:39]
  v_mfma_f32_16x16x32_bf16 v[40:43], a[152:155], v[72:75], v[40:43]
  v_mfma_f32_16x16x32_bf16 v[44:47], a[152:155], v[76:79], v[44:47]
  v_mfma_f32_16x16x32_bf16 v[48:51], v[72:75], a[232:235], v[48:51]
  v_mfma_f32_16x16x32_bf16 v[52:55], v[76:79], a[232:235], v[52:55]
  v_mfma_f32_16x16x32_bf16 v[56:59], v[72:75], v[168:171], v[56:59]
  v_mfma_f32_16x16x32_bf16 v[60:63], v[76:79], v[168:171], v[60:63]
  s_waitcnt lgkmcnt(0)
  v_mfma_f32_16x16x32_bf16 v[32:35], a[76:79], v[80:83], v[32:35]
  v_mfma_f32_16x16x32_bf16 v[36:39], a[76:79], v[84:87], v[36:39]
  v_mfma_f32_16x16x32_bf16 v[40:43], a[156:159], v[80:83], v[40:43]
  v_mfma_f32_16x16x32_bf16 v[44:47], a[156:159], v[84:87], v[44:47]
  v_mfma_f32_16x16x32_bf16 v[48:51], v[80:83], a[236:239], v[48:51]
  v_mfma_f32_16x16x32_bf16 v[52:55], v[84:87], a[236:239], v[52:55]
  v_mfma_f32_16x16x32_bf16 v[56:59], v[80:83], v[172:175], v[56:59]
  v_mfma_f32_16x16x32_bf16 v[60:63], v[84:87], v[172:175], v[60:63]
  s_nop 0
  v_cvt_pk_bf16_f32 v8, v32, v33
  v_cvt_pk_bf16_f32 v9, v34, v35
  v_cvt_pk_bf16_f32 v10, v40, v41
  v_cvt_pk_bf16_f32 v11, v42, v43
  s_add_u32 s34, s22, 0
  buffer_store_dwordx4 v[8:11], v1, s[4:7], s34 offen
  v_cvt_pk_bf16_f32 v12, v36, v37
  v_cvt_pk_bf16_f32 v13, v38, v39
  v_cvt_pk_bf16_f32 v14, v44, v45
  v_cvt_pk_bf16_f32 v15, v46, v47
  s_add_u32 s34, s22, 6144
  buffer_store_dwordx4 v[12:15], v1, s[4:7], s34 offen
  v_cvt_pk_bf16_f32 v8, v48, v49
  v_cvt_pk_bf16_f32 v9, v50, v51
  v_cvt_pk_bf16_f32 v10, v52, v53
  v_cvt_pk_bf16_f32 v11, v54, v55
  s_add_u32 s34, s23, 4096
  buffer_store_dwordx4 v[8:11], v1, s[4:7], s34 offen
  v_cvt_pk_bf16_f32 v12, v56, v57
  v_cvt_pk_bf16_f32 v13, v58, v59
  v_cvt_pk_bf16_f32 v14, v60, v61
  v_cvt_pk_bf16_f32 v15, v62, v63
  s_add_u32 s34, s23, 5120
  buffer_store_dwordx4 v[12:15], v1, s[4:7], s34 offen
  s_waitcnt vmcnt(0)
  s_barrier
  s_add_u32 s17, s17, 1
  s_cmp_lt_u32 s17, 64
  s_cbranch_scc1 reca_ptop194
  s_branch reca_exit1
reca_pslow193:
reca_ptop199:
  s_cmp_lt_u32 s17, 6
  s_cbranch_scc1 reca_pgo200
  s_sub_u32 s36, s17, 6
reca_ppoll201:
  buffer_load_dword v28, v4, s[4:7], s25 offen sc1
  s_waitcnt vmcnt(0)
  v_readfirstlane_b32 s34, v28
  s_nop 3
  s_cmp_ge_i32 s34, s36
  s_cbranch_scc1 reca_pgo200
  s_sleep 8
  s_sub_u32 s18, s18, 1
  s_cbranch_scc0 reca_ppoll201
  s_mov_b32 s18, 0
reca_pgo200:
  s_waitcnt vmcnt(0)
  s_barrier
  v_add_u32 v7, s26, v1
  s_xor_b32 s26, s26, 40960
  s_add_u32 s37, s17, 1
  s_cmp_ge_u32 s37, 64
  s_cbranch_scc1 reca_pnodma202
  s_mul_i32 s20, s37, 40960
  s_add_u32 s20, s20, 153636864
  s_add_u32 m0, s26, 20480
  s_nop 0
  buffer_load_dwordx4 v1, s[4:7], s20 offen offset:0 lds
  buffer_load_dwordx4 v1, s[4:7], s20 offen offset:1024 lds
  buffer_load_dwordx4 v1, s[4:7], s20 offen offset:2048 lds
  buffer_load_dwordx4 v1, s[4:7], s20 offen offset:3072 lds
  s_add_u32 s20, s20, 4096
  s_add_u32 m0, s26, 24576
  s_nop 0
  buffer_load_dwordx4 v1, s[4:7], s20 offen offset:0 lds
  buffer_load_dwordx4 v1, s[4:7], s20 offen offset:1024 lds
  buffer_load_dwordx4 v1, s[4:7], s20 offen offset:2048 lds
  buffer_load_dwordx4 v1, s[4:7], s20 offen offset:3072 lds
  s_add_u32 s20, s20, 4096
  s_add_u32 m0, s26, 28672
  s_nop 0
  buffer_load_dwordx4 v1, s[4:7], s20 offen offset:0 lds
  buffer_load_dwordx4 v1, s[4:7], s20 offen offset:1024 lds
  s_lshl_b32 s34, s15, 6
  s_add_u32 s34, s34, s37
  s_mul_i32 s34, s34, 12288
  s_mul_i32 s35, s16, 3072
  s_add_u32 s35, s35, s34
  s_add_u32 s27, s35, 37748736
  s_mul_i32 s35, s16, 6144
  s_add_u32 s35, s35, s34
  s_add_u32 s28, s35, 62914560
  s_add_u32 s34, s28, 4096
  buffer_load_dwordx4 v[16:19], v1, s[4:7], s34 offen sc1
  s_add_u32 s34, s28, 5120
  buffer_load_dwordx4 v[16:19], v1, s[4:7], s34 offen sc1
reca_pnodma202:
  s_lshl_b32 s34, s15, 6
  s_add_u32 s34, s34, s17
  s_mul_i32 s34, s34, 12288
  s_mul_i32 s35, s16, 3072
  s_add_u32 s35, s35, s34
  s_add_u32 s21, s35, 37748736
  s_add_u32 s22, s35, 88080384
  s_mul_i32 s35, s16, 6144
  s_add_u32 s35, s35, s34
  s_add_u32 s23, s35, 62914560
  ds_read_b128 v[72:75], v7 offset:0
  ds_read_b128 v[76:79], v7 offset:20480
  ds_read_b128 v[80:83], v7 offset:1024
  ds_read_b128 v[84:87], v7 offset:21504
  ds_read_b128 v[88:91], v7 offset:2048
  ds_read_b128 v[92:95], v7 offset:22528
  s_waitcnt lgkmcnt(4)
  v_mfma_f32_16x16x32_bf16 v[32:35], a[0:3], v[72:75], 0
  v_mfma_f32_16x16x32_bf16 v[36:39], a[0:3], v[76:79], 0
  v_mfma_f32_16x16x32_bf16 v[40:43], a[80:83], v[72:75], 0
  v_mfma_f32_16x16x32_bf16 v[44:47], a[80:83], v[76:79], 0
  v_mfma_f32_16x16x32_bf16 v[48:51], v[72:75], a[160:163], 0
  v_mfma_f32_16x16x32_bf16 v[52:55], v[76:79], a[160:163], 0
  v_mfma_f32_16x16x32_bf16 v[56:59], v[72:75], v[96:99], 0
  v_mfma_f32_16x16x32_bf16 v[60:63], v[76:79], v[96:99], 0
  ds_read_b128 v[72:75], v7 offset:3072
  ds_read_b128 v[76:79], v7 offset:23552
  s_waitcnt lgkmcnt(4)
  v_mfma_f32_16x16x32_bf16 v[32:35], a[4:7], v[80:83], v[32:35]
  v_mfma_f32_16x16x32_bf16 v[36:39], a[4:7], v[84:87], v[36:39]
  v_mfma_f32_16x16x32_bf16 v[40:43], a[84:87], v[80:83], v[40:43]
  v_mfma_f32_16x16x32_bf16 v[44:47], a[84:87], v[84:87], v[44:47]
  v_mfma_f32_16x16x32_bf16 v[48:51], v[80:83], a[164:167], v[48:51]
  v_mfma_f32_16x16x32_bf16 v[52:55], v[84:87], a[164:167], v[52:55]
  v_mfma_f32_16x16x32_bf16 v[56:59], v[80:83], v[100:103], v[56:59]
  v_mfma_f32_16x16x32_bf16 v[60:63], v[84:87], v[100:103], v[60:63]
  ds_read_b128 v[80:83], v7 offset:4096
  ds_read_b128 v[84:87], v7 offset:24576
  s_waitcnt lgkmcnt(4)
  v_mfma_f32_16x16x32_bf16 v[32:35], a[8:11], v[88:91], v[32:35]
  v_mfma_f32_16x16x32_bf16 v[36:39], a[8:11], v[92:95], v[36:39]
  v_mfma_f32_16x16x32_bf16 v[40:43], a[88:91], v[88:91], v[40:43]
  v_mfma_f32_16x16x32_bf16 v[44:47], a[88:91], v[92:95], v[44:47]
  v_mfma_f32_16x16x32_bf16 v[48:51], v[88:91], a[168:171], v[48:51]
  v_mfma_f32_16x16x32_bf16 v[52:55], v[92:95], a[168:171], v[52:55]
  v_mfma_f32_16x16x32_bf16 v[56:59], v[88:91], v[104:107], v[56:59]
  v_mfma_f32_16x16x32_bf16 v[60:63], v[92:95], v[104:107], v[60:63]
  ds_read_b128 v[88:91], v7 offset:5120
  ds_read_b128 v[92:95], v7 offset:25600
  s_waitcnt lgkmcnt(4)
  v_mfma_f32_16x16x32_bf16 v[32:35], a[12:15], v[72:75], v[32:35]
  v_mfma_f32_16x16x32_bf16 v[36:39], a[12:15], v[76:79], v[36:39]
  v_mfma_f32_16x16x32_bf16 v[40:43], a[92:95], v[72:75], v[40:43]
  v_mfma_f32_16x16x32_bf16 v[44:47], a[92:95], v[76:79], v[44:47]
  v_mfma_f32_16x16x32_bf16 v[48:51], v[72:75], a[172:175], v[48:51]
  v_mfma_f32_16x16x32_bf16 v[52:55], v[76:79], a[172:175], v[52:55]
  v_mfma_f32_16x16x32_bf16 v[56:59], v[72:75], v[108:111], v[56:59]
  v_mfma_f32_16x16x32_bf16 v[60:63], v[76:79], v[108:111], v[60:63]
  ds_read_b128 v[72:75], v7 offset:6144
  ds_read_b128 v[76:79], v7 offset:26624
  s_waitcnt lgkmcnt(4)
  v_mfma_f32_16x16x32_bf16 v[32:35], a[16:19], v[80:83], v[32:35]
  v_mfma_f32_16x16x32_bf16 v[36:39], a[16:19], v[84:87], v[36:39]
  v_mfma_f32_16x16x32_bf16 v[40:43], a[96:99], v[80:83], v[40:43]
  v_mfma_f32_16x16x32_bf16 v[44:47], a[96:99], v[84:87], v[44:47]
  v_mfma_f32_16x16x32_bf16 v[48:51], v[80:83], a[176:179], v[48:51]
  v_mfma_f32_16x16x32_bf16 v[52:55], v[84:87], a[176:179], v[52:55]
  v_mfma_f32_16x16x32_bf16 v[56:59], v[80:83], v[112:115], v[56:59]
  v_mfma_f32_16x16x32_bf16 v[60:63], v[84:87], v[112:115], v[60:63]
  ds_read_b128 v[80:83], v7 offset:7168
  ds_read_b128 v[84:87], v7 offset:27648
  s_waitcnt lgkmcnt(4)
  v_mfma_f32_16x16x32_bf16 v[32:35], a[20:23], v[88:91], v[32:35]
  v_mfma_f32_16x16x32_bf16 v[36:39], a[20:23], v[92:95], v[36:39]
  v_mfma_f32_16x16x32_bf16 v[40:43], a[100:103], v[88:91], v[40:43]
  v_mfma_f32_16x16x32_bf16 v[44:47], a[100:103], v[92:95], v[44:47]
  v_mfma_f32_16x16x32_bf16 v[48:51], v[88:91], a[180:183], v[48:51]
  v_mfma_f32_16x16x32_bf16 v[52:55], v[92:95], a[180:183], v[52:55]
  v_mfma_f32_16x16x32_bf16 v[56:59], v[88:91], v[116:119], v[56:59]
  v_mfma_f32_16x16x32_bf16 v[60:63], v[92:95], v[116:119], v[60:63]
  ds_read_b128 v[88:91], v7 offset:8192
  ds_read_b128 v[92:95], v7 offset:28672
  s_waitcnt lgkmcnt(4)
  v_mfma_f32_16x16x32_bf16 v[32:35], a[24:27], v[72:75], v[32:35]
  v_mfma_f32_16x16x32_bf16 v[36:39], a[24:27], v[76:79], v[36:39]
  v_mfma_f32_16x16x32_bf16 v[40:43], a[104:107], v[72:75], v[40:43]
  v_mfma_f32_16x16x32_bf16 v[44:47], a[104:107], v[76:79], v[44:47]
  v_mfma_f32_16x16x32_bf16 v[48:51], v[72:75], a[184:187], v[48:51]
  v_mfma_f32_16x16x32_bf16 v[52:55], v[76:79], a[184:187], v[52:55]
  v_mfma_f32_16x16x32_bf16 v[56:59], v[72:75], v[120:123], v[56:59]
  v_mfma_f32_16x16x32_bf16 v[60:63], v[76:79], v[120:123], v[60:63]
  ds_read_b128 v[72:75], v7 offset:9216
  ds_read_b128 v[76:79], v7 offset:29696
  s_waitcnt lgkmcnt(4)
  v_mfma_f32_16x16x32_bf16 v[32:35], a[28:31], v[80:83], v[32:35]
  v_mfma_f32_16x16x32_bf16 v[36:39], a[28:31], v[84:87], v[36:39]
  v_mfma_f32_16x16x32_bf16 v[40:43], a[108:111], v[80:83], v[40:43]
  v_mfma_f32_16x16x32_bf16 v[44:47], a[108:111], v[84:87], v[44:47]
  v_mfma_f32_16x16x32_bf16 v[48:51], v[80:83], a[188:191], v[48:51]
  v_mfma_f32_16x16x32_bf16 v[52:55], v[84:87], a[188:191], v[52:55]
  v_mfma_f32_16x16x32_bf16 v[56:59], v[80:83], v[124:127], v[56:59]
  v_mfma_f32_16x16x32_bf16 v[60:63], v[84:87], v[124:127], v[60:63]
  ds_read_b128 v[80:83], v7 offset:10240
  ds_read_b128 v[84:87], v7 offset:30720
  s_waitcnt lgkmcnt(4)
  v_mfma_f32_16x16x32_bf16 v[32:35], a[32:35], v[88:91], v[32:35]
  v_mfma_f32_16x16x32_bf16 v[36:39], a[32:35], v[92:95], v[36:39]
  v_mfma_f32_16x16x32_bf16 v[40:43], a[112:115], v[88:91], v[40:43]
  v_mfma_f32_16x16x32_bf16 v[44:47], a[112:115], v[92:95], v[44:47]
  v_mfma_f32_16x16x32_bf16 v[48:51], v[88:91], a[192:195], v[48:51]
  v_mfma_f32_16x16x32_bf16 v[52:55], v[92:95], a[192:195], v[52:55]
  v_mfma_f32_16x16x32_bf16 v[56:59], v[88:91], v[128:131], v[56:59]
  v_mfma_f32_16x16x32_bf16 v[60:63], v[92:95], v[128:131], v[60:63]
  ds_read_b128 v[88:91], v7 offset:11264
  ds_read_b128 v[92:95], v7 offset:31744
  s_waitcnt lgkmcnt(4)
  v_mfma_f32_16x16x32_bf16 v[32:35], a[36:39], v[72:75], v[32:35]
  v_mfma_f32_16x16x32_bf16 v[36:39], a[36:39], v[76:79], v[36:39]
  v_mfma_f32_16x16x32_bf16 v[40:43], a[116:119], v[72:75], v[40:43]
  v_mfma_f32_16x16x32_bf16 v[44:47], a[116:119], v[76:79], v[44:47]
  v_mfma_f32_16x16x32_bf16 v[48:51], v[72:75], a[196:199], v[48:51]
  v_mfma_f32_16x16x32_bf16 v[52:55], v[76:79], a[196:199], v[52:55]
  v_mfma_f32_16x16x32_bf16 v[56:59], v[72:75], v[132:135], v[56:59]
  v_mfma_f32_16x16x32_bf16 v[60:63], v[76:79], v[132:135], v[60:63]
  ds_read_b128 v[72:75], v7 offset:12288
  ds_read_b128 v[76:79], v7 offset:32768
  s_waitcnt lgkmcnt(4)
  v_mfma_f32_16x16x32_bf16 v[32:35], a[40:43], v[80:83], v[32:35]
  v_mfma_f32_16x16x32_bf16 v[36:39], a[40:43], v[84:87], v[36:39]
  v_mfma_f32_16x16x32_bf16 v[40:43], a[120:123], v[80:83], v[40:43]
  v_mfma_f32_16x16x32_bf16 v[44:47], a[120:123], v[84:87], v[44:47]
  v_mfma_f32_16x16x32_bf16 v[48:51], v[80:83], a[200:203], v[48:51]
  v_mfma_f32_16x16x32_bf16 v[52:55], v[84:87], a[200:203], v[52:55]
  v_mfma_f32_16x16x32_bf16 v[56:59], v[80:83], v[136:139], v[56:59]
  v_mfma_f32_16x16x32_bf16 v[60:63], v[84:87], v[136:139], v[60:63]
  ds_read_b128 v[80:83], v7 offset:13312
  ds_read_b128 v[84:87], v7 offset:33792
  s_waitcnt lgkmcnt(4)
  v_mfma_f32_16x16x32_bf16 v[32:35], a[44:47], v[88:91], v[32:35]
  v_mfma_f32_16x16x32_bf16 v[36:39], a[44:47], v[92:95], v[36:39]
  v_mfma_f32_16x16x32_bf16 v[40:43], a[124:127], v[88:91], v[40:43]
  v_mfma_f32_16x16x32_bf16 v[44:47], a[124:127], v[92:95], v[44:47]
  v_mfma_f32_16x16x32_bf16 v[48:51], v[88:91], a[204:207], v[48:51]
  v_mfma_f32_16x16x32_bf16 v[52:55], v[92:95], a[204:207], v[52:55]
  v_mfma_f32_16x16x32_bf16 v[56:59], v[88:91], v[140:143], v[56:59]
  v_mfma_f32_16x16x32_bf16 v[60:63], v[92:95], v[140:143], v[60:63]
  ds_read_b128 v[88:91], v7 offset:14336
  ds_read_b128 v[92:95], v7 offset:34816
  s_waitcnt lgkmcnt(4)
  v_mfma_f32_16x16x32_bf16 v[32:35], a[48:51], v[72:75], v[32:35]
  v_mfma_f32_16x16x32_bf16 v[36:39], a[48:51], v[76:79], v[36:39]
  v_mfma_f32_16x16x32_bf16 v[40:43], a[128:131], v[72:75], v[40:43]
  v_mfma_f32_16x16x32_bf16 v[44:47], a[128:131], v[76:79], v[44:47]
  v_mfma_f32_16x16x32_bf16 v[48:51], v[72:75], a[208:211], v[48:51]
  v_mfma_f32_16x16x32_bf16 v[52:55], v[76:79], a[208:211], v[52:55]
  v_mfma_f32_16x16x32_bf16 v[56:59], v[72:75], v[144:147], v[56:59]
  v_mfma_f32_16x16x32_bf16 v[60:63], v[76:79], v[144:147], v[60:63]
  ds_read_b128 v[72:75], v7 offset:15360
  ds_read_b128 v[76:79], v7 offset:35840
  s_waitcnt lgkmcnt(4)
  v_mfma_f32_16x16x32_bf16 v[32:35], a[52:55], v[80:83], v[32:35]
  v_mfma_f32_16x16x32_bf16 v[36:39], a[52:55], v[84:87], v[36:39]
  v_mfma_f32_16x16x32_bf16 v[40:43], a[132:135], v[80:83], v[40:43]
  v_mfma_f32_16x16x32_bf16 v[44:47], a[132:135], v[84:87], v[44:47]
  v_mfma_f32_16x16x32_bf16 v[48:51], v[80:83], a[212:215], v[48:51]
  v_mfma_f32_16x16x32_bf16 v[52:55], v[84:87], a[212:215], v[52:55]
  v_mfma_f32_16x16x32_bf16 v[56:59], v[80:83], v[148:151], v[56:59]
  v_mfma_f32_16x16x32_bf16 v[60:63], v[84:87], v[148:151], v[60:63]
  ds_read_b128 v[80:83], v7 offset:16384
  ds_read_b128 v[84:87], v7 offset:36864
  s_waitcnt lgkmcnt(4)
  v_mfma_f32_16x16x32_bf16 v[32:35], a[56:59], v[88:91], v[32:35]
  v_mfma_f32_16x16x32_bf16 v[36:39], a[56:59], v[92:95], v[36:39]
  v_mfma_f32_16x16x32_bf16 v[40:43], a[136:139], v[88:91], v[40:43]
  v_mfma_f32_16x16x32_bf16 v[44:47], a[136:139], v[92:95], v[44:47]
  v_mfma_f32_16x16x32_bf16 v[48:51], v[88:91], a[216:219], v[48:51]
  v_mfma_f32_16x16x32_bf16 v[52:55], v[92:95], a[216:219], v[52:55]
  v_mfma_f32_16x16x32_bf16 v[56:59], v[88:91], v[152:155], v[56:59]
  v_mfma_f32_16x16x32_bf16 v[60:63], v[92:95], v[152:155], v[60:63]
  ds_read_b128 v[88:91], v7 offset:17408
  ds_read_b128 v[92:95], v7 offset:37888
  s_waitcnt lgkmcnt(4)
  v_mfma_f32_16x16x32_bf16 v[32:35], a[60:63], v[72:75], v[32:35]
  v_mfma_f32_16x16x32_bf16 v[36:39], a[60:63], v[76:79], v[36:39]
  v_mfma_f32_16x16x32_bf16 v[40:43], a[140:143], v[72:75], v[40:43]
  v_mfma_f32_16x16x32_bf16 v[44:47], a[140:143], v[76:79], v[44:47]
  v_mfma_f32_16x16x32_bf16 v[48:51], v[72:75], a[220:223], v[48:51]
  v_mfma_f32_16x16x32_bf16 v[52:55], v[76:79], a[220:223], v[52:55]
  v_mfma_f32_16x16x32_bf16 v[56:59], v[72:75], v[156:159], v[56:59]
  v_mfma_f32_16x16x32_bf16 v[60:63], v[76:79], v[156:159], v[60:63]
  ds_read_b128 v[72:75], v7 offset:18432
  ds_read_b128 v[76:79], v7 offset:38912
  s_waitcnt lgkmcnt(4)
  v_mfma_f32_16x16x32_bf16 v[32:35], a[64:67], v[80:83], v[32:35]
  v_mfma_f32_16x16x32_bf16 v[36:39], a[64:67], v[84:87], v[36:39]
  v_mfma_f32_16x16x32_bf16 v[40:43], a[144:147], v[80:83], v[40:43]
  v_mfma_f32_16x16x32_bf16 v[44:47], a[144:147], v[84:87], v[44:47]
  v_mfma_f32_16x16x32_bf16 v[48:51], v[80:83], a[224:227], v[48:51]
  v_mfma_f32_16x16x32_bf16 v[52:55], v[84:87], a[224:227], v[52:55]
  v_mfma_f32_16x16x32_bf16 v[56:59], v[80:83], v[160:163], v[56:59]
  v_mfma_f32_16x16x32_bf16 v[60:63], v[84:87], v[160:163], v[60:63]
  ds_read_b128 v[80:83], v7 offset:19456
  ds_read_b128 v[84:87], v7 offset:39936
  s_waitcnt lgkmcnt(4)
  v_mfma_f32_16x16x32_bf16 v[32:35], a[68:71], v[88:91], v[32:35]
  v_mfma_f32_16x16x32_bf16 v[36:39], a[68:71], v[92:95], v[36:39]
  v_mfma_f32_16x16x32_bf16 v[40:43], a[148:151], v[88:91], v[40:43]
  v_mfma_f32_16x16x32_bf16 v[44:47], a[148:151], v[92:95], v[44:47]
  v_mfma_f32_16x16x32_bf16 v[48:51], v[88:91], a[228:231], v[48:51]
  v_mfma_f32_16x16x32_bf16 v[52:55], v[92:95], a[228:231], v[52:55]
  v_mfma_f32_16x16x32_bf16 v[56:59], v[88:91], v[164:167], v[56:59]
  v_mfma_f32_16x16x32_bf16 v[60:63], v[92:95], v[164:167], v[60:63]
  s_waitcnt lgkmcnt(2)
  v_mfma_f32_16x16x32_bf16 v[32:35], a[72:75], v[72:75], v[32:35]
  v_mfma_f32_16x16x32_bf16 v[36:39], a[72:75], v[76:79], v[36:39]
  v_mfma_f32_16x16x32_bf16 v[40:43], a[152:155], v[72:75], v[40:43]
  v_mfma_f32_16x16x32_bf16 v[44:47], a[152:155], v[76:79], v[44:47]
  v_mfma_f32_16x16x32_bf16 v[48:51], v[72:75], a[232:235], v[48:51]
  v_mfma_f32_16x16x32_bf16 v[52:55], v[76:79], a[232:235], v[52:55]
  v_mfma_f32_16x16x32_bf16 v[56:59], v[72:75], v[168:171], v[56:59]
  v_mfma_f32_16x16x32_bf16 v[60:63], v[76:79], v[168:171], v[60:63]
  s_waitcnt lgkmcnt(0)
  v_mfma_f32_16x16x32_bf16 v[32:35], a[76:79], v[80:83], v[32:35]
  v_mfma_f32_16x16x32_bf16 v[36:39], a[76:79], v[84:87], v[36:39]
  v_mfma_f32_16x16x32_bf16 v[40:43], a[156:159], v[80:83], v[40:43]
  v_mfma_f32_16x16x32_bf16 v[44:47], a[156:159], v[84:87], v[44:47]
  v_mfma_f32_16x16x32_bf16 v[48:51], v[80:83], a[236:239], v[48:51]
  v_mfma_f32_16x16x32_bf16 v[52:55], v[84:87], a[236:239], v[52:55]
  v_mfma_f32_16x16x32_bf16 v[56:59], v[80:83], v[172:175], v[56:59]
  v_mfma_f32_16x16x32_bf16 v[60:63], v[84:87], v[172:175], v[60:63]
  s_nop 0
  v_cvt_pk_bf16_f32 v8, v32, v33
  v_cvt_pk_bf16_f32 v9, v34, v35
  v_cvt_pk_bf16_f32 v10, v40, v41
  v_cvt_pk_bf16_f32 v11, v42, v43
  s_add_u32 s34, s22, 0
  buffer_store_dwordx4 v[8:11], v1, s[4:7], s34 offen
  v_cvt_pk_bf16_f32 v12, v36, v37
  v_cvt_pk_bf16_f32 v13, v38, v39
  v_cvt_pk_bf16_f32 v14, v44, v45
  v_cvt_pk_bf16_f32 v15, v46, v47
  s_add_u32 s34, s22, 6144
  buffer_store_dwordx4 v[12:15], v1, s[4:7], s34 offen
  v_cvt_pk_bf16_f32 v8, v48, v49
  v_cvt_pk_bf16_f32 v9, v50, v51
  v_cvt_pk_bf16_f32 v10, v52, v53
  v_cvt_pk_bf16_f32 v11, v54, v55
  s_add_u32 s34, s23, 4096
  buffer_store_dwordx4 v[8:11], v1, s[4:7], s34 offen sc1
  v_cvt_pk_bf16_f32 v12, v56, v57
  v_cvt_pk_bf16_f32 v13, v58, v59
  v_cvt_pk_bf16_f32 v14, v60, v61
  v_cvt_pk_bf16_f32 v15, v62, v63
  s_add_u32 s34, s23, 5120
  buffer_store_dwordx4 v[12:15], v1, s[4:7], s34 offen sc1
  s_waitcnt vmcnt(0)
  s_barrier
  s_add_u32 s17, s17, 1
  s_cmp_lt_u32 s17, 64
  s_cbranch_scc1 reca_ptop199
  s_branch reca_exit1
reca_pw3_164:
  s_mov_b32 s17, 0
  s_mov_b32 s26, 0
  s_mul_i32 s20, s17, 40960
  s_add_u32 s20, s20, 153647104
  s_add_u32 m0, s26, 30720
  s_nop 0
  buffer_load_dwordx4 v1, s[4:7], s20 offen offset:0 lds
  buffer_load_dwordx4 v1, s[4:7], s20 offen offset:1024 lds
  buffer_load_dwordx4 v1, s[4:7], s20 offen offset:2048 lds
  buffer_load_dwordx4 v1, s[4:7], s20 offen offset:3072 lds
  s_add_u32 s20, s20, 4096
  s_add_u32 m0, s26, 34816
  s_nop 0
  buffer_load_dwordx4 v1, s[4:7], s20 offen offset:0 lds
  buffer_load_dwordx4 v1, s[4:7], s20 offen offset:1024 lds
  buffer_load_dwordx4 v1, s[4:7], s20 offen offset:2048 lds
  buffer_load_dwordx4 v1, s[4:7], s20 offen offset:3072 lds
  s_add_u32 s20, s20, 4096
  s_add_u32 m0, s26, 38912
  s_nop 0
  buffer_load_dwordx4 v1, s[4:7], s20 offen offset:0 lds
  buffer_load_dwordx4 v1, s[4:7], s20 offen offset:1024 lds
  s_lshl_b32 s34, s15, 6
  s_add_u32 s34, s34, s17
  s_mul_i32 s34, s34, 12288
  s_mul_i32 s35, s16, 3072
  s_add_u32 s35, s35, s34
  s_add_u32 s27, s35, 37748736
  s_mul_i32 s35, s16, 6144
  s_add_u32 s35, s35, s34
  s_add_u32 s28, s35, 62914560
  s_mul_i32 s34, s15, 12
  s_mul_i32 s35, s16, 6
  s_add_u32 s34, s34, s35
  s_add_u32 s34, s34, 2
  s_mul_i32 s34, s34, 20480
  s_add_u32 s34, s34, 6291456
  buffer_load_dwordx4 a[0:3], v1, s[4:7], s34 offen offset:0
  buffer_load_dwordx4 a[4:7], v1, s[4:7], s34 offen offset:1024
  buffer_load_dwordx4 a[8:11], v1, s[4:7], s34 offen offset:2048
  buffer_load_dwordx4 a[12:15], v1, s[4:7], s34 offen offset:3072
  s_add_u32 s34, s34, 4096
  buffer_load_dwordx4 a[16:19], v1, s[4:7], s34 offen offset:0
  buffer_load_dwordx4 a[20:23], v1, s[4:7], s34 offen offset:1024
  buffer_load_dwordx4 a[24:27], v1, s[4:7], s34 offen offset:2048
  buffer_load_dwordx4 a[28:31], v1, s[4:7], s34 offen offset:3072
  s_add_u32 s34, s34, 4096
  buffer_load_dwordx4 a[32:35], v1, s[4:7], s34 offen offset:0
  buffer_load_dwordx4 a[36:39], v1, s[4:7], s34 offen offset:1024
  buffer_load_dwordx4 a[40:43], v1, s[4:7], s34 offen offset:2048
  buffer_load_dwordx4 a[44:47], v1, s[4:7], s34 offen offset:3072
  s_add_u32 s34, s34, 4096
  buffer_load_dwordx4 a[48:51], v1, s[4:7], s34 offen offset:0
  buffer_load_dwordx4 a[52:55], v1, s[4:7], s34 offen offset:1024
  buffer_load_dwordx4 a[56:59], v1, s[4:7], s34 offen offset:2048
  buffer_load_dwordx4 a[60:63], v1, s[4:7], s34 offen offset:3072
  s_add_u32 s34, s34, 4096
  buffer_load_dwordx4 a[64:67], v1, s[4:7], s34 offen offset:0
  buffer_load_dwordx4 a[68:71], v1, s[4:7], s34 offen offset:1024
  buffer_load_dwordx4 a[72:75], v1, s[4:7], s34 offen offset:2048
  buffer_load_dwordx4 a[76:79], v1, s[4:7], s34 offen offset:3072
  s_mul_i32 s34, s15, 12
  s_mul_i32 s35, s16, 6
  s_add_u32 s34, s34, s35
  s_add_u32 s34, s34, 3
  s_mul_i32 s34, s34, 20480
  s_add_u32 s34, s34, 6291456
  buffer_load_dwordx4 a[80:83], v1, s[4:7], s34 offen offset:0
  buffer_load_dwordx4 a[84:87], v1, s[4:7], s34 offen offset:1024
  buffer_load_dwordx4 a[88:91], v1, s[4:7], s34 offen offset:2048
  buffer_load_dwordx4 a[92:95], v1, s[4:7], s34 offen offset:3072
  s_add_u32 s34, s34, 4096
  buffer_load_dwordx4 a[96:99], v1, s[4:7], s34 offen offset:0
  buffer_load_dwordx4 a[100:103], v1, s[4:7], s34 offen offset:1024
  buffer_load_dwordx4 a[104:107], v1, s[4:7], s34 offen offset:2048
  buffer_load_dwordx4 a[108:111], v1, s[4:7], s34 offen offset:3072
  s_add_u32 s34, s34, 4096
  buffer_load_dwordx4 a[112:115], v1, s[4:7], s34 offen offset:0
  buffer_load_dwordx4 a[116:119], v1, s[4:7], s34 offen offset:1024
  buffer_load_dwordx4 a[120:123], v1, s[4:7], s34 offen offset:2048
  buffer_load_dwordx4 a[124:127], v1, s[4:7], s34 offen offset:3072
  s_add_u32 s34, s34, 4096
  buffer_load_dwordx4 a[128:131], v1, s[4:7], s34 offen offset:0
  buffer_load_dwordx4 a[132:135], v1, s[4:7], s34 offen offset:1024
  buffer_load_dwordx4 a[136:139], v1, s[4:7], s34 offen offset:2048
  buffer_load_dwordx4 a[140:143], v1, s[4:7], s34 offen offset:3072
  s_add_u32 s34, s34, 4096
  buffer_load_dwordx4 a[144:147], v1, s[4:7], s34 offen offset:0
  buffer_load_dwordx4 a[148:151], v1, s[4:7], s34 offen offset:1024
  buffer_load_dwordx4 a[152:155], v1, s[4:7], s34 offen offset:2048
  buffer_load_dwordx4 a[156:159], v1, s[4:7], s34 offen offset:3072
  s_waitcnt vmcnt(20)
  s_mul_i32 s34, s15, 12
  s_mul_i32 s35, s16, 6
  s_add_u32 s34, s34, s35
  s_add_u32 s34, s34, 4
  s_mul_i32 s34, s34, 20480
  s_add_u32 s34, s34, 6291456
  buffer_load_dwordx4 a[160:163], v1, s[4:7], s34 offen offset:0
  buffer_load_dwordx4 a[164:167], v1, s[4:7], s34 offen offset:1024
  buffer_load_dwordx4 a[168:171], v1, s[4:7], s34 offen offset:2048
  buffer_load_dwordx4 a[172:175], v1, s[4:7], s34 offen offset:3072
  s_add_u32 s34, s34, 4096
  buffer_load_dwordx4 a[176:179], v1, s[4:7], s34 offen offset:0
  buffer_load_dwordx4 a[180:183], v1, s[4:7], s34 offen offset:1024
  buffer_load_dwordx4 a[184:187], v1, s[4:7], s34 offen offset:2048
  buffer_load_dwordx4 a[188:191], v1, s[4:7], s34 offen offset:3072
  s_add_u32 s34, s34, 4096
  buffer_load_dwordx4 a[192:195], v1, s[4:7], s34 offen offset:0
  buffer_load_dwordx4 a[196:199], v1, s[4:7], s34 offen offset:1024
  buffer_load_dwordx4 a[200:203], v1, s[4:7], s34 offen offset:2048
  buffer_load_dwordx4 a[204:207], v1, s[4:7], s34 offen offset:3072
  s_add_u32 s34, s34, 4096
  buffer_load_dwordx4 a[208:211], v1, s[4:7], s34 offen offset:0
  buffer_load_dwordx4 a[212:215], v1, s[4:7], s34 offen offset:1024
  buffer_load_dwordx4 a[216:219], v1, s[4:7], s34 offen offset:2048
  buffer_load_dwordx4 a[220:223], v1, s[4:7], s34 offen offset:3072
  s_add_u32 s34, s34, 4096
  buffer_load_dwordx4 a[224:227], v1, s[4:7], s34 offen offset:0
  buffer_load_dwordx4 a[228:231], v1, s[4:7], s34 offen offset:1024
  buffer_load_dwordx4 a[232:235], v1, s[4:7], s34 offen offset:2048
  buffer_load_dwordx4 a[236:239], v1, s[4:7], s34 offen offset:3072
  s_waitcnt vmcnt(20)
  s_mul_i32 s34, s15, 12
  s_mul_i32 s35, s16, 6
  s_add_u32 s34, s34, s35
  s_add_u32 s34, s34, 5
  s_mul_i32 s34, s34, 20480
  s_add_u32 s34, s34, 6291456
  buffer_load_dwordx4 v[96:99], v1, s[4:7], s34 offen offset:0
  buffer_load_dwordx4 v[100:103], v1, s[4:7], s34 offen offset:1024
  buffer_load_dwordx4 v[104:107], v1, s[4:7], s34 offen offset:2048
  buffer_load_dwordx4 v[108:111], v1, s[4:7], s34 offen offset:3072
  s_add_u32 s34, s34, 4096
  buffer_load_dwordx4 v[112:115], v1, s[4:7], s34 offen offset:0
  buffer_load_dwordx4 v[116:119], v1, s[4:7], s34 offen offset:1024
  buffer_load_dwordx4 v[120:123], v1, s[4:7], s34 offen offset:2048
  buffer_load_dwordx4 v[124:127], v1, s[4:7], s34 offen offset:3072
  s_add_u32 s34, s34, 4096
  buffer_load_dwordx4 v[128:131], v1, s[4:7], s34 offen offset:0
  buffer_load_dwordx4 v[132:135], v1, s[4:7], s34 offen offset:1024
  buffer_load_dwordx4 v[136:139], v1, s[4:7], s34 offen offset:2048
  buffer_load_dwordx4 v[140:143], v1, s[4:7], s34 offen offset:3072
  s_add_u32 s34, s34, 4096
  buffer_load_dwordx4 v[144:147], v1, s[4:7], s34 offen offset:0
  buffer_load_dwordx4 v[148:151], v1, s[4:7], s34 offen offset:1024
  buffer_load_dwordx4 v[152:155], v1, s[4:7], s34 offen offset:2048
  buffer_load_dwordx4 v[156:159], v1, s[4:7], s34 offen offset:3072
  s_add_u32 s34, s34, 4096
  buffer_load_dwordx4 v[160:163], v1, s[4:7], s34 offen offset:0
  buffer_load_dwordx4 v[164:167], v1, s[4:7], s34 offen offset:1024
  buffer_load_dwordx4 v[168:171], v1, s[4:7], s34 offen offset:2048
  buffer_load_dwordx4 v[172:175], v1, s[4:7], s34 offen offset:3072
  s_waitcnt vmcnt(20)
  s_lshl_b32 s34, s13, 3
  v_mov_b32 v30, s34
reca_cens204:
  buffer_load_dwordx2 v[28:29], v30, s[8:11], 0 offen sc1
  s_waitcnt vmcnt(0)
  v_readfirstlane_b32 s35, v28
  v_readfirstlane_b32 s36, v29
  v_sad_u8 v28, v28, 0, 0
  v_sad_u8 v28, v29, 0, v28
  s_nop 0
  v_readfirstlane_b32 s34, v28
  s_nop 3
  s_cmp_ge_u32 s34, 32
  s_cbranch_scc1 reca_censok205
  s_sleep 8
  s_sub_u32 s18, s18, 1
  s_cbranch_scc0 reca_cens204
  s_mov_b32 s18, 0
reca_censok205:
  s_lshl_b32 s34, s42, 3
  s_mov_b32 s37, s36
  s_mov_b32 s36, s35
  s_lshr_b64 s[36:37], s[36:37], s34
  s_and_b32 s36, s36, 0xff
  s_cmp_eq_u32 s36, 32
  s_cselect_b32 s43, 0, 1
  s_cmp_lg_u32 s43, 0
  s_cbranch_scc1 reca_pslow206
reca_ptop207:
  s_cmp_lt_u32 s17, 6
  s_cbranch_scc1 reca_pgo208
  s_sub_u32 s36, s17, 6
reca_ppoll209:
  buffer_load_dword v28, v4, s[4:7], s25 offen sc1
  s_waitcnt vmcnt(0)
  v_readfirstlane_b32 s34, v28
  s_nop 3
  s_cmp_ge_i32 s34, s36
  s_cbranch_scc1 reca_pgo208
  s_sleep 8
  s_sub_u32 s18, s18, 1
  s_cbranch_scc0 reca_ppoll209
  s_mov_b32 s18, 0
reca_pgo208:
  s_waitcnt vmcnt(0)
  s_barrier
  v_add_u32 v7, s26, v1
  s_xor_b32 s26, s26, 40960
  s_add_u32 s37, s17, 1
  s_cmp_ge_u32 s37, 64
  s_cbranch_scc1 reca_pnodma210
  s_mul_i32 s20, s37, 40960
  s_add_u32 s20, s20, 153647104
  s_add_u32 m0, s26, 30720
  s_nop 0
  buffer_load_dwordx4 v1, s[4:7], s20 offen offset:0 lds
  buffer_load_dwordx4 v1, s[4:7], s20 offen offset:1024 lds
  buffer_load_dwordx4 v1, s[4:7], s20 offen offset:2048 lds
  buffer_load_dwordx4 v1, s[4:7], s20 offen offset:3072 lds
  s_add_u32 s20, s20, 4096
  s_add_u32 m0, s26, 34816
  s_nop 0
  buffer_load_dwordx4 v1, s[4:7], s20 offen offset:0 lds
  buffer_load_dwordx4 v1, s[4:7], s20 offen offset:1024 lds
  buffer_load_dwordx4 v1, s[4:7], s20 offen offset:2048 lds
  buffer_load_dwordx4 v1, s[4:7], s20 offen offset:3072 lds
  s_add_u32 s20, s20, 4096
  s_add_u32 m0, s26, 38912
  s_nop 0
  buffer_load_dwordx4 v1, s[4:7], s20 offen offset:0 lds
  buffer_load_dwordx4 v1, s[4:7], s20 offen offset:1024 lds
  s_lshl_b32 s34, s15, 6
  s_add_u32 s34, s34, s37
  s_mul_i32 s34, s34, 12288
  s_mul_i32 s35, s16, 3072
  s_add_u32 s35, s35, s34
  s_add_u32 s27, s35, 37748736
  s_mul_i32 s35, s16, 6144
  s_add_u32 s35, s35, s34
  s_add_u32 s28, s35, 62914560
reca_pnodma210:
  s_lshl_b32 s34, s15, 6
  s_add_u32 s34, s34, s17
  s_mul_i32 s34, s34, 12288
  s_mul_i32 s35, s16, 3072
  s_add_u32 s35, s35, s34
  s_add_u32 s21, s35, 37748736
  s_add_u32 s22, s35, 88080384
  s_mul_i32 s35, s16, 6144
  s_add_u32 s35, s35, s34
  s_add_u32 s23, s35, 62914560
  ds_read_b128 v[72:75], v7 offset:0
  ds_read_b128 v[76:79], v7 offset:20480
  ds_read_b128 v[80:83], v7 offset:1024
  ds_read_b128 v[84:87], v7 offset:21504
  ds_read_b128 v[88:91], v7 offset:2048
  ds_read_b128 v[92:95], v7 offset:22528
  s_waitcnt lgkmcnt(4)
  v_mfma_f32_16x16x32_bf16 v[32:35], a[0:3], v[72:75], 0
  v_mfma_f32_16x16x32_bf16 v[36:39], a[0:3], v[76:79], 0
  v_mfma_f32_16x16x32_bf16 v[40:43], a[80:83], v[72:75], 0
  v_mfma_f32_16x16x32_bf16 v[44:47], a[80:83], v[76:79], 0
  v_mfma_f32_16x16x32_bf16 v[48:51], a[160:163], v[72:75], 0
  v_mfma_f32_16x16x32_bf16 v[52:55], a[160:163], v[76:79], 0
  v_mfma_f32_16x16x32_bf16 v[56:59], v[96:99], v[72:75], 0
  v_mfma_f32_16x16x32_bf16 v[60:63], v[96:99], v[76:79], 0
  ds_read_b128 v[72:75], v7 offset:3072
  ds_read_b128 v[76:79], v7 offset:23552
  s_waitcnt lgkmcnt(4)
  v_mfma_f32_16x16x32_bf16 v[32:35], a[4:7], v[80:83], v[32:35]
  v_mfma_f32_16x16x32_bf16 v[36:39], a[4:7], v[84:87], v[36:39]
  v_mfma_f32_16x16x32_bf16 v[40:43], a[84:87], v[80:83], v[40:43]
  v_mfma_f32_16x16x32_bf16 v[44:47], a[84:87], v[84:87], v[44:47]
  v_mfma_f32_16x16x32_bf16 v[48:51], a[164:167], v[80:83], v[48:51]
  v_mfma_f32_16x16x32_bf16 v[52:55], a[164:167], v[84:87], v[52:55]
  v_mfma_f32_16x16x32_bf16 v[56:59], v[100:103], v[80:83], v[56:59]
  v_mfma_f32_16x16x32_bf16 v[60:63], v[100:103], v[84:87], v[60:63]
  ds_read_b128 v[80:83], v7 offset:4096
  ds_read_b128 v[84:87], v7 offset:24576
  s_waitcnt lgkmcnt(4)
  v_mfma_f32_16x16x32_bf16 v[32:35], a[8:11], v[88:91], v[32:35]
  v_mfma_f32_16x16x32_bf16 v[36:39], a[8:11], v[92:95], v[36:39]
  v_mfma_f32_16x16x32_bf16 v[40:43], a[88:91], v[88:91], v[40:43]
  v_mfma_f32_16x16x32_bf16 v[44:47], a[88:91], v[92:95], v[44:47]
  v_mfma_f32_16x16x32_bf16 v[48:51], a[168:171], v[88:91], v[48:51]
  v_mfma_f32_16x16x32_bf16 v[52:55], a[168:171], v[92:95], v[52:55]
  v_mfma_f32_16x16x32_bf16 v[56:59], v[104:107], v[88:91], v[56:59]
  v_mfma_f32_16x16x32_bf16 v[60:63], v[104:107], v[92:95], v[60:63]
  ds_read_b128 v[88:91], v7 offset:5120
  ds_read_b128 v[92:95], v7 offset:25600
  s_waitcnt lgkmcnt(4)
  v_mfma_f32_16x16x32_bf16 v[32:35], a[12:15], v[72:75], v[32:35]
  v_mfma_f32_16x16x32_bf16 v[36:39], a[12:15], v[76:79], v[36:39]
  v_mfma_f32_16x16x32_bf16 v[40:43], a[92:95], v[72:75], v[40:43]
  v_mfma_f32_16x16x32_bf16 v[44:47], a[92:95], v[76:79], v[44:47]
  v_mfma_f32_16x16x32_bf16 v[48:51], a[172:175], v[72:75], v[48:51]
  v_mfma_f32_16x16x32_bf16 v[52:55], a[172:175], v[76:79], v[52:55]
  v_mfma_f32_16x16x32_bf16 v[56:59], v[108:111], v[72:75], v[56:59]
  v_mfma_f32_16x16x32_bf16 v[60:63], v[108:111], v[76:79], v[60:63]
  ds_read_b128 v[72:75], v7 offset:6144
  ds_read_b128 v[76:79], v7 offset:26624
  s_waitcnt lgkmcnt(4)
  v_mfma_f32_16x16x32_bf16 v[32:35], a[16:19], v[80:83], v[32:35]
  v_mfma_f32_16x16x32_bf16 v[36:39], a[16:19], v[84:87], v[36:39]
  v_mfma_f32_16x16x32_bf16 v[40:43], a[96:99], v[80:83], v[40:43]
  v_mfma_f32_16x16x32_bf16 v[44:47], a[96:99], v[84:87], v[44:47]
  v_mfma_f32_16x16x32_bf16 v[48:51], a[176:179], v[80:83], v[48:51]
  v_mfma_f32_16x16x32_bf16 v[52:55], a[176:179], v[84:87], v[52:55]
  v_mfma_f32_16x16x32_bf16 v[56:59], v[112:115], v[80:83], v[56:59]
  v_mfma_f32_16x16x32_bf16 v[60:63], v[112:115], v[84:87], v[60:63]
  ds_read_b128 v[80:83], v7 offset:7168
  ds_read_b128 v[84:87], v7 offset:27648
  s_waitcnt lgkmcnt(4)
  v_mfma_f32_16x16x32_bf16 v[32:35], a[20:23], v[88:91], v[32:35]
  v_mfma_f32_16x16x32_bf16 v[36:39], a[20:23], v[92:95], v[36:39]
  v_mfma_f32_16x16x32_bf16 v[40:43], a[100:103], v[88:91], v[40:43]
  v_mfma_f32_16x16x32_bf16 v[44:47], a[100:103], v[92:95], v[44:47]
  v_mfma_f32_16x16x32_bf16 v[48:51], a[180:183], v[88:91], v[48:51]
  v_mfma_f32_16x16x32_bf16 v[52:55], a[180:183], v[92:95], v[52:55]
  v_mfma_f32_16x16x32_bf16 v[56:59], v[116:119], v[88:91], v[56:59]
  v_mfma_f32_16x16x32_bf16 v[60:63], v[116:119], v[92:95], v[60:63]
  ds_read_b128 v[88:91], v7 offset:8192
  ds_read_b128 v[92:95], v7 offset:28672
  s_waitcnt lgkmcnt(4)
  v_mfma_f32_16x16x32_bf16 v[32:35], a[24:27], v[72:75], v[32:35]
  v_mfma_f32_16x16x32_bf16 v[36:39], a[24:27], v[76:79], v[36:39]
  v_mfma_f32_16x16x32_bf16 v[40:43], a[104:107], v[72:75], v[40:43]
  v_mfma_f32_16x16x32_bf16 v[44:47], a[104:107], v[76:79], v[44:47]
  v_mfma_f32_16x16x32_bf16 v[48:51], a[184:187], v[72:75], v[48:51]
  v_mfma_f32_16x16x32_bf16 v[52:55], a[184:187], v[76:79], v[52:55]
  v_mfma_f32_16x16x32_bf16 v[56:59], v[120:123], v[72:75], v[56:59]
  v_mfma_f32_16x16x32_bf16 v[60:63], v[120:123], v[76:79], v[60:63]
  ds_read_b128 v[72:75], v7 offset:9216
  ds_read_b128 v[76:79], v7 offset:29696
  s_waitcnt lgkmcnt(4)
  v_mfma_f32_16x16x32_bf16 v[32:35], a[28:31], v[80:83], v[32:35]
  v_mfma_f32_16x16x32_bf16 v[36:39], a[28:31], v[84:87], v[36:39]
  v_mfma_f32_16x16x32_bf16 v[40:43], a[108:111], v[80:83], v[40:43]
  v_mfma_f32_16x16x32_bf16 v[44:47], a[108:111], v[84:87], v[44:47]
  v_mfma_f32_16x16x32_bf16 v[48:51], a[188:191], v[80:83], v[48:51]
  v_mfma_f32_16x16x32_bf16 v[52:55], a[188:191], v[84:87], v[52:55]
  v_mfma_f32_16x16x32_bf16 v[56:59], v[124:127], v[80:83], v[56:59]
  v_mfma_f32_16x16x32_bf16 v[60:63], v[124:127], v[84:87], v[60:63]
  ds_read_b128 v[80:83], v7 offset:10240
  ds_read_b128 v[84:87], v7 offset:30720
  s_waitcnt lgkmcnt(4)
  v_mfma_f32_16x16x32_bf16 v[32:35], a[32:35], v[88:91], v[32:35]
  v_mfma_f32_16x16x32_bf16 v[36:39], a[32:35], v[92:95], v[36:39]
  v_mfma_f32_16x16x32_bf16 v[40:43], a[112:115], v[88:91], v[40:43]
  v_mfma_f32_16x16x32_bf16 v[44:47], a[112:115], v[92:95], v[44:47]
  v_mfma_f32_16x16x32_bf16 v[48:51], a[192:195], v[88:91], v[48:51]
  v_mfma_f32_16x16x32_bf16 v[52:55], a[192:195], v[92:95], v[52:55]
  v_mfma_f32_16x16x32_bf16 v[56:59], v[128:131], v[88:91], v[56:59]
  v_mfma_f32_16x16x32_bf16 v[60:63], v[128:131], v[92:95], v[60:63]
  ds_read_b128 v[88:91], v7 offset:11264
  ds_read_b128 v[92:95], v7 offset:31744
  s_waitcnt lgkmcnt(4)
  v_mfma_f32_16x16x32_bf16 v[32:35], a[36:39], v[72:75], v[32:35]
  v_mfma_f32_16x16x32_bf16 v[36:39], a[36:39], v[76:79], v[36:39]
  v_mfma_f32_16x16x32_bf16 v[40:43], a[116:119], v[72:75], v[40:43]
  v_mfma_f32_16x16x32_bf16 v[44:47], a[116:119], v[76:79], v[44:47]
  v_mfma_f32_16x16x32_bf16 v[48:51], a[196:199], v[72:75], v[48:51]
  v_mfma_f32_16x16x32_bf16 v[52:55], a[196:199], v[76:79], v[52:55]
  v_mfma_f32_16x16x32_bf16 v[56:59], v[132:135], v[72:75], v[56:59]
  v_mfma_f32_16x16x32_bf16 v[60:63], v[132:135], v[76:79], v[60:63]
  ds_read_b128 v[72:75], v7 offset:12288
  ds_read_b128 v[76:79], v7 offset:32768
  s_waitcnt lgkmcnt(4)
  v_mfma_f32_16x16x32_bf16 v[32:35], a[40:43], v[80:83], v[32:35]
  v_mfma_f32_16x16x32_bf16 v[36:39], a[40:43], v[84:87], v[36:39]
  v_mfma_f32_16x16x32_bf16 v[40:43], a[120:123], v[80:83], v[40:43]
  v_mfma_f32_16x16x32_bf16 v[44:47], a[120:123], v[84:87], v[44:47]
  v_mfma_f32_16x16x32_bf16 v[48:51], a[200:203], v[80:83], v[48:51]
  v_mfma_f32_16x16x32_bf16 v[52:55], a[200:203], v[84:87], v[52:55]
  v_mfma_f32_16x16x32_bf16 v[56:59], v[136:139], v[80:83], v[56:59]
  v_mfma_f32_16x16x32_bf16 v[60:63], v[136:139], v[84:87], v[60:63]
  ds_read_b128 v[80:83], v7 offset:13312
  ds_read_b128 v[84:87], v7 offset:33792
  s_waitcnt lgkmcnt(4)
  v_mfma_f32_16x16x32_bf16 v[32:35], a[44:47], v[88:91], v[32:35]
  v_mfma_f32_16x16x32_bf16 v[36:39], a[44:47], v[92:95], v[36:39]
  v_mfma_f32_16x16x32_bf16 v[40:43], a[124:127], v[88:91], v[40:43]
  v_mfma_f32_16x16x32_bf16 v[44:47], a[124:127], v[92:95], v[44:47]
  v_mfma_f32_16x16x32_bf16 v[48:51], a[204:207], v[88:91], v[48:51]
  v_mfma_f32_16x16x32_bf16 v[52:55], a[204:207], v[92:95], v[52:55]
  v_mfma_f32_16x16x32_bf16 v[56:59], v[140:143], v[88:91], v[56:59]
  v_mfma_f32_16x16x32_bf16 v[60:63], v[140:143], v[92:95], v[60:63]
  ds_read_b128 v[88:91], v7 offset:14336
  ds_read_b128 v[92:95], v7 offset:34816
  s_waitcnt lgkmcnt(4)
  v_mfma_f32_16x16x32_bf16 v[32:35], a[48:51], v[72:75], v[32:35]
  v_mfma_f32_16x16x32_bf16 v[36:39], a[48:51], v[76:79], v[36:39]
  v_mfma_f32_16x16x32_bf16 v[40:43], a[128:131], v[72:75], v[40:43]
  v_mfma_f32_16x16x32_bf16 v[44:47], a[128:131], v[76:79], v[44:47]
  v_mfma_f32_16x16x32_bf16 v[48:51], a[208:211], v[72:75], v[48:51]
  v_mfma_f32_16x16x32_bf16 v[52:55], a[208:211], v[76:79], v[52:55]
  v_mfma_f32_16x16x32_bf16 v[56:59], v[144:147], v[72:75], v[56:59]
  v_mfma_f32_16x16x32_bf16 v[60:63], v[144:147], v[76:79], v[60:63]
  ds_read_b128 v[72:75], v7 offset:15360
  ds_read_b128 v[76:79], v7 offset:35840
  s_waitcnt lgkmcnt(4)
  v_mfma_f32_16x16x32_bf16 v[32:35], a[52:55], v[80:83], v[32:35]
  v_mfma_f32_16x16x32_bf16 v[36:39], a[52:55], v[84:87], v[36:39]
  v_mfma_f32_16x16x32_bf16 v[40:43], a[132:135], v[80:83], v[40:43]
  v_mfma_f32_16x16x32_bf16 v[44:47], a[132:135], v[84:87], v[44:47]
  v_mfma_f32_16x16x32_bf16 v[48:51], a[212:215], v[80:83], v[48:51]
  v_mfma_f32_16x16x32_bf16 v[52:55], a[212:215], v[84:87], v[52:55]
  v_mfma_f32_16x16x32_bf16 v[56:59], v[148:151], v[80:83], v[56:59]
  v_mfma_f32_16x16x32_bf16 v[60:63], v[148:151], v[84:87], v[60:63]
  ds_read_b128 v[80:83], v7 offset:16384
  ds_read_b128 v[84:87], v7 offset:36864
  s_waitcnt lgkmcnt(4)
  v_mfma_f32_16x16x32_bf16 v[32:35], a[56:59], v[88:91], v[32:35]
  v_mfma_f32_16x16x32_bf16 v[36:39], a[56:59], v[92:95], v[36:39]
  v_mfma_f32_16x16x32_bf16 v[40:43], a[136:139], v[88:91], v[40:43]
  v_mfma_f32_16x16x32_bf16 v[44:47], a[136:139], v[92:95], v[44:47]
  v_mfma_f32_16x16x32_bf16 v[48:51], a[216:219], v[88:91], v[48:51]
  v_mfma_f32_16x16x32_bf16 v[52:55], a[216:219], v[92:95], v[52:55]
  v_mfma_f32_16x16x32_bf16 v[56:59], v[152:155], v[88:91], v[56:59]
  v_mfma_f32_16x16x32_bf16 v[60:63], v[152:155], v[92:95], v[60:63]
  ds_read_b128 v[88:91], v7 offset:17408
  ds_read_b128 v[92:95], v7 offset:37888
  s_waitcnt lgkmcnt(4)
  v_mfma_f32_16x16x32_bf16 v[32:35], a[60:63], v[72:75], v[32:35]
  v_mfma_f32_16x16x32_bf16 v[36:39], a[60:63], v[76:79], v[36:39]
  v_mfma_f32_16x16x32_bf16 v[40:43], a[140:143], v[72:75], v[40:43]
  v_mfma_f32_16x16x32_bf16 v[44:47], a[140:143], v[76:79], v[44:47]
  v_mfma_f32_16x16x32_bf16 v[48:51], a[220:223], v[72:75], v[48:51]
  v_mfma_f32_16x16x32_bf16 v[52:55], a[220:223], v[76:79], v[52:55]
  v_mfma_f32_16x16x32_bf16 v[56:59], v[156:159], v[72:75], v[56:59]
  v_mfma_f32_16x16x32_bf16 v[60:63], v[156:159], v[76:79], v[60:63]
  ds_read_b128 v[72:75], v7 offset:18432
  ds_read_b128 v[76:79], v7 offset:38912
  s_waitcnt lgkmcnt(4)
  v_mfma_f32_16x16x32_bf16 v[32:35], a[64:67], v[80:83], v[32:35]
  v_mfma_f32_16x16x32_bf16 v[36:39], a[64:67], v[84:87], v[36:39]
  v_mfma_f32_16x16x32_bf16 v[40:43], a[144:147], v[80:83], v[40:43]
  v_mfma_f32_16x16x32_bf16 v[44:47], a[144:147], v[84:87], v[44:47]
  v_mfma_f32_16x16x32_bf16 v[48:51], a[224:227], v[80:83], v[48:51]
  v_mfma_f32_16x16x32_bf16 v[52:55], a[224:227], v[84:87], v[52:55]
  v_mfma_f32_16x16x32_bf16 v[56:59], v[160:163], v[80:83], v[56:59]
  v_mfma_f32_16x16x32_bf16 v[60:63], v[160:163], v[84:87], v[60:63]
  ds_read_b128 v[80:83], v7 offset:19456
  ds_read_b128 v[84:87], v7 offset:39936
  s_waitcnt lgkmcnt(4)
  v_mfma_f32_16x16x32_bf16 v[32:35], a[68:71], v[88:91], v[32:35]
  v_mfma_f32_16x16x32_bf16 v[36:39], a[68:71], v[92:95], v[36:39]
  v_mfma_f32_16x16x32_bf16 v[40:43], a[148:151], v[88:91], v[40:43]
  v_mfma_f32_16x16x32_bf16 v[44:47], a[148:151], v[92:95], v[44:47]
  v_mfma_f32_16x16x32_bf16 v[48:51], a[228:231], v[88:91], v[48:51]
  v_mfma_f32_16x16x32_bf16 v[52:55], a[228:231], v[92:95], v[52:55]
  v_mfma_f32_16x16x32_bf16 v[56:59], v[164:167], v[88:91], v[56:59]
  v_mfma_f32_16x16x32_bf16 v[60:63], v[164:167], v[92:95], v[60:63]
  s_waitcnt lgkmcnt(2)
  v_mfma_f32_16x16x32_bf16 v[32:35], a[72:75], v[72:75], v[32:35]
  v_mfma_f32_16x16x32_bf16 v[36:39], a[72:75], v[76:79], v[36:39]
  v_mfma_f32_16x16x32_bf16 v[40:43], a[152:155], v[72:75], v[40:43]
  v_mfma_f32_16x16x32_bf16 v[44:47], a[152:155], v[76:79], v[44:47]
  v_mfma_f32_16x16x32_bf16 v[48:51], a[232:235], v[72:75], v[48:51]
  v_mfma_f32_16x16x32_bf16 v[52:55], a[232:235], v[76:79], v[52:55]
  v_mfma_f32_16x16x32_bf16 v[56:59], v[168:171], v[72:75], v[56:59]
  v_mfma_f32_16x16x32_bf16 v[60:63], v[168:171], v[76:79], v[60:63]
  s_waitcnt lgkmcnt(0)
  v_mfma_f32_16x16x32_bf16 v[32:35], a[76:79], v[80:83], v[32:35]
  v_mfma_f32_16x16x32_bf16 v[36:39], a[76:79], v[84:87], v[36:39]
  v_mfma_f32_16x16x32_bf16 v[40:43], a[156:159], v[80:83], v[40:43]
  v_mfma_f32_16x16x32_bf16 v[44:47], a[156:159], v[84:87], v[44:47]
  v_mfma_f32_16x16x32_bf16 v[48:51], a[236:239], v[80:83], v[48:51]
  v_mfma_f32_16x16x32_bf16 v[52:55], a[236:239], v[84:87], v[52:55]
  v_mfma_f32_16x16x32_bf16 v[56:59], v[172:175], v[80:83], v[56:59]
  v_mfma_f32_16x16x32_bf16 v[60:63], v[172:175], v[84:87], v[60:63]
  s_nop 0
  v_cvt_pk_bf16_f32 v8, v32, v33
  v_cvt_pk_bf16_f32 v9, v34, v35
  v_cvt_pk_bf16_f32 v10, v40, v41
  v_cvt_pk_bf16_f32 v11, v42, v43
  s_add_u32 s34, s22, 1024
  buffer_store_dwordx4 v[8:11], v1, s[4:7], s34 offen
  v_cvt_pk_bf16_f32 v12, v36, v37
  v_cvt_pk_bf16_f32 v13, v38, v39
  v_cvt_pk_bf16_f32 v14, v44, v45
  v_cvt_pk_bf16_f32 v15, v46, v47
  s_add_u32 s34, s22, 7168
  buffer_store_dwordx4 v[12:15], v1, s[4:7], s34 offen
  v_cvt_pk_bf16_f32 v8, v48, v49
  v_cvt_pk_bf16_f32 v9, v50, v51
  v_cvt_pk_bf16_f32 v10, v56, v57
  v_cvt_pk_bf16_f32 v11, v58, v59
  s_add_u32 s34, s22, 2048
  buffer_store_dwordx4 v[8:11], v1, s[4:7], s34 offen
  v_cvt_pk_bf16_f32 v12, v52, v53
  v_cvt_pk_bf16_f32 v13, v54, v55
  v_cvt_pk_bf16_f32 v14, v60, v61
  v_cvt_pk_bf16_f32 v15, v62, v63
  s_add_u32 s34, s22, 8192
  buffer_store_dwordx4 v[12:15], v1, s[4:7], s34 offen
  s_waitcnt vmcnt(0)
  s_barrier
  s_add_u32 s17, s17, 1
  s_cmp_lt_u32 s17, 64
  s_cbranch_scc1 reca_ptop207
  s_branch reca_exit1
reca_pslow206:
reca_ptop212:
  s_cmp_lt_u32 s17, 6
  s_cbranch_scc1 reca_pgo213
  s_sub_u32 s36, s17, 6
reca_ppoll214:
  buffer_load_dword v28, v4, s[4:7], s25 offen sc1
  s_waitcnt vmcnt(0)
  v_readfirstlane_b32 s34, v28
  s_nop 3
  s_cmp_ge_i32 s34, s36
  s_cbranch_scc1 reca_pgo213
  s_sleep 8
  s_sub_u32 s18, s18, 1
  s_cbranch_scc0 reca_ppoll214
  s_mov_b32 s18, 0
reca_pgo213:
  s_waitcnt vmcnt(0)
  s_barrier
  v_add_u32 v7, s26, v1
  s_xor_b32 s26, s26, 40960
  s_add_u32 s37, s17, 1
  s_cmp_ge_u32 s37, 64
  s_cbranch_scc1 reca_pnodma215
  s_mul_i32 s20, s37, 40960
  s_add_u32 s20, s20, 153647104
  s_add_u32 m0, s26, 30720
  s_nop 0
  buffer_load_dwordx4 v1, s[4:7], s20 offen offset:0 lds
  buffer_load_dwordx4 v1, s[4:7], s20 offen offset:1024 lds
  buffer_load_dwordx4 v1, s[4:7], s20 offen offset:2048 lds
  buffer_load_dwordx4 v1, s[4:7], s20 offen offset:3072 lds
  s_add_u32 s20, s20, 4096
  s_add_u32 m0, s26, 34816
  s_nop 0
  buffer_load_dwordx4 v1, s[4:7], s20 offen offset:0 lds
  buffer_load_dwordx4 v1, s[4:7], s20 offen offset:1024 lds
  buffer_load_dwordx4 v1, s[4:7], s20 offen offset:2048 lds
  buffer_load_dwordx4 v1, s[4:7], s20 offen offset:3072 lds
  s_add_u32 s20, s20, 4096
  s_add_u32 m0, s26, 38912
  s_nop 0
  buffer_load_dwordx4 v1, s[4:7], s20 offen offset:0 lds
  buffer_load_dwordx4 v1, s[4:7], s20 offen offset:1024 lds
  s_lshl_b32 s34, s15, 6
  s_add_u32 s34, s34, s37
  s_mul_i32 s34, s34, 12288
  s_mul_i32 s35, s16, 3072
  s_add_u32 s35, s35, s34
  s_add_u32 s27, s35, 37748736
  s_mul_i32 s35, s16, 6144
  s_add_u32 s35, s35, s34
  s_add_u32 s28, s35, 62914560
reca_pnodma215:
  s_lshl_b32 s34, s15, 6
  s_add_u32 s34, s34, s17
  s_mul_i32 s34, s34, 12288
  s_mul_i32 s35, s16, 3072
  s_add_u32 s35, s35, s34
  s_add_u32 s21, s35, 37748736
  s_add_u32 s22, s35, 88080384
  s_mul_i32 s35, s16, 6144
  s_add_u32 s35, s35, s34
  s_add_u32 s23, s35, 62914560
  ds_read_b128 v[72:75], v7 offset:0
  ds_read_b128 v[76:79], v7 offset:20480
  ds_read_b128 v[80:83], v7 offset:1024
  ds_read_b128 v[84:87], v7 offset:21504
  ds_read_b128 v[88:91], v7 offset:2048
  ds_read_b128 v[92:95], v7 offset:22528
  s_waitcnt lgkmcnt(4)
  v_mfma_f32_16x16x32_bf16 v[32:35], a[0:3], v[72:75], 0
  v_mfma_f32_16x16x32_bf16 v[36:39], a[0:3], v[76:79], 0
  v_mfma_f32_16x16x32_bf16 v[40:43], a[80:83], v[72:75], 0
  v_mfma_f32_16x16x32_bf16 v[44:47], a[80:83], v[76:79], 0
  v_mfma_f32_16x16x32_bf16 v[48:51], a[160:163], v[72:75], 0
  v_mfma_f32_16x16x32_bf16 v[52:55], a[160:163], v[76:79], 0
  v_mfma_f32_16x16x32_bf16 v[56:59], v[96:99], v[72:75], 0
  v_mfma_f32_16x16x32_bf16 v[60:63], v[96:99], v[76:79], 0
  ds_read_b128 v[72:75], v7 offset:3072
  ds_read_b128 v[76:79], v7 offset:23552
  s_waitcnt lgkmcnt(4)
  v_mfma_f32_16x16x32_bf16 v[32:35], a[4:7], v[80:83], v[32:35]
  v_mfma_f32_16x16x32_bf16 v[36:39], a[4:7], v[84:87], v[36:39]
  v_mfma_f32_16x16x32_bf16 v[40:43], a[84:87], v[80:83], v[40:43]
  v_mfma_f32_16x16x32_bf16 v[44:47], a[84:87], v[84:87], v[44:47]
  v_mfma_f32_16x16x32_bf16 v[48:51], a[164:167], v[80:83], v[48:51]
  v_mfma_f32_16x16x32_bf16 v[52:55], a[164:167], v[84:87], v[52:55]
  v_mfma_f32_16x16x32_bf16 v[56:59], v[100:103], v[80:83], v[56:59]
  v_mfma_f32_16x16x32_bf16 v[60:63], v[100:103], v[84:87], v[60:63]
  ds_read_b128 v[80:83], v7 offset:4096
  ds_read_b128 v[84:87], v7 offset:24576
  s_waitcnt lgkmcnt(4)
  v_mfma_f32_16x16x32_bf16 v[32:35], a[8:11], v[88:91], v[32:35]
  v_mfma_f32_16x16x32_bf16 v[36:39], a[8:11], v[92:95], v[36:39]
  v_mfma_f32_16x16x32_bf16 v[40:43], a[88:91], v[88:91], v[40:43]
  v_mfma_f32_16x16x32_bf16 v[44:47], a[88:91], v[92:95], v[44:47]
  v_mfma_f32_16x16x32_bf16 v[48:51], a[168:171], v[88:91], v[48:51]
  v_mfma_f32_16x16x32_bf16 v[52:55], a[168:171], v[92:95], v[52:55]
  v_mfma_f32_16x16x32_bf16 v[56:59], v[104:107], v[88:91], v[56:59]
  v_mfma_f32_16x16x32_bf16 v[60:63], v[104:107], v[92:95], v[60:63]
  ds_read_b128 v[88:91], v7 offset:5120
  ds_read_b128 v[92:95], v7 offset:25600
  s_waitcnt lgkmcnt(4)
  v_mfma_f32_16x16x32_bf16 v[32:35], a[12:15], v[72:75], v[32:35]
  v_mfma_f32_16x16x32_bf16 v[36:39], a[12:15], v[76:79], v[36:39]
  v_mfma_f32_16x16x32_bf16 v[40:43], a[92:95], v[72:75], v[40:43]
  v_mfma_f32_16x16x32_bf16 v[44:47], a[92:95], v[76:79], v[44:47]
  v_mfma_f32_16x16x32_bf16 v[48:51], a[172:175], v[72:75], v[48:51]
  v_mfma_f32_16x16x32_bf16 v[52:55], a[172:175], v[76:79], v[52:55]
  v_mfma_f32_16x16x32_bf16 v[56:59], v[108:111], v[72:75], v[56:59]
  v_mfma_f32_16x16x32_bf16 v[60:63], v[108:111], v[76:79], v[60:63]
  ds_read_b128 v[72:75], v7 offset:6144
  ds_read_b128 v[76:79], v7 offset:26624
  s_waitcnt lgkmcnt(4)
  v_mfma_f32_16x16x32_bf16 v[32:35], a[16:19], v[80:83], v[32:35]
  v_mfma_f32_16x16x32_bf16 v[36:39], a[16:19], v[84:87], v[36:39]
  v_mfma_f32_16x16x32_bf16 v[40:43], a[96:99], v[80:83], v[40:43]
  v_mfma_f32_16x16x32_bf16 v[44:47], a[96:99], v[84:87], v[44:47]
  v_mfma_f32_16x16x32_bf16 v[48:51], a[176:179], v[80:83], v[48:51]
  v_mfma_f32_16x16x32_bf16 v[52:55], a[176:179], v[84:87], v[52:55]
  v_mfma_f32_16x16x32_bf16 v[56:59], v[112:115], v[80:83], v[56:59]
  v_mfma_f32_16x16x32_bf16 v[60:63], v[112:115], v[84:87], v[60:63]
  ds_read_b128 v[80:83], v7 offset:7168
  ds_read_b128 v[84:87], v7 offset:27648
  s_waitcnt lgkmcnt(4)
  v_mfma_f32_16x16x32_bf16 v[32:35], a[20:23], v[88:91], v[32:35]
  v_mfma_f32_16x16x32_bf16 v[36:39], a[20:23], v[92:95], v[36:39]
  v_mfma_f32_16x16x32_bf16 v[40:43], a[100:103], v[88:91], v[40:43]
  v_mfma_f32_16x16x32_bf16 v[44:47], a[100:103], v[92:95], v[44:47]
  v_mfma_f32_16x16x32_bf16 v[48:51], a[180:183], v[88:91], v[48:51]
  v_mfma_f32_16x16x32_bf16 v[52:55], a[180:183], v[92:95], v[52:55]
  v_mfma_f32_16x16x32_bf16 v[56:59], v[116:119], v[88:91], v[56:59]
  v_mfma_f32_16x16x32_bf16 v[60:63], v[116:119], v[92:95], v[60:63]
  ds_read_b128 v[88:91], v7 offset:8192
  ds_read_b128 v[92:95], v7 offset:28672
  s_waitcnt lgkmcnt(4)
  v_mfma_f32_16x16x32_bf16 v[32:35], a[24:27], v[72:75], v[32:35]
  v_mfma_f32_16x16x32_bf16 v[36:39], a[24:27], v[76:79], v[36:39]
  v_mfma_f32_16x16x32_bf16 v[40:43], a[104:107], v[72:75], v[40:43]
  v_mfma_f32_16x16x32_bf16 v[44:47], a[104:107], v[76:79], v[44:47]
  v_mfma_f32_16x16x32_bf16 v[48:51], a[184:187], v[72:75], v[48:51]
  v_mfma_f32_16x16x32_bf16 v[52:55], a[184:187], v[76:79], v[52:55]
  v_mfma_f32_16x16x32_bf16 v[56:59], v[120:123], v[72:75], v[56:59]
  v_mfma_f32_16x16x32_bf16 v[60:63], v[120:123], v[76:79], v[60:63]
  ds_read_b128 v[72:75], v7 offset:9216
  ds_read_b128 v[76:79], v7 offset:29696
  s_waitcnt lgkmcnt(4)
  v_mfma_f32_16x16x32_bf16 v[32:35], a[28:31], v[80:83], v[32:35]
  v_mfma_f32_16x16x32_bf16 v[36:39], a[28:31], v[84:87], v[36:39]
  v_mfma_f32_16x16x32_bf16 v[40:43], a[108:111], v[80:83], v[40:43]
  v_mfma_f32_16x16x32_bf16 v[44:47], a[108:111], v[84:87], v[44:47]
  v_mfma_f32_16x16x32_bf16 v[48:51], a[188:191], v[80:83], v[48:51]
  v_mfma_f32_16x16x32_bf16 v[52:55], a[188:191], v[84:87], v[52:55]
  v_mfma_f32_16x16x32_bf16 v[56:59], v[124:127], v[80:83], v[56:59]
  v_mfma_f32_16x16x32_bf16 v[60:63], v[124:127], v[84:87], v[60:63]
  ds_read_b128 v[80:83], v7 offset:10240
  ds_read_b128 v[84:87], v7 offset:30720
  s_waitcnt lgkmcnt(4)
  v_mfma_f32_16x16x32_bf16 v[32:35], a[32:35], v[88:91], v[32:35]
  v_mfma_f32_16x16x32_bf16 v[36:39], a[32:35], v[92:95], v[36:39]
  v_mfma_f32_16x16x32_bf16 v[40:43], a[112:115], v[88:91], v[40:43]
  v_mfma_f32_16x16x32_bf16 v[44:47], a[112:115], v[92:95], v[44:47]
  v_mfma_f32_16x16x32_bf16 v[48:51], a[192:195], v[88:91], v[48:51]
  v_mfma_f32_16x16x32_bf16 v[52:55], a[192:195], v[92:95], v[52:55]
  v_mfma_f32_16x16x32_bf16 v[56:59], v[128:131], v[88:91], v[56:59]
  v_mfma_f32_16x16x32_bf16 v[60:63], v[128:131], v[92:95], v[60:63]
  ds_read_b128 v[88:91], v7 offset:11264
  ds_read_b128 v[92:95], v7 offset:31744
  s_waitcnt lgkmcnt(4)
  v_mfma_f32_16x16x32_bf16 v[32:35], a[36:39], v[72:75], v[32:35]
  v_mfma_f32_16x16x32_bf16 v[36:39], a[36:39], v[76:79], v[36:39]
  v_mfma_f32_16x16x32_bf16 v[40:43], a[116:119], v[72:75], v[40:43]
  v_mfma_f32_16x16x32_bf16 v[44:47], a[116:119], v[76:79], v[44:47]
  v_mfma_f32_16x16x32_bf16 v[48:51], a[196:199], v[72:75], v[48:51]
  v_mfma_f32_16x16x32_bf16 v[52:55], a[196:199], v[76:79], v[52:55]
  v_mfma_f32_16x16x32_bf16 v[56:59], v[132:135], v[72:75], v[56:59]
  v_mfma_f32_16x16x32_bf16 v[60:63], v[132:135], v[76:79], v[60:63]
  ds_read_b128 v[72:75], v7 offset:12288
  ds_read_b128 v[76:79], v7 offset:32768
  s_waitcnt lgkmcnt(4)
  v_mfma_f32_16x16x32_bf16 v[32:35], a[40:43], v[80:83], v[32:35]
  v_mfma_f32_16x16x32_bf16 v[36:39], a[40:43], v[84:87], v[36:39]
  v_mfma_f32_16x16x32_bf16 v[40:43], a[120:123], v[80:83], v[40:43]
  v_mfma_f32_16x16x32_bf16 v[44:47], a[120:123], v[84:87], v[44:47]
  v_mfma_f32_16x16x32_bf16 v[48:51], a[200:203], v[80:83], v[48:51]
  v_mfma_f32_16x16x32_bf16 v[52:55], a[200:203], v[84:87], v[52:55]
  v_mfma_f32_16x16x32_bf16 v[56:59], v[136:139], v[80:83], v[56:59]
  v_mfma_f32_16x16x32_bf16 v[60:63], v[136:139], v[84:87], v[60:63]
  ds_read_b128 v[80:83], v7 offset:13312
  ds_read_b128 v[84:87], v7 offset:33792
  s_waitcnt lgkmcnt(4)
  v_mfma_f32_16x16x32_bf16 v[32:35], a[44:47], v[88:91], v[32:35]
  v_mfma_f32_16x16x32_bf16 v[36:39], a[44:47], v[92:95], v[36:39]
  v_mfma_f32_16x16x32_bf16 v[40:43], a[124:127], v[88:91], v[40:43]
  v_mfma_f32_16x16x32_bf16 v[44:47], a[124:127], v[92:95], v[44:47]
  v_mfma_f32_16x16x32_bf16 v[48:51], a[204:207], v[88:91], v[48:51]
  v_mfma_f32_16x16x32_bf16 v[52:55], a[204:207], v[92:95], v[52:55]
  v_mfma_f32_16x16x32_bf16 v[56:59], v[140:143], v[88:91], v[56:59]
  v_mfma_f32_16x16x32_bf16 v[60:63], v[140:143], v[92:95], v[60:63]
  ds_read_b128 v[88:91], v7 offset:14336
  ds_read_b128 v[92:95], v7 offset:34816
  s_waitcnt lgkmcnt(4)
  v_mfma_f32_16x16x32_bf16 v[32:35], a[48:51], v[72:75], v[32:35]
  v_mfma_f32_16x16x32_bf16 v[36:39], a[48:51], v[76:79], v[36:39]
  v_mfma_f32_16x16x32_bf16 v[40:43], a[128:131], v[72:75], v[40:43]
  v_mfma_f32_16x16x32_bf16 v[44:47], a[128:131], v[76:79], v[44:47]
  v_mfma_f32_16x16x32_bf16 v[48:51], a[208:211], v[72:75], v[48:51]
  v_mfma_f32_16x16x32_bf16 v[52:55], a[208:211], v[76:79], v[52:55]
  v_mfma_f32_16x16x32_bf16 v[56:59], v[144:147], v[72:75], v[56:59]
  v_mfma_f32_16x16x32_bf16 v[60:63], v[144:147], v[76:79], v[60:63]
  ds_read_b128 v[72:75], v7 offset:15360
  ds_read_b128 v[76:79], v7 offset:35840
  s_waitcnt lgkmcnt(4)
  v_mfma_f32_16x16x32_bf16 v[32:35], a[52:55], v[80:83], v[32:35]
  v_mfma_f32_16x16x32_bf16 v[36:39], a[52:55], v[84:87], v[36:39]
  v_mfma_f32_16x16x32_bf16 v[40:43], a[132:135], v[80:83], v[40:43]
  v_mfma_f32_16x16x32_bf16 v[44:47], a[132:135], v[84:87], v[44:47]
  v_mfma_f32_16x16x32_bf16 v[48:51], a[212:215], v[80:83], v[48:51]
  v_mfma_f32_16x16x32_bf16 v[52:55], a[212:215], v[84:87], v[52:55]
  v_mfma_f32_16x16x32_bf16 v[56:59], v[148:151], v[80:83], v[56:59]
  v_mfma_f32_16x16x32_bf16 v[60:63], v[148:151], v[84:87], v[60:63]
  ds_read_b128 v[80:83], v7 offset:16384
  ds_read_b128 v[84:87], v7 offset:36864
  s_waitcnt lgkmcnt(4)
  v_mfma_f32_16x16x32_bf16 v[32:35], a[56:59], v[88:91], v[32:35]
  v_mfma_f32_16x16x32_bf16 v[36:39], a[56:59], v[92:95], v[36:39]
  v_mfma_f32_16x16x32_bf16 v[40:43], a[136:139], v[88:91], v[40:43]
  v_mfma_f32_16x16x32_bf16 v[44:47], a[136:139], v[92:95], v[44:47]
  v_mfma_f32_16x16x32_bf16 v[48:51], a[216:219], v[88:91], v[48:51]
  v_mfma_f32_16x16x32_bf16 v[52:55], a[216:219], v[92:95], v[52:55]
  v_mfma_f32_16x16x32_bf16 v[56:59], v[152:155], v[88:91], v[56:59]
  v_mfma_f32_16x16x32_bf16 v[60:63], v[152:155], v[92:95], v[60:63]
  ds_read_b128 v[88:91], v7 offset:17408
  ds_read_b128 v[92:95], v7 offset:37888
  s_waitcnt lgkmcnt(4)
  v_mfma_f32_16x16x32_bf16 v[32:35], a[60:63], v[72:75], v[32:35]
  v_mfma_f32_16x16x32_bf16 v[36:39], a[60:63], v[76:79], v[36:39]
  v_mfma_f32_16x16x32_bf16 v[40:43], a[140:143], v[72:75], v[40:43]
  v_mfma_f32_16x16x32_bf16 v[44:47], a[140:143], v[76:79], v[44:47]
  v_mfma_f32_16x16x32_bf16 v[48:51], a[220:223], v[72:75], v[48:51]
  v_mfma_f32_16x16x32_bf16 v[52:55], a[220:223], v[76:79], v[52:55]
  v_mfma_f32_16x16x32_bf16 v[56:59], v[156:159], v[72:75], v[56:59]
  v_mfma_f32_16x16x32_bf16 v[60:63], v[156:159], v[76:79], v[60:63]
  ds_read_b128 v[72:75], v7 offset:18432
  ds_read_b128 v[76:79], v7 offset:38912
  s_waitcnt lgkmcnt(4)
  v_mfma_f32_16x16x32_bf16 v[32:35], a[64:67], v[80:83], v[32:35]
  v_mfma_f32_16x16x32_bf16 v[36:39], a[64:67], v[84:87], v[36:39]
  v_mfma_f32_16x16x32_bf16 v[40:43], a[144:147], v[80:83], v[40:43]
  v_mfma_f32_16x16x32_bf16 v[44:47], a[144:147], v[84:87], v[44:47]
  v_mfma_f32_16x16x32_bf16 v[48:51], a[224:227], v[80:83], v[48:51]
  v_mfma_f32_16x16x32_bf16 v[52:55], a[224:227], v[84:87], v[52:55]
  v_mfma_f32_16x16x32_bf16 v[56:59], v[160:163], v[80:83], v[56:59]
  v_mfma_f32_16x16x32_bf16 v[60:63], v[160:163], v[84:87], v[60:63]
  ds_read_b128 v[80:83], v7 offset:19456
  ds_read_b128 v[84:87], v7 offset:39936
  s_waitcnt lgkmcnt(4)
  v_mfma_f32_16x16x32_bf16 v[32:35], a[68:71], v[88:91], v[32:35]
  v_mfma_f32_16x16x32_bf16 v[36:39], a[68:71], v[92:95], v[36:39]
  v_mfma_f32_16x16x32_bf16 v[40:43], a[148:151], v[88:91], v[40:43]
  v_mfma_f32_16x16x32_bf16 v[44:47], a[148:151], v[92:95], v[44:47]
  v_mfma_f32_16x16x32_bf16 v[48:51], a[228:231], v[88:91], v[48:51]
  v_mfma_f32_16x16x32_bf16 v[52:55], a[228:231], v[92:95], v[52:55]
  v_mfma_f32_16x16x32_bf16 v[56:59], v[164:167], v[88:91], v[56:59]
  v_mfma_f32_16x16x32_bf16 v[60:63], v[164:167], v[92:95], v[60:63]
  s_waitcnt lgkmcnt(2)
  v_mfma_f32_16x16x32_bf16 v[32:35], a[72:75], v[72:75], v[32:35]
  v_mfma_f32_16x16x32_bf16 v[36:39], a[72:75], v[76:79], v[36:39]
  v_mfma_f32_16x16x32_bf16 v[40:43], a[152:155], v[72:75], v[40:43]
  v_mfma_f32_16x16x32_bf16 v[44:47], a[152:155], v[76:79], v[44:47]
  v_mfma_f32_16x16x32_bf16 v[48:51], a[232:235], v[72:75], v[48:51]
  v_mfma_f32_16x16x32_bf16 v[52:55], a[232:235], v[76:79], v[52:55]
  v_mfma_f32_16x16x32_bf16 v[56:59], v[168:171], v[72:75], v[56:59]
  v_mfma_f32_16x16x32_bf16 v[60:63], v[168:171], v[76:79], v[60:63]
  s_waitcnt lgkmcnt(0)
  v_mfma_f32_16x16x32_bf16 v[32:35], a[76:79], v[80:83], v[32:35]
  v_mfma_f32_16x16x32_bf16 v[36:39], a[76:79], v[84:87], v[36:39]
  v_mfma_f32_16x16x32_bf16 v[40:43], a[156:159], v[80:83], v[40:43]
  v_mfma_f32_16x16x32_bf16 v[44:47], a[156:159], v[84:87], v[44:47]
  v_mfma_f32_16x16x32_bf16 v[48:51], a[236:239], v[80:83], v[48:51]
  v_mfma_f32_16x16x32_bf16 v[52:55], a[236:239], v[84:87], v[52:55]
  v_mfma_f32_16x16x32_bf16 v[56:59], v[172:175], v[80:83], v[56:59]
  v_mfma_f32_16x16x32_bf16 v[60:63], v[172:175], v[84:87], v[60:63]
  s_nop 0
  v_cvt_pk_bf16_f32 v8, v32, v33
  v_cvt_pk_bf16_f32 v9, v34, v35
  v_cvt_pk_bf16_f32 v10, v40, v41
  v_cvt_pk_bf16_f32 v11, v42, v43
  s_add_u32 s34, s22, 1024
  buffer_store_dwordx4 v[8:11], v1, s[4:7], s34 offen
  v_cvt_pk_bf16_f32 v12, v36, v37
  v_cvt_pk_bf16_f32 v13, v38, v39
  v_cvt_pk_bf16_f32 v14, v44, v45
  v_cvt_pk_bf16_f32 v15, v46, v47
  s_add_u32 s34, s22, 7168
  buffer_store_dwordx4 v[12:15], v1, s[4:7], s34 offen
  v_cvt_pk_bf16_f32 v8, v48, v49
  v_cvt_pk_bf16_f32 v9, v50, v51
  v_cvt_pk_bf16_f32 v10, v56, v57
  v_cvt_pk_bf16_f32 v11, v58, v59
  s_add_u32 s34, s22, 2048
  buffer_store_dwordx4 v[8:11], v1, s[4:7], s34 offen
  v_cvt_pk_bf16_f32 v12, v52, v53
  v_cvt_pk_bf16_f32 v13, v54, v55
  v_cvt_pk_bf16_f32 v14, v60, v61
  v_cvt_pk_bf16_f32 v15, v62, v63
  s_add_u32 s34, s22, 8192
  buffer_store_dwordx4 v[12:15], v1, s[4:7], s34 offen
  s_waitcnt vmcnt(0)
  s_barrier
  s_add_u32 s17, s17, 1
  s_cmp_lt_u32 s17, 64
  s_cbranch_scc1 reca_ptop212
  s_branch reca_exit1
reca_exit1:
reca_exitb3:
  s_endpgm
.globl attna_kernel
.p2align 8
.type attna_kernel,@function
attna_kernel:
  s_cmp_ge_u32 s2, 512
  s_cbranch_scc1 attna_exit1
  s_load_dwordx2 s[8:9], s[0:1], 96
  v_lshrrev_b32 v6, 6, v0
  v_and_b32 v7, 63, v0
  s_nop 0
  v_readfirstlane_b32 s12, v6
  v_lshlrev_b32 v1, 4, v7
  v_add_u32 v2, 0x1000, v1
  v_add_u32 v3, 0x2000, v1
  s_and_b32 s13, s2, 7
  s_lshr_b32 s14, s2, 3
  s_and_b32 s15, s14, 3
  s_lshl_b32 s13, s13, 2
  s_add_u32 s15, s15, s13
  s_lshr_b32 s14, s14, 2
  s_lshl_b32 s14, s14, 2
  s_add_u32 s14, s14, s12
  s_waitcnt lgkmcnt(0)
  s_mov_b32 s4, s8
  s_mov_b32 s5, s9
  s_mov_b32 s6, 0x10000000
  s_mov_b32 s7, 0x20000
  s_lshl_b32 s16, s15, 6
  s_add_u32 s16, s16, s14
  s_mul_i32 s16, s16, 12288
  s_add_u32 s20, s16, 88080384
  s_add_u32 s21, s16, 37748736
  s_add_u32 s22, s16, 62914560
  s_lshl_b32 s17, s14, 5
  s_add_u32 s17, s17, s15
  s_mul_i32 s17, s17, 3072
  s_add_u32 s23, s17, 113246208
  s_add_u32 s24, s17, 119537664
  s_lshl_b32 s17, s14, 1
  s_mul_i32 s17, s17, 196608
  s_mul_i32 s18, s15, 6144
  s_add_u32 s17, s17, s18
  s_add_u32 s25, s17, 125829120
  s_add_u32 s26, s25, 196608
  s_mov_b32 s27, 0x3dd53b95
  v_and_b32 v6, 15, v7
  v_lshrrev_b32 v8, 4, v7
  v_mov_b32 v9, 0x80000000
  v_lshlrev_b32 v10, 4, v6
  v_lshl_add_u32 v10, v8, 7, v10
  v_cmp_gt_u32 vcc, 8, v6
  s_nop 1
  v_cndmask_b32 v4, v9, v10, vcc
  v_lshlrev_b32 v10, 3, v7
  v_cmp_gt_u32 vcc, 32, v7
  s_nop 1
  v_cndmask_b32 v5, v9, v10, vcc
  buffer_load_dwordx4 v[136:139], v1, s[4:7], s21 offen offset:0
  buffer_load_dwordx4 v[140:143], v1, s[4:7], s21 offen offset:1024
  buffer_load_dwordx4 v[144:147], v1, s[4:7], s21 offen offset:2048
  buffer_load_dwordx4 v[148:151], v1, s[4:7], s21 offen offset:3072
  buffer_load_dwordx4 v[152:155], v2, s[4:7], s21 offen offset:0
  buffer_load_dwordx4 v[156:159], v2, s[4:7], s21 offen offset:1024
  buffer_load_dwordx4 v[160:163], v2, s[4:7], s21 offen offset:2048
  buffer_load_dwordx4 v[164:167], v2, s[4:7], s21 offen offset:3072
  buffer_load_dwordx4 v[168:171], v3, s[4:7], s21 offen offset:0
  buffer_load_dwordx4 v[172:175], v3, s[4:7], s21 offen offset:1024
  buffer_load_dwordx4 v[176:179], v3, s[4:7], s21 offen offset:2048
  buffer_load_dwordx4 v[180:183], v3, s[4:7], s21 offen offset:3072
  buffer_load_dwordx4 v[184:187], v4, s[4:7], s23 offen offset:0
  buffer_load_dwordx4 v[188:191], v4, s[4:7], s23 offen offset:512
  buffer_load_dwordx4 v[192:195], v4, s[4:7], s23 offen offset:1024
  buffer_load_dwordx4 v[196:199], v4, s[4:7], s23 offen offset:1536
  buffer_load_dwordx4 v[200:203], v4, s[4:7], s23 offen offset:2048
  buffer_load_dwordx4 v[204:207], v4, s[4:7], s23 offen offset:2560
  buffer_load_dwordx4 v[88:91], v1, s[4:7], s20 offen offset:0
  buffer_load_dwordx4 v[92:95], v1, s[4:7], s20 offen offset:1024
  buffer_load_dwordx4 v[96:99], v1, s[4:7], s20 offen offset:2048
  buffer_load_dwordx4 v[100:103], v1, s[4:7], s20 offen offset:3072
  buffer_load_dwordx4 v[104:107], v2, s[4:7], s20 offen offset:0
  buffer_load_dwordx4 v[108:111], v2, s[4:7], s20 offen offset:1024
  buffer_load_dwordx4 v[112:115], v2, s[4:7], s20 offen offset:2048
  buffer_load_dwordx4 v[116:119], v2, s[4:7], s20 offen offset:3072
  buffer_load_dwordx4 v[120:123], v3, s[4:7], s20 offen offset:0
  buffer_load_dwordx4 v[124:127], v3, s[4:7], s20 offen offset:1024
  buffer_load_dwordx4 v[128:131], v3, s[4:7], s20 offen offset:2048
  buffer_load_dwordx4 v[132:135], v3, s[4:7], s20 offen offset:3072
  v_mov_b32 v10, 0xf149f2ca
  v_cmp_le_u32 vcc, 2, v8
  s_nop 1
  v_cndmask_b32 v12, 0, v10, vcc
  v_mov_b32 v13, v12
  v_mov_b32 v14, v12
  v_mov_b32 v15, v12
  v_lshlrev_b32 v11, 2, v8
  v_add_u32 v7, 0, v11
  v_cmp_gt_u32 vcc, v7, v6
  s_nop 1
  v_cndmask_b32 v16, 0, v10, vcc
  v_add_u32 v7, 1, v11
  v_cmp_gt_u32 vcc, v7, v6
  s_nop 1
  v_cndmask_b32 v17, 0, v10, vcc
  v_add_u32 v7, 2, v11
  v_cmp_gt_u32 vcc, v7, v6
  s_nop 1
  v_cndmask_b32 v18, 0, v10, vcc
  v_add_u32 v7, 3, v11
  v_cmp_gt_u32 vcc, v7, v6
  s_nop 1
  v_cndmask_b32 v19, 0, v10, vcc
  v_mov_b32 v20, 0x3f803f80
  v_mov_b32 v21, 0x3f803f80
  v_mov_b32 v22, 0x3f803f80
  v_mov_b32 v23, 0x3f803f80
  s_waitcnt vmcnt(0)
  v_mfma_f32_16x16x32_bf16 v[24:27], v[184:187], v[88:91], v[12:15]
  v_mfma_f32_16x16x32_bf16 v[28:31], v[136:139], v[88:91], v[16:19]
  v_mfma_f32_16x16x32_bf16 v[32:35], v[184:187], v[112:115], v[12:15]
  v_mfma_f32_16x16x32_bf16 v[36:39], v[136:139], v[112:115], 0
  v_mfma_f32_16x16x32_bf16 v[40:43], v[160:163], v[112:115], v[16:19]
  v_mfma_f32_16x16x32_bf16 v[24:27], v[188:191], v[92:95], v[24:27]
  v_mfma_f32_16x16x32_bf16 v[28:31], v[140:143], v[92:95], v[28:31]
  v_mfma_f32_16x16x32_bf16 v[32:35], v[188:191], v[116:119], v[32:35]
  v_mfma_f32_16x16x32_bf16 v[36:39], v[140:143], v[116:119], v[36:39]
  v_mfma_f32_16x16x32_bf16 v[40:43], v[164:167], v[116:119], v[40:43]
  v_mfma_f32_16x16x32_bf16 v[24:27], v[192:195], v[96:99], v[24:27]
  v_mfma_f32_16x16x32_bf16 v[28:31], v[144:147], v[96:99], v[28:31]
  v_mfma_f32_16x16x32_bf16 v[32:35], v[192:195], v[120:123], v[32:35]
  v_mfma_f32_16x16x32_bf16 v[36:39], v[144:147], v[120:123], v[36:39]
  v_mfma_f32_16x16x32_bf16 v[40:43], v[168:171], v[120:123], v[40:43]
  v_mfma_f32_16x16x32_bf16 v[24:27], v[196:199], v[100:103], v[24:27]
  v_mfma_f32_16x16x32_bf16 v[28:31], v[148:151], v[100:103], v[28:31]
  v_mfma_f32_16x16x32_bf16 v[32:35], v[196:199], v[124:127], v[32:35]
  v_mfma_f32_16x16x32_bf16 v[36:39], v[148:151], v[124:127], v[36:39]
  v_mfma_f32_16x16x32_bf16 v[40:43], v[172:175], v[124:127], v[40:43]
  v_mfma_f32_16x16x32_bf16 v[24:27], v[200:203], v[104:107], v[24:27]
  v_mfma_f32_16x16x32_bf16 v[28:31], v[152:155], v[104:107], v[28:31]
  v_mfma_f32_16x16x32_bf16 v[32:35], v[200:203], v[128:131], v[32:35]
  v_mfma_f32_16x16x32_bf16 v[36:39], v[152:155], v[128:131], v[36:39]
  v_mfma_f32_16x16x32_bf16 v[40:43], v[176:179], v[128:131], v[40:43]
  v_mfma_f32_16x16x32_bf16 v[24:27], v[204:207], v[108:111], v[24:27]
  v_mfma_f32_16x16x32_bf16 v[28:31], v[156:159], v[108:111], v[28:31]
  v_mfma_f32_16x16x32_bf16 v[32:35], v[204:207], v[132:135], v[32:35]
  v_mfma_f32_16x16x32_bf16 v[36:39], v[156:159], v[132:135], v[36:39]
  v_mfma_f32_16x16x32_bf16 v[40:43], v[180:183], v[132:135], v[40:43]
  s_nop 7
  buffer_load_dwordx4 v[88:91], v1, s[4:7], s22 offen offset:0
  buffer_load_dwordx4 v[92:95], v1, s[4:7], s22 offen offset:1024
  buffer_load_dwordx4 v[96:99], v1, s[4:7], s22 offen offset:2048
  buffer_load_dwordx4 v[100:103], v1, s[4:7], s22 offen offset:3072
  buffer_load_dwordx4 v[104:107], v2, s[4:7], s22 offen offset:0
  buffer_load_dwordx4 v[108:111], v2, s[4:7], s22 offen offset:1024
  buffer_load_dwordx4 v[112:115], v2, s[4:7], s22 offen offset:2048
  buffer_load_dwordx4 v[116:119], v2, s[4:7], s22 offen offset:3072
  buffer_load_dwordx4 v[120:123], v3, s[4:7], s22 offen offset:0
  buffer_load_dwordx4 v[124:127], v3, s[4:7], s22 offen offset:1024
  buffer_load_dwordx4 v[128:131], v3, s[4:7], s22 offen offset:2048
  buffer_load_dwordx4 v[132:135], v3, s[4:7], s22 offen offset:3072
  buffer_load_dwordx2 v[136:137], v5, s[4:7], s24 offen offset:0
  buffer_load_dwordx2 v[138:139], v5, s[4:7], s24 offen offset:256
  buffer_load_dwordx2 v[140:141], v5, s[4:7], s24 offen offset:512
  buffer_load_dwordx2 v[142:143], v5, s[4:7], s24 offen offset:768
  buffer_load_dwordx2 v[144:145], v5, s[4:7], s24 offen offset:1024
  buffer_load_dwordx2 v[146:147], v5, s[4:7], s24 offen offset:1280
  buffer_load_dwordx2 v[148:149], v5, s[4:7], s24 offen offset:1536
  buffer_load_dwordx2 v[150:151], v5, s[4:7], s24 offen offset:1792
  buffer_load_dwordx2 v[152:153], v5, s[4:7], s24 offen offset:2048
  buffer_load_dwordx2 v[154:155], v5, s[4:7], s24 offen offset:2304
  buffer_load_dwordx2 v[156:157], v5, s[4:7], s24 offen offset:2560
  buffer_load_dwordx2 v[158:159], v5, s[4:7], s24 offen offset:2816
  v_max3_f32 v6, v24, v25, v26
  v_max3_f32 v6, v6, v27, v28
  v_max3_f32 v6, v6, v29, v30
  v_max_f32 v6, v6, v31
  v_mov_b32 v7, v6
  s_nop 1
  v_permlane32_swap_b32 v6, v7
  v_max_f32 v6, v6, v7
  v_mov_b32 v7, v6
  s_nop 1
  v_permlane16_swap_b32 v6, v7
  v_max_f32 v6, v6, v7
  v_mul_f32 v6, s27, v6
  v_fma_f32 v24, v24, s27, -v6
  v_fma_f32 v25, v25, s27, -v6
  v_fma_f32 v26, v26, s27, -v6
  v_fma_f32 v27, v27, s27, -v6
  v_fma_f32 v28, v28, s27, -v6
  v_fma_f32 v29, v29, s27, -v6
  v_fma_f32 v30, v30, s27, -v6
  v_fma_f32 v31, v31, s27, -v6
  v_exp_f32 v24, v24
  v_exp_f32 v25, v25
  v_exp_f32 v26, v26
  v_exp_f32 v27, v27
  v_exp_f32 v28, v28
  v_exp_f32 v29, v29
  v_exp_f32 v30, v30
  v_exp_f32 v31, v31
  v_max3_f32 v8, v32, v33, v34
  v_max3_f32 v8, v8, v35, v36
  v_max3_f32 v8, v8, v37, v38
  v_max3_f32 v8, v8, v39, v40
  v_max3_f32 v8, v8, v41, v42
  v_max_f32 v8, v8, v43
  v_mov_b32 v10, v8
  s_nop 1
  v_permlane32_swap_b32 v8, v10
  v_max_f32 v8, v8, v10
  v_mov_b32 v10, v8
  s_nop 1
  v_permlane16_swap_b32 v8, v10
  v_max_f32 v8, v8, v10
  v_mul_f32 v8, s27, v8
  v_fma_f32 v32, v32, s27, -v8
  v_fma_f32 v33, v33, s27, -v8
  v_fma_f32 v34, v34, s27, -v8
  v_fma_f32 v35, v35, s27, -v8
  v_fma_f32 v36, v36, s27, -v8
  v_fma_f32 v37, v37, s27, -v8
  v_fma_f32 v38, v38, s27, -v8
  v_fma_f32 v39, v39, s27, -v8
  v_fma_f32 v40, v40, s27, -v8
  v_fma_f32 v41, v41, s27, -v8
  v_fma_f32 v42, v42, s27, -v8
  v_fma_f32 v43, v43, s27, -v8
  v_exp_f32 v32, v32
  v_exp_f32 v33, v33
  v_exp_f32 v34, v34
  v_exp_f32 v35, v35
  v_exp_f32 v36, v36
  v_exp_f32 v37, v37
  v_exp_f32 v38, v38
  v_exp_f32 v39, v39
  v_exp_f32 v40, v40
  v_exp_f32 v41, v41
  v_exp_f32 v42, v42
  v_exp_f32 v43, v43
  v_cvt_pk_bf16_f32 v44, v24, v25
  v_cvt_pk_bf16_f32 v45, v26, v27
  v_cvt_pk_bf16_f32 v46, v28, v29
  v_cvt_pk_bf16_f32 v47, v30, v31
  v_cvt_pk_bf16_f32 v48, v32, v33
  v_cvt_pk_bf16_f32 v49, v34, v35
  v_cvt_pk_bf16_f32 v50, v36, v37
  v_cvt_pk_bf16_f32 v51, v38, v39
  v_cvt_pk_bf16_f32 v52, v40, v41
  v_cvt_pk_bf16_f32 v53, v42, v43
  v_mfma_f32_16x16x16_bf16 v[56:59], v[20:21], v[44:45], 0
  v_mfma_f32_16x16x16_bf16 v[60:63], v[20:21], v[48:49], 0
  v_mfma_f32_16x16x16_bf16 v[56:59], v[20:21], v[46:47], v[56:59]
  v_mfma_f32_16x16x32_bf16 v[60:63], v[20:23], v[50:53], v[60:63]
  s_nop 6
  v_rcp_f32 v10, v56
  v_rcp_f32 v11, v60
  s_waitcnt vmcnt(0)
  v_mfma_f32_16x16x16_bf16 v[64:67], v[136:137], v[44:45], 0
  v_mfma_f32_16x16x16_bf16 v[68:71], v[136:137], v[48:49], 0
  v_mfma_f32_16x16x16_bf16 v[64:67], v[88:89], v[46:47], v[64:67]
  v_mfma_f32_16x16x32_bf16 v[68:71], v[88:91], v[50:53], v[68:71]
  v_mfma_f32_16x16x16_bf16 v[72:75], v[138:139], v[44:45], 0
  v_mfma_f32_16x16x16_bf16 v[76:79], v[138:139], v[48:49], 0
  v_mfma_f32_16x16x16_bf16 v[72:75], v[92:93], v[46:47], v[72:75]
  v_mfma_f32_16x16x32_bf16 v[76:79], v[92:95], v[50:53], v[76:79]
  s_nop 2
  v_mul_f32 v64, v64, v10
  v_mul_f32 v65, v65, v10
  v_mul_f32 v66, v66, v10
  v_mul_f32 v67, v67, v10
  v_cvt_pk_bf16_f32 v80, v64, v65
  v_cvt_pk_bf16_f32 v81, v66, v67
  v_mul_f32 v72, v72, v10
  v_mul_f32 v73, v73, v10
  v_mul_f32 v74, v74, v10
  v_mul_f32 v75, v75, v10
  v_cvt_pk_bf16_f32 v82, v72, v73
  v_cvt_pk_bf16_f32 v83, v74, v75
  buffer_store_dwordx4 v[80:83], v1, s[4:7], s25 offen offset:0
  v_mul_f32 v68, v68, v11
  v_mul_f32 v69, v69, v11
  v_mul_f32 v70, v70, v11
  v_mul_f32 v71, v71, v11
  v_cvt_pk_bf16_f32 v84, v68, v69
  v_cvt_pk_bf16_f32 v85, v70, v71
  v_mul_f32 v76, v76, v11
  v_mul_f32 v77, v77, v11
  v_mul_f32 v78, v78, v11
  v_mul_f32 v79, v79, v11
  v_cvt_pk_bf16_f32 v86, v76, v77
  v_cvt_pk_bf16_f32 v87, v78, v79
  buffer_store_dwordx4 v[84:87], v1, s[4:7], s26 offen offset:0
  v_mfma_f32_16x16x16_bf16 v[64:67], v[140:141], v[44:45], 0
  v_mfma_f32_16x16x16_bf16 v[68:71], v[140:141], v[48:49], 0
  v_mfma_f32_16x16x16_bf16 v[64:67], v[96:97], v[46:47], v[64:67]
  v_mfma_f32_16x16x32_bf16 v[68:71], v[96:99], v[50:53], v[68:71]
  v_mfma_f32_16x16x16_bf16 v[72:75], v[142:143], v[44:45], 0
  v_mfma_f32_16x16x16_bf16 v[76:79], v[142:143], v[48:49], 0
  v_mfma_f32_16x16x16_bf16 v[72:75], v[100:101], v[46:47], v[72:75]
  v_mfma_f32_16x16x32_bf16 v[76:79], v[100:103], v[50:53], v[76:79]
  s_nop 2
  v_mul_f32 v64, v64, v10
  v_mul_f32 v65, v65, v10
  v_mul_f32 v66, v66, v10
  v_mul_f32 v67, v67, v10
  v_cvt_pk_bf16_f32 v80, v64, v65
  v_cvt_pk_bf16_f32 v81, v66, v67
  v_mul_f32 v72, v72, v10
  v_mul_f32 v73, v73, v10
  v_mul_f32 v74, v74, v10
  v_mul_f32 v75, v75, v10
  v_cvt_pk_bf16_f32 v82, v72, v73
  v_cvt_pk_bf16_f32 v83, v74, v75
  buffer_store_dwordx4 v[80:83], v1, s[4:7], s25 offen offset:1024
  v_mul_f32 v68, v68, v11
  v_mul_f32 v69, v69, v11
  v_mul_f32 v70, v70, v11
  v_mul_f32 v71, v71, v11
  v_cvt_pk_bf16_f32 v84, v68, v69
  v_cvt_pk_bf16_f32 v85, v70, v71
  v_mul_f32 v76, v76, v11
  v_mul_f32 v77, v77, v11
  v_mul_f32 v78, v78, v11
  v_mul_f32 v79, v79, v11
  v_cvt_pk_bf16_f32 v86, v76, v77
  v_cvt_pk_bf16_f32 v87, v78, v79
  buffer_store_dwordx4 v[84:87], v1, s[4:7], s26 offen offset:1024
  v_mfma_f32_16x16x16_bf16 v[64:67], v[144:145], v[44:45], 0
  v_mfma_f32_16x16x16_bf16 v[68:71], v[144:145], v[48:49], 0
  v_mfma_f32_16x16x16_bf16 v[64:67], v[104:105], v[46:47], v[64:67]
  v_mfma_f32_16x16x32_bf16 v[68:71], v[104:107], v[50:53], v[68:71]
  v_mfma_f32_16x16x16_bf16 v[72:75], v[146:147], v[44:45], 0
  v_mfma_f32_16x16x16_bf16 v[76:79], v[146:147], v[48:49], 0
  v_mfma_f32_16x16x16_bf16 v[72:75], v[108:109], v[46:47], v[72:75]
  v_mfma_f32_16x16x32_bf16 v[76:79], v[108:111], v[50:53], v[76:79]
  s_nop 2
  v_mul_f32 v64, v64, v10
  v_mul_f32 v65, v65, v10
  v_mul_f32 v66, v66, v10
  v_mul_f32 v67, v67, v10
  v_cvt_pk_bf16_f32 v80, v64, v65
  v_cvt_pk_bf16_f32 v81, v66, v67
  v_mul_f32 v72, v72, v10
  v_mul_f32 v73, v73, v10
  v_mul_f32 v74, v74, v10
  v_mul_f32 v75, v75, v10
  v_cvt_pk_bf16_f32 v82, v72, v73
  v_cvt_pk_bf16_f32 v83, v74, v75
  buffer_store_dwordx4 v[80:83], v1, s[4:7], s25 offen offset:2048
  v_mul_f32 v68, v68, v11
  v_mul_f32 v69, v69, v11
  v_mul_f32 v70, v70, v11
  v_mul_f32 v71, v71, v11
  v_cvt_pk_bf16_f32 v84, v68, v69
  v_cvt_pk_bf16_f32 v85, v70, v71
  v_mul_f32 v76, v76, v11
  v_mul_f32 v77, v77, v11
  v_mul_f32 v78, v78, v11
  v_mul_f32 v79, v79, v11
  v_cvt_pk_bf16_f32 v86, v76, v77
  v_cvt_pk_bf16_f32 v87, v78, v79
  buffer_store_dwordx4 v[84:87], v1, s[4:7], s26 offen offset:2048
  v_mfma_f32_16x16x16_bf16 v[64:67], v[148:149], v[44:45], 0
  v_mfma_f32_16x16x16_bf16 v[68:71], v[148:149], v[48:49], 0
  v_mfma_f32_16x16x16_bf16 v[64:67], v[112:113], v[46:47], v[64:67]
  v_mfma_f32_16x16x32_bf16 v[68:71], v[112:115], v[50:53], v[68:71]
  v_mfma_f32_16x16x16_bf16 v[72:75], v[150:151], v[44:45], 0
  v_mfma_f32_16x16x16_bf16 v[76:79], v[150:151], v[48:49], 0
  v_mfma_f32_16x16x16_bf16 v[72:75], v[116:117], v[46:47], v[72:75]
  v_mfma_f32_16x16x32_bf16 v[76:79], v[116:119], v[50:53], v[76:79]
  s_nop 2
  v_mul_f32 v64, v64, v10
  v_mul_f32 v65, v65, v10
  v_mul_f32 v66, v66, v10
  v_mul_f32 v67, v67, v10
  v_cvt_pk_bf16_f32 v80, v64, v65
  v_cvt_pk_bf16_f32 v81, v66, v67
  v_mul_f32 v72, v72, v10
  v_mul_f32 v73, v73, v10
  v_mul_f32 v74, v74, v10
  v_mul_f32 v75, v75, v10
  v_cvt_pk_bf16_f32 v82, v72, v73
  v_cvt_pk_bf16_f32 v83, v74, v75
  buffer_store_dwordx4 v[80:83], v1, s[4:7], s25 offen offset:3072
  v_mul_f32 v68, v68, v11
  v_mul_f32 v69, v69, v11
  v_mul_f32 v70, v70, v11
  v_mul_f32 v71, v71, v11
  v_cvt_pk_bf16_f32 v84, v68, v69
  v_cvt_pk_bf16_f32 v85, v70, v71
  v_mul_f32 v76, v76, v11
  v_mul_f32 v77, v77, v11
  v_mul_f32 v78, v78, v11
  v_mul_f32 v79, v79, v11
  v_cvt_pk_bf16_f32 v86, v76, v77
  v_cvt_pk_bf16_f32 v87, v78, v79
  buffer_store_dwordx4 v[84:87], v1, s[4:7], s26 offen offset:3072
  v_mfma_f32_16x16x16_bf16 v[64:67], v[152:153], v[44:45], 0
  v_mfma_f32_16x16x16_bf16 v[68:71], v[152:153], v[48:49], 0
  v_mfma_f32_16x16x16_bf16 v[64:67], v[120:121], v[46:47], v[64:67]
  v_mfma_f32_16x16x32_bf16 v[68:71], v[120:123], v[50:53], v[68:71]
  v_mfma_f32_16x16x16_bf16 v[72:75], v[154:155], v[44:45], 0
  v_mfma_f32_16x16x16_bf16 v[76:79], v[154:155], v[48:49], 0
  v_mfma_f32_16x16x16_bf16 v[72:75], v[124:125], v[46:47], v[72:75]
  v_mfma_f32_16x16x32_bf16 v[76:79], v[124:127], v[50:53], v[76:79]
  s_nop 2
  v_mul_f32 v64, v64, v10
  v_mul_f32 v65, v65, v10
  v_mul_f32 v66, v66, v10
  v_mul_f32 v67, v67, v10
  v_cvt_pk_bf16_f32 v80, v64, v65
  v_cvt_pk_bf16_f32 v81, v66, v67
  v_mul_f32 v72, v72, v10
  v_mul_f32 v73, v73, v10
  v_mul_f32 v74, v74, v10
  v_mul_f32 v75, v75, v10
  v_cvt_pk_bf16_f32 v82, v72, v73
  v_cvt_pk_bf16_f32 v83, v74, v75
  buffer_store_dwordx4 v[80:83], v2, s[4:7], s25 offen offset:0
  v_mul_f32 v68, v68, v11
  v_mul_f32 v69, v69, v11
  v_mul_f32 v70, v70, v11
  v_mul_f32 v71, v71, v11
  v_cvt_pk_bf16_f32 v84, v68, v69
  v_cvt_pk_bf16_f32 v85, v70, v71
  v_mul_f32 v76, v76, v11
  v_mul_f32 v77, v77, v11
  v_mul_f32 v78, v78, v11
  v_mul_f32 v79, v79, v11
  v_cvt_pk_bf16_f32 v86, v76, v77
  v_cvt_pk_bf16_f32 v87, v78, v79
  buffer_store_dwordx4 v[84:87], v2, s[4:7], s26 offen offset:0
  v_mfma_f32_16x16x16_bf16 v[64:67], v[156:157], v[44:45], 0
  v_mfma_f32_16x16x16_bf16 v[68:71], v[156:157], v[48:49], 0
  v_mfma_f32_16x16x16_bf16 v[64:67], v[128:129], v[46:47], v[64:67]
  v_mfma_f32_16x16x32_bf16 v[68:71], v[128:131], v[50:53], v[68:71]
  v_mfma_f32_16x16x16_bf16 v[72:75], v[158:159], v[44:45], 0
  v_mfma_f32_16x16x16_bf16 v[76:79], v[158:159], v[48:49], 0
  v_mfma_f32_16x16x16_bf16 v[72:75], v[132:133], v[46:47], v[72:75]
  v_mfma_f32_16x16x32_bf16 v[76:79], v[132:135], v[50:53], v[76:79]
  s_nop 2
  v_mul_f32 v64, v64, v10
  v_mul_f32 v65, v65, v10
  v_mul_f32 v66, v66, v10
  v_mul_f32 v67, v67, v10
  v_cvt_pk_bf16_f32 v80, v64, v65
  v_cvt_pk_bf16_f32 v81, v66, v67
  v_mul_f32 v72, v72, v10
  v_mul_f32 v73, v73, v10
  v_mul_f32 v74, v74, v10
  v_mul_f32 v75, v75, v10
  v_cvt_pk_bf16_f32 v82, v72, v73
  v_cvt_pk_bf16_f32 v83, v74, v75
  buffer_store_dwordx4 v[80:83], v2, s[4:7], s25 offen offset:1024
  v_mul_f32 v68, v68, v11
  v_mul_f32 v69, v69, v11
  v_mul_f32 v70, v70, v11
  v_mul_f32 v71, v71, v11
  v_cvt_pk_bf16_f32 v84, v68, v69
  v_cvt_pk_bf16_f32 v85, v70, v71
  v_mul_f32 v76, v76, v11
  v_mul_f32 v77, v77, v11
  v_mul_f32 v78, v78, v11
  v_mul_f32 v79, v79, v11
  v_cvt_pk_bf16_f32 v86, v76, v77
  v_cvt_pk_bf16_f32 v87, v78, v79
  buffer_store_dwordx4 v[84:87], v2, s[4:7], s26 offen offset:1024
attna_exit1:
  s_endpgm
.globl outa1_kernel
.p2align 8
.type outa1_kernel,@function
outa1_kernel:
  s_cmp_ge_u32 s2, 256
  s_cbranch_scc1 outa1_exit1
  s_load_dwordx2 s[12:13], s[0:1], 96
  s_load_dwordx2 s[14:15], s[0:1], 0
  s_load_dwordx2 s[48:49], s[0:1], 80
  v_lshrrev_b32 v3, 6, v0
  v_and_b32 v4, 63, v0
  s_nop 0
  v_readfirstlane_b32 s16, v3
  v_lshlrev_b32 v1, 4, v4
  s_and_b32 s17, s2, 7
  s_lshl_b32 s17, s17, 2
  s_lshr_b32 s18, s2, 3
  s_and_b32 s19, s18, 3
  s_add_u32 s17, s17, s19
  s_lshr_b32 s18, s18, 2
  s_waitcnt lgkmcnt(0)
  s_mov_b32 s4, s12
  s_mov_b32 s5, s13
  s_mov_b32 s6, 0x10000000
  s_mov_b32 s7, 0x20000
  s_mov_b32 s8, s14
  s_mov_b32 s9, s15
  s_mov_b32 s10, 2621440
  s_mov_b32 s11, 0x20000
  s_mov_b32 s20, 0
  s_mov_b32 s52, s48
  s_mov_b32 s53, s49
  s_mov_b32 s54, 2621440
  s_mov_b32 s55, 0x20000
  s_mul_i32 s21, s18, 5
  s_mul_i32 s21, s21, 196608
  s_add_u32 s24, s21, 29884416
  s_add_u32 s25, s24, 196608
  s_add_u32 s26, s25, 196608
  s_add_u32 s27, s26, 196608
  s_add_u32 s28, s27, 196608
  s_lshl_b32 s21, s17, 2
  s_add_u32 s21, s21, s16
  s_mul_i32 s22, s21, 196608
  s_add_u32 s22, s22, 125829120
  s_lshl_b32 s23, s16, 10
  v_add_u32 v2, s23, v1
  s_mul_i32 s29, s16, 5120
  s_add_u32 m0, s29, 0
  s_nop 0
  buffer_load_dwordx4 v2, s[4:7], s24 offen lds
  s_add_u32 m0, s29, 1024
  s_nop 0
  buffer_load_dwordx4 v2, s[4:7], s25 offen lds
  s_add_u32 m0, s29, 2048
  s_nop 0
  buffer_load_dwordx4 v2, s[4:7], s26 offen lds
  s_add_u32 m0, s29, 3072
  s_nop 0
  buffer_load_dwordx4 v2, s[4:7], s27 offen lds
  s_add_u32 m0, s29, 4096
  s_nop 0
  buffer_load_dwordx4 v2, s[4:7], s28 offen lds
  buffer_load_dwordx4 v[32:35], v1, s[4:7], s22 offen offset:0
  buffer_load_dwordx4 v[36:39], v1, s[4:7], s22 offen offset:1024
  buffer_load_dwordx4 v[40:43], v1, s[4:7], s22 offen offset:2048
  buffer_load_dwordx4 v[44:47], v1, s[4:7], s22 offen offset:3072
  v_add_u32 v2, 0x1000, v2
  s_add_u32 s22, s22, 4096
  s_add_u32 m0, s29, 20480
  s_nop 0
  buffer_load_dwordx4 v2, s[4:7], s24 offen lds
  s_add_u32 m0, s29, 21504
  s_nop 0
  buffer_load_dwordx4 v2, s[4:7], s25 offen lds
  s_add_u32 m0, s29, 22528
  s_nop 0
  buffer_load_dwordx4 v2, s[4:7], s26 offen lds
  s_add_u32 m0, s29, 23552
  s_nop 0
  buffer_load_dwordx4 v2, s[4:7], s27 offen lds
  s_add_u32 m0, s29, 24576
  s_nop 0
  buffer_load_dwordx4 v2, s[4:7], s28 offen lds
  buffer_load_dwordx4 v[48:51], v1, s[4:7], s22 offen offset:0
  buffer_load_dwordx4 v[52:55], v1, s[4:7], s22 offen offset:1024
  buffer_load_dwordx4 v[56:59], v1, s[4:7], s22 offen offset:2048
  buffer_load_dwordx4 v[60:63], v1, s[4:7], s22 offen offset:3072
  v_add_u32 v2, 0x1000, v2
  s_add_u32 s22, s22, 4096
  s_waitcnt vmcnt(9)
  s_barrier
  s_add_u32 m0, s29, 40960
  s_nop 0
  buffer_load_dwordx4 v2, s[4:7], s24 offen lds
  s_add_u32 m0, s29, 41984
  s_nop 0
  buffer_load_dwordx4 v2, s[4:7], s25 offen lds
  s_add_u32 m0, s29, 43008
  s_nop 0
  buffer_load_dwordx4 v2, s[4:7], s26 offen lds
  s_add_u32 m0, s29, 44032
  s_nop 0
  buffer_load_dwordx4 v2, s[4:7], s27 offen lds
  s_add_u32 m0, s29, 45056
  s_nop 0
  buffer_load_dwordx4 v2, s[4:7], s28 offen lds
  buffer_load_dwordx4 v[64:67], v1, s[4:7], s22 offen offset:0
  buffer_load_dwordx4 v[68:71], v1, s[4:7], s22 offen offset:1024
  buffer_load_dwordx4 v[72:75], v1, s[4:7], s22 offen offset:2048
  buffer_load_dwordx4 v[76:79], v1, s[4:7], s22 offen offset:3072
  v_add_u32 v2, 0x1000, v2
  s_add_u32 s22, s22, 4096
  ds_read_b128 v[80:83], v1 offset:0
  ds_read_b128 v[84:87], v1 offset:1024
  ds_read_b128 v[88:91], v1 offset:2048
  ds_read_b128 v[92:95], v1 offset:3072
  ds_read_b128 v[96:99], v1 offset:4096
  ds_read_b128 v[100:103], v1 offset:5120
  ds_read_b128 v[104:107], v1 offset:6144
  ds_read_b128 v[108:111], v1 offset:7168
  ds_read_b128 v[112:115], v1 offset:8192
  ds_read_b128 v[116:119], v1 offset:9216
  s_waitcnt lgkmcnt(5)
  v_mfma_f32_16x16x32_bf16 v[8:11], v[80:83], v[32:35], 0
  v_mfma_f32_16x16x32_bf16 v[12:15], v[84:87], v[32:35], 0
  v_mfma_f32_16x16x32_bf16 v[16:19], v[88:91], v[32:35], 0
  v_mfma_f32_16x16x32_bf16 v[20:23], v[92:95], v[32:35], 0
  v_mfma_f32_16x16x32_bf16 v[24:27], v[96:99], v[32:35], 0
  ds_read_b128 v[80:83], v1 offset:10240
  ds_read_b128 v[84:87], v1 offset:11264
  ds_read_b128 v[88:91], v1 offset:12288
  ds_read_b128 v[92:95], v1 offset:13312
  ds_read_b128 v[96:99], v1 offset:14336
  s_waitcnt lgkmcnt(5)
  v_mfma_f32_16x16x32_bf16 v[8:11], v[100:103], v[36:39], v[8:11]
  v_mfma_f32_16x16x32_bf16 v[12:15], v[104:107], v[36:39], v[12:15]
  v_mfma_f32_16x16x32_bf16 v[16:19], v[108:111], v[36:39], v[16:19]
  v_mfma_f32_16x16x32_bf16 v[20:23], v[112:115], v[36:39], v[20:23]
  v_mfma_f32_16x16x32_bf16 v[24:27], v[116:119], v[36:39], v[24:27]
  ds_read_b128 v[100:103], v1 offset:15360
  ds_read_b128 v[104:107], v1 offset:16384
  ds_read_b128 v[108:111], v1 offset:17408
  ds_read_b128 v[112:115], v1 offset:18432
  ds_read_b128 v[116:119], v1 offset:19456
  s_waitcnt lgkmcnt(5)
  v_mfma_f32_16x16x32_bf16 v[8:11], v[80:83], v[40:43], v[8:11]
  v_mfma_f32_16x16x32_bf16 v[12:15], v[84:87], v[40:43], v[12:15]
  v_mfma_f32_16x16x32_bf16 v[16:19], v[88:91], v[40:43], v[16:19]
  v_mfma_f32_16x16x32_bf16 v[20:23], v[92:95], v[40:43], v[20:23]
  v_mfma_f32_16x16x32_bf16 v[24:27], v[96:99], v[40:43], v[24:27]
  s_waitcnt lgkmcnt(0)
  v_mfma_f32_16x16x32_bf16 v[8:11], v[100:103], v[44:47], v[8:11]
  v_mfma_f32_16x16x32_bf16 v[12:15], v[104:107], v[44:47], v[12:15]
  v_mfma_f32_16x16x32_bf16 v[16:19], v[108:111], v[44:47], v[16:19]
  v_mfma_f32_16x16x32_bf16 v[20:23], v[112:115], v[44:47], v[20:23]
  v_mfma_f32_16x16x32_bf16 v[24:27], v[116:119], v[44:47], v[24:27]
  s_mov_b32 s30, 0
outa1_loop2:
  s_waitcnt vmcnt(9)
  s_barrier
  s_add_u32 m0, s29, 0
  s_nop 0
  buffer_load_dwordx4 v2, s[4:7], s24 offen lds
  s_add_u32 m0, s29, 1024
  s_nop 0
  buffer_load_dwordx4 v2, s[4:7], s25 offen lds
  s_add_u32 m0, s29, 2048
  s_nop 0
  buffer_load_dwordx4 v2, s[4:7], s26 offen lds
  s_add_u32 m0, s29, 3072
  s_nop 0
  buffer_load_dwordx4 v2, s[4:7], s27 offen lds
  s_add_u32 m0, s29, 4096
  s_nop 0
  buffer_load_dwordx4 v2, s[4:7], s28 offen lds
  buffer_load_dwordx4 v[32:35], v1, s[4:7], s22 offen offset:0
  buffer_load_dwordx4 v[36:39], v1, s[4:7], s22 offen offset:1024
  buffer_load_dwordx4 v[40:43], v1, s[4:7], s22 offen offset:2048
  buffer_load_dwordx4 v[44:47], v1, s[4:7], s22 offen offset:3072
  v_add_u32 v2, 0x1000, v2
  s_add_u32 s22, s22, 4096
  ds_read_b128 v[80:83], v1 offset:20480
  ds_read_b128 v[84:87], v1 offset:21504
  ds_read_b128 v[88:91], v1 offset:22528
  ds_read_b128 v[92:95], v1 offset:23552
  ds_read_b128 v[96:99], v1 offset:24576
  ds_read_b128 v[100:103], v1 offset:25600
  ds_read_b128 v[104:107], v1 offset:26624
  ds_read_b128 v[108:111], v1 offset:27648
  ds_read_b128 v[112:115], v1 offset:28672
  ds_read_b128 v[116:119], v1 offset:29696
  s_waitcnt lgkmcnt(5)
  v_mfma_f32_16x16x32_bf16 v[8:11], v[80:83], v[48:51], v[8:11]
  v_mfma_f32_16x16x32_bf16 v[12:15], v[84:87], v[48:51], v[12:15]
  v_mfma_f32_16x16x32_bf16 v[16:19], v[88:91], v[48:51], v[16:19]
  v_mfma_f32_16x16x32_bf16 v[20:23], v[92:95], v[48:51], v[20:23]
  v_mfma_f32_16x16x32_bf16 v[24:27], v[96:99], v[48:51], v[24:27]
  ds_read_b128 v[80:83], v1 offset:30720
  ds_read_b128 v[84:87], v1 offset:31744
  ds_read_b128 v[88:91], v1 offset:32768
  ds_read_b128 v[92:95], v1 offset:33792
  ds_read_b128 v[96:99], v1 offset:34816
  s_waitcnt lgkmcnt(5)
  v_mfma_f32_16x16x32_bf16 v[8:11], v[100:103], v[52:55], v[8:11]
  v_mfma_f32_16x16x32_bf16 v[12:15], v[104:107], v[52:55], v[12:15]
  v_mfma_f32_16x16x32_bf16 v[16:19], v[108:111], v[52:55], v[16:19]
  v_mfma_f32_16x16x32_bf16 v[20:23], v[112:115], v[52:55], v[20:23]
  v_mfma_f32_16x16x32_bf16 v[24:27], v[116:119], v[52:55], v[24:27]
  ds_read_b128 v[100:103], v1 offset:35840
  ds_read_b128 v[104:107], v1 offset:36864
  ds_read_b128 v[108:111], v1 offset:37888
  ds_read_b128 v[112:115], v1 offset:38912
  ds_read_b128 v[116:119], v1 offset:39936
  s_waitcnt lgkmcnt(5)
  v_mfma_f32_16x16x32_bf16 v[8:11], v[80:83], v[56:59], v[8:11]
  v_mfma_f32_16x16x32_bf16 v[12:15], v[84:87], v[56:59], v[12:15]
  v_mfma_f32_16x16x32_bf16 v[16:19], v[88:91], v[56:59], v[16:19]
  v_mfma_f32_16x16x32_bf16 v[20:23], v[92:95], v[56:59], v[20:23]
  v_mfma_f32_16x16x32_bf16 v[24:27], v[96:99], v[56:59], v[24:27]
  s_waitcnt lgkmcnt(0)
  v_mfma_f32_16x16x32_bf16 v[8:11], v[100:103], v[60:63], v[8:11]
  v_mfma_f32_16x16x32_bf16 v[12:15], v[104:107], v[60:63], v[12:15]
  v_mfma_f32_16x16x32_bf16 v[16:19], v[108:111], v[60:63], v[16:19]
  v_mfma_f32_16x16x32_bf16 v[20:23], v[112:115], v[60:63], v[20:23]
  v_mfma_f32_16x16x32_bf16 v[24:27], v[116:119], v[60:63], v[24:27]
  s_waitcnt vmcnt(9)
  s_barrier
  s_add_u32 m0, s29, 20480
  s_nop 0
  buffer_load_dwordx4 v2, s[4:7], s24 offen lds
  s_add_u32 m0, s29, 21504
  s_nop 0
  buffer_load_dwordx4 v2, s[4:7], s25 offen lds
  s_add_u32 m0, s29, 22528
  s_nop 0
  buffer_load_dwordx4 v2, s[4:7], s26 offen lds
  s_add_u32 m0, s29, 23552
  s_nop 0
  buffer_load_dwordx4 v2, s[4:7], s27 offen lds
  s_add_u32 m0, s29, 24576
  s_nop 0
  buffer_load_dwordx4 v2, s[4:7], s28 offen lds
  buffer_load_dwordx4 v[48:51], v1, s[4:7], s22 offen offset:0
  buffer_load_dwordx4 v[52:55], v1, s[4:7], s22 offen offset:1024
  buffer_load_dwordx4 v[56:59], v1, s[4:7], s22 offen offset:2048
  buffer_load_dwordx4 v[60:63], v1, s[4:7], s22 offen offset:3072
  v_add_u32 v2, 0x1000, v2
  s_add_u32 s22, s22, 4096
  ds_read_b128 v[80:83], v1 offset:40960
  ds_read_b128 v[84:87], v1 offset:41984
  ds_read_b128 v[88:91], v1 offset:43008
  ds_read_b128 v[92:95], v1 offset:44032
  ds_read_b128 v[96:99], v1 offset:45056
  ds_read_b128 v[100:103], v1 offset:46080
  ds_read_b128 v[104:107], v1 offset:47104
  ds_read_b128 v[108:111], v1 offset:48128
  ds_read_b128 v[112:115], v1 offset:49152
  ds_read_b128 v[116:119], v1 offset:50176
  s_waitcnt lgkmcnt(5)
  v_mfma_f32_16x16x32_bf16 v[8:11], v[80:83], v[64:67], v[8:11]
  v_mfma_f32_16x16x32_bf16 v[12:15], v[84:87], v[64:67], v[12:15]
  v_mfma_f32_16x16x32_bf16 v[16:19], v[88:91], v[64:67], v[16:19]
  v_mfma_f32_16x16x32_bf16 v[20:23], v[92:95], v[64:67], v[20:23]
  v_mfma_f32_16x16x32_bf16 v[24:27], v[96:99], v[64:67], v[24:27]
  ds_read_b128 v[80:83], v1 offset:51200
  ds_read_b128 v[84:87], v1 offset:52224
  ds_read_b128 v[88:91], v1 offset:53248
  ds_read_b128 v[92:95], v1 offset:54272
  ds_read_b128 v[96:99], v1 offset:55296
  s_waitcnt lgkmcnt(5)
  v_mfma_f32_16x16x32_bf16 v[8:11], v[100:103], v[68:71], v[8:11]
  v_mfma_f32_16x16x32_bf16 v[12:15], v[104:107], v[68:71], v[12:15]
  v_mfma_f32_16x16x32_bf16 v[16:19], v[108:111], v[68:71], v[16:19]
  v_mfma_f32_16x16x32_bf16 v[20:23], v[112:115], v[68:71], v[20:23]
  v_mfma_f32_16x16x32_bf16 v[24:27], v[116:119], v[68:71], v[24:27]
  ds_read_b128 v[100:103], v1 offset:56320
  ds_read_b128 v[104:107], v1 offset:57344
  ds_read_b128 v[108:111], v1 offset:58368
  ds_read_b128 v[112:115], v1 offset:59392
  ds_read_b128 v[116:119], v1 offset:60416
  s_waitcnt lgkmcnt(5)
  v_mfma_f32_16x16x32_bf16 v[8:11], v[80:83], v[72:75], v[8:11]
  v_mfma_f32_16x16x32_bf16 v[12:15], v[84:87], v[72:75], v[12:15]
  v_mfma_f32_16x16x32_bf16 v[16:19], v[88:91], v[72:75], v[16:19]
  v_mfma_f32_16x16x32_bf16 v[20:23], v[92:95], v[72:75], v[20:23]
  v_mfma_f32_16x16x32_bf16 v[24:27], v[96:99], v[72:75], v[24:27]
  s_waitcnt lgkmcnt(0)
  v_mfma_f32_16x16x32_bf16 v[8:11], v[100:103], v[76:79], v[8:11]
  v_mfma_f32_16x16x32_bf16 v[12:15], v[104:107], v[76:79], v[12:15]
  v_mfma_f32_16x16x32_bf16 v[16:19], v[108:111], v[76:79], v[16:19]
  v_mfma_f32_16x16x32_bf16 v[20:23], v[112:115], v[76:79], v[20:23]
  v_mfma_f32_16x16x32_bf16 v[24:27], v[116:119], v[76:79], v[24:27]
  s_waitcnt vmcnt(9)
  s_barrier
  s_add_u32 m0, s29, 40960
  s_nop 0
  buffer_load_dwordx4 v2, s[4:7], s24 offen lds
  s_add_u32 m0, s29, 41984
  s_nop 0
  buffer_load_dwordx4 v2, s[4:7], s25 offen lds
  s_add_u32 m0, s29, 43008
  s_nop 0
  buffer_load_dwordx4 v2, s[4:7], s26 offen lds
  s_add_u32 m0, s29, 44032
  s_nop 0
  buffer_load_dwordx4 v2, s[4:7], s27 offen lds
  s_add_u32 m0, s29, 45056
  s_nop 0
  buffer_load_dwordx4 v2, s[4:7], s28 offen lds
  buffer_load_dwordx4 v[64:67], v1, s[4:7], s22 offen offset:0
  buffer_load_dwordx4 v[68:71], v1, s[4:7], s22 offen offset:1024
  buffer_load_dwordx4 v[72:75], v1, s[4:7], s22 offen offset:2048
  buffer_load_dwordx4 v[76:79], v1, s[4:7], s22 offen offset:3072
  v_add_u32 v2, 0x1000, v2
  s_add_u32 s22, s22, 4096
  ds_read_b128 v[80:83], v1 offset:0
  ds_read_b128 v[84:87], v1 offset:1024
  ds_read_b128 v[88:91], v1 offset:2048
  ds_read_b128 v[92:95], v1 offset:3072
  ds_read_b128 v[96:99], v1 offset:4096
  ds_read_b128 v[100:103], v1 offset:5120
  ds_read_b128 v[104:107], v1 offset:6144
  ds_read_b128 v[108:111], v1 offset:7168
  ds_read_b128 v[112:115], v1 offset:8192
  ds_read_b128 v[116:119], v1 offset:9216
  s_waitcnt lgkmcnt(5)
  v_mfma_f32_16x16x32_bf16 v[8:11], v[80:83], v[32:35], v[8:11]
  v_mfma_f32_16x16x32_bf16 v[12:15], v[84:87], v[32:35], v[12:15]
  v_mfma_f32_16x16x32_bf16 v[16:19], v[88:91], v[32:35], v[16:19]
  v_mfma_f32_16x16x32_bf16 v[20:23], v[92:95], v[32:35], v[20:23]
  v_mfma_f32_16x16x32_bf16 v[24:27], v[96:99], v[32:35], v[24:27]
  ds_read_b128 v[80:83], v1 offset:10240
  ds_read_b128 v[84:87], v1 offset:11264
  ds_read_b128 v[88:91], v1 offset:12288
  ds_read_b128 v[92:95], v1 offset:13312
  ds_read_b128 v[96:99], v1 offset:14336
  s_waitcnt lgkmcnt(5)
  v_mfma_f32_16x16x32_bf16 v[8:11], v[100:103], v[36:39], v[8:11]
  v_mfma_f32_16x16x32_bf16 v[12:15], v[104:107], v[36:39], v[12:15]
  v_mfma_f32_16x16x32_bf16 v[16:19], v[108:111], v[36:39], v[16:19]
  v_mfma_f32_16x16x32_bf16 v[20:23], v[112:115], v[36:39], v[20:23]
  v_mfma_f32_16x16x32_bf16 v[24:27], v[116:119], v[36:39], v[24:27]
  ds_read_b128 v[100:103], v1 offset:15360
  ds_read_b128 v[104:107], v1 offset:16384
  ds_read_b128 v[108:111], v1 offset:17408
  ds_read_b128 v[112:115], v1 offset:18432
  ds_read_b128 v[116:119], v1 offset:19456
  s_waitcnt lgkmcnt(5)
  v_mfma_f32_16x16x32_bf16 v[8:11], v[80:83], v[40:43], v[8:11]
  v_mfma_f32_16x16x32_bf16 v[12:15], v[84:87], v[40:43], v[12:15]
  v_mfma_f32_16x16x32_bf16 v[16:19], v[88:91], v[40:43], v[16:19]
  v_mfma_f32_16x16x32_bf16 v[20:23], v[92:95], v[40:43], v[20:23]
  v_mfma_f32_16x16x32_bf16 v[24:27], v[96:99], v[40:43], v[24:27]
  s_waitcnt lgkmcnt(0)
  v_mfma_f32_16x16x32_bf16 v[8:11], v[100:103], v[44:47], v[8:11]
  v_mfma_f32_16x16x32_bf16 v[12:15], v[104:107], v[44:47], v[12:15]
  v_mfma_f32_16x16x32_bf16 v[16:19], v[108:111], v[44:47], v[16:19]
  v_mfma_f32_16x16x32_bf16 v[20:23], v[112:115], v[44:47], v[20:23]
  v_mfma_f32_16x16x32_bf16 v[24:27], v[116:119], v[44:47], v[24:27]
  s_add_u32 s30, s30, 1
  s_cmp_lt_u32 s30, 15
  s_cbranch_scc1 outa1_loop2
  s_waitcnt vmcnt(9)
  s_barrier
  ds_read_b128 v[80:83], v1 offset:20480
  ds_read_b128 v[84:87], v1 offset:21504
  ds_read_b128 v[88:91], v1 offset:22528
  ds_read_b128 v[92:95], v1 offset:23552
  ds_read_b128 v[96:99], v1 offset:24576
  ds_read_b128 v[100:103], v1 offset:25600
  ds_read_b128 v[104:107], v1 offset:26624
  ds_read_b128 v[108:111], v1 offset:27648
  ds_read_b128 v[112:115], v1 offset:28672
  ds_read_b128 v[116:119], v1 offset:29696
  s_waitcnt lgkmcnt(5)
  v_mfma_f32_16x16x32_bf16 v[8:11], v[80:83], v[48:51], v[8:11]
  v_mfma_f32_16x16x32_bf16 v[12:15], v[84:87], v[48:51], v[12:15]
  v_mfma_f32_16x16x32_bf16 v[16:19], v[88:91], v[48:51], v[16:19]
  v_mfma_f32_16x16x32_bf16 v[20:23], v[92:95], v[48:51], v[20:23]
  v_mfma_f32_16x16x32_bf16 v[24:27], v[96:99], v[48:51], v[24:27]
  ds_read_b128 v[80:83], v1 offset:30720
  ds_read_b128 v[84:87], v1 offset:31744
  ds_read_b128 v[88:91], v1 offset:32768
  ds_read_b128 v[92:95], v1 offset:33792
  ds_read_b128 v[96:99], v1 offset:34816
  s_waitcnt lgkmcnt(5)
  v_mfma_f32_16x16x32_bf16 v[8:11], v[100:103], v[52:55], v[8:11]
  v_mfma_f32_16x16x32_bf16 v[12:15], v[104:107], v[52:55], v[12:15]
  v_mfma_f32_16x16x32_bf16 v[16:19], v[108:111], v[52:55], v[16:19]
  v_mfma_f32_16x16x32_bf16 v[20:23], v[112:115], v[52:55], v[20:23]
  v_mfma_f32_16x16x32_bf16 v[24:27], v[116:119], v[52:55], v[24:27]
  ds_read_b128 v[100:103], v1 offset:35840
  ds_read_b128 v[104:107], v1 offset:36864
  ds_read_b128 v[108:111], v1 offset:37888
  ds_read_b128 v[112:115], v1 offset:38912
  ds_read_b128 v[116:119], v1 offset:39936
  s_waitcnt lgkmcnt(5)
  v_mfma_f32_16x16x32_bf16 v[8:11], v[80:83], v[56:59], v[8:11]
  v_mfma_f32_16x16x32_bf16 v[12:15], v[84:87], v[56:59], v[12:15]
  v_mfma_f32_16x16x32_bf16 v[16:19], v[88:91], v[56:59], v[16:19]
  v_mfma_f32_16x16x32_bf16 v[20:23], v[92:95], v[56:59], v[20:23]
  v_mfma_f32_16x16x32_bf16 v[24:27], v[96:99], v[56:59], v[24:27]
  s_waitcnt lgkmcnt(0)
  v_mfma_f32_16x16x32_bf16 v[8:11], v[100:103], v[60:63], v[8:11]
  v_mfma_f32_16x16x32_bf16 v[12:15], v[104:107], v[60:63], v[12:15]
  v_mfma_f32_16x16x32_bf16 v[16:19], v[108:111], v[60:63], v[16:19]
  v_mfma_f32_16x16x32_bf16 v[20:23], v[112:115], v[60:63], v[20:23]
  v_mfma_f32_16x16x32_bf16 v[24:27], v[116:119], v[60:63], v[24:27]
  s_waitcnt vmcnt(0)
  s_barrier
  ds_read_b128 v[80:83], v1 offset:40960
  ds_read_b128 v[84:87], v1 offset:41984
  ds_read_b128 v[88:91], v1 offset:43008
  ds_read_b128 v[92:95], v1 offset:44032
  ds_read_b128 v[96:99], v1 offset:45056
  ds_read_b128 v[100:103], v1 offset:46080
  ds_read_b128 v[104:107], v1 offset:47104
  ds_read_b128 v[108:111], v1 offset:48128
  ds_read_b128 v[112:115], v1 offset:49152
  ds_read_b128 v[116:119], v1 offset:50176
  s_waitcnt lgkmcnt(5)
  v_mfma_f32_16x16x32_bf16 v[8:11], v[80:83], v[64:67], v[8:11]
  v_mfma_f32_16x16x32_bf16 v[12:15], v[84:87], v[64:67], v[12:15]
  v_mfma_f32_16x16x32_bf16 v[16:19], v[88:91], v[64:67], v[16:19]
  v_mfma_f32_16x16x32_bf16 v[20:23], v[92:95], v[64:67], v[20:23]
  v_mfma_f32_16x16x32_bf16 v[24:27], v[96:99], v[64:67], v[24:27]
  ds_read_b128 v[80:83], v1 offset:51200
  ds_read_b128 v[84:87], v1 offset:52224
  ds_read_b128 v[88:91], v1 offset:53248
  ds_read_b128 v[92:95], v1 offset:54272
  ds_read_b128 v[96:99], v1 offset:55296
  s_waitcnt lgkmcnt(5)
  v_mfma_f32_16x16x32_bf16 v[8:11], v[100:103], v[68:71], v[8:11]
  v_mfma_f32_16x16x32_bf16 v[12:15], v[104:107], v[68:71], v[12:15]
  v_mfma_f32_16x16x32_bf16 v[16:19], v[108:111], v[68:71], v[16:19]
  v_mfma_f32_16x16x32_bf16 v[20:23], v[112:115], v[68:71], v[20:23]
  v_mfma_f32_16x16x32_bf16 v[24:27], v[116:119], v[68:71], v[24:27]
  ds_read_b128 v[100:103], v1 offset:56320
  ds_read_b128 v[104:107], v1 offset:57344
  ds_read_b128 v[108:111], v1 offset:58368
  ds_read_b128 v[112:115], v1 offset:59392
  ds_read_b128 v[116:119], v1 offset:60416
  s_waitcnt lgkmcnt(5)
  v_mfma_f32_16x16x32_bf16 v[8:11], v[80:83], v[72:75], v[8:11]
  v_mfma_f32_16x16x32_bf16 v[12:15], v[84:87], v[72:75], v[12:15]
  v_mfma_f32_16x16x32_bf16 v[16:19], v[88:91], v[72:75], v[16:19]
  v_mfma_f32_16x16x32_bf16 v[20:23], v[92:95], v[72:75], v[20:23]
  v_mfma_f32_16x16x32_bf16 v[24:27], v[96:99], v[72:75], v[24:27]
  s_waitcnt lgkmcnt(0)
  v_mfma_f32_16x16x32_bf16 v[8:11], v[100:103], v[76:79], v[8:11]
  v_mfma_f32_16x16x32_bf16 v[12:15], v[104:107], v[76:79], v[12:15]
  v_mfma_f32_16x16x32_bf16 v[16:19], v[108:111], v[76:79], v[16:19]
  v_mfma_f32_16x16x32_bf16 v[20:23], v[112:115], v[76:79], v[20:23]
  v_mfma_f32_16x16x32_bf16 v[24:27], v[116:119], v[76:79], v[24:27]
  v_and_b32 v3, 63, v0
  v_and_b32 v4, 15, v3
  v_lshrrev_b32 v3, 4, v3
  s_lshl_b32 s21, s17, 6
  s_lshl_b32 s23, s16, 4
  s_add_u32 s21, s21, s23
  v_add_u32 v4, s21, v4
  v_mul_u32_u24 v6, 1280, v4
  v_lshl_add_u32 v6, v3, 4, v6
  s_mul_i32 s21, s18, 5
  s_add_u32 s23, s21, 0
  s_lshr_b32 s31, s23, 1
  s_lshl_b32 s31, s31, 6
  s_and_b32 s23, s23, 1
  s_lshl_b32 s23, s23, 3
  s_add_u32 s32, s31, s23
  s_add_u32 s40, s32, s20
  buffer_load_dwordx2 v[32:33], v6, s[8:11], s40 offen
  s_add_u32 s23, s21, 1
  s_lshr_b32 s31, s23, 1
  s_lshl_b32 s31, s31, 6
  s_and_b32 s23, s23, 1
  s_lshl_b32 s23, s23, 3
  s_add_u32 s33, s31, s23
  s_add_u32 s41, s33, s20
  buffer_load_dwordx2 v[34:35], v6, s[8:11], s41 offen
  s_add_u32 s23, s21, 2
  s_lshr_b32 s31, s23, 1
  s_lshl_b32 s31, s31, 6
  s_and_b32 s23, s23, 1
  s_lshl_b32 s23, s23, 3
  s_add_u32 s34, s31, s23
  s_add_u32 s42, s34, s20
  buffer_load_dwordx2 v[36:37], v6, s[8:11], s42 offen
  s_add_u32 s23, s21, 3
  s_lshr_b32 s31, s23, 1
  s_lshl_b32 s31, s31, 6
  s_and_b32 s23, s23, 1
  s_lshl_b32 s23, s23, 3
  s_add_u32 s35, s31, s23
  s_add_u32 s43, s35, s20
  buffer_load_dwordx2 v[38:39], v6, s[8:11], s43 offen
  s_add_u32 s23, s21, 4
  s_lshr_b32 s31, s23, 1
  s_lshl_b32 s31, s31, 6
  s_and_b32 s23, s23, 1
  s_lshl_b32 s23, s23, 3
  s_add_u32 s36, s31, s23
  s_add_u32 s44, s36, s20
  buffer_load_dwordx2 v[40:41], v6, s[8:11], s44 offen
  s_waitcnt vmcnt(0)
  v_cvt_pk_bf16_f32 v80, v8, v9
  v_cvt_pk_bf16_f32 v81, v10, v11
  v_lshlrev_b32 v8, 16, v80
  v_and_b32 v9, 0xffff0000, v80
  v_lshlrev_b32 v10, 16, v81
  v_and_b32 v11, 0xffff0000, v81
  v_lshlrev_b32 v82, 16, v32
  v_and_b32 v83, 0xffff0000, v32
  v_lshlrev_b32 v84, 16, v33
  v_and_b32 v85, 0xffff0000, v33
  v_add_f32 v8, v8, v82
  v_add_f32 v9, v9, v83
  v_add_f32 v10, v10, v84
  v_add_f32 v11, v11, v85
  v_cvt_pk_bf16_f32 v32, v8, v9
  v_cvt_pk_bf16_f32 v33, v10, v11
  s_add_u32 s23, s32, 150994944
  buffer_store_dwordx2 v[32:33], v6, s[4:7], s23 offen
  v_cvt_pk_bf16_f32 v80, v12, v13
  v_cvt_pk_bf16_f32 v81, v14, v15
  v_lshlrev_b32 v12, 16, v80
  v_and_b32 v13, 0xffff0000, v80
  v_lshlrev_b32 v14, 16, v81
  v_and_b32 v15, 0xffff0000, v81
  v_lshlrev_b32 v82, 16, v34
  v_and_b32 v83, 0xffff0000, v34
  v_lshlrev_b32 v84, 16, v35
  v_and_b32 v85, 0xffff0000, v35
  v_add_f32 v12, v12, v82
  v_add_f32 v13, v13, v83
  v_add_f32 v14, v14, v84
  v_add_f32 v15, v15, v85
  v_cvt_pk_bf16_f32 v34, v12, v13
  v_cvt_pk_bf16_f32 v35, v14, v15
  s_add_u32 s23, s33, 150994944
  buffer_store_dwordx2 v[34:35], v6, s[4:7], s23 offen
  v_cvt_pk_bf16_f32 v80, v16, v17
  v_cvt_pk_bf16_f32 v81, v18, v19
  v_lshlrev_b32 v16, 16, v80
  v_and_b32 v17, 0xffff0000, v80
  v_lshlrev_b32 v18, 16, v81
  v_and_b32 v19, 0xffff0000, v81
  v_lshlrev_b32 v82, 16, v36
  v_and_b32 v83, 0xffff0000, v36
  v_lshlrev_b32 v84, 16, v37
  v_and_b32 v85, 0xffff0000, v37
  v_add_f32 v16, v16, v82
  v_add_f32 v17, v17, v83
  v_add_f32 v18, v18, v84
  v_add_f32 v19, v19, v85
  v_cvt_pk_bf16_f32 v36, v16, v17
  v_cvt_pk_bf16_f32 v37, v18, v19
  s_add_u32 s23, s34, 150994944
  buffer_store_dwordx2 v[36:37], v6, s[4:7], s23 offen
  v_cvt_pk_bf16_f32 v80, v20, v21
  v_cvt_pk_bf16_f32 v81, v22, v23
  v_lshlrev_b32 v20, 16, v80
  v_and_b32 v21, 0xffff0000, v80
  v_lshlrev_b32 v22, 16, v81
  v_and_b32 v23, 0xffff0000, v81
  v_lshlrev_b32 v82, 16, v38
  v_and_b32 v83, 0xffff0000, v38
  v_lshlrev_b32 v84, 16, v39
  v_and_b32 v85, 0xffff0000, v39
  v_add_f32 v20, v20, v82
  v_add_f32 v21, v21, v83
  v_add_f32 v22, v22, v84
  v_add_f32 v23, v23, v85
  v_cvt_pk_bf16_f32 v38, v20, v21
  v_cvt_pk_bf16_f32 v39, v22, v23
  s_add_u32 s23, s35, 150994944
  buffer_store_dwordx2 v[38:39], v6, s[4:7], s23 offen
  v_cvt_pk_bf16_f32 v80, v24, v25
  v_cvt_pk_bf16_f32 v81, v26, v27
  v_lshlrev_b32 v24, 16, v80
  v_and_b32 v25, 0xffff0000, v80
  v_lshlrev_b32 v26, 16, v81
  v_and_b32 v27, 0xffff0000, v81
  v_lshlrev_b32 v82, 16, v40
  v_and_b32 v83, 0xffff0000, v40
  v_lshlrev_b32 v84, 16, v41
  v_and_b32 v85, 0xffff0000, v41
  v_add_f32 v24, v24, v82
  v_add_f32 v25, v25, v83
  v_add_f32 v26, v26, v84
  v_add_f32 v27, v27, v85
  v_cvt_pk_bf16_f32 v40, v24, v25
  v_cvt_pk_bf16_f32 v41, v26, v27
  s_add_u32 s23, s36, 150994944
  buffer_store_dwordx2 v[40:41], v6, s[4:7], s23 offen
outa1_exit1:
  s_endpgm
.globl outa2_kernel
.p2align 8
.type outa2_kernel,@function
outa2_kernel:
  s_cmp_ge_u32 s2, 256
  s_cbranch_scc1 outa2_exit1
  s_load_dwordx2 s[12:13], s[0:1], 96
  s_load_dwordx2 s[14:15], s[0:1], 0
  s_load_dwordx2 s[48:49], s[0:1], 80
  v_lshrrev_b32 v3, 6, v0
  v_and_b32 v4, 63, v0
  s_nop 0
  v_readfirstlane_b32 s16, v3
  v_lshlrev_b32 v1, 4, v4
  s_and_b32 s17, s2, 7
  s_lshl_b32 s17, s17, 2
  s_lshr_b32 s18, s2, 3
  s_and_b32 s19, s18, 3
  s_add_u32 s17, s17, s19
  s_lshr_b32 s18, s18, 2
  s_waitcnt lgkmcnt(0)
  s_mov_b32 s4, s12
  s_mov_b32 s5, s13
  s_mov_b32 s6, 0x10000000
  s_mov_b32 s7, 0x20000
  s_mov_b32 s8, s12
  s_mov_b32 s9, s13
  s_mov_b32 s10, 0x10000000
  s_mov_b32 s11, 0x20000
  s_mov_b32 s20, 150994944
  s_mov_b32 s52, s48
  s_mov_b32 s53, s49
  s_mov_b32 s54, 2621440
  s_mov_b32 s55, 0x20000
  s_mul_i32 s21, s18, 5
  s_mul_i32 s21, s21, 196608
  s_add_u32 s24, s21, 29884416
  s_add_u32 s25, s24, 196608
  s_add_u32 s26, s25, 196608
  s_add_u32 s27, s26, 196608
  s_add_u32 s28, s27, 196608
  s_lshl_b32 s21, s17, 2
  s_add_u32 s21, s21, s16
  s_mul_i32 s22, s21, 196608
  s_add_u32 s22, s22, 125829120
  s_lshl_b32 s23, s16, 10
  v_add_u32 v2, s23, v1
  s_mul_i32 s29, s16, 5120
  s_add_u32 m0, s29, 0
  s_nop 0
  buffer_load_dwordx4 v2, s[4:7], s24 offen lds
  s_add_u32 m0, s29, 1024
  s_nop 0
  buffer_load_dwordx4 v2, s[4:7], s25 offen lds
  s_add_u32 m0, s29, 2048
  s_nop 0
  buffer_load_dwordx4 v2, s[4:7], s26 offen lds
  s_add_u32 m0, s29, 3072
  s_nop 0
  buffer_load_dwordx4 v2, s[4:7], s27 offen lds
  s_add_u32 m0, s29, 4096
  s_nop 0
  buffer_load_dwordx4 v2, s[4:7], s28 offen lds
  buffer_load_dwordx4 v[32:35], v1, s[4:7], s22 offen offset:0
  buffer_load_dwordx4 v[36:39], v1, s[4:7], s22 offen offset:1024
  buffer_load_dwordx4 v[40:43], v1, s[4:7], s22 offen offset:2048
  buffer_load_dwordx4 v[44:47], v1, s[4:7], s22 offen offset:3072
  v_add_u32 v2, 0x1000, v2
  s_add_u32 s22, s22, 4096
  s_add_u32 m0, s29, 20480
  s_nop 0
  buffer_load_dwordx4 v2, s[4:7], s24 offen lds
  s_add_u32 m0, s29, 21504
  s_nop 0
  buffer_load_dwordx4 v2, s[4:7], s25 offen lds
  s_add_u32 m0, s29, 22528
  s_nop 0
  buffer_load_dwordx4 v2, s[4:7], s26 offen lds
  s_add_u32 m0, s29, 23552
  s_nop 0
  buffer_load_dwordx4 v2, s[4:7], s27 offen lds
  s_add_u32 m0, s29, 24576
  s_nop 0
  buffer_load_dwordx4 v2, s[4:7], s28 offen lds
  buffer_load_dwordx4 v[48:51], v1, s[4:7], s22 offen offset:0
  buffer_load_dwordx4 v[52:55], v1, s[4:7], s22 offen offset:1024
  buffer_load_dwordx4 v[56:59], v1, s[4:7], s22 offen offset:2048
  buffer_load_dwordx4 v[60:63], v1, s[4:7], s22 offen offset:3072
  v_add_u32 v2, 0x1000, v2
  s_add_u32 s22, s22, 4096
  s_waitcnt vmcnt(9)
  s_barrier
  s_add_u32 m0, s29, 40960
  s_nop 0
  buffer_load_dwordx4 v2, s[4:7], s24 offen lds
  s_add_u32 m0, s29, 41984
  s_nop 0
  buffer_load_dwordx4 v2, s[4:7], s25 offen lds
  s_add_u32 m0, s29, 43008
  s_nop 0
  buffer_load_dwordx4 v2, s[4:7], s26 offen lds
  s_add_u32 m0, s29, 44032
  s_nop 0
  buffer_load_dwordx4 v2, s[4:7], s27 offen lds
  s_add_u32 m0, s29, 45056
  s_nop 0
  buffer_load_dwordx4 v2, s[4:7], s28 offen lds
  buffer_load_dwordx4 v[64:67], v1, s[4:7], s22 offen offset:0
  buffer_load_dwordx4 v[68:71], v1, s[4:7], s22 offen offset:1024
  buffer_load_dwordx4 v[72:75], v1, s[4:7], s22 offen offset:2048
  buffer_load_dwordx4 v[76:79], v1, s[4:7], s22 offen offset:3072
  v_add_u32 v2, 0x1000, v2
  s_add_u32 s22, s22, 4096
  ds_read_b128 v[80:83], v1 offset:0
  ds_read_b128 v[84:87], v1 offset:1024
  ds_read_b128 v[88:91], v1 offset:2048
  ds_read_b128 v[92:95], v1 offset:3072
  ds_read_b128 v[96:99], v1 offset:4096
  ds_read_b128 v[100:103], v1 offset:5120
  ds_read_b128 v[104:107], v1 offset:6144
  ds_read_b128 v[108:111], v1 offset:7168
  ds_read_b128 v[112:115], v1 offset:8192
  ds_read_b128 v[116:119], v1 offset:9216
  s_waitcnt lgkmcnt(5)
  v_mfma_f32_16x16x32_bf16 v[8:11], v[80:83], v[32:35], 0
  v_mfma_f32_16x16x32_bf16 v[12:15], v[84:87], v[32:35], 0
  v_mfma_f32_16x16x32_bf16 v[16:19], v[88:91], v[32:35], 0
  v_mfma_f32_16x16x32_bf16 v[20:23], v[92:95], v[32:35], 0
  v_mfma_f32_16x16x32_bf16 v[24:27], v[96:99], v[32:35], 0
  ds_read_b128 v[80:83], v1 offset:10240
  ds_read_b128 v[84:87], v1 offset:11264
  ds_read_b128 v[88:91], v1 offset:12288
  ds_read_b128 v[92:95], v1 offset:13312
  ds_read_b128 v[96:99], v1 offset:14336
  s_waitcnt lgkmcnt(5)
  v_mfma_f32_16x16x32_bf16 v[8:11], v[100:103], v[36:39], v[8:11]
  v_mfma_f32_16x16x32_bf16 v[12:15], v[104:107], v[36:39], v[12:15]
  v_mfma_f32_16x16x32_bf16 v[16:19], v[108:111], v[36:39], v[16:19]
  v_mfma_f32_16x16x32_bf16 v[20:23], v[112:115], v[36:39], v[20:23]
  v_mfma_f32_16x16x32_bf16 v[24:27], v[116:119], v[36:39], v[24:27]
  ds_read_b128 v[100:103], v1 offset:15360
  ds_read_b128 v[104:107], v1 offset:16384
  ds_read_b128 v[108:111], v1 offset:17408
  ds_read_b128 v[112:115], v1 offset:18432
  ds_read_b128 v[116:119], v1 offset:19456
  s_waitcnt lgkmcnt(5)
  v_mfma_f32_16x16x32_bf16 v[8:11], v[80:83], v[40:43], v[8:11]
  v_mfma_f32_16x16x32_bf16 v[12:15], v[84:87], v[40:43], v[12:15]
  v_mfma_f32_16x16x32_bf16 v[16:19], v[88:91], v[40:43], v[16:19]
  v_mfma_f32_16x16x32_bf16 v[20:23], v[92:95], v[40:43], v[20:23]
  v_mfma_f32_16x16x32_bf16 v[24:27], v[96:99], v[40:43], v[24:27]
  s_waitcnt lgkmcnt(0)
  v_mfma_f32_16x16x32_bf16 v[8:11], v[100:103], v[44:47], v[8:11]
  v_mfma_f32_16x16x32_bf16 v[12:15], v[104:107], v[44:47], v[12:15]
  v_mfma_f32_16x16x32_bf16 v[16:19], v[108:111], v[44:47], v[16:19]
  v_mfma_f32_16x16x32_bf16 v[20:23], v[112:115], v[44:47], v[20:23]
  v_mfma_f32_16x16x32_bf16 v[24:27], v[116:119], v[44:47], v[24:27]
  s_mov_b32 s30, 0
outa2_loop2:
  s_waitcnt vmcnt(9)
  s_barrier
  s_add_u32 m0, s29, 0
  s_nop 0
  buffer_load_dwordx4 v2, s[4:7], s24 offen lds
  s_add_u32 m0, s29, 1024
  s_nop 0
  buffer_load_dwordx4 v2, s[4:7], s25 offen lds
  s_add_u32 m0, s29, 2048
  s_nop 0
  buffer_load_dwordx4 v2, s[4:7], s26 offen lds
  s_add_u32 m0, s29, 3072
  s_nop 0
  buffer_load_dwordx4 v2, s[4:7], s27 offen lds
  s_add_u32 m0, s29, 4096
  s_nop 0
  buffer_load_dwordx4 v2, s[4:7], s28 offen lds
  buffer_load_dwordx4 v[32:35], v1, s[4:7], s22 offen offset:0
  buffer_load_dwordx4 v[36:39], v1, s[4:7], s22 offen offset:1024
  buffer_load_dwordx4 v[40:43], v1, s[4:7], s22 offen offset:2048
  buffer_load_dwordx4 v[44:47], v1, s[4:7], s22 offen offset:3072
  v_add_u32 v2, 0x1000, v2
  s_add_u32 s22, s22, 4096
  ds_read_b128 v[80:83], v1 offset:20480
  ds_read_b128 v[84:87], v1 offset:21504
  ds_read_b128 v[88:91], v1 offset:22528
  ds_read_b128 v[92:95], v1 offset:23552
  ds_read_b128 v[96:99], v1 offset:24576
  ds_read_b128 v[100:103], v1 offset:25600
  ds_read_b128 v[104:107], v1 offset:26624
  ds_read_b128 v[108:111], v1 offset:27648
  ds_read_b128 v[112:115], v1 offset:28672
  ds_read_b128 v[116:119], v1 offset:29696
  s_waitcnt lgkmcnt(5)
  v_mfma_f32_16x16x32_bf16 v[8:11], v[80:83], v[48:51], v[8:11]
  v_mfma_f32_16x16x32_bf16 v[12:15], v[84:87], v[48:51], v[12:15]
  v_mfma_f32_16x16x32_bf16 v[16:19], v[88:91], v[48:51], v[16:19]
  v_mfma_f32_16x16x32_bf16 v[20:23], v[92:95], v[48:51], v[20:23]
  v_mfma_f32_16x16x32_bf16 v[24:27], v[96:99], v[48:51], v[24:27]
  ds_read_b128 v[80:83], v1 offset:30720
  ds_read_b128 v[84:87], v1 offset:31744
  ds_read_b128 v[88:91], v1 offset:32768
  ds_read_b128 v[92:95], v1 offset:33792
  ds_read_b128 v[96:99], v1 offset:34816
  s_waitcnt lgkmcnt(5)
  v_mfma_f32_16x16x32_bf16 v[8:11], v[100:103], v[52:55], v[8:11]
  v_mfma_f32_16x16x32_bf16 v[12:15], v[104:107], v[52:55], v[12:15]
  v_mfma_f32_16x16x32_bf16 v[16:19], v[108:111], v[52:55], v[16:19]
  v_mfma_f32_16x16x32_bf16 v[20:23], v[112:115], v[52:55], v[20:23]
  v_mfma_f32_16x16x32_bf16 v[24:27], v[116:119], v[52:55], v[24:27]
  ds_read_b128 v[100:103], v1 offset:35840
  ds_read_b128 v[104:107], v1 offset:36864
  ds_read_b128 v[108:111], v1 offset:37888
  ds_read_b128 v[112:115], v1 offset:38912
  ds_read_b128 v[116:119], v1 offset:39936
  s_waitcnt lgkmcnt(5)
  v_mfma_f32_16x16x32_bf16 v[8:11], v[80:83], v[56:59], v[8:11]
  v_mfma_f32_16x16x32_bf16 v[12:15], v[84:87], v[56:59], v[12:15]
  v_mfma_f32_16x16x32_bf16 v[16:19], v[88:91], v[56:59], v[16:19]
  v_mfma_f32_16x16x32_bf16 v[20:23], v[92:95], v[56:59], v[20:23]
  v_mfma_f32_16x16x32_bf16 v[24:27], v[96:99], v[56:59], v[24:27]
  s_waitcnt lgkmcnt(0)
  v_mfma_f32_16x16x32_bf16 v[8:11], v[100:103], v[60:63], v[8:11]
  v_mfma_f32_16x16x32_bf16 v[12:15], v[104:107], v[60:63], v[12:15]
  v_mfma_f32_16x16x32_bf16 v[16:19], v[108:111], v[60:63], v[16:19]
  v_mfma_f32_16x16x32_bf16 v[20:23], v[112:115], v[60:63], v[20:23]
  v_mfma_f32_16x16x32_bf16 v[24:27], v[116:119], v[60:63], v[24:27]
  s_waitcnt vmcnt(9)
  s_barrier
  s_add_u32 m0, s29, 20480
  s_nop 0
  buffer_load_dwordx4 v2, s[4:7], s24 offen lds
  s_add_u32 m0, s29, 21504
  s_nop 0
  buffer_load_dwordx4 v2, s[4:7], s25 offen lds
  s_add_u32 m0, s29, 22528
  s_nop 0
  buffer_load_dwordx4 v2, s[4:7], s26 offen lds
  s_add_u32 m0, s29, 23552
  s_nop 0
  buffer_load_dwordx4 v2, s[4:7], s27 offen lds
  s_add_u32 m0, s29, 24576
  s_nop 0
  buffer_load_dwordx4 v2, s[4:7], s28 offen lds
  buffer_load_dwordx4 v[48:51], v1, s[4:7], s22 offen offset:0
  buffer_load_dwordx4 v[52:55], v1, s[4:7], s22 offen offset:1024
  buffer_load_dwordx4 v[56:59], v1, s[4:7], s22 offen offset:2048
  buffer_load_dwordx4 v[60:63], v1, s[4:7], s22 offen offset:3072
  v_add_u32 v2, 0x1000, v2
  s_add_u32 s22, s22, 4096
  ds_read_b128 v[80:83], v1 offset:40960
  ds_read_b128 v[84:87], v1 offset:41984
  ds_read_b128 v[88:91], v1 offset:43008
  ds_read_b128 v[92:95], v1 offset:44032
  ds_read_b128 v[96:99], v1 offset:45056
  ds_read_b128 v[100:103], v1 offset:46080
  ds_read_b128 v[104:107], v1 offset:47104
  ds_read_b128 v[108:111], v1 offset:48128
  ds_read_b128 v[112:115], v1 offset:49152
  ds_read_b128 v[116:119], v1 offset:50176
  s_waitcnt lgkmcnt(5)
  v_mfma_f32_16x16x32_bf16 v[8:11], v[80:83], v[64:67], v[8:11]
  v_mfma_f32_16x16x32_bf16 v[12:15], v[84:87], v[64:67], v[12:15]
  v_mfma_f32_16x16x32_bf16 v[16:19], v[88:91], v[64:67], v[16:19]
  v_mfma_f32_16x16x32_bf16 v[20:23], v[92:95], v[64:67], v[20:23]
  v_mfma_f32_16x16x32_bf16 v[24:27], v[96:99], v[64:67], v[24:27]
  ds_read_b128 v[80:83], v1 offset:51200
  ds_read_b128 v[84:87], v1 offset:52224
  ds_read_b128 v[88:91], v1 offset:53248
  ds_read_b128 v[92:95], v1 offset:54272
  ds_read_b128 v[96:99], v1 offset:55296
  s_waitcnt lgkmcnt(5)
  v_mfma_f32_16x16x32_bf16 v[8:11], v[100:103], v[68:71], v[8:11]
  v_mfma_f32_16x16x32_bf16 v[12:15], v[104:107], v[68:71], v[12:15]
  v_mfma_f32_16x16x32_bf16 v[16:19], v[108:111], v[68:71], v[16:19]
  v_mfma_f32_16x16x32_bf16 v[20:23], v[112:115], v[68:71], v[20:23]
  v_mfma_f32_16x16x32_bf16 v[24:27], v[116:119], v[68:71], v[24:27]
  ds_read_b128 v[100:103], v1 offset:56320
  ds_read_b128 v[104:107], v1 offset:57344
  ds_read_b128 v[108:111], v1 offset:58368
  ds_read_b128 v[112:115], v1 offset:59392
  ds_read_b128 v[116:119], v1 offset:60416
  s_waitcnt lgkmcnt(5)
  v_mfma_f32_16x16x32_bf16 v[8:11], v[80:83], v[72:75], v[8:11]
  v_mfma_f32_16x16x32_bf16 v[12:15], v[84:87], v[72:75], v[12:15]
  v_mfma_f32_16x16x32_bf16 v[16:19], v[88:91], v[72:75], v[16:19]
  v_mfma_f32_16x16x32_bf16 v[20:23], v[92:95], v[72:75], v[20:23]
  v_mfma_f32_16x16x32_bf16 v[24:27], v[96:99], v[72:75], v[24:27]
  s_waitcnt lgkmcnt(0)
  v_mfma_f32_16x16x32_bf16 v[8:11], v[100:103], v[76:79], v[8:11]
  v_mfma_f32_16x16x32_bf16 v[12:15], v[104:107], v[76:79], v[12:15]
  v_mfma_f32_16x16x32_bf16 v[16:19], v[108:111], v[76:79], v[16:19]
  v_mfma_f32_16x16x32_bf16 v[20:23], v[112:115], v[76:79], v[20:23]
  v_mfma_f32_16x16x32_bf16 v[24:27], v[116:119], v[76:79], v[24:27]
  s_waitcnt vmcnt(9)
  s_barrier
  s_add_u32 m0, s29, 40960
  s_nop 0
  buffer_load_dwordx4 v2, s[4:7], s24 offen lds
  s_add_u32 m0, s29, 41984
  s_nop 0
  buffer_load_dwordx4 v2, s[4:7], s25 offen lds
  s_add_u32 m0, s29, 43008
  s_nop 0
  buffer_load_dwordx4 v2, s[4:7], s26 offen lds
  s_add_u32 m0, s29, 44032
  s_nop 0
  buffer_load_dwordx4 v2, s[4:7], s27 offen lds
  s_add_u32 m0, s29, 45056
  s_nop 0
  buffer_load_dwordx4 v2, s[4:7], s28 offen lds
  buffer_load_dwordx4 v[64:67], v1, s[4:7], s22 offen offset:0
  buffer_load_dwordx4 v[68:71], v1, s[4:7], s22 offen offset:1024
  buffer_load_dwordx4 v[72:75], v1, s[4:7], s22 offen offset:2048
  buffer_load_dwordx4 v[76:79], v1, s[4:7], s22 offen offset:3072
  v_add_u32 v2, 0x1000, v2
  s_add_u32 s22, s22, 4096
  ds_read_b128 v[80:83], v1 offset:0
  ds_read_b128 v[84:87], v1 offset:1024
  ds_read_b128 v[88:91], v1 offset:2048
  ds_read_b128 v[92:95], v1 offset:3072
  ds_read_b128 v[96:99], v1 offset:4096
  ds_read_b128 v[100:103], v1 offset:5120
  ds_read_b128 v[104:107], v1 offset:6144
  ds_read_b128 v[108:111], v1 offset:7168
  ds_read_b128 v[112:115], v1 offset:8192
  ds_read_b128 v[116:119], v1 offset:9216
  s_waitcnt lgkmcnt(5)
  v_mfma_f32_16x16x32_bf16 v[8:11], v[80:83], v[32:35], v[8:11]
  v_mfma_f32_16x16x32_bf16 v[12:15], v[84:87], v[32:35], v[12:15]
  v_mfma_f32_16x16x32_bf16 v[16:19], v[88:91], v[32:35], v[16:19]
  v_mfma_f32_16x16x32_bf16 v[20:23], v[92:95], v[32:35], v[20:23]
  v_mfma_f32_16x16x32_bf16 v[24:27], v[96:99], v[32:35], v[24:27]
  ds_read_b128 v[80:83], v1 offset:10240
  ds_read_b128 v[84:87], v1 offset:11264
  ds_read_b128 v[88:91], v1 offset:12288
  ds_read_b128 v[92:95], v1 offset:13312
  ds_read_b128 v[96:99], v1 offset:14336
  s_waitcnt lgkmcnt(5)
  v_mfma_f32_16x16x32_bf16 v[8:11], v[100:103], v[36:39], v[8:11]
  v_mfma_f32_16x16x32_bf16 v[12:15], v[104:107], v[36:39], v[12:15]
  v_mfma_f32_16x16x32_bf16 v[16:19], v[108:111], v[36:39], v[16:19]
  v_mfma_f32_16x16x32_bf16 v[20:23], v[112:115], v[36:39], v[20:23]
  v_mfma_f32_16x16x32_bf16 v[24:27], v[116:119], v[36:39], v[24:27]
  ds_read_b128 v[100:103], v1 offset:15360
  ds_read_b128 v[104:107], v1 offset:16384
  ds_read_b128 v[108:111], v1 offset:17408
  ds_read_b128 v[112:115], v1 offset:18432
  ds_read_b128 v[116:119], v1 offset:19456
  s_waitcnt lgkmcnt(5)
  v_mfma_f32_16x16x32_bf16 v[8:11], v[80:83], v[40:43], v[8:11]
  v_mfma_f32_16x16x32_bf16 v[12:15], v[84:87], v[40:43], v[12:15]
  v_mfma_f32_16x16x32_bf16 v[16:19], v[88:91], v[40:43], v[16:19]
  v_mfma_f32_16x16x32_bf16 v[20:23], v[92:95], v[40:43], v[20:23]
  v_mfma_f32_16x16x32_bf16 v[24:27], v[96:99], v[40:43], v[24:27]
  s_waitcnt lgkmcnt(0)
  v_mfma_f32_16x16x32_bf16 v[8:11], v[100:103], v[44:47], v[8:11]
  v_mfma_f32_16x16x32_bf16 v[12:15], v[104:107], v[44:47], v[12:15]
  v_mfma_f32_16x16x32_bf16 v[16:19], v[108:111], v[44:47], v[16:19]
  v_mfma_f32_16x16x32_bf16 v[20:23], v[112:115], v[44:47], v[20:23]
  v_mfma_f32_16x16x32_bf16 v[24:27], v[116:119], v[44:47], v[24:27]
  s_add_u32 s30, s30, 1
  s_cmp_lt_u32 s30, 15
  s_cbranch_scc1 outa2_loop2
  s_waitcnt vmcnt(9)
  s_barrier
  ds_read_b128 v[80:83], v1 offset:20480
  ds_read_b128 v[84:87], v1 offset:21504
  ds_read_b128 v[88:91], v1 offset:22528
  ds_read_b128 v[92:95], v1 offset:23552
  ds_read_b128 v[96:99], v1 offset:24576
  ds_read_b128 v[100:103], v1 offset:25600
  ds_read_b128 v[104:107], v1 offset:26624
  ds_read_b128 v[108:111], v1 offset:27648
  ds_read_b128 v[112:115], v1 offset:28672
  ds_read_b128 v[116:119], v1 offset:29696
  s_waitcnt lgkmcnt(5)
  v_mfma_f32_16x16x32_bf16 v[8:11], v[80:83], v[48:51], v[8:11]
  v_mfma_f32_16x16x32_bf16 v[12:15], v[84:87], v[48:51], v[12:15]
  v_mfma_f32_16x16x32_bf16 v[16:19], v[88:91], v[48:51], v[16:19]
  v_mfma_f32_16x16x32_bf16 v[20:23], v[92:95], v[48:51], v[20:23]
  v_mfma_f32_16x16x32_bf16 v[24:27], v[96:99], v[48:51], v[24:27]
  ds_read_b128 v[80:83], v1 offset:30720
  ds_read_b128 v[84:87], v1 offset:31744
  ds_read_b128 v[88:91], v1 offset:32768
  ds_read_b128 v[92:95], v1 offset:33792
  ds_read_b128 v[96:99], v1 offset:34816
  s_waitcnt lgkmcnt(5)
  v_mfma_f32_16x16x32_bf16 v[8:11], v[100:103], v[52:55], v[8:11]
  v_mfma_f32_16x16x32_bf16 v[12:15], v[104:107], v[52:55], v[12:15]
  v_mfma_f32_16x16x32_bf16 v[16:19], v[108:111], v[52:55], v[16:19]
  v_mfma_f32_16x16x32_bf16 v[20:23], v[112:115], v[52:55], v[20:23]
  v_mfma_f32_16x16x32_bf16 v[24:27], v[116:119], v[52:55], v[24:27]
  ds_read_b128 v[100:103], v1 offset:35840
  ds_read_b128 v[104:107], v1 offset:36864
  ds_read_b128 v[108:111], v1 offset:37888
  ds_read_b128 v[112:115], v1 offset:38912
  ds_read_b128 v[116:119], v1 offset:39936
  s_waitcnt lgkmcnt(5)
  v_mfma_f32_16x16x32_bf16 v[8:11], v[80:83], v[56:59], v[8:11]
  v_mfma_f32_16x16x32_bf16 v[12:15], v[84:87], v[56:59], v[12:15]
  v_mfma_f32_16x16x32_bf16 v[16:19], v[88:91], v[56:59], v[16:19]
  v_mfma_f32_16x16x32_bf16 v[20:23], v[92:95], v[56:59], v[20:23]
  v_mfma_f32_16x16x32_bf16 v[24:27], v[96:99], v[56:59], v[24:27]
  s_waitcnt lgkmcnt(0)
  v_mfma_f32_16x16x32_bf16 v[8:11], v[100:103], v[60:63], v[8:11]
  v_mfma_f32_16x16x32_bf16 v[12:15], v[104:107], v[60:63], v[12:15]
  v_mfma_f32_16x16x32_bf16 v[16:19], v[108:111], v[60:63], v[16:19]
  v_mfma_f32_16x16x32_bf16 v[20:23], v[112:115], v[60:63], v[20:23]
  v_mfma_f32_16x16x32_bf16 v[24:27], v[116:119], v[60:63], v[24:27]
  s_waitcnt vmcnt(0)
  s_barrier
  ds_read_b128 v[80:83], v1 offset:40960
  ds_read_b128 v[84:87], v1 offset:41984
  ds_read_b128 v[88:91], v1 offset:43008
  ds_read_b128 v[92:95], v1 offset:44032
  ds_read_b128 v[96:99], v1 offset:45056
  ds_read_b128 v[100:103], v1 offset:46080
  ds_read_b128 v[104:107], v1 offset:47104
  ds_read_b128 v[108:111], v1 offset:48128
  ds_read_b128 v[112:115], v1 offset:49152
  ds_read_b128 v[116:119], v1 offset:50176
  s_waitcnt lgkmcnt(5)
  v_mfma_f32_16x16x32_bf16 v[8:11], v[80:83], v[64:67], v[8:11]
  v_mfma_f32_16x16x32_bf16 v[12:15], v[84:87], v[64:67], v[12:15]
  v_mfma_f32_16x16x32_bf16 v[16:19], v[88:91], v[64:67], v[16:19]
  v_mfma_f32_16x16x32_bf16 v[20:23], v[92:95], v[64:67], v[20:23]
  v_mfma_f32_16x16x32_bf16 v[24:27], v[96:99], v[64:67], v[24:27]
  ds_read_b128 v[80:83], v1 offset:51200
  ds_read_b128 v[84:87], v1 offset:52224
  ds_read_b128 v[88:91], v1 offset:53248
  ds_read_b128 v[92:95], v1 offset:54272
  ds_read_b128 v[96:99], v1 offset:55296
  s_waitcnt lgkmcnt(5)
  v_mfma_f32_16x16x32_bf16 v[8:11], v[100:103], v[68:71], v[8:11]
  v_mfma_f32_16x16x32_bf16 v[12:15], v[104:107], v[68:71], v[12:15]
  v_mfma_f32_16x16x32_bf16 v[16:19], v[108:111], v[68:71], v[16:19]
  v_mfma_f32_16x16x32_bf16 v[20:23], v[112:115], v[68:71], v[20:23]
  v_mfma_f32_16x16x32_bf16 v[24:27], v[116:119], v[68:71], v[24:27]
  ds_read_b128 v[100:103], v1 offset:56320
  ds_read_b128 v[104:107], v1 offset:57344
  ds_read_b128 v[108:111], v1 offset:58368
  ds_read_b128 v[112:115], v1 offset:59392
  ds_read_b128 v[116:119], v1 offset:60416
  s_waitcnt lgkmcnt(5)
  v_mfma_f32_16x16x32_bf16 v[8:11], v[80:83], v[72:75], v[8:11]
  v_mfma_f32_16x16x32_bf16 v[12:15], v[84:87], v[72:75], v[12:15]
  v_mfma_f32_16x16x32_bf16 v[16:19], v[88:91], v[72:75], v[16:19]
  v_mfma_f32_16x16x32_bf16 v[20:23], v[92:95], v[72:75], v[20:23]
  v_mfma_f32_16x16x32_bf16 v[24:27], v[96:99], v[72:75], v[24:27]
  s_waitcnt lgkmcnt(0)
  v_mfma_f32_16x16x32_bf16 v[8:11], v[100:103], v[76:79], v[8:11]
  v_mfma_f32_16x16x32_bf16 v[12:15], v[104:107], v[76:79], v[12:15]
  v_mfma_f32_16x16x32_bf16 v[16:19], v[108:111], v[76:79], v[16:19]
  v_mfma_f32_16x16x32_bf16 v[20:23], v[112:115], v[76:79], v[20:23]
  v_mfma_f32_16x16x32_bf16 v[24:27], v[116:119], v[76:79], v[24:27]
  v_and_b32 v3, 63, v0
  v_and_b32 v4, 15, v3
  v_lshrrev_b32 v3, 4, v3
  s_lshl_b32 s21, s17, 6
  s_lshl_b32 s23, s16, 4
  s_add_u32 s21, s21, s23
  v_add_u32 v4, s21, v4
  v_mul_u32_u24 v6, 1280, v4
  v_lshl_add_u32 v6, v3, 4, v6
  s_mul_i32 s21, s18, 5
  s_add_u32 s23, s21, 0
  s_lshr_b32 s31, s23, 1
  s_lshl_b32 s31, s31, 6
  s_and_b32 s23, s23, 1
  s_lshl_b32 s23, s23, 3
  s_add_u32 s32, s31, s23
  s_add_u32 s40, s32, s20
  buffer_load_dwordx2 v[32:33], v6, s[8:11], s40 offen
  s_add_u32 s23, s21, 1
  s_lshr_b32 s31, s23, 1
  s_lshl_b32 s31, s31, 6
  s_and_b32 s23, s23, 1
  s_lshl_b32 s23, s23, 3
  s_add_u32 s33, s31, s23
  s_add_u32 s41, s33, s20
  buffer_load_dwordx2 v[34:35], v6, s[8:11], s41 offen
  s_add_u32 s23, s21, 2
  s_lshr_b32 s31, s23, 1
  s_lshl_b32 s31, s31, 6
  s_and_b32 s23, s23, 1
  s_lshl_b32 s23, s23, 3
  s_add_u32 s34, s31, s23
  s_add_u32 s42, s34, s20
  buffer_load_dwordx2 v[36:37], v6, s[8:11], s42 offen
  s_add_u32 s23, s21, 3
  s_lshr_b32 s31, s23, 1
  s_lshl_b32 s31, s31, 6
  s_and_b32 s23, s23, 1
  s_lshl_b32 s23, s23, 3
  s_add_u32 s35, s31, s23
  s_add_u32 s43, s35, s20
  buffer_load_dwordx2 v[38:39], v6, s[8:11], s43 offen
  s_add_u32 s23, s21, 4
  s_lshr_b32 s31, s23, 1
  s_lshl_b32 s31, s31, 6
  s_and_b32 s23, s23, 1
  s_lshl_b32 s23, s23, 3
  s_add_u32 s36, s31, s23
  s_add_u32 s44, s36, s20
  buffer_load_dwordx2 v[40:41], v6, s[8:11], s44 offen
  s_waitcnt vmcnt(0)
  v_cvt_pk_bf16_f32 v80, v8, v9
  v_cvt_pk_bf16_f32 v81, v10, v11
  v_lshlrev_b32 v8, 16, v80
  v_and_b32 v9, 0xffff0000, v80
  v_lshlrev_b32 v10, 16, v81
  v_and_b32 v11, 0xffff0000, v81
  v_lshlrev_b32 v82, 16, v32
  v_and_b32 v83, 0xffff0000, v32
  v_lshlrev_b32 v84, 16, v33
  v_and_b32 v85, 0xffff0000, v33
  v_add_f32 v8, v8, v82
  v_add_f32 v9, v9, v83
  v_add_f32 v10, v10, v84
  v_add_f32 v11, v11, v85
  v_cvt_pk_bf16_f32 v32, v8, v9
  v_cvt_pk_bf16_f32 v33, v10, v11
  s_add_u32 s23, s32, 150994944
  buffer_store_dwordx2 v[32:33], v6, s[4:7], s23 offen
  v_cvt_pk_bf16_f32 v80, v12, v13
  v_cvt_pk_bf16_f32 v81, v14, v15
  v_lshlrev_b32 v12, 16, v80
  v_and_b32 v13, 0xffff0000, v80
  v_lshlrev_b32 v14, 16, v81
  v_and_b32 v15, 0xffff0000, v81
  v_lshlrev_b32 v82, 16, v34
  v_and_b32 v83, 0xffff0000, v34
  v_lshlrev_b32 v84, 16, v35
  v_and_b32 v85, 0xffff0000, v35
  v_add_f32 v12, v12, v82
  v_add_f32 v13, v13, v83
  v_add_f32 v14, v14, v84
  v_add_f32 v15, v15, v85
  v_cvt_pk_bf16_f32 v34, v12, v13
  v_cvt_pk_bf16_f32 v35, v14, v15
  s_add_u32 s23, s33, 150994944
  buffer_store_dwordx2 v[34:35], v6, s[4:7], s23 offen
  v_cvt_pk_bf16_f32 v80, v16, v17
  v_cvt_pk_bf16_f32 v81, v18, v19
  v_lshlrev_b32 v16, 16, v80
  v_and_b32 v17, 0xffff0000, v80
  v_lshlrev_b32 v18, 16, v81
  v_and_b32 v19, 0xffff0000, v81
  v_lshlrev_b32 v82, 16, v36
  v_and_b32 v83, 0xffff0000, v36
  v_lshlrev_b32 v84, 16, v37
  v_and_b32 v85, 0xffff0000, v37
  v_add_f32 v16, v16, v82
  v_add_f32 v17, v17, v83
  v_add_f32 v18, v18, v84
  v_add_f32 v19, v19, v85
  v_cvt_pk_bf16_f32 v36, v16, v17
  v_cvt_pk_bf16_f32 v37, v18, v19
  s_add_u32 s23, s34, 150994944
  buffer_store_dwordx2 v[36:37], v6, s[4:7], s23 offen
  v_cvt_pk_bf16_f32 v80, v20, v21
  v_cvt_pk_bf16_f32 v81, v22, v23
  v_lshlrev_b32 v20, 16, v80
  v_and_b32 v21, 0xffff0000, v80
  v_lshlrev_b32 v22, 16, v81
  v_and_b32 v23, 0xffff0000, v81
  v_lshlrev_b32 v82, 16, v38
  v_and_b32 v83, 0xffff0000, v38
  v_lshlrev_b32 v84, 16, v39
  v_and_b32 v85, 0xffff0000, v39
  v_add_f32 v20, v20, v82
  v_add_f32 v21, v21, v83
  v_add_f32 v22, v22, v84
  v_add_f32 v23, v23, v85
  v_cvt_pk_bf16_f32 v38, v20, v21
  v_cvt_pk_bf16_f32 v39, v22, v23
  s_add_u32 s23, s35, 150994944
  buffer_store_dwordx2 v[38:39], v6, s[4:7], s23 offen
  v_cvt_pk_bf16_f32 v80, v24, v25
  v_cvt_pk_bf16_f32 v81, v26, v27
  v_lshlrev_b32 v24, 16, v80
  v_and_b32 v25, 0xffff0000, v80
  v_lshlrev_b32 v26, 16, v81
  v_and_b32 v27, 0xffff0000, v81
  v_lshlrev_b32 v82, 16, v40
  v_and_b32 v83, 0xffff0000, v40
  v_lshlrev_b32 v84, 16, v41
  v_and_b32 v85, 0xffff0000, v41
  v_add_f32 v24, v24, v82
  v_add_f32 v25, v25, v83
  v_add_f32 v26, v26, v84
  v_add_f32 v27, v27, v85
  v_cvt_pk_bf16_f32 v40, v24, v25
  v_cvt_pk_bf16_f32 v41, v26, v27
  s_add_u32 s23, s36, 150994944
  buffer_store_dwordx2 v[40:41], v6, s[4:7], s23 offen
outa2_exit1:
  s_endpgm
.globl qkvb_kernel
.p2align 8
.type qkvb_kernel,@function
qkvb_kernel:
  s_cmp_ge_u32 s2, 256
  s_cbranch_scc1 qkvb_exit1
  s_load_dwordx2 s[12:13], s[0:1], 96
  v_lshrrev_b32 v2, 6, v0
  v_and_b32 v3, 63, v0
  s_nop 0
  v_readfirstlane_b32 s16, v2
  v_lshlrev_b32 v8, 4, v3
  s_and_b32 s17, s2, 7
  s_lshr_b32 s18, s2, 3
  s_waitcnt lgkmcnt(0)
  s_mov_b32 s4, s12
  s_mov_b32 s5, s13
  s_mov_b32 s6, 0x10000000
  s_mov_b32 s7, 0x20000
  s_and_b32 s19, s16, 1
  s_lshr_b32 s20, s16, 1
  v_and_b32 v2, 31, v3
  v_lshrrev_b32 v4, 5, v3
  s_lshl_b32 s21, s18, 6
  s_lshl_b32 s22, s19, 5
  s_add_u32 s21, s21, s22
  v_add_u32 v1, s21, v2
  v_mul_u32_u24 v1, 1280, v1
  v_lshl_add_u32 v1, v4, 4, v1
  s_mul_i32 s21, s20, 640
  s_add_u32 s21, s21, 150994944
  buffer_load_dwordx4 v[16:19], v1, s[4:7], s21 offen offset:0
  buffer_load_dwordx4 v[20:23], v1, s[4:7], s21 offen offset:32
  buffer_load_dwordx4 v[24:27], v1, s[4:7], s21 offen offset:64
  buffer_load_dwordx4 v[28:31], v1, s[4:7], s21 offen offset:96
  buffer_load_dwordx4 v[32:35], v1, s[4:7], s21 offen offset:128
  buffer_load_dwordx4 v[36:39], v1, s[4:7], s21 offen offset:160
  buffer_load_dwordx4 v[40:43], v1, s[4:7], s21 offen offset:192
  buffer_load_dwordx4 v[44:47], v1, s[4:7], s21 offen offset:224
  buffer_load_dwordx4 v[48:51], v1, s[4:7], s21 offen offset:256
  buffer_load_dwordx4 v[52:55], v1, s[4:7], s21 offen offset:288
  buffer_load_dwordx4 v[56:59], v1, s[4:7], s21 offen offset:320
  buffer_load_dwordx4 v[60:63], v1, s[4:7], s21 offen offset:352
  buffer_load_dwordx4 v[64:67], v1, s[4:7], s21 offen offset:384
  buffer_load_dwordx4 v[68:71], v1, s[4:7], s21 offen offset:416
  buffer_load_dwordx4 v[72:75], v1, s[4:7], s21 offen offset:448
  buffer_load_dwordx4 v[76:79], v1, s[4:7], s21 offen offset:480
  buffer_load_dwordx4 v[80:83], v1, s[4:7], s21 offen offset:512
  buffer_load_dwordx4 v[84:87], v1, s[4:7], s21 offen offset:544
  buffer_load_dwordx4 v[88:91], v1, s[4:7], s21 offen offset:576
  buffer_load_dwordx4 v[92:95], v1, s[4:7], s21 offen offset:608
  s_lshl_b32 s23, s17, 2
  s_add_u32 s23, s23, s16
  s_mul_i32 s24, s23, 40960
  s_add_u32 s24, s24, 156237824
  s_add_u32 s25, s24, 1310720
  s_add_u32 s26, s25, 1310720
  s_lshl_b32 s21, s19, 7
  s_add_u32 s21, s21, 81920
  v_lshlrev_b32 v5, 2, v2
  v_add_u32 v5, s21, v5
  s_lshl_b32 s21, s20, 8
  v_add_u32 v1, s21, v5
  s_waitcnt vmcnt(0)
  v_lshlrev_b32 v96, 16, v16
  v_and_b32 v97, 0xffff0000, v16
  v_lshlrev_b32 v98, 16, v17
  v_and_b32 v99, 0xffff0000, v17
  v_lshlrev_b32 v100, 16, v18
  v_and_b32 v101, 0xffff0000, v18
  v_lshlrev_b32 v102, 16, v19
  v_and_b32 v103, 0xffff0000, v19
  v_lshlrev_b32 v104, 16, v20
  v_and_b32 v105, 0xffff0000, v20
  v_lshlrev_b32 v106, 16, v21
  v_and_b32 v107, 0xffff0000, v21
  v_lshlrev_b32 v108, 16, v22
  v_and_b32 v109, 0xffff0000, v22
  v_lshlrev_b32 v110, 16, v23
  v_and_b32 v111, 0xffff0000, v23
  v_lshlrev_b32 v112, 16, v24
  v_and_b32 v113, 0xffff0000, v24
  v_lshlrev_b32 v114, 16, v25
  v_and_b32 v115, 0xffff0000, v25
  v_lshlrev_b32 v116, 16, v26
  v_and_b32 v117, 0xffff0000, v26
  v_lshlrev_b32 v118, 16, v27
  v_and_b32 v119, 0xffff0000, v27
  v_lshlrev_b32 v120, 16, v28
  v_and_b32 v121, 0xffff0000, v28
  v_lshlrev_b32 v122, 16, v29
  v_and_b32 v123, 0xffff0000, v29
  v_lshlrev_b32 v124, 16, v30
  v_and_b32 v125, 0xffff0000, v30
  v_lshlrev_b32 v126, 16, v31
  v_and_b32 v127, 0xffff0000, v31
  v_lshlrev_b32 v128, 16, v32
  v_and_b32 v129, 0xffff0000, v32
  v_lshlrev_b32 v130, 16, v33
  v_and_b32 v131, 0xffff0000, v33
  v_lshlrev_b32 v132, 16, v34
  v_and_b32 v133, 0xffff0000, v34
  v_lshlrev_b32 v134, 16, v35
  v_and_b32 v135, 0xffff0000, v35
  v_lshlrev_b32 v136, 16, v36
  v_and_b32 v137, 0xffff0000, v36
  v_lshlrev_b32 v138, 16, v37
  v_and_b32 v139, 0xffff0000, v37
  v_lshlrev_b32 v140, 16, v38
  v_and_b32 v141, 0xffff0000, v38
  v_lshlrev_b32 v142, 16, v39
  v_and_b32 v143, 0xffff0000, v39
  v_lshlrev_b32 v144, 16, v40
  v_and_b32 v145, 0xffff0000, v40
  v_lshlrev_b32 v146, 16, v41
  v_and_b32 v147, 0xffff0000, v41
  v_lshlrev_b32 v148, 16, v42
  v_and_b32 v149, 0xffff0000, v42
  v_lshlrev_b32 v150, 16, v43
  v_and_b32 v151, 0xffff0000, v43
  v_lshlrev_b32 v152, 16, v44
  v_and_b32 v153, 0xffff0000, v44
  v_lshlrev_b32 v154, 16, v45
  v_and_b32 v155, 0xffff0000, v45
  v_lshlrev_b32 v156, 16, v46
  v_and_b32 v157, 0xffff0000, v46
  v_lshlrev_b32 v158, 16, v47
  v_and_b32 v159, 0xffff0000, v47
  v_lshlrev_b32 v160, 16, v48
  v_and_b32 v161, 0xffff0000, v48
  v_lshlrev_b32 v162, 16, v49
  v_and_b32 v163, 0xffff0000, v49
  v_lshlrev_b32 v164, 16, v50
  v_and_b32 v165, 0xffff0000, v50
  v_lshlrev_b32 v166, 16, v51
  v_and_b32 v167, 0xffff0000, v51
  v_lshlrev_b32 v168, 16, v52
  v_and_b32 v169, 0xffff0000, v52
  v_lshlrev_b32 v170, 16, v53
  v_and_b32 v171, 0xffff0000, v53
  v_lshlrev_b32 v172, 16, v54
  v_and_b32 v173, 0xffff0000, v54
  v_lshlrev_b32 v174, 16, v55
  v_and_b32 v175, 0xffff0000, v55
  v_lshlrev_b32 v176, 16, v56
  v_and_b32 v177, 0xffff0000, v56
  v_lshlrev_b32 v178, 16, v57
  v_and_b32 v179, 0xffff0000, v57
  v_lshlrev_b32 v180, 16, v58
  v_and_b32 v181, 0xffff0000, v58
  v_lshlrev_b32 v182, 16, v59
  v_and_b32 v183, 0xffff0000, v59
  v_lshlrev_b32 v184, 16, v60
  v_and_b32 v185, 0xffff0000, v60
  v_lshlrev_b32 v186, 16, v61
  v_and_b32 v187, 0xffff0000, v61
  v_lshlrev_b32 v188, 16, v62
  v_and_b32 v189, 0xffff0000, v62
  v_lshlrev_b32 v190, 16, v63
  v_and_b32 v191, 0xffff0000, v63
  v_lshlrev_b32 v192, 16, v64
  v_and_b32 v193, 0xffff0000, v64
  v_lshlrev_b32 v194, 16, v65
  v_and_b32 v195, 0xffff0000, v65
  v_lshlrev_b32 v196, 16, v66
  v_and_b32 v197, 0xffff0000, v66
  v_lshlrev_b32 v198, 16, v67
  v_and_b32 v199, 0xffff0000, v67
  v_lshlrev_b32 v200, 16, v68
  v_and_b32 v201, 0xffff0000, v68
  v_lshlrev_b32 v202, 16, v69
  v_and_b32 v203, 0xffff0000, v69
  v_lshlrev_b32 v204, 16, v70
  v_and_b32 v205, 0xffff0000, v70
  v_lshlrev_b32 v206, 16, v71
  v_and_b32 v207, 0xffff0000, v71
  v_lshlrev_b32 v208, 16, v72
  v_and_b32 v209, 0xffff0000, v72
  v_lshlrev_b32 v210, 16, v73
  v_and_b32 v211, 0xffff0000, v73
  v_lshlrev_b32 v212, 16, v74
  v_and_b32 v213, 0xffff0000, v74
  v_lshlrev_b32 v214, 16, v75
  v_and_b32 v215, 0xffff0000, v75
  v_lshlrev_b32 v216, 16, v76
  v_and_b32 v217, 0xffff0000, v76
  v_lshlrev_b32 v218, 16, v77
  v_and_b32 v219, 0xffff0000, v77
  v_lshlrev_b32 v220, 16, v78
  v_and_b32 v221, 0xffff0000, v78
  v_lshlrev_b32 v222, 16, v79
  v_and_b32 v223, 0xffff0000, v79
  v_lshlrev_b32 v224, 16, v80
  v_and_b32 v225, 0xffff0000, v80
  v_lshlrev_b32 v226, 16, v81
  v_and_b32 v227, 0xffff0000, v81
  v_lshlrev_b32 v228, 16, v82
  v_and_b32 v229, 0xffff0000, v82
  v_lshlrev_b32 v230, 16, v83
  v_and_b32 v231, 0xffff0000, v83
  v_lshlrev_b32 v232, 16, v84
  v_and_b32 v233, 0xffff0000, v84
  v_lshlrev_b32 v234, 16, v85
  v_and_b32 v235, 0xffff0000, v85
  v_lshlrev_b32 v236, 16, v86
  v_and_b32 v237, 0xffff0000, v86
  v_lshlrev_b32 v238, 16, v87
  v_and_b32 v239, 0xffff0000, v87
  v_lshlrev_b32 v240, 16, v88
  v_and_b32 v241, 0xffff0000, v88
  v_lshlrev_b32 v242, 16, v89
  v_and_b32 v243, 0xffff0000, v89
  v_lshlrev_b32 v244, 16, v90
  v_and_b32 v245, 0xffff0000, v90
  v_lshlrev_b32 v246, 16, v91
  v_and_b32 v247, 0xffff0000, v91
  v_lshlrev_b32 v248, 16, v92
  v_and_b32 v249, 0xffff0000, v92
  v_lshlrev_b32 v250, 16, v93
  v_and_b32 v251, 0xffff0000, v93
  v_lshlrev_b32 v252, 16, v94
  v_and_b32 v253, 0xffff0000, v94
  v_lshlrev_b32 v254, 16, v95
  v_and_b32 v255, 0xffff0000, v95
  v_pk_add_f32 v[6:7], v[96:97], v[98:99]
  v_pk_add_f32 v[6:7], v[6:7], v[100:101]
  v_pk_add_f32 v[6:7], v[6:7], v[102:103]
  v_pk_add_f32 v[6:7], v[6:7], v[104:105]
  v_pk_add_f32 v[6:7], v[6:7], v[106:107]
  v_pk_add_f32 v[6:7], v[6:7], v[108:109]
  v_pk_add_f32 v[6:7], v[6:7], v[110:111]
  v_pk_add_f32 v[6:7], v[6:7], v[112:113]
  v_pk_add_f32 v[6:7], v[6:7], v[114:115]
  v_pk_add_f32 v[6:7], v[6:7], v[116:117]
  v_pk_add_f32 v[6:7], v[6:7], v[118:119]
  v_pk_add_f32 v[6:7], v[6:7], v[120:121]
  v_pk_add_f32 v[6:7], v[6:7], v[122:123]
  v_pk_add_f32 v[6:7], v[6:7], v[124:125]
  v_pk_add_f32 v[6:7], v[6:7], v[126:127]
  v_pk_add_f32 v[6:7], v[6:7], v[128:129]
  v_pk_add_f32 v[6:7], v[6:7], v[130:131]
  v_pk_add_f32 v[6:7], v[6:7], v[132:133]
  v_pk_add_f32 v[6:7], v[6:7], v[134:135]
  v_pk_add_f32 v[6:7], v[6:7], v[136:137]
  v_pk_add_f32 v[6:7], v[6:7], v[138:139]
  v_pk_add_f32 v[6:7], v[6:7], v[140:141]
  v_pk_add_f32 v[6:7], v[6:7], v[142:143]
  v_pk_add_f32 v[6:7], v[6:7], v[144:145]
  v_pk_add_f32 v[6:7], v[6:7], v[146:147]
  v_pk_add_f32 v[6:7], v[6:7], v[148:149]
  v_pk_add_f32 v[6:7], v[6:7], v[150:151]
  v_pk_add_f32 v[6:7], v[6:7], v[152:153]
  v_pk_add_f32 v[6:7], v[6:7], v[154:155]
  v_pk_add_f32 v[6:7], v[6:7], v[156:157]
  v_pk_add_f32 v[6:7], v[6:7], v[158:159]
  v_pk_add_f32 v[6:7], v[6:7], v[160:161]
  v_pk_add_f32 v[6:7], v[6:7], v[162:163]
  v_pk_add_f32 v[6:7], v[6:7], v[164:165]
  v_pk_add_f32 v[6:7], v[6:7], v[166:167]
  v_pk_add_f32 v[6:7], v[6:7], v[168:169]
  v_pk_add_f32 v[6:7], v[6:7], v[170:171]
  v_pk_add_f32 v[6:7], v[6:7], v[172:173]
  v_pk_add_f32 v[6:7], v[6:7], v[174:175]
  v_pk_add_f32 v[6:7], v[6:7], v[176:177]
  v_pk_add_f32 v[6:7], v[6:7], v[178:179]
  v_pk_add_f32 v[6:7], v[6:7], v[180:181]
  v_pk_add_f32 v[6:7], v[6:7], v[182:183]
  v_pk_add_f32 v[6:7], v[6:7], v[184:185]
  v_pk_add_f32 v[6:7], v[6:7], v[186:187]
  v_pk_add_f32 v[6:7], v[6:7], v[188:189]
  v_pk_add_f32 v[6:7], v[6:7], v[190:191]
  v_pk_add_f32 v[6:7], v[6:7], v[192:193]
  v_pk_add_f32 v[6:7], v[6:7], v[194:195]
  v_pk_add_f32 v[6:7], v[6:7], v[196:197]
  v_pk_add_f32 v[6:7], v[6:7], v[198:199]
  v_pk_add_f32 v[6:7], v[6:7], v[200:201]
  v_pk_add_f32 v[6:7], v[6:7], v[202:203]
  v_pk_add_f32 v[6:7], v[6:7], v[204:205]
  v_pk_add_f32 v[6:7], v[6:7], v[206:207]
  v_pk_add_f32 v[6:7], v[6:7], v[208:209]
  v_pk_add_f32 v[6:7], v[6:7], v[210:211]
  v_pk_add_f32 v[6:7], v[6:7], v[212:213]
  v_pk_add_f32 v[6:7], v[6:7], v[214:215]
  v_pk_add_f32 v[6:7], v[6:7], v[216:217]
  v_pk_add_f32 v[6:7], v[6:7], v[218:219]
  v_pk_add_f32 v[6:7], v[6:7], v[220:221]
  v_pk_add_f32 v[6:7], v[6:7], v[222:223]
  v_pk_add_f32 v[6:7], v[6:7], v[224:225]
  v_pk_add_f32 v[6:7], v[6:7], v[226:227]
  v_pk_add_f32 v[6:7], v[6:7], v[228:229]
  v_pk_add_f32 v[6:7], v[6:7], v[230:231]
  v_pk_add_f32 v[6:7], v[6:7], v[232:233]
  v_pk_add_f32 v[6:7], v[6:7], v[234:235]
  v_pk_add_f32 v[6:7], v[6:7], v[236:237]
  v_pk_add_f32 v[6:7], v[6:7], v[238:239]
  v_pk_add_f32 v[6:7], v[6:7], v[240:241]
  v_pk_add_f32 v[6:7], v[6:7], v[242:243]
  v_pk_add_f32 v[6:7], v[6:7], v[244:245]
  v_pk_add_f32 v[6:7], v[6:7], v[246:247]
  v_pk_add_f32 v[6:7], v[6:7], v[248:249]
  v_pk_add_f32 v[6:7], v[6:7], v[250:251]
  v_pk_add_f32 v[6:7], v[6:7], v[252:253]
  v_pk_add_f32 v[6:7], v[6:7], v[254:255]
  v_add_f32 v4, v6, v7
  v_mov_b32 v2, v4
  s_nop 1
  v_permlane32_swap_b32 v4, v2
  v_add_f32 v4, v4, v2
  ds_write_b32 v1, v4 offset:0
  s_waitcnt lgkmcnt(0)
  s_barrier
  ds_read_b32 v4, v5 offset:0
  ds_read_b32 v2, v5 offset:256
  s_waitcnt lgkmcnt(0)
  v_add_f32 v4, v4, v2
  v_mul_f32 v4, 0x3acccccd, v4
  v_sub_f32 v96, v96, v4
  v_sub_f32 v97, v97, v4
  v_sub_f32 v98, v98, v4
  v_sub_f32 v99, v99, v4
  v_sub_f32 v100, v100, v4
  v_sub_f32 v101, v101, v4
  v_sub_f32 v102, v102, v4
  v_sub_f32 v103, v103, v4
  v_sub_f32 v104, v104, v4
  v_sub_f32 v105, v105, v4
  v_sub_f32 v106, v106, v4
  v_sub_f32 v107, v107, v4
  v_sub_f32 v108, v108, v4
  v_sub_f32 v109, v109, v4
  v_sub_f32 v110, v110, v4
  v_sub_f32 v111, v111, v4
  v_sub_f32 v112, v112, v4
  v_sub_f32 v113, v113, v4
  v_sub_f32 v114, v114, v4
  v_sub_f32 v115, v115, v4
  v_sub_f32 v116, v116, v4
  v_sub_f32 v117, v117, v4
  v_sub_f32 v118, v118, v4
  v_sub_f32 v119, v119, v4
  v_sub_f32 v120, v120, v4
  v_sub_f32 v121, v121, v4
  v_sub_f32 v122, v122, v4
  v_sub_f32 v123, v123, v4
  v_sub_f32 v124, v124, v4
  v_sub_f32 v125, v125, v4
  v_sub_f32 v126, v126, v4
  v_sub_f32 v127, v127, v4
  v_sub_f32 v128, v128, v4
  v_sub_f32 v129, v129, v4
  v_sub_f32 v130, v130, v4
  v_sub_f32 v131, v131, v4
  v_sub_f32 v132, v132, v4
  v_sub_f32 v133, v133, v4
  v_sub_f32 v134, v134, v4
  v_sub_f32 v135, v135, v4
  v_sub_f32 v136, v136, v4
  v_sub_f32 v137, v137, v4
  v_sub_f32 v138, v138, v4
  v_sub_f32 v139, v139, v4
  v_sub_f32 v140, v140, v4
  v_sub_f32 v141, v141, v4
  v_sub_f32 v142, v142, v4
  v_sub_f32 v143, v143, v4
  v_sub_f32 v144, v144, v4
  v_sub_f32 v145, v145, v4
  v_sub_f32 v146, v146, v4
  v_sub_f32 v147, v147, v4
  v_sub_f32 v148, v148, v4
  v_sub_f32 v149, v149, v4
  v_sub_f32 v150, v150, v4
  v_sub_f32 v151, v151, v4
  v_sub_f32 v152, v152, v4
  v_sub_f32 v153, v153, v4
  v_sub_f32 v154, v154, v4
  v_sub_f32 v155, v155, v4
  v_sub_f32 v156, v156, v4
  v_sub_f32 v157, v157, v4
  v_sub_f32 v158, v158, v4
  v_sub_f32 v159, v159, v4
  v_sub_f32 v160, v160, v4
  v_sub_f32 v161, v161, v4
  v_sub_f32 v162, v162, v4
  v_sub_f32 v163, v163, v4
  v_sub_f32 v164, v164, v4
  v_sub_f32 v165, v165, v4
  v_sub_f32 v166, v166, v4
  v_sub_f32 v167, v167, v4
  v_sub_f32 v168, v168, v4
  v_sub_f32 v169, v169, v4
  v_sub_f32 v170, v170, v4
  v_sub_f32 v171, v171, v4
  v_sub_f32 v172, v172, v4
  v_sub_f32 v173, v173, v4
  v_sub_f32 v174, v174, v4
  v_sub_f32 v175, v175, v4
  v_sub_f32 v176, v176, v4
  v_sub_f32 v177, v177, v4
  v_sub_f32 v178, v178, v4
  v_sub_f32 v179, v179, v4
  v_sub_f32 v180, v180, v4
  v_sub_f32 v181, v181, v4
  v_sub_f32 v182, v182, v4
  v_sub_f32 v183, v183, v4
  v_sub_f32 v184, v184, v4
  v_sub_f32 v185, v185, v4
  v_sub_f32 v186, v186, v4
  v_sub_f32 v187, v187, v4
  v_sub_f32 v188, v188, v4
  v_sub_f32 v189, v189, v4
  v_sub_f32 v190, v190, v4
  v_sub_f32 v191, v191, v4
  v_sub_f32 v192, v192, v4
  v_sub_f32 v193, v193, v4
  v_sub_f32 v194, v194, v4
  v_sub_f32 v195, v195, v4
  v_sub_f32 v196, v196, v4
  v_sub_f32 v197, v197, v4
  v_sub_f32 v198, v198, v4
  v_sub_f32 v199, v199, v4
  v_sub_f32 v200, v200, v4
  v_sub_f32 v201, v201, v4
  v_sub_f32 v202, v202, v4
  v_sub_f32 v203, v203, v4
  v_sub_f32 v204, v204, v4
  v_sub_f32 v205, v205, v4
  v_sub_f32 v206, v206, v4
  v_sub_f32 v207, v207, v4
  v_sub_f32 v208, v208, v4
  v_sub_f32 v209, v209, v4
  v_sub_f32 v210, v210, v4
  v_sub_f32 v211, v211, v4
  v_sub_f32 v212, v212, v4
  v_sub_f32 v213, v213, v4
  v_sub_f32 v214, v214, v4
  v_sub_f32 v215, v215, v4
  v_sub_f32 v216, v216, v4
  v_sub_f32 v217, v217, v4
  v_sub_f32 v218, v218, v4
  v_sub_f32 v219, v219, v4
  v_sub_f32 v220, v220, v4
  v_sub_f32 v221, v221, v4
  v_sub_f32 v222, v222, v4
  v_sub_f32 v223, v223, v4
  v_sub_f32 v224, v224, v4
  v_sub_f32 v225, v225, v4
  v_sub_f32 v226, v226, v4
  v_sub_f32 v227, v227, v4
  v_sub_f32 v228, v228, v4
  v_sub_f32 v229, v229, v4
  v_sub_f32 v230, v230, v4
  v_sub_f32 v231, v231, v4
  v_sub_f32 v232, v232, v4
  v_sub_f32 v233, v233, v4
  v_sub_f32 v234, v234, v4
  v_sub_f32 v235, v235, v4
  v_sub_f32 v236, v236, v4
  v_sub_f32 v237, v237, v4
  v_sub_f32 v238, v238, v4
  v_sub_f32 v239, v239, v4
  v_sub_f32 v240, v240, v4
  v_sub_f32 v241, v241, v4
  v_sub_f32 v242, v242, v4
  v_sub_f32 v243, v243, v4
  v_sub_f32 v244, v244, v4
  v_sub_f32 v245, v245, v4
  v_sub_f32 v246, v246, v4
  v_sub_f32 v247, v247, v4
  v_sub_f32 v248, v248, v4
  v_sub_f32 v249, v249, v4
  v_sub_f32 v250, v250, v4
  v_sub_f32 v251, v251, v4
  v_sub_f32 v252, v252, v4
  v_sub_f32 v253, v253, v4
  v_sub_f32 v254, v254, v4
  v_sub_f32 v255, v255, v4
  v_mul_f32 v6, v96, v96
  v_mul_f32 v7, v97, v97
  v_fmac_f32 v6, v98, v98
  v_fmac_f32 v7, v99, v99
  v_fmac_f32 v6, v100, v100
  v_fmac_f32 v7, v101, v101
  v_fmac_f32 v6, v102, v102
  v_fmac_f32 v7, v103, v103
  v_fmac_f32 v6, v104, v104
  v_fmac_f32 v7, v105, v105
  v_fmac_f32 v6, v106, v106
  v_fmac_f32 v7, v107, v107
  v_fmac_f32 v6, v108, v108
  v_fmac_f32 v7, v109, v109
  v_fmac_f32 v6, v110, v110
  v_fmac_f32 v7, v111, v111
  v_fmac_f32 v6, v112, v112
  v_fmac_f32 v7, v113, v113
  v_fmac_f32 v6, v114, v114
  v_fmac_f32 v7, v115, v115
  v_fmac_f32 v6, v116, v116
  v_fmac_f32 v7, v117, v117
  v_fmac_f32 v6, v118, v118
  v_fmac_f32 v7, v119, v119
  v_fmac_f32 v6, v120, v120
  v_fmac_f32 v7, v121, v121
  v_fmac_f32 v6, v122, v122
  v_fmac_f32 v7, v123, v123
  v_fmac_f32 v6, v124, v124
  v_fmac_f32 v7, v125, v125
  v_fmac_f32 v6, v126, v126
  v_fmac_f32 v7, v127, v127
  v_fmac_f32 v6, v128, v128
  v_fmac_f32 v7, v129, v129
  v_fmac_f32 v6, v130, v130
  v_fmac_f32 v7, v131, v131
  v_fmac_f32 v6, v132, v132
  v_fmac_f32 v7, v133, v133
  v_fmac_f32 v6, v134, v134
  v_fmac_f32 v7, v135, v135
  v_fmac_f32 v6, v136, v136
  v_fmac_f32 v7, v137, v137
  v_fmac_f32 v6, v138, v138
  v_fmac_f32 v7, v139, v139
  v_fmac_f32 v6, v140, v140
  v_fmac_f32 v7, v141, v141
  v_fmac_f32 v6, v142, v142
  v_fmac_f32 v7, v143, v143
  v_fmac_f32 v6, v144, v144
  v_fmac_f32 v7, v145, v145
  v_fmac_f32 v6, v146, v146
  v_fmac_f32 v7, v147, v147
  v_fmac_f32 v6, v148, v148
  v_fmac_f32 v7, v149, v149
  v_fmac_f32 v6, v150, v150
  v_fmac_f32 v7, v151, v151
  v_fmac_f32 v6, v152, v152
  v_fmac_f32 v7, v153, v153
  v_fmac_f32 v6, v154, v154
  v_fmac_f32 v7, v155, v155
  v_fmac_f32 v6, v156, v156
  v_fmac_f32 v7, v157, v157
  v_fmac_f32 v6, v158, v158
  v_fmac_f32 v7, v159, v159
  v_fmac_f32 v6, v160, v160
  v_fmac_f32 v7, v161, v161
  v_fmac_f32 v6, v162, v162
  v_fmac_f32 v7, v163, v163
  v_fmac_f32 v6, v164, v164
  v_fmac_f32 v7, v165, v165
  v_fmac_f32 v6, v166, v166
  v_fmac_f32 v7, v167, v167
  v_fmac_f32 v6, v168, v168
  v_fmac_f32 v7, v169, v169
  v_fmac_f32 v6, v170, v170
  v_fmac_f32 v7, v171, v171
  v_fmac_f32 v6, v172, v172
  v_fmac_f32 v7, v173, v173
  v_fmac_f32 v6, v174, v174
  v_fmac_f32 v7, v175, v175
  v_fmac_f32 v6, v176, v176
  v_fmac_f32 v7, v177, v177
  v_fmac_f32 v6, v178, v178
  v_fmac_f32 v7, v179, v179
  v_fmac_f32 v6, v180, v180
  v_fmac_f32 v7, v181, v181
  v_fmac_f32 v6, v182, v182
  v_fmac_f32 v7, v183, v183
  v_fmac_f32 v6, v184, v184
  v_fmac_f32 v7, v185, v185
  v_fmac_f32 v6, v186, v186
  v_fmac_f32 v7, v187, v187
  v_fmac_f32 v6, v188, v188
  v_fmac_f32 v7, v189, v189
  v_fmac_f32 v6, v190, v190
  v_fmac_f32 v7, v191, v191
  v_fmac_f32 v6, v192, v192
  v_fmac_f32 v7, v193, v193
  v_fmac_f32 v6, v194, v194
  v_fmac_f32 v7, v195, v195
  v_fmac_f32 v6, v196, v196
  v_fmac_f32 v7, v197, v197
  v_fmac_f32 v6, v198, v198
  v_fmac_f32 v7, v199, v199
  v_fmac_f32 v6, v200, v200
  v_fmac_f32 v7, v201, v201
  v_fmac_f32 v6, v202, v202
  v_fmac_f32 v7, v203, v203
  v_fmac_f32 v6, v204, v204
  v_fmac_f32 v7, v205, v205
  v_fmac_f32 v6, v206, v206
  v_fmac_f32 v7, v207, v207
  v_fmac_f32 v6, v208, v208
  v_fmac_f32 v7, v209, v209
  v_fmac_f32 v6, v210, v210
  v_fmac_f32 v7, v211, v211
  v_fmac_f32 v6, v212, v212
  v_fmac_f32 v7, v213, v213
  v_fmac_f32 v6, v214, v214
  v_fmac_f32 v7, v215, v215
  v_fmac_f32 v6, v216, v216
  v_fmac_f32 v7, v217, v217
  v_fmac_f32 v6, v218, v218
  v_fmac_f32 v7, v219, v219
  v_fmac_f32 v6, v220, v220
  v_fmac_f32 v7, v221, v221
  v_fmac_f32 v6, v222, v222
  v_fmac_f32 v7, v223, v223
  v_fmac_f32 v6, v224, v224
  v_fmac_f32 v7, v225, v225
  v_fmac_f32 v6, v226, v226
  v_fmac_f32 v7, v227, v227
  v_fmac_f32 v6, v228, v228
  v_fmac_f32 v7, v229, v229
  v_fmac_f32 v6, v230, v230
  v_fmac_f32 v7, v231, v231
  v_fmac_f32 v6, v232, v232
  v_fmac_f32 v7, v233, v233
  v_fmac_f32 v6, v234, v234
  v_fmac_f32 v7, v235, v235
  v_fmac_f32 v6, v236, v236
  v_fmac_f32 v7, v237, v237
  v_fmac_f32 v6, v238, v238
  v_fmac_f32 v7, v239, v239
  v_fmac_f32 v6, v240, v240
  v_fmac_f32 v7, v241, v241
  v_fmac_f32 v6, v242, v242
  v_fmac_f32 v7, v243, v243
  v_fmac_f32 v6, v244, v244
  v_fmac_f32 v7, v245, v245
  v_fmac_f32 v6, v246, v246
  v_fmac_f32 v7, v247, v247
  v_fmac_f32 v6, v248, v248
  v_fmac_f32 v7, v249, v249
  v_fmac_f32 v6, v250, v250
  v_fmac_f32 v7, v251, v251
  v_fmac_f32 v6, v252, v252
  v_fmac_f32 v7, v253, v253
  v_fmac_f32 v6, v254, v254
  v_fmac_f32 v7, v255, v255
  v_add_f32 v4, v6, v7
  v_mov_b32 v2, v4
  s_nop 1
  v_permlane32_swap_b32 v4, v2
  v_add_f32 v4, v4, v2
  ds_write_b32 v1, v4 offset:512
  s_waitcnt lgkmcnt(0)
  s_barrier
  ds_read_b32 v4, v5 offset:512
  ds_read_b32 v2, v5 offset:768
  s_waitcnt lgkmcnt(0)
  v_add_f32 v4, v4, v2
  v_mov_b32 v2, 0x3727c5ac
  v_fmac_f32 v2, 0x3acccccd, v4
  v_rsq_f32 v4, v2
  s_nop 0
  v_mul_f32 v96, v96, v4
  v_mul_f32 v97, v97, v4
  v_mul_f32 v98, v98, v4
  v_mul_f32 v99, v99, v4
  v_mul_f32 v100, v100, v4
  v_mul_f32 v101, v101, v4
  v_mul_f32 v102, v102, v4
  v_mul_f32 v103, v103, v4
  v_mul_f32 v104, v104, v4
  v_mul_f32 v105, v105, v4
  v_mul_f32 v106, v106, v4
  v_mul_f32 v107, v107, v4
  v_mul_f32 v108, v108, v4
  v_mul_f32 v109, v109, v4
  v_mul_f32 v110, v110, v4
  v_mul_f32 v111, v111, v4
  v_mul_f32 v112, v112, v4
  v_mul_f32 v113, v113, v4
  v_mul_f32 v114, v114, v4
  v_mul_f32 v115, v115, v4
  v_mul_f32 v116, v116, v4
  v_mul_f32 v117, v117, v4
  v_mul_f32 v118, v118, v4
  v_mul_f32 v119, v119, v4
  v_mul_f32 v120, v120, v4
  v_mul_f32 v121, v121, v4
  v_mul_f32 v122, v122, v4
  v_mul_f32 v123, v123, v4
  v_mul_f32 v124, v124, v4
  v_mul_f32 v125, v125, v4
  v_mul_f32 v126, v126, v4
  v_mul_f32 v127, v127, v4
  v_mul_f32 v128, v128, v4
  v_mul_f32 v129, v129, v4
  v_mul_f32 v130, v130, v4
  v_mul_f32 v131, v131, v4
  v_mul_f32 v132, v132, v4
  v_mul_f32 v133, v133, v4
  v_mul_f32 v134, v134, v4
  v_mul_f32 v135, v135, v4
  v_mul_f32 v136, v136, v4
  v_mul_f32 v137, v137, v4
  v_mul_f32 v138, v138, v4
  v_mul_f32 v139, v139, v4
  v_mul_f32 v140, v140, v4
  v_mul_f32 v141, v141, v4
  v_mul_f32 v142, v142, v4
  v_mul_f32 v143, v143, v4
  v_mul_f32 v144, v144, v4
  v_mul_f32 v145, v145, v4
  v_mul_f32 v146, v146, v4
  v_mul_f32 v147, v147, v4
  v_mul_f32 v148, v148, v4
  v_mul_f32 v149, v149, v4
  v_mul_f32 v150, v150, v4
  v_mul_f32 v151, v151, v4
  v_mul_f32 v152, v152, v4
  v_mul_f32 v153, v153, v4
  v_mul_f32 v154, v154, v4
  v_mul_f32 v155, v155, v4
  v_mul_f32 v156, v156, v4
  v_mul_f32 v157, v157, v4
  v_mul_f32 v158, v158, v4
  v_mul_f32 v159, v159, v4
  v_mul_f32 v160, v160, v4
  v_mul_f32 v161, v161, v4
  v_mul_f32 v162, v162, v4
  v_mul_f32 v163, v163, v4
  v_mul_f32 v164, v164, v4
  v_mul_f32 v165, v165, v4
  v_mul_f32 v166, v166, v4
  v_mul_f32 v167, v167, v4
  v_mul_f32 v168, v168, v4
  v_mul_f32 v169, v169, v4
  v_mul_f32 v170, v170, v4
  v_mul_f32 v171, v171, v4
  v_mul_f32 v172, v172, v4
  v_mul_f32 v173, v173, v4
  v_mul_f32 v174, v174, v4
  v_mul_f32 v175, v175, v4
  v_mul_f32 v176, v176, v4
  v_mul_f32 v177, v177, v4
  v_mul_f32 v178, v178, v4
  v_mul_f32 v179, v179, v4
  v_mul_f32 v180, v180, v4
  v_mul_f32 v181, v181, v4
  v_mul_f32 v182, v182, v4
  v_mul_f32 v183, v183, v4
  v_mul_f32 v184, v184, v4
  v_mul_f32 v185, v185, v4
  v_mul_f32 v186, v186, v4
  v_mul_f32 v187, v187, v4
  v_mul_f32 v188, v188, v4
  v_mul_f32 v189, v189, v4
  v_mul_f32 v190, v190, v4
  v_mul_f32 v191, v191, v4
  v_mul_f32 v192, v192, v4
  v_mul_f32 v193, v193, v4
  v_mul_f32 v194, v194, v4
  v_mul_f32 v195, v195, v4
  v_mul_f32 v196, v196, v4
  v_mul_f32 v197, v197, v4
  v_mul_f32 v198, v198, v4
  v_mul_f32 v199, v199, v4
  v_mul_f32 v200, v200, v4
  v_mul_f32 v201, v201, v4
  v_mul_f32 v202, v202, v4
  v_mul_f32 v203, v203, v4
  v_mul_f32 v204, v204, v4
  v_mul_f32 v205, v205, v4
  v_mul_f32 v206, v206, v4
  v_mul_f32 v207, v207, v4
  v_mul_f32 v208, v208, v4
  v_mul_f32 v209, v209, v4
  v_mul_f32 v210, v210, v4
  v_mul_f32 v211, v211, v4
  v_mul_f32 v212, v212, v4
  v_mul_f32 v213, v213, v4
  v_mul_f32 v214, v214, v4
  v_mul_f32 v215, v215, v4
  v_mul_f32 v216, v216, v4
  v_mul_f32 v217, v217, v4
  v_mul_f32 v218, v218, v4
  v_mul_f32 v219, v219, v4
  v_mul_f32 v220, v220, v4
  v_mul_f32 v221, v221, v4
  v_mul_f32 v222, v222, v4
  v_mul_f32 v223, v223, v4
  v_mul_f32 v224, v224, v4
  v_mul_f32 v225, v225, v4
  v_mul_f32 v226, v226, v4
  v_mul_f32 v227, v227, v4
  v_mul_f32 v228, v228, v4
  v_mul_f32 v229, v229, v4
  v_mul_f32 v230, v230, v4
  v_mul_f32 v231, v231, v4
  v_mul_f32 v232, v232, v4
  v_mul_f32 v233, v233, v4
  v_mul_f32 v234, v234, v4
  v_mul_f32 v235, v235, v4
  v_mul_f32 v236, v236, v4
  v_mul_f32 v237, v237, v4
  v_mul_f32 v238, v238, v4
  v_mul_f32 v239, v239, v4
  v_mul_f32 v240, v240, v4
  v_mul_f32 v241, v241, v4
  v_mul_f32 v242, v242, v4
  v_mul_f32 v243, v243, v4
  v_mul_f32 v244, v244, v4
  v_mul_f32 v245, v245, v4
  v_mul_f32 v246, v246, v4
  v_mul_f32 v247, v247, v4
  v_mul_f32 v248, v248, v4
  v_mul_f32 v249, v249, v4
  v_mul_f32 v250, v250, v4
  v_mul_f32 v251, v251, v4
  v_mul_f32 v252, v252, v4
  v_mul_f32 v253, v253, v4
  v_mul_f32 v254, v254, v4
  v_mul_f32 v255, v255, v4
  v_cvt_pk_bf16_f32 v16, v96, v97
  v_cvt_pk_bf16_f32 v17, v98, v99
  v_cvt_pk_bf16_f32 v18, v100, v101
  v_cvt_pk_bf16_f32 v19, v102, v103
  v_cvt_pk_bf16_f32 v20, v104, v105
  v_cvt_pk_bf16_f32 v21, v106, v107
  v_cvt_pk_bf16_f32 v22, v108, v109
  v_cvt_pk_bf16_f32 v23, v110, v111
  v_cvt_pk_bf16_f32 v24, v112, v113
  v_cvt_pk_bf16_f32 v25, v114, v115
  v_cvt_pk_bf16_f32 v26, v116, v117
  v_cvt_pk_bf16_f32 v27, v118, v119
  v_cvt_pk_bf16_f32 v28, v120, v121
  v_cvt_pk_bf16_f32 v29, v122, v123
  v_cvt_pk_bf16_f32 v30, v124, v125
  v_cvt_pk_bf16_f32 v31, v126, v127
  v_cvt_pk_bf16_f32 v32, v128, v129
  v_cvt_pk_bf16_f32 v33, v130, v131
  v_cvt_pk_bf16_f32 v34, v132, v133
  v_cvt_pk_bf16_f32 v35, v134, v135
  v_cvt_pk_bf16_f32 v36, v136, v137
  v_cvt_pk_bf16_f32 v37, v138, v139
  v_cvt_pk_bf16_f32 v38, v140, v141
  v_cvt_pk_bf16_f32 v39, v142, v143
  v_cvt_pk_bf16_f32 v40, v144, v145
  v_cvt_pk_bf16_f32 v41, v146, v147
  v_cvt_pk_bf16_f32 v42, v148, v149
  v_cvt_pk_bf16_f32 v43, v150, v151
  v_cvt_pk_bf16_f32 v44, v152, v153
  v_cvt_pk_bf16_f32 v45, v154, v155
  v_cvt_pk_bf16_f32 v46, v156, v157
  v_cvt_pk_bf16_f32 v47, v158, v159
  v_cvt_pk_bf16_f32 v48, v160, v161
  v_cvt_pk_bf16_f32 v49, v162, v163
  v_cvt_pk_bf16_f32 v50, v164, v165
  v_cvt_pk_bf16_f32 v51, v166, v167
  v_cvt_pk_bf16_f32 v52, v168, v169
  v_cvt_pk_bf16_f32 v53, v170, v171
  v_cvt_pk_bf16_f32 v54, v172, v173
  v_cvt_pk_bf16_f32 v55, v174, v175
  v_cvt_pk_bf16_f32 v56, v176, v177
  v_cvt_pk_bf16_f32 v57, v178, v179
  v_cvt_pk_bf16_f32 v58, v180, v181
  v_cvt_pk_bf16_f32 v59, v182, v183
  v_cvt_pk_bf16_f32 v60, v184, v185
  v_cvt_pk_bf16_f32 v61, v186, v187
  v_cvt_pk_bf16_f32 v62, v188, v189
  v_cvt_pk_bf16_f32 v63, v190, v191
  v_cvt_pk_bf16_f32 v64, v192, v193
  v_cvt_pk_bf16_f32 v65, v194, v195
  v_cvt_pk_bf16_f32 v66, v196, v197
  v_cvt_pk_bf16_f32 v67, v198, v199
  v_cvt_pk_bf16_f32 v68, v200, v201
  v_cvt_pk_bf16_f32 v69, v202, v203
  v_cvt_pk_bf16_f32 v70, v204, v205
  v_cvt_pk_bf16_f32 v71, v206, v207
  v_cvt_pk_bf16_f32 v72, v208, v209
  v_cvt_pk_bf16_f32 v73, v210, v211
  v_cvt_pk_bf16_f32 v74, v212, v213
  v_cvt_pk_bf16_f32 v75, v214, v215
  v_cvt_pk_bf16_f32 v76, v216, v217
  v_cvt_pk_bf16_f32 v77, v218, v219
  v_cvt_pk_bf16_f32 v78, v220, v221
  v_cvt_pk_bf16_f32 v79, v222, v223
  v_cvt_pk_bf16_f32 v80, v224, v225
  v_cvt_pk_bf16_f32 v81, v226, v227
  v_cvt_pk_bf16_f32 v82, v228, v229
  v_cvt_pk_bf16_f32 v83, v230, v231
  v_cvt_pk_bf16_f32 v84, v232, v233
  v_cvt_pk_bf16_f32 v85, v234, v235
  v_cvt_pk_bf16_f32 v86, v236, v237
  v_cvt_pk_bf16_f32 v87, v238, v239
  v_cvt_pk_bf16_f32 v88, v240, v241
  v_cvt_pk_bf16_f32 v89, v242, v243
  v_cvt_pk_bf16_f32 v90, v244, v245
  v_cvt_pk_bf16_f32 v91, v246, v247
  v_cvt_pk_bf16_f32 v92, v248, v249
  v_cvt_pk_bf16_f32 v93, v250, v251
  v_cvt_pk_bf16_f32 v94, v252, v253
  v_cvt_pk_bf16_f32 v95, v254, v255
  s_mul_i32 s21, s19, 40960
  s_mul_i32 s22, s20, 20480
  s_add_u32 s21, s21, s22
  v_add_u32 v1, s21, v8
  ds_write_b128 v1, v[16:19] offset:0
  ds_write_b128 v1, v[20:23] offset:1024
  ds_write_b128 v1, v[24:27] offset:2048
  ds_write_b128 v1, v[28:31] offset:3072
  ds_write_b128 v1, v[32:35] offset:4096
  ds_write_b128 v1, v[36:39] offset:5120
  ds_write_b128 v1, v[40:43] offset:6144
  ds_write_b128 v1, v[44:47] offset:7168
  ds_write_b128 v1, v[48:51] offset:8192
  ds_write_b128 v1, v[52:55] offset:9216
  ds_write_b128 v1, v[56:59] offset:10240
  ds_write_b128 v1, v[60:63] offset:11264
  ds_write_b128 v1, v[64:67] offset:12288
  ds_write_b128 v1, v[68:71] offset:13312
  ds_write_b128 v1, v[72:75] offset:14336
  ds_write_b128 v1, v[76:79] offset:15360
  ds_write_b128 v1, v[80:83] offset:16384
  ds_write_b128 v1, v[84:87] offset:17408
  ds_write_b128 v1, v[88:91] offset:18432
  ds_write_b128 v1, v[92:95] offset:19456
  v_add_u32 v9, 40960, v8
  s_waitcnt lgkmcnt(0)
  s_barrier
  buffer_load_dwordx4 v[192:195], v8, s[4:7], s24 offen offset:0
  buffer_load_dwordx4 v[196:199], v8, s[4:7], s25 offen offset:0
  buffer_load_dwordx4 v[200:203], v8, s[4:7], s26 offen offset:0
  buffer_load_dwordx4 v[204:207], v8, s[4:7], s24 offen offset:1024
  buffer_load_dwordx4 v[208:211], v8, s[4:7], s25 offen offset:1024
  buffer_load_dwordx4 v[212:215], v8, s[4:7], s26 offen offset:1024
  buffer_load_dwordx4 v[216:219], v8, s[4:7], s24 offen offset:2048
  buffer_load_dwordx4 v[220:223], v8, s[4:7], s25 offen offset:2048
  buffer_load_dwordx4 v[224:227], v8, s[4:7], s26 offen offset:2048
  ds_read_b128 v[16:19], v8 offset:0
  ds_read_b128 v[20:23], v9 offset:0
  ds_read_b128 v[24:27], v8 offset:1024
  ds_read_b128 v[28:31], v9 offset:1024
  buffer_load_dwordx4 v[228:231], v8, s[4:7], s24 offen offset:3072
  buffer_load_dwordx4 v[232:235], v8, s[4:7], s25 offen offset:3072
  buffer_load_dwordx4 v[236:239], v8, s[4:7], s26 offen offset:3072
  s_add_u32 s24, s24, 4096
  s_add_u32 s25, s25, 4096
  s_add_u32 s26, s26, 4096
  s_waitcnt vmcnt(9)
  ds_read_b128 v[32:35], v8 offset:2048
  ds_read_b128 v[36:39], v9 offset:2048
  s_waitcnt lgkmcnt(4)
  v_mfma_f32_32x32x16_bf16 v[96:111], v[192:195], v[16:19], 0
  v_mfma_f32_32x32x16_bf16 v[112:127], v[192:195], v[20:23], 0
  v_mfma_f32_32x32x16_bf16 v[128:143], v[196:199], v[16:19], 0
  v_mfma_f32_32x32x16_bf16 v[144:159], v[196:199], v[20:23], 0
  v_mfma_f32_32x32x16_bf16 v[160:175], v[16:19], v[200:203], 0
  v_mfma_f32_32x32x16_bf16 v[176:191], v[20:23], v[200:203], 0
  buffer_load_dwordx4 v[192:195], v8, s[4:7], s24 offen offset:0
  buffer_load_dwordx4 v[196:199], v8, s[4:7], s25 offen offset:0
  buffer_load_dwordx4 v[200:203], v8, s[4:7], s26 offen offset:0
  s_waitcnt vmcnt(9)
  ds_read_b128 v[16:19], v8 offset:3072
  ds_read_b128 v[20:23], v9 offset:3072
  s_waitcnt lgkmcnt(4)
  v_mfma_f32_32x32x16_bf16 v[96:111], v[204:207], v[24:27], v[96:111]
  v_mfma_f32_32x32x16_bf16 v[112:127], v[204:207], v[28:31], v[112:127]
  v_mfma_f32_32x32x16_bf16 v[128:143], v[208:211], v[24:27], v[128:143]
  v_mfma_f32_32x32x16_bf16 v[144:159], v[208:211], v[28:31], v[144:159]
  v_mfma_f32_32x32x16_bf16 v[160:175], v[24:27], v[212:215], v[160:175]
  v_mfma_f32_32x32x16_bf16 v[176:191], v[28:31], v[212:215], v[176:191]
  buffer_load_dwordx4 v[204:207], v8, s[4:7], s24 offen offset:1024
  buffer_load_dwordx4 v[208:211], v8, s[4:7], s25 offen offset:1024
  buffer_load_dwordx4 v[212:215], v8, s[4:7], s26 offen offset:1024
  s_waitcnt vmcnt(9)
  ds_read_b128 v[24:27], v8 offset:4096
  ds_read_b128 v[28:31], v9 offset:4096
  s_waitcnt lgkmcnt(4)
  v_mfma_f32_32x32x16_bf16 v[96:111], v[216:219], v[32:35], v[96:111]
  v_mfma_f32_32x32x16_bf16 v[112:127], v[216:219], v[36:39], v[112:127]
  v_mfma_f32_32x32x16_bf16 v[128:143], v[220:223], v[32:35], v[128:143]
  v_mfma_f32_32x32x16_bf16 v[144:159], v[220:223], v[36:39], v[144:159]
  v_mfma_f32_32x32x16_bf16 v[160:175], v[32:35], v[224:227], v[160:175]
  v_mfma_f32_32x32x16_bf16 v[176:191], v[36:39], v[224:227], v[176:191]
  buffer_load_dwordx4 v[216:219], v8, s[4:7], s24 offen offset:2048
  buffer_load_dwordx4 v[220:223], v8, s[4:7], s25 offen offset:2048
  buffer_load_dwordx4 v[224:227], v8, s[4:7], s26 offen offset:2048
  s_waitcnt vmcnt(9)
  ds_read_b128 v[32:35], v8 offset:5120
  ds_read_b128 v[36:39], v9 offset:5120
  s_waitcnt lgkmcnt(4)
  v_mfma_f32_32x32x16_bf16 v[96:111], v[228:231], v[16:19], v[96:111]
  v_mfma_f32_32x32x16_bf16 v[112:127], v[228:231], v[20:23], v[112:127]
  v_mfma_f32_32x32x16_bf16 v[128:143], v[232:235], v[16:19], v[128:143]
  v_mfma_f32_32x32x16_bf16 v[144:159], v[232:235], v[20:23], v[144:159]
  v_mfma_f32_32x32x16_bf16 v[160:175], v[16:19], v[236:239], v[160:175]
  v_mfma_f32_32x32x16_bf16 v[176:191], v[20:23], v[236:239], v[176:191]
  buffer_load_dwordx4 v[228:231], v8, s[4:7], s24 offen offset:3072
  buffer_load_dwordx4 v[232:235], v8, s[4:7], s25 offen offset:3072
  buffer_load_dwordx4 v[236:239], v8, s[4:7], s26 offen offset:3072
  s_add_u32 s24, s24, 4096
  s_add_u32 s25, s25, 4096
  s_add_u32 s26, s26, 4096
  s_waitcnt vmcnt(9)
  ds_read_b128 v[16:19], v8 offset:6144
  ds_read_b128 v[20:23], v9 offset:6144
  s_waitcnt lgkmcnt(4)
  v_mfma_f32_32x32x16_bf16 v[96:111], v[192:195], v[24:27], v[96:111]
  v_mfma_f32_32x32x16_bf16 v[112:127], v[192:195], v[28:31], v[112:127]
  v_mfma_f32_32x32x16_bf16 v[128:143], v[196:199], v[24:27], v[128:143]
  v_mfma_f32_32x32x16_bf16 v[144:159], v[196:199], v[28:31], v[144:159]
  v_mfma_f32_32x32x16_bf16 v[160:175], v[24:27], v[200:203], v[160:175]
  v_mfma_f32_32x32x16_bf16 v[176:191], v[28:31], v[200:203], v[176:191]
  buffer_load_dwordx4 v[192:195], v8, s[4:7], s24 offen offset:0
  buffer_load_dwordx4 v[196:199], v8, s[4:7], s25 offen offset:0
  buffer_load_dwordx4 v[200:203], v8, s[4:7], s26 offen offset:0
  s_waitcnt vmcnt(9)
  ds_read_b128 v[24:27], v8 offset:7168
  ds_read_b128 v[28:31], v9 offset:7168
  s_waitcnt lgkmcnt(4)
  v_mfma_f32_32x32x16_bf16 v[96:111], v[204:207], v[32:35], v[96:111]
  v_mfma_f32_32x32x16_bf16 v[112:127], v[204:207], v[36:39], v[112:127]
  v_mfma_f32_32x32x16_bf16 v[128:143], v[208:211], v[32:35], v[128:143]
  v_mfma_f32_32x32x16_bf16 v[144:159], v[208:211], v[36:39], v[144:159]
  v_mfma_f32_32x32x16_bf16 v[160:175], v[32:35], v[212:215], v[160:175]
  v_mfma_f32_32x32x16_bf16 v[176:191], v[36:39], v[212:215], v[176:191]
  buffer_load_dwordx4 v[204:207], v8, s[4:7], s24 offen offset:1024
  buffer_load_dwordx4 v[208:211], v8, s[4:7], s25 offen offset:1024
  buffer_load_dwordx4 v[212:215], v8, s[4:7], s26 offen offset:1024
  s_waitcnt vmcnt(9)
  ds_read_b128 v[32:35], v8 offset:8192
  ds_read_b128 v[36:39], v9 offset:8192
  s_waitcnt lgkmcnt(4)
  v_mfma_f32_32x32x16_bf16 v[96:111], v[216:219], v[16:19], v[96:111]
  v_mfma_f32_32x32x16_bf16 v[112:127], v[216:219], v[20:23], v[112:127]
  v_mfma_f32_32x32x16_bf16 v[128:143], v[220:223], v[16:19], v[128:143]
  v_mfma_f32_32x32x16_bf16 v[144:159], v[220:223], v[20:23], v[144:159]
  v_mfma_f32_32x32x16_bf16 v[160:175], v[16:19], v[224:227], v[160:175]
  v_mfma_f32_32x32x16_bf16 v[176:191], v[20:23], v[224:227], v[176:191]
  buffer_load_dwordx4 v[216:219], v8, s[4:7], s24 offen offset:2048
  buffer_load_dwordx4 v[220:223], v8, s[4:7], s25 offen offset:2048
  buffer_load_dwordx4 v[224:227], v8, s[4:7], s26 offen offset:2048
  s_waitcnt vmcnt(9)
  ds_read_b128 v[16:19], v8 offset:9216
  ds_read_b128 v[20:23], v9 offset:9216
  s_waitcnt lgkmcnt(4)
  v_mfma_f32_32x32x16_bf16 v[96:111], v[228:231], v[24:27], v[96:111]
  v_mfma_f32_32x32x16_bf16 v[112:127], v[228:231], v[28:31], v[112:127]
  v_mfma_f32_32x32x16_bf16 v[128:143], v[232:235], v[24:27], v[128:143]
  v_mfma_f32_32x32x16_bf16 v[144:159], v[232:235], v[28:31], v[144:159]
  v_mfma_f32_32x32x16_bf16 v[160:175], v[24:27], v[236:239], v[160:175]
  v_mfma_f32_32x32x16_bf16 v[176:191], v[28:31], v[236:239], v[176:191]
  buffer_load_dwordx4 v[228:231], v8, s[4:7], s24 offen offset:3072
  buffer_load_dwordx4 v[232:235], v8, s[4:7], s25 offen offset:3072
  buffer_load_dwordx4 v[236:239], v8, s[4:7], s26 offen offset:3072
  s_add_u32 s24, s24, 4096
  s_add_u32 s25, s25, 4096
  s_add_u32 s26, s26, 4096
  s_waitcnt vmcnt(9)
  ds_read_b128 v[24:27], v8 offset:10240
  ds_read_b128 v[28:31], v9 offset:10240
  s_waitcnt lgkmcnt(4)
  v_mfma_f32_32x32x16_bf16 v[96:111], v[192:195], v[32:35], v[96:111]
  v_mfma_f32_32x32x16_bf16 v[112:127], v[192:195], v[36:39], v[112:127]
  v_mfma_f32_32x32x16_bf16 v[128:143], v[196:199], v[32:35], v[128:143]
  v_mfma_f32_32x32x16_bf16 v[144:159], v[196:199], v[36:39], v[144:159]
  v_mfma_f32_32x32x16_bf16 v[160:175], v[32:35], v[200:203], v[160:175]
  v_mfma_f32_32x32x16_bf16 v[176:191], v[36:39], v[200:203], v[176:191]
  buffer_load_dwordx4 v[192:195], v8, s[4:7], s24 offen offset:0
  buffer_load_dwordx4 v[196:199], v8, s[4:7], s25 offen offset:0
  buffer_load_dwordx4 v[200:203], v8, s[4:7], s26 offen offset:0
  s_waitcnt vmcnt(9)
  ds_read_b128 v[32:35], v8 offset:11264
  ds_read_b128 v[36:39], v9 offset:11264
  s_waitcnt lgkmcnt(4)
  v_mfma_f32_32x32x16_bf16 v[96:111], v[204:207], v[16:19], v[96:111]
  v_mfma_f32_32x32x16_bf16 v[112:127], v[204:207], v[20:23], v[112:127]
  v_mfma_f32_32x32x16_bf16 v[128:143], v[208:211], v[16:19], v[128:143]
  v_mfma_f32_32x32x16_bf16 v[144:159], v[208:211], v[20:23], v[144:159]
  v_mfma_f32_32x32x16_bf16 v[160:175], v[16:19], v[212:215], v[160:175]
  v_mfma_f32_32x32x16_bf16 v[176:191], v[20:23], v[212:215], v[176:191]
  buffer_load_dwordx4 v[204:207], v8, s[4:7], s24 offen offset:1024
  buffer_load_dwordx4 v[208:211], v8, s[4:7], s25 offen offset:1024
  buffer_load_dwordx4 v[212:215], v8, s[4:7], s26 offen offset:1024
  s_waitcnt vmcnt(9)
  ds_read_b128 v[16:19], v8 offset:12288
  ds_read_b128 v[20:23], v9 offset:12288
  s_waitcnt lgkmcnt(4)
  v_mfma_f32_32x32x16_bf16 v[96:111], v[216:219], v[24:27], v[96:111]
  v_mfma_f32_32x32x16_bf16 v[112:127], v[216:219], v[28:31], v[112:127]
  v_mfma_f32_32x32x16_bf16 v[128:143], v[220:223], v[24:27], v[128:143]
  v_mfma_f32_32x32x16_bf16 v[144:159], v[220:223], v[28:31], v[144:159]
  v_mfma_f32_32x32x16_bf16 v[160:175], v[24:27], v[224:227], v[160:175]
  v_mfma_f32_32x32x16_bf16 v[176:191], v[28:31], v[224:227], v[176:191]
  buffer_load_dwordx4 v[216:219], v8, s[4:7], s24 offen offset:2048
  buffer_load_dwordx4 v[220:223], v8, s[4:7], s25 offen offset:2048
  buffer_load_dwordx4 v[224:227], v8, s[4:7], s26 offen offset:2048
  s_waitcnt vmcnt(9)
  ds_read_b128 v[24:27], v8 offset:13312
  ds_read_b128 v[28:31], v9 offset:13312
  s_waitcnt lgkmcnt(4)
  v_mfma_f32_32x32x16_bf16 v[96:111], v[228:231], v[32:35], v[96:111]
  v_mfma_f32_32x32x16_bf16 v[112:127], v[228:231], v[36:39], v[112:127]
  v_mfma_f32_32x32x16_bf16 v[128:143], v[232:235], v[32:35], v[128:143]
  v_mfma_f32_32x32x16_bf16 v[144:159], v[232:235], v[36:39], v[144:159]
  v_mfma_f32_32x32x16_bf16 v[160:175], v[32:35], v[236:239], v[160:175]
  v_mfma_f32_32x32x16_bf16 v[176:191], v[36:39], v[236:239], v[176:191]
  buffer_load_dwordx4 v[228:231], v8, s[4:7], s24 offen offset:3072
  buffer_load_dwordx4 v[232:235], v8, s[4:7], s25 offen offset:3072
  buffer_load_dwordx4 v[236:239], v8, s[4:7], s26 offen offset:3072
  s_add_u32 s24, s24, 4096
  s_add_u32 s25, s25, 4096
  s_add_u32 s26, s26, 4096
  s_waitcnt vmcnt(9)
  ds_read_b128 v[32:35], v8 offset:14336
  ds_read_b128 v[36:39], v9 offset:14336
  s_waitcnt lgkmcnt(4)
  v_mfma_f32_32x32x16_bf16 v[96:111], v[192:195], v[16:19], v[96:111]
  v_mfma_f32_32x32x16_bf16 v[112:127], v[192:195], v[20:23], v[112:127]
  v_mfma_f32_32x32x16_bf16 v[128:143], v[196:199], v[16:19], v[128:143]
  v_mfma_f32_32x32x16_bf16 v[144:159], v[196:199], v[20:23], v[144:159]
  v_mfma_f32_32x32x16_bf16 v[160:175], v[16:19], v[200:203], v[160:175]
  v_mfma_f32_32x32x16_bf16 v[176:191], v[20:23], v[200:203], v[176:191]
  buffer_load_dwordx4 v[192:195], v8, s[4:7], s24 offen offset:0
  buffer_load_dwordx4 v[196:199], v8, s[4:7], s25 offen offset:0
  buffer_load_dwordx4 v[200:203], v8, s[4:7], s26 offen offset:0
  s_waitcnt vmcnt(9)
  ds_read_b128 v[16:19], v8 offset:15360
  ds_read_b128 v[20:23], v9 offset:15360
  s_waitcnt lgkmcnt(4)
  v_mfma_f32_32x32x16_bf16 v[96:111], v[204:207], v[24:27], v[96:111]
  v_mfma_f32_32x32x16_bf16 v[112:127], v[204:207], v[28:31], v[112:127]
  v_mfma_f32_32x32x16_bf16 v[128:143], v[208:211], v[24:27], v[128:143]
  v_mfma_f32_32x32x16_bf16 v[144:159], v[208:211], v[28:31], v[144:159]
  v_mfma_f32_32x32x16_bf16 v[160:175], v[24:27], v[212:215], v[160:175]
  v_mfma_f32_32x32x16_bf16 v[176:191], v[28:31], v[212:215], v[176:191]
  buffer_load_dwordx4 v[204:207], v8, s[4:7], s24 offen offset:1024
  buffer_load_dwordx4 v[208:211], v8, s[4:7], s25 offen offset:1024
  buffer_load_dwordx4 v[212:215], v8, s[4:7], s26 offen offset:1024
  s_waitcnt vmcnt(9)
  ds_read_b128 v[24:27], v8 offset:16384
  ds_read_b128 v[28:31], v9 offset:16384
  s_waitcnt lgkmcnt(4)
  v_mfma_f32_32x32x16_bf16 v[96:111], v[216:219], v[32:35], v[96:111]
  v_mfma_f32_32x32x16_bf16 v[112:127], v[216:219], v[36:39], v[112:127]
  v_mfma_f32_32x32x16_bf16 v[128:143], v[220:223], v[32:35], v[128:143]
  v_mfma_f32_32x32x16_bf16 v[144:159], v[220:223], v[36:39], v[144:159]
  v_mfma_f32_32x32x16_bf16 v[160:175], v[32:35], v[224:227], v[160:175]
  v_mfma_f32_32x32x16_bf16 v[176:191], v[36:39], v[224:227], v[176:191]
  buffer_load_dwordx4 v[216:219], v8, s[4:7], s24 offen offset:2048
  buffer_load_dwordx4 v[220:223], v8, s[4:7], s25 offen offset:2048
  buffer_load_dwordx4 v[224:227], v8, s[4:7], s26 offen offset:2048
  s_waitcnt vmcnt(9)
  ds_read_b128 v[32:35], v8 offset:17408
  ds_read_b128 v[36:39], v9 offset:17408
  s_waitcnt lgkmcnt(4)
  v_mfma_f32_32x32x16_bf16 v[96:111], v[228:231], v[16:19], v[96:111]
  v_mfma_f32_32x32x16_bf16 v[112:127], v[228:231], v[20:23], v[112:127]
  v_mfma_f32_32x32x16_bf16 v[128:143], v[232:235], v[16:19], v[128:143]
  v_mfma_f32_32x32x16_bf16 v[144:159], v[232:235], v[20:23], v[144:159]
  v_mfma_f32_32x32x16_bf16 v[160:175], v[16:19], v[236:239], v[160:175]
  v_mfma_f32_32x32x16_bf16 v[176:191], v[20:23], v[236:239], v[176:191]
  buffer_load_dwordx4 v[228:231], v8, s[4:7], s24 offen offset:3072
  buffer_load_dwordx4 v[232:235], v8, s[4:7], s25 offen offset:3072
  buffer_load_dwordx4 v[236:239], v8, s[4:7], s26 offen offset:3072
  s_add_u32 s24, s24, 4096
  s_add_u32 s25, s25, 4096
  s_add_u32 s26, s26, 4096
  s_waitcnt vmcnt(9)
  ds_read_b128 v[16:19], v8 offset:18432
  ds_read_b128 v[20:23], v9 offset:18432
  s_waitcnt lgkmcnt(4)
  v_mfma_f32_32x32x16_bf16 v[96:111], v[192:195], v[24:27], v[96:111]
  v_mfma_f32_32x32x16_bf16 v[112:127], v[192:195], v[28:31], v[112:127]
  v_mfma_f32_32x32x16_bf16 v[128:143], v[196:199], v[24:27], v[128:143]
  v_mfma_f32_32x32x16_bf16 v[144:159], v[196:199], v[28:31], v[144:159]
  v_mfma_f32_32x32x16_bf16 v[160:175], v[24:27], v[200:203], v[160:175]
  v_mfma_f32_32x32x16_bf16 v[176:191], v[28:31], v[200:203], v[176:191]
  buffer_load_dwordx4 v[192:195], v8, s[4:7], s24 offen offset:0
  buffer_load_dwordx4 v[196:199], v8, s[4:7], s25 offen offset:0
  buffer_load_dwordx4 v[200:203], v8, s[4:7], s26 offen offset:0
  s_waitcnt vmcnt(9)
  ds_read_b128 v[24:27], v8 offset:19456
  ds_read_b128 v[28:31], v9 offset:19456
  s_waitcnt lgkmcnt(4)
  v_mfma_f32_32x32x16_bf16 v[96:111], v[204:207], v[32:35], v[96:111]
  v_mfma_f32_32x32x16_bf16 v[112:127], v[204:207], v[36:39], v[112:127]
  v_mfma_f32_32x32x16_bf16 v[128:143], v[208:211], v[32:35], v[128:143]
  v_mfma_f32_32x32x16_bf16 v[144:159], v[208:211], v[36:39], v[144:159]
  v_mfma_f32_32x32x16_bf16 v[160:175], v[32:35], v[212:215], v[160:175]
  v_mfma_f32_32x32x16_bf16 v[176:191], v[36:39], v[212:215], v[176:191]
  buffer_load_dwordx4 v[204:207], v8, s[4:7], s24 offen offset:1024
  buffer_load_dwordx4 v[208:211], v8, s[4:7], s25 offen offset:1024
  buffer_load_dwordx4 v[212:215], v8, s[4:7], s26 offen offset:1024
  s_waitcnt vmcnt(9)
  ds_read_b128 v[32:35], v8 offset:20480
  ds_read_b128 v[36:39], v9 offset:20480
  s_waitcnt lgkmcnt(4)
  v_mfma_f32_32x32x16_bf16 v[96:111], v[216:219], v[16:19], v[96:111]
  v_mfma_f32_32x32x16_bf16 v[112:127], v[216:219], v[20:23], v[112:127]
  v_mfma_f32_32x32x16_bf16 v[128:143], v[220:223], v[16:19], v[128:143]
  v_mfma_f32_32x32x16_bf16 v[144:159], v[220:223], v[20:23], v[144:159]
  v_mfma_f32_32x32x16_bf16 v[160:175], v[16:19], v[224:227], v[160:175]
  v_mfma_f32_32x32x16_bf16 v[176:191], v[20:23], v[224:227], v[176:191]
  buffer_load_dwordx4 v[216:219], v8, s[4:7], s24 offen offset:2048
  buffer_load_dwordx4 v[220:223], v8, s[4:7], s25 offen offset:2048
  buffer_load_dwordx4 v[224:227], v8, s[4:7], s26 offen offset:2048
  s_waitcnt vmcnt(9)
  ds_read_b128 v[16:19], v8 offset:21504
  ds_read_b128 v[20:23], v9 offset:21504
  s_waitcnt lgkmcnt(4)
  v_mfma_f32_32x32x16_bf16 v[96:111], v[228:231], v[24:27], v[96:111]
  v_mfma_f32_32x32x16_bf16 v[112:127], v[228:231], v[28:31], v[112:127]
  v_mfma_f32_32x32x16_bf16 v[128:143], v[232:235], v[24:27], v[128:143]
  v_mfma_f32_32x32x16_bf16 v[144:159], v[232:235], v[28:31], v[144:159]
  v_mfma_f32_32x32x16_bf16 v[160:175], v[24:27], v[236:239], v[160:175]
  v_mfma_f32_32x32x16_bf16 v[176:191], v[28:31], v[236:239], v[176:191]
  buffer_load_dwordx4 v[228:231], v8, s[4:7], s24 offen offset:3072
  buffer_load_dwordx4 v[232:235], v8, s[4:7], s25 offen offset:3072
  buffer_load_dwordx4 v[236:239], v8, s[4:7], s26 offen offset:3072
  s_add_u32 s24, s24, 4096
  s_add_u32 s25, s25, 4096
  s_add_u32 s26, s26, 4096
  s_waitcnt vmcnt(9)
  ds_read_b128 v[24:27], v8 offset:22528
  ds_read_b128 v[28:31], v9 offset:22528
  s_waitcnt lgkmcnt(4)
  v_mfma_f32_32x32x16_bf16 v[96:111], v[192:195], v[32:35], v[96:111]
  v_mfma_f32_32x32x16_bf16 v[112:127], v[192:195], v[36:39], v[112:127]
  v_mfma_f32_32x32x16_bf16 v[128:143], v[196:199], v[32:35], v[128:143]
  v_mfma_f32_32x32x16_bf16 v[144:159], v[196:199], v[36:39], v[144:159]
  v_mfma_f32_32x32x16_bf16 v[160:175], v[32:35], v[200:203], v[160:175]
  v_mfma_f32_32x32x16_bf16 v[176:191], v[36:39], v[200:203], v[176:191]
  buffer_load_dwordx4 v[192:195], v8, s[4:7], s24 offen offset:0
  buffer_load_dwordx4 v[196:199], v8, s[4:7], s25 offen offset:0
  buffer_load_dwordx4 v[200:203], v8, s[4:7], s26 offen offset:0
  s_waitcnt vmcnt(9)
  ds_read_b128 v[32:35], v8 offset:23552
  ds_read_b128 v[36:39], v9 offset:23552
  s_waitcnt lgkmcnt(4)
  v_mfma_f32_32x32x16_bf16 v[96:111], v[204:207], v[16:19], v[96:111]
  v_mfma_f32_32x32x16_bf16 v[112:127], v[204:207], v[20:23], v[112:127]
  v_mfma_f32_32x32x16_bf16 v[128:143], v[208:211], v[16:19], v[128:143]
  v_mfma_f32_32x32x16_bf16 v[144:159], v[208:211], v[20:23], v[144:159]
  v_mfma_f32_32x32x16_bf16 v[160:175], v[16:19], v[212:215], v[160:175]
  v_mfma_f32_32x32x16_bf16 v[176:191], v[20:23], v[212:215], v[176:191]
  buffer_load_dwordx4 v[204:207], v8, s[4:7], s24 offen offset:1024
  buffer_load_dwordx4 v[208:211], v8, s[4:7], s25 offen offset:1024
  buffer_load_dwordx4 v[212:215], v8, s[4:7], s26 offen offset:1024
  s_waitcnt vmcnt(9)
  ds_read_b128 v[16:19], v8 offset:24576
  ds_read_b128 v[20:23], v9 offset:24576
  s_waitcnt lgkmcnt(4)
  v_mfma_f32_32x32x16_bf16 v[96:111], v[216:219], v[24:27], v[96:111]
  v_mfma_f32_32x32x16_bf16 v[112:127], v[216:219], v[28:31], v[112:127]
  v_mfma_f32_32x32x16_bf16 v[128:143], v[220:223], v[24:27], v[128:143]
  v_mfma_f32_32x32x16_bf16 v[144:159], v[220:223], v[28:31], v[144:159]
  v_mfma_f32_32x32x16_bf16 v[160:175], v[24:27], v[224:227], v[160:175]
  v_mfma_f32_32x32x16_bf16 v[176:191], v[28:31], v[224:227], v[176:191]
  buffer_load_dwordx4 v[216:219], v8, s[4:7], s24 offen offset:2048
  buffer_load_dwordx4 v[220:223], v8, s[4:7], s25 offen offset:2048
  buffer_load_dwordx4 v[224:227], v8, s[4:7], s26 offen offset:2048
  s_waitcnt vmcnt(9)
  ds_read_b128 v[24:27], v8 offset:25600
  ds_read_b128 v[28:31], v9 offset:25600
  s_waitcnt lgkmcnt(4)
  v_mfma_f32_32x32x16_bf16 v[96:111], v[228:231], v[32:35], v[96:111]
  v_mfma_f32_32x32x16_bf16 v[112:127], v[228:231], v[36:39], v[112:127]
  v_mfma_f32_32x32x16_bf16 v[128:143], v[232:235], v[32:35], v[128:143]
  v_mfma_f32_32x32x16_bf16 v[144:159], v[232:235], v[36:39], v[144:159]
  v_mfma_f32_32x32x16_bf16 v[160:175], v[32:35], v[236:239], v[160:175]
  v_mfma_f32_32x32x16_bf16 v[176:191], v[36:39], v[236:239], v[176:191]
  buffer_load_dwordx4 v[228:231], v8, s[4:7], s24 offen offset:3072
  buffer_load_dwordx4 v[232:235], v8, s[4:7], s25 offen offset:3072
  buffer_load_dwordx4 v[236:239], v8, s[4:7], s26 offen offset:3072
  s_add_u32 s24, s24, 4096
  s_add_u32 s25, s25, 4096
  s_add_u32 s26, s26, 4096
  s_waitcnt vmcnt(9)
  ds_read_b128 v[32:35], v8 offset:26624
  ds_read_b128 v[36:39], v9 offset:26624
  s_waitcnt lgkmcnt(4)
  v_mfma_f32_32x32x16_bf16 v[96:111], v[192:195], v[16:19], v[96:111]
  v_mfma_f32_32x32x16_bf16 v[112:127], v[192:195], v[20:23], v[112:127]
  v_mfma_f32_32x32x16_bf16 v[128:143], v[196:199], v[16:19], v[128:143]
  v_mfma_f32_32x32x16_bf16 v[144:159], v[196:199], v[20:23], v[144:159]
  v_mfma_f32_32x32x16_bf16 v[160:175], v[16:19], v[200:203], v[160:175]
  v_mfma_f32_32x32x16_bf16 v[176:191], v[20:23], v[200:203], v[176:191]
  buffer_load_dwordx4 v[192:195], v8, s[4:7], s24 offen offset:0
  buffer_load_dwordx4 v[196:199], v8, s[4:7], s25 offen offset:0
  buffer_load_dwordx4 v[200:203], v8, s[4:7], s26 offen offset:0
  s_waitcnt vmcnt(9)
  ds_read_b128 v[16:19], v8 offset:27648
  ds_read_b128 v[20:23], v9 offset:27648
  s_waitcnt lgkmcnt(4)
  v_mfma_f32_32x32x16_bf16 v[96:111], v[204:207], v[24:27], v[96:111]
  v_mfma_f32_32x32x16_bf16 v[112:127], v[204:207], v[28:31], v[112:127]
  v_mfma_f32_32x32x16_bf16 v[128:143], v[208:211], v[24:27], v[128:143]
  v_mfma_f32_32x32x16_bf16 v[144:159], v[208:211], v[28:31], v[144:159]
  v_mfma_f32_32x32x16_bf16 v[160:175], v[24:27], v[212:215], v[160:175]
  v_mfma_f32_32x32x16_bf16 v[176:191], v[28:31], v[212:215], v[176:191]
  buffer_load_dwordx4 v[204:207], v8, s[4:7], s24 offen offset:1024
  buffer_load_dwordx4 v[208:211], v8, s[4:7], s25 offen offset:1024
  buffer_load_dwordx4 v[212:215], v8, s[4:7], s26 offen offset:1024
  s_waitcnt vmcnt(9)
  ds_read_b128 v[24:27], v8 offset:28672
  ds_read_b128 v[28:31], v9 offset:28672
  s_waitcnt lgkmcnt(4)
  v_mfma_f32_32x32x16_bf16 v[96:111], v[216:219], v[32:35], v[96:111]
  v_mfma_f32_32x32x16_bf16 v[112:127], v[216:219], v[36:39], v[112:127]
  v_mfma_f32_32x32x16_bf16 v[128:143], v[220:223], v[32:35], v[128:143]
  v_mfma_f32_32x32x16_bf16 v[144:159], v[220:223], v[36:39], v[144:159]
  v_mfma_f32_32x32x16_bf16 v[160:175], v[32:35], v[224:227], v[160:175]
  v_mfma_f32_32x32x16_bf16 v[176:191], v[36:39], v[224:227], v[176:191]
  buffer_load_dwordx4 v[216:219], v8, s[4:7], s24 offen offset:2048
  buffer_load_dwordx4 v[220:223], v8, s[4:7], s25 offen offset:2048
  buffer_load_dwordx4 v[224:227], v8, s[4:7], s26 offen offset:2048
  s_waitcnt vmcnt(9)
  ds_read_b128 v[32:35], v8 offset:29696
  ds_read_b128 v[36:39], v9 offset:29696
  s_waitcnt lgkmcnt(4)
  v_mfma_f32_32x32x16_bf16 v[96:111], v[228:231], v[16:19], v[96:111]
  v_mfma_f32_32x32x16_bf16 v[112:127], v[228:231], v[20:23], v[112:127]
  v_mfma_f32_32x32x16_bf16 v[128:143], v[232:235], v[16:19], v[128:143]
  v_mfma_f32_32x32x16_bf16 v[144:159], v[232:235], v[20:23], v[144:159]
  v_mfma_f32_32x32x16_bf16 v[160:175], v[16:19], v[236:239], v[160:175]
  v_mfma_f32_32x32x16_bf16 v[176:191], v[20:23], v[236:239], v[176:191]
  buffer_load_dwordx4 v[228:231], v8, s[4:7], s24 offen offset:3072
  buffer_load_dwordx4 v[232:235], v8, s[4:7], s25 offen offset:3072
  buffer_load_dwordx4 v[236:239], v8, s[4:7], s26 offen offset:3072
  s_add_u32 s24, s24, 4096
  s_add_u32 s25, s25, 4096
  s_add_u32 s26, s26, 4096
  s_waitcnt vmcnt(9)
  ds_read_b128 v[16:19], v8 offset:30720
  ds_read_b128 v[20:23], v9 offset:30720
  s_waitcnt lgkmcnt(4)
  v_mfma_f32_32x32x16_bf16 v[96:111], v[192:195], v[24:27], v[96:111]
  v_mfma_f32_32x32x16_bf16 v[112:127], v[192:195], v[28:31], v[112:127]
  v_mfma_f32_32x32x16_bf16 v[128:143], v[196:199], v[24:27], v[128:143]
  v_mfma_f32_32x32x16_bf16 v[144:159], v[196:199], v[28:31], v[144:159]
  v_mfma_f32_32x32x16_bf16 v[160:175], v[24:27], v[200:203], v[160:175]
  v_mfma_f32_32x32x16_bf16 v[176:191], v[28:31], v[200:203], v[176:191]
  buffer_load_dwordx4 v[192:195], v8, s[4:7], s24 offen offset:0
  buffer_load_dwordx4 v[196:199], v8, s[4:7], s25 offen offset:0
  buffer_load_dwordx4 v[200:203], v8, s[4:7], s26 offen offset:0
  s_waitcnt vmcnt(9)
  ds_read_b128 v[24:27], v8 offset:31744
  ds_read_b128 v[28:31], v9 offset:31744
  s_waitcnt lgkmcnt(4)
  v_mfma_f32_32x32x16_bf16 v[96:111], v[204:207], v[32:35], v[96:111]
  v_mfma_f32_32x32x16_bf16 v[112:127], v[204:207], v[36:39], v[112:127]
  v_mfma_f32_32x32x16_bf16 v[128:143], v[208:211], v[32:35], v[128:143]
  v_mfma_f32_32x32x16_bf16 v[144:159], v[208:211], v[36:39], v[144:159]
  v_mfma_f32_32x32x16_bf16 v[160:175], v[32:35], v[212:215], v[160:175]
  v_mfma_f32_32x32x16_bf16 v[176:191], v[36:39], v[212:215], v[176:191]
  buffer_load_dwordx4 v[204:207], v8, s[4:7], s24 offen offset:1024
  buffer_load_dwordx4 v[208:211], v8, s[4:7], s25 offen offset:1024
  buffer_load_dwordx4 v[212:215], v8, s[4:7], s26 offen offset:1024
  s_waitcnt vmcnt(9)
  ds_read_b128 v[32:35], v8 offset:32768
  ds_read_b128 v[36:39], v9 offset:32768
  s_waitcnt lgkmcnt(4)
  v_mfma_f32_32x32x16_bf16 v[96:111], v[216:219], v[16:19], v[96:111]
  v_mfma_f32_32x32x16_bf16 v[112:127], v[216:219], v[20:23], v[112:127]
  v_mfma_f32_32x32x16_bf16 v[128:143], v[220:223], v[16:19], v[128:143]
  v_mfma_f32_32x32x16_bf16 v[144:159], v[220:223], v[20:23], v[144:159]
  v_mfma_f32_32x32x16_bf16 v[160:175], v[16:19], v[224:227], v[160:175]
  v_mfma_f32_32x32x16_bf16 v[176:191], v[20:23], v[224:227], v[176:191]
  buffer_load_dwordx4 v[216:219], v8, s[4:7], s24 offen offset:2048
  buffer_load_dwordx4 v[220:223], v8, s[4:7], s25 offen offset:2048
  buffer_load_dwordx4 v[224:227], v8, s[4:7], s26 offen offset:2048
  s_waitcnt vmcnt(9)
  ds_read_b128 v[16:19], v8 offset:33792
  ds_read_b128 v[20:23], v9 offset:33792
  s_waitcnt lgkmcnt(4)
  v_mfma_f32_32x32x16_bf16 v[96:111], v[228:231], v[24:27], v[96:111]
  v_mfma_f32_32x32x16_bf16 v[112:127], v[228:231], v[28:31], v[112:127]
  v_mfma_f32_32x32x16_bf16 v[128:143], v[232:235], v[24:27], v[128:143]
  v_mfma_f32_32x32x16_bf16 v[144:159], v[232:235], v[28:31], v[144:159]
  v_mfma_f32_32x32x16_bf16 v[160:175], v[24:27], v[236:239], v[160:175]
  v_mfma_f32_32x32x16_bf16 v[176:191], v[28:31], v[236:239], v[176:191]
  buffer_load_dwordx4 v[228:231], v8, s[4:7], s24 offen offset:3072
  buffer_load_dwordx4 v[232:235], v8, s[4:7], s25 offen offset:3072
  buffer_load_dwordx4 v[236:239], v8, s[4:7], s26 offen offset:3072
  s_add_u32 s24, s24, 4096
  s_add_u32 s25, s25, 4096
  s_add_u32 s26, s26, 4096
  s_waitcnt vmcnt(9)
  ds_read_b128 v[24:27], v8 offset:34816
  ds_read_b128 v[28:31], v9 offset:34816
  s_waitcnt lgkmcnt(4)
  v_mfma_f32_32x32x16_bf16 v[96:111], v[192:195], v[32:35], v[96:111]
  v_mfma_f32_32x32x16_bf16 v[112:127], v[192:195], v[36:39], v[112:127]
  v_mfma_f32_32x32x16_bf16 v[128:143], v[196:199], v[32:35], v[128:143]
  v_mfma_f32_32x32x16_bf16 v[144:159], v[196:199], v[36:39], v[144:159]
  v_mfma_f32_32x32x16_bf16 v[160:175], v[32:35], v[200:203], v[160:175]
  v_mfma_f32_32x32x16_bf16 v[176:191], v[36:39], v[200:203], v[176:191]
  buffer_load_dwordx4 v[192:195], v8, s[4:7], s24 offen offset:0
  buffer_load_dwordx4 v[196:199], v8, s[4:7], s25 offen offset:0
  buffer_load_dwordx4 v[200:203], v8, s[4:7], s26 offen offset:0
  s_waitcnt vmcnt(9)
  ds_read_b128 v[32:35], v8 offset:35840
  ds_read_b128 v[36:39], v9 offset:35840
  s_waitcnt lgkmcnt(4)
  v_mfma_f32_32x32x16_bf16 v[96:111], v[204:207], v[16:19], v[96:111]
  v_mfma_f32_32x32x16_bf16 v[112:127], v[204:207], v[20:23], v[112:127]
  v_mfma_f32_32x32x16_bf16 v[128:143], v[208:211], v[16:19], v[128:143]
  v_mfma_f32_32x32x16_bf16 v[144:159], v[208:211], v[20:23], v[144:159]
  v_mfma_f32_32x32x16_bf16 v[160:175], v[16:19], v[212:215], v[160:175]
  v_mfma_f32_32x32x16_bf16 v[176:191], v[20:23], v[212:215], v[176:191]
  buffer_load_dwordx4 v[204:207], v8, s[4:7], s24 offen offset:1024
  buffer_load_dwordx4 v[208:211], v8, s[4:7], s25 offen offset:1024
  buffer_load_dwordx4 v[212:215], v8, s[4:7], s26 offen offset:1024
  s_waitcnt vmcnt(9)
  ds_read_b128 v[16:19], v8 offset:36864
  ds_read_b128 v[20:23], v9 offset:36864
  s_waitcnt lgkmcnt(4)
  v_mfma_f32_32x32x16_bf16 v[96:111], v[216:219], v[24:27], v[96:111]
  v_mfma_f32_32x32x16_bf16 v[112:127], v[216:219], v[28:31], v[112:127]
  v_mfma_f32_32x32x16_bf16 v[128:143], v[220:223], v[24:27], v[128:143]
  v_mfma_f32_32x32x16_bf16 v[144:159], v[220:223], v[28:31], v[144:159]
  v_mfma_f32_32x32x16_bf16 v[160:175], v[24:27], v[224:227], v[160:175]
  v_mfma_f32_32x32x16_bf16 v[176:191], v[28:31], v[224:227], v[176:191]
  buffer_load_dwordx4 v[216:219], v8, s[4:7], s24 offen offset:2048
  buffer_load_dwordx4 v[220:223], v8, s[4:7], s25 offen offset:2048
  buffer_load_dwordx4 v[224:227], v8, s[4:7], s26 offen offset:2048
  s_waitcnt vmcnt(9)
  ds_read_b128 v[24:27], v8 offset:37888
  ds_read_b128 v[28:31], v9 offset:37888
  s_waitcnt lgkmcnt(4)
  v_mfma_f32_32x32x16_bf16 v[96:111], v[228:231], v[32:35], v[96:111]
  v_mfma_f32_32x32x16_bf16 v[112:127], v[228:231], v[36:39], v[112:127]
  v_mfma_f32_32x32x16_bf16 v[128:143], v[232:235], v[32:35], v[128:143]
  v_mfma_f32_32x32x16_bf16 v[144:159], v[232:235], v[36:39], v[144:159]
  v_mfma_f32_32x32x16_bf16 v[160:175], v[32:35], v[236:239], v[160:175]
  v_mfma_f32_32x32x16_bf16 v[176:191], v[36:39], v[236:239], v[176:191]
  buffer_load_dwordx4 v[228:231], v8, s[4:7], s24 offen offset:3072
  buffer_load_dwordx4 v[232:235], v8, s[4:7], s25 offen offset:3072
  buffer_load_dwordx4 v[236:239], v8, s[4:7], s26 offen offset:3072
  s_add_u32 s24, s24, 4096
  s_add_u32 s25, s25, 4096
  s_add_u32 s26, s26, 4096
  s_waitcnt vmcnt(9)
  ds_read_b128 v[32:35], v8 offset:38912
  ds_read_b128 v[36:39], v9 offset:38912
  s_waitcnt lgkmcnt(4)
  v_mfma_f32_32x32x16_bf16 v[96:111], v[192:195], v[16:19], v[96:111]
  v_mfma_f32_32x32x16_bf16 v[112:127], v[192:195], v[20:23], v[112:127]
  v_mfma_f32_32x32x16_bf16 v[128:143], v[196:199], v[16:19], v[128:143]
  v_mfma_f32_32x32x16_bf16 v[144:159], v[196:199], v[20:23], v[144:159]
  v_mfma_f32_32x32x16_bf16 v[160:175], v[16:19], v[200:203], v[160:175]
  v_mfma_f32_32x32x16_bf16 v[176:191], v[20:23], v[200:203], v[176:191]
  s_waitcnt vmcnt(6)
  ds_read_b128 v[16:19], v8 offset:39936
  ds_read_b128 v[20:23], v9 offset:39936
  s_waitcnt lgkmcnt(4)
  v_mfma_f32_32x32x16_bf16 v[96:111], v[204:207], v[24:27], v[96:111]
  v_mfma_f32_32x32x16_bf16 v[112:127], v[204:207], v[28:31], v[112:127]
  v_mfma_f32_32x32x16_bf16 v[128:143], v[208:211], v[24:27], v[128:143]
  v_mfma_f32_32x32x16_bf16 v[144:159], v[208:211], v[28:31], v[144:159]
  v_mfma_f32_32x32x16_bf16 v[160:175], v[24:27], v[212:215], v[160:175]
  v_mfma_f32_32x32x16_bf16 v[176:191], v[28:31], v[212:215], v[176:191]
  s_waitcnt vmcnt(3)
  s_waitcnt lgkmcnt(2)
  v_mfma_f32_32x32x16_bf16 v[96:111], v[216:219], v[32:35], v[96:111]
  v_mfma_f32_32x32x16_bf16 v[112:127], v[216:219], v[36:39], v[112:127]
  v_mfma_f32_32x32x16_bf16 v[128:143], v[220:223], v[32:35], v[128:143]
  v_mfma_f32_32x32x16_bf16 v[144:159], v[220:223], v[36:39], v[144:159]
  v_mfma_f32_32x32x16_bf16 v[160:175], v[32:35], v[224:227], v[160:175]
  v_mfma_f32_32x32x16_bf16 v[176:191], v[36:39], v[224:227], v[176:191]
  s_waitcnt vmcnt(0)
  s_waitcnt lgkmcnt(0)
  v_mfma_f32_32x32x16_bf16 v[96:111], v[228:231], v[16:19], v[96:111]
  v_mfma_f32_32x32x16_bf16 v[112:127], v[228:231], v[20:23], v[112:127]
  v_mfma_f32_32x32x16_bf16 v[128:143], v[232:235], v[16:19], v[128:143]
  v_mfma_f32_32x32x16_bf16 v[144:159], v[232:235], v[20:23], v[144:159]
  v_mfma_f32_32x32x16_bf16 v[160:175], v[16:19], v[236:239], v[160:175]
  v_mfma_f32_32x32x16_bf16 v[176:191], v[20:23], v[236:239], v[176:191]
  s_lshl_b32 s21, s18, 1
  s_lshl_b32 s22, s23, 6
  s_add_u32 s21, s21, s22
  s_lshl_b32 s21, s21, 11
  s_add_u32 s27, s21, 161480704
  s_add_u32 s28, s21, 165675008
  s_add_u32 s29, s21, 169869312
  s_mov_b32 s30, 0x3ea52b5c
  v_and_b32 v2, 31, v0
  v_cmp_eq_u32 s[32:33], 20, v2
  v_mov_b32 v3, 0x3f803f80
  v_mul_f32 v96, s30, v96
  v_mul_f32 v97, s30, v97
  v_mul_f32 v98, s30, v98
  v_mul_f32 v99, s30, v99
  v_mul_f32 v100, s30, v100
  v_mul_f32 v101, s30, v101
  v_mul_f32 v102, s30, v102
  v_mul_f32 v103, s30, v103
  v_mul_f32 v104, s30, v104
  v_mul_f32 v105, s30, v105
  v_mul_f32 v106, s30, v106
  v_mul_f32 v107, s30, v107
  v_mul_f32 v108, s30, v108
  v_mul_f32 v109, s30, v109
  v_mul_f32 v110, s30, v110
  v_mul_f32 v111, s30, v111
  v_cvt_pk_bf16_f32 v16, v96, v97
  v_cvt_pk_bf16_f32 v17, v98, v99
  v_cvt_pk_bf16_f32 v18, v100, v101
  v_cvt_pk_bf16_f32 v19, v102, v103
  v_cvt_pk_bf16_f32 v20, v104, v105
  v_cvt_pk_bf16_f32 v21, v106, v107
  v_cvt_pk_bf16_f32 v22, v108, v109
  v_cvt_pk_bf16_f32 v23, v110, v111
  buffer_store_dwordx4 v[16:19], v8, s[4:7], s27 offen offset:0
  buffer_store_dwordx4 v[20:23], v8, s[4:7], s27 offen offset:1024
  v_mul_f32 v112, s30, v112
  v_mul_f32 v113, s30, v113
  v_mul_f32 v114, s30, v114
  v_mul_f32 v115, s30, v115
  v_mul_f32 v116, s30, v116
  v_mul_f32 v117, s30, v117
  v_mul_f32 v118, s30, v118
  v_mul_f32 v119, s30, v119
  v_mul_f32 v120, s30, v120
  v_mul_f32 v121, s30, v121
  v_mul_f32 v122, s30, v122
  v_mul_f32 v123, s30, v123
  v_mul_f32 v124, s30, v124
  v_mul_f32 v125, s30, v125
  v_mul_f32 v126, s30, v126
  v_mul_f32 v127, s30, v127
  v_cvt_pk_bf16_f32 v24, v112, v113
  v_cvt_pk_bf16_f32 v25, v114, v115
  v_cvt_pk_bf16_f32 v26, v116, v117
  v_cvt_pk_bf16_f32 v27, v118, v119
  v_cvt_pk_bf16_f32 v28, v120, v121
  v_cvt_pk_bf16_f32 v29, v122, v123
  v_cvt_pk_bf16_f32 v30, v124, v125
  v_cvt_pk_bf16_f32 v31, v126, v127
  buffer_store_dwordx4 v[24:27], v8, s[4:7], s27 offen offset:2048
  buffer_store_dwordx4 v[28:31], v8, s[4:7], s27 offen offset:3072
  v_cvt_pk_bf16_f32 v16, v128, v129
  v_cvt_pk_bf16_f32 v17, v130, v131
  v_cvt_pk_bf16_f32 v18, v132, v133
  v_cvt_pk_bf16_f32 v19, v134, v135
  v_cvt_pk_bf16_f32 v20, v136, v137
  v_cvt_pk_bf16_f32 v21, v138, v139
  v_cvt_pk_bf16_f32 v22, v140, v141
  v_cvt_pk_bf16_f32 v23, v142, v143
  buffer_store_dwordx4 v[16:19], v8, s[4:7], s28 offen offset:0
  buffer_store_dwordx4 v[20:23], v8, s[4:7], s28 offen offset:1024
  v_cvt_pk_bf16_f32 v24, v144, v145
  v_cvt_pk_bf16_f32 v25, v146, v147
  v_cvt_pk_bf16_f32 v26, v148, v149
  v_cvt_pk_bf16_f32 v27, v150, v151
  v_cvt_pk_bf16_f32 v28, v152, v153
  v_cvt_pk_bf16_f32 v29, v154, v155
  v_cvt_pk_bf16_f32 v30, v156, v157
  v_cvt_pk_bf16_f32 v31, v158, v159
  buffer_store_dwordx4 v[24:27], v8, s[4:7], s28 offen offset:2048
  buffer_store_dwordx4 v[28:31], v8, s[4:7], s28 offen offset:3072
  v_cvt_pk_bf16_f32 v16, v160, v161
  v_cvt_pk_bf16_f32 v17, v162, v163
  v_cvt_pk_bf16_f32 v18, v164, v165
  v_cvt_pk_bf16_f32 v19, v166, v167
  v_cvt_pk_bf16_f32 v20, v168, v169
  v_cvt_pk_bf16_f32 v21, v170, v171
  v_cvt_pk_bf16_f32 v22, v172, v173
  v_cvt_pk_bf16_f32 v23, v174, v175
  v_cndmask_b32 v16, v16, v3, s[32:33]
  v_cndmask_b32 v17, v17, v3, s[32:33]
  v_cndmask_b32 v18, v18, v3, s[32:33]
  v_cndmask_b32 v19, v19, v3, s[32:33]
  v_cndmask_b32 v20, v20, v3, s[32:33]
  v_cndmask_b32 v21, v21, v3, s[32:33]
  v_cndmask_b32 v22, v22, v3, s[32:33]
  v_cndmask_b32 v23, v23, v3, s[32:33]
  buffer_store_dwordx4 v[16:19], v8, s[4:7], s29 offen offset:0
  buffer_store_dwordx4 v[20:23], v8, s[4:7], s29 offen offset:1024
  v_cvt_pk_bf16_f32 v24, v176, v177
  v_cvt_pk_bf16_f32 v25, v178, v179
  v_cvt_pk_bf16_f32 v26, v180, v181
  v_cvt_pk_bf16_f32 v27, v182, v183
  v_cvt_pk_bf16_f32 v28, v184, v185
  v_cvt_pk_bf16_f32 v29, v186, v187
  v_cvt_pk_bf16_f32 v30, v188, v189
  v_cvt_pk_bf16_f32 v31, v190, v191
  v_cndmask_b32 v24, v24, v3, s[32:33]
  v_cndmask_b32 v25, v25, v3, s[32:33]
  v_cndmask_b32 v26, v26, v3, s[32:33]
  v_cndmask_b32 v27, v27, v3, s[32:33]
  v_cndmask_b32 v28, v28, v3, s[32:33]
  v_cndmask_b32 v29, v29, v3, s[32:33]
  v_cndmask_b32 v30, v30, v3, s[32:33]
  v_cndmask_b32 v31, v31, v3, s[32:33]
  buffer_store_dwordx4 v[24:27], v8, s[4:7], s29 offen offset:2048
  buffer_store_dwordx4 v[28:31], v8, s[4:7], s29 offen offset:3072
qkvb_exit1:
  s_endpgm
.globl attnb_kernel
.p2align 8
.type attnb_kernel,@function
attnb_kernel:
  s_cmp_ge_u32 s2, 256
  s_cbranch_scc1 attnb_exit1
  s_load_dwordx2 s[12:13], s[0:1], 96
  v_lshrrev_b32 v2, 6, v0
  v_and_b32 v3, 63, v0
  s_nop 0
  v_readfirstlane_b32 s16, v2
  v_lshlrev_b32 v1, 4, v3
  s_and_b32 s17, s2, 7
  s_lshl_b32 s17, s17, 2
  s_lshr_b32 s18, s2, 3
  s_and_b32 s19, s18, 3
  s_add_u32 s17, s17, s19
  s_lshr_b32 s18, s18, 2
  s_waitcnt lgkmcnt(0)
  s_mov_b32 s4, s12
  s_mov_b32 s5, s13
  s_mov_b32 s6, 0x10000000
  s_mov_b32 s7, 0x20000
  s_lshl_b32 s20, s17, 17
  s_add_u32 s21, s20, 165675008
  s_add_u32 s22, s20, 169869312
  s_lshl_b32 s23, s18, 3
  s_lshl_b32 s24, s16, 1
  s_add_u32 s23, s23, s24
  s_lshl_b32 s24, s23, 11
  s_add_u32 s24, s24, s20
  s_add_u32 s24, s24, 161480704
  buffer_load_dwordx4 v[8:11], v1, s[4:7], s24 offen offset:0
  buffer_load_dwordx4 v[12:15], v1, s[4:7], s24 offen offset:1024
  buffer_load_dwordx4 v[16:19], v1, s[4:7], s24 offen offset:2048
  buffer_load_dwordx4 v[20:23], v1, s[4:7], s24 offen offset:3072
  s_mov_b32 s25, s21
  s_mov_b32 s26, s22
  buffer_load_dwordx4 v[136:139], v1, s[4:7], s25 offen
  buffer_load_dwordx4 v[140:143], v1, s[4:7], s25 offen offset:1024
  buffer_load_dwordx4 v[144:147], v1, s[4:7], s26 offen
  buffer_load_dwordx4 v[148:151], v1, s[4:7], s26 offen offset:1024
  s_add_u32 s25, s25, 2048
  s_add_u32 s26, s26, 2048
  s_waitcnt vmcnt(0)
  v_mfma_f32_32x32x16_bf16 v[88:103], v[136:139], v[8:11], 0
  v_mfma_f32_32x32x16_bf16 v[88:103], v[140:143], v[12:15], v[88:103]
  v_mfma_f32_32x32x16_bf16 v[104:119], v[136:139], v[16:19], 0
  v_mfma_f32_32x32x16_bf16 v[104:119], v[140:143], v[20:23], v[104:119]
  s_nop 9
  v_max3_f32 v2, v88, v89, v90
  v_max3_f32 v2, v2, v91, v92
  v_max3_f32 v2, v2, v93, v94
  v_max3_f32 v2, v2, v95, v96
  v_max3_f32 v2, v2, v97, v98
  v_max3_f32 v2, v2, v99, v100
  v_max3_f32 v2, v2, v101, v102
  v_max_f32 v2, v2, v103
  v_mov_b32 v4, v2
  s_nop 1
  v_permlane32_swap_b32 v2, v4
  v_max_f32 v2, v2, v4
  v_sub_f32 v24, 0, v2
  v_sub_f32 v25, 0, v2
  v_sub_f32 v26, 0, v2
  v_sub_f32 v27, 0, v2
  v_sub_f32 v28, 0, v2
  v_sub_f32 v29, 0, v2
  v_sub_f32 v30, 0, v2
  v_sub_f32 v31, 0, v2
  v_sub_f32 v32, 0, v2
  v_sub_f32 v33, 0, v2
  v_sub_f32 v34, 0, v2
  v_sub_f32 v35, 0, v2
  v_sub_f32 v36, 0, v2
  v_sub_f32 v37, 0, v2
  v_sub_f32 v38, 0, v2
  v_sub_f32 v39, 0, v2
  v_max3_f32 v3, v104, v105, v106
  v_max3_f32 v3, v3, v107, v108
  v_max3_f32 v3, v3, v109, v110
  v_max3_f32 v3, v3, v111, v112
  v_max3_f32 v3, v3, v113, v114
  v_max3_f32 v3, v3, v115, v116
  v_max3_f32 v3, v3, v117, v118
  v_max_f32 v3, v3, v119
  v_mov_b32 v4, v3
  s_nop 1
  v_permlane32_swap_b32 v3, v4
  v_max_f32 v3, v3, v4
  v_sub_f32 v40, 0, v3
  v_sub_f32 v41, 0, v3
  v_sub_f32 v42, 0, v3
  v_sub_f32 v43, 0, v3
  v_sub_f32 v44, 0, v3
  v_sub_f32 v45, 0, v3
  v_sub_f32 v46, 0, v3
  v_sub_f32 v47, 0, v3
  v_sub_f32 v48, 0, v3
  v_sub_f32 v49, 0, v3
  v_sub_f32 v50, 0, v3
  v_sub_f32 v51, 0, v3
  v_sub_f32 v52, 0, v3
  v_sub_f32 v53, 0, v3
  v_sub_f32 v54, 0, v3
  v_sub_f32 v55, 0, v3
  s_mov_b32 s28, 0
attnb_main2:
  s_mov_b32 s25, s21
  s_mov_b32 s26, s22
  buffer_load_dwordx4 v[136:139], v1, s[4:7], s25 offen
  buffer_load_dwordx4 v[140:143], v1, s[4:7], s25 offen offset:1024
  buffer_load_dwordx4 v[144:147], v1, s[4:7], s26 offen
  buffer_load_dwordx4 v[148:151], v1, s[4:7], s26 offen offset:1024
  s_add_u32 s25, s25, 2048
  s_add_u32 s26, s26, 2048
  buffer_load_dwordx4 v[152:155], v1, s[4:7], s25 offen
  buffer_load_dwordx4 v[156:159], v1, s[4:7], s25 offen offset:1024
  buffer_load_dwordx4 v[160:163], v1, s[4:7], s26 offen
  buffer_load_dwordx4 v[164:167], v1, s[4:7], s26 offen offset:1024
  s_add_u32 s25, s25, 2048
  s_add_u32 s26, s26, 2048
  v_mov_b32 v56, 0
  v_mov_b32 v57, 0
  v_mov_b32 v58, 0
  v_mov_b32 v59, 0
  v_mov_b32 v60, 0
  v_mov_b32 v61, 0
  v_mov_b32 v62, 0
  v_mov_b32 v63, 0
  v_mov_b32 v64, 0
  v_mov_b32 v65, 0
  v_mov_b32 v66, 0
  v_mov_b32 v67, 0
  v_mov_b32 v68, 0
  v_mov_b32 v69, 0
  v_mov_b32 v70, 0
  v_mov_b32 v71, 0
  v_mov_b32 v72, 0
  v_mov_b32 v73, 0
  v_mov_b32 v74, 0
  v_mov_b32 v75, 0
  v_mov_b32 v76, 0
  v_mov_b32 v77, 0
  v_mov_b32 v78, 0
  v_mov_b32 v79, 0
  v_mov_b32 v80, 0
  v_mov_b32 v81, 0
  v_mov_b32 v82, 0
  v_mov_b32 v83, 0
  v_mov_b32 v84, 0
  v_mov_b32 v85, 0
  v_mov_b32 v86, 0
  v_mov_b32 v87, 0
  s_mov_b32 s27, 0
attnb_loop3:
  buffer_load_dwordx4 v[168:171], v1, s[4:7], s25 offen
  buffer_load_dwordx4 v[172:175], v1, s[4:7], s25 offen offset:1024
  buffer_load_dwordx4 v[176:179], v1, s[4:7], s26 offen
  buffer_load_dwordx4 v[180:183], v1, s[4:7], s26 offen offset:1024
  s_add_u32 s25, s25, 2048
  s_add_u32 s26, s26, 2048
  s_waitcnt vmcnt(8)
  v_mfma_f32_32x32x16_bf16 v[88:103], v[136:139], v[8:11], v[24:39]
  v_mfma_f32_32x32x16_bf16 v[88:103], v[140:143], v[12:15], v[88:103]
  v_mfma_f32_32x32x16_bf16 v[104:119], v[136:139], v[16:19], v[40:55]
  v_mfma_f32_32x32x16_bf16 v[104:119], v[140:143], v[20:23], v[104:119]
  s_nop 9
  v_exp_f32 v88, v88
  v_exp_f32 v89, v89
  v_exp_f32 v90, v90
  v_exp_f32 v91, v91
  v_exp_f32 v92, v92
  v_exp_f32 v93, v93
  v_exp_f32 v94, v94
  v_exp_f32 v95, v95
  v_exp_f32 v96, v96
  v_exp_f32 v97, v97
  v_exp_f32 v98, v98
  v_exp_f32 v99, v99
  v_exp_f32 v100, v100
  v_exp_f32 v101, v101
  v_exp_f32 v102, v102
  v_exp_f32 v103, v103
  v_cvt_pk_bf16_f32 v120, v88, v89
  v_cvt_pk_bf16_f32 v121, v90, v91
  v_cvt_pk_bf16_f32 v122, v92, v93
  v_cvt_pk_bf16_f32 v123, v94, v95
  v_cvt_pk_bf16_f32 v124, v96, v97
  v_cvt_pk_bf16_f32 v125, v98, v99
  v_cvt_pk_bf16_f32 v126, v100, v101
  v_cvt_pk_bf16_f32 v127, v102, v103
  v_mfma_f32_32x32x16_bf16 v[56:71], v[144:147], v[120:123], v[56:71]
  s_nop 0
  v_mfma_f32_32x32x16_bf16 v[56:71], v[148:151], v[124:127], v[56:71]
  v_exp_f32 v104, v104
  v_exp_f32 v105, v105
  v_exp_f32 v106, v106
  v_exp_f32 v107, v107
  v_exp_f32 v108, v108
  v_exp_f32 v109, v109
  v_exp_f32 v110, v110
  v_exp_f32 v111, v111
  v_exp_f32 v112, v112
  v_exp_f32 v113, v113
  v_exp_f32 v114, v114
  v_exp_f32 v115, v115
  v_exp_f32 v116, v116
  v_exp_f32 v117, v117
  v_exp_f32 v118, v118
  v_exp_f32 v119, v119
  v_cvt_pk_bf16_f32 v128, v104, v105
  v_cvt_pk_bf16_f32 v129, v106, v107
  v_cvt_pk_bf16_f32 v130, v108, v109
  v_cvt_pk_bf16_f32 v131, v110, v111
  v_cvt_pk_bf16_f32 v132, v112, v113
  v_cvt_pk_bf16_f32 v133, v114, v115
  v_cvt_pk_bf16_f32 v134, v116, v117
  v_cvt_pk_bf16_f32 v135, v118, v119
  v_mfma_f32_32x32x16_bf16 v[72:87], v[144:147], v[128:131], v[72:87]
  s_nop 0
  v_mfma_f32_32x32x16_bf16 v[72:87], v[148:151], v[132:135], v[72:87]
  buffer_load_dwordx4 v[136:139], v1, s[4:7], s25 offen
  buffer_load_dwordx4 v[140:143], v1, s[4:7], s25 offen offset:1024
  buffer_load_dwordx4 v[144:147], v1, s[4:7], s26 offen
  buffer_load_dwordx4 v[148:151], v1, s[4:7], s26 offen offset:1024
  s_add_u32 s25, s25, 2048
  s_add_u32 s26, s26, 2048
  s_waitcnt vmcnt(8)
  v_mfma_f32_32x32x16_bf16 v[88:103], v[152:155], v[8:11], v[24:39]
  v_mfma_f32_32x32x16_bf16 v[88:103], v[156:159], v[12:15], v[88:103]
  v_mfma_f32_32x32x16_bf16 v[104:119], v[152:155], v[16:19], v[40:55]
  v_mfma_f32_32x32x16_bf16 v[104:119], v[156:159], v[20:23], v[104:119]
  s_nop 9
  v_exp_f32 v88, v88
  v_exp_f32 v89, v89
  v_exp_f32 v90, v90
  v_exp_f32 v91, v91
  v_exp_f32 v92, v92
  v_exp_f32 v93, v93
  v_exp_f32 v94, v94
  v_exp_f32 v95, v95
  v_exp_f32 v96, v96
  v_exp_f32 v97, v97
  v_exp_f32 v98, v98
  v_exp_f32 v99, v99
  v_exp_f32 v100, v100
  v_exp_f32 v101, v101
  v_exp_f32 v102, v102
  v_exp_f32 v103, v103
  v_cvt_pk_bf16_f32 v120, v88, v89
  v_cvt_pk_bf16_f32 v121, v90, v91
  v_cvt_pk_bf16_f32 v122, v92, v93
  v_cvt_pk_bf16_f32 v123, v94, v95
  v_cvt_pk_bf16_f32 v124, v96, v97
  v_cvt_pk_bf16_f32 v125, v98, v99
  v_cvt_pk_bf16_f32 v126, v100, v101
  v_cvt_pk_bf16_f32 v127, v102, v103
  v_mfma_f32_32x32x16_bf16 v[56:71], v[160:163], v[120:123], v[56:71]
  s_nop 0
  v_mfma_f32_32x32x16_bf16 v[56:71], v[164:167], v[124:127], v[56:71]
  v_exp_f32 v104, v104
  v_exp_f32 v105, v105
  v_exp_f32 v106, v106
  v_exp_f32 v107, v107
  v_exp_f32 v108, v108
  v_exp_f32 v109, v109
  v_exp_f32 v110, v110
  v_exp_f32 v111, v111
  v_exp_f32 v112, v112
  v_exp_f32 v113, v113
  v_exp_f32 v114, v114
  v_exp_f32 v115, v115
  v_exp_f32 v116, v116
  v_exp_f32 v117, v117
  v_exp_f32 v118, v118
  v_exp_f32 v119, v119
  v_cvt_pk_bf16_f32 v128, v104, v105
  v_cvt_pk_bf16_f32 v129, v106, v107
  v_cvt_pk_bf16_f32 v130, v108, v109
  v_cvt_pk_bf16_f32 v131, v110, v111
  v_cvt_pk_bf16_f32 v132, v112, v113
  v_cvt_pk_bf16_f32 v133, v114, v115
  v_cvt_pk_bf16_f32 v134, v116, v117
  v_cvt_pk_bf16_f32 v135, v118, v119
  v_mfma_f32_32x32x16_bf16 v[72:87], v[160:163], v[128:131], v[72:87]
  s_nop 0
  v_mfma_f32_32x32x16_bf16 v[72:87], v[164:167], v[132:135], v[72:87]
  buffer_load_dwordx4 v[152:155], v1, s[4:7], s25 offen
  buffer_load_dwordx4 v[156:159], v1, s[4:7], s25 offen offset:1024
  buffer_load_dwordx4 v[160:163], v1, s[4:7], s26 offen
  buffer_load_dwordx4 v[164:167], v1, s[4:7], s26 offen offset:1024
  s_add_u32 s25, s25, 2048
  s_add_u32 s26, s26, 2048
  s_waitcnt vmcnt(8)
  v_mfma_f32_32x32x16_bf16 v[88:103], v[168:171], v[8:11], v[24:39]
  v_mfma_f32_32x32x16_bf16 v[88:103], v[172:175], v[12:15], v[88:103]
  v_mfma_f32_32x32x16_bf16 v[104:119], v[168:171], v[16:19], v[40:55]
  v_mfma_f32_32x32x16_bf16 v[104:119], v[172:175], v[20:23], v[104:119]
  s_nop 9
  v_exp_f32 v88, v88
  v_exp_f32 v89, v89
  v_exp_f32 v90, v90
  v_exp_f32 v91, v91
  v_exp_f32 v92, v92
  v_exp_f32 v93, v93
  v_exp_f32 v94, v94
  v_exp_f32 v95, v95
  v_exp_f32 v96, v96
  v_exp_f32 v97, v97
  v_exp_f32 v98, v98
  v_exp_f32 v99, v99
  v_exp_f32 v100, v100
  v_exp_f32 v101, v101
  v_exp_f32 v102, v102
  v_exp_f32 v103, v103
  v_cvt_pk_bf16_f32 v120, v88, v89
  v_cvt_pk_bf16_f32 v121, v90, v91
  v_cvt_pk_bf16_f32 v122, v92, v93
  v_cvt_pk_bf16_f32 v123, v94, v95
  v_cvt_pk_bf16_f32 v124, v96, v97
  v_cvt_pk_bf16_f32 v125, v98, v99
  v_cvt_pk_bf16_f32 v126, v100, v101
  v_cvt_pk_bf16_f32 v127, v102, v103
  v_mfma_f32_32x32x16_bf16 v[56:71], v[176:179], v[120:123], v[56:71]
  s_nop 0
  v_mfma_f32_32x32x16_bf16 v[56:71], v[180:183], v[124:127], v[56:71]
  v_exp_f32 v104, v104
  v_exp_f32 v105, v105
  v_exp_f32 v106, v106
  v_exp_f32 v107, v107
  v_exp_f32 v108, v108
  v_exp_f32 v109, v109
  v_exp_f32 v110, v110
  v_exp_f32 v111, v111
  v_exp_f32 v112, v112
  v_exp_f32 v113, v113
  v_exp_f32 v114, v114
  v_exp_f32 v115, v115
  v_exp_f32 v116, v116
  v_exp_f32 v117, v117
  v_exp_f32 v118, v118
  v_exp_f32 v119, v119
  v_cvt_pk_bf16_f32 v128, v104, v105
  v_cvt_pk_bf16_f32 v129, v106, v107
  v_cvt_pk_bf16_f32 v130, v108, v109
  v_cvt_pk_bf16_f32 v131, v110, v111
  v_cvt_pk_bf16_f32 v132, v112, v113
  v_cvt_pk_bf16_f32 v133, v114, v115
  v_cvt_pk_bf16_f32 v134, v116, v117
  v_cvt_pk_bf16_f32 v135, v118, v119
  v_mfma_f32_32x32x16_bf16 v[72:87], v[176:179], v[128:131], v[72:87]
  s_nop 0
  v_mfma_f32_32x32x16_bf16 v[72:87], v[180:183], v[132:135], v[72:87]
  s_add_u32 s27, s27, 1
  s_cmp_lt_u32 s27, 20
  s_cbranch_scc1 attnb_loop3
  buffer_load_dwordx4 v[168:171], v1, s[4:7], s25 offen
  buffer_load_dwordx4 v[172:175], v1, s[4:7], s25 offen offset:1024
  buffer_load_dwordx4 v[176:179], v1, s[4:7], s26 offen
  buffer_load_dwordx4 v[180:183], v1, s[4:7], s26 offen offset:1024
  s_add_u32 s25, s25, 2048
  s_add_u32 s26, s26, 2048
  s_waitcnt vmcnt(8)
  v_mfma_f32_32x32x16_bf16 v[88:103], v[136:139], v[8:11], v[24:39]
  v_mfma_f32_32x32x16_bf16 v[88:103], v[140:143], v[12:15], v[88:103]
  v_mfma_f32_32x32x16_bf16 v[104:119], v[136:139], v[16:19], v[40:55]
  v_mfma_f32_32x32x16_bf16 v[104:119], v[140:143], v[20:23], v[104:119]
  s_nop 9
  v_exp_f32 v88, v88
  v_exp_f32 v89, v89
  v_exp_f32 v90, v90
  v_exp_f32 v91, v91
  v_exp_f32 v92, v92
  v_exp_f32 v93, v93
  v_exp_f32 v94, v94
  v_exp_f32 v95, v95
  v_exp_f32 v96, v96
  v_exp_f32 v97, v97
  v_exp_f32 v98, v98
  v_exp_f32 v99, v99
  v_exp_f32 v100, v100
  v_exp_f32 v101, v101
  v_exp_f32 v102, v102
  v_exp_f32 v103, v103
  v_cvt_pk_bf16_f32 v120, v88, v89
  v_cvt_pk_bf16_f32 v121, v90, v91
  v_cvt_pk_bf16_f32 v122, v92, v93
  v_cvt_pk_bf16_f32 v123, v94, v95
  v_cvt_pk_bf16_f32 v124, v96, v97
  v_cvt_pk_bf16_f32 v125, v98, v99
  v_cvt_pk_bf16_f32 v126, v100, v101
  v_cvt_pk_bf16_f32 v127, v102, v103
  v_mfma_f32_32x32x16_bf16 v[56:71], v[144:147], v[120:123], v[56:71]
  s_nop 0
  v_mfma_f32_32x32x16_bf16 v[56:71], v[148:151], v[124:127], v[56:71]
  v_exp_f32 v104, v104
  v_exp_f32 v105, v105
  v_exp_f32 v106, v106
  v_exp_f32 v107, v107
  v_exp_f32 v108, v108
  v_exp_f32 v109, v109
  v_exp_f32 v110, v110
  v_exp_f32 v111, v111
  v_exp_f32 v112, v112
  v_exp_f32 v113, v113
  v_exp_f32 v114, v114
  v_exp_f32 v115, v115
  v_exp_f32 v116, v116
  v_exp_f32 v117, v117
  v_exp_f32 v118, v118
  v_exp_f32 v119, v119
  v_cvt_pk_bf16_f32 v128, v104, v105
  v_cvt_pk_bf16_f32 v129, v106, v107
  v_cvt_pk_bf16_f32 v130, v108, v109
  v_cvt_pk_bf16_f32 v131, v110, v111
  v_cvt_pk_bf16_f32 v132, v112, v113
  v_cvt_pk_bf16_f32 v133, v114, v115
  v_cvt_pk_bf16_f32 v134, v116, v117
  v_cvt_pk_bf16_f32 v135, v118, v119
  v_mfma_f32_32x32x16_bf16 v[72:87], v[144:147], v[128:131], v[72:87]
  s_nop 0
  v_mfma_f32_32x32x16_bf16 v[72:87], v[148:151], v[132:135], v[72:87]
  buffer_load_dwordx4 v[136:139], v1, s[4:7], s25 offen
  buffer_load_dwordx4 v[140:143], v1, s[4:7], s25 offen offset:1024
  buffer_load_dwordx4 v[144:147], v1, s[4:7], s26 offen
  buffer_load_dwordx4 v[148:151], v1, s[4:7], s26 offen offset:1024
  s_add_u32 s25, s25, 2048
  s_add_u32 s26, s26, 2048
  s_waitcnt vmcnt(8)
  v_mfma_f32_32x32x16_bf16 v[88:103], v[152:155], v[8:11], v[24:39]
  v_mfma_f32_32x32x16_bf16 v[88:103], v[156:159], v[12:15], v[88:103]
  v_mfma_f32_32x32x16_bf16 v[104:119], v[152:155], v[16:19], v[40:55]
  v_mfma_f32_32x32x16_bf16 v[104:119], v[156:159], v[20:23], v[104:119]
  s_nop 9
  v_exp_f32 v88, v88
  v_exp_f32 v89, v89
  v_exp_f32 v90, v90
  v_exp_f32 v91, v91
  v_exp_f32 v92, v92
  v_exp_f32 v93, v93
  v_exp_f32 v94, v94
  v_exp_f32 v95, v95
  v_exp_f32 v96, v96
  v_exp_f32 v97, v97
  v_exp_f32 v98, v98
  v_exp_f32 v99, v99
  v_exp_f32 v100, v100
  v_exp_f32 v101, v101
  v_exp_f32 v102, v102
  v_exp_f32 v103, v103
  v_cvt_pk_bf16_f32 v120, v88, v89
  v_cvt_pk_bf16_f32 v121, v90, v91
  v_cvt_pk_bf16_f32 v122, v92, v93
  v_cvt_pk_bf16_f32 v123, v94, v95
  v_cvt_pk_bf16_f32 v124, v96, v97
  v_cvt_pk_bf16_f32 v125, v98, v99
  v_cvt_pk_bf16_f32 v126, v100, v101
  v_cvt_pk_bf16_f32 v127, v102, v103
  v_mfma_f32_32x32x16_bf16 v[56:71], v[160:163], v[120:123], v[56:71]
  s_nop 0
  v_mfma_f32_32x32x16_bf16 v[56:71], v[164:167], v[124:127], v[56:71]
  v_exp_f32 v104, v104
  v_exp_f32 v105, v105
  v_exp_f32 v106, v106
  v_exp_f32 v107, v107
  v_exp_f32 v108, v108
  v_exp_f32 v109, v109
  v_exp_f32 v110, v110
  v_exp_f32 v111, v111
  v_exp_f32 v112, v112
  v_exp_f32 v113, v113
  v_exp_f32 v114, v114
  v_exp_f32 v115, v115
  v_exp_f32 v116, v116
  v_exp_f32 v117, v117
  v_exp_f32 v118, v118
  v_exp_f32 v119, v119
  v_cvt_pk_bf16_f32 v128, v104, v105
  v_cvt_pk_bf16_f32 v129, v106, v107
  v_cvt_pk_bf16_f32 v130, v108, v109
  v_cvt_pk_bf16_f32 v131, v110, v111
  v_cvt_pk_bf16_f32 v132, v112, v113
  v_cvt_pk_bf16_f32 v133, v114, v115
  v_cvt_pk_bf16_f32 v134, v116, v117
  v_cvt_pk_bf16_f32 v135, v118, v119
  v_mfma_f32_32x32x16_bf16 v[72:87], v[160:163], v[128:131], v[72:87]
  s_nop 0
  v_mfma_f32_32x32x16_bf16 v[72:87], v[164:167], v[132:135], v[72:87]
  s_waitcnt vmcnt(4)
  v_mfma_f32_32x32x16_bf16 v[88:103], v[168:171], v[8:11], v[24:39]
  v_mfma_f32_32x32x16_bf16 v[88:103], v[172:175], v[12:15], v[88:103]
  v_mfma_f32_32x32x16_bf16 v[104:119], v[168:171], v[16:19], v[40:55]
  v_mfma_f32_32x32x16_bf16 v[104:119], v[172:175], v[20:23], v[104:119]
  s_nop 9
  v_exp_f32 v88, v88
  v_exp_f32 v89, v89
  v_exp_f32 v90, v90
  v_exp_f32 v91, v91
  v_exp_f32 v92, v92
  v_exp_f32 v93, v93
  v_exp_f32 v94, v94
  v_exp_f32 v95, v95
  v_exp_f32 v96, v96
  v_exp_f32 v97, v97
  v_exp_f32 v98, v98
  v_exp_f32 v99, v99
  v_exp_f32 v100, v100
  v_exp_f32 v101, v101
  v_exp_f32 v102, v102
  v_exp_f32 v103, v103
  v_cvt_pk_bf16_f32 v120, v88, v89
  v_cvt_pk_bf16_f32 v121, v90, v91
  v_cvt_pk_bf16_f32 v122, v92, v93
  v_cvt_pk_bf16_f32 v123, v94, v95
  v_cvt_pk_bf16_f32 v124, v96, v97
  v_cvt_pk_bf16_f32 v125, v98, v99
  v_cvt_pk_bf16_f32 v126, v100, v101
  v_cvt_pk_bf16_f32 v127, v102, v103
  v_mfma_f32_32x32x16_bf16 v[56:71], v[176:179], v[120:123], v[56:71]
  s_nop 0
  v_mfma_f32_32x32x16_bf16 v[56:71], v[180:183], v[124:127], v[56:71]
  v_exp_f32 v104, v104
  v_exp_f32 v105, v105
  v_exp_f32 v106, v106
  v_exp_f32 v107, v107
  v_exp_f32 v108, v108
  v_exp_f32 v109, v109
  v_exp_f32 v110, v110
  v_exp_f32 v111, v111
  v_exp_f32 v112, v112
  v_exp_f32 v113, v113
  v_exp_f32 v114, v114
  v_exp_f32 v115, v115
  v_exp_f32 v116, v116
  v_exp_f32 v117, v117
  v_exp_f32 v118, v118
  v_exp_f32 v119, v119
  v_cvt_pk_bf16_f32 v128, v104, v105
  v_cvt_pk_bf16_f32 v129, v106, v107
  v_cvt_pk_bf16_f32 v130, v108, v109
  v_cvt_pk_bf16_f32 v131, v110, v111
  v_cvt_pk_bf16_f32 v132, v112, v113
  v_cvt_pk_bf16_f32 v133, v114, v115
  v_cvt_pk_bf16_f32 v134, v116, v117
  v_cvt_pk_bf16_f32 v135, v118, v119
  v_mfma_f32_32x32x16_bf16 v[72:87], v[176:179], v[128:131], v[72:87]
  s_nop 0
  v_mfma_f32_32x32x16_bf16 v[72:87], v[180:183], v[132:135], v[72:87]
  s_waitcnt vmcnt(0)
  v_mfma_f32_32x32x16_bf16 v[88:103], v[136:139], v[8:11], v[24:39]
  v_mfma_f32_32x32x16_bf16 v[88:103], v[140:143], v[12:15], v[88:103]
  v_mfma_f32_32x32x16_bf16 v[104:119], v[136:139], v[16:19], v[40:55]
  v_mfma_f32_32x32x16_bf16 v[104:119], v[140:143], v[20:23], v[104:119]
  s_nop 9
  v_exp_f32 v88, v88
  v_exp_f32 v89, v89
  v_exp_f32 v90, v90
  v_exp_f32 v91, v91
  v_exp_f32 v92, v92
  v_exp_f32 v93, v93
  v_exp_f32 v94, v94
  v_exp_f32 v95, v95
  v_exp_f32 v96, v96
  v_exp_f32 v97, v97
  v_exp_f32 v98, v98
  v_exp_f32 v99, v99
  v_exp_f32 v100, v100
  v_exp_f32 v101, v101
  v_exp_f32 v102, v102
  v_exp_f32 v103, v103
  v_cvt_pk_bf16_f32 v120, v88, v89
  v_cvt_pk_bf16_f32 v121, v90, v91
  v_cvt_pk_bf16_f32 v122, v92, v93
  v_cvt_pk_bf16_f32 v123, v94, v95
  v_cvt_pk_bf16_f32 v124, v96, v97
  v_cvt_pk_bf16_f32 v125, v98, v99
  v_cvt_pk_bf16_f32 v126, v100, v101
  v_cvt_pk_bf16_f32 v127, v102, v103
  v_mfma_f32_32x32x16_bf16 v[56:71], v[144:147], v[120:123], v[56:71]
  s_nop 0
  v_mfma_f32_32x32x16_bf16 v[56:71], v[148:151], v[124:127], v[56:71]
  v_exp_f32 v104, v104
  v_exp_f32 v105, v105
  v_exp_f32 v106, v106
  v_exp_f32 v107, v107
  v_exp_f32 v108, v108
  v_exp_f32 v109, v109
  v_exp_f32 v110, v110
  v_exp_f32 v111, v111
  v_exp_f32 v112, v112
  v_exp_f32 v113, v113
  v_exp_f32 v114, v114
  v_exp_f32 v115, v115
  v_exp_f32 v116, v116
  v_exp_f32 v117, v117
  v_exp_f32 v118, v118
  v_exp_f32 v119, v119
  v_cvt_pk_bf16_f32 v128, v104, v105
  v_cvt_pk_bf16_f32 v129, v106, v107
  v_cvt_pk_bf16_f32 v130, v108, v109
  v_cvt_pk_bf16_f32 v131, v110, v111
  v_cvt_pk_bf16_f32 v132, v112, v113
  v_cvt_pk_bf16_f32 v133, v114, v115
  v_cvt_pk_bf16_f32 v134, v116, v117
  v_cvt_pk_bf16_f32 v135, v118, v119
  v_mfma_f32_32x32x16_bf16 v[72:87], v[144:147], v[128:131], v[72:87]
  s_nop 0
  v_mfma_f32_32x32x16_bf16 v[72:87], v[148:151], v[132:135], v[72:87]
  v_mov_b32 v2, v64
  v_mov_b32 v4, v2
  s_nop 1
  v_permlane32_swap_b32 v4, v2
  s_nop 6
  v_mov_b32 v3, v80
  v_mov_b32 v4, v3
  s_nop 1
  v_permlane32_swap_b32 v4, v3
  s_cmp_eq_u32 s28, 1
  s_cbranch_scc1 attnb_done5
  v_max_f32 v4, v2, v3
  v_cmp_nge_f32 vcc, 0x53800000, v4
  v_cmp_u_f32 s[30:31], v2, v3
  s_nop 3
  s_or_b64 vcc, vcc, s[30:31]
  s_cbranch_vccz attnb_done5
  s_mov_b32 s25, s21
  s_mov_b32 s27, 0
  v_mov_b32 v120, 0xff800000
  v_mov_b32 v121, 0xff800000
attnb_fb4:
  buffer_load_dwordx4 v[136:139], v1, s[4:7], s25 offen
  buffer_load_dwordx4 v[140:143], v1, s[4:7], s25 offen offset:1024
  s_add_u32 s25, s25, 2048
  s_waitcnt vmcnt(0)
  v_mfma_f32_32x32x16_bf16 v[88:103], v[136:139], v[8:11], 0
  v_mfma_f32_32x32x16_bf16 v[88:103], v[140:143], v[12:15], v[88:103]
  v_mfma_f32_32x32x16_bf16 v[104:119], v[136:139], v[16:19], 0
  v_mfma_f32_32x32x16_bf16 v[104:119], v[140:143], v[20:23], v[104:119]
  s_nop 9
  v_max3_f32 v2, v88, v89, v90
  v_max3_f32 v2, v2, v91, v92
  v_max3_f32 v2, v2, v93, v94
  v_max3_f32 v2, v2, v95, v96
  v_max3_f32 v2, v2, v97, v98
  v_max3_f32 v2, v2, v99, v100
  v_max3_f32 v2, v2, v101, v102
  v_max_f32 v2, v2, v103
  v_max_f32 v120, v120, v2
  v_max3_f32 v3, v104, v105, v106
  v_max3_f32 v3, v3, v107, v108
  v_max3_f32 v3, v3, v109, v110
  v_max3_f32 v3, v3, v111, v112
  v_max3_f32 v3, v3, v113, v114
  v_max3_f32 v3, v3, v115, v116
  v_max3_f32 v3, v3, v117, v118
  v_max_f32 v3, v3, v119
  v_max_f32 v121, v121, v3
  s_add_u32 s27, s27, 1
  s_cmp_lt_u32 s27, 64
  s_cbranch_scc1 attnb_fb4
  v_mov_b32 v4, v120
  s_nop 1
  v_permlane32_swap_b32 v120, v4
  v_max_f32 v120, v120, v4
  v_sub_f32 v24, 0, v120
  v_sub_f32 v25, 0, v120
  v_sub_f32 v26, 0, v120
  v_sub_f32 v27, 0, v120
  v_sub_f32 v28, 0, v120
  v_sub_f32 v29, 0, v120
  v_sub_f32 v30, 0, v120
  v_sub_f32 v31, 0, v120
  v_sub_f32 v32, 0, v120
  v_sub_f32 v33, 0, v120
  v_sub_f32 v34, 0, v120
  v_sub_f32 v35, 0, v120
  v_sub_f32 v36, 0, v120
  v_sub_f32 v37, 0, v120
  v_sub_f32 v38, 0, v120
  v_sub_f32 v39, 0, v120
  v_mov_b32 v4, v121
  s_nop 1
  v_permlane32_swap_b32 v121, v4
  v_max_f32 v121, v121, v4
  v_sub_f32 v40, 0, v121
  v_sub_f32 v41, 0, v121
  v_sub_f32 v42, 0, v121
  v_sub_f32 v43, 0, v121
  v_sub_f32 v44, 0, v121
  v_sub_f32 v45, 0, v121
  v_sub_f32 v46, 0, v121
  v_sub_f32 v47, 0, v121
  v_sub_f32 v48, 0, v121
  v_sub_f32 v49, 0, v121
  v_sub_f32 v50, 0, v121
  v_sub_f32 v51, 0, v121
  v_sub_f32 v52, 0, v121
  v_sub_f32 v53, 0, v121
  v_sub_f32 v54, 0, v121
  v_sub_f32 v55, 0, v121
  s_mov_b32 s28, 1
  s_branch attnb_main2
attnb_done5:
  v_and_b32 v136, 63, v0
  v_and_b32 v137, 15, v136
  v_lshlrev_b32 v137, 4, v137
  v_lshrrev_b32 v138, 5, v136
  v_lshl_add_u32 v137, v138, 8, v137
  v_bfe_u32 v138, v136, 4, 1
  v_lshl_add_u32 v137, v138, 15, v137
  s_lshl_b32 s24, s23, 16
  s_lshl_b32 s25, s17, 10
  s_add_u32 s24, s24, s25
  s_add_u32 s24, s24, 174063616
  v_rcp_f32 v4, v2
  s_nop 0
  v_mul_f32 v56, v56, v4
  v_mul_f32 v57, v57, v4
  v_mul_f32 v58, v58, v4
  v_mul_f32 v59, v59, v4
  v_mul_f32 v60, v60, v4
  v_mul_f32 v61, v61, v4
  v_mul_f32 v62, v62, v4
  v_mul_f32 v63, v63, v4
  v_mul_f32 v64, v64, v4
  v_mul_f32 v65, v65, v4
  v_mul_f32 v66, v66, v4
  v_mul_f32 v67, v67, v4
  v_mul_f32 v68, v68, v4
  v_mul_f32 v69, v69, v4
  v_mul_f32 v70, v70, v4
  v_mul_f32 v71, v71, v4
  v_cvt_pk_bf16_f32 v120, v56, v57
  v_cvt_pk_bf16_f32 v121, v58, v59
  v_cvt_pk_bf16_f32 v122, v60, v61
  v_cvt_pk_bf16_f32 v123, v62, v63
  v_cvt_pk_bf16_f32 v124, v64, v65
  v_cvt_pk_bf16_f32 v125, v66, v67
  v_cvt_pk_bf16_f32 v126, v68, v69
  v_cvt_pk_bf16_f32 v127, v70, v71
  buffer_store_dwordx4 v[120:123], v137, s[4:7], s24 offen
  buffer_store_dwordx4 v[124:127], v137, s[4:7], s24 offen offset:512
  v_rcp_f32 v4, v3
  s_nop 0
  v_mul_f32 v72, v72, v4
  v_mul_f32 v73, v73, v4
  v_mul_f32 v74, v74, v4
  v_mul_f32 v75, v75, v4
  v_mul_f32 v76, v76, v4
  v_mul_f32 v77, v77, v4
  v_mul_f32 v78, v78, v4
  v_mul_f32 v79, v79, v4
  v_mul_f32 v80, v80, v4
  v_mul_f32 v81, v81, v4
  v_mul_f32 v82, v82, v4
  v_mul_f32 v83, v83, v4
  v_mul_f32 v84, v84, v4
  v_mul_f32 v85, v85, v4
  v_mul_f32 v86, v86, v4
  v_mul_f32 v87, v87, v4
  v_cvt_pk_bf16_f32 v128, v72, v73
  v_cvt_pk_bf16_f32 v129, v74, v75
  v_cvt_pk_bf16_f32 v130, v76, v77
  v_cvt_pk_bf16_f32 v131, v78, v79
  v_cvt_pk_bf16_f32 v132, v80, v81
  v_cvt_pk_bf16_f32 v133, v82, v83
  v_cvt_pk_bf16_f32 v134, v84, v85
  v_cvt_pk_bf16_f32 v135, v86, v87
  s_add_u32 s24, s24, 65536
  buffer_store_dwordx4 v[128:131], v137, s[4:7], s24 offen
  buffer_store_dwordx4 v[132:135], v137, s[4:7], s24 offen offset:512
attnb_exit1:
  s_endpgm
.globl outb1_kernel
.p2align 8
.type outb1_kernel,@function
outb1_kernel:
  s_cmp_ge_u32 s2, 256
  s_cbranch_scc1 outb1_exit1
  s_load_dwordx2 s[12:13], s[0:1], 96
  s_load_dwordx2 s[14:15], s[0:1], 0
  s_load_dwordx2 s[48:49], s[0:1], 80
  v_lshrrev_b32 v3, 6, v0
  v_and_b32 v4, 63, v0
  s_nop 0
  v_readfirstlane_b32 s16, v3
  v_lshlrev_b32 v1, 4, v4
  s_and_b32 s17, s2, 7
  s_lshl_b32 s17, s17, 2
  s_lshr_b32 s18, s2, 3
  s_and_b32 s19, s18, 3
  s_add_u32 s17, s17, s19
  s_lshr_b32 s18, s18, 2
  s_waitcnt lgkmcnt(0)
  s_mov_b32 s4, s12
  s_mov_b32 s5, s13
  s_mov_b32 s6, 0x10000000
  s_mov_b32 s7, 0x20000
  s_mov_b32 s8, s12
  s_mov_b32 s9, s13
  s_mov_b32 s10, 0x10000000
  s_mov_b32 s11, 0x20000
  s_mov_b32 s20, 150994944
  s_mov_b32 s52, s48
  s_mov_b32 s53, s49
  s_mov_b32 s54, 2621440
  s_mov_b32 s55, 0x20000
  s_mul_i32 s21, s18, 5
  s_mul_i32 s21, s21, 32768
  s_add_u32 s24, s21, 160169984
  s_add_u32 s25, s24, 32768
  s_add_u32 s26, s25, 32768
  s_add_u32 s27, s26, 32768
  s_add_u32 s28, s27, 32768
  s_lshl_b32 s21, s17, 2
  s_add_u32 s21, s21, s16
  s_mul_i32 s22, s21, 32768
  s_add_u32 s22, s22, 174063616
  s_lshl_b32 s23, s16, 10
  v_add_u32 v2, s23, v1
  s_mul_i32 s29, s16, 5120
  s_add_u32 m0, s29, 0
  s_nop 0
  buffer_load_dwordx4 v2, s[4:7], s24 offen lds
  s_add_u32 m0, s29, 1024
  s_nop 0
  buffer_load_dwordx4 v2, s[4:7], s25 offen lds
  s_add_u32 m0, s29, 2048
  s_nop 0
  buffer_load_dwordx4 v2, s[4:7], s26 offen lds
  s_add_u32 m0, s29, 3072
  s_nop 0
  buffer_load_dwordx4 v2, s[4:7], s27 offen lds
  s_add_u32 m0, s29, 4096
  s_nop 0
  buffer_load_dwordx4 v2, s[4:7], s28 offen lds
  buffer_load_dwordx4 v[32:35], v1, s[4:7], s22 offen offset:0
  buffer_load_dwordx4 v[36:39], v1, s[4:7], s22 offen offset:1024
  buffer_load_dwordx4 v[40:43], v1, s[4:7], s22 offen offset:2048
  buffer_load_dwordx4 v[44:47], v1, s[4:7], s22 offen offset:3072
  v_add_u32 v2, 0x1000, v2
  s_add_u32 s22, s22, 4096
  s_add_u32 m0, s29, 20480
  s_nop 0
  buffer_load_dwordx4 v2, s[4:7], s24 offen lds
  s_add_u32 m0, s29, 21504
  s_nop 0
  buffer_load_dwordx4 v2, s[4:7], s25 offen lds
  s_add_u32 m0, s29, 22528
  s_nop 0
  buffer_load_dwordx4 v2, s[4:7], s26 offen lds
  s_add_u32 m0, s29, 23552
  s_nop 0
  buffer_load_dwordx4 v2, s[4:7], s27 offen lds
  s_add_u32 m0, s29, 24576
  s_nop 0
  buffer_load_dwordx4 v2, s[4:7], s28 offen lds
  buffer_load_dwordx4 v[48:51], v1, s[4:7], s22 offen offset:0
  buffer_load_dwordx4 v[52:55], v1, s[4:7], s22 offen offset:1024
  buffer_load_dwordx4 v[56:59], v1, s[4:7], s22 offen offset:2048
  buffer_load_dwordx4 v[60:63], v1, s[4:7], s22 offen offset:3072
  v_add_u32 v2, 0x1000, v2
  s_add_u32 s22, s22, 4096
  s_waitcnt vmcnt(9)
  s_barrier
  s_add_u32 m0, s29, 40960
  s_nop 0
  buffer_load_dwordx4 v2, s[4:7], s24 offen lds
  s_add_u32 m0, s29, 41984
  s_nop 0
  buffer_load_dwordx4 v2, s[4:7], s25 offen lds
  s_add_u32 m0, s29, 43008
  s_nop 0
  buffer_load_dwordx4 v2, s[4:7], s26 offen lds
  s_add_u32 m0, s29, 44032
  s_nop 0
  buffer_load_dwordx4 v2, s[4:7], s27 offen lds
  s_add_u32 m0, s29, 45056
  s_nop 0
  buffer_load_dwordx4 v2, s[4:7], s28 offen lds
  buffer_load_dwordx4 v[64:67], v1, s[4:7], s22 offen offset:0
  buffer_load_dwordx4 v[68:71], v1, s[4:7], s22 offen offset:1024
  buffer_load_dwordx4 v[72:75], v1, s[4:7], s22 offen offset:2048
  buffer_load_dwordx4 v[76:79], v1, s[4:7], s22 offen offset:3072
  v_add_u32 v2, 0x1000, v2
  s_add_u32 s22, s22, 4096
  ds_read_b128 v[80:83], v1 offset:0
  ds_read_b128 v[84:87], v1 offset:1024
  ds_read_b128 v[88:91], v1 offset:2048
  ds_read_b128 v[92:95], v1 offset:3072
  ds_read_b128 v[96:99], v1 offset:4096
  ds_read_b128 v[100:103], v1 offset:5120
  ds_read_b128 v[104:107], v1 offset:6144
  ds_read_b128 v[108:111], v1 offset:7168
  ds_read_b128 v[112:115], v1 offset:8192
  ds_read_b128 v[116:119], v1 offset:9216
  s_waitcnt lgkmcnt(5)
  v_mfma_f32_16x16x32_bf16 v[8:11], v[80:83], v[32:35], 0
  v_mfma_f32_16x16x32_bf16 v[12:15], v[84:87], v[32:35], 0
  v_mfma_f32_16x16x32_bf16 v[16:19], v[88:91], v[32:35], 0
  v_mfma_f32_16x16x32_bf16 v[20:23], v[92:95], v[32:35], 0
  v_mfma_f32_16x16x32_bf16 v[24:27], v[96:99], v[32:35], 0
  ds_read_b128 v[80:83], v1 offset:10240
  ds_read_b128 v[84:87], v1 offset:11264
  ds_read_b128 v[88:91], v1 offset:12288
  ds_read_b128 v[92:95], v1 offset:13312
  ds_read_b128 v[96:99], v1 offset:14336
  s_waitcnt lgkmcnt(5)
  v_mfma_f32_16x16x32_bf16 v[8:11], v[100:103], v[36:39], v[8:11]
  v_mfma_f32_16x16x32_bf16 v[12:15], v[104:107], v[36:39], v[12:15]
  v_mfma_f32_16x16x32_bf16 v[16:19], v[108:111], v[36:39], v[16:19]
  v_mfma_f32_16x16x32_bf16 v[20:23], v[112:115], v[36:39], v[20:23]
  v_mfma_f32_16x16x32_bf16 v[24:27], v[116:119], v[36:39], v[24:27]
  ds_read_b128 v[100:103], v1 offset:15360
  ds_read_b128 v[104:107], v1 offset:16384
  ds_read_b128 v[108:111], v1 offset:17408
  ds_read_b128 v[112:115], v1 offset:18432
  ds_read_b128 v[116:119], v1 offset:19456
  s_waitcnt lgkmcnt(5)
  v_mfma_f32_16x16x32_bf16 v[8:11], v[80:83], v[40:43], v[8:11]
  v_mfma_f32_16x16x32_bf16 v[12:15], v[84:87], v[40:43], v[12:15]
  v_mfma_f32_16x16x32_bf16 v[16:19], v[88:91], v[40:43], v[16:19]
  v_mfma_f32_16x16x32_bf16 v[20:23], v[92:95], v[40:43], v[20:23]
  v_mfma_f32_16x16x32_bf16 v[24:27], v[96:99], v[40:43], v[24:27]
  s_waitcnt lgkmcnt(0)
  v_mfma_f32_16x16x32_bf16 v[8:11], v[100:103], v[44:47], v[8:11]
  v_mfma_f32_16x16x32_bf16 v[12:15], v[104:107], v[44:47], v[12:15]
  v_mfma_f32_16x16x32_bf16 v[16:19], v[108:111], v[44:47], v[16:19]
  v_mfma_f32_16x16x32_bf16 v[20:23], v[112:115], v[44:47], v[20:23]
  v_mfma_f32_16x16x32_bf16 v[24:27], v[116:119], v[44:47], v[24:27]
  s_mov_b32 s30, 0
outb1_loop2:
  s_waitcnt vmcnt(9)
  s_barrier
  s_add_u32 m0, s29, 0
  s_nop 0
  buffer_load_dwordx4 v2, s[4:7], s24 offen lds
  s_add_u32 m0, s29, 1024
  s_nop 0
  buffer_load_dwordx4 v2, s[4:7], s25 offen lds
  s_add_u32 m0, s29, 2048
  s_nop 0
  buffer_load_dwordx4 v2, s[4:7], s26 offen lds
  s_add_u32 m0, s29, 3072
  s_nop 0
  buffer_load_dwordx4 v2, s[4:7], s27 offen lds
  s_add_u32 m0, s29, 4096
  s_nop 0
  buffer_load_dwordx4 v2, s[4:7], s28 offen lds
  buffer_load_dwordx4 v[32:35], v1, s[4:7], s22 offen offset:0
  buffer_load_dwordx4 v[36:39], v1, s[4:7], s22 offen offset:1024
  buffer_load_dwordx4 v[40:43], v1, s[4:7], s22 offen offset:2048
  buffer_load_dwordx4 v[44:47], v1, s[4:7], s22 offen offset:3072
  v_add_u32 v2, 0x1000, v2
  s_add_u32 s22, s22, 4096
  ds_read_b128 v[80:83], v1 offset:20480
  ds_read_b128 v[84:87], v1 offset:21504
  ds_read_b128 v[88:91], v1 offset:22528
  ds_read_b128 v[92:95], v1 offset:23552
  ds_read_b128 v[96:99], v1 offset:24576
  ds_read_b128 v[100:103], v1 offset:25600
  ds_read_b128 v[104:107], v1 offset:26624
  ds_read_b128 v[108:111], v1 offset:27648
  ds_read_b128 v[112:115], v1 offset:28672
  ds_read_b128 v[116:119], v1 offset:29696
  s_waitcnt lgkmcnt(5)
  v_mfma_f32_16x16x32_bf16 v[8:11], v[80:83], v[48:51], v[8:11]
  v_mfma_f32_16x16x32_bf16 v[12:15], v[84:87], v[48:51], v[12:15]
  v_mfma_f32_16x16x32_bf16 v[16:19], v[88:91], v[48:51], v[16:19]
  v_mfma_f32_16x16x32_bf16 v[20:23], v[92:95], v[48:51], v[20:23]
  v_mfma_f32_16x16x32_bf16 v[24:27], v[96:99], v[48:51], v[24:27]
  ds_read_b128 v[80:83], v1 offset:30720
  ds_read_b128 v[84:87], v1 offset:31744
  ds_read_b128 v[88:91], v1 offset:32768
  ds_read_b128 v[92:95], v1 offset:33792
  ds_read_b128 v[96:99], v1 offset:34816
  s_waitcnt lgkmcnt(5)
  v_mfma_f32_16x16x32_bf16 v[8:11], v[100:103], v[52:55], v[8:11]
  v_mfma_f32_16x16x32_bf16 v[12:15], v[104:107], v[52:55], v[12:15]
  v_mfma_f32_16x16x32_bf16 v[16:19], v[108:111], v[52:55], v[16:19]
  v_mfma_f32_16x16x32_bf16 v[20:23], v[112:115], v[52:55], v[20:23]
  v_mfma_f32_16x16x32_bf16 v[24:27], v[116:119], v[52:55], v[24:27]
  ds_read_b128 v[100:103], v1 offset:35840
  ds_read_b128 v[104:107], v1 offset:36864
  ds_read_b128 v[108:111], v1 offset:37888
  ds_read_b128 v[112:115], v1 offset:38912
  ds_read_b128 v[116:119], v1 offset:39936
  s_waitcnt lgkmcnt(5)
  v_mfma_f32_16x16x32_bf16 v[8:11], v[80:83], v[56:59], v[8:11]
  v_mfma_f32_16x16x32_bf16 v[12:15], v[84:87], v[56:59], v[12:15]
  v_mfma_f32_16x16x32_bf16 v[16:19], v[88:91], v[56:59], v[16:19]
  v_mfma_f32_16x16x32_bf16 v[20:23], v[92:95], v[56:59], v[20:23]
  v_mfma_f32_16x16x32_bf16 v[24:27], v[96:99], v[56:59], v[24:27]
  s_waitcnt lgkmcnt(0)
  v_mfma_f32_16x16x32_bf16 v[8:11], v[100:103], v[60:63], v[8:11]
  v_mfma_f32_16x16x32_bf16 v[12:15], v[104:107], v[60:63], v[12:15]
  v_mfma_f32_16x16x32_bf16 v[16:19], v[108:111], v[60:63], v[16:19]
  v_mfma_f32_16x16x32_bf16 v[20:23], v[112:115], v[60:63], v[20:23]
  v_mfma_f32_16x16x32_bf16 v[24:27], v[116:119], v[60:63], v[24:27]
  s_waitcnt vmcnt(9)
  s_barrier
  s_add_u32 m0, s29, 20480
  s_nop 0
  buffer_load_dwordx4 v2, s[4:7], s24 offen lds
  s_add_u32 m0, s29, 21504
  s_nop 0
  buffer_load_dwordx4 v2, s[4:7], s25 offen lds
  s_add_u32 m0, s29, 22528
  s_nop 0
  buffer_load_dwordx4 v2, s[4:7], s26 offen lds
  s_add_u32 m0, s29, 23552
  s_nop 0
  buffer_load_dwordx4 v2, s[4:7], s27 offen lds
  s_add_u32 m0, s29, 24576
  s_nop 0
  buffer_load_dwordx4 v2, s[4:7], s28 offen lds
  buffer_load_dwordx4 v[48:51], v1, s[4:7], s22 offen offset:0
  buffer_load_dwordx4 v[52:55], v1, s[4:7], s22 offen offset:1024
  buffer_load_dwordx4 v[56:59], v1, s[4:7], s22 offen offset:2048
  buffer_load_dwordx4 v[60:63], v1, s[4:7], s22 offen offset:3072
  v_add_u32 v2, 0x1000, v2
  s_add_u32 s22, s22, 4096
  ds_read_b128 v[80:83], v1 offset:40960
  ds_read_b128 v[84:87], v1 offset:41984
  ds_read_b128 v[88:91], v1 offset:43008
  ds_read_b128 v[92:95], v1 offset:44032
  ds_read_b128 v[96:99], v1 offset:45056
  ds_read_b128 v[100:103], v1 offset:46080
  ds_read_b128 v[104:107], v1 offset:47104
  ds_read_b128 v[108:111], v1 offset:48128
  ds_read_b128 v[112:115], v1 offset:49152
  ds_read_b128 v[116:119], v1 offset:50176
  s_waitcnt lgkmcnt(5)
  v_mfma_f32_16x16x32_bf16 v[8:11], v[80:83], v[64:67], v[8:11]
  v_mfma_f32_16x16x32_bf16 v[12:15], v[84:87], v[64:67], v[12:15]
  v_mfma_f32_16x16x32_bf16 v[16:19], v[88:91], v[64:67], v[16:19]
  v_mfma_f32_16x16x32_bf16 v[20:23], v[92:95], v[64:67], v[20:23]
  v_mfma_f32_16x16x32_bf16 v[24:27], v[96:99], v[64:67], v[24:27]
  ds_read_b128 v[80:83], v1 offset:51200
  ds_read_b128 v[84:87], v1 offset:52224
  ds_read_b128 v[88:91], v1 offset:53248
  ds_read_b128 v[92:95], v1 offset:54272
  ds_read_b128 v[96:99], v1 offset:55296
  s_waitcnt lgkmcnt(5)
  v_mfma_f32_16x16x32_bf16 v[8:11], v[100:103], v[68:71], v[8:11]
  v_mfma_f32_16x16x32_bf16 v[12:15], v[104:107], v[68:71], v[12:15]
  v_mfma_f32_16x16x32_bf16 v[16:19], v[108:111], v[68:71], v[16:19]
  v_mfma_f32_16x16x32_bf16 v[20:23], v[112:115], v[68:71], v[20:23]
  v_mfma_f32_16x16x32_bf16 v[24:27], v[116:119], v[68:71], v[24:27]
  ds_read_b128 v[100:103], v1 offset:56320
  ds_read_b128 v[104:107], v1 offset:57344
  ds_read_b128 v[108:111], v1 offset:58368
  ds_read_b128 v[112:115], v1 offset:59392
  ds_read_b128 v[116:119], v1 offset:60416
  s_waitcnt lgkmcnt(5)
  v_mfma_f32_16x16x32_bf16 v[8:11], v[80:83], v[72:75], v[8:11]
  v_mfma_f32_16x16x32_bf16 v[12:15], v[84:87], v[72:75], v[12:15]
  v_mfma_f32_16x16x32_bf16 v[16:19], v[88:91], v[72:75], v[16:19]
  v_mfma_f32_16x16x32_bf16 v[20:23], v[92:95], v[72:75], v[20:23]
  v_mfma_f32_16x16x32_bf16 v[24:27], v[96:99], v[72:75], v[24:27]
  s_waitcnt lgkmcnt(0)
  v_mfma_f32_16x16x32_bf16 v[8:11], v[100:103], v[76:79], v[8:11]
  v_mfma_f32_16x16x32_bf16 v[12:15], v[104:107], v[76:79], v[12:15]
  v_mfma_f32_16x16x32_bf16 v[16:19], v[108:111], v[76:79], v[16:19]
  v_mfma_f32_16x16x32_bf16 v[20:23], v[112:115], v[76:79], v[20:23]
  v_mfma_f32_16x16x32_bf16 v[24:27], v[116:119], v[76:79], v[24:27]
  s_waitcnt vmcnt(9)
  s_barrier
  s_add_u32 m0, s29, 40960
  s_nop 0
  buffer_load_dwordx4 v2, s[4:7], s24 offen lds
  s_add_u32 m0, s29, 41984
  s_nop 0
  buffer_load_dwordx4 v2, s[4:7], s25 offen lds
  s_add_u32 m0, s29, 43008
  s_nop 0
  buffer_load_dwordx4 v2, s[4:7], s26 offen lds
  s_add_u32 m0, s29, 44032
  s_nop 0
  buffer_load_dwordx4 v2, s[4:7], s27 offen lds
  s_add_u32 m0, s29, 45056
  s_nop 0
  buffer_load_dwordx4 v2, s[4:7], s28 offen lds
  buffer_load_dwordx4 v[64:67], v1, s[4:7], s22 offen offset:0
  buffer_load_dwordx4 v[68:71], v1, s[4:7], s22 offen offset:1024
  buffer_load_dwordx4 v[72:75], v1, s[4:7], s22 offen offset:2048
  buffer_load_dwordx4 v[76:79], v1, s[4:7], s22 offen offset:3072
  v_add_u32 v2, 0x1000, v2
  s_add_u32 s22, s22, 4096
  ds_read_b128 v[80:83], v1 offset:0
  ds_read_b128 v[84:87], v1 offset:1024
  ds_read_b128 v[88:91], v1 offset:2048
  ds_read_b128 v[92:95], v1 offset:3072
  ds_read_b128 v[96:99], v1 offset:4096
  ds_read_b128 v[100:103], v1 offset:5120
  ds_read_b128 v[104:107], v1 offset:6144
  ds_read_b128 v[108:111], v1 offset:7168
  ds_read_b128 v[112:115], v1 offset:8192
  ds_read_b128 v[116:119], v1 offset:9216
  s_waitcnt lgkmcnt(5)
  v_mfma_f32_16x16x32_bf16 v[8:11], v[80:83], v[32:35], v[8:11]
  v_mfma_f32_16x16x32_bf16 v[12:15], v[84:87], v[32:35], v[12:15]
  v_mfma_f32_16x16x32_bf16 v[16:19], v[88:91], v[32:35], v[16:19]
  v_mfma_f32_16x16x32_bf16 v[20:23], v[92:95], v[32:35], v[20:23]
  v_mfma_f32_16x16x32_bf16 v[24:27], v[96:99], v[32:35], v[24:27]
  ds_read_b128 v[80:83], v1 offset:10240
  ds_read_b128 v[84:87], v1 offset:11264
  ds_read_b128 v[88:91], v1 offset:12288
  ds_read_b128 v[92:95], v1 offset:13312
  ds_read_b128 v[96:99], v1 offset:14336
  s_waitcnt lgkmcnt(5)
  v_mfma_f32_16x16x32_bf16 v[8:11], v[100:103], v[36:39], v[8:11]
  v_mfma_f32_16x16x32_bf16 v[12:15], v[104:107], v[36:39], v[12:15]
  v_mfma_f32_16x16x32_bf16 v[16:19], v[108:111], v[36:39], v[16:19]
  v_mfma_f32_16x16x32_bf16 v[20:23], v[112:115], v[36:39], v[20:23]
  v_mfma_f32_16x16x32_bf16 v[24:27], v[116:119], v[36:39], v[24:27]
  ds_read_b128 v[100:103], v1 offset:15360
  ds_read_b128 v[104:107], v1 offset:16384
  ds_read_b128 v[108:111], v1 offset:17408
  ds_read_b128 v[112:115], v1 offset:18432
  ds_read_b128 v[116:119], v1 offset:19456
  s_waitcnt lgkmcnt(5)
  v_mfma_f32_16x16x32_bf16 v[8:11], v[80:83], v[40:43], v[8:11]
  v_mfma_f32_16x16x32_bf16 v[12:15], v[84:87], v[40:43], v[12:15]
  v_mfma_f32_16x16x32_bf16 v[16:19], v[88:91], v[40:43], v[16:19]
  v_mfma_f32_16x16x32_bf16 v[20:23], v[92:95], v[40:43], v[20:23]
  v_mfma_f32_16x16x32_bf16 v[24:27], v[96:99], v[40:43], v[24:27]
  s_waitcnt lgkmcnt(0)
  v_mfma_f32_16x16x32_bf16 v[8:11], v[100:103], v[44:47], v[8:11]
  v_mfma_f32_16x16x32_bf16 v[12:15], v[104:107], v[44:47], v[12:15]
  v_mfma_f32_16x16x32_bf16 v[16:19], v[108:111], v[44:47], v[16:19]
  v_mfma_f32_16x16x32_bf16 v[20:23], v[112:115], v[44:47], v[20:23]
  v_mfma_f32_16x16x32_bf16 v[24:27], v[116:119], v[44:47], v[24:27]
  s_add_u32 s30, s30, 1
  s_cmp_lt_u32 s30, 1
  s_cbranch_scc1 outb1_loop2
  s_waitcnt vmcnt(9)
  s_barrier
  s_add_u32 m0, s29, 0
  s_nop 0
  buffer_load_dwordx4 v2, s[4:7], s24 offen lds
  s_add_u32 m0, s29, 1024
  s_nop 0
  buffer_load_dwordx4 v2, s[4:7], s25 offen lds
  s_add_u32 m0, s29, 2048
  s_nop 0
  buffer_load_dwordx4 v2, s[4:7], s26 offen lds
  s_add_u32 m0, s29, 3072
  s_nop 0
  buffer_load_dwordx4 v2, s[4:7], s27 offen lds
  s_add_u32 m0, s29, 4096
  s_nop 0
  buffer_load_dwordx4 v2, s[4:7], s28 offen lds
  buffer_load_dwordx4 v[32:35], v1, s[4:7], s22 offen offset:0
  buffer_load_dwordx4 v[36:39], v1, s[4:7], s22 offen offset:1024
  buffer_load_dwordx4 v[40:43], v1, s[4:7], s22 offen offset:2048
  buffer_load_dwordx4 v[44:47], v1, s[4:7], s22 offen offset:3072
  v_add_u32 v2, 0x1000, v2
  s_add_u32 s22, s22, 4096
  ds_read_b128 v[80:83], v1 offset:20480
  ds_read_b128 v[84:87], v1 offset:21504
  ds_read_b128 v[88:91], v1 offset:22528
  ds_read_b128 v[92:95], v1 offset:23552
  ds_read_b128 v[96:99], v1 offset:24576
  ds_read_b128 v[100:103], v1 offset:25600
  ds_read_b128 v[104:107], v1 offset:26624
  ds_read_b128 v[108:111], v1 offset:27648
  ds_read_b128 v[112:115], v1 offset:28672
  ds_read_b128 v[116:119], v1 offset:29696
  s_waitcnt lgkmcnt(5)
  v_mfma_f32_16x16x32_bf16 v[8:11], v[80:83], v[48:51], v[8:11]
  v_mfma_f32_16x16x32_bf16 v[12:15], v[84:87], v[48:51], v[12:15]
  v_mfma_f32_16x16x32_bf16 v[16:19], v[88:91], v[48:51], v[16:19]
  v_mfma_f32_16x16x32_bf16 v[20:23], v[92:95], v[48:51], v[20:23]
  v_mfma_f32_16x16x32_bf16 v[24:27], v[96:99], v[48:51], v[24:27]
  ds_read_b128 v[80:83], v1 offset:30720
  ds_read_b128 v[84:87], v1 offset:31744
  ds_read_b128 v[88:91], v1 offset:32768
  ds_read_b128 v[92:95], v1 offset:33792
  ds_read_b128 v[96:99], v1 offset:34816
  s_waitcnt lgkmcnt(5)
  v_mfma_f32_16x16x32_bf16 v[8:11], v[100:103], v[52:55], v[8:11]
  v_mfma_f32_16x16x32_bf16 v[12:15], v[104:107], v[52:55], v[12:15]
  v_mfma_f32_16x16x32_bf16 v[16:19], v[108:111], v[52:55], v[16:19]
  v_mfma_f32_16x16x32_bf16 v[20:23], v[112:115], v[52:55], v[20:23]
  v_mfma_f32_16x16x32_bf16 v[24:27], v[116:119], v[52:55], v[24:27]
  ds_read_b128 v[100:103], v1 offset:35840
  ds_read_b128 v[104:107], v1 offset:36864
  ds_read_b128 v[108:111], v1 offset:37888
  ds_read_b128 v[112:115], v1 offset:38912
  ds_read_b128 v[116:119], v1 offset:39936
  s_waitcnt lgkmcnt(5)
  v_mfma_f32_16x16x32_bf16 v[8:11], v[80:83], v[56:59], v[8:11]
  v_mfma_f32_16x16x32_bf16 v[12:15], v[84:87], v[56:59], v[12:15]
  v_mfma_f32_16x16x32_bf16 v[16:19], v[88:91], v[56:59], v[16:19]
  v_mfma_f32_16x16x32_bf16 v[20:23], v[92:95], v[56:59], v[20:23]
  v_mfma_f32_16x16x32_bf16 v[24:27], v[96:99], v[56:59], v[24:27]
  s_waitcnt lgkmcnt(0)
  v_mfma_f32_16x16x32_bf16 v[8:11], v[100:103], v[60:63], v[8:11]
  v_mfma_f32_16x16x32_bf16 v[12:15], v[104:107], v[60:63], v[12:15]
  v_mfma_f32_16x16x32_bf16 v[16:19], v[108:111], v[60:63], v[16:19]
  v_mfma_f32_16x16x32_bf16 v[20:23], v[112:115], v[60:63], v[20:23]
  v_mfma_f32_16x16x32_bf16 v[24:27], v[116:119], v[60:63], v[24:27]
  s_waitcnt vmcnt(9)
  s_barrier
  s_add_u32 m0, s29, 20480
  s_nop 0
  buffer_load_dwordx4 v2, s[4:7], s24 offen lds
  s_add_u32 m0, s29, 21504
  s_nop 0
  buffer_load_dwordx4 v2, s[4:7], s25 offen lds
  s_add_u32 m0, s29, 22528
  s_nop 0
  buffer_load_dwordx4 v2, s[4:7], s26 offen lds
  s_add_u32 m0, s29, 23552
  s_nop 0
  buffer_load_dwordx4 v2, s[4:7], s27 offen lds
  s_add_u32 m0, s29, 24576
  s_nop 0
  buffer_load_dwordx4 v2, s[4:7], s28 offen lds
  buffer_load_dwordx4 v[48:51], v1, s[4:7], s22 offen offset:0
  buffer_load_dwordx4 v[52:55], v1, s[4:7], s22 offen offset:1024
  buffer_load_dwordx4 v[56:59], v1, s[4:7], s22 offen offset:2048
  buffer_load_dwordx4 v[60:63], v1, s[4:7], s22 offen offset:3072
  v_add_u32 v2, 0x1000, v2
  s_add_u32 s22, s22, 4096
  ds_read_b128 v[80:83], v1 offset:40960
  ds_read_b128 v[84:87], v1 offset:41984
  ds_read_b128 v[88:91], v1 offset:43008
  ds_read_b128 v[92:95], v1 offset:44032
  ds_read_b128 v[96:99], v1 offset:45056
  ds_read_b128 v[100:103], v1 offset:46080
  ds_read_b128 v[104:107], v1 offset:47104
  ds_read_b128 v[108:111], v1 offset:48128
  ds_read_b128 v[112:115], v1 offset:49152
  ds_read_b128 v[116:119], v1 offset:50176
  s_waitcnt lgkmcnt(5)
  v_mfma_f32_16x16x32_bf16 v[8:11], v[80:83], v[64:67], v[8:11]
  v_mfma_f32_16x16x32_bf16 v[12:15], v[84:87], v[64:67], v[12:15]
  v_mfma_f32_16x16x32_bf16 v[16:19], v[88:91], v[64:67], v[16:19]
  v_mfma_f32_16x16x32_bf16 v[20:23], v[92:95], v[64:67], v[20:23]
  v_mfma_f32_16x16x32_bf16 v[24:27], v[96:99], v[64:67], v[24:27]
  ds_read_b128 v[80:83], v1 offset:51200
  ds_read_b128 v[84:87], v1 offset:52224
  ds_read_b128 v[88:91], v1 offset:53248
  ds_read_b128 v[92:95], v1 offset:54272
  ds_read_b128 v[96:99], v1 offset:55296
  s_waitcnt lgkmcnt(5)
  v_mfma_f32_16x16x32_bf16 v[8:11], v[100:103], v[68:71], v[8:11]
  v_mfma_f32_16x16x32_bf16 v[12:15], v[104:107], v[68:71], v[12:15]
  v_mfma_f32_16x16x32_bf16 v[16:19], v[108:111], v[68:71], v[16:19]
  v_mfma_f32_16x16x32_bf16 v[20:23], v[112:115], v[68:71], v[20:23]
  v_mfma_f32_16x16x32_bf16 v[24:27], v[116:119], v[68:71], v[24:27]
  ds_read_b128 v[100:103], v1 offset:56320
  ds_read_b128 v[104:107], v1 offset:57344
  ds_read_b128 v[108:111], v1 offset:58368
  ds_read_b128 v[112:115], v1 offset:59392
  ds_read_b128 v[116:119], v1 offset:60416
  s_waitcnt lgkmcnt(5)
  v_mfma_f32_16x16x32_bf16 v[8:11], v[80:83], v[72:75], v[8:11]
  v_mfma_f32_16x16x32_bf16 v[12:15], v[84:87], v[72:75], v[12:15]
  v_mfma_f32_16x16x32_bf16 v[16:19], v[88:91], v[72:75], v[16:19]
  v_mfma_f32_16x16x32_bf16 v[20:23], v[92:95], v[72:75], v[20:23]
  v_mfma_f32_16x16x32_bf16 v[24:27], v[96:99], v[72:75], v[24:27]
  s_waitcnt lgkmcnt(0)
  v_mfma_f32_16x16x32_bf16 v[8:11], v[100:103], v[76:79], v[8:11]
  v_mfma_f32_16x16x32_bf16 v[12:15], v[104:107], v[76:79], v[12:15]
  v_mfma_f32_16x16x32_bf16 v[16:19], v[108:111], v[76:79], v[16:19]
  v_mfma_f32_16x16x32_bf16 v[20:23], v[112:115], v[76:79], v[20:23]
  v_mfma_f32_16x16x32_bf16 v[24:27], v[116:119], v[76:79], v[24:27]
  s_waitcnt vmcnt(9)
  s_barrier
  ds_read_b128 v[80:83], v1 offset:0
  ds_read_b128 v[84:87], v1 offset:1024
  ds_read_b128 v[88:91], v1 offset:2048
  ds_read_b128 v[92:95], v1 offset:3072
  ds_read_b128 v[96:99], v1 offset:4096
  ds_read_b128 v[100:103], v1 offset:5120
  ds_read_b128 v[104:107], v1 offset:6144
  ds_read_b128 v[108:111], v1 offset:7168
  ds_read_b128 v[112:115], v1 offset:8192
  ds_read_b128 v[116:119], v1 offset:9216
  s_waitcnt lgkmcnt(5)
  v_mfma_f32_16x16x32_bf16 v[8:11], v[80:83], v[32:35], v[8:11]
  v_mfma_f32_16x16x32_bf16 v[12:15], v[84:87], v[32:35], v[12:15]
  v_mfma_f32_16x16x32_bf16 v[16:19], v[88:91], v[32:35], v[16:19]
  v_mfma_f32_16x16x32_bf16 v[20:23], v[92:95], v[32:35], v[20:23]
  v_mfma_f32_16x16x32_bf16 v[24:27], v[96:99], v[32:35], v[24:27]
  ds_read_b128 v[80:83], v1 offset:10240
  ds_read_b128 v[84:87], v1 offset:11264
  ds_read_b128 v[88:91], v1 offset:12288
  ds_read_b128 v[92:95], v1 offset:13312
  ds_read_b128 v[96:99], v1 offset:14336
  s_waitcnt lgkmcnt(5)
  v_mfma_f32_16x16x32_bf16 v[8:11], v[100:103], v[36:39], v[8:11]
  v_mfma_f32_16x16x32_bf16 v[12:15], v[104:107], v[36:39], v[12:15]
  v_mfma_f32_16x16x32_bf16 v[16:19], v[108:111], v[36:39], v[16:19]
  v_mfma_f32_16x16x32_bf16 v[20:23], v[112:115], v[36:39], v[20:23]
  v_mfma_f32_16x16x32_bf16 v[24:27], v[116:119], v[36:39], v[24:27]
  ds_read_b128 v[100:103], v1 offset:15360
  ds_read_b128 v[104:107], v1 offset:16384
  ds_read_b128 v[108:111], v1 offset:17408
  ds_read_b128 v[112:115], v1 offset:18432
  ds_read_b128 v[116:119], v1 offset:19456
  s_waitcnt lgkmcnt(5)
  v_mfma_f32_16x16x32_bf16 v[8:11], v[80:83], v[40:43], v[8:11]
  v_mfma_f32_16x16x32_bf16 v[12:15], v[84:87], v[40:43], v[12:15]
  v_mfma_f32_16x16x32_bf16 v[16:19], v[88:91], v[40:43], v[16:19]
  v_mfma_f32_16x16x32_bf16 v[20:23], v[92:95], v[40:43], v[20:23]
  v_mfma_f32_16x16x32_bf16 v[24:27], v[96:99], v[40:43], v[24:27]
  s_waitcnt lgkmcnt(0)
  v_mfma_f32_16x16x32_bf16 v[8:11], v[100:103], v[44:47], v[8:11]
  v_mfma_f32_16x16x32_bf16 v[12:15], v[104:107], v[44:47], v[12:15]
  v_mfma_f32_16x16x32_bf16 v[16:19], v[108:111], v[44:47], v[16:19]
  v_mfma_f32_16x16x32_bf16 v[20:23], v[112:115], v[44:47], v[20:23]
  v_mfma_f32_16x16x32_bf16 v[24:27], v[116:119], v[44:47], v[24:27]
  s_waitcnt vmcnt(0)
  s_barrier
  ds_read_b128 v[80:83], v1 offset:20480
  ds_read_b128 v[84:87], v1 offset:21504
  ds_read_b128 v[88:91], v1 offset:22528
  ds_read_b128 v[92:95], v1 offset:23552
  ds_read_b128 v[96:99], v1 offset:24576
  ds_read_b128 v[100:103], v1 offset:25600
  ds_read_b128 v[104:107], v1 offset:26624
  ds_read_b128 v[108:111], v1 offset:27648
  ds_read_b128 v[112:115], v1 offset:28672
  ds_read_b128 v[116:119], v1 offset:29696
  s_waitcnt lgkmcnt(5)
  v_mfma_f32_16x16x32_bf16 v[8:11], v[80:83], v[48:51], v[8:11]
  v_mfma_f32_16x16x32_bf16 v[12:15], v[84:87], v[48:51], v[12:15]
  v_mfma_f32_16x16x32_bf16 v[16:19], v[88:91], v[48:51], v[16:19]
  v_mfma_f32_16x16x32_bf16 v[20:23], v[92:95], v[48:51], v[20:23]
  v_mfma_f32_16x16x32_bf16 v[24:27], v[96:99], v[48:51], v[24:27]
  ds_read_b128 v[80:83], v1 offset:30720
  ds_read_b128 v[84:87], v1 offset:31744
  ds_read_b128 v[88:91], v1 offset:32768
  ds_read_b128 v[92:95], v1 offset:33792
  ds_read_b128 v[96:99], v1 offset:34816
  s_waitcnt lgkmcnt(5)
  v_mfma_f32_16x16x32_bf16 v[8:11], v[100:103], v[52:55], v[8:11]
  v_mfma_f32_16x16x32_bf16 v[12:15], v[104:107], v[52:55], v[12:15]
  v_mfma_f32_16x16x32_bf16 v[16:19], v[108:111], v[52:55], v[16:19]
  v_mfma_f32_16x16x32_bf16 v[20:23], v[112:115], v[52:55], v[20:23]
  v_mfma_f32_16x16x32_bf16 v[24:27], v[116:119], v[52:55], v[24:27]
  ds_read_b128 v[100:103], v1 offset:35840
  ds_read_b128 v[104:107], v1 offset:36864
  ds_read_b128 v[108:111], v1 offset:37888
  ds_read_b128 v[112:115], v1 offset:38912
  ds_read_b128 v[116:119], v1 offset:39936
  s_waitcnt lgkmcnt(5)
  v_mfma_f32_16x16x32_bf16 v[8:11], v[80:83], v[56:59], v[8:11]
  v_mfma_f32_16x16x32_bf16 v[12:15], v[84:87], v[56:59], v[12:15]
  v_mfma_f32_16x16x32_bf16 v[16:19], v[88:91], v[56:59], v[16:19]
  v_mfma_f32_16x16x32_bf16 v[20:23], v[92:95], v[56:59], v[20:23]
  v_mfma_f32_16x16x32_bf16 v[24:27], v[96:99], v[56:59], v[24:27]
  s_waitcnt lgkmcnt(0)
  v_mfma_f32_16x16x32_bf16 v[8:11], v[100:103], v[60:63], v[8:11]
  v_mfma_f32_16x16x32_bf16 v[12:15], v[104:107], v[60:63], v[12:15]
  v_mfma_f32_16x16x32_bf16 v[16:19], v[108:111], v[60:63], v[16:19]
  v_mfma_f32_16x16x32_bf16 v[20:23], v[112:115], v[60:63], v[20:23]
  v_mfma_f32_16x16x32_bf16 v[24:27], v[116:119], v[60:63], v[24:27]
  v_and_b32 v3, 63, v0
  v_and_b32 v4, 15, v3
  v_lshrrev_b32 v3, 4, v3
  s_lshl_b32 s21, s17, 6
  s_lshl_b32 s23, s16, 4
  s_add_u32 s21, s21, s23
  v_add_u32 v4, s21, v4
  v_mul_u32_u24 v6, 1280, v4
  v_lshl_add_u32 v6, v3, 4, v6
  s_mul_i32 s21, s18, 5
  s_add_u32 s23, s21, 0
  s_lshr_b32 s31, s23, 1
  s_lshl_b32 s31, s31, 6
  s_and_b32 s23, s23, 1
  s_lshl_b32 s23, s23, 3
  s_add_u32 s32, s31, s23
  s_add_u32 s40, s32, s20
  buffer_load_dwordx2 v[32:33], v6, s[8:11], s40 offen
  s_add_u32 s23, s21, 1
  s_lshr_b32 s31, s23, 1
  s_lshl_b32 s31, s31, 6
  s_and_b32 s23, s23, 1
  s_lshl_b32 s23, s23, 3
  s_add_u32 s33, s31, s23
  s_add_u32 s41, s33, s20
  buffer_load_dwordx2 v[34:35], v6, s[8:11], s41 offen
  s_add_u32 s23, s21, 2
  s_lshr_b32 s31, s23, 1
  s_lshl_b32 s31, s31, 6
  s_and_b32 s23, s23, 1
  s_lshl_b32 s23, s23, 3
  s_add_u32 s34, s31, s23
  s_add_u32 s42, s34, s20
  buffer_load_dwordx2 v[36:37], v6, s[8:11], s42 offen
  s_add_u32 s23, s21, 3
  s_lshr_b32 s31, s23, 1
  s_lshl_b32 s31, s31, 6
  s_and_b32 s23, s23, 1
  s_lshl_b32 s23, s23, 3
  s_add_u32 s35, s31, s23
  s_add_u32 s43, s35, s20
  buffer_load_dwordx2 v[38:39], v6, s[8:11], s43 offen
  s_add_u32 s23, s21, 4
  s_lshr_b32 s31, s23, 1
  s_lshl_b32 s31, s31, 6
  s_and_b32 s23, s23, 1
  s_lshl_b32 s23, s23, 3
  s_add_u32 s36, s31, s23
  s_add_u32 s44, s36, s20
  buffer_load_dwordx2 v[40:41], v6, s[8:11], s44 offen
  s_waitcnt vmcnt(0)
  v_cvt_pk_bf16_f32 v80, v8, v9
  v_cvt_pk_bf16_f32 v81, v10, v11
  v_lshlrev_b32 v8, 16, v80
  v_and_b32 v9, 0xffff0000, v80
  v_lshlrev_b32 v10, 16, v81
  v_and_b32 v11, 0xffff0000, v81
  v_lshlrev_b32 v82, 16, v32
  v_and_b32 v83, 0xffff0000, v32
  v_lshlrev_b32 v84, 16, v33
  v_and_b32 v85, 0xffff0000, v33
  v_add_f32 v8, v8, v82
  v_add_f32 v9, v9, v83
  v_add_f32 v10, v10, v84
  v_add_f32 v11, v11, v85
  v_cvt_pk_bf16_f32 v32, v8, v9
  v_cvt_pk_bf16_f32 v33, v10, v11
  s_add_u32 s23, s32, 150994944
  buffer_store_dwordx2 v[32:33], v6, s[4:7], s23 offen
  v_cvt_pk_bf16_f32 v80, v12, v13
  v_cvt_pk_bf16_f32 v81, v14, v15
  v_lshlrev_b32 v12, 16, v80
  v_and_b32 v13, 0xffff0000, v80
  v_lshlrev_b32 v14, 16, v81
  v_and_b32 v15, 0xffff0000, v81
  v_lshlrev_b32 v82, 16, v34
  v_and_b32 v83, 0xffff0000, v34
  v_lshlrev_b32 v84, 16, v35
  v_and_b32 v85, 0xffff0000, v35
  v_add_f32 v12, v12, v82
  v_add_f32 v13, v13, v83
  v_add_f32 v14, v14, v84
  v_add_f32 v15, v15, v85
  v_cvt_pk_bf16_f32 v34, v12, v13
  v_cvt_pk_bf16_f32 v35, v14, v15
  s_add_u32 s23, s33, 150994944
  buffer_store_dwordx2 v[34:35], v6, s[4:7], s23 offen
  v_cvt_pk_bf16_f32 v80, v16, v17
  v_cvt_pk_bf16_f32 v81, v18, v19
  v_lshlrev_b32 v16, 16, v80
  v_and_b32 v17, 0xffff0000, v80
  v_lshlrev_b32 v18, 16, v81
  v_and_b32 v19, 0xffff0000, v81
  v_lshlrev_b32 v82, 16, v36
  v_and_b32 v83, 0xffff0000, v36
  v_lshlrev_b32 v84, 16, v37
  v_and_b32 v85, 0xffff0000, v37
  v_add_f32 v16, v16, v82
  v_add_f32 v17, v17, v83
  v_add_f32 v18, v18, v84
  v_add_f32 v19, v19, v85
  v_cvt_pk_bf16_f32 v36, v16, v17
  v_cvt_pk_bf16_f32 v37, v18, v19
  s_add_u32 s23, s34, 150994944
  buffer_store_dwordx2 v[36:37], v6, s[4:7], s23 offen
  v_cvt_pk_bf16_f32 v80, v20, v21
  v_cvt_pk_bf16_f32 v81, v22, v23
  v_lshlrev_b32 v20, 16, v80
  v_and_b32 v21, 0xffff0000, v80
  v_lshlrev_b32 v22, 16, v81
  v_and_b32 v23, 0xffff0000, v81
  v_lshlrev_b32 v82, 16, v38
  v_and_b32 v83, 0xffff0000, v38
  v_lshlrev_b32 v84, 16, v39
  v_and_b32 v85, 0xffff0000, v39
  v_add_f32 v20, v20, v82
  v_add_f32 v21, v21, v83
  v_add_f32 v22, v22, v84
  v_add_f32 v23, v23, v85
  v_cvt_pk_bf16_f32 v38, v20, v21
  v_cvt_pk_bf16_f32 v39, v22, v23
  s_add_u32 s23, s35, 150994944
  buffer_store_dwordx2 v[38:39], v6, s[4:7], s23 offen
  v_cvt_pk_bf16_f32 v80, v24, v25
  v_cvt_pk_bf16_f32 v81, v26, v27
  v_lshlrev_b32 v24, 16, v80
  v_and_b32 v25, 0xffff0000, v80
  v_lshlrev_b32 v26, 16, v81
  v_and_b32 v27, 0xffff0000, v81
  v_lshlrev_b32 v82, 16, v40
  v_and_b32 v83, 0xffff0000, v40
  v_lshlrev_b32 v84, 16, v41
  v_and_b32 v85, 0xffff0000, v41
  v_add_f32 v24, v24, v82
  v_add_f32 v25, v25, v83
  v_add_f32 v26, v26, v84
  v_add_f32 v27, v27, v85
  v_cvt_pk_bf16_f32 v40, v24, v25
  v_cvt_pk_bf16_f32 v41, v26, v27
  s_add_u32 s23, s36, 150994944
  buffer_store_dwordx2 v[40:41], v6, s[4:7], s23 offen
outb1_exit1:
  s_endpgm
.globl outb2_kernel
.p2align 8
.type outb2_kernel,@function
outb2_kernel:
  s_cmp_ge_u32 s2, 256
  s_cbranch_scc1 outb2_exit1
  s_load_dwordx2 s[12:13], s[0:1], 96
  s_load_dwordx2 s[14:15], s[0:1], 0
  s_load_dwordx2 s[48:49], s[0:1], 80
  v_lshrrev_b32 v3, 6, v0
  v_and_b32 v4, 63, v0
  s_nop 0
  v_readfirstlane_b32 s16, v3
  v_lshlrev_b32 v1, 4, v4
  s_and_b32 s17, s2, 7
  s_lshl_b32 s17, s17, 2
  s_lshr_b32 s18, s2, 3
  s_and_b32 s19, s18, 3
  s_add_u32 s17, s17, s19
  s_lshr_b32 s18, s18, 2
  s_waitcnt lgkmcnt(0)
  s_mov_b32 s4, s12
  s_mov_b32 s5, s13
  s_mov_b32 s6, 0x10000000
  s_mov_b32 s7, 0x20000
  s_mov_b32 s8, s12
  s_mov_b32 s9, s13
  s_mov_b32 s10, 0x10000000
  s_mov_b32 s11, 0x20000
  s_mov_b32 s20, 150994944
  s_mov_b32 s52, s48
  s_mov_b32 s53, s49
  s_mov_b32 s54, 2621440
  s_mov_b32 s55, 0x20000
  s_mul_i32 s21, s18, 5
  s_mul_i32 s21, s21, 32768
  s_add_u32 s24, s21, 160169984
  s_add_u32 s25, s24, 32768
  s_add_u32 s26, s25, 32768
  s_add_u32 s27, s26, 32768
  s_add_u32 s28, s27, 32768
  s_lshl_b32 s21, s17, 2
  s_add_u32 s21, s21, s16
  s_mul_i32 s22, s21, 32768
  s_add_u32 s22, s22, 174063616
  s_lshl_b32 s23, s16, 10
  v_add_u32 v2, s23, v1
  s_mul_i32 s29, s16, 5120
  s_add_u32 m0, s29, 0
  s_nop 0
  buffer_load_dwordx4 v2, s[4:7], s24 offen lds
  s_add_u32 m0, s29, 1024
  s_nop 0
  buffer_load_dwordx4 v2, s[4:7], s25 offen lds
  s_add_u32 m0, s29, 2048
  s_nop 0
  buffer_load_dwordx4 v2, s[4:7], s26 offen lds
  s_add_u32 m0, s29, 3072
  s_nop 0
  buffer_load_dwordx4 v2, s[4:7], s27 offen lds
  s_add_u32 m0, s29, 4096
  s_nop 0
  buffer_load_dwordx4 v2, s[4:7], s28 offen lds
  buffer_load_dwordx4 v[32:35], v1, s[4:7], s22 offen offset:0
  buffer_load_dwordx4 v[36:39], v1, s[4:7], s22 offen offset:1024
  buffer_load_dwordx4 v[40:43], v1, s[4:7], s22 offen offset:2048
  buffer_load_dwordx4 v[44:47], v1, s[4:7], s22 offen offset:3072
  v_add_u32 v2, 0x1000, v2
  s_add_u32 s22, s22, 4096
  s_add_u32 m0, s29, 20480
  s_nop 0
  buffer_load_dwordx4 v2, s[4:7], s24 offen lds
  s_add_u32 m0, s29, 21504
  s_nop 0
  buffer_load_dwordx4 v2, s[4:7], s25 offen lds
  s_add_u32 m0, s29, 22528
  s_nop 0
  buffer_load_dwordx4 v2, s[4:7], s26 offen lds
  s_add_u32 m0, s29, 23552
  s_nop 0
  buffer_load_dwordx4 v2, s[4:7], s27 offen lds
  s_add_u32 m0, s29, 24576
  s_nop 0
  buffer_load_dwordx4 v2, s[4:7], s28 offen lds
  buffer_load_dwordx4 v[48:51], v1, s[4:7], s22 offen offset:0
  buffer_load_dwordx4 v[52:55], v1, s[4:7], s22 offen offset:1024
  buffer_load_dwordx4 v[56:59], v1, s[4:7], s22 offen offset:2048
  buffer_load_dwordx4 v[60:63], v1, s[4:7], s22 offen offset:3072
  v_add_u32 v2, 0x1000, v2
  s_add_u32 s22, s22, 4096
  s_waitcnt vmcnt(9)
  s_barrier
  s_add_u32 m0, s29, 40960
  s_nop 0
  buffer_load_dwordx4 v2, s[4:7], s24 offen lds
  s_add_u32 m0, s29, 41984
  s_nop 0
  buffer_load_dwordx4 v2, s[4:7], s25 offen lds
  s_add_u32 m0, s29, 43008
  s_nop 0
  buffer_load_dwordx4 v2, s[4:7], s26 offen lds
  s_add_u32 m0, s29, 44032
  s_nop 0
  buffer_load_dwordx4 v2, s[4:7], s27 offen lds
  s_add_u32 m0, s29, 45056
  s_nop 0
  buffer_load_dwordx4 v2, s[4:7], s28 offen lds
  buffer_load_dwordx4 v[64:67], v1, s[4:7], s22 offen offset:0
  buffer_load_dwordx4 v[68:71], v1, s[4:7], s22 offen offset:1024
  buffer_load_dwordx4 v[72:75], v1, s[4:7], s22 offen offset:2048
  buffer_load_dwordx4 v[76:79], v1, s[4:7], s22 offen offset:3072
  v_add_u32 v2, 0x1000, v2
  s_add_u32 s22, s22, 4096
  ds_read_b128 v[80:83], v1 offset:0
  ds_read_b128 v[84:87], v1 offset:1024
  ds_read_b128 v[88:91], v1 offset:2048
  ds_read_b128 v[92:95], v1 offset:3072
  ds_read_b128 v[96:99], v1 offset:4096
  ds_read_b128 v[100:103], v1 offset:5120
  ds_read_b128 v[104:107], v1 offset:6144
  ds_read_b128 v[108:111], v1 offset:7168
  ds_read_b128 v[112:115], v1 offset:8192
  ds_read_b128 v[116:119], v1 offset:9216
  s_waitcnt lgkmcnt(5)
  v_mfma_f32_16x16x32_bf16 v[8:11], v[80:83], v[32:35], 0
  v_mfma_f32_16x16x32_bf16 v[12:15], v[84:87], v[32:35], 0
  v_mfma_f32_16x16x32_bf16 v[16:19], v[88:91], v[32:35], 0
  v_mfma_f32_16x16x32_bf16 v[20:23], v[92:95], v[32:35], 0
  v_mfma_f32_16x16x32_bf16 v[24:27], v[96:99], v[32:35], 0
  ds_read_b128 v[80:83], v1 offset:10240
  ds_read_b128 v[84:87], v1 offset:11264
  ds_read_b128 v[88:91], v1 offset:12288
  ds_read_b128 v[92:95], v1 offset:13312
  ds_read_b128 v[96:99], v1 offset:14336
  s_waitcnt lgkmcnt(5)
  v_mfma_f32_16x16x32_bf16 v[8:11], v[100:103], v[36:39], v[8:11]
  v_mfma_f32_16x16x32_bf16 v[12:15], v[104:107], v[36:39], v[12:15]
  v_mfma_f32_16x16x32_bf16 v[16:19], v[108:111], v[36:39], v[16:19]
  v_mfma_f32_16x16x32_bf16 v[20:23], v[112:115], v[36:39], v[20:23]
  v_mfma_f32_16x16x32_bf16 v[24:27], v[116:119], v[36:39], v[24:27]
  ds_read_b128 v[100:103], v1 offset:15360
  ds_read_b128 v[104:107], v1 offset:16384
  ds_read_b128 v[108:111], v1 offset:17408
  ds_read_b128 v[112:115], v1 offset:18432
  ds_read_b128 v[116:119], v1 offset:19456
  s_waitcnt lgkmcnt(5)
  v_mfma_f32_16x16x32_bf16 v[8:11], v[80:83], v[40:43], v[8:11]
  v_mfma_f32_16x16x32_bf16 v[12:15], v[84:87], v[40:43], v[12:15]
  v_mfma_f32_16x16x32_bf16 v[16:19], v[88:91], v[40:43], v[16:19]
  v_mfma_f32_16x16x32_bf16 v[20:23], v[92:95], v[40:43], v[20:23]
  v_mfma_f32_16x16x32_bf16 v[24:27], v[96:99], v[40:43], v[24:27]
  s_waitcnt lgkmcnt(0)
  v_mfma_f32_16x16x32_bf16 v[8:11], v[100:103], v[44:47], v[8:11]
  v_mfma_f32_16x16x32_bf16 v[12:15], v[104:107], v[44:47], v[12:15]
  v_mfma_f32_16x16x32_bf16 v[16:19], v[108:111], v[44:47], v[16:19]
  v_mfma_f32_16x16x32_bf16 v[20:23], v[112:115], v[44:47], v[20:23]
  v_mfma_f32_16x16x32_bf16 v[24:27], v[116:119], v[44:47], v[24:27]
  s_mov_b32 s30, 0
outb2_loop2:
  s_waitcnt vmcnt(9)
  s_barrier
  s_add_u32 m0, s29, 0
  s_nop 0
  buffer_load_dwordx4 v2, s[4:7], s24 offen lds
  s_add_u32 m0, s29, 1024
  s_nop 0
  buffer_load_dwordx4 v2, s[4:7], s25 offen lds
  s_add_u32 m0, s29, 2048
  s_nop 0
  buffer_load_dwordx4 v2, s[4:7], s26 offen lds
  s_add_u32 m0, s29, 3072
  s_nop 0
  buffer_load_dwordx4 v2, s[4:7], s27 offen lds
  s_add_u32 m0, s29, 4096
  s_nop 0
  buffer_load_dwordx4 v2, s[4:7], s28 offen lds
  buffer_load_dwordx4 v[32:35], v1, s[4:7], s22 offen offset:0
  buffer_load_dwordx4 v[36:39], v1, s[4:7], s22 offen offset:1024
  buffer_load_dwordx4 v[40:43], v1, s[4:7], s22 offen offset:2048
  buffer_load_dwordx4 v[44:47], v1, s[4:7], s22 offen offset:3072
  v_add_u32 v2, 0x1000, v2
  s_add_u32 s22, s22, 4096
  ds_read_b128 v[80:83], v1 offset:20480
  ds_read_b128 v[84:87], v1 offset:21504
  ds_read_b128 v[88:91], v1 offset:22528
  ds_read_b128 v[92:95], v1 offset:23552
  ds_read_b128 v[96:99], v1 offset:24576
  ds_read_b128 v[100:103], v1 offset:25600
  ds_read_b128 v[104:107], v1 offset:26624
  ds_read_b128 v[108:111], v1 offset:27648
  ds_read_b128 v[112:115], v1 offset:28672
  ds_read_b128 v[116:119], v1 offset:29696
  s_waitcnt lgkmcnt(5)
  v_mfma_f32_16x16x32_bf16 v[8:11], v[80:83], v[48:51], v[8:11]
  v_mfma_f32_16x16x32_bf16 v[12:15], v[84:87], v[48:51], v[12:15]
  v_mfma_f32_16x16x32_bf16 v[16:19], v[88:91], v[48:51], v[16:19]
  v_mfma_f32_16x16x32_bf16 v[20:23], v[92:95], v[48:51], v[20:23]
  v_mfma_f32_16x16x32_bf16 v[24:27], v[96:99], v[48:51], v[24:27]
  ds_read_b128 v[80:83], v1 offset:30720
  ds_read_b128 v[84:87], v1 offset:31744
  ds_read_b128 v[88:91], v1 offset:32768
  ds_read_b128 v[92:95], v1 offset:33792
  ds_read_b128 v[96:99], v1 offset:34816
  s_waitcnt lgkmcnt(5)
  v_mfma_f32_16x16x32_bf16 v[8:11], v[100:103], v[52:55], v[8:11]
  v_mfma_f32_16x16x32_bf16 v[12:15], v[104:107], v[52:55], v[12:15]
  v_mfma_f32_16x16x32_bf16 v[16:19], v[108:111], v[52:55], v[16:19]
  v_mfma_f32_16x16x32_bf16 v[20:23], v[112:115], v[52:55], v[20:23]
  v_mfma_f32_16x16x32_bf16 v[24:27], v[116:119], v[52:55], v[24:27]
  ds_read_b128 v[100:103], v1 offset:35840
  ds_read_b128 v[104:107], v1 offset:36864
  ds_read_b128 v[108:111], v1 offset:37888
  ds_read_b128 v[112:115], v1 offset:38912
  ds_read_b128 v[116:119], v1 offset:39936
  s_waitcnt lgkmcnt(5)
  v_mfma_f32_16x16x32_bf16 v[8:11], v[80:83], v[56:59], v[8:11]
  v_mfma_f32_16x16x32_bf16 v[12:15], v[84:87], v[56:59], v[12:15]
  v_mfma_f32_16x16x32_bf16 v[16:19], v[88:91], v[56:59], v[16:19]
  v_mfma_f32_16x16x32_bf16 v[20:23], v[92:95], v[56:59], v[20:23]
  v_mfma_f32_16x16x32_bf16 v[24:27], v[96:99], v[56:59], v[24:27]
  s_waitcnt lgkmcnt(0)
  v_mfma_f32_16x16x32_bf16 v[8:11], v[100:103], v[60:63], v[8:11]
  v_mfma_f32_16x16x32_bf16 v[12:15], v[104:107], v[60:63], v[12:15]
  v_mfma_f32_16x16x32_bf16 v[16:19], v[108:111], v[60:63], v[16:19]
  v_mfma_f32_16x16x32_bf16 v[20:23], v[112:115], v[60:63], v[20:23]
  v_mfma_f32_16x16x32_bf16 v[24:27], v[116:119], v[60:63], v[24:27]
  s_waitcnt vmcnt(9)
  s_barrier
  s_add_u32 m0, s29, 20480
  s_nop 0
  buffer_load_dwordx4 v2, s[4:7], s24 offen lds
  s_add_u32 m0, s29, 21504
  s_nop 0
  buffer_load_dwordx4 v2, s[4:7], s25 offen lds
  s_add_u32 m0, s29, 22528
  s_nop 0
  buffer_load_dwordx4 v2, s[4:7], s26 offen lds
  s_add_u32 m0, s29, 23552
  s_nop 0
  buffer_load_dwordx4 v2, s[4:7], s27 offen lds
  s_add_u32 m0, s29, 24576
  s_nop 0
  buffer_load_dwordx4 v2, s[4:7], s28 offen lds
  buffer_load_dwordx4 v[48:51], v1, s[4:7], s22 offen offset:0
  buffer_load_dwordx4 v[52:55], v1, s[4:7], s22 offen offset:1024
  buffer_load_dwordx4 v[56:59], v1, s[4:7], s22 offen offset:2048
  buffer_load_dwordx4 v[60:63], v1, s[4:7], s22 offen offset:3072
  v_add_u32 v2, 0x1000, v2
  s_add_u32 s22, s22, 4096
  ds_read_b128 v[80:83], v1 offset:40960
  ds_read_b128 v[84:87], v1 offset:41984
  ds_read_b128 v[88:91], v1 offset:43008
  ds_read_b128 v[92:95], v1 offset:44032
  ds_read_b128 v[96:99], v1 offset:45056
  ds_read_b128 v[100:103], v1 offset:46080
  ds_read_b128 v[104:107], v1 offset:47104
  ds_read_b128 v[108:111], v1 offset:48128
  ds_read_b128 v[112:115], v1 offset:49152
  ds_read_b128 v[116:119], v1 offset:50176
  s_waitcnt lgkmcnt(5)
  v_mfma_f32_16x16x32_bf16 v[8:11], v[80:83], v[64:67], v[8:11]
  v_mfma_f32_16x16x32_bf16 v[12:15], v[84:87], v[64:67], v[12:15]
  v_mfma_f32_16x16x32_bf16 v[16:19], v[88:91], v[64:67], v[16:19]
  v_mfma_f32_16x16x32_bf16 v[20:23], v[92:95], v[64:67], v[20:23]
  v_mfma_f32_16x16x32_bf16 v[24:27], v[96:99], v[64:67], v[24:27]
  ds_read_b128 v[80:83], v1 offset:51200
  ds_read_b128 v[84:87], v1 offset:52224
  ds_read_b128 v[88:91], v1 offset:53248
  ds_read_b128 v[92:95], v1 offset:54272
  ds_read_b128 v[96:99], v1 offset:55296
  s_waitcnt lgkmcnt(5)
  v_mfma_f32_16x16x32_bf16 v[8:11], v[100:103], v[68:71], v[8:11]
  v_mfma_f32_16x16x32_bf16 v[12:15], v[104:107], v[68:71], v[12:15]
  v_mfma_f32_16x16x32_bf16 v[16:19], v[108:111], v[68:71], v[16:19]
  v_mfma_f32_16x16x32_bf16 v[20:23], v[112:115], v[68:71], v[20:23]
  v_mfma_f32_16x16x32_bf16 v[24:27], v[116:119], v[68:71], v[24:27]
  ds_read_b128 v[100:103], v1 offset:56320
  ds_read_b128 v[104:107], v1 offset:57344
  ds_read_b128 v[108:111], v1 offset:58368
  ds_read_b128 v[112:115], v1 offset:59392
  ds_read_b128 v[116:119], v1 offset:60416
  s_waitcnt lgkmcnt(5)
  v_mfma_f32_16x16x32_bf16 v[8:11], v[80:83], v[72:75], v[8:11]
  v_mfma_f32_16x16x32_bf16 v[12:15], v[84:87], v[72:75], v[12:15]
  v_mfma_f32_16x16x32_bf16 v[16:19], v[88:91], v[72:75], v[16:19]
  v_mfma_f32_16x16x32_bf16 v[20:23], v[92:95], v[72:75], v[20:23]
  v_mfma_f32_16x16x32_bf16 v[24:27], v[96:99], v[72:75], v[24:27]
  s_waitcnt lgkmcnt(0)
  v_mfma_f32_16x16x32_bf16 v[8:11], v[100:103], v[76:79], v[8:11]
  v_mfma_f32_16x16x32_bf16 v[12:15], v[104:107], v[76:79], v[12:15]
  v_mfma_f32_16x16x32_bf16 v[16:19], v[108:111], v[76:79], v[16:19]
  v_mfma_f32_16x16x32_bf16 v[20:23], v[112:115], v[76:79], v[20:23]
  v_mfma_f32_16x16x32_bf16 v[24:27], v[116:119], v[76:79], v[24:27]
  s_waitcnt vmcnt(9)
  s_barrier
  s_add_u32 m0, s29, 40960
  s_nop 0
  buffer_load_dwordx4 v2, s[4:7], s24 offen lds
  s_add_u32 m0, s29, 41984
  s_nop 0
  buffer_load_dwordx4 v2, s[4:7], s25 offen lds
  s_add_u32 m0, s29, 43008
  s_nop 0
  buffer_load_dwordx4 v2, s[4:7], s26 offen lds
  s_add_u32 m0, s29, 44032
  s_nop 0
  buffer_load_dwordx4 v2, s[4:7], s27 offen lds
  s_add_u32 m0, s29, 45056
  s_nop 0
  buffer_load_dwordx4 v2, s[4:7], s28 offen lds
  buffer_load_dwordx4 v[64:67], v1, s[4:7], s22 offen offset:0
  buffer_load_dwordx4 v[68:71], v1, s[4:7], s22 offen offset:1024
  buffer_load_dwordx4 v[72:75], v1, s[4:7], s22 offen offset:2048
  buffer_load_dwordx4 v[76:79], v1, s[4:7], s22 offen offset:3072
  v_add_u32 v2, 0x1000, v2
  s_add_u32 s22, s22, 4096
  ds_read_b128 v[80:83], v1 offset:0
  ds_read_b128 v[84:87], v1 offset:1024
  ds_read_b128 v[88:91], v1 offset:2048
  ds_read_b128 v[92:95], v1 offset:3072
  ds_read_b128 v[96:99], v1 offset:4096
  ds_read_b128 v[100:103], v1 offset:5120
  ds_read_b128 v[104:107], v1 offset:6144
  ds_read_b128 v[108:111], v1 offset:7168
  ds_read_b128 v[112:115], v1 offset:8192
  ds_read_b128 v[116:119], v1 offset:9216
  s_waitcnt lgkmcnt(5)
  v_mfma_f32_16x16x32_bf16 v[8:11], v[80:83], v[32:35], v[8:11]
  v_mfma_f32_16x16x32_bf16 v[12:15], v[84:87], v[32:35], v[12:15]
  v_mfma_f32_16x16x32_bf16 v[16:19], v[88:91], v[32:35], v[16:19]
  v_mfma_f32_16x16x32_bf16 v[20:23], v[92:95], v[32:35], v[20:23]
  v_mfma_f32_16x16x32_bf16 v[24:27], v[96:99], v[32:35], v[24:27]
  ds_read_b128 v[80:83], v1 offset:10240
  ds_read_b128 v[84:87], v1 offset:11264
  ds_read_b128 v[88:91], v1 offset:12288
  ds_read_b128 v[92:95], v1 offset:13312
  ds_read_b128 v[96:99], v1 offset:14336
  s_waitcnt lgkmcnt(5)
  v_mfma_f32_16x16x32_bf16 v[8:11], v[100:103], v[36:39], v[8:11]
  v_mfma_f32_16x16x32_bf16 v[12:15], v[104:107], v[36:39], v[12:15]
  v_mfma_f32_16x16x32_bf16 v[16:19], v[108:111], v[36:39], v[16:19]
  v_mfma_f32_16x16x32_bf16 v[20:23], v[112:115], v[36:39], v[20:23]
  v_mfma_f32_16x16x32_bf16 v[24:27], v[116:119], v[36:39], v[24:27]
  ds_read_b128 v[100:103], v1 offset:15360
  ds_read_b128 v[104:107], v1 offset:16384
  ds_read_b128 v[108:111], v1 offset:17408
  ds_read_b128 v[112:115], v1 offset:18432
  ds_read_b128 v[116:119], v1 offset:19456
  s_waitcnt lgkmcnt(5)
  v_mfma_f32_16x16x32_bf16 v[8:11], v[80:83], v[40:43], v[8:11]
  v_mfma_f32_16x16x32_bf16 v[12:15], v[84:87], v[40:43], v[12:15]
  v_mfma_f32_16x16x32_bf16 v[16:19], v[88:91], v[40:43], v[16:19]
  v_mfma_f32_16x16x32_bf16 v[20:23], v[92:95], v[40:43], v[20:23]
  v_mfma_f32_16x16x32_bf16 v[24:27], v[96:99], v[40:43], v[24:27]
  s_waitcnt lgkmcnt(0)
  v_mfma_f32_16x16x32_bf16 v[8:11], v[100:103], v[44:47], v[8:11]
  v_mfma_f32_16x16x32_bf16 v[12:15], v[104:107], v[44:47], v[12:15]
  v_mfma_f32_16x16x32_bf16 v[16:19], v[108:111], v[44:47], v[16:19]
  v_mfma_f32_16x16x32_bf16 v[20:23], v[112:115], v[44:47], v[20:23]
  v_mfma_f32_16x16x32_bf16 v[24:27], v[116:119], v[44:47], v[24:27]
  s_add_u32 s30, s30, 1
  s_cmp_lt_u32 s30, 1
  s_cbranch_scc1 outb2_loop2
  s_waitcnt vmcnt(9)
  s_barrier
  s_add_u32 m0, s29, 0
  s_nop 0
  buffer_load_dwordx4 v2, s[4:7], s24 offen lds
  s_add_u32 m0, s29, 1024
  s_nop 0
  buffer_load_dwordx4 v2, s[4:7], s25 offen lds
  s_add_u32 m0, s29, 2048
  s_nop 0
  buffer_load_dwordx4 v2, s[4:7], s26 offen lds
  s_add_u32 m0, s29, 3072
  s_nop 0
  buffer_load_dwordx4 v2, s[4:7], s27 offen lds
  s_add_u32 m0, s29, 4096
  s_nop 0
  buffer_load_dwordx4 v2, s[4:7], s28 offen lds
  buffer_load_dwordx4 v[32:35], v1, s[4:7], s22 offen offset:0
  buffer_load_dwordx4 v[36:39], v1, s[4:7], s22 offen offset:1024
  buffer_load_dwordx4 v[40:43], v1, s[4:7], s22 offen offset:2048
  buffer_load_dwordx4 v[44:47], v1, s[4:7], s22 offen offset:3072
  v_add_u32 v2, 0x1000, v2
  s_add_u32 s22, s22, 4096
  ds_read_b128 v[80:83], v1 offset:20480
  ds_read_b128 v[84:87], v1 offset:21504
  ds_read_b128 v[88:91], v1 offset:22528
  ds_read_b128 v[92:95], v1 offset:23552
  ds_read_b128 v[96:99], v1 offset:24576
  ds_read_b128 v[100:103], v1 offset:25600
  ds_read_b128 v[104:107], v1 offset:26624
  ds_read_b128 v[108:111], v1 offset:27648
  ds_read_b128 v[112:115], v1 offset:28672
  ds_read_b128 v[116:119], v1 offset:29696
  s_waitcnt lgkmcnt(5)
  v_mfma_f32_16x16x32_bf16 v[8:11], v[80:83], v[48:51], v[8:11]
  v_mfma_f32_16x16x32_bf16 v[12:15], v[84:87], v[48:51], v[12:15]
  v_mfma_f32_16x16x32_bf16 v[16:19], v[88:91], v[48:51], v[16:19]
  v_mfma_f32_16x16x32_bf16 v[20:23], v[92:95], v[48:51], v[20:23]
  v_mfma_f32_16x16x32_bf16 v[24:27], v[96:99], v[48:51], v[24:27]
  ds_read_b128 v[80:83], v1 offset:30720
  ds_read_b128 v[84:87], v1 offset:31744
  ds_read_b128 v[88:91], v1 offset:32768
  ds_read_b128 v[92:95], v1 offset:33792
  ds_read_b128 v[96:99], v1 offset:34816
  s_waitcnt lgkmcnt(5)
  v_mfma_f32_16x16x32_bf16 v[8:11], v[100:103], v[52:55], v[8:11]
  v_mfma_f32_16x16x32_bf16 v[12:15], v[104:107], v[52:55], v[12:15]
  v_mfma_f32_16x16x32_bf16 v[16:19], v[108:111], v[52:55], v[16:19]
  v_mfma_f32_16x16x32_bf16 v[20:23], v[112:115], v[52:55], v[20:23]
  v_mfma_f32_16x16x32_bf16 v[24:27], v[116:119], v[52:55], v[24:27]
  ds_read_b128 v[100:103], v1 offset:35840
  ds_read_b128 v[104:107], v1 offset:36864
  ds_read_b128 v[108:111], v1 offset:37888
  ds_read_b128 v[112:115], v1 offset:38912
  ds_read_b128 v[116:119], v1 offset:39936
  s_waitcnt lgkmcnt(5)
  v_mfma_f32_16x16x32_bf16 v[8:11], v[80:83], v[56:59], v[8:11]
  v_mfma_f32_16x16x32_bf16 v[12:15], v[84:87], v[56:59], v[12:15]
  v_mfma_f32_16x16x32_bf16 v[16:19], v[88:91], v[56:59], v[16:19]
  v_mfma_f32_16x16x32_bf16 v[20:23], v[92:95], v[56:59], v[20:23]
  v_mfma_f32_16x16x32_bf16 v[24:27], v[96:99], v[56:59], v[24:27]
  s_waitcnt lgkmcnt(0)
  v_mfma_f32_16x16x32_bf16 v[8:11], v[100:103], v[60:63], v[8:11]
  v_mfma_f32_16x16x32_bf16 v[12:15], v[104:107], v[60:63], v[12:15]
  v_mfma_f32_16x16x32_bf16 v[16:19], v[108:111], v[60:63], v[16:19]
  v_mfma_f32_16x16x32_bf16 v[20:23], v[112:115], v[60:63], v[20:23]
  v_mfma_f32_16x16x32_bf16 v[24:27], v[116:119], v[60:63], v[24:27]
  s_waitcnt vmcnt(9)
  s_barrier
  s_add_u32 m0, s29, 20480
  s_nop 0
  buffer_load_dwordx4 v2, s[4:7], s24 offen lds
  s_add_u32 m0, s29, 21504
  s_nop 0
  buffer_load_dwordx4 v2, s[4:7], s25 offen lds
  s_add_u32 m0, s29, 22528
  s_nop 0
  buffer_load_dwordx4 v2, s[4:7], s26 offen lds
  s_add_u32 m0, s29, 23552
  s_nop 0
  buffer_load_dwordx4 v2, s[4:7], s27 offen lds
  s_add_u32 m0, s29, 24576
  s_nop 0
  buffer_load_dwordx4 v2, s[4:7], s28 offen lds
  buffer_load_dwordx4 v[48:51], v1, s[4:7], s22 offen offset:0
  buffer_load_dwordx4 v[52:55], v1, s[4:7], s22 offen offset:1024
  buffer_load_dwordx4 v[56:59], v1, s[4:7], s22 offen offset:2048
  buffer_load_dwordx4 v[60:63], v1, s[4:7], s22 offen offset:3072
  v_add_u32 v2, 0x1000, v2
  s_add_u32 s22, s22, 4096
  ds_read_b128 v[80:83], v1 offset:40960
  ds_read_b128 v[84:87], v1 offset:41984
  ds_read_b128 v[88:91], v1 offset:43008
  ds_read_b128 v[92:95], v1 offset:44032
  ds_read_b128 v[96:99], v1 offset:45056
  ds_read_b128 v[100:103], v1 offset:46080
  ds_read_b128 v[104:107], v1 offset:47104
  ds_read_b128 v[108:111], v1 offset:48128
  ds_read_b128 v[112:115], v1 offset:49152
  ds_read_b128 v[116:119], v1 offset:50176
  s_waitcnt lgkmcnt(5)
  v_mfma_f32_16x16x32_bf16 v[8:11], v[80:83], v[64:67], v[8:11]
  v_mfma_f32_16x16x32_bf16 v[12:15], v[84:87], v[64:67], v[12:15]
  v_mfma_f32_16x16x32_bf16 v[16:19], v[88:91], v[64:67], v[16:19]
  v_mfma_f32_16x16x32_bf16 v[20:23], v[92:95], v[64:67], v[20:23]
  v_mfma_f32_16x16x32_bf16 v[24:27], v[96:99], v[64:67], v[24:27]
  ds_read_b128 v[80:83], v1 offset:51200
  ds_read_b128 v[84:87], v1 offset:52224
  ds_read_b128 v[88:91], v1 offset:53248
  ds_read_b128 v[92:95], v1 offset:54272
  ds_read_b128 v[96:99], v1 offset:55296
  s_waitcnt lgkmcnt(5)
  v_mfma_f32_16x16x32_bf16 v[8:11], v[100:103], v[68:71], v[8:11]
  v_mfma_f32_16x16x32_bf16 v[12:15], v[104:107], v[68:71], v[12:15]
  v_mfma_f32_16x16x32_bf16 v[16:19], v[108:111], v[68:71], v[16:19]
  v_mfma_f32_16x16x32_bf16 v[20:23], v[112:115], v[68:71], v[20:23]
  v_mfma_f32_16x16x32_bf16 v[24:27], v[116:119], v[68:71], v[24:27]
  ds_read_b128 v[100:103], v1 offset:56320
  ds_read_b128 v[104:107], v1 offset:57344
  ds_read_b128 v[108:111], v1 offset:58368
  ds_read_b128 v[112:115], v1 offset:59392
  ds_read_b128 v[116:119], v1 offset:60416
  s_waitcnt lgkmcnt(5)
  v_mfma_f32_16x16x32_bf16 v[8:11], v[80:83], v[72:75], v[8:11]
  v_mfma_f32_16x16x32_bf16 v[12:15], v[84:87], v[72:75], v[12:15]
  v_mfma_f32_16x16x32_bf16 v[16:19], v[88:91], v[72:75], v[16:19]
  v_mfma_f32_16x16x32_bf16 v[20:23], v[92:95], v[72:75], v[20:23]
  v_mfma_f32_16x16x32_bf16 v[24:27], v[96:99], v[72:75], v[24:27]
  s_waitcnt lgkmcnt(0)
  v_mfma_f32_16x16x32_bf16 v[8:11], v[100:103], v[76:79], v[8:11]
  v_mfma_f32_16x16x32_bf16 v[12:15], v[104:107], v[76:79], v[12:15]
  v_mfma_f32_16x16x32_bf16 v[16:19], v[108:111], v[76:79], v[16:19]
  v_mfma_f32_16x16x32_bf16 v[20:23], v[112:115], v[76:79], v[20:23]
  v_mfma_f32_16x16x32_bf16 v[24:27], v[116:119], v[76:79], v[24:27]
  s_waitcnt vmcnt(9)
  s_barrier
  ds_read_b128 v[80:83], v1 offset:0
  ds_read_b128 v[84:87], v1 offset:1024
  ds_read_b128 v[88:91], v1 offset:2048
  ds_read_b128 v[92:95], v1 offset:3072
  ds_read_b128 v[96:99], v1 offset:4096
  ds_read_b128 v[100:103], v1 offset:5120
  ds_read_b128 v[104:107], v1 offset:6144
  ds_read_b128 v[108:111], v1 offset:7168
  ds_read_b128 v[112:115], v1 offset:8192
  ds_read_b128 v[116:119], v1 offset:9216
  s_waitcnt lgkmcnt(5)
  v_mfma_f32_16x16x32_bf16 v[8:11], v[80:83], v[32:35], v[8:11]
  v_mfma_f32_16x16x32_bf16 v[12:15], v[84:87], v[32:35], v[12:15]
  v_mfma_f32_16x16x32_bf16 v[16:19], v[88:91], v[32:35], v[16:19]
  v_mfma_f32_16x16x32_bf16 v[20:23], v[92:95], v[32:35], v[20:23]
  v_mfma_f32_16x16x32_bf16 v[24:27], v[96:99], v[32:35], v[24:27]
  ds_read_b128 v[80:83], v1 offset:10240
  ds_read_b128 v[84:87], v1 offset:11264
  ds_read_b128 v[88:91], v1 offset:12288
  ds_read_b128 v[92:95], v1 offset:13312
  ds_read_b128 v[96:99], v1 offset:14336
  s_waitcnt lgkmcnt(5)
  v_mfma_f32_16x16x32_bf16 v[8:11], v[100:103], v[36:39], v[8:11]
  v_mfma_f32_16x16x32_bf16 v[12:15], v[104:107], v[36:39], v[12:15]
  v_mfma_f32_16x16x32_bf16 v[16:19], v[108:111], v[36:39], v[16:19]
  v_mfma_f32_16x16x32_bf16 v[20:23], v[112:115], v[36:39], v[20:23]
  v_mfma_f32_16x16x32_bf16 v[24:27], v[116:119], v[36:39], v[24:27]
  ds_read_b128 v[100:103], v1 offset:15360
  ds_read_b128 v[104:107], v1 offset:16384
  ds_read_b128 v[108:111], v1 offset:17408
  ds_read_b128 v[112:115], v1 offset:18432
  ds_read_b128 v[116:119], v1 offset:19456
  s_waitcnt lgkmcnt(5)
  v_mfma_f32_16x16x32_bf16 v[8:11], v[80:83], v[40:43], v[8:11]
  v_mfma_f32_16x16x32_bf16 v[12:15], v[84:87], v[40:43], v[12:15]
  v_mfma_f32_16x16x32_bf16 v[16:19], v[88:91], v[40:43], v[16:19]
  v_mfma_f32_16x16x32_bf16 v[20:23], v[92:95], v[40:43], v[20:23]
  v_mfma_f32_16x16x32_bf16 v[24:27], v[96:99], v[40:43], v[24:27]
  s_waitcnt lgkmcnt(0)
  v_mfma_f32_16x16x32_bf16 v[8:11], v[100:103], v[44:47], v[8:11]
  v_mfma_f32_16x16x32_bf16 v[12:15], v[104:107], v[44:47], v[12:15]
  v_mfma_f32_16x16x32_bf16 v[16:19], v[108:111], v[44:47], v[16:19]
  v_mfma_f32_16x16x32_bf16 v[20:23], v[112:115], v[44:47], v[20:23]
  v_mfma_f32_16x16x32_bf16 v[24:27], v[116:119], v[44:47], v[24:27]
  s_waitcnt vmcnt(0)
  s_barrier
  ds_read_b128 v[80:83], v1 offset:20480
  ds_read_b128 v[84:87], v1 offset:21504
  ds_read_b128 v[88:91], v1 offset:22528
  ds_read_b128 v[92:95], v1 offset:23552
  ds_read_b128 v[96:99], v1 offset:24576
  ds_read_b128 v[100:103], v1 offset:25600
  ds_read_b128 v[104:107], v1 offset:26624
  ds_read_b128 v[108:111], v1 offset:27648
  ds_read_b128 v[112:115], v1 offset:28672
  ds_read_b128 v[116:119], v1 offset:29696
  s_waitcnt lgkmcnt(5)
  v_mfma_f32_16x16x32_bf16 v[8:11], v[80:83], v[48:51], v[8:11]
  v_mfma_f32_16x16x32_bf16 v[12:15], v[84:87], v[48:51], v[12:15]
  v_mfma_f32_16x16x32_bf16 v[16:19], v[88:91], v[48:51], v[16:19]
  v_mfma_f32_16x16x32_bf16 v[20:23], v[92:95], v[48:51], v[20:23]
  v_mfma_f32_16x16x32_bf16 v[24:27], v[96:99], v[48:51], v[24:27]
  ds_read_b128 v[80:83], v1 offset:30720
  ds_read_b128 v[84:87], v1 offset:31744
  ds_read_b128 v[88:91], v1 offset:32768
  ds_read_b128 v[92:95], v1 offset:33792
  ds_read_b128 v[96:99], v1 offset:34816
  s_waitcnt lgkmcnt(5)
  v_mfma_f32_16x16x32_bf16 v[8:11], v[100:103], v[52:55], v[8:11]
  v_mfma_f32_16x16x32_bf16 v[12:15], v[104:107], v[52:55], v[12:15]
  v_mfma_f32_16x16x32_bf16 v[16:19], v[108:111], v[52:55], v[16:19]
  v_mfma_f32_16x16x32_bf16 v[20:23], v[112:115], v[52:55], v[20:23]
  v_mfma_f32_16x16x32_bf16 v[24:27], v[116:119], v[52:55], v[24:27]
  ds_read_b128 v[100:103], v1 offset:35840
  ds_read_b128 v[104:107], v1 offset:36864
  ds_read_b128 v[108:111], v1 offset:37888
  ds_read_b128 v[112:115], v1 offset:38912
  ds_read_b128 v[116:119], v1 offset:39936
  s_waitcnt lgkmcnt(5)
  v_mfma_f32_16x16x32_bf16 v[8:11], v[80:83], v[56:59], v[8:11]
  v_mfma_f32_16x16x32_bf16 v[12:15], v[84:87], v[56:59], v[12:15]
  v_mfma_f32_16x16x32_bf16 v[16:19], v[88:91], v[56:59], v[16:19]
  v_mfma_f32_16x16x32_bf16 v[20:23], v[92:95], v[56:59], v[20:23]
  v_mfma_f32_16x16x32_bf16 v[24:27], v[96:99], v[56:59], v[24:27]
  s_waitcnt lgkmcnt(0)
  v_mfma_f32_16x16x32_bf16 v[8:11], v[100:103], v[60:63], v[8:11]
  v_mfma_f32_16x16x32_bf16 v[12:15], v[104:107], v[60:63], v[12:15]
  v_mfma_f32_16x16x32_bf16 v[16:19], v[108:111], v[60:63], v[16:19]
  v_mfma_f32_16x16x32_bf16 v[20:23], v[112:115], v[60:63], v[20:23]
  v_mfma_f32_16x16x32_bf16 v[24:27], v[116:119], v[60:63], v[24:27]
  v_and_b32 v3, 63, v0
  v_and_b32 v4, 15, v3
  v_lshrrev_b32 v3, 4, v3
  s_lshl_b32 s21, s17, 6
  s_lshl_b32 s23, s16, 4
  s_add_u32 s21, s21, s23
  v_add_u32 v4, s21, v4
  v_mul_u32_u24 v6, 1280, v4
  v_lshl_add_u32 v6, v3, 4, v6
  s_mul_i32 s21, s18, 5
  s_add_u32 s23, s21, 0
  s_lshr_b32 s31, s23, 1
  s_lshl_b32 s31, s31, 6
  s_and_b32 s23, s23, 1
  s_lshl_b32 s23, s23, 3
  s_add_u32 s32, s31, s23
  s_add_u32 s40, s32, s20
  buffer_load_dwordx2 v[32:33], v6, s[8:11], s40 offen
  s_add_u32 s23, s21, 1
  s_lshr_b32 s31, s23, 1
  s_lshl_b32 s31, s31, 6
  s_and_b32 s23, s23, 1
  s_lshl_b32 s23, s23, 3
  s_add_u32 s33, s31, s23
  s_add_u32 s41, s33, s20
  buffer_load_dwordx2 v[34:35], v6, s[8:11], s41 offen
  s_add_u32 s23, s21, 2
  s_lshr_b32 s31, s23, 1
  s_lshl_b32 s31, s31, 6
  s_and_b32 s23, s23, 1
  s_lshl_b32 s23, s23, 3
  s_add_u32 s34, s31, s23
  s_add_u32 s42, s34, s20
  buffer_load_dwordx2 v[36:37], v6, s[8:11], s42 offen
  s_add_u32 s23, s21, 3
  s_lshr_b32 s31, s23, 1
  s_lshl_b32 s31, s31, 6
  s_and_b32 s23, s23, 1
  s_lshl_b32 s23, s23, 3
  s_add_u32 s35, s31, s23
  s_add_u32 s43, s35, s20
  buffer_load_dwordx2 v[38:39], v6, s[8:11], s43 offen
  s_add_u32 s23, s21, 4
  s_lshr_b32 s31, s23, 1
  s_lshl_b32 s31, s31, 6
  s_and_b32 s23, s23, 1
  s_lshl_b32 s23, s23, 3
  s_add_u32 s36, s31, s23
  s_add_u32 s44, s36, s20
  buffer_load_dwordx2 v[40:41], v6, s[8:11], s44 offen
  s_waitcnt vmcnt(0)
  v_cvt_pk_bf16_f32 v80, v8, v9
  v_cvt_pk_bf16_f32 v81, v10, v11
  v_lshlrev_b32 v8, 16, v80
  v_and_b32 v9, 0xffff0000, v80
  v_lshlrev_b32 v10, 16, v81
  v_and_b32 v11, 0xffff0000, v81
  v_lshlrev_b32 v82, 16, v32
  v_and_b32 v83, 0xffff0000, v32
  v_lshlrev_b32 v84, 16, v33
  v_and_b32 v85, 0xffff0000, v33
  v_add_f32 v8, v8, v82
  v_add_f32 v9, v9, v83
  v_add_f32 v10, v10, v84
  v_add_f32 v11, v11, v85
  v_cvt_pk_bf16_f32 v32, v8, v9
  v_cvt_pk_bf16_f32 v33, v10, v11
  buffer_store_dwordx2 v[32:33], v6, s[52:55], s32 offen
  v_cvt_pk_bf16_f32 v80, v12, v13
  v_cvt_pk_bf16_f32 v81, v14, v15
  v_lshlrev_b32 v12, 16, v80
  v_and_b32 v13, 0xffff0000, v80
  v_lshlrev_b32 v14, 16, v81
  v_and_b32 v15, 0xffff0000, v81
  v_lshlrev_b32 v82, 16, v34
  v_and_b32 v83, 0xffff0000, v34
  v_lshlrev_b32 v84, 16, v35
  v_and_b32 v85, 0xffff0000, v35
  v_add_f32 v12, v12, v82
  v_add_f32 v13, v13, v83
  v_add_f32 v14, v14, v84
  v_add_f32 v15, v15, v85
  v_cvt_pk_bf16_f32 v34, v12, v13
  v_cvt_pk_bf16_f32 v35, v14, v15
  buffer_store_dwordx2 v[34:35], v6, s[52:55], s33 offen
  v_cvt_pk_bf16_f32 v80, v16, v17
  v_cvt_pk_bf16_f32 v81, v18, v19
  v_lshlrev_b32 v16, 16, v80
  v_and_b32 v17, 0xffff0000, v80
  v_lshlrev_b32 v18, 16, v81
  v_and_b32 v19, 0xffff0000, v81
  v_lshlrev_b32 v82, 16, v36
  v_and_b32 v83, 0xffff0000, v36
  v_lshlrev_b32 v84, 16, v37
  v_and_b32 v85, 0xffff0000, v37
  v_add_f32 v16, v16, v82
  v_add_f32 v17, v17, v83
  v_add_f32 v18, v18, v84
  v_add_f32 v19, v19, v85
  v_cvt_pk_bf16_f32 v36, v16, v17
  v_cvt_pk_bf16_f32 v37, v18, v19
  buffer_store_dwordx2 v[36:37], v6, s[52:55], s34 offen
  v_cvt_pk_bf16_f32 v80, v20, v21
  v_cvt_pk_bf16_f32 v81, v22, v23
  v_lshlrev_b32 v20, 16, v80
  v_and_b32 v21, 0xffff0000, v80
  v_lshlrev_b32 v22, 16, v81
  v_and_b32 v23, 0xffff0000, v81
  v_lshlrev_b32 v82, 16, v38
  v_and_b32 v83, 0xffff0000, v38
  v_lshlrev_b32 v84, 16, v39
  v_and_b32 v85, 0xffff0000, v39
  v_add_f32 v20, v20, v82
  v_add_f32 v21, v21, v83
  v_add_f32 v22, v22, v84
  v_add_f32 v23, v23, v85
  v_cvt_pk_bf16_f32 v38, v20, v21
  v_cvt_pk_bf16_f32 v39, v22, v23
  buffer_store_dwordx2 v[38:39], v6, s[52:55], s35 offen
  v_cvt_pk_bf16_f32 v80, v24, v25
  v_cvt_pk_bf16_f32 v81, v26, v27
  v_lshlrev_b32 v24, 16, v80
  v_and_b32 v25, 0xffff0000, v80
  v_lshlrev_b32 v26, 16, v81
  v_and_b32 v27, 0xffff0000, v81
  v_lshlrev_b32 v82, 16, v40
  v_and_b32 v83, 0xffff0000, v40
  v_lshlrev_b32 v84, 16, v41
  v_and_b32 v85, 0xffff0000, v41
  v_add_f32 v24, v24, v82
  v_add_f32 v25, v25, v83
  v_add_f32 v26, v26, v84
  v_add_f32 v27, v27, v85
  v_cvt_pk_bf16_f32 v40, v24, v25
  v_cvt_pk_bf16_f32 v41, v26, v27
  buffer_store_dwordx2 v[40:41], v6, s[52:55], s36 offen
outb2_exit1:
  s_endpgm
.section .rodata,"a"
.p2align 6
.amdhsa_kernel prep_kernel
  .amdhsa_next_free_vgpr 64
  .amdhsa_next_free_sgpr 64
  .amdhsa_accum_offset 64
  .amdhsa_group_segment_fixed_size 0
  .amdhsa_kernarg_size 104
  .amdhsa_user_sgpr_count 2
  .amdhsa_user_sgpr_kernarg_segment_ptr 1
  .amdhsa_system_sgpr_workgroup_id_x 1
  .amdhsa_float_denorm_mode_32 3
.end_amdhsa_kernel
.p2align 6
.amdhsa_kernel ln1_kernel
  .amdhsa_next_free_vgpr 80
  .amdhsa_next_free_sgpr 40
  .amdhsa_accum_offset 80
  .amdhsa_group_segment_fixed_size 0
  .amdhsa_kernarg_size 104
  .amdhsa_user_sgpr_count 2
  .amdhsa_user_sgpr_kernarg_segment_ptr 1
  .amdhsa_system_sgpr_workgroup_id_x 1
  .amdhsa_float_denorm_mode_32 3
.end_amdhsa_kernel
.p2align 6
.amdhsa_kernel ln2_kernel
  .amdhsa_next_free_vgpr 80
  .amdhsa_next_free_sgpr 40
  .amdhsa_accum_offset 80
  .amdhsa_group_segment_fixed_size 0
  .amdhsa_kernarg_size 104
  .amdhsa_user_sgpr_count 2
  .amdhsa_user_sgpr_kernarg_segment_ptr 1
  .amdhsa_system_sgpr_workgroup_id_x 1
  .amdhsa_float_denorm_mode_32 3
.end_amdhsa_kernel
.p2align 6
.amdhsa_kernel reca_kernel
  .amdhsa_next_free_vgpr 512
  .amdhsa_next_free_sgpr 102
  .amdhsa_accum_offset 256
  .amdhsa_group_segment_fixed_size 0
  .amdhsa_kernarg_size 104
  .amdhsa_user_sgpr_count 2
  .amdhsa_user_sgpr_kernarg_segment_ptr 1
  .amdhsa_system_sgpr_workgroup_id_x 1
  .amdhsa_float_denorm_mode_32 3
.end_amdhsa_kernel
.p2align 6
.amdhsa_kernel attna_kernel
  .amdhsa_next_free_vgpr 248
  .amdhsa_next_free_sgpr 48
  .amdhsa_accum_offset 248
  .amdhsa_group_segment_fixed_size 0
  .amdhsa_kernarg_size 104
  .amdhsa_user_sgpr_count 2
  .amdhsa_user_sgpr_kernarg_segment_ptr 1
  .amdhsa_system_sgpr_workgroup_id_x 1
  .amdhsa_float_denorm_mode_32 3
.end_amdhsa_kernel
.p2align 6
.amdhsa_kernel outa1_kernel
  .amdhsa_next_free_vgpr 128
  .amdhsa_next_free_sgpr 64
  .amdhsa_accum_offset 128
  .amdhsa_group_segment_fixed_size 0
  .amdhsa_kernarg_size 104
  .amdhsa_user_sgpr_count 2
  .amdhsa_user_sgpr_kernarg_segment_ptr 1
  .amdhsa_system_sgpr_workgroup_id_x 1
  .amdhsa_float_denorm_mode_32 3
.end_amdhsa_kernel
.p2align 6
.amdhsa_kernel outa2_kernel
  .amdhsa_next_free_vgpr 128
  .amdhsa_next_free_sgpr 64
  .amdhsa_accum_offset 128
  .amdhsa_group_segment_fixed_size 0
  .amdhsa_kernarg_size 104
  .amdhsa_user_sgpr_count 2
  .amdhsa_user_sgpr_kernarg_segment_ptr 1
  .amdhsa_system_sgpr_workgroup_id_x 1
  .amdhsa_float_denorm_mode_32 3
.end_amdhsa_kernel
.p2align 6
.amdhsa_kernel qkvb_kernel
  .amdhsa_next_free_vgpr 256
  .amdhsa_next_free_sgpr 48
  .amdhsa_accum_offset 256
  .amdhsa_group_segment_fixed_size 0
  .amdhsa_kernarg_size 104
  .amdhsa_user_sgpr_count 2
  .amdhsa_user_sgpr_kernarg_segment_ptr 1
  .amdhsa_system_sgpr_workgroup_id_x 1
  .amdhsa_float_denorm_mode_32 3
.end_amdhsa_kernel
.p2align 6
.amdhsa_kernel attnb_kernel
  .amdhsa_next_free_vgpr 200
  .amdhsa_next_free_sgpr 48
  .amdhsa_accum_offset 200
  .amdhsa_group_segment_fixed_size 0
  .amdhsa_kernarg_size 104
  .amdhsa_user_sgpr_count 2
  .amdhsa_user_sgpr_kernarg_segment_ptr 1
  .amdhsa_system_sgpr_workgroup_id_x 1
  .amdhsa_float_denorm_mode_32 3
.end_amdhsa_kernel
.p2align 6
.amdhsa_kernel outb1_kernel
  .amdhsa_next_free_vgpr 128
  .amdhsa_next_free_sgpr 64
  .amdhsa_accum_offset 128
  .amdhsa_group_segment_fixed_size 0
  .amdhsa_kernarg_size 104
  .amdhsa_user_sgpr_count 2
  .amdhsa_user_sgpr_kernarg_segment_ptr 1
  .amdhsa_system_sgpr_workgroup_id_x 1
  .amdhsa_float_denorm_mode_32 3
.end_amdhsa_kernel
.p2align 6
.amdhsa_kernel outb2_kernel
  .amdhsa_next_free_vgpr 128
  .amdhsa_next_free_sgpr 64
  .amdhsa_accum_offset 128
  .amdhsa_group_segment_fixed_size 0
  .amdhsa_kernarg_size 104
  .amdhsa_user_sgpr_count 2
  .amdhsa_user_sgpr_kernarg_segment_ptr 1
  .amdhsa_system_sgpr_workgroup_id_x 1
  .amdhsa_float_denorm_mode_32 3
.end_amdhsa_kernel
```

```asm
; @launch kernel=prep_kernel grid=(2368,1,1) block=(256,1,1) lds=512
; @launch kernel=reca_kernel grid=(256,1,1) block=(256,1,1) lds=81920
; @launch kernel=fin_kernel grid=(256,1,1) block=(256,1,1) lds=98304
; @launch kernel=redln1_kernel grid=(128,1,1) block=(256,1,1) lds=512
; @launch kernel=qkvb_kernel grid=(256,1,1) block=(256,1,1) lds=81920
; @launch kernel=attnb_kernel grid=(256,1,1) block=(256,1,1) lds=0
; @launch kernel=outb1_kernel grid=(256,1,1) block=(256,1,1) lds=61440
; @launch kernel=ln2_kernel grid=(128,1,1) block=(256,1,1) lds=512
; @launch kernel=reca_kernel grid=(256,1,1) block=(256,1,1) lds=81920
; @launch kernel=fin_kernel grid=(256,1,1) block=(256,1,1) lds=98304
; @launch kernel=redln2_kernel grid=(128,1,1) block=(256,1,1) lds=512
; @launch kernel=qkvb_kernel grid=(256,1,1) block=(256,1,1) lds=81920
; @launch kernel=attnb_kernel grid=(256,1,1) block=(256,1,1) lds=0
; @launch kernel=outb2_kernel grid=(256,1,1) block=(256,1,1) lds=61440
.amdgcn_target "amdgcn-amd-amdhsa--gfx950"
.text
.globl prep_kernel
.p2align 8
.type prep_kernel,@function
prep_kernel:
  s_cmp_ge_u32 s2, 128
  s_cbranch_scc1 prep_notln5
  s_load_dwordx2 s[12:13], s[0:1], 96
  s_load_dwordx2 s[14:15], s[0:1], 0
  v_lshrrev_b32 v2, 6, v0
  v_and_b32 v3, 63, v0
  s_nop 0
  v_readfirstlane_b32 s16, v2
  s_waitcnt lgkmcnt(0)
  s_mov_b32 s4, s12
  s_mov_b32 s5, s13
  s_mov_b32 s6, 0x10000000
  s_mov_b32 s7, 0x20000
  s_mov_b32 s8, s14
  s_mov_b32 s9, s15
  s_mov_b32 s10, 2621440
  s_mov_b32 s11, 0x20000
  s_mov_b32 s20, 0
  v_and_b32 v2, 15, v3
  v_lshrrev_b32 v4, 4, v3
  s_lshl_b32 s17, s2, 4
  v_add_u32 v1, s17, v2
  v_mul_u32_u24 v1, 1280, v1
  v_lshl_add_u32 v1, v4, 4, v1
  s_mul_i32 s17, s16, 320
  s_add_u32 s20, s20, s17
  buffer_load_dwordx4 v[8:11], v1, s[8:11], s20 offen offset:0
  buffer_load_dwordx4 v[12:15], v1, s[8:11], s20 offen offset:64
  buffer_load_dwordx4 v[16:19], v1, s[8:11], s20 offen offset:128
  buffer_load_dwordx4 v[20:23], v1, s[8:11], s20 offen offset:192
  buffer_load_dwordx4 v[24:27], v1, s[8:11], s20 offen offset:256
  s_sub_u32 s21, 0, s12
  s_and_b32 s21, s21, 0x1fffff
  s_add_u32 s21, s21, 2097152
  v_mov_b32 v68, -1
  v_mov_b32 v69, -1
  v_mov_b32 v70, -1
  v_mov_b32 v71, -1
  v_lshlrev_b32 v72, 4, v0
  s_mul_i32 s22, s2, 12096
  s_add_u32 s22, s22, 0
  s_mul_i32 s23, s2, 12288
  s_add_u32 s23, s23, s21
  buffer_store_dwordx4 v[68:71], v72, s[4:7], s22 offen
  s_add_u32 s22, s22, 4096
  buffer_store_dwordx4 v[68:71], v72, s[4:7], s22 offen
  s_add_u32 s22, s22, 4096
  v_mov_b32 v73, 0x80000000
  v_cmp_gt_u32 vcc, 244, v0
  s_nop 1
  v_cndmask_b32 v73, v73, v72, vcc
  buffer_store_dwordx4 v[68:71], v73, s[4:7], s22 offen
  buffer_store_dwordx4 v[68:71], v72, s[4:7], s23 offen
  s_add_u32 s23, s23, 4096
  buffer_store_dwordx4 v[68:71], v72, s[4:7], s23 offen
  s_add_u32 s23, s23, 4096
  buffer_store_dwordx4 v[68:71], v72, s[4:7], s23 offen
  s_add_u32 s23, s23, 4096
  s_mul_i32 s23, s2, 2048
  s_add_u32 s23, s23, s21
  s_add_u32 s23, s23, 1572864
  v_mov_b32 v73, 0x80000000
  v_cmp_gt_u32 vcc, 128, v0
  s_nop 1
  v_cndmask_b32 v73, v73, v72, vcc
  buffer_store_dwordx4 v[68:71], v73, s[4:7], s23 offen sc1
  v_lshlrev_b32 v5, 2, v2
  s_lshl_b32 s17, s16, 6
  v_add_u32 v1, s17, v5
  s_waitcnt vmcnt(7)
  v_lshlrev_b32 v28, 16, v8
  v_and_b32 v29, 0xffff0000, v8
  v_lshlrev_b32 v30, 16, v9
  v_and_b32 v31, 0xffff0000, v9
  v_lshlrev_b32 v32, 16, v10
  v_and_b32 v33, 0xffff0000, v10
  v_lshlrev_b32 v34, 16, v11
  v_and_b32 v35, 0xffff0000, v11
  v_lshlrev_b32 v36, 16, v12
  v_and_b32 v37, 0xffff0000, v12
  v_lshlrev_b32 v38, 16, v13
  v_and_b32 v39, 0xffff0000, v13
  v_lshlrev_b32 v40, 16, v14
  v_and_b32 v41, 0xffff0000, v14
  v_lshlrev_b32 v42, 16, v15
  v_and_b32 v43, 0xffff0000, v15
  v_lshlrev_b32 v44, 16, v16
  v_and_b32 v45, 0xffff0000, v16
  v_lshlrev_b32 v46, 16, v17
  v_and_b32 v47, 0xffff0000, v17
  v_lshlrev_b32 v48, 16, v18
  v_and_b32 v49, 0xffff0000, v18
  v_lshlrev_b32 v50, 16, v19
  v_and_b32 v51, 0xffff0000, v19
  v_lshlrev_b32 v52, 16, v20
  v_and_b32 v53, 0xffff0000, v20
  v_lshlrev_b32 v54, 16, v21
  v_and_b32 v55, 0xffff0000, v21
  v_lshlrev_b32 v56, 16, v22
  v_and_b32 v57, 0xffff0000, v22
  v_lshlrev_b32 v58, 16, v23
  v_and_b32 v59, 0xffff0000, v23
  v_lshlrev_b32 v60, 16, v24
  v_and_b32 v61, 0xffff0000, v24
  v_lshlrev_b32 v62, 16, v25
  v_and_b32 v63, 0xffff0000, v25
  v_lshlrev_b32 v64, 16, v26
  v_and_b32 v65, 0xffff0000, v26
  v_lshlrev_b32 v66, 16, v27
  v_and_b32 v67, 0xffff0000, v27
  v_pk_add_f32 v[6:7], v[28:29], v[30:31]
  v_pk_add_f32 v[6:7], v[6:7], v[32:33]
  v_pk_add_f32 v[6:7], v[6:7], v[34:35]
  v_pk_add_f32 v[6:7], v[6:7], v[36:37]
  v_pk_add_f32 v[6:7], v[6:7], v[38:39]
  v_pk_add_f32 v[6:7], v[6:7], v[40:41]
  v_pk_add_f32 v[6:7], v[6:7], v[42:43]
  v_pk_add_f32 v[6:7], v[6:7], v[44:45]
  v_pk_add_f32 v[6:7], v[6:7], v[46:47]
  v_pk_add_f32 v[6:7], v[6:7], v[48:49]
  v_pk_add_f32 v[6:7], v[6:7], v[50:51]
  v_pk_add_f32 v[6:7], v[6:7], v[52:53]
  v_pk_add_f32 v[6:7], v[6:7], v[54:55]
  v_pk_add_f32 v[6:7], v[6:7], v[56:57]
  v_pk_add_f32 v[6:7], v[6:7], v[58:59]
  v_pk_add_f32 v[6:7], v[6:7], v[60:61]
  v_pk_add_f32 v[6:7], v[6:7], v[62:63]
  v_pk_add_f32 v[6:7], v[6:7], v[64:65]
  v_pk_add_f32 v[6:7], v[6:7], v[66:67]
  v_add_f32 v4, v6, v7
  v_mov_b32 v2, v4
  s_nop 1
  v_permlane32_swap_b32 v4, v2
  v_add_f32 v4, v4, v2
  v_mov_b32 v2, v4
  s_nop 1
  v_permlane16_swap_b32 v4, v2
  v_add_f32 v4, v4, v2
  ds_write_b32 v1, v4 offset:0
  s_waitcnt lgkmcnt(0)
  s_barrier
  ds_read_b32 v4, v5 offset:0
  ds_read_b32 v2, v5 offset:64
  ds_read_b32 v3, v5 offset:128
  ds_read_b32 v6, v5 offset:192
  s_waitcnt lgkmcnt(0)
  v_add_f32 v4, v4, v2
  v_add_f32 v3, v3, v6
  v_add_f32 v4, v4, v3
  v_mul_f32 v4, 0x3acccccd, v4
  v_sub_f32 v28, v28, v4
  v_sub_f32 v29, v29, v4
  v_sub_f32 v30, v30, v4
  v_sub_f32 v31, v31, v4
  v_sub_f32 v32, v32, v4
  v_sub_f32 v33, v33, v4
  v_sub_f32 v34, v34, v4
  v_sub_f32 v35, v35, v4
  v_sub_f32 v36, v36, v4
  v_sub_f32 v37, v37, v4
  v_sub_f32 v38, v38, v4
  v_sub_f32 v39, v39, v4
  v_sub_f32 v40, v40, v4
  v_sub_f32 v41, v41, v4
  v_sub_f32 v42, v42, v4
  v_sub_f32 v43, v43, v4
  v_sub_f32 v44, v44, v4
  v_sub_f32 v45, v45, v4
  v_sub_f32 v46, v46, v4
  v_sub_f32 v47, v47, v4
  v_sub_f32 v48, v48, v4
  v_sub_f32 v49, v49, v4
  v_sub_f32 v50, v50, v4
  v_sub_f32 v51, v51, v4
  v_sub_f32 v52, v52, v4
  v_sub_f32 v53, v53, v4
  v_sub_f32 v54, v54, v4
  v_sub_f32 v55, v55, v4
  v_sub_f32 v56, v56, v4
  v_sub_f32 v57, v57, v4
  v_sub_f32 v58, v58, v4
  v_sub_f32 v59, v59, v4
  v_sub_f32 v60, v60, v4
  v_sub_f32 v61, v61, v4
  v_sub_f32 v62, v62, v4
  v_sub_f32 v63, v63, v4
  v_sub_f32 v64, v64, v4
  v_sub_f32 v65, v65, v4
  v_sub_f32 v66, v66, v4
  v_sub_f32 v67, v67, v4
  v_mul_f32 v6, v28, v28
  v_mul_f32 v7, v29, v29
  v_fmac_f32 v6, v30, v30
  v_fmac_f32 v7, v31, v31
  v_fmac_f32 v6, v32, v32
  v_fmac_f32 v7, v33, v33
  v_fmac_f32 v6, v34, v34
  v_fmac_f32 v7, v35, v35
  v_fmac_f32 v6, v36, v36
  v_fmac_f32 v7, v37, v37
  v_fmac_f32 v6, v38, v38
  v_fmac_f32 v7, v39, v39
  v_fmac_f32 v6, v40, v40
  v_fmac_f32 v7, v41, v41
  v_fmac_f32 v6, v42, v42
  v_fmac_f32 v7, v43, v43
  v_fmac_f32 v6, v44, v44
  v_fmac_f32 v7, v45, v45
  v_fmac_f32 v6, v46, v46
  v_fmac_f32 v7, v47, v47
  v_fmac_f32 v6, v48, v48
  v_fmac_f32 v7, v49, v49
  v_fmac_f32 v6, v50, v50
  v_fmac_f32 v7, v51, v51
  v_fmac_f32 v6, v52, v52
  v_fmac_f32 v7, v53, v53
  v_fmac_f32 v6, v54, v54
  v_fmac_f32 v7, v55, v55
  v_fmac_f32 v6, v56, v56
  v_fmac_f32 v7, v57, v57
  v_fmac_f32 v6, v58, v58
  v_fmac_f32 v7, v59, v59
  v_fmac_f32 v6, v60, v60
  v_fmac_f32 v7, v61, v61
  v_fmac_f32 v6, v62, v62
  v_fmac_f32 v7, v63, v63
  v_fmac_f32 v6, v64, v64
  v_fmac_f32 v7, v65, v65
  v_fmac_f32 v6, v66, v66
  v_fmac_f32 v7, v67, v67
  v_add_f32 v4, v6, v7
  v_mov_b32 v2, v4
  s_nop 1
  v_permlane32_swap_b32 v4, v2
  v_add_f32 v4, v4, v2
  v_mov_b32 v2, v4
  s_nop 1
  v_permlane16_swap_b32 v4, v2
  v_add_f32 v4, v4, v2
  ds_write_b32 v1, v4 offset:256
  s_waitcnt lgkmcnt(0)
  s_barrier
  ds_read_b32 v4, v5 offset:256
  ds_read_b32 v2, v5 offset:320
  ds_read_b32 v3, v5 offset:384
  ds_read_b32 v6, v5 offset:448
  s_waitcnt lgkmcnt(0)
  v_add_f32 v4, v4, v2
  v_add_f32 v3, v3, v6
  v_add_f32 v4, v4, v3
  v_mov_b32 v2, 0x3727c5ac
  v_fmac_f32 v2, 0x3acccccd, v4
  v_rsq_f32 v4, v2
  s_nop 0
  v_mul_f32 v28, v28, v4
  v_mul_f32 v29, v29, v4
  v_mul_f32 v30, v30, v4
  v_mul_f32 v31, v31, v4
  v_mul_f32 v32, v32, v4
  v_mul_f32 v33, v33, v4
  v_mul_f32 v34, v34, v4
  v_mul_f32 v35, v35, v4
  v_mul_f32 v36, v36, v4
  v_mul_f32 v37, v37, v4
  v_mul_f32 v38, v38, v4
  v_mul_f32 v39, v39, v4
  v_mul_f32 v40, v40, v4
  v_mul_f32 v41, v41, v4
  v_mul_f32 v42, v42, v4
  v_mul_f32 v43, v43, v4
  v_mul_f32 v44, v44, v4
  v_mul_f32 v45, v45, v4
  v_mul_f32 v46, v46, v4
  v_mul_f32 v47, v47, v4
  v_mul_f32 v48, v48, v4
  v_mul_f32 v49, v49, v4
  v_mul_f32 v50, v50, v4
  v_mul_f32 v51, v51, v4
  v_mul_f32 v52, v52, v4
  v_mul_f32 v53, v53, v4
  v_mul_f32 v54, v54, v4
  v_mul_f32 v55, v55, v4
  v_mul_f32 v56, v56, v4
  v_mul_f32 v57, v57, v4
  v_mul_f32 v58, v58, v4
  v_mul_f32 v59, v59, v4
  v_mul_f32 v60, v60, v4
  v_mul_f32 v61, v61, v4
  v_mul_f32 v62, v62, v4
  v_mul_f32 v63, v63, v4
  v_mul_f32 v64, v64, v4
  v_mul_f32 v65, v65, v4
  v_mul_f32 v66, v66, v4
  v_mul_f32 v67, v67, v4
  v_cvt_pk_bf16_f32 v8, v28, v29
  v_cvt_pk_bf16_f32 v9, v30, v31
  v_cvt_pk_bf16_f32 v10, v32, v33
  v_cvt_pk_bf16_f32 v11, v34, v35
  v_cvt_pk_bf16_f32 v12, v36, v37
  v_cvt_pk_bf16_f32 v13, v38, v39
  v_cvt_pk_bf16_f32 v14, v40, v41
  v_cvt_pk_bf16_f32 v15, v42, v43
  v_cvt_pk_bf16_f32 v16, v44, v45
  v_cvt_pk_bf16_f32 v17, v46, v47
  v_cvt_pk_bf16_f32 v18, v48, v49
  v_cvt_pk_bf16_f32 v19, v50, v51
  v_cvt_pk_bf16_f32 v20, v52, v53
  v_cvt_pk_bf16_f32 v21, v54, v55
  v_cvt_pk_bf16_f32 v22, v56, v57
  v_cvt_pk_bf16_f32 v23, v58, v59
  v_cvt_pk_bf16_f32 v24, v60, v61
  v_cvt_pk_bf16_f32 v25, v62, v63
  v_cvt_pk_bf16_f32 v26, v64, v65
  v_cvt_pk_bf16_f32 v27, v66, v67
  v_and_b32 v3, 63, v0
  v_lshlrev_b32 v1, 4, v3
  s_mul_i32 s17, s2, 20480
  s_mul_i32 s18, s16, 5120
  s_add_u32 s17, s17, s18
  s_add_u32 s17, s17, 153616384
  buffer_store_dwordx4 v[8:11], v1, s[4:7], s17 offen offset:0
  buffer_store_dwordx4 v[12:15], v1, s[4:7], s17 offen offset:1024
  buffer_store_dwordx4 v[16:19], v1, s[4:7], s17 offen offset:2048
  buffer_store_dwordx4 v[20:23], v1, s[4:7], s17 offen offset:3072
  s_add_u32 s17, s17, 4096
  buffer_store_dwordx4 v[24:27], v1, s[4:7], s17 offen offset:0
  s_endpgm
prep_notln5:
  s_sub_u32 s2, s2, 128
  s_cmp_ge_u32 s2, 2240
  s_cbranch_scc1 prep_exit1
  s_load_dwordx2 s[12:13], s[0:1], 96
  s_load_dwordx4 s[16:19], s[0:1], 16
  s_load_dwordx4 s[20:23], s[0:1], 32
  s_load_dwordx4 s[24:27], s[0:1], 64
  v_lshrrev_b32 v6, 6, v0
  v_and_b32 v1, 63, v0
  s_nop 0
  v_readfirstlane_b32 s14, v6
  v_lshlrev_b32 v5, 4, v1
  s_lshl_b32 s15, s2, 2
  s_nop 1
  s_add_u32 s15, s15, s14
  s_waitcnt lgkmcnt(0)
  s_mov_b32 s4, s12
  s_mov_b32 s5, s13
  s_mov_b32 s6, 0x10000000
  s_mov_b32 s7, 0x20000
  s_mov_b32 s11, 0x20000
  v_and_b32 v2, 15, v1
  v_lshrrev_b32 v3, 4, v1
  s_cmp_ge_u32 s15, 5760
  s_cbranch_scc1 prep_s22
  s_mul_hi_u32 s31, s15, 2236963
  s_mul_i32 s32, s31, 1920
  s_sub_u32 s32, s15, s32
  s_mul_hi_u32 s33, s32, 214748365
  s_mul_i32 s34, s33, 20
  s_sub_u32 s34, s32, s34
  s_cmp_eq_u32 s31, 0
  s_cselect_b32 s8, s16, s18
  s_cselect_b32 s9, s17, s19
  s_cmp_eq_u32 s31, 2
  s_cselect_b32 s8, s20, s8
  s_cselect_b32 s9, s21, s9
  s_mov_b32 s10, 7864320
  s_mul_i32 s35, s31, 7864320
  s_add_u32 s35, s35, 6291456
  v_lshlrev_b32 v6, 3, v3
  s_lshl_b32 s36, s34, 5
  v_add_u32 v6, s36, v6
  s_mov_b32 s37, 12288
  v_mul_lo_u32 v4, v6, s37
  s_lshl_b32 s36, s33, 7
  v_lshl_add_u32 v4, v2, 1, v4
  v_add_u32 v4, s36, v4
  s_mov_b32 s29, 0
  buffer_load_ushort v16, v4, s[8:11], s29 offen
  s_mov_b32 s29, 12288
  buffer_load_ushort v17, v4, s[8:11], s29 offen
  s_mov_b32 s29, 24576
  buffer_load_ushort v18, v4, s[8:11], s29 offen
  s_mov_b32 s29, 36864
  buffer_load_ushort v19, v4, s[8:11], s29 offen
  s_mov_b32 s29, 49152
  buffer_load_ushort v20, v4, s[8:11], s29 offen
  s_mov_b32 s29, 61440
  buffer_load_ushort v21, v4, s[8:11], s29 offen
  s_mov_b32 s29, 73728
  buffer_load_ushort v22, v4, s[8:11], s29 offen
  s_mov_b32 s29, 86016
  buffer_load_ushort v23, v4, s[8:11], s29 offen
  s_mov_b32 s29, 32
  buffer_load_ushort v24, v4, s[8:11], s29 offen
  s_mov_b32 s29, 12320
  buffer_load_ushort v25, v4, s[8:11], s29 offen
  s_mov_b32 s29, 24608
  buffer_load_ushort v26, v4, s[8:11], s29 offen
  s_mov_b32 s29, 36896
  buffer_load_ushort v27, v4, s[8:11], s29 offen
  s_mov_b32 s29, 49184
  buffer_load_ushort v28, v4, s[8:11], s29 offen
  s_mov_b32 s29, 61472
  buffer_load_ushort v29, v4, s[8:11], s29 offen
  s_mov_b32 s29, 73760
  buffer_load_ushort v30, v4, s[8:11], s29 offen
  s_mov_b32 s29, 86048
  buffer_load_ushort v31, v4, s[8:11], s29 offen
  s_mov_b32 s29, 64
  buffer_load_ushort v32, v4, s[8:11], s29 offen
  s_mov_b32 s29, 12352
  buffer_load_ushort v33, v4, s[8:11], s29 offen
  s_mov_b32 s29, 24640
  buffer_load_ushort v34, v4, s[8:11], s29 offen
  s_mov_b32 s29, 36928
  buffer_load_ushort v35, v4, s[8:11], s29 offen
  s_mov_b32 s29, 49216
  buffer_load_ushort v36, v4, s[8:11], s29 offen
  s_mov_b32 s29, 61504
  buffer_load_ushort v37, v4, s[8:11], s29 offen
  s_mov_b32 s29, 73792
  buffer_load_ushort v38, v4, s[8:11], s29 offen
  s_mov_b32 s29, 86080
  buffer_load_ushort v39, v4, s[8:11], s29 offen
  s_mov_b32 s29, 96
  buffer_load_ushort v40, v4, s[8:11], s29 offen
  s_mov_b32 s29, 12384
  buffer_load_ushort v41, v4, s[8:11], s29 offen
  s_mov_b32 s29, 24672
  buffer_load_ushort v42, v4, s[8:11], s29 offen
  s_mov_b32 s29, 36960
  buffer_load_ushort v43, v4, s[8:11], s29 offen
  s_mov_b32 s29, 49248
  buffer_load_ushort v44, v4, s[8:11], s29 offen
  s_mov_b32 s29, 61536
  buffer_load_ushort v45, v4, s[8:11], s29 offen
  s_mov_b32 s29, 73824
  buffer_load_ushort v46, v4, s[8:11], s29 offen
  s_mov_b32 s29, 86112
  buffer_load_ushort v47, v4, s[8:11], s29 offen
  s_waitcnt vmcnt(24)
  v_lshl_or_b32 v48, v17, 16, v16
  v_lshl_or_b32 v49, v19, 16, v18
  v_lshl_or_b32 v50, v21, 16, v20
  v_lshl_or_b32 v51, v23, 16, v22
  s_lshl_b32 s30, s33, 2
  s_add_u32 s30, s30, 0
  s_mul_i32 s30, s30, 20
  s_add_u32 s30, s30, s34
  s_lshl_b32 s30, s30, 10
  s_add_u32 s30, s30, s35
  buffer_store_dwordx4 v[48:51], v5, s[4:7], s30 offen
  s_waitcnt vmcnt(17)
  v_lshl_or_b32 v52, v25, 16, v24
  v_lshl_or_b32 v53, v27, 16, v26
  v_lshl_or_b32 v54, v29, 16, v28
  v_lshl_or_b32 v55, v31, 16, v30
  s_lshl_b32 s30, s33, 2
  s_add_u32 s30, s30, 1
  s_mul_i32 s30, s30, 20
  s_add_u32 s30, s30, s34
  s_lshl_b32 s30, s30, 10
  s_add_u32 s30, s30, s35
  buffer_store_dwordx4 v[52:55], v5, s[4:7], s30 offen
  s_waitcnt vmcnt(10)
  v_lshl_or_b32 v56, v33, 16, v32
  v_lshl_or_b32 v57, v35, 16, v34
  v_lshl_or_b32 v58, v37, 16, v36
  v_lshl_or_b32 v59, v39, 16, v38
  s_lshl_b32 s30, s33, 2
  s_add_u32 s30, s30, 2
  s_mul_i32 s30, s30, 20
  s_add_u32 s30, s30, s34
  s_lshl_b32 s30, s30, 10
  s_add_u32 s30, s30, s35
  buffer_store_dwordx4 v[56:59], v5, s[4:7], s30 offen
  s_waitcnt vmcnt(3)
  v_lshl_or_b32 v60, v41, 16, v40
  v_lshl_or_b32 v61, v43, 16, v42
  v_lshl_or_b32 v62, v45, 16, v44
  v_lshl_or_b32 v63, v47, 16, v46
  s_lshl_b32 s30, s33, 2
  s_add_u32 s30, s30, 3
  s_mul_i32 s30, s30, 20
  s_add_u32 s30, s30, s34
  s_lshl_b32 s30, s30, 10
  s_add_u32 s30, s30, s35
  buffer_store_dwordx4 v[60:63], v5, s[4:7], s30 offen
  s_branch prep_exit1
prep_s22:
  s_sub_u32 s15, s15, 5760
  s_cmp_ge_u32 s15, 1920
  s_cbranch_scc1 prep_s33
  s_mul_hi_u32 s33, s15, 22369622
  s_mul_i32 s34, s33, 192
  s_sub_u32 s34, s15, s34
  s_mov_b32 s8, s22
  s_mov_b32 s9, s23
  s_mov_b32 s10, 7864320
  v_lshlrev_b32 v6, 2, v3
  s_lshl_b32 s36, s34, 5
  v_add_u32 v6, s36, v6
  v_mul_u32_u24 v4, 1280, v6
  v_lshrrev_b32 v6, 2, v2
  v_lshl_add_u32 v4, v6, 4, v4
  v_and_b32 v6, 3, v2
  v_lshl_add_u32 v4, v6, 1, v4
  s_lshl_b32 s36, s33, 7
  v_add_u32 v4, s36, v4
  s_mov_b32 s29, 0
  buffer_load_ushort v16, v4, s[8:11], s29 offen
  s_mov_b32 s29, 1280
  buffer_load_ushort v17, v4, s[8:11], s29 offen
  s_mov_b32 s29, 2560
  buffer_load_ushort v18, v4, s[8:11], s29 offen
  s_mov_b32 s29, 3840
  buffer_load_ushort v19, v4, s[8:11], s29 offen
  s_mov_b32 s29, 20480
  buffer_load_ushort v20, v4, s[8:11], s29 offen
  s_mov_b32 s29, 21760
  buffer_load_ushort v21, v4, s[8:11], s29 offen
  s_mov_b32 s29, 23040
  buffer_load_ushort v22, v4, s[8:11], s29 offen
  s_mov_b32 s29, 24320
  buffer_load_ushort v23, v4, s[8:11], s29 offen
  s_mov_b32 s29, 8
  buffer_load_ushort v24, v4, s[8:11], s29 offen
  s_mov_b32 s29, 1288
  buffer_load_ushort v25, v4, s[8:11], s29 offen
  s_mov_b32 s29, 2568
  buffer_load_ushort v26, v4, s[8:11], s29 offen
  s_mov_b32 s29, 3848
  buffer_load_ushort v27, v4, s[8:11], s29 offen
  s_mov_b32 s29, 20488
  buffer_load_ushort v28, v4, s[8:11], s29 offen
  s_mov_b32 s29, 21768
  buffer_load_ushort v29, v4, s[8:11], s29 offen
  s_mov_b32 s29, 23048
  buffer_load_ushort v30, v4, s[8:11], s29 offen
  s_mov_b32 s29, 24328
  buffer_load_ushort v31, v4, s[8:11], s29 offen
  s_mov_b32 s29, 64
  buffer_load_ushort v32, v4, s[8:11], s29 offen
  s_mov_b32 s29, 1344
  buffer_load_ushort v33, v4, s[8:11], s29 offen
  s_mov_b32 s29, 2624
  buffer_load_ushort v34, v4, s[8:11], s29 offen
  s_mov_b32 s29, 3904
  buffer_load_ushort v35, v4, s[8:11], s29 offen
  s_mov_b32 s29, 20544
  buffer_load_ushort v36, v4, s[8:11], s29 offen
  s_mov_b32 s29, 21824
  buffer_load_ushort v37, v4, s[8:11], s29 offen
  s_mov_b32 s29, 23104
  buffer_load_ushort v38, v4, s[8:11], s29 offen
  s_mov_b32 s29, 24384
  buffer_load_ushort v39, v4, s[8:11], s29 offen
  s_mov_b32 s29, 72
  buffer_load_ushort v40, v4, s[8:11], s29 offen
  s_mov_b32 s29, 1352
  buffer_load_ushort v41, v4, s[8:11], s29 offen
  s_mov_b32 s29, 2632
  buffer_load_ushort v42, v4, s[8:11], s29 offen
  s_mov_b32 s29, 3912
  buffer_load_ushort v43, v4, s[8:11], s29 offen
  s_mov_b32 s29, 20552
  buffer_load_ushort v44, v4, s[8:11], s29 offen
  s_mov_b32 s29, 21832
  buffer_load_ushort v45, v4, s[8:11], s29 offen
  s_mov_b32 s29, 23112
  buffer_load_ushort v46, v4, s[8:11], s29 offen
  s_mov_b32 s29, 24392
  buffer_load_ushort v47, v4, s[8:11], s29 offen
  s_waitcnt vmcnt(24)
  v_lshl_or_b32 v48, v17, 16, v16
  v_lshl_or_b32 v49, v19, 16, v18
  v_lshl_or_b32 v50, v21, 16, v20
  v_lshl_or_b32 v51, v23, 16, v22
  s_lshl_b32 s30, s33, 2
  s_add_u32 s30, s30, 0
  s_mul_i32 s30, s30, 192
  s_add_u32 s30, s30, s34
  s_lshl_b32 s30, s30, 10
  s_add_u32 s30, s30, 29884416
  buffer_store_dwordx4 v[48:51], v5, s[4:7], s30 offen
  s_waitcnt vmcnt(17)
  v_lshl_or_b32 v52, v25, 16, v24
  v_lshl_or_b32 v53, v27, 16, v26
  v_lshl_or_b32 v54, v29, 16, v28
  v_lshl_or_b32 v55, v31, 16, v30
  s_lshl_b32 s30, s33, 2
  s_add_u32 s30, s30, 1
  s_mul_i32 s30, s30, 192
  s_add_u32 s30, s30, s34
  s_lshl_b32 s30, s30, 10
  s_add_u32 s30, s30, 29884416
  buffer_store_dwordx4 v[52:55], v5, s[4:7], s30 offen
  s_waitcnt vmcnt(10)
  v_lshl_or_b32 v56, v33, 16, v32
  v_lshl_or_b32 v57, v35, 16, v34
  v_lshl_or_b32 v58, v37, 16, v36
  v_lshl_or_b32 v59, v39, 16, v38
  s_lshl_b32 s30, s33, 2
  s_add_u32 s30, s30, 2
  s_mul_i32 s30, s30, 192
  s_add_u32 s30, s30, s34
  s_lshl_b32 s30, s30, 10
  s_add_u32 s30, s30, 29884416
  buffer_store_dwordx4 v[56:59], v5, s[4:7], s30 offen
  s_waitcnt vmcnt(3)
  v_lshl_or_b32 v60, v41, 16, v40
  v_lshl_or_b32 v61, v43, 16, v42
  v_lshl_or_b32 v62, v45, 16, v44
  v_lshl_or_b32 v63, v47, 16, v46
  s_lshl_b32 s30, s33, 2
  s_add_u32 s30, s30, 3
  s_mul_i32 s30, s30, 192
  s_add_u32 s30, s30, s34
  s_lshl_b32 s30, s30, 10
  s_add_u32 s30, s30, 29884416
  buffer_store_dwordx4 v[60:63], v5, s[4:7], s30 offen
  s_branch prep_exit1
prep_s33:
  s_sub_u32 s15, s15, 1920
  s_cmp_ge_u32 s15, 960
  s_cbranch_scc1 prep_s44
  s_mul_hi_u32 s33, s15, 107374183
  s_mul_i32 s34, s33, 40
  s_sub_u32 s34, s15, s34
  s_mov_b32 s8, s24
  s_mov_b32 s9, s25
  s_mov_b32 s10, 2457600
  v_lshrrev_b32 v6, 5, v1
  v_lshlrev_b32 v6, 3, v6
  s_lshl_b32 s36, s34, 4
  v_add_u32 v6, s36, v6
  v_mul_u32_u24 v4, 3840, v6
  v_and_b32 v6, 31, v1
  v_lshl_add_u32 v4, v6, 1, v4
  s_mul_i32 s36, s33, 160
  v_add_u32 v4, s36, v4
  v_cmp_gt_u32 vcc, 20, v6
  v_mov_b32 v6, 0x80000000
  s_nop 0
  v_cndmask_b32 v4, v6, v4, vcc
  s_mov_b32 s29, 0
  buffer_load_ushort v16, v4, s[8:11], s29 offen
  s_mov_b32 s29, 3840
  buffer_load_ushort v17, v4, s[8:11], s29 offen
  s_mov_b32 s29, 7680
  buffer_load_ushort v18, v4, s[8:11], s29 offen
  s_mov_b32 s29, 11520
  buffer_load_ushort v19, v4, s[8:11], s29 offen
  s_mov_b32 s29, 15360
  buffer_load_ushort v20, v4, s[8:11], s29 offen
  s_mov_b32 s29, 19200
  buffer_load_ushort v21, v4, s[8:11], s29 offen
  s_mov_b32 s29, 23040
  buffer_load_ushort v22, v4, s[8:11], s29 offen
  s_mov_b32 s29, 26880
  buffer_load_ushort v23, v4, s[8:11], s29 offen
  s_mov_b32 s29, 40
  buffer_load_ushort v24, v4, s[8:11], s29 offen
  s_mov_b32 s29, 3880
  buffer_load_ushort v25, v4, s[8:11], s29 offen
  s_mov_b32 s29, 7720
  buffer_load_ushort v26, v4, s[8:11], s29 offen
  s_mov_b32 s29, 11560
  buffer_load_ushort v27, v4, s[8:11], s29 offen
  s_mov_b32 s29, 15400
  buffer_load_ushort v28, v4, s[8:11], s29 offen
  s_mov_b32 s29, 19240
  buffer_load_ushort v29, v4, s[8:11], s29 offen
  s_mov_b32 s29, 23080
  buffer_load_ushort v30, v4, s[8:11], s29 offen
  s_mov_b32 s29, 26920
  buffer_load_ushort v31, v4, s[8:11], s29 offen
  s_mov_b32 s29, 80
  buffer_load_ushort v32, v4, s[8:11], s29 offen
  s_mov_b32 s29, 3920
  buffer_load_ushort v33, v4, s[8:11], s29 offen
  s_mov_b32 s29, 7760
  buffer_load_ushort v34, v4, s[8:11], s29 offen
  s_mov_b32 s29, 11600
  buffer_load_ushort v35, v4, s[8:11], s29 offen
  s_mov_b32 s29, 15440
  buffer_load_ushort v36, v4, s[8:11], s29 offen
  s_mov_b32 s29, 19280
  buffer_load_ushort v37, v4, s[8:11], s29 offen
  s_mov_b32 s29, 23120
  buffer_load_ushort v38, v4, s[8:11], s29 offen
  s_mov_b32 s29, 26960
  buffer_load_ushort v39, v4, s[8:11], s29 offen
  s_mov_b32 s29, 120
  buffer_load_ushort v40, v4, s[8:11], s29 offen
  s_mov_b32 s29, 3960
  buffer_load_ushort v41, v4, s[8:11], s29 offen
  s_mov_b32 s29, 7800
  buffer_load_ushort v42, v4, s[8:11], s29 offen
  s_mov_b32 s29, 11640
  buffer_load_ushort v43, v4, s[8:11], s29 offen
  s_mov_b32 s29, 15480
  buffer_load_ushort v44, v4, s[8:11], s29 offen
  s_mov_b32 s29, 19320
  buffer_load_ushort v45, v4, s[8:11], s29 offen
  s_mov_b32 s29, 23160
  buffer_load_ushort v46, v4, s[8:11], s29 offen
  s_mov_b32 s29, 27000
  buffer_load_ushort v47, v4, s[8:11], s29 offen
  s_waitcnt vmcnt(24)
  v_lshl_or_b32 v48, v17, 16, v16
  v_lshl_or_b32 v49, v19, 16, v18
  v_lshl_or_b32 v50, v21, 16, v20
  v_lshl_or_b32 v51, v23, 16, v22
  s_lshl_b32 s30, s33, 2
  s_add_u32 s30, s30, 0
  s_mul_i32 s30, s30, 40
  s_add_u32 s30, s30, s34
  s_lshl_b32 s30, s30, 10
  s_add_u32 s30, s30, 156237824
  buffer_store_dwordx4 v[48:51], v5, s[4:7], s30 offen
  s_waitcnt vmcnt(17)
  v_lshl_or_b32 v52, v25, 16, v24
  v_lshl_or_b32 v53, v27, 16, v26
  v_lshl_or_b32 v54, v29, 16, v28
  v_lshl_or_b32 v55, v31, 16, v30
  s_lshl_b32 s30, s33, 2
  s_add_u32 s30, s30, 1
  s_mul_i32 s30, s30, 40
  s_add_u32 s30, s30, s34
  s_lshl_b32 s30, s30, 10
  s_add_u32 s30, s30, 156237824
  buffer_store_dwordx4 v[52:55], v5, s[4:7], s30 offen
  s_waitcnt vmcnt(10)
  v_lshl_or_b32 v56, v33, 16, v32
  v_lshl_or_b32 v57, v35, 16, v34
  v_lshl_or_b32 v58, v37, 16, v36
  v_lshl_or_b32 v59, v39, 16, v38
  s_lshl_b32 s30, s33, 2
  s_add_u32 s30, s30, 2
  s_mul_i32 s30, s30, 40
  s_add_u32 s30, s30, s34
  s_lshl_b32 s30, s30, 10
  s_add_u32 s30, s30, 156237824
  buffer_store_dwordx4 v[56:59], v5, s[4:7], s30 offen
  s_waitcnt vmcnt(3)
  v_lshl_or_b32 v60, v41, 16, v40
  v_lshl_or_b32 v61, v43, 16, v42
  v_lshl_or_b32 v62, v45, 16, v44
  v_lshl_or_b32 v63, v47, 16, v46
  s_lshl_b32 s30, s33, 2
  s_add_u32 s30, s30, 3
  s_mul_i32 s30, s30, 40
  s_add_u32 s30, s30, s34
  s_lshl_b32 s30, s30, 10
  s_add_u32 s30, s30, 156237824
  buffer_store_dwordx4 v[60:63], v5, s[4:7], s30 offen
  s_branch prep_exit1
prep_s44:
  s_sub_u32 s15, s15, 960
  s_mul_hi_u32 s33, s15, 134217728
  s_and_b32 s34, s15, 31
  s_lshr_b32 s33, s15, 5
  s_mov_b32 s8, s26
  s_mov_b32 s9, s27
  s_mov_b32 s10, 819200
  v_lshrrev_b32 v6, 1, v3
  v_lshlrev_b32 v6, 4, v6
  v_and_b32 v7, 1, v3
  v_lshl_add_u32 v6, v7, 2, v6
  v_mov_b32 v8, v6
  s_mul_i32 s36, s34, 20
  v_add_u32 v6, s36, v6
  v_mul_u32_u24 v4, 1280, v6
  v_lshrrev_b32 v6, 2, v2
  v_lshl_add_u32 v4, v6, 4, v4
  v_and_b32 v6, 3, v2
  v_lshl_add_u32 v4, v6, 1, v4
  s_lshl_b32 s36, s33, 7
  v_add_u32 v4, s36, v4
  v_mov_b32 v9, 0x80000000
  v_cmp_gt_u32 vcc, 17, v8
  s_nop 1
  v_cndmask_b32 v10, v9, v4, vcc
  v_cmp_gt_u32 vcc, 9, v8
  s_nop 1
  v_cndmask_b32 v11, v9, v4, vcc
  s_mov_b32 s29, 0
  buffer_load_ushort v16, v10, s[8:11], s29 offen
  s_mov_b32 s29, 1280
  buffer_load_ushort v17, v10, s[8:11], s29 offen
  s_mov_b32 s29, 2560
  buffer_load_ushort v18, v10, s[8:11], s29 offen
  s_mov_b32 s29, 3840
  buffer_load_ushort v19, v10, s[8:11], s29 offen
  s_mov_b32 s29, 10240
  buffer_load_ushort v20, v11, s[8:11], s29 offen
  s_mov_b32 s29, 11520
  buffer_load_ushort v21, v11, s[8:11], s29 offen
  s_mov_b32 s29, 12800
  buffer_load_ushort v22, v11, s[8:11], s29 offen
  s_mov_b32 s29, 14080
  buffer_load_ushort v23, v11, s[8:11], s29 offen
  s_mov_b32 s29, 8
  buffer_load_ushort v24, v10, s[8:11], s29 offen
  s_mov_b32 s29, 1288
  buffer_load_ushort v25, v10, s[8:11], s29 offen
  s_mov_b32 s29, 2568
  buffer_load_ushort v26, v10, s[8:11], s29 offen
  s_mov_b32 s29, 3848
  buffer_load_ushort v27, v10, s[8:11], s29 offen
  s_mov_b32 s29, 10248
  buffer_load_ushort v28, v11, s[8:11], s29 offen
  s_mov_b32 s29, 11528
  buffer_load_ushort v29, v11, s[8:11], s29 offen
  s_mov_b32 s29, 12808
  buffer_load_ushort v30, v11, s[8:11], s29 offen
  s_mov_b32 s29, 14088
  buffer_load_ushort v31, v11, s[8:11], s29 offen
  s_mov_b32 s29, 64
  buffer_load_ushort v32, v10, s[8:11], s29 offen
  s_mov_b32 s29, 1344
  buffer_load_ushort v33, v10, s[8:11], s29 offen
  s_mov_b32 s29, 2624
  buffer_load_ushort v34, v10, s[8:11], s29 offen
  s_mov_b32 s29, 3904
  buffer_load_ushort v35, v10, s[8:11], s29 offen
  s_mov_b32 s29, 10304
  buffer_load_ushort v36, v11, s[8:11], s29 offen
  s_mov_b32 s29, 11584
  buffer_load_ushort v37, v11, s[8:11], s29 offen
  s_mov_b32 s29, 12864
  buffer_load_ushort v38, v11, s[8:11], s29 offen
  s_mov_b32 s29, 14144
  buffer_load_ushort v39, v11, s[8:11], s29 offen
  s_mov_b32 s29, 72
  buffer_load_ushort v40, v10, s[8:11], s29 offen
  s_mov_b32 s29, 1352
  buffer_load_ushort v41, v10, s[8:11], s29 offen
  s_mov_b32 s29, 2632
  buffer_load_ushort v42, v10, s[8:11], s29 offen
  s_mov_b32 s29, 3912
  buffer_load_ushort v43, v10, s[8:11], s29 offen
  s_mov_b32 s29, 10312
  buffer_load_ushort v44, v11, s[8:11], s29 offen
  s_mov_b32 s29, 11592
  buffer_load_ushort v45, v11, s[8:11], s29 offen
  s_mov_b32 s29, 12872
  buffer_load_ushort v46, v11, s[8:11], s29 offen
  s_mov_b32 s29, 14152
  buffer_load_ushort v47, v11, s[8:11], s29 offen
  s_waitcnt vmcnt(24)
  v_lshl_or_b32 v48, v17, 16, v16
  v_lshl_or_b32 v49, v19, 16, v18
  v_lshl_or_b32 v50, v21, 16, v20
  v_lshl_or_b32 v51, v23, 16, v22
  s_lshl_b32 s30, s33, 2
  s_add_u32 s30, s30, 0
  s_lshl_b32 s30, s30, 5
  s_add_u32 s30, s30, s34
  s_lshl_b32 s30, s30, 10
  s_add_u32 s30, s30, 160169984
  buffer_store_dwordx4 v[48:51], v5, s[4:7], s30 offen
  s_waitcnt vmcnt(17)
  v_lshl_or_b32 v52, v25, 16, v24
  v_lshl_or_b32 v53, v27, 16, v26
  v_lshl_or_b32 v54, v29, 16, v28
  v_lshl_or_b32 v55, v31, 16, v30
  s_lshl_b32 s30, s33, 2
  s_add_u32 s30, s30, 1
  s_lshl_b32 s30, s30, 5
  s_add_u32 s30, s30, s34
  s_lshl_b32 s30, s30, 10
  s_add_u32 s30, s30, 160169984
  buffer_store_dwordx4 v[52:55], v5, s[4:7], s30 offen
  s_waitcnt vmcnt(10)
  v_lshl_or_b32 v56, v33, 16, v32
  v_lshl_or_b32 v57, v35, 16, v34
  v_lshl_or_b32 v58, v37, 16, v36
  v_lshl_or_b32 v59, v39, 16, v38
  s_lshl_b32 s30, s33, 2
  s_add_u32 s30, s30, 2
  s_lshl_b32 s30, s30, 5
  s_add_u32 s30, s30, s34
  s_lshl_b32 s30, s30, 10
  s_add_u32 s30, s30, 160169984
  buffer_store_dwordx4 v[56:59], v5, s[4:7], s30 offen
  s_waitcnt vmcnt(3)
  v_lshl_or_b32 v60, v41, 16, v40
  v_lshl_or_b32 v61, v43, 16, v42
  v_lshl_or_b32 v62, v45, 16, v44
  v_lshl_or_b32 v63, v47, 16, v46
  s_lshl_b32 s30, s33, 2
  s_add_u32 s30, s30, 3
  s_lshl_b32 s30, s30, 5
  s_add_u32 s30, s30, s34
  s_lshl_b32 s30, s30, 10
  s_add_u32 s30, s30, 160169984
  buffer_store_dwordx4 v[60:63], v5, s[4:7], s30 offen
prep_exit1:
  s_endpgm
.globl ln2_kernel
.p2align 8
.type ln2_kernel,@function
ln2_kernel:
  s_cmp_ge_u32 s2, 128
  s_cbranch_scc1 ln2_exit1
  s_load_dwordx2 s[12:13], s[0:1], 96
  s_load_dwordx2 s[14:15], s[0:1], 0
  v_lshrrev_b32 v2, 6, v0
  v_and_b32 v3, 63, v0
  s_nop 0
  v_readfirstlane_b32 s16, v2
  s_waitcnt lgkmcnt(0)
  s_mov_b32 s4, s12
  s_mov_b32 s5, s13
  s_mov_b32 s6, 0x10000000
  s_mov_b32 s7, 0x20000
  s_mov_b32 s8, s12
  s_mov_b32 s9, s13
  s_mov_b32 s10, 0x10000000
  s_mov_b32 s11, 0x20000
  s_mov_b32 s20, 150994944
  v_and_b32 v2, 15, v3
  v_lshrrev_b32 v4, 4, v3
  s_lshl_b32 s17, s2, 4
  v_add_u32 v1, s17, v2
  v_mul_u32_u24 v1, 1280, v1
  v_lshl_add_u32 v1, v4, 4, v1
  s_mul_i32 s17, s16, 320
  s_add_u32 s20, s20, s17
  buffer_load_dwordx4 v[8:11], v1, s[8:11], s20 offen offset:0
  buffer_load_dwordx4 v[12:15], v1, s[8:11], s20 offen offset:64
  buffer_load_dwordx4 v[16:19], v1, s[8:11], s20 offen offset:128
  buffer_load_dwordx4 v[20:23], v1, s[8:11], s20 offen offset:192
  buffer_load_dwordx4 v[24:27], v1, s[8:11], s20 offen offset:256
  s_sub_u32 s21, 0, s12
  s_and_b32 s21, s21, 0x1fffff
  s_add_u32 s21, s21, 2097152
  v_mov_b32 v68, -1
  v_mov_b32 v69, -1
  v_mov_b32 v70, -1
  v_mov_b32 v71, -1
  v_lshlrev_b32 v72, 4, v0
  s_mul_i32 s22, s2, 12096
  s_add_u32 s22, s22, 0
  s_mul_i32 s23, s2, 12288
  s_add_u32 s23, s23, s21
  buffer_store_dwordx4 v[68:71], v72, s[4:7], s22 offen
  s_add_u32 s22, s22, 4096
  buffer_store_dwordx4 v[68:71], v72, s[4:7], s22 offen
  s_add_u32 s22, s22, 4096
  v_mov_b32 v73, 0x80000000
  v_cmp_gt_u32 vcc, 244, v0
  s_nop 1
  v_cndmask_b32 v73, v73, v72, vcc
  buffer_store_dwordx4 v[68:71], v73, s[4:7], s22 offen
  buffer_store_dwordx4 v[68:71], v72, s[4:7], s23 offen
  s_add_u32 s23, s23, 4096
  buffer_store_dwordx4 v[68:71], v72, s[4:7], s23 offen
  s_add_u32 s23, s23, 4096
  buffer_store_dwordx4 v[68:71], v72, s[4:7], s23 offen
  s_add_u32 s23, s23, 4096
  s_mul_i32 s23, s2, 2048
  s_add_u32 s23, s23, s21
  s_add_u32 s23, s23, 1572864
  v_mov_b32 v73, 0x80000000
  v_cmp_gt_u32 vcc, 128, v0
  s_nop 1
  v_cndmask_b32 v73, v73, v72, vcc
  buffer_store_dwordx4 v[68:71], v73, s[4:7], s23 offen sc1
  v_lshlrev_b32 v5, 2, v2
  s_lshl_b32 s17, s16, 6
  v_add_u32 v1, s17, v5
  s_waitcnt vmcnt(7)
  v_lshlrev_b32 v28, 16, v8
  v_and_b32 v29, 0xffff0000, v8
  v_lshlrev_b32 v30, 16, v9
  v_and_b32 v31, 0xffff0000, v9
  v_lshlrev_b32 v32, 16, v10
  v_and_b32 v33, 0xffff0000, v10
  v_lshlrev_b32 v34, 16, v11
  v_and_b32 v35, 0xffff0000, v11
  v_lshlrev_b32 v36, 16, v12
  v_and_b32 v37, 0xffff0000, v12
  v_lshlrev_b32 v38, 16, v13
  v_and_b32 v39, 0xffff0000, v13
  v_lshlrev_b32 v40, 16, v14
  v_and_b32 v41, 0xffff0000, v14
  v_lshlrev_b32 v42, 16, v15
  v_and_b32 v43, 0xffff0000, v15
  v_lshlrev_b32 v44, 16, v16
  v_and_b32 v45, 0xffff0000, v16
  v_lshlrev_b32 v46, 16, v17
  v_and_b32 v47, 0xffff0000, v17
  v_lshlrev_b32 v48, 16, v18
  v_and_b32 v49, 0xffff0000, v18
  v_lshlrev_b32 v50, 16, v19
  v_and_b32 v51, 0xffff0000, v19
  v_lshlrev_b32 v52, 16, v20
  v_and_b32 v53, 0xffff0000, v20
  v_lshlrev_b32 v54, 16, v21
  v_and_b32 v55, 0xffff0000, v21
  v_lshlrev_b32 v56, 16, v22
  v_and_b32 v57, 0xffff0000, v22
  v_lshlrev_b32 v58, 16, v23
  v_and_b32 v59, 0xffff0000, v23
  v_lshlrev_b32 v60, 16, v24
  v_and_b32 v61, 0xffff0000, v24
  v_lshlrev_b32 v62, 16, v25
  v_and_b32 v63, 0xffff0000, v25
  v_lshlrev_b32 v64, 16, v26
  v_and_b32 v65, 0xffff0000, v26
  v_lshlrev_b32 v66, 16, v27
  v_and_b32 v67, 0xffff0000, v27
  v_pk_add_f32 v[6:7], v[28:29], v[30:31]
  v_pk_add_f32 v[6:7], v[6:7], v[32:33]
  v_pk_add_f32 v[6:7], v[6:7], v[34:35]
  v_pk_add_f32 v[6:7], v[6:7], v[36:37]
  v_pk_add_f32 v[6:7], v[6:7], v[38:39]
  v_pk_add_f32 v[6:7], v[6:7], v[40:41]
  v_pk_add_f32 v[6:7], v[6:7], v[42:43]
  v_pk_add_f32 v[6:7], v[6:7], v[44:45]
  v_pk_add_f32 v[6:7], v[6:7], v[46:47]
  v_pk_add_f32 v[6:7], v[6:7], v[48:49]
  v_pk_add_f32 v[6:7], v[6:7], v[50:51]
  v_pk_add_f32 v[6:7], v[6:7], v[52:53]
  v_pk_add_f32 v[6:7], v[6:7], v[54:55]
  v_pk_add_f32 v[6:7], v[6:7], v[56:57]
  v_pk_add_f32 v[6:7], v[6:7], v[58:59]
  v_pk_add_f32 v[6:7], v[6:7], v[60:61]
  v_pk_add_f32 v[6:7], v[6:7], v[62:63]
  v_pk_add_f32 v[6:7], v[6:7], v[64:65]
  v_pk_add_f32 v[6:7], v[6:7], v[66:67]
  v_add_f32 v4, v6, v7
  v_mov_b32 v2, v4
  s_nop 1
  v_permlane32_swap_b32 v4, v2
  v_add_f32 v4, v4, v2
  v_mov_b32 v2, v4
  s_nop 1
  v_permlane16_swap_b32 v4, v2
  v_add_f32 v4, v4, v2
  ds_write_b32 v1, v4 offset:0
  s_waitcnt lgkmcnt(0)
  s_barrier
  ds_read_b32 v4, v5 offset:0
  ds_read_b32 v2, v5 offset:64
  ds_read_b32 v3, v5 offset:128
  ds_read_b32 v6, v5 offset:192
  s_waitcnt lgkmcnt(0)
  v_add_f32 v4, v4, v2
  v_add_f32 v3, v3, v6
  v_add_f32 v4, v4, v3
  v_mul_f32 v4, 0x3acccccd, v4
  v_sub_f32 v28, v28, v4
  v_sub_f32 v29, v29, v4
  v_sub_f32 v30, v30, v4
  v_sub_f32 v31, v31, v4
  v_sub_f32 v32, v32, v4
  v_sub_f32 v33, v33, v4
  v_sub_f32 v34, v34, v4
  v_sub_f32 v35, v35, v4
  v_sub_f32 v36, v36, v4
  v_sub_f32 v37, v37, v4
  v_sub_f32 v38, v38, v4
  v_sub_f32 v39, v39, v4
  v_sub_f32 v40, v40, v4
  v_sub_f32 v41, v41, v4
  v_sub_f32 v42, v42, v4
  v_sub_f32 v43, v43, v4
  v_sub_f32 v44, v44, v4
  v_sub_f32 v45, v45, v4
  v_sub_f32 v46, v46, v4
  v_sub_f32 v47, v47, v4
  v_sub_f32 v48, v48, v4
  v_sub_f32 v49, v49, v4
  v_sub_f32 v50, v50, v4
  v_sub_f32 v51, v51, v4
  v_sub_f32 v52, v52, v4
  v_sub_f32 v53, v53, v4
  v_sub_f32 v54, v54, v4
  v_sub_f32 v55, v55, v4
  v_sub_f32 v56, v56, v4
  v_sub_f32 v57, v57, v4
  v_sub_f32 v58, v58, v4
  v_sub_f32 v59, v59, v4
  v_sub_f32 v60, v60, v4
  v_sub_f32 v61, v61, v4
  v_sub_f32 v62, v62, v4
  v_sub_f32 v63, v63, v4
  v_sub_f32 v64, v64, v4
  v_sub_f32 v65, v65, v4
  v_sub_f32 v66, v66, v4
  v_sub_f32 v67, v67, v4
  v_mul_f32 v6, v28, v28
  v_mul_f32 v7, v29, v29
  v_fmac_f32 v6, v30, v30
  v_fmac_f32 v7, v31, v31
  v_fmac_f32 v6, v32, v32
  v_fmac_f32 v7, v33, v33
  v_fmac_f32 v6, v34, v34
  v_fmac_f32 v7, v35, v35
  v_fmac_f32 v6, v36, v36
  v_fmac_f32 v7, v37, v37
  v_fmac_f32 v6, v38, v38
  v_fmac_f32 v7, v39, v39
  v_fmac_f32 v6, v40, v40
  v_fmac_f32 v7, v41, v41
  v_fmac_f32 v6, v42, v42
  v_fmac_f32 v7, v43, v43
  v_fmac_f32 v6, v44, v44
  v_fmac_f32 v7, v45, v45
  v_fmac_f32 v6, v46, v46
  v_fmac_f32 v7, v47, v47
  v_fmac_f32 v6, v48, v48
  v_fmac_f32 v7, v49, v49
  v_fmac_f32 v6, v50, v50
  v_fmac_f32 v7, v51, v51
  v_fmac_f32 v6, v52, v52
  v_fmac_f32 v7, v53, v53
  v_fmac_f32 v6, v54, v54
  v_fmac_f32 v7, v55, v55
  v_fmac_f32 v6, v56, v56
  v_fmac_f32 v7, v57, v57
  v_fmac_f32 v6, v58, v58
  v_fmac_f32 v7, v59, v59
  v_fmac_f32 v6, v60, v60
  v_fmac_f32 v7, v61, v61
  v_fmac_f32 v6, v62, v62
  v_fmac_f32 v7, v63, v63
  v_fmac_f32 v6, v64, v64
  v_fmac_f32 v7, v65, v65
  v_fmac_f32 v6, v66, v66
  v_fmac_f32 v7, v67, v67
  v_add_f32 v4, v6, v7
  v_mov_b32 v2, v4
  s_nop 1
  v_permlane32_swap_b32 v4, v2
  v_add_f32 v4, v4, v2
  v_mov_b32 v2, v4
  s_nop 1
  v_permlane16_swap_b32 v4, v2
  v_add_f32 v4, v4, v2
  ds_write_b32 v1, v4 offset:256
  s_waitcnt lgkmcnt(0)
  s_barrier
  ds_read_b32 v4, v5 offset:256
  ds_read_b32 v2, v5 offset:320
  ds_read_b32 v3, v5 offset:384
  ds_read_b32 v6, v5 offset:448
  s_waitcnt lgkmcnt(0)
  v_add_f32 v4, v4, v2
  v_add_f32 v3, v3, v6
  v_add_f32 v4, v4, v3
  v_mov_b32 v2, 0x3727c5ac
  v_fmac_f32 v2, 0x3acccccd, v4
  v_rsq_f32 v4, v2
  s_nop 0
  v_mul_f32 v28, v28, v4
  v_mul_f32 v29, v29, v4
  v_mul_f32 v30, v30, v4
  v_mul_f32 v31, v31, v4
  v_mul_f32 v32, v32, v4
  v_mul_f32 v33, v33, v4
  v_mul_f32 v34, v34, v4
  v_mul_f32 v35, v35, v4
  v_mul_f32 v36, v36, v4
  v_mul_f32 v37, v37, v4
  v_mul_f32 v38, v38, v4
  v_mul_f32 v39, v39, v4
  v_mul_f32 v40, v40, v4
  v_mul_f32 v41, v41, v4
  v_mul_f32 v42, v42, v4
  v_mul_f32 v43, v43, v4
  v_mul_f32 v44, v44, v4
  v_mul_f32 v45, v45, v4
  v_mul_f32 v46, v46, v4
  v_mul_f32 v47, v47, v4
  v_mul_f32 v48, v48, v4
  v_mul_f32 v49, v49, v4
  v_mul_f32 v50, v50, v4
  v_mul_f32 v51, v51, v4
  v_mul_f32 v52, v52, v4
  v_mul_f32 v53, v53, v4
  v_mul_f32 v54, v54, v4
  v_mul_f32 v55, v55, v4
  v_mul_f32 v56, v56, v4
  v_mul_f32 v57, v57, v4
  v_mul_f32 v58, v58, v4
  v_mul_f32 v59, v59, v4
  v_mul_f32 v60, v60, v4
  v_mul_f32 v61, v61, v4
  v_mul_f32 v62, v62, v4
  v_mul_f32 v63, v63, v4
  v_mul_f32 v64, v64, v4
  v_mul_f32 v65, v65, v4
  v_mul_f32 v66, v66, v4
  v_mul_f32 v67, v67, v4
  v_cvt_pk_bf16_f32 v8, v28, v29
  v_cvt_pk_bf16_f32 v9, v30, v31
  v_cvt_pk_bf16_f32 v10, v32, v33
  v_cvt_pk_bf16_f32 v11, v34, v35
  v_cvt_pk_bf16_f32 v12, v36, v37
  v_cvt_pk_bf16_f32 v13, v38, v39
  v_cvt_pk_bf16_f32 v14, v40, v41
  v_cvt_pk_bf16_f32 v15, v42, v43
  v_cvt_pk_bf16_f32 v16, v44, v45
  v_cvt_pk_bf16_f32 v17, v46, v47
  v_cvt_pk_bf16_f32 v18, v48, v49
  v_cvt_pk_bf16_f32 v19, v50, v51
  v_cvt_pk_bf16_f32 v20, v52, v53
  v_cvt_pk_bf16_f32 v21, v54, v55
  v_cvt_pk_bf16_f32 v22, v56, v57
  v_cvt_pk_bf16_f32 v23, v58, v59
  v_cvt_pk_bf16_f32 v24, v60, v61
  v_cvt_pk_bf16_f32 v25, v62, v63
  v_cvt_pk_bf16_f32 v26, v64, v65
  v_cvt_pk_bf16_f32 v27, v66, v67
  v_and_b32 v3, 63, v0
  v_lshlrev_b32 v1, 4, v3
  s_mul_i32 s17, s2, 20480
  s_mul_i32 s18, s16, 5120
  s_add_u32 s17, s17, s18
  s_add_u32 s17, s17, 153616384
  buffer_store_dwordx4 v[8:11], v1, s[4:7], s17 offen offset:0
  buffer_store_dwordx4 v[12:15], v1, s[4:7], s17 offen offset:1024
  buffer_store_dwordx4 v[16:19], v1, s[4:7], s17 offen offset:2048
  buffer_store_dwordx4 v[20:23], v1, s[4:7], s17 offen offset:3072
  s_add_u32 s17, s17, 4096
  buffer_store_dwordx4 v[24:27], v1, s[4:7], s17 offen offset:0
ln2_exit1:
  s_endpgm
.globl reca_kernel
.p2align 8
.type reca_kernel,@function
reca_kernel:
  s_cmp_ge_u32 s2, 256
  s_cbranch_scc1 reca_exitb3
  s_load_dwordx2 s[48:49], s[0:1], 96
  s_load_dwordx2 s[50:51], s[0:1], 88
  s_load_dwordx2 s[52:53], s[0:1], 8
  s_getreg_b32 s42, hwreg(HW_REG_XCC_ID, 0, 3)
  v_lshrrev_b32 v28, 6, v0
  v_and_b32 v29, 63, v0
  s_and_b32 s13, s2, 7
  v_readfirstlane_b32 s12, v28
  v_lshlrev_b32 v1, 4, v29
  s_lshr_b32 s14, s2, 3
  s_mov_b32 s18, 0x100000
  s_waitcnt lgkmcnt(0)
  s_mov_b32 s57, 0
  s_mov_b32 s4, s48
  s_mov_b32 s5, s49
  s_mov_b32 s6, 0x10000000
  s_mov_b32 s7, 0x20000
  s_mov_b32 s8, s50
  s_mov_b32 s9, s51
  s_mov_b32 s10, 256
  s_mov_b32 s11, 0x20000
  v_add_u32 v2, 0x1000, v1
  v_add_u32 v3, 0x2000, v1
  v_mov_b32 v31, 0x80000000
  s_lshl_b32 s34, s42, 3
  s_lshl_b64 s[36:37], 1, s34
  s_lshl_b32 s34, s13, 3
  v_cmp_eq_u32 vcc, 0, v0
  v_mov_b32 v30, s34
  s_nop 0
  v_cndmask_b32 v30, v31, v30, vcc
  v_mov_b32 v44, s36
  v_mov_b32 v45, s37
  buffer_atomic_add_x2 v[44:45], v30, s[8:11], 0 offen
  s_sub_u32 s56, 0, s48
  s_and_b32 s56, s56, 0x1fffff
  s_add_u32 s56, s56, 2097152
  s_nop 0
  s_cmp_ge_u32 s14, 24
  s_cbranch_scc1 reca_proj2
  s_mul_i32 s34, s14, 43
  s_lshr_b32 s34, s34, 8
  s_mul_i32 s35, s34, 6
  s_sub_u32 s16, s14, s35
  s_lshl_b32 s15, s13, 2
  s_add_u32 s15, s15, s34
  s_lshr_b32 s19, s12, 1
  s_and_b32 s37, s12, 1
  s_mul_i32 s34, s15, 12
  s_lshl_b32 s35, s16, 1
  s_add_u32 s34, s34, s35
  s_add_u32 s34, s34, s37
  s_mul_i32 s34, s34, 20480
  s_mov_b32 s35, 14155776
  s_cmp_eq_u32 s19, 0
  s_cselect_b32 s35, 6291456, s35
  s_add_u32 s35, s35, s34
  s_mul_i32 s36, s19, 10240
  s_add_u32 s20, s35, s36
  s_sub_u32 s36, 10240, s36
  s_add_u32 s21, s35, s36
  s_add_u32 s22, s34, 22020096
  s_mul_i32 s36, s19, 10240
  s_add_u32 s22, s22, s36
  buffer_load_dwordx4 a[0:3], v1, s[4:7], s20 offen offset:0
  buffer_load_dwordx4 a[4:7], v1, s[4:7], s20 offen offset:1024
  buffer_load_dwordx4 a[8:11], v1, s[4:7], s20 offen offset:2048
  buffer_load_dwordx4 a[12:15], v1, s[4:7], s20 offen offset:3072
  buffer_load_dwordx4 a[16:19], v2, s[4:7], s20 offen offset:0
  buffer_load_dwordx4 a[20:23], v2, s[4:7], s20 offen offset:1024
  buffer_load_dwordx4 a[24:27], v2, s[4:7], s20 offen offset:2048
  buffer_load_dwordx4 a[28:31], v2, s[4:7], s20 offen offset:3072
  buffer_load_dwordx4 a[32:35], v3, s[4:7], s20 offen offset:0
  buffer_load_dwordx4 a[36:39], v3, s[4:7], s20 offen offset:1024
  buffer_load_dwordx4 a[40:43], v1, s[4:7], s21 offen offset:0
  buffer_load_dwordx4 a[44:47], v1, s[4:7], s21 offen offset:1024
  buffer_load_dwordx4 a[48:51], v1, s[4:7], s21 offen offset:2048
  buffer_load_dwordx4 a[52:55], v1, s[4:7], s21 offen offset:3072
  buffer_load_dwordx4 a[56:59], v2, s[4:7], s21 offen offset:0
  buffer_load_dwordx4 a[60:63], v2, s[4:7], s21 offen offset:1024
  buffer_load_dwordx4 a[64:67], v2, s[4:7], s21 offen offset:2048
  buffer_load_dwordx4 a[68:71], v2, s[4:7], s21 offen offset:3072
  buffer_load_dwordx4 a[72:75], v3, s[4:7], s21 offen offset:0
  buffer_load_dwordx4 a[76:79], v3, s[4:7], s21 offen offset:1024
  buffer_load_dwordx4 a[80:83], v1, s[4:7], s22 offen offset:0
  buffer_load_dwordx4 a[84:87], v1, s[4:7], s22 offen offset:1024
  buffer_load_dwordx4 a[88:91], v1, s[4:7], s22 offen offset:2048
  buffer_load_dwordx4 a[92:95], v1, s[4:7], s22 offen offset:3072
  buffer_load_dwordx4 a[96:99], v2, s[4:7], s22 offen offset:0
  buffer_load_dwordx4 a[100:103], v2, s[4:7], s22 offen offset:1024
  buffer_load_dwordx4 a[104:107], v2, s[4:7], s22 offen offset:2048
  buffer_load_dwordx4 a[108:111], v2, s[4:7], s22 offen offset:3072
  buffer_load_dwordx4 a[112:115], v3, s[4:7], s22 offen offset:0
  buffer_load_dwordx4 a[116:119], v3, s[4:7], s22 offen offset:1024
  s_cmp_ge_u32 s14, 20
  s_cbranch_scc1 reca_now24
  s_cmp_ge_u32 s12, 2
  s_cbranch_scc1 reca_now24
  s_lshl_b32 s34, s14, 1
  s_add_u32 s34, s34, s12
  s_mul_i32 s34, s34, 192
  s_mul_i32 s35, s13, 24
  s_add_u32 s34, s34, s35
  s_lshl_b32 s34, s34, 10
  s_add_u32 s34, s34, 29884416
  buffer_load_dwordx4 a[120:123], v1, s[4:7], s34 offen offset:0
  buffer_load_dwordx4 a[124:127], v1, s[4:7], s34 offen offset:1024
  buffer_load_dwordx4 a[128:131], v1, s[4:7], s34 offen offset:2048
  buffer_load_dwordx4 a[132:135], v1, s[4:7], s34 offen offset:3072
  buffer_load_dwordx4 a[136:139], v2, s[4:7], s34 offen offset:0
  buffer_load_dwordx4 a[140:143], v2, s[4:7], s34 offen offset:1024
  buffer_load_dwordx4 a[144:147], v2, s[4:7], s34 offen offset:2048
  buffer_load_dwordx4 a[148:151], v2, s[4:7], s34 offen offset:3072
  buffer_load_dwordx4 a[152:155], v3, s[4:7], s34 offen offset:0
  buffer_load_dwordx4 a[156:159], v3, s[4:7], s34 offen offset:1024
  buffer_load_dwordx4 a[160:163], v3, s[4:7], s34 offen offset:2048
  buffer_load_dwordx4 a[164:167], v3, s[4:7], s34 offen offset:3072
  s_add_u32 s34, s34, 12288
  buffer_load_dwordx4 a[168:171], v1, s[4:7], s34 offen offset:0
  buffer_load_dwordx4 a[172:175], v1, s[4:7], s34 offen offset:1024
  buffer_load_dwordx4 a[176:179], v1, s[4:7], s34 offen offset:2048
  buffer_load_dwordx4 a[180:183], v1, s[4:7], s34 offen offset:3072
  buffer_load_dwordx4 a[184:187], v2, s[4:7], s34 offen offset:0
  buffer_load_dwordx4 a[188:191], v2, s[4:7], s34 offen offset:1024
  buffer_load_dwordx4 a[192:195], v2, s[4:7], s34 offen offset:2048
  buffer_load_dwordx4 a[196:199], v2, s[4:7], s34 offen offset:3072
  buffer_load_dwordx4 a[200:203], v3, s[4:7], s34 offen offset:0
  buffer_load_dwordx4 a[204:207], v3, s[4:7], s34 offen offset:1024
  buffer_load_dwordx4 a[208:211], v3, s[4:7], s34 offen offset:2048
  buffer_load_dwordx4 a[212:215], v3, s[4:7], s34 offen offset:3072
reca_now24:
  v_and_b32 v29, 63, v0
  v_and_b32 v28, 15, v29
  v_lshrrev_b32 v30, 4, v29
  v_mov_b32 v32, -1
  v_mov_b32 v33, -1
  v_mov_b32 v34, -1
  v_mov_b32 v35, -1
  s_mul_i32 s34, s12, 2560
  v_add_u32 v4, s34, v1
  v_and_b32 v44, 31, v29
  v_lshlrev_b32 v44, 4, v44
  s_add_u32 s34, s34, 2048
  v_add_u32 v5, s34, v44
  v_and_b32 v44, 7, v29
  v_lshlrev_b32 v44, 4, v44
  v_lshl_add_u32 v44, v30, 7, v44
  s_mul_i32 s34, s19, 5120
  v_add_u32 v6, s34, v44
  s_sub_u32 s34, 5120, s34
  v_add_u32 v7, s34, v44
  v_lshrrev_b32 v45, 3, v28
  v_lshl_add_u32 v12, v45, 9, v44
  v_add_u32 v13, 0x1000, v12
  v_add_u32 v14, 0x2000, v12
  v_cmp_gt_u32 s[54:55], 8, v28
  s_lshl_b32 s34, s16, 10
  s_lshl_b32 s35, s19, 7
  s_add_u32 s34, s34, s35
  s_and_b32 s35, s12, 1
  s_lshl_b32 s36, s35, 3
  s_add_u32 s34, s34, s36
  v_lshlrev_b32 v44, 4, v28
  v_lshl_add_u32 v45, v30, 8, v44
  v_add_u32 v45, s34, v45
  v_cndmask_b32 v8, v31, v45, s[54:55]
  v_lshl_add_u32 v44, v30, 7, v44
  v_add_u32 v45, s36, v44
  v_cndmask_b32 v9, v31, v45, s[54:55]
  s_lshl_b32 s34, s14, 9
  v_add_u32 v45, s34, v44
  v_cndmask_b32 v11, v31, v45, s[54:55]
  s_mul_i32 s34, s13, 49152
  s_lshr_b32 s35, s14, 3
  s_lshl_b32 s35, s35, 14
  s_add_u32 s34, s34, s35
  s_and_b32 s35, s14, 7
  s_lshl_b32 s35, s35, 10
  s_add_u32 s34, s34, s35
  s_lshl_b32 s35, s12, 9
  s_add_u32 s34, s34, s35
  v_add_u32 v45, s34, v44
  v_cndmask_b32 v15, v31, v45, s[54:55]
  s_cmp_lt_u32 s14, 20
  s_cselect_b32 s34, 0, 0x80000000
  v_or_b32 v15, s34, v15
  v_lshlrev_b32 v45, 3, v29
  v_cmp_gt_u32 vcc, 32, v29
  s_nop 1
  v_cndmask_b32 v10, v31, v45, vcc
  s_sub_u32 s35, s14, 4
  s_cmp_lt_u32 s14, 20
  s_cselect_b32 s34, s14, s35
  s_lshr_b32 s35, s34, 3
  s_lshl_b32 s35, s35, 14
  s_and_b32 s34, s34, 7
  s_lshl_b32 s34, s34, 10
  s_add_u32 s34, s34, s35
  v_add_u32 v20, s34, v1
  v_add_u32 v21, 49152, v20
  v_add_u32 v22, 98304, v20
  v_add_u32 v23, 147456, v20
  v_add_u32 v24, 196608, v20
  v_add_u32 v25, 245760, v20
  v_add_u32 v26, 294912, v20
  v_add_u32 v27, 344064, v20
  v_lshrrev_b32 v44, 3, v29
  v_and_b32 v44, 3, v44
  v_lshlrev_b32 v44, 7, v44
  v_and_b32 v45, 7, v29
  v_lshl_add_u32 v44, v45, 4, v44
  v_lshrrev_b32 v45, 5, v29
  v_lshl_add_u32 v44, v45, 3, v44
  s_lshl_b32 s34, s14, 9
  s_cmp_lt_u32 s14, 20
  s_cselect_b32 s34, s34, 0x80000000
  v_add_u32 v16, s34, v44
  v_cmp_eq_u32 vcc, 0, v29
  v_mov_b32 v45, 0
  s_nop 0
  v_cndmask_b32 v19, v31, v45, vcc
  s_lshl_b32 s34, s15, 8
  s_add_u32 s34, s34, 1540096
  v_and_b32 v45, 1, v29
  v_lshlrev_b32 v45, 7, v45
  v_add_u32 v233, s34, v45
  s_lshl_b32 s34, s12, 10
  s_add_u32 s34, s34, 10240
  v_add_u32 v17, s34, v1
  v_mov_b32 v36, 0x3f803f80
  v_mov_b32 v37, 0x3f803f80
  v_mov_b32 v38, 0x3f803f80
  v_mov_b32 v39, 0x3f803f80
  v_mov_b32 v44, 0xf149f2ca
  v_cmp_gt_u32 vcc, 2, v30
  s_nop 1
  v_cndmask_b32 v40, 0, v44, vcc
  v_mov_b32 v41, v40
  v_mov_b32 v42, v40
  v_mov_b32 v43, v40
  s_mov_b32 s41, 0x3dd53b95
  s_mul_i32 s38, s13, 40960
  s_add_u32 s38, s38, 0
  s_mul_i32 s39, s15, 24576
  s_add_u32 s39, s39, 327680
  s_mul_i32 s40, s13, 49152
  s_add_u32 s40, s40, 1114112
  s_mov_b32 s60, s52
  s_mov_b32 s61, s53
  s_mov_b32 s62, 10240
  s_mov_b32 s63, 0x20000
  v_and_b32 v29, 63, v0
  v_and_b32 v44, 7, v29
  v_mul_u32_u24 v44, 1280, v44
  v_lshrrev_b32 v45, 3, v29
  v_and_b32 v45, 3, v45
  v_lshl_add_u32 v44, v45, 4, v44
  s_mul_i32 s34, s12, 320
  v_add_u32 v44, s34, v44
  v_add_u32 v46, 256, v44
  v_lshrrev_b32 v45, 5, v29
  v_lshl_add_u32 v44, v45, 6, v44
  buffer_load_dwordx4 v[128:131], v44, s[60:63], 0 offen
  buffer_load_dwordx4 v[132:135], v44, s[60:63], 0 offen offset:128
  buffer_load_dwordx4 v[136:139], v46, s[60:63], 0 offen
  v_and_b32 v44, 63, v0
  v_and_b32 v45, 3, v44
  v_lshlrev_b32 v45, 21, v45
  v_min_u32 v45, 6291392, v45
  v_add_u32 v46, 113246208, v45
  v_add_u32 v45, 119537664, v45
  v_cmp_gt_u32 vcc, 4, v44
  s_nop 1
  v_cndmask_b32 v46, v45, v46, vcc
  s_mul_i32 s34, s15, 786432
  v_and_b32 v45, 1, v44
  v_mul_u32_u24 v45, 786368, v45
  v_add_u32 v45, s34, v45
  v_add_u32 v28, 37748736, v45
  v_add_u32 v45, 62914560, v45
  v_cmp_gt_u32 vcc, 10, v44
  s_nop 1
  v_cndmask_b32 v45, v45, v28, vcc
  v_cmp_gt_u32 vcc, 8, v44
  s_nop 1
  v_cndmask_b32 v46, v45, v46, vcc
  v_cmp_gt_u32 vcc, 12, v44
  s_nop 1
  v_cndmask_b32 v46, v31, v46, vcc
  buffer_load_dword v234, v46, s[4:7], 0 offen
  v_and_b32 v30, 7, v0
  v_lshlrev_b32 v30, 3, v30
reca_cens5:
  buffer_load_dwordx2 v[28:29], v30, s[8:11], 0 offen sc1
  s_waitcnt vmcnt(0)
  v_sad_u8 v31, v28, 0, 0
  v_sad_u8 v31, v29, 0, v31
  v_cmp_gt_u32 vcc, 32, v31
  s_cbranch_vccz reca_censok6
  s_sleep 8
  s_sub_u32 s18, s18, 1
  s_cbranch_scc0 reca_cens5
  s_mov_b32 s18, 0
reca_censok6:
  v_and_b32 v28, 0x20202020, v28
  v_and_b32 v29, 0x20202020, v29
  v_cmp_ne_u32 s[34:35], 0, v28
  v_cmp_ne_u32 s[36:37], 0, v29
  s_nop 3
  s_and_b32 s34, s34, 0xff
  s_and_b32 s36, s36, 0xff
  s_or_b32 s35, s34, s36
  s_lshr_b32 s37, s35, s13
  s_and_b32 s37, s37, 1
  s_xor_b32 s43, s37, 1
  s_cmp_eq_u32 s57, 0
  s_cselect_b32 s58, s36, s34
  v_mov_b32 v31, 0x80000000
  v_add_u32 v232, 0x2000, v15
  s_lshr_b32 s44, s2, 4
  s_lshl_b32 s44, s44, 14
  s_and_b32 s34, s2, 15
  s_lshl_b32 s34, s34, 9
  s_add_u32 s44, s44, s34
  s_add_u32 s44, s44, 1572864
  s_add_u32 s44, s44, s56
  s_mov_b32 s45, -1
  s_mov_b32 s47, -1
  s_cmp_lg_u32 s12, 2
  s_cbranch_scc1 reca_noprobe7
  s_add_u32 s35, s44, 0
  s_memtime s[60:61]
  s_waitcnt lgkmcnt(0)
  buffer_load_dword v28, v19, s[4:7], s35 offen sc1
  s_waitcnt vmcnt(0)
  s_memtime s[62:63]
  s_waitcnt lgkmcnt(0)
  s_sub_u32 s36, s62, s60
  s_min_u32 s45, s45, s36
  s_add_u32 s35, s44, 8192
  s_memtime s[60:61]
  s_waitcnt lgkmcnt(0)
  buffer_load_dword v28, v19, s[4:7], s35 offen sc1
  s_waitcnt vmcnt(0)
  s_memtime s[62:63]
  s_waitcnt lgkmcnt(0)
  s_sub_u32 s36, s62, s60
  s_min_u32 s47, s47, s36
  s_add_u32 s35, s44, 128
  s_memtime s[60:61]
  s_waitcnt lgkmcnt(0)
  buffer_load_dword v28, v19, s[4:7], s35 offen sc1
  s_waitcnt vmcnt(0)
  s_memtime s[62:63]
  s_waitcnt lgkmcnt(0)
  s_sub_u32 s36, s62, s60
  s_min_u32 s45, s45, s36
  s_add_u32 s35, s44, 8320
  s_memtime s[60:61]
  s_waitcnt lgkmcnt(0)
  buffer_load_dword v28, v19, s[4:7], s35 offen sc1
  s_waitcnt vmcnt(0)
  s_memtime s[62:63]
  s_waitcnt lgkmcnt(0)
  s_sub_u32 s36, s62, s60
  s_min_u32 s47, s47, s36
  s_add_u32 s35, s44, 256
  s_memtime s[60:61]
  s_waitcnt lgkmcnt(0)
  buffer_load_dword v28, v19, s[4:7], s35 offen sc1
  s_waitcnt vmcnt(0)
  s_memtime s[62:63]
  s_waitcnt lgkmcnt(0)
  s_sub_u32 s36, s62, s60
  s_min_u32 s45, s45, s36
  s_add_u32 s35, s44, 8448
  s_memtime s[60:61]
  s_waitcnt lgkmcnt(0)
  buffer_load_dword v28, v19, s[4:7], s35 offen sc1
  s_waitcnt vmcnt(0)
  s_memtime s[62:63]
  s_waitcnt lgkmcnt(0)
  s_sub_u32 s36, s62, s60
  s_min_u32 s47, s47, s36
  s_cmp_lt_u32 s47, s45
  s_cbranch_scc0 reca_noprobe7
  v_add_u32 v20, 0x2000, v20
  v_add_u32 v21, 0x2000, v21
  v_add_u32 v22, 0x2000, v22
  v_add_u32 v23, 0x2000, v23
  v_add_u32 v24, 0x2000, v24
  v_add_u32 v25, 0x2000, v25
  v_add_u32 v26, 0x2000, v26
  v_add_u32 v27, 0x2000, v27
reca_noprobe7:
  s_mov_b32 s17, 0
  s_cmp_lg_u32 s12, 3
  s_cbranch_scc1 reca_nopf08
  s_add_u32 s37, s17, 1
reca_pf9:
  buffer_load_dword v28, v233, s[4:7], 0 offen sc1
  s_waitcnt vmcnt(0)
  v_cmp_gt_i32 vcc, s37, v28
  s_cbranch_vccz reca_pfok10
  s_sleep 1
  s_sub_u32 s18, s18, 1
  s_cbranch_scc0 reca_pf9
  s_mov_b32 s18, 0
reca_pfok10:
  s_lshl_b32 s34, s15, 6
  s_add_u32 s34, s34, s17
  s_mul_i32 s34, s34, 12288
  s_add_u32 s32, s34, 37748736
  s_lshl_b32 s35, s16, 11
  s_add_u32 s34, s34, s35
  s_add_u32 s33, s34, 62914560
  buffer_load_dwordx4 a[120:123], v1, s[4:7], s32 offen offset:0 sc1
  buffer_load_dwordx4 a[124:127], v1, s[4:7], s32 offen offset:1024 sc1
  buffer_load_dwordx4 a[128:131], v1, s[4:7], s32 offen offset:2048 sc1
  buffer_load_dwordx4 a[132:135], v1, s[4:7], s32 offen offset:3072 sc1
  buffer_load_dwordx4 a[136:139], v2, s[4:7], s32 offen offset:0 sc1
  buffer_load_dwordx4 a[140:143], v2, s[4:7], s32 offen offset:1024 sc1
  buffer_load_dwordx4 a[144:147], v2, s[4:7], s32 offen offset:2048 sc1
  buffer_load_dwordx4 a[148:151], v2, s[4:7], s32 offen offset:3072 sc1
  buffer_load_dwordx4 a[152:155], v3, s[4:7], s32 offen offset:0 sc1
  buffer_load_dwordx4 a[156:159], v3, s[4:7], s32 offen offset:1024 sc1
  buffer_load_dwordx4 a[160:163], v3, s[4:7], s32 offen offset:2048 sc1
  buffer_load_dwordx4 a[164:167], v3, s[4:7], s32 offen offset:3072 sc1
  buffer_load_dwordx4 a[168:171], v1, s[4:7], s33 offen offset:0 sc1
  buffer_load_dwordx4 a[172:175], v1, s[4:7], s33 offen offset:1024 sc1
  s_waitcnt vmcnt(0)
reca_nopf08:
  s_cmp_lg_u32 s43, 0
  s_cbranch_scc1 reca_slow11
  s_branch reca_gotmem13
reca_step12:
  s_and_b32 s34, s17, 3
  s_mul_i32 s20, s34, 10240
  s_add_u32 s20, s20, s38
  s_sleep 2
  buffer_load_dwordx4 v[128:131], v4, s[4:7], s20 offen sc1
  buffer_load_dwordx4 v[132:135], v4, s[4:7], s20 offen offset:1024 sc1
  buffer_load_dwordx4 v[136:139], v5, s[4:7], s20 offen sc1
  s_waitcnt vmcnt(2)
  v_max_u32 v29, v128, v130
  v_cmp_eq_u32 vcc, -1, v29
  s_cbranch_vccnz reca_retry15
reca_resume16:
  s_waitcnt vmcnt(1)
  v_max_u32 v29, v132, v134
  v_cmp_eq_u32 vcc, -1, v29
  ds_write_b128 v4, v[128:131]
  s_cbranch_vccnz reca_retry17
reca_resume18:
  s_waitcnt vmcnt(0)
  v_max_u32 v29, v136, v138
  v_cmp_eq_u32 vcc, -1, v29
  ds_write_b128 v4, v[132:135] offset:1024
  s_cbranch_vccnz reca_retry19
reca_resume20:
  ds_write_b128 v5, v[136:139]
  s_branch reca_gotmem214
reca_gotmem13:
  ds_write_b128 v4, v[128:131]
  ds_write_b128 v4, v[132:135] offset:1024
  ds_write_b128 v5, v[136:139]
reca_gotmem214:
  s_and_b32 s34, s17, 3
  s_mul_i32 s21, s34, 6144
  s_add_u32 s21, s21, s39
  s_mul_i32 s22, s34, 12288
  s_add_u32 s22, s22, s40
  s_mul_i32 s25, s34, 393216
  s_add_u32 s25, s25, s56
  s_add_u32 s35, s17, 1
  s_and_b32 s35, s35, 3
  s_mul_i32 s24, s35, 10240
  s_add_u32 s24, s24, s38
  s_waitcnt lgkmcnt(0)
  s_barrier
  ds_read_b128 v[128:131], v6 offset:0
  ds_read_b128 v[132:135], v6 offset:512
  ds_read_b128 v[136:139], v6 offset:1024
  ds_read_b128 v[140:143], v6 offset:1536
  ds_read_b128 v[144:147], v6 offset:2048
  ds_read_b128 v[148:151], v6 offset:2560
  ds_read_b128 v[152:155], v6 offset:3072
  ds_read_b128 v[156:159], v6 offset:3584
  ds_read_b128 v[160:163], v6 offset:4096
  ds_read_b128 v[164:167], v6 offset:4608
  ds_read_b128 v[168:171], v7 offset:0
  ds_read_b128 v[172:175], v7 offset:512
  ds_read_b128 v[176:179], v7 offset:1024
  s_waitcnt lgkmcnt(12)
  v_mfma_f32_16x16x32_bf16 v[44:47], a[0:3], v[128:131], 0
  ds_read_b128 v[180:183], v7 offset:1536
  s_waitcnt lgkmcnt(12)
  v_mfma_f32_16x16x32_bf16 v[44:47], a[4:7], v[132:135], v[44:47]
  ds_read_b128 v[184:187], v7 offset:2048
  s_waitcnt lgkmcnt(12)
  v_mfma_f32_16x16x32_bf16 v[44:47], a[8:11], v[136:139], v[44:47]
  ds_read_b128 v[188:191], v7 offset:2560
  s_waitcnt lgkmcnt(12)
  v_mfma_f32_16x16x32_bf16 v[44:47], a[12:15], v[140:143], v[44:47]
  ds_read_b128 v[192:195], v7 offset:3072
  s_waitcnt lgkmcnt(12)
  v_mfma_f32_16x16x32_bf16 v[44:47], a[16:19], v[144:147], v[44:47]
  ds_read_b128 v[196:199], v7 offset:3584
  s_waitcnt lgkmcnt(12)
  v_mfma_f32_16x16x32_bf16 v[44:47], a[20:23], v[148:151], v[44:47]
  ds_read_b128 v[200:203], v7 offset:4096
  s_waitcnt lgkmcnt(12)
  v_mfma_f32_16x16x32_bf16 v[44:47], a[24:27], v[152:155], v[44:47]
  ds_read_b128 v[204:207], v7 offset:4608
  s_waitcnt lgkmcnt(12)
  v_mfma_f32_16x16x32_bf16 v[44:47], a[28:31], v[156:159], v[44:47]
  s_waitcnt lgkmcnt(11)
  v_mfma_f32_16x16x32_bf16 v[44:47], a[32:35], v[160:163], v[44:47]
  s_waitcnt lgkmcnt(10)
  v_mfma_f32_16x16x32_bf16 v[44:47], a[36:39], v[164:167], v[44:47]
  s_waitcnt lgkmcnt(9)
  v_mfma_f32_16x16x32_bf16 v[44:47], a[40:43], v[168:171], v[44:47]
  s_waitcnt lgkmcnt(8)
  v_mfma_f32_16x16x32_bf16 v[44:47], a[44:47], v[172:175], v[44:47]
  s_waitcnt lgkmcnt(7)
  v_mfma_f32_16x16x32_bf16 v[44:47], a[48:51], v[176:179], v[44:47]
  s_waitcnt lgkmcnt(6)
  v_mfma_f32_16x16x32_bf16 v[44:47], a[52:55], v[180:183], v[44:47]
  s_waitcnt lgkmcnt(5)
  v_mfma_f32_16x16x32_bf16 v[44:47], a[56:59], v[184:187], v[44:47]
  s_waitcnt lgkmcnt(4)
  v_mfma_f32_16x16x32_bf16 v[44:47], a[60:63], v[188:191], v[44:47]
  s_waitcnt lgkmcnt(3)
  v_mfma_f32_16x16x32_bf16 v[44:47], a[64:67], v[192:195], v[44:47]
  s_waitcnt lgkmcnt(2)
  v_mfma_f32_16x16x32_bf16 v[44:47], a[68:71], v[196:199], v[44:47]
  s_waitcnt lgkmcnt(1)
  v_mfma_f32_16x16x32_bf16 v[44:47], a[72:75], v[200:203], v[44:47]
  s_waitcnt lgkmcnt(0)
  v_mfma_f32_16x16x32_bf16 v[44:47], a[76:79], v[204:207], v[44:47]
  v_mfma_f32_16x16x32_bf16 v[48:51], v[128:131], a[80:83], 0
  s_lshl_b32 s34, s17, 5
  s_add_u32 s34, s34, s15
  s_mul_i32 s34, s34, 3072
  s_lshl_b32 s35, s16, 9
  s_add_u32 s34, s34, s35
  s_add_u32 s30, s34, 113246208
  s_add_u32 s31, s34, 119537664
  v_cvt_pk_bf16_f32 v52, v44, v45
  v_cvt_pk_bf16_f32 v53, v46, v47
  buffer_store_dwordx2 v[52:53], v8, s[4:7], s21 offen
  v_mfma_f32_16x16x32_bf16 v[48:51], v[132:135], a[84:87], v[48:51]
  v_mfma_f32_16x16x32_bf16 v[48:51], v[136:139], a[88:91], v[48:51]
  v_mfma_f32_16x16x32_bf16 v[48:51], v[140:143], a[92:95], v[48:51]
  v_mfma_f32_16x16x32_bf16 v[48:51], v[144:147], a[96:99], v[48:51]
  v_mfma_f32_16x16x32_bf16 v[48:51], v[148:151], a[100:103], v[48:51]
  v_mfma_f32_16x16x32_bf16 v[48:51], v[152:155], a[104:107], v[48:51]
  v_mfma_f32_16x16x32_bf16 v[48:51], v[156:159], a[108:111], v[48:51]
  v_mfma_f32_16x16x32_bf16 v[48:51], v[160:163], a[112:115], v[48:51]
  v_mfma_f32_16x16x32_bf16 v[48:51], v[164:167], a[116:119], v[48:51]
  s_cmp_eq_u32 s12, 3
  s_cbranch_scc1 reca_swave21
  s_nop 5
  ds_write_b128 v17, v[48:51]
  s_add_u32 s34, s17, 2
  s_and_b32 s34, s34, 3
  s_mul_i32 s26, s34, 10240
  s_add_u32 s26, s26, s38
  s_mul_i32 s27, s34, 6144
  s_add_u32 s27, s27, s39
  s_mul_i32 s28, s34, 12288
  s_add_u32 s28, s28, s40
  s_mul_i32 s29, s34, 393216
  s_add_u32 s29, s29, s56
  s_waitcnt lgkmcnt(0)
  s_barrier
  s_cmp_eq_u32 s17, 63
  s_cbranch_scc1 reca_last23
  buffer_store_dwordx2 v[32:33], v8, s[4:7], s27 offen
  s_cmp_lg_u32 s12, 2
  s_cbranch_scc1 reca_b324
  buffer_store_dwordx2 v[52:53], v9, s[4:7], s30 offen
  buffer_store_dwordx2 v[32:33], v16, s[4:7], s26 offen
  s_cmp_lg_u32 s14, 0
  s_cbranch_scc1 reca_b324
  v_mov_b32 v28, s17
  s_lshl_b32 s34, s13, 7
  s_add_u32 s34, s34, 1507328
  buffer_store_dword v28, v19, s[4:7], s34 offen
  s_branch reca_b324
reca_last23:
  s_cmp_lg_u32 s12, 2
  s_cbranch_scc1 reca_exit1
  buffer_store_dwordx2 v[52:53], v9, s[4:7], s30 offen
  s_branch reca_exit1
reca_swave21:
  s_cmp_lg_u32 s17, 63
  s_cbranch_scc1 reca_vmst27
  s_barrier
  ds_read_b128 v[56:59], v1 offset:10240
  ds_read_b128 v[60:63], v1 offset:11264
  ds_read_b128 v[64:67], v1 offset:12288
  s_waitcnt lgkmcnt(0)
  v_add_f32 v56, v56, v64
  v_add_f32 v60, v60, v48
  v_add_f32 v57, v57, v65
  v_add_f32 v61, v61, v49
  v_add_f32 v58, v58, v66
  v_add_f32 v62, v62, v50
  v_add_f32 v59, v59, v67
  v_add_f32 v63, v63, v51
  v_cvt_pk_bf16_f32 v68, v56, v57
  v_cvt_pk_bf16_f32 v69, v58, v59
  v_cvt_pk_bf16_f32 v70, v60, v61
  v_cvt_pk_bf16_f32 v71, v62, v63
  buffer_store_dwordx2 v[52:53], v9, s[4:7], s30 offen
  buffer_store_dwordx2 v[68:69], v10, s[4:7], s31 offen
  buffer_store_dwordx2 v[70:71], v10, s[4:7], s31 offen offset:256
  s_branch reca_exit1
reca_vmst27:
  s_sleep 1
  buffer_load_dwordx4 v[208:211], v1, s[4:7], s21 offen offset:0 sc1
  buffer_load_dwordx4 v[212:215], v1, s[4:7], s21 offen offset:1024 sc1
  buffer_load_dwordx4 v[216:219], v1, s[4:7], s21 offen offset:2048 sc1
  buffer_load_dwordx4 v[220:223], v1, s[4:7], s21 offen offset:3072 sc1
  buffer_load_dwordx4 v[224:227], v2, s[4:7], s21 offen offset:0 sc1
  buffer_load_dwordx4 v[228:231], v2, s[4:7], s21 offen offset:1024 sc1
  s_waitcnt vmcnt(5)
  v_max_u32 v29, v208, v210
  v_cmp_eq_u32 vcc, -1, v29
  s_cbranch_vccnz reca_retry28
reca_resume29:
  s_waitcnt vmcnt(4)
  v_max_u32 v29, v212, v214
  v_cmp_eq_u32 vcc, -1, v29
  v_mfma_f32_16x16x32_bf16 v[76:79], a[120:123], v[208:211], 0
  v_mfma_f32_16x16x32_bf16 v[80:83], a[144:147], v[208:211], 0
  v_mfma_f32_16x16x32_bf16 v[72:75], v[208:211], v[208:211], v[40:43]
  s_cbranch_vccnz reca_retry30
reca_resume31:
  s_waitcnt vmcnt(3)
  v_max_u32 v29, v216, v218
  v_cmp_eq_u32 vcc, -1, v29
  v_mfma_f32_16x16x32_bf16 v[76:79], a[124:127], v[212:215], v[76:79]
  v_mfma_f32_16x16x32_bf16 v[80:83], a[148:151], v[212:215], v[80:83]
  v_mfma_f32_16x16x32_bf16 v[72:75], v[212:215], v[212:215], v[72:75]
  s_cbranch_vccnz reca_retry32
reca_resume33:
  s_waitcnt vmcnt(2)
  v_max_u32 v29, v220, v222
  v_cmp_eq_u32 vcc, -1, v29
  v_mfma_f32_16x16x32_bf16 v[76:79], a[128:131], v[216:219], v[76:79]
  v_mfma_f32_16x16x32_bf16 v[80:83], a[152:155], v[216:219], v[80:83]
  v_mfma_f32_16x16x32_bf16 v[72:75], v[216:219], v[216:219], v[72:75]
  s_cbranch_vccnz reca_retry34
reca_resume35:
  s_waitcnt vmcnt(1)
  v_max_u32 v29, v224, v226
  v_cmp_eq_u32 vcc, -1, v29
  v_mfma_f32_16x16x32_bf16 v[76:79], a[132:135], v[220:223], v[76:79]
  v_mfma_f32_16x16x32_bf16 v[80:83], a[156:159], v[220:223], v[80:83]
  v_mfma_f32_16x16x32_bf16 v[72:75], v[220:223], v[220:223], v[72:75]
  s_cbranch_vccnz reca_retry36
reca_resume37:
  s_waitcnt vmcnt(0)
  v_max_u32 v29, v228, v230
  v_cmp_eq_u32 vcc, -1, v29
  v_mfma_f32_16x16x32_bf16 v[76:79], a[136:139], v[224:227], v[76:79]
  v_mfma_f32_16x16x32_bf16 v[80:83], a[160:163], v[224:227], v[80:83]
  v_mfma_f32_16x16x32_bf16 v[72:75], v[224:227], v[224:227], v[72:75]
  s_cbranch_vccnz reca_retry38
reca_resume39:
  v_mfma_f32_16x16x32_bf16 v[76:79], a[140:143], v[228:231], v[76:79]
  v_mfma_f32_16x16x32_bf16 v[80:83], a[164:167], v[228:231], v[80:83]
  v_mfma_f32_16x16x32_bf16 v[72:75], v[228:231], v[228:231], v[72:75]
  s_barrier
  ds_read_b128 v[56:59], v1 offset:10240
  ds_read_b128 v[60:63], v1 offset:11264
  ds_read_b128 v[64:67], v1 offset:12288
  s_nop 1
  v_max3_f32 v28, v76, v77, v78
  v_max3_f32 v29, v80, v81, v82
  v_max3_f32 v28, v28, v79, v83
  v_max3_f32 v29, v29, v72, v73
  v_max3_f32 v28, v28, v74, v75
  v_max_f32 v28, v28, v29
  v_mov_b32 v29, v28
  s_nop 1
  v_permlane32_swap_b32 v28, v29
  v_max_f32 v28, v28, v29
  v_mov_b32 v29, v28
  s_nop 1
  v_permlane16_swap_b32 v28, v29
  v_max_f32 v28, v28, v29
  v_mul_f32 v28, s41, v28
  v_fma_f32 v76, v76, s41, -v28
  v_fma_f32 v77, v77, s41, -v28
  v_fma_f32 v78, v78, s41, -v28
  v_fma_f32 v79, v79, s41, -v28
  v_fma_f32 v80, v80, s41, -v28
  v_fma_f32 v81, v81, s41, -v28
  v_fma_f32 v82, v82, s41, -v28
  v_fma_f32 v83, v83, s41, -v28
  v_fma_f32 v72, v72, s41, -v28
  v_fma_f32 v73, v73, s41, -v28
  v_fma_f32 v74, v74, s41, -v28
  v_fma_f32 v75, v75, s41, -v28
  v_exp_f32 v76, v76
  v_exp_f32 v77, v77
  v_exp_f32 v78, v78
  v_exp_f32 v79, v79
  v_exp_f32 v80, v80
  v_exp_f32 v81, v81
  v_exp_f32 v82, v82
  v_exp_f32 v83, v83
  v_cvt_pk_bf16_f32 v84, v76, v77
  v_cvt_pk_bf16_f32 v85, v78, v79
  v_cvt_pk_bf16_f32 v86, v80, v81
  v_cvt_pk_bf16_f32 v87, v82, v83
  v_exp_f32 v72, v72
  v_exp_f32 v73, v73
  v_mfma_f32_16x16x32_bf16 v[100:103], v[36:39], v[84:87], 0
  v_exp_f32 v74, v74
  v_exp_f32 v75, v75
  v_mfma_f32_16x16x32_bf16 v[92:95], a[168:171], v[84:87], 0
  v_cvt_pk_bf16_f32 v88, v72, v73
  v_cvt_pk_bf16_f32 v89, v74, v75
  v_mfma_f32_16x16x32_bf16 v[96:99], a[172:175], v[84:87], 0
  s_waitcnt lgkmcnt(0)
  v_mfma_f32_16x16x16_bf16 v[100:103], v[36:37], v[88:89], v[100:103]
  v_add_f32 v56, v56, v64
  v_add_f32 v60, v60, v48
  v_add_f32 v57, v57, v65
  v_add_f32 v61, v61, v49
  v_add_f32 v58, v58, v66
  v_add_f32 v62, v62, v50
  v_add_f32 v59, v59, v67
  v_add_f32 v63, v63, v51
  v_cvt_pk_bf16_f32 v68, v56, v57
  v_cvt_pk_bf16_f32 v69, v58, v59
  v_cvt_pk_bf16_f32 v70, v60, v61
  v_cvt_pk_bf16_f32 v71, v62, v63
  v_mfma_f32_16x16x16_bf16 v[92:95], v[68:69], v[88:89], v[92:95]
  v_rcp_f32 v28, v100
  v_mfma_f32_16x16x16_bf16 v[96:99], v[70:71], v[88:89], v[96:99]
  v_mov_b32 v29, v28
  s_nop 4
  v_pk_mul_f32 v[92:93], v[92:93], v[28:29]
  v_pk_mul_f32 v[94:95], v[94:95], v[28:29]
  v_pk_mul_f32 v[96:97], v[96:97], v[28:29]
  v_pk_mul_f32 v[98:99], v[98:99], v[28:29]
  v_cvt_pk_bf16_f32 v104, v92, v93
  v_cvt_pk_bf16_f32 v105, v94, v95
  v_cvt_pk_bf16_f32 v106, v96, v97
  v_cvt_pk_bf16_f32 v107, v98, v99
  buffer_store_dwordx4 v[104:107], v11, s[4:7], s22 offen
reca_b324:
  s_barrier
  s_cmp_ge_u32 s12, 2
  s_cbranch_scc1 reca_notg240
  s_sleep 3
  buffer_load_dwordx4 v[128:131], v12, s[4:7], s22 offen offset:0 sc1
  buffer_load_dwordx4 v[132:135], v12, s[4:7], s22 offen offset:1024 sc1
  buffer_load_dwordx4 v[136:139], v12, s[4:7], s22 offen offset:2048 sc1
  buffer_load_dwordx4 v[140:143], v12, s[4:7], s22 offen offset:3072 sc1
  buffer_load_dwordx4 v[144:147], v13, s[4:7], s22 offen offset:0 sc1
  buffer_load_dwordx4 v[148:151], v13, s[4:7], s22 offen offset:1024 sc1
  buffer_load_dwordx4 v[152:155], v13, s[4:7], s22 offen offset:2048 sc1
  buffer_load_dwordx4 v[156:159], v13, s[4:7], s22 offen offset:3072 sc1
  buffer_load_dwordx4 v[160:163], v14, s[4:7], s22 offen offset:0 sc1
  buffer_load_dwordx4 v[164:167], v14, s[4:7], s22 offen offset:1024 sc1
  buffer_load_dwordx4 v[168:171], v14, s[4:7], s22 offen offset:2048 sc1
  buffer_load_dwordx4 v[172:175], v14, s[4:7], s22 offen offset:3072 sc1
  s_waitcnt vmcnt(11)
  v_cmp_eq_u32 vcc, -1, v128
  s_cbranch_vccnz reca_retry41
reca_resume42:
  s_waitcnt vmcnt(10)
  v_cmp_eq_u32 vcc, -1, v132
  v_mfma_f32_16x16x32_bf16 v[108:111], a[120:123], v[128:131], 0
  v_mfma_f32_16x16x32_bf16 v[112:115], a[124:127], v[128:131], 0
  s_cbranch_vccnz reca_retry43
reca_resume44:
  s_waitcnt vmcnt(9)
  v_cmp_eq_u32 vcc, -1, v136
  v_mfma_f32_16x16x32_bf16 v[108:111], a[128:131], v[132:135], v[108:111]
  v_mfma_f32_16x16x32_bf16 v[112:115], a[132:135], v[132:135], v[112:115]
  s_cbranch_vccnz reca_retry45
reca_resume46:
  s_waitcnt vmcnt(8)
  v_cmp_eq_u32 vcc, -1, v140
  v_mfma_f32_16x16x32_bf16 v[108:111], a[136:139], v[136:139], v[108:111]
  v_mfma_f32_16x16x32_bf16 v[112:115], a[140:143], v[136:139], v[112:115]
  s_cbranch_vccnz reca_retry47
reca_resume48:
  s_waitcnt vmcnt(7)
  v_cmp_eq_u32 vcc, -1, v144
  v_mfma_f32_16x16x32_bf16 v[108:111], a[144:147], v[140:143], v[108:111]
  v_mfma_f32_16x16x32_bf16 v[112:115], a[148:151], v[140:143], v[112:115]
  s_cbranch_vccnz reca_retry49
reca_resume50:
  s_waitcnt vmcnt(6)
  v_cmp_eq_u32 vcc, -1, v148
  v_mfma_f32_16x16x32_bf16 v[108:111], a[152:155], v[144:147], v[108:111]
  v_mfma_f32_16x16x32_bf16 v[112:115], a[156:159], v[144:147], v[112:115]
  s_cbranch_vccnz reca_retry51
reca_resume52:
  s_waitcnt vmcnt(5)
  v_cmp_eq_u32 vcc, -1, v152
  v_mfma_f32_16x16x32_bf16 v[108:111], a[160:163], v[148:151], v[108:111]
  v_mfma_f32_16x16x32_bf16 v[112:115], a[164:167], v[148:151], v[112:115]
  s_cbranch_vccnz reca_retry53
reca_resume54:
  s_waitcnt vmcnt(4)
  v_cmp_eq_u32 vcc, -1, v156
  v_mfma_f32_16x16x32_bf16 v[108:111], a[168:171], v[152:155], v[108:111]
  v_mfma_f32_16x16x32_bf16 v[112:115], a[172:175], v[152:155], v[112:115]
  s_cbranch_vccnz reca_retry55
reca_resume56:
  s_waitcnt vmcnt(3)
  v_cmp_eq_u32 vcc, -1, v160
  v_mfma_f32_16x16x32_bf16 v[108:111], a[176:179], v[156:159], v[108:111]
  v_mfma_f32_16x16x32_bf16 v[112:115], a[180:183], v[156:159], v[112:115]
  s_cbranch_vccnz reca_retry57
reca_resume58:
  s_waitcnt vmcnt(2)
  v_cmp_eq_u32 vcc, -1, v164
  v_mfma_f32_16x16x32_bf16 v[108:111], a[184:187], v[160:163], v[108:111]
  v_mfma_f32_16x16x32_bf16 v[112:115], a[188:191], v[160:163], v[112:115]
  s_cbranch_vccnz reca_retry59
reca_resume60:
  s_waitcnt vmcnt(1)
  v_cmp_eq_u32 vcc, -1, v168
  v_mfma_f32_16x16x32_bf16 v[108:111], a[192:195], v[164:167], v[108:111]
  v_mfma_f32_16x16x32_bf16 v[112:115], a[196:199], v[164:167], v[112:115]
  s_cbranch_vccnz reca_retry61
reca_resume62:
  s_waitcnt vmcnt(0)
  v_cmp_eq_u32 vcc, -1, v172
  v_mfma_f32_16x16x32_bf16 v[108:111], a[200:203], v[168:171], v[108:111]
  v_mfma_f32_16x16x32_bf16 v[112:115], a[204:207], v[168:171], v[112:115]
  s_cbranch_vccnz reca_retry63
reca_resume64:
  v_mfma_f32_16x16x32_bf16 v[108:111], a[208:211], v[172:175], v[108:111]
  v_mfma_f32_16x16x32_bf16 v[112:115], a[212:215], v[172:175], v[112:115]
  s_nop 7
  v_add_f32_dpp v116, v112, v108 row_ror:8 row_mask:0xf bank_mask:0xf
  v_add_f32_dpp v117, v113, v109 row_ror:8 row_mask:0xf bank_mask:0xf
  v_add_f32_dpp v118, v114, v110 row_ror:8 row_mask:0xf bank_mask:0xf
  v_add_f32_dpp v119, v115, v111 row_ror:8 row_mask:0xf bank_mask:0xf
  buffer_store_dwordx4 v[116:119], v15, s[4:7], s25 offen sc1
  buffer_store_dwordx4 v[116:119], v232, s[4:7], s25 offen sc1
  buffer_store_dwordx4 v[32:35], v15, s[4:7], s29 offen sc1
  buffer_store_dwordx4 v[32:35], v232, s[4:7], s29 offen sc1
  s_branch reca_b425
reca_notg240:
  s_cmp_lg_u32 s12, 3
  s_cbranch_scc1 reca_b425
  s_add_u32 s34, s17, 2
  s_and_b32 s34, s34, 3
  s_mul_i32 s26, s34, 10240
  s_add_u32 s26, s26, s38
  s_mul_i32 s27, s34, 6144
  s_add_u32 s27, s27, s39
  s_mul_i32 s28, s34, 12288
  s_add_u32 s28, s28, s40
  s_mul_i32 s29, s34, 393216
  s_add_u32 s29, s29, s56
  buffer_store_dwordx2 v[32:33], v8, s[4:7], s27 offen
  buffer_store_dwordx4 v[32:35], v11, s[4:7], s28 offen
reca_b425:
  s_barrier
  s_cmp_lg_u32 s12, 2
  s_cbranch_scc1 reca_not265
  s_sleep 8
  buffer_load_dwordx4 v[128:131], v20, s[4:7], s25 offen sc1
  buffer_load_dwordx4 v[132:135], v21, s[4:7], s25 offen sc1
  buffer_load_dwordx4 v[136:139], v22, s[4:7], s25 offen sc1
  buffer_load_dwordx4 v[140:143], v23, s[4:7], s25 offen sc1
  buffer_load_dwordx4 v[144:147], v24, s[4:7], s25 offen sc1
  buffer_load_dwordx4 v[148:151], v25, s[4:7], s25 offen sc1
  buffer_load_dwordx4 v[152:155], v26, s[4:7], s25 offen sc1
  buffer_load_dwordx4 v[156:159], v27, s[4:7], s25 offen sc1
  s_waitcnt vmcnt(7)
  v_cmp_eq_u32 vcc, -1, v128
  s_cbranch_vccnz reca_retry66
reca_resume67:
  s_waitcnt vmcnt(6)
  v_cmp_eq_u32 vcc, -1, v132
  s_cbranch_vccnz reca_retry68
reca_resume69:
  s_waitcnt vmcnt(5)
  v_cmp_eq_u32 vcc, -1, v136
  v_pk_add_f32 v[116:117], v[128:129], v[132:133]
  v_pk_add_f32 v[118:119], v[130:131], v[134:135]
  s_cbranch_vccnz reca_retry70
reca_resume71:
  s_waitcnt vmcnt(4)
  v_cmp_eq_u32 vcc, -1, v140
  v_pk_add_f32 v[116:117], v[116:117], v[136:137]
  v_pk_add_f32 v[118:119], v[118:119], v[138:139]
  s_cbranch_vccnz reca_retry72
reca_resume73:
  s_waitcnt vmcnt(3)
  v_cmp_eq_u32 vcc, -1, v144
  v_pk_add_f32 v[116:117], v[116:117], v[140:141]
  v_pk_add_f32 v[118:119], v[118:119], v[142:143]
  s_cbranch_vccnz reca_retry74
reca_resume75:
  s_waitcnt vmcnt(2)
  v_cmp_eq_u32 vcc, -1, v148
  v_pk_add_f32 v[116:117], v[116:117], v[144:145]
  v_pk_add_f32 v[118:119], v[118:119], v[146:147]
  s_cbranch_vccnz reca_retry76
reca_resume77:
  s_waitcnt vmcnt(1)
  v_cmp_eq_u32 vcc, -1, v152
  v_pk_add_f32 v[116:117], v[116:117], v[148:149]
  v_pk_add_f32 v[118:119], v[118:119], v[150:151]
  s_cbranch_vccnz reca_retry78
reca_resume79:
  s_waitcnt vmcnt(0)
  v_cmp_eq_u32 vcc, -1, v156
  v_pk_add_f32 v[116:117], v[116:117], v[152:153]
  v_pk_add_f32 v[118:119], v[118:119], v[154:155]
  s_cbranch_vccnz reca_retry80
reca_resume81:
  v_pk_add_f32 v[116:117], v[116:117], v[156:157]
  v_pk_add_f32 v[118:119], v[118:119], v[158:159]
  v_cvt_pk_bf16_f32 v132, v116, v117
  v_cvt_pk_bf16_f32 v133, v118, v119
  buffer_store_dwordx2 v[132:133], v16, s[4:7], s24 offen
  s_branch reca_b526
reca_not265:
  s_cmp_lg_u32 s12, 3
  s_cbranch_scc1 reca_b526
  s_add_u32 s36, s17, 1
  s_cmp_ge_u32 s36, 63
  s_cbranch_scc1 reca_nopf82
  s_add_u32 s37, s36, 1
reca_pf83:
  buffer_load_dword v28, v233, s[4:7], 0 offen sc1
  s_waitcnt vmcnt(0)
  v_cmp_gt_i32 vcc, s37, v28
  s_cbranch_vccz reca_pfok84
  s_sleep 1
  s_sub_u32 s18, s18, 1
  s_cbranch_scc0 reca_pf83
  s_mov_b32 s18, 0
reca_pfok84:
  s_lshl_b32 s34, s15, 6
  s_add_u32 s34, s34, s36
  s_mul_i32 s34, s34, 12288
  s_add_u32 s32, s34, 37748736
  s_lshl_b32 s35, s16, 11
  s_add_u32 s34, s34, s35
  s_add_u32 s33, s34, 62914560
  buffer_load_dwordx4 a[120:123], v1, s[4:7], s32 offen offset:0 sc1
  buffer_load_dwordx4 a[124:127], v1, s[4:7], s32 offen offset:1024 sc1
  buffer_load_dwordx4 a[128:131], v1, s[4:7], s32 offen offset:2048 sc1
  buffer_load_dwordx4 a[132:135], v1, s[4:7], s32 offen offset:3072 sc1
  buffer_load_dwordx4 a[136:139], v2, s[4:7], s32 offen offset:0 sc1
  buffer_load_dwordx4 a[140:143], v2, s[4:7], s32 offen offset:1024 sc1
  buffer_load_dwordx4 a[144:147], v2, s[4:7], s32 offen offset:2048 sc1
  buffer_load_dwordx4 a[148:151], v2, s[4:7], s32 offen offset:3072 sc1
  buffer_load_dwordx4 a[152:155], v3, s[4:7], s32 offen offset:0 sc1
  buffer_load_dwordx4 a[156:159], v3, s[4:7], s32 offen offset:1024 sc1
  buffer_load_dwordx4 a[160:163], v3, s[4:7], s32 offen offset:2048 sc1
  buffer_load_dwordx4 a[164:167], v3, s[4:7], s32 offen offset:3072 sc1
  buffer_load_dwordx4 a[168:171], v1, s[4:7], s33 offen offset:0 sc1
  buffer_load_dwordx4 a[172:175], v1, s[4:7], s33 offen offset:1024 sc1
reca_nopf82:
  buffer_store_dwordx2 v[52:53], v9, s[4:7], s30 offen
  buffer_store_dwordx2 v[68:69], v10, s[4:7], s31 offen
  buffer_store_dwordx2 v[70:71], v10, s[4:7], s31 offen offset:256
reca_b526:
  s_barrier
  s_add_u32 s17, s17, 1
  s_branch reca_step12
reca_retry15:
  s_sub_u32 s18, s18, 1
  s_cbranch_scc1 reca_retry15_to
  buffer_load_dwordx4 v[128:131], v4, s[4:7], s20 offen sc1
  buffer_load_dwordx4 v[132:135], v4, s[4:7], s20 offen offset:1024 sc1
  buffer_load_dwordx4 v[136:139], v5, s[4:7], s20 offen sc1
  s_waitcnt vmcnt(2)
  v_max_u32 v29, v128, v130
  v_cmp_eq_u32 vcc, -1, v29
  s_cbranch_vccnz reca_retry15
  s_branch reca_resume16
reca_retry15_to:
  s_mov_b32 s18, 0
  s_waitcnt vmcnt(0)
  s_branch reca_resume16
reca_retry17:
  s_sub_u32 s18, s18, 1
  s_cbranch_scc1 reca_retry17_to
  buffer_load_dwordx4 v[132:135], v4, s[4:7], s20 offen offset:1024 sc1
  buffer_load_dwordx4 v[136:139], v5, s[4:7], s20 offen sc1
  s_waitcnt vmcnt(1)
  v_max_u32 v29, v132, v134
  v_cmp_eq_u32 vcc, -1, v29
  s_cbranch_vccnz reca_retry17
  s_branch reca_resume18
reca_retry17_to:
  s_mov_b32 s18, 0
  s_waitcnt vmcnt(0)
  s_branch reca_resume18
reca_retry19:
  s_sub_u32 s18, s18, 1
  s_cbranch_scc1 reca_retry19_to
  buffer_load_dwordx4 v[136:139], v5, s[4:7], s20 offen sc1
  s_waitcnt vmcnt(0)
  v_max_u32 v29, v136, v138
  v_cmp_eq_u32 vcc, -1, v29
  s_cbranch_vccnz reca_retry19
  s_branch reca_resume20
reca_retry19_to:
  s_mov_b32 s18, 0
  s_waitcnt vmcnt(0)
  s_branch reca_resume20
reca_retry28:
  s_sub_u32 s18, s18, 1
  s_cbranch_scc1 reca_retry28_to
  buffer_load_dwordx4 v[208:211], v1, s[4:7], s21 offen offset:0 sc1
  buffer_load_dwordx4 v[212:215], v1, s[4:7], s21 offen offset:1024 sc1
  buffer_load_dwordx4 v[216:219], v1, s[4:7], s21 offen offset:2048 sc1
  buffer_load_dwordx4 v[220:223], v1, s[4:7], s21 offen offset:3072 sc1
  buffer_load_dwordx4 v[224:227], v2, s[4:7], s21 offen offset:0 sc1
  buffer_load_dwordx4 v[228:231], v2, s[4:7], s21 offen offset:1024 sc1
  s_waitcnt vmcnt(5)
  v_max_u32 v29, v208, v210
  v_cmp_eq_u32 vcc, -1, v29
  s_cbranch_vccnz reca_retry28
  s_branch reca_resume29
reca_retry28_to:
  s_mov_b32 s18, 0
  s_waitcnt vmcnt(0)
  s_branch reca_resume29
reca_retry30:
  s_sub_u32 s18, s18, 1
  s_cbranch_scc1 reca_retry30_to
  buffer_load_dwordx4 v[212:215], v1, s[4:7], s21 offen offset:1024 sc1
  buffer_load_dwordx4 v[216:219], v1, s[4:7], s21 offen offset:2048 sc1
  buffer_load_dwordx4 v[220:223], v1, s[4:7], s21 offen offset:3072 sc1
  buffer_load_dwordx4 v[224:227], v2, s[4:7], s21 offen offset:0 sc1
  buffer_load_dwordx4 v[228:231], v2, s[4:7], s21 offen offset:1024 sc1
  s_waitcnt vmcnt(4)
  v_max_u32 v29, v212, v214
  v_cmp_eq_u32 vcc, -1, v29
  s_cbranch_vccnz reca_retry30
  s_branch reca_resume31
reca_retry30_to:
  s_mov_b32 s18, 0
  s_waitcnt vmcnt(0)
  s_branch reca_resume31
reca_retry32:
  s_sub_u32 s18, s18, 1
  s_cbranch_scc1 reca_retry32_to
  buffer_load_dwordx4 v[216:219], v1, s[4:7], s21 offen offset:2048 sc1
  buffer_load_dwordx4 v[220:223], v1, s[4:7], s21 offen offset:3072 sc1
  buffer_load_dwordx4 v[224:227], v2, s[4:7], s21 offen offset:0 sc1
  buffer_load_dwordx4 v[228:231], v2, s[4:7], s21 offen offset:1024 sc1
  s_waitcnt vmcnt(3)
  v_max_u32 v29, v216, v218
  v_cmp_eq_u32 vcc, -1, v29
  s_cbranch_vccnz reca_retry32
  s_branch reca_resume33
reca_retry32_to:
  s_mov_b32 s18, 0
  s_waitcnt vmcnt(0)
  s_branch reca_resume33
reca_retry34:
  s_sub_u32 s18, s18, 1
  s_cbranch_scc1 reca_retry34_to
  buffer_load_dwordx4 v[220:223], v1, s[4:7], s21 offen offset:3072 sc1
  buffer_load_dwordx4 v[224:227], v2, s[4:7], s21 offen offset:0 sc1
  buffer_load_dwordx4 v[228:231], v2, s[4:7], s21 offen offset:1024 sc1
  s_waitcnt vmcnt(2)
  v_max_u32 v29, v220, v222
  v_cmp_eq_u32 vcc, -1, v29
  s_cbranch_vccnz reca_retry34
  s_branch reca_resume35
reca_retry34_to:
  s_mov_b32 s18, 0
  s_waitcnt vmcnt(0)
  s_branch reca_resume35
reca_retry36:
  s_sub_u32 s18, s18, 1
  s_cbranch_scc1 reca_retry36_to
  buffer_load_dwordx4 v[224:227], v2, s[4:7], s21 offen offset:0 sc1
  buffer_load_dwordx4 v[228:231], v2, s[4:7], s21 offen offset:1024 sc1
  s_waitcnt vmcnt(1)
  v_max_u32 v29, v224, v226
  v_cmp_eq_u32 vcc, -1, v29
  s_cbranch_vccnz reca_retry36
  s_branch reca_resume37
reca_retry36_to:
  s_mov_b32 s18, 0
  s_waitcnt vmcnt(0)
  s_branch reca_resume37
reca_retry38:
  s_sub_u32 s18, s18, 1
  s_cbranch_scc1 reca_retry38_to
  buffer_load_dwordx4 v[228:231], v2, s[4:7], s21 offen offset:1024 sc1
  s_waitcnt vmcnt(0)
  v_max_u32 v29, v228, v230
  v_cmp_eq_u32 vcc, -1, v29
  s_cbranch_vccnz reca_retry38
  s_branch reca_resume39
reca_retry38_to:
  s_mov_b32 s18, 0
  s_waitcnt vmcnt(0)
  s_branch reca_resume39
reca_retry41:
  s_sub_u32 s18, s18, 1
  s_cbranch_scc1 reca_retry41_to
  buffer_load_dwordx4 v[128:131], v12, s[4:7], s22 offen offset:0 sc1
  buffer_load_dwordx4 v[132:135], v12, s[4:7], s22 offen offset:1024 sc1
  buffer_load_dwordx4 v[136:139], v12, s[4:7], s22 offen offset:2048 sc1
  buffer_load_dwordx4 v[140:143], v12, s[4:7], s22 offen offset:3072 sc1
  buffer_load_dwordx4 v[144:147], v13, s[4:7], s22 offen offset:0 sc1
  buffer_load_dwordx4 v[148:151], v13, s[4:7], s22 offen offset:1024 sc1
  buffer_load_dwordx4 v[152:155], v13, s[4:7], s22 offen offset:2048 sc1
  buffer_load_dwordx4 v[156:159], v13, s[4:7], s22 offen offset:3072 sc1
  buffer_load_dwordx4 v[160:163], v14, s[4:7], s22 offen offset:0 sc1
  buffer_load_dwordx4 v[164:167], v14, s[4:7], s22 offen offset:1024 sc1
  buffer_load_dwordx4 v[168:171], v14, s[4:7], s22 offen offset:2048 sc1
  buffer_load_dwordx4 v[172:175], v14, s[4:7], s22 offen offset:3072 sc1
  s_waitcnt vmcnt(11)
  v_cmp_eq_u32 vcc, -1, v128
  s_cbranch_vccnz reca_retry41
  s_branch reca_resume42
reca_retry41_to:
  s_mov_b32 s18, 0
  s_waitcnt vmcnt(0)
  s_branch reca_resume42
reca_retry43:
  s_sub_u32 s18, s18, 1
  s_cbranch_scc1 reca_retry43_to
  buffer_load_dwordx4 v[132:135], v12, s[4:7], s22 offen offset:1024 sc1
  buffer_load_dwordx4 v[136:139], v12, s[4:7], s22 offen offset:2048 sc1
  buffer_load_dwordx4 v[140:143], v12, s[4:7], s22 offen offset:3072 sc1
  buffer_load_dwordx4 v[144:147], v13, s[4:7], s22 offen offset:0 sc1
  buffer_load_dwordx4 v[148:151], v13, s[4:7], s22 offen offset:1024 sc1
  buffer_load_dwordx4 v[152:155], v13, s[4:7], s22 offen offset:2048 sc1
  buffer_load_dwordx4 v[156:159], v13, s[4:7], s22 offen offset:3072 sc1
  buffer_load_dwordx4 v[160:163], v14, s[4:7], s22 offen offset:0 sc1
  buffer_load_dwordx4 v[164:167], v14, s[4:7], s22 offen offset:1024 sc1
  buffer_load_dwordx4 v[168:171], v14, s[4:7], s22 offen offset:2048 sc1
  buffer_load_dwordx4 v[172:175], v14, s[4:7], s22 offen offset:3072 sc1
  s_waitcnt vmcnt(10)
  v_cmp_eq_u32 vcc, -1, v132
  s_cbranch_vccnz reca_retry43
  s_branch reca_resume44
reca_retry43_to:
  s_mov_b32 s18, 0
  s_waitcnt vmcnt(0)
  s_branch reca_resume44
reca_retry45:
  s_sub_u32 s18, s18, 1
  s_cbranch_scc1 reca_retry45_to
  buffer_load_dwordx4 v[136:139], v12, s[4:7], s22 offen offset:2048 sc1
  buffer_load_dwordx4 v[140:143], v12, s[4:7], s22 offen offset:3072 sc1
  buffer_load_dwordx4 v[144:147], v13, s[4:7], s22 offen offset:0 sc1
  buffer_load_dwordx4 v[148:151], v13, s[4:7], s22 offen offset:1024 sc1
  buffer_load_dwordx4 v[152:155], v13, s[4:7], s22 offen offset:2048 sc1
  buffer_load_dwordx4 v[156:159], v13, s[4:7], s22 offen offset:3072 sc1
  buffer_load_dwordx4 v[160:163], v14, s[4:7], s22 offen offset:0 sc1
  buffer_load_dwordx4 v[164:167], v14, s[4:7], s22 offen offset:1024 sc1
  buffer_load_dwordx4 v[168:171], v14, s[4:7], s22 offen offset:2048 sc1
  buffer_load_dwordx4 v[172:175], v14, s[4:7], s22 offen offset:3072 sc1
  s_waitcnt vmcnt(9)
  v_cmp_eq_u32 vcc, -1, v136
  s_cbranch_vccnz reca_retry45
  s_branch reca_resume46
reca_retry45_to:
  s_mov_b32 s18, 0
  s_waitcnt vmcnt(0)
  s_branch reca_resume46
reca_retry47:
  s_sub_u32 s18, s18, 1
  s_cbranch_scc1 reca_retry47_to
  buffer_load_dwordx4 v[140:143], v12, s[4:7], s22 offen offset:3072 sc1
  buffer_load_dwordx4 v[144:147], v13, s[4:7], s22 offen offset:0 sc1
  buffer_load_dwordx4 v[148:151], v13, s[4:7], s22 offen offset:1024 sc1
  buffer_load_dwordx4 v[152:155], v13, s[4:7], s22 offen offset:2048 sc1
  buffer_load_dwordx4 v[156:159], v13, s[4:7], s22 offen offset:3072 sc1
  buffer_load_dwordx4 v[160:163], v14, s[4:7], s22 offen offset:0 sc1
  buffer_load_dwordx4 v[164:167], v14, s[4:7], s22 offen offset:1024 sc1
  buffer_load_dwordx4 v[168:171], v14, s[4:7], s22 offen offset:2048 sc1
  buffer_load_dwordx4 v[172:175], v14, s[4:7], s22 offen offset:3072 sc1
  s_waitcnt vmcnt(8)
  v_cmp_eq_u32 vcc, -1, v140
  s_cbranch_vccnz reca_retry47
  s_branch reca_resume48
reca_retry47_to:
  s_mov_b32 s18, 0
  s_waitcnt vmcnt(0)
  s_branch reca_resume48
reca_retry49:
  s_sub_u32 s18, s18, 1
  s_cbranch_scc1 reca_retry49_to
  buffer_load_dwordx4 v[144:147], v13, s[4:7], s22 offen offset:0 sc1
  buffer_load_dwordx4 v[148:151], v13, s[4:7], s22 offen offset:1024 sc1
  buffer_load_dwordx4 v[152:155], v13, s[4:7], s22 offen offset:2048 sc1
  buffer_load_dwordx4 v[156:159], v13, s[4:7], s22 offen offset:3072 sc1
  buffer_load_dwordx4 v[160:163], v14, s[4:7], s22 offen offset:0 sc1
  buffer_load_dwordx4 v[164:167], v14, s[4:7], s22 offen offset:1024 sc1
  buffer_load_dwordx4 v[168:171], v14, s[4:7], s22 offen offset:2048 sc1
  buffer_load_dwordx4 v[172:175], v14, s[4:7], s22 offen offset:3072 sc1
  s_waitcnt vmcnt(7)
  v_cmp_eq_u32 vcc, -1, v144
  s_cbranch_vccnz reca_retry49
  s_branch reca_resume50
reca_retry49_to:
  s_mov_b32 s18, 0
  s_waitcnt vmcnt(0)
  s_branch reca_resume50
reca_retry51:
  s_sub_u32 s18, s18, 1
  s_cbranch_scc1 reca_retry51_to
  buffer_load_dwordx4 v[148:151], v13, s[4:7], s22 offen offset:1024 sc1
  buffer_load_dwordx4 v[152:155], v13, s[4:7], s22 offen offset:2048 sc1
  buffer_load_dwordx4 v[156:159], v13, s[4:7], s22 offen offset:3072 sc1
  buffer_load_dwordx4 v[160:163], v14, s[4:7], s22 offen offset:0 sc1
  buffer_load_dwordx4 v[164:167], v14, s[4:7], s22 offen offset:1024 sc1
  buffer_load_dwordx4 v[168:171], v14, s[4:7], s22 offen offset:2048 sc1
  buffer_load_dwordx4 v[172:175], v14, s[4:7], s22 offen offset:3072 sc1
  s_waitcnt vmcnt(6)
  v_cmp_eq_u32 vcc, -1, v148
  s_cbranch_vccnz reca_retry51
  s_branch reca_resume52
reca_retry51_to:
  s_mov_b32 s18, 0
  s_waitcnt vmcnt(0)
  s_branch reca_resume52
reca_retry53:
  s_sub_u32 s18, s18, 1
  s_cbranch_scc1 reca_retry53_to
  buffer_load_dwordx4 v[152:155], v13, s[4:7], s22 offen offset:2048 sc1
  buffer_load_dwordx4 v[156:159], v13, s[4:7], s22 offen offset:3072 sc1
  buffer_load_dwordx4 v[160:163], v14, s[4:7], s22 offen offset:0 sc1
  buffer_load_dwordx4 v[164:167], v14, s[4:7], s22 offen offset:1024 sc1
  buffer_load_dwordx4 v[168:171], v14, s[4:7], s22 offen offset:2048 sc1
  buffer_load_dwordx4 v[172:175], v14, s[4:7], s22 offen offset:3072 sc1
  s_waitcnt vmcnt(5)
  v_cmp_eq_u32 vcc, -1, v152
  s_cbranch_vccnz reca_retry53
  s_branch reca_resume54
reca_retry53_to:
  s_mov_b32 s18, 0
  s_waitcnt vmcnt(0)
  s_branch reca_resume54
reca_retry55:
  s_sub_u32 s18, s18, 1
  s_cbranch_scc1 reca_retry55_to
  buffer_load_dwordx4 v[156:159], v13, s[4:7], s22 offen offset:3072 sc1
  buffer_load_dwordx4 v[160:163], v14, s[4:7], s22 offen offset:0 sc1
  buffer_load_dwordx4 v[164:167], v14, s[4:7], s22 offen offset:1024 sc1
  buffer_load_dwordx4 v[168:171], v14, s[4:7], s22 offen offset:2048 sc1
  buffer_load_dwordx4 v[172:175], v14, s[4:7], s22 offen offset:3072 sc1
  s_waitcnt vmcnt(4)
  v_cmp_eq_u32 vcc, -1, v156
  s_cbranch_vccnz reca_retry55
  s_branch reca_resume56
reca_retry55_to:
  s_mov_b32 s18, 0
  s_waitcnt vmcnt(0)
  s_branch reca_resume56
reca_retry57:
  s_sub_u32 s18, s18, 1
  s_cbranch_scc1 reca_retry57_to
  buffer_load_dwordx4 v[160:163], v14, s[4:7], s22 offen offset:0 sc1
  buffer_load_dwordx4 v[164:167], v14, s[4:7], s22 offen offset:1024 sc1
  buffer_load_dwordx4 v[168:171], v14, s[4:7], s22 offen offset:2048 sc1
  buffer_load_dwordx4 v[172:175], v14, s[4:7], s22 offen offset:3072 sc1
  s_waitcnt vmcnt(3)
  v_cmp_eq_u32 vcc, -1, v160
  s_cbranch_vccnz reca_retry57
  s_branch reca_resume58
reca_retry57_to:
  s_mov_b32 s18, 0
  s_waitcnt vmcnt(0)
  s_branch reca_resume58
reca_retry59:
  s_sub_u32 s18, s18, 1
  s_cbranch_scc1 reca_retry59_to
  buffer_load_dwordx4 v[164:167], v14, s[4:7], s22 offen offset:1024 sc1
  buffer_load_dwordx4 v[168:171], v14, s[4:7], s22 offen offset:2048 sc1
  buffer_load_dwordx4 v[172:175], v14, s[4:7], s22 offen offset:3072 sc1
  s_waitcnt vmcnt(2)
  v_cmp_eq_u32 vcc, -1, v164
  s_cbranch_vccnz reca_retry59
  s_branch reca_resume60
reca_retry59_to:
  s_mov_b32 s18, 0
  s_waitcnt vmcnt(0)
  s_branch reca_resume60
reca_retry61:
  s_sub_u32 s18, s18, 1
  s_cbranch_scc1 reca_retry61_to
  buffer_load_dwordx4 v[168:171], v14, s[4:7], s22 offen offset:2048 sc1
  buffer_load_dwordx4 v[172:175], v14, s[4:7], s22 offen offset:3072 sc1
  s_waitcnt vmcnt(1)
  v_cmp_eq_u32 vcc, -1, v168
  s_cbranch_vccnz reca_retry61
  s_branch reca_resume62
reca_retry61_to:
  s_mov_b32 s18, 0
  s_waitcnt vmcnt(0)
  s_branch reca_resume62
reca_retry63:
  s_sub_u32 s18, s18, 1
  s_cbranch_scc1 reca_retry63_to
  buffer_load_dwordx4 v[172:175], v14, s[4:7], s22 offen offset:3072 sc1
  s_waitcnt vmcnt(0)
  v_cmp_eq_u32 vcc, -1, v172
  s_cbranch_vccnz reca_retry63
  s_branch reca_resume64
reca_retry63_to:
  s_mov_b32 s18, 0
  s_waitcnt vmcnt(0)
  s_branch reca_resume64
reca_retry66:
  s_sub_u32 s18, s18, 1
  s_cbranch_scc1 reca_retry66_to
  buffer_load_dwordx4 v[128:131], v20, s[4:7], s25 offen sc1
  buffer_load_dwordx4 v[132:135], v21, s[4:7], s25 offen sc1
  buffer_load_dwordx4 v[136:139], v22, s[4:7], s25 offen sc1
  buffer_load_dwordx4 v[140:143], v23, s[4:7], s25 offen sc1
  buffer_load_dwordx4 v[144:147], v24, s[4:7], s25 offen sc1
  buffer_load_dwordx4 v[148:151], v25, s[4:7], s25 offen sc1
  buffer_load_dwordx4 v[152:155], v26, s[4:7], s25 offen sc1
  buffer_load_dwordx4 v[156:159], v27, s[4:7], s25 offen sc1
  s_waitcnt vmcnt(7)
  v_cmp_eq_u32 vcc, -1, v128
  s_cbranch_vccnz reca_retry66
  s_branch reca_resume67
reca_retry66_to:
  s_mov_b32 s18, 0
  s_waitcnt vmcnt(0)
  s_branch reca_resume67
reca_retry68:
  s_sub_u32 s18, s18, 1
  s_cbranch_scc1 reca_retry68_to
  buffer_load_dwordx4 v[132:135], v21, s[4:7], s25 offen sc1
  buffer_load_dwordx4 v[136:139], v22, s[4:7], s25 offen sc1
  buffer_load_dwordx4 v[140:143], v23, s[4:7], s25 offen sc1
  buffer_load_dwordx4 v[144:147], v24, s[4:7], s25 offen sc1
  buffer_load_dwordx4 v[148:151], v25, s[4:7], s25 offen sc1
  buffer_load_dwordx4 v[152:155], v26, s[4:7], s25 offen sc1
  buffer_load_dwordx4 v[156:159], v27, s[4:7], s25 offen sc1
  s_waitcnt vmcnt(6)
  v_cmp_eq_u32 vcc, -1, v132
  s_cbranch_vccnz reca_retry68
  s_branch reca_resume69
reca_retry68_to:
  s_mov_b32 s18, 0
  s_waitcnt vmcnt(0)
  s_branch reca_resume69
reca_retry70:
  s_sub_u32 s18, s18, 1
  s_cbranch_scc1 reca_retry70_to
  buffer_load_dwordx4 v[136:139], v22, s[4:7], s25 offen sc1
  buffer_load_dwordx4 v[140:143], v23, s[4:7], s25 offen sc1
  buffer_load_dwordx4 v[144:147], v24, s[4:7], s25 offen sc1
  buffer_load_dwordx4 v[148:151], v25, s[4:7], s25 offen sc1
  buffer_load_dwordx4 v[152:155], v26, s[4:7], s25 offen sc1
  buffer_load_dwordx4 v[156:159], v27, s[4:7], s25 offen sc1
  s_waitcnt vmcnt(5)
  v_cmp_eq_u32 vcc, -1, v136
  s_cbranch_vccnz reca_retry70
  s_branch reca_resume71
reca_retry70_to:
  s_mov_b32 s18, 0
  s_waitcnt vmcnt(0)
  s_branch reca_resume71
reca_retry72:
  s_sub_u32 s18, s18, 1
  s_cbranch_scc1 reca_retry72_to
  buffer_load_dwordx4 v[140:143], v23, s[4:7], s25 offen sc1
  buffer_load_dwordx4 v[144:147], v24, s[4:7], s25 offen sc1
  buffer_load_dwordx4 v[148:151], v25, s[4:7], s25 offen sc1
  buffer_load_dwordx4 v[152:155], v26, s[4:7], s25 offen sc1
  buffer_load_dwordx4 v[156:159], v27, s[4:7], s25 offen sc1
  s_waitcnt vmcnt(4)
  v_cmp_eq_u32 vcc, -1, v140
  s_cbranch_vccnz reca_retry72
  s_branch reca_resume73
reca_retry72_to:
  s_mov_b32 s18, 0
  s_waitcnt vmcnt(0)
  s_branch reca_resume73
reca_retry74:
  s_sub_u32 s18, s18, 1
  s_cbranch_scc1 reca_retry74_to
  buffer_load_dwordx4 v[144:147], v24, s[4:7], s25 offen sc1
  buffer_load_dwordx4 v[148:151], v25, s[4:7], s25 offen sc1
  buffer_load_dwordx4 v[152:155], v26, s[4:7], s25 offen sc1
  buffer_load_dwordx4 v[156:159], v27, s[4:7], s25 offen sc1
  s_waitcnt vmcnt(3)
  v_cmp_eq_u32 vcc, -1, v144
  s_cbranch_vccnz reca_retry74
  s_branch reca_resume75
reca_retry74_to:
  s_mov_b32 s18, 0
  s_waitcnt vmcnt(0)
  s_branch reca_resume75
reca_retry76:
  s_sub_u32 s18, s18, 1
  s_cbranch_scc1 reca_retry76_to
  buffer_load_dwordx4 v[148:151], v25, s[4:7], s25 offen sc1
  buffer_load_dwordx4 v[152:155], v26, s[4:7], s25 offen sc1
  buffer_load_dwordx4 v[156:159], v27, s[4:7], s25 offen sc1
  s_waitcnt vmcnt(2)
  v_cmp_eq_u32 vcc, -1, v148
  s_cbranch_vccnz reca_retry76
  s_branch reca_resume77
reca_retry76_to:
  s_mov_b32 s18, 0
  s_waitcnt vmcnt(0)
  s_branch reca_resume77
reca_retry78:
  s_sub_u32 s18, s18, 1
  s_cbranch_scc1 reca_retry78_to
  buffer_load_dwordx4 v[152:155], v26, s[4:7], s25 offen sc1
  buffer_load_dwordx4 v[156:159], v27, s[4:7], s25 offen sc1
  s_waitcnt vmcnt(1)
  v_cmp_eq_u32 vcc, -1, v152
  s_cbranch_vccnz reca_retry78
  s_branch reca_resume79
reca_retry78_to:
  s_mov_b32 s18, 0
  s_waitcnt vmcnt(0)
  s_branch reca_resume79
reca_retry80:
  s_sub_u32 s18, s18, 1
  s_cbranch_scc1 reca_retry80_to
  buffer_load_dwordx4 v[156:159], v27, s[4:7], s25 offen sc1
  s_waitcnt vmcnt(0)
  v_cmp_eq_u32 vcc, -1, v156
  s_cbranch_vccnz reca_retry80
  s_branch reca_resume81
reca_retry80_to:
  s_mov_b32 s18, 0
  s_waitcnt vmcnt(0)
  s_branch reca_resume81
reca_slow11:
  s_branch reca_gotmem86
reca_step85:
  s_and_b32 s34, s17, 3
  s_mul_i32 s20, s34, 10240
  s_add_u32 s20, s20, s38
  s_sleep 2
  buffer_load_dwordx4 v[128:131], v4, s[4:7], s20 offen sc1
  buffer_load_dwordx4 v[132:135], v4, s[4:7], s20 offen offset:1024 sc1
  buffer_load_dwordx4 v[136:139], v5, s[4:7], s20 offen sc1
  s_waitcnt vmcnt(2)
  v_max_u32 v29, v128, v130
  v_cmp_eq_u32 vcc, -1, v29
  s_cbranch_vccnz reca_retry88
reca_resume89:
  s_waitcnt vmcnt(1)
  v_max_u32 v29, v132, v134
  v_cmp_eq_u32 vcc, -1, v29
  ds_write_b128 v4, v[128:131]
  s_cbranch_vccnz reca_retry90
reca_resume91:
  s_waitcnt vmcnt(0)
  v_max_u32 v29, v136, v138
  v_cmp_eq_u32 vcc, -1, v29
  ds_write_b128 v4, v[132:135] offset:1024
  s_cbranch_vccnz reca_retry92
reca_resume93:
  ds_write_b128 v5, v[136:139]
  s_branch reca_gotmem287
reca_gotmem86:
  ds_write_b128 v4, v[128:131]
  ds_write_b128 v4, v[132:135] offset:1024
  ds_write_b128 v5, v[136:139]
reca_gotmem287:
  s_and_b32 s34, s17, 3
  s_mul_i32 s21, s34, 6144
  s_add_u32 s21, s21, s39
  s_mul_i32 s22, s34, 12288
  s_add_u32 s22, s22, s40
  s_mul_i32 s25, s34, 393216
  s_add_u32 s25, s25, s56
  s_add_u32 s35, s17, 1
  s_and_b32 s35, s35, 3
  s_mul_i32 s24, s35, 10240
  s_add_u32 s24, s24, s38
  s_waitcnt lgkmcnt(0)
  s_barrier
  ds_read_b128 v[128:131], v6 offset:0
  ds_read_b128 v[132:135], v6 offset:512
  ds_read_b128 v[136:139], v6 offset:1024
  ds_read_b128 v[140:143], v6 offset:1536
  ds_read_b128 v[144:147], v6 offset:2048
  ds_read_b128 v[148:151], v6 offset:2560
  ds_read_b128 v[152:155], v6 offset:3072
  ds_read_b128 v[156:159], v6 offset:3584
  ds_read_b128 v[160:163], v6 offset:4096
  ds_read_b128 v[164:167], v6 offset:4608
  ds_read_b128 v[168:171], v7 offset:0
  ds_read_b128 v[172:175], v7 offset:512
  ds_read_b128 v[176:179], v7 offset:1024
  s_waitcnt lgkmcnt(12)
  v_mfma_f32_16x16x32_bf16 v[44:47], a[0:3], v[128:131], 0
  ds_read_b128 v[180:183], v7 offset:1536
  s_waitcnt lgkmcnt(12)
  v_mfma_f32_16x16x32_bf16 v[44:47], a[4:7], v[132:135], v[44:47]
  ds_read_b128 v[184:187], v7 offset:2048
  s_waitcnt lgkmcnt(12)
  v_mfma_f32_16x16x32_bf16 v[44:47], a[8:11], v[136:139], v[44:47]
  ds_read_b128 v[188:191], v7 offset:2560
  s_waitcnt lgkmcnt(12)
  v_mfma_f32_16x16x32_bf16 v[44:47], a[12:15], v[140:143], v[44:47]
  ds_read_b128 v[192:195], v7 offset:3072
  s_waitcnt lgkmcnt(12)
  v_mfma_f32_16x16x32_bf16 v[44:47], a[16:19], v[144:147], v[44:47]
  ds_read_b128 v[196:199], v7 offset:3584
  s_waitcnt lgkmcnt(12)
  v_mfma_f32_16x16x32_bf16 v[44:47], a[20:23], v[148:151], v[44:47]
  ds_read_b128 v[200:203], v7 offset:4096
  s_waitcnt lgkmcnt(12)
  v_mfma_f32_16x16x32_bf16 v[44:47], a[24:27], v[152:155], v[44:47]
  ds_read_b128 v[204:207], v7 offset:4608
  s_waitcnt lgkmcnt(12)
  v_mfma_f32_16x16x32_bf16 v[44:47], a[28:31], v[156:159], v[44:47]
  s_waitcnt lgkmcnt(11)
  v_mfma_f32_16x16x32_bf16 v[44:47], a[32:35], v[160:163], v[44:47]
  s_waitcnt lgkmcnt(10)
  v_mfma_f32_16x16x32_bf16 v[44:47], a[36:39], v[164:167], v[44:47]
  s_waitcnt lgkmcnt(9)
  v_mfma_f32_16x16x32_bf16 v[44:47], a[40:43], v[168:171], v[44:47]
  s_waitcnt lgkmcnt(8)
  v_mfma_f32_16x16x32_bf16 v[44:47], a[44:47], v[172:175], v[44:47]
  s_waitcnt lgkmcnt(7)
  v_mfma_f32_16x16x32_bf16 v[44:47], a[48:51], v[176:179], v[44:47]
  s_waitcnt lgkmcnt(6)
  v_mfma_f32_16x16x32_bf16 v[44:47], a[52:55], v[180:183], v[44:47]
  s_waitcnt lgkmcnt(5)
  v_mfma_f32_16x16x32_bf16 v[44:47], a[56:59], v[184:187], v[44:47]
  s_waitcnt lgkmcnt(4)
  v_mfma_f32_16x16x32_bf16 v[44:47], a[60:63], v[188:191], v[44:47]
  s_waitcnt lgkmcnt(3)
  v_mfma_f32_16x16x32_bf16 v[44:47], a[64:67], v[192:195], v[44:47]
  s_waitcnt lgkmcnt(2)
  v_mfma_f32_16x16x32_bf16 v[44:47], a[68:71], v[196:199], v[44:47]
  s_waitcnt lgkmcnt(1)
  v_mfma_f32_16x16x32_bf16 v[44:47], a[72:75], v[200:203], v[44:47]
  s_waitcnt lgkmcnt(0)
  v_mfma_f32_16x16x32_bf16 v[44:47], a[76:79], v[204:207], v[44:47]
  v_mfma_f32_16x16x32_bf16 v[48:51], v[128:131], a[80:83], 0
  s_lshl_b32 s34, s17, 5
  s_add_u32 s34, s34, s15
  s_mul_i32 s34, s34, 3072
  s_lshl_b32 s35, s16, 9
  s_add_u32 s34, s34, s35
  s_add_u32 s30, s34, 113246208
  s_add_u32 s31, s34, 119537664
  v_cvt_pk_bf16_f32 v52, v44, v45
  v_cvt_pk_bf16_f32 v53, v46, v47
  buffer_store_dwordx2 v[52:53], v8, s[4:7], s21 offen sc1
  v_mfma_f32_16x16x32_bf16 v[48:51], v[132:135], a[84:87], v[48:51]
  v_mfma_f32_16x16x32_bf16 v[48:51], v[136:139], a[88:91], v[48:51]
  v_mfma_f32_16x16x32_bf16 v[48:51], v[140:143], a[92:95], v[48:51]
  v_mfma_f32_16x16x32_bf16 v[48:51], v[144:147], a[96:99], v[48:51]
  v_mfma_f32_16x16x32_bf16 v[48:51], v[148:151], a[100:103], v[48:51]
  v_mfma_f32_16x16x32_bf16 v[48:51], v[152:155], a[104:107], v[48:51]
  v_mfma_f32_16x16x32_bf16 v[48:51], v[156:159], a[108:111], v[48:51]
  v_mfma_f32_16x16x32_bf16 v[48:51], v[160:163], a[112:115], v[48:51]
  v_mfma_f32_16x16x32_bf16 v[48:51], v[164:167], a[116:119], v[48:51]
  s_cmp_eq_u32 s12, 3
  s_cbranch_scc1 reca_swave94
  s_nop 5
  ds_write_b128 v17, v[48:51]
  s_add_u32 s34, s17, 2
  s_and_b32 s34, s34, 3
  s_mul_i32 s26, s34, 10240
  s_add_u32 s26, s26, s38
  s_mul_i32 s27, s34, 6144
  s_add_u32 s27, s27, s39
  s_mul_i32 s28, s34, 12288
  s_add_u32 s28, s28, s40
  s_mul_i32 s29, s34, 393216
  s_add_u32 s29, s29, s56
  s_waitcnt lgkmcnt(0)
  s_barrier
  s_cmp_eq_u32 s17, 63
  s_cbranch_scc1 reca_last96
  buffer_store_dwordx2 v[32:33], v8, s[4:7], s27 offen sc1
  s_cmp_lg_u32 s12, 2
  s_cbranch_scc1 reca_b397
  buffer_store_dwordx2 v[52:53], v9, s[4:7], s30 offen
  buffer_store_dwordx2 v[32:33], v16, s[4:7], s26 offen sc1
  s_cmp_lg_u32 s14, 0
  s_cbranch_scc1 reca_b397
  v_mov_b32 v28, s17
  s_lshl_b32 s34, s13, 7
  s_add_u32 s34, s34, 1507328
  buffer_store_dword v28, v19, s[4:7], s34 offen sc1
  s_branch reca_b397
reca_last96:
  s_cmp_lg_u32 s12, 2
  s_cbranch_scc1 reca_exit1
  buffer_store_dwordx2 v[52:53], v9, s[4:7], s30 offen
  s_branch reca_exit1
reca_swave94:
  s_cmp_lg_u32 s17, 63
  s_cbranch_scc1 reca_vmst100
  s_barrier
  ds_read_b128 v[56:59], v1 offset:10240
  ds_read_b128 v[60:63], v1 offset:11264
  ds_read_b128 v[64:67], v1 offset:12288
  s_waitcnt lgkmcnt(0)
  v_add_f32 v56, v56, v64
  v_add_f32 v60, v60, v48
  v_add_f32 v57, v57, v65
  v_add_f32 v61, v61, v49
  v_add_f32 v58, v58, v66
  v_add_f32 v62, v62, v50
  v_add_f32 v59, v59, v67
  v_add_f32 v63, v63, v51
  v_cvt_pk_bf16_f32 v68, v56, v57
  v_cvt_pk_bf16_f32 v69, v58, v59
  v_cvt_pk_bf16_f32 v70, v60, v61
  v_cvt_pk_bf16_f32 v71, v62, v63
  buffer_store_dwordx2 v[52:53], v9, s[4:7], s30 offen
  buffer_store_dwordx2 v[68:69], v10, s[4:7], s31 offen
  buffer_store_dwordx2 v[70:71], v10, s[4:7], s31 offen offset:256
  s_branch reca_exit1
reca_vmst100:
  s_sleep 1
  buffer_load_dwordx4 v[208:211], v1, s[4:7], s21 offen offset:0 sc1
  buffer_load_dwordx4 v[212:215], v1, s[4:7], s21 offen offset:1024 sc1
  buffer_load_dwordx4 v[216:219], v1, s[4:7], s21 offen offset:2048 sc1
  buffer_load_dwordx4 v[220:223], v1, s[4:7], s21 offen offset:3072 sc1
  buffer_load_dwordx4 v[224:227], v2, s[4:7], s21 offen offset:0 sc1
  buffer_load_dwordx4 v[228:231], v2, s[4:7], s21 offen offset:1024 sc1
  s_waitcnt vmcnt(5)
  v_max_u32 v29, v208, v210
  v_cmp_eq_u32 vcc, -1, v29
  s_cbranch_vccnz reca_retry101
reca_resume102:
  s_waitcnt vmcnt(4)
  v_max_u32 v29, v212, v214
  v_cmp_eq_u32 vcc, -1, v29
  v_mfma_f32_16x16x32_bf16 v[76:79], a[120:123], v[208:211], 0
  v_mfma_f32_16x16x32_bf16 v[80:83], a[144:147], v[208:211], 0
  v_mfma_f32_16x16x32_bf16 v[72:75], v[208:211], v[208:211], v[40:43]
  s_cbranch_vccnz reca_retry103
reca_resume104:
  s_waitcnt vmcnt(3)
  v_max_u32 v29, v216, v218
  v_cmp_eq_u32 vcc, -1, v29
  v_mfma_f32_16x16x32_bf16 v[76:79], a[124:127], v[212:215], v[76:79]
  v_mfma_f32_16x16x32_bf16 v[80:83], a[148:151], v[212:215], v[80:83]
  v_mfma_f32_16x16x32_bf16 v[72:75], v[212:215], v[212:215], v[72:75]
  s_cbranch_vccnz reca_retry105
reca_resume106:
  s_waitcnt vmcnt(2)
  v_max_u32 v29, v220, v222
  v_cmp_eq_u32 vcc, -1, v29
  v_mfma_f32_16x16x32_bf16 v[76:79], a[128:131], v[216:219], v[76:79]
  v_mfma_f32_16x16x32_bf16 v[80:83], a[152:155], v[216:219], v[80:83]
  v_mfma_f32_16x16x32_bf16 v[72:75], v[216:219], v[216:219], v[72:75]
  s_cbranch_vccnz reca_retry107
reca_resume108:
  s_waitcnt vmcnt(1)
  v_max_u32 v29, v224, v226
  v_cmp_eq_u32 vcc, -1, v29
  v_mfma_f32_16x16x32_bf16 v[76:79], a[132:135], v[220:223], v[76:79]
  v_mfma_f32_16x16x32_bf16 v[80:83], a[156:159], v[220:223], v[80:83]
  v_mfma_f32_16x16x32_bf16 v[72:75], v[220:223], v[220:223], v[72:75]
  s_cbranch_vccnz reca_retry109
reca_resume110:
  s_waitcnt vmcnt(0)
  v_max_u32 v29, v228, v230
  v_cmp_eq_u32 vcc, -1, v29
  v_mfma_f32_16x16x32_bf16 v[76:79], a[136:139], v[224:227], v[76:79]
  v_mfma_f32_16x16x32_bf16 v[80:83], a[160:163], v[224:227], v[80:83]
  v_mfma_f32_16x16x32_bf16 v[72:75], v[224:227], v[224:227], v[72:75]
  s_cbranch_vccnz reca_retry111
reca_resume112:
  v_mfma_f32_16x16x32_bf16 v[76:79], a[140:143], v[228:231], v[76:79]
  v_mfma_f32_16x16x32_bf16 v[80:83], a[164:167], v[228:231], v[80:83]
  v_mfma_f32_16x16x32_bf16 v[72:75], v[228:231], v[228:231], v[72:75]
  s_barrier
  ds_read_b128 v[56:59], v1 offset:10240
  ds_read_b128 v[60:63], v1 offset:11264
  ds_read_b128 v[64:67], v1 offset:12288
  s_nop 1
  v_max3_f32 v28, v76, v77, v78
  v_max3_f32 v29, v80, v81, v82
  v_max3_f32 v28, v28, v79, v83
  v_max3_f32 v29, v29, v72, v73
  v_max3_f32 v28, v28, v74, v75
  v_max_f32 v28, v28, v29
  v_mov_b32 v29, v28
  s_nop 1
  v_permlane32_swap_b32 v28, v29
  v_max_f32 v28, v28, v29
  v_mov_b32 v29, v28
  s_nop 1
  v_permlane16_swap_b32 v28, v29
  v_max_f32 v28, v28, v29
  v_mul_f32 v28, s41, v28
  v_fma_f32 v76, v76, s41, -v28
  v_fma_f32 v77, v77, s41, -v28
  v_fma_f32 v78, v78, s41, -v28
  v_fma_f32 v79, v79, s41, -v28
  v_fma_f32 v80, v80, s41, -v28
  v_fma_f32 v81, v81, s41, -v28
  v_fma_f32 v82, v82, s41, -v28
  v_fma_f32 v83, v83, s41, -v28
  v_fma_f32 v72, v72, s41, -v28
  v_fma_f32 v73, v73, s41, -v28
  v_fma_f32 v74, v74, s41, -v28
  v_fma_f32 v75, v75, s41, -v28
  v_exp_f32 v76, v76
  v_exp_f32 v77, v77
  v_exp_f32 v78, v78
  v_exp_f32 v79, v79
  v_exp_f32 v80, v80
  v_exp_f32 v81, v81
  v_exp_f32 v82, v82
  v_exp_f32 v83, v83
  v_cvt_pk_bf16_f32 v84, v76, v77
  v_cvt_pk_bf16_f32 v85, v78, v79
  v_cvt_pk_bf16_f32 v86, v80, v81
  v_cvt_pk_bf16_f32 v87, v82, v83
  v_exp_f32 v72, v72
  v_exp_f32 v73, v73
  v_mfma_f32_16x16x32_bf16 v[100:103], v[36:39], v[84:87], 0
  v_exp_f32 v74, v74
  v_exp_f32 v75, v75
  v_mfma_f32_16x16x32_bf16 v[92:95], a[168:171], v[84:87], 0
  v_cvt_pk_bf16_f32 v88, v72, v73
  v_cvt_pk_bf16_f32 v89, v74, v75
  v_mfma_f32_16x16x32_bf16 v[96:99], a[172:175], v[84:87], 0
  s_waitcnt lgkmcnt(0)
  v_mfma_f32_16x16x16_bf16 v[100:103], v[36:37], v[88:89], v[100:103]
  v_add_f32 v56, v56, v64
  v_add_f32 v60, v60, v48
  v_add_f32 v57, v57, v65
  v_add_f32 v61, v61, v49
  v_add_f32 v58, v58, v66
  v_add_f32 v62, v62, v50
  v_add_f32 v59, v59, v67
  v_add_f32 v63, v63, v51
  v_cvt_pk_bf16_f32 v68, v56, v57
  v_cvt_pk_bf16_f32 v69, v58, v59
  v_cvt_pk_bf16_f32 v70, v60, v61
  v_cvt_pk_bf16_f32 v71, v62, v63
  v_mfma_f32_16x16x16_bf16 v[92:95], v[68:69], v[88:89], v[92:95]
  v_rcp_f32 v28, v100
  v_mfma_f32_16x16x16_bf16 v[96:99], v[70:71], v[88:89], v[96:99]
  v_mov_b32 v29, v28
  s_nop 4
  v_pk_mul_f32 v[92:93], v[92:93], v[28:29]
  v_pk_mul_f32 v[94:95], v[94:95], v[28:29]
  v_pk_mul_f32 v[96:97], v[96:97], v[28:29]
  v_pk_mul_f32 v[98:99], v[98:99], v[28:29]
  v_cvt_pk_bf16_f32 v104, v92, v93
  v_cvt_pk_bf16_f32 v105, v94, v95
  v_cvt_pk_bf16_f32 v106, v96, v97
  v_cvt_pk_bf16_f32 v107, v98, v99
  buffer_store_dwordx4 v[104:107], v11, s[4:7], s22 offen sc1
reca_b397:
  s_barrier
  s_cmp_ge_u32 s12, 2
  s_cbranch_scc1 reca_notg2113
  s_sleep 3
  buffer_load_dwordx4 v[128:131], v12, s[4:7], s22 offen offset:0 sc1
  buffer_load_dwordx4 v[132:135], v12, s[4:7], s22 offen offset:1024 sc1
  buffer_load_dwordx4 v[136:139], v12, s[4:7], s22 offen offset:2048 sc1
  buffer_load_dwordx4 v[140:143], v12, s[4:7], s22 offen offset:3072 sc1
  buffer_load_dwordx4 v[144:147], v13, s[4:7], s22 offen offset:0 sc1
  buffer_load_dwordx4 v[148:151], v13, s[4:7], s22 offen offset:1024 sc1
  buffer_load_dwordx4 v[152:155], v13, s[4:7], s22 offen offset:2048 sc1
  buffer_load_dwordx4 v[156:159], v13, s[4:7], s22 offen offset:3072 sc1
  buffer_load_dwordx4 v[160:163], v14, s[4:7], s22 offen offset:0 sc1
  buffer_load_dwordx4 v[164:167], v14, s[4:7], s22 offen offset:1024 sc1
  buffer_load_dwordx4 v[168:171], v14, s[4:7], s22 offen offset:2048 sc1
  buffer_load_dwordx4 v[172:175], v14, s[4:7], s22 offen offset:3072 sc1
  s_waitcnt vmcnt(11)
  v_cmp_eq_u32 vcc, -1, v128
  s_cbranch_vccnz reca_retry114
reca_resume115:
  s_waitcnt vmcnt(10)
  v_cmp_eq_u32 vcc, -1, v132
  v_mfma_f32_16x16x32_bf16 v[108:111], a[120:123], v[128:131], 0
  v_mfma_f32_16x16x32_bf16 v[112:115], a[124:127], v[128:131], 0
  s_cbranch_vccnz reca_retry116
reca_resume117:
  s_waitcnt vmcnt(9)
  v_cmp_eq_u32 vcc, -1, v136
  v_mfma_f32_16x16x32_bf16 v[108:111], a[128:131], v[132:135], v[108:111]
  v_mfma_f32_16x16x32_bf16 v[112:115], a[132:135], v[132:135], v[112:115]
  s_cbranch_vccnz reca_retry118
reca_resume119:
  s_waitcnt vmcnt(8)
  v_cmp_eq_u32 vcc, -1, v140
  v_mfma_f32_16x16x32_bf16 v[108:111], a[136:139], v[136:139], v[108:111]
  v_mfma_f32_16x16x32_bf16 v[112:115], a[140:143], v[136:139], v[112:115]
  s_cbranch_vccnz reca_retry120
reca_resume121:
  s_waitcnt vmcnt(7)
  v_cmp_eq_u32 vcc, -1, v144
  v_mfma_f32_16x16x32_bf16 v[108:111], a[144:147], v[140:143], v[108:111]
  v_mfma_f32_16x16x32_bf16 v[112:115], a[148:151], v[140:143], v[112:115]
  s_cbranch_vccnz reca_retry122
reca_resume123:
  s_waitcnt vmcnt(6)
  v_cmp_eq_u32 vcc, -1, v148
  v_mfma_f32_16x16x32_bf16 v[108:111], a[152:155], v[144:147], v[108:111]
  v_mfma_f32_16x16x32_bf16 v[112:115], a[156:159], v[144:147], v[112:115]
  s_cbranch_vccnz reca_retry124
reca_resume125:
  s_waitcnt vmcnt(5)
  v_cmp_eq_u32 vcc, -1, v152
  v_mfma_f32_16x16x32_bf16 v[108:111], a[160:163], v[148:151], v[108:111]
  v_mfma_f32_16x16x32_bf16 v[112:115], a[164:167], v[148:151], v[112:115]
  s_cbranch_vccnz reca_retry126
reca_resume127:
  s_waitcnt vmcnt(4)
  v_cmp_eq_u32 vcc, -1, v156
  v_mfma_f32_16x16x32_bf16 v[108:111], a[168:171], v[152:155], v[108:111]
  v_mfma_f32_16x16x32_bf16 v[112:115], a[172:175], v[152:155], v[112:115]
  s_cbranch_vccnz reca_retry128
reca_resume129:
  s_waitcnt vmcnt(3)
  v_cmp_eq_u32 vcc, -1, v160
  v_mfma_f32_16x16x32_bf16 v[108:111], a[176:179], v[156:159], v[108:111]
  v_mfma_f32_16x16x32_bf16 v[112:115], a[180:183], v[156:159], v[112:115]
  s_cbranch_vccnz reca_retry130
reca_resume131:
  s_waitcnt vmcnt(2)
  v_cmp_eq_u32 vcc, -1, v164
  v_mfma_f32_16x16x32_bf16 v[108:111], a[184:187], v[160:163], v[108:111]
  v_mfma_f32_16x16x32_bf16 v[112:115], a[188:191], v[160:163], v[112:115]
  s_cbranch_vccnz reca_retry132
reca_resume133:
  s_waitcnt vmcnt(1)
  v_cmp_eq_u32 vcc, -1, v168
  v_mfma_f32_16x16x32_bf16 v[108:111], a[192:195], v[164:167], v[108:111]
  v_mfma_f32_16x16x32_bf16 v[112:115], a[196:199], v[164:167], v[112:115]
  s_cbranch_vccnz reca_retry134
reca_resume135:
  s_waitcnt vmcnt(0)
  v_cmp_eq_u32 vcc, -1, v172
  v_mfma_f32_16x16x32_bf16 v[108:111], a[200:203], v[168:171], v[108:111]
  v_mfma_f32_16x16x32_bf16 v[112:115], a[204:207], v[168:171], v[112:115]
  s_cbranch_vccnz reca_retry136
reca_resume137:
  v_mfma_f32_16x16x32_bf16 v[108:111], a[208:211], v[172:175], v[108:111]
  v_mfma_f32_16x16x32_bf16 v[112:115], a[212:215], v[172:175], v[112:115]
  s_nop 7
  v_add_f32_dpp v116, v112, v108 row_ror:8 row_mask:0xf bank_mask:0xf
  v_add_f32_dpp v117, v113, v109 row_ror:8 row_mask:0xf bank_mask:0xf
  v_add_f32_dpp v118, v114, v110 row_ror:8 row_mask:0xf bank_mask:0xf
  v_add_f32_dpp v119, v115, v111 row_ror:8 row_mask:0xf bank_mask:0xf
  buffer_store_dwordx4 v[116:119], v15, s[4:7], s25 offen sc1
  buffer_store_dwordx4 v[116:119], v232, s[4:7], s25 offen sc1
  buffer_store_dwordx4 v[32:35], v15, s[4:7], s29 offen sc1
  buffer_store_dwordx4 v[32:35], v232, s[4:7], s29 offen sc1
  s_branch reca_b498
reca_notg2113:
  s_cmp_lg_u32 s12, 3
  s_cbranch_scc1 reca_b498
  s_add_u32 s34, s17, 2
  s_and_b32 s34, s34, 3
  s_mul_i32 s26, s34, 10240
  s_add_u32 s26, s26, s38
  s_mul_i32 s27, s34, 6144
  s_add_u32 s27, s27, s39
  s_mul_i32 s28, s34, 12288
  s_add_u32 s28, s28, s40
  s_mul_i32 s29, s34, 393216
  s_add_u32 s29, s29, s56
  buffer_store_dwordx2 v[32:33], v8, s[4:7], s27 offen sc1
  buffer_store_dwordx4 v[32:35], v11, s[4:7], s28 offen sc1
reca_b498:
  s_barrier
  s_cmp_lg_u32 s12, 2
  s_cbranch_scc1 reca_not2138
  s_sleep 8
  buffer_load_dwordx4 v[128:131], v20, s[4:7], s25 offen sc1
  buffer_load_dwordx4 v[132:135], v21, s[4:7], s25 offen sc1
  buffer_load_dwordx4 v[136:139], v22, s[4:7], s25 offen sc1
  buffer_load_dwordx4 v[140:143], v23, s[4:7], s25 offen sc1
  buffer_load_dwordx4 v[144:147], v24, s[4:7], s25 offen sc1
  buffer_load_dwordx4 v[148:151], v25, s[4:7], s25 offen sc1
  buffer_load_dwordx4 v[152:155], v26, s[4:7], s25 offen sc1
  buffer_load_dwordx4 v[156:159], v27, s[4:7], s25 offen sc1
  s_waitcnt vmcnt(7)
  v_cmp_eq_u32 vcc, -1, v128
  s_cbranch_vccnz reca_retry139
reca_resume140:
  s_waitcnt vmcnt(6)
  v_cmp_eq_u32 vcc, -1, v132
  s_cbranch_vccnz reca_retry141
reca_resume142:
  s_waitcnt vmcnt(5)
  v_cmp_eq_u32 vcc, -1, v136
  v_pk_add_f32 v[116:117], v[128:129], v[132:133]
  v_pk_add_f32 v[118:119], v[130:131], v[134:135]
  s_cbranch_vccnz reca_retry143
reca_resume144:
  s_waitcnt vmcnt(4)
  v_cmp_eq_u32 vcc, -1, v140
  v_pk_add_f32 v[116:117], v[116:117], v[136:137]
  v_pk_add_f32 v[118:119], v[118:119], v[138:139]
  s_cbranch_vccnz reca_retry145
reca_resume146:
  s_waitcnt vmcnt(3)
  v_cmp_eq_u32 vcc, -1, v144
  v_pk_add_f32 v[116:117], v[116:117], v[140:141]
  v_pk_add_f32 v[118:119], v[118:119], v[142:143]
  s_cbranch_vccnz reca_retry147
reca_resume148:
  s_waitcnt vmcnt(2)
  v_cmp_eq_u32 vcc, -1, v148
  v_pk_add_f32 v[116:117], v[116:117], v[144:145]
  v_pk_add_f32 v[118:119], v[118:119], v[146:147]
  s_cbranch_vccnz reca_retry149
reca_resume150:
  s_waitcnt vmcnt(1)
  v_cmp_eq_u32 vcc, -1, v152
  v_pk_add_f32 v[116:117], v[116:117], v[148:149]
  v_pk_add_f32 v[118:119], v[118:119], v[150:151]
  s_cbranch_vccnz reca_retry151
reca_resume152:
  s_waitcnt vmcnt(0)
  v_cmp_eq_u32 vcc, -1, v156
  v_pk_add_f32 v[116:117], v[116:117], v[152:153]
  v_pk_add_f32 v[118:119], v[118:119], v[154:155]
  s_cbranch_vccnz reca_retry153
reca_resume154:
  v_pk_add_f32 v[116:117], v[116:117], v[156:157]
  v_pk_add_f32 v[118:119], v[118:119], v[158:159]
  v_cvt_pk_bf16_f32 v132, v116, v117
  v_cvt_pk_bf16_f32 v133, v118, v119
  buffer_store_dwordx2 v[132:133], v16, s[4:7], s24 offen sc1
  s_branch reca_b599
reca_not2138:
  s_cmp_lg_u32 s12, 3
  s_cbranch_scc1 reca_b599
  s_add_u32 s36, s17, 1
  s_cmp_ge_u32 s36, 63
  s_cbranch_scc1 reca_nopf155
  s_add_u32 s37, s36, 1
reca_pf156:
  buffer_load_dword v28, v233, s[4:7], 0 offen sc1
  s_waitcnt vmcnt(0)
  v_cmp_gt_i32 vcc, s37, v28
  s_cbranch_vccz reca_pfok157
  s_sleep 1
  s_sub_u32 s18, s18, 1
  s_cbranch_scc0 reca_pf156
  s_mov_b32 s18, 0
reca_pfok157:
  s_lshl_b32 s34, s15, 6
  s_add_u32 s34, s34, s36
  s_mul_i32 s34, s34, 12288
  s_add_u32 s32, s34, 37748736
  s_lshl_b32 s35, s16, 11
  s_add_u32 s34, s34, s35
  s_add_u32 s33, s34, 62914560
  buffer_load_dwordx4 a[120:123], v1, s[4:7], s32 offen offset:0 sc1
  buffer_load_dwordx4 a[124:127], v1, s[4:7], s32 offen offset:1024 sc1
  buffer_load_dwordx4 a[128:131], v1, s[4:7], s32 offen offset:2048 sc1
  buffer_load_dwordx4 a[132:135], v1, s[4:7], s32 offen offset:3072 sc1
  buffer_load_dwordx4 a[136:139], v2, s[4:7], s32 offen offset:0 sc1
  buffer_load_dwordx4 a[140:143], v2, s[4:7], s32 offen offset:1024 sc1
  buffer_load_dwordx4 a[144:147], v2, s[4:7], s32 offen offset:2048 sc1
  buffer_load_dwordx4 a[148:151], v2, s[4:7], s32 offen offset:3072 sc1
  buffer_load_dwordx4 a[152:155], v3, s[4:7], s32 offen offset:0 sc1
  buffer_load_dwordx4 a[156:159], v3, s[4:7], s32 offen offset:1024 sc1
  buffer_load_dwordx4 a[160:163], v3, s[4:7], s32 offen offset:2048 sc1
  buffer_load_dwordx4 a[164:167], v3, s[4:7], s32 offen offset:3072 sc1
  buffer_load_dwordx4 a[168:171], v1, s[4:7], s33 offen offset:0 sc1
  buffer_load_dwordx4 a[172:175], v1, s[4:7], s33 offen offset:1024 sc1
reca_nopf155:
  buffer_store_dwordx2 v[52:53], v9, s[4:7], s30 offen
  buffer_store_dwordx2 v[68:69], v10, s[4:7], s31 offen
  buffer_store_dwordx2 v[70:71], v10, s[4:7], s31 offen offset:256
reca_b599:
  s_barrier
  s_add_u32 s17, s17, 1
  s_branch reca_step85
reca_retry88:
  s_sub_u32 s18, s18, 1
  s_cbranch_scc1 reca_retry88_to
  buffer_load_dwordx4 v[128:131], v4, s[4:7], s20 offen sc1
  buffer_load_dwordx4 v[132:135], v4, s[4:7], s20 offen offset:1024 sc1
  buffer_load_dwordx4 v[136:139], v5, s[4:7], s20 offen sc1
  s_waitcnt vmcnt(2)
  v_max_u32 v29, v128, v130
  v_cmp_eq_u32 vcc, -1, v29
  s_cbranch_vccnz reca_retry88
  s_branch reca_resume89
reca_retry88_to:
  s_mov_b32 s18, 0
  s_waitcnt vmcnt(0)
  s_branch reca_resume89
reca_retry90:
  s_sub_u32 s18, s18, 1
  s_cbranch_scc1 reca_retry90_to
  buffer_load_dwordx4 v[132:135], v4, s[4:7], s20 offen offset:1024 sc1
  buffer_load_dwordx4 v[136:139], v5, s[4:7], s20 offen sc1
  s_waitcnt vmcnt(1)
  v_max_u32 v29, v132, v134
  v_cmp_eq_u32 vcc, -1, v29
  s_cbranch_vccnz reca_retry90
  s_branch reca_resume91
reca_retry90_to:
  s_mov_b32 s18, 0
  s_waitcnt vmcnt(0)
  s_branch reca_resume91
reca_retry92:
  s_sub_u32 s18, s18, 1
  s_cbranch_scc1 reca_retry92_to
  buffer_load_dwordx4 v[136:139], v5, s[4:7], s20 offen sc1
  s_waitcnt vmcnt(0)
  v_max_u32 v29, v136, v138
  v_cmp_eq_u32 vcc, -1, v29
  s_cbranch_vccnz reca_retry92
  s_branch reca_resume93
reca_retry92_to:
  s_mov_b32 s18, 0
  s_waitcnt vmcnt(0)
  s_branch reca_resume93
reca_retry101:
  s_sub_u32 s18, s18, 1
  s_cbranch_scc1 reca_retry101_to
  buffer_load_dwordx4 v[208:211], v1, s[4:7], s21 offen offset:0 sc1
  buffer_load_dwordx4 v[212:215], v1, s[4:7], s21 offen offset:1024 sc1
  buffer_load_dwordx4 v[216:219], v1, s[4:7], s21 offen offset:2048 sc1
  buffer_load_dwordx4 v[220:223], v1, s[4:7], s21 offen offset:3072 sc1
  buffer_load_dwordx4 v[224:227], v2, s[4:7], s21 offen offset:0 sc1
  buffer_load_dwordx4 v[228:231], v2, s[4:7], s21 offen offset:1024 sc1
  s_waitcnt vmcnt(5)
  v_max_u32 v29, v208, v210
  v_cmp_eq_u32 vcc, -1, v29
  s_cbranch_vccnz reca_retry101
  s_branch reca_resume102
reca_retry101_to:
  s_mov_b32 s18, 0
  s_waitcnt vmcnt(0)
  s_branch reca_resume102
reca_retry103:
  s_sub_u32 s18, s18, 1
  s_cbranch_scc1 reca_retry103_to
  buffer_load_dwordx4 v[212:215], v1, s[4:7], s21 offen offset:1024 sc1
  buffer_load_dwordx4 v[216:219], v1, s[4:7], s21 offen offset:2048 sc1
  buffer_load_dwordx4 v[220:223], v1, s[4:7], s21 offen offset:3072 sc1
  buffer_load_dwordx4 v[224:227], v2, s[4:7], s21 offen offset:0 sc1
  buffer_load_dwordx4 v[228:231], v2, s[4:7], s21 offen offset:1024 sc1
  s_waitcnt vmcnt(4)
  v_max_u32 v29, v212, v214
  v_cmp_eq_u32 vcc, -1, v29
  s_cbranch_vccnz reca_retry103
  s_branch reca_resume104
reca_retry103_to:
  s_mov_b32 s18, 0
  s_waitcnt vmcnt(0)
  s_branch reca_resume104
reca_retry105:
  s_sub_u32 s18, s18, 1
  s_cbranch_scc1 reca_retry105_to
  buffer_load_dwordx4 v[216:219], v1, s[4:7], s21 offen offset:2048 sc1
  buffer_load_dwordx4 v[220:223], v1, s[4:7], s21 offen offset:3072 sc1
  buffer_load_dwordx4 v[224:227], v2, s[4:7], s21 offen offset:0 sc1
  buffer_load_dwordx4 v[228:231], v2, s[4:7], s21 offen offset:1024 sc1
  s_waitcnt vmcnt(3)
  v_max_u32 v29, v216, v218
  v_cmp_eq_u32 vcc, -1, v29
  s_cbranch_vccnz reca_retry105
  s_branch reca_resume106
reca_retry105_to:
  s_mov_b32 s18, 0
  s_waitcnt vmcnt(0)
  s_branch reca_resume106
reca_retry107:
  s_sub_u32 s18, s18, 1
  s_cbranch_scc1 reca_retry107_to
  buffer_load_dwordx4 v[220:223], v1, s[4:7], s21 offen offset:3072 sc1
  buffer_load_dwordx4 v[224:227], v2, s[4:7], s21 offen offset:0 sc1
  buffer_load_dwordx4 v[228:231], v2, s[4:7], s21 offen offset:1024 sc1
  s_waitcnt vmcnt(2)
  v_max_u32 v29, v220, v222
  v_cmp_eq_u32 vcc, -1, v29
  s_cbranch_vccnz reca_retry107
  s_branch reca_resume108
reca_retry107_to:
  s_mov_b32 s18, 0
  s_waitcnt vmcnt(0)
  s_branch reca_resume108
reca_retry109:
  s_sub_u32 s18, s18, 1
  s_cbranch_scc1 reca_retry109_to
  buffer_load_dwordx4 v[224:227], v2, s[4:7], s21 offen offset:0 sc1
  buffer_load_dwordx4 v[228:231], v2, s[4:7], s21 offen offset:1024 sc1
  s_waitcnt vmcnt(1)
  v_max_u32 v29, v224, v226
  v_cmp_eq_u32 vcc, -1, v29
  s_cbranch_vccnz reca_retry109
  s_branch reca_resume110
reca_retry109_to:
  s_mov_b32 s18, 0
  s_waitcnt vmcnt(0)
  s_branch reca_resume110
reca_retry111:
  s_sub_u32 s18, s18, 1
  s_cbranch_scc1 reca_retry111_to
  buffer_load_dwordx4 v[228:231], v2, s[4:7], s21 offen offset:1024 sc1
  s_waitcnt vmcnt(0)
  v_max_u32 v29, v228, v230
  v_cmp_eq_u32 vcc, -1, v29
  s_cbranch_vccnz reca_retry111
  s_branch reca_resume112
reca_retry111_to:
  s_mov_b32 s18, 0
  s_waitcnt vmcnt(0)
  s_branch reca_resume112
reca_retry114:
  s_sub_u32 s18, s18, 1
  s_cbranch_scc1 reca_retry114_to
  buffer_load_dwordx4 v[128:131], v12, s[4:7], s22 offen offset:0 sc1
  buffer_load_dwordx4 v[132:135], v12, s[4:7], s22 offen offset:1024 sc1
  buffer_load_dwordx4 v[136:139], v12, s[4:7], s22 offen offset:2048 sc1
  buffer_load_dwordx4 v[140:143], v12, s[4:7], s22 offen offset:3072 sc1
  buffer_load_dwordx4 v[144:147], v13, s[4:7], s22 offen offset:0 sc1
  buffer_load_dwordx4 v[148:151], v13, s[4:7], s22 offen offset:1024 sc1
  buffer_load_dwordx4 v[152:155], v13, s[4:7], s22 offen offset:2048 sc1
  buffer_load_dwordx4 v[156:159], v13, s[4:7], s22 offen offset:3072 sc1
  buffer_load_dwordx4 v[160:163], v14, s[4:7], s22 offen offset:0 sc1
  buffer_load_dwordx4 v[164:167], v14, s[4:7], s22 offen offset:1024 sc1
  buffer_load_dwordx4 v[168:171], v14, s[4:7], s22 offen offset:2048 sc1
  buffer_load_dwordx4 v[172:175], v14, s[4:7], s22 offen offset:3072 sc1
  s_waitcnt vmcnt(11)
  v_cmp_eq_u32 vcc, -1, v128
  s_cbranch_vccnz reca_retry114
  s_branch reca_resume115
reca_retry114_to:
  s_mov_b32 s18, 0
  s_waitcnt vmcnt(0)
  s_branch reca_resume115
reca_retry116:
  s_sub_u32 s18, s18, 1
  s_cbranch_scc1 reca_retry116_to
  buffer_load_dwordx4 v[132:135], v12, s[4:7], s22 offen offset:1024 sc1
  buffer_load_dwordx4 v[136:139], v12, s[4:7], s22 offen offset:2048 sc1
  buffer_load_dwordx4 v[140:143], v12, s[4:7], s22 offen offset:3072 sc1
  buffer_load_dwordx4 v[144:147], v13, s[4:7], s22 offen offset:0 sc1
  buffer_load_dwordx4 v[148:151], v13, s[4:7], s22 offen offset:1024 sc1
  buffer_load_dwordx4 v[152:155], v13, s[4:7], s22 offen offset:2048 sc1
  buffer_load_dwordx4 v[156:159], v13, s[4:7], s22 offen offset:3072 sc1
  buffer_load_dwordx4 v[160:163], v14, s[4:7], s22 offen offset:0 sc1
  buffer_load_dwordx4 v[164:167], v14, s[4:7], s22 offen offset:1024 sc1
  buffer_load_dwordx4 v[168:171], v14, s[4:7], s22 offen offset:2048 sc1
  buffer_load_dwordx4 v[172:175], v14, s[4:7], s22 offen offset:3072 sc1
  s_waitcnt vmcnt(10)
  v_cmp_eq_u32 vcc, -1, v132
  s_cbranch_vccnz reca_retry116
  s_branch reca_resume117
reca_retry116_to:
  s_mov_b32 s18, 0
  s_waitcnt vmcnt(0)
  s_branch reca_resume117
reca_retry118:
  s_sub_u32 s18, s18, 1
  s_cbranch_scc1 reca_retry118_to
  buffer_load_dwordx4 v[136:139], v12, s[4:7], s22 offen offset:2048 sc1
  buffer_load_dwordx4 v[140:143], v12, s[4:7], s22 offen offset:3072 sc1
  buffer_load_dwordx4 v[144:147], v13, s[4:7], s22 offen offset:0 sc1
  buffer_load_dwordx4 v[148:151], v13, s[4:7], s22 offen offset:1024 sc1
  buffer_load_dwordx4 v[152:155], v13, s[4:7], s22 offen offset:2048 sc1
  buffer_load_dwordx4 v[156:159], v13, s[4:7], s22 offen offset:3072 sc1
  buffer_load_dwordx4 v[160:163], v14, s[4:7], s22 offen offset:0 sc1
  buffer_load_dwordx4 v[164:167], v14, s[4:7], s22 offen offset:1024 sc1
  buffer_load_dwordx4 v[168:171], v14, s[4:7], s22 offen offset:2048 sc1
  buffer_load_dwordx4 v[172:175], v14, s[4:7], s22 offen offset:3072 sc1
  s_waitcnt vmcnt(9)
  v_cmp_eq_u32 vcc, -1, v136
  s_cbranch_vccnz reca_retry118
  s_branch reca_resume119
reca_retry118_to:
  s_mov_b32 s18, 0
  s_waitcnt vmcnt(0)
  s_branch reca_resume119
reca_retry120:
  s_sub_u32 s18, s18, 1
  s_cbranch_scc1 reca_retry120_to
  buffer_load_dwordx4 v[140:143], v12, s[4:7], s22 offen offset:3072 sc1
  buffer_load_dwordx4 v[144:147], v13, s[4:7], s22 offen offset:0 sc1
  buffer_load_dwordx4 v[148:151], v13, s[4:7], s22 offen offset:1024 sc1
  buffer_load_dwordx4 v[152:155], v13, s[4:7], s22 offen offset:2048 sc1
  buffer_load_dwordx4 v[156:159], v13, s[4:7], s22 offen offset:3072 sc1
  buffer_load_dwordx4 v[160:163], v14, s[4:7], s22 offen offset:0 sc1
  buffer_load_dwordx4 v[164:167], v14, s[4:7], s22 offen offset:1024 sc1
  buffer_load_dwordx4 v[168:171], v14, s[4:7], s22 offen offset:2048 sc1
  buffer_load_dwordx4 v[172:175], v14, s[4:7], s22 offen offset:3072 sc1
  s_waitcnt vmcnt(8)
  v_cmp_eq_u32 vcc, -1, v140
  s_cbranch_vccnz reca_retry120
  s_branch reca_resume121
reca_retry120_to:
  s_mov_b32 s18, 0
  s_waitcnt vmcnt(0)
  s_branch reca_resume121
reca_retry122:
  s_sub_u32 s18, s18, 1
  s_cbranch_scc1 reca_retry122_to
  buffer_load_dwordx4 v[144:147], v13, s[4:7], s22 offen offset:0 sc1
  buffer_load_dwordx4 v[148:151], v13, s[4:7], s22 offen offset:1024 sc1
  buffer_load_dwordx4 v[152:155], v13, s[4:7], s22 offen offset:2048 sc1
  buffer_load_dwordx4 v[156:159], v13, s[4:7], s22 offen offset:3072 sc1
  buffer_load_dwordx4 v[160:163], v14, s[4:7], s22 offen offset:0 sc1
  buffer_load_dwordx4 v[164:167], v14, s[4:7], s22 offen offset:1024 sc1
  buffer_load_dwordx4 v[168:171], v14, s[4:7], s22 offen offset:2048 sc1
  buffer_load_dwordx4 v[172:175], v14, s[4:7], s22 offen offset:3072 sc1
  s_waitcnt vmcnt(7)
  v_cmp_eq_u32 vcc, -1, v144
  s_cbranch_vccnz reca_retry122
  s_branch reca_resume123
reca_retry122_to:
  s_mov_b32 s18, 0
  s_waitcnt vmcnt(0)
  s_branch reca_resume123
reca_retry124:
  s_sub_u32 s18, s18, 1
  s_cbranch_scc1 reca_retry124_to
  buffer_load_dwordx4 v[148:151], v13, s[4:7], s22 offen offset:1024 sc1
  buffer_load_dwordx4 v[152:155], v13, s[4:7], s22 offen offset:2048 sc1
  buffer_load_dwordx4 v[156:159], v13, s[4:7], s22 offen offset:3072 sc1
  buffer_load_dwordx4 v[160:163], v14, s[4:7], s22 offen offset:0 sc1
  buffer_load_dwordx4 v[164:167], v14, s[4:7], s22 offen offset:1024 sc1
  buffer_load_dwordx4 v[168:171], v14, s[4:7], s22 offen offset:2048 sc1
  buffer_load_dwordx4 v[172:175], v14, s[4:7], s22 offen offset:3072 sc1
  s_waitcnt vmcnt(6)
  v_cmp_eq_u32 vcc, -1, v148
  s_cbranch_vccnz reca_retry124
  s_branch reca_resume125
reca_retry124_to:
  s_mov_b32 s18, 0
  s_waitcnt vmcnt(0)
  s_branch reca_resume125
reca_retry126:
  s_sub_u32 s18, s18, 1
  s_cbranch_scc1 reca_retry126_to
  buffer_load_dwordx4 v[152:155], v13, s[4:7], s22 offen offset:2048 sc1
  buffer_load_dwordx4 v[156:159], v13, s[4:7], s22 offen offset:3072 sc1
  buffer_load_dwordx4 v[160:163], v14, s[4:7], s22 offen offset:0 sc1
  buffer_load_dwordx4 v[164:167], v14, s[4:7], s22 offen offset:1024 sc1
  buffer_load_dwordx4 v[168:171], v14, s[4:7], s22 offen offset:2048 sc1
  buffer_load_dwordx4 v[172:175], v14, s[4:7], s22 offen offset:3072 sc1
  s_waitcnt vmcnt(5)
  v_cmp_eq_u32 vcc, -1, v152
  s_cbranch_vccnz reca_retry126
  s_branch reca_resume127
reca_retry126_to:
  s_mov_b32 s18, 0
  s_waitcnt vmcnt(0)
  s_branch reca_resume127
reca_retry128:
  s_sub_u32 s18, s18, 1
  s_cbranch_scc1 reca_retry128_to
  buffer_load_dwordx4 v[156:159], v13, s[4:7], s22 offen offset:3072 sc1
  buffer_load_dwordx4 v[160:163], v14, s[4:7], s22 offen offset:0 sc1
  buffer_load_dwordx4 v[164:167], v14, s[4:7], s22 offen offset:1024 sc1
  buffer_load_dwordx4 v[168:171], v14, s[4:7], s22 offen offset:2048 sc1
  buffer_load_dwordx4 v[172:175], v14, s[4:7], s22 offen offset:3072 sc1
  s_waitcnt vmcnt(4)
  v_cmp_eq_u32 vcc, -1, v156
  s_cbranch_vccnz reca_retry128
  s_branch reca_resume129
reca_retry128_to:
  s_mov_b32 s18, 0
  s_waitcnt vmcnt(0)
  s_branch reca_resume129
reca_retry130:
  s_sub_u32 s18, s18, 1
  s_cbranch_scc1 reca_retry130_to
  buffer_load_dwordx4 v[160:163], v14, s[4:7], s22 offen offset:0 sc1
  buffer_load_dwordx4 v[164:167], v14, s[4:7], s22 offen offset:1024 sc1
  buffer_load_dwordx4 v[168:171], v14, s[4:7], s22 offen offset:2048 sc1
  buffer_load_dwordx4 v[172:175], v14, s[4:7], s22 offen offset:3072 sc1
  s_waitcnt vmcnt(3)
  v_cmp_eq_u32 vcc, -1, v160
  s_cbranch_vccnz reca_retry130
  s_branch reca_resume131
reca_retry130_to:
  s_mov_b32 s18, 0
  s_waitcnt vmcnt(0)
  s_branch reca_resume131
reca_retry132:
  s_sub_u32 s18, s18, 1
  s_cbranch_scc1 reca_retry132_to
  buffer_load_dwordx4 v[164:167], v14, s[4:7], s22 offen offset:1024 sc1
  buffer_load_dwordx4 v[168:171], v14, s[4:7], s22 offen offset:2048 sc1
  buffer_load_dwordx4 v[172:175], v14, s[4:7], s22 offen offset:3072 sc1
  s_waitcnt vmcnt(2)
  v_cmp_eq_u32 vcc, -1, v164
  s_cbranch_vccnz reca_retry132
  s_branch reca_resume133
reca_retry132_to:
  s_mov_b32 s18, 0
  s_waitcnt vmcnt(0)
  s_branch reca_resume133
reca_retry134:
  s_sub_u32 s18, s18, 1
  s_cbranch_scc1 reca_retry134_to
  buffer_load_dwordx4 v[168:171], v14, s[4:7], s22 offen offset:2048 sc1
  buffer_load_dwordx4 v[172:175], v14, s[4:7], s22 offen offset:3072 sc1
  s_waitcnt vmcnt(1)
  v_cmp_eq_u32 vcc, -1, v168
  s_cbranch_vccnz reca_retry134
  s_branch reca_resume135
reca_retry134_to:
  s_mov_b32 s18, 0
  s_waitcnt vmcnt(0)
  s_branch reca_resume135
reca_retry136:
  s_sub_u32 s18, s18, 1
  s_cbranch_scc1 reca_retry136_to
  buffer_load_dwordx4 v[172:175], v14, s[4:7], s22 offen offset:3072 sc1
  s_waitcnt vmcnt(0)
  v_cmp_eq_u32 vcc, -1, v172
  s_cbranch_vccnz reca_retry136
  s_branch reca_resume137
reca_retry136_to:
  s_mov_b32 s18, 0
  s_waitcnt vmcnt(0)
  s_branch reca_resume137
reca_retry139:
  s_sub_u32 s18, s18, 1
  s_cbranch_scc1 reca_retry139_to
  buffer_load_dwordx4 v[128:131], v20, s[4:7], s25 offen sc1
  buffer_load_dwordx4 v[132:135], v21, s[4:7], s25 offen sc1
  buffer_load_dwordx4 v[136:139], v22, s[4:7], s25 offen sc1
  buffer_load_dwordx4 v[140:143], v23, s[4:7], s25 offen sc1
  buffer_load_dwordx4 v[144:147], v24, s[4:7], s25 offen sc1
  buffer_load_dwordx4 v[148:151], v25, s[4:7], s25 offen sc1
  buffer_load_dwordx4 v[152:155], v26, s[4:7], s25 offen sc1
  buffer_load_dwordx4 v[156:159], v27, s[4:7], s25 offen sc1
  s_waitcnt vmcnt(7)
  v_cmp_eq_u32 vcc, -1, v128
  s_cbranch_vccnz reca_retry139
  s_branch reca_resume140
reca_retry139_to:
  s_mov_b32 s18, 0
  s_waitcnt vmcnt(0)
  s_branch reca_resume140
reca_retry141:
  s_sub_u32 s18, s18, 1
  s_cbranch_scc1 reca_retry141_to
  buffer_load_dwordx4 v[132:135], v21, s[4:7], s25 offen sc1
  buffer_load_dwordx4 v[136:139], v22, s[4:7], s25 offen sc1
  buffer_load_dwordx4 v[140:143], v23, s[4:7], s25 offen sc1
  buffer_load_dwordx4 v[144:147], v24, s[4:7], s25 offen sc1
  buffer_load_dwordx4 v[148:151], v25, s[4:7], s25 offen sc1
  buffer_load_dwordx4 v[152:155], v26, s[4:7], s25 offen sc1
  buffer_load_dwordx4 v[156:159], v27, s[4:7], s25 offen sc1
  s_waitcnt vmcnt(6)
  v_cmp_eq_u32 vcc, -1, v132
  s_cbranch_vccnz reca_retry141
  s_branch reca_resume142
reca_retry141_to:
  s_mov_b32 s18, 0
  s_waitcnt vmcnt(0)
  s_branch reca_resume142
reca_retry143:
  s_sub_u32 s18, s18, 1
  s_cbranch_scc1 reca_retry143_to
  buffer_load_dwordx4 v[136:139], v22, s[4:7], s25 offen sc1
  buffer_load_dwordx4 v[140:143], v23, s[4:7], s25 offen sc1
  buffer_load_dwordx4 v[144:147], v24, s[4:7], s25 offen sc1
  buffer_load_dwordx4 v[148:151], v25, s[4:7], s25 offen sc1
  buffer_load_dwordx4 v[152:155], v26, s[4:7], s25 offen sc1
  buffer_load_dwordx4 v[156:159], v27, s[4:7], s25 offen sc1
  s_waitcnt vmcnt(5)
  v_cmp_eq_u32 vcc, -1, v136
  s_cbranch_vccnz reca_retry143
  s_branch reca_resume144
reca_retry143_to:
  s_mov_b32 s18, 0
  s_waitcnt vmcnt(0)
  s_branch reca_resume144
reca_retry145:
  s_sub_u32 s18, s18, 1
  s_cbranch_scc1 reca_retry145_to
  buffer_load_dwordx4 v[140:143], v23, s[4:7], s25 offen sc1
  buffer_load_dwordx4 v[144:147], v24, s[4:7], s25 offen sc1
  buffer_load_dwordx4 v[148:151], v25, s[4:7], s25 offen sc1
  buffer_load_dwordx4 v[152:155], v26, s[4:7], s25 offen sc1
  buffer_load_dwordx4 v[156:159], v27, s[4:7], s25 offen sc1
  s_waitcnt vmcnt(4)
  v_cmp_eq_u32 vcc, -1, v140
  s_cbranch_vccnz reca_retry145
  s_branch reca_resume146
reca_retry145_to:
  s_mov_b32 s18, 0
  s_waitcnt vmcnt(0)
  s_branch reca_resume146
reca_retry147:
  s_sub_u32 s18, s18, 1
  s_cbranch_scc1 reca_retry147_to
  buffer_load_dwordx4 v[144:147], v24, s[4:7], s25 offen sc1
  buffer_load_dwordx4 v[148:151], v25, s[4:7], s25 offen sc1
  buffer_load_dwordx4 v[152:155], v26, s[4:7], s25 offen sc1
  buffer_load_dwordx4 v[156:159], v27, s[4:7], s25 offen sc1
  s_waitcnt vmcnt(3)
  v_cmp_eq_u32 vcc, -1, v144
  s_cbranch_vccnz reca_retry147
  s_branch reca_resume148
reca_retry147_to:
  s_mov_b32 s18, 0
  s_waitcnt vmcnt(0)
  s_branch reca_resume148
reca_retry149:
  s_sub_u32 s18, s18, 1
  s_cbranch_scc1 reca_retry149_to
  buffer_load_dwordx4 v[148:151], v25, s[4:7], s25 offen sc1
  buffer_load_dwordx4 v[152:155], v26, s[4:7], s25 offen sc1
  buffer_load_dwordx4 v[156:159], v27, s[4:7], s25 offen sc1
  s_waitcnt vmcnt(2)
  v_cmp_eq_u32 vcc, -1, v148
  s_cbranch_vccnz reca_retry149
  s_branch reca_resume150
reca_retry149_to:
  s_mov_b32 s18, 0
  s_waitcnt vmcnt(0)
  s_branch reca_resume150
reca_retry151:
  s_sub_u32 s18, s18, 1
  s_cbranch_scc1 reca_retry151_to
  buffer_load_dwordx4 v[152:155], v26, s[4:7], s25 offen sc1
  buffer_load_dwordx4 v[156:159], v27, s[4:7], s25 offen sc1
  s_waitcnt vmcnt(1)
  v_cmp_eq_u32 vcc, -1, v152
  s_cbranch_vccnz reca_retry151
  s_branch reca_resume152
reca_retry151_to:
  s_mov_b32 s18, 0
  s_waitcnt vmcnt(0)
  s_branch reca_resume152
reca_retry153:
  s_sub_u32 s18, s18, 1
  s_cbranch_scc1 reca_retry153_to
  buffer_load_dwordx4 v[156:159], v27, s[4:7], s25 offen sc1
  s_waitcnt vmcnt(0)
  v_cmp_eq_u32 vcc, -1, v156
  s_cbranch_vccnz reca_retry153
  s_branch reca_resume154
reca_retry153_to:
  s_mov_b32 s18, 0
  s_waitcnt vmcnt(0)
  s_branch reca_resume154
reca_proj2:
  s_sub_u32 s34, s14, 24
  s_lshr_b32 s35, s34, 1
  s_and_b32 s16, s34, 1
  s_lshl_b32 s15, s13, 2
  s_add_u32 s15, s15, s35
  s_lshl_b32 s24, s13, 3
  s_add_u32 s24, s24, s34
  s_lshl_b32 s24, s24, 7
  s_add_u32 s24, s24, 1540096
  s_lshl_b32 s25, s13, 7
  s_add_u32 s25, s25, 1507328
  v_and_b32 v28, 63, v0
  v_lshlrev_b32 v1, 4, v28
  v_mov_b32 v29, 0x80000000
  v_cmp_eq_u32 vcc, 0, v28
  v_mov_b32 v4, 0
  s_nop 0
  v_cndmask_b32 v4, v29, v4, vcc
  s_cmp_eq_u32 s12, 0
  s_cbranch_scc1 reca_pw0_158
  s_cmp_eq_u32 s12, 1
  s_cbranch_scc1 reca_pw1_159
  s_cmp_eq_u32 s12, 2
  s_cbranch_scc1 reca_pw2_160
  s_branch reca_pw3_161
reca_pw0_158:
  s_mov_b32 s17, 0
  s_mov_b32 s26, 0
  s_mul_i32 s20, s17, 40960
  s_add_u32 s20, s20, 153616384
  s_add_u32 m0, s26, 0
  s_nop 0
  buffer_load_dwordx4 v1, s[4:7], s20 offen offset:0 lds
  buffer_load_dwordx4 v1, s[4:7], s20 offen offset:1024 lds
  buffer_load_dwordx4 v1, s[4:7], s20 offen offset:2048 lds
  buffer_load_dwordx4 v1, s[4:7], s20 offen offset:3072 lds
  s_add_u32 s20, s20, 4096
  s_add_u32 m0, s26, 4096
  s_nop 0
  buffer_load_dwordx4 v1, s[4:7], s20 offen offset:0 lds
  buffer_load_dwordx4 v1, s[4:7], s20 offen offset:1024 lds
  buffer_load_dwordx4 v1, s[4:7], s20 offen offset:2048 lds
  buffer_load_dwordx4 v1, s[4:7], s20 offen offset:3072 lds
  s_add_u32 s20, s20, 4096
  s_add_u32 m0, s26, 8192
  s_nop 0
  buffer_load_dwordx4 v1, s[4:7], s20 offen offset:0 lds
  buffer_load_dwordx4 v1, s[4:7], s20 offen offset:1024 lds
  s_lshl_b32 s34, s15, 6
  s_add_u32 s34, s34, s17
  s_mul_i32 s34, s34, 12288
  s_mul_i32 s35, s16, 3072
  s_add_u32 s35, s35, s34
  s_add_u32 s27, s35, 37748736
  s_mul_i32 s35, s16, 6144
  s_add_u32 s35, s35, s34
  s_add_u32 s28, s35, 62914560
  s_add_u32 s34, s27, 0
  buffer_load_dwordx4 v[16:19], v1, s[4:7], s34 offen sc1
  s_add_u32 s34, s27, 6144
  buffer_load_dwordx4 v[16:19], v1, s[4:7], s34 offen sc1
  s_add_u32 s34, s27, 1024
  buffer_load_dwordx4 v[16:19], v1, s[4:7], s34 offen sc1
  s_add_u32 s34, s27, 7168
  buffer_load_dwordx4 v[16:19], v1, s[4:7], s34 offen sc1
  s_add_u32 s34, s28, 0
  buffer_load_dwordx4 v[16:19], v1, s[4:7], s34 offen sc1
  s_mul_i32 s34, s15, 12
  s_mul_i32 s35, s16, 6
  s_add_u32 s34, s34, s35
  s_add_u32 s34, s34, 0
  s_mul_i32 s34, s34, 20480
  s_add_u32 s34, s34, 14155776
  buffer_load_dwordx4 a[0:3], v1, s[4:7], s34 offen offset:0
  buffer_load_dwordx4 a[4:7], v1, s[4:7], s34 offen offset:1024
  buffer_load_dwordx4 a[8:11], v1, s[4:7], s34 offen offset:2048
  buffer_load_dwordx4 a[12:15], v1, s[4:7], s34 offen offset:3072
  s_add_u32 s34, s34, 4096
  buffer_load_dwordx4 a[16:19], v1, s[4:7], s34 offen offset:0
  buffer_load_dwordx4 a[20:23], v1, s[4:7], s34 offen offset:1024
  buffer_load_dwordx4 a[24:27], v1, s[4:7], s34 offen offset:2048
  buffer_load_dwordx4 a[28:31], v1, s[4:7], s34 offen offset:3072
  s_add_u32 s34, s34, 4096
  buffer_load_dwordx4 a[32:35], v1, s[4:7], s34 offen offset:0
  buffer_load_dwordx4 a[36:39], v1, s[4:7], s34 offen offset:1024
  buffer_load_dwordx4 a[40:43], v1, s[4:7], s34 offen offset:2048
  buffer_load_dwordx4 a[44:47], v1, s[4:7], s34 offen offset:3072
  s_add_u32 s34, s34, 4096
  buffer_load_dwordx4 a[48:51], v1, s[4:7], s34 offen offset:0
  buffer_load_dwordx4 a[52:55], v1, s[4:7], s34 offen offset:1024
  buffer_load_dwordx4 a[56:59], v1, s[4:7], s34 offen offset:2048
  buffer_load_dwordx4 a[60:63], v1, s[4:7], s34 offen offset:3072
  s_add_u32 s34, s34, 4096
  buffer_load_dwordx4 a[64:67], v1, s[4:7], s34 offen offset:0
  buffer_load_dwordx4 a[68:71], v1, s[4:7], s34 offen offset:1024
  buffer_load_dwordx4 a[72:75], v1, s[4:7], s34 offen offset:2048
  buffer_load_dwordx4 a[76:79], v1, s[4:7], s34 offen offset:3072
  s_mul_i32 s34, s15, 12
  s_mul_i32 s35, s16, 6
  s_add_u32 s34, s34, s35
  s_add_u32 s34, s34, 1
  s_mul_i32 s34, s34, 20480
  s_add_u32 s34, s34, 14155776
  buffer_load_dwordx4 a[80:83], v1, s[4:7], s34 offen offset:0
  buffer_load_dwordx4 a[84:87], v1, s[4:7], s34 offen offset:1024
  buffer_load_dwordx4 a[88:91], v1, s[4:7], s34 offen offset:2048
  buffer_load_dwordx4 a[92:95], v1, s[4:7], s34 offen offset:3072
  s_add_u32 s34, s34, 4096
  buffer_load_dwordx4 a[96:99], v1, s[4:7], s34 offen offset:0
  buffer_load_dwordx4 a[100:103], v1, s[4:7], s34 offen offset:1024
  buffer_load_dwordx4 a[104:107], v1, s[4:7], s34 offen offset:2048
  buffer_load_dwordx4 a[108:111], v1, s[4:7], s34 offen offset:3072
  s_add_u32 s34, s34, 4096
  buffer_load_dwordx4 a[112:115], v1, s[4:7], s34 offen offset:0
  buffer_load_dwordx4 a[116:119], v1, s[4:7], s34 offen offset:1024
  buffer_load_dwordx4 a[120:123], v1, s[4:7], s34 offen offset:2048
  buffer_load_dwordx4 a[124:127], v1, s[4:7], s34 offen offset:3072
  s_add_u32 s34, s34, 4096
  buffer_load_dwordx4 a[128:131], v1, s[4:7], s34 offen offset:0
  buffer_load_dwordx4 a[132:135], v1, s[4:7], s34 offen offset:1024
  buffer_load_dwordx4 a[136:139], v1, s[4:7], s34 offen offset:2048
  buffer_load_dwordx4 a[140:143], v1, s[4:7], s34 offen offset:3072
  s_add_u32 s34, s34, 4096
  buffer_load_dwordx4 a[144:147], v1, s[4:7], s34 offen offset:0
  buffer_load_dwordx4 a[148:151], v1, s[4:7], s34 offen offset:1024
  buffer_load_dwordx4 a[152:155], v1, s[4:7], s34 offen offset:2048
  buffer_load_dwordx4 a[156:159], v1, s[4:7], s34 offen offset:3072
  s_waitcnt vmcnt(20)
  s_mul_i32 s34, s15, 12
  s_mul_i32 s35, s16, 6
  s_add_u32 s34, s34, s35
  s_add_u32 s34, s34, 2
  s_mul_i32 s34, s34, 20480
  s_add_u32 s34, s34, 14155776
  buffer_load_dwordx4 a[160:163], v1, s[4:7], s34 offen offset:0
  buffer_load_dwordx4 a[164:167], v1, s[4:7], s34 offen offset:1024
  buffer_load_dwordx4 a[168:171], v1, s[4:7], s34 offen offset:2048
  buffer_load_dwordx4 a[172:175], v1, s[4:7], s34 offen offset:3072
  s_add_u32 s34, s34, 4096
  buffer_load_dwordx4 a[176:179], v1, s[4:7], s34 offen offset:0
  buffer_load_dwordx4 a[180:183], v1, s[4:7], s34 offen offset:1024
  buffer_load_dwordx4 a[184:187], v1, s[4:7], s34 offen offset:2048
  buffer_load_dwordx4 a[188:191], v1, s[4:7], s34 offen offset:3072
  s_add_u32 s34, s34, 4096
  buffer_load_dwordx4 a[192:195], v1, s[4:7], s34 offen offset:0
  buffer_load_dwordx4 a[196:199], v1, s[4:7], s34 offen offset:1024
  buffer_load_dwordx4 a[200:203], v1, s[4:7], s34 offen offset:2048
  buffer_load_dwordx4 a[204:207], v1, s[4:7], s34 offen offset:3072
  s_add_u32 s34, s34, 4096
  buffer_load_dwordx4 a[208:211], v1, s[4:7], s34 offen offset:0
  buffer_load_dwordx4 a[212:215], v1, s[4:7], s34 offen offset:1024
  buffer_load_dwordx4 a[216:219], v1, s[4:7], s34 offen offset:2048
  buffer_load_dwordx4 a[220:223], v1, s[4:7], s34 offen offset:3072
  s_add_u32 s34, s34, 4096
  buffer_load_dwordx4 a[224:227], v1, s[4:7], s34 offen offset:0
  buffer_load_dwordx4 a[228:231], v1, s[4:7], s34 offen offset:1024
  buffer_load_dwordx4 a[232:235], v1, s[4:7], s34 offen offset:2048
  buffer_load_dwordx4 a[236:239], v1, s[4:7], s34 offen offset:3072
  s_waitcnt vmcnt(20)
  s_mul_i32 s34, s15, 12
  s_mul_i32 s35, s16, 6
  s_add_u32 s34, s34, s35
  s_add_u32 s34, s34, 3
  s_mul_i32 s34, s34, 20480
  s_add_u32 s34, s34, 14155776
  buffer_load_dwordx4 v[96:99], v1, s[4:7], s34 offen offset:0
  buffer_load_dwordx4 v[100:103], v1, s[4:7], s34 offen offset:1024
  buffer_load_dwordx4 v[104:107], v1, s[4:7], s34 offen offset:2048
  buffer_load_dwordx4 v[108:111], v1, s[4:7], s34 offen offset:3072
  s_add_u32 s34, s34, 4096
  buffer_load_dwordx4 v[112:115], v1, s[4:7], s34 offen offset:0
  buffer_load_dwordx4 v[116:119], v1, s[4:7], s34 offen offset:1024
  buffer_load_dwordx4 v[120:123], v1, s[4:7], s34 offen offset:2048
  buffer_load_dwordx4 v[124:127], v1, s[4:7], s34 offen offset:3072
  s_add_u32 s34, s34, 4096
  buffer_load_dwordx4 v[128:131], v1, s[4:7], s34 offen offset:0
  buffer_load_dwordx4 v[132:135], v1, s[4:7], s34 offen offset:1024
  buffer_load_dwordx4 v[136:139], v1, s[4:7], s34 offen offset:2048
  buffer_load_dwordx4 v[140:143], v1, s[4:7], s34 offen offset:3072
  s_add_u32 s34, s34, 4096
  buffer_load_dwordx4 v[144:147], v1, s[4:7], s34 offen offset:0
  buffer_load_dwordx4 v[148:151], v1, s[4:7], s34 offen offset:1024
  buffer_load_dwordx4 v[152:155], v1, s[4:7], s34 offen offset:2048
  buffer_load_dwordx4 v[156:159], v1, s[4:7], s34 offen offset:3072
  s_add_u32 s34, s34, 4096
  buffer_load_dwordx4 v[160:163], v1, s[4:7], s34 offen offset:0
  buffer_load_dwordx4 v[164:167], v1, s[4:7], s34 offen offset:1024
  buffer_load_dwordx4 v[168:171], v1, s[4:7], s34 offen offset:2048
  buffer_load_dwordx4 v[172:175], v1, s[4:7], s34 offen offset:3072
  s_waitcnt vmcnt(20)
  s_mul_i32 s34, s15, 12
  s_mul_i32 s35, s16, 6
  s_add_u32 s34, s34, s35
  s_add_u32 s34, s34, 0
  s_mul_i32 s34, s34, 20480
  s_add_u32 s34, s34, 22020096
  buffer_load_dwordx4 v[176:179], v1, s[4:7], s34 offen offset:0
  buffer_load_dwordx4 v[180:183], v1, s[4:7], s34 offen offset:1024
  buffer_load_dwordx4 v[184:187], v1, s[4:7], s34 offen offset:2048
  buffer_load_dwordx4 v[188:191], v1, s[4:7], s34 offen offset:3072
  s_add_u32 s34, s34, 4096
  buffer_load_dwordx4 v[192:195], v1, s[4:7], s34 offen offset:0
  buffer_load_dwordx4 v[196:199], v1, s[4:7], s34 offen offset:1024
  buffer_load_dwordx4 v[200:203], v1, s[4:7], s34 offen offset:2048
  buffer_load_dwordx4 v[204:207], v1, s[4:7], s34 offen offset:3072
  s_add_u32 s34, s34, 4096
  buffer_load_dwordx4 v[208:211], v1, s[4:7], s34 offen offset:0
  buffer_load_dwordx4 v[212:215], v1, s[4:7], s34 offen offset:1024
  buffer_load_dwordx4 v[216:219], v1, s[4:7], s34 offen offset:2048
  buffer_load_dwordx4 v[220:223], v1, s[4:7], s34 offen offset:3072
  s_add_u32 s34, s34, 4096
  buffer_load_dwordx4 v[224:227], v1, s[4:7], s34 offen offset:0
  buffer_load_dwordx4 v[228:231], v1, s[4:7], s34 offen offset:1024
  buffer_load_dwordx4 v[232:235], v1, s[4:7], s34 offen offset:2048
  buffer_load_dwordx4 v[236:239], v1, s[4:7], s34 offen offset:3072
  s_add_u32 s34, s34, 4096
  buffer_load_dwordx4 v[240:243], v1, s[4:7], s34 offen offset:0
  buffer_load_dwordx4 v[244:247], v1, s[4:7], s34 offen offset:1024
  buffer_load_dwordx4 v[248:251], v1, s[4:7], s34 offen offset:2048
  buffer_load_dwordx4 v[252:255], v1, s[4:7], s34 offen offset:3072
  s_waitcnt vmcnt(20)
  v_and_b32 v30, 7, v0
  v_lshlrev_b32 v30, 3, v30
reca_cens162:
  buffer_load_dwordx2 v[28:29], v30, s[8:11], 0 offen sc1
  s_waitcnt vmcnt(0)
  v_sad_u8 v31, v28, 0, 0
  v_sad_u8 v31, v29, 0, v31
  v_cmp_gt_u32 vcc, 32, v31
  s_cbranch_vccz reca_censok163
  s_sleep 8
  s_sub_u32 s18, s18, 1
  s_cbranch_scc0 reca_cens162
  s_mov_b32 s18, 0
reca_censok163:
  v_and_b32 v28, 0x20202020, v28
  v_and_b32 v29, 0x20202020, v29
  v_cmp_ne_u32 s[34:35], 0, v28
  v_cmp_ne_u32 s[36:37], 0, v29
  s_nop 3
  s_and_b32 s34, s34, 0xff
  s_and_b32 s36, s36, 0xff
  s_or_b32 s35, s34, s36
  s_lshr_b32 s37, s35, s13
  s_and_b32 s37, s37, 1
  s_xor_b32 s43, s37, 1
  s_cmp_eq_u32 s57, 0
  s_cselect_b32 s58, s36, s34
  v_mov_b32 v31, 0x80000000
  s_cmp_lg_u32 s43, 0
  s_cbranch_scc1 reca_pslow164
reca_ptop165:
  s_cmp_lt_u32 s17, 6
  s_cbranch_scc1 reca_pgo166
  s_sub_u32 s36, s17, 6
reca_ppoll167:
  buffer_load_dword v28, v4, s[4:7], s25 offen sc1
  s_waitcnt vmcnt(0)
  v_readfirstlane_b32 s34, v28
  s_nop 3
  s_cmp_ge_i32 s34, s36
  s_cbranch_scc1 reca_pgo166
  s_sleep 8
  s_sub_u32 s18, s18, 1
  s_cbranch_scc0 reca_ppoll167
  s_mov_b32 s18, 0
reca_pgo166:
  s_waitcnt vmcnt(0)
  s_barrier
  v_add_u32 v7, s26, v1
  s_xor_b32 s26, s26, 40960
  s_add_u32 s37, s17, 1
  s_cmp_ge_u32 s37, 64
  s_cbranch_scc1 reca_pnodma168
  s_mul_i32 s20, s37, 40960
  s_add_u32 s20, s20, 153616384
  s_add_u32 m0, s26, 0
  s_nop 0
  buffer_load_dwordx4 v1, s[4:7], s20 offen offset:0 lds
  buffer_load_dwordx4 v1, s[4:7], s20 offen offset:1024 lds
  buffer_load_dwordx4 v1, s[4:7], s20 offen offset:2048 lds
  buffer_load_dwordx4 v1, s[4:7], s20 offen offset:3072 lds
  s_add_u32 s20, s20, 4096
  s_add_u32 m0, s26, 4096
  s_nop 0
  buffer_load_dwordx4 v1, s[4:7], s20 offen offset:0 lds
  buffer_load_dwordx4 v1, s[4:7], s20 offen offset:1024 lds
  buffer_load_dwordx4 v1, s[4:7], s20 offen offset:2048 lds
  buffer_load_dwordx4 v1, s[4:7], s20 offen offset:3072 lds
  s_add_u32 s20, s20, 4096
  s_add_u32 m0, s26, 8192
  s_nop 0
  buffer_load_dwordx4 v1, s[4:7], s20 offen offset:0 lds
  buffer_load_dwordx4 v1, s[4:7], s20 offen offset:1024 lds
  s_lshl_b32 s34, s15, 6
  s_add_u32 s34, s34, s37
  s_mul_i32 s34, s34, 12288
  s_mul_i32 s35, s16, 3072
  s_add_u32 s35, s35, s34
  s_add_u32 s27, s35, 37748736
  s_mul_i32 s35, s16, 6144
  s_add_u32 s35, s35, s34
  s_add_u32 s28, s35, 62914560
  s_add_u32 s34, s27, 0
  buffer_load_dwordx4 v[16:19], v1, s[4:7], s34 offen sc1
  s_add_u32 s34, s27, 6144
  buffer_load_dwordx4 v[16:19], v1, s[4:7], s34 offen sc1
  s_add_u32 s34, s27, 1024
  buffer_load_dwordx4 v[16:19], v1, s[4:7], s34 offen sc1
  s_add_u32 s34, s27, 7168
  buffer_load_dwordx4 v[16:19], v1, s[4:7], s34 offen sc1
  s_add_u32 s34, s28, 0
  buffer_load_dwordx4 v[16:19], v1, s[4:7], s34 offen sc1
reca_pnodma168:
  s_lshl_b32 s34, s15, 6
  s_add_u32 s34, s34, s17
  s_mul_i32 s34, s34, 12288
  s_mul_i32 s35, s16, 3072
  s_add_u32 s35, s35, s34
  s_add_u32 s21, s35, 37748736
  s_add_u32 s22, s35, 88080384
  s_mul_i32 s35, s16, 6144
  s_add_u32 s35, s35, s34
  s_add_u32 s23, s35, 62914560
  ds_read_b128 v[72:75], v7 offset:0
  ds_read_b128 v[76:79], v7 offset:20480
  ds_read_b128 v[80:83], v7 offset:1024
  ds_read_b128 v[84:87], v7 offset:21504
  ds_read_b128 v[88:91], v7 offset:2048
  ds_read_b128 v[92:95], v7 offset:22528
  s_waitcnt lgkmcnt(4)
  v_mfma_f32_16x16x32_bf16 v[32:35], a[0:3], v[72:75], 0
  v_mfma_f32_16x16x32_bf16 v[36:39], a[0:3], v[76:79], 0
  v_mfma_f32_16x16x32_bf16 v[40:43], a[80:83], v[72:75], 0
  v_mfma_f32_16x16x32_bf16 v[44:47], a[80:83], v[76:79], 0
  v_mfma_f32_16x16x32_bf16 v[48:51], a[160:163], v[72:75], 0
  v_mfma_f32_16x16x32_bf16 v[52:55], a[160:163], v[76:79], 0
  v_mfma_f32_16x16x32_bf16 v[56:59], v[96:99], v[72:75], 0
  v_mfma_f32_16x16x32_bf16 v[60:63], v[96:99], v[76:79], 0
  v_mfma_f32_16x16x32_bf16 v[64:67], v[72:75], v[176:179], 0
  v_mfma_f32_16x16x32_bf16 v[68:71], v[76:79], v[176:179], 0
  ds_read_b128 v[72:75], v7 offset:3072
  ds_read_b128 v[76:79], v7 offset:23552
  s_waitcnt lgkmcnt(4)
  v_mfma_f32_16x16x32_bf16 v[32:35], a[4:7], v[80:83], v[32:35]
  v_mfma_f32_16x16x32_bf16 v[36:39], a[4:7], v[84:87], v[36:39]
  v_mfma_f32_16x16x32_bf16 v[40:43], a[84:87], v[80:83], v[40:43]
  v_mfma_f32_16x16x32_bf16 v[44:47], a[84:87], v[84:87], v[44:47]
  v_mfma_f32_16x16x32_bf16 v[48:51], a[164:167], v[80:83], v[48:51]
  v_mfma_f32_16x16x32_bf16 v[52:55], a[164:167], v[84:87], v[52:55]
  v_mfma_f32_16x16x32_bf16 v[56:59], v[100:103], v[80:83], v[56:59]
  v_mfma_f32_16x16x32_bf16 v[60:63], v[100:103], v[84:87], v[60:63]
  v_mfma_f32_16x16x32_bf16 v[64:67], v[80:83], v[180:183], v[64:67]
  v_mfma_f32_16x16x32_bf16 v[68:71], v[84:87], v[180:183], v[68:71]
  ds_read_b128 v[80:83], v7 offset:4096
  ds_read_b128 v[84:87], v7 offset:24576
  s_waitcnt lgkmcnt(4)
  v_mfma_f32_16x16x32_bf16 v[32:35], a[8:11], v[88:91], v[32:35]
  v_mfma_f32_16x16x32_bf16 v[36:39], a[8:11], v[92:95], v[36:39]
  v_mfma_f32_16x16x32_bf16 v[40:43], a[88:91], v[88:91], v[40:43]
  v_mfma_f32_16x16x32_bf16 v[44:47], a[88:91], v[92:95], v[44:47]
  v_mfma_f32_16x16x32_bf16 v[48:51], a[168:171], v[88:91], v[48:51]
  v_mfma_f32_16x16x32_bf16 v[52:55], a[168:171], v[92:95], v[52:55]
  v_mfma_f32_16x16x32_bf16 v[56:59], v[104:107], v[88:91], v[56:59]
  v_mfma_f32_16x16x32_bf16 v[60:63], v[104:107], v[92:95], v[60:63]
  v_mfma_f32_16x16x32_bf16 v[64:67], v[88:91], v[184:187], v[64:67]
  v_mfma_f32_16x16x32_bf16 v[68:71], v[92:95], v[184:187], v[68:71]
  ds_read_b128 v[88:91], v7 offset:5120
  ds_read_b128 v[92:95], v7 offset:25600
  s_waitcnt lgkmcnt(4)
  v_mfma_f32_16x16x32_bf16 v[32:35], a[12:15], v[72:75], v[32:35]
  v_mfma_f32_16x16x32_bf16 v[36:39], a[12:15], v[76:79], v[36:39]
  v_mfma_f32_16x16x32_bf16 v[40:43], a[92:95], v[72:75], v[40:43]
  v_mfma_f32_16x16x32_bf16 v[44:47], a[92:95], v[76:79], v[44:47]
  v_mfma_f32_16x16x32_bf16 v[48:51], a[172:175], v[72:75], v[48:51]
  v_mfma_f32_16x16x32_bf16 v[52:55], a[172:175], v[76:79], v[52:55]
  v_mfma_f32_16x16x32_bf16 v[56:59], v[108:111], v[72:75], v[56:59]
  v_mfma_f32_16x16x32_bf16 v[60:63], v[108:111], v[76:79], v[60:63]
  v_mfma_f32_16x16x32_bf16 v[64:67], v[72:75], v[188:191], v[64:67]
  v_mfma_f32_16x16x32_bf16 v[68:71], v[76:79], v[188:191], v[68:71]
  ds_read_b128 v[72:75], v7 offset:6144
  ds_read_b128 v[76:79], v7 offset:26624
  s_waitcnt lgkmcnt(4)
  v_mfma_f32_16x16x32_bf16 v[32:35], a[16:19], v[80:83], v[32:35]
  v_mfma_f32_16x16x32_bf16 v[36:39], a[16:19], v[84:87], v[36:39]
  v_mfma_f32_16x16x32_bf16 v[40:43], a[96:99], v[80:83], v[40:43]
  v_mfma_f32_16x16x32_bf16 v[44:47], a[96:99], v[84:87], v[44:47]
  v_mfma_f32_16x16x32_bf16 v[48:51], a[176:179], v[80:83], v[48:51]
  v_mfma_f32_16x16x32_bf16 v[52:55], a[176:179], v[84:87], v[52:55]
  v_mfma_f32_16x16x32_bf16 v[56:59], v[112:115], v[80:83], v[56:59]
  v_mfma_f32_16x16x32_bf16 v[60:63], v[112:115], v[84:87], v[60:63]
  v_mfma_f32_16x16x32_bf16 v[64:67], v[80:83], v[192:195], v[64:67]
  v_mfma_f32_16x16x32_bf16 v[68:71], v[84:87], v[192:195], v[68:71]
  ds_read_b128 v[80:83], v7 offset:7168
  ds_read_b128 v[84:87], v7 offset:27648
  s_waitcnt lgkmcnt(4)
  v_mfma_f32_16x16x32_bf16 v[32:35], a[20:23], v[88:91], v[32:35]
  v_mfma_f32_16x16x32_bf16 v[36:39], a[20:23], v[92:95], v[36:39]
  v_mfma_f32_16x16x32_bf16 v[40:43], a[100:103], v[88:91], v[40:43]
  v_mfma_f32_16x16x32_bf16 v[44:47], a[100:103], v[92:95], v[44:47]
  v_mfma_f32_16x16x32_bf16 v[48:51], a[180:183], v[88:91], v[48:51]
  v_mfma_f32_16x16x32_bf16 v[52:55], a[180:183], v[92:95], v[52:55]
  v_mfma_f32_16x16x32_bf16 v[56:59], v[116:119], v[88:91], v[56:59]
  v_mfma_f32_16x16x32_bf16 v[60:63], v[116:119], v[92:95], v[60:63]
  v_mfma_f32_16x16x32_bf16 v[64:67], v[88:91], v[196:199], v[64:67]
  v_mfma_f32_16x16x32_bf16 v[68:71], v[92:95], v[196:199], v[68:71]
  ds_read_b128 v[88:91], v7 offset:8192
  ds_read_b128 v[92:95], v7 offset:28672
  s_waitcnt lgkmcnt(4)
  v_mfma_f32_16x16x32_bf16 v[32:35], a[24:27], v[72:75], v[32:35]
  v_mfma_f32_16x16x32_bf16 v[36:39], a[24:27], v[76:79], v[36:39]
  v_mfma_f32_16x16x32_bf16 v[40:43], a[104:107], v[72:75], v[40:43]
  v_mfma_f32_16x16x32_bf16 v[44:47], a[104:107], v[76:79], v[44:47]
  v_mfma_f32_16x16x32_bf16 v[48:51], a[184:187], v[72:75], v[48:51]
  v_mfma_f32_16x16x32_bf16 v[52:55], a[184:187], v[76:79], v[52:55]
  v_mfma_f32_16x16x32_bf16 v[56:59], v[120:123], v[72:75], v[56:59]
  v_mfma_f32_16x16x32_bf16 v[60:63], v[120:123], v[76:79], v[60:63]
  v_mfma_f32_16x16x32_bf16 v[64:67], v[72:75], v[200:203], v[64:67]
  v_mfma_f32_16x16x32_bf16 v[68:71], v[76:79], v[200:203], v[68:71]
  ds_read_b128 v[72:75], v7 offset:9216
  ds_read_b128 v[76:79], v7 offset:29696
  s_waitcnt lgkmcnt(4)
  v_mfma_f32_16x16x32_bf16 v[32:35], a[28:31], v[80:83], v[32:35]
  v_mfma_f32_16x16x32_bf16 v[36:39], a[28:31], v[84:87], v[36:39]
  v_mfma_f32_16x16x32_bf16 v[40:43], a[108:111], v[80:83], v[40:43]
  v_mfma_f32_16x16x32_bf16 v[44:47], a[108:111], v[84:87], v[44:47]
  v_mfma_f32_16x16x32_bf16 v[48:51], a[188:191], v[80:83], v[48:51]
  v_mfma_f32_16x16x32_bf16 v[52:55], a[188:191], v[84:87], v[52:55]
  v_mfma_f32_16x16x32_bf16 v[56:59], v[124:127], v[80:83], v[56:59]
  v_mfma_f32_16x16x32_bf16 v[60:63], v[124:127], v[84:87], v[60:63]
  v_mfma_f32_16x16x32_bf16 v[64:67], v[80:83], v[204:207], v[64:67]
  v_mfma_f32_16x16x32_bf16 v[68:71], v[84:87], v[204:207], v[68:71]
  ds_read_b128 v[80:83], v7 offset:10240
  ds_read_b128 v[84:87], v7 offset:30720
  s_waitcnt lgkmcnt(4)
  v_mfma_f32_16x16x32_bf16 v[32:35], a[32:35], v[88:91], v[32:35]
  v_mfma_f32_16x16x32_bf16 v[36:39], a[32:35], v[92:95], v[36:39]
  v_mfma_f32_16x16x32_bf16 v[40:43], a[112:115], v[88:91], v[40:43]
  v_mfma_f32_16x16x32_bf16 v[44:47], a[112:115], v[92:95], v[44:47]
  v_mfma_f32_16x16x32_bf16 v[48:51], a[192:195], v[88:91], v[48:51]
  v_mfma_f32_16x16x32_bf16 v[52:55], a[192:195], v[92:95], v[52:55]
  v_mfma_f32_16x16x32_bf16 v[56:59], v[128:131], v[88:91], v[56:59]
  v_mfma_f32_16x16x32_bf16 v[60:63], v[128:131], v[92:95], v[60:63]
  v_mfma_f32_16x16x32_bf16 v[64:67], v[88:91], v[208:211], v[64:67]
  v_mfma_f32_16x16x32_bf16 v[68:71], v[92:95], v[208:211], v[68:71]
  ds_read_b128 v[88:91], v7 offset:11264
  ds_read_b128 v[92:95], v7 offset:31744
  s_waitcnt lgkmcnt(4)
  v_mfma_f32_16x16x32_bf16 v[32:35], a[36:39], v[72:75], v[32:35]
  v_mfma_f32_16x16x32_bf16 v[36:39], a[36:39], v[76:79], v[36:39]
  v_mfma_f32_16x16x32_bf16 v[40:43], a[116:119], v[72:75], v[40:43]
  v_mfma_f32_16x16x32_bf16 v[44:47], a[116:119], v[76:79], v[44:47]
  v_mfma_f32_16x16x32_bf16 v[48:51], a[196:199], v[72:75], v[48:51]
  v_mfma_f32_16x16x32_bf16 v[52:55], a[196:199], v[76:79], v[52:55]
  v_mfma_f32_16x16x32_bf16 v[56:59], v[132:135], v[72:75], v[56:59]
  v_mfma_f32_16x16x32_bf16 v[60:63], v[132:135], v[76:79], v[60:63]
  v_mfma_f32_16x16x32_bf16 v[64:67], v[72:75], v[212:215], v[64:67]
  v_mfma_f32_16x16x32_bf16 v[68:71], v[76:79], v[212:215], v[68:71]
  ds_read_b128 v[72:75], v7 offset:12288
  ds_read_b128 v[76:79], v7 offset:32768
  s_waitcnt lgkmcnt(4)
  v_mfma_f32_16x16x32_bf16 v[32:35], a[40:43], v[80:83], v[32:35]
  v_mfma_f32_16x16x32_bf16 v[36:39], a[40:43], v[84:87], v[36:39]
  v_mfma_f32_16x16x32_bf16 v[40:43], a[120:123], v[80:83], v[40:43]
  v_mfma_f32_16x16x32_bf16 v[44:47], a[120:123], v[84:87], v[44:47]
  v_mfma_f32_16x16x32_bf16 v[48:51], a[200:203], v[80:83], v[48:51]
  v_mfma_f32_16x16x32_bf16 v[52:55], a[200:203], v[84:87], v[52:55]
  v_mfma_f32_16x16x32_bf16 v[56:59], v[136:139], v[80:83], v[56:59]
  v_mfma_f32_16x16x32_bf16 v[60:63], v[136:139], v[84:87], v[60:63]
  v_mfma_f32_16x16x32_bf16 v[64:67], v[80:83], v[216:219], v[64:67]
  v_mfma_f32_16x16x32_bf16 v[68:71], v[84:87], v[216:219], v[68:71]
  ds_read_b128 v[80:83], v7 offset:13312
  ds_read_b128 v[84:87], v7 offset:33792
  s_waitcnt lgkmcnt(4)
  v_mfma_f32_16x16x32_bf16 v[32:35], a[44:47], v[88:91], v[32:35]
  v_mfma_f32_16x16x32_bf16 v[36:39], a[44:47], v[92:95], v[36:39]
  v_mfma_f32_16x16x32_bf16 v[40:43], a[124:127], v[88:91], v[40:43]
  v_mfma_f32_16x16x32_bf16 v[44:47], a[124:127], v[92:95], v[44:47]
  v_mfma_f32_16x16x32_bf16 v[48:51], a[204:207], v[88:91], v[48:51]
  v_mfma_f32_16x16x32_bf16 v[52:55], a[204:207], v[92:95], v[52:55]
  v_mfma_f32_16x16x32_bf16 v[56:59], v[140:143], v[88:91], v[56:59]
  v_mfma_f32_16x16x32_bf16 v[60:63], v[140:143], v[92:95], v[60:63]
  v_mfma_f32_16x16x32_bf16 v[64:67], v[88:91], v[220:223], v[64:67]
  v_mfma_f32_16x16x32_bf16 v[68:71], v[92:95], v[220:223], v[68:71]
  ds_read_b128 v[88:91], v7 offset:14336
  ds_read_b128 v[92:95], v7 offset:34816
  s_waitcnt lgkmcnt(4)
  v_mfma_f32_16x16x32_bf16 v[32:35], a[48:51], v[72:75], v[32:35]
  v_mfma_f32_16x16x32_bf16 v[36:39], a[48:51], v[76:79], v[36:39]
  v_mfma_f32_16x16x32_bf16 v[40:43], a[128:131], v[72:75], v[40:43]
  v_mfma_f32_16x16x32_bf16 v[44:47], a[128:131], v[76:79], v[44:47]
  v_mfma_f32_16x16x32_bf16 v[48:51], a[208:211], v[72:75], v[48:51]
  v_mfma_f32_16x16x32_bf16 v[52:55], a[208:211], v[76:79], v[52:55]
  v_mfma_f32_16x16x32_bf16 v[56:59], v[144:147], v[72:75], v[56:59]
  v_mfma_f32_16x16x32_bf16 v[60:63], v[144:147], v[76:79], v[60:63]
  v_mfma_f32_16x16x32_bf16 v[64:67], v[72:75], v[224:227], v[64:67]
  v_mfma_f32_16x16x32_bf16 v[68:71], v[76:79], v[224:227], v[68:71]
  ds_read_b128 v[72:75], v7 offset:15360
  ds_read_b128 v[76:79], v7 offset:35840
  s_waitcnt lgkmcnt(4)
  v_mfma_f32_16x16x32_bf16 v[32:35], a[52:55], v[80:83], v[32:35]
  v_mfma_f32_16x16x32_bf16 v[36:39], a[52:55], v[84:87], v[36:39]
  v_mfma_f32_16x16x32_bf16 v[40:43], a[132:135], v[80:83], v[40:43]
  v_mfma_f32_16x16x32_bf16 v[44:47], a[132:135], v[84:87], v[44:47]
  v_mfma_f32_16x16x32_bf16 v[48:51], a[212:215], v[80:83], v[48:51]
  v_mfma_f32_16x16x32_bf16 v[52:55], a[212:215], v[84:87], v[52:55]
  v_mfma_f32_16x16x32_bf16 v[56:59], v[148:151], v[80:83], v[56:59]
  v_mfma_f32_16x16x32_bf16 v[60:63], v[148:151], v[84:87], v[60:63]
  v_mfma_f32_16x16x32_bf16 v[64:67], v[80:83], v[228:231], v[64:67]
  v_mfma_f32_16x16x32_bf16 v[68:71], v[84:87], v[228:231], v[68:71]
  ds_read_b128 v[80:83], v7 offset:16384
  ds_read_b128 v[84:87], v7 offset:36864
  s_waitcnt lgkmcnt(4)
  v_mfma_f32_16x16x32_bf16 v[32:35], a[56:59], v[88:91], v[32:35]
  v_mfma_f32_16x16x32_bf16 v[36:39], a[56:59], v[92:95], v[36:39]
  v_mfma_f32_16x16x32_bf16 v[40:43], a[136:139], v[88:91], v[40:43]
  v_mfma_f32_16x16x32_bf16 v[44:47], a[136:139], v[92:95], v[44:47]
  v_mfma_f32_16x16x32_bf16 v[48:51], a[216:219], v[88:91], v[48:51]
  v_mfma_f32_16x16x32_bf16 v[52:55], a[216:219], v[92:95], v[52:55]
  v_mfma_f32_16x16x32_bf16 v[56:59], v[152:155], v[88:91], v[56:59]
  v_mfma_f32_16x16x32_bf16 v[60:63], v[152:155], v[92:95], v[60:63]
  v_mfma_f32_16x16x32_bf16 v[64:67], v[88:91], v[232:235], v[64:67]
  v_mfma_f32_16x16x32_bf16 v[68:71], v[92:95], v[232:235], v[68:71]
  ds_read_b128 v[88:91], v7 offset:17408
  ds_read_b128 v[92:95], v7 offset:37888
  s_waitcnt lgkmcnt(4)
  v_mfma_f32_16x16x32_bf16 v[32:35], a[60:63], v[72:75], v[32:35]
  v_mfma_f32_16x16x32_bf16 v[36:39], a[60:63], v[76:79], v[36:39]
  v_mfma_f32_16x16x32_bf16 v[40:43], a[140:143], v[72:75], v[40:43]
  v_mfma_f32_16x16x32_bf16 v[44:47], a[140:143], v[76:79], v[44:47]
  v_mfma_f32_16x16x32_bf16 v[48:51], a[220:223], v[72:75], v[48:51]
  v_mfma_f32_16x16x32_bf16 v[52:55], a[220:223], v[76:79], v[52:55]
  v_mfma_f32_16x16x32_bf16 v[56:59], v[156:159], v[72:75], v[56:59]
  v_mfma_f32_16x16x32_bf16 v[60:63], v[156:159], v[76:79], v[60:63]
  v_mfma_f32_16x16x32_bf16 v[64:67], v[72:75], v[236:239], v[64:67]
  v_mfma_f32_16x16x32_bf16 v[68:71], v[76:79], v[236:239], v[68:71]
  ds_read_b128 v[72:75], v7 offset:18432
  ds_read_b128 v[76:79], v7 offset:38912
  s_waitcnt lgkmcnt(4)
  v_mfma_f32_16x16x32_bf16 v[32:35], a[64:67], v[80:83], v[32:35]
  v_mfma_f32_16x16x32_bf16 v[36:39], a[64:67], v[84:87], v[36:39]
  v_mfma_f32_16x16x32_bf16 v[40:43], a[144:147], v[80:83], v[40:43]
  v_mfma_f32_16x16x32_bf16 v[44:47], a[144:147], v[84:87], v[44:47]
  v_mfma_f32_16x16x32_bf16 v[48:51], a[224:227], v[80:83], v[48:51]
  v_mfma_f32_16x16x32_bf16 v[52:55], a[224:227], v[84:87], v[52:55]
  v_mfma_f32_16x16x32_bf16 v[56:59], v[160:163], v[80:83], v[56:59]
  v_mfma_f32_16x16x32_bf16 v[60:63], v[160:163], v[84:87], v[60:63]
  v_mfma_f32_16x16x32_bf16 v[64:67], v[80:83], v[240:243], v[64:67]
  v_mfma_f32_16x16x32_bf16 v[68:71], v[84:87], v[240:243], v[68:71]
  ds_read_b128 v[80:83], v7 offset:19456
  ds_read_b128 v[84:87], v7 offset:39936
  s_waitcnt lgkmcnt(4)
  v_mfma_f32_16x16x32_bf16 v[32:35], a[68:71], v[88:91], v[32:35]
  v_mfma_f32_16x16x32_bf16 v[36:39], a[68:71], v[92:95], v[36:39]
  v_mfma_f32_16x16x32_bf16 v[40:43], a[148:151], v[88:91], v[40:43]
  v_mfma_f32_16x16x32_bf16 v[44:47], a[148:151], v[92:95], v[44:47]
  v_mfma_f32_16x16x32_bf16 v[48:51], a[228:231], v[88:91], v[48:51]
  v_mfma_f32_16x16x32_bf16 v[52:55], a[228:231], v[92:95], v[52:55]
  v_mfma_f32_16x16x32_bf16 v[56:59], v[164:167], v[88:91], v[56:59]
  v_mfma_f32_16x16x32_bf16 v[60:63], v[164:167], v[92:95], v[60:63]
  v_mfma_f32_16x16x32_bf16 v[64:67], v[88:91], v[244:247], v[64:67]
  v_mfma_f32_16x16x32_bf16 v[68:71], v[92:95], v[244:247], v[68:71]
  s_waitcnt lgkmcnt(2)
  v_mfma_f32_16x16x32_bf16 v[32:35], a[72:75], v[72:75], v[32:35]
  v_mfma_f32_16x16x32_bf16 v[36:39], a[72:75], v[76:79], v[36:39]
  v_mfma_f32_16x16x32_bf16 v[40:43], a[152:155], v[72:75], v[40:43]
  v_mfma_f32_16x16x32_bf16 v[44:47], a[152:155], v[76:79], v[44:47]
  v_mfma_f32_16x16x32_bf16 v[48:51], a[232:235], v[72:75], v[48:51]
  v_mfma_f32_16x16x32_bf16 v[52:55], a[232:235], v[76:79], v[52:55]
  v_mfma_f32_16x16x32_bf16 v[56:59], v[168:171], v[72:75], v[56:59]
  v_mfma_f32_16x16x32_bf16 v[60:63], v[168:171], v[76:79], v[60:63]
  v_mfma_f32_16x16x32_bf16 v[64:67], v[72:75], v[248:251], v[64:67]
  v_mfma_f32_16x16x32_bf16 v[68:71], v[76:79], v[248:251], v[68:71]
  s_waitcnt lgkmcnt(0)
  v_mfma_f32_16x16x32_bf16 v[32:35], a[76:79], v[80:83], v[32:35]
  v_mfma_f32_16x16x32_bf16 v[36:39], a[76:79], v[84:87], v[36:39]
  v_mfma_f32_16x16x32_bf16 v[40:43], a[156:159], v[80:83], v[40:43]
  v_mfma_f32_16x16x32_bf16 v[44:47], a[156:159], v[84:87], v[44:47]
  v_mfma_f32_16x16x32_bf16 v[48:51], a[236:239], v[80:83], v[48:51]
  v_mfma_f32_16x16x32_bf16 v[52:55], a[236:239], v[84:87], v[52:55]
  v_mfma_f32_16x16x32_bf16 v[56:59], v[172:175], v[80:83], v[56:59]
  v_mfma_f32_16x16x32_bf16 v[60:63], v[172:175], v[84:87], v[60:63]
  v_mfma_f32_16x16x32_bf16 v[64:67], v[80:83], v[252:255], v[64:67]
  v_mfma_f32_16x16x32_bf16 v[68:71], v[84:87], v[252:255], v[68:71]
  v_cvt_pk_bf16_f32 v8, v32, v33
  v_cvt_pk_bf16_f32 v9, v34, v35
  v_cvt_pk_bf16_f32 v10, v40, v41
  v_cvt_pk_bf16_f32 v11, v42, v43
  s_add_u32 s34, s21, 0
  buffer_store_dwordx4 v[8:11], v1, s[4:7], s34 offen
  v_cvt_pk_bf16_f32 v12, v36, v37
  v_cvt_pk_bf16_f32 v13, v38, v39
  v_cvt_pk_bf16_f32 v14, v44, v45
  v_cvt_pk_bf16_f32 v15, v46, v47
  s_add_u32 s34, s21, 6144
  buffer_store_dwordx4 v[12:15], v1, s[4:7], s34 offen
  v_cvt_pk_bf16_f32 v8, v48, v49
  v_cvt_pk_bf16_f32 v9, v50, v51
  v_cvt_pk_bf16_f32 v10, v56, v57
  v_cvt_pk_bf16_f32 v11, v58, v59
  s_add_u32 s34, s21, 1024
  buffer_store_dwordx4 v[8:11], v1, s[4:7], s34 offen
  v_cvt_pk_bf16_f32 v12, v52, v53
  v_cvt_pk_bf16_f32 v13, v54, v55
  v_cvt_pk_bf16_f32 v14, v60, v61
  v_cvt_pk_bf16_f32 v15, v62, v63
  s_add_u32 s34, s21, 7168
  buffer_store_dwordx4 v[12:15], v1, s[4:7], s34 offen
  v_cvt_pk_bf16_f32 v8, v64, v65
  v_cvt_pk_bf16_f32 v9, v66, v67
  v_cvt_pk_bf16_f32 v10, v68, v69
  v_cvt_pk_bf16_f32 v11, v70, v71
  s_add_u32 s34, s23, 0
  buffer_store_dwordx4 v[8:11], v1, s[4:7], s34 offen
  s_waitcnt vmcnt(0)
  s_barrier
  s_add_u32 s17, s17, 1
  v_mov_b32 v28, s17
  buffer_store_dword v28, v4, s[4:7], s24 offen
  s_cmp_lt_u32 s17, 64
  s_cbranch_scc1 reca_ptop165
  s_branch reca_exit1
reca_pslow164:
reca_ptop170:
  s_cmp_lt_u32 s17, 6
  s_cbranch_scc1 reca_pgo171
  s_sub_u32 s36, s17, 6
reca_ppoll172:
  buffer_load_dword v28, v4, s[4:7], s25 offen sc1
  s_waitcnt vmcnt(0)
  v_readfirstlane_b32 s34, v28
  s_nop 3
  s_cmp_ge_i32 s34, s36
  s_cbranch_scc1 reca_pgo171
  s_sleep 8
  s_sub_u32 s18, s18, 1
  s_cbranch_scc0 reca_ppoll172
  s_mov_b32 s18, 0
reca_pgo171:
  s_waitcnt vmcnt(0)
  s_barrier
  v_add_u32 v7, s26, v1
  s_xor_b32 s26, s26, 40960
  s_add_u32 s37, s17, 1
  s_cmp_ge_u32 s37, 64
  s_cbranch_scc1 reca_pnodma173
  s_mul_i32 s20, s37, 40960
  s_add_u32 s20, s20, 153616384
  s_add_u32 m0, s26, 0
  s_nop 0
  buffer_load_dwordx4 v1, s[4:7], s20 offen offset:0 lds
  buffer_load_dwordx4 v1, s[4:7], s20 offen offset:1024 lds
  buffer_load_dwordx4 v1, s[4:7], s20 offen offset:2048 lds
  buffer_load_dwordx4 v1, s[4:7], s20 offen offset:3072 lds
  s_add_u32 s20, s20, 4096
  s_add_u32 m0, s26, 4096
  s_nop 0
  buffer_load_dwordx4 v1, s[4:7], s20 offen offset:0 lds
  buffer_load_dwordx4 v1, s[4:7], s20 offen offset:1024 lds
  buffer_load_dwordx4 v1, s[4:7], s20 offen offset:2048 lds
  buffer_load_dwordx4 v1, s[4:7], s20 offen offset:3072 lds
  s_add_u32 s20, s20, 4096
  s_add_u32 m0, s26, 8192
  s_nop 0
  buffer_load_dwordx4 v1, s[4:7], s20 offen offset:0 lds
  buffer_load_dwordx4 v1, s[4:7], s20 offen offset:1024 lds
  s_lshl_b32 s34, s15, 6
  s_add_u32 s34, s34, s37
  s_mul_i32 s34, s34, 12288
  s_mul_i32 s35, s16, 3072
  s_add_u32 s35, s35, s34
  s_add_u32 s27, s35, 37748736
  s_mul_i32 s35, s16, 6144
  s_add_u32 s35, s35, s34
  s_add_u32 s28, s35, 62914560
  s_add_u32 s34, s27, 0
  buffer_load_dwordx4 v[16:19], v1, s[4:7], s34 offen sc1
  s_add_u32 s34, s27, 6144
  buffer_load_dwordx4 v[16:19], v1, s[4:7], s34 offen sc1
  s_add_u32 s34, s27, 1024
  buffer_load_dwordx4 v[16:19], v1, s[4:7], s34 offen sc1
  s_add_u32 s34, s27, 7168
  buffer_load_dwordx4 v[16:19], v1, s[4:7], s34 offen sc1
  s_add_u32 s34, s28, 0
  buffer_load_dwordx4 v[16:19], v1, s[4:7], s34 offen sc1
reca_pnodma173:
  s_lshl_b32 s34, s15, 6
  s_add_u32 s34, s34, s17
  s_mul_i32 s34, s34, 12288
  s_mul_i32 s35, s16, 3072
  s_add_u32 s35, s35, s34
  s_add_u32 s21, s35, 37748736
  s_add_u32 s22, s35, 88080384
  s_mul_i32 s35, s16, 6144
  s_add_u32 s35, s35, s34
  s_add_u32 s23, s35, 62914560
  ds_read_b128 v[72:75], v7 offset:0
  ds_read_b128 v[76:79], v7 offset:20480
  ds_read_b128 v[80:83], v7 offset:1024
  ds_read_b128 v[84:87], v7 offset:21504
  ds_read_b128 v[88:91], v7 offset:2048
  ds_read_b128 v[92:95], v7 offset:22528
  s_waitcnt lgkmcnt(4)
  v_mfma_f32_16x16x32_bf16 v[32:35], a[0:3], v[72:75], 0
  v_mfma_f32_16x16x32_bf16 v[36:39], a[0:3], v[76:79], 0
  v_mfma_f32_16x16x32_bf16 v[40:43], a[80:83], v[72:75], 0
  v_mfma_f32_16x16x32_bf16 v[44:47], a[80:83], v[76:79], 0
  v_mfma_f32_16x16x32_bf16 v[48:51], a[160:163], v[72:75], 0
  v_mfma_f32_16x16x32_bf16 v[52:55], a[160:163], v[76:79], 0
  v_mfma_f32_16x16x32_bf16 v[56:59], v[96:99], v[72:75], 0
  v_mfma_f32_16x16x32_bf16 v[60:63], v[96:99], v[76:79], 0
  v_mfma_f32_16x16x32_bf16 v[64:67], v[72:75], v[176:179], 0
  v_mfma_f32_16x16x32_bf16 v[68:71], v[76:79], v[176:179], 0
  ds_read_b128 v[72:75], v7 offset:3072
  ds_read_b128 v[76:79], v7 offset:23552
  s_waitcnt lgkmcnt(4)
  v_mfma_f32_16x16x32_bf16 v[32:35], a[4:7], v[80:83], v[32:35]
  v_mfma_f32_16x16x32_bf16 v[36:39], a[4:7], v[84:87], v[36:39]
  v_mfma_f32_16x16x32_bf16 v[40:43], a[84:87], v[80:83], v[40:43]
  v_mfma_f32_16x16x32_bf16 v[44:47], a[84:87], v[84:87], v[44:47]
  v_mfma_f32_16x16x32_bf16 v[48:51], a[164:167], v[80:83], v[48:51]
  v_mfma_f32_16x16x32_bf16 v[52:55], a[164:167], v[84:87], v[52:55]
  v_mfma_f32_16x16x32_bf16 v[56:59], v[100:103], v[80:83], v[56:59]
  v_mfma_f32_16x16x32_bf16 v[60:63], v[100:103], v[84:87], v[60:63]
  v_mfma_f32_16x16x32_bf16 v[64:67], v[80:83], v[180:183], v[64:67]
  v_mfma_f32_16x16x32_bf16 v[68:71], v[84:87], v[180:183], v[68:71]
  ds_read_b128 v[80:83], v7 offset:4096
  ds_read_b128 v[84:87], v7 offset:24576
  s_waitcnt lgkmcnt(4)
  v_mfma_f32_16x16x32_bf16 v[32:35], a[8:11], v[88:91], v[32:35]
  v_mfma_f32_16x16x32_bf16 v[36:39], a[8:11], v[92:95], v[36:39]
  v_mfma_f32_16x16x32_bf16 v[40:43], a[88:91], v[88:91], v[40:43]
  v_mfma_f32_16x16x32_bf16 v[44:47], a[88:91], v[92:95], v[44:47]
  v_mfma_f32_16x16x32_bf16 v[48:51], a[168:171], v[88:91], v[48:51]
  v_mfma_f32_16x16x32_bf16 v[52:55], a[168:171], v[92:95], v[52:55]
  v_mfma_f32_16x16x32_bf16 v[56:59], v[104:107], v[88:91], v[56:59]
  v_mfma_f32_16x16x32_bf16 v[60:63], v[104:107], v[92:95], v[60:63]
  v_mfma_f32_16x16x32_bf16 v[64:67], v[88:91], v[184:187], v[64:67]
  v_mfma_f32_16x16x32_bf16 v[68:71], v[92:95], v[184:187], v[68:71]
  ds_read_b128 v[88:91], v7 offset:5120
  ds_read_b128 v[92:95], v7 offset:25600
  s_waitcnt lgkmcnt(4)
  v_mfma_f32_16x16x32_bf16 v[32:35], a[12:15], v[72:75], v[32:35]
  v_mfma_f32_16x16x32_bf16 v[36:39], a[12:15], v[76:79], v[36:39]
  v_mfma_f32_16x16x32_bf16 v[40:43], a[92:95], v[72:75], v[40:43]
  v_mfma_f32_16x16x32_bf16 v[44:47], a[92:95], v[76:79], v[44:47]
  v_mfma_f32_16x16x32_bf16 v[48:51], a[172:175], v[72:75], v[48:51]
  v_mfma_f32_16x16x32_bf16 v[52:55], a[172:175], v[76:79], v[52:55]
  v_mfma_f32_16x16x32_bf16 v[56:59], v[108:111], v[72:75], v[56:59]
  v_mfma_f32_16x16x32_bf16 v[60:63], v[108:111], v[76:79], v[60:63]
  v_mfma_f32_16x16x32_bf16 v[64:67], v[72:75], v[188:191], v[64:67]
  v_mfma_f32_16x16x32_bf16 v[68:71], v[76:79], v[188:191], v[68:71]
  ds_read_b128 v[72:75], v7 offset:6144
  ds_read_b128 v[76:79], v7 offset:26624
  s_waitcnt lgkmcnt(4)
  v_mfma_f32_16x16x32_bf16 v[32:35], a[16:19], v[80:83], v[32:35]
  v_mfma_f32_16x16x32_bf16 v[36:39], a[16:19], v[84:87], v[36:39]
  v_mfma_f32_16x16x32_bf16 v[40:43], a[96:99], v[80:83], v[40:43]
  v_mfma_f32_16x16x32_bf16 v[44:47], a[96:99], v[84:87], v[44:47]
  v_mfma_f32_16x16x32_bf16 v[48:51], a[176:179], v[80:83], v[48:51]
  v_mfma_f32_16x16x32_bf16 v[52:55], a[176:179], v[84:87], v[52:55]
  v_mfma_f32_16x16x32_bf16 v[56:59], v[112:115], v[80:83], v[56:59]
  v_mfma_f32_16x16x32_bf16 v[60:63], v[112:115], v[84:87], v[60:63]
  v_mfma_f32_16x16x32_bf16 v[64:67], v[80:83], v[192:195], v[64:67]
  v_mfma_f32_16x16x32_bf16 v[68:71], v[84:87], v[192:195], v[68:71]
  ds_read_b128 v[80:83], v7 offset:7168
  ds_read_b128 v[84:87], v7 offset:27648
  s_waitcnt lgkmcnt(4)
  v_mfma_f32_16x16x32_bf16 v[32:35], a[20:23], v[88:91], v[32:35]
  v_mfma_f32_16x16x32_bf16 v[36:39], a[20:23], v[92:95], v[36:39]
  v_mfma_f32_16x16x32_bf16 v[40:43], a[100:103], v[88:91], v[40:43]
  v_mfma_f32_16x16x32_bf16 v[44:47], a[100:103], v[92:95], v[44:47]
  v_mfma_f32_16x16x32_bf16 v[48:51], a[180:183], v[88:91], v[48:51]
  v_mfma_f32_16x16x32_bf16 v[52:55], a[180:183], v[92:95], v[52:55]
  v_mfma_f32_16x16x32_bf16 v[56:59], v[116:119], v[88:91], v[56:59]
  v_mfma_f32_16x16x32_bf16 v[60:63], v[116:119], v[92:95], v[60:63]
  v_mfma_f32_16x16x32_bf16 v[64:67], v[88:91], v[196:199], v[64:67]
  v_mfma_f32_16x16x32_bf16 v[68:71], v[92:95], v[196:199], v[68:71]
  ds_read_b128 v[88:91], v7 offset:8192
  ds_read_b128 v[92:95], v7 offset:28672
  s_waitcnt lgkmcnt(4)
  v_mfma_f32_16x16x32_bf16 v[32:35], a[24:27], v[72:75], v[32:35]
  v_mfma_f32_16x16x32_bf16 v[36:39], a[24:27], v[76:79], v[36:39]
  v_mfma_f32_16x16x32_bf16 v[40:43], a[104:107], v[72:75], v[40:43]
  v_mfma_f32_16x16x32_bf16 v[44:47], a[104:107], v[76:79], v[44:47]
  v_mfma_f32_16x16x32_bf16 v[48:51], a[184:187], v[72:75], v[48:51]
  v_mfma_f32_16x16x32_bf16 v[52:55], a[184:187], v[76:79], v[52:55]
  v_mfma_f32_16x16x32_bf16 v[56:59], v[120:123], v[72:75], v[56:59]
  v_mfma_f32_16x16x32_bf16 v[60:63], v[120:123], v[76:79], v[60:63]
  v_mfma_f32_16x16x32_bf16 v[64:67], v[72:75], v[200:203], v[64:67]
  v_mfma_f32_16x16x32_bf16 v[68:71], v[76:79], v[200:203], v[68:71]
  ds_read_b128 v[72:75], v7 offset:9216
  ds_read_b128 v[76:79], v7 offset:29696
  s_waitcnt lgkmcnt(4)
  v_mfma_f32_16x16x32_bf16 v[32:35], a[28:31], v[80:83], v[32:35]
  v_mfma_f32_16x16x32_bf16 v[36:39], a[28:31], v[84:87], v[36:39]
  v_mfma_f32_16x16x32_bf16 v[40:43], a[108:111], v[80:83], v[40:43]
  v_mfma_f32_16x16x32_bf16 v[44:47], a[108:111], v[84:87], v[44:47]
  v_mfma_f32_16x16x32_bf16 v[48:51], a[188:191], v[80:83], v[48:51]
  v_mfma_f32_16x16x32_bf16 v[52:55], a[188:191], v[84:87], v[52:55]
  v_mfma_f32_16x16x32_bf16 v[56:59], v[124:127], v[80:83], v[56:59]
  v_mfma_f32_16x16x32_bf16 v[60:63], v[124:127], v[84:87], v[60:63]
  v_mfma_f32_16x16x32_bf16 v[64:67], v[80:83], v[204:207], v[64:67]
  v_mfma_f32_16x16x32_bf16 v[68:71], v[84:87], v[204:207], v[68:71]
  ds_read_b128 v[80:83], v7 offset:10240
  ds_read_b128 v[84:87], v7 offset:30720
  s_waitcnt lgkmcnt(4)
  v_mfma_f32_16x16x32_bf16 v[32:35], a[32:35], v[88:91], v[32:35]
  v_mfma_f32_16x16x32_bf16 v[36:39], a[32:35], v[92:95], v[36:39]
  v_mfma_f32_16x16x32_bf16 v[40:43], a[112:115], v[88:91], v[40:43]
  v_mfma_f32_16x16x32_bf16 v[44:47], a[112:115], v[92:95], v[44:47]
  v_mfma_f32_16x16x32_bf16 v[48:51], a[192:195], v[88:91], v[48:51]
  v_mfma_f32_16x16x32_bf16 v[52:55], a[192:195], v[92:95], v[52:55]
  v_mfma_f32_16x16x32_bf16 v[56:59], v[128:131], v[88:91], v[56:59]
  v_mfma_f32_16x16x32_bf16 v[60:63], v[128:131], v[92:95], v[60:63]
  v_mfma_f32_16x16x32_bf16 v[64:67], v[88:91], v[208:211], v[64:67]
  v_mfma_f32_16x16x32_bf16 v[68:71], v[92:95], v[208:211], v[68:71]
  ds_read_b128 v[88:91], v7 offset:11264
  ds_read_b128 v[92:95], v7 offset:31744
  s_waitcnt lgkmcnt(4)
  v_mfma_f32_16x16x32_bf16 v[32:35], a[36:39], v[72:75], v[32:35]
  v_mfma_f32_16x16x32_bf16 v[36:39], a[36:39], v[76:79], v[36:39]
  v_mfma_f32_16x16x32_bf16 v[40:43], a[116:119], v[72:75], v[40:43]
  v_mfma_f32_16x16x32_bf16 v[44:47], a[116:119], v[76:79], v[44:47]
  v_mfma_f32_16x16x32_bf16 v[48:51], a[196:199], v[72:75], v[48:51]
  v_mfma_f32_16x16x32_bf16 v[52:55], a[196:199], v[76:79], v[52:55]
  v_mfma_f32_16x16x32_bf16 v[56:59], v[132:135], v[72:75], v[56:59]
  v_mfma_f32_16x16x32_bf16 v[60:63], v[132:135], v[76:79], v[60:63]
  v_mfma_f32_16x16x32_bf16 v[64:67], v[72:75], v[212:215], v[64:67]
  v_mfma_f32_16x16x32_bf16 v[68:71], v[76:79], v[212:215], v[68:71]
  ds_read_b128 v[72:75], v7 offset:12288
  ds_read_b128 v[76:79], v7 offset:32768
  s_waitcnt lgkmcnt(4)
  v_mfma_f32_16x16x32_bf16 v[32:35], a[40:43], v[80:83], v[32:35]
  v_mfma_f32_16x16x32_bf16 v[36:39], a[40:43], v[84:87], v[36:39]
  v_mfma_f32_16x16x32_bf16 v[40:43], a[120:123], v[80:83], v[40:43]
  v_mfma_f32_16x16x32_bf16 v[44:47], a[120:123], v[84:87], v[44:47]
  v_mfma_f32_16x16x32_bf16 v[48:51], a[200:203], v[80:83], v[48:51]
  v_mfma_f32_16x16x32_bf16 v[52:55], a[200:203], v[84:87], v[52:55]
  v_mfma_f32_16x16x32_bf16 v[56:59], v[136:139], v[80:83], v[56:59]
  v_mfma_f32_16x16x32_bf16 v[60:63], v[136:139], v[84:87], v[60:63]
  v_mfma_f32_16x16x32_bf16 v[64:67], v[80:83], v[216:219], v[64:67]
  v_mfma_f32_16x16x32_bf16 v[68:71], v[84:87], v[216:219], v[68:71]
  ds_read_b128 v[80:83], v7 offset:13312
  ds_read_b128 v[84:87], v7 offset:33792
  s_waitcnt lgkmcnt(4)
  v_mfma_f32_16x16x32_bf16 v[32:35], a[44:47], v[88:91], v[32:35]
  v_mfma_f32_16x16x32_bf16 v[36:39], a[44:47], v[92:95], v[36:39]
  v_mfma_f32_16x16x32_bf16 v[40:43], a[124:127], v[88:91], v[40:43]
  v_mfma_f32_16x16x32_bf16 v[44:47], a[124:127], v[92:95], v[44:47]
  v_mfma_f32_16x16x32_bf16 v[48:51], a[204:207], v[88:91], v[48:51]
  v_mfma_f32_16x16x32_bf16 v[52:55], a[204:207], v[92:95], v[52:55]
  v_mfma_f32_16x16x32_bf16 v[56:59], v[140:143], v[88:91], v[56:59]
  v_mfma_f32_16x16x32_bf16 v[60:63], v[140:143], v[92:95], v[60:63]
  v_mfma_f32_16x16x32_bf16 v[64:67], v[88:91], v[220:223], v[64:67]
  v_mfma_f32_16x16x32_bf16 v[68:71], v[92:95], v[220:223], v[68:71]
  ds_read_b128 v[88:91], v7 offset:14336
  ds_read_b128 v[92:95], v7 offset:34816
  s_waitcnt lgkmcnt(4)
  v_mfma_f32_16x16x32_bf16 v[32:35], a[48:51], v[72:75], v[32:35]
  v_mfma_f32_16x16x32_bf16 v[36:39], a[48:51], v[76:79], v[36:39]
  v_mfma_f32_16x16x32_bf16 v[40:43], a[128:131], v[72:75], v[40:43]
  v_mfma_f32_16x16x32_bf16 v[44:47], a[128:131], v[76:79], v[44:47]
  v_mfma_f32_16x16x32_bf16 v[48:51], a[208:211], v[72:75], v[48:51]
  v_mfma_f32_16x16x32_bf16 v[52:55], a[208:211], v[76:79], v[52:55]
  v_mfma_f32_16x16x32_bf16 v[56:59], v[144:147], v[72:75], v[56:59]
  v_mfma_f32_16x16x32_bf16 v[60:63], v[144:147], v[76:79], v[60:63]
  v_mfma_f32_16x16x32_bf16 v[64:67], v[72:75], v[224:227], v[64:67]
  v_mfma_f32_16x16x32_bf16 v[68:71], v[76:79], v[224:227], v[68:71]
  ds_read_b128 v[72:75], v7 offset:15360
  ds_read_b128 v[76:79], v7 offset:35840
  s_waitcnt lgkmcnt(4)
  v_mfma_f32_16x16x32_bf16 v[32:35], a[52:55], v[80:83], v[32:35]
  v_mfma_f32_16x16x32_bf16 v[36:39], a[52:55], v[84:87], v[36:39]
  v_mfma_f32_16x16x32_bf16 v[40:43], a[132:135], v[80:83], v[40:43]
  v_mfma_f32_16x16x32_bf16 v[44:47], a[132:135], v[84:87], v[44:47]
  v_mfma_f32_16x16x32_bf16 v[48:51], a[212:215], v[80:83], v[48:51]
  v_mfma_f32_16x16x32_bf16 v[52:55], a[212:215], v[84:87], v[52:55]
  v_mfma_f32_16x16x32_bf16 v[56:59], v[148:151], v[80:83], v[56:59]
  v_mfma_f32_16x16x32_bf16 v[60:63], v[148:151], v[84:87], v[60:63]
  v_mfma_f32_16x16x32_bf16 v[64:67], v[80:83], v[228:231], v[64:67]
  v_mfma_f32_16x16x32_bf16 v[68:71], v[84:87], v[228:231], v[68:71]
  ds_read_b128 v[80:83], v7 offset:16384
  ds_read_b128 v[84:87], v7 offset:36864
  s_waitcnt lgkmcnt(4)
  v_mfma_f32_16x16x32_bf16 v[32:35], a[56:59], v[88:91], v[32:35]
  v_mfma_f32_16x16x32_bf16 v[36:39], a[56:59], v[92:95], v[36:39]
  v_mfma_f32_16x16x32_bf16 v[40:43], a[136:139], v[88:91], v[40:43]
  v_mfma_f32_16x16x32_bf16 v[44:47], a[136:139], v[92:95], v[44:47]
  v_mfma_f32_16x16x32_bf16 v[48:51], a[216:219], v[88:91], v[48:51]
  v_mfma_f32_16x16x32_bf16 v[52:55], a[216:219], v[92:95], v[52:55]
  v_mfma_f32_16x16x32_bf16 v[56:59], v[152:155], v[88:91], v[56:59]
  v_mfma_f32_16x16x32_bf16 v[60:63], v[152:155], v[92:95], v[60:63]
  v_mfma_f32_16x16x32_bf16 v[64:67], v[88:91], v[232:235], v[64:67]
  v_mfma_f32_16x16x32_bf16 v[68:71], v[92:95], v[232:235], v[68:71]
  ds_read_b128 v[88:91], v7 offset:17408
  ds_read_b128 v[92:95], v7 offset:37888
  s_waitcnt lgkmcnt(4)
  v_mfma_f32_16x16x32_bf16 v[32:35], a[60:63], v[72:75], v[32:35]
  v_mfma_f32_16x16x32_bf16 v[36:39], a[60:63], v[76:79], v[36:39]
  v_mfma_f32_16x16x32_bf16 v[40:43], a[140:143], v[72:75], v[40:43]
  v_mfma_f32_16x16x32_bf16 v[44:47], a[140:143], v[76:79], v[44:47]
  v_mfma_f32_16x16x32_bf16 v[48:51], a[220:223], v[72:75], v[48:51]
  v_mfma_f32_16x16x32_bf16 v[52:55], a[220:223], v[76:79], v[52:55]
  v_mfma_f32_16x16x32_bf16 v[56:59], v[156:159], v[72:75], v[56:59]
  v_mfma_f32_16x16x32_bf16 v[60:63], v[156:159], v[76:79], v[60:63]
  v_mfma_f32_16x16x32_bf16 v[64:67], v[72:75], v[236:239], v[64:67]
  v_mfma_f32_16x16x32_bf16 v[68:71], v[76:79], v[236:239], v[68:71]
  ds_read_b128 v[72:75], v7 offset:18432
  ds_read_b128 v[76:79], v7 offset:38912
  s_waitcnt lgkmcnt(4)
  v_mfma_f32_16x16x32_bf16 v[32:35], a[64:67], v[80:83], v[32:35]
  v_mfma_f32_16x16x32_bf16 v[36:39], a[64:67], v[84:87], v[36:39]
  v_mfma_f32_16x16x32_bf16 v[40:43], a[144:147], v[80:83], v[40:43]
  v_mfma_f32_16x16x32_bf16 v[44:47], a[144:147], v[84:87], v[44:47]
  v_mfma_f32_16x16x32_bf16 v[48:51], a[224:227], v[80:83], v[48:51]
  v_mfma_f32_16x16x32_bf16 v[52:55], a[224:227], v[84:87], v[52:55]
  v_mfma_f32_16x16x32_bf16 v[56:59], v[160:163], v[80:83], v[56:59]
  v_mfma_f32_16x16x32_bf16 v[60:63], v[160:163], v[84:87], v[60:63]
  v_mfma_f32_16x16x32_bf16 v[64:67], v[80:83], v[240:243], v[64:67]
  v_mfma_f32_16x16x32_bf16 v[68:71], v[84:87], v[240:243], v[68:71]
  ds_read_b128 v[80:83], v7 offset:19456
  ds_read_b128 v[84:87], v7 offset:39936
  s_waitcnt lgkmcnt(4)
  v_mfma_f32_16x16x32_bf16 v[32:35], a[68:71], v[88:91], v[32:35]
  v_mfma_f32_16x16x32_bf16 v[36:39], a[68:71], v[92:95], v[36:39]
  v_mfma_f32_16x16x32_bf16 v[40:43], a[148:151], v[88:91], v[40:43]
  v_mfma_f32_16x16x32_bf16 v[44:47], a[148:151], v[92:95], v[44:47]
  v_mfma_f32_16x16x32_bf16 v[48:51], a[228:231], v[88:91], v[48:51]
  v_mfma_f32_16x16x32_bf16 v[52:55], a[228:231], v[92:95], v[52:55]
  v_mfma_f32_16x16x32_bf16 v[56:59], v[164:167], v[88:91], v[56:59]
  v_mfma_f32_16x16x32_bf16 v[60:63], v[164:167], v[92:95], v[60:63]
  v_mfma_f32_16x16x32_bf16 v[64:67], v[88:91], v[244:247], v[64:67]
  v_mfma_f32_16x16x32_bf16 v[68:71], v[92:95], v[244:247], v[68:71]
  s_waitcnt lgkmcnt(2)
  v_mfma_f32_16x16x32_bf16 v[32:35], a[72:75], v[72:75], v[32:35]
  v_mfma_f32_16x16x32_bf16 v[36:39], a[72:75], v[76:79], v[36:39]
  v_mfma_f32_16x16x32_bf16 v[40:43], a[152:155], v[72:75], v[40:43]
  v_mfma_f32_16x16x32_bf16 v[44:47], a[152:155], v[76:79], v[44:47]
  v_mfma_f32_16x16x32_bf16 v[48:51], a[232:235], v[72:75], v[48:51]
  v_mfma_f32_16x16x32_bf16 v[52:55], a[232:235], v[76:79], v[52:55]
  v_mfma_f32_16x16x32_bf16 v[56:59], v[168:171], v[72:75], v[56:59]
  v_mfma_f32_16x16x32_bf16 v[60:63], v[168:171], v[76:79], v[60:63]
  v_mfma_f32_16x16x32_bf16 v[64:67], v[72:75], v[248:251], v[64:67]
  v_mfma_f32_16x16x32_bf16 v[68:71], v[76:79], v[248:251], v[68:71]
  s_waitcnt lgkmcnt(0)
  v_mfma_f32_16x16x32_bf16 v[32:35], a[76:79], v[80:83], v[32:35]
  v_mfma_f32_16x16x32_bf16 v[36:39], a[76:79], v[84:87], v[36:39]
  v_mfma_f32_16x16x32_bf16 v[40:43], a[156:159], v[80:83], v[40:43]
  v_mfma_f32_16x16x32_bf16 v[44:47], a[156:159], v[84:87], v[44:47]
  v_mfma_f32_16x16x32_bf16 v[48:51], a[236:239], v[80:83], v[48:51]
  v_mfma_f32_16x16x32_bf16 v[52:55], a[236:239], v[84:87], v[52:55]
  v_mfma_f32_16x16x32_bf16 v[56:59], v[172:175], v[80:83], v[56:59]
  v_mfma_f32_16x16x32_bf16 v[60:63], v[172:175], v[84:87], v[60:63]
  v_mfma_f32_16x16x32_bf16 v[64:67], v[80:83], v[252:255], v[64:67]
  v_mfma_f32_16x16x32_bf16 v[68:71], v[84:87], v[252:255], v[68:71]
  v_cvt_pk_bf16_f32 v8, v32, v33
  v_cvt_pk_bf16_f32 v9, v34, v35
  v_cvt_pk_bf16_f32 v10, v40, v41
  v_cvt_pk_bf16_f32 v11, v42, v43
  s_add_u32 s34, s21, 0
  buffer_store_dwordx4 v[8:11], v1, s[4:7], s34 offen sc1
  v_cvt_pk_bf16_f32 v12, v36, v37
  v_cvt_pk_bf16_f32 v13, v38, v39
  v_cvt_pk_bf16_f32 v14, v44, v45
  v_cvt_pk_bf16_f32 v15, v46, v47
  s_add_u32 s34, s21, 6144
  buffer_store_dwordx4 v[12:15], v1, s[4:7], s34 offen sc1
  v_cvt_pk_bf16_f32 v8, v48, v49
  v_cvt_pk_bf16_f32 v9, v50, v51
  v_cvt_pk_bf16_f32 v10, v56, v57
  v_cvt_pk_bf16_f32 v11, v58, v59
  s_add_u32 s34, s21, 1024
  buffer_store_dwordx4 v[8:11], v1, s[4:7], s34 offen sc1
  v_cvt_pk_bf16_f32 v12, v52, v53
  v_cvt_pk_bf16_f32 v13, v54, v55
  v_cvt_pk_bf16_f32 v14, v60, v61
  v_cvt_pk_bf16_f32 v15, v62, v63
  s_add_u32 s34, s21, 7168
  buffer_store_dwordx4 v[12:15], v1, s[4:7], s34 offen sc1
  v_cvt_pk_bf16_f32 v8, v64, v65
  v_cvt_pk_bf16_f32 v9, v66, v67
  v_cvt_pk_bf16_f32 v10, v68, v69
  v_cvt_pk_bf16_f32 v11, v70, v71
  s_add_u32 s34, s23, 0
  buffer_store_dwordx4 v[8:11], v1, s[4:7], s34 offen sc1
  s_waitcnt vmcnt(0)
  s_barrier
  s_add_u32 s17, s17, 1
  v_mov_b32 v28, s17
  buffer_store_dword v28, v4, s[4:7], s24 offen sc1
  s_cmp_lt_u32 s17, 64
  s_cbranch_scc1 reca_ptop170
  s_branch reca_exit1
reca_pw1_159:
  s_mov_b32 s17, 0
  s_mov_b32 s26, 0
  s_mul_i32 s20, s17, 40960
  s_add_u32 s20, s20, 153626624
  s_add_u32 m0, s26, 10240
  s_nop 0
  buffer_load_dwordx4 v1, s[4:7], s20 offen offset:0 lds
  buffer_load_dwordx4 v1, s[4:7], s20 offen offset:1024 lds
  buffer_load_dwordx4 v1, s[4:7], s20 offen offset:2048 lds
  buffer_load_dwordx4 v1, s[4:7], s20 offen offset:3072 lds
  s_add_u32 s20, s20, 4096
  s_add_u32 m0, s26, 14336
  s_nop 0
  buffer_load_dwordx4 v1, s[4:7], s20 offen offset:0 lds
  buffer_load_dwordx4 v1, s[4:7], s20 offen offset:1024 lds
  buffer_load_dwordx4 v1, s[4:7], s20 offen offset:2048 lds
  buffer_load_dwordx4 v1, s[4:7], s20 offen offset:3072 lds
  s_add_u32 s20, s20, 4096
  s_add_u32 m0, s26, 18432
  s_nop 0
  buffer_load_dwordx4 v1, s[4:7], s20 offen offset:0 lds
  buffer_load_dwordx4 v1, s[4:7], s20 offen offset:1024 lds
  s_lshl_b32 s34, s15, 6
  s_add_u32 s34, s34, s17
  s_mul_i32 s34, s34, 12288
  s_mul_i32 s35, s16, 3072
  s_add_u32 s35, s35, s34
  s_add_u32 s27, s35, 37748736
  s_mul_i32 s35, s16, 6144
  s_add_u32 s35, s35, s34
  s_add_u32 s28, s35, 62914560
  s_add_u32 s34, s27, 2048
  buffer_load_dwordx4 v[16:19], v1, s[4:7], s34 offen sc1
  s_add_u32 s34, s27, 8192
  buffer_load_dwordx4 v[16:19], v1, s[4:7], s34 offen sc1
  s_add_u32 s34, s28, 1024
  buffer_load_dwordx4 v[16:19], v1, s[4:7], s34 offen sc1
  s_add_u32 s34, s28, 2048
  buffer_load_dwordx4 v[16:19], v1, s[4:7], s34 offen sc1
  s_add_u32 s34, s28, 3072
  buffer_load_dwordx4 v[16:19], v1, s[4:7], s34 offen sc1
  s_mul_i32 s34, s15, 12
  s_mul_i32 s35, s16, 6
  s_add_u32 s34, s34, s35
  s_add_u32 s34, s34, 4
  s_mul_i32 s34, s34, 20480
  s_add_u32 s34, s34, 14155776
  buffer_load_dwordx4 a[0:3], v1, s[4:7], s34 offen offset:0
  buffer_load_dwordx4 a[4:7], v1, s[4:7], s34 offen offset:1024
  buffer_load_dwordx4 a[8:11], v1, s[4:7], s34 offen offset:2048
  buffer_load_dwordx4 a[12:15], v1, s[4:7], s34 offen offset:3072
  s_add_u32 s34, s34, 4096
  buffer_load_dwordx4 a[16:19], v1, s[4:7], s34 offen offset:0
  buffer_load_dwordx4 a[20:23], v1, s[4:7], s34 offen offset:1024
  buffer_load_dwordx4 a[24:27], v1, s[4:7], s34 offen offset:2048
  buffer_load_dwordx4 a[28:31], v1, s[4:7], s34 offen offset:3072
  s_add_u32 s34, s34, 4096
  buffer_load_dwordx4 a[32:35], v1, s[4:7], s34 offen offset:0
  buffer_load_dwordx4 a[36:39], v1, s[4:7], s34 offen offset:1024
  buffer_load_dwordx4 a[40:43], v1, s[4:7], s34 offen offset:2048
  buffer_load_dwordx4 a[44:47], v1, s[4:7], s34 offen offset:3072
  s_add_u32 s34, s34, 4096
  buffer_load_dwordx4 a[48:51], v1, s[4:7], s34 offen offset:0
  buffer_load_dwordx4 a[52:55], v1, s[4:7], s34 offen offset:1024
  buffer_load_dwordx4 a[56:59], v1, s[4:7], s34 offen offset:2048
  buffer_load_dwordx4 a[60:63], v1, s[4:7], s34 offen offset:3072
  s_add_u32 s34, s34, 4096
  buffer_load_dwordx4 a[64:67], v1, s[4:7], s34 offen offset:0
  buffer_load_dwordx4 a[68:71], v1, s[4:7], s34 offen offset:1024
  buffer_load_dwordx4 a[72:75], v1, s[4:7], s34 offen offset:2048
  buffer_load_dwordx4 a[76:79], v1, s[4:7], s34 offen offset:3072
  s_mul_i32 s34, s15, 12
  s_mul_i32 s35, s16, 6
  s_add_u32 s34, s34, s35
  s_add_u32 s34, s34, 5
  s_mul_i32 s34, s34, 20480
  s_add_u32 s34, s34, 14155776
  buffer_load_dwordx4 a[80:83], v1, s[4:7], s34 offen offset:0
  buffer_load_dwordx4 a[84:87], v1, s[4:7], s34 offen offset:1024
  buffer_load_dwordx4 a[88:91], v1, s[4:7], s34 offen offset:2048
  buffer_load_dwordx4 a[92:95], v1, s[4:7], s34 offen offset:3072
  s_add_u32 s34, s34, 4096
  buffer_load_dwordx4 a[96:99], v1, s[4:7], s34 offen offset:0
  buffer_load_dwordx4 a[100:103], v1, s[4:7], s34 offen offset:1024
  buffer_load_dwordx4 a[104:107], v1, s[4:7], s34 offen offset:2048
  buffer_load_dwordx4 a[108:111], v1, s[4:7], s34 offen offset:3072
  s_add_u32 s34, s34, 4096
  buffer_load_dwordx4 a[112:115], v1, s[4:7], s34 offen offset:0
  buffer_load_dwordx4 a[116:119], v1, s[4:7], s34 offen offset:1024
  buffer_load_dwordx4 a[120:123], v1, s[4:7], s34 offen offset:2048
  buffer_load_dwordx4 a[124:127], v1, s[4:7], s34 offen offset:3072
  s_add_u32 s34, s34, 4096
  buffer_load_dwordx4 a[128:131], v1, s[4:7], s34 offen offset:0
  buffer_load_dwordx4 a[132:135], v1, s[4:7], s34 offen offset:1024
  buffer_load_dwordx4 a[136:139], v1, s[4:7], s34 offen offset:2048
  buffer_load_dwordx4 a[140:143], v1, s[4:7], s34 offen offset:3072
  s_add_u32 s34, s34, 4096
  buffer_load_dwordx4 a[144:147], v1, s[4:7], s34 offen offset:0
  buffer_load_dwordx4 a[148:151], v1, s[4:7], s34 offen offset:1024
  buffer_load_dwordx4 a[152:155], v1, s[4:7], s34 offen offset:2048
  buffer_load_dwordx4 a[156:159], v1, s[4:7], s34 offen offset:3072
  s_waitcnt vmcnt(20)
  s_mul_i32 s34, s15, 12
  s_mul_i32 s35, s16, 6
  s_add_u32 s34, s34, s35
  s_add_u32 s34, s34, 1
  s_mul_i32 s34, s34, 20480
  s_add_u32 s34, s34, 22020096
  buffer_load_dwordx4 a[160:163], v1, s[4:7], s34 offen offset:0
  buffer_load_dwordx4 a[164:167], v1, s[4:7], s34 offen offset:1024
  buffer_load_dwordx4 a[168:171], v1, s[4:7], s34 offen offset:2048
  buffer_load_dwordx4 a[172:175], v1, s[4:7], s34 offen offset:3072
  s_add_u32 s34, s34, 4096
  buffer_load_dwordx4 a[176:179], v1, s[4:7], s34 offen offset:0
  buffer_load_dwordx4 a[180:183], v1, s[4:7], s34 offen offset:1024
  buffer_load_dwordx4 a[184:187], v1, s[4:7], s34 offen offset:2048
  buffer_load_dwordx4 a[188:191], v1, s[4:7], s34 offen offset:3072
  s_add_u32 s34, s34, 4096
  buffer_load_dwordx4 a[192:195], v1, s[4:7], s34 offen offset:0
  buffer_load_dwordx4 a[196:199], v1, s[4:7], s34 offen offset:1024
  buffer_load_dwordx4 a[200:203], v1, s[4:7], s34 offen offset:2048
  buffer_load_dwordx4 a[204:207], v1, s[4:7], s34 offen offset:3072
  s_add_u32 s34, s34, 4096
  buffer_load_dwordx4 a[208:211], v1, s[4:7], s34 offen offset:0
  buffer_load_dwordx4 a[212:215], v1, s[4:7], s34 offen offset:1024
  buffer_load_dwordx4 a[216:219], v1, s[4:7], s34 offen offset:2048
  buffer_load_dwordx4 a[220:223], v1, s[4:7], s34 offen offset:3072
  s_add_u32 s34, s34, 4096
  buffer_load_dwordx4 a[224:227], v1, s[4:7], s34 offen offset:0
  buffer_load_dwordx4 a[228:231], v1, s[4:7], s34 offen offset:1024
  buffer_load_dwordx4 a[232:235], v1, s[4:7], s34 offen offset:2048
  buffer_load_dwordx4 a[236:239], v1, s[4:7], s34 offen offset:3072
  s_waitcnt vmcnt(20)
  s_mul_i32 s34, s15, 12
  s_mul_i32 s35, s16, 6
  s_add_u32 s34, s34, s35
  s_add_u32 s34, s34, 2
  s_mul_i32 s34, s34, 20480
  s_add_u32 s34, s34, 22020096
  buffer_load_dwordx4 v[96:99], v1, s[4:7], s34 offen offset:0
  buffer_load_dwordx4 v[100:103], v1, s[4:7], s34 offen offset:1024
  buffer_load_dwordx4 v[104:107], v1, s[4:7], s34 offen offset:2048
  buffer_load_dwordx4 v[108:111], v1, s[4:7], s34 offen offset:3072
  s_add_u32 s34, s34, 4096
  buffer_load_dwordx4 v[112:115], v1, s[4:7], s34 offen offset:0
  buffer_load_dwordx4 v[116:119], v1, s[4:7], s34 offen offset:1024
  buffer_load_dwordx4 v[120:123], v1, s[4:7], s34 offen offset:2048
  buffer_load_dwordx4 v[124:127], v1, s[4:7], s34 offen offset:3072
  s_add_u32 s34, s34, 4096
  buffer_load_dwordx4 v[128:131], v1, s[4:7], s34 offen offset:0
  buffer_load_dwordx4 v[132:135], v1, s[4:7], s34 offen offset:1024
  buffer_load_dwordx4 v[136:139], v1, s[4:7], s34 offen offset:2048
  buffer_load_dwordx4 v[140:143], v1, s[4:7], s34 offen offset:3072
  s_add_u32 s34, s34, 4096
  buffer_load_dwordx4 v[144:147], v1, s[4:7], s34 offen offset:0
  buffer_load_dwordx4 v[148:151], v1, s[4:7], s34 offen offset:1024
  buffer_load_dwordx4 v[152:155], v1, s[4:7], s34 offen offset:2048
  buffer_load_dwordx4 v[156:159], v1, s[4:7], s34 offen offset:3072
  s_add_u32 s34, s34, 4096
  buffer_load_dwordx4 v[160:163], v1, s[4:7], s34 offen offset:0
  buffer_load_dwordx4 v[164:167], v1, s[4:7], s34 offen offset:1024
  buffer_load_dwordx4 v[168:171], v1, s[4:7], s34 offen offset:2048
  buffer_load_dwordx4 v[172:175], v1, s[4:7], s34 offen offset:3072
  s_waitcnt vmcnt(20)
  s_mul_i32 s34, s15, 12
  s_mul_i32 s35, s16, 6
  s_add_u32 s34, s34, s35
  s_add_u32 s34, s34, 3
  s_mul_i32 s34, s34, 20480
  s_add_u32 s34, s34, 22020096
  buffer_load_dwordx4 v[176:179], v1, s[4:7], s34 offen offset:0
  buffer_load_dwordx4 v[180:183], v1, s[4:7], s34 offen offset:1024
  buffer_load_dwordx4 v[184:187], v1, s[4:7], s34 offen offset:2048
  buffer_load_dwordx4 v[188:191], v1, s[4:7], s34 offen offset:3072
  s_add_u32 s34, s34, 4096
  buffer_load_dwordx4 v[192:195], v1, s[4:7], s34 offen offset:0
  buffer_load_dwordx4 v[196:199], v1, s[4:7], s34 offen offset:1024
  buffer_load_dwordx4 v[200:203], v1, s[4:7], s34 offen offset:2048
  buffer_load_dwordx4 v[204:207], v1, s[4:7], s34 offen offset:3072
  s_add_u32 s34, s34, 4096
  buffer_load_dwordx4 v[208:211], v1, s[4:7], s34 offen offset:0
  buffer_load_dwordx4 v[212:215], v1, s[4:7], s34 offen offset:1024
  buffer_load_dwordx4 v[216:219], v1, s[4:7], s34 offen offset:2048
  buffer_load_dwordx4 v[220:223], v1, s[4:7], s34 offen offset:3072
  s_add_u32 s34, s34, 4096
  buffer_load_dwordx4 v[224:227], v1, s[4:7], s34 offen offset:0
  buffer_load_dwordx4 v[228:231], v1, s[4:7], s34 offen offset:1024
  buffer_load_dwordx4 v[232:235], v1, s[4:7], s34 offen offset:2048
  buffer_load_dwordx4 v[236:239], v1, s[4:7], s34 offen offset:3072
  s_add_u32 s34, s34, 4096
  buffer_load_dwordx4 v[240:243], v1, s[4:7], s34 offen offset:0
  buffer_load_dwordx4 v[244:247], v1, s[4:7], s34 offen offset:1024
  buffer_load_dwordx4 v[248:251], v1, s[4:7], s34 offen offset:2048
  buffer_load_dwordx4 v[252:255], v1, s[4:7], s34 offen offset:3072
  s_waitcnt vmcnt(20)
  v_and_b32 v30, 7, v0
  v_lshlrev_b32 v30, 3, v30
reca_cens175:
  buffer_load_dwordx2 v[28:29], v30, s[8:11], 0 offen sc1
  s_waitcnt vmcnt(0)
  v_sad_u8 v31, v28, 0, 0
  v_sad_u8 v31, v29, 0, v31
  v_cmp_gt_u32 vcc, 32, v31
  s_cbranch_vccz reca_censok176
  s_sleep 8
  s_sub_u32 s18, s18, 1
  s_cbranch_scc0 reca_cens175
  s_mov_b32 s18, 0
reca_censok176:
  v_and_b32 v28, 0x20202020, v28
  v_and_b32 v29, 0x20202020, v29
  v_cmp_ne_u32 s[34:35], 0, v28
  v_cmp_ne_u32 s[36:37], 0, v29
  s_nop 3
  s_and_b32 s34, s34, 0xff
  s_and_b32 s36, s36, 0xff
  s_or_b32 s35, s34, s36
  s_lshr_b32 s37, s35, s13
  s_and_b32 s37, s37, 1
  s_xor_b32 s43, s37, 1
  s_cmp_eq_u32 s57, 0
  s_cselect_b32 s58, s36, s34
  v_mov_b32 v31, 0x80000000
  s_cmp_lg_u32 s43, 0
  s_cbranch_scc1 reca_pslow177
reca_ptop178:
  s_cmp_lt_u32 s17, 6
  s_cbranch_scc1 reca_pgo179
  s_sub_u32 s36, s17, 6
reca_ppoll180:
  buffer_load_dword v28, v4, s[4:7], s25 offen sc1
  s_waitcnt vmcnt(0)
  v_readfirstlane_b32 s34, v28
  s_nop 3
  s_cmp_ge_i32 s34, s36
  s_cbranch_scc1 reca_pgo179
  s_sleep 8
  s_sub_u32 s18, s18, 1
  s_cbranch_scc0 reca_ppoll180
  s_mov_b32 s18, 0
reca_pgo179:
  s_waitcnt vmcnt(0)
  s_barrier
  v_add_u32 v7, s26, v1
  s_xor_b32 s26, s26, 40960
  s_add_u32 s37, s17, 1
  s_cmp_ge_u32 s37, 64
  s_cbranch_scc1 reca_pnodma181
  s_mul_i32 s20, s37, 40960
  s_add_u32 s20, s20, 153626624
  s_add_u32 m0, s26, 10240
  s_nop 0
  buffer_load_dwordx4 v1, s[4:7], s20 offen offset:0 lds
  buffer_load_dwordx4 v1, s[4:7], s20 offen offset:1024 lds
  buffer_load_dwordx4 v1, s[4:7], s20 offen offset:2048 lds
  buffer_load_dwordx4 v1, s[4:7], s20 offen offset:3072 lds
  s_add_u32 s20, s20, 4096
  s_add_u32 m0, s26, 14336
  s_nop 0
  buffer_load_dwordx4 v1, s[4:7], s20 offen offset:0 lds
  buffer_load_dwordx4 v1, s[4:7], s20 offen offset:1024 lds
  buffer_load_dwordx4 v1, s[4:7], s20 offen offset:2048 lds
  buffer_load_dwordx4 v1, s[4:7], s20 offen offset:3072 lds
  s_add_u32 s20, s20, 4096
  s_add_u32 m0, s26, 18432
  s_nop 0
  buffer_load_dwordx4 v1, s[4:7], s20 offen offset:0 lds
  buffer_load_dwordx4 v1, s[4:7], s20 offen offset:1024 lds
  s_lshl_b32 s34, s15, 6
  s_add_u32 s34, s34, s37
  s_mul_i32 s34, s34, 12288
  s_mul_i32 s35, s16, 3072
  s_add_u32 s35, s35, s34
  s_add_u32 s27, s35, 37748736
  s_mul_i32 s35, s16, 6144
  s_add_u32 s35, s35, s34
  s_add_u32 s28, s35, 62914560
  s_add_u32 s34, s27, 2048
  buffer_load_dwordx4 v[16:19], v1, s[4:7], s34 offen sc1
  s_add_u32 s34, s27, 8192
  buffer_load_dwordx4 v[16:19], v1, s[4:7], s34 offen sc1
  s_add_u32 s34, s28, 1024
  buffer_load_dwordx4 v[16:19], v1, s[4:7], s34 offen sc1
  s_add_u32 s34, s28, 2048
  buffer_load_dwordx4 v[16:19], v1, s[4:7], s34 offen sc1
  s_add_u32 s34, s28, 3072
  buffer_load_dwordx4 v[16:19], v1, s[4:7], s34 offen sc1
reca_pnodma181:
  s_lshl_b32 s34, s15, 6
  s_add_u32 s34, s34, s17
  s_mul_i32 s34, s34, 12288
  s_mul_i32 s35, s16, 3072
  s_add_u32 s35, s35, s34
  s_add_u32 s21, s35, 37748736
  s_add_u32 s22, s35, 88080384
  s_mul_i32 s35, s16, 6144
  s_add_u32 s35, s35, s34
  s_add_u32 s23, s35, 62914560
  ds_read_b128 v[72:75], v7 offset:0
  ds_read_b128 v[76:79], v7 offset:20480
  ds_read_b128 v[80:83], v7 offset:1024
  ds_read_b128 v[84:87], v7 offset:21504
  ds_read_b128 v[88:91], v7 offset:2048
  ds_read_b128 v[92:95], v7 offset:22528
  s_waitcnt lgkmcnt(4)
  v_mfma_f32_16x16x32_bf16 v[32:35], a[0:3], v[72:75], 0
  v_mfma_f32_16x16x32_bf16 v[36:39], a[0:3], v[76:79], 0
  v_mfma_f32_16x16x32_bf16 v[40:43], a[80:83], v[72:75], 0
  v_mfma_f32_16x16x32_bf16 v[44:47], a[80:83], v[76:79], 0
  v_mfma_f32_16x16x32_bf16 v[48:51], v[72:75], a[160:163], 0
  v_mfma_f32_16x16x32_bf16 v[52:55], v[76:79], a[160:163], 0
  v_mfma_f32_16x16x32_bf16 v[56:59], v[72:75], v[96:99], 0
  v_mfma_f32_16x16x32_bf16 v[60:63], v[76:79], v[96:99], 0
  v_mfma_f32_16x16x32_bf16 v[64:67], v[72:75], v[176:179], 0
  v_mfma_f32_16x16x32_bf16 v[68:71], v[76:79], v[176:179], 0
  ds_read_b128 v[72:75], v7 offset:3072
  ds_read_b128 v[76:79], v7 offset:23552
  s_waitcnt lgkmcnt(4)
  v_mfma_f32_16x16x32_bf16 v[32:35], a[4:7], v[80:83], v[32:35]
  v_mfma_f32_16x16x32_bf16 v[36:39], a[4:7], v[84:87], v[36:39]
  v_mfma_f32_16x16x32_bf16 v[40:43], a[84:87], v[80:83], v[40:43]
  v_mfma_f32_16x16x32_bf16 v[44:47], a[84:87], v[84:87], v[44:47]
  v_mfma_f32_16x16x32_bf16 v[48:51], v[80:83], a[164:167], v[48:51]
  v_mfma_f32_16x16x32_bf16 v[52:55], v[84:87], a[164:167], v[52:55]
  v_mfma_f32_16x16x32_bf16 v[56:59], v[80:83], v[100:103], v[56:59]
  v_mfma_f32_16x16x32_bf16 v[60:63], v[84:87], v[100:103], v[60:63]
  v_mfma_f32_16x16x32_bf16 v[64:67], v[80:83], v[180:183], v[64:67]
  v_mfma_f32_16x16x32_bf16 v[68:71], v[84:87], v[180:183], v[68:71]
  ds_read_b128 v[80:83], v7 offset:4096
  ds_read_b128 v[84:87], v7 offset:24576
  s_waitcnt lgkmcnt(4)
  v_mfma_f32_16x16x32_bf16 v[32:35], a[8:11], v[88:91], v[32:35]
  v_mfma_f32_16x16x32_bf16 v[36:39], a[8:11], v[92:95], v[36:39]
  v_mfma_f32_16x16x32_bf16 v[40:43], a[88:91], v[88:91], v[40:43]
  v_mfma_f32_16x16x32_bf16 v[44:47], a[88:91], v[92:95], v[44:47]
  v_mfma_f32_16x16x32_bf16 v[48:51], v[88:91], a[168:171], v[48:51]
  v_mfma_f32_16x16x32_bf16 v[52:55], v[92:95], a[168:171], v[52:55]
  v_mfma_f32_16x16x32_bf16 v[56:59], v[88:91], v[104:107], v[56:59]
  v_mfma_f32_16x16x32_bf16 v[60:63], v[92:95], v[104:107], v[60:63]
  v_mfma_f32_16x16x32_bf16 v[64:67], v[88:91], v[184:187], v[64:67]
  v_mfma_f32_16x16x32_bf16 v[68:71], v[92:95], v[184:187], v[68:71]
  ds_read_b128 v[88:91], v7 offset:5120
  ds_read_b128 v[92:95], v7 offset:25600
  s_waitcnt lgkmcnt(4)
  v_mfma_f32_16x16x32_bf16 v[32:35], a[12:15], v[72:75], v[32:35]
  v_mfma_f32_16x16x32_bf16 v[36:39], a[12:15], v[76:79], v[36:39]
  v_mfma_f32_16x16x32_bf16 v[40:43], a[92:95], v[72:75], v[40:43]
  v_mfma_f32_16x16x32_bf16 v[44:47], a[92:95], v[76:79], v[44:47]
  v_mfma_f32_16x16x32_bf16 v[48:51], v[72:75], a[172:175], v[48:51]
  v_mfma_f32_16x16x32_bf16 v[52:55], v[76:79], a[172:175], v[52:55]
  v_mfma_f32_16x16x32_bf16 v[56:59], v[72:75], v[108:111], v[56:59]
  v_mfma_f32_16x16x32_bf16 v[60:63], v[76:79], v[108:111], v[60:63]
  v_mfma_f32_16x16x32_bf16 v[64:67], v[72:75], v[188:191], v[64:67]
  v_mfma_f32_16x16x32_bf16 v[68:71], v[76:79], v[188:191], v[68:71]
  ds_read_b128 v[72:75], v7 offset:6144
  ds_read_b128 v[76:79], v7 offset:26624
  s_waitcnt lgkmcnt(4)
  v_mfma_f32_16x16x32_bf16 v[32:35], a[16:19], v[80:83], v[32:35]
  v_mfma_f32_16x16x32_bf16 v[36:39], a[16:19], v[84:87], v[36:39]
  v_mfma_f32_16x16x32_bf16 v[40:43], a[96:99], v[80:83], v[40:43]
  v_mfma_f32_16x16x32_bf16 v[44:47], a[96:99], v[84:87], v[44:47]
  v_mfma_f32_16x16x32_bf16 v[48:51], v[80:83], a[176:179], v[48:51]
  v_mfma_f32_16x16x32_bf16 v[52:55], v[84:87], a[176:179], v[52:55]
  v_mfma_f32_16x16x32_bf16 v[56:59], v[80:83], v[112:115], v[56:59]
  v_mfma_f32_16x16x32_bf16 v[60:63], v[84:87], v[112:115], v[60:63]
  v_mfma_f32_16x16x32_bf16 v[64:67], v[80:83], v[192:195], v[64:67]
  v_mfma_f32_16x16x32_bf16 v[68:71], v[84:87], v[192:195], v[68:71]
  ds_read_b128 v[80:83], v7 offset:7168
  ds_read_b128 v[84:87], v7 offset:27648
  s_waitcnt lgkmcnt(4)
  v_mfma_f32_16x16x32_bf16 v[32:35], a[20:23], v[88:91], v[32:35]
  v_mfma_f32_16x16x32_bf16 v[36:39], a[20:23], v[92:95], v[36:39]
  v_mfma_f32_16x16x32_bf16 v[40:43], a[100:103], v[88:91], v[40:43]
  v_mfma_f32_16x16x32_bf16 v[44:47], a[100:103], v[92:95], v[44:47]
  v_mfma_f32_16x16x32_bf16 v[48:51], v[88:91], a[180:183], v[48:51]
  v_mfma_f32_16x16x32_bf16 v[52:55], v[92:95], a[180:183], v[52:55]
  v_mfma_f32_16x16x32_bf16 v[56:59], v[88:91], v[116:119], v[56:59]
  v_mfma_f32_16x16x32_bf16 v[60:63], v[92:95], v[116:119], v[60:63]
  v_mfma_f32_16x16x32_bf16 v[64:67], v[88:91], v[196:199], v[64:67]
  v_mfma_f32_16x16x32_bf16 v[68:71], v[92:95], v[196:199], v[68:71]
  ds_read_b128 v[88:91], v7 offset:8192
  ds_read_b128 v[92:95], v7 offset:28672
  s_waitcnt lgkmcnt(4)
  v_mfma_f32_16x16x32_bf16 v[32:35], a[24:27], v[72:75], v[32:35]
  v_mfma_f32_16x16x32_bf16 v[36:39], a[24:27], v[76:79], v[36:39]
  v_mfma_f32_16x16x32_bf16 v[40:43], a[104:107], v[72:75], v[40:43]
  v_mfma_f32_16x16x32_bf16 v[44:47], a[104:107], v[76:79], v[44:47]
  v_mfma_f32_16x16x32_bf16 v[48:51], v[72:75], a[184:187], v[48:51]
  v_mfma_f32_16x16x32_bf16 v[52:55], v[76:79], a[184:187], v[52:55]
  v_mfma_f32_16x16x32_bf16 v[56:59], v[72:75], v[120:123], v[56:59]
  v_mfma_f32_16x16x32_bf16 v[60:63], v[76:79], v[120:123], v[60:63]
  v_mfma_f32_16x16x32_bf16 v[64:67], v[72:75], v[200:203], v[64:67]
  v_mfma_f32_16x16x32_bf16 v[68:71], v[76:79], v[200:203], v[68:71]
  ds_read_b128 v[72:75], v7 offset:9216
  ds_read_b128 v[76:79], v7 offset:29696
  s_waitcnt lgkmcnt(4)
  v_mfma_f32_16x16x32_bf16 v[32:35], a[28:31], v[80:83], v[32:35]
  v_mfma_f32_16x16x32_bf16 v[36:39], a[28:31], v[84:87], v[36:39]
  v_mfma_f32_16x16x32_bf16 v[40:43], a[108:111], v[80:83], v[40:43]
  v_mfma_f32_16x16x32_bf16 v[44:47], a[108:111], v[84:87], v[44:47]
  v_mfma_f32_16x16x32_bf16 v[48:51], v[80:83], a[188:191], v[48:51]
  v_mfma_f32_16x16x32_bf16 v[52:55], v[84:87], a[188:191], v[52:55]
  v_mfma_f32_16x16x32_bf16 v[56:59], v[80:83], v[124:127], v[56:59]
  v_mfma_f32_16x16x32_bf16 v[60:63], v[84:87], v[124:127], v[60:63]
  v_mfma_f32_16x16x32_bf16 v[64:67], v[80:83], v[204:207], v[64:67]
  v_mfma_f32_16x16x32_bf16 v[68:71], v[84:87], v[204:207], v[68:71]
  ds_read_b128 v[80:83], v7 offset:10240
  ds_read_b128 v[84:87], v7 offset:30720
  s_waitcnt lgkmcnt(4)
  v_mfma_f32_16x16x32_bf16 v[32:35], a[32:35], v[88:91], v[32:35]
  v_mfma_f32_16x16x32_bf16 v[36:39], a[32:35], v[92:95], v[36:39]
  v_mfma_f32_16x16x32_bf16 v[40:43], a[112:115], v[88:91], v[40:43]
  v_mfma_f32_16x16x32_bf16 v[44:47], a[112:115], v[92:95], v[44:47]
  v_mfma_f32_16x16x32_bf16 v[48:51], v[88:91], a[192:195], v[48:51]
  v_mfma_f32_16x16x32_bf16 v[52:55], v[92:95], a[192:195], v[52:55]
  v_mfma_f32_16x16x32_bf16 v[56:59], v[88:91], v[128:131], v[56:59]
  v_mfma_f32_16x16x32_bf16 v[60:63], v[92:95], v[128:131], v[60:63]
  v_mfma_f32_16x16x32_bf16 v[64:67], v[88:91], v[208:211], v[64:67]
  v_mfma_f32_16x16x32_bf16 v[68:71], v[92:95], v[208:211], v[68:71]
  ds_read_b128 v[88:91], v7 offset:11264
  ds_read_b128 v[92:95], v7 offset:31744
  s_waitcnt lgkmcnt(4)
  v_mfma_f32_16x16x32_bf16 v[32:35], a[36:39], v[72:75], v[32:35]
  v_mfma_f32_16x16x32_bf16 v[36:39], a[36:39], v[76:79], v[36:39]
  v_mfma_f32_16x16x32_bf16 v[40:43], a[116:119], v[72:75], v[40:43]
  v_mfma_f32_16x16x32_bf16 v[44:47], a[116:119], v[76:79], v[44:47]
  v_mfma_f32_16x16x32_bf16 v[48:51], v[72:75], a[196:199], v[48:51]
  v_mfma_f32_16x16x32_bf16 v[52:55], v[76:79], a[196:199], v[52:55]
  v_mfma_f32_16x16x32_bf16 v[56:59], v[72:75], v[132:135], v[56:59]
  v_mfma_f32_16x16x32_bf16 v[60:63], v[76:79], v[132:135], v[60:63]
  v_mfma_f32_16x16x32_bf16 v[64:67], v[72:75], v[212:215], v[64:67]
  v_mfma_f32_16x16x32_bf16 v[68:71], v[76:79], v[212:215], v[68:71]
  ds_read_b128 v[72:75], v7 offset:12288
  ds_read_b128 v[76:79], v7 offset:32768
  s_waitcnt lgkmcnt(4)
  v_mfma_f32_16x16x32_bf16 v[32:35], a[40:43], v[80:83], v[32:35]
  v_mfma_f32_16x16x32_bf16 v[36:39], a[40:43], v[84:87], v[36:39]
  v_mfma_f32_16x16x32_bf16 v[40:43], a[120:123], v[80:83], v[40:43]
  v_mfma_f32_16x16x32_bf16 v[44:47], a[120:123], v[84:87], v[44:47]
  v_mfma_f32_16x16x32_bf16 v[48:51], v[80:83], a[200:203], v[48:51]
  v_mfma_f32_16x16x32_bf16 v[52:55], v[84:87], a[200:203], v[52:55]
  v_mfma_f32_16x16x32_bf16 v[56:59], v[80:83], v[136:139], v[56:59]
  v_mfma_f32_16x16x32_bf16 v[60:63], v[84:87], v[136:139], v[60:63]
  v_mfma_f32_16x16x32_bf16 v[64:67], v[80:83], v[216:219], v[64:67]
  v_mfma_f32_16x16x32_bf16 v[68:71], v[84:87], v[216:219], v[68:71]
  ds_read_b128 v[80:83], v7 offset:13312
  ds_read_b128 v[84:87], v7 offset:33792
  s_waitcnt lgkmcnt(4)
  v_mfma_f32_16x16x32_bf16 v[32:35], a[44:47], v[88:91], v[32:35]
  v_mfma_f32_16x16x32_bf16 v[36:39], a[44:47], v[92:95], v[36:39]
  v_mfma_f32_16x16x32_bf16 v[40:43], a[124:127], v[88:91], v[40:43]
  v_mfma_f32_16x16x32_bf16 v[44:47], a[124:127], v[92:95], v[44:47]
  v_mfma_f32_16x16x32_bf16 v[48:51], v[88:91], a[204:207], v[48:51]
  v_mfma_f32_16x16x32_bf16 v[52:55], v[92:95], a[204:207], v[52:55]
  v_mfma_f32_16x16x32_bf16 v[56:59], v[88:91], v[140:143], v[56:59]
  v_mfma_f32_16x16x32_bf16 v[60:63], v[92:95], v[140:143], v[60:63]
  v_mfma_f32_16x16x32_bf16 v[64:67], v[88:91], v[220:223], v[64:67]
  v_mfma_f32_16x16x32_bf16 v[68:71], v[92:95], v[220:223], v[68:71]
  ds_read_b128 v[88:91], v7 offset:14336
  ds_read_b128 v[92:95], v7 offset:34816
  s_waitcnt lgkmcnt(4)
  v_mfma_f32_16x16x32_bf16 v[32:35], a[48:51], v[72:75], v[32:35]
  v_mfma_f32_16x16x32_bf16 v[36:39], a[48:51], v[76:79], v[36:39]
  v_mfma_f32_16x16x32_bf16 v[40:43], a[128:131], v[72:75], v[40:43]
  v_mfma_f32_16x16x32_bf16 v[44:47], a[128:131], v[76:79], v[44:47]
  v_mfma_f32_16x16x32_bf16 v[48:51], v[72:75], a[208:211], v[48:51]
  v_mfma_f32_16x16x32_bf16 v[52:55], v[76:79], a[208:211], v[52:55]
  v_mfma_f32_16x16x32_bf16 v[56:59], v[72:75], v[144:147], v[56:59]
  v_mfma_f32_16x16x32_bf16 v[60:63], v[76:79], v[144:147], v[60:63]
  v_mfma_f32_16x16x32_bf16 v[64:67], v[72:75], v[224:227], v[64:67]
  v_mfma_f32_16x16x32_bf16 v[68:71], v[76:79], v[224:227], v[68:71]
  ds_read_b128 v[72:75], v7 offset:15360
  ds_read_b128 v[76:79], v7 offset:35840
  s_waitcnt lgkmcnt(4)
  v_mfma_f32_16x16x32_bf16 v[32:35], a[52:55], v[80:83], v[32:35]
  v_mfma_f32_16x16x32_bf16 v[36:39], a[52:55], v[84:87], v[36:39]
  v_mfma_f32_16x16x32_bf16 v[40:43], a[132:135], v[80:83], v[40:43]
  v_mfma_f32_16x16x32_bf16 v[44:47], a[132:135], v[84:87], v[44:47]
  v_mfma_f32_16x16x32_bf16 v[48:51], v[80:83], a[212:215], v[48:51]
  v_mfma_f32_16x16x32_bf16 v[52:55], v[84:87], a[212:215], v[52:55]
  v_mfma_f32_16x16x32_bf16 v[56:59], v[80:83], v[148:151], v[56:59]
  v_mfma_f32_16x16x32_bf16 v[60:63], v[84:87], v[148:151], v[60:63]
  v_mfma_f32_16x16x32_bf16 v[64:67], v[80:83], v[228:231], v[64:67]
  v_mfma_f32_16x16x32_bf16 v[68:71], v[84:87], v[228:231], v[68:71]
  ds_read_b128 v[80:83], v7 offset:16384
  ds_read_b128 v[84:87], v7 offset:36864
  s_waitcnt lgkmcnt(4)
  v_mfma_f32_16x16x32_bf16 v[32:35], a[56:59], v[88:91], v[32:35]
  v_mfma_f32_16x16x32_bf16 v[36:39], a[56:59], v[92:95], v[36:39]
  v_mfma_f32_16x16x32_bf16 v[40:43], a[136:139], v[88:91], v[40:43]
  v_mfma_f32_16x16x32_bf16 v[44:47], a[136:139], v[92:95], v[44:47]
  v_mfma_f32_16x16x32_bf16 v[48:51], v[88:91], a[216:219], v[48:51]
  v_mfma_f32_16x16x32_bf16 v[52:55], v[92:95], a[216:219], v[52:55]
  v_mfma_f32_16x16x32_bf16 v[56:59], v[88:91], v[152:155], v[56:59]
  v_mfma_f32_16x16x32_bf16 v[60:63], v[92:95], v[152:155], v[60:63]
  v_mfma_f32_16x16x32_bf16 v[64:67], v[88:91], v[232:235], v[64:67]
  v_mfma_f32_16x16x32_bf16 v[68:71], v[92:95], v[232:235], v[68:71]
  ds_read_b128 v[88:91], v7 offset:17408
  ds_read_b128 v[92:95], v7 offset:37888
  s_waitcnt lgkmcnt(4)
  v_mfma_f32_16x16x32_bf16 v[32:35], a[60:63], v[72:75], v[32:35]
  v_mfma_f32_16x16x32_bf16 v[36:39], a[60:63], v[76:79], v[36:39]
  v_mfma_f32_16x16x32_bf16 v[40:43], a[140:143], v[72:75], v[40:43]
  v_mfma_f32_16x16x32_bf16 v[44:47], a[140:143], v[76:79], v[44:47]
  v_mfma_f32_16x16x32_bf16 v[48:51], v[72:75], a[220:223], v[48:51]
  v_mfma_f32_16x16x32_bf16 v[52:55], v[76:79], a[220:223], v[52:55]
  v_mfma_f32_16x16x32_bf16 v[56:59], v[72:75], v[156:159], v[56:59]
  v_mfma_f32_16x16x32_bf16 v[60:63], v[76:79], v[156:159], v[60:63]
  v_mfma_f32_16x16x32_bf16 v[64:67], v[72:75], v[236:239], v[64:67]
  v_mfma_f32_16x16x32_bf16 v[68:71], v[76:79], v[236:239], v[68:71]
  ds_read_b128 v[72:75], v7 offset:18432
  ds_read_b128 v[76:79], v7 offset:38912
  s_waitcnt lgkmcnt(4)
  v_mfma_f32_16x16x32_bf16 v[32:35], a[64:67], v[80:83], v[32:35]
  v_mfma_f32_16x16x32_bf16 v[36:39], a[64:67], v[84:87], v[36:39]
  v_mfma_f32_16x16x32_bf16 v[40:43], a[144:147], v[80:83], v[40:43]
  v_mfma_f32_16x16x32_bf16 v[44:47], a[144:147], v[84:87], v[44:47]
  v_mfma_f32_16x16x32_bf16 v[48:51], v[80:83], a[224:227], v[48:51]
  v_mfma_f32_16x16x32_bf16 v[52:55], v[84:87], a[224:227], v[52:55]
  v_mfma_f32_16x16x32_bf16 v[56:59], v[80:83], v[160:163], v[56:59]
  v_mfma_f32_16x16x32_bf16 v[60:63], v[84:87], v[160:163], v[60:63]
  v_mfma_f32_16x16x32_bf16 v[64:67], v[80:83], v[240:243], v[64:67]
  v_mfma_f32_16x16x32_bf16 v[68:71], v[84:87], v[240:243], v[68:71]
  ds_read_b128 v[80:83], v7 offset:19456
  ds_read_b128 v[84:87], v7 offset:39936
  s_waitcnt lgkmcnt(4)
  v_mfma_f32_16x16x32_bf16 v[32:35], a[68:71], v[88:91], v[32:35]
  v_mfma_f32_16x16x32_bf16 v[36:39], a[68:71], v[92:95], v[36:39]
  v_mfma_f32_16x16x32_bf16 v[40:43], a[148:151], v[88:91], v[40:43]
  v_mfma_f32_16x16x32_bf16 v[44:47], a[148:151], v[92:95], v[44:47]
  v_mfma_f32_16x16x32_bf16 v[48:51], v[88:91], a[228:231], v[48:51]
  v_mfma_f32_16x16x32_bf16 v[52:55], v[92:95], a[228:231], v[52:55]
  v_mfma_f32_16x16x32_bf16 v[56:59], v[88:91], v[164:167], v[56:59]
  v_mfma_f32_16x16x32_bf16 v[60:63], v[92:95], v[164:167], v[60:63]
  v_mfma_f32_16x16x32_bf16 v[64:67], v[88:91], v[244:247], v[64:67]
  v_mfma_f32_16x16x32_bf16 v[68:71], v[92:95], v[244:247], v[68:71]
  s_waitcnt lgkmcnt(2)
  v_mfma_f32_16x16x32_bf16 v[32:35], a[72:75], v[72:75], v[32:35]
  v_mfma_f32_16x16x32_bf16 v[36:39], a[72:75], v[76:79], v[36:39]
  v_mfma_f32_16x16x32_bf16 v[40:43], a[152:155], v[72:75], v[40:43]
  v_mfma_f32_16x16x32_bf16 v[44:47], a[152:155], v[76:79], v[44:47]
  v_mfma_f32_16x16x32_bf16 v[48:51], v[72:75], a[232:235], v[48:51]
  v_mfma_f32_16x16x32_bf16 v[52:55], v[76:79], a[232:235], v[52:55]
  v_mfma_f32_16x16x32_bf16 v[56:59], v[72:75], v[168:171], v[56:59]
  v_mfma_f32_16x16x32_bf16 v[60:63], v[76:79], v[168:171], v[60:63]
  v_mfma_f32_16x16x32_bf16 v[64:67], v[72:75], v[248:251], v[64:67]
  v_mfma_f32_16x16x32_bf16 v[68:71], v[76:79], v[248:251], v[68:71]
  s_waitcnt lgkmcnt(0)
  v_mfma_f32_16x16x32_bf16 v[32:35], a[76:79], v[80:83], v[32:35]
  v_mfma_f32_16x16x32_bf16 v[36:39], a[76:79], v[84:87], v[36:39]
  v_mfma_f32_16x16x32_bf16 v[40:43], a[156:159], v[80:83], v[40:43]
  v_mfma_f32_16x16x32_bf16 v[44:47], a[156:159], v[84:87], v[44:47]
  v_mfma_f32_16x16x32_bf16 v[48:51], v[80:83], a[236:239], v[48:51]
  v_mfma_f32_16x16x32_bf16 v[52:55], v[84:87], a[236:239], v[52:55]
  v_mfma_f32_16x16x32_bf16 v[56:59], v[80:83], v[172:175], v[56:59]
  v_mfma_f32_16x16x32_bf16 v[60:63], v[84:87], v[172:175], v[60:63]
  v_mfma_f32_16x16x32_bf16 v[64:67], v[80:83], v[252:255], v[64:67]
  v_mfma_f32_16x16x32_bf16 v[68:71], v[84:87], v[252:255], v[68:71]
  v_cvt_pk_bf16_f32 v8, v32, v33
  v_cvt_pk_bf16_f32 v9, v34, v35
  v_cvt_pk_bf16_f32 v10, v40, v41
  v_cvt_pk_bf16_f32 v11, v42, v43
  s_add_u32 s34, s21, 2048
  buffer_store_dwordx4 v[8:11], v1, s[4:7], s34 offen
  v_cvt_pk_bf16_f32 v12, v36, v37
  v_cvt_pk_bf16_f32 v13, v38, v39
  v_cvt_pk_bf16_f32 v14, v44, v45
  v_cvt_pk_bf16_f32 v15, v46, v47
  s_add_u32 s34, s21, 8192
  buffer_store_dwordx4 v[12:15], v1, s[4:7], s34 offen
  v_cvt_pk_bf16_f32 v8, v48, v49
  v_cvt_pk_bf16_f32 v9, v50, v51
  v_cvt_pk_bf16_f32 v10, v52, v53
  v_cvt_pk_bf16_f32 v11, v54, v55
  s_add_u32 s34, s23, 1024
  buffer_store_dwordx4 v[8:11], v1, s[4:7], s34 offen
  v_cvt_pk_bf16_f32 v12, v56, v57
  v_cvt_pk_bf16_f32 v13, v58, v59
  v_cvt_pk_bf16_f32 v14, v60, v61
  v_cvt_pk_bf16_f32 v15, v62, v63
  s_add_u32 s34, s23, 2048
  buffer_store_dwordx4 v[12:15], v1, s[4:7], s34 offen
  v_cvt_pk_bf16_f32 v8, v64, v65
  v_cvt_pk_bf16_f32 v9, v66, v67
  v_cvt_pk_bf16_f32 v10, v68, v69
  v_cvt_pk_bf16_f32 v11, v70, v71
  s_add_u32 s34, s23, 3072
  buffer_store_dwordx4 v[8:11], v1, s[4:7], s34 offen
  s_waitcnt vmcnt(0)
  s_barrier
  s_add_u32 s17, s17, 1
  s_cmp_lt_u32 s17, 64
  s_cbranch_scc1 reca_ptop178
  s_branch reca_exit1
reca_pslow177:
reca_ptop183:
  s_cmp_lt_u32 s17, 6
  s_cbranch_scc1 reca_pgo184
  s_sub_u32 s36, s17, 6
reca_ppoll185:
  buffer_load_dword v28, v4, s[4:7], s25 offen sc1
  s_waitcnt vmcnt(0)
  v_readfirstlane_b32 s34, v28
  s_nop 3
  s_cmp_ge_i32 s34, s36
  s_cbranch_scc1 reca_pgo184
  s_sleep 8
  s_sub_u32 s18, s18, 1
  s_cbranch_scc0 reca_ppoll185
  s_mov_b32 s18, 0
reca_pgo184:
  s_waitcnt vmcnt(0)
  s_barrier
  v_add_u32 v7, s26, v1
  s_xor_b32 s26, s26, 40960
  s_add_u32 s37, s17, 1
  s_cmp_ge_u32 s37, 64
  s_cbranch_scc1 reca_pnodma186
  s_mul_i32 s20, s37, 40960
  s_add_u32 s20, s20, 153626624
  s_add_u32 m0, s26, 10240
  s_nop 0
  buffer_load_dwordx4 v1, s[4:7], s20 offen offset:0 lds
  buffer_load_dwordx4 v1, s[4:7], s20 offen offset:1024 lds
  buffer_load_dwordx4 v1, s[4:7], s20 offen offset:2048 lds
  buffer_load_dwordx4 v1, s[4:7], s20 offen offset:3072 lds
  s_add_u32 s20, s20, 4096
  s_add_u32 m0, s26, 14336
  s_nop 0
  buffer_load_dwordx4 v1, s[4:7], s20 offen offset:0 lds
  buffer_load_dwordx4 v1, s[4:7], s20 offen offset:1024 lds
  buffer_load_dwordx4 v1, s[4:7], s20 offen offset:2048 lds
  buffer_load_dwordx4 v1, s[4:7], s20 offen offset:3072 lds
  s_add_u32 s20, s20, 4096
  s_add_u32 m0, s26, 18432
  s_nop 0
  buffer_load_dwordx4 v1, s[4:7], s20 offen offset:0 lds
  buffer_load_dwordx4 v1, s[4:7], s20 offen offset:1024 lds
  s_lshl_b32 s34, s15, 6
  s_add_u32 s34, s34, s37
  s_mul_i32 s34, s34, 12288
  s_mul_i32 s35, s16, 3072
  s_add_u32 s35, s35, s34
  s_add_u32 s27, s35, 37748736
  s_mul_i32 s35, s16, 6144
  s_add_u32 s35, s35, s34
  s_add_u32 s28, s35, 62914560
  s_add_u32 s34, s27, 2048
  buffer_load_dwordx4 v[16:19], v1, s[4:7], s34 offen sc1
  s_add_u32 s34, s27, 8192
  buffer_load_dwordx4 v[16:19], v1, s[4:7], s34 offen sc1
  s_add_u32 s34, s28, 1024
  buffer_load_dwordx4 v[16:19], v1, s[4:7], s34 offen sc1
  s_add_u32 s34, s28, 2048
  buffer_load_dwordx4 v[16:19], v1, s[4:7], s34 offen sc1
  s_add_u32 s34, s28, 3072
  buffer_load_dwordx4 v[16:19], v1, s[4:7], s34 offen sc1
reca_pnodma186:
  s_lshl_b32 s34, s15, 6
  s_add_u32 s34, s34, s17
  s_mul_i32 s34, s34, 12288
  s_mul_i32 s35, s16, 3072
  s_add_u32 s35, s35, s34
  s_add_u32 s21, s35, 37748736
  s_add_u32 s22, s35, 88080384
  s_mul_i32 s35, s16, 6144
  s_add_u32 s35, s35, s34
  s_add_u32 s23, s35, 62914560
  ds_read_b128 v[72:75], v7 offset:0
  ds_read_b128 v[76:79], v7 offset:20480
  ds_read_b128 v[80:83], v7 offset:1024
  ds_read_b128 v[84:87], v7 offset:21504
  ds_read_b128 v[88:91], v7 offset:2048
  ds_read_b128 v[92:95], v7 offset:22528
  s_waitcnt lgkmcnt(4)
  v_mfma_f32_16x16x32_bf16 v[32:35], a[0:3], v[72:75], 0
  v_mfma_f32_16x16x32_bf16 v[36:39], a[0:3], v[76:79], 0
  v_mfma_f32_16x16x32_bf16 v[40:43], a[80:83], v[72:75], 0
  v_mfma_f32_16x16x32_bf16 v[44:47], a[80:83], v[76:79], 0
  v_mfma_f32_16x16x32_bf16 v[48:51], v[72:75], a[160:163], 0
  v_mfma_f32_16x16x32_bf16 v[52:55], v[76:79], a[160:163], 0
  v_mfma_f32_16x16x32_bf16 v[56:59], v[72:75], v[96:99], 0
  v_mfma_f32_16x16x32_bf16 v[60:63], v[76:79], v[96:99], 0
  v_mfma_f32_16x16x32_bf16 v[64:67], v[72:75], v[176:179], 0
  v_mfma_f32_16x16x32_bf16 v[68:71], v[76:79], v[176:179], 0
  ds_read_b128 v[72:75], v7 offset:3072
  ds_read_b128 v[76:79], v7 offset:23552
  s_waitcnt lgkmcnt(4)
  v_mfma_f32_16x16x32_bf16 v[32:35], a[4:7], v[80:83], v[32:35]
  v_mfma_f32_16x16x32_bf16 v[36:39], a[4:7], v[84:87], v[36:39]
  v_mfma_f32_16x16x32_bf16 v[40:43], a[84:87], v[80:83], v[40:43]
  v_mfma_f32_16x16x32_bf16 v[44:47], a[84:87], v[84:87], v[44:47]
  v_mfma_f32_16x16x32_bf16 v[48:51], v[80:83], a[164:167], v[48:51]
  v_mfma_f32_16x16x32_bf16 v[52:55], v[84:87], a[164:167], v[52:55]
  v_mfma_f32_16x16x32_bf16 v[56:59], v[80:83], v[100:103], v[56:59]
  v_mfma_f32_16x16x32_bf16 v[60:63], v[84:87], v[100:103], v[60:63]
  v_mfma_f32_16x16x32_bf16 v[64:67], v[80:83], v[180:183], v[64:67]
  v_mfma_f32_16x16x32_bf16 v[68:71], v[84:87], v[180:183], v[68:71]
  ds_read_b128 v[80:83], v7 offset:4096
  ds_read_b128 v[84:87], v7 offset:24576
  s_waitcnt lgkmcnt(4)
  v_mfma_f32_16x16x32_bf16 v[32:35], a[8:11], v[88:91], v[32:35]
  v_mfma_f32_16x16x32_bf16 v[36:39], a[8:11], v[92:95], v[36:39]
  v_mfma_f32_16x16x32_bf16 v[40:43], a[88:91], v[88:91], v[40:43]
  v_mfma_f32_16x16x32_bf16 v[44:47], a[88:91], v[92:95], v[44:47]
  v_mfma_f32_16x16x32_bf16 v[48:51], v[88:91], a[168:171], v[48:51]
  v_mfma_f32_16x16x32_bf16 v[52:55], v[92:95], a[168:171], v[52:55]
  v_mfma_f32_16x16x32_bf16 v[56:59], v[88:91], v[104:107], v[56:59]
  v_mfma_f32_16x16x32_bf16 v[60:63], v[92:95], v[104:107], v[60:63]
  v_mfma_f32_16x16x32_bf16 v[64:67], v[88:91], v[184:187], v[64:67]
  v_mfma_f32_16x16x32_bf16 v[68:71], v[92:95], v[184:187], v[68:71]
  ds_read_b128 v[88:91], v7 offset:5120
  ds_read_b128 v[92:95], v7 offset:25600
  s_waitcnt lgkmcnt(4)
  v_mfma_f32_16x16x32_bf16 v[32:35], a[12:15], v[72:75], v[32:35]
  v_mfma_f32_16x16x32_bf16 v[36:39], a[12:15], v[76:79], v[36:39]
  v_mfma_f32_16x16x32_bf16 v[40:43], a[92:95], v[72:75], v[40:43]
  v_mfma_f32_16x16x32_bf16 v[44:47], a[92:95], v[76:79], v[44:47]
  v_mfma_f32_16x16x32_bf16 v[48:51], v[72:75], a[172:175], v[48:51]
  v_mfma_f32_16x16x32_bf16 v[52:55], v[76:79], a[172:175], v[52:55]
  v_mfma_f32_16x16x32_bf16 v[56:59], v[72:75], v[108:111], v[56:59]
  v_mfma_f32_16x16x32_bf16 v[60:63], v[76:79], v[108:111], v[60:63]
  v_mfma_f32_16x16x32_bf16 v[64:67], v[72:75], v[188:191], v[64:67]
  v_mfma_f32_16x16x32_bf16 v[68:71], v[76:79], v[188:191], v[68:71]
  ds_read_b128 v[72:75], v7 offset:6144
  ds_read_b128 v[76:79], v7 offset:26624
  s_waitcnt lgkmcnt(4)
  v_mfma_f32_16x16x32_bf16 v[32:35], a[16:19], v[80:83], v[32:35]
  v_mfma_f32_16x16x32_bf16 v[36:39], a[16:19], v[84:87], v[36:39]
  v_mfma_f32_16x16x32_bf16 v[40:43], a[96:99], v[80:83], v[40:43]
  v_mfma_f32_16x16x32_bf16 v[44:47], a[96:99], v[84:87], v[44:47]
  v_mfma_f32_16x16x32_bf16 v[48:51], v[80:83], a[176:179], v[48:51]
  v_mfma_f32_16x16x32_bf16 v[52:55], v[84:87], a[176:179], v[52:55]
  v_mfma_f32_16x16x32_bf16 v[56:59], v[80:83], v[112:115], v[56:59]
  v_mfma_f32_16x16x32_bf16 v[60:63], v[84:87], v[112:115], v[60:63]
  v_mfma_f32_16x16x32_bf16 v[64:67], v[80:83], v[192:195], v[64:67]
  v_mfma_f32_16x16x32_bf16 v[68:71], v[84:87], v[192:195], v[68:71]
  ds_read_b128 v[80:83], v7 offset:7168
  ds_read_b128 v[84:87], v7 offset:27648
  s_waitcnt lgkmcnt(4)
  v_mfma_f32_16x16x32_bf16 v[32:35], a[20:23], v[88:91], v[32:35]
  v_mfma_f32_16x16x32_bf16 v[36:39], a[20:23], v[92:95], v[36:39]
  v_mfma_f32_16x16x32_bf16 v[40:43], a[100:103], v[88:91], v[40:43]
  v_mfma_f32_16x16x32_bf16 v[44:47], a[100:103], v[92:95], v[44:47]
  v_mfma_f32_16x16x32_bf16 v[48:51], v[88:91], a[180:183], v[48:51]
  v_mfma_f32_16x16x32_bf16 v[52:55], v[92:95], a[180:183], v[52:55]
  v_mfma_f32_16x16x32_bf16 v[56:59], v[88:91], v[116:119], v[56:59]
  v_mfma_f32_16x16x32_bf16 v[60:63], v[92:95], v[116:119], v[60:63]
  v_mfma_f32_16x16x32_bf16 v[64:67], v[88:91], v[196:199], v[64:67]
  v_mfma_f32_16x16x32_bf16 v[68:71], v[92:95], v[196:199], v[68:71]
  ds_read_b128 v[88:91], v7 offset:8192
  ds_read_b128 v[92:95], v7 offset:28672
  s_waitcnt lgkmcnt(4)
  v_mfma_f32_16x16x32_bf16 v[32:35], a[24:27], v[72:75], v[32:35]
  v_mfma_f32_16x16x32_bf16 v[36:39], a[24:27], v[76:79], v[36:39]
  v_mfma_f32_16x16x32_bf16 v[40:43], a[104:107], v[72:75], v[40:43]
  v_mfma_f32_16x16x32_bf16 v[44:47], a[104:107], v[76:79], v[44:47]
  v_mfma_f32_16x16x32_bf16 v[48:51], v[72:75], a[184:187], v[48:51]
  v_mfma_f32_16x16x32_bf16 v[52:55], v[76:79], a[184:187], v[52:55]
  v_mfma_f32_16x16x32_bf16 v[56:59], v[72:75], v[120:123], v[56:59]
  v_mfma_f32_16x16x32_bf16 v[60:63], v[76:79], v[120:123], v[60:63]
  v_mfma_f32_16x16x32_bf16 v[64:67], v[72:75], v[200:203], v[64:67]
  v_mfma_f32_16x16x32_bf16 v[68:71], v[76:79], v[200:203], v[68:71]
  ds_read_b128 v[72:75], v7 offset:9216
  ds_read_b128 v[76:79], v7 offset:29696
  s_waitcnt lgkmcnt(4)
  v_mfma_f32_16x16x32_bf16 v[32:35], a[28:31], v[80:83], v[32:35]
  v_mfma_f32_16x16x32_bf16 v[36:39], a[28:31], v[84:87], v[36:39]
  v_mfma_f32_16x16x32_bf16 v[40:43], a[108:111], v[80:83], v[40:43]
  v_mfma_f32_16x16x32_bf16 v[44:47], a[108:111], v[84:87], v[44:47]
  v_mfma_f32_16x16x32_bf16 v[48:51], v[80:83], a[188:191], v[48:51]
  v_mfma_f32_16x16x32_bf16 v[52:55], v[84:87], a[188:191], v[52:55]
  v_mfma_f32_16x16x32_bf16 v[56:59], v[80:83], v[124:127], v[56:59]
  v_mfma_f32_16x16x32_bf16 v[60:63], v[84:87], v[124:127], v[60:63]
  v_mfma_f32_16x16x32_bf16 v[64:67], v[80:83], v[204:207], v[64:67]
  v_mfma_f32_16x16x32_bf16 v[68:71], v[84:87], v[204:207], v[68:71]
  ds_read_b128 v[80:83], v7 offset:10240
  ds_read_b128 v[84:87], v7 offset:30720
  s_waitcnt lgkmcnt(4)
  v_mfma_f32_16x16x32_bf16 v[32:35], a[32:35], v[88:91], v[32:35]
  v_mfma_f32_16x16x32_bf16 v[36:39], a[32:35], v[92:95], v[36:39]
  v_mfma_f32_16x16x32_bf16 v[40:43], a[112:115], v[88:91], v[40:43]
  v_mfma_f32_16x16x32_bf16 v[44:47], a[112:115], v[92:95], v[44:47]
  v_mfma_f32_16x16x32_bf16 v[48:51], v[88:91], a[192:195], v[48:51]
  v_mfma_f32_16x16x32_bf16 v[52:55], v[92:95], a[192:195], v[52:55]
  v_mfma_f32_16x16x32_bf16 v[56:59], v[88:91], v[128:131], v[56:59]
  v_mfma_f32_16x16x32_bf16 v[60:63], v[92:95], v[128:131], v[60:63]
  v_mfma_f32_16x16x32_bf16 v[64:67], v[88:91], v[208:211], v[64:67]
  v_mfma_f32_16x16x32_bf16 v[68:71], v[92:95], v[208:211], v[68:71]
  ds_read_b128 v[88:91], v7 offset:11264
  ds_read_b128 v[92:95], v7 offset:31744
  s_waitcnt lgkmcnt(4)
  v_mfma_f32_16x16x32_bf16 v[32:35], a[36:39], v[72:75], v[32:35]
  v_mfma_f32_16x16x32_bf16 v[36:39], a[36:39], v[76:79], v[36:39]
  v_mfma_f32_16x16x32_bf16 v[40:43], a[116:119], v[72:75], v[40:43]
  v_mfma_f32_16x16x32_bf16 v[44:47], a[116:119], v[76:79], v[44:47]
  v_mfma_f32_16x16x32_bf16 v[48:51], v[72:75], a[196:199], v[48:51]
  v_mfma_f32_16x16x32_bf16 v[52:55], v[76:79], a[196:199], v[52:55]
  v_mfma_f32_16x16x32_bf16 v[56:59], v[72:75], v[132:135], v[56:59]
  v_mfma_f32_16x16x32_bf16 v[60:63], v[76:79], v[132:135], v[60:63]
  v_mfma_f32_16x16x32_bf16 v[64:67], v[72:75], v[212:215], v[64:67]
  v_mfma_f32_16x16x32_bf16 v[68:71], v[76:79], v[212:215], v[68:71]
  ds_read_b128 v[72:75], v7 offset:12288
  ds_read_b128 v[76:79], v7 offset:32768
  s_waitcnt lgkmcnt(4)
  v_mfma_f32_16x16x32_bf16 v[32:35], a[40:43], v[80:83], v[32:35]
  v_mfma_f32_16x16x32_bf16 v[36:39], a[40:43], v[84:87], v[36:39]
  v_mfma_f32_16x16x32_bf16 v[40:43], a[120:123], v[80:83], v[40:43]
  v_mfma_f32_16x16x32_bf16 v[44:47], a[120:123], v[84:87], v[44:47]
  v_mfma_f32_16x16x32_bf16 v[48:51], v[80:83], a[200:203], v[48:51]
  v_mfma_f32_16x16x32_bf16 v[52:55], v[84:87], a[200:203], v[52:55]
  v_mfma_f32_16x16x32_bf16 v[56:59], v[80:83], v[136:139], v[56:59]
  v_mfma_f32_16x16x32_bf16 v[60:63], v[84:87], v[136:139], v[60:63]
  v_mfma_f32_16x16x32_bf16 v[64:67], v[80:83], v[216:219], v[64:67]
  v_mfma_f32_16x16x32_bf16 v[68:71], v[84:87], v[216:219], v[68:71]
  ds_read_b128 v[80:83], v7 offset:13312
  ds_read_b128 v[84:87], v7 offset:33792
  s_waitcnt lgkmcnt(4)
  v_mfma_f32_16x16x32_bf16 v[32:35], a[44:47], v[88:91], v[32:35]
  v_mfma_f32_16x16x32_bf16 v[36:39], a[44:47], v[92:95], v[36:39]
  v_mfma_f32_16x16x32_bf16 v[40:43], a[124:127], v[88:91], v[40:43]
  v_mfma_f32_16x16x32_bf16 v[44:47], a[124:127], v[92:95], v[44:47]
  v_mfma_f32_16x16x32_bf16 v[48:51], v[88:91], a[204:207], v[48:51]
  v_mfma_f32_16x16x32_bf16 v[52:55], v[92:95], a[204:207], v[52:55]
  v_mfma_f32_16x16x32_bf16 v[56:59], v[88:91], v[140:143], v[56:59]
  v_mfma_f32_16x16x32_bf16 v[60:63], v[92:95], v[140:143], v[60:63]
  v_mfma_f32_16x16x32_bf16 v[64:67], v[88:91], v[220:223], v[64:67]
  v_mfma_f32_16x16x32_bf16 v[68:71], v[92:95], v[220:223], v[68:71]
  ds_read_b128 v[88:91], v7 offset:14336
  ds_read_b128 v[92:95], v7 offset:34816
  s_waitcnt lgkmcnt(4)
  v_mfma_f32_16x16x32_bf16 v[32:35], a[48:51], v[72:75], v[32:35]
  v_mfma_f32_16x16x32_bf16 v[36:39], a[48:51], v[76:79], v[36:39]
  v_mfma_f32_16x16x32_bf16 v[40:43], a[128:131], v[72:75], v[40:43]
  v_mfma_f32_16x16x32_bf16 v[44:47], a[128:131], v[76:79], v[44:47]
  v_mfma_f32_16x16x32_bf16 v[48:51], v[72:75], a[208:211], v[48:51]
  v_mfma_f32_16x16x32_bf16 v[52:55], v[76:79], a[208:211], v[52:55]
  v_mfma_f32_16x16x32_bf16 v[56:59], v[72:75], v[144:147], v[56:59]
  v_mfma_f32_16x16x32_bf16 v[60:63], v[76:79], v[144:147], v[60:63]
  v_mfma_f32_16x16x32_bf16 v[64:67], v[72:75], v[224:227], v[64:67]
  v_mfma_f32_16x16x32_bf16 v[68:71], v[76:79], v[224:227], v[68:71]
  ds_read_b128 v[72:75], v7 offset:15360
  ds_read_b128 v[76:79], v7 offset:35840
  s_waitcnt lgkmcnt(4)
  v_mfma_f32_16x16x32_bf16 v[32:35], a[52:55], v[80:83], v[32:35]
  v_mfma_f32_16x16x32_bf16 v[36:39], a[52:55], v[84:87], v[36:39]
  v_mfma_f32_16x16x32_bf16 v[40:43], a[132:135], v[80:83], v[40:43]
  v_mfma_f32_16x16x32_bf16 v[44:47], a[132:135], v[84:87], v[44:47]
  v_mfma_f32_16x16x32_bf16 v[48:51], v[80:83], a[212:215], v[48:51]
  v_mfma_f32_16x16x32_bf16 v[52:55], v[84:87], a[212:215], v[52:55]
  v_mfma_f32_16x16x32_bf16 v[56:59], v[80:83], v[148:151], v[56:59]
  v_mfma_f32_16x16x32_bf16 v[60:63], v[84:87], v[148:151], v[60:63]
  v_mfma_f32_16x16x32_bf16 v[64:67], v[80:83], v[228:231], v[64:67]
  v_mfma_f32_16x16x32_bf16 v[68:71], v[84:87], v[228:231], v[68:71]
  ds_read_b128 v[80:83], v7 offset:16384
  ds_read_b128 v[84:87], v7 offset:36864
  s_waitcnt lgkmcnt(4)
  v_mfma_f32_16x16x32_bf16 v[32:35], a[56:59], v[88:91], v[32:35]
  v_mfma_f32_16x16x32_bf16 v[36:39], a[56:59], v[92:95], v[36:39]
  v_mfma_f32_16x16x32_bf16 v[40:43], a[136:139], v[88:91], v[40:43]
  v_mfma_f32_16x16x32_bf16 v[44:47], a[136:139], v[92:95], v[44:47]
  v_mfma_f32_16x16x32_bf16 v[48:51], v[88:91], a[216:219], v[48:51]
  v_mfma_f32_16x16x32_bf16 v[52:55], v[92:95], a[216:219], v[52:55]
  v_mfma_f32_16x16x32_bf16 v[56:59], v[88:91], v[152:155], v[56:59]
  v_mfma_f32_16x16x32_bf16 v[60:63], v[92:95], v[152:155], v[60:63]
  v_mfma_f32_16x16x32_bf16 v[64:67], v[88:91], v[232:235], v[64:67]
  v_mfma_f32_16x16x32_bf16 v[68:71], v[92:95], v[232:235], v[68:71]
  ds_read_b128 v[88:91], v7 offset:17408
  ds_read_b128 v[92:95], v7 offset:37888
  s_waitcnt lgkmcnt(4)
  v_mfma_f32_16x16x32_bf16 v[32:35], a[60:63], v[72:75], v[32:35]
  v_mfma_f32_16x16x32_bf16 v[36:39], a[60:63], v[76:79], v[36:39]
  v_mfma_f32_16x16x32_bf16 v[40:43], a[140:143], v[72:75], v[40:43]
  v_mfma_f32_16x16x32_bf16 v[44:47], a[140:143], v[76:79], v[44:47]
  v_mfma_f32_16x16x32_bf16 v[48:51], v[72:75], a[220:223], v[48:51]
  v_mfma_f32_16x16x32_bf16 v[52:55], v[76:79], a[220:223], v[52:55]
  v_mfma_f32_16x16x32_bf16 v[56:59], v[72:75], v[156:159], v[56:59]
  v_mfma_f32_16x16x32_bf16 v[60:63], v[76:79], v[156:159], v[60:63]
  v_mfma_f32_16x16x32_bf16 v[64:67], v[72:75], v[236:239], v[64:67]
  v_mfma_f32_16x16x32_bf16 v[68:71], v[76:79], v[236:239], v[68:71]
  ds_read_b128 v[72:75], v7 offset:18432
  ds_read_b128 v[76:79], v7 offset:38912
  s_waitcnt lgkmcnt(4)
  v_mfma_f32_16x16x32_bf16 v[32:35], a[64:67], v[80:83], v[32:35]
  v_mfma_f32_16x16x32_bf16 v[36:39], a[64:67], v[84:87], v[36:39]
  v_mfma_f32_16x16x32_bf16 v[40:43], a[144:147], v[80:83], v[40:43]
  v_mfma_f32_16x16x32_bf16 v[44:47], a[144:147], v[84:87], v[44:47]
  v_mfma_f32_16x16x32_bf16 v[48:51], v[80:83], a[224:227], v[48:51]
  v_mfma_f32_16x16x32_bf16 v[52:55], v[84:87], a[224:227], v[52:55]
  v_mfma_f32_16x16x32_bf16 v[56:59], v[80:83], v[160:163], v[56:59]
  v_mfma_f32_16x16x32_bf16 v[60:63], v[84:87], v[160:163], v[60:63]
  v_mfma_f32_16x16x32_bf16 v[64:67], v[80:83], v[240:243], v[64:67]
  v_mfma_f32_16x16x32_bf16 v[68:71], v[84:87], v[240:243], v[68:71]
  ds_read_b128 v[80:83], v7 offset:19456
  ds_read_b128 v[84:87], v7 offset:39936
  s_waitcnt lgkmcnt(4)
  v_mfma_f32_16x16x32_bf16 v[32:35], a[68:71], v[88:91], v[32:35]
  v_mfma_f32_16x16x32_bf16 v[36:39], a[68:71], v[92:95], v[36:39]
  v_mfma_f32_16x16x32_bf16 v[40:43], a[148:151], v[88:91], v[40:43]
  v_mfma_f32_16x16x32_bf16 v[44:47], a[148:151], v[92:95], v[44:47]
  v_mfma_f32_16x16x32_bf16 v[48:51], v[88:91], a[228:231], v[48:51]
  v_mfma_f32_16x16x32_bf16 v[52:55], v[92:95], a[228:231], v[52:55]
  v_mfma_f32_16x16x32_bf16 v[56:59], v[88:91], v[164:167], v[56:59]
  v_mfma_f32_16x16x32_bf16 v[60:63], v[92:95], v[164:167], v[60:63]
  v_mfma_f32_16x16x32_bf16 v[64:67], v[88:91], v[244:247], v[64:67]
  v_mfma_f32_16x16x32_bf16 v[68:71], v[92:95], v[244:247], v[68:71]
  s_waitcnt lgkmcnt(2)
  v_mfma_f32_16x16x32_bf16 v[32:35], a[72:75], v[72:75], v[32:35]
  v_mfma_f32_16x16x32_bf16 v[36:39], a[72:75], v[76:79], v[36:39]
  v_mfma_f32_16x16x32_bf16 v[40:43], a[152:155], v[72:75], v[40:43]
  v_mfma_f32_16x16x32_bf16 v[44:47], a[152:155], v[76:79], v[44:47]
  v_mfma_f32_16x16x32_bf16 v[48:51], v[72:75], a[232:235], v[48:51]
  v_mfma_f32_16x16x32_bf16 v[52:55], v[76:79], a[232:235], v[52:55]
  v_mfma_f32_16x16x32_bf16 v[56:59], v[72:75], v[168:171], v[56:59]
  v_mfma_f32_16x16x32_bf16 v[60:63], v[76:79], v[168:171], v[60:63]
  v_mfma_f32_16x16x32_bf16 v[64:67], v[72:75], v[248:251], v[64:67]
  v_mfma_f32_16x16x32_bf16 v[68:71], v[76:79], v[248:251], v[68:71]
  s_waitcnt lgkmcnt(0)
  v_mfma_f32_16x16x32_bf16 v[32:35], a[76:79], v[80:83], v[32:35]
  v_mfma_f32_16x16x32_bf16 v[36:39], a[76:79], v[84:87], v[36:39]
  v_mfma_f32_16x16x32_bf16 v[40:43], a[156:159], v[80:83], v[40:43]
  v_mfma_f32_16x16x32_bf16 v[44:47], a[156:159], v[84:87], v[44:47]
  v_mfma_f32_16x16x32_bf16 v[48:51], v[80:83], a[236:239], v[48:51]
  v_mfma_f32_16x16x32_bf16 v[52:55], v[84:87], a[236:239], v[52:55]
  v_mfma_f32_16x16x32_bf16 v[56:59], v[80:83], v[172:175], v[56:59]
  v_mfma_f32_16x16x32_bf16 v[60:63], v[84:87], v[172:175], v[60:63]
  v_mfma_f32_16x16x32_bf16 v[64:67], v[80:83], v[252:255], v[64:67]
  v_mfma_f32_16x16x32_bf16 v[68:71], v[84:87], v[252:255], v[68:71]
  v_cvt_pk_bf16_f32 v8, v32, v33
  v_cvt_pk_bf16_f32 v9, v34, v35
  v_cvt_pk_bf16_f32 v10, v40, v41
  v_cvt_pk_bf16_f32 v11, v42, v43
  s_add_u32 s34, s21, 2048
  buffer_store_dwordx4 v[8:11], v1, s[4:7], s34 offen sc1
  v_cvt_pk_bf16_f32 v12, v36, v37
  v_cvt_pk_bf16_f32 v13, v38, v39
  v_cvt_pk_bf16_f32 v14, v44, v45
  v_cvt_pk_bf16_f32 v15, v46, v47
  s_add_u32 s34, s21, 8192
  buffer_store_dwordx4 v[12:15], v1, s[4:7], s34 offen sc1
  v_cvt_pk_bf16_f32 v8, v48, v49
  v_cvt_pk_bf16_f32 v9, v50, v51
  v_cvt_pk_bf16_f32 v10, v52, v53
  v_cvt_pk_bf16_f32 v11, v54, v55
  s_add_u32 s34, s23, 1024
  buffer_store_dwordx4 v[8:11], v1, s[4:7], s34 offen sc1
  v_cvt_pk_bf16_f32 v12, v56, v57
  v_cvt_pk_bf16_f32 v13, v58, v59
  v_cvt_pk_bf16_f32 v14, v60, v61
  v_cvt_pk_bf16_f32 v15, v62, v63
  s_add_u32 s34, s23, 2048
  buffer_store_dwordx4 v[12:15], v1, s[4:7], s34 offen sc1
  v_cvt_pk_bf16_f32 v8, v64, v65
  v_cvt_pk_bf16_f32 v9, v66, v67
  v_cvt_pk_bf16_f32 v10, v68, v69
  v_cvt_pk_bf16_f32 v11, v70, v71
  s_add_u32 s34, s23, 3072
  buffer_store_dwordx4 v[8:11], v1, s[4:7], s34 offen sc1
  s_waitcnt vmcnt(0)
  s_barrier
  s_add_u32 s17, s17, 1
  s_cmp_lt_u32 s17, 64
  s_cbranch_scc1 reca_ptop183
  s_branch reca_exit1
reca_pw2_160:
  s_mov_b32 s17, 0
  s_mov_b32 s26, 0
  s_mul_i32 s20, s17, 40960
  s_add_u32 s20, s20, 153636864
  s_add_u32 m0, s26, 20480
  s_nop 0
  buffer_load_dwordx4 v1, s[4:7], s20 offen offset:0 lds
  buffer_load_dwordx4 v1, s[4:7], s20 offen offset:1024 lds
  buffer_load_dwordx4 v1, s[4:7], s20 offen offset:2048 lds
  buffer_load_dwordx4 v1, s[4:7], s20 offen offset:3072 lds
  s_add_u32 s20, s20, 4096
  s_add_u32 m0, s26, 24576
  s_nop 0
  buffer_load_dwordx4 v1, s[4:7], s20 offen offset:0 lds
  buffer_load_dwordx4 v1, s[4:7], s20 offen offset:1024 lds
  buffer_load_dwordx4 v1, s[4:7], s20 offen offset:2048 lds
  buffer_load_dwordx4 v1, s[4:7], s20 offen offset:3072 lds
  s_add_u32 s20, s20, 4096
  s_add_u32 m0, s26, 28672
  s_nop 0
  buffer_load_dwordx4 v1, s[4:7], s20 offen offset:0 lds
  buffer_load_dwordx4 v1, s[4:7], s20 offen offset:1024 lds
  s_lshl_b32 s34, s15, 6
  s_add_u32 s34, s34, s17
  s_mul_i32 s34, s34, 12288
  s_mul_i32 s35, s16, 3072
  s_add_u32 s35, s35, s34
  s_add_u32 s27, s35, 37748736
  s_mul_i32 s35, s16, 6144
  s_add_u32 s35, s35, s34
  s_add_u32 s28, s35, 62914560
  s_add_u32 s34, s28, 4096
  buffer_load_dwordx4 v[16:19], v1, s[4:7], s34 offen sc1
  s_add_u32 s34, s28, 5120
  buffer_load_dwordx4 v[16:19], v1, s[4:7], s34 offen sc1
  s_mul_i32 s34, s15, 12
  s_mul_i32 s35, s16, 6
  s_add_u32 s34, s34, s35
  s_add_u32 s34, s34, 0
  s_mul_i32 s34, s34, 20480
  s_add_u32 s34, s34, 6291456
  buffer_load_dwordx4 a[0:3], v1, s[4:7], s34 offen offset:0
  buffer_load_dwordx4 a[4:7], v1, s[4:7], s34 offen offset:1024
  buffer_load_dwordx4 a[8:11], v1, s[4:7], s34 offen offset:2048
  buffer_load_dwordx4 a[12:15], v1, s[4:7], s34 offen offset:3072
  s_add_u32 s34, s34, 4096
  buffer_load_dwordx4 a[16:19], v1, s[4:7], s34 offen offset:0
  buffer_load_dwordx4 a[20:23], v1, s[4:7], s34 offen offset:1024
  buffer_load_dwordx4 a[24:27], v1, s[4:7], s34 offen offset:2048
  buffer_load_dwordx4 a[28:31], v1, s[4:7], s34 offen offset:3072
  s_add_u32 s34, s34, 4096
  buffer_load_dwordx4 a[32:35], v1, s[4:7], s34 offen offset:0
  buffer_load_dwordx4 a[36:39], v1, s[4:7], s34 offen offset:1024
  buffer_load_dwordx4 a[40:43], v1, s[4:7], s34 offen offset:2048
  buffer_load_dwordx4 a[44:47], v1, s[4:7], s34 offen offset:3072
  s_add_u32 s34, s34, 4096
  buffer_load_dwordx4 a[48:51], v1, s[4:7], s34 offen offset:0
  buffer_load_dwordx4 a[52:55], v1, s[4:7], s34 offen offset:1024
  buffer_load_dwordx4 a[56:59], v1, s[4:7], s34 offen offset:2048
  buffer_load_dwordx4 a[60:63], v1, s[4:7], s34 offen offset:3072
  s_add_u32 s34, s34, 4096
  buffer_load_dwordx4 a[64:67], v1, s[4:7], s34 offen offset:0
  buffer_load_dwordx4 a[68:71], v1, s[4:7], s34 offen offset:1024
  buffer_load_dwordx4 a[72:75], v1, s[4:7], s34 offen offset:2048
  buffer_load_dwordx4 a[76:79], v1, s[4:7], s34 offen offset:3072
  s_mul_i32 s34, s15, 12
  s_mul_i32 s35, s16, 6
  s_add_u32 s34, s34, s35
  s_add_u32 s34, s34, 1
  s_mul_i32 s34, s34, 20480
  s_add_u32 s34, s34, 6291456
  buffer_load_dwordx4 a[80:83], v1, s[4:7], s34 offen offset:0
  buffer_load_dwordx4 a[84:87], v1, s[4:7], s34 offen offset:1024
  buffer_load_dwordx4 a[88:91], v1, s[4:7], s34 offen offset:2048
  buffer_load_dwordx4 a[92:95], v1, s[4:7], s34 offen offset:3072
  s_add_u32 s34, s34, 4096
  buffer_load_dwordx4 a[96:99], v1, s[4:7], s34 offen offset:0
  buffer_load_dwordx4 a[100:103], v1, s[4:7], s34 offen offset:1024
  buffer_load_dwordx4 a[104:107], v1, s[4:7], s34 offen offset:2048
  buffer_load_dwordx4 a[108:111], v1, s[4:7], s34 offen offset:3072
  s_add_u32 s34, s34, 4096
  buffer_load_dwordx4 a[112:115], v1, s[4:7], s34 offen offset:0
  buffer_load_dwordx4 a[116:119], v1, s[4:7], s34 offen offset:1024
  buffer_load_dwordx4 a[120:123], v1, s[4:7], s34 offen offset:2048
  buffer_load_dwordx4 a[124:127], v1, s[4:7], s34 offen offset:3072
  s_add_u32 s34, s34, 4096
  buffer_load_dwordx4 a[128:131], v1, s[4:7], s34 offen offset:0
  buffer_load_dwordx4 a[132:135], v1, s[4:7], s34 offen offset:1024
  buffer_load_dwordx4 a[136:139], v1, s[4:7], s34 offen offset:2048
  buffer_load_dwordx4 a[140:143], v1, s[4:7], s34 offen offset:3072
  s_add_u32 s34, s34, 4096
  buffer_load_dwordx4 a[144:147], v1, s[4:7], s34 offen offset:0
  buffer_load_dwordx4 a[148:151], v1, s[4:7], s34 offen offset:1024
  buffer_load_dwordx4 a[152:155], v1, s[4:7], s34 offen offset:2048
  buffer_load_dwordx4 a[156:159], v1, s[4:7], s34 offen offset:3072
  s_waitcnt vmcnt(20)
  s_mul_i32 s34, s15, 12
  s_mul_i32 s35, s16, 6
  s_add_u32 s34, s34, s35
  s_add_u32 s34, s34, 4
  s_mul_i32 s34, s34, 20480
  s_add_u32 s34, s34, 22020096
  buffer_load_dwordx4 a[160:163], v1, s[4:7], s34 offen offset:0
  buffer_load_dwordx4 a[164:167], v1, s[4:7], s34 offen offset:1024
  buffer_load_dwordx4 a[168:171], v1, s[4:7], s34 offen offset:2048
  buffer_load_dwordx4 a[172:175], v1, s[4:7], s34 offen offset:3072
  s_add_u32 s34, s34, 4096
  buffer_load_dwordx4 a[176:179], v1, s[4:7], s34 offen offset:0
  buffer_load_dwordx4 a[180:183], v1, s[4:7], s34 offen offset:1024
  buffer_load_dwordx4 a[184:187], v1, s[4:7], s34 offen offset:2048
  buffer_load_dwordx4 a[188:191], v1, s[4:7], s34 offen offset:3072
  s_add_u32 s34, s34, 4096
  buffer_load_dwordx4 a[192:195], v1, s[4:7], s34 offen offset:0
  buffer_load_dwordx4 a[196:199], v1, s[4:7], s34 offen offset:1024
  buffer_load_dwordx4 a[200:203], v1, s[4:7], s34 offen offset:2048
  buffer_load_dwordx4 a[204:207], v1, s[4:7], s34 offen offset:3072
  s_add_u32 s34, s34, 4096
  buffer_load_dwordx4 a[208:211], v1, s[4:7], s34 offen offset:0
  buffer_load_dwordx4 a[212:215], v1, s[4:7], s34 offen offset:1024
  buffer_load_dwordx4 a[216:219], v1, s[4:7], s34 offen offset:2048
  buffer_load_dwordx4 a[220:223], v1, s[4:7], s34 offen offset:3072
  s_add_u32 s34, s34, 4096
  buffer_load_dwordx4 a[224:227], v1, s[4:7], s34 offen offset:0
  buffer_load_dwordx4 a[228:231], v1, s[4:7], s34 offen offset:1024
  buffer_load_dwordx4 a[232:235], v1, s[4:7], s34 offen offset:2048
  buffer_load_dwordx4 a[236:239], v1, s[4:7], s34 offen offset:3072
  s_waitcnt vmcnt(20)
  s_mul_i32 s34, s15, 12
  s_mul_i32 s35, s16, 6
  s_add_u32 s34, s34, s35
  s_add_u32 s34, s34, 5
  s_mul_i32 s34, s34, 20480
  s_add_u32 s34, s34, 22020096
  buffer_load_dwordx4 v[96:99], v1, s[4:7], s34 offen offset:0
  buffer_load_dwordx4 v[100:103], v1, s[4:7], s34 offen offset:1024
  buffer_load_dwordx4 v[104:107], v1, s[4:7], s34 offen offset:2048
  buffer_load_dwordx4 v[108:111], v1, s[4:7], s34 offen offset:3072
  s_add_u32 s34, s34, 4096
  buffer_load_dwordx4 v[112:115], v1, s[4:7], s34 offen offset:0
  buffer_load_dwordx4 v[116:119], v1, s[4:7], s34 offen offset:1024
  buffer_load_dwordx4 v[120:123], v1, s[4:7], s34 offen offset:2048
  buffer_load_dwordx4 v[124:127], v1, s[4:7], s34 offen offset:3072
  s_add_u32 s34, s34, 4096
  buffer_load_dwordx4 v[128:131], v1, s[4:7], s34 offen offset:0
  buffer_load_dwordx4 v[132:135], v1, s[4:7], s34 offen offset:1024
  buffer_load_dwordx4 v[136:139], v1, s[4:7], s34 offen offset:2048
  buffer_load_dwordx4 v[140:143], v1, s[4:7], s34 offen offset:3072
  s_add_u32 s34, s34, 4096
  buffer_load_dwordx4 v[144:147], v1, s[4:7], s34 offen offset:0
  buffer_load_dwordx4 v[148:151], v1, s[4:7], s34 offen offset:1024
  buffer_load_dwordx4 v[152:155], v1, s[4:7], s34 offen offset:2048
  buffer_load_dwordx4 v[156:159], v1, s[4:7], s34 offen offset:3072
  s_add_u32 s34, s34, 4096
  buffer_load_dwordx4 v[160:163], v1, s[4:7], s34 offen offset:0
  buffer_load_dwordx4 v[164:167], v1, s[4:7], s34 offen offset:1024
  buffer_load_dwordx4 v[168:171], v1, s[4:7], s34 offen offset:2048
  buffer_load_dwordx4 v[172:175], v1, s[4:7], s34 offen offset:3072
  s_waitcnt vmcnt(20)
  v_and_b32 v30, 7, v0
  v_lshlrev_b32 v30, 3, v30
reca_cens188:
  buffer_load_dwordx2 v[28:29], v30, s[8:11], 0 offen sc1
  s_waitcnt vmcnt(0)
  v_sad_u8 v31, v28, 0, 0
  v_sad_u8 v31, v29, 0, v31
  v_cmp_gt_u32 vcc, 32, v31
  s_cbranch_vccz reca_censok189
  s_sleep 8
  s_sub_u32 s18, s18, 1
  s_cbranch_scc0 reca_cens188
  s_mov_b32 s18, 0
reca_censok189:
  v_and_b32 v28, 0x20202020, v28
  v_and_b32 v29, 0x20202020, v29
  v_cmp_ne_u32 s[34:35], 0, v28
  v_cmp_ne_u32 s[36:37], 0, v29
  s_nop 3
  s_and_b32 s34, s34, 0xff
  s_and_b32 s36, s36, 0xff
  s_or_b32 s35, s34, s36
  s_lshr_b32 s37, s35, s13
  s_and_b32 s37, s37, 1
  s_xor_b32 s43, s37, 1
  s_cmp_eq_u32 s57, 0
  s_cselect_b32 s58, s36, s34
  v_mov_b32 v31, 0x80000000
  s_cmp_lg_u32 s43, 0
  s_cbranch_scc1 reca_pslow190
reca_ptop191:
  s_cmp_lt_u32 s17, 6
  s_cbranch_scc1 reca_pgo192
  s_sub_u32 s36, s17, 6
reca_ppoll193:
  buffer_load_dword v28, v4, s[4:7], s25 offen sc1
  s_waitcnt vmcnt(0)
  v_readfirstlane_b32 s34, v28
  s_nop 3
  s_cmp_ge_i32 s34, s36
  s_cbranch_scc1 reca_pgo192
  s_sleep 8
  s_sub_u32 s18, s18, 1
  s_cbranch_scc0 reca_ppoll193
  s_mov_b32 s18, 0
reca_pgo192:
  s_waitcnt vmcnt(0)
  s_barrier
  v_add_u32 v7, s26, v1
  s_xor_b32 s26, s26, 40960
  s_add_u32 s37, s17, 1
  s_cmp_ge_u32 s37, 64
  s_cbranch_scc1 reca_pnodma194
  s_mul_i32 s20, s37, 40960
  s_add_u32 s20, s20, 153636864
  s_add_u32 m0, s26, 20480
  s_nop 0
  buffer_load_dwordx4 v1, s[4:7], s20 offen offset:0 lds
  buffer_load_dwordx4 v1, s[4:7], s20 offen offset:1024 lds
  buffer_load_dwordx4 v1, s[4:7], s20 offen offset:2048 lds
  buffer_load_dwordx4 v1, s[4:7], s20 offen offset:3072 lds
  s_add_u32 s20, s20, 4096
  s_add_u32 m0, s26, 24576
  s_nop 0
  buffer_load_dwordx4 v1, s[4:7], s20 offen offset:0 lds
  buffer_load_dwordx4 v1, s[4:7], s20 offen offset:1024 lds
  buffer_load_dwordx4 v1, s[4:7], s20 offen offset:2048 lds
  buffer_load_dwordx4 v1, s[4:7], s20 offen offset:3072 lds
  s_add_u32 s20, s20, 4096
  s_add_u32 m0, s26, 28672
  s_nop 0
  buffer_load_dwordx4 v1, s[4:7], s20 offen offset:0 lds
  buffer_load_dwordx4 v1, s[4:7], s20 offen offset:1024 lds
  s_lshl_b32 s34, s15, 6
  s_add_u32 s34, s34, s37
  s_mul_i32 s34, s34, 12288
  s_mul_i32 s35, s16, 3072
  s_add_u32 s35, s35, s34
  s_add_u32 s27, s35, 37748736
  s_mul_i32 s35, s16, 6144
  s_add_u32 s35, s35, s34
  s_add_u32 s28, s35, 62914560
  s_add_u32 s34, s28, 4096
  buffer_load_dwordx4 v[16:19], v1, s[4:7], s34 offen sc1
  s_add_u32 s34, s28, 5120
  buffer_load_dwordx4 v[16:19], v1, s[4:7], s34 offen sc1
reca_pnodma194:
  s_lshl_b32 s34, s15, 6
  s_add_u32 s34, s34, s17
  s_mul_i32 s34, s34, 12288
  s_mul_i32 s35, s16, 3072
  s_add_u32 s35, s35, s34
  s_add_u32 s21, s35, 37748736
  s_add_u32 s22, s35, 88080384
  s_mul_i32 s35, s16, 6144
  s_add_u32 s35, s35, s34
  s_add_u32 s23, s35, 62914560
  ds_read_b128 v[72:75], v7 offset:0
  ds_read_b128 v[76:79], v7 offset:20480
  ds_read_b128 v[80:83], v7 offset:1024
  ds_read_b128 v[84:87], v7 offset:21504
  ds_read_b128 v[88:91], v7 offset:2048
  ds_read_b128 v[92:95], v7 offset:22528
  s_waitcnt lgkmcnt(4)
  v_mfma_f32_16x16x32_bf16 v[32:35], a[0:3], v[72:75], 0
  v_mfma_f32_16x16x32_bf16 v[36:39], a[0:3], v[76:79], 0
  v_mfma_f32_16x16x32_bf16 v[40:43], a[80:83], v[72:75], 0
  v_mfma_f32_16x16x32_bf16 v[44:47], a[80:83], v[76:79], 0
  v_mfma_f32_16x16x32_bf16 v[48:51], v[72:75], a[160:163], 0
  v_mfma_f32_16x16x32_bf16 v[52:55], v[76:79], a[160:163], 0
  v_mfma_f32_16x16x32_bf16 v[56:59], v[72:75], v[96:99], 0
  v_mfma_f32_16x16x32_bf16 v[60:63], v[76:79], v[96:99], 0
  ds_read_b128 v[72:75], v7 offset:3072
  ds_read_b128 v[76:79], v7 offset:23552
  s_waitcnt lgkmcnt(4)
  v_mfma_f32_16x16x32_bf16 v[32:35], a[4:7], v[80:83], v[32:35]
  v_mfma_f32_16x16x32_bf16 v[36:39], a[4:7], v[84:87], v[36:39]
  v_mfma_f32_16x16x32_bf16 v[40:43], a[84:87], v[80:83], v[40:43]
  v_mfma_f32_16x16x32_bf16 v[44:47], a[84:87], v[84:87], v[44:47]
  v_mfma_f32_16x16x32_bf16 v[48:51], v[80:83], a[164:167], v[48:51]
  v_mfma_f32_16x16x32_bf16 v[52:55], v[84:87], a[164:167], v[52:55]
  v_mfma_f32_16x16x32_bf16 v[56:59], v[80:83], v[100:103], v[56:59]
  v_mfma_f32_16x16x32_bf16 v[60:63], v[84:87], v[100:103], v[60:63]
  ds_read_b128 v[80:83], v7 offset:4096
  ds_read_b128 v[84:87], v7 offset:24576
  s_waitcnt lgkmcnt(4)
  v_mfma_f32_16x16x32_bf16 v[32:35], a[8:11], v[88:91], v[32:35]
  v_mfma_f32_16x16x32_bf16 v[36:39], a[8:11], v[92:95], v[36:39]
  v_mfma_f32_16x16x32_bf16 v[40:43], a[88:91], v[88:91], v[40:43]
  v_mfma_f32_16x16x32_bf16 v[44:47], a[88:91], v[92:95], v[44:47]
  v_mfma_f32_16x16x32_bf16 v[48:51], v[88:91], a[168:171], v[48:51]
  v_mfma_f32_16x16x32_bf16 v[52:55], v[92:95], a[168:171], v[52:55]
  v_mfma_f32_16x16x32_bf16 v[56:59], v[88:91], v[104:107], v[56:59]
  v_mfma_f32_16x16x32_bf16 v[60:63], v[92:95], v[104:107], v[60:63]
  ds_read_b128 v[88:91], v7 offset:5120
  ds_read_b128 v[92:95], v7 offset:25600
  s_waitcnt lgkmcnt(4)
  v_mfma_f32_16x16x32_bf16 v[32:35], a[12:15], v[72:75], v[32:35]
  v_mfma_f32_16x16x32_bf16 v[36:39], a[12:15], v[76:79], v[36:39]
  v_mfma_f32_16x16x32_bf16 v[40:43], a[92:95], v[72:75], v[40:43]
  v_mfma_f32_16x16x32_bf16 v[44:47], a[92:95], v[76:79], v[44:47]
  v_mfma_f32_16x16x32_bf16 v[48:51], v[72:75], a[172:175], v[48:51]
  v_mfma_f32_16x16x32_bf16 v[52:55], v[76:79], a[172:175], v[52:55]
  v_mfma_f32_16x16x32_bf16 v[56:59], v[72:75], v[108:111], v[56:59]
  v_mfma_f32_16x16x32_bf16 v[60:63], v[76:79], v[108:111], v[60:63]
  ds_read_b128 v[72:75], v7 offset:6144
  ds_read_b128 v[76:79], v7 offset:26624
  s_waitcnt lgkmcnt(4)
  v_mfma_f32_16x16x32_bf16 v[32:35], a[16:19], v[80:83], v[32:35]
  v_mfma_f32_16x16x32_bf16 v[36:39], a[16:19], v[84:87], v[36:39]
  v_mfma_f32_16x16x32_bf16 v[40:43], a[96:99], v[80:83], v[40:43]
  v_mfma_f32_16x16x32_bf16 v[44:47], a[96:99], v[84:87], v[44:47]
  v_mfma_f32_16x16x32_bf16 v[48:51], v[80:83], a[176:179], v[48:51]
  v_mfma_f32_16x16x32_bf16 v[52:55], v[84:87], a[176:179], v[52:55]
  v_mfma_f32_16x16x32_bf16 v[56:59], v[80:83], v[112:115], v[56:59]
  v_mfma_f32_16x16x32_bf16 v[60:63], v[84:87], v[112:115], v[60:63]
  ds_read_b128 v[80:83], v7 offset:7168
  ds_read_b128 v[84:87], v7 offset:27648
  s_waitcnt lgkmcnt(4)
  v_mfma_f32_16x16x32_bf16 v[32:35], a[20:23], v[88:91], v[32:35]
  v_mfma_f32_16x16x32_bf16 v[36:39], a[20:23], v[92:95], v[36:39]
  v_mfma_f32_16x16x32_bf16 v[40:43], a[100:103], v[88:91], v[40:43]
  v_mfma_f32_16x16x32_bf16 v[44:47], a[100:103], v[92:95], v[44:47]
  v_mfma_f32_16x16x32_bf16 v[48:51], v[88:91], a[180:183], v[48:51]
  v_mfma_f32_16x16x32_bf16 v[52:55], v[92:95], a[180:183], v[52:55]
  v_mfma_f32_16x16x32_bf16 v[56:59], v[88:91], v[116:119], v[56:59]
  v_mfma_f32_16x16x32_bf16 v[60:63], v[92:95], v[116:119], v[60:63]
  ds_read_b128 v[88:91], v7 offset:8192
  ds_read_b128 v[92:95], v7 offset:28672
  s_waitcnt lgkmcnt(4)
  v_mfma_f32_16x16x32_bf16 v[32:35], a[24:27], v[72:75], v[32:35]
  v_mfma_f32_16x16x32_bf16 v[36:39], a[24:27], v[76:79], v[36:39]
  v_mfma_f32_16x16x32_bf16 v[40:43], a[104:107], v[72:75], v[40:43]
  v_mfma_f32_16x16x32_bf16 v[44:47], a[104:107], v[76:79], v[44:47]
  v_mfma_f32_16x16x32_bf16 v[48:51], v[72:75], a[184:187], v[48:51]
  v_mfma_f32_16x16x32_bf16 v[52:55], v[76:79], a[184:187], v[52:55]
  v_mfma_f32_16x16x32_bf16 v[56:59], v[72:75], v[120:123], v[56:59]
  v_mfma_f32_16x16x32_bf16 v[60:63], v[76:79], v[120:123], v[60:63]
  ds_read_b128 v[72:75], v7 offset:9216
  ds_read_b128 v[76:79], v7 offset:29696
  s_waitcnt lgkmcnt(4)
  v_mfma_f32_16x16x32_bf16 v[32:35], a[28:31], v[80:83], v[32:35]
  v_mfma_f32_16x16x32_bf16 v[36:39], a[28:31], v[84:87], v[36:39]
  v_mfma_f32_16x16x32_bf16 v[40:43], a[108:111], v[80:83], v[40:43]
  v_mfma_f32_16x16x32_bf16 v[44:47], a[108:111], v[84:87], v[44:47]
  v_mfma_f32_16x16x32_bf16 v[48:51], v[80:83], a[188:191], v[48:51]
  v_mfma_f32_16x16x32_bf16 v[52:55], v[84:87], a[188:191], v[52:55]
  v_mfma_f32_16x16x32_bf16 v[56:59], v[80:83], v[124:127], v[56:59]
  v_mfma_f32_16x16x32_bf16 v[60:63], v[84:87], v[124:127], v[60:63]
  ds_read_b128 v[80:83], v7 offset:10240
  ds_read_b128 v[84:87], v7 offset:30720
  s_waitcnt lgkmcnt(4)
  v_mfma_f32_16x16x32_bf16 v[32:35], a[32:35], v[88:91], v[32:35]
  v_mfma_f32_16x16x32_bf16 v[36:39], a[32:35], v[92:95], v[36:39]
  v_mfma_f32_16x16x32_bf16 v[40:43], a[112:115], v[88:91], v[40:43]
  v_mfma_f32_16x16x32_bf16 v[44:47], a[112:115], v[92:95], v[44:47]
  v_mfma_f32_16x16x32_bf16 v[48:51], v[88:91], a[192:195], v[48:51]
  v_mfma_f32_16x16x32_bf16 v[52:55], v[92:95], a[192:195], v[52:55]
  v_mfma_f32_16x16x32_bf16 v[56:59], v[88:91], v[128:131], v[56:59]
  v_mfma_f32_16x16x32_bf16 v[60:63], v[92:95], v[128:131], v[60:63]
  ds_read_b128 v[88:91], v7 offset:11264
  ds_read_b128 v[92:95], v7 offset:31744
  s_waitcnt lgkmcnt(4)
  v_mfma_f32_16x16x32_bf16 v[32:35], a[36:39], v[72:75], v[32:35]
  v_mfma_f32_16x16x32_bf16 v[36:39], a[36:39], v[76:79], v[36:39]
  v_mfma_f32_16x16x32_bf16 v[40:43], a[116:119], v[72:75], v[40:43]
  v_mfma_f32_16x16x32_bf16 v[44:47], a[116:119], v[76:79], v[44:47]
  v_mfma_f32_16x16x32_bf16 v[48:51], v[72:75], a[196:199], v[48:51]
  v_mfma_f32_16x16x32_bf16 v[52:55], v[76:79], a[196:199], v[52:55]
  v_mfma_f32_16x16x32_bf16 v[56:59], v[72:75], v[132:135], v[56:59]
  v_mfma_f32_16x16x32_bf16 v[60:63], v[76:79], v[132:135], v[60:63]
  ds_read_b128 v[72:75], v7 offset:12288
  ds_read_b128 v[76:79], v7 offset:32768
  s_waitcnt lgkmcnt(4)
  v_mfma_f32_16x16x32_bf16 v[32:35], a[40:43], v[80:83], v[32:35]
  v_mfma_f32_16x16x32_bf16 v[36:39], a[40:43], v[84:87], v[36:39]
  v_mfma_f32_16x16x32_bf16 v[40:43], a[120:123], v[80:83], v[40:43]
  v_mfma_f32_16x16x32_bf16 v[44:47], a[120:123], v[84:87], v[44:47]
  v_mfma_f32_16x16x32_bf16 v[48:51], v[80:83], a[200:203], v[48:51]
  v_mfma_f32_16x16x32_bf16 v[52:55], v[84:87], a[200:203], v[52:55]
  v_mfma_f32_16x16x32_bf16 v[56:59], v[80:83], v[136:139], v[56:59]
  v_mfma_f32_16x16x32_bf16 v[60:63], v[84:87], v[136:139], v[60:63]
  ds_read_b128 v[80:83], v7 offset:13312
  ds_read_b128 v[84:87], v7 offset:33792
  s_waitcnt lgkmcnt(4)
  v_mfma_f32_16x16x32_bf16 v[32:35], a[44:47], v[88:91], v[32:35]
  v_mfma_f32_16x16x32_bf16 v[36:39], a[44:47], v[92:95], v[36:39]
  v_mfma_f32_16x16x32_bf16 v[40:43], a[124:127], v[88:91], v[40:43]
  v_mfma_f32_16x16x32_bf16 v[44:47], a[124:127], v[92:95], v[44:47]
  v_mfma_f32_16x16x32_bf16 v[48:51], v[88:91], a[204:207], v[48:51]
  v_mfma_f32_16x16x32_bf16 v[52:55], v[92:95], a[204:207], v[52:55]
  v_mfma_f32_16x16x32_bf16 v[56:59], v[88:91], v[140:143], v[56:59]
  v_mfma_f32_16x16x32_bf16 v[60:63], v[92:95], v[140:143], v[60:63]
  ds_read_b128 v[88:91], v7 offset:14336
  ds_read_b128 v[92:95], v7 offset:34816
  s_waitcnt lgkmcnt(4)
  v_mfma_f32_16x16x32_bf16 v[32:35], a[48:51], v[72:75], v[32:35]
  v_mfma_f32_16x16x32_bf16 v[36:39], a[48:51], v[76:79], v[36:39]
  v_mfma_f32_16x16x32_bf16 v[40:43], a[128:131], v[72:75], v[40:43]
  v_mfma_f32_16x16x32_bf16 v[44:47], a[128:131], v[76:79], v[44:47]
  v_mfma_f32_16x16x32_bf16 v[48:51], v[72:75], a[208:211], v[48:51]
  v_mfma_f32_16x16x32_bf16 v[52:55], v[76:79], a[208:211], v[52:55]
  v_mfma_f32_16x16x32_bf16 v[56:59], v[72:75], v[144:147], v[56:59]
  v_mfma_f32_16x16x32_bf16 v[60:63], v[76:79], v[144:147], v[60:63]
  ds_read_b128 v[72:75], v7 offset:15360
  ds_read_b128 v[76:79], v7 offset:35840
  s_waitcnt lgkmcnt(4)
  v_mfma_f32_16x16x32_bf16 v[32:35], a[52:55], v[80:83], v[32:35]
  v_mfma_f32_16x16x32_bf16 v[36:39], a[52:55], v[84:87], v[36:39]
  v_mfma_f32_16x16x32_bf16 v[40:43], a[132:135], v[80:83], v[40:43]
  v_mfma_f32_16x16x32_bf16 v[44:47], a[132:135], v[84:87], v[44:47]
  v_mfma_f32_16x16x32_bf16 v[48:51], v[80:83], a[212:215], v[48:51]
  v_mfma_f32_16x16x32_bf16 v[52:55], v[84:87], a[212:215], v[52:55]
  v_mfma_f32_16x16x32_bf16 v[56:59], v[80:83], v[148:151], v[56:59]
  v_mfma_f32_16x16x32_bf16 v[60:63], v[84:87], v[148:151], v[60:63]
  ds_read_b128 v[80:83], v7 offset:16384
  ds_read_b128 v[84:87], v7 offset:36864
  s_waitcnt lgkmcnt(4)
  v_mfma_f32_16x16x32_bf16 v[32:35], a[56:59], v[88:91], v[32:35]
  v_mfma_f32_16x16x32_bf16 v[36:39], a[56:59], v[92:95], v[36:39]
  v_mfma_f32_16x16x32_bf16 v[40:43], a[136:139], v[88:91], v[40:43]
  v_mfma_f32_16x16x32_bf16 v[44:47], a[136:139], v[92:95], v[44:47]
  v_mfma_f32_16x16x32_bf16 v[48:51], v[88:91], a[216:219], v[48:51]
  v_mfma_f32_16x16x32_bf16 v[52:55], v[92:95], a[216:219], v[52:55]
  v_mfma_f32_16x16x32_bf16 v[56:59], v[88:91], v[152:155], v[56:59]
  v_mfma_f32_16x16x32_bf16 v[60:63], v[92:95], v[152:155], v[60:63]
  ds_read_b128 v[88:91], v7 offset:17408
  ds_read_b128 v[92:95], v7 offset:37888
  s_waitcnt lgkmcnt(4)
  v_mfma_f32_16x16x32_bf16 v[32:35], a[60:63], v[72:75], v[32:35]
  v_mfma_f32_16x16x32_bf16 v[36:39], a[60:63], v[76:79], v[36:39]
  v_mfma_f32_16x16x32_bf16 v[40:43], a[140:143], v[72:75], v[40:43]
  v_mfma_f32_16x16x32_bf16 v[44:47], a[140:143], v[76:79], v[44:47]
  v_mfma_f32_16x16x32_bf16 v[48:51], v[72:75], a[220:223], v[48:51]
  v_mfma_f32_16x16x32_bf16 v[52:55], v[76:79], a[220:223], v[52:55]
  v_mfma_f32_16x16x32_bf16 v[56:59], v[72:75], v[156:159], v[56:59]
  v_mfma_f32_16x16x32_bf16 v[60:63], v[76:79], v[156:159], v[60:63]
  ds_read_b128 v[72:75], v7 offset:18432
  ds_read_b128 v[76:79], v7 offset:38912
  s_waitcnt lgkmcnt(4)
  v_mfma_f32_16x16x32_bf16 v[32:35], a[64:67], v[80:83], v[32:35]
  v_mfma_f32_16x16x32_bf16 v[36:39], a[64:67], v[84:87], v[36:39]
  v_mfma_f32_16x16x32_bf16 v[40:43], a[144:147], v[80:83], v[40:43]
  v_mfma_f32_16x16x32_bf16 v[44:47], a[144:147], v[84:87], v[44:47]
  v_mfma_f32_16x16x32_bf16 v[48:51], v[80:83], a[224:227], v[48:51]
  v_mfma_f32_16x16x32_bf16 v[52:55], v[84:87], a[224:227], v[52:55]
  v_mfma_f32_16x16x32_bf16 v[56:59], v[80:83], v[160:163], v[56:59]
  v_mfma_f32_16x16x32_bf16 v[60:63], v[84:87], v[160:163], v[60:63]
  ds_read_b128 v[80:83], v7 offset:19456
  ds_read_b128 v[84:87], v7 offset:39936
  s_waitcnt lgkmcnt(4)
  v_mfma_f32_16x16x32_bf16 v[32:35], a[68:71], v[88:91], v[32:35]
  v_mfma_f32_16x16x32_bf16 v[36:39], a[68:71], v[92:95], v[36:39]
  v_mfma_f32_16x16x32_bf16 v[40:43], a[148:151], v[88:91], v[40:43]
  v_mfma_f32_16x16x32_bf16 v[44:47], a[148:151], v[92:95], v[44:47]
  v_mfma_f32_16x16x32_bf16 v[48:51], v[88:91], a[228:231], v[48:51]
  v_mfma_f32_16x16x32_bf16 v[52:55], v[92:95], a[228:231], v[52:55]
  v_mfma_f32_16x16x32_bf16 v[56:59], v[88:91], v[164:167], v[56:59]
  v_mfma_f32_16x16x32_bf16 v[60:63], v[92:95], v[164:167], v[60:63]
  s_waitcnt lgkmcnt(2)
  v_mfma_f32_16x16x32_bf16 v[32:35], a[72:75], v[72:75], v[32:35]
  v_mfma_f32_16x16x32_bf16 v[36:39], a[72:75], v[76:79], v[36:39]
  v_mfma_f32_16x16x32_bf16 v[40:43], a[152:155], v[72:75], v[40:43]
  v_mfma_f32_16x16x32_bf16 v[44:47], a[152:155], v[76:79], v[44:47]
  v_mfma_f32_16x16x32_bf16 v[48:51], v[72:75], a[232:235], v[48:51]
  v_mfma_f32_16x16x32_bf16 v[52:55], v[76:79], a[232:235], v[52:55]
  v_mfma_f32_16x16x32_bf16 v[56:59], v[72:75], v[168:171], v[56:59]
  v_mfma_f32_16x16x32_bf16 v[60:63], v[76:79], v[168:171], v[60:63]
  s_waitcnt lgkmcnt(0)
  v_mfma_f32_16x16x32_bf16 v[32:35], a[76:79], v[80:83], v[32:35]
  v_mfma_f32_16x16x32_bf16 v[36:39], a[76:79], v[84:87], v[36:39]
  v_mfma_f32_16x16x32_bf16 v[40:43], a[156:159], v[80:83], v[40:43]
  v_mfma_f32_16x16x32_bf16 v[44:47], a[156:159], v[84:87], v[44:47]
  v_mfma_f32_16x16x32_bf16 v[48:51], v[80:83], a[236:239], v[48:51]
  v_mfma_f32_16x16x32_bf16 v[52:55], v[84:87], a[236:239], v[52:55]
  v_mfma_f32_16x16x32_bf16 v[56:59], v[80:83], v[172:175], v[56:59]
  v_mfma_f32_16x16x32_bf16 v[60:63], v[84:87], v[172:175], v[60:63]
  s_nop 0
  v_cvt_pk_bf16_f32 v8, v32, v33
  v_cvt_pk_bf16_f32 v9, v34, v35
  v_cvt_pk_bf16_f32 v10, v40, v41
  v_cvt_pk_bf16_f32 v11, v42, v43
  s_add_u32 s34, s22, 0
  buffer_store_dwordx4 v[8:11], v1, s[4:7], s34 offen
  v_cvt_pk_bf16_f32 v12, v36, v37
  v_cvt_pk_bf16_f32 v13, v38, v39
  v_cvt_pk_bf16_f32 v14, v44, v45
  v_cvt_pk_bf16_f32 v15, v46, v47
  s_add_u32 s34, s22, 6144
  buffer_store_dwordx4 v[12:15], v1, s[4:7], s34 offen
  v_cvt_pk_bf16_f32 v8, v48, v49
  v_cvt_pk_bf16_f32 v9, v50, v51
  v_cvt_pk_bf16_f32 v10, v52, v53
  v_cvt_pk_bf16_f32 v11, v54, v55
  s_add_u32 s34, s23, 4096
  buffer_store_dwordx4 v[8:11], v1, s[4:7], s34 offen
  v_cvt_pk_bf16_f32 v12, v56, v57
  v_cvt_pk_bf16_f32 v13, v58, v59
  v_cvt_pk_bf16_f32 v14, v60, v61
  v_cvt_pk_bf16_f32 v15, v62, v63
  s_add_u32 s34, s23, 5120
  buffer_store_dwordx4 v[12:15], v1, s[4:7], s34 offen
  s_waitcnt vmcnt(0)
  s_barrier
  s_add_u32 s17, s17, 1
  s_cmp_lt_u32 s17, 64
  s_cbranch_scc1 reca_ptop191
  s_branch reca_exit1
reca_pslow190:
reca_ptop196:
  s_cmp_lt_u32 s17, 6
  s_cbranch_scc1 reca_pgo197
  s_sub_u32 s36, s17, 6
reca_ppoll198:
  buffer_load_dword v28, v4, s[4:7], s25 offen sc1
  s_waitcnt vmcnt(0)
  v_readfirstlane_b32 s34, v28
  s_nop 3
  s_cmp_ge_i32 s34, s36
  s_cbranch_scc1 reca_pgo197
  s_sleep 8
  s_sub_u32 s18, s18, 1
  s_cbranch_scc0 reca_ppoll198
  s_mov_b32 s18, 0
reca_pgo197:
  s_waitcnt vmcnt(0)
  s_barrier
  v_add_u32 v7, s26, v1
  s_xor_b32 s26, s26, 40960
  s_add_u32 s37, s17, 1
  s_cmp_ge_u32 s37, 64
  s_cbranch_scc1 reca_pnodma199
  s_mul_i32 s20, s37, 40960
  s_add_u32 s20, s20, 153636864
  s_add_u32 m0, s26, 20480
  s_nop 0
  buffer_load_dwordx4 v1, s[4:7], s20 offen offset:0 lds
  buffer_load_dwordx4 v1, s[4:7], s20 offen offset:1024 lds
  buffer_load_dwordx4 v1, s[4:7], s20 offen offset:2048 lds
  buffer_load_dwordx4 v1, s[4:7], s20 offen offset:3072 lds
  s_add_u32 s20, s20, 4096
  s_add_u32 m0, s26, 24576
  s_nop 0
  buffer_load_dwordx4 v1, s[4:7], s20 offen offset:0 lds
  buffer_load_dwordx4 v1, s[4:7], s20 offen offset:1024 lds
  buffer_load_dwordx4 v1, s[4:7], s20 offen offset:2048 lds
  buffer_load_dwordx4 v1, s[4:7], s20 offen offset:3072 lds
  s_add_u32 s20, s20, 4096
  s_add_u32 m0, s26, 28672
  s_nop 0
  buffer_load_dwordx4 v1, s[4:7], s20 offen offset:0 lds
  buffer_load_dwordx4 v1, s[4:7], s20 offen offset:1024 lds
  s_lshl_b32 s34, s15, 6
  s_add_u32 s34, s34, s37
  s_mul_i32 s34, s34, 12288
  s_mul_i32 s35, s16, 3072
  s_add_u32 s35, s35, s34
  s_add_u32 s27, s35, 37748736
  s_mul_i32 s35, s16, 6144
  s_add_u32 s35, s35, s34
  s_add_u32 s28, s35, 62914560
  s_add_u32 s34, s28, 4096
  buffer_load_dwordx4 v[16:19], v1, s[4:7], s34 offen sc1
  s_add_u32 s34, s28, 5120
  buffer_load_dwordx4 v[16:19], v1, s[4:7], s34 offen sc1
reca_pnodma199:
  s_lshl_b32 s34, s15, 6
  s_add_u32 s34, s34, s17
  s_mul_i32 s34, s34, 12288
  s_mul_i32 s35, s16, 3072
  s_add_u32 s35, s35, s34
  s_add_u32 s21, s35, 37748736
  s_add_u32 s22, s35, 88080384
  s_mul_i32 s35, s16, 6144
  s_add_u32 s35, s35, s34
  s_add_u32 s23, s35, 62914560
  ds_read_b128 v[72:75], v7 offset:0
  ds_read_b128 v[76:79], v7 offset:20480
  ds_read_b128 v[80:83], v7 offset:1024
  ds_read_b128 v[84:87], v7 offset:21504
  ds_read_b128 v[88:91], v7 offset:2048
  ds_read_b128 v[92:95], v7 offset:22528
  s_waitcnt lgkmcnt(4)
  v_mfma_f32_16x16x32_bf16 v[32:35], a[0:3], v[72:75], 0
  v_mfma_f32_16x16x32_bf16 v[36:39], a[0:3], v[76:79], 0
  v_mfma_f32_16x16x32_bf16 v[40:43], a[80:83], v[72:75], 0
  v_mfma_f32_16x16x32_bf16 v[44:47], a[80:83], v[76:79], 0
  v_mfma_f32_16x16x32_bf16 v[48:51], v[72:75], a[160:163], 0
  v_mfma_f32_16x16x32_bf16 v[52:55], v[76:79], a[160:163], 0
  v_mfma_f32_16x16x32_bf16 v[56:59], v[72:75], v[96:99], 0
  v_mfma_f32_16x16x32_bf16 v[60:63], v[76:79], v[96:99], 0
  ds_read_b128 v[72:75], v7 offset:3072
  ds_read_b128 v[76:79], v7 offset:23552
  s_waitcnt lgkmcnt(4)
  v_mfma_f32_16x16x32_bf16 v[32:35], a[4:7], v[80:83], v[32:35]
  v_mfma_f32_16x16x32_bf16 v[36:39], a[4:7], v[84:87], v[36:39]
  v_mfma_f32_16x16x32_bf16 v[40:43], a[84:87], v[80:83], v[40:43]
  v_mfma_f32_16x16x32_bf16 v[44:47], a[84:87], v[84:87], v[44:47]
  v_mfma_f32_16x16x32_bf16 v[48:51], v[80:83], a[164:167], v[48:51]
  v_mfma_f32_16x16x32_bf16 v[52:55], v[84:87], a[164:167], v[52:55]
  v_mfma_f32_16x16x32_bf16 v[56:59], v[80:83], v[100:103], v[56:59]
  v_mfma_f32_16x16x32_bf16 v[60:63], v[84:87], v[100:103], v[60:63]
  ds_read_b128 v[80:83], v7 offset:4096
  ds_read_b128 v[84:87], v7 offset:24576
  s_waitcnt lgkmcnt(4)
  v_mfma_f32_16x16x32_bf16 v[32:35], a[8:11], v[88:91], v[32:35]
  v_mfma_f32_16x16x32_bf16 v[36:39], a[8:11], v[92:95], v[36:39]
  v_mfma_f32_16x16x32_bf16 v[40:43], a[88:91], v[88:91], v[40:43]
  v_mfma_f32_16x16x32_bf16 v[44:47], a[88:91], v[92:95], v[44:47]
  v_mfma_f32_16x16x32_bf16 v[48:51], v[88:91], a[168:171], v[48:51]
  v_mfma_f32_16x16x32_bf16 v[52:55], v[92:95], a[168:171], v[52:55]
  v_mfma_f32_16x16x32_bf16 v[56:59], v[88:91], v[104:107], v[56:59]
  v_mfma_f32_16x16x32_bf16 v[60:63], v[92:95], v[104:107], v[60:63]
  ds_read_b128 v[88:91], v7 offset:5120
  ds_read_b128 v[92:95], v7 offset:25600
  s_waitcnt lgkmcnt(4)
  v_mfma_f32_16x16x32_bf16 v[32:35], a[12:15], v[72:75], v[32:35]
  v_mfma_f32_16x16x32_bf16 v[36:39], a[12:15], v[76:79], v[36:39]
  v_mfma_f32_16x16x32_bf16 v[40:43], a[92:95], v[72:75], v[40:43]
  v_mfma_f32_16x16x32_bf16 v[44:47], a[92:95], v[76:79], v[44:47]
  v_mfma_f32_16x16x32_bf16 v[48:51], v[72:75], a[172:175], v[48:51]
  v_mfma_f32_16x16x32_bf16 v[52:55], v[76:79], a[172:175], v[52:55]
  v_mfma_f32_16x16x32_bf16 v[56:59], v[72:75], v[108:111], v[56:59]
  v_mfma_f32_16x16x32_bf16 v[60:63], v[76:79], v[108:111], v[60:63]
  ds_read_b128 v[72:75], v7 offset:6144
  ds_read_b128 v[76:79], v7 offset:26624
  s_waitcnt lgkmcnt(4)
  v_mfma_f32_16x16x32_bf16 v[32:35], a[16:19], v[80:83], v[32:35]
  v_mfma_f32_16x16x32_bf16 v[36:39], a[16:19], v[84:87], v[36:39]
  v_mfma_f32_16x16x32_bf16 v[40:43], a[96:99], v[80:83], v[40:43]
  v_mfma_f32_16x16x32_bf16 v[44:47], a[96:99], v[84:87], v[44:47]
  v_mfma_f32_16x16x32_bf16 v[48:51], v[80:83], a[176:179], v[48:51]
  v_mfma_f32_16x16x32_bf16 v[52:55], v[84:87], a[176:179], v[52:55]
  v_mfma_f32_16x16x32_bf16 v[56:59], v[80:83], v[112:115], v[56:59]
  v_mfma_f32_16x16x32_bf16 v[60:63], v[84:87], v[112:115], v[60:63]
  ds_read_b128 v[80:83], v7 offset:7168
  ds_read_b128 v[84:87], v7 offset:27648
  s_waitcnt lgkmcnt(4)
  v_mfma_f32_16x16x32_bf16 v[32:35], a[20:23], v[88:91], v[32:35]
  v_mfma_f32_16x16x32_bf16 v[36:39], a[20:23], v[92:95], v[36:39]
  v_mfma_f32_16x16x32_bf16 v[40:43], a[100:103], v[88:91], v[40:43]
  v_mfma_f32_16x16x32_bf16 v[44:47], a[100:103], v[92:95], v[44:47]
  v_mfma_f32_16x16x32_bf16 v[48:51], v[88:91], a[180:183], v[48:51]
  v_mfma_f32_16x16x32_bf16 v[52:55], v[92:95], a[180:183], v[52:55]
  v_mfma_f32_16x16x32_bf16 v[56:59], v[88:91], v[116:119], v[56:59]
  v_mfma_f32_16x16x32_bf16 v[60:63], v[92:95], v[116:119], v[60:63]
  ds_read_b128 v[88:91], v7 offset:8192
  ds_read_b128 v[92:95], v7 offset:28672
  s_waitcnt lgkmcnt(4)
  v_mfma_f32_16x16x32_bf16 v[32:35], a[24:27], v[72:75], v[32:35]
  v_mfma_f32_16x16x32_bf16 v[36:39], a[24:27], v[76:79], v[36:39]
  v_mfma_f32_16x16x32_bf16 v[40:43], a[104:107], v[72:75], v[40:43]
  v_mfma_f32_16x16x32_bf16 v[44:47], a[104:107], v[76:79], v[44:47]
  v_mfma_f32_16x16x32_bf16 v[48:51], v[72:75], a[184:187], v[48:51]
  v_mfma_f32_16x16x32_bf16 v[52:55], v[76:79], a[184:187], v[52:55]
  v_mfma_f32_16x16x32_bf16 v[56:59], v[72:75], v[120:123], v[56:59]
  v_mfma_f32_16x16x32_bf16 v[60:63], v[76:79], v[120:123], v[60:63]
  ds_read_b128 v[72:75], v7 offset:9216
  ds_read_b128 v[76:79], v7 offset:29696
  s_waitcnt lgkmcnt(4)
  v_mfma_f32_16x16x32_bf16 v[32:35], a[28:31], v[80:83], v[32:35]
  v_mfma_f32_16x16x32_bf16 v[36:39], a[28:31], v[84:87], v[36:39]
  v_mfma_f32_16x16x32_bf16 v[40:43], a[108:111], v[80:83], v[40:43]
  v_mfma_f32_16x16x32_bf16 v[44:47], a[108:111], v[84:87], v[44:47]
  v_mfma_f32_16x16x32_bf16 v[48:51], v[80:83], a[188:191], v[48:51]
  v_mfma_f32_16x16x32_bf16 v[52:55], v[84:87], a[188:191], v[52:55]
  v_mfma_f32_16x16x32_bf16 v[56:59], v[80:83], v[124:127], v[56:59]
  v_mfma_f32_16x16x32_bf16 v[60:63], v[84:87], v[124:127], v[60:63]
  ds_read_b128 v[80:83], v7 offset:10240
  ds_read_b128 v[84:87], v7 offset:30720
  s_waitcnt lgkmcnt(4)
  v_mfma_f32_16x16x32_bf16 v[32:35], a[32:35], v[88:91], v[32:35]
  v_mfma_f32_16x16x32_bf16 v[36:39], a[32:35], v[92:95], v[36:39]
  v_mfma_f32_16x16x32_bf16 v[40:43], a[112:115], v[88:91], v[40:43]
  v_mfma_f32_16x16x32_bf16 v[44:47], a[112:115], v[92:95], v[44:47]
  v_mfma_f32_16x16x32_bf16 v[48:51], v[88:91], a[192:195], v[48:51]
  v_mfma_f32_16x16x32_bf16 v[52:55], v[92:95], a[192:195], v[52:55]
  v_mfma_f32_16x16x32_bf16 v[56:59], v[88:91], v[128:131], v[56:59]
  v_mfma_f32_16x16x32_bf16 v[60:63], v[92:95], v[128:131], v[60:63]
  ds_read_b128 v[88:91], v7 offset:11264
  ds_read_b128 v[92:95], v7 offset:31744
  s_waitcnt lgkmcnt(4)
  v_mfma_f32_16x16x32_bf16 v[32:35], a[36:39], v[72:75], v[32:35]
  v_mfma_f32_16x16x32_bf16 v[36:39], a[36:39], v[76:79], v[36:39]
  v_mfma_f32_16x16x32_bf16 v[40:43], a[116:119], v[72:75], v[40:43]
  v_mfma_f32_16x16x32_bf16 v[44:47], a[116:119], v[76:79], v[44:47]
  v_mfma_f32_16x16x32_bf16 v[48:51], v[72:75], a[196:199], v[48:51]
  v_mfma_f32_16x16x32_bf16 v[52:55], v[76:79], a[196:199], v[52:55]
  v_mfma_f32_16x16x32_bf16 v[56:59], v[72:75], v[132:135], v[56:59]
  v_mfma_f32_16x16x32_bf16 v[60:63], v[76:79], v[132:135], v[60:63]
  ds_read_b128 v[72:75], v7 offset:12288
  ds_read_b128 v[76:79], v7 offset:32768
  s_waitcnt lgkmcnt(4)
  v_mfma_f32_16x16x32_bf16 v[32:35], a[40:43], v[80:83], v[32:35]
  v_mfma_f32_16x16x32_bf16 v[36:39], a[40:43], v[84:87], v[36:39]
  v_mfma_f32_16x16x32_bf16 v[40:43], a[120:123], v[80:83], v[40:43]
  v_mfma_f32_16x16x32_bf16 v[44:47], a[120:123], v[84:87], v[44:47]
  v_mfma_f32_16x16x32_bf16 v[48:51], v[80:83], a[200:203], v[48:51]
  v_mfma_f32_16x16x32_bf16 v[52:55], v[84:87], a[200:203], v[52:55]
  v_mfma_f32_16x16x32_bf16 v[56:59], v[80:83], v[136:139], v[56:59]
  v_mfma_f32_16x16x32_bf16 v[60:63], v[84:87], v[136:139], v[60:63]
  ds_read_b128 v[80:83], v7 offset:13312
  ds_read_b128 v[84:87], v7 offset:33792
  s_waitcnt lgkmcnt(4)
  v_mfma_f32_16x16x32_bf16 v[32:35], a[44:47], v[88:91], v[32:35]
  v_mfma_f32_16x16x32_bf16 v[36:39], a[44:47], v[92:95], v[36:39]
  v_mfma_f32_16x16x32_bf16 v[40:43], a[124:127], v[88:91], v[40:43]
  v_mfma_f32_16x16x32_bf16 v[44:47], a[124:127], v[92:95], v[44:47]
  v_mfma_f32_16x16x32_bf16 v[48:51], v[88:91], a[204:207], v[48:51]
  v_mfma_f32_16x16x32_bf16 v[52:55], v[92:95], a[204:207], v[52:55]
  v_mfma_f32_16x16x32_bf16 v[56:59], v[88:91], v[140:143], v[56:59]
  v_mfma_f32_16x16x32_bf16 v[60:63], v[92:95], v[140:143], v[60:63]
  ds_read_b128 v[88:91], v7 offset:14336
  ds_read_b128 v[92:95], v7 offset:34816
  s_waitcnt lgkmcnt(4)
  v_mfma_f32_16x16x32_bf16 v[32:35], a[48:51], v[72:75], v[32:35]
  v_mfma_f32_16x16x32_bf16 v[36:39], a[48:51], v[76:79], v[36:39]
  v_mfma_f32_16x16x32_bf16 v[40:43], a[128:131], v[72:75], v[40:43]
  v_mfma_f32_16x16x32_bf16 v[44:47], a[128:131], v[76:79], v[44:47]
  v_mfma_f32_16x16x32_bf16 v[48:51], v[72:75], a[208:211], v[48:51]
  v_mfma_f32_16x16x32_bf16 v[52:55], v[76:79], a[208:211], v[52:55]
  v_mfma_f32_16x16x32_bf16 v[56:59], v[72:75], v[144:147], v[56:59]
  v_mfma_f32_16x16x32_bf16 v[60:63], v[76:79], v[144:147], v[60:63]
  ds_read_b128 v[72:75], v7 offset:15360
  ds_read_b128 v[76:79], v7 offset:35840
  s_waitcnt lgkmcnt(4)
  v_mfma_f32_16x16x32_bf16 v[32:35], a[52:55], v[80:83], v[32:35]
  v_mfma_f32_16x16x32_bf16 v[36:39], a[52:55], v[84:87], v[36:39]
  v_mfma_f32_16x16x32_bf16 v[40:43], a[132:135], v[80:83], v[40:43]
  v_mfma_f32_16x16x32_bf16 v[44:47], a[132:135], v[84:87], v[44:47]
  v_mfma_f32_16x16x32_bf16 v[48:51], v[80:83], a[212:215], v[48:51]
  v_mfma_f32_16x16x32_bf16 v[52:55], v[84:87], a[212:215], v[52:55]
  v_mfma_f32_16x16x32_bf16 v[56:59], v[80:83], v[148:151], v[56:59]
  v_mfma_f32_16x16x32_bf16 v[60:63], v[84:87], v[148:151], v[60:63]
  ds_read_b128 v[80:83], v7 offset:16384
  ds_read_b128 v[84:87], v7 offset:36864
  s_waitcnt lgkmcnt(4)
  v_mfma_f32_16x16x32_bf16 v[32:35], a[56:59], v[88:91], v[32:35]
  v_mfma_f32_16x16x32_bf16 v[36:39], a[56:59], v[92:95], v[36:39]
  v_mfma_f32_16x16x32_bf16 v[40:43], a[136:139], v[88:91], v[40:43]
  v_mfma_f32_16x16x32_bf16 v[44:47], a[136:139], v[92:95], v[44:47]
  v_mfma_f32_16x16x32_bf16 v[48:51], v[88:91], a[216:219], v[48:51]
  v_mfma_f32_16x16x32_bf16 v[52:55], v[92:95], a[216:219], v[52:55]
  v_mfma_f32_16x16x32_bf16 v[56:59], v[88:91], v[152:155], v[56:59]
  v_mfma_f32_16x16x32_bf16 v[60:63], v[92:95], v[152:155], v[60:63]
  ds_read_b128 v[88:91], v7 offset:17408
  ds_read_b128 v[92:95], v7 offset:37888
  s_waitcnt lgkmcnt(4)
  v_mfma_f32_16x16x32_bf16 v[32:35], a[60:63], v[72:75], v[32:35]
  v_mfma_f32_16x16x32_bf16 v[36:39], a[60:63], v[76:79], v[36:39]
  v_mfma_f32_16x16x32_bf16 v[40:43], a[140:143], v[72:75], v[40:43]
  v_mfma_f32_16x16x32_bf16 v[44:47], a[140:143], v[76:79], v[44:47]
  v_mfma_f32_16x16x32_bf16 v[48:51], v[72:75], a[220:223], v[48:51]
  v_mfma_f32_16x16x32_bf16 v[52:55], v[76:79], a[220:223], v[52:55]
  v_mfma_f32_16x16x32_bf16 v[56:59], v[72:75], v[156:159], v[56:59]
  v_mfma_f32_16x16x32_bf16 v[60:63], v[76:79], v[156:159], v[60:63]
  ds_read_b128 v[72:75], v7 offset:18432
  ds_read_b128 v[76:79], v7 offset:38912
  s_waitcnt lgkmcnt(4)
  v_mfma_f32_16x16x32_bf16 v[32:35], a[64:67], v[80:83], v[32:35]
  v_mfma_f32_16x16x32_bf16 v[36:39], a[64:67], v[84:87], v[36:39]
  v_mfma_f32_16x16x32_bf16 v[40:43], a[144:147], v[80:83], v[40:43]
  v_mfma_f32_16x16x32_bf16 v[44:47], a[144:147], v[84:87], v[44:47]
  v_mfma_f32_16x16x32_bf16 v[48:51], v[80:83], a[224:227], v[48:51]
  v_mfma_f32_16x16x32_bf16 v[52:55], v[84:87], a[224:227], v[52:55]
  v_mfma_f32_16x16x32_bf16 v[56:59], v[80:83], v[160:163], v[56:59]
  v_mfma_f32_16x16x32_bf16 v[60:63], v[84:87], v[160:163], v[60:63]
  ds_read_b128 v[80:83], v7 offset:19456
  ds_read_b128 v[84:87], v7 offset:39936
  s_waitcnt lgkmcnt(4)
  v_mfma_f32_16x16x32_bf16 v[32:35], a[68:71], v[88:91], v[32:35]
  v_mfma_f32_16x16x32_bf16 v[36:39], a[68:71], v[92:95], v[36:39]
  v_mfma_f32_16x16x32_bf16 v[40:43], a[148:151], v[88:91], v[40:43]
  v_mfma_f32_16x16x32_bf16 v[44:47], a[148:151], v[92:95], v[44:47]
  v_mfma_f32_16x16x32_bf16 v[48:51], v[88:91], a[228:231], v[48:51]
  v_mfma_f32_16x16x32_bf16 v[52:55], v[92:95], a[228:231], v[52:55]
  v_mfma_f32_16x16x32_bf16 v[56:59], v[88:91], v[164:167], v[56:59]
  v_mfma_f32_16x16x32_bf16 v[60:63], v[92:95], v[164:167], v[60:63]
  s_waitcnt lgkmcnt(2)
  v_mfma_f32_16x16x32_bf16 v[32:35], a[72:75], v[72:75], v[32:35]
  v_mfma_f32_16x16x32_bf16 v[36:39], a[72:75], v[76:79], v[36:39]
  v_mfma_f32_16x16x32_bf16 v[40:43], a[152:155], v[72:75], v[40:43]
  v_mfma_f32_16x16x32_bf16 v[44:47], a[152:155], v[76:79], v[44:47]
  v_mfma_f32_16x16x32_bf16 v[48:51], v[72:75], a[232:235], v[48:51]
  v_mfma_f32_16x16x32_bf16 v[52:55], v[76:79], a[232:235], v[52:55]
  v_mfma_f32_16x16x32_bf16 v[56:59], v[72:75], v[168:171], v[56:59]
  v_mfma_f32_16x16x32_bf16 v[60:63], v[76:79], v[168:171], v[60:63]
  s_waitcnt lgkmcnt(0)
  v_mfma_f32_16x16x32_bf16 v[32:35], a[76:79], v[80:83], v[32:35]
  v_mfma_f32_16x16x32_bf16 v[36:39], a[76:79], v[84:87], v[36:39]
  v_mfma_f32_16x16x32_bf16 v[40:43], a[156:159], v[80:83], v[40:43]
  v_mfma_f32_16x16x32_bf16 v[44:47], a[156:159], v[84:87], v[44:47]
  v_mfma_f32_16x16x32_bf16 v[48:51], v[80:83], a[236:239], v[48:51]
  v_mfma_f32_16x16x32_bf16 v[52:55], v[84:87], a[236:239], v[52:55]
  v_mfma_f32_16x16x32_bf16 v[56:59], v[80:83], v[172:175], v[56:59]
  v_mfma_f32_16x16x32_bf16 v[60:63], v[84:87], v[172:175], v[60:63]
  s_nop 0
  v_cvt_pk_bf16_f32 v8, v32, v33
  v_cvt_pk_bf16_f32 v9, v34, v35
  v_cvt_pk_bf16_f32 v10, v40, v41
  v_cvt_pk_bf16_f32 v11, v42, v43
  s_add_u32 s34, s22, 0
  buffer_store_dwordx4 v[8:11], v1, s[4:7], s34 offen
  v_cvt_pk_bf16_f32 v12, v36, v37
  v_cvt_pk_bf16_f32 v13, v38, v39
  v_cvt_pk_bf16_f32 v14, v44, v45
  v_cvt_pk_bf16_f32 v15, v46, v47
  s_add_u32 s34, s22, 6144
  buffer_store_dwordx4 v[12:15], v1, s[4:7], s34 offen
  v_cvt_pk_bf16_f32 v8, v48, v49
  v_cvt_pk_bf16_f32 v9, v50, v51
  v_cvt_pk_bf16_f32 v10, v52, v53
  v_cvt_pk_bf16_f32 v11, v54, v55
  s_add_u32 s34, s23, 4096
  buffer_store_dwordx4 v[8:11], v1, s[4:7], s34 offen sc1
  v_cvt_pk_bf16_f32 v12, v56, v57
  v_cvt_pk_bf16_f32 v13, v58, v59
  v_cvt_pk_bf16_f32 v14, v60, v61
  v_cvt_pk_bf16_f32 v15, v62, v63
  s_add_u32 s34, s23, 5120
  buffer_store_dwordx4 v[12:15], v1, s[4:7], s34 offen sc1
  s_waitcnt vmcnt(0)
  s_barrier
  s_add_u32 s17, s17, 1
  s_cmp_lt_u32 s17, 64
  s_cbranch_scc1 reca_ptop196
  s_branch reca_exit1
reca_pw3_161:
  s_mov_b32 s17, 0
  s_mov_b32 s26, 0
  s_mul_i32 s20, s17, 40960
  s_add_u32 s20, s20, 153647104
  s_add_u32 m0, s26, 30720
  s_nop 0
  buffer_load_dwordx4 v1, s[4:7], s20 offen offset:0 lds
  buffer_load_dwordx4 v1, s[4:7], s20 offen offset:1024 lds
  buffer_load_dwordx4 v1, s[4:7], s20 offen offset:2048 lds
  buffer_load_dwordx4 v1, s[4:7], s20 offen offset:3072 lds
  s_add_u32 s20, s20, 4096
  s_add_u32 m0, s26, 34816
  s_nop 0
  buffer_load_dwordx4 v1, s[4:7], s20 offen offset:0 lds
  buffer_load_dwordx4 v1, s[4:7], s20 offen offset:1024 lds
  buffer_load_dwordx4 v1, s[4:7], s20 offen offset:2048 lds
  buffer_load_dwordx4 v1, s[4:7], s20 offen offset:3072 lds
  s_add_u32 s20, s20, 4096
  s_add_u32 m0, s26, 38912
  s_nop 0
  buffer_load_dwordx4 v1, s[4:7], s20 offen offset:0 lds
  buffer_load_dwordx4 v1, s[4:7], s20 offen offset:1024 lds
  s_lshl_b32 s34, s15, 6
  s_add_u32 s34, s34, s17
  s_mul_i32 s34, s34, 12288
  s_mul_i32 s35, s16, 3072
  s_add_u32 s35, s35, s34
  s_add_u32 s27, s35, 37748736
  s_mul_i32 s35, s16, 6144
  s_add_u32 s35, s35, s34
  s_add_u32 s28, s35, 62914560
  s_mul_i32 s34, s15, 12
  s_mul_i32 s35, s16, 6
  s_add_u32 s34, s34, s35
  s_add_u32 s34, s34, 2
  s_mul_i32 s34, s34, 20480
  s_add_u32 s34, s34, 6291456
  buffer_load_dwordx4 a[0:3], v1, s[4:7], s34 offen offset:0
  buffer_load_dwordx4 a[4:7], v1, s[4:7], s34 offen offset:1024
  buffer_load_dwordx4 a[8:11], v1, s[4:7], s34 offen offset:2048
  buffer_load_dwordx4 a[12:15], v1, s[4:7], s34 offen offset:3072
  s_add_u32 s34, s34, 4096
  buffer_load_dwordx4 a[16:19], v1, s[4:7], s34 offen offset:0
  buffer_load_dwordx4 a[20:23], v1, s[4:7], s34 offen offset:1024
  buffer_load_dwordx4 a[24:27], v1, s[4:7], s34 offen offset:2048
  buffer_load_dwordx4 a[28:31], v1, s[4:7], s34 offen offset:3072
  s_add_u32 s34, s34, 4096
  buffer_load_dwordx4 a[32:35], v1, s[4:7], s34 offen offset:0
  buffer_load_dwordx4 a[36:39], v1, s[4:7], s34 offen offset:1024
  buffer_load_dwordx4 a[40:43], v1, s[4:7], s34 offen offset:2048
  buffer_load_dwordx4 a[44:47], v1, s[4:7], s34 offen offset:3072
  s_add_u32 s34, s34, 4096
  buffer_load_dwordx4 a[48:51], v1, s[4:7], s34 offen offset:0
  buffer_load_dwordx4 a[52:55], v1, s[4:7], s34 offen offset:1024
  buffer_load_dwordx4 a[56:59], v1, s[4:7], s34 offen offset:2048
  buffer_load_dwordx4 a[60:63], v1, s[4:7], s34 offen offset:3072
  s_add_u32 s34, s34, 4096
  buffer_load_dwordx4 a[64:67], v1, s[4:7], s34 offen offset:0
  buffer_load_dwordx4 a[68:71], v1, s[4:7], s34 offen offset:1024
  buffer_load_dwordx4 a[72:75], v1, s[4:7], s34 offen offset:2048
  buffer_load_dwordx4 a[76:79], v1, s[4:7], s34 offen offset:3072
  s_mul_i32 s34, s15, 12
  s_mul_i32 s35, s16, 6
  s_add_u32 s34, s34, s35
  s_add_u32 s34, s34, 3
  s_mul_i32 s34, s34, 20480
  s_add_u32 s34, s34, 6291456
  buffer_load_dwordx4 a[80:83], v1, s[4:7], s34 offen offset:0
  buffer_load_dwordx4 a[84:87], v1, s[4:7], s34 offen offset:1024
  buffer_load_dwordx4 a[88:91], v1, s[4:7], s34 offen offset:2048
  buffer_load_dwordx4 a[92:95], v1, s[4:7], s34 offen offset:3072
  s_add_u32 s34, s34, 4096
  buffer_load_dwordx4 a[96:99], v1, s[4:7], s34 offen offset:0
  buffer_load_dwordx4 a[100:103], v1, s[4:7], s34 offen offset:1024
  buffer_load_dwordx4 a[104:107], v1, s[4:7], s34 offen offset:2048
  buffer_load_dwordx4 a[108:111], v1, s[4:7], s34 offen offset:3072
  s_add_u32 s34, s34, 4096
  buffer_load_dwordx4 a[112:115], v1, s[4:7], s34 offen offset:0
  buffer_load_dwordx4 a[116:119], v1, s[4:7], s34 offen offset:1024
  buffer_load_dwordx4 a[120:123], v1, s[4:7], s34 offen offset:2048
  buffer_load_dwordx4 a[124:127], v1, s[4:7], s34 offen offset:3072
  s_add_u32 s34, s34, 4096
  buffer_load_dwordx4 a[128:131], v1, s[4:7], s34 offen offset:0
  buffer_load_dwordx4 a[132:135], v1, s[4:7], s34 offen offset:1024
  buffer_load_dwordx4 a[136:139], v1, s[4:7], s34 offen offset:2048
  buffer_load_dwordx4 a[140:143], v1, s[4:7], s34 offen offset:3072
  s_add_u32 s34, s34, 4096
  buffer_load_dwordx4 a[144:147], v1, s[4:7], s34 offen offset:0
  buffer_load_dwordx4 a[148:151], v1, s[4:7], s34 offen offset:1024
  buffer_load_dwordx4 a[152:155], v1, s[4:7], s34 offen offset:2048
  buffer_load_dwordx4 a[156:159], v1, s[4:7], s34 offen offset:3072
  s_waitcnt vmcnt(20)
  s_mul_i32 s34, s15, 12
  s_mul_i32 s35, s16, 6
  s_add_u32 s34, s34, s35
  s_add_u32 s34, s34, 4
  s_mul_i32 s34, s34, 20480
  s_add_u32 s34, s34, 6291456
  buffer_load_dwordx4 a[160:163], v1, s[4:7], s34 offen offset:0
  buffer_load_dwordx4 a[164:167], v1, s[4:7], s34 offen offset:1024
  buffer_load_dwordx4 a[168:171], v1, s[4:7], s34 offen offset:2048
  buffer_load_dwordx4 a[172:175], v1, s[4:7], s34 offen offset:3072
  s_add_u32 s34, s34, 4096
  buffer_load_dwordx4 a[176:179], v1, s[4:7], s34 offen offset:0
  buffer_load_dwordx4 a[180:183], v1, s[4:7], s34 offen offset:1024
  buffer_load_dwordx4 a[184:187], v1, s[4:7], s34 offen offset:2048
  buffer_load_dwordx4 a[188:191], v1, s[4:7], s34 offen offset:3072
  s_add_u32 s34, s34, 4096
  buffer_load_dwordx4 a[192:195], v1, s[4:7], s34 offen offset:0
  buffer_load_dwordx4 a[196:199], v1, s[4:7], s34 offen offset:1024
  buffer_load_dwordx4 a[200:203], v1, s[4:7], s34 offen offset:2048
  buffer_load_dwordx4 a[204:207], v1, s[4:7], s34 offen offset:3072
  s_add_u32 s34, s34, 4096
  buffer_load_dwordx4 a[208:211], v1, s[4:7], s34 offen offset:0
  buffer_load_dwordx4 a[212:215], v1, s[4:7], s34 offen offset:1024
  buffer_load_dwordx4 a[216:219], v1, s[4:7], s34 offen offset:2048
  buffer_load_dwordx4 a[220:223], v1, s[4:7], s34 offen offset:3072
  s_add_u32 s34, s34, 4096
  buffer_load_dwordx4 a[224:227], v1, s[4:7], s34 offen offset:0
  buffer_load_dwordx4 a[228:231], v1, s[4:7], s34 offen offset:1024
  buffer_load_dwordx4 a[232:235], v1, s[4:7], s34 offen offset:2048
  buffer_load_dwordx4 a[236:239], v1, s[4:7], s34 offen offset:3072
  s_waitcnt vmcnt(20)
  s_mul_i32 s34, s15, 12
  s_mul_i32 s35, s16, 6
  s_add_u32 s34, s34, s35
  s_add_u32 s34, s34, 5
  s_mul_i32 s34, s34, 20480
  s_add_u32 s34, s34, 6291456
  buffer_load_dwordx4 v[96:99], v1, s[4:7], s34 offen offset:0
  buffer_load_dwordx4 v[100:103], v1, s[4:7], s34 offen offset:1024
  buffer_load_dwordx4 v[104:107], v1, s[4:7], s34 offen offset:2048
  buffer_load_dwordx4 v[108:111], v1, s[4:7], s34 offen offset:3072
  s_add_u32 s34, s34, 4096
  buffer_load_dwordx4 v[112:115], v1, s[4:7], s34 offen offset:0
  buffer_load_dwordx4 v[116:119], v1, s[4:7], s34 offen offset:1024
  buffer_load_dwordx4 v[120:123], v1, s[4:7], s34 offen offset:2048
  buffer_load_dwordx4 v[124:127], v1, s[4:7], s34 offen offset:3072
  s_add_u32 s34, s34, 4096
  buffer_load_dwordx4 v[128:131], v1, s[4:7], s34 offen offset:0
  buffer_load_dwordx4 v[132:135], v1, s[4:7], s34 offen offset:1024
  buffer_load_dwordx4 v[136:139], v1, s[4:7], s34 offen offset:2048
  buffer_load_dwordx4 v[140:143], v1, s[4:7], s34 offen offset:3072
  s_add_u32 s34, s34, 4096
  buffer_load_dwordx4 v[144:147], v1, s[4:7], s34 offen offset:0
  buffer_load_dwordx4 v[148:151], v1, s[4:7], s34 offen offset:1024
  buffer_load_dwordx4 v[152:155], v1, s[4:7], s34 offen offset:2048
  buffer_load_dwordx4 v[156:159], v1, s[4:7], s34 offen offset:3072
  s_add_u32 s34, s34, 4096
  buffer_load_dwordx4 v[160:163], v1, s[4:7], s34 offen offset:0
  buffer_load_dwordx4 v[164:167], v1, s[4:7], s34 offen offset:1024
  buffer_load_dwordx4 v[168:171], v1, s[4:7], s34 offen offset:2048
  buffer_load_dwordx4 v[172:175], v1, s[4:7], s34 offen offset:3072
  s_waitcnt vmcnt(20)
  v_and_b32 v30, 7, v0
  v_lshlrev_b32 v30, 3, v30
reca_cens201:
  buffer_load_dwordx2 v[28:29], v30, s[8:11], 0 offen sc1
  s_waitcnt vmcnt(0)
  v_sad_u8 v31, v28, 0, 0
  v_sad_u8 v31, v29, 0, v31
  v_cmp_gt_u32 vcc, 32, v31
  s_cbranch_vccz reca_censok202
  s_sleep 8
  s_sub_u32 s18, s18, 1
  s_cbranch_scc0 reca_cens201
  s_mov_b32 s18, 0
reca_censok202:
  v_and_b32 v28, 0x20202020, v28
  v_and_b32 v29, 0x20202020, v29
  v_cmp_ne_u32 s[34:35], 0, v28
  v_cmp_ne_u32 s[36:37], 0, v29
  s_nop 3
  s_and_b32 s34, s34, 0xff
  s_and_b32 s36, s36, 0xff
  s_or_b32 s35, s34, s36
  s_lshr_b32 s37, s35, s13
  s_and_b32 s37, s37, 1
  s_xor_b32 s43, s37, 1
  s_cmp_eq_u32 s57, 0
  s_cselect_b32 s58, s36, s34
  v_mov_b32 v31, 0x80000000
  s_cmp_lg_u32 s43, 0
  s_cbranch_scc1 reca_pslow203
reca_ptop204:
  s_cmp_lt_u32 s17, 6
  s_cbranch_scc1 reca_pgo205
  s_sub_u32 s36, s17, 6
reca_ppoll206:
  buffer_load_dword v28, v4, s[4:7], s25 offen sc1
  s_waitcnt vmcnt(0)
  v_readfirstlane_b32 s34, v28
  s_nop 3
  s_cmp_ge_i32 s34, s36
  s_cbranch_scc1 reca_pgo205
  s_sleep 8
  s_sub_u32 s18, s18, 1
  s_cbranch_scc0 reca_ppoll206
  s_mov_b32 s18, 0
reca_pgo205:
  s_waitcnt vmcnt(0)
  s_barrier
  v_add_u32 v7, s26, v1
  s_xor_b32 s26, s26, 40960
  s_add_u32 s37, s17, 1
  s_cmp_ge_u32 s37, 64
  s_cbranch_scc1 reca_pnodma207
  s_mul_i32 s20, s37, 40960
  s_add_u32 s20, s20, 153647104
  s_add_u32 m0, s26, 30720
  s_nop 0
  buffer_load_dwordx4 v1, s[4:7], s20 offen offset:0 lds
  buffer_load_dwordx4 v1, s[4:7], s20 offen offset:1024 lds
  buffer_load_dwordx4 v1, s[4:7], s20 offen offset:2048 lds
  buffer_load_dwordx4 v1, s[4:7], s20 offen offset:3072 lds
  s_add_u32 s20, s20, 4096
  s_add_u32 m0, s26, 34816
  s_nop 0
  buffer_load_dwordx4 v1, s[4:7], s20 offen offset:0 lds
  buffer_load_dwordx4 v1, s[4:7], s20 offen offset:1024 lds
  buffer_load_dwordx4 v1, s[4:7], s20 offen offset:2048 lds
  buffer_load_dwordx4 v1, s[4:7], s20 offen offset:3072 lds
  s_add_u32 s20, s20, 4096
  s_add_u32 m0, s26, 38912
  s_nop 0
  buffer_load_dwordx4 v1, s[4:7], s20 offen offset:0 lds
  buffer_load_dwordx4 v1, s[4:7], s20 offen offset:1024 lds
  s_lshl_b32 s34, s15, 6
  s_add_u32 s34, s34, s37
  s_mul_i32 s34, s34, 12288
  s_mul_i32 s35, s16, 3072
  s_add_u32 s35, s35, s34
  s_add_u32 s27, s35, 37748736
  s_mul_i32 s35, s16, 6144
  s_add_u32 s35, s35, s34
  s_add_u32 s28, s35, 62914560
reca_pnodma207:
  s_lshl_b32 s34, s15, 6
  s_add_u32 s34, s34, s17
  s_mul_i32 s34, s34, 12288
  s_mul_i32 s35, s16, 3072
  s_add_u32 s35, s35, s34
  s_add_u32 s21, s35, 37748736
  s_add_u32 s22, s35, 88080384
  s_mul_i32 s35, s16, 6144
  s_add_u32 s35, s35, s34
  s_add_u32 s23, s35, 62914560
  ds_read_b128 v[72:75], v7 offset:0
  ds_read_b128 v[76:79], v7 offset:20480
  ds_read_b128 v[80:83], v7 offset:1024
  ds_read_b128 v[84:87], v7 offset:21504
  ds_read_b128 v[88:91], v7 offset:2048
  ds_read_b128 v[92:95], v7 offset:22528
  s_waitcnt lgkmcnt(4)
  v_mfma_f32_16x16x32_bf16 v[32:35], a[0:3], v[72:75], 0
  v_mfma_f32_16x16x32_bf16 v[36:39], a[0:3], v[76:79], 0
  v_mfma_f32_16x16x32_bf16 v[40:43], a[80:83], v[72:75], 0
  v_mfma_f32_16x16x32_bf16 v[44:47], a[80:83], v[76:79], 0
  v_mfma_f32_16x16x32_bf16 v[48:51], a[160:163], v[72:75], 0
  v_mfma_f32_16x16x32_bf16 v[52:55], a[160:163], v[76:79], 0
  v_mfma_f32_16x16x32_bf16 v[56:59], v[96:99], v[72:75], 0
  v_mfma_f32_16x16x32_bf16 v[60:63], v[96:99], v[76:79], 0
  ds_read_b128 v[72:75], v7 offset:3072
  ds_read_b128 v[76:79], v7 offset:23552
  s_waitcnt lgkmcnt(4)
  v_mfma_f32_16x16x32_bf16 v[32:35], a[4:7], v[80:83], v[32:35]
  v_mfma_f32_16x16x32_bf16 v[36:39], a[4:7], v[84:87], v[36:39]
  v_mfma_f32_16x16x32_bf16 v[40:43], a[84:87], v[80:83], v[40:43]
  v_mfma_f32_16x16x32_bf16 v[44:47], a[84:87], v[84:87], v[44:47]
  v_mfma_f32_16x16x32_bf16 v[48:51], a[164:167], v[80:83], v[48:51]
  v_mfma_f32_16x16x32_bf16 v[52:55], a[164:167], v[84:87], v[52:55]
  v_mfma_f32_16x16x32_bf16 v[56:59], v[100:103], v[80:83], v[56:59]
  v_mfma_f32_16x16x32_bf16 v[60:63], v[100:103], v[84:87], v[60:63]
  ds_read_b128 v[80:83], v7 offset:4096
  ds_read_b128 v[84:87], v7 offset:24576
  s_waitcnt lgkmcnt(4)
  v_mfma_f32_16x16x32_bf16 v[32:35], a[8:11], v[88:91], v[32:35]
  v_mfma_f32_16x16x32_bf16 v[36:39], a[8:11], v[92:95], v[36:39]
  v_mfma_f32_16x16x32_bf16 v[40:43], a[88:91], v[88:91], v[40:43]
  v_mfma_f32_16x16x32_bf16 v[44:47], a[88:91], v[92:95], v[44:47]
  v_mfma_f32_16x16x32_bf16 v[48:51], a[168:171], v[88:91], v[48:51]
  v_mfma_f32_16x16x32_bf16 v[52:55], a[168:171], v[92:95], v[52:55]
  v_mfma_f32_16x16x32_bf16 v[56:59], v[104:107], v[88:91], v[56:59]
  v_mfma_f32_16x16x32_bf16 v[60:63], v[104:107], v[92:95], v[60:63]
  ds_read_b128 v[88:91], v7 offset:5120
  ds_read_b128 v[92:95], v7 offset:25600
  s_waitcnt lgkmcnt(4)
  v_mfma_f32_16x16x32_bf16 v[32:35], a[12:15], v[72:75], v[32:35]
  v_mfma_f32_16x16x32_bf16 v[36:39], a[12:15], v[76:79], v[36:39]
  v_mfma_f32_16x16x32_bf16 v[40:43], a[92:95], v[72:75], v[40:43]
  v_mfma_f32_16x16x32_bf16 v[44:47], a[92:95], v[76:79], v[44:47]
  v_mfma_f32_16x16x32_bf16 v[48:51], a[172:175], v[72:75], v[48:51]
  v_mfma_f32_16x16x32_bf16 v[52:55], a[172:175], v[76:79], v[52:55]
  v_mfma_f32_16x16x32_bf16 v[56:59], v[108:111], v[72:75], v[56:59]
  v_mfma_f32_16x16x32_bf16 v[60:63], v[108:111], v[76:79], v[60:63]
  ds_read_b128 v[72:75], v7 offset:6144
  ds_read_b128 v[76:79], v7 offset:26624
  s_waitcnt lgkmcnt(4)
  v_mfma_f32_16x16x32_bf16 v[32:35], a[16:19], v[80:83], v[32:35]
  v_mfma_f32_16x16x32_bf16 v[36:39], a[16:19], v[84:87], v[36:39]
  v_mfma_f32_16x16x32_bf16 v[40:43], a[96:99], v[80:83], v[40:43]
  v_mfma_f32_16x16x32_bf16 v[44:47], a[96:99], v[84:87], v[44:47]
  v_mfma_f32_16x16x32_bf16 v[48:51], a[176:179], v[80:83], v[48:51]
  v_mfma_f32_16x16x32_bf16 v[52:55], a[176:179], v[84:87], v[52:55]
  v_mfma_f32_16x16x32_bf16 v[56:59], v[112:115], v[80:83], v[56:59]
  v_mfma_f32_16x16x32_bf16 v[60:63], v[112:115], v[84:87], v[60:63]
  ds_read_b128 v[80:83], v7 offset:7168
  ds_read_b128 v[84:87], v7 offset:27648
  s_waitcnt lgkmcnt(4)
  v_mfma_f32_16x16x32_bf16 v[32:35], a[20:23], v[88:91], v[32:35]
  v_mfma_f32_16x16x32_bf16 v[36:39], a[20:23], v[92:95], v[36:39]
  v_mfma_f32_16x16x32_bf16 v[40:43], a[100:103], v[88:91], v[40:43]
  v_mfma_f32_16x16x32_bf16 v[44:47], a[100:103], v[92:95], v[44:47]
  v_mfma_f32_16x16x32_bf16 v[48:51], a[180:183], v[88:91], v[48:51]
  v_mfma_f32_16x16x32_bf16 v[52:55], a[180:183], v[92:95], v[52:55]
  v_mfma_f32_16x16x32_bf16 v[56:59], v[116:119], v[88:91], v[56:59]
  v_mfma_f32_16x16x32_bf16 v[60:63], v[116:119], v[92:95], v[60:63]
  ds_read_b128 v[88:91], v7 offset:8192
  ds_read_b128 v[92:95], v7 offset:28672
  s_waitcnt lgkmcnt(4)
  v_mfma_f32_16x16x32_bf16 v[32:35], a[24:27], v[72:75], v[32:35]
  v_mfma_f32_16x16x32_bf16 v[36:39], a[24:27], v[76:79], v[36:39]
  v_mfma_f32_16x16x32_bf16 v[40:43], a[104:107], v[72:75], v[40:43]
  v_mfma_f32_16x16x32_bf16 v[44:47], a[104:107], v[76:79], v[44:47]
  v_mfma_f32_16x16x32_bf16 v[48:51], a[184:187], v[72:75], v[48:51]
  v_mfma_f32_16x16x32_bf16 v[52:55], a[184:187], v[76:79], v[52:55]
  v_mfma_f32_16x16x32_bf16 v[56:59], v[120:123], v[72:75], v[56:59]
  v_mfma_f32_16x16x32_bf16 v[60:63], v[120:123], v[76:79], v[60:63]
  ds_read_b128 v[72:75], v7 offset:9216
  ds_read_b128 v[76:79], v7 offset:29696
  s_waitcnt lgkmcnt(4)
  v_mfma_f32_16x16x32_bf16 v[32:35], a[28:31], v[80:83], v[32:35]
  v_mfma_f32_16x16x32_bf16 v[36:39], a[28:31], v[84:87], v[36:39]
  v_mfma_f32_16x16x32_bf16 v[40:43], a[108:111], v[80:83], v[40:43]
  v_mfma_f32_16x16x32_bf16 v[44:47], a[108:111], v[84:87], v[44:47]
  v_mfma_f32_16x16x32_bf16 v[48:51], a[188:191], v[80:83], v[48:51]
  v_mfma_f32_16x16x32_bf16 v[52:55], a[188:191], v[84:87], v[52:55]
  v_mfma_f32_16x16x32_bf16 v[56:59], v[124:127], v[80:83], v[56:59]
  v_mfma_f32_16x16x32_bf16 v[60:63], v[124:127], v[84:87], v[60:63]
  ds_read_b128 v[80:83], v7 offset:10240
  ds_read_b128 v[84:87], v7 offset:30720
  s_waitcnt lgkmcnt(4)
  v_mfma_f32_16x16x32_bf16 v[32:35], a[32:35], v[88:91], v[32:35]
  v_mfma_f32_16x16x32_bf16 v[36:39], a[32:35], v[92:95], v[36:39]
  v_mfma_f32_16x16x32_bf16 v[40:43], a[112:115], v[88:91], v[40:43]
  v_mfma_f32_16x16x32_bf16 v[44:47], a[112:115], v[92:95], v[44:47]
  v_mfma_f32_16x16x32_bf16 v[48:51], a[192:195], v[88:91], v[48:51]
  v_mfma_f32_16x16x32_bf16 v[52:55], a[192:195], v[92:95], v[52:55]
  v_mfma_f32_16x16x32_bf16 v[56:59], v[128:131], v[88:91], v[56:59]
  v_mfma_f32_16x16x32_bf16 v[60:63], v[128:131], v[92:95], v[60:63]
  ds_read_b128 v[88:91], v7 offset:11264
  ds_read_b128 v[92:95], v7 offset:31744
  s_waitcnt lgkmcnt(4)
  v_mfma_f32_16x16x32_bf16 v[32:35], a[36:39], v[72:75], v[32:35]
  v_mfma_f32_16x16x32_bf16 v[36:39], a[36:39], v[76:79], v[36:39]
  v_mfma_f32_16x16x32_bf16 v[40:43], a[116:119], v[72:75], v[40:43]
  v_mfma_f32_16x16x32_bf16 v[44:47], a[116:119], v[76:79], v[44:47]
  v_mfma_f32_16x16x32_bf16 v[48:51], a[196:199], v[72:75], v[48:51]
  v_mfma_f32_16x16x32_bf16 v[52:55], a[196:199], v[76:79], v[52:55]
  v_mfma_f32_16x16x32_bf16 v[56:59], v[132:135], v[72:75], v[56:59]
  v_mfma_f32_16x16x32_bf16 v[60:63], v[132:135], v[76:79], v[60:63]
  ds_read_b128 v[72:75], v7 offset:12288
  ds_read_b128 v[76:79], v7 offset:32768
  s_waitcnt lgkmcnt(4)
  v_mfma_f32_16x16x32_bf16 v[32:35], a[40:43], v[80:83], v[32:35]
  v_mfma_f32_16x16x32_bf16 v[36:39], a[40:43], v[84:87], v[36:39]
  v_mfma_f32_16x16x32_bf16 v[40:43], a[120:123], v[80:83], v[40:43]
  v_mfma_f32_16x16x32_bf16 v[44:47], a[120:123], v[84:87], v[44:47]
  v_mfma_f32_16x16x32_bf16 v[48:51], a[200:203], v[80:83], v[48:51]
  v_mfma_f32_16x16x32_bf16 v[52:55], a[200:203], v[84:87], v[52:55]
  v_mfma_f32_16x16x32_bf16 v[56:59], v[136:139], v[80:83], v[56:59]
  v_mfma_f32_16x16x32_bf16 v[60:63], v[136:139], v[84:87], v[60:63]
  ds_read_b128 v[80:83], v7 offset:13312
  ds_read_b128 v[84:87], v7 offset:33792
  s_waitcnt lgkmcnt(4)
  v_mfma_f32_16x16x32_bf16 v[32:35], a[44:47], v[88:91], v[32:35]
  v_mfma_f32_16x16x32_bf16 v[36:39], a[44:47], v[92:95], v[36:39]
  v_mfma_f32_16x16x32_bf16 v[40:43], a[124:127], v[88:91], v[40:43]
  v_mfma_f32_16x16x32_bf16 v[44:47], a[124:127], v[92:95], v[44:47]
  v_mfma_f32_16x16x32_bf16 v[48:51], a[204:207], v[88:91], v[48:51]
  v_mfma_f32_16x16x32_bf16 v[52:55], a[204:207], v[92:95], v[52:55]
  v_mfma_f32_16x16x32_bf16 v[56:59], v[140:143], v[88:91], v[56:59]
  v_mfma_f32_16x16x32_bf16 v[60:63], v[140:143], v[92:95], v[60:63]
  ds_read_b128 v[88:91], v7 offset:14336
  ds_read_b128 v[92:95], v7 offset:34816
  s_waitcnt lgkmcnt(4)
  v_mfma_f32_16x16x32_bf16 v[32:35], a[48:51], v[72:75], v[32:35]
  v_mfma_f32_16x16x32_bf16 v[36:39], a[48:51], v[76:79], v[36:39]
  v_mfma_f32_16x16x32_bf16 v[40:43], a[128:131], v[72:75], v[40:43]
  v_mfma_f32_16x16x32_bf16 v[44:47], a[128:131], v[76:79], v[44:47]
  v_mfma_f32_16x16x32_bf16 v[48:51], a[208:211], v[72:75], v[48:51]
  v_mfma_f32_16x16x32_bf16 v[52:55], a[208:211], v[76:79], v[52:55]
  v_mfma_f32_16x16x32_bf16 v[56:59], v[144:147], v[72:75], v[56:59]
  v_mfma_f32_16x16x32_bf16 v[60:63], v[144:147], v[76:79], v[60:63]
  ds_read_b128 v[72:75], v7 offset:15360
  ds_read_b128 v[76:79], v7 offset:35840
  s_waitcnt lgkmcnt(4)
  v_mfma_f32_16x16x32_bf16 v[32:35], a[52:55], v[80:83], v[32:35]
  v_mfma_f32_16x16x32_bf16 v[36:39], a[52:55], v[84:87], v[36:39]
  v_mfma_f32_16x16x32_bf16 v[40:43], a[132:135], v[80:83], v[40:43]
  v_mfma_f32_16x16x32_bf16 v[44:47], a[132:135], v[84:87], v[44:47]
  v_mfma_f32_16x16x32_bf16 v[48:51], a[212:215], v[80:83], v[48:51]
  v_mfma_f32_16x16x32_bf16 v[52:55], a[212:215], v[84:87], v[52:55]
  v_mfma_f32_16x16x32_bf16 v[56:59], v[148:151], v[80:83], v[56:59]
  v_mfma_f32_16x16x32_bf16 v[60:63], v[148:151], v[84:87], v[60:63]
  ds_read_b128 v[80:83], v7 offset:16384
  ds_read_b128 v[84:87], v7 offset:36864
  s_waitcnt lgkmcnt(4)
  v_mfma_f32_16x16x32_bf16 v[32:35], a[56:59], v[88:91], v[32:35]
  v_mfma_f32_16x16x32_bf16 v[36:39], a[56:59], v[92:95], v[36:39]
  v_mfma_f32_16x16x32_bf16 v[40:43], a[136:139], v[88:91], v[40:43]
  v_mfma_f32_16x16x32_bf16 v[44:47], a[136:139], v[92:95], v[44:47]
  v_mfma_f32_16x16x32_bf16 v[48:51], a[216:219], v[88:91], v[48:51]
  v_mfma_f32_16x16x32_bf16 v[52:55], a[216:219], v[92:95], v[52:55]
  v_mfma_f32_16x16x32_bf16 v[56:59], v[152:155], v[88:91], v[56:59]
  v_mfma_f32_16x16x32_bf16 v[60:63], v[152:155], v[92:95], v[60:63]
  ds_read_b128 v[88:91], v7 offset:17408
  ds_read_b128 v[92:95], v7 offset:37888
  s_waitcnt lgkmcnt(4)
  v_mfma_f32_16x16x32_bf16 v[32:35], a[60:63], v[72:75], v[32:35]
  v_mfma_f32_16x16x32_bf16 v[36:39], a[60:63], v[76:79], v[36:39]
  v_mfma_f32_16x16x32_bf16 v[40:43], a[140:143], v[72:75], v[40:43]
  v_mfma_f32_16x16x32_bf16 v[44:47], a[140:143], v[76:79], v[44:47]
  v_mfma_f32_16x16x32_bf16 v[48:51], a[220:223], v[72:75], v[48:51]
  v_mfma_f32_16x16x32_bf16 v[52:55], a[220:223], v[76:79], v[52:55]
  v_mfma_f32_16x16x32_bf16 v[56:59], v[156:159], v[72:75], v[56:59]
  v_mfma_f32_16x16x32_bf16 v[60:63], v[156:159], v[76:79], v[60:63]
  ds_read_b128 v[72:75], v7 offset:18432
  ds_read_b128 v[76:79], v7 offset:38912
  s_waitcnt lgkmcnt(4)
  v_mfma_f32_16x16x32_bf16 v[32:35], a[64:67], v[80:83], v[32:35]
  v_mfma_f32_16x16x32_bf16 v[36:39], a[64:67], v[84:87], v[36:39]
  v_mfma_f32_16x16x32_bf16 v[40:43], a[144:147], v[80:83], v[40:43]
  v_mfma_f32_16x16x32_bf16 v[44:47], a[144:147], v[84:87], v[44:47]
  v_mfma_f32_16x16x32_bf16 v[48:51], a[224:227], v[80:83], v[48:51]
  v_mfma_f32_16x16x32_bf16 v[52:55], a[224:227], v[84:87], v[52:55]
  v_mfma_f32_16x16x32_bf16 v[56:59], v[160:163], v[80:83], v[56:59]
  v_mfma_f32_16x16x32_bf16 v[60:63], v[160:163], v[84:87], v[60:63]
  ds_read_b128 v[80:83], v7 offset:19456
  ds_read_b128 v[84:87], v7 offset:39936
  s_waitcnt lgkmcnt(4)
  v_mfma_f32_16x16x32_bf16 v[32:35], a[68:71], v[88:91], v[32:35]
  v_mfma_f32_16x16x32_bf16 v[36:39], a[68:71], v[92:95], v[36:39]
  v_mfma_f32_16x16x32_bf16 v[40:43], a[148:151], v[88:91], v[40:43]
  v_mfma_f32_16x16x32_bf16 v[44:47], a[148:151], v[92:95], v[44:47]
  v_mfma_f32_16x16x32_bf16 v[48:51], a[228:231], v[88:91], v[48:51]
  v_mfma_f32_16x16x32_bf16 v[52:55], a[228:231], v[92:95], v[52:55]
  v_mfma_f32_16x16x32_bf16 v[56:59], v[164:167], v[88:91], v[56:59]
  v_mfma_f32_16x16x32_bf16 v[60:63], v[164:167], v[92:95], v[60:63]
  s_waitcnt lgkmcnt(2)
  v_mfma_f32_16x16x32_bf16 v[32:35], a[72:75], v[72:75], v[32:35]
  v_mfma_f32_16x16x32_bf16 v[36:39], a[72:75], v[76:79], v[36:39]
  v_mfma_f32_16x16x32_bf16 v[40:43], a[152:155], v[72:75], v[40:43]
  v_mfma_f32_16x16x32_bf16 v[44:47], a[152:155], v[76:79], v[44:47]
  v_mfma_f32_16x16x32_bf16 v[48:51], a[232:235], v[72:75], v[48:51]
  v_mfma_f32_16x16x32_bf16 v[52:55], a[232:235], v[76:79], v[52:55]
  v_mfma_f32_16x16x32_bf16 v[56:59], v[168:171], v[72:75], v[56:59]
  v_mfma_f32_16x16x32_bf16 v[60:63], v[168:171], v[76:79], v[60:63]
  s_waitcnt lgkmcnt(0)
  v_mfma_f32_16x16x32_bf16 v[32:35], a[76:79], v[80:83], v[32:35]
  v_mfma_f32_16x16x32_bf16 v[36:39], a[76:79], v[84:87], v[36:39]
  v_mfma_f32_16x16x32_bf16 v[40:43], a[156:159], v[80:83], v[40:43]
  v_mfma_f32_16x16x32_bf16 v[44:47], a[156:159], v[84:87], v[44:47]
  v_mfma_f32_16x16x32_bf16 v[48:51], a[236:239], v[80:83], v[48:51]
  v_mfma_f32_16x16x32_bf16 v[52:55], a[236:239], v[84:87], v[52:55]
  v_mfma_f32_16x16x32_bf16 v[56:59], v[172:175], v[80:83], v[56:59]
  v_mfma_f32_16x16x32_bf16 v[60:63], v[172:175], v[84:87], v[60:63]
  s_nop 0
  v_cvt_pk_bf16_f32 v8, v32, v33
  v_cvt_pk_bf16_f32 v9, v34, v35
  v_cvt_pk_bf16_f32 v10, v40, v41
  v_cvt_pk_bf16_f32 v11, v42, v43
  s_add_u32 s34, s22, 1024
  buffer_store_dwordx4 v[8:11], v1, s[4:7], s34 offen
  v_cvt_pk_bf16_f32 v12, v36, v37
  v_cvt_pk_bf16_f32 v13, v38, v39
  v_cvt_pk_bf16_f32 v14, v44, v45
  v_cvt_pk_bf16_f32 v15, v46, v47
  s_add_u32 s34, s22, 7168
  buffer_store_dwordx4 v[12:15], v1, s[4:7], s34 offen
  v_cvt_pk_bf16_f32 v8, v48, v49
  v_cvt_pk_bf16_f32 v9, v50, v51
  v_cvt_pk_bf16_f32 v10, v56, v57
  v_cvt_pk_bf16_f32 v11, v58, v59
  s_add_u32 s34, s22, 2048
  buffer_store_dwordx4 v[8:11], v1, s[4:7], s34 offen
  v_cvt_pk_bf16_f32 v12, v52, v53
  v_cvt_pk_bf16_f32 v13, v54, v55
  v_cvt_pk_bf16_f32 v14, v60, v61
  v_cvt_pk_bf16_f32 v15, v62, v63
  s_add_u32 s34, s22, 8192
  buffer_store_dwordx4 v[12:15], v1, s[4:7], s34 offen
  s_waitcnt vmcnt(0)
  s_barrier
  s_add_u32 s17, s17, 1
  s_cmp_lt_u32 s17, 64
  s_cbranch_scc1 reca_ptop204
  s_branch reca_exit1
reca_pslow203:
reca_ptop209:
  s_cmp_lt_u32 s17, 6
  s_cbranch_scc1 reca_pgo210
  s_sub_u32 s36, s17, 6
reca_ppoll211:
  buffer_load_dword v28, v4, s[4:7], s25 offen sc1
  s_waitcnt vmcnt(0)
  v_readfirstlane_b32 s34, v28
  s_nop 3
  s_cmp_ge_i32 s34, s36
  s_cbranch_scc1 reca_pgo210
  s_sleep 8
  s_sub_u32 s18, s18, 1
  s_cbranch_scc0 reca_ppoll211
  s_mov_b32 s18, 0
reca_pgo210:
  s_waitcnt vmcnt(0)
  s_barrier
  v_add_u32 v7, s26, v1
  s_xor_b32 s26, s26, 40960
  s_add_u32 s37, s17, 1
  s_cmp_ge_u32 s37, 64
  s_cbranch_scc1 reca_pnodma212
  s_mul_i32 s20, s37, 40960
  s_add_u32 s20, s20, 153647104
  s_add_u32 m0, s26, 30720
  s_nop 0
  buffer_load_dwordx4 v1, s[4:7], s20 offen offset:0 lds
  buffer_load_dwordx4 v1, s[4:7], s20 offen offset:1024 lds
  buffer_load_dwordx4 v1, s[4:7], s20 offen offset:2048 lds
  buffer_load_dwordx4 v1, s[4:7], s20 offen offset:3072 lds
  s_add_u32 s20, s20, 4096
  s_add_u32 m0, s26, 34816
  s_nop 0
  buffer_load_dwordx4 v1, s[4:7], s20 offen offset:0 lds
  buffer_load_dwordx4 v1, s[4:7], s20 offen offset:1024 lds
  buffer_load_dwordx4 v1, s[4:7], s20 offen offset:2048 lds
  buffer_load_dwordx4 v1, s[4:7], s20 offen offset:3072 lds
  s_add_u32 s20, s20, 4096
  s_add_u32 m0, s26, 38912
  s_nop 0
  buffer_load_dwordx4 v1, s[4:7], s20 offen offset:0 lds
  buffer_load_dwordx4 v1, s[4:7], s20 offen offset:1024 lds
  s_lshl_b32 s34, s15, 6
  s_add_u32 s34, s34, s37
  s_mul_i32 s34, s34, 12288
  s_mul_i32 s35, s16, 3072
  s_add_u32 s35, s35, s34
  s_add_u32 s27, s35, 37748736
  s_mul_i32 s35, s16, 6144
  s_add_u32 s35, s35, s34
  s_add_u32 s28, s35, 62914560
reca_pnodma212:
  s_lshl_b32 s34, s15, 6
  s_add_u32 s34, s34, s17
  s_mul_i32 s34, s34, 12288
  s_mul_i32 s35, s16, 3072
  s_add_u32 s35, s35, s34
  s_add_u32 s21, s35, 37748736
  s_add_u32 s22, s35, 88080384
  s_mul_i32 s35, s16, 6144
  s_add_u32 s35, s35, s34
  s_add_u32 s23, s35, 62914560
  ds_read_b128 v[72:75], v7 offset:0
  ds_read_b128 v[76:79], v7 offset:20480
  ds_read_b128 v[80:83], v7 offset:1024
  ds_read_b128 v[84:87], v7 offset:21504
  ds_read_b128 v[88:91], v7 offset:2048
  ds_read_b128 v[92:95], v7 offset:22528
  s_waitcnt lgkmcnt(4)
  v_mfma_f32_16x16x32_bf16 v[32:35], a[0:3], v[72:75], 0
  v_mfma_f32_16x16x32_bf16 v[36:39], a[0:3], v[76:79], 0
  v_mfma_f32_16x16x32_bf16 v[40:43], a[80:83], v[72:75], 0
  v_mfma_f32_16x16x32_bf16 v[44:47], a[80:83], v[76:79], 0
  v_mfma_f32_16x16x32_bf16 v[48:51], a[160:163], v[72:75], 0
  v_mfma_f32_16x16x32_bf16 v[52:55], a[160:163], v[76:79], 0
  v_mfma_f32_16x16x32_bf16 v[56:59], v[96:99], v[72:75], 0
  v_mfma_f32_16x16x32_bf16 v[60:63], v[96:99], v[76:79], 0
  ds_read_b128 v[72:75], v7 offset:3072
  ds_read_b128 v[76:79], v7 offset:23552
  s_waitcnt lgkmcnt(4)
  v_mfma_f32_16x16x32_bf16 v[32:35], a[4:7], v[80:83], v[32:35]
  v_mfma_f32_16x16x32_bf16 v[36:39], a[4:7], v[84:87], v[36:39]
  v_mfma_f32_16x16x32_bf16 v[40:43], a[84:87], v[80:83], v[40:43]
  v_mfma_f32_16x16x32_bf16 v[44:47], a[84:87], v[84:87], v[44:47]
  v_mfma_f32_16x16x32_bf16 v[48:51], a[164:167], v[80:83], v[48:51]
  v_mfma_f32_16x16x32_bf16 v[52:55], a[164:167], v[84:87], v[52:55]
  v_mfma_f32_16x16x32_bf16 v[56:59], v[100:103], v[80:83], v[56:59]
  v_mfma_f32_16x16x32_bf16 v[60:63], v[100:103], v[84:87], v[60:63]
  ds_read_b128 v[80:83], v7 offset:4096
  ds_read_b128 v[84:87], v7 offset:24576
  s_waitcnt lgkmcnt(4)
  v_mfma_f32_16x16x32_bf16 v[32:35], a[8:11], v[88:91], v[32:35]
  v_mfma_f32_16x16x32_bf16 v[36:39], a[8:11], v[92:95], v[36:39]
  v_mfma_f32_16x16x32_bf16 v[40:43], a[88:91], v[88:91], v[40:43]
  v_mfma_f32_16x16x32_bf16 v[44:47], a[88:91], v[92:95], v[44:47]
  v_mfma_f32_16x16x32_bf16 v[48:51], a[168:171], v[88:91], v[48:51]
  v_mfma_f32_16x16x32_bf16 v[52:55], a[168:171], v[92:95], v[52:55]
  v_mfma_f32_16x16x32_bf16 v[56:59], v[104:107], v[88:91], v[56:59]
  v_mfma_f32_16x16x32_bf16 v[60:63], v[104:107], v[92:95], v[60:63]
  ds_read_b128 v[88:91], v7 offset:5120
  ds_read_b128 v[92:95], v7 offset:25600
  s_waitcnt lgkmcnt(4)
  v_mfma_f32_16x16x32_bf16 v[32:35], a[12:15], v[72:75], v[32:35]
  v_mfma_f32_16x16x32_bf16 v[36:39], a[12:15], v[76:79], v[36:39]
  v_mfma_f32_16x16x32_bf16 v[40:43], a[92:95], v[72:75], v[40:43]
  v_mfma_f32_16x16x32_bf16 v[44:47], a[92:95], v[76:79], v[44:47]
  v_mfma_f32_16x16x32_bf16 v[48:51], a[172:175], v[72:75], v[48:51]
  v_mfma_f32_16x16x32_bf16 v[52:55], a[172:175], v[76:79], v[52:55]
  v_mfma_f32_16x16x32_bf16 v[56:59], v[108:111], v[72:75], v[56:59]
  v_mfma_f32_16x16x32_bf16 v[60:63], v[108:111], v[76:79], v[60:63]
  ds_read_b128 v[72:75], v7 offset:6144
  ds_read_b128 v[76:79], v7 offset:26624
  s_waitcnt lgkmcnt(4)
  v_mfma_f32_16x16x32_bf16 v[32:35], a[16:19], v[80:83], v[32:35]
  v_mfma_f32_16x16x32_bf16 v[36:39], a[16:19], v[84:87], v[36:39]
  v_mfma_f32_16x16x32_bf16 v[40:43], a[96:99], v[80:83], v[40:43]
  v_mfma_f32_16x16x32_bf16 v[44:47], a[96:99], v[84:87], v[44:47]
  v_mfma_f32_16x16x32_bf16 v[48:51], a[176:179], v[80:83], v[48:51]
  v_mfma_f32_16x16x32_bf16 v[52:55], a[176:179], v[84:87], v[52:55]
  v_mfma_f32_16x16x32_bf16 v[56:59], v[112:115], v[80:83], v[56:59]
  v_mfma_f32_16x16x32_bf16 v[60:63], v[112:115], v[84:87], v[60:63]
  ds_read_b128 v[80:83], v7 offset:7168
  ds_read_b128 v[84:87], v7 offset:27648
  s_waitcnt lgkmcnt(4)
  v_mfma_f32_16x16x32_bf16 v[32:35], a[20:23], v[88:91], v[32:35]
  v_mfma_f32_16x16x32_bf16 v[36:39], a[20:23], v[92:95], v[36:39]
  v_mfma_f32_16x16x32_bf16 v[40:43], a[100:103], v[88:91], v[40:43]
  v_mfma_f32_16x16x32_bf16 v[44:47], a[100:103], v[92:95], v[44:47]
  v_mfma_f32_16x16x32_bf16 v[48:51], a[180:183], v[88:91], v[48:51]
  v_mfma_f32_16x16x32_bf16 v[52:55], a[180:183], v[92:95], v[52:55]
  v_mfma_f32_16x16x32_bf16 v[56:59], v[116:119], v[88:91], v[56:59]
  v_mfma_f32_16x16x32_bf16 v[60:63], v[116:119], v[92:95], v[60:63]
  ds_read_b128 v[88:91], v7 offset:8192
  ds_read_b128 v[92:95], v7 offset:28672
  s_waitcnt lgkmcnt(4)
  v_mfma_f32_16x16x32_bf16 v[32:35], a[24:27], v[72:75], v[32:35]
  v_mfma_f32_16x16x32_bf16 v[36:39], a[24:27], v[76:79], v[36:39]
  v_mfma_f32_16x16x32_bf16 v[40:43], a[104:107], v[72:75], v[40:43]
  v_mfma_f32_16x16x32_bf16 v[44:47], a[104:107], v[76:79], v[44:47]
  v_mfma_f32_16x16x32_bf16 v[48:51], a[184:187], v[72:75], v[48:51]
  v_mfma_f32_16x16x32_bf16 v[52:55], a[184:187], v[76:79], v[52:55]
  v_mfma_f32_16x16x32_bf16 v[56:59], v[120:123], v[72:75], v[56:59]
  v_mfma_f32_16x16x32_bf16 v[60:63], v[120:123], v[76:79], v[60:63]
  ds_read_b128 v[72:75], v7 offset:9216
  ds_read_b128 v[76:79], v7 offset:29696
  s_waitcnt lgkmcnt(4)
  v_mfma_f32_16x16x32_bf16 v[32:35], a[28:31], v[80:83], v[32:35]
  v_mfma_f32_16x16x32_bf16 v[36:39], a[28:31], v[84:87], v[36:39]
  v_mfma_f32_16x16x32_bf16 v[40:43], a[108:111], v[80:83], v[40:43]
  v_mfma_f32_16x16x32_bf16 v[44:47], a[108:111], v[84:87], v[44:47]
  v_mfma_f32_16x16x32_bf16 v[48:51], a[188:191], v[80:83], v[48:51]
  v_mfma_f32_16x16x32_bf16 v[52:55], a[188:191], v[84:87], v[52:55]
  v_mfma_f32_16x16x32_bf16 v[56:59], v[124:127], v[80:83], v[56:59]
  v_mfma_f32_16x16x32_bf16 v[60:63], v[124:127], v[84:87], v[60:63]
  ds_read_b128 v[80:83], v7 offset:10240
  ds_read_b128 v[84:87], v7 offset:30720
  s_waitcnt lgkmcnt(4)
  v_mfma_f32_16x16x32_bf16 v[32:35], a[32:35], v[88:91], v[32:35]
  v_mfma_f32_16x16x32_bf16 v[36:39], a[32:35], v[92:95], v[36:39]
  v_mfma_f32_16x16x32_bf16 v[40:43], a[112:115], v[88:91], v[40:43]
  v_mfma_f32_16x16x32_bf16 v[44:47], a[112:115], v[92:95], v[44:47]
  v_mfma_f32_16x16x32_bf16 v[48:51], a[192:195], v[88:91], v[48:51]
  v_mfma_f32_16x16x32_bf16 v[52:55], a[192:195], v[92:95], v[52:55]
  v_mfma_f32_16x16x32_bf16 v[56:59], v[128:131], v[88:91], v[56:59]
  v_mfma_f32_16x16x32_bf16 v[60:63], v[128:131], v[92:95], v[60:63]
  ds_read_b128 v[88:91], v7 offset:11264
  ds_read_b128 v[92:95], v7 offset:31744
  s_waitcnt lgkmcnt(4)
  v_mfma_f32_16x16x32_bf16 v[32:35], a[36:39], v[72:75], v[32:35]
  v_mfma_f32_16x16x32_bf16 v[36:39], a[36:39], v[76:79], v[36:39]
  v_mfma_f32_16x16x32_bf16 v[40:43], a[116:119], v[72:75], v[40:43]
  v_mfma_f32_16x16x32_bf16 v[44:47], a[116:119], v[76:79], v[44:47]
  v_mfma_f32_16x16x32_bf16 v[48:51], a[196:199], v[72:75], v[48:51]
  v_mfma_f32_16x16x32_bf16 v[52:55], a[196:199], v[76:79], v[52:55]
  v_mfma_f32_16x16x32_bf16 v[56:59], v[132:135], v[72:75], v[56:59]
  v_mfma_f32_16x16x32_bf16 v[60:63], v[132:135], v[76:79], v[60:63]
  ds_read_b128 v[72:75], v7 offset:12288
  ds_read_b128 v[76:79], v7 offset:32768
  s_waitcnt lgkmcnt(4)
  v_mfma_f32_16x16x32_bf16 v[32:35], a[40:43], v[80:83], v[32:35]
  v_mfma_f32_16x16x32_bf16 v[36:39], a[40:43], v[84:87], v[36:39]
  v_mfma_f32_16x16x32_bf16 v[40:43], a[120:123], v[80:83], v[40:43]
  v_mfma_f32_16x16x32_bf16 v[44:47], a[120:123], v[84:87], v[44:47]
  v_mfma_f32_16x16x32_bf16 v[48:51], a[200:203], v[80:83], v[48:51]
  v_mfma_f32_16x16x32_bf16 v[52:55], a[200:203], v[84:87], v[52:55]
  v_mfma_f32_16x16x32_bf16 v[56:59], v[136:139], v[80:83], v[56:59]
  v_mfma_f32_16x16x32_bf16 v[60:63], v[136:139], v[84:87], v[60:63]
  ds_read_b128 v[80:83], v7 offset:13312
  ds_read_b128 v[84:87], v7 offset:33792
  s_waitcnt lgkmcnt(4)
  v_mfma_f32_16x16x32_bf16 v[32:35], a[44:47], v[88:91], v[32:35]
  v_mfma_f32_16x16x32_bf16 v[36:39], a[44:47], v[92:95], v[36:39]
  v_mfma_f32_16x16x32_bf16 v[40:43], a[124:127], v[88:91], v[40:43]
  v_mfma_f32_16x16x32_bf16 v[44:47], a[124:127], v[92:95], v[44:47]
  v_mfma_f32_16x16x32_bf16 v[48:51], a[204:207], v[88:91], v[48:51]
  v_mfma_f32_16x16x32_bf16 v[52:55], a[204:207], v[92:95], v[52:55]
  v_mfma_f32_16x16x32_bf16 v[56:59], v[140:143], v[88:91], v[56:59]
  v_mfma_f32_16x16x32_bf16 v[60:63], v[140:143], v[92:95], v[60:63]
  ds_read_b128 v[88:91], v7 offset:14336
  ds_read_b128 v[92:95], v7 offset:34816
  s_waitcnt lgkmcnt(4)
  v_mfma_f32_16x16x32_bf16 v[32:35], a[48:51], v[72:75], v[32:35]
  v_mfma_f32_16x16x32_bf16 v[36:39], a[48:51], v[76:79], v[36:39]
  v_mfma_f32_16x16x32_bf16 v[40:43], a[128:131], v[72:75], v[40:43]
  v_mfma_f32_16x16x32_bf16 v[44:47], a[128:131], v[76:79], v[44:47]
  v_mfma_f32_16x16x32_bf16 v[48:51], a[208:211], v[72:75], v[48:51]
  v_mfma_f32_16x16x32_bf16 v[52:55], a[208:211], v[76:79], v[52:55]
  v_mfma_f32_16x16x32_bf16 v[56:59], v[144:147], v[72:75], v[56:59]
  v_mfma_f32_16x16x32_bf16 v[60:63], v[144:147], v[76:79], v[60:63]
  ds_read_b128 v[72:75], v7 offset:15360
  ds_read_b128 v[76:79], v7 offset:35840
  s_waitcnt lgkmcnt(4)
  v_mfma_f32_16x16x32_bf16 v[32:35], a[52:55], v[80:83], v[32:35]
  v_mfma_f32_16x16x32_bf16 v[36:39], a[52:55], v[84:87], v[36:39]
  v_mfma_f32_16x16x32_bf16 v[40:43], a[132:135], v[80:83], v[40:43]
  v_mfma_f32_16x16x32_bf16 v[44:47], a[132:135], v[84:87], v[44:47]
  v_mfma_f32_16x16x32_bf16 v[48:51], a[212:215], v[80:83], v[48:51]
  v_mfma_f32_16x16x32_bf16 v[52:55], a[212:215], v[84:87], v[52:55]
  v_mfma_f32_16x16x32_bf16 v[56:59], v[148:151], v[80:83], v[56:59]
  v_mfma_f32_16x16x32_bf16 v[60:63], v[148:151], v[84:87], v[60:63]
  ds_read_b128 v[80:83], v7 offset:16384
  ds_read_b128 v[84:87], v7 offset:36864
  s_waitcnt lgkmcnt(4)
  v_mfma_f32_16x16x32_bf16 v[32:35], a[56:59], v[88:91], v[32:35]
  v_mfma_f32_16x16x32_bf16 v[36:39], a[56:59], v[92:95], v[36:39]
  v_mfma_f32_16x16x32_bf16 v[40:43], a[136:139], v[88:91], v[40:43]
  v_mfma_f32_16x16x32_bf16 v[44:47], a[136:139], v[92:95], v[44:47]
  v_mfma_f32_16x16x32_bf16 v[48:51], a[216:219], v[88:91], v[48:51]
  v_mfma_f32_16x16x32_bf16 v[52:55], a[216:219], v[92:95], v[52:55]
  v_mfma_f32_16x16x32_bf16 v[56:59], v[152:155], v[88:91], v[56:59]
  v_mfma_f32_16x16x32_bf16 v[60:63], v[152:155], v[92:95], v[60:63]
  ds_read_b128 v[88:91], v7 offset:17408
  ds_read_b128 v[92:95], v7 offset:37888
  s_waitcnt lgkmcnt(4)
  v_mfma_f32_16x16x32_bf16 v[32:35], a[60:63], v[72:75], v[32:35]
  v_mfma_f32_16x16x32_bf16 v[36:39], a[60:63], v[76:79], v[36:39]
  v_mfma_f32_16x16x32_bf16 v[40:43], a[140:143], v[72:75], v[40:43]
  v_mfma_f32_16x16x32_bf16 v[44:47], a[140:143], v[76:79], v[44:47]
  v_mfma_f32_16x16x32_bf16 v[48:51], a[220:223], v[72:75], v[48:51]
  v_mfma_f32_16x16x32_bf16 v[52:55], a[220:223], v[76:79], v[52:55]
  v_mfma_f32_16x16x32_bf16 v[56:59], v[156:159], v[72:75], v[56:59]
  v_mfma_f32_16x16x32_bf16 v[60:63], v[156:159], v[76:79], v[60:63]
  ds_read_b128 v[72:75], v7 offset:18432
  ds_read_b128 v[76:79], v7 offset:38912
  s_waitcnt lgkmcnt(4)
  v_mfma_f32_16x16x32_bf16 v[32:35], a[64:67], v[80:83], v[32:35]
  v_mfma_f32_16x16x32_bf16 v[36:39], a[64:67], v[84:87], v[36:39]
  v_mfma_f32_16x16x32_bf16 v[40:43], a[144:147], v[80:83], v[40:43]
  v_mfma_f32_16x16x32_bf16 v[44:47], a[144:147], v[84:87], v[44:47]
  v_mfma_f32_16x16x32_bf16 v[48:51], a[224:227], v[80:83], v[48:51]
  v_mfma_f32_16x16x32_bf16 v[52:55], a[224:227], v[84:87], v[52:55]
  v_mfma_f32_16x16x32_bf16 v[56:59], v[160:163], v[80:83], v[56:59]
  v_mfma_f32_16x16x32_bf16 v[60:63], v[160:163], v[84:87], v[60:63]
  ds_read_b128 v[80:83], v7 offset:19456
  ds_read_b128 v[84:87], v7 offset:39936
  s_waitcnt lgkmcnt(4)
  v_mfma_f32_16x16x32_bf16 v[32:35], a[68:71], v[88:91], v[32:35]
  v_mfma_f32_16x16x32_bf16 v[36:39], a[68:71], v[92:95], v[36:39]
  v_mfma_f32_16x16x32_bf16 v[40:43], a[148:151], v[88:91], v[40:43]
  v_mfma_f32_16x16x32_bf16 v[44:47], a[148:151], v[92:95], v[44:47]
  v_mfma_f32_16x16x32_bf16 v[48:51], a[228:231], v[88:91], v[48:51]
  v_mfma_f32_16x16x32_bf16 v[52:55], a[228:231], v[92:95], v[52:55]
  v_mfma_f32_16x16x32_bf16 v[56:59], v[164:167], v[88:91], v[56:59]
  v_mfma_f32_16x16x32_bf16 v[60:63], v[164:167], v[92:95], v[60:63]
  s_waitcnt lgkmcnt(2)
  v_mfma_f32_16x16x32_bf16 v[32:35], a[72:75], v[72:75], v[32:35]
  v_mfma_f32_16x16x32_bf16 v[36:39], a[72:75], v[76:79], v[36:39]
  v_mfma_f32_16x16x32_bf16 v[40:43], a[152:155], v[72:75], v[40:43]
  v_mfma_f32_16x16x32_bf16 v[44:47], a[152:155], v[76:79], v[44:47]
  v_mfma_f32_16x16x32_bf16 v[48:51], a[232:235], v[72:75], v[48:51]
  v_mfma_f32_16x16x32_bf16 v[52:55], a[232:235], v[76:79], v[52:55]
  v_mfma_f32_16x16x32_bf16 v[56:59], v[168:171], v[72:75], v[56:59]
  v_mfma_f32_16x16x32_bf16 v[60:63], v[168:171], v[76:79], v[60:63]
  s_waitcnt lgkmcnt(0)
  v_mfma_f32_16x16x32_bf16 v[32:35], a[76:79], v[80:83], v[32:35]
  v_mfma_f32_16x16x32_bf16 v[36:39], a[76:79], v[84:87], v[36:39]
  v_mfma_f32_16x16x32_bf16 v[40:43], a[156:159], v[80:83], v[40:43]
  v_mfma_f32_16x16x32_bf16 v[44:47], a[156:159], v[84:87], v[44:47]
  v_mfma_f32_16x16x32_bf16 v[48:51], a[236:239], v[80:83], v[48:51]
  v_mfma_f32_16x16x32_bf16 v[52:55], a[236:239], v[84:87], v[52:55]
  v_mfma_f32_16x16x32_bf16 v[56:59], v[172:175], v[80:83], v[56:59]
  v_mfma_f32_16x16x32_bf16 v[60:63], v[172:175], v[84:87], v[60:63]
  s_nop 0
  v_cvt_pk_bf16_f32 v8, v32, v33
  v_cvt_pk_bf16_f32 v9, v34, v35
  v_cvt_pk_bf16_f32 v10, v40, v41
  v_cvt_pk_bf16_f32 v11, v42, v43
  s_add_u32 s34, s22, 1024
  buffer_store_dwordx4 v[8:11], v1, s[4:7], s34 offen
  v_cvt_pk_bf16_f32 v12, v36, v37
  v_cvt_pk_bf16_f32 v13, v38, v39
  v_cvt_pk_bf16_f32 v14, v44, v45
  v_cvt_pk_bf16_f32 v15, v46, v47
  s_add_u32 s34, s22, 7168
  buffer_store_dwordx4 v[12:15], v1, s[4:7], s34 offen
  v_cvt_pk_bf16_f32 v8, v48, v49
  v_cvt_pk_bf16_f32 v9, v50, v51
  v_cvt_pk_bf16_f32 v10, v56, v57
  v_cvt_pk_bf16_f32 v11, v58, v59
  s_add_u32 s34, s22, 2048
  buffer_store_dwordx4 v[8:11], v1, s[4:7], s34 offen
  v_cvt_pk_bf16_f32 v12, v52, v53
  v_cvt_pk_bf16_f32 v13, v54, v55
  v_cvt_pk_bf16_f32 v14, v60, v61
  v_cvt_pk_bf16_f32 v15, v62, v63
  s_add_u32 s34, s22, 8192
  buffer_store_dwordx4 v[12:15], v1, s[4:7], s34 offen
  s_waitcnt vmcnt(0)
  s_barrier
  s_add_u32 s17, s17, 1
  s_cmp_lt_u32 s17, 64
  s_cbranch_scc1 reca_ptop209
  s_branch reca_exit1
reca_exit1:
reca_exitb3:
  s_endpgm
.globl fin_kernel
.p2align 8
.type fin_kernel,@function
fin_kernel:
  s_cmp_ge_u32 s2, 256
  s_cbranch_scc1 fin_exit1
  s_load_dwordx2 s[8:9], s[0:1], 96
  v_lshrrev_b32 v6, 6, v0
  v_and_b32 v7, 63, v0
  s_and_b32 s13, s2, 7
  v_readfirstlane_b32 s12, v6
  v_lshlrev_b32 v1, 4, v7
  v_add_u32 v2, 0x1000, v1
  v_add_u32 v3, 0x2000, v1
  s_lshr_b32 s14, s2, 3
  s_lshl_b32 s15, s13, 2
  s_add_u32 s15, s15, s12
  s_waitcnt lgkmcnt(0)
  s_mov_b32 s4, s8
  s_mov_b32 s5, s9
  s_mov_b32 s6, 0x10000000
  s_mov_b32 s7, 0x20000
  s_mov_b32 s27, 0x3dd53b95
  v_and_b32 v6, 15, v7
  v_lshrrev_b32 v8, 4, v7
  v_mov_b32 v9, 0x80000000
  v_lshlrev_b32 v10, 4, v6
  v_lshl_add_u32 v10, v8, 7, v10
  v_cmp_gt_u32 vcc, 8, v6
  s_nop 1
  v_cndmask_b32 v4, v9, v10, vcc
  v_lshlrev_b32 v10, 3, v7
  v_cmp_gt_u32 vcc, 32, v7
  s_nop 1
  v_cndmask_b32 v5, v9, v10, vcc
  v_mov_b32 v10, 0xf149f2ca
  v_cmp_le_u32 vcc, 2, v8
  s_nop 1
  v_cndmask_b32 v12, 0, v10, vcc
  v_mov_b32 v13, v12
  v_mov_b32 v14, v12
  v_mov_b32 v15, v12
  v_lshlrev_b32 v11, 2, v8
  v_add_u32 v7, 0, v11
  v_cmp_gt_u32 vcc, v7, v6
  s_nop 1
  v_cndmask_b32 v16, 0, v10, vcc
  v_add_u32 v7, 1, v11
  v_cmp_gt_u32 vcc, v7, v6
  s_nop 1
  v_cndmask_b32 v17, 0, v10, vcc
  v_add_u32 v7, 2, v11
  v_cmp_gt_u32 vcc, v7, v6
  s_nop 1
  v_cndmask_b32 v18, 0, v10, vcc
  v_add_u32 v7, 3, v11
  v_cmp_gt_u32 vcc, v7, v6
  s_nop 1
  v_cndmask_b32 v19, 0, v10, vcc
  v_mov_b32 v20, 0x3f803f80
  v_mov_b32 v21, 0x3f803f80
  v_mov_b32 v22, 0x3f803f80
  v_mov_b32 v23, 0x3f803f80
  s_mul_i32 s16, s12, 6144
  v_add_u32 v240, s16, v1
  v_add_u32 v241, 49152, v240
  s_mul_i32 s16, s12, 10
  s_mul_i32 s16, s16, 192
  s_mul_i32 s17, s13, 24
  s_add_u32 s16, s16, s17
  s_lshl_b32 s16, s16, 10
  s_add_u32 s16, s16, 29884416
  s_add_u32 s30, s16, 0
  s_add_u32 s31, s16, 196608
  s_add_u32 s32, s16, 393216
  s_add_u32 s33, s16, 589824
  s_add_u32 s34, s16, 786432
  s_add_u32 s35, s16, 983040
  s_add_u32 s36, s16, 1179648
  s_add_u32 s37, s16, 1376256
  s_add_u32 s38, s16, 1572864
  s_add_u32 s39, s16, 1769472
  s_lshl_b32 s17, s14, 1
  s_add_u32 s17, s17, 0
  s_lshl_b32 s16, s15, 6
  s_add_u32 s16, s16, s17
  s_mul_i32 s16, s16, 12288
  s_add_u32 s20, s16, 88080384
  s_add_u32 s21, s16, 37748736
  s_add_u32 s22, s16, 62914560
  s_lshl_b32 s17, s17, 5
  s_add_u32 s17, s17, s15
  s_mul_i32 s17, s17, 3072
  s_add_u32 s23, s17, 113246208
  s_add_u32 s24, s17, 119537664
  buffer_load_dwordx4 v[136:139], v1, s[4:7], s21 offen offset:0
  buffer_load_dwordx4 v[140:143], v1, s[4:7], s21 offen offset:1024
  buffer_load_dwordx4 v[144:147], v1, s[4:7], s21 offen offset:2048
  buffer_load_dwordx4 v[148:151], v1, s[4:7], s21 offen offset:3072
  buffer_load_dwordx4 v[152:155], v2, s[4:7], s21 offen offset:0
  buffer_load_dwordx4 v[156:159], v2, s[4:7], s21 offen offset:1024
  buffer_load_dwordx4 v[160:163], v2, s[4:7], s21 offen offset:2048
  buffer_load_dwordx4 v[164:167], v2, s[4:7], s21 offen offset:3072
  buffer_load_dwordx4 v[168:171], v3, s[4:7], s21 offen offset:0
  buffer_load_dwordx4 v[172:175], v3, s[4:7], s21 offen offset:1024
  buffer_load_dwordx4 v[176:179], v3, s[4:7], s21 offen offset:2048
  buffer_load_dwordx4 v[180:183], v3, s[4:7], s21 offen offset:3072
  buffer_load_dwordx4 v[184:187], v4, s[4:7], s23 offen offset:0
  buffer_load_dwordx4 v[188:191], v4, s[4:7], s23 offen offset:512
  buffer_load_dwordx4 v[192:195], v4, s[4:7], s23 offen offset:1024
  buffer_load_dwordx4 v[196:199], v4, s[4:7], s23 offen offset:1536
  buffer_load_dwordx4 v[200:203], v4, s[4:7], s23 offen offset:2048
  buffer_load_dwordx4 v[204:207], v4, s[4:7], s23 offen offset:2560
  buffer_load_dwordx4 v[88:91], v1, s[4:7], s20 offen offset:0
  buffer_load_dwordx4 v[92:95], v1, s[4:7], s20 offen offset:1024
  buffer_load_dwordx4 v[96:99], v1, s[4:7], s20 offen offset:2048
  buffer_load_dwordx4 v[100:103], v1, s[4:7], s20 offen offset:3072
  buffer_load_dwordx4 v[104:107], v2, s[4:7], s20 offen offset:0
  buffer_load_dwordx4 v[108:111], v2, s[4:7], s20 offen offset:1024
  buffer_load_dwordx4 v[112:115], v2, s[4:7], s20 offen offset:2048
  buffer_load_dwordx4 v[116:119], v2, s[4:7], s20 offen offset:3072
  buffer_load_dwordx4 v[120:123], v3, s[4:7], s20 offen offset:0
  buffer_load_dwordx4 v[124:127], v3, s[4:7], s20 offen offset:1024
  buffer_load_dwordx4 v[128:131], v3, s[4:7], s20 offen offset:2048
  buffer_load_dwordx4 v[132:135], v3, s[4:7], s20 offen offset:3072
  s_waitcnt vmcnt(5)
  v_mfma_f32_16x16x32_bf16 v[24:27], v[184:187], v[88:91], v[12:15]
  v_mfma_f32_16x16x32_bf16 v[28:31], v[136:139], v[88:91], v[16:19]
  v_mfma_f32_16x16x32_bf16 v[32:35], v[184:187], v[112:115], v[12:15]
  v_mfma_f32_16x16x32_bf16 v[36:39], v[136:139], v[112:115], 0
  v_mfma_f32_16x16x32_bf16 v[40:43], v[160:163], v[112:115], v[16:19]
  s_waitcnt vmcnt(4)
  v_mfma_f32_16x16x32_bf16 v[24:27], v[188:191], v[92:95], v[24:27]
  v_mfma_f32_16x16x32_bf16 v[28:31], v[140:143], v[92:95], v[28:31]
  v_mfma_f32_16x16x32_bf16 v[32:35], v[188:191], v[116:119], v[32:35]
  v_mfma_f32_16x16x32_bf16 v[36:39], v[140:143], v[116:119], v[36:39]
  v_mfma_f32_16x16x32_bf16 v[40:43], v[164:167], v[116:119], v[40:43]
  s_waitcnt vmcnt(3)
  v_mfma_f32_16x16x32_bf16 v[24:27], v[192:195], v[96:99], v[24:27]
  v_mfma_f32_16x16x32_bf16 v[28:31], v[144:147], v[96:99], v[28:31]
  v_mfma_f32_16x16x32_bf16 v[32:35], v[192:195], v[120:123], v[32:35]
  v_mfma_f32_16x16x32_bf16 v[36:39], v[144:147], v[120:123], v[36:39]
  v_mfma_f32_16x16x32_bf16 v[40:43], v[168:171], v[120:123], v[40:43]
  s_waitcnt vmcnt(2)
  v_mfma_f32_16x16x32_bf16 v[24:27], v[196:199], v[100:103], v[24:27]
  v_mfma_f32_16x16x32_bf16 v[28:31], v[148:151], v[100:103], v[28:31]
  v_mfma_f32_16x16x32_bf16 v[32:35], v[196:199], v[124:127], v[32:35]
  v_mfma_f32_16x16x32_bf16 v[36:39], v[148:151], v[124:127], v[36:39]
  v_mfma_f32_16x16x32_bf16 v[40:43], v[172:175], v[124:127], v[40:43]
  s_waitcnt vmcnt(1)
  v_mfma_f32_16x16x32_bf16 v[24:27], v[200:203], v[104:107], v[24:27]
  v_mfma_f32_16x16x32_bf16 v[28:31], v[152:155], v[104:107], v[28:31]
  v_mfma_f32_16x16x32_bf16 v[32:35], v[200:203], v[128:131], v[32:35]
  v_mfma_f32_16x16x32_bf16 v[36:39], v[152:155], v[128:131], v[36:39]
  v_mfma_f32_16x16x32_bf16 v[40:43], v[176:179], v[128:131], v[40:43]
  s_waitcnt vmcnt(0)
  v_mfma_f32_16x16x32_bf16 v[24:27], v[204:207], v[108:111], v[24:27]
  v_mfma_f32_16x16x32_bf16 v[28:31], v[156:159], v[108:111], v[28:31]
  v_mfma_f32_16x16x32_bf16 v[32:35], v[204:207], v[132:135], v[32:35]
  v_mfma_f32_16x16x32_bf16 v[36:39], v[156:159], v[132:135], v[36:39]
  v_mfma_f32_16x16x32_bf16 v[40:43], v[180:183], v[132:135], v[40:43]
  buffer_load_dwordx4 v[88:91], v1, s[4:7], s22 offen offset:0
  buffer_load_dwordx4 v[92:95], v1, s[4:7], s22 offen offset:1024
  buffer_load_dwordx4 v[96:99], v1, s[4:7], s22 offen offset:2048
  buffer_load_dwordx4 v[100:103], v1, s[4:7], s22 offen offset:3072
  buffer_load_dwordx4 v[104:107], v2, s[4:7], s22 offen offset:0
  buffer_load_dwordx4 v[108:111], v2, s[4:7], s22 offen offset:1024
  buffer_load_dwordx4 v[112:115], v2, s[4:7], s22 offen offset:2048
  buffer_load_dwordx4 v[116:119], v2, s[4:7], s22 offen offset:3072
  buffer_load_dwordx4 v[120:123], v3, s[4:7], s22 offen offset:0
  buffer_load_dwordx4 v[124:127], v3, s[4:7], s22 offen offset:1024
  buffer_load_dwordx4 v[128:131], v3, s[4:7], s22 offen offset:2048
  buffer_load_dwordx4 v[132:135], v3, s[4:7], s22 offen offset:3072
  buffer_load_dwordx2 v[136:137], v5, s[4:7], s24 offen offset:0
  buffer_load_dwordx2 v[138:139], v5, s[4:7], s24 offen offset:256
  buffer_load_dwordx2 v[140:141], v5, s[4:7], s24 offen offset:512
  buffer_load_dwordx2 v[142:143], v5, s[4:7], s24 offen offset:768
  buffer_load_dwordx2 v[144:145], v5, s[4:7], s24 offen offset:1024
  buffer_load_dwordx2 v[146:147], v5, s[4:7], s24 offen offset:1280
  buffer_load_dwordx2 v[148:149], v5, s[4:7], s24 offen offset:1536
  buffer_load_dwordx2 v[150:151], v5, s[4:7], s24 offen offset:1792
  buffer_load_dwordx2 v[152:153], v5, s[4:7], s24 offen offset:2048
  buffer_load_dwordx2 v[154:155], v5, s[4:7], s24 offen offset:2304
  buffer_load_dwordx2 v[156:157], v5, s[4:7], s24 offen offset:2560
  buffer_load_dwordx2 v[158:159], v5, s[4:7], s24 offen offset:2816
  v_max3_f32 v6, v24, v25, v26
  v_max3_f32 v6, v6, v27, v28
  v_max3_f32 v6, v6, v29, v30
  v_max_f32 v6, v6, v31
  v_mov_b32 v7, v6
  s_nop 1
  v_permlane32_swap_b32 v6, v7
  v_max_f32 v6, v6, v7
  v_mov_b32 v7, v6
  s_nop 1
  v_permlane16_swap_b32 v6, v7
  v_max_f32 v6, v6, v7
  v_mul_f32 v6, s27, v6
  v_fma_f32 v24, v24, s27, -v6
  v_fma_f32 v25, v25, s27, -v6
  v_fma_f32 v26, v26, s27, -v6
  v_fma_f32 v27, v27, s27, -v6
  v_fma_f32 v28, v28, s27, -v6
  v_fma_f32 v29, v29, s27, -v6
  v_fma_f32 v30, v30, s27, -v6
  v_fma_f32 v31, v31, s27, -v6
  v_exp_f32 v24, v24
  v_exp_f32 v25, v25
  v_exp_f32 v26, v26
  v_exp_f32 v27, v27
  v_exp_f32 v28, v28
  v_exp_f32 v29, v29
  v_exp_f32 v30, v30
  v_exp_f32 v31, v31
  v_max3_f32 v8, v32, v33, v34
  v_max3_f32 v8, v8, v35, v36
  v_max3_f32 v8, v8, v37, v38
  v_max3_f32 v8, v8, v39, v40
  v_max3_f32 v8, v8, v41, v42
  v_max_f32 v8, v8, v43
  v_mov_b32 v10, v8
  s_nop 1
  v_permlane32_swap_b32 v8, v10
  v_max_f32 v8, v8, v10
  v_mov_b32 v10, v8
  s_nop 1
  v_permlane16_swap_b32 v8, v10
  v_max_f32 v8, v8, v10
  v_mul_f32 v8, s27, v8
  v_fma_f32 v32, v32, s27, -v8
  v_fma_f32 v33, v33, s27, -v8
  v_fma_f32 v34, v34, s27, -v8
  v_fma_f32 v35, v35, s27, -v8
  v_fma_f32 v36, v36, s27, -v8
  v_fma_f32 v37, v37, s27, -v8
  v_fma_f32 v38, v38, s27, -v8
  v_fma_f32 v39, v39, s27, -v8
  v_fma_f32 v40, v40, s27, -v8
  v_fma_f32 v41, v41, s27, -v8
  v_fma_f32 v42, v42, s27, -v8
  v_fma_f32 v43, v43, s27, -v8
  v_exp_f32 v32, v32
  v_exp_f32 v33, v33
  v_exp_f32 v34, v34
  v_exp_f32 v35, v35
  v_exp_f32 v36, v36
  v_exp_f32 v37, v37
  v_exp_f32 v38, v38
  v_exp_f32 v39, v39
  v_exp_f32 v40, v40
  v_exp_f32 v41, v41
  v_exp_f32 v42, v42
  v_exp_f32 v43, v43
  v_cvt_pk_bf16_f32 v44, v24, v25
  v_cvt_pk_bf16_f32 v45, v26, v27
  v_cvt_pk_bf16_f32 v46, v28, v29
  v_cvt_pk_bf16_f32 v47, v30, v31
  v_cvt_pk_bf16_f32 v48, v32, v33
  v_cvt_pk_bf16_f32 v49, v34, v35
  v_cvt_pk_bf16_f32 v50, v36, v37
  v_cvt_pk_bf16_f32 v51, v38, v39
  v_cvt_pk_bf16_f32 v52, v40, v41
  v_cvt_pk_bf16_f32 v53, v42, v43
  v_mfma_f32_16x16x16_bf16 v[56:59], v[20:21], v[44:45], 0
  v_mfma_f32_16x16x16_bf16 v[60:63], v[20:21], v[48:49], 0
  v_mfma_f32_16x16x16_bf16 v[56:59], v[20:21], v[46:47], v[56:59]
  v_mfma_f32_16x16x32_bf16 v[60:63], v[20:23], v[50:53], v[60:63]
  s_nop 6
  v_rcp_f32 v10, v56
  v_rcp_f32 v11, v60
  s_waitcnt vmcnt(0)
  v_mfma_f32_16x16x16_bf16 v[64:67], v[136:137], v[44:45], 0
  v_mfma_f32_16x16x16_bf16 v[68:71], v[136:137], v[48:49], 0
  v_mfma_f32_16x16x16_bf16 v[64:67], v[88:89], v[46:47], v[64:67]
  v_mfma_f32_16x16x32_bf16 v[68:71], v[88:91], v[50:53], v[68:71]
  v_mfma_f32_16x16x16_bf16 v[72:75], v[138:139], v[44:45], 0
  v_mfma_f32_16x16x16_bf16 v[76:79], v[138:139], v[48:49], 0
  v_mfma_f32_16x16x16_bf16 v[72:75], v[92:93], v[46:47], v[72:75]
  v_mfma_f32_16x16x32_bf16 v[76:79], v[92:95], v[50:53], v[76:79]
  s_nop 2
  v_mul_f32 v64, v64, v10
  v_mul_f32 v65, v65, v10
  v_mul_f32 v66, v66, v10
  v_mul_f32 v67, v67, v10
  v_cvt_pk_bf16_f32 v80, v64, v65
  v_cvt_pk_bf16_f32 v81, v66, v67
  v_mul_f32 v72, v72, v10
  v_mul_f32 v73, v73, v10
  v_mul_f32 v74, v74, v10
  v_mul_f32 v75, v75, v10
  v_cvt_pk_bf16_f32 v82, v72, v73
  v_cvt_pk_bf16_f32 v83, v74, v75
  ds_write_b128 v240, v[80:83] offset:0
  v_mul_f32 v68, v68, v11
  v_mul_f32 v69, v69, v11
  v_mul_f32 v70, v70, v11
  v_mul_f32 v71, v71, v11
  v_cvt_pk_bf16_f32 v84, v68, v69
  v_cvt_pk_bf16_f32 v85, v70, v71
  v_mul_f32 v76, v76, v11
  v_mul_f32 v77, v77, v11
  v_mul_f32 v78, v78, v11
  v_mul_f32 v79, v79, v11
  v_cvt_pk_bf16_f32 v86, v76, v77
  v_cvt_pk_bf16_f32 v87, v78, v79
  ds_write_b128 v240, v[84:87] offset:24576
  v_mfma_f32_16x16x16_bf16 v[64:67], v[140:141], v[44:45], 0
  v_mfma_f32_16x16x16_bf16 v[68:71], v[140:141], v[48:49], 0
  v_mfma_f32_16x16x16_bf16 v[64:67], v[96:97], v[46:47], v[64:67]
  v_mfma_f32_16x16x32_bf16 v[68:71], v[96:99], v[50:53], v[68:71]
  v_mfma_f32_16x16x16_bf16 v[72:75], v[142:143], v[44:45], 0
  v_mfma_f32_16x16x16_bf16 v[76:79], v[142:143], v[48:49], 0
  v_mfma_f32_16x16x16_bf16 v[72:75], v[100:101], v[46:47], v[72:75]
  v_mfma_f32_16x16x32_bf16 v[76:79], v[100:103], v[50:53], v[76:79]
  s_nop 2
  v_mul_f32 v64, v64, v10
  v_mul_f32 v65, v65, v10
  v_mul_f32 v66, v66, v10
  v_mul_f32 v67, v67, v10
  v_cvt_pk_bf16_f32 v80, v64, v65
  v_cvt_pk_bf16_f32 v81, v66, v67
  v_mul_f32 v72, v72, v10
  v_mul_f32 v73, v73, v10
  v_mul_f32 v74, v74, v10
  v_mul_f32 v75, v75, v10
  v_cvt_pk_bf16_f32 v82, v72, v73
  v_cvt_pk_bf16_f32 v83, v74, v75
  ds_write_b128 v240, v[80:83] offset:1024
  v_mul_f32 v68, v68, v11
  v_mul_f32 v69, v69, v11
  v_mul_f32 v70, v70, v11
  v_mul_f32 v71, v71, v11
  v_cvt_pk_bf16_f32 v84, v68, v69
  v_cvt_pk_bf16_f32 v85, v70, v71
  v_mul_f32 v76, v76, v11
  v_mul_f32 v77, v77, v11
  v_mul_f32 v78, v78, v11
  v_mul_f32 v79, v79, v11
  v_cvt_pk_bf16_f32 v86, v76, v77
  v_cvt_pk_bf16_f32 v87, v78, v79
  ds_write_b128 v240, v[84:87] offset:25600
  v_mfma_f32_16x16x16_bf16 v[64:67], v[144:145], v[44:45], 0
  v_mfma_f32_16x16x16_bf16 v[68:71], v[144:145], v[48:49], 0
  v_mfma_f32_16x16x16_bf16 v[64:67], v[104:105], v[46:47], v[64:67]
  v_mfma_f32_16x16x32_bf16 v[68:71], v[104:107], v[50:53], v[68:71]
  v_mfma_f32_16x16x16_bf16 v[72:75], v[146:147], v[44:45], 0
  v_mfma_f32_16x16x16_bf16 v[76:79], v[146:147], v[48:49], 0
  v_mfma_f32_16x16x16_bf16 v[72:75], v[108:109], v[46:47], v[72:75]
  v_mfma_f32_16x16x32_bf16 v[76:79], v[108:111], v[50:53], v[76:79]
  s_nop 2
  v_mul_f32 v64, v64, v10
  v_mul_f32 v65, v65, v10
  v_mul_f32 v66, v66, v10
  v_mul_f32 v67, v67, v10
  v_cvt_pk_bf16_f32 v80, v64, v65
  v_cvt_pk_bf16_f32 v81, v66, v67
  v_mul_f32 v72, v72, v10
  v_mul_f32 v73, v73, v10
  v_mul_f32 v74, v74, v10
  v_mul_f32 v75, v75, v10
  v_cvt_pk_bf16_f32 v82, v72, v73
  v_cvt_pk_bf16_f32 v83, v74, v75
  ds_write_b128 v240, v[80:83] offset:2048
  v_mul_f32 v68, v68, v11
  v_mul_f32 v69, v69, v11
  v_mul_f32 v70, v70, v11
  v_mul_f32 v71, v71, v11
  v_cvt_pk_bf16_f32 v84, v68, v69
  v_cvt_pk_bf16_f32 v85, v70, v71
  v_mul_f32 v76, v76, v11
  v_mul_f32 v77, v77, v11
  v_mul_f32 v78, v78, v11
  v_mul_f32 v79, v79, v11
  v_cvt_pk_bf16_f32 v86, v76, v77
  v_cvt_pk_bf16_f32 v87, v78, v79
  ds_write_b128 v240, v[84:87] offset:26624
  v_mfma_f32_16x16x16_bf16 v[64:67], v[148:149], v[44:45], 0
  v_mfma_f32_16x16x16_bf16 v[68:71], v[148:149], v[48:49], 0
  v_mfma_f32_16x16x16_bf16 v[64:67], v[112:113], v[46:47], v[64:67]
  v_mfma_f32_16x16x32_bf16 v[68:71], v[112:115], v[50:53], v[68:71]
  v_mfma_f32_16x16x16_bf16 v[72:75], v[150:151], v[44:45], 0
  v_mfma_f32_16x16x16_bf16 v[76:79], v[150:151], v[48:49], 0
  v_mfma_f32_16x16x16_bf16 v[72:75], v[116:117], v[46:47], v[72:75]
  v_mfma_f32_16x16x32_bf16 v[76:79], v[116:119], v[50:53], v[76:79]
  s_nop 2
  v_mul_f32 v64, v64, v10
  v_mul_f32 v65, v65, v10
  v_mul_f32 v66, v66, v10
  v_mul_f32 v67, v67, v10
  v_cvt_pk_bf16_f32 v80, v64, v65
  v_cvt_pk_bf16_f32 v81, v66, v67
  v_mul_f32 v72, v72, v10
  v_mul_f32 v73, v73, v10
  v_mul_f32 v74, v74, v10
  v_mul_f32 v75, v75, v10
  v_cvt_pk_bf16_f32 v82, v72, v73
  v_cvt_pk_bf16_f32 v83, v74, v75
  ds_write_b128 v240, v[80:83] offset:3072
  v_mul_f32 v68, v68, v11
  v_mul_f32 v69, v69, v11
  v_mul_f32 v70, v70, v11
  v_mul_f32 v71, v71, v11
  v_cvt_pk_bf16_f32 v84, v68, v69
  v_cvt_pk_bf16_f32 v85, v70, v71
  v_mul_f32 v76, v76, v11
  v_mul_f32 v77, v77, v11
  v_mul_f32 v78, v78, v11
  v_mul_f32 v79, v79, v11
  v_cvt_pk_bf16_f32 v86, v76, v77
  v_cvt_pk_bf16_f32 v87, v78, v79
  ds_write_b128 v240, v[84:87] offset:27648
  v_mfma_f32_16x16x16_bf16 v[64:67], v[152:153], v[44:45], 0
  v_mfma_f32_16x16x16_bf16 v[68:71], v[152:153], v[48:49], 0
  v_mfma_f32_16x16x16_bf16 v[64:67], v[120:121], v[46:47], v[64:67]
  v_mfma_f32_16x16x32_bf16 v[68:71], v[120:123], v[50:53], v[68:71]
  v_mfma_f32_16x16x16_bf16 v[72:75], v[154:155], v[44:45], 0
  v_mfma_f32_16x16x16_bf16 v[76:79], v[154:155], v[48:49], 0
  v_mfma_f32_16x16x16_bf16 v[72:75], v[124:125], v[46:47], v[72:75]
  v_mfma_f32_16x16x32_bf16 v[76:79], v[124:127], v[50:53], v[76:79]
  s_nop 2
  v_mul_f32 v64, v64, v10
  v_mul_f32 v65, v65, v10
  v_mul_f32 v66, v66, v10
  v_mul_f32 v67, v67, v10
  v_cvt_pk_bf16_f32 v80, v64, v65
  v_cvt_pk_bf16_f32 v81, v66, v67
  v_mul_f32 v72, v72, v10
  v_mul_f32 v73, v73, v10
  v_mul_f32 v74, v74, v10
  v_mul_f32 v75, v75, v10
  v_cvt_pk_bf16_f32 v82, v72, v73
  v_cvt_pk_bf16_f32 v83, v74, v75
  ds_write_b128 v240, v[80:83] offset:4096
  v_mul_f32 v68, v68, v11
  v_mul_f32 v69, v69, v11
  v_mul_f32 v70, v70, v11
  v_mul_f32 v71, v71, v11
  v_cvt_pk_bf16_f32 v84, v68, v69
  v_cvt_pk_bf16_f32 v85, v70, v71
  v_mul_f32 v76, v76, v11
  v_mul_f32 v77, v77, v11
  v_mul_f32 v78, v78, v11
  v_mul_f32 v79, v79, v11
  v_cvt_pk_bf16_f32 v86, v76, v77
  v_cvt_pk_bf16_f32 v87, v78, v79
  ds_write_b128 v240, v[84:87] offset:28672
  v_mfma_f32_16x16x16_bf16 v[64:67], v[156:157], v[44:45], 0
  v_mfma_f32_16x16x16_bf16 v[68:71], v[156:157], v[48:49], 0
  v_mfma_f32_16x16x16_bf16 v[64:67], v[128:129], v[46:47], v[64:67]
  v_mfma_f32_16x16x32_bf16 v[68:71], v[128:131], v[50:53], v[68:71]
  v_mfma_f32_16x16x16_bf16 v[72:75], v[158:159], v[44:45], 0
  v_mfma_f32_16x16x16_bf16 v[76:79], v[158:159], v[48:49], 0
  v_mfma_f32_16x16x16_bf16 v[72:75], v[132:133], v[46:47], v[72:75]
  v_mfma_f32_16x16x32_bf16 v[76:79], v[132:135], v[50:53], v[76:79]
  s_nop 2
  v_mul_f32 v64, v64, v10
  v_mul_f32 v65, v65, v10
  v_mul_f32 v66, v66, v10
  v_mul_f32 v67, v67, v10
  v_cvt_pk_bf16_f32 v80, v64, v65
  v_cvt_pk_bf16_f32 v81, v66, v67
  v_mul_f32 v72, v72, v10
  v_mul_f32 v73, v73, v10
  v_mul_f32 v74, v74, v10
  v_mul_f32 v75, v75, v10
  v_cvt_pk_bf16_f32 v82, v72, v73
  v_cvt_pk_bf16_f32 v83, v74, v75
  ds_write_b128 v240, v[80:83] offset:5120
  v_mul_f32 v68, v68, v11
  v_mul_f32 v69, v69, v11
  v_mul_f32 v70, v70, v11
  v_mul_f32 v71, v71, v11
  v_cvt_pk_bf16_f32 v84, v68, v69
  v_cvt_pk_bf16_f32 v85, v70, v71
  v_mul_f32 v76, v76, v11
  v_mul_f32 v77, v77, v11
  v_mul_f32 v78, v78, v11
  v_mul_f32 v79, v79, v11
  v_cvt_pk_bf16_f32 v86, v76, v77
  v_cvt_pk_bf16_f32 v87, v78, v79
  ds_write_b128 v240, v[84:87] offset:29696
  s_lshl_b32 s17, s14, 1
  s_add_u32 s17, s17, 1
  s_lshl_b32 s16, s15, 6
  s_add_u32 s16, s16, s17
  s_mul_i32 s16, s16, 12288
  s_add_u32 s20, s16, 88080384
  s_add_u32 s21, s16, 37748736
  s_add_u32 s22, s16, 62914560
  s_lshl_b32 s17, s17, 5
  s_add_u32 s17, s17, s15
  s_mul_i32 s17, s17, 3072
  s_add_u32 s23, s17, 113246208
  s_add_u32 s24, s17, 119537664
  buffer_load_dwordx4 v[136:139], v1, s[4:7], s21 offen offset:0
  buffer_load_dwordx4 v[140:143], v1, s[4:7], s21 offen offset:1024
  buffer_load_dwordx4 v[144:147], v1, s[4:7], s21 offen offset:2048
  buffer_load_dwordx4 v[148:151], v1, s[4:7], s21 offen offset:3072
  buffer_load_dwordx4 v[152:155], v2, s[4:7], s21 offen offset:0
  buffer_load_dwordx4 v[156:159], v2, s[4:7], s21 offen offset:1024
  buffer_load_dwordx4 v[160:163], v2, s[4:7], s21 offen offset:2048
  buffer_load_dwordx4 v[164:167], v2, s[4:7], s21 offen offset:3072
  buffer_load_dwordx4 v[168:171], v3, s[4:7], s21 offen offset:0
  buffer_load_dwordx4 v[172:175], v3, s[4:7], s21 offen offset:1024
  buffer_load_dwordx4 v[176:179], v3, s[4:7], s21 offen offset:2048
  buffer_load_dwordx4 v[180:183], v3, s[4:7], s21 offen offset:3072
  buffer_load_dwordx4 v[184:187], v4, s[4:7], s23 offen offset:0
  buffer_load_dwordx4 v[188:191], v4, s[4:7], s23 offen offset:512
  buffer_load_dwordx4 v[192:195], v4, s[4:7], s23 offen offset:1024
  buffer_load_dwordx4 v[196:199], v4, s[4:7], s23 offen offset:1536
  buffer_load_dwordx4 v[200:203], v4, s[4:7], s23 offen offset:2048
  buffer_load_dwordx4 v[204:207], v4, s[4:7], s23 offen offset:2560
  buffer_load_dwordx4 v[88:91], v1, s[4:7], s20 offen offset:0
  buffer_load_dwordx4 v[92:95], v1, s[4:7], s20 offen offset:1024
  buffer_load_dwordx4 v[96:99], v1, s[4:7], s20 offen offset:2048
  buffer_load_dwordx4 v[100:103], v1, s[4:7], s20 offen offset:3072
  buffer_load_dwordx4 v[104:107], v2, s[4:7], s20 offen offset:0
  buffer_load_dwordx4 v[108:111], v2, s[4:7], s20 offen offset:1024
  buffer_load_dwordx4 v[112:115], v2, s[4:7], s20 offen offset:2048
  buffer_load_dwordx4 v[116:119], v2, s[4:7], s20 offen offset:3072
  buffer_load_dwordx4 v[120:123], v3, s[4:7], s20 offen offset:0
  buffer_load_dwordx4 v[124:127], v3, s[4:7], s20 offen offset:1024
  buffer_load_dwordx4 v[128:131], v3, s[4:7], s20 offen offset:2048
  buffer_load_dwordx4 v[132:135], v3, s[4:7], s20 offen offset:3072
  s_waitcnt vmcnt(5)
  v_mfma_f32_16x16x32_bf16 v[24:27], v[184:187], v[88:91], v[12:15]
  v_mfma_f32_16x16x32_bf16 v[28:31], v[136:139], v[88:91], v[16:19]
  v_mfma_f32_16x16x32_bf16 v[32:35], v[184:187], v[112:115], v[12:15]
  v_mfma_f32_16x16x32_bf16 v[36:39], v[136:139], v[112:115], 0
  v_mfma_f32_16x16x32_bf16 v[40:43], v[160:163], v[112:115], v[16:19]
  s_waitcnt vmcnt(4)
  v_mfma_f32_16x16x32_bf16 v[24:27], v[188:191], v[92:95], v[24:27]
  v_mfma_f32_16x16x32_bf16 v[28:31], v[140:143], v[92:95], v[28:31]
  v_mfma_f32_16x16x32_bf16 v[32:35], v[188:191], v[116:119], v[32:35]
  v_mfma_f32_16x16x32_bf16 v[36:39], v[140:143], v[116:119], v[36:39]
  v_mfma_f32_16x16x32_bf16 v[40:43], v[164:167], v[116:119], v[40:43]
  s_waitcnt vmcnt(3)
  v_mfma_f32_16x16x32_bf16 v[24:27], v[192:195], v[96:99], v[24:27]
  v_mfma_f32_16x16x32_bf16 v[28:31], v[144:147], v[96:99], v[28:31]
  v_mfma_f32_16x16x32_bf16 v[32:35], v[192:195], v[120:123], v[32:35]
  v_mfma_f32_16x16x32_bf16 v[36:39], v[144:147], v[120:123], v[36:39]
  v_mfma_f32_16x16x32_bf16 v[40:43], v[168:171], v[120:123], v[40:43]
  s_waitcnt vmcnt(2)
  v_mfma_f32_16x16x32_bf16 v[24:27], v[196:199], v[100:103], v[24:27]
  v_mfma_f32_16x16x32_bf16 v[28:31], v[148:151], v[100:103], v[28:31]
  v_mfma_f32_16x16x32_bf16 v[32:35], v[196:199], v[124:127], v[32:35]
  v_mfma_f32_16x16x32_bf16 v[36:39], v[148:151], v[124:127], v[36:39]
  v_mfma_f32_16x16x32_bf16 v[40:43], v[172:175], v[124:127], v[40:43]
  s_waitcnt vmcnt(1)
  v_mfma_f32_16x16x32_bf16 v[24:27], v[200:203], v[104:107], v[24:27]
  v_mfma_f32_16x16x32_bf16 v[28:31], v[152:155], v[104:107], v[28:31]
  v_mfma_f32_16x16x32_bf16 v[32:35], v[200:203], v[128:131], v[32:35]
  v_mfma_f32_16x16x32_bf16 v[36:39], v[152:155], v[128:131], v[36:39]
  v_mfma_f32_16x16x32_bf16 v[40:43], v[176:179], v[128:131], v[40:43]
  s_waitcnt vmcnt(0)
  v_mfma_f32_16x16x32_bf16 v[24:27], v[204:207], v[108:111], v[24:27]
  v_mfma_f32_16x16x32_bf16 v[28:31], v[156:159], v[108:111], v[28:31]
  v_mfma_f32_16x16x32_bf16 v[32:35], v[204:207], v[132:135], v[32:35]
  v_mfma_f32_16x16x32_bf16 v[36:39], v[156:159], v[132:135], v[36:39]
  v_mfma_f32_16x16x32_bf16 v[40:43], v[180:183], v[132:135], v[40:43]
  buffer_load_dwordx4 v[88:91], v1, s[4:7], s22 offen offset:0
  buffer_load_dwordx4 v[92:95], v1, s[4:7], s22 offen offset:1024
  buffer_load_dwordx4 v[96:99], v1, s[4:7], s22 offen offset:2048
  buffer_load_dwordx4 v[100:103], v1, s[4:7], s22 offen offset:3072
  buffer_load_dwordx4 v[104:107], v2, s[4:7], s22 offen offset:0
  buffer_load_dwordx4 v[108:111], v2, s[4:7], s22 offen offset:1024
  buffer_load_dwordx4 v[112:115], v2, s[4:7], s22 offen offset:2048
  buffer_load_dwordx4 v[116:119], v2, s[4:7], s22 offen offset:3072
  buffer_load_dwordx4 v[120:123], v3, s[4:7], s22 offen offset:0
  buffer_load_dwordx4 v[124:127], v3, s[4:7], s22 offen offset:1024
  buffer_load_dwordx4 v[128:131], v3, s[4:7], s22 offen offset:2048
  buffer_load_dwordx4 v[132:135], v3, s[4:7], s22 offen offset:3072
  buffer_load_dwordx2 v[136:137], v5, s[4:7], s24 offen offset:0
  buffer_load_dwordx2 v[138:139], v5, s[4:7], s24 offen offset:256
  buffer_load_dwordx2 v[140:141], v5, s[4:7], s24 offen offset:512
  buffer_load_dwordx2 v[142:143], v5, s[4:7], s24 offen offset:768
  buffer_load_dwordx2 v[144:145], v5, s[4:7], s24 offen offset:1024
  buffer_load_dwordx2 v[146:147], v5, s[4:7], s24 offen offset:1280
  buffer_load_dwordx2 v[148:149], v5, s[4:7], s24 offen offset:1536
  buffer_load_dwordx2 v[150:151], v5, s[4:7], s24 offen offset:1792
  buffer_load_dwordx2 v[152:153], v5, s[4:7], s24 offen offset:2048
  buffer_load_dwordx2 v[154:155], v5, s[4:7], s24 offen offset:2304
  buffer_load_dwordx2 v[156:157], v5, s[4:7], s24 offen offset:2560
  buffer_load_dwordx2 v[158:159], v5, s[4:7], s24 offen offset:2816
  v_max3_f32 v6, v24, v25, v26
  v_max3_f32 v6, v6, v27, v28
  v_max3_f32 v6, v6, v29, v30
  v_max_f32 v6, v6, v31
  v_mov_b32 v7, v6
  s_nop 1
  v_permlane32_swap_b32 v6, v7
  v_max_f32 v6, v6, v7
  v_mov_b32 v7, v6
  s_nop 1
  v_permlane16_swap_b32 v6, v7
  v_max_f32 v6, v6, v7
  v_mul_f32 v6, s27, v6
  v_fma_f32 v24, v24, s27, -v6
  v_fma_f32 v25, v25, s27, -v6
  v_fma_f32 v26, v26, s27, -v6
  v_fma_f32 v27, v27, s27, -v6
  v_fma_f32 v28, v28, s27, -v6
  v_fma_f32 v29, v29, s27, -v6
  v_fma_f32 v30, v30, s27, -v6
  v_fma_f32 v31, v31, s27, -v6
  v_exp_f32 v24, v24
  v_exp_f32 v25, v25
  v_exp_f32 v26, v26
  v_exp_f32 v27, v27
  v_exp_f32 v28, v28
  v_exp_f32 v29, v29
  v_exp_f32 v30, v30
  v_exp_f32 v31, v31
  v_max3_f32 v8, v32, v33, v34
  v_max3_f32 v8, v8, v35, v36
  v_max3_f32 v8, v8, v37, v38
  v_max3_f32 v8, v8, v39, v40
  v_max3_f32 v8, v8, v41, v42
  v_max_f32 v8, v8, v43
  v_mov_b32 v10, v8
  s_nop 1
  v_permlane32_swap_b32 v8, v10
  v_max_f32 v8, v8, v10
  v_mov_b32 v10, v8
  s_nop 1
  v_permlane16_swap_b32 v8, v10
  v_max_f32 v8, v8, v10
  v_mul_f32 v8, s27, v8
  v_fma_f32 v32, v32, s27, -v8
  v_fma_f32 v33, v33, s27, -v8
  v_fma_f32 v34, v34, s27, -v8
  v_fma_f32 v35, v35, s27, -v8
  v_fma_f32 v36, v36, s27, -v8
  v_fma_f32 v37, v37, s27, -v8
  v_fma_f32 v38, v38, s27, -v8
  v_fma_f32 v39, v39, s27, -v8
  v_fma_f32 v40, v40, s27, -v8
  v_fma_f32 v41, v41, s27, -v8
  v_fma_f32 v42, v42, s27, -v8
  v_fma_f32 v43, v43, s27, -v8
  v_exp_f32 v32, v32
  v_exp_f32 v33, v33
  v_exp_f32 v34, v34
  v_exp_f32 v35, v35
  v_exp_f32 v36, v36
  v_exp_f32 v37, v37
  v_exp_f32 v38, v38
  v_exp_f32 v39, v39
  v_exp_f32 v40, v40
  v_exp_f32 v41, v41
  v_exp_f32 v42, v42
  v_exp_f32 v43, v43
  v_cvt_pk_bf16_f32 v44, v24, v25
  v_cvt_pk_bf16_f32 v45, v26, v27
  v_cvt_pk_bf16_f32 v46, v28, v29
  v_cvt_pk_bf16_f32 v47, v30, v31
  v_cvt_pk_bf16_f32 v48, v32, v33
  v_cvt_pk_bf16_f32 v49, v34, v35
  v_cvt_pk_bf16_f32 v50, v36, v37
  v_cvt_pk_bf16_f32 v51, v38, v39
  v_cvt_pk_bf16_f32 v52, v40, v41
  v_cvt_pk_bf16_f32 v53, v42, v43
  v_mfma_f32_16x16x16_bf16 v[56:59], v[20:21], v[44:45], 0
  v_mfma_f32_16x16x16_bf16 v[60:63], v[20:21], v[48:49], 0
  v_mfma_f32_16x16x16_bf16 v[56:59], v[20:21], v[46:47], v[56:59]
  v_mfma_f32_16x16x32_bf16 v[60:63], v[20:23], v[50:53], v[60:63]
  s_nop 6
  v_rcp_f32 v10, v56
  v_rcp_f32 v11, v60
  s_waitcnt vmcnt(0)
  buffer_load_dwordx4 a[160:163], v1, s[4:7], s30 offen offset:0
  buffer_load_dwordx4 a[164:167], v1, s[4:7], s31 offen offset:0
  buffer_load_dwordx4 a[168:171], v1, s[4:7], s32 offen offset:0
  buffer_load_dwordx4 a[172:175], v1, s[4:7], s33 offen offset:0
  buffer_load_dwordx4 a[176:179], v1, s[4:7], s34 offen offset:0
  buffer_load_dwordx4 a[180:183], v1, s[4:7], s35 offen offset:0
  buffer_load_dwordx4 a[184:187], v1, s[4:7], s36 offen offset:0
  buffer_load_dwordx4 a[188:191], v1, s[4:7], s37 offen offset:0
  buffer_load_dwordx4 a[192:195], v1, s[4:7], s38 offen offset:0
  buffer_load_dwordx4 a[196:199], v1, s[4:7], s39 offen offset:0
  buffer_load_dwordx4 a[200:203], v1, s[4:7], s30 offen offset:1024
  buffer_load_dwordx4 a[204:207], v1, s[4:7], s31 offen offset:1024
  buffer_load_dwordx4 a[208:211], v1, s[4:7], s32 offen offset:1024
  buffer_load_dwordx4 a[212:215], v1, s[4:7], s33 offen offset:1024
  buffer_load_dwordx4 a[216:219], v1, s[4:7], s34 offen offset:1024
  buffer_load_dwordx4 a[220:223], v1, s[4:7], s35 offen offset:1024
  buffer_load_dwordx4 a[224:227], v1, s[4:7], s36 offen offset:1024
  buffer_load_dwordx4 a[228:231], v1, s[4:7], s37 offen offset:1024
  buffer_load_dwordx4 a[232:235], v1, s[4:7], s38 offen offset:1024
  buffer_load_dwordx4 a[236:239], v1, s[4:7], s39 offen offset:1024
  v_mfma_f32_16x16x16_bf16 v[64:67], v[136:137], v[44:45], 0
  v_mfma_f32_16x16x16_bf16 v[68:71], v[136:137], v[48:49], 0
  v_mfma_f32_16x16x16_bf16 v[64:67], v[88:89], v[46:47], v[64:67]
  v_mfma_f32_16x16x32_bf16 v[68:71], v[88:91], v[50:53], v[68:71]
  v_mfma_f32_16x16x16_bf16 v[72:75], v[138:139], v[44:45], 0
  v_mfma_f32_16x16x16_bf16 v[76:79], v[138:139], v[48:49], 0
  v_mfma_f32_16x16x16_bf16 v[72:75], v[92:93], v[46:47], v[72:75]
  v_mfma_f32_16x16x32_bf16 v[76:79], v[92:95], v[50:53], v[76:79]
  s_nop 2
  v_mul_f32 v64, v64, v10
  v_mul_f32 v65, v65, v10
  v_mul_f32 v66, v66, v10
  v_mul_f32 v67, v67, v10
  v_cvt_pk_bf16_f32 v80, v64, v65
  v_cvt_pk_bf16_f32 v81, v66, v67
  v_mul_f32 v72, v72, v10
  v_mul_f32 v73, v73, v10
  v_mul_f32 v74, v74, v10
  v_mul_f32 v75, v75, v10
  v_cvt_pk_bf16_f32 v82, v72, v73
  v_cvt_pk_bf16_f32 v83, v74, v75
  ds_write_b128 v241, v[80:83] offset:0
  v_mul_f32 v68, v68, v11
  v_mul_f32 v69, v69, v11
  v_mul_f32 v70, v70, v11
  v_mul_f32 v71, v71, v11
  v_cvt_pk_bf16_f32 v84, v68, v69
  v_cvt_pk_bf16_f32 v85, v70, v71
  v_mul_f32 v76, v76, v11
  v_mul_f32 v77, v77, v11
  v_mul_f32 v78, v78, v11
  v_mul_f32 v79, v79, v11
  v_cvt_pk_bf16_f32 v86, v76, v77
  v_cvt_pk_bf16_f32 v87, v78, v79
  ds_write_b128 v241, v[84:87] offset:24576
  v_mfma_f32_16x16x16_bf16 v[64:67], v[140:141], v[44:45], 0
  v_mfma_f32_16x16x16_bf16 v[68:71], v[140:141], v[48:49], 0
  v_mfma_f32_16x16x16_bf16 v[64:67], v[96:97], v[46:47], v[64:67]
  v_mfma_f32_16x16x32_bf16 v[68:71], v[96:99], v[50:53], v[68:71]
  v_mfma_f32_16x16x16_bf16 v[72:75], v[142:143], v[44:45], 0
  v_mfma_f32_16x16x16_bf16 v[76:79], v[142:143], v[48:49], 0
  v_mfma_f32_16x16x16_bf16 v[72:75], v[100:101], v[46:47], v[72:75]
  v_mfma_f32_16x16x32_bf16 v[76:79], v[100:103], v[50:53], v[76:79]
  s_nop 2
  v_mul_f32 v64, v64, v10
  v_mul_f32 v65, v65, v10
  v_mul_f32 v66, v66, v10
  v_mul_f32 v67, v67, v10
  v_cvt_pk_bf16_f32 v80, v64, v65
  v_cvt_pk_bf16_f32 v81, v66, v67
  v_mul_f32 v72, v72, v10
  v_mul_f32 v73, v73, v10
  v_mul_f32 v74, v74, v10
  v_mul_f32 v75, v75, v10
  v_cvt_pk_bf16_f32 v82, v72, v73
  v_cvt_pk_bf16_f32 v83, v74, v75
  ds_write_b128 v241, v[80:83] offset:1024
  v_mul_f32 v68, v68, v11
  v_mul_f32 v69, v69, v11
  v_mul_f32 v70, v70, v11
  v_mul_f32 v71, v71, v11
  v_cvt_pk_bf16_f32 v84, v68, v69
  v_cvt_pk_bf16_f32 v85, v70, v71
  v_mul_f32 v76, v76, v11
  v_mul_f32 v77, v77, v11
  v_mul_f32 v78, v78, v11
  v_mul_f32 v79, v79, v11
  v_cvt_pk_bf16_f32 v86, v76, v77
  v_cvt_pk_bf16_f32 v87, v78, v79
  ds_write_b128 v241, v[84:87] offset:25600
  v_mfma_f32_16x16x16_bf16 v[64:67], v[144:145], v[44:45], 0
  v_mfma_f32_16x16x16_bf16 v[68:71], v[144:145], v[48:49], 0
  v_mfma_f32_16x16x16_bf16 v[64:67], v[104:105], v[46:47], v[64:67]
  v_mfma_f32_16x16x32_bf16 v[68:71], v[104:107], v[50:53], v[68:71]
  v_mfma_f32_16x16x16_bf16 v[72:75], v[146:147], v[44:45], 0
  v_mfma_f32_16x16x16_bf16 v[76:79], v[146:147], v[48:49], 0
  v_mfma_f32_16x16x16_bf16 v[72:75], v[108:109], v[46:47], v[72:75]
  v_mfma_f32_16x16x32_bf16 v[76:79], v[108:111], v[50:53], v[76:79]
  s_nop 2
  v_mul_f32 v64, v64, v10
  v_mul_f32 v65, v65, v10
  v_mul_f32 v66, v66, v10
  v_mul_f32 v67, v67, v10
  v_cvt_pk_bf16_f32 v80, v64, v65
  v_cvt_pk_bf16_f32 v81, v66, v67
  v_mul_f32 v72, v72, v10
  v_mul_f32 v73, v73, v10
  v_mul_f32 v74, v74, v10
  v_mul_f32 v75, v75, v10
  v_cvt_pk_bf16_f32 v82, v72, v73
  v_cvt_pk_bf16_f32 v83, v74, v75
  ds_write_b128 v241, v[80:83] offset:2048
  v_mul_f32 v68, v68, v11
  v_mul_f32 v69, v69, v11
  v_mul_f32 v70, v70, v11
  v_mul_f32 v71, v71, v11
  v_cvt_pk_bf16_f32 v84, v68, v69
  v_cvt_pk_bf16_f32 v85, v70, v71
  v_mul_f32 v76, v76, v11
  v_mul_f32 v77, v77, v11
  v_mul_f32 v78, v78, v11
  v_mul_f32 v79, v79, v11
  v_cvt_pk_bf16_f32 v86, v76, v77
  v_cvt_pk_bf16_f32 v87, v78, v79
  ds_write_b128 v241, v[84:87] offset:26624
  v_mfma_f32_16x16x16_bf16 v[64:67], v[148:149], v[44:45], 0
  v_mfma_f32_16x16x16_bf16 v[68:71], v[148:149], v[48:49], 0
  v_mfma_f32_16x16x16_bf16 v[64:67], v[112:113], v[46:47], v[64:67]
  v_mfma_f32_16x16x32_bf16 v[68:71], v[112:115], v[50:53], v[68:71]
  v_mfma_f32_16x16x16_bf16 v[72:75], v[150:151], v[44:45], 0
  v_mfma_f32_16x16x16_bf16 v[76:79], v[150:151], v[48:49], 0
  v_mfma_f32_16x16x16_bf16 v[72:75], v[116:117], v[46:47], v[72:75]
  v_mfma_f32_16x16x32_bf16 v[76:79], v[116:119], v[50:53], v[76:79]
  s_nop 2
  v_mul_f32 v64, v64, v10
  v_mul_f32 v65, v65, v10
  v_mul_f32 v66, v66, v10
  v_mul_f32 v67, v67, v10
  v_cvt_pk_bf16_f32 v80, v64, v65
  v_cvt_pk_bf16_f32 v81, v66, v67
  v_mul_f32 v72, v72, v10
  v_mul_f32 v73, v73, v10
  v_mul_f32 v74, v74, v10
  v_mul_f32 v75, v75, v10
  v_cvt_pk_bf16_f32 v82, v72, v73
  v_cvt_pk_bf16_f32 v83, v74, v75
  ds_write_b128 v241, v[80:83] offset:3072
  v_mul_f32 v68, v68, v11
  v_mul_f32 v69, v69, v11
  v_mul_f32 v70, v70, v11
  v_mul_f32 v71, v71, v11
  v_cvt_pk_bf16_f32 v84, v68, v69
  v_cvt_pk_bf16_f32 v85, v70, v71
  v_mul_f32 v76, v76, v11
  v_mul_f32 v77, v77, v11
  v_mul_f32 v78, v78, v11
  v_mul_f32 v79, v79, v11
  v_cvt_pk_bf16_f32 v86, v76, v77
  v_cvt_pk_bf16_f32 v87, v78, v79
  ds_write_b128 v241, v[84:87] offset:27648
  v_mfma_f32_16x16x16_bf16 v[64:67], v[152:153], v[44:45], 0
  v_mfma_f32_16x16x16_bf16 v[68:71], v[152:153], v[48:49], 0
  v_mfma_f32_16x16x16_bf16 v[64:67], v[120:121], v[46:47], v[64:67]
  v_mfma_f32_16x16x32_bf16 v[68:71], v[120:123], v[50:53], v[68:71]
  v_mfma_f32_16x16x16_bf16 v[72:75], v[154:155], v[44:45], 0
  v_mfma_f32_16x16x16_bf16 v[76:79], v[154:155], v[48:49], 0
  v_mfma_f32_16x16x16_bf16 v[72:75], v[124:125], v[46:47], v[72:75]
  v_mfma_f32_16x16x32_bf16 v[76:79], v[124:127], v[50:53], v[76:79]
  s_nop 2
  v_mul_f32 v64, v64, v10
  v_mul_f32 v65, v65, v10
  v_mul_f32 v66, v66, v10
  v_mul_f32 v67, v67, v10
  v_cvt_pk_bf16_f32 v80, v64, v65
  v_cvt_pk_bf16_f32 v81, v66, v67
  v_mul_f32 v72, v72, v10
  v_mul_f32 v73, v73, v10
  v_mul_f32 v74, v74, v10
  v_mul_f32 v75, v75, v10
  v_cvt_pk_bf16_f32 v82, v72, v73
  v_cvt_pk_bf16_f32 v83, v74, v75
  ds_write_b128 v241, v[80:83] offset:4096
  v_mul_f32 v68, v68, v11
  v_mul_f32 v69, v69, v11
  v_mul_f32 v70, v70, v11
  v_mul_f32 v71, v71, v11
  v_cvt_pk_bf16_f32 v84, v68, v69
  v_cvt_pk_bf16_f32 v85, v70, v71
  v_mul_f32 v76, v76, v11
  v_mul_f32 v77, v77, v11
  v_mul_f32 v78, v78, v11
  v_mul_f32 v79, v79, v11
  v_cvt_pk_bf16_f32 v86, v76, v77
  v_cvt_pk_bf16_f32 v87, v78, v79
  ds_write_b128 v241, v[84:87] offset:28672
  v_mfma_f32_16x16x16_bf16 v[64:67], v[156:157], v[44:45], 0
  v_mfma_f32_16x16x16_bf16 v[68:71], v[156:157], v[48:49], 0
  v_mfma_f32_16x16x16_bf16 v[64:67], v[128:129], v[46:47], v[64:67]
  v_mfma_f32_16x16x32_bf16 v[68:71], v[128:131], v[50:53], v[68:71]
  v_mfma_f32_16x16x16_bf16 v[72:75], v[158:159], v[44:45], 0
  v_mfma_f32_16x16x16_bf16 v[76:79], v[158:159], v[48:49], 0
  v_mfma_f32_16x16x16_bf16 v[72:75], v[132:133], v[46:47], v[72:75]
  v_mfma_f32_16x16x32_bf16 v[76:79], v[132:135], v[50:53], v[76:79]
  s_nop 2
  v_mul_f32 v64, v64, v10
  v_mul_f32 v65, v65, v10
  v_mul_f32 v66, v66, v10
  v_mul_f32 v67, v67, v10
  v_cvt_pk_bf16_f32 v80, v64, v65
  v_cvt_pk_bf16_f32 v81, v66, v67
  v_mul_f32 v72, v72, v10
  v_mul_f32 v73, v73, v10
  v_mul_f32 v74, v74, v10
  v_mul_f32 v75, v75, v10
  v_cvt_pk_bf16_f32 v82, v72, v73
  v_cvt_pk_bf16_f32 v83, v74, v75
  ds_write_b128 v241, v[80:83] offset:5120
  v_mul_f32 v68, v68, v11
  v_mul_f32 v69, v69, v11
  v_mul_f32 v70, v70, v11
  v_mul_f32 v71, v71, v11
  v_cvt_pk_bf16_f32 v84, v68, v69
  v_cvt_pk_bf16_f32 v85, v70, v71
  v_mul_f32 v76, v76, v11
  v_mul_f32 v77, v77, v11
  v_mul_f32 v78, v78, v11
  v_mul_f32 v79, v79, v11
  v_cvt_pk_bf16_f32 v86, v76, v77
  v_cvt_pk_bf16_f32 v87, v78, v79
  ds_write_b128 v241, v[84:87] offset:29696
  s_waitcnt lgkmcnt(0)
  buffer_load_dwordx4 v[104:107], v1, s[4:7], s30 offen offset:2048
  buffer_load_dwordx4 v[108:111], v1, s[4:7], s31 offen offset:2048
  buffer_load_dwordx4 v[112:115], v1, s[4:7], s32 offen offset:2048
  buffer_load_dwordx4 v[116:119], v1, s[4:7], s33 offen offset:2048
  buffer_load_dwordx4 v[120:123], v1, s[4:7], s34 offen offset:2048
  buffer_load_dwordx4 v[124:127], v1, s[4:7], s35 offen offset:2048
  buffer_load_dwordx4 v[128:131], v1, s[4:7], s36 offen offset:2048
  buffer_load_dwordx4 v[132:135], v1, s[4:7], s37 offen offset:2048
  buffer_load_dwordx4 v[136:139], v1, s[4:7], s38 offen offset:2048
  buffer_load_dwordx4 v[140:143], v1, s[4:7], s39 offen offset:2048
  buffer_load_dwordx4 v[144:147], v1, s[4:7], s30 offen offset:3072
  buffer_load_dwordx4 v[148:151], v1, s[4:7], s31 offen offset:3072
  buffer_load_dwordx4 v[152:155], v1, s[4:7], s32 offen offset:3072
  buffer_load_dwordx4 v[156:159], v1, s[4:7], s33 offen offset:3072
  buffer_load_dwordx4 v[160:163], v1, s[4:7], s34 offen offset:3072
  buffer_load_dwordx4 v[164:167], v1, s[4:7], s35 offen offset:3072
  buffer_load_dwordx4 v[168:171], v1, s[4:7], s36 offen offset:3072
  buffer_load_dwordx4 v[172:175], v1, s[4:7], s37 offen offset:3072
  buffer_load_dwordx4 v[176:179], v1, s[4:7], s38 offen offset:3072
  buffer_load_dwordx4 v[180:183], v1, s[4:7], s39 offen offset:3072
  s_add_u32 s30, s30, 4096
  s_add_u32 s31, s31, 4096
  s_add_u32 s32, s32, 4096
  s_add_u32 s33, s33, 4096
  s_add_u32 s34, s34, 4096
  s_add_u32 s35, s35, 4096
  s_add_u32 s36, s36, 4096
  s_add_u32 s37, s37, 4096
  s_add_u32 s38, s38, 4096
  s_add_u32 s39, s39, 4096
  v_add_u32 v6, 49152, v1
  s_barrier
  ds_read_b128 v[184:187], v1 offset:0
  ds_read_b128 v[188:191], v1 offset:24576
  ds_read_b128 v[192:195], v6 offset:0
  ds_read_b128 v[196:199], v6 offset:24576
  s_waitcnt vmcnt(30)
  ds_read_b128 v[200:203], v1 offset:1024
  ds_read_b128 v[204:207], v1 offset:25600
  ds_read_b128 v[208:211], v6 offset:1024
  ds_read_b128 v[212:215], v6 offset:25600
  s_waitcnt lgkmcnt(4)
  v_mfma_f32_16x16x32_bf16 a[0:3], a[160:163], v[184:187], 0
  v_mfma_f32_16x16x32_bf16 a[4:7], a[160:163], v[188:191], 0
  v_mfma_f32_16x16x32_bf16 a[8:11], a[160:163], v[192:195], 0
  v_mfma_f32_16x16x32_bf16 a[12:15], a[160:163], v[196:199], 0
  v_mfma_f32_16x16x32_bf16 a[16:19], a[164:167], v[184:187], 0
  v_mfma_f32_16x16x32_bf16 a[20:23], a[164:167], v[188:191], 0
  v_mfma_f32_16x16x32_bf16 a[24:27], a[164:167], v[192:195], 0
  v_mfma_f32_16x16x32_bf16 a[28:31], a[164:167], v[196:199], 0
  v_mfma_f32_16x16x32_bf16 a[32:35], a[168:171], v[184:187], 0
  v_mfma_f32_16x16x32_bf16 a[36:39], a[168:171], v[188:191], 0
  v_mfma_f32_16x16x32_bf16 a[40:43], a[168:171], v[192:195], 0
  v_mfma_f32_16x16x32_bf16 a[44:47], a[168:171], v[196:199], 0
  v_mfma_f32_16x16x32_bf16 a[48:51], a[172:175], v[184:187], 0
  v_mfma_f32_16x16x32_bf16 a[52:55], a[172:175], v[188:191], 0
  v_mfma_f32_16x16x32_bf16 a[56:59], a[172:175], v[192:195], 0
  v_mfma_f32_16x16x32_bf16 a[60:63], a[172:175], v[196:199], 0
  v_mfma_f32_16x16x32_bf16 a[64:67], a[176:179], v[184:187], 0
  v_mfma_f32_16x16x32_bf16 a[68:71], a[176:179], v[188:191], 0
  v_mfma_f32_16x16x32_bf16 a[72:75], a[176:179], v[192:195], 0
  v_mfma_f32_16x16x32_bf16 a[76:79], a[176:179], v[196:199], 0
  v_mfma_f32_16x16x32_bf16 a[80:83], a[180:183], v[184:187], 0
  v_mfma_f32_16x16x32_bf16 a[84:87], a[180:183], v[188:191], 0
  v_mfma_f32_16x16x32_bf16 a[88:91], a[180:183], v[192:195], 0
  v_mfma_f32_16x16x32_bf16 a[92:95], a[180:183], v[196:199], 0
  v_mfma_f32_16x16x32_bf16 a[96:99], a[184:187], v[184:187], 0
  v_mfma_f32_16x16x32_bf16 a[100:103], a[184:187], v[188:191], 0
  v_mfma_f32_16x16x32_bf16 a[104:107], a[184:187], v[192:195], 0
  v_mfma_f32_16x16x32_bf16 a[108:111], a[184:187], v[196:199], 0
  v_mfma_f32_16x16x32_bf16 a[112:115], a[188:191], v[184:187], 0
  v_mfma_f32_16x16x32_bf16 a[116:119], a[188:191], v[188:191], 0
  v_mfma_f32_16x16x32_bf16 a[120:123], a[188:191], v[192:195], 0
  v_mfma_f32_16x16x32_bf16 a[124:127], a[188:191], v[196:199], 0
  v_mfma_f32_16x16x32_bf16 a[128:131], a[192:195], v[184:187], 0
  v_mfma_f32_16x16x32_bf16 a[132:135], a[192:195], v[188:191], 0
  v_mfma_f32_16x16x32_bf16 a[136:139], a[192:195], v[192:195], 0
  v_mfma_f32_16x16x32_bf16 a[140:143], a[192:195], v[196:199], 0
  v_mfma_f32_16x16x32_bf16 a[144:147], a[196:199], v[184:187], 0
  v_mfma_f32_16x16x32_bf16 a[148:151], a[196:199], v[188:191], 0
  v_mfma_f32_16x16x32_bf16 a[152:155], a[196:199], v[192:195], 0
  v_mfma_f32_16x16x32_bf16 a[156:159], a[196:199], v[196:199], 0
  buffer_load_dwordx4 v[24:27], v1, s[4:7], s30 offen offset:0
  buffer_load_dwordx4 v[28:31], v1, s[4:7], s31 offen offset:0
  buffer_load_dwordx4 v[32:35], v1, s[4:7], s32 offen offset:0
  buffer_load_dwordx4 v[36:39], v1, s[4:7], s33 offen offset:0
  buffer_load_dwordx4 v[40:43], v1, s[4:7], s34 offen offset:0
  buffer_load_dwordx4 v[44:47], v1, s[4:7], s35 offen offset:0
  buffer_load_dwordx4 v[48:51], v1, s[4:7], s36 offen offset:0
  buffer_load_dwordx4 v[52:55], v1, s[4:7], s37 offen offset:0
  buffer_load_dwordx4 v[56:59], v1, s[4:7], s38 offen offset:0
  buffer_load_dwordx4 v[60:63], v1, s[4:7], s39 offen offset:0
  s_waitcnt vmcnt(30)
  ds_read_b128 v[184:187], v1 offset:2048
  ds_read_b128 v[188:191], v1 offset:26624
  ds_read_b128 v[192:195], v6 offset:2048
  ds_read_b128 v[196:199], v6 offset:26624
  s_waitcnt lgkmcnt(4)
  v_mfma_f32_16x16x32_bf16 a[0:3], a[200:203], v[200:203], a[0:3]
  v_mfma_f32_16x16x32_bf16 a[4:7], a[200:203], v[204:207], a[4:7]
  v_mfma_f32_16x16x32_bf16 a[8:11], a[200:203], v[208:211], a[8:11]
  v_mfma_f32_16x16x32_bf16 a[12:15], a[200:203], v[212:215], a[12:15]
  v_mfma_f32_16x16x32_bf16 a[16:19], a[204:207], v[200:203], a[16:19]
  v_mfma_f32_16x16x32_bf16 a[20:23], a[204:207], v[204:207], a[20:23]
  v_mfma_f32_16x16x32_bf16 a[24:27], a[204:207], v[208:211], a[24:27]
  v_mfma_f32_16x16x32_bf16 a[28:31], a[204:207], v[212:215], a[28:31]
  v_mfma_f32_16x16x32_bf16 a[32:35], a[208:211], v[200:203], a[32:35]
  v_mfma_f32_16x16x32_bf16 a[36:39], a[208:211], v[204:207], a[36:39]
  v_mfma_f32_16x16x32_bf16 a[40:43], a[208:211], v[208:211], a[40:43]
  v_mfma_f32_16x16x32_bf16 a[44:47], a[208:211], v[212:215], a[44:47]
  v_mfma_f32_16x16x32_bf16 a[48:51], a[212:215], v[200:203], a[48:51]
  v_mfma_f32_16x16x32_bf16 a[52:55], a[212:215], v[204:207], a[52:55]
  v_mfma_f32_16x16x32_bf16 a[56:59], a[212:215], v[208:211], a[56:59]
  v_mfma_f32_16x16x32_bf16 a[60:63], a[212:215], v[212:215], a[60:63]
  v_mfma_f32_16x16x32_bf16 a[64:67], a[216:219], v[200:203], a[64:67]
  v_mfma_f32_16x16x32_bf16 a[68:71], a[216:219], v[204:207], a[68:71]
  v_mfma_f32_16x16x32_bf16 a[72:75], a[216:219], v[208:211], a[72:75]
  v_mfma_f32_16x16x32_bf16 a[76:79], a[216:219], v[212:215], a[76:79]
  v_mfma_f32_16x16x32_bf16 a[80:83], a[220:223], v[200:203], a[80:83]
  v_mfma_f32_16x16x32_bf16 a[84:87], a[220:223], v[204:207], a[84:87]
  v_mfma_f32_16x16x32_bf16 a[88:91], a[220:223], v[208:211], a[88:91]
  v_mfma_f32_16x16x32_bf16 a[92:95], a[220:223], v[212:215], a[92:95]
  v_mfma_f32_16x16x32_bf16 a[96:99], a[224:227], v[200:203], a[96:99]
  v_mfma_f32_16x16x32_bf16 a[100:103], a[224:227], v[204:207], a[100:103]
  v_mfma_f32_16x16x32_bf16 a[104:107], a[224:227], v[208:211], a[104:107]
  v_mfma_f32_16x16x32_bf16 a[108:111], a[224:227], v[212:215], a[108:111]
  v_mfma_f32_16x16x32_bf16 a[112:115], a[228:231], v[200:203], a[112:115]
  v_mfma_f32_16x16x32_bf16 a[116:119], a[228:231], v[204:207], a[116:119]
  v_mfma_f32_16x16x32_bf16 a[120:123], a[228:231], v[208:211], a[120:123]
  v_mfma_f32_16x16x32_bf16 a[124:127], a[228:231], v[212:215], a[124:127]
  v_mfma_f32_16x16x32_bf16 a[128:131], a[232:235], v[200:203], a[128:131]
  v_mfma_f32_16x16x32_bf16 a[132:135], a[232:235], v[204:207], a[132:135]
  v_mfma_f32_16x16x32_bf16 a[136:139], a[232:235], v[208:211], a[136:139]
  v_mfma_f32_16x16x32_bf16 a[140:143], a[232:235], v[212:215], a[140:143]
  v_mfma_f32_16x16x32_bf16 a[144:147], a[236:239], v[200:203], a[144:147]
  v_mfma_f32_16x16x32_bf16 a[148:151], a[236:239], v[204:207], a[148:151]
  v_mfma_f32_16x16x32_bf16 a[152:155], a[236:239], v[208:211], a[152:155]
  v_mfma_f32_16x16x32_bf16 a[156:159], a[236:239], v[212:215], a[156:159]
  buffer_load_dwordx4 v[64:67], v1, s[4:7], s30 offen offset:1024
  buffer_load_dwordx4 v[68:71], v1, s[4:7], s31 offen offset:1024
  buffer_load_dwordx4 v[72:75], v1, s[4:7], s32 offen offset:1024
  buffer_load_dwordx4 v[76:79], v1, s[4:7], s33 offen offset:1024
  buffer_load_dwordx4 v[80:83], v1, s[4:7], s34 offen offset:1024
  buffer_load_dwordx4 v[84:87], v1, s[4:7], s35 offen offset:1024
  buffer_load_dwordx4 v[88:91], v1, s[4:7], s36 offen offset:1024
  buffer_load_dwordx4 v[92:95], v1, s[4:7], s37 offen offset:1024
  buffer_load_dwordx4 v[96:99], v1, s[4:7], s38 offen offset:1024
  buffer_load_dwordx4 v[100:103], v1, s[4:7], s39 offen offset:1024
  s_waitcnt vmcnt(30)
  ds_read_b128 v[200:203], v1 offset:3072
  ds_read_b128 v[204:207], v1 offset:27648
  ds_read_b128 v[208:211], v6 offset:3072
  ds_read_b128 v[212:215], v6 offset:27648
  s_waitcnt lgkmcnt(4)
  v_mfma_f32_16x16x32_bf16 a[0:3], v[104:107], v[184:187], a[0:3]
  v_mfma_f32_16x16x32_bf16 a[4:7], v[104:107], v[188:191], a[4:7]
  v_mfma_f32_16x16x32_bf16 a[8:11], v[104:107], v[192:195], a[8:11]
  v_mfma_f32_16x16x32_bf16 a[12:15], v[104:107], v[196:199], a[12:15]
  v_mfma_f32_16x16x32_bf16 a[16:19], v[108:111], v[184:187], a[16:19]
  v_mfma_f32_16x16x32_bf16 a[20:23], v[108:111], v[188:191], a[20:23]
  v_mfma_f32_16x16x32_bf16 a[24:27], v[108:111], v[192:195], a[24:27]
  v_mfma_f32_16x16x32_bf16 a[28:31], v[108:111], v[196:199], a[28:31]
  v_mfma_f32_16x16x32_bf16 a[32:35], v[112:115], v[184:187], a[32:35]
  v_mfma_f32_16x16x32_bf16 a[36:39], v[112:115], v[188:191], a[36:39]
  v_mfma_f32_16x16x32_bf16 a[40:43], v[112:115], v[192:195], a[40:43]
  v_mfma_f32_16x16x32_bf16 a[44:47], v[112:115], v[196:199], a[44:47]
  v_mfma_f32_16x16x32_bf16 a[48:51], v[116:119], v[184:187], a[48:51]
  v_mfma_f32_16x16x32_bf16 a[52:55], v[116:119], v[188:191], a[52:55]
  v_mfma_f32_16x16x32_bf16 a[56:59], v[116:119], v[192:195], a[56:59]
  v_mfma_f32_16x16x32_bf16 a[60:63], v[116:119], v[196:199], a[60:63]
  v_mfma_f32_16x16x32_bf16 a[64:67], v[120:123], v[184:187], a[64:67]
  v_mfma_f32_16x16x32_bf16 a[68:71], v[120:123], v[188:191], a[68:71]
  v_mfma_f32_16x16x32_bf16 a[72:75], v[120:123], v[192:195], a[72:75]
  v_mfma_f32_16x16x32_bf16 a[76:79], v[120:123], v[196:199], a[76:79]
  v_mfma_f32_16x16x32_bf16 a[80:83], v[124:127], v[184:187], a[80:83]
  v_mfma_f32_16x16x32_bf16 a[84:87], v[124:127], v[188:191], a[84:87]
  v_mfma_f32_16x16x32_bf16 a[88:91], v[124:127], v[192:195], a[88:91]
  v_mfma_f32_16x16x32_bf16 a[92:95], v[124:127], v[196:199], a[92:95]
  v_mfma_f32_16x16x32_bf16 a[96:99], v[128:131], v[184:187], a[96:99]
  v_mfma_f32_16x16x32_bf16 a[100:103], v[128:131], v[188:191], a[100:103]
  v_mfma_f32_16x16x32_bf16 a[104:107], v[128:131], v[192:195], a[104:107]
  v_mfma_f32_16x16x32_bf16 a[108:111], v[128:131], v[196:199], a[108:111]
  v_mfma_f32_16x16x32_bf16 a[112:115], v[132:135], v[184:187], a[112:115]
  v_mfma_f32_16x16x32_bf16 a[116:119], v[132:135], v[188:191], a[116:119]
  v_mfma_f32_16x16x32_bf16 a[120:123], v[132:135], v[192:195], a[120:123]
  v_mfma_f32_16x16x32_bf16 a[124:127], v[132:135], v[196:199], a[124:127]
  v_mfma_f32_16x16x32_bf16 a[128:131], v[136:139], v[184:187], a[128:131]
  v_mfma_f32_16x16x32_bf16 a[132:135], v[136:139], v[188:191], a[132:135]
  v_mfma_f32_16x16x32_bf16 a[136:139], v[136:139], v[192:195], a[136:139]
  v_mfma_f32_16x16x32_bf16 a[140:143], v[136:139], v[196:199], a[140:143]
  v_mfma_f32_16x16x32_bf16 a[144:147], v[140:143], v[184:187], a[144:147]
  v_mfma_f32_16x16x32_bf16 a[148:151], v[140:143], v[188:191], a[148:151]
  v_mfma_f32_16x16x32_bf16 a[152:155], v[140:143], v[192:195], a[152:155]
  v_mfma_f32_16x16x32_bf16 a[156:159], v[140:143], v[196:199], a[156:159]
  buffer_load_dwordx4 v[104:107], v1, s[4:7], s30 offen offset:2048
  buffer_load_dwordx4 v[108:111], v1, s[4:7], s31 offen offset:2048
  buffer_load_dwordx4 v[112:115], v1, s[4:7], s32 offen offset:2048
  buffer_load_dwordx4 v[116:119], v1, s[4:7], s33 offen offset:2048
  buffer_load_dwordx4 v[120:123], v1, s[4:7], s34 offen offset:2048
  buffer_load_dwordx4 v[124:127], v1, s[4:7], s35 offen offset:2048
  buffer_load_dwordx4 v[128:131], v1, s[4:7], s36 offen offset:2048
  buffer_load_dwordx4 v[132:135], v1, s[4:7], s37 offen offset:2048
  buffer_load_dwordx4 v[136:139], v1, s[4:7], s38 offen offset:2048
  buffer_load_dwordx4 v[140:143], v1, s[4:7], s39 offen offset:2048
  s_waitcnt vmcnt(30)
  ds_read_b128 v[184:187], v1 offset:4096
  ds_read_b128 v[188:191], v1 offset:28672
  ds_read_b128 v[192:195], v6 offset:4096
  ds_read_b128 v[196:199], v6 offset:28672
  s_waitcnt lgkmcnt(4)
  v_mfma_f32_16x16x32_bf16 a[0:3], v[144:147], v[200:203], a[0:3]
  v_mfma_f32_16x16x32_bf16 a[4:7], v[144:147], v[204:207], a[4:7]
  v_mfma_f32_16x16x32_bf16 a[8:11], v[144:147], v[208:211], a[8:11]
  v_mfma_f32_16x16x32_bf16 a[12:15], v[144:147], v[212:215], a[12:15]
  v_mfma_f32_16x16x32_bf16 a[16:19], v[148:151], v[200:203], a[16:19]
  v_mfma_f32_16x16x32_bf16 a[20:23], v[148:151], v[204:207], a[20:23]
  v_mfma_f32_16x16x32_bf16 a[24:27], v[148:151], v[208:211], a[24:27]
  v_mfma_f32_16x16x32_bf16 a[28:31], v[148:151], v[212:215], a[28:31]
  v_mfma_f32_16x16x32_bf16 a[32:35], v[152:155], v[200:203], a[32:35]
  v_mfma_f32_16x16x32_bf16 a[36:39], v[152:155], v[204:207], a[36:39]
  v_mfma_f32_16x16x32_bf16 a[40:43], v[152:155], v[208:211], a[40:43]
  v_mfma_f32_16x16x32_bf16 a[44:47], v[152:155], v[212:215], a[44:47]
  v_mfma_f32_16x16x32_bf16 a[48:51], v[156:159], v[200:203], a[48:51]
  v_mfma_f32_16x16x32_bf16 a[52:55], v[156:159], v[204:207], a[52:55]
  v_mfma_f32_16x16x32_bf16 a[56:59], v[156:159], v[208:211], a[56:59]
  v_mfma_f32_16x16x32_bf16 a[60:63], v[156:159], v[212:215], a[60:63]
  v_mfma_f32_16x16x32_bf16 a[64:67], v[160:163], v[200:203], a[64:67]
  v_mfma_f32_16x16x32_bf16 a[68:71], v[160:163], v[204:207], a[68:71]
  v_mfma_f32_16x16x32_bf16 a[72:75], v[160:163], v[208:211], a[72:75]
  v_mfma_f32_16x16x32_bf16 a[76:79], v[160:163], v[212:215], a[76:79]
  v_mfma_f32_16x16x32_bf16 a[80:83], v[164:167], v[200:203], a[80:83]
  v_mfma_f32_16x16x32_bf16 a[84:87], v[164:167], v[204:207], a[84:87]
  v_mfma_f32_16x16x32_bf16 a[88:91], v[164:167], v[208:211], a[88:91]
  v_mfma_f32_16x16x32_bf16 a[92:95], v[164:167], v[212:215], a[92:95]
  v_mfma_f32_16x16x32_bf16 a[96:99], v[168:171], v[200:203], a[96:99]
  v_mfma_f32_16x16x32_bf16 a[100:103], v[168:171], v[204:207], a[100:103]
  v_mfma_f32_16x16x32_bf16 a[104:107], v[168:171], v[208:211], a[104:107]
  v_mfma_f32_16x16x32_bf16 a[108:111], v[168:171], v[212:215], a[108:111]
  v_mfma_f32_16x16x32_bf16 a[112:115], v[172:175], v[200:203], a[112:115]
  v_mfma_f32_16x16x32_bf16 a[116:119], v[172:175], v[204:207], a[116:119]
  v_mfma_f32_16x16x32_bf16 a[120:123], v[172:175], v[208:211], a[120:123]
  v_mfma_f32_16x16x32_bf16 a[124:127], v[172:175], v[212:215], a[124:127]
  v_mfma_f32_16x16x32_bf16 a[128:131], v[176:179], v[200:203], a[128:131]
  v_mfma_f32_16x16x32_bf16 a[132:135], v[176:179], v[204:207], a[132:135]
  v_mfma_f32_16x16x32_bf16 a[136:139], v[176:179], v[208:211], a[136:139]
  v_mfma_f32_16x16x32_bf16 a[140:143], v[176:179], v[212:215], a[140:143]
  v_mfma_f32_16x16x32_bf16 a[144:147], v[180:183], v[200:203], a[144:147]
  v_mfma_f32_16x16x32_bf16 a[148:151], v[180:183], v[204:207], a[148:151]
  v_mfma_f32_16x16x32_bf16 a[152:155], v[180:183], v[208:211], a[152:155]
  v_mfma_f32_16x16x32_bf16 a[156:159], v[180:183], v[212:215], a[156:159]
  buffer_load_dwordx4 v[144:147], v1, s[4:7], s30 offen offset:3072
  buffer_load_dwordx4 v[148:151], v1, s[4:7], s31 offen offset:3072
  buffer_load_dwordx4 v[152:155], v1, s[4:7], s32 offen offset:3072
  buffer_load_dwordx4 v[156:159], v1, s[4:7], s33 offen offset:3072
  buffer_load_dwordx4 v[160:163], v1, s[4:7], s34 offen offset:3072
  buffer_load_dwordx4 v[164:167], v1, s[4:7], s35 offen offset:3072
  buffer_load_dwordx4 v[168:171], v1, s[4:7], s36 offen offset:3072
  buffer_load_dwordx4 v[172:175], v1, s[4:7], s37 offen offset:3072
  buffer_load_dwordx4 v[176:179], v1, s[4:7], s38 offen offset:3072
  buffer_load_dwordx4 v[180:183], v1, s[4:7], s39 offen offset:3072
  s_add_u32 s30, s30, 4096
  s_add_u32 s31, s31, 4096
  s_add_u32 s32, s32, 4096
  s_add_u32 s33, s33, 4096
  s_add_u32 s34, s34, 4096
  s_add_u32 s35, s35, 4096
  s_add_u32 s36, s36, 4096
  s_add_u32 s37, s37, 4096
  s_add_u32 s38, s38, 4096
  s_add_u32 s39, s39, 4096
  s_waitcnt vmcnt(30)
  ds_read_b128 v[200:203], v1 offset:5120
  ds_read_b128 v[204:207], v1 offset:29696
  ds_read_b128 v[208:211], v6 offset:5120
  ds_read_b128 v[212:215], v6 offset:29696
  s_waitcnt lgkmcnt(4)
  v_mfma_f32_16x16x32_bf16 a[0:3], v[24:27], v[184:187], a[0:3]
  v_mfma_f32_16x16x32_bf16 a[4:7], v[24:27], v[188:191], a[4:7]
  v_mfma_f32_16x16x32_bf16 a[8:11], v[24:27], v[192:195], a[8:11]
  v_mfma_f32_16x16x32_bf16 a[12:15], v[24:27], v[196:199], a[12:15]
  v_mfma_f32_16x16x32_bf16 a[16:19], v[28:31], v[184:187], a[16:19]
  v_mfma_f32_16x16x32_bf16 a[20:23], v[28:31], v[188:191], a[20:23]
  v_mfma_f32_16x16x32_bf16 a[24:27], v[28:31], v[192:195], a[24:27]
  v_mfma_f32_16x16x32_bf16 a[28:31], v[28:31], v[196:199], a[28:31]
  v_mfma_f32_16x16x32_bf16 a[32:35], v[32:35], v[184:187], a[32:35]
  v_mfma_f32_16x16x32_bf16 a[36:39], v[32:35], v[188:191], a[36:39]
  v_mfma_f32_16x16x32_bf16 a[40:43], v[32:35], v[192:195], a[40:43]
  v_mfma_f32_16x16x32_bf16 a[44:47], v[32:35], v[196:199], a[44:47]
  v_mfma_f32_16x16x32_bf16 a[48:51], v[36:39], v[184:187], a[48:51]
  v_mfma_f32_16x16x32_bf16 a[52:55], v[36:39], v[188:191], a[52:55]
  v_mfma_f32_16x16x32_bf16 a[56:59], v[36:39], v[192:195], a[56:59]
  v_mfma_f32_16x16x32_bf16 a[60:63], v[36:39], v[196:199], a[60:63]
  v_mfma_f32_16x16x32_bf16 a[64:67], v[40:43], v[184:187], a[64:67]
  v_mfma_f32_16x16x32_bf16 a[68:71], v[40:43], v[188:191], a[68:71]
  v_mfma_f32_16x16x32_bf16 a[72:75], v[40:43], v[192:195], a[72:75]
  v_mfma_f32_16x16x32_bf16 a[76:79], v[40:43], v[196:199], a[76:79]
  v_mfma_f32_16x16x32_bf16 a[80:83], v[44:47], v[184:187], a[80:83]
  v_mfma_f32_16x16x32_bf16 a[84:87], v[44:47], v[188:191], a[84:87]
  v_mfma_f32_16x16x32_bf16 a[88:91], v[44:47], v[192:195], a[88:91]
  v_mfma_f32_16x16x32_bf16 a[92:95], v[44:47], v[196:199], a[92:95]
  v_mfma_f32_16x16x32_bf16 a[96:99], v[48:51], v[184:187], a[96:99]
  v_mfma_f32_16x16x32_bf16 a[100:103], v[48:51], v[188:191], a[100:103]
  v_mfma_f32_16x16x32_bf16 a[104:107], v[48:51], v[192:195], a[104:107]
  v_mfma_f32_16x16x32_bf16 a[108:111], v[48:51], v[196:199], a[108:111]
  v_mfma_f32_16x16x32_bf16 a[112:115], v[52:55], v[184:187], a[112:115]
  v_mfma_f32_16x16x32_bf16 a[116:119], v[52:55], v[188:191], a[116:119]
  v_mfma_f32_16x16x32_bf16 a[120:123], v[52:55], v[192:195], a[120:123]
  v_mfma_f32_16x16x32_bf16 a[124:127], v[52:55], v[196:199], a[124:127]
  v_mfma_f32_16x16x32_bf16 a[128:131], v[56:59], v[184:187], a[128:131]
  v_mfma_f32_16x16x32_bf16 a[132:135], v[56:59], v[188:191], a[132:135]
  v_mfma_f32_16x16x32_bf16 a[136:139], v[56:59], v[192:195], a[136:139]
  v_mfma_f32_16x16x32_bf16 a[140:143], v[56:59], v[196:199], a[140:143]
  v_mfma_f32_16x16x32_bf16 a[144:147], v[60:63], v[184:187], a[144:147]
  v_mfma_f32_16x16x32_bf16 a[148:151], v[60:63], v[188:191], a[148:151]
  v_mfma_f32_16x16x32_bf16 a[152:155], v[60:63], v[192:195], a[152:155]
  v_mfma_f32_16x16x32_bf16 a[156:159], v[60:63], v[196:199], a[156:159]
  buffer_load_dwordx4 v[24:27], v1, s[4:7], s30 offen offset:0
  buffer_load_dwordx4 v[28:31], v1, s[4:7], s31 offen offset:0
  buffer_load_dwordx4 v[32:35], v1, s[4:7], s32 offen offset:0
  buffer_load_dwordx4 v[36:39], v1, s[4:7], s33 offen offset:0
  buffer_load_dwordx4 v[40:43], v1, s[4:7], s34 offen offset:0
  buffer_load_dwordx4 v[44:47], v1, s[4:7], s35 offen offset:0
  buffer_load_dwordx4 v[48:51], v1, s[4:7], s36 offen offset:0
  buffer_load_dwordx4 v[52:55], v1, s[4:7], s37 offen offset:0
  buffer_load_dwordx4 v[56:59], v1, s[4:7], s38 offen offset:0
  buffer_load_dwordx4 v[60:63], v1, s[4:7], s39 offen offset:0
  s_waitcnt vmcnt(30)
  ds_read_b128 v[184:187], v1 offset:6144
  ds_read_b128 v[188:191], v1 offset:30720
  ds_read_b128 v[192:195], v6 offset:6144
  ds_read_b128 v[196:199], v6 offset:30720
  s_waitcnt lgkmcnt(4)
  v_mfma_f32_16x16x32_bf16 a[0:3], v[64:67], v[200:203], a[0:3]
  v_mfma_f32_16x16x32_bf16 a[4:7], v[64:67], v[204:207], a[4:7]
  v_mfma_f32_16x16x32_bf16 a[8:11], v[64:67], v[208:211], a[8:11]
  v_mfma_f32_16x16x32_bf16 a[12:15], v[64:67], v[212:215], a[12:15]
  v_mfma_f32_16x16x32_bf16 a[16:19], v[68:71], v[200:203], a[16:19]
  v_mfma_f32_16x16x32_bf16 a[20:23], v[68:71], v[204:207], a[20:23]
  v_mfma_f32_16x16x32_bf16 a[24:27], v[68:71], v[208:211], a[24:27]
  v_mfma_f32_16x16x32_bf16 a[28:31], v[68:71], v[212:215], a[28:31]
  v_mfma_f32_16x16x32_bf16 a[32:35], v[72:75], v[200:203], a[32:35]
  v_mfma_f32_16x16x32_bf16 a[36:39], v[72:75], v[204:207], a[36:39]
  v_mfma_f32_16x16x32_bf16 a[40:43], v[72:75], v[208:211], a[40:43]
  v_mfma_f32_16x16x32_bf16 a[44:47], v[72:75], v[212:215], a[44:47]
  v_mfma_f32_16x16x32_bf16 a[48:51], v[76:79], v[200:203], a[48:51]
  v_mfma_f32_16x16x32_bf16 a[52:55], v[76:79], v[204:207], a[52:55]
  v_mfma_f32_16x16x32_bf16 a[56:59], v[76:79], v[208:211], a[56:59]
  v_mfma_f32_16x16x32_bf16 a[60:63], v[76:79], v[212:215], a[60:63]
  v_mfma_f32_16x16x32_bf16 a[64:67], v[80:83], v[200:203], a[64:67]
  v_mfma_f32_16x16x32_bf16 a[68:71], v[80:83], v[204:207], a[68:71]
  v_mfma_f32_16x16x32_bf16 a[72:75], v[80:83], v[208:211], a[72:75]
  v_mfma_f32_16x16x32_bf16 a[76:79], v[80:83], v[212:215], a[76:79]
  v_mfma_f32_16x16x32_bf16 a[80:83], v[84:87], v[200:203], a[80:83]
  v_mfma_f32_16x16x32_bf16 a[84:87], v[84:87], v[204:207], a[84:87]
  v_mfma_f32_16x16x32_bf16 a[88:91], v[84:87], v[208:211], a[88:91]
  v_mfma_f32_16x16x32_bf16 a[92:95], v[84:87], v[212:215], a[92:95]
  v_mfma_f32_16x16x32_bf16 a[96:99], v[88:91], v[200:203], a[96:99]
  v_mfma_f32_16x16x32_bf16 a[100:103], v[88:91], v[204:207], a[100:103]
  v_mfma_f32_16x16x32_bf16 a[104:107], v[88:91], v[208:211], a[104:107]
  v_mfma_f32_16x16x32_bf16 a[108:111], v[88:91], v[212:215], a[108:111]
  v_mfma_f32_16x16x32_bf16 a[112:115], v[92:95], v[200:203], a[112:115]
  v_mfma_f32_16x16x32_bf16 a[116:119], v[92:95], v[204:207], a[116:119]
  v_mfma_f32_16x16x32_bf16 a[120:123], v[92:95], v[208:211], a[120:123]
  v_mfma_f32_16x16x32_bf16 a[124:127], v[92:95], v[212:215], a[124:127]
  v_mfma_f32_16x16x32_bf16 a[128:131], v[96:99], v[200:203], a[128:131]
  v_mfma_f32_16x16x32_bf16 a[132:135], v[96:99], v[204:207], a[132:135]
  v_mfma_f32_16x16x32_bf16 a[136:139], v[96:99], v[208:211], a[136:139]
  v_mfma_f32_16x16x32_bf16 a[140:143], v[96:99], v[212:215], a[140:143]
  v_mfma_f32_16x16x32_bf16 a[144:147], v[100:103], v[200:203], a[144:147]
  v_mfma_f32_16x16x32_bf16 a[148:151], v[100:103], v[204:207], a[148:151]
  v_mfma_f32_16x16x32_bf16 a[152:155], v[100:103], v[208:211], a[152:155]
  v_mfma_f32_16x16x32_bf16 a[156:159], v[100:103], v[212:215], a[156:159]
  buffer_load_dwordx4 v[64:67], v1, s[4:7], s30 offen offset:1024
  buffer_load_dwordx4 v[68:71], v1, s[4:7], s31 offen offset:1024
  buffer_load_dwordx4 v[72:75], v1, s[4:7], s32 offen offset:1024
  buffer_load_dwordx4 v[76:79], v1, s[4:7], s33 offen offset:1024
  buffer_load_dwordx4 v[80:83], v1, s[4:7], s34 offen offset:1024
  buffer_load_dwordx4 v[84:87], v1, s[4:7], s35 offen offset:1024
  buffer_load_dwordx4 v[88:91], v1, s[4:7], s36 offen offset:1024
  buffer_load_dwordx4 v[92:95], v1, s[4:7], s37 offen offset:1024
  buffer_load_dwordx4 v[96:99], v1, s[4:7], s38 offen offset:1024
  buffer_load_dwordx4 v[100:103], v1, s[4:7], s39 offen offset:1024
  s_waitcnt vmcnt(30)
  ds_read_b128 v[200:203], v1 offset:7168
  ds_read_b128 v[204:207], v1 offset:31744
  ds_read_b128 v[208:211], v6 offset:7168
  ds_read_b128 v[212:215], v6 offset:31744
  s_waitcnt lgkmcnt(4)
  v_mfma_f32_16x16x32_bf16 a[0:3], v[104:107], v[184:187], a[0:3]
  v_mfma_f32_16x16x32_bf16 a[4:7], v[104:107], v[188:191], a[4:7]
  v_mfma_f32_16x16x32_bf16 a[8:11], v[104:107], v[192:195], a[8:11]
  v_mfma_f32_16x16x32_bf16 a[12:15], v[104:107], v[196:199], a[12:15]
  v_mfma_f32_16x16x32_bf16 a[16:19], v[108:111], v[184:187], a[16:19]
  v_mfma_f32_16x16x32_bf16 a[20:23], v[108:111], v[188:191], a[20:23]
  v_mfma_f32_16x16x32_bf16 a[24:27], v[108:111], v[192:195], a[24:27]
  v_mfma_f32_16x16x32_bf16 a[28:31], v[108:111], v[196:199], a[28:31]
  v_mfma_f32_16x16x32_bf16 a[32:35], v[112:115], v[184:187], a[32:35]
  v_mfma_f32_16x16x32_bf16 a[36:39], v[112:115], v[188:191], a[36:39]
  v_mfma_f32_16x16x32_bf16 a[40:43], v[112:115], v[192:195], a[40:43]
  v_mfma_f32_16x16x32_bf16 a[44:47], v[112:115], v[196:199], a[44:47]
  v_mfma_f32_16x16x32_bf16 a[48:51], v[116:119], v[184:187], a[48:51]
  v_mfma_f32_16x16x32_bf16 a[52:55], v[116:119], v[188:191], a[52:55]
  v_mfma_f32_16x16x32_bf16 a[56:59], v[116:119], v[192:195], a[56:59]
  v_mfma_f32_16x16x32_bf16 a[60:63], v[116:119], v[196:199], a[60:63]
  v_mfma_f32_16x16x32_bf16 a[64:67], v[120:123], v[184:187], a[64:67]
  v_mfma_f32_16x16x32_bf16 a[68:71], v[120:123], v[188:191], a[68:71]
  v_mfma_f32_16x16x32_bf16 a[72:75], v[120:123], v[192:195], a[72:75]
  v_mfma_f32_16x16x32_bf16 a[76:79], v[120:123], v[196:199], a[76:79]
  v_mfma_f32_16x16x32_bf16 a[80:83], v[124:127], v[184:187], a[80:83]
  v_mfma_f32_16x16x32_bf16 a[84:87], v[124:127], v[188:191], a[84:87]
  v_mfma_f32_16x16x32_bf16 a[88:91], v[124:127], v[192:195], a[88:91]
  v_mfma_f32_16x16x32_bf16 a[92:95], v[124:127], v[196:199], a[92:95]
  v_mfma_f32_16x16x32_bf16 a[96:99], v[128:131], v[184:187], a[96:99]
  v_mfma_f32_16x16x32_bf16 a[100:103], v[128:131], v[188:191], a[100:103]
  v_mfma_f32_16x16x32_bf16 a[104:107], v[128:131], v[192:195], a[104:107]
  v_mfma_f32_16x16x32_bf16 a[108:111], v[128:131], v[196:199], a[108:111]
  v_mfma_f32_16x16x32_bf16 a[112:115], v[132:135], v[184:187], a[112:115]
  v_mfma_f32_16x16x32_bf16 a[116:119], v[132:135], v[188:191], a[116:119]
  v_mfma_f32_16x16x32_bf16 a[120:123], v[132:135], v[192:195], a[120:123]
  v_mfma_f32_16x16x32_bf16 a[124:127], v[132:135], v[196:199], a[124:127]
  v_mfma_f32_16x16x32_bf16 a[128:131], v[136:139], v[184:187], a[128:131]
  v_mfma_f32_16x16x32_bf16 a[132:135], v[136:139], v[188:191], a[132:135]
  v_mfma_f32_16x16x32_bf16 a[136:139], v[136:139], v[192:195], a[136:139]
  v_mfma_f32_16x16x32_bf16 a[140:143], v[136:139], v[196:199], a[140:143]
  v_mfma_f32_16x16x32_bf16 a[144:147], v[140:143], v[184:187], a[144:147]
  v_mfma_f32_16x16x32_bf16 a[148:151], v[140:143], v[188:191], a[148:151]
  v_mfma_f32_16x16x32_bf16 a[152:155], v[140:143], v[192:195], a[152:155]
  v_mfma_f32_16x16x32_bf16 a[156:159], v[140:143], v[196:199], a[156:159]
  buffer_load_dwordx4 v[104:107], v1, s[4:7], s30 offen offset:2048
  buffer_load_dwordx4 v[108:111], v1, s[4:7], s31 offen offset:2048
  buffer_load_dwordx4 v[112:115], v1, s[4:7], s32 offen offset:2048
  buffer_load_dwordx4 v[116:119], v1, s[4:7], s33 offen offset:2048
  buffer_load_dwordx4 v[120:123], v1, s[4:7], s34 offen offset:2048
  buffer_load_dwordx4 v[124:127], v1, s[4:7], s35 offen offset:2048
  buffer_load_dwordx4 v[128:131], v1, s[4:7], s36 offen offset:2048
  buffer_load_dwordx4 v[132:135], v1, s[4:7], s37 offen offset:2048
  buffer_load_dwordx4 v[136:139], v1, s[4:7], s38 offen offset:2048
  buffer_load_dwordx4 v[140:143], v1, s[4:7], s39 offen offset:2048
  s_waitcnt vmcnt(30)
  ds_read_b128 v[184:187], v1 offset:8192
  ds_read_b128 v[188:191], v1 offset:32768
  ds_read_b128 v[192:195], v6 offset:8192
  ds_read_b128 v[196:199], v6 offset:32768
  s_waitcnt lgkmcnt(4)
  v_mfma_f32_16x16x32_bf16 a[0:3], v[144:147], v[200:203], a[0:3]
  v_mfma_f32_16x16x32_bf16 a[4:7], v[144:147], v[204:207], a[4:7]
  v_mfma_f32_16x16x32_bf16 a[8:11], v[144:147], v[208:211], a[8:11]
  v_mfma_f32_16x16x32_bf16 a[12:15], v[144:147], v[212:215], a[12:15]
  v_mfma_f32_16x16x32_bf16 a[16:19], v[148:151], v[200:203], a[16:19]
  v_mfma_f32_16x16x32_bf16 a[20:23], v[148:151], v[204:207], a[20:23]
  v_mfma_f32_16x16x32_bf16 a[24:27], v[148:151], v[208:211], a[24:27]
  v_mfma_f32_16x16x32_bf16 a[28:31], v[148:151], v[212:215], a[28:31]
  v_mfma_f32_16x16x32_bf16 a[32:35], v[152:155], v[200:203], a[32:35]
  v_mfma_f32_16x16x32_bf16 a[36:39], v[152:155], v[204:207], a[36:39]
  v_mfma_f32_16x16x32_bf16 a[40:43], v[152:155], v[208:211], a[40:43]
  v_mfma_f32_16x16x32_bf16 a[44:47], v[152:155], v[212:215], a[44:47]
  v_mfma_f32_16x16x32_bf16 a[48:51], v[156:159], v[200:203], a[48:51]
  v_mfma_f32_16x16x32_bf16 a[52:55], v[156:159], v[204:207], a[52:55]
  v_mfma_f32_16x16x32_bf16 a[56:59], v[156:159], v[208:211], a[56:59]
  v_mfma_f32_16x16x32_bf16 a[60:63], v[156:159], v[212:215], a[60:63]
  v_mfma_f32_16x16x32_bf16 a[64:67], v[160:163], v[200:203], a[64:67]
  v_mfma_f32_16x16x32_bf16 a[68:71], v[160:163], v[204:207], a[68:71]
  v_mfma_f32_16x16x32_bf16 a[72:75], v[160:163], v[208:211], a[72:75]
  v_mfma_f32_16x16x32_bf16 a[76:79], v[160:163], v[212:215], a[76:79]
  v_mfma_f32_16x16x32_bf16 a[80:83], v[164:167], v[200:203], a[80:83]
  v_mfma_f32_16x16x32_bf16 a[84:87], v[164:167], v[204:207], a[84:87]
  v_mfma_f32_16x16x32_bf16 a[88:91], v[164:167], v[208:211], a[88:91]
  v_mfma_f32_16x16x32_bf16 a[92:95], v[164:167], v[212:215], a[92:95]
  v_mfma_f32_16x16x32_bf16 a[96:99], v[168:171], v[200:203], a[96:99]
  v_mfma_f32_16x16x32_bf16 a[100:103], v[168:171], v[204:207], a[100:103]
  v_mfma_f32_16x16x32_bf16 a[104:107], v[168:171], v[208:211], a[104:107]
  v_mfma_f32_16x16x32_bf16 a[108:111], v[168:171], v[212:215], a[108:111]
  v_mfma_f32_16x16x32_bf16 a[112:115], v[172:175], v[200:203], a[112:115]
  v_mfma_f32_16x16x32_bf16 a[116:119], v[172:175], v[204:207], a[116:119]
  v_mfma_f32_16x16x32_bf16 a[120:123], v[172:175], v[208:211], a[120:123]
  v_mfma_f32_16x16x32_bf16 a[124:127], v[172:175], v[212:215], a[124:127]
  v_mfma_f32_16x16x32_bf16 a[128:131], v[176:179], v[200:203], a[128:131]
  v_mfma_f32_16x16x32_bf16 a[132:135], v[176:179], v[204:207], a[132:135]
  v_mfma_f32_16x16x32_bf16 a[136:139], v[176:179], v[208:211], a[136:139]
  v_mfma_f32_16x16x32_bf16 a[140:143], v[176:179], v[212:215], a[140:143]
  v_mfma_f32_16x16x32_bf16 a[144:147], v[180:183], v[200:203], a[144:147]
  v_mfma_f32_16x16x32_bf16 a[148:151], v[180:183], v[204:207], a[148:151]
  v_mfma_f32_16x16x32_bf16 a[152:155], v[180:183], v[208:211], a[152:155]
  v_mfma_f32_16x16x32_bf16 a[156:159], v[180:183], v[212:215], a[156:159]
  buffer_load_dwordx4 v[144:147], v1, s[4:7], s30 offen offset:3072
  buffer_load_dwordx4 v[148:151], v1, s[4:7], s31 offen offset:3072
  buffer_load_dwordx4 v[152:155], v1, s[4:7], s32 offen offset:3072
  buffer_load_dwordx4 v[156:159], v1, s[4:7], s33 offen offset:3072
  buffer_load_dwordx4 v[160:163], v1, s[4:7], s34 offen offset:3072
  buffer_load_dwordx4 v[164:167], v1, s[4:7], s35 offen offset:3072
  buffer_load_dwordx4 v[168:171], v1, s[4:7], s36 offen offset:3072
  buffer_load_dwordx4 v[172:175], v1, s[4:7], s37 offen offset:3072
  buffer_load_dwordx4 v[176:179], v1, s[4:7], s38 offen offset:3072
  buffer_load_dwordx4 v[180:183], v1, s[4:7], s39 offen offset:3072
  s_add_u32 s30, s30, 4096
  s_add_u32 s31, s31, 4096
  s_add_u32 s32, s32, 4096
  s_add_u32 s33, s33, 4096
  s_add_u32 s34, s34, 4096
  s_add_u32 s35, s35, 4096
  s_add_u32 s36, s36, 4096
  s_add_u32 s37, s37, 4096
  s_add_u32 s38, s38, 4096
  s_add_u32 s39, s39, 4096
  s_waitcnt vmcnt(30)
  ds_read_b128 v[200:203], v1 offset:9216
  ds_read_b128 v[204:207], v1 offset:33792
  ds_read_b128 v[208:211], v6 offset:9216
  ds_read_b128 v[212:215], v6 offset:33792
  s_waitcnt lgkmcnt(4)
  v_mfma_f32_16x16x32_bf16 a[0:3], v[24:27], v[184:187], a[0:3]
  v_mfma_f32_16x16x32_bf16 a[4:7], v[24:27], v[188:191], a[4:7]
  v_mfma_f32_16x16x32_bf16 a[8:11], v[24:27], v[192:195], a[8:11]
  v_mfma_f32_16x16x32_bf16 a[12:15], v[24:27], v[196:199], a[12:15]
  v_mfma_f32_16x16x32_bf16 a[16:19], v[28:31], v[184:187], a[16:19]
  v_mfma_f32_16x16x32_bf16 a[20:23], v[28:31], v[188:191], a[20:23]
  v_mfma_f32_16x16x32_bf16 a[24:27], v[28:31], v[192:195], a[24:27]
  v_mfma_f32_16x16x32_bf16 a[28:31], v[28:31], v[196:199], a[28:31]
  v_mfma_f32_16x16x32_bf16 a[32:35], v[32:35], v[184:187], a[32:35]
  v_mfma_f32_16x16x32_bf16 a[36:39], v[32:35], v[188:191], a[36:39]
  v_mfma_f32_16x16x32_bf16 a[40:43], v[32:35], v[192:195], a[40:43]
  v_mfma_f32_16x16x32_bf16 a[44:47], v[32:35], v[196:199], a[44:47]
  v_mfma_f32_16x16x32_bf16 a[48:51], v[36:39], v[184:187], a[48:51]
  v_mfma_f32_16x16x32_bf16 a[52:55], v[36:39], v[188:191], a[52:55]
  v_mfma_f32_16x16x32_bf16 a[56:59], v[36:39], v[192:195], a[56:59]
  v_mfma_f32_16x16x32_bf16 a[60:63], v[36:39], v[196:199], a[60:63]
  v_mfma_f32_16x16x32_bf16 a[64:67], v[40:43], v[184:187], a[64:67]
  v_mfma_f32_16x16x32_bf16 a[68:71], v[40:43], v[188:191], a[68:71]
  v_mfma_f32_16x16x32_bf16 a[72:75], v[40:43], v[192:195], a[72:75]
  v_mfma_f32_16x16x32_bf16 a[76:79], v[40:43], v[196:199], a[76:79]
  v_mfma_f32_16x16x32_bf16 a[80:83], v[44:47], v[184:187], a[80:83]
  v_mfma_f32_16x16x32_bf16 a[84:87], v[44:47], v[188:191], a[84:87]
  v_mfma_f32_16x16x32_bf16 a[88:91], v[44:47], v[192:195], a[88:91]
  v_mfma_f32_16x16x32_bf16 a[92:95], v[44:47], v[196:199], a[92:95]
  v_mfma_f32_16x16x32_bf16 a[96:99], v[48:51], v[184:187], a[96:99]
  v_mfma_f32_16x16x32_bf16 a[100:103], v[48:51], v[188:191], a[100:103]
  v_mfma_f32_16x16x32_bf16 a[104:107], v[48:51], v[192:195], a[104:107]
  v_mfma_f32_16x16x32_bf16 a[108:111], v[48:51], v[196:199], a[108:111]
  v_mfma_f32_16x16x32_bf16 a[112:115], v[52:55], v[184:187], a[112:115]
  v_mfma_f32_16x16x32_bf16 a[116:119], v[52:55], v[188:191], a[116:119]
  v_mfma_f32_16x16x32_bf16 a[120:123], v[52:55], v[192:195], a[120:123]
  v_mfma_f32_16x16x32_bf16 a[124:127], v[52:55], v[196:199], a[124:127]
  v_mfma_f32_16x16x32_bf16 a[128:131], v[56:59], v[184:187], a[128:131]
  v_mfma_f32_16x16x32_bf16 a[132:135], v[56:59], v[188:191], a[132:135]
  v_mfma_f32_16x16x32_bf16 a[136:139], v[56:59], v[192:195], a[136:139]
  v_mfma_f32_16x16x32_bf16 a[140:143], v[56:59], v[196:199], a[140:143]
  v_mfma_f32_16x16x32_bf16 a[144:147], v[60:63], v[184:187], a[144:147]
  v_mfma_f32_16x16x32_bf16 a[148:151], v[60:63], v[188:191], a[148:151]
  v_mfma_f32_16x16x32_bf16 a[152:155], v[60:63], v[192:195], a[152:155]
  v_mfma_f32_16x16x32_bf16 a[156:159], v[60:63], v[196:199], a[156:159]
  buffer_load_dwordx4 v[24:27], v1, s[4:7], s30 offen offset:0
  buffer_load_dwordx4 v[28:31], v1, s[4:7], s31 offen offset:0
  buffer_load_dwordx4 v[32:35], v1, s[4:7], s32 offen offset:0
  buffer_load_dwordx4 v[36:39], v1, s[4:7], s33 offen offset:0
  buffer_load_dwordx4 v[40:43], v1, s[4:7], s34 offen offset:0
  buffer_load_dwordx4 v[44:47], v1, s[4:7], s35 offen offset:0
  buffer_load_dwordx4 v[48:51], v1, s[4:7], s36 offen offset:0
  buffer_load_dwordx4 v[52:55], v1, s[4:7], s37 offen offset:0
  buffer_load_dwordx4 v[56:59], v1, s[4:7], s38 offen offset:0
  buffer_load_dwordx4 v[60:63], v1, s[4:7], s39 offen offset:0
  s_waitcnt vmcnt(30)
  ds_read_b128 v[184:187], v1 offset:10240
  ds_read_b128 v[188:191], v1 offset:34816
  ds_read_b128 v[192:195], v6 offset:10240
  ds_read_b128 v[196:199], v6 offset:34816
  s_waitcnt lgkmcnt(4)
  v_mfma_f32_16x16x32_bf16 a[0:3], v[64:67], v[200:203], a[0:3]
  v_mfma_f32_16x16x32_bf16 a[4:7], v[64:67], v[204:207], a[4:7]
  v_mfma_f32_16x16x32_bf16 a[8:11], v[64:67], v[208:211], a[8:11]
  v_mfma_f32_16x16x32_bf16 a[12:15], v[64:67], v[212:215], a[12:15]
  v_mfma_f32_16x16x32_bf16 a[16:19], v[68:71], v[200:203], a[16:19]
  v_mfma_f32_16x16x32_bf16 a[20:23], v[68:71], v[204:207], a[20:23]
  v_mfma_f32_16x16x32_bf16 a[24:27], v[68:71], v[208:211], a[24:27]
  v_mfma_f32_16x16x32_bf16 a[28:31], v[68:71], v[212:215], a[28:31]
  v_mfma_f32_16x16x32_bf16 a[32:35], v[72:75], v[200:203], a[32:35]
  v_mfma_f32_16x16x32_bf16 a[36:39], v[72:75], v[204:207], a[36:39]
  v_mfma_f32_16x16x32_bf16 a[40:43], v[72:75], v[208:211], a[40:43]
  v_mfma_f32_16x16x32_bf16 a[44:47], v[72:75], v[212:215], a[44:47]
  v_mfma_f32_16x16x32_bf16 a[48:51], v[76:79], v[200:203], a[48:51]
  v_mfma_f32_16x16x32_bf16 a[52:55], v[76:79], v[204:207], a[52:55]
  v_mfma_f32_16x16x32_bf16 a[56:59], v[76:79], v[208:211], a[56:59]
  v_mfma_f32_16x16x32_bf16 a[60:63], v[76:79], v[212:215], a[60:63]
  v_mfma_f32_16x16x32_bf16 a[64:67], v[80:83], v[200:203], a[64:67]
  v_mfma_f32_16x16x32_bf16 a[68:71], v[80:83], v[204:207], a[68:71]
  v_mfma_f32_16x16x32_bf16 a[72:75], v[80:83], v[208:211], a[72:75]
  v_mfma_f32_16x16x32_bf16 a[76:79], v[80:83], v[212:215], a[76:79]
  v_mfma_f32_16x16x32_bf16 a[80:83], v[84:87], v[200:203], a[80:83]
  v_mfma_f32_16x16x32_bf16 a[84:87], v[84:87], v[204:207], a[84:87]
  v_mfma_f32_16x16x32_bf16 a[88:91], v[84:87], v[208:211], a[88:91]
  v_mfma_f32_16x16x32_bf16 a[92:95], v[84:87], v[212:215], a[92:95]
  v_mfma_f32_16x16x32_bf16 a[96:99], v[88:91], v[200:203], a[96:99]
  v_mfma_f32_16x16x32_bf16 a[100:103], v[88:91], v[204:207], a[100:103]
  v_mfma_f32_16x16x32_bf16 a[104:107], v[88:91], v[208:211], a[104:107]
  v_mfma_f32_16x16x32_bf16 a[108:111], v[88:91], v[212:215], a[108:111]
  v_mfma_f32_16x16x32_bf16 a[112:115], v[92:95], v[200:203], a[112:115]
  v_mfma_f32_16x16x32_bf16 a[116:119], v[92:95], v[204:207], a[116:119]
  v_mfma_f32_16x16x32_bf16 a[120:123], v[92:95], v[208:211], a[120:123]
  v_mfma_f32_16x16x32_bf16 a[124:127], v[92:95], v[212:215], a[124:127]
  v_mfma_f32_16x16x32_bf16 a[128:131], v[96:99], v[200:203], a[128:131]
  v_mfma_f32_16x16x32_bf16 a[132:135], v[96:99], v[204:207], a[132:135]
  v_mfma_f32_16x16x32_bf16 a[136:139], v[96:99], v[208:211], a[136:139]
  v_mfma_f32_16x16x32_bf16 a[140:143], v[96:99], v[212:215], a[140:143]
  v_mfma_f32_16x16x32_bf16 a[144:147], v[100:103], v[200:203], a[144:147]
  v_mfma_f32_16x16x32_bf16 a[148:151], v[100:103], v[204:207], a[148:151]
  v_mfma_f32_16x16x32_bf16 a[152:155], v[100:103], v[208:211], a[152:155]
  v_mfma_f32_16x16x32_bf16 a[156:159], v[100:103], v[212:215], a[156:159]
  buffer_load_dwordx4 v[64:67], v1, s[4:7], s30 offen offset:1024
  buffer_load_dwordx4 v[68:71], v1, s[4:7], s31 offen offset:1024
  buffer_load_dwordx4 v[72:75], v1, s[4:7], s32 offen offset:1024
  buffer_load_dwordx4 v[76:79], v1, s[4:7], s33 offen offset:1024
  buffer_load_dwordx4 v[80:83], v1, s[4:7], s34 offen offset:1024
  buffer_load_dwordx4 v[84:87], v1, s[4:7], s35 offen offset:1024
  buffer_load_dwordx4 v[88:91], v1, s[4:7], s36 offen offset:1024
  buffer_load_dwordx4 v[92:95], v1, s[4:7], s37 offen offset:1024
  buffer_load_dwordx4 v[96:99], v1, s[4:7], s38 offen offset:1024
  buffer_load_dwordx4 v[100:103], v1, s[4:7], s39 offen offset:1024
  s_waitcnt vmcnt(30)
  ds_read_b128 v[200:203], v1 offset:11264
  ds_read_b128 v[204:207], v1 offset:35840
  ds_read_b128 v[208:211], v6 offset:11264
  ds_read_b128 v[212:215], v6 offset:35840
  s_waitcnt lgkmcnt(4)
  v_mfma_f32_16x16x32_bf16 a[0:3], v[104:107], v[184:187], a[0:3]
  v_mfma_f32_16x16x32_bf16 a[4:7], v[104:107], v[188:191], a[4:7]
  v_mfma_f32_16x16x32_bf16 a[8:11], v[104:107], v[192:195], a[8:11]
  v_mfma_f32_16x16x32_bf16 a[12:15], v[104:107], v[196:199], a[12:15]
  v_mfma_f32_16x16x32_bf16 a[16:19], v[108:111], v[184:187], a[16:19]
  v_mfma_f32_16x16x32_bf16 a[20:23], v[108:111], v[188:191], a[20:23]
  v_mfma_f32_16x16x32_bf16 a[24:27], v[108:111], v[192:195], a[24:27]
  v_mfma_f32_16x16x32_bf16 a[28:31], v[108:111], v[196:199], a[28:31]
  v_mfma_f32_16x16x32_bf16 a[32:35], v[112:115], v[184:187], a[32:35]
  v_mfma_f32_16x16x32_bf16 a[36:39], v[112:115], v[188:191], a[36:39]
  v_mfma_f32_16x16x32_bf16 a[40:43], v[112:115], v[192:195], a[40:43]
  v_mfma_f32_16x16x32_bf16 a[44:47], v[112:115], v[196:199], a[44:47]
  v_mfma_f32_16x16x32_bf16 a[48:51], v[116:119], v[184:187], a[48:51]
  v_mfma_f32_16x16x32_bf16 a[52:55], v[116:119], v[188:191], a[52:55]
  v_mfma_f32_16x16x32_bf16 a[56:59], v[116:119], v[192:195], a[56:59]
  v_mfma_f32_16x16x32_bf16 a[60:63], v[116:119], v[196:199], a[60:63]
  v_mfma_f32_16x16x32_bf16 a[64:67], v[120:123], v[184:187], a[64:67]
  v_mfma_f32_16x16x32_bf16 a[68:71], v[120:123], v[188:191], a[68:71]
  v_mfma_f32_16x16x32_bf16 a[72:75], v[120:123], v[192:195], a[72:75]
  v_mfma_f32_16x16x32_bf16 a[76:79], v[120:123], v[196:199], a[76:79]
  v_mfma_f32_16x16x32_bf16 a[80:83], v[124:127], v[184:187], a[80:83]
  v_mfma_f32_16x16x32_bf16 a[84:87], v[124:127], v[188:191], a[84:87]
  v_mfma_f32_16x16x32_bf16 a[88:91], v[124:127], v[192:195], a[88:91]
  v_mfma_f32_16x16x32_bf16 a[92:95], v[124:127], v[196:199], a[92:95]
  v_mfma_f32_16x16x32_bf16 a[96:99], v[128:131], v[184:187], a[96:99]
  v_mfma_f32_16x16x32_bf16 a[100:103], v[128:131], v[188:191], a[100:103]
  v_mfma_f32_16x16x32_bf16 a[104:107], v[128:131], v[192:195], a[104:107]
  v_mfma_f32_16x16x32_bf16 a[108:111], v[128:131], v[196:199], a[108:111]
  v_mfma_f32_16x16x32_bf16 a[112:115], v[132:135], v[184:187], a[112:115]
  v_mfma_f32_16x16x32_bf16 a[116:119], v[132:135], v[188:191], a[116:119]
  v_mfma_f32_16x16x32_bf16 a[120:123], v[132:135], v[192:195], a[120:123]
  v_mfma_f32_16x16x32_bf16 a[124:127], v[132:135], v[196:199], a[124:127]
  v_mfma_f32_16x16x32_bf16 a[128:131], v[136:139], v[184:187], a[128:131]
  v_mfma_f32_16x16x32_bf16 a[132:135], v[136:139], v[188:191], a[132:135]
  v_mfma_f32_16x16x32_bf16 a[136:139], v[136:139], v[192:195], a[136:139]
  v_mfma_f32_16x16x32_bf16 a[140:143], v[136:139], v[196:199], a[140:143]
  v_mfma_f32_16x16x32_bf16 a[144:147], v[140:143], v[184:187], a[144:147]
  v_mfma_f32_16x16x32_bf16 a[148:151], v[140:143], v[188:191], a[148:151]
  v_mfma_f32_16x16x32_bf16 a[152:155], v[140:143], v[192:195], a[152:155]
  v_mfma_f32_16x16x32_bf16 a[156:159], v[140:143], v[196:199], a[156:159]
  buffer_load_dwordx4 v[104:107], v1, s[4:7], s30 offen offset:2048
  buffer_load_dwordx4 v[108:111], v1, s[4:7], s31 offen offset:2048
  buffer_load_dwordx4 v[112:115], v1, s[4:7], s32 offen offset:2048
  buffer_load_dwordx4 v[116:119], v1, s[4:7], s33 offen offset:2048
  buffer_load_dwordx4 v[120:123], v1, s[4:7], s34 offen offset:2048
  buffer_load_dwordx4 v[124:127], v1, s[4:7], s35 offen offset:2048
  buffer_load_dwordx4 v[128:131], v1, s[4:7], s36 offen offset:2048
  buffer_load_dwordx4 v[132:135], v1, s[4:7], s37 offen offset:2048
  buffer_load_dwordx4 v[136:139], v1, s[4:7], s38 offen offset:2048
  buffer_load_dwordx4 v[140:143], v1, s[4:7], s39 offen offset:2048
  s_waitcnt vmcnt(30)
  ds_read_b128 v[184:187], v1 offset:12288
  ds_read_b128 v[188:191], v1 offset:36864
  ds_read_b128 v[192:195], v6 offset:12288
  ds_read_b128 v[196:199], v6 offset:36864
  s_waitcnt lgkmcnt(4)
  v_mfma_f32_16x16x32_bf16 a[0:3], v[144:147], v[200:203], a[0:3]
  v_mfma_f32_16x16x32_bf16 a[4:7], v[144:147], v[204:207], a[4:7]
  v_mfma_f32_16x16x32_bf16 a[8:11], v[144:147], v[208:211], a[8:11]
  v_mfma_f32_16x16x32_bf16 a[12:15], v[144:147], v[212:215], a[12:15]
  v_mfma_f32_16x16x32_bf16 a[16:19], v[148:151], v[200:203], a[16:19]
  v_mfma_f32_16x16x32_bf16 a[20:23], v[148:151], v[204:207], a[20:23]
  v_mfma_f32_16x16x32_bf16 a[24:27], v[148:151], v[208:211], a[24:27]
  v_mfma_f32_16x16x32_bf16 a[28:31], v[148:151], v[212:215], a[28:31]
  v_mfma_f32_16x16x32_bf16 a[32:35], v[152:155], v[200:203], a[32:35]
  v_mfma_f32_16x16x32_bf16 a[36:39], v[152:155], v[204:207], a[36:39]
  v_mfma_f32_16x16x32_bf16 a[40:43], v[152:155], v[208:211], a[40:43]
  v_mfma_f32_16x16x32_bf16 a[44:47], v[152:155], v[212:215], a[44:47]
  v_mfma_f32_16x16x32_bf16 a[48:51], v[156:159], v[200:203], a[48:51]
  v_mfma_f32_16x16x32_bf16 a[52:55], v[156:159], v[204:207], a[52:55]
  v_mfma_f32_16x16x32_bf16 a[56:59], v[156:159], v[208:211], a[56:59]
  v_mfma_f32_16x16x32_bf16 a[60:63], v[156:159], v[212:215], a[60:63]
  v_mfma_f32_16x16x32_bf16 a[64:67], v[160:163], v[200:203], a[64:67]
  v_mfma_f32_16x16x32_bf16 a[68:71], v[160:163], v[204:207], a[68:71]
  v_mfma_f32_16x16x32_bf16 a[72:75], v[160:163], v[208:211], a[72:75]
  v_mfma_f32_16x16x32_bf16 a[76:79], v[160:163], v[212:215], a[76:79]
  v_mfma_f32_16x16x32_bf16 a[80:83], v[164:167], v[200:203], a[80:83]
  v_mfma_f32_16x16x32_bf16 a[84:87], v[164:167], v[204:207], a[84:87]
  v_mfma_f32_16x16x32_bf16 a[88:91], v[164:167], v[208:211], a[88:91]
  v_mfma_f32_16x16x32_bf16 a[92:95], v[164:167], v[212:215], a[92:95]
  v_mfma_f32_16x16x32_bf16 a[96:99], v[168:171], v[200:203], a[96:99]
  v_mfma_f32_16x16x32_bf16 a[100:103], v[168:171], v[204:207], a[100:103]
  v_mfma_f32_16x16x32_bf16 a[104:107], v[168:171], v[208:211], a[104:107]
  v_mfma_f32_16x16x32_bf16 a[108:111], v[168:171], v[212:215], a[108:111]
  v_mfma_f32_16x16x32_bf16 a[112:115], v[172:175], v[200:203], a[112:115]
  v_mfma_f32_16x16x32_bf16 a[116:119], v[172:175], v[204:207], a[116:119]
  v_mfma_f32_16x16x32_bf16 a[120:123], v[172:175], v[208:211], a[120:123]
  v_mfma_f32_16x16x32_bf16 a[124:127], v[172:175], v[212:215], a[124:127]
  v_mfma_f32_16x16x32_bf16 a[128:131], v[176:179], v[200:203], a[128:131]
  v_mfma_f32_16x16x32_bf16 a[132:135], v[176:179], v[204:207], a[132:135]
  v_mfma_f32_16x16x32_bf16 a[136:139], v[176:179], v[208:211], a[136:139]
  v_mfma_f32_16x16x32_bf16 a[140:143], v[176:179], v[212:215], a[140:143]
  v_mfma_f32_16x16x32_bf16 a[144:147], v[180:183], v[200:203], a[144:147]
  v_mfma_f32_16x16x32_bf16 a[148:151], v[180:183], v[204:207], a[148:151]
  v_mfma_f32_16x16x32_bf16 a[152:155], v[180:183], v[208:211], a[152:155]
  v_mfma_f32_16x16x32_bf16 a[156:159], v[180:183], v[212:215], a[156:159]
  buffer_load_dwordx4 v[144:147], v1, s[4:7], s30 offen offset:3072
  buffer_load_dwordx4 v[148:151], v1, s[4:7], s31 offen offset:3072
  buffer_load_dwordx4 v[152:155], v1, s[4:7], s32 offen offset:3072
  buffer_load_dwordx4 v[156:159], v1, s[4:7], s33 offen offset:3072
  buffer_load_dwordx4 v[160:163], v1, s[4:7], s34 offen offset:3072
  buffer_load_dwordx4 v[164:167], v1, s[4:7], s35 offen offset:3072
  buffer_load_dwordx4 v[168:171], v1, s[4:7], s36 offen offset:3072
  buffer_load_dwordx4 v[172:175], v1, s[4:7], s37 offen offset:3072
  buffer_load_dwordx4 v[176:179], v1, s[4:7], s38 offen offset:3072
  buffer_load_dwordx4 v[180:183], v1, s[4:7], s39 offen offset:3072
  s_add_u32 s30, s30, 4096
  s_add_u32 s31, s31, 4096
  s_add_u32 s32, s32, 4096
  s_add_u32 s33, s33, 4096
  s_add_u32 s34, s34, 4096
  s_add_u32 s35, s35, 4096
  s_add_u32 s36, s36, 4096
  s_add_u32 s37, s37, 4096
  s_add_u32 s38, s38, 4096
  s_add_u32 s39, s39, 4096
  s_waitcnt vmcnt(30)
  ds_read_b128 v[200:203], v1 offset:13312
  ds_read_b128 v[204:207], v1 offset:37888
  ds_read_b128 v[208:211], v6 offset:13312
  ds_read_b128 v[212:215], v6 offset:37888
  s_waitcnt lgkmcnt(4)
  v_mfma_f32_16x16x32_bf16 a[0:3], v[24:27], v[184:187], a[0:3]
  v_mfma_f32_16x16x32_bf16 a[4:7], v[24:27], v[188:191], a[4:7]
  v_mfma_f32_16x16x32_bf16 a[8:11], v[24:27], v[192:195], a[8:11]
  v_mfma_f32_16x16x32_bf16 a[12:15], v[24:27], v[196:199], a[12:15]
  v_mfma_f32_16x16x32_bf16 a[16:19], v[28:31], v[184:187], a[16:19]
  v_mfma_f32_16x16x32_bf16 a[20:23], v[28:31], v[188:191], a[20:23]
  v_mfma_f32_16x16x32_bf16 a[24:27], v[28:31], v[192:195], a[24:27]
  v_mfma_f32_16x16x32_bf16 a[28:31], v[28:31], v[196:199], a[28:31]
  v_mfma_f32_16x16x32_bf16 a[32:35], v[32:35], v[184:187], a[32:35]
  v_mfma_f32_16x16x32_bf16 a[36:39], v[32:35], v[188:191], a[36:39]
  v_mfma_f32_16x16x32_bf16 a[40:43], v[32:35], v[192:195], a[40:43]
  v_mfma_f32_16x16x32_bf16 a[44:47], v[32:35], v[196:199], a[44:47]
  v_mfma_f32_16x16x32_bf16 a[48:51], v[36:39], v[184:187], a[48:51]
  v_mfma_f32_16x16x32_bf16 a[52:55], v[36:39], v[188:191], a[52:55]
  v_mfma_f32_16x16x32_bf16 a[56:59], v[36:39], v[192:195], a[56:59]
  v_mfma_f32_16x16x32_bf16 a[60:63], v[36:39], v[196:199], a[60:63]
  v_mfma_f32_16x16x32_bf16 a[64:67], v[40:43], v[184:187], a[64:67]
  v_mfma_f32_16x16x32_bf16 a[68:71], v[40:43], v[188:191], a[68:71]
  v_mfma_f32_16x16x32_bf16 a[72:75], v[40:43], v[192:195], a[72:75]
  v_mfma_f32_16x16x32_bf16 a[76:79], v[40:43], v[196:199], a[76:79]
  v_mfma_f32_16x16x32_bf16 a[80:83], v[44:47], v[184:187], a[80:83]
  v_mfma_f32_16x16x32_bf16 a[84:87], v[44:47], v[188:191], a[84:87]
  v_mfma_f32_16x16x32_bf16 a[88:91], v[44:47], v[192:195], a[88:91]
  v_mfma_f32_16x16x32_bf16 a[92:95], v[44:47], v[196:199], a[92:95]
  v_mfma_f32_16x16x32_bf16 a[96:99], v[48:51], v[184:187], a[96:99]
  v_mfma_f32_16x16x32_bf16 a[100:103], v[48:51], v[188:191], a[100:103]
  v_mfma_f32_16x16x32_bf16 a[104:107], v[48:51], v[192:195], a[104:107]
  v_mfma_f32_16x16x32_bf16 a[108:111], v[48:51], v[196:199], a[108:111]
  v_mfma_f32_16x16x32_bf16 a[112:115], v[52:55], v[184:187], a[112:115]
  v_mfma_f32_16x16x32_bf16 a[116:119], v[52:55], v[188:191], a[116:119]
  v_mfma_f32_16x16x32_bf16 a[120:123], v[52:55], v[192:195], a[120:123]
  v_mfma_f32_16x16x32_bf16 a[124:127], v[52:55], v[196:199], a[124:127]
  v_mfma_f32_16x16x32_bf16 a[128:131], v[56:59], v[184:187], a[128:131]
  v_mfma_f32_16x16x32_bf16 a[132:135], v[56:59], v[188:191], a[132:135]
  v_mfma_f32_16x16x32_bf16 a[136:139], v[56:59], v[192:195], a[136:139]
  v_mfma_f32_16x16x32_bf16 a[140:143], v[56:59], v[196:199], a[140:143]
  v_mfma_f32_16x16x32_bf16 a[144:147], v[60:63], v[184:187], a[144:147]
  v_mfma_f32_16x16x32_bf16 a[148:151], v[60:63], v[188:191], a[148:151]
  v_mfma_f32_16x16x32_bf16 a[152:155], v[60:63], v[192:195], a[152:155]
  v_mfma_f32_16x16x32_bf16 a[156:159], v[60:63], v[196:199], a[156:159]
  buffer_load_dwordx4 v[24:27], v1, s[4:7], s30 offen offset:0
  buffer_load_dwordx4 v[28:31], v1, s[4:7], s31 offen offset:0
  buffer_load_dwordx4 v[32:35], v1, s[4:7], s32 offen offset:0
  buffer_load_dwordx4 v[36:39], v1, s[4:7], s33 offen offset:0
  buffer_load_dwordx4 v[40:43], v1, s[4:7], s34 offen offset:0
  buffer_load_dwordx4 v[44:47], v1, s[4:7], s35 offen offset:0
  buffer_load_dwordx4 v[48:51], v1, s[4:7], s36 offen offset:0
  buffer_load_dwordx4 v[52:55], v1, s[4:7], s37 offen offset:0
  buffer_load_dwordx4 v[56:59], v1, s[4:7], s38 offen offset:0
  buffer_load_dwordx4 v[60:63], v1, s[4:7], s39 offen offset:0
  s_waitcnt vmcnt(30)
  ds_read_b128 v[184:187], v1 offset:14336
  ds_read_b128 v[188:191], v1 offset:38912
  ds_read_b128 v[192:195], v6 offset:14336
  ds_read_b128 v[196:199], v6 offset:38912
  s_waitcnt lgkmcnt(4)
  v_mfma_f32_16x16x32_bf16 a[0:3], v[64:67], v[200:203], a[0:3]
  v_mfma_f32_16x16x32_bf16 a[4:7], v[64:67], v[204:207], a[4:7]
  v_mfma_f32_16x16x32_bf16 a[8:11], v[64:67], v[208:211], a[8:11]
  v_mfma_f32_16x16x32_bf16 a[12:15], v[64:67], v[212:215], a[12:15]
  v_mfma_f32_16x16x32_bf16 a[16:19], v[68:71], v[200:203], a[16:19]
  v_mfma_f32_16x16x32_bf16 a[20:23], v[68:71], v[204:207], a[20:23]
  v_mfma_f32_16x16x32_bf16 a[24:27], v[68:71], v[208:211], a[24:27]
  v_mfma_f32_16x16x32_bf16 a[28:31], v[68:71], v[212:215], a[28:31]
  v_mfma_f32_16x16x32_bf16 a[32:35], v[72:75], v[200:203], a[32:35]
  v_mfma_f32_16x16x32_bf16 a[36:39], v[72:75], v[204:207], a[36:39]
  v_mfma_f32_16x16x32_bf16 a[40:43], v[72:75], v[208:211], a[40:43]
  v_mfma_f32_16x16x32_bf16 a[44:47], v[72:75], v[212:215], a[44:47]
  v_mfma_f32_16x16x32_bf16 a[48:51], v[76:79], v[200:203], a[48:51]
  v_mfma_f32_16x16x32_bf16 a[52:55], v[76:79], v[204:207], a[52:55]
  v_mfma_f32_16x16x32_bf16 a[56:59], v[76:79], v[208:211], a[56:59]
  v_mfma_f32_16x16x32_bf16 a[60:63], v[76:79], v[212:215], a[60:63]
  v_mfma_f32_16x16x32_bf16 a[64:67], v[80:83], v[200:203], a[64:67]
  v_mfma_f32_16x16x32_bf16 a[68:71], v[80:83], v[204:207], a[68:71]
  v_mfma_f32_16x16x32_bf16 a[72:75], v[80:83], v[208:211], a[72:75]
  v_mfma_f32_16x16x32_bf16 a[76:79], v[80:83], v[212:215], a[76:79]
  v_mfma_f32_16x16x32_bf16 a[80:83], v[84:87], v[200:203], a[80:83]
  v_mfma_f32_16x16x32_bf16 a[84:87], v[84:87], v[204:207], a[84:87]
  v_mfma_f32_16x16x32_bf16 a[88:91], v[84:87], v[208:211], a[88:91]
  v_mfma_f32_16x16x32_bf16 a[92:95], v[84:87], v[212:215], a[92:95]
  v_mfma_f32_16x16x32_bf16 a[96:99], v[88:91], v[200:203], a[96:99]
  v_mfma_f32_16x16x32_bf16 a[100:103], v[88:91], v[204:207], a[100:103]
  v_mfma_f32_16x16x32_bf16 a[104:107], v[88:91], v[208:211], a[104:107]
  v_mfma_f32_16x16x32_bf16 a[108:111], v[88:91], v[212:215], a[108:111]
  v_mfma_f32_16x16x32_bf16 a[112:115], v[92:95], v[200:203], a[112:115]
  v_mfma_f32_16x16x32_bf16 a[116:119], v[92:95], v[204:207], a[116:119]
  v_mfma_f32_16x16x32_bf16 a[120:123], v[92:95], v[208:211], a[120:123]
  v_mfma_f32_16x16x32_bf16 a[124:127], v[92:95], v[212:215], a[124:127]
  v_mfma_f32_16x16x32_bf16 a[128:131], v[96:99], v[200:203], a[128:131]
  v_mfma_f32_16x16x32_bf16 a[132:135], v[96:99], v[204:207], a[132:135]
  v_mfma_f32_16x16x32_bf16 a[136:139], v[96:99], v[208:211], a[136:139]
  v_mfma_f32_16x16x32_bf16 a[140:143], v[96:99], v[212:215], a[140:143]
  v_mfma_f32_16x16x32_bf16 a[144:147], v[100:103], v[200:203], a[144:147]
  v_mfma_f32_16x16x32_bf16 a[148:151], v[100:103], v[204:207], a[148:151]
  v_mfma_f32_16x16x32_bf16 a[152:155], v[100:103], v[208:211], a[152:155]
  v_mfma_f32_16x16x32_bf16 a[156:159], v[100:103], v[212:215], a[156:159]
  buffer_load_dwordx4 v[64:67], v1, s[4:7], s30 offen offset:1024
  buffer_load_dwordx4 v[68:71], v1, s[4:7], s31 offen offset:1024
  buffer_load_dwordx4 v[72:75], v1, s[4:7], s32 offen offset:1024
  buffer_load_dwordx4 v[76:79], v1, s[4:7], s33 offen offset:1024
  buffer_load_dwordx4 v[80:83], v1, s[4:7], s34 offen offset:1024
  buffer_load_dwordx4 v[84:87], v1, s[4:7], s35 offen offset:1024
  buffer_load_dwordx4 v[88:91], v1, s[4:7], s36 offen offset:1024
  buffer_load_dwordx4 v[92:95], v1, s[4:7], s37 offen offset:1024
  buffer_load_dwordx4 v[96:99], v1, s[4:7], s38 offen offset:1024
  buffer_load_dwordx4 v[100:103], v1, s[4:7], s39 offen offset:1024
  s_waitcnt vmcnt(30)
  ds_read_b128 v[200:203], v1 offset:15360
  ds_read_b128 v[204:207], v1 offset:39936
  ds_read_b128 v[208:211], v6 offset:15360
  ds_read_b128 v[212:215], v6 offset:39936
  s_waitcnt lgkmcnt(4)
  v_mfma_f32_16x16x32_bf16 a[0:3], v[104:107], v[184:187], a[0:3]
  v_mfma_f32_16x16x32_bf16 a[4:7], v[104:107], v[188:191], a[4:7]
  v_mfma_f32_16x16x32_bf16 a[8:11], v[104:107], v[192:195], a[8:11]
  v_mfma_f32_16x16x32_bf16 a[12:15], v[104:107], v[196:199], a[12:15]
  v_mfma_f32_16x16x32_bf16 a[16:19], v[108:111], v[184:187], a[16:19]
  v_mfma_f32_16x16x32_bf16 a[20:23], v[108:111], v[188:191], a[20:23]
  v_mfma_f32_16x16x32_bf16 a[24:27], v[108:111], v[192:195], a[24:27]
  v_mfma_f32_16x16x32_bf16 a[28:31], v[108:111], v[196:199], a[28:31]
  v_mfma_f32_16x16x32_bf16 a[32:35], v[112:115], v[184:187], a[32:35]
  v_mfma_f32_16x16x32_bf16 a[36:39], v[112:115], v[188:191], a[36:39]
  v_mfma_f32_16x16x32_bf16 a[40:43], v[112:115], v[192:195], a[40:43]
  v_mfma_f32_16x16x32_bf16 a[44:47], v[112:115], v[196:199], a[44:47]
  v_mfma_f32_16x16x32_bf16 a[48:51], v[116:119], v[184:187], a[48:51]
  v_mfma_f32_16x16x32_bf16 a[52:55], v[116:119], v[188:191], a[52:55]
  v_mfma_f32_16x16x32_bf16 a[56:59], v[116:119], v[192:195], a[56:59]
  v_mfma_f32_16x16x32_bf16 a[60:63], v[116:119], v[196:199], a[60:63]
  v_mfma_f32_16x16x32_bf16 a[64:67], v[120:123], v[184:187], a[64:67]
  v_mfma_f32_16x16x32_bf16 a[68:71], v[120:123], v[188:191], a[68:71]
  v_mfma_f32_16x16x32_bf16 a[72:75], v[120:123], v[192:195], a[72:75]
  v_mfma_f32_16x16x32_bf16 a[76:79], v[120:123], v[196:199], a[76:79]
  v_mfma_f32_16x16x32_bf16 a[80:83], v[124:127], v[184:187], a[80:83]
  v_mfma_f32_16x16x32_bf16 a[84:87], v[124:127], v[188:191], a[84:87]
  v_mfma_f32_16x16x32_bf16 a[88:91], v[124:127], v[192:195], a[88:91]
  v_mfma_f32_16x16x32_bf16 a[92:95], v[124:127], v[196:199], a[92:95]
  v_mfma_f32_16x16x32_bf16 a[96:99], v[128:131], v[184:187], a[96:99]
  v_mfma_f32_16x16x32_bf16 a[100:103], v[128:131], v[188:191], a[100:103]
  v_mfma_f32_16x16x32_bf16 a[104:107], v[128:131], v[192:195], a[104:107]
  v_mfma_f32_16x16x32_bf16 a[108:111], v[128:131], v[196:199], a[108:111]
  v_mfma_f32_16x16x32_bf16 a[112:115], v[132:135], v[184:187], a[112:115]
  v_mfma_f32_16x16x32_bf16 a[116:119], v[132:135], v[188:191], a[116:119]
  v_mfma_f32_16x16x32_bf16 a[120:123], v[132:135], v[192:195], a[120:123]
  v_mfma_f32_16x16x32_bf16 a[124:127], v[132:135], v[196:199], a[124:127]
  v_mfma_f32_16x16x32_bf16 a[128:131], v[136:139], v[184:187], a[128:131]
  v_mfma_f32_16x16x32_bf16 a[132:135], v[136:139], v[188:191], a[132:135]
  v_mfma_f32_16x16x32_bf16 a[136:139], v[136:139], v[192:195], a[136:139]
  v_mfma_f32_16x16x32_bf16 a[140:143], v[136:139], v[196:199], a[140:143]
  v_mfma_f32_16x16x32_bf16 a[144:147], v[140:143], v[184:187], a[144:147]
  v_mfma_f32_16x16x32_bf16 a[148:151], v[140:143], v[188:191], a[148:151]
  v_mfma_f32_16x16x32_bf16 a[152:155], v[140:143], v[192:195], a[152:155]
  v_mfma_f32_16x16x32_bf16 a[156:159], v[140:143], v[196:199], a[156:159]
  buffer_load_dwordx4 v[104:107], v1, s[4:7], s30 offen offset:2048
  buffer_load_dwordx4 v[108:111], v1, s[4:7], s31 offen offset:2048
  buffer_load_dwordx4 v[112:115], v1, s[4:7], s32 offen offset:2048
  buffer_load_dwordx4 v[116:119], v1, s[4:7], s33 offen offset:2048
  buffer_load_dwordx4 v[120:123], v1, s[4:7], s34 offen offset:2048
  buffer_load_dwordx4 v[124:127], v1, s[4:7], s35 offen offset:2048
  buffer_load_dwordx4 v[128:131], v1, s[4:7], s36 offen offset:2048
  buffer_load_dwordx4 v[132:135], v1, s[4:7], s37 offen offset:2048
  buffer_load_dwordx4 v[136:139], v1, s[4:7], s38 offen offset:2048
  buffer_load_dwordx4 v[140:143], v1, s[4:7], s39 offen offset:2048
  s_waitcnt vmcnt(30)
  ds_read_b128 v[184:187], v1 offset:16384
  ds_read_b128 v[188:191], v1 offset:40960
  ds_read_b128 v[192:195], v6 offset:16384
  ds_read_b128 v[196:199], v6 offset:40960
  s_waitcnt lgkmcnt(4)
  v_mfma_f32_16x16x32_bf16 a[0:3], v[144:147], v[200:203], a[0:3]
  v_mfma_f32_16x16x32_bf16 a[4:7], v[144:147], v[204:207], a[4:7]
  v_mfma_f32_16x16x32_bf16 a[8:11], v[144:147], v[208:211], a[8:11]
  v_mfma_f32_16x16x32_bf16 a[12:15], v[144:147], v[212:215], a[12:15]
  v_mfma_f32_16x16x32_bf16 a[16:19], v[148:151], v[200:203], a[16:19]
  v_mfma_f32_16x16x32_bf16 a[20:23], v[148:151], v[204:207], a[20:23]
  v_mfma_f32_16x16x32_bf16 a[24:27], v[148:151], v[208:211], a[24:27]
  v_mfma_f32_16x16x32_bf16 a[28:31], v[148:151], v[212:215], a[28:31]
  v_mfma_f32_16x16x32_bf16 a[32:35], v[152:155], v[200:203], a[32:35]
  v_mfma_f32_16x16x32_bf16 a[36:39], v[152:155], v[204:207], a[36:39]
  v_mfma_f32_16x16x32_bf16 a[40:43], v[152:155], v[208:211], a[40:43]
  v_mfma_f32_16x16x32_bf16 a[44:47], v[152:155], v[212:215], a[44:47]
  v_mfma_f32_16x16x32_bf16 a[48:51], v[156:159], v[200:203], a[48:51]
  v_mfma_f32_16x16x32_bf16 a[52:55], v[156:159], v[204:207], a[52:55]
  v_mfma_f32_16x16x32_bf16 a[56:59], v[156:159], v[208:211], a[56:59]
  v_mfma_f32_16x16x32_bf16 a[60:63], v[156:159], v[212:215], a[60:63]
  v_mfma_f32_16x16x32_bf16 a[64:67], v[160:163], v[200:203], a[64:67]
  v_mfma_f32_16x16x32_bf16 a[68:71], v[160:163], v[204:207], a[68:71]
  v_mfma_f32_16x16x32_bf16 a[72:75], v[160:163], v[208:211], a[72:75]
  v_mfma_f32_16x16x32_bf16 a[76:79], v[160:163], v[212:215], a[76:79]
  v_mfma_f32_16x16x32_bf16 a[80:83], v[164:167], v[200:203], a[80:83]
  v_mfma_f32_16x16x32_bf16 a[84:87], v[164:167], v[204:207], a[84:87]
  v_mfma_f32_16x16x32_bf16 a[88:91], v[164:167], v[208:211], a[88:91]
  v_mfma_f32_16x16x32_bf16 a[92:95], v[164:167], v[212:215], a[92:95]
  v_mfma_f32_16x16x32_bf16 a[96:99], v[168:171], v[200:203], a[96:99]
  v_mfma_f32_16x16x32_bf16 a[100:103], v[168:171], v[204:207], a[100:103]
  v_mfma_f32_16x16x32_bf16 a[104:107], v[168:171], v[208:211], a[104:107]
  v_mfma_f32_16x16x32_bf16 a[108:111], v[168:171], v[212:215], a[108:111]
  v_mfma_f32_16x16x32_bf16 a[112:115], v[172:175], v[200:203], a[112:115]
  v_mfma_f32_16x16x32_bf16 a[116:119], v[172:175], v[204:207], a[116:119]
  v_mfma_f32_16x16x32_bf16 a[120:123], v[172:175], v[208:211], a[120:123]
  v_mfma_f32_16x16x32_bf16 a[124:127], v[172:175], v[212:215], a[124:127]
  v_mfma_f32_16x16x32_bf16 a[128:131], v[176:179], v[200:203], a[128:131]
  v_mfma_f32_16x16x32_bf16 a[132:135], v[176:179], v[204:207], a[132:135]
  v_mfma_f32_16x16x32_bf16 a[136:139], v[176:179], v[208:211], a[136:139]
  v_mfma_f32_16x16x32_bf16 a[140:143], v[176:179], v[212:215], a[140:143]
  v_mfma_f32_16x16x32_bf16 a[144:147], v[180:183], v[200:203], a[144:147]
  v_mfma_f32_16x16x32_bf16 a[148:151], v[180:183], v[204:207], a[148:151]
  v_mfma_f32_16x16x32_bf16 a[152:155], v[180:183], v[208:211], a[152:155]
  v_mfma_f32_16x16x32_bf16 a[156:159], v[180:183], v[212:215], a[156:159]
  buffer_load_dwordx4 v[144:147], v1, s[4:7], s30 offen offset:3072
  buffer_load_dwordx4 v[148:151], v1, s[4:7], s31 offen offset:3072
  buffer_load_dwordx4 v[152:155], v1, s[4:7], s32 offen offset:3072
  buffer_load_dwordx4 v[156:159], v1, s[4:7], s33 offen offset:3072
  buffer_load_dwordx4 v[160:163], v1, s[4:7], s34 offen offset:3072
  buffer_load_dwordx4 v[164:167], v1, s[4:7], s35 offen offset:3072
  buffer_load_dwordx4 v[168:171], v1, s[4:7], s36 offen offset:3072
  buffer_load_dwordx4 v[172:175], v1, s[4:7], s37 offen offset:3072
  buffer_load_dwordx4 v[176:179], v1, s[4:7], s38 offen offset:3072
  buffer_load_dwordx4 v[180:183], v1, s[4:7], s39 offen offset:3072
  s_add_u32 s30, s30, 4096
  s_add_u32 s31, s31, 4096
  s_add_u32 s32, s32, 4096
  s_add_u32 s33, s33, 4096
  s_add_u32 s34, s34, 4096
  s_add_u32 s35, s35, 4096
  s_add_u32 s36, s36, 4096
  s_add_u32 s37, s37, 4096
  s_add_u32 s38, s38, 4096
  s_add_u32 s39, s39, 4096
  s_waitcnt vmcnt(30)
  ds_read_b128 v[200:203], v1 offset:17408
  ds_read_b128 v[204:207], v1 offset:41984
  ds_read_b128 v[208:211], v6 offset:17408
  ds_read_b128 v[212:215], v6 offset:41984
  s_waitcnt lgkmcnt(4)
  v_mfma_f32_16x16x32_bf16 a[0:3], v[24:27], v[184:187], a[0:3]
  v_mfma_f32_16x16x32_bf16 a[4:7], v[24:27], v[188:191], a[4:7]
  v_mfma_f32_16x16x32_bf16 a[8:11], v[24:27], v[192:195], a[8:11]
  v_mfma_f32_16x16x32_bf16 a[12:15], v[24:27], v[196:199], a[12:15]
  v_mfma_f32_16x16x32_bf16 a[16:19], v[28:31], v[184:187], a[16:19]
  v_mfma_f32_16x16x32_bf16 a[20:23], v[28:31], v[188:191], a[20:23]
  v_mfma_f32_16x16x32_bf16 a[24:27], v[28:31], v[192:195], a[24:27]
  v_mfma_f32_16x16x32_bf16 a[28:31], v[28:31], v[196:199], a[28:31]
  v_mfma_f32_16x16x32_bf16 a[32:35], v[32:35], v[184:187], a[32:35]
  v_mfma_f32_16x16x32_bf16 a[36:39], v[32:35], v[188:191], a[36:39]
  v_mfma_f32_16x16x32_bf16 a[40:43], v[32:35], v[192:195], a[40:43]
  v_mfma_f32_16x16x32_bf16 a[44:47], v[32:35], v[196:199], a[44:47]
  v_mfma_f32_16x16x32_bf16 a[48:51], v[36:39], v[184:187], a[48:51]
  v_mfma_f32_16x16x32_bf16 a[52:55], v[36:39], v[188:191], a[52:55]
  v_mfma_f32_16x16x32_bf16 a[56:59], v[36:39], v[192:195], a[56:59]
  v_mfma_f32_16x16x32_bf16 a[60:63], v[36:39], v[196:199], a[60:63]
  v_mfma_f32_16x16x32_bf16 a[64:67], v[40:43], v[184:187], a[64:67]
  v_mfma_f32_16x16x32_bf16 a[68:71], v[40:43], v[188:191], a[68:71]
  v_mfma_f32_16x16x32_bf16 a[72:75], v[40:43], v[192:195], a[72:75]
  v_mfma_f32_16x16x32_bf16 a[76:79], v[40:43], v[196:199], a[76:79]
  v_mfma_f32_16x16x32_bf16 a[80:83], v[44:47], v[184:187], a[80:83]
  v_mfma_f32_16x16x32_bf16 a[84:87], v[44:47], v[188:191], a[84:87]
  v_mfma_f32_16x16x32_bf16 a[88:91], v[44:47], v[192:195], a[88:91]
  v_mfma_f32_16x16x32_bf16 a[92:95], v[44:47], v[196:199], a[92:95]
  v_mfma_f32_16x16x32_bf16 a[96:99], v[48:51], v[184:187], a[96:99]
  v_mfma_f32_16x16x32_bf16 a[100:103], v[48:51], v[188:191], a[100:103]
  v_mfma_f32_16x16x32_bf16 a[104:107], v[48:51], v[192:195], a[104:107]
  v_mfma_f32_16x16x32_bf16 a[108:111], v[48:51], v[196:199], a[108:111]
  v_mfma_f32_16x16x32_bf16 a[112:115], v[52:55], v[184:187], a[112:115]
  v_mfma_f32_16x16x32_bf16 a[116:119], v[52:55], v[188:191], a[116:119]
  v_mfma_f32_16x16x32_bf16 a[120:123], v[52:55], v[192:195], a[120:123]
  v_mfma_f32_16x16x32_bf16 a[124:127], v[52:55], v[196:199], a[124:127]
  v_mfma_f32_16x16x32_bf16 a[128:131], v[56:59], v[184:187], a[128:131]
  v_mfma_f32_16x16x32_bf16 a[132:135], v[56:59], v[188:191], a[132:135]
  v_mfma_f32_16x16x32_bf16 a[136:139], v[56:59], v[192:195], a[136:139]
  v_mfma_f32_16x16x32_bf16 a[140:143], v[56:59], v[196:199], a[140:143]
  v_mfma_f32_16x16x32_bf16 a[144:147], v[60:63], v[184:187], a[144:147]
  v_mfma_f32_16x16x32_bf16 a[148:151], v[60:63], v[188:191], a[148:151]
  v_mfma_f32_16x16x32_bf16 a[152:155], v[60:63], v[192:195], a[152:155]
  v_mfma_f32_16x16x32_bf16 a[156:159], v[60:63], v[196:199], a[156:159]
  buffer_load_dwordx4 v[24:27], v1, s[4:7], s30 offen offset:0
  buffer_load_dwordx4 v[28:31], v1, s[4:7], s31 offen offset:0
  buffer_load_dwordx4 v[32:35], v1, s[4:7], s32 offen offset:0
  buffer_load_dwordx4 v[36:39], v1, s[4:7], s33 offen offset:0
  buffer_load_dwordx4 v[40:43], v1, s[4:7], s34 offen offset:0
  buffer_load_dwordx4 v[44:47], v1, s[4:7], s35 offen offset:0
  buffer_load_dwordx4 v[48:51], v1, s[4:7], s36 offen offset:0
  buffer_load_dwordx4 v[52:55], v1, s[4:7], s37 offen offset:0
  buffer_load_dwordx4 v[56:59], v1, s[4:7], s38 offen offset:0
  buffer_load_dwordx4 v[60:63], v1, s[4:7], s39 offen offset:0
  s_waitcnt vmcnt(30)
  ds_read_b128 v[184:187], v1 offset:18432
  ds_read_b128 v[188:191], v1 offset:43008
  ds_read_b128 v[192:195], v6 offset:18432
  ds_read_b128 v[196:199], v6 offset:43008
  s_waitcnt lgkmcnt(4)
  v_mfma_f32_16x16x32_bf16 a[0:3], v[64:67], v[200:203], a[0:3]
  v_mfma_f32_16x16x32_bf16 a[4:7], v[64:67], v[204:207], a[4:7]
  v_mfma_f32_16x16x32_bf16 a[8:11], v[64:67], v[208:211], a[8:11]
  v_mfma_f32_16x16x32_bf16 a[12:15], v[64:67], v[212:215], a[12:15]
  v_mfma_f32_16x16x32_bf16 a[16:19], v[68:71], v[200:203], a[16:19]
  v_mfma_f32_16x16x32_bf16 a[20:23], v[68:71], v[204:207], a[20:23]
  v_mfma_f32_16x16x32_bf16 a[24:27], v[68:71], v[208:211], a[24:27]
  v_mfma_f32_16x16x32_bf16 a[28:31], v[68:71], v[212:215], a[28:31]
  v_mfma_f32_16x16x32_bf16 a[32:35], v[72:75], v[200:203], a[32:35]
  v_mfma_f32_16x16x32_bf16 a[36:39], v[72:75], v[204:207], a[36:39]
  v_mfma_f32_16x16x32_bf16 a[40:43], v[72:75], v[208:211], a[40:43]
  v_mfma_f32_16x16x32_bf16 a[44:47], v[72:75], v[212:215], a[44:47]
  v_mfma_f32_16x16x32_bf16 a[48:51], v[76:79], v[200:203], a[48:51]
  v_mfma_f32_16x16x32_bf16 a[52:55], v[76:79], v[204:207], a[52:55]
  v_mfma_f32_16x16x32_bf16 a[56:59], v[76:79], v[208:211], a[56:59]
  v_mfma_f32_16x16x32_bf16 a[60:63], v[76:79], v[212:215], a[60:63]
  v_mfma_f32_16x16x32_bf16 a[64:67], v[80:83], v[200:203], a[64:67]
  v_mfma_f32_16x16x32_bf16 a[68:71], v[80:83], v[204:207], a[68:71]
  v_mfma_f32_16x16x32_bf16 a[72:75], v[80:83], v[208:211], a[72:75]
  v_mfma_f32_16x16x32_bf16 a[76:79], v[80:83], v[212:215], a[76:79]
  v_mfma_f32_16x16x32_bf16 a[80:83], v[84:87], v[200:203], a[80:83]
  v_mfma_f32_16x16x32_bf16 a[84:87], v[84:87], v[204:207], a[84:87]
  v_mfma_f32_16x16x32_bf16 a[88:91], v[84:87], v[208:211], a[88:91]
  v_mfma_f32_16x16x32_bf16 a[92:95], v[84:87], v[212:215], a[92:95]
  v_mfma_f32_16x16x32_bf16 a[96:99], v[88:91], v[200:203], a[96:99]
  v_mfma_f32_16x16x32_bf16 a[100:103], v[88:91], v[204:207], a[100:103]
  v_mfma_f32_16x16x32_bf16 a[104:107], v[88:91], v[208:211], a[104:107]
  v_mfma_f32_16x16x32_bf16 a[108:111], v[88:91], v[212:215], a[108:111]
  v_mfma_f32_16x16x32_bf16 a[112:115], v[92:95], v[200:203], a[112:115]
  v_mfma_f32_16x16x32_bf16 a[116:119], v[92:95], v[204:207], a[116:119]
  v_mfma_f32_16x16x32_bf16 a[120:123], v[92:95], v[208:211], a[120:123]
  v_mfma_f32_16x16x32_bf16 a[124:127], v[92:95], v[212:215], a[124:127]
  v_mfma_f32_16x16x32_bf16 a[128:131], v[96:99], v[200:203], a[128:131]
  v_mfma_f32_16x16x32_bf16 a[132:135], v[96:99], v[204:207], a[132:135]
  v_mfma_f32_16x16x32_bf16 a[136:139], v[96:99], v[208:211], a[136:139]
  v_mfma_f32_16x16x32_bf16 a[140:143], v[96:99], v[212:215], a[140:143]
  v_mfma_f32_16x16x32_bf16 a[144:147], v[100:103], v[200:203], a[144:147]
  v_mfma_f32_16x16x32_bf16 a[148:151], v[100:103], v[204:207], a[148:151]
  v_mfma_f32_16x16x32_bf16 a[152:155], v[100:103], v[208:211], a[152:155]
  v_mfma_f32_16x16x32_bf16 a[156:159], v[100:103], v[212:215], a[156:159]
  buffer_load_dwordx4 v[64:67], v1, s[4:7], s30 offen offset:1024
  buffer_load_dwordx4 v[68:71], v1, s[4:7], s31 offen offset:1024
  buffer_load_dwordx4 v[72:75], v1, s[4:7], s32 offen offset:1024
  buffer_load_dwordx4 v[76:79], v1, s[4:7], s33 offen offset:1024
  buffer_load_dwordx4 v[80:83], v1, s[4:7], s34 offen offset:1024
  buffer_load_dwordx4 v[84:87], v1, s[4:7], s35 offen offset:1024
  buffer_load_dwordx4 v[88:91], v1, s[4:7], s36 offen offset:1024
  buffer_load_dwordx4 v[92:95], v1, s[4:7], s37 offen offset:1024
  buffer_load_dwordx4 v[96:99], v1, s[4:7], s38 offen offset:1024
  buffer_load_dwordx4 v[100:103], v1, s[4:7], s39 offen offset:1024
  s_waitcnt vmcnt(30)
  ds_read_b128 v[200:203], v1 offset:19456
  ds_read_b128 v[204:207], v1 offset:44032
  ds_read_b128 v[208:211], v6 offset:19456
  ds_read_b128 v[212:215], v6 offset:44032
  s_waitcnt lgkmcnt(4)
  v_mfma_f32_16x16x32_bf16 a[0:3], v[104:107], v[184:187], a[0:3]
  v_mfma_f32_16x16x32_bf16 a[4:7], v[104:107], v[188:191], a[4:7]
  v_mfma_f32_16x16x32_bf16 a[8:11], v[104:107], v[192:195], a[8:11]
  v_mfma_f32_16x16x32_bf16 a[12:15], v[104:107], v[196:199], a[12:15]
  v_mfma_f32_16x16x32_bf16 a[16:19], v[108:111], v[184:187], a[16:19]
  v_mfma_f32_16x16x32_bf16 a[20:23], v[108:111], v[188:191], a[20:23]
  v_mfma_f32_16x16x32_bf16 a[24:27], v[108:111], v[192:195], a[24:27]
  v_mfma_f32_16x16x32_bf16 a[28:31], v[108:111], v[196:199], a[28:31]
  v_mfma_f32_16x16x32_bf16 a[32:35], v[112:115], v[184:187], a[32:35]
  v_mfma_f32_16x16x32_bf16 a[36:39], v[112:115], v[188:191], a[36:39]
  v_mfma_f32_16x16x32_bf16 a[40:43], v[112:115], v[192:195], a[40:43]
  v_mfma_f32_16x16x32_bf16 a[44:47], v[112:115], v[196:199], a[44:47]
  v_mfma_f32_16x16x32_bf16 a[48:51], v[116:119], v[184:187], a[48:51]
  v_mfma_f32_16x16x32_bf16 a[52:55], v[116:119], v[188:191], a[52:55]
  v_mfma_f32_16x16x32_bf16 a[56:59], v[116:119], v[192:195], a[56:59]
  v_mfma_f32_16x16x32_bf16 a[60:63], v[116:119], v[196:199], a[60:63]
  v_mfma_f32_16x16x32_bf16 a[64:67], v[120:123], v[184:187], a[64:67]
  v_mfma_f32_16x16x32_bf16 a[68:71], v[120:123], v[188:191], a[68:71]
  v_mfma_f32_16x16x32_bf16 a[72:75], v[120:123], v[192:195], a[72:75]
  v_mfma_f32_16x16x32_bf16 a[76:79], v[120:123], v[196:199], a[76:79]
  v_mfma_f32_16x16x32_bf16 a[80:83], v[124:127], v[184:187], a[80:83]
  v_mfma_f32_16x16x32_bf16 a[84:87], v[124:127], v[188:191], a[84:87]
  v_mfma_f32_16x16x32_bf16 a[88:91], v[124:127], v[192:195], a[88:91]
  v_mfma_f32_16x16x32_bf16 a[92:95], v[124:127], v[196:199], a[92:95]
  v_mfma_f32_16x16x32_bf16 a[96:99], v[128:131], v[184:187], a[96:99]
  v_mfma_f32_16x16x32_bf16 a[100:103], v[128:131], v[188:191], a[100:103]
  v_mfma_f32_16x16x32_bf16 a[104:107], v[128:131], v[192:195], a[104:107]
  v_mfma_f32_16x16x32_bf16 a[108:111], v[128:131], v[196:199], a[108:111]
  v_mfma_f32_16x16x32_bf16 a[112:115], v[132:135], v[184:187], a[112:115]
  v_mfma_f32_16x16x32_bf16 a[116:119], v[132:135], v[188:191], a[116:119]
  v_mfma_f32_16x16x32_bf16 a[120:123], v[132:135], v[192:195], a[120:123]
  v_mfma_f32_16x16x32_bf16 a[124:127], v[132:135], v[196:199], a[124:127]
  v_mfma_f32_16x16x32_bf16 a[128:131], v[136:139], v[184:187], a[128:131]
  v_mfma_f32_16x16x32_bf16 a[132:135], v[136:139], v[188:191], a[132:135]
  v_mfma_f32_16x16x32_bf16 a[136:139], v[136:139], v[192:195], a[136:139]
  v_mfma_f32_16x16x32_bf16 a[140:143], v[136:139], v[196:199], a[140:143]
  v_mfma_f32_16x16x32_bf16 a[144:147], v[140:143], v[184:187], a[144:147]
  v_mfma_f32_16x16x32_bf16 a[148:151], v[140:143], v[188:191], a[148:151]
  v_mfma_f32_16x16x32_bf16 a[152:155], v[140:143], v[192:195], a[152:155]
  v_mfma_f32_16x16x32_bf16 a[156:159], v[140:143], v[196:199], a[156:159]
  buffer_load_dwordx4 v[104:107], v1, s[4:7], s30 offen offset:2048
  buffer_load_dwordx4 v[108:111], v1, s[4:7], s31 offen offset:2048
  buffer_load_dwordx4 v[112:115], v1, s[4:7], s32 offen offset:2048
  buffer_load_dwordx4 v[116:119], v1, s[4:7], s33 offen offset:2048
  buffer_load_dwordx4 v[120:123], v1, s[4:7], s34 offen offset:2048
  buffer_load_dwordx4 v[124:127], v1, s[4:7], s35 offen offset:2048
  buffer_load_dwordx4 v[128:131], v1, s[4:7], s36 offen offset:2048
  buffer_load_dwordx4 v[132:135], v1, s[4:7], s37 offen offset:2048
  buffer_load_dwordx4 v[136:139], v1, s[4:7], s38 offen offset:2048
  buffer_load_dwordx4 v[140:143], v1, s[4:7], s39 offen offset:2048
  s_waitcnt vmcnt(30)
  ds_read_b128 v[184:187], v1 offset:20480
  ds_read_b128 v[188:191], v1 offset:45056
  ds_read_b128 v[192:195], v6 offset:20480
  ds_read_b128 v[196:199], v6 offset:45056
  s_waitcnt lgkmcnt(4)
  v_mfma_f32_16x16x32_bf16 a[0:3], v[144:147], v[200:203], a[0:3]
  v_mfma_f32_16x16x32_bf16 a[4:7], v[144:147], v[204:207], a[4:7]
  v_mfma_f32_16x16x32_bf16 a[8:11], v[144:147], v[208:211], a[8:11]
  v_mfma_f32_16x16x32_bf16 a[12:15], v[144:147], v[212:215], a[12:15]
  v_mfma_f32_16x16x32_bf16 a[16:19], v[148:151], v[200:203], a[16:19]
  v_mfma_f32_16x16x32_bf16 a[20:23], v[148:151], v[204:207], a[20:23]
  v_mfma_f32_16x16x32_bf16 a[24:27], v[148:151], v[208:211], a[24:27]
  v_mfma_f32_16x16x32_bf16 a[28:31], v[148:151], v[212:215], a[28:31]
  v_mfma_f32_16x16x32_bf16 a[32:35], v[152:155], v[200:203], a[32:35]
  v_mfma_f32_16x16x32_bf16 a[36:39], v[152:155], v[204:207], a[36:39]
  v_mfma_f32_16x16x32_bf16 a[40:43], v[152:155], v[208:211], a[40:43]
  v_mfma_f32_16x16x32_bf16 a[44:47], v[152:155], v[212:215], a[44:47]
  v_mfma_f32_16x16x32_bf16 a[48:51], v[156:159], v[200:203], a[48:51]
  v_mfma_f32_16x16x32_bf16 a[52:55], v[156:159], v[204:207], a[52:55]
  v_mfma_f32_16x16x32_bf16 a[56:59], v[156:159], v[208:211], a[56:59]
  v_mfma_f32_16x16x32_bf16 a[60:63], v[156:159], v[212:215], a[60:63]
  v_mfma_f32_16x16x32_bf16 a[64:67], v[160:163], v[200:203], a[64:67]
  v_mfma_f32_16x16x32_bf16 a[68:71], v[160:163], v[204:207], a[68:71]
  v_mfma_f32_16x16x32_bf16 a[72:75], v[160:163], v[208:211], a[72:75]
  v_mfma_f32_16x16x32_bf16 a[76:79], v[160:163], v[212:215], a[76:79]
  v_mfma_f32_16x16x32_bf16 a[80:83], v[164:167], v[200:203], a[80:83]
  v_mfma_f32_16x16x32_bf16 a[84:87], v[164:167], v[204:207], a[84:87]
  v_mfma_f32_16x16x32_bf16 a[88:91], v[164:167], v[208:211], a[88:91]
  v_mfma_f32_16x16x32_bf16 a[92:95], v[164:167], v[212:215], a[92:95]
  v_mfma_f32_16x16x32_bf16 a[96:99], v[168:171], v[200:203], a[96:99]
  v_mfma_f32_16x16x32_bf16 a[100:103], v[168:171], v[204:207], a[100:103]
  v_mfma_f32_16x16x32_bf16 a[104:107], v[168:171], v[208:211], a[104:107]
  v_mfma_f32_16x16x32_bf16 a[108:111], v[168:171], v[212:215], a[108:111]
  v_mfma_f32_16x16x32_bf16 a[112:115], v[172:175], v[200:203], a[112:115]
  v_mfma_f32_16x16x32_bf16 a[116:119], v[172:175], v[204:207], a[116:119]
  v_mfma_f32_16x16x32_bf16 a[120:123], v[172:175], v[208:211], a[120:123]
  v_mfma_f32_16x16x32_bf16 a[124:127], v[172:175], v[212:215], a[124:127]
  v_mfma_f32_16x16x32_bf16 a[128:131], v[176:179], v[200:203], a[128:131]
  v_mfma_f32_16x16x32_bf16 a[132:135], v[176:179], v[204:207], a[132:135]
  v_mfma_f32_16x16x32_bf16 a[136:139], v[176:179], v[208:211], a[136:139]
  v_mfma_f32_16x16x32_bf16 a[140:143], v[176:179], v[212:215], a[140:143]
  v_mfma_f32_16x16x32_bf16 a[144:147], v[180:183], v[200:203], a[144:147]
  v_mfma_f32_16x16x32_bf16 a[148:151], v[180:183], v[204:207], a[148:151]
  v_mfma_f32_16x16x32_bf16 a[152:155], v[180:183], v[208:211], a[152:155]
  v_mfma_f32_16x16x32_bf16 a[156:159], v[180:183], v[212:215], a[156:159]
  buffer_load_dwordx4 v[144:147], v1, s[4:7], s30 offen offset:3072
  buffer_load_dwordx4 v[148:151], v1, s[4:7], s31 offen offset:3072
  buffer_load_dwordx4 v[152:155], v1, s[4:7], s32 offen offset:3072
  buffer_load_dwordx4 v[156:159], v1, s[4:7], s33 offen offset:3072
  buffer_load_dwordx4 v[160:163], v1, s[4:7], s34 offen offset:3072
  buffer_load_dwordx4 v[164:167], v1, s[4:7], s35 offen offset:3072
  buffer_load_dwordx4 v[168:171], v1, s[4:7], s36 offen offset:3072
  buffer_load_dwordx4 v[172:175], v1, s[4:7], s37 offen offset:3072
  buffer_load_dwordx4 v[176:179], v1, s[4:7], s38 offen offset:3072
  buffer_load_dwordx4 v[180:183], v1, s[4:7], s39 offen offset:3072
  s_add_u32 s30, s30, 4096
  s_add_u32 s31, s31, 4096
  s_add_u32 s32, s32, 4096
  s_add_u32 s33, s33, 4096
  s_add_u32 s34, s34, 4096
  s_add_u32 s35, s35, 4096
  s_add_u32 s36, s36, 4096
  s_add_u32 s37, s37, 4096
  s_add_u32 s38, s38, 4096
  s_add_u32 s39, s39, 4096
  s_waitcnt vmcnt(30)
  ds_read_b128 v[200:203], v1 offset:21504
  ds_read_b128 v[204:207], v1 offset:46080
  ds_read_b128 v[208:211], v6 offset:21504
  ds_read_b128 v[212:215], v6 offset:46080
  s_waitcnt lgkmcnt(4)
  v_mfma_f32_16x16x32_bf16 a[0:3], v[24:27], v[184:187], a[0:3]
  v_mfma_f32_16x16x32_bf16 a[4:7], v[24:27], v[188:191], a[4:7]
  v_mfma_f32_16x16x32_bf16 a[8:11], v[24:27], v[192:195], a[8:11]
  v_mfma_f32_16x16x32_bf16 a[12:15], v[24:27], v[196:199], a[12:15]
  v_mfma_f32_16x16x32_bf16 a[16:19], v[28:31], v[184:187], a[16:19]
  v_mfma_f32_16x16x32_bf16 a[20:23], v[28:31], v[188:191], a[20:23]
  v_mfma_f32_16x16x32_bf16 a[24:27], v[28:31], v[192:195], a[24:27]
  v_mfma_f32_16x16x32_bf16 a[28:31], v[28:31], v[196:199], a[28:31]
  v_mfma_f32_16x16x32_bf16 a[32:35], v[32:35], v[184:187], a[32:35]
  v_mfma_f32_16x16x32_bf16 a[36:39], v[32:35], v[188:191], a[36:39]
  v_mfma_f32_16x16x32_bf16 a[40:43], v[32:35], v[192:195], a[40:43]
  v_mfma_f32_16x16x32_bf16 a[44:47], v[32:35], v[196:199], a[44:47]
  v_mfma_f32_16x16x32_bf16 a[48:51], v[36:39], v[184:187], a[48:51]
  v_mfma_f32_16x16x32_bf16 a[52:55], v[36:39], v[188:191], a[52:55]
  v_mfma_f32_16x16x32_bf16 a[56:59], v[36:39], v[192:195], a[56:59]
  v_mfma_f32_16x16x32_bf16 a[60:63], v[36:39], v[196:199], a[60:63]
  v_mfma_f32_16x16x32_bf16 a[64:67], v[40:43], v[184:187], a[64:67]
  v_mfma_f32_16x16x32_bf16 a[68:71], v[40:43], v[188:191], a[68:71]
  v_mfma_f32_16x16x32_bf16 a[72:75], v[40:43], v[192:195], a[72:75]
  v_mfma_f32_16x16x32_bf16 a[76:79], v[40:43], v[196:199], a[76:79]
  v_mfma_f32_16x16x32_bf16 a[80:83], v[44:47], v[184:187], a[80:83]
  v_mfma_f32_16x16x32_bf16 a[84:87], v[44:47], v[188:191], a[84:87]
  v_mfma_f32_16x16x32_bf16 a[88:91], v[44:47], v[192:195], a[88:91]
  v_mfma_f32_16x16x32_bf16 a[92:95], v[44:47], v[196:199], a[92:95]
  v_mfma_f32_16x16x32_bf16 a[96:99], v[48:51], v[184:187], a[96:99]
  v_mfma_f32_16x16x32_bf16 a[100:103], v[48:51], v[188:191], a[100:103]
  v_mfma_f32_16x16x32_bf16 a[104:107], v[48:51], v[192:195], a[104:107]
  v_mfma_f32_16x16x32_bf16 a[108:111], v[48:51], v[196:199], a[108:111]
  v_mfma_f32_16x16x32_bf16 a[112:115], v[52:55], v[184:187], a[112:115]
  v_mfma_f32_16x16x32_bf16 a[116:119], v[52:55], v[188:191], a[116:119]
  v_mfma_f32_16x16x32_bf16 a[120:123], v[52:55], v[192:195], a[120:123]
  v_mfma_f32_16x16x32_bf16 a[124:127], v[52:55], v[196:199], a[124:127]
  v_mfma_f32_16x16x32_bf16 a[128:131], v[56:59], v[184:187], a[128:131]
  v_mfma_f32_16x16x32_bf16 a[132:135], v[56:59], v[188:191], a[132:135]
  v_mfma_f32_16x16x32_bf16 a[136:139], v[56:59], v[192:195], a[136:139]
  v_mfma_f32_16x16x32_bf16 a[140:143], v[56:59], v[196:199], a[140:143]
  v_mfma_f32_16x16x32_bf16 a[144:147], v[60:63], v[184:187], a[144:147]
  v_mfma_f32_16x16x32_bf16 a[148:151], v[60:63], v[188:191], a[148:151]
  v_mfma_f32_16x16x32_bf16 a[152:155], v[60:63], v[192:195], a[152:155]
  v_mfma_f32_16x16x32_bf16 a[156:159], v[60:63], v[196:199], a[156:159]
  s_waitcnt vmcnt(20)
  ds_read_b128 v[184:187], v1 offset:22528
  ds_read_b128 v[188:191], v1 offset:47104
  ds_read_b128 v[192:195], v6 offset:22528
  ds_read_b128 v[196:199], v6 offset:47104
  s_waitcnt lgkmcnt(4)
  v_mfma_f32_16x16x32_bf16 a[0:3], v[64:67], v[200:203], a[0:3]
  v_mfma_f32_16x16x32_bf16 a[4:7], v[64:67], v[204:207], a[4:7]
  v_mfma_f32_16x16x32_bf16 a[8:11], v[64:67], v[208:211], a[8:11]
  v_mfma_f32_16x16x32_bf16 a[12:15], v[64:67], v[212:215], a[12:15]
  v_mfma_f32_16x16x32_bf16 a[16:19], v[68:71], v[200:203], a[16:19]
  v_mfma_f32_16x16x32_bf16 a[20:23], v[68:71], v[204:207], a[20:23]
  v_mfma_f32_16x16x32_bf16 a[24:27], v[68:71], v[208:211], a[24:27]
  v_mfma_f32_16x16x32_bf16 a[28:31], v[68:71], v[212:215], a[28:31]
  v_mfma_f32_16x16x32_bf16 a[32:35], v[72:75], v[200:203], a[32:35]
  v_mfma_f32_16x16x32_bf16 a[36:39], v[72:75], v[204:207], a[36:39]
  v_mfma_f32_16x16x32_bf16 a[40:43], v[72:75], v[208:211], a[40:43]
  v_mfma_f32_16x16x32_bf16 a[44:47], v[72:75], v[212:215], a[44:47]
  v_mfma_f32_16x16x32_bf16 a[48:51], v[76:79], v[200:203], a[48:51]
  v_mfma_f32_16x16x32_bf16 a[52:55], v[76:79], v[204:207], a[52:55]
  v_mfma_f32_16x16x32_bf16 a[56:59], v[76:79], v[208:211], a[56:59]
  v_mfma_f32_16x16x32_bf16 a[60:63], v[76:79], v[212:215], a[60:63]
  v_mfma_f32_16x16x32_bf16 a[64:67], v[80:83], v[200:203], a[64:67]
  v_mfma_f32_16x16x32_bf16 a[68:71], v[80:83], v[204:207], a[68:71]
  v_mfma_f32_16x16x32_bf16 a[72:75], v[80:83], v[208:211], a[72:75]
  v_mfma_f32_16x16x32_bf16 a[76:79], v[80:83], v[212:215], a[76:79]
  v_mfma_f32_16x16x32_bf16 a[80:83], v[84:87], v[200:203], a[80:83]
  v_mfma_f32_16x16x32_bf16 a[84:87], v[84:87], v[204:207], a[84:87]
  v_mfma_f32_16x16x32_bf16 a[88:91], v[84:87], v[208:211], a[88:91]
  v_mfma_f32_16x16x32_bf16 a[92:95], v[84:87], v[212:215], a[92:95]
  v_mfma_f32_16x16x32_bf16 a[96:99], v[88:91], v[200:203], a[96:99]
  v_mfma_f32_16x16x32_bf16 a[100:103], v[88:91], v[204:207], a[100:103]
  v_mfma_f32_16x16x32_bf16 a[104:107], v[88:91], v[208:211], a[104:107]
  v_mfma_f32_16x16x32_bf16 a[108:111], v[88:91], v[212:215], a[108:111]
  v_mfma_f32_16x16x32_bf16 a[112:115], v[92:95], v[200:203], a[112:115]
  v_mfma_f32_16x16x32_bf16 a[116:119], v[92:95], v[204:207], a[116:119]
  v_mfma_f32_16x16x32_bf16 a[120:123], v[92:95], v[208:211], a[120:123]
  v_mfma_f32_16x16x32_bf16 a[124:127], v[92:95], v[212:215], a[124:127]
  v_mfma_f32_16x16x32_bf16 a[128:131], v[96:99], v[200:203], a[128:131]
  v_mfma_f32_16x16x32_bf16 a[132:135], v[96:99], v[204:207], a[132:135]
  v_mfma_f32_16x16x32_bf16 a[136:139], v[96:99], v[208:211], a[136:139]
  v_mfma_f32_16x16x32_bf16 a[140:143], v[96:99], v[212:215], a[140:143]
  v_mfma_f32_16x16x32_bf16 a[144:147], v[100:103], v[200:203], a[144:147]
  v_mfma_f32_16x16x32_bf16 a[148:151], v[100:103], v[204:207], a[148:151]
  v_mfma_f32_16x16x32_bf16 a[152:155], v[100:103], v[208:211], a[152:155]
  v_mfma_f32_16x16x32_bf16 a[156:159], v[100:103], v[212:215], a[156:159]
  s_waitcnt vmcnt(10)
  ds_read_b128 v[200:203], v1 offset:23552
  ds_read_b128 v[204:207], v1 offset:48128
  ds_read_b128 v[208:211], v6 offset:23552
  ds_read_b128 v[212:215], v6 offset:48128
  s_waitcnt lgkmcnt(4)
  v_mfma_f32_16x16x32_bf16 a[0:3], v[104:107], v[184:187], a[0:3]
  v_mfma_f32_16x16x32_bf16 a[4:7], v[104:107], v[188:191], a[4:7]
  v_mfma_f32_16x16x32_bf16 a[8:11], v[104:107], v[192:195], a[8:11]
  v_mfma_f32_16x16x32_bf16 a[12:15], v[104:107], v[196:199], a[12:15]
  v_mfma_f32_16x16x32_bf16 a[16:19], v[108:111], v[184:187], a[16:19]
  v_mfma_f32_16x16x32_bf16 a[20:23], v[108:111], v[188:191], a[20:23]
  v_mfma_f32_16x16x32_bf16 a[24:27], v[108:111], v[192:195], a[24:27]
  v_mfma_f32_16x16x32_bf16 a[28:31], v[108:111], v[196:199], a[28:31]
  v_mfma_f32_16x16x32_bf16 a[32:35], v[112:115], v[184:187], a[32:35]
  v_mfma_f32_16x16x32_bf16 a[36:39], v[112:115], v[188:191], a[36:39]
  v_mfma_f32_16x16x32_bf16 a[40:43], v[112:115], v[192:195], a[40:43]
  v_mfma_f32_16x16x32_bf16 a[44:47], v[112:115], v[196:199], a[44:47]
  v_mfma_f32_16x16x32_bf16 a[48:51], v[116:119], v[184:187], a[48:51]
  v_mfma_f32_16x16x32_bf16 a[52:55], v[116:119], v[188:191], a[52:55]
  v_mfma_f32_16x16x32_bf16 a[56:59], v[116:119], v[192:195], a[56:59]
  v_mfma_f32_16x16x32_bf16 a[60:63], v[116:119], v[196:199], a[60:63]
  v_mfma_f32_16x16x32_bf16 a[64:67], v[120:123], v[184:187], a[64:67]
  v_mfma_f32_16x16x32_bf16 a[68:71], v[120:123], v[188:191], a[68:71]
  v_mfma_f32_16x16x32_bf16 a[72:75], v[120:123], v[192:195], a[72:75]
  v_mfma_f32_16x16x32_bf16 a[76:79], v[120:123], v[196:199], a[76:79]
  v_mfma_f32_16x16x32_bf16 a[80:83], v[124:127], v[184:187], a[80:83]
  v_mfma_f32_16x16x32_bf16 a[84:87], v[124:127], v[188:191], a[84:87]
  v_mfma_f32_16x16x32_bf16 a[88:91], v[124:127], v[192:195], a[88:91]
  v_mfma_f32_16x16x32_bf16 a[92:95], v[124:127], v[196:199], a[92:95]
  v_mfma_f32_16x16x32_bf16 a[96:99], v[128:131], v[184:187], a[96:99]
  v_mfma_f32_16x16x32_bf16 a[100:103], v[128:131], v[188:191], a[100:103]
  v_mfma_f32_16x16x32_bf16 a[104:107], v[128:131], v[192:195], a[104:107]
  v_mfma_f32_16x16x32_bf16 a[108:111], v[128:131], v[196:199], a[108:111]
  v_mfma_f32_16x16x32_bf16 a[112:115], v[132:135], v[184:187], a[112:115]
  v_mfma_f32_16x16x32_bf16 a[116:119], v[132:135], v[188:191], a[116:119]
  v_mfma_f32_16x16x32_bf16 a[120:123], v[132:135], v[192:195], a[120:123]
  v_mfma_f32_16x16x32_bf16 a[124:127], v[132:135], v[196:199], a[124:127]
  v_mfma_f32_16x16x32_bf16 a[128:131], v[136:139], v[184:187], a[128:131]
  v_mfma_f32_16x16x32_bf16 a[132:135], v[136:139], v[188:191], a[132:135]
  v_mfma_f32_16x16x32_bf16 a[136:139], v[136:139], v[192:195], a[136:139]
  v_mfma_f32_16x16x32_bf16 a[140:143], v[136:139], v[196:199], a[140:143]
  v_mfma_f32_16x16x32_bf16 a[144:147], v[140:143], v[184:187], a[144:147]
  v_mfma_f32_16x16x32_bf16 a[148:151], v[140:143], v[188:191], a[148:151]
  v_mfma_f32_16x16x32_bf16 a[152:155], v[140:143], v[192:195], a[152:155]
  v_mfma_f32_16x16x32_bf16 a[156:159], v[140:143], v[196:199], a[156:159]
  s_waitcnt vmcnt(0)
  s_waitcnt lgkmcnt(0)
  v_mfma_f32_16x16x32_bf16 a[0:3], v[144:147], v[200:203], a[0:3]
  v_mfma_f32_16x16x32_bf16 a[4:7], v[144:147], v[204:207], a[4:7]
  v_mfma_f32_16x16x32_bf16 a[8:11], v[144:147], v[208:211], a[8:11]
  v_mfma_f32_16x16x32_bf16 a[12:15], v[144:147], v[212:215], a[12:15]
  v_mfma_f32_16x16x32_bf16 a[16:19], v[148:151], v[200:203], a[16:19]
  v_mfma_f32_16x16x32_bf16 a[20:23], v[148:151], v[204:207], a[20:23]
  v_mfma_f32_16x16x32_bf16 a[24:27], v[148:151], v[208:211], a[24:27]
  v_mfma_f32_16x16x32_bf16 a[28:31], v[148:151], v[212:215], a[28:31]
  v_mfma_f32_16x16x32_bf16 a[32:35], v[152:155], v[200:203], a[32:35]
  v_mfma_f32_16x16x32_bf16 a[36:39], v[152:155], v[204:207], a[36:39]
  v_mfma_f32_16x16x32_bf16 a[40:43], v[152:155], v[208:211], a[40:43]
  v_mfma_f32_16x16x32_bf16 a[44:47], v[152:155], v[212:215], a[44:47]
  v_mfma_f32_16x16x32_bf16 a[48:51], v[156:159], v[200:203], a[48:51]
  v_mfma_f32_16x16x32_bf16 a[52:55], v[156:159], v[204:207], a[52:55]
  v_mfma_f32_16x16x32_bf16 a[56:59], v[156:159], v[208:211], a[56:59]
  v_mfma_f32_16x16x32_bf16 a[60:63], v[156:159], v[212:215], a[60:63]
  v_mfma_f32_16x16x32_bf16 a[64:67], v[160:163], v[200:203], a[64:67]
  v_mfma_f32_16x16x32_bf16 a[68:71], v[160:163], v[204:207], a[68:71]
  v_mfma_f32_16x16x32_bf16 a[72:75], v[160:163], v[208:211], a[72:75]
  v_mfma_f32_16x16x32_bf16 a[76:79], v[160:163], v[212:215], a[76:79]
  v_mfma_f32_16x16x32_bf16 a[80:83], v[164:167], v[200:203], a[80:83]
  v_mfma_f32_16x16x32_bf16 a[84:87], v[164:167], v[204:207], a[84:87]
  v_mfma_f32_16x16x32_bf16 a[88:91], v[164:167], v[208:211], a[88:91]
  v_mfma_f32_16x16x32_bf16 a[92:95], v[164:167], v[212:215], a[92:95]
  v_mfma_f32_16x16x32_bf16 a[96:99], v[168:171], v[200:203], a[96:99]
  v_mfma_f32_16x16x32_bf16 a[100:103], v[168:171], v[204:207], a[100:103]
  v_mfma_f32_16x16x32_bf16 a[104:107], v[168:171], v[208:211], a[104:107]
  v_mfma_f32_16x16x32_bf16 a[108:111], v[168:171], v[212:215], a[108:111]
  v_mfma_f32_16x16x32_bf16 a[112:115], v[172:175], v[200:203], a[112:115]
  v_mfma_f32_16x16x32_bf16 a[116:119], v[172:175], v[204:207], a[116:119]
  v_mfma_f32_16x16x32_bf16 a[120:123], v[172:175], v[208:211], a[120:123]
  v_mfma_f32_16x16x32_bf16 a[124:127], v[172:175], v[212:215], a[124:127]
  v_mfma_f32_16x16x32_bf16 a[128:131], v[176:179], v[200:203], a[128:131]
  v_mfma_f32_16x16x32_bf16 a[132:135], v[176:179], v[204:207], a[132:135]
  v_mfma_f32_16x16x32_bf16 a[136:139], v[176:179], v[208:211], a[136:139]
  v_mfma_f32_16x16x32_bf16 a[140:143], v[176:179], v[212:215], a[140:143]
  v_mfma_f32_16x16x32_bf16 a[144:147], v[180:183], v[200:203], a[144:147]
  v_mfma_f32_16x16x32_bf16 a[148:151], v[180:183], v[204:207], a[148:151]
  v_mfma_f32_16x16x32_bf16 a[152:155], v[180:183], v[208:211], a[152:155]
  v_mfma_f32_16x16x32_bf16 a[156:159], v[180:183], v[212:215], a[156:159]
  s_lshl_b32 s16, s13, 7
  s_lshl_b32 s17, s14, 2
  s_add_u32 s16, s16, s17
  s_mul_i32 s16, s16, 20
  s_mul_i32 s17, s12, 5
  s_add_u32 s16, s16, s17
  s_lshl_b32 s16, s16, 10
  s_add_u32 s16, s16, 178257920
  s_nop 7
  s_add_u32 s17, s16, 0
  v_accvgpr_read_b32 v24, a0
  v_accvgpr_read_b32 v25, a1
  v_accvgpr_read_b32 v26, a2
  v_accvgpr_read_b32 v27, a3
  v_accvgpr_read_b32 v28, a16
  v_accvgpr_read_b32 v29, a17
  v_accvgpr_read_b32 v30, a18
  v_accvgpr_read_b32 v31, a19
  v_cvt_pk_bf16_f32 v32, v24, v25
  v_cvt_pk_bf16_f32 v33, v26, v27
  v_cvt_pk_bf16_f32 v34, v28, v29
  v_cvt_pk_bf16_f32 v35, v30, v31
  buffer_store_dwordx4 v[32:35], v1, s[4:7], s17 offen offset:0
  v_accvgpr_read_b32 v36, a32
  v_accvgpr_read_b32 v37, a33
  v_accvgpr_read_b32 v38, a34
  v_accvgpr_read_b32 v39, a35
  v_accvgpr_read_b32 v40, a48
  v_accvgpr_read_b32 v41, a49
  v_accvgpr_read_b32 v42, a50
  v_accvgpr_read_b32 v43, a51
  v_cvt_pk_bf16_f32 v44, v36, v37
  v_cvt_pk_bf16_f32 v45, v38, v39
  v_cvt_pk_bf16_f32 v46, v40, v41
  v_cvt_pk_bf16_f32 v47, v42, v43
  buffer_store_dwordx4 v[44:47], v1, s[4:7], s17 offen offset:1024
  v_accvgpr_read_b32 v48, a64
  v_accvgpr_read_b32 v49, a65
  v_accvgpr_read_b32 v50, a66
  v_accvgpr_read_b32 v51, a67
  v_accvgpr_read_b32 v52, a80
  v_accvgpr_read_b32 v53, a81
  v_accvgpr_read_b32 v54, a82
  v_accvgpr_read_b32 v55, a83
  v_cvt_pk_bf16_f32 v56, v48, v49
  v_cvt_pk_bf16_f32 v57, v50, v51
  v_cvt_pk_bf16_f32 v58, v52, v53
  v_cvt_pk_bf16_f32 v59, v54, v55
  buffer_store_dwordx4 v[56:59], v1, s[4:7], s17 offen offset:2048
  v_accvgpr_read_b32 v60, a96
  v_accvgpr_read_b32 v61, a97
  v_accvgpr_read_b32 v62, a98
  v_accvgpr_read_b32 v63, a99
  v_accvgpr_read_b32 v64, a112
  v_accvgpr_read_b32 v65, a113
  v_accvgpr_read_b32 v66, a114
  v_accvgpr_read_b32 v67, a115
  v_cvt_pk_bf16_f32 v68, v60, v61
  v_cvt_pk_bf16_f32 v69, v62, v63
  v_cvt_pk_bf16_f32 v70, v64, v65
  v_cvt_pk_bf16_f32 v71, v66, v67
  buffer_store_dwordx4 v[68:71], v1, s[4:7], s17 offen offset:3072
  v_accvgpr_read_b32 v24, a128
  v_accvgpr_read_b32 v25, a129
  v_accvgpr_read_b32 v26, a130
  v_accvgpr_read_b32 v27, a131
  v_accvgpr_read_b32 v28, a144
  v_accvgpr_read_b32 v29, a145
  v_accvgpr_read_b32 v30, a146
  v_accvgpr_read_b32 v31, a147
  v_cvt_pk_bf16_f32 v32, v24, v25
  v_cvt_pk_bf16_f32 v33, v26, v27
  v_cvt_pk_bf16_f32 v34, v28, v29
  v_cvt_pk_bf16_f32 v35, v30, v31
  s_add_u32 s17, s17, 4096
  buffer_store_dwordx4 v[32:35], v1, s[4:7], s17 offen offset:0
  s_add_u32 s17, s16, 20480
  v_accvgpr_read_b32 v36, a4
  v_accvgpr_read_b32 v37, a5
  v_accvgpr_read_b32 v38, a6
  v_accvgpr_read_b32 v39, a7
  v_accvgpr_read_b32 v40, a20
  v_accvgpr_read_b32 v41, a21
  v_accvgpr_read_b32 v42, a22
  v_accvgpr_read_b32 v43, a23
  v_cvt_pk_bf16_f32 v44, v36, v37
  v_cvt_pk_bf16_f32 v45, v38, v39
  v_cvt_pk_bf16_f32 v46, v40, v41
  v_cvt_pk_bf16_f32 v47, v42, v43
  buffer_store_dwordx4 v[44:47], v1, s[4:7], s17 offen offset:0
  v_accvgpr_read_b32 v48, a36
  v_accvgpr_read_b32 v49, a37
  v_accvgpr_read_b32 v50, a38
  v_accvgpr_read_b32 v51, a39
  v_accvgpr_read_b32 v52, a52
  v_accvgpr_read_b32 v53, a53
  v_accvgpr_read_b32 v54, a54
  v_accvgpr_read_b32 v55, a55
  v_cvt_pk_bf16_f32 v56, v48, v49
  v_cvt_pk_bf16_f32 v57, v50, v51
  v_cvt_pk_bf16_f32 v58, v52, v53
  v_cvt_pk_bf16_f32 v59, v54, v55
  buffer_store_dwordx4 v[56:59], v1, s[4:7], s17 offen offset:1024
  v_accvgpr_read_b32 v60, a68
  v_accvgpr_read_b32 v61, a69
  v_accvgpr_read_b32 v62, a70
  v_accvgpr_read_b32 v63, a71
  v_accvgpr_read_b32 v64, a84
  v_accvgpr_read_b32 v65, a85
  v_accvgpr_read_b32 v66, a86
  v_accvgpr_read_b32 v67, a87
  v_cvt_pk_bf16_f32 v68, v60, v61
  v_cvt_pk_bf16_f32 v69, v62, v63
  v_cvt_pk_bf16_f32 v70, v64, v65
  v_cvt_pk_bf16_f32 v71, v66, v67
  buffer_store_dwordx4 v[68:71], v1, s[4:7], s17 offen offset:2048
  v_accvgpr_read_b32 v24, a100
  v_accvgpr_read_b32 v25, a101
  v_accvgpr_read_b32 v26, a102
  v_accvgpr_read_b32 v27, a103
  v_accvgpr_read_b32 v28, a116
  v_accvgpr_read_b32 v29, a117
  v_accvgpr_read_b32 v30, a118
  v_accvgpr_read_b32 v31, a119
  v_cvt_pk_bf16_f32 v32, v24, v25
  v_cvt_pk_bf16_f32 v33, v26, v27
  v_cvt_pk_bf16_f32 v34, v28, v29
  v_cvt_pk_bf16_f32 v35, v30, v31
  buffer_store_dwordx4 v[32:35], v1, s[4:7], s17 offen offset:3072
  v_accvgpr_read_b32 v36, a132
  v_accvgpr_read_b32 v37, a133
  v_accvgpr_read_b32 v38, a134
  v_accvgpr_read_b32 v39, a135
  v_accvgpr_read_b32 v40, a148
  v_accvgpr_read_b32 v41, a149
  v_accvgpr_read_b32 v42, a150
  v_accvgpr_read_b32 v43, a151
  v_cvt_pk_bf16_f32 v44, v36, v37
  v_cvt_pk_bf16_f32 v45, v38, v39
  v_cvt_pk_bf16_f32 v46, v40, v41
  v_cvt_pk_bf16_f32 v47, v42, v43
  s_add_u32 s17, s17, 4096
  buffer_store_dwordx4 v[44:47], v1, s[4:7], s17 offen offset:0
  s_add_u32 s17, s16, 40960
  v_accvgpr_read_b32 v48, a8
  v_accvgpr_read_b32 v49, a9
  v_accvgpr_read_b32 v50, a10
  v_accvgpr_read_b32 v51, a11
  v_accvgpr_read_b32 v52, a24
  v_accvgpr_read_b32 v53, a25
  v_accvgpr_read_b32 v54, a26
  v_accvgpr_read_b32 v55, a27
  v_cvt_pk_bf16_f32 v56, v48, v49
  v_cvt_pk_bf16_f32 v57, v50, v51
  v_cvt_pk_bf16_f32 v58, v52, v53
  v_cvt_pk_bf16_f32 v59, v54, v55
  buffer_store_dwordx4 v[56:59], v1, s[4:7], s17 offen offset:0
  v_accvgpr_read_b32 v60, a40
  v_accvgpr_read_b32 v61, a41
  v_accvgpr_read_b32 v62, a42
  v_accvgpr_read_b32 v63, a43
  v_accvgpr_read_b32 v64, a56
  v_accvgpr_read_b32 v65, a57
  v_accvgpr_read_b32 v66, a58
  v_accvgpr_read_b32 v67, a59
  v_cvt_pk_bf16_f32 v68, v60, v61
  v_cvt_pk_bf16_f32 v69, v62, v63
  v_cvt_pk_bf16_f32 v70, v64, v65
  v_cvt_pk_bf16_f32 v71, v66, v67
  buffer_store_dwordx4 v[68:71], v1, s[4:7], s17 offen offset:1024
  v_accvgpr_read_b32 v24, a72
  v_accvgpr_read_b32 v25, a73
  v_accvgpr_read_b32 v26, a74
  v_accvgpr_read_b32 v27, a75
  v_accvgpr_read_b32 v28, a88
  v_accvgpr_read_b32 v29, a89
  v_accvgpr_read_b32 v30, a90
  v_accvgpr_read_b32 v31, a91
  v_cvt_pk_bf16_f32 v32, v24, v25
  v_cvt_pk_bf16_f32 v33, v26, v27
  v_cvt_pk_bf16_f32 v34, v28, v29
  v_cvt_pk_bf16_f32 v35, v30, v31
  buffer_store_dwordx4 v[32:35], v1, s[4:7], s17 offen offset:2048
  v_accvgpr_read_b32 v36, a104
  v_accvgpr_read_b32 v37, a105
  v_accvgpr_read_b32 v38, a106
  v_accvgpr_read_b32 v39, a107
  v_accvgpr_read_b32 v40, a120
  v_accvgpr_read_b32 v41, a121
  v_accvgpr_read_b32 v42, a122
  v_accvgpr_read_b32 v43, a123
  v_cvt_pk_bf16_f32 v44, v36, v37
  v_cvt_pk_bf16_f32 v45, v38, v39
  v_cvt_pk_bf16_f32 v46, v40, v41
  v_cvt_pk_bf16_f32 v47, v42, v43
  buffer_store_dwordx4 v[44:47], v1, s[4:7], s17 offen offset:3072
  v_accvgpr_read_b32 v48, a136
  v_accvgpr_read_b32 v49, a137
  v_accvgpr_read_b32 v50, a138
  v_accvgpr_read_b32 v51, a139
  v_accvgpr_read_b32 v52, a152
  v_accvgpr_read_b32 v53, a153
  v_accvgpr_read_b32 v54, a154
  v_accvgpr_read_b32 v55, a155
  v_cvt_pk_bf16_f32 v56, v48, v49
  v_cvt_pk_bf16_f32 v57, v50, v51
  v_cvt_pk_bf16_f32 v58, v52, v53
  v_cvt_pk_bf16_f32 v59, v54, v55
  s_add_u32 s17, s17, 4096
  buffer_store_dwordx4 v[56:59], v1, s[4:7], s17 offen offset:0
  s_add_u32 s17, s16, 61440
  v_accvgpr_read_b32 v60, a12
  v_accvgpr_read_b32 v61, a13
  v_accvgpr_read_b32 v62, a14
  v_accvgpr_read_b32 v63, a15
  v_accvgpr_read_b32 v64, a28
  v_accvgpr_read_b32 v65, a29
  v_accvgpr_read_b32 v66, a30
  v_accvgpr_read_b32 v67, a31
  v_cvt_pk_bf16_f32 v68, v60, v61
  v_cvt_pk_bf16_f32 v69, v62, v63
  v_cvt_pk_bf16_f32 v70, v64, v65
  v_cvt_pk_bf16_f32 v71, v66, v67
  buffer_store_dwordx4 v[68:71], v1, s[4:7], s17 offen offset:0
  v_accvgpr_read_b32 v24, a44
  v_accvgpr_read_b32 v25, a45
  v_accvgpr_read_b32 v26, a46
  v_accvgpr_read_b32 v27, a47
  v_accvgpr_read_b32 v28, a60
  v_accvgpr_read_b32 v29, a61
  v_accvgpr_read_b32 v30, a62
  v_accvgpr_read_b32 v31, a63
  v_cvt_pk_bf16_f32 v32, v24, v25
  v_cvt_pk_bf16_f32 v33, v26, v27
  v_cvt_pk_bf16_f32 v34, v28, v29
  v_cvt_pk_bf16_f32 v35, v30, v31
  buffer_store_dwordx4 v[32:35], v1, s[4:7], s17 offen offset:1024
  v_accvgpr_read_b32 v36, a76
  v_accvgpr_read_b32 v37, a77
  v_accvgpr_read_b32 v38, a78
  v_accvgpr_read_b32 v39, a79
  v_accvgpr_read_b32 v40, a92
  v_accvgpr_read_b32 v41, a93
  v_accvgpr_read_b32 v42, a94
  v_accvgpr_read_b32 v43, a95
  v_cvt_pk_bf16_f32 v44, v36, v37
  v_cvt_pk_bf16_f32 v45, v38, v39
  v_cvt_pk_bf16_f32 v46, v40, v41
  v_cvt_pk_bf16_f32 v47, v42, v43
  buffer_store_dwordx4 v[44:47], v1, s[4:7], s17 offen offset:2048
  v_accvgpr_read_b32 v48, a108
  v_accvgpr_read_b32 v49, a109
  v_accvgpr_read_b32 v50, a110
  v_accvgpr_read_b32 v51, a111
  v_accvgpr_read_b32 v52, a124
  v_accvgpr_read_b32 v53, a125
  v_accvgpr_read_b32 v54, a126
  v_accvgpr_read_b32 v55, a127
  v_cvt_pk_bf16_f32 v56, v48, v49
  v_cvt_pk_bf16_f32 v57, v50, v51
  v_cvt_pk_bf16_f32 v58, v52, v53
  v_cvt_pk_bf16_f32 v59, v54, v55
  buffer_store_dwordx4 v[56:59], v1, s[4:7], s17 offen offset:3072
  v_accvgpr_read_b32 v60, a140
  v_accvgpr_read_b32 v61, a141
  v_accvgpr_read_b32 v62, a142
  v_accvgpr_read_b32 v63, a143
  v_accvgpr_read_b32 v64, a156
  v_accvgpr_read_b32 v65, a157
  v_accvgpr_read_b32 v66, a158
  v_accvgpr_read_b32 v67, a159
  v_cvt_pk_bf16_f32 v68, v60, v61
  v_cvt_pk_bf16_f32 v69, v62, v63
  v_cvt_pk_bf16_f32 v70, v64, v65
  v_cvt_pk_bf16_f32 v71, v66, v67
  s_add_u32 s17, s17, 4096
  buffer_store_dwordx4 v[68:71], v1, s[4:7], s17 offen offset:0
fin_exit1:
  s_endpgm
.globl redln1_kernel
.p2align 8
.type redln1_kernel,@function
redln1_kernel:
  s_cmp_ge_u32 s2, 128
  s_cbranch_scc1 redln1_exit1
  s_load_dwordx2 s[12:13], s[0:1], 96
  s_load_dwordx2 s[14:15], s[0:1], 0
  v_lshrrev_b32 v2, 6, v0
  v_and_b32 v3, 63, v0
  s_nop 0
  v_readfirstlane_b32 s16, v2
  v_lshlrev_b32 v14, 4, v3
  s_waitcnt lgkmcnt(0)
  s_mov_b32 s4, s12
  s_mov_b32 s5, s13
  s_mov_b32 s6, 0x10000000
  s_mov_b32 s7, 0x20000
  s_mov_b32 s8, s14
  s_mov_b32 s9, s15
  s_mov_b32 s10, 2621440
  s_mov_b32 s11, 0x20000
  s_mov_b32 s20, 0
  v_and_b32 v2, 15, v3
  v_lshrrev_b32 v4, 4, v3
  s_lshl_b32 s17, s2, 4
  v_add_u32 v15, s17, v2
  v_mul_u32_u24 v15, 1280, v15
  v_lshl_add_u32 v15, v4, 4, v15
  s_mul_i32 s17, s16, 320
  s_add_u32 s20, s20, s17
  s_add_u32 s21, s17, 150994944
  s_mul_i32 s22, s2, 20
  s_mul_i32 s23, s16, 5
  s_add_u32 s22, s22, s23
  s_lshl_b32 s22, s22, 10
  s_add_u32 s22, s22, 178257920
  s_add_u32 s24, s22, 0
  s_add_u32 s25, s22, 2621440
  s_add_u32 s26, s22, 5242880
  s_add_u32 s27, s22, 7864320
  s_add_u32 s28, s22, 10485760
  s_add_u32 s29, s22, 13107200
  s_add_u32 s30, s22, 15728640
  s_add_u32 s31, s22, 18350080
  v_add_u32 v6, 0x1000, v14
  buffer_load_dwordx4 v[16:19], v15, s[8:11], s20 offen offset:0
  buffer_load_dwordx4 v[20:23], v15, s[8:11], s20 offen offset:64
  buffer_load_dwordx4 v[24:27], v15, s[8:11], s20 offen offset:128
  buffer_load_dwordx4 v[28:31], v15, s[8:11], s20 offen offset:192
  buffer_load_dwordx4 v[32:35], v15, s[8:11], s20 offen offset:256
  buffer_load_dwordx4 v[80:83], v14, s[4:7], s24 offen offset:0
  buffer_load_dwordx4 v[84:87], v14, s[4:7], s25 offen offset:0
  buffer_load_dwordx4 v[88:91], v14, s[4:7], s26 offen offset:0
  buffer_load_dwordx4 v[92:95], v14, s[4:7], s27 offen offset:0
  buffer_load_dwordx4 v[96:99], v14, s[4:7], s28 offen offset:0
  buffer_load_dwordx4 v[100:103], v14, s[4:7], s29 offen offset:0
  buffer_load_dwordx4 v[104:107], v14, s[4:7], s30 offen offset:0
  buffer_load_dwordx4 v[108:111], v14, s[4:7], s31 offen offset:0
  buffer_load_dwordx4 v[112:115], v14, s[4:7], s24 offen offset:1024
  buffer_load_dwordx4 v[116:119], v14, s[4:7], s25 offen offset:1024
  buffer_load_dwordx4 v[120:123], v14, s[4:7], s26 offen offset:1024
  buffer_load_dwordx4 v[124:127], v14, s[4:7], s27 offen offset:1024
  buffer_load_dwordx4 v[128:131], v14, s[4:7], s28 offen offset:1024
  buffer_load_dwordx4 v[132:135], v14, s[4:7], s29 offen offset:1024
  buffer_load_dwordx4 v[136:139], v14, s[4:7], s30 offen offset:1024
  buffer_load_dwordx4 v[140:143], v14, s[4:7], s31 offen offset:1024
  buffer_load_dwordx4 v[144:147], v14, s[4:7], s24 offen offset:2048
  buffer_load_dwordx4 v[148:151], v14, s[4:7], s25 offen offset:2048
  buffer_load_dwordx4 v[152:155], v14, s[4:7], s26 offen offset:2048
  buffer_load_dwordx4 v[156:159], v14, s[4:7], s27 offen offset:2048
  buffer_load_dwordx4 v[160:163], v14, s[4:7], s28 offen offset:2048
  buffer_load_dwordx4 v[164:167], v14, s[4:7], s29 offen offset:2048
  buffer_load_dwordx4 v[168:171], v14, s[4:7], s30 offen offset:2048
  buffer_load_dwordx4 v[172:175], v14, s[4:7], s31 offen offset:2048
  buffer_load_dwordx4 v[176:179], v14, s[4:7], s24 offen offset:3072
  buffer_load_dwordx4 v[180:183], v14, s[4:7], s25 offen offset:3072
  buffer_load_dwordx4 v[184:187], v14, s[4:7], s26 offen offset:3072
  buffer_load_dwordx4 v[188:191], v14, s[4:7], s27 offen offset:3072
  buffer_load_dwordx4 v[192:195], v14, s[4:7], s28 offen offset:3072
  buffer_load_dwordx4 v[196:199], v14, s[4:7], s29 offen offset:3072
  buffer_load_dwordx4 v[200:203], v14, s[4:7], s30 offen offset:3072
  buffer_load_dwordx4 v[204:207], v14, s[4:7], s31 offen offset:3072
  buffer_load_dwordx4 v[208:211], v6, s[4:7], s24 offen offset:0
  buffer_load_dwordx4 v[212:215], v6, s[4:7], s25 offen offset:0
  buffer_load_dwordx4 v[216:219], v6, s[4:7], s26 offen offset:0
  buffer_load_dwordx4 v[220:223], v6, s[4:7], s27 offen offset:0
  buffer_load_dwordx4 v[224:227], v6, s[4:7], s28 offen offset:0
  buffer_load_dwordx4 v[228:231], v6, s[4:7], s29 offen offset:0
  buffer_load_dwordx4 v[232:235], v6, s[4:7], s30 offen offset:0
  buffer_load_dwordx4 v[236:239], v6, s[4:7], s31 offen offset:0
  s_waitcnt vmcnt(32)
  v_lshlrev_b32 v36, 16, v80
  v_and_b32 v37, 0xffff0000, v80
  v_lshlrev_b32 v38, 16, v81
  v_and_b32 v39, 0xffff0000, v81
  v_lshlrev_b32 v40, 16, v82
  v_and_b32 v41, 0xffff0000, v82
  v_lshlrev_b32 v42, 16, v83
  v_and_b32 v43, 0xffff0000, v83
  v_lshlrev_b32 v8, 16, v84
  v_and_b32 v9, 0xffff0000, v84
  v_pk_add_f32 v[36:37], v[36:37], v[8:9]
  v_lshlrev_b32 v8, 16, v85
  v_and_b32 v9, 0xffff0000, v85
  v_pk_add_f32 v[38:39], v[38:39], v[8:9]
  v_lshlrev_b32 v8, 16, v86
  v_and_b32 v9, 0xffff0000, v86
  v_pk_add_f32 v[40:41], v[40:41], v[8:9]
  v_lshlrev_b32 v8, 16, v87
  v_and_b32 v9, 0xffff0000, v87
  v_pk_add_f32 v[42:43], v[42:43], v[8:9]
  v_lshlrev_b32 v8, 16, v88
  v_and_b32 v9, 0xffff0000, v88
  v_pk_add_f32 v[36:37], v[36:37], v[8:9]
  v_lshlrev_b32 v8, 16, v89
  v_and_b32 v9, 0xffff0000, v89
  v_pk_add_f32 v[38:39], v[38:39], v[8:9]
  v_lshlrev_b32 v8, 16, v90
  v_and_b32 v9, 0xffff0000, v90
  v_pk_add_f32 v[40:41], v[40:41], v[8:9]
  v_lshlrev_b32 v8, 16, v91
  v_and_b32 v9, 0xffff0000, v91
  v_pk_add_f32 v[42:43], v[42:43], v[8:9]
  v_lshlrev_b32 v8, 16, v92
  v_and_b32 v9, 0xffff0000, v92
  v_pk_add_f32 v[36:37], v[36:37], v[8:9]
  v_lshlrev_b32 v8, 16, v93
  v_and_b32 v9, 0xffff0000, v93
  v_pk_add_f32 v[38:39], v[38:39], v[8:9]
  v_lshlrev_b32 v8, 16, v94
  v_and_b32 v9, 0xffff0000, v94
  v_pk_add_f32 v[40:41], v[40:41], v[8:9]
  v_lshlrev_b32 v8, 16, v95
  v_and_b32 v9, 0xffff0000, v95
  v_pk_add_f32 v[42:43], v[42:43], v[8:9]
  v_lshlrev_b32 v8, 16, v96
  v_and_b32 v9, 0xffff0000, v96
  v_pk_add_f32 v[36:37], v[36:37], v[8:9]
  v_lshlrev_b32 v8, 16, v97
  v_and_b32 v9, 0xffff0000, v97
  v_pk_add_f32 v[38:39], v[38:39], v[8:9]
  v_lshlrev_b32 v8, 16, v98
  v_and_b32 v9, 0xffff0000, v98
  v_pk_add_f32 v[40:41], v[40:41], v[8:9]
  v_lshlrev_b32 v8, 16, v99
  v_and_b32 v9, 0xffff0000, v99
  v_pk_add_f32 v[42:43], v[42:43], v[8:9]
  v_lshlrev_b32 v8, 16, v100
  v_and_b32 v9, 0xffff0000, v100
  v_pk_add_f32 v[36:37], v[36:37], v[8:9]
  v_lshlrev_b32 v8, 16, v101
  v_and_b32 v9, 0xffff0000, v101
  v_pk_add_f32 v[38:39], v[38:39], v[8:9]
  v_lshlrev_b32 v8, 16, v102
  v_and_b32 v9, 0xffff0000, v102
  v_pk_add_f32 v[40:41], v[40:41], v[8:9]
  v_lshlrev_b32 v8, 16, v103
  v_and_b32 v9, 0xffff0000, v103
  v_pk_add_f32 v[42:43], v[42:43], v[8:9]
  v_lshlrev_b32 v8, 16, v104
  v_and_b32 v9, 0xffff0000, v104
  v_pk_add_f32 v[36:37], v[36:37], v[8:9]
  v_lshlrev_b32 v8, 16, v105
  v_and_b32 v9, 0xffff0000, v105
  v_pk_add_f32 v[38:39], v[38:39], v[8:9]
  v_lshlrev_b32 v8, 16, v106
  v_and_b32 v9, 0xffff0000, v106
  v_pk_add_f32 v[40:41], v[40:41], v[8:9]
  v_lshlrev_b32 v8, 16, v107
  v_and_b32 v9, 0xffff0000, v107
  v_pk_add_f32 v[42:43], v[42:43], v[8:9]
  v_lshlrev_b32 v8, 16, v108
  v_and_b32 v9, 0xffff0000, v108
  v_pk_add_f32 v[36:37], v[36:37], v[8:9]
  v_lshlrev_b32 v8, 16, v109
  v_and_b32 v9, 0xffff0000, v109
  v_pk_add_f32 v[38:39], v[38:39], v[8:9]
  v_lshlrev_b32 v8, 16, v110
  v_and_b32 v9, 0xffff0000, v110
  v_pk_add_f32 v[40:41], v[40:41], v[8:9]
  v_lshlrev_b32 v8, 16, v111
  v_and_b32 v9, 0xffff0000, v111
  v_pk_add_f32 v[42:43], v[42:43], v[8:9]
  v_cvt_pk_bf16_f32 v8, v36, v37
  v_lshlrev_b32 v36, 16, v8
  v_and_b32 v37, 0xffff0000, v8
  v_lshlrev_b32 v10, 16, v16
  v_and_b32 v11, 0xffff0000, v16
  v_pk_add_f32 v[36:37], v[36:37], v[10:11]
  v_cvt_pk_bf16_f32 v16, v36, v37
  v_lshlrev_b32 v36, 16, v16
  v_and_b32 v37, 0xffff0000, v16
  v_cvt_pk_bf16_f32 v8, v38, v39
  v_lshlrev_b32 v38, 16, v8
  v_and_b32 v39, 0xffff0000, v8
  v_lshlrev_b32 v10, 16, v17
  v_and_b32 v11, 0xffff0000, v17
  v_pk_add_f32 v[38:39], v[38:39], v[10:11]
  v_cvt_pk_bf16_f32 v17, v38, v39
  v_lshlrev_b32 v38, 16, v17
  v_and_b32 v39, 0xffff0000, v17
  v_cvt_pk_bf16_f32 v8, v40, v41
  v_lshlrev_b32 v40, 16, v8
  v_and_b32 v41, 0xffff0000, v8
  v_lshlrev_b32 v10, 16, v18
  v_and_b32 v11, 0xffff0000, v18
  v_pk_add_f32 v[40:41], v[40:41], v[10:11]
  v_cvt_pk_bf16_f32 v18, v40, v41
  v_lshlrev_b32 v40, 16, v18
  v_and_b32 v41, 0xffff0000, v18
  v_cvt_pk_bf16_f32 v8, v42, v43
  v_lshlrev_b32 v42, 16, v8
  v_and_b32 v43, 0xffff0000, v8
  v_lshlrev_b32 v10, 16, v19
  v_and_b32 v11, 0xffff0000, v19
  v_pk_add_f32 v[42:43], v[42:43], v[10:11]
  v_cvt_pk_bf16_f32 v19, v42, v43
  v_lshlrev_b32 v42, 16, v19
  v_and_b32 v43, 0xffff0000, v19
  buffer_store_dwordx4 v[16:19], v15, s[4:7], s21 offen offset:0
  s_waitcnt vmcnt(25)
  v_lshlrev_b32 v44, 16, v112
  v_and_b32 v45, 0xffff0000, v112
  v_lshlrev_b32 v46, 16, v113
  v_and_b32 v47, 0xffff0000, v113
  v_lshlrev_b32 v48, 16, v114
  v_and_b32 v49, 0xffff0000, v114
  v_lshlrev_b32 v50, 16, v115
  v_and_b32 v51, 0xffff0000, v115
  v_lshlrev_b32 v8, 16, v116
  v_and_b32 v9, 0xffff0000, v116
  v_pk_add_f32 v[44:45], v[44:45], v[8:9]
  v_lshlrev_b32 v8, 16, v117
  v_and_b32 v9, 0xffff0000, v117
  v_pk_add_f32 v[46:47], v[46:47], v[8:9]
  v_lshlrev_b32 v8, 16, v118
  v_and_b32 v9, 0xffff0000, v118
  v_pk_add_f32 v[48:49], v[48:49], v[8:9]
  v_lshlrev_b32 v8, 16, v119
  v_and_b32 v9, 0xffff0000, v119
  v_pk_add_f32 v[50:51], v[50:51], v[8:9]
  v_lshlrev_b32 v8, 16, v120
  v_and_b32 v9, 0xffff0000, v120
  v_pk_add_f32 v[44:45], v[44:45], v[8:9]
  v_lshlrev_b32 v8, 16, v121
  v_and_b32 v9, 0xffff0000, v121
  v_pk_add_f32 v[46:47], v[46:47], v[8:9]
  v_lshlrev_b32 v8, 16, v122
  v_and_b32 v9, 0xffff0000, v122
  v_pk_add_f32 v[48:49], v[48:49], v[8:9]
  v_lshlrev_b32 v8, 16, v123
  v_and_b32 v9, 0xffff0000, v123
  v_pk_add_f32 v[50:51], v[50:51], v[8:9]
  v_lshlrev_b32 v8, 16, v124
  v_and_b32 v9, 0xffff0000, v124
  v_pk_add_f32 v[44:45], v[44:45], v[8:9]
  v_lshlrev_b32 v8, 16, v125
  v_and_b32 v9, 0xffff0000, v125
  v_pk_add_f32 v[46:47], v[46:47], v[8:9]
  v_lshlrev_b32 v8, 16, v126
  v_and_b32 v9, 0xffff0000, v126
  v_pk_add_f32 v[48:49], v[48:49], v[8:9]
  v_lshlrev_b32 v8, 16, v127
  v_and_b32 v9, 0xffff0000, v127
  v_pk_add_f32 v[50:51], v[50:51], v[8:9]
  v_lshlrev_b32 v8, 16, v128
  v_and_b32 v9, 0xffff0000, v128
  v_pk_add_f32 v[44:45], v[44:45], v[8:9]
  v_lshlrev_b32 v8, 16, v129
  v_and_b32 v9, 0xffff0000, v129
  v_pk_add_f32 v[46:47], v[46:47], v[8:9]
  v_lshlrev_b32 v8, 16, v130
  v_and_b32 v9, 0xffff0000, v130
  v_pk_add_f32 v[48:49], v[48:49], v[8:9]
  v_lshlrev_b32 v8, 16, v131
  v_and_b32 v9, 0xffff0000, v131
  v_pk_add_f32 v[50:51], v[50:51], v[8:9]
  v_lshlrev_b32 v8, 16, v132
  v_and_b32 v9, 0xffff0000, v132
  v_pk_add_f32 v[44:45], v[44:45], v[8:9]
  v_lshlrev_b32 v8, 16, v133
  v_and_b32 v9, 0xffff0000, v133
  v_pk_add_f32 v[46:47], v[46:47], v[8:9]
  v_lshlrev_b32 v8, 16, v134
  v_and_b32 v9, 0xffff0000, v134
  v_pk_add_f32 v[48:49], v[48:49], v[8:9]
  v_lshlrev_b32 v8, 16, v135
  v_and_b32 v9, 0xffff0000, v135
  v_pk_add_f32 v[50:51], v[50:51], v[8:9]
  v_lshlrev_b32 v8, 16, v136
  v_and_b32 v9, 0xffff0000, v136
  v_pk_add_f32 v[44:45], v[44:45], v[8:9]
  v_lshlrev_b32 v8, 16, v137
  v_and_b32 v9, 0xffff0000, v137
  v_pk_add_f32 v[46:47], v[46:47], v[8:9]
  v_lshlrev_b32 v8, 16, v138
  v_and_b32 v9, 0xffff0000, v138
  v_pk_add_f32 v[48:49], v[48:49], v[8:9]
  v_lshlrev_b32 v8, 16, v139
  v_and_b32 v9, 0xffff0000, v139
  v_pk_add_f32 v[50:51], v[50:51], v[8:9]
  v_lshlrev_b32 v8, 16, v140
  v_and_b32 v9, 0xffff0000, v140
  v_pk_add_f32 v[44:45], v[44:45], v[8:9]
  v_lshlrev_b32 v8, 16, v141
  v_and_b32 v9, 0xffff0000, v141
  v_pk_add_f32 v[46:47], v[46:47], v[8:9]
  v_lshlrev_b32 v8, 16, v142
  v_and_b32 v9, 0xffff0000, v142
  v_pk_add_f32 v[48:49], v[48:49], v[8:9]
  v_lshlrev_b32 v8, 16, v143
  v_and_b32 v9, 0xffff0000, v143
  v_pk_add_f32 v[50:51], v[50:51], v[8:9]
  v_cvt_pk_bf16_f32 v8, v44, v45
  v_lshlrev_b32 v44, 16, v8
  v_and_b32 v45, 0xffff0000, v8
  v_lshlrev_b32 v10, 16, v20
  v_and_b32 v11, 0xffff0000, v20
  v_pk_add_f32 v[44:45], v[44:45], v[10:11]
  v_cvt_pk_bf16_f32 v20, v44, v45
  v_lshlrev_b32 v44, 16, v20
  v_and_b32 v45, 0xffff0000, v20
  v_cvt_pk_bf16_f32 v8, v46, v47
  v_lshlrev_b32 v46, 16, v8
  v_and_b32 v47, 0xffff0000, v8
  v_lshlrev_b32 v10, 16, v21
  v_and_b32 v11, 0xffff0000, v21
  v_pk_add_f32 v[46:47], v[46:47], v[10:11]
  v_cvt_pk_bf16_f32 v21, v46, v47
  v_lshlrev_b32 v46, 16, v21
  v_and_b32 v47, 0xffff0000, v21
  v_cvt_pk_bf16_f32 v8, v48, v49
  v_lshlrev_b32 v48, 16, v8
  v_and_b32 v49, 0xffff0000, v8
  v_lshlrev_b32 v10, 16, v22
  v_and_b32 v11, 0xffff0000, v22
  v_pk_add_f32 v[48:49], v[48:49], v[10:11]
  v_cvt_pk_bf16_f32 v22, v48, v49
  v_lshlrev_b32 v48, 16, v22
  v_and_b32 v49, 0xffff0000, v22
  v_cvt_pk_bf16_f32 v8, v50, v51
  v_lshlrev_b32 v50, 16, v8
  v_and_b32 v51, 0xffff0000, v8
  v_lshlrev_b32 v10, 16, v23
  v_and_b32 v11, 0xffff0000, v23
  v_pk_add_f32 v[50:51], v[50:51], v[10:11]
  v_cvt_pk_bf16_f32 v23, v50, v51
  v_lshlrev_b32 v50, 16, v23
  v_and_b32 v51, 0xffff0000, v23
  buffer_store_dwordx4 v[20:23], v15, s[4:7], s21 offen offset:64
  s_waitcnt vmcnt(18)
  v_lshlrev_b32 v52, 16, v144
  v_and_b32 v53, 0xffff0000, v144
  v_lshlrev_b32 v54, 16, v145
  v_and_b32 v55, 0xffff0000, v145
  v_lshlrev_b32 v56, 16, v146
  v_and_b32 v57, 0xffff0000, v146
  v_lshlrev_b32 v58, 16, v147
  v_and_b32 v59, 0xffff0000, v147
  v_lshlrev_b32 v8, 16, v148
  v_and_b32 v9, 0xffff0000, v148
  v_pk_add_f32 v[52:53], v[52:53], v[8:9]
  v_lshlrev_b32 v8, 16, v149
  v_and_b32 v9, 0xffff0000, v149
  v_pk_add_f32 v[54:55], v[54:55], v[8:9]
  v_lshlrev_b32 v8, 16, v150
  v_and_b32 v9, 0xffff0000, v150
  v_pk_add_f32 v[56:57], v[56:57], v[8:9]
  v_lshlrev_b32 v8, 16, v151
  v_and_b32 v9, 0xffff0000, v151
  v_pk_add_f32 v[58:59], v[58:59], v[8:9]
  v_lshlrev_b32 v8, 16, v152
  v_and_b32 v9, 0xffff0000, v152
  v_pk_add_f32 v[52:53], v[52:53], v[8:9]
  v_lshlrev_b32 v8, 16, v153
  v_and_b32 v9, 0xffff0000, v153
  v_pk_add_f32 v[54:55], v[54:55], v[8:9]
  v_lshlrev_b32 v8, 16, v154
  v_and_b32 v9, 0xffff0000, v154
  v_pk_add_f32 v[56:57], v[56:57], v[8:9]
  v_lshlrev_b32 v8, 16, v155
  v_and_b32 v9, 0xffff0000, v155
  v_pk_add_f32 v[58:59], v[58:59], v[8:9]
  v_lshlrev_b32 v8, 16, v156
  v_and_b32 v9, 0xffff0000, v156
  v_pk_add_f32 v[52:53], v[52:53], v[8:9]
  v_lshlrev_b32 v8, 16, v157
  v_and_b32 v9, 0xffff0000, v157
  v_pk_add_f32 v[54:55], v[54:55], v[8:9]
  v_lshlrev_b32 v8, 16, v158
  v_and_b32 v9, 0xffff0000, v158
  v_pk_add_f32 v[56:57], v[56:57], v[8:9]
  v_lshlrev_b32 v8, 16, v159
  v_and_b32 v9, 0xffff0000, v159
  v_pk_add_f32 v[58:59], v[58:59], v[8:9]
  v_lshlrev_b32 v8, 16, v160
  v_and_b32 v9, 0xffff0000, v160
  v_pk_add_f32 v[52:53], v[52:53], v[8:9]
  v_lshlrev_b32 v8, 16, v161
  v_and_b32 v9, 0xffff0000, v161
  v_pk_add_f32 v[54:55], v[54:55], v[8:9]
  v_lshlrev_b32 v8, 16, v162
  v_and_b32 v9, 0xffff0000, v162
  v_pk_add_f32 v[56:57], v[56:57], v[8:9]
  v_lshlrev_b32 v8, 16, v163
  v_and_b32 v9, 0xffff0000, v163
  v_pk_add_f32 v[58:59], v[58:59], v[8:9]
  v_lshlrev_b32 v8, 16, v164
  v_and_b32 v9, 0xffff0000, v164
  v_pk_add_f32 v[52:53], v[52:53], v[8:9]
  v_lshlrev_b32 v8, 16, v165
  v_and_b32 v9, 0xffff0000, v165
  v_pk_add_f32 v[54:55], v[54:55], v[8:9]
  v_lshlrev_b32 v8, 16, v166
  v_and_b32 v9, 0xffff0000, v166
  v_pk_add_f32 v[56:57], v[56:57], v[8:9]
  v_lshlrev_b32 v8, 16, v167
  v_and_b32 v9, 0xffff0000, v167
  v_pk_add_f32 v[58:59], v[58:59], v[8:9]
  v_lshlrev_b32 v8, 16, v168
  v_and_b32 v9, 0xffff0000, v168
  v_pk_add_f32 v[52:53], v[52:53], v[8:9]
  v_lshlrev_b32 v8, 16, v169
  v_and_b32 v9, 0xffff0000, v169
  v_pk_add_f32 v[54:55], v[54:55], v[8:9]
  v_lshlrev_b32 v8, 16, v170
  v_and_b32 v9, 0xffff0000, v170
  v_pk_add_f32 v[56:57], v[56:57], v[8:9]
  v_lshlrev_b32 v8, 16, v171
  v_and_b32 v9, 0xffff0000, v171
  v_pk_add_f32 v[58:59], v[58:59], v[8:9]
  v_lshlrev_b32 v8, 16, v172
  v_and_b32 v9, 0xffff0000, v172
  v_pk_add_f32 v[52:53], v[52:53], v[8:9]
  v_lshlrev_b32 v8, 16, v173
  v_and_b32 v9, 0xffff0000, v173
  v_pk_add_f32 v[54:55], v[54:55], v[8:9]
  v_lshlrev_b32 v8, 16, v174
  v_and_b32 v9, 0xffff0000, v174
  v_pk_add_f32 v[56:57], v[56:57], v[8:9]
  v_lshlrev_b32 v8, 16, v175
  v_and_b32 v9, 0xffff0000, v175
  v_pk_add_f32 v[58:59], v[58:59], v[8:9]
  v_cvt_pk_bf16_f32 v8, v52, v53
  v_lshlrev_b32 v52, 16, v8
  v_and_b32 v53, 0xffff0000, v8
  v_lshlrev_b32 v10, 16, v24
  v_and_b32 v11, 0xffff0000, v24
  v_pk_add_f32 v[52:53], v[52:53], v[10:11]
  v_cvt_pk_bf16_f32 v24, v52, v53
  v_lshlrev_b32 v52, 16, v24
  v_and_b32 v53, 0xffff0000, v24
  v_cvt_pk_bf16_f32 v8, v54, v55
  v_lshlrev_b32 v54, 16, v8
  v_and_b32 v55, 0xffff0000, v8
  v_lshlrev_b32 v10, 16, v25
  v_and_b32 v11, 0xffff0000, v25
  v_pk_add_f32 v[54:55], v[54:55], v[10:11]
  v_cvt_pk_bf16_f32 v25, v54, v55
  v_lshlrev_b32 v54, 16, v25
  v_and_b32 v55, 0xffff0000, v25
  v_cvt_pk_bf16_f32 v8, v56, v57
  v_lshlrev_b32 v56, 16, v8
  v_and_b32 v57, 0xffff0000, v8
  v_lshlrev_b32 v10, 16, v26
  v_and_b32 v11, 0xffff0000, v26
  v_pk_add_f32 v[56:57], v[56:57], v[10:11]
  v_cvt_pk_bf16_f32 v26, v56, v57
  v_lshlrev_b32 v56, 16, v26
  v_and_b32 v57, 0xffff0000, v26
  v_cvt_pk_bf16_f32 v8, v58, v59
  v_lshlrev_b32 v58, 16, v8
  v_and_b32 v59, 0xffff0000, v8
  v_lshlrev_b32 v10, 16, v27
  v_and_b32 v11, 0xffff0000, v27
  v_pk_add_f32 v[58:59], v[58:59], v[10:11]
  v_cvt_pk_bf16_f32 v27, v58, v59
  v_lshlrev_b32 v58, 16, v27
  v_and_b32 v59, 0xffff0000, v27
  buffer_store_dwordx4 v[24:27], v15, s[4:7], s21 offen offset:128
  s_waitcnt vmcnt(11)
  v_lshlrev_b32 v60, 16, v176
  v_and_b32 v61, 0xffff0000, v176
  v_lshlrev_b32 v62, 16, v177
  v_and_b32 v63, 0xffff0000, v177
  v_lshlrev_b32 v64, 16, v178
  v_and_b32 v65, 0xffff0000, v178
  v_lshlrev_b32 v66, 16, v179
  v_and_b32 v67, 0xffff0000, v179
  v_lshlrev_b32 v8, 16, v180
  v_and_b32 v9, 0xffff0000, v180
  v_pk_add_f32 v[60:61], v[60:61], v[8:9]
  v_lshlrev_b32 v8, 16, v181
  v_and_b32 v9, 0xffff0000, v181
  v_pk_add_f32 v[62:63], v[62:63], v[8:9]
  v_lshlrev_b32 v8, 16, v182
  v_and_b32 v9, 0xffff0000, v182
  v_pk_add_f32 v[64:65], v[64:65], v[8:9]
  v_lshlrev_b32 v8, 16, v183
  v_and_b32 v9, 0xffff0000, v183
  v_pk_add_f32 v[66:67], v[66:67], v[8:9]
  v_lshlrev_b32 v8, 16, v184
  v_and_b32 v9, 0xffff0000, v184
  v_pk_add_f32 v[60:61], v[60:61], v[8:9]
  v_lshlrev_b32 v8, 16, v185
  v_and_b32 v9, 0xffff0000, v185
  v_pk_add_f32 v[62:63], v[62:63], v[8:9]
  v_lshlrev_b32 v8, 16, v186
  v_and_b32 v9, 0xffff0000, v186
  v_pk_add_f32 v[64:65], v[64:65], v[8:9]
  v_lshlrev_b32 v8, 16, v187
  v_and_b32 v9, 0xffff0000, v187
  v_pk_add_f32 v[66:67], v[66:67], v[8:9]
  v_lshlrev_b32 v8, 16, v188
  v_and_b32 v9, 0xffff0000, v188
  v_pk_add_f32 v[60:61], v[60:61], v[8:9]
  v_lshlrev_b32 v8, 16, v189
  v_and_b32 v9, 0xffff0000, v189
  v_pk_add_f32 v[62:63], v[62:63], v[8:9]
  v_lshlrev_b32 v8, 16, v190
  v_and_b32 v9, 0xffff0000, v190
  v_pk_add_f32 v[64:65], v[64:65], v[8:9]
  v_lshlrev_b32 v8, 16, v191
  v_and_b32 v9, 0xffff0000, v191
  v_pk_add_f32 v[66:67], v[66:67], v[8:9]
  v_lshlrev_b32 v8, 16, v192
  v_and_b32 v9, 0xffff0000, v192
  v_pk_add_f32 v[60:61], v[60:61], v[8:9]
  v_lshlrev_b32 v8, 16, v193
  v_and_b32 v9, 0xffff0000, v193
  v_pk_add_f32 v[62:63], v[62:63], v[8:9]
  v_lshlrev_b32 v8, 16, v194
  v_and_b32 v9, 0xffff0000, v194
  v_pk_add_f32 v[64:65], v[64:65], v[8:9]
  v_lshlrev_b32 v8, 16, v195
  v_and_b32 v9, 0xffff0000, v195
  v_pk_add_f32 v[66:67], v[66:67], v[8:9]
  v_lshlrev_b32 v8, 16, v196
  v_and_b32 v9, 0xffff0000, v196
  v_pk_add_f32 v[60:61], v[60:61], v[8:9]
  v_lshlrev_b32 v8, 16, v197
  v_and_b32 v9, 0xffff0000, v197
  v_pk_add_f32 v[62:63], v[62:63], v[8:9]
  v_lshlrev_b32 v8, 16, v198
  v_and_b32 v9, 0xffff0000, v198
  v_pk_add_f32 v[64:65], v[64:65], v[8:9]
  v_lshlrev_b32 v8, 16, v199
  v_and_b32 v9, 0xffff0000, v199
  v_pk_add_f32 v[66:67], v[66:67], v[8:9]
  v_lshlrev_b32 v8, 16, v200
  v_and_b32 v9, 0xffff0000, v200
  v_pk_add_f32 v[60:61], v[60:61], v[8:9]
  v_lshlrev_b32 v8, 16, v201
  v_and_b32 v9, 0xffff0000, v201
  v_pk_add_f32 v[62:63], v[62:63], v[8:9]
  v_lshlrev_b32 v8, 16, v202
  v_and_b32 v9, 0xffff0000, v202
  v_pk_add_f32 v[64:65], v[64:65], v[8:9]
  v_lshlrev_b32 v8, 16, v203
  v_and_b32 v9, 0xffff0000, v203
  v_pk_add_f32 v[66:67], v[66:67], v[8:9]
  v_lshlrev_b32 v8, 16, v204
  v_and_b32 v9, 0xffff0000, v204
  v_pk_add_f32 v[60:61], v[60:61], v[8:9]
  v_lshlrev_b32 v8, 16, v205
  v_and_b32 v9, 0xffff0000, v205
  v_pk_add_f32 v[62:63], v[62:63], v[8:9]
  v_lshlrev_b32 v8, 16, v206
  v_and_b32 v9, 0xffff0000, v206
  v_pk_add_f32 v[64:65], v[64:65], v[8:9]
  v_lshlrev_b32 v8, 16, v207
  v_and_b32 v9, 0xffff0000, v207
  v_pk_add_f32 v[66:67], v[66:67], v[8:9]
  v_cvt_pk_bf16_f32 v8, v60, v61
  v_lshlrev_b32 v60, 16, v8
  v_and_b32 v61, 0xffff0000, v8
  v_lshlrev_b32 v10, 16, v28
  v_and_b32 v11, 0xffff0000, v28
  v_pk_add_f32 v[60:61], v[60:61], v[10:11]
  v_cvt_pk_bf16_f32 v28, v60, v61
  v_lshlrev_b32 v60, 16, v28
  v_and_b32 v61, 0xffff0000, v28
  v_cvt_pk_bf16_f32 v8, v62, v63
  v_lshlrev_b32 v62, 16, v8
  v_and_b32 v63, 0xffff0000, v8
  v_lshlrev_b32 v10, 16, v29
  v_and_b32 v11, 0xffff0000, v29
  v_pk_add_f32 v[62:63], v[62:63], v[10:11]
  v_cvt_pk_bf16_f32 v29, v62, v63
  v_lshlrev_b32 v62, 16, v29
  v_and_b32 v63, 0xffff0000, v29
  v_cvt_pk_bf16_f32 v8, v64, v65
  v_lshlrev_b32 v64, 16, v8
  v_and_b32 v65, 0xffff0000, v8
  v_lshlrev_b32 v10, 16, v30
  v_and_b32 v11, 0xffff0000, v30
  v_pk_add_f32 v[64:65], v[64:65], v[10:11]
  v_cvt_pk_bf16_f32 v30, v64, v65
  v_lshlrev_b32 v64, 16, v30
  v_and_b32 v65, 0xffff0000, v30
  v_cvt_pk_bf16_f32 v8, v66, v67
  v_lshlrev_b32 v66, 16, v8
  v_and_b32 v67, 0xffff0000, v8
  v_lshlrev_b32 v10, 16, v31
  v_and_b32 v11, 0xffff0000, v31
  v_pk_add_f32 v[66:67], v[66:67], v[10:11]
  v_cvt_pk_bf16_f32 v31, v66, v67
  v_lshlrev_b32 v66, 16, v31
  v_and_b32 v67, 0xffff0000, v31
  buffer_store_dwordx4 v[28:31], v15, s[4:7], s21 offen offset:192
  s_waitcnt vmcnt(4)
  v_lshlrev_b32 v68, 16, v208
  v_and_b32 v69, 0xffff0000, v208
  v_lshlrev_b32 v70, 16, v209
  v_and_b32 v71, 0xffff0000, v209
  v_lshlrev_b32 v72, 16, v210
  v_and_b32 v73, 0xffff0000, v210
  v_lshlrev_b32 v74, 16, v211
  v_and_b32 v75, 0xffff0000, v211
  v_lshlrev_b32 v8, 16, v212
  v_and_b32 v9, 0xffff0000, v212
  v_pk_add_f32 v[68:69], v[68:69], v[8:9]
  v_lshlrev_b32 v8, 16, v213
  v_and_b32 v9, 0xffff0000, v213
  v_pk_add_f32 v[70:71], v[70:71], v[8:9]
  v_lshlrev_b32 v8, 16, v214
  v_and_b32 v9, 0xffff0000, v214
  v_pk_add_f32 v[72:73], v[72:73], v[8:9]
  v_lshlrev_b32 v8, 16, v215
  v_and_b32 v9, 0xffff0000, v215
  v_pk_add_f32 v[74:75], v[74:75], v[8:9]
  v_lshlrev_b32 v8, 16, v216
  v_and_b32 v9, 0xffff0000, v216
  v_pk_add_f32 v[68:69], v[68:69], v[8:9]
  v_lshlrev_b32 v8, 16, v217
  v_and_b32 v9, 0xffff0000, v217
  v_pk_add_f32 v[70:71], v[70:71], v[8:9]
  v_lshlrev_b32 v8, 16, v218
  v_and_b32 v9, 0xffff0000, v218
  v_pk_add_f32 v[72:73], v[72:73], v[8:9]
  v_lshlrev_b32 v8, 16, v219
  v_and_b32 v9, 0xffff0000, v219
  v_pk_add_f32 v[74:75], v[74:75], v[8:9]
  v_lshlrev_b32 v8, 16, v220
  v_and_b32 v9, 0xffff0000, v220
  v_pk_add_f32 v[68:69], v[68:69], v[8:9]
  v_lshlrev_b32 v8, 16, v221
  v_and_b32 v9, 0xffff0000, v221
  v_pk_add_f32 v[70:71], v[70:71], v[8:9]
  v_lshlrev_b32 v8, 16, v222
  v_and_b32 v9, 0xffff0000, v222
  v_pk_add_f32 v[72:73], v[72:73], v[8:9]
  v_lshlrev_b32 v8, 16, v223
  v_and_b32 v9, 0xffff0000, v223
  v_pk_add_f32 v[74:75], v[74:75], v[8:9]
  v_lshlrev_b32 v8, 16, v224
  v_and_b32 v9, 0xffff0000, v224
  v_pk_add_f32 v[68:69], v[68:69], v[8:9]
  v_lshlrev_b32 v8, 16, v225
  v_and_b32 v9, 0xffff0000, v225
  v_pk_add_f32 v[70:71], v[70:71], v[8:9]
  v_lshlrev_b32 v8, 16, v226
  v_and_b32 v9, 0xffff0000, v226
  v_pk_add_f32 v[72:73], v[72:73], v[8:9]
  v_lshlrev_b32 v8, 16, v227
  v_and_b32 v9, 0xffff0000, v227
  v_pk_add_f32 v[74:75], v[74:75], v[8:9]
  v_lshlrev_b32 v8, 16, v228
  v_and_b32 v9, 0xffff0000, v228
  v_pk_add_f32 v[68:69], v[68:69], v[8:9]
  v_lshlrev_b32 v8, 16, v229
  v_and_b32 v9, 0xffff0000, v229
  v_pk_add_f32 v[70:71], v[70:71], v[8:9]
  v_lshlrev_b32 v8, 16, v230
  v_and_b32 v9, 0xffff0000, v230
  v_pk_add_f32 v[72:73], v[72:73], v[8:9]
  v_lshlrev_b32 v8, 16, v231
  v_and_b32 v9, 0xffff0000, v231
  v_pk_add_f32 v[74:75], v[74:75], v[8:9]
  v_lshlrev_b32 v8, 16, v232
  v_and_b32 v9, 0xffff0000, v232
  v_pk_add_f32 v[68:69], v[68:69], v[8:9]
  v_lshlrev_b32 v8, 16, v233
  v_and_b32 v9, 0xffff0000, v233
  v_pk_add_f32 v[70:71], v[70:71], v[8:9]
  v_lshlrev_b32 v8, 16, v234
  v_and_b32 v9, 0xffff0000, v234
  v_pk_add_f32 v[72:73], v[72:73], v[8:9]
  v_lshlrev_b32 v8, 16, v235
  v_and_b32 v9, 0xffff0000, v235
  v_pk_add_f32 v[74:75], v[74:75], v[8:9]
  v_lshlrev_b32 v8, 16, v236
  v_and_b32 v9, 0xffff0000, v236
  v_pk_add_f32 v[68:69], v[68:69], v[8:9]
  v_lshlrev_b32 v8, 16, v237
  v_and_b32 v9, 0xffff0000, v237
  v_pk_add_f32 v[70:71], v[70:71], v[8:9]
  v_lshlrev_b32 v8, 16, v238
  v_and_b32 v9, 0xffff0000, v238
  v_pk_add_f32 v[72:73], v[72:73], v[8:9]
  v_lshlrev_b32 v8, 16, v239
  v_and_b32 v9, 0xffff0000, v239
  v_pk_add_f32 v[74:75], v[74:75], v[8:9]
  v_cvt_pk_bf16_f32 v8, v68, v69
  v_lshlrev_b32 v68, 16, v8
  v_and_b32 v69, 0xffff0000, v8
  v_lshlrev_b32 v10, 16, v32
  v_and_b32 v11, 0xffff0000, v32
  v_pk_add_f32 v[68:69], v[68:69], v[10:11]
  v_cvt_pk_bf16_f32 v32, v68, v69
  v_lshlrev_b32 v68, 16, v32
  v_and_b32 v69, 0xffff0000, v32
  v_cvt_pk_bf16_f32 v8, v70, v71
  v_lshlrev_b32 v70, 16, v8
  v_and_b32 v71, 0xffff0000, v8
  v_lshlrev_b32 v10, 16, v33
  v_and_b32 v11, 0xffff0000, v33
  v_pk_add_f32 v[70:71], v[70:71], v[10:11]
  v_cvt_pk_bf16_f32 v33, v70, v71
  v_lshlrev_b32 v70, 16, v33
  v_and_b32 v71, 0xffff0000, v33
  v_cvt_pk_bf16_f32 v8, v72, v73
  v_lshlrev_b32 v72, 16, v8
  v_and_b32 v73, 0xffff0000, v8
  v_lshlrev_b32 v10, 16, v34
  v_and_b32 v11, 0xffff0000, v34
  v_pk_add_f32 v[72:73], v[72:73], v[10:11]
  v_cvt_pk_bf16_f32 v34, v72, v73
  v_lshlrev_b32 v72, 16, v34
  v_and_b32 v73, 0xffff0000, v34
  v_cvt_pk_bf16_f32 v8, v74, v75
  v_lshlrev_b32 v74, 16, v8
  v_and_b32 v75, 0xffff0000, v8
  v_lshlrev_b32 v10, 16, v35
  v_and_b32 v11, 0xffff0000, v35
  v_pk_add_f32 v[74:75], v[74:75], v[10:11]
  v_cvt_pk_bf16_f32 v35, v74, v75
  v_lshlrev_b32 v74, 16, v35
  v_and_b32 v75, 0xffff0000, v35
  buffer_store_dwordx4 v[32:35], v15, s[4:7], s21 offen offset:256
  v_and_b32 v3, 63, v0
  v_and_b32 v2, 15, v3
  v_lshlrev_b32 v5, 2, v2
  s_lshl_b32 s17, s16, 6
  v_add_u32 v1, s17, v5
  v_pk_add_f32 v[6:7], v[36:37], v[38:39]
  v_pk_add_f32 v[6:7], v[6:7], v[40:41]
  v_pk_add_f32 v[6:7], v[6:7], v[42:43]
  v_pk_add_f32 v[6:7], v[6:7], v[44:45]
  v_pk_add_f32 v[6:7], v[6:7], v[46:47]
  v_pk_add_f32 v[6:7], v[6:7], v[48:49]
  v_pk_add_f32 v[6:7], v[6:7], v[50:51]
  v_pk_add_f32 v[6:7], v[6:7], v[52:53]
  v_pk_add_f32 v[6:7], v[6:7], v[54:55]
  v_pk_add_f32 v[6:7], v[6:7], v[56:57]
  v_pk_add_f32 v[6:7], v[6:7], v[58:59]
  v_pk_add_f32 v[6:7], v[6:7], v[60:61]
  v_pk_add_f32 v[6:7], v[6:7], v[62:63]
  v_pk_add_f32 v[6:7], v[6:7], v[64:65]
  v_pk_add_f32 v[6:7], v[6:7], v[66:67]
  v_pk_add_f32 v[6:7], v[6:7], v[68:69]
  v_pk_add_f32 v[6:7], v[6:7], v[70:71]
  v_pk_add_f32 v[6:7], v[6:7], v[72:73]
  v_pk_add_f32 v[6:7], v[6:7], v[74:75]
  v_add_f32 v4, v6, v7
  v_mov_b32 v2, v4
  s_nop 1
  v_permlane32_swap_b32 v4, v2
  v_add_f32 v4, v4, v2
  v_mov_b32 v2, v4
  s_nop 1
  v_permlane16_swap_b32 v4, v2
  v_add_f32 v4, v4, v2
  ds_write_b32 v1, v4 offset:0
  s_waitcnt lgkmcnt(0)
  s_barrier
  ds_read_b32 v4, v5 offset:0
  ds_read_b32 v2, v5 offset:64
  ds_read_b32 v3, v5 offset:128
  ds_read_b32 v6, v5 offset:192
  s_waitcnt lgkmcnt(0)
  v_add_f32 v4, v4, v2
  v_add_f32 v3, v3, v6
  v_add_f32 v4, v4, v3
  v_mul_f32 v6, 0xbacccccd, v4
  v_mov_b32 v7, v6
  v_pk_add_f32 v[36:37], v[36:37], v[6:7]
  v_pk_add_f32 v[38:39], v[38:39], v[6:7]
  v_pk_add_f32 v[40:41], v[40:41], v[6:7]
  v_pk_add_f32 v[42:43], v[42:43], v[6:7]
  v_pk_add_f32 v[44:45], v[44:45], v[6:7]
  v_pk_add_f32 v[46:47], v[46:47], v[6:7]
  v_pk_add_f32 v[48:49], v[48:49], v[6:7]
  v_pk_add_f32 v[50:51], v[50:51], v[6:7]
  v_pk_add_f32 v[52:53], v[52:53], v[6:7]
  v_pk_add_f32 v[54:55], v[54:55], v[6:7]
  v_pk_add_f32 v[56:57], v[56:57], v[6:7]
  v_pk_add_f32 v[58:59], v[58:59], v[6:7]
  v_pk_add_f32 v[60:61], v[60:61], v[6:7]
  v_pk_add_f32 v[62:63], v[62:63], v[6:7]
  v_pk_add_f32 v[64:65], v[64:65], v[6:7]
  v_pk_add_f32 v[66:67], v[66:67], v[6:7]
  v_pk_add_f32 v[68:69], v[68:69], v[6:7]
  v_pk_add_f32 v[70:71], v[70:71], v[6:7]
  v_pk_add_f32 v[72:73], v[72:73], v[6:7]
  v_pk_add_f32 v[74:75], v[74:75], v[6:7]
  v_pk_mul_f32 v[6:7], v[36:37], v[36:37]
  v_pk_fma_f32 v[6:7], v[38:39], v[38:39], v[6:7]
  v_pk_fma_f32 v[6:7], v[40:41], v[40:41], v[6:7]
  v_pk_fma_f32 v[6:7], v[42:43], v[42:43], v[6:7]
  v_pk_fma_f32 v[6:7], v[44:45], v[44:45], v[6:7]
  v_pk_fma_f32 v[6:7], v[46:47], v[46:47], v[6:7]
  v_pk_fma_f32 v[6:7], v[48:49], v[48:49], v[6:7]
  v_pk_fma_f32 v[6:7], v[50:51], v[50:51], v[6:7]
  v_pk_fma_f32 v[6:7], v[52:53], v[52:53], v[6:7]
  v_pk_fma_f32 v[6:7], v[54:55], v[54:55], v[6:7]
  v_pk_fma_f32 v[6:7], v[56:57], v[56:57], v[6:7]
  v_pk_fma_f32 v[6:7], v[58:59], v[58:59], v[6:7]
  v_pk_fma_f32 v[6:7], v[60:61], v[60:61], v[6:7]
  v_pk_fma_f32 v[6:7], v[62:63], v[62:63], v[6:7]
  v_pk_fma_f32 v[6:7], v[64:65], v[64:65], v[6:7]
  v_pk_fma_f32 v[6:7], v[66:67], v[66:67], v[6:7]
  v_pk_fma_f32 v[6:7], v[68:69], v[68:69], v[6:7]
  v_pk_fma_f32 v[6:7], v[70:71], v[70:71], v[6:7]
  v_pk_fma_f32 v[6:7], v[72:73], v[72:73], v[6:7]
  v_pk_fma_f32 v[6:7], v[74:75], v[74:75], v[6:7]
  v_add_f32 v4, v6, v7
  v_mov_b32 v2, v4
  s_nop 1
  v_permlane32_swap_b32 v4, v2
  v_add_f32 v4, v4, v2
  v_mov_b32 v2, v4
  s_nop 1
  v_permlane16_swap_b32 v4, v2
  v_add_f32 v4, v4, v2
  ds_write_b32 v1, v4 offset:256
  s_waitcnt lgkmcnt(0)
  s_barrier
  ds_read_b32 v4, v5 offset:256
  ds_read_b32 v2, v5 offset:320
  ds_read_b32 v3, v5 offset:384
  ds_read_b32 v6, v5 offset:448
  s_waitcnt lgkmcnt(0)
  v_add_f32 v4, v4, v2
  v_add_f32 v3, v3, v6
  v_add_f32 v4, v4, v3
  v_mov_b32 v2, 0x3727c5ac
  v_fmac_f32 v2, 0x3acccccd, v4
  v_rsq_f32 v6, v2
  s_nop 0
  v_mov_b32 v7, v6
  v_pk_mul_f32 v[36:37], v[36:37], v[6:7]
  v_pk_mul_f32 v[38:39], v[38:39], v[6:7]
  v_pk_mul_f32 v[40:41], v[40:41], v[6:7]
  v_pk_mul_f32 v[42:43], v[42:43], v[6:7]
  v_pk_mul_f32 v[44:45], v[44:45], v[6:7]
  v_pk_mul_f32 v[46:47], v[46:47], v[6:7]
  v_pk_mul_f32 v[48:49], v[48:49], v[6:7]
  v_pk_mul_f32 v[50:51], v[50:51], v[6:7]
  v_pk_mul_f32 v[52:53], v[52:53], v[6:7]
  v_pk_mul_f32 v[54:55], v[54:55], v[6:7]
  v_pk_mul_f32 v[56:57], v[56:57], v[6:7]
  v_pk_mul_f32 v[58:59], v[58:59], v[6:7]
  v_pk_mul_f32 v[60:61], v[60:61], v[6:7]
  v_pk_mul_f32 v[62:63], v[62:63], v[6:7]
  v_pk_mul_f32 v[64:65], v[64:65], v[6:7]
  v_pk_mul_f32 v[66:67], v[66:67], v[6:7]
  v_pk_mul_f32 v[68:69], v[68:69], v[6:7]
  v_pk_mul_f32 v[70:71], v[70:71], v[6:7]
  v_pk_mul_f32 v[72:73], v[72:73], v[6:7]
  v_pk_mul_f32 v[74:75], v[74:75], v[6:7]
  v_cvt_pk_bf16_f32 v16, v36, v37
  v_cvt_pk_bf16_f32 v17, v38, v39
  v_cvt_pk_bf16_f32 v18, v40, v41
  v_cvt_pk_bf16_f32 v19, v42, v43
  v_cvt_pk_bf16_f32 v20, v44, v45
  v_cvt_pk_bf16_f32 v21, v46, v47
  v_cvt_pk_bf16_f32 v22, v48, v49
  v_cvt_pk_bf16_f32 v23, v50, v51
  v_cvt_pk_bf16_f32 v24, v52, v53
  v_cvt_pk_bf16_f32 v25, v54, v55
  v_cvt_pk_bf16_f32 v26, v56, v57
  v_cvt_pk_bf16_f32 v27, v58, v59
  v_cvt_pk_bf16_f32 v28, v60, v61
  v_cvt_pk_bf16_f32 v29, v62, v63
  v_cvt_pk_bf16_f32 v30, v64, v65
  v_cvt_pk_bf16_f32 v31, v66, v67
  v_cvt_pk_bf16_f32 v32, v68, v69
  v_cvt_pk_bf16_f32 v33, v70, v71
  v_cvt_pk_bf16_f32 v34, v72, v73
  v_cvt_pk_bf16_f32 v35, v74, v75
  v_and_b32 v3, 63, v0
  v_and_b32 v2, 15, v3
  v_lshlrev_b32 v1, 4, v2
  v_bfe_u32 v2, v3, 4, 1
  v_lshl_add_u32 v1, v2, 9, v1
  v_lshrrev_b32 v2, 5, v3
  v_lshl_add_u32 v1, v2, 10, v1
  s_lshr_b32 s17, s2, 1
  s_mul_i32 s17, s17, 40960
  s_and_b32 s18, s2, 1
  s_lshl_b32 s18, s18, 8
  s_add_u32 s17, s17, s18
  s_mul_i32 s18, s16, 10240
  s_add_u32 s17, s17, s18
  s_add_u32 s17, s17, 199229440
  buffer_store_dwordx4 v[16:19], v1, s[4:7], s17 offen offset:0
  buffer_store_dwordx4 v[20:23], v1, s[4:7], s17 offen offset:2048
  s_add_u32 s17, s17, 4096
  buffer_store_dwordx4 v[24:27], v1, s[4:7], s17 offen offset:0
  buffer_store_dwordx4 v[28:31], v1, s[4:7], s17 offen offset:2048
  s_add_u32 s17, s17, 4096
  buffer_store_dwordx4 v[32:35], v1, s[4:7], s17 offen offset:0
redln1_exit1:
  s_endpgm
.globl redln2_kernel
.p2align 8
.type redln2_kernel,@function
redln2_kernel:
  s_cmp_ge_u32 s2, 128
  s_cbranch_scc1 redln2_exit1
  s_load_dwordx2 s[12:13], s[0:1], 96
  s_load_dwordx2 s[14:15], s[0:1], 0
  v_lshrrev_b32 v2, 6, v0
  v_and_b32 v3, 63, v0
  s_nop 0
  v_readfirstlane_b32 s16, v2
  v_lshlrev_b32 v14, 4, v3
  s_waitcnt lgkmcnt(0)
  s_mov_b32 s4, s12
  s_mov_b32 s5, s13
  s_mov_b32 s6, 0x10000000
  s_mov_b32 s7, 0x20000
  s_mov_b32 s8, s12
  s_mov_b32 s9, s13
  s_mov_b32 s10, 0x10000000
  s_mov_b32 s11, 0x20000
  s_mov_b32 s20, 150994944
  v_and_b32 v2, 15, v3
  v_lshrrev_b32 v4, 4, v3
  s_lshl_b32 s17, s2, 4
  v_add_u32 v15, s17, v2
  v_mul_u32_u24 v15, 1280, v15
  v_lshl_add_u32 v15, v4, 4, v15
  s_mul_i32 s17, s16, 320
  s_add_u32 s20, s20, s17
  s_add_u32 s21, s17, 150994944
  s_mul_i32 s22, s2, 20
  s_mul_i32 s23, s16, 5
  s_add_u32 s22, s22, s23
  s_lshl_b32 s22, s22, 10
  s_add_u32 s22, s22, 178257920
  s_add_u32 s24, s22, 0
  s_add_u32 s25, s22, 2621440
  s_add_u32 s26, s22, 5242880
  s_add_u32 s27, s22, 7864320
  s_add_u32 s28, s22, 10485760
  s_add_u32 s29, s22, 13107200
  s_add_u32 s30, s22, 15728640
  s_add_u32 s31, s22, 18350080
  v_add_u32 v6, 0x1000, v14
  buffer_load_dwordx4 v[16:19], v15, s[8:11], s20 offen offset:0
  buffer_load_dwordx4 v[20:23], v15, s[8:11], s20 offen offset:64
  buffer_load_dwordx4 v[24:27], v15, s[8:11], s20 offen offset:128
  buffer_load_dwordx4 v[28:31], v15, s[8:11], s20 offen offset:192
  buffer_load_dwordx4 v[32:35], v15, s[8:11], s20 offen offset:256
  buffer_load_dwordx4 v[80:83], v14, s[4:7], s24 offen offset:0
  buffer_load_dwordx4 v[84:87], v14, s[4:7], s25 offen offset:0
  buffer_load_dwordx4 v[88:91], v14, s[4:7], s26 offen offset:0
  buffer_load_dwordx4 v[92:95], v14, s[4:7], s27 offen offset:0
  buffer_load_dwordx4 v[96:99], v14, s[4:7], s28 offen offset:0
  buffer_load_dwordx4 v[100:103], v14, s[4:7], s29 offen offset:0
  buffer_load_dwordx4 v[104:107], v14, s[4:7], s30 offen offset:0
  buffer_load_dwordx4 v[108:111], v14, s[4:7], s31 offen offset:0
  buffer_load_dwordx4 v[112:115], v14, s[4:7], s24 offen offset:1024
  buffer_load_dwordx4 v[116:119], v14, s[4:7], s25 offen offset:1024
  buffer_load_dwordx4 v[120:123], v14, s[4:7], s26 offen offset:1024
  buffer_load_dwordx4 v[124:127], v14, s[4:7], s27 offen offset:1024
  buffer_load_dwordx4 v[128:131], v14, s[4:7], s28 offen offset:1024
  buffer_load_dwordx4 v[132:135], v14, s[4:7], s29 offen offset:1024
  buffer_load_dwordx4 v[136:139], v14, s[4:7], s30 offen offset:1024
  buffer_load_dwordx4 v[140:143], v14, s[4:7], s31 offen offset:1024
  buffer_load_dwordx4 v[144:147], v14, s[4:7], s24 offen offset:2048
  buffer_load_dwordx4 v[148:151], v14, s[4:7], s25 offen offset:2048
  buffer_load_dwordx4 v[152:155], v14, s[4:7], s26 offen offset:2048
  buffer_load_dwordx4 v[156:159], v14, s[4:7], s27 offen offset:2048
  buffer_load_dwordx4 v[160:163], v14, s[4:7], s28 offen offset:2048
  buffer_load_dwordx4 v[164:167], v14, s[4:7], s29 offen offset:2048
  buffer_load_dwordx4 v[168:171], v14, s[4:7], s30 offen offset:2048
  buffer_load_dwordx4 v[172:175], v14, s[4:7], s31 offen offset:2048
  buffer_load_dwordx4 v[176:179], v14, s[4:7], s24 offen offset:3072
  buffer_load_dwordx4 v[180:183], v14, s[4:7], s25 offen offset:3072
  buffer_load_dwordx4 v[184:187], v14, s[4:7], s26 offen offset:3072
  buffer_load_dwordx4 v[188:191], v14, s[4:7], s27 offen offset:3072
  buffer_load_dwordx4 v[192:195], v14, s[4:7], s28 offen offset:3072
  buffer_load_dwordx4 v[196:199], v14, s[4:7], s29 offen offset:3072
  buffer_load_dwordx4 v[200:203], v14, s[4:7], s30 offen offset:3072
  buffer_load_dwordx4 v[204:207], v14, s[4:7], s31 offen offset:3072
  buffer_load_dwordx4 v[208:211], v6, s[4:7], s24 offen offset:0
  buffer_load_dwordx4 v[212:215], v6, s[4:7], s25 offen offset:0
  buffer_load_dwordx4 v[216:219], v6, s[4:7], s26 offen offset:0
  buffer_load_dwordx4 v[220:223], v6, s[4:7], s27 offen offset:0
  buffer_load_dwordx4 v[224:227], v6, s[4:7], s28 offen offset:0
  buffer_load_dwordx4 v[228:231], v6, s[4:7], s29 offen offset:0
  buffer_load_dwordx4 v[232:235], v6, s[4:7], s30 offen offset:0
  buffer_load_dwordx4 v[236:239], v6, s[4:7], s31 offen offset:0
  s_waitcnt vmcnt(32)
  v_lshlrev_b32 v36, 16, v80
  v_and_b32 v37, 0xffff0000, v80
  v_lshlrev_b32 v38, 16, v81
  v_and_b32 v39, 0xffff0000, v81
  v_lshlrev_b32 v40, 16, v82
  v_and_b32 v41, 0xffff0000, v82
  v_lshlrev_b32 v42, 16, v83
  v_and_b32 v43, 0xffff0000, v83
  v_lshlrev_b32 v8, 16, v84
  v_and_b32 v9, 0xffff0000, v84
  v_pk_add_f32 v[36:37], v[36:37], v[8:9]
  v_lshlrev_b32 v8, 16, v85
  v_and_b32 v9, 0xffff0000, v85
  v_pk_add_f32 v[38:39], v[38:39], v[8:9]
  v_lshlrev_b32 v8, 16, v86
  v_and_b32 v9, 0xffff0000, v86
  v_pk_add_f32 v[40:41], v[40:41], v[8:9]
  v_lshlrev_b32 v8, 16, v87
  v_and_b32 v9, 0xffff0000, v87
  v_pk_add_f32 v[42:43], v[42:43], v[8:9]
  v_lshlrev_b32 v8, 16, v88
  v_and_b32 v9, 0xffff0000, v88
  v_pk_add_f32 v[36:37], v[36:37], v[8:9]
  v_lshlrev_b32 v8, 16, v89
  v_and_b32 v9, 0xffff0000, v89
  v_pk_add_f32 v[38:39], v[38:39], v[8:9]
  v_lshlrev_b32 v8, 16, v90
  v_and_b32 v9, 0xffff0000, v90
  v_pk_add_f32 v[40:41], v[40:41], v[8:9]
  v_lshlrev_b32 v8, 16, v91
  v_and_b32 v9, 0xffff0000, v91
  v_pk_add_f32 v[42:43], v[42:43], v[8:9]
  v_lshlrev_b32 v8, 16, v92
  v_and_b32 v9, 0xffff0000, v92
  v_pk_add_f32 v[36:37], v[36:37], v[8:9]
  v_lshlrev_b32 v8, 16, v93
  v_and_b32 v9, 0xffff0000, v93
  v_pk_add_f32 v[38:39], v[38:39], v[8:9]
  v_lshlrev_b32 v8, 16, v94
  v_and_b32 v9, 0xffff0000, v94
  v_pk_add_f32 v[40:41], v[40:41], v[8:9]
  v_lshlrev_b32 v8, 16, v95
  v_and_b32 v9, 0xffff0000, v95
  v_pk_add_f32 v[42:43], v[42:43], v[8:9]
  v_lshlrev_b32 v8, 16, v96
  v_and_b32 v9, 0xffff0000, v96
  v_pk_add_f32 v[36:37], v[36:37], v[8:9]
  v_lshlrev_b32 v8, 16, v97
  v_and_b32 v9, 0xffff0000, v97
  v_pk_add_f32 v[38:39], v[38:39], v[8:9]
  v_lshlrev_b32 v8, 16, v98
  v_and_b32 v9, 0xffff0000, v98
  v_pk_add_f32 v[40:41], v[40:41], v[8:9]
  v_lshlrev_b32 v8, 16, v99
  v_and_b32 v9, 0xffff0000, v99
  v_pk_add_f32 v[42:43], v[42:43], v[8:9]
  v_lshlrev_b32 v8, 16, v100
  v_and_b32 v9, 0xffff0000, v100
  v_pk_add_f32 v[36:37], v[36:37], v[8:9]
  v_lshlrev_b32 v8, 16, v101
  v_and_b32 v9, 0xffff0000, v101
  v_pk_add_f32 v[38:39], v[38:39], v[8:9]
  v_lshlrev_b32 v8, 16, v102
  v_and_b32 v9, 0xffff0000, v102
  v_pk_add_f32 v[40:41], v[40:41], v[8:9]
  v_lshlrev_b32 v8, 16, v103
  v_and_b32 v9, 0xffff0000, v103
  v_pk_add_f32 v[42:43], v[42:43], v[8:9]
  v_lshlrev_b32 v8, 16, v104
  v_and_b32 v9, 0xffff0000, v104
  v_pk_add_f32 v[36:37], v[36:37], v[8:9]
  v_lshlrev_b32 v8, 16, v105
  v_and_b32 v9, 0xffff0000, v105
  v_pk_add_f32 v[38:39], v[38:39], v[8:9]
  v_lshlrev_b32 v8, 16, v106
  v_and_b32 v9, 0xffff0000, v106
  v_pk_add_f32 v[40:41], v[40:41], v[8:9]
  v_lshlrev_b32 v8, 16, v107
  v_and_b32 v9, 0xffff0000, v107
  v_pk_add_f32 v[42:43], v[42:43], v[8:9]
  v_lshlrev_b32 v8, 16, v108
  v_and_b32 v9, 0xffff0000, v108
  v_pk_add_f32 v[36:37], v[36:37], v[8:9]
  v_lshlrev_b32 v8, 16, v109
  v_and_b32 v9, 0xffff0000, v109
  v_pk_add_f32 v[38:39], v[38:39], v[8:9]
  v_lshlrev_b32 v8, 16, v110
  v_and_b32 v9, 0xffff0000, v110
  v_pk_add_f32 v[40:41], v[40:41], v[8:9]
  v_lshlrev_b32 v8, 16, v111
  v_and_b32 v9, 0xffff0000, v111
  v_pk_add_f32 v[42:43], v[42:43], v[8:9]
  v_cvt_pk_bf16_f32 v8, v36, v37
  v_lshlrev_b32 v36, 16, v8
  v_and_b32 v37, 0xffff0000, v8
  v_lshlrev_b32 v10, 16, v16
  v_and_b32 v11, 0xffff0000, v16
  v_pk_add_f32 v[36:37], v[36:37], v[10:11]
  v_cvt_pk_bf16_f32 v16, v36, v37
  v_lshlrev_b32 v36, 16, v16
  v_and_b32 v37, 0xffff0000, v16
  v_cvt_pk_bf16_f32 v8, v38, v39
  v_lshlrev_b32 v38, 16, v8
  v_and_b32 v39, 0xffff0000, v8
  v_lshlrev_b32 v10, 16, v17
  v_and_b32 v11, 0xffff0000, v17
  v_pk_add_f32 v[38:39], v[38:39], v[10:11]
  v_cvt_pk_bf16_f32 v17, v38, v39
  v_lshlrev_b32 v38, 16, v17
  v_and_b32 v39, 0xffff0000, v17
  v_cvt_pk_bf16_f32 v8, v40, v41
  v_lshlrev_b32 v40, 16, v8
  v_and_b32 v41, 0xffff0000, v8
  v_lshlrev_b32 v10, 16, v18
  v_and_b32 v11, 0xffff0000, v18
  v_pk_add_f32 v[40:41], v[40:41], v[10:11]
  v_cvt_pk_bf16_f32 v18, v40, v41
  v_lshlrev_b32 v40, 16, v18
  v_and_b32 v41, 0xffff0000, v18
  v_cvt_pk_bf16_f32 v8, v42, v43
  v_lshlrev_b32 v42, 16, v8
  v_and_b32 v43, 0xffff0000, v8
  v_lshlrev_b32 v10, 16, v19
  v_and_b32 v11, 0xffff0000, v19
  v_pk_add_f32 v[42:43], v[42:43], v[10:11]
  v_cvt_pk_bf16_f32 v19, v42, v43
  v_lshlrev_b32 v42, 16, v19
  v_and_b32 v43, 0xffff0000, v19
  buffer_store_dwordx4 v[16:19], v15, s[4:7], s21 offen offset:0
  s_waitcnt vmcnt(25)
  v_lshlrev_b32 v44, 16, v112
  v_and_b32 v45, 0xffff0000, v112
  v_lshlrev_b32 v46, 16, v113
  v_and_b32 v47, 0xffff0000, v113
  v_lshlrev_b32 v48, 16, v114
  v_and_b32 v49, 0xffff0000, v114
  v_lshlrev_b32 v50, 16, v115
  v_and_b32 v51, 0xffff0000, v115
  v_lshlrev_b32 v8, 16, v116
  v_and_b32 v9, 0xffff0000, v116
  v_pk_add_f32 v[44:45], v[44:45], v[8:9]
  v_lshlrev_b32 v8, 16, v117
  v_and_b32 v9, 0xffff0000, v117
  v_pk_add_f32 v[46:47], v[46:47], v[8:9]
  v_lshlrev_b32 v8, 16, v118
  v_and_b32 v9, 0xffff0000, v118
  v_pk_add_f32 v[48:49], v[48:49], v[8:9]
  v_lshlrev_b32 v8, 16, v119
  v_and_b32 v9, 0xffff0000, v119
  v_pk_add_f32 v[50:51], v[50:51], v[8:9]
  v_lshlrev_b32 v8, 16, v120
  v_and_b32 v9, 0xffff0000, v120
  v_pk_add_f32 v[44:45], v[44:45], v[8:9]
  v_lshlrev_b32 v8, 16, v121
  v_and_b32 v9, 0xffff0000, v121
  v_pk_add_f32 v[46:47], v[46:47], v[8:9]
  v_lshlrev_b32 v8, 16, v122
  v_and_b32 v9, 0xffff0000, v122
  v_pk_add_f32 v[48:49], v[48:49], v[8:9]
  v_lshlrev_b32 v8, 16, v123
  v_and_b32 v9, 0xffff0000, v123
  v_pk_add_f32 v[50:51], v[50:51], v[8:9]
  v_lshlrev_b32 v8, 16, v124
  v_and_b32 v9, 0xffff0000, v124
  v_pk_add_f32 v[44:45], v[44:45], v[8:9]
  v_lshlrev_b32 v8, 16, v125
  v_and_b32 v9, 0xffff0000, v125
  v_pk_add_f32 v[46:47], v[46:47], v[8:9]
  v_lshlrev_b32 v8, 16, v126
  v_and_b32 v9, 0xffff0000, v126
  v_pk_add_f32 v[48:49], v[48:49], v[8:9]
  v_lshlrev_b32 v8, 16, v127
  v_and_b32 v9, 0xffff0000, v127
  v_pk_add_f32 v[50:51], v[50:51], v[8:9]
  v_lshlrev_b32 v8, 16, v128
  v_and_b32 v9, 0xffff0000, v128
  v_pk_add_f32 v[44:45], v[44:45], v[8:9]
  v_lshlrev_b32 v8, 16, v129
  v_and_b32 v9, 0xffff0000, v129
  v_pk_add_f32 v[46:47], v[46:47], v[8:9]
  v_lshlrev_b32 v8, 16, v130
  v_and_b32 v9, 0xffff0000, v130
  v_pk_add_f32 v[48:49], v[48:49], v[8:9]
  v_lshlrev_b32 v8, 16, v131
  v_and_b32 v9, 0xffff0000, v131
  v_pk_add_f32 v[50:51], v[50:51], v[8:9]
  v_lshlrev_b32 v8, 16, v132
  v_and_b32 v9, 0xffff0000, v132
  v_pk_add_f32 v[44:45], v[44:45], v[8:9]
  v_lshlrev_b32 v8, 16, v133
  v_and_b32 v9, 0xffff0000, v133
  v_pk_add_f32 v[46:47], v[46:47], v[8:9]
  v_lshlrev_b32 v8, 16, v134
  v_and_b32 v9, 0xffff0000, v134
  v_pk_add_f32 v[48:49], v[48:49], v[8:9]
  v_lshlrev_b32 v8, 16, v135
  v_and_b32 v9, 0xffff0000, v135
  v_pk_add_f32 v[50:51], v[50:51], v[8:9]
  v_lshlrev_b32 v8, 16, v136
  v_and_b32 v9, 0xffff0000, v136
  v_pk_add_f32 v[44:45], v[44:45], v[8:9]
  v_lshlrev_b32 v8, 16, v137
  v_and_b32 v9, 0xffff0000, v137
  v_pk_add_f32 v[46:47], v[46:47], v[8:9]
  v_lshlrev_b32 v8, 16, v138
  v_and_b32 v9, 0xffff0000, v138
  v_pk_add_f32 v[48:49], v[48:49], v[8:9]
  v_lshlrev_b32 v8, 16, v139
  v_and_b32 v9, 0xffff0000, v139
  v_pk_add_f32 v[50:51], v[50:51], v[8:9]
  v_lshlrev_b32 v8, 16, v140
  v_and_b32 v9, 0xffff0000, v140
  v_pk_add_f32 v[44:45], v[44:45], v[8:9]
  v_lshlrev_b32 v8, 16, v141
  v_and_b32 v9, 0xffff0000, v141
  v_pk_add_f32 v[46:47], v[46:47], v[8:9]
  v_lshlrev_b32 v8, 16, v142
  v_and_b32 v9, 0xffff0000, v142
  v_pk_add_f32 v[48:49], v[48:49], v[8:9]
  v_lshlrev_b32 v8, 16, v143
  v_and_b32 v9, 0xffff0000, v143
  v_pk_add_f32 v[50:51], v[50:51], v[8:9]
  v_cvt_pk_bf16_f32 v8, v44, v45
  v_lshlrev_b32 v44, 16, v8
  v_and_b32 v45, 0xffff0000, v8
  v_lshlrev_b32 v10, 16, v20
  v_and_b32 v11, 0xffff0000, v20
  v_pk_add_f32 v[44:45], v[44:45], v[10:11]
  v_cvt_pk_bf16_f32 v20, v44, v45
  v_lshlrev_b32 v44, 16, v20
  v_and_b32 v45, 0xffff0000, v20
  v_cvt_pk_bf16_f32 v8, v46, v47
  v_lshlrev_b32 v46, 16, v8
  v_and_b32 v47, 0xffff0000, v8
  v_lshlrev_b32 v10, 16, v21
  v_and_b32 v11, 0xffff0000, v21
  v_pk_add_f32 v[46:47], v[46:47], v[10:11]
  v_cvt_pk_bf16_f32 v21, v46, v47
  v_lshlrev_b32 v46, 16, v21
  v_and_b32 v47, 0xffff0000, v21
  v_cvt_pk_bf16_f32 v8, v48, v49
  v_lshlrev_b32 v48, 16, v8
  v_and_b32 v49, 0xffff0000, v8
  v_lshlrev_b32 v10, 16, v22
  v_and_b32 v11, 0xffff0000, v22
  v_pk_add_f32 v[48:49], v[48:49], v[10:11]
  v_cvt_pk_bf16_f32 v22, v48, v49
  v_lshlrev_b32 v48, 16, v22
  v_and_b32 v49, 0xffff0000, v22
  v_cvt_pk_bf16_f32 v8, v50, v51
  v_lshlrev_b32 v50, 16, v8
  v_and_b32 v51, 0xffff0000, v8
  v_lshlrev_b32 v10, 16, v23
  v_and_b32 v11, 0xffff0000, v23
  v_pk_add_f32 v[50:51], v[50:51], v[10:11]
  v_cvt_pk_bf16_f32 v23, v50, v51
  v_lshlrev_b32 v50, 16, v23
  v_and_b32 v51, 0xffff0000, v23
  buffer_store_dwordx4 v[20:23], v15, s[4:7], s21 offen offset:64
  s_waitcnt vmcnt(18)
  v_lshlrev_b32 v52, 16, v144
  v_and_b32 v53, 0xffff0000, v144
  v_lshlrev_b32 v54, 16, v145
  v_and_b32 v55, 0xffff0000, v145
  v_lshlrev_b32 v56, 16, v146
  v_and_b32 v57, 0xffff0000, v146
  v_lshlrev_b32 v58, 16, v147
  v_and_b32 v59, 0xffff0000, v147
  v_lshlrev_b32 v8, 16, v148
  v_and_b32 v9, 0xffff0000, v148
  v_pk_add_f32 v[52:53], v[52:53], v[8:9]
  v_lshlrev_b32 v8, 16, v149
  v_and_b32 v9, 0xffff0000, v149
  v_pk_add_f32 v[54:55], v[54:55], v[8:9]
  v_lshlrev_b32 v8, 16, v150
  v_and_b32 v9, 0xffff0000, v150
  v_pk_add_f32 v[56:57], v[56:57], v[8:9]
  v_lshlrev_b32 v8, 16, v151
  v_and_b32 v9, 0xffff0000, v151
  v_pk_add_f32 v[58:59], v[58:59], v[8:9]
  v_lshlrev_b32 v8, 16, v152
  v_and_b32 v9, 0xffff0000, v152
  v_pk_add_f32 v[52:53], v[52:53], v[8:9]
  v_lshlrev_b32 v8, 16, v153
  v_and_b32 v9, 0xffff0000, v153
  v_pk_add_f32 v[54:55], v[54:55], v[8:9]
  v_lshlrev_b32 v8, 16, v154
  v_and_b32 v9, 0xffff0000, v154
  v_pk_add_f32 v[56:57], v[56:57], v[8:9]
  v_lshlrev_b32 v8, 16, v155
  v_and_b32 v9, 0xffff0000, v155
  v_pk_add_f32 v[58:59], v[58:59], v[8:9]
  v_lshlrev_b32 v8, 16, v156
  v_and_b32 v9, 0xffff0000, v156
  v_pk_add_f32 v[52:53], v[52:53], v[8:9]
  v_lshlrev_b32 v8, 16, v157
  v_and_b32 v9, 0xffff0000, v157
  v_pk_add_f32 v[54:55], v[54:55], v[8:9]
  v_lshlrev_b32 v8, 16, v158
  v_and_b32 v9, 0xffff0000, v158
  v_pk_add_f32 v[56:57], v[56:57], v[8:9]
  v_lshlrev_b32 v8, 16, v159
  v_and_b32 v9, 0xffff0000, v159
  v_pk_add_f32 v[58:59], v[58:59], v[8:9]
  v_lshlrev_b32 v8, 16, v160
  v_and_b32 v9, 0xffff0000, v160
  v_pk_add_f32 v[52:53], v[52:53], v[8:9]
  v_lshlrev_b32 v8, 16, v161
  v_and_b32 v9, 0xffff0000, v161
  v_pk_add_f32 v[54:55], v[54:55], v[8:9]
  v_lshlrev_b32 v8, 16, v162
  v_and_b32 v9, 0xffff0000, v162
  v_pk_add_f32 v[56:57], v[56:57], v[8:9]
  v_lshlrev_b32 v8, 16, v163
  v_and_b32 v9, 0xffff0000, v163
  v_pk_add_f32 v[58:59], v[58:59], v[8:9]
  v_lshlrev_b32 v8, 16, v164
  v_and_b32 v9, 0xffff0000, v164
  v_pk_add_f32 v[52:53], v[52:53], v[8:9]
  v_lshlrev_b32 v8, 16, v165
  v_and_b32 v9, 0xffff0000, v165
  v_pk_add_f32 v[54:55], v[54:55], v[8:9]
  v_lshlrev_b32 v8, 16, v166
  v_and_b32 v9, 0xffff0000, v166
  v_pk_add_f32 v[56:57], v[56:57], v[8:9]
  v_lshlrev_b32 v8, 16, v167
  v_and_b32 v9, 0xffff0000, v167
  v_pk_add_f32 v[58:59], v[58:59], v[8:9]
  v_lshlrev_b32 v8, 16, v168
  v_and_b32 v9, 0xffff0000, v168
  v_pk_add_f32 v[52:53], v[52:53], v[8:9]
  v_lshlrev_b32 v8, 16, v169
  v_and_b32 v9, 0xffff0000, v169
  v_pk_add_f32 v[54:55], v[54:55], v[8:9]
  v_lshlrev_b32 v8, 16, v170
  v_and_b32 v9, 0xffff0000, v170
  v_pk_add_f32 v[56:57], v[56:57], v[8:9]
  v_lshlrev_b32 v8, 16, v171
  v_and_b32 v9, 0xffff0000, v171
  v_pk_add_f32 v[58:59], v[58:59], v[8:9]
  v_lshlrev_b32 v8, 16, v172
  v_and_b32 v9, 0xffff0000, v172
  v_pk_add_f32 v[52:53], v[52:53], v[8:9]
  v_lshlrev_b32 v8, 16, v173
  v_and_b32 v9, 0xffff0000, v173
  v_pk_add_f32 v[54:55], v[54:55], v[8:9]
  v_lshlrev_b32 v8, 16, v174
  v_and_b32 v9, 0xffff0000, v174
  v_pk_add_f32 v[56:57], v[56:57], v[8:9]
  v_lshlrev_b32 v8, 16, v175
  v_and_b32 v9, 0xffff0000, v175
  v_pk_add_f32 v[58:59], v[58:59], v[8:9]
  v_cvt_pk_bf16_f32 v8, v52, v53
  v_lshlrev_b32 v52, 16, v8
  v_and_b32 v53, 0xffff0000, v8
  v_lshlrev_b32 v10, 16, v24
  v_and_b32 v11, 0xffff0000, v24
  v_pk_add_f32 v[52:53], v[52:53], v[10:11]
  v_cvt_pk_bf16_f32 v24, v52, v53
  v_lshlrev_b32 v52, 16, v24
  v_and_b32 v53, 0xffff0000, v24
  v_cvt_pk_bf16_f32 v8, v54, v55
  v_lshlrev_b32 v54, 16, v8
  v_and_b32 v55, 0xffff0000, v8
  v_lshlrev_b32 v10, 16, v25
  v_and_b32 v11, 0xffff0000, v25
  v_pk_add_f32 v[54:55], v[54:55], v[10:11]
  v_cvt_pk_bf16_f32 v25, v54, v55
  v_lshlrev_b32 v54, 16, v25
  v_and_b32 v55, 0xffff0000, v25
  v_cvt_pk_bf16_f32 v8, v56, v57
  v_lshlrev_b32 v56, 16, v8
  v_and_b32 v57, 0xffff0000, v8
  v_lshlrev_b32 v10, 16, v26
  v_and_b32 v11, 0xffff0000, v26
  v_pk_add_f32 v[56:57], v[56:57], v[10:11]
  v_cvt_pk_bf16_f32 v26, v56, v57
  v_lshlrev_b32 v56, 16, v26
  v_and_b32 v57, 0xffff0000, v26
  v_cvt_pk_bf16_f32 v8, v58, v59
  v_lshlrev_b32 v58, 16, v8
  v_and_b32 v59, 0xffff0000, v8
  v_lshlrev_b32 v10, 16, v27
  v_and_b32 v11, 0xffff0000, v27
  v_pk_add_f32 v[58:59], v[58:59], v[10:11]
  v_cvt_pk_bf16_f32 v27, v58, v59
  v_lshlrev_b32 v58, 16, v27
  v_and_b32 v59, 0xffff0000, v27
  buffer_store_dwordx4 v[24:27], v15, s[4:7], s21 offen offset:128
  s_waitcnt vmcnt(11)
  v_lshlrev_b32 v60, 16, v176
  v_and_b32 v61, 0xffff0000, v176
  v_lshlrev_b32 v62, 16, v177
  v_and_b32 v63, 0xffff0000, v177
  v_lshlrev_b32 v64, 16, v178
  v_and_b32 v65, 0xffff0000, v178
  v_lshlrev_b32 v66, 16, v179
  v_and_b32 v67, 0xffff0000, v179
  v_lshlrev_b32 v8, 16, v180
  v_and_b32 v9, 0xffff0000, v180
  v_pk_add_f32 v[60:61], v[60:61], v[8:9]
  v_lshlrev_b32 v8, 16, v181
  v_and_b32 v9, 0xffff0000, v181
  v_pk_add_f32 v[62:63], v[62:63], v[8:9]
  v_lshlrev_b32 v8, 16, v182
  v_and_b32 v9, 0xffff0000, v182
  v_pk_add_f32 v[64:65], v[64:65], v[8:9]
  v_lshlrev_b32 v8, 16, v183
  v_and_b32 v9, 0xffff0000, v183
  v_pk_add_f32 v[66:67], v[66:67], v[8:9]
  v_lshlrev_b32 v8, 16, v184
  v_and_b32 v9, 0xffff0000, v184
  v_pk_add_f32 v[60:61], v[60:61], v[8:9]
  v_lshlrev_b32 v8, 16, v185
  v_and_b32 v9, 0xffff0000, v185
  v_pk_add_f32 v[62:63], v[62:63], v[8:9]
  v_lshlrev_b32 v8, 16, v186
  v_and_b32 v9, 0xffff0000, v186
  v_pk_add_f32 v[64:65], v[64:65], v[8:9]
  v_lshlrev_b32 v8, 16, v187
  v_and_b32 v9, 0xffff0000, v187
  v_pk_add_f32 v[66:67], v[66:67], v[8:9]
  v_lshlrev_b32 v8, 16, v188
  v_and_b32 v9, 0xffff0000, v188
  v_pk_add_f32 v[60:61], v[60:61], v[8:9]
  v_lshlrev_b32 v8, 16, v189
  v_and_b32 v9, 0xffff0000, v189
  v_pk_add_f32 v[62:63], v[62:63], v[8:9]
  v_lshlrev_b32 v8, 16, v190
  v_and_b32 v9, 0xffff0000, v190
  v_pk_add_f32 v[64:65], v[64:65], v[8:9]
  v_lshlrev_b32 v8, 16, v191
  v_and_b32 v9, 0xffff0000, v191
  v_pk_add_f32 v[66:67], v[66:67], v[8:9]
  v_lshlrev_b32 v8, 16, v192
  v_and_b32 v9, 0xffff0000, v192
  v_pk_add_f32 v[60:61], v[60:61], v[8:9]
  v_lshlrev_b32 v8, 16, v193
  v_and_b32 v9, 0xffff0000, v193
  v_pk_add_f32 v[62:63], v[62:63], v[8:9]
  v_lshlrev_b32 v8, 16, v194
  v_and_b32 v9, 0xffff0000, v194
  v_pk_add_f32 v[64:65], v[64:65], v[8:9]
  v_lshlrev_b32 v8, 16, v195
  v_and_b32 v9, 0xffff0000, v195
  v_pk_add_f32 v[66:67], v[66:67], v[8:9]
  v_lshlrev_b32 v8, 16, v196
  v_and_b32 v9, 0xffff0000, v196
  v_pk_add_f32 v[60:61], v[60:61], v[8:9]
  v_lshlrev_b32 v8, 16, v197
  v_and_b32 v9, 0xffff0000, v197
  v_pk_add_f32 v[62:63], v[62:63], v[8:9]
  v_lshlrev_b32 v8, 16, v198
  v_and_b32 v9, 0xffff0000, v198
  v_pk_add_f32 v[64:65], v[64:65], v[8:9]
  v_lshlrev_b32 v8, 16, v199
  v_and_b32 v9, 0xffff0000, v199
  v_pk_add_f32 v[66:67], v[66:67], v[8:9]
  v_lshlrev_b32 v8, 16, v200
  v_and_b32 v9, 0xffff0000, v200
  v_pk_add_f32 v[60:61], v[60:61], v[8:9]
  v_lshlrev_b32 v8, 16, v201
  v_and_b32 v9, 0xffff0000, v201
  v_pk_add_f32 v[62:63], v[62:63], v[8:9]
  v_lshlrev_b32 v8, 16, v202
  v_and_b32 v9, 0xffff0000, v202
  v_pk_add_f32 v[64:65], v[64:65], v[8:9]
  v_lshlrev_b32 v8, 16, v203
  v_and_b32 v9, 0xffff0000, v203
  v_pk_add_f32 v[66:67], v[66:67], v[8:9]
  v_lshlrev_b32 v8, 16, v204
  v_and_b32 v9, 0xffff0000, v204
  v_pk_add_f32 v[60:61], v[60:61], v[8:9]
  v_lshlrev_b32 v8, 16, v205
  v_and_b32 v9, 0xffff0000, v205
  v_pk_add_f32 v[62:63], v[62:63], v[8:9]
  v_lshlrev_b32 v8, 16, v206
  v_and_b32 v9, 0xffff0000, v206
  v_pk_add_f32 v[64:65], v[64:65], v[8:9]
  v_lshlrev_b32 v8, 16, v207
  v_and_b32 v9, 0xffff0000, v207
  v_pk_add_f32 v[66:67], v[66:67], v[8:9]
  v_cvt_pk_bf16_f32 v8, v60, v61
  v_lshlrev_b32 v60, 16, v8
  v_and_b32 v61, 0xffff0000, v8
  v_lshlrev_b32 v10, 16, v28
  v_and_b32 v11, 0xffff0000, v28
  v_pk_add_f32 v[60:61], v[60:61], v[10:11]
  v_cvt_pk_bf16_f32 v28, v60, v61
  v_lshlrev_b32 v60, 16, v28
  v_and_b32 v61, 0xffff0000, v28
  v_cvt_pk_bf16_f32 v8, v62, v63
  v_lshlrev_b32 v62, 16, v8
  v_and_b32 v63, 0xffff0000, v8
  v_lshlrev_b32 v10, 16, v29
  v_and_b32 v11, 0xffff0000, v29
  v_pk_add_f32 v[62:63], v[62:63], v[10:11]
  v_cvt_pk_bf16_f32 v29, v62, v63
  v_lshlrev_b32 v62, 16, v29
  v_and_b32 v63, 0xffff0000, v29
  v_cvt_pk_bf16_f32 v8, v64, v65
  v_lshlrev_b32 v64, 16, v8
  v_and_b32 v65, 0xffff0000, v8
  v_lshlrev_b32 v10, 16, v30
  v_and_b32 v11, 0xffff0000, v30
  v_pk_add_f32 v[64:65], v[64:65], v[10:11]
  v_cvt_pk_bf16_f32 v30, v64, v65
  v_lshlrev_b32 v64, 16, v30
  v_and_b32 v65, 0xffff0000, v30
  v_cvt_pk_bf16_f32 v8, v66, v67
  v_lshlrev_b32 v66, 16, v8
  v_and_b32 v67, 0xffff0000, v8
  v_lshlrev_b32 v10, 16, v31
  v_and_b32 v11, 0xffff0000, v31
  v_pk_add_f32 v[66:67], v[66:67], v[10:11]
  v_cvt_pk_bf16_f32 v31, v66, v67
  v_lshlrev_b32 v66, 16, v31
  v_and_b32 v67, 0xffff0000, v31
  buffer_store_dwordx4 v[28:31], v15, s[4:7], s21 offen offset:192
  s_waitcnt vmcnt(4)
  v_lshlrev_b32 v68, 16, v208
  v_and_b32 v69, 0xffff0000, v208
  v_lshlrev_b32 v70, 16, v209
  v_and_b32 v71, 0xffff0000, v209
  v_lshlrev_b32 v72, 16, v210
  v_and_b32 v73, 0xffff0000, v210
  v_lshlrev_b32 v74, 16, v211
  v_and_b32 v75, 0xffff0000, v211
  v_lshlrev_b32 v8, 16, v212
  v_and_b32 v9, 0xffff0000, v212
  v_pk_add_f32 v[68:69], v[68:69], v[8:9]
  v_lshlrev_b32 v8, 16, v213
  v_and_b32 v9, 0xffff0000, v213
  v_pk_add_f32 v[70:71], v[70:71], v[8:9]
  v_lshlrev_b32 v8, 16, v214
  v_and_b32 v9, 0xffff0000, v214
  v_pk_add_f32 v[72:73], v[72:73], v[8:9]
  v_lshlrev_b32 v8, 16, v215
  v_and_b32 v9, 0xffff0000, v215
  v_pk_add_f32 v[74:75], v[74:75], v[8:9]
  v_lshlrev_b32 v8, 16, v216
  v_and_b32 v9, 0xffff0000, v216
  v_pk_add_f32 v[68:69], v[68:69], v[8:9]
  v_lshlrev_b32 v8, 16, v217
  v_and_b32 v9, 0xffff0000, v217
  v_pk_add_f32 v[70:71], v[70:71], v[8:9]
  v_lshlrev_b32 v8, 16, v218
  v_and_b32 v9, 0xffff0000, v218
  v_pk_add_f32 v[72:73], v[72:73], v[8:9]
  v_lshlrev_b32 v8, 16, v219
  v_and_b32 v9, 0xffff0000, v219
  v_pk_add_f32 v[74:75], v[74:75], v[8:9]
  v_lshlrev_b32 v8, 16, v220
  v_and_b32 v9, 0xffff0000, v220
  v_pk_add_f32 v[68:69], v[68:69], v[8:9]
  v_lshlrev_b32 v8, 16, v221
  v_and_b32 v9, 0xffff0000, v221
  v_pk_add_f32 v[70:71], v[70:71], v[8:9]
  v_lshlrev_b32 v8, 16, v222
  v_and_b32 v9, 0xffff0000, v222
  v_pk_add_f32 v[72:73], v[72:73], v[8:9]
  v_lshlrev_b32 v8, 16, v223
  v_and_b32 v9, 0xffff0000, v223
  v_pk_add_f32 v[74:75], v[74:75], v[8:9]
  v_lshlrev_b32 v8, 16, v224
  v_and_b32 v9, 0xffff0000, v224
  v_pk_add_f32 v[68:69], v[68:69], v[8:9]
  v_lshlrev_b32 v8, 16, v225
  v_and_b32 v9, 0xffff0000, v225
  v_pk_add_f32 v[70:71], v[70:71], v[8:9]
  v_lshlrev_b32 v8, 16, v226
  v_and_b32 v9, 0xffff0000, v226
  v_pk_add_f32 v[72:73], v[72:73], v[8:9]
  v_lshlrev_b32 v8, 16, v227
  v_and_b32 v9, 0xffff0000, v227
  v_pk_add_f32 v[74:75], v[74:75], v[8:9]
  v_lshlrev_b32 v8, 16, v228
  v_and_b32 v9, 0xffff0000, v228
  v_pk_add_f32 v[68:69], v[68:69], v[8:9]
  v_lshlrev_b32 v8, 16, v229
  v_and_b32 v9, 0xffff0000, v229
  v_pk_add_f32 v[70:71], v[70:71], v[8:9]
  v_lshlrev_b32 v8, 16, v230
  v_and_b32 v9, 0xffff0000, v230
  v_pk_add_f32 v[72:73], v[72:73], v[8:9]
  v_lshlrev_b32 v8, 16, v231
  v_and_b32 v9, 0xffff0000, v231
  v_pk_add_f32 v[74:75], v[74:75], v[8:9]
  v_lshlrev_b32 v8, 16, v232
  v_and_b32 v9, 0xffff0000, v232
  v_pk_add_f32 v[68:69], v[68:69], v[8:9]
  v_lshlrev_b32 v8, 16, v233
  v_and_b32 v9, 0xffff0000, v233
  v_pk_add_f32 v[70:71], v[70:71], v[8:9]
  v_lshlrev_b32 v8, 16, v234
  v_and_b32 v9, 0xffff0000, v234
  v_pk_add_f32 v[72:73], v[72:73], v[8:9]
  v_lshlrev_b32 v8, 16, v235
  v_and_b32 v9, 0xffff0000, v235
  v_pk_add_f32 v[74:75], v[74:75], v[8:9]
  v_lshlrev_b32 v8, 16, v236
  v_and_b32 v9, 0xffff0000, v236
  v_pk_add_f32 v[68:69], v[68:69], v[8:9]
  v_lshlrev_b32 v8, 16, v237
  v_and_b32 v9, 0xffff0000, v237
  v_pk_add_f32 v[70:71], v[70:71], v[8:9]
  v_lshlrev_b32 v8, 16, v238
  v_and_b32 v9, 0xffff0000, v238
  v_pk_add_f32 v[72:73], v[72:73], v[8:9]
  v_lshlrev_b32 v8, 16, v239
  v_and_b32 v9, 0xffff0000, v239
  v_pk_add_f32 v[74:75], v[74:75], v[8:9]
  v_cvt_pk_bf16_f32 v8, v68, v69
  v_lshlrev_b32 v68, 16, v8
  v_and_b32 v69, 0xffff0000, v8
  v_lshlrev_b32 v10, 16, v32
  v_and_b32 v11, 0xffff0000, v32
  v_pk_add_f32 v[68:69], v[68:69], v[10:11]
  v_cvt_pk_bf16_f32 v32, v68, v69
  v_lshlrev_b32 v68, 16, v32
  v_and_b32 v69, 0xffff0000, v32
  v_cvt_pk_bf16_f32 v8, v70, v71
  v_lshlrev_b32 v70, 16, v8
  v_and_b32 v71, 0xffff0000, v8
  v_lshlrev_b32 v10, 16, v33
  v_and_b32 v11, 0xffff0000, v33
  v_pk_add_f32 v[70:71], v[70:71], v[10:11]
  v_cvt_pk_bf16_f32 v33, v70, v71
  v_lshlrev_b32 v70, 16, v33
  v_and_b32 v71, 0xffff0000, v33
  v_cvt_pk_bf16_f32 v8, v72, v73
  v_lshlrev_b32 v72, 16, v8
  v_and_b32 v73, 0xffff0000, v8
  v_lshlrev_b32 v10, 16, v34
  v_and_b32 v11, 0xffff0000, v34
  v_pk_add_f32 v[72:73], v[72:73], v[10:11]
  v_cvt_pk_bf16_f32 v34, v72, v73
  v_lshlrev_b32 v72, 16, v34
  v_and_b32 v73, 0xffff0000, v34
  v_cvt_pk_bf16_f32 v8, v74, v75
  v_lshlrev_b32 v74, 16, v8
  v_and_b32 v75, 0xffff0000, v8
  v_lshlrev_b32 v10, 16, v35
  v_and_b32 v11, 0xffff0000, v35
  v_pk_add_f32 v[74:75], v[74:75], v[10:11]
  v_cvt_pk_bf16_f32 v35, v74, v75
  v_lshlrev_b32 v74, 16, v35
  v_and_b32 v75, 0xffff0000, v35
  buffer_store_dwordx4 v[32:35], v15, s[4:7], s21 offen offset:256
  v_and_b32 v3, 63, v0
  v_and_b32 v2, 15, v3
  v_lshlrev_b32 v5, 2, v2
  s_lshl_b32 s17, s16, 6
  v_add_u32 v1, s17, v5
  v_pk_add_f32 v[6:7], v[36:37], v[38:39]
  v_pk_add_f32 v[6:7], v[6:7], v[40:41]
  v_pk_add_f32 v[6:7], v[6:7], v[42:43]
  v_pk_add_f32 v[6:7], v[6:7], v[44:45]
  v_pk_add_f32 v[6:7], v[6:7], v[46:47]
  v_pk_add_f32 v[6:7], v[6:7], v[48:49]
  v_pk_add_f32 v[6:7], v[6:7], v[50:51]
  v_pk_add_f32 v[6:7], v[6:7], v[52:53]
  v_pk_add_f32 v[6:7], v[6:7], v[54:55]
  v_pk_add_f32 v[6:7], v[6:7], v[56:57]
  v_pk_add_f32 v[6:7], v[6:7], v[58:59]
  v_pk_add_f32 v[6:7], v[6:7], v[60:61]
  v_pk_add_f32 v[6:7], v[6:7], v[62:63]
  v_pk_add_f32 v[6:7], v[6:7], v[64:65]
  v_pk_add_f32 v[6:7], v[6:7], v[66:67]
  v_pk_add_f32 v[6:7], v[6:7], v[68:69]
  v_pk_add_f32 v[6:7], v[6:7], v[70:71]
  v_pk_add_f32 v[6:7], v[6:7], v[72:73]
  v_pk_add_f32 v[6:7], v[6:7], v[74:75]
  v_add_f32 v4, v6, v7
  v_mov_b32 v2, v4
  s_nop 1
  v_permlane32_swap_b32 v4, v2
  v_add_f32 v4, v4, v2
  v_mov_b32 v2, v4
  s_nop 1
  v_permlane16_swap_b32 v4, v2
  v_add_f32 v4, v4, v2
  ds_write_b32 v1, v4 offset:0
  s_waitcnt lgkmcnt(0)
  s_barrier
  ds_read_b32 v4, v5 offset:0
  ds_read_b32 v2, v5 offset:64
  ds_read_b32 v3, v5 offset:128
  ds_read_b32 v6, v5 offset:192
  s_waitcnt lgkmcnt(0)
  v_add_f32 v4, v4, v2
  v_add_f32 v3, v3, v6
  v_add_f32 v4, v4, v3
  v_mul_f32 v6, 0xbacccccd, v4
  v_mov_b32 v7, v6
  v_pk_add_f32 v[36:37], v[36:37], v[6:7]
  v_pk_add_f32 v[38:39], v[38:39], v[6:7]
  v_pk_add_f32 v[40:41], v[40:41], v[6:7]
  v_pk_add_f32 v[42:43], v[42:43], v[6:7]
  v_pk_add_f32 v[44:45], v[44:45], v[6:7]
  v_pk_add_f32 v[46:47], v[46:47], v[6:7]
  v_pk_add_f32 v[48:49], v[48:49], v[6:7]
  v_pk_add_f32 v[50:51], v[50:51], v[6:7]
  v_pk_add_f32 v[52:53], v[52:53], v[6:7]
  v_pk_add_f32 v[54:55], v[54:55], v[6:7]
  v_pk_add_f32 v[56:57], v[56:57], v[6:7]
  v_pk_add_f32 v[58:59], v[58:59], v[6:7]
  v_pk_add_f32 v[60:61], v[60:61], v[6:7]
  v_pk_add_f32 v[62:63], v[62:63], v[6:7]
  v_pk_add_f32 v[64:65], v[64:65], v[6:7]
  v_pk_add_f32 v[66:67], v[66:67], v[6:7]
  v_pk_add_f32 v[68:69], v[68:69], v[6:7]
  v_pk_add_f32 v[70:71], v[70:71], v[6:7]
  v_pk_add_f32 v[72:73], v[72:73], v[6:7]
  v_pk_add_f32 v[74:75], v[74:75], v[6:7]
  v_pk_mul_f32 v[6:7], v[36:37], v[36:37]
  v_pk_fma_f32 v[6:7], v[38:39], v[38:39], v[6:7]
  v_pk_fma_f32 v[6:7], v[40:41], v[40:41], v[6:7]
  v_pk_fma_f32 v[6:7], v[42:43], v[42:43], v[6:7]
  v_pk_fma_f32 v[6:7], v[44:45], v[44:45], v[6:7]
  v_pk_fma_f32 v[6:7], v[46:47], v[46:47], v[6:7]
  v_pk_fma_f32 v[6:7], v[48:49], v[48:49], v[6:7]
  v_pk_fma_f32 v[6:7], v[50:51], v[50:51], v[6:7]
  v_pk_fma_f32 v[6:7], v[52:53], v[52:53], v[6:7]
  v_pk_fma_f32 v[6:7], v[54:55], v[54:55], v[6:7]
  v_pk_fma_f32 v[6:7], v[56:57], v[56:57], v[6:7]
  v_pk_fma_f32 v[6:7], v[58:59], v[58:59], v[6:7]
  v_pk_fma_f32 v[6:7], v[60:61], v[60:61], v[6:7]
  v_pk_fma_f32 v[6:7], v[62:63], v[62:63], v[6:7]
  v_pk_fma_f32 v[6:7], v[64:65], v[64:65], v[6:7]
  v_pk_fma_f32 v[6:7], v[66:67], v[66:67], v[6:7]
  v_pk_fma_f32 v[6:7], v[68:69], v[68:69], v[6:7]
  v_pk_fma_f32 v[6:7], v[70:71], v[70:71], v[6:7]
  v_pk_fma_f32 v[6:7], v[72:73], v[72:73], v[6:7]
  v_pk_fma_f32 v[6:7], v[74:75], v[74:75], v[6:7]
  v_add_f32 v4, v6, v7
  v_mov_b32 v2, v4
  s_nop 1
  v_permlane32_swap_b32 v4, v2
  v_add_f32 v4, v4, v2
  v_mov_b32 v2, v4
  s_nop 1
  v_permlane16_swap_b32 v4, v2
  v_add_f32 v4, v4, v2
  ds_write_b32 v1, v4 offset:256
  s_waitcnt lgkmcnt(0)
  s_barrier
  ds_read_b32 v4, v5 offset:256
  ds_read_b32 v2, v5 offset:320
  ds_read_b32 v3, v5 offset:384
  ds_read_b32 v6, v5 offset:448
  s_waitcnt lgkmcnt(0)
  v_add_f32 v4, v4, v2
  v_add_f32 v3, v3, v6
  v_add_f32 v4, v4, v3
  v_mov_b32 v2, 0x3727c5ac
  v_fmac_f32 v2, 0x3acccccd, v4
  v_rsq_f32 v6, v2
  s_nop 0
  v_mov_b32 v7, v6
  v_pk_mul_f32 v[36:37], v[36:37], v[6:7]
  v_pk_mul_f32 v[38:39], v[38:39], v[6:7]
  v_pk_mul_f32 v[40:41], v[40:41], v[6:7]
  v_pk_mul_f32 v[42:43], v[42:43], v[6:7]
  v_pk_mul_f32 v[44:45], v[44:45], v[6:7]
  v_pk_mul_f32 v[46:47], v[46:47], v[6:7]
  v_pk_mul_f32 v[48:49], v[48:49], v[6:7]
  v_pk_mul_f32 v[50:51], v[50:51], v[6:7]
  v_pk_mul_f32 v[52:53], v[52:53], v[6:7]
  v_pk_mul_f32 v[54:55], v[54:55], v[6:7]
  v_pk_mul_f32 v[56:57], v[56:57], v[6:7]
  v_pk_mul_f32 v[58:59], v[58:59], v[6:7]
  v_pk_mul_f32 v[60:61], v[60:61], v[6:7]
  v_pk_mul_f32 v[62:63], v[62:63], v[6:7]
  v_pk_mul_f32 v[64:65], v[64:65], v[6:7]
  v_pk_mul_f32 v[66:67], v[66:67], v[6:7]
  v_pk_mul_f32 v[68:69], v[68:69], v[6:7]
  v_pk_mul_f32 v[70:71], v[70:71], v[6:7]
  v_pk_mul_f32 v[72:73], v[72:73], v[6:7]
  v_pk_mul_f32 v[74:75], v[74:75], v[6:7]
  v_cvt_pk_bf16_f32 v16, v36, v37
  v_cvt_pk_bf16_f32 v17, v38, v39
  v_cvt_pk_bf16_f32 v18, v40, v41
  v_cvt_pk_bf16_f32 v19, v42, v43
  v_cvt_pk_bf16_f32 v20, v44, v45
  v_cvt_pk_bf16_f32 v21, v46, v47
  v_cvt_pk_bf16_f32 v22, v48, v49
  v_cvt_pk_bf16_f32 v23, v50, v51
  v_cvt_pk_bf16_f32 v24, v52, v53
  v_cvt_pk_bf16_f32 v25, v54, v55
  v_cvt_pk_bf16_f32 v26, v56, v57
  v_cvt_pk_bf16_f32 v27, v58, v59
  v_cvt_pk_bf16_f32 v28, v60, v61
  v_cvt_pk_bf16_f32 v29, v62, v63
  v_cvt_pk_bf16_f32 v30, v64, v65
  v_cvt_pk_bf16_f32 v31, v66, v67
  v_cvt_pk_bf16_f32 v32, v68, v69
  v_cvt_pk_bf16_f32 v33, v70, v71
  v_cvt_pk_bf16_f32 v34, v72, v73
  v_cvt_pk_bf16_f32 v35, v74, v75
  v_and_b32 v3, 63, v0
  v_and_b32 v2, 15, v3
  v_lshlrev_b32 v1, 4, v2
  v_bfe_u32 v2, v3, 4, 1
  v_lshl_add_u32 v1, v2, 9, v1
  v_lshrrev_b32 v2, 5, v3
  v_lshl_add_u32 v1, v2, 10, v1
  s_lshr_b32 s17, s2, 1
  s_mul_i32 s17, s17, 40960
  s_and_b32 s18, s2, 1
  s_lshl_b32 s18, s18, 8
  s_add_u32 s17, s17, s18
  s_mul_i32 s18, s16, 10240
  s_add_u32 s17, s17, s18
  s_add_u32 s17, s17, 199229440
  buffer_store_dwordx4 v[16:19], v1, s[4:7], s17 offen offset:0
  buffer_store_dwordx4 v[20:23], v1, s[4:7], s17 offen offset:2048
  s_add_u32 s17, s17, 4096
  buffer_store_dwordx4 v[24:27], v1, s[4:7], s17 offen offset:0
  buffer_store_dwordx4 v[28:31], v1, s[4:7], s17 offen offset:2048
  s_add_u32 s17, s17, 4096
  buffer_store_dwordx4 v[32:35], v1, s[4:7], s17 offen offset:0
redln2_exit1:
  s_endpgm
.globl qkvb_kernel
.p2align 8
.type qkvb_kernel,@function
qkvb_kernel:
  s_cmp_ge_u32 s2, 256
  s_cbranch_scc1 qkvb_exit1
  s_load_dwordx2 s[12:13], s[0:1], 96
  v_lshrrev_b32 v2, 6, v0
  v_and_b32 v3, 63, v0
  s_nop 0
  v_readfirstlane_b32 s16, v2
  v_lshlrev_b32 v8, 4, v3
  s_and_b32 s17, s2, 7
  s_lshr_b32 s18, s2, 3
  s_waitcnt lgkmcnt(0)
  s_mov_b32 s4, s12
  s_mov_b32 s5, s13
  s_mov_b32 s6, 0x10000000
  s_mov_b32 s7, 0x20000
  s_mul_i32 s21, s18, 81920
  s_mul_i32 s22, s16, 20480
  s_add_u32 s21, s21, s22
  s_add_u32 s21, s21, 199229440
  s_add_u32 m0, s22, 0
  s_nop 0
  buffer_load_dwordx4 v8, s[4:7], s21 offen offset:0 lds
  buffer_load_dwordx4 v8, s[4:7], s21 offen offset:1024 lds
  buffer_load_dwordx4 v8, s[4:7], s21 offen offset:2048 lds
  buffer_load_dwordx4 v8, s[4:7], s21 offen offset:3072 lds
  s_add_u32 s21, s21, 4096
  s_add_u32 m0, s22, 4096
  s_nop 0
  buffer_load_dwordx4 v8, s[4:7], s21 offen offset:0 lds
  buffer_load_dwordx4 v8, s[4:7], s21 offen offset:1024 lds
  buffer_load_dwordx4 v8, s[4:7], s21 offen offset:2048 lds
  buffer_load_dwordx4 v8, s[4:7], s21 offen offset:3072 lds
  s_add_u32 s21, s21, 4096
  s_add_u32 m0, s22, 8192
  s_nop 0
  buffer_load_dwordx4 v8, s[4:7], s21 offen offset:0 lds
  buffer_load_dwordx4 v8, s[4:7], s21 offen offset:1024 lds
  buffer_load_dwordx4 v8, s[4:7], s21 offen offset:2048 lds
  buffer_load_dwordx4 v8, s[4:7], s21 offen offset:3072 lds
  s_add_u32 s21, s21, 4096
  s_add_u32 m0, s22, 12288
  s_nop 0
  buffer_load_dwordx4 v8, s[4:7], s21 offen offset:0 lds
  buffer_load_dwordx4 v8, s[4:7], s21 offen offset:1024 lds
  buffer_load_dwordx4 v8, s[4:7], s21 offen offset:2048 lds
  buffer_load_dwordx4 v8, s[4:7], s21 offen offset:3072 lds
  s_add_u32 s21, s21, 4096
  s_add_u32 m0, s22, 16384
  s_nop 0
  buffer_load_dwordx4 v8, s[4:7], s21 offen offset:0 lds
  buffer_load_dwordx4 v8, s[4:7], s21 offen offset:1024 lds
  buffer_load_dwordx4 v8, s[4:7], s21 offen offset:2048 lds
  buffer_load_dwordx4 v8, s[4:7], s21 offen offset:3072 lds
  s_add_u32 s21, s21, 4096
  s_lshl_b32 s23, s17, 2
  s_add_u32 s23, s23, s16
  s_mul_i32 s24, s23, 40960
  s_add_u32 s24, s24, 156237824
  s_add_u32 s25, s24, 1310720
  s_add_u32 s26, s25, 1310720
  buffer_load_dwordx4 a[0:3], v8, s[4:7], s24 offen offset:0
  buffer_load_dwordx4 a[4:7], v8, s[4:7], s25 offen offset:0
  buffer_load_dwordx4 a[8:11], v8, s[4:7], s26 offen offset:0
  buffer_load_dwordx4 a[12:15], v8, s[4:7], s24 offen offset:1024
  buffer_load_dwordx4 a[16:19], v8, s[4:7], s25 offen offset:1024
  buffer_load_dwordx4 a[20:23], v8, s[4:7], s26 offen offset:1024
  buffer_load_dwordx4 a[24:27], v8, s[4:7], s24 offen offset:2048
  buffer_load_dwordx4 a[28:31], v8, s[4:7], s25 offen offset:2048
  buffer_load_dwordx4 a[32:35], v8, s[4:7], s26 offen offset:2048
  buffer_load_dwordx4 a[36:39], v8, s[4:7], s24 offen offset:3072
  buffer_load_dwordx4 a[40:43], v8, s[4:7], s25 offen offset:3072
  buffer_load_dwordx4 a[44:47], v8, s[4:7], s26 offen offset:3072
  s_add_u32 s24, s24, 4096
  s_add_u32 s25, s25, 4096
  s_add_u32 s26, s26, 4096
  buffer_load_dwordx4 a[48:51], v8, s[4:7], s24 offen offset:0
  buffer_load_dwordx4 a[52:55], v8, s[4:7], s25 offen offset:0
  buffer_load_dwordx4 a[56:59], v8, s[4:7], s26 offen offset:0
  buffer_load_dwordx4 a[60:63], v8, s[4:7], s24 offen offset:1024
  buffer_load_dwordx4 a[64:67], v8, s[4:7], s25 offen offset:1024
  buffer_load_dwordx4 a[68:71], v8, s[4:7], s26 offen offset:1024
  buffer_load_dwordx4 a[72:75], v8, s[4:7], s24 offen offset:2048
  buffer_load_dwordx4 a[76:79], v8, s[4:7], s25 offen offset:2048
  buffer_load_dwordx4 a[80:83], v8, s[4:7], s26 offen offset:2048
  buffer_load_dwordx4 a[84:87], v8, s[4:7], s24 offen offset:3072
  buffer_load_dwordx4 a[88:91], v8, s[4:7], s25 offen offset:3072
  buffer_load_dwordx4 a[92:95], v8, s[4:7], s26 offen offset:3072
  s_add_u32 s24, s24, 4096
  s_add_u32 s25, s25, 4096
  s_add_u32 s26, s26, 4096
  buffer_load_dwordx4 a[96:99], v8, s[4:7], s24 offen offset:0
  buffer_load_dwordx4 a[100:103], v8, s[4:7], s25 offen offset:0
  buffer_load_dwordx4 a[104:107], v8, s[4:7], s26 offen offset:0
  buffer_load_dwordx4 a[108:111], v8, s[4:7], s24 offen offset:1024
  buffer_load_dwordx4 a[112:115], v8, s[4:7], s25 offen offset:1024
  buffer_load_dwordx4 a[116:119], v8, s[4:7], s26 offen offset:1024
  buffer_load_dwordx4 a[120:123], v8, s[4:7], s24 offen offset:2048
  buffer_load_dwordx4 a[124:127], v8, s[4:7], s25 offen offset:2048
  buffer_load_dwordx4 a[128:131], v8, s[4:7], s26 offen offset:2048
  buffer_load_dwordx4 a[132:135], v8, s[4:7], s24 offen offset:3072
  buffer_load_dwordx4 a[136:139], v8, s[4:7], s25 offen offset:3072
  buffer_load_dwordx4 a[140:143], v8, s[4:7], s26 offen offset:3072
  s_add_u32 s24, s24, 4096
  s_add_u32 s25, s25, 4096
  s_add_u32 s26, s26, 4096
  buffer_load_dwordx4 a[144:147], v8, s[4:7], s24 offen offset:0
  buffer_load_dwordx4 a[148:151], v8, s[4:7], s25 offen offset:0
  buffer_load_dwordx4 a[152:155], v8, s[4:7], s26 offen offset:0
  s_waitcnt vmcnt(39)
  v_add_u32 v9, 40960, v8
  s_barrier
  ds_read_b128 v[16:19], v8 offset:0
  ds_read_b128 v[20:23], v9 offset:0
  ds_read_b128 v[24:27], v8 offset:1024
  ds_read_b128 v[28:31], v9 offset:1024
  buffer_load_dwordx4 a[156:159], v8, s[4:7], s24 offen offset:1024
  buffer_load_dwordx4 a[160:163], v8, s[4:7], s25 offen offset:1024
  buffer_load_dwordx4 a[164:167], v8, s[4:7], s26 offen offset:1024
  s_waitcnt vmcnt(39)
  ds_read_b128 v[32:35], v8 offset:2048
  ds_read_b128 v[36:39], v9 offset:2048
  s_waitcnt lgkmcnt(4)
  v_mfma_f32_32x32x16_bf16 v[96:111], a[0:3], v[16:19], 0
  v_mfma_f32_32x32x16_bf16 v[112:127], a[0:3], v[20:23], 0
  v_mfma_f32_32x32x16_bf16 v[128:143], a[4:7], v[16:19], 0
  v_mfma_f32_32x32x16_bf16 v[144:159], a[4:7], v[20:23], 0
  v_mfma_f32_32x32x16_bf16 v[160:175], v[16:19], a[8:11], 0
  v_mfma_f32_32x32x16_bf16 v[176:191], v[20:23], a[8:11], 0
  buffer_load_dwordx4 a[168:171], v8, s[4:7], s24 offen offset:2048
  buffer_load_dwordx4 a[172:175], v8, s[4:7], s25 offen offset:2048
  buffer_load_dwordx4 a[176:179], v8, s[4:7], s26 offen offset:2048
  s_waitcnt vmcnt(39)
  ds_read_b128 v[16:19], v8 offset:3072
  ds_read_b128 v[20:23], v9 offset:3072
  s_waitcnt lgkmcnt(4)
  v_mfma_f32_32x32x16_bf16 v[96:111], a[12:15], v[24:27], v[96:111]
  v_mfma_f32_32x32x16_bf16 v[112:127], a[12:15], v[28:31], v[112:127]
  v_mfma_f32_32x32x16_bf16 v[128:143], a[16:19], v[24:27], v[128:143]
  v_mfma_f32_32x32x16_bf16 v[144:159], a[16:19], v[28:31], v[144:159]
  v_mfma_f32_32x32x16_bf16 v[160:175], v[24:27], a[20:23], v[160:175]
  v_mfma_f32_32x32x16_bf16 v[176:191], v[28:31], a[20:23], v[176:191]
  buffer_load_dwordx4 a[180:183], v8, s[4:7], s24 offen offset:3072
  buffer_load_dwordx4 a[184:187], v8, s[4:7], s25 offen offset:3072
  buffer_load_dwordx4 a[188:191], v8, s[4:7], s26 offen offset:3072
  s_add_u32 s24, s24, 4096
  s_add_u32 s25, s25, 4096
  s_add_u32 s26, s26, 4096
  s_waitcnt vmcnt(39)
  ds_read_b128 v[24:27], v8 offset:4096
  ds_read_b128 v[28:31], v9 offset:4096
  s_waitcnt lgkmcnt(4)
  v_mfma_f32_32x32x16_bf16 v[96:111], a[24:27], v[32:35], v[96:111]
  v_mfma_f32_32x32x16_bf16 v[112:127], a[24:27], v[36:39], v[112:127]
  v_mfma_f32_32x32x16_bf16 v[128:143], a[28:31], v[32:35], v[128:143]
  v_mfma_f32_32x32x16_bf16 v[144:159], a[28:31], v[36:39], v[144:159]
  v_mfma_f32_32x32x16_bf16 v[160:175], v[32:35], a[32:35], v[160:175]
  v_mfma_f32_32x32x16_bf16 v[176:191], v[36:39], a[32:35], v[176:191]
  buffer_load_dwordx4 a[0:3], v8, s[4:7], s24 offen offset:0
  buffer_load_dwordx4 a[4:7], v8, s[4:7], s25 offen offset:0
  buffer_load_dwordx4 a[8:11], v8, s[4:7], s26 offen offset:0
  s_waitcnt vmcnt(39)
  ds_read_b128 v[32:35], v8 offset:5120
  ds_read_b128 v[36:39], v9 offset:5120
  s_waitcnt lgkmcnt(4)
  v_mfma_f32_32x32x16_bf16 v[96:111], a[36:39], v[16:19], v[96:111]
  v_mfma_f32_32x32x16_bf16 v[112:127], a[36:39], v[20:23], v[112:127]
  v_mfma_f32_32x32x16_bf16 v[128:143], a[40:43], v[16:19], v[128:143]
  v_mfma_f32_32x32x16_bf16 v[144:159], a[40:43], v[20:23], v[144:159]
  v_mfma_f32_32x32x16_bf16 v[160:175], v[16:19], a[44:47], v[160:175]
  v_mfma_f32_32x32x16_bf16 v[176:191], v[20:23], a[44:47], v[176:191]
  buffer_load_dwordx4 a[12:15], v8, s[4:7], s24 offen offset:1024
  buffer_load_dwordx4 a[16:19], v8, s[4:7], s25 offen offset:1024
  buffer_load_dwordx4 a[20:23], v8, s[4:7], s26 offen offset:1024
  s_waitcnt vmcnt(39)
  ds_read_b128 v[16:19], v8 offset:6144
  ds_read_b128 v[20:23], v9 offset:6144
  s_waitcnt lgkmcnt(4)
  v_mfma_f32_32x32x16_bf16 v[96:111], a[48:51], v[24:27], v[96:111]
  v_mfma_f32_32x32x16_bf16 v[112:127], a[48:51], v[28:31], v[112:127]
  v_mfma_f32_32x32x16_bf16 v[128:143], a[52:55], v[24:27], v[128:143]
  v_mfma_f32_32x32x16_bf16 v[144:159], a[52:55], v[28:31], v[144:159]
  v_mfma_f32_32x32x16_bf16 v[160:175], v[24:27], a[56:59], v[160:175]
  v_mfma_f32_32x32x16_bf16 v[176:191], v[28:31], a[56:59], v[176:191]
  buffer_load_dwordx4 a[24:27], v8, s[4:7], s24 offen offset:2048
  buffer_load_dwordx4 a[28:31], v8, s[4:7], s25 offen offset:2048
  buffer_load_dwordx4 a[32:35], v8, s[4:7], s26 offen offset:2048
  s_waitcnt vmcnt(39)
  ds_read_b128 v[24:27], v8 offset:7168
  ds_read_b128 v[28:31], v9 offset:7168
  s_waitcnt lgkmcnt(4)
  v_mfma_f32_32x32x16_bf16 v[96:111], a[60:63], v[32:35], v[96:111]
  v_mfma_f32_32x32x16_bf16 v[112:127], a[60:63], v[36:39], v[112:127]
  v_mfma_f32_32x32x16_bf16 v[128:143], a[64:67], v[32:35], v[128:143]
  v_mfma_f32_32x32x16_bf16 v[144:159], a[64:67], v[36:39], v[144:159]
  v_mfma_f32_32x32x16_bf16 v[160:175], v[32:35], a[68:71], v[160:175]
  v_mfma_f32_32x32x16_bf16 v[176:191], v[36:39], a[68:71], v[176:191]
  buffer_load_dwordx4 a[36:39], v8, s[4:7], s24 offen offset:3072
  buffer_load_dwordx4 a[40:43], v8, s[4:7], s25 offen offset:3072
  buffer_load_dwordx4 a[44:47], v8, s[4:7], s26 offen offset:3072
  s_add_u32 s24, s24, 4096
  s_add_u32 s25, s25, 4096
  s_add_u32 s26, s26, 4096
  s_waitcnt vmcnt(39)
  ds_read_b128 v[32:35], v8 offset:8192
  ds_read_b128 v[36:39], v9 offset:8192
  s_waitcnt lgkmcnt(4)
  v_mfma_f32_32x32x16_bf16 v[96:111], a[72:75], v[16:19], v[96:111]
  v_mfma_f32_32x32x16_bf16 v[112:127], a[72:75], v[20:23], v[112:127]
  v_mfma_f32_32x32x16_bf16 v[128:143], a[76:79], v[16:19], v[128:143]
  v_mfma_f32_32x32x16_bf16 v[144:159], a[76:79], v[20:23], v[144:159]
  v_mfma_f32_32x32x16_bf16 v[160:175], v[16:19], a[80:83], v[160:175]
  v_mfma_f32_32x32x16_bf16 v[176:191], v[20:23], a[80:83], v[176:191]
  buffer_load_dwordx4 a[48:51], v8, s[4:7], s24 offen offset:0
  buffer_load_dwordx4 a[52:55], v8, s[4:7], s25 offen offset:0
  buffer_load_dwordx4 a[56:59], v8, s[4:7], s26 offen offset:0
  s_waitcnt vmcnt(39)
  ds_read_b128 v[16:19], v8 offset:9216
  ds_read_b128 v[20:23], v9 offset:9216
  s_waitcnt lgkmcnt(4)
  v_mfma_f32_32x32x16_bf16 v[96:111], a[84:87], v[24:27], v[96:111]
  v_mfma_f32_32x32x16_bf16 v[112:127], a[84:87], v[28:31], v[112:127]
  v_mfma_f32_32x32x16_bf16 v[128:143], a[88:91], v[24:27], v[128:143]
  v_mfma_f32_32x32x16_bf16 v[144:159], a[88:91], v[28:31], v[144:159]
  v_mfma_f32_32x32x16_bf16 v[160:175], v[24:27], a[92:95], v[160:175]
  v_mfma_f32_32x32x16_bf16 v[176:191], v[28:31], a[92:95], v[176:191]
  buffer_load_dwordx4 a[60:63], v8, s[4:7], s24 offen offset:1024
  buffer_load_dwordx4 a[64:67], v8, s[4:7], s25 offen offset:1024
  buffer_load_dwordx4 a[68:71], v8, s[4:7], s26 offen offset:1024
  s_waitcnt vmcnt(39)
  ds_read_b128 v[24:27], v8 offset:10240
  ds_read_b128 v[28:31], v9 offset:10240
  s_waitcnt lgkmcnt(4)
  v_mfma_f32_32x32x16_bf16 v[96:111], a[96:99], v[32:35], v[96:111]
  v_mfma_f32_32x32x16_bf16 v[112:127], a[96:99], v[36:39], v[112:127]
  v_mfma_f32_32x32x16_bf16 v[128:143], a[100:103], v[32:35], v[128:143]
  v_mfma_f32_32x32x16_bf16 v[144:159], a[100:103], v[36:39], v[144:159]
  v_mfma_f32_32x32x16_bf16 v[160:175], v[32:35], a[104:107], v[160:175]
  v_mfma_f32_32x32x16_bf16 v[176:191], v[36:39], a[104:107], v[176:191]
  buffer_load_dwordx4 a[72:75], v8, s[4:7], s24 offen offset:2048
  buffer_load_dwordx4 a[76:79], v8, s[4:7], s25 offen offset:2048
  buffer_load_dwordx4 a[80:83], v8, s[4:7], s26 offen offset:2048
  s_waitcnt vmcnt(39)
  ds_read_b128 v[32:35], v8 offset:11264
  ds_read_b128 v[36:39], v9 offset:11264
  s_waitcnt lgkmcnt(4)
  v_mfma_f32_32x32x16_bf16 v[96:111], a[108:111], v[16:19], v[96:111]
  v_mfma_f32_32x32x16_bf16 v[112:127], a[108:111], v[20:23], v[112:127]
  v_mfma_f32_32x32x16_bf16 v[128:143], a[112:115], v[16:19], v[128:143]
  v_mfma_f32_32x32x16_bf16 v[144:159], a[112:115], v[20:23], v[144:159]
  v_mfma_f32_32x32x16_bf16 v[160:175], v[16:19], a[116:119], v[160:175]
  v_mfma_f32_32x32x16_bf16 v[176:191], v[20:23], a[116:119], v[176:191]
  buffer_load_dwordx4 a[84:87], v8, s[4:7], s24 offen offset:3072
  buffer_load_dwordx4 a[88:91], v8, s[4:7], s25 offen offset:3072
  buffer_load_dwordx4 a[92:95], v8, s[4:7], s26 offen offset:3072
  s_add_u32 s24, s24, 4096
  s_add_u32 s25, s25, 4096
  s_add_u32 s26, s26, 4096
  s_waitcnt vmcnt(39)
  ds_read_b128 v[16:19], v8 offset:12288
  ds_read_b128 v[20:23], v9 offset:12288
  s_waitcnt lgkmcnt(4)
  v_mfma_f32_32x32x16_bf16 v[96:111], a[120:123], v[24:27], v[96:111]
  v_mfma_f32_32x32x16_bf16 v[112:127], a[120:123], v[28:31], v[112:127]
  v_mfma_f32_32x32x16_bf16 v[128:143], a[124:127], v[24:27], v[128:143]
  v_mfma_f32_32x32x16_bf16 v[144:159], a[124:127], v[28:31], v[144:159]
  v_mfma_f32_32x32x16_bf16 v[160:175], v[24:27], a[128:131], v[160:175]
  v_mfma_f32_32x32x16_bf16 v[176:191], v[28:31], a[128:131], v[176:191]
  buffer_load_dwordx4 a[96:99], v8, s[4:7], s24 offen offset:0
  buffer_load_dwordx4 a[100:103], v8, s[4:7], s25 offen offset:0
  buffer_load_dwordx4 a[104:107], v8, s[4:7], s26 offen offset:0
  s_waitcnt vmcnt(39)
  ds_read_b128 v[24:27], v8 offset:13312
  ds_read_b128 v[28:31], v9 offset:13312
  s_waitcnt lgkmcnt(4)
  v_mfma_f32_32x32x16_bf16 v[96:111], a[132:135], v[32:35], v[96:111]
  v_mfma_f32_32x32x16_bf16 v[112:127], a[132:135], v[36:39], v[112:127]
  v_mfma_f32_32x32x16_bf16 v[128:143], a[136:139], v[32:35], v[128:143]
  v_mfma_f32_32x32x16_bf16 v[144:159], a[136:139], v[36:39], v[144:159]
  v_mfma_f32_32x32x16_bf16 v[160:175], v[32:35], a[140:143], v[160:175]
  v_mfma_f32_32x32x16_bf16 v[176:191], v[36:39], a[140:143], v[176:191]
  buffer_load_dwordx4 a[108:111], v8, s[4:7], s24 offen offset:1024
  buffer_load_dwordx4 a[112:115], v8, s[4:7], s25 offen offset:1024
  buffer_load_dwordx4 a[116:119], v8, s[4:7], s26 offen offset:1024
  s_waitcnt vmcnt(39)
  ds_read_b128 v[32:35], v8 offset:14336
  ds_read_b128 v[36:39], v9 offset:14336
  s_waitcnt lgkmcnt(4)
  v_mfma_f32_32x32x16_bf16 v[96:111], a[144:147], v[16:19], v[96:111]
  v_mfma_f32_32x32x16_bf16 v[112:127], a[144:147], v[20:23], v[112:127]
  v_mfma_f32_32x32x16_bf16 v[128:143], a[148:151], v[16:19], v[128:143]
  v_mfma_f32_32x32x16_bf16 v[144:159], a[148:151], v[20:23], v[144:159]
  v_mfma_f32_32x32x16_bf16 v[160:175], v[16:19], a[152:155], v[160:175]
  v_mfma_f32_32x32x16_bf16 v[176:191], v[20:23], a[152:155], v[176:191]
  buffer_load_dwordx4 a[120:123], v8, s[4:7], s24 offen offset:2048
  buffer_load_dwordx4 a[124:127], v8, s[4:7], s25 offen offset:2048
  buffer_load_dwordx4 a[128:131], v8, s[4:7], s26 offen offset:2048
  s_waitcnt vmcnt(39)
  ds_read_b128 v[16:19], v8 offset:15360
  ds_read_b128 v[20:23], v9 offset:15360
  s_waitcnt lgkmcnt(4)
  v_mfma_f32_32x32x16_bf16 v[96:111], a[156:159], v[24:27], v[96:111]
  v_mfma_f32_32x32x16_bf16 v[112:127], a[156:159], v[28:31], v[112:127]
  v_mfma_f32_32x32x16_bf16 v[128:143], a[160:163], v[24:27], v[128:143]
  v_mfma_f32_32x32x16_bf16 v[144:159], a[160:163], v[28:31], v[144:159]
  v_mfma_f32_32x32x16_bf16 v[160:175], v[24:27], a[164:167], v[160:175]
  v_mfma_f32_32x32x16_bf16 v[176:191], v[28:31], a[164:167], v[176:191]
  buffer_load_dwordx4 a[132:135], v8, s[4:7], s24 offen offset:3072
  buffer_load_dwordx4 a[136:139], v8, s[4:7], s25 offen offset:3072
  buffer_load_dwordx4 a[140:143], v8, s[4:7], s26 offen offset:3072
  s_add_u32 s24, s24, 4096
  s_add_u32 s25, s25, 4096
  s_add_u32 s26, s26, 4096
  s_waitcnt vmcnt(39)
  ds_read_b128 v[24:27], v8 offset:16384
  ds_read_b128 v[28:31], v9 offset:16384
  s_waitcnt lgkmcnt(4)
  v_mfma_f32_32x32x16_bf16 v[96:111], a[168:171], v[32:35], v[96:111]
  v_mfma_f32_32x32x16_bf16 v[112:127], a[168:171], v[36:39], v[112:127]
  v_mfma_f32_32x32x16_bf16 v[128:143], a[172:175], v[32:35], v[128:143]
  v_mfma_f32_32x32x16_bf16 v[144:159], a[172:175], v[36:39], v[144:159]
  v_mfma_f32_32x32x16_bf16 v[160:175], v[32:35], a[176:179], v[160:175]
  v_mfma_f32_32x32x16_bf16 v[176:191], v[36:39], a[176:179], v[176:191]
  buffer_load_dwordx4 a[144:147], v8, s[4:7], s24 offen offset:0
  buffer_load_dwordx4 a[148:151], v8, s[4:7], s25 offen offset:0
  buffer_load_dwordx4 a[152:155], v8, s[4:7], s26 offen offset:0
  s_waitcnt vmcnt(39)
  ds_read_b128 v[32:35], v8 offset:17408
  ds_read_b128 v[36:39], v9 offset:17408
  s_waitcnt lgkmcnt(4)
  v_mfma_f32_32x32x16_bf16 v[96:111], a[180:183], v[16:19], v[96:111]
  v_mfma_f32_32x32x16_bf16 v[112:127], a[180:183], v[20:23], v[112:127]
  v_mfma_f32_32x32x16_bf16 v[128:143], a[184:187], v[16:19], v[128:143]
  v_mfma_f32_32x32x16_bf16 v[144:159], a[184:187], v[20:23], v[144:159]
  v_mfma_f32_32x32x16_bf16 v[160:175], v[16:19], a[188:191], v[160:175]
  v_mfma_f32_32x32x16_bf16 v[176:191], v[20:23], a[188:191], v[176:191]
  buffer_load_dwordx4 a[156:159], v8, s[4:7], s24 offen offset:1024
  buffer_load_dwordx4 a[160:163], v8, s[4:7], s25 offen offset:1024
  buffer_load_dwordx4 a[164:167], v8, s[4:7], s26 offen offset:1024
  s_waitcnt vmcnt(39)
  ds_read_b128 v[16:19], v8 offset:18432
  ds_read_b128 v[20:23], v9 offset:18432
  s_waitcnt lgkmcnt(4)
  v_mfma_f32_32x32x16_bf16 v[96:111], a[0:3], v[24:27], v[96:111]
  v_mfma_f32_32x32x16_bf16 v[112:127], a[0:3], v[28:31], v[112:127]
  v_mfma_f32_32x32x16_bf16 v[128:143], a[4:7], v[24:27], v[128:143]
  v_mfma_f32_32x32x16_bf16 v[144:159], a[4:7], v[28:31], v[144:159]
  v_mfma_f32_32x32x16_bf16 v[160:175], v[24:27], a[8:11], v[160:175]
  v_mfma_f32_32x32x16_bf16 v[176:191], v[28:31], a[8:11], v[176:191]
  buffer_load_dwordx4 a[168:171], v8, s[4:7], s24 offen offset:2048
  buffer_load_dwordx4 a[172:175], v8, s[4:7], s25 offen offset:2048
  buffer_load_dwordx4 a[176:179], v8, s[4:7], s26 offen offset:2048
  s_waitcnt vmcnt(39)
  ds_read_b128 v[24:27], v8 offset:19456
  ds_read_b128 v[28:31], v9 offset:19456
  s_waitcnt lgkmcnt(4)
  v_mfma_f32_32x32x16_bf16 v[96:111], a[12:15], v[32:35], v[96:111]
  v_mfma_f32_32x32x16_bf16 v[112:127], a[12:15], v[36:39], v[112:127]
  v_mfma_f32_32x32x16_bf16 v[128:143], a[16:19], v[32:35], v[128:143]
  v_mfma_f32_32x32x16_bf16 v[144:159], a[16:19], v[36:39], v[144:159]
  v_mfma_f32_32x32x16_bf16 v[160:175], v[32:35], a[20:23], v[160:175]
  v_mfma_f32_32x32x16_bf16 v[176:191], v[36:39], a[20:23], v[176:191]
  buffer_load_dwordx4 a[180:183], v8, s[4:7], s24 offen offset:3072
  buffer_load_dwordx4 a[184:187], v8, s[4:7], s25 offen offset:3072
  buffer_load_dwordx4 a[188:191], v8, s[4:7], s26 offen offset:3072
  s_add_u32 s24, s24, 4096
  s_add_u32 s25, s25, 4096
  s_add_u32 s26, s26, 4096
  s_waitcnt vmcnt(39)
  ds_read_b128 v[32:35], v8 offset:20480
  ds_read_b128 v[36:39], v9 offset:20480
  s_waitcnt lgkmcnt(4)
  v_mfma_f32_32x32x16_bf16 v[96:111], a[24:27], v[16:19], v[96:111]
  v_mfma_f32_32x32x16_bf16 v[112:127], a[24:27], v[20:23], v[112:127]
  v_mfma_f32_32x32x16_bf16 v[128:143], a[28:31], v[16:19], v[128:143]
  v_mfma_f32_32x32x16_bf16 v[144:159], a[28:31], v[20:23], v[144:159]
  v_mfma_f32_32x32x16_bf16 v[160:175], v[16:19], a[32:35], v[160:175]
  v_mfma_f32_32x32x16_bf16 v[176:191], v[20:23], a[32:35], v[176:191]
  buffer_load_dwordx4 a[0:3], v8, s[4:7], s24 offen offset:0
  buffer_load_dwordx4 a[4:7], v8, s[4:7], s25 offen offset:0
  buffer_load_dwordx4 a[8:11], v8, s[4:7], s26 offen offset:0
  s_waitcnt vmcnt(39)
  ds_read_b128 v[16:19], v8 offset:21504
  ds_read_b128 v[20:23], v9 offset:21504
  s_waitcnt lgkmcnt(4)
  v_mfma_f32_32x32x16_bf16 v[96:111], a[36:39], v[24:27], v[96:111]
  v_mfma_f32_32x32x16_bf16 v[112:127], a[36:39], v[28:31], v[112:127]
  v_mfma_f32_32x32x16_bf16 v[128:143], a[40:43], v[24:27], v[128:143]
  v_mfma_f32_32x32x16_bf16 v[144:159], a[40:43], v[28:31], v[144:159]
  v_mfma_f32_32x32x16_bf16 v[160:175], v[24:27], a[44:47], v[160:175]
  v_mfma_f32_32x32x16_bf16 v[176:191], v[28:31], a[44:47], v[176:191]
  buffer_load_dwordx4 a[12:15], v8, s[4:7], s24 offen offset:1024
  buffer_load_dwordx4 a[16:19], v8, s[4:7], s25 offen offset:1024
  buffer_load_dwordx4 a[20:23], v8, s[4:7], s26 offen offset:1024
  s_waitcnt vmcnt(39)
  ds_read_b128 v[24:27], v8 offset:22528
  ds_read_b128 v[28:31], v9 offset:22528
  s_waitcnt lgkmcnt(4)
  v_mfma_f32_32x32x16_bf16 v[96:111], a[48:51], v[32:35], v[96:111]
  v_mfma_f32_32x32x16_bf16 v[112:127], a[48:51], v[36:39], v[112:127]
  v_mfma_f32_32x32x16_bf16 v[128:143], a[52:55], v[32:35], v[128:143]
  v_mfma_f32_32x32x16_bf16 v[144:159], a[52:55], v[36:39], v[144:159]
  v_mfma_f32_32x32x16_bf16 v[160:175], v[32:35], a[56:59], v[160:175]
  v_mfma_f32_32x32x16_bf16 v[176:191], v[36:39], a[56:59], v[176:191]
  buffer_load_dwordx4 a[24:27], v8, s[4:7], s24 offen offset:2048
  buffer_load_dwordx4 a[28:31], v8, s[4:7], s25 offen offset:2048
  buffer_load_dwordx4 a[32:35], v8, s[4:7], s26 offen offset:2048
  s_waitcnt vmcnt(39)
  ds_read_b128 v[32:35], v8 offset:23552
  ds_read_b128 v[36:39], v9 offset:23552
  s_waitcnt lgkmcnt(4)
  v_mfma_f32_32x32x16_bf16 v[96:111], a[60:63], v[16:19], v[96:111]
  v_mfma_f32_32x32x16_bf16 v[112:127], a[60:63], v[20:23], v[112:127]
  v_mfma_f32_32x32x16_bf16 v[128:143], a[64:67], v[16:19], v[128:143]
  v_mfma_f32_32x32x16_bf16 v[144:159], a[64:67], v[20:23], v[144:159]
  v_mfma_f32_32x32x16_bf16 v[160:175], v[16:19], a[68:71], v[160:175]
  v_mfma_f32_32x32x16_bf16 v[176:191], v[20:23], a[68:71], v[176:191]
  buffer_load_dwordx4 a[36:39], v8, s[4:7], s24 offen offset:3072
  buffer_load_dwordx4 a[40:43], v8, s[4:7], s25 offen offset:3072
  buffer_load_dwordx4 a[44:47], v8, s[4:7], s26 offen offset:3072
  s_add_u32 s24, s24, 4096
  s_add_u32 s25, s25, 4096
  s_add_u32 s26, s26, 4096
  s_waitcnt vmcnt(39)
  ds_read_b128 v[16:19], v8 offset:24576
  ds_read_b128 v[20:23], v9 offset:24576
  s_waitcnt lgkmcnt(4)
  v_mfma_f32_32x32x16_bf16 v[96:111], a[72:75], v[24:27], v[96:111]
  v_mfma_f32_32x32x16_bf16 v[112:127], a[72:75], v[28:31], v[112:127]
  v_mfma_f32_32x32x16_bf16 v[128:143], a[76:79], v[24:27], v[128:143]
  v_mfma_f32_32x32x16_bf16 v[144:159], a[76:79], v[28:31], v[144:159]
  v_mfma_f32_32x32x16_bf16 v[160:175], v[24:27], a[80:83], v[160:175]
  v_mfma_f32_32x32x16_bf16 v[176:191], v[28:31], a[80:83], v[176:191]
  buffer_load_dwordx4 a[48:51], v8, s[4:7], s24 offen offset:0
  buffer_load_dwordx4 a[52:55], v8, s[4:7], s25 offen offset:0
  buffer_load_dwordx4 a[56:59], v8, s[4:7], s26 offen offset:0
  s_waitcnt vmcnt(39)
  ds_read_b128 v[24:27], v8 offset:25600
  ds_read_b128 v[28:31], v9 offset:25600
  s_waitcnt lgkmcnt(4)
  v_mfma_f32_32x32x16_bf16 v[96:111], a[84:87], v[32:35], v[96:111]
  v_mfma_f32_32x32x16_bf16 v[112:127], a[84:87], v[36:39], v[112:127]
  v_mfma_f32_32x32x16_bf16 v[128:143], a[88:91], v[32:35], v[128:143]
  v_mfma_f32_32x32x16_bf16 v[144:159], a[88:91], v[36:39], v[144:159]
  v_mfma_f32_32x32x16_bf16 v[160:175], v[32:35], a[92:95], v[160:175]
  v_mfma_f32_32x32x16_bf16 v[176:191], v[36:39], a[92:95], v[176:191]
  buffer_load_dwordx4 a[60:63], v8, s[4:7], s24 offen offset:1024
  buffer_load_dwordx4 a[64:67], v8, s[4:7], s25 offen offset:1024
  buffer_load_dwordx4 a[68:71], v8, s[4:7], s26 offen offset:1024
  s_waitcnt vmcnt(39)
  ds_read_b128 v[32:35], v8 offset:26624
  ds_read_b128 v[36:39], v9 offset:26624
  s_waitcnt lgkmcnt(4)
  v_mfma_f32_32x32x16_bf16 v[96:111], a[96:99], v[16:19], v[96:111]
  v_mfma_f32_32x32x16_bf16 v[112:127], a[96:99], v[20:23], v[112:127]
  v_mfma_f32_32x32x16_bf16 v[128:143], a[100:103], v[16:19], v[128:143]
  v_mfma_f32_32x32x16_bf16 v[144:159], a[100:103], v[20:23], v[144:159]
  v_mfma_f32_32x32x16_bf16 v[160:175], v[16:19], a[104:107], v[160:175]
  v_mfma_f32_32x32x16_bf16 v[176:191], v[20:23], a[104:107], v[176:191]
  buffer_load_dwordx4 a[72:75], v8, s[4:7], s24 offen offset:2048
  buffer_load_dwordx4 a[76:79], v8, s[4:7], s25 offen offset:2048
  buffer_load_dwordx4 a[80:83], v8, s[4:7], s26 offen offset:2048
  s_waitcnt vmcnt(39)
  ds_read_b128 v[16:19], v8 offset:27648
  ds_read_b128 v[20:23], v9 offset:27648
  s_waitcnt lgkmcnt(4)
  v_mfma_f32_32x32x16_bf16 v[96:111], a[108:111], v[24:27], v[96:111]
  v_mfma_f32_32x32x16_bf16 v[112:127], a[108:111], v[28:31], v[112:127]
  v_mfma_f32_32x32x16_bf16 v[128:143], a[112:115], v[24:27], v[128:143]
  v_mfma_f32_32x32x16_bf16 v[144:159], a[112:115], v[28:31], v[144:159]
  v_mfma_f32_32x32x16_bf16 v[160:175], v[24:27], a[116:119], v[160:175]
  v_mfma_f32_32x32x16_bf16 v[176:191], v[28:31], a[116:119], v[176:191]
  buffer_load_dwordx4 a[84:87], v8, s[4:7], s24 offen offset:3072
  buffer_load_dwordx4 a[88:91], v8, s[4:7], s25 offen offset:3072
  buffer_load_dwordx4 a[92:95], v8, s[4:7], s26 offen offset:3072
  s_add_u32 s24, s24, 4096
  s_add_u32 s25, s25, 4096
  s_add_u32 s26, s26, 4096
  s_waitcnt vmcnt(39)
  ds_read_b128 v[24:27], v8 offset:28672
  ds_read_b128 v[28:31], v9 offset:28672
  s_waitcnt lgkmcnt(4)
  v_mfma_f32_32x32x16_bf16 v[96:111], a[120:123], v[32:35], v[96:111]
  v_mfma_f32_32x32x16_bf16 v[112:127], a[120:123], v[36:39], v[112:127]
  v_mfma_f32_32x32x16_bf16 v[128:143], a[124:127], v[32:35], v[128:143]
  v_mfma_f32_32x32x16_bf16 v[144:159], a[124:127], v[36:39], v[144:159]
  v_mfma_f32_32x32x16_bf16 v[160:175], v[32:35], a[128:131], v[160:175]
  v_mfma_f32_32x32x16_bf16 v[176:191], v[36:39], a[128:131], v[176:191]
  s_waitcnt vmcnt(36)
  ds_read_b128 v[32:35], v8 offset:29696
  ds_read_b128 v[36:39], v9 offset:29696
  s_waitcnt lgkmcnt(4)
  v_mfma_f32_32x32x16_bf16 v[96:111], a[132:135], v[16:19], v[96:111]
  v_mfma_f32_32x32x16_bf16 v[112:127], a[132:135], v[20:23], v[112:127]
  v_mfma_f32_32x32x16_bf16 v[128:143], a[136:139], v[16:19], v[128:143]
  v_mfma_f32_32x32x16_bf16 v[144:159], a[136:139], v[20:23], v[144:159]
  v_mfma_f32_32x32x16_bf16 v[160:175], v[16:19], a[140:143], v[160:175]
  v_mfma_f32_32x32x16_bf16 v[176:191], v[20:23], a[140:143], v[176:191]
  s_waitcnt vmcnt(33)
  ds_read_b128 v[16:19], v8 offset:30720
  ds_read_b128 v[20:23], v9 offset:30720
  s_waitcnt lgkmcnt(4)
  v_mfma_f32_32x32x16_bf16 v[96:111], a[144:147], v[24:27], v[96:111]
  v_mfma_f32_32x32x16_bf16 v[112:127], a[144:147], v[28:31], v[112:127]
  v_mfma_f32_32x32x16_bf16 v[128:143], a[148:151], v[24:27], v[128:143]
  v_mfma_f32_32x32x16_bf16 v[144:159], a[148:151], v[28:31], v[144:159]
  v_mfma_f32_32x32x16_bf16 v[160:175], v[24:27], a[152:155], v[160:175]
  v_mfma_f32_32x32x16_bf16 v[176:191], v[28:31], a[152:155], v[176:191]
  s_waitcnt vmcnt(30)
  ds_read_b128 v[24:27], v8 offset:31744
  ds_read_b128 v[28:31], v9 offset:31744
  s_waitcnt lgkmcnt(4)
  v_mfma_f32_32x32x16_bf16 v[96:111], a[156:159], v[32:35], v[96:111]
  v_mfma_f32_32x32x16_bf16 v[112:127], a[156:159], v[36:39], v[112:127]
  v_mfma_f32_32x32x16_bf16 v[128:143], a[160:163], v[32:35], v[128:143]
  v_mfma_f32_32x32x16_bf16 v[144:159], a[160:163], v[36:39], v[144:159]
  v_mfma_f32_32x32x16_bf16 v[160:175], v[32:35], a[164:167], v[160:175]
  v_mfma_f32_32x32x16_bf16 v[176:191], v[36:39], a[164:167], v[176:191]
  s_waitcnt vmcnt(27)
  ds_read_b128 v[32:35], v8 offset:32768
  ds_read_b128 v[36:39], v9 offset:32768
  s_waitcnt lgkmcnt(4)
  v_mfma_f32_32x32x16_bf16 v[96:111], a[168:171], v[16:19], v[96:111]
  v_mfma_f32_32x32x16_bf16 v[112:127], a[168:171], v[20:23], v[112:127]
  v_mfma_f32_32x32x16_bf16 v[128:143], a[172:175], v[16:19], v[128:143]
  v_mfma_f32_32x32x16_bf16 v[144:159], a[172:175], v[20:23], v[144:159]
  v_mfma_f32_32x32x16_bf16 v[160:175], v[16:19], a[176:179], v[160:175]
  v_mfma_f32_32x32x16_bf16 v[176:191], v[20:23], a[176:179], v[176:191]
  s_waitcnt vmcnt(24)
  ds_read_b128 v[16:19], v8 offset:33792
  ds_read_b128 v[20:23], v9 offset:33792
  s_waitcnt lgkmcnt(4)
  v_mfma_f32_32x32x16_bf16 v[96:111], a[180:183], v[24:27], v[96:111]
  v_mfma_f32_32x32x16_bf16 v[112:127], a[180:183], v[28:31], v[112:127]
  v_mfma_f32_32x32x16_bf16 v[128:143], a[184:187], v[24:27], v[128:143]
  v_mfma_f32_32x32x16_bf16 v[144:159], a[184:187], v[28:31], v[144:159]
  v_mfma_f32_32x32x16_bf16 v[160:175], v[24:27], a[188:191], v[160:175]
  v_mfma_f32_32x32x16_bf16 v[176:191], v[28:31], a[188:191], v[176:191]
  s_waitcnt vmcnt(21)
  ds_read_b128 v[24:27], v8 offset:34816
  ds_read_b128 v[28:31], v9 offset:34816
  s_waitcnt lgkmcnt(4)
  v_mfma_f32_32x32x16_bf16 v[96:111], a[0:3], v[32:35], v[96:111]
  v_mfma_f32_32x32x16_bf16 v[112:127], a[0:3], v[36:39], v[112:127]
  v_mfma_f32_32x32x16_bf16 v[128:143], a[4:7], v[32:35], v[128:143]
  v_mfma_f32_32x32x16_bf16 v[144:159], a[4:7], v[36:39], v[144:159]
  v_mfma_f32_32x32x16_bf16 v[160:175], v[32:35], a[8:11], v[160:175]
  v_mfma_f32_32x32x16_bf16 v[176:191], v[36:39], a[8:11], v[176:191]
  s_waitcnt vmcnt(18)
  ds_read_b128 v[32:35], v8 offset:35840
  ds_read_b128 v[36:39], v9 offset:35840
  s_waitcnt lgkmcnt(4)
  v_mfma_f32_32x32x16_bf16 v[96:111], a[12:15], v[16:19], v[96:111]
  v_mfma_f32_32x32x16_bf16 v[112:127], a[12:15], v[20:23], v[112:127]
  v_mfma_f32_32x32x16_bf16 v[128:143], a[16:19], v[16:19], v[128:143]
  v_mfma_f32_32x32x16_bf16 v[144:159], a[16:19], v[20:23], v[144:159]
  v_mfma_f32_32x32x16_bf16 v[160:175], v[16:19], a[20:23], v[160:175]
  v_mfma_f32_32x32x16_bf16 v[176:191], v[20:23], a[20:23], v[176:191]
  s_waitcnt vmcnt(15)
  ds_read_b128 v[16:19], v8 offset:36864
  ds_read_b128 v[20:23], v9 offset:36864
  s_waitcnt lgkmcnt(4)
  v_mfma_f32_32x32x16_bf16 v[96:111], a[24:27], v[24:27], v[96:111]
  v_mfma_f32_32x32x16_bf16 v[112:127], a[24:27], v[28:31], v[112:127]
  v_mfma_f32_32x32x16_bf16 v[128:143], a[28:31], v[24:27], v[128:143]
  v_mfma_f32_32x32x16_bf16 v[144:159], a[28:31], v[28:31], v[144:159]
  v_mfma_f32_32x32x16_bf16 v[160:175], v[24:27], a[32:35], v[160:175]
  v_mfma_f32_32x32x16_bf16 v[176:191], v[28:31], a[32:35], v[176:191]
  s_waitcnt vmcnt(12)
  ds_read_b128 v[24:27], v8 offset:37888
  ds_read_b128 v[28:31], v9 offset:37888
  s_waitcnt lgkmcnt(4)
  v_mfma_f32_32x32x16_bf16 v[96:111], a[36:39], v[32:35], v[96:111]
  v_mfma_f32_32x32x16_bf16 v[112:127], a[36:39], v[36:39], v[112:127]
  v_mfma_f32_32x32x16_bf16 v[128:143], a[40:43], v[32:35], v[128:143]
  v_mfma_f32_32x32x16_bf16 v[144:159], a[40:43], v[36:39], v[144:159]
  v_mfma_f32_32x32x16_bf16 v[160:175], v[32:35], a[44:47], v[160:175]
  v_mfma_f32_32x32x16_bf16 v[176:191], v[36:39], a[44:47], v[176:191]
  s_waitcnt vmcnt(9)
  ds_read_b128 v[32:35], v8 offset:38912
  ds_read_b128 v[36:39], v9 offset:38912
  s_waitcnt lgkmcnt(4)
  v_mfma_f32_32x32x16_bf16 v[96:111], a[48:51], v[16:19], v[96:111]
  v_mfma_f32_32x32x16_bf16 v[112:127], a[48:51], v[20:23], v[112:127]
  v_mfma_f32_32x32x16_bf16 v[128:143], a[52:55], v[16:19], v[128:143]
  v_mfma_f32_32x32x16_bf16 v[144:159], a[52:55], v[20:23], v[144:159]
  v_mfma_f32_32x32x16_bf16 v[160:175], v[16:19], a[56:59], v[160:175]
  v_mfma_f32_32x32x16_bf16 v[176:191], v[20:23], a[56:59], v[176:191]
  s_waitcnt vmcnt(6)
  ds_read_b128 v[16:19], v8 offset:39936
  ds_read_b128 v[20:23], v9 offset:39936
  s_waitcnt lgkmcnt(4)
  v_mfma_f32_32x32x16_bf16 v[96:111], a[60:63], v[24:27], v[96:111]
  v_mfma_f32_32x32x16_bf16 v[112:127], a[60:63], v[28:31], v[112:127]
  v_mfma_f32_32x32x16_bf16 v[128:143], a[64:67], v[24:27], v[128:143]
  v_mfma_f32_32x32x16_bf16 v[144:159], a[64:67], v[28:31], v[144:159]
  v_mfma_f32_32x32x16_bf16 v[160:175], v[24:27], a[68:71], v[160:175]
  v_mfma_f32_32x32x16_bf16 v[176:191], v[28:31], a[68:71], v[176:191]
  s_waitcnt vmcnt(3)
  s_waitcnt lgkmcnt(2)
  v_mfma_f32_32x32x16_bf16 v[96:111], a[72:75], v[32:35], v[96:111]
  v_mfma_f32_32x32x16_bf16 v[112:127], a[72:75], v[36:39], v[112:127]
  v_mfma_f32_32x32x16_bf16 v[128:143], a[76:79], v[32:35], v[128:143]
  v_mfma_f32_32x32x16_bf16 v[144:159], a[76:79], v[36:39], v[144:159]
  v_mfma_f32_32x32x16_bf16 v[160:175], v[32:35], a[80:83], v[160:175]
  v_mfma_f32_32x32x16_bf16 v[176:191], v[36:39], a[80:83], v[176:191]
  s_waitcnt vmcnt(0)
  s_waitcnt lgkmcnt(0)
  v_mfma_f32_32x32x16_bf16 v[96:111], a[84:87], v[16:19], v[96:111]
  v_mfma_f32_32x32x16_bf16 v[112:127], a[84:87], v[20:23], v[112:127]
  v_mfma_f32_32x32x16_bf16 v[128:143], a[88:91], v[16:19], v[128:143]
  v_mfma_f32_32x32x16_bf16 v[144:159], a[88:91], v[20:23], v[144:159]
  v_mfma_f32_32x32x16_bf16 v[160:175], v[16:19], a[92:95], v[160:175]
  v_mfma_f32_32x32x16_bf16 v[176:191], v[20:23], a[92:95], v[176:191]
  s_lshl_b32 s21, s18, 1
  s_lshl_b32 s22, s23, 6
  s_add_u32 s21, s21, s22
  s_lshl_b32 s21, s21, 11
  s_add_u32 s27, s21, 161480704
  s_add_u32 s28, s21, 165675008
  s_add_u32 s29, s21, 169869312
  s_mov_b32 s30, 0x3ea52b5c
  v_and_b32 v2, 31, v0
  v_cmp_eq_u32 s[32:33], 20, v2
  v_mov_b32 v3, 0x3f803f80
  v_mul_f32 v96, s30, v96
  v_mul_f32 v97, s30, v97
  v_mul_f32 v98, s30, v98
  v_mul_f32 v99, s30, v99
  v_mul_f32 v100, s30, v100
  v_mul_f32 v101, s30, v101
  v_mul_f32 v102, s30, v102
  v_mul_f32 v103, s30, v103
  v_mul_f32 v104, s30, v104
  v_mul_f32 v105, s30, v105
  v_mul_f32 v106, s30, v106
  v_mul_f32 v107, s30, v107
  v_mul_f32 v108, s30, v108
  v_mul_f32 v109, s30, v109
  v_mul_f32 v110, s30, v110
  v_mul_f32 v111, s30, v111
  v_cvt_pk_bf16_f32 v16, v96, v97
  v_cvt_pk_bf16_f32 v17, v98, v99
  v_cvt_pk_bf16_f32 v18, v100, v101
  v_cvt_pk_bf16_f32 v19, v102, v103
  v_cvt_pk_bf16_f32 v20, v104, v105
  v_cvt_pk_bf16_f32 v21, v106, v107
  v_cvt_pk_bf16_f32 v22, v108, v109
  v_cvt_pk_bf16_f32 v23, v110, v111
  buffer_store_dwordx4 v[16:19], v8, s[4:7], s27 offen offset:0
  buffer_store_dwordx4 v[20:23], v8, s[4:7], s27 offen offset:1024
  v_mul_f32 v112, s30, v112
  v_mul_f32 v113, s30, v113
  v_mul_f32 v114, s30, v114
  v_mul_f32 v115, s30, v115
  v_mul_f32 v116, s30, v116
  v_mul_f32 v117, s30, v117
  v_mul_f32 v118, s30, v118
  v_mul_f32 v119, s30, v119
  v_mul_f32 v120, s30, v120
  v_mul_f32 v121, s30, v121
  v_mul_f32 v122, s30, v122
  v_mul_f32 v123, s30, v123
  v_mul_f32 v124, s30, v124
  v_mul_f32 v125, s30, v125
  v_mul_f32 v126, s30, v126
  v_mul_f32 v127, s30, v127
  v_cvt_pk_bf16_f32 v24, v112, v113
  v_cvt_pk_bf16_f32 v25, v114, v115
  v_cvt_pk_bf16_f32 v26, v116, v117
  v_cvt_pk_bf16_f32 v27, v118, v119
  v_cvt_pk_bf16_f32 v28, v120, v121
  v_cvt_pk_bf16_f32 v29, v122, v123
  v_cvt_pk_bf16_f32 v30, v124, v125
  v_cvt_pk_bf16_f32 v31, v126, v127
  buffer_store_dwordx4 v[24:27], v8, s[4:7], s27 offen offset:2048
  buffer_store_dwordx4 v[28:31], v8, s[4:7], s27 offen offset:3072
  v_cvt_pk_bf16_f32 v16, v128, v129
  v_cvt_pk_bf16_f32 v17, v130, v131
  v_cvt_pk_bf16_f32 v18, v132, v133
  v_cvt_pk_bf16_f32 v19, v134, v135
  v_cvt_pk_bf16_f32 v20, v136, v137
  v_cvt_pk_bf16_f32 v21, v138, v139
  v_cvt_pk_bf16_f32 v22, v140, v141
  v_cvt_pk_bf16_f32 v23, v142, v143
  buffer_store_dwordx4 v[16:19], v8, s[4:7], s28 offen offset:0
  buffer_store_dwordx4 v[20:23], v8, s[4:7], s28 offen offset:1024
  v_cvt_pk_bf16_f32 v24, v144, v145
  v_cvt_pk_bf16_f32 v25, v146, v147
  v_cvt_pk_bf16_f32 v26, v148, v149
  v_cvt_pk_bf16_f32 v27, v150, v151
  v_cvt_pk_bf16_f32 v28, v152, v153
  v_cvt_pk_bf16_f32 v29, v154, v155
  v_cvt_pk_bf16_f32 v30, v156, v157
  v_cvt_pk_bf16_f32 v31, v158, v159
  buffer_store_dwordx4 v[24:27], v8, s[4:7], s28 offen offset:2048
  buffer_store_dwordx4 v[28:31], v8, s[4:7], s28 offen offset:3072
  v_cvt_pk_bf16_f32 v16, v160, v161
  v_cvt_pk_bf16_f32 v17, v162, v163
  v_cvt_pk_bf16_f32 v18, v164, v165
  v_cvt_pk_bf16_f32 v19, v166, v167
  v_cvt_pk_bf16_f32 v20, v168, v169
  v_cvt_pk_bf16_f32 v21, v170, v171
  v_cvt_pk_bf16_f32 v22, v172, v173
  v_cvt_pk_bf16_f32 v23, v174, v175
  v_cndmask_b32 v16, v16, v3, s[32:33]
  v_cndmask_b32 v17, v17, v3, s[32:33]
  v_cndmask_b32 v18, v18, v3, s[32:33]
  v_cndmask_b32 v19, v19, v3, s[32:33]
  v_cndmask_b32 v20, v20, v3, s[32:33]
  v_cndmask_b32 v21, v21, v3, s[32:33]
  v_cndmask_b32 v22, v22, v3, s[32:33]
  v_cndmask_b32 v23, v23, v3, s[32:33]
  buffer_store_dwordx4 v[16:19], v8, s[4:7], s29 offen offset:0
  buffer_store_dwordx4 v[20:23], v8, s[4:7], s29 offen offset:1024
  v_cvt_pk_bf16_f32 v24, v176, v177
  v_cvt_pk_bf16_f32 v25, v178, v179
  v_cvt_pk_bf16_f32 v26, v180, v181
  v_cvt_pk_bf16_f32 v27, v182, v183
  v_cvt_pk_bf16_f32 v28, v184, v185
  v_cvt_pk_bf16_f32 v29, v186, v187
  v_cvt_pk_bf16_f32 v30, v188, v189
  v_cvt_pk_bf16_f32 v31, v190, v191
  v_cndmask_b32 v24, v24, v3, s[32:33]
  v_cndmask_b32 v25, v25, v3, s[32:33]
  v_cndmask_b32 v26, v26, v3, s[32:33]
  v_cndmask_b32 v27, v27, v3, s[32:33]
  v_cndmask_b32 v28, v28, v3, s[32:33]
  v_cndmask_b32 v29, v29, v3, s[32:33]
  v_cndmask_b32 v30, v30, v3, s[32:33]
  v_cndmask_b32 v31, v31, v3, s[32:33]
  buffer_store_dwordx4 v[24:27], v8, s[4:7], s29 offen offset:2048
  buffer_store_dwordx4 v[28:31], v8, s[4:7], s29 offen offset:3072
  s_waitcnt vmcnt(0)
qkvb_exit1:
  s_endpgm
.globl attnb_kernel
.p2align 8
.type attnb_kernel,@function
attnb_kernel:
  s_cmp_ge_u32 s2, 256
  s_cbranch_scc1 attnb_exit1
  s_load_dwordx2 s[12:13], s[0:1], 96
  v_lshrrev_b32 v2, 6, v0
  v_and_b32 v3, 63, v0
  s_nop 0
  v_readfirstlane_b32 s16, v2
  v_lshlrev_b32 v1, 4, v3
  s_and_b32 s17, s2, 7
  s_lshl_b32 s17, s17, 2
  s_lshr_b32 s18, s2, 3
  s_and_b32 s19, s18, 3
  s_add_u32 s17, s17, s19
  s_lshr_b32 s18, s18, 2
  s_waitcnt lgkmcnt(0)
  s_mov_b32 s4, s12
  s_mov_b32 s5, s13
  s_mov_b32 s6, 0x10000000
  s_mov_b32 s7, 0x20000
  s_lshl_b32 s20, s17, 17
  s_add_u32 s21, s20, 165675008
  s_add_u32 s22, s20, 169869312
  s_lshl_b32 s23, s18, 3
  s_lshl_b32 s24, s16, 1
  s_add_u32 s23, s23, s24
  s_lshl_b32 s24, s23, 11
  s_add_u32 s24, s24, s20
  s_add_u32 s24, s24, 161480704
  buffer_load_dwordx4 v[8:11], v1, s[4:7], s24 offen offset:0
  buffer_load_dwordx4 v[12:15], v1, s[4:7], s24 offen offset:1024
  buffer_load_dwordx4 v[16:19], v1, s[4:7], s24 offen offset:2048
  buffer_load_dwordx4 v[20:23], v1, s[4:7], s24 offen offset:3072
  s_mov_b32 s25, s21
  s_mov_b32 s26, s22
  buffer_load_dwordx4 v[136:139], v1, s[4:7], s25 offen
  buffer_load_dwordx4 v[140:143], v1, s[4:7], s25 offen offset:1024
  buffer_load_dwordx4 v[144:147], v1, s[4:7], s26 offen
  buffer_load_dwordx4 v[148:151], v1, s[4:7], s26 offen offset:1024
  s_add_u32 s25, s25, 2048
  s_add_u32 s26, s26, 2048
  s_waitcnt vmcnt(0)
  v_mfma_f32_32x32x16_bf16 v[88:103], v[136:139], v[8:11], 0
  v_mfma_f32_32x32x16_bf16 v[88:103], v[140:143], v[12:15], v[88:103]
  v_mfma_f32_32x32x16_bf16 v[104:119], v[136:139], v[16:19], 0
  v_mfma_f32_32x32x16_bf16 v[104:119], v[140:143], v[20:23], v[104:119]
  s_nop 9
  v_max3_f32 v2, v88, v89, v90
  v_max3_f32 v2, v2, v91, v92
  v_max3_f32 v2, v2, v93, v94
  v_max3_f32 v2, v2, v95, v96
  v_max3_f32 v2, v2, v97, v98
  v_max3_f32 v2, v2, v99, v100
  v_max3_f32 v2, v2, v101, v102
  v_max_f32 v2, v2, v103
  v_mov_b32 v4, v2
  s_nop 1
  v_permlane32_swap_b32 v2, v4
  v_max_f32 v2, v2, v4
  v_sub_f32 v24, 0, v2
  v_sub_f32 v25, 0, v2
  v_sub_f32 v26, 0, v2
  v_sub_f32 v27, 0, v2
  v_sub_f32 v28, 0, v2
  v_sub_f32 v29, 0, v2
  v_sub_f32 v30, 0, v2
  v_sub_f32 v31, 0, v2
  v_sub_f32 v32, 0, v2
  v_sub_f32 v33, 0, v2
  v_sub_f32 v34, 0, v2
  v_sub_f32 v35, 0, v2
  v_sub_f32 v36, 0, v2
  v_sub_f32 v37, 0, v2
  v_sub_f32 v38, 0, v2
  v_sub_f32 v39, 0, v2
  v_max3_f32 v3, v104, v105, v106
  v_max3_f32 v3, v3, v107, v108
  v_max3_f32 v3, v3, v109, v110
  v_max3_f32 v3, v3, v111, v112
  v_max3_f32 v3, v3, v113, v114
  v_max3_f32 v3, v3, v115, v116
  v_max3_f32 v3, v3, v117, v118
  v_max_f32 v3, v3, v119
  v_mov_b32 v4, v3
  s_nop 1
  v_permlane32_swap_b32 v3, v4
  v_max_f32 v3, v3, v4
  v_sub_f32 v40, 0, v3
  v_sub_f32 v41, 0, v3
  v_sub_f32 v42, 0, v3
  v_sub_f32 v43, 0, v3
  v_sub_f32 v44, 0, v3
  v_sub_f32 v45, 0, v3
  v_sub_f32 v46, 0, v3
  v_sub_f32 v47, 0, v3
  v_sub_f32 v48, 0, v3
  v_sub_f32 v49, 0, v3
  v_sub_f32 v50, 0, v3
  v_sub_f32 v51, 0, v3
  v_sub_f32 v52, 0, v3
  v_sub_f32 v53, 0, v3
  v_sub_f32 v54, 0, v3
  v_sub_f32 v55, 0, v3
  s_mov_b32 s28, 0
attnb_main2:
  s_mov_b32 s25, s21
  s_mov_b32 s26, s22
  buffer_load_dwordx4 v[136:139], v1, s[4:7], s25 offen
  buffer_load_dwordx4 v[140:143], v1, s[4:7], s25 offen offset:1024
  buffer_load_dwordx4 v[144:147], v1, s[4:7], s26 offen
  buffer_load_dwordx4 v[148:151], v1, s[4:7], s26 offen offset:1024
  s_add_u32 s25, s25, 2048
  s_add_u32 s26, s26, 2048
  buffer_load_dwordx4 v[152:155], v1, s[4:7], s25 offen
  buffer_load_dwordx4 v[156:159], v1, s[4:7], s25 offen offset:1024
  buffer_load_dwordx4 v[160:163], v1, s[4:7], s26 offen
  buffer_load_dwordx4 v[164:167], v1, s[4:7], s26 offen offset:1024
  s_add_u32 s25, s25, 2048
  s_add_u32 s26, s26, 2048
  v_mov_b32 v56, 0
  v_mov_b32 v57, 0
  v_mov_b32 v58, 0
  v_mov_b32 v59, 0
  v_mov_b32 v60, 0
  v_mov_b32 v61, 0
  v_mov_b32 v62, 0
  v_mov_b32 v63, 0
  v_mov_b32 v64, 0
  v_mov_b32 v65, 0
  v_mov_b32 v66, 0
  v_mov_b32 v67, 0
  v_mov_b32 v68, 0
  v_mov_b32 v69, 0
  v_mov_b32 v70, 0
  v_mov_b32 v71, 0
  v_mov_b32 v72, 0
  v_mov_b32 v73, 0
  v_mov_b32 v74, 0
  v_mov_b32 v75, 0
  v_mov_b32 v76, 0
  v_mov_b32 v77, 0
  v_mov_b32 v78, 0
  v_mov_b32 v79, 0
  v_mov_b32 v80, 0
  v_mov_b32 v81, 0
  v_mov_b32 v82, 0
  v_mov_b32 v83, 0
  v_mov_b32 v84, 0
  v_mov_b32 v85, 0
  v_mov_b32 v86, 0
  v_mov_b32 v87, 0
  s_waitcnt vmcnt(4)
  v_mfma_f32_32x32x16_bf16 v[88:103], v[136:139], v[8:11], v[24:39]
  v_mfma_f32_32x32x16_bf16 v[88:103], v[140:143], v[12:15], v[88:103]
  s_nop 11
  v_exp_f32 v88, v88
  v_exp_f32 v89, v89
  v_exp_f32 v90, v90
  v_exp_f32 v91, v91
  v_exp_f32 v92, v92
  v_exp_f32 v93, v93
  v_exp_f32 v94, v94
  v_exp_f32 v95, v95
  v_mfma_f32_32x32x16_bf16 v[104:119], v[136:139], v[16:19], v[40:55]
  v_cvt_pk_bf16_f32 v120, v88, v89
  v_cvt_pk_bf16_f32 v121, v90, v91
  v_cvt_pk_bf16_f32 v122, v92, v93
  v_cvt_pk_bf16_f32 v123, v94, v95
  v_exp_f32 v96, v96
  v_exp_f32 v97, v97
  v_mfma_f32_32x32x16_bf16 v[104:119], v[140:143], v[20:23], v[104:119]
  v_exp_f32 v98, v98
  v_exp_f32 v99, v99
  v_exp_f32 v100, v100
  v_exp_f32 v101, v101
  v_mfma_f32_32x32x16_bf16 v[56:71], v[144:147], v[120:123], v[56:71]
  v_exp_f32 v102, v102
  v_exp_f32 v103, v103
  v_cvt_pk_bf16_f32 v124, v96, v97
  v_cvt_pk_bf16_f32 v125, v98, v99
  v_cvt_pk_bf16_f32 v126, v100, v101
  v_cvt_pk_bf16_f32 v127, v102, v103
  buffer_load_dwordx4 v[168:171], v1, s[4:7], s25 offen
  buffer_load_dwordx4 v[172:175], v1, s[4:7], s25 offen offset:1024
  buffer_load_dwordx4 v[176:179], v1, s[4:7], s26 offen
  buffer_load_dwordx4 v[180:183], v1, s[4:7], s26 offen offset:1024
  s_add_u32 s25, s25, 2048
  s_add_u32 s26, s26, 2048
  s_waitcnt vmcnt(4)
  v_exp_f32 v104, v104
  v_exp_f32 v105, v105
  v_exp_f32 v106, v106
  v_exp_f32 v107, v107
  v_mfma_f32_32x32x16_bf16 v[56:71], v[148:151], v[124:127], v[56:71]
  v_exp_f32 v108, v108
  v_exp_f32 v109, v109
  v_exp_f32 v110, v110
  v_exp_f32 v111, v111
  v_mfma_f32_32x32x16_bf16 v[88:103], v[152:155], v[8:11], v[24:39]
  v_cvt_pk_bf16_f32 v128, v104, v105
  v_cvt_pk_bf16_f32 v129, v106, v107
  v_cvt_pk_bf16_f32 v130, v108, v109
  v_cvt_pk_bf16_f32 v131, v110, v111
  v_exp_f32 v112, v112
  v_exp_f32 v113, v113
  v_mfma_f32_32x32x16_bf16 v[88:103], v[156:159], v[12:15], v[88:103]
  v_exp_f32 v114, v114
  v_exp_f32 v115, v115
  v_exp_f32 v116, v116
  v_exp_f32 v117, v117
  v_mfma_f32_32x32x16_bf16 v[72:87], v[144:147], v[128:131], v[72:87]
  v_exp_f32 v118, v118
  v_exp_f32 v119, v119
  v_cvt_pk_bf16_f32 v132, v112, v113
  v_cvt_pk_bf16_f32 v133, v114, v115
  v_cvt_pk_bf16_f32 v134, v116, v117
  v_cvt_pk_bf16_f32 v135, v118, v119
  s_mov_b32 s27, 0
attnb_loop3:
  v_exp_f32 v88, v88
  v_exp_f32 v89, v89
  v_exp_f32 v90, v90
  v_exp_f32 v91, v91
  v_mfma_f32_32x32x16_bf16 v[72:87], v[148:151], v[132:135], v[72:87]
  v_exp_f32 v92, v92
  v_exp_f32 v93, v93
  v_exp_f32 v94, v94
  v_exp_f32 v95, v95
  v_mfma_f32_32x32x16_bf16 v[104:119], v[152:155], v[16:19], v[40:55]
  v_cvt_pk_bf16_f32 v120, v88, v89
  v_cvt_pk_bf16_f32 v121, v90, v91
  v_cvt_pk_bf16_f32 v122, v92, v93
  v_cvt_pk_bf16_f32 v123, v94, v95
  v_exp_f32 v96, v96
  v_exp_f32 v97, v97
  v_mfma_f32_32x32x16_bf16 v[104:119], v[156:159], v[20:23], v[104:119]
  v_exp_f32 v98, v98
  v_exp_f32 v99, v99
  v_exp_f32 v100, v100
  v_exp_f32 v101, v101
  v_mfma_f32_32x32x16_bf16 v[56:71], v[160:163], v[120:123], v[56:71]
  v_exp_f32 v102, v102
  v_exp_f32 v103, v103
  v_cvt_pk_bf16_f32 v124, v96, v97
  v_cvt_pk_bf16_f32 v125, v98, v99
  v_cvt_pk_bf16_f32 v126, v100, v101
  v_cvt_pk_bf16_f32 v127, v102, v103
  buffer_load_dwordx4 v[136:139], v1, s[4:7], s25 offen
  buffer_load_dwordx4 v[140:143], v1, s[4:7], s25 offen offset:1024
  buffer_load_dwordx4 v[144:147], v1, s[4:7], s26 offen
  buffer_load_dwordx4 v[148:151], v1, s[4:7], s26 offen offset:1024
  s_add_u32 s25, s25, 2048
  s_add_u32 s26, s26, 2048
  s_waitcnt vmcnt(4)
  v_exp_f32 v104, v104
  v_exp_f32 v105, v105
  v_exp_f32 v106, v106
  v_exp_f32 v107, v107
  v_mfma_f32_32x32x16_bf16 v[56:71], v[164:167], v[124:127], v[56:71]
  v_exp_f32 v108, v108
  v_exp_f32 v109, v109
  v_exp_f32 v110, v110
  v_exp_f32 v111, v111
  v_mfma_f32_32x32x16_bf16 v[88:103], v[168:171], v[8:11], v[24:39]
  v_cvt_pk_bf16_f32 v128, v104, v105
  v_cvt_pk_bf16_f32 v129, v106, v107
  v_cvt_pk_bf16_f32 v130, v108, v109
  v_cvt_pk_bf16_f32 v131, v110, v111
  v_exp_f32 v112, v112
  v_exp_f32 v113, v113
  v_mfma_f32_32x32x16_bf16 v[88:103], v[172:175], v[12:15], v[88:103]
  v_exp_f32 v114, v114
  v_exp_f32 v115, v115
  v_exp_f32 v116, v116
  v_exp_f32 v117, v117
  v_mfma_f32_32x32x16_bf16 v[72:87], v[160:163], v[128:131], v[72:87]
  v_exp_f32 v118, v118
  v_exp_f32 v119, v119
  v_cvt_pk_bf16_f32 v132, v112, v113
  v_cvt_pk_bf16_f32 v133, v114, v115
  v_cvt_pk_bf16_f32 v134, v116, v117
  v_cvt_pk_bf16_f32 v135, v118, v119
  s_nop 0
  v_exp_f32 v88, v88
  v_exp_f32 v89, v89
  v_exp_f32 v90, v90
  v_exp_f32 v91, v91
  v_mfma_f32_32x32x16_bf16 v[72:87], v[164:167], v[132:135], v[72:87]
  v_exp_f32 v92, v92
  v_exp_f32 v93, v93
  v_exp_f32 v94, v94
  v_exp_f32 v95, v95
  v_mfma_f32_32x32x16_bf16 v[104:119], v[168:171], v[16:19], v[40:55]
  v_cvt_pk_bf16_f32 v120, v88, v89
  v_cvt_pk_bf16_f32 v121, v90, v91
  v_cvt_pk_bf16_f32 v122, v92, v93
  v_cvt_pk_bf16_f32 v123, v94, v95
  v_exp_f32 v96, v96
  v_exp_f32 v97, v97
  v_mfma_f32_32x32x16_bf16 v[104:119], v[172:175], v[20:23], v[104:119]
  v_exp_f32 v98, v98
  v_exp_f32 v99, v99
  v_exp_f32 v100, v100
  v_exp_f32 v101, v101
  v_mfma_f32_32x32x16_bf16 v[56:71], v[176:179], v[120:123], v[56:71]
  v_exp_f32 v102, v102
  v_exp_f32 v103, v103
  v_cvt_pk_bf16_f32 v124, v96, v97
  v_cvt_pk_bf16_f32 v125, v98, v99
  v_cvt_pk_bf16_f32 v126, v100, v101
  v_cvt_pk_bf16_f32 v127, v102, v103
  buffer_load_dwordx4 v[152:155], v1, s[4:7], s25 offen
  buffer_load_dwordx4 v[156:159], v1, s[4:7], s25 offen offset:1024
  buffer_load_dwordx4 v[160:163], v1, s[4:7], s26 offen
  buffer_load_dwordx4 v[164:167], v1, s[4:7], s26 offen offset:1024
  s_add_u32 s25, s25, 2048
  s_add_u32 s26, s26, 2048
  s_waitcnt vmcnt(4)
  v_exp_f32 v104, v104
  v_exp_f32 v105, v105
  v_exp_f32 v106, v106
  v_exp_f32 v107, v107
  v_mfma_f32_32x32x16_bf16 v[56:71], v[180:183], v[124:127], v[56:71]
  v_exp_f32 v108, v108
  v_exp_f32 v109, v109
  v_exp_f32 v110, v110
  v_exp_f32 v111, v111
  v_mfma_f32_32x32x16_bf16 v[88:103], v[136:139], v[8:11], v[24:39]
  v_cvt_pk_bf16_f32 v128, v104, v105
  v_cvt_pk_bf16_f32 v129, v106, v107
  v_cvt_pk_bf16_f32 v130, v108, v109
  v_cvt_pk_bf16_f32 v131, v110, v111
  v_exp_f32 v112, v112
  v_exp_f32 v113, v113
  v_mfma_f32_32x32x16_bf16 v[88:103], v[140:143], v[12:15], v[88:103]
  v_exp_f32 v114, v114
  v_exp_f32 v115, v115
  v_exp_f32 v116, v116
  v_exp_f32 v117, v117
  v_mfma_f32_32x32x16_bf16 v[72:87], v[176:179], v[128:131], v[72:87]
  v_exp_f32 v118, v118
  v_exp_f32 v119, v119
  v_cvt_pk_bf16_f32 v132, v112, v113
  v_cvt_pk_bf16_f32 v133, v114, v115
  v_cvt_pk_bf16_f32 v134, v116, v117
  v_cvt_pk_bf16_f32 v135, v118, v119
  s_nop 0
  v_exp_f32 v88, v88
  v_exp_f32 v89, v89
  v_exp_f32 v90, v90
  v_exp_f32 v91, v91
  v_mfma_f32_32x32x16_bf16 v[72:87], v[180:183], v[132:135], v[72:87]
  v_exp_f32 v92, v92
  v_exp_f32 v93, v93
  v_exp_f32 v94, v94
  v_exp_f32 v95, v95
  v_mfma_f32_32x32x16_bf16 v[104:119], v[136:139], v[16:19], v[40:55]
  v_cvt_pk_bf16_f32 v120, v88, v89
  v_cvt_pk_bf16_f32 v121, v90, v91
  v_cvt_pk_bf16_f32 v122, v92, v93
  v_cvt_pk_bf16_f32 v123, v94, v95
  v_exp_f32 v96, v96
  v_exp_f32 v97, v97
  v_mfma_f32_32x32x16_bf16 v[104:119], v[140:143], v[20:23], v[104:119]
  v_exp_f32 v98, v98
  v_exp_f32 v99, v99
  v_exp_f32 v100, v100
  v_exp_f32 v101, v101
  v_mfma_f32_32x32x16_bf16 v[56:71], v[144:147], v[120:123], v[56:71]
  v_exp_f32 v102, v102
  v_exp_f32 v103, v103
  v_cvt_pk_bf16_f32 v124, v96, v97
  v_cvt_pk_bf16_f32 v125, v98, v99
  v_cvt_pk_bf16_f32 v126, v100, v101
  v_cvt_pk_bf16_f32 v127, v102, v103
  buffer_load_dwordx4 v[168:171], v1, s[4:7], s25 offen
  buffer_load_dwordx4 v[172:175], v1, s[4:7], s25 offen offset:1024
  buffer_load_dwordx4 v[176:179], v1, s[4:7], s26 offen
  buffer_load_dwordx4 v[180:183], v1, s[4:7], s26 offen offset:1024
  s_add_u32 s25, s25, 2048
  s_add_u32 s26, s26, 2048
  s_waitcnt vmcnt(4)
  v_exp_f32 v104, v104
  v_exp_f32 v105, v105
  v_exp_f32 v106, v106
  v_exp_f32 v107, v107
  v_mfma_f32_32x32x16_bf16 v[56:71], v[148:151], v[124:127], v[56:71]
  v_exp_f32 v108, v108
  v_exp_f32 v109, v109
  v_exp_f32 v110, v110
  v_exp_f32 v111, v111
  v_mfma_f32_32x32x16_bf16 v[88:103], v[152:155], v[8:11], v[24:39]
  v_cvt_pk_bf16_f32 v128, v104, v105
  v_cvt_pk_bf16_f32 v129, v106, v107
  v_cvt_pk_bf16_f32 v130, v108, v109
  v_cvt_pk_bf16_f32 v131, v110, v111
  v_exp_f32 v112, v112
  v_exp_f32 v113, v113
  v_mfma_f32_32x32x16_bf16 v[88:103], v[156:159], v[12:15], v[88:103]
  v_exp_f32 v114, v114
  v_exp_f32 v115, v115
  v_exp_f32 v116, v116
  v_exp_f32 v117, v117
  v_mfma_f32_32x32x16_bf16 v[72:87], v[144:147], v[128:131], v[72:87]
  v_exp_f32 v118, v118
  v_exp_f32 v119, v119
  v_cvt_pk_bf16_f32 v132, v112, v113
  v_cvt_pk_bf16_f32 v133, v114, v115
  v_cvt_pk_bf16_f32 v134, v116, v117
  v_cvt_pk_bf16_f32 v135, v118, v119
  s_add_u32 s27, s27, 1
  s_cmp_lt_u32 s27, 20
  s_cbranch_scc1 attnb_loop3
  v_exp_f32 v88, v88
  v_exp_f32 v89, v89
  v_exp_f32 v90, v90
  v_exp_f32 v91, v91
  v_mfma_f32_32x32x16_bf16 v[72:87], v[148:151], v[132:135], v[72:87]
  v_exp_f32 v92, v92
  v_exp_f32 v93, v93
  v_exp_f32 v94, v94
  v_exp_f32 v95, v95
  v_mfma_f32_32x32x16_bf16 v[104:119], v[152:155], v[16:19], v[40:55]
  v_cvt_pk_bf16_f32 v120, v88, v89
  v_cvt_pk_bf16_f32 v121, v90, v91
  v_cvt_pk_bf16_f32 v122, v92, v93
  v_cvt_pk_bf16_f32 v123, v94, v95
  v_exp_f32 v96, v96
  v_exp_f32 v97, v97
  v_mfma_f32_32x32x16_bf16 v[104:119], v[156:159], v[20:23], v[104:119]
  v_exp_f32 v98, v98
  v_exp_f32 v99, v99
  v_exp_f32 v100, v100
  v_exp_f32 v101, v101
  v_mfma_f32_32x32x16_bf16 v[56:71], v[160:163], v[120:123], v[56:71]
  v_exp_f32 v102, v102
  v_exp_f32 v103, v103
  v_cvt_pk_bf16_f32 v124, v96, v97
  v_cvt_pk_bf16_f32 v125, v98, v99
  v_cvt_pk_bf16_f32 v126, v100, v101
  v_cvt_pk_bf16_f32 v127, v102, v103
  buffer_load_dwordx4 v[136:139], v1, s[4:7], s25 offen
  buffer_load_dwordx4 v[140:143], v1, s[4:7], s25 offen offset:1024
  buffer_load_dwordx4 v[144:147], v1, s[4:7], s26 offen
  buffer_load_dwordx4 v[148:151], v1, s[4:7], s26 offen offset:1024
  s_add_u32 s25, s25, 2048
  s_add_u32 s26, s26, 2048
  s_waitcnt vmcnt(4)
  v_exp_f32 v104, v104
  v_exp_f32 v105, v105
  v_exp_f32 v106, v106
  v_exp_f32 v107, v107
  v_mfma_f32_32x32x16_bf16 v[56:71], v[164:167], v[124:127], v[56:71]
  v_exp_f32 v108, v108
  v_exp_f32 v109, v109
  v_exp_f32 v110, v110
  v_exp_f32 v111, v111
  v_mfma_f32_32x32x16_bf16 v[88:103], v[168:171], v[8:11], v[24:39]
  v_cvt_pk_bf16_f32 v128, v104, v105
  v_cvt_pk_bf16_f32 v129, v106, v107
  v_cvt_pk_bf16_f32 v130, v108, v109
  v_cvt_pk_bf16_f32 v131, v110, v111
  v_exp_f32 v112, v112
  v_exp_f32 v113, v113
  v_mfma_f32_32x32x16_bf16 v[88:103], v[172:175], v[12:15], v[88:103]
  v_exp_f32 v114, v114
  v_exp_f32 v115, v115
  v_exp_f32 v116, v116
  v_exp_f32 v117, v117
  v_mfma_f32_32x32x16_bf16 v[72:87], v[160:163], v[128:131], v[72:87]
  v_exp_f32 v118, v118
  v_exp_f32 v119, v119
  v_cvt_pk_bf16_f32 v132, v112, v113
  v_cvt_pk_bf16_f32 v133, v114, v115
  v_cvt_pk_bf16_f32 v134, v116, v117
  v_cvt_pk_bf16_f32 v135, v118, v119
  s_nop 0
  v_exp_f32 v88, v88
  v_exp_f32 v89, v89
  v_exp_f32 v90, v90
  v_exp_f32 v91, v91
  v_mfma_f32_32x32x16_bf16 v[72:87], v[164:167], v[132:135], v[72:87]
  v_exp_f32 v92, v92
  v_exp_f32 v93, v93
  v_exp_f32 v94, v94
  v_exp_f32 v95, v95
  v_mfma_f32_32x32x16_bf16 v[104:119], v[168:171], v[16:19], v[40:55]
  v_cvt_pk_bf16_f32 v120, v88, v89
  v_cvt_pk_bf16_f32 v121, v90, v91
  v_cvt_pk_bf16_f32 v122, v92, v93
  v_cvt_pk_bf16_f32 v123, v94, v95
  v_exp_f32 v96, v96
  v_exp_f32 v97, v97
  v_mfma_f32_32x32x16_bf16 v[104:119], v[172:175], v[20:23], v[104:119]
  v_exp_f32 v98, v98
  v_exp_f32 v99, v99
  v_exp_f32 v100, v100
  v_exp_f32 v101, v101
  v_mfma_f32_32x32x16_bf16 v[56:71], v[176:179], v[120:123], v[56:71]
  v_exp_f32 v102, v102
  v_exp_f32 v103, v103
  v_cvt_pk_bf16_f32 v124, v96, v97
  v_cvt_pk_bf16_f32 v125, v98, v99
  v_cvt_pk_bf16_f32 v126, v100, v101
  v_cvt_pk_bf16_f32 v127, v102, v103
  s_waitcnt vmcnt(0)
  v_exp_f32 v104, v104
  v_exp_f32 v105, v105
  v_exp_f32 v106, v106
  v_exp_f32 v107, v107
  v_mfma_f32_32x32x16_bf16 v[56:71], v[180:183], v[124:127], v[56:71]
  v_exp_f32 v108, v108
  v_exp_f32 v109, v109
  v_exp_f32 v110, v110
  v_exp_f32 v111, v111
  v_mfma_f32_32x32x16_bf16 v[88:103], v[136:139], v[8:11], v[24:39]
  v_cvt_pk_bf16_f32 v128, v104, v105
  v_cvt_pk_bf16_f32 v129, v106, v107
  v_cvt_pk_bf16_f32 v130, v108, v109
  v_cvt_pk_bf16_f32 v131, v110, v111
  v_exp_f32 v112, v112
  v_exp_f32 v113, v113
  v_mfma_f32_32x32x16_bf16 v[88:103], v[140:143], v[12:15], v[88:103]
  v_exp_f32 v114, v114
  v_exp_f32 v115, v115
  v_exp_f32 v116, v116
  v_exp_f32 v117, v117
  v_mfma_f32_32x32x16_bf16 v[72:87], v[176:179], v[128:131], v[72:87]
  v_exp_f32 v118, v118
  v_exp_f32 v119, v119
  v_cvt_pk_bf16_f32 v132, v112, v113
  v_cvt_pk_bf16_f32 v133, v114, v115
  v_cvt_pk_bf16_f32 v134, v116, v117
  v_cvt_pk_bf16_f32 v135, v118, v119
  s_nop 0
  v_exp_f32 v88, v88
  v_exp_f32 v89, v89
  v_exp_f32 v90, v90
  v_exp_f32 v91, v91
  v_mfma_f32_32x32x16_bf16 v[72:87], v[180:183], v[132:135], v[72:87]
  v_exp_f32 v92, v92
  v_exp_f32 v93, v93
  v_exp_f32 v94, v94
  v_exp_f32 v95, v95
  v_mfma_f32_32x32x16_bf16 v[104:119], v[136:139], v[16:19], v[40:55]
  v_cvt_pk_bf16_f32 v120, v88, v89
  v_cvt_pk_bf16_f32 v121, v90, v91
  v_cvt_pk_bf16_f32 v122, v92, v93
  v_cvt_pk_bf16_f32 v123, v94, v95
  v_exp_f32 v96, v96
  v_exp_f32 v97, v97
  v_mfma_f32_32x32x16_bf16 v[104:119], v[140:143], v[20:23], v[104:119]
  v_exp_f32 v98, v98
  v_exp_f32 v99, v99
  v_exp_f32 v100, v100
  v_exp_f32 v101, v101
  v_mfma_f32_32x32x16_bf16 v[56:71], v[144:147], v[120:123], v[56:71]
  v_exp_f32 v102, v102
  v_exp_f32 v103, v103
  v_cvt_pk_bf16_f32 v124, v96, v97
  v_cvt_pk_bf16_f32 v125, v98, v99
  v_cvt_pk_bf16_f32 v126, v100, v101
  v_cvt_pk_bf16_f32 v127, v102, v103
  s_nop 0
  v_exp_f32 v104, v104
  v_exp_f32 v105, v105
  v_exp_f32 v106, v106
  v_exp_f32 v107, v107
  v_mfma_f32_32x32x16_bf16 v[56:71], v[148:151], v[124:127], v[56:71]
  v_exp_f32 v108, v108
  v_exp_f32 v109, v109
  v_exp_f32 v110, v110
  v_exp_f32 v111, v111
  v_cvt_pk_bf16_f32 v128, v104, v105
  v_cvt_pk_bf16_f32 v129, v106, v107
  v_cvt_pk_bf16_f32 v130, v108, v109
  v_cvt_pk_bf16_f32 v131, v110, v111
  v_exp_f32 v112, v112
  v_exp_f32 v113, v113
  v_exp_f32 v114, v114
  v_exp_f32 v115, v115
  v_exp_f32 v116, v116
  v_exp_f32 v117, v117
  v_mfma_f32_32x32x16_bf16 v[72:87], v[144:147], v[128:131], v[72:87]
  v_exp_f32 v118, v118
  v_exp_f32 v119, v119
  v_cvt_pk_bf16_f32 v132, v112, v113
  v_cvt_pk_bf16_f32 v133, v114, v115
  v_cvt_pk_bf16_f32 v134, v116, v117
  v_cvt_pk_bf16_f32 v135, v118, v119
  s_nop 1
  v_mfma_f32_32x32x16_bf16 v[72:87], v[148:151], v[132:135], v[72:87]
  v_mov_b32 v2, v64
  v_mov_b32 v4, v2
  s_nop 1
  v_permlane32_swap_b32 v4, v2
  s_nop 6
  v_mov_b32 v3, v80
  v_mov_b32 v4, v3
  s_nop 1
  v_permlane32_swap_b32 v4, v3
  s_cmp_eq_u32 s28, 1
  s_cbranch_scc1 attnb_done5
  v_max_f32 v4, v2, v3
  v_cmp_nge_f32 vcc, 0x4e800000, v4
  v_cmp_u_f32 s[30:31], v2, v3
  s_nop 3
  s_or_b64 s[32:33], vcc, s[30:31]
  s_movk_i32 s34, 0x207
  v_cmp_class_f32 vcc, v56, s34
  s_nop 3
  s_or_b64 s[32:33], s[32:33], vcc
  v_cmp_class_f32 vcc, v57, s34
  s_nop 3
  s_or_b64 s[32:33], s[32:33], vcc
  v_cmp_class_f32 vcc, v58, s34
  s_nop 3
  s_or_b64 s[32:33], s[32:33], vcc
  v_cmp_class_f32 vcc, v59, s34
  s_nop 3
  s_or_b64 s[32:33], s[32:33], vcc
  v_cmp_class_f32 vcc, v60, s34
  s_nop 3
  s_or_b64 s[32:33], s[32:33], vcc
  v_cmp_class_f32 vcc, v61, s34
  s_nop 3
  s_or_b64 s[32:33], s[32:33], vcc
  v_cmp_class_f32 vcc, v62, s34
  s_nop 3
  s_or_b64 s[32:33], s[32:33], vcc
  v_cmp_class_f32 vcc, v63, s34
  s_nop 3
  s_or_b64 s[32:33], s[32:33], vcc
  v_cmp_class_f32 vcc, v64, s34
  s_nop 3
  s_or_b64 s[32:33], s[32:33], vcc
  v_cmp_class_f32 vcc, v65, s34
  s_nop 3
  s_or_b64 s[32:33], s[32:33], vcc
  v_cmp_class_f32 vcc, v66, s34
  s_nop 3
  s_or_b64 s[32:33], s[32:33], vcc
  v_cmp_class_f32 vcc, v67, s34
  s_nop 3
  s_or_b64 s[32:33], s[32:33], vcc
  v_cmp_class_f32 vcc, v68, s34
  s_nop 3
  s_or_b64 s[32:33], s[32:33], vcc
  v_cmp_class_f32 vcc, v69, s34
  s_nop 3
  s_or_b64 s[32:33], s[32:33], vcc
  v_cmp_class_f32 vcc, v70, s34
  s_nop 3
  s_or_b64 s[32:33], s[32:33], vcc
  v_cmp_class_f32 vcc, v71, s34
  s_nop 3
  s_or_b64 s[32:33], s[32:33], vcc
  v_cmp_class_f32 vcc, v72, s34
  s_nop 3
  s_or_b64 s[32:33], s[32:33], vcc
  v_cmp_class_f32 vcc, v73, s34
  s_nop 3
  s_or_b64 s[32:33], s[32:33], vcc
  v_cmp_class_f32 vcc, v74, s34
  s_nop 3
  s_or_b64 s[32:33], s[32:33], vcc
  v_cmp_class_f32 vcc, v75, s34
  s_nop 3
  s_or_b64 s[32:33], s[32:33], vcc
  v_cmp_class_f32 vcc, v76, s34
  s_nop 3
  s_or_b64 s[32:33], s[32:33], vcc
  v_cmp_class_f32 vcc, v77, s34
  s_nop 3
  s_or_b64 s[32:33], s[32:33], vcc
  v_cmp_class_f32 vcc, v78, s34
  s_nop 3
  s_or_b64 s[32:33], s[32:33], vcc
  v_cmp_class_f32 vcc, v79, s34
  s_nop 3
  s_or_b64 s[32:33], s[32:33], vcc
  v_cmp_class_f32 vcc, v80, s34
  s_nop 3
  s_or_b64 s[32:33], s[32:33], vcc
  v_cmp_class_f32 vcc, v81, s34
  s_nop 3
  s_or_b64 s[32:33], s[32:33], vcc
  v_cmp_class_f32 vcc, v82, s34
  s_nop 3
  s_or_b64 s[32:33], s[32:33], vcc
  v_cmp_class_f32 vcc, v83, s34
  s_nop 3
  s_or_b64 s[32:33], s[32:33], vcc
  v_cmp_class_f32 vcc, v84, s34
  s_nop 3
  s_or_b64 s[32:33], s[32:33], vcc
  v_cmp_class_f32 vcc, v85, s34
  s_nop 3
  s_or_b64 s[32:33], s[32:33], vcc
  v_cmp_class_f32 vcc, v86, s34
  s_nop 3
  s_or_b64 s[32:33], s[32:33], vcc
  v_cmp_class_f32 vcc, v87, s34
  s_nop 3
  s_or_b64 s[32:33], s[32:33], vcc
  s_mov_b64 vcc, s[32:33]
  s_cbranch_vccz attnb_done5
  s_mov_b32 s25, s21
  s_mov_b32 s27, 0
  v_mov_b32 v120, 0xff800000
  v_mov_b32 v121, 0xff800000
attnb_fb4:
  buffer_load_dwordx4 v[136:139], v1, s[4:7], s25 offen
  buffer_load_dwordx4 v[140:143], v1, s[4:7], s25 offen offset:1024
  s_add_u32 s25, s25, 2048
  s_waitcnt vmcnt(0)
  v_mfma_f32_32x32x16_bf16 v[88:103], v[136:139], v[8:11], 0
  v_mfma_f32_32x32x16_bf16 v[88:103], v[140:143], v[12:15], v[88:103]
  v_mfma_f32_32x32x16_bf16 v[104:119], v[136:139], v[16:19], 0
  v_mfma_f32_32x32x16_bf16 v[104:119], v[140:143], v[20:23], v[104:119]
  s_nop 9
  v_max3_f32 v2, v88, v89, v90
  v_max3_f32 v2, v2, v91, v92
  v_max3_f32 v2, v2, v93, v94
  v_max3_f32 v2, v2, v95, v96
  v_max3_f32 v2, v2, v97, v98
  v_max3_f32 v2, v2, v99, v100
  v_max3_f32 v2, v2, v101, v102
  v_max_f32 v2, v2, v103
  v_max_f32 v120, v120, v2
  s_nop 2
  v_max3_f32 v3, v104, v105, v106
  v_max3_f32 v3, v3, v107, v108
  v_max3_f32 v3, v3, v109, v110
  v_max3_f32 v3, v3, v111, v112
  v_max3_f32 v3, v3, v113, v114
  v_max3_f32 v3, v3, v115, v116
  v_max3_f32 v3, v3, v117, v118
  v_max_f32 v3, v3, v119
  v_max_f32 v121, v121, v3
  s_add_u32 s27, s27, 1
  s_cmp_lt_u32 s27, 64
  s_cbranch_scc1 attnb_fb4
  v_mov_b32 v4, v120
  s_nop 1
  v_permlane32_swap_b32 v120, v4
  v_max_f32 v120, v120, v4
  v_sub_f32 v24, 0, v120
  v_sub_f32 v25, 0, v120
  v_sub_f32 v26, 0, v120
  v_sub_f32 v27, 0, v120
  v_sub_f32 v28, 0, v120
  v_sub_f32 v29, 0, v120
  v_sub_f32 v30, 0, v120
  v_sub_f32 v31, 0, v120
  v_sub_f32 v32, 0, v120
  v_sub_f32 v33, 0, v120
  v_sub_f32 v34, 0, v120
  v_sub_f32 v35, 0, v120
  v_sub_f32 v36, 0, v120
  v_sub_f32 v37, 0, v120
  v_sub_f32 v38, 0, v120
  v_sub_f32 v39, 0, v120
  v_mov_b32 v4, v121
  s_nop 1
  v_permlane32_swap_b32 v121, v4
  v_max_f32 v121, v121, v4
  v_sub_f32 v40, 0, v121
  v_sub_f32 v41, 0, v121
  v_sub_f32 v42, 0, v121
  v_sub_f32 v43, 0, v121
  v_sub_f32 v44, 0, v121
  v_sub_f32 v45, 0, v121
  v_sub_f32 v46, 0, v121
  v_sub_f32 v47, 0, v121
  v_sub_f32 v48, 0, v121
  v_sub_f32 v49, 0, v121
  v_sub_f32 v50, 0, v121
  v_sub_f32 v51, 0, v121
  v_sub_f32 v52, 0, v121
  v_sub_f32 v53, 0, v121
  v_sub_f32 v54, 0, v121
  v_sub_f32 v55, 0, v121
  s_mov_b32 s28, 1
  s_branch attnb_main2
attnb_done5:
  v_and_b32 v136, 63, v0
  v_and_b32 v137, 15, v136
  v_lshlrev_b32 v137, 4, v137
  v_lshrrev_b32 v138, 5, v136
  v_lshl_add_u32 v137, v138, 8, v137
  v_bfe_u32 v138, v136, 4, 1
  v_lshl_add_u32 v137, v138, 15, v137
  s_lshl_b32 s24, s23, 16
  s_lshl_b32 s25, s17, 10
  s_add_u32 s24, s24, s25
  s_add_u32 s24, s24, 174063616
  v_rcp_f32 v4, v2
  s_nop 0
  v_mul_f32 v56, v56, v4
  v_mul_f32 v57, v57, v4
  v_mul_f32 v58, v58, v4
  v_mul_f32 v59, v59, v4
  v_mul_f32 v60, v60, v4
  v_mul_f32 v61, v61, v4
  v_mul_f32 v62, v62, v4
  v_mul_f32 v63, v63, v4
  v_mul_f32 v64, v64, v4
  v_mul_f32 v65, v65, v4
  v_mul_f32 v66, v66, v4
  v_mul_f32 v67, v67, v4
  v_mul_f32 v68, v68, v4
  v_mul_f32 v69, v69, v4
  v_mul_f32 v70, v70, v4
  v_mul_f32 v71, v71, v4
  v_cvt_pk_bf16_f32 v120, v56, v57
  v_cvt_pk_bf16_f32 v121, v58, v59
  v_cvt_pk_bf16_f32 v122, v60, v61
  v_cvt_pk_bf16_f32 v123, v62, v63
  v_cvt_pk_bf16_f32 v124, v64, v65
  v_cvt_pk_bf16_f32 v125, v66, v67
  v_cvt_pk_bf16_f32 v126, v68, v69
  v_cvt_pk_bf16_f32 v127, v70, v71
  buffer_store_dwordx4 v[120:123], v137, s[4:7], s24 offen
  buffer_store_dwordx4 v[124:127], v137, s[4:7], s24 offen offset:512
  v_rcp_f32 v4, v3
  s_nop 0
  v_mul_f32 v72, v72, v4
  v_mul_f32 v73, v73, v4
  v_mul_f32 v74, v74, v4
  v_mul_f32 v75, v75, v4
  v_mul_f32 v76, v76, v4
  v_mul_f32 v77, v77, v4
  v_mul_f32 v78, v78, v4
  v_mul_f32 v79, v79, v4
  v_mul_f32 v80, v80, v4
  v_mul_f32 v81, v81, v4
  v_mul_f32 v82, v82, v4
  v_mul_f32 v83, v83, v4
  v_mul_f32 v84, v84, v4
  v_mul_f32 v85, v85, v4
  v_mul_f32 v86, v86, v4
  v_mul_f32 v87, v87, v4
  v_cvt_pk_bf16_f32 v128, v72, v73
  v_cvt_pk_bf16_f32 v129, v74, v75
  v_cvt_pk_bf16_f32 v130, v76, v77
  v_cvt_pk_bf16_f32 v131, v78, v79
  v_cvt_pk_bf16_f32 v132, v80, v81
  v_cvt_pk_bf16_f32 v133, v82, v83
  v_cvt_pk_bf16_f32 v134, v84, v85
  v_cvt_pk_bf16_f32 v135, v86, v87
  s_add_u32 s24, s24, 65536
  buffer_store_dwordx4 v[128:131], v137, s[4:7], s24 offen
  buffer_store_dwordx4 v[132:135], v137, s[4:7], s24 offen offset:512
attnb_exit1:
  s_endpgm
.globl outb1_kernel
.p2align 8
.type outb1_kernel,@function
outb1_kernel:
  s_cmp_ge_u32 s2, 256
  s_cbranch_scc1 outb1_exit1
  s_load_dwordx2 s[12:13], s[0:1], 96
  s_load_dwordx2 s[14:15], s[0:1], 0
  s_load_dwordx2 s[48:49], s[0:1], 80
  v_lshrrev_b32 v3, 6, v0
  v_and_b32 v4, 63, v0
  s_nop 0
  v_readfirstlane_b32 s16, v3
  v_lshlrev_b32 v1, 4, v4
  s_and_b32 s17, s2, 7
  s_lshl_b32 s17, s17, 2
  s_lshr_b32 s18, s2, 3
  s_and_b32 s19, s18, 3
  s_add_u32 s17, s17, s19
  s_lshr_b32 s18, s18, 2
  s_waitcnt lgkmcnt(0)
  s_mov_b32 s4, s12
  s_mov_b32 s5, s13
  s_mov_b32 s6, 0x10000000
  s_mov_b32 s7, 0x20000
  s_mov_b32 s8, s12
  s_mov_b32 s9, s13
  s_mov_b32 s10, 0x10000000
  s_mov_b32 s11, 0x20000
  s_mov_b32 s20, 150994944
  s_mov_b32 s52, s48
  s_mov_b32 s53, s49
  s_mov_b32 s54, 2621440
  s_mov_b32 s55, 0x20000
  s_mul_i32 s21, s18, 5
  s_mul_i32 s21, s21, 32768
  s_add_u32 s24, s21, 160169984
  s_add_u32 s25, s24, 32768
  s_add_u32 s26, s25, 32768
  s_add_u32 s27, s26, 32768
  s_add_u32 s28, s27, 32768
  s_lshl_b32 s21, s17, 2
  s_add_u32 s21, s21, s16
  s_mul_i32 s22, s21, 32768
  s_add_u32 s22, s22, 174063616
  s_lshl_b32 s23, s16, 10
  v_add_u32 v2, s23, v1
  s_mul_i32 s29, s16, 5120
  s_add_u32 m0, s29, 0
  s_nop 0
  buffer_load_dwordx4 v2, s[4:7], s24 offen lds
  s_add_u32 m0, s29, 1024
  s_nop 0
  buffer_load_dwordx4 v2, s[4:7], s25 offen lds
  s_add_u32 m0, s29, 2048
  s_nop 0
  buffer_load_dwordx4 v2, s[4:7], s26 offen lds
  s_add_u32 m0, s29, 3072
  s_nop 0
  buffer_load_dwordx4 v2, s[4:7], s27 offen lds
  s_add_u32 m0, s29, 4096
  s_nop 0
  buffer_load_dwordx4 v2, s[4:7], s28 offen lds
  buffer_load_dwordx4 v[32:35], v1, s[4:7], s22 offen offset:0
  buffer_load_dwordx4 v[36:39], v1, s[4:7], s22 offen offset:1024
  buffer_load_dwordx4 v[40:43], v1, s[4:7], s22 offen offset:2048
  buffer_load_dwordx4 v[44:47], v1, s[4:7], s22 offen offset:3072
  v_add_u32 v2, 0x1000, v2
  s_add_u32 s22, s22, 4096
  s_add_u32 m0, s29, 20480
  s_nop 0
  buffer_load_dwordx4 v2, s[4:7], s24 offen lds
  s_add_u32 m0, s29, 21504
  s_nop 0
  buffer_load_dwordx4 v2, s[4:7], s25 offen lds
  s_add_u32 m0, s29, 22528
  s_nop 0
  buffer_load_dwordx4 v2, s[4:7], s26 offen lds
  s_add_u32 m0, s29, 23552
  s_nop 0
  buffer_load_dwordx4 v2, s[4:7], s27 offen lds
  s_add_u32 m0, s29, 24576
  s_nop 0
  buffer_load_dwordx4 v2, s[4:7], s28 offen lds
  buffer_load_dwordx4 v[48:51], v1, s[4:7], s22 offen offset:0
  buffer_load_dwordx4 v[52:55], v1, s[4:7], s22 offen offset:1024
  buffer_load_dwordx4 v[56:59], v1, s[4:7], s22 offen offset:2048
  buffer_load_dwordx4 v[60:63], v1, s[4:7], s22 offen offset:3072
  v_add_u32 v2, 0x1000, v2
  s_add_u32 s22, s22, 4096
  s_waitcnt vmcnt(9)
  s_barrier
  s_add_u32 m0, s29, 40960
  s_nop 0
  buffer_load_dwordx4 v2, s[4:7], s24 offen lds
  s_add_u32 m0, s29, 41984
  s_nop 0
  buffer_load_dwordx4 v2, s[4:7], s25 offen lds
  s_add_u32 m0, s29, 43008
  s_nop 0
  buffer_load_dwordx4 v2, s[4:7], s26 offen lds
  s_add_u32 m0, s29, 44032
  s_nop 0
  buffer_load_dwordx4 v2, s[4:7], s27 offen lds
  s_add_u32 m0, s29, 45056
  s_nop 0
  buffer_load_dwordx4 v2, s[4:7], s28 offen lds
  buffer_load_dwordx4 v[64:67], v1, s[4:7], s22 offen offset:0
  buffer_load_dwordx4 v[68:71], v1, s[4:7], s22 offen offset:1024
  buffer_load_dwordx4 v[72:75], v1, s[4:7], s22 offen offset:2048
  buffer_load_dwordx4 v[76:79], v1, s[4:7], s22 offen offset:3072
  v_add_u32 v2, 0x1000, v2
  s_add_u32 s22, s22, 4096
  ds_read_b128 v[80:83], v1 offset:0
  ds_read_b128 v[84:87], v1 offset:1024
  ds_read_b128 v[88:91], v1 offset:2048
  ds_read_b128 v[92:95], v1 offset:3072
  ds_read_b128 v[96:99], v1 offset:4096
  ds_read_b128 v[100:103], v1 offset:5120
  ds_read_b128 v[104:107], v1 offset:6144
  ds_read_b128 v[108:111], v1 offset:7168
  ds_read_b128 v[112:115], v1 offset:8192
  ds_read_b128 v[116:119], v1 offset:9216
  s_waitcnt lgkmcnt(5)
  v_mfma_f32_16x16x32_bf16 v[8:11], v[80:83], v[32:35], 0
  v_mfma_f32_16x16x32_bf16 v[12:15], v[84:87], v[32:35], 0
  v_mfma_f32_16x16x32_bf16 v[16:19], v[88:91], v[32:35], 0
  v_mfma_f32_16x16x32_bf16 v[20:23], v[92:95], v[32:35], 0
  v_mfma_f32_16x16x32_bf16 v[24:27], v[96:99], v[32:35], 0
  ds_read_b128 v[80:83], v1 offset:10240
  ds_read_b128 v[84:87], v1 offset:11264
  ds_read_b128 v[88:91], v1 offset:12288
  ds_read_b128 v[92:95], v1 offset:13312
  ds_read_b128 v[96:99], v1 offset:14336
  s_waitcnt lgkmcnt(5)
  v_mfma_f32_16x16x32_bf16 v[8:11], v[100:103], v[36:39], v[8:11]
  v_mfma_f32_16x16x32_bf16 v[12:15], v[104:107], v[36:39], v[12:15]
  v_mfma_f32_16x16x32_bf16 v[16:19], v[108:111], v[36:39], v[16:19]
  v_mfma_f32_16x16x32_bf16 v[20:23], v[112:115], v[36:39], v[20:23]
  v_mfma_f32_16x16x32_bf16 v[24:27], v[116:119], v[36:39], v[24:27]
  ds_read_b128 v[100:103], v1 offset:15360
  ds_read_b128 v[104:107], v1 offset:16384
  ds_read_b128 v[108:111], v1 offset:17408
  ds_read_b128 v[112:115], v1 offset:18432
  ds_read_b128 v[116:119], v1 offset:19456
  s_waitcnt lgkmcnt(5)
  v_mfma_f32_16x16x32_bf16 v[8:11], v[80:83], v[40:43], v[8:11]
  v_mfma_f32_16x16x32_bf16 v[12:15], v[84:87], v[40:43], v[12:15]
  v_mfma_f32_16x16x32_bf16 v[16:19], v[88:91], v[40:43], v[16:19]
  v_mfma_f32_16x16x32_bf16 v[20:23], v[92:95], v[40:43], v[20:23]
  v_mfma_f32_16x16x32_bf16 v[24:27], v[96:99], v[40:43], v[24:27]
  s_waitcnt lgkmcnt(0)
  v_mfma_f32_16x16x32_bf16 v[8:11], v[100:103], v[44:47], v[8:11]
  v_mfma_f32_16x16x32_bf16 v[12:15], v[104:107], v[44:47], v[12:15]
  v_mfma_f32_16x16x32_bf16 v[16:19], v[108:111], v[44:47], v[16:19]
  v_mfma_f32_16x16x32_bf16 v[20:23], v[112:115], v[44:47], v[20:23]
  v_mfma_f32_16x16x32_bf16 v[24:27], v[116:119], v[44:47], v[24:27]
  s_mov_b32 s30, 0
outb1_loop2:
  s_waitcnt vmcnt(9)
  s_barrier
  s_add_u32 m0, s29, 0
  s_nop 0
  buffer_load_dwordx4 v2, s[4:7], s24 offen lds
  s_add_u32 m0, s29, 1024
  s_nop 0
  buffer_load_dwordx4 v2, s[4:7], s25 offen lds
  s_add_u32 m0, s29, 2048
  s_nop 0
  buffer_load_dwordx4 v2, s[4:7], s26 offen lds
  s_add_u32 m0, s29, 3072
  s_nop 0
  buffer_load_dwordx4 v2, s[4:7], s27 offen lds
  s_add_u32 m0, s29, 4096
  s_nop 0
  buffer_load_dwordx4 v2, s[4:7], s28 offen lds
  buffer_load_dwordx4 v[32:35], v1, s[4:7], s22 offen offset:0
  buffer_load_dwordx4 v[36:39], v1, s[4:7], s22 offen offset:1024
  buffer_load_dwordx4 v[40:43], v1, s[4:7], s22 offen offset:2048
  buffer_load_dwordx4 v[44:47], v1, s[4:7], s22 offen offset:3072
  v_add_u32 v2, 0x1000, v2
  s_add_u32 s22, s22, 4096
  ds_read_b128 v[80:83], v1 offset:20480
  ds_read_b128 v[84:87], v1 offset:21504
  ds_read_b128 v[88:91], v1 offset:22528
  ds_read_b128 v[92:95], v1 offset:23552
  ds_read_b128 v[96:99], v1 offset:24576
  ds_read_b128 v[100:103], v1 offset:25600
  ds_read_b128 v[104:107], v1 offset:26624
  ds_read_b128 v[108:111], v1 offset:27648
  ds_read_b128 v[112:115], v1 offset:28672
  ds_read_b128 v[116:119], v1 offset:29696
  s_waitcnt lgkmcnt(5)
  v_mfma_f32_16x16x32_bf16 v[8:11], v[80:83], v[48:51], v[8:11]
  v_mfma_f32_16x16x32_bf16 v[12:15], v[84:87], v[48:51], v[12:15]
  v_mfma_f32_16x16x32_bf16 v[16:19], v[88:91], v[48:51], v[16:19]
  v_mfma_f32_16x16x32_bf16 v[20:23], v[92:95], v[48:51], v[20:23]
  v_mfma_f32_16x16x32_bf16 v[24:27], v[96:99], v[48:51], v[24:27]
  ds_read_b128 v[80:83], v1 offset:30720
  ds_read_b128 v[84:87], v1 offset:31744
  ds_read_b128 v[88:91], v1 offset:32768
  ds_read_b128 v[92:95], v1 offset:33792
  ds_read_b128 v[96:99], v1 offset:34816
  s_waitcnt lgkmcnt(5)
  v_mfma_f32_16x16x32_bf16 v[8:11], v[100:103], v[52:55], v[8:11]
  v_mfma_f32_16x16x32_bf16 v[12:15], v[104:107], v[52:55], v[12:15]
  v_mfma_f32_16x16x32_bf16 v[16:19], v[108:111], v[52:55], v[16:19]
  v_mfma_f32_16x16x32_bf16 v[20:23], v[112:115], v[52:55], v[20:23]
  v_mfma_f32_16x16x32_bf16 v[24:27], v[116:119], v[52:55], v[24:27]
  ds_read_b128 v[100:103], v1 offset:35840
  ds_read_b128 v[104:107], v1 offset:36864
  ds_read_b128 v[108:111], v1 offset:37888
  ds_read_b128 v[112:115], v1 offset:38912
  ds_read_b128 v[116:119], v1 offset:39936
  s_waitcnt lgkmcnt(5)
  v_mfma_f32_16x16x32_bf16 v[8:11], v[80:83], v[56:59], v[8:11]
  v_mfma_f32_16x16x32_bf16 v[12:15], v[84:87], v[56:59], v[12:15]
  v_mfma_f32_16x16x32_bf16 v[16:19], v[88:91], v[56:59], v[16:19]
  v_mfma_f32_16x16x32_bf16 v[20:23], v[92:95], v[56:59], v[20:23]
  v_mfma_f32_16x16x32_bf16 v[24:27], v[96:99], v[56:59], v[24:27]
  s_waitcnt lgkmcnt(0)
  v_mfma_f32_16x16x32_bf16 v[8:11], v[100:103], v[60:63], v[8:11]
  v_mfma_f32_16x16x32_bf16 v[12:15], v[104:107], v[60:63], v[12:15]
  v_mfma_f32_16x16x32_bf16 v[16:19], v[108:111], v[60:63], v[16:19]
  v_mfma_f32_16x16x32_bf16 v[20:23], v[112:115], v[60:63], v[20:23]
  v_mfma_f32_16x16x32_bf16 v[24:27], v[116:119], v[60:63], v[24:27]
  s_waitcnt vmcnt(9)
  s_barrier
  s_add_u32 m0, s29, 20480
  s_nop 0
  buffer_load_dwordx4 v2, s[4:7], s24 offen lds
  s_add_u32 m0, s29, 21504
  s_nop 0
  buffer_load_dwordx4 v2, s[4:7], s25 offen lds
  s_add_u32 m0, s29, 22528
  s_nop 0
  buffer_load_dwordx4 v2, s[4:7], s26 offen lds
  s_add_u32 m0, s29, 23552
  s_nop 0
  buffer_load_dwordx4 v2, s[4:7], s27 offen lds
  s_add_u32 m0, s29, 24576
  s_nop 0
  buffer_load_dwordx4 v2, s[4:7], s28 offen lds
  buffer_load_dwordx4 v[48:51], v1, s[4:7], s22 offen offset:0
  buffer_load_dwordx4 v[52:55], v1, s[4:7], s22 offen offset:1024
  buffer_load_dwordx4 v[56:59], v1, s[4:7], s22 offen offset:2048
  buffer_load_dwordx4 v[60:63], v1, s[4:7], s22 offen offset:3072
  v_add_u32 v2, 0x1000, v2
  s_add_u32 s22, s22, 4096
  ds_read_b128 v[80:83], v1 offset:40960
  ds_read_b128 v[84:87], v1 offset:41984
  ds_read_b128 v[88:91], v1 offset:43008
  ds_read_b128 v[92:95], v1 offset:44032
  ds_read_b128 v[96:99], v1 offset:45056
  ds_read_b128 v[100:103], v1 offset:46080
  ds_read_b128 v[104:107], v1 offset:47104
  ds_read_b128 v[108:111], v1 offset:48128
  ds_read_b128 v[112:115], v1 offset:49152
  ds_read_b128 v[116:119], v1 offset:50176
  s_waitcnt lgkmcnt(5)
  v_mfma_f32_16x16x32_bf16 v[8:11], v[80:83], v[64:67], v[8:11]
  v_mfma_f32_16x16x32_bf16 v[12:15], v[84:87], v[64:67], v[12:15]
  v_mfma_f32_16x16x32_bf16 v[16:19], v[88:91], v[64:67], v[16:19]
  v_mfma_f32_16x16x32_bf16 v[20:23], v[92:95], v[64:67], v[20:23]
  v_mfma_f32_16x16x32_bf16 v[24:27], v[96:99], v[64:67], v[24:27]
  ds_read_b128 v[80:83], v1 offset:51200
  ds_read_b128 v[84:87], v1 offset:52224
  ds_read_b128 v[88:91], v1 offset:53248
  ds_read_b128 v[92:95], v1 offset:54272
  ds_read_b128 v[96:99], v1 offset:55296
  s_waitcnt lgkmcnt(5)
  v_mfma_f32_16x16x32_bf16 v[8:11], v[100:103], v[68:71], v[8:11]
  v_mfma_f32_16x16x32_bf16 v[12:15], v[104:107], v[68:71], v[12:15]
  v_mfma_f32_16x16x32_bf16 v[16:19], v[108:111], v[68:71], v[16:19]
  v_mfma_f32_16x16x32_bf16 v[20:23], v[112:115], v[68:71], v[20:23]
  v_mfma_f32_16x16x32_bf16 v[24:27], v[116:119], v[68:71], v[24:27]
  ds_read_b128 v[100:103], v1 offset:56320
  ds_read_b128 v[104:107], v1 offset:57344
  ds_read_b128 v[108:111], v1 offset:58368
  ds_read_b128 v[112:115], v1 offset:59392
  ds_read_b128 v[116:119], v1 offset:60416
  s_waitcnt lgkmcnt(5)
  v_mfma_f32_16x16x32_bf16 v[8:11], v[80:83], v[72:75], v[8:11]
  v_mfma_f32_16x16x32_bf16 v[12:15], v[84:87], v[72:75], v[12:15]
  v_mfma_f32_16x16x32_bf16 v[16:19], v[88:91], v[72:75], v[16:19]
  v_mfma_f32_16x16x32_bf16 v[20:23], v[92:95], v[72:75], v[20:23]
  v_mfma_f32_16x16x32_bf16 v[24:27], v[96:99], v[72:75], v[24:27]
  s_waitcnt lgkmcnt(0)
  v_mfma_f32_16x16x32_bf16 v[8:11], v[100:103], v[76:79], v[8:11]
  v_mfma_f32_16x16x32_bf16 v[12:15], v[104:107], v[76:79], v[12:15]
  v_mfma_f32_16x16x32_bf16 v[16:19], v[108:111], v[76:79], v[16:19]
  v_mfma_f32_16x16x32_bf16 v[20:23], v[112:115], v[76:79], v[20:23]
  v_mfma_f32_16x16x32_bf16 v[24:27], v[116:119], v[76:79], v[24:27]
  s_waitcnt vmcnt(9)
  s_barrier
  s_add_u32 m0, s29, 40960
  s_nop 0
  buffer_load_dwordx4 v2, s[4:7], s24 offen lds
  s_add_u32 m0, s29, 41984
  s_nop 0
  buffer_load_dwordx4 v2, s[4:7], s25 offen lds
  s_add_u32 m0, s29, 43008
  s_nop 0
  buffer_load_dwordx4 v2, s[4:7], s26 offen lds
  s_add_u32 m0, s29, 44032
  s_nop 0
  buffer_load_dwordx4 v2, s[4:7], s27 offen lds
  s_add_u32 m0, s29, 45056
  s_nop 0
  buffer_load_dwordx4 v2, s[4:7], s28 offen lds
  buffer_load_dwordx4 v[64:67], v1, s[4:7], s22 offen offset:0
  buffer_load_dwordx4 v[68:71], v1, s[4:7], s22 offen offset:1024
  buffer_load_dwordx4 v[72:75], v1, s[4:7], s22 offen offset:2048
  buffer_load_dwordx4 v[76:79], v1, s[4:7], s22 offen offset:3072
  v_add_u32 v2, 0x1000, v2
  s_add_u32 s22, s22, 4096
  ds_read_b128 v[80:83], v1 offset:0
  ds_read_b128 v[84:87], v1 offset:1024
  ds_read_b128 v[88:91], v1 offset:2048
  ds_read_b128 v[92:95], v1 offset:3072
  ds_read_b128 v[96:99], v1 offset:4096
  ds_read_b128 v[100:103], v1 offset:5120
  ds_read_b128 v[104:107], v1 offset:6144
  ds_read_b128 v[108:111], v1 offset:7168
  ds_read_b128 v[112:115], v1 offset:8192
  ds_read_b128 v[116:119], v1 offset:9216
  s_waitcnt lgkmcnt(5)
  v_mfma_f32_16x16x32_bf16 v[8:11], v[80:83], v[32:35], v[8:11]
  v_mfma_f32_16x16x32_bf16 v[12:15], v[84:87], v[32:35], v[12:15]
  v_mfma_f32_16x16x32_bf16 v[16:19], v[88:91], v[32:35], v[16:19]
  v_mfma_f32_16x16x32_bf16 v[20:23], v[92:95], v[32:35], v[20:23]
  v_mfma_f32_16x16x32_bf16 v[24:27], v[96:99], v[32:35], v[24:27]
  ds_read_b128 v[80:83], v1 offset:10240
  ds_read_b128 v[84:87], v1 offset:11264
  ds_read_b128 v[88:91], v1 offset:12288
  ds_read_b128 v[92:95], v1 offset:13312
  ds_read_b128 v[96:99], v1 offset:14336
  s_waitcnt lgkmcnt(5)
  v_mfma_f32_16x16x32_bf16 v[8:11], v[100:103], v[36:39], v[8:11]
  v_mfma_f32_16x16x32_bf16 v[12:15], v[104:107], v[36:39], v[12:15]
  v_mfma_f32_16x16x32_bf16 v[16:19], v[108:111], v[36:39], v[16:19]
  v_mfma_f32_16x16x32_bf16 v[20:23], v[112:115], v[36:39], v[20:23]
  v_mfma_f32_16x16x32_bf16 v[24:27], v[116:119], v[36:39], v[24:27]
  ds_read_b128 v[100:103], v1 offset:15360
  ds_read_b128 v[104:107], v1 offset:16384
  ds_read_b128 v[108:111], v1 offset:17408
  ds_read_b128 v[112:115], v1 offset:18432
  ds_read_b128 v[116:119], v1 offset:19456
  s_waitcnt lgkmcnt(5)
  v_mfma_f32_16x16x32_bf16 v[8:11], v[80:83], v[40:43], v[8:11]
  v_mfma_f32_16x16x32_bf16 v[12:15], v[84:87], v[40:43], v[12:15]
  v_mfma_f32_16x16x32_bf16 v[16:19], v[88:91], v[40:43], v[16:19]
  v_mfma_f32_16x16x32_bf16 v[20:23], v[92:95], v[40:43], v[20:23]
  v_mfma_f32_16x16x32_bf16 v[24:27], v[96:99], v[40:43], v[24:27]
  s_waitcnt lgkmcnt(0)
  v_mfma_f32_16x16x32_bf16 v[8:11], v[100:103], v[44:47], v[8:11]
  v_mfma_f32_16x16x32_bf16 v[12:15], v[104:107], v[44:47], v[12:15]
  v_mfma_f32_16x16x32_bf16 v[16:19], v[108:111], v[44:47], v[16:19]
  v_mfma_f32_16x16x32_bf16 v[20:23], v[112:115], v[44:47], v[20:23]
  v_mfma_f32_16x16x32_bf16 v[24:27], v[116:119], v[44:47], v[24:27]
  s_add_u32 s30, s30, 1
  s_cmp_lt_u32 s30, 1
  s_cbranch_scc1 outb1_loop2
  s_waitcnt vmcnt(9)
  s_barrier
  s_add_u32 m0, s29, 0
  s_nop 0
  buffer_load_dwordx4 v2, s[4:7], s24 offen lds
  s_add_u32 m0, s29, 1024
  s_nop 0
  buffer_load_dwordx4 v2, s[4:7], s25 offen lds
  s_add_u32 m0, s29, 2048
  s_nop 0
  buffer_load_dwordx4 v2, s[4:7], s26 offen lds
  s_add_u32 m0, s29, 3072
  s_nop 0
  buffer_load_dwordx4 v2, s[4:7], s27 offen lds
  s_add_u32 m0, s29, 4096
  s_nop 0
  buffer_load_dwordx4 v2, s[4:7], s28 offen lds
  buffer_load_dwordx4 v[32:35], v1, s[4:7], s22 offen offset:0
  buffer_load_dwordx4 v[36:39], v1, s[4:7], s22 offen offset:1024
  buffer_load_dwordx4 v[40:43], v1, s[4:7], s22 offen offset:2048
  buffer_load_dwordx4 v[44:47], v1, s[4:7], s22 offen offset:3072
  v_add_u32 v2, 0x1000, v2
  s_add_u32 s22, s22, 4096
  ds_read_b128 v[80:83], v1 offset:20480
  ds_read_b128 v[84:87], v1 offset:21504
  ds_read_b128 v[88:91], v1 offset:22528
  ds_read_b128 v[92:95], v1 offset:23552
  ds_read_b128 v[96:99], v1 offset:24576
  ds_read_b128 v[100:103], v1 offset:25600
  ds_read_b128 v[104:107], v1 offset:26624
  ds_read_b128 v[108:111], v1 offset:27648
  ds_read_b128 v[112:115], v1 offset:28672
  ds_read_b128 v[116:119], v1 offset:29696
  s_waitcnt lgkmcnt(5)
  v_mfma_f32_16x16x32_bf16 v[8:11], v[80:83], v[48:51], v[8:11]
  v_mfma_f32_16x16x32_bf16 v[12:15], v[84:87], v[48:51], v[12:15]
  v_mfma_f32_16x16x32_bf16 v[16:19], v[88:91], v[48:51], v[16:19]
  v_mfma_f32_16x16x32_bf16 v[20:23], v[92:95], v[48:51], v[20:23]
  v_mfma_f32_16x16x32_bf16 v[24:27], v[96:99], v[48:51], v[24:27]
  ds_read_b128 v[80:83], v1 offset:30720
  ds_read_b128 v[84:87], v1 offset:31744
  ds_read_b128 v[88:91], v1 offset:32768
  ds_read_b128 v[92:95], v1 offset:33792
  ds_read_b128 v[96:99], v1 offset:34816
  s_waitcnt lgkmcnt(5)
  v_mfma_f32_16x16x32_bf16 v[8:11], v[100:103], v[52:55], v[8:11]
  v_mfma_f32_16x16x32_bf16 v[12:15], v[104:107], v[52:55], v[12:15]
  v_mfma_f32_16x16x32_bf16 v[16:19], v[108:111], v[52:55], v[16:19]
  v_mfma_f32_16x16x32_bf16 v[20:23], v[112:115], v[52:55], v[20:23]
  v_mfma_f32_16x16x32_bf16 v[24:27], v[116:119], v[52:55], v[24:27]
  ds_read_b128 v[100:103], v1 offset:35840
  ds_read_b128 v[104:107], v1 offset:36864
  ds_read_b128 v[108:111], v1 offset:37888
  ds_read_b128 v[112:115], v1 offset:38912
  ds_read_b128 v[116:119], v1 offset:39936
  s_waitcnt lgkmcnt(5)
  v_mfma_f32_16x16x32_bf16 v[8:11], v[80:83], v[56:59], v[8:11]
  v_mfma_f32_16x16x32_bf16 v[12:15], v[84:87], v[56:59], v[12:15]
  v_mfma_f32_16x16x32_bf16 v[16:19], v[88:91], v[56:59], v[16:19]
  v_mfma_f32_16x16x32_bf16 v[20:23], v[92:95], v[56:59], v[20:23]
  v_mfma_f32_16x16x32_bf16 v[24:27], v[96:99], v[56:59], v[24:27]
  s_waitcnt lgkmcnt(0)
  v_mfma_f32_16x16x32_bf16 v[8:11], v[100:103], v[60:63], v[8:11]
  v_mfma_f32_16x16x32_bf16 v[12:15], v[104:107], v[60:63], v[12:15]
  v_mfma_f32_16x16x32_bf16 v[16:19], v[108:111], v[60:63], v[16:19]
  v_mfma_f32_16x16x32_bf16 v[20:23], v[112:115], v[60:63], v[20:23]
  v_mfma_f32_16x16x32_bf16 v[24:27], v[116:119], v[60:63], v[24:27]
  s_waitcnt vmcnt(9)
  s_barrier
  s_add_u32 m0, s29, 20480
  s_nop 0
  buffer_load_dwordx4 v2, s[4:7], s24 offen lds
  s_add_u32 m0, s29, 21504
  s_nop 0
  buffer_load_dwordx4 v2, s[4:7], s25 offen lds
  s_add_u32 m0, s29, 22528
  s_nop 0
  buffer_load_dwordx4 v2, s[4:7], s26 offen lds
  s_add_u32 m0, s29, 23552
  s_nop 0
  buffer_load_dwordx4 v2, s[4:7], s27 offen lds
  s_add_u32 m0, s29, 24576
  s_nop 0
  buffer_load_dwordx4 v2, s[4:7], s28 offen lds
  buffer_load_dwordx4 v[48:51], v1, s[4:7], s22 offen offset:0
  buffer_load_dwordx4 v[52:55], v1, s[4:7], s22 offen offset:1024
  buffer_load_dwordx4 v[56:59], v1, s[4:7], s22 offen offset:2048
  buffer_load_dwordx4 v[60:63], v1, s[4:7], s22 offen offset:3072
  v_add_u32 v2, 0x1000, v2
  s_add_u32 s22, s22, 4096
  ds_read_b128 v[80:83], v1 offset:40960
  ds_read_b128 v[84:87], v1 offset:41984
  ds_read_b128 v[88:91], v1 offset:43008
  ds_read_b128 v[92:95], v1 offset:44032
  ds_read_b128 v[96:99], v1 offset:45056
  ds_read_b128 v[100:103], v1 offset:46080
  ds_read_b128 v[104:107], v1 offset:47104
  ds_read_b128 v[108:111], v1 offset:48128
  ds_read_b128 v[112:115], v1 offset:49152
  ds_read_b128 v[116:119], v1 offset:50176
  s_waitcnt lgkmcnt(5)
  v_mfma_f32_16x16x32_bf16 v[8:11], v[80:83], v[64:67], v[8:11]
  v_mfma_f32_16x16x32_bf16 v[12:15], v[84:87], v[64:67], v[12:15]
  v_mfma_f32_16x16x32_bf16 v[16:19], v[88:91], v[64:67], v[16:19]
  v_mfma_f32_16x16x32_bf16 v[20:23], v[92:95], v[64:67], v[20:23]
  v_mfma_f32_16x16x32_bf16 v[24:27], v[96:99], v[64:67], v[24:27]
  ds_read_b128 v[80:83], v1 offset:51200
  ds_read_b128 v[84:87], v1 offset:52224
  ds_read_b128 v[88:91], v1 offset:53248
  ds_read_b128 v[92:95], v1 offset:54272
  ds_read_b128 v[96:99], v1 offset:55296
  s_waitcnt lgkmcnt(5)
  v_mfma_f32_16x16x32_bf16 v[8:11], v[100:103], v[68:71], v[8:11]
  v_mfma_f32_16x16x32_bf16 v[12:15], v[104:107], v[68:71], v[12:15]
  v_mfma_f32_16x16x32_bf16 v[16:19], v[108:111], v[68:71], v[16:19]
  v_mfma_f32_16x16x32_bf16 v[20:23], v[112:115], v[68:71], v[20:23]
  v_mfma_f32_16x16x32_bf16 v[24:27], v[116:119], v[68:71], v[24:27]
  ds_read_b128 v[100:103], v1 offset:56320
  ds_read_b128 v[104:107], v1 offset:57344
  ds_read_b128 v[108:111], v1 offset:58368
  ds_read_b128 v[112:115], v1 offset:59392
  ds_read_b128 v[116:119], v1 offset:60416
  s_waitcnt lgkmcnt(5)
  v_mfma_f32_16x16x32_bf16 v[8:11], v[80:83], v[72:75], v[8:11]
  v_mfma_f32_16x16x32_bf16 v[12:15], v[84:87], v[72:75], v[12:15]
  v_mfma_f32_16x16x32_bf16 v[16:19], v[88:91], v[72:75], v[16:19]
  v_mfma_f32_16x16x32_bf16 v[20:23], v[92:95], v[72:75], v[20:23]
  v_mfma_f32_16x16x32_bf16 v[24:27], v[96:99], v[72:75], v[24:27]
  s_waitcnt lgkmcnt(0)
  v_mfma_f32_16x16x32_bf16 v[8:11], v[100:103], v[76:79], v[8:11]
  v_mfma_f32_16x16x32_bf16 v[12:15], v[104:107], v[76:79], v[12:15]
  v_mfma_f32_16x16x32_bf16 v[16:19], v[108:111], v[76:79], v[16:19]
  v_mfma_f32_16x16x32_bf16 v[20:23], v[112:115], v[76:79], v[20:23]
  v_mfma_f32_16x16x32_bf16 v[24:27], v[116:119], v[76:79], v[24:27]
  s_waitcnt vmcnt(9)
  s_barrier
  ds_read_b128 v[80:83], v1 offset:0
  ds_read_b128 v[84:87], v1 offset:1024
  ds_read_b128 v[88:91], v1 offset:2048
  ds_read_b128 v[92:95], v1 offset:3072
  ds_read_b128 v[96:99], v1 offset:4096
  ds_read_b128 v[100:103], v1 offset:5120
  ds_read_b128 v[104:107], v1 offset:6144
  ds_read_b128 v[108:111], v1 offset:7168
  ds_read_b128 v[112:115], v1 offset:8192
  ds_read_b128 v[116:119], v1 offset:9216
  s_waitcnt lgkmcnt(5)
  v_mfma_f32_16x16x32_bf16 v[8:11], v[80:83], v[32:35], v[8:11]
  v_mfma_f32_16x16x32_bf16 v[12:15], v[84:87], v[32:35], v[12:15]
  v_mfma_f32_16x16x32_bf16 v[16:19], v[88:91], v[32:35], v[16:19]
  v_mfma_f32_16x16x32_bf16 v[20:23], v[92:95], v[32:35], v[20:23]
  v_mfma_f32_16x16x32_bf16 v[24:27], v[96:99], v[32:35], v[24:27]
  ds_read_b128 v[80:83], v1 offset:10240
  ds_read_b128 v[84:87], v1 offset:11264
  ds_read_b128 v[88:91], v1 offset:12288
  ds_read_b128 v[92:95], v1 offset:13312
  ds_read_b128 v[96:99], v1 offset:14336
  s_waitcnt lgkmcnt(5)
  v_mfma_f32_16x16x32_bf16 v[8:11], v[100:103], v[36:39], v[8:11]
  v_mfma_f32_16x16x32_bf16 v[12:15], v[104:107], v[36:39], v[12:15]
  v_mfma_f32_16x16x32_bf16 v[16:19], v[108:111], v[36:39], v[16:19]
  v_mfma_f32_16x16x32_bf16 v[20:23], v[112:115], v[36:39], v[20:23]
  v_mfma_f32_16x16x32_bf16 v[24:27], v[116:119], v[36:39], v[24:27]
  ds_read_b128 v[100:103], v1 offset:15360
  ds_read_b128 v[104:107], v1 offset:16384
  ds_read_b128 v[108:111], v1 offset:17408
  ds_read_b128 v[112:115], v1 offset:18432
  ds_read_b128 v[116:119], v1 offset:19456
  s_waitcnt lgkmcnt(5)
  v_mfma_f32_16x16x32_bf16 v[8:11], v[80:83], v[40:43], v[8:11]
  v_mfma_f32_16x16x32_bf16 v[12:15], v[84:87], v[40:43], v[12:15]
  v_mfma_f32_16x16x32_bf16 v[16:19], v[88:91], v[40:43], v[16:19]
  v_mfma_f32_16x16x32_bf16 v[20:23], v[92:95], v[40:43], v[20:23]
  v_mfma_f32_16x16x32_bf16 v[24:27], v[96:99], v[40:43], v[24:27]
  s_waitcnt lgkmcnt(0)
  v_mfma_f32_16x16x32_bf16 v[8:11], v[100:103], v[44:47], v[8:11]
  v_mfma_f32_16x16x32_bf16 v[12:15], v[104:107], v[44:47], v[12:15]
  v_mfma_f32_16x16x32_bf16 v[16:19], v[108:111], v[44:47], v[16:19]
  v_mfma_f32_16x16x32_bf16 v[20:23], v[112:115], v[44:47], v[20:23]
  v_mfma_f32_16x16x32_bf16 v[24:27], v[116:119], v[44:47], v[24:27]
  s_waitcnt vmcnt(0)
  s_barrier
  ds_read_b128 v[80:83], v1 offset:20480
  ds_read_b128 v[84:87], v1 offset:21504
  ds_read_b128 v[88:91], v1 offset:22528
  ds_read_b128 v[92:95], v1 offset:23552
  ds_read_b128 v[96:99], v1 offset:24576
  ds_read_b128 v[100:103], v1 offset:25600
  ds_read_b128 v[104:107], v1 offset:26624
  ds_read_b128 v[108:111], v1 offset:27648
  ds_read_b128 v[112:115], v1 offset:28672
  ds_read_b128 v[116:119], v1 offset:29696
  s_waitcnt lgkmcnt(5)
  v_mfma_f32_16x16x32_bf16 v[8:11], v[80:83], v[48:51], v[8:11]
  v_mfma_f32_16x16x32_bf16 v[12:15], v[84:87], v[48:51], v[12:15]
  v_mfma_f32_16x16x32_bf16 v[16:19], v[88:91], v[48:51], v[16:19]
  v_mfma_f32_16x16x32_bf16 v[20:23], v[92:95], v[48:51], v[20:23]
  v_mfma_f32_16x16x32_bf16 v[24:27], v[96:99], v[48:51], v[24:27]
  ds_read_b128 v[80:83], v1 offset:30720
  ds_read_b128 v[84:87], v1 offset:31744
  ds_read_b128 v[88:91], v1 offset:32768
  ds_read_b128 v[92:95], v1 offset:33792
  ds_read_b128 v[96:99], v1 offset:34816
  s_waitcnt lgkmcnt(5)
  v_mfma_f32_16x16x32_bf16 v[8:11], v[100:103], v[52:55], v[8:11]
  v_mfma_f32_16x16x32_bf16 v[12:15], v[104:107], v[52:55], v[12:15]
  v_mfma_f32_16x16x32_bf16 v[16:19], v[108:111], v[52:55], v[16:19]
  v_mfma_f32_16x16x32_bf16 v[20:23], v[112:115], v[52:55], v[20:23]
  v_mfma_f32_16x16x32_bf16 v[24:27], v[116:119], v[52:55], v[24:27]
  ds_read_b128 v[100:103], v1 offset:35840
  ds_read_b128 v[104:107], v1 offset:36864
  ds_read_b128 v[108:111], v1 offset:37888
  ds_read_b128 v[112:115], v1 offset:38912
  ds_read_b128 v[116:119], v1 offset:39936
  s_waitcnt lgkmcnt(5)
  v_mfma_f32_16x16x32_bf16 v[8:11], v[80:83], v[56:59], v[8:11]
  v_mfma_f32_16x16x32_bf16 v[12:15], v[84:87], v[56:59], v[12:15]
  v_mfma_f32_16x16x32_bf16 v[16:19], v[88:91], v[56:59], v[16:19]
  v_mfma_f32_16x16x32_bf16 v[20:23], v[92:95], v[56:59], v[20:23]
  v_mfma_f32_16x16x32_bf16 v[24:27], v[96:99], v[56:59], v[24:27]
  s_waitcnt lgkmcnt(0)
  v_mfma_f32_16x16x32_bf16 v[8:11], v[100:103], v[60:63], v[8:11]
  v_mfma_f32_16x16x32_bf16 v[12:15], v[104:107], v[60:63], v[12:15]
  v_mfma_f32_16x16x32_bf16 v[16:19], v[108:111], v[60:63], v[16:19]
  v_mfma_f32_16x16x32_bf16 v[20:23], v[112:115], v[60:63], v[20:23]
  v_mfma_f32_16x16x32_bf16 v[24:27], v[116:119], v[60:63], v[24:27]
  v_and_b32 v3, 63, v0
  v_and_b32 v4, 15, v3
  v_lshrrev_b32 v3, 4, v3
  s_lshl_b32 s21, s17, 6
  s_lshl_b32 s23, s16, 4
  s_add_u32 s21, s21, s23
  v_add_u32 v4, s21, v4
  v_mul_u32_u24 v6, 1280, v4
  v_lshl_add_u32 v6, v3, 4, v6
  s_mul_i32 s21, s18, 5
  s_add_u32 s23, s21, 0
  s_lshr_b32 s31, s23, 1
  s_lshl_b32 s31, s31, 6
  s_and_b32 s23, s23, 1
  s_lshl_b32 s23, s23, 3
  s_add_u32 s32, s31, s23
  s_add_u32 s40, s32, s20
  buffer_load_dwordx2 v[32:33], v6, s[8:11], s40 offen
  s_add_u32 s23, s21, 1
  s_lshr_b32 s31, s23, 1
  s_lshl_b32 s31, s31, 6
  s_and_b32 s23, s23, 1
  s_lshl_b32 s23, s23, 3
  s_add_u32 s33, s31, s23
  s_add_u32 s41, s33, s20
  buffer_load_dwordx2 v[34:35], v6, s[8:11], s41 offen
  s_add_u32 s23, s21, 2
  s_lshr_b32 s31, s23, 1
  s_lshl_b32 s31, s31, 6
  s_and_b32 s23, s23, 1
  s_lshl_b32 s23, s23, 3
  s_add_u32 s34, s31, s23
  s_add_u32 s42, s34, s20
  buffer_load_dwordx2 v[36:37], v6, s[8:11], s42 offen
  s_add_u32 s23, s21, 3
  s_lshr_b32 s31, s23, 1
  s_lshl_b32 s31, s31, 6
  s_and_b32 s23, s23, 1
  s_lshl_b32 s23, s23, 3
  s_add_u32 s35, s31, s23
  s_add_u32 s43, s35, s20
  buffer_load_dwordx2 v[38:39], v6, s[8:11], s43 offen
  s_add_u32 s23, s21, 4
  s_lshr_b32 s31, s23, 1
  s_lshl_b32 s31, s31, 6
  s_and_b32 s23, s23, 1
  s_lshl_b32 s23, s23, 3
  s_add_u32 s36, s31, s23
  s_add_u32 s44, s36, s20
  buffer_load_dwordx2 v[40:41], v6, s[8:11], s44 offen
  s_waitcnt vmcnt(0)
  v_cvt_pk_bf16_f32 v80, v8, v9
  v_cvt_pk_bf16_f32 v81, v10, v11
  v_lshlrev_b32 v8, 16, v80
  v_and_b32 v9, 0xffff0000, v80
  v_lshlrev_b32 v10, 16, v81
  v_and_b32 v11, 0xffff0000, v81
  v_lshlrev_b32 v82, 16, v32
  v_and_b32 v83, 0xffff0000, v32
  v_lshlrev_b32 v84, 16, v33
  v_and_b32 v85, 0xffff0000, v33
  v_add_f32 v8, v8, v82
  v_add_f32 v9, v9, v83
  v_add_f32 v10, v10, v84
  v_add_f32 v11, v11, v85
  v_cvt_pk_bf16_f32 v32, v8, v9
  v_cvt_pk_bf16_f32 v33, v10, v11
  s_add_u32 s23, s32, 150994944
  buffer_store_dwordx2 v[32:33], v6, s[4:7], s23 offen
  v_cvt_pk_bf16_f32 v80, v12, v13
  v_cvt_pk_bf16_f32 v81, v14, v15
  v_lshlrev_b32 v12, 16, v80
  v_and_b32 v13, 0xffff0000, v80
  v_lshlrev_b32 v14, 16, v81
  v_and_b32 v15, 0xffff0000, v81
  v_lshlrev_b32 v82, 16, v34
  v_and_b32 v83, 0xffff0000, v34
  v_lshlrev_b32 v84, 16, v35
  v_and_b32 v85, 0xffff0000, v35
  v_add_f32 v12, v12, v82
  v_add_f32 v13, v13, v83
  v_add_f32 v14, v14, v84
  v_add_f32 v15, v15, v85
  v_cvt_pk_bf16_f32 v34, v12, v13
  v_cvt_pk_bf16_f32 v35, v14, v15
  s_add_u32 s23, s33, 150994944
  buffer_store_dwordx2 v[34:35], v6, s[4:7], s23 offen
  v_cvt_pk_bf16_f32 v80, v16, v17
  v_cvt_pk_bf16_f32 v81, v18, v19
  v_lshlrev_b32 v16, 16, v80
  v_and_b32 v17, 0xffff0000, v80
  v_lshlrev_b32 v18, 16, v81
  v_and_b32 v19, 0xffff0000, v81
  v_lshlrev_b32 v82, 16, v36
  v_and_b32 v83, 0xffff0000, v36
  v_lshlrev_b32 v84, 16, v37
  v_and_b32 v85, 0xffff0000, v37
  v_add_f32 v16, v16, v82
  v_add_f32 v17, v17, v83
  v_add_f32 v18, v18, v84
  v_add_f32 v19, v19, v85
  v_cvt_pk_bf16_f32 v36, v16, v17
  v_cvt_pk_bf16_f32 v37, v18, v19
  s_add_u32 s23, s34, 150994944
  buffer_store_dwordx2 v[36:37], v6, s[4:7], s23 offen
  v_cvt_pk_bf16_f32 v80, v20, v21
  v_cvt_pk_bf16_f32 v81, v22, v23
  v_lshlrev_b32 v20, 16, v80
  v_and_b32 v21, 0xffff0000, v80
  v_lshlrev_b32 v22, 16, v81
  v_and_b32 v23, 0xffff0000, v81
  v_lshlrev_b32 v82, 16, v38
  v_and_b32 v83, 0xffff0000, v38
  v_lshlrev_b32 v84, 16, v39
  v_and_b32 v85, 0xffff0000, v39
  v_add_f32 v20, v20, v82
  v_add_f32 v21, v21, v83
  v_add_f32 v22, v22, v84
  v_add_f32 v23, v23, v85
  v_cvt_pk_bf16_f32 v38, v20, v21
  v_cvt_pk_bf16_f32 v39, v22, v23
  s_add_u32 s23, s35, 150994944
  buffer_store_dwordx2 v[38:39], v6, s[4:7], s23 offen
  v_cvt_pk_bf16_f32 v80, v24, v25
  v_cvt_pk_bf16_f32 v81, v26, v27
  v_lshlrev_b32 v24, 16, v80
  v_and_b32 v25, 0xffff0000, v80
  v_lshlrev_b32 v26, 16, v81
  v_and_b32 v27, 0xffff0000, v81
  v_lshlrev_b32 v82, 16, v40
  v_and_b32 v83, 0xffff0000, v40
  v_lshlrev_b32 v84, 16, v41
  v_and_b32 v85, 0xffff0000, v41
  v_add_f32 v24, v24, v82
  v_add_f32 v25, v25, v83
  v_add_f32 v26, v26, v84
  v_add_f32 v27, v27, v85
  v_cvt_pk_bf16_f32 v40, v24, v25
  v_cvt_pk_bf16_f32 v41, v26, v27
  s_add_u32 s23, s36, 150994944
  buffer_store_dwordx2 v[40:41], v6, s[4:7], s23 offen
outb1_exit1:
  s_endpgm
.globl outb2_kernel
.p2align 8
.type outb2_kernel,@function
outb2_kernel:
  s_cmp_ge_u32 s2, 256
  s_cbranch_scc1 outb2_exit1
  s_load_dwordx2 s[12:13], s[0:1], 96
  s_load_dwordx2 s[14:15], s[0:1], 0
  s_load_dwordx2 s[48:49], s[0:1], 80
  v_lshrrev_b32 v3, 6, v0
  v_and_b32 v4, 63, v0
  s_nop 0
  v_readfirstlane_b32 s16, v3
  v_lshlrev_b32 v1, 4, v4
  s_and_b32 s17, s2, 7
  s_lshl_b32 s17, s17, 2
  s_lshr_b32 s18, s2, 3
  s_and_b32 s19, s18, 3
  s_add_u32 s17, s17, s19
  s_lshr_b32 s18, s18, 2
  s_waitcnt lgkmcnt(0)
  s_mov_b32 s4, s12
  s_mov_b32 s5, s13
  s_mov_b32 s6, 0x10000000
  s_mov_b32 s7, 0x20000
  s_mov_b32 s8, s12
  s_mov_b32 s9, s13
  s_mov_b32 s10, 0x10000000
  s_mov_b32 s11, 0x20000
  s_mov_b32 s20, 150994944
  s_mov_b32 s52, s48
  s_mov_b32 s53, s49
  s_mov_b32 s54, 2621440
  s_mov_b32 s55, 0x20000
  s_mul_i32 s21, s18, 5
  s_mul_i32 s21, s21, 32768
  s_add_u32 s24, s21, 160169984
  s_add_u32 s25, s24, 32768
  s_add_u32 s26, s25, 32768
  s_add_u32 s27, s26, 32768
  s_add_u32 s28, s27, 32768
  s_lshl_b32 s21, s17, 2
  s_add_u32 s21, s21, s16
  s_mul_i32 s22, s21, 32768
  s_add_u32 s22, s22, 174063616
  s_lshl_b32 s23, s16, 10
  v_add_u32 v2, s23, v1
  s_mul_i32 s29, s16, 5120
  s_add_u32 m0, s29, 0
  s_nop 0
  buffer_load_dwordx4 v2, s[4:7], s24 offen lds
  s_add_u32 m0, s29, 1024
  s_nop 0
  buffer_load_dwordx4 v2, s[4:7], s25 offen lds
  s_add_u32 m0, s29, 2048
  s_nop 0
  buffer_load_dwordx4 v2, s[4:7], s26 offen lds
  s_add_u32 m0, s29, 3072
  s_nop 0
  buffer_load_dwordx4 v2, s[4:7], s27 offen lds
  s_add_u32 m0, s29, 4096
  s_nop 0
  buffer_load_dwordx4 v2, s[4:7], s28 offen lds
  buffer_load_dwordx4 v[32:35], v1, s[4:7], s22 offen offset:0
  buffer_load_dwordx4 v[36:39], v1, s[4:7], s22 offen offset:1024
  buffer_load_dwordx4 v[40:43], v1, s[4:7], s22 offen offset:2048
  buffer_load_dwordx4 v[44:47], v1, s[4:7], s22 offen offset:3072
  v_add_u32 v2, 0x1000, v2
  s_add_u32 s22, s22, 4096
  s_add_u32 m0, s29, 20480
  s_nop 0
  buffer_load_dwordx4 v2, s[4:7], s24 offen lds
  s_add_u32 m0, s29, 21504
  s_nop 0
  buffer_load_dwordx4 v2, s[4:7], s25 offen lds
  s_add_u32 m0, s29, 22528
  s_nop 0
  buffer_load_dwordx4 v2, s[4:7], s26 offen lds
  s_add_u32 m0, s29, 23552
  s_nop 0
  buffer_load_dwordx4 v2, s[4:7], s27 offen lds
  s_add_u32 m0, s29, 24576
  s_nop 0
  buffer_load_dwordx4 v2, s[4:7], s28 offen lds
  buffer_load_dwordx4 v[48:51], v1, s[4:7], s22 offen offset:0
  buffer_load_dwordx4 v[52:55], v1, s[4:7], s22 offen offset:1024
  buffer_load_dwordx4 v[56:59], v1, s[4:7], s22 offen offset:2048
  buffer_load_dwordx4 v[60:63], v1, s[4:7], s22 offen offset:3072
  v_add_u32 v2, 0x1000, v2
  s_add_u32 s22, s22, 4096
  s_waitcnt vmcnt(9)
  s_barrier
  s_add_u32 m0, s29, 40960
  s_nop 0
  buffer_load_dwordx4 v2, s[4:7], s24 offen lds
  s_add_u32 m0, s29, 41984
  s_nop 0
  buffer_load_dwordx4 v2, s[4:7], s25 offen lds
  s_add_u32 m0, s29, 43008
  s_nop 0
  buffer_load_dwordx4 v2, s[4:7], s26 offen lds
  s_add_u32 m0, s29, 44032
  s_nop 0
  buffer_load_dwordx4 v2, s[4:7], s27 offen lds
  s_add_u32 m0, s29, 45056
  s_nop 0
  buffer_load_dwordx4 v2, s[4:7], s28 offen lds
  buffer_load_dwordx4 v[64:67], v1, s[4:7], s22 offen offset:0
  buffer_load_dwordx4 v[68:71], v1, s[4:7], s22 offen offset:1024
  buffer_load_dwordx4 v[72:75], v1, s[4:7], s22 offen offset:2048
  buffer_load_dwordx4 v[76:79], v1, s[4:7], s22 offen offset:3072
  v_add_u32 v2, 0x1000, v2
  s_add_u32 s22, s22, 4096
  ds_read_b128 v[80:83], v1 offset:0
  ds_read_b128 v[84:87], v1 offset:1024
  ds_read_b128 v[88:91], v1 offset:2048
  ds_read_b128 v[92:95], v1 offset:3072
  ds_read_b128 v[96:99], v1 offset:4096
  ds_read_b128 v[100:103], v1 offset:5120
  ds_read_b128 v[104:107], v1 offset:6144
  ds_read_b128 v[108:111], v1 offset:7168
  ds_read_b128 v[112:115], v1 offset:8192
  ds_read_b128 v[116:119], v1 offset:9216
  s_waitcnt lgkmcnt(5)
  v_mfma_f32_16x16x32_bf16 v[8:11], v[80:83], v[32:35], 0
  v_mfma_f32_16x16x32_bf16 v[12:15], v[84:87], v[32:35], 0
  v_mfma_f32_16x16x32_bf16 v[16:19], v[88:91], v[32:35], 0
  v_mfma_f32_16x16x32_bf16 v[20:23], v[92:95], v[32:35], 0
  v_mfma_f32_16x16x32_bf16 v[24:27], v[96:99], v[32:35], 0
  ds_read_b128 v[80:83], v1 offset:10240
  ds_read_b128 v[84:87], v1 offset:11264
  ds_read_b128 v[88:91], v1 offset:12288
  ds_read_b128 v[92:95], v1 offset:13312
  ds_read_b128 v[96:99], v1 offset:14336
  s_waitcnt lgkmcnt(5)
  v_mfma_f32_16x16x32_bf16 v[8:11], v[100:103], v[36:39], v[8:11]
  v_mfma_f32_16x16x32_bf16 v[12:15], v[104:107], v[36:39], v[12:15]
  v_mfma_f32_16x16x32_bf16 v[16:19], v[108:111], v[36:39], v[16:19]
  v_mfma_f32_16x16x32_bf16 v[20:23], v[112:115], v[36:39], v[20:23]
  v_mfma_f32_16x16x32_bf16 v[24:27], v[116:119], v[36:39], v[24:27]
  ds_read_b128 v[100:103], v1 offset:15360
  ds_read_b128 v[104:107], v1 offset:16384
  ds_read_b128 v[108:111], v1 offset:17408
  ds_read_b128 v[112:115], v1 offset:18432
  ds_read_b128 v[116:119], v1 offset:19456
  s_waitcnt lgkmcnt(5)
  v_mfma_f32_16x16x32_bf16 v[8:11], v[80:83], v[40:43], v[8:11]
  v_mfma_f32_16x16x32_bf16 v[12:15], v[84:87], v[40:43], v[12:15]
  v_mfma_f32_16x16x32_bf16 v[16:19], v[88:91], v[40:43], v[16:19]
  v_mfma_f32_16x16x32_bf16 v[20:23], v[92:95], v[40:43], v[20:23]
  v_mfma_f32_16x16x32_bf16 v[24:27], v[96:99], v[40:43], v[24:27]
  s_waitcnt lgkmcnt(0)
  v_mfma_f32_16x16x32_bf16 v[8:11], v[100:103], v[44:47], v[8:11]
  v_mfma_f32_16x16x32_bf16 v[12:15], v[104:107], v[44:47], v[12:15]
  v_mfma_f32_16x16x32_bf16 v[16:19], v[108:111], v[44:47], v[16:19]
  v_mfma_f32_16x16x32_bf16 v[20:23], v[112:115], v[44:47], v[20:23]
  v_mfma_f32_16x16x32_bf16 v[24:27], v[116:119], v[44:47], v[24:27]
  s_mov_b32 s30, 0
outb2_loop2:
  s_waitcnt vmcnt(9)
  s_barrier
  s_add_u32 m0, s29, 0
  s_nop 0
  buffer_load_dwordx4 v2, s[4:7], s24 offen lds
  s_add_u32 m0, s29, 1024
  s_nop 0
  buffer_load_dwordx4 v2, s[4:7], s25 offen lds
  s_add_u32 m0, s29, 2048
  s_nop 0
  buffer_load_dwordx4 v2, s[4:7], s26 offen lds
  s_add_u32 m0, s29, 3072
  s_nop 0
  buffer_load_dwordx4 v2, s[4:7], s27 offen lds
  s_add_u32 m0, s29, 4096
  s_nop 0
  buffer_load_dwordx4 v2, s[4:7], s28 offen lds
  buffer_load_dwordx4 v[32:35], v1, s[4:7], s22 offen offset:0
  buffer_load_dwordx4 v[36:39], v1, s[4:7], s22 offen offset:1024
  buffer_load_dwordx4 v[40:43], v1, s[4:7], s22 offen offset:2048
  buffer_load_dwordx4 v[44:47], v1, s[4:7], s22 offen offset:3072
  v_add_u32 v2, 0x1000, v2
  s_add_u32 s22, s22, 4096
  ds_read_b128 v[80:83], v1 offset:20480
  ds_read_b128 v[84:87], v1 offset:21504
  ds_read_b128 v[88:91], v1 offset:22528
  ds_read_b128 v[92:95], v1 offset:23552
  ds_read_b128 v[96:99], v1 offset:24576
  ds_read_b128 v[100:103], v1 offset:25600
  ds_read_b128 v[104:107], v1 offset:26624
  ds_read_b128 v[108:111], v1 offset:27648
  ds_read_b128 v[112:115], v1 offset:28672
  ds_read_b128 v[116:119], v1 offset:29696
  s_waitcnt lgkmcnt(5)
  v_mfma_f32_16x16x32_bf16 v[8:11], v[80:83], v[48:51], v[8:11]
  v_mfma_f32_16x16x32_bf16 v[12:15], v[84:87], v[48:51], v[12:15]
  v_mfma_f32_16x16x32_bf16 v[16:19], v[88:91], v[48:51], v[16:19]
  v_mfma_f32_16x16x32_bf16 v[20:23], v[92:95], v[48:51], v[20:23]
  v_mfma_f32_16x16x32_bf16 v[24:27], v[96:99], v[48:51], v[24:27]
  ds_read_b128 v[80:83], v1 offset:30720
  ds_read_b128 v[84:87], v1 offset:31744
  ds_read_b128 v[88:91], v1 offset:32768
  ds_read_b128 v[92:95], v1 offset:33792
  ds_read_b128 v[96:99], v1 offset:34816
  s_waitcnt lgkmcnt(5)
  v_mfma_f32_16x16x32_bf16 v[8:11], v[100:103], v[52:55], v[8:11]
  v_mfma_f32_16x16x32_bf16 v[12:15], v[104:107], v[52:55], v[12:15]
  v_mfma_f32_16x16x32_bf16 v[16:19], v[108:111], v[52:55], v[16:19]
  v_mfma_f32_16x16x32_bf16 v[20:23], v[112:115], v[52:55], v[20:23]
  v_mfma_f32_16x16x32_bf16 v[24:27], v[116:119], v[52:55], v[24:27]
  ds_read_b128 v[100:103], v1 offset:35840
  ds_read_b128 v[104:107], v1 offset:36864
  ds_read_b128 v[108:111], v1 offset:37888
  ds_read_b128 v[112:115], v1 offset:38912
  ds_read_b128 v[116:119], v1 offset:39936
  s_waitcnt lgkmcnt(5)
  v_mfma_f32_16x16x32_bf16 v[8:11], v[80:83], v[56:59], v[8:11]
  v_mfma_f32_16x16x32_bf16 v[12:15], v[84:87], v[56:59], v[12:15]
  v_mfma_f32_16x16x32_bf16 v[16:19], v[88:91], v[56:59], v[16:19]
  v_mfma_f32_16x16x32_bf16 v[20:23], v[92:95], v[56:59], v[20:23]
  v_mfma_f32_16x16x32_bf16 v[24:27], v[96:99], v[56:59], v[24:27]
  s_waitcnt lgkmcnt(0)
  v_mfma_f32_16x16x32_bf16 v[8:11], v[100:103], v[60:63], v[8:11]
  v_mfma_f32_16x16x32_bf16 v[12:15], v[104:107], v[60:63], v[12:15]
  v_mfma_f32_16x16x32_bf16 v[16:19], v[108:111], v[60:63], v[16:19]
  v_mfma_f32_16x16x32_bf16 v[20:23], v[112:115], v[60:63], v[20:23]
  v_mfma_f32_16x16x32_bf16 v[24:27], v[116:119], v[60:63], v[24:27]
  s_waitcnt vmcnt(9)
  s_barrier
  s_add_u32 m0, s29, 20480
  s_nop 0
  buffer_load_dwordx4 v2, s[4:7], s24 offen lds
  s_add_u32 m0, s29, 21504
  s_nop 0
  buffer_load_dwordx4 v2, s[4:7], s25 offen lds
  s_add_u32 m0, s29, 22528
  s_nop 0
  buffer_load_dwordx4 v2, s[4:7], s26 offen lds
  s_add_u32 m0, s29, 23552
  s_nop 0
  buffer_load_dwordx4 v2, s[4:7], s27 offen lds
  s_add_u32 m0, s29, 24576
  s_nop 0
  buffer_load_dwordx4 v2, s[4:7], s28 offen lds
  buffer_load_dwordx4 v[48:51], v1, s[4:7], s22 offen offset:0
  buffer_load_dwordx4 v[52:55], v1, s[4:7], s22 offen offset:1024
  buffer_load_dwordx4 v[56:59], v1, s[4:7], s22 offen offset:2048
  buffer_load_dwordx4 v[60:63], v1, s[4:7], s22 offen offset:3072
  v_add_u32 v2, 0x1000, v2
  s_add_u32 s22, s22, 4096
  ds_read_b128 v[80:83], v1 offset:40960
  ds_read_b128 v[84:87], v1 offset:41984
  ds_read_b128 v[88:91], v1 offset:43008
  ds_read_b128 v[92:95], v1 offset:44032
  ds_read_b128 v[96:99], v1 offset:45056
  ds_read_b128 v[100:103], v1 offset:46080
  ds_read_b128 v[104:107], v1 offset:47104
  ds_read_b128 v[108:111], v1 offset:48128
  ds_read_b128 v[112:115], v1 offset:49152
  ds_read_b128 v[116:119], v1 offset:50176
  s_waitcnt lgkmcnt(5)
  v_mfma_f32_16x16x32_bf16 v[8:11], v[80:83], v[64:67], v[8:11]
  v_mfma_f32_16x16x32_bf16 v[12:15], v[84:87], v[64:67], v[12:15]
  v_mfma_f32_16x16x32_bf16 v[16:19], v[88:91], v[64:67], v[16:19]
  v_mfma_f32_16x16x32_bf16 v[20:23], v[92:95], v[64:67], v[20:23]
  v_mfma_f32_16x16x32_bf16 v[24:27], v[96:99], v[64:67], v[24:27]
  ds_read_b128 v[80:83], v1 offset:51200
  ds_read_b128 v[84:87], v1 offset:52224
  ds_read_b128 v[88:91], v1 offset:53248
  ds_read_b128 v[92:95], v1 offset:54272
  ds_read_b128 v[96:99], v1 offset:55296
  s_waitcnt lgkmcnt(5)
  v_mfma_f32_16x16x32_bf16 v[8:11], v[100:103], v[68:71], v[8:11]
  v_mfma_f32_16x16x32_bf16 v[12:15], v[104:107], v[68:71], v[12:15]
  v_mfma_f32_16x16x32_bf16 v[16:19], v[108:111], v[68:71], v[16:19]
  v_mfma_f32_16x16x32_bf16 v[20:23], v[112:115], v[68:71], v[20:23]
  v_mfma_f32_16x16x32_bf16 v[24:27], v[116:119], v[68:71], v[24:27]
  ds_read_b128 v[100:103], v1 offset:56320
  ds_read_b128 v[104:107], v1 offset:57344
  ds_read_b128 v[108:111], v1 offset:58368
  ds_read_b128 v[112:115], v1 offset:59392
  ds_read_b128 v[116:119], v1 offset:60416
  s_waitcnt lgkmcnt(5)
  v_mfma_f32_16x16x32_bf16 v[8:11], v[80:83], v[72:75], v[8:11]
  v_mfma_f32_16x16x32_bf16 v[12:15], v[84:87], v[72:75], v[12:15]
  v_mfma_f32_16x16x32_bf16 v[16:19], v[88:91], v[72:75], v[16:19]
  v_mfma_f32_16x16x32_bf16 v[20:23], v[92:95], v[72:75], v[20:23]
  v_mfma_f32_16x16x32_bf16 v[24:27], v[96:99], v[72:75], v[24:27]
  s_waitcnt lgkmcnt(0)
  v_mfma_f32_16x16x32_bf16 v[8:11], v[100:103], v[76:79], v[8:11]
  v_mfma_f32_16x16x32_bf16 v[12:15], v[104:107], v[76:79], v[12:15]
  v_mfma_f32_16x16x32_bf16 v[16:19], v[108:111], v[76:79], v[16:19]
  v_mfma_f32_16x16x32_bf16 v[20:23], v[112:115], v[76:79], v[20:23]
  v_mfma_f32_16x16x32_bf16 v[24:27], v[116:119], v[76:79], v[24:27]
  s_waitcnt vmcnt(9)
  s_barrier
  s_add_u32 m0, s29, 40960
  s_nop 0
  buffer_load_dwordx4 v2, s[4:7], s24 offen lds
  s_add_u32 m0, s29, 41984
  s_nop 0
  buffer_load_dwordx4 v2, s[4:7], s25 offen lds
  s_add_u32 m0, s29, 43008
  s_nop 0
  buffer_load_dwordx4 v2, s[4:7], s26 offen lds
  s_add_u32 m0, s29, 44032
  s_nop 0
  buffer_load_dwordx4 v2, s[4:7], s27 offen lds
  s_add_u32 m0, s29, 45056
  s_nop 0
  buffer_load_dwordx4 v2, s[4:7], s28 offen lds
  buffer_load_dwordx4 v[64:67], v1, s[4:7], s22 offen offset:0
  buffer_load_dwordx4 v[68:71], v1, s[4:7], s22 offen offset:1024
  buffer_load_dwordx4 v[72:75], v1, s[4:7], s22 offen offset:2048
  buffer_load_dwordx4 v[76:79], v1, s[4:7], s22 offen offset:3072
  v_add_u32 v2, 0x1000, v2
  s_add_u32 s22, s22, 4096
  ds_read_b128 v[80:83], v1 offset:0
  ds_read_b128 v[84:87], v1 offset:1024
  ds_read_b128 v[88:91], v1 offset:2048
  ds_read_b128 v[92:95], v1 offset:3072
  ds_read_b128 v[96:99], v1 offset:4096
  ds_read_b128 v[100:103], v1 offset:5120
  ds_read_b128 v[104:107], v1 offset:6144
  ds_read_b128 v[108:111], v1 offset:7168
  ds_read_b128 v[112:115], v1 offset:8192
  ds_read_b128 v[116:119], v1 offset:9216
  s_waitcnt lgkmcnt(5)
  v_mfma_f32_16x16x32_bf16 v[8:11], v[80:83], v[32:35], v[8:11]
  v_mfma_f32_16x16x32_bf16 v[12:15], v[84:87], v[32:35], v[12:15]
  v_mfma_f32_16x16x32_bf16 v[16:19], v[88:91], v[32:35], v[16:19]
  v_mfma_f32_16x16x32_bf16 v[20:23], v[92:95], v[32:35], v[20:23]
  v_mfma_f32_16x16x32_bf16 v[24:27], v[96:99], v[32:35], v[24:27]
  ds_read_b128 v[80:83], v1 offset:10240
  ds_read_b128 v[84:87], v1 offset:11264
  ds_read_b128 v[88:91], v1 offset:12288
  ds_read_b128 v[92:95], v1 offset:13312
  ds_read_b128 v[96:99], v1 offset:14336
  s_waitcnt lgkmcnt(5)
  v_mfma_f32_16x16x32_bf16 v[8:11], v[100:103], v[36:39], v[8:11]
  v_mfma_f32_16x16x32_bf16 v[12:15], v[104:107], v[36:39], v[12:15]
  v_mfma_f32_16x16x32_bf16 v[16:19], v[108:111], v[36:39], v[16:19]
  v_mfma_f32_16x16x32_bf16 v[20:23], v[112:115], v[36:39], v[20:23]
  v_mfma_f32_16x16x32_bf16 v[24:27], v[116:119], v[36:39], v[24:27]
  ds_read_b128 v[100:103], v1 offset:15360
  ds_read_b128 v[104:107], v1 offset:16384
  ds_read_b128 v[108:111], v1 offset:17408
  ds_read_b128 v[112:115], v1 offset:18432
  ds_read_b128 v[116:119], v1 offset:19456
  s_waitcnt lgkmcnt(5)
  v_mfma_f32_16x16x32_bf16 v[8:11], v[80:83], v[40:43], v[8:11]
  v_mfma_f32_16x16x32_bf16 v[12:15], v[84:87], v[40:43], v[12:15]
  v_mfma_f32_16x16x32_bf16 v[16:19], v[88:91], v[40:43], v[16:19]
  v_mfma_f32_16x16x32_bf16 v[20:23], v[92:95], v[40:43], v[20:23]
  v_mfma_f32_16x16x32_bf16 v[24:27], v[96:99], v[40:43], v[24:27]
  s_waitcnt lgkmcnt(0)
  v_mfma_f32_16x16x32_bf16 v[8:11], v[100:103], v[44:47], v[8:11]
  v_mfma_f32_16x16x32_bf16 v[12:15], v[104:107], v[44:47], v[12:15]
  v_mfma_f32_16x16x32_bf16 v[16:19], v[108:111], v[44:47], v[16:19]
  v_mfma_f32_16x16x32_bf16 v[20:23], v[112:115], v[44:47], v[20:23]
  v_mfma_f32_16x16x32_bf16 v[24:27], v[116:119], v[44:47], v[24:27]
  s_add_u32 s30, s30, 1
  s_cmp_lt_u32 s30, 1
  s_cbranch_scc1 outb2_loop2
  s_waitcnt vmcnt(9)
  s_barrier
  s_add_u32 m0, s29, 0
  s_nop 0
  buffer_load_dwordx4 v2, s[4:7], s24 offen lds
  s_add_u32 m0, s29, 1024
  s_nop 0
  buffer_load_dwordx4 v2, s[4:7], s25 offen lds
  s_add_u32 m0, s29, 2048
  s_nop 0
  buffer_load_dwordx4 v2, s[4:7], s26 offen lds
  s_add_u32 m0, s29, 3072
  s_nop 0
  buffer_load_dwordx4 v2, s[4:7], s27 offen lds
  s_add_u32 m0, s29, 4096
  s_nop 0
  buffer_load_dwordx4 v2, s[4:7], s28 offen lds
  buffer_load_dwordx4 v[32:35], v1, s[4:7], s22 offen offset:0
  buffer_load_dwordx4 v[36:39], v1, s[4:7], s22 offen offset:1024
  buffer_load_dwordx4 v[40:43], v1, s[4:7], s22 offen offset:2048
  buffer_load_dwordx4 v[44:47], v1, s[4:7], s22 offen offset:3072
  v_add_u32 v2, 0x1000, v2
  s_add_u32 s22, s22, 4096
  ds_read_b128 v[80:83], v1 offset:20480
  ds_read_b128 v[84:87], v1 offset:21504
  ds_read_b128 v[88:91], v1 offset:22528
  ds_read_b128 v[92:95], v1 offset:23552
  ds_read_b128 v[96:99], v1 offset:24576
  ds_read_b128 v[100:103], v1 offset:25600
  ds_read_b128 v[104:107], v1 offset:26624
  ds_read_b128 v[108:111], v1 offset:27648
  ds_read_b128 v[112:115], v1 offset:28672
  ds_read_b128 v[116:119], v1 offset:29696
  s_waitcnt lgkmcnt(5)
  v_mfma_f32_16x16x32_bf16 v[8:11], v[80:83], v[48:51], v[8:11]
  v_mfma_f32_16x16x32_bf16 v[12:15], v[84:87], v[48:51], v[12:15]
  v_mfma_f32_16x16x32_bf16 v[16:19], v[88:91], v[48:51], v[16:19]
  v_mfma_f32_16x16x32_bf16 v[20:23], v[92:95], v[48:51], v[20:23]
  v_mfma_f32_16x16x32_bf16 v[24:27], v[96:99], v[48:51], v[24:27]
  ds_read_b128 v[80:83], v1 offset:30720
  ds_read_b128 v[84:87], v1 offset:31744
  ds_read_b128 v[88:91], v1 offset:32768
  ds_read_b128 v[92:95], v1 offset:33792
  ds_read_b128 v[96:99], v1 offset:34816
  s_waitcnt lgkmcnt(5)
  v_mfma_f32_16x16x32_bf16 v[8:11], v[100:103], v[52:55], v[8:11]
  v_mfma_f32_16x16x32_bf16 v[12:15], v[104:107], v[52:55], v[12:15]
  v_mfma_f32_16x16x32_bf16 v[16:19], v[108:111], v[52:55], v[16:19]
  v_mfma_f32_16x16x32_bf16 v[20:23], v[112:115], v[52:55], v[20:23]
  v_mfma_f32_16x16x32_bf16 v[24:27], v[116:119], v[52:55], v[24:27]
  ds_read_b128 v[100:103], v1 offset:35840
  ds_read_b128 v[104:107], v1 offset:36864
  ds_read_b128 v[108:111], v1 offset:37888
  ds_read_b128 v[112:115], v1 offset:38912
  ds_read_b128 v[116:119], v1 offset:39936
  s_waitcnt lgkmcnt(5)
  v_mfma_f32_16x16x32_bf16 v[8:11], v[80:83], v[56:59], v[8:11]
  v_mfma_f32_16x16x32_bf16 v[12:15], v[84:87], v[56:59], v[12:15]
  v_mfma_f32_16x16x32_bf16 v[16:19], v[88:91], v[56:59], v[16:19]
  v_mfma_f32_16x16x32_bf16 v[20:23], v[92:95], v[56:59], v[20:23]
  v_mfma_f32_16x16x32_bf16 v[24:27], v[96:99], v[56:59], v[24:27]
  s_waitcnt lgkmcnt(0)
  v_mfma_f32_16x16x32_bf16 v[8:11], v[100:103], v[60:63], v[8:11]
  v_mfma_f32_16x16x32_bf16 v[12:15], v[104:107], v[60:63], v[12:15]
  v_mfma_f32_16x16x32_bf16 v[16:19], v[108:111], v[60:63], v[16:19]
  v_mfma_f32_16x16x32_bf16 v[20:23], v[112:115], v[60:63], v[20:23]
  v_mfma_f32_16x16x32_bf16 v[24:27], v[116:119], v[60:63], v[24:27]
  s_waitcnt vmcnt(9)
  s_barrier
  s_add_u32 m0, s29, 20480
  s_nop 0
  buffer_load_dwordx4 v2, s[4:7], s24 offen lds
  s_add_u32 m0, s29, 21504
  s_nop 0
  buffer_load_dwordx4 v2, s[4:7], s25 offen lds
  s_add_u32 m0, s29, 22528
  s_nop 0
  buffer_load_dwordx4 v2, s[4:7], s26 offen lds
  s_add_u32 m0, s29, 23552
  s_nop 0
  buffer_load_dwordx4 v2, s[4:7], s27 offen lds
  s_add_u32 m0, s29, 24576
  s_nop 0
  buffer_load_dwordx4 v2, s[4:7], s28 offen lds
  buffer_load_dwordx4 v[48:51], v1, s[4:7], s22 offen offset:0
  buffer_load_dwordx4 v[52:55], v1, s[4:7], s22 offen offset:1024
  buffer_load_dwordx4 v[56:59], v1, s[4:7], s22 offen offset:2048
  buffer_load_dwordx4 v[60:63], v1, s[4:7], s22 offen offset:3072
  v_add_u32 v2, 0x1000, v2
  s_add_u32 s22, s22, 4096
  ds_read_b128 v[80:83], v1 offset:40960
  ds_read_b128 v[84:87], v1 offset:41984
  ds_read_b128 v[88:91], v1 offset:43008
  ds_read_b128 v[92:95], v1 offset:44032
  ds_read_b128 v[96:99], v1 offset:45056
  ds_read_b128 v[100:103], v1 offset:46080
  ds_read_b128 v[104:107], v1 offset:47104
  ds_read_b128 v[108:111], v1 offset:48128
  ds_read_b128 v[112:115], v1 offset:49152
  ds_read_b128 v[116:119], v1 offset:50176
  s_waitcnt lgkmcnt(5)
  v_mfma_f32_16x16x32_bf16 v[8:11], v[80:83], v[64:67], v[8:11]
  v_mfma_f32_16x16x32_bf16 v[12:15], v[84:87], v[64:67], v[12:15]
  v_mfma_f32_16x16x32_bf16 v[16:19], v[88:91], v[64:67], v[16:19]
  v_mfma_f32_16x16x32_bf16 v[20:23], v[92:95], v[64:67], v[20:23]
  v_mfma_f32_16x16x32_bf16 v[24:27], v[96:99], v[64:67], v[24:27]
  ds_read_b128 v[80:83], v1 offset:51200
  ds_read_b128 v[84:87], v1 offset:52224
  ds_read_b128 v[88:91], v1 offset:53248
  ds_read_b128 v[92:95], v1 offset:54272
  ds_read_b128 v[96:99], v1 offset:55296
  s_waitcnt lgkmcnt(5)
  v_mfma_f32_16x16x32_bf16 v[8:11], v[100:103], v[68:71], v[8:11]
  v_mfma_f32_16x16x32_bf16 v[12:15], v[104:107], v[68:71], v[12:15]
  v_mfma_f32_16x16x32_bf16 v[16:19], v[108:111], v[68:71], v[16:19]
  v_mfma_f32_16x16x32_bf16 v[20:23], v[112:115], v[68:71], v[20:23]
  v_mfma_f32_16x16x32_bf16 v[24:27], v[116:119], v[68:71], v[24:27]
  ds_read_b128 v[100:103], v1 offset:56320
  ds_read_b128 v[104:107], v1 offset:57344
  ds_read_b128 v[108:111], v1 offset:58368
  ds_read_b128 v[112:115], v1 offset:59392
  ds_read_b128 v[116:119], v1 offset:60416
  s_waitcnt lgkmcnt(5)
  v_mfma_f32_16x16x32_bf16 v[8:11], v[80:83], v[72:75], v[8:11]
  v_mfma_f32_16x16x32_bf16 v[12:15], v[84:87], v[72:75], v[12:15]
  v_mfma_f32_16x16x32_bf16 v[16:19], v[88:91], v[72:75], v[16:19]
  v_mfma_f32_16x16x32_bf16 v[20:23], v[92:95], v[72:75], v[20:23]
  v_mfma_f32_16x16x32_bf16 v[24:27], v[96:99], v[72:75], v[24:27]
  s_waitcnt lgkmcnt(0)
  v_mfma_f32_16x16x32_bf16 v[8:11], v[100:103], v[76:79], v[8:11]
  v_mfma_f32_16x16x32_bf16 v[12:15], v[104:107], v[76:79], v[12:15]
  v_mfma_f32_16x16x32_bf16 v[16:19], v[108:111], v[76:79], v[16:19]
  v_mfma_f32_16x16x32_bf16 v[20:23], v[112:115], v[76:79], v[20:23]
  v_mfma_f32_16x16x32_bf16 v[24:27], v[116:119], v[76:79], v[24:27]
  s_waitcnt vmcnt(9)
  s_barrier
  ds_read_b128 v[80:83], v1 offset:0
  ds_read_b128 v[84:87], v1 offset:1024
  ds_read_b128 v[88:91], v1 offset:2048
  ds_read_b128 v[92:95], v1 offset:3072
  ds_read_b128 v[96:99], v1 offset:4096
  ds_read_b128 v[100:103], v1 offset:5120
  ds_read_b128 v[104:107], v1 offset:6144
  ds_read_b128 v[108:111], v1 offset:7168
  ds_read_b128 v[112:115], v1 offset:8192
  ds_read_b128 v[116:119], v1 offset:9216
  s_waitcnt lgkmcnt(5)
  v_mfma_f32_16x16x32_bf16 v[8:11], v[80:83], v[32:35], v[8:11]
  v_mfma_f32_16x16x32_bf16 v[12:15], v[84:87], v[32:35], v[12:15]
  v_mfma_f32_16x16x32_bf16 v[16:19], v[88:91], v[32:35], v[16:19]
  v_mfma_f32_16x16x32_bf16 v[20:23], v[92:95], v[32:35], v[20:23]
  v_mfma_f32_16x16x32_bf16 v[24:27], v[96:99], v[32:35], v[24:27]
  ds_read_b128 v[80:83], v1 offset:10240
  ds_read_b128 v[84:87], v1 offset:11264
  ds_read_b128 v[88:91], v1 offset:12288
  ds_read_b128 v[92:95], v1 offset:13312
  ds_read_b128 v[96:99], v1 offset:14336
  s_waitcnt lgkmcnt(5)
  v_mfma_f32_16x16x32_bf16 v[8:11], v[100:103], v[36:39], v[8:11]
  v_mfma_f32_16x16x32_bf16 v[12:15], v[104:107], v[36:39], v[12:15]
  v_mfma_f32_16x16x32_bf16 v[16:19], v[108:111], v[36:39], v[16:19]
  v_mfma_f32_16x16x32_bf16 v[20:23], v[112:115], v[36:39], v[20:23]
  v_mfma_f32_16x16x32_bf16 v[24:27], v[116:119], v[36:39], v[24:27]
  ds_read_b128 v[100:103], v1 offset:15360
  ds_read_b128 v[104:107], v1 offset:16384
  ds_read_b128 v[108:111], v1 offset:17408
  ds_read_b128 v[112:115], v1 offset:18432
  ds_read_b128 v[116:119], v1 offset:19456
  s_waitcnt lgkmcnt(5)
  v_mfma_f32_16x16x32_bf16 v[8:11], v[80:83], v[40:43], v[8:11]
  v_mfma_f32_16x16x32_bf16 v[12:15], v[84:87], v[40:43], v[12:15]
  v_mfma_f32_16x16x32_bf16 v[16:19], v[88:91], v[40:43], v[16:19]
  v_mfma_f32_16x16x32_bf16 v[20:23], v[92:95], v[40:43], v[20:23]
  v_mfma_f32_16x16x32_bf16 v[24:27], v[96:99], v[40:43], v[24:27]
  s_waitcnt lgkmcnt(0)
  v_mfma_f32_16x16x32_bf16 v[8:11], v[100:103], v[44:47], v[8:11]
  v_mfma_f32_16x16x32_bf16 v[12:15], v[104:107], v[44:47], v[12:15]
  v_mfma_f32_16x16x32_bf16 v[16:19], v[108:111], v[44:47], v[16:19]
  v_mfma_f32_16x16x32_bf16 v[20:23], v[112:115], v[44:47], v[20:23]
  v_mfma_f32_16x16x32_bf16 v[24:27], v[116:119], v[44:47], v[24:27]
  s_waitcnt vmcnt(0)
  s_barrier
  ds_read_b128 v[80:83], v1 offset:20480
  ds_read_b128 v[84:87], v1 offset:21504
  ds_read_b128 v[88:91], v1 offset:22528
  ds_read_b128 v[92:95], v1 offset:23552
  ds_read_b128 v[96:99], v1 offset:24576
  ds_read_b128 v[100:103], v1 offset:25600
  ds_read_b128 v[104:107], v1 offset:26624
  ds_read_b128 v[108:111], v1 offset:27648
  ds_read_b128 v[112:115], v1 offset:28672
  ds_read_b128 v[116:119], v1 offset:29696
  s_waitcnt lgkmcnt(5)
  v_mfma_f32_16x16x32_bf16 v[8:11], v[80:83], v[48:51], v[8:11]
  v_mfma_f32_16x16x32_bf16 v[12:15], v[84:87], v[48:51], v[12:15]
  v_mfma_f32_16x16x32_bf16 v[16:19], v[88:91], v[48:51], v[16:19]
  v_mfma_f32_16x16x32_bf16 v[20:23], v[92:95], v[48:51], v[20:23]
  v_mfma_f32_16x16x32_bf16 v[24:27], v[96:99], v[48:51], v[24:27]
  ds_read_b128 v[80:83], v1 offset:30720
  ds_read_b128 v[84:87], v1 offset:31744
  ds_read_b128 v[88:91], v1 offset:32768
  ds_read_b128 v[92:95], v1 offset:33792
  ds_read_b128 v[96:99], v1 offset:34816
  s_waitcnt lgkmcnt(5)
  v_mfma_f32_16x16x32_bf16 v[8:11], v[100:103], v[52:55], v[8:11]
  v_mfma_f32_16x16x32_bf16 v[12:15], v[104:107], v[52:55], v[12:15]
  v_mfma_f32_16x16x32_bf16 v[16:19], v[108:111], v[52:55], v[16:19]
  v_mfma_f32_16x16x32_bf16 v[20:23], v[112:115], v[52:55], v[20:23]
  v_mfma_f32_16x16x32_bf16 v[24:27], v[116:119], v[52:55], v[24:27]
  ds_read_b128 v[100:103], v1 offset:35840
  ds_read_b128 v[104:107], v1 offset:36864
  ds_read_b128 v[108:111], v1 offset:37888
  ds_read_b128 v[112:115], v1 offset:38912
  ds_read_b128 v[116:119], v1 offset:39936
  s_waitcnt lgkmcnt(5)
  v_mfma_f32_16x16x32_bf16 v[8:11], v[80:83], v[56:59], v[8:11]
  v_mfma_f32_16x16x32_bf16 v[12:15], v[84:87], v[56:59], v[12:15]
  v_mfma_f32_16x16x32_bf16 v[16:19], v[88:91], v[56:59], v[16:19]
  v_mfma_f32_16x16x32_bf16 v[20:23], v[92:95], v[56:59], v[20:23]
  v_mfma_f32_16x16x32_bf16 v[24:27], v[96:99], v[56:59], v[24:27]
  s_waitcnt lgkmcnt(0)
  v_mfma_f32_16x16x32_bf16 v[8:11], v[100:103], v[60:63], v[8:11]
  v_mfma_f32_16x16x32_bf16 v[12:15], v[104:107], v[60:63], v[12:15]
  v_mfma_f32_16x16x32_bf16 v[16:19], v[108:111], v[60:63], v[16:19]
  v_mfma_f32_16x16x32_bf16 v[20:23], v[112:115], v[60:63], v[20:23]
  v_mfma_f32_16x16x32_bf16 v[24:27], v[116:119], v[60:63], v[24:27]
  v_and_b32 v3, 63, v0
  v_and_b32 v4, 15, v3
  v_lshrrev_b32 v3, 4, v3
  s_lshl_b32 s21, s17, 6
  s_lshl_b32 s23, s16, 4
  s_add_u32 s21, s21, s23
  v_add_u32 v4, s21, v4
  v_mul_u32_u24 v6, 1280, v4
  v_lshl_add_u32 v6, v3, 4, v6
  s_mul_i32 s21, s18, 5
  s_add_u32 s23, s21, 0
  s_lshr_b32 s31, s23, 1
  s_lshl_b32 s31, s31, 6
  s_and_b32 s23, s23, 1
  s_lshl_b32 s23, s23, 3
  s_add_u32 s32, s31, s23
  s_add_u32 s40, s32, s20
  buffer_load_dwordx2 v[32:33], v6, s[8:11], s40 offen
  s_add_u32 s23, s21, 1
  s_lshr_b32 s31, s23, 1
  s_lshl_b32 s31, s31, 6
  s_and_b32 s23, s23, 1
  s_lshl_b32 s23, s23, 3
  s_add_u32 s33, s31, s23
  s_add_u32 s41, s33, s20
  buffer_load_dwordx2 v[34:35], v6, s[8:11], s41 offen
  s_add_u32 s23, s21, 2
  s_lshr_b32 s31, s23, 1
  s_lshl_b32 s31, s31, 6
  s_and_b32 s23, s23, 1
  s_lshl_b32 s23, s23, 3
  s_add_u32 s34, s31, s23
  s_add_u32 s42, s34, s20
  buffer_load_dwordx2 v[36:37], v6, s[8:11], s42 offen
  s_add_u32 s23, s21, 3
  s_lshr_b32 s31, s23, 1
  s_lshl_b32 s31, s31, 6
  s_and_b32 s23, s23, 1
  s_lshl_b32 s23, s23, 3
  s_add_u32 s35, s31, s23
  s_add_u32 s43, s35, s20
  buffer_load_dwordx2 v[38:39], v6, s[8:11], s43 offen
  s_add_u32 s23, s21, 4
  s_lshr_b32 s31, s23, 1
  s_lshl_b32 s31, s31, 6
  s_and_b32 s23, s23, 1
  s_lshl_b32 s23, s23, 3
  s_add_u32 s36, s31, s23
  s_add_u32 s44, s36, s20
  buffer_load_dwordx2 v[40:41], v6, s[8:11], s44 offen
  s_waitcnt vmcnt(0)
  v_cvt_pk_bf16_f32 v80, v8, v9
  v_cvt_pk_bf16_f32 v81, v10, v11
  v_lshlrev_b32 v8, 16, v80
  v_and_b32 v9, 0xffff0000, v80
  v_lshlrev_b32 v10, 16, v81
  v_and_b32 v11, 0xffff0000, v81
  v_lshlrev_b32 v82, 16, v32
  v_and_b32 v83, 0xffff0000, v32
  v_lshlrev_b32 v84, 16, v33
  v_and_b32 v85, 0xffff0000, v33
  v_add_f32 v8, v8, v82
  v_add_f32 v9, v9, v83
  v_add_f32 v10, v10, v84
  v_add_f32 v11, v11, v85
  v_cvt_pk_bf16_f32 v32, v8, v9
  v_cvt_pk_bf16_f32 v33, v10, v11
  buffer_store_dwordx2 v[32:33], v6, s[52:55], s32 offen
  v_cvt_pk_bf16_f32 v80, v12, v13
  v_cvt_pk_bf16_f32 v81, v14, v15
  v_lshlrev_b32 v12, 16, v80
  v_and_b32 v13, 0xffff0000, v80
  v_lshlrev_b32 v14, 16, v81
  v_and_b32 v15, 0xffff0000, v81
  v_lshlrev_b32 v82, 16, v34
  v_and_b32 v83, 0xffff0000, v34
  v_lshlrev_b32 v84, 16, v35
  v_and_b32 v85, 0xffff0000, v35
  v_add_f32 v12, v12, v82
  v_add_f32 v13, v13, v83
  v_add_f32 v14, v14, v84
  v_add_f32 v15, v15, v85
  v_cvt_pk_bf16_f32 v34, v12, v13
  v_cvt_pk_bf16_f32 v35, v14, v15
  buffer_store_dwordx2 v[34:35], v6, s[52:55], s33 offen
  v_cvt_pk_bf16_f32 v80, v16, v17
  v_cvt_pk_bf16_f32 v81, v18, v19
  v_lshlrev_b32 v16, 16, v80
  v_and_b32 v17, 0xffff0000, v80
  v_lshlrev_b32 v18, 16, v81
  v_and_b32 v19, 0xffff0000, v81
  v_lshlrev_b32 v82, 16, v36
  v_and_b32 v83, 0xffff0000, v36
  v_lshlrev_b32 v84, 16, v37
  v_and_b32 v85, 0xffff0000, v37
  v_add_f32 v16, v16, v82
  v_add_f32 v17, v17, v83
  v_add_f32 v18, v18, v84
  v_add_f32 v19, v19, v85
  v_cvt_pk_bf16_f32 v36, v16, v17
  v_cvt_pk_bf16_f32 v37, v18, v19
  buffer_store_dwordx2 v[36:37], v6, s[52:55], s34 offen
  v_cvt_pk_bf16_f32 v80, v20, v21
  v_cvt_pk_bf16_f32 v81, v22, v23
  v_lshlrev_b32 v20, 16, v80
  v_and_b32 v21, 0xffff0000, v80
  v_lshlrev_b32 v22, 16, v81
  v_and_b32 v23, 0xffff0000, v81
  v_lshlrev_b32 v82, 16, v38
  v_and_b32 v83, 0xffff0000, v38
  v_lshlrev_b32 v84, 16, v39
  v_and_b32 v85, 0xffff0000, v39
  v_add_f32 v20, v20, v82
  v_add_f32 v21, v21, v83
  v_add_f32 v22, v22, v84
  v_add_f32 v23, v23, v85
  v_cvt_pk_bf16_f32 v38, v20, v21
  v_cvt_pk_bf16_f32 v39, v22, v23
  buffer_store_dwordx2 v[38:39], v6, s[52:55], s35 offen
  v_cvt_pk_bf16_f32 v80, v24, v25
  v_cvt_pk_bf16_f32 v81, v26, v27
  v_lshlrev_b32 v24, 16, v80
  v_and_b32 v25, 0xffff0000, v80
  v_lshlrev_b32 v26, 16, v81
  v_and_b32 v27, 0xffff0000, v81
  v_lshlrev_b32 v82, 16, v40
  v_and_b32 v83, 0xffff0000, v40
  v_lshlrev_b32 v84, 16, v41
  v_and_b32 v85, 0xffff0000, v41
  v_add_f32 v24, v24, v82
  v_add_f32 v25, v25, v83
  v_add_f32 v26, v26, v84
  v_add_f32 v27, v27, v85
  v_cvt_pk_bf16_f32 v40, v24, v25
  v_cvt_pk_bf16_f32 v41, v26, v27
  buffer_store_dwordx2 v[40:41], v6, s[52:55], s36 offen
outb2_exit1:
  s_endpgm
.section .rodata,"a"
.p2align 6
.amdhsa_kernel prep_kernel
  .amdhsa_next_free_vgpr 80
  .amdhsa_next_free_sgpr 64
  .amdhsa_accum_offset 80
  .amdhsa_group_segment_fixed_size 0
  .amdhsa_kernarg_size 104
  .amdhsa_user_sgpr_count 2
  .amdhsa_user_sgpr_kernarg_segment_ptr 1
  .amdhsa_system_sgpr_workgroup_id_x 1
  .amdhsa_float_denorm_mode_32 3
.end_amdhsa_kernel
.p2align 6
.amdhsa_kernel ln2_kernel
  .amdhsa_next_free_vgpr 80
  .amdhsa_next_free_sgpr 40
  .amdhsa_accum_offset 80
  .amdhsa_group_segment_fixed_size 0
  .amdhsa_kernarg_size 104
  .amdhsa_user_sgpr_count 2
  .amdhsa_user_sgpr_kernarg_segment_ptr 1
  .amdhsa_system_sgpr_workgroup_id_x 1
  .amdhsa_float_denorm_mode_32 3
.end_amdhsa_kernel
.p2align 6
.amdhsa_kernel reca_kernel
  .amdhsa_next_free_vgpr 512
  .amdhsa_next_free_sgpr 102
  .amdhsa_accum_offset 256
  .amdhsa_group_segment_fixed_size 0
  .amdhsa_kernarg_size 104
  .amdhsa_user_sgpr_count 2
  .amdhsa_user_sgpr_kernarg_segment_ptr 1
  .amdhsa_system_sgpr_workgroup_id_x 1
  .amdhsa_float_denorm_mode_32 3
.end_amdhsa_kernel
.p2align 6
.amdhsa_kernel fin_kernel
  .amdhsa_next_free_vgpr 496
  .amdhsa_next_free_sgpr 64
  .amdhsa_accum_offset 256
  .amdhsa_group_segment_fixed_size 0
  .amdhsa_kernarg_size 104
  .amdhsa_user_sgpr_count 2
  .amdhsa_user_sgpr_kernarg_segment_ptr 1
  .amdhsa_system_sgpr_workgroup_id_x 1
  .amdhsa_float_denorm_mode_32 3
.end_amdhsa_kernel
.p2align 6
.amdhsa_kernel redln1_kernel
  .amdhsa_next_free_vgpr 248
  .amdhsa_next_free_sgpr 48
  .amdhsa_accum_offset 248
  .amdhsa_group_segment_fixed_size 0
  .amdhsa_kernarg_size 104
  .amdhsa_user_sgpr_count 2
  .amdhsa_user_sgpr_kernarg_segment_ptr 1
  .amdhsa_system_sgpr_workgroup_id_x 1
  .amdhsa_float_denorm_mode_32 3
.end_amdhsa_kernel
.p2align 6
.amdhsa_kernel redln2_kernel
  .amdhsa_next_free_vgpr 248
  .amdhsa_next_free_sgpr 48
  .amdhsa_accum_offset 248
  .amdhsa_group_segment_fixed_size 0
  .amdhsa_kernarg_size 104
  .amdhsa_user_sgpr_count 2
  .amdhsa_user_sgpr_kernarg_segment_ptr 1
  .amdhsa_system_sgpr_workgroup_id_x 1
  .amdhsa_float_denorm_mode_32 3
.end_amdhsa_kernel
.p2align 6
.amdhsa_kernel qkvb_kernel
  .amdhsa_next_free_vgpr 448
  .amdhsa_next_free_sgpr 102
  .amdhsa_accum_offset 256
  .amdhsa_group_segment_fixed_size 0
  .amdhsa_kernarg_size 104
  .amdhsa_user_sgpr_count 2
  .amdhsa_user_sgpr_kernarg_segment_ptr 1
  .amdhsa_system_sgpr_workgroup_id_x 1
  .amdhsa_float_denorm_mode_32 3
.end_amdhsa_kernel
.p2align 6
.amdhsa_kernel attnb_kernel
  .amdhsa_next_free_vgpr 200
  .amdhsa_next_free_sgpr 48
  .amdhsa_accum_offset 200
  .amdhsa_group_segment_fixed_size 0
  .amdhsa_kernarg_size 104
  .amdhsa_user_sgpr_count 2
  .amdhsa_user_sgpr_kernarg_segment_ptr 1
  .amdhsa_system_sgpr_workgroup_id_x 1
  .amdhsa_float_denorm_mode_32 3
.end_amdhsa_kernel
.p2align 6
.amdhsa_kernel outb1_kernel
  .amdhsa_next_free_vgpr 128
  .amdhsa_next_free_sgpr 64
  .amdhsa_accum_offset 128
  .amdhsa_group_segment_fixed_size 0
  .amdhsa_kernarg_size 104
  .amdhsa_user_sgpr_count 2
  .amdhsa_user_sgpr_kernarg_segment_ptr 1
  .amdhsa_system_sgpr_workgroup_id_x 1
  .amdhsa_float_denorm_mode_32 3
.end_amdhsa_kernel
.p2align 6
.amdhsa_kernel outb2_kernel
  .amdhsa_next_free_vgpr 128
  .amdhsa_next_free_sgpr 64
  .amdhsa_accum_offset 128
  .amdhsa_group_segment_fixed_size 0
  .amdhsa_kernarg_size 104
  .amdhsa_user_sgpr_count 2
  .amdhsa_user_sgpr_kernarg_segment_ptr 1
  .amdhsa_system_sgpr_workgroup_id_x 1
  .amdhsa_float_denorm_mode_32 3
.end_amdhsa_kernel
```

```asm
; @launch kernel=prep_kernel grid=(2368,1,1) block=(256,1,1) lds=18944
; @launch kernel=reca_kernel grid=(256,1,1) block=(256,1,1) lds=81920
; @launch kernel=fin_kernel grid=(256,1,1) block=(256,1,1) lds=98304
; @launch kernel=redln1_kernel grid=(128,1,1) block=(256,1,1) lds=512
; @launch kernel=qkvb_kernel grid=(256,1,1) block=(256,1,1) lds=81920
; @launch kernel=attnb_kernel grid=(256,1,1) block=(256,1,1) lds=0
; @launch kernel=outb1_kernel grid=(256,1,1) block=(256,1,1) lds=61440
; @launch kernel=ln2_kernel grid=(128,1,1) block=(256,1,1) lds=512
; @launch kernel=reca_kernel grid=(256,1,1) block=(256,1,1) lds=81920
; @launch kernel=fin_kernel grid=(256,1,1) block=(256,1,1) lds=98304
; @launch kernel=redln2_kernel grid=(128,1,1) block=(256,1,1) lds=512
; @launch kernel=qkvb_kernel grid=(256,1,1) block=(256,1,1) lds=81920
; @launch kernel=attnb_kernel grid=(256,1,1) block=(256,1,1) lds=0
; @launch kernel=outb2_kernel grid=(256,1,1) block=(256,1,1) lds=61440
.amdgcn_target "amdgcn-amd-amdhsa--gfx950"
.text
.globl prep_kernel
.p2align 8
.type prep_kernel,@function
prep_kernel:
  s_cmp_ge_u32 s2, 128
  s_cbranch_scc1 prep_notln5
  s_load_dwordx2 s[12:13], s[0:1], 96
  s_load_dwordx2 s[14:15], s[0:1], 0
  v_lshrrev_b32 v2, 6, v0
  v_and_b32 v3, 63, v0
  s_nop 0
  v_readfirstlane_b32 s16, v2
  s_waitcnt lgkmcnt(0)
  s_mov_b32 s4, s12
  s_mov_b32 s5, s13
  s_mov_b32 s6, 0x10000000
  s_mov_b32 s7, 0x20000
  s_mov_b32 s8, s14
  s_mov_b32 s9, s15
  s_mov_b32 s10, 2621440
  s_mov_b32 s11, 0x20000
  s_mov_b32 s20, 0
  v_and_b32 v2, 15, v3
  v_lshrrev_b32 v4, 4, v3
  s_lshl_b32 s17, s2, 4
  v_add_u32 v1, s17, v2
  v_mul_u32_u24 v1, 1280, v1
  v_lshl_add_u32 v1, v4, 4, v1
  s_mul_i32 s17, s16, 320
  s_add_u32 s20, s20, s17
  buffer_load_dwordx4 v[8:11], v1, s[8:11], s20 offen offset:0
  buffer_load_dwordx4 v[12:15], v1, s[8:11], s20 offen offset:64
  buffer_load_dwordx4 v[16:19], v1, s[8:11], s20 offen offset:128
  buffer_load_dwordx4 v[20:23], v1, s[8:11], s20 offen offset:192
  buffer_load_dwordx4 v[24:27], v1, s[8:11], s20 offen offset:256
  s_sub_u32 s21, 0, s12
  s_and_b32 s21, s21, 0x1fffff
  s_add_u32 s21, s21, 2097152
  v_mov_b32 v68, -1
  v_mov_b32 v69, -1
  v_mov_b32 v70, -1
  v_mov_b32 v71, -1
  v_lshlrev_b32 v72, 4, v0
  s_mul_i32 s22, s2, 12096
  s_add_u32 s22, s22, 0
  s_mul_i32 s23, s2, 12288
  s_add_u32 s23, s23, s21
  buffer_store_dwordx4 v[68:71], v72, s[4:7], s22 offen
  s_add_u32 s22, s22, 4096
  buffer_store_dwordx4 v[68:71], v72, s[4:7], s22 offen
  s_add_u32 s22, s22, 4096
  v_mov_b32 v73, 0x80000000
  v_cmp_gt_u32 vcc, 244, v0
  s_nop 1
  v_cndmask_b32 v73, v73, v72, vcc
  buffer_store_dwordx4 v[68:71], v73, s[4:7], s22 offen
  buffer_store_dwordx4 v[68:71], v72, s[4:7], s23 offen
  s_add_u32 s23, s23, 4096
  buffer_store_dwordx4 v[68:71], v72, s[4:7], s23 offen
  s_add_u32 s23, s23, 4096
  buffer_store_dwordx4 v[68:71], v72, s[4:7], s23 offen
  s_add_u32 s23, s23, 4096
  s_mul_i32 s23, s2, 2048
  s_add_u32 s23, s23, s21
  s_add_u32 s23, s23, 1572864
  v_mov_b32 v73, 0x80000000
  v_cmp_gt_u32 vcc, 128, v0
  s_nop 1
  v_cndmask_b32 v73, v73, v72, vcc
  buffer_store_dwordx4 v[68:71], v73, s[4:7], s23 offen sc1
  v_lshlrev_b32 v5, 2, v2
  s_lshl_b32 s17, s16, 6
  v_add_u32 v1, s17, v5
  s_waitcnt vmcnt(7)
  v_lshlrev_b32 v28, 16, v8
  v_and_b32 v29, 0xffff0000, v8
  v_lshlrev_b32 v30, 16, v9
  v_and_b32 v31, 0xffff0000, v9
  v_lshlrev_b32 v32, 16, v10
  v_and_b32 v33, 0xffff0000, v10
  v_lshlrev_b32 v34, 16, v11
  v_and_b32 v35, 0xffff0000, v11
  v_lshlrev_b32 v36, 16, v12
  v_and_b32 v37, 0xffff0000, v12
  v_lshlrev_b32 v38, 16, v13
  v_and_b32 v39, 0xffff0000, v13
  v_lshlrev_b32 v40, 16, v14
  v_and_b32 v41, 0xffff0000, v14
  v_lshlrev_b32 v42, 16, v15
  v_and_b32 v43, 0xffff0000, v15
  v_lshlrev_b32 v44, 16, v16
  v_and_b32 v45, 0xffff0000, v16
  v_lshlrev_b32 v46, 16, v17
  v_and_b32 v47, 0xffff0000, v17
  v_lshlrev_b32 v48, 16, v18
  v_and_b32 v49, 0xffff0000, v18
  v_lshlrev_b32 v50, 16, v19
  v_and_b32 v51, 0xffff0000, v19
  v_lshlrev_b32 v52, 16, v20
  v_and_b32 v53, 0xffff0000, v20
  v_lshlrev_b32 v54, 16, v21
  v_and_b32 v55, 0xffff0000, v21
  v_lshlrev_b32 v56, 16, v22
  v_and_b32 v57, 0xffff0000, v22
  v_lshlrev_b32 v58, 16, v23
  v_and_b32 v59, 0xffff0000, v23
  v_lshlrev_b32 v60, 16, v24
  v_and_b32 v61, 0xffff0000, v24
  v_lshlrev_b32 v62, 16, v25
  v_and_b32 v63, 0xffff0000, v25
  v_lshlrev_b32 v64, 16, v26
  v_and_b32 v65, 0xffff0000, v26
  v_lshlrev_b32 v66, 16, v27
  v_and_b32 v67, 0xffff0000, v27
  v_pk_add_f32 v[6:7], v[28:29], v[30:31]
  v_pk_add_f32 v[6:7], v[6:7], v[32:33]
  v_pk_add_f32 v[6:7], v[6:7], v[34:35]
  v_pk_add_f32 v[6:7], v[6:7], v[36:37]
  v_pk_add_f32 v[6:7], v[6:7], v[38:39]
  v_pk_add_f32 v[6:7], v[6:7], v[40:41]
  v_pk_add_f32 v[6:7], v[6:7], v[42:43]
  v_pk_add_f32 v[6:7], v[6:7], v[44:45]
  v_pk_add_f32 v[6:7], v[6:7], v[46:47]
  v_pk_add_f32 v[6:7], v[6:7], v[48:49]
  v_pk_add_f32 v[6:7], v[6:7], v[50:51]
  v_pk_add_f32 v[6:7], v[6:7], v[52:53]
  v_pk_add_f32 v[6:7], v[6:7], v[54:55]
  v_pk_add_f32 v[6:7], v[6:7], v[56:57]
  v_pk_add_f32 v[6:7], v[6:7], v[58:59]
  v_pk_add_f32 v[6:7], v[6:7], v[60:61]
  v_pk_add_f32 v[6:7], v[6:7], v[62:63]
  v_pk_add_f32 v[6:7], v[6:7], v[64:65]
  v_pk_add_f32 v[6:7], v[6:7], v[66:67]
  v_add_f32 v4, v6, v7
  v_mov_b32 v2, v4
  s_nop 1
  v_permlane32_swap_b32 v4, v2
  v_add_f32 v4, v4, v2
  v_mov_b32 v2, v4
  s_nop 1
  v_permlane16_swap_b32 v4, v2
  v_add_f32 v4, v4, v2
  ds_write_b32 v1, v4 offset:0
  s_waitcnt lgkmcnt(0)
  s_barrier
  ds_read_b32 v4, v5 offset:0
  ds_read_b32 v2, v5 offset:64
  ds_read_b32 v3, v5 offset:128
  ds_read_b32 v6, v5 offset:192
  s_waitcnt lgkmcnt(0)
  v_add_f32 v4, v4, v2
  v_add_f32 v3, v3, v6
  v_add_f32 v4, v4, v3
  v_mul_f32 v4, 0x3acccccd, v4
  v_sub_f32 v28, v28, v4
  v_sub_f32 v29, v29, v4
  v_sub_f32 v30, v30, v4
  v_sub_f32 v31, v31, v4
  v_sub_f32 v32, v32, v4
  v_sub_f32 v33, v33, v4
  v_sub_f32 v34, v34, v4
  v_sub_f32 v35, v35, v4
  v_sub_f32 v36, v36, v4
  v_sub_f32 v37, v37, v4
  v_sub_f32 v38, v38, v4
  v_sub_f32 v39, v39, v4
  v_sub_f32 v40, v40, v4
  v_sub_f32 v41, v41, v4
  v_sub_f32 v42, v42, v4
  v_sub_f32 v43, v43, v4
  v_sub_f32 v44, v44, v4
  v_sub_f32 v45, v45, v4
  v_sub_f32 v46, v46, v4
  v_sub_f32 v47, v47, v4
  v_sub_f32 v48, v48, v4
  v_sub_f32 v49, v49, v4
  v_sub_f32 v50, v50, v4
  v_sub_f32 v51, v51, v4
  v_sub_f32 v52, v52, v4
  v_sub_f32 v53, v53, v4
  v_sub_f32 v54, v54, v4
  v_sub_f32 v55, v55, v4
  v_sub_f32 v56, v56, v4
  v_sub_f32 v57, v57, v4
  v_sub_f32 v58, v58, v4
  v_sub_f32 v59, v59, v4
  v_sub_f32 v60, v60, v4
  v_sub_f32 v61, v61, v4
  v_sub_f32 v62, v62, v4
  v_sub_f32 v63, v63, v4
  v_sub_f32 v64, v64, v4
  v_sub_f32 v65, v65, v4
  v_sub_f32 v66, v66, v4
  v_sub_f32 v67, v67, v4
  v_mul_f32 v6, v28, v28
  v_mul_f32 v7, v29, v29
  v_fmac_f32 v6, v30, v30
  v_fmac_f32 v7, v31, v31
  v_fmac_f32 v6, v32, v32
  v_fmac_f32 v7, v33, v33
  v_fmac_f32 v6, v34, v34
  v_fmac_f32 v7, v35, v35
  v_fmac_f32 v6, v36, v36
  v_fmac_f32 v7, v37, v37
  v_fmac_f32 v6, v38, v38
  v_fmac_f32 v7, v39, v39
  v_fmac_f32 v6, v40, v40
  v_fmac_f32 v7, v41, v41
  v_fmac_f32 v6, v42, v42
  v_fmac_f32 v7, v43, v43
  v_fmac_f32 v6, v44, v44
  v_fmac_f32 v7, v45, v45
  v_fmac_f32 v6, v46, v46
  v_fmac_f32 v7, v47, v47
  v_fmac_f32 v6, v48, v48
  v_fmac_f32 v7, v49, v49
  v_fmac_f32 v6, v50, v50
  v_fmac_f32 v7, v51, v51
  v_fmac_f32 v6, v52, v52
  v_fmac_f32 v7, v53, v53
  v_fmac_f32 v6, v54, v54
  v_fmac_f32 v7, v55, v55
  v_fmac_f32 v6, v56, v56
  v_fmac_f32 v7, v57, v57
  v_fmac_f32 v6, v58, v58
  v_fmac_f32 v7, v59, v59
  v_fmac_f32 v6, v60, v60
  v_fmac_f32 v7, v61, v61
  v_fmac_f32 v6, v62, v62
  v_fmac_f32 v7, v63, v63
  v_fmac_f32 v6, v64, v64
  v_fmac_f32 v7, v65, v65
  v_fmac_f32 v6, v66, v66
  v_fmac_f32 v7, v67, v67
  v_add_f32 v4, v6, v7
  v_mov_b32 v2, v4
  s_nop 1
  v_permlane32_swap_b32 v4, v2
  v_add_f32 v4, v4, v2
  v_mov_b32 v2, v4
  s_nop 1
  v_permlane16_swap_b32 v4, v2
  v_add_f32 v4, v4, v2
  ds_write_b32 v1, v4 offset:256
  s_waitcnt lgkmcnt(0)
  s_barrier
  ds_read_b32 v4, v5 offset:256
  ds_read_b32 v2, v5 offset:320
  ds_read_b32 v3, v5 offset:384
  ds_read_b32 v6, v5 offset:448
  s_waitcnt lgkmcnt(0)
  v_add_f32 v4, v4, v2
  v_add_f32 v3, v3, v6
  v_add_f32 v4, v4, v3
  v_mov_b32 v2, 0x3727c5ac
  v_fmac_f32 v2, 0x3acccccd, v4
  v_rsq_f32 v4, v2
  s_nop 0
  v_mul_f32 v28, v28, v4
  v_mul_f32 v29, v29, v4
  v_mul_f32 v30, v30, v4
  v_mul_f32 v31, v31, v4
  v_mul_f32 v32, v32, v4
  v_mul_f32 v33, v33, v4
  v_mul_f32 v34, v34, v4
  v_mul_f32 v35, v35, v4
  v_mul_f32 v36, v36, v4
  v_mul_f32 v37, v37, v4
  v_mul_f32 v38, v38, v4
  v_mul_f32 v39, v39, v4
  v_mul_f32 v40, v40, v4
  v_mul_f32 v41, v41, v4
  v_mul_f32 v42, v42, v4
  v_mul_f32 v43, v43, v4
  v_mul_f32 v44, v44, v4
  v_mul_f32 v45, v45, v4
  v_mul_f32 v46, v46, v4
  v_mul_f32 v47, v47, v4
  v_mul_f32 v48, v48, v4
  v_mul_f32 v49, v49, v4
  v_mul_f32 v50, v50, v4
  v_mul_f32 v51, v51, v4
  v_mul_f32 v52, v52, v4
  v_mul_f32 v53, v53, v4
  v_mul_f32 v54, v54, v4
  v_mul_f32 v55, v55, v4
  v_mul_f32 v56, v56, v4
  v_mul_f32 v57, v57, v4
  v_mul_f32 v58, v58, v4
  v_mul_f32 v59, v59, v4
  v_mul_f32 v60, v60, v4
  v_mul_f32 v61, v61, v4
  v_mul_f32 v62, v62, v4
  v_mul_f32 v63, v63, v4
  v_mul_f32 v64, v64, v4
  v_mul_f32 v65, v65, v4
  v_mul_f32 v66, v66, v4
  v_mul_f32 v67, v67, v4
  v_cvt_pk_bf16_f32 v8, v28, v29
  v_cvt_pk_bf16_f32 v9, v30, v31
  v_cvt_pk_bf16_f32 v10, v32, v33
  v_cvt_pk_bf16_f32 v11, v34, v35
  v_cvt_pk_bf16_f32 v12, v36, v37
  v_cvt_pk_bf16_f32 v13, v38, v39
  v_cvt_pk_bf16_f32 v14, v40, v41
  v_cvt_pk_bf16_f32 v15, v42, v43
  v_cvt_pk_bf16_f32 v16, v44, v45
  v_cvt_pk_bf16_f32 v17, v46, v47
  v_cvt_pk_bf16_f32 v18, v48, v49
  v_cvt_pk_bf16_f32 v19, v50, v51
  v_cvt_pk_bf16_f32 v20, v52, v53
  v_cvt_pk_bf16_f32 v21, v54, v55
  v_cvt_pk_bf16_f32 v22, v56, v57
  v_cvt_pk_bf16_f32 v23, v58, v59
  v_cvt_pk_bf16_f32 v24, v60, v61
  v_cvt_pk_bf16_f32 v25, v62, v63
  v_cvt_pk_bf16_f32 v26, v64, v65
  v_cvt_pk_bf16_f32 v27, v66, v67
  v_and_b32 v3, 63, v0
  v_lshlrev_b32 v1, 4, v3
  s_mul_i32 s17, s2, 20480
  s_mul_i32 s18, s16, 5120
  s_add_u32 s17, s17, s18
  s_add_u32 s17, s17, 153616384
  buffer_store_dwordx4 v[8:11], v1, s[4:7], s17 offen offset:0
  buffer_store_dwordx4 v[12:15], v1, s[4:7], s17 offen offset:1024
  buffer_store_dwordx4 v[16:19], v1, s[4:7], s17 offen offset:2048
  buffer_store_dwordx4 v[20:23], v1, s[4:7], s17 offen offset:3072
  s_add_u32 s17, s17, 4096
  buffer_store_dwordx4 v[24:27], v1, s[4:7], s17 offen offset:0
  s_endpgm
prep_notln5:
  s_sub_u32 s2, s2, 128
  s_cmp_ge_u32 s2, 2240
  s_cbranch_scc1 prep_exit1
  s_load_dwordx2 s[12:13], s[0:1], 96
  s_load_dwordx4 s[16:19], s[0:1], 16
  s_load_dwordx4 s[20:23], s[0:1], 32
  s_load_dwordx4 s[24:27], s[0:1], 64
  v_lshrrev_b32 v6, 6, v0
  v_and_b32 v1, 63, v0
  s_nop 0
  v_readfirstlane_b32 s14, v6
  v_lshlrev_b32 v5, 4, v1
  s_lshl_b32 s15, s2, 2
  s_nop 1
  s_add_u32 s15, s15, s14
  s_add_u32 s28, s15, 7680
  s_sub_u32 s29, s15, 1280
  s_cmp_lt_u32 s15, 1280
  s_cselect_b32 s15, s28, s29
  s_waitcnt lgkmcnt(0)
  s_mov_b32 s4, s12
  s_mov_b32 s5, s13
  s_mov_b32 s6, 0x10000000
  s_mov_b32 s7, 0x20000
  s_mov_b32 s11, 0x20000
  v_and_b32 v2, 15, v1
  v_lshrrev_b32 v3, 4, v1
  s_cmp_ge_u32 s15, 5760
  s_cbranch_scc1 prep_s22
  s_mul_hi_u32 s31, s15, 2236963
  s_mul_i32 s32, s31, 1920
  s_sub_u32 s32, s15, s32
  s_mul_hi_u32 s33, s32, 214748365
  s_mul_i32 s34, s33, 20
  s_sub_u32 s34, s32, s34
  s_cmp_eq_u32 s31, 0
  s_cselect_b32 s8, s16, s18
  s_cselect_b32 s9, s17, s19
  s_cmp_eq_u32 s31, 2
  s_cselect_b32 s8, s20, s8
  s_cselect_b32 s9, s21, s9
  s_mov_b32 s10, 7864320
  s_mul_i32 s35, s31, 7864320
  s_add_u32 s35, s35, 6291456
  v_lshrrev_b32 v6, 3, v1
  s_lshl_b32 s36, s34, 5
  v_add_u32 v6, s36, v6
  s_mov_b32 s37, 12288
  v_mul_lo_u32 v4, v6, s37
  s_lshl_b32 s36, s33, 7
  v_and_b32 v6, 7, v1
  v_lshl_add_u32 v4, v6, 4, v4
  v_add_u32 v4, s36, v4
  v_lshrrev_b32 v6, 3, v1
  v_mul_u32_u24 v12, 144, v6
  v_and_b32 v6, 7, v1
  v_lshl_add_u32 v12, v6, 4, v12
  s_mul_i32 s36, s14, 4608
  s_add_u32 s36, s36, 512
  v_add_u32 v12, s36, v12
  s_mov_b32 s29, 0
  buffer_load_dwordx4 v[16:19], v4, s[8:11], s29 offen
  s_mov_b32 s29, 98304
  buffer_load_dwordx4 v[20:23], v4, s[8:11], s29 offen
  s_mov_b32 s29, 196608
  buffer_load_dwordx4 v[24:27], v4, s[8:11], s29 offen
  s_mov_b32 s29, 294912
  buffer_load_dwordx4 v[28:31], v4, s[8:11], s29 offen
  v_bfe_u32 v6, v1, 2, 2
  v_lshlrev_b32 v13, 3, v3
  v_add_u32 v13, v13, v6
  v_mul_u32_u24 v13, 144, v13
  v_and_b32 v6, 3, v1
  v_lshl_add_u32 v13, v6, 3, v13
  v_add_u32 v13, s36, v13
  s_waitcnt vmcnt(3)
  ds_write_b128 v12, v[16:19] offset:0
  s_waitcnt vmcnt(2)
  ds_write_b128 v12, v[20:23] offset:1152
  s_waitcnt vmcnt(1)
  ds_write_b128 v12, v[24:27] offset:2304
  s_waitcnt vmcnt(0)
  ds_write_b128 v12, v[28:31] offset:3456
  s_waitcnt lgkmcnt(0)
  ds_read_b64_tr_b16 v[48:49], v13 offset:0
  ds_read_b64_tr_b16 v[50:51], v13 offset:576
  ds_read_b64_tr_b16 v[52:53], v13 offset:32
  ds_read_b64_tr_b16 v[54:55], v13 offset:608
  ds_read_b64_tr_b16 v[56:57], v13 offset:64
  ds_read_b64_tr_b16 v[58:59], v13 offset:640
  ds_read_b64_tr_b16 v[60:61], v13 offset:96
  ds_read_b64_tr_b16 v[62:63], v13 offset:672
  s_waitcnt lgkmcnt(6)
  s_lshl_b32 s30, s33, 2
  s_add_u32 s30, s30, 0
  s_mul_i32 s30, s30, 20
  s_add_u32 s30, s30, s34
  s_lshl_b32 s30, s30, 10
  s_add_u32 s30, s30, s35
  buffer_store_dwordx4 v[48:51], v5, s[4:7], s30 offen
  s_waitcnt lgkmcnt(4)
  s_lshl_b32 s30, s33, 2
  s_add_u32 s30, s30, 1
  s_mul_i32 s30, s30, 20
  s_add_u32 s30, s30, s34
  s_lshl_b32 s30, s30, 10
  s_add_u32 s30, s30, s35
  buffer_store_dwordx4 v[52:55], v5, s[4:7], s30 offen
  s_waitcnt lgkmcnt(2)
  s_lshl_b32 s30, s33, 2
  s_add_u32 s30, s30, 2
  s_mul_i32 s30, s30, 20
  s_add_u32 s30, s30, s34
  s_lshl_b32 s30, s30, 10
  s_add_u32 s30, s30, s35
  buffer_store_dwordx4 v[56:59], v5, s[4:7], s30 offen
  s_waitcnt lgkmcnt(0)
  s_lshl_b32 s30, s33, 2
  s_add_u32 s30, s30, 3
  s_mul_i32 s30, s30, 20
  s_add_u32 s30, s30, s34
  s_lshl_b32 s30, s30, 10
  s_add_u32 s30, s30, s35
  buffer_store_dwordx4 v[60:63], v5, s[4:7], s30 offen
  s_branch prep_exit1
prep_s22:
  s_sub_u32 s15, s15, 5760
  s_cmp_ge_u32 s15, 1920
  s_cbranch_scc1 prep_s33
  s_mul_hi_u32 s33, s15, 22369622
  s_mul_i32 s34, s33, 192
  s_sub_u32 s34, s15, s34
  s_mov_b32 s8, s22
  s_mov_b32 s9, s23
  s_mov_b32 s10, 7864320
  v_lshrrev_b32 v6, 3, v1
  s_lshl_b32 s36, s34, 5
  v_add_u32 v6, s36, v6
  v_mul_u32_u24 v4, 1280, v6
  s_lshl_b32 s36, s33, 7
  v_and_b32 v6, 7, v1
  v_lshl_add_u32 v4, v6, 4, v4
  v_add_u32 v4, s36, v4
  v_lshrrev_b32 v6, 3, v1
  v_mul_u32_u24 v12, 144, v6
  v_and_b32 v6, 7, v1
  v_lshl_add_u32 v12, v6, 4, v12
  s_mul_i32 s36, s14, 4608
  s_add_u32 s36, s36, 512
  v_add_u32 v12, s36, v12
  s_mov_b32 s29, 0
  buffer_load_dwordx4 v[16:19], v4, s[8:11], s29 offen
  s_mov_b32 s29, 10240
  buffer_load_dwordx4 v[20:23], v4, s[8:11], s29 offen
  s_mov_b32 s29, 20480
  buffer_load_dwordx4 v[24:27], v4, s[8:11], s29 offen
  s_mov_b32 s29, 30720
  buffer_load_dwordx4 v[28:31], v4, s[8:11], s29 offen
  v_bfe_u32 v6, v1, 2, 2
  v_lshlrev_b32 v13, 2, v3
  v_add_u32 v13, v13, v6
  v_mul_u32_u24 v13, 144, v13
  v_and_b32 v6, 3, v1
  v_lshl_add_u32 v13, v6, 4, v13
  v_add_u32 v13, s36, v13
  s_waitcnt vmcnt(3)
  ds_write_b128 v12, v[16:19] offset:0
  s_waitcnt vmcnt(2)
  ds_write_b128 v12, v[20:23] offset:1152
  s_waitcnt vmcnt(1)
  ds_write_b128 v12, v[24:27] offset:2304
  s_waitcnt vmcnt(0)
  ds_write_b128 v12, v[28:31] offset:3456
  s_waitcnt lgkmcnt(0)
  ds_read_b64_tr_b16 v[48:49], v13 offset:0
  ds_read_b64_tr_b16 v[50:51], v13 offset:2304
  ds_read_b64_tr_b16 v[52:53], v13 offset:8
  ds_read_b64_tr_b16 v[54:55], v13 offset:2312
  ds_read_b64_tr_b16 v[56:57], v13 offset:64
  ds_read_b64_tr_b16 v[58:59], v13 offset:2368
  ds_read_b64_tr_b16 v[60:61], v13 offset:72
  ds_read_b64_tr_b16 v[62:63], v13 offset:2376
  s_waitcnt lgkmcnt(6)
  s_lshl_b32 s30, s33, 2
  s_add_u32 s30, s30, 0
  s_mul_i32 s30, s30, 192
  s_add_u32 s30, s30, s34
  s_lshl_b32 s30, s30, 10
  s_add_u32 s30, s30, 29884416
  buffer_store_dwordx4 v[48:51], v5, s[4:7], s30 offen
  s_waitcnt lgkmcnt(4)
  s_lshl_b32 s30, s33, 2
  s_add_u32 s30, s30, 1
  s_mul_i32 s30, s30, 192
  s_add_u32 s30, s30, s34
  s_lshl_b32 s30, s30, 10
  s_add_u32 s30, s30, 29884416
  buffer_store_dwordx4 v[52:55], v5, s[4:7], s30 offen
  s_waitcnt lgkmcnt(2)
  s_lshl_b32 s30, s33, 2
  s_add_u32 s30, s30, 2
  s_mul_i32 s30, s30, 192
  s_add_u32 s30, s30, s34
  s_lshl_b32 s30, s30, 10
  s_add_u32 s30, s30, 29884416
  buffer_store_dwordx4 v[56:59], v5, s[4:7], s30 offen
  s_waitcnt lgkmcnt(0)
  s_lshl_b32 s30, s33, 2
  s_add_u32 s30, s30, 3
  s_mul_i32 s30, s30, 192
  s_add_u32 s30, s30, s34
  s_lshl_b32 s30, s30, 10
  s_add_u32 s30, s30, 29884416
  buffer_store_dwordx4 v[60:63], v5, s[4:7], s30 offen
  s_branch prep_exit1
prep_s33:
  s_sub_u32 s15, s15, 1920
  s_cmp_ge_u32 s15, 960
  s_cbranch_scc1 prep_s44
  s_mul_hi_u32 s33, s15, 107374183
  s_mul_i32 s34, s33, 40
  s_sub_u32 s34, s15, s34
  s_mov_b32 s8, s24
  s_mov_b32 s9, s25
  s_mov_b32 s10, 2457600
  v_lshrrev_b32 v6, 5, v1
  v_lshlrev_b32 v6, 3, v6
  s_lshl_b32 s36, s34, 4
  v_add_u32 v6, s36, v6
  v_mul_u32_u24 v4, 3840, v6
  v_and_b32 v6, 31, v1
  v_lshl_add_u32 v4, v6, 1, v4
  s_mul_i32 s36, s33, 160
  v_add_u32 v4, s36, v4
  v_cmp_gt_u32 vcc, 20, v6
  v_mov_b32 v6, 0x80000000
  s_nop 0
  v_cndmask_b32 v4, v6, v4, vcc
  s_mov_b32 s29, 0
  buffer_load_ushort v16, v4, s[8:11], s29 offen
  s_mov_b32 s29, 3840
  buffer_load_ushort v17, v4, s[8:11], s29 offen
  s_mov_b32 s29, 7680
  buffer_load_ushort v18, v4, s[8:11], s29 offen
  s_mov_b32 s29, 11520
  buffer_load_ushort v19, v4, s[8:11], s29 offen
  s_mov_b32 s29, 15360
  buffer_load_ushort v20, v4, s[8:11], s29 offen
  s_mov_b32 s29, 19200
  buffer_load_ushort v21, v4, s[8:11], s29 offen
  s_mov_b32 s29, 23040
  buffer_load_ushort v22, v4, s[8:11], s29 offen
  s_mov_b32 s29, 26880
  buffer_load_ushort v23, v4, s[8:11], s29 offen
  s_mov_b32 s29, 40
  buffer_load_ushort v24, v4, s[8:11], s29 offen
  s_mov_b32 s29, 3880
  buffer_load_ushort v25, v4, s[8:11], s29 offen
  s_mov_b32 s29, 7720
  buffer_load_ushort v26, v4, s[8:11], s29 offen
  s_mov_b32 s29, 11560
  buffer_load_ushort v27, v4, s[8:11], s29 offen
  s_mov_b32 s29, 15400
  buffer_load_ushort v28, v4, s[8:11], s29 offen
  s_mov_b32 s29, 19240
  buffer_load_ushort v29, v4, s[8:11], s29 offen
  s_mov_b32 s29, 23080
  buffer_load_ushort v30, v4, s[8:11], s29 offen
  s_mov_b32 s29, 26920
  buffer_load_ushort v31, v4, s[8:11], s29 offen
  s_mov_b32 s29, 80
  buffer_load_ushort v32, v4, s[8:11], s29 offen
  s_mov_b32 s29, 3920
  buffer_load_ushort v33, v4, s[8:11], s29 offen
  s_mov_b32 s29, 7760
  buffer_load_ushort v34, v4, s[8:11], s29 offen
  s_mov_b32 s29, 11600
  buffer_load_ushort v35, v4, s[8:11], s29 offen
  s_mov_b32 s29, 15440
  buffer_load_ushort v36, v4, s[8:11], s29 offen
  s_mov_b32 s29, 19280
  buffer_load_ushort v37, v4, s[8:11], s29 offen
  s_mov_b32 s29, 23120
  buffer_load_ushort v38, v4, s[8:11], s29 offen
  s_mov_b32 s29, 26960
  buffer_load_ushort v39, v4, s[8:11], s29 offen
  s_mov_b32 s29, 120
  buffer_load_ushort v40, v4, s[8:11], s29 offen
  s_mov_b32 s29, 3960
  buffer_load_ushort v41, v4, s[8:11], s29 offen
  s_mov_b32 s29, 7800
  buffer_load_ushort v42, v4, s[8:11], s29 offen
  s_mov_b32 s29, 11640
  buffer_load_ushort v43, v4, s[8:11], s29 offen
  s_mov_b32 s29, 15480
  buffer_load_ushort v44, v4, s[8:11], s29 offen
  s_mov_b32 s29, 19320
  buffer_load_ushort v45, v4, s[8:11], s29 offen
  s_mov_b32 s29, 23160
  buffer_load_ushort v46, v4, s[8:11], s29 offen
  s_mov_b32 s29, 27000
  buffer_load_ushort v47, v4, s[8:11], s29 offen
  s_waitcnt vmcnt(24)
  v_lshl_or_b32 v48, v17, 16, v16
  v_lshl_or_b32 v49, v19, 16, v18
  v_lshl_or_b32 v50, v21, 16, v20
  v_lshl_or_b32 v51, v23, 16, v22
  s_lshl_b32 s30, s33, 2
  s_add_u32 s30, s30, 0
  s_mul_i32 s30, s30, 40
  s_add_u32 s30, s30, s34
  s_lshl_b32 s30, s30, 10
  s_add_u32 s30, s30, 156237824
  buffer_store_dwordx4 v[48:51], v5, s[4:7], s30 offen
  s_waitcnt vmcnt(17)
  v_lshl_or_b32 v52, v25, 16, v24
  v_lshl_or_b32 v53, v27, 16, v26
  v_lshl_or_b32 v54, v29, 16, v28
  v_lshl_or_b32 v55, v31, 16, v30
  s_lshl_b32 s30, s33, 2
  s_add_u32 s30, s30, 1
  s_mul_i32 s30, s30, 40
  s_add_u32 s30, s30, s34
  s_lshl_b32 s30, s30, 10
  s_add_u32 s30, s30, 156237824
  buffer_store_dwordx4 v[52:55], v5, s[4:7], s30 offen
  s_waitcnt vmcnt(10)
  v_lshl_or_b32 v56, v33, 16, v32
  v_lshl_or_b32 v57, v35, 16, v34
  v_lshl_or_b32 v58, v37, 16, v36
  v_lshl_or_b32 v59, v39, 16, v38
  s_lshl_b32 s30, s33, 2
  s_add_u32 s30, s30, 2
  s_mul_i32 s30, s30, 40
  s_add_u32 s30, s30, s34
  s_lshl_b32 s30, s30, 10
  s_add_u32 s30, s30, 156237824
  buffer_store_dwordx4 v[56:59], v5, s[4:7], s30 offen
  s_waitcnt vmcnt(3)
  v_lshl_or_b32 v60, v41, 16, v40
  v_lshl_or_b32 v61, v43, 16, v42
  v_lshl_or_b32 v62, v45, 16, v44
  v_lshl_or_b32 v63, v47, 16, v46
  s_lshl_b32 s30, s33, 2
  s_add_u32 s30, s30, 3
  s_mul_i32 s30, s30, 40
  s_add_u32 s30, s30, s34
  s_lshl_b32 s30, s30, 10
  s_add_u32 s30, s30, 156237824
  buffer_store_dwordx4 v[60:63], v5, s[4:7], s30 offen
  s_branch prep_exit1
prep_s44:
  s_sub_u32 s15, s15, 960
  s_mul_hi_u32 s33, s15, 134217728
  s_and_b32 s34, s15, 31
  s_lshr_b32 s33, s15, 5
  s_mov_b32 s8, s26
  s_mov_b32 s9, s27
  s_mov_b32 s10, 819200
  v_lshrrev_b32 v6, 1, v3
  v_lshlrev_b32 v6, 4, v6
  v_and_b32 v7, 1, v3
  v_lshl_add_u32 v6, v7, 2, v6
  v_mov_b32 v8, v6
  s_mul_i32 s36, s34, 20
  v_add_u32 v6, s36, v6
  v_mul_u32_u24 v4, 1280, v6
  v_lshrrev_b32 v6, 2, v2
  v_lshl_add_u32 v4, v6, 4, v4
  v_and_b32 v6, 3, v2
  v_lshl_add_u32 v4, v6, 1, v4
  s_lshl_b32 s36, s33, 7
  v_add_u32 v4, s36, v4
  v_mov_b32 v9, 0x80000000
  v_cmp_gt_u32 vcc, 17, v8
  s_nop 1
  v_cndmask_b32 v10, v9, v4, vcc
  v_cmp_gt_u32 vcc, 9, v8
  s_nop 1
  v_cndmask_b32 v11, v9, v4, vcc
  s_mov_b32 s29, 0
  buffer_load_ushort v16, v10, s[8:11], s29 offen
  s_mov_b32 s29, 1280
  buffer_load_ushort v17, v10, s[8:11], s29 offen
  s_mov_b32 s29, 2560
  buffer_load_ushort v18, v10, s[8:11], s29 offen
  s_mov_b32 s29, 3840
  buffer_load_ushort v19, v10, s[8:11], s29 offen
  s_mov_b32 s29, 10240
  buffer_load_ushort v20, v11, s[8:11], s29 offen
  s_mov_b32 s29, 11520
  buffer_load_ushort v21, v11, s[8:11], s29 offen
  s_mov_b32 s29, 12800
  buffer_load_ushort v22, v11, s[8:11], s29 offen
  s_mov_b32 s29, 14080
  buffer_load_ushort v23, v11, s[8:11], s29 offen
  s_mov_b32 s29, 8
  buffer_load_ushort v24, v10, s[8:11], s29 offen
  s_mov_b32 s29, 1288
  buffer_load_ushort v25, v10, s[8:11], s29 offen
  s_mov_b32 s29, 2568
  buffer_load_ushort v26, v10, s[8:11], s29 offen
  s_mov_b32 s29, 3848
  buffer_load_ushort v27, v10, s[8:11], s29 offen
  s_mov_b32 s29, 10248
  buffer_load_ushort v28, v11, s[8:11], s29 offen
  s_mov_b32 s29, 11528
  buffer_load_ushort v29, v11, s[8:11], s29 offen
  s_mov_b32 s29, 12808
  buffer_load_ushort v30, v11, s[8:11], s29 offen
  s_mov_b32 s29, 14088
  buffer_load_ushort v31, v11, s[8:11], s29 offen
  s_mov_b32 s29, 64
  buffer_load_ushort v32, v10, s[8:11], s29 offen
  s_mov_b32 s29, 1344
  buffer_load_ushort v33, v10, s[8:11], s29 offen
  s_mov_b32 s29, 2624
  buffer_load_ushort v34, v10, s[8:11], s29 offen
  s_mov_b32 s29, 3904
  buffer_load_ushort v35, v10, s[8:11], s29 offen
  s_mov_b32 s29, 10304
  buffer_load_ushort v36, v11, s[8:11], s29 offen
  s_mov_b32 s29, 11584
  buffer_load_ushort v37, v11, s[8:11], s29 offen
  s_mov_b32 s29, 12864
  buffer_load_ushort v38, v11, s[8:11], s29 offen
  s_mov_b32 s29, 14144
  buffer_load_ushort v39, v11, s[8:11], s29 offen
  s_mov_b32 s29, 72
  buffer_load_ushort v40, v10, s[8:11], s29 offen
  s_mov_b32 s29, 1352
  buffer_load_ushort v41, v10, s[8:11], s29 offen
  s_mov_b32 s29, 2632
  buffer_load_ushort v42, v10, s[8:11], s29 offen
  s_mov_b32 s29, 3912
  buffer_load_ushort v43, v10, s[8:11], s29 offen
  s_mov_b32 s29, 10312
  buffer_load_ushort v44, v11, s[8:11], s29 offen
  s_mov_b32 s29, 11592
  buffer_load_ushort v45, v11, s[8:11], s29 offen
  s_mov_b32 s29, 12872
  buffer_load_ushort v46, v11, s[8:11], s29 offen
  s_mov_b32 s29, 14152
  buffer_load_ushort v47, v11, s[8:11], s29 offen
  s_waitcnt vmcnt(24)
  v_lshl_or_b32 v48, v17, 16, v16
  v_lshl_or_b32 v49, v19, 16, v18
  v_lshl_or_b32 v50, v21, 16, v20
  v_lshl_or_b32 v51, v23, 16, v22
  s_lshl_b32 s30, s33, 2
  s_add_u32 s30, s30, 0
  s_lshl_b32 s30, s30, 5
  s_add_u32 s30, s30, s34
  s_lshl_b32 s30, s30, 10
  s_add_u32 s30, s30, 160169984
  buffer_store_dwordx4 v[48:51], v5, s[4:7], s30 offen
  s_waitcnt vmcnt(17)
  v_lshl_or_b32 v52, v25, 16, v24
  v_lshl_or_b32 v53, v27, 16, v26
  v_lshl_or_b32 v54, v29, 16, v28
  v_lshl_or_b32 v55, v31, 16, v30
  s_lshl_b32 s30, s33, 2
  s_add_u32 s30, s30, 1
  s_lshl_b32 s30, s30, 5
  s_add_u32 s30, s30, s34
  s_lshl_b32 s30, s30, 10
  s_add_u32 s30, s30, 160169984
  buffer_store_dwordx4 v[52:55], v5, s[4:7], s30 offen
  s_waitcnt vmcnt(10)
  v_lshl_or_b32 v56, v33, 16, v32
  v_lshl_or_b32 v57, v35, 16, v34
  v_lshl_or_b32 v58, v37, 16, v36
  v_lshl_or_b32 v59, v39, 16, v38
  s_lshl_b32 s30, s33, 2
  s_add_u32 s30, s30, 2
  s_lshl_b32 s30, s30, 5
  s_add_u32 s30, s30, s34
  s_lshl_b32 s30, s30, 10
  s_add_u32 s30, s30, 160169984
  buffer_store_dwordx4 v[56:59], v5, s[4:7], s30 offen
  s_waitcnt vmcnt(3)
  v_lshl_or_b32 v60, v41, 16, v40
  v_lshl_or_b32 v61, v43, 16, v42
  v_lshl_or_b32 v62, v45, 16, v44
  v_lshl_or_b32 v63, v47, 16, v46
  s_lshl_b32 s30, s33, 2
  s_add_u32 s30, s30, 3
  s_lshl_b32 s30, s30, 5
  s_add_u32 s30, s30, s34
  s_lshl_b32 s30, s30, 10
  s_add_u32 s30, s30, 160169984
  buffer_store_dwordx4 v[60:63], v5, s[4:7], s30 offen
prep_exit1:
  s_endpgm
.globl ln2_kernel
.p2align 8
.type ln2_kernel,@function
ln2_kernel:
  s_cmp_ge_u32 s2, 128
  s_cbranch_scc1 ln2_exit1
  s_load_dwordx2 s[12:13], s[0:1], 96
  s_load_dwordx2 s[14:15], s[0:1], 0
  v_lshrrev_b32 v2, 6, v0
  v_and_b32 v3, 63, v0
  s_nop 0
  v_readfirstlane_b32 s16, v2
  s_waitcnt lgkmcnt(0)
  s_mov_b32 s4, s12
  s_mov_b32 s5, s13
  s_mov_b32 s6, 0x10000000
  s_mov_b32 s7, 0x20000
  s_mov_b32 s8, s12
  s_mov_b32 s9, s13
  s_mov_b32 s10, 0x10000000
  s_mov_b32 s11, 0x20000
  s_mov_b32 s20, 150994944
  v_and_b32 v2, 15, v3
  v_lshrrev_b32 v4, 4, v3
  s_lshl_b32 s17, s2, 4
  v_add_u32 v1, s17, v2
  v_mul_u32_u24 v1, 1280, v1
  v_lshl_add_u32 v1, v4, 4, v1
  s_mul_i32 s17, s16, 320
  s_add_u32 s20, s20, s17
  buffer_load_dwordx4 v[8:11], v1, s[8:11], s20 offen offset:0
  buffer_load_dwordx4 v[12:15], v1, s[8:11], s20 offen offset:64
  buffer_load_dwordx4 v[16:19], v1, s[8:11], s20 offen offset:128
  buffer_load_dwordx4 v[20:23], v1, s[8:11], s20 offen offset:192
  buffer_load_dwordx4 v[24:27], v1, s[8:11], s20 offen offset:256
  s_sub_u32 s21, 0, s12
  s_and_b32 s21, s21, 0x1fffff
  s_add_u32 s21, s21, 2097152
  v_mov_b32 v68, -1
  v_mov_b32 v69, -1
  v_mov_b32 v70, -1
  v_mov_b32 v71, -1
  v_lshlrev_b32 v72, 4, v0
  s_mul_i32 s22, s2, 12096
  s_add_u32 s22, s22, 0
  s_mul_i32 s23, s2, 12288
  s_add_u32 s23, s23, s21
  buffer_store_dwordx4 v[68:71], v72, s[4:7], s22 offen
  s_add_u32 s22, s22, 4096
  buffer_store_dwordx4 v[68:71], v72, s[4:7], s22 offen
  s_add_u32 s22, s22, 4096
  v_mov_b32 v73, 0x80000000
  v_cmp_gt_u32 vcc, 244, v0
  s_nop 1
  v_cndmask_b32 v73, v73, v72, vcc
  buffer_store_dwordx4 v[68:71], v73, s[4:7], s22 offen
  buffer_store_dwordx4 v[68:71], v72, s[4:7], s23 offen
  s_add_u32 s23, s23, 4096
  buffer_store_dwordx4 v[68:71], v72, s[4:7], s23 offen
  s_add_u32 s23, s23, 4096
  buffer_store_dwordx4 v[68:71], v72, s[4:7], s23 offen
  s_add_u32 s23, s23, 4096
  s_mul_i32 s23, s2, 2048
  s_add_u32 s23, s23, s21
  s_add_u32 s23, s23, 1572864
  v_mov_b32 v73, 0x80000000
  v_cmp_gt_u32 vcc, 128, v0
  s_nop 1
  v_cndmask_b32 v73, v73, v72, vcc
  buffer_store_dwordx4 v[68:71], v73, s[4:7], s23 offen sc1
  v_lshlrev_b32 v5, 2, v2
  s_lshl_b32 s17, s16, 6
  v_add_u32 v1, s17, v5
  s_waitcnt vmcnt(7)
  v_lshlrev_b32 v28, 16, v8
  v_and_b32 v29, 0xffff0000, v8
  v_lshlrev_b32 v30, 16, v9
  v_and_b32 v31, 0xffff0000, v9
  v_lshlrev_b32 v32, 16, v10
  v_and_b32 v33, 0xffff0000, v10
  v_lshlrev_b32 v34, 16, v11
  v_and_b32 v35, 0xffff0000, v11
  v_lshlrev_b32 v36, 16, v12
  v_and_b32 v37, 0xffff0000, v12
  v_lshlrev_b32 v38, 16, v13
  v_and_b32 v39, 0xffff0000, v13
  v_lshlrev_b32 v40, 16, v14
  v_and_b32 v41, 0xffff0000, v14
  v_lshlrev_b32 v42, 16, v15
  v_and_b32 v43, 0xffff0000, v15
  v_lshlrev_b32 v44, 16, v16
  v_and_b32 v45, 0xffff0000, v16
  v_lshlrev_b32 v46, 16, v17
  v_and_b32 v47, 0xffff0000, v17
  v_lshlrev_b32 v48, 16, v18
  v_and_b32 v49, 0xffff0000, v18
  v_lshlrev_b32 v50, 16, v19
  v_and_b32 v51, 0xffff0000, v19
  v_lshlrev_b32 v52, 16, v20
  v_and_b32 v53, 0xffff0000, v20
  v_lshlrev_b32 v54, 16, v21
  v_and_b32 v55, 0xffff0000, v21
  v_lshlrev_b32 v56, 16, v22
  v_and_b32 v57, 0xffff0000, v22
  v_lshlrev_b32 v58, 16, v23
  v_and_b32 v59, 0xffff0000, v23
  v_lshlrev_b32 v60, 16, v24
  v_and_b32 v61, 0xffff0000, v24
  v_lshlrev_b32 v62, 16, v25
  v_and_b32 v63, 0xffff0000, v25
  v_lshlrev_b32 v64, 16, v26
  v_and_b32 v65, 0xffff0000, v26
  v_lshlrev_b32 v66, 16, v27
  v_and_b32 v67, 0xffff0000, v27
  v_pk_add_f32 v[6:7], v[28:29], v[30:31]
  v_pk_add_f32 v[6:7], v[6:7], v[32:33]
  v_pk_add_f32 v[6:7], v[6:7], v[34:35]
  v_pk_add_f32 v[6:7], v[6:7], v[36:37]
  v_pk_add_f32 v[6:7], v[6:7], v[38:39]
  v_pk_add_f32 v[6:7], v[6:7], v[40:41]
  v_pk_add_f32 v[6:7], v[6:7], v[42:43]
  v_pk_add_f32 v[6:7], v[6:7], v[44:45]
  v_pk_add_f32 v[6:7], v[6:7], v[46:47]
  v_pk_add_f32 v[6:7], v[6:7], v[48:49]
  v_pk_add_f32 v[6:7], v[6:7], v[50:51]
  v_pk_add_f32 v[6:7], v[6:7], v[52:53]
  v_pk_add_f32 v[6:7], v[6:7], v[54:55]
  v_pk_add_f32 v[6:7], v[6:7], v[56:57]
  v_pk_add_f32 v[6:7], v[6:7], v[58:59]
  v_pk_add_f32 v[6:7], v[6:7], v[60:61]
  v_pk_add_f32 v[6:7], v[6:7], v[62:63]
  v_pk_add_f32 v[6:7], v[6:7], v[64:65]
  v_pk_add_f32 v[6:7], v[6:7], v[66:67]
  v_add_f32 v4, v6, v7
  v_mov_b32 v2, v4
  s_nop 1
  v_permlane32_swap_b32 v4, v2
  v_add_f32 v4, v4, v2
  v_mov_b32 v2, v4
  s_nop 1
  v_permlane16_swap_b32 v4, v2
  v_add_f32 v4, v4, v2
  ds_write_b32 v1, v4 offset:0
  s_waitcnt lgkmcnt(0)
  s_barrier
  ds_read_b32 v4, v5 offset:0
  ds_read_b32 v2, v5 offset:64
  ds_read_b32 v3, v5 offset:128
  ds_read_b32 v6, v5 offset:192
  s_waitcnt lgkmcnt(0)
  v_add_f32 v4, v4, v2
  v_add_f32 v3, v3, v6
  v_add_f32 v4, v4, v3
  v_mul_f32 v4, 0x3acccccd, v4
  v_sub_f32 v28, v28, v4
  v_sub_f32 v29, v29, v4
  v_sub_f32 v30, v30, v4
  v_sub_f32 v31, v31, v4
  v_sub_f32 v32, v32, v4
  v_sub_f32 v33, v33, v4
  v_sub_f32 v34, v34, v4
  v_sub_f32 v35, v35, v4
  v_sub_f32 v36, v36, v4
  v_sub_f32 v37, v37, v4
  v_sub_f32 v38, v38, v4
  v_sub_f32 v39, v39, v4
  v_sub_f32 v40, v40, v4
  v_sub_f32 v41, v41, v4
  v_sub_f32 v42, v42, v4
  v_sub_f32 v43, v43, v4
  v_sub_f32 v44, v44, v4
  v_sub_f32 v45, v45, v4
  v_sub_f32 v46, v46, v4
  v_sub_f32 v47, v47, v4
  v_sub_f32 v48, v48, v4
  v_sub_f32 v49, v49, v4
  v_sub_f32 v50, v50, v4
  v_sub_f32 v51, v51, v4
  v_sub_f32 v52, v52, v4
  v_sub_f32 v53, v53, v4
  v_sub_f32 v54, v54, v4
  v_sub_f32 v55, v55, v4
  v_sub_f32 v56, v56, v4
  v_sub_f32 v57, v57, v4
  v_sub_f32 v58, v58, v4
  v_sub_f32 v59, v59, v4
  v_sub_f32 v60, v60, v4
  v_sub_f32 v61, v61, v4
  v_sub_f32 v62, v62, v4
  v_sub_f32 v63, v63, v4
  v_sub_f32 v64, v64, v4
  v_sub_f32 v65, v65, v4
  v_sub_f32 v66, v66, v4
  v_sub_f32 v67, v67, v4
  v_mul_f32 v6, v28, v28
  v_mul_f32 v7, v29, v29
  v_fmac_f32 v6, v30, v30
  v_fmac_f32 v7, v31, v31
  v_fmac_f32 v6, v32, v32
  v_fmac_f32 v7, v33, v33
  v_fmac_f32 v6, v34, v34
  v_fmac_f32 v7, v35, v35
  v_fmac_f32 v6, v36, v36
  v_fmac_f32 v7, v37, v37
  v_fmac_f32 v6, v38, v38
  v_fmac_f32 v7, v39, v39
  v_fmac_f32 v6, v40, v40
  v_fmac_f32 v7, v41, v41
  v_fmac_f32 v6, v42, v42
  v_fmac_f32 v7, v43, v43
  v_fmac_f32 v6, v44, v44
  v_fmac_f32 v7, v45, v45
  v_fmac_f32 v6, v46, v46
  v_fmac_f32 v7, v47, v47
  v_fmac_f32 v6, v48, v48
  v_fmac_f32 v7, v49, v49
  v_fmac_f32 v6, v50, v50
  v_fmac_f32 v7, v51, v51
  v_fmac_f32 v6, v52, v52
  v_fmac_f32 v7, v53, v53
  v_fmac_f32 v6, v54, v54
  v_fmac_f32 v7, v55, v55
  v_fmac_f32 v6, v56, v56
  v_fmac_f32 v7, v57, v57
  v_fmac_f32 v6, v58, v58
  v_fmac_f32 v7, v59, v59
  v_fmac_f32 v6, v60, v60
  v_fmac_f32 v7, v61, v61
  v_fmac_f32 v6, v62, v62
  v_fmac_f32 v7, v63, v63
  v_fmac_f32 v6, v64, v64
  v_fmac_f32 v7, v65, v65
  v_fmac_f32 v6, v66, v66
  v_fmac_f32 v7, v67, v67
  v_add_f32 v4, v6, v7
  v_mov_b32 v2, v4
  s_nop 1
  v_permlane32_swap_b32 v4, v2
  v_add_f32 v4, v4, v2
  v_mov_b32 v2, v4
  s_nop 1
  v_permlane16_swap_b32 v4, v2
  v_add_f32 v4, v4, v2
  ds_write_b32 v1, v4 offset:256
  s_waitcnt lgkmcnt(0)
  s_barrier
  ds_read_b32 v4, v5 offset:256
  ds_read_b32 v2, v5 offset:320
  ds_read_b32 v3, v5 offset:384
  ds_read_b32 v6, v5 offset:448
  s_waitcnt lgkmcnt(0)
  v_add_f32 v4, v4, v2
  v_add_f32 v3, v3, v6
  v_add_f32 v4, v4, v3
  v_mov_b32 v2, 0x3727c5ac
  v_fmac_f32 v2, 0x3acccccd, v4
  v_rsq_f32 v4, v2
  s_nop 0
  v_mul_f32 v28, v28, v4
  v_mul_f32 v29, v29, v4
  v_mul_f32 v30, v30, v4
  v_mul_f32 v31, v31, v4
  v_mul_f32 v32, v32, v4
  v_mul_f32 v33, v33, v4
  v_mul_f32 v34, v34, v4
  v_mul_f32 v35, v35, v4
  v_mul_f32 v36, v36, v4
  v_mul_f32 v37, v37, v4
  v_mul_f32 v38, v38, v4
  v_mul_f32 v39, v39, v4
  v_mul_f32 v40, v40, v4
  v_mul_f32 v41, v41, v4
  v_mul_f32 v42, v42, v4
  v_mul_f32 v43, v43, v4
  v_mul_f32 v44, v44, v4
  v_mul_f32 v45, v45, v4
  v_mul_f32 v46, v46, v4
  v_mul_f32 v47, v47, v4
  v_mul_f32 v48, v48, v4
  v_mul_f32 v49, v49, v4
  v_mul_f32 v50, v50, v4
  v_mul_f32 v51, v51, v4
  v_mul_f32 v52, v52, v4
  v_mul_f32 v53, v53, v4
  v_mul_f32 v54, v54, v4
  v_mul_f32 v55, v55, v4
  v_mul_f32 v56, v56, v4
  v_mul_f32 v57, v57, v4
  v_mul_f32 v58, v58, v4
  v_mul_f32 v59, v59, v4
  v_mul_f32 v60, v60, v4
  v_mul_f32 v61, v61, v4
  v_mul_f32 v62, v62, v4
  v_mul_f32 v63, v63, v4
  v_mul_f32 v64, v64, v4
  v_mul_f32 v65, v65, v4
  v_mul_f32 v66, v66, v4
  v_mul_f32 v67, v67, v4
  v_cvt_pk_bf16_f32 v8, v28, v29
  v_cvt_pk_bf16_f32 v9, v30, v31
  v_cvt_pk_bf16_f32 v10, v32, v33
  v_cvt_pk_bf16_f32 v11, v34, v35
  v_cvt_pk_bf16_f32 v12, v36, v37
  v_cvt_pk_bf16_f32 v13, v38, v39
  v_cvt_pk_bf16_f32 v14, v40, v41
  v_cvt_pk_bf16_f32 v15, v42, v43
  v_cvt_pk_bf16_f32 v16, v44, v45
  v_cvt_pk_bf16_f32 v17, v46, v47
  v_cvt_pk_bf16_f32 v18, v48, v49
  v_cvt_pk_bf16_f32 v19, v50, v51
  v_cvt_pk_bf16_f32 v20, v52, v53
  v_cvt_pk_bf16_f32 v21, v54, v55
  v_cvt_pk_bf16_f32 v22, v56, v57
  v_cvt_pk_bf16_f32 v23, v58, v59
  v_cvt_pk_bf16_f32 v24, v60, v61
  v_cvt_pk_bf16_f32 v25, v62, v63
  v_cvt_pk_bf16_f32 v26, v64, v65
  v_cvt_pk_bf16_f32 v27, v66, v67
  v_and_b32 v3, 63, v0
  v_lshlrev_b32 v1, 4, v3
  s_mul_i32 s17, s2, 20480
  s_mul_i32 s18, s16, 5120
  s_add_u32 s17, s17, s18
  s_add_u32 s17, s17, 153616384
  buffer_store_dwordx4 v[8:11], v1, s[4:7], s17 offen offset:0
  buffer_store_dwordx4 v[12:15], v1, s[4:7], s17 offen offset:1024
  buffer_store_dwordx4 v[16:19], v1, s[4:7], s17 offen offset:2048
  buffer_store_dwordx4 v[20:23], v1, s[4:7], s17 offen offset:3072
  s_add_u32 s17, s17, 4096
  buffer_store_dwordx4 v[24:27], v1, s[4:7], s17 offen offset:0
ln2_exit1:
  s_endpgm
.globl reca_kernel
.p2align 8
.type reca_kernel,@function
reca_kernel:
  s_cmp_ge_u32 s2, 256
  s_cbranch_scc1 reca_exitb3
  s_load_dwordx2 s[48:49], s[0:1], 96
  s_load_dwordx2 s[50:51], s[0:1], 88
  s_load_dwordx2 s[52:53], s[0:1], 8
  s_getreg_b32 s42, hwreg(HW_REG_XCC_ID, 0, 3)
  v_lshrrev_b32 v28, 6, v0
  v_and_b32 v29, 63, v0
  s_and_b32 s13, s2, 7
  v_readfirstlane_b32 s12, v28
  v_lshlrev_b32 v1, 4, v29
  s_lshr_b32 s14, s2, 3
  s_mov_b32 s18, 0x100000
  s_waitcnt lgkmcnt(0)
  s_mov_b32 s57, 0
  s_mov_b32 s4, s48
  s_mov_b32 s5, s49
  s_mov_b32 s6, 0x10000000
  s_mov_b32 s7, 0x20000
  s_mov_b32 s8, s50
  s_mov_b32 s9, s51
  s_mov_b32 s10, 256
  s_mov_b32 s11, 0x20000
  v_add_u32 v2, 0x1000, v1
  v_add_u32 v3, 0x2000, v1
  v_mov_b32 v31, 0x80000000
  s_lshl_b32 s34, s42, 3
  s_lshl_b64 s[36:37], 1, s34
  s_lshl_b32 s34, s13, 3
  v_cmp_eq_u32 vcc, 0, v0
  v_mov_b32 v30, s34
  s_nop 0
  v_cndmask_b32 v30, v31, v30, vcc
  v_mov_b32 v44, s36
  v_mov_b32 v45, s37
  buffer_atomic_add_x2 v[44:45], v30, s[8:11], 0 offen
  s_sub_u32 s56, 0, s48
  s_and_b32 s56, s56, 0x1fffff
  s_add_u32 s56, s56, 2097152
  s_nop 0
  s_cmp_ge_u32 s14, 24
  s_cbranch_scc1 reca_proj2
  s_mul_i32 s34, s14, 43
  s_lshr_b32 s34, s34, 8
  s_mul_i32 s35, s34, 6
  s_sub_u32 s16, s14, s35
  s_lshl_b32 s15, s13, 2
  s_add_u32 s15, s15, s34
  s_lshr_b32 s19, s12, 1
  s_and_b32 s37, s12, 1
  s_mul_i32 s34, s15, 12
  s_lshl_b32 s35, s16, 1
  s_add_u32 s34, s34, s35
  s_add_u32 s34, s34, s37
  s_mul_i32 s34, s34, 20480
  s_mov_b32 s35, 14155776
  s_cmp_eq_u32 s19, 0
  s_cselect_b32 s35, 6291456, s35
  s_add_u32 s35, s35, s34
  s_mul_i32 s36, s19, 10240
  s_add_u32 s20, s35, s36
  s_sub_u32 s36, 10240, s36
  s_add_u32 s21, s35, s36
  s_add_u32 s22, s34, 22020096
  s_mul_i32 s36, s19, 10240
  s_add_u32 s22, s22, s36
  buffer_load_dwordx4 a[0:3], v1, s[4:7], s20 offen offset:0
  buffer_load_dwordx4 a[4:7], v1, s[4:7], s20 offen offset:1024
  buffer_load_dwordx4 a[8:11], v1, s[4:7], s20 offen offset:2048
  buffer_load_dwordx4 a[12:15], v1, s[4:7], s20 offen offset:3072
  buffer_load_dwordx4 a[16:19], v2, s[4:7], s20 offen offset:0
  buffer_load_dwordx4 a[20:23], v2, s[4:7], s20 offen offset:1024
  buffer_load_dwordx4 a[24:27], v2, s[4:7], s20 offen offset:2048
  buffer_load_dwordx4 a[28:31], v2, s[4:7], s20 offen offset:3072
  buffer_load_dwordx4 a[32:35], v3, s[4:7], s20 offen offset:0
  buffer_load_dwordx4 a[36:39], v3, s[4:7], s20 offen offset:1024
  buffer_load_dwordx4 a[40:43], v1, s[4:7], s21 offen offset:0
  buffer_load_dwordx4 a[44:47], v1, s[4:7], s21 offen offset:1024
  buffer_load_dwordx4 a[48:51], v1, s[4:7], s21 offen offset:2048
  buffer_load_dwordx4 a[52:55], v1, s[4:7], s21 offen offset:3072
  buffer_load_dwordx4 a[56:59], v2, s[4:7], s21 offen offset:0
  buffer_load_dwordx4 a[60:63], v2, s[4:7], s21 offen offset:1024
  buffer_load_dwordx4 a[64:67], v2, s[4:7], s21 offen offset:2048
  buffer_load_dwordx4 a[68:71], v2, s[4:7], s21 offen offset:3072
  buffer_load_dwordx4 a[72:75], v3, s[4:7], s21 offen offset:0
  buffer_load_dwordx4 a[76:79], v3, s[4:7], s21 offen offset:1024
  buffer_load_dwordx4 a[80:83], v1, s[4:7], s22 offen offset:0
  buffer_load_dwordx4 a[84:87], v1, s[4:7], s22 offen offset:1024
  buffer_load_dwordx4 a[88:91], v1, s[4:7], s22 offen offset:2048
  buffer_load_dwordx4 a[92:95], v1, s[4:7], s22 offen offset:3072
  buffer_load_dwordx4 a[96:99], v2, s[4:7], s22 offen offset:0
  buffer_load_dwordx4 a[100:103], v2, s[4:7], s22 offen offset:1024
  buffer_load_dwordx4 a[104:107], v2, s[4:7], s22 offen offset:2048
  buffer_load_dwordx4 a[108:111], v2, s[4:7], s22 offen offset:3072
  buffer_load_dwordx4 a[112:115], v3, s[4:7], s22 offen offset:0
  buffer_load_dwordx4 a[116:119], v3, s[4:7], s22 offen offset:1024
  s_cmp_ge_u32 s14, 20
  s_cbranch_scc1 reca_now24
  s_cmp_ge_u32 s12, 2
  s_cbranch_scc1 reca_now24
  s_lshl_b32 s34, s14, 1
  s_add_u32 s34, s34, s12
  s_mul_i32 s34, s34, 192
  s_mul_i32 s35, s13, 24
  s_add_u32 s34, s34, s35
  s_lshl_b32 s34, s34, 10
  s_add_u32 s34, s34, 29884416
  buffer_load_dwordx4 a[120:123], v1, s[4:7], s34 offen offset:0
  buffer_load_dwordx4 a[124:127], v1, s[4:7], s34 offen offset:1024
  buffer_load_dwordx4 a[128:131], v1, s[4:7], s34 offen offset:2048
  buffer_load_dwordx4 a[132:135], v1, s[4:7], s34 offen offset:3072
  buffer_load_dwordx4 a[136:139], v2, s[4:7], s34 offen offset:0
  buffer_load_dwordx4 a[140:143], v2, s[4:7], s34 offen offset:1024
  buffer_load_dwordx4 a[144:147], v2, s[4:7], s34 offen offset:2048
  buffer_load_dwordx4 a[148:151], v2, s[4:7], s34 offen offset:3072
  buffer_load_dwordx4 a[152:155], v3, s[4:7], s34 offen offset:0
  buffer_load_dwordx4 a[156:159], v3, s[4:7], s34 offen offset:1024
  buffer_load_dwordx4 a[160:163], v3, s[4:7], s34 offen offset:2048
  buffer_load_dwordx4 a[164:167], v3, s[4:7], s34 offen offset:3072
  s_add_u32 s34, s34, 12288
  buffer_load_dwordx4 a[168:171], v1, s[4:7], s34 offen offset:0
  buffer_load_dwordx4 a[172:175], v1, s[4:7], s34 offen offset:1024
  buffer_load_dwordx4 a[176:179], v1, s[4:7], s34 offen offset:2048
  buffer_load_dwordx4 a[180:183], v1, s[4:7], s34 offen offset:3072
  buffer_load_dwordx4 a[184:187], v2, s[4:7], s34 offen offset:0
  buffer_load_dwordx4 a[188:191], v2, s[4:7], s34 offen offset:1024
  buffer_load_dwordx4 a[192:195], v2, s[4:7], s34 offen offset:2048
  buffer_load_dwordx4 a[196:199], v2, s[4:7], s34 offen offset:3072
  buffer_load_dwordx4 a[200:203], v3, s[4:7], s34 offen offset:0
  buffer_load_dwordx4 a[204:207], v3, s[4:7], s34 offen offset:1024
  buffer_load_dwordx4 a[208:211], v3, s[4:7], s34 offen offset:2048
  buffer_load_dwordx4 a[212:215], v3, s[4:7], s34 offen offset:3072
reca_now24:
  v_and_b32 v29, 63, v0
  v_and_b32 v28, 15, v29
  v_lshrrev_b32 v30, 4, v29
  v_mov_b32 v32, -1
  v_mov_b32 v33, -1
  v_mov_b32 v34, -1
  v_mov_b32 v35, -1
  s_mul_i32 s34, s12, 2560
  v_add_u32 v4, s34, v1
  v_and_b32 v44, 31, v29
  v_lshlrev_b32 v44, 4, v44
  s_add_u32 s34, s34, 2048
  v_add_u32 v5, s34, v44
  v_and_b32 v44, 7, v29
  v_lshlrev_b32 v44, 4, v44
  v_lshl_add_u32 v44, v30, 7, v44
  s_mul_i32 s34, s19, 5120
  v_add_u32 v6, s34, v44
  s_sub_u32 s34, 5120, s34
  v_add_u32 v7, s34, v44
  v_lshrrev_b32 v45, 3, v28
  v_lshl_add_u32 v12, v45, 9, v44
  s_mul_i32 s34, s19, 5120
  v_add_u32 v236, s34, v12
  s_sub_u32 s34, 5120, s34
  v_add_u32 v237, s34, v12
  v_add_u32 v13, 0x1000, v12
  v_add_u32 v14, 0x2000, v12
  v_cmp_gt_u32 s[54:55], 8, v28
  s_lshl_b32 s34, s16, 10
  s_lshl_b32 s35, s19, 7
  s_add_u32 s34, s34, s35
  s_and_b32 s35, s12, 1
  s_lshl_b32 s36, s35, 3
  s_add_u32 s34, s34, s36
  v_lshlrev_b32 v44, 4, v28
  v_lshl_add_u32 v45, v30, 8, v44
  v_add_u32 v45, s34, v45
  v_cndmask_b32 v8, v31, v45, s[54:55]
  v_lshl_add_u32 v44, v30, 7, v44
  v_add_u32 v45, s36, v44
  v_cndmask_b32 v9, v31, v45, s[54:55]
  s_lshl_b32 s34, s14, 9
  v_add_u32 v45, s34, v44
  v_cndmask_b32 v11, v31, v45, s[54:55]
  s_mul_i32 s34, s13, 49152
  s_lshr_b32 s35, s14, 3
  s_lshl_b32 s35, s35, 14
  s_add_u32 s34, s34, s35
  s_and_b32 s35, s14, 7
  s_lshl_b32 s35, s35, 10
  s_add_u32 s34, s34, s35
  s_lshl_b32 s35, s12, 9
  s_add_u32 s34, s34, s35
  v_add_u32 v45, s34, v44
  v_cndmask_b32 v15, v31, v45, s[54:55]
  s_cmp_lt_u32 s14, 20
  s_cselect_b32 s34, 0, 0x80000000
  v_or_b32 v15, s34, v15
  v_lshlrev_b32 v45, 3, v29
  v_cmp_gt_u32 vcc, 32, v29
  s_nop 1
  v_cndmask_b32 v10, v31, v45, vcc
  s_sub_u32 s35, s14, 4
  s_cmp_lt_u32 s14, 20
  s_cselect_b32 s34, s14, s35
  s_lshr_b32 s35, s34, 3
  s_lshl_b32 s35, s35, 14
  s_and_b32 s34, s34, 7
  s_lshl_b32 s34, s34, 10
  s_add_u32 s34, s34, s35
  v_add_u32 v20, s34, v1
  v_add_u32 v21, 49152, v20
  v_add_u32 v22, 98304, v20
  v_add_u32 v23, 147456, v20
  v_add_u32 v24, 196608, v20
  v_add_u32 v25, 245760, v20
  v_add_u32 v26, 294912, v20
  v_add_u32 v27, 344064, v20
  v_lshrrev_b32 v44, 3, v29
  v_and_b32 v44, 3, v44
  v_lshlrev_b32 v44, 7, v44
  v_and_b32 v45, 7, v29
  v_lshl_add_u32 v44, v45, 4, v44
  v_lshrrev_b32 v45, 5, v29
  v_lshl_add_u32 v44, v45, 3, v44
  s_lshl_b32 s34, s14, 9
  s_cmp_lt_u32 s14, 20
  s_cselect_b32 s34, s34, 0x80000000
  v_add_u32 v16, s34, v44
  v_cmp_eq_u32 vcc, 0, v29
  v_mov_b32 v45, 0
  s_nop 0
  v_cndmask_b32 v19, v31, v45, vcc
  s_lshl_b32 s34, s15, 8
  s_add_u32 s34, s34, 1540096
  v_and_b32 v45, 1, v29
  v_lshlrev_b32 v45, 7, v45
  v_add_u32 v233, s34, v45
  s_lshl_b32 s34, s12, 10
  s_add_u32 s34, s34, 10240
  v_add_u32 v17, s34, v1
  v_mov_b32 v36, 0x3f803f80
  v_mov_b32 v37, 0x3f803f80
  v_mov_b32 v38, 0x3f803f80
  v_mov_b32 v39, 0x3f803f80
  v_mov_b32 v44, 0xf149f2ca
  v_cmp_gt_u32 vcc, 2, v30
  s_nop 1
  v_cndmask_b32 v40, 0, v44, vcc
  v_mov_b32 v41, v40
  v_mov_b32 v42, v40
  v_mov_b32 v43, v40
  s_mov_b32 s41, 0x3dd53b95
  s_mul_i32 s38, s13, 40960
  s_add_u32 s38, s38, 0
  s_mul_i32 s39, s15, 24576
  s_add_u32 s39, s39, 327680
  s_mul_i32 s40, s13, 49152
  s_add_u32 s40, s40, 1114112
  s_mov_b32 s60, s52
  s_mov_b32 s61, s53
  s_mov_b32 s62, 10240
  s_mov_b32 s63, 0x20000
  v_and_b32 v29, 63, v0
  v_and_b32 v44, 7, v29
  v_mul_u32_u24 v44, 1280, v44
  v_lshrrev_b32 v45, 3, v29
  v_and_b32 v45, 3, v45
  v_lshl_add_u32 v44, v45, 4, v44
  s_mul_i32 s34, s12, 320
  v_add_u32 v44, s34, v44
  v_add_u32 v46, 256, v44
  v_lshrrev_b32 v45, 5, v29
  v_lshl_add_u32 v44, v45, 6, v44
  buffer_load_dwordx4 v[128:131], v44, s[60:63], 0 offen
  buffer_load_dwordx4 v[132:135], v44, s[60:63], 0 offen offset:128
  buffer_load_dwordx4 v[136:139], v46, s[60:63], 0 offen
  v_and_b32 v44, 63, v0
  v_and_b32 v45, 3, v44
  v_lshlrev_b32 v45, 21, v45
  v_min_u32 v45, 6291392, v45
  v_add_u32 v46, 113246208, v45
  v_add_u32 v45, 119537664, v45
  v_cmp_gt_u32 vcc, 4, v44
  s_nop 1
  v_cndmask_b32 v46, v45, v46, vcc
  s_mul_i32 s34, s15, 786432
  v_and_b32 v45, 1, v44
  v_mul_u32_u24 v45, 786368, v45
  v_add_u32 v45, s34, v45
  v_add_u32 v28, 37748736, v45
  v_add_u32 v45, 62914560, v45
  v_cmp_gt_u32 vcc, 10, v44
  s_nop 1
  v_cndmask_b32 v45, v45, v28, vcc
  v_cmp_gt_u32 vcc, 8, v44
  s_nop 1
  v_cndmask_b32 v46, v45, v46, vcc
  v_cmp_gt_u32 vcc, 12, v44
  s_nop 1
  v_cndmask_b32 v46, v31, v46, vcc
  buffer_load_dword v234, v46, s[4:7], 0 offen
  v_and_b32 v30, 7, v0
  v_lshlrev_b32 v30, 3, v30
reca_cens5:
  buffer_load_dwordx2 v[28:29], v30, s[8:11], 0 offen sc1
  s_waitcnt vmcnt(0)
  v_sad_u8 v31, v28, 0, 0
  v_sad_u8 v31, v29, 0, v31
  v_cmp_gt_u32 vcc, 32, v31
  s_cbranch_vccz reca_censok6
  s_sleep 8
  s_sub_u32 s18, s18, 1
  s_cbranch_scc0 reca_cens5
  s_mov_b32 s18, 0
reca_censok6:
  v_and_b32 v28, 0x20202020, v28
  v_and_b32 v29, 0x20202020, v29
  v_cmp_ne_u32 s[34:35], 0, v28
  v_cmp_ne_u32 s[36:37], 0, v29
  s_nop 3
  s_and_b32 s34, s34, 0xff
  s_and_b32 s36, s36, 0xff
  s_or_b32 s35, s34, s36
  s_lshr_b32 s37, s35, s13
  s_and_b32 s37, s37, 1
  s_xor_b32 s43, s37, 1
  s_cmp_eq_u32 s57, 0
  s_cselect_b32 s58, s36, s34
  v_mov_b32 v31, 0x80000000
  v_add_u32 v232, 0x2000, v15
  s_lshr_b32 s44, s2, 4
  s_lshl_b32 s44, s44, 14
  s_and_b32 s34, s2, 15
  s_lshl_b32 s34, s34, 9
  s_add_u32 s44, s44, s34
  s_add_u32 s44, s44, 1572864
  s_add_u32 s44, s44, s56
  s_mov_b32 s45, -1
  s_mov_b32 s47, -1
  s_cmp_lg_u32 s12, 2
  s_cbranch_scc1 reca_noprobe7
  s_add_u32 s35, s44, 0
  s_memtime s[60:61]
  s_waitcnt lgkmcnt(0)
  buffer_load_dword v28, v19, s[4:7], s35 offen sc1
  s_waitcnt vmcnt(0)
  s_memtime s[62:63]
  s_waitcnt lgkmcnt(0)
  s_sub_u32 s36, s62, s60
  s_min_u32 s45, s45, s36
  s_add_u32 s35, s44, 8192
  s_memtime s[60:61]
  s_waitcnt lgkmcnt(0)
  buffer_load_dword v28, v19, s[4:7], s35 offen sc1
  s_waitcnt vmcnt(0)
  s_memtime s[62:63]
  s_waitcnt lgkmcnt(0)
  s_sub_u32 s36, s62, s60
  s_min_u32 s47, s47, s36
  s_add_u32 s35, s44, 128
  s_memtime s[60:61]
  s_waitcnt lgkmcnt(0)
  buffer_load_dword v28, v19, s[4:7], s35 offen sc1
  s_waitcnt vmcnt(0)
  s_memtime s[62:63]
  s_waitcnt lgkmcnt(0)
  s_sub_u32 s36, s62, s60
  s_min_u32 s45, s45, s36
  s_add_u32 s35, s44, 8320
  s_memtime s[60:61]
  s_waitcnt lgkmcnt(0)
  buffer_load_dword v28, v19, s[4:7], s35 offen sc1
  s_waitcnt vmcnt(0)
  s_memtime s[62:63]
  s_waitcnt lgkmcnt(0)
  s_sub_u32 s36, s62, s60
  s_min_u32 s47, s47, s36
  s_add_u32 s35, s44, 256
  s_memtime s[60:61]
  s_waitcnt lgkmcnt(0)
  buffer_load_dword v28, v19, s[4:7], s35 offen sc1
  s_waitcnt vmcnt(0)
  s_memtime s[62:63]
  s_waitcnt lgkmcnt(0)
  s_sub_u32 s36, s62, s60
  s_min_u32 s45, s45, s36
  s_add_u32 s35, s44, 8448
  s_memtime s[60:61]
  s_waitcnt lgkmcnt(0)
  buffer_load_dword v28, v19, s[4:7], s35 offen sc1
  s_waitcnt vmcnt(0)
  s_memtime s[62:63]
  s_waitcnt lgkmcnt(0)
  s_sub_u32 s36, s62, s60
  s_min_u32 s47, s47, s36
  s_cmp_lt_u32 s47, s45
  s_cbranch_scc0 reca_noprobe7
  v_add_u32 v20, 0x2000, v20
  v_add_u32 v21, 0x2000, v21
  v_add_u32 v22, 0x2000, v22
  v_add_u32 v23, 0x2000, v23
  v_add_u32 v24, 0x2000, v24
  v_add_u32 v25, 0x2000, v25
  v_add_u32 v26, 0x2000, v26
  v_add_u32 v27, 0x2000, v27
reca_noprobe7:
  s_lshl_b32 s59, s13, 2
  s_add_u32 s59, s59, s14
  s_sub_u32 s59, s59, 20
  v_and_b32 v29, 63, v0
  v_and_b32 v28, 15, v29
  v_lshrrev_b32 v30, 4, v29
  v_lshlrev_b32 v92, 4, v28
  v_lshl_add_u32 v92, v30, 7, v92
  v_cmp_gt_u32 vcc, 8, v28
  s_nop 1
  v_cndmask_b32 v92, v31, v92, vcc
  v_lshlrev_b32 v93, 3, v29
  v_cmp_gt_u32 vcc, 32, v29
  s_nop 1
  v_cndmask_b32 v93, v31, v93, vcc
  v_mov_b32 v82, 0xf149f2ca
  v_cmp_le_u32 vcc, 2, v30
  s_nop 1
  v_cndmask_b32 v84, 0, v82, vcc
  v_mov_b32 v85, v84
  v_mov_b32 v86, v84
  v_mov_b32 v87, v84
  v_lshlrev_b32 v30, 2, v30
  v_add_u32 v29, 0, v30
  v_cmp_gt_u32 vcc, v29, v28
  s_nop 1
  v_cndmask_b32 v88, 0, v82, vcc
  v_add_u32 v29, 1, v30
  v_cmp_gt_u32 vcc, v29, v28
  s_nop 1
  v_cndmask_b32 v89, 0, v82, vcc
  v_add_u32 v29, 2, v30
  v_cmp_gt_u32 vcc, v29, v28
  s_nop 1
  v_cndmask_b32 v90, 0, v82, vcc
  v_add_u32 v29, 3, v30
  v_cmp_gt_u32 vcc, v29, v28
  s_nop 1
  v_cndmask_b32 v91, 0, v82, vcc
  s_mov_b32 s17, 0
  s_cmp_lg_u32 s12, 3
  s_cbranch_scc1 reca_nopf08
  s_add_u32 s37, s17, 1
reca_pf9:
  buffer_load_dword v28, v233, s[4:7], 0 offen sc1
  s_waitcnt vmcnt(0)
  v_cmp_gt_i32 vcc, s37, v28
  s_cbranch_vccz reca_pfok10
  s_sleep 1
  s_sub_u32 s18, s18, 1
  s_cbranch_scc0 reca_pf9
  s_mov_b32 s18, 0
reca_pfok10:
  s_lshl_b32 s34, s15, 6
  s_add_u32 s34, s34, s17
  s_mul_i32 s34, s34, 12288
  s_add_u32 s32, s34, 37748736
  s_lshl_b32 s35, s16, 11
  s_add_u32 s34, s34, s35
  s_add_u32 s33, s34, 62914560
  buffer_load_dwordx4 a[120:123], v1, s[4:7], s32 offen offset:0 sc1
  buffer_load_dwordx4 a[124:127], v1, s[4:7], s32 offen offset:1024 sc1
  buffer_load_dwordx4 a[128:131], v1, s[4:7], s32 offen offset:2048 sc1
  buffer_load_dwordx4 a[132:135], v1, s[4:7], s32 offen offset:3072 sc1
  buffer_load_dwordx4 a[136:139], v2, s[4:7], s32 offen offset:0 sc1
  buffer_load_dwordx4 a[140:143], v2, s[4:7], s32 offen offset:1024 sc1
  buffer_load_dwordx4 a[144:147], v2, s[4:7], s32 offen offset:2048 sc1
  buffer_load_dwordx4 a[148:151], v2, s[4:7], s32 offen offset:3072 sc1
  buffer_load_dwordx4 a[152:155], v3, s[4:7], s32 offen offset:0 sc1
  buffer_load_dwordx4 a[156:159], v3, s[4:7], s32 offen offset:1024 sc1
  buffer_load_dwordx4 a[160:163], v3, s[4:7], s32 offen offset:2048 sc1
  buffer_load_dwordx4 a[164:167], v3, s[4:7], s32 offen offset:3072 sc1
  buffer_load_dwordx4 a[168:171], v1, s[4:7], s33 offen offset:0 sc1
  buffer_load_dwordx4 a[172:175], v1, s[4:7], s33 offen offset:1024 sc1
  s_waitcnt vmcnt(0)
reca_nopf08:
  s_cmp_lg_u32 s43, 0
  s_cbranch_scc1 reca_slow11
  s_cmp_ge_u32 s14, 20
  s_cbranch_scc1 reca_twinf12
  s_branch reca_gotmem15
reca_step14:
  s_and_b32 s34, s17, 3
  s_mul_i32 s20, s34, 10240
  s_add_u32 s20, s20, s38
  s_sleep 2
  buffer_load_dwordx4 v[128:131], v4, s[4:7], s20 offen sc1
  buffer_load_dwordx4 v[132:135], v4, s[4:7], s20 offen offset:1024 sc1
  buffer_load_dwordx4 v[136:139], v5, s[4:7], s20 offen sc1
  s_waitcnt vmcnt(2)
  v_max_u32 v29, v128, v130
  v_cmp_eq_u32 vcc, -1, v29
  s_cbranch_vccnz reca_retry17
reca_resume18:
  s_waitcnt vmcnt(1)
  v_max_u32 v29, v132, v134
  v_cmp_eq_u32 vcc, -1, v29
  ds_write_b128 v4, v[128:131]
  s_cbranch_vccnz reca_retry19
reca_resume20:
  s_waitcnt vmcnt(0)
  v_max_u32 v29, v136, v138
  v_cmp_eq_u32 vcc, -1, v29
  ds_write_b128 v4, v[132:135] offset:1024
  s_cbranch_vccnz reca_retry21
reca_resume22:
  ds_write_b128 v5, v[136:139]
  s_branch reca_gotmem216
reca_gotmem15:
  ds_write_b128 v4, v[128:131]
  ds_write_b128 v4, v[132:135] offset:1024
  ds_write_b128 v5, v[136:139]
reca_gotmem216:
  s_and_b32 s34, s17, 3
  s_mul_i32 s21, s34, 6144
  s_add_u32 s21, s21, s39
  s_mul_i32 s22, s34, 12288
  s_add_u32 s22, s22, s40
  s_mul_i32 s25, s34, 393216
  s_add_u32 s25, s25, s56
  s_add_u32 s35, s17, 1
  s_and_b32 s35, s35, 3
  s_mul_i32 s24, s35, 10240
  s_add_u32 s24, s24, s38
  s_waitcnt lgkmcnt(0)
  s_barrier
  ds_read_b128 v[128:131], v236 offset:0
  ds_read_b128 v[132:135], v236 offset:1024
  ds_read_b128 v[136:139], v236 offset:2048
  ds_read_b128 v[140:143], v236 offset:3072
  ds_read_b128 v[144:147], v236 offset:4096
  ds_read_b128 v[148:151], v237 offset:0
  ds_read_b128 v[152:155], v237 offset:1024
  ds_read_b128 v[156:159], v237 offset:2048
  ds_read_b128 v[160:163], v237 offset:3072
  ds_read_b128 v[164:167], v237 offset:4096
  s_waitcnt lgkmcnt(9)
  v_mfma_f32_16x16x32_bf16 v[44:47], a[0:3], v[128:131], 0
  ds_read_b128 v[168:171], v6 offset:0
  v_mfma_f32_16x16x32_bf16 v[240:243], a[4:7], v[128:131], 0
  s_waitcnt lgkmcnt(9)
  v_mfma_f32_16x16x32_bf16 v[44:47], a[8:11], v[132:135], v[44:47]
  ds_read_b128 v[172:175], v6 offset:512
  v_mfma_f32_16x16x32_bf16 v[240:243], a[12:15], v[132:135], v[240:243]
  s_waitcnt lgkmcnt(9)
  v_mfma_f32_16x16x32_bf16 v[44:47], a[16:19], v[136:139], v[44:47]
  ds_read_b128 v[176:179], v6 offset:1024
  v_mfma_f32_16x16x32_bf16 v[240:243], a[20:23], v[136:139], v[240:243]
  s_waitcnt lgkmcnt(9)
  v_mfma_f32_16x16x32_bf16 v[44:47], a[24:27], v[140:143], v[44:47]
  ds_read_b128 v[180:183], v6 offset:1536
  v_mfma_f32_16x16x32_bf16 v[240:243], a[28:31], v[140:143], v[240:243]
  s_waitcnt lgkmcnt(9)
  v_mfma_f32_16x16x32_bf16 v[44:47], a[32:35], v[144:147], v[44:47]
  ds_read_b128 v[184:187], v6 offset:2048
  v_mfma_f32_16x16x32_bf16 v[240:243], a[36:39], v[144:147], v[240:243]
  s_waitcnt lgkmcnt(9)
  v_mfma_f32_16x16x32_bf16 v[44:47], a[40:43], v[148:151], v[44:47]
  ds_read_b128 v[188:191], v6 offset:2560
  v_mfma_f32_16x16x32_bf16 v[240:243], a[44:47], v[148:151], v[240:243]
  s_waitcnt lgkmcnt(9)
  v_mfma_f32_16x16x32_bf16 v[44:47], a[48:51], v[152:155], v[44:47]
  ds_read_b128 v[192:195], v6 offset:3072
  v_mfma_f32_16x16x32_bf16 v[240:243], a[52:55], v[152:155], v[240:243]
  s_waitcnt lgkmcnt(9)
  v_mfma_f32_16x16x32_bf16 v[44:47], a[56:59], v[156:159], v[44:47]
  ds_read_b128 v[196:199], v6 offset:3584
  v_mfma_f32_16x16x32_bf16 v[240:243], a[60:63], v[156:159], v[240:243]
  s_waitcnt lgkmcnt(9)
  v_mfma_f32_16x16x32_bf16 v[44:47], a[64:67], v[160:163], v[44:47]
  ds_read_b128 v[200:203], v6 offset:4096
  v_mfma_f32_16x16x32_bf16 v[240:243], a[68:71], v[160:163], v[240:243]
  s_waitcnt lgkmcnt(9)
  v_mfma_f32_16x16x32_bf16 v[44:47], a[72:75], v[164:167], v[44:47]
  ds_read_b128 v[204:207], v6 offset:4608
  v_mfma_f32_16x16x32_bf16 v[240:243], a[76:79], v[164:167], v[240:243]
  s_waitcnt lgkmcnt(9)
  v_mfma_f32_16x16x32_bf16 v[48:51], v[168:171], a[80:83], 0
  s_lshl_b32 s34, s17, 5
  s_add_u32 s34, s34, s15
  s_mul_i32 s34, s34, 3072
  s_lshl_b32 s35, s16, 9
  s_add_u32 s34, s34, s35
  s_add_u32 s30, s34, 113246208
  s_add_u32 s31, s34, 119537664
  v_add_f32_dpp v44, v240, v44 row_ror:8 row_mask:0xf bank_mask:0xf
  v_add_f32_dpp v45, v241, v45 row_ror:8 row_mask:0xf bank_mask:0xf
  v_add_f32_dpp v46, v242, v46 row_ror:8 row_mask:0xf bank_mask:0xf
  v_add_f32_dpp v47, v243, v47 row_ror:8 row_mask:0xf bank_mask:0xf
  v_cvt_pk_bf16_f32 v52, v44, v45
  v_cvt_pk_bf16_f32 v53, v46, v47
  buffer_store_dwordx2 v[52:53], v8, s[4:7], s21 offen
  s_waitcnt lgkmcnt(8)
  v_mfma_f32_16x16x32_bf16 v[48:51], v[172:175], a[84:87], v[48:51]
  s_waitcnt lgkmcnt(7)
  v_mfma_f32_16x16x32_bf16 v[48:51], v[176:179], a[88:91], v[48:51]
  s_waitcnt lgkmcnt(6)
  v_mfma_f32_16x16x32_bf16 v[48:51], v[180:183], a[92:95], v[48:51]
  s_waitcnt lgkmcnt(5)
  v_mfma_f32_16x16x32_bf16 v[48:51], v[184:187], a[96:99], v[48:51]
  s_waitcnt lgkmcnt(4)
  v_mfma_f32_16x16x32_bf16 v[48:51], v[188:191], a[100:103], v[48:51]
  s_waitcnt lgkmcnt(3)
  v_mfma_f32_16x16x32_bf16 v[48:51], v[192:195], a[104:107], v[48:51]
  s_waitcnt lgkmcnt(2)
  v_mfma_f32_16x16x32_bf16 v[48:51], v[196:199], a[108:111], v[48:51]
  s_waitcnt lgkmcnt(1)
  v_mfma_f32_16x16x32_bf16 v[48:51], v[200:203], a[112:115], v[48:51]
  s_waitcnt lgkmcnt(0)
  v_mfma_f32_16x16x32_bf16 v[48:51], v[204:207], a[116:119], v[48:51]
  s_cmp_eq_u32 s12, 3
  s_cbranch_scc1 reca_swave23
  s_nop 5
  ds_write_b128 v17, v[48:51]
  s_add_u32 s34, s17, 2
  s_and_b32 s34, s34, 3
  s_mul_i32 s26, s34, 10240
  s_add_u32 s26, s26, s38
  s_mul_i32 s27, s34, 6144
  s_add_u32 s27, s27, s39
  s_mul_i32 s28, s34, 12288
  s_add_u32 s28, s28, s40
  s_mul_i32 s29, s34, 393216
  s_add_u32 s29, s29, s56
  s_waitcnt lgkmcnt(0)
  s_barrier
  s_cmp_eq_u32 s17, 63
  s_cbranch_scc1 reca_last25
  buffer_store_dwordx2 v[32:33], v8, s[4:7], s27 offen
  s_cmp_lg_u32 s12, 2
  s_cbranch_scc1 reca_b326
  buffer_store_dwordx2 v[52:53], v9, s[4:7], s30 offen
  buffer_store_dwordx2 v[32:33], v16, s[4:7], s26 offen
  s_cmp_lg_u32 s14, 0
  s_cbranch_scc1 reca_b326
  v_mov_b32 v28, s17
  s_lshl_b32 s34, s13, 7
  s_add_u32 s34, s34, 1507328
  buffer_store_dword v28, v19, s[4:7], s34 offen
  s_branch reca_b326
reca_last25:
  s_cmp_lg_u32 s12, 2
  s_cbranch_scc1 reca_exit1
  buffer_store_dwordx2 v[52:53], v9, s[4:7], s30 offen
  s_branch reca_exit1
reca_swave23:
  s_cmp_lg_u32 s17, 63
  s_cbranch_scc1 reca_vmst29
  s_barrier
  ds_read_b128 v[56:59], v1 offset:10240
  ds_read_b128 v[60:63], v1 offset:11264
  ds_read_b128 v[64:67], v1 offset:12288
  s_waitcnt lgkmcnt(0)
  v_add_f32 v56, v56, v64
  v_add_f32 v60, v60, v48
  v_add_f32 v57, v57, v65
  v_add_f32 v61, v61, v49
  v_add_f32 v58, v58, v66
  v_add_f32 v62, v62, v50
  v_add_f32 v59, v59, v67
  v_add_f32 v63, v63, v51
  v_cvt_pk_bf16_f32 v68, v56, v57
  v_cvt_pk_bf16_f32 v69, v58, v59
  v_cvt_pk_bf16_f32 v70, v60, v61
  v_cvt_pk_bf16_f32 v71, v62, v63
  buffer_store_dwordx2 v[52:53], v9, s[4:7], s30 offen
  buffer_store_dwordx2 v[68:69], v10, s[4:7], s31 offen
  buffer_store_dwordx2 v[70:71], v10, s[4:7], s31 offen offset:256
  s_branch reca_exit1
reca_vmst29:
  s_sleep 1
  buffer_load_dwordx4 v[208:211], v1, s[4:7], s21 offen offset:0 sc1
  buffer_load_dwordx4 v[212:215], v1, s[4:7], s21 offen offset:1024 sc1
  buffer_load_dwordx4 v[216:219], v1, s[4:7], s21 offen offset:2048 sc1
  buffer_load_dwordx4 v[220:223], v1, s[4:7], s21 offen offset:3072 sc1
  buffer_load_dwordx4 v[224:227], v2, s[4:7], s21 offen offset:0 sc1
  buffer_load_dwordx4 v[228:231], v2, s[4:7], s21 offen offset:1024 sc1
  s_waitcnt vmcnt(5)
  v_max_u32 v29, v208, v210
  v_cmp_eq_u32 vcc, -1, v29
  s_cbranch_vccnz reca_retry30
reca_resume31:
  s_waitcnt vmcnt(4)
  v_max_u32 v29, v212, v214
  v_cmp_eq_u32 vcc, -1, v29
  v_mfma_f32_16x16x32_bf16 v[76:79], a[120:123], v[208:211], 0
  v_mfma_f32_16x16x32_bf16 v[80:83], a[144:147], v[208:211], 0
  v_mfma_f32_16x16x32_bf16 v[72:75], v[208:211], v[208:211], v[40:43]
  s_cbranch_vccnz reca_retry32
reca_resume33:
  s_waitcnt vmcnt(3)
  v_max_u32 v29, v216, v218
  v_cmp_eq_u32 vcc, -1, v29
  v_mfma_f32_16x16x32_bf16 v[76:79], a[124:127], v[212:215], v[76:79]
  v_mfma_f32_16x16x32_bf16 v[80:83], a[148:151], v[212:215], v[80:83]
  v_mfma_f32_16x16x32_bf16 v[72:75], v[212:215], v[212:215], v[72:75]
  s_cbranch_vccnz reca_retry34
reca_resume35:
  s_waitcnt vmcnt(2)
  v_max_u32 v29, v220, v222
  v_cmp_eq_u32 vcc, -1, v29
  v_mfma_f32_16x16x32_bf16 v[76:79], a[128:131], v[216:219], v[76:79]
  v_mfma_f32_16x16x32_bf16 v[80:83], a[152:155], v[216:219], v[80:83]
  v_mfma_f32_16x16x32_bf16 v[72:75], v[216:219], v[216:219], v[72:75]
  s_cbranch_vccnz reca_retry36
reca_resume37:
  s_waitcnt vmcnt(1)
  v_max_u32 v29, v224, v226
  v_cmp_eq_u32 vcc, -1, v29
  v_mfma_f32_16x16x32_bf16 v[76:79], a[132:135], v[220:223], v[76:79]
  v_mfma_f32_16x16x32_bf16 v[80:83], a[156:159], v[220:223], v[80:83]
  v_mfma_f32_16x16x32_bf16 v[72:75], v[220:223], v[220:223], v[72:75]
  s_cbranch_vccnz reca_retry38
reca_resume39:
  s_waitcnt vmcnt(0)
  v_max_u32 v29, v228, v230
  v_cmp_eq_u32 vcc, -1, v29
  v_mfma_f32_16x16x32_bf16 v[76:79], a[136:139], v[224:227], v[76:79]
  v_mfma_f32_16x16x32_bf16 v[80:83], a[160:163], v[224:227], v[80:83]
  v_mfma_f32_16x16x32_bf16 v[72:75], v[224:227], v[224:227], v[72:75]
  s_cbranch_vccnz reca_retry40
reca_resume41:
  v_mfma_f32_16x16x32_bf16 v[76:79], a[140:143], v[228:231], v[76:79]
  v_mfma_f32_16x16x32_bf16 v[80:83], a[164:167], v[228:231], v[80:83]
  v_mfma_f32_16x16x32_bf16 v[72:75], v[228:231], v[228:231], v[72:75]
  s_barrier
  ds_read_b128 v[56:59], v1 offset:10240
  ds_read_b128 v[60:63], v1 offset:11264
  ds_read_b128 v[64:67], v1 offset:12288
  s_nop 1
  v_max3_f32 v28, v76, v77, v78
  v_max3_f32 v29, v80, v81, v82
  v_max3_f32 v28, v28, v79, v83
  v_max3_f32 v29, v29, v72, v73
  v_max3_f32 v28, v28, v74, v75
  v_max_f32 v28, v28, v29
  v_mov_b32 v29, v28
  s_nop 1
  v_permlane32_swap_b32 v28, v29
  v_max_f32 v28, v28, v29
  v_mov_b32 v29, v28
  s_nop 1
  v_permlane16_swap_b32 v28, v29
  v_max_f32 v28, v28, v29
  v_mul_f32 v28, s41, v28
  v_fma_f32 v76, v76, s41, -v28
  v_fma_f32 v77, v77, s41, -v28
  v_fma_f32 v78, v78, s41, -v28
  v_fma_f32 v79, v79, s41, -v28
  v_fma_f32 v80, v80, s41, -v28
  v_fma_f32 v81, v81, s41, -v28
  v_fma_f32 v82, v82, s41, -v28
  v_fma_f32 v83, v83, s41, -v28
  v_fma_f32 v72, v72, s41, -v28
  v_fma_f32 v73, v73, s41, -v28
  v_fma_f32 v74, v74, s41, -v28
  v_fma_f32 v75, v75, s41, -v28
  v_exp_f32 v76, v76
  v_exp_f32 v77, v77
  v_exp_f32 v78, v78
  v_exp_f32 v79, v79
  v_exp_f32 v80, v80
  v_exp_f32 v81, v81
  v_exp_f32 v82, v82
  v_exp_f32 v83, v83
  v_cvt_pk_bf16_f32 v84, v76, v77
  v_cvt_pk_bf16_f32 v85, v78, v79
  v_cvt_pk_bf16_f32 v86, v80, v81
  v_cvt_pk_bf16_f32 v87, v82, v83
  v_exp_f32 v72, v72
  v_exp_f32 v73, v73
  v_mfma_f32_16x16x32_bf16 v[100:103], v[36:39], v[84:87], 0
  v_exp_f32 v74, v74
  v_exp_f32 v75, v75
  v_mfma_f32_16x16x32_bf16 v[92:95], a[168:171], v[84:87], 0
  v_cvt_pk_bf16_f32 v88, v72, v73
  v_cvt_pk_bf16_f32 v89, v74, v75
  v_mfma_f32_16x16x32_bf16 v[96:99], a[172:175], v[84:87], 0
  s_waitcnt lgkmcnt(0)
  v_mfma_f32_16x16x16_bf16 v[100:103], v[36:37], v[88:89], v[100:103]
  v_add_f32 v56, v56, v64
  v_add_f32 v60, v60, v48
  v_add_f32 v57, v57, v65
  v_add_f32 v61, v61, v49
  v_add_f32 v58, v58, v66
  v_add_f32 v62, v62, v50
  v_add_f32 v59, v59, v67
  v_add_f32 v63, v63, v51
  v_cvt_pk_bf16_f32 v68, v56, v57
  v_cvt_pk_bf16_f32 v69, v58, v59
  v_cvt_pk_bf16_f32 v70, v60, v61
  v_cvt_pk_bf16_f32 v71, v62, v63
  v_mfma_f32_16x16x16_bf16 v[92:95], v[68:69], v[88:89], v[92:95]
  v_rcp_f32 v28, v100
  v_mfma_f32_16x16x16_bf16 v[96:99], v[70:71], v[88:89], v[96:99]
  v_mov_b32 v29, v28
  s_nop 4
  v_pk_mul_f32 v[92:93], v[92:93], v[28:29]
  v_pk_mul_f32 v[94:95], v[94:95], v[28:29]
  v_pk_mul_f32 v[96:97], v[96:97], v[28:29]
  v_pk_mul_f32 v[98:99], v[98:99], v[28:29]
  v_cvt_pk_bf16_f32 v104, v92, v93
  v_cvt_pk_bf16_f32 v105, v94, v95
  v_cvt_pk_bf16_f32 v106, v96, v97
  v_cvt_pk_bf16_f32 v107, v98, v99
  buffer_store_dwordx4 v[104:107], v11, s[4:7], s22 offen
reca_b326:
  s_barrier
  s_cmp_ge_u32 s12, 2
  s_cbranch_scc1 reca_notg242
  s_sleep 3
  buffer_load_dwordx4 v[128:131], v12, s[4:7], s22 offen offset:0 sc1
  buffer_load_dwordx4 v[132:135], v12, s[4:7], s22 offen offset:1024 sc1
  buffer_load_dwordx4 v[136:139], v12, s[4:7], s22 offen offset:2048 sc1
  buffer_load_dwordx4 v[140:143], v12, s[4:7], s22 offen offset:3072 sc1
  buffer_load_dwordx4 v[144:147], v13, s[4:7], s22 offen offset:0 sc1
  buffer_load_dwordx4 v[148:151], v13, s[4:7], s22 offen offset:1024 sc1
  buffer_load_dwordx4 v[152:155], v13, s[4:7], s22 offen offset:2048 sc1
  buffer_load_dwordx4 v[156:159], v13, s[4:7], s22 offen offset:3072 sc1
  buffer_load_dwordx4 v[160:163], v14, s[4:7], s22 offen offset:0 sc1
  buffer_load_dwordx4 v[164:167], v14, s[4:7], s22 offen offset:1024 sc1
  buffer_load_dwordx4 v[168:171], v14, s[4:7], s22 offen offset:2048 sc1
  buffer_load_dwordx4 v[172:175], v14, s[4:7], s22 offen offset:3072 sc1
  s_waitcnt vmcnt(11)
  v_cmp_eq_u32 vcc, -1, v128
  s_cbranch_vccnz reca_retry43
reca_resume44:
  s_waitcnt vmcnt(10)
  v_cmp_eq_u32 vcc, -1, v132
  v_mfma_f32_16x16x32_bf16 v[108:111], a[120:123], v[128:131], 0
  v_mfma_f32_16x16x32_bf16 v[112:115], a[124:127], v[128:131], 0
  s_cbranch_vccnz reca_retry45
reca_resume46:
  s_waitcnt vmcnt(9)
  v_cmp_eq_u32 vcc, -1, v136
  v_mfma_f32_16x16x32_bf16 v[108:111], a[128:131], v[132:135], v[108:111]
  v_mfma_f32_16x16x32_bf16 v[112:115], a[132:135], v[132:135], v[112:115]
  s_cbranch_vccnz reca_retry47
reca_resume48:
  s_waitcnt vmcnt(8)
  v_cmp_eq_u32 vcc, -1, v140
  v_mfma_f32_16x16x32_bf16 v[108:111], a[136:139], v[136:139], v[108:111]
  v_mfma_f32_16x16x32_bf16 v[112:115], a[140:143], v[136:139], v[112:115]
  s_cbranch_vccnz reca_retry49
reca_resume50:
  s_waitcnt vmcnt(7)
  v_cmp_eq_u32 vcc, -1, v144
  v_mfma_f32_16x16x32_bf16 v[108:111], a[144:147], v[140:143], v[108:111]
  v_mfma_f32_16x16x32_bf16 v[112:115], a[148:151], v[140:143], v[112:115]
  s_cbranch_vccnz reca_retry51
reca_resume52:
  s_waitcnt vmcnt(6)
  v_cmp_eq_u32 vcc, -1, v148
  v_mfma_f32_16x16x32_bf16 v[108:111], a[152:155], v[144:147], v[108:111]
  v_mfma_f32_16x16x32_bf16 v[112:115], a[156:159], v[144:147], v[112:115]
  s_cbranch_vccnz reca_retry53
reca_resume54:
  s_waitcnt vmcnt(5)
  v_cmp_eq_u32 vcc, -1, v152
  v_mfma_f32_16x16x32_bf16 v[108:111], a[160:163], v[148:151], v[108:111]
  v_mfma_f32_16x16x32_bf16 v[112:115], a[164:167], v[148:151], v[112:115]
  s_cbranch_vccnz reca_retry55
reca_resume56:
  s_waitcnt vmcnt(4)
  v_cmp_eq_u32 vcc, -1, v156
  v_mfma_f32_16x16x32_bf16 v[108:111], a[168:171], v[152:155], v[108:111]
  v_mfma_f32_16x16x32_bf16 v[112:115], a[172:175], v[152:155], v[112:115]
  s_cbranch_vccnz reca_retry57
reca_resume58:
  s_waitcnt vmcnt(3)
  v_cmp_eq_u32 vcc, -1, v160
  v_mfma_f32_16x16x32_bf16 v[108:111], a[176:179], v[156:159], v[108:111]
  v_mfma_f32_16x16x32_bf16 v[112:115], a[180:183], v[156:159], v[112:115]
  s_cbranch_vccnz reca_retry59
reca_resume60:
  s_waitcnt vmcnt(2)
  v_cmp_eq_u32 vcc, -1, v164
  v_mfma_f32_16x16x32_bf16 v[108:111], a[184:187], v[160:163], v[108:111]
  v_mfma_f32_16x16x32_bf16 v[112:115], a[188:191], v[160:163], v[112:115]
  s_cbranch_vccnz reca_retry61
reca_resume62:
  s_waitcnt vmcnt(1)
  v_cmp_eq_u32 vcc, -1, v168
  v_mfma_f32_16x16x32_bf16 v[108:111], a[192:195], v[164:167], v[108:111]
  v_mfma_f32_16x16x32_bf16 v[112:115], a[196:199], v[164:167], v[112:115]
  s_cbranch_vccnz reca_retry63
reca_resume64:
  s_waitcnt vmcnt(0)
  v_cmp_eq_u32 vcc, -1, v172
  v_mfma_f32_16x16x32_bf16 v[108:111], a[200:203], v[168:171], v[108:111]
  v_mfma_f32_16x16x32_bf16 v[112:115], a[204:207], v[168:171], v[112:115]
  s_cbranch_vccnz reca_retry65
reca_resume66:
  v_mfma_f32_16x16x32_bf16 v[108:111], a[208:211], v[172:175], v[108:111]
  v_mfma_f32_16x16x32_bf16 v[112:115], a[212:215], v[172:175], v[112:115]
  s_nop 7
  v_add_f32_dpp v116, v112, v108 row_ror:8 row_mask:0xf bank_mask:0xf
  v_add_f32_dpp v117, v113, v109 row_ror:8 row_mask:0xf bank_mask:0xf
  v_add_f32_dpp v118, v114, v110 row_ror:8 row_mask:0xf bank_mask:0xf
  v_add_f32_dpp v119, v115, v111 row_ror:8 row_mask:0xf bank_mask:0xf
  buffer_store_dwordx4 v[116:119], v15, s[4:7], s25 offen sc1
  buffer_store_dwordx4 v[116:119], v232, s[4:7], s25 offen sc1
  buffer_store_dwordx4 v[32:35], v15, s[4:7], s29 offen sc1
  buffer_store_dwordx4 v[32:35], v232, s[4:7], s29 offen sc1
  s_branch reca_b427
reca_notg242:
  s_cmp_lg_u32 s12, 3
  s_cbranch_scc1 reca_b427
  s_add_u32 s34, s17, 2
  s_and_b32 s34, s34, 3
  s_mul_i32 s26, s34, 10240
  s_add_u32 s26, s26, s38
  s_mul_i32 s27, s34, 6144
  s_add_u32 s27, s27, s39
  s_mul_i32 s28, s34, 12288
  s_add_u32 s28, s28, s40
  s_mul_i32 s29, s34, 393216
  s_add_u32 s29, s29, s56
  buffer_store_dwordx2 v[32:33], v8, s[4:7], s27 offen
  buffer_store_dwordx4 v[32:35], v11, s[4:7], s28 offen
reca_b427:
  s_barrier
  s_cmp_lg_u32 s12, 2
  s_cbranch_scc1 reca_not267
  s_sleep 8
  buffer_load_dwordx4 v[128:131], v20, s[4:7], s25 offen sc1
  buffer_load_dwordx4 v[132:135], v21, s[4:7], s25 offen sc1
  buffer_load_dwordx4 v[136:139], v22, s[4:7], s25 offen sc1
  buffer_load_dwordx4 v[140:143], v23, s[4:7], s25 offen sc1
  buffer_load_dwordx4 v[144:147], v24, s[4:7], s25 offen sc1
  buffer_load_dwordx4 v[148:151], v25, s[4:7], s25 offen sc1
  buffer_load_dwordx4 v[152:155], v26, s[4:7], s25 offen sc1
  buffer_load_dwordx4 v[156:159], v27, s[4:7], s25 offen sc1
  s_waitcnt vmcnt(7)
  v_cmp_eq_u32 vcc, -1, v128
  s_cbranch_vccnz reca_retry68
reca_resume69:
  s_waitcnt vmcnt(6)
  v_cmp_eq_u32 vcc, -1, v132
  s_cbranch_vccnz reca_retry70
reca_resume71:
  s_waitcnt vmcnt(5)
  v_cmp_eq_u32 vcc, -1, v136
  v_pk_add_f32 v[116:117], v[128:129], v[132:133]
  v_pk_add_f32 v[118:119], v[130:131], v[134:135]
  s_cbranch_vccnz reca_retry72
reca_resume73:
  s_waitcnt vmcnt(4)
  v_cmp_eq_u32 vcc, -1, v140
  v_pk_add_f32 v[116:117], v[116:117], v[136:137]
  v_pk_add_f32 v[118:119], v[118:119], v[138:139]
  s_cbranch_vccnz reca_retry74
reca_resume75:
  s_waitcnt vmcnt(3)
  v_cmp_eq_u32 vcc, -1, v144
  v_pk_add_f32 v[116:117], v[116:117], v[140:141]
  v_pk_add_f32 v[118:119], v[118:119], v[142:143]
  s_cbranch_vccnz reca_retry76
reca_resume77:
  s_waitcnt vmcnt(2)
  v_cmp_eq_u32 vcc, -1, v148
  v_pk_add_f32 v[116:117], v[116:117], v[144:145]
  v_pk_add_f32 v[118:119], v[118:119], v[146:147]
  s_cbranch_vccnz reca_retry78
reca_resume79:
  s_waitcnt vmcnt(1)
  v_cmp_eq_u32 vcc, -1, v152
  v_pk_add_f32 v[116:117], v[116:117], v[148:149]
  v_pk_add_f32 v[118:119], v[118:119], v[150:151]
  s_cbranch_vccnz reca_retry80
reca_resume81:
  s_waitcnt vmcnt(0)
  v_cmp_eq_u32 vcc, -1, v156
  v_pk_add_f32 v[116:117], v[116:117], v[152:153]
  v_pk_add_f32 v[118:119], v[118:119], v[154:155]
  s_cbranch_vccnz reca_retry82
reca_resume83:
  v_pk_add_f32 v[116:117], v[116:117], v[156:157]
  v_pk_add_f32 v[118:119], v[118:119], v[158:159]
  v_cvt_pk_bf16_f32 v132, v116, v117
  v_cvt_pk_bf16_f32 v133, v118, v119
  buffer_store_dwordx2 v[132:133], v16, s[4:7], s24 offen
  s_branch reca_b528
reca_not267:
  s_cmp_lg_u32 s12, 3
  s_cbranch_scc1 reca_b528
  s_add_u32 s36, s17, 1
  s_cmp_ge_u32 s36, 63
  s_cbranch_scc1 reca_nopf84
  s_add_u32 s37, s36, 1
reca_pf85:
  buffer_load_dword v28, v233, s[4:7], 0 offen sc1
  s_waitcnt vmcnt(0)
  v_cmp_gt_i32 vcc, s37, v28
  s_cbranch_vccz reca_pfok86
  s_sleep 1
  s_sub_u32 s18, s18, 1
  s_cbranch_scc0 reca_pf85
  s_mov_b32 s18, 0
reca_pfok86:
  s_lshl_b32 s34, s15, 6
  s_add_u32 s34, s34, s36
  s_mul_i32 s34, s34, 12288
  s_add_u32 s32, s34, 37748736
  s_lshl_b32 s35, s16, 11
  s_add_u32 s34, s34, s35
  s_add_u32 s33, s34, 62914560
  buffer_load_dwordx4 a[120:123], v1, s[4:7], s32 offen offset:0 sc1
  buffer_load_dwordx4 a[124:127], v1, s[4:7], s32 offen offset:1024 sc1
  buffer_load_dwordx4 a[128:131], v1, s[4:7], s32 offen offset:2048 sc1
  buffer_load_dwordx4 a[132:135], v1, s[4:7], s32 offen offset:3072 sc1
  buffer_load_dwordx4 a[136:139], v2, s[4:7], s32 offen offset:0 sc1
  buffer_load_dwordx4 a[140:143], v2, s[4:7], s32 offen offset:1024 sc1
  buffer_load_dwordx4 a[144:147], v2, s[4:7], s32 offen offset:2048 sc1
  buffer_load_dwordx4 a[148:151], v2, s[4:7], s32 offen offset:3072 sc1
  buffer_load_dwordx4 a[152:155], v3, s[4:7], s32 offen offset:0 sc1
  buffer_load_dwordx4 a[156:159], v3, s[4:7], s32 offen offset:1024 sc1
  buffer_load_dwordx4 a[160:163], v3, s[4:7], s32 offen offset:2048 sc1
  buffer_load_dwordx4 a[164:167], v3, s[4:7], s32 offen offset:3072 sc1
  buffer_load_dwordx4 a[168:171], v1, s[4:7], s33 offen offset:0 sc1
  buffer_load_dwordx4 a[172:175], v1, s[4:7], s33 offen offset:1024 sc1
reca_nopf84:
  buffer_store_dwordx2 v[52:53], v9, s[4:7], s30 offen
  buffer_store_dwordx2 v[68:69], v10, s[4:7], s31 offen
  buffer_store_dwordx2 v[70:71], v10, s[4:7], s31 offen offset:256
reca_b528:
  s_barrier
  s_add_u32 s17, s17, 1
  s_branch reca_step14
reca_retry17:
  s_sub_u32 s18, s18, 1
  s_cbranch_scc1 reca_retry17_to
  buffer_load_dwordx4 v[128:131], v4, s[4:7], s20 offen sc1
  buffer_load_dwordx4 v[132:135], v4, s[4:7], s20 offen offset:1024 sc1
  buffer_load_dwordx4 v[136:139], v5, s[4:7], s20 offen sc1
  s_waitcnt vmcnt(2)
  v_max_u32 v29, v128, v130
  v_cmp_eq_u32 vcc, -1, v29
  s_cbranch_vccnz reca_retry17
  s_branch reca_resume18
reca_retry17_to:
  s_mov_b32 s18, 0
  s_waitcnt vmcnt(0)
  s_branch reca_resume18
reca_retry19:
  s_sub_u32 s18, s18, 1
  s_cbranch_scc1 reca_retry19_to
  buffer_load_dwordx4 v[132:135], v4, s[4:7], s20 offen offset:1024 sc1
  buffer_load_dwordx4 v[136:139], v5, s[4:7], s20 offen sc1
  s_waitcnt vmcnt(1)
  v_max_u32 v29, v132, v134
  v_cmp_eq_u32 vcc, -1, v29
  s_cbranch_vccnz reca_retry19
  s_branch reca_resume20
reca_retry19_to:
  s_mov_b32 s18, 0
  s_waitcnt vmcnt(0)
  s_branch reca_resume20
reca_retry21:
  s_sub_u32 s18, s18, 1
  s_cbranch_scc1 reca_retry21_to
  buffer_load_dwordx4 v[136:139], v5, s[4:7], s20 offen sc1
  s_waitcnt vmcnt(0)
  v_max_u32 v29, v136, v138
  v_cmp_eq_u32 vcc, -1, v29
  s_cbranch_vccnz reca_retry21
  s_branch reca_resume22
reca_retry21_to:
  s_mov_b32 s18, 0
  s_waitcnt vmcnt(0)
  s_branch reca_resume22
reca_retry30:
  s_sub_u32 s18, s18, 1
  s_cbranch_scc1 reca_retry30_to
  buffer_load_dwordx4 v[208:211], v1, s[4:7], s21 offen offset:0 sc1
  buffer_load_dwordx4 v[212:215], v1, s[4:7], s21 offen offset:1024 sc1
  buffer_load_dwordx4 v[216:219], v1, s[4:7], s21 offen offset:2048 sc1
  buffer_load_dwordx4 v[220:223], v1, s[4:7], s21 offen offset:3072 sc1
  buffer_load_dwordx4 v[224:227], v2, s[4:7], s21 offen offset:0 sc1
  buffer_load_dwordx4 v[228:231], v2, s[4:7], s21 offen offset:1024 sc1
  s_waitcnt vmcnt(5)
  v_max_u32 v29, v208, v210
  v_cmp_eq_u32 vcc, -1, v29
  s_cbranch_vccnz reca_retry30
  s_branch reca_resume31
reca_retry30_to:
  s_mov_b32 s18, 0
  s_waitcnt vmcnt(0)
  s_branch reca_resume31
reca_retry32:
  s_sub_u32 s18, s18, 1
  s_cbranch_scc1 reca_retry32_to
  buffer_load_dwordx4 v[212:215], v1, s[4:7], s21 offen offset:1024 sc1
  buffer_load_dwordx4 v[216:219], v1, s[4:7], s21 offen offset:2048 sc1
  buffer_load_dwordx4 v[220:223], v1, s[4:7], s21 offen offset:3072 sc1
  buffer_load_dwordx4 v[224:227], v2, s[4:7], s21 offen offset:0 sc1
  buffer_load_dwordx4 v[228:231], v2, s[4:7], s21 offen offset:1024 sc1
  s_waitcnt vmcnt(4)
  v_max_u32 v29, v212, v214
  v_cmp_eq_u32 vcc, -1, v29
  s_cbranch_vccnz reca_retry32
  s_branch reca_resume33
reca_retry32_to:
  s_mov_b32 s18, 0
  s_waitcnt vmcnt(0)
  s_branch reca_resume33
reca_retry34:
  s_sub_u32 s18, s18, 1
  s_cbranch_scc1 reca_retry34_to
  buffer_load_dwordx4 v[216:219], v1, s[4:7], s21 offen offset:2048 sc1
  buffer_load_dwordx4 v[220:223], v1, s[4:7], s21 offen offset:3072 sc1
  buffer_load_dwordx4 v[224:227], v2, s[4:7], s21 offen offset:0 sc1
  buffer_load_dwordx4 v[228:231], v2, s[4:7], s21 offen offset:1024 sc1
  s_waitcnt vmcnt(3)
  v_max_u32 v29, v216, v218
  v_cmp_eq_u32 vcc, -1, v29
  s_cbranch_vccnz reca_retry34
  s_branch reca_resume35
reca_retry34_to:
  s_mov_b32 s18, 0
  s_waitcnt vmcnt(0)
  s_branch reca_resume35
reca_retry36:
  s_sub_u32 s18, s18, 1
  s_cbranch_scc1 reca_retry36_to
  buffer_load_dwordx4 v[220:223], v1, s[4:7], s21 offen offset:3072 sc1
  buffer_load_dwordx4 v[224:227], v2, s[4:7], s21 offen offset:0 sc1
  buffer_load_dwordx4 v[228:231], v2, s[4:7], s21 offen offset:1024 sc1
  s_waitcnt vmcnt(2)
  v_max_u32 v29, v220, v222
  v_cmp_eq_u32 vcc, -1, v29
  s_cbranch_vccnz reca_retry36
  s_branch reca_resume37
reca_retry36_to:
  s_mov_b32 s18, 0
  s_waitcnt vmcnt(0)
  s_branch reca_resume37
reca_retry38:
  s_sub_u32 s18, s18, 1
  s_cbranch_scc1 reca_retry38_to
  buffer_load_dwordx4 v[224:227], v2, s[4:7], s21 offen offset:0 sc1
  buffer_load_dwordx4 v[228:231], v2, s[4:7], s21 offen offset:1024 sc1
  s_waitcnt vmcnt(1)
  v_max_u32 v29, v224, v226
  v_cmp_eq_u32 vcc, -1, v29
  s_cbranch_vccnz reca_retry38
  s_branch reca_resume39
reca_retry38_to:
  s_mov_b32 s18, 0
  s_waitcnt vmcnt(0)
  s_branch reca_resume39
reca_retry40:
  s_sub_u32 s18, s18, 1
  s_cbranch_scc1 reca_retry40_to
  buffer_load_dwordx4 v[228:231], v2, s[4:7], s21 offen offset:1024 sc1
  s_waitcnt vmcnt(0)
  v_max_u32 v29, v228, v230
  v_cmp_eq_u32 vcc, -1, v29
  s_cbranch_vccnz reca_retry40
  s_branch reca_resume41
reca_retry40_to:
  s_mov_b32 s18, 0
  s_waitcnt vmcnt(0)
  s_branch reca_resume41
reca_retry43:
  s_sub_u32 s18, s18, 1
  s_cbranch_scc1 reca_retry43_to
  buffer_load_dwordx4 v[128:131], v12, s[4:7], s22 offen offset:0 sc1
  buffer_load_dwordx4 v[132:135], v12, s[4:7], s22 offen offset:1024 sc1
  buffer_load_dwordx4 v[136:139], v12, s[4:7], s22 offen offset:2048 sc1
  buffer_load_dwordx4 v[140:143], v12, s[4:7], s22 offen offset:3072 sc1
  buffer_load_dwordx4 v[144:147], v13, s[4:7], s22 offen offset:0 sc1
  buffer_load_dwordx4 v[148:151], v13, s[4:7], s22 offen offset:1024 sc1
  buffer_load_dwordx4 v[152:155], v13, s[4:7], s22 offen offset:2048 sc1
  buffer_load_dwordx4 v[156:159], v13, s[4:7], s22 offen offset:3072 sc1
  buffer_load_dwordx4 v[160:163], v14, s[4:7], s22 offen offset:0 sc1
  buffer_load_dwordx4 v[164:167], v14, s[4:7], s22 offen offset:1024 sc1
  buffer_load_dwordx4 v[168:171], v14, s[4:7], s22 offen offset:2048 sc1
  buffer_load_dwordx4 v[172:175], v14, s[4:7], s22 offen offset:3072 sc1
  s_waitcnt vmcnt(11)
  v_cmp_eq_u32 vcc, -1, v128
  s_cbranch_vccnz reca_retry43
  s_branch reca_resume44
reca_retry43_to:
  s_mov_b32 s18, 0
  s_waitcnt vmcnt(0)
  s_branch reca_resume44
reca_retry45:
  s_sub_u32 s18, s18, 1
  s_cbranch_scc1 reca_retry45_to
  buffer_load_dwordx4 v[132:135], v12, s[4:7], s22 offen offset:1024 sc1
  buffer_load_dwordx4 v[136:139], v12, s[4:7], s22 offen offset:2048 sc1
  buffer_load_dwordx4 v[140:143], v12, s[4:7], s22 offen offset:3072 sc1
  buffer_load_dwordx4 v[144:147], v13, s[4:7], s22 offen offset:0 sc1
  buffer_load_dwordx4 v[148:151], v13, s[4:7], s22 offen offset:1024 sc1
  buffer_load_dwordx4 v[152:155], v13, s[4:7], s22 offen offset:2048 sc1
  buffer_load_dwordx4 v[156:159], v13, s[4:7], s22 offen offset:3072 sc1
  buffer_load_dwordx4 v[160:163], v14, s[4:7], s22 offen offset:0 sc1
  buffer_load_dwordx4 v[164:167], v14, s[4:7], s22 offen offset:1024 sc1
  buffer_load_dwordx4 v[168:171], v14, s[4:7], s22 offen offset:2048 sc1
  buffer_load_dwordx4 v[172:175], v14, s[4:7], s22 offen offset:3072 sc1
  s_waitcnt vmcnt(10)
  v_cmp_eq_u32 vcc, -1, v132
  s_cbranch_vccnz reca_retry45
  s_branch reca_resume46
reca_retry45_to:
  s_mov_b32 s18, 0
  s_waitcnt vmcnt(0)
  s_branch reca_resume46
reca_retry47:
  s_sub_u32 s18, s18, 1
  s_cbranch_scc1 reca_retry47_to
  buffer_load_dwordx4 v[136:139], v12, s[4:7], s22 offen offset:2048 sc1
  buffer_load_dwordx4 v[140:143], v12, s[4:7], s22 offen offset:3072 sc1
  buffer_load_dwordx4 v[144:147], v13, s[4:7], s22 offen offset:0 sc1
  buffer_load_dwordx4 v[148:151], v13, s[4:7], s22 offen offset:1024 sc1
  buffer_load_dwordx4 v[152:155], v13, s[4:7], s22 offen offset:2048 sc1
  buffer_load_dwordx4 v[156:159], v13, s[4:7], s22 offen offset:3072 sc1
  buffer_load_dwordx4 v[160:163], v14, s[4:7], s22 offen offset:0 sc1
  buffer_load_dwordx4 v[164:167], v14, s[4:7], s22 offen offset:1024 sc1
  buffer_load_dwordx4 v[168:171], v14, s[4:7], s22 offen offset:2048 sc1
  buffer_load_dwordx4 v[172:175], v14, s[4:7], s22 offen offset:3072 sc1
  s_waitcnt vmcnt(9)
  v_cmp_eq_u32 vcc, -1, v136
  s_cbranch_vccnz reca_retry47
  s_branch reca_resume48
reca_retry47_to:
  s_mov_b32 s18, 0
  s_waitcnt vmcnt(0)
  s_branch reca_resume48
reca_retry49:
  s_sub_u32 s18, s18, 1
  s_cbranch_scc1 reca_retry49_to
  buffer_load_dwordx4 v[140:143], v12, s[4:7], s22 offen offset:3072 sc1
  buffer_load_dwordx4 v[144:147], v13, s[4:7], s22 offen offset:0 sc1
  buffer_load_dwordx4 v[148:151], v13, s[4:7], s22 offen offset:1024 sc1
  buffer_load_dwordx4 v[152:155], v13, s[4:7], s22 offen offset:2048 sc1
  buffer_load_dwordx4 v[156:159], v13, s[4:7], s22 offen offset:3072 sc1
  buffer_load_dwordx4 v[160:163], v14, s[4:7], s22 offen offset:0 sc1
  buffer_load_dwordx4 v[164:167], v14, s[4:7], s22 offen offset:1024 sc1
  buffer_load_dwordx4 v[168:171], v14, s[4:7], s22 offen offset:2048 sc1
  buffer_load_dwordx4 v[172:175], v14, s[4:7], s22 offen offset:3072 sc1
  s_waitcnt vmcnt(8)
  v_cmp_eq_u32 vcc, -1, v140
  s_cbranch_vccnz reca_retry49
  s_branch reca_resume50
reca_retry49_to:
  s_mov_b32 s18, 0
  s_waitcnt vmcnt(0)
  s_branch reca_resume50
reca_retry51:
  s_sub_u32 s18, s18, 1
  s_cbranch_scc1 reca_retry51_to
  buffer_load_dwordx4 v[144:147], v13, s[4:7], s22 offen offset:0 sc1
  buffer_load_dwordx4 v[148:151], v13, s[4:7], s22 offen offset:1024 sc1
  buffer_load_dwordx4 v[152:155], v13, s[4:7], s22 offen offset:2048 sc1
  buffer_load_dwordx4 v[156:159], v13, s[4:7], s22 offen offset:3072 sc1
  buffer_load_dwordx4 v[160:163], v14, s[4:7], s22 offen offset:0 sc1
  buffer_load_dwordx4 v[164:167], v14, s[4:7], s22 offen offset:1024 sc1
  buffer_load_dwordx4 v[168:171], v14, s[4:7], s22 offen offset:2048 sc1
  buffer_load_dwordx4 v[172:175], v14, s[4:7], s22 offen offset:3072 sc1
  s_waitcnt vmcnt(7)
  v_cmp_eq_u32 vcc, -1, v144
  s_cbranch_vccnz reca_retry51
  s_branch reca_resume52
reca_retry51_to:
  s_mov_b32 s18, 0
  s_waitcnt vmcnt(0)
  s_branch reca_resume52
reca_retry53:
  s_sub_u32 s18, s18, 1
  s_cbranch_scc1 reca_retry53_to
  buffer_load_dwordx4 v[148:151], v13, s[4:7], s22 offen offset:1024 sc1
  buffer_load_dwordx4 v[152:155], v13, s[4:7], s22 offen offset:2048 sc1
  buffer_load_dwordx4 v[156:159], v13, s[4:7], s22 offen offset:3072 sc1
  buffer_load_dwordx4 v[160:163], v14, s[4:7], s22 offen offset:0 sc1
  buffer_load_dwordx4 v[164:167], v14, s[4:7], s22 offen offset:1024 sc1
  buffer_load_dwordx4 v[168:171], v14, s[4:7], s22 offen offset:2048 sc1
  buffer_load_dwordx4 v[172:175], v14, s[4:7], s22 offen offset:3072 sc1
  s_waitcnt vmcnt(6)
  v_cmp_eq_u32 vcc, -1, v148
  s_cbranch_vccnz reca_retry53
  s_branch reca_resume54
reca_retry53_to:
  s_mov_b32 s18, 0
  s_waitcnt vmcnt(0)
  s_branch reca_resume54
reca_retry55:
  s_sub_u32 s18, s18, 1
  s_cbranch_scc1 reca_retry55_to
  buffer_load_dwordx4 v[152:155], v13, s[4:7], s22 offen offset:2048 sc1
  buffer_load_dwordx4 v[156:159], v13, s[4:7], s22 offen offset:3072 sc1
  buffer_load_dwordx4 v[160:163], v14, s[4:7], s22 offen offset:0 sc1
  buffer_load_dwordx4 v[164:167], v14, s[4:7], s22 offen offset:1024 sc1
  buffer_load_dwordx4 v[168:171], v14, s[4:7], s22 offen offset:2048 sc1
  buffer_load_dwordx4 v[172:175], v14, s[4:7], s22 offen offset:3072 sc1
  s_waitcnt vmcnt(5)
  v_cmp_eq_u32 vcc, -1, v152
  s_cbranch_vccnz reca_retry55
  s_branch reca_resume56
reca_retry55_to:
  s_mov_b32 s18, 0
  s_waitcnt vmcnt(0)
  s_branch reca_resume56
reca_retry57:
  s_sub_u32 s18, s18, 1
  s_cbranch_scc1 reca_retry57_to
  buffer_load_dwordx4 v[156:159], v13, s[4:7], s22 offen offset:3072 sc1
  buffer_load_dwordx4 v[160:163], v14, s[4:7], s22 offen offset:0 sc1
  buffer_load_dwordx4 v[164:167], v14, s[4:7], s22 offen offset:1024 sc1
  buffer_load_dwordx4 v[168:171], v14, s[4:7], s22 offen offset:2048 sc1
  buffer_load_dwordx4 v[172:175], v14, s[4:7], s22 offen offset:3072 sc1
  s_waitcnt vmcnt(4)
  v_cmp_eq_u32 vcc, -1, v156
  s_cbranch_vccnz reca_retry57
  s_branch reca_resume58
reca_retry57_to:
  s_mov_b32 s18, 0
  s_waitcnt vmcnt(0)
  s_branch reca_resume58
reca_retry59:
  s_sub_u32 s18, s18, 1
  s_cbranch_scc1 reca_retry59_to
  buffer_load_dwordx4 v[160:163], v14, s[4:7], s22 offen offset:0 sc1
  buffer_load_dwordx4 v[164:167], v14, s[4:7], s22 offen offset:1024 sc1
  buffer_load_dwordx4 v[168:171], v14, s[4:7], s22 offen offset:2048 sc1
  buffer_load_dwordx4 v[172:175], v14, s[4:7], s22 offen offset:3072 sc1
  s_waitcnt vmcnt(3)
  v_cmp_eq_u32 vcc, -1, v160
  s_cbranch_vccnz reca_retry59
  s_branch reca_resume60
reca_retry59_to:
  s_mov_b32 s18, 0
  s_waitcnt vmcnt(0)
  s_branch reca_resume60
reca_retry61:
  s_sub_u32 s18, s18, 1
  s_cbranch_scc1 reca_retry61_to
  buffer_load_dwordx4 v[164:167], v14, s[4:7], s22 offen offset:1024 sc1
  buffer_load_dwordx4 v[168:171], v14, s[4:7], s22 offen offset:2048 sc1
  buffer_load_dwordx4 v[172:175], v14, s[4:7], s22 offen offset:3072 sc1
  s_waitcnt vmcnt(2)
  v_cmp_eq_u32 vcc, -1, v164
  s_cbranch_vccnz reca_retry61
  s_branch reca_resume62
reca_retry61_to:
  s_mov_b32 s18, 0
  s_waitcnt vmcnt(0)
  s_branch reca_resume62
reca_retry63:
  s_sub_u32 s18, s18, 1
  s_cbranch_scc1 reca_retry63_to
  buffer_load_dwordx4 v[168:171], v14, s[4:7], s22 offen offset:2048 sc1
  buffer_load_dwordx4 v[172:175], v14, s[4:7], s22 offen offset:3072 sc1
  s_waitcnt vmcnt(1)
  v_cmp_eq_u32 vcc, -1, v168
  s_cbranch_vccnz reca_retry63
  s_branch reca_resume64
reca_retry63_to:
  s_mov_b32 s18, 0
  s_waitcnt vmcnt(0)
  s_branch reca_resume64
reca_retry65:
  s_sub_u32 s18, s18, 1
  s_cbranch_scc1 reca_retry65_to
  buffer_load_dwordx4 v[172:175], v14, s[4:7], s22 offen offset:3072 sc1
  s_waitcnt vmcnt(0)
  v_cmp_eq_u32 vcc, -1, v172
  s_cbranch_vccnz reca_retry65
  s_branch reca_resume66
reca_retry65_to:
  s_mov_b32 s18, 0
  s_waitcnt vmcnt(0)
  s_branch reca_resume66
reca_retry68:
  s_sub_u32 s18, s18, 1
  s_cbranch_scc1 reca_retry68_to
  buffer_load_dwordx4 v[128:131], v20, s[4:7], s25 offen sc1
  buffer_load_dwordx4 v[132:135], v21, s[4:7], s25 offen sc1
  buffer_load_dwordx4 v[136:139], v22, s[4:7], s25 offen sc1
  buffer_load_dwordx4 v[140:143], v23, s[4:7], s25 offen sc1
  buffer_load_dwordx4 v[144:147], v24, s[4:7], s25 offen sc1
  buffer_load_dwordx4 v[148:151], v25, s[4:7], s25 offen sc1
  buffer_load_dwordx4 v[152:155], v26, s[4:7], s25 offen sc1
  buffer_load_dwordx4 v[156:159], v27, s[4:7], s25 offen sc1
  s_waitcnt vmcnt(7)
  v_cmp_eq_u32 vcc, -1, v128
  s_cbranch_vccnz reca_retry68
  s_branch reca_resume69
reca_retry68_to:
  s_mov_b32 s18, 0
  s_waitcnt vmcnt(0)
  s_branch reca_resume69
reca_retry70:
  s_sub_u32 s18, s18, 1
  s_cbranch_scc1 reca_retry70_to
  buffer_load_dwordx4 v[132:135], v21, s[4:7], s25 offen sc1
  buffer_load_dwordx4 v[136:139], v22, s[4:7], s25 offen sc1
  buffer_load_dwordx4 v[140:143], v23, s[4:7], s25 offen sc1
  buffer_load_dwordx4 v[144:147], v24, s[4:7], s25 offen sc1
  buffer_load_dwordx4 v[148:151], v25, s[4:7], s25 offen sc1
  buffer_load_dwordx4 v[152:155], v26, s[4:7], s25 offen sc1
  buffer_load_dwordx4 v[156:159], v27, s[4:7], s25 offen sc1
  s_waitcnt vmcnt(6)
  v_cmp_eq_u32 vcc, -1, v132
  s_cbranch_vccnz reca_retry70
  s_branch reca_resume71
reca_retry70_to:
  s_mov_b32 s18, 0
  s_waitcnt vmcnt(0)
  s_branch reca_resume71
reca_retry72:
  s_sub_u32 s18, s18, 1
  s_cbranch_scc1 reca_retry72_to
  buffer_load_dwordx4 v[136:139], v22, s[4:7], s25 offen sc1
  buffer_load_dwordx4 v[140:143], v23, s[4:7], s25 offen sc1
  buffer_load_dwordx4 v[144:147], v24, s[4:7], s25 offen sc1
  buffer_load_dwordx4 v[148:151], v25, s[4:7], s25 offen sc1
  buffer_load_dwordx4 v[152:155], v26, s[4:7], s25 offen sc1
  buffer_load_dwordx4 v[156:159], v27, s[4:7], s25 offen sc1
  s_waitcnt vmcnt(5)
  v_cmp_eq_u32 vcc, -1, v136
  s_cbranch_vccnz reca_retry72
  s_branch reca_resume73
reca_retry72_to:
  s_mov_b32 s18, 0
  s_waitcnt vmcnt(0)
  s_branch reca_resume73
reca_retry74:
  s_sub_u32 s18, s18, 1
  s_cbranch_scc1 reca_retry74_to
  buffer_load_dwordx4 v[140:143], v23, s[4:7], s25 offen sc1
  buffer_load_dwordx4 v[144:147], v24, s[4:7], s25 offen sc1
  buffer_load_dwordx4 v[148:151], v25, s[4:7], s25 offen sc1
  buffer_load_dwordx4 v[152:155], v26, s[4:7], s25 offen sc1
  buffer_load_dwordx4 v[156:159], v27, s[4:7], s25 offen sc1
  s_waitcnt vmcnt(4)
  v_cmp_eq_u32 vcc, -1, v140
  s_cbranch_vccnz reca_retry74
  s_branch reca_resume75
reca_retry74_to:
  s_mov_b32 s18, 0
  s_waitcnt vmcnt(0)
  s_branch reca_resume75
reca_retry76:
  s_sub_u32 s18, s18, 1
  s_cbranch_scc1 reca_retry76_to
  buffer_load_dwordx4 v[144:147], v24, s[4:7], s25 offen sc1
  buffer_load_dwordx4 v[148:151], v25, s[4:7], s25 offen sc1
  buffer_load_dwordx4 v[152:155], v26, s[4:7], s25 offen sc1
  buffer_load_dwordx4 v[156:159], v27, s[4:7], s25 offen sc1
  s_waitcnt vmcnt(3)
  v_cmp_eq_u32 vcc, -1, v144
  s_cbranch_vccnz reca_retry76
  s_branch reca_resume77
reca_retry76_to:
  s_mov_b32 s18, 0
  s_waitcnt vmcnt(0)
  s_branch reca_resume77
reca_retry78:
  s_sub_u32 s18, s18, 1
  s_cbranch_scc1 reca_retry78_to
  buffer_load_dwordx4 v[148:151], v25, s[4:7], s25 offen sc1
  buffer_load_dwordx4 v[152:155], v26, s[4:7], s25 offen sc1
  buffer_load_dwordx4 v[156:159], v27, s[4:7], s25 offen sc1
  s_waitcnt vmcnt(2)
  v_cmp_eq_u32 vcc, -1, v148
  s_cbranch_vccnz reca_retry78
  s_branch reca_resume79
reca_retry78_to:
  s_mov_b32 s18, 0
  s_waitcnt vmcnt(0)
  s_branch reca_resume79
reca_retry80:
  s_sub_u32 s18, s18, 1
  s_cbranch_scc1 reca_retry80_to
  buffer_load_dwordx4 v[152:155], v26, s[4:7], s25 offen sc1
  buffer_load_dwordx4 v[156:159], v27, s[4:7], s25 offen sc1
  s_waitcnt vmcnt(1)
  v_cmp_eq_u32 vcc, -1, v152
  s_cbranch_vccnz reca_retry80
  s_branch reca_resume81
reca_retry80_to:
  s_mov_b32 s18, 0
  s_waitcnt vmcnt(0)
  s_branch reca_resume81
reca_retry82:
  s_sub_u32 s18, s18, 1
  s_cbranch_scc1 reca_retry82_to
  buffer_load_dwordx4 v[156:159], v27, s[4:7], s25 offen sc1
  s_waitcnt vmcnt(0)
  v_cmp_eq_u32 vcc, -1, v156
  s_cbranch_vccnz reca_retry82
  s_branch reca_resume83
reca_retry82_to:
  s_mov_b32 s18, 0
  s_waitcnt vmcnt(0)
  s_branch reca_resume83
reca_twinf12:
  s_branch reca_gotmem88
reca_step87:
  s_and_b32 s34, s17, 3
  s_mul_i32 s20, s34, 10240
  s_add_u32 s20, s20, s38
  s_sleep 5
  buffer_load_dwordx4 v[128:131], v4, s[4:7], s20 offen sc1
  buffer_load_dwordx4 v[132:135], v4, s[4:7], s20 offen offset:1024 sc1
  buffer_load_dwordx4 v[136:139], v5, s[4:7], s20 offen sc1
  s_waitcnt vmcnt(2)
  v_max_u32 v29, v128, v130
  v_cmp_eq_u32 vcc, -1, v29
  s_cbranch_vccnz reca_retry90
reca_resume91:
  s_waitcnt vmcnt(1)
  v_max_u32 v29, v132, v134
  v_cmp_eq_u32 vcc, -1, v29
  ds_write_b128 v4, v[128:131]
  s_cbranch_vccnz reca_retry92
reca_resume93:
  s_waitcnt vmcnt(0)
  v_max_u32 v29, v136, v138
  v_cmp_eq_u32 vcc, -1, v29
  ds_write_b128 v4, v[132:135] offset:1024
  s_cbranch_vccnz reca_retry94
reca_resume95:
  ds_write_b128 v5, v[136:139]
  s_branch reca_gotmem289
reca_gotmem88:
  ds_write_b128 v4, v[128:131]
  ds_write_b128 v4, v[132:135] offset:1024
  ds_write_b128 v5, v[136:139]
reca_gotmem289:
  s_and_b32 s34, s17, 3
  s_mul_i32 s21, s34, 6144
  s_add_u32 s21, s21, s39
  s_mul_i32 s22, s34, 12288
  s_add_u32 s22, s22, s40
  s_mul_i32 s25, s34, 393216
  s_add_u32 s25, s25, s56
  s_add_u32 s35, s17, 1
  s_and_b32 s35, s35, 3
  s_mul_i32 s24, s35, 10240
  s_add_u32 s24, s24, s38
  s_waitcnt lgkmcnt(0)
  s_barrier
  ds_read_b128 v[128:131], v236 offset:0
  ds_read_b128 v[132:135], v236 offset:1024
  ds_read_b128 v[136:139], v236 offset:2048
  ds_read_b128 v[140:143], v236 offset:3072
  ds_read_b128 v[144:147], v236 offset:4096
  ds_read_b128 v[148:151], v237 offset:0
  ds_read_b128 v[152:155], v237 offset:1024
  ds_read_b128 v[156:159], v237 offset:2048
  ds_read_b128 v[160:163], v237 offset:3072
  ds_read_b128 v[164:167], v237 offset:4096
  s_waitcnt lgkmcnt(9)
  v_mfma_f32_16x16x32_bf16 v[44:47], a[0:3], v[128:131], 0
  ds_read_b128 v[168:171], v6 offset:0
  v_mfma_f32_16x16x32_bf16 v[240:243], a[4:7], v[128:131], 0
  s_waitcnt lgkmcnt(9)
  v_mfma_f32_16x16x32_bf16 v[44:47], a[8:11], v[132:135], v[44:47]
  ds_read_b128 v[172:175], v6 offset:512
  v_mfma_f32_16x16x32_bf16 v[240:243], a[12:15], v[132:135], v[240:243]
  s_waitcnt lgkmcnt(9)
  v_mfma_f32_16x16x32_bf16 v[44:47], a[16:19], v[136:139], v[44:47]
  ds_read_b128 v[176:179], v6 offset:1024
  v_mfma_f32_16x16x32_bf16 v[240:243], a[20:23], v[136:139], v[240:243]
  s_waitcnt lgkmcnt(9)
  v_mfma_f32_16x16x32_bf16 v[44:47], a[24:27], v[140:143], v[44:47]
  ds_read_b128 v[180:183], v6 offset:1536
  v_mfma_f32_16x16x32_bf16 v[240:243], a[28:31], v[140:143], v[240:243]
  s_waitcnt lgkmcnt(9)
  v_mfma_f32_16x16x32_bf16 v[44:47], a[32:35], v[144:147], v[44:47]
  ds_read_b128 v[184:187], v6 offset:2048
  v_mfma_f32_16x16x32_bf16 v[240:243], a[36:39], v[144:147], v[240:243]
  s_waitcnt lgkmcnt(9)
  v_mfma_f32_16x16x32_bf16 v[44:47], a[40:43], v[148:151], v[44:47]
  ds_read_b128 v[188:191], v6 offset:2560
  v_mfma_f32_16x16x32_bf16 v[240:243], a[44:47], v[148:151], v[240:243]
  s_waitcnt lgkmcnt(9)
  v_mfma_f32_16x16x32_bf16 v[44:47], a[48:51], v[152:155], v[44:47]
  ds_read_b128 v[192:195], v6 offset:3072
  v_mfma_f32_16x16x32_bf16 v[240:243], a[52:55], v[152:155], v[240:243]
  s_waitcnt lgkmcnt(9)
  v_mfma_f32_16x16x32_bf16 v[44:47], a[56:59], v[156:159], v[44:47]
  ds_read_b128 v[196:199], v6 offset:3584
  v_mfma_f32_16x16x32_bf16 v[240:243], a[60:63], v[156:159], v[240:243]
  s_waitcnt lgkmcnt(9)
  v_mfma_f32_16x16x32_bf16 v[44:47], a[64:67], v[160:163], v[44:47]
  ds_read_b128 v[200:203], v6 offset:4096
  v_mfma_f32_16x16x32_bf16 v[240:243], a[68:71], v[160:163], v[240:243]
  s_waitcnt lgkmcnt(9)
  v_mfma_f32_16x16x32_bf16 v[44:47], a[72:75], v[164:167], v[44:47]
  ds_read_b128 v[204:207], v6 offset:4608
  v_mfma_f32_16x16x32_bf16 v[240:243], a[76:79], v[164:167], v[240:243]
  s_waitcnt lgkmcnt(9)
  v_mfma_f32_16x16x32_bf16 v[48:51], v[168:171], a[80:83], 0
  s_lshl_b32 s34, s17, 5
  s_add_u32 s34, s34, s15
  s_mul_i32 s34, s34, 3072
  s_lshl_b32 s35, s16, 9
  s_add_u32 s34, s34, s35
  s_add_u32 s30, s34, 113246208
  s_add_u32 s31, s34, 119537664
  v_add_f32_dpp v44, v240, v44 row_ror:8 row_mask:0xf bank_mask:0xf
  v_add_f32_dpp v45, v241, v45 row_ror:8 row_mask:0xf bank_mask:0xf
  v_add_f32_dpp v46, v242, v46 row_ror:8 row_mask:0xf bank_mask:0xf
  v_add_f32_dpp v47, v243, v47 row_ror:8 row_mask:0xf bank_mask:0xf
  v_cvt_pk_bf16_f32 v52, v44, v45
  v_cvt_pk_bf16_f32 v53, v46, v47
  buffer_store_dwordx2 v[52:53], v8, s[4:7], s21 offen
  s_waitcnt lgkmcnt(8)
  v_mfma_f32_16x16x32_bf16 v[48:51], v[172:175], a[84:87], v[48:51]
  s_waitcnt lgkmcnt(7)
  v_mfma_f32_16x16x32_bf16 v[48:51], v[176:179], a[88:91], v[48:51]
  s_waitcnt lgkmcnt(6)
  v_mfma_f32_16x16x32_bf16 v[48:51], v[180:183], a[92:95], v[48:51]
  s_waitcnt lgkmcnt(5)
  v_mfma_f32_16x16x32_bf16 v[48:51], v[184:187], a[96:99], v[48:51]
  s_waitcnt lgkmcnt(4)
  v_mfma_f32_16x16x32_bf16 v[48:51], v[188:191], a[100:103], v[48:51]
  s_waitcnt lgkmcnt(3)
  v_mfma_f32_16x16x32_bf16 v[48:51], v[192:195], a[104:107], v[48:51]
  s_waitcnt lgkmcnt(2)
  v_mfma_f32_16x16x32_bf16 v[48:51], v[196:199], a[108:111], v[48:51]
  s_waitcnt lgkmcnt(1)
  v_mfma_f32_16x16x32_bf16 v[48:51], v[200:203], a[112:115], v[48:51]
  s_waitcnt lgkmcnt(0)
  v_mfma_f32_16x16x32_bf16 v[48:51], v[204:207], a[116:119], v[48:51]
  s_cmp_eq_u32 s12, 3
  s_cbranch_scc1 reca_swave96
  s_nop 5
  ds_write_b128 v17, v[48:51]
  s_add_u32 s34, s17, 2
  s_and_b32 s34, s34, 3
  s_mul_i32 s26, s34, 10240
  s_add_u32 s26, s26, s38
  s_mul_i32 s27, s34, 6144
  s_add_u32 s27, s27, s39
  s_mul_i32 s28, s34, 12288
  s_add_u32 s28, s28, s40
  s_mul_i32 s29, s34, 393216
  s_add_u32 s29, s29, s56
  s_waitcnt lgkmcnt(0)
  s_barrier
  s_cmp_eq_u32 s17, 63
  s_cbranch_scc1 reca_last98
  buffer_store_dwordx2 v[32:33], v8, s[4:7], s27 offen
  s_cmp_lg_u32 s12, 2
  s_cbranch_scc1 reca_tw1102_n
  buffer_store_dwordx2 v[52:53], v9, s[4:7], s30 offen
reca_tw1102_n:
  s_barrier
  s_cmp_eq_u32 s12, 1
  s_cbranch_scc1 reca_tw1102
  s_cmp_eq_u32 s12, 2
  s_cbranch_scc1 reca_tw2103
  s_cmp_lt_u32 s17, 2
  s_cbranch_scc1 reca_b5101
  s_cmp_gt_u32 s17, 61
  s_cbranch_scc1 reca_b5101
  s_sub_u32 s36, s17, 2
  s_lshl_b32 s34, s59, 6
  s_add_u32 s34, s34, s36
  s_mul_i32 s34, s34, 12288
  s_add_u32 s23, s34, 37748736
  s_add_u32 s60, s34, 88080384
  s_lshl_b32 s35, s36, 5
  s_add_u32 s35, s35, s59
  s_mul_i32 s35, s35, 3072
  s_add_u32 s61, s35, 113246208
  buffer_load_dwordx4 a[120:123], v1, s[4:7], s23 offen offset:0 sc1
  buffer_load_dwordx4 a[124:127], v1, s[4:7], s23 offen offset:1024 sc1
  buffer_load_dwordx4 a[128:131], v1, s[4:7], s23 offen offset:2048 sc1
  buffer_load_dwordx4 a[132:135], v1, s[4:7], s23 offen offset:3072 sc1
  buffer_load_dwordx4 a[136:139], v2, s[4:7], s23 offen offset:0 sc1
  buffer_load_dwordx4 a[140:143], v2, s[4:7], s23 offen offset:1024 sc1
  buffer_load_dwordx4 a[144:147], v2, s[4:7], s23 offen offset:2048 sc1
  buffer_load_dwordx4 a[148:151], v2, s[4:7], s23 offen offset:3072 sc1
  buffer_load_dwordx4 a[152:155], v3, s[4:7], s23 offen offset:0 sc1
  buffer_load_dwordx4 a[156:159], v3, s[4:7], s23 offen offset:1024 sc1
  buffer_load_dwordx4 a[160:163], v3, s[4:7], s23 offen offset:2048 sc1
  buffer_load_dwordx4 a[164:167], v3, s[4:7], s23 offen offset:3072 sc1
  buffer_load_dwordx4 a[216:219], v92, s[4:7], s61 offen offset:0 sc1
  buffer_load_dwordx4 a[220:223], v92, s[4:7], s61 offen offset:512 sc1
  buffer_load_dwordx4 a[224:227], v92, s[4:7], s61 offen offset:1024 sc1
  buffer_load_dwordx4 a[228:231], v92, s[4:7], s61 offen offset:1536 sc1
  buffer_load_dwordx4 a[232:235], v92, s[4:7], s61 offen offset:2048 sc1
  buffer_load_dwordx4 a[236:239], v92, s[4:7], s61 offen offset:2560 sc1
  buffer_load_dwordx4 a[168:171], v1, s[4:7], s60 offen offset:0 sc1
  buffer_load_dwordx4 a[172:175], v1, s[4:7], s60 offen offset:1024 sc1
  buffer_load_dwordx4 a[176:179], v1, s[4:7], s60 offen offset:2048 sc1
  buffer_load_dwordx4 a[180:183], v1, s[4:7], s60 offen offset:3072 sc1
  buffer_load_dwordx4 a[184:187], v2, s[4:7], s60 offen offset:0 sc1
  buffer_load_dwordx4 a[188:191], v2, s[4:7], s60 offen offset:1024 sc1
  buffer_load_dwordx4 a[192:195], v2, s[4:7], s60 offen offset:2048 sc1
  buffer_load_dwordx4 a[196:199], v2, s[4:7], s60 offen offset:3072 sc1
  buffer_load_dwordx4 a[200:203], v3, s[4:7], s60 offen offset:0 sc1
  buffer_load_dwordx4 a[204:207], v3, s[4:7], s60 offen offset:1024 sc1
  buffer_load_dwordx4 a[208:211], v3, s[4:7], s60 offen offset:2048 sc1
  buffer_load_dwordx4 a[212:215], v3, s[4:7], s60 offen offset:3072 sc1
  s_waitcnt vmcnt(5)
  v_mfma_f32_16x16x32_bf16 v[128:131], a[216:219], a[168:171], v[84:87]
  v_mfma_f32_16x16x32_bf16 v[132:135], a[120:123], a[168:171], v[88:91]
  v_mfma_f32_16x16x32_bf16 v[136:139], a[216:219], a[192:195], v[84:87]
  v_mfma_f32_16x16x32_bf16 v[140:143], a[120:123], a[192:195], 0
  v_mfma_f32_16x16x32_bf16 v[144:147], a[144:147], a[192:195], v[88:91]
  s_waitcnt vmcnt(4)
  v_mfma_f32_16x16x32_bf16 v[128:131], a[220:223], a[172:175], v[128:131]
  v_mfma_f32_16x16x32_bf16 v[132:135], a[124:127], a[172:175], v[132:135]
  v_mfma_f32_16x16x32_bf16 v[136:139], a[220:223], a[196:199], v[136:139]
  v_mfma_f32_16x16x32_bf16 v[140:143], a[124:127], a[196:199], v[140:143]
  v_mfma_f32_16x16x32_bf16 v[144:147], a[148:151], a[196:199], v[144:147]
  s_waitcnt vmcnt(3)
  v_mfma_f32_16x16x32_bf16 v[128:131], a[224:227], a[176:179], v[128:131]
  v_mfma_f32_16x16x32_bf16 v[132:135], a[128:131], a[176:179], v[132:135]
  v_mfma_f32_16x16x32_bf16 v[136:139], a[224:227], a[200:203], v[136:139]
  v_mfma_f32_16x16x32_bf16 v[140:143], a[128:131], a[200:203], v[140:143]
  v_mfma_f32_16x16x32_bf16 v[144:147], a[152:155], a[200:203], v[144:147]
  s_waitcnt vmcnt(2)
  v_mfma_f32_16x16x32_bf16 v[128:131], a[228:231], a[180:183], v[128:131]
  v_mfma_f32_16x16x32_bf16 v[132:135], a[132:135], a[180:183], v[132:135]
  v_mfma_f32_16x16x32_bf16 v[136:139], a[228:231], a[204:207], v[136:139]
  v_mfma_f32_16x16x32_bf16 v[140:143], a[132:135], a[204:207], v[140:143]
  v_mfma_f32_16x16x32_bf16 v[144:147], a[156:159], a[204:207], v[144:147]
  s_waitcnt vmcnt(1)
  v_mfma_f32_16x16x32_bf16 v[128:131], a[232:235], a[184:187], v[128:131]
  v_mfma_f32_16x16x32_bf16 v[132:135], a[136:139], a[184:187], v[132:135]
  v_mfma_f32_16x16x32_bf16 v[136:139], a[232:235], a[208:211], v[136:139]
  v_mfma_f32_16x16x32_bf16 v[140:143], a[136:139], a[208:211], v[140:143]
  v_mfma_f32_16x16x32_bf16 v[144:147], a[160:163], a[208:211], v[144:147]
  s_waitcnt vmcnt(0)
  v_mfma_f32_16x16x32_bf16 v[128:131], a[236:239], a[188:191], v[128:131]
  v_mfma_f32_16x16x32_bf16 v[132:135], a[140:143], a[188:191], v[132:135]
  v_mfma_f32_16x16x32_bf16 v[136:139], a[236:239], a[212:215], v[136:139]
  v_mfma_f32_16x16x32_bf16 v[140:143], a[140:143], a[212:215], v[140:143]
  v_mfma_f32_16x16x32_bf16 v[144:147], a[164:167], a[212:215], v[144:147]
  s_nop 3
  v_max3_f32 v28, v128, v129, v130
  v_max3_f32 v28, v28, v131, v132
  v_max3_f32 v28, v28, v133, v134
  v_max_f32 v28, v28, v135
  v_mov_b32 v29, v28
  s_nop 1
  v_permlane32_swap_b32 v28, v29
  v_max_f32 v28, v28, v29
  v_mov_b32 v29, v28
  s_nop 1
  v_permlane16_swap_b32 v28, v29
  v_max_f32 v28, v28, v29
  v_mul_f32 v28, s41, v28
  v_fma_f32 v128, v128, s41, -v28
  v_fma_f32 v129, v129, s41, -v28
  v_fma_f32 v130, v130, s41, -v28
  v_fma_f32 v131, v131, s41, -v28
  v_fma_f32 v132, v132, s41, -v28
  v_fma_f32 v133, v133, s41, -v28
  v_fma_f32 v134, v134, s41, -v28
  v_fma_f32 v135, v135, s41, -v28
  v_exp_f32 v128, v128
  v_exp_f32 v129, v129
  v_exp_f32 v130, v130
  v_exp_f32 v131, v131
  v_exp_f32 v132, v132
  v_exp_f32 v133, v133
  v_exp_f32 v134, v134
  v_exp_f32 v135, v135
  v_max3_f32 v30, v136, v137, v138
  v_max3_f32 v30, v30, v139, v140
  v_max3_f32 v30, v30, v141, v142
  v_max3_f32 v30, v30, v143, v144
  v_max3_f32 v30, v30, v145, v146
  v_max_f32 v30, v30, v147
  v_mov_b32 v29, v30
  s_nop 1
  v_permlane32_swap_b32 v30, v29
  v_max_f32 v30, v30, v29
  v_mov_b32 v29, v30
  s_nop 1
  v_permlane16_swap_b32 v30, v29
  v_max_f32 v30, v30, v29
  v_mul_f32 v30, s41, v30
  v_fma_f32 v136, v136, s41, -v30
  v_fma_f32 v137, v137, s41, -v30
  v_fma_f32 v138, v138, s41, -v30
  v_fma_f32 v139, v139, s41, -v30
  v_fma_f32 v140, v140, s41, -v30
  v_fma_f32 v141, v141, s41, -v30
  v_fma_f32 v142, v142, s41, -v30
  v_fma_f32 v143, v143, s41, -v30
  v_fma_f32 v144, v144, s41, -v30
  v_fma_f32 v145, v145, s41, -v30
  v_fma_f32 v146, v146, s41, -v30
  v_fma_f32 v147, v147, s41, -v30
  v_exp_f32 v136, v136
  v_exp_f32 v137, v137
  v_exp_f32 v138, v138
  v_exp_f32 v139, v139
  v_exp_f32 v140, v140
  v_exp_f32 v141, v141
  v_exp_f32 v142, v142
  v_exp_f32 v143, v143
  v_exp_f32 v144, v144
  v_exp_f32 v145, v145
  v_exp_f32 v146, v146
  v_exp_f32 v147, v147
  v_cvt_pk_bf16_f32 v72, v128, v129
  v_cvt_pk_bf16_f32 v73, v130, v131
  v_cvt_pk_bf16_f32 v74, v132, v133
  v_cvt_pk_bf16_f32 v75, v134, v135
  v_cvt_pk_bf16_f32 v76, v136, v137
  v_cvt_pk_bf16_f32 v77, v138, v139
  v_cvt_pk_bf16_f32 v78, v140, v141
  v_cvt_pk_bf16_f32 v79, v142, v143
  v_cvt_pk_bf16_f32 v80, v144, v145
  v_cvt_pk_bf16_f32 v81, v146, v147
  v_mfma_f32_16x16x16_bf16 v[148:151], v[36:37], v[72:73], 0
  v_mfma_f32_16x16x16_bf16 v[152:155], v[36:37], v[76:77], 0
  v_mfma_f32_16x16x16_bf16 v[148:151], v[36:37], v[74:75], v[148:151]
  v_mfma_f32_16x16x32_bf16 v[152:155], v[36:39], v[78:81], v[152:155]
  s_nop 6
  v_rcp_f32 v82, v148
  v_rcp_f32 v83, v152
  s_and_b32 s34, s17, 1
  s_mul_i32 s34, s34, 3072
  v_add_u32 v28, s34, v1
  ds_write_b128 v28, v[72:75] offset:16384
  ds_write_b128 v28, v[76:79] offset:17408
  ds_write_b128 v28, v[80:83] offset:18432
  s_waitcnt lgkmcnt(0)
  s_branch reca_b5101
reca_tw1102:
  s_cmp_lt_u32 s17, 3
  s_cbranch_scc1 reca_b5101
  s_sub_u32 s36, s17, 3
  s_lshl_b32 s34, s59, 6
  s_add_u32 s34, s34, s36
  s_mul_i32 s34, s34, 12288
  s_add_u32 s23, s34, 62914560
  s_lshl_b32 s35, s36, 5
  s_add_u32 s35, s35, s59
  s_mul_i32 s35, s35, 3072
  s_add_u32 s61, s35, 119537664
  s_mul_i32 s34, s36, 393216
  s_mul_i32 s35, s59, 6144
  s_add_u32 s34, s34, s35
  s_add_u32 s60, s34, 125829120
  s_add_u32 s34, s17, 1
  s_and_b32 s34, s34, 1
  s_mul_i32 s34, s34, 3072
  v_add_u32 v28, s34, v1
  ds_read_b128 v[72:75], v28 offset:16384
  ds_read_b128 v[76:79], v28 offset:17408
  ds_read_b128 v[80:83], v28 offset:18432
  buffer_load_dwordx2 a[168:169], v93, s[4:7], s61 offen offset:0 sc1
  buffer_load_dwordx4 a[120:123], v1, s[4:7], s23 offen offset:0 sc1
  buffer_load_dwordx2 a[170:171], v93, s[4:7], s61 offen offset:256 sc1
  buffer_load_dwordx4 a[124:127], v1, s[4:7], s23 offen offset:1024 sc1
  buffer_load_dwordx2 a[172:173], v93, s[4:7], s61 offen offset:512 sc1
  buffer_load_dwordx4 a[128:131], v1, s[4:7], s23 offen offset:2048 sc1
  buffer_load_dwordx2 a[174:175], v93, s[4:7], s61 offen offset:768 sc1
  buffer_load_dwordx4 a[132:135], v1, s[4:7], s23 offen offset:3072 sc1
  buffer_load_dwordx2 a[176:177], v93, s[4:7], s61 offen offset:1024 sc1
  buffer_load_dwordx4 a[136:139], v2, s[4:7], s23 offen offset:0 sc1
  buffer_load_dwordx2 a[178:179], v93, s[4:7], s61 offen offset:1280 sc1
  buffer_load_dwordx4 a[140:143], v2, s[4:7], s23 offen offset:1024 sc1
  s_waitcnt lgkmcnt(0)
  s_waitcnt vmcnt(8)
  v_mfma_f32_16x16x16_bf16 v[156:159], a[168:169], v[72:73], 0
  v_mfma_f32_16x16x16_bf16 v[160:163], a[168:169], v[76:77], 0
  v_mfma_f32_16x16x16_bf16 v[156:159], a[120:121], v[74:75], v[156:159]
  v_mfma_f32_16x16x32_bf16 v[160:163], a[120:123], v[78:81], v[160:163]
  v_mfma_f32_16x16x16_bf16 v[164:167], a[170:171], v[72:73], 0
  v_mfma_f32_16x16x16_bf16 v[168:171], a[170:171], v[76:77], 0
  v_mfma_f32_16x16x16_bf16 v[164:167], a[124:125], v[74:75], v[164:167]
  v_mfma_f32_16x16x32_bf16 v[168:171], a[124:127], v[78:81], v[168:171]
  s_nop 2
  v_mul_f32 v156, v156, v82
  v_mul_f32 v157, v157, v82
  v_mul_f32 v158, v158, v82
  v_mul_f32 v159, v159, v82
  v_cvt_pk_bf16_f32 v172, v156, v157
  v_cvt_pk_bf16_f32 v173, v158, v159
  v_mul_f32 v164, v164, v82
  v_mul_f32 v165, v165, v82
  v_mul_f32 v166, v166, v82
  v_mul_f32 v167, v167, v82
  v_cvt_pk_bf16_f32 v174, v164, v165
  v_cvt_pk_bf16_f32 v175, v166, v167
  buffer_store_dwordx4 v[172:175], v1, s[4:7], s60 offen offset:0
  v_mul_f32 v160, v160, v83
  v_mul_f32 v161, v161, v83
  v_mul_f32 v162, v162, v83
  v_mul_f32 v163, v163, v83
  v_cvt_pk_bf16_f32 v176, v160, v161
  v_cvt_pk_bf16_f32 v177, v162, v163
  v_mul_f32 v168, v168, v83
  v_mul_f32 v169, v169, v83
  v_mul_f32 v170, v170, v83
  v_mul_f32 v171, v171, v83
  v_cvt_pk_bf16_f32 v178, v168, v169
  v_cvt_pk_bf16_f32 v179, v170, v171
  s_add_u32 s34, s60, 196608
  buffer_store_dwordx4 v[176:179], v1, s[4:7], s34 offen offset:0
  s_waitcnt vmcnt(6)
  v_mfma_f32_16x16x16_bf16 v[156:159], a[172:173], v[72:73], 0
  v_mfma_f32_16x16x16_bf16 v[160:163], a[172:173], v[76:77], 0
  v_mfma_f32_16x16x16_bf16 v[156:159], a[128:129], v[74:75], v[156:159]
  v_mfma_f32_16x16x32_bf16 v[160:163], a[128:131], v[78:81], v[160:163]
  v_mfma_f32_16x16x16_bf16 v[164:167], a[174:175], v[72:73], 0
  v_mfma_f32_16x16x16_bf16 v[168:171], a[174:175], v[76:77], 0
  v_mfma_f32_16x16x16_bf16 v[164:167], a[132:133], v[74:75], v[164:167]
  v_mfma_f32_16x16x32_bf16 v[168:171], a[132:135], v[78:81], v[168:171]
  s_nop 2
  v_mul_f32 v156, v156, v82
  v_mul_f32 v157, v157, v82
  v_mul_f32 v158, v158, v82
  v_mul_f32 v159, v159, v82
  v_cvt_pk_bf16_f32 v172, v156, v157
  v_cvt_pk_bf16_f32 v173, v158, v159
  v_mul_f32 v164, v164, v82
  v_mul_f32 v165, v165, v82
  v_mul_f32 v166, v166, v82
  v_mul_f32 v167, v167, v82
  v_cvt_pk_bf16_f32 v174, v164, v165
  v_cvt_pk_bf16_f32 v175, v166, v167
  buffer_store_dwordx4 v[172:175], v1, s[4:7], s60 offen offset:1024
  v_mul_f32 v160, v160, v83
  v_mul_f32 v161, v161, v83
  v_mul_f32 v162, v162, v83
  v_mul_f32 v163, v163, v83
  v_cvt_pk_bf16_f32 v176, v160, v161
  v_cvt_pk_bf16_f32 v177, v162, v163
  v_mul_f32 v168, v168, v83
  v_mul_f32 v169, v169, v83
  v_mul_f32 v170, v170, v83
  v_mul_f32 v171, v171, v83
  v_cvt_pk_bf16_f32 v178, v168, v169
  v_cvt_pk_bf16_f32 v179, v170, v171
  s_add_u32 s34, s60, 196608
  buffer_store_dwordx4 v[176:179], v1, s[4:7], s34 offen offset:1024
  s_waitcnt vmcnt(4)
  v_mfma_f32_16x16x16_bf16 v[156:159], a[176:177], v[72:73], 0
  v_mfma_f32_16x16x16_bf16 v[160:163], a[176:177], v[76:77], 0
  v_mfma_f32_16x16x16_bf16 v[156:159], a[136:137], v[74:75], v[156:159]
  v_mfma_f32_16x16x32_bf16 v[160:163], a[136:139], v[78:81], v[160:163]
  v_mfma_f32_16x16x16_bf16 v[164:167], a[178:179], v[72:73], 0
  v_mfma_f32_16x16x16_bf16 v[168:171], a[178:179], v[76:77], 0
  v_mfma_f32_16x16x16_bf16 v[164:167], a[140:141], v[74:75], v[164:167]
  v_mfma_f32_16x16x32_bf16 v[168:171], a[140:143], v[78:81], v[168:171]
  s_nop 2
  v_mul_f32 v156, v156, v82
  v_mul_f32 v157, v157, v82
  v_mul_f32 v158, v158, v82
  v_mul_f32 v159, v159, v82
  v_cvt_pk_bf16_f32 v172, v156, v157
  v_cvt_pk_bf16_f32 v173, v158, v159
  v_mul_f32 v164, v164, v82
  v_mul_f32 v165, v165, v82
  v_mul_f32 v166, v166, v82
  v_mul_f32 v167, v167, v82
  v_cvt_pk_bf16_f32 v174, v164, v165
  v_cvt_pk_bf16_f32 v175, v166, v167
  buffer_store_dwordx4 v[172:175], v1, s[4:7], s60 offen offset:2048
  v_mul_f32 v160, v160, v83
  v_mul_f32 v161, v161, v83
  v_mul_f32 v162, v162, v83
  v_mul_f32 v163, v163, v83
  v_cvt_pk_bf16_f32 v176, v160, v161
  v_cvt_pk_bf16_f32 v177, v162, v163
  v_mul_f32 v168, v168, v83
  v_mul_f32 v169, v169, v83
  v_mul_f32 v170, v170, v83
  v_mul_f32 v171, v171, v83
  v_cvt_pk_bf16_f32 v178, v168, v169
  v_cvt_pk_bf16_f32 v179, v170, v171
  s_add_u32 s34, s60, 196608
  buffer_store_dwordx4 v[176:179], v1, s[4:7], s34 offen offset:2048
  s_branch reca_b5101
reca_tw2103:
  s_cmp_lt_u32 s17, 3
  s_cbranch_scc1 reca_b5101
  s_sub_u32 s36, s17, 3
  s_lshl_b32 s34, s59, 6
  s_add_u32 s34, s34, s36
  s_mul_i32 s34, s34, 12288
  s_add_u32 s23, s34, 62914560
  s_lshl_b32 s35, s36, 5
  s_add_u32 s35, s35, s59
  s_mul_i32 s35, s35, 3072
  s_add_u32 s61, s35, 119537664
  s_mul_i32 s34, s36, 393216
  s_mul_i32 s35, s59, 6144
  s_add_u32 s34, s34, s35
  s_add_u32 s60, s34, 125829120
  s_add_u32 s34, s17, 1
  s_and_b32 s34, s34, 1
  s_mul_i32 s34, s34, 3072
  v_add_u32 v28, s34, v1
  ds_read_b128 v[72:75], v28 offset:16384
  ds_read_b128 v[76:79], v28 offset:17408
  ds_read_b128 v[80:83], v28 offset:18432
  buffer_load_dwordx2 a[180:181], v93, s[4:7], s61 offen offset:1536 sc1
  buffer_load_dwordx4 a[144:147], v2, s[4:7], s23 offen offset:2048 sc1
  buffer_load_dwordx2 a[182:183], v93, s[4:7], s61 offen offset:1792 sc1
  buffer_load_dwordx4 a[148:151], v2, s[4:7], s23 offen offset:3072 sc1
  buffer_load_dwordx2 a[184:185], v93, s[4:7], s61 offen offset:2048 sc1
  buffer_load_dwordx4 a[152:155], v3, s[4:7], s23 offen offset:0 sc1
  buffer_load_dwordx2 a[186:187], v93, s[4:7], s61 offen offset:2304 sc1
  buffer_load_dwordx4 a[156:159], v3, s[4:7], s23 offen offset:1024 sc1
  buffer_load_dwordx2 a[188:189], v93, s[4:7], s61 offen offset:2560 sc1
  buffer_load_dwordx4 a[160:163], v3, s[4:7], s23 offen offset:2048 sc1
  buffer_load_dwordx2 a[190:191], v93, s[4:7], s61 offen offset:2816 sc1
  buffer_load_dwordx4 a[164:167], v3, s[4:7], s23 offen offset:3072 sc1
  s_waitcnt lgkmcnt(0)
  s_waitcnt vmcnt(8)
  v_mfma_f32_16x16x16_bf16 v[156:159], a[180:181], v[72:73], 0
  v_mfma_f32_16x16x16_bf16 v[160:163], a[180:181], v[76:77], 0
  v_mfma_f32_16x16x16_bf16 v[156:159], a[144:145], v[74:75], v[156:159]
  v_mfma_f32_16x16x32_bf16 v[160:163], a[144:147], v[78:81], v[160:163]
  v_mfma_f32_16x16x16_bf16 v[164:167], a[182:183], v[72:73], 0
  v_mfma_f32_16x16x16_bf16 v[168:171], a[182:183], v[76:77], 0
  v_mfma_f32_16x16x16_bf16 v[164:167], a[148:149], v[74:75], v[164:167]
  v_mfma_f32_16x16x32_bf16 v[168:171], a[148:151], v[78:81], v[168:171]
  s_nop 2
  v_mul_f32 v156, v156, v82
  v_mul_f32 v157, v157, v82
  v_mul_f32 v158, v158, v82
  v_mul_f32 v159, v159, v82
  v_cvt_pk_bf16_f32 v172, v156, v157
  v_cvt_pk_bf16_f32 v173, v158, v159
  v_mul_f32 v164, v164, v82
  v_mul_f32 v165, v165, v82
  v_mul_f32 v166, v166, v82
  v_mul_f32 v167, v167, v82
  v_cvt_pk_bf16_f32 v174, v164, v165
  v_cvt_pk_bf16_f32 v175, v166, v167
  buffer_store_dwordx4 v[172:175], v1, s[4:7], s60 offen offset:3072
  v_mul_f32 v160, v160, v83
  v_mul_f32 v161, v161, v83
  v_mul_f32 v162, v162, v83
  v_mul_f32 v163, v163, v83
  v_cvt_pk_bf16_f32 v176, v160, v161
  v_cvt_pk_bf16_f32 v177, v162, v163
  v_mul_f32 v168, v168, v83
  v_mul_f32 v169, v169, v83
  v_mul_f32 v170, v170, v83
  v_mul_f32 v171, v171, v83
  v_cvt_pk_bf16_f32 v178, v168, v169
  v_cvt_pk_bf16_f32 v179, v170, v171
  s_add_u32 s34, s60, 196608
  buffer_store_dwordx4 v[176:179], v1, s[4:7], s34 offen offset:3072
  s_waitcnt vmcnt(6)
  v_mfma_f32_16x16x16_bf16 v[156:159], a[184:185], v[72:73], 0
  v_mfma_f32_16x16x16_bf16 v[160:163], a[184:185], v[76:77], 0
  v_mfma_f32_16x16x16_bf16 v[156:159], a[152:153], v[74:75], v[156:159]
  v_mfma_f32_16x16x32_bf16 v[160:163], a[152:155], v[78:81], v[160:163]
  v_mfma_f32_16x16x16_bf16 v[164:167], a[186:187], v[72:73], 0
  v_mfma_f32_16x16x16_bf16 v[168:171], a[186:187], v[76:77], 0
  v_mfma_f32_16x16x16_bf16 v[164:167], a[156:157], v[74:75], v[164:167]
  v_mfma_f32_16x16x32_bf16 v[168:171], a[156:159], v[78:81], v[168:171]
  s_nop 2
  v_mul_f32 v156, v156, v82
  v_mul_f32 v157, v157, v82
  v_mul_f32 v158, v158, v82
  v_mul_f32 v159, v159, v82
  v_cvt_pk_bf16_f32 v172, v156, v157
  v_cvt_pk_bf16_f32 v173, v158, v159
  v_mul_f32 v164, v164, v82
  v_mul_f32 v165, v165, v82
  v_mul_f32 v166, v166, v82
  v_mul_f32 v167, v167, v82
  v_cvt_pk_bf16_f32 v174, v164, v165
  v_cvt_pk_bf16_f32 v175, v166, v167
  buffer_store_dwordx4 v[172:175], v2, s[4:7], s60 offen offset:0
  v_mul_f32 v160, v160, v83
  v_mul_f32 v161, v161, v83
  v_mul_f32 v162, v162, v83
  v_mul_f32 v163, v163, v83
  v_cvt_pk_bf16_f32 v176, v160, v161
  v_cvt_pk_bf16_f32 v177, v162, v163
  v_mul_f32 v168, v168, v83
  v_mul_f32 v169, v169, v83
  v_mul_f32 v170, v170, v83
  v_mul_f32 v171, v171, v83
  v_cvt_pk_bf16_f32 v178, v168, v169
  v_cvt_pk_bf16_f32 v179, v170, v171
  s_add_u32 s34, s60, 196608
  buffer_store_dwordx4 v[176:179], v2, s[4:7], s34 offen offset:0
  s_waitcnt vmcnt(4)
  v_mfma_f32_16x16x16_bf16 v[156:159], a[188:189], v[72:73], 0
  v_mfma_f32_16x16x16_bf16 v[160:163], a[188:189], v[76:77], 0
  v_mfma_f32_16x16x16_bf16 v[156:159], a[160:161], v[74:75], v[156:159]
  v_mfma_f32_16x16x32_bf16 v[160:163], a[160:163], v[78:81], v[160:163]
  v_mfma_f32_16x16x16_bf16 v[164:167], a[190:191], v[72:73], 0
  v_mfma_f32_16x16x16_bf16 v[168:171], a[190:191], v[76:77], 0
  v_mfma_f32_16x16x16_bf16 v[164:167], a[164:165], v[74:75], v[164:167]
  v_mfma_f32_16x16x32_bf16 v[168:171], a[164:167], v[78:81], v[168:171]
  s_nop 2
  v_mul_f32 v156, v156, v82
  v_mul_f32 v157, v157, v82
  v_mul_f32 v158, v158, v82
  v_mul_f32 v159, v159, v82
  v_cvt_pk_bf16_f32 v172, v156, v157
  v_cvt_pk_bf16_f32 v173, v158, v159
  v_mul_f32 v164, v164, v82
  v_mul_f32 v165, v165, v82
  v_mul_f32 v166, v166, v82
  v_mul_f32 v167, v167, v82
  v_cvt_pk_bf16_f32 v174, v164, v165
  v_cvt_pk_bf16_f32 v175, v166, v167
  buffer_store_dwordx4 v[172:175], v2, s[4:7], s60 offen offset:1024
  v_mul_f32 v160, v160, v83
  v_mul_f32 v161, v161, v83
  v_mul_f32 v162, v162, v83
  v_mul_f32 v163, v163, v83
  v_cvt_pk_bf16_f32 v176, v160, v161
  v_cvt_pk_bf16_f32 v177, v162, v163
  v_mul_f32 v168, v168, v83
  v_mul_f32 v169, v169, v83
  v_mul_f32 v170, v170, v83
  v_mul_f32 v171, v171, v83
  v_cvt_pk_bf16_f32 v178, v168, v169
  v_cvt_pk_bf16_f32 v179, v170, v171
  s_add_u32 s34, s60, 196608
  buffer_store_dwordx4 v[176:179], v2, s[4:7], s34 offen offset:1024
  s_branch reca_b5101
  s_cmp_lg_u32 s12, 2
  s_cbranch_scc1 reca_b399
  buffer_store_dwordx2 v[52:53], v9, s[4:7], s30 offen
  buffer_store_dwordx2 v[32:33], v16, s[4:7], s26 offen
  s_cmp_lg_u32 s14, 0
  s_cbranch_scc1 reca_b399
  v_mov_b32 v28, s17
  s_lshl_b32 s34, s13, 7
  s_add_u32 s34, s34, 1507328
  buffer_store_dword v28, v19, s[4:7], s34 offen
  s_branch reca_b399
reca_last98:
  s_cmp_lg_u32 s12, 2
  s_cbranch_scc1 reca_exit1
  buffer_store_dwordx2 v[52:53], v9, s[4:7], s30 offen
  s_branch reca_exit1
reca_swave96:
  s_cmp_lg_u32 s17, 63
  s_cbranch_scc1 reca_vmst104
  s_barrier
  ds_read_b128 v[56:59], v1 offset:10240
  ds_read_b128 v[60:63], v1 offset:11264
  ds_read_b128 v[64:67], v1 offset:12288
  s_waitcnt lgkmcnt(0)
  v_add_f32 v56, v56, v64
  v_add_f32 v60, v60, v48
  v_add_f32 v57, v57, v65
  v_add_f32 v61, v61, v49
  v_add_f32 v58, v58, v66
  v_add_f32 v62, v62, v50
  v_add_f32 v59, v59, v67
  v_add_f32 v63, v63, v51
  v_cvt_pk_bf16_f32 v68, v56, v57
  v_cvt_pk_bf16_f32 v69, v58, v59
  v_cvt_pk_bf16_f32 v70, v60, v61
  v_cvt_pk_bf16_f32 v71, v62, v63
  buffer_store_dwordx2 v[52:53], v9, s[4:7], s30 offen
  buffer_store_dwordx2 v[68:69], v10, s[4:7], s31 offen
  buffer_store_dwordx2 v[70:71], v10, s[4:7], s31 offen offset:256
  s_branch reca_exit1
reca_vmst104:
  s_sleep 1
  buffer_load_dwordx4 v[208:211], v1, s[4:7], s21 offen offset:0 sc1
  buffer_load_dwordx4 v[212:215], v1, s[4:7], s21 offen offset:1024 sc1
  buffer_load_dwordx4 v[216:219], v1, s[4:7], s21 offen offset:2048 sc1
  buffer_load_dwordx4 v[220:223], v1, s[4:7], s21 offen offset:3072 sc1
  buffer_load_dwordx4 v[224:227], v2, s[4:7], s21 offen offset:0 sc1
  buffer_load_dwordx4 v[228:231], v2, s[4:7], s21 offen offset:1024 sc1
  s_waitcnt vmcnt(5)
  v_max_u32 v29, v208, v210
  v_cmp_eq_u32 vcc, -1, v29
  s_cbranch_vccnz reca_retry105
reca_resume106:
  s_waitcnt vmcnt(4)
  v_max_u32 v29, v212, v214
  v_cmp_eq_u32 vcc, -1, v29
  v_mfma_f32_16x16x32_bf16 v[76:79], a[120:123], v[208:211], 0
  v_mfma_f32_16x16x32_bf16 v[80:83], a[144:147], v[208:211], 0
  v_mfma_f32_16x16x32_bf16 v[72:75], v[208:211], v[208:211], v[40:43]
  s_cbranch_vccnz reca_retry107
reca_resume108:
  s_waitcnt vmcnt(3)
  v_max_u32 v29, v216, v218
  v_cmp_eq_u32 vcc, -1, v29
  v_mfma_f32_16x16x32_bf16 v[76:79], a[124:127], v[212:215], v[76:79]
  v_mfma_f32_16x16x32_bf16 v[80:83], a[148:151], v[212:215], v[80:83]
  v_mfma_f32_16x16x32_bf16 v[72:75], v[212:215], v[212:215], v[72:75]
  s_cbranch_vccnz reca_retry109
reca_resume110:
  s_waitcnt vmcnt(2)
  v_max_u32 v29, v220, v222
  v_cmp_eq_u32 vcc, -1, v29
  v_mfma_f32_16x16x32_bf16 v[76:79], a[128:131], v[216:219], v[76:79]
  v_mfma_f32_16x16x32_bf16 v[80:83], a[152:155], v[216:219], v[80:83]
  v_mfma_f32_16x16x32_bf16 v[72:75], v[216:219], v[216:219], v[72:75]
  s_cbranch_vccnz reca_retry111
reca_resume112:
  s_waitcnt vmcnt(1)
  v_max_u32 v29, v224, v226
  v_cmp_eq_u32 vcc, -1, v29
  v_mfma_f32_16x16x32_bf16 v[76:79], a[132:135], v[220:223], v[76:79]
  v_mfma_f32_16x16x32_bf16 v[80:83], a[156:159], v[220:223], v[80:83]
  v_mfma_f32_16x16x32_bf16 v[72:75], v[220:223], v[220:223], v[72:75]
  s_cbranch_vccnz reca_retry113
reca_resume114:
  s_waitcnt vmcnt(0)
  v_max_u32 v29, v228, v230
  v_cmp_eq_u32 vcc, -1, v29
  v_mfma_f32_16x16x32_bf16 v[76:79], a[136:139], v[224:227], v[76:79]
  v_mfma_f32_16x16x32_bf16 v[80:83], a[160:163], v[224:227], v[80:83]
  v_mfma_f32_16x16x32_bf16 v[72:75], v[224:227], v[224:227], v[72:75]
  s_cbranch_vccnz reca_retry115
reca_resume116:
  v_mfma_f32_16x16x32_bf16 v[76:79], a[140:143], v[228:231], v[76:79]
  v_mfma_f32_16x16x32_bf16 v[80:83], a[164:167], v[228:231], v[80:83]
  v_mfma_f32_16x16x32_bf16 v[72:75], v[228:231], v[228:231], v[72:75]
  s_barrier
  ds_read_b128 v[56:59], v1 offset:10240
  ds_read_b128 v[60:63], v1 offset:11264
  ds_read_b128 v[64:67], v1 offset:12288
  s_nop 1
  v_max3_f32 v28, v76, v77, v78
  v_max3_f32 v29, v80, v81, v82
  v_max3_f32 v28, v28, v79, v83
  v_max3_f32 v29, v29, v72, v73
  v_max3_f32 v28, v28, v74, v75
  v_max_f32 v28, v28, v29
  v_mov_b32 v29, v28
  s_nop 1
  v_permlane32_swap_b32 v28, v29
  v_max_f32 v28, v28, v29
  v_mov_b32 v29, v28
  s_nop 1
  v_permlane16_swap_b32 v28, v29
  v_max_f32 v28, v28, v29
  v_mul_f32 v28, s41, v28
  v_fma_f32 v76, v76, s41, -v28
  v_fma_f32 v77, v77, s41, -v28
  v_fma_f32 v78, v78, s41, -v28
  v_fma_f32 v79, v79, s41, -v28
  v_fma_f32 v80, v80, s41, -v28
  v_fma_f32 v81, v81, s41, -v28
  v_fma_f32 v82, v82, s41, -v28
  v_fma_f32 v83, v83, s41, -v28
  v_fma_f32 v72, v72, s41, -v28
  v_fma_f32 v73, v73, s41, -v28
  v_fma_f32 v74, v74, s41, -v28
  v_fma_f32 v75, v75, s41, -v28
  v_exp_f32 v76, v76
  v_exp_f32 v77, v77
  v_exp_f32 v78, v78
  v_exp_f32 v79, v79
  v_exp_f32 v80, v80
  v_exp_f32 v81, v81
  v_exp_f32 v82, v82
  v_exp_f32 v83, v83
  v_cvt_pk_bf16_f32 v84, v76, v77
  v_cvt_pk_bf16_f32 v85, v78, v79
  v_cvt_pk_bf16_f32 v86, v80, v81
  v_cvt_pk_bf16_f32 v87, v82, v83
  v_exp_f32 v72, v72
  v_exp_f32 v73, v73
  v_mfma_f32_16x16x32_bf16 v[100:103], v[36:39], v[84:87], 0
  v_exp_f32 v74, v74
  v_exp_f32 v75, v75
  v_mfma_f32_16x16x32_bf16 v[92:95], a[168:171], v[84:87], 0
  v_cvt_pk_bf16_f32 v88, v72, v73
  v_cvt_pk_bf16_f32 v89, v74, v75
  v_mfma_f32_16x16x32_bf16 v[96:99], a[172:175], v[84:87], 0
  s_waitcnt lgkmcnt(0)
  v_mfma_f32_16x16x16_bf16 v[100:103], v[36:37], v[88:89], v[100:103]
  v_add_f32 v56, v56, v64
  v_add_f32 v60, v60, v48
  v_add_f32 v57, v57, v65
  v_add_f32 v61, v61, v49
  v_add_f32 v58, v58, v66
  v_add_f32 v62, v62, v50
  v_add_f32 v59, v59, v67
  v_add_f32 v63, v63, v51
  v_cvt_pk_bf16_f32 v68, v56, v57
  v_cvt_pk_bf16_f32 v69, v58, v59
  v_cvt_pk_bf16_f32 v70, v60, v61
  v_cvt_pk_bf16_f32 v71, v62, v63
  v_mfma_f32_16x16x16_bf16 v[92:95], v[68:69], v[88:89], v[92:95]
  v_rcp_f32 v28, v100
  v_mfma_f32_16x16x16_bf16 v[96:99], v[70:71], v[88:89], v[96:99]
  v_mov_b32 v29, v28
  s_nop 4
  v_pk_mul_f32 v[92:93], v[92:93], v[28:29]
  v_pk_mul_f32 v[94:95], v[94:95], v[28:29]
  v_pk_mul_f32 v[96:97], v[96:97], v[28:29]
  v_pk_mul_f32 v[98:99], v[98:99], v[28:29]
  v_cvt_pk_bf16_f32 v104, v92, v93
  v_cvt_pk_bf16_f32 v105, v94, v95
  v_cvt_pk_bf16_f32 v106, v96, v97
  v_cvt_pk_bf16_f32 v107, v98, v99
  buffer_store_dwordx4 v[104:107], v11, s[4:7], s22 offen
  s_barrier
  s_add_u32 s34, s17, 2
  s_and_b32 s34, s34, 3
  s_mul_i32 s26, s34, 10240
  s_add_u32 s26, s26, s38
  s_mul_i32 s27, s34, 6144
  s_add_u32 s27, s27, s39
  s_mul_i32 s28, s34, 12288
  s_add_u32 s28, s28, s40
  s_mul_i32 s29, s34, 393216
  s_add_u32 s29, s29, s56
  buffer_store_dwordx2 v[32:33], v8, s[4:7], s27 offen
  buffer_store_dwordx4 v[32:35], v11, s[4:7], s28 offen
  s_add_u32 s36, s17, 1
  s_cmp_ge_u32 s36, 63
  s_cbranch_scc1 reca_nopf117
  s_add_u32 s37, s36, 1
reca_pf118:
  buffer_load_dword v28, v233, s[4:7], 0 offen sc1
  s_waitcnt vmcnt(0)
  v_cmp_gt_i32 vcc, s37, v28
  s_cbranch_vccz reca_pfok119
  s_sleep 1
  s_sub_u32 s18, s18, 1
  s_cbranch_scc0 reca_pf118
  s_mov_b32 s18, 0
reca_pfok119:
  s_lshl_b32 s34, s15, 6
  s_add_u32 s34, s34, s36
  s_mul_i32 s34, s34, 12288
  s_add_u32 s32, s34, 37748736
  s_lshl_b32 s35, s16, 11
  s_add_u32 s34, s34, s35
  s_add_u32 s33, s34, 62914560
  buffer_load_dwordx4 a[120:123], v1, s[4:7], s32 offen offset:0 sc1
  buffer_load_dwordx4 a[124:127], v1, s[4:7], s32 offen offset:1024 sc1
  buffer_load_dwordx4 a[128:131], v1, s[4:7], s32 offen offset:2048 sc1
  buffer_load_dwordx4 a[132:135], v1, s[4:7], s32 offen offset:3072 sc1
  buffer_load_dwordx4 a[136:139], v2, s[4:7], s32 offen offset:0 sc1
  buffer_load_dwordx4 a[140:143], v2, s[4:7], s32 offen offset:1024 sc1
  buffer_load_dwordx4 a[144:147], v2, s[4:7], s32 offen offset:2048 sc1
  buffer_load_dwordx4 a[148:151], v2, s[4:7], s32 offen offset:3072 sc1
  buffer_load_dwordx4 a[152:155], v3, s[4:7], s32 offen offset:0 sc1
  buffer_load_dwordx4 a[156:159], v3, s[4:7], s32 offen offset:1024 sc1
  buffer_load_dwordx4 a[160:163], v3, s[4:7], s32 offen offset:2048 sc1
  buffer_load_dwordx4 a[164:167], v3, s[4:7], s32 offen offset:3072 sc1
  buffer_load_dwordx4 a[168:171], v1, s[4:7], s33 offen offset:0 sc1
  buffer_load_dwordx4 a[172:175], v1, s[4:7], s33 offen offset:1024 sc1
reca_nopf117:
  buffer_store_dwordx2 v[52:53], v9, s[4:7], s30 offen
  buffer_store_dwordx2 v[68:69], v10, s[4:7], s31 offen
  buffer_store_dwordx2 v[70:71], v10, s[4:7], s31 offen offset:256
reca_b5101:
  s_barrier
  s_add_u32 s17, s17, 1
  s_branch reca_step87
reca_b399:
  s_endpgm
reca_retry90:
  s_sub_u32 s18, s18, 1
  s_cbranch_scc1 reca_retry90_to
  buffer_load_dwordx4 v[128:131], v4, s[4:7], s20 offen sc1
  buffer_load_dwordx4 v[132:135], v4, s[4:7], s20 offen offset:1024 sc1
  buffer_load_dwordx4 v[136:139], v5, s[4:7], s20 offen sc1
  s_waitcnt vmcnt(2)
  v_max_u32 v29, v128, v130
  v_cmp_eq_u32 vcc, -1, v29
  s_cbranch_vccnz reca_retry90
  s_branch reca_resume91
reca_retry90_to:
  s_mov_b32 s18, 0
  s_waitcnt vmcnt(0)
  s_branch reca_resume91
reca_retry92:
  s_sub_u32 s18, s18, 1
  s_cbranch_scc1 reca_retry92_to
  buffer_load_dwordx4 v[132:135], v4, s[4:7], s20 offen offset:1024 sc1
  buffer_load_dwordx4 v[136:139], v5, s[4:7], s20 offen sc1
  s_waitcnt vmcnt(1)
  v_max_u32 v29, v132, v134
  v_cmp_eq_u32 vcc, -1, v29
  s_cbranch_vccnz reca_retry92
  s_branch reca_resume93
reca_retry92_to:
  s_mov_b32 s18, 0
  s_waitcnt vmcnt(0)
  s_branch reca_resume93
reca_retry94:
  s_sub_u32 s18, s18, 1
  s_cbranch_scc1 reca_retry94_to
  buffer_load_dwordx4 v[136:139], v5, s[4:7], s20 offen sc1
  s_waitcnt vmcnt(0)
  v_max_u32 v29, v136, v138
  v_cmp_eq_u32 vcc, -1, v29
  s_cbranch_vccnz reca_retry94
  s_branch reca_resume95
reca_retry94_to:
  s_mov_b32 s18, 0
  s_waitcnt vmcnt(0)
  s_branch reca_resume95
reca_retry105:
  s_sub_u32 s18, s18, 1
  s_cbranch_scc1 reca_retry105_to
  buffer_load_dwordx4 v[208:211], v1, s[4:7], s21 offen offset:0 sc1
  buffer_load_dwordx4 v[212:215], v1, s[4:7], s21 offen offset:1024 sc1
  buffer_load_dwordx4 v[216:219], v1, s[4:7], s21 offen offset:2048 sc1
  buffer_load_dwordx4 v[220:223], v1, s[4:7], s21 offen offset:3072 sc1
  buffer_load_dwordx4 v[224:227], v2, s[4:7], s21 offen offset:0 sc1
  buffer_load_dwordx4 v[228:231], v2, s[4:7], s21 offen offset:1024 sc1
  s_waitcnt vmcnt(5)
  v_max_u32 v29, v208, v210
  v_cmp_eq_u32 vcc, -1, v29
  s_cbranch_vccnz reca_retry105
  s_branch reca_resume106
reca_retry105_to:
  s_mov_b32 s18, 0
  s_waitcnt vmcnt(0)
  s_branch reca_resume106
reca_retry107:
  s_sub_u32 s18, s18, 1
  s_cbranch_scc1 reca_retry107_to
  buffer_load_dwordx4 v[212:215], v1, s[4:7], s21 offen offset:1024 sc1
  buffer_load_dwordx4 v[216:219], v1, s[4:7], s21 offen offset:2048 sc1
  buffer_load_dwordx4 v[220:223], v1, s[4:7], s21 offen offset:3072 sc1
  buffer_load_dwordx4 v[224:227], v2, s[4:7], s21 offen offset:0 sc1
  buffer_load_dwordx4 v[228:231], v2, s[4:7], s21 offen offset:1024 sc1
  s_waitcnt vmcnt(4)
  v_max_u32 v29, v212, v214
  v_cmp_eq_u32 vcc, -1, v29
  s_cbranch_vccnz reca_retry107
  s_branch reca_resume108
reca_retry107_to:
  s_mov_b32 s18, 0
  s_waitcnt vmcnt(0)
  s_branch reca_resume108
reca_retry109:
  s_sub_u32 s18, s18, 1
  s_cbranch_scc1 reca_retry109_to
  buffer_load_dwordx4 v[216:219], v1, s[4:7], s21 offen offset:2048 sc1
  buffer_load_dwordx4 v[220:223], v1, s[4:7], s21 offen offset:3072 sc1
  buffer_load_dwordx4 v[224:227], v2, s[4:7], s21 offen offset:0 sc1
  buffer_load_dwordx4 v[228:231], v2, s[4:7], s21 offen offset:1024 sc1
  s_waitcnt vmcnt(3)
  v_max_u32 v29, v216, v218
  v_cmp_eq_u32 vcc, -1, v29
  s_cbranch_vccnz reca_retry109
  s_branch reca_resume110
reca_retry109_to:
  s_mov_b32 s18, 0
  s_waitcnt vmcnt(0)
  s_branch reca_resume110
reca_retry111:
  s_sub_u32 s18, s18, 1
  s_cbranch_scc1 reca_retry111_to
  buffer_load_dwordx4 v[220:223], v1, s[4:7], s21 offen offset:3072 sc1
  buffer_load_dwordx4 v[224:227], v2, s[4:7], s21 offen offset:0 sc1
  buffer_load_dwordx4 v[228:231], v2, s[4:7], s21 offen offset:1024 sc1
  s_waitcnt vmcnt(2)
  v_max_u32 v29, v220, v222
  v_cmp_eq_u32 vcc, -1, v29
  s_cbranch_vccnz reca_retry111
  s_branch reca_resume112
reca_retry111_to:
  s_mov_b32 s18, 0
  s_waitcnt vmcnt(0)
  s_branch reca_resume112
reca_retry113:
  s_sub_u32 s18, s18, 1
  s_cbranch_scc1 reca_retry113_to
  buffer_load_dwordx4 v[224:227], v2, s[4:7], s21 offen offset:0 sc1
  buffer_load_dwordx4 v[228:231], v2, s[4:7], s21 offen offset:1024 sc1
  s_waitcnt vmcnt(1)
  v_max_u32 v29, v224, v226
  v_cmp_eq_u32 vcc, -1, v29
  s_cbranch_vccnz reca_retry113
  s_branch reca_resume114
reca_retry113_to:
  s_mov_b32 s18, 0
  s_waitcnt vmcnt(0)
  s_branch reca_resume114
reca_retry115:
  s_sub_u32 s18, s18, 1
  s_cbranch_scc1 reca_retry115_to
  buffer_load_dwordx4 v[228:231], v2, s[4:7], s21 offen offset:1024 sc1
  s_waitcnt vmcnt(0)
  v_max_u32 v29, v228, v230
  v_cmp_eq_u32 vcc, -1, v29
  s_cbranch_vccnz reca_retry115
  s_branch reca_resume116
reca_retry115_to:
  s_mov_b32 s18, 0
  s_waitcnt vmcnt(0)
  s_branch reca_resume116
reca_slow11:
  s_cmp_ge_u32 s14, 20
  s_cbranch_scc1 reca_twins13
  s_branch reca_gotmem121
reca_step120:
  s_and_b32 s34, s17, 3
  s_mul_i32 s20, s34, 10240
  s_add_u32 s20, s20, s38
  s_sleep 2
  buffer_load_dwordx4 v[128:131], v4, s[4:7], s20 offen sc1
  buffer_load_dwordx4 v[132:135], v4, s[4:7], s20 offen offset:1024 sc1
  buffer_load_dwordx4 v[136:139], v5, s[4:7], s20 offen sc1
  s_waitcnt vmcnt(2)
  v_max_u32 v29, v128, v130
  v_cmp_eq_u32 vcc, -1, v29
  s_cbranch_vccnz reca_retry123
reca_resume124:
  s_waitcnt vmcnt(1)
  v_max_u32 v29, v132, v134
  v_cmp_eq_u32 vcc, -1, v29
  ds_write_b128 v4, v[128:131]
  s_cbranch_vccnz reca_retry125
reca_resume126:
  s_waitcnt vmcnt(0)
  v_max_u32 v29, v136, v138
  v_cmp_eq_u32 vcc, -1, v29
  ds_write_b128 v4, v[132:135] offset:1024
  s_cbranch_vccnz reca_retry127
reca_resume128:
  ds_write_b128 v5, v[136:139]
  s_branch reca_gotmem2122
reca_gotmem121:
  ds_write_b128 v4, v[128:131]
  ds_write_b128 v4, v[132:135] offset:1024
  ds_write_b128 v5, v[136:139]
reca_gotmem2122:
  s_and_b32 s34, s17, 3
  s_mul_i32 s21, s34, 6144
  s_add_u32 s21, s21, s39
  s_mul_i32 s22, s34, 12288
  s_add_u32 s22, s22, s40
  s_mul_i32 s25, s34, 393216
  s_add_u32 s25, s25, s56
  s_add_u32 s35, s17, 1
  s_and_b32 s35, s35, 3
  s_mul_i32 s24, s35, 10240
  s_add_u32 s24, s24, s38
  s_waitcnt lgkmcnt(0)
  s_barrier
  ds_read_b128 v[128:131], v236 offset:0
  ds_read_b128 v[132:135], v236 offset:1024
  ds_read_b128 v[136:139], v236 offset:2048
  ds_read_b128 v[140:143], v236 offset:3072
  ds_read_b128 v[144:147], v236 offset:4096
  ds_read_b128 v[148:151], v237 offset:0
  ds_read_b128 v[152:155], v237 offset:1024
  ds_read_b128 v[156:159], v237 offset:2048
  ds_read_b128 v[160:163], v237 offset:3072
  ds_read_b128 v[164:167], v237 offset:4096
  s_waitcnt lgkmcnt(9)
  v_mfma_f32_16x16x32_bf16 v[44:47], a[0:3], v[128:131], 0
  ds_read_b128 v[168:171], v6 offset:0
  v_mfma_f32_16x16x32_bf16 v[240:243], a[4:7], v[128:131], 0
  s_waitcnt lgkmcnt(9)
  v_mfma_f32_16x16x32_bf16 v[44:47], a[8:11], v[132:135], v[44:47]
  ds_read_b128 v[172:175], v6 offset:512
  v_mfma_f32_16x16x32_bf16 v[240:243], a[12:15], v[132:135], v[240:243]
  s_waitcnt lgkmcnt(9)
  v_mfma_f32_16x16x32_bf16 v[44:47], a[16:19], v[136:139], v[44:47]
  ds_read_b128 v[176:179], v6 offset:1024
  v_mfma_f32_16x16x32_bf16 v[240:243], a[20:23], v[136:139], v[240:243]
  s_waitcnt lgkmcnt(9)
  v_mfma_f32_16x16x32_bf16 v[44:47], a[24:27], v[140:143], v[44:47]
  ds_read_b128 v[180:183], v6 offset:1536
  v_mfma_f32_16x16x32_bf16 v[240:243], a[28:31], v[140:143], v[240:243]
  s_waitcnt lgkmcnt(9)
  v_mfma_f32_16x16x32_bf16 v[44:47], a[32:35], v[144:147], v[44:47]
  ds_read_b128 v[184:187], v6 offset:2048
  v_mfma_f32_16x16x32_bf16 v[240:243], a[36:39], v[144:147], v[240:243]
  s_waitcnt lgkmcnt(9)
  v_mfma_f32_16x16x32_bf16 v[44:47], a[40:43], v[148:151], v[44:47]
  ds_read_b128 v[188:191], v6 offset:2560
  v_mfma_f32_16x16x32_bf16 v[240:243], a[44:47], v[148:151], v[240:243]
  s_waitcnt lgkmcnt(9)
  v_mfma_f32_16x16x32_bf16 v[44:47], a[48:51], v[152:155], v[44:47]
  ds_read_b128 v[192:195], v6 offset:3072
  v_mfma_f32_16x16x32_bf16 v[240:243], a[52:55], v[152:155], v[240:243]
  s_waitcnt lgkmcnt(9)
  v_mfma_f32_16x16x32_bf16 v[44:47], a[56:59], v[156:159], v[44:47]
  ds_read_b128 v[196:199], v6 offset:3584
  v_mfma_f32_16x16x32_bf16 v[240:243], a[60:63], v[156:159], v[240:243]
  s_waitcnt lgkmcnt(9)
  v_mfma_f32_16x16x32_bf16 v[44:47], a[64:67], v[160:163], v[44:47]
  ds_read_b128 v[200:203], v6 offset:4096
  v_mfma_f32_16x16x32_bf16 v[240:243], a[68:71], v[160:163], v[240:243]
  s_waitcnt lgkmcnt(9)
  v_mfma_f32_16x16x32_bf16 v[44:47], a[72:75], v[164:167], v[44:47]
  ds_read_b128 v[204:207], v6 offset:4608
  v_mfma_f32_16x16x32_bf16 v[240:243], a[76:79], v[164:167], v[240:243]
  s_waitcnt lgkmcnt(9)
  v_mfma_f32_16x16x32_bf16 v[48:51], v[168:171], a[80:83], 0
  s_lshl_b32 s34, s17, 5
  s_add_u32 s34, s34, s15
  s_mul_i32 s34, s34, 3072
  s_lshl_b32 s35, s16, 9
  s_add_u32 s34, s34, s35
  s_add_u32 s30, s34, 113246208
  s_add_u32 s31, s34, 119537664
  v_add_f32_dpp v44, v240, v44 row_ror:8 row_mask:0xf bank_mask:0xf
  v_add_f32_dpp v45, v241, v45 row_ror:8 row_mask:0xf bank_mask:0xf
  v_add_f32_dpp v46, v242, v46 row_ror:8 row_mask:0xf bank_mask:0xf
  v_add_f32_dpp v47, v243, v47 row_ror:8 row_mask:0xf bank_mask:0xf
  v_cvt_pk_bf16_f32 v52, v44, v45
  v_cvt_pk_bf16_f32 v53, v46, v47
  buffer_store_dwordx2 v[52:53], v8, s[4:7], s21 offen sc1
  s_waitcnt lgkmcnt(8)
  v_mfma_f32_16x16x32_bf16 v[48:51], v[172:175], a[84:87], v[48:51]
  s_waitcnt lgkmcnt(7)
  v_mfma_f32_16x16x32_bf16 v[48:51], v[176:179], a[88:91], v[48:51]
  s_waitcnt lgkmcnt(6)
  v_mfma_f32_16x16x32_bf16 v[48:51], v[180:183], a[92:95], v[48:51]
  s_waitcnt lgkmcnt(5)
  v_mfma_f32_16x16x32_bf16 v[48:51], v[184:187], a[96:99], v[48:51]
  s_waitcnt lgkmcnt(4)
  v_mfma_f32_16x16x32_bf16 v[48:51], v[188:191], a[100:103], v[48:51]
  s_waitcnt lgkmcnt(3)
  v_mfma_f32_16x16x32_bf16 v[48:51], v[192:195], a[104:107], v[48:51]
  s_waitcnt lgkmcnt(2)
  v_mfma_f32_16x16x32_bf16 v[48:51], v[196:199], a[108:111], v[48:51]
  s_waitcnt lgkmcnt(1)
  v_mfma_f32_16x16x32_bf16 v[48:51], v[200:203], a[112:115], v[48:51]
  s_waitcnt lgkmcnt(0)
  v_mfma_f32_16x16x32_bf16 v[48:51], v[204:207], a[116:119], v[48:51]
  s_cmp_eq_u32 s12, 3
  s_cbranch_scc1 reca_swave129
  s_nop 5
  ds_write_b128 v17, v[48:51]
  s_add_u32 s34, s17, 2
  s_and_b32 s34, s34, 3
  s_mul_i32 s26, s34, 10240
  s_add_u32 s26, s26, s38
  s_mul_i32 s27, s34, 6144
  s_add_u32 s27, s27, s39
  s_mul_i32 s28, s34, 12288
  s_add_u32 s28, s28, s40
  s_mul_i32 s29, s34, 393216
  s_add_u32 s29, s29, s56
  s_waitcnt lgkmcnt(0)
  s_barrier
  s_cmp_eq_u32 s17, 63
  s_cbranch_scc1 reca_last131
  buffer_store_dwordx2 v[32:33], v8, s[4:7], s27 offen sc1
  s_cmp_lg_u32 s12, 2
  s_cbranch_scc1 reca_b3132
  buffer_store_dwordx2 v[52:53], v9, s[4:7], s30 offen sc1
  buffer_store_dwordx2 v[32:33], v16, s[4:7], s26 offen sc1
  s_cmp_lg_u32 s14, 0
  s_cbranch_scc1 reca_b3132
  v_mov_b32 v28, s17
  s_lshl_b32 s34, s13, 7
  s_add_u32 s34, s34, 1507328
  buffer_store_dword v28, v19, s[4:7], s34 offen sc1
  s_branch reca_b3132
reca_last131:
  s_cmp_lg_u32 s12, 2
  s_cbranch_scc1 reca_exit1
  buffer_store_dwordx2 v[52:53], v9, s[4:7], s30 offen
  s_branch reca_exit1
reca_swave129:
  s_cmp_lg_u32 s17, 63
  s_cbranch_scc1 reca_vmst135
  s_barrier
  ds_read_b128 v[56:59], v1 offset:10240
  ds_read_b128 v[60:63], v1 offset:11264
  ds_read_b128 v[64:67], v1 offset:12288
  s_waitcnt lgkmcnt(0)
  v_add_f32 v56, v56, v64
  v_add_f32 v60, v60, v48
  v_add_f32 v57, v57, v65
  v_add_f32 v61, v61, v49
  v_add_f32 v58, v58, v66
  v_add_f32 v62, v62, v50
  v_add_f32 v59, v59, v67
  v_add_f32 v63, v63, v51
  v_cvt_pk_bf16_f32 v68, v56, v57
  v_cvt_pk_bf16_f32 v69, v58, v59
  v_cvt_pk_bf16_f32 v70, v60, v61
  v_cvt_pk_bf16_f32 v71, v62, v63
  buffer_store_dwordx2 v[52:53], v9, s[4:7], s30 offen
  buffer_store_dwordx2 v[68:69], v10, s[4:7], s31 offen
  buffer_store_dwordx2 v[70:71], v10, s[4:7], s31 offen offset:256
  s_branch reca_exit1
reca_vmst135:
  s_sleep 1
  buffer_load_dwordx4 v[208:211], v1, s[4:7], s21 offen offset:0 sc1
  buffer_load_dwordx4 v[212:215], v1, s[4:7], s21 offen offset:1024 sc1
  buffer_load_dwordx4 v[216:219], v1, s[4:7], s21 offen offset:2048 sc1
  buffer_load_dwordx4 v[220:223], v1, s[4:7], s21 offen offset:3072 sc1
  buffer_load_dwordx4 v[224:227], v2, s[4:7], s21 offen offset:0 sc1
  buffer_load_dwordx4 v[228:231], v2, s[4:7], s21 offen offset:1024 sc1
  s_waitcnt vmcnt(5)
  v_max_u32 v29, v208, v210
  v_cmp_eq_u32 vcc, -1, v29
  s_cbranch_vccnz reca_retry136
reca_resume137:
  s_waitcnt vmcnt(4)
  v_max_u32 v29, v212, v214
  v_cmp_eq_u32 vcc, -1, v29
  v_mfma_f32_16x16x32_bf16 v[76:79], a[120:123], v[208:211], 0
  v_mfma_f32_16x16x32_bf16 v[80:83], a[144:147], v[208:211], 0
  v_mfma_f32_16x16x32_bf16 v[72:75], v[208:211], v[208:211], v[40:43]
  s_cbranch_vccnz reca_retry138
reca_resume139:
  s_waitcnt vmcnt(3)
  v_max_u32 v29, v216, v218
  v_cmp_eq_u32 vcc, -1, v29
  v_mfma_f32_16x16x32_bf16 v[76:79], a[124:127], v[212:215], v[76:79]
  v_mfma_f32_16x16x32_bf16 v[80:83], a[148:151], v[212:215], v[80:83]
  v_mfma_f32_16x16x32_bf16 v[72:75], v[212:215], v[212:215], v[72:75]
  s_cbranch_vccnz reca_retry140
reca_resume141:
  s_waitcnt vmcnt(2)
  v_max_u32 v29, v220, v222
  v_cmp_eq_u32 vcc, -1, v29
  v_mfma_f32_16x16x32_bf16 v[76:79], a[128:131], v[216:219], v[76:79]
  v_mfma_f32_16x16x32_bf16 v[80:83], a[152:155], v[216:219], v[80:83]
  v_mfma_f32_16x16x32_bf16 v[72:75], v[216:219], v[216:219], v[72:75]
  s_cbranch_vccnz reca_retry142
reca_resume143:
  s_waitcnt vmcnt(1)
  v_max_u32 v29, v224, v226
  v_cmp_eq_u32 vcc, -1, v29
  v_mfma_f32_16x16x32_bf16 v[76:79], a[132:135], v[220:223], v[76:79]
  v_mfma_f32_16x16x32_bf16 v[80:83], a[156:159], v[220:223], v[80:83]
  v_mfma_f32_16x16x32_bf16 v[72:75], v[220:223], v[220:223], v[72:75]
  s_cbranch_vccnz reca_retry144
reca_resume145:
  s_waitcnt vmcnt(0)
  v_max_u32 v29, v228, v230
  v_cmp_eq_u32 vcc, -1, v29
  v_mfma_f32_16x16x32_bf16 v[76:79], a[136:139], v[224:227], v[76:79]
  v_mfma_f32_16x16x32_bf16 v[80:83], a[160:163], v[224:227], v[80:83]
  v_mfma_f32_16x16x32_bf16 v[72:75], v[224:227], v[224:227], v[72:75]
  s_cbranch_vccnz reca_retry146
reca_resume147:
  v_mfma_f32_16x16x32_bf16 v[76:79], a[140:143], v[228:231], v[76:79]
  v_mfma_f32_16x16x32_bf16 v[80:83], a[164:167], v[228:231], v[80:83]
  v_mfma_f32_16x16x32_bf16 v[72:75], v[228:231], v[228:231], v[72:75]
  s_barrier
  ds_read_b128 v[56:59], v1 offset:10240
  ds_read_b128 v[60:63], v1 offset:11264
  ds_read_b128 v[64:67], v1 offset:12288
  s_nop 1
  v_max3_f32 v28, v76, v77, v78
  v_max3_f32 v29, v80, v81, v82
  v_max3_f32 v28, v28, v79, v83
  v_max3_f32 v29, v29, v72, v73
  v_max3_f32 v28, v28, v74, v75
  v_max_f32 v28, v28, v29
  v_mov_b32 v29, v28
  s_nop 1
  v_permlane32_swap_b32 v28, v29
  v_max_f32 v28, v28, v29
  v_mov_b32 v29, v28
  s_nop 1
  v_permlane16_swap_b32 v28, v29
  v_max_f32 v28, v28, v29
  v_mul_f32 v28, s41, v28
  v_fma_f32 v76, v76, s41, -v28
  v_fma_f32 v77, v77, s41, -v28
  v_fma_f32 v78, v78, s41, -v28
  v_fma_f32 v79, v79, s41, -v28
  v_fma_f32 v80, v80, s41, -v28
  v_fma_f32 v81, v81, s41, -v28
  v_fma_f32 v82, v82, s41, -v28
  v_fma_f32 v83, v83, s41, -v28
  v_fma_f32 v72, v72, s41, -v28
  v_fma_f32 v73, v73, s41, -v28
  v_fma_f32 v74, v74, s41, -v28
  v_fma_f32 v75, v75, s41, -v28
  v_exp_f32 v76, v76
  v_exp_f32 v77, v77
  v_exp_f32 v78, v78
  v_exp_f32 v79, v79
  v_exp_f32 v80, v80
  v_exp_f32 v81, v81
  v_exp_f32 v82, v82
  v_exp_f32 v83, v83
  v_cvt_pk_bf16_f32 v84, v76, v77
  v_cvt_pk_bf16_f32 v85, v78, v79
  v_cvt_pk_bf16_f32 v86, v80, v81
  v_cvt_pk_bf16_f32 v87, v82, v83
  v_exp_f32 v72, v72
  v_exp_f32 v73, v73
  v_mfma_f32_16x16x32_bf16 v[100:103], v[36:39], v[84:87], 0
  v_exp_f32 v74, v74
  v_exp_f32 v75, v75
  v_mfma_f32_16x16x32_bf16 v[92:95], a[168:171], v[84:87], 0
  v_cvt_pk_bf16_f32 v88, v72, v73
  v_cvt_pk_bf16_f32 v89, v74, v75
  v_mfma_f32_16x16x32_bf16 v[96:99], a[172:175], v[84:87], 0
  s_waitcnt lgkmcnt(0)
  v_mfma_f32_16x16x16_bf16 v[100:103], v[36:37], v[88:89], v[100:103]
  v_add_f32 v56, v56, v64
  v_add_f32 v60, v60, v48
  v_add_f32 v57, v57, v65
  v_add_f32 v61, v61, v49
  v_add_f32 v58, v58, v66
  v_add_f32 v62, v62, v50
  v_add_f32 v59, v59, v67
  v_add_f32 v63, v63, v51
  v_cvt_pk_bf16_f32 v68, v56, v57
  v_cvt_pk_bf16_f32 v69, v58, v59
  v_cvt_pk_bf16_f32 v70, v60, v61
  v_cvt_pk_bf16_f32 v71, v62, v63
  v_mfma_f32_16x16x16_bf16 v[92:95], v[68:69], v[88:89], v[92:95]
  v_rcp_f32 v28, v100
  v_mfma_f32_16x16x16_bf16 v[96:99], v[70:71], v[88:89], v[96:99]
  v_mov_b32 v29, v28
  s_nop 4
  v_pk_mul_f32 v[92:93], v[92:93], v[28:29]
  v_pk_mul_f32 v[94:95], v[94:95], v[28:29]
  v_pk_mul_f32 v[96:97], v[96:97], v[28:29]
  v_pk_mul_f32 v[98:99], v[98:99], v[28:29]
  v_cvt_pk_bf16_f32 v104, v92, v93
  v_cvt_pk_bf16_f32 v105, v94, v95
  v_cvt_pk_bf16_f32 v106, v96, v97
  v_cvt_pk_bf16_f32 v107, v98, v99
  buffer_store_dwordx4 v[104:107], v11, s[4:7], s22 offen sc1
reca_b3132:
  s_barrier
  s_cmp_ge_u32 s12, 2
  s_cbranch_scc1 reca_notg2148
  s_sleep 3
  buffer_load_dwordx4 v[128:131], v12, s[4:7], s22 offen offset:0 sc1
  buffer_load_dwordx4 v[132:135], v12, s[4:7], s22 offen offset:1024 sc1
  buffer_load_dwordx4 v[136:139], v12, s[4:7], s22 offen offset:2048 sc1
  buffer_load_dwordx4 v[140:143], v12, s[4:7], s22 offen offset:3072 sc1
  buffer_load_dwordx4 v[144:147], v13, s[4:7], s22 offen offset:0 sc1
  buffer_load_dwordx4 v[148:151], v13, s[4:7], s22 offen offset:1024 sc1
  buffer_load_dwordx4 v[152:155], v13, s[4:7], s22 offen offset:2048 sc1
  buffer_load_dwordx4 v[156:159], v13, s[4:7], s22 offen offset:3072 sc1
  buffer_load_dwordx4 v[160:163], v14, s[4:7], s22 offen offset:0 sc1
  buffer_load_dwordx4 v[164:167], v14, s[4:7], s22 offen offset:1024 sc1
  buffer_load_dwordx4 v[168:171], v14, s[4:7], s22 offen offset:2048 sc1
  buffer_load_dwordx4 v[172:175], v14, s[4:7], s22 offen offset:3072 sc1
  s_waitcnt vmcnt(11)
  v_cmp_eq_u32 vcc, -1, v128
  s_cbranch_vccnz reca_retry149
reca_resume150:
  s_waitcnt vmcnt(10)
  v_cmp_eq_u32 vcc, -1, v132
  v_mfma_f32_16x16x32_bf16 v[108:111], a[120:123], v[128:131], 0
  v_mfma_f32_16x16x32_bf16 v[112:115], a[124:127], v[128:131], 0
  s_cbranch_vccnz reca_retry151
reca_resume152:
  s_waitcnt vmcnt(9)
  v_cmp_eq_u32 vcc, -1, v136
  v_mfma_f32_16x16x32_bf16 v[108:111], a[128:131], v[132:135], v[108:111]
  v_mfma_f32_16x16x32_bf16 v[112:115], a[132:135], v[132:135], v[112:115]
  s_cbranch_vccnz reca_retry153
reca_resume154:
  s_waitcnt vmcnt(8)
  v_cmp_eq_u32 vcc, -1, v140
  v_mfma_f32_16x16x32_bf16 v[108:111], a[136:139], v[136:139], v[108:111]
  v_mfma_f32_16x16x32_bf16 v[112:115], a[140:143], v[136:139], v[112:115]
  s_cbranch_vccnz reca_retry155
reca_resume156:
  s_waitcnt vmcnt(7)
  v_cmp_eq_u32 vcc, -1, v144
  v_mfma_f32_16x16x32_bf16 v[108:111], a[144:147], v[140:143], v[108:111]
  v_mfma_f32_16x16x32_bf16 v[112:115], a[148:151], v[140:143], v[112:115]
  s_cbranch_vccnz reca_retry157
reca_resume158:
  s_waitcnt vmcnt(6)
  v_cmp_eq_u32 vcc, -1, v148
  v_mfma_f32_16x16x32_bf16 v[108:111], a[152:155], v[144:147], v[108:111]
  v_mfma_f32_16x16x32_bf16 v[112:115], a[156:159], v[144:147], v[112:115]
  s_cbranch_vccnz reca_retry159
reca_resume160:
  s_waitcnt vmcnt(5)
  v_cmp_eq_u32 vcc, -1, v152
  v_mfma_f32_16x16x32_bf16 v[108:111], a[160:163], v[148:151], v[108:111]
  v_mfma_f32_16x16x32_bf16 v[112:115], a[164:167], v[148:151], v[112:115]
  s_cbranch_vccnz reca_retry161
reca_resume162:
  s_waitcnt vmcnt(4)
  v_cmp_eq_u32 vcc, -1, v156
  v_mfma_f32_16x16x32_bf16 v[108:111], a[168:171], v[152:155], v[108:111]
  v_mfma_f32_16x16x32_bf16 v[112:115], a[172:175], v[152:155], v[112:115]
  s_cbranch_vccnz reca_retry163
reca_resume164:
  s_waitcnt vmcnt(3)
  v_cmp_eq_u32 vcc, -1, v160
  v_mfma_f32_16x16x32_bf16 v[108:111], a[176:179], v[156:159], v[108:111]
  v_mfma_f32_16x16x32_bf16 v[112:115], a[180:183], v[156:159], v[112:115]
  s_cbranch_vccnz reca_retry165
reca_resume166:
  s_waitcnt vmcnt(2)
  v_cmp_eq_u32 vcc, -1, v164
  v_mfma_f32_16x16x32_bf16 v[108:111], a[184:187], v[160:163], v[108:111]
  v_mfma_f32_16x16x32_bf16 v[112:115], a[188:191], v[160:163], v[112:115]
  s_cbranch_vccnz reca_retry167
reca_resume168:
  s_waitcnt vmcnt(1)
  v_cmp_eq_u32 vcc, -1, v168
  v_mfma_f32_16x16x32_bf16 v[108:111], a[192:195], v[164:167], v[108:111]
  v_mfma_f32_16x16x32_bf16 v[112:115], a[196:199], v[164:167], v[112:115]
  s_cbranch_vccnz reca_retry169
reca_resume170:
  s_waitcnt vmcnt(0)
  v_cmp_eq_u32 vcc, -1, v172
  v_mfma_f32_16x16x32_bf16 v[108:111], a[200:203], v[168:171], v[108:111]
  v_mfma_f32_16x16x32_bf16 v[112:115], a[204:207], v[168:171], v[112:115]
  s_cbranch_vccnz reca_retry171
reca_resume172:
  v_mfma_f32_16x16x32_bf16 v[108:111], a[208:211], v[172:175], v[108:111]
  v_mfma_f32_16x16x32_bf16 v[112:115], a[212:215], v[172:175], v[112:115]
  s_nop 7
  v_add_f32_dpp v116, v112, v108 row_ror:8 row_mask:0xf bank_mask:0xf
  v_add_f32_dpp v117, v113, v109 row_ror:8 row_mask:0xf bank_mask:0xf
  v_add_f32_dpp v118, v114, v110 row_ror:8 row_mask:0xf bank_mask:0xf
  v_add_f32_dpp v119, v115, v111 row_ror:8 row_mask:0xf bank_mask:0xf
  buffer_store_dwordx4 v[116:119], v15, s[4:7], s25 offen sc1
  buffer_store_dwordx4 v[116:119], v232, s[4:7], s25 offen sc1
  buffer_store_dwordx4 v[32:35], v15, s[4:7], s29 offen sc1
  buffer_store_dwordx4 v[32:35], v232, s[4:7], s29 offen sc1
  s_branch reca_b4133
reca_notg2148:
  s_cmp_lg_u32 s12, 3
  s_cbranch_scc1 reca_b4133
  s_add_u32 s34, s17, 2
  s_and_b32 s34, s34, 3
  s_mul_i32 s26, s34, 10240
  s_add_u32 s26, s26, s38
  s_mul_i32 s27, s34, 6144
  s_add_u32 s27, s27, s39
  s_mul_i32 s28, s34, 12288
  s_add_u32 s28, s28, s40
  s_mul_i32 s29, s34, 393216
  s_add_u32 s29, s29, s56
  buffer_store_dwordx2 v[32:33], v8, s[4:7], s27 offen sc1
  buffer_store_dwordx4 v[32:35], v11, s[4:7], s28 offen sc1
reca_b4133:
  s_barrier
  s_cmp_lg_u32 s12, 2
  s_cbranch_scc1 reca_not2173
  s_sleep 8
  buffer_load_dwordx4 v[128:131], v20, s[4:7], s25 offen sc1
  buffer_load_dwordx4 v[132:135], v21, s[4:7], s25 offen sc1
  buffer_load_dwordx4 v[136:139], v22, s[4:7], s25 offen sc1
  buffer_load_dwordx4 v[140:143], v23, s[4:7], s25 offen sc1
  buffer_load_dwordx4 v[144:147], v24, s[4:7], s25 offen sc1
  buffer_load_dwordx4 v[148:151], v25, s[4:7], s25 offen sc1
  buffer_load_dwordx4 v[152:155], v26, s[4:7], s25 offen sc1
  buffer_load_dwordx4 v[156:159], v27, s[4:7], s25 offen sc1
  s_waitcnt vmcnt(7)
  v_cmp_eq_u32 vcc, -1, v128
  s_cbranch_vccnz reca_retry174
reca_resume175:
  s_waitcnt vmcnt(6)
  v_cmp_eq_u32 vcc, -1, v132
  s_cbranch_vccnz reca_retry176
reca_resume177:
  s_waitcnt vmcnt(5)
  v_cmp_eq_u32 vcc, -1, v136
  v_pk_add_f32 v[116:117], v[128:129], v[132:133]
  v_pk_add_f32 v[118:119], v[130:131], v[134:135]
  s_cbranch_vccnz reca_retry178
reca_resume179:
  s_waitcnt vmcnt(4)
  v_cmp_eq_u32 vcc, -1, v140
  v_pk_add_f32 v[116:117], v[116:117], v[136:137]
  v_pk_add_f32 v[118:119], v[118:119], v[138:139]
  s_cbranch_vccnz reca_retry180
reca_resume181:
  s_waitcnt vmcnt(3)
  v_cmp_eq_u32 vcc, -1, v144
  v_pk_add_f32 v[116:117], v[116:117], v[140:141]
  v_pk_add_f32 v[118:119], v[118:119], v[142:143]
  s_cbranch_vccnz reca_retry182
reca_resume183:
  s_waitcnt vmcnt(2)
  v_cmp_eq_u32 vcc, -1, v148
  v_pk_add_f32 v[116:117], v[116:117], v[144:145]
  v_pk_add_f32 v[118:119], v[118:119], v[146:147]
  s_cbranch_vccnz reca_retry184
reca_resume185:
  s_waitcnt vmcnt(1)
  v_cmp_eq_u32 vcc, -1, v152
  v_pk_add_f32 v[116:117], v[116:117], v[148:149]
  v_pk_add_f32 v[118:119], v[118:119], v[150:151]
  s_cbranch_vccnz reca_retry186
reca_resume187:
  s_waitcnt vmcnt(0)
  v_cmp_eq_u32 vcc, -1, v156
  v_pk_add_f32 v[116:117], v[116:117], v[152:153]
  v_pk_add_f32 v[118:119], v[118:119], v[154:155]
  s_cbranch_vccnz reca_retry188
reca_resume189:
  v_pk_add_f32 v[116:117], v[116:117], v[156:157]
  v_pk_add_f32 v[118:119], v[118:119], v[158:159]
  v_cvt_pk_bf16_f32 v132, v116, v117
  v_cvt_pk_bf16_f32 v133, v118, v119
  buffer_store_dwordx2 v[132:133], v16, s[4:7], s24 offen sc1
  s_branch reca_b5134
reca_not2173:
  s_cmp_lg_u32 s12, 3
  s_cbranch_scc1 reca_b5134
  s_add_u32 s36, s17, 1
  s_cmp_ge_u32 s36, 63
  s_cbranch_scc1 reca_nopf190
  s_add_u32 s37, s36, 1
reca_pf191:
  buffer_load_dword v28, v233, s[4:7], 0 offen sc1
  s_waitcnt vmcnt(0)
  v_cmp_gt_i32 vcc, s37, v28
  s_cbranch_vccz reca_pfok192
  s_sleep 1
  s_sub_u32 s18, s18, 1
  s_cbranch_scc0 reca_pf191
  s_mov_b32 s18, 0
reca_pfok192:
  s_lshl_b32 s34, s15, 6
  s_add_u32 s34, s34, s36
  s_mul_i32 s34, s34, 12288
  s_add_u32 s32, s34, 37748736
  s_lshl_b32 s35, s16, 11
  s_add_u32 s34, s34, s35
  s_add_u32 s33, s34, 62914560
  buffer_load_dwordx4 a[120:123], v1, s[4:7], s32 offen offset:0 sc1
  buffer_load_dwordx4 a[124:127], v1, s[4:7], s32 offen offset:1024 sc1
  buffer_load_dwordx4 a[128:131], v1, s[4:7], s32 offen offset:2048 sc1
  buffer_load_dwordx4 a[132:135], v1, s[4:7], s32 offen offset:3072 sc1
  buffer_load_dwordx4 a[136:139], v2, s[4:7], s32 offen offset:0 sc1
  buffer_load_dwordx4 a[140:143], v2, s[4:7], s32 offen offset:1024 sc1
  buffer_load_dwordx4 a[144:147], v2, s[4:7], s32 offen offset:2048 sc1
  buffer_load_dwordx4 a[148:151], v2, s[4:7], s32 offen offset:3072 sc1
  buffer_load_dwordx4 a[152:155], v3, s[4:7], s32 offen offset:0 sc1
  buffer_load_dwordx4 a[156:159], v3, s[4:7], s32 offen offset:1024 sc1
  buffer_load_dwordx4 a[160:163], v3, s[4:7], s32 offen offset:2048 sc1
  buffer_load_dwordx4 a[164:167], v3, s[4:7], s32 offen offset:3072 sc1
  buffer_load_dwordx4 a[168:171], v1, s[4:7], s33 offen offset:0 sc1
  buffer_load_dwordx4 a[172:175], v1, s[4:7], s33 offen offset:1024 sc1
reca_nopf190:
  buffer_store_dwordx2 v[52:53], v9, s[4:7], s30 offen sc1
  buffer_store_dwordx2 v[68:69], v10, s[4:7], s31 offen sc1
  buffer_store_dwordx2 v[70:71], v10, s[4:7], s31 offen offset:256 sc1
reca_b5134:
  s_barrier
  s_add_u32 s17, s17, 1
  s_branch reca_step120
reca_retry123:
  s_sub_u32 s18, s18, 1
  s_cbranch_scc1 reca_retry123_to
  buffer_load_dwordx4 v[128:131], v4, s[4:7], s20 offen sc1
  buffer_load_dwordx4 v[132:135], v4, s[4:7], s20 offen offset:1024 sc1
  buffer_load_dwordx4 v[136:139], v5, s[4:7], s20 offen sc1
  s_waitcnt vmcnt(2)
  v_max_u32 v29, v128, v130
  v_cmp_eq_u32 vcc, -1, v29
  s_cbranch_vccnz reca_retry123
  s_branch reca_resume124
reca_retry123_to:
  s_mov_b32 s18, 0
  s_waitcnt vmcnt(0)
  s_branch reca_resume124
reca_retry125:
  s_sub_u32 s18, s18, 1
  s_cbranch_scc1 reca_retry125_to
  buffer_load_dwordx4 v[132:135], v4, s[4:7], s20 offen offset:1024 sc1
  buffer_load_dwordx4 v[136:139], v5, s[4:7], s20 offen sc1
  s_waitcnt vmcnt(1)
  v_max_u32 v29, v132, v134
  v_cmp_eq_u32 vcc, -1, v29
  s_cbranch_vccnz reca_retry125
  s_branch reca_resume126
reca_retry125_to:
  s_mov_b32 s18, 0
  s_waitcnt vmcnt(0)
  s_branch reca_resume126
reca_retry127:
  s_sub_u32 s18, s18, 1
  s_cbranch_scc1 reca_retry127_to
  buffer_load_dwordx4 v[136:139], v5, s[4:7], s20 offen sc1
  s_waitcnt vmcnt(0)
  v_max_u32 v29, v136, v138
  v_cmp_eq_u32 vcc, -1, v29
  s_cbranch_vccnz reca_retry127
  s_branch reca_resume128
reca_retry127_to:
  s_mov_b32 s18, 0
  s_waitcnt vmcnt(0)
  s_branch reca_resume128
reca_retry136:
  s_sub_u32 s18, s18, 1
  s_cbranch_scc1 reca_retry136_to
  buffer_load_dwordx4 v[208:211], v1, s[4:7], s21 offen offset:0 sc1
  buffer_load_dwordx4 v[212:215], v1, s[4:7], s21 offen offset:1024 sc1
  buffer_load_dwordx4 v[216:219], v1, s[4:7], s21 offen offset:2048 sc1
  buffer_load_dwordx4 v[220:223], v1, s[4:7], s21 offen offset:3072 sc1
  buffer_load_dwordx4 v[224:227], v2, s[4:7], s21 offen offset:0 sc1
  buffer_load_dwordx4 v[228:231], v2, s[4:7], s21 offen offset:1024 sc1
  s_waitcnt vmcnt(5)
  v_max_u32 v29, v208, v210
  v_cmp_eq_u32 vcc, -1, v29
  s_cbranch_vccnz reca_retry136
  s_branch reca_resume137
reca_retry136_to:
  s_mov_b32 s18, 0
  s_waitcnt vmcnt(0)
  s_branch reca_resume137
reca_retry138:
  s_sub_u32 s18, s18, 1
  s_cbranch_scc1 reca_retry138_to
  buffer_load_dwordx4 v[212:215], v1, s[4:7], s21 offen offset:1024 sc1
  buffer_load_dwordx4 v[216:219], v1, s[4:7], s21 offen offset:2048 sc1
  buffer_load_dwordx4 v[220:223], v1, s[4:7], s21 offen offset:3072 sc1
  buffer_load_dwordx4 v[224:227], v2, s[4:7], s21 offen offset:0 sc1
  buffer_load_dwordx4 v[228:231], v2, s[4:7], s21 offen offset:1024 sc1
  s_waitcnt vmcnt(4)
  v_max_u32 v29, v212, v214
  v_cmp_eq_u32 vcc, -1, v29
  s_cbranch_vccnz reca_retry138
  s_branch reca_resume139
reca_retry138_to:
  s_mov_b32 s18, 0
  s_waitcnt vmcnt(0)
  s_branch reca_resume139
reca_retry140:
  s_sub_u32 s18, s18, 1
  s_cbranch_scc1 reca_retry140_to
  buffer_load_dwordx4 v[216:219], v1, s[4:7], s21 offen offset:2048 sc1
  buffer_load_dwordx4 v[220:223], v1, s[4:7], s21 offen offset:3072 sc1
  buffer_load_dwordx4 v[224:227], v2, s[4:7], s21 offen offset:0 sc1
  buffer_load_dwordx4 v[228:231], v2, s[4:7], s21 offen offset:1024 sc1
  s_waitcnt vmcnt(3)
  v_max_u32 v29, v216, v218
  v_cmp_eq_u32 vcc, -1, v29
  s_cbranch_vccnz reca_retry140
  s_branch reca_resume141
reca_retry140_to:
  s_mov_b32 s18, 0
  s_waitcnt vmcnt(0)
  s_branch reca_resume141
reca_retry142:
  s_sub_u32 s18, s18, 1
  s_cbranch_scc1 reca_retry142_to
  buffer_load_dwordx4 v[220:223], v1, s[4:7], s21 offen offset:3072 sc1
  buffer_load_dwordx4 v[224:227], v2, s[4:7], s21 offen offset:0 sc1
  buffer_load_dwordx4 v[228:231], v2, s[4:7], s21 offen offset:1024 sc1
  s_waitcnt vmcnt(2)
  v_max_u32 v29, v220, v222
  v_cmp_eq_u32 vcc, -1, v29
  s_cbranch_vccnz reca_retry142
  s_branch reca_resume143
reca_retry142_to:
  s_mov_b32 s18, 0
  s_waitcnt vmcnt(0)
  s_branch reca_resume143
reca_retry144:
  s_sub_u32 s18, s18, 1
  s_cbranch_scc1 reca_retry144_to
  buffer_load_dwordx4 v[224:227], v2, s[4:7], s21 offen offset:0 sc1
  buffer_load_dwordx4 v[228:231], v2, s[4:7], s21 offen offset:1024 sc1
  s_waitcnt vmcnt(1)
  v_max_u32 v29, v224, v226
  v_cmp_eq_u32 vcc, -1, v29
  s_cbranch_vccnz reca_retry144
  s_branch reca_resume145
reca_retry144_to:
  s_mov_b32 s18, 0
  s_waitcnt vmcnt(0)
  s_branch reca_resume145
reca_retry146:
  s_sub_u32 s18, s18, 1
  s_cbranch_scc1 reca_retry146_to
  buffer_load_dwordx4 v[228:231], v2, s[4:7], s21 offen offset:1024 sc1
  s_waitcnt vmcnt(0)
  v_max_u32 v29, v228, v230
  v_cmp_eq_u32 vcc, -1, v29
  s_cbranch_vccnz reca_retry146
  s_branch reca_resume147
reca_retry146_to:
  s_mov_b32 s18, 0
  s_waitcnt vmcnt(0)
  s_branch reca_resume147
reca_retry149:
  s_sub_u32 s18, s18, 1
  s_cbranch_scc1 reca_retry149_to
  buffer_load_dwordx4 v[128:131], v12, s[4:7], s22 offen offset:0 sc1
  buffer_load_dwordx4 v[132:135], v12, s[4:7], s22 offen offset:1024 sc1
  buffer_load_dwordx4 v[136:139], v12, s[4:7], s22 offen offset:2048 sc1
  buffer_load_dwordx4 v[140:143], v12, s[4:7], s22 offen offset:3072 sc1
  buffer_load_dwordx4 v[144:147], v13, s[4:7], s22 offen offset:0 sc1
  buffer_load_dwordx4 v[148:151], v13, s[4:7], s22 offen offset:1024 sc1
  buffer_load_dwordx4 v[152:155], v13, s[4:7], s22 offen offset:2048 sc1
  buffer_load_dwordx4 v[156:159], v13, s[4:7], s22 offen offset:3072 sc1
  buffer_load_dwordx4 v[160:163], v14, s[4:7], s22 offen offset:0 sc1
  buffer_load_dwordx4 v[164:167], v14, s[4:7], s22 offen offset:1024 sc1
  buffer_load_dwordx4 v[168:171], v14, s[4:7], s22 offen offset:2048 sc1
  buffer_load_dwordx4 v[172:175], v14, s[4:7], s22 offen offset:3072 sc1
  s_waitcnt vmcnt(11)
  v_cmp_eq_u32 vcc, -1, v128
  s_cbranch_vccnz reca_retry149
  s_branch reca_resume150
reca_retry149_to:
  s_mov_b32 s18, 0
  s_waitcnt vmcnt(0)
  s_branch reca_resume150
reca_retry151:
  s_sub_u32 s18, s18, 1
  s_cbranch_scc1 reca_retry151_to
  buffer_load_dwordx4 v[132:135], v12, s[4:7], s22 offen offset:1024 sc1
  buffer_load_dwordx4 v[136:139], v12, s[4:7], s22 offen offset:2048 sc1
  buffer_load_dwordx4 v[140:143], v12, s[4:7], s22 offen offset:3072 sc1
  buffer_load_dwordx4 v[144:147], v13, s[4:7], s22 offen offset:0 sc1
  buffer_load_dwordx4 v[148:151], v13, s[4:7], s22 offen offset:1024 sc1
  buffer_load_dwordx4 v[152:155], v13, s[4:7], s22 offen offset:2048 sc1
  buffer_load_dwordx4 v[156:159], v13, s[4:7], s22 offen offset:3072 sc1
  buffer_load_dwordx4 v[160:163], v14, s[4:7], s22 offen offset:0 sc1
  buffer_load_dwordx4 v[164:167], v14, s[4:7], s22 offen offset:1024 sc1
  buffer_load_dwordx4 v[168:171], v14, s[4:7], s22 offen offset:2048 sc1
  buffer_load_dwordx4 v[172:175], v14, s[4:7], s22 offen offset:3072 sc1
  s_waitcnt vmcnt(10)
  v_cmp_eq_u32 vcc, -1, v132
  s_cbranch_vccnz reca_retry151
  s_branch reca_resume152
reca_retry151_to:
  s_mov_b32 s18, 0
  s_waitcnt vmcnt(0)
  s_branch reca_resume152
reca_retry153:
  s_sub_u32 s18, s18, 1
  s_cbranch_scc1 reca_retry153_to
  buffer_load_dwordx4 v[136:139], v12, s[4:7], s22 offen offset:2048 sc1
  buffer_load_dwordx4 v[140:143], v12, s[4:7], s22 offen offset:3072 sc1
  buffer_load_dwordx4 v[144:147], v13, s[4:7], s22 offen offset:0 sc1
  buffer_load_dwordx4 v[148:151], v13, s[4:7], s22 offen offset:1024 sc1
  buffer_load_dwordx4 v[152:155], v13, s[4:7], s22 offen offset:2048 sc1
  buffer_load_dwordx4 v[156:159], v13, s[4:7], s22 offen offset:3072 sc1
  buffer_load_dwordx4 v[160:163], v14, s[4:7], s22 offen offset:0 sc1
  buffer_load_dwordx4 v[164:167], v14, s[4:7], s22 offen offset:1024 sc1
  buffer_load_dwordx4 v[168:171], v14, s[4:7], s22 offen offset:2048 sc1
  buffer_load_dwordx4 v[172:175], v14, s[4:7], s22 offen offset:3072 sc1
  s_waitcnt vmcnt(9)
  v_cmp_eq_u32 vcc, -1, v136
  s_cbranch_vccnz reca_retry153
  s_branch reca_resume154
reca_retry153_to:
  s_mov_b32 s18, 0
  s_waitcnt vmcnt(0)
  s_branch reca_resume154
reca_retry155:
  s_sub_u32 s18, s18, 1
  s_cbranch_scc1 reca_retry155_to
  buffer_load_dwordx4 v[140:143], v12, s[4:7], s22 offen offset:3072 sc1
  buffer_load_dwordx4 v[144:147], v13, s[4:7], s22 offen offset:0 sc1
  buffer_load_dwordx4 v[148:151], v13, s[4:7], s22 offen offset:1024 sc1
  buffer_load_dwordx4 v[152:155], v13, s[4:7], s22 offen offset:2048 sc1
  buffer_load_dwordx4 v[156:159], v13, s[4:7], s22 offen offset:3072 sc1
  buffer_load_dwordx4 v[160:163], v14, s[4:7], s22 offen offset:0 sc1
  buffer_load_dwordx4 v[164:167], v14, s[4:7], s22 offen offset:1024 sc1
  buffer_load_dwordx4 v[168:171], v14, s[4:7], s22 offen offset:2048 sc1
  buffer_load_dwordx4 v[172:175], v14, s[4:7], s22 offen offset:3072 sc1
  s_waitcnt vmcnt(8)
  v_cmp_eq_u32 vcc, -1, v140
  s_cbranch_vccnz reca_retry155
  s_branch reca_resume156
reca_retry155_to:
  s_mov_b32 s18, 0
  s_waitcnt vmcnt(0)
  s_branch reca_resume156
reca_retry157:
  s_sub_u32 s18, s18, 1
  s_cbranch_scc1 reca_retry157_to
  buffer_load_dwordx4 v[144:147], v13, s[4:7], s22 offen offset:0 sc1
  buffer_load_dwordx4 v[148:151], v13, s[4:7], s22 offen offset:1024 sc1
  buffer_load_dwordx4 v[152:155], v13, s[4:7], s22 offen offset:2048 sc1
  buffer_load_dwordx4 v[156:159], v13, s[4:7], s22 offen offset:3072 sc1
  buffer_load_dwordx4 v[160:163], v14, s[4:7], s22 offen offset:0 sc1
  buffer_load_dwordx4 v[164:167], v14, s[4:7], s22 offen offset:1024 sc1
  buffer_load_dwordx4 v[168:171], v14, s[4:7], s22 offen offset:2048 sc1
  buffer_load_dwordx4 v[172:175], v14, s[4:7], s22 offen offset:3072 sc1
  s_waitcnt vmcnt(7)
  v_cmp_eq_u32 vcc, -1, v144
  s_cbranch_vccnz reca_retry157
  s_branch reca_resume158
reca_retry157_to:
  s_mov_b32 s18, 0
  s_waitcnt vmcnt(0)
  s_branch reca_resume158
reca_retry159:
  s_sub_u32 s18, s18, 1
  s_cbranch_scc1 reca_retry159_to
  buffer_load_dwordx4 v[148:151], v13, s[4:7], s22 offen offset:1024 sc1
  buffer_load_dwordx4 v[152:155], v13, s[4:7], s22 offen offset:2048 sc1
  buffer_load_dwordx4 v[156:159], v13, s[4:7], s22 offen offset:3072 sc1
  buffer_load_dwordx4 v[160:163], v14, s[4:7], s22 offen offset:0 sc1
  buffer_load_dwordx4 v[164:167], v14, s[4:7], s22 offen offset:1024 sc1
  buffer_load_dwordx4 v[168:171], v14, s[4:7], s22 offen offset:2048 sc1
  buffer_load_dwordx4 v[172:175], v14, s[4:7], s22 offen offset:3072 sc1
  s_waitcnt vmcnt(6)
  v_cmp_eq_u32 vcc, -1, v148
  s_cbranch_vccnz reca_retry159
  s_branch reca_resume160
reca_retry159_to:
  s_mov_b32 s18, 0
  s_waitcnt vmcnt(0)
  s_branch reca_resume160
reca_retry161:
  s_sub_u32 s18, s18, 1
  s_cbranch_scc1 reca_retry161_to
  buffer_load_dwordx4 v[152:155], v13, s[4:7], s22 offen offset:2048 sc1
  buffer_load_dwordx4 v[156:159], v13, s[4:7], s22 offen offset:3072 sc1
  buffer_load_dwordx4 v[160:163], v14, s[4:7], s22 offen offset:0 sc1
  buffer_load_dwordx4 v[164:167], v14, s[4:7], s22 offen offset:1024 sc1
  buffer_load_dwordx4 v[168:171], v14, s[4:7], s22 offen offset:2048 sc1
  buffer_load_dwordx4 v[172:175], v14, s[4:7], s22 offen offset:3072 sc1
  s_waitcnt vmcnt(5)
  v_cmp_eq_u32 vcc, -1, v152
  s_cbranch_vccnz reca_retry161
  s_branch reca_resume162
reca_retry161_to:
  s_mov_b32 s18, 0
  s_waitcnt vmcnt(0)
  s_branch reca_resume162
reca_retry163:
  s_sub_u32 s18, s18, 1
  s_cbranch_scc1 reca_retry163_to
  buffer_load_dwordx4 v[156:159], v13, s[4:7], s22 offen offset:3072 sc1
  buffer_load_dwordx4 v[160:163], v14, s[4:7], s22 offen offset:0 sc1
  buffer_load_dwordx4 v[164:167], v14, s[4:7], s22 offen offset:1024 sc1
  buffer_load_dwordx4 v[168:171], v14, s[4:7], s22 offen offset:2048 sc1
  buffer_load_dwordx4 v[172:175], v14, s[4:7], s22 offen offset:3072 sc1
  s_waitcnt vmcnt(4)
  v_cmp_eq_u32 vcc, -1, v156
  s_cbranch_vccnz reca_retry163
  s_branch reca_resume164
reca_retry163_to:
  s_mov_b32 s18, 0
  s_waitcnt vmcnt(0)
  s_branch reca_resume164
reca_retry165:
  s_sub_u32 s18, s18, 1
  s_cbranch_scc1 reca_retry165_to
  buffer_load_dwordx4 v[160:163], v14, s[4:7], s22 offen offset:0 sc1
  buffer_load_dwordx4 v[164:167], v14, s[4:7], s22 offen offset:1024 sc1
  buffer_load_dwordx4 v[168:171], v14, s[4:7], s22 offen offset:2048 sc1
  buffer_load_dwordx4 v[172:175], v14, s[4:7], s22 offen offset:3072 sc1
  s_waitcnt vmcnt(3)
  v_cmp_eq_u32 vcc, -1, v160
  s_cbranch_vccnz reca_retry165
  s_branch reca_resume166
reca_retry165_to:
  s_mov_b32 s18, 0
  s_waitcnt vmcnt(0)
  s_branch reca_resume166
reca_retry167:
  s_sub_u32 s18, s18, 1
  s_cbranch_scc1 reca_retry167_to
  buffer_load_dwordx4 v[164:167], v14, s[4:7], s22 offen offset:1024 sc1
  buffer_load_dwordx4 v[168:171], v14, s[4:7], s22 offen offset:2048 sc1
  buffer_load_dwordx4 v[172:175], v14, s[4:7], s22 offen offset:3072 sc1
  s_waitcnt vmcnt(2)
  v_cmp_eq_u32 vcc, -1, v164
  s_cbranch_vccnz reca_retry167
  s_branch reca_resume168
reca_retry167_to:
  s_mov_b32 s18, 0
  s_waitcnt vmcnt(0)
  s_branch reca_resume168
reca_retry169:
  s_sub_u32 s18, s18, 1
  s_cbranch_scc1 reca_retry169_to
  buffer_load_dwordx4 v[168:171], v14, s[4:7], s22 offen offset:2048 sc1
  buffer_load_dwordx4 v[172:175], v14, s[4:7], s22 offen offset:3072 sc1
  s_waitcnt vmcnt(1)
  v_cmp_eq_u32 vcc, -1, v168
  s_cbranch_vccnz reca_retry169
  s_branch reca_resume170
reca_retry169_to:
  s_mov_b32 s18, 0
  s_waitcnt vmcnt(0)
  s_branch reca_resume170
reca_retry171:
  s_sub_u32 s18, s18, 1
  s_cbranch_scc1 reca_retry171_to
  buffer_load_dwordx4 v[172:175], v14, s[4:7], s22 offen offset:3072 sc1
  s_waitcnt vmcnt(0)
  v_cmp_eq_u32 vcc, -1, v172
  s_cbranch_vccnz reca_retry171
  s_branch reca_resume172
reca_retry171_to:
  s_mov_b32 s18, 0
  s_waitcnt vmcnt(0)
  s_branch reca_resume172
reca_retry174:
  s_sub_u32 s18, s18, 1
  s_cbranch_scc1 reca_retry174_to
  buffer_load_dwordx4 v[128:131], v20, s[4:7], s25 offen sc1
  buffer_load_dwordx4 v[132:135], v21, s[4:7], s25 offen sc1
  buffer_load_dwordx4 v[136:139], v22, s[4:7], s25 offen sc1
  buffer_load_dwordx4 v[140:143], v23, s[4:7], s25 offen sc1
  buffer_load_dwordx4 v[144:147], v24, s[4:7], s25 offen sc1
  buffer_load_dwordx4 v[148:151], v25, s[4:7], s25 offen sc1
  buffer_load_dwordx4 v[152:155], v26, s[4:7], s25 offen sc1
  buffer_load_dwordx4 v[156:159], v27, s[4:7], s25 offen sc1
  s_waitcnt vmcnt(7)
  v_cmp_eq_u32 vcc, -1, v128
  s_cbranch_vccnz reca_retry174
  s_branch reca_resume175
reca_retry174_to:
  s_mov_b32 s18, 0
  s_waitcnt vmcnt(0)
  s_branch reca_resume175
reca_retry176:
  s_sub_u32 s18, s18, 1
  s_cbranch_scc1 reca_retry176_to
  buffer_load_dwordx4 v[132:135], v21, s[4:7], s25 offen sc1
  buffer_load_dwordx4 v[136:139], v22, s[4:7], s25 offen sc1
  buffer_load_dwordx4 v[140:143], v23, s[4:7], s25 offen sc1
  buffer_load_dwordx4 v[144:147], v24, s[4:7], s25 offen sc1
  buffer_load_dwordx4 v[148:151], v25, s[4:7], s25 offen sc1
  buffer_load_dwordx4 v[152:155], v26, s[4:7], s25 offen sc1
  buffer_load_dwordx4 v[156:159], v27, s[4:7], s25 offen sc1
  s_waitcnt vmcnt(6)
  v_cmp_eq_u32 vcc, -1, v132
  s_cbranch_vccnz reca_retry176
  s_branch reca_resume177
reca_retry176_to:
  s_mov_b32 s18, 0
  s_waitcnt vmcnt(0)
  s_branch reca_resume177
reca_retry178:
  s_sub_u32 s18, s18, 1
  s_cbranch_scc1 reca_retry178_to
  buffer_load_dwordx4 v[136:139], v22, s[4:7], s25 offen sc1
  buffer_load_dwordx4 v[140:143], v23, s[4:7], s25 offen sc1
  buffer_load_dwordx4 v[144:147], v24, s[4:7], s25 offen sc1
  buffer_load_dwordx4 v[148:151], v25, s[4:7], s25 offen sc1
  buffer_load_dwordx4 v[152:155], v26, s[4:7], s25 offen sc1
  buffer_load_dwordx4 v[156:159], v27, s[4:7], s25 offen sc1
  s_waitcnt vmcnt(5)
  v_cmp_eq_u32 vcc, -1, v136
  s_cbranch_vccnz reca_retry178
  s_branch reca_resume179
reca_retry178_to:
  s_mov_b32 s18, 0
  s_waitcnt vmcnt(0)
  s_branch reca_resume179
reca_retry180:
  s_sub_u32 s18, s18, 1
  s_cbranch_scc1 reca_retry180_to
  buffer_load_dwordx4 v[140:143], v23, s[4:7], s25 offen sc1
  buffer_load_dwordx4 v[144:147], v24, s[4:7], s25 offen sc1
  buffer_load_dwordx4 v[148:151], v25, s[4:7], s25 offen sc1
  buffer_load_dwordx4 v[152:155], v26, s[4:7], s25 offen sc1
  buffer_load_dwordx4 v[156:159], v27, s[4:7], s25 offen sc1
  s_waitcnt vmcnt(4)
  v_cmp_eq_u32 vcc, -1, v140
  s_cbranch_vccnz reca_retry180
  s_branch reca_resume181
reca_retry180_to:
  s_mov_b32 s18, 0
  s_waitcnt vmcnt(0)
  s_branch reca_resume181
reca_retry182:
  s_sub_u32 s18, s18, 1
  s_cbranch_scc1 reca_retry182_to
  buffer_load_dwordx4 v[144:147], v24, s[4:7], s25 offen sc1
  buffer_load_dwordx4 v[148:151], v25, s[4:7], s25 offen sc1
  buffer_load_dwordx4 v[152:155], v26, s[4:7], s25 offen sc1
  buffer_load_dwordx4 v[156:159], v27, s[4:7], s25 offen sc1
  s_waitcnt vmcnt(3)
  v_cmp_eq_u32 vcc, -1, v144
  s_cbranch_vccnz reca_retry182
  s_branch reca_resume183
reca_retry182_to:
  s_mov_b32 s18, 0
  s_waitcnt vmcnt(0)
  s_branch reca_resume183
reca_retry184:
  s_sub_u32 s18, s18, 1
  s_cbranch_scc1 reca_retry184_to
  buffer_load_dwordx4 v[148:151], v25, s[4:7], s25 offen sc1
  buffer_load_dwordx4 v[152:155], v26, s[4:7], s25 offen sc1
  buffer_load_dwordx4 v[156:159], v27, s[4:7], s25 offen sc1
  s_waitcnt vmcnt(2)
  v_cmp_eq_u32 vcc, -1, v148
  s_cbranch_vccnz reca_retry184
  s_branch reca_resume185
reca_retry184_to:
  s_mov_b32 s18, 0
  s_waitcnt vmcnt(0)
  s_branch reca_resume185
reca_retry186:
  s_sub_u32 s18, s18, 1
  s_cbranch_scc1 reca_retry186_to
  buffer_load_dwordx4 v[152:155], v26, s[4:7], s25 offen sc1
  buffer_load_dwordx4 v[156:159], v27, s[4:7], s25 offen sc1
  s_waitcnt vmcnt(1)
  v_cmp_eq_u32 vcc, -1, v152
  s_cbranch_vccnz reca_retry186
  s_branch reca_resume187
reca_retry186_to:
  s_mov_b32 s18, 0
  s_waitcnt vmcnt(0)
  s_branch reca_resume187
reca_retry188:
  s_sub_u32 s18, s18, 1
  s_cbranch_scc1 reca_retry188_to
  buffer_load_dwordx4 v[156:159], v27, s[4:7], s25 offen sc1
  s_waitcnt vmcnt(0)
  v_cmp_eq_u32 vcc, -1, v156
  s_cbranch_vccnz reca_retry188
  s_branch reca_resume189
reca_retry188_to:
  s_mov_b32 s18, 0
  s_waitcnt vmcnt(0)
  s_branch reca_resume189
reca_twins13:
  s_branch reca_gotmem194
reca_step193:
  s_and_b32 s34, s17, 3
  s_mul_i32 s20, s34, 10240
  s_add_u32 s20, s20, s38
  s_sleep 5
  buffer_load_dwordx4 v[128:131], v4, s[4:7], s20 offen sc1
  buffer_load_dwordx4 v[132:135], v4, s[4:7], s20 offen offset:1024 sc1
  buffer_load_dwordx4 v[136:139], v5, s[4:7], s20 offen sc1
  s_waitcnt vmcnt(2)
  v_max_u32 v29, v128, v130
  v_cmp_eq_u32 vcc, -1, v29
  s_cbranch_vccnz reca_retry196
reca_resume197:
  s_waitcnt vmcnt(1)
  v_max_u32 v29, v132, v134
  v_cmp_eq_u32 vcc, -1, v29
  ds_write_b128 v4, v[128:131]
  s_cbranch_vccnz reca_retry198
reca_resume199:
  s_waitcnt vmcnt(0)
  v_max_u32 v29, v136, v138
  v_cmp_eq_u32 vcc, -1, v29
  ds_write_b128 v4, v[132:135] offset:1024
  s_cbranch_vccnz reca_retry200
reca_resume201:
  ds_write_b128 v5, v[136:139]
  s_branch reca_gotmem2195
reca_gotmem194:
  ds_write_b128 v4, v[128:131]
  ds_write_b128 v4, v[132:135] offset:1024
  ds_write_b128 v5, v[136:139]
reca_gotmem2195:
  s_and_b32 s34, s17, 3
  s_mul_i32 s21, s34, 6144
  s_add_u32 s21, s21, s39
  s_mul_i32 s22, s34, 12288
  s_add_u32 s22, s22, s40
  s_mul_i32 s25, s34, 393216
  s_add_u32 s25, s25, s56
  s_add_u32 s35, s17, 1
  s_and_b32 s35, s35, 3
  s_mul_i32 s24, s35, 10240
  s_add_u32 s24, s24, s38
  s_waitcnt lgkmcnt(0)
  s_barrier
  ds_read_b128 v[128:131], v236 offset:0
  ds_read_b128 v[132:135], v236 offset:1024
  ds_read_b128 v[136:139], v236 offset:2048
  ds_read_b128 v[140:143], v236 offset:3072
  ds_read_b128 v[144:147], v236 offset:4096
  ds_read_b128 v[148:151], v237 offset:0
  ds_read_b128 v[152:155], v237 offset:1024
  ds_read_b128 v[156:159], v237 offset:2048
  ds_read_b128 v[160:163], v237 offset:3072
  ds_read_b128 v[164:167], v237 offset:4096
  s_waitcnt lgkmcnt(9)
  v_mfma_f32_16x16x32_bf16 v[44:47], a[0:3], v[128:131], 0
  ds_read_b128 v[168:171], v6 offset:0
  v_mfma_f32_16x16x32_bf16 v[240:243], a[4:7], v[128:131], 0
  s_waitcnt lgkmcnt(9)
  v_mfma_f32_16x16x32_bf16 v[44:47], a[8:11], v[132:135], v[44:47]
  ds_read_b128 v[172:175], v6 offset:512
  v_mfma_f32_16x16x32_bf16 v[240:243], a[12:15], v[132:135], v[240:243]
  s_waitcnt lgkmcnt(9)
  v_mfma_f32_16x16x32_bf16 v[44:47], a[16:19], v[136:139], v[44:47]
  ds_read_b128 v[176:179], v6 offset:1024
  v_mfma_f32_16x16x32_bf16 v[240:243], a[20:23], v[136:139], v[240:243]
  s_waitcnt lgkmcnt(9)
  v_mfma_f32_16x16x32_bf16 v[44:47], a[24:27], v[140:143], v[44:47]
  ds_read_b128 v[180:183], v6 offset:1536
  v_mfma_f32_16x16x32_bf16 v[240:243], a[28:31], v[140:143], v[240:243]
  s_waitcnt lgkmcnt(9)
  v_mfma_f32_16x16x32_bf16 v[44:47], a[32:35], v[144:147], v[44:47]
  ds_read_b128 v[184:187], v6 offset:2048
  v_mfma_f32_16x16x32_bf16 v[240:243], a[36:39], v[144:147], v[240:243]
  s_waitcnt lgkmcnt(9)
  v_mfma_f32_16x16x32_bf16 v[44:47], a[40:43], v[148:151], v[44:47]
  ds_read_b128 v[188:191], v6 offset:2560
  v_mfma_f32_16x16x32_bf16 v[240:243], a[44:47], v[148:151], v[240:243]
  s_waitcnt lgkmcnt(9)
  v_mfma_f32_16x16x32_bf16 v[44:47], a[48:51], v[152:155], v[44:47]
  ds_read_b128 v[192:195], v6 offset:3072
  v_mfma_f32_16x16x32_bf16 v[240:243], a[52:55], v[152:155], v[240:243]
  s_waitcnt lgkmcnt(9)
  v_mfma_f32_16x16x32_bf16 v[44:47], a[56:59], v[156:159], v[44:47]
  ds_read_b128 v[196:199], v6 offset:3584
  v_mfma_f32_16x16x32_bf16 v[240:243], a[60:63], v[156:159], v[240:243]
  s_waitcnt lgkmcnt(9)
  v_mfma_f32_16x16x32_bf16 v[44:47], a[64:67], v[160:163], v[44:47]
  ds_read_b128 v[200:203], v6 offset:4096
  v_mfma_f32_16x16x32_bf16 v[240:243], a[68:71], v[160:163], v[240:243]
  s_waitcnt lgkmcnt(9)
  v_mfma_f32_16x16x32_bf16 v[44:47], a[72:75], v[164:167], v[44:47]
  ds_read_b128 v[204:207], v6 offset:4608
  v_mfma_f32_16x16x32_bf16 v[240:243], a[76:79], v[164:167], v[240:243]
  s_waitcnt lgkmcnt(9)
  v_mfma_f32_16x16x32_bf16 v[48:51], v[168:171], a[80:83], 0
  s_lshl_b32 s34, s17, 5
  s_add_u32 s34, s34, s15
  s_mul_i32 s34, s34, 3072
  s_lshl_b32 s35, s16, 9
  s_add_u32 s34, s34, s35
  s_add_u32 s30, s34, 113246208
  s_add_u32 s31, s34, 119537664
  v_add_f32_dpp v44, v240, v44 row_ror:8 row_mask:0xf bank_mask:0xf
  v_add_f32_dpp v45, v241, v45 row_ror:8 row_mask:0xf bank_mask:0xf
  v_add_f32_dpp v46, v242, v46 row_ror:8 row_mask:0xf bank_mask:0xf
  v_add_f32_dpp v47, v243, v47 row_ror:8 row_mask:0xf bank_mask:0xf
  v_cvt_pk_bf16_f32 v52, v44, v45
  v_cvt_pk_bf16_f32 v53, v46, v47
  buffer_store_dwordx2 v[52:53], v8, s[4:7], s21 offen sc1
  s_waitcnt lgkmcnt(8)
  v_mfma_f32_16x16x32_bf16 v[48:51], v[172:175], a[84:87], v[48:51]
  s_waitcnt lgkmcnt(7)
  v_mfma_f32_16x16x32_bf16 v[48:51], v[176:179], a[88:91], v[48:51]
  s_waitcnt lgkmcnt(6)
  v_mfma_f32_16x16x32_bf16 v[48:51], v[180:183], a[92:95], v[48:51]
  s_waitcnt lgkmcnt(5)
  v_mfma_f32_16x16x32_bf16 v[48:51], v[184:187], a[96:99], v[48:51]
  s_waitcnt lgkmcnt(4)
  v_mfma_f32_16x16x32_bf16 v[48:51], v[188:191], a[100:103], v[48:51]
  s_waitcnt lgkmcnt(3)
  v_mfma_f32_16x16x32_bf16 v[48:51], v[192:195], a[104:107], v[48:51]
  s_waitcnt lgkmcnt(2)
  v_mfma_f32_16x16x32_bf16 v[48:51], v[196:199], a[108:111], v[48:51]
  s_waitcnt lgkmcnt(1)
  v_mfma_f32_16x16x32_bf16 v[48:51], v[200:203], a[112:115], v[48:51]
  s_waitcnt lgkmcnt(0)
  v_mfma_f32_16x16x32_bf16 v[48:51], v[204:207], a[116:119], v[48:51]
  s_cmp_eq_u32 s12, 3
  s_cbranch_scc1 reca_swave202
  s_nop 5
  ds_write_b128 v17, v[48:51]
  s_add_u32 s34, s17, 2
  s_and_b32 s34, s34, 3
  s_mul_i32 s26, s34, 10240
  s_add_u32 s26, s26, s38
  s_mul_i32 s27, s34, 6144
  s_add_u32 s27, s27, s39
  s_mul_i32 s28, s34, 12288
  s_add_u32 s28, s28, s40
  s_mul_i32 s29, s34, 393216
  s_add_u32 s29, s29, s56
  s_waitcnt lgkmcnt(0)
  s_barrier
  s_cmp_eq_u32 s17, 63
  s_cbranch_scc1 reca_last204
  buffer_store_dwordx2 v[32:33], v8, s[4:7], s27 offen sc1
  s_cmp_lg_u32 s12, 2
  s_cbranch_scc1 reca_tw1208_n
  buffer_store_dwordx2 v[52:53], v9, s[4:7], s30 offen sc1
reca_tw1208_n:
  s_barrier
  s_cmp_eq_u32 s12, 1
  s_cbranch_scc1 reca_tw1208
  s_cmp_eq_u32 s12, 2
  s_cbranch_scc1 reca_tw2209
  s_cmp_lt_u32 s17, 2
  s_cbranch_scc1 reca_b5207
  s_cmp_gt_u32 s17, 61
  s_cbranch_scc1 reca_b5207
  s_sub_u32 s36, s17, 2
  s_lshl_b32 s34, s59, 6
  s_add_u32 s34, s34, s36
  s_mul_i32 s34, s34, 12288
  s_add_u32 s23, s34, 37748736
  s_add_u32 s60, s34, 88080384
  s_lshl_b32 s35, s36, 5
  s_add_u32 s35, s35, s59
  s_mul_i32 s35, s35, 3072
  s_add_u32 s61, s35, 113246208
  buffer_load_dwordx4 a[120:123], v1, s[4:7], s23 offen offset:0 sc1
  buffer_load_dwordx4 a[124:127], v1, s[4:7], s23 offen offset:1024 sc1
  buffer_load_dwordx4 a[128:131], v1, s[4:7], s23 offen offset:2048 sc1
  buffer_load_dwordx4 a[132:135], v1, s[4:7], s23 offen offset:3072 sc1
  buffer_load_dwordx4 a[136:139], v2, s[4:7], s23 offen offset:0 sc1
  buffer_load_dwordx4 a[140:143], v2, s[4:7], s23 offen offset:1024 sc1
  buffer_load_dwordx4 a[144:147], v2, s[4:7], s23 offen offset:2048 sc1
  buffer_load_dwordx4 a[148:151], v2, s[4:7], s23 offen offset:3072 sc1
  buffer_load_dwordx4 a[152:155], v3, s[4:7], s23 offen offset:0 sc1
  buffer_load_dwordx4 a[156:159], v3, s[4:7], s23 offen offset:1024 sc1
  buffer_load_dwordx4 a[160:163], v3, s[4:7], s23 offen offset:2048 sc1
  buffer_load_dwordx4 a[164:167], v3, s[4:7], s23 offen offset:3072 sc1
  buffer_load_dwordx4 a[216:219], v92, s[4:7], s61 offen offset:0 sc1
  buffer_load_dwordx4 a[220:223], v92, s[4:7], s61 offen offset:512 sc1
  buffer_load_dwordx4 a[224:227], v92, s[4:7], s61 offen offset:1024 sc1
  buffer_load_dwordx4 a[228:231], v92, s[4:7], s61 offen offset:1536 sc1
  buffer_load_dwordx4 a[232:235], v92, s[4:7], s61 offen offset:2048 sc1
  buffer_load_dwordx4 a[236:239], v92, s[4:7], s61 offen offset:2560 sc1
  buffer_load_dwordx4 a[168:171], v1, s[4:7], s60 offen offset:0 sc1
  buffer_load_dwordx4 a[172:175], v1, s[4:7], s60 offen offset:1024 sc1
  buffer_load_dwordx4 a[176:179], v1, s[4:7], s60 offen offset:2048 sc1
  buffer_load_dwordx4 a[180:183], v1, s[4:7], s60 offen offset:3072 sc1
  buffer_load_dwordx4 a[184:187], v2, s[4:7], s60 offen offset:0 sc1
  buffer_load_dwordx4 a[188:191], v2, s[4:7], s60 offen offset:1024 sc1
  buffer_load_dwordx4 a[192:195], v2, s[4:7], s60 offen offset:2048 sc1
  buffer_load_dwordx4 a[196:199], v2, s[4:7], s60 offen offset:3072 sc1
  buffer_load_dwordx4 a[200:203], v3, s[4:7], s60 offen offset:0 sc1
  buffer_load_dwordx4 a[204:207], v3, s[4:7], s60 offen offset:1024 sc1
  buffer_load_dwordx4 a[208:211], v3, s[4:7], s60 offen offset:2048 sc1
  buffer_load_dwordx4 a[212:215], v3, s[4:7], s60 offen offset:3072 sc1
  s_waitcnt vmcnt(5)
  v_mfma_f32_16x16x32_bf16 v[128:131], a[216:219], a[168:171], v[84:87]
  v_mfma_f32_16x16x32_bf16 v[132:135], a[120:123], a[168:171], v[88:91]
  v_mfma_f32_16x16x32_bf16 v[136:139], a[216:219], a[192:195], v[84:87]
  v_mfma_f32_16x16x32_bf16 v[140:143], a[120:123], a[192:195], 0
  v_mfma_f32_16x16x32_bf16 v[144:147], a[144:147], a[192:195], v[88:91]
  s_waitcnt vmcnt(4)
  v_mfma_f32_16x16x32_bf16 v[128:131], a[220:223], a[172:175], v[128:131]
  v_mfma_f32_16x16x32_bf16 v[132:135], a[124:127], a[172:175], v[132:135]
  v_mfma_f32_16x16x32_bf16 v[136:139], a[220:223], a[196:199], v[136:139]
  v_mfma_f32_16x16x32_bf16 v[140:143], a[124:127], a[196:199], v[140:143]
  v_mfma_f32_16x16x32_bf16 v[144:147], a[148:151], a[196:199], v[144:147]
  s_waitcnt vmcnt(3)
  v_mfma_f32_16x16x32_bf16 v[128:131], a[224:227], a[176:179], v[128:131]
  v_mfma_f32_16x16x32_bf16 v[132:135], a[128:131], a[176:179], v[132:135]
  v_mfma_f32_16x16x32_bf16 v[136:139], a[224:227], a[200:203], v[136:139]
  v_mfma_f32_16x16x32_bf16 v[140:143], a[128:131], a[200:203], v[140:143]
  v_mfma_f32_16x16x32_bf16 v[144:147], a[152:155], a[200:203], v[144:147]
  s_waitcnt vmcnt(2)
  v_mfma_f32_16x16x32_bf16 v[128:131], a[228:231], a[180:183], v[128:131]
  v_mfma_f32_16x16x32_bf16 v[132:135], a[132:135], a[180:183], v[132:135]
  v_mfma_f32_16x16x32_bf16 v[136:139], a[228:231], a[204:207], v[136:139]
  v_mfma_f32_16x16x32_bf16 v[140:143], a[132:135], a[204:207], v[140:143]
  v_mfma_f32_16x16x32_bf16 v[144:147], a[156:159], a[204:207], v[144:147]
  s_waitcnt vmcnt(1)
  v_mfma_f32_16x16x32_bf16 v[128:131], a[232:235], a[184:187], v[128:131]
  v_mfma_f32_16x16x32_bf16 v[132:135], a[136:139], a[184:187], v[132:135]
  v_mfma_f32_16x16x32_bf16 v[136:139], a[232:235], a[208:211], v[136:139]
  v_mfma_f32_16x16x32_bf16 v[140:143], a[136:139], a[208:211], v[140:143]
  v_mfma_f32_16x16x32_bf16 v[144:147], a[160:163], a[208:211], v[144:147]
  s_waitcnt vmcnt(0)
  v_mfma_f32_16x16x32_bf16 v[128:131], a[236:239], a[188:191], v[128:131]
  v_mfma_f32_16x16x32_bf16 v[132:135], a[140:143], a[188:191], v[132:135]
  v_mfma_f32_16x16x32_bf16 v[136:139], a[236:239], a[212:215], v[136:139]
  v_mfma_f32_16x16x32_bf16 v[140:143], a[140:143], a[212:215], v[140:143]
  v_mfma_f32_16x16x32_bf16 v[144:147], a[164:167], a[212:215], v[144:147]
  s_nop 3
  v_max3_f32 v28, v128, v129, v130
  v_max3_f32 v28, v28, v131, v132
  v_max3_f32 v28, v28, v133, v134
  v_max_f32 v28, v28, v135
  v_mov_b32 v29, v28
  s_nop 1
  v_permlane32_swap_b32 v28, v29
  v_max_f32 v28, v28, v29
  v_mov_b32 v29, v28
  s_nop 1
  v_permlane16_swap_b32 v28, v29
  v_max_f32 v28, v28, v29
  v_mul_f32 v28, s41, v28
  v_fma_f32 v128, v128, s41, -v28
  v_fma_f32 v129, v129, s41, -v28
  v_fma_f32 v130, v130, s41, -v28
  v_fma_f32 v131, v131, s41, -v28
  v_fma_f32 v132, v132, s41, -v28
  v_fma_f32 v133, v133, s41, -v28
  v_fma_f32 v134, v134, s41, -v28
  v_fma_f32 v135, v135, s41, -v28
  v_exp_f32 v128, v128
  v_exp_f32 v129, v129
  v_exp_f32 v130, v130
  v_exp_f32 v131, v131
  v_exp_f32 v132, v132
  v_exp_f32 v133, v133
  v_exp_f32 v134, v134
  v_exp_f32 v135, v135
  v_max3_f32 v30, v136, v137, v138
  v_max3_f32 v30, v30, v139, v140
  v_max3_f32 v30, v30, v141, v142
  v_max3_f32 v30, v30, v143, v144
  v_max3_f32 v30, v30, v145, v146
  v_max_f32 v30, v30, v147
  v_mov_b32 v29, v30
  s_nop 1
  v_permlane32_swap_b32 v30, v29
  v_max_f32 v30, v30, v29
  v_mov_b32 v29, v30
  s_nop 1
  v_permlane16_swap_b32 v30, v29
  v_max_f32 v30, v30, v29
  v_mul_f32 v30, s41, v30
  v_fma_f32 v136, v136, s41, -v30
  v_fma_f32 v137, v137, s41, -v30
  v_fma_f32 v138, v138, s41, -v30
  v_fma_f32 v139, v139, s41, -v30
  v_fma_f32 v140, v140, s41, -v30
  v_fma_f32 v141, v141, s41, -v30
  v_fma_f32 v142, v142, s41, -v30
  v_fma_f32 v143, v143, s41, -v30
  v_fma_f32 v144, v144, s41, -v30
  v_fma_f32 v145, v145, s41, -v30
  v_fma_f32 v146, v146, s41, -v30
  v_fma_f32 v147, v147, s41, -v30
  v_exp_f32 v136, v136
  v_exp_f32 v137, v137
  v_exp_f32 v138, v138
  v_exp_f32 v139, v139
  v_exp_f32 v140, v140
  v_exp_f32 v141, v141
  v_exp_f32 v142, v142
  v_exp_f32 v143, v143
  v_exp_f32 v144, v144
  v_exp_f32 v145, v145
  v_exp_f32 v146, v146
  v_exp_f32 v147, v147
  v_cvt_pk_bf16_f32 v72, v128, v129
  v_cvt_pk_bf16_f32 v73, v130, v131
  v_cvt_pk_bf16_f32 v74, v132, v133
  v_cvt_pk_bf16_f32 v75, v134, v135
  v_cvt_pk_bf16_f32 v76, v136, v137
  v_cvt_pk_bf16_f32 v77, v138, v139
  v_cvt_pk_bf16_f32 v78, v140, v141
  v_cvt_pk_bf16_f32 v79, v142, v143
  v_cvt_pk_bf16_f32 v80, v144, v145
  v_cvt_pk_bf16_f32 v81, v146, v147
  v_mfma_f32_16x16x16_bf16 v[148:151], v[36:37], v[72:73], 0
  v_mfma_f32_16x16x16_bf16 v[152:155], v[36:37], v[76:77], 0
  v_mfma_f32_16x16x16_bf16 v[148:151], v[36:37], v[74:75], v[148:151]
  v_mfma_f32_16x16x32_bf16 v[152:155], v[36:39], v[78:81], v[152:155]
  s_nop 6
  v_rcp_f32 v82, v148
  v_rcp_f32 v83, v152
  s_and_b32 s34, s17, 1
  s_mul_i32 s34, s34, 3072
  v_add_u32 v28, s34, v1
  ds_write_b128 v28, v[72:75] offset:16384
  ds_write_b128 v28, v[76:79] offset:17408
  ds_write_b128 v28, v[80:83] offset:18432
  s_waitcnt lgkmcnt(0)
  s_branch reca_b5207
reca_tw1208:
  s_cmp_lt_u32 s17, 3
  s_cbranch_scc1 reca_b5207
  s_sub_u32 s36, s17, 3
  s_lshl_b32 s34, s59, 6
  s_add_u32 s34, s34, s36
  s_mul_i32 s34, s34, 12288
  s_add_u32 s23, s34, 62914560
  s_lshl_b32 s35, s36, 5
  s_add_u32 s35, s35, s59
  s_mul_i32 s35, s35, 3072
  s_add_u32 s61, s35, 119537664
  s_mul_i32 s34, s36, 393216
  s_mul_i32 s35, s59, 6144
  s_add_u32 s34, s34, s35
  s_add_u32 s60, s34, 125829120
  s_add_u32 s34, s17, 1
  s_and_b32 s34, s34, 1
  s_mul_i32 s34, s34, 3072
  v_add_u32 v28, s34, v1
  ds_read_b128 v[72:75], v28 offset:16384
  ds_read_b128 v[76:79], v28 offset:17408
  ds_read_b128 v[80:83], v28 offset:18432
  buffer_load_dwordx2 a[168:169], v93, s[4:7], s61 offen offset:0 sc1
  buffer_load_dwordx4 a[120:123], v1, s[4:7], s23 offen offset:0 sc1
  buffer_load_dwordx2 a[170:171], v93, s[4:7], s61 offen offset:256 sc1
  buffer_load_dwordx4 a[124:127], v1, s[4:7], s23 offen offset:1024 sc1
  buffer_load_dwordx2 a[172:173], v93, s[4:7], s61 offen offset:512 sc1
  buffer_load_dwordx4 a[128:131], v1, s[4:7], s23 offen offset:2048 sc1
  buffer_load_dwordx2 a[174:175], v93, s[4:7], s61 offen offset:768 sc1
  buffer_load_dwordx4 a[132:135], v1, s[4:7], s23 offen offset:3072 sc1
  buffer_load_dwordx2 a[176:177], v93, s[4:7], s61 offen offset:1024 sc1
  buffer_load_dwordx4 a[136:139], v2, s[4:7], s23 offen offset:0 sc1
  buffer_load_dwordx2 a[178:179], v93, s[4:7], s61 offen offset:1280 sc1
  buffer_load_dwordx4 a[140:143], v2, s[4:7], s23 offen offset:1024 sc1
  s_waitcnt lgkmcnt(0)
  s_waitcnt vmcnt(8)
  v_mfma_f32_16x16x16_bf16 v[156:159], a[168:169], v[72:73], 0
  v_mfma_f32_16x16x16_bf16 v[160:163], a[168:169], v[76:77], 0
  v_mfma_f32_16x16x16_bf16 v[156:159], a[120:121], v[74:75], v[156:159]
  v_mfma_f32_16x16x32_bf16 v[160:163], a[120:123], v[78:81], v[160:163]
  v_mfma_f32_16x16x16_bf16 v[164:167], a[170:171], v[72:73], 0
  v_mfma_f32_16x16x16_bf16 v[168:171], a[170:171], v[76:77], 0
  v_mfma_f32_16x16x16_bf16 v[164:167], a[124:125], v[74:75], v[164:167]
  v_mfma_f32_16x16x32_bf16 v[168:171], a[124:127], v[78:81], v[168:171]
  s_nop 2
  v_mul_f32 v156, v156, v82
  v_mul_f32 v157, v157, v82
  v_mul_f32 v158, v158, v82
  v_mul_f32 v159, v159, v82
  v_cvt_pk_bf16_f32 v172, v156, v157
  v_cvt_pk_bf16_f32 v173, v158, v159
  v_mul_f32 v164, v164, v82
  v_mul_f32 v165, v165, v82
  v_mul_f32 v166, v166, v82
  v_mul_f32 v167, v167, v82
  v_cvt_pk_bf16_f32 v174, v164, v165
  v_cvt_pk_bf16_f32 v175, v166, v167
  buffer_store_dwordx4 v[172:175], v1, s[4:7], s60 offen offset:0
  v_mul_f32 v160, v160, v83
  v_mul_f32 v161, v161, v83
  v_mul_f32 v162, v162, v83
  v_mul_f32 v163, v163, v83
  v_cvt_pk_bf16_f32 v176, v160, v161
  v_cvt_pk_bf16_f32 v177, v162, v163
  v_mul_f32 v168, v168, v83
  v_mul_f32 v169, v169, v83
  v_mul_f32 v170, v170, v83
  v_mul_f32 v171, v171, v83
  v_cvt_pk_bf16_f32 v178, v168, v169
  v_cvt_pk_bf16_f32 v179, v170, v171
  s_add_u32 s34, s60, 196608
  buffer_store_dwordx4 v[176:179], v1, s[4:7], s34 offen offset:0
  s_waitcnt vmcnt(6)
  v_mfma_f32_16x16x16_bf16 v[156:159], a[172:173], v[72:73], 0
  v_mfma_f32_16x16x16_bf16 v[160:163], a[172:173], v[76:77], 0
  v_mfma_f32_16x16x16_bf16 v[156:159], a[128:129], v[74:75], v[156:159]
  v_mfma_f32_16x16x32_bf16 v[160:163], a[128:131], v[78:81], v[160:163]
  v_mfma_f32_16x16x16_bf16 v[164:167], a[174:175], v[72:73], 0
  v_mfma_f32_16x16x16_bf16 v[168:171], a[174:175], v[76:77], 0
  v_mfma_f32_16x16x16_bf16 v[164:167], a[132:133], v[74:75], v[164:167]
  v_mfma_f32_16x16x32_bf16 v[168:171], a[132:135], v[78:81], v[168:171]
  s_nop 2
  v_mul_f32 v156, v156, v82
  v_mul_f32 v157, v157, v82
  v_mul_f32 v158, v158, v82
  v_mul_f32 v159, v159, v82
  v_cvt_pk_bf16_f32 v172, v156, v157
  v_cvt_pk_bf16_f32 v173, v158, v159
  v_mul_f32 v164, v164, v82
  v_mul_f32 v165, v165, v82
  v_mul_f32 v166, v166, v82
  v_mul_f32 v167, v167, v82
  v_cvt_pk_bf16_f32 v174, v164, v165
  v_cvt_pk_bf16_f32 v175, v166, v167
  buffer_store_dwordx4 v[172:175], v1, s[4:7], s60 offen offset:1024
  v_mul_f32 v160, v160, v83
  v_mul_f32 v161, v161, v83
  v_mul_f32 v162, v162, v83
  v_mul_f32 v163, v163, v83
  v_cvt_pk_bf16_f32 v176, v160, v161
  v_cvt_pk_bf16_f32 v177, v162, v163
  v_mul_f32 v168, v168, v83
  v_mul_f32 v169, v169, v83
  v_mul_f32 v170, v170, v83
  v_mul_f32 v171, v171, v83
  v_cvt_pk_bf16_f32 v178, v168, v169
  v_cvt_pk_bf16_f32 v179, v170, v171
  s_add_u32 s34, s60, 196608
  buffer_store_dwordx4 v[176:179], v1, s[4:7], s34 offen offset:1024
  s_waitcnt vmcnt(4)
  v_mfma_f32_16x16x16_bf16 v[156:159], a[176:177], v[72:73], 0
  v_mfma_f32_16x16x16_bf16 v[160:163], a[176:177], v[76:77], 0
  v_mfma_f32_16x16x16_bf16 v[156:159], a[136:137], v[74:75], v[156:159]
  v_mfma_f32_16x16x32_bf16 v[160:163], a[136:139], v[78:81], v[160:163]
  v_mfma_f32_16x16x16_bf16 v[164:167], a[178:179], v[72:73], 0
  v_mfma_f32_16x16x16_bf16 v[168:171], a[178:179], v[76:77], 0
  v_mfma_f32_16x16x16_bf16 v[164:167], a[140:141], v[74:75], v[164:167]
  v_mfma_f32_16x16x32_bf16 v[168:171], a[140:143], v[78:81], v[168:171]
  s_nop 2
  v_mul_f32 v156, v156, v82
  v_mul_f32 v157, v157, v82
  v_mul_f32 v158, v158, v82
  v_mul_f32 v159, v159, v82
  v_cvt_pk_bf16_f32 v172, v156, v157
  v_cvt_pk_bf16_f32 v173, v158, v159
  v_mul_f32 v164, v164, v82
  v_mul_f32 v165, v165, v82
  v_mul_f32 v166, v166, v82
  v_mul_f32 v167, v167, v82
  v_cvt_pk_bf16_f32 v174, v164, v165
  v_cvt_pk_bf16_f32 v175, v166, v167
  buffer_store_dwordx4 v[172:175], v1, s[4:7], s60 offen offset:2048
  v_mul_f32 v160, v160, v83
  v_mul_f32 v161, v161, v83
  v_mul_f32 v162, v162, v83
  v_mul_f32 v163, v163, v83
  v_cvt_pk_bf16_f32 v176, v160, v161
  v_cvt_pk_bf16_f32 v177, v162, v163
  v_mul_f32 v168, v168, v83
  v_mul_f32 v169, v169, v83
  v_mul_f32 v170, v170, v83
  v_mul_f32 v171, v171, v83
  v_cvt_pk_bf16_f32 v178, v168, v169
  v_cvt_pk_bf16_f32 v179, v170, v171
  s_add_u32 s34, s60, 196608
  buffer_store_dwordx4 v[176:179], v1, s[4:7], s34 offen offset:2048
  s_branch reca_b5207
reca_tw2209:
  s_cmp_lt_u32 s17, 3
  s_cbranch_scc1 reca_b5207
  s_sub_u32 s36, s17, 3
  s_lshl_b32 s34, s59, 6
  s_add_u32 s34, s34, s36
  s_mul_i32 s34, s34, 12288
  s_add_u32 s23, s34, 62914560
  s_lshl_b32 s35, s36, 5
  s_add_u32 s35, s35, s59
  s_mul_i32 s35, s35, 3072
  s_add_u32 s61, s35, 119537664
  s_mul_i32 s34, s36, 393216
  s_mul_i32 s35, s59, 6144
  s_add_u32 s34, s34, s35
  s_add_u32 s60, s34, 125829120
  s_add_u32 s34, s17, 1
  s_and_b32 s34, s34, 1
  s_mul_i32 s34, s34, 3072
  v_add_u32 v28, s34, v1
  ds_read_b128 v[72:75], v28 offset:16384
  ds_read_b128 v[76:79], v28 offset:17408
  ds_read_b128 v[80:83], v28 offset:18432
  buffer_load_dwordx2 a[180:181], v93, s[4:7], s61 offen offset:1536 sc1
  buffer_load_dwordx4 a[144:147], v2, s[4:7], s23 offen offset:2048 sc1
  buffer_load_dwordx2 a[182:183], v93, s[4:7], s61 offen offset:1792 sc1
  buffer_load_dwordx4 a[148:151], v2, s[4:7], s23 offen offset:3072 sc1
  buffer_load_dwordx2 a[184:185], v93, s[4:7], s61 offen offset:2048 sc1
  buffer_load_dwordx4 a[152:155], v3, s[4:7], s23 offen offset:0 sc1
  buffer_load_dwordx2 a[186:187], v93, s[4:7], s61 offen offset:2304 sc1
  buffer_load_dwordx4 a[156:159], v3, s[4:7], s23 offen offset:1024 sc1
  buffer_load_dwordx2 a[188:189], v93, s[4:7], s61 offen offset:2560 sc1
  buffer_load_dwordx4 a[160:163], v3, s[4:7], s23 offen offset:2048 sc1
  buffer_load_dwordx2 a[190:191], v93, s[4:7], s61 offen offset:2816 sc1
  buffer_load_dwordx4 a[164:167], v3, s[4:7], s23 offen offset:3072 sc1
  s_waitcnt lgkmcnt(0)
  s_waitcnt vmcnt(8)
  v_mfma_f32_16x16x16_bf16 v[156:159], a[180:181], v[72:73], 0
  v_mfma_f32_16x16x16_bf16 v[160:163], a[180:181], v[76:77], 0
  v_mfma_f32_16x16x16_bf16 v[156:159], a[144:145], v[74:75], v[156:159]
  v_mfma_f32_16x16x32_bf16 v[160:163], a[144:147], v[78:81], v[160:163]
  v_mfma_f32_16x16x16_bf16 v[164:167], a[182:183], v[72:73], 0
  v_mfma_f32_16x16x16_bf16 v[168:171], a[182:183], v[76:77], 0
  v_mfma_f32_16x16x16_bf16 v[164:167], a[148:149], v[74:75], v[164:167]
  v_mfma_f32_16x16x32_bf16 v[168:171], a[148:151], v[78:81], v[168:171]
  s_nop 2
  v_mul_f32 v156, v156, v82
  v_mul_f32 v157, v157, v82
  v_mul_f32 v158, v158, v82
  v_mul_f32 v159, v159, v82
  v_cvt_pk_bf16_f32 v172, v156, v157
  v_cvt_pk_bf16_f32 v173, v158, v159
  v_mul_f32 v164, v164, v82
  v_mul_f32 v165, v165, v82
  v_mul_f32 v166, v166, v82
  v_mul_f32 v167, v167, v82
  v_cvt_pk_bf16_f32 v174, v164, v165
  v_cvt_pk_bf16_f32 v175, v166, v167
  buffer_store_dwordx4 v[172:175], v1, s[4:7], s60 offen offset:3072
  v_mul_f32 v160, v160, v83
  v_mul_f32 v161, v161, v83
  v_mul_f32 v162, v162, v83
  v_mul_f32 v163, v163, v83
  v_cvt_pk_bf16_f32 v176, v160, v161
  v_cvt_pk_bf16_f32 v177, v162, v163
  v_mul_f32 v168, v168, v83
  v_mul_f32 v169, v169, v83
  v_mul_f32 v170, v170, v83
  v_mul_f32 v171, v171, v83
  v_cvt_pk_bf16_f32 v178, v168, v169
  v_cvt_pk_bf16_f32 v179, v170, v171
  s_add_u32 s34, s60, 196608
  buffer_store_dwordx4 v[176:179], v1, s[4:7], s34 offen offset:3072
  s_waitcnt vmcnt(6)
  v_mfma_f32_16x16x16_bf16 v[156:159], a[184:185], v[72:73], 0
  v_mfma_f32_16x16x16_bf16 v[160:163], a[184:185], v[76:77], 0
  v_mfma_f32_16x16x16_bf16 v[156:159], a[152:153], v[74:75], v[156:159]
  v_mfma_f32_16x16x32_bf16 v[160:163], a[152:155], v[78:81], v[160:163]
  v_mfma_f32_16x16x16_bf16 v[164:167], a[186:187], v[72:73], 0
  v_mfma_f32_16x16x16_bf16 v[168:171], a[186:187], v[76:77], 0
  v_mfma_f32_16x16x16_bf16 v[164:167], a[156:157], v[74:75], v[164:167]
  v_mfma_f32_16x16x32_bf16 v[168:171], a[156:159], v[78:81], v[168:171]
  s_nop 2
  v_mul_f32 v156, v156, v82
  v_mul_f32 v157, v157, v82
  v_mul_f32 v158, v158, v82
  v_mul_f32 v159, v159, v82
  v_cvt_pk_bf16_f32 v172, v156, v157
  v_cvt_pk_bf16_f32 v173, v158, v159
  v_mul_f32 v164, v164, v82
  v_mul_f32 v165, v165, v82
  v_mul_f32 v166, v166, v82
  v_mul_f32 v167, v167, v82
  v_cvt_pk_bf16_f32 v174, v164, v165
  v_cvt_pk_bf16_f32 v175, v166, v167
  buffer_store_dwordx4 v[172:175], v2, s[4:7], s60 offen offset:0
  v_mul_f32 v160, v160, v83
  v_mul_f32 v161, v161, v83
  v_mul_f32 v162, v162, v83
  v_mul_f32 v163, v163, v83
  v_cvt_pk_bf16_f32 v176, v160, v161
  v_cvt_pk_bf16_f32 v177, v162, v163
  v_mul_f32 v168, v168, v83
  v_mul_f32 v169, v169, v83
  v_mul_f32 v170, v170, v83
  v_mul_f32 v171, v171, v83
  v_cvt_pk_bf16_f32 v178, v168, v169
  v_cvt_pk_bf16_f32 v179, v170, v171
  s_add_u32 s34, s60, 196608
  buffer_store_dwordx4 v[176:179], v2, s[4:7], s34 offen offset:0
  s_waitcnt vmcnt(4)
  v_mfma_f32_16x16x16_bf16 v[156:159], a[188:189], v[72:73], 0
  v_mfma_f32_16x16x16_bf16 v[160:163], a[188:189], v[76:77], 0
  v_mfma_f32_16x16x16_bf16 v[156:159], a[160:161], v[74:75], v[156:159]
  v_mfma_f32_16x16x32_bf16 v[160:163], a[160:163], v[78:81], v[160:163]
  v_mfma_f32_16x16x16_bf16 v[164:167], a[190:191], v[72:73], 0
  v_mfma_f32_16x16x16_bf16 v[168:171], a[190:191], v[76:77], 0
  v_mfma_f32_16x16x16_bf16 v[164:167], a[164:165], v[74:75], v[164:167]
  v_mfma_f32_16x16x32_bf16 v[168:171], a[164:167], v[78:81], v[168:171]
  s_nop 2
  v_mul_f32 v156, v156, v82
  v_mul_f32 v157, v157, v82
  v_mul_f32 v158, v158, v82
  v_mul_f32 v159, v159, v82
  v_cvt_pk_bf16_f32 v172, v156, v157
  v_cvt_pk_bf16_f32 v173, v158, v159
  v_mul_f32 v164, v164, v82
  v_mul_f32 v165, v165, v82
  v_mul_f32 v166, v166, v82
  v_mul_f32 v167, v167, v82
  v_cvt_pk_bf16_f32 v174, v164, v165
  v_cvt_pk_bf16_f32 v175, v166, v167
  buffer_store_dwordx4 v[172:175], v2, s[4:7], s60 offen offset:1024
  v_mul_f32 v160, v160, v83
  v_mul_f32 v161, v161, v83
  v_mul_f32 v162, v162, v83
  v_mul_f32 v163, v163, v83
  v_cvt_pk_bf16_f32 v176, v160, v161
  v_cvt_pk_bf16_f32 v177, v162, v163
  v_mul_f32 v168, v168, v83
  v_mul_f32 v169, v169, v83
  v_mul_f32 v170, v170, v83
  v_mul_f32 v171, v171, v83
  v_cvt_pk_bf16_f32 v178, v168, v169
  v_cvt_pk_bf16_f32 v179, v170, v171
  s_add_u32 s34, s60, 196608
  buffer_store_dwordx4 v[176:179], v2, s[4:7], s34 offen offset:1024
  s_branch reca_b5207
  s_cmp_lg_u32 s12, 2
  s_cbranch_scc1 reca_b3205
  buffer_store_dwordx2 v[52:53], v9, s[4:7], s30 offen sc1
  buffer_store_dwordx2 v[32:33], v16, s[4:7], s26 offen sc1
  s_cmp_lg_u32 s14, 0
  s_cbranch_scc1 reca_b3205
  v_mov_b32 v28, s17
  s_lshl_b32 s34, s13, 7
  s_add_u32 s34, s34, 1507328
  buffer_store_dword v28, v19, s[4:7], s34 offen sc1
  s_branch reca_b3205
reca_last204:
  s_cmp_lg_u32 s12, 2
  s_cbranch_scc1 reca_exit1
  buffer_store_dwordx2 v[52:53], v9, s[4:7], s30 offen
  s_branch reca_exit1
reca_swave202:
  s_cmp_lg_u32 s17, 63
  s_cbranch_scc1 reca_vmst210
  s_barrier
  ds_read_b128 v[56:59], v1 offset:10240
  ds_read_b128 v[60:63], v1 offset:11264
  ds_read_b128 v[64:67], v1 offset:12288
  s_waitcnt lgkmcnt(0)
  v_add_f32 v56, v56, v64
  v_add_f32 v60, v60, v48
  v_add_f32 v57, v57, v65
  v_add_f32 v61, v61, v49
  v_add_f32 v58, v58, v66
  v_add_f32 v62, v62, v50
  v_add_f32 v59, v59, v67
  v_add_f32 v63, v63, v51
  v_cvt_pk_bf16_f32 v68, v56, v57
  v_cvt_pk_bf16_f32 v69, v58, v59
  v_cvt_pk_bf16_f32 v70, v60, v61
  v_cvt_pk_bf16_f32 v71, v62, v63
  buffer_store_dwordx2 v[52:53], v9, s[4:7], s30 offen
  buffer_store_dwordx2 v[68:69], v10, s[4:7], s31 offen
  buffer_store_dwordx2 v[70:71], v10, s[4:7], s31 offen offset:256
  s_branch reca_exit1
reca_vmst210:
  s_sleep 1
  buffer_load_dwordx4 v[208:211], v1, s[4:7], s21 offen offset:0 sc1
  buffer_load_dwordx4 v[212:215], v1, s[4:7], s21 offen offset:1024 sc1
  buffer_load_dwordx4 v[216:219], v1, s[4:7], s21 offen offset:2048 sc1
  buffer_load_dwordx4 v[220:223], v1, s[4:7], s21 offen offset:3072 sc1
  buffer_load_dwordx4 v[224:227], v2, s[4:7], s21 offen offset:0 sc1
  buffer_load_dwordx4 v[228:231], v2, s[4:7], s21 offen offset:1024 sc1
  s_waitcnt vmcnt(5)
  v_max_u32 v29, v208, v210
  v_cmp_eq_u32 vcc, -1, v29
  s_cbranch_vccnz reca_retry211
reca_resume212:
  s_waitcnt vmcnt(4)
  v_max_u32 v29, v212, v214
  v_cmp_eq_u32 vcc, -1, v29
  v_mfma_f32_16x16x32_bf16 v[76:79], a[120:123], v[208:211], 0
  v_mfma_f32_16x16x32_bf16 v[80:83], a[144:147], v[208:211], 0
  v_mfma_f32_16x16x32_bf16 v[72:75], v[208:211], v[208:211], v[40:43]
  s_cbranch_vccnz reca_retry213
reca_resume214:
  s_waitcnt vmcnt(3)
  v_max_u32 v29, v216, v218
  v_cmp_eq_u32 vcc, -1, v29
  v_mfma_f32_16x16x32_bf16 v[76:79], a[124:127], v[212:215], v[76:79]
  v_mfma_f32_16x16x32_bf16 v[80:83], a[148:151], v[212:215], v[80:83]
  v_mfma_f32_16x16x32_bf16 v[72:75], v[212:215], v[212:215], v[72:75]
  s_cbranch_vccnz reca_retry215
reca_resume216:
  s_waitcnt vmcnt(2)
  v_max_u32 v29, v220, v222
  v_cmp_eq_u32 vcc, -1, v29
  v_mfma_f32_16x16x32_bf16 v[76:79], a[128:131], v[216:219], v[76:79]
  v_mfma_f32_16x16x32_bf16 v[80:83], a[152:155], v[216:219], v[80:83]
  v_mfma_f32_16x16x32_bf16 v[72:75], v[216:219], v[216:219], v[72:75]
  s_cbranch_vccnz reca_retry217
reca_resume218:
  s_waitcnt vmcnt(1)
  v_max_u32 v29, v224, v226
  v_cmp_eq_u32 vcc, -1, v29
  v_mfma_f32_16x16x32_bf16 v[76:79], a[132:135], v[220:223], v[76:79]
  v_mfma_f32_16x16x32_bf16 v[80:83], a[156:159], v[220:223], v[80:83]
  v_mfma_f32_16x16x32_bf16 v[72:75], v[220:223], v[220:223], v[72:75]
  s_cbranch_vccnz reca_retry219
reca_resume220:
  s_waitcnt vmcnt(0)
  v_max_u32 v29, v228, v230
  v_cmp_eq_u32 vcc, -1, v29
  v_mfma_f32_16x16x32_bf16 v[76:79], a[136:139], v[224:227], v[76:79]
  v_mfma_f32_16x16x32_bf16 v[80:83], a[160:163], v[224:227], v[80:83]
  v_mfma_f32_16x16x32_bf16 v[72:75], v[224:227], v[224:227], v[72:75]
  s_cbranch_vccnz reca_retry221
reca_resume222:
  v_mfma_f32_16x16x32_bf16 v[76:79], a[140:143], v[228:231], v[76:79]
  v_mfma_f32_16x16x32_bf16 v[80:83], a[164:167], v[228:231], v[80:83]
  v_mfma_f32_16x16x32_bf16 v[72:75], v[228:231], v[228:231], v[72:75]
  s_barrier
  ds_read_b128 v[56:59], v1 offset:10240
  ds_read_b128 v[60:63], v1 offset:11264
  ds_read_b128 v[64:67], v1 offset:12288
  s_nop 1
  v_max3_f32 v28, v76, v77, v78
  v_max3_f32 v29, v80, v81, v82
  v_max3_f32 v28, v28, v79, v83
  v_max3_f32 v29, v29, v72, v73
  v_max3_f32 v28, v28, v74, v75
  v_max_f32 v28, v28, v29
  v_mov_b32 v29, v28
  s_nop 1
  v_permlane32_swap_b32 v28, v29
  v_max_f32 v28, v28, v29
  v_mov_b32 v29, v28
  s_nop 1
  v_permlane16_swap_b32 v28, v29
  v_max_f32 v28, v28, v29
  v_mul_f32 v28, s41, v28
  v_fma_f32 v76, v76, s41, -v28
  v_fma_f32 v77, v77, s41, -v28
  v_fma_f32 v78, v78, s41, -v28
  v_fma_f32 v79, v79, s41, -v28
  v_fma_f32 v80, v80, s41, -v28
  v_fma_f32 v81, v81, s41, -v28
  v_fma_f32 v82, v82, s41, -v28
  v_fma_f32 v83, v83, s41, -v28
  v_fma_f32 v72, v72, s41, -v28
  v_fma_f32 v73, v73, s41, -v28
  v_fma_f32 v74, v74, s41, -v28
  v_fma_f32 v75, v75, s41, -v28
  v_exp_f32 v76, v76
  v_exp_f32 v77, v77
  v_exp_f32 v78, v78
  v_exp_f32 v79, v79
  v_exp_f32 v80, v80
  v_exp_f32 v81, v81
  v_exp_f32 v82, v82
  v_exp_f32 v83, v83
  v_cvt_pk_bf16_f32 v84, v76, v77
  v_cvt_pk_bf16_f32 v85, v78, v79
  v_cvt_pk_bf16_f32 v86, v80, v81
  v_cvt_pk_bf16_f32 v87, v82, v83
  v_exp_f32 v72, v72
  v_exp_f32 v73, v73
  v_mfma_f32_16x16x32_bf16 v[100:103], v[36:39], v[84:87], 0
  v_exp_f32 v74, v74
  v_exp_f32 v75, v75
  v_mfma_f32_16x16x32_bf16 v[92:95], a[168:171], v[84:87], 0
  v_cvt_pk_bf16_f32 v88, v72, v73
  v_cvt_pk_bf16_f32 v89, v74, v75
  v_mfma_f32_16x16x32_bf16 v[96:99], a[172:175], v[84:87], 0
  s_waitcnt lgkmcnt(0)
  v_mfma_f32_16x16x16_bf16 v[100:103], v[36:37], v[88:89], v[100:103]
  v_add_f32 v56, v56, v64
  v_add_f32 v60, v60, v48
  v_add_f32 v57, v57, v65
  v_add_f32 v61, v61, v49
  v_add_f32 v58, v58, v66
  v_add_f32 v62, v62, v50
  v_add_f32 v59, v59, v67
  v_add_f32 v63, v63, v51
  v_cvt_pk_bf16_f32 v68, v56, v57
  v_cvt_pk_bf16_f32 v69, v58, v59
  v_cvt_pk_bf16_f32 v70, v60, v61
  v_cvt_pk_bf16_f32 v71, v62, v63
  v_mfma_f32_16x16x16_bf16 v[92:95], v[68:69], v[88:89], v[92:95]
  v_rcp_f32 v28, v100
  v_mfma_f32_16x16x16_bf16 v[96:99], v[70:71], v[88:89], v[96:99]
  v_mov_b32 v29, v28
  s_nop 4
  v_pk_mul_f32 v[92:93], v[92:93], v[28:29]
  v_pk_mul_f32 v[94:95], v[94:95], v[28:29]
  v_pk_mul_f32 v[96:97], v[96:97], v[28:29]
  v_pk_mul_f32 v[98:99], v[98:99], v[28:29]
  v_cvt_pk_bf16_f32 v104, v92, v93
  v_cvt_pk_bf16_f32 v105, v94, v95
  v_cvt_pk_bf16_f32 v106, v96, v97
  v_cvt_pk_bf16_f32 v107, v98, v99
  buffer_store_dwordx4 v[104:107], v11, s[4:7], s22 offen sc1
  s_barrier
  s_add_u32 s34, s17, 2
  s_and_b32 s34, s34, 3
  s_mul_i32 s26, s34, 10240
  s_add_u32 s26, s26, s38
  s_mul_i32 s27, s34, 6144
  s_add_u32 s27, s27, s39
  s_mul_i32 s28, s34, 12288
  s_add_u32 s28, s28, s40
  s_mul_i32 s29, s34, 393216
  s_add_u32 s29, s29, s56
  buffer_store_dwordx2 v[32:33], v8, s[4:7], s27 offen sc1
  buffer_store_dwordx4 v[32:35], v11, s[4:7], s28 offen sc1
  s_add_u32 s36, s17, 1
  s_cmp_ge_u32 s36, 63
  s_cbranch_scc1 reca_nopf223
  s_add_u32 s37, s36, 1
reca_pf224:
  buffer_load_dword v28, v233, s[4:7], 0 offen sc1
  s_waitcnt vmcnt(0)
  v_cmp_gt_i32 vcc, s37, v28
  s_cbranch_vccz reca_pfok225
  s_sleep 1
  s_sub_u32 s18, s18, 1
  s_cbranch_scc0 reca_pf224
  s_mov_b32 s18, 0
reca_pfok225:
  s_lshl_b32 s34, s15, 6
  s_add_u32 s34, s34, s36
  s_mul_i32 s34, s34, 12288
  s_add_u32 s32, s34, 37748736
  s_lshl_b32 s35, s16, 11
  s_add_u32 s34, s34, s35
  s_add_u32 s33, s34, 62914560
  buffer_load_dwordx4 a[120:123], v1, s[4:7], s32 offen offset:0 sc1
  buffer_load_dwordx4 a[124:127], v1, s[4:7], s32 offen offset:1024 sc1
  buffer_load_dwordx4 a[128:131], v1, s[4:7], s32 offen offset:2048 sc1
  buffer_load_dwordx4 a[132:135], v1, s[4:7], s32 offen offset:3072 sc1
  buffer_load_dwordx4 a[136:139], v2, s[4:7], s32 offen offset:0 sc1
  buffer_load_dwordx4 a[140:143], v2, s[4:7], s32 offen offset:1024 sc1
  buffer_load_dwordx4 a[144:147], v2, s[4:7], s32 offen offset:2048 sc1
  buffer_load_dwordx4 a[148:151], v2, s[4:7], s32 offen offset:3072 sc1
  buffer_load_dwordx4 a[152:155], v3, s[4:7], s32 offen offset:0 sc1
  buffer_load_dwordx4 a[156:159], v3, s[4:7], s32 offen offset:1024 sc1
  buffer_load_dwordx4 a[160:163], v3, s[4:7], s32 offen offset:2048 sc1
  buffer_load_dwordx4 a[164:167], v3, s[4:7], s32 offen offset:3072 sc1
  buffer_load_dwordx4 a[168:171], v1, s[4:7], s33 offen offset:0 sc1
  buffer_load_dwordx4 a[172:175], v1, s[4:7], s33 offen offset:1024 sc1
reca_nopf223:
  buffer_store_dwordx2 v[52:53], v9, s[4:7], s30 offen sc1
  buffer_store_dwordx2 v[68:69], v10, s[4:7], s31 offen sc1
  buffer_store_dwordx2 v[70:71], v10, s[4:7], s31 offen offset:256 sc1
reca_b5207:
  s_barrier
  s_add_u32 s17, s17, 1
  s_branch reca_step193
reca_b3205:
  s_endpgm
reca_retry196:
  s_sub_u32 s18, s18, 1
  s_cbranch_scc1 reca_retry196_to
  buffer_load_dwordx4 v[128:131], v4, s[4:7], s20 offen sc1
  buffer_load_dwordx4 v[132:135], v4, s[4:7], s20 offen offset:1024 sc1
  buffer_load_dwordx4 v[136:139], v5, s[4:7], s20 offen sc1
  s_waitcnt vmcnt(2)
  v_max_u32 v29, v128, v130
  v_cmp_eq_u32 vcc, -1, v29
  s_cbranch_vccnz reca_retry196
  s_branch reca_resume197
reca_retry196_to:
  s_mov_b32 s18, 0
  s_waitcnt vmcnt(0)
  s_branch reca_resume197
reca_retry198:
  s_sub_u32 s18, s18, 1
  s_cbranch_scc1 reca_retry198_to
  buffer_load_dwordx4 v[132:135], v4, s[4:7], s20 offen offset:1024 sc1
  buffer_load_dwordx4 v[136:139], v5, s[4:7], s20 offen sc1
  s_waitcnt vmcnt(1)
  v_max_u32 v29, v132, v134
  v_cmp_eq_u32 vcc, -1, v29
  s_cbranch_vccnz reca_retry198
  s_branch reca_resume199
reca_retry198_to:
  s_mov_b32 s18, 0
  s_waitcnt vmcnt(0)
  s_branch reca_resume199
reca_retry200:
  s_sub_u32 s18, s18, 1
  s_cbranch_scc1 reca_retry200_to
  buffer_load_dwordx4 v[136:139], v5, s[4:7], s20 offen sc1
  s_waitcnt vmcnt(0)
  v_max_u32 v29, v136, v138
  v_cmp_eq_u32 vcc, -1, v29
  s_cbranch_vccnz reca_retry200
  s_branch reca_resume201
reca_retry200_to:
  s_mov_b32 s18, 0
  s_waitcnt vmcnt(0)
  s_branch reca_resume201
reca_retry211:
  s_sub_u32 s18, s18, 1
  s_cbranch_scc1 reca_retry211_to
  buffer_load_dwordx4 v[208:211], v1, s[4:7], s21 offen offset:0 sc1
  buffer_load_dwordx4 v[212:215], v1, s[4:7], s21 offen offset:1024 sc1
  buffer_load_dwordx4 v[216:219], v1, s[4:7], s21 offen offset:2048 sc1
  buffer_load_dwordx4 v[220:223], v1, s[4:7], s21 offen offset:3072 sc1
  buffer_load_dwordx4 v[224:227], v2, s[4:7], s21 offen offset:0 sc1
  buffer_load_dwordx4 v[228:231], v2, s[4:7], s21 offen offset:1024 sc1
  s_waitcnt vmcnt(5)
  v_max_u32 v29, v208, v210
  v_cmp_eq_u32 vcc, -1, v29
  s_cbranch_vccnz reca_retry211
  s_branch reca_resume212
reca_retry211_to:
  s_mov_b32 s18, 0
  s_waitcnt vmcnt(0)
  s_branch reca_resume212
reca_retry213:
  s_sub_u32 s18, s18, 1
  s_cbranch_scc1 reca_retry213_to
  buffer_load_dwordx4 v[212:215], v1, s[4:7], s21 offen offset:1024 sc1
  buffer_load_dwordx4 v[216:219], v1, s[4:7], s21 offen offset:2048 sc1
  buffer_load_dwordx4 v[220:223], v1, s[4:7], s21 offen offset:3072 sc1
  buffer_load_dwordx4 v[224:227], v2, s[4:7], s21 offen offset:0 sc1
  buffer_load_dwordx4 v[228:231], v2, s[4:7], s21 offen offset:1024 sc1
  s_waitcnt vmcnt(4)
  v_max_u32 v29, v212, v214
  v_cmp_eq_u32 vcc, -1, v29
  s_cbranch_vccnz reca_retry213
  s_branch reca_resume214
reca_retry213_to:
  s_mov_b32 s18, 0
  s_waitcnt vmcnt(0)
  s_branch reca_resume214
reca_retry215:
  s_sub_u32 s18, s18, 1
  s_cbranch_scc1 reca_retry215_to
  buffer_load_dwordx4 v[216:219], v1, s[4:7], s21 offen offset:2048 sc1
  buffer_load_dwordx4 v[220:223], v1, s[4:7], s21 offen offset:3072 sc1
  buffer_load_dwordx4 v[224:227], v2, s[4:7], s21 offen offset:0 sc1
  buffer_load_dwordx4 v[228:231], v2, s[4:7], s21 offen offset:1024 sc1
  s_waitcnt vmcnt(3)
  v_max_u32 v29, v216, v218
  v_cmp_eq_u32 vcc, -1, v29
  s_cbranch_vccnz reca_retry215
  s_branch reca_resume216
reca_retry215_to:
  s_mov_b32 s18, 0
  s_waitcnt vmcnt(0)
  s_branch reca_resume216
reca_retry217:
  s_sub_u32 s18, s18, 1
  s_cbranch_scc1 reca_retry217_to
  buffer_load_dwordx4 v[220:223], v1, s[4:7], s21 offen offset:3072 sc1
  buffer_load_dwordx4 v[224:227], v2, s[4:7], s21 offen offset:0 sc1
  buffer_load_dwordx4 v[228:231], v2, s[4:7], s21 offen offset:1024 sc1
  s_waitcnt vmcnt(2)
  v_max_u32 v29, v220, v222
  v_cmp_eq_u32 vcc, -1, v29
  s_cbranch_vccnz reca_retry217
  s_branch reca_resume218
reca_retry217_to:
  s_mov_b32 s18, 0
  s_waitcnt vmcnt(0)
  s_branch reca_resume218
reca_retry219:
  s_sub_u32 s18, s18, 1
  s_cbranch_scc1 reca_retry219_to
  buffer_load_dwordx4 v[224:227], v2, s[4:7], s21 offen offset:0 sc1
  buffer_load_dwordx4 v[228:231], v2, s[4:7], s21 offen offset:1024 sc1
  s_waitcnt vmcnt(1)
  v_max_u32 v29, v224, v226
  v_cmp_eq_u32 vcc, -1, v29
  s_cbranch_vccnz reca_retry219
  s_branch reca_resume220
reca_retry219_to:
  s_mov_b32 s18, 0
  s_waitcnt vmcnt(0)
  s_branch reca_resume220
reca_retry221:
  s_sub_u32 s18, s18, 1
  s_cbranch_scc1 reca_retry221_to
  buffer_load_dwordx4 v[228:231], v2, s[4:7], s21 offen offset:1024 sc1
  s_waitcnt vmcnt(0)
  v_max_u32 v29, v228, v230
  v_cmp_eq_u32 vcc, -1, v29
  s_cbranch_vccnz reca_retry221
  s_branch reca_resume222
reca_retry221_to:
  s_mov_b32 s18, 0
  s_waitcnt vmcnt(0)
  s_branch reca_resume222
reca_proj2:
  s_sub_u32 s34, s14, 24
  s_lshr_b32 s35, s34, 1
  s_and_b32 s16, s34, 1
  s_lshl_b32 s15, s13, 2
  s_add_u32 s15, s15, s35
  s_lshl_b32 s24, s13, 3
  s_add_u32 s24, s24, s34
  s_lshl_b32 s24, s24, 7
  s_add_u32 s24, s24, 1540096
  s_lshl_b32 s25, s13, 7
  s_add_u32 s25, s25, 1507328
  v_and_b32 v28, 63, v0
  v_lshlrev_b32 v1, 4, v28
  v_mov_b32 v29, 0x80000000
  v_cmp_eq_u32 vcc, 0, v28
  v_mov_b32 v4, 0
  s_nop 0
  v_cndmask_b32 v4, v29, v4, vcc
  s_cmp_eq_u32 s12, 0
  s_cbranch_scc1 reca_pw0_226
  s_cmp_eq_u32 s12, 1
  s_cbranch_scc1 reca_pw1_227
  s_cmp_eq_u32 s12, 2
  s_cbranch_scc1 reca_pw2_228
  s_branch reca_pw3_229
reca_pw0_226:
  s_mov_b32 s17, 0
  s_mov_b32 s26, 0
  s_mul_i32 s20, s17, 40960
  s_add_u32 s20, s20, 153616384
  s_add_u32 m0, s26, 0
  s_nop 0
  buffer_load_dwordx4 v1, s[4:7], s20 offen offset:0 lds
  buffer_load_dwordx4 v1, s[4:7], s20 offen offset:1024 lds
  buffer_load_dwordx4 v1, s[4:7], s20 offen offset:2048 lds
  buffer_load_dwordx4 v1, s[4:7], s20 offen offset:3072 lds
  s_add_u32 s20, s20, 4096
  s_add_u32 m0, s26, 4096
  s_nop 0
  buffer_load_dwordx4 v1, s[4:7], s20 offen offset:0 lds
  buffer_load_dwordx4 v1, s[4:7], s20 offen offset:1024 lds
  buffer_load_dwordx4 v1, s[4:7], s20 offen offset:2048 lds
  buffer_load_dwordx4 v1, s[4:7], s20 offen offset:3072 lds
  s_add_u32 s20, s20, 4096
  s_add_u32 m0, s26, 8192
  s_nop 0
  buffer_load_dwordx4 v1, s[4:7], s20 offen offset:0 lds
  buffer_load_dwordx4 v1, s[4:7], s20 offen offset:1024 lds
  s_lshl_b32 s34, s15, 6
  s_add_u32 s34, s34, s17
  s_mul_i32 s34, s34, 12288
  s_mul_i32 s35, s16, 3072
  s_add_u32 s35, s35, s34
  s_add_u32 s27, s35, 37748736
  s_mul_i32 s35, s16, 6144
  s_add_u32 s35, s35, s34
  s_add_u32 s28, s35, 62914560
  s_add_u32 s34, s27, 0
  buffer_load_dwordx4 v[16:19], v1, s[4:7], s34 offen sc1
  s_add_u32 s34, s27, 6144
  buffer_load_dwordx4 v[16:19], v1, s[4:7], s34 offen sc1
  s_add_u32 s34, s27, 1024
  buffer_load_dwordx4 v[16:19], v1, s[4:7], s34 offen sc1
  s_add_u32 s34, s27, 7168
  buffer_load_dwordx4 v[16:19], v1, s[4:7], s34 offen sc1
  s_add_u32 s34, s28, 0
  buffer_load_dwordx4 v[16:19], v1, s[4:7], s34 offen sc1
  s_mul_i32 s34, s15, 12
  s_mul_i32 s35, s16, 6
  s_add_u32 s34, s34, s35
  s_add_u32 s34, s34, 0
  s_mul_i32 s34, s34, 20480
  s_add_u32 s34, s34, 14155776
  buffer_load_dwordx4 a[0:3], v1, s[4:7], s34 offen offset:0
  buffer_load_dwordx4 a[4:7], v1, s[4:7], s34 offen offset:1024
  buffer_load_dwordx4 a[8:11], v1, s[4:7], s34 offen offset:2048
  buffer_load_dwordx4 a[12:15], v1, s[4:7], s34 offen offset:3072
  s_add_u32 s34, s34, 4096
  buffer_load_dwordx4 a[16:19], v1, s[4:7], s34 offen offset:0
  buffer_load_dwordx4 a[20:23], v1, s[4:7], s34 offen offset:1024
  buffer_load_dwordx4 a[24:27], v1, s[4:7], s34 offen offset:2048
  buffer_load_dwordx4 a[28:31], v1, s[4:7], s34 offen offset:3072
  s_add_u32 s34, s34, 4096
  buffer_load_dwordx4 a[32:35], v1, s[4:7], s34 offen offset:0
  buffer_load_dwordx4 a[36:39], v1, s[4:7], s34 offen offset:1024
  buffer_load_dwordx4 a[40:43], v1, s[4:7], s34 offen offset:2048
  buffer_load_dwordx4 a[44:47], v1, s[4:7], s34 offen offset:3072
  s_add_u32 s34, s34, 4096
  buffer_load_dwordx4 a[48:51], v1, s[4:7], s34 offen offset:0
  buffer_load_dwordx4 a[52:55], v1, s[4:7], s34 offen offset:1024
  buffer_load_dwordx4 a[56:59], v1, s[4:7], s34 offen offset:2048
  buffer_load_dwordx4 a[60:63], v1, s[4:7], s34 offen offset:3072
  s_add_u32 s34, s34, 4096
  buffer_load_dwordx4 a[64:67], v1, s[4:7], s34 offen offset:0
  buffer_load_dwordx4 a[68:71], v1, s[4:7], s34 offen offset:1024
  buffer_load_dwordx4 a[72:75], v1, s[4:7], s34 offen offset:2048
  buffer_load_dwordx4 a[76:79], v1, s[4:7], s34 offen offset:3072
  s_mul_i32 s34, s15, 12
  s_mul_i32 s35, s16, 6
  s_add_u32 s34, s34, s35
  s_add_u32 s34, s34, 1
  s_mul_i32 s34, s34, 20480
  s_add_u32 s34, s34, 14155776
  buffer_load_dwordx4 a[80:83], v1, s[4:7], s34 offen offset:0
  buffer_load_dwordx4 a[84:87], v1, s[4:7], s34 offen offset:1024
  buffer_load_dwordx4 a[88:91], v1, s[4:7], s34 offen offset:2048
  buffer_load_dwordx4 a[92:95], v1, s[4:7], s34 offen offset:3072
  s_add_u32 s34, s34, 4096
  buffer_load_dwordx4 a[96:99], v1, s[4:7], s34 offen offset:0
  buffer_load_dwordx4 a[100:103], v1, s[4:7], s34 offen offset:1024
  buffer_load_dwordx4 a[104:107], v1, s[4:7], s34 offen offset:2048
  buffer_load_dwordx4 a[108:111], v1, s[4:7], s34 offen offset:3072
  s_add_u32 s34, s34, 4096
  buffer_load_dwordx4 a[112:115], v1, s[4:7], s34 offen offset:0
  buffer_load_dwordx4 a[116:119], v1, s[4:7], s34 offen offset:1024
  buffer_load_dwordx4 a[120:123], v1, s[4:7], s34 offen offset:2048
  buffer_load_dwordx4 a[124:127], v1, s[4:7], s34 offen offset:3072
  s_add_u32 s34, s34, 4096
  buffer_load_dwordx4 a[128:131], v1, s[4:7], s34 offen offset:0
  buffer_load_dwordx4 a[132:135], v1, s[4:7], s34 offen offset:1024
  buffer_load_dwordx4 a[136:139], v1, s[4:7], s34 offen offset:2048
  buffer_load_dwordx4 a[140:143], v1, s[4:7], s34 offen offset:3072
  s_add_u32 s34, s34, 4096
  buffer_load_dwordx4 a[144:147], v1, s[4:7], s34 offen offset:0
  buffer_load_dwordx4 a[148:151], v1, s[4:7], s34 offen offset:1024
  buffer_load_dwordx4 a[152:155], v1, s[4:7], s34 offen offset:2048
  buffer_load_dwordx4 a[156:159], v1, s[4:7], s34 offen offset:3072
  s_waitcnt vmcnt(20)
  s_mul_i32 s34, s15, 12
  s_mul_i32 s35, s16, 6
  s_add_u32 s34, s34, s35
  s_add_u32 s34, s34, 2
  s_mul_i32 s34, s34, 20480
  s_add_u32 s34, s34, 14155776
  buffer_load_dwordx4 a[160:163], v1, s[4:7], s34 offen offset:0
  buffer_load_dwordx4 a[164:167], v1, s[4:7], s34 offen offset:1024
  buffer_load_dwordx4 a[168:171], v1, s[4:7], s34 offen offset:2048
  buffer_load_dwordx4 a[172:175], v1, s[4:7], s34 offen offset:3072
  s_add_u32 s34, s34, 4096
  buffer_load_dwordx4 a[176:179], v1, s[4:7], s34 offen offset:0
  buffer_load_dwordx4 a[180:183], v1, s[4:7], s34 offen offset:1024
  buffer_load_dwordx4 a[184:187], v1, s[4:7], s34 offen offset:2048
  buffer_load_dwordx4 a[188:191], v1, s[4:7], s34 offen offset:3072
  s_add_u32 s34, s34, 4096
  buffer_load_dwordx4 a[192:195], v1, s[4:7], s34 offen offset:0
  buffer_load_dwordx4 a[196:199], v1, s[4:7], s34 offen offset:1024
  buffer_load_dwordx4 a[200:203], v1, s[4:7], s34 offen offset:2048
  buffer_load_dwordx4 a[204:207], v1, s[4:7], s34 offen offset:3072
  s_add_u32 s34, s34, 4096
  buffer_load_dwordx4 a[208:211], v1, s[4:7], s34 offen offset:0
  buffer_load_dwordx4 a[212:215], v1, s[4:7], s34 offen offset:1024
  buffer_load_dwordx4 a[216:219], v1, s[4:7], s34 offen offset:2048
  buffer_load_dwordx4 a[220:223], v1, s[4:7], s34 offen offset:3072
  s_add_u32 s34, s34, 4096
  buffer_load_dwordx4 a[224:227], v1, s[4:7], s34 offen offset:0
  buffer_load_dwordx4 a[228:231], v1, s[4:7], s34 offen offset:1024
  buffer_load_dwordx4 a[232:235], v1, s[4:7], s34 offen offset:2048
  buffer_load_dwordx4 a[236:239], v1, s[4:7], s34 offen offset:3072
  s_waitcnt vmcnt(20)
  s_mul_i32 s34, s15, 12
  s_mul_i32 s35, s16, 6
  s_add_u32 s34, s34, s35
  s_add_u32 s34, s34, 3
  s_mul_i32 s34, s34, 20480
  s_add_u32 s34, s34, 14155776
  buffer_load_dwordx4 v[96:99], v1, s[4:7], s34 offen offset:0
  buffer_load_dwordx4 v[100:103], v1, s[4:7], s34 offen offset:1024
  buffer_load_dwordx4 v[104:107], v1, s[4:7], s34 offen offset:2048
  buffer_load_dwordx4 v[108:111], v1, s[4:7], s34 offen offset:3072
  s_add_u32 s34, s34, 4096
  buffer_load_dwordx4 v[112:115], v1, s[4:7], s34 offen offset:0
  buffer_load_dwordx4 v[116:119], v1, s[4:7], s34 offen offset:1024
  buffer_load_dwordx4 v[120:123], v1, s[4:7], s34 offen offset:2048
  buffer_load_dwordx4 v[124:127], v1, s[4:7], s34 offen offset:3072
  s_add_u32 s34, s34, 4096
  buffer_load_dwordx4 v[128:131], v1, s[4:7], s34 offen offset:0
  buffer_load_dwordx4 v[132:135], v1, s[4:7], s34 offen offset:1024
  buffer_load_dwordx4 v[136:139], v1, s[4:7], s34 offen offset:2048
  buffer_load_dwordx4 v[140:143], v1, s[4:7], s34 offen offset:3072
  s_add_u32 s34, s34, 4096
  buffer_load_dwordx4 v[144:147], v1, s[4:7], s34 offen offset:0
  buffer_load_dwordx4 v[148:151], v1, s[4:7], s34 offen offset:1024
  buffer_load_dwordx4 v[152:155], v1, s[4:7], s34 offen offset:2048
  buffer_load_dwordx4 v[156:159], v1, s[4:7], s34 offen offset:3072
  s_add_u32 s34, s34, 4096
  buffer_load_dwordx4 v[160:163], v1, s[4:7], s34 offen offset:0
  buffer_load_dwordx4 v[164:167], v1, s[4:7], s34 offen offset:1024
  buffer_load_dwordx4 v[168:171], v1, s[4:7], s34 offen offset:2048
  buffer_load_dwordx4 v[172:175], v1, s[4:7], s34 offen offset:3072
  s_waitcnt vmcnt(20)
  s_mul_i32 s34, s15, 12
  s_mul_i32 s35, s16, 6
  s_add_u32 s34, s34, s35
  s_add_u32 s34, s34, 0
  s_mul_i32 s34, s34, 20480
  s_add_u32 s34, s34, 22020096
  buffer_load_dwordx4 v[176:179], v1, s[4:7], s34 offen offset:0
  buffer_load_dwordx4 v[180:183], v1, s[4:7], s34 offen offset:1024
  buffer_load_dwordx4 v[184:187], v1, s[4:7], s34 offen offset:2048
  buffer_load_dwordx4 v[188:191], v1, s[4:7], s34 offen offset:3072
  s_add_u32 s34, s34, 4096
  buffer_load_dwordx4 v[192:195], v1, s[4:7], s34 offen offset:0
  buffer_load_dwordx4 v[196:199], v1, s[4:7], s34 offen offset:1024
  buffer_load_dwordx4 v[200:203], v1, s[4:7], s34 offen offset:2048
  buffer_load_dwordx4 v[204:207], v1, s[4:7], s34 offen offset:3072
  s_add_u32 s34, s34, 4096
  buffer_load_dwordx4 v[208:211], v1, s[4:7], s34 offen offset:0
  buffer_load_dwordx4 v[212:215], v1, s[4:7], s34 offen offset:1024
  buffer_load_dwordx4 v[216:219], v1, s[4:7], s34 offen offset:2048
  buffer_load_dwordx4 v[220:223], v1, s[4:7], s34 offen offset:3072
  s_add_u32 s34, s34, 4096
  buffer_load_dwordx4 v[224:227], v1, s[4:7], s34 offen offset:0
  buffer_load_dwordx4 v[228:231], v1, s[4:7], s34 offen offset:1024
  buffer_load_dwordx4 v[232:235], v1, s[4:7], s34 offen offset:2048
  buffer_load_dwordx4 v[236:239], v1, s[4:7], s34 offen offset:3072
  s_add_u32 s34, s34, 4096
  buffer_load_dwordx4 v[240:243], v1, s[4:7], s34 offen offset:0
  buffer_load_dwordx4 v[244:247], v1, s[4:7], s34 offen offset:1024
  buffer_load_dwordx4 v[248:251], v1, s[4:7], s34 offen offset:2048
  buffer_load_dwordx4 v[252:255], v1, s[4:7], s34 offen offset:3072
  s_waitcnt vmcnt(20)
  v_and_b32 v30, 7, v0
  v_lshlrev_b32 v30, 3, v30
reca_cens230:
  buffer_load_dwordx2 v[28:29], v30, s[8:11], 0 offen sc1
  s_waitcnt vmcnt(0)
  v_sad_u8 v31, v28, 0, 0
  v_sad_u8 v31, v29, 0, v31
  v_cmp_gt_u32 vcc, 32, v31
  s_cbranch_vccz reca_censok231
  s_sleep 8
  s_sub_u32 s18, s18, 1
  s_cbranch_scc0 reca_cens230
  s_mov_b32 s18, 0
reca_censok231:
  v_and_b32 v28, 0x20202020, v28
  v_and_b32 v29, 0x20202020, v29
  v_cmp_ne_u32 s[34:35], 0, v28
  v_cmp_ne_u32 s[36:37], 0, v29
  s_nop 3
  s_and_b32 s34, s34, 0xff
  s_and_b32 s36, s36, 0xff
  s_or_b32 s35, s34, s36
  s_lshr_b32 s37, s35, s13
  s_and_b32 s37, s37, 1
  s_xor_b32 s43, s37, 1
  s_cmp_eq_u32 s57, 0
  s_cselect_b32 s58, s36, s34
  v_mov_b32 v31, 0x80000000
  s_cmp_lg_u32 s43, 0
  s_cbranch_scc1 reca_pslow232
reca_ptop233:
  s_cmp_lt_u32 s17, 6
  s_cbranch_scc1 reca_pgo234
  s_sub_u32 s36, s17, 6
reca_ppoll235:
  buffer_load_dword v28, v4, s[4:7], s25 offen sc1
  s_waitcnt vmcnt(0)
  v_readfirstlane_b32 s34, v28
  s_nop 3
  s_cmp_ge_i32 s34, s36
  s_cbranch_scc1 reca_pgo234
  s_sleep 8
  s_sub_u32 s18, s18, 1
  s_cbranch_scc0 reca_ppoll235
  s_mov_b32 s18, 0
reca_pgo234:
  s_waitcnt vmcnt(0)
  s_barrier
  v_add_u32 v7, s26, v1
  s_xor_b32 s26, s26, 40960
  s_add_u32 s37, s17, 1
  s_cmp_ge_u32 s37, 64
  s_cbranch_scc1 reca_pnodma236
  s_mul_i32 s20, s37, 40960
  s_add_u32 s20, s20, 153616384
  s_add_u32 m0, s26, 0
  s_nop 0
  buffer_load_dwordx4 v1, s[4:7], s20 offen offset:0 lds
  buffer_load_dwordx4 v1, s[4:7], s20 offen offset:1024 lds
  buffer_load_dwordx4 v1, s[4:7], s20 offen offset:2048 lds
  buffer_load_dwordx4 v1, s[4:7], s20 offen offset:3072 lds
  s_add_u32 s20, s20, 4096
  s_add_u32 m0, s26, 4096
  s_nop 0
  buffer_load_dwordx4 v1, s[4:7], s20 offen offset:0 lds
  buffer_load_dwordx4 v1, s[4:7], s20 offen offset:1024 lds
  buffer_load_dwordx4 v1, s[4:7], s20 offen offset:2048 lds
  buffer_load_dwordx4 v1, s[4:7], s20 offen offset:3072 lds
  s_add_u32 s20, s20, 4096
  s_add_u32 m0, s26, 8192
  s_nop 0
  buffer_load_dwordx4 v1, s[4:7], s20 offen offset:0 lds
  buffer_load_dwordx4 v1, s[4:7], s20 offen offset:1024 lds
  s_lshl_b32 s34, s15, 6
  s_add_u32 s34, s34, s37
  s_mul_i32 s34, s34, 12288
  s_mul_i32 s35, s16, 3072
  s_add_u32 s35, s35, s34
  s_add_u32 s27, s35, 37748736
  s_mul_i32 s35, s16, 6144
  s_add_u32 s35, s35, s34
  s_add_u32 s28, s35, 62914560
  s_add_u32 s34, s27, 0
  buffer_load_dwordx4 v[16:19], v1, s[4:7], s34 offen sc1
  s_add_u32 s34, s27, 6144
  buffer_load_dwordx4 v[16:19], v1, s[4:7], s34 offen sc1
  s_add_u32 s34, s27, 1024
  buffer_load_dwordx4 v[16:19], v1, s[4:7], s34 offen sc1
  s_add_u32 s34, s27, 7168
  buffer_load_dwordx4 v[16:19], v1, s[4:7], s34 offen sc1
  s_add_u32 s34, s28, 0
  buffer_load_dwordx4 v[16:19], v1, s[4:7], s34 offen sc1
reca_pnodma236:
  s_lshl_b32 s34, s15, 6
  s_add_u32 s34, s34, s17
  s_mul_i32 s34, s34, 12288
  s_mul_i32 s35, s16, 3072
  s_add_u32 s35, s35, s34
  s_add_u32 s21, s35, 37748736
  s_add_u32 s22, s35, 88080384
  s_mul_i32 s35, s16, 6144
  s_add_u32 s35, s35, s34
  s_add_u32 s23, s35, 62914560
  ds_read_b128 v[72:75], v7 offset:0
  ds_read_b128 v[76:79], v7 offset:20480
  ds_read_b128 v[80:83], v7 offset:1024
  ds_read_b128 v[84:87], v7 offset:21504
  ds_read_b128 v[88:91], v7 offset:2048
  ds_read_b128 v[92:95], v7 offset:22528
  s_waitcnt lgkmcnt(4)
  v_mfma_f32_16x16x32_bf16 v[32:35], a[0:3], v[72:75], 0
  v_mfma_f32_16x16x32_bf16 v[36:39], a[0:3], v[76:79], 0
  v_mfma_f32_16x16x32_bf16 v[40:43], a[80:83], v[72:75], 0
  v_mfma_f32_16x16x32_bf16 v[44:47], a[80:83], v[76:79], 0
  v_mfma_f32_16x16x32_bf16 v[48:51], a[160:163], v[72:75], 0
  v_mfma_f32_16x16x32_bf16 v[52:55], a[160:163], v[76:79], 0
  v_mfma_f32_16x16x32_bf16 v[56:59], v[96:99], v[72:75], 0
  v_mfma_f32_16x16x32_bf16 v[60:63], v[96:99], v[76:79], 0
  v_mfma_f32_16x16x32_bf16 v[64:67], v[72:75], v[176:179], 0
  v_mfma_f32_16x16x32_bf16 v[68:71], v[76:79], v[176:179], 0
  ds_read_b128 v[72:75], v7 offset:3072
  ds_read_b128 v[76:79], v7 offset:23552
  s_waitcnt lgkmcnt(4)
  v_mfma_f32_16x16x32_bf16 v[32:35], a[4:7], v[80:83], v[32:35]
  v_mfma_f32_16x16x32_bf16 v[36:39], a[4:7], v[84:87], v[36:39]
  v_mfma_f32_16x16x32_bf16 v[40:43], a[84:87], v[80:83], v[40:43]
  v_mfma_f32_16x16x32_bf16 v[44:47], a[84:87], v[84:87], v[44:47]
  v_mfma_f32_16x16x32_bf16 v[48:51], a[164:167], v[80:83], v[48:51]
  v_mfma_f32_16x16x32_bf16 v[52:55], a[164:167], v[84:87], v[52:55]
  v_mfma_f32_16x16x32_bf16 v[56:59], v[100:103], v[80:83], v[56:59]
  v_mfma_f32_16x16x32_bf16 v[60:63], v[100:103], v[84:87], v[60:63]
  v_mfma_f32_16x16x32_bf16 v[64:67], v[80:83], v[180:183], v[64:67]
  v_mfma_f32_16x16x32_bf16 v[68:71], v[84:87], v[180:183], v[68:71]
  ds_read_b128 v[80:83], v7 offset:4096
  ds_read_b128 v[84:87], v7 offset:24576
  s_waitcnt lgkmcnt(4)
  v_mfma_f32_16x16x32_bf16 v[32:35], a[8:11], v[88:91], v[32:35]
  v_mfma_f32_16x16x32_bf16 v[36:39], a[8:11], v[92:95], v[36:39]
  v_mfma_f32_16x16x32_bf16 v[40:43], a[88:91], v[88:91], v[40:43]
  v_mfma_f32_16x16x32_bf16 v[44:47], a[88:91], v[92:95], v[44:47]
  v_mfma_f32_16x16x32_bf16 v[48:51], a[168:171], v[88:91], v[48:51]
  v_mfma_f32_16x16x32_bf16 v[52:55], a[168:171], v[92:95], v[52:55]
  v_mfma_f32_16x16x32_bf16 v[56:59], v[104:107], v[88:91], v[56:59]
  v_mfma_f32_16x16x32_bf16 v[60:63], v[104:107], v[92:95], v[60:63]
  v_mfma_f32_16x16x32_bf16 v[64:67], v[88:91], v[184:187], v[64:67]
  v_mfma_f32_16x16x32_bf16 v[68:71], v[92:95], v[184:187], v[68:71]
  ds_read_b128 v[88:91], v7 offset:5120
  ds_read_b128 v[92:95], v7 offset:25600
  s_waitcnt lgkmcnt(4)
  v_mfma_f32_16x16x32_bf16 v[32:35], a[12:15], v[72:75], v[32:35]
  v_mfma_f32_16x16x32_bf16 v[36:39], a[12:15], v[76:79], v[36:39]
  v_mfma_f32_16x16x32_bf16 v[40:43], a[92:95], v[72:75], v[40:43]
  v_mfma_f32_16x16x32_bf16 v[44:47], a[92:95], v[76:79], v[44:47]
  v_mfma_f32_16x16x32_bf16 v[48:51], a[172:175], v[72:75], v[48:51]
  v_mfma_f32_16x16x32_bf16 v[52:55], a[172:175], v[76:79], v[52:55]
  v_mfma_f32_16x16x32_bf16 v[56:59], v[108:111], v[72:75], v[56:59]
  v_mfma_f32_16x16x32_bf16 v[60:63], v[108:111], v[76:79], v[60:63]
  v_mfma_f32_16x16x32_bf16 v[64:67], v[72:75], v[188:191], v[64:67]
  v_mfma_f32_16x16x32_bf16 v[68:71], v[76:79], v[188:191], v[68:71]
  ds_read_b128 v[72:75], v7 offset:6144
  ds_read_b128 v[76:79], v7 offset:26624
  s_waitcnt lgkmcnt(4)
  v_mfma_f32_16x16x32_bf16 v[32:35], a[16:19], v[80:83], v[32:35]
  v_mfma_f32_16x16x32_bf16 v[36:39], a[16:19], v[84:87], v[36:39]
  v_mfma_f32_16x16x32_bf16 v[40:43], a[96:99], v[80:83], v[40:43]
  v_mfma_f32_16x16x32_bf16 v[44:47], a[96:99], v[84:87], v[44:47]
  v_mfma_f32_16x16x32_bf16 v[48:51], a[176:179], v[80:83], v[48:51]
  v_mfma_f32_16x16x32_bf16 v[52:55], a[176:179], v[84:87], v[52:55]
  v_mfma_f32_16x16x32_bf16 v[56:59], v[112:115], v[80:83], v[56:59]
  v_mfma_f32_16x16x32_bf16 v[60:63], v[112:115], v[84:87], v[60:63]
  v_mfma_f32_16x16x32_bf16 v[64:67], v[80:83], v[192:195], v[64:67]
  v_mfma_f32_16x16x32_bf16 v[68:71], v[84:87], v[192:195], v[68:71]
  ds_read_b128 v[80:83], v7 offset:7168
  ds_read_b128 v[84:87], v7 offset:27648
  s_waitcnt lgkmcnt(4)
  v_mfma_f32_16x16x32_bf16 v[32:35], a[20:23], v[88:91], v[32:35]
  v_mfma_f32_16x16x32_bf16 v[36:39], a[20:23], v[92:95], v[36:39]
  v_mfma_f32_16x16x32_bf16 v[40:43], a[100:103], v[88:91], v[40:43]
  v_mfma_f32_16x16x32_bf16 v[44:47], a[100:103], v[92:95], v[44:47]
  v_mfma_f32_16x16x32_bf16 v[48:51], a[180:183], v[88:91], v[48:51]
  v_mfma_f32_16x16x32_bf16 v[52:55], a[180:183], v[92:95], v[52:55]
  v_mfma_f32_16x16x32_bf16 v[56:59], v[116:119], v[88:91], v[56:59]
  v_mfma_f32_16x16x32_bf16 v[60:63], v[116:119], v[92:95], v[60:63]
  v_mfma_f32_16x16x32_bf16 v[64:67], v[88:91], v[196:199], v[64:67]
  v_mfma_f32_16x16x32_bf16 v[68:71], v[92:95], v[196:199], v[68:71]
  ds_read_b128 v[88:91], v7 offset:8192
  ds_read_b128 v[92:95], v7 offset:28672
  s_waitcnt lgkmcnt(4)
  v_mfma_f32_16x16x32_bf16 v[32:35], a[24:27], v[72:75], v[32:35]
  v_mfma_f32_16x16x32_bf16 v[36:39], a[24:27], v[76:79], v[36:39]
  v_mfma_f32_16x16x32_bf16 v[40:43], a[104:107], v[72:75], v[40:43]
  v_mfma_f32_16x16x32_bf16 v[44:47], a[104:107], v[76:79], v[44:47]
  v_mfma_f32_16x16x32_bf16 v[48:51], a[184:187], v[72:75], v[48:51]
  v_mfma_f32_16x16x32_bf16 v[52:55], a[184:187], v[76:79], v[52:55]
  v_mfma_f32_16x16x32_bf16 v[56:59], v[120:123], v[72:75], v[56:59]
  v_mfma_f32_16x16x32_bf16 v[60:63], v[120:123], v[76:79], v[60:63]
  v_mfma_f32_16x16x32_bf16 v[64:67], v[72:75], v[200:203], v[64:67]
  v_mfma_f32_16x16x32_bf16 v[68:71], v[76:79], v[200:203], v[68:71]
  ds_read_b128 v[72:75], v7 offset:9216
  ds_read_b128 v[76:79], v7 offset:29696
  s_waitcnt lgkmcnt(4)
  v_mfma_f32_16x16x32_bf16 v[32:35], a[28:31], v[80:83], v[32:35]
  v_mfma_f32_16x16x32_bf16 v[36:39], a[28:31], v[84:87], v[36:39]
  v_mfma_f32_16x16x32_bf16 v[40:43], a[108:111], v[80:83], v[40:43]
  v_mfma_f32_16x16x32_bf16 v[44:47], a[108:111], v[84:87], v[44:47]
  v_mfma_f32_16x16x32_bf16 v[48:51], a[188:191], v[80:83], v[48:51]
  v_mfma_f32_16x16x32_bf16 v[52:55], a[188:191], v[84:87], v[52:55]
  v_mfma_f32_16x16x32_bf16 v[56:59], v[124:127], v[80:83], v[56:59]
  v_mfma_f32_16x16x32_bf16 v[60:63], v[124:127], v[84:87], v[60:63]
  v_mfma_f32_16x16x32_bf16 v[64:67], v[80:83], v[204:207], v[64:67]
  v_mfma_f32_16x16x32_bf16 v[68:71], v[84:87], v[204:207], v[68:71]
  ds_read_b128 v[80:83], v7 offset:10240
  ds_read_b128 v[84:87], v7 offset:30720
  s_waitcnt lgkmcnt(4)
  v_mfma_f32_16x16x32_bf16 v[32:35], a[32:35], v[88:91], v[32:35]
  v_mfma_f32_16x16x32_bf16 v[36:39], a[32:35], v[92:95], v[36:39]
  v_mfma_f32_16x16x32_bf16 v[40:43], a[112:115], v[88:91], v[40:43]
  v_mfma_f32_16x16x32_bf16 v[44:47], a[112:115], v[92:95], v[44:47]
  v_mfma_f32_16x16x32_bf16 v[48:51], a[192:195], v[88:91], v[48:51]
  v_mfma_f32_16x16x32_bf16 v[52:55], a[192:195], v[92:95], v[52:55]
  v_mfma_f32_16x16x32_bf16 v[56:59], v[128:131], v[88:91], v[56:59]
  v_mfma_f32_16x16x32_bf16 v[60:63], v[128:131], v[92:95], v[60:63]
  v_mfma_f32_16x16x32_bf16 v[64:67], v[88:91], v[208:211], v[64:67]
  v_mfma_f32_16x16x32_bf16 v[68:71], v[92:95], v[208:211], v[68:71]
  ds_read_b128 v[88:91], v7 offset:11264
  ds_read_b128 v[92:95], v7 offset:31744
  s_waitcnt lgkmcnt(4)
  v_mfma_f32_16x16x32_bf16 v[32:35], a[36:39], v[72:75], v[32:35]
  v_mfma_f32_16x16x32_bf16 v[36:39], a[36:39], v[76:79], v[36:39]
  v_mfma_f32_16x16x32_bf16 v[40:43], a[116:119], v[72:75], v[40:43]
  v_mfma_f32_16x16x32_bf16 v[44:47], a[116:119], v[76:79], v[44:47]
  v_mfma_f32_16x16x32_bf16 v[48:51], a[196:199], v[72:75], v[48:51]
  v_mfma_f32_16x16x32_bf16 v[52:55], a[196:199], v[76:79], v[52:55]
  v_mfma_f32_16x16x32_bf16 v[56:59], v[132:135], v[72:75], v[56:59]
  v_mfma_f32_16x16x32_bf16 v[60:63], v[132:135], v[76:79], v[60:63]
  v_mfma_f32_16x16x32_bf16 v[64:67], v[72:75], v[212:215], v[64:67]
  v_mfma_f32_16x16x32_bf16 v[68:71], v[76:79], v[212:215], v[68:71]
  ds_read_b128 v[72:75], v7 offset:12288
  ds_read_b128 v[76:79], v7 offset:32768
  s_waitcnt lgkmcnt(4)
  v_mfma_f32_16x16x32_bf16 v[32:35], a[40:43], v[80:83], v[32:35]
  v_mfma_f32_16x16x32_bf16 v[36:39], a[40:43], v[84:87], v[36:39]
  v_mfma_f32_16x16x32_bf16 v[40:43], a[120:123], v[80:83], v[40:43]
  v_mfma_f32_16x16x32_bf16 v[44:47], a[120:123], v[84:87], v[44:47]
  v_mfma_f32_16x16x32_bf16 v[48:51], a[200:203], v[80:83], v[48:51]
  v_mfma_f32_16x16x32_bf16 v[52:55], a[200:203], v[84:87], v[52:55]
  v_mfma_f32_16x16x32_bf16 v[56:59], v[136:139], v[80:83], v[56:59]
  v_mfma_f32_16x16x32_bf16 v[60:63], v[136:139], v[84:87], v[60:63]
  v_mfma_f32_16x16x32_bf16 v[64:67], v[80:83], v[216:219], v[64:67]
  v_mfma_f32_16x16x32_bf16 v[68:71], v[84:87], v[216:219], v[68:71]
  ds_read_b128 v[80:83], v7 offset:13312
  ds_read_b128 v[84:87], v7 offset:33792
  s_waitcnt lgkmcnt(4)
  v_mfma_f32_16x16x32_bf16 v[32:35], a[44:47], v[88:91], v[32:35]
  v_mfma_f32_16x16x32_bf16 v[36:39], a[44:47], v[92:95], v[36:39]
  v_mfma_f32_16x16x32_bf16 v[40:43], a[124:127], v[88:91], v[40:43]
  v_mfma_f32_16x16x32_bf16 v[44:47], a[124:127], v[92:95], v[44:47]
  v_mfma_f32_16x16x32_bf16 v[48:51], a[204:207], v[88:91], v[48:51]
  v_mfma_f32_16x16x32_bf16 v[52:55], a[204:207], v[92:95], v[52:55]
  v_mfma_f32_16x16x32_bf16 v[56:59], v[140:143], v[88:91], v[56:59]
  v_mfma_f32_16x16x32_bf16 v[60:63], v[140:143], v[92:95], v[60:63]
  v_mfma_f32_16x16x32_bf16 v[64:67], v[88:91], v[220:223], v[64:67]
  v_mfma_f32_16x16x32_bf16 v[68:71], v[92:95], v[220:223], v[68:71]
  ds_read_b128 v[88:91], v7 offset:14336
  ds_read_b128 v[92:95], v7 offset:34816
  s_waitcnt lgkmcnt(4)
  v_mfma_f32_16x16x32_bf16 v[32:35], a[48:51], v[72:75], v[32:35]
  v_mfma_f32_16x16x32_bf16 v[36:39], a[48:51], v[76:79], v[36:39]
  v_mfma_f32_16x16x32_bf16 v[40:43], a[128:131], v[72:75], v[40:43]
  v_mfma_f32_16x16x32_bf16 v[44:47], a[128:131], v[76:79], v[44:47]
  v_mfma_f32_16x16x32_bf16 v[48:51], a[208:211], v[72:75], v[48:51]
  v_mfma_f32_16x16x32_bf16 v[52:55], a[208:211], v[76:79], v[52:55]
  v_mfma_f32_16x16x32_bf16 v[56:59], v[144:147], v[72:75], v[56:59]
  v_mfma_f32_16x16x32_bf16 v[60:63], v[144:147], v[76:79], v[60:63]
  v_mfma_f32_16x16x32_bf16 v[64:67], v[72:75], v[224:227], v[64:67]
  v_mfma_f32_16x16x32_bf16 v[68:71], v[76:79], v[224:227], v[68:71]
  ds_read_b128 v[72:75], v7 offset:15360
  ds_read_b128 v[76:79], v7 offset:35840
  s_waitcnt lgkmcnt(4)
  v_mfma_f32_16x16x32_bf16 v[32:35], a[52:55], v[80:83], v[32:35]
  v_mfma_f32_16x16x32_bf16 v[36:39], a[52:55], v[84:87], v[36:39]
  v_mfma_f32_16x16x32_bf16 v[40:43], a[132:135], v[80:83], v[40:43]
  v_mfma_f32_16x16x32_bf16 v[44:47], a[132:135], v[84:87], v[44:47]
  v_mfma_f32_16x16x32_bf16 v[48:51], a[212:215], v[80:83], v[48:51]
  v_mfma_f32_16x16x32_bf16 v[52:55], a[212:215], v[84:87], v[52:55]
  v_mfma_f32_16x16x32_bf16 v[56:59], v[148:151], v[80:83], v[56:59]
  v_mfma_f32_16x16x32_bf16 v[60:63], v[148:151], v[84:87], v[60:63]
  v_mfma_f32_16x16x32_bf16 v[64:67], v[80:83], v[228:231], v[64:67]
  v_mfma_f32_16x16x32_bf16 v[68:71], v[84:87], v[228:231], v[68:71]
  ds_read_b128 v[80:83], v7 offset:16384
  ds_read_b128 v[84:87], v7 offset:36864
  s_waitcnt lgkmcnt(4)
  v_mfma_f32_16x16x32_bf16 v[32:35], a[56:59], v[88:91], v[32:35]
  v_mfma_f32_16x16x32_bf16 v[36:39], a[56:59], v[92:95], v[36:39]
  v_mfma_f32_16x16x32_bf16 v[40:43], a[136:139], v[88:91], v[40:43]
  v_mfma_f32_16x16x32_bf16 v[44:47], a[136:139], v[92:95], v[44:47]
  v_mfma_f32_16x16x32_bf16 v[48:51], a[216:219], v[88:91], v[48:51]
  v_mfma_f32_16x16x32_bf16 v[52:55], a[216:219], v[92:95], v[52:55]
  v_mfma_f32_16x16x32_bf16 v[56:59], v[152:155], v[88:91], v[56:59]
  v_mfma_f32_16x16x32_bf16 v[60:63], v[152:155], v[92:95], v[60:63]
  v_mfma_f32_16x16x32_bf16 v[64:67], v[88:91], v[232:235], v[64:67]
  v_mfma_f32_16x16x32_bf16 v[68:71], v[92:95], v[232:235], v[68:71]
  ds_read_b128 v[88:91], v7 offset:17408
  ds_read_b128 v[92:95], v7 offset:37888
  s_waitcnt lgkmcnt(4)
  v_mfma_f32_16x16x32_bf16 v[32:35], a[60:63], v[72:75], v[32:35]
  v_mfma_f32_16x16x32_bf16 v[36:39], a[60:63], v[76:79], v[36:39]
  v_mfma_f32_16x16x32_bf16 v[40:43], a[140:143], v[72:75], v[40:43]
  v_mfma_f32_16x16x32_bf16 v[44:47], a[140:143], v[76:79], v[44:47]
  v_mfma_f32_16x16x32_bf16 v[48:51], a[220:223], v[72:75], v[48:51]
  v_mfma_f32_16x16x32_bf16 v[52:55], a[220:223], v[76:79], v[52:55]
  v_mfma_f32_16x16x32_bf16 v[56:59], v[156:159], v[72:75], v[56:59]
  v_mfma_f32_16x16x32_bf16 v[60:63], v[156:159], v[76:79], v[60:63]
  v_mfma_f32_16x16x32_bf16 v[64:67], v[72:75], v[236:239], v[64:67]
  v_mfma_f32_16x16x32_bf16 v[68:71], v[76:79], v[236:239], v[68:71]
  ds_read_b128 v[72:75], v7 offset:18432
  ds_read_b128 v[76:79], v7 offset:38912
  s_waitcnt lgkmcnt(4)
  v_mfma_f32_16x16x32_bf16 v[32:35], a[64:67], v[80:83], v[32:35]
  v_mfma_f32_16x16x32_bf16 v[36:39], a[64:67], v[84:87], v[36:39]
  v_mfma_f32_16x16x32_bf16 v[40:43], a[144:147], v[80:83], v[40:43]
  v_mfma_f32_16x16x32_bf16 v[44:47], a[144:147], v[84:87], v[44:47]
  v_mfma_f32_16x16x32_bf16 v[48:51], a[224:227], v[80:83], v[48:51]
  v_mfma_f32_16x16x32_bf16 v[52:55], a[224:227], v[84:87], v[52:55]
  v_mfma_f32_16x16x32_bf16 v[56:59], v[160:163], v[80:83], v[56:59]
  v_mfma_f32_16x16x32_bf16 v[60:63], v[160:163], v[84:87], v[60:63]
  v_mfma_f32_16x16x32_bf16 v[64:67], v[80:83], v[240:243], v[64:67]
  v_mfma_f32_16x16x32_bf16 v[68:71], v[84:87], v[240:243], v[68:71]
  ds_read_b128 v[80:83], v7 offset:19456
  ds_read_b128 v[84:87], v7 offset:39936
  s_waitcnt lgkmcnt(4)
  v_mfma_f32_16x16x32_bf16 v[32:35], a[68:71], v[88:91], v[32:35]
  v_mfma_f32_16x16x32_bf16 v[36:39], a[68:71], v[92:95], v[36:39]
  v_mfma_f32_16x16x32_bf16 v[40:43], a[148:151], v[88:91], v[40:43]
  v_mfma_f32_16x16x32_bf16 v[44:47], a[148:151], v[92:95], v[44:47]
  v_mfma_f32_16x16x32_bf16 v[48:51], a[228:231], v[88:91], v[48:51]
  v_mfma_f32_16x16x32_bf16 v[52:55], a[228:231], v[92:95], v[52:55]
  v_mfma_f32_16x16x32_bf16 v[56:59], v[164:167], v[88:91], v[56:59]
  v_mfma_f32_16x16x32_bf16 v[60:63], v[164:167], v[92:95], v[60:63]
  v_mfma_f32_16x16x32_bf16 v[64:67], v[88:91], v[244:247], v[64:67]
  v_mfma_f32_16x16x32_bf16 v[68:71], v[92:95], v[244:247], v[68:71]
  s_waitcnt lgkmcnt(2)
  v_mfma_f32_16x16x32_bf16 v[32:35], a[72:75], v[72:75], v[32:35]
  v_mfma_f32_16x16x32_bf16 v[36:39], a[72:75], v[76:79], v[36:39]
  v_mfma_f32_16x16x32_bf16 v[40:43], a[152:155], v[72:75], v[40:43]
  v_mfma_f32_16x16x32_bf16 v[44:47], a[152:155], v[76:79], v[44:47]
  v_mfma_f32_16x16x32_bf16 v[48:51], a[232:235], v[72:75], v[48:51]
  v_mfma_f32_16x16x32_bf16 v[52:55], a[232:235], v[76:79], v[52:55]
  v_mfma_f32_16x16x32_bf16 v[56:59], v[168:171], v[72:75], v[56:59]
  v_mfma_f32_16x16x32_bf16 v[60:63], v[168:171], v[76:79], v[60:63]
  v_mfma_f32_16x16x32_bf16 v[64:67], v[72:75], v[248:251], v[64:67]
  v_mfma_f32_16x16x32_bf16 v[68:71], v[76:79], v[248:251], v[68:71]
  s_waitcnt lgkmcnt(0)
  v_mfma_f32_16x16x32_bf16 v[32:35], a[76:79], v[80:83], v[32:35]
  v_mfma_f32_16x16x32_bf16 v[36:39], a[76:79], v[84:87], v[36:39]
  v_mfma_f32_16x16x32_bf16 v[40:43], a[156:159], v[80:83], v[40:43]
  v_mfma_f32_16x16x32_bf16 v[44:47], a[156:159], v[84:87], v[44:47]
  v_mfma_f32_16x16x32_bf16 v[48:51], a[236:239], v[80:83], v[48:51]
  v_mfma_f32_16x16x32_bf16 v[52:55], a[236:239], v[84:87], v[52:55]
  v_mfma_f32_16x16x32_bf16 v[56:59], v[172:175], v[80:83], v[56:59]
  v_mfma_f32_16x16x32_bf16 v[60:63], v[172:175], v[84:87], v[60:63]
  v_mfma_f32_16x16x32_bf16 v[64:67], v[80:83], v[252:255], v[64:67]
  v_mfma_f32_16x16x32_bf16 v[68:71], v[84:87], v[252:255], v[68:71]
  v_cvt_pk_bf16_f32 v8, v32, v33
  v_cvt_pk_bf16_f32 v9, v34, v35
  v_cvt_pk_bf16_f32 v10, v40, v41
  v_cvt_pk_bf16_f32 v11, v42, v43
  s_add_u32 s34, s21, 0
  buffer_store_dwordx4 v[8:11], v1, s[4:7], s34 offen
  v_cvt_pk_bf16_f32 v12, v36, v37
  v_cvt_pk_bf16_f32 v13, v38, v39
  v_cvt_pk_bf16_f32 v14, v44, v45
  v_cvt_pk_bf16_f32 v15, v46, v47
  s_add_u32 s34, s21, 6144
  buffer_store_dwordx4 v[12:15], v1, s[4:7], s34 offen
  v_cvt_pk_bf16_f32 v8, v48, v49
  v_cvt_pk_bf16_f32 v9, v50, v51
  v_cvt_pk_bf16_f32 v10, v56, v57
  v_cvt_pk_bf16_f32 v11, v58, v59
  s_add_u32 s34, s21, 1024
  buffer_store_dwordx4 v[8:11], v1, s[4:7], s34 offen
  v_cvt_pk_bf16_f32 v12, v52, v53
  v_cvt_pk_bf16_f32 v13, v54, v55
  v_cvt_pk_bf16_f32 v14, v60, v61
  v_cvt_pk_bf16_f32 v15, v62, v63
  s_add_u32 s34, s21, 7168
  buffer_store_dwordx4 v[12:15], v1, s[4:7], s34 offen
  v_cvt_pk_bf16_f32 v8, v64, v65
  v_cvt_pk_bf16_f32 v9, v66, v67
  v_cvt_pk_bf16_f32 v10, v68, v69
  v_cvt_pk_bf16_f32 v11, v70, v71
  s_add_u32 s34, s23, 0
  buffer_store_dwordx4 v[8:11], v1, s[4:7], s34 offen
  s_waitcnt vmcnt(0)
  s_barrier
  s_add_u32 s17, s17, 1
  v_mov_b32 v28, s17
  buffer_store_dword v28, v4, s[4:7], s24 offen
  s_cmp_lt_u32 s17, 64
  s_cbranch_scc1 reca_ptop233
  s_branch reca_exit1
reca_pslow232:
reca_ptop238:
  s_cmp_lt_u32 s17, 6
  s_cbranch_scc1 reca_pgo239
  s_sub_u32 s36, s17, 6
reca_ppoll240:
  buffer_load_dword v28, v4, s[4:7], s25 offen sc1
  s_waitcnt vmcnt(0)
  v_readfirstlane_b32 s34, v28
  s_nop 3
  s_cmp_ge_i32 s34, s36
  s_cbranch_scc1 reca_pgo239
  s_sleep 8
  s_sub_u32 s18, s18, 1
  s_cbranch_scc0 reca_ppoll240
  s_mov_b32 s18, 0
reca_pgo239:
  s_waitcnt vmcnt(0)
  s_barrier
  v_add_u32 v7, s26, v1
  s_xor_b32 s26, s26, 40960
  s_add_u32 s37, s17, 1
  s_cmp_ge_u32 s37, 64
  s_cbranch_scc1 reca_pnodma241
  s_mul_i32 s20, s37, 40960
  s_add_u32 s20, s20, 153616384
  s_add_u32 m0, s26, 0
  s_nop 0
  buffer_load_dwordx4 v1, s[4:7], s20 offen offset:0 lds
  buffer_load_dwordx4 v1, s[4:7], s20 offen offset:1024 lds
  buffer_load_dwordx4 v1, s[4:7], s20 offen offset:2048 lds
  buffer_load_dwordx4 v1, s[4:7], s20 offen offset:3072 lds
  s_add_u32 s20, s20, 4096
  s_add_u32 m0, s26, 4096
  s_nop 0
  buffer_load_dwordx4 v1, s[4:7], s20 offen offset:0 lds
  buffer_load_dwordx4 v1, s[4:7], s20 offen offset:1024 lds
  buffer_load_dwordx4 v1, s[4:7], s20 offen offset:2048 lds
  buffer_load_dwordx4 v1, s[4:7], s20 offen offset:3072 lds
  s_add_u32 s20, s20, 4096
  s_add_u32 m0, s26, 8192
  s_nop 0
  buffer_load_dwordx4 v1, s[4:7], s20 offen offset:0 lds
  buffer_load_dwordx4 v1, s[4:7], s20 offen offset:1024 lds
  s_lshl_b32 s34, s15, 6
  s_add_u32 s34, s34, s37
  s_mul_i32 s34, s34, 12288
  s_mul_i32 s35, s16, 3072
  s_add_u32 s35, s35, s34
  s_add_u32 s27, s35, 37748736
  s_mul_i32 s35, s16, 6144
  s_add_u32 s35, s35, s34
  s_add_u32 s28, s35, 62914560
  s_add_u32 s34, s27, 0
  buffer_load_dwordx4 v[16:19], v1, s[4:7], s34 offen sc1
  s_add_u32 s34, s27, 6144
  buffer_load_dwordx4 v[16:19], v1, s[4:7], s34 offen sc1
  s_add_u32 s34, s27, 1024
  buffer_load_dwordx4 v[16:19], v1, s[4:7], s34 offen sc1
  s_add_u32 s34, s27, 7168
  buffer_load_dwordx4 v[16:19], v1, s[4:7], s34 offen sc1
  s_add_u32 s34, s28, 0
  buffer_load_dwordx4 v[16:19], v1, s[4:7], s34 offen sc1
reca_pnodma241:
  s_lshl_b32 s34, s15, 6
  s_add_u32 s34, s34, s17
  s_mul_i32 s34, s34, 12288
  s_mul_i32 s35, s16, 3072
  s_add_u32 s35, s35, s34
  s_add_u32 s21, s35, 37748736
  s_add_u32 s22, s35, 88080384
  s_mul_i32 s35, s16, 6144
  s_add_u32 s35, s35, s34
  s_add_u32 s23, s35, 62914560
  ds_read_b128 v[72:75], v7 offset:0
  ds_read_b128 v[76:79], v7 offset:20480
  ds_read_b128 v[80:83], v7 offset:1024
  ds_read_b128 v[84:87], v7 offset:21504
  ds_read_b128 v[88:91], v7 offset:2048
  ds_read_b128 v[92:95], v7 offset:22528
  s_waitcnt lgkmcnt(4)
  v_mfma_f32_16x16x32_bf16 v[32:35], a[0:3], v[72:75], 0
  v_mfma_f32_16x16x32_bf16 v[36:39], a[0:3], v[76:79], 0
  v_mfma_f32_16x16x32_bf16 v[40:43], a[80:83], v[72:75], 0
  v_mfma_f32_16x16x32_bf16 v[44:47], a[80:83], v[76:79], 0
  v_mfma_f32_16x16x32_bf16 v[48:51], a[160:163], v[72:75], 0
  v_mfma_f32_16x16x32_bf16 v[52:55], a[160:163], v[76:79], 0
  v_mfma_f32_16x16x32_bf16 v[56:59], v[96:99], v[72:75], 0
  v_mfma_f32_16x16x32_bf16 v[60:63], v[96:99], v[76:79], 0
  v_mfma_f32_16x16x32_bf16 v[64:67], v[72:75], v[176:179], 0
  v_mfma_f32_16x16x32_bf16 v[68:71], v[76:79], v[176:179], 0
  ds_read_b128 v[72:75], v7 offset:3072
  ds_read_b128 v[76:79], v7 offset:23552
  s_waitcnt lgkmcnt(4)
  v_mfma_f32_16x16x32_bf16 v[32:35], a[4:7], v[80:83], v[32:35]
  v_mfma_f32_16x16x32_bf16 v[36:39], a[4:7], v[84:87], v[36:39]
  v_mfma_f32_16x16x32_bf16 v[40:43], a[84:87], v[80:83], v[40:43]
  v_mfma_f32_16x16x32_bf16 v[44:47], a[84:87], v[84:87], v[44:47]
  v_mfma_f32_16x16x32_bf16 v[48:51], a[164:167], v[80:83], v[48:51]
  v_mfma_f32_16x16x32_bf16 v[52:55], a[164:167], v[84:87], v[52:55]
  v_mfma_f32_16x16x32_bf16 v[56:59], v[100:103], v[80:83], v[56:59]
  v_mfma_f32_16x16x32_bf16 v[60:63], v[100:103], v[84:87], v[60:63]
  v_mfma_f32_16x16x32_bf16 v[64:67], v[80:83], v[180:183], v[64:67]
  v_mfma_f32_16x16x32_bf16 v[68:71], v[84:87], v[180:183], v[68:71]
  ds_read_b128 v[80:83], v7 offset:4096
  ds_read_b128 v[84:87], v7 offset:24576
  s_waitcnt lgkmcnt(4)
  v_mfma_f32_16x16x32_bf16 v[32:35], a[8:11], v[88:91], v[32:35]
  v_mfma_f32_16x16x32_bf16 v[36:39], a[8:11], v[92:95], v[36:39]
  v_mfma_f32_16x16x32_bf16 v[40:43], a[88:91], v[88:91], v[40:43]
  v_mfma_f32_16x16x32_bf16 v[44:47], a[88:91], v[92:95], v[44:47]
  v_mfma_f32_16x16x32_bf16 v[48:51], a[168:171], v[88:91], v[48:51]
  v_mfma_f32_16x16x32_bf16 v[52:55], a[168:171], v[92:95], v[52:55]
  v_mfma_f32_16x16x32_bf16 v[56:59], v[104:107], v[88:91], v[56:59]
  v_mfma_f32_16x16x32_bf16 v[60:63], v[104:107], v[92:95], v[60:63]
  v_mfma_f32_16x16x32_bf16 v[64:67], v[88:91], v[184:187], v[64:67]
  v_mfma_f32_16x16x32_bf16 v[68:71], v[92:95], v[184:187], v[68:71]
  ds_read_b128 v[88:91], v7 offset:5120
  ds_read_b128 v[92:95], v7 offset:25600
  s_waitcnt lgkmcnt(4)
  v_mfma_f32_16x16x32_bf16 v[32:35], a[12:15], v[72:75], v[32:35]
  v_mfma_f32_16x16x32_bf16 v[36:39], a[12:15], v[76:79], v[36:39]
  v_mfma_f32_16x16x32_bf16 v[40:43], a[92:95], v[72:75], v[40:43]
  v_mfma_f32_16x16x32_bf16 v[44:47], a[92:95], v[76:79], v[44:47]
  v_mfma_f32_16x16x32_bf16 v[48:51], a[172:175], v[72:75], v[48:51]
  v_mfma_f32_16x16x32_bf16 v[52:55], a[172:175], v[76:79], v[52:55]
  v_mfma_f32_16x16x32_bf16 v[56:59], v[108:111], v[72:75], v[56:59]
  v_mfma_f32_16x16x32_bf16 v[60:63], v[108:111], v[76:79], v[60:63]
  v_mfma_f32_16x16x32_bf16 v[64:67], v[72:75], v[188:191], v[64:67]
  v_mfma_f32_16x16x32_bf16 v[68:71], v[76:79], v[188:191], v[68:71]
  ds_read_b128 v[72:75], v7 offset:6144
  ds_read_b128 v[76:79], v7 offset:26624
  s_waitcnt lgkmcnt(4)
  v_mfma_f32_16x16x32_bf16 v[32:35], a[16:19], v[80:83], v[32:35]
  v_mfma_f32_16x16x32_bf16 v[36:39], a[16:19], v[84:87], v[36:39]
  v_mfma_f32_16x16x32_bf16 v[40:43], a[96:99], v[80:83], v[40:43]
  v_mfma_f32_16x16x32_bf16 v[44:47], a[96:99], v[84:87], v[44:47]
  v_mfma_f32_16x16x32_bf16 v[48:51], a[176:179], v[80:83], v[48:51]
  v_mfma_f32_16x16x32_bf16 v[52:55], a[176:179], v[84:87], v[52:55]
  v_mfma_f32_16x16x32_bf16 v[56:59], v[112:115], v[80:83], v[56:59]
  v_mfma_f32_16x16x32_bf16 v[60:63], v[112:115], v[84:87], v[60:63]
  v_mfma_f32_16x16x32_bf16 v[64:67], v[80:83], v[192:195], v[64:67]
  v_mfma_f32_16x16x32_bf16 v[68:71], v[84:87], v[192:195], v[68:71]
  ds_read_b128 v[80:83], v7 offset:7168
  ds_read_b128 v[84:87], v7 offset:27648
  s_waitcnt lgkmcnt(4)
  v_mfma_f32_16x16x32_bf16 v[32:35], a[20:23], v[88:91], v[32:35]
  v_mfma_f32_16x16x32_bf16 v[36:39], a[20:23], v[92:95], v[36:39]
  v_mfma_f32_16x16x32_bf16 v[40:43], a[100:103], v[88:91], v[40:43]
  v_mfma_f32_16x16x32_bf16 v[44:47], a[100:103], v[92:95], v[44:47]
  v_mfma_f32_16x16x32_bf16 v[48:51], a[180:183], v[88:91], v[48:51]
  v_mfma_f32_16x16x32_bf16 v[52:55], a[180:183], v[92:95], v[52:55]
  v_mfma_f32_16x16x32_bf16 v[56:59], v[116:119], v[88:91], v[56:59]
  v_mfma_f32_16x16x32_bf16 v[60:63], v[116:119], v[92:95], v[60:63]
  v_mfma_f32_16x16x32_bf16 v[64:67], v[88:91], v[196:199], v[64:67]
  v_mfma_f32_16x16x32_bf16 v[68:71], v[92:95], v[196:199], v[68:71]
  ds_read_b128 v[88:91], v7 offset:8192
  ds_read_b128 v[92:95], v7 offset:28672
  s_waitcnt lgkmcnt(4)
  v_mfma_f32_16x16x32_bf16 v[32:35], a[24:27], v[72:75], v[32:35]
  v_mfma_f32_16x16x32_bf16 v[36:39], a[24:27], v[76:79], v[36:39]
  v_mfma_f32_16x16x32_bf16 v[40:43], a[104:107], v[72:75], v[40:43]
  v_mfma_f32_16x16x32_bf16 v[44:47], a[104:107], v[76:79], v[44:47]
  v_mfma_f32_16x16x32_bf16 v[48:51], a[184:187], v[72:75], v[48:51]
  v_mfma_f32_16x16x32_bf16 v[52:55], a[184:187], v[76:79], v[52:55]
  v_mfma_f32_16x16x32_bf16 v[56:59], v[120:123], v[72:75], v[56:59]
  v_mfma_f32_16x16x32_bf16 v[60:63], v[120:123], v[76:79], v[60:63]
  v_mfma_f32_16x16x32_bf16 v[64:67], v[72:75], v[200:203], v[64:67]
  v_mfma_f32_16x16x32_bf16 v[68:71], v[76:79], v[200:203], v[68:71]
  ds_read_b128 v[72:75], v7 offset:9216
  ds_read_b128 v[76:79], v7 offset:29696
  s_waitcnt lgkmcnt(4)
  v_mfma_f32_16x16x32_bf16 v[32:35], a[28:31], v[80:83], v[32:35]
  v_mfma_f32_16x16x32_bf16 v[36:39], a[28:31], v[84:87], v[36:39]
  v_mfma_f32_16x16x32_bf16 v[40:43], a[108:111], v[80:83], v[40:43]
  v_mfma_f32_16x16x32_bf16 v[44:47], a[108:111], v[84:87], v[44:47]
  v_mfma_f32_16x16x32_bf16 v[48:51], a[188:191], v[80:83], v[48:51]
  v_mfma_f32_16x16x32_bf16 v[52:55], a[188:191], v[84:87], v[52:55]
  v_mfma_f32_16x16x32_bf16 v[56:59], v[124:127], v[80:83], v[56:59]
  v_mfma_f32_16x16x32_bf16 v[60:63], v[124:127], v[84:87], v[60:63]
  v_mfma_f32_16x16x32_bf16 v[64:67], v[80:83], v[204:207], v[64:67]
  v_mfma_f32_16x16x32_bf16 v[68:71], v[84:87], v[204:207], v[68:71]
  ds_read_b128 v[80:83], v7 offset:10240
  ds_read_b128 v[84:87], v7 offset:30720
  s_waitcnt lgkmcnt(4)
  v_mfma_f32_16x16x32_bf16 v[32:35], a[32:35], v[88:91], v[32:35]
  v_mfma_f32_16x16x32_bf16 v[36:39], a[32:35], v[92:95], v[36:39]
  v_mfma_f32_16x16x32_bf16 v[40:43], a[112:115], v[88:91], v[40:43]
  v_mfma_f32_16x16x32_bf16 v[44:47], a[112:115], v[92:95], v[44:47]
  v_mfma_f32_16x16x32_bf16 v[48:51], a[192:195], v[88:91], v[48:51]
  v_mfma_f32_16x16x32_bf16 v[52:55], a[192:195], v[92:95], v[52:55]
  v_mfma_f32_16x16x32_bf16 v[56:59], v[128:131], v[88:91], v[56:59]
  v_mfma_f32_16x16x32_bf16 v[60:63], v[128:131], v[92:95], v[60:63]
  v_mfma_f32_16x16x32_bf16 v[64:67], v[88:91], v[208:211], v[64:67]
  v_mfma_f32_16x16x32_bf16 v[68:71], v[92:95], v[208:211], v[68:71]
  ds_read_b128 v[88:91], v7 offset:11264
  ds_read_b128 v[92:95], v7 offset:31744
  s_waitcnt lgkmcnt(4)
  v_mfma_f32_16x16x32_bf16 v[32:35], a[36:39], v[72:75], v[32:35]
  v_mfma_f32_16x16x32_bf16 v[36:39], a[36:39], v[76:79], v[36:39]
  v_mfma_f32_16x16x32_bf16 v[40:43], a[116:119], v[72:75], v[40:43]
  v_mfma_f32_16x16x32_bf16 v[44:47], a[116:119], v[76:79], v[44:47]
  v_mfma_f32_16x16x32_bf16 v[48:51], a[196:199], v[72:75], v[48:51]
  v_mfma_f32_16x16x32_bf16 v[52:55], a[196:199], v[76:79], v[52:55]
  v_mfma_f32_16x16x32_bf16 v[56:59], v[132:135], v[72:75], v[56:59]
  v_mfma_f32_16x16x32_bf16 v[60:63], v[132:135], v[76:79], v[60:63]
  v_mfma_f32_16x16x32_bf16 v[64:67], v[72:75], v[212:215], v[64:67]
  v_mfma_f32_16x16x32_bf16 v[68:71], v[76:79], v[212:215], v[68:71]
  ds_read_b128 v[72:75], v7 offset:12288
  ds_read_b128 v[76:79], v7 offset:32768
  s_waitcnt lgkmcnt(4)
  v_mfma_f32_16x16x32_bf16 v[32:35], a[40:43], v[80:83], v[32:35]
  v_mfma_f32_16x16x32_bf16 v[36:39], a[40:43], v[84:87], v[36:39]
  v_mfma_f32_16x16x32_bf16 v[40:43], a[120:123], v[80:83], v[40:43]
  v_mfma_f32_16x16x32_bf16 v[44:47], a[120:123], v[84:87], v[44:47]
  v_mfma_f32_16x16x32_bf16 v[48:51], a[200:203], v[80:83], v[48:51]
  v_mfma_f32_16x16x32_bf16 v[52:55], a[200:203], v[84:87], v[52:55]
  v_mfma_f32_16x16x32_bf16 v[56:59], v[136:139], v[80:83], v[56:59]
  v_mfma_f32_16x16x32_bf16 v[60:63], v[136:139], v[84:87], v[60:63]
  v_mfma_f32_16x16x32_bf16 v[64:67], v[80:83], v[216:219], v[64:67]
  v_mfma_f32_16x16x32_bf16 v[68:71], v[84:87], v[216:219], v[68:71]
  ds_read_b128 v[80:83], v7 offset:13312
  ds_read_b128 v[84:87], v7 offset:33792
  s_waitcnt lgkmcnt(4)
  v_mfma_f32_16x16x32_bf16 v[32:35], a[44:47], v[88:91], v[32:35]
  v_mfma_f32_16x16x32_bf16 v[36:39], a[44:47], v[92:95], v[36:39]
  v_mfma_f32_16x16x32_bf16 v[40:43], a[124:127], v[88:91], v[40:43]
  v_mfma_f32_16x16x32_bf16 v[44:47], a[124:127], v[92:95], v[44:47]
  v_mfma_f32_16x16x32_bf16 v[48:51], a[204:207], v[88:91], v[48:51]
  v_mfma_f32_16x16x32_bf16 v[52:55], a[204:207], v[92:95], v[52:55]
  v_mfma_f32_16x16x32_bf16 v[56:59], v[140:143], v[88:91], v[56:59]
  v_mfma_f32_16x16x32_bf16 v[60:63], v[140:143], v[92:95], v[60:63]
  v_mfma_f32_16x16x32_bf16 v[64:67], v[88:91], v[220:223], v[64:67]
  v_mfma_f32_16x16x32_bf16 v[68:71], v[92:95], v[220:223], v[68:71]
  ds_read_b128 v[88:91], v7 offset:14336
  ds_read_b128 v[92:95], v7 offset:34816
  s_waitcnt lgkmcnt(4)
  v_mfma_f32_16x16x32_bf16 v[32:35], a[48:51], v[72:75], v[32:35]
  v_mfma_f32_16x16x32_bf16 v[36:39], a[48:51], v[76:79], v[36:39]
  v_mfma_f32_16x16x32_bf16 v[40:43], a[128:131], v[72:75], v[40:43]
  v_mfma_f32_16x16x32_bf16 v[44:47], a[128:131], v[76:79], v[44:47]
  v_mfma_f32_16x16x32_bf16 v[48:51], a[208:211], v[72:75], v[48:51]
  v_mfma_f32_16x16x32_bf16 v[52:55], a[208:211], v[76:79], v[52:55]
  v_mfma_f32_16x16x32_bf16 v[56:59], v[144:147], v[72:75], v[56:59]
  v_mfma_f32_16x16x32_bf16 v[60:63], v[144:147], v[76:79], v[60:63]
  v_mfma_f32_16x16x32_bf16 v[64:67], v[72:75], v[224:227], v[64:67]
  v_mfma_f32_16x16x32_bf16 v[68:71], v[76:79], v[224:227], v[68:71]
  ds_read_b128 v[72:75], v7 offset:15360
  ds_read_b128 v[76:79], v7 offset:35840
  s_waitcnt lgkmcnt(4)
  v_mfma_f32_16x16x32_bf16 v[32:35], a[52:55], v[80:83], v[32:35]
  v_mfma_f32_16x16x32_bf16 v[36:39], a[52:55], v[84:87], v[36:39]
  v_mfma_f32_16x16x32_bf16 v[40:43], a[132:135], v[80:83], v[40:43]
  v_mfma_f32_16x16x32_bf16 v[44:47], a[132:135], v[84:87], v[44:47]
  v_mfma_f32_16x16x32_bf16 v[48:51], a[212:215], v[80:83], v[48:51]
  v_mfma_f32_16x16x32_bf16 v[52:55], a[212:215], v[84:87], v[52:55]
  v_mfma_f32_16x16x32_bf16 v[56:59], v[148:151], v[80:83], v[56:59]
  v_mfma_f32_16x16x32_bf16 v[60:63], v[148:151], v[84:87], v[60:63]
  v_mfma_f32_16x16x32_bf16 v[64:67], v[80:83], v[228:231], v[64:67]
  v_mfma_f32_16x16x32_bf16 v[68:71], v[84:87], v[228:231], v[68:71]
  ds_read_b128 v[80:83], v7 offset:16384
  ds_read_b128 v[84:87], v7 offset:36864
  s_waitcnt lgkmcnt(4)
  v_mfma_f32_16x16x32_bf16 v[32:35], a[56:59], v[88:91], v[32:35]
  v_mfma_f32_16x16x32_bf16 v[36:39], a[56:59], v[92:95], v[36:39]
  v_mfma_f32_16x16x32_bf16 v[40:43], a[136:139], v[88:91], v[40:43]
  v_mfma_f32_16x16x32_bf16 v[44:47], a[136:139], v[92:95], v[44:47]
  v_mfma_f32_16x16x32_bf16 v[48:51], a[216:219], v[88:91], v[48:51]
  v_mfma_f32_16x16x32_bf16 v[52:55], a[216:219], v[92:95], v[52:55]
  v_mfma_f32_16x16x32_bf16 v[56:59], v[152:155], v[88:91], v[56:59]
  v_mfma_f32_16x16x32_bf16 v[60:63], v[152:155], v[92:95], v[60:63]
  v_mfma_f32_16x16x32_bf16 v[64:67], v[88:91], v[232:235], v[64:67]
  v_mfma_f32_16x16x32_bf16 v[68:71], v[92:95], v[232:235], v[68:71]
  ds_read_b128 v[88:91], v7 offset:17408
  ds_read_b128 v[92:95], v7 offset:37888
  s_waitcnt lgkmcnt(4)
  v_mfma_f32_16x16x32_bf16 v[32:35], a[60:63], v[72:75], v[32:35]
  v_mfma_f32_16x16x32_bf16 v[36:39], a[60:63], v[76:79], v[36:39]
  v_mfma_f32_16x16x32_bf16 v[40:43], a[140:143], v[72:75], v[40:43]
  v_mfma_f32_16x16x32_bf16 v[44:47], a[140:143], v[76:79], v[44:47]
  v_mfma_f32_16x16x32_bf16 v[48:51], a[220:223], v[72:75], v[48:51]
  v_mfma_f32_16x16x32_bf16 v[52:55], a[220:223], v[76:79], v[52:55]
  v_mfma_f32_16x16x32_bf16 v[56:59], v[156:159], v[72:75], v[56:59]
  v_mfma_f32_16x16x32_bf16 v[60:63], v[156:159], v[76:79], v[60:63]
  v_mfma_f32_16x16x32_bf16 v[64:67], v[72:75], v[236:239], v[64:67]
  v_mfma_f32_16x16x32_bf16 v[68:71], v[76:79], v[236:239], v[68:71]
  ds_read_b128 v[72:75], v7 offset:18432
  ds_read_b128 v[76:79], v7 offset:38912
  s_waitcnt lgkmcnt(4)
  v_mfma_f32_16x16x32_bf16 v[32:35], a[64:67], v[80:83], v[32:35]
  v_mfma_f32_16x16x32_bf16 v[36:39], a[64:67], v[84:87], v[36:39]
  v_mfma_f32_16x16x32_bf16 v[40:43], a[144:147], v[80:83], v[40:43]
  v_mfma_f32_16x16x32_bf16 v[44:47], a[144:147], v[84:87], v[44:47]
  v_mfma_f32_16x16x32_bf16 v[48:51], a[224:227], v[80:83], v[48:51]
  v_mfma_f32_16x16x32_bf16 v[52:55], a[224:227], v[84:87], v[52:55]
  v_mfma_f32_16x16x32_bf16 v[56:59], v[160:163], v[80:83], v[56:59]
  v_mfma_f32_16x16x32_bf16 v[60:63], v[160:163], v[84:87], v[60:63]
  v_mfma_f32_16x16x32_bf16 v[64:67], v[80:83], v[240:243], v[64:67]
  v_mfma_f32_16x16x32_bf16 v[68:71], v[84:87], v[240:243], v[68:71]
  ds_read_b128 v[80:83], v7 offset:19456
  ds_read_b128 v[84:87], v7 offset:39936
  s_waitcnt lgkmcnt(4)
  v_mfma_f32_16x16x32_bf16 v[32:35], a[68:71], v[88:91], v[32:35]
  v_mfma_f32_16x16x32_bf16 v[36:39], a[68:71], v[92:95], v[36:39]
  v_mfma_f32_16x16x32_bf16 v[40:43], a[148:151], v[88:91], v[40:43]
  v_mfma_f32_16x16x32_bf16 v[44:47], a[148:151], v[92:95], v[44:47]
  v_mfma_f32_16x16x32_bf16 v[48:51], a[228:231], v[88:91], v[48:51]
  v_mfma_f32_16x16x32_bf16 v[52:55], a[228:231], v[92:95], v[52:55]
  v_mfma_f32_16x16x32_bf16 v[56:59], v[164:167], v[88:91], v[56:59]
  v_mfma_f32_16x16x32_bf16 v[60:63], v[164:167], v[92:95], v[60:63]
  v_mfma_f32_16x16x32_bf16 v[64:67], v[88:91], v[244:247], v[64:67]
  v_mfma_f32_16x16x32_bf16 v[68:71], v[92:95], v[244:247], v[68:71]
  s_waitcnt lgkmcnt(2)
  v_mfma_f32_16x16x32_bf16 v[32:35], a[72:75], v[72:75], v[32:35]
  v_mfma_f32_16x16x32_bf16 v[36:39], a[72:75], v[76:79], v[36:39]
  v_mfma_f32_16x16x32_bf16 v[40:43], a[152:155], v[72:75], v[40:43]
  v_mfma_f32_16x16x32_bf16 v[44:47], a[152:155], v[76:79], v[44:47]
  v_mfma_f32_16x16x32_bf16 v[48:51], a[232:235], v[72:75], v[48:51]
  v_mfma_f32_16x16x32_bf16 v[52:55], a[232:235], v[76:79], v[52:55]
  v_mfma_f32_16x16x32_bf16 v[56:59], v[168:171], v[72:75], v[56:59]
  v_mfma_f32_16x16x32_bf16 v[60:63], v[168:171], v[76:79], v[60:63]
  v_mfma_f32_16x16x32_bf16 v[64:67], v[72:75], v[248:251], v[64:67]
  v_mfma_f32_16x16x32_bf16 v[68:71], v[76:79], v[248:251], v[68:71]
  s_waitcnt lgkmcnt(0)
  v_mfma_f32_16x16x32_bf16 v[32:35], a[76:79], v[80:83], v[32:35]
  v_mfma_f32_16x16x32_bf16 v[36:39], a[76:79], v[84:87], v[36:39]
  v_mfma_f32_16x16x32_bf16 v[40:43], a[156:159], v[80:83], v[40:43]
  v_mfma_f32_16x16x32_bf16 v[44:47], a[156:159], v[84:87], v[44:47]
  v_mfma_f32_16x16x32_bf16 v[48:51], a[236:239], v[80:83], v[48:51]
  v_mfma_f32_16x16x32_bf16 v[52:55], a[236:239], v[84:87], v[52:55]
  v_mfma_f32_16x16x32_bf16 v[56:59], v[172:175], v[80:83], v[56:59]
  v_mfma_f32_16x16x32_bf16 v[60:63], v[172:175], v[84:87], v[60:63]
  v_mfma_f32_16x16x32_bf16 v[64:67], v[80:83], v[252:255], v[64:67]
  v_mfma_f32_16x16x32_bf16 v[68:71], v[84:87], v[252:255], v[68:71]
  v_cvt_pk_bf16_f32 v8, v32, v33
  v_cvt_pk_bf16_f32 v9, v34, v35
  v_cvt_pk_bf16_f32 v10, v40, v41
  v_cvt_pk_bf16_f32 v11, v42, v43
  s_add_u32 s34, s21, 0
  buffer_store_dwordx4 v[8:11], v1, s[4:7], s34 offen sc1
  v_cvt_pk_bf16_f32 v12, v36, v37
  v_cvt_pk_bf16_f32 v13, v38, v39
  v_cvt_pk_bf16_f32 v14, v44, v45
  v_cvt_pk_bf16_f32 v15, v46, v47
  s_add_u32 s34, s21, 6144
  buffer_store_dwordx4 v[12:15], v1, s[4:7], s34 offen sc1
  v_cvt_pk_bf16_f32 v8, v48, v49
  v_cvt_pk_bf16_f32 v9, v50, v51
  v_cvt_pk_bf16_f32 v10, v56, v57
  v_cvt_pk_bf16_f32 v11, v58, v59
  s_add_u32 s34, s21, 1024
  buffer_store_dwordx4 v[8:11], v1, s[4:7], s34 offen sc1
  v_cvt_pk_bf16_f32 v12, v52, v53
  v_cvt_pk_bf16_f32 v13, v54, v55
  v_cvt_pk_bf16_f32 v14, v60, v61
  v_cvt_pk_bf16_f32 v15, v62, v63
  s_add_u32 s34, s21, 7168
  buffer_store_dwordx4 v[12:15], v1, s[4:7], s34 offen sc1
  v_cvt_pk_bf16_f32 v8, v64, v65
  v_cvt_pk_bf16_f32 v9, v66, v67
  v_cvt_pk_bf16_f32 v10, v68, v69
  v_cvt_pk_bf16_f32 v11, v70, v71
  s_add_u32 s34, s23, 0
  buffer_store_dwordx4 v[8:11], v1, s[4:7], s34 offen sc1
  s_waitcnt vmcnt(0)
  s_barrier
  s_add_u32 s17, s17, 1
  v_mov_b32 v28, s17
  buffer_store_dword v28, v4, s[4:7], s24 offen sc1
  s_cmp_lt_u32 s17, 64
  s_cbranch_scc1 reca_ptop238
  s_branch reca_exit1
reca_pw1_227:
  s_mov_b32 s17, 0
  s_mov_b32 s26, 0
  s_mul_i32 s20, s17, 40960
  s_add_u32 s20, s20, 153626624
  s_add_u32 m0, s26, 10240
  s_nop 0
  buffer_load_dwordx4 v1, s[4:7], s20 offen offset:0 lds
  buffer_load_dwordx4 v1, s[4:7], s20 offen offset:1024 lds
  buffer_load_dwordx4 v1, s[4:7], s20 offen offset:2048 lds
  buffer_load_dwordx4 v1, s[4:7], s20 offen offset:3072 lds
  s_add_u32 s20, s20, 4096
  s_add_u32 m0, s26, 14336
  s_nop 0
  buffer_load_dwordx4 v1, s[4:7], s20 offen offset:0 lds
  buffer_load_dwordx4 v1, s[4:7], s20 offen offset:1024 lds
  buffer_load_dwordx4 v1, s[4:7], s20 offen offset:2048 lds
  buffer_load_dwordx4 v1, s[4:7], s20 offen offset:3072 lds
  s_add_u32 s20, s20, 4096
  s_add_u32 m0, s26, 18432
  s_nop 0
  buffer_load_dwordx4 v1, s[4:7], s20 offen offset:0 lds
  buffer_load_dwordx4 v1, s[4:7], s20 offen offset:1024 lds
  s_lshl_b32 s34, s15, 6
  s_add_u32 s34, s34, s17
  s_mul_i32 s34, s34, 12288
  s_mul_i32 s35, s16, 3072
  s_add_u32 s35, s35, s34
  s_add_u32 s27, s35, 37748736
  s_mul_i32 s35, s16, 6144
  s_add_u32 s35, s35, s34
  s_add_u32 s28, s35, 62914560
  s_add_u32 s34, s27, 2048
  buffer_load_dwordx4 v[16:19], v1, s[4:7], s34 offen sc1
  s_add_u32 s34, s27, 8192
  buffer_load_dwordx4 v[16:19], v1, s[4:7], s34 offen sc1
  s_add_u32 s34, s28, 1024
  buffer_load_dwordx4 v[16:19], v1, s[4:7], s34 offen sc1
  s_add_u32 s34, s28, 2048
  buffer_load_dwordx4 v[16:19], v1, s[4:7], s34 offen sc1
  s_add_u32 s34, s28, 3072
  buffer_load_dwordx4 v[16:19], v1, s[4:7], s34 offen sc1
  s_mul_i32 s34, s15, 12
  s_mul_i32 s35, s16, 6
  s_add_u32 s34, s34, s35
  s_add_u32 s34, s34, 4
  s_mul_i32 s34, s34, 20480
  s_add_u32 s34, s34, 14155776
  buffer_load_dwordx4 a[0:3], v1, s[4:7], s34 offen offset:0
  buffer_load_dwordx4 a[4:7], v1, s[4:7], s34 offen offset:1024
  buffer_load_dwordx4 a[8:11], v1, s[4:7], s34 offen offset:2048
  buffer_load_dwordx4 a[12:15], v1, s[4:7], s34 offen offset:3072
  s_add_u32 s34, s34, 4096
  buffer_load_dwordx4 a[16:19], v1, s[4:7], s34 offen offset:0
  buffer_load_dwordx4 a[20:23], v1, s[4:7], s34 offen offset:1024
  buffer_load_dwordx4 a[24:27], v1, s[4:7], s34 offen offset:2048
  buffer_load_dwordx4 a[28:31], v1, s[4:7], s34 offen offset:3072
  s_add_u32 s34, s34, 4096
  buffer_load_dwordx4 a[32:35], v1, s[4:7], s34 offen offset:0
  buffer_load_dwordx4 a[36:39], v1, s[4:7], s34 offen offset:1024
  buffer_load_dwordx4 a[40:43], v1, s[4:7], s34 offen offset:2048
  buffer_load_dwordx4 a[44:47], v1, s[4:7], s34 offen offset:3072
  s_add_u32 s34, s34, 4096
  buffer_load_dwordx4 a[48:51], v1, s[4:7], s34 offen offset:0
  buffer_load_dwordx4 a[52:55], v1, s[4:7], s34 offen offset:1024
  buffer_load_dwordx4 a[56:59], v1, s[4:7], s34 offen offset:2048
  buffer_load_dwordx4 a[60:63], v1, s[4:7], s34 offen offset:3072
  s_add_u32 s34, s34, 4096
  buffer_load_dwordx4 a[64:67], v1, s[4:7], s34 offen offset:0
  buffer_load_dwordx4 a[68:71], v1, s[4:7], s34 offen offset:1024
  buffer_load_dwordx4 a[72:75], v1, s[4:7], s34 offen offset:2048
  buffer_load_dwordx4 a[76:79], v1, s[4:7], s34 offen offset:3072
  s_mul_i32 s34, s15, 12
  s_mul_i32 s35, s16, 6
  s_add_u32 s34, s34, s35
  s_add_u32 s34, s34, 5
  s_mul_i32 s34, s34, 20480
  s_add_u32 s34, s34, 14155776
  buffer_load_dwordx4 a[80:83], v1, s[4:7], s34 offen offset:0
  buffer_load_dwordx4 a[84:87], v1, s[4:7], s34 offen offset:1024
  buffer_load_dwordx4 a[88:91], v1, s[4:7], s34 offen offset:2048
  buffer_load_dwordx4 a[92:95], v1, s[4:7], s34 offen offset:3072
  s_add_u32 s34, s34, 4096
  buffer_load_dwordx4 a[96:99], v1, s[4:7], s34 offen offset:0
  buffer_load_dwordx4 a[100:103], v1, s[4:7], s34 offen offset:1024
  buffer_load_dwordx4 a[104:107], v1, s[4:7], s34 offen offset:2048
  buffer_load_dwordx4 a[108:111], v1, s[4:7], s34 offen offset:3072
  s_add_u32 s34, s34, 4096
  buffer_load_dwordx4 a[112:115], v1, s[4:7], s34 offen offset:0
  buffer_load_dwordx4 a[116:119], v1, s[4:7], s34 offen offset:1024
  buffer_load_dwordx4 a[120:123], v1, s[4:7], s34 offen offset:2048
  buffer_load_dwordx4 a[124:127], v1, s[4:7], s34 offen offset:3072
  s_add_u32 s34, s34, 4096
  buffer_load_dwordx4 a[128:131], v1, s[4:7], s34 offen offset:0
  buffer_load_dwordx4 a[132:135], v1, s[4:7], s34 offen offset:1024
  buffer_load_dwordx4 a[136:139], v1, s[4:7], s34 offen offset:2048
  buffer_load_dwordx4 a[140:143], v1, s[4:7], s34 offen offset:3072
  s_add_u32 s34, s34, 4096
  buffer_load_dwordx4 a[144:147], v1, s[4:7], s34 offen offset:0
  buffer_load_dwordx4 a[148:151], v1, s[4:7], s34 offen offset:1024
  buffer_load_dwordx4 a[152:155], v1, s[4:7], s34 offen offset:2048
  buffer_load_dwordx4 a[156:159], v1, s[4:7], s34 offen offset:3072
  s_waitcnt vmcnt(20)
  s_mul_i32 s34, s15, 12
  s_mul_i32 s35, s16, 6
  s_add_u32 s34, s34, s35
  s_add_u32 s34, s34, 1
  s_mul_i32 s34, s34, 20480
  s_add_u32 s34, s34, 22020096
  buffer_load_dwordx4 a[160:163], v1, s[4:7], s34 offen offset:0
  buffer_load_dwordx4 a[164:167], v1, s[4:7], s34 offen offset:1024
  buffer_load_dwordx4 a[168:171], v1, s[4:7], s34 offen offset:2048
  buffer_load_dwordx4 a[172:175], v1, s[4:7], s34 offen offset:3072
  s_add_u32 s34, s34, 4096
  buffer_load_dwordx4 a[176:179], v1, s[4:7], s34 offen offset:0
  buffer_load_dwordx4 a[180:183], v1, s[4:7], s34 offen offset:1024
  buffer_load_dwordx4 a[184:187], v1, s[4:7], s34 offen offset:2048
  buffer_load_dwordx4 a[188:191], v1, s[4:7], s34 offen offset:3072
  s_add_u32 s34, s34, 4096
  buffer_load_dwordx4 a[192:195], v1, s[4:7], s34 offen offset:0
  buffer_load_dwordx4 a[196:199], v1, s[4:7], s34 offen offset:1024
  buffer_load_dwordx4 a[200:203], v1, s[4:7], s34 offen offset:2048
  buffer_load_dwordx4 a[204:207], v1, s[4:7], s34 offen offset:3072
  s_add_u32 s34, s34, 4096
  buffer_load_dwordx4 a[208:211], v1, s[4:7], s34 offen offset:0
  buffer_load_dwordx4 a[212:215], v1, s[4:7], s34 offen offset:1024
  buffer_load_dwordx4 a[216:219], v1, s[4:7], s34 offen offset:2048
  buffer_load_dwordx4 a[220:223], v1, s[4:7], s34 offen offset:3072
  s_add_u32 s34, s34, 4096
  buffer_load_dwordx4 a[224:227], v1, s[4:7], s34 offen offset:0
  buffer_load_dwordx4 a[228:231], v1, s[4:7], s34 offen offset:1024
  buffer_load_dwordx4 a[232:235], v1, s[4:7], s34 offen offset:2048
  buffer_load_dwordx4 a[236:239], v1, s[4:7], s34 offen offset:3072
  s_waitcnt vmcnt(20)
  s_mul_i32 s34, s15, 12
  s_mul_i32 s35, s16, 6
  s_add_u32 s34, s34, s35
  s_add_u32 s34, s34, 2
  s_mul_i32 s34, s34, 20480
  s_add_u32 s34, s34, 22020096
  buffer_load_dwordx4 v[96:99], v1, s[4:7], s34 offen offset:0
  buffer_load_dwordx4 v[100:103], v1, s[4:7], s34 offen offset:1024
  buffer_load_dwordx4 v[104:107], v1, s[4:7], s34 offen offset:2048
  buffer_load_dwordx4 v[108:111], v1, s[4:7], s34 offen offset:3072
  s_add_u32 s34, s34, 4096
  buffer_load_dwordx4 v[112:115], v1, s[4:7], s34 offen offset:0
  buffer_load_dwordx4 v[116:119], v1, s[4:7], s34 offen offset:1024
  buffer_load_dwordx4 v[120:123], v1, s[4:7], s34 offen offset:2048
  buffer_load_dwordx4 v[124:127], v1, s[4:7], s34 offen offset:3072
  s_add_u32 s34, s34, 4096
  buffer_load_dwordx4 v[128:131], v1, s[4:7], s34 offen offset:0
  buffer_load_dwordx4 v[132:135], v1, s[4:7], s34 offen offset:1024
  buffer_load_dwordx4 v[136:139], v1, s[4:7], s34 offen offset:2048
  buffer_load_dwordx4 v[140:143], v1, s[4:7], s34 offen offset:3072
  s_add_u32 s34, s34, 4096
  buffer_load_dwordx4 v[144:147], v1, s[4:7], s34 offen offset:0
  buffer_load_dwordx4 v[148:151], v1, s[4:7], s34 offen offset:1024
  buffer_load_dwordx4 v[152:155], v1, s[4:7], s34 offen offset:2048
  buffer_load_dwordx4 v[156:159], v1, s[4:7], s34 offen offset:3072
  s_add_u32 s34, s34, 4096
  buffer_load_dwordx4 v[160:163], v1, s[4:7], s34 offen offset:0
  buffer_load_dwordx4 v[164:167], v1, s[4:7], s34 offen offset:1024
  buffer_load_dwordx4 v[168:171], v1, s[4:7], s34 offen offset:2048
  buffer_load_dwordx4 v[172:175], v1, s[4:7], s34 offen offset:3072
  s_waitcnt vmcnt(20)
  s_mul_i32 s34, s15, 12
  s_mul_i32 s35, s16, 6
  s_add_u32 s34, s34, s35
  s_add_u32 s34, s34, 3
  s_mul_i32 s34, s34, 20480
  s_add_u32 s34, s34, 22020096
  buffer_load_dwordx4 v[176:179], v1, s[4:7], s34 offen offset:0
  buffer_load_dwordx4 v[180:183], v1, s[4:7], s34 offen offset:1024
  buffer_load_dwordx4 v[184:187], v1, s[4:7], s34 offen offset:2048
  buffer_load_dwordx4 v[188:191], v1, s[4:7], s34 offen offset:3072
  s_add_u32 s34, s34, 4096
  buffer_load_dwordx4 v[192:195], v1, s[4:7], s34 offen offset:0
  buffer_load_dwordx4 v[196:199], v1, s[4:7], s34 offen offset:1024
  buffer_load_dwordx4 v[200:203], v1, s[4:7], s34 offen offset:2048
  buffer_load_dwordx4 v[204:207], v1, s[4:7], s34 offen offset:3072
  s_add_u32 s34, s34, 4096
  buffer_load_dwordx4 v[208:211], v1, s[4:7], s34 offen offset:0
  buffer_load_dwordx4 v[212:215], v1, s[4:7], s34 offen offset:1024
  buffer_load_dwordx4 v[216:219], v1, s[4:7], s34 offen offset:2048
  buffer_load_dwordx4 v[220:223], v1, s[4:7], s34 offen offset:3072
  s_add_u32 s34, s34, 4096
  buffer_load_dwordx4 v[224:227], v1, s[4:7], s34 offen offset:0
  buffer_load_dwordx4 v[228:231], v1, s[4:7], s34 offen offset:1024
  buffer_load_dwordx4 v[232:235], v1, s[4:7], s34 offen offset:2048
  buffer_load_dwordx4 v[236:239], v1, s[4:7], s34 offen offset:3072
  s_add_u32 s34, s34, 4096
  buffer_load_dwordx4 v[240:243], v1, s[4:7], s34 offen offset:0
  buffer_load_dwordx4 v[244:247], v1, s[4:7], s34 offen offset:1024
  buffer_load_dwordx4 v[248:251], v1, s[4:7], s34 offen offset:2048
  buffer_load_dwordx4 v[252:255], v1, s[4:7], s34 offen offset:3072
  s_waitcnt vmcnt(20)
  v_and_b32 v30, 7, v0
  v_lshlrev_b32 v30, 3, v30
reca_cens243:
  buffer_load_dwordx2 v[28:29], v30, s[8:11], 0 offen sc1
  s_waitcnt vmcnt(0)
  v_sad_u8 v31, v28, 0, 0
  v_sad_u8 v31, v29, 0, v31
  v_cmp_gt_u32 vcc, 32, v31
  s_cbranch_vccz reca_censok244
  s_sleep 8
  s_sub_u32 s18, s18, 1
  s_cbranch_scc0 reca_cens243
  s_mov_b32 s18, 0
reca_censok244:
  v_and_b32 v28, 0x20202020, v28
  v_and_b32 v29, 0x20202020, v29
  v_cmp_ne_u32 s[34:35], 0, v28
  v_cmp_ne_u32 s[36:37], 0, v29
  s_nop 3
  s_and_b32 s34, s34, 0xff
  s_and_b32 s36, s36, 0xff
  s_or_b32 s35, s34, s36
  s_lshr_b32 s37, s35, s13
  s_and_b32 s37, s37, 1
  s_xor_b32 s43, s37, 1
  s_cmp_eq_u32 s57, 0
  s_cselect_b32 s58, s36, s34
  v_mov_b32 v31, 0x80000000
  s_cmp_lg_u32 s43, 0
  s_cbranch_scc1 reca_pslow245
reca_ptop246:
  s_cmp_lt_u32 s17, 6
  s_cbranch_scc1 reca_pgo247
  s_sub_u32 s36, s17, 6
reca_ppoll248:
  buffer_load_dword v28, v4, s[4:7], s25 offen sc1
  s_waitcnt vmcnt(0)
  v_readfirstlane_b32 s34, v28
  s_nop 3
  s_cmp_ge_i32 s34, s36
  s_cbranch_scc1 reca_pgo247
  s_sleep 8
  s_sub_u32 s18, s18, 1
  s_cbranch_scc0 reca_ppoll248
  s_mov_b32 s18, 0
reca_pgo247:
  s_waitcnt vmcnt(0)
  s_barrier
  v_add_u32 v7, s26, v1
  s_xor_b32 s26, s26, 40960
  s_add_u32 s37, s17, 1
  s_cmp_ge_u32 s37, 64
  s_cbranch_scc1 reca_pnodma249
  s_mul_i32 s20, s37, 40960
  s_add_u32 s20, s20, 153626624
  s_add_u32 m0, s26, 10240
  s_nop 0
  buffer_load_dwordx4 v1, s[4:7], s20 offen offset:0 lds
  buffer_load_dwordx4 v1, s[4:7], s20 offen offset:1024 lds
  buffer_load_dwordx4 v1, s[4:7], s20 offen offset:2048 lds
  buffer_load_dwordx4 v1, s[4:7], s20 offen offset:3072 lds
  s_add_u32 s20, s20, 4096
  s_add_u32 m0, s26, 14336
  s_nop 0
  buffer_load_dwordx4 v1, s[4:7], s20 offen offset:0 lds
  buffer_load_dwordx4 v1, s[4:7], s20 offen offset:1024 lds
  buffer_load_dwordx4 v1, s[4:7], s20 offen offset:2048 lds
  buffer_load_dwordx4 v1, s[4:7], s20 offen offset:3072 lds
  s_add_u32 s20, s20, 4096
  s_add_u32 m0, s26, 18432
  s_nop 0
  buffer_load_dwordx4 v1, s[4:7], s20 offen offset:0 lds
  buffer_load_dwordx4 v1, s[4:7], s20 offen offset:1024 lds
  s_lshl_b32 s34, s15, 6
  s_add_u32 s34, s34, s37
  s_mul_i32 s34, s34, 12288
  s_mul_i32 s35, s16, 3072
  s_add_u32 s35, s35, s34
  s_add_u32 s27, s35, 37748736
  s_mul_i32 s35, s16, 6144
  s_add_u32 s35, s35, s34
  s_add_u32 s28, s35, 62914560
  s_add_u32 s34, s27, 2048
  buffer_load_dwordx4 v[16:19], v1, s[4:7], s34 offen sc1
  s_add_u32 s34, s27, 8192
  buffer_load_dwordx4 v[16:19], v1, s[4:7], s34 offen sc1
  s_add_u32 s34, s28, 1024
  buffer_load_dwordx4 v[16:19], v1, s[4:7], s34 offen sc1
  s_add_u32 s34, s28, 2048
  buffer_load_dwordx4 v[16:19], v1, s[4:7], s34 offen sc1
  s_add_u32 s34, s28, 3072
  buffer_load_dwordx4 v[16:19], v1, s[4:7], s34 offen sc1
reca_pnodma249:
  s_lshl_b32 s34, s15, 6
  s_add_u32 s34, s34, s17
  s_mul_i32 s34, s34, 12288
  s_mul_i32 s35, s16, 3072
  s_add_u32 s35, s35, s34
  s_add_u32 s21, s35, 37748736
  s_add_u32 s22, s35, 88080384
  s_mul_i32 s35, s16, 6144
  s_add_u32 s35, s35, s34
  s_add_u32 s23, s35, 62914560
  ds_read_b128 v[72:75], v7 offset:0
  ds_read_b128 v[76:79], v7 offset:20480
  ds_read_b128 v[80:83], v7 offset:1024
  ds_read_b128 v[84:87], v7 offset:21504
  ds_read_b128 v[88:91], v7 offset:2048
  ds_read_b128 v[92:95], v7 offset:22528
  s_waitcnt lgkmcnt(4)
  v_mfma_f32_16x16x32_bf16 v[32:35], a[0:3], v[72:75], 0
  v_mfma_f32_16x16x32_bf16 v[36:39], a[0:3], v[76:79], 0
  v_mfma_f32_16x16x32_bf16 v[40:43], a[80:83], v[72:75], 0
  v_mfma_f32_16x16x32_bf16 v[44:47], a[80:83], v[76:79], 0
  v_mfma_f32_16x16x32_bf16 v[48:51], v[72:75], a[160:163], 0
  v_mfma_f32_16x16x32_bf16 v[52:55], v[76:79], a[160:163], 0
  v_mfma_f32_16x16x32_bf16 v[56:59], v[72:75], v[96:99], 0
  v_mfma_f32_16x16x32_bf16 v[60:63], v[76:79], v[96:99], 0
  v_mfma_f32_16x16x32_bf16 v[64:67], v[72:75], v[176:179], 0
  v_mfma_f32_16x16x32_bf16 v[68:71], v[76:79], v[176:179], 0
  ds_read_b128 v[72:75], v7 offset:3072
  ds_read_b128 v[76:79], v7 offset:23552
  s_waitcnt lgkmcnt(4)
  v_mfma_f32_16x16x32_bf16 v[32:35], a[4:7], v[80:83], v[32:35]
  v_mfma_f32_16x16x32_bf16 v[36:39], a[4:7], v[84:87], v[36:39]
  v_mfma_f32_16x16x32_bf16 v[40:43], a[84:87], v[80:83], v[40:43]
  v_mfma_f32_16x16x32_bf16 v[44:47], a[84:87], v[84:87], v[44:47]
  v_mfma_f32_16x16x32_bf16 v[48:51], v[80:83], a[164:167], v[48:51]
  v_mfma_f32_16x16x32_bf16 v[52:55], v[84:87], a[164:167], v[52:55]
  v_mfma_f32_16x16x32_bf16 v[56:59], v[80:83], v[100:103], v[56:59]
  v_mfma_f32_16x16x32_bf16 v[60:63], v[84:87], v[100:103], v[60:63]
  v_mfma_f32_16x16x32_bf16 v[64:67], v[80:83], v[180:183], v[64:67]
  v_mfma_f32_16x16x32_bf16 v[68:71], v[84:87], v[180:183], v[68:71]
  ds_read_b128 v[80:83], v7 offset:4096
  ds_read_b128 v[84:87], v7 offset:24576
  s_waitcnt lgkmcnt(4)
  v_mfma_f32_16x16x32_bf16 v[32:35], a[8:11], v[88:91], v[32:35]
  v_mfma_f32_16x16x32_bf16 v[36:39], a[8:11], v[92:95], v[36:39]
  v_mfma_f32_16x16x32_bf16 v[40:43], a[88:91], v[88:91], v[40:43]
  v_mfma_f32_16x16x32_bf16 v[44:47], a[88:91], v[92:95], v[44:47]
  v_mfma_f32_16x16x32_bf16 v[48:51], v[88:91], a[168:171], v[48:51]
  v_mfma_f32_16x16x32_bf16 v[52:55], v[92:95], a[168:171], v[52:55]
  v_mfma_f32_16x16x32_bf16 v[56:59], v[88:91], v[104:107], v[56:59]
  v_mfma_f32_16x16x32_bf16 v[60:63], v[92:95], v[104:107], v[60:63]
  v_mfma_f32_16x16x32_bf16 v[64:67], v[88:91], v[184:187], v[64:67]
  v_mfma_f32_16x16x32_bf16 v[68:71], v[92:95], v[184:187], v[68:71]
  ds_read_b128 v[88:91], v7 offset:5120
  ds_read_b128 v[92:95], v7 offset:25600
  s_waitcnt lgkmcnt(4)
  v_mfma_f32_16x16x32_bf16 v[32:35], a[12:15], v[72:75], v[32:35]
  v_mfma_f32_16x16x32_bf16 v[36:39], a[12:15], v[76:79], v[36:39]
  v_mfma_f32_16x16x32_bf16 v[40:43], a[92:95], v[72:75], v[40:43]
  v_mfma_f32_16x16x32_bf16 v[44:47], a[92:95], v[76:79], v[44:47]
  v_mfma_f32_16x16x32_bf16 v[48:51], v[72:75], a[172:175], v[48:51]
  v_mfma_f32_16x16x32_bf16 v[52:55], v[76:79], a[172:175], v[52:55]
  v_mfma_f32_16x16x32_bf16 v[56:59], v[72:75], v[108:111], v[56:59]
  v_mfma_f32_16x16x32_bf16 v[60:63], v[76:79], v[108:111], v[60:63]
  v_mfma_f32_16x16x32_bf16 v[64:67], v[72:75], v[188:191], v[64:67]
  v_mfma_f32_16x16x32_bf16 v[68:71], v[76:79], v[188:191], v[68:71]
  ds_read_b128 v[72:75], v7 offset:6144
  ds_read_b128 v[76:79], v7 offset:26624
  s_waitcnt lgkmcnt(4)
  v_mfma_f32_16x16x32_bf16 v[32:35], a[16:19], v[80:83], v[32:35]
  v_mfma_f32_16x16x32_bf16 v[36:39], a[16:19], v[84:87], v[36:39]
  v_mfma_f32_16x16x32_bf16 v[40:43], a[96:99], v[80:83], v[40:43]
  v_mfma_f32_16x16x32_bf16 v[44:47], a[96:99], v[84:87], v[44:47]
  v_mfma_f32_16x16x32_bf16 v[48:51], v[80:83], a[176:179], v[48:51]
  v_mfma_f32_16x16x32_bf16 v[52:55], v[84:87], a[176:179], v[52:55]
  v_mfma_f32_16x16x32_bf16 v[56:59], v[80:83], v[112:115], v[56:59]
  v_mfma_f32_16x16x32_bf16 v[60:63], v[84:87], v[112:115], v[60:63]
  v_mfma_f32_16x16x32_bf16 v[64:67], v[80:83], v[192:195], v[64:67]
  v_mfma_f32_16x16x32_bf16 v[68:71], v[84:87], v[192:195], v[68:71]
  ds_read_b128 v[80:83], v7 offset:7168
  ds_read_b128 v[84:87], v7 offset:27648
  s_waitcnt lgkmcnt(4)
  v_mfma_f32_16x16x32_bf16 v[32:35], a[20:23], v[88:91], v[32:35]
  v_mfma_f32_16x16x32_bf16 v[36:39], a[20:23], v[92:95], v[36:39]
  v_mfma_f32_16x16x32_bf16 v[40:43], a[100:103], v[88:91], v[40:43]
  v_mfma_f32_16x16x32_bf16 v[44:47], a[100:103], v[92:95], v[44:47]
  v_mfma_f32_16x16x32_bf16 v[48:51], v[88:91], a[180:183], v[48:51]
  v_mfma_f32_16x16x32_bf16 v[52:55], v[92:95], a[180:183], v[52:55]
  v_mfma_f32_16x16x32_bf16 v[56:59], v[88:91], v[116:119], v[56:59]
  v_mfma_f32_16x16x32_bf16 v[60:63], v[92:95], v[116:119], v[60:63]
  v_mfma_f32_16x16x32_bf16 v[64:67], v[88:91], v[196:199], v[64:67]
  v_mfma_f32_16x16x32_bf16 v[68:71], v[92:95], v[196:199], v[68:71]
  ds_read_b128 v[88:91], v7 offset:8192
  ds_read_b128 v[92:95], v7 offset:28672
  s_waitcnt lgkmcnt(4)
  v_mfma_f32_16x16x32_bf16 v[32:35], a[24:27], v[72:75], v[32:35]
  v_mfma_f32_16x16x32_bf16 v[36:39], a[24:27], v[76:79], v[36:39]
  v_mfma_f32_16x16x32_bf16 v[40:43], a[104:107], v[72:75], v[40:43]
  v_mfma_f32_16x16x32_bf16 v[44:47], a[104:107], v[76:79], v[44:47]
  v_mfma_f32_16x16x32_bf16 v[48:51], v[72:75], a[184:187], v[48:51]
  v_mfma_f32_16x16x32_bf16 v[52:55], v[76:79], a[184:187], v[52:55]
  v_mfma_f32_16x16x32_bf16 v[56:59], v[72:75], v[120:123], v[56:59]
  v_mfma_f32_16x16x32_bf16 v[60:63], v[76:79], v[120:123], v[60:63]
  v_mfma_f32_16x16x32_bf16 v[64:67], v[72:75], v[200:203], v[64:67]
  v_mfma_f32_16x16x32_bf16 v[68:71], v[76:79], v[200:203], v[68:71]
  ds_read_b128 v[72:75], v7 offset:9216
  ds_read_b128 v[76:79], v7 offset:29696
  s_waitcnt lgkmcnt(4)
  v_mfma_f32_16x16x32_bf16 v[32:35], a[28:31], v[80:83], v[32:35]
  v_mfma_f32_16x16x32_bf16 v[36:39], a[28:31], v[84:87], v[36:39]
  v_mfma_f32_16x16x32_bf16 v[40:43], a[108:111], v[80:83], v[40:43]
  v_mfma_f32_16x16x32_bf16 v[44:47], a[108:111], v[84:87], v[44:47]
  v_mfma_f32_16x16x32_bf16 v[48:51], v[80:83], a[188:191], v[48:51]
  v_mfma_f32_16x16x32_bf16 v[52:55], v[84:87], a[188:191], v[52:55]
  v_mfma_f32_16x16x32_bf16 v[56:59], v[80:83], v[124:127], v[56:59]
  v_mfma_f32_16x16x32_bf16 v[60:63], v[84:87], v[124:127], v[60:63]
  v_mfma_f32_16x16x32_bf16 v[64:67], v[80:83], v[204:207], v[64:67]
  v_mfma_f32_16x16x32_bf16 v[68:71], v[84:87], v[204:207], v[68:71]
  ds_read_b128 v[80:83], v7 offset:10240
  ds_read_b128 v[84:87], v7 offset:30720
  s_waitcnt lgkmcnt(4)
  v_mfma_f32_16x16x32_bf16 v[32:35], a[32:35], v[88:91], v[32:35]
  v_mfma_f32_16x16x32_bf16 v[36:39], a[32:35], v[92:95], v[36:39]
  v_mfma_f32_16x16x32_bf16 v[40:43], a[112:115], v[88:91], v[40:43]
  v_mfma_f32_16x16x32_bf16 v[44:47], a[112:115], v[92:95], v[44:47]
  v_mfma_f32_16x16x32_bf16 v[48:51], v[88:91], a[192:195], v[48:51]
  v_mfma_f32_16x16x32_bf16 v[52:55], v[92:95], a[192:195], v[52:55]
  v_mfma_f32_16x16x32_bf16 v[56:59], v[88:91], v[128:131], v[56:59]
  v_mfma_f32_16x16x32_bf16 v[60:63], v[92:95], v[128:131], v[60:63]
  v_mfma_f32_16x16x32_bf16 v[64:67], v[88:91], v[208:211], v[64:67]
  v_mfma_f32_16x16x32_bf16 v[68:71], v[92:95], v[208:211], v[68:71]
  ds_read_b128 v[88:91], v7 offset:11264
  ds_read_b128 v[92:95], v7 offset:31744
  s_waitcnt lgkmcnt(4)
  v_mfma_f32_16x16x32_bf16 v[32:35], a[36:39], v[72:75], v[32:35]
  v_mfma_f32_16x16x32_bf16 v[36:39], a[36:39], v[76:79], v[36:39]
  v_mfma_f32_16x16x32_bf16 v[40:43], a[116:119], v[72:75], v[40:43]
  v_mfma_f32_16x16x32_bf16 v[44:47], a[116:119], v[76:79], v[44:47]
  v_mfma_f32_16x16x32_bf16 v[48:51], v[72:75], a[196:199], v[48:51]
  v_mfma_f32_16x16x32_bf16 v[52:55], v[76:79], a[196:199], v[52:55]
  v_mfma_f32_16x16x32_bf16 v[56:59], v[72:75], v[132:135], v[56:59]
  v_mfma_f32_16x16x32_bf16 v[60:63], v[76:79], v[132:135], v[60:63]
  v_mfma_f32_16x16x32_bf16 v[64:67], v[72:75], v[212:215], v[64:67]
  v_mfma_f32_16x16x32_bf16 v[68:71], v[76:79], v[212:215], v[68:71]
  ds_read_b128 v[72:75], v7 offset:12288
  ds_read_b128 v[76:79], v7 offset:32768
  s_waitcnt lgkmcnt(4)
  v_mfma_f32_16x16x32_bf16 v[32:35], a[40:43], v[80:83], v[32:35]
  v_mfma_f32_16x16x32_bf16 v[36:39], a[40:43], v[84:87], v[36:39]
  v_mfma_f32_16x16x32_bf16 v[40:43], a[120:123], v[80:83], v[40:43]
  v_mfma_f32_16x16x32_bf16 v[44:47], a[120:123], v[84:87], v[44:47]
  v_mfma_f32_16x16x32_bf16 v[48:51], v[80:83], a[200:203], v[48:51]
  v_mfma_f32_16x16x32_bf16 v[52:55], v[84:87], a[200:203], v[52:55]
  v_mfma_f32_16x16x32_bf16 v[56:59], v[80:83], v[136:139], v[56:59]
  v_mfma_f32_16x16x32_bf16 v[60:63], v[84:87], v[136:139], v[60:63]
  v_mfma_f32_16x16x32_bf16 v[64:67], v[80:83], v[216:219], v[64:67]
  v_mfma_f32_16x16x32_bf16 v[68:71], v[84:87], v[216:219], v[68:71]
  ds_read_b128 v[80:83], v7 offset:13312
  ds_read_b128 v[84:87], v7 offset:33792
  s_waitcnt lgkmcnt(4)
  v_mfma_f32_16x16x32_bf16 v[32:35], a[44:47], v[88:91], v[32:35]
  v_mfma_f32_16x16x32_bf16 v[36:39], a[44:47], v[92:95], v[36:39]
  v_mfma_f32_16x16x32_bf16 v[40:43], a[124:127], v[88:91], v[40:43]
  v_mfma_f32_16x16x32_bf16 v[44:47], a[124:127], v[92:95], v[44:47]
  v_mfma_f32_16x16x32_bf16 v[48:51], v[88:91], a[204:207], v[48:51]
  v_mfma_f32_16x16x32_bf16 v[52:55], v[92:95], a[204:207], v[52:55]
  v_mfma_f32_16x16x32_bf16 v[56:59], v[88:91], v[140:143], v[56:59]
  v_mfma_f32_16x16x32_bf16 v[60:63], v[92:95], v[140:143], v[60:63]
  v_mfma_f32_16x16x32_bf16 v[64:67], v[88:91], v[220:223], v[64:67]
  v_mfma_f32_16x16x32_bf16 v[68:71], v[92:95], v[220:223], v[68:71]
  ds_read_b128 v[88:91], v7 offset:14336
  ds_read_b128 v[92:95], v7 offset:34816
  s_waitcnt lgkmcnt(4)
  v_mfma_f32_16x16x32_bf16 v[32:35], a[48:51], v[72:75], v[32:35]
  v_mfma_f32_16x16x32_bf16 v[36:39], a[48:51], v[76:79], v[36:39]
  v_mfma_f32_16x16x32_bf16 v[40:43], a[128:131], v[72:75], v[40:43]
  v_mfma_f32_16x16x32_bf16 v[44:47], a[128:131], v[76:79], v[44:47]
  v_mfma_f32_16x16x32_bf16 v[48:51], v[72:75], a[208:211], v[48:51]
  v_mfma_f32_16x16x32_bf16 v[52:55], v[76:79], a[208:211], v[52:55]
  v_mfma_f32_16x16x32_bf16 v[56:59], v[72:75], v[144:147], v[56:59]
  v_mfma_f32_16x16x32_bf16 v[60:63], v[76:79], v[144:147], v[60:63]
  v_mfma_f32_16x16x32_bf16 v[64:67], v[72:75], v[224:227], v[64:67]
  v_mfma_f32_16x16x32_bf16 v[68:71], v[76:79], v[224:227], v[68:71]
  ds_read_b128 v[72:75], v7 offset:15360
  ds_read_b128 v[76:79], v7 offset:35840
  s_waitcnt lgkmcnt(4)
  v_mfma_f32_16x16x32_bf16 v[32:35], a[52:55], v[80:83], v[32:35]
  v_mfma_f32_16x16x32_bf16 v[36:39], a[52:55], v[84:87], v[36:39]
  v_mfma_f32_16x16x32_bf16 v[40:43], a[132:135], v[80:83], v[40:43]
  v_mfma_f32_16x16x32_bf16 v[44:47], a[132:135], v[84:87], v[44:47]
  v_mfma_f32_16x16x32_bf16 v[48:51], v[80:83], a[212:215], v[48:51]
  v_mfma_f32_16x16x32_bf16 v[52:55], v[84:87], a[212:215], v[52:55]
  v_mfma_f32_16x16x32_bf16 v[56:59], v[80:83], v[148:151], v[56:59]
  v_mfma_f32_16x16x32_bf16 v[60:63], v[84:87], v[148:151], v[60:63]
  v_mfma_f32_16x16x32_bf16 v[64:67], v[80:83], v[228:231], v[64:67]
  v_mfma_f32_16x16x32_bf16 v[68:71], v[84:87], v[228:231], v[68:71]
  ds_read_b128 v[80:83], v7 offset:16384
  ds_read_b128 v[84:87], v7 offset:36864
  s_waitcnt lgkmcnt(4)
  v_mfma_f32_16x16x32_bf16 v[32:35], a[56:59], v[88:91], v[32:35]
  v_mfma_f32_16x16x32_bf16 v[36:39], a[56:59], v[92:95], v[36:39]
  v_mfma_f32_16x16x32_bf16 v[40:43], a[136:139], v[88:91], v[40:43]
  v_mfma_f32_16x16x32_bf16 v[44:47], a[136:139], v[92:95], v[44:47]
  v_mfma_f32_16x16x32_bf16 v[48:51], v[88:91], a[216:219], v[48:51]
  v_mfma_f32_16x16x32_bf16 v[52:55], v[92:95], a[216:219], v[52:55]
  v_mfma_f32_16x16x32_bf16 v[56:59], v[88:91], v[152:155], v[56:59]
  v_mfma_f32_16x16x32_bf16 v[60:63], v[92:95], v[152:155], v[60:63]
  v_mfma_f32_16x16x32_bf16 v[64:67], v[88:91], v[232:235], v[64:67]
  v_mfma_f32_16x16x32_bf16 v[68:71], v[92:95], v[232:235], v[68:71]
  ds_read_b128 v[88:91], v7 offset:17408
  ds_read_b128 v[92:95], v7 offset:37888
  s_waitcnt lgkmcnt(4)
  v_mfma_f32_16x16x32_bf16 v[32:35], a[60:63], v[72:75], v[32:35]
  v_mfma_f32_16x16x32_bf16 v[36:39], a[60:63], v[76:79], v[36:39]
  v_mfma_f32_16x16x32_bf16 v[40:43], a[140:143], v[72:75], v[40:43]
  v_mfma_f32_16x16x32_bf16 v[44:47], a[140:143], v[76:79], v[44:47]
  v_mfma_f32_16x16x32_bf16 v[48:51], v[72:75], a[220:223], v[48:51]
  v_mfma_f32_16x16x32_bf16 v[52:55], v[76:79], a[220:223], v[52:55]
  v_mfma_f32_16x16x32_bf16 v[56:59], v[72:75], v[156:159], v[56:59]
  v_mfma_f32_16x16x32_bf16 v[60:63], v[76:79], v[156:159], v[60:63]
  v_mfma_f32_16x16x32_bf16 v[64:67], v[72:75], v[236:239], v[64:67]
  v_mfma_f32_16x16x32_bf16 v[68:71], v[76:79], v[236:239], v[68:71]
  ds_read_b128 v[72:75], v7 offset:18432
  ds_read_b128 v[76:79], v7 offset:38912
  s_waitcnt lgkmcnt(4)
  v_mfma_f32_16x16x32_bf16 v[32:35], a[64:67], v[80:83], v[32:35]
  v_mfma_f32_16x16x32_bf16 v[36:39], a[64:67], v[84:87], v[36:39]
  v_mfma_f32_16x16x32_bf16 v[40:43], a[144:147], v[80:83], v[40:43]
  v_mfma_f32_16x16x32_bf16 v[44:47], a[144:147], v[84:87], v[44:47]
  v_mfma_f32_16x16x32_bf16 v[48:51], v[80:83], a[224:227], v[48:51]
  v_mfma_f32_16x16x32_bf16 v[52:55], v[84:87], a[224:227], v[52:55]
  v_mfma_f32_16x16x32_bf16 v[56:59], v[80:83], v[160:163], v[56:59]
  v_mfma_f32_16x16x32_bf16 v[60:63], v[84:87], v[160:163], v[60:63]
  v_mfma_f32_16x16x32_bf16 v[64:67], v[80:83], v[240:243], v[64:67]
  v_mfma_f32_16x16x32_bf16 v[68:71], v[84:87], v[240:243], v[68:71]
  ds_read_b128 v[80:83], v7 offset:19456
  ds_read_b128 v[84:87], v7 offset:39936
  s_waitcnt lgkmcnt(4)
  v_mfma_f32_16x16x32_bf16 v[32:35], a[68:71], v[88:91], v[32:35]
  v_mfma_f32_16x16x32_bf16 v[36:39], a[68:71], v[92:95], v[36:39]
  v_mfma_f32_16x16x32_bf16 v[40:43], a[148:151], v[88:91], v[40:43]
  v_mfma_f32_16x16x32_bf16 v[44:47], a[148:151], v[92:95], v[44:47]
  v_mfma_f32_16x16x32_bf16 v[48:51], v[88:91], a[228:231], v[48:51]
  v_mfma_f32_16x16x32_bf16 v[52:55], v[92:95], a[228:231], v[52:55]
  v_mfma_f32_16x16x32_bf16 v[56:59], v[88:91], v[164:167], v[56:59]
  v_mfma_f32_16x16x32_bf16 v[60:63], v[92:95], v[164:167], v[60:63]
  v_mfma_f32_16x16x32_bf16 v[64:67], v[88:91], v[244:247], v[64:67]
  v_mfma_f32_16x16x32_bf16 v[68:71], v[92:95], v[244:247], v[68:71]
  s_waitcnt lgkmcnt(2)
  v_mfma_f32_16x16x32_bf16 v[32:35], a[72:75], v[72:75], v[32:35]
  v_mfma_f32_16x16x32_bf16 v[36:39], a[72:75], v[76:79], v[36:39]
  v_mfma_f32_16x16x32_bf16 v[40:43], a[152:155], v[72:75], v[40:43]
  v_mfma_f32_16x16x32_bf16 v[44:47], a[152:155], v[76:79], v[44:47]
  v_mfma_f32_16x16x32_bf16 v[48:51], v[72:75], a[232:235], v[48:51]
  v_mfma_f32_16x16x32_bf16 v[52:55], v[76:79], a[232:235], v[52:55]
  v_mfma_f32_16x16x32_bf16 v[56:59], v[72:75], v[168:171], v[56:59]
  v_mfma_f32_16x16x32_bf16 v[60:63], v[76:79], v[168:171], v[60:63]
  v_mfma_f32_16x16x32_bf16 v[64:67], v[72:75], v[248:251], v[64:67]
  v_mfma_f32_16x16x32_bf16 v[68:71], v[76:79], v[248:251], v[68:71]
  s_waitcnt lgkmcnt(0)
  v_mfma_f32_16x16x32_bf16 v[32:35], a[76:79], v[80:83], v[32:35]
  v_mfma_f32_16x16x32_bf16 v[36:39], a[76:79], v[84:87], v[36:39]
  v_mfma_f32_16x16x32_bf16 v[40:43], a[156:159], v[80:83], v[40:43]
  v_mfma_f32_16x16x32_bf16 v[44:47], a[156:159], v[84:87], v[44:47]
  v_mfma_f32_16x16x32_bf16 v[48:51], v[80:83], a[236:239], v[48:51]
  v_mfma_f32_16x16x32_bf16 v[52:55], v[84:87], a[236:239], v[52:55]
  v_mfma_f32_16x16x32_bf16 v[56:59], v[80:83], v[172:175], v[56:59]
  v_mfma_f32_16x16x32_bf16 v[60:63], v[84:87], v[172:175], v[60:63]
  v_mfma_f32_16x16x32_bf16 v[64:67], v[80:83], v[252:255], v[64:67]
  v_mfma_f32_16x16x32_bf16 v[68:71], v[84:87], v[252:255], v[68:71]
  v_cvt_pk_bf16_f32 v8, v32, v33
  v_cvt_pk_bf16_f32 v9, v34, v35
  v_cvt_pk_bf16_f32 v10, v40, v41
  v_cvt_pk_bf16_f32 v11, v42, v43
  s_add_u32 s34, s21, 2048
  buffer_store_dwordx4 v[8:11], v1, s[4:7], s34 offen
  v_cvt_pk_bf16_f32 v12, v36, v37
  v_cvt_pk_bf16_f32 v13, v38, v39
  v_cvt_pk_bf16_f32 v14, v44, v45
  v_cvt_pk_bf16_f32 v15, v46, v47
  s_add_u32 s34, s21, 8192
  buffer_store_dwordx4 v[12:15], v1, s[4:7], s34 offen
  v_cvt_pk_bf16_f32 v8, v48, v49
  v_cvt_pk_bf16_f32 v9, v50, v51
  v_cvt_pk_bf16_f32 v10, v52, v53
  v_cvt_pk_bf16_f32 v11, v54, v55
  s_add_u32 s34, s23, 1024
  buffer_store_dwordx4 v[8:11], v1, s[4:7], s34 offen
  v_cvt_pk_bf16_f32 v12, v56, v57
  v_cvt_pk_bf16_f32 v13, v58, v59
  v_cvt_pk_bf16_f32 v14, v60, v61
  v_cvt_pk_bf16_f32 v15, v62, v63
  s_add_u32 s34, s23, 2048
  buffer_store_dwordx4 v[12:15], v1, s[4:7], s34 offen
  v_cvt_pk_bf16_f32 v8, v64, v65
  v_cvt_pk_bf16_f32 v9, v66, v67
  v_cvt_pk_bf16_f32 v10, v68, v69
  v_cvt_pk_bf16_f32 v11, v70, v71
  s_add_u32 s34, s23, 3072
  buffer_store_dwordx4 v[8:11], v1, s[4:7], s34 offen
  s_waitcnt vmcnt(0)
  s_barrier
  s_add_u32 s17, s17, 1
  s_cmp_lt_u32 s17, 64
  s_cbranch_scc1 reca_ptop246
  s_branch reca_exit1
reca_pslow245:
reca_ptop251:
  s_cmp_lt_u32 s17, 6
  s_cbranch_scc1 reca_pgo252
  s_sub_u32 s36, s17, 6
reca_ppoll253:
  buffer_load_dword v28, v4, s[4:7], s25 offen sc1
  s_waitcnt vmcnt(0)
  v_readfirstlane_b32 s34, v28
  s_nop 3
  s_cmp_ge_i32 s34, s36
  s_cbranch_scc1 reca_pgo252
  s_sleep 8
  s_sub_u32 s18, s18, 1
  s_cbranch_scc0 reca_ppoll253
  s_mov_b32 s18, 0
reca_pgo252:
  s_waitcnt vmcnt(0)
  s_barrier
  v_add_u32 v7, s26, v1
  s_xor_b32 s26, s26, 40960
  s_add_u32 s37, s17, 1
  s_cmp_ge_u32 s37, 64
  s_cbranch_scc1 reca_pnodma254
  s_mul_i32 s20, s37, 40960
  s_add_u32 s20, s20, 153626624
  s_add_u32 m0, s26, 10240
  s_nop 0
  buffer_load_dwordx4 v1, s[4:7], s20 offen offset:0 lds
  buffer_load_dwordx4 v1, s[4:7], s20 offen offset:1024 lds
  buffer_load_dwordx4 v1, s[4:7], s20 offen offset:2048 lds
  buffer_load_dwordx4 v1, s[4:7], s20 offen offset:3072 lds
  s_add_u32 s20, s20, 4096
  s_add_u32 m0, s26, 14336
  s_nop 0
  buffer_load_dwordx4 v1, s[4:7], s20 offen offset:0 lds
  buffer_load_dwordx4 v1, s[4:7], s20 offen offset:1024 lds
  buffer_load_dwordx4 v1, s[4:7], s20 offen offset:2048 lds
  buffer_load_dwordx4 v1, s[4:7], s20 offen offset:3072 lds
  s_add_u32 s20, s20, 4096
  s_add_u32 m0, s26, 18432
  s_nop 0
  buffer_load_dwordx4 v1, s[4:7], s20 offen offset:0 lds
  buffer_load_dwordx4 v1, s[4:7], s20 offen offset:1024 lds
  s_lshl_b32 s34, s15, 6
  s_add_u32 s34, s34, s37
  s_mul_i32 s34, s34, 12288
  s_mul_i32 s35, s16, 3072
  s_add_u32 s35, s35, s34
  s_add_u32 s27, s35, 37748736
  s_mul_i32 s35, s16, 6144
  s_add_u32 s35, s35, s34
  s_add_u32 s28, s35, 62914560
  s_add_u32 s34, s27, 2048
  buffer_load_dwordx4 v[16:19], v1, s[4:7], s34 offen sc1
  s_add_u32 s34, s27, 8192
  buffer_load_dwordx4 v[16:19], v1, s[4:7], s34 offen sc1
  s_add_u32 s34, s28, 1024
  buffer_load_dwordx4 v[16:19], v1, s[4:7], s34 offen sc1
  s_add_u32 s34, s28, 2048
  buffer_load_dwordx4 v[16:19], v1, s[4:7], s34 offen sc1
  s_add_u32 s34, s28, 3072
  buffer_load_dwordx4 v[16:19], v1, s[4:7], s34 offen sc1
reca_pnodma254:
  s_lshl_b32 s34, s15, 6
  s_add_u32 s34, s34, s17
  s_mul_i32 s34, s34, 12288
  s_mul_i32 s35, s16, 3072
  s_add_u32 s35, s35, s34
  s_add_u32 s21, s35, 37748736
  s_add_u32 s22, s35, 88080384
  s_mul_i32 s35, s16, 6144
  s_add_u32 s35, s35, s34
  s_add_u32 s23, s35, 62914560
  ds_read_b128 v[72:75], v7 offset:0
  ds_read_b128 v[76:79], v7 offset:20480
  ds_read_b128 v[80:83], v7 offset:1024
  ds_read_b128 v[84:87], v7 offset:21504
  ds_read_b128 v[88:91], v7 offset:2048
  ds_read_b128 v[92:95], v7 offset:22528
  s_waitcnt lgkmcnt(4)
  v_mfma_f32_16x16x32_bf16 v[32:35], a[0:3], v[72:75], 0
  v_mfma_f32_16x16x32_bf16 v[36:39], a[0:3], v[76:79], 0
  v_mfma_f32_16x16x32_bf16 v[40:43], a[80:83], v[72:75], 0
  v_mfma_f32_16x16x32_bf16 v[44:47], a[80:83], v[76:79], 0
  v_mfma_f32_16x16x32_bf16 v[48:51], v[72:75], a[160:163], 0
  v_mfma_f32_16x16x32_bf16 v[52:55], v[76:79], a[160:163], 0
  v_mfma_f32_16x16x32_bf16 v[56:59], v[72:75], v[96:99], 0
  v_mfma_f32_16x16x32_bf16 v[60:63], v[76:79], v[96:99], 0
  v_mfma_f32_16x16x32_bf16 v[64:67], v[72:75], v[176:179], 0
  v_mfma_f32_16x16x32_bf16 v[68:71], v[76:79], v[176:179], 0
  ds_read_b128 v[72:75], v7 offset:3072
  ds_read_b128 v[76:79], v7 offset:23552
  s_waitcnt lgkmcnt(4)
  v_mfma_f32_16x16x32_bf16 v[32:35], a[4:7], v[80:83], v[32:35]
  v_mfma_f32_16x16x32_bf16 v[36:39], a[4:7], v[84:87], v[36:39]
  v_mfma_f32_16x16x32_bf16 v[40:43], a[84:87], v[80:83], v[40:43]
  v_mfma_f32_16x16x32_bf16 v[44:47], a[84:87], v[84:87], v[44:47]
  v_mfma_f32_16x16x32_bf16 v[48:51], v[80:83], a[164:167], v[48:51]
  v_mfma_f32_16x16x32_bf16 v[52:55], v[84:87], a[164:167], v[52:55]
  v_mfma_f32_16x16x32_bf16 v[56:59], v[80:83], v[100:103], v[56:59]
  v_mfma_f32_16x16x32_bf16 v[60:63], v[84:87], v[100:103], v[60:63]
  v_mfma_f32_16x16x32_bf16 v[64:67], v[80:83], v[180:183], v[64:67]
  v_mfma_f32_16x16x32_bf16 v[68:71], v[84:87], v[180:183], v[68:71]
  ds_read_b128 v[80:83], v7 offset:4096
  ds_read_b128 v[84:87], v7 offset:24576
  s_waitcnt lgkmcnt(4)
  v_mfma_f32_16x16x32_bf16 v[32:35], a[8:11], v[88:91], v[32:35]
  v_mfma_f32_16x16x32_bf16 v[36:39], a[8:11], v[92:95], v[36:39]
  v_mfma_f32_16x16x32_bf16 v[40:43], a[88:91], v[88:91], v[40:43]
  v_mfma_f32_16x16x32_bf16 v[44:47], a[88:91], v[92:95], v[44:47]
  v_mfma_f32_16x16x32_bf16 v[48:51], v[88:91], a[168:171], v[48:51]
  v_mfma_f32_16x16x32_bf16 v[52:55], v[92:95], a[168:171], v[52:55]
  v_mfma_f32_16x16x32_bf16 v[56:59], v[88:91], v[104:107], v[56:59]
  v_mfma_f32_16x16x32_bf16 v[60:63], v[92:95], v[104:107], v[60:63]
  v_mfma_f32_16x16x32_bf16 v[64:67], v[88:91], v[184:187], v[64:67]
  v_mfma_f32_16x16x32_bf16 v[68:71], v[92:95], v[184:187], v[68:71]
  ds_read_b128 v[88:91], v7 offset:5120
  ds_read_b128 v[92:95], v7 offset:25600
  s_waitcnt lgkmcnt(4)
  v_mfma_f32_16x16x32_bf16 v[32:35], a[12:15], v[72:75], v[32:35]
  v_mfma_f32_16x16x32_bf16 v[36:39], a[12:15], v[76:79], v[36:39]
  v_mfma_f32_16x16x32_bf16 v[40:43], a[92:95], v[72:75], v[40:43]
  v_mfma_f32_16x16x32_bf16 v[44:47], a[92:95], v[76:79], v[44:47]
  v_mfma_f32_16x16x32_bf16 v[48:51], v[72:75], a[172:175], v[48:51]
  v_mfma_f32_16x16x32_bf16 v[52:55], v[76:79], a[172:175], v[52:55]
  v_mfma_f32_16x16x32_bf16 v[56:59], v[72:75], v[108:111], v[56:59]
  v_mfma_f32_16x16x32_bf16 v[60:63], v[76:79], v[108:111], v[60:63]
  v_mfma_f32_16x16x32_bf16 v[64:67], v[72:75], v[188:191], v[64:67]
  v_mfma_f32_16x16x32_bf16 v[68:71], v[76:79], v[188:191], v[68:71]
  ds_read_b128 v[72:75], v7 offset:6144
  ds_read_b128 v[76:79], v7 offset:26624
  s_waitcnt lgkmcnt(4)
  v_mfma_f32_16x16x32_bf16 v[32:35], a[16:19], v[80:83], v[32:35]
  v_mfma_f32_16x16x32_bf16 v[36:39], a[16:19], v[84:87], v[36:39]
  v_mfma_f32_16x16x32_bf16 v[40:43], a[96:99], v[80:83], v[40:43]
  v_mfma_f32_16x16x32_bf16 v[44:47], a[96:99], v[84:87], v[44:47]
  v_mfma_f32_16x16x32_bf16 v[48:51], v[80:83], a[176:179], v[48:51]
  v_mfma_f32_16x16x32_bf16 v[52:55], v[84:87], a[176:179], v[52:55]
  v_mfma_f32_16x16x32_bf16 v[56:59], v[80:83], v[112:115], v[56:59]
  v_mfma_f32_16x16x32_bf16 v[60:63], v[84:87], v[112:115], v[60:63]
  v_mfma_f32_16x16x32_bf16 v[64:67], v[80:83], v[192:195], v[64:67]
  v_mfma_f32_16x16x32_bf16 v[68:71], v[84:87], v[192:195], v[68:71]
  ds_read_b128 v[80:83], v7 offset:7168
  ds_read_b128 v[84:87], v7 offset:27648
  s_waitcnt lgkmcnt(4)
  v_mfma_f32_16x16x32_bf16 v[32:35], a[20:23], v[88:91], v[32:35]
  v_mfma_f32_16x16x32_bf16 v[36:39], a[20:23], v[92:95], v[36:39]
  v_mfma_f32_16x16x32_bf16 v[40:43], a[100:103], v[88:91], v[40:43]
  v_mfma_f32_16x16x32_bf16 v[44:47], a[100:103], v[92:95], v[44:47]
  v_mfma_f32_16x16x32_bf16 v[48:51], v[88:91], a[180:183], v[48:51]
  v_mfma_f32_16x16x32_bf16 v[52:55], v[92:95], a[180:183], v[52:55]
  v_mfma_f32_16x16x32_bf16 v[56:59], v[88:91], v[116:119], v[56:59]
  v_mfma_f32_16x16x32_bf16 v[60:63], v[92:95], v[116:119], v[60:63]
  v_mfma_f32_16x16x32_bf16 v[64:67], v[88:91], v[196:199], v[64:67]
  v_mfma_f32_16x16x32_bf16 v[68:71], v[92:95], v[196:199], v[68:71]
  ds_read_b128 v[88:91], v7 offset:8192
  ds_read_b128 v[92:95], v7 offset:28672
  s_waitcnt lgkmcnt(4)
  v_mfma_f32_16x16x32_bf16 v[32:35], a[24:27], v[72:75], v[32:35]
  v_mfma_f32_16x16x32_bf16 v[36:39], a[24:27], v[76:79], v[36:39]
  v_mfma_f32_16x16x32_bf16 v[40:43], a[104:107], v[72:75], v[40:43]
  v_mfma_f32_16x16x32_bf16 v[44:47], a[104:107], v[76:79], v[44:47]
  v_mfma_f32_16x16x32_bf16 v[48:51], v[72:75], a[184:187], v[48:51]
  v_mfma_f32_16x16x32_bf16 v[52:55], v[76:79], a[184:187], v[52:55]
  v_mfma_f32_16x16x32_bf16 v[56:59], v[72:75], v[120:123], v[56:59]
  v_mfma_f32_16x16x32_bf16 v[60:63], v[76:79], v[120:123], v[60:63]
  v_mfma_f32_16x16x32_bf16 v[64:67], v[72:75], v[200:203], v[64:67]
  v_mfma_f32_16x16x32_bf16 v[68:71], v[76:79], v[200:203], v[68:71]
  ds_read_b128 v[72:75], v7 offset:9216
  ds_read_b128 v[76:79], v7 offset:29696
  s_waitcnt lgkmcnt(4)
  v_mfma_f32_16x16x32_bf16 v[32:35], a[28:31], v[80:83], v[32:35]
  v_mfma_f32_16x16x32_bf16 v[36:39], a[28:31], v[84:87], v[36:39]
  v_mfma_f32_16x16x32_bf16 v[40:43], a[108:111], v[80:83], v[40:43]
  v_mfma_f32_16x16x32_bf16 v[44:47], a[108:111], v[84:87], v[44:47]
  v_mfma_f32_16x16x32_bf16 v[48:51], v[80:83], a[188:191], v[48:51]
  v_mfma_f32_16x16x32_bf16 v[52:55], v[84:87], a[188:191], v[52:55]
  v_mfma_f32_16x16x32_bf16 v[56:59], v[80:83], v[124:127], v[56:59]
  v_mfma_f32_16x16x32_bf16 v[60:63], v[84:87], v[124:127], v[60:63]
  v_mfma_f32_16x16x32_bf16 v[64:67], v[80:83], v[204:207], v[64:67]
  v_mfma_f32_16x16x32_bf16 v[68:71], v[84:87], v[204:207], v[68:71]
  ds_read_b128 v[80:83], v7 offset:10240
  ds_read_b128 v[84:87], v7 offset:30720
  s_waitcnt lgkmcnt(4)
  v_mfma_f32_16x16x32_bf16 v[32:35], a[32:35], v[88:91], v[32:35]
  v_mfma_f32_16x16x32_bf16 v[36:39], a[32:35], v[92:95], v[36:39]
  v_mfma_f32_16x16x32_bf16 v[40:43], a[112:115], v[88:91], v[40:43]
  v_mfma_f32_16x16x32_bf16 v[44:47], a[112:115], v[92:95], v[44:47]
  v_mfma_f32_16x16x32_bf16 v[48:51], v[88:91], a[192:195], v[48:51]
  v_mfma_f32_16x16x32_bf16 v[52:55], v[92:95], a[192:195], v[52:55]
  v_mfma_f32_16x16x32_bf16 v[56:59], v[88:91], v[128:131], v[56:59]
  v_mfma_f32_16x16x32_bf16 v[60:63], v[92:95], v[128:131], v[60:63]
  v_mfma_f32_16x16x32_bf16 v[64:67], v[88:91], v[208:211], v[64:67]
  v_mfma_f32_16x16x32_bf16 v[68:71], v[92:95], v[208:211], v[68:71]
  ds_read_b128 v[88:91], v7 offset:11264
  ds_read_b128 v[92:95], v7 offset:31744
  s_waitcnt lgkmcnt(4)
  v_mfma_f32_16x16x32_bf16 v[32:35], a[36:39], v[72:75], v[32:35]
  v_mfma_f32_16x16x32_bf16 v[36:39], a[36:39], v[76:79], v[36:39]
  v_mfma_f32_16x16x32_bf16 v[40:43], a[116:119], v[72:75], v[40:43]
  v_mfma_f32_16x16x32_bf16 v[44:47], a[116:119], v[76:79], v[44:47]
  v_mfma_f32_16x16x32_bf16 v[48:51], v[72:75], a[196:199], v[48:51]
  v_mfma_f32_16x16x32_bf16 v[52:55], v[76:79], a[196:199], v[52:55]
  v_mfma_f32_16x16x32_bf16 v[56:59], v[72:75], v[132:135], v[56:59]
  v_mfma_f32_16x16x32_bf16 v[60:63], v[76:79], v[132:135], v[60:63]
  v_mfma_f32_16x16x32_bf16 v[64:67], v[72:75], v[212:215], v[64:67]
  v_mfma_f32_16x16x32_bf16 v[68:71], v[76:79], v[212:215], v[68:71]
  ds_read_b128 v[72:75], v7 offset:12288
  ds_read_b128 v[76:79], v7 offset:32768
  s_waitcnt lgkmcnt(4)
  v_mfma_f32_16x16x32_bf16 v[32:35], a[40:43], v[80:83], v[32:35]
  v_mfma_f32_16x16x32_bf16 v[36:39], a[40:43], v[84:87], v[36:39]
  v_mfma_f32_16x16x32_bf16 v[40:43], a[120:123], v[80:83], v[40:43]
  v_mfma_f32_16x16x32_bf16 v[44:47], a[120:123], v[84:87], v[44:47]
  v_mfma_f32_16x16x32_bf16 v[48:51], v[80:83], a[200:203], v[48:51]
  v_mfma_f32_16x16x32_bf16 v[52:55], v[84:87], a[200:203], v[52:55]
  v_mfma_f32_16x16x32_bf16 v[56:59], v[80:83], v[136:139], v[56:59]
  v_mfma_f32_16x16x32_bf16 v[60:63], v[84:87], v[136:139], v[60:63]
  v_mfma_f32_16x16x32_bf16 v[64:67], v[80:83], v[216:219], v[64:67]
  v_mfma_f32_16x16x32_bf16 v[68:71], v[84:87], v[216:219], v[68:71]
  ds_read_b128 v[80:83], v7 offset:13312
  ds_read_b128 v[84:87], v7 offset:33792
  s_waitcnt lgkmcnt(4)
  v_mfma_f32_16x16x32_bf16 v[32:35], a[44:47], v[88:91], v[32:35]
  v_mfma_f32_16x16x32_bf16 v[36:39], a[44:47], v[92:95], v[36:39]
  v_mfma_f32_16x16x32_bf16 v[40:43], a[124:127], v[88:91], v[40:43]
  v_mfma_f32_16x16x32_bf16 v[44:47], a[124:127], v[92:95], v[44:47]
  v_mfma_f32_16x16x32_bf16 v[48:51], v[88:91], a[204:207], v[48:51]
  v_mfma_f32_16x16x32_bf16 v[52:55], v[92:95], a[204:207], v[52:55]
  v_mfma_f32_16x16x32_bf16 v[56:59], v[88:91], v[140:143], v[56:59]
  v_mfma_f32_16x16x32_bf16 v[60:63], v[92:95], v[140:143], v[60:63]
  v_mfma_f32_16x16x32_bf16 v[64:67], v[88:91], v[220:223], v[64:67]
  v_mfma_f32_16x16x32_bf16 v[68:71], v[92:95], v[220:223], v[68:71]
  ds_read_b128 v[88:91], v7 offset:14336
  ds_read_b128 v[92:95], v7 offset:34816
  s_waitcnt lgkmcnt(4)
  v_mfma_f32_16x16x32_bf16 v[32:35], a[48:51], v[72:75], v[32:35]
  v_mfma_f32_16x16x32_bf16 v[36:39], a[48:51], v[76:79], v[36:39]
  v_mfma_f32_16x16x32_bf16 v[40:43], a[128:131], v[72:75], v[40:43]
  v_mfma_f32_16x16x32_bf16 v[44:47], a[128:131], v[76:79], v[44:47]
  v_mfma_f32_16x16x32_bf16 v[48:51], v[72:75], a[208:211], v[48:51]
  v_mfma_f32_16x16x32_bf16 v[52:55], v[76:79], a[208:211], v[52:55]
  v_mfma_f32_16x16x32_bf16 v[56:59], v[72:75], v[144:147], v[56:59]
  v_mfma_f32_16x16x32_bf16 v[60:63], v[76:79], v[144:147], v[60:63]
  v_mfma_f32_16x16x32_bf16 v[64:67], v[72:75], v[224:227], v[64:67]
  v_mfma_f32_16x16x32_bf16 v[68:71], v[76:79], v[224:227], v[68:71]
  ds_read_b128 v[72:75], v7 offset:15360
  ds_read_b128 v[76:79], v7 offset:35840
  s_waitcnt lgkmcnt(4)
  v_mfma_f32_16x16x32_bf16 v[32:35], a[52:55], v[80:83], v[32:35]
  v_mfma_f32_16x16x32_bf16 v[36:39], a[52:55], v[84:87], v[36:39]
  v_mfma_f32_16x16x32_bf16 v[40:43], a[132:135], v[80:83], v[40:43]
  v_mfma_f32_16x16x32_bf16 v[44:47], a[132:135], v[84:87], v[44:47]
  v_mfma_f32_16x16x32_bf16 v[48:51], v[80:83], a[212:215], v[48:51]
  v_mfma_f32_16x16x32_bf16 v[52:55], v[84:87], a[212:215], v[52:55]
  v_mfma_f32_16x16x32_bf16 v[56:59], v[80:83], v[148:151], v[56:59]
  v_mfma_f32_16x16x32_bf16 v[60:63], v[84:87], v[148:151], v[60:63]
  v_mfma_f32_16x16x32_bf16 v[64:67], v[80:83], v[228:231], v[64:67]
  v_mfma_f32_16x16x32_bf16 v[68:71], v[84:87], v[228:231], v[68:71]
  ds_read_b128 v[80:83], v7 offset:16384
  ds_read_b128 v[84:87], v7 offset:36864
  s_waitcnt lgkmcnt(4)
  v_mfma_f32_16x16x32_bf16 v[32:35], a[56:59], v[88:91], v[32:35]
  v_mfma_f32_16x16x32_bf16 v[36:39], a[56:59], v[92:95], v[36:39]
  v_mfma_f32_16x16x32_bf16 v[40:43], a[136:139], v[88:91], v[40:43]
  v_mfma_f32_16x16x32_bf16 v[44:47], a[136:139], v[92:95], v[44:47]
  v_mfma_f32_16x16x32_bf16 v[48:51], v[88:91], a[216:219], v[48:51]
  v_mfma_f32_16x16x32_bf16 v[52:55], v[92:95], a[216:219], v[52:55]
  v_mfma_f32_16x16x32_bf16 v[56:59], v[88:91], v[152:155], v[56:59]
  v_mfma_f32_16x16x32_bf16 v[60:63], v[92:95], v[152:155], v[60:63]
  v_mfma_f32_16x16x32_bf16 v[64:67], v[88:91], v[232:235], v[64:67]
  v_mfma_f32_16x16x32_bf16 v[68:71], v[92:95], v[232:235], v[68:71]
  ds_read_b128 v[88:91], v7 offset:17408
  ds_read_b128 v[92:95], v7 offset:37888
  s_waitcnt lgkmcnt(4)
  v_mfma_f32_16x16x32_bf16 v[32:35], a[60:63], v[72:75], v[32:35]
  v_mfma_f32_16x16x32_bf16 v[36:39], a[60:63], v[76:79], v[36:39]
  v_mfma_f32_16x16x32_bf16 v[40:43], a[140:143], v[72:75], v[40:43]
  v_mfma_f32_16x16x32_bf16 v[44:47], a[140:143], v[76:79], v[44:47]
  v_mfma_f32_16x16x32_bf16 v[48:51], v[72:75], a[220:223], v[48:51]
  v_mfma_f32_16x16x32_bf16 v[52:55], v[76:79], a[220:223], v[52:55]
  v_mfma_f32_16x16x32_bf16 v[56:59], v[72:75], v[156:159], v[56:59]
  v_mfma_f32_16x16x32_bf16 v[60:63], v[76:79], v[156:159], v[60:63]
  v_mfma_f32_16x16x32_bf16 v[64:67], v[72:75], v[236:239], v[64:67]
  v_mfma_f32_16x16x32_bf16 v[68:71], v[76:79], v[236:239], v[68:71]
  ds_read_b128 v[72:75], v7 offset:18432
  ds_read_b128 v[76:79], v7 offset:38912
  s_waitcnt lgkmcnt(4)
  v_mfma_f32_16x16x32_bf16 v[32:35], a[64:67], v[80:83], v[32:35]
  v_mfma_f32_16x16x32_bf16 v[36:39], a[64:67], v[84:87], v[36:39]
  v_mfma_f32_16x16x32_bf16 v[40:43], a[144:147], v[80:83], v[40:43]
  v_mfma_f32_16x16x32_bf16 v[44:47], a[144:147], v[84:87], v[44:47]
  v_mfma_f32_16x16x32_bf16 v[48:51], v[80:83], a[224:227], v[48:51]
  v_mfma_f32_16x16x32_bf16 v[52:55], v[84:87], a[224:227], v[52:55]
  v_mfma_f32_16x16x32_bf16 v[56:59], v[80:83], v[160:163], v[56:59]
  v_mfma_f32_16x16x32_bf16 v[60:63], v[84:87], v[160:163], v[60:63]
  v_mfma_f32_16x16x32_bf16 v[64:67], v[80:83], v[240:243], v[64:67]
  v_mfma_f32_16x16x32_bf16 v[68:71], v[84:87], v[240:243], v[68:71]
  ds_read_b128 v[80:83], v7 offset:19456
  ds_read_b128 v[84:87], v7 offset:39936
  s_waitcnt lgkmcnt(4)
  v_mfma_f32_16x16x32_bf16 v[32:35], a[68:71], v[88:91], v[32:35]
  v_mfma_f32_16x16x32_bf16 v[36:39], a[68:71], v[92:95], v[36:39]
  v_mfma_f32_16x16x32_bf16 v[40:43], a[148:151], v[88:91], v[40:43]
  v_mfma_f32_16x16x32_bf16 v[44:47], a[148:151], v[92:95], v[44:47]
  v_mfma_f32_16x16x32_bf16 v[48:51], v[88:91], a[228:231], v[48:51]
  v_mfma_f32_16x16x32_bf16 v[52:55], v[92:95], a[228:231], v[52:55]
  v_mfma_f32_16x16x32_bf16 v[56:59], v[88:91], v[164:167], v[56:59]
  v_mfma_f32_16x16x32_bf16 v[60:63], v[92:95], v[164:167], v[60:63]
  v_mfma_f32_16x16x32_bf16 v[64:67], v[88:91], v[244:247], v[64:67]
  v_mfma_f32_16x16x32_bf16 v[68:71], v[92:95], v[244:247], v[68:71]
  s_waitcnt lgkmcnt(2)
  v_mfma_f32_16x16x32_bf16 v[32:35], a[72:75], v[72:75], v[32:35]
  v_mfma_f32_16x16x32_bf16 v[36:39], a[72:75], v[76:79], v[36:39]
  v_mfma_f32_16x16x32_bf16 v[40:43], a[152:155], v[72:75], v[40:43]
  v_mfma_f32_16x16x32_bf16 v[44:47], a[152:155], v[76:79], v[44:47]
  v_mfma_f32_16x16x32_bf16 v[48:51], v[72:75], a[232:235], v[48:51]
  v_mfma_f32_16x16x32_bf16 v[52:55], v[76:79], a[232:235], v[52:55]
  v_mfma_f32_16x16x32_bf16 v[56:59], v[72:75], v[168:171], v[56:59]
  v_mfma_f32_16x16x32_bf16 v[60:63], v[76:79], v[168:171], v[60:63]
  v_mfma_f32_16x16x32_bf16 v[64:67], v[72:75], v[248:251], v[64:67]
  v_mfma_f32_16x16x32_bf16 v[68:71], v[76:79], v[248:251], v[68:71]
  s_waitcnt lgkmcnt(0)
  v_mfma_f32_16x16x32_bf16 v[32:35], a[76:79], v[80:83], v[32:35]
  v_mfma_f32_16x16x32_bf16 v[36:39], a[76:79], v[84:87], v[36:39]
  v_mfma_f32_16x16x32_bf16 v[40:43], a[156:159], v[80:83], v[40:43]
  v_mfma_f32_16x16x32_bf16 v[44:47], a[156:159], v[84:87], v[44:47]
  v_mfma_f32_16x16x32_bf16 v[48:51], v[80:83], a[236:239], v[48:51]
  v_mfma_f32_16x16x32_bf16 v[52:55], v[84:87], a[236:239], v[52:55]
  v_mfma_f32_16x16x32_bf16 v[56:59], v[80:83], v[172:175], v[56:59]
  v_mfma_f32_16x16x32_bf16 v[60:63], v[84:87], v[172:175], v[60:63]
  v_mfma_f32_16x16x32_bf16 v[64:67], v[80:83], v[252:255], v[64:67]
  v_mfma_f32_16x16x32_bf16 v[68:71], v[84:87], v[252:255], v[68:71]
  v_cvt_pk_bf16_f32 v8, v32, v33
  v_cvt_pk_bf16_f32 v9, v34, v35
  v_cvt_pk_bf16_f32 v10, v40, v41
  v_cvt_pk_bf16_f32 v11, v42, v43
  s_add_u32 s34, s21, 2048
  buffer_store_dwordx4 v[8:11], v1, s[4:7], s34 offen sc1
  v_cvt_pk_bf16_f32 v12, v36, v37
  v_cvt_pk_bf16_f32 v13, v38, v39
  v_cvt_pk_bf16_f32 v14, v44, v45
  v_cvt_pk_bf16_f32 v15, v46, v47
  s_add_u32 s34, s21, 8192
  buffer_store_dwordx4 v[12:15], v1, s[4:7], s34 offen sc1
  v_cvt_pk_bf16_f32 v8, v48, v49
  v_cvt_pk_bf16_f32 v9, v50, v51
  v_cvt_pk_bf16_f32 v10, v52, v53
  v_cvt_pk_bf16_f32 v11, v54, v55
  s_add_u32 s34, s23, 1024
  buffer_store_dwordx4 v[8:11], v1, s[4:7], s34 offen sc1
  v_cvt_pk_bf16_f32 v12, v56, v57
  v_cvt_pk_bf16_f32 v13, v58, v59
  v_cvt_pk_bf16_f32 v14, v60, v61
  v_cvt_pk_bf16_f32 v15, v62, v63
  s_add_u32 s34, s23, 2048
  buffer_store_dwordx4 v[12:15], v1, s[4:7], s34 offen sc1
  v_cvt_pk_bf16_f32 v8, v64, v65
  v_cvt_pk_bf16_f32 v9, v66, v67
  v_cvt_pk_bf16_f32 v10, v68, v69
  v_cvt_pk_bf16_f32 v11, v70, v71
  s_add_u32 s34, s23, 3072
  buffer_store_dwordx4 v[8:11], v1, s[4:7], s34 offen sc1
  s_waitcnt vmcnt(0)
  s_barrier
  s_add_u32 s17, s17, 1
  s_cmp_lt_u32 s17, 64
  s_cbranch_scc1 reca_ptop251
  s_branch reca_exit1
reca_pw2_228:
  s_mov_b32 s17, 0
  s_mov_b32 s26, 0
  s_mul_i32 s20, s17, 40960
  s_add_u32 s20, s20, 153636864
  s_add_u32 m0, s26, 20480
  s_nop 0
  buffer_load_dwordx4 v1, s[4:7], s20 offen offset:0 lds
  buffer_load_dwordx4 v1, s[4:7], s20 offen offset:1024 lds
  buffer_load_dwordx4 v1, s[4:7], s20 offen offset:2048 lds
  buffer_load_dwordx4 v1, s[4:7], s20 offen offset:3072 lds
  s_add_u32 s20, s20, 4096
  s_add_u32 m0, s26, 24576
  s_nop 0
  buffer_load_dwordx4 v1, s[4:7], s20 offen offset:0 lds
  buffer_load_dwordx4 v1, s[4:7], s20 offen offset:1024 lds
  buffer_load_dwordx4 v1, s[4:7], s20 offen offset:2048 lds
  buffer_load_dwordx4 v1, s[4:7], s20 offen offset:3072 lds
  s_add_u32 s20, s20, 4096
  s_add_u32 m0, s26, 28672
  s_nop 0
  buffer_load_dwordx4 v1, s[4:7], s20 offen offset:0 lds
  buffer_load_dwordx4 v1, s[4:7], s20 offen offset:1024 lds
  s_lshl_b32 s34, s15, 6
  s_add_u32 s34, s34, s17
  s_mul_i32 s34, s34, 12288
  s_mul_i32 s35, s16, 3072
  s_add_u32 s35, s35, s34
  s_add_u32 s27, s35, 37748736
  s_mul_i32 s35, s16, 6144
  s_add_u32 s35, s35, s34
  s_add_u32 s28, s35, 62914560
  s_add_u32 s34, s28, 4096
  buffer_load_dwordx4 v[16:19], v1, s[4:7], s34 offen sc1
  s_add_u32 s34, s28, 5120
  buffer_load_dwordx4 v[16:19], v1, s[4:7], s34 offen sc1
  s_mul_i32 s34, s15, 12
  s_mul_i32 s35, s16, 6
  s_add_u32 s34, s34, s35
  s_add_u32 s34, s34, 0
  s_mul_i32 s34, s34, 20480
  s_add_u32 s34, s34, 6291456
  buffer_load_dwordx4 a[0:3], v1, s[4:7], s34 offen offset:0
  buffer_load_dwordx4 a[4:7], v1, s[4:7], s34 offen offset:1024
  buffer_load_dwordx4 a[8:11], v1, s[4:7], s34 offen offset:2048
  buffer_load_dwordx4 a[12:15], v1, s[4:7], s34 offen offset:3072
  s_add_u32 s34, s34, 4096
  buffer_load_dwordx4 a[16:19], v1, s[4:7], s34 offen offset:0
  buffer_load_dwordx4 a[20:23], v1, s[4:7], s34 offen offset:1024
  buffer_load_dwordx4 a[24:27], v1, s[4:7], s34 offen offset:2048
  buffer_load_dwordx4 a[28:31], v1, s[4:7], s34 offen offset:3072
  s_add_u32 s34, s34, 4096
  buffer_load_dwordx4 a[32:35], v1, s[4:7], s34 offen offset:0
  buffer_load_dwordx4 a[36:39], v1, s[4:7], s34 offen offset:1024
  buffer_load_dwordx4 a[40:43], v1, s[4:7], s34 offen offset:2048
  buffer_load_dwordx4 a[44:47], v1, s[4:7], s34 offen offset:3072
  s_add_u32 s34, s34, 4096
  buffer_load_dwordx4 a[48:51], v1, s[4:7], s34 offen offset:0
  buffer_load_dwordx4 a[52:55], v1, s[4:7], s34 offen offset:1024
  buffer_load_dwordx4 a[56:59], v1, s[4:7], s34 offen offset:2048
  buffer_load_dwordx4 a[60:63], v1, s[4:7], s34 offen offset:3072
  s_add_u32 s34, s34, 4096
  buffer_load_dwordx4 a[64:67], v1, s[4:7], s34 offen offset:0
  buffer_load_dwordx4 a[68:71], v1, s[4:7], s34 offen offset:1024
  buffer_load_dwordx4 a[72:75], v1, s[4:7], s34 offen offset:2048
  buffer_load_dwordx4 a[76:79], v1, s[4:7], s34 offen offset:3072
  s_mul_i32 s34, s15, 12
  s_mul_i32 s35, s16, 6
  s_add_u32 s34, s34, s35
  s_add_u32 s34, s34, 1
  s_mul_i32 s34, s34, 20480
  s_add_u32 s34, s34, 6291456
  buffer_load_dwordx4 a[80:83], v1, s[4:7], s34 offen offset:0
  buffer_load_dwordx4 a[84:87], v1, s[4:7], s34 offen offset:1024
  buffer_load_dwordx4 a[88:91], v1, s[4:7], s34 offen offset:2048
  buffer_load_dwordx4 a[92:95], v1, s[4:7], s34 offen offset:3072
  s_add_u32 s34, s34, 4096
  buffer_load_dwordx4 a[96:99], v1, s[4:7], s34 offen offset:0
  buffer_load_dwordx4 a[100:103], v1, s[4:7], s34 offen offset:1024
  buffer_load_dwordx4 a[104:107], v1, s[4:7], s34 offen offset:2048
  buffer_load_dwordx4 a[108:111], v1, s[4:7], s34 offen offset:3072
  s_add_u32 s34, s34, 4096
  buffer_load_dwordx4 a[112:115], v1, s[4:7], s34 offen offset:0
  buffer_load_dwordx4 a[116:119], v1, s[4:7], s34 offen offset:1024
  buffer_load_dwordx4 a[120:123], v1, s[4:7], s34 offen offset:2048
  buffer_load_dwordx4 a[124:127], v1, s[4:7], s34 offen offset:3072
  s_add_u32 s34, s34, 4096
  buffer_load_dwordx4 a[128:131], v1, s[4:7], s34 offen offset:0
  buffer_load_dwordx4 a[132:135], v1, s[4:7], s34 offen offset:1024
  buffer_load_dwordx4 a[136:139], v1, s[4:7], s34 offen offset:2048
  buffer_load_dwordx4 a[140:143], v1, s[4:7], s34 offen offset:3072
  s_add_u32 s34, s34, 4096
  buffer_load_dwordx4 a[144:147], v1, s[4:7], s34 offen offset:0
  buffer_load_dwordx4 a[148:151], v1, s[4:7], s34 offen offset:1024
  buffer_load_dwordx4 a[152:155], v1, s[4:7], s34 offen offset:2048
  buffer_load_dwordx4 a[156:159], v1, s[4:7], s34 offen offset:3072
  s_waitcnt vmcnt(20)
  s_mul_i32 s34, s15, 12
  s_mul_i32 s35, s16, 6
  s_add_u32 s34, s34, s35
  s_add_u32 s34, s34, 4
  s_mul_i32 s34, s34, 20480
  s_add_u32 s34, s34, 22020096
  buffer_load_dwordx4 a[160:163], v1, s[4:7], s34 offen offset:0
  buffer_load_dwordx4 a[164:167], v1, s[4:7], s34 offen offset:1024
  buffer_load_dwordx4 a[168:171], v1, s[4:7], s34 offen offset:2048
  buffer_load_dwordx4 a[172:175], v1, s[4:7], s34 offen offset:3072
  s_add_u32 s34, s34, 4096
  buffer_load_dwordx4 a[176:179], v1, s[4:7], s34 offen offset:0
  buffer_load_dwordx4 a[180:183], v1, s[4:7], s34 offen offset:1024
  buffer_load_dwordx4 a[184:187], v1, s[4:7], s34 offen offset:2048
  buffer_load_dwordx4 a[188:191], v1, s[4:7], s34 offen offset:3072
  s_add_u32 s34, s34, 4096
  buffer_load_dwordx4 a[192:195], v1, s[4:7], s34 offen offset:0
  buffer_load_dwordx4 a[196:199], v1, s[4:7], s34 offen offset:1024
  buffer_load_dwordx4 a[200:203], v1, s[4:7], s34 offen offset:2048
  buffer_load_dwordx4 a[204:207], v1, s[4:7], s34 offen offset:3072
  s_add_u32 s34, s34, 4096
  buffer_load_dwordx4 a[208:211], v1, s[4:7], s34 offen offset:0
  buffer_load_dwordx4 a[212:215], v1, s[4:7], s34 offen offset:1024
  buffer_load_dwordx4 a[216:219], v1, s[4:7], s34 offen offset:2048
  buffer_load_dwordx4 a[220:223], v1, s[4:7], s34 offen offset:3072
  s_add_u32 s34, s34, 4096
  buffer_load_dwordx4 a[224:227], v1, s[4:7], s34 offen offset:0
  buffer_load_dwordx4 a[228:231], v1, s[4:7], s34 offen offset:1024
  buffer_load_dwordx4 a[232:235], v1, s[4:7], s34 offen offset:2048
  buffer_load_dwordx4 a[236:239], v1, s[4:7], s34 offen offset:3072
  s_waitcnt vmcnt(20)
  s_mul_i32 s34, s15, 12
  s_mul_i32 s35, s16, 6
  s_add_u32 s34, s34, s35
  s_add_u32 s34, s34, 5
  s_mul_i32 s34, s34, 20480
  s_add_u32 s34, s34, 22020096
  buffer_load_dwordx4 v[96:99], v1, s[4:7], s34 offen offset:0
  buffer_load_dwordx4 v[100:103], v1, s[4:7], s34 offen offset:1024
  buffer_load_dwordx4 v[104:107], v1, s[4:7], s34 offen offset:2048
  buffer_load_dwordx4 v[108:111], v1, s[4:7], s34 offen offset:3072
  s_add_u32 s34, s34, 4096
  buffer_load_dwordx4 v[112:115], v1, s[4:7], s34 offen offset:0
  buffer_load_dwordx4 v[116:119], v1, s[4:7], s34 offen offset:1024
  buffer_load_dwordx4 v[120:123], v1, s[4:7], s34 offen offset:2048
  buffer_load_dwordx4 v[124:127], v1, s[4:7], s34 offen offset:3072
  s_add_u32 s34, s34, 4096
  buffer_load_dwordx4 v[128:131], v1, s[4:7], s34 offen offset:0
  buffer_load_dwordx4 v[132:135], v1, s[4:7], s34 offen offset:1024
  buffer_load_dwordx4 v[136:139], v1, s[4:7], s34 offen offset:2048
  buffer_load_dwordx4 v[140:143], v1, s[4:7], s34 offen offset:3072
  s_add_u32 s34, s34, 4096
  buffer_load_dwordx4 v[144:147], v1, s[4:7], s34 offen offset:0
  buffer_load_dwordx4 v[148:151], v1, s[4:7], s34 offen offset:1024
  buffer_load_dwordx4 v[152:155], v1, s[4:7], s34 offen offset:2048
  buffer_load_dwordx4 v[156:159], v1, s[4:7], s34 offen offset:3072
  s_add_u32 s34, s34, 4096
  buffer_load_dwordx4 v[160:163], v1, s[4:7], s34 offen offset:0
  buffer_load_dwordx4 v[164:167], v1, s[4:7], s34 offen offset:1024
  buffer_load_dwordx4 v[168:171], v1, s[4:7], s34 offen offset:2048
  buffer_load_dwordx4 v[172:175], v1, s[4:7], s34 offen offset:3072
  s_waitcnt vmcnt(20)
  v_and_b32 v30, 7, v0
  v_lshlrev_b32 v30, 3, v30
reca_cens256:
  buffer_load_dwordx2 v[28:29], v30, s[8:11], 0 offen sc1
  s_waitcnt vmcnt(0)
  v_sad_u8 v31, v28, 0, 0
  v_sad_u8 v31, v29, 0, v31
  v_cmp_gt_u32 vcc, 32, v31
  s_cbranch_vccz reca_censok257
  s_sleep 8
  s_sub_u32 s18, s18, 1
  s_cbranch_scc0 reca_cens256
  s_mov_b32 s18, 0
reca_censok257:
  v_and_b32 v28, 0x20202020, v28
  v_and_b32 v29, 0x20202020, v29
  v_cmp_ne_u32 s[34:35], 0, v28
  v_cmp_ne_u32 s[36:37], 0, v29
  s_nop 3
  s_and_b32 s34, s34, 0xff
  s_and_b32 s36, s36, 0xff
  s_or_b32 s35, s34, s36
  s_lshr_b32 s37, s35, s13
  s_and_b32 s37, s37, 1
  s_xor_b32 s43, s37, 1
  s_cmp_eq_u32 s57, 0
  s_cselect_b32 s58, s36, s34
  v_mov_b32 v31, 0x80000000
  s_cmp_lg_u32 s43, 0
  s_cbranch_scc1 reca_pslow258
reca_ptop259:
  s_cmp_lt_u32 s17, 6
  s_cbranch_scc1 reca_pgo260
  s_sub_u32 s36, s17, 6
reca_ppoll261:
  buffer_load_dword v28, v4, s[4:7], s25 offen sc1
  s_waitcnt vmcnt(0)
  v_readfirstlane_b32 s34, v28
  s_nop 3
  s_cmp_ge_i32 s34, s36
  s_cbranch_scc1 reca_pgo260
  s_sleep 8
  s_sub_u32 s18, s18, 1
  s_cbranch_scc0 reca_ppoll261
  s_mov_b32 s18, 0
reca_pgo260:
  s_waitcnt vmcnt(0)
  s_barrier
  v_add_u32 v7, s26, v1
  s_xor_b32 s26, s26, 40960
  s_add_u32 s37, s17, 1
  s_cmp_ge_u32 s37, 64
  s_cbranch_scc1 reca_pnodma262
  s_mul_i32 s20, s37, 40960
  s_add_u32 s20, s20, 153636864
  s_add_u32 m0, s26, 20480
  s_nop 0
  buffer_load_dwordx4 v1, s[4:7], s20 offen offset:0 lds
  buffer_load_dwordx4 v1, s[4:7], s20 offen offset:1024 lds
  buffer_load_dwordx4 v1, s[4:7], s20 offen offset:2048 lds
  buffer_load_dwordx4 v1, s[4:7], s20 offen offset:3072 lds
  s_add_u32 s20, s20, 4096
  s_add_u32 m0, s26, 24576
  s_nop 0
  buffer_load_dwordx4 v1, s[4:7], s20 offen offset:0 lds
  buffer_load_dwordx4 v1, s[4:7], s20 offen offset:1024 lds
  buffer_load_dwordx4 v1, s[4:7], s20 offen offset:2048 lds
  buffer_load_dwordx4 v1, s[4:7], s20 offen offset:3072 lds
  s_add_u32 s20, s20, 4096
  s_add_u32 m0, s26, 28672
  s_nop 0
  buffer_load_dwordx4 v1, s[4:7], s20 offen offset:0 lds
  buffer_load_dwordx4 v1, s[4:7], s20 offen offset:1024 lds
  s_lshl_b32 s34, s15, 6
  s_add_u32 s34, s34, s37
  s_mul_i32 s34, s34, 12288
  s_mul_i32 s35, s16, 3072
  s_add_u32 s35, s35, s34
  s_add_u32 s27, s35, 37748736
  s_mul_i32 s35, s16, 6144
  s_add_u32 s35, s35, s34
  s_add_u32 s28, s35, 62914560
  s_add_u32 s34, s28, 4096
  buffer_load_dwordx4 v[16:19], v1, s[4:7], s34 offen sc1
  s_add_u32 s34, s28, 5120
  buffer_load_dwordx4 v[16:19], v1, s[4:7], s34 offen sc1
reca_pnodma262:
  s_lshl_b32 s34, s15, 6
  s_add_u32 s34, s34, s17
  s_mul_i32 s34, s34, 12288
  s_mul_i32 s35, s16, 3072
  s_add_u32 s35, s35, s34
  s_add_u32 s21, s35, 37748736
  s_add_u32 s22, s35, 88080384
  s_mul_i32 s35, s16, 6144
  s_add_u32 s35, s35, s34
  s_add_u32 s23, s35, 62914560
  ds_read_b128 v[72:75], v7 offset:0
  ds_read_b128 v[76:79], v7 offset:20480
  ds_read_b128 v[80:83], v7 offset:1024
  ds_read_b128 v[84:87], v7 offset:21504
  ds_read_b128 v[88:91], v7 offset:2048
  ds_read_b128 v[92:95], v7 offset:22528
  s_waitcnt lgkmcnt(4)
  v_mfma_f32_16x16x32_bf16 v[32:35], a[0:3], v[72:75], 0
  v_mfma_f32_16x16x32_bf16 v[36:39], a[0:3], v[76:79], 0
  v_mfma_f32_16x16x32_bf16 v[40:43], a[80:83], v[72:75], 0
  v_mfma_f32_16x16x32_bf16 v[44:47], a[80:83], v[76:79], 0
  v_mfma_f32_16x16x32_bf16 v[48:51], v[72:75], a[160:163], 0
  v_mfma_f32_16x16x32_bf16 v[52:55], v[76:79], a[160:163], 0
  v_mfma_f32_16x16x32_bf16 v[56:59], v[72:75], v[96:99], 0
  v_mfma_f32_16x16x32_bf16 v[60:63], v[76:79], v[96:99], 0
  ds_read_b128 v[72:75], v7 offset:3072
  ds_read_b128 v[76:79], v7 offset:23552
  s_waitcnt lgkmcnt(4)
  v_mfma_f32_16x16x32_bf16 v[32:35], a[4:7], v[80:83], v[32:35]
  v_mfma_f32_16x16x32_bf16 v[36:39], a[4:7], v[84:87], v[36:39]
  v_mfma_f32_16x16x32_bf16 v[40:43], a[84:87], v[80:83], v[40:43]
  v_mfma_f32_16x16x32_bf16 v[44:47], a[84:87], v[84:87], v[44:47]
  v_mfma_f32_16x16x32_bf16 v[48:51], v[80:83], a[164:167], v[48:51]
  v_mfma_f32_16x16x32_bf16 v[52:55], v[84:87], a[164:167], v[52:55]
  v_mfma_f32_16x16x32_bf16 v[56:59], v[80:83], v[100:103], v[56:59]
  v_mfma_f32_16x16x32_bf16 v[60:63], v[84:87], v[100:103], v[60:63]
  ds_read_b128 v[80:83], v7 offset:4096
  ds_read_b128 v[84:87], v7 offset:24576
  s_waitcnt lgkmcnt(4)
  v_mfma_f32_16x16x32_bf16 v[32:35], a[8:11], v[88:91], v[32:35]
  v_mfma_f32_16x16x32_bf16 v[36:39], a[8:11], v[92:95], v[36:39]
  v_mfma_f32_16x16x32_bf16 v[40:43], a[88:91], v[88:91], v[40:43]
  v_mfma_f32_16x16x32_bf16 v[44:47], a[88:91], v[92:95], v[44:47]
  v_mfma_f32_16x16x32_bf16 v[48:51], v[88:91], a[168:171], v[48:51]
  v_mfma_f32_16x16x32_bf16 v[52:55], v[92:95], a[168:171], v[52:55]
  v_mfma_f32_16x16x32_bf16 v[56:59], v[88:91], v[104:107], v[56:59]
  v_mfma_f32_16x16x32_bf16 v[60:63], v[92:95], v[104:107], v[60:63]
  ds_read_b128 v[88:91], v7 offset:5120
  ds_read_b128 v[92:95], v7 offset:25600
  s_waitcnt lgkmcnt(4)
  v_mfma_f32_16x16x32_bf16 v[32:35], a[12:15], v[72:75], v[32:35]
  v_mfma_f32_16x16x32_bf16 v[36:39], a[12:15], v[76:79], v[36:39]
  v_mfma_f32_16x16x32_bf16 v[40:43], a[92:95], v[72:75], v[40:43]
  v_mfma_f32_16x16x32_bf16 v[44:47], a[92:95], v[76:79], v[44:47]
  v_mfma_f32_16x16x32_bf16 v[48:51], v[72:75], a[172:175], v[48:51]
  v_mfma_f32_16x16x32_bf16 v[52:55], v[76:79], a[172:175], v[52:55]
  v_mfma_f32_16x16x32_bf16 v[56:59], v[72:75], v[108:111], v[56:59]
  v_mfma_f32_16x16x32_bf16 v[60:63], v[76:79], v[108:111], v[60:63]
  ds_read_b128 v[72:75], v7 offset:6144
  ds_read_b128 v[76:79], v7 offset:26624
  s_waitcnt lgkmcnt(4)
  v_mfma_f32_16x16x32_bf16 v[32:35], a[16:19], v[80:83], v[32:35]
  v_mfma_f32_16x16x32_bf16 v[36:39], a[16:19], v[84:87], v[36:39]
  v_mfma_f32_16x16x32_bf16 v[40:43], a[96:99], v[80:83], v[40:43]
  v_mfma_f32_16x16x32_bf16 v[44:47], a[96:99], v[84:87], v[44:47]
  v_mfma_f32_16x16x32_bf16 v[48:51], v[80:83], a[176:179], v[48:51]
  v_mfma_f32_16x16x32_bf16 v[52:55], v[84:87], a[176:179], v[52:55]
  v_mfma_f32_16x16x32_bf16 v[56:59], v[80:83], v[112:115], v[56:59]
  v_mfma_f32_16x16x32_bf16 v[60:63], v[84:87], v[112:115], v[60:63]
  ds_read_b128 v[80:83], v7 offset:7168
  ds_read_b128 v[84:87], v7 offset:27648
  s_waitcnt lgkmcnt(4)
  v_mfma_f32_16x16x32_bf16 v[32:35], a[20:23], v[88:91], v[32:35]
  v_mfma_f32_16x16x32_bf16 v[36:39], a[20:23], v[92:95], v[36:39]
  v_mfma_f32_16x16x32_bf16 v[40:43], a[100:103], v[88:91], v[40:43]
  v_mfma_f32_16x16x32_bf16 v[44:47], a[100:103], v[92:95], v[44:47]
  v_mfma_f32_16x16x32_bf16 v[48:51], v[88:91], a[180:183], v[48:51]
  v_mfma_f32_16x16x32_bf16 v[52:55], v[92:95], a[180:183], v[52:55]
  v_mfma_f32_16x16x32_bf16 v[56:59], v[88:91], v[116:119], v[56:59]
  v_mfma_f32_16x16x32_bf16 v[60:63], v[92:95], v[116:119], v[60:63]
  ds_read_b128 v[88:91], v7 offset:8192
  ds_read_b128 v[92:95], v7 offset:28672
  s_waitcnt lgkmcnt(4)
  v_mfma_f32_16x16x32_bf16 v[32:35], a[24:27], v[72:75], v[32:35]
  v_mfma_f32_16x16x32_bf16 v[36:39], a[24:27], v[76:79], v[36:39]
  v_mfma_f32_16x16x32_bf16 v[40:43], a[104:107], v[72:75], v[40:43]
  v_mfma_f32_16x16x32_bf16 v[44:47], a[104:107], v[76:79], v[44:47]
  v_mfma_f32_16x16x32_bf16 v[48:51], v[72:75], a[184:187], v[48:51]
  v_mfma_f32_16x16x32_bf16 v[52:55], v[76:79], a[184:187], v[52:55]
  v_mfma_f32_16x16x32_bf16 v[56:59], v[72:75], v[120:123], v[56:59]
  v_mfma_f32_16x16x32_bf16 v[60:63], v[76:79], v[120:123], v[60:63]
  ds_read_b128 v[72:75], v7 offset:9216
  ds_read_b128 v[76:79], v7 offset:29696
  s_waitcnt lgkmcnt(4)
  v_mfma_f32_16x16x32_bf16 v[32:35], a[28:31], v[80:83], v[32:35]
  v_mfma_f32_16x16x32_bf16 v[36:39], a[28:31], v[84:87], v[36:39]
  v_mfma_f32_16x16x32_bf16 v[40:43], a[108:111], v[80:83], v[40:43]
  v_mfma_f32_16x16x32_bf16 v[44:47], a[108:111], v[84:87], v[44:47]
  v_mfma_f32_16x16x32_bf16 v[48:51], v[80:83], a[188:191], v[48:51]
  v_mfma_f32_16x16x32_bf16 v[52:55], v[84:87], a[188:191], v[52:55]
  v_mfma_f32_16x16x32_bf16 v[56:59], v[80:83], v[124:127], v[56:59]
  v_mfma_f32_16x16x32_bf16 v[60:63], v[84:87], v[124:127], v[60:63]
  ds_read_b128 v[80:83], v7 offset:10240
  ds_read_b128 v[84:87], v7 offset:30720
  s_waitcnt lgkmcnt(4)
  v_mfma_f32_16x16x32_bf16 v[32:35], a[32:35], v[88:91], v[32:35]
  v_mfma_f32_16x16x32_bf16 v[36:39], a[32:35], v[92:95], v[36:39]
  v_mfma_f32_16x16x32_bf16 v[40:43], a[112:115], v[88:91], v[40:43]
  v_mfma_f32_16x16x32_bf16 v[44:47], a[112:115], v[92:95], v[44:47]
  v_mfma_f32_16x16x32_bf16 v[48:51], v[88:91], a[192:195], v[48:51]
  v_mfma_f32_16x16x32_bf16 v[52:55], v[92:95], a[192:195], v[52:55]
  v_mfma_f32_16x16x32_bf16 v[56:59], v[88:91], v[128:131], v[56:59]
  v_mfma_f32_16x16x32_bf16 v[60:63], v[92:95], v[128:131], v[60:63]
  ds_read_b128 v[88:91], v7 offset:11264
  ds_read_b128 v[92:95], v7 offset:31744
  s_waitcnt lgkmcnt(4)
  v_mfma_f32_16x16x32_bf16 v[32:35], a[36:39], v[72:75], v[32:35]
  v_mfma_f32_16x16x32_bf16 v[36:39], a[36:39], v[76:79], v[36:39]
  v_mfma_f32_16x16x32_bf16 v[40:43], a[116:119], v[72:75], v[40:43]
  v_mfma_f32_16x16x32_bf16 v[44:47], a[116:119], v[76:79], v[44:47]
  v_mfma_f32_16x16x32_bf16 v[48:51], v[72:75], a[196:199], v[48:51]
  v_mfma_f32_16x16x32_bf16 v[52:55], v[76:79], a[196:199], v[52:55]
  v_mfma_f32_16x16x32_bf16 v[56:59], v[72:75], v[132:135], v[56:59]
  v_mfma_f32_16x16x32_bf16 v[60:63], v[76:79], v[132:135], v[60:63]
  ds_read_b128 v[72:75], v7 offset:12288
  ds_read_b128 v[76:79], v7 offset:32768
  s_waitcnt lgkmcnt(4)
  v_mfma_f32_16x16x32_bf16 v[32:35], a[40:43], v[80:83], v[32:35]
  v_mfma_f32_16x16x32_bf16 v[36:39], a[40:43], v[84:87], v[36:39]
  v_mfma_f32_16x16x32_bf16 v[40:43], a[120:123], v[80:83], v[40:43]
  v_mfma_f32_16x16x32_bf16 v[44:47], a[120:123], v[84:87], v[44:47]
  v_mfma_f32_16x16x32_bf16 v[48:51], v[80:83], a[200:203], v[48:51]
  v_mfma_f32_16x16x32_bf16 v[52:55], v[84:87], a[200:203], v[52:55]
  v_mfma_f32_16x16x32_bf16 v[56:59], v[80:83], v[136:139], v[56:59]
  v_mfma_f32_16x16x32_bf16 v[60:63], v[84:87], v[136:139], v[60:63]
  ds_read_b128 v[80:83], v7 offset:13312
  ds_read_b128 v[84:87], v7 offset:33792
  s_waitcnt lgkmcnt(4)
  v_mfma_f32_16x16x32_bf16 v[32:35], a[44:47], v[88:91], v[32:35]
  v_mfma_f32_16x16x32_bf16 v[36:39], a[44:47], v[92:95], v[36:39]
  v_mfma_f32_16x16x32_bf16 v[40:43], a[124:127], v[88:91], v[40:43]
  v_mfma_f32_16x16x32_bf16 v[44:47], a[124:127], v[92:95], v[44:47]
  v_mfma_f32_16x16x32_bf16 v[48:51], v[88:91], a[204:207], v[48:51]
  v_mfma_f32_16x16x32_bf16 v[52:55], v[92:95], a[204:207], v[52:55]
  v_mfma_f32_16x16x32_bf16 v[56:59], v[88:91], v[140:143], v[56:59]
  v_mfma_f32_16x16x32_bf16 v[60:63], v[92:95], v[140:143], v[60:63]
  ds_read_b128 v[88:91], v7 offset:14336
  ds_read_b128 v[92:95], v7 offset:34816
  s_waitcnt lgkmcnt(4)
  v_mfma_f32_16x16x32_bf16 v[32:35], a[48:51], v[72:75], v[32:35]
  v_mfma_f32_16x16x32_bf16 v[36:39], a[48:51], v[76:79], v[36:39]
  v_mfma_f32_16x16x32_bf16 v[40:43], a[128:131], v[72:75], v[40:43]
  v_mfma_f32_16x16x32_bf16 v[44:47], a[128:131], v[76:79], v[44:47]
  v_mfma_f32_16x16x32_bf16 v[48:51], v[72:75], a[208:211], v[48:51]
  v_mfma_f32_16x16x32_bf16 v[52:55], v[76:79], a[208:211], v[52:55]
  v_mfma_f32_16x16x32_bf16 v[56:59], v[72:75], v[144:147], v[56:59]
  v_mfma_f32_16x16x32_bf16 v[60:63], v[76:79], v[144:147], v[60:63]
  ds_read_b128 v[72:75], v7 offset:15360
  ds_read_b128 v[76:79], v7 offset:35840
  s_waitcnt lgkmcnt(4)
  v_mfma_f32_16x16x32_bf16 v[32:35], a[52:55], v[80:83], v[32:35]
  v_mfma_f32_16x16x32_bf16 v[36:39], a[52:55], v[84:87], v[36:39]
  v_mfma_f32_16x16x32_bf16 v[40:43], a[132:135], v[80:83], v[40:43]
  v_mfma_f32_16x16x32_bf16 v[44:47], a[132:135], v[84:87], v[44:47]
  v_mfma_f32_16x16x32_bf16 v[48:51], v[80:83], a[212:215], v[48:51]
  v_mfma_f32_16x16x32_bf16 v[52:55], v[84:87], a[212:215], v[52:55]
  v_mfma_f32_16x16x32_bf16 v[56:59], v[80:83], v[148:151], v[56:59]
  v_mfma_f32_16x16x32_bf16 v[60:63], v[84:87], v[148:151], v[60:63]
  ds_read_b128 v[80:83], v7 offset:16384
  ds_read_b128 v[84:87], v7 offset:36864
  s_waitcnt lgkmcnt(4)
  v_mfma_f32_16x16x32_bf16 v[32:35], a[56:59], v[88:91], v[32:35]
  v_mfma_f32_16x16x32_bf16 v[36:39], a[56:59], v[92:95], v[36:39]
  v_mfma_f32_16x16x32_bf16 v[40:43], a[136:139], v[88:91], v[40:43]
  v_mfma_f32_16x16x32_bf16 v[44:47], a[136:139], v[92:95], v[44:47]
  v_mfma_f32_16x16x32_bf16 v[48:51], v[88:91], a[216:219], v[48:51]
  v_mfma_f32_16x16x32_bf16 v[52:55], v[92:95], a[216:219], v[52:55]
  v_mfma_f32_16x16x32_bf16 v[56:59], v[88:91], v[152:155], v[56:59]
  v_mfma_f32_16x16x32_bf16 v[60:63], v[92:95], v[152:155], v[60:63]
  ds_read_b128 v[88:91], v7 offset:17408
  ds_read_b128 v[92:95], v7 offset:37888
  s_waitcnt lgkmcnt(4)
  v_mfma_f32_16x16x32_bf16 v[32:35], a[60:63], v[72:75], v[32:35]
  v_mfma_f32_16x16x32_bf16 v[36:39], a[60:63], v[76:79], v[36:39]
  v_mfma_f32_16x16x32_bf16 v[40:43], a[140:143], v[72:75], v[40:43]
  v_mfma_f32_16x16x32_bf16 v[44:47], a[140:143], v[76:79], v[44:47]
  v_mfma_f32_16x16x32_bf16 v[48:51], v[72:75], a[220:223], v[48:51]
  v_mfma_f32_16x16x32_bf16 v[52:55], v[76:79], a[220:223], v[52:55]
  v_mfma_f32_16x16x32_bf16 v[56:59], v[72:75], v[156:159], v[56:59]
  v_mfma_f32_16x16x32_bf16 v[60:63], v[76:79], v[156:159], v[60:63]
  ds_read_b128 v[72:75], v7 offset:18432
  ds_read_b128 v[76:79], v7 offset:38912
  s_waitcnt lgkmcnt(4)
  v_mfma_f32_16x16x32_bf16 v[32:35], a[64:67], v[80:83], v[32:35]
  v_mfma_f32_16x16x32_bf16 v[36:39], a[64:67], v[84:87], v[36:39]
  v_mfma_f32_16x16x32_bf16 v[40:43], a[144:147], v[80:83], v[40:43]
  v_mfma_f32_16x16x32_bf16 v[44:47], a[144:147], v[84:87], v[44:47]
  v_mfma_f32_16x16x32_bf16 v[48:51], v[80:83], a[224:227], v[48:51]
  v_mfma_f32_16x16x32_bf16 v[52:55], v[84:87], a[224:227], v[52:55]
  v_mfma_f32_16x16x32_bf16 v[56:59], v[80:83], v[160:163], v[56:59]
  v_mfma_f32_16x16x32_bf16 v[60:63], v[84:87], v[160:163], v[60:63]
  ds_read_b128 v[80:83], v7 offset:19456
  ds_read_b128 v[84:87], v7 offset:39936
  s_waitcnt lgkmcnt(4)
  v_mfma_f32_16x16x32_bf16 v[32:35], a[68:71], v[88:91], v[32:35]
  v_mfma_f32_16x16x32_bf16 v[36:39], a[68:71], v[92:95], v[36:39]
  v_mfma_f32_16x16x32_bf16 v[40:43], a[148:151], v[88:91], v[40:43]
  v_mfma_f32_16x16x32_bf16 v[44:47], a[148:151], v[92:95], v[44:47]
  v_mfma_f32_16x16x32_bf16 v[48:51], v[88:91], a[228:231], v[48:51]
  v_mfma_f32_16x16x32_bf16 v[52:55], v[92:95], a[228:231], v[52:55]
  v_mfma_f32_16x16x32_bf16 v[56:59], v[88:91], v[164:167], v[56:59]
  v_mfma_f32_16x16x32_bf16 v[60:63], v[92:95], v[164:167], v[60:63]
  s_waitcnt lgkmcnt(2)
  v_mfma_f32_16x16x32_bf16 v[32:35], a[72:75], v[72:75], v[32:35]
  v_mfma_f32_16x16x32_bf16 v[36:39], a[72:75], v[76:79], v[36:39]
  v_mfma_f32_16x16x32_bf16 v[40:43], a[152:155], v[72:75], v[40:43]
  v_mfma_f32_16x16x32_bf16 v[44:47], a[152:155], v[76:79], v[44:47]
  v_mfma_f32_16x16x32_bf16 v[48:51], v[72:75], a[232:235], v[48:51]
  v_mfma_f32_16x16x32_bf16 v[52:55], v[76:79], a[232:235], v[52:55]
  v_mfma_f32_16x16x32_bf16 v[56:59], v[72:75], v[168:171], v[56:59]
  v_mfma_f32_16x16x32_bf16 v[60:63], v[76:79], v[168:171], v[60:63]
  s_waitcnt lgkmcnt(0)
  v_mfma_f32_16x16x32_bf16 v[32:35], a[76:79], v[80:83], v[32:35]
  v_mfma_f32_16x16x32_bf16 v[36:39], a[76:79], v[84:87], v[36:39]
  v_mfma_f32_16x16x32_bf16 v[40:43], a[156:159], v[80:83], v[40:43]
  v_mfma_f32_16x16x32_bf16 v[44:47], a[156:159], v[84:87], v[44:47]
  v_mfma_f32_16x16x32_bf16 v[48:51], v[80:83], a[236:239], v[48:51]
  v_mfma_f32_16x16x32_bf16 v[52:55], v[84:87], a[236:239], v[52:55]
  v_mfma_f32_16x16x32_bf16 v[56:59], v[80:83], v[172:175], v[56:59]
  v_mfma_f32_16x16x32_bf16 v[60:63], v[84:87], v[172:175], v[60:63]
  s_nop 0
  v_cvt_pk_bf16_f32 v8, v32, v33
  v_cvt_pk_bf16_f32 v9, v34, v35
  v_cvt_pk_bf16_f32 v10, v40, v41
  v_cvt_pk_bf16_f32 v11, v42, v43
  s_add_u32 s34, s22, 0
  buffer_store_dwordx4 v[8:11], v1, s[4:7], s34 offen
  v_cvt_pk_bf16_f32 v12, v36, v37
  v_cvt_pk_bf16_f32 v13, v38, v39
  v_cvt_pk_bf16_f32 v14, v44, v45
  v_cvt_pk_bf16_f32 v15, v46, v47
  s_add_u32 s34, s22, 6144
  buffer_store_dwordx4 v[12:15], v1, s[4:7], s34 offen
  v_cvt_pk_bf16_f32 v8, v48, v49
  v_cvt_pk_bf16_f32 v9, v50, v51
  v_cvt_pk_bf16_f32 v10, v52, v53
  v_cvt_pk_bf16_f32 v11, v54, v55
  s_add_u32 s34, s23, 4096
  buffer_store_dwordx4 v[8:11], v1, s[4:7], s34 offen
  v_cvt_pk_bf16_f32 v12, v56, v57
  v_cvt_pk_bf16_f32 v13, v58, v59
  v_cvt_pk_bf16_f32 v14, v60, v61
  v_cvt_pk_bf16_f32 v15, v62, v63
  s_add_u32 s34, s23, 5120
  buffer_store_dwordx4 v[12:15], v1, s[4:7], s34 offen
  s_waitcnt vmcnt(0)
  s_barrier
  s_add_u32 s17, s17, 1
  s_cmp_lt_u32 s17, 64
  s_cbranch_scc1 reca_ptop259
  s_branch reca_exit1
reca_pslow258:
reca_ptop264:
  s_cmp_lt_u32 s17, 6
  s_cbranch_scc1 reca_pgo265
  s_sub_u32 s36, s17, 6
reca_ppoll266:
  buffer_load_dword v28, v4, s[4:7], s25 offen sc1
  s_waitcnt vmcnt(0)
  v_readfirstlane_b32 s34, v28
  s_nop 3
  s_cmp_ge_i32 s34, s36
  s_cbranch_scc1 reca_pgo265
  s_sleep 8
  s_sub_u32 s18, s18, 1
  s_cbranch_scc0 reca_ppoll266
  s_mov_b32 s18, 0
reca_pgo265:
  s_waitcnt vmcnt(0)
  s_barrier
  v_add_u32 v7, s26, v1
  s_xor_b32 s26, s26, 40960
  s_add_u32 s37, s17, 1
  s_cmp_ge_u32 s37, 64
  s_cbranch_scc1 reca_pnodma267
  s_mul_i32 s20, s37, 40960
  s_add_u32 s20, s20, 153636864
  s_add_u32 m0, s26, 20480
  s_nop 0
  buffer_load_dwordx4 v1, s[4:7], s20 offen offset:0 lds
  buffer_load_dwordx4 v1, s[4:7], s20 offen offset:1024 lds
  buffer_load_dwordx4 v1, s[4:7], s20 offen offset:2048 lds
  buffer_load_dwordx4 v1, s[4:7], s20 offen offset:3072 lds
  s_add_u32 s20, s20, 4096
  s_add_u32 m0, s26, 24576
  s_nop 0
  buffer_load_dwordx4 v1, s[4:7], s20 offen offset:0 lds
  buffer_load_dwordx4 v1, s[4:7], s20 offen offset:1024 lds
  buffer_load_dwordx4 v1, s[4:7], s20 offen offset:2048 lds
  buffer_load_dwordx4 v1, s[4:7], s20 offen offset:3072 lds
  s_add_u32 s20, s20, 4096
  s_add_u32 m0, s26, 28672
  s_nop 0
  buffer_load_dwordx4 v1, s[4:7], s20 offen offset:0 lds
  buffer_load_dwordx4 v1, s[4:7], s20 offen offset:1024 lds
  s_lshl_b32 s34, s15, 6
  s_add_u32 s34, s34, s37
  s_mul_i32 s34, s34, 12288
  s_mul_i32 s35, s16, 3072
  s_add_u32 s35, s35, s34
  s_add_u32 s27, s35, 37748736
  s_mul_i32 s35, s16, 6144
  s_add_u32 s35, s35, s34
  s_add_u32 s28, s35, 62914560
  s_add_u32 s34, s28, 4096
  buffer_load_dwordx4 v[16:19], v1, s[4:7], s34 offen sc1
  s_add_u32 s34, s28, 5120
  buffer_load_dwordx4 v[16:19], v1, s[4:7], s34 offen sc1
reca_pnodma267:
  s_lshl_b32 s34, s15, 6
  s_add_u32 s34, s34, s17
  s_mul_i32 s34, s34, 12288
  s_mul_i32 s35, s16, 3072
  s_add_u32 s35, s35, s34
  s_add_u32 s21, s35, 37748736
  s_add_u32 s22, s35, 88080384
  s_mul_i32 s35, s16, 6144
  s_add_u32 s35, s35, s34
  s_add_u32 s23, s35, 62914560
  ds_read_b128 v[72:75], v7 offset:0
  ds_read_b128 v[76:79], v7 offset:20480
  ds_read_b128 v[80:83], v7 offset:1024
  ds_read_b128 v[84:87], v7 offset:21504
  ds_read_b128 v[88:91], v7 offset:2048
  ds_read_b128 v[92:95], v7 offset:22528
  s_waitcnt lgkmcnt(4)
  v_mfma_f32_16x16x32_bf16 v[32:35], a[0:3], v[72:75], 0
  v_mfma_f32_16x16x32_bf16 v[36:39], a[0:3], v[76:79], 0
  v_mfma_f32_16x16x32_bf16 v[40:43], a[80:83], v[72:75], 0
  v_mfma_f32_16x16x32_bf16 v[44:47], a[80:83], v[76:79], 0
  v_mfma_f32_16x16x32_bf16 v[48:51], v[72:75], a[160:163], 0
  v_mfma_f32_16x16x32_bf16 v[52:55], v[76:79], a[160:163], 0
  v_mfma_f32_16x16x32_bf16 v[56:59], v[72:75], v[96:99], 0
  v_mfma_f32_16x16x32_bf16 v[60:63], v[76:79], v[96:99], 0
  ds_read_b128 v[72:75], v7 offset:3072
  ds_read_b128 v[76:79], v7 offset:23552
  s_waitcnt lgkmcnt(4)
  v_mfma_f32_16x16x32_bf16 v[32:35], a[4:7], v[80:83], v[32:35]
  v_mfma_f32_16x16x32_bf16 v[36:39], a[4:7], v[84:87], v[36:39]
  v_mfma_f32_16x16x32_bf16 v[40:43], a[84:87], v[80:83], v[40:43]
  v_mfma_f32_16x16x32_bf16 v[44:47], a[84:87], v[84:87], v[44:47]
  v_mfma_f32_16x16x32_bf16 v[48:51], v[80:83], a[164:167], v[48:51]
  v_mfma_f32_16x16x32_bf16 v[52:55], v[84:87], a[164:167], v[52:55]
  v_mfma_f32_16x16x32_bf16 v[56:59], v[80:83], v[100:103], v[56:59]
  v_mfma_f32_16x16x32_bf16 v[60:63], v[84:87], v[100:103], v[60:63]
  ds_read_b128 v[80:83], v7 offset:4096
  ds_read_b128 v[84:87], v7 offset:24576
  s_waitcnt lgkmcnt(4)
  v_mfma_f32_16x16x32_bf16 v[32:35], a[8:11], v[88:91], v[32:35]
  v_mfma_f32_16x16x32_bf16 v[36:39], a[8:11], v[92:95], v[36:39]
  v_mfma_f32_16x16x32_bf16 v[40:43], a[88:91], v[88:91], v[40:43]
  v_mfma_f32_16x16x32_bf16 v[44:47], a[88:91], v[92:95], v[44:47]
  v_mfma_f32_16x16x32_bf16 v[48:51], v[88:91], a[168:171], v[48:51]
  v_mfma_f32_16x16x32_bf16 v[52:55], v[92:95], a[168:171], v[52:55]
  v_mfma_f32_16x16x32_bf16 v[56:59], v[88:91], v[104:107], v[56:59]
  v_mfma_f32_16x16x32_bf16 v[60:63], v[92:95], v[104:107], v[60:63]
  ds_read_b128 v[88:91], v7 offset:5120
  ds_read_b128 v[92:95], v7 offset:25600
  s_waitcnt lgkmcnt(4)
  v_mfma_f32_16x16x32_bf16 v[32:35], a[12:15], v[72:75], v[32:35]
  v_mfma_f32_16x16x32_bf16 v[36:39], a[12:15], v[76:79], v[36:39]
  v_mfma_f32_16x16x32_bf16 v[40:43], a[92:95], v[72:75], v[40:43]
  v_mfma_f32_16x16x32_bf16 v[44:47], a[92:95], v[76:79], v[44:47]
  v_mfma_f32_16x16x32_bf16 v[48:51], v[72:75], a[172:175], v[48:51]
  v_mfma_f32_16x16x32_bf16 v[52:55], v[76:79], a[172:175], v[52:55]
  v_mfma_f32_16x16x32_bf16 v[56:59], v[72:75], v[108:111], v[56:59]
  v_mfma_f32_16x16x32_bf16 v[60:63], v[76:79], v[108:111], v[60:63]
  ds_read_b128 v[72:75], v7 offset:6144
  ds_read_b128 v[76:79], v7 offset:26624
  s_waitcnt lgkmcnt(4)
  v_mfma_f32_16x16x32_bf16 v[32:35], a[16:19], v[80:83], v[32:35]
  v_mfma_f32_16x16x32_bf16 v[36:39], a[16:19], v[84:87], v[36:39]
  v_mfma_f32_16x16x32_bf16 v[40:43], a[96:99], v[80:83], v[40:43]
  v_mfma_f32_16x16x32_bf16 v[44:47], a[96:99], v[84:87], v[44:47]
  v_mfma_f32_16x16x32_bf16 v[48:51], v[80:83], a[176:179], v[48:51]
  v_mfma_f32_16x16x32_bf16 v[52:55], v[84:87], a[176:179], v[52:55]
  v_mfma_f32_16x16x32_bf16 v[56:59], v[80:83], v[112:115], v[56:59]
  v_mfma_f32_16x16x32_bf16 v[60:63], v[84:87], v[112:115], v[60:63]
  ds_read_b128 v[80:83], v7 offset:7168
  ds_read_b128 v[84:87], v7 offset:27648
  s_waitcnt lgkmcnt(4)
  v_mfma_f32_16x16x32_bf16 v[32:35], a[20:23], v[88:91], v[32:35]
  v_mfma_f32_16x16x32_bf16 v[36:39], a[20:23], v[92:95], v[36:39]
  v_mfma_f32_16x16x32_bf16 v[40:43], a[100:103], v[88:91], v[40:43]
  v_mfma_f32_16x16x32_bf16 v[44:47], a[100:103], v[92:95], v[44:47]
  v_mfma_f32_16x16x32_bf16 v[48:51], v[88:91], a[180:183], v[48:51]
  v_mfma_f32_16x16x32_bf16 v[52:55], v[92:95], a[180:183], v[52:55]
  v_mfma_f32_16x16x32_bf16 v[56:59], v[88:91], v[116:119], v[56:59]
  v_mfma_f32_16x16x32_bf16 v[60:63], v[92:95], v[116:119], v[60:63]
  ds_read_b128 v[88:91], v7 offset:8192
  ds_read_b128 v[92:95], v7 offset:28672
  s_waitcnt lgkmcnt(4)
  v_mfma_f32_16x16x32_bf16 v[32:35], a[24:27], v[72:75], v[32:35]
  v_mfma_f32_16x16x32_bf16 v[36:39], a[24:27], v[76:79], v[36:39]
  v_mfma_f32_16x16x32_bf16 v[40:43], a[104:107], v[72:75], v[40:43]
  v_mfma_f32_16x16x32_bf16 v[44:47], a[104:107], v[76:79], v[44:47]
  v_mfma_f32_16x16x32_bf16 v[48:51], v[72:75], a[184:187], v[48:51]
  v_mfma_f32_16x16x32_bf16 v[52:55], v[76:79], a[184:187], v[52:55]
  v_mfma_f32_16x16x32_bf16 v[56:59], v[72:75], v[120:123], v[56:59]
  v_mfma_f32_16x16x32_bf16 v[60:63], v[76:79], v[120:123], v[60:63]
  ds_read_b128 v[72:75], v7 offset:9216
  ds_read_b128 v[76:79], v7 offset:29696
  s_waitcnt lgkmcnt(4)
  v_mfma_f32_16x16x32_bf16 v[32:35], a[28:31], v[80:83], v[32:35]
  v_mfma_f32_16x16x32_bf16 v[36:39], a[28:31], v[84:87], v[36:39]
  v_mfma_f32_16x16x32_bf16 v[40:43], a[108:111], v[80:83], v[40:43]
  v_mfma_f32_16x16x32_bf16 v[44:47], a[108:111], v[84:87], v[44:47]
  v_mfma_f32_16x16x32_bf16 v[48:51], v[80:83], a[188:191], v[48:51]
  v_mfma_f32_16x16x32_bf16 v[52:55], v[84:87], a[188:191], v[52:55]
  v_mfma_f32_16x16x32_bf16 v[56:59], v[80:83], v[124:127], v[56:59]
  v_mfma_f32_16x16x32_bf16 v[60:63], v[84:87], v[124:127], v[60:63]
  ds_read_b128 v[80:83], v7 offset:10240
  ds_read_b128 v[84:87], v7 offset:30720
  s_waitcnt lgkmcnt(4)
  v_mfma_f32_16x16x32_bf16 v[32:35], a[32:35], v[88:91], v[32:35]
  v_mfma_f32_16x16x32_bf16 v[36:39], a[32:35], v[92:95], v[36:39]
  v_mfma_f32_16x16x32_bf16 v[40:43], a[112:115], v[88:91], v[40:43]
  v_mfma_f32_16x16x32_bf16 v[44:47], a[112:115], v[92:95], v[44:47]
  v_mfma_f32_16x16x32_bf16 v[48:51], v[88:91], a[192:195], v[48:51]
  v_mfma_f32_16x16x32_bf16 v[52:55], v[92:95], a[192:195], v[52:55]
  v_mfma_f32_16x16x32_bf16 v[56:59], v[88:91], v[128:131], v[56:59]
  v_mfma_f32_16x16x32_bf16 v[60:63], v[92:95], v[128:131], v[60:63]
  ds_read_b128 v[88:91], v7 offset:11264
  ds_read_b128 v[92:95], v7 offset:31744
  s_waitcnt lgkmcnt(4)
  v_mfma_f32_16x16x32_bf16 v[32:35], a[36:39], v[72:75], v[32:35]
  v_mfma_f32_16x16x32_bf16 v[36:39], a[36:39], v[76:79], v[36:39]
  v_mfma_f32_16x16x32_bf16 v[40:43], a[116:119], v[72:75], v[40:43]
  v_mfma_f32_16x16x32_bf16 v[44:47], a[116:119], v[76:79], v[44:47]
  v_mfma_f32_16x16x32_bf16 v[48:51], v[72:75], a[196:199], v[48:51]
  v_mfma_f32_16x16x32_bf16 v[52:55], v[76:79], a[196:199], v[52:55]
  v_mfma_f32_16x16x32_bf16 v[56:59], v[72:75], v[132:135], v[56:59]
  v_mfma_f32_16x16x32_bf16 v[60:63], v[76:79], v[132:135], v[60:63]
  ds_read_b128 v[72:75], v7 offset:12288
  ds_read_b128 v[76:79], v7 offset:32768
  s_waitcnt lgkmcnt(4)
  v_mfma_f32_16x16x32_bf16 v[32:35], a[40:43], v[80:83], v[32:35]
  v_mfma_f32_16x16x32_bf16 v[36:39], a[40:43], v[84:87], v[36:39]
  v_mfma_f32_16x16x32_bf16 v[40:43], a[120:123], v[80:83], v[40:43]
  v_mfma_f32_16x16x32_bf16 v[44:47], a[120:123], v[84:87], v[44:47]
  v_mfma_f32_16x16x32_bf16 v[48:51], v[80:83], a[200:203], v[48:51]
  v_mfma_f32_16x16x32_bf16 v[52:55], v[84:87], a[200:203], v[52:55]
  v_mfma_f32_16x16x32_bf16 v[56:59], v[80:83], v[136:139], v[56:59]
  v_mfma_f32_16x16x32_bf16 v[60:63], v[84:87], v[136:139], v[60:63]
  ds_read_b128 v[80:83], v7 offset:13312
  ds_read_b128 v[84:87], v7 offset:33792
  s_waitcnt lgkmcnt(4)
  v_mfma_f32_16x16x32_bf16 v[32:35], a[44:47], v[88:91], v[32:35]
  v_mfma_f32_16x16x32_bf16 v[36:39], a[44:47], v[92:95], v[36:39]
  v_mfma_f32_16x16x32_bf16 v[40:43], a[124:127], v[88:91], v[40:43]
  v_mfma_f32_16x16x32_bf16 v[44:47], a[124:127], v[92:95], v[44:47]
  v_mfma_f32_16x16x32_bf16 v[48:51], v[88:91], a[204:207], v[48:51]
  v_mfma_f32_16x16x32_bf16 v[52:55], v[92:95], a[204:207], v[52:55]
  v_mfma_f32_16x16x32_bf16 v[56:59], v[88:91], v[140:143], v[56:59]
  v_mfma_f32_16x16x32_bf16 v[60:63], v[92:95], v[140:143], v[60:63]
  ds_read_b128 v[88:91], v7 offset:14336
  ds_read_b128 v[92:95], v7 offset:34816
  s_waitcnt lgkmcnt(4)
  v_mfma_f32_16x16x32_bf16 v[32:35], a[48:51], v[72:75], v[32:35]
  v_mfma_f32_16x16x32_bf16 v[36:39], a[48:51], v[76:79], v[36:39]
  v_mfma_f32_16x16x32_bf16 v[40:43], a[128:131], v[72:75], v[40:43]
  v_mfma_f32_16x16x32_bf16 v[44:47], a[128:131], v[76:79], v[44:47]
  v_mfma_f32_16x16x32_bf16 v[48:51], v[72:75], a[208:211], v[48:51]
  v_mfma_f32_16x16x32_bf16 v[52:55], v[76:79], a[208:211], v[52:55]
  v_mfma_f32_16x16x32_bf16 v[56:59], v[72:75], v[144:147], v[56:59]
  v_mfma_f32_16x16x32_bf16 v[60:63], v[76:79], v[144:147], v[60:63]
  ds_read_b128 v[72:75], v7 offset:15360
  ds_read_b128 v[76:79], v7 offset:35840
  s_waitcnt lgkmcnt(4)
  v_mfma_f32_16x16x32_bf16 v[32:35], a[52:55], v[80:83], v[32:35]
  v_mfma_f32_16x16x32_bf16 v[36:39], a[52:55], v[84:87], v[36:39]
  v_mfma_f32_16x16x32_bf16 v[40:43], a[132:135], v[80:83], v[40:43]
  v_mfma_f32_16x16x32_bf16 v[44:47], a[132:135], v[84:87], v[44:47]
  v_mfma_f32_16x16x32_bf16 v[48:51], v[80:83], a[212:215], v[48:51]
  v_mfma_f32_16x16x32_bf16 v[52:55], v[84:87], a[212:215], v[52:55]
  v_mfma_f32_16x16x32_bf16 v[56:59], v[80:83], v[148:151], v[56:59]
  v_mfma_f32_16x16x32_bf16 v[60:63], v[84:87], v[148:151], v[60:63]
  ds_read_b128 v[80:83], v7 offset:16384
  ds_read_b128 v[84:87], v7 offset:36864
  s_waitcnt lgkmcnt(4)
  v_mfma_f32_16x16x32_bf16 v[32:35], a[56:59], v[88:91], v[32:35]
  v_mfma_f32_16x16x32_bf16 v[36:39], a[56:59], v[92:95], v[36:39]
  v_mfma_f32_16x16x32_bf16 v[40:43], a[136:139], v[88:91], v[40:43]
  v_mfma_f32_16x16x32_bf16 v[44:47], a[136:139], v[92:95], v[44:47]
  v_mfma_f32_16x16x32_bf16 v[48:51], v[88:91], a[216:219], v[48:51]
  v_mfma_f32_16x16x32_bf16 v[52:55], v[92:95], a[216:219], v[52:55]
  v_mfma_f32_16x16x32_bf16 v[56:59], v[88:91], v[152:155], v[56:59]
  v_mfma_f32_16x16x32_bf16 v[60:63], v[92:95], v[152:155], v[60:63]
  ds_read_b128 v[88:91], v7 offset:17408
  ds_read_b128 v[92:95], v7 offset:37888
  s_waitcnt lgkmcnt(4)
  v_mfma_f32_16x16x32_bf16 v[32:35], a[60:63], v[72:75], v[32:35]
  v_mfma_f32_16x16x32_bf16 v[36:39], a[60:63], v[76:79], v[36:39]
  v_mfma_f32_16x16x32_bf16 v[40:43], a[140:143], v[72:75], v[40:43]
  v_mfma_f32_16x16x32_bf16 v[44:47], a[140:143], v[76:79], v[44:47]
  v_mfma_f32_16x16x32_bf16 v[48:51], v[72:75], a[220:223], v[48:51]
  v_mfma_f32_16x16x32_bf16 v[52:55], v[76:79], a[220:223], v[52:55]
  v_mfma_f32_16x16x32_bf16 v[56:59], v[72:75], v[156:159], v[56:59]
  v_mfma_f32_16x16x32_bf16 v[60:63], v[76:79], v[156:159], v[60:63]
  ds_read_b128 v[72:75], v7 offset:18432
  ds_read_b128 v[76:79], v7 offset:38912
  s_waitcnt lgkmcnt(4)
  v_mfma_f32_16x16x32_bf16 v[32:35], a[64:67], v[80:83], v[32:35]
  v_mfma_f32_16x16x32_bf16 v[36:39], a[64:67], v[84:87], v[36:39]
  v_mfma_f32_16x16x32_bf16 v[40:43], a[144:147], v[80:83], v[40:43]
  v_mfma_f32_16x16x32_bf16 v[44:47], a[144:147], v[84:87], v[44:47]
  v_mfma_f32_16x16x32_bf16 v[48:51], v[80:83], a[224:227], v[48:51]
  v_mfma_f32_16x16x32_bf16 v[52:55], v[84:87], a[224:227], v[52:55]
  v_mfma_f32_16x16x32_bf16 v[56:59], v[80:83], v[160:163], v[56:59]
  v_mfma_f32_16x16x32_bf16 v[60:63], v[84:87], v[160:163], v[60:63]
  ds_read_b128 v[80:83], v7 offset:19456
  ds_read_b128 v[84:87], v7 offset:39936
  s_waitcnt lgkmcnt(4)
  v_mfma_f32_16x16x32_bf16 v[32:35], a[68:71], v[88:91], v[32:35]
  v_mfma_f32_16x16x32_bf16 v[36:39], a[68:71], v[92:95], v[36:39]
  v_mfma_f32_16x16x32_bf16 v[40:43], a[148:151], v[88:91], v[40:43]
  v_mfma_f32_16x16x32_bf16 v[44:47], a[148:151], v[92:95], v[44:47]
  v_mfma_f32_16x16x32_bf16 v[48:51], v[88:91], a[228:231], v[48:51]
  v_mfma_f32_16x16x32_bf16 v[52:55], v[92:95], a[228:231], v[52:55]
  v_mfma_f32_16x16x32_bf16 v[56:59], v[88:91], v[164:167], v[56:59]
  v_mfma_f32_16x16x32_bf16 v[60:63], v[92:95], v[164:167], v[60:63]
  s_waitcnt lgkmcnt(2)
  v_mfma_f32_16x16x32_bf16 v[32:35], a[72:75], v[72:75], v[32:35]
  v_mfma_f32_16x16x32_bf16 v[36:39], a[72:75], v[76:79], v[36:39]
  v_mfma_f32_16x16x32_bf16 v[40:43], a[152:155], v[72:75], v[40:43]
  v_mfma_f32_16x16x32_bf16 v[44:47], a[152:155], v[76:79], v[44:47]
  v_mfma_f32_16x16x32_bf16 v[48:51], v[72:75], a[232:235], v[48:51]
  v_mfma_f32_16x16x32_bf16 v[52:55], v[76:79], a[232:235], v[52:55]
  v_mfma_f32_16x16x32_bf16 v[56:59], v[72:75], v[168:171], v[56:59]
  v_mfma_f32_16x16x32_bf16 v[60:63], v[76:79], v[168:171], v[60:63]
  s_waitcnt lgkmcnt(0)
  v_mfma_f32_16x16x32_bf16 v[32:35], a[76:79], v[80:83], v[32:35]
  v_mfma_f32_16x16x32_bf16 v[36:39], a[76:79], v[84:87], v[36:39]
  v_mfma_f32_16x16x32_bf16 v[40:43], a[156:159], v[80:83], v[40:43]
  v_mfma_f32_16x16x32_bf16 v[44:47], a[156:159], v[84:87], v[44:47]
  v_mfma_f32_16x16x32_bf16 v[48:51], v[80:83], a[236:239], v[48:51]
  v_mfma_f32_16x16x32_bf16 v[52:55], v[84:87], a[236:239], v[52:55]
  v_mfma_f32_16x16x32_bf16 v[56:59], v[80:83], v[172:175], v[56:59]
  v_mfma_f32_16x16x32_bf16 v[60:63], v[84:87], v[172:175], v[60:63]
  s_nop 0
  v_cvt_pk_bf16_f32 v8, v32, v33
  v_cvt_pk_bf16_f32 v9, v34, v35
  v_cvt_pk_bf16_f32 v10, v40, v41
  v_cvt_pk_bf16_f32 v11, v42, v43
  s_add_u32 s34, s22, 0
  buffer_store_dwordx4 v[8:11], v1, s[4:7], s34 offen sc1
  v_cvt_pk_bf16_f32 v12, v36, v37
  v_cvt_pk_bf16_f32 v13, v38, v39
  v_cvt_pk_bf16_f32 v14, v44, v45
  v_cvt_pk_bf16_f32 v15, v46, v47
  s_add_u32 s34, s22, 6144
  buffer_store_dwordx4 v[12:15], v1, s[4:7], s34 offen sc1
  v_cvt_pk_bf16_f32 v8, v48, v49
  v_cvt_pk_bf16_f32 v9, v50, v51
  v_cvt_pk_bf16_f32 v10, v52, v53
  v_cvt_pk_bf16_f32 v11, v54, v55
  s_add_u32 s34, s23, 4096
  buffer_store_dwordx4 v[8:11], v1, s[4:7], s34 offen sc1
  v_cvt_pk_bf16_f32 v12, v56, v57
  v_cvt_pk_bf16_f32 v13, v58, v59
  v_cvt_pk_bf16_f32 v14, v60, v61
  v_cvt_pk_bf16_f32 v15, v62, v63
  s_add_u32 s34, s23, 5120
  buffer_store_dwordx4 v[12:15], v1, s[4:7], s34 offen sc1
  s_waitcnt vmcnt(0)
  s_barrier
  s_add_u32 s17, s17, 1
  s_cmp_lt_u32 s17, 64
  s_cbranch_scc1 reca_ptop264
  s_branch reca_exit1
reca_pw3_229:
  s_mov_b32 s17, 0
  s_mov_b32 s26, 0
  s_mul_i32 s20, s17, 40960
  s_add_u32 s20, s20, 153647104
  s_add_u32 m0, s26, 30720
  s_nop 0
  buffer_load_dwordx4 v1, s[4:7], s20 offen offset:0 lds
  buffer_load_dwordx4 v1, s[4:7], s20 offen offset:1024 lds
  buffer_load_dwordx4 v1, s[4:7], s20 offen offset:2048 lds
  buffer_load_dwordx4 v1, s[4:7], s20 offen offset:3072 lds
  s_add_u32 s20, s20, 4096
  s_add_u32 m0, s26, 34816
  s_nop 0
  buffer_load_dwordx4 v1, s[4:7], s20 offen offset:0 lds
  buffer_load_dwordx4 v1, s[4:7], s20 offen offset:1024 lds
  buffer_load_dwordx4 v1, s[4:7], s20 offen offset:2048 lds
  buffer_load_dwordx4 v1, s[4:7], s20 offen offset:3072 lds
  s_add_u32 s20, s20, 4096
  s_add_u32 m0, s26, 38912
  s_nop 0
  buffer_load_dwordx4 v1, s[4:7], s20 offen offset:0 lds
  buffer_load_dwordx4 v1, s[4:7], s20 offen offset:1024 lds
  s_lshl_b32 s34, s15, 6
  s_add_u32 s34, s34, s17
  s_mul_i32 s34, s34, 12288
  s_mul_i32 s35, s16, 3072
  s_add_u32 s35, s35, s34
  s_add_u32 s27, s35, 37748736
  s_mul_i32 s35, s16, 6144
  s_add_u32 s35, s35, s34
  s_add_u32 s28, s35, 62914560
  s_mul_i32 s34, s15, 12
  s_mul_i32 s35, s16, 6
  s_add_u32 s34, s34, s35
  s_add_u32 s34, s34, 2
  s_mul_i32 s34, s34, 20480
  s_add_u32 s34, s34, 6291456
  buffer_load_dwordx4 a[0:3], v1, s[4:7], s34 offen offset:0
  buffer_load_dwordx4 a[4:7], v1, s[4:7], s34 offen offset:1024
  buffer_load_dwordx4 a[8:11], v1, s[4:7], s34 offen offset:2048
  buffer_load_dwordx4 a[12:15], v1, s[4:7], s34 offen offset:3072
  s_add_u32 s34, s34, 4096
  buffer_load_dwordx4 a[16:19], v1, s[4:7], s34 offen offset:0
  buffer_load_dwordx4 a[20:23], v1, s[4:7], s34 offen offset:1024
  buffer_load_dwordx4 a[24:27], v1, s[4:7], s34 offen offset:2048
  buffer_load_dwordx4 a[28:31], v1, s[4:7], s34 offen offset:3072
  s_add_u32 s34, s34, 4096
  buffer_load_dwordx4 a[32:35], v1, s[4:7], s34 offen offset:0
  buffer_load_dwordx4 a[36:39], v1, s[4:7], s34 offen offset:1024
  buffer_load_dwordx4 a[40:43], v1, s[4:7], s34 offen offset:2048
  buffer_load_dwordx4 a[44:47], v1, s[4:7], s34 offen offset:3072
  s_add_u32 s34, s34, 4096
  buffer_load_dwordx4 a[48:51], v1, s[4:7], s34 offen offset:0
  buffer_load_dwordx4 a[52:55], v1, s[4:7], s34 offen offset:1024
  buffer_load_dwordx4 a[56:59], v1, s[4:7], s34 offen offset:2048
  buffer_load_dwordx4 a[60:63], v1, s[4:7], s34 offen offset:3072
  s_add_u32 s34, s34, 4096
  buffer_load_dwordx4 a[64:67], v1, s[4:7], s34 offen offset:0
  buffer_load_dwordx4 a[68:71], v1, s[4:7], s34 offen offset:1024
  buffer_load_dwordx4 a[72:75], v1, s[4:7], s34 offen offset:2048
  buffer_load_dwordx4 a[76:79], v1, s[4:7], s34 offen offset:3072
  s_mul_i32 s34, s15, 12
  s_mul_i32 s35, s16, 6
  s_add_u32 s34, s34, s35
  s_add_u32 s34, s34, 3
  s_mul_i32 s34, s34, 20480
  s_add_u32 s34, s34, 6291456
  buffer_load_dwordx4 a[80:83], v1, s[4:7], s34 offen offset:0
  buffer_load_dwordx4 a[84:87], v1, s[4:7], s34 offen offset:1024
  buffer_load_dwordx4 a[88:91], v1, s[4:7], s34 offen offset:2048
  buffer_load_dwordx4 a[92:95], v1, s[4:7], s34 offen offset:3072
  s_add_u32 s34, s34, 4096
  buffer_load_dwordx4 a[96:99], v1, s[4:7], s34 offen offset:0
  buffer_load_dwordx4 a[100:103], v1, s[4:7], s34 offen offset:1024
  buffer_load_dwordx4 a[104:107], v1, s[4:7], s34 offen offset:2048
  buffer_load_dwordx4 a[108:111], v1, s[4:7], s34 offen offset:3072
  s_add_u32 s34, s34, 4096
  buffer_load_dwordx4 a[112:115], v1, s[4:7], s34 offen offset:0
  buffer_load_dwordx4 a[116:119], v1, s[4:7], s34 offen offset:1024
  buffer_load_dwordx4 a[120:123], v1, s[4:7], s34 offen offset:2048
  buffer_load_dwordx4 a[124:127], v1, s[4:7], s34 offen offset:3072
  s_add_u32 s34, s34, 4096
  buffer_load_dwordx4 a[128:131], v1, s[4:7], s34 offen offset:0
  buffer_load_dwordx4 a[132:135], v1, s[4:7], s34 offen offset:1024
  buffer_load_dwordx4 a[136:139], v1, s[4:7], s34 offen offset:2048
  buffer_load_dwordx4 a[140:143], v1, s[4:7], s34 offen offset:3072
  s_add_u32 s34, s34, 4096
  buffer_load_dwordx4 a[144:147], v1, s[4:7], s34 offen offset:0
  buffer_load_dwordx4 a[148:151], v1, s[4:7], s34 offen offset:1024
  buffer_load_dwordx4 a[152:155], v1, s[4:7], s34 offen offset:2048
  buffer_load_dwordx4 a[156:159], v1, s[4:7], s34 offen offset:3072
  s_waitcnt vmcnt(20)
  s_mul_i32 s34, s15, 12
  s_mul_i32 s35, s16, 6
  s_add_u32 s34, s34, s35
  s_add_u32 s34, s34, 4
  s_mul_i32 s34, s34, 20480
  s_add_u32 s34, s34, 6291456
  buffer_load_dwordx4 a[160:163], v1, s[4:7], s34 offen offset:0
  buffer_load_dwordx4 a[164:167], v1, s[4:7], s34 offen offset:1024
  buffer_load_dwordx4 a[168:171], v1, s[4:7], s34 offen offset:2048
  buffer_load_dwordx4 a[172:175], v1, s[4:7], s34 offen offset:3072
  s_add_u32 s34, s34, 4096
  buffer_load_dwordx4 a[176:179], v1, s[4:7], s34 offen offset:0
  buffer_load_dwordx4 a[180:183], v1, s[4:7], s34 offen offset:1024
  buffer_load_dwordx4 a[184:187], v1, s[4:7], s34 offen offset:2048
  buffer_load_dwordx4 a[188:191], v1, s[4:7], s34 offen offset:3072
  s_add_u32 s34, s34, 4096
  buffer_load_dwordx4 a[192:195], v1, s[4:7], s34 offen offset:0
  buffer_load_dwordx4 a[196:199], v1, s[4:7], s34 offen offset:1024
  buffer_load_dwordx4 a[200:203], v1, s[4:7], s34 offen offset:2048
  buffer_load_dwordx4 a[204:207], v1, s[4:7], s34 offen offset:3072
  s_add_u32 s34, s34, 4096
  buffer_load_dwordx4 a[208:211], v1, s[4:7], s34 offen offset:0
  buffer_load_dwordx4 a[212:215], v1, s[4:7], s34 offen offset:1024
  buffer_load_dwordx4 a[216:219], v1, s[4:7], s34 offen offset:2048
  buffer_load_dwordx4 a[220:223], v1, s[4:7], s34 offen offset:3072
  s_add_u32 s34, s34, 4096
  buffer_load_dwordx4 a[224:227], v1, s[4:7], s34 offen offset:0
  buffer_load_dwordx4 a[228:231], v1, s[4:7], s34 offen offset:1024
  buffer_load_dwordx4 a[232:235], v1, s[4:7], s34 offen offset:2048
  buffer_load_dwordx4 a[236:239], v1, s[4:7], s34 offen offset:3072
  s_waitcnt vmcnt(20)
  s_mul_i32 s34, s15, 12
  s_mul_i32 s35, s16, 6
  s_add_u32 s34, s34, s35
  s_add_u32 s34, s34, 5
  s_mul_i32 s34, s34, 20480
  s_add_u32 s34, s34, 6291456
  buffer_load_dwordx4 v[96:99], v1, s[4:7], s34 offen offset:0
  buffer_load_dwordx4 v[100:103], v1, s[4:7], s34 offen offset:1024
  buffer_load_dwordx4 v[104:107], v1, s[4:7], s34 offen offset:2048
  buffer_load_dwordx4 v[108:111], v1, s[4:7], s34 offen offset:3072
  s_add_u32 s34, s34, 4096
  buffer_load_dwordx4 v[112:115], v1, s[4:7], s34 offen offset:0
  buffer_load_dwordx4 v[116:119], v1, s[4:7], s34 offen offset:1024
  buffer_load_dwordx4 v[120:123], v1, s[4:7], s34 offen offset:2048
  buffer_load_dwordx4 v[124:127], v1, s[4:7], s34 offen offset:3072
  s_add_u32 s34, s34, 4096
  buffer_load_dwordx4 v[128:131], v1, s[4:7], s34 offen offset:0
  buffer_load_dwordx4 v[132:135], v1, s[4:7], s34 offen offset:1024
  buffer_load_dwordx4 v[136:139], v1, s[4:7], s34 offen offset:2048
  buffer_load_dwordx4 v[140:143], v1, s[4:7], s34 offen offset:3072
  s_add_u32 s34, s34, 4096
  buffer_load_dwordx4 v[144:147], v1, s[4:7], s34 offen offset:0
  buffer_load_dwordx4 v[148:151], v1, s[4:7], s34 offen offset:1024
  buffer_load_dwordx4 v[152:155], v1, s[4:7], s34 offen offset:2048
  buffer_load_dwordx4 v[156:159], v1, s[4:7], s34 offen offset:3072
  s_add_u32 s34, s34, 4096
  buffer_load_dwordx4 v[160:163], v1, s[4:7], s34 offen offset:0
  buffer_load_dwordx4 v[164:167], v1, s[4:7], s34 offen offset:1024
  buffer_load_dwordx4 v[168:171], v1, s[4:7], s34 offen offset:2048
  buffer_load_dwordx4 v[172:175], v1, s[4:7], s34 offen offset:3072
  s_waitcnt vmcnt(20)
  v_and_b32 v30, 7, v0
  v_lshlrev_b32 v30, 3, v30
reca_cens269:
  buffer_load_dwordx2 v[28:29], v30, s[8:11], 0 offen sc1
  s_waitcnt vmcnt(0)
  v_sad_u8 v31, v28, 0, 0
  v_sad_u8 v31, v29, 0, v31
  v_cmp_gt_u32 vcc, 32, v31
  s_cbranch_vccz reca_censok270
  s_sleep 8
  s_sub_u32 s18, s18, 1
  s_cbranch_scc0 reca_cens269
  s_mov_b32 s18, 0
reca_censok270:
  v_and_b32 v28, 0x20202020, v28
  v_and_b32 v29, 0x20202020, v29
  v_cmp_ne_u32 s[34:35], 0, v28
  v_cmp_ne_u32 s[36:37], 0, v29
  s_nop 3
  s_and_b32 s34, s34, 0xff
  s_and_b32 s36, s36, 0xff
  s_or_b32 s35, s34, s36
  s_lshr_b32 s37, s35, s13
  s_and_b32 s37, s37, 1
  s_xor_b32 s43, s37, 1
  s_cmp_eq_u32 s57, 0
  s_cselect_b32 s58, s36, s34
  v_mov_b32 v31, 0x80000000
  s_cmp_lg_u32 s43, 0
  s_cbranch_scc1 reca_pslow271
reca_ptop272:
  s_cmp_lt_u32 s17, 6
  s_cbranch_scc1 reca_pgo273
  s_sub_u32 s36, s17, 6
reca_ppoll274:
  buffer_load_dword v28, v4, s[4:7], s25 offen sc1
  s_waitcnt vmcnt(0)
  v_readfirstlane_b32 s34, v28
  s_nop 3
  s_cmp_ge_i32 s34, s36
  s_cbranch_scc1 reca_pgo273
  s_sleep 8
  s_sub_u32 s18, s18, 1
  s_cbranch_scc0 reca_ppoll274
  s_mov_b32 s18, 0
reca_pgo273:
  s_waitcnt vmcnt(0)
  s_barrier
  v_add_u32 v7, s26, v1
  s_xor_b32 s26, s26, 40960
  s_add_u32 s37, s17, 1
  s_cmp_ge_u32 s37, 64
  s_cbranch_scc1 reca_pnodma275
  s_mul_i32 s20, s37, 40960
  s_add_u32 s20, s20, 153647104
  s_add_u32 m0, s26, 30720
  s_nop 0
  buffer_load_dwordx4 v1, s[4:7], s20 offen offset:0 lds
  buffer_load_dwordx4 v1, s[4:7], s20 offen offset:1024 lds
  buffer_load_dwordx4 v1, s[4:7], s20 offen offset:2048 lds
  buffer_load_dwordx4 v1, s[4:7], s20 offen offset:3072 lds
  s_add_u32 s20, s20, 4096
  s_add_u32 m0, s26, 34816
  s_nop 0
  buffer_load_dwordx4 v1, s[4:7], s20 offen offset:0 lds
  buffer_load_dwordx4 v1, s[4:7], s20 offen offset:1024 lds
  buffer_load_dwordx4 v1, s[4:7], s20 offen offset:2048 lds
  buffer_load_dwordx4 v1, s[4:7], s20 offen offset:3072 lds
  s_add_u32 s20, s20, 4096
  s_add_u32 m0, s26, 38912
  s_nop 0
  buffer_load_dwordx4 v1, s[4:7], s20 offen offset:0 lds
  buffer_load_dwordx4 v1, s[4:7], s20 offen offset:1024 lds
  s_lshl_b32 s34, s15, 6
  s_add_u32 s34, s34, s37
  s_mul_i32 s34, s34, 12288
  s_mul_i32 s35, s16, 3072
  s_add_u32 s35, s35, s34
  s_add_u32 s27, s35, 37748736
  s_mul_i32 s35, s16, 6144
  s_add_u32 s35, s35, s34
  s_add_u32 s28, s35, 62914560
reca_pnodma275:
  s_lshl_b32 s34, s15, 6
  s_add_u32 s34, s34, s17
  s_mul_i32 s34, s34, 12288
  s_mul_i32 s35, s16, 3072
  s_add_u32 s35, s35, s34
  s_add_u32 s21, s35, 37748736
  s_add_u32 s22, s35, 88080384
  s_mul_i32 s35, s16, 6144
  s_add_u32 s35, s35, s34
  s_add_u32 s23, s35, 62914560
  ds_read_b128 v[72:75], v7 offset:0
  ds_read_b128 v[76:79], v7 offset:20480
  ds_read_b128 v[80:83], v7 offset:1024
  ds_read_b128 v[84:87], v7 offset:21504
  ds_read_b128 v[88:91], v7 offset:2048
  ds_read_b128 v[92:95], v7 offset:22528
  s_waitcnt lgkmcnt(4)
  v_mfma_f32_16x16x32_bf16 v[32:35], a[0:3], v[72:75], 0
  v_mfma_f32_16x16x32_bf16 v[36:39], a[0:3], v[76:79], 0
  v_mfma_f32_16x16x32_bf16 v[40:43], a[80:83], v[72:75], 0
  v_mfma_f32_16x16x32_bf16 v[44:47], a[80:83], v[76:79], 0
  v_mfma_f32_16x16x32_bf16 v[48:51], a[160:163], v[72:75], 0
  v_mfma_f32_16x16x32_bf16 v[52:55], a[160:163], v[76:79], 0
  v_mfma_f32_16x16x32_bf16 v[56:59], v[96:99], v[72:75], 0
  v_mfma_f32_16x16x32_bf16 v[60:63], v[96:99], v[76:79], 0
  ds_read_b128 v[72:75], v7 offset:3072
  ds_read_b128 v[76:79], v7 offset:23552
  s_waitcnt lgkmcnt(4)
  v_mfma_f32_16x16x32_bf16 v[32:35], a[4:7], v[80:83], v[32:35]
  v_mfma_f32_16x16x32_bf16 v[36:39], a[4:7], v[84:87], v[36:39]
  v_mfma_f32_16x16x32_bf16 v[40:43], a[84:87], v[80:83], v[40:43]
  v_mfma_f32_16x16x32_bf16 v[44:47], a[84:87], v[84:87], v[44:47]
  v_mfma_f32_16x16x32_bf16 v[48:51], a[164:167], v[80:83], v[48:51]
  v_mfma_f32_16x16x32_bf16 v[52:55], a[164:167], v[84:87], v[52:55]
  v_mfma_f32_16x16x32_bf16 v[56:59], v[100:103], v[80:83], v[56:59]
  v_mfma_f32_16x16x32_bf16 v[60:63], v[100:103], v[84:87], v[60:63]
  ds_read_b128 v[80:83], v7 offset:4096
  ds_read_b128 v[84:87], v7 offset:24576
  s_waitcnt lgkmcnt(4)
  v_mfma_f32_16x16x32_bf16 v[32:35], a[8:11], v[88:91], v[32:35]
  v_mfma_f32_16x16x32_bf16 v[36:39], a[8:11], v[92:95], v[36:39]
  v_mfma_f32_16x16x32_bf16 v[40:43], a[88:91], v[88:91], v[40:43]
  v_mfma_f32_16x16x32_bf16 v[44:47], a[88:91], v[92:95], v[44:47]
  v_mfma_f32_16x16x32_bf16 v[48:51], a[168:171], v[88:91], v[48:51]
  v_mfma_f32_16x16x32_bf16 v[52:55], a[168:171], v[92:95], v[52:55]
  v_mfma_f32_16x16x32_bf16 v[56:59], v[104:107], v[88:91], v[56:59]
  v_mfma_f32_16x16x32_bf16 v[60:63], v[104:107], v[92:95], v[60:63]
  ds_read_b128 v[88:91], v7 offset:5120
  ds_read_b128 v[92:95], v7 offset:25600
  s_waitcnt lgkmcnt(4)
  v_mfma_f32_16x16x32_bf16 v[32:35], a[12:15], v[72:75], v[32:35]
  v_mfma_f32_16x16x32_bf16 v[36:39], a[12:15], v[76:79], v[36:39]
  v_mfma_f32_16x16x32_bf16 v[40:43], a[92:95], v[72:75], v[40:43]
  v_mfma_f32_16x16x32_bf16 v[44:47], a[92:95], v[76:79], v[44:47]
  v_mfma_f32_16x16x32_bf16 v[48:51], a[172:175], v[72:75], v[48:51]
  v_mfma_f32_16x16x32_bf16 v[52:55], a[172:175], v[76:79], v[52:55]
  v_mfma_f32_16x16x32_bf16 v[56:59], v[108:111], v[72:75], v[56:59]
  v_mfma_f32_16x16x32_bf16 v[60:63], v[108:111], v[76:79], v[60:63]
  ds_read_b128 v[72:75], v7 offset:6144
  ds_read_b128 v[76:79], v7 offset:26624
  s_waitcnt lgkmcnt(4)
  v_mfma_f32_16x16x32_bf16 v[32:35], a[16:19], v[80:83], v[32:35]
  v_mfma_f32_16x16x32_bf16 v[36:39], a[16:19], v[84:87], v[36:39]
  v_mfma_f32_16x16x32_bf16 v[40:43], a[96:99], v[80:83], v[40:43]
  v_mfma_f32_16x16x32_bf16 v[44:47], a[96:99], v[84:87], v[44:47]
  v_mfma_f32_16x16x32_bf16 v[48:51], a[176:179], v[80:83], v[48:51]
  v_mfma_f32_16x16x32_bf16 v[52:55], a[176:179], v[84:87], v[52:55]
  v_mfma_f32_16x16x32_bf16 v[56:59], v[112:115], v[80:83], v[56:59]
  v_mfma_f32_16x16x32_bf16 v[60:63], v[112:115], v[84:87], v[60:63]
  ds_read_b128 v[80:83], v7 offset:7168
  ds_read_b128 v[84:87], v7 offset:27648
  s_waitcnt lgkmcnt(4)
  v_mfma_f32_16x16x32_bf16 v[32:35], a[20:23], v[88:91], v[32:35]
  v_mfma_f32_16x16x32_bf16 v[36:39], a[20:23], v[92:95], v[36:39]
  v_mfma_f32_16x16x32_bf16 v[40:43], a[100:103], v[88:91], v[40:43]
  v_mfma_f32_16x16x32_bf16 v[44:47], a[100:103], v[92:95], v[44:47]
  v_mfma_f32_16x16x32_bf16 v[48:51], a[180:183], v[88:91], v[48:51]
  v_mfma_f32_16x16x32_bf16 v[52:55], a[180:183], v[92:95], v[52:55]
  v_mfma_f32_16x16x32_bf16 v[56:59], v[116:119], v[88:91], v[56:59]
  v_mfma_f32_16x16x32_bf16 v[60:63], v[116:119], v[92:95], v[60:63]
  ds_read_b128 v[88:91], v7 offset:8192
  ds_read_b128 v[92:95], v7 offset:28672
  s_waitcnt lgkmcnt(4)
  v_mfma_f32_16x16x32_bf16 v[32:35], a[24:27], v[72:75], v[32:35]
  v_mfma_f32_16x16x32_bf16 v[36:39], a[24:27], v[76:79], v[36:39]
  v_mfma_f32_16x16x32_bf16 v[40:43], a[104:107], v[72:75], v[40:43]
  v_mfma_f32_16x16x32_bf16 v[44:47], a[104:107], v[76:79], v[44:47]
  v_mfma_f32_16x16x32_bf16 v[48:51], a[184:187], v[72:75], v[48:51]
  v_mfma_f32_16x16x32_bf16 v[52:55], a[184:187], v[76:79], v[52:55]
  v_mfma_f32_16x16x32_bf16 v[56:59], v[120:123], v[72:75], v[56:59]
  v_mfma_f32_16x16x32_bf16 v[60:63], v[120:123], v[76:79], v[60:63]
  ds_read_b128 v[72:75], v7 offset:9216
  ds_read_b128 v[76:79], v7 offset:29696
  s_waitcnt lgkmcnt(4)
  v_mfma_f32_16x16x32_bf16 v[32:35], a[28:31], v[80:83], v[32:35]
  v_mfma_f32_16x16x32_bf16 v[36:39], a[28:31], v[84:87], v[36:39]
  v_mfma_f32_16x16x32_bf16 v[40:43], a[108:111], v[80:83], v[40:43]
  v_mfma_f32_16x16x32_bf16 v[44:47], a[108:111], v[84:87], v[44:47]
  v_mfma_f32_16x16x32_bf16 v[48:51], a[188:191], v[80:83], v[48:51]
  v_mfma_f32_16x16x32_bf16 v[52:55], a[188:191], v[84:87], v[52:55]
  v_mfma_f32_16x16x32_bf16 v[56:59], v[124:127], v[80:83], v[56:59]
  v_mfma_f32_16x16x32_bf16 v[60:63], v[124:127], v[84:87], v[60:63]
  ds_read_b128 v[80:83], v7 offset:10240
  ds_read_b128 v[84:87], v7 offset:30720
  s_waitcnt lgkmcnt(4)
  v_mfma_f32_16x16x32_bf16 v[32:35], a[32:35], v[88:91], v[32:35]
  v_mfma_f32_16x16x32_bf16 v[36:39], a[32:35], v[92:95], v[36:39]
  v_mfma_f32_16x16x32_bf16 v[40:43], a[112:115], v[88:91], v[40:43]
  v_mfma_f32_16x16x32_bf16 v[44:47], a[112:115], v[92:95], v[44:47]
  v_mfma_f32_16x16x32_bf16 v[48:51], a[192:195], v[88:91], v[48:51]
  v_mfma_f32_16x16x32_bf16 v[52:55], a[192:195], v[92:95], v[52:55]
  v_mfma_f32_16x16x32_bf16 v[56:59], v[128:131], v[88:91], v[56:59]
  v_mfma_f32_16x16x32_bf16 v[60:63], v[128:131], v[92:95], v[60:63]
  ds_read_b128 v[88:91], v7 offset:11264
  ds_read_b128 v[92:95], v7 offset:31744
  s_waitcnt lgkmcnt(4)
  v_mfma_f32_16x16x32_bf16 v[32:35], a[36:39], v[72:75], v[32:35]
  v_mfma_f32_16x16x32_bf16 v[36:39], a[36:39], v[76:79], v[36:39]
  v_mfma_f32_16x16x32_bf16 v[40:43], a[116:119], v[72:75], v[40:43]
  v_mfma_f32_16x16x32_bf16 v[44:47], a[116:119], v[76:79], v[44:47]
  v_mfma_f32_16x16x32_bf16 v[48:51], a[196:199], v[72:75], v[48:51]
  v_mfma_f32_16x16x32_bf16 v[52:55], a[196:199], v[76:79], v[52:55]
  v_mfma_f32_16x16x32_bf16 v[56:59], v[132:135], v[72:75], v[56:59]
  v_mfma_f32_16x16x32_bf16 v[60:63], v[132:135], v[76:79], v[60:63]
  ds_read_b128 v[72:75], v7 offset:12288
  ds_read_b128 v[76:79], v7 offset:32768
  s_waitcnt lgkmcnt(4)
  v_mfma_f32_16x16x32_bf16 v[32:35], a[40:43], v[80:83], v[32:35]
  v_mfma_f32_16x16x32_bf16 v[36:39], a[40:43], v[84:87], v[36:39]
  v_mfma_f32_16x16x32_bf16 v[40:43], a[120:123], v[80:83], v[40:43]
  v_mfma_f32_16x16x32_bf16 v[44:47], a[120:123], v[84:87], v[44:47]
  v_mfma_f32_16x16x32_bf16 v[48:51], a[200:203], v[80:83], v[48:51]
  v_mfma_f32_16x16x32_bf16 v[52:55], a[200:203], v[84:87], v[52:55]
  v_mfma_f32_16x16x32_bf16 v[56:59], v[136:139], v[80:83], v[56:59]
  v_mfma_f32_16x16x32_bf16 v[60:63], v[136:139], v[84:87], v[60:63]
  ds_read_b128 v[80:83], v7 offset:13312
  ds_read_b128 v[84:87], v7 offset:33792
  s_waitcnt lgkmcnt(4)
  v_mfma_f32_16x16x32_bf16 v[32:35], a[44:47], v[88:91], v[32:35]
  v_mfma_f32_16x16x32_bf16 v[36:39], a[44:47], v[92:95], v[36:39]
  v_mfma_f32_16x16x32_bf16 v[40:43], a[124:127], v[88:91], v[40:43]
  v_mfma_f32_16x16x32_bf16 v[44:47], a[124:127], v[92:95], v[44:47]
  v_mfma_f32_16x16x32_bf16 v[48:51], a[204:207], v[88:91], v[48:51]
  v_mfma_f32_16x16x32_bf16 v[52:55], a[204:207], v[92:95], v[52:55]
  v_mfma_f32_16x16x32_bf16 v[56:59], v[140:143], v[88:91], v[56:59]
  v_mfma_f32_16x16x32_bf16 v[60:63], v[140:143], v[92:95], v[60:63]
  ds_read_b128 v[88:91], v7 offset:14336
  ds_read_b128 v[92:95], v7 offset:34816
  s_waitcnt lgkmcnt(4)
  v_mfma_f32_16x16x32_bf16 v[32:35], a[48:51], v[72:75], v[32:35]
  v_mfma_f32_16x16x32_bf16 v[36:39], a[48:51], v[76:79], v[36:39]
  v_mfma_f32_16x16x32_bf16 v[40:43], a[128:131], v[72:75], v[40:43]
  v_mfma_f32_16x16x32_bf16 v[44:47], a[128:131], v[76:79], v[44:47]
  v_mfma_f32_16x16x32_bf16 v[48:51], a[208:211], v[72:75], v[48:51]
  v_mfma_f32_16x16x32_bf16 v[52:55], a[208:211], v[76:79], v[52:55]
  v_mfma_f32_16x16x32_bf16 v[56:59], v[144:147], v[72:75], v[56:59]
  v_mfma_f32_16x16x32_bf16 v[60:63], v[144:147], v[76:79], v[60:63]
  ds_read_b128 v[72:75], v7 offset:15360
  ds_read_b128 v[76:79], v7 offset:35840
  s_waitcnt lgkmcnt(4)
  v_mfma_f32_16x16x32_bf16 v[32:35], a[52:55], v[80:83], v[32:35]
  v_mfma_f32_16x16x32_bf16 v[36:39], a[52:55], v[84:87], v[36:39]
  v_mfma_f32_16x16x32_bf16 v[40:43], a[132:135], v[80:83], v[40:43]
  v_mfma_f32_16x16x32_bf16 v[44:47], a[132:135], v[84:87], v[44:47]
  v_mfma_f32_16x16x32_bf16 v[48:51], a[212:215], v[80:83], v[48:51]
  v_mfma_f32_16x16x32_bf16 v[52:55], a[212:215], v[84:87], v[52:55]
  v_mfma_f32_16x16x32_bf16 v[56:59], v[148:151], v[80:83], v[56:59]
  v_mfma_f32_16x16x32_bf16 v[60:63], v[148:151], v[84:87], v[60:63]
  ds_read_b128 v[80:83], v7 offset:16384
  ds_read_b128 v[84:87], v7 offset:36864
  s_waitcnt lgkmcnt(4)
  v_mfma_f32_16x16x32_bf16 v[32:35], a[56:59], v[88:91], v[32:35]
  v_mfma_f32_16x16x32_bf16 v[36:39], a[56:59], v[92:95], v[36:39]
  v_mfma_f32_16x16x32_bf16 v[40:43], a[136:139], v[88:91], v[40:43]
  v_mfma_f32_16x16x32_bf16 v[44:47], a[136:139], v[92:95], v[44:47]
  v_mfma_f32_16x16x32_bf16 v[48:51], a[216:219], v[88:91], v[48:51]
  v_mfma_f32_16x16x32_bf16 v[52:55], a[216:219], v[92:95], v[52:55]
  v_mfma_f32_16x16x32_bf16 v[56:59], v[152:155], v[88:91], v[56:59]
  v_mfma_f32_16x16x32_bf16 v[60:63], v[152:155], v[92:95], v[60:63]
  ds_read_b128 v[88:91], v7 offset:17408
  ds_read_b128 v[92:95], v7 offset:37888
  s_waitcnt lgkmcnt(4)
  v_mfma_f32_16x16x32_bf16 v[32:35], a[60:63], v[72:75], v[32:35]
  v_mfma_f32_16x16x32_bf16 v[36:39], a[60:63], v[76:79], v[36:39]
  v_mfma_f32_16x16x32_bf16 v[40:43], a[140:143], v[72:75], v[40:43]
  v_mfma_f32_16x16x32_bf16 v[44:47], a[140:143], v[76:79], v[44:47]
  v_mfma_f32_16x16x32_bf16 v[48:51], a[220:223], v[72:75], v[48:51]
  v_mfma_f32_16x16x32_bf16 v[52:55], a[220:223], v[76:79], v[52:55]
  v_mfma_f32_16x16x32_bf16 v[56:59], v[156:159], v[72:75], v[56:59]
  v_mfma_f32_16x16x32_bf16 v[60:63], v[156:159], v[76:79], v[60:63]
  ds_read_b128 v[72:75], v7 offset:18432
  ds_read_b128 v[76:79], v7 offset:38912
  s_waitcnt lgkmcnt(4)
  v_mfma_f32_16x16x32_bf16 v[32:35], a[64:67], v[80:83], v[32:35]
  v_mfma_f32_16x16x32_bf16 v[36:39], a[64:67], v[84:87], v[36:39]
  v_mfma_f32_16x16x32_bf16 v[40:43], a[144:147], v[80:83], v[40:43]
  v_mfma_f32_16x16x32_bf16 v[44:47], a[144:147], v[84:87], v[44:47]
  v_mfma_f32_16x16x32_bf16 v[48:51], a[224:227], v[80:83], v[48:51]
  v_mfma_f32_16x16x32_bf16 v[52:55], a[224:227], v[84:87], v[52:55]
  v_mfma_f32_16x16x32_bf16 v[56:59], v[160:163], v[80:83], v[56:59]
  v_mfma_f32_16x16x32_bf16 v[60:63], v[160:163], v[84:87], v[60:63]
  ds_read_b128 v[80:83], v7 offset:19456
  ds_read_b128 v[84:87], v7 offset:39936
  s_waitcnt lgkmcnt(4)
  v_mfma_f32_16x16x32_bf16 v[32:35], a[68:71], v[88:91], v[32:35]
  v_mfma_f32_16x16x32_bf16 v[36:39], a[68:71], v[92:95], v[36:39]
  v_mfma_f32_16x16x32_bf16 v[40:43], a[148:151], v[88:91], v[40:43]
  v_mfma_f32_16x16x32_bf16 v[44:47], a[148:151], v[92:95], v[44:47]
  v_mfma_f32_16x16x32_bf16 v[48:51], a[228:231], v[88:91], v[48:51]
  v_mfma_f32_16x16x32_bf16 v[52:55], a[228:231], v[92:95], v[52:55]
  v_mfma_f32_16x16x32_bf16 v[56:59], v[164:167], v[88:91], v[56:59]
  v_mfma_f32_16x16x32_bf16 v[60:63], v[164:167], v[92:95], v[60:63]
  s_waitcnt lgkmcnt(2)
  v_mfma_f32_16x16x32_bf16 v[32:35], a[72:75], v[72:75], v[32:35]
  v_mfma_f32_16x16x32_bf16 v[36:39], a[72:75], v[76:79], v[36:39]
  v_mfma_f32_16x16x32_bf16 v[40:43], a[152:155], v[72:75], v[40:43]
  v_mfma_f32_16x16x32_bf16 v[44:47], a[152:155], v[76:79], v[44:47]
  v_mfma_f32_16x16x32_bf16 v[48:51], a[232:235], v[72:75], v[48:51]
  v_mfma_f32_16x16x32_bf16 v[52:55], a[232:235], v[76:79], v[52:55]
  v_mfma_f32_16x16x32_bf16 v[56:59], v[168:171], v[72:75], v[56:59]
  v_mfma_f32_16x16x32_bf16 v[60:63], v[168:171], v[76:79], v[60:63]
  s_waitcnt lgkmcnt(0)
  v_mfma_f32_16x16x32_bf16 v[32:35], a[76:79], v[80:83], v[32:35]
  v_mfma_f32_16x16x32_bf16 v[36:39], a[76:79], v[84:87], v[36:39]
  v_mfma_f32_16x16x32_bf16 v[40:43], a[156:159], v[80:83], v[40:43]
  v_mfma_f32_16x16x32_bf16 v[44:47], a[156:159], v[84:87], v[44:47]
  v_mfma_f32_16x16x32_bf16 v[48:51], a[236:239], v[80:83], v[48:51]
  v_mfma_f32_16x16x32_bf16 v[52:55], a[236:239], v[84:87], v[52:55]
  v_mfma_f32_16x16x32_bf16 v[56:59], v[172:175], v[80:83], v[56:59]
  v_mfma_f32_16x16x32_bf16 v[60:63], v[172:175], v[84:87], v[60:63]
  s_nop 0
  v_cvt_pk_bf16_f32 v8, v32, v33
  v_cvt_pk_bf16_f32 v9, v34, v35
  v_cvt_pk_bf16_f32 v10, v40, v41
  v_cvt_pk_bf16_f32 v11, v42, v43
  s_add_u32 s34, s22, 1024
  buffer_store_dwordx4 v[8:11], v1, s[4:7], s34 offen
  v_cvt_pk_bf16_f32 v12, v36, v37
  v_cvt_pk_bf16_f32 v13, v38, v39
  v_cvt_pk_bf16_f32 v14, v44, v45
  v_cvt_pk_bf16_f32 v15, v46, v47
  s_add_u32 s34, s22, 7168
  buffer_store_dwordx4 v[12:15], v1, s[4:7], s34 offen
  v_cvt_pk_bf16_f32 v8, v48, v49
  v_cvt_pk_bf16_f32 v9, v50, v51
  v_cvt_pk_bf16_f32 v10, v56, v57
  v_cvt_pk_bf16_f32 v11, v58, v59
  s_add_u32 s34, s22, 2048
  buffer_store_dwordx4 v[8:11], v1, s[4:7], s34 offen
  v_cvt_pk_bf16_f32 v12, v52, v53
  v_cvt_pk_bf16_f32 v13, v54, v55
  v_cvt_pk_bf16_f32 v14, v60, v61
  v_cvt_pk_bf16_f32 v15, v62, v63
  s_add_u32 s34, s22, 8192
  buffer_store_dwordx4 v[12:15], v1, s[4:7], s34 offen
  s_waitcnt vmcnt(0)
  s_barrier
  s_add_u32 s17, s17, 1
  s_cmp_lt_u32 s17, 64
  s_cbranch_scc1 reca_ptop272
  s_branch reca_exit1
reca_pslow271:
reca_ptop277:
  s_cmp_lt_u32 s17, 6
  s_cbranch_scc1 reca_pgo278
  s_sub_u32 s36, s17, 6
reca_ppoll279:
  buffer_load_dword v28, v4, s[4:7], s25 offen sc1
  s_waitcnt vmcnt(0)
  v_readfirstlane_b32 s34, v28
  s_nop 3
  s_cmp_ge_i32 s34, s36
  s_cbranch_scc1 reca_pgo278
  s_sleep 8
  s_sub_u32 s18, s18, 1
  s_cbranch_scc0 reca_ppoll279
  s_mov_b32 s18, 0
reca_pgo278:
  s_waitcnt vmcnt(0)
  s_barrier
  v_add_u32 v7, s26, v1
  s_xor_b32 s26, s26, 40960
  s_add_u32 s37, s17, 1
  s_cmp_ge_u32 s37, 64
  s_cbranch_scc1 reca_pnodma280
  s_mul_i32 s20, s37, 40960
  s_add_u32 s20, s20, 153647104
  s_add_u32 m0, s26, 30720
  s_nop 0
  buffer_load_dwordx4 v1, s[4:7], s20 offen offset:0 lds
  buffer_load_dwordx4 v1, s[4:7], s20 offen offset:1024 lds
  buffer_load_dwordx4 v1, s[4:7], s20 offen offset:2048 lds
  buffer_load_dwordx4 v1, s[4:7], s20 offen offset:3072 lds
  s_add_u32 s20, s20, 4096
  s_add_u32 m0, s26, 34816
  s_nop 0
  buffer_load_dwordx4 v1, s[4:7], s20 offen offset:0 lds
  buffer_load_dwordx4 v1, s[4:7], s20 offen offset:1024 lds
  buffer_load_dwordx4 v1, s[4:7], s20 offen offset:2048 lds
  buffer_load_dwordx4 v1, s[4:7], s20 offen offset:3072 lds
  s_add_u32 s20, s20, 4096
  s_add_u32 m0, s26, 38912
  s_nop 0
  buffer_load_dwordx4 v1, s[4:7], s20 offen offset:0 lds
  buffer_load_dwordx4 v1, s[4:7], s20 offen offset:1024 lds
  s_lshl_b32 s34, s15, 6
  s_add_u32 s34, s34, s37
  s_mul_i32 s34, s34, 12288
  s_mul_i32 s35, s16, 3072
  s_add_u32 s35, s35, s34
  s_add_u32 s27, s35, 37748736
  s_mul_i32 s35, s16, 6144
  s_add_u32 s35, s35, s34
  s_add_u32 s28, s35, 62914560
reca_pnodma280:
  s_lshl_b32 s34, s15, 6
  s_add_u32 s34, s34, s17
  s_mul_i32 s34, s34, 12288
  s_mul_i32 s35, s16, 3072
  s_add_u32 s35, s35, s34
  s_add_u32 s21, s35, 37748736
  s_add_u32 s22, s35, 88080384
  s_mul_i32 s35, s16, 6144
  s_add_u32 s35, s35, s34
  s_add_u32 s23, s35, 62914560
  ds_read_b128 v[72:75], v7 offset:0
  ds_read_b128 v[76:79], v7 offset:20480
  ds_read_b128 v[80:83], v7 offset:1024
  ds_read_b128 v[84:87], v7 offset:21504
  ds_read_b128 v[88:91], v7 offset:2048
  ds_read_b128 v[92:95], v7 offset:22528
  s_waitcnt lgkmcnt(4)
  v_mfma_f32_16x16x32_bf16 v[32:35], a[0:3], v[72:75], 0
  v_mfma_f32_16x16x32_bf16 v[36:39], a[0:3], v[76:79], 0
  v_mfma_f32_16x16x32_bf16 v[40:43], a[80:83], v[72:75], 0
  v_mfma_f32_16x16x32_bf16 v[44:47], a[80:83], v[76:79], 0
  v_mfma_f32_16x16x32_bf16 v[48:51], a[160:163], v[72:75], 0
  v_mfma_f32_16x16x32_bf16 v[52:55], a[160:163], v[76:79], 0
  v_mfma_f32_16x16x32_bf16 v[56:59], v[96:99], v[72:75], 0
  v_mfma_f32_16x16x32_bf16 v[60:63], v[96:99], v[76:79], 0
  ds_read_b128 v[72:75], v7 offset:3072
  ds_read_b128 v[76:79], v7 offset:23552
  s_waitcnt lgkmcnt(4)
  v_mfma_f32_16x16x32_bf16 v[32:35], a[4:7], v[80:83], v[32:35]
  v_mfma_f32_16x16x32_bf16 v[36:39], a[4:7], v[84:87], v[36:39]
  v_mfma_f32_16x16x32_bf16 v[40:43], a[84:87], v[80:83], v[40:43]
  v_mfma_f32_16x16x32_bf16 v[44:47], a[84:87], v[84:87], v[44:47]
  v_mfma_f32_16x16x32_bf16 v[48:51], a[164:167], v[80:83], v[48:51]
  v_mfma_f32_16x16x32_bf16 v[52:55], a[164:167], v[84:87], v[52:55]
  v_mfma_f32_16x16x32_bf16 v[56:59], v[100:103], v[80:83], v[56:59]
  v_mfma_f32_16x16x32_bf16 v[60:63], v[100:103], v[84:87], v[60:63]
  ds_read_b128 v[80:83], v7 offset:4096
  ds_read_b128 v[84:87], v7 offset:24576
  s_waitcnt lgkmcnt(4)
  v_mfma_f32_16x16x32_bf16 v[32:35], a[8:11], v[88:91], v[32:35]
  v_mfma_f32_16x16x32_bf16 v[36:39], a[8:11], v[92:95], v[36:39]
  v_mfma_f32_16x16x32_bf16 v[40:43], a[88:91], v[88:91], v[40:43]
  v_mfma_f32_16x16x32_bf16 v[44:47], a[88:91], v[92:95], v[44:47]
  v_mfma_f32_16x16x32_bf16 v[48:51], a[168:171], v[88:91], v[48:51]
  v_mfma_f32_16x16x32_bf16 v[52:55], a[168:171], v[92:95], v[52:55]
  v_mfma_f32_16x16x32_bf16 v[56:59], v[104:107], v[88:91], v[56:59]
  v_mfma_f32_16x16x32_bf16 v[60:63], v[104:107], v[92:95], v[60:63]
  ds_read_b128 v[88:91], v7 offset:5120
  ds_read_b128 v[92:95], v7 offset:25600
  s_waitcnt lgkmcnt(4)
  v_mfma_f32_16x16x32_bf16 v[32:35], a[12:15], v[72:75], v[32:35]
  v_mfma_f32_16x16x32_bf16 v[36:39], a[12:15], v[76:79], v[36:39]
  v_mfma_f32_16x16x32_bf16 v[40:43], a[92:95], v[72:75], v[40:43]
  v_mfma_f32_16x16x32_bf16 v[44:47], a[92:95], v[76:79], v[44:47]
  v_mfma_f32_16x16x32_bf16 v[48:51], a[172:175], v[72:75], v[48:51]
  v_mfma_f32_16x16x32_bf16 v[52:55], a[172:175], v[76:79], v[52:55]
  v_mfma_f32_16x16x32_bf16 v[56:59], v[108:111], v[72:75], v[56:59]
  v_mfma_f32_16x16x32_bf16 v[60:63], v[108:111], v[76:79], v[60:63]
  ds_read_b128 v[72:75], v7 offset:6144
  ds_read_b128 v[76:79], v7 offset:26624
  s_waitcnt lgkmcnt(4)
  v_mfma_f32_16x16x32_bf16 v[32:35], a[16:19], v[80:83], v[32:35]
  v_mfma_f32_16x16x32_bf16 v[36:39], a[16:19], v[84:87], v[36:39]
  v_mfma_f32_16x16x32_bf16 v[40:43], a[96:99], v[80:83], v[40:43]
  v_mfma_f32_16x16x32_bf16 v[44:47], a[96:99], v[84:87], v[44:47]
  v_mfma_f32_16x16x32_bf16 v[48:51], a[176:179], v[80:83], v[48:51]
  v_mfma_f32_16x16x32_bf16 v[52:55], a[176:179], v[84:87], v[52:55]
  v_mfma_f32_16x16x32_bf16 v[56:59], v[112:115], v[80:83], v[56:59]
  v_mfma_f32_16x16x32_bf16 v[60:63], v[112:115], v[84:87], v[60:63]
  ds_read_b128 v[80:83], v7 offset:7168
  ds_read_b128 v[84:87], v7 offset:27648
  s_waitcnt lgkmcnt(4)
  v_mfma_f32_16x16x32_bf16 v[32:35], a[20:23], v[88:91], v[32:35]
  v_mfma_f32_16x16x32_bf16 v[36:39], a[20:23], v[92:95], v[36:39]
  v_mfma_f32_16x16x32_bf16 v[40:43], a[100:103], v[88:91], v[40:43]
  v_mfma_f32_16x16x32_bf16 v[44:47], a[100:103], v[92:95], v[44:47]
  v_mfma_f32_16x16x32_bf16 v[48:51], a[180:183], v[88:91], v[48:51]
  v_mfma_f32_16x16x32_bf16 v[52:55], a[180:183], v[92:95], v[52:55]
  v_mfma_f32_16x16x32_bf16 v[56:59], v[116:119], v[88:91], v[56:59]
  v_mfma_f32_16x16x32_bf16 v[60:63], v[116:119], v[92:95], v[60:63]
  ds_read_b128 v[88:91], v7 offset:8192
  ds_read_b128 v[92:95], v7 offset:28672
  s_waitcnt lgkmcnt(4)
  v_mfma_f32_16x16x32_bf16 v[32:35], a[24:27], v[72:75], v[32:35]
  v_mfma_f32_16x16x32_bf16 v[36:39], a[24:27], v[76:79], v[36:39]
  v_mfma_f32_16x16x32_bf16 v[40:43], a[104:107], v[72:75], v[40:43]
  v_mfma_f32_16x16x32_bf16 v[44:47], a[104:107], v[76:79], v[44:47]
  v_mfma_f32_16x16x32_bf16 v[48:51], a[184:187], v[72:75], v[48:51]
  v_mfma_f32_16x16x32_bf16 v[52:55], a[184:187], v[76:79], v[52:55]
  v_mfma_f32_16x16x32_bf16 v[56:59], v[120:123], v[72:75], v[56:59]
  v_mfma_f32_16x16x32_bf16 v[60:63], v[120:123], v[76:79], v[60:63]
  ds_read_b128 v[72:75], v7 offset:9216
  ds_read_b128 v[76:79], v7 offset:29696
  s_waitcnt lgkmcnt(4)
  v_mfma_f32_16x16x32_bf16 v[32:35], a[28:31], v[80:83], v[32:35]
  v_mfma_f32_16x16x32_bf16 v[36:39], a[28:31], v[84:87], v[36:39]
  v_mfma_f32_16x16x32_bf16 v[40:43], a[108:111], v[80:83], v[40:43]
  v_mfma_f32_16x16x32_bf16 v[44:47], a[108:111], v[84:87], v[44:47]
  v_mfma_f32_16x16x32_bf16 v[48:51], a[188:191], v[80:83], v[48:51]
  v_mfma_f32_16x16x32_bf16 v[52:55], a[188:191], v[84:87], v[52:55]
  v_mfma_f32_16x16x32_bf16 v[56:59], v[124:127], v[80:83], v[56:59]
  v_mfma_f32_16x16x32_bf16 v[60:63], v[124:127], v[84:87], v[60:63]
  ds_read_b128 v[80:83], v7 offset:10240
  ds_read_b128 v[84:87], v7 offset:30720
  s_waitcnt lgkmcnt(4)
  v_mfma_f32_16x16x32_bf16 v[32:35], a[32:35], v[88:91], v[32:35]
  v_mfma_f32_16x16x32_bf16 v[36:39], a[32:35], v[92:95], v[36:39]
  v_mfma_f32_16x16x32_bf16 v[40:43], a[112:115], v[88:91], v[40:43]
  v_mfma_f32_16x16x32_bf16 v[44:47], a[112:115], v[92:95], v[44:47]
  v_mfma_f32_16x16x32_bf16 v[48:51], a[192:195], v[88:91], v[48:51]
  v_mfma_f32_16x16x32_bf16 v[52:55], a[192:195], v[92:95], v[52:55]
  v_mfma_f32_16x16x32_bf16 v[56:59], v[128:131], v[88:91], v[56:59]
  v_mfma_f32_16x16x32_bf16 v[60:63], v[128:131], v[92:95], v[60:63]
  ds_read_b128 v[88:91], v7 offset:11264
  ds_read_b128 v[92:95], v7 offset:31744
  s_waitcnt lgkmcnt(4)
  v_mfma_f32_16x16x32_bf16 v[32:35], a[36:39], v[72:75], v[32:35]
  v_mfma_f32_16x16x32_bf16 v[36:39], a[36:39], v[76:79], v[36:39]
  v_mfma_f32_16x16x32_bf16 v[40:43], a[116:119], v[72:75], v[40:43]
  v_mfma_f32_16x16x32_bf16 v[44:47], a[116:119], v[76:79], v[44:47]
  v_mfma_f32_16x16x32_bf16 v[48:51], a[196:199], v[72:75], v[48:51]
  v_mfma_f32_16x16x32_bf16 v[52:55], a[196:199], v[76:79], v[52:55]
  v_mfma_f32_16x16x32_bf16 v[56:59], v[132:135], v[72:75], v[56:59]
  v_mfma_f32_16x16x32_bf16 v[60:63], v[132:135], v[76:79], v[60:63]
  ds_read_b128 v[72:75], v7 offset:12288
  ds_read_b128 v[76:79], v7 offset:32768
  s_waitcnt lgkmcnt(4)
  v_mfma_f32_16x16x32_bf16 v[32:35], a[40:43], v[80:83], v[32:35]
  v_mfma_f32_16x16x32_bf16 v[36:39], a[40:43], v[84:87], v[36:39]
  v_mfma_f32_16x16x32_bf16 v[40:43], a[120:123], v[80:83], v[40:43]
  v_mfma_f32_16x16x32_bf16 v[44:47], a[120:123], v[84:87], v[44:47]
  v_mfma_f32_16x16x32_bf16 v[48:51], a[200:203], v[80:83], v[48:51]
  v_mfma_f32_16x16x32_bf16 v[52:55], a[200:203], v[84:87], v[52:55]
  v_mfma_f32_16x16x32_bf16 v[56:59], v[136:139], v[80:83], v[56:59]
  v_mfma_f32_16x16x32_bf16 v[60:63], v[136:139], v[84:87], v[60:63]
  ds_read_b128 v[80:83], v7 offset:13312
  ds_read_b128 v[84:87], v7 offset:33792
  s_waitcnt lgkmcnt(4)
  v_mfma_f32_16x16x32_bf16 v[32:35], a[44:47], v[88:91], v[32:35]
  v_mfma_f32_16x16x32_bf16 v[36:39], a[44:47], v[92:95], v[36:39]
  v_mfma_f32_16x16x32_bf16 v[40:43], a[124:127], v[88:91], v[40:43]
  v_mfma_f32_16x16x32_bf16 v[44:47], a[124:127], v[92:95], v[44:47]
  v_mfma_f32_16x16x32_bf16 v[48:51], a[204:207], v[88:91], v[48:51]
  v_mfma_f32_16x16x32_bf16 v[52:55], a[204:207], v[92:95], v[52:55]
  v_mfma_f32_16x16x32_bf16 v[56:59], v[140:143], v[88:91], v[56:59]
  v_mfma_f32_16x16x32_bf16 v[60:63], v[140:143], v[92:95], v[60:63]
  ds_read_b128 v[88:91], v7 offset:14336
  ds_read_b128 v[92:95], v7 offset:34816
  s_waitcnt lgkmcnt(4)
  v_mfma_f32_16x16x32_bf16 v[32:35], a[48:51], v[72:75], v[32:35]
  v_mfma_f32_16x16x32_bf16 v[36:39], a[48:51], v[76:79], v[36:39]
  v_mfma_f32_16x16x32_bf16 v[40:43], a[128:131], v[72:75], v[40:43]
  v_mfma_f32_16x16x32_bf16 v[44:47], a[128:131], v[76:79], v[44:47]
  v_mfma_f32_16x16x32_bf16 v[48:51], a[208:211], v[72:75], v[48:51]
  v_mfma_f32_16x16x32_bf16 v[52:55], a[208:211], v[76:79], v[52:55]
  v_mfma_f32_16x16x32_bf16 v[56:59], v[144:147], v[72:75], v[56:59]
  v_mfma_f32_16x16x32_bf16 v[60:63], v[144:147], v[76:79], v[60:63]
  ds_read_b128 v[72:75], v7 offset:15360
  ds_read_b128 v[76:79], v7 offset:35840
  s_waitcnt lgkmcnt(4)
  v_mfma_f32_16x16x32_bf16 v[32:35], a[52:55], v[80:83], v[32:35]
  v_mfma_f32_16x16x32_bf16 v[36:39], a[52:55], v[84:87], v[36:39]
  v_mfma_f32_16x16x32_bf16 v[40:43], a[132:135], v[80:83], v[40:43]
  v_mfma_f32_16x16x32_bf16 v[44:47], a[132:135], v[84:87], v[44:47]
  v_mfma_f32_16x16x32_bf16 v[48:51], a[212:215], v[80:83], v[48:51]
  v_mfma_f32_16x16x32_bf16 v[52:55], a[212:215], v[84:87], v[52:55]
  v_mfma_f32_16x16x32_bf16 v[56:59], v[148:151], v[80:83], v[56:59]
  v_mfma_f32_16x16x32_bf16 v[60:63], v[148:151], v[84:87], v[60:63]
  ds_read_b128 v[80:83], v7 offset:16384
  ds_read_b128 v[84:87], v7 offset:36864
  s_waitcnt lgkmcnt(4)
  v_mfma_f32_16x16x32_bf16 v[32:35], a[56:59], v[88:91], v[32:35]
  v_mfma_f32_16x16x32_bf16 v[36:39], a[56:59], v[92:95], v[36:39]
  v_mfma_f32_16x16x32_bf16 v[40:43], a[136:139], v[88:91], v[40:43]
  v_mfma_f32_16x16x32_bf16 v[44:47], a[136:139], v[92:95], v[44:47]
  v_mfma_f32_16x16x32_bf16 v[48:51], a[216:219], v[88:91], v[48:51]
  v_mfma_f32_16x16x32_bf16 v[52:55], a[216:219], v[92:95], v[52:55]
  v_mfma_f32_16x16x32_bf16 v[56:59], v[152:155], v[88:91], v[56:59]
  v_mfma_f32_16x16x32_bf16 v[60:63], v[152:155], v[92:95], v[60:63]
  ds_read_b128 v[88:91], v7 offset:17408
  ds_read_b128 v[92:95], v7 offset:37888
  s_waitcnt lgkmcnt(4)
  v_mfma_f32_16x16x32_bf16 v[32:35], a[60:63], v[72:75], v[32:35]
  v_mfma_f32_16x16x32_bf16 v[36:39], a[60:63], v[76:79], v[36:39]
  v_mfma_f32_16x16x32_bf16 v[40:43], a[140:143], v[72:75], v[40:43]
  v_mfma_f32_16x16x32_bf16 v[44:47], a[140:143], v[76:79], v[44:47]
  v_mfma_f32_16x16x32_bf16 v[48:51], a[220:223], v[72:75], v[48:51]
  v_mfma_f32_16x16x32_bf16 v[52:55], a[220:223], v[76:79], v[52:55]
  v_mfma_f32_16x16x32_bf16 v[56:59], v[156:159], v[72:75], v[56:59]
  v_mfma_f32_16x16x32_bf16 v[60:63], v[156:159], v[76:79], v[60:63]
  ds_read_b128 v[72:75], v7 offset:18432
  ds_read_b128 v[76:79], v7 offset:38912
  s_waitcnt lgkmcnt(4)
  v_mfma_f32_16x16x32_bf16 v[32:35], a[64:67], v[80:83], v[32:35]
  v_mfma_f32_16x16x32_bf16 v[36:39], a[64:67], v[84:87], v[36:39]
  v_mfma_f32_16x16x32_bf16 v[40:43], a[144:147], v[80:83], v[40:43]
  v_mfma_f32_16x16x32_bf16 v[44:47], a[144:147], v[84:87], v[44:47]
  v_mfma_f32_16x16x32_bf16 v[48:51], a[224:227], v[80:83], v[48:51]
  v_mfma_f32_16x16x32_bf16 v[52:55], a[224:227], v[84:87], v[52:55]
  v_mfma_f32_16x16x32_bf16 v[56:59], v[160:163], v[80:83], v[56:59]
  v_mfma_f32_16x16x32_bf16 v[60:63], v[160:163], v[84:87], v[60:63]
  ds_read_b128 v[80:83], v7 offset:19456
  ds_read_b128 v[84:87], v7 offset:39936
  s_waitcnt lgkmcnt(4)
  v_mfma_f32_16x16x32_bf16 v[32:35], a[68:71], v[88:91], v[32:35]
  v_mfma_f32_16x16x32_bf16 v[36:39], a[68:71], v[92:95], v[36:39]
  v_mfma_f32_16x16x32_bf16 v[40:43], a[148:151], v[88:91], v[40:43]
  v_mfma_f32_16x16x32_bf16 v[44:47], a[148:151], v[92:95], v[44:47]
  v_mfma_f32_16x16x32_bf16 v[48:51], a[228:231], v[88:91], v[48:51]
  v_mfma_f32_16x16x32_bf16 v[52:55], a[228:231], v[92:95], v[52:55]
  v_mfma_f32_16x16x32_bf16 v[56:59], v[164:167], v[88:91], v[56:59]
  v_mfma_f32_16x16x32_bf16 v[60:63], v[164:167], v[92:95], v[60:63]
  s_waitcnt lgkmcnt(2)
  v_mfma_f32_16x16x32_bf16 v[32:35], a[72:75], v[72:75], v[32:35]
  v_mfma_f32_16x16x32_bf16 v[36:39], a[72:75], v[76:79], v[36:39]
  v_mfma_f32_16x16x32_bf16 v[40:43], a[152:155], v[72:75], v[40:43]
  v_mfma_f32_16x16x32_bf16 v[44:47], a[152:155], v[76:79], v[44:47]
  v_mfma_f32_16x16x32_bf16 v[48:51], a[232:235], v[72:75], v[48:51]
  v_mfma_f32_16x16x32_bf16 v[52:55], a[232:235], v[76:79], v[52:55]
  v_mfma_f32_16x16x32_bf16 v[56:59], v[168:171], v[72:75], v[56:59]
  v_mfma_f32_16x16x32_bf16 v[60:63], v[168:171], v[76:79], v[60:63]
  s_waitcnt lgkmcnt(0)
  v_mfma_f32_16x16x32_bf16 v[32:35], a[76:79], v[80:83], v[32:35]
  v_mfma_f32_16x16x32_bf16 v[36:39], a[76:79], v[84:87], v[36:39]
  v_mfma_f32_16x16x32_bf16 v[40:43], a[156:159], v[80:83], v[40:43]
  v_mfma_f32_16x16x32_bf16 v[44:47], a[156:159], v[84:87], v[44:47]
  v_mfma_f32_16x16x32_bf16 v[48:51], a[236:239], v[80:83], v[48:51]
  v_mfma_f32_16x16x32_bf16 v[52:55], a[236:239], v[84:87], v[52:55]
  v_mfma_f32_16x16x32_bf16 v[56:59], v[172:175], v[80:83], v[56:59]
  v_mfma_f32_16x16x32_bf16 v[60:63], v[172:175], v[84:87], v[60:63]
  s_nop 0
  v_cvt_pk_bf16_f32 v8, v32, v33
  v_cvt_pk_bf16_f32 v9, v34, v35
  v_cvt_pk_bf16_f32 v10, v40, v41
  v_cvt_pk_bf16_f32 v11, v42, v43
  s_add_u32 s34, s22, 1024
  buffer_store_dwordx4 v[8:11], v1, s[4:7], s34 offen sc1
  v_cvt_pk_bf16_f32 v12, v36, v37
  v_cvt_pk_bf16_f32 v13, v38, v39
  v_cvt_pk_bf16_f32 v14, v44, v45
  v_cvt_pk_bf16_f32 v15, v46, v47
  s_add_u32 s34, s22, 7168
  buffer_store_dwordx4 v[12:15], v1, s[4:7], s34 offen sc1
  v_cvt_pk_bf16_f32 v8, v48, v49
  v_cvt_pk_bf16_f32 v9, v50, v51
  v_cvt_pk_bf16_f32 v10, v56, v57
  v_cvt_pk_bf16_f32 v11, v58, v59
  s_add_u32 s34, s22, 2048
  buffer_store_dwordx4 v[8:11], v1, s[4:7], s34 offen sc1
  v_cvt_pk_bf16_f32 v12, v52, v53
  v_cvt_pk_bf16_f32 v13, v54, v55
  v_cvt_pk_bf16_f32 v14, v60, v61
  v_cvt_pk_bf16_f32 v15, v62, v63
  s_add_u32 s34, s22, 8192
  buffer_store_dwordx4 v[12:15], v1, s[4:7], s34 offen sc1
  s_waitcnt vmcnt(0)
  s_barrier
  s_add_u32 s17, s17, 1
  s_cmp_lt_u32 s17, 64
  s_cbranch_scc1 reca_ptop277
  s_branch reca_exit1
reca_exit1:
reca_exitb3:
  s_endpgm
.globl fin_kernel
.p2align 8
.type fin_kernel,@function
fin_kernel:
  s_cmp_ge_u32 s2, 256
  s_cbranch_scc1 fin_exit1
  s_load_dwordx2 s[8:9], s[0:1], 96
  v_lshrrev_b32 v6, 6, v0
  v_and_b32 v7, 63, v0
  s_and_b32 s13, s2, 7
  v_readfirstlane_b32 s12, v6
  v_lshlrev_b32 v1, 4, v7
  v_add_u32 v2, 0x1000, v1
  v_add_u32 v3, 0x2000, v1
  s_lshr_b32 s14, s2, 3
  s_lshl_b32 s15, s13, 2
  s_add_u32 s15, s15, s12
  s_waitcnt lgkmcnt(0)
  s_mov_b32 s4, s8
  s_mov_b32 s5, s9
  s_mov_b32 s6, 0x10000000
  s_mov_b32 s7, 0x20000
  s_mov_b32 s27, 0x3dd53b95
  v_and_b32 v6, 15, v7
  v_lshrrev_b32 v8, 4, v7
  v_mov_b32 v9, 0x80000000
  v_lshlrev_b32 v10, 4, v6
  v_lshl_add_u32 v10, v8, 7, v10
  v_cmp_gt_u32 vcc, 8, v6
  s_nop 1
  v_cndmask_b32 v4, v9, v10, vcc
  v_lshlrev_b32 v10, 3, v7
  v_cmp_gt_u32 vcc, 32, v7
  s_nop 1
  v_cndmask_b32 v5, v9, v10, vcc
  v_mov_b32 v10, 0xf149f2ca
  v_cmp_le_u32 vcc, 2, v8
  s_nop 1
  v_cndmask_b32 v12, 0, v10, vcc
  v_mov_b32 v13, v12
  v_mov_b32 v14, v12
  v_mov_b32 v15, v12
  v_lshlrev_b32 v11, 2, v8
  v_add_u32 v7, 0, v11
  v_cmp_gt_u32 vcc, v7, v6
  s_nop 1
  v_cndmask_b32 v16, 0, v10, vcc
  v_add_u32 v7, 1, v11
  v_cmp_gt_u32 vcc, v7, v6
  s_nop 1
  v_cndmask_b32 v17, 0, v10, vcc
  v_add_u32 v7, 2, v11
  v_cmp_gt_u32 vcc, v7, v6
  s_nop 1
  v_cndmask_b32 v18, 0, v10, vcc
  v_add_u32 v7, 3, v11
  v_cmp_gt_u32 vcc, v7, v6
  s_nop 1
  v_cndmask_b32 v19, 0, v10, vcc
  v_mov_b32 v20, 0x3f803f80
  v_mov_b32 v21, 0x3f803f80
  v_mov_b32 v22, 0x3f803f80
  v_mov_b32 v23, 0x3f803f80
  s_mul_i32 s16, s12, 6144
  v_add_u32 v240, s16, v1
  v_add_u32 v241, 49152, v240
  s_mul_i32 s16, s12, 10
  s_mul_i32 s16, s16, 192
  s_mul_i32 s17, s13, 24
  s_add_u32 s16, s16, s17
  s_lshl_b32 s16, s16, 10
  s_add_u32 s16, s16, 29884416
  s_add_u32 s30, s16, 0
  s_add_u32 s31, s16, 196608
  s_add_u32 s32, s16, 393216
  s_add_u32 s33, s16, 589824
  s_add_u32 s34, s16, 786432
  s_add_u32 s35, s16, 983040
  s_add_u32 s36, s16, 1179648
  s_add_u32 s37, s16, 1376256
  s_add_u32 s38, s16, 1572864
  s_add_u32 s39, s16, 1769472
  s_cmp_lt_u32 s14, 30
  s_cbranch_scc1 fin_odma3
  s_lshl_b32 s17, s14, 1
  s_add_u32 s17, s17, 0
  s_lshl_b32 s16, s15, 6
  s_add_u32 s16, s16, s17
  s_mul_i32 s16, s16, 12288
  s_add_u32 s20, s16, 88080384
  s_add_u32 s21, s16, 37748736
  s_add_u32 s22, s16, 62914560
  s_lshl_b32 s17, s17, 5
  s_add_u32 s17, s17, s15
  s_mul_i32 s17, s17, 3072
  s_add_u32 s23, s17, 113246208
  s_add_u32 s24, s17, 119537664
  buffer_load_dwordx4 v[136:139], v1, s[4:7], s21 offen offset:0
  buffer_load_dwordx4 v[140:143], v1, s[4:7], s21 offen offset:1024
  buffer_load_dwordx4 v[144:147], v1, s[4:7], s21 offen offset:2048
  buffer_load_dwordx4 v[148:151], v1, s[4:7], s21 offen offset:3072
  buffer_load_dwordx4 v[152:155], v2, s[4:7], s21 offen offset:0
  buffer_load_dwordx4 v[156:159], v2, s[4:7], s21 offen offset:1024
  buffer_load_dwordx4 v[160:163], v2, s[4:7], s21 offen offset:2048
  buffer_load_dwordx4 v[164:167], v2, s[4:7], s21 offen offset:3072
  buffer_load_dwordx4 v[168:171], v3, s[4:7], s21 offen offset:0
  buffer_load_dwordx4 v[172:175], v3, s[4:7], s21 offen offset:1024
  buffer_load_dwordx4 v[176:179], v3, s[4:7], s21 offen offset:2048
  buffer_load_dwordx4 v[180:183], v3, s[4:7], s21 offen offset:3072
  buffer_load_dwordx4 v[184:187], v4, s[4:7], s23 offen offset:0
  buffer_load_dwordx4 v[188:191], v4, s[4:7], s23 offen offset:512
  buffer_load_dwordx4 v[192:195], v4, s[4:7], s23 offen offset:1024
  buffer_load_dwordx4 v[196:199], v4, s[4:7], s23 offen offset:1536
  buffer_load_dwordx4 v[200:203], v4, s[4:7], s23 offen offset:2048
  buffer_load_dwordx4 v[204:207], v4, s[4:7], s23 offen offset:2560
  buffer_load_dwordx4 v[88:91], v1, s[4:7], s20 offen offset:0
  buffer_load_dwordx4 v[92:95], v1, s[4:7], s20 offen offset:1024
  buffer_load_dwordx4 v[96:99], v1, s[4:7], s20 offen offset:2048
  buffer_load_dwordx4 v[100:103], v1, s[4:7], s20 offen offset:3072
  buffer_load_dwordx4 v[104:107], v2, s[4:7], s20 offen offset:0
  buffer_load_dwordx4 v[108:111], v2, s[4:7], s20 offen offset:1024
  buffer_load_dwordx4 v[112:115], v2, s[4:7], s20 offen offset:2048
  buffer_load_dwordx4 v[116:119], v2, s[4:7], s20 offen offset:3072
  buffer_load_dwordx4 v[120:123], v3, s[4:7], s20 offen offset:0
  buffer_load_dwordx4 v[124:127], v3, s[4:7], s20 offen offset:1024
  buffer_load_dwordx4 v[128:131], v3, s[4:7], s20 offen offset:2048
  buffer_load_dwordx4 v[132:135], v3, s[4:7], s20 offen offset:3072
  s_waitcnt vmcnt(5)
  v_mfma_f32_16x16x32_bf16 v[24:27], v[184:187], v[88:91], v[12:15]
  v_mfma_f32_16x16x32_bf16 v[28:31], v[136:139], v[88:91], v[16:19]
  v_mfma_f32_16x16x32_bf16 v[32:35], v[184:187], v[112:115], v[12:15]
  v_mfma_f32_16x16x32_bf16 v[36:39], v[136:139], v[112:115], 0
  v_mfma_f32_16x16x32_bf16 v[40:43], v[160:163], v[112:115], v[16:19]
  s_waitcnt vmcnt(4)
  v_mfma_f32_16x16x32_bf16 v[24:27], v[188:191], v[92:95], v[24:27]
  v_mfma_f32_16x16x32_bf16 v[28:31], v[140:143], v[92:95], v[28:31]
  v_mfma_f32_16x16x32_bf16 v[32:35], v[188:191], v[116:119], v[32:35]
  v_mfma_f32_16x16x32_bf16 v[36:39], v[140:143], v[116:119], v[36:39]
  v_mfma_f32_16x16x32_bf16 v[40:43], v[164:167], v[116:119], v[40:43]
  s_waitcnt vmcnt(3)
  v_mfma_f32_16x16x32_bf16 v[24:27], v[192:195], v[96:99], v[24:27]
  v_mfma_f32_16x16x32_bf16 v[28:31], v[144:147], v[96:99], v[28:31]
  v_mfma_f32_16x16x32_bf16 v[32:35], v[192:195], v[120:123], v[32:35]
  v_mfma_f32_16x16x32_bf16 v[36:39], v[144:147], v[120:123], v[36:39]
  v_mfma_f32_16x16x32_bf16 v[40:43], v[168:171], v[120:123], v[40:43]
  s_waitcnt vmcnt(2)
  v_mfma_f32_16x16x32_bf16 v[24:27], v[196:199], v[100:103], v[24:27]
  v_mfma_f32_16x16x32_bf16 v[28:31], v[148:151], v[100:103], v[28:31]
  v_mfma_f32_16x16x32_bf16 v[32:35], v[196:199], v[124:127], v[32:35]
  v_mfma_f32_16x16x32_bf16 v[36:39], v[148:151], v[124:127], v[36:39]
  v_mfma_f32_16x16x32_bf16 v[40:43], v[172:175], v[124:127], v[40:43]
  s_waitcnt vmcnt(1)
  v_mfma_f32_16x16x32_bf16 v[24:27], v[200:203], v[104:107], v[24:27]
  v_mfma_f32_16x16x32_bf16 v[28:31], v[152:155], v[104:107], v[28:31]
  v_mfma_f32_16x16x32_bf16 v[32:35], v[200:203], v[128:131], v[32:35]
  v_mfma_f32_16x16x32_bf16 v[36:39], v[152:155], v[128:131], v[36:39]
  v_mfma_f32_16x16x32_bf16 v[40:43], v[176:179], v[128:131], v[40:43]
  s_waitcnt vmcnt(0)
  v_mfma_f32_16x16x32_bf16 v[24:27], v[204:207], v[108:111], v[24:27]
  v_mfma_f32_16x16x32_bf16 v[28:31], v[156:159], v[108:111], v[28:31]
  v_mfma_f32_16x16x32_bf16 v[32:35], v[204:207], v[132:135], v[32:35]
  v_mfma_f32_16x16x32_bf16 v[36:39], v[156:159], v[132:135], v[36:39]
  v_mfma_f32_16x16x32_bf16 v[40:43], v[180:183], v[132:135], v[40:43]
  buffer_load_dwordx4 v[88:91], v1, s[4:7], s22 offen offset:0
  buffer_load_dwordx4 v[92:95], v1, s[4:7], s22 offen offset:1024
  buffer_load_dwordx4 v[96:99], v1, s[4:7], s22 offen offset:2048
  buffer_load_dwordx4 v[100:103], v1, s[4:7], s22 offen offset:3072
  buffer_load_dwordx4 v[104:107], v2, s[4:7], s22 offen offset:0
  buffer_load_dwordx4 v[108:111], v2, s[4:7], s22 offen offset:1024
  buffer_load_dwordx4 v[112:115], v2, s[4:7], s22 offen offset:2048
  buffer_load_dwordx4 v[116:119], v2, s[4:7], s22 offen offset:3072
  buffer_load_dwordx4 v[120:123], v3, s[4:7], s22 offen offset:0
  buffer_load_dwordx4 v[124:127], v3, s[4:7], s22 offen offset:1024
  buffer_load_dwordx4 v[128:131], v3, s[4:7], s22 offen offset:2048
  buffer_load_dwordx4 v[132:135], v3, s[4:7], s22 offen offset:3072
  buffer_load_dwordx2 v[136:137], v5, s[4:7], s24 offen offset:0
  buffer_load_dwordx2 v[138:139], v5, s[4:7], s24 offen offset:256
  buffer_load_dwordx2 v[140:141], v5, s[4:7], s24 offen offset:512
  buffer_load_dwordx2 v[142:143], v5, s[4:7], s24 offen offset:768
  buffer_load_dwordx2 v[144:145], v5, s[4:7], s24 offen offset:1024
  buffer_load_dwordx2 v[146:147], v5, s[4:7], s24 offen offset:1280
  buffer_load_dwordx2 v[148:149], v5, s[4:7], s24 offen offset:1536
  buffer_load_dwordx2 v[150:151], v5, s[4:7], s24 offen offset:1792
  buffer_load_dwordx2 v[152:153], v5, s[4:7], s24 offen offset:2048
  buffer_load_dwordx2 v[154:155], v5, s[4:7], s24 offen offset:2304
  buffer_load_dwordx2 v[156:157], v5, s[4:7], s24 offen offset:2560
  buffer_load_dwordx2 v[158:159], v5, s[4:7], s24 offen offset:2816
  v_max3_f32 v6, v24, v25, v26
  v_max3_f32 v6, v6, v27, v28
  v_max3_f32 v6, v6, v29, v30
  v_max_f32 v6, v6, v31
  v_mov_b32 v7, v6
  s_nop 1
  v_permlane32_swap_b32 v6, v7
  v_max_f32 v6, v6, v7
  v_mov_b32 v7, v6
  s_nop 1
  v_permlane16_swap_b32 v6, v7
  v_max_f32 v6, v6, v7
  v_mul_f32 v6, s27, v6
  v_fma_f32 v24, v24, s27, -v6
  v_fma_f32 v25, v25, s27, -v6
  v_fma_f32 v26, v26, s27, -v6
  v_fma_f32 v27, v27, s27, -v6
  v_fma_f32 v28, v28, s27, -v6
  v_fma_f32 v29, v29, s27, -v6
  v_fma_f32 v30, v30, s27, -v6
  v_fma_f32 v31, v31, s27, -v6
  v_exp_f32 v24, v24
  v_exp_f32 v25, v25
  v_exp_f32 v26, v26
  v_exp_f32 v27, v27
  v_exp_f32 v28, v28
  v_exp_f32 v29, v29
  v_exp_f32 v30, v30
  v_exp_f32 v31, v31
  v_max3_f32 v8, v32, v33, v34
  v_max3_f32 v8, v8, v35, v36
  v_max3_f32 v8, v8, v37, v38
  v_max3_f32 v8, v8, v39, v40
  v_max3_f32 v8, v8, v41, v42
  v_max_f32 v8, v8, v43
  v_mov_b32 v10, v8
  s_nop 1
  v_permlane32_swap_b32 v8, v10
  v_max_f32 v8, v8, v10
  v_mov_b32 v10, v8
  s_nop 1
  v_permlane16_swap_b32 v8, v10
  v_max_f32 v8, v8, v10
  v_mul_f32 v8, s27, v8
  v_fma_f32 v32, v32, s27, -v8
  v_fma_f32 v33, v33, s27, -v8
  v_fma_f32 v34, v34, s27, -v8
  v_fma_f32 v35, v35, s27, -v8
  v_fma_f32 v36, v36, s27, -v8
  v_fma_f32 v37, v37, s27, -v8
  v_fma_f32 v38, v38, s27, -v8
  v_fma_f32 v39, v39, s27, -v8
  v_fma_f32 v40, v40, s27, -v8
  v_fma_f32 v41, v41, s27, -v8
  v_fma_f32 v42, v42, s27, -v8
  v_fma_f32 v43, v43, s27, -v8
  v_exp_f32 v32, v32
  v_exp_f32 v33, v33
  v_exp_f32 v34, v34
  v_exp_f32 v35, v35
  v_exp_f32 v36, v36
  v_exp_f32 v37, v37
  v_exp_f32 v38, v38
  v_exp_f32 v39, v39
  v_exp_f32 v40, v40
  v_exp_f32 v41, v41
  v_exp_f32 v42, v42
  v_exp_f32 v43, v43
  v_cvt_pk_bf16_f32 v44, v24, v25
  v_cvt_pk_bf16_f32 v45, v26, v27
  v_cvt_pk_bf16_f32 v46, v28, v29
  v_cvt_pk_bf16_f32 v47, v30, v31
  v_cvt_pk_bf16_f32 v48, v32, v33
  v_cvt_pk_bf16_f32 v49, v34, v35
  v_cvt_pk_bf16_f32 v50, v36, v37
  v_cvt_pk_bf16_f32 v51, v38, v39
  v_cvt_pk_bf16_f32 v52, v40, v41
  v_cvt_pk_bf16_f32 v53, v42, v43
  v_mfma_f32_16x16x16_bf16 v[56:59], v[20:21], v[44:45], 0
  v_mfma_f32_16x16x16_bf16 v[60:63], v[20:21], v[48:49], 0
  v_mfma_f32_16x16x16_bf16 v[56:59], v[20:21], v[46:47], v[56:59]
  v_mfma_f32_16x16x32_bf16 v[60:63], v[20:23], v[50:53], v[60:63]
  s_nop 6
  v_rcp_f32 v10, v56
  v_rcp_f32 v11, v60
  s_waitcnt vmcnt(0)
  v_mfma_f32_16x16x16_bf16 v[64:67], v[136:137], v[44:45], 0
  v_mfma_f32_16x16x16_bf16 v[68:71], v[136:137], v[48:49], 0
  v_mfma_f32_16x16x16_bf16 v[64:67], v[88:89], v[46:47], v[64:67]
  v_mfma_f32_16x16x32_bf16 v[68:71], v[88:91], v[50:53], v[68:71]
  v_mfma_f32_16x16x16_bf16 v[72:75], v[138:139], v[44:45], 0
  v_mfma_f32_16x16x16_bf16 v[76:79], v[138:139], v[48:49], 0
  v_mfma_f32_16x16x16_bf16 v[72:75], v[92:93], v[46:47], v[72:75]
  v_mfma_f32_16x16x32_bf16 v[76:79], v[92:95], v[50:53], v[76:79]
  s_nop 2
  v_mul_f32 v64, v64, v10
  v_mul_f32 v65, v65, v10
  v_mul_f32 v66, v66, v10
  v_mul_f32 v67, v67, v10
  v_cvt_pk_bf16_f32 v80, v64, v65
  v_cvt_pk_bf16_f32 v81, v66, v67
  v_mul_f32 v72, v72, v10
  v_mul_f32 v73, v73, v10
  v_mul_f32 v74, v74, v10
  v_mul_f32 v75, v75, v10
  v_cvt_pk_bf16_f32 v82, v72, v73
  v_cvt_pk_bf16_f32 v83, v74, v75
  ds_write_b128 v240, v[80:83] offset:0
  v_mul_f32 v68, v68, v11
  v_mul_f32 v69, v69, v11
  v_mul_f32 v70, v70, v11
  v_mul_f32 v71, v71, v11
  v_cvt_pk_bf16_f32 v84, v68, v69
  v_cvt_pk_bf16_f32 v85, v70, v71
  v_mul_f32 v76, v76, v11
  v_mul_f32 v77, v77, v11
  v_mul_f32 v78, v78, v11
  v_mul_f32 v79, v79, v11
  v_cvt_pk_bf16_f32 v86, v76, v77
  v_cvt_pk_bf16_f32 v87, v78, v79
  ds_write_b128 v240, v[84:87] offset:24576
  v_mfma_f32_16x16x16_bf16 v[64:67], v[140:141], v[44:45], 0
  v_mfma_f32_16x16x16_bf16 v[68:71], v[140:141], v[48:49], 0
  v_mfma_f32_16x16x16_bf16 v[64:67], v[96:97], v[46:47], v[64:67]
  v_mfma_f32_16x16x32_bf16 v[68:71], v[96:99], v[50:53], v[68:71]
  v_mfma_f32_16x16x16_bf16 v[72:75], v[142:143], v[44:45], 0
  v_mfma_f32_16x16x16_bf16 v[76:79], v[142:143], v[48:49], 0
  v_mfma_f32_16x16x16_bf16 v[72:75], v[100:101], v[46:47], v[72:75]
  v_mfma_f32_16x16x32_bf16 v[76:79], v[100:103], v[50:53], v[76:79]
  s_nop 2
  v_mul_f32 v64, v64, v10
  v_mul_f32 v65, v65, v10
  v_mul_f32 v66, v66, v10
  v_mul_f32 v67, v67, v10
  v_cvt_pk_bf16_f32 v80, v64, v65
  v_cvt_pk_bf16_f32 v81, v66, v67
  v_mul_f32 v72, v72, v10
  v_mul_f32 v73, v73, v10
  v_mul_f32 v74, v74, v10
  v_mul_f32 v75, v75, v10
  v_cvt_pk_bf16_f32 v82, v72, v73
  v_cvt_pk_bf16_f32 v83, v74, v75
  ds_write_b128 v240, v[80:83] offset:1024
  v_mul_f32 v68, v68, v11
  v_mul_f32 v69, v69, v11
  v_mul_f32 v70, v70, v11
  v_mul_f32 v71, v71, v11
  v_cvt_pk_bf16_f32 v84, v68, v69
  v_cvt_pk_bf16_f32 v85, v70, v71
  v_mul_f32 v76, v76, v11
  v_mul_f32 v77, v77, v11
  v_mul_f32 v78, v78, v11
  v_mul_f32 v79, v79, v11
  v_cvt_pk_bf16_f32 v86, v76, v77
  v_cvt_pk_bf16_f32 v87, v78, v79
  ds_write_b128 v240, v[84:87] offset:25600
  v_mfma_f32_16x16x16_bf16 v[64:67], v[144:145], v[44:45], 0
  v_mfma_f32_16x16x16_bf16 v[68:71], v[144:145], v[48:49], 0
  v_mfma_f32_16x16x16_bf16 v[64:67], v[104:105], v[46:47], v[64:67]
  v_mfma_f32_16x16x32_bf16 v[68:71], v[104:107], v[50:53], v[68:71]
  v_mfma_f32_16x16x16_bf16 v[72:75], v[146:147], v[44:45], 0
  v_mfma_f32_16x16x16_bf16 v[76:79], v[146:147], v[48:49], 0
  v_mfma_f32_16x16x16_bf16 v[72:75], v[108:109], v[46:47], v[72:75]
  v_mfma_f32_16x16x32_bf16 v[76:79], v[108:111], v[50:53], v[76:79]
  s_nop 2
  v_mul_f32 v64, v64, v10
  v_mul_f32 v65, v65, v10
  v_mul_f32 v66, v66, v10
  v_mul_f32 v67, v67, v10
  v_cvt_pk_bf16_f32 v80, v64, v65
  v_cvt_pk_bf16_f32 v81, v66, v67
  v_mul_f32 v72, v72, v10
  v_mul_f32 v73, v73, v10
  v_mul_f32 v74, v74, v10
  v_mul_f32 v75, v75, v10
  v_cvt_pk_bf16_f32 v82, v72, v73
  v_cvt_pk_bf16_f32 v83, v74, v75
  ds_write_b128 v240, v[80:83] offset:2048
  v_mul_f32 v68, v68, v11
  v_mul_f32 v69, v69, v11
  v_mul_f32 v70, v70, v11
  v_mul_f32 v71, v71, v11
  v_cvt_pk_bf16_f32 v84, v68, v69
  v_cvt_pk_bf16_f32 v85, v70, v71
  v_mul_f32 v76, v76, v11
  v_mul_f32 v77, v77, v11
  v_mul_f32 v78, v78, v11
  v_mul_f32 v79, v79, v11
  v_cvt_pk_bf16_f32 v86, v76, v77
  v_cvt_pk_bf16_f32 v87, v78, v79
  ds_write_b128 v240, v[84:87] offset:26624
  v_mfma_f32_16x16x16_bf16 v[64:67], v[148:149], v[44:45], 0
  v_mfma_f32_16x16x16_bf16 v[68:71], v[148:149], v[48:49], 0
  v_mfma_f32_16x16x16_bf16 v[64:67], v[112:113], v[46:47], v[64:67]
  v_mfma_f32_16x16x32_bf16 v[68:71], v[112:115], v[50:53], v[68:71]
  v_mfma_f32_16x16x16_bf16 v[72:75], v[150:151], v[44:45], 0
  v_mfma_f32_16x16x16_bf16 v[76:79], v[150:151], v[48:49], 0
  v_mfma_f32_16x16x16_bf16 v[72:75], v[116:117], v[46:47], v[72:75]
  v_mfma_f32_16x16x32_bf16 v[76:79], v[116:119], v[50:53], v[76:79]
  s_nop 2
  v_mul_f32 v64, v64, v10
  v_mul_f32 v65, v65, v10
  v_mul_f32 v66, v66, v10
  v_mul_f32 v67, v67, v10
  v_cvt_pk_bf16_f32 v80, v64, v65
  v_cvt_pk_bf16_f32 v81, v66, v67
  v_mul_f32 v72, v72, v10
  v_mul_f32 v73, v73, v10
  v_mul_f32 v74, v74, v10
  v_mul_f32 v75, v75, v10
  v_cvt_pk_bf16_f32 v82, v72, v73
  v_cvt_pk_bf16_f32 v83, v74, v75
  ds_write_b128 v240, v[80:83] offset:3072
  v_mul_f32 v68, v68, v11
  v_mul_f32 v69, v69, v11
  v_mul_f32 v70, v70, v11
  v_mul_f32 v71, v71, v11
  v_cvt_pk_bf16_f32 v84, v68, v69
  v_cvt_pk_bf16_f32 v85, v70, v71
  v_mul_f32 v76, v76, v11
  v_mul_f32 v77, v77, v11
  v_mul_f32 v78, v78, v11
  v_mul_f32 v79, v79, v11
  v_cvt_pk_bf16_f32 v86, v76, v77
  v_cvt_pk_bf16_f32 v87, v78, v79
  ds_write_b128 v240, v[84:87] offset:27648
  v_mfma_f32_16x16x16_bf16 v[64:67], v[152:153], v[44:45], 0
  v_mfma_f32_16x16x16_bf16 v[68:71], v[152:153], v[48:49], 0
  v_mfma_f32_16x16x16_bf16 v[64:67], v[120:121], v[46:47], v[64:67]
  v_mfma_f32_16x16x32_bf16 v[68:71], v[120:123], v[50:53], v[68:71]
  v_mfma_f32_16x16x16_bf16 v[72:75], v[154:155], v[44:45], 0
  v_mfma_f32_16x16x16_bf16 v[76:79], v[154:155], v[48:49], 0
  v_mfma_f32_16x16x16_bf16 v[72:75], v[124:125], v[46:47], v[72:75]
  v_mfma_f32_16x16x32_bf16 v[76:79], v[124:127], v[50:53], v[76:79]
  s_nop 2
  v_mul_f32 v64, v64, v10
  v_mul_f32 v65, v65, v10
  v_mul_f32 v66, v66, v10
  v_mul_f32 v67, v67, v10
  v_cvt_pk_bf16_f32 v80, v64, v65
  v_cvt_pk_bf16_f32 v81, v66, v67
  v_mul_f32 v72, v72, v10
  v_mul_f32 v73, v73, v10
  v_mul_f32 v74, v74, v10
  v_mul_f32 v75, v75, v10
  v_cvt_pk_bf16_f32 v82, v72, v73
  v_cvt_pk_bf16_f32 v83, v74, v75
  ds_write_b128 v240, v[80:83] offset:4096
  v_mul_f32 v68, v68, v11
  v_mul_f32 v69, v69, v11
  v_mul_f32 v70, v70, v11
  v_mul_f32 v71, v71, v11
  v_cvt_pk_bf16_f32 v84, v68, v69
  v_cvt_pk_bf16_f32 v85, v70, v71
  v_mul_f32 v76, v76, v11
  v_mul_f32 v77, v77, v11
  v_mul_f32 v78, v78, v11
  v_mul_f32 v79, v79, v11
  v_cvt_pk_bf16_f32 v86, v76, v77
  v_cvt_pk_bf16_f32 v87, v78, v79
  ds_write_b128 v240, v[84:87] offset:28672
  v_mfma_f32_16x16x16_bf16 v[64:67], v[156:157], v[44:45], 0
  v_mfma_f32_16x16x16_bf16 v[68:71], v[156:157], v[48:49], 0
  v_mfma_f32_16x16x16_bf16 v[64:67], v[128:129], v[46:47], v[64:67]
  v_mfma_f32_16x16x32_bf16 v[68:71], v[128:131], v[50:53], v[68:71]
  v_mfma_f32_16x16x16_bf16 v[72:75], v[158:159], v[44:45], 0
  v_mfma_f32_16x16x16_bf16 v[76:79], v[158:159], v[48:49], 0
  v_mfma_f32_16x16x16_bf16 v[72:75], v[132:133], v[46:47], v[72:75]
  v_mfma_f32_16x16x32_bf16 v[76:79], v[132:135], v[50:53], v[76:79]
  s_nop 2
  v_mul_f32 v64, v64, v10
  v_mul_f32 v65, v65, v10
  v_mul_f32 v66, v66, v10
  v_mul_f32 v67, v67, v10
  v_cvt_pk_bf16_f32 v80, v64, v65
  v_cvt_pk_bf16_f32 v81, v66, v67
  v_mul_f32 v72, v72, v10
  v_mul_f32 v73, v73, v10
  v_mul_f32 v74, v74, v10
  v_mul_f32 v75, v75, v10
  v_cvt_pk_bf16_f32 v82, v72, v73
  v_cvt_pk_bf16_f32 v83, v74, v75
  ds_write_b128 v240, v[80:83] offset:5120
  v_mul_f32 v68, v68, v11
  v_mul_f32 v69, v69, v11
  v_mul_f32 v70, v70, v11
  v_mul_f32 v71, v71, v11
  v_cvt_pk_bf16_f32 v84, v68, v69
  v_cvt_pk_bf16_f32 v85, v70, v71
  v_mul_f32 v76, v76, v11
  v_mul_f32 v77, v77, v11
  v_mul_f32 v78, v78, v11
  v_mul_f32 v79, v79, v11
  v_cvt_pk_bf16_f32 v86, v76, v77
  v_cvt_pk_bf16_f32 v87, v78, v79
  ds_write_b128 v240, v[84:87] offset:29696
  s_lshl_b32 s17, s14, 1
  s_add_u32 s17, s17, 1
  s_lshl_b32 s16, s15, 6
  s_add_u32 s16, s16, s17
  s_mul_i32 s16, s16, 12288
  s_add_u32 s20, s16, 88080384
  s_add_u32 s21, s16, 37748736
  s_add_u32 s22, s16, 62914560
  s_lshl_b32 s17, s17, 5
  s_add_u32 s17, s17, s15
  s_mul_i32 s17, s17, 3072
  s_add_u32 s23, s17, 113246208
  s_add_u32 s24, s17, 119537664
  buffer_load_dwordx4 v[136:139], v1, s[4:7], s21 offen offset:0
  buffer_load_dwordx4 v[140:143], v1, s[4:7], s21 offen offset:1024
  buffer_load_dwordx4 v[144:147], v1, s[4:7], s21 offen offset:2048
  buffer_load_dwordx4 v[148:151], v1, s[4:7], s21 offen offset:3072
  buffer_load_dwordx4 v[152:155], v2, s[4:7], s21 offen offset:0
  buffer_load_dwordx4 v[156:159], v2, s[4:7], s21 offen offset:1024
  buffer_load_dwordx4 v[160:163], v2, s[4:7], s21 offen offset:2048
  buffer_load_dwordx4 v[164:167], v2, s[4:7], s21 offen offset:3072
  buffer_load_dwordx4 v[168:171], v3, s[4:7], s21 offen offset:0
  buffer_load_dwordx4 v[172:175], v3, s[4:7], s21 offen offset:1024
  buffer_load_dwordx4 v[176:179], v3, s[4:7], s21 offen offset:2048
  buffer_load_dwordx4 v[180:183], v3, s[4:7], s21 offen offset:3072
  buffer_load_dwordx4 v[184:187], v4, s[4:7], s23 offen offset:0
  buffer_load_dwordx4 v[188:191], v4, s[4:7], s23 offen offset:512
  buffer_load_dwordx4 v[192:195], v4, s[4:7], s23 offen offset:1024
  buffer_load_dwordx4 v[196:199], v4, s[4:7], s23 offen offset:1536
  buffer_load_dwordx4 v[200:203], v4, s[4:7], s23 offen offset:2048
  buffer_load_dwordx4 v[204:207], v4, s[4:7], s23 offen offset:2560
  buffer_load_dwordx4 v[88:91], v1, s[4:7], s20 offen offset:0
  buffer_load_dwordx4 v[92:95], v1, s[4:7], s20 offen offset:1024
  buffer_load_dwordx4 v[96:99], v1, s[4:7], s20 offen offset:2048
  buffer_load_dwordx4 v[100:103], v1, s[4:7], s20 offen offset:3072
  buffer_load_dwordx4 v[104:107], v2, s[4:7], s20 offen offset:0
  buffer_load_dwordx4 v[108:111], v2, s[4:7], s20 offen offset:1024
  buffer_load_dwordx4 v[112:115], v2, s[4:7], s20 offen offset:2048
  buffer_load_dwordx4 v[116:119], v2, s[4:7], s20 offen offset:3072
  buffer_load_dwordx4 v[120:123], v3, s[4:7], s20 offen offset:0
  buffer_load_dwordx4 v[124:127], v3, s[4:7], s20 offen offset:1024
  buffer_load_dwordx4 v[128:131], v3, s[4:7], s20 offen offset:2048
  buffer_load_dwordx4 v[132:135], v3, s[4:7], s20 offen offset:3072
  s_waitcnt vmcnt(5)
  v_mfma_f32_16x16x32_bf16 v[24:27], v[184:187], v[88:91], v[12:15]
  v_mfma_f32_16x16x32_bf16 v[28:31], v[136:139], v[88:91], v[16:19]
  v_mfma_f32_16x16x32_bf16 v[32:35], v[184:187], v[112:115], v[12:15]
  v_mfma_f32_16x16x32_bf16 v[36:39], v[136:139], v[112:115], 0
  v_mfma_f32_16x16x32_bf16 v[40:43], v[160:163], v[112:115], v[16:19]
  s_waitcnt vmcnt(4)
  v_mfma_f32_16x16x32_bf16 v[24:27], v[188:191], v[92:95], v[24:27]
  v_mfma_f32_16x16x32_bf16 v[28:31], v[140:143], v[92:95], v[28:31]
  v_mfma_f32_16x16x32_bf16 v[32:35], v[188:191], v[116:119], v[32:35]
  v_mfma_f32_16x16x32_bf16 v[36:39], v[140:143], v[116:119], v[36:39]
  v_mfma_f32_16x16x32_bf16 v[40:43], v[164:167], v[116:119], v[40:43]
  s_waitcnt vmcnt(3)
  v_mfma_f32_16x16x32_bf16 v[24:27], v[192:195], v[96:99], v[24:27]
  v_mfma_f32_16x16x32_bf16 v[28:31], v[144:147], v[96:99], v[28:31]
  v_mfma_f32_16x16x32_bf16 v[32:35], v[192:195], v[120:123], v[32:35]
  v_mfma_f32_16x16x32_bf16 v[36:39], v[144:147], v[120:123], v[36:39]
  v_mfma_f32_16x16x32_bf16 v[40:43], v[168:171], v[120:123], v[40:43]
  s_waitcnt vmcnt(2)
  v_mfma_f32_16x16x32_bf16 v[24:27], v[196:199], v[100:103], v[24:27]
  v_mfma_f32_16x16x32_bf16 v[28:31], v[148:151], v[100:103], v[28:31]
  v_mfma_f32_16x16x32_bf16 v[32:35], v[196:199], v[124:127], v[32:35]
  v_mfma_f32_16x16x32_bf16 v[36:39], v[148:151], v[124:127], v[36:39]
  v_mfma_f32_16x16x32_bf16 v[40:43], v[172:175], v[124:127], v[40:43]
  s_waitcnt vmcnt(1)
  v_mfma_f32_16x16x32_bf16 v[24:27], v[200:203], v[104:107], v[24:27]
  v_mfma_f32_16x16x32_bf16 v[28:31], v[152:155], v[104:107], v[28:31]
  v_mfma_f32_16x16x32_bf16 v[32:35], v[200:203], v[128:131], v[32:35]
  v_mfma_f32_16x16x32_bf16 v[36:39], v[152:155], v[128:131], v[36:39]
  v_mfma_f32_16x16x32_bf16 v[40:43], v[176:179], v[128:131], v[40:43]
  s_waitcnt vmcnt(0)
  v_mfma_f32_16x16x32_bf16 v[24:27], v[204:207], v[108:111], v[24:27]
  v_mfma_f32_16x16x32_bf16 v[28:31], v[156:159], v[108:111], v[28:31]
  v_mfma_f32_16x16x32_bf16 v[32:35], v[204:207], v[132:135], v[32:35]
  v_mfma_f32_16x16x32_bf16 v[36:39], v[156:159], v[132:135], v[36:39]
  v_mfma_f32_16x16x32_bf16 v[40:43], v[180:183], v[132:135], v[40:43]
  buffer_load_dwordx4 v[88:91], v1, s[4:7], s22 offen offset:0
  buffer_load_dwordx4 v[92:95], v1, s[4:7], s22 offen offset:1024
  buffer_load_dwordx4 v[96:99], v1, s[4:7], s22 offen offset:2048
  buffer_load_dwordx4 v[100:103], v1, s[4:7], s22 offen offset:3072
  buffer_load_dwordx4 v[104:107], v2, s[4:7], s22 offen offset:0
  buffer_load_dwordx4 v[108:111], v2, s[4:7], s22 offen offset:1024
  buffer_load_dwordx4 v[112:115], v2, s[4:7], s22 offen offset:2048
  buffer_load_dwordx4 v[116:119], v2, s[4:7], s22 offen offset:3072
  buffer_load_dwordx4 v[120:123], v3, s[4:7], s22 offen offset:0
  buffer_load_dwordx4 v[124:127], v3, s[4:7], s22 offen offset:1024
  buffer_load_dwordx4 v[128:131], v3, s[4:7], s22 offen offset:2048
  buffer_load_dwordx4 v[132:135], v3, s[4:7], s22 offen offset:3072
  buffer_load_dwordx2 v[136:137], v5, s[4:7], s24 offen offset:0
  buffer_load_dwordx2 v[138:139], v5, s[4:7], s24 offen offset:256
  buffer_load_dwordx2 v[140:141], v5, s[4:7], s24 offen offset:512
  buffer_load_dwordx2 v[142:143], v5, s[4:7], s24 offen offset:768
  buffer_load_dwordx2 v[144:145], v5, s[4:7], s24 offen offset:1024
  buffer_load_dwordx2 v[146:147], v5, s[4:7], s24 offen offset:1280
  buffer_load_dwordx2 v[148:149], v5, s[4:7], s24 offen offset:1536
  buffer_load_dwordx2 v[150:151], v5, s[4:7], s24 offen offset:1792
  buffer_load_dwordx2 v[152:153], v5, s[4:7], s24 offen offset:2048
  buffer_load_dwordx2 v[154:155], v5, s[4:7], s24 offen offset:2304
  buffer_load_dwordx2 v[156:157], v5, s[4:7], s24 offen offset:2560
  buffer_load_dwordx2 v[158:159], v5, s[4:7], s24 offen offset:2816
  v_max3_f32 v6, v24, v25, v26
  v_max3_f32 v6, v6, v27, v28
  v_max3_f32 v6, v6, v29, v30
  v_max_f32 v6, v6, v31
  v_mov_b32 v7, v6
  s_nop 1
  v_permlane32_swap_b32 v6, v7
  v_max_f32 v6, v6, v7
  v_mov_b32 v7, v6
  s_nop 1
  v_permlane16_swap_b32 v6, v7
  v_max_f32 v6, v6, v7
  v_mul_f32 v6, s27, v6
  v_fma_f32 v24, v24, s27, -v6
  v_fma_f32 v25, v25, s27, -v6
  v_fma_f32 v26, v26, s27, -v6
  v_fma_f32 v27, v27, s27, -v6
  v_fma_f32 v28, v28, s27, -v6
  v_fma_f32 v29, v29, s27, -v6
  v_fma_f32 v30, v30, s27, -v6
  v_fma_f32 v31, v31, s27, -v6
  v_exp_f32 v24, v24
  v_exp_f32 v25, v25
  v_exp_f32 v26, v26
  v_exp_f32 v27, v27
  v_exp_f32 v28, v28
  v_exp_f32 v29, v29
  v_exp_f32 v30, v30
  v_exp_f32 v31, v31
  v_max3_f32 v8, v32, v33, v34
  v_max3_f32 v8, v8, v35, v36
  v_max3_f32 v8, v8, v37, v38
  v_max3_f32 v8, v8, v39, v40
  v_max3_f32 v8, v8, v41, v42
  v_max_f32 v8, v8, v43
  v_mov_b32 v10, v8
  s_nop 1
  v_permlane32_swap_b32 v8, v10
  v_max_f32 v8, v8, v10
  v_mov_b32 v10, v8
  s_nop 1
  v_permlane16_swap_b32 v8, v10
  v_max_f32 v8, v8, v10
  v_mul_f32 v8, s27, v8
  v_fma_f32 v32, v32, s27, -v8
  v_fma_f32 v33, v33, s27, -v8
  v_fma_f32 v34, v34, s27, -v8
  v_fma_f32 v35, v35, s27, -v8
  v_fma_f32 v36, v36, s27, -v8
  v_fma_f32 v37, v37, s27, -v8
  v_fma_f32 v38, v38, s27, -v8
  v_fma_f32 v39, v39, s27, -v8
  v_fma_f32 v40, v40, s27, -v8
  v_fma_f32 v41, v41, s27, -v8
  v_fma_f32 v42, v42, s27, -v8
  v_fma_f32 v43, v43, s27, -v8
  v_exp_f32 v32, v32
  v_exp_f32 v33, v33
  v_exp_f32 v34, v34
  v_exp_f32 v35, v35
  v_exp_f32 v36, v36
  v_exp_f32 v37, v37
  v_exp_f32 v38, v38
  v_exp_f32 v39, v39
  v_exp_f32 v40, v40
  v_exp_f32 v41, v41
  v_exp_f32 v42, v42
  v_exp_f32 v43, v43
  v_cvt_pk_bf16_f32 v44, v24, v25
  v_cvt_pk_bf16_f32 v45, v26, v27
  v_cvt_pk_bf16_f32 v46, v28, v29
  v_cvt_pk_bf16_f32 v47, v30, v31
  v_cvt_pk_bf16_f32 v48, v32, v33
  v_cvt_pk_bf16_f32 v49, v34, v35
  v_cvt_pk_bf16_f32 v50, v36, v37
  v_cvt_pk_bf16_f32 v51, v38, v39
  v_cvt_pk_bf16_f32 v52, v40, v41
  v_cvt_pk_bf16_f32 v53, v42, v43
  v_mfma_f32_16x16x16_bf16 v[56:59], v[20:21], v[44:45], 0
  v_mfma_f32_16x16x16_bf16 v[60:63], v[20:21], v[48:49], 0
  v_mfma_f32_16x16x16_bf16 v[56:59], v[20:21], v[46:47], v[56:59]
  v_mfma_f32_16x16x32_bf16 v[60:63], v[20:23], v[50:53], v[60:63]
  s_nop 6
  v_rcp_f32 v10, v56
  v_rcp_f32 v11, v60
  s_waitcnt vmcnt(0)
  buffer_load_dwordx4 a[160:163], v1, s[4:7], s30 offen offset:0
  buffer_load_dwordx4 a[164:167], v1, s[4:7], s31 offen offset:0
  buffer_load_dwordx4 a[168:171], v1, s[4:7], s32 offen offset:0
  buffer_load_dwordx4 a[172:175], v1, s[4:7], s33 offen offset:0
  buffer_load_dwordx4 a[176:179], v1, s[4:7], s34 offen offset:0
  buffer_load_dwordx4 a[180:183], v1, s[4:7], s35 offen offset:0
  buffer_load_dwordx4 a[184:187], v1, s[4:7], s36 offen offset:0
  buffer_load_dwordx4 a[188:191], v1, s[4:7], s37 offen offset:0
  buffer_load_dwordx4 a[192:195], v1, s[4:7], s38 offen offset:0
  buffer_load_dwordx4 a[196:199], v1, s[4:7], s39 offen offset:0
  buffer_load_dwordx4 a[200:203], v1, s[4:7], s30 offen offset:1024
  buffer_load_dwordx4 a[204:207], v1, s[4:7], s31 offen offset:1024
  buffer_load_dwordx4 a[208:211], v1, s[4:7], s32 offen offset:1024
  buffer_load_dwordx4 a[212:215], v1, s[4:7], s33 offen offset:1024
  buffer_load_dwordx4 a[216:219], v1, s[4:7], s34 offen offset:1024
  buffer_load_dwordx4 a[220:223], v1, s[4:7], s35 offen offset:1024
  buffer_load_dwordx4 a[224:227], v1, s[4:7], s36 offen offset:1024
  buffer_load_dwordx4 a[228:231], v1, s[4:7], s37 offen offset:1024
  buffer_load_dwordx4 a[232:235], v1, s[4:7], s38 offen offset:1024
  buffer_load_dwordx4 a[236:239], v1, s[4:7], s39 offen offset:1024
  v_mfma_f32_16x16x16_bf16 v[64:67], v[136:137], v[44:45], 0
  v_mfma_f32_16x16x16_bf16 v[68:71], v[136:137], v[48:49], 0
  v_mfma_f32_16x16x16_bf16 v[64:67], v[88:89], v[46:47], v[64:67]
  v_mfma_f32_16x16x32_bf16 v[68:71], v[88:91], v[50:53], v[68:71]
  v_mfma_f32_16x16x16_bf16 v[72:75], v[138:139], v[44:45], 0
  v_mfma_f32_16x16x16_bf16 v[76:79], v[138:139], v[48:49], 0
  v_mfma_f32_16x16x16_bf16 v[72:75], v[92:93], v[46:47], v[72:75]
  v_mfma_f32_16x16x32_bf16 v[76:79], v[92:95], v[50:53], v[76:79]
  s_nop 2
  v_mul_f32 v64, v64, v10
  v_mul_f32 v65, v65, v10
  v_mul_f32 v66, v66, v10
  v_mul_f32 v67, v67, v10
  v_cvt_pk_bf16_f32 v80, v64, v65
  v_cvt_pk_bf16_f32 v81, v66, v67
  v_mul_f32 v72, v72, v10
  v_mul_f32 v73, v73, v10
  v_mul_f32 v74, v74, v10
  v_mul_f32 v75, v75, v10
  v_cvt_pk_bf16_f32 v82, v72, v73
  v_cvt_pk_bf16_f32 v83, v74, v75
  ds_write_b128 v241, v[80:83] offset:0
  v_mul_f32 v68, v68, v11
  v_mul_f32 v69, v69, v11
  v_mul_f32 v70, v70, v11
  v_mul_f32 v71, v71, v11
  v_cvt_pk_bf16_f32 v84, v68, v69
  v_cvt_pk_bf16_f32 v85, v70, v71
  v_mul_f32 v76, v76, v11
  v_mul_f32 v77, v77, v11
  v_mul_f32 v78, v78, v11
  v_mul_f32 v79, v79, v11
  v_cvt_pk_bf16_f32 v86, v76, v77
  v_cvt_pk_bf16_f32 v87, v78, v79
  ds_write_b128 v241, v[84:87] offset:24576
  v_mfma_f32_16x16x16_bf16 v[64:67], v[140:141], v[44:45], 0
  v_mfma_f32_16x16x16_bf16 v[68:71], v[140:141], v[48:49], 0
  v_mfma_f32_16x16x16_bf16 v[64:67], v[96:97], v[46:47], v[64:67]
  v_mfma_f32_16x16x32_bf16 v[68:71], v[96:99], v[50:53], v[68:71]
  v_mfma_f32_16x16x16_bf16 v[72:75], v[142:143], v[44:45], 0
  v_mfma_f32_16x16x16_bf16 v[76:79], v[142:143], v[48:49], 0
  v_mfma_f32_16x16x16_bf16 v[72:75], v[100:101], v[46:47], v[72:75]
  v_mfma_f32_16x16x32_bf16 v[76:79], v[100:103], v[50:53], v[76:79]
  s_nop 2
  v_mul_f32 v64, v64, v10
  v_mul_f32 v65, v65, v10
  v_mul_f32 v66, v66, v10
  v_mul_f32 v67, v67, v10
  v_cvt_pk_bf16_f32 v80, v64, v65
  v_cvt_pk_bf16_f32 v81, v66, v67
  v_mul_f32 v72, v72, v10
  v_mul_f32 v73, v73, v10
  v_mul_f32 v74, v74, v10
  v_mul_f32 v75, v75, v10
  v_cvt_pk_bf16_f32 v82, v72, v73
  v_cvt_pk_bf16_f32 v83, v74, v75
  ds_write_b128 v241, v[80:83] offset:1024
  v_mul_f32 v68, v68, v11
  v_mul_f32 v69, v69, v11
  v_mul_f32 v70, v70, v11
  v_mul_f32 v71, v71, v11
  v_cvt_pk_bf16_f32 v84, v68, v69
  v_cvt_pk_bf16_f32 v85, v70, v71
  v_mul_f32 v76, v76, v11
  v_mul_f32 v77, v77, v11
  v_mul_f32 v78, v78, v11
  v_mul_f32 v79, v79, v11
  v_cvt_pk_bf16_f32 v86, v76, v77
  v_cvt_pk_bf16_f32 v87, v78, v79
  ds_write_b128 v241, v[84:87] offset:25600
  v_mfma_f32_16x16x16_bf16 v[64:67], v[144:145], v[44:45], 0
  v_mfma_f32_16x16x16_bf16 v[68:71], v[144:145], v[48:49], 0
  v_mfma_f32_16x16x16_bf16 v[64:67], v[104:105], v[46:47], v[64:67]
  v_mfma_f32_16x16x32_bf16 v[68:71], v[104:107], v[50:53], v[68:71]
  v_mfma_f32_16x16x16_bf16 v[72:75], v[146:147], v[44:45], 0
  v_mfma_f32_16x16x16_bf16 v[76:79], v[146:147], v[48:49], 0
  v_mfma_f32_16x16x16_bf16 v[72:75], v[108:109], v[46:47], v[72:75]
  v_mfma_f32_16x16x32_bf16 v[76:79], v[108:111], v[50:53], v[76:79]
  s_nop 2
  v_mul_f32 v64, v64, v10
  v_mul_f32 v65, v65, v10
  v_mul_f32 v66, v66, v10
  v_mul_f32 v67, v67, v10
  v_cvt_pk_bf16_f32 v80, v64, v65
  v_cvt_pk_bf16_f32 v81, v66, v67
  v_mul_f32 v72, v72, v10
  v_mul_f32 v73, v73, v10
  v_mul_f32 v74, v74, v10
  v_mul_f32 v75, v75, v10
  v_cvt_pk_bf16_f32 v82, v72, v73
  v_cvt_pk_bf16_f32 v83, v74, v75
  ds_write_b128 v241, v[80:83] offset:2048
  v_mul_f32 v68, v68, v11
  v_mul_f32 v69, v69, v11
  v_mul_f32 v70, v70, v11
  v_mul_f32 v71, v71, v11
  v_cvt_pk_bf16_f32 v84, v68, v69
  v_cvt_pk_bf16_f32 v85, v70, v71
  v_mul_f32 v76, v76, v11
  v_mul_f32 v77, v77, v11
  v_mul_f32 v78, v78, v11
  v_mul_f32 v79, v79, v11
  v_cvt_pk_bf16_f32 v86, v76, v77
  v_cvt_pk_bf16_f32 v87, v78, v79
  ds_write_b128 v241, v[84:87] offset:26624
  v_mfma_f32_16x16x16_bf16 v[64:67], v[148:149], v[44:45], 0
  v_mfma_f32_16x16x16_bf16 v[68:71], v[148:149], v[48:49], 0
  v_mfma_f32_16x16x16_bf16 v[64:67], v[112:113], v[46:47], v[64:67]
  v_mfma_f32_16x16x32_bf16 v[68:71], v[112:115], v[50:53], v[68:71]
  v_mfma_f32_16x16x16_bf16 v[72:75], v[150:151], v[44:45], 0
  v_mfma_f32_16x16x16_bf16 v[76:79], v[150:151], v[48:49], 0
  v_mfma_f32_16x16x16_bf16 v[72:75], v[116:117], v[46:47], v[72:75]
  v_mfma_f32_16x16x32_bf16 v[76:79], v[116:119], v[50:53], v[76:79]
  s_nop 2
  v_mul_f32 v64, v64, v10
  v_mul_f32 v65, v65, v10
  v_mul_f32 v66, v66, v10
  v_mul_f32 v67, v67, v10
  v_cvt_pk_bf16_f32 v80, v64, v65
  v_cvt_pk_bf16_f32 v81, v66, v67
  v_mul_f32 v72, v72, v10
  v_mul_f32 v73, v73, v10
  v_mul_f32 v74, v74, v10
  v_mul_f32 v75, v75, v10
  v_cvt_pk_bf16_f32 v82, v72, v73
  v_cvt_pk_bf16_f32 v83, v74, v75
  ds_write_b128 v241, v[80:83] offset:3072
  v_mul_f32 v68, v68, v11
  v_mul_f32 v69, v69, v11
  v_mul_f32 v70, v70, v11
  v_mul_f32 v71, v71, v11
  v_cvt_pk_bf16_f32 v84, v68, v69
  v_cvt_pk_bf16_f32 v85, v70, v71
  v_mul_f32 v76, v76, v11
  v_mul_f32 v77, v77, v11
  v_mul_f32 v78, v78, v11
  v_mul_f32 v79, v79, v11
  v_cvt_pk_bf16_f32 v86, v76, v77
  v_cvt_pk_bf16_f32 v87, v78, v79
  ds_write_b128 v241, v[84:87] offset:27648
  v_mfma_f32_16x16x16_bf16 v[64:67], v[152:153], v[44:45], 0
  v_mfma_f32_16x16x16_bf16 v[68:71], v[152:153], v[48:49], 0
  v_mfma_f32_16x16x16_bf16 v[64:67], v[120:121], v[46:47], v[64:67]
  v_mfma_f32_16x16x32_bf16 v[68:71], v[120:123], v[50:53], v[68:71]
  v_mfma_f32_16x16x16_bf16 v[72:75], v[154:155], v[44:45], 0
  v_mfma_f32_16x16x16_bf16 v[76:79], v[154:155], v[48:49], 0
  v_mfma_f32_16x16x16_bf16 v[72:75], v[124:125], v[46:47], v[72:75]
  v_mfma_f32_16x16x32_bf16 v[76:79], v[124:127], v[50:53], v[76:79]
  s_nop 2
  v_mul_f32 v64, v64, v10
  v_mul_f32 v65, v65, v10
  v_mul_f32 v66, v66, v10
  v_mul_f32 v67, v67, v10
  v_cvt_pk_bf16_f32 v80, v64, v65
  v_cvt_pk_bf16_f32 v81, v66, v67
  v_mul_f32 v72, v72, v10
  v_mul_f32 v73, v73, v10
  v_mul_f32 v74, v74, v10
  v_mul_f32 v75, v75, v10
  v_cvt_pk_bf16_f32 v82, v72, v73
  v_cvt_pk_bf16_f32 v83, v74, v75
  ds_write_b128 v241, v[80:83] offset:4096
  v_mul_f32 v68, v68, v11
  v_mul_f32 v69, v69, v11
  v_mul_f32 v70, v70, v11
  v_mul_f32 v71, v71, v11
  v_cvt_pk_bf16_f32 v84, v68, v69
  v_cvt_pk_bf16_f32 v85, v70, v71
  v_mul_f32 v76, v76, v11
  v_mul_f32 v77, v77, v11
  v_mul_f32 v78, v78, v11
  v_mul_f32 v79, v79, v11
  v_cvt_pk_bf16_f32 v86, v76, v77
  v_cvt_pk_bf16_f32 v87, v78, v79
  ds_write_b128 v241, v[84:87] offset:28672
  v_mfma_f32_16x16x16_bf16 v[64:67], v[156:157], v[44:45], 0
  v_mfma_f32_16x16x16_bf16 v[68:71], v[156:157], v[48:49], 0
  v_mfma_f32_16x16x16_bf16 v[64:67], v[128:129], v[46:47], v[64:67]
  v_mfma_f32_16x16x32_bf16 v[68:71], v[128:131], v[50:53], v[68:71]
  v_mfma_f32_16x16x16_bf16 v[72:75], v[158:159], v[44:45], 0
  v_mfma_f32_16x16x16_bf16 v[76:79], v[158:159], v[48:49], 0
  v_mfma_f32_16x16x16_bf16 v[72:75], v[132:133], v[46:47], v[72:75]
  v_mfma_f32_16x16x32_bf16 v[76:79], v[132:135], v[50:53], v[76:79]
  s_nop 2
  v_mul_f32 v64, v64, v10
  v_mul_f32 v65, v65, v10
  v_mul_f32 v66, v66, v10
  v_mul_f32 v67, v67, v10
  v_cvt_pk_bf16_f32 v80, v64, v65
  v_cvt_pk_bf16_f32 v81, v66, v67
  v_mul_f32 v72, v72, v10
  v_mul_f32 v73, v73, v10
  v_mul_f32 v74, v74, v10
  v_mul_f32 v75, v75, v10
  v_cvt_pk_bf16_f32 v82, v72, v73
  v_cvt_pk_bf16_f32 v83, v74, v75
  ds_write_b128 v241, v[80:83] offset:5120
  v_mul_f32 v68, v68, v11
  v_mul_f32 v69, v69, v11
  v_mul_f32 v70, v70, v11
  v_mul_f32 v71, v71, v11
  v_cvt_pk_bf16_f32 v84, v68, v69
  v_cvt_pk_bf16_f32 v85, v70, v71
  v_mul_f32 v76, v76, v11
  v_mul_f32 v77, v77, v11
  v_mul_f32 v78, v78, v11
  v_mul_f32 v79, v79, v11
  v_cvt_pk_bf16_f32 v86, v76, v77
  v_cvt_pk_bf16_f32 v87, v78, v79
  ds_write_b128 v241, v[84:87] offset:29696
  s_branch fin_phase22
fin_odma3:
  s_lshl_b32 s16, s14, 2
  s_add_u32 s16, s16, s12
  s_mul_i32 s16, s16, 192
  s_mul_i32 s17, s13, 24
  s_add_u32 s16, s16, s17
  s_lshl_b32 s16, s16, 10
  s_add_u32 s16, s16, 125829120
  s_mul_i32 s17, s12, 24576
  s_add_u32 m0, s17, 0
  s_nop 0
  buffer_load_dwordx4 v1, s[4:7], s16 offen offset:0 lds
  buffer_load_dwordx4 v1, s[4:7], s16 offen offset:1024 lds
  buffer_load_dwordx4 v1, s[4:7], s16 offen offset:2048 lds
  buffer_load_dwordx4 v1, s[4:7], s16 offen offset:3072 lds
  s_add_u32 s16, s16, 4096
  s_add_u32 m0, s17, 4096
  s_nop 0
  buffer_load_dwordx4 v1, s[4:7], s16 offen offset:0 lds
  buffer_load_dwordx4 v1, s[4:7], s16 offen offset:1024 lds
  buffer_load_dwordx4 v1, s[4:7], s16 offen offset:2048 lds
  buffer_load_dwordx4 v1, s[4:7], s16 offen offset:3072 lds
  s_add_u32 s16, s16, 4096
  s_add_u32 m0, s17, 8192
  s_nop 0
  buffer_load_dwordx4 v1, s[4:7], s16 offen offset:0 lds
  buffer_load_dwordx4 v1, s[4:7], s16 offen offset:1024 lds
  buffer_load_dwordx4 v1, s[4:7], s16 offen offset:2048 lds
  buffer_load_dwordx4 v1, s[4:7], s16 offen offset:3072 lds
  s_add_u32 s16, s16, 4096
  s_add_u32 m0, s17, 12288
  s_nop 0
  buffer_load_dwordx4 v1, s[4:7], s16 offen offset:0 lds
  buffer_load_dwordx4 v1, s[4:7], s16 offen offset:1024 lds
  buffer_load_dwordx4 v1, s[4:7], s16 offen offset:2048 lds
  buffer_load_dwordx4 v1, s[4:7], s16 offen offset:3072 lds
  s_add_u32 s16, s16, 4096
  s_add_u32 m0, s17, 16384
  s_nop 0
  buffer_load_dwordx4 v1, s[4:7], s16 offen offset:0 lds
  buffer_load_dwordx4 v1, s[4:7], s16 offen offset:1024 lds
  buffer_load_dwordx4 v1, s[4:7], s16 offen offset:2048 lds
  buffer_load_dwordx4 v1, s[4:7], s16 offen offset:3072 lds
  s_add_u32 s16, s16, 4096
  s_add_u32 m0, s17, 20480
  s_nop 0
  buffer_load_dwordx4 v1, s[4:7], s16 offen offset:0 lds
  buffer_load_dwordx4 v1, s[4:7], s16 offen offset:1024 lds
  buffer_load_dwordx4 v1, s[4:7], s16 offen offset:2048 lds
  buffer_load_dwordx4 v1, s[4:7], s16 offen offset:3072 lds
  s_add_u32 s16, s16, 4096
  buffer_load_dwordx4 a[160:163], v1, s[4:7], s30 offen offset:0
  buffer_load_dwordx4 a[164:167], v1, s[4:7], s31 offen offset:0
  buffer_load_dwordx4 a[168:171], v1, s[4:7], s32 offen offset:0
  buffer_load_dwordx4 a[172:175], v1, s[4:7], s33 offen offset:0
  buffer_load_dwordx4 a[176:179], v1, s[4:7], s34 offen offset:0
  buffer_load_dwordx4 a[180:183], v1, s[4:7], s35 offen offset:0
  buffer_load_dwordx4 a[184:187], v1, s[4:7], s36 offen offset:0
  buffer_load_dwordx4 a[188:191], v1, s[4:7], s37 offen offset:0
  buffer_load_dwordx4 a[192:195], v1, s[4:7], s38 offen offset:0
  buffer_load_dwordx4 a[196:199], v1, s[4:7], s39 offen offset:0
  buffer_load_dwordx4 a[200:203], v1, s[4:7], s30 offen offset:1024
  buffer_load_dwordx4 a[204:207], v1, s[4:7], s31 offen offset:1024
  buffer_load_dwordx4 a[208:211], v1, s[4:7], s32 offen offset:1024
  buffer_load_dwordx4 a[212:215], v1, s[4:7], s33 offen offset:1024
  buffer_load_dwordx4 a[216:219], v1, s[4:7], s34 offen offset:1024
  buffer_load_dwordx4 a[220:223], v1, s[4:7], s35 offen offset:1024
  buffer_load_dwordx4 a[224:227], v1, s[4:7], s36 offen offset:1024
  buffer_load_dwordx4 a[228:231], v1, s[4:7], s37 offen offset:1024
  buffer_load_dwordx4 a[232:235], v1, s[4:7], s38 offen offset:1024
  buffer_load_dwordx4 a[236:239], v1, s[4:7], s39 offen offset:1024
  s_waitcnt vmcnt(20)
fin_phase22:
  s_waitcnt lgkmcnt(0)
  buffer_load_dwordx4 v[104:107], v1, s[4:7], s30 offen offset:2048
  buffer_load_dwordx4 v[108:111], v1, s[4:7], s31 offen offset:2048
  buffer_load_dwordx4 v[112:115], v1, s[4:7], s32 offen offset:2048
  buffer_load_dwordx4 v[116:119], v1, s[4:7], s33 offen offset:2048
  buffer_load_dwordx4 v[120:123], v1, s[4:7], s34 offen offset:2048
  buffer_load_dwordx4 v[124:127], v1, s[4:7], s35 offen offset:2048
  buffer_load_dwordx4 v[128:131], v1, s[4:7], s36 offen offset:2048
  buffer_load_dwordx4 v[132:135], v1, s[4:7], s37 offen offset:2048
  buffer_load_dwordx4 v[136:139], v1, s[4:7], s38 offen offset:2048
  buffer_load_dwordx4 v[140:143], v1, s[4:7], s39 offen offset:2048
  buffer_load_dwordx4 v[144:147], v1, s[4:7], s30 offen offset:3072
  buffer_load_dwordx4 v[148:151], v1, s[4:7], s31 offen offset:3072
  buffer_load_dwordx4 v[152:155], v1, s[4:7], s32 offen offset:3072
  buffer_load_dwordx4 v[156:159], v1, s[4:7], s33 offen offset:3072
  buffer_load_dwordx4 v[160:163], v1, s[4:7], s34 offen offset:3072
  buffer_load_dwordx4 v[164:167], v1, s[4:7], s35 offen offset:3072
  buffer_load_dwordx4 v[168:171], v1, s[4:7], s36 offen offset:3072
  buffer_load_dwordx4 v[172:175], v1, s[4:7], s37 offen offset:3072
  buffer_load_dwordx4 v[176:179], v1, s[4:7], s38 offen offset:3072
  buffer_load_dwordx4 v[180:183], v1, s[4:7], s39 offen offset:3072
  s_add_u32 s30, s30, 4096
  s_add_u32 s31, s31, 4096
  s_add_u32 s32, s32, 4096
  s_add_u32 s33, s33, 4096
  s_add_u32 s34, s34, 4096
  s_add_u32 s35, s35, 4096
  s_add_u32 s36, s36, 4096
  s_add_u32 s37, s37, 4096
  s_add_u32 s38, s38, 4096
  s_add_u32 s39, s39, 4096
  v_add_u32 v6, 49152, v1
  s_barrier
  ds_read_b128 v[184:187], v1 offset:0
  ds_read_b128 v[188:191], v1 offset:24576
  ds_read_b128 v[192:195], v6 offset:0
  ds_read_b128 v[196:199], v6 offset:24576
  s_waitcnt vmcnt(30)
  ds_read_b128 v[200:203], v1 offset:1024
  ds_read_b128 v[204:207], v1 offset:25600
  ds_read_b128 v[208:211], v6 offset:1024
  ds_read_b128 v[212:215], v6 offset:25600
  s_waitcnt lgkmcnt(4)
  v_mfma_f32_16x16x32_bf16 a[0:3], a[160:163], v[184:187], 0
  v_mfma_f32_16x16x32_bf16 a[4:7], a[160:163], v[188:191], 0
  v_mfma_f32_16x16x32_bf16 a[8:11], a[160:163], v[192:195], 0
  v_mfma_f32_16x16x32_bf16 a[12:15], a[160:163], v[196:199], 0
  v_mfma_f32_16x16x32_bf16 a[16:19], a[164:167], v[184:187], 0
  v_mfma_f32_16x16x32_bf16 a[20:23], a[164:167], v[188:191], 0
  v_mfma_f32_16x16x32_bf16 a[24:27], a[164:167], v[192:195], 0
  v_mfma_f32_16x16x32_bf16 a[28:31], a[164:167], v[196:199], 0
  v_mfma_f32_16x16x32_bf16 a[32:35], a[168:171], v[184:187], 0
  v_mfma_f32_16x16x32_bf16 a[36:39], a[168:171], v[188:191], 0
  v_mfma_f32_16x16x32_bf16 a[40:43], a[168:171], v[192:195], 0
  v_mfma_f32_16x16x32_bf16 a[44:47], a[168:171], v[196:199], 0
  v_mfma_f32_16x16x32_bf16 a[48:51], a[172:175], v[184:187], 0
  v_mfma_f32_16x16x32_bf16 a[52:55], a[172:175], v[188:191], 0
  v_mfma_f32_16x16x32_bf16 a[56:59], a[172:175], v[192:195], 0
  v_mfma_f32_16x16x32_bf16 a[60:63], a[172:175], v[196:199], 0
  v_mfma_f32_16x16x32_bf16 a[64:67], a[176:179], v[184:187], 0
  v_mfma_f32_16x16x32_bf16 a[68:71], a[176:179], v[188:191], 0
  v_mfma_f32_16x16x32_bf16 a[72:75], a[176:179], v[192:195], 0
  v_mfma_f32_16x16x32_bf16 a[76:79], a[176:179], v[196:199], 0
  v_mfma_f32_16x16x32_bf16 a[80:83], a[180:183], v[184:187], 0
  v_mfma_f32_16x16x32_bf16 a[84:87], a[180:183], v[188:191], 0
  v_mfma_f32_16x16x32_bf16 a[88:91], a[180:183], v[192:195], 0
  v_mfma_f32_16x16x32_bf16 a[92:95], a[180:183], v[196:199], 0
  v_mfma_f32_16x16x32_bf16 a[96:99], a[184:187], v[184:187], 0
  v_mfma_f32_16x16x32_bf16 a[100:103], a[184:187], v[188:191], 0
  v_mfma_f32_16x16x32_bf16 a[104:107], a[184:187], v[192:195], 0
  v_mfma_f32_16x16x32_bf16 a[108:111], a[184:187], v[196:199], 0
  v_mfma_f32_16x16x32_bf16 a[112:115], a[188:191], v[184:187], 0
  v_mfma_f32_16x16x32_bf16 a[116:119], a[188:191], v[188:191], 0
  v_mfma_f32_16x16x32_bf16 a[120:123], a[188:191], v[192:195], 0
  v_mfma_f32_16x16x32_bf16 a[124:127], a[188:191], v[196:199], 0
  v_mfma_f32_16x16x32_bf16 a[128:131], a[192:195], v[184:187], 0
  v_mfma_f32_16x16x32_bf16 a[132:135], a[192:195], v[188:191], 0
  v_mfma_f32_16x16x32_bf16 a[136:139], a[192:195], v[192:195], 0
  v_mfma_f32_16x16x32_bf16 a[140:143], a[192:195], v[196:199], 0
  v_mfma_f32_16x16x32_bf16 a[144:147], a[196:199], v[184:187], 0
  v_mfma_f32_16x16x32_bf16 a[148:151], a[196:199], v[188:191], 0
  v_mfma_f32_16x16x32_bf16 a[152:155], a[196:199], v[192:195], 0
  v_mfma_f32_16x16x32_bf16 a[156:159], a[196:199], v[196:199], 0
  buffer_load_dwordx4 v[24:27], v1, s[4:7], s30 offen offset:0
  buffer_load_dwordx4 v[28:31], v1, s[4:7], s31 offen offset:0
  buffer_load_dwordx4 v[32:35], v1, s[4:7], s32 offen offset:0
  buffer_load_dwordx4 v[36:39], v1, s[4:7], s33 offen offset:0
  buffer_load_dwordx4 v[40:43], v1, s[4:7], s34 offen offset:0
  buffer_load_dwordx4 v[44:47], v1, s[4:7], s35 offen offset:0
  buffer_load_dwordx4 v[48:51], v1, s[4:7], s36 offen offset:0
  buffer_load_dwordx4 v[52:55], v1, s[4:7], s37 offen offset:0
  buffer_load_dwordx4 v[56:59], v1, s[4:7], s38 offen offset:0
  buffer_load_dwordx4 v[60:63], v1, s[4:7], s39 offen offset:0
  s_waitcnt vmcnt(30)
  ds_read_b128 v[184:187], v1 offset:2048
  ds_read_b128 v[188:191], v1 offset:26624
  ds_read_b128 v[192:195], v6 offset:2048
  ds_read_b128 v[196:199], v6 offset:26624
  s_waitcnt lgkmcnt(4)
  v_mfma_f32_16x16x32_bf16 a[0:3], a[200:203], v[200:203], a[0:3]
  v_mfma_f32_16x16x32_bf16 a[4:7], a[200:203], v[204:207], a[4:7]
  v_mfma_f32_16x16x32_bf16 a[8:11], a[200:203], v[208:211], a[8:11]
  v_mfma_f32_16x16x32_bf16 a[12:15], a[200:203], v[212:215], a[12:15]
  v_mfma_f32_16x16x32_bf16 a[16:19], a[204:207], v[200:203], a[16:19]
  v_mfma_f32_16x16x32_bf16 a[20:23], a[204:207], v[204:207], a[20:23]
  v_mfma_f32_16x16x32_bf16 a[24:27], a[204:207], v[208:211], a[24:27]
  v_mfma_f32_16x16x32_bf16 a[28:31], a[204:207], v[212:215], a[28:31]
  v_mfma_f32_16x16x32_bf16 a[32:35], a[208:211], v[200:203], a[32:35]
  v_mfma_f32_16x16x32_bf16 a[36:39], a[208:211], v[204:207], a[36:39]
  v_mfma_f32_16x16x32_bf16 a[40:43], a[208:211], v[208:211], a[40:43]
  v_mfma_f32_16x16x32_bf16 a[44:47], a[208:211], v[212:215], a[44:47]
  v_mfma_f32_16x16x32_bf16 a[48:51], a[212:215], v[200:203], a[48:51]
  v_mfma_f32_16x16x32_bf16 a[52:55], a[212:215], v[204:207], a[52:55]
  v_mfma_f32_16x16x32_bf16 a[56:59], a[212:215], v[208:211], a[56:59]
  v_mfma_f32_16x16x32_bf16 a[60:63], a[212:215], v[212:215], a[60:63]
  v_mfma_f32_16x16x32_bf16 a[64:67], a[216:219], v[200:203], a[64:67]
  v_mfma_f32_16x16x32_bf16 a[68:71], a[216:219], v[204:207], a[68:71]
  v_mfma_f32_16x16x32_bf16 a[72:75], a[216:219], v[208:211], a[72:75]
  v_mfma_f32_16x16x32_bf16 a[76:79], a[216:219], v[212:215], a[76:79]
  v_mfma_f32_16x16x32_bf16 a[80:83], a[220:223], v[200:203], a[80:83]
  v_mfma_f32_16x16x32_bf16 a[84:87], a[220:223], v[204:207], a[84:87]
  v_mfma_f32_16x16x32_bf16 a[88:91], a[220:223], v[208:211], a[88:91]
  v_mfma_f32_16x16x32_bf16 a[92:95], a[220:223], v[212:215], a[92:95]
  v_mfma_f32_16x16x32_bf16 a[96:99], a[224:227], v[200:203], a[96:99]
  v_mfma_f32_16x16x32_bf16 a[100:103], a[224:227], v[204:207], a[100:103]
  v_mfma_f32_16x16x32_bf16 a[104:107], a[224:227], v[208:211], a[104:107]
  v_mfma_f32_16x16x32_bf16 a[108:111], a[224:227], v[212:215], a[108:111]
  v_mfma_f32_16x16x32_bf16 a[112:115], a[228:231], v[200:203], a[112:115]
  v_mfma_f32_16x16x32_bf16 a[116:119], a[228:231], v[204:207], a[116:119]
  v_mfma_f32_16x16x32_bf16 a[120:123], a[228:231], v[208:211], a[120:123]
  v_mfma_f32_16x16x32_bf16 a[124:127], a[228:231], v[212:215], a[124:127]
  v_mfma_f32_16x16x32_bf16 a[128:131], a[232:235], v[200:203], a[128:131]
  v_mfma_f32_16x16x32_bf16 a[132:135], a[232:235], v[204:207], a[132:135]
  v_mfma_f32_16x16x32_bf16 a[136:139], a[232:235], v[208:211], a[136:139]
  v_mfma_f32_16x16x32_bf16 a[140:143], a[232:235], v[212:215], a[140:143]
  v_mfma_f32_16x16x32_bf16 a[144:147], a[236:239], v[200:203], a[144:147]
  v_mfma_f32_16x16x32_bf16 a[148:151], a[236:239], v[204:207], a[148:151]
  v_mfma_f32_16x16x32_bf16 a[152:155], a[236:239], v[208:211], a[152:155]
  v_mfma_f32_16x16x32_bf16 a[156:159], a[236:239], v[212:215], a[156:159]
  buffer_load_dwordx4 v[64:67], v1, s[4:7], s30 offen offset:1024
  buffer_load_dwordx4 v[68:71], v1, s[4:7], s31 offen offset:1024
  buffer_load_dwordx4 v[72:75], v1, s[4:7], s32 offen offset:1024
  buffer_load_dwordx4 v[76:79], v1, s[4:7], s33 offen offset:1024
  buffer_load_dwordx4 v[80:83], v1, s[4:7], s34 offen offset:1024
  buffer_load_dwordx4 v[84:87], v1, s[4:7], s35 offen offset:1024
  buffer_load_dwordx4 v[88:91], v1, s[4:7], s36 offen offset:1024
  buffer_load_dwordx4 v[92:95], v1, s[4:7], s37 offen offset:1024
  buffer_load_dwordx4 v[96:99], v1, s[4:7], s38 offen offset:1024
  buffer_load_dwordx4 v[100:103], v1, s[4:7], s39 offen offset:1024
  s_waitcnt vmcnt(30)
  ds_read_b128 v[200:203], v1 offset:3072
  ds_read_b128 v[204:207], v1 offset:27648
  ds_read_b128 v[208:211], v6 offset:3072
  ds_read_b128 v[212:215], v6 offset:27648
  s_waitcnt lgkmcnt(4)
  v_mfma_f32_16x16x32_bf16 a[0:3], v[104:107], v[184:187], a[0:3]
  v_mfma_f32_16x16x32_bf16 a[4:7], v[104:107], v[188:191], a[4:7]
  v_mfma_f32_16x16x32_bf16 a[8:11], v[104:107], v[192:195], a[8:11]
  v_mfma_f32_16x16x32_bf16 a[12:15], v[104:107], v[196:199], a[12:15]
  v_mfma_f32_16x16x32_bf16 a[16:19], v[108:111], v[184:187], a[16:19]
  v_mfma_f32_16x16x32_bf16 a[20:23], v[108:111], v[188:191], a[20:23]
  v_mfma_f32_16x16x32_bf16 a[24:27], v[108:111], v[192:195], a[24:27]
  v_mfma_f32_16x16x32_bf16 a[28:31], v[108:111], v[196:199], a[28:31]
  v_mfma_f32_16x16x32_bf16 a[32:35], v[112:115], v[184:187], a[32:35]
  v_mfma_f32_16x16x32_bf16 a[36:39], v[112:115], v[188:191], a[36:39]
  v_mfma_f32_16x16x32_bf16 a[40:43], v[112:115], v[192:195], a[40:43]
  v_mfma_f32_16x16x32_bf16 a[44:47], v[112:115], v[196:199], a[44:47]
  v_mfma_f32_16x16x32_bf16 a[48:51], v[116:119], v[184:187], a[48:51]
  v_mfma_f32_16x16x32_bf16 a[52:55], v[116:119], v[188:191], a[52:55]
  v_mfma_f32_16x16x32_bf16 a[56:59], v[116:119], v[192:195], a[56:59]
  v_mfma_f32_16x16x32_bf16 a[60:63], v[116:119], v[196:199], a[60:63]
  v_mfma_f32_16x16x32_bf16 a[64:67], v[120:123], v[184:187], a[64:67]
  v_mfma_f32_16x16x32_bf16 a[68:71], v[120:123], v[188:191], a[68:71]
  v_mfma_f32_16x16x32_bf16 a[72:75], v[120:123], v[192:195], a[72:75]
  v_mfma_f32_16x16x32_bf16 a[76:79], v[120:123], v[196:199], a[76:79]
  v_mfma_f32_16x16x32_bf16 a[80:83], v[124:127], v[184:187], a[80:83]
  v_mfma_f32_16x16x32_bf16 a[84:87], v[124:127], v[188:191], a[84:87]
  v_mfma_f32_16x16x32_bf16 a[88:91], v[124:127], v[192:195], a[88:91]
  v_mfma_f32_16x16x32_bf16 a[92:95], v[124:127], v[196:199], a[92:95]
  v_mfma_f32_16x16x32_bf16 a[96:99], v[128:131], v[184:187], a[96:99]
  v_mfma_f32_16x16x32_bf16 a[100:103], v[128:131], v[188:191], a[100:103]
  v_mfma_f32_16x16x32_bf16 a[104:107], v[128:131], v[192:195], a[104:107]
  v_mfma_f32_16x16x32_bf16 a[108:111], v[128:131], v[196:199], a[108:111]
  v_mfma_f32_16x16x32_bf16 a[112:115], v[132:135], v[184:187], a[112:115]
  v_mfma_f32_16x16x32_bf16 a[116:119], v[132:135], v[188:191], a[116:119]
  v_mfma_f32_16x16x32_bf16 a[120:123], v[132:135], v[192:195], a[120:123]
  v_mfma_f32_16x16x32_bf16 a[124:127], v[132:135], v[196:199], a[124:127]
  v_mfma_f32_16x16x32_bf16 a[128:131], v[136:139], v[184:187], a[128:131]
  v_mfma_f32_16x16x32_bf16 a[132:135], v[136:139], v[188:191], a[132:135]
  v_mfma_f32_16x16x32_bf16 a[136:139], v[136:139], v[192:195], a[136:139]
  v_mfma_f32_16x16x32_bf16 a[140:143], v[136:139], v[196:199], a[140:143]
  v_mfma_f32_16x16x32_bf16 a[144:147], v[140:143], v[184:187], a[144:147]
  v_mfma_f32_16x16x32_bf16 a[148:151], v[140:143], v[188:191], a[148:151]
  v_mfma_f32_16x16x32_bf16 a[152:155], v[140:143], v[192:195], a[152:155]
  v_mfma_f32_16x16x32_bf16 a[156:159], v[140:143], v[196:199], a[156:159]
  buffer_load_dwordx4 v[104:107], v1, s[4:7], s30 offen offset:2048
  buffer_load_dwordx4 v[108:111], v1, s[4:7], s31 offen offset:2048
  buffer_load_dwordx4 v[112:115], v1, s[4:7], s32 offen offset:2048
  buffer_load_dwordx4 v[116:119], v1, s[4:7], s33 offen offset:2048
  buffer_load_dwordx4 v[120:123], v1, s[4:7], s34 offen offset:2048
  buffer_load_dwordx4 v[124:127], v1, s[4:7], s35 offen offset:2048
  buffer_load_dwordx4 v[128:131], v1, s[4:7], s36 offen offset:2048
  buffer_load_dwordx4 v[132:135], v1, s[4:7], s37 offen offset:2048
  buffer_load_dwordx4 v[136:139], v1, s[4:7], s38 offen offset:2048
  buffer_load_dwordx4 v[140:143], v1, s[4:7], s39 offen offset:2048
  s_waitcnt vmcnt(30)
  ds_read_b128 v[184:187], v1 offset:4096
  ds_read_b128 v[188:191], v1 offset:28672
  ds_read_b128 v[192:195], v6 offset:4096
  ds_read_b128 v[196:199], v6 offset:28672
  s_waitcnt lgkmcnt(4)
  v_mfma_f32_16x16x32_bf16 a[0:3], v[144:147], v[200:203], a[0:3]
  v_mfma_f32_16x16x32_bf16 a[4:7], v[144:147], v[204:207], a[4:7]
  v_mfma_f32_16x16x32_bf16 a[8:11], v[144:147], v[208:211], a[8:11]
  v_mfma_f32_16x16x32_bf16 a[12:15], v[144:147], v[212:215], a[12:15]
  v_mfma_f32_16x16x32_bf16 a[16:19], v[148:151], v[200:203], a[16:19]
  v_mfma_f32_16x16x32_bf16 a[20:23], v[148:151], v[204:207], a[20:23]
  v_mfma_f32_16x16x32_bf16 a[24:27], v[148:151], v[208:211], a[24:27]
  v_mfma_f32_16x16x32_bf16 a[28:31], v[148:151], v[212:215], a[28:31]
  v_mfma_f32_16x16x32_bf16 a[32:35], v[152:155], v[200:203], a[32:35]
  v_mfma_f32_16x16x32_bf16 a[36:39], v[152:155], v[204:207], a[36:39]
  v_mfma_f32_16x16x32_bf16 a[40:43], v[152:155], v[208:211], a[40:43]
  v_mfma_f32_16x16x32_bf16 a[44:47], v[152:155], v[212:215], a[44:47]
  v_mfma_f32_16x16x32_bf16 a[48:51], v[156:159], v[200:203], a[48:51]
  v_mfma_f32_16x16x32_bf16 a[52:55], v[156:159], v[204:207], a[52:55]
  v_mfma_f32_16x16x32_bf16 a[56:59], v[156:159], v[208:211], a[56:59]
  v_mfma_f32_16x16x32_bf16 a[60:63], v[156:159], v[212:215], a[60:63]
  v_mfma_f32_16x16x32_bf16 a[64:67], v[160:163], v[200:203], a[64:67]
  v_mfma_f32_16x16x32_bf16 a[68:71], v[160:163], v[204:207], a[68:71]
  v_mfma_f32_16x16x32_bf16 a[72:75], v[160:163], v[208:211], a[72:75]
  v_mfma_f32_16x16x32_bf16 a[76:79], v[160:163], v[212:215], a[76:79]
  v_mfma_f32_16x16x32_bf16 a[80:83], v[164:167], v[200:203], a[80:83]
  v_mfma_f32_16x16x32_bf16 a[84:87], v[164:167], v[204:207], a[84:87]
  v_mfma_f32_16x16x32_bf16 a[88:91], v[164:167], v[208:211], a[88:91]
  v_mfma_f32_16x16x32_bf16 a[92:95], v[164:167], v[212:215], a[92:95]
  v_mfma_f32_16x16x32_bf16 a[96:99], v[168:171], v[200:203], a[96:99]
  v_mfma_f32_16x16x32_bf16 a[100:103], v[168:171], v[204:207], a[100:103]
  v_mfma_f32_16x16x32_bf16 a[104:107], v[168:171], v[208:211], a[104:107]
  v_mfma_f32_16x16x32_bf16 a[108:111], v[168:171], v[212:215], a[108:111]
  v_mfma_f32_16x16x32_bf16 a[112:115], v[172:175], v[200:203], a[112:115]
  v_mfma_f32_16x16x32_bf16 a[116:119], v[172:175], v[204:207], a[116:119]
  v_mfma_f32_16x16x32_bf16 a[120:123], v[172:175], v[208:211], a[120:123]
  v_mfma_f32_16x16x32_bf16 a[124:127], v[172:175], v[212:215], a[124:127]
  v_mfma_f32_16x16x32_bf16 a[128:131], v[176:179], v[200:203], a[128:131]
  v_mfma_f32_16x16x32_bf16 a[132:135], v[176:179], v[204:207], a[132:135]
  v_mfma_f32_16x16x32_bf16 a[136:139], v[176:179], v[208:211], a[136:139]
  v_mfma_f32_16x16x32_bf16 a[140:143], v[176:179], v[212:215], a[140:143]
  v_mfma_f32_16x16x32_bf16 a[144:147], v[180:183], v[200:203], a[144:147]
  v_mfma_f32_16x16x32_bf16 a[148:151], v[180:183], v[204:207], a[148:151]
  v_mfma_f32_16x16x32_bf16 a[152:155], v[180:183], v[208:211], a[152:155]
  v_mfma_f32_16x16x32_bf16 a[156:159], v[180:183], v[212:215], a[156:159]
  buffer_load_dwordx4 v[144:147], v1, s[4:7], s30 offen offset:3072
  buffer_load_dwordx4 v[148:151], v1, s[4:7], s31 offen offset:3072
  buffer_load_dwordx4 v[152:155], v1, s[4:7], s32 offen offset:3072
  buffer_load_dwordx4 v[156:159], v1, s[4:7], s33 offen offset:3072
  buffer_load_dwordx4 v[160:163], v1, s[4:7], s34 offen offset:3072
  buffer_load_dwordx4 v[164:167], v1, s[4:7], s35 offen offset:3072
  buffer_load_dwordx4 v[168:171], v1, s[4:7], s36 offen offset:3072
  buffer_load_dwordx4 v[172:175], v1, s[4:7], s37 offen offset:3072
  buffer_load_dwordx4 v[176:179], v1, s[4:7], s38 offen offset:3072
  buffer_load_dwordx4 v[180:183], v1, s[4:7], s39 offen offset:3072
  s_add_u32 s30, s30, 4096
  s_add_u32 s31, s31, 4096
  s_add_u32 s32, s32, 4096
  s_add_u32 s33, s33, 4096
  s_add_u32 s34, s34, 4096
  s_add_u32 s35, s35, 4096
  s_add_u32 s36, s36, 4096
  s_add_u32 s37, s37, 4096
  s_add_u32 s38, s38, 4096
  s_add_u32 s39, s39, 4096
  s_waitcnt vmcnt(30)
  ds_read_b128 v[200:203], v1 offset:5120
  ds_read_b128 v[204:207], v1 offset:29696
  ds_read_b128 v[208:211], v6 offset:5120
  ds_read_b128 v[212:215], v6 offset:29696
  s_waitcnt lgkmcnt(4)
  v_mfma_f32_16x16x32_bf16 a[0:3], v[24:27], v[184:187], a[0:3]
  v_mfma_f32_16x16x32_bf16 a[4:7], v[24:27], v[188:191], a[4:7]
  v_mfma_f32_16x16x32_bf16 a[8:11], v[24:27], v[192:195], a[8:11]
  v_mfma_f32_16x16x32_bf16 a[12:15], v[24:27], v[196:199], a[12:15]
  v_mfma_f32_16x16x32_bf16 a[16:19], v[28:31], v[184:187], a[16:19]
  v_mfma_f32_16x16x32_bf16 a[20:23], v[28:31], v[188:191], a[20:23]
  v_mfma_f32_16x16x32_bf16 a[24:27], v[28:31], v[192:195], a[24:27]
  v_mfma_f32_16x16x32_bf16 a[28:31], v[28:31], v[196:199], a[28:31]
  v_mfma_f32_16x16x32_bf16 a[32:35], v[32:35], v[184:187], a[32:35]
  v_mfma_f32_16x16x32_bf16 a[36:39], v[32:35], v[188:191], a[36:39]
  v_mfma_f32_16x16x32_bf16 a[40:43], v[32:35], v[192:195], a[40:43]
  v_mfma_f32_16x16x32_bf16 a[44:47], v[32:35], v[196:199], a[44:47]
  v_mfma_f32_16x16x32_bf16 a[48:51], v[36:39], v[184:187], a[48:51]
  v_mfma_f32_16x16x32_bf16 a[52:55], v[36:39], v[188:191], a[52:55]
  v_mfma_f32_16x16x32_bf16 a[56:59], v[36:39], v[192:195], a[56:59]
  v_mfma_f32_16x16x32_bf16 a[60:63], v[36:39], v[196:199], a[60:63]
  v_mfma_f32_16x16x32_bf16 a[64:67], v[40:43], v[184:187], a[64:67]
  v_mfma_f32_16x16x32_bf16 a[68:71], v[40:43], v[188:191], a[68:71]
  v_mfma_f32_16x16x32_bf16 a[72:75], v[40:43], v[192:195], a[72:75]
  v_mfma_f32_16x16x32_bf16 a[76:79], v[40:43], v[196:199], a[76:79]
  v_mfma_f32_16x16x32_bf16 a[80:83], v[44:47], v[184:187], a[80:83]
  v_mfma_f32_16x16x32_bf16 a[84:87], v[44:47], v[188:191], a[84:87]
  v_mfma_f32_16x16x32_bf16 a[88:91], v[44:47], v[192:195], a[88:91]
  v_mfma_f32_16x16x32_bf16 a[92:95], v[44:47], v[196:199], a[92:95]
  v_mfma_f32_16x16x32_bf16 a[96:99], v[48:51], v[184:187], a[96:99]
  v_mfma_f32_16x16x32_bf16 a[100:103], v[48:51], v[188:191], a[100:103]
  v_mfma_f32_16x16x32_bf16 a[104:107], v[48:51], v[192:195], a[104:107]
  v_mfma_f32_16x16x32_bf16 a[108:111], v[48:51], v[196:199], a[108:111]
  v_mfma_f32_16x16x32_bf16 a[112:115], v[52:55], v[184:187], a[112:115]
  v_mfma_f32_16x16x32_bf16 a[116:119], v[52:55], v[188:191], a[116:119]
  v_mfma_f32_16x16x32_bf16 a[120:123], v[52:55], v[192:195], a[120:123]
  v_mfma_f32_16x16x32_bf16 a[124:127], v[52:55], v[196:199], a[124:127]
  v_mfma_f32_16x16x32_bf16 a[128:131], v[56:59], v[184:187], a[128:131]
  v_mfma_f32_16x16x32_bf16 a[132:135], v[56:59], v[188:191], a[132:135]
  v_mfma_f32_16x16x32_bf16 a[136:139], v[56:59], v[192:195], a[136:139]
  v_mfma_f32_16x16x32_bf16 a[140:143], v[56:59], v[196:199], a[140:143]
  v_mfma_f32_16x16x32_bf16 a[144:147], v[60:63], v[184:187], a[144:147]
  v_mfma_f32_16x16x32_bf16 a[148:151], v[60:63], v[188:191], a[148:151]
  v_mfma_f32_16x16x32_bf16 a[152:155], v[60:63], v[192:195], a[152:155]
  v_mfma_f32_16x16x32_bf16 a[156:159], v[60:63], v[196:199], a[156:159]
  buffer_load_dwordx4 v[24:27], v1, s[4:7], s30 offen offset:0
  buffer_load_dwordx4 v[28:31], v1, s[4:7], s31 offen offset:0
  buffer_load_dwordx4 v[32:35], v1, s[4:7], s32 offen offset:0
  buffer_load_dwordx4 v[36:39], v1, s[4:7], s33 offen offset:0
  buffer_load_dwordx4 v[40:43], v1, s[4:7], s34 offen offset:0
  buffer_load_dwordx4 v[44:47], v1, s[4:7], s35 offen offset:0
  buffer_load_dwordx4 v[48:51], v1, s[4:7], s36 offen offset:0
  buffer_load_dwordx4 v[52:55], v1, s[4:7], s37 offen offset:0
  buffer_load_dwordx4 v[56:59], v1, s[4:7], s38 offen offset:0
  buffer_load_dwordx4 v[60:63], v1, s[4:7], s39 offen offset:0
  s_waitcnt vmcnt(30)
  ds_read_b128 v[184:187], v1 offset:6144
  ds_read_b128 v[188:191], v1 offset:30720
  ds_read_b128 v[192:195], v6 offset:6144
  ds_read_b128 v[196:199], v6 offset:30720
  s_waitcnt lgkmcnt(4)
  v_mfma_f32_16x16x32_bf16 a[0:3], v[64:67], v[200:203], a[0:3]
  v_mfma_f32_16x16x32_bf16 a[4:7], v[64:67], v[204:207], a[4:7]
  v_mfma_f32_16x16x32_bf16 a[8:11], v[64:67], v[208:211], a[8:11]
  v_mfma_f32_16x16x32_bf16 a[12:15], v[64:67], v[212:215], a[12:15]
  v_mfma_f32_16x16x32_bf16 a[16:19], v[68:71], v[200:203], a[16:19]
  v_mfma_f32_16x16x32_bf16 a[20:23], v[68:71], v[204:207], a[20:23]
  v_mfma_f32_16x16x32_bf16 a[24:27], v[68:71], v[208:211], a[24:27]
  v_mfma_f32_16x16x32_bf16 a[28:31], v[68:71], v[212:215], a[28:31]
  v_mfma_f32_16x16x32_bf16 a[32:35], v[72:75], v[200:203], a[32:35]
  v_mfma_f32_16x16x32_bf16 a[36:39], v[72:75], v[204:207], a[36:39]
  v_mfma_f32_16x16x32_bf16 a[40:43], v[72:75], v[208:211], a[40:43]
  v_mfma_f32_16x16x32_bf16 a[44:47], v[72:75], v[212:215], a[44:47]
  v_mfma_f32_16x16x32_bf16 a[48:51], v[76:79], v[200:203], a[48:51]
  v_mfma_f32_16x16x32_bf16 a[52:55], v[76:79], v[204:207], a[52:55]
  v_mfma_f32_16x16x32_bf16 a[56:59], v[76:79], v[208:211], a[56:59]
  v_mfma_f32_16x16x32_bf16 a[60:63], v[76:79], v[212:215], a[60:63]
  v_mfma_f32_16x16x32_bf16 a[64:67], v[80:83], v[200:203], a[64:67]
  v_mfma_f32_16x16x32_bf16 a[68:71], v[80:83], v[204:207], a[68:71]
  v_mfma_f32_16x16x32_bf16 a[72:75], v[80:83], v[208:211], a[72:75]
  v_mfma_f32_16x16x32_bf16 a[76:79], v[80:83], v[212:215], a[76:79]
  v_mfma_f32_16x16x32_bf16 a[80:83], v[84:87], v[200:203], a[80:83]
  v_mfma_f32_16x16x32_bf16 a[84:87], v[84:87], v[204:207], a[84:87]
  v_mfma_f32_16x16x32_bf16 a[88:91], v[84:87], v[208:211], a[88:91]
  v_mfma_f32_16x16x32_bf16 a[92:95], v[84:87], v[212:215], a[92:95]
  v_mfma_f32_16x16x32_bf16 a[96:99], v[88:91], v[200:203], a[96:99]
  v_mfma_f32_16x16x32_bf16 a[100:103], v[88:91], v[204:207], a[100:103]
  v_mfma_f32_16x16x32_bf16 a[104:107], v[88:91], v[208:211], a[104:107]
  v_mfma_f32_16x16x32_bf16 a[108:111], v[88:91], v[212:215], a[108:111]
  v_mfma_f32_16x16x32_bf16 a[112:115], v[92:95], v[200:203], a[112:115]
  v_mfma_f32_16x16x32_bf16 a[116:119], v[92:95], v[204:207], a[116:119]
  v_mfma_f32_16x16x32_bf16 a[120:123], v[92:95], v[208:211], a[120:123]
  v_mfma_f32_16x16x32_bf16 a[124:127], v[92:95], v[212:215], a[124:127]
  v_mfma_f32_16x16x32_bf16 a[128:131], v[96:99], v[200:203], a[128:131]
  v_mfma_f32_16x16x32_bf16 a[132:135], v[96:99], v[204:207], a[132:135]
  v_mfma_f32_16x16x32_bf16 a[136:139], v[96:99], v[208:211], a[136:139]
  v_mfma_f32_16x16x32_bf16 a[140:143], v[96:99], v[212:215], a[140:143]
  v_mfma_f32_16x16x32_bf16 a[144:147], v[100:103], v[200:203], a[144:147]
  v_mfma_f32_16x16x32_bf16 a[148:151], v[100:103], v[204:207], a[148:151]
  v_mfma_f32_16x16x32_bf16 a[152:155], v[100:103], v[208:211], a[152:155]
  v_mfma_f32_16x16x32_bf16 a[156:159], v[100:103], v[212:215], a[156:159]
  buffer_load_dwordx4 v[64:67], v1, s[4:7], s30 offen offset:1024
  buffer_load_dwordx4 v[68:71], v1, s[4:7], s31 offen offset:1024
  buffer_load_dwordx4 v[72:75], v1, s[4:7], s32 offen offset:1024
  buffer_load_dwordx4 v[76:79], v1, s[4:7], s33 offen offset:1024
  buffer_load_dwordx4 v[80:83], v1, s[4:7], s34 offen offset:1024
  buffer_load_dwordx4 v[84:87], v1, s[4:7], s35 offen offset:1024
  buffer_load_dwordx4 v[88:91], v1, s[4:7], s36 offen offset:1024
  buffer_load_dwordx4 v[92:95], v1, s[4:7], s37 offen offset:1024
  buffer_load_dwordx4 v[96:99], v1, s[4:7], s38 offen offset:1024
  buffer_load_dwordx4 v[100:103], v1, s[4:7], s39 offen offset:1024
  s_waitcnt vmcnt(30)
  ds_read_b128 v[200:203], v1 offset:7168
  ds_read_b128 v[204:207], v1 offset:31744
  ds_read_b128 v[208:211], v6 offset:7168
  ds_read_b128 v[212:215], v6 offset:31744
  s_waitcnt lgkmcnt(4)
  v_mfma_f32_16x16x32_bf16 a[0:3], v[104:107], v[184:187], a[0:3]
  v_mfma_f32_16x16x32_bf16 a[4:7], v[104:107], v[188:191], a[4:7]
  v_mfma_f32_16x16x32_bf16 a[8:11], v[104:107], v[192:195], a[8:11]
  v_mfma_f32_16x16x32_bf16 a[12:15], v[104:107], v[196:199], a[12:15]
  v_mfma_f32_16x16x32_bf16 a[16:19], v[108:111], v[184:187], a[16:19]
  v_mfma_f32_16x16x32_bf16 a[20:23], v[108:111], v[188:191], a[20:23]
  v_mfma_f32_16x16x32_bf16 a[24:27], v[108:111], v[192:195], a[24:27]
  v_mfma_f32_16x16x32_bf16 a[28:31], v[108:111], v[196:199], a[28:31]
  v_mfma_f32_16x16x32_bf16 a[32:35], v[112:115], v[184:187], a[32:35]
  v_mfma_f32_16x16x32_bf16 a[36:39], v[112:115], v[188:191], a[36:39]
  v_mfma_f32_16x16x32_bf16 a[40:43], v[112:115], v[192:195], a[40:43]
  v_mfma_f32_16x16x32_bf16 a[44:47], v[112:115], v[196:199], a[44:47]
  v_mfma_f32_16x16x32_bf16 a[48:51], v[116:119], v[184:187], a[48:51]
  v_mfma_f32_16x16x32_bf16 a[52:55], v[116:119], v[188:191], a[52:55]
  v_mfma_f32_16x16x32_bf16 a[56:59], v[116:119], v[192:195], a[56:59]
  v_mfma_f32_16x16x32_bf16 a[60:63], v[116:119], v[196:199], a[60:63]
  v_mfma_f32_16x16x32_bf16 a[64:67], v[120:123], v[184:187], a[64:67]
  v_mfma_f32_16x16x32_bf16 a[68:71], v[120:123], v[188:191], a[68:71]
  v_mfma_f32_16x16x32_bf16 a[72:75], v[120:123], v[192:195], a[72:75]
  v_mfma_f32_16x16x32_bf16 a[76:79], v[120:123], v[196:199], a[76:79]
  v_mfma_f32_16x16x32_bf16 a[80:83], v[124:127], v[184:187], a[80:83]
  v_mfma_f32_16x16x32_bf16 a[84:87], v[124:127], v[188:191], a[84:87]
  v_mfma_f32_16x16x32_bf16 a[88:91], v[124:127], v[192:195], a[88:91]
  v_mfma_f32_16x16x32_bf16 a[92:95], v[124:127], v[196:199], a[92:95]
  v_mfma_f32_16x16x32_bf16 a[96:99], v[128:131], v[184:187], a[96:99]
  v_mfma_f32_16x16x32_bf16 a[100:103], v[128:131], v[188:191], a[100:103]
  v_mfma_f32_16x16x32_bf16 a[104:107], v[128:131], v[192:195], a[104:107]
  v_mfma_f32_16x16x32_bf16 a[108:111], v[128:131], v[196:199], a[108:111]
  v_mfma_f32_16x16x32_bf16 a[112:115], v[132:135], v[184:187], a[112:115]
  v_mfma_f32_16x16x32_bf16 a[116:119], v[132:135], v[188:191], a[116:119]
  v_mfma_f32_16x16x32_bf16 a[120:123], v[132:135], v[192:195], a[120:123]
  v_mfma_f32_16x16x32_bf16 a[124:127], v[132:135], v[196:199], a[124:127]
  v_mfma_f32_16x16x32_bf16 a[128:131], v[136:139], v[184:187], a[128:131]
  v_mfma_f32_16x16x32_bf16 a[132:135], v[136:139], v[188:191], a[132:135]
  v_mfma_f32_16x16x32_bf16 a[136:139], v[136:139], v[192:195], a[136:139]
  v_mfma_f32_16x16x32_bf16 a[140:143], v[136:139], v[196:199], a[140:143]
  v_mfma_f32_16x16x32_bf16 a[144:147], v[140:143], v[184:187], a[144:147]
  v_mfma_f32_16x16x32_bf16 a[148:151], v[140:143], v[188:191], a[148:151]
  v_mfma_f32_16x16x32_bf16 a[152:155], v[140:143], v[192:195], a[152:155]
  v_mfma_f32_16x16x32_bf16 a[156:159], v[140:143], v[196:199], a[156:159]
  buffer_load_dwordx4 v[104:107], v1, s[4:7], s30 offen offset:2048
  buffer_load_dwordx4 v[108:111], v1, s[4:7], s31 offen offset:2048
  buffer_load_dwordx4 v[112:115], v1, s[4:7], s32 offen offset:2048
  buffer_load_dwordx4 v[116:119], v1, s[4:7], s33 offen offset:2048
  buffer_load_dwordx4 v[120:123], v1, s[4:7], s34 offen offset:2048
  buffer_load_dwordx4 v[124:127], v1, s[4:7], s35 offen offset:2048
  buffer_load_dwordx4 v[128:131], v1, s[4:7], s36 offen offset:2048
  buffer_load_dwordx4 v[132:135], v1, s[4:7], s37 offen offset:2048
  buffer_load_dwordx4 v[136:139], v1, s[4:7], s38 offen offset:2048
  buffer_load_dwordx4 v[140:143], v1, s[4:7], s39 offen offset:2048
  s_waitcnt vmcnt(30)
  ds_read_b128 v[184:187], v1 offset:8192
  ds_read_b128 v[188:191], v1 offset:32768
  ds_read_b128 v[192:195], v6 offset:8192
  ds_read_b128 v[196:199], v6 offset:32768
  s_waitcnt lgkmcnt(4)
  v_mfma_f32_16x16x32_bf16 a[0:3], v[144:147], v[200:203], a[0:3]
  v_mfma_f32_16x16x32_bf16 a[4:7], v[144:147], v[204:207], a[4:7]
  v_mfma_f32_16x16x32_bf16 a[8:11], v[144:147], v[208:211], a[8:11]
  v_mfma_f32_16x16x32_bf16 a[12:15], v[144:147], v[212:215], a[12:15]
  v_mfma_f32_16x16x32_bf16 a[16:19], v[148:151], v[200:203], a[16:19]
  v_mfma_f32_16x16x32_bf16 a[20:23], v[148:151], v[204:207], a[20:23]
  v_mfma_f32_16x16x32_bf16 a[24:27], v[148:151], v[208:211], a[24:27]
  v_mfma_f32_16x16x32_bf16 a[28:31], v[148:151], v[212:215], a[28:31]
  v_mfma_f32_16x16x32_bf16 a[32:35], v[152:155], v[200:203], a[32:35]
  v_mfma_f32_16x16x32_bf16 a[36:39], v[152:155], v[204:207], a[36:39]
  v_mfma_f32_16x16x32_bf16 a[40:43], v[152:155], v[208:211], a[40:43]
  v_mfma_f32_16x16x32_bf16 a[44:47], v[152:155], v[212:215], a[44:47]
  v_mfma_f32_16x16x32_bf16 a[48:51], v[156:159], v[200:203], a[48:51]
  v_mfma_f32_16x16x32_bf16 a[52:55], v[156:159], v[204:207], a[52:55]
  v_mfma_f32_16x16x32_bf16 a[56:59], v[156:159], v[208:211], a[56:59]
  v_mfma_f32_16x16x32_bf16 a[60:63], v[156:159], v[212:215], a[60:63]
  v_mfma_f32_16x16x32_bf16 a[64:67], v[160:163], v[200:203], a[64:67]
  v_mfma_f32_16x16x32_bf16 a[68:71], v[160:163], v[204:207], a[68:71]
  v_mfma_f32_16x16x32_bf16 a[72:75], v[160:163], v[208:211], a[72:75]
  v_mfma_f32_16x16x32_bf16 a[76:79], v[160:163], v[212:215], a[76:79]
  v_mfma_f32_16x16x32_bf16 a[80:83], v[164:167], v[200:203], a[80:83]
  v_mfma_f32_16x16x32_bf16 a[84:87], v[164:167], v[204:207], a[84:87]
  v_mfma_f32_16x16x32_bf16 a[88:91], v[164:167], v[208:211], a[88:91]
  v_mfma_f32_16x16x32_bf16 a[92:95], v[164:167], v[212:215], a[92:95]
  v_mfma_f32_16x16x32_bf16 a[96:99], v[168:171], v[200:203], a[96:99]
  v_mfma_f32_16x16x32_bf16 a[100:103], v[168:171], v[204:207], a[100:103]
  v_mfma_f32_16x16x32_bf16 a[104:107], v[168:171], v[208:211], a[104:107]
  v_mfma_f32_16x16x32_bf16 a[108:111], v[168:171], v[212:215], a[108:111]
  v_mfma_f32_16x16x32_bf16 a[112:115], v[172:175], v[200:203], a[112:115]
  v_mfma_f32_16x16x32_bf16 a[116:119], v[172:175], v[204:207], a[116:119]
  v_mfma_f32_16x16x32_bf16 a[120:123], v[172:175], v[208:211], a[120:123]
  v_mfma_f32_16x16x32_bf16 a[124:127], v[172:175], v[212:215], a[124:127]
  v_mfma_f32_16x16x32_bf16 a[128:131], v[176:179], v[200:203], a[128:131]
  v_mfma_f32_16x16x32_bf16 a[132:135], v[176:179], v[204:207], a[132:135]
  v_mfma_f32_16x16x32_bf16 a[136:139], v[176:179], v[208:211], a[136:139]
  v_mfma_f32_16x16x32_bf16 a[140:143], v[176:179], v[212:215], a[140:143]
  v_mfma_f32_16x16x32_bf16 a[144:147], v[180:183], v[200:203], a[144:147]
  v_mfma_f32_16x16x32_bf16 a[148:151], v[180:183], v[204:207], a[148:151]
  v_mfma_f32_16x16x32_bf16 a[152:155], v[180:183], v[208:211], a[152:155]
  v_mfma_f32_16x16x32_bf16 a[156:159], v[180:183], v[212:215], a[156:159]
  buffer_load_dwordx4 v[144:147], v1, s[4:7], s30 offen offset:3072
  buffer_load_dwordx4 v[148:151], v1, s[4:7], s31 offen offset:3072
  buffer_load_dwordx4 v[152:155], v1, s[4:7], s32 offen offset:3072
  buffer_load_dwordx4 v[156:159], v1, s[4:7], s33 offen offset:3072
  buffer_load_dwordx4 v[160:163], v1, s[4:7], s34 offen offset:3072
  buffer_load_dwordx4 v[164:167], v1, s[4:7], s35 offen offset:3072
  buffer_load_dwordx4 v[168:171], v1, s[4:7], s36 offen offset:3072
  buffer_load_dwordx4 v[172:175], v1, s[4:7], s37 offen offset:3072
  buffer_load_dwordx4 v[176:179], v1, s[4:7], s38 offen offset:3072
  buffer_load_dwordx4 v[180:183], v1, s[4:7], s39 offen offset:3072
  s_add_u32 s30, s30, 4096
  s_add_u32 s31, s31, 4096
  s_add_u32 s32, s32, 4096
  s_add_u32 s33, s33, 4096
  s_add_u32 s34, s34, 4096
  s_add_u32 s35, s35, 4096
  s_add_u32 s36, s36, 4096
  s_add_u32 s37, s37, 4096
  s_add_u32 s38, s38, 4096
  s_add_u32 s39, s39, 4096
  s_waitcnt vmcnt(30)
  ds_read_b128 v[200:203], v1 offset:9216
  ds_read_b128 v[204:207], v1 offset:33792
  ds_read_b128 v[208:211], v6 offset:9216
  ds_read_b128 v[212:215], v6 offset:33792
  s_waitcnt lgkmcnt(4)
  v_mfma_f32_16x16x32_bf16 a[0:3], v[24:27], v[184:187], a[0:3]
  v_mfma_f32_16x16x32_bf16 a[4:7], v[24:27], v[188:191], a[4:7]
  v_mfma_f32_16x16x32_bf16 a[8:11], v[24:27], v[192:195], a[8:11]
  v_mfma_f32_16x16x32_bf16 a[12:15], v[24:27], v[196:199], a[12:15]
  v_mfma_f32_16x16x32_bf16 a[16:19], v[28:31], v[184:187], a[16:19]
  v_mfma_f32_16x16x32_bf16 a[20:23], v[28:31], v[188:191], a[20:23]
  v_mfma_f32_16x16x32_bf16 a[24:27], v[28:31], v[192:195], a[24:27]
  v_mfma_f32_16x16x32_bf16 a[28:31], v[28:31], v[196:199], a[28:31]
  v_mfma_f32_16x16x32_bf16 a[32:35], v[32:35], v[184:187], a[32:35]
  v_mfma_f32_16x16x32_bf16 a[36:39], v[32:35], v[188:191], a[36:39]
  v_mfma_f32_16x16x32_bf16 a[40:43], v[32:35], v[192:195], a[40:43]
  v_mfma_f32_16x16x32_bf16 a[44:47], v[32:35], v[196:199], a[44:47]
  v_mfma_f32_16x16x32_bf16 a[48:51], v[36:39], v[184:187], a[48:51]
  v_mfma_f32_16x16x32_bf16 a[52:55], v[36:39], v[188:191], a[52:55]
  v_mfma_f32_16x16x32_bf16 a[56:59], v[36:39], v[192:195], a[56:59]
  v_mfma_f32_16x16x32_bf16 a[60:63], v[36:39], v[196:199], a[60:63]
  v_mfma_f32_16x16x32_bf16 a[64:67], v[40:43], v[184:187], a[64:67]
  v_mfma_f32_16x16x32_bf16 a[68:71], v[40:43], v[188:191], a[68:71]
  v_mfma_f32_16x16x32_bf16 a[72:75], v[40:43], v[192:195], a[72:75]
  v_mfma_f32_16x16x32_bf16 a[76:79], v[40:43], v[196:199], a[76:79]
  v_mfma_f32_16x16x32_bf16 a[80:83], v[44:47], v[184:187], a[80:83]
  v_mfma_f32_16x16x32_bf16 a[84:87], v[44:47], v[188:191], a[84:87]
  v_mfma_f32_16x16x32_bf16 a[88:91], v[44:47], v[192:195], a[88:91]
  v_mfma_f32_16x16x32_bf16 a[92:95], v[44:47], v[196:199], a[92:95]
  v_mfma_f32_16x16x32_bf16 a[96:99], v[48:51], v[184:187], a[96:99]
  v_mfma_f32_16x16x32_bf16 a[100:103], v[48:51], v[188:191], a[100:103]
  v_mfma_f32_16x16x32_bf16 a[104:107], v[48:51], v[192:195], a[104:107]
  v_mfma_f32_16x16x32_bf16 a[108:111], v[48:51], v[196:199], a[108:111]
  v_mfma_f32_16x16x32_bf16 a[112:115], v[52:55], v[184:187], a[112:115]
  v_mfma_f32_16x16x32_bf16 a[116:119], v[52:55], v[188:191], a[116:119]
  v_mfma_f32_16x16x32_bf16 a[120:123], v[52:55], v[192:195], a[120:123]
  v_mfma_f32_16x16x32_bf16 a[124:127], v[52:55], v[196:199], a[124:127]
  v_mfma_f32_16x16x32_bf16 a[128:131], v[56:59], v[184:187], a[128:131]
  v_mfma_f32_16x16x32_bf16 a[132:135], v[56:59], v[188:191], a[132:135]
  v_mfma_f32_16x16x32_bf16 a[136:139], v[56:59], v[192:195], a[136:139]
  v_mfma_f32_16x16x32_bf16 a[140:143], v[56:59], v[196:199], a[140:143]
  v_mfma_f32_16x16x32_bf16 a[144:147], v[60:63], v[184:187], a[144:147]
  v_mfma_f32_16x16x32_bf16 a[148:151], v[60:63], v[188:191], a[148:151]
  v_mfma_f32_16x16x32_bf16 a[152:155], v[60:63], v[192:195], a[152:155]
  v_mfma_f32_16x16x32_bf16 a[156:159], v[60:63], v[196:199], a[156:159]
  buffer_load_dwordx4 v[24:27], v1, s[4:7], s30 offen offset:0
  buffer_load_dwordx4 v[28:31], v1, s[4:7], s31 offen offset:0
  buffer_load_dwordx4 v[32:35], v1, s[4:7], s32 offen offset:0
  buffer_load_dwordx4 v[36:39], v1, s[4:7], s33 offen offset:0
  buffer_load_dwordx4 v[40:43], v1, s[4:7], s34 offen offset:0
  buffer_load_dwordx4 v[44:47], v1, s[4:7], s35 offen offset:0
  buffer_load_dwordx4 v[48:51], v1, s[4:7], s36 offen offset:0
  buffer_load_dwordx4 v[52:55], v1, s[4:7], s37 offen offset:0
  buffer_load_dwordx4 v[56:59], v1, s[4:7], s38 offen offset:0
  buffer_load_dwordx4 v[60:63], v1, s[4:7], s39 offen offset:0
  s_waitcnt vmcnt(30)
  ds_read_b128 v[184:187], v1 offset:10240
  ds_read_b128 v[188:191], v1 offset:34816
  ds_read_b128 v[192:195], v6 offset:10240
  ds_read_b128 v[196:199], v6 offset:34816
  s_waitcnt lgkmcnt(4)
  v_mfma_f32_16x16x32_bf16 a[0:3], v[64:67], v[200:203], a[0:3]
  v_mfma_f32_16x16x32_bf16 a[4:7], v[64:67], v[204:207], a[4:7]
  v_mfma_f32_16x16x32_bf16 a[8:11], v[64:67], v[208:211], a[8:11]
  v_mfma_f32_16x16x32_bf16 a[12:15], v[64:67], v[212:215], a[12:15]
  v_mfma_f32_16x16x32_bf16 a[16:19], v[68:71], v[200:203], a[16:19]
  v_mfma_f32_16x16x32_bf16 a[20:23], v[68:71], v[204:207], a[20:23]
  v_mfma_f32_16x16x32_bf16 a[24:27], v[68:71], v[208:211], a[24:27]
  v_mfma_f32_16x16x32_bf16 a[28:31], v[68:71], v[212:215], a[28:31]
  v_mfma_f32_16x16x32_bf16 a[32:35], v[72:75], v[200:203], a[32:35]
  v_mfma_f32_16x16x32_bf16 a[36:39], v[72:75], v[204:207], a[36:39]
  v_mfma_f32_16x16x32_bf16 a[40:43], v[72:75], v[208:211], a[40:43]
  v_mfma_f32_16x16x32_bf16 a[44:47], v[72:75], v[212:215], a[44:47]
  v_mfma_f32_16x16x32_bf16 a[48:51], v[76:79], v[200:203], a[48:51]
  v_mfma_f32_16x16x32_bf16 a[52:55], v[76:79], v[204:207], a[52:55]
  v_mfma_f32_16x16x32_bf16 a[56:59], v[76:79], v[208:211], a[56:59]
  v_mfma_f32_16x16x32_bf16 a[60:63], v[76:79], v[212:215], a[60:63]
  v_mfma_f32_16x16x32_bf16 a[64:67], v[80:83], v[200:203], a[64:67]
  v_mfma_f32_16x16x32_bf16 a[68:71], v[80:83], v[204:207], a[68:71]
  v_mfma_f32_16x16x32_bf16 a[72:75], v[80:83], v[208:211], a[72:75]
  v_mfma_f32_16x16x32_bf16 a[76:79], v[80:83], v[212:215], a[76:79]
  v_mfma_f32_16x16x32_bf16 a[80:83], v[84:87], v[200:203], a[80:83]
  v_mfma_f32_16x16x32_bf16 a[84:87], v[84:87], v[204:207], a[84:87]
  v_mfma_f32_16x16x32_bf16 a[88:91], v[84:87], v[208:211], a[88:91]
  v_mfma_f32_16x16x32_bf16 a[92:95], v[84:87], v[212:215], a[92:95]
  v_mfma_f32_16x16x32_bf16 a[96:99], v[88:91], v[200:203], a[96:99]
  v_mfma_f32_16x16x32_bf16 a[100:103], v[88:91], v[204:207], a[100:103]
  v_mfma_f32_16x16x32_bf16 a[104:107], v[88:91], v[208:211], a[104:107]
  v_mfma_f32_16x16x32_bf16 a[108:111], v[88:91], v[212:215], a[108:111]
  v_mfma_f32_16x16x32_bf16 a[112:115], v[92:95], v[200:203], a[112:115]
  v_mfma_f32_16x16x32_bf16 a[116:119], v[92:95], v[204:207], a[116:119]
  v_mfma_f32_16x16x32_bf16 a[120:123], v[92:95], v[208:211], a[120:123]
  v_mfma_f32_16x16x32_bf16 a[124:127], v[92:95], v[212:215], a[124:127]
  v_mfma_f32_16x16x32_bf16 a[128:131], v[96:99], v[200:203], a[128:131]
  v_mfma_f32_16x16x32_bf16 a[132:135], v[96:99], v[204:207], a[132:135]
  v_mfma_f32_16x16x32_bf16 a[136:139], v[96:99], v[208:211], a[136:139]
  v_mfma_f32_16x16x32_bf16 a[140:143], v[96:99], v[212:215], a[140:143]
  v_mfma_f32_16x16x32_bf16 a[144:147], v[100:103], v[200:203], a[144:147]
  v_mfma_f32_16x16x32_bf16 a[148:151], v[100:103], v[204:207], a[148:151]
  v_mfma_f32_16x16x32_bf16 a[152:155], v[100:103], v[208:211], a[152:155]
  v_mfma_f32_16x16x32_bf16 a[156:159], v[100:103], v[212:215], a[156:159]
  buffer_load_dwordx4 v[64:67], v1, s[4:7], s30 offen offset:1024
  buffer_load_dwordx4 v[68:71], v1, s[4:7], s31 offen offset:1024
  buffer_load_dwordx4 v[72:75], v1, s[4:7], s32 offen offset:1024
  buffer_load_dwordx4 v[76:79], v1, s[4:7], s33 offen offset:1024
  buffer_load_dwordx4 v[80:83], v1, s[4:7], s34 offen offset:1024
  buffer_load_dwordx4 v[84:87], v1, s[4:7], s35 offen offset:1024
  buffer_load_dwordx4 v[88:91], v1, s[4:7], s36 offen offset:1024
  buffer_load_dwordx4 v[92:95], v1, s[4:7], s37 offen offset:1024
  buffer_load_dwordx4 v[96:99], v1, s[4:7], s38 offen offset:1024
  buffer_load_dwordx4 v[100:103], v1, s[4:7], s39 offen offset:1024
  s_waitcnt vmcnt(30)
  ds_read_b128 v[200:203], v1 offset:11264
  ds_read_b128 v[204:207], v1 offset:35840
  ds_read_b128 v[208:211], v6 offset:11264
  ds_read_b128 v[212:215], v6 offset:35840
  s_waitcnt lgkmcnt(4)
  v_mfma_f32_16x16x32_bf16 a[0:3], v[104:107], v[184:187], a[0:3]
  v_mfma_f32_16x16x32_bf16 a[4:7], v[104:107], v[188:191], a[4:7]
  v_mfma_f32_16x16x32_bf16 a[8:11], v[104:107], v[192:195], a[8:11]
  v_mfma_f32_16x16x32_bf16 a[12:15], v[104:107], v[196:199], a[12:15]
  v_mfma_f32_16x16x32_bf16 a[16:19], v[108:111], v[184:187], a[16:19]
  v_mfma_f32_16x16x32_bf16 a[20:23], v[108:111], v[188:191], a[20:23]
  v_mfma_f32_16x16x32_bf16 a[24:27], v[108:111], v[192:195], a[24:27]
  v_mfma_f32_16x16x32_bf16 a[28:31], v[108:111], v[196:199], a[28:31]
  v_mfma_f32_16x16x32_bf16 a[32:35], v[112:115], v[184:187], a[32:35]
  v_mfma_f32_16x16x32_bf16 a[36:39], v[112:115], v[188:191], a[36:39]
  v_mfma_f32_16x16x32_bf16 a[40:43], v[112:115], v[192:195], a[40:43]
  v_mfma_f32_16x16x32_bf16 a[44:47], v[112:115], v[196:199], a[44:47]
  v_mfma_f32_16x16x32_bf16 a[48:51], v[116:119], v[184:187], a[48:51]
  v_mfma_f32_16x16x32_bf16 a[52:55], v[116:119], v[188:191], a[52:55]
  v_mfma_f32_16x16x32_bf16 a[56:59], v[116:119], v[192:195], a[56:59]
  v_mfma_f32_16x16x32_bf16 a[60:63], v[116:119], v[196:199], a[60:63]
  v_mfma_f32_16x16x32_bf16 a[64:67], v[120:123], v[184:187], a[64:67]
  v_mfma_f32_16x16x32_bf16 a[68:71], v[120:123], v[188:191], a[68:71]
  v_mfma_f32_16x16x32_bf16 a[72:75], v[120:123], v[192:195], a[72:75]
  v_mfma_f32_16x16x32_bf16 a[76:79], v[120:123], v[196:199], a[76:79]
  v_mfma_f32_16x16x32_bf16 a[80:83], v[124:127], v[184:187], a[80:83]
  v_mfma_f32_16x16x32_bf16 a[84:87], v[124:127], v[188:191], a[84:87]
  v_mfma_f32_16x16x32_bf16 a[88:91], v[124:127], v[192:195], a[88:91]
  v_mfma_f32_16x16x32_bf16 a[92:95], v[124:127], v[196:199], a[92:95]
  v_mfma_f32_16x16x32_bf16 a[96:99], v[128:131], v[184:187], a[96:99]
  v_mfma_f32_16x16x32_bf16 a[100:103], v[128:131], v[188:191], a[100:103]
  v_mfma_f32_16x16x32_bf16 a[104:107], v[128:131], v[192:195], a[104:107]
  v_mfma_f32_16x16x32_bf16 a[108:111], v[128:131], v[196:199], a[108:111]
  v_mfma_f32_16x16x32_bf16 a[112:115], v[132:135], v[184:187], a[112:115]
  v_mfma_f32_16x16x32_bf16 a[116:119], v[132:135], v[188:191], a[116:119]
  v_mfma_f32_16x16x32_bf16 a[120:123], v[132:135], v[192:195], a[120:123]
  v_mfma_f32_16x16x32_bf16 a[124:127], v[132:135], v[196:199], a[124:127]
  v_mfma_f32_16x16x32_bf16 a[128:131], v[136:139], v[184:187], a[128:131]
  v_mfma_f32_16x16x32_bf16 a[132:135], v[136:139], v[188:191], a[132:135]
  v_mfma_f32_16x16x32_bf16 a[136:139], v[136:139], v[192:195], a[136:139]
  v_mfma_f32_16x16x32_bf16 a[140:143], v[136:139], v[196:199], a[140:143]
  v_mfma_f32_16x16x32_bf16 a[144:147], v[140:143], v[184:187], a[144:147]
  v_mfma_f32_16x16x32_bf16 a[148:151], v[140:143], v[188:191], a[148:151]
  v_mfma_f32_16x16x32_bf16 a[152:155], v[140:143], v[192:195], a[152:155]
  v_mfma_f32_16x16x32_bf16 a[156:159], v[140:143], v[196:199], a[156:159]
  buffer_load_dwordx4 v[104:107], v1, s[4:7], s30 offen offset:2048
  buffer_load_dwordx4 v[108:111], v1, s[4:7], s31 offen offset:2048
  buffer_load_dwordx4 v[112:115], v1, s[4:7], s32 offen offset:2048
  buffer_load_dwordx4 v[116:119], v1, s[4:7], s33 offen offset:2048
  buffer_load_dwordx4 v[120:123], v1, s[4:7], s34 offen offset:2048
  buffer_load_dwordx4 v[124:127], v1, s[4:7], s35 offen offset:2048
  buffer_load_dwordx4 v[128:131], v1, s[4:7], s36 offen offset:2048
  buffer_load_dwordx4 v[132:135], v1, s[4:7], s37 offen offset:2048
  buffer_load_dwordx4 v[136:139], v1, s[4:7], s38 offen offset:2048
  buffer_load_dwordx4 v[140:143], v1, s[4:7], s39 offen offset:2048
  s_waitcnt vmcnt(30)
  ds_read_b128 v[184:187], v1 offset:12288
  ds_read_b128 v[188:191], v1 offset:36864
  ds_read_b128 v[192:195], v6 offset:12288
  ds_read_b128 v[196:199], v6 offset:36864
  s_waitcnt lgkmcnt(4)
  v_mfma_f32_16x16x32_bf16 a[0:3], v[144:147], v[200:203], a[0:3]
  v_mfma_f32_16x16x32_bf16 a[4:7], v[144:147], v[204:207], a[4:7]
  v_mfma_f32_16x16x32_bf16 a[8:11], v[144:147], v[208:211], a[8:11]
  v_mfma_f32_16x16x32_bf16 a[12:15], v[144:147], v[212:215], a[12:15]
  v_mfma_f32_16x16x32_bf16 a[16:19], v[148:151], v[200:203], a[16:19]
  v_mfma_f32_16x16x32_bf16 a[20:23], v[148:151], v[204:207], a[20:23]
  v_mfma_f32_16x16x32_bf16 a[24:27], v[148:151], v[208:211], a[24:27]
  v_mfma_f32_16x16x32_bf16 a[28:31], v[148:151], v[212:215], a[28:31]
  v_mfma_f32_16x16x32_bf16 a[32:35], v[152:155], v[200:203], a[32:35]
  v_mfma_f32_16x16x32_bf16 a[36:39], v[152:155], v[204:207], a[36:39]
  v_mfma_f32_16x16x32_bf16 a[40:43], v[152:155], v[208:211], a[40:43]
  v_mfma_f32_16x16x32_bf16 a[44:47], v[152:155], v[212:215], a[44:47]
  v_mfma_f32_16x16x32_bf16 a[48:51], v[156:159], v[200:203], a[48:51]
  v_mfma_f32_16x16x32_bf16 a[52:55], v[156:159], v[204:207], a[52:55]
  v_mfma_f32_16x16x32_bf16 a[56:59], v[156:159], v[208:211], a[56:59]
  v_mfma_f32_16x16x32_bf16 a[60:63], v[156:159], v[212:215], a[60:63]
  v_mfma_f32_16x16x32_bf16 a[64:67], v[160:163], v[200:203], a[64:67]
  v_mfma_f32_16x16x32_bf16 a[68:71], v[160:163], v[204:207], a[68:71]
  v_mfma_f32_16x16x32_bf16 a[72:75], v[160:163], v[208:211], a[72:75]
  v_mfma_f32_16x16x32_bf16 a[76:79], v[160:163], v[212:215], a[76:79]
  v_mfma_f32_16x16x32_bf16 a[80:83], v[164:167], v[200:203], a[80:83]
  v_mfma_f32_16x16x32_bf16 a[84:87], v[164:167], v[204:207], a[84:87]
  v_mfma_f32_16x16x32_bf16 a[88:91], v[164:167], v[208:211], a[88:91]
  v_mfma_f32_16x16x32_bf16 a[92:95], v[164:167], v[212:215], a[92:95]
  v_mfma_f32_16x16x32_bf16 a[96:99], v[168:171], v[200:203], a[96:99]
  v_mfma_f32_16x16x32_bf16 a[100:103], v[168:171], v[204:207], a[100:103]
  v_mfma_f32_16x16x32_bf16 a[104:107], v[168:171], v[208:211], a[104:107]
  v_mfma_f32_16x16x32_bf16 a[108:111], v[168:171], v[212:215], a[108:111]
  v_mfma_f32_16x16x32_bf16 a[112:115], v[172:175], v[200:203], a[112:115]
  v_mfma_f32_16x16x32_bf16 a[116:119], v[172:175], v[204:207], a[116:119]
  v_mfma_f32_16x16x32_bf16 a[120:123], v[172:175], v[208:211], a[120:123]
  v_mfma_f32_16x16x32_bf16 a[124:127], v[172:175], v[212:215], a[124:127]
  v_mfma_f32_16x16x32_bf16 a[128:131], v[176:179], v[200:203], a[128:131]
  v_mfma_f32_16x16x32_bf16 a[132:135], v[176:179], v[204:207], a[132:135]
  v_mfma_f32_16x16x32_bf16 a[136:139], v[176:179], v[208:211], a[136:139]
  v_mfma_f32_16x16x32_bf16 a[140:143], v[176:179], v[212:215], a[140:143]
  v_mfma_f32_16x16x32_bf16 a[144:147], v[180:183], v[200:203], a[144:147]
  v_mfma_f32_16x16x32_bf16 a[148:151], v[180:183], v[204:207], a[148:151]
  v_mfma_f32_16x16x32_bf16 a[152:155], v[180:183], v[208:211], a[152:155]
  v_mfma_f32_16x16x32_bf16 a[156:159], v[180:183], v[212:215], a[156:159]
  buffer_load_dwordx4 v[144:147], v1, s[4:7], s30 offen offset:3072
  buffer_load_dwordx4 v[148:151], v1, s[4:7], s31 offen offset:3072
  buffer_load_dwordx4 v[152:155], v1, s[4:7], s32 offen offset:3072
  buffer_load_dwordx4 v[156:159], v1, s[4:7], s33 offen offset:3072
  buffer_load_dwordx4 v[160:163], v1, s[4:7], s34 offen offset:3072
  buffer_load_dwordx4 v[164:167], v1, s[4:7], s35 offen offset:3072
  buffer_load_dwordx4 v[168:171], v1, s[4:7], s36 offen offset:3072
  buffer_load_dwordx4 v[172:175], v1, s[4:7], s37 offen offset:3072
  buffer_load_dwordx4 v[176:179], v1, s[4:7], s38 offen offset:3072
  buffer_load_dwordx4 v[180:183], v1, s[4:7], s39 offen offset:3072
  s_add_u32 s30, s30, 4096
  s_add_u32 s31, s31, 4096
  s_add_u32 s32, s32, 4096
  s_add_u32 s33, s33, 4096
  s_add_u32 s34, s34, 4096
  s_add_u32 s35, s35, 4096
  s_add_u32 s36, s36, 4096
  s_add_u32 s37, s37, 4096
  s_add_u32 s38, s38, 4096
  s_add_u32 s39, s39, 4096
  s_waitcnt vmcnt(30)
  ds_read_b128 v[200:203], v1 offset:13312
  ds_read_b128 v[204:207], v1 offset:37888
  ds_read_b128 v[208:211], v6 offset:13312
  ds_read_b128 v[212:215], v6 offset:37888
  s_waitcnt lgkmcnt(4)
  v_mfma_f32_16x16x32_bf16 a[0:3], v[24:27], v[184:187], a[0:3]
  v_mfma_f32_16x16x32_bf16 a[4:7], v[24:27], v[188:191], a[4:7]
  v_mfma_f32_16x16x32_bf16 a[8:11], v[24:27], v[192:195], a[8:11]
  v_mfma_f32_16x16x32_bf16 a[12:15], v[24:27], v[196:199], a[12:15]
  v_mfma_f32_16x16x32_bf16 a[16:19], v[28:31], v[184:187], a[16:19]
  v_mfma_f32_16x16x32_bf16 a[20:23], v[28:31], v[188:191], a[20:23]
  v_mfma_f32_16x16x32_bf16 a[24:27], v[28:31], v[192:195], a[24:27]
  v_mfma_f32_16x16x32_bf16 a[28:31], v[28:31], v[196:199], a[28:31]
  v_mfma_f32_16x16x32_bf16 a[32:35], v[32:35], v[184:187], a[32:35]
  v_mfma_f32_16x16x32_bf16 a[36:39], v[32:35], v[188:191], a[36:39]
  v_mfma_f32_16x16x32_bf16 a[40:43], v[32:35], v[192:195], a[40:43]
  v_mfma_f32_16x16x32_bf16 a[44:47], v[32:35], v[196:199], a[44:47]
  v_mfma_f32_16x16x32_bf16 a[48:51], v[36:39], v[184:187], a[48:51]
  v_mfma_f32_16x16x32_bf16 a[52:55], v[36:39], v[188:191], a[52:55]
  v_mfma_f32_16x16x32_bf16 a[56:59], v[36:39], v[192:195], a[56:59]
  v_mfma_f32_16x16x32_bf16 a[60:63], v[36:39], v[196:199], a[60:63]
  v_mfma_f32_16x16x32_bf16 a[64:67], v[40:43], v[184:187], a[64:67]
  v_mfma_f32_16x16x32_bf16 a[68:71], v[40:43], v[188:191], a[68:71]
  v_mfma_f32_16x16x32_bf16 a[72:75], v[40:43], v[192:195], a[72:75]
  v_mfma_f32_16x16x32_bf16 a[76:79], v[40:43], v[196:199], a[76:79]
  v_mfma_f32_16x16x32_bf16 a[80:83], v[44:47], v[184:187], a[80:83]
  v_mfma_f32_16x16x32_bf16 a[84:87], v[44:47], v[188:191], a[84:87]
  v_mfma_f32_16x16x32_bf16 a[88:91], v[44:47], v[192:195], a[88:91]
  v_mfma_f32_16x16x32_bf16 a[92:95], v[44:47], v[196:199], a[92:95]
  v_mfma_f32_16x16x32_bf16 a[96:99], v[48:51], v[184:187], a[96:99]
  v_mfma_f32_16x16x32_bf16 a[100:103], v[48:51], v[188:191], a[100:103]
  v_mfma_f32_16x16x32_bf16 a[104:107], v[48:51], v[192:195], a[104:107]
  v_mfma_f32_16x16x32_bf16 a[108:111], v[48:51], v[196:199], a[108:111]
  v_mfma_f32_16x16x32_bf16 a[112:115], v[52:55], v[184:187], a[112:115]
  v_mfma_f32_16x16x32_bf16 a[116:119], v[52:55], v[188:191], a[116:119]
  v_mfma_f32_16x16x32_bf16 a[120:123], v[52:55], v[192:195], a[120:123]
  v_mfma_f32_16x16x32_bf16 a[124:127], v[52:55], v[196:199], a[124:127]
  v_mfma_f32_16x16x32_bf16 a[128:131], v[56:59], v[184:187], a[128:131]
  v_mfma_f32_16x16x32_bf16 a[132:135], v[56:59], v[188:191], a[132:135]
  v_mfma_f32_16x16x32_bf16 a[136:139], v[56:59], v[192:195], a[136:139]
  v_mfma_f32_16x16x32_bf16 a[140:143], v[56:59], v[196:199], a[140:143]
  v_mfma_f32_16x16x32_bf16 a[144:147], v[60:63], v[184:187], a[144:147]
  v_mfma_f32_16x16x32_bf16 a[148:151], v[60:63], v[188:191], a[148:151]
  v_mfma_f32_16x16x32_bf16 a[152:155], v[60:63], v[192:195], a[152:155]
  v_mfma_f32_16x16x32_bf16 a[156:159], v[60:63], v[196:199], a[156:159]
  buffer_load_dwordx4 v[24:27], v1, s[4:7], s30 offen offset:0
  buffer_load_dwordx4 v[28:31], v1, s[4:7], s31 offen offset:0
  buffer_load_dwordx4 v[32:35], v1, s[4:7], s32 offen offset:0
  buffer_load_dwordx4 v[36:39], v1, s[4:7], s33 offen offset:0
  buffer_load_dwordx4 v[40:43], v1, s[4:7], s34 offen offset:0
  buffer_load_dwordx4 v[44:47], v1, s[4:7], s35 offen offset:0
  buffer_load_dwordx4 v[48:51], v1, s[4:7], s36 offen offset:0
  buffer_load_dwordx4 v[52:55], v1, s[4:7], s37 offen offset:0
  buffer_load_dwordx4 v[56:59], v1, s[4:7], s38 offen offset:0
  buffer_load_dwordx4 v[60:63], v1, s[4:7], s39 offen offset:0
  s_waitcnt vmcnt(30)
  ds_read_b128 v[184:187], v1 offset:14336
  ds_read_b128 v[188:191], v1 offset:38912
  ds_read_b128 v[192:195], v6 offset:14336
  ds_read_b128 v[196:199], v6 offset:38912
  s_waitcnt lgkmcnt(4)
  v_mfma_f32_16x16x32_bf16 a[0:3], v[64:67], v[200:203], a[0:3]
  v_mfma_f32_16x16x32_bf16 a[4:7], v[64:67], v[204:207], a[4:7]
  v_mfma_f32_16x16x32_bf16 a[8:11], v[64:67], v[208:211], a[8:11]
  v_mfma_f32_16x16x32_bf16 a[12:15], v[64:67], v[212:215], a[12:15]
  v_mfma_f32_16x16x32_bf16 a[16:19], v[68:71], v[200:203], a[16:19]
  v_mfma_f32_16x16x32_bf16 a[20:23], v[68:71], v[204:207], a[20:23]
  v_mfma_f32_16x16x32_bf16 a[24:27], v[68:71], v[208:211], a[24:27]
  v_mfma_f32_16x16x32_bf16 a[28:31], v[68:71], v[212:215], a[28:31]
  v_mfma_f32_16x16x32_bf16 a[32:35], v[72:75], v[200:203], a[32:35]
  v_mfma_f32_16x16x32_bf16 a[36:39], v[72:75], v[204:207], a[36:39]
  v_mfma_f32_16x16x32_bf16 a[40:43], v[72:75], v[208:211], a[40:43]
  v_mfma_f32_16x16x32_bf16 a[44:47], v[72:75], v[212:215], a[44:47]
  v_mfma_f32_16x16x32_bf16 a[48:51], v[76:79], v[200:203], a[48:51]
  v_mfma_f32_16x16x32_bf16 a[52:55], v[76:79], v[204:207], a[52:55]
  v_mfma_f32_16x16x32_bf16 a[56:59], v[76:79], v[208:211], a[56:59]
  v_mfma_f32_16x16x32_bf16 a[60:63], v[76:79], v[212:215], a[60:63]
  v_mfma_f32_16x16x32_bf16 a[64:67], v[80:83], v[200:203], a[64:67]
  v_mfma_f32_16x16x32_bf16 a[68:71], v[80:83], v[204:207], a[68:71]
  v_mfma_f32_16x16x32_bf16 a[72:75], v[80:83], v[208:211], a[72:75]
  v_mfma_f32_16x16x32_bf16 a[76:79], v[80:83], v[212:215], a[76:79]
  v_mfma_f32_16x16x32_bf16 a[80:83], v[84:87], v[200:203], a[80:83]
  v_mfma_f32_16x16x32_bf16 a[84:87], v[84:87], v[204:207], a[84:87]
  v_mfma_f32_16x16x32_bf16 a[88:91], v[84:87], v[208:211], a[88:91]
  v_mfma_f32_16x16x32_bf16 a[92:95], v[84:87], v[212:215], a[92:95]
  v_mfma_f32_16x16x32_bf16 a[96:99], v[88:91], v[200:203], a[96:99]
  v_mfma_f32_16x16x32_bf16 a[100:103], v[88:91], v[204:207], a[100:103]
  v_mfma_f32_16x16x32_bf16 a[104:107], v[88:91], v[208:211], a[104:107]
  v_mfma_f32_16x16x32_bf16 a[108:111], v[88:91], v[212:215], a[108:111]
  v_mfma_f32_16x16x32_bf16 a[112:115], v[92:95], v[200:203], a[112:115]
  v_mfma_f32_16x16x32_bf16 a[116:119], v[92:95], v[204:207], a[116:119]
  v_mfma_f32_16x16x32_bf16 a[120:123], v[92:95], v[208:211], a[120:123]
  v_mfma_f32_16x16x32_bf16 a[124:127], v[92:95], v[212:215], a[124:127]
  v_mfma_f32_16x16x32_bf16 a[128:131], v[96:99], v[200:203], a[128:131]
  v_mfma_f32_16x16x32_bf16 a[132:135], v[96:99], v[204:207], a[132:135]
  v_mfma_f32_16x16x32_bf16 a[136:139], v[96:99], v[208:211], a[136:139]
  v_mfma_f32_16x16x32_bf16 a[140:143], v[96:99], v[212:215], a[140:143]
  v_mfma_f32_16x16x32_bf16 a[144:147], v[100:103], v[200:203], a[144:147]
  v_mfma_f32_16x16x32_bf16 a[148:151], v[100:103], v[204:207], a[148:151]
  v_mfma_f32_16x16x32_bf16 a[152:155], v[100:103], v[208:211], a[152:155]
  v_mfma_f32_16x16x32_bf16 a[156:159], v[100:103], v[212:215], a[156:159]
  buffer_load_dwordx4 v[64:67], v1, s[4:7], s30 offen offset:1024
  buffer_load_dwordx4 v[68:71], v1, s[4:7], s31 offen offset:1024
  buffer_load_dwordx4 v[72:75], v1, s[4:7], s32 offen offset:1024
  buffer_load_dwordx4 v[76:79], v1, s[4:7], s33 offen offset:1024
  buffer_load_dwordx4 v[80:83], v1, s[4:7], s34 offen offset:1024
  buffer_load_dwordx4 v[84:87], v1, s[4:7], s35 offen offset:1024
  buffer_load_dwordx4 v[88:91], v1, s[4:7], s36 offen offset:1024
  buffer_load_dwordx4 v[92:95], v1, s[4:7], s37 offen offset:1024
  buffer_load_dwordx4 v[96:99], v1, s[4:7], s38 offen offset:1024
  buffer_load_dwordx4 v[100:103], v1, s[4:7], s39 offen offset:1024
  s_waitcnt vmcnt(30)
  ds_read_b128 v[200:203], v1 offset:15360
  ds_read_b128 v[204:207], v1 offset:39936
  ds_read_b128 v[208:211], v6 offset:15360
  ds_read_b128 v[212:215], v6 offset:39936
  s_waitcnt lgkmcnt(4)
  v_mfma_f32_16x16x32_bf16 a[0:3], v[104:107], v[184:187], a[0:3]
  v_mfma_f32_16x16x32_bf16 a[4:7], v[104:107], v[188:191], a[4:7]
  v_mfma_f32_16x16x32_bf16 a[8:11], v[104:107], v[192:195], a[8:11]
  v_mfma_f32_16x16x32_bf16 a[12:15], v[104:107], v[196:199], a[12:15]
  v_mfma_f32_16x16x32_bf16 a[16:19], v[108:111], v[184:187], a[16:19]
  v_mfma_f32_16x16x32_bf16 a[20:23], v[108:111], v[188:191], a[20:23]
  v_mfma_f32_16x16x32_bf16 a[24:27], v[108:111], v[192:195], a[24:27]
  v_mfma_f32_16x16x32_bf16 a[28:31], v[108:111], v[196:199], a[28:31]
  v_mfma_f32_16x16x32_bf16 a[32:35], v[112:115], v[184:187], a[32:35]
  v_mfma_f32_16x16x32_bf16 a[36:39], v[112:115], v[188:191], a[36:39]
  v_mfma_f32_16x16x32_bf16 a[40:43], v[112:115], v[192:195], a[40:43]
  v_mfma_f32_16x16x32_bf16 a[44:47], v[112:115], v[196:199], a[44:47]
  v_mfma_f32_16x16x32_bf16 a[48:51], v[116:119], v[184:187], a[48:51]
  v_mfma_f32_16x16x32_bf16 a[52:55], v[116:119], v[188:191], a[52:55]
  v_mfma_f32_16x16x32_bf16 a[56:59], v[116:119], v[192:195], a[56:59]
  v_mfma_f32_16x16x32_bf16 a[60:63], v[116:119], v[196:199], a[60:63]
  v_mfma_f32_16x16x32_bf16 a[64:67], v[120:123], v[184:187], a[64:67]
  v_mfma_f32_16x16x32_bf16 a[68:71], v[120:123], v[188:191], a[68:71]
  v_mfma_f32_16x16x32_bf16 a[72:75], v[120:123], v[192:195], a[72:75]
  v_mfma_f32_16x16x32_bf16 a[76:79], v[120:123], v[196:199], a[76:79]
  v_mfma_f32_16x16x32_bf16 a[80:83], v[124:127], v[184:187], a[80:83]
  v_mfma_f32_16x16x32_bf16 a[84:87], v[124:127], v[188:191], a[84:87]
  v_mfma_f32_16x16x32_bf16 a[88:91], v[124:127], v[192:195], a[88:91]
  v_mfma_f32_16x16x32_bf16 a[92:95], v[124:127], v[196:199], a[92:95]
  v_mfma_f32_16x16x32_bf16 a[96:99], v[128:131], v[184:187], a[96:99]
  v_mfma_f32_16x16x32_bf16 a[100:103], v[128:131], v[188:191], a[100:103]
  v_mfma_f32_16x16x32_bf16 a[104:107], v[128:131], v[192:195], a[104:107]
  v_mfma_f32_16x16x32_bf16 a[108:111], v[128:131], v[196:199], a[108:111]
  v_mfma_f32_16x16x32_bf16 a[112:115], v[132:135], v[184:187], a[112:115]
  v_mfma_f32_16x16x32_bf16 a[116:119], v[132:135], v[188:191], a[116:119]
  v_mfma_f32_16x16x32_bf16 a[120:123], v[132:135], v[192:195], a[120:123]
  v_mfma_f32_16x16x32_bf16 a[124:127], v[132:135], v[196:199], a[124:127]
  v_mfma_f32_16x16x32_bf16 a[128:131], v[136:139], v[184:187], a[128:131]
  v_mfma_f32_16x16x32_bf16 a[132:135], v[136:139], v[188:191], a[132:135]
  v_mfma_f32_16x16x32_bf16 a[136:139], v[136:139], v[192:195], a[136:139]
  v_mfma_f32_16x16x32_bf16 a[140:143], v[136:139], v[196:199], a[140:143]
  v_mfma_f32_16x16x32_bf16 a[144:147], v[140:143], v[184:187], a[144:147]
  v_mfma_f32_16x16x32_bf16 a[148:151], v[140:143], v[188:191], a[148:151]
  v_mfma_f32_16x16x32_bf16 a[152:155], v[140:143], v[192:195], a[152:155]
  v_mfma_f32_16x16x32_bf16 a[156:159], v[140:143], v[196:199], a[156:159]
  buffer_load_dwordx4 v[104:107], v1, s[4:7], s30 offen offset:2048
  buffer_load_dwordx4 v[108:111], v1, s[4:7], s31 offen offset:2048
  buffer_load_dwordx4 v[112:115], v1, s[4:7], s32 offen offset:2048
  buffer_load_dwordx4 v[116:119], v1, s[4:7], s33 offen offset:2048
  buffer_load_dwordx4 v[120:123], v1, s[4:7], s34 offen offset:2048
  buffer_load_dwordx4 v[124:127], v1, s[4:7], s35 offen offset:2048
  buffer_load_dwordx4 v[128:131], v1, s[4:7], s36 offen offset:2048
  buffer_load_dwordx4 v[132:135], v1, s[4:7], s37 offen offset:2048
  buffer_load_dwordx4 v[136:139], v1, s[4:7], s38 offen offset:2048
  buffer_load_dwordx4 v[140:143], v1, s[4:7], s39 offen offset:2048
  s_waitcnt vmcnt(30)
  ds_read_b128 v[184:187], v1 offset:16384
  ds_read_b128 v[188:191], v1 offset:40960
  ds_read_b128 v[192:195], v6 offset:16384
  ds_read_b128 v[196:199], v6 offset:40960
  s_waitcnt lgkmcnt(4)
  v_mfma_f32_16x16x32_bf16 a[0:3], v[144:147], v[200:203], a[0:3]
  v_mfma_f32_16x16x32_bf16 a[4:7], v[144:147], v[204:207], a[4:7]
  v_mfma_f32_16x16x32_bf16 a[8:11], v[144:147], v[208:211], a[8:11]
  v_mfma_f32_16x16x32_bf16 a[12:15], v[144:147], v[212:215], a[12:15]
  v_mfma_f32_16x16x32_bf16 a[16:19], v[148:151], v[200:203], a[16:19]
  v_mfma_f32_16x16x32_bf16 a[20:23], v[148:151], v[204:207], a[20:23]
  v_mfma_f32_16x16x32_bf16 a[24:27], v[148:151], v[208:211], a[24:27]
  v_mfma_f32_16x16x32_bf16 a[28:31], v[148:151], v[212:215], a[28:31]
  v_mfma_f32_16x16x32_bf16 a[32:35], v[152:155], v[200:203], a[32:35]
  v_mfma_f32_16x16x32_bf16 a[36:39], v[152:155], v[204:207], a[36:39]
  v_mfma_f32_16x16x32_bf16 a[40:43], v[152:155], v[208:211], a[40:43]
  v_mfma_f32_16x16x32_bf16 a[44:47], v[152:155], v[212:215], a[44:47]
  v_mfma_f32_16x16x32_bf16 a[48:51], v[156:159], v[200:203], a[48:51]
  v_mfma_f32_16x16x32_bf16 a[52:55], v[156:159], v[204:207], a[52:55]
  v_mfma_f32_16x16x32_bf16 a[56:59], v[156:159], v[208:211], a[56:59]
  v_mfma_f32_16x16x32_bf16 a[60:63], v[156:159], v[212:215], a[60:63]
  v_mfma_f32_16x16x32_bf16 a[64:67], v[160:163], v[200:203], a[64:67]
  v_mfma_f32_16x16x32_bf16 a[68:71], v[160:163], v[204:207], a[68:71]
  v_mfma_f32_16x16x32_bf16 a[72:75], v[160:163], v[208:211], a[72:75]
  v_mfma_f32_16x16x32_bf16 a[76:79], v[160:163], v[212:215], a[76:79]
  v_mfma_f32_16x16x32_bf16 a[80:83], v[164:167], v[200:203], a[80:83]
  v_mfma_f32_16x16x32_bf16 a[84:87], v[164:167], v[204:207], a[84:87]
  v_mfma_f32_16x16x32_bf16 a[88:91], v[164:167], v[208:211], a[88:91]
  v_mfma_f32_16x16x32_bf16 a[92:95], v[164:167], v[212:215], a[92:95]
  v_mfma_f32_16x16x32_bf16 a[96:99], v[168:171], v[200:203], a[96:99]
  v_mfma_f32_16x16x32_bf16 a[100:103], v[168:171], v[204:207], a[100:103]
  v_mfma_f32_16x16x32_bf16 a[104:107], v[168:171], v[208:211], a[104:107]
  v_mfma_f32_16x16x32_bf16 a[108:111], v[168:171], v[212:215], a[108:111]
  v_mfma_f32_16x16x32_bf16 a[112:115], v[172:175], v[200:203], a[112:115]
  v_mfma_f32_16x16x32_bf16 a[116:119], v[172:175], v[204:207], a[116:119]
  v_mfma_f32_16x16x32_bf16 a[120:123], v[172:175], v[208:211], a[120:123]
  v_mfma_f32_16x16x32_bf16 a[124:127], v[172:175], v[212:215], a[124:127]
  v_mfma_f32_16x16x32_bf16 a[128:131], v[176:179], v[200:203], a[128:131]
  v_mfma_f32_16x16x32_bf16 a[132:135], v[176:179], v[204:207], a[132:135]
  v_mfma_f32_16x16x32_bf16 a[136:139], v[176:179], v[208:211], a[136:139]
  v_mfma_f32_16x16x32_bf16 a[140:143], v[176:179], v[212:215], a[140:143]
  v_mfma_f32_16x16x32_bf16 a[144:147], v[180:183], v[200:203], a[144:147]
  v_mfma_f32_16x16x32_bf16 a[148:151], v[180:183], v[204:207], a[148:151]
  v_mfma_f32_16x16x32_bf16 a[152:155], v[180:183], v[208:211], a[152:155]
  v_mfma_f32_16x16x32_bf16 a[156:159], v[180:183], v[212:215], a[156:159]
  buffer_load_dwordx4 v[144:147], v1, s[4:7], s30 offen offset:3072
  buffer_load_dwordx4 v[148:151], v1, s[4:7], s31 offen offset:3072
  buffer_load_dwordx4 v[152:155], v1, s[4:7], s32 offen offset:3072
  buffer_load_dwordx4 v[156:159], v1, s[4:7], s33 offen offset:3072
  buffer_load_dwordx4 v[160:163], v1, s[4:7], s34 offen offset:3072
  buffer_load_dwordx4 v[164:167], v1, s[4:7], s35 offen offset:3072
  buffer_load_dwordx4 v[168:171], v1, s[4:7], s36 offen offset:3072
  buffer_load_dwordx4 v[172:175], v1, s[4:7], s37 offen offset:3072
  buffer_load_dwordx4 v[176:179], v1, s[4:7], s38 offen offset:3072
  buffer_load_dwordx4 v[180:183], v1, s[4:7], s39 offen offset:3072
  s_add_u32 s30, s30, 4096
  s_add_u32 s31, s31, 4096
  s_add_u32 s32, s32, 4096
  s_add_u32 s33, s33, 4096
  s_add_u32 s34, s34, 4096
  s_add_u32 s35, s35, 4096
  s_add_u32 s36, s36, 4096
  s_add_u32 s37, s37, 4096
  s_add_u32 s38, s38, 4096
  s_add_u32 s39, s39, 4096
  s_waitcnt vmcnt(30)
  ds_read_b128 v[200:203], v1 offset:17408
  ds_read_b128 v[204:207], v1 offset:41984
  ds_read_b128 v[208:211], v6 offset:17408
  ds_read_b128 v[212:215], v6 offset:41984
  s_waitcnt lgkmcnt(4)
  v_mfma_f32_16x16x32_bf16 a[0:3], v[24:27], v[184:187], a[0:3]
  v_mfma_f32_16x16x32_bf16 a[4:7], v[24:27], v[188:191], a[4:7]
  v_mfma_f32_16x16x32_bf16 a[8:11], v[24:27], v[192:195], a[8:11]
  v_mfma_f32_16x16x32_bf16 a[12:15], v[24:27], v[196:199], a[12:15]
  v_mfma_f32_16x16x32_bf16 a[16:19], v[28:31], v[184:187], a[16:19]
  v_mfma_f32_16x16x32_bf16 a[20:23], v[28:31], v[188:191], a[20:23]
  v_mfma_f32_16x16x32_bf16 a[24:27], v[28:31], v[192:195], a[24:27]
  v_mfma_f32_16x16x32_bf16 a[28:31], v[28:31], v[196:199], a[28:31]
  v_mfma_f32_16x16x32_bf16 a[32:35], v[32:35], v[184:187], a[32:35]
  v_mfma_f32_16x16x32_bf16 a[36:39], v[32:35], v[188:191], a[36:39]
  v_mfma_f32_16x16x32_bf16 a[40:43], v[32:35], v[192:195], a[40:43]
  v_mfma_f32_16x16x32_bf16 a[44:47], v[32:35], v[196:199], a[44:47]
  v_mfma_f32_16x16x32_bf16 a[48:51], v[36:39], v[184:187], a[48:51]
  v_mfma_f32_16x16x32_bf16 a[52:55], v[36:39], v[188:191], a[52:55]
  v_mfma_f32_16x16x32_bf16 a[56:59], v[36:39], v[192:195], a[56:59]
  v_mfma_f32_16x16x32_bf16 a[60:63], v[36:39], v[196:199], a[60:63]
  v_mfma_f32_16x16x32_bf16 a[64:67], v[40:43], v[184:187], a[64:67]
  v_mfma_f32_16x16x32_bf16 a[68:71], v[40:43], v[188:191], a[68:71]
  v_mfma_f32_16x16x32_bf16 a[72:75], v[40:43], v[192:195], a[72:75]
  v_mfma_f32_16x16x32_bf16 a[76:79], v[40:43], v[196:199], a[76:79]
  v_mfma_f32_16x16x32_bf16 a[80:83], v[44:47], v[184:187], a[80:83]
  v_mfma_f32_16x16x32_bf16 a[84:87], v[44:47], v[188:191], a[84:87]
  v_mfma_f32_16x16x32_bf16 a[88:91], v[44:47], v[192:195], a[88:91]
  v_mfma_f32_16x16x32_bf16 a[92:95], v[44:47], v[196:199], a[92:95]
  v_mfma_f32_16x16x32_bf16 a[96:99], v[48:51], v[184:187], a[96:99]
  v_mfma_f32_16x16x32_bf16 a[100:103], v[48:51], v[188:191], a[100:103]
  v_mfma_f32_16x16x32_bf16 a[104:107], v[48:51], v[192:195], a[104:107]
  v_mfma_f32_16x16x32_bf16 a[108:111], v[48:51], v[196:199], a[108:111]
  v_mfma_f32_16x16x32_bf16 a[112:115], v[52:55], v[184:187], a[112:115]
  v_mfma_f32_16x16x32_bf16 a[116:119], v[52:55], v[188:191], a[116:119]
  v_mfma_f32_16x16x32_bf16 a[120:123], v[52:55], v[192:195], a[120:123]
  v_mfma_f32_16x16x32_bf16 a[124:127], v[52:55], v[196:199], a[124:127]
  v_mfma_f32_16x16x32_bf16 a[128:131], v[56:59], v[184:187], a[128:131]
  v_mfma_f32_16x16x32_bf16 a[132:135], v[56:59], v[188:191], a[132:135]
  v_mfma_f32_16x16x32_bf16 a[136:139], v[56:59], v[192:195], a[136:139]
  v_mfma_f32_16x16x32_bf16 a[140:143], v[56:59], v[196:199], a[140:143]
  v_mfma_f32_16x16x32_bf16 a[144:147], v[60:63], v[184:187], a[144:147]
  v_mfma_f32_16x16x32_bf16 a[148:151], v[60:63], v[188:191], a[148:151]
  v_mfma_f32_16x16x32_bf16 a[152:155], v[60:63], v[192:195], a[152:155]
  v_mfma_f32_16x16x32_bf16 a[156:159], v[60:63], v[196:199], a[156:159]
  buffer_load_dwordx4 v[24:27], v1, s[4:7], s30 offen offset:0
  buffer_load_dwordx4 v[28:31], v1, s[4:7], s31 offen offset:0
  buffer_load_dwordx4 v[32:35], v1, s[4:7], s32 offen offset:0
  buffer_load_dwordx4 v[36:39], v1, s[4:7], s33 offen offset:0
  buffer_load_dwordx4 v[40:43], v1, s[4:7], s34 offen offset:0
  buffer_load_dwordx4 v[44:47], v1, s[4:7], s35 offen offset:0
  buffer_load_dwordx4 v[48:51], v1, s[4:7], s36 offen offset:0
  buffer_load_dwordx4 v[52:55], v1, s[4:7], s37 offen offset:0
  buffer_load_dwordx4 v[56:59], v1, s[4:7], s38 offen offset:0
  buffer_load_dwordx4 v[60:63], v1, s[4:7], s39 offen offset:0
  s_waitcnt vmcnt(30)
  ds_read_b128 v[184:187], v1 offset:18432
  ds_read_b128 v[188:191], v1 offset:43008
  ds_read_b128 v[192:195], v6 offset:18432
  ds_read_b128 v[196:199], v6 offset:43008
  s_waitcnt lgkmcnt(4)
  v_mfma_f32_16x16x32_bf16 a[0:3], v[64:67], v[200:203], a[0:3]
  v_mfma_f32_16x16x32_bf16 a[4:7], v[64:67], v[204:207], a[4:7]
  v_mfma_f32_16x16x32_bf16 a[8:11], v[64:67], v[208:211], a[8:11]
  v_mfma_f32_16x16x32_bf16 a[12:15], v[64:67], v[212:215], a[12:15]
  v_mfma_f32_16x16x32_bf16 a[16:19], v[68:71], v[200:203], a[16:19]
  v_mfma_f32_16x16x32_bf16 a[20:23], v[68:71], v[204:207], a[20:23]
  v_mfma_f32_16x16x32_bf16 a[24:27], v[68:71], v[208:211], a[24:27]
  v_mfma_f32_16x16x32_bf16 a[28:31], v[68:71], v[212:215], a[28:31]
  v_mfma_f32_16x16x32_bf16 a[32:35], v[72:75], v[200:203], a[32:35]
  v_mfma_f32_16x16x32_bf16 a[36:39], v[72:75], v[204:207], a[36:39]
  v_mfma_f32_16x16x32_bf16 a[40:43], v[72:75], v[208:211], a[40:43]
  v_mfma_f32_16x16x32_bf16 a[44:47], v[72:75], v[212:215], a[44:47]
  v_mfma_f32_16x16x32_bf16 a[48:51], v[76:79], v[200:203], a[48:51]
  v_mfma_f32_16x16x32_bf16 a[52:55], v[76:79], v[204:207], a[52:55]
  v_mfma_f32_16x16x32_bf16 a[56:59], v[76:79], v[208:211], a[56:59]
  v_mfma_f32_16x16x32_bf16 a[60:63], v[76:79], v[212:215], a[60:63]
  v_mfma_f32_16x16x32_bf16 a[64:67], v[80:83], v[200:203], a[64:67]
  v_mfma_f32_16x16x32_bf16 a[68:71], v[80:83], v[204:207], a[68:71]
  v_mfma_f32_16x16x32_bf16 a[72:75], v[80:83], v[208:211], a[72:75]
  v_mfma_f32_16x16x32_bf16 a[76:79], v[80:83], v[212:215], a[76:79]
  v_mfma_f32_16x16x32_bf16 a[80:83], v[84:87], v[200:203], a[80:83]
  v_mfma_f32_16x16x32_bf16 a[84:87], v[84:87], v[204:207], a[84:87]
  v_mfma_f32_16x16x32_bf16 a[88:91], v[84:87], v[208:211], a[88:91]
  v_mfma_f32_16x16x32_bf16 a[92:95], v[84:87], v[212:215], a[92:95]
  v_mfma_f32_16x16x32_bf16 a[96:99], v[88:91], v[200:203], a[96:99]
  v_mfma_f32_16x16x32_bf16 a[100:103], v[88:91], v[204:207], a[100:103]
  v_mfma_f32_16x16x32_bf16 a[104:107], v[88:91], v[208:211], a[104:107]
  v_mfma_f32_16x16x32_bf16 a[108:111], v[88:91], v[212:215], a[108:111]
  v_mfma_f32_16x16x32_bf16 a[112:115], v[92:95], v[200:203], a[112:115]
  v_mfma_f32_16x16x32_bf16 a[116:119], v[92:95], v[204:207], a[116:119]
  v_mfma_f32_16x16x32_bf16 a[120:123], v[92:95], v[208:211], a[120:123]
  v_mfma_f32_16x16x32_bf16 a[124:127], v[92:95], v[212:215], a[124:127]
  v_mfma_f32_16x16x32_bf16 a[128:131], v[96:99], v[200:203], a[128:131]
  v_mfma_f32_16x16x32_bf16 a[132:135], v[96:99], v[204:207], a[132:135]
  v_mfma_f32_16x16x32_bf16 a[136:139], v[96:99], v[208:211], a[136:139]
  v_mfma_f32_16x16x32_bf16 a[140:143], v[96:99], v[212:215], a[140:143]
  v_mfma_f32_16x16x32_bf16 a[144:147], v[100:103], v[200:203], a[144:147]
  v_mfma_f32_16x16x32_bf16 a[148:151], v[100:103], v[204:207], a[148:151]
  v_mfma_f32_16x16x32_bf16 a[152:155], v[100:103], v[208:211], a[152:155]
  v_mfma_f32_16x16x32_bf16 a[156:159], v[100:103], v[212:215], a[156:159]
  buffer_load_dwordx4 v[64:67], v1, s[4:7], s30 offen offset:1024
  buffer_load_dwordx4 v[68:71], v1, s[4:7], s31 offen offset:1024
  buffer_load_dwordx4 v[72:75], v1, s[4:7], s32 offen offset:1024
  buffer_load_dwordx4 v[76:79], v1, s[4:7], s33 offen offset:1024
  buffer_load_dwordx4 v[80:83], v1, s[4:7], s34 offen offset:1024
  buffer_load_dwordx4 v[84:87], v1, s[4:7], s35 offen offset:1024
  buffer_load_dwordx4 v[88:91], v1, s[4:7], s36 offen offset:1024
  buffer_load_dwordx4 v[92:95], v1, s[4:7], s37 offen offset:1024
  buffer_load_dwordx4 v[96:99], v1, s[4:7], s38 offen offset:1024
  buffer_load_dwordx4 v[100:103], v1, s[4:7], s39 offen offset:1024
  s_waitcnt vmcnt(30)
  ds_read_b128 v[200:203], v1 offset:19456
  ds_read_b128 v[204:207], v1 offset:44032
  ds_read_b128 v[208:211], v6 offset:19456
  ds_read_b128 v[212:215], v6 offset:44032
  s_waitcnt lgkmcnt(4)
  v_mfma_f32_16x16x32_bf16 a[0:3], v[104:107], v[184:187], a[0:3]
  v_mfma_f32_16x16x32_bf16 a[4:7], v[104:107], v[188:191], a[4:7]
  v_mfma_f32_16x16x32_bf16 a[8:11], v[104:107], v[192:195], a[8:11]
  v_mfma_f32_16x16x32_bf16 a[12:15], v[104:107], v[196:199], a[12:15]
  v_mfma_f32_16x16x32_bf16 a[16:19], v[108:111], v[184:187], a[16:19]
  v_mfma_f32_16x16x32_bf16 a[20:23], v[108:111], v[188:191], a[20:23]
  v_mfma_f32_16x16x32_bf16 a[24:27], v[108:111], v[192:195], a[24:27]
  v_mfma_f32_16x16x32_bf16 a[28:31], v[108:111], v[196:199], a[28:31]
  v_mfma_f32_16x16x32_bf16 a[32:35], v[112:115], v[184:187], a[32:35]
  v_mfma_f32_16x16x32_bf16 a[36:39], v[112:115], v[188:191], a[36:39]
  v_mfma_f32_16x16x32_bf16 a[40:43], v[112:115], v[192:195], a[40:43]
  v_mfma_f32_16x16x32_bf16 a[44:47], v[112:115], v[196:199], a[44:47]
  v_mfma_f32_16x16x32_bf16 a[48:51], v[116:119], v[184:187], a[48:51]
  v_mfma_f32_16x16x32_bf16 a[52:55], v[116:119], v[188:191], a[52:55]
  v_mfma_f32_16x16x32_bf16 a[56:59], v[116:119], v[192:195], a[56:59]
  v_mfma_f32_16x16x32_bf16 a[60:63], v[116:119], v[196:199], a[60:63]
  v_mfma_f32_16x16x32_bf16 a[64:67], v[120:123], v[184:187], a[64:67]
  v_mfma_f32_16x16x32_bf16 a[68:71], v[120:123], v[188:191], a[68:71]
  v_mfma_f32_16x16x32_bf16 a[72:75], v[120:123], v[192:195], a[72:75]
  v_mfma_f32_16x16x32_bf16 a[76:79], v[120:123], v[196:199], a[76:79]
  v_mfma_f32_16x16x32_bf16 a[80:83], v[124:127], v[184:187], a[80:83]
  v_mfma_f32_16x16x32_bf16 a[84:87], v[124:127], v[188:191], a[84:87]
  v_mfma_f32_16x16x32_bf16 a[88:91], v[124:127], v[192:195], a[88:91]
  v_mfma_f32_16x16x32_bf16 a[92:95], v[124:127], v[196:199], a[92:95]
  v_mfma_f32_16x16x32_bf16 a[96:99], v[128:131], v[184:187], a[96:99]
  v_mfma_f32_16x16x32_bf16 a[100:103], v[128:131], v[188:191], a[100:103]
  v_mfma_f32_16x16x32_bf16 a[104:107], v[128:131], v[192:195], a[104:107]
  v_mfma_f32_16x16x32_bf16 a[108:111], v[128:131], v[196:199], a[108:111]
  v_mfma_f32_16x16x32_bf16 a[112:115], v[132:135], v[184:187], a[112:115]
  v_mfma_f32_16x16x32_bf16 a[116:119], v[132:135], v[188:191], a[116:119]
  v_mfma_f32_16x16x32_bf16 a[120:123], v[132:135], v[192:195], a[120:123]
  v_mfma_f32_16x16x32_bf16 a[124:127], v[132:135], v[196:199], a[124:127]
  v_mfma_f32_16x16x32_bf16 a[128:131], v[136:139], v[184:187], a[128:131]
  v_mfma_f32_16x16x32_bf16 a[132:135], v[136:139], v[188:191], a[132:135]
  v_mfma_f32_16x16x32_bf16 a[136:139], v[136:139], v[192:195], a[136:139]
  v_mfma_f32_16x16x32_bf16 a[140:143], v[136:139], v[196:199], a[140:143]
  v_mfma_f32_16x16x32_bf16 a[144:147], v[140:143], v[184:187], a[144:147]
  v_mfma_f32_16x16x32_bf16 a[148:151], v[140:143], v[188:191], a[148:151]
  v_mfma_f32_16x16x32_bf16 a[152:155], v[140:143], v[192:195], a[152:155]
  v_mfma_f32_16x16x32_bf16 a[156:159], v[140:143], v[196:199], a[156:159]
  buffer_load_dwordx4 v[104:107], v1, s[4:7], s30 offen offset:2048
  buffer_load_dwordx4 v[108:111], v1, s[4:7], s31 offen offset:2048
  buffer_load_dwordx4 v[112:115], v1, s[4:7], s32 offen offset:2048
  buffer_load_dwordx4 v[116:119], v1, s[4:7], s33 offen offset:2048
  buffer_load_dwordx4 v[120:123], v1, s[4:7], s34 offen offset:2048
  buffer_load_dwordx4 v[124:127], v1, s[4:7], s35 offen offset:2048
  buffer_load_dwordx4 v[128:131], v1, s[4:7], s36 offen offset:2048
  buffer_load_dwordx4 v[132:135], v1, s[4:7], s37 offen offset:2048
  buffer_load_dwordx4 v[136:139], v1, s[4:7], s38 offen offset:2048
  buffer_load_dwordx4 v[140:143], v1, s[4:7], s39 offen offset:2048
  s_waitcnt vmcnt(30)
  ds_read_b128 v[184:187], v1 offset:20480
  ds_read_b128 v[188:191], v1 offset:45056
  ds_read_b128 v[192:195], v6 offset:20480
  ds_read_b128 v[196:199], v6 offset:45056
  s_waitcnt lgkmcnt(4)
  v_mfma_f32_16x16x32_bf16 a[0:3], v[144:147], v[200:203], a[0:3]
  v_mfma_f32_16x16x32_bf16 a[4:7], v[144:147], v[204:207], a[4:7]
  v_mfma_f32_16x16x32_bf16 a[8:11], v[144:147], v[208:211], a[8:11]
  v_mfma_f32_16x16x32_bf16 a[12:15], v[144:147], v[212:215], a[12:15]
  v_mfma_f32_16x16x32_bf16 a[16:19], v[148:151], v[200:203], a[16:19]
  v_mfma_f32_16x16x32_bf16 a[20:23], v[148:151], v[204:207], a[20:23]
  v_mfma_f32_16x16x32_bf16 a[24:27], v[148:151], v[208:211], a[24:27]
  v_mfma_f32_16x16x32_bf16 a[28:31], v[148:151], v[212:215], a[28:31]
  v_mfma_f32_16x16x32_bf16 a[32:35], v[152:155], v[200:203], a[32:35]
  v_mfma_f32_16x16x32_bf16 a[36:39], v[152:155], v[204:207], a[36:39]
  v_mfma_f32_16x16x32_bf16 a[40:43], v[152:155], v[208:211], a[40:43]
  v_mfma_f32_16x16x32_bf16 a[44:47], v[152:155], v[212:215], a[44:47]
  v_mfma_f32_16x16x32_bf16 a[48:51], v[156:159], v[200:203], a[48:51]
  v_mfma_f32_16x16x32_bf16 a[52:55], v[156:159], v[204:207], a[52:55]
  v_mfma_f32_16x16x32_bf16 a[56:59], v[156:159], v[208:211], a[56:59]
  v_mfma_f32_16x16x32_bf16 a[60:63], v[156:159], v[212:215], a[60:63]
  v_mfma_f32_16x16x32_bf16 a[64:67], v[160:163], v[200:203], a[64:67]
  v_mfma_f32_16x16x32_bf16 a[68:71], v[160:163], v[204:207], a[68:71]
  v_mfma_f32_16x16x32_bf16 a[72:75], v[160:163], v[208:211], a[72:75]
  v_mfma_f32_16x16x32_bf16 a[76:79], v[160:163], v[212:215], a[76:79]
  v_mfma_f32_16x16x32_bf16 a[80:83], v[164:167], v[200:203], a[80:83]
  v_mfma_f32_16x16x32_bf16 a[84:87], v[164:167], v[204:207], a[84:87]
  v_mfma_f32_16x16x32_bf16 a[88:91], v[164:167], v[208:211], a[88:91]
  v_mfma_f32_16x16x32_bf16 a[92:95], v[164:167], v[212:215], a[92:95]
  v_mfma_f32_16x16x32_bf16 a[96:99], v[168:171], v[200:203], a[96:99]
  v_mfma_f32_16x16x32_bf16 a[100:103], v[168:171], v[204:207], a[100:103]
  v_mfma_f32_16x16x32_bf16 a[104:107], v[168:171], v[208:211], a[104:107]
  v_mfma_f32_16x16x32_bf16 a[108:111], v[168:171], v[212:215], a[108:111]
  v_mfma_f32_16x16x32_bf16 a[112:115], v[172:175], v[200:203], a[112:115]
  v_mfma_f32_16x16x32_bf16 a[116:119], v[172:175], v[204:207], a[116:119]
  v_mfma_f32_16x16x32_bf16 a[120:123], v[172:175], v[208:211], a[120:123]
  v_mfma_f32_16x16x32_bf16 a[124:127], v[172:175], v[212:215], a[124:127]
  v_mfma_f32_16x16x32_bf16 a[128:131], v[176:179], v[200:203], a[128:131]
  v_mfma_f32_16x16x32_bf16 a[132:135], v[176:179], v[204:207], a[132:135]
  v_mfma_f32_16x16x32_bf16 a[136:139], v[176:179], v[208:211], a[136:139]
  v_mfma_f32_16x16x32_bf16 a[140:143], v[176:179], v[212:215], a[140:143]
  v_mfma_f32_16x16x32_bf16 a[144:147], v[180:183], v[200:203], a[144:147]
  v_mfma_f32_16x16x32_bf16 a[148:151], v[180:183], v[204:207], a[148:151]
  v_mfma_f32_16x16x32_bf16 a[152:155], v[180:183], v[208:211], a[152:155]
  v_mfma_f32_16x16x32_bf16 a[156:159], v[180:183], v[212:215], a[156:159]
  buffer_load_dwordx4 v[144:147], v1, s[4:7], s30 offen offset:3072
  buffer_load_dwordx4 v[148:151], v1, s[4:7], s31 offen offset:3072
  buffer_load_dwordx4 v[152:155], v1, s[4:7], s32 offen offset:3072
  buffer_load_dwordx4 v[156:159], v1, s[4:7], s33 offen offset:3072
  buffer_load_dwordx4 v[160:163], v1, s[4:7], s34 offen offset:3072
  buffer_load_dwordx4 v[164:167], v1, s[4:7], s35 offen offset:3072
  buffer_load_dwordx4 v[168:171], v1, s[4:7], s36 offen offset:3072
  buffer_load_dwordx4 v[172:175], v1, s[4:7], s37 offen offset:3072
  buffer_load_dwordx4 v[176:179], v1, s[4:7], s38 offen offset:3072
  buffer_load_dwordx4 v[180:183], v1, s[4:7], s39 offen offset:3072
  s_add_u32 s30, s30, 4096
  s_add_u32 s31, s31, 4096
  s_add_u32 s32, s32, 4096
  s_add_u32 s33, s33, 4096
  s_add_u32 s34, s34, 4096
  s_add_u32 s35, s35, 4096
  s_add_u32 s36, s36, 4096
  s_add_u32 s37, s37, 4096
  s_add_u32 s38, s38, 4096
  s_add_u32 s39, s39, 4096
  s_waitcnt vmcnt(30)
  ds_read_b128 v[200:203], v1 offset:21504
  ds_read_b128 v[204:207], v1 offset:46080
  ds_read_b128 v[208:211], v6 offset:21504
  ds_read_b128 v[212:215], v6 offset:46080
  s_waitcnt lgkmcnt(4)
  v_mfma_f32_16x16x32_bf16 a[0:3], v[24:27], v[184:187], a[0:3]
  v_mfma_f32_16x16x32_bf16 a[4:7], v[24:27], v[188:191], a[4:7]
  v_mfma_f32_16x16x32_bf16 a[8:11], v[24:27], v[192:195], a[8:11]
  v_mfma_f32_16x16x32_bf16 a[12:15], v[24:27], v[196:199], a[12:15]
  v_mfma_f32_16x16x32_bf16 a[16:19], v[28:31], v[184:187], a[16:19]
  v_mfma_f32_16x16x32_bf16 a[20:23], v[28:31], v[188:191], a[20:23]
  v_mfma_f32_16x16x32_bf16 a[24:27], v[28:31], v[192:195], a[24:27]
  v_mfma_f32_16x16x32_bf16 a[28:31], v[28:31], v[196:199], a[28:31]
  v_mfma_f32_16x16x32_bf16 a[32:35], v[32:35], v[184:187], a[32:35]
  v_mfma_f32_16x16x32_bf16 a[36:39], v[32:35], v[188:191], a[36:39]
  v_mfma_f32_16x16x32_bf16 a[40:43], v[32:35], v[192:195], a[40:43]
  v_mfma_f32_16x16x32_bf16 a[44:47], v[32:35], v[196:199], a[44:47]
  v_mfma_f32_16x16x32_bf16 a[48:51], v[36:39], v[184:187], a[48:51]
  v_mfma_f32_16x16x32_bf16 a[52:55], v[36:39], v[188:191], a[52:55]
  v_mfma_f32_16x16x32_bf16 a[56:59], v[36:39], v[192:195], a[56:59]
  v_mfma_f32_16x16x32_bf16 a[60:63], v[36:39], v[196:199], a[60:63]
  v_mfma_f32_16x16x32_bf16 a[64:67], v[40:43], v[184:187], a[64:67]
  v_mfma_f32_16x16x32_bf16 a[68:71], v[40:43], v[188:191], a[68:71]
  v_mfma_f32_16x16x32_bf16 a[72:75], v[40:43], v[192:195], a[72:75]
  v_mfma_f32_16x16x32_bf16 a[76:79], v[40:43], v[196:199], a[76:79]
  v_mfma_f32_16x16x32_bf16 a[80:83], v[44:47], v[184:187], a[80:83]
  v_mfma_f32_16x16x32_bf16 a[84:87], v[44:47], v[188:191], a[84:87]
  v_mfma_f32_16x16x32_bf16 a[88:91], v[44:47], v[192:195], a[88:91]
  v_mfma_f32_16x16x32_bf16 a[92:95], v[44:47], v[196:199], a[92:95]
  v_mfma_f32_16x16x32_bf16 a[96:99], v[48:51], v[184:187], a[96:99]
  v_mfma_f32_16x16x32_bf16 a[100:103], v[48:51], v[188:191], a[100:103]
  v_mfma_f32_16x16x32_bf16 a[104:107], v[48:51], v[192:195], a[104:107]
  v_mfma_f32_16x16x32_bf16 a[108:111], v[48:51], v[196:199], a[108:111]
  v_mfma_f32_16x16x32_bf16 a[112:115], v[52:55], v[184:187], a[112:115]
  v_mfma_f32_16x16x32_bf16 a[116:119], v[52:55], v[188:191], a[116:119]
  v_mfma_f32_16x16x32_bf16 a[120:123], v[52:55], v[192:195], a[120:123]
  v_mfma_f32_16x16x32_bf16 a[124:127], v[52:55], v[196:199], a[124:127]
  v_mfma_f32_16x16x32_bf16 a[128:131], v[56:59], v[184:187], a[128:131]
  v_mfma_f32_16x16x32_bf16 a[132:135], v[56:59], v[188:191], a[132:135]
  v_mfma_f32_16x16x32_bf16 a[136:139], v[56:59], v[192:195], a[136:139]
  v_mfma_f32_16x16x32_bf16 a[140:143], v[56:59], v[196:199], a[140:143]
  v_mfma_f32_16x16x32_bf16 a[144:147], v[60:63], v[184:187], a[144:147]
  v_mfma_f32_16x16x32_bf16 a[148:151], v[60:63], v[188:191], a[148:151]
  v_mfma_f32_16x16x32_bf16 a[152:155], v[60:63], v[192:195], a[152:155]
  v_mfma_f32_16x16x32_bf16 a[156:159], v[60:63], v[196:199], a[156:159]
  s_waitcnt vmcnt(20)
  ds_read_b128 v[184:187], v1 offset:22528
  ds_read_b128 v[188:191], v1 offset:47104
  ds_read_b128 v[192:195], v6 offset:22528
  ds_read_b128 v[196:199], v6 offset:47104
  s_waitcnt lgkmcnt(4)
  v_mfma_f32_16x16x32_bf16 a[0:3], v[64:67], v[200:203], a[0:3]
  v_mfma_f32_16x16x32_bf16 a[4:7], v[64:67], v[204:207], a[4:7]
  v_mfma_f32_16x16x32_bf16 a[8:11], v[64:67], v[208:211], a[8:11]
  v_mfma_f32_16x16x32_bf16 a[12:15], v[64:67], v[212:215], a[12:15]
  v_mfma_f32_16x16x32_bf16 a[16:19], v[68:71], v[200:203], a[16:19]
  v_mfma_f32_16x16x32_bf16 a[20:23], v[68:71], v[204:207], a[20:23]
  v_mfma_f32_16x16x32_bf16 a[24:27], v[68:71], v[208:211], a[24:27]
  v_mfma_f32_16x16x32_bf16 a[28:31], v[68:71], v[212:215], a[28:31]
  v_mfma_f32_16x16x32_bf16 a[32:35], v[72:75], v[200:203], a[32:35]
  v_mfma_f32_16x16x32_bf16 a[36:39], v[72:75], v[204:207], a[36:39]
  v_mfma_f32_16x16x32_bf16 a[40:43], v[72:75], v[208:211], a[40:43]
  v_mfma_f32_16x16x32_bf16 a[44:47], v[72:75], v[212:215], a[44:47]
  v_mfma_f32_16x16x32_bf16 a[48:51], v[76:79], v[200:203], a[48:51]
  v_mfma_f32_16x16x32_bf16 a[52:55], v[76:79], v[204:207], a[52:55]
  v_mfma_f32_16x16x32_bf16 a[56:59], v[76:79], v[208:211], a[56:59]
  v_mfma_f32_16x16x32_bf16 a[60:63], v[76:79], v[212:215], a[60:63]
  v_mfma_f32_16x16x32_bf16 a[64:67], v[80:83], v[200:203], a[64:67]
  v_mfma_f32_16x16x32_bf16 a[68:71], v[80:83], v[204:207], a[68:71]
  v_mfma_f32_16x16x32_bf16 a[72:75], v[80:83], v[208:211], a[72:75]
  v_mfma_f32_16x16x32_bf16 a[76:79], v[80:83], v[212:215], a[76:79]
  v_mfma_f32_16x16x32_bf16 a[80:83], v[84:87], v[200:203], a[80:83]
  v_mfma_f32_16x16x32_bf16 a[84:87], v[84:87], v[204:207], a[84:87]
  v_mfma_f32_16x16x32_bf16 a[88:91], v[84:87], v[208:211], a[88:91]
  v_mfma_f32_16x16x32_bf16 a[92:95], v[84:87], v[212:215], a[92:95]
  v_mfma_f32_16x16x32_bf16 a[96:99], v[88:91], v[200:203], a[96:99]
  v_mfma_f32_16x16x32_bf16 a[100:103], v[88:91], v[204:207], a[100:103]
  v_mfma_f32_16x16x32_bf16 a[104:107], v[88:91], v[208:211], a[104:107]
  v_mfma_f32_16x16x32_bf16 a[108:111], v[88:91], v[212:215], a[108:111]
  v_mfma_f32_16x16x32_bf16 a[112:115], v[92:95], v[200:203], a[112:115]
  v_mfma_f32_16x16x32_bf16 a[116:119], v[92:95], v[204:207], a[116:119]
  v_mfma_f32_16x16x32_bf16 a[120:123], v[92:95], v[208:211], a[120:123]
  v_mfma_f32_16x16x32_bf16 a[124:127], v[92:95], v[212:215], a[124:127]
  v_mfma_f32_16x16x32_bf16 a[128:131], v[96:99], v[200:203], a[128:131]
  v_mfma_f32_16x16x32_bf16 a[132:135], v[96:99], v[204:207], a[132:135]
  v_mfma_f32_16x16x32_bf16 a[136:139], v[96:99], v[208:211], a[136:139]
  v_mfma_f32_16x16x32_bf16 a[140:143], v[96:99], v[212:215], a[140:143]
  v_mfma_f32_16x16x32_bf16 a[144:147], v[100:103], v[200:203], a[144:147]
  v_mfma_f32_16x16x32_bf16 a[148:151], v[100:103], v[204:207], a[148:151]
  v_mfma_f32_16x16x32_bf16 a[152:155], v[100:103], v[208:211], a[152:155]
  v_mfma_f32_16x16x32_bf16 a[156:159], v[100:103], v[212:215], a[156:159]
  s_waitcnt vmcnt(10)
  ds_read_b128 v[200:203], v1 offset:23552
  ds_read_b128 v[204:207], v1 offset:48128
  ds_read_b128 v[208:211], v6 offset:23552
  ds_read_b128 v[212:215], v6 offset:48128
  s_waitcnt lgkmcnt(4)
  v_mfma_f32_16x16x32_bf16 a[0:3], v[104:107], v[184:187], a[0:3]
  v_mfma_f32_16x16x32_bf16 a[4:7], v[104:107], v[188:191], a[4:7]
  v_mfma_f32_16x16x32_bf16 a[8:11], v[104:107], v[192:195], a[8:11]
  v_mfma_f32_16x16x32_bf16 a[12:15], v[104:107], v[196:199], a[12:15]
  v_mfma_f32_16x16x32_bf16 a[16:19], v[108:111], v[184:187], a[16:19]
  v_mfma_f32_16x16x32_bf16 a[20:23], v[108:111], v[188:191], a[20:23]
  v_mfma_f32_16x16x32_bf16 a[24:27], v[108:111], v[192:195], a[24:27]
  v_mfma_f32_16x16x32_bf16 a[28:31], v[108:111], v[196:199], a[28:31]
  v_mfma_f32_16x16x32_bf16 a[32:35], v[112:115], v[184:187], a[32:35]
  v_mfma_f32_16x16x32_bf16 a[36:39], v[112:115], v[188:191], a[36:39]
  v_mfma_f32_16x16x32_bf16 a[40:43], v[112:115], v[192:195], a[40:43]
  v_mfma_f32_16x16x32_bf16 a[44:47], v[112:115], v[196:199], a[44:47]
  v_mfma_f32_16x16x32_bf16 a[48:51], v[116:119], v[184:187], a[48:51]
  v_mfma_f32_16x16x32_bf16 a[52:55], v[116:119], v[188:191], a[52:55]
  v_mfma_f32_16x16x32_bf16 a[56:59], v[116:119], v[192:195], a[56:59]
  v_mfma_f32_16x16x32_bf16 a[60:63], v[116:119], v[196:199], a[60:63]
  v_mfma_f32_16x16x32_bf16 a[64:67], v[120:123], v[184:187], a[64:67]
  v_mfma_f32_16x16x32_bf16 a[68:71], v[120:123], v[188:191], a[68:71]
  v_mfma_f32_16x16x32_bf16 a[72:75], v[120:123], v[192:195], a[72:75]
  v_mfma_f32_16x16x32_bf16 a[76:79], v[120:123], v[196:199], a[76:79]
  v_mfma_f32_16x16x32_bf16 a[80:83], v[124:127], v[184:187], a[80:83]
  v_mfma_f32_16x16x32_bf16 a[84:87], v[124:127], v[188:191], a[84:87]
  v_mfma_f32_16x16x32_bf16 a[88:91], v[124:127], v[192:195], a[88:91]
  v_mfma_f32_16x16x32_bf16 a[92:95], v[124:127], v[196:199], a[92:95]
  v_mfma_f32_16x16x32_bf16 a[96:99], v[128:131], v[184:187], a[96:99]
  v_mfma_f32_16x16x32_bf16 a[100:103], v[128:131], v[188:191], a[100:103]
  v_mfma_f32_16x16x32_bf16 a[104:107], v[128:131], v[192:195], a[104:107]
  v_mfma_f32_16x16x32_bf16 a[108:111], v[128:131], v[196:199], a[108:111]
  v_mfma_f32_16x16x32_bf16 a[112:115], v[132:135], v[184:187], a[112:115]
  v_mfma_f32_16x16x32_bf16 a[116:119], v[132:135], v[188:191], a[116:119]
  v_mfma_f32_16x16x32_bf16 a[120:123], v[132:135], v[192:195], a[120:123]
  v_mfma_f32_16x16x32_bf16 a[124:127], v[132:135], v[196:199], a[124:127]
  v_mfma_f32_16x16x32_bf16 a[128:131], v[136:139], v[184:187], a[128:131]
  v_mfma_f32_16x16x32_bf16 a[132:135], v[136:139], v[188:191], a[132:135]
  v_mfma_f32_16x16x32_bf16 a[136:139], v[136:139], v[192:195], a[136:139]
  v_mfma_f32_16x16x32_bf16 a[140:143], v[136:139], v[196:199], a[140:143]
  v_mfma_f32_16x16x32_bf16 a[144:147], v[140:143], v[184:187], a[144:147]
  v_mfma_f32_16x16x32_bf16 a[148:151], v[140:143], v[188:191], a[148:151]
  v_mfma_f32_16x16x32_bf16 a[152:155], v[140:143], v[192:195], a[152:155]
  v_mfma_f32_16x16x32_bf16 a[156:159], v[140:143], v[196:199], a[156:159]
  s_waitcnt vmcnt(0)
  s_waitcnt lgkmcnt(0)
  v_mfma_f32_16x16x32_bf16 a[0:3], v[144:147], v[200:203], a[0:3]
  v_mfma_f32_16x16x32_bf16 a[4:7], v[144:147], v[204:207], a[4:7]
  v_mfma_f32_16x16x32_bf16 a[8:11], v[144:147], v[208:211], a[8:11]
  v_mfma_f32_16x16x32_bf16 a[12:15], v[144:147], v[212:215], a[12:15]
  v_mfma_f32_16x16x32_bf16 a[16:19], v[148:151], v[200:203], a[16:19]
  v_mfma_f32_16x16x32_bf16 a[20:23], v[148:151], v[204:207], a[20:23]
  v_mfma_f32_16x16x32_bf16 a[24:27], v[148:151], v[208:211], a[24:27]
  v_mfma_f32_16x16x32_bf16 a[28:31], v[148:151], v[212:215], a[28:31]
  v_mfma_f32_16x16x32_bf16 a[32:35], v[152:155], v[200:203], a[32:35]
  v_mfma_f32_16x16x32_bf16 a[36:39], v[152:155], v[204:207], a[36:39]
  v_mfma_f32_16x16x32_bf16 a[40:43], v[152:155], v[208:211], a[40:43]
  v_mfma_f32_16x16x32_bf16 a[44:47], v[152:155], v[212:215], a[44:47]
  v_mfma_f32_16x16x32_bf16 a[48:51], v[156:159], v[200:203], a[48:51]
  v_mfma_f32_16x16x32_bf16 a[52:55], v[156:159], v[204:207], a[52:55]
  v_mfma_f32_16x16x32_bf16 a[56:59], v[156:159], v[208:211], a[56:59]
  v_mfma_f32_16x16x32_bf16 a[60:63], v[156:159], v[212:215], a[60:63]
  v_mfma_f32_16x16x32_bf16 a[64:67], v[160:163], v[200:203], a[64:67]
  v_mfma_f32_16x16x32_bf16 a[68:71], v[160:163], v[204:207], a[68:71]
  v_mfma_f32_16x16x32_bf16 a[72:75], v[160:163], v[208:211], a[72:75]
  v_mfma_f32_16x16x32_bf16 a[76:79], v[160:163], v[212:215], a[76:79]
  v_mfma_f32_16x16x32_bf16 a[80:83], v[164:167], v[200:203], a[80:83]
  v_mfma_f32_16x16x32_bf16 a[84:87], v[164:167], v[204:207], a[84:87]
  v_mfma_f32_16x16x32_bf16 a[88:91], v[164:167], v[208:211], a[88:91]
  v_mfma_f32_16x16x32_bf16 a[92:95], v[164:167], v[212:215], a[92:95]
  v_mfma_f32_16x16x32_bf16 a[96:99], v[168:171], v[200:203], a[96:99]
  v_mfma_f32_16x16x32_bf16 a[100:103], v[168:171], v[204:207], a[100:103]
  v_mfma_f32_16x16x32_bf16 a[104:107], v[168:171], v[208:211], a[104:107]
  v_mfma_f32_16x16x32_bf16 a[108:111], v[168:171], v[212:215], a[108:111]
  v_mfma_f32_16x16x32_bf16 a[112:115], v[172:175], v[200:203], a[112:115]
  v_mfma_f32_16x16x32_bf16 a[116:119], v[172:175], v[204:207], a[116:119]
  v_mfma_f32_16x16x32_bf16 a[120:123], v[172:175], v[208:211], a[120:123]
  v_mfma_f32_16x16x32_bf16 a[124:127], v[172:175], v[212:215], a[124:127]
  v_mfma_f32_16x16x32_bf16 a[128:131], v[176:179], v[200:203], a[128:131]
  v_mfma_f32_16x16x32_bf16 a[132:135], v[176:179], v[204:207], a[132:135]
  v_mfma_f32_16x16x32_bf16 a[136:139], v[176:179], v[208:211], a[136:139]
  v_mfma_f32_16x16x32_bf16 a[140:143], v[176:179], v[212:215], a[140:143]
  v_mfma_f32_16x16x32_bf16 a[144:147], v[180:183], v[200:203], a[144:147]
  v_mfma_f32_16x16x32_bf16 a[148:151], v[180:183], v[204:207], a[148:151]
  v_mfma_f32_16x16x32_bf16 a[152:155], v[180:183], v[208:211], a[152:155]
  v_mfma_f32_16x16x32_bf16 a[156:159], v[180:183], v[212:215], a[156:159]
  s_lshl_b32 s16, s13, 7
  s_lshl_b32 s17, s14, 2
  s_add_u32 s16, s16, s17
  s_mul_i32 s16, s16, 20
  s_mul_i32 s17, s12, 5
  s_add_u32 s16, s16, s17
  s_lshl_b32 s16, s16, 10
  s_add_u32 s16, s16, 178257920
  s_nop 7
  s_add_u32 s17, s16, 0
  v_accvgpr_read_b32 v24, a0
  v_accvgpr_read_b32 v25, a1
  v_accvgpr_read_b32 v26, a2
  v_accvgpr_read_b32 v27, a3
  v_accvgpr_read_b32 v28, a16
  v_accvgpr_read_b32 v29, a17
  v_accvgpr_read_b32 v30, a18
  v_accvgpr_read_b32 v31, a19
  v_cvt_pk_bf16_f32 v32, v24, v25
  v_cvt_pk_bf16_f32 v33, v26, v27
  v_cvt_pk_bf16_f32 v34, v28, v29
  v_cvt_pk_bf16_f32 v35, v30, v31
  buffer_store_dwordx4 v[32:35], v1, s[4:7], s17 offen offset:0
  v_accvgpr_read_b32 v36, a32
  v_accvgpr_read_b32 v37, a33
  v_accvgpr_read_b32 v38, a34
  v_accvgpr_read_b32 v39, a35
  v_accvgpr_read_b32 v40, a48
  v_accvgpr_read_b32 v41, a49
  v_accvgpr_read_b32 v42, a50
  v_accvgpr_read_b32 v43, a51
  v_cvt_pk_bf16_f32 v44, v36, v37
  v_cvt_pk_bf16_f32 v45, v38, v39
  v_cvt_pk_bf16_f32 v46, v40, v41
  v_cvt_pk_bf16_f32 v47, v42, v43
  buffer_store_dwordx4 v[44:47], v1, s[4:7], s17 offen offset:1024
  v_accvgpr_read_b32 v48, a64
  v_accvgpr_read_b32 v49, a65
  v_accvgpr_read_b32 v50, a66
  v_accvgpr_read_b32 v51, a67
  v_accvgpr_read_b32 v52, a80
  v_accvgpr_read_b32 v53, a81
  v_accvgpr_read_b32 v54, a82
  v_accvgpr_read_b32 v55, a83
  v_cvt_pk_bf16_f32 v56, v48, v49
  v_cvt_pk_bf16_f32 v57, v50, v51
  v_cvt_pk_bf16_f32 v58, v52, v53
  v_cvt_pk_bf16_f32 v59, v54, v55
  buffer_store_dwordx4 v[56:59], v1, s[4:7], s17 offen offset:2048
  v_accvgpr_read_b32 v60, a96
  v_accvgpr_read_b32 v61, a97
  v_accvgpr_read_b32 v62, a98
  v_accvgpr_read_b32 v63, a99
  v_accvgpr_read_b32 v64, a112
  v_accvgpr_read_b32 v65, a113
  v_accvgpr_read_b32 v66, a114
  v_accvgpr_read_b32 v67, a115
  v_cvt_pk_bf16_f32 v68, v60, v61
  v_cvt_pk_bf16_f32 v69, v62, v63
  v_cvt_pk_bf16_f32 v70, v64, v65
  v_cvt_pk_bf16_f32 v71, v66, v67
  buffer_store_dwordx4 v[68:71], v1, s[4:7], s17 offen offset:3072
  v_accvgpr_read_b32 v24, a128
  v_accvgpr_read_b32 v25, a129
  v_accvgpr_read_b32 v26, a130
  v_accvgpr_read_b32 v27, a131
  v_accvgpr_read_b32 v28, a144
  v_accvgpr_read_b32 v29, a145
  v_accvgpr_read_b32 v30, a146
  v_accvgpr_read_b32 v31, a147
  v_cvt_pk_bf16_f32 v32, v24, v25
  v_cvt_pk_bf16_f32 v33, v26, v27
  v_cvt_pk_bf16_f32 v34, v28, v29
  v_cvt_pk_bf16_f32 v35, v30, v31
  s_add_u32 s17, s17, 4096
  buffer_store_dwordx4 v[32:35], v1, s[4:7], s17 offen offset:0
  s_add_u32 s17, s16, 20480
  v_accvgpr_read_b32 v36, a4
  v_accvgpr_read_b32 v37, a5
  v_accvgpr_read_b32 v38, a6
  v_accvgpr_read_b32 v39, a7
  v_accvgpr_read_b32 v40, a20
  v_accvgpr_read_b32 v41, a21
  v_accvgpr_read_b32 v42, a22
  v_accvgpr_read_b32 v43, a23
  v_cvt_pk_bf16_f32 v44, v36, v37
  v_cvt_pk_bf16_f32 v45, v38, v39
  v_cvt_pk_bf16_f32 v46, v40, v41
  v_cvt_pk_bf16_f32 v47, v42, v43
  buffer_store_dwordx4 v[44:47], v1, s[4:7], s17 offen offset:0
  v_accvgpr_read_b32 v48, a36
  v_accvgpr_read_b32 v49, a37
  v_accvgpr_read_b32 v50, a38
  v_accvgpr_read_b32 v51, a39
  v_accvgpr_read_b32 v52, a52
  v_accvgpr_read_b32 v53, a53
  v_accvgpr_read_b32 v54, a54
  v_accvgpr_read_b32 v55, a55
  v_cvt_pk_bf16_f32 v56, v48, v49
  v_cvt_pk_bf16_f32 v57, v50, v51
  v_cvt_pk_bf16_f32 v58, v52, v53
  v_cvt_pk_bf16_f32 v59, v54, v55
  buffer_store_dwordx4 v[56:59], v1, s[4:7], s17 offen offset:1024
  v_accvgpr_read_b32 v60, a68
  v_accvgpr_read_b32 v61, a69
  v_accvgpr_read_b32 v62, a70
  v_accvgpr_read_b32 v63, a71
  v_accvgpr_read_b32 v64, a84
  v_accvgpr_read_b32 v65, a85
  v_accvgpr_read_b32 v66, a86
  v_accvgpr_read_b32 v67, a87
  v_cvt_pk_bf16_f32 v68, v60, v61
  v_cvt_pk_bf16_f32 v69, v62, v63
  v_cvt_pk_bf16_f32 v70, v64, v65
  v_cvt_pk_bf16_f32 v71, v66, v67
  buffer_store_dwordx4 v[68:71], v1, s[4:7], s17 offen offset:2048
  v_accvgpr_read_b32 v24, a100
  v_accvgpr_read_b32 v25, a101
  v_accvgpr_read_b32 v26, a102
  v_accvgpr_read_b32 v27, a103
  v_accvgpr_read_b32 v28, a116
  v_accvgpr_read_b32 v29, a117
  v_accvgpr_read_b32 v30, a118
  v_accvgpr_read_b32 v31, a119
  v_cvt_pk_bf16_f32 v32, v24, v25
  v_cvt_pk_bf16_f32 v33, v26, v27
  v_cvt_pk_bf16_f32 v34, v28, v29
  v_cvt_pk_bf16_f32 v35, v30, v31
  buffer_store_dwordx4 v[32:35], v1, s[4:7], s17 offen offset:3072
  v_accvgpr_read_b32 v36, a132
  v_accvgpr_read_b32 v37, a133
  v_accvgpr_read_b32 v38, a134
  v_accvgpr_read_b32 v39, a135
  v_accvgpr_read_b32 v40, a148
  v_accvgpr_read_b32 v41, a149
  v_accvgpr_read_b32 v42, a150
  v_accvgpr_read_b32 v43, a151
  v_cvt_pk_bf16_f32 v44, v36, v37
  v_cvt_pk_bf16_f32 v45, v38, v39
  v_cvt_pk_bf16_f32 v46, v40, v41
  v_cvt_pk_bf16_f32 v47, v42, v43
  s_add_u32 s17, s17, 4096
  buffer_store_dwordx4 v[44:47], v1, s[4:7], s17 offen offset:0
  s_add_u32 s17, s16, 40960
  v_accvgpr_read_b32 v48, a8
  v_accvgpr_read_b32 v49, a9
  v_accvgpr_read_b32 v50, a10
  v_accvgpr_read_b32 v51, a11
  v_accvgpr_read_b32 v52, a24
  v_accvgpr_read_b32 v53, a25
  v_accvgpr_read_b32 v54, a26
  v_accvgpr_read_b32 v55, a27
  v_cvt_pk_bf16_f32 v56, v48, v49
  v_cvt_pk_bf16_f32 v57, v50, v51
  v_cvt_pk_bf16_f32 v58, v52, v53
  v_cvt_pk_bf16_f32 v59, v54, v55
  buffer_store_dwordx4 v[56:59], v1, s[4:7], s17 offen offset:0
  v_accvgpr_read_b32 v60, a40
  v_accvgpr_read_b32 v61, a41
  v_accvgpr_read_b32 v62, a42
  v_accvgpr_read_b32 v63, a43
  v_accvgpr_read_b32 v64, a56
  v_accvgpr_read_b32 v65, a57
  v_accvgpr_read_b32 v66, a58
  v_accvgpr_read_b32 v67, a59
  v_cvt_pk_bf16_f32 v68, v60, v61
  v_cvt_pk_bf16_f32 v69, v62, v63
  v_cvt_pk_bf16_f32 v70, v64, v65
  v_cvt_pk_bf16_f32 v71, v66, v67
  buffer_store_dwordx4 v[68:71], v1, s[4:7], s17 offen offset:1024
  v_accvgpr_read_b32 v24, a72
  v_accvgpr_read_b32 v25, a73
  v_accvgpr_read_b32 v26, a74
  v_accvgpr_read_b32 v27, a75
  v_accvgpr_read_b32 v28, a88
  v_accvgpr_read_b32 v29, a89
  v_accvgpr_read_b32 v30, a90
  v_accvgpr_read_b32 v31, a91
  v_cvt_pk_bf16_f32 v32, v24, v25
  v_cvt_pk_bf16_f32 v33, v26, v27
  v_cvt_pk_bf16_f32 v34, v28, v29
  v_cvt_pk_bf16_f32 v35, v30, v31
  buffer_store_dwordx4 v[32:35], v1, s[4:7], s17 offen offset:2048
  v_accvgpr_read_b32 v36, a104
  v_accvgpr_read_b32 v37, a105
  v_accvgpr_read_b32 v38, a106
  v_accvgpr_read_b32 v39, a107
  v_accvgpr_read_b32 v40, a120
  v_accvgpr_read_b32 v41, a121
  v_accvgpr_read_b32 v42, a122
  v_accvgpr_read_b32 v43, a123
  v_cvt_pk_bf16_f32 v44, v36, v37
  v_cvt_pk_bf16_f32 v45, v38, v39
  v_cvt_pk_bf16_f32 v46, v40, v41
  v_cvt_pk_bf16_f32 v47, v42, v43
  buffer_store_dwordx4 v[44:47], v1, s[4:7], s17 offen offset:3072
  v_accvgpr_read_b32 v48, a136
  v_accvgpr_read_b32 v49, a137
  v_accvgpr_read_b32 v50, a138
  v_accvgpr_read_b32 v51, a139
  v_accvgpr_read_b32 v52, a152
  v_accvgpr_read_b32 v53, a153
  v_accvgpr_read_b32 v54, a154
  v_accvgpr_read_b32 v55, a155
  v_cvt_pk_bf16_f32 v56, v48, v49
  v_cvt_pk_bf16_f32 v57, v50, v51
  v_cvt_pk_bf16_f32 v58, v52, v53
  v_cvt_pk_bf16_f32 v59, v54, v55
  s_add_u32 s17, s17, 4096
  buffer_store_dwordx4 v[56:59], v1, s[4:7], s17 offen offset:0
  s_add_u32 s17, s16, 61440
  v_accvgpr_read_b32 v60, a12
  v_accvgpr_read_b32 v61, a13
  v_accvgpr_read_b32 v62, a14
  v_accvgpr_read_b32 v63, a15
  v_accvgpr_read_b32 v64, a28
  v_accvgpr_read_b32 v65, a29
  v_accvgpr_read_b32 v66, a30
  v_accvgpr_read_b32 v67, a31
  v_cvt_pk_bf16_f32 v68, v60, v61
  v_cvt_pk_bf16_f32 v69, v62, v63
  v_cvt_pk_bf16_f32 v70, v64, v65
  v_cvt_pk_bf16_f32 v71, v66, v67
  buffer_store_dwordx4 v[68:71], v1, s[4:7], s17 offen offset:0
  v_accvgpr_read_b32 v24, a44
  v_accvgpr_read_b32 v25, a45
  v_accvgpr_read_b32 v26, a46
  v_accvgpr_read_b32 v27, a47
  v_accvgpr_read_b32 v28, a60
  v_accvgpr_read_b32 v29, a61
  v_accvgpr_read_b32 v30, a62
  v_accvgpr_read_b32 v31, a63
  v_cvt_pk_bf16_f32 v32, v24, v25
  v_cvt_pk_bf16_f32 v33, v26, v27
  v_cvt_pk_bf16_f32 v34, v28, v29
  v_cvt_pk_bf16_f32 v35, v30, v31
  buffer_store_dwordx4 v[32:35], v1, s[4:7], s17 offen offset:1024
  v_accvgpr_read_b32 v36, a76
  v_accvgpr_read_b32 v37, a77
  v_accvgpr_read_b32 v38, a78
  v_accvgpr_read_b32 v39, a79
  v_accvgpr_read_b32 v40, a92
  v_accvgpr_read_b32 v41, a93
  v_accvgpr_read_b32 v42, a94
  v_accvgpr_read_b32 v43, a95
  v_cvt_pk_bf16_f32 v44, v36, v37
  v_cvt_pk_bf16_f32 v45, v38, v39
  v_cvt_pk_bf16_f32 v46, v40, v41
  v_cvt_pk_bf16_f32 v47, v42, v43
  buffer_store_dwordx4 v[44:47], v1, s[4:7], s17 offen offset:2048
  v_accvgpr_read_b32 v48, a108
  v_accvgpr_read_b32 v49, a109
  v_accvgpr_read_b32 v50, a110
  v_accvgpr_read_b32 v51, a111
  v_accvgpr_read_b32 v52, a124
  v_accvgpr_read_b32 v53, a125
  v_accvgpr_read_b32 v54, a126
  v_accvgpr_read_b32 v55, a127
  v_cvt_pk_bf16_f32 v56, v48, v49
  v_cvt_pk_bf16_f32 v57, v50, v51
  v_cvt_pk_bf16_f32 v58, v52, v53
  v_cvt_pk_bf16_f32 v59, v54, v55
  buffer_store_dwordx4 v[56:59], v1, s[4:7], s17 offen offset:3072
  v_accvgpr_read_b32 v60, a140
  v_accvgpr_read_b32 v61, a141
  v_accvgpr_read_b32 v62, a142
  v_accvgpr_read_b32 v63, a143
  v_accvgpr_read_b32 v64, a156
  v_accvgpr_read_b32 v65, a157
  v_accvgpr_read_b32 v66, a158
  v_accvgpr_read_b32 v67, a159
  v_cvt_pk_bf16_f32 v68, v60, v61
  v_cvt_pk_bf16_f32 v69, v62, v63
  v_cvt_pk_bf16_f32 v70, v64, v65
  v_cvt_pk_bf16_f32 v71, v66, v67
  s_add_u32 s17, s17, 4096
  buffer_store_dwordx4 v[68:71], v1, s[4:7], s17 offen offset:0
fin_exit1:
  s_endpgm
.globl redln1_kernel
.p2align 8
.type redln1_kernel,@function
redln1_kernel:
  s_cmp_ge_u32 s2, 128
  s_cbranch_scc1 redln1_exit1
  s_load_dwordx2 s[12:13], s[0:1], 96
  s_load_dwordx2 s[14:15], s[0:1], 0
  v_lshrrev_b32 v2, 6, v0
  v_and_b32 v3, 63, v0
  s_nop 0
  v_readfirstlane_b32 s16, v2
  v_lshlrev_b32 v14, 4, v3
  s_waitcnt lgkmcnt(0)
  s_mov_b32 s4, s12
  s_mov_b32 s5, s13
  s_mov_b32 s6, 0x10000000
  s_mov_b32 s7, 0x20000
  s_mov_b32 s8, s14
  s_mov_b32 s9, s15
  s_mov_b32 s10, 2621440
  s_mov_b32 s11, 0x20000
  s_mov_b32 s20, 0
  v_and_b32 v2, 15, v3
  v_lshrrev_b32 v4, 4, v3
  s_lshl_b32 s17, s2, 4
  v_add_u32 v15, s17, v2
  v_mul_u32_u24 v15, 1280, v15
  v_lshl_add_u32 v15, v4, 4, v15
  s_mul_i32 s17, s16, 320
  s_add_u32 s20, s20, s17
  s_add_u32 s21, s17, 150994944
  s_mul_i32 s22, s2, 20
  s_mul_i32 s23, s16, 5
  s_add_u32 s22, s22, s23
  s_lshl_b32 s22, s22, 10
  s_add_u32 s22, s22, 178257920
  s_add_u32 s24, s22, 0
  s_add_u32 s25, s22, 2621440
  s_add_u32 s26, s22, 5242880
  s_add_u32 s27, s22, 7864320
  s_add_u32 s28, s22, 10485760
  s_add_u32 s29, s22, 13107200
  s_add_u32 s30, s22, 15728640
  s_add_u32 s31, s22, 18350080
  v_add_u32 v6, 0x1000, v14
  buffer_load_dwordx4 v[16:19], v15, s[8:11], s20 offen offset:0
  buffer_load_dwordx4 v[20:23], v15, s[8:11], s20 offen offset:64
  buffer_load_dwordx4 v[24:27], v15, s[8:11], s20 offen offset:128
  buffer_load_dwordx4 v[28:31], v15, s[8:11], s20 offen offset:192
  buffer_load_dwordx4 v[32:35], v15, s[8:11], s20 offen offset:256
  buffer_load_dwordx4 v[80:83], v14, s[4:7], s24 offen offset:0
  buffer_load_dwordx4 v[84:87], v14, s[4:7], s25 offen offset:0
  buffer_load_dwordx4 v[88:91], v14, s[4:7], s26 offen offset:0
  buffer_load_dwordx4 v[92:95], v14, s[4:7], s27 offen offset:0
  buffer_load_dwordx4 v[96:99], v14, s[4:7], s28 offen offset:0
  buffer_load_dwordx4 v[100:103], v14, s[4:7], s29 offen offset:0
  buffer_load_dwordx4 v[104:107], v14, s[4:7], s30 offen offset:0
  buffer_load_dwordx4 v[108:111], v14, s[4:7], s31 offen offset:0
  buffer_load_dwordx4 v[112:115], v14, s[4:7], s24 offen offset:1024
  buffer_load_dwordx4 v[116:119], v14, s[4:7], s25 offen offset:1024
  buffer_load_dwordx4 v[120:123], v14, s[4:7], s26 offen offset:1024
  buffer_load_dwordx4 v[124:127], v14, s[4:7], s27 offen offset:1024
  buffer_load_dwordx4 v[128:131], v14, s[4:7], s28 offen offset:1024
  buffer_load_dwordx4 v[132:135], v14, s[4:7], s29 offen offset:1024
  buffer_load_dwordx4 v[136:139], v14, s[4:7], s30 offen offset:1024
  buffer_load_dwordx4 v[140:143], v14, s[4:7], s31 offen offset:1024
  buffer_load_dwordx4 v[144:147], v14, s[4:7], s24 offen offset:2048
  buffer_load_dwordx4 v[148:151], v14, s[4:7], s25 offen offset:2048
  buffer_load_dwordx4 v[152:155], v14, s[4:7], s26 offen offset:2048
  buffer_load_dwordx4 v[156:159], v14, s[4:7], s27 offen offset:2048
  buffer_load_dwordx4 v[160:163], v14, s[4:7], s28 offen offset:2048
  buffer_load_dwordx4 v[164:167], v14, s[4:7], s29 offen offset:2048
  buffer_load_dwordx4 v[168:171], v14, s[4:7], s30 offen offset:2048
  buffer_load_dwordx4 v[172:175], v14, s[4:7], s31 offen offset:2048
  buffer_load_dwordx4 v[176:179], v14, s[4:7], s24 offen offset:3072
  buffer_load_dwordx4 v[180:183], v14, s[4:7], s25 offen offset:3072
  buffer_load_dwordx4 v[184:187], v14, s[4:7], s26 offen offset:3072
  buffer_load_dwordx4 v[188:191], v14, s[4:7], s27 offen offset:3072
  buffer_load_dwordx4 v[192:195], v14, s[4:7], s28 offen offset:3072
  buffer_load_dwordx4 v[196:199], v14, s[4:7], s29 offen offset:3072
  buffer_load_dwordx4 v[200:203], v14, s[4:7], s30 offen offset:3072
  buffer_load_dwordx4 v[204:207], v14, s[4:7], s31 offen offset:3072
  buffer_load_dwordx4 v[208:211], v6, s[4:7], s24 offen offset:0
  buffer_load_dwordx4 v[212:215], v6, s[4:7], s25 offen offset:0
  buffer_load_dwordx4 v[216:219], v6, s[4:7], s26 offen offset:0
  buffer_load_dwordx4 v[220:223], v6, s[4:7], s27 offen offset:0
  buffer_load_dwordx4 v[224:227], v6, s[4:7], s28 offen offset:0
  buffer_load_dwordx4 v[228:231], v6, s[4:7], s29 offen offset:0
  buffer_load_dwordx4 v[232:235], v6, s[4:7], s30 offen offset:0
  buffer_load_dwordx4 v[236:239], v6, s[4:7], s31 offen offset:0
  s_waitcnt vmcnt(32)
  v_lshlrev_b32 v36, 16, v80
  v_and_b32 v37, 0xffff0000, v80
  v_lshlrev_b32 v38, 16, v81
  v_and_b32 v39, 0xffff0000, v81
  v_lshlrev_b32 v40, 16, v82
  v_and_b32 v41, 0xffff0000, v82
  v_lshlrev_b32 v42, 16, v83
  v_and_b32 v43, 0xffff0000, v83
  v_lshlrev_b32 v8, 16, v84
  v_and_b32 v9, 0xffff0000, v84
  v_pk_add_f32 v[36:37], v[36:37], v[8:9]
  v_lshlrev_b32 v8, 16, v85
  v_and_b32 v9, 0xffff0000, v85
  v_pk_add_f32 v[38:39], v[38:39], v[8:9]
  v_lshlrev_b32 v8, 16, v86
  v_and_b32 v9, 0xffff0000, v86
  v_pk_add_f32 v[40:41], v[40:41], v[8:9]
  v_lshlrev_b32 v8, 16, v87
  v_and_b32 v9, 0xffff0000, v87
  v_pk_add_f32 v[42:43], v[42:43], v[8:9]
  v_lshlrev_b32 v8, 16, v88
  v_and_b32 v9, 0xffff0000, v88
  v_pk_add_f32 v[36:37], v[36:37], v[8:9]
  v_lshlrev_b32 v8, 16, v89
  v_and_b32 v9, 0xffff0000, v89
  v_pk_add_f32 v[38:39], v[38:39], v[8:9]
  v_lshlrev_b32 v8, 16, v90
  v_and_b32 v9, 0xffff0000, v90
  v_pk_add_f32 v[40:41], v[40:41], v[8:9]
  v_lshlrev_b32 v8, 16, v91
  v_and_b32 v9, 0xffff0000, v91
  v_pk_add_f32 v[42:43], v[42:43], v[8:9]
  v_lshlrev_b32 v8, 16, v92
  v_and_b32 v9, 0xffff0000, v92
  v_pk_add_f32 v[36:37], v[36:37], v[8:9]
  v_lshlrev_b32 v8, 16, v93
  v_and_b32 v9, 0xffff0000, v93
  v_pk_add_f32 v[38:39], v[38:39], v[8:9]
  v_lshlrev_b32 v8, 16, v94
  v_and_b32 v9, 0xffff0000, v94
  v_pk_add_f32 v[40:41], v[40:41], v[8:9]
  v_lshlrev_b32 v8, 16, v95
  v_and_b32 v9, 0xffff0000, v95
  v_pk_add_f32 v[42:43], v[42:43], v[8:9]
  v_lshlrev_b32 v8, 16, v96
  v_and_b32 v9, 0xffff0000, v96
  v_pk_add_f32 v[36:37], v[36:37], v[8:9]
  v_lshlrev_b32 v8, 16, v97
  v_and_b32 v9, 0xffff0000, v97
  v_pk_add_f32 v[38:39], v[38:39], v[8:9]
  v_lshlrev_b32 v8, 16, v98
  v_and_b32 v9, 0xffff0000, v98
  v_pk_add_f32 v[40:41], v[40:41], v[8:9]
  v_lshlrev_b32 v8, 16, v99
  v_and_b32 v9, 0xffff0000, v99
  v_pk_add_f32 v[42:43], v[42:43], v[8:9]
  v_lshlrev_b32 v8, 16, v100
  v_and_b32 v9, 0xffff0000, v100
  v_pk_add_f32 v[36:37], v[36:37], v[8:9]
  v_lshlrev_b32 v8, 16, v101
  v_and_b32 v9, 0xffff0000, v101
  v_pk_add_f32 v[38:39], v[38:39], v[8:9]
  v_lshlrev_b32 v8, 16, v102
  v_and_b32 v9, 0xffff0000, v102
  v_pk_add_f32 v[40:41], v[40:41], v[8:9]
  v_lshlrev_b32 v8, 16, v103
  v_and_b32 v9, 0xffff0000, v103
  v_pk_add_f32 v[42:43], v[42:43], v[8:9]
  v_lshlrev_b32 v8, 16, v104
  v_and_b32 v9, 0xffff0000, v104
  v_pk_add_f32 v[36:37], v[36:37], v[8:9]
  v_lshlrev_b32 v8, 16, v105
  v_and_b32 v9, 0xffff0000, v105
  v_pk_add_f32 v[38:39], v[38:39], v[8:9]
  v_lshlrev_b32 v8, 16, v106
  v_and_b32 v9, 0xffff0000, v106
  v_pk_add_f32 v[40:41], v[40:41], v[8:9]
  v_lshlrev_b32 v8, 16, v107
  v_and_b32 v9, 0xffff0000, v107
  v_pk_add_f32 v[42:43], v[42:43], v[8:9]
  v_lshlrev_b32 v8, 16, v108
  v_and_b32 v9, 0xffff0000, v108
  v_pk_add_f32 v[36:37], v[36:37], v[8:9]
  v_lshlrev_b32 v8, 16, v109
  v_and_b32 v9, 0xffff0000, v109
  v_pk_add_f32 v[38:39], v[38:39], v[8:9]
  v_lshlrev_b32 v8, 16, v110
  v_and_b32 v9, 0xffff0000, v110
  v_pk_add_f32 v[40:41], v[40:41], v[8:9]
  v_lshlrev_b32 v8, 16, v111
  v_and_b32 v9, 0xffff0000, v111
  v_pk_add_f32 v[42:43], v[42:43], v[8:9]
  v_cvt_pk_bf16_f32 v8, v36, v37
  v_lshlrev_b32 v36, 16, v8
  v_and_b32 v37, 0xffff0000, v8
  v_lshlrev_b32 v10, 16, v16
  v_and_b32 v11, 0xffff0000, v16
  v_pk_add_f32 v[36:37], v[36:37], v[10:11]
  v_cvt_pk_bf16_f32 v16, v36, v37
  v_lshlrev_b32 v36, 16, v16
  v_and_b32 v37, 0xffff0000, v16
  v_cvt_pk_bf16_f32 v8, v38, v39
  v_lshlrev_b32 v38, 16, v8
  v_and_b32 v39, 0xffff0000, v8
  v_lshlrev_b32 v10, 16, v17
  v_and_b32 v11, 0xffff0000, v17
  v_pk_add_f32 v[38:39], v[38:39], v[10:11]
  v_cvt_pk_bf16_f32 v17, v38, v39
  v_lshlrev_b32 v38, 16, v17
  v_and_b32 v39, 0xffff0000, v17
  v_cvt_pk_bf16_f32 v8, v40, v41
  v_lshlrev_b32 v40, 16, v8
  v_and_b32 v41, 0xffff0000, v8
  v_lshlrev_b32 v10, 16, v18
  v_and_b32 v11, 0xffff0000, v18
  v_pk_add_f32 v[40:41], v[40:41], v[10:11]
  v_cvt_pk_bf16_f32 v18, v40, v41
  v_lshlrev_b32 v40, 16, v18
  v_and_b32 v41, 0xffff0000, v18
  v_cvt_pk_bf16_f32 v8, v42, v43
  v_lshlrev_b32 v42, 16, v8
  v_and_b32 v43, 0xffff0000, v8
  v_lshlrev_b32 v10, 16, v19
  v_and_b32 v11, 0xffff0000, v19
  v_pk_add_f32 v[42:43], v[42:43], v[10:11]
  v_cvt_pk_bf16_f32 v19, v42, v43
  v_lshlrev_b32 v42, 16, v19
  v_and_b32 v43, 0xffff0000, v19
  buffer_store_dwordx4 v[16:19], v15, s[4:7], s21 offen offset:0
  s_waitcnt vmcnt(25)
  v_lshlrev_b32 v44, 16, v112
  v_and_b32 v45, 0xffff0000, v112
  v_lshlrev_b32 v46, 16, v113
  v_and_b32 v47, 0xffff0000, v113
  v_lshlrev_b32 v48, 16, v114
  v_and_b32 v49, 0xffff0000, v114
  v_lshlrev_b32 v50, 16, v115
  v_and_b32 v51, 0xffff0000, v115
  v_lshlrev_b32 v8, 16, v116
  v_and_b32 v9, 0xffff0000, v116
  v_pk_add_f32 v[44:45], v[44:45], v[8:9]
  v_lshlrev_b32 v8, 16, v117
  v_and_b32 v9, 0xffff0000, v117
  v_pk_add_f32 v[46:47], v[46:47], v[8:9]
  v_lshlrev_b32 v8, 16, v118
  v_and_b32 v9, 0xffff0000, v118
  v_pk_add_f32 v[48:49], v[48:49], v[8:9]
  v_lshlrev_b32 v8, 16, v119
  v_and_b32 v9, 0xffff0000, v119
  v_pk_add_f32 v[50:51], v[50:51], v[8:9]
  v_lshlrev_b32 v8, 16, v120
  v_and_b32 v9, 0xffff0000, v120
  v_pk_add_f32 v[44:45], v[44:45], v[8:9]
  v_lshlrev_b32 v8, 16, v121
  v_and_b32 v9, 0xffff0000, v121
  v_pk_add_f32 v[46:47], v[46:47], v[8:9]
  v_lshlrev_b32 v8, 16, v122
  v_and_b32 v9, 0xffff0000, v122
  v_pk_add_f32 v[48:49], v[48:49], v[8:9]
  v_lshlrev_b32 v8, 16, v123
  v_and_b32 v9, 0xffff0000, v123
  v_pk_add_f32 v[50:51], v[50:51], v[8:9]
  v_lshlrev_b32 v8, 16, v124
  v_and_b32 v9, 0xffff0000, v124
  v_pk_add_f32 v[44:45], v[44:45], v[8:9]
  v_lshlrev_b32 v8, 16, v125
  v_and_b32 v9, 0xffff0000, v125
  v_pk_add_f32 v[46:47], v[46:47], v[8:9]
  v_lshlrev_b32 v8, 16, v126
  v_and_b32 v9, 0xffff0000, v126
  v_pk_add_f32 v[48:49], v[48:49], v[8:9]
  v_lshlrev_b32 v8, 16, v127
  v_and_b32 v9, 0xffff0000, v127
  v_pk_add_f32 v[50:51], v[50:51], v[8:9]
  v_lshlrev_b32 v8, 16, v128
  v_and_b32 v9, 0xffff0000, v128
  v_pk_add_f32 v[44:45], v[44:45], v[8:9]
  v_lshlrev_b32 v8, 16, v129
  v_and_b32 v9, 0xffff0000, v129
  v_pk_add_f32 v[46:47], v[46:47], v[8:9]
  v_lshlrev_b32 v8, 16, v130
  v_and_b32 v9, 0xffff0000, v130
  v_pk_add_f32 v[48:49], v[48:49], v[8:9]
  v_lshlrev_b32 v8, 16, v131
  v_and_b32 v9, 0xffff0000, v131
  v_pk_add_f32 v[50:51], v[50:51], v[8:9]
  v_lshlrev_b32 v8, 16, v132
  v_and_b32 v9, 0xffff0000, v132
  v_pk_add_f32 v[44:45], v[44:45], v[8:9]
  v_lshlrev_b32 v8, 16, v133
  v_and_b32 v9, 0xffff0000, v133
  v_pk_add_f32 v[46:47], v[46:47], v[8:9]
  v_lshlrev_b32 v8, 16, v134
  v_and_b32 v9, 0xffff0000, v134
  v_pk_add_f32 v[48:49], v[48:49], v[8:9]
  v_lshlrev_b32 v8, 16, v135
  v_and_b32 v9, 0xffff0000, v135
  v_pk_add_f32 v[50:51], v[50:51], v[8:9]
  v_lshlrev_b32 v8, 16, v136
  v_and_b32 v9, 0xffff0000, v136
  v_pk_add_f32 v[44:45], v[44:45], v[8:9]
  v_lshlrev_b32 v8, 16, v137
  v_and_b32 v9, 0xffff0000, v137
  v_pk_add_f32 v[46:47], v[46:47], v[8:9]
  v_lshlrev_b32 v8, 16, v138
  v_and_b32 v9, 0xffff0000, v138
  v_pk_add_f32 v[48:49], v[48:49], v[8:9]
  v_lshlrev_b32 v8, 16, v139
  v_and_b32 v9, 0xffff0000, v139
  v_pk_add_f32 v[50:51], v[50:51], v[8:9]
  v_lshlrev_b32 v8, 16, v140
  v_and_b32 v9, 0xffff0000, v140
  v_pk_add_f32 v[44:45], v[44:45], v[8:9]
  v_lshlrev_b32 v8, 16, v141
  v_and_b32 v9, 0xffff0000, v141
  v_pk_add_f32 v[46:47], v[46:47], v[8:9]
  v_lshlrev_b32 v8, 16, v142
  v_and_b32 v9, 0xffff0000, v142
  v_pk_add_f32 v[48:49], v[48:49], v[8:9]
  v_lshlrev_b32 v8, 16, v143
  v_and_b32 v9, 0xffff0000, v143
  v_pk_add_f32 v[50:51], v[50:51], v[8:9]
  v_cvt_pk_bf16_f32 v8, v44, v45
  v_lshlrev_b32 v44, 16, v8
  v_and_b32 v45, 0xffff0000, v8
  v_lshlrev_b32 v10, 16, v20
  v_and_b32 v11, 0xffff0000, v20
  v_pk_add_f32 v[44:45], v[44:45], v[10:11]
  v_cvt_pk_bf16_f32 v20, v44, v45
  v_lshlrev_b32 v44, 16, v20
  v_and_b32 v45, 0xffff0000, v20
  v_cvt_pk_bf16_f32 v8, v46, v47
  v_lshlrev_b32 v46, 16, v8
  v_and_b32 v47, 0xffff0000, v8
  v_lshlrev_b32 v10, 16, v21
  v_and_b32 v11, 0xffff0000, v21
  v_pk_add_f32 v[46:47], v[46:47], v[10:11]
  v_cvt_pk_bf16_f32 v21, v46, v47
  v_lshlrev_b32 v46, 16, v21
  v_and_b32 v47, 0xffff0000, v21
  v_cvt_pk_bf16_f32 v8, v48, v49
  v_lshlrev_b32 v48, 16, v8
  v_and_b32 v49, 0xffff0000, v8
  v_lshlrev_b32 v10, 16, v22
  v_and_b32 v11, 0xffff0000, v22
  v_pk_add_f32 v[48:49], v[48:49], v[10:11]
  v_cvt_pk_bf16_f32 v22, v48, v49
  v_lshlrev_b32 v48, 16, v22
  v_and_b32 v49, 0xffff0000, v22
  v_cvt_pk_bf16_f32 v8, v50, v51
  v_lshlrev_b32 v50, 16, v8
  v_and_b32 v51, 0xffff0000, v8
  v_lshlrev_b32 v10, 16, v23
  v_and_b32 v11, 0xffff0000, v23
  v_pk_add_f32 v[50:51], v[50:51], v[10:11]
  v_cvt_pk_bf16_f32 v23, v50, v51
  v_lshlrev_b32 v50, 16, v23
  v_and_b32 v51, 0xffff0000, v23
  buffer_store_dwordx4 v[20:23], v15, s[4:7], s21 offen offset:64
  s_waitcnt vmcnt(18)
  v_lshlrev_b32 v52, 16, v144
  v_and_b32 v53, 0xffff0000, v144
  v_lshlrev_b32 v54, 16, v145
  v_and_b32 v55, 0xffff0000, v145
  v_lshlrev_b32 v56, 16, v146
  v_and_b32 v57, 0xffff0000, v146
  v_lshlrev_b32 v58, 16, v147
  v_and_b32 v59, 0xffff0000, v147
  v_lshlrev_b32 v8, 16, v148
  v_and_b32 v9, 0xffff0000, v148
  v_pk_add_f32 v[52:53], v[52:53], v[8:9]
  v_lshlrev_b32 v8, 16, v149
  v_and_b32 v9, 0xffff0000, v149
  v_pk_add_f32 v[54:55], v[54:55], v[8:9]
  v_lshlrev_b32 v8, 16, v150
  v_and_b32 v9, 0xffff0000, v150
  v_pk_add_f32 v[56:57], v[56:57], v[8:9]
  v_lshlrev_b32 v8, 16, v151
  v_and_b32 v9, 0xffff0000, v151
  v_pk_add_f32 v[58:59], v[58:59], v[8:9]
  v_lshlrev_b32 v8, 16, v152
  v_and_b32 v9, 0xffff0000, v152
  v_pk_add_f32 v[52:53], v[52:53], v[8:9]
  v_lshlrev_b32 v8, 16, v153
  v_and_b32 v9, 0xffff0000, v153
  v_pk_add_f32 v[54:55], v[54:55], v[8:9]
  v_lshlrev_b32 v8, 16, v154
  v_and_b32 v9, 0xffff0000, v154
  v_pk_add_f32 v[56:57], v[56:57], v[8:9]
  v_lshlrev_b32 v8, 16, v155
  v_and_b32 v9, 0xffff0000, v155
  v_pk_add_f32 v[58:59], v[58:59], v[8:9]
  v_lshlrev_b32 v8, 16, v156
  v_and_b32 v9, 0xffff0000, v156
  v_pk_add_f32 v[52:53], v[52:53], v[8:9]
  v_lshlrev_b32 v8, 16, v157
  v_and_b32 v9, 0xffff0000, v157
  v_pk_add_f32 v[54:55], v[54:55], v[8:9]
  v_lshlrev_b32 v8, 16, v158
  v_and_b32 v9, 0xffff0000, v158
  v_pk_add_f32 v[56:57], v[56:57], v[8:9]
  v_lshlrev_b32 v8, 16, v159
  v_and_b32 v9, 0xffff0000, v159
  v_pk_add_f32 v[58:59], v[58:59], v[8:9]
  v_lshlrev_b32 v8, 16, v160
  v_and_b32 v9, 0xffff0000, v160
  v_pk_add_f32 v[52:53], v[52:53], v[8:9]
  v_lshlrev_b32 v8, 16, v161
  v_and_b32 v9, 0xffff0000, v161
  v_pk_add_f32 v[54:55], v[54:55], v[8:9]
  v_lshlrev_b32 v8, 16, v162
  v_and_b32 v9, 0xffff0000, v162
  v_pk_add_f32 v[56:57], v[56:57], v[8:9]
  v_lshlrev_b32 v8, 16, v163
  v_and_b32 v9, 0xffff0000, v163
  v_pk_add_f32 v[58:59], v[58:59], v[8:9]
  v_lshlrev_b32 v8, 16, v164
  v_and_b32 v9, 0xffff0000, v164
  v_pk_add_f32 v[52:53], v[52:53], v[8:9]
  v_lshlrev_b32 v8, 16, v165
  v_and_b32 v9, 0xffff0000, v165
  v_pk_add_f32 v[54:55], v[54:55], v[8:9]
  v_lshlrev_b32 v8, 16, v166
  v_and_b32 v9, 0xffff0000, v166
  v_pk_add_f32 v[56:57], v[56:57], v[8:9]
  v_lshlrev_b32 v8, 16, v167
  v_and_b32 v9, 0xffff0000, v167
  v_pk_add_f32 v[58:59], v[58:59], v[8:9]
  v_lshlrev_b32 v8, 16, v168
  v_and_b32 v9, 0xffff0000, v168
  v_pk_add_f32 v[52:53], v[52:53], v[8:9]
  v_lshlrev_b32 v8, 16, v169
  v_and_b32 v9, 0xffff0000, v169
  v_pk_add_f32 v[54:55], v[54:55], v[8:9]
  v_lshlrev_b32 v8, 16, v170
  v_and_b32 v9, 0xffff0000, v170
  v_pk_add_f32 v[56:57], v[56:57], v[8:9]
  v_lshlrev_b32 v8, 16, v171
  v_and_b32 v9, 0xffff0000, v171
  v_pk_add_f32 v[58:59], v[58:59], v[8:9]
  v_lshlrev_b32 v8, 16, v172
  v_and_b32 v9, 0xffff0000, v172
  v_pk_add_f32 v[52:53], v[52:53], v[8:9]
  v_lshlrev_b32 v8, 16, v173
  v_and_b32 v9, 0xffff0000, v173
  v_pk_add_f32 v[54:55], v[54:55], v[8:9]
  v_lshlrev_b32 v8, 16, v174
  v_and_b32 v9, 0xffff0000, v174
  v_pk_add_f32 v[56:57], v[56:57], v[8:9]
  v_lshlrev_b32 v8, 16, v175
  v_and_b32 v9, 0xffff0000, v175
  v_pk_add_f32 v[58:59], v[58:59], v[8:9]
  v_cvt_pk_bf16_f32 v8, v52, v53
  v_lshlrev_b32 v52, 16, v8
  v_and_b32 v53, 0xffff0000, v8
  v_lshlrev_b32 v10, 16, v24
  v_and_b32 v11, 0xffff0000, v24
  v_pk_add_f32 v[52:53], v[52:53], v[10:11]
  v_cvt_pk_bf16_f32 v24, v52, v53
  v_lshlrev_b32 v52, 16, v24
  v_and_b32 v53, 0xffff0000, v24
  v_cvt_pk_bf16_f32 v8, v54, v55
  v_lshlrev_b32 v54, 16, v8
  v_and_b32 v55, 0xffff0000, v8
  v_lshlrev_b32 v10, 16, v25
  v_and_b32 v11, 0xffff0000, v25
  v_pk_add_f32 v[54:55], v[54:55], v[10:11]
  v_cvt_pk_bf16_f32 v25, v54, v55
  v_lshlrev_b32 v54, 16, v25
  v_and_b32 v55, 0xffff0000, v25
  v_cvt_pk_bf16_f32 v8, v56, v57
  v_lshlrev_b32 v56, 16, v8
  v_and_b32 v57, 0xffff0000, v8
  v_lshlrev_b32 v10, 16, v26
  v_and_b32 v11, 0xffff0000, v26
  v_pk_add_f32 v[56:57], v[56:57], v[10:11]
  v_cvt_pk_bf16_f32 v26, v56, v57
  v_lshlrev_b32 v56, 16, v26
  v_and_b32 v57, 0xffff0000, v26
  v_cvt_pk_bf16_f32 v8, v58, v59
  v_lshlrev_b32 v58, 16, v8
  v_and_b32 v59, 0xffff0000, v8
  v_lshlrev_b32 v10, 16, v27
  v_and_b32 v11, 0xffff0000, v27
  v_pk_add_f32 v[58:59], v[58:59], v[10:11]
  v_cvt_pk_bf16_f32 v27, v58, v59
  v_lshlrev_b32 v58, 16, v27
  v_and_b32 v59, 0xffff0000, v27
  buffer_store_dwordx4 v[24:27], v15, s[4:7], s21 offen offset:128
  s_waitcnt vmcnt(11)
  v_lshlrev_b32 v60, 16, v176
  v_and_b32 v61, 0xffff0000, v176
  v_lshlrev_b32 v62, 16, v177
  v_and_b32 v63, 0xffff0000, v177
  v_lshlrev_b32 v64, 16, v178
  v_and_b32 v65, 0xffff0000, v178
  v_lshlrev_b32 v66, 16, v179
  v_and_b32 v67, 0xffff0000, v179
  v_lshlrev_b32 v8, 16, v180
  v_and_b32 v9, 0xffff0000, v180
  v_pk_add_f32 v[60:61], v[60:61], v[8:9]
  v_lshlrev_b32 v8, 16, v181
  v_and_b32 v9, 0xffff0000, v181
  v_pk_add_f32 v[62:63], v[62:63], v[8:9]
  v_lshlrev_b32 v8, 16, v182
  v_and_b32 v9, 0xffff0000, v182
  v_pk_add_f32 v[64:65], v[64:65], v[8:9]
  v_lshlrev_b32 v8, 16, v183
  v_and_b32 v9, 0xffff0000, v183
  v_pk_add_f32 v[66:67], v[66:67], v[8:9]
  v_lshlrev_b32 v8, 16, v184
  v_and_b32 v9, 0xffff0000, v184
  v_pk_add_f32 v[60:61], v[60:61], v[8:9]
  v_lshlrev_b32 v8, 16, v185
  v_and_b32 v9, 0xffff0000, v185
  v_pk_add_f32 v[62:63], v[62:63], v[8:9]
  v_lshlrev_b32 v8, 16, v186
  v_and_b32 v9, 0xffff0000, v186
  v_pk_add_f32 v[64:65], v[64:65], v[8:9]
  v_lshlrev_b32 v8, 16, v187
  v_and_b32 v9, 0xffff0000, v187
  v_pk_add_f32 v[66:67], v[66:67], v[8:9]
  v_lshlrev_b32 v8, 16, v188
  v_and_b32 v9, 0xffff0000, v188
  v_pk_add_f32 v[60:61], v[60:61], v[8:9]
  v_lshlrev_b32 v8, 16, v189
  v_and_b32 v9, 0xffff0000, v189
  v_pk_add_f32 v[62:63], v[62:63], v[8:9]
  v_lshlrev_b32 v8, 16, v190
  v_and_b32 v9, 0xffff0000, v190
  v_pk_add_f32 v[64:65], v[64:65], v[8:9]
  v_lshlrev_b32 v8, 16, v191
  v_and_b32 v9, 0xffff0000, v191
  v_pk_add_f32 v[66:67], v[66:67], v[8:9]
  v_lshlrev_b32 v8, 16, v192
  v_and_b32 v9, 0xffff0000, v192
  v_pk_add_f32 v[60:61], v[60:61], v[8:9]
  v_lshlrev_b32 v8, 16, v193
  v_and_b32 v9, 0xffff0000, v193
  v_pk_add_f32 v[62:63], v[62:63], v[8:9]
  v_lshlrev_b32 v8, 16, v194
  v_and_b32 v9, 0xffff0000, v194
  v_pk_add_f32 v[64:65], v[64:65], v[8:9]
  v_lshlrev_b32 v8, 16, v195
  v_and_b32 v9, 0xffff0000, v195
  v_pk_add_f32 v[66:67], v[66:67], v[8:9]
  v_lshlrev_b32 v8, 16, v196
  v_and_b32 v9, 0xffff0000, v196
  v_pk_add_f32 v[60:61], v[60:61], v[8:9]
  v_lshlrev_b32 v8, 16, v197
  v_and_b32 v9, 0xffff0000, v197
  v_pk_add_f32 v[62:63], v[62:63], v[8:9]
  v_lshlrev_b32 v8, 16, v198
  v_and_b32 v9, 0xffff0000, v198
  v_pk_add_f32 v[64:65], v[64:65], v[8:9]
  v_lshlrev_b32 v8, 16, v199
  v_and_b32 v9, 0xffff0000, v199
  v_pk_add_f32 v[66:67], v[66:67], v[8:9]
  v_lshlrev_b32 v8, 16, v200
  v_and_b32 v9, 0xffff0000, v200
  v_pk_add_f32 v[60:61], v[60:61], v[8:9]
  v_lshlrev_b32 v8, 16, v201
  v_and_b32 v9, 0xffff0000, v201
  v_pk_add_f32 v[62:63], v[62:63], v[8:9]
  v_lshlrev_b32 v8, 16, v202
  v_and_b32 v9, 0xffff0000, v202
  v_pk_add_f32 v[64:65], v[64:65], v[8:9]
  v_lshlrev_b32 v8, 16, v203
  v_and_b32 v9, 0xffff0000, v203
  v_pk_add_f32 v[66:67], v[66:67], v[8:9]
  v_lshlrev_b32 v8, 16, v204
  v_and_b32 v9, 0xffff0000, v204
  v_pk_add_f32 v[60:61], v[60:61], v[8:9]
  v_lshlrev_b32 v8, 16, v205
  v_and_b32 v9, 0xffff0000, v205
  v_pk_add_f32 v[62:63], v[62:63], v[8:9]
  v_lshlrev_b32 v8, 16, v206
  v_and_b32 v9, 0xffff0000, v206
  v_pk_add_f32 v[64:65], v[64:65], v[8:9]
  v_lshlrev_b32 v8, 16, v207
  v_and_b32 v9, 0xffff0000, v207
  v_pk_add_f32 v[66:67], v[66:67], v[8:9]
  v_cvt_pk_bf16_f32 v8, v60, v61
  v_lshlrev_b32 v60, 16, v8
  v_and_b32 v61, 0xffff0000, v8
  v_lshlrev_b32 v10, 16, v28
  v_and_b32 v11, 0xffff0000, v28
  v_pk_add_f32 v[60:61], v[60:61], v[10:11]
  v_cvt_pk_bf16_f32 v28, v60, v61
  v_lshlrev_b32 v60, 16, v28
  v_and_b32 v61, 0xffff0000, v28
  v_cvt_pk_bf16_f32 v8, v62, v63
  v_lshlrev_b32 v62, 16, v8
  v_and_b32 v63, 0xffff0000, v8
  v_lshlrev_b32 v10, 16, v29
  v_and_b32 v11, 0xffff0000, v29
  v_pk_add_f32 v[62:63], v[62:63], v[10:11]
  v_cvt_pk_bf16_f32 v29, v62, v63
  v_lshlrev_b32 v62, 16, v29
  v_and_b32 v63, 0xffff0000, v29
  v_cvt_pk_bf16_f32 v8, v64, v65
  v_lshlrev_b32 v64, 16, v8
  v_and_b32 v65, 0xffff0000, v8
  v_lshlrev_b32 v10, 16, v30
  v_and_b32 v11, 0xffff0000, v30
  v_pk_add_f32 v[64:65], v[64:65], v[10:11]
  v_cvt_pk_bf16_f32 v30, v64, v65
  v_lshlrev_b32 v64, 16, v30
  v_and_b32 v65, 0xffff0000, v30
  v_cvt_pk_bf16_f32 v8, v66, v67
  v_lshlrev_b32 v66, 16, v8
  v_and_b32 v67, 0xffff0000, v8
  v_lshlrev_b32 v10, 16, v31
  v_and_b32 v11, 0xffff0000, v31
  v_pk_add_f32 v[66:67], v[66:67], v[10:11]
  v_cvt_pk_bf16_f32 v31, v66, v67
  v_lshlrev_b32 v66, 16, v31
  v_and_b32 v67, 0xffff0000, v31
  buffer_store_dwordx4 v[28:31], v15, s[4:7], s21 offen offset:192
  s_waitcnt vmcnt(4)
  v_lshlrev_b32 v68, 16, v208
  v_and_b32 v69, 0xffff0000, v208
  v_lshlrev_b32 v70, 16, v209
  v_and_b32 v71, 0xffff0000, v209
  v_lshlrev_b32 v72, 16, v210
  v_and_b32 v73, 0xffff0000, v210
  v_lshlrev_b32 v74, 16, v211
  v_and_b32 v75, 0xffff0000, v211
  v_lshlrev_b32 v8, 16, v212
  v_and_b32 v9, 0xffff0000, v212
  v_pk_add_f32 v[68:69], v[68:69], v[8:9]
  v_lshlrev_b32 v8, 16, v213
  v_and_b32 v9, 0xffff0000, v213
  v_pk_add_f32 v[70:71], v[70:71], v[8:9]
  v_lshlrev_b32 v8, 16, v214
  v_and_b32 v9, 0xffff0000, v214
  v_pk_add_f32 v[72:73], v[72:73], v[8:9]
  v_lshlrev_b32 v8, 16, v215
  v_and_b32 v9, 0xffff0000, v215
  v_pk_add_f32 v[74:75], v[74:75], v[8:9]
  v_lshlrev_b32 v8, 16, v216
  v_and_b32 v9, 0xffff0000, v216
  v_pk_add_f32 v[68:69], v[68:69], v[8:9]
  v_lshlrev_b32 v8, 16, v217
  v_and_b32 v9, 0xffff0000, v217
  v_pk_add_f32 v[70:71], v[70:71], v[8:9]
  v_lshlrev_b32 v8, 16, v218
  v_and_b32 v9, 0xffff0000, v218
  v_pk_add_f32 v[72:73], v[72:73], v[8:9]
  v_lshlrev_b32 v8, 16, v219
  v_and_b32 v9, 0xffff0000, v219
  v_pk_add_f32 v[74:75], v[74:75], v[8:9]
  v_lshlrev_b32 v8, 16, v220
  v_and_b32 v9, 0xffff0000, v220
  v_pk_add_f32 v[68:69], v[68:69], v[8:9]
  v_lshlrev_b32 v8, 16, v221
  v_and_b32 v9, 0xffff0000, v221
  v_pk_add_f32 v[70:71], v[70:71], v[8:9]
  v_lshlrev_b32 v8, 16, v222
  v_and_b32 v9, 0xffff0000, v222
  v_pk_add_f32 v[72:73], v[72:73], v[8:9]
  v_lshlrev_b32 v8, 16, v223
  v_and_b32 v9, 0xffff0000, v223
  v_pk_add_f32 v[74:75], v[74:75], v[8:9]
  v_lshlrev_b32 v8, 16, v224
  v_and_b32 v9, 0xffff0000, v224
  v_pk_add_f32 v[68:69], v[68:69], v[8:9]
  v_lshlrev_b32 v8, 16, v225
  v_and_b32 v9, 0xffff0000, v225
  v_pk_add_f32 v[70:71], v[70:71], v[8:9]
  v_lshlrev_b32 v8, 16, v226
  v_and_b32 v9, 0xffff0000, v226
  v_pk_add_f32 v[72:73], v[72:73], v[8:9]
  v_lshlrev_b32 v8, 16, v227
  v_and_b32 v9, 0xffff0000, v227
  v_pk_add_f32 v[74:75], v[74:75], v[8:9]
  v_lshlrev_b32 v8, 16, v228
  v_and_b32 v9, 0xffff0000, v228
  v_pk_add_f32 v[68:69], v[68:69], v[8:9]
  v_lshlrev_b32 v8, 16, v229
  v_and_b32 v9, 0xffff0000, v229
  v_pk_add_f32 v[70:71], v[70:71], v[8:9]
  v_lshlrev_b32 v8, 16, v230
  v_and_b32 v9, 0xffff0000, v230
  v_pk_add_f32 v[72:73], v[72:73], v[8:9]
  v_lshlrev_b32 v8, 16, v231
  v_and_b32 v9, 0xffff0000, v231
  v_pk_add_f32 v[74:75], v[74:75], v[8:9]
  v_lshlrev_b32 v8, 16, v232
  v_and_b32 v9, 0xffff0000, v232
  v_pk_add_f32 v[68:69], v[68:69], v[8:9]
  v_lshlrev_b32 v8, 16, v233
  v_and_b32 v9, 0xffff0000, v233
  v_pk_add_f32 v[70:71], v[70:71], v[8:9]
  v_lshlrev_b32 v8, 16, v234
  v_and_b32 v9, 0xffff0000, v234
  v_pk_add_f32 v[72:73], v[72:73], v[8:9]
  v_lshlrev_b32 v8, 16, v235
  v_and_b32 v9, 0xffff0000, v235
  v_pk_add_f32 v[74:75], v[74:75], v[8:9]
  v_lshlrev_b32 v8, 16, v236
  v_and_b32 v9, 0xffff0000, v236
  v_pk_add_f32 v[68:69], v[68:69], v[8:9]
  v_lshlrev_b32 v8, 16, v237
  v_and_b32 v9, 0xffff0000, v237
  v_pk_add_f32 v[70:71], v[70:71], v[8:9]
  v_lshlrev_b32 v8, 16, v238
  v_and_b32 v9, 0xffff0000, v238
  v_pk_add_f32 v[72:73], v[72:73], v[8:9]
  v_lshlrev_b32 v8, 16, v239
  v_and_b32 v9, 0xffff0000, v239
  v_pk_add_f32 v[74:75], v[74:75], v[8:9]
  v_cvt_pk_bf16_f32 v8, v68, v69
  v_lshlrev_b32 v68, 16, v8
  v_and_b32 v69, 0xffff0000, v8
  v_lshlrev_b32 v10, 16, v32
  v_and_b32 v11, 0xffff0000, v32
  v_pk_add_f32 v[68:69], v[68:69], v[10:11]
  v_cvt_pk_bf16_f32 v32, v68, v69
  v_lshlrev_b32 v68, 16, v32
  v_and_b32 v69, 0xffff0000, v32
  v_cvt_pk_bf16_f32 v8, v70, v71
  v_lshlrev_b32 v70, 16, v8
  v_and_b32 v71, 0xffff0000, v8
  v_lshlrev_b32 v10, 16, v33
  v_and_b32 v11, 0xffff0000, v33
  v_pk_add_f32 v[70:71], v[70:71], v[10:11]
  v_cvt_pk_bf16_f32 v33, v70, v71
  v_lshlrev_b32 v70, 16, v33
  v_and_b32 v71, 0xffff0000, v33
  v_cvt_pk_bf16_f32 v8, v72, v73
  v_lshlrev_b32 v72, 16, v8
  v_and_b32 v73, 0xffff0000, v8
  v_lshlrev_b32 v10, 16, v34
  v_and_b32 v11, 0xffff0000, v34
  v_pk_add_f32 v[72:73], v[72:73], v[10:11]
  v_cvt_pk_bf16_f32 v34, v72, v73
  v_lshlrev_b32 v72, 16, v34
  v_and_b32 v73, 0xffff0000, v34
  v_cvt_pk_bf16_f32 v8, v74, v75
  v_lshlrev_b32 v74, 16, v8
  v_and_b32 v75, 0xffff0000, v8
  v_lshlrev_b32 v10, 16, v35
  v_and_b32 v11, 0xffff0000, v35
  v_pk_add_f32 v[74:75], v[74:75], v[10:11]
  v_cvt_pk_bf16_f32 v35, v74, v75
  v_lshlrev_b32 v74, 16, v35
  v_and_b32 v75, 0xffff0000, v35
  buffer_store_dwordx4 v[32:35], v15, s[4:7], s21 offen offset:256
  v_and_b32 v3, 63, v0
  v_and_b32 v2, 15, v3
  v_lshlrev_b32 v5, 2, v2
  s_lshl_b32 s17, s16, 6
  v_add_u32 v1, s17, v5
  v_pk_add_f32 v[6:7], v[36:37], v[38:39]
  v_pk_add_f32 v[6:7], v[6:7], v[40:41]
  v_pk_add_f32 v[6:7], v[6:7], v[42:43]
  v_pk_add_f32 v[6:7], v[6:7], v[44:45]
  v_pk_add_f32 v[6:7], v[6:7], v[46:47]
  v_pk_add_f32 v[6:7], v[6:7], v[48:49]
  v_pk_add_f32 v[6:7], v[6:7], v[50:51]
  v_pk_add_f32 v[6:7], v[6:7], v[52:53]
  v_pk_add_f32 v[6:7], v[6:7], v[54:55]
  v_pk_add_f32 v[6:7], v[6:7], v[56:57]
  v_pk_add_f32 v[6:7], v[6:7], v[58:59]
  v_pk_add_f32 v[6:7], v[6:7], v[60:61]
  v_pk_add_f32 v[6:7], v[6:7], v[62:63]
  v_pk_add_f32 v[6:7], v[6:7], v[64:65]
  v_pk_add_f32 v[6:7], v[6:7], v[66:67]
  v_pk_add_f32 v[6:7], v[6:7], v[68:69]
  v_pk_add_f32 v[6:7], v[6:7], v[70:71]
  v_pk_add_f32 v[6:7], v[6:7], v[72:73]
  v_pk_add_f32 v[6:7], v[6:7], v[74:75]
  v_add_f32 v4, v6, v7
  v_mov_b32 v2, v4
  s_nop 1
  v_permlane32_swap_b32 v4, v2
  v_add_f32 v4, v4, v2
  v_mov_b32 v2, v4
  s_nop 1
  v_permlane16_swap_b32 v4, v2
  v_add_f32 v4, v4, v2
  ds_write_b32 v1, v4 offset:0
  s_waitcnt lgkmcnt(0)
  s_barrier
  ds_read_b32 v4, v5 offset:0
  ds_read_b32 v2, v5 offset:64
  ds_read_b32 v3, v5 offset:128
  ds_read_b32 v6, v5 offset:192
  s_waitcnt lgkmcnt(0)
  v_add_f32 v4, v4, v2
  v_add_f32 v3, v3, v6
  v_add_f32 v4, v4, v3
  v_mul_f32 v6, 0xbacccccd, v4
  v_mov_b32 v7, v6
  v_pk_add_f32 v[36:37], v[36:37], v[6:7]
  v_pk_add_f32 v[38:39], v[38:39], v[6:7]
  v_pk_add_f32 v[40:41], v[40:41], v[6:7]
  v_pk_add_f32 v[42:43], v[42:43], v[6:7]
  v_pk_add_f32 v[44:45], v[44:45], v[6:7]
  v_pk_add_f32 v[46:47], v[46:47], v[6:7]
  v_pk_add_f32 v[48:49], v[48:49], v[6:7]
  v_pk_add_f32 v[50:51], v[50:51], v[6:7]
  v_pk_add_f32 v[52:53], v[52:53], v[6:7]
  v_pk_add_f32 v[54:55], v[54:55], v[6:7]
  v_pk_add_f32 v[56:57], v[56:57], v[6:7]
  v_pk_add_f32 v[58:59], v[58:59], v[6:7]
  v_pk_add_f32 v[60:61], v[60:61], v[6:7]
  v_pk_add_f32 v[62:63], v[62:63], v[6:7]
  v_pk_add_f32 v[64:65], v[64:65], v[6:7]
  v_pk_add_f32 v[66:67], v[66:67], v[6:7]
  v_pk_add_f32 v[68:69], v[68:69], v[6:7]
  v_pk_add_f32 v[70:71], v[70:71], v[6:7]
  v_pk_add_f32 v[72:73], v[72:73], v[6:7]
  v_pk_add_f32 v[74:75], v[74:75], v[6:7]
  v_pk_mul_f32 v[6:7], v[36:37], v[36:37]
  v_pk_fma_f32 v[6:7], v[38:39], v[38:39], v[6:7]
  v_pk_fma_f32 v[6:7], v[40:41], v[40:41], v[6:7]
  v_pk_fma_f32 v[6:7], v[42:43], v[42:43], v[6:7]
  v_pk_fma_f32 v[6:7], v[44:45], v[44:45], v[6:7]
  v_pk_fma_f32 v[6:7], v[46:47], v[46:47], v[6:7]
  v_pk_fma_f32 v[6:7], v[48:49], v[48:49], v[6:7]
  v_pk_fma_f32 v[6:7], v[50:51], v[50:51], v[6:7]
  v_pk_fma_f32 v[6:7], v[52:53], v[52:53], v[6:7]
  v_pk_fma_f32 v[6:7], v[54:55], v[54:55], v[6:7]
  v_pk_fma_f32 v[6:7], v[56:57], v[56:57], v[6:7]
  v_pk_fma_f32 v[6:7], v[58:59], v[58:59], v[6:7]
  v_pk_fma_f32 v[6:7], v[60:61], v[60:61], v[6:7]
  v_pk_fma_f32 v[6:7], v[62:63], v[62:63], v[6:7]
  v_pk_fma_f32 v[6:7], v[64:65], v[64:65], v[6:7]
  v_pk_fma_f32 v[6:7], v[66:67], v[66:67], v[6:7]
  v_pk_fma_f32 v[6:7], v[68:69], v[68:69], v[6:7]
  v_pk_fma_f32 v[6:7], v[70:71], v[70:71], v[6:7]
  v_pk_fma_f32 v[6:7], v[72:73], v[72:73], v[6:7]
  v_pk_fma_f32 v[6:7], v[74:75], v[74:75], v[6:7]
  v_add_f32 v4, v6, v7
  v_mov_b32 v2, v4
  s_nop 1
  v_permlane32_swap_b32 v4, v2
  v_add_f32 v4, v4, v2
  v_mov_b32 v2, v4
  s_nop 1
  v_permlane16_swap_b32 v4, v2
  v_add_f32 v4, v4, v2
  ds_write_b32 v1, v4 offset:256
  s_waitcnt lgkmcnt(0)
  s_barrier
  ds_read_b32 v4, v5 offset:256
  ds_read_b32 v2, v5 offset:320
  ds_read_b32 v3, v5 offset:384
  ds_read_b32 v6, v5 offset:448
  s_waitcnt lgkmcnt(0)
  v_add_f32 v4, v4, v2
  v_add_f32 v3, v3, v6
  v_add_f32 v4, v4, v3
  v_mov_b32 v2, 0x3727c5ac
  v_fmac_f32 v2, 0x3acccccd, v4
  v_rsq_f32 v6, v2
  s_nop 0
  v_mov_b32 v7, v6
  v_pk_mul_f32 v[36:37], v[36:37], v[6:7]
  v_pk_mul_f32 v[38:39], v[38:39], v[6:7]
  v_pk_mul_f32 v[40:41], v[40:41], v[6:7]
  v_pk_mul_f32 v[42:43], v[42:43], v[6:7]
  v_pk_mul_f32 v[44:45], v[44:45], v[6:7]
  v_pk_mul_f32 v[46:47], v[46:47], v[6:7]
  v_pk_mul_f32 v[48:49], v[48:49], v[6:7]
  v_pk_mul_f32 v[50:51], v[50:51], v[6:7]
  v_pk_mul_f32 v[52:53], v[52:53], v[6:7]
  v_pk_mul_f32 v[54:55], v[54:55], v[6:7]
  v_pk_mul_f32 v[56:57], v[56:57], v[6:7]
  v_pk_mul_f32 v[58:59], v[58:59], v[6:7]
  v_pk_mul_f32 v[60:61], v[60:61], v[6:7]
  v_pk_mul_f32 v[62:63], v[62:63], v[6:7]
  v_pk_mul_f32 v[64:65], v[64:65], v[6:7]
  v_pk_mul_f32 v[66:67], v[66:67], v[6:7]
  v_pk_mul_f32 v[68:69], v[68:69], v[6:7]
  v_pk_mul_f32 v[70:71], v[70:71], v[6:7]
  v_pk_mul_f32 v[72:73], v[72:73], v[6:7]
  v_pk_mul_f32 v[74:75], v[74:75], v[6:7]
  v_cvt_pk_bf16_f32 v16, v36, v37
  v_cvt_pk_bf16_f32 v17, v38, v39
  v_cvt_pk_bf16_f32 v18, v40, v41
  v_cvt_pk_bf16_f32 v19, v42, v43
  v_cvt_pk_bf16_f32 v20, v44, v45
  v_cvt_pk_bf16_f32 v21, v46, v47
  v_cvt_pk_bf16_f32 v22, v48, v49
  v_cvt_pk_bf16_f32 v23, v50, v51
  v_cvt_pk_bf16_f32 v24, v52, v53
  v_cvt_pk_bf16_f32 v25, v54, v55
  v_cvt_pk_bf16_f32 v26, v56, v57
  v_cvt_pk_bf16_f32 v27, v58, v59
  v_cvt_pk_bf16_f32 v28, v60, v61
  v_cvt_pk_bf16_f32 v29, v62, v63
  v_cvt_pk_bf16_f32 v30, v64, v65
  v_cvt_pk_bf16_f32 v31, v66, v67
  v_cvt_pk_bf16_f32 v32, v68, v69
  v_cvt_pk_bf16_f32 v33, v70, v71
  v_cvt_pk_bf16_f32 v34, v72, v73
  v_cvt_pk_bf16_f32 v35, v74, v75
  v_and_b32 v3, 63, v0
  v_and_b32 v2, 15, v3
  v_lshlrev_b32 v1, 4, v2
  v_bfe_u32 v2, v3, 4, 1
  v_lshl_add_u32 v1, v2, 9, v1
  v_lshrrev_b32 v2, 5, v3
  v_lshl_add_u32 v1, v2, 10, v1
  s_lshr_b32 s17, s2, 1
  s_mul_i32 s17, s17, 40960
  s_and_b32 s18, s2, 1
  s_lshl_b32 s18, s18, 8
  s_add_u32 s17, s17, s18
  s_mul_i32 s18, s16, 10240
  s_add_u32 s17, s17, s18
  s_add_u32 s17, s17, 199229440
  buffer_store_dwordx4 v[16:19], v1, s[4:7], s17 offen offset:0
  buffer_store_dwordx4 v[20:23], v1, s[4:7], s17 offen offset:2048
  s_add_u32 s17, s17, 4096
  buffer_store_dwordx4 v[24:27], v1, s[4:7], s17 offen offset:0
  buffer_store_dwordx4 v[28:31], v1, s[4:7], s17 offen offset:2048
  s_add_u32 s17, s17, 4096
  buffer_store_dwordx4 v[32:35], v1, s[4:7], s17 offen offset:0
redln1_exit1:
  s_endpgm
.globl redln2_kernel
.p2align 8
.type redln2_kernel,@function
redln2_kernel:
  s_cmp_ge_u32 s2, 128
  s_cbranch_scc1 redln2_exit1
  s_load_dwordx2 s[12:13], s[0:1], 96
  s_load_dwordx2 s[14:15], s[0:1], 0
  v_lshrrev_b32 v2, 6, v0
  v_and_b32 v3, 63, v0
  s_nop 0
  v_readfirstlane_b32 s16, v2
  v_lshlrev_b32 v14, 4, v3
  s_waitcnt lgkmcnt(0)
  s_mov_b32 s4, s12
  s_mov_b32 s5, s13
  s_mov_b32 s6, 0x10000000
  s_mov_b32 s7, 0x20000
  s_mov_b32 s8, s12
  s_mov_b32 s9, s13
  s_mov_b32 s10, 0x10000000
  s_mov_b32 s11, 0x20000
  s_mov_b32 s20, 150994944
  v_and_b32 v2, 15, v3
  v_lshrrev_b32 v4, 4, v3
  s_lshl_b32 s17, s2, 4
  v_add_u32 v15, s17, v2
  v_mul_u32_u24 v15, 1280, v15
  v_lshl_add_u32 v15, v4, 4, v15
  s_mul_i32 s17, s16, 320
  s_add_u32 s20, s20, s17
  s_add_u32 s21, s17, 150994944
  s_mul_i32 s22, s2, 20
  s_mul_i32 s23, s16, 5
  s_add_u32 s22, s22, s23
  s_lshl_b32 s22, s22, 10
  s_add_u32 s22, s22, 178257920
  s_add_u32 s24, s22, 0
  s_add_u32 s25, s22, 2621440
  s_add_u32 s26, s22, 5242880
  s_add_u32 s27, s22, 7864320
  s_add_u32 s28, s22, 10485760
  s_add_u32 s29, s22, 13107200
  s_add_u32 s30, s22, 15728640
  s_add_u32 s31, s22, 18350080
  v_add_u32 v6, 0x1000, v14
  buffer_load_dwordx4 v[16:19], v15, s[8:11], s20 offen offset:0
  buffer_load_dwordx4 v[20:23], v15, s[8:11], s20 offen offset:64
  buffer_load_dwordx4 v[24:27], v15, s[8:11], s20 offen offset:128
  buffer_load_dwordx4 v[28:31], v15, s[8:11], s20 offen offset:192
  buffer_load_dwordx4 v[32:35], v15, s[8:11], s20 offen offset:256
  buffer_load_dwordx4 v[80:83], v14, s[4:7], s24 offen offset:0
  buffer_load_dwordx4 v[84:87], v14, s[4:7], s25 offen offset:0
  buffer_load_dwordx4 v[88:91], v14, s[4:7], s26 offen offset:0
  buffer_load_dwordx4 v[92:95], v14, s[4:7], s27 offen offset:0
  buffer_load_dwordx4 v[96:99], v14, s[4:7], s28 offen offset:0
  buffer_load_dwordx4 v[100:103], v14, s[4:7], s29 offen offset:0
  buffer_load_dwordx4 v[104:107], v14, s[4:7], s30 offen offset:0
  buffer_load_dwordx4 v[108:111], v14, s[4:7], s31 offen offset:0
  buffer_load_dwordx4 v[112:115], v14, s[4:7], s24 offen offset:1024
  buffer_load_dwordx4 v[116:119], v14, s[4:7], s25 offen offset:1024
  buffer_load_dwordx4 v[120:123], v14, s[4:7], s26 offen offset:1024
  buffer_load_dwordx4 v[124:127], v14, s[4:7], s27 offen offset:1024
  buffer_load_dwordx4 v[128:131], v14, s[4:7], s28 offen offset:1024
  buffer_load_dwordx4 v[132:135], v14, s[4:7], s29 offen offset:1024
  buffer_load_dwordx4 v[136:139], v14, s[4:7], s30 offen offset:1024
  buffer_load_dwordx4 v[140:143], v14, s[4:7], s31 offen offset:1024
  buffer_load_dwordx4 v[144:147], v14, s[4:7], s24 offen offset:2048
  buffer_load_dwordx4 v[148:151], v14, s[4:7], s25 offen offset:2048
  buffer_load_dwordx4 v[152:155], v14, s[4:7], s26 offen offset:2048
  buffer_load_dwordx4 v[156:159], v14, s[4:7], s27 offen offset:2048
  buffer_load_dwordx4 v[160:163], v14, s[4:7], s28 offen offset:2048
  buffer_load_dwordx4 v[164:167], v14, s[4:7], s29 offen offset:2048
  buffer_load_dwordx4 v[168:171], v14, s[4:7], s30 offen offset:2048
  buffer_load_dwordx4 v[172:175], v14, s[4:7], s31 offen offset:2048
  buffer_load_dwordx4 v[176:179], v14, s[4:7], s24 offen offset:3072
  buffer_load_dwordx4 v[180:183], v14, s[4:7], s25 offen offset:3072
  buffer_load_dwordx4 v[184:187], v14, s[4:7], s26 offen offset:3072
  buffer_load_dwordx4 v[188:191], v14, s[4:7], s27 offen offset:3072
  buffer_load_dwordx4 v[192:195], v14, s[4:7], s28 offen offset:3072
  buffer_load_dwordx4 v[196:199], v14, s[4:7], s29 offen offset:3072
  buffer_load_dwordx4 v[200:203], v14, s[4:7], s30 offen offset:3072
  buffer_load_dwordx4 v[204:207], v14, s[4:7], s31 offen offset:3072
  buffer_load_dwordx4 v[208:211], v6, s[4:7], s24 offen offset:0
  buffer_load_dwordx4 v[212:215], v6, s[4:7], s25 offen offset:0
  buffer_load_dwordx4 v[216:219], v6, s[4:7], s26 offen offset:0
  buffer_load_dwordx4 v[220:223], v6, s[4:7], s27 offen offset:0
  buffer_load_dwordx4 v[224:227], v6, s[4:7], s28 offen offset:0
  buffer_load_dwordx4 v[228:231], v6, s[4:7], s29 offen offset:0
  buffer_load_dwordx4 v[232:235], v6, s[4:7], s30 offen offset:0
  buffer_load_dwordx4 v[236:239], v6, s[4:7], s31 offen offset:0
  s_waitcnt vmcnt(32)
  v_lshlrev_b32 v36, 16, v80
  v_and_b32 v37, 0xffff0000, v80
  v_lshlrev_b32 v38, 16, v81
  v_and_b32 v39, 0xffff0000, v81
  v_lshlrev_b32 v40, 16, v82
  v_and_b32 v41, 0xffff0000, v82
  v_lshlrev_b32 v42, 16, v83
  v_and_b32 v43, 0xffff0000, v83
  v_lshlrev_b32 v8, 16, v84
  v_and_b32 v9, 0xffff0000, v84
  v_pk_add_f32 v[36:37], v[36:37], v[8:9]
  v_lshlrev_b32 v8, 16, v85
  v_and_b32 v9, 0xffff0000, v85
  v_pk_add_f32 v[38:39], v[38:39], v[8:9]
  v_lshlrev_b32 v8, 16, v86
  v_and_b32 v9, 0xffff0000, v86
  v_pk_add_f32 v[40:41], v[40:41], v[8:9]
  v_lshlrev_b32 v8, 16, v87
  v_and_b32 v9, 0xffff0000, v87
  v_pk_add_f32 v[42:43], v[42:43], v[8:9]
  v_lshlrev_b32 v8, 16, v88
  v_and_b32 v9, 0xffff0000, v88
  v_pk_add_f32 v[36:37], v[36:37], v[8:9]
  v_lshlrev_b32 v8, 16, v89
  v_and_b32 v9, 0xffff0000, v89
  v_pk_add_f32 v[38:39], v[38:39], v[8:9]
  v_lshlrev_b32 v8, 16, v90
  v_and_b32 v9, 0xffff0000, v90
  v_pk_add_f32 v[40:41], v[40:41], v[8:9]
  v_lshlrev_b32 v8, 16, v91
  v_and_b32 v9, 0xffff0000, v91
  v_pk_add_f32 v[42:43], v[42:43], v[8:9]
  v_lshlrev_b32 v8, 16, v92
  v_and_b32 v9, 0xffff0000, v92
  v_pk_add_f32 v[36:37], v[36:37], v[8:9]
  v_lshlrev_b32 v8, 16, v93
  v_and_b32 v9, 0xffff0000, v93
  v_pk_add_f32 v[38:39], v[38:39], v[8:9]
  v_lshlrev_b32 v8, 16, v94
  v_and_b32 v9, 0xffff0000, v94
  v_pk_add_f32 v[40:41], v[40:41], v[8:9]
  v_lshlrev_b32 v8, 16, v95
  v_and_b32 v9, 0xffff0000, v95
  v_pk_add_f32 v[42:43], v[42:43], v[8:9]
  v_lshlrev_b32 v8, 16, v96
  v_and_b32 v9, 0xffff0000, v96
  v_pk_add_f32 v[36:37], v[36:37], v[8:9]
  v_lshlrev_b32 v8, 16, v97
  v_and_b32 v9, 0xffff0000, v97
  v_pk_add_f32 v[38:39], v[38:39], v[8:9]
  v_lshlrev_b32 v8, 16, v98
  v_and_b32 v9, 0xffff0000, v98
  v_pk_add_f32 v[40:41], v[40:41], v[8:9]
  v_lshlrev_b32 v8, 16, v99
  v_and_b32 v9, 0xffff0000, v99
  v_pk_add_f32 v[42:43], v[42:43], v[8:9]
  v_lshlrev_b32 v8, 16, v100
  v_and_b32 v9, 0xffff0000, v100
  v_pk_add_f32 v[36:37], v[36:37], v[8:9]
  v_lshlrev_b32 v8, 16, v101
  v_and_b32 v9, 0xffff0000, v101
  v_pk_add_f32 v[38:39], v[38:39], v[8:9]
  v_lshlrev_b32 v8, 16, v102
  v_and_b32 v9, 0xffff0000, v102
  v_pk_add_f32 v[40:41], v[40:41], v[8:9]
  v_lshlrev_b32 v8, 16, v103
  v_and_b32 v9, 0xffff0000, v103
  v_pk_add_f32 v[42:43], v[42:43], v[8:9]
  v_lshlrev_b32 v8, 16, v104
  v_and_b32 v9, 0xffff0000, v104
  v_pk_add_f32 v[36:37], v[36:37], v[8:9]
  v_lshlrev_b32 v8, 16, v105
  v_and_b32 v9, 0xffff0000, v105
  v_pk_add_f32 v[38:39], v[38:39], v[8:9]
  v_lshlrev_b32 v8, 16, v106
  v_and_b32 v9, 0xffff0000, v106
  v_pk_add_f32 v[40:41], v[40:41], v[8:9]
  v_lshlrev_b32 v8, 16, v107
  v_and_b32 v9, 0xffff0000, v107
  v_pk_add_f32 v[42:43], v[42:43], v[8:9]
  v_lshlrev_b32 v8, 16, v108
  v_and_b32 v9, 0xffff0000, v108
  v_pk_add_f32 v[36:37], v[36:37], v[8:9]
  v_lshlrev_b32 v8, 16, v109
  v_and_b32 v9, 0xffff0000, v109
  v_pk_add_f32 v[38:39], v[38:39], v[8:9]
  v_lshlrev_b32 v8, 16, v110
  v_and_b32 v9, 0xffff0000, v110
  v_pk_add_f32 v[40:41], v[40:41], v[8:9]
  v_lshlrev_b32 v8, 16, v111
  v_and_b32 v9, 0xffff0000, v111
  v_pk_add_f32 v[42:43], v[42:43], v[8:9]
  v_cvt_pk_bf16_f32 v8, v36, v37
  v_lshlrev_b32 v36, 16, v8
  v_and_b32 v37, 0xffff0000, v8
  v_lshlrev_b32 v10, 16, v16
  v_and_b32 v11, 0xffff0000, v16
  v_pk_add_f32 v[36:37], v[36:37], v[10:11]
  v_cvt_pk_bf16_f32 v16, v36, v37
  v_lshlrev_b32 v36, 16, v16
  v_and_b32 v37, 0xffff0000, v16
  v_cvt_pk_bf16_f32 v8, v38, v39
  v_lshlrev_b32 v38, 16, v8
  v_and_b32 v39, 0xffff0000, v8
  v_lshlrev_b32 v10, 16, v17
  v_and_b32 v11, 0xffff0000, v17
  v_pk_add_f32 v[38:39], v[38:39], v[10:11]
  v_cvt_pk_bf16_f32 v17, v38, v39
  v_lshlrev_b32 v38, 16, v17
  v_and_b32 v39, 0xffff0000, v17
  v_cvt_pk_bf16_f32 v8, v40, v41
  v_lshlrev_b32 v40, 16, v8
  v_and_b32 v41, 0xffff0000, v8
  v_lshlrev_b32 v10, 16, v18
  v_and_b32 v11, 0xffff0000, v18
  v_pk_add_f32 v[40:41], v[40:41], v[10:11]
  v_cvt_pk_bf16_f32 v18, v40, v41
  v_lshlrev_b32 v40, 16, v18
  v_and_b32 v41, 0xffff0000, v18
  v_cvt_pk_bf16_f32 v8, v42, v43
  v_lshlrev_b32 v42, 16, v8
  v_and_b32 v43, 0xffff0000, v8
  v_lshlrev_b32 v10, 16, v19
  v_and_b32 v11, 0xffff0000, v19
  v_pk_add_f32 v[42:43], v[42:43], v[10:11]
  v_cvt_pk_bf16_f32 v19, v42, v43
  v_lshlrev_b32 v42, 16, v19
  v_and_b32 v43, 0xffff0000, v19
  buffer_store_dwordx4 v[16:19], v15, s[4:7], s21 offen offset:0
  s_waitcnt vmcnt(25)
  v_lshlrev_b32 v44, 16, v112
  v_and_b32 v45, 0xffff0000, v112
  v_lshlrev_b32 v46, 16, v113
  v_and_b32 v47, 0xffff0000, v113
  v_lshlrev_b32 v48, 16, v114
  v_and_b32 v49, 0xffff0000, v114
  v_lshlrev_b32 v50, 16, v115
  v_and_b32 v51, 0xffff0000, v115
  v_lshlrev_b32 v8, 16, v116
  v_and_b32 v9, 0xffff0000, v116
  v_pk_add_f32 v[44:45], v[44:45], v[8:9]
  v_lshlrev_b32 v8, 16, v117
  v_and_b32 v9, 0xffff0000, v117
  v_pk_add_f32 v[46:47], v[46:47], v[8:9]
  v_lshlrev_b32 v8, 16, v118
  v_and_b32 v9, 0xffff0000, v118
  v_pk_add_f32 v[48:49], v[48:49], v[8:9]
  v_lshlrev_b32 v8, 16, v119
  v_and_b32 v9, 0xffff0000, v119
  v_pk_add_f32 v[50:51], v[50:51], v[8:9]
  v_lshlrev_b32 v8, 16, v120
  v_and_b32 v9, 0xffff0000, v120
  v_pk_add_f32 v[44:45], v[44:45], v[8:9]
  v_lshlrev_b32 v8, 16, v121
  v_and_b32 v9, 0xffff0000, v121
  v_pk_add_f32 v[46:47], v[46:47], v[8:9]
  v_lshlrev_b32 v8, 16, v122
  v_and_b32 v9, 0xffff0000, v122
  v_pk_add_f32 v[48:49], v[48:49], v[8:9]
  v_lshlrev_b32 v8, 16, v123
  v_and_b32 v9, 0xffff0000, v123
  v_pk_add_f32 v[50:51], v[50:51], v[8:9]
  v_lshlrev_b32 v8, 16, v124
  v_and_b32 v9, 0xffff0000, v124
  v_pk_add_f32 v[44:45], v[44:45], v[8:9]
  v_lshlrev_b32 v8, 16, v125
  v_and_b32 v9, 0xffff0000, v125
  v_pk_add_f32 v[46:47], v[46:47], v[8:9]
  v_lshlrev_b32 v8, 16, v126
  v_and_b32 v9, 0xffff0000, v126
  v_pk_add_f32 v[48:49], v[48:49], v[8:9]
  v_lshlrev_b32 v8, 16, v127
  v_and_b32 v9, 0xffff0000, v127
  v_pk_add_f32 v[50:51], v[50:51], v[8:9]
  v_lshlrev_b32 v8, 16, v128
  v_and_b32 v9, 0xffff0000, v128
  v_pk_add_f32 v[44:45], v[44:45], v[8:9]
  v_lshlrev_b32 v8, 16, v129
  v_and_b32 v9, 0xffff0000, v129
  v_pk_add_f32 v[46:47], v[46:47], v[8:9]
  v_lshlrev_b32 v8, 16, v130
  v_and_b32 v9, 0xffff0000, v130
  v_pk_add_f32 v[48:49], v[48:49], v[8:9]
  v_lshlrev_b32 v8, 16, v131
  v_and_b32 v9, 0xffff0000, v131
  v_pk_add_f32 v[50:51], v[50:51], v[8:9]
  v_lshlrev_b32 v8, 16, v132
  v_and_b32 v9, 0xffff0000, v132
  v_pk_add_f32 v[44:45], v[44:45], v[8:9]
  v_lshlrev_b32 v8, 16, v133
  v_and_b32 v9, 0xffff0000, v133
  v_pk_add_f32 v[46:47], v[46:47], v[8:9]
  v_lshlrev_b32 v8, 16, v134
  v_and_b32 v9, 0xffff0000, v134
  v_pk_add_f32 v[48:49], v[48:49], v[8:9]
  v_lshlrev_b32 v8, 16, v135
  v_and_b32 v9, 0xffff0000, v135
  v_pk_add_f32 v[50:51], v[50:51], v[8:9]
  v_lshlrev_b32 v8, 16, v136
  v_and_b32 v9, 0xffff0000, v136
  v_pk_add_f32 v[44:45], v[44:45], v[8:9]
  v_lshlrev_b32 v8, 16, v137
  v_and_b32 v9, 0xffff0000, v137
  v_pk_add_f32 v[46:47], v[46:47], v[8:9]
  v_lshlrev_b32 v8, 16, v138
  v_and_b32 v9, 0xffff0000, v138
  v_pk_add_f32 v[48:49], v[48:49], v[8:9]
  v_lshlrev_b32 v8, 16, v139
  v_and_b32 v9, 0xffff0000, v139
  v_pk_add_f32 v[50:51], v[50:51], v[8:9]
  v_lshlrev_b32 v8, 16, v140
  v_and_b32 v9, 0xffff0000, v140
  v_pk_add_f32 v[44:45], v[44:45], v[8:9]
  v_lshlrev_b32 v8, 16, v141
  v_and_b32 v9, 0xffff0000, v141
  v_pk_add_f32 v[46:47], v[46:47], v[8:9]
  v_lshlrev_b32 v8, 16, v142
  v_and_b32 v9, 0xffff0000, v142
  v_pk_add_f32 v[48:49], v[48:49], v[8:9]
  v_lshlrev_b32 v8, 16, v143
  v_and_b32 v9, 0xffff0000, v143
  v_pk_add_f32 v[50:51], v[50:51], v[8:9]
  v_cvt_pk_bf16_f32 v8, v44, v45
  v_lshlrev_b32 v44, 16, v8
  v_and_b32 v45, 0xffff0000, v8
  v_lshlrev_b32 v10, 16, v20
  v_and_b32 v11, 0xffff0000, v20
  v_pk_add_f32 v[44:45], v[44:45], v[10:11]
  v_cvt_pk_bf16_f32 v20, v44, v45
  v_lshlrev_b32 v44, 16, v20
  v_and_b32 v45, 0xffff0000, v20
  v_cvt_pk_bf16_f32 v8, v46, v47
  v_lshlrev_b32 v46, 16, v8
  v_and_b32 v47, 0xffff0000, v8
  v_lshlrev_b32 v10, 16, v21
  v_and_b32 v11, 0xffff0000, v21
  v_pk_add_f32 v[46:47], v[46:47], v[10:11]
  v_cvt_pk_bf16_f32 v21, v46, v47
  v_lshlrev_b32 v46, 16, v21
  v_and_b32 v47, 0xffff0000, v21
  v_cvt_pk_bf16_f32 v8, v48, v49
  v_lshlrev_b32 v48, 16, v8
  v_and_b32 v49, 0xffff0000, v8
  v_lshlrev_b32 v10, 16, v22
  v_and_b32 v11, 0xffff0000, v22
  v_pk_add_f32 v[48:49], v[48:49], v[10:11]
  v_cvt_pk_bf16_f32 v22, v48, v49
  v_lshlrev_b32 v48, 16, v22
  v_and_b32 v49, 0xffff0000, v22
  v_cvt_pk_bf16_f32 v8, v50, v51
  v_lshlrev_b32 v50, 16, v8
  v_and_b32 v51, 0xffff0000, v8
  v_lshlrev_b32 v10, 16, v23
  v_and_b32 v11, 0xffff0000, v23
  v_pk_add_f32 v[50:51], v[50:51], v[10:11]
  v_cvt_pk_bf16_f32 v23, v50, v51
  v_lshlrev_b32 v50, 16, v23
  v_and_b32 v51, 0xffff0000, v23
  buffer_store_dwordx4 v[20:23], v15, s[4:7], s21 offen offset:64
  s_waitcnt vmcnt(18)
  v_lshlrev_b32 v52, 16, v144
  v_and_b32 v53, 0xffff0000, v144
  v_lshlrev_b32 v54, 16, v145
  v_and_b32 v55, 0xffff0000, v145
  v_lshlrev_b32 v56, 16, v146
  v_and_b32 v57, 0xffff0000, v146
  v_lshlrev_b32 v58, 16, v147
  v_and_b32 v59, 0xffff0000, v147
  v_lshlrev_b32 v8, 16, v148
  v_and_b32 v9, 0xffff0000, v148
  v_pk_add_f32 v[52:53], v[52:53], v[8:9]
  v_lshlrev_b32 v8, 16, v149
  v_and_b32 v9, 0xffff0000, v149
  v_pk_add_f32 v[54:55], v[54:55], v[8:9]
  v_lshlrev_b32 v8, 16, v150
  v_and_b32 v9, 0xffff0000, v150
  v_pk_add_f32 v[56:57], v[56:57], v[8:9]
  v_lshlrev_b32 v8, 16, v151
  v_and_b32 v9, 0xffff0000, v151
  v_pk_add_f32 v[58:59], v[58:59], v[8:9]
  v_lshlrev_b32 v8, 16, v152
  v_and_b32 v9, 0xffff0000, v152
  v_pk_add_f32 v[52:53], v[52:53], v[8:9]
  v_lshlrev_b32 v8, 16, v153
  v_and_b32 v9, 0xffff0000, v153
  v_pk_add_f32 v[54:55], v[54:55], v[8:9]
  v_lshlrev_b32 v8, 16, v154
  v_and_b32 v9, 0xffff0000, v154
  v_pk_add_f32 v[56:57], v[56:57], v[8:9]
  v_lshlrev_b32 v8, 16, v155
  v_and_b32 v9, 0xffff0000, v155
  v_pk_add_f32 v[58:59], v[58:59], v[8:9]
  v_lshlrev_b32 v8, 16, v156
  v_and_b32 v9, 0xffff0000, v156
  v_pk_add_f32 v[52:53], v[52:53], v[8:9]
  v_lshlrev_b32 v8, 16, v157
  v_and_b32 v9, 0xffff0000, v157
  v_pk_add_f32 v[54:55], v[54:55], v[8:9]
  v_lshlrev_b32 v8, 16, v158
  v_and_b32 v9, 0xffff0000, v158
  v_pk_add_f32 v[56:57], v[56:57], v[8:9]
  v_lshlrev_b32 v8, 16, v159
  v_and_b32 v9, 0xffff0000, v159
  v_pk_add_f32 v[58:59], v[58:59], v[8:9]
  v_lshlrev_b32 v8, 16, v160
  v_and_b32 v9, 0xffff0000, v160
  v_pk_add_f32 v[52:53], v[52:53], v[8:9]
  v_lshlrev_b32 v8, 16, v161
  v_and_b32 v9, 0xffff0000, v161
  v_pk_add_f32 v[54:55], v[54:55], v[8:9]
  v_lshlrev_b32 v8, 16, v162
  v_and_b32 v9, 0xffff0000, v162
  v_pk_add_f32 v[56:57], v[56:57], v[8:9]
  v_lshlrev_b32 v8, 16, v163
  v_and_b32 v9, 0xffff0000, v163
  v_pk_add_f32 v[58:59], v[58:59], v[8:9]
  v_lshlrev_b32 v8, 16, v164
  v_and_b32 v9, 0xffff0000, v164
  v_pk_add_f32 v[52:53], v[52:53], v[8:9]
  v_lshlrev_b32 v8, 16, v165
  v_and_b32 v9, 0xffff0000, v165
  v_pk_add_f32 v[54:55], v[54:55], v[8:9]
  v_lshlrev_b32 v8, 16, v166
  v_and_b32 v9, 0xffff0000, v166
  v_pk_add_f32 v[56:57], v[56:57], v[8:9]
  v_lshlrev_b32 v8, 16, v167
  v_and_b32 v9, 0xffff0000, v167
  v_pk_add_f32 v[58:59], v[58:59], v[8:9]
  v_lshlrev_b32 v8, 16, v168
  v_and_b32 v9, 0xffff0000, v168
  v_pk_add_f32 v[52:53], v[52:53], v[8:9]
  v_lshlrev_b32 v8, 16, v169
  v_and_b32 v9, 0xffff0000, v169
  v_pk_add_f32 v[54:55], v[54:55], v[8:9]
  v_lshlrev_b32 v8, 16, v170
  v_and_b32 v9, 0xffff0000, v170
  v_pk_add_f32 v[56:57], v[56:57], v[8:9]
  v_lshlrev_b32 v8, 16, v171
  v_and_b32 v9, 0xffff0000, v171
  v_pk_add_f32 v[58:59], v[58:59], v[8:9]
  v_lshlrev_b32 v8, 16, v172
  v_and_b32 v9, 0xffff0000, v172
  v_pk_add_f32 v[52:53], v[52:53], v[8:9]
  v_lshlrev_b32 v8, 16, v173
  v_and_b32 v9, 0xffff0000, v173
  v_pk_add_f32 v[54:55], v[54:55], v[8:9]
  v_lshlrev_b32 v8, 16, v174
  v_and_b32 v9, 0xffff0000, v174
  v_pk_add_f32 v[56:57], v[56:57], v[8:9]
  v_lshlrev_b32 v8, 16, v175
  v_and_b32 v9, 0xffff0000, v175
  v_pk_add_f32 v[58:59], v[58:59], v[8:9]
  v_cvt_pk_bf16_f32 v8, v52, v53
  v_lshlrev_b32 v52, 16, v8
  v_and_b32 v53, 0xffff0000, v8
  v_lshlrev_b32 v10, 16, v24
  v_and_b32 v11, 0xffff0000, v24
  v_pk_add_f32 v[52:53], v[52:53], v[10:11]
  v_cvt_pk_bf16_f32 v24, v52, v53
  v_lshlrev_b32 v52, 16, v24
  v_and_b32 v53, 0xffff0000, v24
  v_cvt_pk_bf16_f32 v8, v54, v55
  v_lshlrev_b32 v54, 16, v8
  v_and_b32 v55, 0xffff0000, v8
  v_lshlrev_b32 v10, 16, v25
  v_and_b32 v11, 0xffff0000, v25
  v_pk_add_f32 v[54:55], v[54:55], v[10:11]
  v_cvt_pk_bf16_f32 v25, v54, v55
  v_lshlrev_b32 v54, 16, v25
  v_and_b32 v55, 0xffff0000, v25
  v_cvt_pk_bf16_f32 v8, v56, v57
  v_lshlrev_b32 v56, 16, v8
  v_and_b32 v57, 0xffff0000, v8
  v_lshlrev_b32 v10, 16, v26
  v_and_b32 v11, 0xffff0000, v26
  v_pk_add_f32 v[56:57], v[56:57], v[10:11]
  v_cvt_pk_bf16_f32 v26, v56, v57
  v_lshlrev_b32 v56, 16, v26
  v_and_b32 v57, 0xffff0000, v26
  v_cvt_pk_bf16_f32 v8, v58, v59
  v_lshlrev_b32 v58, 16, v8
  v_and_b32 v59, 0xffff0000, v8
  v_lshlrev_b32 v10, 16, v27
  v_and_b32 v11, 0xffff0000, v27
  v_pk_add_f32 v[58:59], v[58:59], v[10:11]
  v_cvt_pk_bf16_f32 v27, v58, v59
  v_lshlrev_b32 v58, 16, v27
  v_and_b32 v59, 0xffff0000, v27
  buffer_store_dwordx4 v[24:27], v15, s[4:7], s21 offen offset:128
  s_waitcnt vmcnt(11)
  v_lshlrev_b32 v60, 16, v176
  v_and_b32 v61, 0xffff0000, v176
  v_lshlrev_b32 v62, 16, v177
  v_and_b32 v63, 0xffff0000, v177
  v_lshlrev_b32 v64, 16, v178
  v_and_b32 v65, 0xffff0000, v178
  v_lshlrev_b32 v66, 16, v179
  v_and_b32 v67, 0xffff0000, v179
  v_lshlrev_b32 v8, 16, v180
  v_and_b32 v9, 0xffff0000, v180
  v_pk_add_f32 v[60:61], v[60:61], v[8:9]
  v_lshlrev_b32 v8, 16, v181
  v_and_b32 v9, 0xffff0000, v181
  v_pk_add_f32 v[62:63], v[62:63], v[8:9]
  v_lshlrev_b32 v8, 16, v182
  v_and_b32 v9, 0xffff0000, v182
  v_pk_add_f32 v[64:65], v[64:65], v[8:9]
  v_lshlrev_b32 v8, 16, v183
  v_and_b32 v9, 0xffff0000, v183
  v_pk_add_f32 v[66:67], v[66:67], v[8:9]
  v_lshlrev_b32 v8, 16, v184
  v_and_b32 v9, 0xffff0000, v184
  v_pk_add_f32 v[60:61], v[60:61], v[8:9]
  v_lshlrev_b32 v8, 16, v185
  v_and_b32 v9, 0xffff0000, v185
  v_pk_add_f32 v[62:63], v[62:63], v[8:9]
  v_lshlrev_b32 v8, 16, v186
  v_and_b32 v9, 0xffff0000, v186
  v_pk_add_f32 v[64:65], v[64:65], v[8:9]
  v_lshlrev_b32 v8, 16, v187
  v_and_b32 v9, 0xffff0000, v187
  v_pk_add_f32 v[66:67], v[66:67], v[8:9]
  v_lshlrev_b32 v8, 16, v188
  v_and_b32 v9, 0xffff0000, v188
  v_pk_add_f32 v[60:61], v[60:61], v[8:9]
  v_lshlrev_b32 v8, 16, v189
  v_and_b32 v9, 0xffff0000, v189
  v_pk_add_f32 v[62:63], v[62:63], v[8:9]
  v_lshlrev_b32 v8, 16, v190
  v_and_b32 v9, 0xffff0000, v190
  v_pk_add_f32 v[64:65], v[64:65], v[8:9]
  v_lshlrev_b32 v8, 16, v191
  v_and_b32 v9, 0xffff0000, v191
  v_pk_add_f32 v[66:67], v[66:67], v[8:9]
  v_lshlrev_b32 v8, 16, v192
  v_and_b32 v9, 0xffff0000, v192
  v_pk_add_f32 v[60:61], v[60:61], v[8:9]
  v_lshlrev_b32 v8, 16, v193
  v_and_b32 v9, 0xffff0000, v193
  v_pk_add_f32 v[62:63], v[62:63], v[8:9]
  v_lshlrev_b32 v8, 16, v194
  v_and_b32 v9, 0xffff0000, v194
  v_pk_add_f32 v[64:65], v[64:65], v[8:9]
  v_lshlrev_b32 v8, 16, v195
  v_and_b32 v9, 0xffff0000, v195
  v_pk_add_f32 v[66:67], v[66:67], v[8:9]
  v_lshlrev_b32 v8, 16, v196
  v_and_b32 v9, 0xffff0000, v196
  v_pk_add_f32 v[60:61], v[60:61], v[8:9]
  v_lshlrev_b32 v8, 16, v197
  v_and_b32 v9, 0xffff0000, v197
  v_pk_add_f32 v[62:63], v[62:63], v[8:9]
  v_lshlrev_b32 v8, 16, v198
  v_and_b32 v9, 0xffff0000, v198
  v_pk_add_f32 v[64:65], v[64:65], v[8:9]
  v_lshlrev_b32 v8, 16, v199
  v_and_b32 v9, 0xffff0000, v199
  v_pk_add_f32 v[66:67], v[66:67], v[8:9]
  v_lshlrev_b32 v8, 16, v200
  v_and_b32 v9, 0xffff0000, v200
  v_pk_add_f32 v[60:61], v[60:61], v[8:9]
  v_lshlrev_b32 v8, 16, v201
  v_and_b32 v9, 0xffff0000, v201
  v_pk_add_f32 v[62:63], v[62:63], v[8:9]
  v_lshlrev_b32 v8, 16, v202
  v_and_b32 v9, 0xffff0000, v202
  v_pk_add_f32 v[64:65], v[64:65], v[8:9]
  v_lshlrev_b32 v8, 16, v203
  v_and_b32 v9, 0xffff0000, v203
  v_pk_add_f32 v[66:67], v[66:67], v[8:9]
  v_lshlrev_b32 v8, 16, v204
  v_and_b32 v9, 0xffff0000, v204
  v_pk_add_f32 v[60:61], v[60:61], v[8:9]
  v_lshlrev_b32 v8, 16, v205
  v_and_b32 v9, 0xffff0000, v205
  v_pk_add_f32 v[62:63], v[62:63], v[8:9]
  v_lshlrev_b32 v8, 16, v206
  v_and_b32 v9, 0xffff0000, v206
  v_pk_add_f32 v[64:65], v[64:65], v[8:9]
  v_lshlrev_b32 v8, 16, v207
  v_and_b32 v9, 0xffff0000, v207
  v_pk_add_f32 v[66:67], v[66:67], v[8:9]
  v_cvt_pk_bf16_f32 v8, v60, v61
  v_lshlrev_b32 v60, 16, v8
  v_and_b32 v61, 0xffff0000, v8
  v_lshlrev_b32 v10, 16, v28
  v_and_b32 v11, 0xffff0000, v28
  v_pk_add_f32 v[60:61], v[60:61], v[10:11]
  v_cvt_pk_bf16_f32 v28, v60, v61
  v_lshlrev_b32 v60, 16, v28
  v_and_b32 v61, 0xffff0000, v28
  v_cvt_pk_bf16_f32 v8, v62, v63
  v_lshlrev_b32 v62, 16, v8
  v_and_b32 v63, 0xffff0000, v8
  v_lshlrev_b32 v10, 16, v29
  v_and_b32 v11, 0xffff0000, v29
  v_pk_add_f32 v[62:63], v[62:63], v[10:11]
  v_cvt_pk_bf16_f32 v29, v62, v63
  v_lshlrev_b32 v62, 16, v29
  v_and_b32 v63, 0xffff0000, v29
  v_cvt_pk_bf16_f32 v8, v64, v65
  v_lshlrev_b32 v64, 16, v8
  v_and_b32 v65, 0xffff0000, v8
  v_lshlrev_b32 v10, 16, v30
  v_and_b32 v11, 0xffff0000, v30
  v_pk_add_f32 v[64:65], v[64:65], v[10:11]
  v_cvt_pk_bf16_f32 v30, v64, v65
  v_lshlrev_b32 v64, 16, v30
  v_and_b32 v65, 0xffff0000, v30
  v_cvt_pk_bf16_f32 v8, v66, v67
  v_lshlrev_b32 v66, 16, v8
  v_and_b32 v67, 0xffff0000, v8
  v_lshlrev_b32 v10, 16, v31
  v_and_b32 v11, 0xffff0000, v31
  v_pk_add_f32 v[66:67], v[66:67], v[10:11]
  v_cvt_pk_bf16_f32 v31, v66, v67
  v_lshlrev_b32 v66, 16, v31
  v_and_b32 v67, 0xffff0000, v31
  buffer_store_dwordx4 v[28:31], v15, s[4:7], s21 offen offset:192
  s_waitcnt vmcnt(4)
  v_lshlrev_b32 v68, 16, v208
  v_and_b32 v69, 0xffff0000, v208
  v_lshlrev_b32 v70, 16, v209
  v_and_b32 v71, 0xffff0000, v209
  v_lshlrev_b32 v72, 16, v210
  v_and_b32 v73, 0xffff0000, v210
  v_lshlrev_b32 v74, 16, v211
  v_and_b32 v75, 0xffff0000, v211
  v_lshlrev_b32 v8, 16, v212
  v_and_b32 v9, 0xffff0000, v212
  v_pk_add_f32 v[68:69], v[68:69], v[8:9]
  v_lshlrev_b32 v8, 16, v213
  v_and_b32 v9, 0xffff0000, v213
  v_pk_add_f32 v[70:71], v[70:71], v[8:9]
  v_lshlrev_b32 v8, 16, v214
  v_and_b32 v9, 0xffff0000, v214
  v_pk_add_f32 v[72:73], v[72:73], v[8:9]
  v_lshlrev_b32 v8, 16, v215
  v_and_b32 v9, 0xffff0000, v215
  v_pk_add_f32 v[74:75], v[74:75], v[8:9]
  v_lshlrev_b32 v8, 16, v216
  v_and_b32 v9, 0xffff0000, v216
  v_pk_add_f32 v[68:69], v[68:69], v[8:9]
  v_lshlrev_b32 v8, 16, v217
  v_and_b32 v9, 0xffff0000, v217
  v_pk_add_f32 v[70:71], v[70:71], v[8:9]
  v_lshlrev_b32 v8, 16, v218
  v_and_b32 v9, 0xffff0000, v218
  v_pk_add_f32 v[72:73], v[72:73], v[8:9]
  v_lshlrev_b32 v8, 16, v219
  v_and_b32 v9, 0xffff0000, v219
  v_pk_add_f32 v[74:75], v[74:75], v[8:9]
  v_lshlrev_b32 v8, 16, v220
  v_and_b32 v9, 0xffff0000, v220
  v_pk_add_f32 v[68:69], v[68:69], v[8:9]
  v_lshlrev_b32 v8, 16, v221
  v_and_b32 v9, 0xffff0000, v221
  v_pk_add_f32 v[70:71], v[70:71], v[8:9]
  v_lshlrev_b32 v8, 16, v222
  v_and_b32 v9, 0xffff0000, v222
  v_pk_add_f32 v[72:73], v[72:73], v[8:9]
  v_lshlrev_b32 v8, 16, v223
  v_and_b32 v9, 0xffff0000, v223
  v_pk_add_f32 v[74:75], v[74:75], v[8:9]
  v_lshlrev_b32 v8, 16, v224
  v_and_b32 v9, 0xffff0000, v224
  v_pk_add_f32 v[68:69], v[68:69], v[8:9]
  v_lshlrev_b32 v8, 16, v225
  v_and_b32 v9, 0xffff0000, v225
  v_pk_add_f32 v[70:71], v[70:71], v[8:9]
  v_lshlrev_b32 v8, 16, v226
  v_and_b32 v9, 0xffff0000, v226
  v_pk_add_f32 v[72:73], v[72:73], v[8:9]
  v_lshlrev_b32 v8, 16, v227
  v_and_b32 v9, 0xffff0000, v227
  v_pk_add_f32 v[74:75], v[74:75], v[8:9]
  v_lshlrev_b32 v8, 16, v228
  v_and_b32 v9, 0xffff0000, v228
  v_pk_add_f32 v[68:69], v[68:69], v[8:9]
  v_lshlrev_b32 v8, 16, v229
  v_and_b32 v9, 0xffff0000, v229
  v_pk_add_f32 v[70:71], v[70:71], v[8:9]
  v_lshlrev_b32 v8, 16, v230
  v_and_b32 v9, 0xffff0000, v230
  v_pk_add_f32 v[72:73], v[72:73], v[8:9]
  v_lshlrev_b32 v8, 16, v231
  v_and_b32 v9, 0xffff0000, v231
  v_pk_add_f32 v[74:75], v[74:75], v[8:9]
  v_lshlrev_b32 v8, 16, v232
  v_and_b32 v9, 0xffff0000, v232
  v_pk_add_f32 v[68:69], v[68:69], v[8:9]
  v_lshlrev_b32 v8, 16, v233
  v_and_b32 v9, 0xffff0000, v233
  v_pk_add_f32 v[70:71], v[70:71], v[8:9]
  v_lshlrev_b32 v8, 16, v234
  v_and_b32 v9, 0xffff0000, v234
  v_pk_add_f32 v[72:73], v[72:73], v[8:9]
  v_lshlrev_b32 v8, 16, v235
  v_and_b32 v9, 0xffff0000, v235
  v_pk_add_f32 v[74:75], v[74:75], v[8:9]
  v_lshlrev_b32 v8, 16, v236
  v_and_b32 v9, 0xffff0000, v236
  v_pk_add_f32 v[68:69], v[68:69], v[8:9]
  v_lshlrev_b32 v8, 16, v237
  v_and_b32 v9, 0xffff0000, v237
  v_pk_add_f32 v[70:71], v[70:71], v[8:9]
  v_lshlrev_b32 v8, 16, v238
  v_and_b32 v9, 0xffff0000, v238
  v_pk_add_f32 v[72:73], v[72:73], v[8:9]
  v_lshlrev_b32 v8, 16, v239
  v_and_b32 v9, 0xffff0000, v239
  v_pk_add_f32 v[74:75], v[74:75], v[8:9]
  v_cvt_pk_bf16_f32 v8, v68, v69
  v_lshlrev_b32 v68, 16, v8
  v_and_b32 v69, 0xffff0000, v8
  v_lshlrev_b32 v10, 16, v32
  v_and_b32 v11, 0xffff0000, v32
  v_pk_add_f32 v[68:69], v[68:69], v[10:11]
  v_cvt_pk_bf16_f32 v32, v68, v69
  v_lshlrev_b32 v68, 16, v32
  v_and_b32 v69, 0xffff0000, v32
  v_cvt_pk_bf16_f32 v8, v70, v71
  v_lshlrev_b32 v70, 16, v8
  v_and_b32 v71, 0xffff0000, v8
  v_lshlrev_b32 v10, 16, v33
  v_and_b32 v11, 0xffff0000, v33
  v_pk_add_f32 v[70:71], v[70:71], v[10:11]
  v_cvt_pk_bf16_f32 v33, v70, v71
  v_lshlrev_b32 v70, 16, v33
  v_and_b32 v71, 0xffff0000, v33
  v_cvt_pk_bf16_f32 v8, v72, v73
  v_lshlrev_b32 v72, 16, v8
  v_and_b32 v73, 0xffff0000, v8
  v_lshlrev_b32 v10, 16, v34
  v_and_b32 v11, 0xffff0000, v34
  v_pk_add_f32 v[72:73], v[72:73], v[10:11]
  v_cvt_pk_bf16_f32 v34, v72, v73
  v_lshlrev_b32 v72, 16, v34
  v_and_b32 v73, 0xffff0000, v34
  v_cvt_pk_bf16_f32 v8, v74, v75
  v_lshlrev_b32 v74, 16, v8
  v_and_b32 v75, 0xffff0000, v8
  v_lshlrev_b32 v10, 16, v35
  v_and_b32 v11, 0xffff0000, v35
  v_pk_add_f32 v[74:75], v[74:75], v[10:11]
  v_cvt_pk_bf16_f32 v35, v74, v75
  v_lshlrev_b32 v74, 16, v35
  v_and_b32 v75, 0xffff0000, v35
  buffer_store_dwordx4 v[32:35], v15, s[4:7], s21 offen offset:256
  v_and_b32 v3, 63, v0
  v_and_b32 v2, 15, v3
  v_lshlrev_b32 v5, 2, v2
  s_lshl_b32 s17, s16, 6
  v_add_u32 v1, s17, v5
  v_pk_add_f32 v[6:7], v[36:37], v[38:39]
  v_pk_add_f32 v[6:7], v[6:7], v[40:41]
  v_pk_add_f32 v[6:7], v[6:7], v[42:43]
  v_pk_add_f32 v[6:7], v[6:7], v[44:45]
  v_pk_add_f32 v[6:7], v[6:7], v[46:47]
  v_pk_add_f32 v[6:7], v[6:7], v[48:49]
  v_pk_add_f32 v[6:7], v[6:7], v[50:51]
  v_pk_add_f32 v[6:7], v[6:7], v[52:53]
  v_pk_add_f32 v[6:7], v[6:7], v[54:55]
  v_pk_add_f32 v[6:7], v[6:7], v[56:57]
  v_pk_add_f32 v[6:7], v[6:7], v[58:59]
  v_pk_add_f32 v[6:7], v[6:7], v[60:61]
  v_pk_add_f32 v[6:7], v[6:7], v[62:63]
  v_pk_add_f32 v[6:7], v[6:7], v[64:65]
  v_pk_add_f32 v[6:7], v[6:7], v[66:67]
  v_pk_add_f32 v[6:7], v[6:7], v[68:69]
  v_pk_add_f32 v[6:7], v[6:7], v[70:71]
  v_pk_add_f32 v[6:7], v[6:7], v[72:73]
  v_pk_add_f32 v[6:7], v[6:7], v[74:75]
  v_add_f32 v4, v6, v7
  v_mov_b32 v2, v4
  s_nop 1
  v_permlane32_swap_b32 v4, v2
  v_add_f32 v4, v4, v2
  v_mov_b32 v2, v4
  s_nop 1
  v_permlane16_swap_b32 v4, v2
  v_add_f32 v4, v4, v2
  ds_write_b32 v1, v4 offset:0
  s_waitcnt lgkmcnt(0)
  s_barrier
  ds_read_b32 v4, v5 offset:0
  ds_read_b32 v2, v5 offset:64
  ds_read_b32 v3, v5 offset:128
  ds_read_b32 v6, v5 offset:192
  s_waitcnt lgkmcnt(0)
  v_add_f32 v4, v4, v2
  v_add_f32 v3, v3, v6
  v_add_f32 v4, v4, v3
  v_mul_f32 v6, 0xbacccccd, v4
  v_mov_b32 v7, v6
  v_pk_add_f32 v[36:37], v[36:37], v[6:7]
  v_pk_add_f32 v[38:39], v[38:39], v[6:7]
  v_pk_add_f32 v[40:41], v[40:41], v[6:7]
  v_pk_add_f32 v[42:43], v[42:43], v[6:7]
  v_pk_add_f32 v[44:45], v[44:45], v[6:7]
  v_pk_add_f32 v[46:47], v[46:47], v[6:7]
  v_pk_add_f32 v[48:49], v[48:49], v[6:7]
  v_pk_add_f32 v[50:51], v[50:51], v[6:7]
  v_pk_add_f32 v[52:53], v[52:53], v[6:7]
  v_pk_add_f32 v[54:55], v[54:55], v[6:7]
  v_pk_add_f32 v[56:57], v[56:57], v[6:7]
  v_pk_add_f32 v[58:59], v[58:59], v[6:7]
  v_pk_add_f32 v[60:61], v[60:61], v[6:7]
  v_pk_add_f32 v[62:63], v[62:63], v[6:7]
  v_pk_add_f32 v[64:65], v[64:65], v[6:7]
  v_pk_add_f32 v[66:67], v[66:67], v[6:7]
  v_pk_add_f32 v[68:69], v[68:69], v[6:7]
  v_pk_add_f32 v[70:71], v[70:71], v[6:7]
  v_pk_add_f32 v[72:73], v[72:73], v[6:7]
  v_pk_add_f32 v[74:75], v[74:75], v[6:7]
  v_pk_mul_f32 v[6:7], v[36:37], v[36:37]
  v_pk_fma_f32 v[6:7], v[38:39], v[38:39], v[6:7]
  v_pk_fma_f32 v[6:7], v[40:41], v[40:41], v[6:7]
  v_pk_fma_f32 v[6:7], v[42:43], v[42:43], v[6:7]
  v_pk_fma_f32 v[6:7], v[44:45], v[44:45], v[6:7]
  v_pk_fma_f32 v[6:7], v[46:47], v[46:47], v[6:7]
  v_pk_fma_f32 v[6:7], v[48:49], v[48:49], v[6:7]
  v_pk_fma_f32 v[6:7], v[50:51], v[50:51], v[6:7]
  v_pk_fma_f32 v[6:7], v[52:53], v[52:53], v[6:7]
  v_pk_fma_f32 v[6:7], v[54:55], v[54:55], v[6:7]
  v_pk_fma_f32 v[6:7], v[56:57], v[56:57], v[6:7]
  v_pk_fma_f32 v[6:7], v[58:59], v[58:59], v[6:7]
  v_pk_fma_f32 v[6:7], v[60:61], v[60:61], v[6:7]
  v_pk_fma_f32 v[6:7], v[62:63], v[62:63], v[6:7]
  v_pk_fma_f32 v[6:7], v[64:65], v[64:65], v[6:7]
  v_pk_fma_f32 v[6:7], v[66:67], v[66:67], v[6:7]
  v_pk_fma_f32 v[6:7], v[68:69], v[68:69], v[6:7]
  v_pk_fma_f32 v[6:7], v[70:71], v[70:71], v[6:7]
  v_pk_fma_f32 v[6:7], v[72:73], v[72:73], v[6:7]
  v_pk_fma_f32 v[6:7], v[74:75], v[74:75], v[6:7]
  v_add_f32 v4, v6, v7
  v_mov_b32 v2, v4
  s_nop 1
  v_permlane32_swap_b32 v4, v2
  v_add_f32 v4, v4, v2
  v_mov_b32 v2, v4
  s_nop 1
  v_permlane16_swap_b32 v4, v2
  v_add_f32 v4, v4, v2
  ds_write_b32 v1, v4 offset:256
  s_waitcnt lgkmcnt(0)
  s_barrier
  ds_read_b32 v4, v5 offset:256
  ds_read_b32 v2, v5 offset:320
  ds_read_b32 v3, v5 offset:384
  ds_read_b32 v6, v5 offset:448
  s_waitcnt lgkmcnt(0)
  v_add_f32 v4, v4, v2
  v_add_f32 v3, v3, v6
  v_add_f32 v4, v4, v3
  v_mov_b32 v2, 0x3727c5ac
  v_fmac_f32 v2, 0x3acccccd, v4
  v_rsq_f32 v6, v2
  s_nop 0
  v_mov_b32 v7, v6
  v_pk_mul_f32 v[36:37], v[36:37], v[6:7]
  v_pk_mul_f32 v[38:39], v[38:39], v[6:7]
  v_pk_mul_f32 v[40:41], v[40:41], v[6:7]
  v_pk_mul_f32 v[42:43], v[42:43], v[6:7]
  v_pk_mul_f32 v[44:45], v[44:45], v[6:7]
  v_pk_mul_f32 v[46:47], v[46:47], v[6:7]
  v_pk_mul_f32 v[48:49], v[48:49], v[6:7]
  v_pk_mul_f32 v[50:51], v[50:51], v[6:7]
  v_pk_mul_f32 v[52:53], v[52:53], v[6:7]
  v_pk_mul_f32 v[54:55], v[54:55], v[6:7]
  v_pk_mul_f32 v[56:57], v[56:57], v[6:7]
  v_pk_mul_f32 v[58:59], v[58:59], v[6:7]
  v_pk_mul_f32 v[60:61], v[60:61], v[6:7]
  v_pk_mul_f32 v[62:63], v[62:63], v[6:7]
  v_pk_mul_f32 v[64:65], v[64:65], v[6:7]
  v_pk_mul_f32 v[66:67], v[66:67], v[6:7]
  v_pk_mul_f32 v[68:69], v[68:69], v[6:7]
  v_pk_mul_f32 v[70:71], v[70:71], v[6:7]
  v_pk_mul_f32 v[72:73], v[72:73], v[6:7]
  v_pk_mul_f32 v[74:75], v[74:75], v[6:7]
  v_cvt_pk_bf16_f32 v16, v36, v37
  v_cvt_pk_bf16_f32 v17, v38, v39
  v_cvt_pk_bf16_f32 v18, v40, v41
  v_cvt_pk_bf16_f32 v19, v42, v43
  v_cvt_pk_bf16_f32 v20, v44, v45
  v_cvt_pk_bf16_f32 v21, v46, v47
  v_cvt_pk_bf16_f32 v22, v48, v49
  v_cvt_pk_bf16_f32 v23, v50, v51
  v_cvt_pk_bf16_f32 v24, v52, v53
  v_cvt_pk_bf16_f32 v25, v54, v55
  v_cvt_pk_bf16_f32 v26, v56, v57
  v_cvt_pk_bf16_f32 v27, v58, v59
  v_cvt_pk_bf16_f32 v28, v60, v61
  v_cvt_pk_bf16_f32 v29, v62, v63
  v_cvt_pk_bf16_f32 v30, v64, v65
  v_cvt_pk_bf16_f32 v31, v66, v67
  v_cvt_pk_bf16_f32 v32, v68, v69
  v_cvt_pk_bf16_f32 v33, v70, v71
  v_cvt_pk_bf16_f32 v34, v72, v73
  v_cvt_pk_bf16_f32 v35, v74, v75
  v_and_b32 v3, 63, v0
  v_and_b32 v2, 15, v3
  v_lshlrev_b32 v1, 4, v2
  v_bfe_u32 v2, v3, 4, 1
  v_lshl_add_u32 v1, v2, 9, v1
  v_lshrrev_b32 v2, 5, v3
  v_lshl_add_u32 v1, v2, 10, v1
  s_lshr_b32 s17, s2, 1
  s_mul_i32 s17, s17, 40960
  s_and_b32 s18, s2, 1
  s_lshl_b32 s18, s18, 8
  s_add_u32 s17, s17, s18
  s_mul_i32 s18, s16, 10240
  s_add_u32 s17, s17, s18
  s_add_u32 s17, s17, 199229440
  buffer_store_dwordx4 v[16:19], v1, s[4:7], s17 offen offset:0
  buffer_store_dwordx4 v[20:23], v1, s[4:7], s17 offen offset:2048
  s_add_u32 s17, s17, 4096
  buffer_store_dwordx4 v[24:27], v1, s[4:7], s17 offen offset:0
  buffer_store_dwordx4 v[28:31], v1, s[4:7], s17 offen offset:2048
  s_add_u32 s17, s17, 4096
  buffer_store_dwordx4 v[32:35], v1, s[4:7], s17 offen offset:0
redln2_exit1:
  s_endpgm
.globl qkvb_kernel
.p2align 8
.type qkvb_kernel,@function
qkvb_kernel:
  s_cmp_ge_u32 s2, 256
  s_cbranch_scc1 qkvb_exit1
  s_load_dwordx2 s[12:13], s[0:1], 96
  v_lshrrev_b32 v2, 6, v0
  v_and_b32 v3, 63, v0
  s_nop 0
  v_readfirstlane_b32 s16, v2
  v_lshlrev_b32 v8, 4, v3
  s_and_b32 s17, s2, 7
  s_lshr_b32 s18, s2, 3
  s_waitcnt lgkmcnt(0)
  s_mov_b32 s4, s12
  s_mov_b32 s5, s13
  s_mov_b32 s6, 0x10000000
  s_mov_b32 s7, 0x20000
  s_mul_i32 s21, s18, 81920
  s_mul_i32 s22, s16, 20480
  s_add_u32 s21, s21, s22
  s_add_u32 s21, s21, 199229440
  s_add_u32 m0, s22, 0
  s_nop 0
  buffer_load_dwordx4 v8, s[4:7], s21 offen offset:0 lds
  buffer_load_dwordx4 v8, s[4:7], s21 offen offset:1024 lds
  buffer_load_dwordx4 v8, s[4:7], s21 offen offset:2048 lds
  buffer_load_dwordx4 v8, s[4:7], s21 offen offset:3072 lds
  s_add_u32 s21, s21, 4096
  s_add_u32 m0, s22, 4096
  s_nop 0
  buffer_load_dwordx4 v8, s[4:7], s21 offen offset:0 lds
  buffer_load_dwordx4 v8, s[4:7], s21 offen offset:1024 lds
  buffer_load_dwordx4 v8, s[4:7], s21 offen offset:2048 lds
  buffer_load_dwordx4 v8, s[4:7], s21 offen offset:3072 lds
  s_add_u32 s21, s21, 4096
  s_add_u32 m0, s22, 8192
  s_nop 0
  buffer_load_dwordx4 v8, s[4:7], s21 offen offset:0 lds
  buffer_load_dwordx4 v8, s[4:7], s21 offen offset:1024 lds
  buffer_load_dwordx4 v8, s[4:7], s21 offen offset:2048 lds
  buffer_load_dwordx4 v8, s[4:7], s21 offen offset:3072 lds
  s_add_u32 s21, s21, 4096
  s_add_u32 m0, s22, 12288
  s_nop 0
  buffer_load_dwordx4 v8, s[4:7], s21 offen offset:0 lds
  buffer_load_dwordx4 v8, s[4:7], s21 offen offset:1024 lds
  buffer_load_dwordx4 v8, s[4:7], s21 offen offset:2048 lds
  buffer_load_dwordx4 v8, s[4:7], s21 offen offset:3072 lds
  s_add_u32 s21, s21, 4096
  s_add_u32 m0, s22, 16384
  s_nop 0
  buffer_load_dwordx4 v8, s[4:7], s21 offen offset:0 lds
  buffer_load_dwordx4 v8, s[4:7], s21 offen offset:1024 lds
  buffer_load_dwordx4 v8, s[4:7], s21 offen offset:2048 lds
  buffer_load_dwordx4 v8, s[4:7], s21 offen offset:3072 lds
  s_add_u32 s21, s21, 4096
  s_lshl_b32 s23, s17, 2
  s_add_u32 s23, s23, s16
  s_mul_i32 s24, s23, 40960
  s_add_u32 s24, s24, 156237824
  s_add_u32 s25, s24, 1310720
  s_add_u32 s26, s25, 1310720
  buffer_load_dwordx4 a[0:3], v8, s[4:7], s24 offen offset:0
  buffer_load_dwordx4 a[4:7], v8, s[4:7], s25 offen offset:0
  buffer_load_dwordx4 a[8:11], v8, s[4:7], s26 offen offset:0
  buffer_load_dwordx4 a[12:15], v8, s[4:7], s24 offen offset:1024
  buffer_load_dwordx4 a[16:19], v8, s[4:7], s25 offen offset:1024
  buffer_load_dwordx4 a[20:23], v8, s[4:7], s26 offen offset:1024
  buffer_load_dwordx4 a[24:27], v8, s[4:7], s24 offen offset:2048
  buffer_load_dwordx4 a[28:31], v8, s[4:7], s25 offen offset:2048
  buffer_load_dwordx4 a[32:35], v8, s[4:7], s26 offen offset:2048
  buffer_load_dwordx4 a[36:39], v8, s[4:7], s24 offen offset:3072
  buffer_load_dwordx4 a[40:43], v8, s[4:7], s25 offen offset:3072
  buffer_load_dwordx4 a[44:47], v8, s[4:7], s26 offen offset:3072
  s_add_u32 s24, s24, 4096
  s_add_u32 s25, s25, 4096
  s_add_u32 s26, s26, 4096
  buffer_load_dwordx4 a[48:51], v8, s[4:7], s24 offen offset:0
  buffer_load_dwordx4 a[52:55], v8, s[4:7], s25 offen offset:0
  buffer_load_dwordx4 a[56:59], v8, s[4:7], s26 offen offset:0
  buffer_load_dwordx4 a[60:63], v8, s[4:7], s24 offen offset:1024
  buffer_load_dwordx4 a[64:67], v8, s[4:7], s25 offen offset:1024
  buffer_load_dwordx4 a[68:71], v8, s[4:7], s26 offen offset:1024
  buffer_load_dwordx4 a[72:75], v8, s[4:7], s24 offen offset:2048
  buffer_load_dwordx4 a[76:79], v8, s[4:7], s25 offen offset:2048
  buffer_load_dwordx4 a[80:83], v8, s[4:7], s26 offen offset:2048
  buffer_load_dwordx4 a[84:87], v8, s[4:7], s24 offen offset:3072
  buffer_load_dwordx4 a[88:91], v8, s[4:7], s25 offen offset:3072
  buffer_load_dwordx4 a[92:95], v8, s[4:7], s26 offen offset:3072
  s_add_u32 s24, s24, 4096
  s_add_u32 s25, s25, 4096
  s_add_u32 s26, s26, 4096
  buffer_load_dwordx4 a[96:99], v8, s[4:7], s24 offen offset:0
  buffer_load_dwordx4 a[100:103], v8, s[4:7], s25 offen offset:0
  buffer_load_dwordx4 a[104:107], v8, s[4:7], s26 offen offset:0
  buffer_load_dwordx4 a[108:111], v8, s[4:7], s24 offen offset:1024
  buffer_load_dwordx4 a[112:115], v8, s[4:7], s25 offen offset:1024
  buffer_load_dwordx4 a[116:119], v8, s[4:7], s26 offen offset:1024
  buffer_load_dwordx4 a[120:123], v8, s[4:7], s24 offen offset:2048
  buffer_load_dwordx4 a[124:127], v8, s[4:7], s25 offen offset:2048
  buffer_load_dwordx4 a[128:131], v8, s[4:7], s26 offen offset:2048
  buffer_load_dwordx4 a[132:135], v8, s[4:7], s24 offen offset:3072
  buffer_load_dwordx4 a[136:139], v8, s[4:7], s25 offen offset:3072
  buffer_load_dwordx4 a[140:143], v8, s[4:7], s26 offen offset:3072
  s_add_u32 s24, s24, 4096
  s_add_u32 s25, s25, 4096
  s_add_u32 s26, s26, 4096
  buffer_load_dwordx4 a[144:147], v8, s[4:7], s24 offen offset:0
  buffer_load_dwordx4 a[148:151], v8, s[4:7], s25 offen offset:0
  buffer_load_dwordx4 a[152:155], v8, s[4:7], s26 offen offset:0
  s_waitcnt vmcnt(39)
  v_add_u32 v9, 40960, v8
  s_barrier
  ds_read_b128 v[16:19], v8 offset:0
  ds_read_b128 v[20:23], v9 offset:0
  ds_read_b128 v[24:27], v8 offset:1024
  ds_read_b128 v[28:31], v9 offset:1024
  buffer_load_dwordx4 a[156:159], v8, s[4:7], s24 offen offset:1024
  buffer_load_dwordx4 a[160:163], v8, s[4:7], s25 offen offset:1024
  buffer_load_dwordx4 a[164:167], v8, s[4:7], s26 offen offset:1024
  s_waitcnt vmcnt(39)
  ds_read_b128 v[32:35], v8 offset:2048
  ds_read_b128 v[36:39], v9 offset:2048
  s_waitcnt lgkmcnt(4)
  v_mfma_f32_32x32x16_bf16 v[96:111], a[0:3], v[16:19], 0
  v_mfma_f32_32x32x16_bf16 v[112:127], a[0:3], v[20:23], 0
  v_mfma_f32_32x32x16_bf16 v[128:143], a[4:7], v[16:19], 0
  v_mfma_f32_32x32x16_bf16 v[144:159], a[4:7], v[20:23], 0
  v_mfma_f32_32x32x16_bf16 v[160:175], v[16:19], a[8:11], 0
  v_mfma_f32_32x32x16_bf16 v[176:191], v[20:23], a[8:11], 0
  buffer_load_dwordx4 a[168:171], v8, s[4:7], s24 offen offset:2048
  buffer_load_dwordx4 a[172:175], v8, s[4:7], s25 offen offset:2048
  buffer_load_dwordx4 a[176:179], v8, s[4:7], s26 offen offset:2048
  s_waitcnt vmcnt(39)
  ds_read_b128 v[16:19], v8 offset:3072
  ds_read_b128 v[20:23], v9 offset:3072
  s_waitcnt lgkmcnt(4)
  v_mfma_f32_32x32x16_bf16 v[96:111], a[12:15], v[24:27], v[96:111]
  v_mfma_f32_32x32x16_bf16 v[112:127], a[12:15], v[28:31], v[112:127]
  v_mfma_f32_32x32x16_bf16 v[128:143], a[16:19], v[24:27], v[128:143]
  v_mfma_f32_32x32x16_bf16 v[144:159], a[16:19], v[28:31], v[144:159]
  v_mfma_f32_32x32x16_bf16 v[160:175], v[24:27], a[20:23], v[160:175]
  v_mfma_f32_32x32x16_bf16 v[176:191], v[28:31], a[20:23], v[176:191]
  buffer_load_dwordx4 a[180:183], v8, s[4:7], s24 offen offset:3072
  buffer_load_dwordx4 a[184:187], v8, s[4:7], s25 offen offset:3072
  buffer_load_dwordx4 a[188:191], v8, s[4:7], s26 offen offset:3072
  s_add_u32 s24, s24, 4096
  s_add_u32 s25, s25, 4096
  s_add_u32 s26, s26, 4096
  s_waitcnt vmcnt(39)
  ds_read_b128 v[24:27], v8 offset:4096
  ds_read_b128 v[28:31], v9 offset:4096
  s_waitcnt lgkmcnt(4)
  v_mfma_f32_32x32x16_bf16 v[96:111], a[24:27], v[32:35], v[96:111]
  v_mfma_f32_32x32x16_bf16 v[112:127], a[24:27], v[36:39], v[112:127]
  v_mfma_f32_32x32x16_bf16 v[128:143], a[28:31], v[32:35], v[128:143]
  v_mfma_f32_32x32x16_bf16 v[144:159], a[28:31], v[36:39], v[144:159]
  v_mfma_f32_32x32x16_bf16 v[160:175], v[32:35], a[32:35], v[160:175]
  v_mfma_f32_32x32x16_bf16 v[176:191], v[36:39], a[32:35], v[176:191]
  buffer_load_dwordx4 a[0:3], v8, s[4:7], s24 offen offset:0
  buffer_load_dwordx4 a[4:7], v8, s[4:7], s25 offen offset:0
  buffer_load_dwordx4 a[8:11], v8, s[4:7], s26 offen offset:0
  s_waitcnt vmcnt(39)
  ds_read_b128 v[32:35], v8 offset:5120
  ds_read_b128 v[36:39], v9 offset:5120
  s_waitcnt lgkmcnt(4)
  v_mfma_f32_32x32x16_bf16 v[96:111], a[36:39], v[16:19], v[96:111]
  v_mfma_f32_32x32x16_bf16 v[112:127], a[36:39], v[20:23], v[112:127]
  v_mfma_f32_32x32x16_bf16 v[128:143], a[40:43], v[16:19], v[128:143]
  v_mfma_f32_32x32x16_bf16 v[144:159], a[40:43], v[20:23], v[144:159]
  v_mfma_f32_32x32x16_bf16 v[160:175], v[16:19], a[44:47], v[160:175]
  v_mfma_f32_32x32x16_bf16 v[176:191], v[20:23], a[44:47], v[176:191]
  buffer_load_dwordx4 a[12:15], v8, s[4:7], s24 offen offset:1024
  buffer_load_dwordx4 a[16:19], v8, s[4:7], s25 offen offset:1024
  buffer_load_dwordx4 a[20:23], v8, s[4:7], s26 offen offset:1024
  s_waitcnt vmcnt(39)
  ds_read_b128 v[16:19], v8 offset:6144
  ds_read_b128 v[20:23], v9 offset:6144
  s_waitcnt lgkmcnt(4)
  v_mfma_f32_32x32x16_bf16 v[96:111], a[48:51], v[24:27], v[96:111]
  v_mfma_f32_32x32x16_bf16 v[112:127], a[48:51], v[28:31], v[112:127]
  v_mfma_f32_32x32x16_bf16 v[128:143], a[52:55], v[24:27], v[128:143]
  v_mfma_f32_32x32x16_bf16 v[144:159], a[52:55], v[28:31], v[144:159]
  v_mfma_f32_32x32x16_bf16 v[160:175], v[24:27], a[56:59], v[160:175]
  v_mfma_f32_32x32x16_bf16 v[176:191], v[28:31], a[56:59], v[176:191]
  buffer_load_dwordx4 a[24:27], v8, s[4:7], s24 offen offset:2048
  buffer_load_dwordx4 a[28:31], v8, s[4:7], s25 offen offset:2048
  buffer_load_dwordx4 a[32:35], v8, s[4:7], s26 offen offset:2048
  s_waitcnt vmcnt(39)
  ds_read_b128 v[24:27], v8 offset:7168
  ds_read_b128 v[28:31], v9 offset:7168
  s_waitcnt lgkmcnt(4)
  v_mfma_f32_32x32x16_bf16 v[96:111], a[60:63], v[32:35], v[96:111]
  v_mfma_f32_32x32x16_bf16 v[112:127], a[60:63], v[36:39], v[112:127]
  v_mfma_f32_32x32x16_bf16 v[128:143], a[64:67], v[32:35], v[128:143]
  v_mfma_f32_32x32x16_bf16 v[144:159], a[64:67], v[36:39], v[144:159]
  v_mfma_f32_32x32x16_bf16 v[160:175], v[32:35], a[68:71], v[160:175]
  v_mfma_f32_32x32x16_bf16 v[176:191], v[36:39], a[68:71], v[176:191]
  buffer_load_dwordx4 a[36:39], v8, s[4:7], s24 offen offset:3072
  buffer_load_dwordx4 a[40:43], v8, s[4:7], s25 offen offset:3072
  buffer_load_dwordx4 a[44:47], v8, s[4:7], s26 offen offset:3072
  s_add_u32 s24, s24, 4096
  s_add_u32 s25, s25, 4096
  s_add_u32 s26, s26, 4096
  s_waitcnt vmcnt(39)
  ds_read_b128 v[32:35], v8 offset:8192
  ds_read_b128 v[36:39], v9 offset:8192
  s_waitcnt lgkmcnt(4)
  v_mfma_f32_32x32x16_bf16 v[96:111], a[72:75], v[16:19], v[96:111]
  v_mfma_f32_32x32x16_bf16 v[112:127], a[72:75], v[20:23], v[112:127]
  v_mfma_f32_32x32x16_bf16 v[128:143], a[76:79], v[16:19], v[128:143]
  v_mfma_f32_32x32x16_bf16 v[144:159], a[76:79], v[20:23], v[144:159]
  v_mfma_f32_32x32x16_bf16 v[160:175], v[16:19], a[80:83], v[160:175]
  v_mfma_f32_32x32x16_bf16 v[176:191], v[20:23], a[80:83], v[176:191]
  buffer_load_dwordx4 a[48:51], v8, s[4:7], s24 offen offset:0
  buffer_load_dwordx4 a[52:55], v8, s[4:7], s25 offen offset:0
  buffer_load_dwordx4 a[56:59], v8, s[4:7], s26 offen offset:0
  s_waitcnt vmcnt(39)
  ds_read_b128 v[16:19], v8 offset:9216
  ds_read_b128 v[20:23], v9 offset:9216
  s_waitcnt lgkmcnt(4)
  v_mfma_f32_32x32x16_bf16 v[96:111], a[84:87], v[24:27], v[96:111]
  v_mfma_f32_32x32x16_bf16 v[112:127], a[84:87], v[28:31], v[112:127]
  v_mfma_f32_32x32x16_bf16 v[128:143], a[88:91], v[24:27], v[128:143]
  v_mfma_f32_32x32x16_bf16 v[144:159], a[88:91], v[28:31], v[144:159]
  v_mfma_f32_32x32x16_bf16 v[160:175], v[24:27], a[92:95], v[160:175]
  v_mfma_f32_32x32x16_bf16 v[176:191], v[28:31], a[92:95], v[176:191]
  buffer_load_dwordx4 a[60:63], v8, s[4:7], s24 offen offset:1024
  buffer_load_dwordx4 a[64:67], v8, s[4:7], s25 offen offset:1024
  buffer_load_dwordx4 a[68:71], v8, s[4:7], s26 offen offset:1024
  s_waitcnt vmcnt(39)
  ds_read_b128 v[24:27], v8 offset:10240
  ds_read_b128 v[28:31], v9 offset:10240
  s_waitcnt lgkmcnt(4)
  v_mfma_f32_32x32x16_bf16 v[96:111], a[96:99], v[32:35], v[96:111]
  v_mfma_f32_32x32x16_bf16 v[112:127], a[96:99], v[36:39], v[112:127]
  v_mfma_f32_32x32x16_bf16 v[128:143], a[100:103], v[32:35], v[128:143]
  v_mfma_f32_32x32x16_bf16 v[144:159], a[100:103], v[36:39], v[144:159]
  v_mfma_f32_32x32x16_bf16 v[160:175], v[32:35], a[104:107], v[160:175]
  v_mfma_f32_32x32x16_bf16 v[176:191], v[36:39], a[104:107], v[176:191]
  buffer_load_dwordx4 a[72:75], v8, s[4:7], s24 offen offset:2048
  buffer_load_dwordx4 a[76:79], v8, s[4:7], s25 offen offset:2048
  buffer_load_dwordx4 a[80:83], v8, s[4:7], s26 offen offset:2048
  s_waitcnt vmcnt(39)
  ds_read_b128 v[32:35], v8 offset:11264
  ds_read_b128 v[36:39], v9 offset:11264
  s_waitcnt lgkmcnt(4)
  v_mfma_f32_32x32x16_bf16 v[96:111], a[108:111], v[16:19], v[96:111]
  v_mfma_f32_32x32x16_bf16 v[112:127], a[108:111], v[20:23], v[112:127]
  v_mfma_f32_32x32x16_bf16 v[128:143], a[112:115], v[16:19], v[128:143]
  v_mfma_f32_32x32x16_bf16 v[144:159], a[112:115], v[20:23], v[144:159]
  v_mfma_f32_32x32x16_bf16 v[160:175], v[16:19], a[116:119], v[160:175]
  v_mfma_f32_32x32x16_bf16 v[176:191], v[20:23], a[116:119], v[176:191]
  buffer_load_dwordx4 a[84:87], v8, s[4:7], s24 offen offset:3072
  buffer_load_dwordx4 a[88:91], v8, s[4:7], s25 offen offset:3072
  buffer_load_dwordx4 a[92:95], v8, s[4:7], s26 offen offset:3072
  s_add_u32 s24, s24, 4096
  s_add_u32 s25, s25, 4096
  s_add_u32 s26, s26, 4096
  s_waitcnt vmcnt(39)
  ds_read_b128 v[16:19], v8 offset:12288
  ds_read_b128 v[20:23], v9 offset:12288
  s_waitcnt lgkmcnt(4)
  v_mfma_f32_32x32x16_bf16 v[96:111], a[120:123], v[24:27], v[96:111]
  v_mfma_f32_32x32x16_bf16 v[112:127], a[120:123], v[28:31], v[112:127]
  v_mfma_f32_32x32x16_bf16 v[128:143], a[124:127], v[24:27], v[128:143]
  v_mfma_f32_32x32x16_bf16 v[144:159], a[124:127], v[28:31], v[144:159]
  v_mfma_f32_32x32x16_bf16 v[160:175], v[24:27], a[128:131], v[160:175]
  v_mfma_f32_32x32x16_bf16 v[176:191], v[28:31], a[128:131], v[176:191]
  buffer_load_dwordx4 a[96:99], v8, s[4:7], s24 offen offset:0
  buffer_load_dwordx4 a[100:103], v8, s[4:7], s25 offen offset:0
  buffer_load_dwordx4 a[104:107], v8, s[4:7], s26 offen offset:0
  s_waitcnt vmcnt(39)
  ds_read_b128 v[24:27], v8 offset:13312
  ds_read_b128 v[28:31], v9 offset:13312
  s_waitcnt lgkmcnt(4)
  v_mfma_f32_32x32x16_bf16 v[96:111], a[132:135], v[32:35], v[96:111]
  v_mfma_f32_32x32x16_bf16 v[112:127], a[132:135], v[36:39], v[112:127]
  v_mfma_f32_32x32x16_bf16 v[128:143], a[136:139], v[32:35], v[128:143]
  v_mfma_f32_32x32x16_bf16 v[144:159], a[136:139], v[36:39], v[144:159]
  v_mfma_f32_32x32x16_bf16 v[160:175], v[32:35], a[140:143], v[160:175]
  v_mfma_f32_32x32x16_bf16 v[176:191], v[36:39], a[140:143], v[176:191]
  buffer_load_dwordx4 a[108:111], v8, s[4:7], s24 offen offset:1024
  buffer_load_dwordx4 a[112:115], v8, s[4:7], s25 offen offset:1024
  buffer_load_dwordx4 a[116:119], v8, s[4:7], s26 offen offset:1024
  s_waitcnt vmcnt(39)
  ds_read_b128 v[32:35], v8 offset:14336
  ds_read_b128 v[36:39], v9 offset:14336
  s_waitcnt lgkmcnt(4)
  v_mfma_f32_32x32x16_bf16 v[96:111], a[144:147], v[16:19], v[96:111]
  v_mfma_f32_32x32x16_bf16 v[112:127], a[144:147], v[20:23], v[112:127]
  v_mfma_f32_32x32x16_bf16 v[128:143], a[148:151], v[16:19], v[128:143]
  v_mfma_f32_32x32x16_bf16 v[144:159], a[148:151], v[20:23], v[144:159]
  v_mfma_f32_32x32x16_bf16 v[160:175], v[16:19], a[152:155], v[160:175]
  v_mfma_f32_32x32x16_bf16 v[176:191], v[20:23], a[152:155], v[176:191]
  buffer_load_dwordx4 a[120:123], v8, s[4:7], s24 offen offset:2048
  buffer_load_dwordx4 a[124:127], v8, s[4:7], s25 offen offset:2048
  buffer_load_dwordx4 a[128:131], v8, s[4:7], s26 offen offset:2048
  s_waitcnt vmcnt(39)
  ds_read_b128 v[16:19], v8 offset:15360
  ds_read_b128 v[20:23], v9 offset:15360
  s_waitcnt lgkmcnt(4)
  v_mfma_f32_32x32x16_bf16 v[96:111], a[156:159], v[24:27], v[96:111]
  v_mfma_f32_32x32x16_bf16 v[112:127], a[156:159], v[28:31], v[112:127]
  v_mfma_f32_32x32x16_bf16 v[128:143], a[160:163], v[24:27], v[128:143]
  v_mfma_f32_32x32x16_bf16 v[144:159], a[160:163], v[28:31], v[144:159]
  v_mfma_f32_32x32x16_bf16 v[160:175], v[24:27], a[164:167], v[160:175]
  v_mfma_f32_32x32x16_bf16 v[176:191], v[28:31], a[164:167], v[176:191]
  buffer_load_dwordx4 a[132:135], v8, s[4:7], s24 offen offset:3072
  buffer_load_dwordx4 a[136:139], v8, s[4:7], s25 offen offset:3072
  buffer_load_dwordx4 a[140:143], v8, s[4:7], s26 offen offset:3072
  s_add_u32 s24, s24, 4096
  s_add_u32 s25, s25, 4096
  s_add_u32 s26, s26, 4096
  s_waitcnt vmcnt(39)
  ds_read_b128 v[24:27], v8 offset:16384
  ds_read_b128 v[28:31], v9 offset:16384
  s_waitcnt lgkmcnt(4)
  v_mfma_f32_32x32x16_bf16 v[96:111], a[168:171], v[32:35], v[96:111]
  v_mfma_f32_32x32x16_bf16 v[112:127], a[168:171], v[36:39], v[112:127]
  v_mfma_f32_32x32x16_bf16 v[128:143], a[172:175], v[32:35], v[128:143]
  v_mfma_f32_32x32x16_bf16 v[144:159], a[172:175], v[36:39], v[144:159]
  v_mfma_f32_32x32x16_bf16 v[160:175], v[32:35], a[176:179], v[160:175]
  v_mfma_f32_32x32x16_bf16 v[176:191], v[36:39], a[176:179], v[176:191]
  buffer_load_dwordx4 a[144:147], v8, s[4:7], s24 offen offset:0
  buffer_load_dwordx4 a[148:151], v8, s[4:7], s25 offen offset:0
  buffer_load_dwordx4 a[152:155], v8, s[4:7], s26 offen offset:0
  s_waitcnt vmcnt(39)
  ds_read_b128 v[32:35], v8 offset:17408
  ds_read_b128 v[36:39], v9 offset:17408
  s_waitcnt lgkmcnt(4)
  v_mfma_f32_32x32x16_bf16 v[96:111], a[180:183], v[16:19], v[96:111]
  v_mfma_f32_32x32x16_bf16 v[112:127], a[180:183], v[20:23], v[112:127]
  v_mfma_f32_32x32x16_bf16 v[128:143], a[184:187], v[16:19], v[128:143]
  v_mfma_f32_32x32x16_bf16 v[144:159], a[184:187], v[20:23], v[144:159]
  v_mfma_f32_32x32x16_bf16 v[160:175], v[16:19], a[188:191], v[160:175]
  v_mfma_f32_32x32x16_bf16 v[176:191], v[20:23], a[188:191], v[176:191]
  buffer_load_dwordx4 a[156:159], v8, s[4:7], s24 offen offset:1024
  buffer_load_dwordx4 a[160:163], v8, s[4:7], s25 offen offset:1024
  buffer_load_dwordx4 a[164:167], v8, s[4:7], s26 offen offset:1024
  s_waitcnt vmcnt(39)
  ds_read_b128 v[16:19], v8 offset:18432
  ds_read_b128 v[20:23], v9 offset:18432
  s_waitcnt lgkmcnt(4)
  v_mfma_f32_32x32x16_bf16 v[96:111], a[0:3], v[24:27], v[96:111]
  v_mfma_f32_32x32x16_bf16 v[112:127], a[0:3], v[28:31], v[112:127]
  v_mfma_f32_32x32x16_bf16 v[128:143], a[4:7], v[24:27], v[128:143]
  v_mfma_f32_32x32x16_bf16 v[144:159], a[4:7], v[28:31], v[144:159]
  v_mfma_f32_32x32x16_bf16 v[160:175], v[24:27], a[8:11], v[160:175]
  v_mfma_f32_32x32x16_bf16 v[176:191], v[28:31], a[8:11], v[176:191]
  buffer_load_dwordx4 a[168:171], v8, s[4:7], s24 offen offset:2048
  buffer_load_dwordx4 a[172:175], v8, s[4:7], s25 offen offset:2048
  buffer_load_dwordx4 a[176:179], v8, s[4:7], s26 offen offset:2048
  s_waitcnt vmcnt(39)
  ds_read_b128 v[24:27], v8 offset:19456
  ds_read_b128 v[28:31], v9 offset:19456
  s_waitcnt lgkmcnt(4)
  v_mfma_f32_32x32x16_bf16 v[96:111], a[12:15], v[32:35], v[96:111]
  v_mfma_f32_32x32x16_bf16 v[112:127], a[12:15], v[36:39], v[112:127]
  v_mfma_f32_32x32x16_bf16 v[128:143], a[16:19], v[32:35], v[128:143]
  v_mfma_f32_32x32x16_bf16 v[144:159], a[16:19], v[36:39], v[144:159]
  v_mfma_f32_32x32x16_bf16 v[160:175], v[32:35], a[20:23], v[160:175]
  v_mfma_f32_32x32x16_bf16 v[176:191], v[36:39], a[20:23], v[176:191]
  buffer_load_dwordx4 a[180:183], v8, s[4:7], s24 offen offset:3072
  buffer_load_dwordx4 a[184:187], v8, s[4:7], s25 offen offset:3072
  buffer_load_dwordx4 a[188:191], v8, s[4:7], s26 offen offset:3072
  s_add_u32 s24, s24, 4096
  s_add_u32 s25, s25, 4096
  s_add_u32 s26, s26, 4096
  s_waitcnt vmcnt(39)
  ds_read_b128 v[32:35], v8 offset:20480
  ds_read_b128 v[36:39], v9 offset:20480
  s_waitcnt lgkmcnt(4)
  v_mfma_f32_32x32x16_bf16 v[96:111], a[24:27], v[16:19], v[96:111]
  v_mfma_f32_32x32x16_bf16 v[112:127], a[24:27], v[20:23], v[112:127]
  v_mfma_f32_32x32x16_bf16 v[128:143], a[28:31], v[16:19], v[128:143]
  v_mfma_f32_32x32x16_bf16 v[144:159], a[28:31], v[20:23], v[144:159]
  v_mfma_f32_32x32x16_bf16 v[160:175], v[16:19], a[32:35], v[160:175]
  v_mfma_f32_32x32x16_bf16 v[176:191], v[20:23], a[32:35], v[176:191]
  buffer_load_dwordx4 a[0:3], v8, s[4:7], s24 offen offset:0
  buffer_load_dwordx4 a[4:7], v8, s[4:7], s25 offen offset:0
  buffer_load_dwordx4 a[8:11], v8, s[4:7], s26 offen offset:0
  s_waitcnt vmcnt(39)
  ds_read_b128 v[16:19], v8 offset:21504
  ds_read_b128 v[20:23], v9 offset:21504
  s_waitcnt lgkmcnt(4)
  v_mfma_f32_32x32x16_bf16 v[96:111], a[36:39], v[24:27], v[96:111]
  v_mfma_f32_32x32x16_bf16 v[112:127], a[36:39], v[28:31], v[112:127]
  v_mfma_f32_32x32x16_bf16 v[128:143], a[40:43], v[24:27], v[128:143]
  v_mfma_f32_32x32x16_bf16 v[144:159], a[40:43], v[28:31], v[144:159]
  v_mfma_f32_32x32x16_bf16 v[160:175], v[24:27], a[44:47], v[160:175]
  v_mfma_f32_32x32x16_bf16 v[176:191], v[28:31], a[44:47], v[176:191]
  buffer_load_dwordx4 a[12:15], v8, s[4:7], s24 offen offset:1024
  buffer_load_dwordx4 a[16:19], v8, s[4:7], s25 offen offset:1024
  buffer_load_dwordx4 a[20:23], v8, s[4:7], s26 offen offset:1024
  s_waitcnt vmcnt(39)
  ds_read_b128 v[24:27], v8 offset:22528
  ds_read_b128 v[28:31], v9 offset:22528
  s_waitcnt lgkmcnt(4)
  v_mfma_f32_32x32x16_bf16 v[96:111], a[48:51], v[32:35], v[96:111]
  v_mfma_f32_32x32x16_bf16 v[112:127], a[48:51], v[36:39], v[112:127]
  v_mfma_f32_32x32x16_bf16 v[128:143], a[52:55], v[32:35], v[128:143]
  v_mfma_f32_32x32x16_bf16 v[144:159], a[52:55], v[36:39], v[144:159]
  v_mfma_f32_32x32x16_bf16 v[160:175], v[32:35], a[56:59], v[160:175]
  v_mfma_f32_32x32x16_bf16 v[176:191], v[36:39], a[56:59], v[176:191]
  buffer_load_dwordx4 a[24:27], v8, s[4:7], s24 offen offset:2048
  buffer_load_dwordx4 a[28:31], v8, s[4:7], s25 offen offset:2048
  buffer_load_dwordx4 a[32:35], v8, s[4:7], s26 offen offset:2048
  s_waitcnt vmcnt(39)
  ds_read_b128 v[32:35], v8 offset:23552
  ds_read_b128 v[36:39], v9 offset:23552
  s_waitcnt lgkmcnt(4)
  v_mfma_f32_32x32x16_bf16 v[96:111], a[60:63], v[16:19], v[96:111]
  v_mfma_f32_32x32x16_bf16 v[112:127], a[60:63], v[20:23], v[112:127]
  v_mfma_f32_32x32x16_bf16 v[128:143], a[64:67], v[16:19], v[128:143]
  v_mfma_f32_32x32x16_bf16 v[144:159], a[64:67], v[20:23], v[144:159]
  v_mfma_f32_32x32x16_bf16 v[160:175], v[16:19], a[68:71], v[160:175]
  v_mfma_f32_32x32x16_bf16 v[176:191], v[20:23], a[68:71], v[176:191]
  buffer_load_dwordx4 a[36:39], v8, s[4:7], s24 offen offset:3072
  buffer_load_dwordx4 a[40:43], v8, s[4:7], s25 offen offset:3072
  buffer_load_dwordx4 a[44:47], v8, s[4:7], s26 offen offset:3072
  s_add_u32 s24, s24, 4096
  s_add_u32 s25, s25, 4096
  s_add_u32 s26, s26, 4096
  s_waitcnt vmcnt(39)
  ds_read_b128 v[16:19], v8 offset:24576
  ds_read_b128 v[20:23], v9 offset:24576
  s_waitcnt lgkmcnt(4)
  v_mfma_f32_32x32x16_bf16 v[96:111], a[72:75], v[24:27], v[96:111]
  v_mfma_f32_32x32x16_bf16 v[112:127], a[72:75], v[28:31], v[112:127]
  v_mfma_f32_32x32x16_bf16 v[128:143], a[76:79], v[24:27], v[128:143]
  v_mfma_f32_32x32x16_bf16 v[144:159], a[76:79], v[28:31], v[144:159]
  v_mfma_f32_32x32x16_bf16 v[160:175], v[24:27], a[80:83], v[160:175]
  v_mfma_f32_32x32x16_bf16 v[176:191], v[28:31], a[80:83], v[176:191]
  buffer_load_dwordx4 a[48:51], v8, s[4:7], s24 offen offset:0
  buffer_load_dwordx4 a[52:55], v8, s[4:7], s25 offen offset:0
  buffer_load_dwordx4 a[56:59], v8, s[4:7], s26 offen offset:0
  s_waitcnt vmcnt(39)
  ds_read_b128 v[24:27], v8 offset:25600
  ds_read_b128 v[28:31], v9 offset:25600
  s_waitcnt lgkmcnt(4)
  v_mfma_f32_32x32x16_bf16 v[96:111], a[84:87], v[32:35], v[96:111]
  v_mfma_f32_32x32x16_bf16 v[112:127], a[84:87], v[36:39], v[112:127]
  v_mfma_f32_32x32x16_bf16 v[128:143], a[88:91], v[32:35], v[128:143]
  v_mfma_f32_32x32x16_bf16 v[144:159], a[88:91], v[36:39], v[144:159]
  v_mfma_f32_32x32x16_bf16 v[160:175], v[32:35], a[92:95], v[160:175]
  v_mfma_f32_32x32x16_bf16 v[176:191], v[36:39], a[92:95], v[176:191]
  buffer_load_dwordx4 a[60:63], v8, s[4:7], s24 offen offset:1024
  buffer_load_dwordx4 a[64:67], v8, s[4:7], s25 offen offset:1024
  buffer_load_dwordx4 a[68:71], v8, s[4:7], s26 offen offset:1024
  s_waitcnt vmcnt(39)
  ds_read_b128 v[32:35], v8 offset:26624
  ds_read_b128 v[36:39], v9 offset:26624
  s_waitcnt lgkmcnt(4)
  v_mfma_f32_32x32x16_bf16 v[96:111], a[96:99], v[16:19], v[96:111]
  v_mfma_f32_32x32x16_bf16 v[112:127], a[96:99], v[20:23], v[112:127]
  v_mfma_f32_32x32x16_bf16 v[128:143], a[100:103], v[16:19], v[128:143]
  v_mfma_f32_32x32x16_bf16 v[144:159], a[100:103], v[20:23], v[144:159]
  v_mfma_f32_32x32x16_bf16 v[160:175], v[16:19], a[104:107], v[160:175]
  v_mfma_f32_32x32x16_bf16 v[176:191], v[20:23], a[104:107], v[176:191]
  buffer_load_dwordx4 a[72:75], v8, s[4:7], s24 offen offset:2048
  buffer_load_dwordx4 a[76:79], v8, s[4:7], s25 offen offset:2048
  buffer_load_dwordx4 a[80:83], v8, s[4:7], s26 offen offset:2048
  s_waitcnt vmcnt(39)
  ds_read_b128 v[16:19], v8 offset:27648
  ds_read_b128 v[20:23], v9 offset:27648
  s_waitcnt lgkmcnt(4)
  v_mfma_f32_32x32x16_bf16 v[96:111], a[108:111], v[24:27], v[96:111]
  v_mfma_f32_32x32x16_bf16 v[112:127], a[108:111], v[28:31], v[112:127]
  v_mfma_f32_32x32x16_bf16 v[128:143], a[112:115], v[24:27], v[128:143]
  v_mfma_f32_32x32x16_bf16 v[144:159], a[112:115], v[28:31], v[144:159]
  v_mfma_f32_32x32x16_bf16 v[160:175], v[24:27], a[116:119], v[160:175]
  v_mfma_f32_32x32x16_bf16 v[176:191], v[28:31], a[116:119], v[176:191]
  buffer_load_dwordx4 a[84:87], v8, s[4:7], s24 offen offset:3072
  buffer_load_dwordx4 a[88:91], v8, s[4:7], s25 offen offset:3072
  buffer_load_dwordx4 a[92:95], v8, s[4:7], s26 offen offset:3072
  s_add_u32 s24, s24, 4096
  s_add_u32 s25, s25, 4096
  s_add_u32 s26, s26, 4096
  s_waitcnt vmcnt(39)
  ds_read_b128 v[24:27], v8 offset:28672
  ds_read_b128 v[28:31], v9 offset:28672
  s_waitcnt lgkmcnt(4)
  v_mfma_f32_32x32x16_bf16 v[96:111], a[120:123], v[32:35], v[96:111]
  v_mfma_f32_32x32x16_bf16 v[112:127], a[120:123], v[36:39], v[112:127]
  v_mfma_f32_32x32x16_bf16 v[128:143], a[124:127], v[32:35], v[128:143]
  v_mfma_f32_32x32x16_bf16 v[144:159], a[124:127], v[36:39], v[144:159]
  v_mfma_f32_32x32x16_bf16 v[160:175], v[32:35], a[128:131], v[160:175]
  v_mfma_f32_32x32x16_bf16 v[176:191], v[36:39], a[128:131], v[176:191]
  s_waitcnt vmcnt(36)
  ds_read_b128 v[32:35], v8 offset:29696
  ds_read_b128 v[36:39], v9 offset:29696
  s_waitcnt lgkmcnt(4)
  v_mfma_f32_32x32x16_bf16 v[96:111], a[132:135], v[16:19], v[96:111]
  v_mfma_f32_32x32x16_bf16 v[112:127], a[132:135], v[20:23], v[112:127]
  v_mfma_f32_32x32x16_bf16 v[128:143], a[136:139], v[16:19], v[128:143]
  v_mfma_f32_32x32x16_bf16 v[144:159], a[136:139], v[20:23], v[144:159]
  v_mfma_f32_32x32x16_bf16 v[160:175], v[16:19], a[140:143], v[160:175]
  v_mfma_f32_32x32x16_bf16 v[176:191], v[20:23], a[140:143], v[176:191]
  s_waitcnt vmcnt(33)
  ds_read_b128 v[16:19], v8 offset:30720
  ds_read_b128 v[20:23], v9 offset:30720
  s_waitcnt lgkmcnt(4)
  v_mfma_f32_32x32x16_bf16 v[96:111], a[144:147], v[24:27], v[96:111]
  v_mfma_f32_32x32x16_bf16 v[112:127], a[144:147], v[28:31], v[112:127]
  v_mfma_f32_32x32x16_bf16 v[128:143], a[148:151], v[24:27], v[128:143]
  v_mfma_f32_32x32x16_bf16 v[144:159], a[148:151], v[28:31], v[144:159]
  v_mfma_f32_32x32x16_bf16 v[160:175], v[24:27], a[152:155], v[160:175]
  v_mfma_f32_32x32x16_bf16 v[176:191], v[28:31], a[152:155], v[176:191]
  s_waitcnt vmcnt(30)
  ds_read_b128 v[24:27], v8 offset:31744
  ds_read_b128 v[28:31], v9 offset:31744
  s_waitcnt lgkmcnt(4)
  v_mfma_f32_32x32x16_bf16 v[96:111], a[156:159], v[32:35], v[96:111]
  v_mfma_f32_32x32x16_bf16 v[112:127], a[156:159], v[36:39], v[112:127]
  v_mfma_f32_32x32x16_bf16 v[128:143], a[160:163], v[32:35], v[128:143]
  v_mfma_f32_32x32x16_bf16 v[144:159], a[160:163], v[36:39], v[144:159]
  v_mfma_f32_32x32x16_bf16 v[160:175], v[32:35], a[164:167], v[160:175]
  v_mfma_f32_32x32x16_bf16 v[176:191], v[36:39], a[164:167], v[176:191]
  s_waitcnt vmcnt(27)
  ds_read_b128 v[32:35], v8 offset:32768
  ds_read_b128 v[36:39], v9 offset:32768
  s_waitcnt lgkmcnt(4)
  v_mfma_f32_32x32x16_bf16 v[96:111], a[168:171], v[16:19], v[96:111]
  v_mfma_f32_32x32x16_bf16 v[112:127], a[168:171], v[20:23], v[112:127]
  v_mfma_f32_32x32x16_bf16 v[128:143], a[172:175], v[16:19], v[128:143]
  v_mfma_f32_32x32x16_bf16 v[144:159], a[172:175], v[20:23], v[144:159]
  v_mfma_f32_32x32x16_bf16 v[160:175], v[16:19], a[176:179], v[160:175]
  v_mfma_f32_32x32x16_bf16 v[176:191], v[20:23], a[176:179], v[176:191]
  s_waitcnt vmcnt(24)
  ds_read_b128 v[16:19], v8 offset:33792
  ds_read_b128 v[20:23], v9 offset:33792
  s_waitcnt lgkmcnt(4)
  v_mfma_f32_32x32x16_bf16 v[96:111], a[180:183], v[24:27], v[96:111]
  v_mfma_f32_32x32x16_bf16 v[112:127], a[180:183], v[28:31], v[112:127]
  v_mfma_f32_32x32x16_bf16 v[128:143], a[184:187], v[24:27], v[128:143]
  v_mfma_f32_32x32x16_bf16 v[144:159], a[184:187], v[28:31], v[144:159]
  v_mfma_f32_32x32x16_bf16 v[160:175], v[24:27], a[188:191], v[160:175]
  v_mfma_f32_32x32x16_bf16 v[176:191], v[28:31], a[188:191], v[176:191]
  s_waitcnt vmcnt(21)
  ds_read_b128 v[24:27], v8 offset:34816
  ds_read_b128 v[28:31], v9 offset:34816
  s_waitcnt lgkmcnt(4)
  v_mfma_f32_32x32x16_bf16 v[96:111], a[0:3], v[32:35], v[96:111]
  v_mfma_f32_32x32x16_bf16 v[112:127], a[0:3], v[36:39], v[112:127]
  v_mfma_f32_32x32x16_bf16 v[128:143], a[4:7], v[32:35], v[128:143]
  v_mfma_f32_32x32x16_bf16 v[144:159], a[4:7], v[36:39], v[144:159]
  v_mfma_f32_32x32x16_bf16 v[160:175], v[32:35], a[8:11], v[160:175]
  v_mfma_f32_32x32x16_bf16 v[176:191], v[36:39], a[8:11], v[176:191]
  s_waitcnt vmcnt(18)
  ds_read_b128 v[32:35], v8 offset:35840
  ds_read_b128 v[36:39], v9 offset:35840
  s_waitcnt lgkmcnt(4)
  v_mfma_f32_32x32x16_bf16 v[96:111], a[12:15], v[16:19], v[96:111]
  v_mfma_f32_32x32x16_bf16 v[112:127], a[12:15], v[20:23], v[112:127]
  v_mfma_f32_32x32x16_bf16 v[128:143], a[16:19], v[16:19], v[128:143]
  v_mfma_f32_32x32x16_bf16 v[144:159], a[16:19], v[20:23], v[144:159]
  v_mfma_f32_32x32x16_bf16 v[160:175], v[16:19], a[20:23], v[160:175]
  v_mfma_f32_32x32x16_bf16 v[176:191], v[20:23], a[20:23], v[176:191]
  s_waitcnt vmcnt(15)
  ds_read_b128 v[16:19], v8 offset:36864
  ds_read_b128 v[20:23], v9 offset:36864
  s_waitcnt lgkmcnt(4)
  v_mfma_f32_32x32x16_bf16 v[96:111], a[24:27], v[24:27], v[96:111]
  v_mfma_f32_32x32x16_bf16 v[112:127], a[24:27], v[28:31], v[112:127]
  v_mfma_f32_32x32x16_bf16 v[128:143], a[28:31], v[24:27], v[128:143]
  v_mfma_f32_32x32x16_bf16 v[144:159], a[28:31], v[28:31], v[144:159]
  v_mfma_f32_32x32x16_bf16 v[160:175], v[24:27], a[32:35], v[160:175]
  v_mfma_f32_32x32x16_bf16 v[176:191], v[28:31], a[32:35], v[176:191]
  s_waitcnt vmcnt(12)
  ds_read_b128 v[24:27], v8 offset:37888
  ds_read_b128 v[28:31], v9 offset:37888
  s_waitcnt lgkmcnt(4)
  v_mfma_f32_32x32x16_bf16 v[96:111], a[36:39], v[32:35], v[96:111]
  v_mfma_f32_32x32x16_bf16 v[112:127], a[36:39], v[36:39], v[112:127]
  v_mfma_f32_32x32x16_bf16 v[128:143], a[40:43], v[32:35], v[128:143]
  v_mfma_f32_32x32x16_bf16 v[144:159], a[40:43], v[36:39], v[144:159]
  v_mfma_f32_32x32x16_bf16 v[160:175], v[32:35], a[44:47], v[160:175]
  v_mfma_f32_32x32x16_bf16 v[176:191], v[36:39], a[44:47], v[176:191]
  s_waitcnt vmcnt(9)
  ds_read_b128 v[32:35], v8 offset:38912
  ds_read_b128 v[36:39], v9 offset:38912
  s_waitcnt lgkmcnt(4)
  v_mfma_f32_32x32x16_bf16 v[96:111], a[48:51], v[16:19], v[96:111]
  v_mfma_f32_32x32x16_bf16 v[112:127], a[48:51], v[20:23], v[112:127]
  v_mfma_f32_32x32x16_bf16 v[128:143], a[52:55], v[16:19], v[128:143]
  v_mfma_f32_32x32x16_bf16 v[144:159], a[52:55], v[20:23], v[144:159]
  v_mfma_f32_32x32x16_bf16 v[160:175], v[16:19], a[56:59], v[160:175]
  v_mfma_f32_32x32x16_bf16 v[176:191], v[20:23], a[56:59], v[176:191]
  s_waitcnt vmcnt(6)
  ds_read_b128 v[16:19], v8 offset:39936
  ds_read_b128 v[20:23], v9 offset:39936
  s_waitcnt lgkmcnt(4)
  v_mfma_f32_32x32x16_bf16 v[96:111], a[60:63], v[24:27], v[96:111]
  v_mfma_f32_32x32x16_bf16 v[112:127], a[60:63], v[28:31], v[112:127]
  v_mfma_f32_32x32x16_bf16 v[128:143], a[64:67], v[24:27], v[128:143]
  v_mfma_f32_32x32x16_bf16 v[144:159], a[64:67], v[28:31], v[144:159]
  v_mfma_f32_32x32x16_bf16 v[160:175], v[24:27], a[68:71], v[160:175]
  v_mfma_f32_32x32x16_bf16 v[176:191], v[28:31], a[68:71], v[176:191]
  s_waitcnt vmcnt(3)
  s_waitcnt lgkmcnt(2)
  v_mfma_f32_32x32x16_bf16 v[96:111], a[72:75], v[32:35], v[96:111]
  v_mfma_f32_32x32x16_bf16 v[112:127], a[72:75], v[36:39], v[112:127]
  v_mfma_f32_32x32x16_bf16 v[128:143], a[76:79], v[32:35], v[128:143]
  v_mfma_f32_32x32x16_bf16 v[144:159], a[76:79], v[36:39], v[144:159]
  v_mfma_f32_32x32x16_bf16 v[160:175], v[32:35], a[80:83], v[160:175]
  v_mfma_f32_32x32x16_bf16 v[176:191], v[36:39], a[80:83], v[176:191]
  s_waitcnt vmcnt(0)
  s_waitcnt lgkmcnt(0)
  v_mfma_f32_32x32x16_bf16 v[96:111], a[84:87], v[16:19], v[96:111]
  v_mfma_f32_32x32x16_bf16 v[112:127], a[84:87], v[20:23], v[112:127]
  v_mfma_f32_32x32x16_bf16 v[128:143], a[88:91], v[16:19], v[128:143]
  v_mfma_f32_32x32x16_bf16 v[144:159], a[88:91], v[20:23], v[144:159]
  v_mfma_f32_32x32x16_bf16 v[160:175], v[16:19], a[92:95], v[160:175]
  v_mfma_f32_32x32x16_bf16 v[176:191], v[20:23], a[92:95], v[176:191]
  s_lshl_b32 s21, s18, 1
  s_lshl_b32 s22, s23, 6
  s_add_u32 s21, s21, s22
  s_lshl_b32 s21, s21, 11
  s_add_u32 s27, s21, 161480704
  s_add_u32 s28, s21, 165675008
  s_add_u32 s29, s21, 169869312
  s_mov_b32 s30, 0x3ea52b5c
  v_and_b32 v2, 31, v0
  v_cmp_eq_u32 s[32:33], 20, v2
  v_mov_b32 v3, 0x3f803f80
  v_mul_f32 v96, s30, v96
  v_mul_f32 v97, s30, v97
  v_mul_f32 v98, s30, v98
  v_mul_f32 v99, s30, v99
  v_mul_f32 v100, s30, v100
  v_mul_f32 v101, s30, v101
  v_mul_f32 v102, s30, v102
  v_mul_f32 v103, s30, v103
  v_mul_f32 v104, s30, v104
  v_mul_f32 v105, s30, v105
  v_mul_f32 v106, s30, v106
  v_mul_f32 v107, s30, v107
  v_mul_f32 v108, s30, v108
  v_mul_f32 v109, s30, v109
  v_mul_f32 v110, s30, v110
  v_mul_f32 v111, s30, v111
  v_cvt_pk_bf16_f32 v16, v96, v97
  v_cvt_pk_bf16_f32 v17, v98, v99
  v_cvt_pk_bf16_f32 v18, v100, v101
  v_cvt_pk_bf16_f32 v19, v102, v103
  v_cvt_pk_bf16_f32 v20, v104, v105
  v_cvt_pk_bf16_f32 v21, v106, v107
  v_cvt_pk_bf16_f32 v22, v108, v109
  v_cvt_pk_bf16_f32 v23, v110, v111
  buffer_store_dwordx4 v[16:19], v8, s[4:7], s27 offen offset:0
  buffer_store_dwordx4 v[20:23], v8, s[4:7], s27 offen offset:1024
  v_mul_f32 v112, s30, v112
  v_mul_f32 v113, s30, v113
  v_mul_f32 v114, s30, v114
  v_mul_f32 v115, s30, v115
  v_mul_f32 v116, s30, v116
  v_mul_f32 v117, s30, v117
  v_mul_f32 v118, s30, v118
  v_mul_f32 v119, s30, v119
  v_mul_f32 v120, s30, v120
  v_mul_f32 v121, s30, v121
  v_mul_f32 v122, s30, v122
  v_mul_f32 v123, s30, v123
  v_mul_f32 v124, s30, v124
  v_mul_f32 v125, s30, v125
  v_mul_f32 v126, s30, v126
  v_mul_f32 v127, s30, v127
  v_cvt_pk_bf16_f32 v24, v112, v113
  v_cvt_pk_bf16_f32 v25, v114, v115
  v_cvt_pk_bf16_f32 v26, v116, v117
  v_cvt_pk_bf16_f32 v27, v118, v119
  v_cvt_pk_bf16_f32 v28, v120, v121
  v_cvt_pk_bf16_f32 v29, v122, v123
  v_cvt_pk_bf16_f32 v30, v124, v125
  v_cvt_pk_bf16_f32 v31, v126, v127
  buffer_store_dwordx4 v[24:27], v8, s[4:7], s27 offen offset:2048
  buffer_store_dwordx4 v[28:31], v8, s[4:7], s27 offen offset:3072
  v_cvt_pk_bf16_f32 v16, v128, v129
  v_cvt_pk_bf16_f32 v17, v130, v131
  v_cvt_pk_bf16_f32 v18, v132, v133
  v_cvt_pk_bf16_f32 v19, v134, v135
  v_cvt_pk_bf16_f32 v20, v136, v137
  v_cvt_pk_bf16_f32 v21, v138, v139
  v_cvt_pk_bf16_f32 v22, v140, v141
  v_cvt_pk_bf16_f32 v23, v142, v143
  buffer_store_dwordx4 v[16:19], v8, s[4:7], s28 offen offset:0
  buffer_store_dwordx4 v[20:23], v8, s[4:7], s28 offen offset:1024
  v_cvt_pk_bf16_f32 v24, v144, v145
  v_cvt_pk_bf16_f32 v25, v146, v147
  v_cvt_pk_bf16_f32 v26, v148, v149
  v_cvt_pk_bf16_f32 v27, v150, v151
  v_cvt_pk_bf16_f32 v28, v152, v153
  v_cvt_pk_bf16_f32 v29, v154, v155
  v_cvt_pk_bf16_f32 v30, v156, v157
  v_cvt_pk_bf16_f32 v31, v158, v159
  buffer_store_dwordx4 v[24:27], v8, s[4:7], s28 offen offset:2048
  buffer_store_dwordx4 v[28:31], v8, s[4:7], s28 offen offset:3072
  v_cvt_pk_bf16_f32 v16, v160, v161
  v_cvt_pk_bf16_f32 v17, v162, v163
  v_cvt_pk_bf16_f32 v18, v164, v165
  v_cvt_pk_bf16_f32 v19, v166, v167
  v_cvt_pk_bf16_f32 v20, v168, v169
  v_cvt_pk_bf16_f32 v21, v170, v171
  v_cvt_pk_bf16_f32 v22, v172, v173
  v_cvt_pk_bf16_f32 v23, v174, v175
  v_cndmask_b32 v16, v16, v3, s[32:33]
  v_cndmask_b32 v17, v17, v3, s[32:33]
  v_cndmask_b32 v18, v18, v3, s[32:33]
  v_cndmask_b32 v19, v19, v3, s[32:33]
  v_cndmask_b32 v20, v20, v3, s[32:33]
  v_cndmask_b32 v21, v21, v3, s[32:33]
  v_cndmask_b32 v22, v22, v3, s[32:33]
  v_cndmask_b32 v23, v23, v3, s[32:33]
  buffer_store_dwordx4 v[16:19], v8, s[4:7], s29 offen offset:0
  buffer_store_dwordx4 v[20:23], v8, s[4:7], s29 offen offset:1024
  v_cvt_pk_bf16_f32 v24, v176, v177
  v_cvt_pk_bf16_f32 v25, v178, v179
  v_cvt_pk_bf16_f32 v26, v180, v181
  v_cvt_pk_bf16_f32 v27, v182, v183
  v_cvt_pk_bf16_f32 v28, v184, v185
  v_cvt_pk_bf16_f32 v29, v186, v187
  v_cvt_pk_bf16_f32 v30, v188, v189
  v_cvt_pk_bf16_f32 v31, v190, v191
  v_cndmask_b32 v24, v24, v3, s[32:33]
  v_cndmask_b32 v25, v25, v3, s[32:33]
  v_cndmask_b32 v26, v26, v3, s[32:33]
  v_cndmask_b32 v27, v27, v3, s[32:33]
  v_cndmask_b32 v28, v28, v3, s[32:33]
  v_cndmask_b32 v29, v29, v3, s[32:33]
  v_cndmask_b32 v30, v30, v3, s[32:33]
  v_cndmask_b32 v31, v31, v3, s[32:33]
  buffer_store_dwordx4 v[24:27], v8, s[4:7], s29 offen offset:2048
  buffer_store_dwordx4 v[28:31], v8, s[4:7], s29 offen offset:3072
  s_waitcnt vmcnt(0)
qkvb_exit1:
  s_endpgm
.globl attnb_kernel
.p2align 8
.type attnb_kernel,@function
attnb_kernel:
  s_cmp_ge_u32 s2, 256
  s_cbranch_scc1 attnb_exit1
  s_load_dwordx2 s[12:13], s[0:1], 96
  v_lshrrev_b32 v2, 6, v0
  v_and_b32 v3, 63, v0
  s_nop 0
  v_readfirstlane_b32 s16, v2
  v_lshlrev_b32 v1, 4, v3
  s_and_b32 s17, s2, 7
  s_lshl_b32 s17, s17, 2
  s_lshr_b32 s18, s2, 3
  s_and_b32 s19, s18, 3
  s_add_u32 s17, s17, s19
  s_lshr_b32 s18, s18, 2
  s_waitcnt lgkmcnt(0)
  s_mov_b32 s4, s12
  s_mov_b32 s5, s13
  s_mov_b32 s6, 0x10000000
  s_mov_b32 s7, 0x20000
  s_lshl_b32 s20, s17, 17
  s_add_u32 s21, s20, 165675008
  s_add_u32 s22, s20, 169869312
  s_lshl_b32 s23, s18, 3
  s_lshl_b32 s24, s16, 1
  s_add_u32 s23, s23, s24
  s_lshl_b32 s24, s23, 11
  s_add_u32 s24, s24, s20
  s_add_u32 s24, s24, 161480704
  buffer_load_dwordx4 v[8:11], v1, s[4:7], s24 offen offset:0
  buffer_load_dwordx4 v[12:15], v1, s[4:7], s24 offen offset:1024
  buffer_load_dwordx4 v[16:19], v1, s[4:7], s24 offen offset:2048
  buffer_load_dwordx4 v[20:23], v1, s[4:7], s24 offen offset:3072
  s_mov_b32 s25, s21
  s_mov_b32 s26, s22
  buffer_load_dwordx4 v[136:139], v1, s[4:7], s25 offen
  buffer_load_dwordx4 v[140:143], v1, s[4:7], s25 offen offset:1024
  buffer_load_dwordx4 v[144:147], v1, s[4:7], s26 offen
  buffer_load_dwordx4 v[148:151], v1, s[4:7], s26 offen offset:1024
  s_add_u32 s25, s25, 2048
  s_add_u32 s26, s26, 2048
  s_waitcnt vmcnt(0)
  v_mfma_f32_32x32x16_bf16 v[88:103], v[136:139], v[8:11], 0
  v_mfma_f32_32x32x16_bf16 v[88:103], v[140:143], v[12:15], v[88:103]
  v_mfma_f32_32x32x16_bf16 v[104:119], v[136:139], v[16:19], 0
  v_mfma_f32_32x32x16_bf16 v[104:119], v[140:143], v[20:23], v[104:119]
  s_nop 9
  v_max3_f32 v2, v88, v89, v90
  v_max3_f32 v2, v2, v91, v92
  v_max3_f32 v2, v2, v93, v94
  v_max3_f32 v2, v2, v95, v96
  v_max3_f32 v2, v2, v97, v98
  v_max3_f32 v2, v2, v99, v100
  v_max3_f32 v2, v2, v101, v102
  v_max_f32 v2, v2, v103
  v_mov_b32 v4, v2
  s_nop 1
  v_permlane32_swap_b32 v2, v4
  v_max_f32 v2, v2, v4
  v_sub_f32 v24, 0, v2
  v_sub_f32 v25, 0, v2
  v_sub_f32 v26, 0, v2
  v_sub_f32 v27, 0, v2
  v_sub_f32 v28, 0, v2
  v_sub_f32 v29, 0, v2
  v_sub_f32 v30, 0, v2
  v_sub_f32 v31, 0, v2
  v_sub_f32 v32, 0, v2
  v_sub_f32 v33, 0, v2
  v_sub_f32 v34, 0, v2
  v_sub_f32 v35, 0, v2
  v_sub_f32 v36, 0, v2
  v_sub_f32 v37, 0, v2
  v_sub_f32 v38, 0, v2
  v_sub_f32 v39, 0, v2
  v_max3_f32 v3, v104, v105, v106
  v_max3_f32 v3, v3, v107, v108
  v_max3_f32 v3, v3, v109, v110
  v_max3_f32 v3, v3, v111, v112
  v_max3_f32 v3, v3, v113, v114
  v_max3_f32 v3, v3, v115, v116
  v_max3_f32 v3, v3, v117, v118
  v_max_f32 v3, v3, v119
  v_mov_b32 v4, v3
  s_nop 1
  v_permlane32_swap_b32 v3, v4
  v_max_f32 v3, v3, v4
  v_sub_f32 v40, 0, v3
  v_sub_f32 v41, 0, v3
  v_sub_f32 v42, 0, v3
  v_sub_f32 v43, 0, v3
  v_sub_f32 v44, 0, v3
  v_sub_f32 v45, 0, v3
  v_sub_f32 v46, 0, v3
  v_sub_f32 v47, 0, v3
  v_sub_f32 v48, 0, v3
  v_sub_f32 v49, 0, v3
  v_sub_f32 v50, 0, v3
  v_sub_f32 v51, 0, v3
  v_sub_f32 v52, 0, v3
  v_sub_f32 v53, 0, v3
  v_sub_f32 v54, 0, v3
  v_sub_f32 v55, 0, v3
  s_mov_b32 s28, 0
attnb_main2:
  s_mov_b32 s25, s21
  s_mov_b32 s26, s22
  buffer_load_dwordx4 v[136:139], v1, s[4:7], s25 offen
  buffer_load_dwordx4 v[140:143], v1, s[4:7], s25 offen offset:1024
  buffer_load_dwordx4 v[144:147], v1, s[4:7], s26 offen
  buffer_load_dwordx4 v[148:151], v1, s[4:7], s26 offen offset:1024
  s_add_u32 s25, s25, 2048
  s_add_u32 s26, s26, 2048
  buffer_load_dwordx4 v[152:155], v1, s[4:7], s25 offen
  buffer_load_dwordx4 v[156:159], v1, s[4:7], s25 offen offset:1024
  buffer_load_dwordx4 v[160:163], v1, s[4:7], s26 offen
  buffer_load_dwordx4 v[164:167], v1, s[4:7], s26 offen offset:1024
  s_add_u32 s25, s25, 2048
  s_add_u32 s26, s26, 2048
  v_mov_b32 v56, 0
  v_mov_b32 v57, 0
  v_mov_b32 v58, 0
  v_mov_b32 v59, 0
  v_mov_b32 v60, 0
  v_mov_b32 v61, 0
  v_mov_b32 v62, 0
  v_mov_b32 v63, 0
  v_mov_b32 v64, 0
  v_mov_b32 v65, 0
  v_mov_b32 v66, 0
  v_mov_b32 v67, 0
  v_mov_b32 v68, 0
  v_mov_b32 v69, 0
  v_mov_b32 v70, 0
  v_mov_b32 v71, 0
  v_mov_b32 v72, 0
  v_mov_b32 v73, 0
  v_mov_b32 v74, 0
  v_mov_b32 v75, 0
  v_mov_b32 v76, 0
  v_mov_b32 v77, 0
  v_mov_b32 v78, 0
  v_mov_b32 v79, 0
  v_mov_b32 v80, 0
  v_mov_b32 v81, 0
  v_mov_b32 v82, 0
  v_mov_b32 v83, 0
  v_mov_b32 v84, 0
  v_mov_b32 v85, 0
  v_mov_b32 v86, 0
  v_mov_b32 v87, 0
  s_waitcnt vmcnt(4)
  v_mfma_f32_32x32x16_bf16 v[88:103], v[136:139], v[8:11], v[24:39]
  v_mfma_f32_32x32x16_bf16 v[88:103], v[140:143], v[12:15], v[88:103]
  s_nop 11
  v_exp_f32 v88, v88
  v_exp_f32 v89, v89
  v_exp_f32 v90, v90
  v_exp_f32 v91, v91
  v_exp_f32 v92, v92
  v_exp_f32 v93, v93
  v_exp_f32 v94, v94
  v_exp_f32 v95, v95
  v_mfma_f32_32x32x16_bf16 v[104:119], v[136:139], v[16:19], v[40:55]
  v_cvt_pk_bf16_f32 v120, v88, v89
  v_cvt_pk_bf16_f32 v121, v90, v91
  v_cvt_pk_bf16_f32 v122, v92, v93
  v_cvt_pk_bf16_f32 v123, v94, v95
  v_exp_f32 v96, v96
  v_exp_f32 v97, v97
  v_mfma_f32_32x32x16_bf16 v[104:119], v[140:143], v[20:23], v[104:119]
  v_exp_f32 v98, v98
  v_exp_f32 v99, v99
  v_exp_f32 v100, v100
  v_exp_f32 v101, v101
  v_mfma_f32_32x32x16_bf16 v[56:71], v[144:147], v[120:123], v[56:71]
  v_exp_f32 v102, v102
  v_exp_f32 v103, v103
  v_cvt_pk_bf16_f32 v124, v96, v97
  v_cvt_pk_bf16_f32 v125, v98, v99
  v_cvt_pk_bf16_f32 v126, v100, v101
  v_cvt_pk_bf16_f32 v127, v102, v103
  buffer_load_dwordx4 v[168:171], v1, s[4:7], s25 offen
  buffer_load_dwordx4 v[172:175], v1, s[4:7], s25 offen offset:1024
  buffer_load_dwordx4 v[176:179], v1, s[4:7], s26 offen
  buffer_load_dwordx4 v[180:183], v1, s[4:7], s26 offen offset:1024
  s_add_u32 s25, s25, 2048
  s_add_u32 s26, s26, 2048
  s_waitcnt vmcnt(4)
  v_exp_f32 v104, v104
  v_exp_f32 v105, v105
  v_exp_f32 v106, v106
  v_exp_f32 v107, v107
  v_mfma_f32_32x32x16_bf16 v[56:71], v[148:151], v[124:127], v[56:71]
  v_exp_f32 v108, v108
  v_exp_f32 v109, v109
  v_exp_f32 v110, v110
  v_exp_f32 v111, v111
  v_mfma_f32_32x32x16_bf16 v[88:103], v[152:155], v[8:11], v[24:39]
  v_cvt_pk_bf16_f32 v128, v104, v105
  v_cvt_pk_bf16_f32 v129, v106, v107
  v_cvt_pk_bf16_f32 v130, v108, v109
  v_cvt_pk_bf16_f32 v131, v110, v111
  v_exp_f32 v112, v112
  v_exp_f32 v113, v113
  v_mfma_f32_32x32x16_bf16 v[88:103], v[156:159], v[12:15], v[88:103]
  v_exp_f32 v114, v114
  v_exp_f32 v115, v115
  v_exp_f32 v116, v116
  v_exp_f32 v117, v117
  v_mfma_f32_32x32x16_bf16 v[72:87], v[144:147], v[128:131], v[72:87]
  v_exp_f32 v118, v118
  v_exp_f32 v119, v119
  v_cvt_pk_bf16_f32 v132, v112, v113
  v_cvt_pk_bf16_f32 v133, v114, v115
  v_cvt_pk_bf16_f32 v134, v116, v117
  v_cvt_pk_bf16_f32 v135, v118, v119
  s_mov_b32 s27, 0
attnb_loop3:
  v_exp_f32 v88, v88
  v_exp_f32 v89, v89
  v_exp_f32 v90, v90
  v_exp_f32 v91, v91
  v_mfma_f32_32x32x16_bf16 v[72:87], v[148:151], v[132:135], v[72:87]
  v_exp_f32 v92, v92
  v_exp_f32 v93, v93
  v_exp_f32 v94, v94
  v_exp_f32 v95, v95
  v_mfma_f32_32x32x16_bf16 v[104:119], v[152:155], v[16:19], v[40:55]
  v_cvt_pk_bf16_f32 v120, v88, v89
  v_cvt_pk_bf16_f32 v121, v90, v91
  v_cvt_pk_bf16_f32 v122, v92, v93
  v_cvt_pk_bf16_f32 v123, v94, v95
  v_exp_f32 v96, v96
  v_exp_f32 v97, v97
  v_mfma_f32_32x32x16_bf16 v[104:119], v[156:159], v[20:23], v[104:119]
  v_exp_f32 v98, v98
  v_exp_f32 v99, v99
  v_exp_f32 v100, v100
  v_exp_f32 v101, v101
  v_mfma_f32_32x32x16_bf16 v[56:71], v[160:163], v[120:123], v[56:71]
  v_exp_f32 v102, v102
  v_exp_f32 v103, v103
  v_cvt_pk_bf16_f32 v124, v96, v97
  v_cvt_pk_bf16_f32 v125, v98, v99
  v_cvt_pk_bf16_f32 v126, v100, v101
  v_cvt_pk_bf16_f32 v127, v102, v103
  buffer_load_dwordx4 v[136:139], v1, s[4:7], s25 offen
  buffer_load_dwordx4 v[140:143], v1, s[4:7], s25 offen offset:1024
  buffer_load_dwordx4 v[144:147], v1, s[4:7], s26 offen
  buffer_load_dwordx4 v[148:151], v1, s[4:7], s26 offen offset:1024
  s_add_u32 s25, s25, 2048
  s_add_u32 s26, s26, 2048
  s_waitcnt vmcnt(4)
  v_exp_f32 v104, v104
  v_exp_f32 v105, v105
  v_exp_f32 v106, v106
  v_exp_f32 v107, v107
  v_mfma_f32_32x32x16_bf16 v[56:71], v[164:167], v[124:127], v[56:71]
  v_exp_f32 v108, v108
  v_exp_f32 v109, v109
  v_exp_f32 v110, v110
  v_exp_f32 v111, v111
  v_mfma_f32_32x32x16_bf16 v[88:103], v[168:171], v[8:11], v[24:39]
  v_cvt_pk_bf16_f32 v128, v104, v105
  v_cvt_pk_bf16_f32 v129, v106, v107
  v_cvt_pk_bf16_f32 v130, v108, v109
  v_cvt_pk_bf16_f32 v131, v110, v111
  v_exp_f32 v112, v112
  v_exp_f32 v113, v113
  v_mfma_f32_32x32x16_bf16 v[88:103], v[172:175], v[12:15], v[88:103]
  v_exp_f32 v114, v114
  v_exp_f32 v115, v115
  v_exp_f32 v116, v116
  v_exp_f32 v117, v117
  v_mfma_f32_32x32x16_bf16 v[72:87], v[160:163], v[128:131], v[72:87]
  v_exp_f32 v118, v118
  v_exp_f32 v119, v119
  v_cvt_pk_bf16_f32 v132, v112, v113
  v_cvt_pk_bf16_f32 v133, v114, v115
  v_cvt_pk_bf16_f32 v134, v116, v117
  v_cvt_pk_bf16_f32 v135, v118, v119
  s_nop 0
  v_exp_f32 v88, v88
  v_exp_f32 v89, v89
  v_exp_f32 v90, v90
  v_exp_f32 v91, v91
  v_mfma_f32_32x32x16_bf16 v[72:87], v[164:167], v[132:135], v[72:87]
  v_exp_f32 v92, v92
  v_exp_f32 v93, v93
  v_exp_f32 v94, v94
  v_exp_f32 v95, v95
  v_mfma_f32_32x32x16_bf16 v[104:119], v[168:171], v[16:19], v[40:55]
  v_cvt_pk_bf16_f32 v120, v88, v89
  v_cvt_pk_bf16_f32 v121, v90, v91
  v_cvt_pk_bf16_f32 v122, v92, v93
  v_cvt_pk_bf16_f32 v123, v94, v95
  v_exp_f32 v96, v96
  v_exp_f32 v97, v97
  v_mfma_f32_32x32x16_bf16 v[104:119], v[172:175], v[20:23], v[104:119]
  v_exp_f32 v98, v98
  v_exp_f32 v99, v99
  v_exp_f32 v100, v100
  v_exp_f32 v101, v101
  v_mfma_f32_32x32x16_bf16 v[56:71], v[176:179], v[120:123], v[56:71]
  v_exp_f32 v102, v102
  v_exp_f32 v103, v103
  v_cvt_pk_bf16_f32 v124, v96, v97
  v_cvt_pk_bf16_f32 v125, v98, v99
  v_cvt_pk_bf16_f32 v126, v100, v101
  v_cvt_pk_bf16_f32 v127, v102, v103
  buffer_load_dwordx4 v[152:155], v1, s[4:7], s25 offen
  buffer_load_dwordx4 v[156:159], v1, s[4:7], s25 offen offset:1024
  buffer_load_dwordx4 v[160:163], v1, s[4:7], s26 offen
  buffer_load_dwordx4 v[164:167], v1, s[4:7], s26 offen offset:1024
  s_add_u32 s25, s25, 2048
  s_add_u32 s26, s26, 2048
  s_waitcnt vmcnt(4)
  v_exp_f32 v104, v104
  v_exp_f32 v105, v105
  v_exp_f32 v106, v106
  v_exp_f32 v107, v107
  v_mfma_f32_32x32x16_bf16 v[56:71], v[180:183], v[124:127], v[56:71]
  v_exp_f32 v108, v108
  v_exp_f32 v109, v109
  v_exp_f32 v110, v110
  v_exp_f32 v111, v111
  v_mfma_f32_32x32x16_bf16 v[88:103], v[136:139], v[8:11], v[24:39]
  v_cvt_pk_bf16_f32 v128, v104, v105
  v_cvt_pk_bf16_f32 v129, v106, v107
  v_cvt_pk_bf16_f32 v130, v108, v109
  v_cvt_pk_bf16_f32 v131, v110, v111
  v_exp_f32 v112, v112
  v_exp_f32 v113, v113
  v_mfma_f32_32x32x16_bf16 v[88:103], v[140:143], v[12:15], v[88:103]
  v_exp_f32 v114, v114
  v_exp_f32 v115, v115
  v_exp_f32 v116, v116
  v_exp_f32 v117, v117
  v_mfma_f32_32x32x16_bf16 v[72:87], v[176:179], v[128:131], v[72:87]
  v_exp_f32 v118, v118
  v_exp_f32 v119, v119
  v_cvt_pk_bf16_f32 v132, v112, v113
  v_cvt_pk_bf16_f32 v133, v114, v115
  v_cvt_pk_bf16_f32 v134, v116, v117
  v_cvt_pk_bf16_f32 v135, v118, v119
  s_nop 0
  v_exp_f32 v88, v88
  v_exp_f32 v89, v89
  v_exp_f32 v90, v90
  v_exp_f32 v91, v91
  v_mfma_f32_32x32x16_bf16 v[72:87], v[180:183], v[132:135], v[72:87]
  v_exp_f32 v92, v92
  v_exp_f32 v93, v93
  v_exp_f32 v94, v94
  v_exp_f32 v95, v95
  v_mfma_f32_32x32x16_bf16 v[104:119], v[136:139], v[16:19], v[40:55]
  v_cvt_pk_bf16_f32 v120, v88, v89
  v_cvt_pk_bf16_f32 v121, v90, v91
  v_cvt_pk_bf16_f32 v122, v92, v93
  v_cvt_pk_bf16_f32 v123, v94, v95
  v_exp_f32 v96, v96
  v_exp_f32 v97, v97
  v_mfma_f32_32x32x16_bf16 v[104:119], v[140:143], v[20:23], v[104:119]
  v_exp_f32 v98, v98
  v_exp_f32 v99, v99
  v_exp_f32 v100, v100
  v_exp_f32 v101, v101
  v_mfma_f32_32x32x16_bf16 v[56:71], v[144:147], v[120:123], v[56:71]
  v_exp_f32 v102, v102
  v_exp_f32 v103, v103
  v_cvt_pk_bf16_f32 v124, v96, v97
  v_cvt_pk_bf16_f32 v125, v98, v99
  v_cvt_pk_bf16_f32 v126, v100, v101
  v_cvt_pk_bf16_f32 v127, v102, v103
  buffer_load_dwordx4 v[168:171], v1, s[4:7], s25 offen
  buffer_load_dwordx4 v[172:175], v1, s[4:7], s25 offen offset:1024
  buffer_load_dwordx4 v[176:179], v1, s[4:7], s26 offen
  buffer_load_dwordx4 v[180:183], v1, s[4:7], s26 offen offset:1024
  s_add_u32 s25, s25, 2048
  s_add_u32 s26, s26, 2048
  s_waitcnt vmcnt(4)
  v_exp_f32 v104, v104
  v_exp_f32 v105, v105
  v_exp_f32 v106, v106
  v_exp_f32 v107, v107
  v_mfma_f32_32x32x16_bf16 v[56:71], v[148:151], v[124:127], v[56:71]
  v_exp_f32 v108, v108
  v_exp_f32 v109, v109
  v_exp_f32 v110, v110
  v_exp_f32 v111, v111
  v_mfma_f32_32x32x16_bf16 v[88:103], v[152:155], v[8:11], v[24:39]
  v_cvt_pk_bf16_f32 v128, v104, v105
  v_cvt_pk_bf16_f32 v129, v106, v107
  v_cvt_pk_bf16_f32 v130, v108, v109
  v_cvt_pk_bf16_f32 v131, v110, v111
  v_exp_f32 v112, v112
  v_exp_f32 v113, v113
  v_mfma_f32_32x32x16_bf16 v[88:103], v[156:159], v[12:15], v[88:103]
  v_exp_f32 v114, v114
  v_exp_f32 v115, v115
  v_exp_f32 v116, v116
  v_exp_f32 v117, v117
  v_mfma_f32_32x32x16_bf16 v[72:87], v[144:147], v[128:131], v[72:87]
  v_exp_f32 v118, v118
  v_exp_f32 v119, v119
  v_cvt_pk_bf16_f32 v132, v112, v113
  v_cvt_pk_bf16_f32 v133, v114, v115
  v_cvt_pk_bf16_f32 v134, v116, v117
  v_cvt_pk_bf16_f32 v135, v118, v119
  s_add_u32 s27, s27, 1
  s_cmp_lt_u32 s27, 20
  s_cbranch_scc1 attnb_loop3
  v_exp_f32 v88, v88
  v_exp_f32 v89, v89
  v_exp_f32 v90, v90
  v_exp_f32 v91, v91
  v_mfma_f32_32x32x16_bf16 v[72:87], v[148:151], v[132:135], v[72:87]
  v_exp_f32 v92, v92
  v_exp_f32 v93, v93
  v_exp_f32 v94, v94
  v_exp_f32 v95, v95
  v_mfma_f32_32x32x16_bf16 v[104:119], v[152:155], v[16:19], v[40:55]
  v_cvt_pk_bf16_f32 v120, v88, v89
  v_cvt_pk_bf16_f32 v121, v90, v91
  v_cvt_pk_bf16_f32 v122, v92, v93
  v_cvt_pk_bf16_f32 v123, v94, v95
  v_exp_f32 v96, v96
  v_exp_f32 v97, v97
  v_mfma_f32_32x32x16_bf16 v[104:119], v[156:159], v[20:23], v[104:119]
  v_exp_f32 v98, v98
  v_exp_f32 v99, v99
  v_exp_f32 v100, v100
  v_exp_f32 v101, v101
  v_mfma_f32_32x32x16_bf16 v[56:71], v[160:163], v[120:123], v[56:71]
  v_exp_f32 v102, v102
  v_exp_f32 v103, v103
  v_cvt_pk_bf16_f32 v124, v96, v97
  v_cvt_pk_bf16_f32 v125, v98, v99
  v_cvt_pk_bf16_f32 v126, v100, v101
  v_cvt_pk_bf16_f32 v127, v102, v103
  buffer_load_dwordx4 v[136:139], v1, s[4:7], s25 offen
  buffer_load_dwordx4 v[140:143], v1, s[4:7], s25 offen offset:1024
  buffer_load_dwordx4 v[144:147], v1, s[4:7], s26 offen
  buffer_load_dwordx4 v[148:151], v1, s[4:7], s26 offen offset:1024
  s_add_u32 s25, s25, 2048
  s_add_u32 s26, s26, 2048
  s_waitcnt vmcnt(4)
  v_exp_f32 v104, v104
  v_exp_f32 v105, v105
  v_exp_f32 v106, v106
  v_exp_f32 v107, v107
  v_mfma_f32_32x32x16_bf16 v[56:71], v[164:167], v[124:127], v[56:71]
  v_exp_f32 v108, v108
  v_exp_f32 v109, v109
  v_exp_f32 v110, v110
  v_exp_f32 v111, v111
  v_mfma_f32_32x32x16_bf16 v[88:103], v[168:171], v[8:11], v[24:39]
  v_cvt_pk_bf16_f32 v128, v104, v105
  v_cvt_pk_bf16_f32 v129, v106, v107
  v_cvt_pk_bf16_f32 v130, v108, v109
  v_cvt_pk_bf16_f32 v131, v110, v111
  v_exp_f32 v112, v112
  v_exp_f32 v113, v113
  v_mfma_f32_32x32x16_bf16 v[88:103], v[172:175], v[12:15], v[88:103]
  v_exp_f32 v114, v114
  v_exp_f32 v115, v115
  v_exp_f32 v116, v116
  v_exp_f32 v117, v117
  v_mfma_f32_32x32x16_bf16 v[72:87], v[160:163], v[128:131], v[72:87]
  v_exp_f32 v118, v118
  v_exp_f32 v119, v119
  v_cvt_pk_bf16_f32 v132, v112, v113
  v_cvt_pk_bf16_f32 v133, v114, v115
  v_cvt_pk_bf16_f32 v134, v116, v117
  v_cvt_pk_bf16_f32 v135, v118, v119
  s_nop 0
  v_exp_f32 v88, v88
  v_exp_f32 v89, v89
  v_exp_f32 v90, v90
  v_exp_f32 v91, v91
  v_mfma_f32_32x32x16_bf16 v[72:87], v[164:167], v[132:135], v[72:87]
  v_exp_f32 v92, v92
  v_exp_f32 v93, v93
  v_exp_f32 v94, v94
  v_exp_f32 v95, v95
  v_mfma_f32_32x32x16_bf16 v[104:119], v[168:171], v[16:19], v[40:55]
  v_cvt_pk_bf16_f32 v120, v88, v89
  v_cvt_pk_bf16_f32 v121, v90, v91
  v_cvt_pk_bf16_f32 v122, v92, v93
  v_cvt_pk_bf16_f32 v123, v94, v95
  v_exp_f32 v96, v96
  v_exp_f32 v97, v97
  v_mfma_f32_32x32x16_bf16 v[104:119], v[172:175], v[20:23], v[104:119]
  v_exp_f32 v98, v98
  v_exp_f32 v99, v99
  v_exp_f32 v100, v100
  v_exp_f32 v101, v101
  v_mfma_f32_32x32x16_bf16 v[56:71], v[176:179], v[120:123], v[56:71]
  v_exp_f32 v102, v102
  v_exp_f32 v103, v103
  v_cvt_pk_bf16_f32 v124, v96, v97
  v_cvt_pk_bf16_f32 v125, v98, v99
  v_cvt_pk_bf16_f32 v126, v100, v101
  v_cvt_pk_bf16_f32 v127, v102, v103
  s_waitcnt vmcnt(0)
  v_exp_f32 v104, v104
  v_exp_f32 v105, v105
  v_exp_f32 v106, v106
  v_exp_f32 v107, v107
  v_mfma_f32_32x32x16_bf16 v[56:71], v[180:183], v[124:127], v[56:71]
  v_exp_f32 v108, v108
  v_exp_f32 v109, v109
  v_exp_f32 v110, v110
  v_exp_f32 v111, v111
  v_mfma_f32_32x32x16_bf16 v[88:103], v[136:139], v[8:11], v[24:39]
  v_cvt_pk_bf16_f32 v128, v104, v105
  v_cvt_pk_bf16_f32 v129, v106, v107
  v_cvt_pk_bf16_f32 v130, v108, v109
  v_cvt_pk_bf16_f32 v131, v110, v111
  v_exp_f32 v112, v112
  v_exp_f32 v113, v113
  v_mfma_f32_32x32x16_bf16 v[88:103], v[140:143], v[12:15], v[88:103]
  v_exp_f32 v114, v114
  v_exp_f32 v115, v115
  v_exp_f32 v116, v116
  v_exp_f32 v117, v117
  v_mfma_f32_32x32x16_bf16 v[72:87], v[176:179], v[128:131], v[72:87]
  v_exp_f32 v118, v118
  v_exp_f32 v119, v119
  v_cvt_pk_bf16_f32 v132, v112, v113
  v_cvt_pk_bf16_f32 v133, v114, v115
  v_cvt_pk_bf16_f32 v134, v116, v117
  v_cvt_pk_bf16_f32 v135, v118, v119
  s_nop 0
  v_exp_f32 v88, v88
  v_exp_f32 v89, v89
  v_exp_f32 v90, v90
  v_exp_f32 v91, v91
  v_mfma_f32_32x32x16_bf16 v[72:87], v[180:183], v[132:135], v[72:87]
  v_exp_f32 v92, v92
  v_exp_f32 v93, v93
  v_exp_f32 v94, v94
  v_exp_f32 v95, v95
  v_mfma_f32_32x32x16_bf16 v[104:119], v[136:139], v[16:19], v[40:55]
  v_cvt_pk_bf16_f32 v120, v88, v89
  v_cvt_pk_bf16_f32 v121, v90, v91
  v_cvt_pk_bf16_f32 v122, v92, v93
  v_cvt_pk_bf16_f32 v123, v94, v95
  v_exp_f32 v96, v96
  v_exp_f32 v97, v97
  v_mfma_f32_32x32x16_bf16 v[104:119], v[140:143], v[20:23], v[104:119]
  v_exp_f32 v98, v98
  v_exp_f32 v99, v99
  v_exp_f32 v100, v100
  v_exp_f32 v101, v101
  v_mfma_f32_32x32x16_bf16 v[56:71], v[144:147], v[120:123], v[56:71]
  v_exp_f32 v102, v102
  v_exp_f32 v103, v103
  v_cvt_pk_bf16_f32 v124, v96, v97
  v_cvt_pk_bf16_f32 v125, v98, v99
  v_cvt_pk_bf16_f32 v126, v100, v101
  v_cvt_pk_bf16_f32 v127, v102, v103
  s_nop 0
  v_exp_f32 v104, v104
  v_exp_f32 v105, v105
  v_exp_f32 v106, v106
  v_exp_f32 v107, v107
  v_mfma_f32_32x32x16_bf16 v[56:71], v[148:151], v[124:127], v[56:71]
  v_exp_f32 v108, v108
  v_exp_f32 v109, v109
  v_exp_f32 v110, v110
  v_exp_f32 v111, v111
  v_cvt_pk_bf16_f32 v128, v104, v105
  v_cvt_pk_bf16_f32 v129, v106, v107
  v_cvt_pk_bf16_f32 v130, v108, v109
  v_cvt_pk_bf16_f32 v131, v110, v111
  v_exp_f32 v112, v112
  v_exp_f32 v113, v113
  v_exp_f32 v114, v114
  v_exp_f32 v115, v115
  v_exp_f32 v116, v116
  v_exp_f32 v117, v117
  v_mfma_f32_32x32x16_bf16 v[72:87], v[144:147], v[128:131], v[72:87]
  v_exp_f32 v118, v118
  v_exp_f32 v119, v119
  v_cvt_pk_bf16_f32 v132, v112, v113
  v_cvt_pk_bf16_f32 v133, v114, v115
  v_cvt_pk_bf16_f32 v134, v116, v117
  v_cvt_pk_bf16_f32 v135, v118, v119
  s_nop 1
  v_mfma_f32_32x32x16_bf16 v[72:87], v[148:151], v[132:135], v[72:87]
  v_mov_b32 v2, v64
  v_mov_b32 v4, v2
  s_nop 1
  v_permlane32_swap_b32 v4, v2
  s_nop 6
  v_mov_b32 v3, v80
  v_mov_b32 v4, v3
  s_nop 1
  v_permlane32_swap_b32 v4, v3
  s_cmp_eq_u32 s28, 1
  s_cbranch_scc1 attnb_done5
  v_max_f32 v4, v2, v3
  v_cmp_nge_f32 vcc, 0x4e800000, v4
  v_cmp_u_f32 s[30:31], v2, v3
  s_nop 3
  s_or_b64 s[32:33], vcc, s[30:31]
  s_movk_i32 s34, 0x207
  v_cmp_class_f32 vcc, v56, s34
  s_nop 3
  s_or_b64 s[32:33], s[32:33], vcc
  v_cmp_class_f32 vcc, v57, s34
  s_nop 3
  s_or_b64 s[32:33], s[32:33], vcc
  v_cmp_class_f32 vcc, v58, s34
  s_nop 3
  s_or_b64 s[32:33], s[32:33], vcc
  v_cmp_class_f32 vcc, v59, s34
  s_nop 3
  s_or_b64 s[32:33], s[32:33], vcc
  v_cmp_class_f32 vcc, v60, s34
  s_nop 3
  s_or_b64 s[32:33], s[32:33], vcc
  v_cmp_class_f32 vcc, v61, s34
  s_nop 3
  s_or_b64 s[32:33], s[32:33], vcc
  v_cmp_class_f32 vcc, v62, s34
  s_nop 3
  s_or_b64 s[32:33], s[32:33], vcc
  v_cmp_class_f32 vcc, v63, s34
  s_nop 3
  s_or_b64 s[32:33], s[32:33], vcc
  v_cmp_class_f32 vcc, v64, s34
  s_nop 3
  s_or_b64 s[32:33], s[32:33], vcc
  v_cmp_class_f32 vcc, v65, s34
  s_nop 3
  s_or_b64 s[32:33], s[32:33], vcc
  v_cmp_class_f32 vcc, v66, s34
  s_nop 3
  s_or_b64 s[32:33], s[32:33], vcc
  v_cmp_class_f32 vcc, v67, s34
  s_nop 3
  s_or_b64 s[32:33], s[32:33], vcc
  v_cmp_class_f32 vcc, v68, s34
  s_nop 3
  s_or_b64 s[32:33], s[32:33], vcc
  v_cmp_class_f32 vcc, v69, s34
  s_nop 3
  s_or_b64 s[32:33], s[32:33], vcc
  v_cmp_class_f32 vcc, v70, s34
  s_nop 3
  s_or_b64 s[32:33], s[32:33], vcc
  v_cmp_class_f32 vcc, v71, s34
  s_nop 3
  s_or_b64 s[32:33], s[32:33], vcc
  v_cmp_class_f32 vcc, v72, s34
  s_nop 3
  s_or_b64 s[32:33], s[32:33], vcc
  v_cmp_class_f32 vcc, v73, s34
  s_nop 3
  s_or_b64 s[32:33], s[32:33], vcc
  v_cmp_class_f32 vcc, v74, s34
  s_nop 3
  s_or_b64 s[32:33], s[32:33], vcc
  v_cmp_class_f32 vcc, v75, s34
  s_nop 3
  s_or_b64 s[32:33], s[32:33], vcc
  v_cmp_class_f32 vcc, v76, s34
  s_nop 3
  s_or_b64 s[32:33], s[32:33], vcc
  v_cmp_class_f32 vcc, v77, s34
  s_nop 3
  s_or_b64 s[32:33], s[32:33], vcc
  v_cmp_class_f32 vcc, v78, s34
  s_nop 3
  s_or_b64 s[32:33], s[32:33], vcc
  v_cmp_class_f32 vcc, v79, s34
  s_nop 3
  s_or_b64 s[32:33], s[32:33], vcc
  v_cmp_class_f32 vcc, v80, s34
  s_nop 3
  s_or_b64 s[32:33], s[32:33], vcc
  v_cmp_class_f32 vcc, v81, s34
  s_nop 3
  s_or_b64 s[32:33], s[32:33], vcc
  v_cmp_class_f32 vcc, v82, s34
  s_nop 3
  s_or_b64 s[32:33], s[32:33], vcc
  v_cmp_class_f32 vcc, v83, s34
  s_nop 3
  s_or_b64 s[32:33], s[32:33], vcc
  v_cmp_class_f32 vcc, v84, s34
  s_nop 3
  s_or_b64 s[32:33], s[32:33], vcc
  v_cmp_class_f32 vcc, v85, s34
  s_nop 3
  s_or_b64 s[32:33], s[32:33], vcc
  v_cmp_class_f32 vcc, v86, s34
  s_nop 3
  s_or_b64 s[32:33], s[32:33], vcc
  v_cmp_class_f32 vcc, v87, s34
  s_nop 3
  s_or_b64 s[32:33], s[32:33], vcc
  s_mov_b64 vcc, s[32:33]
  s_cbranch_vccz attnb_done5
  s_mov_b32 s25, s21
  s_mov_b32 s27, 0
  v_mov_b32 v120, 0xff800000
  v_mov_b32 v121, 0xff800000
attnb_fb4:
  buffer_load_dwordx4 v[136:139], v1, s[4:7], s25 offen
  buffer_load_dwordx4 v[140:143], v1, s[4:7], s25 offen offset:1024
  s_add_u32 s25, s25, 2048
  s_waitcnt vmcnt(0)
  v_mfma_f32_32x32x16_bf16 v[88:103], v[136:139], v[8:11], 0
  v_mfma_f32_32x32x16_bf16 v[88:103], v[140:143], v[12:15], v[88:103]
  v_mfma_f32_32x32x16_bf16 v[104:119], v[136:139], v[16:19], 0
  v_mfma_f32_32x32x16_bf16 v[104:119], v[140:143], v[20:23], v[104:119]
  s_nop 9
  v_max3_f32 v2, v88, v89, v90
  v_max3_f32 v2, v2, v91, v92
  v_max3_f32 v2, v2, v93, v94
  v_max3_f32 v2, v2, v95, v96
  v_max3_f32 v2, v2, v97, v98
  v_max3_f32 v2, v2, v99, v100
  v_max3_f32 v2, v2, v101, v102
  v_max_f32 v2, v2, v103
  v_max_f32 v120, v120, v2
  s_nop 2
  v_max3_f32 v3, v104, v105, v106
  v_max3_f32 v3, v3, v107, v108
  v_max3_f32 v3, v3, v109, v110
  v_max3_f32 v3, v3, v111, v112
  v_max3_f32 v3, v3, v113, v114
  v_max3_f32 v3, v3, v115, v116
  v_max3_f32 v3, v3, v117, v118
  v_max_f32 v3, v3, v119
  v_max_f32 v121, v121, v3
  s_add_u32 s27, s27, 1
  s_cmp_lt_u32 s27, 64
  s_cbranch_scc1 attnb_fb4
  v_mov_b32 v4, v120
  s_nop 1
  v_permlane32_swap_b32 v120, v4
  v_max_f32 v120, v120, v4
  v_sub_f32 v24, 0, v120
  v_sub_f32 v25, 0, v120
  v_sub_f32 v26, 0, v120
  v_sub_f32 v27, 0, v120
  v_sub_f32 v28, 0, v120
  v_sub_f32 v29, 0, v120
  v_sub_f32 v30, 0, v120
  v_sub_f32 v31, 0, v120
  v_sub_f32 v32, 0, v120
  v_sub_f32 v33, 0, v120
  v_sub_f32 v34, 0, v120
  v_sub_f32 v35, 0, v120
  v_sub_f32 v36, 0, v120
  v_sub_f32 v37, 0, v120
  v_sub_f32 v38, 0, v120
  v_sub_f32 v39, 0, v120
  v_mov_b32 v4, v121
  s_nop 1
  v_permlane32_swap_b32 v121, v4
  v_max_f32 v121, v121, v4
  v_sub_f32 v40, 0, v121
  v_sub_f32 v41, 0, v121
  v_sub_f32 v42, 0, v121
  v_sub_f32 v43, 0, v121
  v_sub_f32 v44, 0, v121
  v_sub_f32 v45, 0, v121
  v_sub_f32 v46, 0, v121
  v_sub_f32 v47, 0, v121
  v_sub_f32 v48, 0, v121
  v_sub_f32 v49, 0, v121
  v_sub_f32 v50, 0, v121
  v_sub_f32 v51, 0, v121
  v_sub_f32 v52, 0, v121
  v_sub_f32 v53, 0, v121
  v_sub_f32 v54, 0, v121
  v_sub_f32 v55, 0, v121
  s_mov_b32 s28, 1
  s_branch attnb_main2
attnb_done5:
  v_and_b32 v136, 63, v0
  v_and_b32 v137, 15, v136
  v_lshlrev_b32 v137, 4, v137
  v_lshrrev_b32 v138, 5, v136
  v_lshl_add_u32 v137, v138, 8, v137
  v_bfe_u32 v138, v136, 4, 1
  v_lshl_add_u32 v137, v138, 15, v137
  s_lshl_b32 s24, s23, 16
  s_lshl_b32 s25, s17, 10
  s_add_u32 s24, s24, s25
  s_add_u32 s24, s24, 174063616
  v_rcp_f32 v4, v2
  s_nop 0
  v_mul_f32 v56, v56, v4
  v_mul_f32 v57, v57, v4
  v_mul_f32 v58, v58, v4
  v_mul_f32 v59, v59, v4
  v_mul_f32 v60, v60, v4
  v_mul_f32 v61, v61, v4
  v_mul_f32 v62, v62, v4
  v_mul_f32 v63, v63, v4
  v_mul_f32 v64, v64, v4
  v_mul_f32 v65, v65, v4
  v_mul_f32 v66, v66, v4
  v_mul_f32 v67, v67, v4
  v_mul_f32 v68, v68, v4
  v_mul_f32 v69, v69, v4
  v_mul_f32 v70, v70, v4
  v_mul_f32 v71, v71, v4
  v_cvt_pk_bf16_f32 v120, v56, v57
  v_cvt_pk_bf16_f32 v121, v58, v59
  v_cvt_pk_bf16_f32 v122, v60, v61
  v_cvt_pk_bf16_f32 v123, v62, v63
  v_cvt_pk_bf16_f32 v124, v64, v65
  v_cvt_pk_bf16_f32 v125, v66, v67
  v_cvt_pk_bf16_f32 v126, v68, v69
  v_cvt_pk_bf16_f32 v127, v70, v71
  buffer_store_dwordx4 v[120:123], v137, s[4:7], s24 offen
  buffer_store_dwordx4 v[124:127], v137, s[4:7], s24 offen offset:512
  v_rcp_f32 v4, v3
  s_nop 0
  v_mul_f32 v72, v72, v4
  v_mul_f32 v73, v73, v4
  v_mul_f32 v74, v74, v4
  v_mul_f32 v75, v75, v4
  v_mul_f32 v76, v76, v4
  v_mul_f32 v77, v77, v4
  v_mul_f32 v78, v78, v4
  v_mul_f32 v79, v79, v4
  v_mul_f32 v80, v80, v4
  v_mul_f32 v81, v81, v4
  v_mul_f32 v82, v82, v4
  v_mul_f32 v83, v83, v4
  v_mul_f32 v84, v84, v4
  v_mul_f32 v85, v85, v4
  v_mul_f32 v86, v86, v4
  v_mul_f32 v87, v87, v4
  v_cvt_pk_bf16_f32 v128, v72, v73
  v_cvt_pk_bf16_f32 v129, v74, v75
  v_cvt_pk_bf16_f32 v130, v76, v77
  v_cvt_pk_bf16_f32 v131, v78, v79
  v_cvt_pk_bf16_f32 v132, v80, v81
  v_cvt_pk_bf16_f32 v133, v82, v83
  v_cvt_pk_bf16_f32 v134, v84, v85
  v_cvt_pk_bf16_f32 v135, v86, v87
  s_add_u32 s24, s24, 65536
  buffer_store_dwordx4 v[128:131], v137, s[4:7], s24 offen
  buffer_store_dwordx4 v[132:135], v137, s[4:7], s24 offen offset:512
attnb_exit1:
  s_endpgm
.globl outb1_kernel
.p2align 8
.type outb1_kernel,@function
outb1_kernel:
  s_cmp_ge_u32 s2, 256
  s_cbranch_scc1 outb1_exit1
  s_load_dwordx2 s[12:13], s[0:1], 96
  s_load_dwordx2 s[14:15], s[0:1], 0
  s_load_dwordx2 s[48:49], s[0:1], 80
  v_lshrrev_b32 v3, 6, v0
  v_and_b32 v4, 63, v0
  s_nop 0
  v_readfirstlane_b32 s16, v3
  v_lshlrev_b32 v1, 4, v4
  s_and_b32 s17, s2, 7
  s_lshl_b32 s17, s17, 2
  s_lshr_b32 s18, s2, 3
  s_and_b32 s19, s18, 3
  s_add_u32 s17, s17, s19
  s_lshr_b32 s18, s18, 2
  s_waitcnt lgkmcnt(0)
  s_mov_b32 s4, s12
  s_mov_b32 s5, s13
  s_mov_b32 s6, 0x10000000
  s_mov_b32 s7, 0x20000
  s_mov_b32 s8, s12
  s_mov_b32 s9, s13
  s_mov_b32 s10, 0x10000000
  s_mov_b32 s11, 0x20000
  s_mov_b32 s20, 150994944
  s_mov_b32 s52, s48
  s_mov_b32 s53, s49
  s_mov_b32 s54, 2621440
  s_mov_b32 s55, 0x20000
  s_mul_i32 s21, s18, 5
  s_mul_i32 s21, s21, 32768
  s_add_u32 s24, s21, 160169984
  s_add_u32 s25, s24, 32768
  s_add_u32 s26, s25, 32768
  s_add_u32 s27, s26, 32768
  s_add_u32 s28, s27, 32768
  s_lshl_b32 s21, s17, 2
  s_add_u32 s21, s21, s16
  s_mul_i32 s22, s21, 32768
  s_add_u32 s22, s22, 174063616
  s_lshl_b32 s23, s16, 10
  v_add_u32 v2, s23, v1
  s_mul_i32 s29, s16, 5120
  s_add_u32 m0, s29, 0
  s_nop 0
  buffer_load_dwordx4 v2, s[4:7], s24 offen lds
  s_add_u32 m0, s29, 1024
  s_nop 0
  buffer_load_dwordx4 v2, s[4:7], s25 offen lds
  s_add_u32 m0, s29, 2048
  s_nop 0
  buffer_load_dwordx4 v2, s[4:7], s26 offen lds
  s_add_u32 m0, s29, 3072
  s_nop 0
  buffer_load_dwordx4 v2, s[4:7], s27 offen lds
  s_add_u32 m0, s29, 4096
  s_nop 0
  buffer_load_dwordx4 v2, s[4:7], s28 offen lds
  buffer_load_dwordx4 v[32:35], v1, s[4:7], s22 offen offset:0
  buffer_load_dwordx4 v[36:39], v1, s[4:7], s22 offen offset:1024
  buffer_load_dwordx4 v[40:43], v1, s[4:7], s22 offen offset:2048
  buffer_load_dwordx4 v[44:47], v1, s[4:7], s22 offen offset:3072
  v_add_u32 v2, 0x1000, v2
  s_add_u32 s22, s22, 4096
  s_add_u32 m0, s29, 20480
  s_nop 0
  buffer_load_dwordx4 v2, s[4:7], s24 offen lds
  s_add_u32 m0, s29, 21504
  s_nop 0
  buffer_load_dwordx4 v2, s[4:7], s25 offen lds
  s_add_u32 m0, s29, 22528
  s_nop 0
  buffer_load_dwordx4 v2, s[4:7], s26 offen lds
  s_add_u32 m0, s29, 23552
  s_nop 0
  buffer_load_dwordx4 v2, s[4:7], s27 offen lds
  s_add_u32 m0, s29, 24576
  s_nop 0
  buffer_load_dwordx4 v2, s[4:7], s28 offen lds
  buffer_load_dwordx4 v[48:51], v1, s[4:7], s22 offen offset:0
  buffer_load_dwordx4 v[52:55], v1, s[4:7], s22 offen offset:1024
  buffer_load_dwordx4 v[56:59], v1, s[4:7], s22 offen offset:2048
  buffer_load_dwordx4 v[60:63], v1, s[4:7], s22 offen offset:3072
  v_add_u32 v2, 0x1000, v2
  s_add_u32 s22, s22, 4096
  s_waitcnt vmcnt(9)
  s_barrier
  s_add_u32 m0, s29, 40960
  s_nop 0
  buffer_load_dwordx4 v2, s[4:7], s24 offen lds
  s_add_u32 m0, s29, 41984
  s_nop 0
  buffer_load_dwordx4 v2, s[4:7], s25 offen lds
  s_add_u32 m0, s29, 43008
  s_nop 0
  buffer_load_dwordx4 v2, s[4:7], s26 offen lds
  s_add_u32 m0, s29, 44032
  s_nop 0
  buffer_load_dwordx4 v2, s[4:7], s27 offen lds
  s_add_u32 m0, s29, 45056
  s_nop 0
  buffer_load_dwordx4 v2, s[4:7], s28 offen lds
  buffer_load_dwordx4 v[64:67], v1, s[4:7], s22 offen offset:0
  buffer_load_dwordx4 v[68:71], v1, s[4:7], s22 offen offset:1024
  buffer_load_dwordx4 v[72:75], v1, s[4:7], s22 offen offset:2048
  buffer_load_dwordx4 v[76:79], v1, s[4:7], s22 offen offset:3072
  v_add_u32 v2, 0x1000, v2
  s_add_u32 s22, s22, 4096
  ds_read_b128 v[80:83], v1 offset:0
  ds_read_b128 v[84:87], v1 offset:1024
  ds_read_b128 v[88:91], v1 offset:2048
  ds_read_b128 v[92:95], v1 offset:3072
  ds_read_b128 v[96:99], v1 offset:4096
  ds_read_b128 v[100:103], v1 offset:5120
  ds_read_b128 v[104:107], v1 offset:6144
  ds_read_b128 v[108:111], v1 offset:7168
  ds_read_b128 v[112:115], v1 offset:8192
  ds_read_b128 v[116:119], v1 offset:9216
  s_waitcnt lgkmcnt(5)
  v_mfma_f32_16x16x32_bf16 v[8:11], v[80:83], v[32:35], 0
  v_mfma_f32_16x16x32_bf16 v[12:15], v[84:87], v[32:35], 0
  v_mfma_f32_16x16x32_bf16 v[16:19], v[88:91], v[32:35], 0
  v_mfma_f32_16x16x32_bf16 v[20:23], v[92:95], v[32:35], 0
  v_mfma_f32_16x16x32_bf16 v[24:27], v[96:99], v[32:35], 0
  ds_read_b128 v[80:83], v1 offset:10240
  ds_read_b128 v[84:87], v1 offset:11264
  ds_read_b128 v[88:91], v1 offset:12288
  ds_read_b128 v[92:95], v1 offset:13312
  ds_read_b128 v[96:99], v1 offset:14336
  s_waitcnt lgkmcnt(5)
  v_mfma_f32_16x16x32_bf16 v[8:11], v[100:103], v[36:39], v[8:11]
  v_mfma_f32_16x16x32_bf16 v[12:15], v[104:107], v[36:39], v[12:15]
  v_mfma_f32_16x16x32_bf16 v[16:19], v[108:111], v[36:39], v[16:19]
  v_mfma_f32_16x16x32_bf16 v[20:23], v[112:115], v[36:39], v[20:23]
  v_mfma_f32_16x16x32_bf16 v[24:27], v[116:119], v[36:39], v[24:27]
  ds_read_b128 v[100:103], v1 offset:15360
  ds_read_b128 v[104:107], v1 offset:16384
  ds_read_b128 v[108:111], v1 offset:17408
  ds_read_b128 v[112:115], v1 offset:18432
  ds_read_b128 v[116:119], v1 offset:19456
  s_waitcnt lgkmcnt(5)
  v_mfma_f32_16x16x32_bf16 v[8:11], v[80:83], v[40:43], v[8:11]
  v_mfma_f32_16x16x32_bf16 v[12:15], v[84:87], v[40:43], v[12:15]
  v_mfma_f32_16x16x32_bf16 v[16:19], v[88:91], v[40:43], v[16:19]
  v_mfma_f32_16x16x32_bf16 v[20:23], v[92:95], v[40:43], v[20:23]
  v_mfma_f32_16x16x32_bf16 v[24:27], v[96:99], v[40:43], v[24:27]
  s_waitcnt lgkmcnt(0)
  v_mfma_f32_16x16x32_bf16 v[8:11], v[100:103], v[44:47], v[8:11]
  v_mfma_f32_16x16x32_bf16 v[12:15], v[104:107], v[44:47], v[12:15]
  v_mfma_f32_16x16x32_bf16 v[16:19], v[108:111], v[44:47], v[16:19]
  v_mfma_f32_16x16x32_bf16 v[20:23], v[112:115], v[44:47], v[20:23]
  v_mfma_f32_16x16x32_bf16 v[24:27], v[116:119], v[44:47], v[24:27]
  s_mov_b32 s30, 0
outb1_loop2:
  s_waitcnt vmcnt(9)
  s_barrier
  s_add_u32 m0, s29, 0
  s_nop 0
  buffer_load_dwordx4 v2, s[4:7], s24 offen lds
  s_add_u32 m0, s29, 1024
  s_nop 0
  buffer_load_dwordx4 v2, s[4:7], s25 offen lds
  s_add_u32 m0, s29, 2048
  s_nop 0
  buffer_load_dwordx4 v2, s[4:7], s26 offen lds
  s_add_u32 m0, s29, 3072
  s_nop 0
  buffer_load_dwordx4 v2, s[4:7], s27 offen lds
  s_add_u32 m0, s29, 4096
  s_nop 0
  buffer_load_dwordx4 v2, s[4:7], s28 offen lds
  buffer_load_dwordx4 v[32:35], v1, s[4:7], s22 offen offset:0
  buffer_load_dwordx4 v[36:39], v1, s[4:7], s22 offen offset:1024
  buffer_load_dwordx4 v[40:43], v1, s[4:7], s22 offen offset:2048
  buffer_load_dwordx4 v[44:47], v1, s[4:7], s22 offen offset:3072
  v_add_u32 v2, 0x1000, v2
  s_add_u32 s22, s22, 4096
  ds_read_b128 v[80:83], v1 offset:20480
  ds_read_b128 v[84:87], v1 offset:21504
  ds_read_b128 v[88:91], v1 offset:22528
  ds_read_b128 v[92:95], v1 offset:23552
  ds_read_b128 v[96:99], v1 offset:24576
  ds_read_b128 v[100:103], v1 offset:25600
  ds_read_b128 v[104:107], v1 offset:26624
  ds_read_b128 v[108:111], v1 offset:27648
  ds_read_b128 v[112:115], v1 offset:28672
  ds_read_b128 v[116:119], v1 offset:29696
  s_waitcnt lgkmcnt(5)
  v_mfma_f32_16x16x32_bf16 v[8:11], v[80:83], v[48:51], v[8:11]
  v_mfma_f32_16x16x32_bf16 v[12:15], v[84:87], v[48:51], v[12:15]
  v_mfma_f32_16x16x32_bf16 v[16:19], v[88:91], v[48:51], v[16:19]
  v_mfma_f32_16x16x32_bf16 v[20:23], v[92:95], v[48:51], v[20:23]
  v_mfma_f32_16x16x32_bf16 v[24:27], v[96:99], v[48:51], v[24:27]
  ds_read_b128 v[80:83], v1 offset:30720
  ds_read_b128 v[84:87], v1 offset:31744
  ds_read_b128 v[88:91], v1 offset:32768
  ds_read_b128 v[92:95], v1 offset:33792
  ds_read_b128 v[96:99], v1 offset:34816
  s_waitcnt lgkmcnt(5)
  v_mfma_f32_16x16x32_bf16 v[8:11], v[100:103], v[52:55], v[8:11]
  v_mfma_f32_16x16x32_bf16 v[12:15], v[104:107], v[52:55], v[12:15]
  v_mfma_f32_16x16x32_bf16 v[16:19], v[108:111], v[52:55], v[16:19]
  v_mfma_f32_16x16x32_bf16 v[20:23], v[112:115], v[52:55], v[20:23]
  v_mfma_f32_16x16x32_bf16 v[24:27], v[116:119], v[52:55], v[24:27]
  ds_read_b128 v[100:103], v1 offset:35840
  ds_read_b128 v[104:107], v1 offset:36864
  ds_read_b128 v[108:111], v1 offset:37888
  ds_read_b128 v[112:115], v1 offset:38912
  ds_read_b128 v[116:119], v1 offset:39936
  s_waitcnt lgkmcnt(5)
  v_mfma_f32_16x16x32_bf16 v[8:11], v[80:83], v[56:59], v[8:11]
  v_mfma_f32_16x16x32_bf16 v[12:15], v[84:87], v[56:59], v[12:15]
  v_mfma_f32_16x16x32_bf16 v[16:19], v[88:91], v[56:59], v[16:19]
  v_mfma_f32_16x16x32_bf16 v[20:23], v[92:95], v[56:59], v[20:23]
  v_mfma_f32_16x16x32_bf16 v[24:27], v[96:99], v[56:59], v[24:27]
  s_waitcnt lgkmcnt(0)
  v_mfma_f32_16x16x32_bf16 v[8:11], v[100:103], v[60:63], v[8:11]
  v_mfma_f32_16x16x32_bf16 v[12:15], v[104:107], v[60:63], v[12:15]
  v_mfma_f32_16x16x32_bf16 v[16:19], v[108:111], v[60:63], v[16:19]
  v_mfma_f32_16x16x32_bf16 v[20:23], v[112:115], v[60:63], v[20:23]
  v_mfma_f32_16x16x32_bf16 v[24:27], v[116:119], v[60:63], v[24:27]
  s_waitcnt vmcnt(9)
  s_barrier
  s_add_u32 m0, s29, 20480
  s_nop 0
  buffer_load_dwordx4 v2, s[4:7], s24 offen lds
  s_add_u32 m0, s29, 21504
  s_nop 0
  buffer_load_dwordx4 v2, s[4:7], s25 offen lds
  s_add_u32 m0, s29, 22528
  s_nop 0
  buffer_load_dwordx4 v2, s[4:7], s26 offen lds
  s_add_u32 m0, s29, 23552
  s_nop 0
  buffer_load_dwordx4 v2, s[4:7], s27 offen lds
  s_add_u32 m0, s29, 24576
  s_nop 0
  buffer_load_dwordx4 v2, s[4:7], s28 offen lds
  buffer_load_dwordx4 v[48:51], v1, s[4:7], s22 offen offset:0
  buffer_load_dwordx4 v[52:55], v1, s[4:7], s22 offen offset:1024
  buffer_load_dwordx4 v[56:59], v1, s[4:7], s22 offen offset:2048
  buffer_load_dwordx4 v[60:63], v1, s[4:7], s22 offen offset:3072
  v_add_u32 v2, 0x1000, v2
  s_add_u32 s22, s22, 4096
  ds_read_b128 v[80:83], v1 offset:40960
  ds_read_b128 v[84:87], v1 offset:41984
  ds_read_b128 v[88:91], v1 offset:43008
  ds_read_b128 v[92:95], v1 offset:44032
  ds_read_b128 v[96:99], v1 offset:45056
  ds_read_b128 v[100:103], v1 offset:46080
  ds_read_b128 v[104:107], v1 offset:47104
  ds_read_b128 v[108:111], v1 offset:48128
  ds_read_b128 v[112:115], v1 offset:49152
  ds_read_b128 v[116:119], v1 offset:50176
  s_waitcnt lgkmcnt(5)
  v_mfma_f32_16x16x32_bf16 v[8:11], v[80:83], v[64:67], v[8:11]
  v_mfma_f32_16x16x32_bf16 v[12:15], v[84:87], v[64:67], v[12:15]
  v_mfma_f32_16x16x32_bf16 v[16:19], v[88:91], v[64:67], v[16:19]
  v_mfma_f32_16x16x32_bf16 v[20:23], v[92:95], v[64:67], v[20:23]
  v_mfma_f32_16x16x32_bf16 v[24:27], v[96:99], v[64:67], v[24:27]
  ds_read_b128 v[80:83], v1 offset:51200
  ds_read_b128 v[84:87], v1 offset:52224
  ds_read_b128 v[88:91], v1 offset:53248
  ds_read_b128 v[92:95], v1 offset:54272
  ds_read_b128 v[96:99], v1 offset:55296
  s_waitcnt lgkmcnt(5)
  v_mfma_f32_16x16x32_bf16 v[8:11], v[100:103], v[68:71], v[8:11]
  v_mfma_f32_16x16x32_bf16 v[12:15], v[104:107], v[68:71], v[12:15]
  v_mfma_f32_16x16x32_bf16 v[16:19], v[108:111], v[68:71], v[16:19]
  v_mfma_f32_16x16x32_bf16 v[20:23], v[112:115], v[68:71], v[20:23]
  v_mfma_f32_16x16x32_bf16 v[24:27], v[116:119], v[68:71], v[24:27]
  ds_read_b128 v[100:103], v1 offset:56320
  ds_read_b128 v[104:107], v1 offset:57344
  ds_read_b128 v[108:111], v1 offset:58368
  ds_read_b128 v[112:115], v1 offset:59392
  ds_read_b128 v[116:119], v1 offset:60416
  s_waitcnt lgkmcnt(5)
  v_mfma_f32_16x16x32_bf16 v[8:11], v[80:83], v[72:75], v[8:11]
  v_mfma_f32_16x16x32_bf16 v[12:15], v[84:87], v[72:75], v[12:15]
  v_mfma_f32_16x16x32_bf16 v[16:19], v[88:91], v[72:75], v[16:19]
  v_mfma_f32_16x16x32_bf16 v[20:23], v[92:95], v[72:75], v[20:23]
  v_mfma_f32_16x16x32_bf16 v[24:27], v[96:99], v[72:75], v[24:27]
  s_waitcnt lgkmcnt(0)
  v_mfma_f32_16x16x32_bf16 v[8:11], v[100:103], v[76:79], v[8:11]
  v_mfma_f32_16x16x32_bf16 v[12:15], v[104:107], v[76:79], v[12:15]
  v_mfma_f32_16x16x32_bf16 v[16:19], v[108:111], v[76:79], v[16:19]
  v_mfma_f32_16x16x32_bf16 v[20:23], v[112:115], v[76:79], v[20:23]
  v_mfma_f32_16x16x32_bf16 v[24:27], v[116:119], v[76:79], v[24:27]
  s_waitcnt vmcnt(9)
  s_barrier
  s_add_u32 m0, s29, 40960
  s_nop 0
  buffer_load_dwordx4 v2, s[4:7], s24 offen lds
  s_add_u32 m0, s29, 41984
  s_nop 0
  buffer_load_dwordx4 v2, s[4:7], s25 offen lds
  s_add_u32 m0, s29, 43008
  s_nop 0
  buffer_load_dwordx4 v2, s[4:7], s26 offen lds
  s_add_u32 m0, s29, 44032
  s_nop 0
  buffer_load_dwordx4 v2, s[4:7], s27 offen lds
  s_add_u32 m0, s29, 45056
  s_nop 0
  buffer_load_dwordx4 v2, s[4:7], s28 offen lds
  buffer_load_dwordx4 v[64:67], v1, s[4:7], s22 offen offset:0
  buffer_load_dwordx4 v[68:71], v1, s[4:7], s22 offen offset:1024
  buffer_load_dwordx4 v[72:75], v1, s[4:7], s22 offen offset:2048
  buffer_load_dwordx4 v[76:79], v1, s[4:7], s22 offen offset:3072
  v_add_u32 v2, 0x1000, v2
  s_add_u32 s22, s22, 4096
  ds_read_b128 v[80:83], v1 offset:0
  ds_read_b128 v[84:87], v1 offset:1024
  ds_read_b128 v[88:91], v1 offset:2048
  ds_read_b128 v[92:95], v1 offset:3072
  ds_read_b128 v[96:99], v1 offset:4096
  ds_read_b128 v[100:103], v1 offset:5120
  ds_read_b128 v[104:107], v1 offset:6144
  ds_read_b128 v[108:111], v1 offset:7168
  ds_read_b128 v[112:115], v1 offset:8192
  ds_read_b128 v[116:119], v1 offset:9216
  s_waitcnt lgkmcnt(5)
  v_mfma_f32_16x16x32_bf16 v[8:11], v[80:83], v[32:35], v[8:11]
  v_mfma_f32_16x16x32_bf16 v[12:15], v[84:87], v[32:35], v[12:15]
  v_mfma_f32_16x16x32_bf16 v[16:19], v[88:91], v[32:35], v[16:19]
  v_mfma_f32_16x16x32_bf16 v[20:23], v[92:95], v[32:35], v[20:23]
  v_mfma_f32_16x16x32_bf16 v[24:27], v[96:99], v[32:35], v[24:27]
  ds_read_b128 v[80:83], v1 offset:10240
  ds_read_b128 v[84:87], v1 offset:11264
  ds_read_b128 v[88:91], v1 offset:12288
  ds_read_b128 v[92:95], v1 offset:13312
  ds_read_b128 v[96:99], v1 offset:14336
  s_waitcnt lgkmcnt(5)
  v_mfma_f32_16x16x32_bf16 v[8:11], v[100:103], v[36:39], v[8:11]
  v_mfma_f32_16x16x32_bf16 v[12:15], v[104:107], v[36:39], v[12:15]
  v_mfma_f32_16x16x32_bf16 v[16:19], v[108:111], v[36:39], v[16:19]
  v_mfma_f32_16x16x32_bf16 v[20:23], v[112:115], v[36:39], v[20:23]
  v_mfma_f32_16x16x32_bf16 v[24:27], v[116:119], v[36:39], v[24:27]
  ds_read_b128 v[100:103], v1 offset:15360
  ds_read_b128 v[104:107], v1 offset:16384
  ds_read_b128 v[108:111], v1 offset:17408
  ds_read_b128 v[112:115], v1 offset:18432
  ds_read_b128 v[116:119], v1 offset:19456
  s_waitcnt lgkmcnt(5)
  v_mfma_f32_16x16x32_bf16 v[8:11], v[80:83], v[40:43], v[8:11]
  v_mfma_f32_16x16x32_bf16 v[12:15], v[84:87], v[40:43], v[12:15]
  v_mfma_f32_16x16x32_bf16 v[16:19], v[88:91], v[40:43], v[16:19]
  v_mfma_f32_16x16x32_bf16 v[20:23], v[92:95], v[40:43], v[20:23]
  v_mfma_f32_16x16x32_bf16 v[24:27], v[96:99], v[40:43], v[24:27]
  s_waitcnt lgkmcnt(0)
  v_mfma_f32_16x16x32_bf16 v[8:11], v[100:103], v[44:47], v[8:11]
  v_mfma_f32_16x16x32_bf16 v[12:15], v[104:107], v[44:47], v[12:15]
  v_mfma_f32_16x16x32_bf16 v[16:19], v[108:111], v[44:47], v[16:19]
  v_mfma_f32_16x16x32_bf16 v[20:23], v[112:115], v[44:47], v[20:23]
  v_mfma_f32_16x16x32_bf16 v[24:27], v[116:119], v[44:47], v[24:27]
  s_add_u32 s30, s30, 1
  s_cmp_lt_u32 s30, 1
  s_cbranch_scc1 outb1_loop2
  s_waitcnt vmcnt(9)
  s_barrier
  s_add_u32 m0, s29, 0
  s_nop 0
  buffer_load_dwordx4 v2, s[4:7], s24 offen lds
  s_add_u32 m0, s29, 1024
  s_nop 0
  buffer_load_dwordx4 v2, s[4:7], s25 offen lds
  s_add_u32 m0, s29, 2048
  s_nop 0
  buffer_load_dwordx4 v2, s[4:7], s26 offen lds
  s_add_u32 m0, s29, 3072
  s_nop 0
  buffer_load_dwordx4 v2, s[4:7], s27 offen lds
  s_add_u32 m0, s29, 4096
  s_nop 0
  buffer_load_dwordx4 v2, s[4:7], s28 offen lds
  buffer_load_dwordx4 v[32:35], v1, s[4:7], s22 offen offset:0
  buffer_load_dwordx4 v[36:39], v1, s[4:7], s22 offen offset:1024
  buffer_load_dwordx4 v[40:43], v1, s[4:7], s22 offen offset:2048
  buffer_load_dwordx4 v[44:47], v1, s[4:7], s22 offen offset:3072
  v_add_u32 v2, 0x1000, v2
  s_add_u32 s22, s22, 4096
  ds_read_b128 v[80:83], v1 offset:20480
  ds_read_b128 v[84:87], v1 offset:21504
  ds_read_b128 v[88:91], v1 offset:22528
  ds_read_b128 v[92:95], v1 offset:23552
  ds_read_b128 v[96:99], v1 offset:24576
  ds_read_b128 v[100:103], v1 offset:25600
  ds_read_b128 v[104:107], v1 offset:26624
  ds_read_b128 v[108:111], v1 offset:27648
  ds_read_b128 v[112:115], v1 offset:28672
  ds_read_b128 v[116:119], v1 offset:29696
  s_waitcnt lgkmcnt(5)
  v_mfma_f32_16x16x32_bf16 v[8:11], v[80:83], v[48:51], v[8:11]
  v_mfma_f32_16x16x32_bf16 v[12:15], v[84:87], v[48:51], v[12:15]
  v_mfma_f32_16x16x32_bf16 v[16:19], v[88:91], v[48:51], v[16:19]
  v_mfma_f32_16x16x32_bf16 v[20:23], v[92:95], v[48:51], v[20:23]
  v_mfma_f32_16x16x32_bf16 v[24:27], v[96:99], v[48:51], v[24:27]
  ds_read_b128 v[80:83], v1 offset:30720
  ds_read_b128 v[84:87], v1 offset:31744
  ds_read_b128 v[88:91], v1 offset:32768
  ds_read_b128 v[92:95], v1 offset:33792
  ds_read_b128 v[96:99], v1 offset:34816
  s_waitcnt lgkmcnt(5)
  v_mfma_f32_16x16x32_bf16 v[8:11], v[100:103], v[52:55], v[8:11]
  v_mfma_f32_16x16x32_bf16 v[12:15], v[104:107], v[52:55], v[12:15]
  v_mfma_f32_16x16x32_bf16 v[16:19], v[108:111], v[52:55], v[16:19]
  v_mfma_f32_16x16x32_bf16 v[20:23], v[112:115], v[52:55], v[20:23]
  v_mfma_f32_16x16x32_bf16 v[24:27], v[116:119], v[52:55], v[24:27]
  ds_read_b128 v[100:103], v1 offset:35840
  ds_read_b128 v[104:107], v1 offset:36864
  ds_read_b128 v[108:111], v1 offset:37888
  ds_read_b128 v[112:115], v1 offset:38912
  ds_read_b128 v[116:119], v1 offset:39936
  s_waitcnt lgkmcnt(5)
  v_mfma_f32_16x16x32_bf16 v[8:11], v[80:83], v[56:59], v[8:11]
  v_mfma_f32_16x16x32_bf16 v[12:15], v[84:87], v[56:59], v[12:15]
  v_mfma_f32_16x16x32_bf16 v[16:19], v[88:91], v[56:59], v[16:19]
  v_mfma_f32_16x16x32_bf16 v[20:23], v[92:95], v[56:59], v[20:23]
  v_mfma_f32_16x16x32_bf16 v[24:27], v[96:99], v[56:59], v[24:27]
  s_waitcnt lgkmcnt(0)
  v_mfma_f32_16x16x32_bf16 v[8:11], v[100:103], v[60:63], v[8:11]
  v_mfma_f32_16x16x32_bf16 v[12:15], v[104:107], v[60:63], v[12:15]
  v_mfma_f32_16x16x32_bf16 v[16:19], v[108:111], v[60:63], v[16:19]
  v_mfma_f32_16x16x32_bf16 v[20:23], v[112:115], v[60:63], v[20:23]
  v_mfma_f32_16x16x32_bf16 v[24:27], v[116:119], v[60:63], v[24:27]
  s_waitcnt vmcnt(9)
  s_barrier
  s_add_u32 m0, s29, 20480
  s_nop 0
  buffer_load_dwordx4 v2, s[4:7], s24 offen lds
  s_add_u32 m0, s29, 21504
  s_nop 0
  buffer_load_dwordx4 v2, s[4:7], s25 offen lds
  s_add_u32 m0, s29, 22528
  s_nop 0
  buffer_load_dwordx4 v2, s[4:7], s26 offen lds
  s_add_u32 m0, s29, 23552
  s_nop 0
  buffer_load_dwordx4 v2, s[4:7], s27 offen lds
  s_add_u32 m0, s29, 24576
  s_nop 0
  buffer_load_dwordx4 v2, s[4:7], s28 offen lds
  buffer_load_dwordx4 v[48:51], v1, s[4:7], s22 offen offset:0
  buffer_load_dwordx4 v[52:55], v1, s[4:7], s22 offen offset:1024
  buffer_load_dwordx4 v[56:59], v1, s[4:7], s22 offen offset:2048
  buffer_load_dwordx4 v[60:63], v1, s[4:7], s22 offen offset:3072
  v_add_u32 v2, 0x1000, v2
  s_add_u32 s22, s22, 4096
  ds_read_b128 v[80:83], v1 offset:40960
  ds_read_b128 v[84:87], v1 offset:41984
  ds_read_b128 v[88:91], v1 offset:43008
  ds_read_b128 v[92:95], v1 offset:44032
  ds_read_b128 v[96:99], v1 offset:45056
  ds_read_b128 v[100:103], v1 offset:46080
  ds_read_b128 v[104:107], v1 offset:47104
  ds_read_b128 v[108:111], v1 offset:48128
  ds_read_b128 v[112:115], v1 offset:49152
  ds_read_b128 v[116:119], v1 offset:50176
  s_waitcnt lgkmcnt(5)
  v_mfma_f32_16x16x32_bf16 v[8:11], v[80:83], v[64:67], v[8:11]
  v_mfma_f32_16x16x32_bf16 v[12:15], v[84:87], v[64:67], v[12:15]
  v_mfma_f32_16x16x32_bf16 v[16:19], v[88:91], v[64:67], v[16:19]
  v_mfma_f32_16x16x32_bf16 v[20:23], v[92:95], v[64:67], v[20:23]
  v_mfma_f32_16x16x32_bf16 v[24:27], v[96:99], v[64:67], v[24:27]
  ds_read_b128 v[80:83], v1 offset:51200
  ds_read_b128 v[84:87], v1 offset:52224
  ds_read_b128 v[88:91], v1 offset:53248
  ds_read_b128 v[92:95], v1 offset:54272
  ds_read_b128 v[96:99], v1 offset:55296
  s_waitcnt lgkmcnt(5)
  v_mfma_f32_16x16x32_bf16 v[8:11], v[100:103], v[68:71], v[8:11]
  v_mfma_f32_16x16x32_bf16 v[12:15], v[104:107], v[68:71], v[12:15]
  v_mfma_f32_16x16x32_bf16 v[16:19], v[108:111], v[68:71], v[16:19]
  v_mfma_f32_16x16x32_bf16 v[20:23], v[112:115], v[68:71], v[20:23]
  v_mfma_f32_16x16x32_bf16 v[24:27], v[116:119], v[68:71], v[24:27]
  ds_read_b128 v[100:103], v1 offset:56320
  ds_read_b128 v[104:107], v1 offset:57344
  ds_read_b128 v[108:111], v1 offset:58368
  ds_read_b128 v[112:115], v1 offset:59392
  ds_read_b128 v[116:119], v1 offset:60416
  s_waitcnt lgkmcnt(5)
  v_mfma_f32_16x16x32_bf16 v[8:11], v[80:83], v[72:75], v[8:11]
  v_mfma_f32_16x16x32_bf16 v[12:15], v[84:87], v[72:75], v[12:15]
  v_mfma_f32_16x16x32_bf16 v[16:19], v[88:91], v[72:75], v[16:19]
  v_mfma_f32_16x16x32_bf16 v[20:23], v[92:95], v[72:75], v[20:23]
  v_mfma_f32_16x16x32_bf16 v[24:27], v[96:99], v[72:75], v[24:27]
  s_waitcnt lgkmcnt(0)
  v_mfma_f32_16x16x32_bf16 v[8:11], v[100:103], v[76:79], v[8:11]
  v_mfma_f32_16x16x32_bf16 v[12:15], v[104:107], v[76:79], v[12:15]
  v_mfma_f32_16x16x32_bf16 v[16:19], v[108:111], v[76:79], v[16:19]
  v_mfma_f32_16x16x32_bf16 v[20:23], v[112:115], v[76:79], v[20:23]
  v_mfma_f32_16x16x32_bf16 v[24:27], v[116:119], v[76:79], v[24:27]
  s_waitcnt vmcnt(9)
  s_barrier
  ds_read_b128 v[80:83], v1 offset:0
  ds_read_b128 v[84:87], v1 offset:1024
  ds_read_b128 v[88:91], v1 offset:2048
  ds_read_b128 v[92:95], v1 offset:3072
  ds_read_b128 v[96:99], v1 offset:4096
  ds_read_b128 v[100:103], v1 offset:5120
  ds_read_b128 v[104:107], v1 offset:6144
  ds_read_b128 v[108:111], v1 offset:7168
  ds_read_b128 v[112:115], v1 offset:8192
  ds_read_b128 v[116:119], v1 offset:9216
  s_waitcnt lgkmcnt(5)
  v_mfma_f32_16x16x32_bf16 v[8:11], v[80:83], v[32:35], v[8:11]
  v_mfma_f32_16x16x32_bf16 v[12:15], v[84:87], v[32:35], v[12:15]
  v_mfma_f32_16x16x32_bf16 v[16:19], v[88:91], v[32:35], v[16:19]
  v_mfma_f32_16x16x32_bf16 v[20:23], v[92:95], v[32:35], v[20:23]
  v_mfma_f32_16x16x32_bf16 v[24:27], v[96:99], v[32:35], v[24:27]
  ds_read_b128 v[80:83], v1 offset:10240
  ds_read_b128 v[84:87], v1 offset:11264
  ds_read_b128 v[88:91], v1 offset:12288
  ds_read_b128 v[92:95], v1 offset:13312
  ds_read_b128 v[96:99], v1 offset:14336
  s_waitcnt lgkmcnt(5)
  v_mfma_f32_16x16x32_bf16 v[8:11], v[100:103], v[36:39], v[8:11]
  v_mfma_f32_16x16x32_bf16 v[12:15], v[104:107], v[36:39], v[12:15]
  v_mfma_f32_16x16x32_bf16 v[16:19], v[108:111], v[36:39], v[16:19]
  v_mfma_f32_16x16x32_bf16 v[20:23], v[112:115], v[36:39], v[20:23]
  v_mfma_f32_16x16x32_bf16 v[24:27], v[116:119], v[36:39], v[24:27]
  ds_read_b128 v[100:103], v1 offset:15360
  ds_read_b128 v[104:107], v1 offset:16384
  ds_read_b128 v[108:111], v1 offset:17408
  ds_read_b128 v[112:115], v1 offset:18432
  ds_read_b128 v[116:119], v1 offset:19456
  s_waitcnt lgkmcnt(5)
  v_mfma_f32_16x16x32_bf16 v[8:11], v[80:83], v[40:43], v[8:11]
  v_mfma_f32_16x16x32_bf16 v[12:15], v[84:87], v[40:43], v[12:15]
  v_mfma_f32_16x16x32_bf16 v[16:19], v[88:91], v[40:43], v[16:19]
  v_mfma_f32_16x16x32_bf16 v[20:23], v[92:95], v[40:43], v[20:23]
  v_mfma_f32_16x16x32_bf16 v[24:27], v[96:99], v[40:43], v[24:27]
  s_waitcnt lgkmcnt(0)
  v_mfma_f32_16x16x32_bf16 v[8:11], v[100:103], v[44:47], v[8:11]
  v_mfma_f32_16x16x32_bf16 v[12:15], v[104:107], v[44:47], v[12:15]
  v_mfma_f32_16x16x32_bf16 v[16:19], v[108:111], v[44:47], v[16:19]
  v_mfma_f32_16x16x32_bf16 v[20:23], v[112:115], v[44:47], v[20:23]
  v_mfma_f32_16x16x32_bf16 v[24:27], v[116:119], v[44:47], v[24:27]
  s_waitcnt vmcnt(0)
  s_barrier
  ds_read_b128 v[80:83], v1 offset:20480
  ds_read_b128 v[84:87], v1 offset:21504
  ds_read_b128 v[88:91], v1 offset:22528
  ds_read_b128 v[92:95], v1 offset:23552
  ds_read_b128 v[96:99], v1 offset:24576
  ds_read_b128 v[100:103], v1 offset:25600
  ds_read_b128 v[104:107], v1 offset:26624
  ds_read_b128 v[108:111], v1 offset:27648
  ds_read_b128 v[112:115], v1 offset:28672
  ds_read_b128 v[116:119], v1 offset:29696
  s_waitcnt lgkmcnt(5)
  v_mfma_f32_16x16x32_bf16 v[8:11], v[80:83], v[48:51], v[8:11]
  v_mfma_f32_16x16x32_bf16 v[12:15], v[84:87], v[48:51], v[12:15]
  v_mfma_f32_16x16x32_bf16 v[16:19], v[88:91], v[48:51], v[16:19]
  v_mfma_f32_16x16x32_bf16 v[20:23], v[92:95], v[48:51], v[20:23]
  v_mfma_f32_16x16x32_bf16 v[24:27], v[96:99], v[48:51], v[24:27]
  ds_read_b128 v[80:83], v1 offset:30720
  ds_read_b128 v[84:87], v1 offset:31744
  ds_read_b128 v[88:91], v1 offset:32768
  ds_read_b128 v[92:95], v1 offset:33792
  ds_read_b128 v[96:99], v1 offset:34816
  s_waitcnt lgkmcnt(5)
  v_mfma_f32_16x16x32_bf16 v[8:11], v[100:103], v[52:55], v[8:11]
  v_mfma_f32_16x16x32_bf16 v[12:15], v[104:107], v[52:55], v[12:15]
  v_mfma_f32_16x16x32_bf16 v[16:19], v[108:111], v[52:55], v[16:19]
  v_mfma_f32_16x16x32_bf16 v[20:23], v[112:115], v[52:55], v[20:23]
  v_mfma_f32_16x16x32_bf16 v[24:27], v[116:119], v[52:55], v[24:27]
  ds_read_b128 v[100:103], v1 offset:35840
  ds_read_b128 v[104:107], v1 offset:36864
  ds_read_b128 v[108:111], v1 offset:37888
  ds_read_b128 v[112:115], v1 offset:38912
  ds_read_b128 v[116:119], v1 offset:39936
  s_waitcnt lgkmcnt(5)
  v_mfma_f32_16x16x32_bf16 v[8:11], v[80:83], v[56:59], v[8:11]
  v_mfma_f32_16x16x32_bf16 v[12:15], v[84:87], v[56:59], v[12:15]
  v_mfma_f32_16x16x32_bf16 v[16:19], v[88:91], v[56:59], v[16:19]
  v_mfma_f32_16x16x32_bf16 v[20:23], v[92:95], v[56:59], v[20:23]
  v_mfma_f32_16x16x32_bf16 v[24:27], v[96:99], v[56:59], v[24:27]
  s_waitcnt lgkmcnt(0)
  v_mfma_f32_16x16x32_bf16 v[8:11], v[100:103], v[60:63], v[8:11]
  v_mfma_f32_16x16x32_bf16 v[12:15], v[104:107], v[60:63], v[12:15]
  v_mfma_f32_16x16x32_bf16 v[16:19], v[108:111], v[60:63], v[16:19]
  v_mfma_f32_16x16x32_bf16 v[20:23], v[112:115], v[60:63], v[20:23]
  v_mfma_f32_16x16x32_bf16 v[24:27], v[116:119], v[60:63], v[24:27]
  v_and_b32 v3, 63, v0
  v_and_b32 v4, 15, v3
  v_lshrrev_b32 v3, 4, v3
  s_lshl_b32 s21, s17, 6
  s_lshl_b32 s23, s16, 4
  s_add_u32 s21, s21, s23
  v_add_u32 v4, s21, v4
  v_mul_u32_u24 v6, 1280, v4
  v_lshl_add_u32 v6, v3, 4, v6
  s_mul_i32 s21, s18, 5
  s_add_u32 s23, s21, 0
  s_lshr_b32 s31, s23, 1
  s_lshl_b32 s31, s31, 6
  s_and_b32 s23, s23, 1
  s_lshl_b32 s23, s23, 3
  s_add_u32 s32, s31, s23
  s_add_u32 s40, s32, s20
  buffer_load_dwordx2 v[32:33], v6, s[8:11], s40 offen
  s_add_u32 s23, s21, 1
  s_lshr_b32 s31, s23, 1
  s_lshl_b32 s31, s31, 6
  s_and_b32 s23, s23, 1
  s_lshl_b32 s23, s23, 3
  s_add_u32 s33, s31, s23
  s_add_u32 s41, s33, s20
  buffer_load_dwordx2 v[34:35], v6, s[8:11], s41 offen
  s_add_u32 s23, s21, 2
  s_lshr_b32 s31, s23, 1
  s_lshl_b32 s31, s31, 6
  s_and_b32 s23, s23, 1
  s_lshl_b32 s23, s23, 3
  s_add_u32 s34, s31, s23
  s_add_u32 s42, s34, s20
  buffer_load_dwordx2 v[36:37], v6, s[8:11], s42 offen
  s_add_u32 s23, s21, 3
  s_lshr_b32 s31, s23, 1
  s_lshl_b32 s31, s31, 6
  s_and_b32 s23, s23, 1
  s_lshl_b32 s23, s23, 3
  s_add_u32 s35, s31, s23
  s_add_u32 s43, s35, s20
  buffer_load_dwordx2 v[38:39], v6, s[8:11], s43 offen
  s_add_u32 s23, s21, 4
  s_lshr_b32 s31, s23, 1
  s_lshl_b32 s31, s31, 6
  s_and_b32 s23, s23, 1
  s_lshl_b32 s23, s23, 3
  s_add_u32 s36, s31, s23
  s_add_u32 s44, s36, s20
  buffer_load_dwordx2 v[40:41], v6, s[8:11], s44 offen
  s_waitcnt vmcnt(0)
  v_cvt_pk_bf16_f32 v80, v8, v9
  v_cvt_pk_bf16_f32 v81, v10, v11
  v_lshlrev_b32 v8, 16, v80
  v_and_b32 v9, 0xffff0000, v80
  v_lshlrev_b32 v10, 16, v81
  v_and_b32 v11, 0xffff0000, v81
  v_lshlrev_b32 v82, 16, v32
  v_and_b32 v83, 0xffff0000, v32
  v_lshlrev_b32 v84, 16, v33
  v_and_b32 v85, 0xffff0000, v33
  v_add_f32 v8, v8, v82
  v_add_f32 v9, v9, v83
  v_add_f32 v10, v10, v84
  v_add_f32 v11, v11, v85
  v_cvt_pk_bf16_f32 v32, v8, v9
  v_cvt_pk_bf16_f32 v33, v10, v11
  s_add_u32 s23, s32, 150994944
  buffer_store_dwordx2 v[32:33], v6, s[4:7], s23 offen
  v_cvt_pk_bf16_f32 v80, v12, v13
  v_cvt_pk_bf16_f32 v81, v14, v15
  v_lshlrev_b32 v12, 16, v80
  v_and_b32 v13, 0xffff0000, v80
  v_lshlrev_b32 v14, 16, v81
  v_and_b32 v15, 0xffff0000, v81
  v_lshlrev_b32 v82, 16, v34
  v_and_b32 v83, 0xffff0000, v34
  v_lshlrev_b32 v84, 16, v35
  v_and_b32 v85, 0xffff0000, v35
  v_add_f32 v12, v12, v82
  v_add_f32 v13, v13, v83
  v_add_f32 v14, v14, v84
  v_add_f32 v15, v15, v85
  v_cvt_pk_bf16_f32 v34, v12, v13
  v_cvt_pk_bf16_f32 v35, v14, v15
  s_add_u32 s23, s33, 150994944
  buffer_store_dwordx2 v[34:35], v6, s[4:7], s23 offen
  v_cvt_pk_bf16_f32 v80, v16, v17
  v_cvt_pk_bf16_f32 v81, v18, v19
  v_lshlrev_b32 v16, 16, v80
  v_and_b32 v17, 0xffff0000, v80
  v_lshlrev_b32 v18, 16, v81
  v_and_b32 v19, 0xffff0000, v81
  v_lshlrev_b32 v82, 16, v36
  v_and_b32 v83, 0xffff0000, v36
  v_lshlrev_b32 v84, 16, v37
  v_and_b32 v85, 0xffff0000, v37
  v_add_f32 v16, v16, v82
  v_add_f32 v17, v17, v83
  v_add_f32 v18, v18, v84
  v_add_f32 v19, v19, v85
  v_cvt_pk_bf16_f32 v36, v16, v17
  v_cvt_pk_bf16_f32 v37, v18, v19
  s_add_u32 s23, s34, 150994944
  buffer_store_dwordx2 v[36:37], v6, s[4:7], s23 offen
  v_cvt_pk_bf16_f32 v80, v20, v21
  v_cvt_pk_bf16_f32 v81, v22, v23
  v_lshlrev_b32 v20, 16, v80
  v_and_b32 v21, 0xffff0000, v80
  v_lshlrev_b32 v22, 16, v81
  v_and_b32 v23, 0xffff0000, v81
  v_lshlrev_b32 v82, 16, v38
  v_and_b32 v83, 0xffff0000, v38
  v_lshlrev_b32 v84, 16, v39
  v_and_b32 v85, 0xffff0000, v39
  v_add_f32 v20, v20, v82
  v_add_f32 v21, v21, v83
  v_add_f32 v22, v22, v84
  v_add_f32 v23, v23, v85
  v_cvt_pk_bf16_f32 v38, v20, v21
  v_cvt_pk_bf16_f32 v39, v22, v23
  s_add_u32 s23, s35, 150994944
  buffer_store_dwordx2 v[38:39], v6, s[4:7], s23 offen
  v_cvt_pk_bf16_f32 v80, v24, v25
  v_cvt_pk_bf16_f32 v81, v26, v27
  v_lshlrev_b32 v24, 16, v80
  v_and_b32 v25, 0xffff0000, v80
  v_lshlrev_b32 v26, 16, v81
  v_and_b32 v27, 0xffff0000, v81
  v_lshlrev_b32 v82, 16, v40
  v_and_b32 v83, 0xffff0000, v40
  v_lshlrev_b32 v84, 16, v41
  v_and_b32 v85, 0xffff0000, v41
  v_add_f32 v24, v24, v82
  v_add_f32 v25, v25, v83
  v_add_f32 v26, v26, v84
  v_add_f32 v27, v27, v85
  v_cvt_pk_bf16_f32 v40, v24, v25
  v_cvt_pk_bf16_f32 v41, v26, v27
  s_add_u32 s23, s36, 150994944
  buffer_store_dwordx2 v[40:41], v6, s[4:7], s23 offen
outb1_exit1:
  s_endpgm
.globl outb2_kernel
.p2align 8
.type outb2_kernel,@function
outb2_kernel:
  s_cmp_ge_u32 s2, 256
  s_cbranch_scc1 outb2_exit1
  s_load_dwordx2 s[12:13], s[0:1], 96
  s_load_dwordx2 s[14:15], s[0:1], 0
  s_load_dwordx2 s[48:49], s[0:1], 80
  v_lshrrev_b32 v3, 6, v0
  v_and_b32 v4, 63, v0
  s_nop 0
  v_readfirstlane_b32 s16, v3
  v_lshlrev_b32 v1, 4, v4
  s_and_b32 s17, s2, 7
  s_lshl_b32 s17, s17, 2
  s_lshr_b32 s18, s2, 3
  s_and_b32 s19, s18, 3
  s_add_u32 s17, s17, s19
  s_lshr_b32 s18, s18, 2
  s_waitcnt lgkmcnt(0)
  s_mov_b32 s4, s12
  s_mov_b32 s5, s13
  s_mov_b32 s6, 0x10000000
  s_mov_b32 s7, 0x20000
  s_mov_b32 s8, s12
  s_mov_b32 s9, s13
  s_mov_b32 s10, 0x10000000
  s_mov_b32 s11, 0x20000
  s_mov_b32 s20, 150994944
  s_mov_b32 s52, s48
  s_mov_b32 s53, s49
  s_mov_b32 s54, 2621440
  s_mov_b32 s55, 0x20000
  s_mul_i32 s21, s18, 5
  s_mul_i32 s21, s21, 32768
  s_add_u32 s24, s21, 160169984
  s_add_u32 s25, s24, 32768
  s_add_u32 s26, s25, 32768
  s_add_u32 s27, s26, 32768
  s_add_u32 s28, s27, 32768
  s_lshl_b32 s21, s17, 2
  s_add_u32 s21, s21, s16
  s_mul_i32 s22, s21, 32768
  s_add_u32 s22, s22, 174063616
  s_lshl_b32 s23, s16, 10
  v_add_u32 v2, s23, v1
  s_mul_i32 s29, s16, 5120
  s_add_u32 m0, s29, 0
  s_nop 0
  buffer_load_dwordx4 v2, s[4:7], s24 offen lds
  s_add_u32 m0, s29, 1024
  s_nop 0
  buffer_load_dwordx4 v2, s[4:7], s25 offen lds
  s_add_u32 m0, s29, 2048
  s_nop 0
  buffer_load_dwordx4 v2, s[4:7], s26 offen lds
  s_add_u32 m0, s29, 3072
  s_nop 0
  buffer_load_dwordx4 v2, s[4:7], s27 offen lds
  s_add_u32 m0, s29, 4096
  s_nop 0
  buffer_load_dwordx4 v2, s[4:7], s28 offen lds
  buffer_load_dwordx4 v[32:35], v1, s[4:7], s22 offen offset:0
  buffer_load_dwordx4 v[36:39], v1, s[4:7], s22 offen offset:1024
  buffer_load_dwordx4 v[40:43], v1, s[4:7], s22 offen offset:2048
  buffer_load_dwordx4 v[44:47], v1, s[4:7], s22 offen offset:3072
  v_add_u32 v2, 0x1000, v2
  s_add_u32 s22, s22, 4096
  s_add_u32 m0, s29, 20480
  s_nop 0
  buffer_load_dwordx4 v2, s[4:7], s24 offen lds
  s_add_u32 m0, s29, 21504
  s_nop 0
  buffer_load_dwordx4 v2, s[4:7], s25 offen lds
  s_add_u32 m0, s29, 22528
  s_nop 0
  buffer_load_dwordx4 v2, s[4:7], s26 offen lds
  s_add_u32 m0, s29, 23552
  s_nop 0
  buffer_load_dwordx4 v2, s[4:7], s27 offen lds
  s_add_u32 m0, s29, 24576
  s_nop 0
  buffer_load_dwordx4 v2, s[4:7], s28 offen lds
  buffer_load_dwordx4 v[48:51], v1, s[4:7], s22 offen offset:0
  buffer_load_dwordx4 v[52:55], v1, s[4:7], s22 offen offset:1024
  buffer_load_dwordx4 v[56:59], v1, s[4:7], s22 offen offset:2048
  buffer_load_dwordx4 v[60:63], v1, s[4:7], s22 offen offset:3072
  v_add_u32 v2, 0x1000, v2
  s_add_u32 s22, s22, 4096
  s_waitcnt vmcnt(9)
  s_barrier
  s_add_u32 m0, s29, 40960
  s_nop 0
  buffer_load_dwordx4 v2, s[4:7], s24 offen lds
  s_add_u32 m0, s29, 41984
  s_nop 0
  buffer_load_dwordx4 v2, s[4:7], s25 offen lds
  s_add_u32 m0, s29, 43008
  s_nop 0
  buffer_load_dwordx4 v2, s[4:7], s26 offen lds
  s_add_u32 m0, s29, 44032
  s_nop 0
  buffer_load_dwordx4 v2, s[4:7], s27 offen lds
  s_add_u32 m0, s29, 45056
  s_nop 0
  buffer_load_dwordx4 v2, s[4:7], s28 offen lds
  buffer_load_dwordx4 v[64:67], v1, s[4:7], s22 offen offset:0
  buffer_load_dwordx4 v[68:71], v1, s[4:7], s22 offen offset:1024
  buffer_load_dwordx4 v[72:75], v1, s[4:7], s22 offen offset:2048
  buffer_load_dwordx4 v[76:79], v1, s[4:7], s22 offen offset:3072
  v_add_u32 v2, 0x1000, v2
  s_add_u32 s22, s22, 4096
  ds_read_b128 v[80:83], v1 offset:0
  ds_read_b128 v[84:87], v1 offset:1024
  ds_read_b128 v[88:91], v1 offset:2048
  ds_read_b128 v[92:95], v1 offset:3072
  ds_read_b128 v[96:99], v1 offset:4096
  ds_read_b128 v[100:103], v1 offset:5120
  ds_read_b128 v[104:107], v1 offset:6144
  ds_read_b128 v[108:111], v1 offset:7168
  ds_read_b128 v[112:115], v1 offset:8192
  ds_read_b128 v[116:119], v1 offset:9216
  s_waitcnt lgkmcnt(5)
  v_mfma_f32_16x16x32_bf16 v[8:11], v[80:83], v[32:35], 0
  v_mfma_f32_16x16x32_bf16 v[12:15], v[84:87], v[32:35], 0
  v_mfma_f32_16x16x32_bf16 v[16:19], v[88:91], v[32:35], 0
  v_mfma_f32_16x16x32_bf16 v[20:23], v[92:95], v[32:35], 0
  v_mfma_f32_16x16x32_bf16 v[24:27], v[96:99], v[32:35], 0
  ds_read_b128 v[80:83], v1 offset:10240
  ds_read_b128 v[84:87], v1 offset:11264
  ds_read_b128 v[88:91], v1 offset:12288
  ds_read_b128 v[92:95], v1 offset:13312
  ds_read_b128 v[96:99], v1 offset:14336
  s_waitcnt lgkmcnt(5)
  v_mfma_f32_16x16x32_bf16 v[8:11], v[100:103], v[36:39], v[8:11]
  v_mfma_f32_16x16x32_bf16 v[12:15], v[104:107], v[36:39], v[12:15]
  v_mfma_f32_16x16x32_bf16 v[16:19], v[108:111], v[36:39], v[16:19]
  v_mfma_f32_16x16x32_bf16 v[20:23], v[112:115], v[36:39], v[20:23]
  v_mfma_f32_16x16x32_bf16 v[24:27], v[116:119], v[36:39], v[24:27]
  ds_read_b128 v[100:103], v1 offset:15360
  ds_read_b128 v[104:107], v1 offset:16384
  ds_read_b128 v[108:111], v1 offset:17408
  ds_read_b128 v[112:115], v1 offset:18432
  ds_read_b128 v[116:119], v1 offset:19456
  s_waitcnt lgkmcnt(5)
  v_mfma_f32_16x16x32_bf16 v[8:11], v[80:83], v[40:43], v[8:11]
  v_mfma_f32_16x16x32_bf16 v[12:15], v[84:87], v[40:43], v[12:15]
  v_mfma_f32_16x16x32_bf16 v[16:19], v[88:91], v[40:43], v[16:19]
  v_mfma_f32_16x16x32_bf16 v[20:23], v[92:95], v[40:43], v[20:23]
  v_mfma_f32_16x16x32_bf16 v[24:27], v[96:99], v[40:43], v[24:27]
  s_waitcnt lgkmcnt(0)
  v_mfma_f32_16x16x32_bf16 v[8:11], v[100:103], v[44:47], v[8:11]
  v_mfma_f32_16x16x32_bf16 v[12:15], v[104:107], v[44:47], v[12:15]
  v_mfma_f32_16x16x32_bf16 v[16:19], v[108:111], v[44:47], v[16:19]
  v_mfma_f32_16x16x32_bf16 v[20:23], v[112:115], v[44:47], v[20:23]
  v_mfma_f32_16x16x32_bf16 v[24:27], v[116:119], v[44:47], v[24:27]
  s_mov_b32 s30, 0
outb2_loop2:
  s_waitcnt vmcnt(9)
  s_barrier
  s_add_u32 m0, s29, 0
  s_nop 0
  buffer_load_dwordx4 v2, s[4:7], s24 offen lds
  s_add_u32 m0, s29, 1024
  s_nop 0
  buffer_load_dwordx4 v2, s[4:7], s25 offen lds
  s_add_u32 m0, s29, 2048
  s_nop 0
  buffer_load_dwordx4 v2, s[4:7], s26 offen lds
  s_add_u32 m0, s29, 3072
  s_nop 0
  buffer_load_dwordx4 v2, s[4:7], s27 offen lds
  s_add_u32 m0, s29, 4096
  s_nop 0
  buffer_load_dwordx4 v2, s[4:7], s28 offen lds
  buffer_load_dwordx4 v[32:35], v1, s[4:7], s22 offen offset:0
  buffer_load_dwordx4 v[36:39], v1, s[4:7], s22 offen offset:1024
  buffer_load_dwordx4 v[40:43], v1, s[4:7], s22 offen offset:2048
  buffer_load_dwordx4 v[44:47], v1, s[4:7], s22 offen offset:3072
  v_add_u32 v2, 0x1000, v2
  s_add_u32 s22, s22, 4096
  ds_read_b128 v[80:83], v1 offset:20480
  ds_read_b128 v[84:87], v1 offset:21504
  ds_read_b128 v[88:91], v1 offset:22528
  ds_read_b128 v[92:95], v1 offset:23552
  ds_read_b128 v[96:99], v1 offset:24576
  ds_read_b128 v[100:103], v1 offset:25600
  ds_read_b128 v[104:107], v1 offset:26624
  ds_read_b128 v[108:111], v1 offset:27648
  ds_read_b128 v[112:115], v1 offset:28672
  ds_read_b128 v[116:119], v1 offset:29696
  s_waitcnt lgkmcnt(5)
  v_mfma_f32_16x16x32_bf16 v[8:11], v[80:83], v[48:51], v[8:11]
  v_mfma_f32_16x16x32_bf16 v[12:15], v[84:87], v[48:51], v[12:15]
  v_mfma_f32_16x16x32_bf16 v[16:19], v[88:91], v[48:51], v[16:19]
  v_mfma_f32_16x16x32_bf16 v[20:23], v[92:95], v[48:51], v[20:23]
  v_mfma_f32_16x16x32_bf16 v[24:27], v[96:99], v[48:51], v[24:27]
  ds_read_b128 v[80:83], v1 offset:30720
  ds_read_b128 v[84:87], v1 offset:31744
  ds_read_b128 v[88:91], v1 offset:32768
  ds_read_b128 v[92:95], v1 offset:33792
  ds_read_b128 v[96:99], v1 offset:34816
  s_waitcnt lgkmcnt(5)
  v_mfma_f32_16x16x32_bf16 v[8:11], v[100:103], v[52:55], v[8:11]
  v_mfma_f32_16x16x32_bf16 v[12:15], v[104:107], v[52:55], v[12:15]
  v_mfma_f32_16x16x32_bf16 v[16:19], v[108:111], v[52:55], v[16:19]
  v_mfma_f32_16x16x32_bf16 v[20:23], v[112:115], v[52:55], v[20:23]
  v_mfma_f32_16x16x32_bf16 v[24:27], v[116:119], v[52:55], v[24:27]
  ds_read_b128 v[100:103], v1 offset:35840
  ds_read_b128 v[104:107], v1 offset:36864
  ds_read_b128 v[108:111], v1 offset:37888
  ds_read_b128 v[112:115], v1 offset:38912
  ds_read_b128 v[116:119], v1 offset:39936
  s_waitcnt lgkmcnt(5)
  v_mfma_f32_16x16x32_bf16 v[8:11], v[80:83], v[56:59], v[8:11]
  v_mfma_f32_16x16x32_bf16 v[12:15], v[84:87], v[56:59], v[12:15]
  v_mfma_f32_16x16x32_bf16 v[16:19], v[88:91], v[56:59], v[16:19]
  v_mfma_f32_16x16x32_bf16 v[20:23], v[92:95], v[56:59], v[20:23]
  v_mfma_f32_16x16x32_bf16 v[24:27], v[96:99], v[56:59], v[24:27]
  s_waitcnt lgkmcnt(0)
  v_mfma_f32_16x16x32_bf16 v[8:11], v[100:103], v[60:63], v[8:11]
  v_mfma_f32_16x16x32_bf16 v[12:15], v[104:107], v[60:63], v[12:15]
  v_mfma_f32_16x16x32_bf16 v[16:19], v[108:111], v[60:63], v[16:19]
  v_mfma_f32_16x16x32_bf16 v[20:23], v[112:115], v[60:63], v[20:23]
  v_mfma_f32_16x16x32_bf16 v[24:27], v[116:119], v[60:63], v[24:27]
  s_waitcnt vmcnt(9)
  s_barrier
  s_add_u32 m0, s29, 20480
  s_nop 0
  buffer_load_dwordx4 v2, s[4:7], s24 offen lds
  s_add_u32 m0, s29, 21504
  s_nop 0
  buffer_load_dwordx4 v2, s[4:7], s25 offen lds
  s_add_u32 m0, s29, 22528
  s_nop 0
  buffer_load_dwordx4 v2, s[4:7], s26 offen lds
  s_add_u32 m0, s29, 23552
  s_nop 0
  buffer_load_dwordx4 v2, s[4:7], s27 offen lds
  s_add_u32 m0, s29, 24576
  s_nop 0
  buffer_load_dwordx4 v2, s[4:7], s28 offen lds
  buffer_load_dwordx4 v[48:51], v1, s[4:7], s22 offen offset:0
  buffer_load_dwordx4 v[52:55], v1, s[4:7], s22 offen offset:1024
  buffer_load_dwordx4 v[56:59], v1, s[4:7], s22 offen offset:2048
  buffer_load_dwordx4 v[60:63], v1, s[4:7], s22 offen offset:3072
  v_add_u32 v2, 0x1000, v2
  s_add_u32 s22, s22, 4096
  ds_read_b128 v[80:83], v1 offset:40960
  ds_read_b128 v[84:87], v1 offset:41984
  ds_read_b128 v[88:91], v1 offset:43008
  ds_read_b128 v[92:95], v1 offset:44032
  ds_read_b128 v[96:99], v1 offset:45056
  ds_read_b128 v[100:103], v1 offset:46080
  ds_read_b128 v[104:107], v1 offset:47104
  ds_read_b128 v[108:111], v1 offset:48128
  ds_read_b128 v[112:115], v1 offset:49152
  ds_read_b128 v[116:119], v1 offset:50176
  s_waitcnt lgkmcnt(5)
  v_mfma_f32_16x16x32_bf16 v[8:11], v[80:83], v[64:67], v[8:11]
  v_mfma_f32_16x16x32_bf16 v[12:15], v[84:87], v[64:67], v[12:15]
  v_mfma_f32_16x16x32_bf16 v[16:19], v[88:91], v[64:67], v[16:19]
  v_mfma_f32_16x16x32_bf16 v[20:23], v[92:95], v[64:67], v[20:23]
  v_mfma_f32_16x16x32_bf16 v[24:27], v[96:99], v[64:67], v[24:27]
  ds_read_b128 v[80:83], v1 offset:51200
  ds_read_b128 v[84:87], v1 offset:52224
  ds_read_b128 v[88:91], v1 offset:53248
  ds_read_b128 v[92:95], v1 offset:54272
  ds_read_b128 v[96:99], v1 offset:55296
  s_waitcnt lgkmcnt(5)
  v_mfma_f32_16x16x32_bf16 v[8:11], v[100:103], v[68:71], v[8:11]
  v_mfma_f32_16x16x32_bf16 v[12:15], v[104:107], v[68:71], v[12:15]
  v_mfma_f32_16x16x32_bf16 v[16:19], v[108:111], v[68:71], v[16:19]
  v_mfma_f32_16x16x32_bf16 v[20:23], v[112:115], v[68:71], v[20:23]
  v_mfma_f32_16x16x32_bf16 v[24:27], v[116:119], v[68:71], v[24:27]
  ds_read_b128 v[100:103], v1 offset:56320
  ds_read_b128 v[104:107], v1 offset:57344
  ds_read_b128 v[108:111], v1 offset:58368
  ds_read_b128 v[112:115], v1 offset:59392
  ds_read_b128 v[116:119], v1 offset:60416
  s_waitcnt lgkmcnt(5)
  v_mfma_f32_16x16x32_bf16 v[8:11], v[80:83], v[72:75], v[8:11]
  v_mfma_f32_16x16x32_bf16 v[12:15], v[84:87], v[72:75], v[12:15]
  v_mfma_f32_16x16x32_bf16 v[16:19], v[88:91], v[72:75], v[16:19]
  v_mfma_f32_16x16x32_bf16 v[20:23], v[92:95], v[72:75], v[20:23]
  v_mfma_f32_16x16x32_bf16 v[24:27], v[96:99], v[72:75], v[24:27]
  s_waitcnt lgkmcnt(0)
  v_mfma_f32_16x16x32_bf16 v[8:11], v[100:103], v[76:79], v[8:11]
  v_mfma_f32_16x16x32_bf16 v[12:15], v[104:107], v[76:79], v[12:15]
  v_mfma_f32_16x16x32_bf16 v[16:19], v[108:111], v[76:79], v[16:19]
  v_mfma_f32_16x16x32_bf16 v[20:23], v[112:115], v[76:79], v[20:23]
  v_mfma_f32_16x16x32_bf16 v[24:27], v[116:119], v[76:79], v[24:27]
  s_waitcnt vmcnt(9)
  s_barrier
  s_add_u32 m0, s29, 40960
  s_nop 0
  buffer_load_dwordx4 v2, s[4:7], s24 offen lds
  s_add_u32 m0, s29, 41984
  s_nop 0
  buffer_load_dwordx4 v2, s[4:7], s25 offen lds
  s_add_u32 m0, s29, 43008
  s_nop 0
  buffer_load_dwordx4 v2, s[4:7], s26 offen lds
  s_add_u32 m0, s29, 44032
  s_nop 0
  buffer_load_dwordx4 v2, s[4:7], s27 offen lds
  s_add_u32 m0, s29, 45056
  s_nop 0
  buffer_load_dwordx4 v2, s[4:7], s28 offen lds
  buffer_load_dwordx4 v[64:67], v1, s[4:7], s22 offen offset:0
  buffer_load_dwordx4 v[68:71], v1, s[4:7], s22 offen offset:1024
  buffer_load_dwordx4 v[72:75], v1, s[4:7], s22 offen offset:2048
  buffer_load_dwordx4 v[76:79], v1, s[4:7], s22 offen offset:3072
  v_add_u32 v2, 0x1000, v2
  s_add_u32 s22, s22, 4096
  ds_read_b128 v[80:83], v1 offset:0
  ds_read_b128 v[84:87], v1 offset:1024
  ds_read_b128 v[88:91], v1 offset:2048
  ds_read_b128 v[92:95], v1 offset:3072
  ds_read_b128 v[96:99], v1 offset:4096
  ds_read_b128 v[100:103], v1 offset:5120
  ds_read_b128 v[104:107], v1 offset:6144
  ds_read_b128 v[108:111], v1 offset:7168
  ds_read_b128 v[112:115], v1 offset:8192
  ds_read_b128 v[116:119], v1 offset:9216
  s_waitcnt lgkmcnt(5)
  v_mfma_f32_16x16x32_bf16 v[8:11], v[80:83], v[32:35], v[8:11]
  v_mfma_f32_16x16x32_bf16 v[12:15], v[84:87], v[32:35], v[12:15]
  v_mfma_f32_16x16x32_bf16 v[16:19], v[88:91], v[32:35], v[16:19]
  v_mfma_f32_16x16x32_bf16 v[20:23], v[92:95], v[32:35], v[20:23]
  v_mfma_f32_16x16x32_bf16 v[24:27], v[96:99], v[32:35], v[24:27]
  ds_read_b128 v[80:83], v1 offset:10240
  ds_read_b128 v[84:87], v1 offset:11264
  ds_read_b128 v[88:91], v1 offset:12288
  ds_read_b128 v[92:95], v1 offset:13312
  ds_read_b128 v[96:99], v1 offset:14336
  s_waitcnt lgkmcnt(5)
  v_mfma_f32_16x16x32_bf16 v[8:11], v[100:103], v[36:39], v[8:11]
  v_mfma_f32_16x16x32_bf16 v[12:15], v[104:107], v[36:39], v[12:15]
  v_mfma_f32_16x16x32_bf16 v[16:19], v[108:111], v[36:39], v[16:19]
  v_mfma_f32_16x16x32_bf16 v[20:23], v[112:115], v[36:39], v[20:23]
  v_mfma_f32_16x16x32_bf16 v[24:27], v[116:119], v[36:39], v[24:27]
  ds_read_b128 v[100:103], v1 offset:15360
  ds_read_b128 v[104:107], v1 offset:16384
  ds_read_b128 v[108:111], v1 offset:17408
  ds_read_b128 v[112:115], v1 offset:18432
  ds_read_b128 v[116:119], v1 offset:19456
  s_waitcnt lgkmcnt(5)
  v_mfma_f32_16x16x32_bf16 v[8:11], v[80:83], v[40:43], v[8:11]
  v_mfma_f32_16x16x32_bf16 v[12:15], v[84:87], v[40:43], v[12:15]
  v_mfma_f32_16x16x32_bf16 v[16:19], v[88:91], v[40:43], v[16:19]
  v_mfma_f32_16x16x32_bf16 v[20:23], v[92:95], v[40:43], v[20:23]
  v_mfma_f32_16x16x32_bf16 v[24:27], v[96:99], v[40:43], v[24:27]
  s_waitcnt lgkmcnt(0)
  v_mfma_f32_16x16x32_bf16 v[8:11], v[100:103], v[44:47], v[8:11]
  v_mfma_f32_16x16x32_bf16 v[12:15], v[104:107], v[44:47], v[12:15]
  v_mfma_f32_16x16x32_bf16 v[16:19], v[108:111], v[44:47], v[16:19]
  v_mfma_f32_16x16x32_bf16 v[20:23], v[112:115], v[44:47], v[20:23]
  v_mfma_f32_16x16x32_bf16 v[24:27], v[116:119], v[44:47], v[24:27]
  s_add_u32 s30, s30, 1
  s_cmp_lt_u32 s30, 1
  s_cbranch_scc1 outb2_loop2
  s_waitcnt vmcnt(9)
  s_barrier
  s_add_u32 m0, s29, 0
  s_nop 0
  buffer_load_dwordx4 v2, s[4:7], s24 offen lds
  s_add_u32 m0, s29, 1024
  s_nop 0
  buffer_load_dwordx4 v2, s[4:7], s25 offen lds
  s_add_u32 m0, s29, 2048
  s_nop 0
  buffer_load_dwordx4 v2, s[4:7], s26 offen lds
  s_add_u32 m0, s29, 3072
  s_nop 0
  buffer_load_dwordx4 v2, s[4:7], s27 offen lds
  s_add_u32 m0, s29, 4096
  s_nop 0
  buffer_load_dwordx4 v2, s[4:7], s28 offen lds
  buffer_load_dwordx4 v[32:35], v1, s[4:7], s22 offen offset:0
  buffer_load_dwordx4 v[36:39], v1, s[4:7], s22 offen offset:1024
  buffer_load_dwordx4 v[40:43], v1, s[4:7], s22 offen offset:2048
  buffer_load_dwordx4 v[44:47], v1, s[4:7], s22 offen offset:3072
  v_add_u32 v2, 0x1000, v2
  s_add_u32 s22, s22, 4096
  ds_read_b128 v[80:83], v1 offset:20480
  ds_read_b128 v[84:87], v1 offset:21504
  ds_read_b128 v[88:91], v1 offset:22528
  ds_read_b128 v[92:95], v1 offset:23552
  ds_read_b128 v[96:99], v1 offset:24576
  ds_read_b128 v[100:103], v1 offset:25600
  ds_read_b128 v[104:107], v1 offset:26624
  ds_read_b128 v[108:111], v1 offset:27648
  ds_read_b128 v[112:115], v1 offset:28672
  ds_read_b128 v[116:119], v1 offset:29696
  s_waitcnt lgkmcnt(5)
  v_mfma_f32_16x16x32_bf16 v[8:11], v[80:83], v[48:51], v[8:11]
  v_mfma_f32_16x16x32_bf16 v[12:15], v[84:87], v[48:51], v[12:15]
  v_mfma_f32_16x16x32_bf16 v[16:19], v[88:91], v[48:51], v[16:19]
  v_mfma_f32_16x16x32_bf16 v[20:23], v[92:95], v[48:51], v[20:23]
  v_mfma_f32_16x16x32_bf16 v[24:27], v[96:99], v[48:51], v[24:27]
  ds_read_b128 v[80:83], v1 offset:30720
  ds_read_b128 v[84:87], v1 offset:31744
  ds_read_b128 v[88:91], v1 offset:32768
  ds_read_b128 v[92:95], v1 offset:33792
  ds_read_b128 v[96:99], v1 offset:34816
  s_waitcnt lgkmcnt(5)
  v_mfma_f32_16x16x32_bf16 v[8:11], v[100:103], v[52:55], v[8:11]
  v_mfma_f32_16x16x32_bf16 v[12:15], v[104:107], v[52:55], v[12:15]
  v_mfma_f32_16x16x32_bf16 v[16:19], v[108:111], v[52:55], v[16:19]
  v_mfma_f32_16x16x32_bf16 v[20:23], v[112:115], v[52:55], v[20:23]
  v_mfma_f32_16x16x32_bf16 v[24:27], v[116:119], v[52:55], v[24:27]
  ds_read_b128 v[100:103], v1 offset:35840
  ds_read_b128 v[104:107], v1 offset:36864
  ds_read_b128 v[108:111], v1 offset:37888
  ds_read_b128 v[112:115], v1 offset:38912
  ds_read_b128 v[116:119], v1 offset:39936
  s_waitcnt lgkmcnt(5)
  v_mfma_f32_16x16x32_bf16 v[8:11], v[80:83], v[56:59], v[8:11]
  v_mfma_f32_16x16x32_bf16 v[12:15], v[84:87], v[56:59], v[12:15]
  v_mfma_f32_16x16x32_bf16 v[16:19], v[88:91], v[56:59], v[16:19]
  v_mfma_f32_16x16x32_bf16 v[20:23], v[92:95], v[56:59], v[20:23]
  v_mfma_f32_16x16x32_bf16 v[24:27], v[96:99], v[56:59], v[24:27]
  s_waitcnt lgkmcnt(0)
  v_mfma_f32_16x16x32_bf16 v[8:11], v[100:103], v[60:63], v[8:11]
  v_mfma_f32_16x16x32_bf16 v[12:15], v[104:107], v[60:63], v[12:15]
  v_mfma_f32_16x16x32_bf16 v[16:19], v[108:111], v[60:63], v[16:19]
  v_mfma_f32_16x16x32_bf16 v[20:23], v[112:115], v[60:63], v[20:23]
  v_mfma_f32_16x16x32_bf16 v[24:27], v[116:119], v[60:63], v[24:27]
  s_waitcnt vmcnt(9)
  s_barrier
  s_add_u32 m0, s29, 20480
  s_nop 0
  buffer_load_dwordx4 v2, s[4:7], s24 offen lds
  s_add_u32 m0, s29, 21504
  s_nop 0
  buffer_load_dwordx4 v2, s[4:7], s25 offen lds
  s_add_u32 m0, s29, 22528
  s_nop 0
  buffer_load_dwordx4 v2, s[4:7], s26 offen lds
  s_add_u32 m0, s29, 23552
  s_nop 0
  buffer_load_dwordx4 v2, s[4:7], s27 offen lds
  s_add_u32 m0, s29, 24576
  s_nop 0
  buffer_load_dwordx4 v2, s[4:7], s28 offen lds
  buffer_load_dwordx4 v[48:51], v1, s[4:7], s22 offen offset:0
  buffer_load_dwordx4 v[52:55], v1, s[4:7], s22 offen offset:1024
  buffer_load_dwordx4 v[56:59], v1, s[4:7], s22 offen offset:2048
  buffer_load_dwordx4 v[60:63], v1, s[4:7], s22 offen offset:3072
  v_add_u32 v2, 0x1000, v2
  s_add_u32 s22, s22, 4096
  ds_read_b128 v[80:83], v1 offset:40960
  ds_read_b128 v[84:87], v1 offset:41984
  ds_read_b128 v[88:91], v1 offset:43008
  ds_read_b128 v[92:95], v1 offset:44032
  ds_read_b128 v[96:99], v1 offset:45056
  ds_read_b128 v[100:103], v1 offset:46080
  ds_read_b128 v[104:107], v1 offset:47104
  ds_read_b128 v[108:111], v1 offset:48128
  ds_read_b128 v[112:115], v1 offset:49152
  ds_read_b128 v[116:119], v1 offset:50176
  s_waitcnt lgkmcnt(5)
  v_mfma_f32_16x16x32_bf16 v[8:11], v[80:83], v[64:67], v[8:11]
  v_mfma_f32_16x16x32_bf16 v[12:15], v[84:87], v[64:67], v[12:15]
  v_mfma_f32_16x16x32_bf16 v[16:19], v[88:91], v[64:67], v[16:19]
  v_mfma_f32_16x16x32_bf16 v[20:23], v[92:95], v[64:67], v[20:23]
  v_mfma_f32_16x16x32_bf16 v[24:27], v[96:99], v[64:67], v[24:27]
  ds_read_b128 v[80:83], v1 offset:51200
  ds_read_b128 v[84:87], v1 offset:52224
  ds_read_b128 v[88:91], v1 offset:53248
  ds_read_b128 v[92:95], v1 offset:54272
  ds_read_b128 v[96:99], v1 offset:55296
  s_waitcnt lgkmcnt(5)
  v_mfma_f32_16x16x32_bf16 v[8:11], v[100:103], v[68:71], v[8:11]
  v_mfma_f32_16x16x32_bf16 v[12:15], v[104:107], v[68:71], v[12:15]
  v_mfma_f32_16x16x32_bf16 v[16:19], v[108:111], v[68:71], v[16:19]
  v_mfma_f32_16x16x32_bf16 v[20:23], v[112:115], v[68:71], v[20:23]
  v_mfma_f32_16x16x32_bf16 v[24:27], v[116:119], v[68:71], v[24:27]
  ds_read_b128 v[100:103], v1 offset:56320
  ds_read_b128 v[104:107], v1 offset:57344
  ds_read_b128 v[108:111], v1 offset:58368
  ds_read_b128 v[112:115], v1 offset:59392
  ds_read_b128 v[116:119], v1 offset:60416
  s_waitcnt lgkmcnt(5)
  v_mfma_f32_16x16x32_bf16 v[8:11], v[80:83], v[72:75], v[8:11]
  v_mfma_f32_16x16x32_bf16 v[12:15], v[84:87], v[72:75], v[12:15]
  v_mfma_f32_16x16x32_bf16 v[16:19], v[88:91], v[72:75], v[16:19]
  v_mfma_f32_16x16x32_bf16 v[20:23], v[92:95], v[72:75], v[20:23]
  v_mfma_f32_16x16x32_bf16 v[24:27], v[96:99], v[72:75], v[24:27]
  s_waitcnt lgkmcnt(0)
  v_mfma_f32_16x16x32_bf16 v[8:11], v[100:103], v[76:79], v[8:11]
  v_mfma_f32_16x16x32_bf16 v[12:15], v[104:107], v[76:79], v[12:15]
  v_mfma_f32_16x16x32_bf16 v[16:19], v[108:111], v[76:79], v[16:19]
  v_mfma_f32_16x16x32_bf16 v[20:23], v[112:115], v[76:79], v[20:23]
  v_mfma_f32_16x16x32_bf16 v[24:27], v[116:119], v[76:79], v[24:27]
  s_waitcnt vmcnt(9)
  s_barrier
  ds_read_b128 v[80:83], v1 offset:0
  ds_read_b128 v[84:87], v1 offset:1024
  ds_read_b128 v[88:91], v1 offset:2048
  ds_read_b128 v[92:95], v1 offset:3072
  ds_read_b128 v[96:99], v1 offset:4096
  ds_read_b128 v[100:103], v1 offset:5120
  ds_read_b128 v[104:107], v1 offset:6144
  ds_read_b128 v[108:111], v1 offset:7168
  ds_read_b128 v[112:115], v1 offset:8192
  ds_read_b128 v[116:119], v1 offset:9216
  s_waitcnt lgkmcnt(5)
  v_mfma_f32_16x16x32_bf16 v[8:11], v[80:83], v[32:35], v[8:11]
  v_mfma_f32_16x16x32_bf16 v[12:15], v[84:87], v[32:35], v[12:15]
  v_mfma_f32_16x16x32_bf16 v[16:19], v[88:91], v[32:35], v[16:19]
  v_mfma_f32_16x16x32_bf16 v[20:23], v[92:95], v[32:35], v[20:23]
  v_mfma_f32_16x16x32_bf16 v[24:27], v[96:99], v[32:35], v[24:27]
  ds_read_b128 v[80:83], v1 offset:10240
  ds_read_b128 v[84:87], v1 offset:11264
  ds_read_b128 v[88:91], v1 offset:12288
  ds_read_b128 v[92:95], v1 offset:13312
  ds_read_b128 v[96:99], v1 offset:14336
  s_waitcnt lgkmcnt(5)
  v_mfma_f32_16x16x32_bf16 v[8:11], v[100:103], v[36:39], v[8:11]
  v_mfma_f32_16x16x32_bf16 v[12:15], v[104:107], v[36:39], v[12:15]
  v_mfma_f32_16x16x32_bf16 v[16:19], v[108:111], v[36:39], v[16:19]
  v_mfma_f32_16x16x32_bf16 v[20:23], v[112:115], v[36:39], v[20:23]
  v_mfma_f32_16x16x32_bf16 v[24:27], v[116:119], v[36:39], v[24:27]
  ds_read_b128 v[100:103], v1 offset:15360
  ds_read_b128 v[104:107], v1 offset:16384
  ds_read_b128 v[108:111], v1 offset:17408
  ds_read_b128 v[112:115], v1 offset:18432
  ds_read_b128 v[116:119], v1 offset:19456
  s_waitcnt lgkmcnt(5)
  v_mfma_f32_16x16x32_bf16 v[8:11], v[80:83], v[40:43], v[8:11]
  v_mfma_f32_16x16x32_bf16 v[12:15], v[84:87], v[40:43], v[12:15]
  v_mfma_f32_16x16x32_bf16 v[16:19], v[88:91], v[40:43], v[16:19]
  v_mfma_f32_16x16x32_bf16 v[20:23], v[92:95], v[40:43], v[20:23]
  v_mfma_f32_16x16x32_bf16 v[24:27], v[96:99], v[40:43], v[24:27]
  s_waitcnt lgkmcnt(0)
  v_mfma_f32_16x16x32_bf16 v[8:11], v[100:103], v[44:47], v[8:11]
  v_mfma_f32_16x16x32_bf16 v[12:15], v[104:107], v[44:47], v[12:15]
  v_mfma_f32_16x16x32_bf16 v[16:19], v[108:111], v[44:47], v[16:19]
  v_mfma_f32_16x16x32_bf16 v[20:23], v[112:115], v[44:47], v[20:23]
  v_mfma_f32_16x16x32_bf16 v[24:27], v[116:119], v[44:47], v[24:27]
  s_waitcnt vmcnt(0)
  s_barrier
  ds_read_b128 v[80:83], v1 offset:20480
  ds_read_b128 v[84:87], v1 offset:21504
  ds_read_b128 v[88:91], v1 offset:22528
  ds_read_b128 v[92:95], v1 offset:23552
  ds_read_b128 v[96:99], v1 offset:24576
  ds_read_b128 v[100:103], v1 offset:25600
  ds_read_b128 v[104:107], v1 offset:26624
  ds_read_b128 v[108:111], v1 offset:27648
  ds_read_b128 v[112:115], v1 offset:28672
  ds_read_b128 v[116:119], v1 offset:29696
  s_waitcnt lgkmcnt(5)
  v_mfma_f32_16x16x32_bf16 v[8:11], v[80:83], v[48:51], v[8:11]
  v_mfma_f32_16x16x32_bf16 v[12:15], v[84:87], v[48:51], v[12:15]
  v_mfma_f32_16x16x32_bf16 v[16:19], v[88:91], v[48:51], v[16:19]
  v_mfma_f32_16x16x32_bf16 v[20:23], v[92:95], v[48:51], v[20:23]
  v_mfma_f32_16x16x32_bf16 v[24:27], v[96:99], v[48:51], v[24:27]
  ds_read_b128 v[80:83], v1 offset:30720
  ds_read_b128 v[84:87], v1 offset:31744
  ds_read_b128 v[88:91], v1 offset:32768
  ds_read_b128 v[92:95], v1 offset:33792
  ds_read_b128 v[96:99], v1 offset:34816
  s_waitcnt lgkmcnt(5)
  v_mfma_f32_16x16x32_bf16 v[8:11], v[100:103], v[52:55], v[8:11]
  v_mfma_f32_16x16x32_bf16 v[12:15], v[104:107], v[52:55], v[12:15]
  v_mfma_f32_16x16x32_bf16 v[16:19], v[108:111], v[52:55], v[16:19]
  v_mfma_f32_16x16x32_bf16 v[20:23], v[112:115], v[52:55], v[20:23]
  v_mfma_f32_16x16x32_bf16 v[24:27], v[116:119], v[52:55], v[24:27]
  ds_read_b128 v[100:103], v1 offset:35840
  ds_read_b128 v[104:107], v1 offset:36864
  ds_read_b128 v[108:111], v1 offset:37888
  ds_read_b128 v[112:115], v1 offset:38912
  ds_read_b128 v[116:119], v1 offset:39936
  s_waitcnt lgkmcnt(5)
  v_mfma_f32_16x16x32_bf16 v[8:11], v[80:83], v[56:59], v[8:11]
  v_mfma_f32_16x16x32_bf16 v[12:15], v[84:87], v[56:59], v[12:15]
  v_mfma_f32_16x16x32_bf16 v[16:19], v[88:91], v[56:59], v[16:19]
  v_mfma_f32_16x16x32_bf16 v[20:23], v[92:95], v[56:59], v[20:23]
  v_mfma_f32_16x16x32_bf16 v[24:27], v[96:99], v[56:59], v[24:27]
  s_waitcnt lgkmcnt(0)
  v_mfma_f32_16x16x32_bf16 v[8:11], v[100:103], v[60:63], v[8:11]
  v_mfma_f32_16x16x32_bf16 v[12:15], v[104:107], v[60:63], v[12:15]
  v_mfma_f32_16x16x32_bf16 v[16:19], v[108:111], v[60:63], v[16:19]
  v_mfma_f32_16x16x32_bf16 v[20:23], v[112:115], v[60:63], v[20:23]
  v_mfma_f32_16x16x32_bf16 v[24:27], v[116:119], v[60:63], v[24:27]
  v_and_b32 v3, 63, v0
  v_and_b32 v4, 15, v3
  v_lshrrev_b32 v3, 4, v3
  s_lshl_b32 s21, s17, 6
  s_lshl_b32 s23, s16, 4
  s_add_u32 s21, s21, s23
  v_add_u32 v4, s21, v4
  v_mul_u32_u24 v6, 1280, v4
  v_lshl_add_u32 v6, v3, 4, v6
  s_mul_i32 s21, s18, 5
  s_add_u32 s23, s21, 0
  s_lshr_b32 s31, s23, 1
  s_lshl_b32 s31, s31, 6
  s_and_b32 s23, s23, 1
  s_lshl_b32 s23, s23, 3
  s_add_u32 s32, s31, s23
  s_add_u32 s40, s32, s20
  buffer_load_dwordx2 v[32:33], v6, s[8:11], s40 offen
  s_add_u32 s23, s21, 1
  s_lshr_b32 s31, s23, 1
  s_lshl_b32 s31, s31, 6
  s_and_b32 s23, s23, 1
  s_lshl_b32 s23, s23, 3
  s_add_u32 s33, s31, s23
  s_add_u32 s41, s33, s20
  buffer_load_dwordx2 v[34:35], v6, s[8:11], s41 offen
  s_add_u32 s23, s21, 2
  s_lshr_b32 s31, s23, 1
  s_lshl_b32 s31, s31, 6
  s_and_b32 s23, s23, 1
  s_lshl_b32 s23, s23, 3
  s_add_u32 s34, s31, s23
  s_add_u32 s42, s34, s20
  buffer_load_dwordx2 v[36:37], v6, s[8:11], s42 offen
  s_add_u32 s23, s21, 3
  s_lshr_b32 s31, s23, 1
  s_lshl_b32 s31, s31, 6
  s_and_b32 s23, s23, 1
  s_lshl_b32 s23, s23, 3
  s_add_u32 s35, s31, s23
  s_add_u32 s43, s35, s20
  buffer_load_dwordx2 v[38:39], v6, s[8:11], s43 offen
  s_add_u32 s23, s21, 4
  s_lshr_b32 s31, s23, 1
  s_lshl_b32 s31, s31, 6
  s_and_b32 s23, s23, 1
  s_lshl_b32 s23, s23, 3
  s_add_u32 s36, s31, s23
  s_add_u32 s44, s36, s20
  buffer_load_dwordx2 v[40:41], v6, s[8:11], s44 offen
  s_waitcnt vmcnt(0)
  v_cvt_pk_bf16_f32 v80, v8, v9
  v_cvt_pk_bf16_f32 v81, v10, v11
  v_lshlrev_b32 v8, 16, v80
  v_and_b32 v9, 0xffff0000, v80
  v_lshlrev_b32 v10, 16, v81
  v_and_b32 v11, 0xffff0000, v81
  v_lshlrev_b32 v82, 16, v32
  v_and_b32 v83, 0xffff0000, v32
  v_lshlrev_b32 v84, 16, v33
  v_and_b32 v85, 0xffff0000, v33
  v_add_f32 v8, v8, v82
  v_add_f32 v9, v9, v83
  v_add_f32 v10, v10, v84
  v_add_f32 v11, v11, v85
  v_cvt_pk_bf16_f32 v32, v8, v9
  v_cvt_pk_bf16_f32 v33, v10, v11
  buffer_store_dwordx2 v[32:33], v6, s[52:55], s32 offen
  v_cvt_pk_bf16_f32 v80, v12, v13
  v_cvt_pk_bf16_f32 v81, v14, v15
  v_lshlrev_b32 v12, 16, v80
  v_and_b32 v13, 0xffff0000, v80
  v_lshlrev_b32 v14, 16, v81
  v_and_b32 v15, 0xffff0000, v81
  v_lshlrev_b32 v82, 16, v34
  v_and_b32 v83, 0xffff0000, v34
  v_lshlrev_b32 v84, 16, v35
  v_and_b32 v85, 0xffff0000, v35
  v_add_f32 v12, v12, v82
  v_add_f32 v13, v13, v83
  v_add_f32 v14, v14, v84
  v_add_f32 v15, v15, v85
  v_cvt_pk_bf16_f32 v34, v12, v13
  v_cvt_pk_bf16_f32 v35, v14, v15
  buffer_store_dwordx2 v[34:35], v6, s[52:55], s33 offen
  v_cvt_pk_bf16_f32 v80, v16, v17
  v_cvt_pk_bf16_f32 v81, v18, v19
  v_lshlrev_b32 v16, 16, v80
  v_and_b32 v17, 0xffff0000, v80
  v_lshlrev_b32 v18, 16, v81
  v_and_b32 v19, 0xffff0000, v81
  v_lshlrev_b32 v82, 16, v36
  v_and_b32 v83, 0xffff0000, v36
  v_lshlrev_b32 v84, 16, v37
  v_and_b32 v85, 0xffff0000, v37
  v_add_f32 v16, v16, v82
  v_add_f32 v17, v17, v83
  v_add_f32 v18, v18, v84
  v_add_f32 v19, v19, v85
  v_cvt_pk_bf16_f32 v36, v16, v17
  v_cvt_pk_bf16_f32 v37, v18, v19
  buffer_store_dwordx2 v[36:37], v6, s[52:55], s34 offen
  v_cvt_pk_bf16_f32 v80, v20, v21
  v_cvt_pk_bf16_f32 v81, v22, v23
  v_lshlrev_b32 v20, 16, v80
  v_and_b32 v21, 0xffff0000, v80
  v_lshlrev_b32 v22, 16, v81
  v_and_b32 v23, 0xffff0000, v81
  v_lshlrev_b32 v82, 16, v38
  v_and_b32 v83, 0xffff0000, v38
  v_lshlrev_b32 v84, 16, v39
  v_and_b32 v85, 0xffff0000, v39
  v_add_f32 v20, v20, v82
  v_add_f32 v21, v21, v83
  v_add_f32 v22, v22, v84
  v_add_f32 v23, v23, v85
  v_cvt_pk_bf16_f32 v38, v20, v21
  v_cvt_pk_bf16_f32 v39, v22, v23
  buffer_store_dwordx2 v[38:39], v6, s[52:55], s35 offen
  v_cvt_pk_bf16_f32 v80, v24, v25
  v_cvt_pk_bf16_f32 v81, v26, v27
  v_lshlrev_b32 v24, 16, v80
  v_and_b32 v25, 0xffff0000, v80
  v_lshlrev_b32 v26, 16, v81
  v_and_b32 v27, 0xffff0000, v81
  v_lshlrev_b32 v82, 16, v40
  v_and_b32 v83, 0xffff0000, v40
  v_lshlrev_b32 v84, 16, v41
  v_and_b32 v85, 0xffff0000, v41
  v_add_f32 v24, v24, v82
  v_add_f32 v25, v25, v83
  v_add_f32 v26, v26, v84
  v_add_f32 v27, v27, v85
  v_cvt_pk_bf16_f32 v40, v24, v25
  v_cvt_pk_bf16_f32 v41, v26, v27
  buffer_store_dwordx2 v[40:41], v6, s[52:55], s36 offen
outb2_exit1:
  s_endpgm
.section .rodata,"a"
.p2align 6
.amdhsa_kernel prep_kernel
  .amdhsa_next_free_vgpr 80
  .amdhsa_next_free_sgpr 64
  .amdhsa_accum_offset 80
  .amdhsa_group_segment_fixed_size 0
  .amdhsa_kernarg_size 104
  .amdhsa_user_sgpr_count 2
  .amdhsa_user_sgpr_kernarg_segment_ptr 1
  .amdhsa_system_sgpr_workgroup_id_x 1
  .amdhsa_float_denorm_mode_32 3
.end_amdhsa_kernel
.p2align 6
.amdhsa_kernel ln2_kernel
  .amdhsa_next_free_vgpr 80
  .amdhsa_next_free_sgpr 40
  .amdhsa_accum_offset 80
  .amdhsa_group_segment_fixed_size 0
  .amdhsa_kernarg_size 104
  .amdhsa_user_sgpr_count 2
  .amdhsa_user_sgpr_kernarg_segment_ptr 1
  .amdhsa_system_sgpr_workgroup_id_x 1
  .amdhsa_float_denorm_mode_32 3
.end_amdhsa_kernel
.p2align 6
.amdhsa_kernel reca_kernel
  .amdhsa_next_free_vgpr 512
  .amdhsa_next_free_sgpr 102
  .amdhsa_accum_offset 256
  .amdhsa_group_segment_fixed_size 0
  .amdhsa_kernarg_size 104
  .amdhsa_user_sgpr_count 2
  .amdhsa_user_sgpr_kernarg_segment_ptr 1
  .amdhsa_system_sgpr_workgroup_id_x 1
  .amdhsa_float_denorm_mode_32 3
.end_amdhsa_kernel
.p2align 6
.amdhsa_kernel fin_kernel
  .amdhsa_next_free_vgpr 496
  .amdhsa_next_free_sgpr 64
  .amdhsa_accum_offset 256
  .amdhsa_group_segment_fixed_size 0
  .amdhsa_kernarg_size 104
  .amdhsa_user_sgpr_count 2
  .amdhsa_user_sgpr_kernarg_segment_ptr 1
  .amdhsa_system_sgpr_workgroup_id_x 1
  .amdhsa_float_denorm_mode_32 3
.end_amdhsa_kernel
.p2align 6
.amdhsa_kernel redln1_kernel
  .amdhsa_next_free_vgpr 248
  .amdhsa_next_free_sgpr 48
  .amdhsa_accum_offset 248
  .amdhsa_group_segment_fixed_size 0
  .amdhsa_kernarg_size 104
  .amdhsa_user_sgpr_count 2
  .amdhsa_user_sgpr_kernarg_segment_ptr 1
  .amdhsa_system_sgpr_workgroup_id_x 1
  .amdhsa_float_denorm_mode_32 3
.end_amdhsa_kernel
.p2align 6
.amdhsa_kernel redln2_kernel
  .amdhsa_next_free_vgpr 248
  .amdhsa_next_free_sgpr 48
  .amdhsa_accum_offset 248
  .amdhsa_group_segment_fixed_size 0
  .amdhsa_kernarg_size 104
  .amdhsa_user_sgpr_count 2
  .amdhsa_user_sgpr_kernarg_segment_ptr 1
  .amdhsa_system_sgpr_workgroup_id_x 1
  .amdhsa_float_denorm_mode_32 3
.end_amdhsa_kernel
.p2align 6
.amdhsa_kernel qkvb_kernel
  .amdhsa_next_free_vgpr 448
  .amdhsa_next_free_sgpr 102
  .amdhsa_accum_offset 256
  .amdhsa_group_segment_fixed_size 0
  .amdhsa_kernarg_size 104
  .amdhsa_user_sgpr_count 2
  .amdhsa_user_sgpr_kernarg_segment_ptr 1
  .amdhsa_system_sgpr_workgroup_id_x 1
  .amdhsa_float_denorm_mode_32 3
.end_amdhsa_kernel
.p2align 6
.amdhsa_kernel attnb_kernel
  .amdhsa_next_free_vgpr 200
  .amdhsa_next_free_sgpr 48
  .amdhsa_accum_offset 200
  .amdhsa_group_segment_fixed_size 0
  .amdhsa_kernarg_size 104
  .amdhsa_user_sgpr_count 2
  .amdhsa_user_sgpr_kernarg_segment_ptr 1
  .amdhsa_system_sgpr_workgroup_id_x 1
  .amdhsa_float_denorm_mode_32 3
.end_amdhsa_kernel
.p2align 6
.amdhsa_kernel outb1_kernel
  .amdhsa_next_free_vgpr 128
  .amdhsa_next_free_sgpr 64
  .amdhsa_accum_offset 128
  .amdhsa_group_segment_fixed_size 0
  .amdhsa_kernarg_size 104
  .amdhsa_user_sgpr_count 2
  .amdhsa_user_sgpr_kernarg_segment_ptr 1
  .amdhsa_system_sgpr_workgroup_id_x 1
  .amdhsa_float_denorm_mode_32 3
.end_amdhsa_kernel
.p2align 6
.amdhsa_kernel outb2_kernel
  .amdhsa_next_free_vgpr 128
  .amdhsa_next_free_sgpr 64
  .amdhsa_accum_offset 128
  .amdhsa_group_segment_fixed_size 0
  .amdhsa_kernarg_size 104
  .amdhsa_user_sgpr_count 2
  .amdhsa_user_sgpr_kernarg_segment_ptr 1
  .amdhsa_system_sgpr_workgroup_id_x 1
  .amdhsa_float_denorm_mode_32 3
.end_amdhsa_kernel
```

```asm
; @launch kernel=prep_kernel grid=(2368,1,1) block=(256,1,1) lds=18944
; @launch kernel=reca_kernel grid=(256,1,1) block=(256,1,1) lds=81920
; @launch kernel=fin_kernel grid=(256,1,1) block=(256,1,1) lds=98304
; @launch kernel=redln1_kernel grid=(128,1,1) block=(256,1,1) lds=512
; @launch kernel=qkvb_kernel grid=(256,1,1) block=(256,1,1) lds=81920
; @launch kernel=attnb_kernel grid=(256,1,1) block=(256,1,1) lds=0
; @launch kernel=outb1_kernel grid=(256,1,1) block=(256,1,1) lds=61440
; @launch kernel=ln2_kernel grid=(128,1,1) block=(256,1,1) lds=512
; @launch kernel=reca_kernel grid=(256,1,1) block=(256,1,1) lds=81920
; @launch kernel=fin_kernel grid=(256,1,1) block=(256,1,1) lds=98304
; @launch kernel=redln2_kernel grid=(128,1,1) block=(256,1,1) lds=512
; @launch kernel=qkvb_kernel grid=(256,1,1) block=(256,1,1) lds=81920
; @launch kernel=attnb_kernel grid=(256,1,1) block=(256,1,1) lds=0
; @launch kernel=outb2_kernel grid=(256,1,1) block=(256,1,1) lds=61440
.amdgcn_target "amdgcn-amd-amdhsa--gfx950"
.text
.globl prep_kernel
.p2align 8
.type prep_kernel,@function
prep_kernel:
  s_cmp_ge_u32 s2, 128
  s_cbranch_scc1 prep_notln5
  s_load_dwordx2 s[12:13], s[0:1], 96
  s_load_dwordx2 s[14:15], s[0:1], 0
  v_lshrrev_b32 v2, 6, v0
  v_and_b32 v3, 63, v0
  s_nop 0
  v_readfirstlane_b32 s16, v2
  s_waitcnt lgkmcnt(0)
  s_mov_b32 s4, s12
  s_mov_b32 s5, s13
  s_mov_b32 s6, 0x10000000
  s_mov_b32 s7, 0x20000
  s_mov_b32 s8, s14
  s_mov_b32 s9, s15
  s_mov_b32 s10, 2621440
  s_mov_b32 s11, 0x20000
  s_mov_b32 s20, 0
  v_and_b32 v2, 15, v3
  v_lshrrev_b32 v4, 4, v3
  s_lshl_b32 s17, s2, 4
  v_add_u32 v1, s17, v2
  v_mul_u32_u24 v1, 1280, v1
  v_lshl_add_u32 v1, v4, 4, v1
  s_mul_i32 s17, s16, 320
  s_add_u32 s20, s20, s17
  buffer_load_dwordx4 v[8:11], v1, s[8:11], s20 offen offset:0
  buffer_load_dwordx4 v[12:15], v1, s[8:11], s20 offen offset:64
  buffer_load_dwordx4 v[16:19], v1, s[8:11], s20 offen offset:128
  buffer_load_dwordx4 v[20:23], v1, s[8:11], s20 offen offset:192
  buffer_load_dwordx4 v[24:27], v1, s[8:11], s20 offen offset:256
  s_sub_u32 s21, 0, s12
  s_and_b32 s21, s21, 0x1fffff
  s_add_u32 s21, s21, 2097152
  v_mov_b32 v68, -1
  v_mov_b32 v69, -1
  v_mov_b32 v70, -1
  v_mov_b32 v71, -1
  v_lshlrev_b32 v72, 4, v0
  s_mul_i32 s22, s2, 12096
  s_add_u32 s22, s22, 0
  s_mul_i32 s23, s2, 12288
  s_add_u32 s23, s23, s21
  buffer_store_dwordx4 v[68:71], v72, s[4:7], s22 offen sc1
  s_add_u32 s22, s22, 4096
  buffer_store_dwordx4 v[68:71], v72, s[4:7], s22 offen sc1
  s_add_u32 s22, s22, 4096
  v_mov_b32 v73, 0x80000000
  v_cmp_gt_u32 vcc, 244, v0
  s_nop 1
  v_cndmask_b32 v73, v73, v72, vcc
  buffer_store_dwordx4 v[68:71], v73, s[4:7], s22 offen
  buffer_store_dwordx4 v[68:71], v72, s[4:7], s23 offen sc1
  s_add_u32 s23, s23, 4096
  buffer_store_dwordx4 v[68:71], v72, s[4:7], s23 offen sc1
  s_add_u32 s23, s23, 4096
  buffer_store_dwordx4 v[68:71], v72, s[4:7], s23 offen sc1
  s_add_u32 s23, s23, 4096
  s_mul_i32 s23, s2, 2048
  s_add_u32 s23, s23, s21
  s_add_u32 s23, s23, 1572864
  v_mov_b32 v73, 0x80000000
  v_cmp_gt_u32 vcc, 128, v0
  s_nop 1
  v_cndmask_b32 v73, v73, v72, vcc
  buffer_store_dwordx4 v[68:71], v73, s[4:7], s23 offen sc1
  s_waitcnt vmcnt(7)
  s_mul_i32 s17, s16, 320
  s_add_u32 s17, s17, 84934656
  buffer_store_dwordx4 v[8:11], v1, s[4:7], s17 offen offset:0
  buffer_store_dwordx4 v[12:15], v1, s[4:7], s17 offen offset:64
  buffer_store_dwordx4 v[16:19], v1, s[4:7], s17 offen offset:128
  buffer_store_dwordx4 v[20:23], v1, s[4:7], s17 offen offset:192
  buffer_store_dwordx4 v[24:27], v1, s[4:7], s17 offen offset:256
  v_lshlrev_b32 v5, 2, v2
  s_lshl_b32 s17, s16, 6
  v_add_u32 v1, s17, v5
  s_waitcnt vmcnt(5)
  v_lshlrev_b32 v28, 16, v8
  v_and_b32 v29, 0xffff0000, v8
  v_lshlrev_b32 v30, 16, v9
  v_and_b32 v31, 0xffff0000, v9
  v_lshlrev_b32 v32, 16, v10
  v_and_b32 v33, 0xffff0000, v10
  v_lshlrev_b32 v34, 16, v11
  v_and_b32 v35, 0xffff0000, v11
  v_lshlrev_b32 v36, 16, v12
  v_and_b32 v37, 0xffff0000, v12
  v_lshlrev_b32 v38, 16, v13
  v_and_b32 v39, 0xffff0000, v13
  v_lshlrev_b32 v40, 16, v14
  v_and_b32 v41, 0xffff0000, v14
  v_lshlrev_b32 v42, 16, v15
  v_and_b32 v43, 0xffff0000, v15
  v_lshlrev_b32 v44, 16, v16
  v_and_b32 v45, 0xffff0000, v16
  v_lshlrev_b32 v46, 16, v17
  v_and_b32 v47, 0xffff0000, v17
  v_lshlrev_b32 v48, 16, v18
  v_and_b32 v49, 0xffff0000, v18
  v_lshlrev_b32 v50, 16, v19
  v_and_b32 v51, 0xffff0000, v19
  v_lshlrev_b32 v52, 16, v20
  v_and_b32 v53, 0xffff0000, v20
  v_lshlrev_b32 v54, 16, v21
  v_and_b32 v55, 0xffff0000, v21
  v_lshlrev_b32 v56, 16, v22
  v_and_b32 v57, 0xffff0000, v22
  v_lshlrev_b32 v58, 16, v23
  v_and_b32 v59, 0xffff0000, v23
  v_lshlrev_b32 v60, 16, v24
  v_and_b32 v61, 0xffff0000, v24
  v_lshlrev_b32 v62, 16, v25
  v_and_b32 v63, 0xffff0000, v25
  v_lshlrev_b32 v64, 16, v26
  v_and_b32 v65, 0xffff0000, v26
  v_lshlrev_b32 v66, 16, v27
  v_and_b32 v67, 0xffff0000, v27
  v_pk_add_f32 v[6:7], v[28:29], v[30:31]
  v_pk_add_f32 v[6:7], v[6:7], v[32:33]
  v_pk_add_f32 v[6:7], v[6:7], v[34:35]
  v_pk_add_f32 v[6:7], v[6:7], v[36:37]
  v_pk_add_f32 v[6:7], v[6:7], v[38:39]
  v_pk_add_f32 v[6:7], v[6:7], v[40:41]
  v_pk_add_f32 v[6:7], v[6:7], v[42:43]
  v_pk_add_f32 v[6:7], v[6:7], v[44:45]
  v_pk_add_f32 v[6:7], v[6:7], v[46:47]
  v_pk_add_f32 v[6:7], v[6:7], v[48:49]
  v_pk_add_f32 v[6:7], v[6:7], v[50:51]
  v_pk_add_f32 v[6:7], v[6:7], v[52:53]
  v_pk_add_f32 v[6:7], v[6:7], v[54:55]
  v_pk_add_f32 v[6:7], v[6:7], v[56:57]
  v_pk_add_f32 v[6:7], v[6:7], v[58:59]
  v_pk_add_f32 v[6:7], v[6:7], v[60:61]
  v_pk_add_f32 v[6:7], v[6:7], v[62:63]
  v_pk_add_f32 v[6:7], v[6:7], v[64:65]
  v_pk_add_f32 v[6:7], v[6:7], v[66:67]
  v_add_f32 v4, v6, v7
  v_mov_b32 v2, v4
  s_nop 1
  v_permlane32_swap_b32 v4, v2
  v_add_f32 v4, v4, v2
  v_mov_b32 v2, v4
  s_nop 1
  v_permlane16_swap_b32 v4, v2
  v_add_f32 v4, v4, v2
  ds_write_b32 v1, v4 offset:0
  s_waitcnt lgkmcnt(0)
  s_barrier
  ds_read_b32 v4, v5 offset:0
  ds_read_b32 v2, v5 offset:64
  ds_read_b32 v3, v5 offset:128
  ds_read_b32 v6, v5 offset:192
  s_waitcnt lgkmcnt(0)
  v_add_f32 v4, v4, v2
  v_add_f32 v3, v3, v6
  v_add_f32 v4, v4, v3
  v_mul_f32 v4, 0x3acccccd, v4
  v_sub_f32 v28, v28, v4
  v_sub_f32 v29, v29, v4
  v_sub_f32 v30, v30, v4
  v_sub_f32 v31, v31, v4
  v_sub_f32 v32, v32, v4
  v_sub_f32 v33, v33, v4
  v_sub_f32 v34, v34, v4
  v_sub_f32 v35, v35, v4
  v_sub_f32 v36, v36, v4
  v_sub_f32 v37, v37, v4
  v_sub_f32 v38, v38, v4
  v_sub_f32 v39, v39, v4
  v_sub_f32 v40, v40, v4
  v_sub_f32 v41, v41, v4
  v_sub_f32 v42, v42, v4
  v_sub_f32 v43, v43, v4
  v_sub_f32 v44, v44, v4
  v_sub_f32 v45, v45, v4
  v_sub_f32 v46, v46, v4
  v_sub_f32 v47, v47, v4
  v_sub_f32 v48, v48, v4
  v_sub_f32 v49, v49, v4
  v_sub_f32 v50, v50, v4
  v_sub_f32 v51, v51, v4
  v_sub_f32 v52, v52, v4
  v_sub_f32 v53, v53, v4
  v_sub_f32 v54, v54, v4
  v_sub_f32 v55, v55, v4
  v_sub_f32 v56, v56, v4
  v_sub_f32 v57, v57, v4
  v_sub_f32 v58, v58, v4
  v_sub_f32 v59, v59, v4
  v_sub_f32 v60, v60, v4
  v_sub_f32 v61, v61, v4
  v_sub_f32 v62, v62, v4
  v_sub_f32 v63, v63, v4
  v_sub_f32 v64, v64, v4
  v_sub_f32 v65, v65, v4
  v_sub_f32 v66, v66, v4
  v_sub_f32 v67, v67, v4
  v_mul_f32 v6, v28, v28
  v_mul_f32 v7, v29, v29
  v_fmac_f32 v6, v30, v30
  v_fmac_f32 v7, v31, v31
  v_fmac_f32 v6, v32, v32
  v_fmac_f32 v7, v33, v33
  v_fmac_f32 v6, v34, v34
  v_fmac_f32 v7, v35, v35
  v_fmac_f32 v6, v36, v36
  v_fmac_f32 v7, v37, v37
  v_fmac_f32 v6, v38, v38
  v_fmac_f32 v7, v39, v39
  v_fmac_f32 v6, v40, v40
  v_fmac_f32 v7, v41, v41
  v_fmac_f32 v6, v42, v42
  v_fmac_f32 v7, v43, v43
  v_fmac_f32 v6, v44, v44
  v_fmac_f32 v7, v45, v45
  v_fmac_f32 v6, v46, v46
  v_fmac_f32 v7, v47, v47
  v_fmac_f32 v6, v48, v48
  v_fmac_f32 v7, v49, v49
  v_fmac_f32 v6, v50, v50
  v_fmac_f32 v7, v51, v51
  v_fmac_f32 v6, v52, v52
  v_fmac_f32 v7, v53, v53
  v_fmac_f32 v6, v54, v54
  v_fmac_f32 v7, v55, v55
  v_fmac_f32 v6, v56, v56
  v_fmac_f32 v7, v57, v57
  v_fmac_f32 v6, v58, v58
  v_fmac_f32 v7, v59, v59
  v_fmac_f32 v6, v60, v60
  v_fmac_f32 v7, v61, v61
  v_fmac_f32 v6, v62, v62
  v_fmac_f32 v7, v63, v63
  v_fmac_f32 v6, v64, v64
  v_fmac_f32 v7, v65, v65
  v_fmac_f32 v6, v66, v66
  v_fmac_f32 v7, v67, v67
  v_add_f32 v4, v6, v7
  v_mov_b32 v2, v4
  s_nop 1
  v_permlane32_swap_b32 v4, v2
  v_add_f32 v4, v4, v2
  v_mov_b32 v2, v4
  s_nop 1
  v_permlane16_swap_b32 v4, v2
  v_add_f32 v4, v4, v2
  ds_write_b32 v1, v4 offset:256
  s_waitcnt lgkmcnt(0)
  s_barrier
  ds_read_b32 v4, v5 offset:256
  ds_read_b32 v2, v5 offset:320
  ds_read_b32 v3, v5 offset:384
  ds_read_b32 v6, v5 offset:448
  s_waitcnt lgkmcnt(0)
  v_add_f32 v4, v4, v2
  v_add_f32 v3, v3, v6
  v_add_f32 v4, v4, v3
  v_mov_b32 v2, 0x3727c5ac
  v_fmac_f32 v2, 0x3acccccd, v4
  v_rsq_f32 v4, v2
  s_nop 0
  v_mul_f32 v28, v28, v4
  v_mul_f32 v29, v29, v4
  v_mul_f32 v30, v30, v4
  v_mul_f32 v31, v31, v4
  v_mul_f32 v32, v32, v4
  v_mul_f32 v33, v33, v4
  v_mul_f32 v34, v34, v4
  v_mul_f32 v35, v35, v4
  v_mul_f32 v36, v36, v4
  v_mul_f32 v37, v37, v4
  v_mul_f32 v38, v38, v4
  v_mul_f32 v39, v39, v4
  v_mul_f32 v40, v40, v4
  v_mul_f32 v41, v41, v4
  v_mul_f32 v42, v42, v4
  v_mul_f32 v43, v43, v4
  v_mul_f32 v44, v44, v4
  v_mul_f32 v45, v45, v4
  v_mul_f32 v46, v46, v4
  v_mul_f32 v47, v47, v4
  v_mul_f32 v48, v48, v4
  v_mul_f32 v49, v49, v4
  v_mul_f32 v50, v50, v4
  v_mul_f32 v51, v51, v4
  v_mul_f32 v52, v52, v4
  v_mul_f32 v53, v53, v4
  v_mul_f32 v54, v54, v4
  v_mul_f32 v55, v55, v4
  v_mul_f32 v56, v56, v4
  v_mul_f32 v57, v57, v4
  v_mul_f32 v58, v58, v4
  v_mul_f32 v59, v59, v4
  v_mul_f32 v60, v60, v4
  v_mul_f32 v61, v61, v4
  v_mul_f32 v62, v62, v4
  v_mul_f32 v63, v63, v4
  v_mul_f32 v64, v64, v4
  v_mul_f32 v65, v65, v4
  v_mul_f32 v66, v66, v4
  v_mul_f32 v67, v67, v4
  v_cvt_pk_bf16_f32 v8, v28, v29
  v_cvt_pk_bf16_f32 v9, v30, v31
  v_cvt_pk_bf16_f32 v10, v32, v33
  v_cvt_pk_bf16_f32 v11, v34, v35
  v_cvt_pk_bf16_f32 v12, v36, v37
  v_cvt_pk_bf16_f32 v13, v38, v39
  v_cvt_pk_bf16_f32 v14, v40, v41
  v_cvt_pk_bf16_f32 v15, v42, v43
  v_cvt_pk_bf16_f32 v16, v44, v45
  v_cvt_pk_bf16_f32 v17, v46, v47
  v_cvt_pk_bf16_f32 v18, v48, v49
  v_cvt_pk_bf16_f32 v19, v50, v51
  v_cvt_pk_bf16_f32 v20, v52, v53
  v_cvt_pk_bf16_f32 v21, v54, v55
  v_cvt_pk_bf16_f32 v22, v56, v57
  v_cvt_pk_bf16_f32 v23, v58, v59
  v_cvt_pk_bf16_f32 v24, v60, v61
  v_cvt_pk_bf16_f32 v25, v62, v63
  v_cvt_pk_bf16_f32 v26, v64, v65
  v_cvt_pk_bf16_f32 v27, v66, v67
  v_and_b32 v3, 63, v0
  v_lshlrev_b32 v1, 4, v3
  s_mul_i32 s17, s2, 20480
  s_mul_i32 s18, s16, 5120
  s_add_u32 s17, s17, s18
  s_add_u32 s17, s17, 87556096
  buffer_store_dwordx4 v[8:11], v1, s[4:7], s17 offen offset:0 sc1
  buffer_store_dwordx4 v[12:15], v1, s[4:7], s17 offen offset:1024 sc1
  buffer_store_dwordx4 v[16:19], v1, s[4:7], s17 offen offset:2048 sc1
  buffer_store_dwordx4 v[20:23], v1, s[4:7], s17 offen offset:3072 sc1
  s_add_u32 s17, s17, 4096
  buffer_store_dwordx4 v[24:27], v1, s[4:7], s17 offen offset:0 sc1
  s_endpgm
prep_notln5:
  s_sub_u32 s2, s2, 128
  s_cmp_ge_u32 s2, 2240
  s_cbranch_scc1 prep_exit1
  s_load_dwordx2 s[12:13], s[0:1], 96
  s_load_dwordx4 s[16:19], s[0:1], 16
  s_load_dwordx4 s[20:23], s[0:1], 32
  s_load_dwordx4 s[24:27], s[0:1], 64
  v_lshrrev_b32 v6, 6, v0
  v_and_b32 v1, 63, v0
  s_nop 0
  v_readfirstlane_b32 s14, v6
  v_lshlrev_b32 v5, 4, v1
  s_lshl_b32 s15, s2, 2
  s_nop 1
  s_add_u32 s15, s15, s14
  s_add_u32 s28, s15, 7680
  s_sub_u32 s29, s15, 1280
  s_cmp_lt_u32 s15, 1280
  s_cselect_b32 s15, s28, s29
  s_waitcnt lgkmcnt(0)
  s_mov_b32 s4, s12
  s_mov_b32 s5, s13
  s_mov_b32 s6, 0x10000000
  s_mov_b32 s7, 0x20000
  s_mov_b32 s11, 0x20000
  v_and_b32 v2, 15, v1
  v_lshrrev_b32 v3, 4, v1
  s_cmp_ge_u32 s15, 5760
  s_cbranch_scc1 prep_s22
  s_mul_hi_u32 s31, s15, 2236963
  s_mul_i32 s32, s31, 1920
  s_sub_u32 s32, s15, s32
  s_mul_hi_u32 s33, s32, 214748365
  s_mul_i32 s34, s33, 20
  s_sub_u32 s34, s32, s34
  s_cmp_eq_u32 s31, 0
  s_cselect_b32 s8, s16, s18
  s_cselect_b32 s9, s17, s19
  s_cmp_eq_u32 s31, 2
  s_cselect_b32 s8, s20, s8
  s_cselect_b32 s9, s21, s9
  s_mov_b32 s10, 7864320
  s_mul_i32 s35, s31, 7864320
  s_add_u32 s35, s35, 6291456
  v_lshrrev_b32 v6, 3, v1
  s_lshl_b32 s36, s34, 5
  v_add_u32 v6, s36, v6
  s_mov_b32 s37, 12288
  v_mul_lo_u32 v4, v6, s37
  s_lshl_b32 s36, s33, 7
  v_and_b32 v6, 7, v1
  v_lshl_add_u32 v4, v6, 4, v4
  v_add_u32 v4, s36, v4
  v_lshrrev_b32 v6, 3, v1
  v_mul_u32_u24 v12, 144, v6
  v_and_b32 v6, 7, v1
  v_lshl_add_u32 v12, v6, 4, v12
  s_mul_i32 s36, s14, 4608
  s_add_u32 s36, s36, 512
  v_add_u32 v12, s36, v12
  s_mov_b32 s29, 0
  buffer_load_dwordx4 v[16:19], v4, s[8:11], s29 offen
  s_mov_b32 s29, 98304
  buffer_load_dwordx4 v[20:23], v4, s[8:11], s29 offen
  s_mov_b32 s29, 196608
  buffer_load_dwordx4 v[24:27], v4, s[8:11], s29 offen
  s_mov_b32 s29, 294912
  buffer_load_dwordx4 v[28:31], v4, s[8:11], s29 offen
  v_bfe_u32 v6, v1, 2, 2
  v_lshlrev_b32 v13, 3, v3
  v_add_u32 v13, v13, v6
  v_mul_u32_u24 v13, 144, v13
  v_and_b32 v6, 3, v1
  v_lshl_add_u32 v13, v6, 3, v13
  v_add_u32 v13, s36, v13
  s_waitcnt vmcnt(3)
  ds_write_b128 v12, v[16:19] offset:0
  s_waitcnt vmcnt(2)
  ds_write_b128 v12, v[20:23] offset:1152
  s_waitcnt vmcnt(1)
  ds_write_b128 v12, v[24:27] offset:2304
  s_waitcnt vmcnt(0)
  ds_write_b128 v12, v[28:31] offset:3456
  s_waitcnt lgkmcnt(0)
  ds_read_b64_tr_b16 v[48:49], v13 offset:0
  ds_read_b64_tr_b16 v[50:51], v13 offset:576
  ds_read_b64_tr_b16 v[52:53], v13 offset:32
  ds_read_b64_tr_b16 v[54:55], v13 offset:608
  ds_read_b64_tr_b16 v[56:57], v13 offset:64
  ds_read_b64_tr_b16 v[58:59], v13 offset:640
  ds_read_b64_tr_b16 v[60:61], v13 offset:96
  ds_read_b64_tr_b16 v[62:63], v13 offset:672
  s_waitcnt lgkmcnt(6)
  s_lshl_b32 s30, s33, 2
  s_add_u32 s30, s30, 0
  s_mul_i32 s30, s30, 20
  s_add_u32 s30, s30, s34
  s_lshl_b32 s30, s30, 10
  s_add_u32 s30, s30, s35
  buffer_store_dwordx4 v[48:51], v5, s[4:7], s30 offen sc1
  s_waitcnt lgkmcnt(4)
  s_lshl_b32 s30, s33, 2
  s_add_u32 s30, s30, 1
  s_mul_i32 s30, s30, 20
  s_add_u32 s30, s30, s34
  s_lshl_b32 s30, s30, 10
  s_add_u32 s30, s30, s35
  buffer_store_dwordx4 v[52:55], v5, s[4:7], s30 offen sc1
  s_waitcnt lgkmcnt(2)
  s_lshl_b32 s30, s33, 2
  s_add_u32 s30, s30, 2
  s_mul_i32 s30, s30, 20
  s_add_u32 s30, s30, s34
  s_lshl_b32 s30, s30, 10
  s_add_u32 s30, s30, s35
  buffer_store_dwordx4 v[56:59], v5, s[4:7], s30 offen sc1
  s_waitcnt lgkmcnt(0)
  s_lshl_b32 s30, s33, 2
  s_add_u32 s30, s30, 3
  s_mul_i32 s30, s30, 20
  s_add_u32 s30, s30, s34
  s_lshl_b32 s30, s30, 10
  s_add_u32 s30, s30, s35
  buffer_store_dwordx4 v[60:63], v5, s[4:7], s30 offen sc1
  s_branch prep_exit1
prep_s22:
  s_sub_u32 s15, s15, 5760
  s_cmp_ge_u32 s15, 1920
  s_cbranch_scc1 prep_s33
  s_mul_hi_u32 s33, s15, 22369622
  s_mul_i32 s34, s33, 192
  s_sub_u32 s34, s15, s34
  s_mov_b32 s8, s22
  s_mov_b32 s9, s23
  s_mov_b32 s10, 7864320
  v_lshrrev_b32 v6, 3, v1
  s_lshl_b32 s36, s34, 5
  v_add_u32 v6, s36, v6
  v_mul_u32_u24 v4, 1280, v6
  s_lshl_b32 s36, s33, 7
  v_and_b32 v6, 7, v1
  v_lshl_add_u32 v4, v6, 4, v4
  v_add_u32 v4, s36, v4
  v_lshrrev_b32 v6, 3, v1
  v_mul_u32_u24 v12, 144, v6
  v_and_b32 v6, 7, v1
  v_lshl_add_u32 v12, v6, 4, v12
  s_mul_i32 s36, s14, 4608
  s_add_u32 s36, s36, 512
  v_add_u32 v12, s36, v12
  s_mov_b32 s29, 0
  buffer_load_dwordx4 v[16:19], v4, s[8:11], s29 offen
  s_mov_b32 s29, 10240
  buffer_load_dwordx4 v[20:23], v4, s[8:11], s29 offen
  s_mov_b32 s29, 20480
  buffer_load_dwordx4 v[24:27], v4, s[8:11], s29 offen
  s_mov_b32 s29, 30720
  buffer_load_dwordx4 v[28:31], v4, s[8:11], s29 offen
  v_bfe_u32 v6, v1, 2, 2
  v_lshlrev_b32 v13, 2, v3
  v_add_u32 v13, v13, v6
  v_mul_u32_u24 v13, 144, v13
  v_and_b32 v6, 3, v1
  v_lshl_add_u32 v13, v6, 4, v13
  v_add_u32 v13, s36, v13
  s_waitcnt vmcnt(3)
  ds_write_b128 v12, v[16:19] offset:0
  s_waitcnt vmcnt(2)
  ds_write_b128 v12, v[20:23] offset:1152
  s_waitcnt vmcnt(1)
  ds_write_b128 v12, v[24:27] offset:2304
  s_waitcnt vmcnt(0)
  ds_write_b128 v12, v[28:31] offset:3456
  s_waitcnt lgkmcnt(0)
  ds_read_b64_tr_b16 v[48:49], v13 offset:0
  ds_read_b64_tr_b16 v[50:51], v13 offset:2304
  ds_read_b64_tr_b16 v[52:53], v13 offset:8
  ds_read_b64_tr_b16 v[54:55], v13 offset:2312
  ds_read_b64_tr_b16 v[56:57], v13 offset:64
  ds_read_b64_tr_b16 v[58:59], v13 offset:2368
  ds_read_b64_tr_b16 v[60:61], v13 offset:72
  ds_read_b64_tr_b16 v[62:63], v13 offset:2376
  s_waitcnt lgkmcnt(6)
  s_lshl_b32 s30, s33, 2
  s_add_u32 s30, s30, 0
  s_mul_i32 s30, s30, 192
  s_add_u32 s30, s30, s34
  s_lshl_b32 s30, s30, 10
  s_add_u32 s30, s30, 29884416
  buffer_store_dwordx4 v[48:51], v5, s[4:7], s30 offen sc1
  s_waitcnt lgkmcnt(4)
  s_lshl_b32 s30, s33, 2
  s_add_u32 s30, s30, 1
  s_mul_i32 s30, s30, 192
  s_add_u32 s30, s30, s34
  s_lshl_b32 s30, s30, 10
  s_add_u32 s30, s30, 29884416
  buffer_store_dwordx4 v[52:55], v5, s[4:7], s30 offen sc1
  s_waitcnt lgkmcnt(2)
  s_lshl_b32 s30, s33, 2
  s_add_u32 s30, s30, 2
  s_mul_i32 s30, s30, 192
  s_add_u32 s30, s30, s34
  s_lshl_b32 s30, s30, 10
  s_add_u32 s30, s30, 29884416
  buffer_store_dwordx4 v[56:59], v5, s[4:7], s30 offen sc1
  s_waitcnt lgkmcnt(0)
  s_lshl_b32 s30, s33, 2
  s_add_u32 s30, s30, 3
  s_mul_i32 s30, s30, 192
  s_add_u32 s30, s30, s34
  s_lshl_b32 s30, s30, 10
  s_add_u32 s30, s30, 29884416
  buffer_store_dwordx4 v[60:63], v5, s[4:7], s30 offen sc1
  s_branch prep_exit1
prep_s33:
  s_sub_u32 s15, s15, 1920
  s_cmp_ge_u32 s15, 960
  s_cbranch_scc1 prep_s44
  s_mul_hi_u32 s33, s15, 107374183
  s_mul_i32 s34, s33, 40
  s_sub_u32 s34, s15, s34
  s_mov_b32 s8, s24
  s_mov_b32 s9, s25
  s_mov_b32 s10, 2457600
  v_lshrrev_b32 v6, 5, v1
  v_lshlrev_b32 v6, 3, v6
  s_lshl_b32 s36, s34, 4
  v_add_u32 v6, s36, v6
  v_mul_u32_u24 v4, 3840, v6
  v_and_b32 v6, 31, v1
  v_lshl_add_u32 v4, v6, 1, v4
  s_mul_i32 s36, s33, 160
  v_add_u32 v4, s36, v4
  v_cmp_gt_u32 vcc, 20, v6
  v_mov_b32 v6, 0x80000000
  s_nop 0
  v_cndmask_b32 v4, v6, v4, vcc
  s_mov_b32 s29, 0
  buffer_load_ushort v16, v4, s[8:11], s29 offen
  s_mov_b32 s29, 3840
  buffer_load_ushort v17, v4, s[8:11], s29 offen
  s_mov_b32 s29, 7680
  buffer_load_ushort v18, v4, s[8:11], s29 offen
  s_mov_b32 s29, 11520
  buffer_load_ushort v19, v4, s[8:11], s29 offen
  s_mov_b32 s29, 15360
  buffer_load_ushort v20, v4, s[8:11], s29 offen
  s_mov_b32 s29, 19200
  buffer_load_ushort v21, v4, s[8:11], s29 offen
  s_mov_b32 s29, 23040
  buffer_load_ushort v22, v4, s[8:11], s29 offen
  s_mov_b32 s29, 26880
  buffer_load_ushort v23, v4, s[8:11], s29 offen
  s_mov_b32 s29, 40
  buffer_load_ushort v24, v4, s[8:11], s29 offen
  s_mov_b32 s29, 3880
  buffer_load_ushort v25, v4, s[8:11], s29 offen
  s_mov_b32 s29, 7720
  buffer_load_ushort v26, v4, s[8:11], s29 offen
  s_mov_b32 s29, 11560
  buffer_load_ushort v27, v4, s[8:11], s29 offen
  s_mov_b32 s29, 15400
  buffer_load_ushort v28, v4, s[8:11], s29 offen
  s_mov_b32 s29, 19240
  buffer_load_ushort v29, v4, s[8:11], s29 offen
  s_mov_b32 s29, 23080
  buffer_load_ushort v30, v4, s[8:11], s29 offen
  s_mov_b32 s29, 26920
  buffer_load_ushort v31, v4, s[8:11], s29 offen
  s_mov_b32 s29, 80
  buffer_load_ushort v32, v4, s[8:11], s29 offen
  s_mov_b32 s29, 3920
  buffer_load_ushort v33, v4, s[8:11], s29 offen
  s_mov_b32 s29, 7760
  buffer_load_ushort v34, v4, s[8:11], s29 offen
  s_mov_b32 s29, 11600
  buffer_load_ushort v35, v4, s[8:11], s29 offen
  s_mov_b32 s29, 15440
  buffer_load_ushort v36, v4, s[8:11], s29 offen
  s_mov_b32 s29, 19280
  buffer_load_ushort v37, v4, s[8:11], s29 offen
  s_mov_b32 s29, 23120
  buffer_load_ushort v38, v4, s[8:11], s29 offen
  s_mov_b32 s29, 26960
  buffer_load_ushort v39, v4, s[8:11], s29 offen
  s_mov_b32 s29, 120
  buffer_load_ushort v40, v4, s[8:11], s29 offen
  s_mov_b32 s29, 3960
  buffer_load_ushort v41, v4, s[8:11], s29 offen
  s_mov_b32 s29, 7800
  buffer_load_ushort v42, v4, s[8:11], s29 offen
  s_mov_b32 s29, 11640
  buffer_load_ushort v43, v4, s[8:11], s29 offen
  s_mov_b32 s29, 15480
  buffer_load_ushort v44, v4, s[8:11], s29 offen
  s_mov_b32 s29, 19320
  buffer_load_ushort v45, v4, s[8:11], s29 offen
  s_mov_b32 s29, 23160
  buffer_load_ushort v46, v4, s[8:11], s29 offen
  s_mov_b32 s29, 27000
  buffer_load_ushort v47, v4, s[8:11], s29 offen
  s_waitcnt vmcnt(24)
  v_lshl_or_b32 v48, v17, 16, v16
  v_lshl_or_b32 v49, v19, 16, v18
  v_lshl_or_b32 v50, v21, 16, v20
  v_lshl_or_b32 v51, v23, 16, v22
  s_lshl_b32 s30, s33, 2
  s_add_u32 s30, s30, 0
  s_mul_i32 s30, s30, 40
  s_add_u32 s30, s30, s34
  s_lshl_b32 s30, s30, 10
  s_add_u32 s30, s30, 90177536
  buffer_store_dwordx4 v[48:51], v5, s[4:7], s30 offen sc1
  s_waitcnt vmcnt(17)
  v_lshl_or_b32 v52, v25, 16, v24
  v_lshl_or_b32 v53, v27, 16, v26
  v_lshl_or_b32 v54, v29, 16, v28
  v_lshl_or_b32 v55, v31, 16, v30
  s_lshl_b32 s30, s33, 2
  s_add_u32 s30, s30, 1
  s_mul_i32 s30, s30, 40
  s_add_u32 s30, s30, s34
  s_lshl_b32 s30, s30, 10
  s_add_u32 s30, s30, 90177536
  buffer_store_dwordx4 v[52:55], v5, s[4:7], s30 offen sc1
  s_waitcnt vmcnt(10)
  v_lshl_or_b32 v56, v33, 16, v32
  v_lshl_or_b32 v57, v35, 16, v34
  v_lshl_or_b32 v58, v37, 16, v36
  v_lshl_or_b32 v59, v39, 16, v38
  s_lshl_b32 s30, s33, 2
  s_add_u32 s30, s30, 2
  s_mul_i32 s30, s30, 40
  s_add_u32 s30, s30, s34
  s_lshl_b32 s30, s30, 10
  s_add_u32 s30, s30, 90177536
  buffer_store_dwordx4 v[56:59], v5, s[4:7], s30 offen sc1
  s_waitcnt vmcnt(3)
  v_lshl_or_b32 v60, v41, 16, v40
  v_lshl_or_b32 v61, v43, 16, v42
  v_lshl_or_b32 v62, v45, 16, v44
  v_lshl_or_b32 v63, v47, 16, v46
  s_lshl_b32 s30, s33, 2
  s_add_u32 s30, s30, 3
  s_mul_i32 s30, s30, 40
  s_add_u32 s30, s30, s34
  s_lshl_b32 s30, s30, 10
  s_add_u32 s30, s30, 90177536
  buffer_store_dwordx4 v[60:63], v5, s[4:7], s30 offen sc1
  s_branch prep_exit1
prep_s44:
  s_sub_u32 s15, s15, 960
  s_mul_hi_u32 s33, s15, 134217728
  s_and_b32 s34, s15, 31
  s_lshr_b32 s33, s15, 5
  s_mov_b32 s8, s26
  s_mov_b32 s9, s27
  s_mov_b32 s10, 819200
  v_lshrrev_b32 v6, 1, v3
  v_lshlrev_b32 v6, 4, v6
  v_and_b32 v7, 1, v3
  v_lshl_add_u32 v6, v7, 2, v6
  v_mov_b32 v8, v6
  s_mul_i32 s36, s34, 20
  v_add_u32 v6, s36, v6
  v_mul_u32_u24 v4, 1280, v6
  v_lshrrev_b32 v6, 2, v2
  v_lshl_add_u32 v4, v6, 4, v4
  v_and_b32 v6, 3, v2
  v_lshl_add_u32 v4, v6, 1, v4
  s_lshl_b32 s36, s33, 7
  v_add_u32 v4, s36, v4
  v_mov_b32 v9, 0x80000000
  v_cmp_gt_u32 vcc, 17, v8
  s_nop 1
  v_cndmask_b32 v10, v9, v4, vcc
  v_cmp_gt_u32 vcc, 9, v8
  s_nop 1
  v_cndmask_b32 v11, v9, v4, vcc
  s_mov_b32 s29, 0
  buffer_load_ushort v16, v10, s[8:11], s29 offen
  s_mov_b32 s29, 1280
  buffer_load_ushort v17, v10, s[8:11], s29 offen
  s_mov_b32 s29, 2560
  buffer_load_ushort v18, v10, s[8:11], s29 offen
  s_mov_b32 s29, 3840
  buffer_load_ushort v19, v10, s[8:11], s29 offen
  s_mov_b32 s29, 10240
  buffer_load_ushort v20, v11, s[8:11], s29 offen
  s_mov_b32 s29, 11520
  buffer_load_ushort v21, v11, s[8:11], s29 offen
  s_mov_b32 s29, 12800
  buffer_load_ushort v22, v11, s[8:11], s29 offen
  s_mov_b32 s29, 14080
  buffer_load_ushort v23, v11, s[8:11], s29 offen
  s_mov_b32 s29, 8
  buffer_load_ushort v24, v10, s[8:11], s29 offen
  s_mov_b32 s29, 1288
  buffer_load_ushort v25, v10, s[8:11], s29 offen
  s_mov_b32 s29, 2568
  buffer_load_ushort v26, v10, s[8:11], s29 offen
  s_mov_b32 s29, 3848
  buffer_load_ushort v27, v10, s[8:11], s29 offen
  s_mov_b32 s29, 10248
  buffer_load_ushort v28, v11, s[8:11], s29 offen
  s_mov_b32 s29, 11528
  buffer_load_ushort v29, v11, s[8:11], s29 offen
  s_mov_b32 s29, 12808
  buffer_load_ushort v30, v11, s[8:11], s29 offen
  s_mov_b32 s29, 14088
  buffer_load_ushort v31, v11, s[8:11], s29 offen
  s_mov_b32 s29, 64
  buffer_load_ushort v32, v10, s[8:11], s29 offen
  s_mov_b32 s29, 1344
  buffer_load_ushort v33, v10, s[8:11], s29 offen
  s_mov_b32 s29, 2624
  buffer_load_ushort v34, v10, s[8:11], s29 offen
  s_mov_b32 s29, 3904
  buffer_load_ushort v35, v10, s[8:11], s29 offen
  s_mov_b32 s29, 10304
  buffer_load_ushort v36, v11, s[8:11], s29 offen
  s_mov_b32 s29, 11584
  buffer_load_ushort v37, v11, s[8:11], s29 offen
  s_mov_b32 s29, 12864
  buffer_load_ushort v38, v11, s[8:11], s29 offen
  s_mov_b32 s29, 14144
  buffer_load_ushort v39, v11, s[8:11], s29 offen
  s_mov_b32 s29, 72
  buffer_load_ushort v40, v10, s[8:11], s29 offen
  s_mov_b32 s29, 1352
  buffer_load_ushort v41, v10, s[8:11], s29 offen
  s_mov_b32 s29, 2632
  buffer_load_ushort v42, v10, s[8:11], s29 offen
  s_mov_b32 s29, 3912
  buffer_load_ushort v43, v10, s[8:11], s29 offen
  s_mov_b32 s29, 10312
  buffer_load_ushort v44, v11, s[8:11], s29 offen
  s_mov_b32 s29, 11592
  buffer_load_ushort v45, v11, s[8:11], s29 offen
  s_mov_b32 s29, 12872
  buffer_load_ushort v46, v11, s[8:11], s29 offen
  s_mov_b32 s29, 14152
  buffer_load_ushort v47, v11, s[8:11], s29 offen
  s_waitcnt vmcnt(24)
  v_lshl_or_b32 v48, v17, 16, v16
  v_lshl_or_b32 v49, v19, 16, v18
  v_lshl_or_b32 v50, v21, 16, v20
  v_lshl_or_b32 v51, v23, 16, v22
  s_lshl_b32 s30, s33, 2
  s_add_u32 s30, s30, 0
  s_lshl_b32 s30, s30, 5
  s_add_u32 s30, s30, s34
  s_lshl_b32 s30, s30, 10
  s_add_u32 s30, s30, 94109696
  buffer_store_dwordx4 v[48:51], v5, s[4:7], s30 offen sc1
  s_waitcnt vmcnt(17)
  v_lshl_or_b32 v52, v25, 16, v24
  v_lshl_or_b32 v53, v27, 16, v26
  v_lshl_or_b32 v54, v29, 16, v28
  v_lshl_or_b32 v55, v31, 16, v30
  s_lshl_b32 s30, s33, 2
  s_add_u32 s30, s30, 1
  s_lshl_b32 s30, s30, 5
  s_add_u32 s30, s30, s34
  s_lshl_b32 s30, s30, 10
  s_add_u32 s30, s30, 94109696
  buffer_store_dwordx4 v[52:55], v5, s[4:7], s30 offen sc1
  s_waitcnt vmcnt(10)
  v_lshl_or_b32 v56, v33, 16, v32
  v_lshl_or_b32 v57, v35, 16, v34
  v_lshl_or_b32 v58, v37, 16, v36
  v_lshl_or_b32 v59, v39, 16, v38
  s_lshl_b32 s30, s33, 2
  s_add_u32 s30, s30, 2
  s_lshl_b32 s30, s30, 5
  s_add_u32 s30, s30, s34
  s_lshl_b32 s30, s30, 10
  s_add_u32 s30, s30, 94109696
  buffer_store_dwordx4 v[56:59], v5, s[4:7], s30 offen sc1
  s_waitcnt vmcnt(3)
  v_lshl_or_b32 v60, v41, 16, v40
  v_lshl_or_b32 v61, v43, 16, v42
  v_lshl_or_b32 v62, v45, 16, v44
  v_lshl_or_b32 v63, v47, 16, v46
  s_lshl_b32 s30, s33, 2
  s_add_u32 s30, s30, 3
  s_lshl_b32 s30, s30, 5
  s_add_u32 s30, s30, s34
  s_lshl_b32 s30, s30, 10
  s_add_u32 s30, s30, 94109696
  buffer_store_dwordx4 v[60:63], v5, s[4:7], s30 offen sc1
prep_exit1:
  s_endpgm
.globl ln2_kernel
.p2align 8
.type ln2_kernel,@function
ln2_kernel:
  s_cmp_ge_u32 s2, 128
  s_cbranch_scc1 ln2_exit1
  s_load_dwordx2 s[12:13], s[0:1], 96
  s_load_dwordx2 s[14:15], s[0:1], 0
  v_lshrrev_b32 v2, 6, v0
  v_and_b32 v3, 63, v0
  s_nop 0
  v_readfirstlane_b32 s16, v2
  s_waitcnt lgkmcnt(0)
  s_mov_b32 s4, s12
  s_mov_b32 s5, s13
  s_mov_b32 s6, 0x10000000
  s_mov_b32 s7, 0x20000
  s_mov_b32 s8, s12
  s_mov_b32 s9, s13
  s_mov_b32 s10, 0x10000000
  s_mov_b32 s11, 0x20000
  s_mov_b32 s20, 84934656
  v_and_b32 v2, 15, v3
  v_lshrrev_b32 v4, 4, v3
  s_lshl_b32 s17, s2, 4
  v_add_u32 v1, s17, v2
  v_mul_u32_u24 v1, 1280, v1
  v_lshl_add_u32 v1, v4, 4, v1
  s_mul_i32 s17, s16, 320
  s_add_u32 s20, s20, s17
  buffer_load_dwordx4 v[8:11], v1, s[8:11], s20 offen offset:0
  buffer_load_dwordx4 v[12:15], v1, s[8:11], s20 offen offset:64
  buffer_load_dwordx4 v[16:19], v1, s[8:11], s20 offen offset:128
  buffer_load_dwordx4 v[20:23], v1, s[8:11], s20 offen offset:192
  buffer_load_dwordx4 v[24:27], v1, s[8:11], s20 offen offset:256
  s_sub_u32 s21, 0, s12
  s_and_b32 s21, s21, 0x1fffff
  s_add_u32 s21, s21, 2097152
  v_mov_b32 v68, -1
  v_mov_b32 v69, -1
  v_mov_b32 v70, -1
  v_mov_b32 v71, -1
  v_lshlrev_b32 v72, 4, v0
  s_mul_i32 s22, s2, 12096
  s_add_u32 s22, s22, 0
  s_mul_i32 s23, s2, 12288
  s_add_u32 s23, s23, s21
  buffer_store_dwordx4 v[68:71], v72, s[4:7], s22 offen sc1
  s_add_u32 s22, s22, 4096
  buffer_store_dwordx4 v[68:71], v72, s[4:7], s22 offen sc1
  s_add_u32 s22, s22, 4096
  v_mov_b32 v73, 0x80000000
  v_cmp_gt_u32 vcc, 244, v0
  s_nop 1
  v_cndmask_b32 v73, v73, v72, vcc
  buffer_store_dwordx4 v[68:71], v73, s[4:7], s22 offen
  buffer_store_dwordx4 v[68:71], v72, s[4:7], s23 offen sc1
  s_add_u32 s23, s23, 4096
  buffer_store_dwordx4 v[68:71], v72, s[4:7], s23 offen sc1
  s_add_u32 s23, s23, 4096
  buffer_store_dwordx4 v[68:71], v72, s[4:7], s23 offen sc1
  s_add_u32 s23, s23, 4096
  s_mul_i32 s23, s2, 2048
  s_add_u32 s23, s23, s21
  s_add_u32 s23, s23, 1572864
  v_mov_b32 v73, 0x80000000
  v_cmp_gt_u32 vcc, 128, v0
  s_nop 1
  v_cndmask_b32 v73, v73, v72, vcc
  buffer_store_dwordx4 v[68:71], v73, s[4:7], s23 offen sc1
  v_lshlrev_b32 v5, 2, v2
  s_lshl_b32 s17, s16, 6
  v_add_u32 v1, s17, v5
  s_waitcnt vmcnt(7)
  v_lshlrev_b32 v28, 16, v8
  v_and_b32 v29, 0xffff0000, v8
  v_lshlrev_b32 v30, 16, v9
  v_and_b32 v31, 0xffff0000, v9
  v_lshlrev_b32 v32, 16, v10
  v_and_b32 v33, 0xffff0000, v10
  v_lshlrev_b32 v34, 16, v11
  v_and_b32 v35, 0xffff0000, v11
  v_lshlrev_b32 v36, 16, v12
  v_and_b32 v37, 0xffff0000, v12
  v_lshlrev_b32 v38, 16, v13
  v_and_b32 v39, 0xffff0000, v13
  v_lshlrev_b32 v40, 16, v14
  v_and_b32 v41, 0xffff0000, v14
  v_lshlrev_b32 v42, 16, v15
  v_and_b32 v43, 0xffff0000, v15
  v_lshlrev_b32 v44, 16, v16
  v_and_b32 v45, 0xffff0000, v16
  v_lshlrev_b32 v46, 16, v17
  v_and_b32 v47, 0xffff0000, v17
  v_lshlrev_b32 v48, 16, v18
  v_and_b32 v49, 0xffff0000, v18
  v_lshlrev_b32 v50, 16, v19
  v_and_b32 v51, 0xffff0000, v19
  v_lshlrev_b32 v52, 16, v20
  v_and_b32 v53, 0xffff0000, v20
  v_lshlrev_b32 v54, 16, v21
  v_and_b32 v55, 0xffff0000, v21
  v_lshlrev_b32 v56, 16, v22
  v_and_b32 v57, 0xffff0000, v22
  v_lshlrev_b32 v58, 16, v23
  v_and_b32 v59, 0xffff0000, v23
  v_lshlrev_b32 v60, 16, v24
  v_and_b32 v61, 0xffff0000, v24
  v_lshlrev_b32 v62, 16, v25
  v_and_b32 v63, 0xffff0000, v25
  v_lshlrev_b32 v64, 16, v26
  v_and_b32 v65, 0xffff0000, v26
  v_lshlrev_b32 v66, 16, v27
  v_and_b32 v67, 0xffff0000, v27
  v_pk_add_f32 v[6:7], v[28:29], v[30:31]
  v_pk_add_f32 v[6:7], v[6:7], v[32:33]
  v_pk_add_f32 v[6:7], v[6:7], v[34:35]
  v_pk_add_f32 v[6:7], v[6:7], v[36:37]
  v_pk_add_f32 v[6:7], v[6:7], v[38:39]
  v_pk_add_f32 v[6:7], v[6:7], v[40:41]
  v_pk_add_f32 v[6:7], v[6:7], v[42:43]
  v_pk_add_f32 v[6:7], v[6:7], v[44:45]
  v_pk_add_f32 v[6:7], v[6:7], v[46:47]
  v_pk_add_f32 v[6:7], v[6:7], v[48:49]
  v_pk_add_f32 v[6:7], v[6:7], v[50:51]
  v_pk_add_f32 v[6:7], v[6:7], v[52:53]
  v_pk_add_f32 v[6:7], v[6:7], v[54:55]
  v_pk_add_f32 v[6:7], v[6:7], v[56:57]
  v_pk_add_f32 v[6:7], v[6:7], v[58:59]
  v_pk_add_f32 v[6:7], v[6:7], v[60:61]
  v_pk_add_f32 v[6:7], v[6:7], v[62:63]
  v_pk_add_f32 v[6:7], v[6:7], v[64:65]
  v_pk_add_f32 v[6:7], v[6:7], v[66:67]
  v_add_f32 v4, v6, v7
  v_mov_b32 v2, v4
  s_nop 1
  v_permlane32_swap_b32 v4, v2
  v_add_f32 v4, v4, v2
  v_mov_b32 v2, v4
  s_nop 1
  v_permlane16_swap_b32 v4, v2
  v_add_f32 v4, v4, v2
  ds_write_b32 v1, v4 offset:0
  s_waitcnt lgkmcnt(0)
  s_barrier
  ds_read_b32 v4, v5 offset:0
  ds_read_b32 v2, v5 offset:64
  ds_read_b32 v3, v5 offset:128
  ds_read_b32 v6, v5 offset:192
  s_waitcnt lgkmcnt(0)
  v_add_f32 v4, v4, v2
  v_add_f32 v3, v3, v6
  v_add_f32 v4, v4, v3
  v_mul_f32 v4, 0x3acccccd, v4
  v_sub_f32 v28, v28, v4
  v_sub_f32 v29, v29, v4
  v_sub_f32 v30, v30, v4
  v_sub_f32 v31, v31, v4
  v_sub_f32 v32, v32, v4
  v_sub_f32 v33, v33, v4
  v_sub_f32 v34, v34, v4
  v_sub_f32 v35, v35, v4
  v_sub_f32 v36, v36, v4
  v_sub_f32 v37, v37, v4
  v_sub_f32 v38, v38, v4
  v_sub_f32 v39, v39, v4
  v_sub_f32 v40, v40, v4
  v_sub_f32 v41, v41, v4
  v_sub_f32 v42, v42, v4
  v_sub_f32 v43, v43, v4
  v_sub_f32 v44, v44, v4
  v_sub_f32 v45, v45, v4
  v_sub_f32 v46, v46, v4
  v_sub_f32 v47, v47, v4
  v_sub_f32 v48, v48, v4
  v_sub_f32 v49, v49, v4
  v_sub_f32 v50, v50, v4
  v_sub_f32 v51, v51, v4
  v_sub_f32 v52, v52, v4
  v_sub_f32 v53, v53, v4
  v_sub_f32 v54, v54, v4
  v_sub_f32 v55, v55, v4
  v_sub_f32 v56, v56, v4
  v_sub_f32 v57, v57, v4
  v_sub_f32 v58, v58, v4
  v_sub_f32 v59, v59, v4
  v_sub_f32 v60, v60, v4
  v_sub_f32 v61, v61, v4
  v_sub_f32 v62, v62, v4
  v_sub_f32 v63, v63, v4
  v_sub_f32 v64, v64, v4
  v_sub_f32 v65, v65, v4
  v_sub_f32 v66, v66, v4
  v_sub_f32 v67, v67, v4
  v_mul_f32 v6, v28, v28
  v_mul_f32 v7, v29, v29
  v_fmac_f32 v6, v30, v30
  v_fmac_f32 v7, v31, v31
  v_fmac_f32 v6, v32, v32
  v_fmac_f32 v7, v33, v33
  v_fmac_f32 v6, v34, v34
  v_fmac_f32 v7, v35, v35
  v_fmac_f32 v6, v36, v36
  v_fmac_f32 v7, v37, v37
  v_fmac_f32 v6, v38, v38
  v_fmac_f32 v7, v39, v39
  v_fmac_f32 v6, v40, v40
  v_fmac_f32 v7, v41, v41
  v_fmac_f32 v6, v42, v42
  v_fmac_f32 v7, v43, v43
  v_fmac_f32 v6, v44, v44
  v_fmac_f32 v7, v45, v45
  v_fmac_f32 v6, v46, v46
  v_fmac_f32 v7, v47, v47
  v_fmac_f32 v6, v48, v48
  v_fmac_f32 v7, v49, v49
  v_fmac_f32 v6, v50, v50
  v_fmac_f32 v7, v51, v51
  v_fmac_f32 v6, v52, v52
  v_fmac_f32 v7, v53, v53
  v_fmac_f32 v6, v54, v54
  v_fmac_f32 v7, v55, v55
  v_fmac_f32 v6, v56, v56
  v_fmac_f32 v7, v57, v57
  v_fmac_f32 v6, v58, v58
  v_fmac_f32 v7, v59, v59
  v_fmac_f32 v6, v60, v60
  v_fmac_f32 v7, v61, v61
  v_fmac_f32 v6, v62, v62
  v_fmac_f32 v7, v63, v63
  v_fmac_f32 v6, v64, v64
  v_fmac_f32 v7, v65, v65
  v_fmac_f32 v6, v66, v66
  v_fmac_f32 v7, v67, v67
  v_add_f32 v4, v6, v7
  v_mov_b32 v2, v4
  s_nop 1
  v_permlane32_swap_b32 v4, v2
  v_add_f32 v4, v4, v2
  v_mov_b32 v2, v4
  s_nop 1
  v_permlane16_swap_b32 v4, v2
  v_add_f32 v4, v4, v2
  ds_write_b32 v1, v4 offset:256
  s_waitcnt lgkmcnt(0)
  s_barrier
  ds_read_b32 v4, v5 offset:256
  ds_read_b32 v2, v5 offset:320
  ds_read_b32 v3, v5 offset:384
  ds_read_b32 v6, v5 offset:448
  s_waitcnt lgkmcnt(0)
  v_add_f32 v4, v4, v2
  v_add_f32 v3, v3, v6
  v_add_f32 v4, v4, v3
  v_mov_b32 v2, 0x3727c5ac
  v_fmac_f32 v2, 0x3acccccd, v4
  v_rsq_f32 v4, v2
  s_nop 0
  v_mul_f32 v28, v28, v4
  v_mul_f32 v29, v29, v4
  v_mul_f32 v30, v30, v4
  v_mul_f32 v31, v31, v4
  v_mul_f32 v32, v32, v4
  v_mul_f32 v33, v33, v4
  v_mul_f32 v34, v34, v4
  v_mul_f32 v35, v35, v4
  v_mul_f32 v36, v36, v4
  v_mul_f32 v37, v37, v4
  v_mul_f32 v38, v38, v4
  v_mul_f32 v39, v39, v4
  v_mul_f32 v40, v40, v4
  v_mul_f32 v41, v41, v4
  v_mul_f32 v42, v42, v4
  v_mul_f32 v43, v43, v4
  v_mul_f32 v44, v44, v4
  v_mul_f32 v45, v45, v4
  v_mul_f32 v46, v46, v4
  v_mul_f32 v47, v47, v4
  v_mul_f32 v48, v48, v4
  v_mul_f32 v49, v49, v4
  v_mul_f32 v50, v50, v4
  v_mul_f32 v51, v51, v4
  v_mul_f32 v52, v52, v4
  v_mul_f32 v53, v53, v4
  v_mul_f32 v54, v54, v4
  v_mul_f32 v55, v55, v4
  v_mul_f32 v56, v56, v4
  v_mul_f32 v57, v57, v4
  v_mul_f32 v58, v58, v4
  v_mul_f32 v59, v59, v4
  v_mul_f32 v60, v60, v4
  v_mul_f32 v61, v61, v4
  v_mul_f32 v62, v62, v4
  v_mul_f32 v63, v63, v4
  v_mul_f32 v64, v64, v4
  v_mul_f32 v65, v65, v4
  v_mul_f32 v66, v66, v4
  v_mul_f32 v67, v67, v4
  v_cvt_pk_bf16_f32 v8, v28, v29
  v_cvt_pk_bf16_f32 v9, v30, v31
  v_cvt_pk_bf16_f32 v10, v32, v33
  v_cvt_pk_bf16_f32 v11, v34, v35
  v_cvt_pk_bf16_f32 v12, v36, v37
  v_cvt_pk_bf16_f32 v13, v38, v39
  v_cvt_pk_bf16_f32 v14, v40, v41
  v_cvt_pk_bf16_f32 v15, v42, v43
  v_cvt_pk_bf16_f32 v16, v44, v45
  v_cvt_pk_bf16_f32 v17, v46, v47
  v_cvt_pk_bf16_f32 v18, v48, v49
  v_cvt_pk_bf16_f32 v19, v50, v51
  v_cvt_pk_bf16_f32 v20, v52, v53
  v_cvt_pk_bf16_f32 v21, v54, v55
  v_cvt_pk_bf16_f32 v22, v56, v57
  v_cvt_pk_bf16_f32 v23, v58, v59
  v_cvt_pk_bf16_f32 v24, v60, v61
  v_cvt_pk_bf16_f32 v25, v62, v63
  v_cvt_pk_bf16_f32 v26, v64, v65
  v_cvt_pk_bf16_f32 v27, v66, v67
  v_and_b32 v3, 63, v0
  v_lshlrev_b32 v1, 4, v3
  s_mul_i32 s17, s2, 20480
  s_mul_i32 s18, s16, 5120
  s_add_u32 s17, s17, s18
  s_add_u32 s17, s17, 87556096
  buffer_store_dwordx4 v[8:11], v1, s[4:7], s17 offen offset:0 sc1
  buffer_store_dwordx4 v[12:15], v1, s[4:7], s17 offen offset:1024 sc1
  buffer_store_dwordx4 v[16:19], v1, s[4:7], s17 offen offset:2048 sc1
  buffer_store_dwordx4 v[20:23], v1, s[4:7], s17 offen offset:3072 sc1
  s_add_u32 s17, s17, 4096
  buffer_store_dwordx4 v[24:27], v1, s[4:7], s17 offen offset:0 sc1
ln2_exit1:
  s_endpgm
.globl reca_kernel
.p2align 8
.type reca_kernel,@function
reca_kernel:
  s_cmp_ge_u32 s2, 256
  s_cbranch_scc1 reca_exitb3
  s_load_dwordx2 s[48:49], s[0:1], 96
  s_load_dwordx2 s[50:51], s[0:1], 88
  s_load_dwordx2 s[52:53], s[0:1], 8
  s_getreg_b32 s42, hwreg(HW_REG_XCC_ID, 0, 3)
  v_lshrrev_b32 v28, 6, v0
  v_and_b32 v29, 63, v0
  s_and_b32 s13, s2, 7
  v_readfirstlane_b32 s12, v28
  v_lshlrev_b32 v1, 4, v29
  s_lshr_b32 s14, s2, 3
  s_mov_b32 s18, 0x100000
  s_waitcnt lgkmcnt(0)
  s_mov_b32 s57, 0
  s_mov_b32 s4, s48
  s_mov_b32 s5, s49
  s_mov_b32 s6, 0x10000000
  s_mov_b32 s7, 0x20000
  s_mov_b32 s8, s50
  s_mov_b32 s9, s51
  s_mov_b32 s10, 256
  s_mov_b32 s11, 0x20000
  v_add_u32 v2, 0x1000, v1
  v_add_u32 v3, 0x2000, v1
  v_mov_b32 v31, 0x80000000
  s_lshl_b32 s34, s42, 3
  s_lshl_b64 s[36:37], 1, s34
  s_lshl_b32 s34, s13, 3
  v_cmp_eq_u32 vcc, 0, v0
  v_mov_b32 v30, s34
  s_nop 0
  v_cndmask_b32 v30, v31, v30, vcc
  v_mov_b32 v44, s36
  v_mov_b32 v45, s37
  buffer_atomic_add_x2 v[44:45], v30, s[8:11], 0 offen
  s_sub_u32 s56, 0, s48
  s_and_b32 s56, s56, 0x1fffff
  s_add_u32 s56, s56, 2097152
  s_nop 0
  s_cmp_ge_u32 s14, 24
  s_cbranch_scc1 reca_proj2
  s_mul_i32 s34, s14, 43
  s_lshr_b32 s34, s34, 8
  s_mul_i32 s35, s34, 6
  s_sub_u32 s16, s14, s35
  s_lshl_b32 s15, s13, 2
  s_add_u32 s15, s15, s34
  s_lshr_b32 s19, s12, 1
  s_and_b32 s37, s12, 1
  s_mul_i32 s34, s15, 12
  s_lshl_b32 s35, s16, 1
  s_add_u32 s34, s34, s35
  s_add_u32 s34, s34, s37
  s_mul_i32 s34, s34, 20480
  s_mov_b32 s35, 14155776
  s_cmp_eq_u32 s19, 0
  s_cselect_b32 s35, 6291456, s35
  s_add_u32 s35, s35, s34
  s_mul_i32 s36, s19, 10240
  s_add_u32 s20, s35, s36
  s_sub_u32 s36, 10240, s36
  s_add_u32 s21, s35, s36
  s_add_u32 s22, s34, 22020096
  s_mul_i32 s36, s19, 10240
  s_add_u32 s22, s22, s36
  buffer_load_dwordx4 a[0:3], v1, s[4:7], s20 offen offset:0
  buffer_load_dwordx4 a[4:7], v1, s[4:7], s20 offen offset:1024
  buffer_load_dwordx4 a[8:11], v1, s[4:7], s20 offen offset:2048
  buffer_load_dwordx4 a[12:15], v1, s[4:7], s20 offen offset:3072
  buffer_load_dwordx4 a[16:19], v2, s[4:7], s20 offen offset:0
  buffer_load_dwordx4 a[20:23], v2, s[4:7], s20 offen offset:1024
  buffer_load_dwordx4 a[24:27], v2, s[4:7], s20 offen offset:2048
  buffer_load_dwordx4 a[28:31], v2, s[4:7], s20 offen offset:3072
  buffer_load_dwordx4 a[32:35], v3, s[4:7], s20 offen offset:0
  buffer_load_dwordx4 a[36:39], v3, s[4:7], s20 offen offset:1024
  buffer_load_dwordx4 a[40:43], v1, s[4:7], s21 offen offset:0
  buffer_load_dwordx4 a[44:47], v1, s[4:7], s21 offen offset:1024
  buffer_load_dwordx4 a[48:51], v1, s[4:7], s21 offen offset:2048
  buffer_load_dwordx4 a[52:55], v1, s[4:7], s21 offen offset:3072
  buffer_load_dwordx4 a[56:59], v2, s[4:7], s21 offen offset:0
  buffer_load_dwordx4 a[60:63], v2, s[4:7], s21 offen offset:1024
  buffer_load_dwordx4 a[64:67], v2, s[4:7], s21 offen offset:2048
  buffer_load_dwordx4 a[68:71], v2, s[4:7], s21 offen offset:3072
  buffer_load_dwordx4 a[72:75], v3, s[4:7], s21 offen offset:0
  buffer_load_dwordx4 a[76:79], v3, s[4:7], s21 offen offset:1024
  buffer_load_dwordx4 a[80:83], v1, s[4:7], s22 offen offset:0
  buffer_load_dwordx4 a[84:87], v1, s[4:7], s22 offen offset:1024
  buffer_load_dwordx4 a[88:91], v1, s[4:7], s22 offen offset:2048
  buffer_load_dwordx4 a[92:95], v1, s[4:7], s22 offen offset:3072
  buffer_load_dwordx4 a[96:99], v2, s[4:7], s22 offen offset:0
  buffer_load_dwordx4 a[100:103], v2, s[4:7], s22 offen offset:1024
  buffer_load_dwordx4 a[104:107], v2, s[4:7], s22 offen offset:2048
  buffer_load_dwordx4 a[108:111], v2, s[4:7], s22 offen offset:3072
  buffer_load_dwordx4 a[112:115], v3, s[4:7], s22 offen offset:0
  buffer_load_dwordx4 a[116:119], v3, s[4:7], s22 offen offset:1024
  s_cmp_ge_u32 s14, 20
  s_cbranch_scc1 reca_now24
  s_cmp_ge_u32 s12, 2
  s_cbranch_scc1 reca_now24
  s_lshl_b32 s34, s14, 1
  s_add_u32 s34, s34, s12
  s_mul_i32 s34, s34, 192
  s_mul_i32 s35, s13, 24
  s_add_u32 s34, s34, s35
  s_lshl_b32 s34, s34, 10
  s_add_u32 s34, s34, 29884416
  buffer_load_dwordx4 a[120:123], v1, s[4:7], s34 offen offset:0
  buffer_load_dwordx4 a[124:127], v1, s[4:7], s34 offen offset:1024
  buffer_load_dwordx4 a[128:131], v1, s[4:7], s34 offen offset:2048
  buffer_load_dwordx4 a[132:135], v1, s[4:7], s34 offen offset:3072
  buffer_load_dwordx4 a[136:139], v2, s[4:7], s34 offen offset:0
  buffer_load_dwordx4 a[140:143], v2, s[4:7], s34 offen offset:1024
  buffer_load_dwordx4 a[144:147], v2, s[4:7], s34 offen offset:2048
  buffer_load_dwordx4 a[148:151], v2, s[4:7], s34 offen offset:3072
  buffer_load_dwordx4 a[152:155], v3, s[4:7], s34 offen offset:0
  buffer_load_dwordx4 a[156:159], v3, s[4:7], s34 offen offset:1024
  buffer_load_dwordx4 a[160:163], v3, s[4:7], s34 offen offset:2048
  buffer_load_dwordx4 a[164:167], v3, s[4:7], s34 offen offset:3072
  s_add_u32 s34, s34, 12288
  buffer_load_dwordx4 a[168:171], v1, s[4:7], s34 offen offset:0
  buffer_load_dwordx4 a[172:175], v1, s[4:7], s34 offen offset:1024
  buffer_load_dwordx4 a[176:179], v1, s[4:7], s34 offen offset:2048
  buffer_load_dwordx4 a[180:183], v1, s[4:7], s34 offen offset:3072
  buffer_load_dwordx4 a[184:187], v2, s[4:7], s34 offen offset:0
  buffer_load_dwordx4 a[188:191], v2, s[4:7], s34 offen offset:1024
  buffer_load_dwordx4 a[192:195], v2, s[4:7], s34 offen offset:2048
  buffer_load_dwordx4 a[196:199], v2, s[4:7], s34 offen offset:3072
  buffer_load_dwordx4 a[200:203], v3, s[4:7], s34 offen offset:0
  buffer_load_dwordx4 a[204:207], v3, s[4:7], s34 offen offset:1024
  buffer_load_dwordx4 a[208:211], v3, s[4:7], s34 offen offset:2048
  buffer_load_dwordx4 a[212:215], v3, s[4:7], s34 offen offset:3072
reca_now24:
  v_and_b32 v29, 63, v0
  v_and_b32 v28, 15, v29
  v_lshrrev_b32 v30, 4, v29
  v_mov_b32 v32, -1
  v_mov_b32 v33, -1
  v_mov_b32 v34, -1
  v_mov_b32 v35, -1
  s_mul_i32 s34, s12, 2560
  v_add_u32 v4, s34, v1
  v_and_b32 v44, 31, v29
  v_lshlrev_b32 v44, 4, v44
  s_add_u32 s34, s34, 2048
  v_add_u32 v5, s34, v44
  v_and_b32 v44, 7, v29
  v_lshlrev_b32 v44, 4, v44
  v_lshl_add_u32 v44, v30, 7, v44
  s_mul_i32 s34, s19, 5120
  v_add_u32 v6, s34, v44
  s_sub_u32 s34, 5120, s34
  v_add_u32 v7, s34, v44
  v_lshrrev_b32 v45, 3, v28
  v_lshl_add_u32 v12, v45, 9, v44
  s_mul_i32 s34, s19, 5120
  v_add_u32 v236, s34, v12
  s_sub_u32 s34, 5120, s34
  v_add_u32 v237, s34, v12
  v_add_u32 v13, 0x1000, v12
  v_add_u32 v14, 0x2000, v12
  v_cmp_gt_u32 s[54:55], 8, v28
  s_lshl_b32 s34, s16, 10
  s_lshl_b32 s35, s19, 7
  s_add_u32 s34, s34, s35
  s_and_b32 s35, s12, 1
  s_lshl_b32 s36, s35, 3
  s_add_u32 s34, s34, s36
  v_lshlrev_b32 v44, 4, v28
  v_lshl_add_u32 v45, v30, 8, v44
  v_add_u32 v45, s34, v45
  v_cndmask_b32 v8, v31, v45, s[54:55]
  v_lshl_add_u32 v44, v30, 7, v44
  v_add_u32 v45, s36, v44
  v_cndmask_b32 v9, v31, v45, s[54:55]
  s_lshl_b32 s34, s14, 9
  v_add_u32 v45, s34, v44
  v_cndmask_b32 v11, v31, v45, s[54:55]
  s_mul_i32 s34, s13, 49152
  s_lshr_b32 s35, s14, 3
  s_lshl_b32 s35, s35, 14
  s_add_u32 s34, s34, s35
  s_and_b32 s35, s14, 7
  s_lshl_b32 s35, s35, 10
  s_add_u32 s34, s34, s35
  s_lshl_b32 s35, s12, 9
  s_add_u32 s34, s34, s35
  v_add_u32 v45, s34, v44
  v_cndmask_b32 v15, v31, v45, s[54:55]
  s_cmp_lt_u32 s14, 20
  s_cselect_b32 s34, 0, 0x80000000
  v_or_b32 v15, s34, v15
  v_lshlrev_b32 v45, 3, v29
  v_cmp_gt_u32 vcc, 32, v29
  s_nop 1
  v_cndmask_b32 v10, v31, v45, vcc
  s_sub_u32 s35, s14, 4
  s_cmp_lt_u32 s14, 20
  s_cselect_b32 s34, s14, s35
  s_lshr_b32 s35, s34, 3
  s_lshl_b32 s35, s35, 14
  s_and_b32 s34, s34, 7
  s_lshl_b32 s34, s34, 10
  s_add_u32 s34, s34, s35
  v_add_u32 v20, s34, v1
  v_add_u32 v21, 49152, v20
  v_add_u32 v22, 98304, v20
  v_add_u32 v23, 147456, v20
  v_add_u32 v24, 196608, v20
  v_add_u32 v25, 245760, v20
  v_add_u32 v26, 294912, v20
  v_add_u32 v27, 344064, v20
  v_lshrrev_b32 v44, 3, v29
  v_and_b32 v44, 3, v44
  v_lshlrev_b32 v44, 7, v44
  v_and_b32 v45, 7, v29
  v_lshl_add_u32 v44, v45, 4, v44
  v_lshrrev_b32 v45, 5, v29
  v_lshl_add_u32 v44, v45, 3, v44
  s_lshl_b32 s34, s14, 9
  s_cmp_lt_u32 s14, 20
  s_cselect_b32 s34, s34, 0x80000000
  v_add_u32 v16, s34, v44
  v_cmp_eq_u32 vcc, 0, v29
  v_mov_b32 v45, 0
  s_nop 0
  v_cndmask_b32 v19, v31, v45, vcc
  s_lshl_b32 s34, s15, 8
  s_add_u32 s34, s34, 1540096
  v_and_b32 v45, 1, v29
  v_lshlrev_b32 v45, 7, v45
  v_add_u32 v233, s34, v45
  s_lshl_b32 s34, s12, 10
  s_add_u32 s34, s34, 10240
  v_add_u32 v17, s34, v1
  v_mov_b32 v36, 0x3f803f80
  v_mov_b32 v37, 0x3f803f80
  v_mov_b32 v38, 0x3f803f80
  v_mov_b32 v39, 0x3f803f80
  v_mov_b32 v44, 0xf149f2ca
  v_cmp_gt_u32 vcc, 2, v30
  s_nop 1
  v_cndmask_b32 v40, 0, v44, vcc
  v_mov_b32 v41, v40
  v_mov_b32 v42, v40
  v_mov_b32 v43, v40
  v_and_b32 v44, 31, v29
  v_lshlrev_b32 v44, 4, v44
  v_add_u32 v45, 58195968, v44
  v_add_u32 v44, 56623104, v44
  v_cmp_gt_u32 vcc, 32, v29
  s_nop 1
  v_cndmask_b32 v238, v45, v44, vcc
  s_mov_b32 s41, 0x3dd53b95
  s_mul_i32 s38, s13, 40960
  s_add_u32 s38, s38, 0
  s_mul_i32 s39, s15, 24576
  s_add_u32 s39, s39, 327680
  s_mul_i32 s40, s13, 49152
  s_add_u32 s40, s40, 1114112
  s_mov_b32 s60, s52
  s_mov_b32 s61, s53
  s_mov_b32 s62, 10240
  s_mov_b32 s63, 0x20000
  v_and_b32 v29, 63, v0
  v_and_b32 v44, 7, v29
  v_mul_u32_u24 v44, 1280, v44
  v_lshrrev_b32 v45, 3, v29
  v_and_b32 v45, 3, v45
  v_lshl_add_u32 v44, v45, 4, v44
  s_mul_i32 s34, s12, 320
  v_add_u32 v44, s34, v44
  v_add_u32 v46, 256, v44
  v_lshrrev_b32 v45, 5, v29
  v_lshl_add_u32 v44, v45, 6, v44
  buffer_load_dwordx4 v[128:131], v44, s[60:63], 0 offen
  buffer_load_dwordx4 v[132:135], v44, s[60:63], 0 offen offset:128
  buffer_load_dwordx4 v[136:139], v46, s[60:63], 0 offen
  v_and_b32 v44, 63, v0
  v_and_b32 v45, 3, v44
  v_lshlrev_b32 v45, 21, v45
  v_min_u32 v45, 1572800, v45
  v_add_u32 v46, 56623104, v45
  v_add_u32 v45, 58195968, v45
  v_cmp_gt_u32 vcc, 4, v44
  s_nop 1
  v_cndmask_b32 v46, v45, v46, vcc
  s_mul_i32 s34, s15, 196608
  v_and_b32 v45, 1, v44
  v_mul_u32_u24 v45, 196544, v45
  v_add_u32 v45, s34, v45
  v_add_u32 v28, 37748736, v45
  v_add_u32 v45, 44040192, v45
  v_cmp_gt_u32 vcc, 10, v44
  s_nop 1
  v_cndmask_b32 v45, v45, v28, vcc
  v_cmp_gt_u32 vcc, 8, v44
  s_nop 1
  v_cndmask_b32 v46, v45, v46, vcc
  v_cmp_gt_u32 vcc, 12, v44
  s_nop 1
  v_cndmask_b32 v46, v31, v46, vcc
  buffer_load_dword v234, v46, s[4:7], 0 offen
  v_and_b32 v44, 63, v0
  v_lshlrev_b32 v45, 21, v44
  v_min_u32 v45, 25165760, v45
  v_add_u32 v45, 59768832, v45
  s_lshl_b32 s34, s13, 2
  s_add_u32 s34, s34, s14
  s_sub_u32 s34, s34, 20
  s_and_b32 s34, s34, 31
  s_mul_i32 s34, s34, 196608
  s_add_u32 s34, s34, 50331648
  v_and_b32 v46, 1, v44
  v_mul_u32_u24 v46, 196544, v46
  v_add_u32 v46, s34, v46
  v_cmp_gt_u32 vcc, 13, v44
  s_nop 1
  v_cndmask_b32 v46, v46, v45, vcc
  v_cmp_gt_u32 vcc, 15, v44
  s_nop 1
  v_cndmask_b32 v46, v31, v46, vcc
  buffer_load_dword v235, v46, s[4:7], 0 offen
  v_and_b32 v30, 7, v0
  v_lshlrev_b32 v30, 3, v30
reca_cens5:
  buffer_load_dwordx2 v[28:29], v30, s[8:11], 0 offen sc1
  s_waitcnt vmcnt(0)
  v_sad_u8 v31, v28, 0, 0
  v_sad_u8 v31, v29, 0, v31
  v_cmp_gt_u32 vcc, 32, v31
  s_cbranch_vccz reca_censok6
  s_sleep 8
  s_sub_u32 s18, s18, 1
  s_cbranch_scc0 reca_cens5
  s_mov_b32 s18, 0
reca_censok6:
  v_and_b32 v28, 0x20202020, v28
  v_and_b32 v29, 0x20202020, v29
  v_cmp_ne_u32 s[34:35], 0, v28
  v_cmp_ne_u32 s[36:37], 0, v29
  s_nop 3
  s_and_b32 s34, s34, 0xff
  s_and_b32 s36, s36, 0xff
  s_or_b32 s35, s34, s36
  s_lshr_b32 s37, s35, s13
  s_and_b32 s37, s37, 1
  s_xor_b32 s43, s37, 1
  s_cmp_eq_u32 s57, 0
  s_cselect_b32 s58, s36, s34
  v_mov_b32 v31, 0x80000000
  v_add_u32 v232, 0x2000, v15
  s_lshr_b32 s44, s2, 4
  s_lshl_b32 s44, s44, 14
  s_and_b32 s34, s2, 15
  s_lshl_b32 s34, s34, 9
  s_add_u32 s44, s44, s34
  s_add_u32 s44, s44, 1572864
  s_add_u32 s44, s44, s56
  s_mov_b32 s45, -1
  s_mov_b32 s47, -1
  s_cmp_lg_u32 s12, 2
  s_cbranch_scc1 reca_noprobe7
  s_add_u32 s35, s44, 0
  s_memtime s[60:61]
  s_waitcnt lgkmcnt(0)
  buffer_load_dword v28, v19, s[4:7], s35 offen sc1
  s_waitcnt vmcnt(0)
  s_memtime s[62:63]
  s_waitcnt lgkmcnt(0)
  s_sub_u32 s36, s62, s60
  s_min_u32 s45, s45, s36
  s_add_u32 s35, s44, 8192
  s_memtime s[60:61]
  s_waitcnt lgkmcnt(0)
  buffer_load_dword v28, v19, s[4:7], s35 offen sc1
  s_waitcnt vmcnt(0)
  s_memtime s[62:63]
  s_waitcnt lgkmcnt(0)
  s_sub_u32 s36, s62, s60
  s_min_u32 s47, s47, s36
  s_add_u32 s35, s44, 128
  s_memtime s[60:61]
  s_waitcnt lgkmcnt(0)
  buffer_load_dword v28, v19, s[4:7], s35 offen sc1
  s_waitcnt vmcnt(0)
  s_memtime s[62:63]
  s_waitcnt lgkmcnt(0)
  s_sub_u32 s36, s62, s60
  s_min_u32 s45, s45, s36
  s_add_u32 s35, s44, 8320
  s_memtime s[60:61]
  s_waitcnt lgkmcnt(0)
  buffer_load_dword v28, v19, s[4:7], s35 offen sc1
  s_waitcnt vmcnt(0)
  s_memtime s[62:63]
  s_waitcnt lgkmcnt(0)
  s_sub_u32 s36, s62, s60
  s_min_u32 s47, s47, s36
  s_add_u32 s35, s44, 256
  s_memtime s[60:61]
  s_waitcnt lgkmcnt(0)
  buffer_load_dword v28, v19, s[4:7], s35 offen sc1
  s_waitcnt vmcnt(0)
  s_memtime s[62:63]
  s_waitcnt lgkmcnt(0)
  s_sub_u32 s36, s62, s60
  s_min_u32 s45, s45, s36
  s_add_u32 s35, s44, 8448
  s_memtime s[60:61]
  s_waitcnt lgkmcnt(0)
  buffer_load_dword v28, v19, s[4:7], s35 offen sc1
  s_waitcnt vmcnt(0)
  s_memtime s[62:63]
  s_waitcnt lgkmcnt(0)
  s_sub_u32 s36, s62, s60
  s_min_u32 s47, s47, s36
  s_cmp_lt_u32 s47, s45
  s_cbranch_scc0 reca_noprobe7
  v_add_u32 v20, 0x2000, v20
  v_add_u32 v21, 0x2000, v21
  v_add_u32 v22, 0x2000, v22
  v_add_u32 v23, 0x2000, v23
  v_add_u32 v24, 0x2000, v24
  v_add_u32 v25, 0x2000, v25
  v_add_u32 v26, 0x2000, v26
  v_add_u32 v27, 0x2000, v27
reca_noprobe7:
  s_lshl_b32 s59, s13, 2
  s_add_u32 s59, s59, s14
  s_sub_u32 s59, s59, 20
  v_and_b32 v29, 63, v0
  v_and_b32 v28, 15, v29
  v_lshrrev_b32 v30, 4, v29
  v_lshlrev_b32 v92, 4, v28
  v_lshl_add_u32 v92, v30, 7, v92
  v_cmp_gt_u32 vcc, 8, v28
  s_nop 1
  v_cndmask_b32 v92, v31, v92, vcc
  v_lshlrev_b32 v93, 3, v29
  v_cmp_gt_u32 vcc, 32, v29
  s_nop 1
  v_cndmask_b32 v93, v31, v93, vcc
  v_mov_b32 v82, 0xf149f2ca
  v_cmp_le_u32 vcc, 2, v30
  s_nop 1
  v_cndmask_b32 v84, 0, v82, vcc
  v_mov_b32 v85, v84
  v_mov_b32 v86, v84
  v_mov_b32 v87, v84
  v_lshlrev_b32 v30, 2, v30
  v_add_u32 v29, 0, v30
  v_cmp_gt_u32 vcc, v29, v28
  s_nop 1
  v_cndmask_b32 v88, 0, v82, vcc
  v_add_u32 v29, 1, v30
  v_cmp_gt_u32 vcc, v29, v28
  s_nop 1
  v_cndmask_b32 v89, 0, v82, vcc
  v_add_u32 v29, 2, v30
  v_cmp_gt_u32 vcc, v29, v28
  s_nop 1
  v_cndmask_b32 v90, 0, v82, vcc
  v_add_u32 v29, 3, v30
  v_cmp_gt_u32 vcc, v29, v28
  s_nop 1
  v_cndmask_b32 v91, 0, v82, vcc
  s_mov_b32 s17, 0
  s_cmp_lg_u32 s12, 3
  s_cbranch_scc1 reca_nopf08
  s_add_u32 s37, s17, 1
reca_pf9:
  buffer_load_dword v28, v233, s[4:7], 0 offen sc1
  s_waitcnt vmcnt(0)
  v_cmp_gt_i32 vcc, s37, v28
  s_cbranch_vccz reca_pfok10
  s_sleep 1
  s_sub_u32 s18, s18, 1
  s_cbranch_scc0 reca_pf9
  s_mov_b32 s18, 0
reca_pfok10:
  s_lshl_b32 s34, s15, 4
  s_and_b32 s35, s17, 15
  s_add_u32 s34, s34, s35
  s_mul_i32 s34, s34, 12288
  s_add_u32 s32, s34, 37748736
  s_lshl_b32 s35, s16, 11
  s_add_u32 s34, s34, s35
  s_add_u32 s33, s34, 44040192
  buffer_load_dwordx4 a[120:123], v1, s[4:7], s32 offen offset:0 sc1
  buffer_load_dwordx4 a[124:127], v1, s[4:7], s32 offen offset:1024 sc1
  buffer_load_dwordx4 a[128:131], v1, s[4:7], s32 offen offset:2048 sc1
  buffer_load_dwordx4 a[132:135], v1, s[4:7], s32 offen offset:3072 sc1
  buffer_load_dwordx4 a[136:139], v2, s[4:7], s32 offen offset:0 sc1
  buffer_load_dwordx4 a[140:143], v2, s[4:7], s32 offen offset:1024 sc1
  buffer_load_dwordx4 a[144:147], v2, s[4:7], s32 offen offset:2048 sc1
  buffer_load_dwordx4 a[148:151], v2, s[4:7], s32 offen offset:3072 sc1
  buffer_load_dwordx4 a[152:155], v3, s[4:7], s32 offen offset:0 sc1
  buffer_load_dwordx4 a[156:159], v3, s[4:7], s32 offen offset:1024 sc1
  buffer_load_dwordx4 a[160:163], v3, s[4:7], s32 offen offset:2048 sc1
  buffer_load_dwordx4 a[164:167], v3, s[4:7], s32 offen offset:3072 sc1
  buffer_load_dwordx4 a[168:171], v1, s[4:7], s33 offen offset:0 sc1
  buffer_load_dwordx4 a[172:175], v1, s[4:7], s33 offen offset:1024 sc1
  s_waitcnt vmcnt(0)
reca_nopf08:
  s_cmp_lg_u32 s43, 0
  s_cbranch_scc1 reca_slow11
  s_cmp_ge_u32 s14, 20
  s_cbranch_scc1 reca_twinf12
  s_branch reca_gotmem15
reca_step14:
  s_and_b32 s34, s17, 3
  s_mul_i32 s20, s34, 10240
  s_add_u32 s20, s20, s38
  s_sleep 2
  buffer_load_dwordx4 v[128:131], v4, s[4:7], s20 offen sc1
  buffer_load_dwordx4 v[132:135], v4, s[4:7], s20 offen offset:1024 sc1
  buffer_load_dwordx4 v[136:139], v5, s[4:7], s20 offen sc1
  s_waitcnt vmcnt(2)
  v_max_u32 v29, v128, v130
  v_cmp_eq_u32 vcc, -1, v29
  s_cbranch_vccnz reca_retry17
reca_resume18:
  s_waitcnt vmcnt(1)
  v_max_u32 v29, v132, v134
  v_cmp_eq_u32 vcc, -1, v29
  ds_write_b128 v4, v[128:131]
  s_cbranch_vccnz reca_retry19
reca_resume20:
  s_waitcnt vmcnt(0)
  v_max_u32 v29, v136, v138
  v_cmp_eq_u32 vcc, -1, v29
  ds_write_b128 v4, v[132:135] offset:1024
  s_cbranch_vccnz reca_retry21
reca_resume22:
  ds_write_b128 v5, v[136:139]
  s_branch reca_gotmem216
reca_gotmem15:
  ds_write_b128 v4, v[128:131]
  ds_write_b128 v4, v[132:135] offset:1024
  ds_write_b128 v5, v[136:139]
reca_gotmem216:
  s_and_b32 s34, s17, 3
  s_mul_i32 s21, s34, 6144
  s_add_u32 s21, s21, s39
  s_mul_i32 s22, s34, 12288
  s_add_u32 s22, s22, s40
  s_mul_i32 s25, s34, 393216
  s_add_u32 s25, s25, s56
  s_add_u32 s35, s17, 1
  s_and_b32 s35, s35, 3
  s_mul_i32 s24, s35, 10240
  s_add_u32 s24, s24, s38
  s_waitcnt lgkmcnt(0)
  s_barrier
  ds_read_b128 v[128:131], v236 offset:0
  ds_read_b128 v[132:135], v236 offset:1024
  ds_read_b128 v[136:139], v236 offset:2048
  ds_read_b128 v[140:143], v236 offset:3072
  ds_read_b128 v[144:147], v236 offset:4096
  ds_read_b128 v[148:151], v237 offset:0
  ds_read_b128 v[152:155], v237 offset:1024
  ds_read_b128 v[156:159], v237 offset:2048
  ds_read_b128 v[160:163], v237 offset:3072
  ds_read_b128 v[164:167], v237 offset:4096
  s_waitcnt lgkmcnt(9)
  v_mfma_f32_16x16x32_bf16 v[44:47], a[0:3], v[128:131], 0
  ds_read_b128 v[168:171], v6 offset:0
  v_mfma_f32_16x16x32_bf16 v[240:243], a[4:7], v[128:131], 0
  s_waitcnt lgkmcnt(9)
  v_mfma_f32_16x16x32_bf16 v[44:47], a[8:11], v[132:135], v[44:47]
  ds_read_b128 v[172:175], v6 offset:512
  v_mfma_f32_16x16x32_bf16 v[240:243], a[12:15], v[132:135], v[240:243]
  s_waitcnt lgkmcnt(9)
  v_mfma_f32_16x16x32_bf16 v[44:47], a[16:19], v[136:139], v[44:47]
  ds_read_b128 v[176:179], v6 offset:1024
  v_mfma_f32_16x16x32_bf16 v[240:243], a[20:23], v[136:139], v[240:243]
  s_waitcnt lgkmcnt(9)
  v_mfma_f32_16x16x32_bf16 v[44:47], a[24:27], v[140:143], v[44:47]
  ds_read_b128 v[180:183], v6 offset:1536
  v_mfma_f32_16x16x32_bf16 v[240:243], a[28:31], v[140:143], v[240:243]
  s_waitcnt lgkmcnt(9)
  v_mfma_f32_16x16x32_bf16 v[44:47], a[32:35], v[144:147], v[44:47]
  ds_read_b128 v[184:187], v6 offset:2048
  v_mfma_f32_16x16x32_bf16 v[240:243], a[36:39], v[144:147], v[240:243]
  s_waitcnt lgkmcnt(9)
  v_mfma_f32_16x16x32_bf16 v[44:47], a[40:43], v[148:151], v[44:47]
  ds_read_b128 v[188:191], v6 offset:2560
  v_mfma_f32_16x16x32_bf16 v[240:243], a[44:47], v[148:151], v[240:243]
  s_waitcnt lgkmcnt(9)
  v_mfma_f32_16x16x32_bf16 v[44:47], a[48:51], v[152:155], v[44:47]
  ds_read_b128 v[192:195], v6 offset:3072
  v_mfma_f32_16x16x32_bf16 v[240:243], a[52:55], v[152:155], v[240:243]
  s_waitcnt lgkmcnt(9)
  v_mfma_f32_16x16x32_bf16 v[44:47], a[56:59], v[156:159], v[44:47]
  ds_read_b128 v[196:199], v6 offset:3584
  v_mfma_f32_16x16x32_bf16 v[240:243], a[60:63], v[156:159], v[240:243]
  s_waitcnt lgkmcnt(9)
  v_mfma_f32_16x16x32_bf16 v[44:47], a[64:67], v[160:163], v[44:47]
  ds_read_b128 v[200:203], v6 offset:4096
  v_mfma_f32_16x16x32_bf16 v[240:243], a[68:71], v[160:163], v[240:243]
  s_waitcnt lgkmcnt(9)
  v_mfma_f32_16x16x32_bf16 v[44:47], a[72:75], v[164:167], v[44:47]
  ds_read_b128 v[204:207], v6 offset:4608
  v_mfma_f32_16x16x32_bf16 v[240:243], a[76:79], v[164:167], v[240:243]
  s_waitcnt lgkmcnt(9)
  v_mfma_f32_16x16x32_bf16 v[48:51], v[168:171], a[80:83], 0
  s_and_b32 s34, s17, 15
  s_lshl_b32 s34, s34, 5
  s_add_u32 s34, s34, s15
  s_mul_i32 s34, s34, 3072
  s_lshl_b32 s35, s16, 9
  s_add_u32 s34, s34, s35
  s_add_u32 s30, s34, 56623104
  s_add_u32 s31, s34, 58195968
  v_add_f32_dpp v44, v240, v44 row_ror:8 row_mask:0xf bank_mask:0xf
  v_add_f32_dpp v45, v241, v45 row_ror:8 row_mask:0xf bank_mask:0xf
  v_add_f32_dpp v46, v242, v46 row_ror:8 row_mask:0xf bank_mask:0xf
  v_add_f32_dpp v47, v243, v47 row_ror:8 row_mask:0xf bank_mask:0xf
  v_cvt_pk_bf16_f32 v52, v44, v45
  v_cvt_pk_bf16_f32 v53, v46, v47
  buffer_store_dwordx2 v[52:53], v8, s[4:7], s21 offen
  s_waitcnt lgkmcnt(8)
  v_mfma_f32_16x16x32_bf16 v[48:51], v[172:175], a[84:87], v[48:51]
  s_waitcnt lgkmcnt(7)
  v_mfma_f32_16x16x32_bf16 v[48:51], v[176:179], a[88:91], v[48:51]
  s_waitcnt lgkmcnt(6)
  v_mfma_f32_16x16x32_bf16 v[48:51], v[180:183], a[92:95], v[48:51]
  s_waitcnt lgkmcnt(5)
  v_mfma_f32_16x16x32_bf16 v[48:51], v[184:187], a[96:99], v[48:51]
  s_waitcnt lgkmcnt(4)
  v_mfma_f32_16x16x32_bf16 v[48:51], v[188:191], a[100:103], v[48:51]
  s_waitcnt lgkmcnt(3)
  v_mfma_f32_16x16x32_bf16 v[48:51], v[192:195], a[104:107], v[48:51]
  s_waitcnt lgkmcnt(2)
  v_mfma_f32_16x16x32_bf16 v[48:51], v[196:199], a[108:111], v[48:51]
  s_waitcnt lgkmcnt(1)
  v_mfma_f32_16x16x32_bf16 v[48:51], v[200:203], a[112:115], v[48:51]
  s_waitcnt lgkmcnt(0)
  v_mfma_f32_16x16x32_bf16 v[48:51], v[204:207], a[116:119], v[48:51]
  s_cmp_eq_u32 s12, 3
  s_cbranch_scc1 reca_swave23
  s_nop 5
  ds_write_b128 v17, v[48:51]
  s_add_u32 s34, s17, 2
  s_and_b32 s34, s34, 3
  s_mul_i32 s26, s34, 10240
  s_add_u32 s26, s26, s38
  s_mul_i32 s27, s34, 6144
  s_add_u32 s27, s27, s39
  s_mul_i32 s28, s34, 12288
  s_add_u32 s28, s28, s40
  s_mul_i32 s29, s34, 393216
  s_add_u32 s29, s29, s56
  s_waitcnt lgkmcnt(0)
  s_barrier
  s_cmp_eq_u32 s17, 63
  s_cbranch_scc1 reca_last25
  buffer_store_dwordx2 v[32:33], v8, s[4:7], s27 offen
  s_cmp_lg_u32 s12, 2
  s_cbranch_scc1 reca_b326
  buffer_store_dwordx2 v[52:53], v9, s[4:7], s30 offen
  buffer_store_dwordx2 v[32:33], v16, s[4:7], s26 offen
  s_cmp_lg_u32 s14, 0
  s_cbranch_scc1 reca_b326
  v_mov_b32 v28, s17
  s_lshl_b32 s34, s13, 7
  s_add_u32 s34, s34, 1507328
  buffer_store_dword v28, v19, s[4:7], s34 offen
  s_branch reca_b326
reca_last25:
  s_cmp_lg_u32 s12, 2
  s_cbranch_scc1 reca_exit1
  buffer_store_dwordx2 v[52:53], v9, s[4:7], s30 offen
  s_branch reca_exit1
reca_swave23:
  s_cmp_lg_u32 s17, 63
  s_cbranch_scc1 reca_vmst29
  s_barrier
  ds_read_b128 v[56:59], v1 offset:10240
  ds_read_b128 v[60:63], v1 offset:11264
  ds_read_b128 v[64:67], v1 offset:12288
  s_waitcnt lgkmcnt(0)
  v_add_f32 v56, v56, v64
  v_add_f32 v60, v60, v48
  v_add_f32 v57, v57, v65
  v_add_f32 v61, v61, v49
  v_add_f32 v58, v58, v66
  v_add_f32 v62, v62, v50
  v_add_f32 v59, v59, v67
  v_add_f32 v63, v63, v51
  v_cvt_pk_bf16_f32 v68, v56, v57
  v_cvt_pk_bf16_f32 v69, v58, v59
  v_cvt_pk_bf16_f32 v70, v60, v61
  v_cvt_pk_bf16_f32 v71, v62, v63
  buffer_store_dwordx2 v[52:53], v9, s[4:7], s30 offen
  buffer_store_dwordx2 v[68:69], v10, s[4:7], s31 offen
  buffer_store_dwordx2 v[70:71], v10, s[4:7], s31 offen offset:256
  s_branch reca_exit1
reca_vmst29:
  s_sleep 1
  buffer_load_dwordx4 v[208:211], v1, s[4:7], s21 offen offset:0 sc1
  buffer_load_dwordx4 v[212:215], v1, s[4:7], s21 offen offset:1024 sc1
  buffer_load_dwordx4 v[216:219], v1, s[4:7], s21 offen offset:2048 sc1
  buffer_load_dwordx4 v[220:223], v1, s[4:7], s21 offen offset:3072 sc1
  buffer_load_dwordx4 v[224:227], v2, s[4:7], s21 offen offset:0 sc1
  buffer_load_dwordx4 v[228:231], v2, s[4:7], s21 offen offset:1024 sc1
  s_waitcnt vmcnt(5)
  v_max_u32 v29, v208, v210
  v_cmp_eq_u32 vcc, -1, v29
  s_cbranch_vccnz reca_retry30
reca_resume31:
  s_waitcnt vmcnt(4)
  v_max_u32 v29, v212, v214
  v_cmp_eq_u32 vcc, -1, v29
  v_mfma_f32_16x16x32_bf16 v[76:79], a[120:123], v[208:211], 0
  v_mfma_f32_16x16x32_bf16 v[80:83], a[144:147], v[208:211], 0
  v_mfma_f32_16x16x32_bf16 v[72:75], v[208:211], v[208:211], v[40:43]
  s_cbranch_vccnz reca_retry32
reca_resume33:
  s_waitcnt vmcnt(3)
  v_max_u32 v29, v216, v218
  v_cmp_eq_u32 vcc, -1, v29
  v_mfma_f32_16x16x32_bf16 v[76:79], a[124:127], v[212:215], v[76:79]
  v_mfma_f32_16x16x32_bf16 v[80:83], a[148:151], v[212:215], v[80:83]
  v_mfma_f32_16x16x32_bf16 v[72:75], v[212:215], v[212:215], v[72:75]
  s_cbranch_vccnz reca_retry34
reca_resume35:
  s_waitcnt vmcnt(2)
  v_max_u32 v29, v220, v222
  v_cmp_eq_u32 vcc, -1, v29
  v_mfma_f32_16x16x32_bf16 v[76:79], a[128:131], v[216:219], v[76:79]
  v_mfma_f32_16x16x32_bf16 v[80:83], a[152:155], v[216:219], v[80:83]
  v_mfma_f32_16x16x32_bf16 v[72:75], v[216:219], v[216:219], v[72:75]
  s_cbranch_vccnz reca_retry36
reca_resume37:
  s_waitcnt vmcnt(1)
  v_max_u32 v29, v224, v226
  v_cmp_eq_u32 vcc, -1, v29
  v_mfma_f32_16x16x32_bf16 v[76:79], a[132:135], v[220:223], v[76:79]
  v_mfma_f32_16x16x32_bf16 v[80:83], a[156:159], v[220:223], v[80:83]
  v_mfma_f32_16x16x32_bf16 v[72:75], v[220:223], v[220:223], v[72:75]
  s_cbranch_vccnz reca_retry38
reca_resume39:
  s_waitcnt vmcnt(0)
  v_max_u32 v29, v228, v230
  v_cmp_eq_u32 vcc, -1, v29
  v_mfma_f32_16x16x32_bf16 v[76:79], a[136:139], v[224:227], v[76:79]
  v_mfma_f32_16x16x32_bf16 v[80:83], a[160:163], v[224:227], v[80:83]
  v_mfma_f32_16x16x32_bf16 v[72:75], v[224:227], v[224:227], v[72:75]
  s_cbranch_vccnz reca_retry40
reca_resume41:
  v_mfma_f32_16x16x32_bf16 v[76:79], a[140:143], v[228:231], v[76:79]
  v_mfma_f32_16x16x32_bf16 v[80:83], a[164:167], v[228:231], v[80:83]
  v_mfma_f32_16x16x32_bf16 v[72:75], v[228:231], v[228:231], v[72:75]
  s_barrier
  ds_read_b128 v[56:59], v1 offset:10240
  ds_read_b128 v[60:63], v1 offset:11264
  ds_read_b128 v[64:67], v1 offset:12288
  s_nop 1
  v_max3_f32 v28, v76, v77, v78
  v_max3_f32 v29, v80, v81, v82
  v_max3_f32 v28, v28, v79, v83
  v_max3_f32 v29, v29, v72, v73
  v_max3_f32 v28, v28, v74, v75
  v_max_f32 v28, v28, v29
  v_mov_b32 v29, v28
  s_nop 1
  v_permlane32_swap_b32 v28, v29
  v_max_f32 v28, v28, v29
  v_mov_b32 v29, v28
  s_nop 1
  v_permlane16_swap_b32 v28, v29
  v_max_f32 v28, v28, v29
  v_mul_f32 v28, s41, v28
  v_fma_f32 v76, v76, s41, -v28
  v_fma_f32 v77, v77, s41, -v28
  v_fma_f32 v78, v78, s41, -v28
  v_fma_f32 v79, v79, s41, -v28
  v_fma_f32 v80, v80, s41, -v28
  v_fma_f32 v81, v81, s41, -v28
  v_fma_f32 v82, v82, s41, -v28
  v_fma_f32 v83, v83, s41, -v28
  v_fma_f32 v72, v72, s41, -v28
  v_fma_f32 v73, v73, s41, -v28
  v_fma_f32 v74, v74, s41, -v28
  v_fma_f32 v75, v75, s41, -v28
  v_exp_f32 v76, v76
  v_exp_f32 v77, v77
  v_exp_f32 v78, v78
  v_exp_f32 v79, v79
  v_exp_f32 v80, v80
  v_exp_f32 v81, v81
  v_exp_f32 v82, v82
  v_exp_f32 v83, v83
  v_cvt_pk_bf16_f32 v84, v76, v77
  v_cvt_pk_bf16_f32 v85, v78, v79
  v_cvt_pk_bf16_f32 v86, v80, v81
  v_cvt_pk_bf16_f32 v87, v82, v83
  v_exp_f32 v72, v72
  v_exp_f32 v73, v73
  v_mfma_f32_16x16x32_bf16 v[100:103], v[36:39], v[84:87], 0
  v_exp_f32 v74, v74
  v_exp_f32 v75, v75
  v_mfma_f32_16x16x32_bf16 v[92:95], a[168:171], v[84:87], 0
  v_cvt_pk_bf16_f32 v88, v72, v73
  v_cvt_pk_bf16_f32 v89, v74, v75
  v_mfma_f32_16x16x32_bf16 v[96:99], a[172:175], v[84:87], 0
  s_waitcnt lgkmcnt(0)
  v_mfma_f32_16x16x16_bf16 v[100:103], v[36:37], v[88:89], v[100:103]
  v_add_f32 v56, v56, v64
  v_add_f32 v60, v60, v48
  v_add_f32 v57, v57, v65
  v_add_f32 v61, v61, v49
  v_add_f32 v58, v58, v66
  v_add_f32 v62, v62, v50
  v_add_f32 v59, v59, v67
  v_add_f32 v63, v63, v51
  v_cvt_pk_bf16_f32 v68, v56, v57
  v_cvt_pk_bf16_f32 v69, v58, v59
  v_cvt_pk_bf16_f32 v70, v60, v61
  v_cvt_pk_bf16_f32 v71, v62, v63
  v_mfma_f32_16x16x16_bf16 v[92:95], v[68:69], v[88:89], v[92:95]
  v_rcp_f32 v28, v100
  v_mfma_f32_16x16x16_bf16 v[96:99], v[70:71], v[88:89], v[96:99]
  v_mov_b32 v29, v28
  s_nop 4
  v_pk_mul_f32 v[92:93], v[92:93], v[28:29]
  v_pk_mul_f32 v[94:95], v[94:95], v[28:29]
  v_pk_mul_f32 v[96:97], v[96:97], v[28:29]
  v_pk_mul_f32 v[98:99], v[98:99], v[28:29]
  v_cvt_pk_bf16_f32 v104, v92, v93
  v_cvt_pk_bf16_f32 v105, v94, v95
  v_cvt_pk_bf16_f32 v106, v96, v97
  v_cvt_pk_bf16_f32 v107, v98, v99
  buffer_store_dwordx4 v[104:107], v11, s[4:7], s22 offen
reca_b326:
  s_barrier
  s_cmp_ge_u32 s12, 2
  s_cbranch_scc1 reca_notg242
  s_sleep 3
  buffer_load_dwordx4 v[128:131], v12, s[4:7], s22 offen offset:0 sc1
  buffer_load_dwordx4 v[132:135], v12, s[4:7], s22 offen offset:1024 sc1
  buffer_load_dwordx4 v[136:139], v12, s[4:7], s22 offen offset:2048 sc1
  buffer_load_dwordx4 v[140:143], v12, s[4:7], s22 offen offset:3072 sc1
  buffer_load_dwordx4 v[144:147], v13, s[4:7], s22 offen offset:0 sc1
  buffer_load_dwordx4 v[148:151], v13, s[4:7], s22 offen offset:1024 sc1
  buffer_load_dwordx4 v[152:155], v13, s[4:7], s22 offen offset:2048 sc1
  buffer_load_dwordx4 v[156:159], v13, s[4:7], s22 offen offset:3072 sc1
  buffer_load_dwordx4 v[160:163], v14, s[4:7], s22 offen offset:0 sc1
  buffer_load_dwordx4 v[164:167], v14, s[4:7], s22 offen offset:1024 sc1
  buffer_load_dwordx4 v[168:171], v14, s[4:7], s22 offen offset:2048 sc1
  buffer_load_dwordx4 v[172:175], v14, s[4:7], s22 offen offset:3072 sc1
  s_waitcnt vmcnt(11)
  v_cmp_eq_u32 vcc, -1, v128
  s_cbranch_vccnz reca_retry43
reca_resume44:
  s_waitcnt vmcnt(10)
  v_cmp_eq_u32 vcc, -1, v132
  v_mfma_f32_16x16x32_bf16 v[108:111], a[120:123], v[128:131], 0
  v_mfma_f32_16x16x32_bf16 v[112:115], a[124:127], v[128:131], 0
  s_cbranch_vccnz reca_retry45
reca_resume46:
  s_waitcnt vmcnt(9)
  v_cmp_eq_u32 vcc, -1, v136
  v_mfma_f32_16x16x32_bf16 v[108:111], a[128:131], v[132:135], v[108:111]
  v_mfma_f32_16x16x32_bf16 v[112:115], a[132:135], v[132:135], v[112:115]
  s_cbranch_vccnz reca_retry47
reca_resume48:
  s_waitcnt vmcnt(8)
  v_cmp_eq_u32 vcc, -1, v140
  v_mfma_f32_16x16x32_bf16 v[108:111], a[136:139], v[136:139], v[108:111]
  v_mfma_f32_16x16x32_bf16 v[112:115], a[140:143], v[136:139], v[112:115]
  s_cbranch_vccnz reca_retry49
reca_resume50:
  s_waitcnt vmcnt(7)
  v_cmp_eq_u32 vcc, -1, v144
  v_mfma_f32_16x16x32_bf16 v[108:111], a[144:147], v[140:143], v[108:111]
  v_mfma_f32_16x16x32_bf16 v[112:115], a[148:151], v[140:143], v[112:115]
  s_cbranch_vccnz reca_retry51
reca_resume52:
  s_waitcnt vmcnt(6)
  v_cmp_eq_u32 vcc, -1, v148
  v_mfma_f32_16x16x32_bf16 v[108:111], a[152:155], v[144:147], v[108:111]
  v_mfma_f32_16x16x32_bf16 v[112:115], a[156:159], v[144:147], v[112:115]
  s_cbranch_vccnz reca_retry53
reca_resume54:
  s_waitcnt vmcnt(5)
  v_cmp_eq_u32 vcc, -1, v152
  v_mfma_f32_16x16x32_bf16 v[108:111], a[160:163], v[148:151], v[108:111]
  v_mfma_f32_16x16x32_bf16 v[112:115], a[164:167], v[148:151], v[112:115]
  s_cbranch_vccnz reca_retry55
reca_resume56:
  s_waitcnt vmcnt(4)
  v_cmp_eq_u32 vcc, -1, v156
  v_mfma_f32_16x16x32_bf16 v[108:111], a[168:171], v[152:155], v[108:111]
  v_mfma_f32_16x16x32_bf16 v[112:115], a[172:175], v[152:155], v[112:115]
  s_cbranch_vccnz reca_retry57
reca_resume58:
  s_waitcnt vmcnt(3)
  v_cmp_eq_u32 vcc, -1, v160
  v_mfma_f32_16x16x32_bf16 v[108:111], a[176:179], v[156:159], v[108:111]
  v_mfma_f32_16x16x32_bf16 v[112:115], a[180:183], v[156:159], v[112:115]
  s_cbranch_vccnz reca_retry59
reca_resume60:
  s_waitcnt vmcnt(2)
  v_cmp_eq_u32 vcc, -1, v164
  v_mfma_f32_16x16x32_bf16 v[108:111], a[184:187], v[160:163], v[108:111]
  v_mfma_f32_16x16x32_bf16 v[112:115], a[188:191], v[160:163], v[112:115]
  s_cbranch_vccnz reca_retry61
reca_resume62:
  s_waitcnt vmcnt(1)
  v_cmp_eq_u32 vcc, -1, v168
  v_mfma_f32_16x16x32_bf16 v[108:111], a[192:195], v[164:167], v[108:111]
  v_mfma_f32_16x16x32_bf16 v[112:115], a[196:199], v[164:167], v[112:115]
  s_cbranch_vccnz reca_retry63
reca_resume64:
  s_waitcnt vmcnt(0)
  v_cmp_eq_u32 vcc, -1, v172
  v_mfma_f32_16x16x32_bf16 v[108:111], a[200:203], v[168:171], v[108:111]
  v_mfma_f32_16x16x32_bf16 v[112:115], a[204:207], v[168:171], v[112:115]
  s_cbranch_vccnz reca_retry65
reca_resume66:
  v_mfma_f32_16x16x32_bf16 v[108:111], a[208:211], v[172:175], v[108:111]
  v_mfma_f32_16x16x32_bf16 v[112:115], a[212:215], v[172:175], v[112:115]
  s_nop 7
  v_add_f32_dpp v116, v112, v108 row_ror:8 row_mask:0xf bank_mask:0xf
  v_add_f32_dpp v117, v113, v109 row_ror:8 row_mask:0xf bank_mask:0xf
  v_add_f32_dpp v118, v114, v110 row_ror:8 row_mask:0xf bank_mask:0xf
  v_add_f32_dpp v119, v115, v111 row_ror:8 row_mask:0xf bank_mask:0xf
  buffer_store_dwordx4 v[116:119], v15, s[4:7], s25 offen sc1
  buffer_store_dwordx4 v[116:119], v232, s[4:7], s25 offen sc1
  buffer_store_dwordx4 v[32:35], v15, s[4:7], s29 offen sc1
  buffer_store_dwordx4 v[32:35], v232, s[4:7], s29 offen sc1
  s_branch reca_b427
reca_notg242:
  s_cmp_lg_u32 s12, 3
  s_cbranch_scc1 reca_b427
  s_add_u32 s34, s17, 2
  s_and_b32 s34, s34, 3
  s_mul_i32 s26, s34, 10240
  s_add_u32 s26, s26, s38
  s_mul_i32 s27, s34, 6144
  s_add_u32 s27, s27, s39
  s_mul_i32 s28, s34, 12288
  s_add_u32 s28, s28, s40
  s_mul_i32 s29, s34, 393216
  s_add_u32 s29, s29, s56
  buffer_store_dwordx2 v[32:33], v8, s[4:7], s27 offen
  buffer_store_dwordx4 v[32:35], v11, s[4:7], s28 offen
reca_b427:
  s_barrier
  s_cmp_lg_u32 s12, 2
  s_cbranch_scc1 reca_not267
  s_sleep 8
  buffer_load_dwordx4 v[128:131], v20, s[4:7], s25 offen sc1
  buffer_load_dwordx4 v[132:135], v21, s[4:7], s25 offen sc1
  buffer_load_dwordx4 v[136:139], v22, s[4:7], s25 offen sc1
  buffer_load_dwordx4 v[140:143], v23, s[4:7], s25 offen sc1
  buffer_load_dwordx4 v[144:147], v24, s[4:7], s25 offen sc1
  buffer_load_dwordx4 v[148:151], v25, s[4:7], s25 offen sc1
  buffer_load_dwordx4 v[152:155], v26, s[4:7], s25 offen sc1
  buffer_load_dwordx4 v[156:159], v27, s[4:7], s25 offen sc1
  s_waitcnt vmcnt(7)
  v_cmp_eq_u32 vcc, -1, v128
  s_cbranch_vccnz reca_retry68
reca_resume69:
  s_waitcnt vmcnt(6)
  v_cmp_eq_u32 vcc, -1, v132
  s_cbranch_vccnz reca_retry70
reca_resume71:
  s_waitcnt vmcnt(5)
  v_cmp_eq_u32 vcc, -1, v136
  v_pk_add_f32 v[116:117], v[128:129], v[132:133]
  v_pk_add_f32 v[118:119], v[130:131], v[134:135]
  s_cbranch_vccnz reca_retry72
reca_resume73:
  s_waitcnt vmcnt(4)
  v_cmp_eq_u32 vcc, -1, v140
  v_pk_add_f32 v[116:117], v[116:117], v[136:137]
  v_pk_add_f32 v[118:119], v[118:119], v[138:139]
  s_cbranch_vccnz reca_retry74
reca_resume75:
  s_waitcnt vmcnt(3)
  v_cmp_eq_u32 vcc, -1, v144
  v_pk_add_f32 v[116:117], v[116:117], v[140:141]
  v_pk_add_f32 v[118:119], v[118:119], v[142:143]
  s_cbranch_vccnz reca_retry76
reca_resume77:
  s_waitcnt vmcnt(2)
  v_cmp_eq_u32 vcc, -1, v148
  v_pk_add_f32 v[116:117], v[116:117], v[144:145]
  v_pk_add_f32 v[118:119], v[118:119], v[146:147]
  s_cbranch_vccnz reca_retry78
reca_resume79:
  s_waitcnt vmcnt(1)
  v_cmp_eq_u32 vcc, -1, v152
  v_pk_add_f32 v[116:117], v[116:117], v[148:149]
  v_pk_add_f32 v[118:119], v[118:119], v[150:151]
  s_cbranch_vccnz reca_retry80
reca_resume81:
  s_waitcnt vmcnt(0)
  v_cmp_eq_u32 vcc, -1, v156
  v_pk_add_f32 v[116:117], v[116:117], v[152:153]
  v_pk_add_f32 v[118:119], v[118:119], v[154:155]
  s_cbranch_vccnz reca_retry82
reca_resume83:
  v_pk_add_f32 v[116:117], v[116:117], v[156:157]
  v_pk_add_f32 v[118:119], v[118:119], v[158:159]
  v_cvt_pk_bf16_f32 v132, v116, v117
  v_cvt_pk_bf16_f32 v133, v118, v119
  buffer_store_dwordx2 v[132:133], v16, s[4:7], s24 offen
  s_branch reca_b528
reca_not267:
  s_cmp_lg_u32 s12, 3
  s_cbranch_scc1 reca_b528
  s_add_u32 s36, s17, 1
  s_cmp_ge_u32 s36, 63
  s_cbranch_scc1 reca_nopf84
  s_add_u32 s37, s36, 1
reca_pf85:
  buffer_load_dword v28, v233, s[4:7], 0 offen sc1
  s_waitcnt vmcnt(0)
  v_cmp_gt_i32 vcc, s37, v28
  s_cbranch_vccz reca_pfok86
  s_sleep 1
  s_sub_u32 s18, s18, 1
  s_cbranch_scc0 reca_pf85
  s_mov_b32 s18, 0
reca_pfok86:
  s_lshl_b32 s34, s15, 4
  s_and_b32 s35, s36, 15
  s_add_u32 s34, s34, s35
  s_mul_i32 s34, s34, 12288
  s_add_u32 s32, s34, 37748736
  s_lshl_b32 s35, s16, 11
  s_add_u32 s34, s34, s35
  s_add_u32 s33, s34, 44040192
  buffer_load_dwordx4 a[120:123], v1, s[4:7], s32 offen offset:0 sc1
  buffer_load_dwordx4 a[124:127], v1, s[4:7], s32 offen offset:1024 sc1
  buffer_load_dwordx4 a[128:131], v1, s[4:7], s32 offen offset:2048 sc1
  buffer_load_dwordx4 a[132:135], v1, s[4:7], s32 offen offset:3072 sc1
  buffer_load_dwordx4 a[136:139], v2, s[4:7], s32 offen offset:0 sc1
  buffer_load_dwordx4 a[140:143], v2, s[4:7], s32 offen offset:1024 sc1
  buffer_load_dwordx4 a[144:147], v2, s[4:7], s32 offen offset:2048 sc1
  buffer_load_dwordx4 a[148:151], v2, s[4:7], s32 offen offset:3072 sc1
  buffer_load_dwordx4 a[152:155], v3, s[4:7], s32 offen offset:0 sc1
  buffer_load_dwordx4 a[156:159], v3, s[4:7], s32 offen offset:1024 sc1
  buffer_load_dwordx4 a[160:163], v3, s[4:7], s32 offen offset:2048 sc1
  buffer_load_dwordx4 a[164:167], v3, s[4:7], s32 offen offset:3072 sc1
  buffer_load_dwordx4 a[168:171], v1, s[4:7], s33 offen offset:0 sc1
  buffer_load_dwordx4 a[172:175], v1, s[4:7], s33 offen offset:1024 sc1
reca_nopf84:
  buffer_store_dwordx2 v[52:53], v9, s[4:7], s30 offen
  buffer_store_dwordx2 v[68:69], v10, s[4:7], s31 offen
  buffer_store_dwordx2 v[70:71], v10, s[4:7], s31 offen offset:256
reca_b528:
  s_barrier
  s_add_u32 s17, s17, 1
  s_branch reca_step14
reca_retry17:
  s_sub_u32 s18, s18, 1
  s_cbranch_scc1 reca_retry17_to
  buffer_load_dwordx4 v[128:131], v4, s[4:7], s20 offen sc1
  buffer_load_dwordx4 v[132:135], v4, s[4:7], s20 offen offset:1024 sc1
  buffer_load_dwordx4 v[136:139], v5, s[4:7], s20 offen sc1
  s_waitcnt vmcnt(2)
  v_max_u32 v29, v128, v130
  v_cmp_eq_u32 vcc, -1, v29
  s_cbranch_vccnz reca_retry17
  s_branch reca_resume18
reca_retry17_to:
  s_mov_b32 s18, 0
  s_waitcnt vmcnt(0)
  s_branch reca_resume18
reca_retry19:
  s_sub_u32 s18, s18, 1
  s_cbranch_scc1 reca_retry19_to
  buffer_load_dwordx4 v[132:135], v4, s[4:7], s20 offen offset:1024 sc1
  buffer_load_dwordx4 v[136:139], v5, s[4:7], s20 offen sc1
  s_waitcnt vmcnt(1)
  v_max_u32 v29, v132, v134
  v_cmp_eq_u32 vcc, -1, v29
  s_cbranch_vccnz reca_retry19
  s_branch reca_resume20
reca_retry19_to:
  s_mov_b32 s18, 0
  s_waitcnt vmcnt(0)
  s_branch reca_resume20
reca_retry21:
  s_sub_u32 s18, s18, 1
  s_cbranch_scc1 reca_retry21_to
  buffer_load_dwordx4 v[136:139], v5, s[4:7], s20 offen sc1
  s_waitcnt vmcnt(0)
  v_max_u32 v29, v136, v138
  v_cmp_eq_u32 vcc, -1, v29
  s_cbranch_vccnz reca_retry21
  s_branch reca_resume22
reca_retry21_to:
  s_mov_b32 s18, 0
  s_waitcnt vmcnt(0)
  s_branch reca_resume22
reca_retry30:
  s_sub_u32 s18, s18, 1
  s_cbranch_scc1 reca_retry30_to
  buffer_load_dwordx4 v[208:211], v1, s[4:7], s21 offen offset:0 sc1
  buffer_load_dwordx4 v[212:215], v1, s[4:7], s21 offen offset:1024 sc1
  buffer_load_dwordx4 v[216:219], v1, s[4:7], s21 offen offset:2048 sc1
  buffer_load_dwordx4 v[220:223], v1, s[4:7], s21 offen offset:3072 sc1
  buffer_load_dwordx4 v[224:227], v2, s[4:7], s21 offen offset:0 sc1
  buffer_load_dwordx4 v[228:231], v2, s[4:7], s21 offen offset:1024 sc1
  s_waitcnt vmcnt(5)
  v_max_u32 v29, v208, v210
  v_cmp_eq_u32 vcc, -1, v29
  s_cbranch_vccnz reca_retry30
  s_branch reca_resume31
reca_retry30_to:
  s_mov_b32 s18, 0
  s_waitcnt vmcnt(0)
  s_branch reca_resume31
reca_retry32:
  s_sub_u32 s18, s18, 1
  s_cbranch_scc1 reca_retry32_to
  buffer_load_dwordx4 v[212:215], v1, s[4:7], s21 offen offset:1024 sc1
  buffer_load_dwordx4 v[216:219], v1, s[4:7], s21 offen offset:2048 sc1
  buffer_load_dwordx4 v[220:223], v1, s[4:7], s21 offen offset:3072 sc1
  buffer_load_dwordx4 v[224:227], v2, s[4:7], s21 offen offset:0 sc1
  buffer_load_dwordx4 v[228:231], v2, s[4:7], s21 offen offset:1024 sc1
  s_waitcnt vmcnt(4)
  v_max_u32 v29, v212, v214
  v_cmp_eq_u32 vcc, -1, v29
  s_cbranch_vccnz reca_retry32
  s_branch reca_resume33
reca_retry32_to:
  s_mov_b32 s18, 0
  s_waitcnt vmcnt(0)
  s_branch reca_resume33
reca_retry34:
  s_sub_u32 s18, s18, 1
  s_cbranch_scc1 reca_retry34_to
  buffer_load_dwordx4 v[216:219], v1, s[4:7], s21 offen offset:2048 sc1
  buffer_load_dwordx4 v[220:223], v1, s[4:7], s21 offen offset:3072 sc1
  buffer_load_dwordx4 v[224:227], v2, s[4:7], s21 offen offset:0 sc1
  buffer_load_dwordx4 v[228:231], v2, s[4:7], s21 offen offset:1024 sc1
  s_waitcnt vmcnt(3)
  v_max_u32 v29, v216, v218
  v_cmp_eq_u32 vcc, -1, v29
  s_cbranch_vccnz reca_retry34
  s_branch reca_resume35
reca_retry34_to:
  s_mov_b32 s18, 0
  s_waitcnt vmcnt(0)
  s_branch reca_resume35
reca_retry36:
  s_sub_u32 s18, s18, 1
  s_cbranch_scc1 reca_retry36_to
  buffer_load_dwordx4 v[220:223], v1, s[4:7], s21 offen offset:3072 sc1
  buffer_load_dwordx4 v[224:227], v2, s[4:7], s21 offen offset:0 sc1
  buffer_load_dwordx4 v[228:231], v2, s[4:7], s21 offen offset:1024 sc1
  s_waitcnt vmcnt(2)
  v_max_u32 v29, v220, v222
  v_cmp_eq_u32 vcc, -1, v29
  s_cbranch_vccnz reca_retry36
  s_branch reca_resume37
reca_retry36_to:
  s_mov_b32 s18, 0
  s_waitcnt vmcnt(0)
  s_branch reca_resume37
reca_retry38:
  s_sub_u32 s18, s18, 1
  s_cbranch_scc1 reca_retry38_to
  buffer_load_dwordx4 v[224:227], v2, s[4:7], s21 offen offset:0 sc1
  buffer_load_dwordx4 v[228:231], v2, s[4:7], s21 offen offset:1024 sc1
  s_waitcnt vmcnt(1)
  v_max_u32 v29, v224, v226
  v_cmp_eq_u32 vcc, -1, v29
  s_cbranch_vccnz reca_retry38
  s_branch reca_resume39
reca_retry38_to:
  s_mov_b32 s18, 0
  s_waitcnt vmcnt(0)
  s_branch reca_resume39
reca_retry40:
  s_sub_u32 s18, s18, 1
  s_cbranch_scc1 reca_retry40_to
  buffer_load_dwordx4 v[228:231], v2, s[4:7], s21 offen offset:1024 sc1
  s_waitcnt vmcnt(0)
  v_max_u32 v29, v228, v230
  v_cmp_eq_u32 vcc, -1, v29
  s_cbranch_vccnz reca_retry40
  s_branch reca_resume41
reca_retry40_to:
  s_mov_b32 s18, 0
  s_waitcnt vmcnt(0)
  s_branch reca_resume41
reca_retry43:
  s_sub_u32 s18, s18, 1
  s_cbranch_scc1 reca_retry43_to
  buffer_load_dwordx4 v[128:131], v12, s[4:7], s22 offen offset:0 sc1
  buffer_load_dwordx4 v[132:135], v12, s[4:7], s22 offen offset:1024 sc1
  buffer_load_dwordx4 v[136:139], v12, s[4:7], s22 offen offset:2048 sc1
  buffer_load_dwordx4 v[140:143], v12, s[4:7], s22 offen offset:3072 sc1
  buffer_load_dwordx4 v[144:147], v13, s[4:7], s22 offen offset:0 sc1
  buffer_load_dwordx4 v[148:151], v13, s[4:7], s22 offen offset:1024 sc1
  buffer_load_dwordx4 v[152:155], v13, s[4:7], s22 offen offset:2048 sc1
  buffer_load_dwordx4 v[156:159], v13, s[4:7], s22 offen offset:3072 sc1
  buffer_load_dwordx4 v[160:163], v14, s[4:7], s22 offen offset:0 sc1
  buffer_load_dwordx4 v[164:167], v14, s[4:7], s22 offen offset:1024 sc1
  buffer_load_dwordx4 v[168:171], v14, s[4:7], s22 offen offset:2048 sc1
  buffer_load_dwordx4 v[172:175], v14, s[4:7], s22 offen offset:3072 sc1
  s_waitcnt vmcnt(11)
  v_cmp_eq_u32 vcc, -1, v128
  s_cbranch_vccnz reca_retry43
  s_branch reca_resume44
reca_retry43_to:
  s_mov_b32 s18, 0
  s_waitcnt vmcnt(0)
  s_branch reca_resume44
reca_retry45:
  s_sub_u32 s18, s18, 1
  s_cbranch_scc1 reca_retry45_to
  buffer_load_dwordx4 v[132:135], v12, s[4:7], s22 offen offset:1024 sc1
  buffer_load_dwordx4 v[136:139], v12, s[4:7], s22 offen offset:2048 sc1
  buffer_load_dwordx4 v[140:143], v12, s[4:7], s22 offen offset:3072 sc1
  buffer_load_dwordx4 v[144:147], v13, s[4:7], s22 offen offset:0 sc1
  buffer_load_dwordx4 v[148:151], v13, s[4:7], s22 offen offset:1024 sc1
  buffer_load_dwordx4 v[152:155], v13, s[4:7], s22 offen offset:2048 sc1
  buffer_load_dwordx4 v[156:159], v13, s[4:7], s22 offen offset:3072 sc1
  buffer_load_dwordx4 v[160:163], v14, s[4:7], s22 offen offset:0 sc1
  buffer_load_dwordx4 v[164:167], v14, s[4:7], s22 offen offset:1024 sc1
  buffer_load_dwordx4 v[168:171], v14, s[4:7], s22 offen offset:2048 sc1
  buffer_load_dwordx4 v[172:175], v14, s[4:7], s22 offen offset:3072 sc1
  s_waitcnt vmcnt(10)
  v_cmp_eq_u32 vcc, -1, v132
  s_cbranch_vccnz reca_retry45
  s_branch reca_resume46
reca_retry45_to:
  s_mov_b32 s18, 0
  s_waitcnt vmcnt(0)
  s_branch reca_resume46
reca_retry47:
  s_sub_u32 s18, s18, 1
  s_cbranch_scc1 reca_retry47_to
  buffer_load_dwordx4 v[136:139], v12, s[4:7], s22 offen offset:2048 sc1
  buffer_load_dwordx4 v[140:143], v12, s[4:7], s22 offen offset:3072 sc1
  buffer_load_dwordx4 v[144:147], v13, s[4:7], s22 offen offset:0 sc1
  buffer_load_dwordx4 v[148:151], v13, s[4:7], s22 offen offset:1024 sc1
  buffer_load_dwordx4 v[152:155], v13, s[4:7], s22 offen offset:2048 sc1
  buffer_load_dwordx4 v[156:159], v13, s[4:7], s22 offen offset:3072 sc1
  buffer_load_dwordx4 v[160:163], v14, s[4:7], s22 offen offset:0 sc1
  buffer_load_dwordx4 v[164:167], v14, s[4:7], s22 offen offset:1024 sc1
  buffer_load_dwordx4 v[168:171], v14, s[4:7], s22 offen offset:2048 sc1
  buffer_load_dwordx4 v[172:175], v14, s[4:7], s22 offen offset:3072 sc1
  s_waitcnt vmcnt(9)
  v_cmp_eq_u32 vcc, -1, v136
  s_cbranch_vccnz reca_retry47
  s_branch reca_resume48
reca_retry47_to:
  s_mov_b32 s18, 0
  s_waitcnt vmcnt(0)
  s_branch reca_resume48
reca_retry49:
  s_sub_u32 s18, s18, 1
  s_cbranch_scc1 reca_retry49_to
  buffer_load_dwordx4 v[140:143], v12, s[4:7], s22 offen offset:3072 sc1
  buffer_load_dwordx4 v[144:147], v13, s[4:7], s22 offen offset:0 sc1
  buffer_load_dwordx4 v[148:151], v13, s[4:7], s22 offen offset:1024 sc1
  buffer_load_dwordx4 v[152:155], v13, s[4:7], s22 offen offset:2048 sc1
  buffer_load_dwordx4 v[156:159], v13, s[4:7], s22 offen offset:3072 sc1
  buffer_load_dwordx4 v[160:163], v14, s[4:7], s22 offen offset:0 sc1
  buffer_load_dwordx4 v[164:167], v14, s[4:7], s22 offen offset:1024 sc1
  buffer_load_dwordx4 v[168:171], v14, s[4:7], s22 offen offset:2048 sc1
  buffer_load_dwordx4 v[172:175], v14, s[4:7], s22 offen offset:3072 sc1
  s_waitcnt vmcnt(8)
  v_cmp_eq_u32 vcc, -1, v140
  s_cbranch_vccnz reca_retry49
  s_branch reca_resume50
reca_retry49_to:
  s_mov_b32 s18, 0
  s_waitcnt vmcnt(0)
  s_branch reca_resume50
reca_retry51:
  s_sub_u32 s18, s18, 1
  s_cbranch_scc1 reca_retry51_to
  buffer_load_dwordx4 v[144:147], v13, s[4:7], s22 offen offset:0 sc1
  buffer_load_dwordx4 v[148:151], v13, s[4:7], s22 offen offset:1024 sc1
  buffer_load_dwordx4 v[152:155], v13, s[4:7], s22 offen offset:2048 sc1
  buffer_load_dwordx4 v[156:159], v13, s[4:7], s22 offen offset:3072 sc1
  buffer_load_dwordx4 v[160:163], v14, s[4:7], s22 offen offset:0 sc1
  buffer_load_dwordx4 v[164:167], v14, s[4:7], s22 offen offset:1024 sc1
  buffer_load_dwordx4 v[168:171], v14, s[4:7], s22 offen offset:2048 sc1
  buffer_load_dwordx4 v[172:175], v14, s[4:7], s22 offen offset:3072 sc1
  s_waitcnt vmcnt(7)
  v_cmp_eq_u32 vcc, -1, v144
  s_cbranch_vccnz reca_retry51
  s_branch reca_resume52
reca_retry51_to:
  s_mov_b32 s18, 0
  s_waitcnt vmcnt(0)
  s_branch reca_resume52
reca_retry53:
  s_sub_u32 s18, s18, 1
  s_cbranch_scc1 reca_retry53_to
  buffer_load_dwordx4 v[148:151], v13, s[4:7], s22 offen offset:1024 sc1
  buffer_load_dwordx4 v[152:155], v13, s[4:7], s22 offen offset:2048 sc1
  buffer_load_dwordx4 v[156:159], v13, s[4:7], s22 offen offset:3072 sc1
  buffer_load_dwordx4 v[160:163], v14, s[4:7], s22 offen offset:0 sc1
  buffer_load_dwordx4 v[164:167], v14, s[4:7], s22 offen offset:1024 sc1
  buffer_load_dwordx4 v[168:171], v14, s[4:7], s22 offen offset:2048 sc1
  buffer_load_dwordx4 v[172:175], v14, s[4:7], s22 offen offset:3072 sc1
  s_waitcnt vmcnt(6)
  v_cmp_eq_u32 vcc, -1, v148
  s_cbranch_vccnz reca_retry53
  s_branch reca_resume54
reca_retry53_to:
  s_mov_b32 s18, 0
  s_waitcnt vmcnt(0)
  s_branch reca_resume54
reca_retry55:
  s_sub_u32 s18, s18, 1
  s_cbranch_scc1 reca_retry55_to
  buffer_load_dwordx4 v[152:155], v13, s[4:7], s22 offen offset:2048 sc1
  buffer_load_dwordx4 v[156:159], v13, s[4:7], s22 offen offset:3072 sc1
  buffer_load_dwordx4 v[160:163], v14, s[4:7], s22 offen offset:0 sc1
  buffer_load_dwordx4 v[164:167], v14, s[4:7], s22 offen offset:1024 sc1
  buffer_load_dwordx4 v[168:171], v14, s[4:7], s22 offen offset:2048 sc1
  buffer_load_dwordx4 v[172:175], v14, s[4:7], s22 offen offset:3072 sc1
  s_waitcnt vmcnt(5)
  v_cmp_eq_u32 vcc, -1, v152
  s_cbranch_vccnz reca_retry55
  s_branch reca_resume56
reca_retry55_to:
  s_mov_b32 s18, 0
  s_waitcnt vmcnt(0)
  s_branch reca_resume56
reca_retry57:
  s_sub_u32 s18, s18, 1
  s_cbranch_scc1 reca_retry57_to
  buffer_load_dwordx4 v[156:159], v13, s[4:7], s22 offen offset:3072 sc1
  buffer_load_dwordx4 v[160:163], v14, s[4:7], s22 offen offset:0 sc1
  buffer_load_dwordx4 v[164:167], v14, s[4:7], s22 offen offset:1024 sc1
  buffer_load_dwordx4 v[168:171], v14, s[4:7], s22 offen offset:2048 sc1
  buffer_load_dwordx4 v[172:175], v14, s[4:7], s22 offen offset:3072 sc1
  s_waitcnt vmcnt(4)
  v_cmp_eq_u32 vcc, -1, v156
  s_cbranch_vccnz reca_retry57
  s_branch reca_resume58
reca_retry57_to:
  s_mov_b32 s18, 0
  s_waitcnt vmcnt(0)
  s_branch reca_resume58
reca_retry59:
  s_sub_u32 s18, s18, 1
  s_cbranch_scc1 reca_retry59_to
  buffer_load_dwordx4 v[160:163], v14, s[4:7], s22 offen offset:0 sc1
  buffer_load_dwordx4 v[164:167], v14, s[4:7], s22 offen offset:1024 sc1
  buffer_load_dwordx4 v[168:171], v14, s[4:7], s22 offen offset:2048 sc1
  buffer_load_dwordx4 v[172:175], v14, s[4:7], s22 offen offset:3072 sc1
  s_waitcnt vmcnt(3)
  v_cmp_eq_u32 vcc, -1, v160
  s_cbranch_vccnz reca_retry59
  s_branch reca_resume60
reca_retry59_to:
  s_mov_b32 s18, 0
  s_waitcnt vmcnt(0)
  s_branch reca_resume60
reca_retry61:
  s_sub_u32 s18, s18, 1
  s_cbranch_scc1 reca_retry61_to
  buffer_load_dwordx4 v[164:167], v14, s[4:7], s22 offen offset:1024 sc1
  buffer_load_dwordx4 v[168:171], v14, s[4:7], s22 offen offset:2048 sc1
  buffer_load_dwordx4 v[172:175], v14, s[4:7], s22 offen offset:3072 sc1
  s_waitcnt vmcnt(2)
  v_cmp_eq_u32 vcc, -1, v164
  s_cbranch_vccnz reca_retry61
  s_branch reca_resume62
reca_retry61_to:
  s_mov_b32 s18, 0
  s_waitcnt vmcnt(0)
  s_branch reca_resume62
reca_retry63:
  s_sub_u32 s18, s18, 1
  s_cbranch_scc1 reca_retry63_to
  buffer_load_dwordx4 v[168:171], v14, s[4:7], s22 offen offset:2048 sc1
  buffer_load_dwordx4 v[172:175], v14, s[4:7], s22 offen offset:3072 sc1
  s_waitcnt vmcnt(1)
  v_cmp_eq_u32 vcc, -1, v168
  s_cbranch_vccnz reca_retry63
  s_branch reca_resume64
reca_retry63_to:
  s_mov_b32 s18, 0
  s_waitcnt vmcnt(0)
  s_branch reca_resume64
reca_retry65:
  s_sub_u32 s18, s18, 1
  s_cbranch_scc1 reca_retry65_to
  buffer_load_dwordx4 v[172:175], v14, s[4:7], s22 offen offset:3072 sc1
  s_waitcnt vmcnt(0)
  v_cmp_eq_u32 vcc, -1, v172
  s_cbranch_vccnz reca_retry65
  s_branch reca_resume66
reca_retry65_to:
  s_mov_b32 s18, 0
  s_waitcnt vmcnt(0)
  s_branch reca_resume66
reca_retry68:
  s_sub_u32 s18, s18, 1
  s_cbranch_scc1 reca_retry68_to
  buffer_load_dwordx4 v[128:131], v20, s[4:7], s25 offen sc1
  buffer_load_dwordx4 v[132:135], v21, s[4:7], s25 offen sc1
  buffer_load_dwordx4 v[136:139], v22, s[4:7], s25 offen sc1
  buffer_load_dwordx4 v[140:143], v23, s[4:7], s25 offen sc1
  buffer_load_dwordx4 v[144:147], v24, s[4:7], s25 offen sc1
  buffer_load_dwordx4 v[148:151], v25, s[4:7], s25 offen sc1
  buffer_load_dwordx4 v[152:155], v26, s[4:7], s25 offen sc1
  buffer_load_dwordx4 v[156:159], v27, s[4:7], s25 offen sc1
  s_waitcnt vmcnt(7)
  v_cmp_eq_u32 vcc, -1, v128
  s_cbranch_vccnz reca_retry68
  s_branch reca_resume69
reca_retry68_to:
  s_mov_b32 s18, 0
  s_waitcnt vmcnt(0)
  s_branch reca_resume69
reca_retry70:
  s_sub_u32 s18, s18, 1
  s_cbranch_scc1 reca_retry70_to
  buffer_load_dwordx4 v[132:135], v21, s[4:7], s25 offen sc1
  buffer_load_dwordx4 v[136:139], v22, s[4:7], s25 offen sc1
  buffer_load_dwordx4 v[140:143], v23, s[4:7], s25 offen sc1
  buffer_load_dwordx4 v[144:147], v24, s[4:7], s25 offen sc1
  buffer_load_dwordx4 v[148:151], v25, s[4:7], s25 offen sc1
  buffer_load_dwordx4 v[152:155], v26, s[4:7], s25 offen sc1
  buffer_load_dwordx4 v[156:159], v27, s[4:7], s25 offen sc1
  s_waitcnt vmcnt(6)
  v_cmp_eq_u32 vcc, -1, v132
  s_cbranch_vccnz reca_retry70
  s_branch reca_resume71
reca_retry70_to:
  s_mov_b32 s18, 0
  s_waitcnt vmcnt(0)
  s_branch reca_resume71
reca_retry72:
  s_sub_u32 s18, s18, 1
  s_cbranch_scc1 reca_retry72_to
  buffer_load_dwordx4 v[136:139], v22, s[4:7], s25 offen sc1
  buffer_load_dwordx4 v[140:143], v23, s[4:7], s25 offen sc1
  buffer_load_dwordx4 v[144:147], v24, s[4:7], s25 offen sc1
  buffer_load_dwordx4 v[148:151], v25, s[4:7], s25 offen sc1
  buffer_load_dwordx4 v[152:155], v26, s[4:7], s25 offen sc1
  buffer_load_dwordx4 v[156:159], v27, s[4:7], s25 offen sc1
  s_waitcnt vmcnt(5)
  v_cmp_eq_u32 vcc, -1, v136
  s_cbranch_vccnz reca_retry72
  s_branch reca_resume73
reca_retry72_to:
  s_mov_b32 s18, 0
  s_waitcnt vmcnt(0)
  s_branch reca_resume73
reca_retry74:
  s_sub_u32 s18, s18, 1
  s_cbranch_scc1 reca_retry74_to
  buffer_load_dwordx4 v[140:143], v23, s[4:7], s25 offen sc1
  buffer_load_dwordx4 v[144:147], v24, s[4:7], s25 offen sc1
  buffer_load_dwordx4 v[148:151], v25, s[4:7], s25 offen sc1
  buffer_load_dwordx4 v[152:155], v26, s[4:7], s25 offen sc1
  buffer_load_dwordx4 v[156:159], v27, s[4:7], s25 offen sc1
  s_waitcnt vmcnt(4)
  v_cmp_eq_u32 vcc, -1, v140
  s_cbranch_vccnz reca_retry74
  s_branch reca_resume75
reca_retry74_to:
  s_mov_b32 s18, 0
  s_waitcnt vmcnt(0)
  s_branch reca_resume75
reca_retry76:
  s_sub_u32 s18, s18, 1
  s_cbranch_scc1 reca_retry76_to
  buffer_load_dwordx4 v[144:147], v24, s[4:7], s25 offen sc1
  buffer_load_dwordx4 v[148:151], v25, s[4:7], s25 offen sc1
  buffer_load_dwordx4 v[152:155], v26, s[4:7], s25 offen sc1
  buffer_load_dwordx4 v[156:159], v27, s[4:7], s25 offen sc1
  s_waitcnt vmcnt(3)
  v_cmp_eq_u32 vcc, -1, v144
  s_cbranch_vccnz reca_retry76
  s_branch reca_resume77
reca_retry76_to:
  s_mov_b32 s18, 0
  s_waitcnt vmcnt(0)
  s_branch reca_resume77
reca_retry78:
  s_sub_u32 s18, s18, 1
  s_cbranch_scc1 reca_retry78_to
  buffer_load_dwordx4 v[148:151], v25, s[4:7], s25 offen sc1
  buffer_load_dwordx4 v[152:155], v26, s[4:7], s25 offen sc1
  buffer_load_dwordx4 v[156:159], v27, s[4:7], s25 offen sc1
  s_waitcnt vmcnt(2)
  v_cmp_eq_u32 vcc, -1, v148
  s_cbranch_vccnz reca_retry78
  s_branch reca_resume79
reca_retry78_to:
  s_mov_b32 s18, 0
  s_waitcnt vmcnt(0)
  s_branch reca_resume79
reca_retry80:
  s_sub_u32 s18, s18, 1
  s_cbranch_scc1 reca_retry80_to
  buffer_load_dwordx4 v[152:155], v26, s[4:7], s25 offen sc1
  buffer_load_dwordx4 v[156:159], v27, s[4:7], s25 offen sc1
  s_waitcnt vmcnt(1)
  v_cmp_eq_u32 vcc, -1, v152
  s_cbranch_vccnz reca_retry80
  s_branch reca_resume81
reca_retry80_to:
  s_mov_b32 s18, 0
  s_waitcnt vmcnt(0)
  s_branch reca_resume81
reca_retry82:
  s_sub_u32 s18, s18, 1
  s_cbranch_scc1 reca_retry82_to
  buffer_load_dwordx4 v[156:159], v27, s[4:7], s25 offen sc1
  s_waitcnt vmcnt(0)
  v_cmp_eq_u32 vcc, -1, v156
  s_cbranch_vccnz reca_retry82
  s_branch reca_resume83
reca_retry82_to:
  s_mov_b32 s18, 0
  s_waitcnt vmcnt(0)
  s_branch reca_resume83
reca_twinf12:
  s_branch reca_gotmem88
reca_step87:
  s_and_b32 s34, s17, 3
  s_mul_i32 s20, s34, 10240
  s_add_u32 s20, s20, s38
  s_sleep 5
  buffer_load_dwordx4 v[128:131], v4, s[4:7], s20 offen sc1
  buffer_load_dwordx4 v[132:135], v4, s[4:7], s20 offen offset:1024 sc1
  buffer_load_dwordx4 v[136:139], v5, s[4:7], s20 offen sc1
  s_waitcnt vmcnt(2)
  v_max_u32 v29, v128, v130
  v_cmp_eq_u32 vcc, -1, v29
  s_cbranch_vccnz reca_retry90
reca_resume91:
  s_waitcnt vmcnt(1)
  v_max_u32 v29, v132, v134
  v_cmp_eq_u32 vcc, -1, v29
  ds_write_b128 v4, v[128:131]
  s_cbranch_vccnz reca_retry92
reca_resume93:
  s_waitcnt vmcnt(0)
  v_max_u32 v29, v136, v138
  v_cmp_eq_u32 vcc, -1, v29
  ds_write_b128 v4, v[132:135] offset:1024
  s_cbranch_vccnz reca_retry94
reca_resume95:
  ds_write_b128 v5, v[136:139]
  s_branch reca_gotmem289
reca_gotmem88:
  ds_write_b128 v4, v[128:131]
  ds_write_b128 v4, v[132:135] offset:1024
  ds_write_b128 v5, v[136:139]
reca_gotmem289:
  s_and_b32 s34, s17, 3
  s_mul_i32 s21, s34, 6144
  s_add_u32 s21, s21, s39
  s_mul_i32 s22, s34, 12288
  s_add_u32 s22, s22, s40
  s_mul_i32 s25, s34, 393216
  s_add_u32 s25, s25, s56
  s_add_u32 s35, s17, 1
  s_and_b32 s35, s35, 3
  s_mul_i32 s24, s35, 10240
  s_add_u32 s24, s24, s38
  s_waitcnt lgkmcnt(0)
  s_barrier
  ds_read_b128 v[128:131], v236 offset:0
  ds_read_b128 v[132:135], v236 offset:1024
  ds_read_b128 v[136:139], v236 offset:2048
  ds_read_b128 v[140:143], v236 offset:3072
  ds_read_b128 v[144:147], v236 offset:4096
  ds_read_b128 v[148:151], v237 offset:0
  ds_read_b128 v[152:155], v237 offset:1024
  ds_read_b128 v[156:159], v237 offset:2048
  ds_read_b128 v[160:163], v237 offset:3072
  ds_read_b128 v[164:167], v237 offset:4096
  s_waitcnt lgkmcnt(9)
  v_mfma_f32_16x16x32_bf16 v[44:47], a[0:3], v[128:131], 0
  ds_read_b128 v[168:171], v6 offset:0
  v_mfma_f32_16x16x32_bf16 v[240:243], a[4:7], v[128:131], 0
  s_waitcnt lgkmcnt(9)
  v_mfma_f32_16x16x32_bf16 v[44:47], a[8:11], v[132:135], v[44:47]
  ds_read_b128 v[172:175], v6 offset:512
  v_mfma_f32_16x16x32_bf16 v[240:243], a[12:15], v[132:135], v[240:243]
  s_waitcnt lgkmcnt(9)
  v_mfma_f32_16x16x32_bf16 v[44:47], a[16:19], v[136:139], v[44:47]
  ds_read_b128 v[176:179], v6 offset:1024
  v_mfma_f32_16x16x32_bf16 v[240:243], a[20:23], v[136:139], v[240:243]
  s_waitcnt lgkmcnt(9)
  v_mfma_f32_16x16x32_bf16 v[44:47], a[24:27], v[140:143], v[44:47]
  ds_read_b128 v[180:183], v6 offset:1536
  v_mfma_f32_16x16x32_bf16 v[240:243], a[28:31], v[140:143], v[240:243]
  s_waitcnt lgkmcnt(9)
  v_mfma_f32_16x16x32_bf16 v[44:47], a[32:35], v[144:147], v[44:47]
  ds_read_b128 v[184:187], v6 offset:2048
  v_mfma_f32_16x16x32_bf16 v[240:243], a[36:39], v[144:147], v[240:243]
  s_waitcnt lgkmcnt(9)
  v_mfma_f32_16x16x32_bf16 v[44:47], a[40:43], v[148:151], v[44:47]
  ds_read_b128 v[188:191], v6 offset:2560
  v_mfma_f32_16x16x32_bf16 v[240:243], a[44:47], v[148:151], v[240:243]
  s_waitcnt lgkmcnt(9)
  v_mfma_f32_16x16x32_bf16 v[44:47], a[48:51], v[152:155], v[44:47]
  ds_read_b128 v[192:195], v6 offset:3072
  v_mfma_f32_16x16x32_bf16 v[240:243], a[52:55], v[152:155], v[240:243]
  s_waitcnt lgkmcnt(9)
  v_mfma_f32_16x16x32_bf16 v[44:47], a[56:59], v[156:159], v[44:47]
  ds_read_b128 v[196:199], v6 offset:3584
  v_mfma_f32_16x16x32_bf16 v[240:243], a[60:63], v[156:159], v[240:243]
  s_waitcnt lgkmcnt(9)
  v_mfma_f32_16x16x32_bf16 v[44:47], a[64:67], v[160:163], v[44:47]
  ds_read_b128 v[200:203], v6 offset:4096
  v_mfma_f32_16x16x32_bf16 v[240:243], a[68:71], v[160:163], v[240:243]
  s_waitcnt lgkmcnt(9)
  v_mfma_f32_16x16x32_bf16 v[44:47], a[72:75], v[164:167], v[44:47]
  ds_read_b128 v[204:207], v6 offset:4608
  v_mfma_f32_16x16x32_bf16 v[240:243], a[76:79], v[164:167], v[240:243]
  s_waitcnt lgkmcnt(9)
  v_mfma_f32_16x16x32_bf16 v[48:51], v[168:171], a[80:83], 0
  s_and_b32 s34, s17, 15
  s_lshl_b32 s34, s34, 5
  s_add_u32 s34, s34, s15
  s_mul_i32 s34, s34, 3072
  s_lshl_b32 s35, s16, 9
  s_add_u32 s34, s34, s35
  s_add_u32 s30, s34, 56623104
  s_add_u32 s31, s34, 58195968
  v_add_f32_dpp v44, v240, v44 row_ror:8 row_mask:0xf bank_mask:0xf
  v_add_f32_dpp v45, v241, v45 row_ror:8 row_mask:0xf bank_mask:0xf
  v_add_f32_dpp v46, v242, v46 row_ror:8 row_mask:0xf bank_mask:0xf
  v_add_f32_dpp v47, v243, v47 row_ror:8 row_mask:0xf bank_mask:0xf
  v_cvt_pk_bf16_f32 v52, v44, v45
  v_cvt_pk_bf16_f32 v53, v46, v47
  buffer_store_dwordx2 v[52:53], v8, s[4:7], s21 offen
  s_waitcnt lgkmcnt(8)
  v_mfma_f32_16x16x32_bf16 v[48:51], v[172:175], a[84:87], v[48:51]
  s_waitcnt lgkmcnt(7)
  v_mfma_f32_16x16x32_bf16 v[48:51], v[176:179], a[88:91], v[48:51]
  s_waitcnt lgkmcnt(6)
  v_mfma_f32_16x16x32_bf16 v[48:51], v[180:183], a[92:95], v[48:51]
  s_waitcnt lgkmcnt(5)
  v_mfma_f32_16x16x32_bf16 v[48:51], v[184:187], a[96:99], v[48:51]
  s_waitcnt lgkmcnt(4)
  v_mfma_f32_16x16x32_bf16 v[48:51], v[188:191], a[100:103], v[48:51]
  s_waitcnt lgkmcnt(3)
  v_mfma_f32_16x16x32_bf16 v[48:51], v[192:195], a[104:107], v[48:51]
  s_waitcnt lgkmcnt(2)
  v_mfma_f32_16x16x32_bf16 v[48:51], v[196:199], a[108:111], v[48:51]
  s_waitcnt lgkmcnt(1)
  v_mfma_f32_16x16x32_bf16 v[48:51], v[200:203], a[112:115], v[48:51]
  s_waitcnt lgkmcnt(0)
  v_mfma_f32_16x16x32_bf16 v[48:51], v[204:207], a[116:119], v[48:51]
  s_cmp_eq_u32 s12, 3
  s_cbranch_scc1 reca_swave96
  s_nop 5
  ds_write_b128 v17, v[48:51]
  s_add_u32 s34, s17, 2
  s_and_b32 s34, s34, 3
  s_mul_i32 s26, s34, 10240
  s_add_u32 s26, s26, s38
  s_mul_i32 s27, s34, 6144
  s_add_u32 s27, s27, s39
  s_mul_i32 s28, s34, 12288
  s_add_u32 s28, s28, s40
  s_mul_i32 s29, s34, 393216
  s_add_u32 s29, s29, s56
  s_waitcnt lgkmcnt(0)
  s_barrier
  s_cmp_eq_u32 s17, 63
  s_cbranch_scc1 reca_last98
  buffer_store_dwordx2 v[32:33], v8, s[4:7], s27 offen
  s_cmp_lg_u32 s12, 2
  s_cbranch_scc1 reca_tw1102_n
  buffer_store_dwordx2 v[52:53], v9, s[4:7], s30 offen
reca_tw1102_n:
  s_barrier
  s_cmp_eq_u32 s12, 1
  s_cbranch_scc1 reca_tw1102
  s_cmp_eq_u32 s12, 2
  s_cbranch_scc1 reca_tw2103
  s_cmp_lt_u32 s17, 2
  s_cbranch_scc1 reca_b5101
  s_cmp_gt_u32 s17, 61
  s_cbranch_scc1 reca_b5101
  s_sub_u32 s36, s17, 2
  s_and_b32 s36, s36, 15
  s_lshl_b32 s34, s59, 4
  s_add_u32 s34, s34, s36
  s_mul_i32 s34, s34, 12288
  s_add_u32 s23, s34, 37748736
  s_add_u32 s60, s34, 50331648
  s_lshl_b32 s35, s36, 5
  s_add_u32 s35, s35, s59
  s_mul_i32 s35, s35, 3072
  s_add_u32 s61, s35, 56623104
  buffer_load_dwordx4 a[120:123], v1, s[4:7], s23 offen offset:0 sc1
  buffer_load_dwordx4 a[124:127], v1, s[4:7], s23 offen offset:1024 sc1
  buffer_load_dwordx4 a[128:131], v1, s[4:7], s23 offen offset:2048 sc1
  buffer_load_dwordx4 a[132:135], v1, s[4:7], s23 offen offset:3072 sc1
  buffer_load_dwordx4 a[136:139], v2, s[4:7], s23 offen offset:0 sc1
  buffer_load_dwordx4 a[140:143], v2, s[4:7], s23 offen offset:1024 sc1
  buffer_load_dwordx4 a[144:147], v2, s[4:7], s23 offen offset:2048 sc1
  buffer_load_dwordx4 a[148:151], v2, s[4:7], s23 offen offset:3072 sc1
  buffer_load_dwordx4 a[152:155], v3, s[4:7], s23 offen offset:0 sc1
  buffer_load_dwordx4 a[156:159], v3, s[4:7], s23 offen offset:1024 sc1
  buffer_load_dwordx4 a[160:163], v3, s[4:7], s23 offen offset:2048 sc1
  buffer_load_dwordx4 a[164:167], v3, s[4:7], s23 offen offset:3072 sc1
  buffer_load_dwordx4 a[216:219], v92, s[4:7], s61 offen offset:0 sc1
  buffer_load_dwordx4 a[220:223], v92, s[4:7], s61 offen offset:512 sc1
  buffer_load_dwordx4 a[224:227], v92, s[4:7], s61 offen offset:1024 sc1
  buffer_load_dwordx4 a[228:231], v92, s[4:7], s61 offen offset:1536 sc1
  buffer_load_dwordx4 a[232:235], v92, s[4:7], s61 offen offset:2048 sc1
  buffer_load_dwordx4 a[236:239], v92, s[4:7], s61 offen offset:2560 sc1
  buffer_load_dwordx4 a[168:171], v1, s[4:7], s60 offen offset:0 sc1
  buffer_load_dwordx4 a[172:175], v1, s[4:7], s60 offen offset:1024 sc1
  buffer_load_dwordx4 a[176:179], v1, s[4:7], s60 offen offset:2048 sc1
  buffer_load_dwordx4 a[180:183], v1, s[4:7], s60 offen offset:3072 sc1
  buffer_load_dwordx4 a[184:187], v2, s[4:7], s60 offen offset:0 sc1
  buffer_load_dwordx4 a[188:191], v2, s[4:7], s60 offen offset:1024 sc1
  buffer_load_dwordx4 a[192:195], v2, s[4:7], s60 offen offset:2048 sc1
  buffer_load_dwordx4 a[196:199], v2, s[4:7], s60 offen offset:3072 sc1
  buffer_load_dwordx4 a[200:203], v3, s[4:7], s60 offen offset:0 sc1
  buffer_load_dwordx4 a[204:207], v3, s[4:7], s60 offen offset:1024 sc1
  buffer_load_dwordx4 a[208:211], v3, s[4:7], s60 offen offset:2048 sc1
  buffer_load_dwordx4 a[212:215], v3, s[4:7], s60 offen offset:3072 sc1
  s_waitcnt vmcnt(5)
  v_mfma_f32_16x16x32_bf16 v[128:131], a[216:219], a[168:171], v[84:87]
  v_mfma_f32_16x16x32_bf16 v[132:135], a[120:123], a[168:171], v[88:91]
  v_mfma_f32_16x16x32_bf16 v[136:139], a[216:219], a[192:195], v[84:87]
  v_mfma_f32_16x16x32_bf16 v[140:143], a[120:123], a[192:195], 0
  v_mfma_f32_16x16x32_bf16 v[144:147], a[144:147], a[192:195], v[88:91]
  s_waitcnt vmcnt(4)
  v_mfma_f32_16x16x32_bf16 v[128:131], a[220:223], a[172:175], v[128:131]
  v_mfma_f32_16x16x32_bf16 v[132:135], a[124:127], a[172:175], v[132:135]
  v_mfma_f32_16x16x32_bf16 v[136:139], a[220:223], a[196:199], v[136:139]
  v_mfma_f32_16x16x32_bf16 v[140:143], a[124:127], a[196:199], v[140:143]
  v_mfma_f32_16x16x32_bf16 v[144:147], a[148:151], a[196:199], v[144:147]
  s_waitcnt vmcnt(3)
  v_mfma_f32_16x16x32_bf16 v[128:131], a[224:227], a[176:179], v[128:131]
  v_mfma_f32_16x16x32_bf16 v[132:135], a[128:131], a[176:179], v[132:135]
  v_mfma_f32_16x16x32_bf16 v[136:139], a[224:227], a[200:203], v[136:139]
  v_mfma_f32_16x16x32_bf16 v[140:143], a[128:131], a[200:203], v[140:143]
  v_mfma_f32_16x16x32_bf16 v[144:147], a[152:155], a[200:203], v[144:147]
  s_waitcnt vmcnt(2)
  v_mfma_f32_16x16x32_bf16 v[128:131], a[228:231], a[180:183], v[128:131]
  v_mfma_f32_16x16x32_bf16 v[132:135], a[132:135], a[180:183], v[132:135]
  v_mfma_f32_16x16x32_bf16 v[136:139], a[228:231], a[204:207], v[136:139]
  v_mfma_f32_16x16x32_bf16 v[140:143], a[132:135], a[204:207], v[140:143]
  v_mfma_f32_16x16x32_bf16 v[144:147], a[156:159], a[204:207], v[144:147]
  s_waitcnt vmcnt(1)
  v_mfma_f32_16x16x32_bf16 v[128:131], a[232:235], a[184:187], v[128:131]
  v_mfma_f32_16x16x32_bf16 v[132:135], a[136:139], a[184:187], v[132:135]
  v_mfma_f32_16x16x32_bf16 v[136:139], a[232:235], a[208:211], v[136:139]
  v_mfma_f32_16x16x32_bf16 v[140:143], a[136:139], a[208:211], v[140:143]
  v_mfma_f32_16x16x32_bf16 v[144:147], a[160:163], a[208:211], v[144:147]
  s_waitcnt vmcnt(0)
  v_mfma_f32_16x16x32_bf16 v[128:131], a[236:239], a[188:191], v[128:131]
  v_mfma_f32_16x16x32_bf16 v[132:135], a[140:143], a[188:191], v[132:135]
  v_mfma_f32_16x16x32_bf16 v[136:139], a[236:239], a[212:215], v[136:139]
  v_mfma_f32_16x16x32_bf16 v[140:143], a[140:143], a[212:215], v[140:143]
  v_mfma_f32_16x16x32_bf16 v[144:147], a[164:167], a[212:215], v[144:147]
  s_nop 3
  v_max3_f32 v28, v128, v129, v130
  v_max3_f32 v28, v28, v131, v132
  v_max3_f32 v28, v28, v133, v134
  v_max_f32 v28, v28, v135
  v_mov_b32 v29, v28
  s_nop 1
  v_permlane32_swap_b32 v28, v29
  v_max_f32 v28, v28, v29
  v_mov_b32 v29, v28
  s_nop 1
  v_permlane16_swap_b32 v28, v29
  v_max_f32 v28, v28, v29
  v_mul_f32 v28, s41, v28
  v_fma_f32 v128, v128, s41, -v28
  v_fma_f32 v129, v129, s41, -v28
  v_fma_f32 v130, v130, s41, -v28
  v_fma_f32 v131, v131, s41, -v28
  v_fma_f32 v132, v132, s41, -v28
  v_fma_f32 v133, v133, s41, -v28
  v_fma_f32 v134, v134, s41, -v28
  v_fma_f32 v135, v135, s41, -v28
  v_exp_f32 v128, v128
  v_exp_f32 v129, v129
  v_exp_f32 v130, v130
  v_exp_f32 v131, v131
  v_exp_f32 v132, v132
  v_exp_f32 v133, v133
  v_exp_f32 v134, v134
  v_exp_f32 v135, v135
  v_max3_f32 v30, v136, v137, v138
  v_max3_f32 v30, v30, v139, v140
  v_max3_f32 v30, v30, v141, v142
  v_max3_f32 v30, v30, v143, v144
  v_max3_f32 v30, v30, v145, v146
  v_max_f32 v30, v30, v147
  v_mov_b32 v29, v30
  s_nop 1
  v_permlane32_swap_b32 v30, v29
  v_max_f32 v30, v30, v29
  v_mov_b32 v29, v30
  s_nop 1
  v_permlane16_swap_b32 v30, v29
  v_max_f32 v30, v30, v29
  v_mul_f32 v30, s41, v30
  v_fma_f32 v136, v136, s41, -v30
  v_fma_f32 v137, v137, s41, -v30
  v_fma_f32 v138, v138, s41, -v30
  v_fma_f32 v139, v139, s41, -v30
  v_fma_f32 v140, v140, s41, -v30
  v_fma_f32 v141, v141, s41, -v30
  v_fma_f32 v142, v142, s41, -v30
  v_fma_f32 v143, v143, s41, -v30
  v_fma_f32 v144, v144, s41, -v30
  v_fma_f32 v145, v145, s41, -v30
  v_fma_f32 v146, v146, s41, -v30
  v_fma_f32 v147, v147, s41, -v30
  v_exp_f32 v136, v136
  v_exp_f32 v137, v137
  v_exp_f32 v138, v138
  v_exp_f32 v139, v139
  v_exp_f32 v140, v140
  v_exp_f32 v141, v141
  v_exp_f32 v142, v142
  v_exp_f32 v143, v143
  v_exp_f32 v144, v144
  v_exp_f32 v145, v145
  v_exp_f32 v146, v146
  v_exp_f32 v147, v147
  v_cvt_pk_bf16_f32 v72, v128, v129
  v_cvt_pk_bf16_f32 v73, v130, v131
  v_cvt_pk_bf16_f32 v74, v132, v133
  v_cvt_pk_bf16_f32 v75, v134, v135
  v_cvt_pk_bf16_f32 v76, v136, v137
  v_cvt_pk_bf16_f32 v77, v138, v139
  v_cvt_pk_bf16_f32 v78, v140, v141
  v_cvt_pk_bf16_f32 v79, v142, v143
  v_cvt_pk_bf16_f32 v80, v144, v145
  v_cvt_pk_bf16_f32 v81, v146, v147
  v_mfma_f32_16x16x16_bf16 v[148:151], v[36:37], v[72:73], 0
  v_mfma_f32_16x16x16_bf16 v[152:155], v[36:37], v[76:77], 0
  v_mfma_f32_16x16x16_bf16 v[148:151], v[36:37], v[74:75], v[148:151]
  v_mfma_f32_16x16x32_bf16 v[152:155], v[36:39], v[78:81], v[152:155]
  s_nop 6
  v_rcp_f32 v82, v148
  v_rcp_f32 v83, v152
  s_and_b32 s34, s17, 1
  s_mul_i32 s34, s34, 3072
  v_add_u32 v28, s34, v1
  ds_write_b128 v28, v[72:75] offset:16384
  ds_write_b128 v28, v[76:79] offset:17408
  ds_write_b128 v28, v[80:83] offset:18432
  s_waitcnt lgkmcnt(0)
  s_branch reca_b5101
reca_tw1102:
  s_cmp_lt_u32 s17, 3
  s_cbranch_scc1 reca_b5101
  s_sub_u32 s36, s17, 3
  s_and_b32 s37, s36, 15
  s_lshl_b32 s34, s59, 4
  s_add_u32 s34, s34, s37
  s_mul_i32 s34, s34, 12288
  s_add_u32 s23, s34, 44040192
  s_lshl_b32 s35, s37, 5
  s_add_u32 s35, s35, s59
  s_mul_i32 s35, s35, 3072
  s_add_u32 s61, s35, 58195968
  s_mul_i32 s34, s36, 393216
  s_mul_i32 s35, s59, 6144
  s_add_u32 s34, s34, s35
  s_add_u32 s60, s34, 59768832
  s_add_u32 s34, s17, 1
  s_and_b32 s34, s34, 1
  s_mul_i32 s34, s34, 3072
  v_add_u32 v28, s34, v1
  ds_read_b128 v[72:75], v28 offset:16384
  ds_read_b128 v[76:79], v28 offset:17408
  ds_read_b128 v[80:83], v28 offset:18432
  buffer_load_dwordx2 a[168:169], v93, s[4:7], s61 offen offset:0 sc1
  buffer_load_dwordx4 a[120:123], v1, s[4:7], s23 offen offset:0 sc1
  buffer_load_dwordx2 a[170:171], v93, s[4:7], s61 offen offset:256 sc1
  buffer_load_dwordx4 a[124:127], v1, s[4:7], s23 offen offset:1024 sc1
  buffer_load_dwordx2 a[172:173], v93, s[4:7], s61 offen offset:512 sc1
  buffer_load_dwordx4 a[128:131], v1, s[4:7], s23 offen offset:2048 sc1
  buffer_load_dwordx2 a[174:175], v93, s[4:7], s61 offen offset:768 sc1
  buffer_load_dwordx4 a[132:135], v1, s[4:7], s23 offen offset:3072 sc1
  buffer_load_dwordx2 a[176:177], v93, s[4:7], s61 offen offset:1024 sc1
  buffer_load_dwordx4 a[136:139], v2, s[4:7], s23 offen offset:0 sc1
  buffer_load_dwordx2 a[178:179], v93, s[4:7], s61 offen offset:1280 sc1
  buffer_load_dwordx4 a[140:143], v2, s[4:7], s23 offen offset:1024 sc1
  s_waitcnt lgkmcnt(0)
  s_waitcnt vmcnt(8)
  v_mfma_f32_16x16x16_bf16 v[156:159], a[168:169], v[72:73], 0
  v_mfma_f32_16x16x16_bf16 v[160:163], a[168:169], v[76:77], 0
  v_mfma_f32_16x16x16_bf16 v[156:159], a[120:121], v[74:75], v[156:159]
  v_mfma_f32_16x16x32_bf16 v[160:163], a[120:123], v[78:81], v[160:163]
  v_mfma_f32_16x16x16_bf16 v[164:167], a[170:171], v[72:73], 0
  v_mfma_f32_16x16x16_bf16 v[168:171], a[170:171], v[76:77], 0
  v_mfma_f32_16x16x16_bf16 v[164:167], a[124:125], v[74:75], v[164:167]
  v_mfma_f32_16x16x32_bf16 v[168:171], a[124:127], v[78:81], v[168:171]
  s_nop 2
  v_mul_f32 v156, v156, v82
  v_mul_f32 v157, v157, v82
  v_mul_f32 v158, v158, v82
  v_mul_f32 v159, v159, v82
  v_cvt_pk_bf16_f32 v172, v156, v157
  v_cvt_pk_bf16_f32 v173, v158, v159
  v_mul_f32 v164, v164, v82
  v_mul_f32 v165, v165, v82
  v_mul_f32 v166, v166, v82
  v_mul_f32 v167, v167, v82
  v_cvt_pk_bf16_f32 v174, v164, v165
  v_cvt_pk_bf16_f32 v175, v166, v167
  buffer_store_dwordx4 v[172:175], v1, s[4:7], s60 offen offset:0
  v_mul_f32 v160, v160, v83
  v_mul_f32 v161, v161, v83
  v_mul_f32 v162, v162, v83
  v_mul_f32 v163, v163, v83
  v_cvt_pk_bf16_f32 v176, v160, v161
  v_cvt_pk_bf16_f32 v177, v162, v163
  v_mul_f32 v168, v168, v83
  v_mul_f32 v169, v169, v83
  v_mul_f32 v170, v170, v83
  v_mul_f32 v171, v171, v83
  v_cvt_pk_bf16_f32 v178, v168, v169
  v_cvt_pk_bf16_f32 v179, v170, v171
  s_add_u32 s34, s60, 196608
  buffer_store_dwordx4 v[176:179], v1, s[4:7], s34 offen offset:0
  s_waitcnt vmcnt(6)
  v_mfma_f32_16x16x16_bf16 v[156:159], a[172:173], v[72:73], 0
  v_mfma_f32_16x16x16_bf16 v[160:163], a[172:173], v[76:77], 0
  v_mfma_f32_16x16x16_bf16 v[156:159], a[128:129], v[74:75], v[156:159]
  v_mfma_f32_16x16x32_bf16 v[160:163], a[128:131], v[78:81], v[160:163]
  v_mfma_f32_16x16x16_bf16 v[164:167], a[174:175], v[72:73], 0
  v_mfma_f32_16x16x16_bf16 v[168:171], a[174:175], v[76:77], 0
  v_mfma_f32_16x16x16_bf16 v[164:167], a[132:133], v[74:75], v[164:167]
  v_mfma_f32_16x16x32_bf16 v[168:171], a[132:135], v[78:81], v[168:171]
  s_nop 2
  v_mul_f32 v156, v156, v82
  v_mul_f32 v157, v157, v82
  v_mul_f32 v158, v158, v82
  v_mul_f32 v159, v159, v82
  v_cvt_pk_bf16_f32 v172, v156, v157
  v_cvt_pk_bf16_f32 v173, v158, v159
  v_mul_f32 v164, v164, v82
  v_mul_f32 v165, v165, v82
  v_mul_f32 v166, v166, v82
  v_mul_f32 v167, v167, v82
  v_cvt_pk_bf16_f32 v174, v164, v165
  v_cvt_pk_bf16_f32 v175, v166, v167
  buffer_store_dwordx4 v[172:175], v1, s[4:7], s60 offen offset:1024
  v_mul_f32 v160, v160, v83
  v_mul_f32 v161, v161, v83
  v_mul_f32 v162, v162, v83
  v_mul_f32 v163, v163, v83
  v_cvt_pk_bf16_f32 v176, v160, v161
  v_cvt_pk_bf16_f32 v177, v162, v163
  v_mul_f32 v168, v168, v83
  v_mul_f32 v169, v169, v83
  v_mul_f32 v170, v170, v83
  v_mul_f32 v171, v171, v83
  v_cvt_pk_bf16_f32 v178, v168, v169
  v_cvt_pk_bf16_f32 v179, v170, v171
  s_add_u32 s34, s60, 196608
  buffer_store_dwordx4 v[176:179], v1, s[4:7], s34 offen offset:1024
  s_waitcnt vmcnt(4)
  v_mfma_f32_16x16x16_bf16 v[156:159], a[176:177], v[72:73], 0
  v_mfma_f32_16x16x16_bf16 v[160:163], a[176:177], v[76:77], 0
  v_mfma_f32_16x16x16_bf16 v[156:159], a[136:137], v[74:75], v[156:159]
  v_mfma_f32_16x16x32_bf16 v[160:163], a[136:139], v[78:81], v[160:163]
  v_mfma_f32_16x16x16_bf16 v[164:167], a[178:179], v[72:73], 0
  v_mfma_f32_16x16x16_bf16 v[168:171], a[178:179], v[76:77], 0
  v_mfma_f32_16x16x16_bf16 v[164:167], a[140:141], v[74:75], v[164:167]
  v_mfma_f32_16x16x32_bf16 v[168:171], a[140:143], v[78:81], v[168:171]
  s_nop 2
  v_mul_f32 v156, v156, v82
  v_mul_f32 v157, v157, v82
  v_mul_f32 v158, v158, v82
  v_mul_f32 v159, v159, v82
  v_cvt_pk_bf16_f32 v172, v156, v157
  v_cvt_pk_bf16_f32 v173, v158, v159
  v_mul_f32 v164, v164, v82
  v_mul_f32 v165, v165, v82
  v_mul_f32 v166, v166, v82
  v_mul_f32 v167, v167, v82
  v_cvt_pk_bf16_f32 v174, v164, v165
  v_cvt_pk_bf16_f32 v175, v166, v167
  buffer_store_dwordx4 v[172:175], v1, s[4:7], s60 offen offset:2048
  v_mul_f32 v160, v160, v83
  v_mul_f32 v161, v161, v83
  v_mul_f32 v162, v162, v83
  v_mul_f32 v163, v163, v83
  v_cvt_pk_bf16_f32 v176, v160, v161
  v_cvt_pk_bf16_f32 v177, v162, v163
  v_mul_f32 v168, v168, v83
  v_mul_f32 v169, v169, v83
  v_mul_f32 v170, v170, v83
  v_mul_f32 v171, v171, v83
  v_cvt_pk_bf16_f32 v178, v168, v169
  v_cvt_pk_bf16_f32 v179, v170, v171
  s_add_u32 s34, s60, 196608
  buffer_store_dwordx4 v[176:179], v1, s[4:7], s34 offen offset:2048
  s_branch reca_b5101
reca_tw2103:
  s_cmp_lt_u32 s17, 3
  s_cbranch_scc1 reca_b5101
  s_sub_u32 s36, s17, 3
  s_and_b32 s37, s36, 15
  s_lshl_b32 s34, s59, 4
  s_add_u32 s34, s34, s37
  s_mul_i32 s34, s34, 12288
  s_add_u32 s23, s34, 44040192
  s_lshl_b32 s35, s37, 5
  s_add_u32 s35, s35, s59
  s_mul_i32 s35, s35, 3072
  s_add_u32 s61, s35, 58195968
  s_mul_i32 s34, s36, 393216
  s_mul_i32 s35, s59, 6144
  s_add_u32 s34, s34, s35
  s_add_u32 s60, s34, 59768832
  s_add_u32 s34, s17, 1
  s_and_b32 s34, s34, 1
  s_mul_i32 s34, s34, 3072
  v_add_u32 v28, s34, v1
  ds_read_b128 v[72:75], v28 offset:16384
  ds_read_b128 v[76:79], v28 offset:17408
  ds_read_b128 v[80:83], v28 offset:18432
  buffer_load_dwordx2 a[180:181], v93, s[4:7], s61 offen offset:1536 sc1
  buffer_load_dwordx4 a[144:147], v2, s[4:7], s23 offen offset:2048 sc1
  buffer_load_dwordx2 a[182:183], v93, s[4:7], s61 offen offset:1792 sc1
  buffer_load_dwordx4 a[148:151], v2, s[4:7], s23 offen offset:3072 sc1
  buffer_load_dwordx2 a[184:185], v93, s[4:7], s61 offen offset:2048 sc1
  buffer_load_dwordx4 a[152:155], v3, s[4:7], s23 offen offset:0 sc1
  buffer_load_dwordx2 a[186:187], v93, s[4:7], s61 offen offset:2304 sc1
  buffer_load_dwordx4 a[156:159], v3, s[4:7], s23 offen offset:1024 sc1
  buffer_load_dwordx2 a[188:189], v93, s[4:7], s61 offen offset:2560 sc1
  buffer_load_dwordx4 a[160:163], v3, s[4:7], s23 offen offset:2048 sc1
  buffer_load_dwordx2 a[190:191], v93, s[4:7], s61 offen offset:2816 sc1
  buffer_load_dwordx4 a[164:167], v3, s[4:7], s23 offen offset:3072 sc1
  s_waitcnt lgkmcnt(0)
  s_waitcnt vmcnt(8)
  v_mfma_f32_16x16x16_bf16 v[156:159], a[180:181], v[72:73], 0
  v_mfma_f32_16x16x16_bf16 v[160:163], a[180:181], v[76:77], 0
  v_mfma_f32_16x16x16_bf16 v[156:159], a[144:145], v[74:75], v[156:159]
  v_mfma_f32_16x16x32_bf16 v[160:163], a[144:147], v[78:81], v[160:163]
  v_mfma_f32_16x16x16_bf16 v[164:167], a[182:183], v[72:73], 0
  v_mfma_f32_16x16x16_bf16 v[168:171], a[182:183], v[76:77], 0
  v_mfma_f32_16x16x16_bf16 v[164:167], a[148:149], v[74:75], v[164:167]
  v_mfma_f32_16x16x32_bf16 v[168:171], a[148:151], v[78:81], v[168:171]
  s_nop 2
  v_mul_f32 v156, v156, v82
  v_mul_f32 v157, v157, v82
  v_mul_f32 v158, v158, v82
  v_mul_f32 v159, v159, v82
  v_cvt_pk_bf16_f32 v172, v156, v157
  v_cvt_pk_bf16_f32 v173, v158, v159
  v_mul_f32 v164, v164, v82
  v_mul_f32 v165, v165, v82
  v_mul_f32 v166, v166, v82
  v_mul_f32 v167, v167, v82
  v_cvt_pk_bf16_f32 v174, v164, v165
  v_cvt_pk_bf16_f32 v175, v166, v167
  buffer_store_dwordx4 v[172:175], v1, s[4:7], s60 offen offset:3072
  v_mul_f32 v160, v160, v83
  v_mul_f32 v161, v161, v83
  v_mul_f32 v162, v162, v83
  v_mul_f32 v163, v163, v83
  v_cvt_pk_bf16_f32 v176, v160, v161
  v_cvt_pk_bf16_f32 v177, v162, v163
  v_mul_f32 v168, v168, v83
  v_mul_f32 v169, v169, v83
  v_mul_f32 v170, v170, v83
  v_mul_f32 v171, v171, v83
  v_cvt_pk_bf16_f32 v178, v168, v169
  v_cvt_pk_bf16_f32 v179, v170, v171
  s_add_u32 s34, s60, 196608
  buffer_store_dwordx4 v[176:179], v1, s[4:7], s34 offen offset:3072
  s_waitcnt vmcnt(6)
  v_mfma_f32_16x16x16_bf16 v[156:159], a[184:185], v[72:73], 0
  v_mfma_f32_16x16x16_bf16 v[160:163], a[184:185], v[76:77], 0
  v_mfma_f32_16x16x16_bf16 v[156:159], a[152:153], v[74:75], v[156:159]
  v_mfma_f32_16x16x32_bf16 v[160:163], a[152:155], v[78:81], v[160:163]
  v_mfma_f32_16x16x16_bf16 v[164:167], a[186:187], v[72:73], 0
  v_mfma_f32_16x16x16_bf16 v[168:171], a[186:187], v[76:77], 0
  v_mfma_f32_16x16x16_bf16 v[164:167], a[156:157], v[74:75], v[164:167]
  v_mfma_f32_16x16x32_bf16 v[168:171], a[156:159], v[78:81], v[168:171]
  s_nop 2
  v_mul_f32 v156, v156, v82
  v_mul_f32 v157, v157, v82
  v_mul_f32 v158, v158, v82
  v_mul_f32 v159, v159, v82
  v_cvt_pk_bf16_f32 v172, v156, v157
  v_cvt_pk_bf16_f32 v173, v158, v159
  v_mul_f32 v164, v164, v82
  v_mul_f32 v165, v165, v82
  v_mul_f32 v166, v166, v82
  v_mul_f32 v167, v167, v82
  v_cvt_pk_bf16_f32 v174, v164, v165
  v_cvt_pk_bf16_f32 v175, v166, v167
  buffer_store_dwordx4 v[172:175], v2, s[4:7], s60 offen offset:0
  v_mul_f32 v160, v160, v83
  v_mul_f32 v161, v161, v83
  v_mul_f32 v162, v162, v83
  v_mul_f32 v163, v163, v83
  v_cvt_pk_bf16_f32 v176, v160, v161
  v_cvt_pk_bf16_f32 v177, v162, v163
  v_mul_f32 v168, v168, v83
  v_mul_f32 v169, v169, v83
  v_mul_f32 v170, v170, v83
  v_mul_f32 v171, v171, v83
  v_cvt_pk_bf16_f32 v178, v168, v169
  v_cvt_pk_bf16_f32 v179, v170, v171
  s_add_u32 s34, s60, 196608
  buffer_store_dwordx4 v[176:179], v2, s[4:7], s34 offen offset:0
  s_waitcnt vmcnt(4)
  v_mfma_f32_16x16x16_bf16 v[156:159], a[188:189], v[72:73], 0
  v_mfma_f32_16x16x16_bf16 v[160:163], a[188:189], v[76:77], 0
  v_mfma_f32_16x16x16_bf16 v[156:159], a[160:161], v[74:75], v[156:159]
  v_mfma_f32_16x16x32_bf16 v[160:163], a[160:163], v[78:81], v[160:163]
  v_mfma_f32_16x16x16_bf16 v[164:167], a[190:191], v[72:73], 0
  v_mfma_f32_16x16x16_bf16 v[168:171], a[190:191], v[76:77], 0
  v_mfma_f32_16x16x16_bf16 v[164:167], a[164:165], v[74:75], v[164:167]
  v_mfma_f32_16x16x32_bf16 v[168:171], a[164:167], v[78:81], v[168:171]
  s_nop 2
  v_mul_f32 v156, v156, v82
  v_mul_f32 v157, v157, v82
  v_mul_f32 v158, v158, v82
  v_mul_f32 v159, v159, v82
  v_cvt_pk_bf16_f32 v172, v156, v157
  v_cvt_pk_bf16_f32 v173, v158, v159
  v_mul_f32 v164, v164, v82
  v_mul_f32 v165, v165, v82
  v_mul_f32 v166, v166, v82
  v_mul_f32 v167, v167, v82
  v_cvt_pk_bf16_f32 v174, v164, v165
  v_cvt_pk_bf16_f32 v175, v166, v167
  buffer_store_dwordx4 v[172:175], v2, s[4:7], s60 offen offset:1024
  v_mul_f32 v160, v160, v83
  v_mul_f32 v161, v161, v83
  v_mul_f32 v162, v162, v83
  v_mul_f32 v163, v163, v83
  v_cvt_pk_bf16_f32 v176, v160, v161
  v_cvt_pk_bf16_f32 v177, v162, v163
  v_mul_f32 v168, v168, v83
  v_mul_f32 v169, v169, v83
  v_mul_f32 v170, v170, v83
  v_mul_f32 v171, v171, v83
  v_cvt_pk_bf16_f32 v178, v168, v169
  v_cvt_pk_bf16_f32 v179, v170, v171
  s_add_u32 s34, s60, 196608
  buffer_store_dwordx4 v[176:179], v2, s[4:7], s34 offen offset:1024
  s_branch reca_b5101
  s_cmp_lg_u32 s12, 2
  s_cbranch_scc1 reca_b399
  buffer_store_dwordx2 v[52:53], v9, s[4:7], s30 offen
  buffer_store_dwordx2 v[32:33], v16, s[4:7], s26 offen
  s_cmp_lg_u32 s14, 0
  s_cbranch_scc1 reca_b399
  v_mov_b32 v28, s17
  s_lshl_b32 s34, s13, 7
  s_add_u32 s34, s34, 1507328
  buffer_store_dword v28, v19, s[4:7], s34 offen
  s_branch reca_b399
reca_last98:
  s_cmp_lg_u32 s12, 2
  s_cbranch_scc1 reca_exit1
  buffer_store_dwordx2 v[52:53], v9, s[4:7], s30 offen
  s_branch reca_exit1
reca_swave96:
  s_cmp_lg_u32 s17, 63
  s_cbranch_scc1 reca_vmst104
  s_barrier
  ds_read_b128 v[56:59], v1 offset:10240
  ds_read_b128 v[60:63], v1 offset:11264
  ds_read_b128 v[64:67], v1 offset:12288
  s_waitcnt lgkmcnt(0)
  v_add_f32 v56, v56, v64
  v_add_f32 v60, v60, v48
  v_add_f32 v57, v57, v65
  v_add_f32 v61, v61, v49
  v_add_f32 v58, v58, v66
  v_add_f32 v62, v62, v50
  v_add_f32 v59, v59, v67
  v_add_f32 v63, v63, v51
  v_cvt_pk_bf16_f32 v68, v56, v57
  v_cvt_pk_bf16_f32 v69, v58, v59
  v_cvt_pk_bf16_f32 v70, v60, v61
  v_cvt_pk_bf16_f32 v71, v62, v63
  buffer_store_dwordx2 v[52:53], v9, s[4:7], s30 offen
  buffer_store_dwordx2 v[68:69], v10, s[4:7], s31 offen
  buffer_store_dwordx2 v[70:71], v10, s[4:7], s31 offen offset:256
  s_branch reca_exit1
reca_vmst104:
  s_sleep 1
  buffer_load_dwordx4 v[208:211], v1, s[4:7], s21 offen offset:0 sc1
  buffer_load_dwordx4 v[212:215], v1, s[4:7], s21 offen offset:1024 sc1
  buffer_load_dwordx4 v[216:219], v1, s[4:7], s21 offen offset:2048 sc1
  buffer_load_dwordx4 v[220:223], v1, s[4:7], s21 offen offset:3072 sc1
  buffer_load_dwordx4 v[224:227], v2, s[4:7], s21 offen offset:0 sc1
  buffer_load_dwordx4 v[228:231], v2, s[4:7], s21 offen offset:1024 sc1
  s_waitcnt vmcnt(5)
  v_max_u32 v29, v208, v210
  v_cmp_eq_u32 vcc, -1, v29
  s_cbranch_vccnz reca_retry105
reca_resume106:
  s_waitcnt vmcnt(4)
  v_max_u32 v29, v212, v214
  v_cmp_eq_u32 vcc, -1, v29
  v_mfma_f32_16x16x32_bf16 v[76:79], a[120:123], v[208:211], 0
  v_mfma_f32_16x16x32_bf16 v[80:83], a[144:147], v[208:211], 0
  v_mfma_f32_16x16x32_bf16 v[72:75], v[208:211], v[208:211], v[40:43]
  s_cbranch_vccnz reca_retry107
reca_resume108:
  s_waitcnt vmcnt(3)
  v_max_u32 v29, v216, v218
  v_cmp_eq_u32 vcc, -1, v29
  v_mfma_f32_16x16x32_bf16 v[76:79], a[124:127], v[212:215], v[76:79]
  v_mfma_f32_16x16x32_bf16 v[80:83], a[148:151], v[212:215], v[80:83]
  v_mfma_f32_16x16x32_bf16 v[72:75], v[212:215], v[212:215], v[72:75]
  s_cbranch_vccnz reca_retry109
reca_resume110:
  s_waitcnt vmcnt(2)
  v_max_u32 v29, v220, v222
  v_cmp_eq_u32 vcc, -1, v29
  v_mfma_f32_16x16x32_bf16 v[76:79], a[128:131], v[216:219], v[76:79]
  v_mfma_f32_16x16x32_bf16 v[80:83], a[152:155], v[216:219], v[80:83]
  v_mfma_f32_16x16x32_bf16 v[72:75], v[216:219], v[216:219], v[72:75]
  s_cbranch_vccnz reca_retry111
reca_resume112:
  s_waitcnt vmcnt(1)
  v_max_u32 v29, v224, v226
  v_cmp_eq_u32 vcc, -1, v29
  v_mfma_f32_16x16x32_bf16 v[76:79], a[132:135], v[220:223], v[76:79]
  v_mfma_f32_16x16x32_bf16 v[80:83], a[156:159], v[220:223], v[80:83]
  v_mfma_f32_16x16x32_bf16 v[72:75], v[220:223], v[220:223], v[72:75]
  s_cbranch_vccnz reca_retry113
reca_resume114:
  s_waitcnt vmcnt(0)
  v_max_u32 v29, v228, v230
  v_cmp_eq_u32 vcc, -1, v29
  v_mfma_f32_16x16x32_bf16 v[76:79], a[136:139], v[224:227], v[76:79]
  v_mfma_f32_16x16x32_bf16 v[80:83], a[160:163], v[224:227], v[80:83]
  v_mfma_f32_16x16x32_bf16 v[72:75], v[224:227], v[224:227], v[72:75]
  s_cbranch_vccnz reca_retry115
reca_resume116:
  v_mfma_f32_16x16x32_bf16 v[76:79], a[140:143], v[228:231], v[76:79]
  v_mfma_f32_16x16x32_bf16 v[80:83], a[164:167], v[228:231], v[80:83]
  v_mfma_f32_16x16x32_bf16 v[72:75], v[228:231], v[228:231], v[72:75]
  s_barrier
  ds_read_b128 v[56:59], v1 offset:10240
  ds_read_b128 v[60:63], v1 offset:11264
  ds_read_b128 v[64:67], v1 offset:12288
  s_nop 1
  v_max3_f32 v28, v76, v77, v78
  v_max3_f32 v29, v80, v81, v82
  v_max3_f32 v28, v28, v79, v83
  v_max3_f32 v29, v29, v72, v73
  v_max3_f32 v28, v28, v74, v75
  v_max_f32 v28, v28, v29
  v_mov_b32 v29, v28
  s_nop 1
  v_permlane32_swap_b32 v28, v29
  v_max_f32 v28, v28, v29
  v_mov_b32 v29, v28
  s_nop 1
  v_permlane16_swap_b32 v28, v29
  v_max_f32 v28, v28, v29
  v_mul_f32 v28, s41, v28
  v_fma_f32 v76, v76, s41, -v28
  v_fma_f32 v77, v77, s41, -v28
  v_fma_f32 v78, v78, s41, -v28
  v_fma_f32 v79, v79, s41, -v28
  v_fma_f32 v80, v80, s41, -v28
  v_fma_f32 v81, v81, s41, -v28
  v_fma_f32 v82, v82, s41, -v28
  v_fma_f32 v83, v83, s41, -v28
  v_fma_f32 v72, v72, s41, -v28
  v_fma_f32 v73, v73, s41, -v28
  v_fma_f32 v74, v74, s41, -v28
  v_fma_f32 v75, v75, s41, -v28
  v_exp_f32 v76, v76
  v_exp_f32 v77, v77
  v_exp_f32 v78, v78
  v_exp_f32 v79, v79
  v_exp_f32 v80, v80
  v_exp_f32 v81, v81
  v_exp_f32 v82, v82
  v_exp_f32 v83, v83
  v_cvt_pk_bf16_f32 v84, v76, v77
  v_cvt_pk_bf16_f32 v85, v78, v79
  v_cvt_pk_bf16_f32 v86, v80, v81
  v_cvt_pk_bf16_f32 v87, v82, v83
  v_exp_f32 v72, v72
  v_exp_f32 v73, v73
  v_mfma_f32_16x16x32_bf16 v[100:103], v[36:39], v[84:87], 0
  v_exp_f32 v74, v74
  v_exp_f32 v75, v75
  v_mfma_f32_16x16x32_bf16 v[92:95], a[168:171], v[84:87], 0
  v_cvt_pk_bf16_f32 v88, v72, v73
  v_cvt_pk_bf16_f32 v89, v74, v75
  v_mfma_f32_16x16x32_bf16 v[96:99], a[172:175], v[84:87], 0
  s_waitcnt lgkmcnt(0)
  v_mfma_f32_16x16x16_bf16 v[100:103], v[36:37], v[88:89], v[100:103]
  v_add_f32 v56, v56, v64
  v_add_f32 v60, v60, v48
  v_add_f32 v57, v57, v65
  v_add_f32 v61, v61, v49
  v_add_f32 v58, v58, v66
  v_add_f32 v62, v62, v50
  v_add_f32 v59, v59, v67
  v_add_f32 v63, v63, v51
  v_cvt_pk_bf16_f32 v68, v56, v57
  v_cvt_pk_bf16_f32 v69, v58, v59
  v_cvt_pk_bf16_f32 v70, v60, v61
  v_cvt_pk_bf16_f32 v71, v62, v63
  v_mfma_f32_16x16x16_bf16 v[92:95], v[68:69], v[88:89], v[92:95]
  v_rcp_f32 v28, v100
  v_mfma_f32_16x16x16_bf16 v[96:99], v[70:71], v[88:89], v[96:99]
  v_mov_b32 v29, v28
  s_nop 4
  v_pk_mul_f32 v[92:93], v[92:93], v[28:29]
  v_pk_mul_f32 v[94:95], v[94:95], v[28:29]
  v_pk_mul_f32 v[96:97], v[96:97], v[28:29]
  v_pk_mul_f32 v[98:99], v[98:99], v[28:29]
  v_cvt_pk_bf16_f32 v104, v92, v93
  v_cvt_pk_bf16_f32 v105, v94, v95
  v_cvt_pk_bf16_f32 v106, v96, v97
  v_cvt_pk_bf16_f32 v107, v98, v99
  buffer_store_dwordx4 v[104:107], v11, s[4:7], s22 offen
  s_barrier
  s_add_u32 s34, s17, 2
  s_and_b32 s34, s34, 3
  s_mul_i32 s26, s34, 10240
  s_add_u32 s26, s26, s38
  s_mul_i32 s27, s34, 6144
  s_add_u32 s27, s27, s39
  s_mul_i32 s28, s34, 12288
  s_add_u32 s28, s28, s40
  s_mul_i32 s29, s34, 393216
  s_add_u32 s29, s29, s56
  buffer_store_dwordx2 v[32:33], v8, s[4:7], s27 offen
  buffer_store_dwordx4 v[32:35], v11, s[4:7], s28 offen
  s_add_u32 s36, s17, 1
  s_cmp_ge_u32 s36, 63
  s_cbranch_scc1 reca_nopf117
  s_add_u32 s37, s36, 1
reca_pf118:
  buffer_load_dword v28, v233, s[4:7], 0 offen sc1
  s_waitcnt vmcnt(0)
  v_cmp_gt_i32 vcc, s37, v28
  s_cbranch_vccz reca_pfok119
  s_sleep 1
  s_sub_u32 s18, s18, 1
  s_cbranch_scc0 reca_pf118
  s_mov_b32 s18, 0
reca_pfok119:
  s_lshl_b32 s34, s15, 4
  s_and_b32 s35, s36, 15
  s_add_u32 s34, s34, s35
  s_mul_i32 s34, s34, 12288
  s_add_u32 s32, s34, 37748736
  s_lshl_b32 s35, s16, 11
  s_add_u32 s34, s34, s35
  s_add_u32 s33, s34, 44040192
  buffer_load_dwordx4 a[120:123], v1, s[4:7], s32 offen offset:0 sc1
  buffer_load_dwordx4 a[124:127], v1, s[4:7], s32 offen offset:1024 sc1
  buffer_load_dwordx4 a[128:131], v1, s[4:7], s32 offen offset:2048 sc1
  buffer_load_dwordx4 a[132:135], v1, s[4:7], s32 offen offset:3072 sc1
  buffer_load_dwordx4 a[136:139], v2, s[4:7], s32 offen offset:0 sc1
  buffer_load_dwordx4 a[140:143], v2, s[4:7], s32 offen offset:1024 sc1
  buffer_load_dwordx4 a[144:147], v2, s[4:7], s32 offen offset:2048 sc1
  buffer_load_dwordx4 a[148:151], v2, s[4:7], s32 offen offset:3072 sc1
  buffer_load_dwordx4 a[152:155], v3, s[4:7], s32 offen offset:0 sc1
  buffer_load_dwordx4 a[156:159], v3, s[4:7], s32 offen offset:1024 sc1
  buffer_load_dwordx4 a[160:163], v3, s[4:7], s32 offen offset:2048 sc1
  buffer_load_dwordx4 a[164:167], v3, s[4:7], s32 offen offset:3072 sc1
  buffer_load_dwordx4 a[168:171], v1, s[4:7], s33 offen offset:0 sc1
  buffer_load_dwordx4 a[172:175], v1, s[4:7], s33 offen offset:1024 sc1
reca_nopf117:
  buffer_store_dwordx2 v[52:53], v9, s[4:7], s30 offen
  buffer_store_dwordx2 v[68:69], v10, s[4:7], s31 offen
  buffer_store_dwordx2 v[70:71], v10, s[4:7], s31 offen offset:256
reca_b5101:
  s_barrier
  s_add_u32 s17, s17, 1
  s_branch reca_step87
reca_b399:
  s_endpgm
reca_retry90:
  s_sub_u32 s18, s18, 1
  s_cbranch_scc1 reca_retry90_to
  buffer_load_dwordx4 v[128:131], v4, s[4:7], s20 offen sc1
  buffer_load_dwordx4 v[132:135], v4, s[4:7], s20 offen offset:1024 sc1
  buffer_load_dwordx4 v[136:139], v5, s[4:7], s20 offen sc1
  s_waitcnt vmcnt(2)
  v_max_u32 v29, v128, v130
  v_cmp_eq_u32 vcc, -1, v29
  s_cbranch_vccnz reca_retry90
  s_branch reca_resume91
reca_retry90_to:
  s_mov_b32 s18, 0
  s_waitcnt vmcnt(0)
  s_branch reca_resume91
reca_retry92:
  s_sub_u32 s18, s18, 1
  s_cbranch_scc1 reca_retry92_to
  buffer_load_dwordx4 v[132:135], v4, s[4:7], s20 offen offset:1024 sc1
  buffer_load_dwordx4 v[136:139], v5, s[4:7], s20 offen sc1
  s_waitcnt vmcnt(1)
  v_max_u32 v29, v132, v134
  v_cmp_eq_u32 vcc, -1, v29
  s_cbranch_vccnz reca_retry92
  s_branch reca_resume93
reca_retry92_to:
  s_mov_b32 s18, 0
  s_waitcnt vmcnt(0)
  s_branch reca_resume93
reca_retry94:
  s_sub_u32 s18, s18, 1
  s_cbranch_scc1 reca_retry94_to
  buffer_load_dwordx4 v[136:139], v5, s[4:7], s20 offen sc1
  s_waitcnt vmcnt(0)
  v_max_u32 v29, v136, v138
  v_cmp_eq_u32 vcc, -1, v29
  s_cbranch_vccnz reca_retry94
  s_branch reca_resume95
reca_retry94_to:
  s_mov_b32 s18, 0
  s_waitcnt vmcnt(0)
  s_branch reca_resume95
reca_retry105:
  s_sub_u32 s18, s18, 1
  s_cbranch_scc1 reca_retry105_to
  buffer_load_dwordx4 v[208:211], v1, s[4:7], s21 offen offset:0 sc1
  buffer_load_dwordx4 v[212:215], v1, s[4:7], s21 offen offset:1024 sc1
  buffer_load_dwordx4 v[216:219], v1, s[4:7], s21 offen offset:2048 sc1
  buffer_load_dwordx4 v[220:223], v1, s[4:7], s21 offen offset:3072 sc1
  buffer_load_dwordx4 v[224:227], v2, s[4:7], s21 offen offset:0 sc1
  buffer_load_dwordx4 v[228:231], v2, s[4:7], s21 offen offset:1024 sc1
  s_waitcnt vmcnt(5)
  v_max_u32 v29, v208, v210
  v_cmp_eq_u32 vcc, -1, v29
  s_cbranch_vccnz reca_retry105
  s_branch reca_resume106
reca_retry105_to:
  s_mov_b32 s18, 0
  s_waitcnt vmcnt(0)
  s_branch reca_resume106
reca_retry107:
  s_sub_u32 s18, s18, 1
  s_cbranch_scc1 reca_retry107_to
  buffer_load_dwordx4 v[212:215], v1, s[4:7], s21 offen offset:1024 sc1
  buffer_load_dwordx4 v[216:219], v1, s[4:7], s21 offen offset:2048 sc1
  buffer_load_dwordx4 v[220:223], v1, s[4:7], s21 offen offset:3072 sc1
  buffer_load_dwordx4 v[224:227], v2, s[4:7], s21 offen offset:0 sc1
  buffer_load_dwordx4 v[228:231], v2, s[4:7], s21 offen offset:1024 sc1
  s_waitcnt vmcnt(4)
  v_max_u32 v29, v212, v214
  v_cmp_eq_u32 vcc, -1, v29
  s_cbranch_vccnz reca_retry107
  s_branch reca_resume108
reca_retry107_to:
  s_mov_b32 s18, 0
  s_waitcnt vmcnt(0)
  s_branch reca_resume108
reca_retry109:
  s_sub_u32 s18, s18, 1
  s_cbranch_scc1 reca_retry109_to
  buffer_load_dwordx4 v[216:219], v1, s[4:7], s21 offen offset:2048 sc1
  buffer_load_dwordx4 v[220:223], v1, s[4:7], s21 offen offset:3072 sc1
  buffer_load_dwordx4 v[224:227], v2, s[4:7], s21 offen offset:0 sc1
  buffer_load_dwordx4 v[228:231], v2, s[4:7], s21 offen offset:1024 sc1
  s_waitcnt vmcnt(3)
  v_max_u32 v29, v216, v218
  v_cmp_eq_u32 vcc, -1, v29
  s_cbranch_vccnz reca_retry109
  s_branch reca_resume110
reca_retry109_to:
  s_mov_b32 s18, 0
  s_waitcnt vmcnt(0)
  s_branch reca_resume110
reca_retry111:
  s_sub_u32 s18, s18, 1
  s_cbranch_scc1 reca_retry111_to
  buffer_load_dwordx4 v[220:223], v1, s[4:7], s21 offen offset:3072 sc1
  buffer_load_dwordx4 v[224:227], v2, s[4:7], s21 offen offset:0 sc1
  buffer_load_dwordx4 v[228:231], v2, s[4:7], s21 offen offset:1024 sc1
  s_waitcnt vmcnt(2)
  v_max_u32 v29, v220, v222
  v_cmp_eq_u32 vcc, -1, v29
  s_cbranch_vccnz reca_retry111
  s_branch reca_resume112
reca_retry111_to:
  s_mov_b32 s18, 0
  s_waitcnt vmcnt(0)
  s_branch reca_resume112
reca_retry113:
  s_sub_u32 s18, s18, 1
  s_cbranch_scc1 reca_retry113_to
  buffer_load_dwordx4 v[224:227], v2, s[4:7], s21 offen offset:0 sc1
  buffer_load_dwordx4 v[228:231], v2, s[4:7], s21 offen offset:1024 sc1
  s_waitcnt vmcnt(1)
  v_max_u32 v29, v224, v226
  v_cmp_eq_u32 vcc, -1, v29
  s_cbranch_vccnz reca_retry113
  s_branch reca_resume114
reca_retry113_to:
  s_mov_b32 s18, 0
  s_waitcnt vmcnt(0)
  s_branch reca_resume114
reca_retry115:
  s_sub_u32 s18, s18, 1
  s_cbranch_scc1 reca_retry115_to
  buffer_load_dwordx4 v[228:231], v2, s[4:7], s21 offen offset:1024 sc1
  s_waitcnt vmcnt(0)
  v_max_u32 v29, v228, v230
  v_cmp_eq_u32 vcc, -1, v29
  s_cbranch_vccnz reca_retry115
  s_branch reca_resume116
reca_retry115_to:
  s_mov_b32 s18, 0
  s_waitcnt vmcnt(0)
  s_branch reca_resume116
reca_slow11:
  s_cmp_ge_u32 s14, 20
  s_cbranch_scc1 reca_twins13
  s_branch reca_gotmem121
reca_step120:
  s_and_b32 s34, s17, 3
  s_mul_i32 s20, s34, 10240
  s_add_u32 s20, s20, s38
  s_sleep 2
  buffer_load_dwordx4 v[128:131], v4, s[4:7], s20 offen sc1
  buffer_load_dwordx4 v[132:135], v4, s[4:7], s20 offen offset:1024 sc1
  buffer_load_dwordx4 v[136:139], v5, s[4:7], s20 offen sc1
  s_waitcnt vmcnt(2)
  v_max_u32 v29, v128, v130
  v_cmp_eq_u32 vcc, -1, v29
  s_cbranch_vccnz reca_retry123
reca_resume124:
  s_waitcnt vmcnt(1)
  v_max_u32 v29, v132, v134
  v_cmp_eq_u32 vcc, -1, v29
  ds_write_b128 v4, v[128:131]
  s_cbranch_vccnz reca_retry125
reca_resume126:
  s_waitcnt vmcnt(0)
  v_max_u32 v29, v136, v138
  v_cmp_eq_u32 vcc, -1, v29
  ds_write_b128 v4, v[132:135] offset:1024
  s_cbranch_vccnz reca_retry127
reca_resume128:
  ds_write_b128 v5, v[136:139]
  s_branch reca_gotmem2122
reca_gotmem121:
  ds_write_b128 v4, v[128:131]
  ds_write_b128 v4, v[132:135] offset:1024
  ds_write_b128 v5, v[136:139]
reca_gotmem2122:
  s_and_b32 s34, s17, 3
  s_mul_i32 s21, s34, 6144
  s_add_u32 s21, s21, s39
  s_mul_i32 s22, s34, 12288
  s_add_u32 s22, s22, s40
  s_mul_i32 s25, s34, 393216
  s_add_u32 s25, s25, s56
  s_add_u32 s35, s17, 1
  s_and_b32 s35, s35, 3
  s_mul_i32 s24, s35, 10240
  s_add_u32 s24, s24, s38
  s_waitcnt lgkmcnt(0)
  s_barrier
  ds_read_b128 v[128:131], v236 offset:0
  ds_read_b128 v[132:135], v236 offset:1024
  ds_read_b128 v[136:139], v236 offset:2048
  ds_read_b128 v[140:143], v236 offset:3072
  ds_read_b128 v[144:147], v236 offset:4096
  ds_read_b128 v[148:151], v237 offset:0
  ds_read_b128 v[152:155], v237 offset:1024
  ds_read_b128 v[156:159], v237 offset:2048
  ds_read_b128 v[160:163], v237 offset:3072
  ds_read_b128 v[164:167], v237 offset:4096
  s_waitcnt lgkmcnt(9)
  v_mfma_f32_16x16x32_bf16 v[44:47], a[0:3], v[128:131], 0
  ds_read_b128 v[168:171], v6 offset:0
  v_mfma_f32_16x16x32_bf16 v[240:243], a[4:7], v[128:131], 0
  s_waitcnt lgkmcnt(9)
  v_mfma_f32_16x16x32_bf16 v[44:47], a[8:11], v[132:135], v[44:47]
  ds_read_b128 v[172:175], v6 offset:512
  v_mfma_f32_16x16x32_bf16 v[240:243], a[12:15], v[132:135], v[240:243]
  s_waitcnt lgkmcnt(9)
  v_mfma_f32_16x16x32_bf16 v[44:47], a[16:19], v[136:139], v[44:47]
  ds_read_b128 v[176:179], v6 offset:1024
  v_mfma_f32_16x16x32_bf16 v[240:243], a[20:23], v[136:139], v[240:243]
  s_waitcnt lgkmcnt(9)
  v_mfma_f32_16x16x32_bf16 v[44:47], a[24:27], v[140:143], v[44:47]
  ds_read_b128 v[180:183], v6 offset:1536
  v_mfma_f32_16x16x32_bf16 v[240:243], a[28:31], v[140:143], v[240:243]
  s_waitcnt lgkmcnt(9)
  v_mfma_f32_16x16x32_bf16 v[44:47], a[32:35], v[144:147], v[44:47]
  ds_read_b128 v[184:187], v6 offset:2048
  v_mfma_f32_16x16x32_bf16 v[240:243], a[36:39], v[144:147], v[240:243]
  s_waitcnt lgkmcnt(9)
  v_mfma_f32_16x16x32_bf16 v[44:47], a[40:43], v[148:151], v[44:47]
  ds_read_b128 v[188:191], v6 offset:2560
  v_mfma_f32_16x16x32_bf16 v[240:243], a[44:47], v[148:151], v[240:243]
  s_waitcnt lgkmcnt(9)
  v_mfma_f32_16x16x32_bf16 v[44:47], a[48:51], v[152:155], v[44:47]
  ds_read_b128 v[192:195], v6 offset:3072
  v_mfma_f32_16x16x32_bf16 v[240:243], a[52:55], v[152:155], v[240:243]
  s_waitcnt lgkmcnt(9)
  v_mfma_f32_16x16x32_bf16 v[44:47], a[56:59], v[156:159], v[44:47]
  ds_read_b128 v[196:199], v6 offset:3584
  v_mfma_f32_16x16x32_bf16 v[240:243], a[60:63], v[156:159], v[240:243]
  s_waitcnt lgkmcnt(9)
  v_mfma_f32_16x16x32_bf16 v[44:47], a[64:67], v[160:163], v[44:47]
  ds_read_b128 v[200:203], v6 offset:4096
  v_mfma_f32_16x16x32_bf16 v[240:243], a[68:71], v[160:163], v[240:243]
  s_waitcnt lgkmcnt(9)
  v_mfma_f32_16x16x32_bf16 v[44:47], a[72:75], v[164:167], v[44:47]
  ds_read_b128 v[204:207], v6 offset:4608
  v_mfma_f32_16x16x32_bf16 v[240:243], a[76:79], v[164:167], v[240:243]
  s_waitcnt lgkmcnt(9)
  v_mfma_f32_16x16x32_bf16 v[48:51], v[168:171], a[80:83], 0
  s_and_b32 s34, s17, 15
  s_lshl_b32 s34, s34, 5
  s_add_u32 s34, s34, s15
  s_mul_i32 s34, s34, 3072
  s_lshl_b32 s35, s16, 9
  s_add_u32 s34, s34, s35
  s_add_u32 s30, s34, 56623104
  s_add_u32 s31, s34, 58195968
  v_add_f32_dpp v44, v240, v44 row_ror:8 row_mask:0xf bank_mask:0xf
  v_add_f32_dpp v45, v241, v45 row_ror:8 row_mask:0xf bank_mask:0xf
  v_add_f32_dpp v46, v242, v46 row_ror:8 row_mask:0xf bank_mask:0xf
  v_add_f32_dpp v47, v243, v47 row_ror:8 row_mask:0xf bank_mask:0xf
  v_cvt_pk_bf16_f32 v52, v44, v45
  v_cvt_pk_bf16_f32 v53, v46, v47
  buffer_store_dwordx2 v[52:53], v8, s[4:7], s21 offen sc1
  s_waitcnt lgkmcnt(8)
  v_mfma_f32_16x16x32_bf16 v[48:51], v[172:175], a[84:87], v[48:51]
  s_waitcnt lgkmcnt(7)
  v_mfma_f32_16x16x32_bf16 v[48:51], v[176:179], a[88:91], v[48:51]
  s_waitcnt lgkmcnt(6)
  v_mfma_f32_16x16x32_bf16 v[48:51], v[180:183], a[92:95], v[48:51]
  s_waitcnt lgkmcnt(5)
  v_mfma_f32_16x16x32_bf16 v[48:51], v[184:187], a[96:99], v[48:51]
  s_waitcnt lgkmcnt(4)
  v_mfma_f32_16x16x32_bf16 v[48:51], v[188:191], a[100:103], v[48:51]
  s_waitcnt lgkmcnt(3)
  v_mfma_f32_16x16x32_bf16 v[48:51], v[192:195], a[104:107], v[48:51]
  s_waitcnt lgkmcnt(2)
  v_mfma_f32_16x16x32_bf16 v[48:51], v[196:199], a[108:111], v[48:51]
  s_waitcnt lgkmcnt(1)
  v_mfma_f32_16x16x32_bf16 v[48:51], v[200:203], a[112:115], v[48:51]
  s_waitcnt lgkmcnt(0)
  v_mfma_f32_16x16x32_bf16 v[48:51], v[204:207], a[116:119], v[48:51]
  s_cmp_eq_u32 s12, 3
  s_cbranch_scc1 reca_swave129
  s_nop 5
  ds_write_b128 v17, v[48:51]
  s_add_u32 s34, s17, 2
  s_and_b32 s34, s34, 3
  s_mul_i32 s26, s34, 10240
  s_add_u32 s26, s26, s38
  s_mul_i32 s27, s34, 6144
  s_add_u32 s27, s27, s39
  s_mul_i32 s28, s34, 12288
  s_add_u32 s28, s28, s40
  s_mul_i32 s29, s34, 393216
  s_add_u32 s29, s29, s56
  s_waitcnt lgkmcnt(0)
  s_barrier
  s_cmp_eq_u32 s17, 63
  s_cbranch_scc1 reca_last131
  buffer_store_dwordx2 v[32:33], v8, s[4:7], s27 offen sc1
  s_cmp_lg_u32 s12, 2
  s_cbranch_scc1 reca_b3132
  buffer_store_dwordx2 v[52:53], v9, s[4:7], s30 offen sc1
  buffer_store_dwordx2 v[32:33], v16, s[4:7], s26 offen sc1
  s_cmp_lg_u32 s14, 0
  s_cbranch_scc1 reca_b3132
  v_mov_b32 v28, s17
  s_lshl_b32 s34, s13, 7
  s_add_u32 s34, s34, 1507328
  buffer_store_dword v28, v19, s[4:7], s34 offen sc1
  s_branch reca_b3132
reca_last131:
  s_cmp_lg_u32 s12, 2
  s_cbranch_scc1 reca_exit1
  buffer_store_dwordx2 v[52:53], v9, s[4:7], s30 offen
  s_branch reca_exit1
reca_swave129:
  s_cmp_lg_u32 s17, 63
  s_cbranch_scc1 reca_vmst135
  s_barrier
  ds_read_b128 v[56:59], v1 offset:10240
  ds_read_b128 v[60:63], v1 offset:11264
  ds_read_b128 v[64:67], v1 offset:12288
  s_waitcnt lgkmcnt(0)
  v_add_f32 v56, v56, v64
  v_add_f32 v60, v60, v48
  v_add_f32 v57, v57, v65
  v_add_f32 v61, v61, v49
  v_add_f32 v58, v58, v66
  v_add_f32 v62, v62, v50
  v_add_f32 v59, v59, v67
  v_add_f32 v63, v63, v51
  v_cvt_pk_bf16_f32 v68, v56, v57
  v_cvt_pk_bf16_f32 v69, v58, v59
  v_cvt_pk_bf16_f32 v70, v60, v61
  v_cvt_pk_bf16_f32 v71, v62, v63
  buffer_store_dwordx2 v[52:53], v9, s[4:7], s30 offen
  buffer_store_dwordx2 v[68:69], v10, s[4:7], s31 offen
  buffer_store_dwordx2 v[70:71], v10, s[4:7], s31 offen offset:256
  s_branch reca_exit1
reca_vmst135:
  s_sleep 1
  buffer_load_dwordx4 v[208:211], v1, s[4:7], s21 offen offset:0 sc1
  buffer_load_dwordx4 v[212:215], v1, s[4:7], s21 offen offset:1024 sc1
  buffer_load_dwordx4 v[216:219], v1, s[4:7], s21 offen offset:2048 sc1
  buffer_load_dwordx4 v[220:223], v1, s[4:7], s21 offen offset:3072 sc1
  buffer_load_dwordx4 v[224:227], v2, s[4:7], s21 offen offset:0 sc1
  buffer_load_dwordx4 v[228:231], v2, s[4:7], s21 offen offset:1024 sc1
  s_waitcnt vmcnt(5)
  v_max_u32 v29, v208, v210
  v_cmp_eq_u32 vcc, -1, v29
  s_cbranch_vccnz reca_retry136
reca_resume137:
  s_waitcnt vmcnt(4)
  v_max_u32 v29, v212, v214
  v_cmp_eq_u32 vcc, -1, v29
  v_mfma_f32_16x16x32_bf16 v[76:79], a[120:123], v[208:211], 0
  v_mfma_f32_16x16x32_bf16 v[80:83], a[144:147], v[208:211], 0
  v_mfma_f32_16x16x32_bf16 v[72:75], v[208:211], v[208:211], v[40:43]
  s_cbranch_vccnz reca_retry138
reca_resume139:
  s_waitcnt vmcnt(3)
  v_max_u32 v29, v216, v218
  v_cmp_eq_u32 vcc, -1, v29
  v_mfma_f32_16x16x32_bf16 v[76:79], a[124:127], v[212:215], v[76:79]
  v_mfma_f32_16x16x32_bf16 v[80:83], a[148:151], v[212:215], v[80:83]
  v_mfma_f32_16x16x32_bf16 v[72:75], v[212:215], v[212:215], v[72:75]
  s_cbranch_vccnz reca_retry140
reca_resume141:
  s_waitcnt vmcnt(2)
  v_max_u32 v29, v220, v222
  v_cmp_eq_u32 vcc, -1, v29
  v_mfma_f32_16x16x32_bf16 v[76:79], a[128:131], v[216:219], v[76:79]
  v_mfma_f32_16x16x32_bf16 v[80:83], a[152:155], v[216:219], v[80:83]
  v_mfma_f32_16x16x32_bf16 v[72:75], v[216:219], v[216:219], v[72:75]
  s_cbranch_vccnz reca_retry142
reca_resume143:
  s_waitcnt vmcnt(1)
  v_max_u32 v29, v224, v226
  v_cmp_eq_u32 vcc, -1, v29
  v_mfma_f32_16x16x32_bf16 v[76:79], a[132:135], v[220:223], v[76:79]
  v_mfma_f32_16x16x32_bf16 v[80:83], a[156:159], v[220:223], v[80:83]
  v_mfma_f32_16x16x32_bf16 v[72:75], v[220:223], v[220:223], v[72:75]
  s_cbranch_vccnz reca_retry144
reca_resume145:
  s_waitcnt vmcnt(0)
  v_max_u32 v29, v228, v230
  v_cmp_eq_u32 vcc, -1, v29
  v_mfma_f32_16x16x32_bf16 v[76:79], a[136:139], v[224:227], v[76:79]
  v_mfma_f32_16x16x32_bf16 v[80:83], a[160:163], v[224:227], v[80:83]
  v_mfma_f32_16x16x32_bf16 v[72:75], v[224:227], v[224:227], v[72:75]
  s_cbranch_vccnz reca_retry146
reca_resume147:
  v_mfma_f32_16x16x32_bf16 v[76:79], a[140:143], v[228:231], v[76:79]
  v_mfma_f32_16x16x32_bf16 v[80:83], a[164:167], v[228:231], v[80:83]
  v_mfma_f32_16x16x32_bf16 v[72:75], v[228:231], v[228:231], v[72:75]
  s_barrier
  ds_read_b128 v[56:59], v1 offset:10240
  ds_read_b128 v[60:63], v1 offset:11264
  ds_read_b128 v[64:67], v1 offset:12288
  s_nop 1
  v_max3_f32 v28, v76, v77, v78
  v_max3_f32 v29, v80, v81, v82
  v_max3_f32 v28, v28, v79, v83
  v_max3_f32 v29, v29, v72, v73
  v_max3_f32 v28, v28, v74, v75
  v_max_f32 v28, v28, v29
  v_mov_b32 v29, v28
  s_nop 1
  v_permlane32_swap_b32 v28, v29
  v_max_f32 v28, v28, v29
  v_mov_b32 v29, v28
  s_nop 1
  v_permlane16_swap_b32 v28, v29
  v_max_f32 v28, v28, v29
  v_mul_f32 v28, s41, v28
  v_fma_f32 v76, v76, s41, -v28
  v_fma_f32 v77, v77, s41, -v28
  v_fma_f32 v78, v78, s41, -v28
  v_fma_f32 v79, v79, s41, -v28
  v_fma_f32 v80, v80, s41, -v28
  v_fma_f32 v81, v81, s41, -v28
  v_fma_f32 v82, v82, s41, -v28
  v_fma_f32 v83, v83, s41, -v28
  v_fma_f32 v72, v72, s41, -v28
  v_fma_f32 v73, v73, s41, -v28
  v_fma_f32 v74, v74, s41, -v28
  v_fma_f32 v75, v75, s41, -v28
  v_exp_f32 v76, v76
  v_exp_f32 v77, v77
  v_exp_f32 v78, v78
  v_exp_f32 v79, v79
  v_exp_f32 v80, v80
  v_exp_f32 v81, v81
  v_exp_f32 v82, v82
  v_exp_f32 v83, v83
  v_cvt_pk_bf16_f32 v84, v76, v77
  v_cvt_pk_bf16_f32 v85, v78, v79
  v_cvt_pk_bf16_f32 v86, v80, v81
  v_cvt_pk_bf16_f32 v87, v82, v83
  v_exp_f32 v72, v72
  v_exp_f32 v73, v73
  v_mfma_f32_16x16x32_bf16 v[100:103], v[36:39], v[84:87], 0
  v_exp_f32 v74, v74
  v_exp_f32 v75, v75
  v_mfma_f32_16x16x32_bf16 v[92:95], a[168:171], v[84:87], 0
  v_cvt_pk_bf16_f32 v88, v72, v73
  v_cvt_pk_bf16_f32 v89, v74, v75
  v_mfma_f32_16x16x32_bf16 v[96:99], a[172:175], v[84:87], 0
  s_waitcnt lgkmcnt(0)
  v_mfma_f32_16x16x16_bf16 v[100:103], v[36:37], v[88:89], v[100:103]
  v_add_f32 v56, v56, v64
  v_add_f32 v60, v60, v48
  v_add_f32 v57, v57, v65
  v_add_f32 v61, v61, v49
  v_add_f32 v58, v58, v66
  v_add_f32 v62, v62, v50
  v_add_f32 v59, v59, v67
  v_add_f32 v63, v63, v51
  v_cvt_pk_bf16_f32 v68, v56, v57
  v_cvt_pk_bf16_f32 v69, v58, v59
  v_cvt_pk_bf16_f32 v70, v60, v61
  v_cvt_pk_bf16_f32 v71, v62, v63
  v_mfma_f32_16x16x16_bf16 v[92:95], v[68:69], v[88:89], v[92:95]
  v_rcp_f32 v28, v100
  v_mfma_f32_16x16x16_bf16 v[96:99], v[70:71], v[88:89], v[96:99]
  v_mov_b32 v29, v28
  s_nop 4
  v_pk_mul_f32 v[92:93], v[92:93], v[28:29]
  v_pk_mul_f32 v[94:95], v[94:95], v[28:29]
  v_pk_mul_f32 v[96:97], v[96:97], v[28:29]
  v_pk_mul_f32 v[98:99], v[98:99], v[28:29]
  v_cvt_pk_bf16_f32 v104, v92, v93
  v_cvt_pk_bf16_f32 v105, v94, v95
  v_cvt_pk_bf16_f32 v106, v96, v97
  v_cvt_pk_bf16_f32 v107, v98, v99
  buffer_store_dwordx4 v[104:107], v11, s[4:7], s22 offen sc1
reca_b3132:
  s_barrier
  s_cmp_ge_u32 s12, 2
  s_cbranch_scc1 reca_notg2148
  s_sleep 3
  buffer_load_dwordx4 v[128:131], v12, s[4:7], s22 offen offset:0 sc1
  buffer_load_dwordx4 v[132:135], v12, s[4:7], s22 offen offset:1024 sc1
  buffer_load_dwordx4 v[136:139], v12, s[4:7], s22 offen offset:2048 sc1
  buffer_load_dwordx4 v[140:143], v12, s[4:7], s22 offen offset:3072 sc1
  buffer_load_dwordx4 v[144:147], v13, s[4:7], s22 offen offset:0 sc1
  buffer_load_dwordx4 v[148:151], v13, s[4:7], s22 offen offset:1024 sc1
  buffer_load_dwordx4 v[152:155], v13, s[4:7], s22 offen offset:2048 sc1
  buffer_load_dwordx4 v[156:159], v13, s[4:7], s22 offen offset:3072 sc1
  buffer_load_dwordx4 v[160:163], v14, s[4:7], s22 offen offset:0 sc1
  buffer_load_dwordx4 v[164:167], v14, s[4:7], s22 offen offset:1024 sc1
  buffer_load_dwordx4 v[168:171], v14, s[4:7], s22 offen offset:2048 sc1
  buffer_load_dwordx4 v[172:175], v14, s[4:7], s22 offen offset:3072 sc1
  s_waitcnt vmcnt(11)
  v_cmp_eq_u32 vcc, -1, v128
  s_cbranch_vccnz reca_retry149
reca_resume150:
  s_waitcnt vmcnt(10)
  v_cmp_eq_u32 vcc, -1, v132
  v_mfma_f32_16x16x32_bf16 v[108:111], a[120:123], v[128:131], 0
  v_mfma_f32_16x16x32_bf16 v[112:115], a[124:127], v[128:131], 0
  s_cbranch_vccnz reca_retry151
reca_resume152:
  s_waitcnt vmcnt(9)
  v_cmp_eq_u32 vcc, -1, v136
  v_mfma_f32_16x16x32_bf16 v[108:111], a[128:131], v[132:135], v[108:111]
  v_mfma_f32_16x16x32_bf16 v[112:115], a[132:135], v[132:135], v[112:115]
  s_cbranch_vccnz reca_retry153
reca_resume154:
  s_waitcnt vmcnt(8)
  v_cmp_eq_u32 vcc, -1, v140
  v_mfma_f32_16x16x32_bf16 v[108:111], a[136:139], v[136:139], v[108:111]
  v_mfma_f32_16x16x32_bf16 v[112:115], a[140:143], v[136:139], v[112:115]
  s_cbranch_vccnz reca_retry155
reca_resume156:
  s_waitcnt vmcnt(7)
  v_cmp_eq_u32 vcc, -1, v144
  v_mfma_f32_16x16x32_bf16 v[108:111], a[144:147], v[140:143], v[108:111]
  v_mfma_f32_16x16x32_bf16 v[112:115], a[148:151], v[140:143], v[112:115]
  s_cbranch_vccnz reca_retry157
reca_resume158:
  s_waitcnt vmcnt(6)
  v_cmp_eq_u32 vcc, -1, v148
  v_mfma_f32_16x16x32_bf16 v[108:111], a[152:155], v[144:147], v[108:111]
  v_mfma_f32_16x16x32_bf16 v[112:115], a[156:159], v[144:147], v[112:115]
  s_cbranch_vccnz reca_retry159
reca_resume160:
  s_waitcnt vmcnt(5)
  v_cmp_eq_u32 vcc, -1, v152
  v_mfma_f32_16x16x32_bf16 v[108:111], a[160:163], v[148:151], v[108:111]
  v_mfma_f32_16x16x32_bf16 v[112:115], a[164:167], v[148:151], v[112:115]
  s_cbranch_vccnz reca_retry161
reca_resume162:
  s_waitcnt vmcnt(4)
  v_cmp_eq_u32 vcc, -1, v156
  v_mfma_f32_16x16x32_bf16 v[108:111], a[168:171], v[152:155], v[108:111]
  v_mfma_f32_16x16x32_bf16 v[112:115], a[172:175], v[152:155], v[112:115]
  s_cbranch_vccnz reca_retry163
reca_resume164:
  s_waitcnt vmcnt(3)
  v_cmp_eq_u32 vcc, -1, v160
  v_mfma_f32_16x16x32_bf16 v[108:111], a[176:179], v[156:159], v[108:111]
  v_mfma_f32_16x16x32_bf16 v[112:115], a[180:183], v[156:159], v[112:115]
  s_cbranch_vccnz reca_retry165
reca_resume166:
  s_waitcnt vmcnt(2)
  v_cmp_eq_u32 vcc, -1, v164
  v_mfma_f32_16x16x32_bf16 v[108:111], a[184:187], v[160:163], v[108:111]
  v_mfma_f32_16x16x32_bf16 v[112:115], a[188:191], v[160:163], v[112:115]
  s_cbranch_vccnz reca_retry167
reca_resume168:
  s_waitcnt vmcnt(1)
  v_cmp_eq_u32 vcc, -1, v168
  v_mfma_f32_16x16x32_bf16 v[108:111], a[192:195], v[164:167], v[108:111]
  v_mfma_f32_16x16x32_bf16 v[112:115], a[196:199], v[164:167], v[112:115]
  s_cbranch_vccnz reca_retry169
reca_resume170:
  s_waitcnt vmcnt(0)
  v_cmp_eq_u32 vcc, -1, v172
  v_mfma_f32_16x16x32_bf16 v[108:111], a[200:203], v[168:171], v[108:111]
  v_mfma_f32_16x16x32_bf16 v[112:115], a[204:207], v[168:171], v[112:115]
  s_cbranch_vccnz reca_retry171
reca_resume172:
  v_mfma_f32_16x16x32_bf16 v[108:111], a[208:211], v[172:175], v[108:111]
  v_mfma_f32_16x16x32_bf16 v[112:115], a[212:215], v[172:175], v[112:115]
  s_nop 7
  v_add_f32_dpp v116, v112, v108 row_ror:8 row_mask:0xf bank_mask:0xf
  v_add_f32_dpp v117, v113, v109 row_ror:8 row_mask:0xf bank_mask:0xf
  v_add_f32_dpp v118, v114, v110 row_ror:8 row_mask:0xf bank_mask:0xf
  v_add_f32_dpp v119, v115, v111 row_ror:8 row_mask:0xf bank_mask:0xf
  buffer_store_dwordx4 v[116:119], v15, s[4:7], s25 offen sc1
  buffer_store_dwordx4 v[116:119], v232, s[4:7], s25 offen sc1
  buffer_store_dwordx4 v[32:35], v15, s[4:7], s29 offen sc1
  buffer_store_dwordx4 v[32:35], v232, s[4:7], s29 offen sc1
  s_branch reca_b4133
reca_notg2148:
  s_cmp_lg_u32 s12, 3
  s_cbranch_scc1 reca_b4133
  s_add_u32 s34, s17, 2
  s_and_b32 s34, s34, 3
  s_mul_i32 s26, s34, 10240
  s_add_u32 s26, s26, s38
  s_mul_i32 s27, s34, 6144
  s_add_u32 s27, s27, s39
  s_mul_i32 s28, s34, 12288
  s_add_u32 s28, s28, s40
  s_mul_i32 s29, s34, 393216
  s_add_u32 s29, s29, s56
  buffer_store_dwordx2 v[32:33], v8, s[4:7], s27 offen sc1
  buffer_store_dwordx4 v[32:35], v11, s[4:7], s28 offen sc1
reca_b4133:
  s_barrier
  s_cmp_lg_u32 s12, 2
  s_cbranch_scc1 reca_not2173
  s_sleep 8
  buffer_load_dwordx4 v[128:131], v20, s[4:7], s25 offen sc1
  buffer_load_dwordx4 v[132:135], v21, s[4:7], s25 offen sc1
  buffer_load_dwordx4 v[136:139], v22, s[4:7], s25 offen sc1
  buffer_load_dwordx4 v[140:143], v23, s[4:7], s25 offen sc1
  buffer_load_dwordx4 v[144:147], v24, s[4:7], s25 offen sc1
  buffer_load_dwordx4 v[148:151], v25, s[4:7], s25 offen sc1
  buffer_load_dwordx4 v[152:155], v26, s[4:7], s25 offen sc1
  buffer_load_dwordx4 v[156:159], v27, s[4:7], s25 offen sc1
  s_waitcnt vmcnt(7)
  v_cmp_eq_u32 vcc, -1, v128
  s_cbranch_vccnz reca_retry174
reca_resume175:
  s_waitcnt vmcnt(6)
  v_cmp_eq_u32 vcc, -1, v132
  s_cbranch_vccnz reca_retry176
reca_resume177:
  s_waitcnt vmcnt(5)
  v_cmp_eq_u32 vcc, -1, v136
  v_pk_add_f32 v[116:117], v[128:129], v[132:133]
  v_pk_add_f32 v[118:119], v[130:131], v[134:135]
  s_cbranch_vccnz reca_retry178
reca_resume179:
  s_waitcnt vmcnt(4)
  v_cmp_eq_u32 vcc, -1, v140
  v_pk_add_f32 v[116:117], v[116:117], v[136:137]
  v_pk_add_f32 v[118:119], v[118:119], v[138:139]
  s_cbranch_vccnz reca_retry180
reca_resume181:
  s_waitcnt vmcnt(3)
  v_cmp_eq_u32 vcc, -1, v144
  v_pk_add_f32 v[116:117], v[116:117], v[140:141]
  v_pk_add_f32 v[118:119], v[118:119], v[142:143]
  s_cbranch_vccnz reca_retry182
reca_resume183:
  s_waitcnt vmcnt(2)
  v_cmp_eq_u32 vcc, -1, v148
  v_pk_add_f32 v[116:117], v[116:117], v[144:145]
  v_pk_add_f32 v[118:119], v[118:119], v[146:147]
  s_cbranch_vccnz reca_retry184
reca_resume185:
  s_waitcnt vmcnt(1)
  v_cmp_eq_u32 vcc, -1, v152
  v_pk_add_f32 v[116:117], v[116:117], v[148:149]
  v_pk_add_f32 v[118:119], v[118:119], v[150:151]
  s_cbranch_vccnz reca_retry186
reca_resume187:
  s_waitcnt vmcnt(0)
  v_cmp_eq_u32 vcc, -1, v156
  v_pk_add_f32 v[116:117], v[116:117], v[152:153]
  v_pk_add_f32 v[118:119], v[118:119], v[154:155]
  s_cbranch_vccnz reca_retry188
reca_resume189:
  v_pk_add_f32 v[116:117], v[116:117], v[156:157]
  v_pk_add_f32 v[118:119], v[118:119], v[158:159]
  v_cvt_pk_bf16_f32 v132, v116, v117
  v_cvt_pk_bf16_f32 v133, v118, v119
  buffer_store_dwordx2 v[132:133], v16, s[4:7], s24 offen sc1
  s_branch reca_b5134
reca_not2173:
  s_cmp_lg_u32 s12, 3
  s_cbranch_scc1 reca_b5134
  s_add_u32 s36, s17, 1
  s_cmp_ge_u32 s36, 63
  s_cbranch_scc1 reca_nopf190
  s_add_u32 s37, s36, 1
reca_pf191:
  buffer_load_dword v28, v233, s[4:7], 0 offen sc1
  s_waitcnt vmcnt(0)
  v_cmp_gt_i32 vcc, s37, v28
  s_cbranch_vccz reca_pfok192
  s_sleep 1
  s_sub_u32 s18, s18, 1
  s_cbranch_scc0 reca_pf191
  s_mov_b32 s18, 0
reca_pfok192:
  s_lshl_b32 s34, s15, 4
  s_and_b32 s35, s36, 15
  s_add_u32 s34, s34, s35
  s_mul_i32 s34, s34, 12288
  s_add_u32 s32, s34, 37748736
  s_lshl_b32 s35, s16, 11
  s_add_u32 s34, s34, s35
  s_add_u32 s33, s34, 44040192
  buffer_load_dwordx4 a[120:123], v1, s[4:7], s32 offen offset:0 sc1
  buffer_load_dwordx4 a[124:127], v1, s[4:7], s32 offen offset:1024 sc1
  buffer_load_dwordx4 a[128:131], v1, s[4:7], s32 offen offset:2048 sc1
  buffer_load_dwordx4 a[132:135], v1, s[4:7], s32 offen offset:3072 sc1
  buffer_load_dwordx4 a[136:139], v2, s[4:7], s32 offen offset:0 sc1
  buffer_load_dwordx4 a[140:143], v2, s[4:7], s32 offen offset:1024 sc1
  buffer_load_dwordx4 a[144:147], v2, s[4:7], s32 offen offset:2048 sc1
  buffer_load_dwordx4 a[148:151], v2, s[4:7], s32 offen offset:3072 sc1
  buffer_load_dwordx4 a[152:155], v3, s[4:7], s32 offen offset:0 sc1
  buffer_load_dwordx4 a[156:159], v3, s[4:7], s32 offen offset:1024 sc1
  buffer_load_dwordx4 a[160:163], v3, s[4:7], s32 offen offset:2048 sc1
  buffer_load_dwordx4 a[164:167], v3, s[4:7], s32 offen offset:3072 sc1
  buffer_load_dwordx4 a[168:171], v1, s[4:7], s33 offen offset:0 sc1
  buffer_load_dwordx4 a[172:175], v1, s[4:7], s33 offen offset:1024 sc1
reca_nopf190:
  buffer_store_dwordx2 v[52:53], v9, s[4:7], s30 offen sc1
  buffer_store_dwordx2 v[68:69], v10, s[4:7], s31 offen sc1
  buffer_store_dwordx2 v[70:71], v10, s[4:7], s31 offen offset:256 sc1
reca_b5134:
  s_barrier
  s_add_u32 s17, s17, 1
  s_branch reca_step120
reca_retry123:
  s_sub_u32 s18, s18, 1
  s_cbranch_scc1 reca_retry123_to
  buffer_load_dwordx4 v[128:131], v4, s[4:7], s20 offen sc1
  buffer_load_dwordx4 v[132:135], v4, s[4:7], s20 offen offset:1024 sc1
  buffer_load_dwordx4 v[136:139], v5, s[4:7], s20 offen sc1
  s_waitcnt vmcnt(2)
  v_max_u32 v29, v128, v130
  v_cmp_eq_u32 vcc, -1, v29
  s_cbranch_vccnz reca_retry123
  s_branch reca_resume124
reca_retry123_to:
  s_mov_b32 s18, 0
  s_waitcnt vmcnt(0)
  s_branch reca_resume124
reca_retry125:
  s_sub_u32 s18, s18, 1
  s_cbranch_scc1 reca_retry125_to
  buffer_load_dwordx4 v[132:135], v4, s[4:7], s20 offen offset:1024 sc1
  buffer_load_dwordx4 v[136:139], v5, s[4:7], s20 offen sc1
  s_waitcnt vmcnt(1)
  v_max_u32 v29, v132, v134
  v_cmp_eq_u32 vcc, -1, v29
  s_cbranch_vccnz reca_retry125
  s_branch reca_resume126
reca_retry125_to:
  s_mov_b32 s18, 0
  s_waitcnt vmcnt(0)
  s_branch reca_resume126
reca_retry127:
  s_sub_u32 s18, s18, 1
  s_cbranch_scc1 reca_retry127_to
  buffer_load_dwordx4 v[136:139], v5, s[4:7], s20 offen sc1
  s_waitcnt vmcnt(0)
  v_max_u32 v29, v136, v138
  v_cmp_eq_u32 vcc, -1, v29
  s_cbranch_vccnz reca_retry127
  s_branch reca_resume128
reca_retry127_to:
  s_mov_b32 s18, 0
  s_waitcnt vmcnt(0)
  s_branch reca_resume128
reca_retry136:
  s_sub_u32 s18, s18, 1
  s_cbranch_scc1 reca_retry136_to
  buffer_load_dwordx4 v[208:211], v1, s[4:7], s21 offen offset:0 sc1
  buffer_load_dwordx4 v[212:215], v1, s[4:7], s21 offen offset:1024 sc1
  buffer_load_dwordx4 v[216:219], v1, s[4:7], s21 offen offset:2048 sc1
  buffer_load_dwordx4 v[220:223], v1, s[4:7], s21 offen offset:3072 sc1
  buffer_load_dwordx4 v[224:227], v2, s[4:7], s21 offen offset:0 sc1
  buffer_load_dwordx4 v[228:231], v2, s[4:7], s21 offen offset:1024 sc1
  s_waitcnt vmcnt(5)
  v_max_u32 v29, v208, v210
  v_cmp_eq_u32 vcc, -1, v29
  s_cbranch_vccnz reca_retry136
  s_branch reca_resume137
reca_retry136_to:
  s_mov_b32 s18, 0
  s_waitcnt vmcnt(0)
  s_branch reca_resume137
reca_retry138:
  s_sub_u32 s18, s18, 1
  s_cbranch_scc1 reca_retry138_to
  buffer_load_dwordx4 v[212:215], v1, s[4:7], s21 offen offset:1024 sc1
  buffer_load_dwordx4 v[216:219], v1, s[4:7], s21 offen offset:2048 sc1
  buffer_load_dwordx4 v[220:223], v1, s[4:7], s21 offen offset:3072 sc1
  buffer_load_dwordx4 v[224:227], v2, s[4:7], s21 offen offset:0 sc1
  buffer_load_dwordx4 v[228:231], v2, s[4:7], s21 offen offset:1024 sc1
  s_waitcnt vmcnt(4)
  v_max_u32 v29, v212, v214
  v_cmp_eq_u32 vcc, -1, v29
  s_cbranch_vccnz reca_retry138
  s_branch reca_resume139
reca_retry138_to:
  s_mov_b32 s18, 0
  s_waitcnt vmcnt(0)
  s_branch reca_resume139
reca_retry140:
  s_sub_u32 s18, s18, 1
  s_cbranch_scc1 reca_retry140_to
  buffer_load_dwordx4 v[216:219], v1, s[4:7], s21 offen offset:2048 sc1
  buffer_load_dwordx4 v[220:223], v1, s[4:7], s21 offen offset:3072 sc1
  buffer_load_dwordx4 v[224:227], v2, s[4:7], s21 offen offset:0 sc1
  buffer_load_dwordx4 v[228:231], v2, s[4:7], s21 offen offset:1024 sc1
  s_waitcnt vmcnt(3)
  v_max_u32 v29, v216, v218
  v_cmp_eq_u32 vcc, -1, v29
  s_cbranch_vccnz reca_retry140
  s_branch reca_resume141
reca_retry140_to:
  s_mov_b32 s18, 0
  s_waitcnt vmcnt(0)
  s_branch reca_resume141
reca_retry142:
  s_sub_u32 s18, s18, 1
  s_cbranch_scc1 reca_retry142_to
  buffer_load_dwordx4 v[220:223], v1, s[4:7], s21 offen offset:3072 sc1
  buffer_load_dwordx4 v[224:227], v2, s[4:7], s21 offen offset:0 sc1
  buffer_load_dwordx4 v[228:231], v2, s[4:7], s21 offen offset:1024 sc1
  s_waitcnt vmcnt(2)
  v_max_u32 v29, v220, v222
  v_cmp_eq_u32 vcc, -1, v29
  s_cbranch_vccnz reca_retry142
  s_branch reca_resume143
reca_retry142_to:
  s_mov_b32 s18, 0
  s_waitcnt vmcnt(0)
  s_branch reca_resume143
reca_retry144:
  s_sub_u32 s18, s18, 1
  s_cbranch_scc1 reca_retry144_to
  buffer_load_dwordx4 v[224:227], v2, s[4:7], s21 offen offset:0 sc1
  buffer_load_dwordx4 v[228:231], v2, s[4:7], s21 offen offset:1024 sc1
  s_waitcnt vmcnt(1)
  v_max_u32 v29, v224, v226
  v_cmp_eq_u32 vcc, -1, v29
  s_cbranch_vccnz reca_retry144
  s_branch reca_resume145
reca_retry144_to:
  s_mov_b32 s18, 0
  s_waitcnt vmcnt(0)
  s_branch reca_resume145
reca_retry146:
  s_sub_u32 s18, s18, 1
  s_cbranch_scc1 reca_retry146_to
  buffer_load_dwordx4 v[228:231], v2, s[4:7], s21 offen offset:1024 sc1
  s_waitcnt vmcnt(0)
  v_max_u32 v29, v228, v230
  v_cmp_eq_u32 vcc, -1, v29
  s_cbranch_vccnz reca_retry146
  s_branch reca_resume147
reca_retry146_to:
  s_mov_b32 s18, 0
  s_waitcnt vmcnt(0)
  s_branch reca_resume147
reca_retry149:
  s_sub_u32 s18, s18, 1
  s_cbranch_scc1 reca_retry149_to
  buffer_load_dwordx4 v[128:131], v12, s[4:7], s22 offen offset:0 sc1
  buffer_load_dwordx4 v[132:135], v12, s[4:7], s22 offen offset:1024 sc1
  buffer_load_dwordx4 v[136:139], v12, s[4:7], s22 offen offset:2048 sc1
  buffer_load_dwordx4 v[140:143], v12, s[4:7], s22 offen offset:3072 sc1
  buffer_load_dwordx4 v[144:147], v13, s[4:7], s22 offen offset:0 sc1
  buffer_load_dwordx4 v[148:151], v13, s[4:7], s22 offen offset:1024 sc1
  buffer_load_dwordx4 v[152:155], v13, s[4:7], s22 offen offset:2048 sc1
  buffer_load_dwordx4 v[156:159], v13, s[4:7], s22 offen offset:3072 sc1
  buffer_load_dwordx4 v[160:163], v14, s[4:7], s22 offen offset:0 sc1
  buffer_load_dwordx4 v[164:167], v14, s[4:7], s22 offen offset:1024 sc1
  buffer_load_dwordx4 v[168:171], v14, s[4:7], s22 offen offset:2048 sc1
  buffer_load_dwordx4 v[172:175], v14, s[4:7], s22 offen offset:3072 sc1
  s_waitcnt vmcnt(11)
  v_cmp_eq_u32 vcc, -1, v128
  s_cbranch_vccnz reca_retry149
  s_branch reca_resume150
reca_retry149_to:
  s_mov_b32 s18, 0
  s_waitcnt vmcnt(0)
  s_branch reca_resume150
reca_retry151:
  s_sub_u32 s18, s18, 1
  s_cbranch_scc1 reca_retry151_to
  buffer_load_dwordx4 v[132:135], v12, s[4:7], s22 offen offset:1024 sc1
  buffer_load_dwordx4 v[136:139], v12, s[4:7], s22 offen offset:2048 sc1
  buffer_load_dwordx4 v[140:143], v12, s[4:7], s22 offen offset:3072 sc1
  buffer_load_dwordx4 v[144:147], v13, s[4:7], s22 offen offset:0 sc1
  buffer_load_dwordx4 v[148:151], v13, s[4:7], s22 offen offset:1024 sc1
  buffer_load_dwordx4 v[152:155], v13, s[4:7], s22 offen offset:2048 sc1
  buffer_load_dwordx4 v[156:159], v13, s[4:7], s22 offen offset:3072 sc1
  buffer_load_dwordx4 v[160:163], v14, s[4:7], s22 offen offset:0 sc1
  buffer_load_dwordx4 v[164:167], v14, s[4:7], s22 offen offset:1024 sc1
  buffer_load_dwordx4 v[168:171], v14, s[4:7], s22 offen offset:2048 sc1
  buffer_load_dwordx4 v[172:175], v14, s[4:7], s22 offen offset:3072 sc1
  s_waitcnt vmcnt(10)
  v_cmp_eq_u32 vcc, -1, v132
  s_cbranch_vccnz reca_retry151
  s_branch reca_resume152
reca_retry151_to:
  s_mov_b32 s18, 0
  s_waitcnt vmcnt(0)
  s_branch reca_resume152
reca_retry153:
  s_sub_u32 s18, s18, 1
  s_cbranch_scc1 reca_retry153_to
  buffer_load_dwordx4 v[136:139], v12, s[4:7], s22 offen offset:2048 sc1
  buffer_load_dwordx4 v[140:143], v12, s[4:7], s22 offen offset:3072 sc1
  buffer_load_dwordx4 v[144:147], v13, s[4:7], s22 offen offset:0 sc1
  buffer_load_dwordx4 v[148:151], v13, s[4:7], s22 offen offset:1024 sc1
  buffer_load_dwordx4 v[152:155], v13, s[4:7], s22 offen offset:2048 sc1
  buffer_load_dwordx4 v[156:159], v13, s[4:7], s22 offen offset:3072 sc1
  buffer_load_dwordx4 v[160:163], v14, s[4:7], s22 offen offset:0 sc1
  buffer_load_dwordx4 v[164:167], v14, s[4:7], s22 offen offset:1024 sc1
  buffer_load_dwordx4 v[168:171], v14, s[4:7], s22 offen offset:2048 sc1
  buffer_load_dwordx4 v[172:175], v14, s[4:7], s22 offen offset:3072 sc1
  s_waitcnt vmcnt(9)
  v_cmp_eq_u32 vcc, -1, v136
  s_cbranch_vccnz reca_retry153
  s_branch reca_resume154
reca_retry153_to:
  s_mov_b32 s18, 0
  s_waitcnt vmcnt(0)
  s_branch reca_resume154
reca_retry155:
  s_sub_u32 s18, s18, 1
  s_cbranch_scc1 reca_retry155_to
  buffer_load_dwordx4 v[140:143], v12, s[4:7], s22 offen offset:3072 sc1
  buffer_load_dwordx4 v[144:147], v13, s[4:7], s22 offen offset:0 sc1
  buffer_load_dwordx4 v[148:151], v13, s[4:7], s22 offen offset:1024 sc1
  buffer_load_dwordx4 v[152:155], v13, s[4:7], s22 offen offset:2048 sc1
  buffer_load_dwordx4 v[156:159], v13, s[4:7], s22 offen offset:3072 sc1
  buffer_load_dwordx4 v[160:163], v14, s[4:7], s22 offen offset:0 sc1
  buffer_load_dwordx4 v[164:167], v14, s[4:7], s22 offen offset:1024 sc1
  buffer_load_dwordx4 v[168:171], v14, s[4:7], s22 offen offset:2048 sc1
  buffer_load_dwordx4 v[172:175], v14, s[4:7], s22 offen offset:3072 sc1
  s_waitcnt vmcnt(8)
  v_cmp_eq_u32 vcc, -1, v140
  s_cbranch_vccnz reca_retry155
  s_branch reca_resume156
reca_retry155_to:
  s_mov_b32 s18, 0
  s_waitcnt vmcnt(0)
  s_branch reca_resume156
reca_retry157:
  s_sub_u32 s18, s18, 1
  s_cbranch_scc1 reca_retry157_to
  buffer_load_dwordx4 v[144:147], v13, s[4:7], s22 offen offset:0 sc1
  buffer_load_dwordx4 v[148:151], v13, s[4:7], s22 offen offset:1024 sc1
  buffer_load_dwordx4 v[152:155], v13, s[4:7], s22 offen offset:2048 sc1
  buffer_load_dwordx4 v[156:159], v13, s[4:7], s22 offen offset:3072 sc1
  buffer_load_dwordx4 v[160:163], v14, s[4:7], s22 offen offset:0 sc1
  buffer_load_dwordx4 v[164:167], v14, s[4:7], s22 offen offset:1024 sc1
  buffer_load_dwordx4 v[168:171], v14, s[4:7], s22 offen offset:2048 sc1
  buffer_load_dwordx4 v[172:175], v14, s[4:7], s22 offen offset:3072 sc1
  s_waitcnt vmcnt(7)
  v_cmp_eq_u32 vcc, -1, v144
  s_cbranch_vccnz reca_retry157
  s_branch reca_resume158
reca_retry157_to:
  s_mov_b32 s18, 0
  s_waitcnt vmcnt(0)
  s_branch reca_resume158
reca_retry159:
  s_sub_u32 s18, s18, 1
  s_cbranch_scc1 reca_retry159_to
  buffer_load_dwordx4 v[148:151], v13, s[4:7], s22 offen offset:1024 sc1
  buffer_load_dwordx4 v[152:155], v13, s[4:7], s22 offen offset:2048 sc1
  buffer_load_dwordx4 v[156:159], v13, s[4:7], s22 offen offset:3072 sc1
  buffer_load_dwordx4 v[160:163], v14, s[4:7], s22 offen offset:0 sc1
  buffer_load_dwordx4 v[164:167], v14, s[4:7], s22 offen offset:1024 sc1
  buffer_load_dwordx4 v[168:171], v14, s[4:7], s22 offen offset:2048 sc1
  buffer_load_dwordx4 v[172:175], v14, s[4:7], s22 offen offset:3072 sc1
  s_waitcnt vmcnt(6)
  v_cmp_eq_u32 vcc, -1, v148
  s_cbranch_vccnz reca_retry159
  s_branch reca_resume160
reca_retry159_to:
  s_mov_b32 s18, 0
  s_waitcnt vmcnt(0)
  s_branch reca_resume160
reca_retry161:
  s_sub_u32 s18, s18, 1
  s_cbranch_scc1 reca_retry161_to
  buffer_load_dwordx4 v[152:155], v13, s[4:7], s22 offen offset:2048 sc1
  buffer_load_dwordx4 v[156:159], v13, s[4:7], s22 offen offset:3072 sc1
  buffer_load_dwordx4 v[160:163], v14, s[4:7], s22 offen offset:0 sc1
  buffer_load_dwordx4 v[164:167], v14, s[4:7], s22 offen offset:1024 sc1
  buffer_load_dwordx4 v[168:171], v14, s[4:7], s22 offen offset:2048 sc1
  buffer_load_dwordx4 v[172:175], v14, s[4:7], s22 offen offset:3072 sc1
  s_waitcnt vmcnt(5)
  v_cmp_eq_u32 vcc, -1, v152
  s_cbranch_vccnz reca_retry161
  s_branch reca_resume162
reca_retry161_to:
  s_mov_b32 s18, 0
  s_waitcnt vmcnt(0)
  s_branch reca_resume162
reca_retry163:
  s_sub_u32 s18, s18, 1
  s_cbranch_scc1 reca_retry163_to
  buffer_load_dwordx4 v[156:159], v13, s[4:7], s22 offen offset:3072 sc1
  buffer_load_dwordx4 v[160:163], v14, s[4:7], s22 offen offset:0 sc1
  buffer_load_dwordx4 v[164:167], v14, s[4:7], s22 offen offset:1024 sc1
  buffer_load_dwordx4 v[168:171], v14, s[4:7], s22 offen offset:2048 sc1
  buffer_load_dwordx4 v[172:175], v14, s[4:7], s22 offen offset:3072 sc1
  s_waitcnt vmcnt(4)
  v_cmp_eq_u32 vcc, -1, v156
  s_cbranch_vccnz reca_retry163
  s_branch reca_resume164
reca_retry163_to:
  s_mov_b32 s18, 0
  s_waitcnt vmcnt(0)
  s_branch reca_resume164
reca_retry165:
  s_sub_u32 s18, s18, 1
  s_cbranch_scc1 reca_retry165_to
  buffer_load_dwordx4 v[160:163], v14, s[4:7], s22 offen offset:0 sc1
  buffer_load_dwordx4 v[164:167], v14, s[4:7], s22 offen offset:1024 sc1
  buffer_load_dwordx4 v[168:171], v14, s[4:7], s22 offen offset:2048 sc1
  buffer_load_dwordx4 v[172:175], v14, s[4:7], s22 offen offset:3072 sc1
  s_waitcnt vmcnt(3)
  v_cmp_eq_u32 vcc, -1, v160
  s_cbranch_vccnz reca_retry165
  s_branch reca_resume166
reca_retry165_to:
  s_mov_b32 s18, 0
  s_waitcnt vmcnt(0)
  s_branch reca_resume166
reca_retry167:
  s_sub_u32 s18, s18, 1
  s_cbranch_scc1 reca_retry167_to
  buffer_load_dwordx4 v[164:167], v14, s[4:7], s22 offen offset:1024 sc1
  buffer_load_dwordx4 v[168:171], v14, s[4:7], s22 offen offset:2048 sc1
  buffer_load_dwordx4 v[172:175], v14, s[4:7], s22 offen offset:3072 sc1
  s_waitcnt vmcnt(2)
  v_cmp_eq_u32 vcc, -1, v164
  s_cbranch_vccnz reca_retry167
  s_branch reca_resume168
reca_retry167_to:
  s_mov_b32 s18, 0
  s_waitcnt vmcnt(0)
  s_branch reca_resume168
reca_retry169:
  s_sub_u32 s18, s18, 1
  s_cbranch_scc1 reca_retry169_to
  buffer_load_dwordx4 v[168:171], v14, s[4:7], s22 offen offset:2048 sc1
  buffer_load_dwordx4 v[172:175], v14, s[4:7], s22 offen offset:3072 sc1
  s_waitcnt vmcnt(1)
  v_cmp_eq_u32 vcc, -1, v168
  s_cbranch_vccnz reca_retry169
  s_branch reca_resume170
reca_retry169_to:
  s_mov_b32 s18, 0
  s_waitcnt vmcnt(0)
  s_branch reca_resume170
reca_retry171:
  s_sub_u32 s18, s18, 1
  s_cbranch_scc1 reca_retry171_to
  buffer_load_dwordx4 v[172:175], v14, s[4:7], s22 offen offset:3072 sc1
  s_waitcnt vmcnt(0)
  v_cmp_eq_u32 vcc, -1, v172
  s_cbranch_vccnz reca_retry171
  s_branch reca_resume172
reca_retry171_to:
  s_mov_b32 s18, 0
  s_waitcnt vmcnt(0)
  s_branch reca_resume172
reca_retry174:
  s_sub_u32 s18, s18, 1
  s_cbranch_scc1 reca_retry174_to
  buffer_load_dwordx4 v[128:131], v20, s[4:7], s25 offen sc1
  buffer_load_dwordx4 v[132:135], v21, s[4:7], s25 offen sc1
  buffer_load_dwordx4 v[136:139], v22, s[4:7], s25 offen sc1
  buffer_load_dwordx4 v[140:143], v23, s[4:7], s25 offen sc1
  buffer_load_dwordx4 v[144:147], v24, s[4:7], s25 offen sc1
  buffer_load_dwordx4 v[148:151], v25, s[4:7], s25 offen sc1
  buffer_load_dwordx4 v[152:155], v26, s[4:7], s25 offen sc1
  buffer_load_dwordx4 v[156:159], v27, s[4:7], s25 offen sc1
  s_waitcnt vmcnt(7)
  v_cmp_eq_u32 vcc, -1, v128
  s_cbranch_vccnz reca_retry174
  s_branch reca_resume175
reca_retry174_to:
  s_mov_b32 s18, 0
  s_waitcnt vmcnt(0)
  s_branch reca_resume175
reca_retry176:
  s_sub_u32 s18, s18, 1
  s_cbranch_scc1 reca_retry176_to
  buffer_load_dwordx4 v[132:135], v21, s[4:7], s25 offen sc1
  buffer_load_dwordx4 v[136:139], v22, s[4:7], s25 offen sc1
  buffer_load_dwordx4 v[140:143], v23, s[4:7], s25 offen sc1
  buffer_load_dwordx4 v[144:147], v24, s[4:7], s25 offen sc1
  buffer_load_dwordx4 v[148:151], v25, s[4:7], s25 offen sc1
  buffer_load_dwordx4 v[152:155], v26, s[4:7], s25 offen sc1
  buffer_load_dwordx4 v[156:159], v27, s[4:7], s25 offen sc1
  s_waitcnt vmcnt(6)
  v_cmp_eq_u32 vcc, -1, v132
  s_cbranch_vccnz reca_retry176
  s_branch reca_resume177
reca_retry176_to:
  s_mov_b32 s18, 0
  s_waitcnt vmcnt(0)
  s_branch reca_resume177
reca_retry178:
  s_sub_u32 s18, s18, 1
  s_cbranch_scc1 reca_retry178_to
  buffer_load_dwordx4 v[136:139], v22, s[4:7], s25 offen sc1
  buffer_load_dwordx4 v[140:143], v23, s[4:7], s25 offen sc1
  buffer_load_dwordx4 v[144:147], v24, s[4:7], s25 offen sc1
  buffer_load_dwordx4 v[148:151], v25, s[4:7], s25 offen sc1
  buffer_load_dwordx4 v[152:155], v26, s[4:7], s25 offen sc1
  buffer_load_dwordx4 v[156:159], v27, s[4:7], s25 offen sc1
  s_waitcnt vmcnt(5)
  v_cmp_eq_u32 vcc, -1, v136
  s_cbranch_vccnz reca_retry178
  s_branch reca_resume179
reca_retry178_to:
  s_mov_b32 s18, 0
  s_waitcnt vmcnt(0)
  s_branch reca_resume179
reca_retry180:
  s_sub_u32 s18, s18, 1
  s_cbranch_scc1 reca_retry180_to
  buffer_load_dwordx4 v[140:143], v23, s[4:7], s25 offen sc1
  buffer_load_dwordx4 v[144:147], v24, s[4:7], s25 offen sc1
  buffer_load_dwordx4 v[148:151], v25, s[4:7], s25 offen sc1
  buffer_load_dwordx4 v[152:155], v26, s[4:7], s25 offen sc1
  buffer_load_dwordx4 v[156:159], v27, s[4:7], s25 offen sc1
  s_waitcnt vmcnt(4)
  v_cmp_eq_u32 vcc, -1, v140
  s_cbranch_vccnz reca_retry180
  s_branch reca_resume181
reca_retry180_to:
  s_mov_b32 s18, 0
  s_waitcnt vmcnt(0)
  s_branch reca_resume181
reca_retry182:
  s_sub_u32 s18, s18, 1
  s_cbranch_scc1 reca_retry182_to
  buffer_load_dwordx4 v[144:147], v24, s[4:7], s25 offen sc1
  buffer_load_dwordx4 v[148:151], v25, s[4:7], s25 offen sc1
  buffer_load_dwordx4 v[152:155], v26, s[4:7], s25 offen sc1
  buffer_load_dwordx4 v[156:159], v27, s[4:7], s25 offen sc1
  s_waitcnt vmcnt(3)
  v_cmp_eq_u32 vcc, -1, v144
  s_cbranch_vccnz reca_retry182
  s_branch reca_resume183
reca_retry182_to:
  s_mov_b32 s18, 0
  s_waitcnt vmcnt(0)
  s_branch reca_resume183
reca_retry184:
  s_sub_u32 s18, s18, 1
  s_cbranch_scc1 reca_retry184_to
  buffer_load_dwordx4 v[148:151], v25, s[4:7], s25 offen sc1
  buffer_load_dwordx4 v[152:155], v26, s[4:7], s25 offen sc1
  buffer_load_dwordx4 v[156:159], v27, s[4:7], s25 offen sc1
  s_waitcnt vmcnt(2)
  v_cmp_eq_u32 vcc, -1, v148
  s_cbranch_vccnz reca_retry184
  s_branch reca_resume185
reca_retry184_to:
  s_mov_b32 s18, 0
  s_waitcnt vmcnt(0)
  s_branch reca_resume185
reca_retry186:
  s_sub_u32 s18, s18, 1
  s_cbranch_scc1 reca_retry186_to
  buffer_load_dwordx4 v[152:155], v26, s[4:7], s25 offen sc1
  buffer_load_dwordx4 v[156:159], v27, s[4:7], s25 offen sc1
  s_waitcnt vmcnt(1)
  v_cmp_eq_u32 vcc, -1, v152
  s_cbranch_vccnz reca_retry186
  s_branch reca_resume187
reca_retry186_to:
  s_mov_b32 s18, 0
  s_waitcnt vmcnt(0)
  s_branch reca_resume187
reca_retry188:
  s_sub_u32 s18, s18, 1
  s_cbranch_scc1 reca_retry188_to
  buffer_load_dwordx4 v[156:159], v27, s[4:7], s25 offen sc1
  s_waitcnt vmcnt(0)
  v_cmp_eq_u32 vcc, -1, v156
  s_cbranch_vccnz reca_retry188
  s_branch reca_resume189
reca_retry188_to:
  s_mov_b32 s18, 0
  s_waitcnt vmcnt(0)
  s_branch reca_resume189
reca_twins13:
  s_branch reca_gotmem194
reca_step193:
  s_and_b32 s34, s17, 3
  s_mul_i32 s20, s34, 10240
  s_add_u32 s20, s20, s38
  s_sleep 5
  buffer_load_dwordx4 v[128:131], v4, s[4:7], s20 offen sc1
  buffer_load_dwordx4 v[132:135], v4, s[4:7], s20 offen offset:1024 sc1
  buffer_load_dwordx4 v[136:139], v5, s[4:7], s20 offen sc1
  s_waitcnt vmcnt(2)
  v_max_u32 v29, v128, v130
  v_cmp_eq_u32 vcc, -1, v29
  s_cbranch_vccnz reca_retry196
reca_resume197:
  s_waitcnt vmcnt(1)
  v_max_u32 v29, v132, v134
  v_cmp_eq_u32 vcc, -1, v29
  ds_write_b128 v4, v[128:131]
  s_cbranch_vccnz reca_retry198
reca_resume199:
  s_waitcnt vmcnt(0)
  v_max_u32 v29, v136, v138
  v_cmp_eq_u32 vcc, -1, v29
  ds_write_b128 v4, v[132:135] offset:1024
  s_cbranch_vccnz reca_retry200
reca_resume201:
  ds_write_b128 v5, v[136:139]
  s_branch reca_gotmem2195
reca_gotmem194:
  ds_write_b128 v4, v[128:131]
  ds_write_b128 v4, v[132:135] offset:1024
  ds_write_b128 v5, v[136:139]
reca_gotmem2195:
  s_and_b32 s34, s17, 3
  s_mul_i32 s21, s34, 6144
  s_add_u32 s21, s21, s39
  s_mul_i32 s22, s34, 12288
  s_add_u32 s22, s22, s40
  s_mul_i32 s25, s34, 393216
  s_add_u32 s25, s25, s56
  s_add_u32 s35, s17, 1
  s_and_b32 s35, s35, 3
  s_mul_i32 s24, s35, 10240
  s_add_u32 s24, s24, s38
  s_waitcnt lgkmcnt(0)
  s_barrier
  ds_read_b128 v[128:131], v236 offset:0
  ds_read_b128 v[132:135], v236 offset:1024
  ds_read_b128 v[136:139], v236 offset:2048
  ds_read_b128 v[140:143], v236 offset:3072
  ds_read_b128 v[144:147], v236 offset:4096
  ds_read_b128 v[148:151], v237 offset:0
  ds_read_b128 v[152:155], v237 offset:1024
  ds_read_b128 v[156:159], v237 offset:2048
  ds_read_b128 v[160:163], v237 offset:3072
  ds_read_b128 v[164:167], v237 offset:4096
  s_waitcnt lgkmcnt(9)
  v_mfma_f32_16x16x32_bf16 v[44:47], a[0:3], v[128:131], 0
  ds_read_b128 v[168:171], v6 offset:0
  v_mfma_f32_16x16x32_bf16 v[240:243], a[4:7], v[128:131], 0
  s_waitcnt lgkmcnt(9)
  v_mfma_f32_16x16x32_bf16 v[44:47], a[8:11], v[132:135], v[44:47]
  ds_read_b128 v[172:175], v6 offset:512
  v_mfma_f32_16x16x32_bf16 v[240:243], a[12:15], v[132:135], v[240:243]
  s_waitcnt lgkmcnt(9)
  v_mfma_f32_16x16x32_bf16 v[44:47], a[16:19], v[136:139], v[44:47]
  ds_read_b128 v[176:179], v6 offset:1024
  v_mfma_f32_16x16x32_bf16 v[240:243], a[20:23], v[136:139], v[240:243]
  s_waitcnt lgkmcnt(9)
  v_mfma_f32_16x16x32_bf16 v[44:47], a[24:27], v[140:143], v[44:47]
  ds_read_b128 v[180:183], v6 offset:1536
  v_mfma_f32_16x16x32_bf16 v[240:243], a[28:31], v[140:143], v[240:243]
  s_waitcnt lgkmcnt(9)
  v_mfma_f32_16x16x32_bf16 v[44:47], a[32:35], v[144:147], v[44:47]
  ds_read_b128 v[184:187], v6 offset:2048
  v_mfma_f32_16x16x32_bf16 v[240:243], a[36:39], v[144:147], v[240:243]
  s_waitcnt lgkmcnt(9)
  v_mfma_f32_16x16x32_bf16 v[44:47], a[40:43], v[148:151], v[44:47]
  ds_read_b128 v[188:191], v6 offset:2560
  v_mfma_f32_16x16x32_bf16 v[240:243], a[44:47], v[148:151], v[240:243]
  s_waitcnt lgkmcnt(9)
  v_mfma_f32_16x16x32_bf16 v[44:47], a[48:51], v[152:155], v[44:47]
  ds_read_b128 v[192:195], v6 offset:3072
  v_mfma_f32_16x16x32_bf16 v[240:243], a[52:55], v[152:155], v[240:243]
  s_waitcnt lgkmcnt(9)
  v_mfma_f32_16x16x32_bf16 v[44:47], a[56:59], v[156:159], v[44:47]
  ds_read_b128 v[196:199], v6 offset:3584
  v_mfma_f32_16x16x32_bf16 v[240:243], a[60:63], v[156:159], v[240:243]
  s_waitcnt lgkmcnt(9)
  v_mfma_f32_16x16x32_bf16 v[44:47], a[64:67], v[160:163], v[44:47]
  ds_read_b128 v[200:203], v6 offset:4096
  v_mfma_f32_16x16x32_bf16 v[240:243], a[68:71], v[160:163], v[240:243]
  s_waitcnt lgkmcnt(9)
  v_mfma_f32_16x16x32_bf16 v[44:47], a[72:75], v[164:167], v[44:47]
  ds_read_b128 v[204:207], v6 offset:4608
  v_mfma_f32_16x16x32_bf16 v[240:243], a[76:79], v[164:167], v[240:243]
  s_waitcnt lgkmcnt(9)
  v_mfma_f32_16x16x32_bf16 v[48:51], v[168:171], a[80:83], 0
  s_and_b32 s34, s17, 15
  s_lshl_b32 s34, s34, 5
  s_add_u32 s34, s34, s15
  s_mul_i32 s34, s34, 3072
  s_lshl_b32 s35, s16, 9
  s_add_u32 s34, s34, s35
  s_add_u32 s30, s34, 56623104
  s_add_u32 s31, s34, 58195968
  v_add_f32_dpp v44, v240, v44 row_ror:8 row_mask:0xf bank_mask:0xf
  v_add_f32_dpp v45, v241, v45 row_ror:8 row_mask:0xf bank_mask:0xf
  v_add_f32_dpp v46, v242, v46 row_ror:8 row_mask:0xf bank_mask:0xf
  v_add_f32_dpp v47, v243, v47 row_ror:8 row_mask:0xf bank_mask:0xf
  v_cvt_pk_bf16_f32 v52, v44, v45
  v_cvt_pk_bf16_f32 v53, v46, v47
  buffer_store_dwordx2 v[52:53], v8, s[4:7], s21 offen sc1
  s_waitcnt lgkmcnt(8)
  v_mfma_f32_16x16x32_bf16 v[48:51], v[172:175], a[84:87], v[48:51]
  s_waitcnt lgkmcnt(7)
  v_mfma_f32_16x16x32_bf16 v[48:51], v[176:179], a[88:91], v[48:51]
  s_waitcnt lgkmcnt(6)
  v_mfma_f32_16x16x32_bf16 v[48:51], v[180:183], a[92:95], v[48:51]
  s_waitcnt lgkmcnt(5)
  v_mfma_f32_16x16x32_bf16 v[48:51], v[184:187], a[96:99], v[48:51]
  s_waitcnt lgkmcnt(4)
  v_mfma_f32_16x16x32_bf16 v[48:51], v[188:191], a[100:103], v[48:51]
  s_waitcnt lgkmcnt(3)
  v_mfma_f32_16x16x32_bf16 v[48:51], v[192:195], a[104:107], v[48:51]
  s_waitcnt lgkmcnt(2)
  v_mfma_f32_16x16x32_bf16 v[48:51], v[196:199], a[108:111], v[48:51]
  s_waitcnt lgkmcnt(1)
  v_mfma_f32_16x16x32_bf16 v[48:51], v[200:203], a[112:115], v[48:51]
  s_waitcnt lgkmcnt(0)
  v_mfma_f32_16x16x32_bf16 v[48:51], v[204:207], a[116:119], v[48:51]
  s_cmp_eq_u32 s12, 3
  s_cbranch_scc1 reca_swave202
  s_nop 5
  ds_write_b128 v17, v[48:51]
  s_add_u32 s34, s17, 2
  s_and_b32 s34, s34, 3
  s_mul_i32 s26, s34, 10240
  s_add_u32 s26, s26, s38
  s_mul_i32 s27, s34, 6144
  s_add_u32 s27, s27, s39
  s_mul_i32 s28, s34, 12288
  s_add_u32 s28, s28, s40
  s_mul_i32 s29, s34, 393216
  s_add_u32 s29, s29, s56
  s_waitcnt lgkmcnt(0)
  s_barrier
  s_cmp_eq_u32 s17, 63
  s_cbranch_scc1 reca_last204
  buffer_store_dwordx2 v[32:33], v8, s[4:7], s27 offen sc1
  s_cmp_lg_u32 s12, 2
  s_cbranch_scc1 reca_tw1208_n
  buffer_store_dwordx2 v[52:53], v9, s[4:7], s30 offen sc1
reca_tw1208_n:
  s_barrier
  s_cmp_eq_u32 s12, 1
  s_cbranch_scc1 reca_tw1208
  s_cmp_eq_u32 s12, 2
  s_cbranch_scc1 reca_tw2209
  s_cmp_lt_u32 s17, 2
  s_cbranch_scc1 reca_b5207
  s_cmp_gt_u32 s17, 61
  s_cbranch_scc1 reca_b5207
  s_sub_u32 s36, s17, 2
  s_and_b32 s36, s36, 15
  s_lshl_b32 s34, s59, 4
  s_add_u32 s34, s34, s36
  s_mul_i32 s34, s34, 12288
  s_add_u32 s23, s34, 37748736
  s_add_u32 s60, s34, 50331648
  s_lshl_b32 s35, s36, 5
  s_add_u32 s35, s35, s59
  s_mul_i32 s35, s35, 3072
  s_add_u32 s61, s35, 56623104
  buffer_load_dwordx4 a[120:123], v1, s[4:7], s23 offen offset:0 sc1
  buffer_load_dwordx4 a[124:127], v1, s[4:7], s23 offen offset:1024 sc1
  buffer_load_dwordx4 a[128:131], v1, s[4:7], s23 offen offset:2048 sc1
  buffer_load_dwordx4 a[132:135], v1, s[4:7], s23 offen offset:3072 sc1
  buffer_load_dwordx4 a[136:139], v2, s[4:7], s23 offen offset:0 sc1
  buffer_load_dwordx4 a[140:143], v2, s[4:7], s23 offen offset:1024 sc1
  buffer_load_dwordx4 a[144:147], v2, s[4:7], s23 offen offset:2048 sc1
  buffer_load_dwordx4 a[148:151], v2, s[4:7], s23 offen offset:3072 sc1
  buffer_load_dwordx4 a[152:155], v3, s[4:7], s23 offen offset:0 sc1
  buffer_load_dwordx4 a[156:159], v3, s[4:7], s23 offen offset:1024 sc1
  buffer_load_dwordx4 a[160:163], v3, s[4:7], s23 offen offset:2048 sc1
  buffer_load_dwordx4 a[164:167], v3, s[4:7], s23 offen offset:3072 sc1
  buffer_load_dwordx4 a[216:219], v92, s[4:7], s61 offen offset:0 sc1
  buffer_load_dwordx4 a[220:223], v92, s[4:7], s61 offen offset:512 sc1
  buffer_load_dwordx4 a[224:227], v92, s[4:7], s61 offen offset:1024 sc1
  buffer_load_dwordx4 a[228:231], v92, s[4:7], s61 offen offset:1536 sc1
  buffer_load_dwordx4 a[232:235], v92, s[4:7], s61 offen offset:2048 sc1
  buffer_load_dwordx4 a[236:239], v92, s[4:7], s61 offen offset:2560 sc1
  buffer_load_dwordx4 a[168:171], v1, s[4:7], s60 offen offset:0 sc1
  buffer_load_dwordx4 a[172:175], v1, s[4:7], s60 offen offset:1024 sc1
  buffer_load_dwordx4 a[176:179], v1, s[4:7], s60 offen offset:2048 sc1
  buffer_load_dwordx4 a[180:183], v1, s[4:7], s60 offen offset:3072 sc1
  buffer_load_dwordx4 a[184:187], v2, s[4:7], s60 offen offset:0 sc1
  buffer_load_dwordx4 a[188:191], v2, s[4:7], s60 offen offset:1024 sc1
  buffer_load_dwordx4 a[192:195], v2, s[4:7], s60 offen offset:2048 sc1
  buffer_load_dwordx4 a[196:199], v2, s[4:7], s60 offen offset:3072 sc1
  buffer_load_dwordx4 a[200:203], v3, s[4:7], s60 offen offset:0 sc1
  buffer_load_dwordx4 a[204:207], v3, s[4:7], s60 offen offset:1024 sc1
  buffer_load_dwordx4 a[208:211], v3, s[4:7], s60 offen offset:2048 sc1
  buffer_load_dwordx4 a[212:215], v3, s[4:7], s60 offen offset:3072 sc1
  s_waitcnt vmcnt(5)
  v_mfma_f32_16x16x32_bf16 v[128:131], a[216:219], a[168:171], v[84:87]
  v_mfma_f32_16x16x32_bf16 v[132:135], a[120:123], a[168:171], v[88:91]
  v_mfma_f32_16x16x32_bf16 v[136:139], a[216:219], a[192:195], v[84:87]
  v_mfma_f32_16x16x32_bf16 v[140:143], a[120:123], a[192:195], 0
  v_mfma_f32_16x16x32_bf16 v[144:147], a[144:147], a[192:195], v[88:91]
  s_waitcnt vmcnt(4)
  v_mfma_f32_16x16x32_bf16 v[128:131], a[220:223], a[172:175], v[128:131]
  v_mfma_f32_16x16x32_bf16 v[132:135], a[124:127], a[172:175], v[132:135]
  v_mfma_f32_16x16x32_bf16 v[136:139], a[220:223], a[196:199], v[136:139]
  v_mfma_f32_16x16x32_bf16 v[140:143], a[124:127], a[196:199], v[140:143]
  v_mfma_f32_16x16x32_bf16 v[144:147], a[148:151], a[196:199], v[144:147]
  s_waitcnt vmcnt(3)
  v_mfma_f32_16x16x32_bf16 v[128:131], a[224:227], a[176:179], v[128:131]
  v_mfma_f32_16x16x32_bf16 v[132:135], a[128:131], a[176:179], v[132:135]
  v_mfma_f32_16x16x32_bf16 v[136:139], a[224:227], a[200:203], v[136:139]
  v_mfma_f32_16x16x32_bf16 v[140:143], a[128:131], a[200:203], v[140:143]
  v_mfma_f32_16x16x32_bf16 v[144:147], a[152:155], a[200:203], v[144:147]
  s_waitcnt vmcnt(2)
  v_mfma_f32_16x16x32_bf16 v[128:131], a[228:231], a[180:183], v[128:131]
  v_mfma_f32_16x16x32_bf16 v[132:135], a[132:135], a[180:183], v[132:135]
  v_mfma_f32_16x16x32_bf16 v[136:139], a[228:231], a[204:207], v[136:139]
  v_mfma_f32_16x16x32_bf16 v[140:143], a[132:135], a[204:207], v[140:143]
  v_mfma_f32_16x16x32_bf16 v[144:147], a[156:159], a[204:207], v[144:147]
  s_waitcnt vmcnt(1)
  v_mfma_f32_16x16x32_bf16 v[128:131], a[232:235], a[184:187], v[128:131]
  v_mfma_f32_16x16x32_bf16 v[132:135], a[136:139], a[184:187], v[132:135]
  v_mfma_f32_16x16x32_bf16 v[136:139], a[232:235], a[208:211], v[136:139]
  v_mfma_f32_16x16x32_bf16 v[140:143], a[136:139], a[208:211], v[140:143]
  v_mfma_f32_16x16x32_bf16 v[144:147], a[160:163], a[208:211], v[144:147]
  s_waitcnt vmcnt(0)
  v_mfma_f32_16x16x32_bf16 v[128:131], a[236:239], a[188:191], v[128:131]
  v_mfma_f32_16x16x32_bf16 v[132:135], a[140:143], a[188:191], v[132:135]
  v_mfma_f32_16x16x32_bf16 v[136:139], a[236:239], a[212:215], v[136:139]
  v_mfma_f32_16x16x32_bf16 v[140:143], a[140:143], a[212:215], v[140:143]
  v_mfma_f32_16x16x32_bf16 v[144:147], a[164:167], a[212:215], v[144:147]
  s_nop 3
  v_max3_f32 v28, v128, v129, v130
  v_max3_f32 v28, v28, v131, v132
  v_max3_f32 v28, v28, v133, v134
  v_max_f32 v28, v28, v135
  v_mov_b32 v29, v28
  s_nop 1
  v_permlane32_swap_b32 v28, v29
  v_max_f32 v28, v28, v29
  v_mov_b32 v29, v28
  s_nop 1
  v_permlane16_swap_b32 v28, v29
  v_max_f32 v28, v28, v29
  v_mul_f32 v28, s41, v28
  v_fma_f32 v128, v128, s41, -v28
  v_fma_f32 v129, v129, s41, -v28
  v_fma_f32 v130, v130, s41, -v28
  v_fma_f32 v131, v131, s41, -v28
  v_fma_f32 v132, v132, s41, -v28
  v_fma_f32 v133, v133, s41, -v28
  v_fma_f32 v134, v134, s41, -v28
  v_fma_f32 v135, v135, s41, -v28
  v_exp_f32 v128, v128
  v_exp_f32 v129, v129
  v_exp_f32 v130, v130
  v_exp_f32 v131, v131
  v_exp_f32 v132, v132
  v_exp_f32 v133, v133
  v_exp_f32 v134, v134
  v_exp_f32 v135, v135
  v_max3_f32 v30, v136, v137, v138
  v_max3_f32 v30, v30, v139, v140
  v_max3_f32 v30, v30, v141, v142
  v_max3_f32 v30, v30, v143, v144
  v_max3_f32 v30, v30, v145, v146
  v_max_f32 v30, v30, v147
  v_mov_b32 v29, v30
  s_nop 1
  v_permlane32_swap_b32 v30, v29
  v_max_f32 v30, v30, v29
  v_mov_b32 v29, v30
  s_nop 1
  v_permlane16_swap_b32 v30, v29
  v_max_f32 v30, v30, v29
  v_mul_f32 v30, s41, v30
  v_fma_f32 v136, v136, s41, -v30
  v_fma_f32 v137, v137, s41, -v30
  v_fma_f32 v138, v138, s41, -v30
  v_fma_f32 v139, v139, s41, -v30
  v_fma_f32 v140, v140, s41, -v30
  v_fma_f32 v141, v141, s41, -v30
  v_fma_f32 v142, v142, s41, -v30
  v_fma_f32 v143, v143, s41, -v30
  v_fma_f32 v144, v144, s41, -v30
  v_fma_f32 v145, v145, s41, -v30
  v_fma_f32 v146, v146, s41, -v30
  v_fma_f32 v147, v147, s41, -v30
  v_exp_f32 v136, v136
  v_exp_f32 v137, v137
  v_exp_f32 v138, v138
  v_exp_f32 v139, v139
  v_exp_f32 v140, v140
  v_exp_f32 v141, v141
  v_exp_f32 v142, v142
  v_exp_f32 v143, v143
  v_exp_f32 v144, v144
  v_exp_f32 v145, v145
  v_exp_f32 v146, v146
  v_exp_f32 v147, v147
  v_cvt_pk_bf16_f32 v72, v128, v129
  v_cvt_pk_bf16_f32 v73, v130, v131
  v_cvt_pk_bf16_f32 v74, v132, v133
  v_cvt_pk_bf16_f32 v75, v134, v135
  v_cvt_pk_bf16_f32 v76, v136, v137
  v_cvt_pk_bf16_f32 v77, v138, v139
  v_cvt_pk_bf16_f32 v78, v140, v141
  v_cvt_pk_bf16_f32 v79, v142, v143
  v_cvt_pk_bf16_f32 v80, v144, v145
  v_cvt_pk_bf16_f32 v81, v146, v147
  v_mfma_f32_16x16x16_bf16 v[148:151], v[36:37], v[72:73], 0
  v_mfma_f32_16x16x16_bf16 v[152:155], v[36:37], v[76:77], 0
  v_mfma_f32_16x16x16_bf16 v[148:151], v[36:37], v[74:75], v[148:151]
  v_mfma_f32_16x16x32_bf16 v[152:155], v[36:39], v[78:81], v[152:155]
  s_nop 6
  v_rcp_f32 v82, v148
  v_rcp_f32 v83, v152
  s_and_b32 s34, s17, 1
  s_mul_i32 s34, s34, 3072
  v_add_u32 v28, s34, v1
  ds_write_b128 v28, v[72:75] offset:16384
  ds_write_b128 v28, v[76:79] offset:17408
  ds_write_b128 v28, v[80:83] offset:18432
  s_waitcnt lgkmcnt(0)
  s_branch reca_b5207
reca_tw1208:
  s_cmp_lt_u32 s17, 3
  s_cbranch_scc1 reca_b5207
  s_sub_u32 s36, s17, 3
  s_and_b32 s37, s36, 15
  s_lshl_b32 s34, s59, 4
  s_add_u32 s34, s34, s37
  s_mul_i32 s34, s34, 12288
  s_add_u32 s23, s34, 44040192
  s_lshl_b32 s35, s37, 5
  s_add_u32 s35, s35, s59
  s_mul_i32 s35, s35, 3072
  s_add_u32 s61, s35, 58195968
  s_mul_i32 s34, s36, 393216
  s_mul_i32 s35, s59, 6144
  s_add_u32 s34, s34, s35
  s_add_u32 s60, s34, 59768832
  s_add_u32 s34, s17, 1
  s_and_b32 s34, s34, 1
  s_mul_i32 s34, s34, 3072
  v_add_u32 v28, s34, v1
  ds_read_b128 v[72:75], v28 offset:16384
  ds_read_b128 v[76:79], v28 offset:17408
  ds_read_b128 v[80:83], v28 offset:18432
  buffer_load_dwordx2 a[168:169], v93, s[4:7], s61 offen offset:0 sc1
  buffer_load_dwordx4 a[120:123], v1, s[4:7], s23 offen offset:0 sc1
  buffer_load_dwordx2 a[170:171], v93, s[4:7], s61 offen offset:256 sc1
  buffer_load_dwordx4 a[124:127], v1, s[4:7], s23 offen offset:1024 sc1
  buffer_load_dwordx2 a[172:173], v93, s[4:7], s61 offen offset:512 sc1
  buffer_load_dwordx4 a[128:131], v1, s[4:7], s23 offen offset:2048 sc1
  buffer_load_dwordx2 a[174:175], v93, s[4:7], s61 offen offset:768 sc1
  buffer_load_dwordx4 a[132:135], v1, s[4:7], s23 offen offset:3072 sc1
  buffer_load_dwordx2 a[176:177], v93, s[4:7], s61 offen offset:1024 sc1
  buffer_load_dwordx4 a[136:139], v2, s[4:7], s23 offen offset:0 sc1
  buffer_load_dwordx2 a[178:179], v93, s[4:7], s61 offen offset:1280 sc1
  buffer_load_dwordx4 a[140:143], v2, s[4:7], s23 offen offset:1024 sc1
  s_waitcnt lgkmcnt(0)
  s_waitcnt vmcnt(8)
  v_mfma_f32_16x16x16_bf16 v[156:159], a[168:169], v[72:73], 0
  v_mfma_f32_16x16x16_bf16 v[160:163], a[168:169], v[76:77], 0
  v_mfma_f32_16x16x16_bf16 v[156:159], a[120:121], v[74:75], v[156:159]
  v_mfma_f32_16x16x32_bf16 v[160:163], a[120:123], v[78:81], v[160:163]
  v_mfma_f32_16x16x16_bf16 v[164:167], a[170:171], v[72:73], 0
  v_mfma_f32_16x16x16_bf16 v[168:171], a[170:171], v[76:77], 0
  v_mfma_f32_16x16x16_bf16 v[164:167], a[124:125], v[74:75], v[164:167]
  v_mfma_f32_16x16x32_bf16 v[168:171], a[124:127], v[78:81], v[168:171]
  s_nop 2
  v_mul_f32 v156, v156, v82
  v_mul_f32 v157, v157, v82
  v_mul_f32 v158, v158, v82
  v_mul_f32 v159, v159, v82
  v_cvt_pk_bf16_f32 v172, v156, v157
  v_cvt_pk_bf16_f32 v173, v158, v159
  v_mul_f32 v164, v164, v82
  v_mul_f32 v165, v165, v82
  v_mul_f32 v166, v166, v82
  v_mul_f32 v167, v167, v82
  v_cvt_pk_bf16_f32 v174, v164, v165
  v_cvt_pk_bf16_f32 v175, v166, v167
  buffer_store_dwordx4 v[172:175], v1, s[4:7], s60 offen offset:0
  v_mul_f32 v160, v160, v83
  v_mul_f32 v161, v161, v83
  v_mul_f32 v162, v162, v83
  v_mul_f32 v163, v163, v83
  v_cvt_pk_bf16_f32 v176, v160, v161
  v_cvt_pk_bf16_f32 v177, v162, v163
  v_mul_f32 v168, v168, v83
  v_mul_f32 v169, v169, v83
  v_mul_f32 v170, v170, v83
  v_mul_f32 v171, v171, v83
  v_cvt_pk_bf16_f32 v178, v168, v169
  v_cvt_pk_bf16_f32 v179, v170, v171
  s_add_u32 s34, s60, 196608
  buffer_store_dwordx4 v[176:179], v1, s[4:7], s34 offen offset:0
  s_waitcnt vmcnt(6)
  v_mfma_f32_16x16x16_bf16 v[156:159], a[172:173], v[72:73], 0
  v_mfma_f32_16x16x16_bf16 v[160:163], a[172:173], v[76:77], 0
  v_mfma_f32_16x16x16_bf16 v[156:159], a[128:129], v[74:75], v[156:159]
  v_mfma_f32_16x16x32_bf16 v[160:163], a[128:131], v[78:81], v[160:163]
  v_mfma_f32_16x16x16_bf16 v[164:167], a[174:175], v[72:73], 0
  v_mfma_f32_16x16x16_bf16 v[168:171], a[174:175], v[76:77], 0
  v_mfma_f32_16x16x16_bf16 v[164:167], a[132:133], v[74:75], v[164:167]
  v_mfma_f32_16x16x32_bf16 v[168:171], a[132:135], v[78:81], v[168:171]
  s_nop 2
  v_mul_f32 v156, v156, v82
  v_mul_f32 v157, v157, v82
  v_mul_f32 v158, v158, v82
  v_mul_f32 v159, v159, v82
  v_cvt_pk_bf16_f32 v172, v156, v157
  v_cvt_pk_bf16_f32 v173, v158, v159
  v_mul_f32 v164, v164, v82
  v_mul_f32 v165, v165, v82
  v_mul_f32 v166, v166, v82
  v_mul_f32 v167, v167, v82
  v_cvt_pk_bf16_f32 v174, v164, v165
  v_cvt_pk_bf16_f32 v175, v166, v167
  buffer_store_dwordx4 v[172:175], v1, s[4:7], s60 offen offset:1024
  v_mul_f32 v160, v160, v83
  v_mul_f32 v161, v161, v83
  v_mul_f32 v162, v162, v83
  v_mul_f32 v163, v163, v83
  v_cvt_pk_bf16_f32 v176, v160, v161
  v_cvt_pk_bf16_f32 v177, v162, v163
  v_mul_f32 v168, v168, v83
  v_mul_f32 v169, v169, v83
  v_mul_f32 v170, v170, v83
  v_mul_f32 v171, v171, v83
  v_cvt_pk_bf16_f32 v178, v168, v169
  v_cvt_pk_bf16_f32 v179, v170, v171
  s_add_u32 s34, s60, 196608
  buffer_store_dwordx4 v[176:179], v1, s[4:7], s34 offen offset:1024
  s_waitcnt vmcnt(4)
  v_mfma_f32_16x16x16_bf16 v[156:159], a[176:177], v[72:73], 0
  v_mfma_f32_16x16x16_bf16 v[160:163], a[176:177], v[76:77], 0
  v_mfma_f32_16x16x16_bf16 v[156:159], a[136:137], v[74:75], v[156:159]
  v_mfma_f32_16x16x32_bf16 v[160:163], a[136:139], v[78:81], v[160:163]
  v_mfma_f32_16x16x16_bf16 v[164:167], a[178:179], v[72:73], 0
  v_mfma_f32_16x16x16_bf16 v[168:171], a[178:179], v[76:77], 0
  v_mfma_f32_16x16x16_bf16 v[164:167], a[140:141], v[74:75], v[164:167]
  v_mfma_f32_16x16x32_bf16 v[168:171], a[140:143], v[78:81], v[168:171]
  s_nop 2
  v_mul_f32 v156, v156, v82
  v_mul_f32 v157, v157, v82
  v_mul_f32 v158, v158, v82
  v_mul_f32 v159, v159, v82
  v_cvt_pk_bf16_f32 v172, v156, v157
  v_cvt_pk_bf16_f32 v173, v158, v159
  v_mul_f32 v164, v164, v82
  v_mul_f32 v165, v165, v82
  v_mul_f32 v166, v166, v82
  v_mul_f32 v167, v167, v82
  v_cvt_pk_bf16_f32 v174, v164, v165
  v_cvt_pk_bf16_f32 v175, v166, v167
  buffer_store_dwordx4 v[172:175], v1, s[4:7], s60 offen offset:2048
  v_mul_f32 v160, v160, v83
  v_mul_f32 v161, v161, v83
  v_mul_f32 v162, v162, v83
  v_mul_f32 v163, v163, v83
  v_cvt_pk_bf16_f32 v176, v160, v161
  v_cvt_pk_bf16_f32 v177, v162, v163
  v_mul_f32 v168, v168, v83
  v_mul_f32 v169, v169, v83
  v_mul_f32 v170, v170, v83
  v_mul_f32 v171, v171, v83
  v_cvt_pk_bf16_f32 v178, v168, v169
  v_cvt_pk_bf16_f32 v179, v170, v171
  s_add_u32 s34, s60, 196608
  buffer_store_dwordx4 v[176:179], v1, s[4:7], s34 offen offset:2048
  s_branch reca_b5207
reca_tw2209:
  s_cmp_lt_u32 s17, 3
  s_cbranch_scc1 reca_b5207
  s_sub_u32 s36, s17, 3
  s_and_b32 s37, s36, 15
  s_lshl_b32 s34, s59, 4
  s_add_u32 s34, s34, s37
  s_mul_i32 s34, s34, 12288
  s_add_u32 s23, s34, 44040192
  s_lshl_b32 s35, s37, 5
  s_add_u32 s35, s35, s59
  s_mul_i32 s35, s35, 3072
  s_add_u32 s61, s35, 58195968
  s_mul_i32 s34, s36, 393216
  s_mul_i32 s35, s59, 6144
  s_add_u32 s34, s34, s35
  s_add_u32 s60, s34, 59768832
  s_add_u32 s34, s17, 1
  s_and_b32 s34, s34, 1
  s_mul_i32 s34, s34, 3072
  v_add_u32 v28, s34, v1
  ds_read_b128 v[72:75], v28 offset:16384
  ds_read_b128 v[76:79], v28 offset:17408
  ds_read_b128 v[80:83], v28 offset:18432
  buffer_load_dwordx2 a[180:181], v93, s[4:7], s61 offen offset:1536 sc1
  buffer_load_dwordx4 a[144:147], v2, s[4:7], s23 offen offset:2048 sc1
  buffer_load_dwordx2 a[182:183], v93, s[4:7], s61 offen offset:1792 sc1
  buffer_load_dwordx4 a[148:151], v2, s[4:7], s23 offen offset:3072 sc1
  buffer_load_dwordx2 a[184:185], v93, s[4:7], s61 offen offset:2048 sc1
  buffer_load_dwordx4 a[152:155], v3, s[4:7], s23 offen offset:0 sc1
  buffer_load_dwordx2 a[186:187], v93, s[4:7], s61 offen offset:2304 sc1
  buffer_load_dwordx4 a[156:159], v3, s[4:7], s23 offen offset:1024 sc1
  buffer_load_dwordx2 a[188:189], v93, s[4:7], s61 offen offset:2560 sc1
  buffer_load_dwordx4 a[160:163], v3, s[4:7], s23 offen offset:2048 sc1
  buffer_load_dwordx2 a[190:191], v93, s[4:7], s61 offen offset:2816 sc1
  buffer_load_dwordx4 a[164:167], v3, s[4:7], s23 offen offset:3072 sc1
  s_waitcnt lgkmcnt(0)
  s_waitcnt vmcnt(8)
  v_mfma_f32_16x16x16_bf16 v[156:159], a[180:181], v[72:73], 0
  v_mfma_f32_16x16x16_bf16 v[160:163], a[180:181], v[76:77], 0
  v_mfma_f32_16x16x16_bf16 v[156:159], a[144:145], v[74:75], v[156:159]
  v_mfma_f32_16x16x32_bf16 v[160:163], a[144:147], v[78:81], v[160:163]
  v_mfma_f32_16x16x16_bf16 v[164:167], a[182:183], v[72:73], 0
  v_mfma_f32_16x16x16_bf16 v[168:171], a[182:183], v[76:77], 0
  v_mfma_f32_16x16x16_bf16 v[164:167], a[148:149], v[74:75], v[164:167]
  v_mfma_f32_16x16x32_bf16 v[168:171], a[148:151], v[78:81], v[168:171]
  s_nop 2
  v_mul_f32 v156, v156, v82
  v_mul_f32 v157, v157, v82
  v_mul_f32 v158, v158, v82
  v_mul_f32 v159, v159, v82
  v_cvt_pk_bf16_f32 v172, v156, v157
  v_cvt_pk_bf16_f32 v173, v158, v159
  v_mul_f32 v164, v164, v82
  v_mul_f32 v165, v165, v82
  v_mul_f32 v166, v166, v82
  v_mul_f32 v167, v167, v82
  v_cvt_pk_bf16_f32 v174, v164, v165
  v_cvt_pk_bf16_f32 v175, v166, v167
  buffer_store_dwordx4 v[172:175], v1, s[4:7], s60 offen offset:3072
  v_mul_f32 v160, v160, v83
  v_mul_f32 v161, v161, v83
  v_mul_f32 v162, v162, v83
  v_mul_f32 v163, v163, v83
  v_cvt_pk_bf16_f32 v176, v160, v161
  v_cvt_pk_bf16_f32 v177, v162, v163
  v_mul_f32 v168, v168, v83
  v_mul_f32 v169, v169, v83
  v_mul_f32 v170, v170, v83
  v_mul_f32 v171, v171, v83
  v_cvt_pk_bf16_f32 v178, v168, v169
  v_cvt_pk_bf16_f32 v179, v170, v171
  s_add_u32 s34, s60, 196608
  buffer_store_dwordx4 v[176:179], v1, s[4:7], s34 offen offset:3072
  s_waitcnt vmcnt(6)
  v_mfma_f32_16x16x16_bf16 v[156:159], a[184:185], v[72:73], 0
  v_mfma_f32_16x16x16_bf16 v[160:163], a[184:185], v[76:77], 0
  v_mfma_f32_16x16x16_bf16 v[156:159], a[152:153], v[74:75], v[156:159]
  v_mfma_f32_16x16x32_bf16 v[160:163], a[152:155], v[78:81], v[160:163]
  v_mfma_f32_16x16x16_bf16 v[164:167], a[186:187], v[72:73], 0
  v_mfma_f32_16x16x16_bf16 v[168:171], a[186:187], v[76:77], 0
  v_mfma_f32_16x16x16_bf16 v[164:167], a[156:157], v[74:75], v[164:167]
  v_mfma_f32_16x16x32_bf16 v[168:171], a[156:159], v[78:81], v[168:171]
  s_nop 2
  v_mul_f32 v156, v156, v82
  v_mul_f32 v157, v157, v82
  v_mul_f32 v158, v158, v82
  v_mul_f32 v159, v159, v82
  v_cvt_pk_bf16_f32 v172, v156, v157
  v_cvt_pk_bf16_f32 v173, v158, v159
  v_mul_f32 v164, v164, v82
  v_mul_f32 v165, v165, v82
  v_mul_f32 v166, v166, v82
  v_mul_f32 v167, v167, v82
  v_cvt_pk_bf16_f32 v174, v164, v165
  v_cvt_pk_bf16_f32 v175, v166, v167
  buffer_store_dwordx4 v[172:175], v2, s[4:7], s60 offen offset:0
  v_mul_f32 v160, v160, v83
  v_mul_f32 v161, v161, v83
  v_mul_f32 v162, v162, v83
  v_mul_f32 v163, v163, v83
  v_cvt_pk_bf16_f32 v176, v160, v161
  v_cvt_pk_bf16_f32 v177, v162, v163
  v_mul_f32 v168, v168, v83
  v_mul_f32 v169, v169, v83
  v_mul_f32 v170, v170, v83
  v_mul_f32 v171, v171, v83
  v_cvt_pk_bf16_f32 v178, v168, v169
  v_cvt_pk_bf16_f32 v179, v170, v171
  s_add_u32 s34, s60, 196608
  buffer_store_dwordx4 v[176:179], v2, s[4:7], s34 offen offset:0
  s_waitcnt vmcnt(4)
  v_mfma_f32_16x16x16_bf16 v[156:159], a[188:189], v[72:73], 0
  v_mfma_f32_16x16x16_bf16 v[160:163], a[188:189], v[76:77], 0
  v_mfma_f32_16x16x16_bf16 v[156:159], a[160:161], v[74:75], v[156:159]
  v_mfma_f32_16x16x32_bf16 v[160:163], a[160:163], v[78:81], v[160:163]
  v_mfma_f32_16x16x16_bf16 v[164:167], a[190:191], v[72:73], 0
  v_mfma_f32_16x16x16_bf16 v[168:171], a[190:191], v[76:77], 0
  v_mfma_f32_16x16x16_bf16 v[164:167], a[164:165], v[74:75], v[164:167]
  v_mfma_f32_16x16x32_bf16 v[168:171], a[164:167], v[78:81], v[168:171]
  s_nop 2
  v_mul_f32 v156, v156, v82
  v_mul_f32 v157, v157, v82
  v_mul_f32 v158, v158, v82
  v_mul_f32 v159, v159, v82
  v_cvt_pk_bf16_f32 v172, v156, v157
  v_cvt_pk_bf16_f32 v173, v158, v159
  v_mul_f32 v164, v164, v82
  v_mul_f32 v165, v165, v82
  v_mul_f32 v166, v166, v82
  v_mul_f32 v167, v167, v82
  v_cvt_pk_bf16_f32 v174, v164, v165
  v_cvt_pk_bf16_f32 v175, v166, v167
  buffer_store_dwordx4 v[172:175], v2, s[4:7], s60 offen offset:1024
  v_mul_f32 v160, v160, v83
  v_mul_f32 v161, v161, v83
  v_mul_f32 v162, v162, v83
  v_mul_f32 v163, v163, v83
  v_cvt_pk_bf16_f32 v176, v160, v161
  v_cvt_pk_bf16_f32 v177, v162, v163
  v_mul_f32 v168, v168, v83
  v_mul_f32 v169, v169, v83
  v_mul_f32 v170, v170, v83
  v_mul_f32 v171, v171, v83
  v_cvt_pk_bf16_f32 v178, v168, v169
  v_cvt_pk_bf16_f32 v179, v170, v171
  s_add_u32 s34, s60, 196608
  buffer_store_dwordx4 v[176:179], v2, s[4:7], s34 offen offset:1024
  s_branch reca_b5207
  s_cmp_lg_u32 s12, 2
  s_cbranch_scc1 reca_b3205
  buffer_store_dwordx2 v[52:53], v9, s[4:7], s30 offen sc1
  buffer_store_dwordx2 v[32:33], v16, s[4:7], s26 offen sc1
  s_cmp_lg_u32 s14, 0
  s_cbranch_scc1 reca_b3205
  v_mov_b32 v28, s17
  s_lshl_b32 s34, s13, 7
  s_add_u32 s34, s34, 1507328
  buffer_store_dword v28, v19, s[4:7], s34 offen sc1
  s_branch reca_b3205
reca_last204:
  s_cmp_lg_u32 s12, 2
  s_cbranch_scc1 reca_exit1
  buffer_store_dwordx2 v[52:53], v9, s[4:7], s30 offen
  s_branch reca_exit1
reca_swave202:
  s_cmp_lg_u32 s17, 63
  s_cbranch_scc1 reca_vmst210
  s_barrier
  ds_read_b128 v[56:59], v1 offset:10240
  ds_read_b128 v[60:63], v1 offset:11264
  ds_read_b128 v[64:67], v1 offset:12288
  s_waitcnt lgkmcnt(0)
  v_add_f32 v56, v56, v64
  v_add_f32 v60, v60, v48
  v_add_f32 v57, v57, v65
  v_add_f32 v61, v61, v49
  v_add_f32 v58, v58, v66
  v_add_f32 v62, v62, v50
  v_add_f32 v59, v59, v67
  v_add_f32 v63, v63, v51
  v_cvt_pk_bf16_f32 v68, v56, v57
  v_cvt_pk_bf16_f32 v69, v58, v59
  v_cvt_pk_bf16_f32 v70, v60, v61
  v_cvt_pk_bf16_f32 v71, v62, v63
  buffer_store_dwordx2 v[52:53], v9, s[4:7], s30 offen
  buffer_store_dwordx2 v[68:69], v10, s[4:7], s31 offen
  buffer_store_dwordx2 v[70:71], v10, s[4:7], s31 offen offset:256
  s_branch reca_exit1
reca_vmst210:
  s_sleep 1
  buffer_load_dwordx4 v[208:211], v1, s[4:7], s21 offen offset:0 sc1
  buffer_load_dwordx4 v[212:215], v1, s[4:7], s21 offen offset:1024 sc1
  buffer_load_dwordx4 v[216:219], v1, s[4:7], s21 offen offset:2048 sc1
  buffer_load_dwordx4 v[220:223], v1, s[4:7], s21 offen offset:3072 sc1
  buffer_load_dwordx4 v[224:227], v2, s[4:7], s21 offen offset:0 sc1
  buffer_load_dwordx4 v[228:231], v2, s[4:7], s21 offen offset:1024 sc1
  s_waitcnt vmcnt(5)
  v_max_u32 v29, v208, v210
  v_cmp_eq_u32 vcc, -1, v29
  s_cbranch_vccnz reca_retry211
reca_resume212:
  s_waitcnt vmcnt(4)
  v_max_u32 v29, v212, v214
  v_cmp_eq_u32 vcc, -1, v29
  v_mfma_f32_16x16x32_bf16 v[76:79], a[120:123], v[208:211], 0
  v_mfma_f32_16x16x32_bf16 v[80:83], a[144:147], v[208:211], 0
  v_mfma_f32_16x16x32_bf16 v[72:75], v[208:211], v[208:211], v[40:43]
  s_cbranch_vccnz reca_retry213
reca_resume214:
  s_waitcnt vmcnt(3)
  v_max_u32 v29, v216, v218
  v_cmp_eq_u32 vcc, -1, v29
  v_mfma_f32_16x16x32_bf16 v[76:79], a[124:127], v[212:215], v[76:79]
  v_mfma_f32_16x16x32_bf16 v[80:83], a[148:151], v[212:215], v[80:83]
  v_mfma_f32_16x16x32_bf16 v[72:75], v[212:215], v[212:215], v[72:75]
  s_cbranch_vccnz reca_retry215
reca_resume216:
  s_waitcnt vmcnt(2)
  v_max_u32 v29, v220, v222
  v_cmp_eq_u32 vcc, -1, v29
  v_mfma_f32_16x16x32_bf16 v[76:79], a[128:131], v[216:219], v[76:79]
  v_mfma_f32_16x16x32_bf16 v[80:83], a[152:155], v[216:219], v[80:83]
  v_mfma_f32_16x16x32_bf16 v[72:75], v[216:219], v[216:219], v[72:75]
  s_cbranch_vccnz reca_retry217
reca_resume218:
  s_waitcnt vmcnt(1)
  v_max_u32 v29, v224, v226
  v_cmp_eq_u32 vcc, -1, v29
  v_mfma_f32_16x16x32_bf16 v[76:79], a[132:135], v[220:223], v[76:79]
  v_mfma_f32_16x16x32_bf16 v[80:83], a[156:159], v[220:223], v[80:83]
  v_mfma_f32_16x16x32_bf16 v[72:75], v[220:223], v[220:223], v[72:75]
  s_cbranch_vccnz reca_retry219
reca_resume220:
  s_waitcnt vmcnt(0)
  v_max_u32 v29, v228, v230
  v_cmp_eq_u32 vcc, -1, v29
  v_mfma_f32_16x16x32_bf16 v[76:79], a[136:139], v[224:227], v[76:79]
  v_mfma_f32_16x16x32_bf16 v[80:83], a[160:163], v[224:227], v[80:83]
  v_mfma_f32_16x16x32_bf16 v[72:75], v[224:227], v[224:227], v[72:75]
  s_cbranch_vccnz reca_retry221
reca_resume222:
  v_mfma_f32_16x16x32_bf16 v[76:79], a[140:143], v[228:231], v[76:79]
  v_mfma_f32_16x16x32_bf16 v[80:83], a[164:167], v[228:231], v[80:83]
  v_mfma_f32_16x16x32_bf16 v[72:75], v[228:231], v[228:231], v[72:75]
  s_barrier
  ds_read_b128 v[56:59], v1 offset:10240
  ds_read_b128 v[60:63], v1 offset:11264
  ds_read_b128 v[64:67], v1 offset:12288
  s_nop 1
  v_max3_f32 v28, v76, v77, v78
  v_max3_f32 v29, v80, v81, v82
  v_max3_f32 v28, v28, v79, v83
  v_max3_f32 v29, v29, v72, v73
  v_max3_f32 v28, v28, v74, v75
  v_max_f32 v28, v28, v29
  v_mov_b32 v29, v28
  s_nop 1
  v_permlane32_swap_b32 v28, v29
  v_max_f32 v28, v28, v29
  v_mov_b32 v29, v28
  s_nop 1
  v_permlane16_swap_b32 v28, v29
  v_max_f32 v28, v28, v29
  v_mul_f32 v28, s41, v28
  v_fma_f32 v76, v76, s41, -v28
  v_fma_f32 v77, v77, s41, -v28
  v_fma_f32 v78, v78, s41, -v28
  v_fma_f32 v79, v79, s41, -v28
  v_fma_f32 v80, v80, s41, -v28
  v_fma_f32 v81, v81, s41, -v28
  v_fma_f32 v82, v82, s41, -v28
  v_fma_f32 v83, v83, s41, -v28
  v_fma_f32 v72, v72, s41, -v28
  v_fma_f32 v73, v73, s41, -v28
  v_fma_f32 v74, v74, s41, -v28
  v_fma_f32 v75, v75, s41, -v28
  v_exp_f32 v76, v76
  v_exp_f32 v77, v77
  v_exp_f32 v78, v78
  v_exp_f32 v79, v79
  v_exp_f32 v80, v80
  v_exp_f32 v81, v81
  v_exp_f32 v82, v82
  v_exp_f32 v83, v83
  v_cvt_pk_bf16_f32 v84, v76, v77
  v_cvt_pk_bf16_f32 v85, v78, v79
  v_cvt_pk_bf16_f32 v86, v80, v81
  v_cvt_pk_bf16_f32 v87, v82, v83
  v_exp_f32 v72, v72
  v_exp_f32 v73, v73
  v_mfma_f32_16x16x32_bf16 v[100:103], v[36:39], v[84:87], 0
  v_exp_f32 v74, v74
  v_exp_f32 v75, v75
  v_mfma_f32_16x16x32_bf16 v[92:95], a[168:171], v[84:87], 0
  v_cvt_pk_bf16_f32 v88, v72, v73
  v_cvt_pk_bf16_f32 v89, v74, v75
  v_mfma_f32_16x16x32_bf16 v[96:99], a[172:175], v[84:87], 0
  s_waitcnt lgkmcnt(0)
  v_mfma_f32_16x16x16_bf16 v[100:103], v[36:37], v[88:89], v[100:103]
  v_add_f32 v56, v56, v64
  v_add_f32 v60, v60, v48
  v_add_f32 v57, v57, v65
  v_add_f32 v61, v61, v49
  v_add_f32 v58, v58, v66
  v_add_f32 v62, v62, v50
  v_add_f32 v59, v59, v67
  v_add_f32 v63, v63, v51
  v_cvt_pk_bf16_f32 v68, v56, v57
  v_cvt_pk_bf16_f32 v69, v58, v59
  v_cvt_pk_bf16_f32 v70, v60, v61
  v_cvt_pk_bf16_f32 v71, v62, v63
  v_mfma_f32_16x16x16_bf16 v[92:95], v[68:69], v[88:89], v[92:95]
  v_rcp_f32 v28, v100
  v_mfma_f32_16x16x16_bf16 v[96:99], v[70:71], v[88:89], v[96:99]
  v_mov_b32 v29, v28
  s_nop 4
  v_pk_mul_f32 v[92:93], v[92:93], v[28:29]
  v_pk_mul_f32 v[94:95], v[94:95], v[28:29]
  v_pk_mul_f32 v[96:97], v[96:97], v[28:29]
  v_pk_mul_f32 v[98:99], v[98:99], v[28:29]
  v_cvt_pk_bf16_f32 v104, v92, v93
  v_cvt_pk_bf16_f32 v105, v94, v95
  v_cvt_pk_bf16_f32 v106, v96, v97
  v_cvt_pk_bf16_f32 v107, v98, v99
  buffer_store_dwordx4 v[104:107], v11, s[4:7], s22 offen sc1
  s_barrier
  s_add_u32 s34, s17, 2
  s_and_b32 s34, s34, 3
  s_mul_i32 s26, s34, 10240
  s_add_u32 s26, s26, s38
  s_mul_i32 s27, s34, 6144
  s_add_u32 s27, s27, s39
  s_mul_i32 s28, s34, 12288
  s_add_u32 s28, s28, s40
  s_mul_i32 s29, s34, 393216
  s_add_u32 s29, s29, s56
  buffer_store_dwordx2 v[32:33], v8, s[4:7], s27 offen sc1
  buffer_store_dwordx4 v[32:35], v11, s[4:7], s28 offen sc1
  s_add_u32 s36, s17, 1
  s_cmp_ge_u32 s36, 63
  s_cbranch_scc1 reca_nopf223
  s_add_u32 s37, s36, 1
reca_pf224:
  buffer_load_dword v28, v233, s[4:7], 0 offen sc1
  s_waitcnt vmcnt(0)
  v_cmp_gt_i32 vcc, s37, v28
  s_cbranch_vccz reca_pfok225
  s_sleep 1
  s_sub_u32 s18, s18, 1
  s_cbranch_scc0 reca_pf224
  s_mov_b32 s18, 0
reca_pfok225:
  s_lshl_b32 s34, s15, 4
  s_and_b32 s35, s36, 15
  s_add_u32 s34, s34, s35
  s_mul_i32 s34, s34, 12288
  s_add_u32 s32, s34, 37748736
  s_lshl_b32 s35, s16, 11
  s_add_u32 s34, s34, s35
  s_add_u32 s33, s34, 44040192
  buffer_load_dwordx4 a[120:123], v1, s[4:7], s32 offen offset:0 sc1
  buffer_load_dwordx4 a[124:127], v1, s[4:7], s32 offen offset:1024 sc1
  buffer_load_dwordx4 a[128:131], v1, s[4:7], s32 offen offset:2048 sc1
  buffer_load_dwordx4 a[132:135], v1, s[4:7], s32 offen offset:3072 sc1
  buffer_load_dwordx4 a[136:139], v2, s[4:7], s32 offen offset:0 sc1
  buffer_load_dwordx4 a[140:143], v2, s[4:7], s32 offen offset:1024 sc1
  buffer_load_dwordx4 a[144:147], v2, s[4:7], s32 offen offset:2048 sc1
  buffer_load_dwordx4 a[148:151], v2, s[4:7], s32 offen offset:3072 sc1
  buffer_load_dwordx4 a[152:155], v3, s[4:7], s32 offen offset:0 sc1
  buffer_load_dwordx4 a[156:159], v3, s[4:7], s32 offen offset:1024 sc1
  buffer_load_dwordx4 a[160:163], v3, s[4:7], s32 offen offset:2048 sc1
  buffer_load_dwordx4 a[164:167], v3, s[4:7], s32 offen offset:3072 sc1
  buffer_load_dwordx4 a[168:171], v1, s[4:7], s33 offen offset:0 sc1
  buffer_load_dwordx4 a[172:175], v1, s[4:7], s33 offen offset:1024 sc1
reca_nopf223:
  buffer_store_dwordx2 v[52:53], v9, s[4:7], s30 offen sc1
  buffer_store_dwordx2 v[68:69], v10, s[4:7], s31 offen sc1
  buffer_store_dwordx2 v[70:71], v10, s[4:7], s31 offen offset:256 sc1
reca_b5207:
  s_barrier
  s_add_u32 s17, s17, 1
  s_branch reca_step193
reca_b3205:
  s_endpgm
reca_retry196:
  s_sub_u32 s18, s18, 1
  s_cbranch_scc1 reca_retry196_to
  buffer_load_dwordx4 v[128:131], v4, s[4:7], s20 offen sc1
  buffer_load_dwordx4 v[132:135], v4, s[4:7], s20 offen offset:1024 sc1
  buffer_load_dwordx4 v[136:139], v5, s[4:7], s20 offen sc1
  s_waitcnt vmcnt(2)
  v_max_u32 v29, v128, v130
  v_cmp_eq_u32 vcc, -1, v29
  s_cbranch_vccnz reca_retry196
  s_branch reca_resume197
reca_retry196_to:
  s_mov_b32 s18, 0
  s_waitcnt vmcnt(0)
  s_branch reca_resume197
reca_retry198:
  s_sub_u32 s18, s18, 1
  s_cbranch_scc1 reca_retry198_to
  buffer_load_dwordx4 v[132:135], v4, s[4:7], s20 offen offset:1024 sc1
  buffer_load_dwordx4 v[136:139], v5, s[4:7], s20 offen sc1
  s_waitcnt vmcnt(1)
  v_max_u32 v29, v132, v134
  v_cmp_eq_u32 vcc, -1, v29
  s_cbranch_vccnz reca_retry198
  s_branch reca_resume199
reca_retry198_to:
  s_mov_b32 s18, 0
  s_waitcnt vmcnt(0)
  s_branch reca_resume199
reca_retry200:
  s_sub_u32 s18, s18, 1
  s_cbranch_scc1 reca_retry200_to
  buffer_load_dwordx4 v[136:139], v5, s[4:7], s20 offen sc1
  s_waitcnt vmcnt(0)
  v_max_u32 v29, v136, v138
  v_cmp_eq_u32 vcc, -1, v29
  s_cbranch_vccnz reca_retry200
  s_branch reca_resume201
reca_retry200_to:
  s_mov_b32 s18, 0
  s_waitcnt vmcnt(0)
  s_branch reca_resume201
reca_retry211:
  s_sub_u32 s18, s18, 1
  s_cbranch_scc1 reca_retry211_to
  buffer_load_dwordx4 v[208:211], v1, s[4:7], s21 offen offset:0 sc1
  buffer_load_dwordx4 v[212:215], v1, s[4:7], s21 offen offset:1024 sc1
  buffer_load_dwordx4 v[216:219], v1, s[4:7], s21 offen offset:2048 sc1
  buffer_load_dwordx4 v[220:223], v1, s[4:7], s21 offen offset:3072 sc1
  buffer_load_dwordx4 v[224:227], v2, s[4:7], s21 offen offset:0 sc1
  buffer_load_dwordx4 v[228:231], v2, s[4:7], s21 offen offset:1024 sc1
  s_waitcnt vmcnt(5)
  v_max_u32 v29, v208, v210
  v_cmp_eq_u32 vcc, -1, v29
  s_cbranch_vccnz reca_retry211
  s_branch reca_resume212
reca_retry211_to:
  s_mov_b32 s18, 0
  s_waitcnt vmcnt(0)
  s_branch reca_resume212
reca_retry213:
  s_sub_u32 s18, s18, 1
  s_cbranch_scc1 reca_retry213_to
  buffer_load_dwordx4 v[212:215], v1, s[4:7], s21 offen offset:1024 sc1
  buffer_load_dwordx4 v[216:219], v1, s[4:7], s21 offen offset:2048 sc1
  buffer_load_dwordx4 v[220:223], v1, s[4:7], s21 offen offset:3072 sc1
  buffer_load_dwordx4 v[224:227], v2, s[4:7], s21 offen offset:0 sc1
  buffer_load_dwordx4 v[228:231], v2, s[4:7], s21 offen offset:1024 sc1
  s_waitcnt vmcnt(4)
  v_max_u32 v29, v212, v214
  v_cmp_eq_u32 vcc, -1, v29
  s_cbranch_vccnz reca_retry213
  s_branch reca_resume214
reca_retry213_to:
  s_mov_b32 s18, 0
  s_waitcnt vmcnt(0)
  s_branch reca_resume214
reca_retry215:
  s_sub_u32 s18, s18, 1
  s_cbranch_scc1 reca_retry215_to
  buffer_load_dwordx4 v[216:219], v1, s[4:7], s21 offen offset:2048 sc1
  buffer_load_dwordx4 v[220:223], v1, s[4:7], s21 offen offset:3072 sc1
  buffer_load_dwordx4 v[224:227], v2, s[4:7], s21 offen offset:0 sc1
  buffer_load_dwordx4 v[228:231], v2, s[4:7], s21 offen offset:1024 sc1
  s_waitcnt vmcnt(3)
  v_max_u32 v29, v216, v218
  v_cmp_eq_u32 vcc, -1, v29
  s_cbranch_vccnz reca_retry215
  s_branch reca_resume216
reca_retry215_to:
  s_mov_b32 s18, 0
  s_waitcnt vmcnt(0)
  s_branch reca_resume216
reca_retry217:
  s_sub_u32 s18, s18, 1
  s_cbranch_scc1 reca_retry217_to
  buffer_load_dwordx4 v[220:223], v1, s[4:7], s21 offen offset:3072 sc1
  buffer_load_dwordx4 v[224:227], v2, s[4:7], s21 offen offset:0 sc1
  buffer_load_dwordx4 v[228:231], v2, s[4:7], s21 offen offset:1024 sc1
  s_waitcnt vmcnt(2)
  v_max_u32 v29, v220, v222
  v_cmp_eq_u32 vcc, -1, v29
  s_cbranch_vccnz reca_retry217
  s_branch reca_resume218
reca_retry217_to:
  s_mov_b32 s18, 0
  s_waitcnt vmcnt(0)
  s_branch reca_resume218
reca_retry219:
  s_sub_u32 s18, s18, 1
  s_cbranch_scc1 reca_retry219_to
  buffer_load_dwordx4 v[224:227], v2, s[4:7], s21 offen offset:0 sc1
  buffer_load_dwordx4 v[228:231], v2, s[4:7], s21 offen offset:1024 sc1
  s_waitcnt vmcnt(1)
  v_max_u32 v29, v224, v226
  v_cmp_eq_u32 vcc, -1, v29
  s_cbranch_vccnz reca_retry219
  s_branch reca_resume220
reca_retry219_to:
  s_mov_b32 s18, 0
  s_waitcnt vmcnt(0)
  s_branch reca_resume220
reca_retry221:
  s_sub_u32 s18, s18, 1
  s_cbranch_scc1 reca_retry221_to
  buffer_load_dwordx4 v[228:231], v2, s[4:7], s21 offen offset:1024 sc1
  s_waitcnt vmcnt(0)
  v_max_u32 v29, v228, v230
  v_cmp_eq_u32 vcc, -1, v29
  s_cbranch_vccnz reca_retry221
  s_branch reca_resume222
reca_retry221_to:
  s_mov_b32 s18, 0
  s_waitcnt vmcnt(0)
  s_branch reca_resume222
reca_proj2:
  s_sub_u32 s34, s14, 24
  s_lshr_b32 s35, s34, 1
  s_and_b32 s16, s34, 1
  s_lshl_b32 s15, s13, 2
  s_add_u32 s15, s15, s35
  s_lshl_b32 s24, s13, 3
  s_add_u32 s24, s24, s34
  s_lshl_b32 s24, s24, 7
  s_add_u32 s24, s24, 1540096
  s_lshl_b32 s25, s13, 7
  s_add_u32 s25, s25, 1507328
  v_and_b32 v28, 63, v0
  v_lshlrev_b32 v1, 4, v28
  v_mov_b32 v29, 0x80000000
  v_cmp_eq_u32 vcc, 0, v28
  v_mov_b32 v4, 0
  s_nop 0
  v_cndmask_b32 v4, v29, v4, vcc
  v_cmp_gt_u32 vcc, 32, v28
  s_nop 1
  v_cndmask_b32 v5, v29, v1, vcc
  s_cmp_eq_u32 s12, 0
  s_cbranch_scc1 reca_pw0_226
  s_cmp_eq_u32 s12, 1
  s_cbranch_scc1 reca_pw1_227
  s_cmp_eq_u32 s12, 2
  s_cbranch_scc1 reca_pw2_228
  s_branch reca_pw3_229
reca_pw0_226:
  s_mov_b32 s17, 0
  s_mov_b32 s26, 0
  s_mul_i32 s20, s17, 40960
  s_add_u32 s20, s20, 87556096
  s_add_u32 m0, s26, 0
  s_nop 0
  buffer_load_dwordx4 v1, s[4:7], s20 offen offset:0 lds
  buffer_load_dwordx4 v1, s[4:7], s20 offen offset:1024 lds
  buffer_load_dwordx4 v1, s[4:7], s20 offen offset:2048 lds
  buffer_load_dwordx4 v1, s[4:7], s20 offen offset:3072 lds
  s_add_u32 s20, s20, 4096
  s_add_u32 m0, s26, 4096
  s_nop 0
  buffer_load_dwordx4 v1, s[4:7], s20 offen offset:0 lds
  buffer_load_dwordx4 v1, s[4:7], s20 offen offset:1024 lds
  buffer_load_dwordx4 v1, s[4:7], s20 offen offset:2048 lds
  buffer_load_dwordx4 v1, s[4:7], s20 offen offset:3072 lds
  s_add_u32 s20, s20, 4096
  s_add_u32 m0, s26, 8192
  s_nop 0
  buffer_load_dwordx4 v1, s[4:7], s20 offen offset:0 lds
  buffer_load_dwordx4 v1, s[4:7], s20 offen offset:1024 lds
  s_lshl_b32 s34, s15, 4
  s_and_b32 s35, s17, 15
  s_add_u32 s34, s34, s35
  s_mul_i32 s34, s34, 12288
  s_mul_i32 s35, s16, 3072
  s_add_u32 s35, s35, s34
  s_add_u32 s27, s35, 37748736
  s_add_u32 s30, s35, 50331648
  s_mul_i32 s35, s16, 6144
  s_add_u32 s35, s35, s34
  s_add_u32 s28, s35, 44040192
  s_add_u32 s34, s27, 0
  buffer_load_dwordx4 v[16:19], v1, s[4:7], s34 offen sc1
  s_add_u32 s34, s27, 6144
  buffer_load_dwordx4 v[16:19], v1, s[4:7], s34 offen sc1
  s_add_u32 s34, s27, 1024
  buffer_load_dwordx4 v[16:19], v1, s[4:7], s34 offen sc1
  s_add_u32 s34, s27, 7168
  buffer_load_dwordx4 v[16:19], v1, s[4:7], s34 offen sc1
  s_add_u32 s34, s28, 0
  buffer_load_dwordx4 v[16:19], v1, s[4:7], s34 offen sc1
  s_and_b32 s34, s17, 15
  s_lshl_b32 s34, s34, 5
  s_add_u32 s34, s34, s15
  s_mul_i32 s34, s34, 3072
  s_mul_i32 s35, s16, 1536
  s_add_u32 s34, s34, s35
  s_add_u32 s35, s34, 56623104
  buffer_load_dwordx4 v[16:19], v1, s[4:7], s35 offen sc1
  buffer_load_dwordx4 v[16:19], v5, s[4:7], s35 offen offset:1024 sc1
  s_add_u32 s35, s34, 58195968
  buffer_load_dwordx4 v[16:19], v1, s[4:7], s35 offen sc1
  buffer_load_dwordx4 v[16:19], v5, s[4:7], s35 offen offset:1024 sc1
  s_mul_i32 s34, s15, 12
  s_mul_i32 s35, s16, 6
  s_add_u32 s34, s34, s35
  s_add_u32 s34, s34, 0
  s_mul_i32 s34, s34, 20480
  s_add_u32 s34, s34, 14155776
  buffer_load_dwordx4 a[0:3], v1, s[4:7], s34 offen offset:0
  buffer_load_dwordx4 a[4:7], v1, s[4:7], s34 offen offset:1024
  buffer_load_dwordx4 a[8:11], v1, s[4:7], s34 offen offset:2048
  buffer_load_dwordx4 a[12:15], v1, s[4:7], s34 offen offset:3072
  s_add_u32 s34, s34, 4096
  buffer_load_dwordx4 a[16:19], v1, s[4:7], s34 offen offset:0
  buffer_load_dwordx4 a[20:23], v1, s[4:7], s34 offen offset:1024
  buffer_load_dwordx4 a[24:27], v1, s[4:7], s34 offen offset:2048
  buffer_load_dwordx4 a[28:31], v1, s[4:7], s34 offen offset:3072
  s_add_u32 s34, s34, 4096
  buffer_load_dwordx4 a[32:35], v1, s[4:7], s34 offen offset:0
  buffer_load_dwordx4 a[36:39], v1, s[4:7], s34 offen offset:1024
  buffer_load_dwordx4 a[40:43], v1, s[4:7], s34 offen offset:2048
  buffer_load_dwordx4 a[44:47], v1, s[4:7], s34 offen offset:3072
  s_add_u32 s34, s34, 4096
  buffer_load_dwordx4 a[48:51], v1, s[4:7], s34 offen offset:0
  buffer_load_dwordx4 a[52:55], v1, s[4:7], s34 offen offset:1024
  buffer_load_dwordx4 a[56:59], v1, s[4:7], s34 offen offset:2048
  buffer_load_dwordx4 a[60:63], v1, s[4:7], s34 offen offset:3072
  s_add_u32 s34, s34, 4096
  buffer_load_dwordx4 a[64:67], v1, s[4:7], s34 offen offset:0
  buffer_load_dwordx4 a[68:71], v1, s[4:7], s34 offen offset:1024
  buffer_load_dwordx4 a[72:75], v1, s[4:7], s34 offen offset:2048
  buffer_load_dwordx4 a[76:79], v1, s[4:7], s34 offen offset:3072
  s_mul_i32 s34, s15, 12
  s_mul_i32 s35, s16, 6
  s_add_u32 s34, s34, s35
  s_add_u32 s34, s34, 1
  s_mul_i32 s34, s34, 20480
  s_add_u32 s34, s34, 14155776
  buffer_load_dwordx4 a[80:83], v1, s[4:7], s34 offen offset:0
  buffer_load_dwordx4 a[84:87], v1, s[4:7], s34 offen offset:1024
  buffer_load_dwordx4 a[88:91], v1, s[4:7], s34 offen offset:2048
  buffer_load_dwordx4 a[92:95], v1, s[4:7], s34 offen offset:3072
  s_add_u32 s34, s34, 4096
  buffer_load_dwordx4 a[96:99], v1, s[4:7], s34 offen offset:0
  buffer_load_dwordx4 a[100:103], v1, s[4:7], s34 offen offset:1024
  buffer_load_dwordx4 a[104:107], v1, s[4:7], s34 offen offset:2048
  buffer_load_dwordx4 a[108:111], v1, s[4:7], s34 offen offset:3072
  s_add_u32 s34, s34, 4096
  buffer_load_dwordx4 a[112:115], v1, s[4:7], s34 offen offset:0
  buffer_load_dwordx4 a[116:119], v1, s[4:7], s34 offen offset:1024
  buffer_load_dwordx4 a[120:123], v1, s[4:7], s34 offen offset:2048
  buffer_load_dwordx4 a[124:127], v1, s[4:7], s34 offen offset:3072
  s_add_u32 s34, s34, 4096
  buffer_load_dwordx4 a[128:131], v1, s[4:7], s34 offen offset:0
  buffer_load_dwordx4 a[132:135], v1, s[4:7], s34 offen offset:1024
  buffer_load_dwordx4 a[136:139], v1, s[4:7], s34 offen offset:2048
  buffer_load_dwordx4 a[140:143], v1, s[4:7], s34 offen offset:3072
  s_add_u32 s34, s34, 4096
  buffer_load_dwordx4 a[144:147], v1, s[4:7], s34 offen offset:0
  buffer_load_dwordx4 a[148:151], v1, s[4:7], s34 offen offset:1024
  buffer_load_dwordx4 a[152:155], v1, s[4:7], s34 offen offset:2048
  buffer_load_dwordx4 a[156:159], v1, s[4:7], s34 offen offset:3072
  s_waitcnt vmcnt(20)
  s_mul_i32 s34, s15, 12
  s_mul_i32 s35, s16, 6
  s_add_u32 s34, s34, s35
  s_add_u32 s34, s34, 2
  s_mul_i32 s34, s34, 20480
  s_add_u32 s34, s34, 14155776
  buffer_load_dwordx4 a[160:163], v1, s[4:7], s34 offen offset:0
  buffer_load_dwordx4 a[164:167], v1, s[4:7], s34 offen offset:1024
  buffer_load_dwordx4 a[168:171], v1, s[4:7], s34 offen offset:2048
  buffer_load_dwordx4 a[172:175], v1, s[4:7], s34 offen offset:3072
  s_add_u32 s34, s34, 4096
  buffer_load_dwordx4 a[176:179], v1, s[4:7], s34 offen offset:0
  buffer_load_dwordx4 a[180:183], v1, s[4:7], s34 offen offset:1024
  buffer_load_dwordx4 a[184:187], v1, s[4:7], s34 offen offset:2048
  buffer_load_dwordx4 a[188:191], v1, s[4:7], s34 offen offset:3072
  s_add_u32 s34, s34, 4096
  buffer_load_dwordx4 a[192:195], v1, s[4:7], s34 offen offset:0
  buffer_load_dwordx4 a[196:199], v1, s[4:7], s34 offen offset:1024
  buffer_load_dwordx4 a[200:203], v1, s[4:7], s34 offen offset:2048
  buffer_load_dwordx4 a[204:207], v1, s[4:7], s34 offen offset:3072
  s_add_u32 s34, s34, 4096
  buffer_load_dwordx4 a[208:211], v1, s[4:7], s34 offen offset:0
  buffer_load_dwordx4 a[212:215], v1, s[4:7], s34 offen offset:1024
  buffer_load_dwordx4 a[216:219], v1, s[4:7], s34 offen offset:2048
  buffer_load_dwordx4 a[220:223], v1, s[4:7], s34 offen offset:3072
  s_add_u32 s34, s34, 4096
  buffer_load_dwordx4 a[224:227], v1, s[4:7], s34 offen offset:0
  buffer_load_dwordx4 a[228:231], v1, s[4:7], s34 offen offset:1024
  buffer_load_dwordx4 a[232:235], v1, s[4:7], s34 offen offset:2048
  buffer_load_dwordx4 a[236:239], v1, s[4:7], s34 offen offset:3072
  s_waitcnt vmcnt(20)
  s_mul_i32 s34, s15, 12
  s_mul_i32 s35, s16, 6
  s_add_u32 s34, s34, s35
  s_add_u32 s34, s34, 3
  s_mul_i32 s34, s34, 20480
  s_add_u32 s34, s34, 14155776
  buffer_load_dwordx4 v[96:99], v1, s[4:7], s34 offen offset:0
  buffer_load_dwordx4 v[100:103], v1, s[4:7], s34 offen offset:1024
  buffer_load_dwordx4 v[104:107], v1, s[4:7], s34 offen offset:2048
  buffer_load_dwordx4 v[108:111], v1, s[4:7], s34 offen offset:3072
  s_add_u32 s34, s34, 4096
  buffer_load_dwordx4 v[112:115], v1, s[4:7], s34 offen offset:0
  buffer_load_dwordx4 v[116:119], v1, s[4:7], s34 offen offset:1024
  buffer_load_dwordx4 v[120:123], v1, s[4:7], s34 offen offset:2048
  buffer_load_dwordx4 v[124:127], v1, s[4:7], s34 offen offset:3072
  s_add_u32 s34, s34, 4096
  buffer_load_dwordx4 v[128:131], v1, s[4:7], s34 offen offset:0
  buffer_load_dwordx4 v[132:135], v1, s[4:7], s34 offen offset:1024
  buffer_load_dwordx4 v[136:139], v1, s[4:7], s34 offen offset:2048
  buffer_load_dwordx4 v[140:143], v1, s[4:7], s34 offen offset:3072
  s_add_u32 s34, s34, 4096
  buffer_load_dwordx4 v[144:147], v1, s[4:7], s34 offen offset:0
  buffer_load_dwordx4 v[148:151], v1, s[4:7], s34 offen offset:1024
  buffer_load_dwordx4 v[152:155], v1, s[4:7], s34 offen offset:2048
  buffer_load_dwordx4 v[156:159], v1, s[4:7], s34 offen offset:3072
  s_add_u32 s34, s34, 4096
  buffer_load_dwordx4 v[160:163], v1, s[4:7], s34 offen offset:0
  buffer_load_dwordx4 v[164:167], v1, s[4:7], s34 offen offset:1024
  buffer_load_dwordx4 v[168:171], v1, s[4:7], s34 offen offset:2048
  buffer_load_dwordx4 v[172:175], v1, s[4:7], s34 offen offset:3072
  s_waitcnt vmcnt(20)
  s_mul_i32 s34, s15, 12
  s_mul_i32 s35, s16, 6
  s_add_u32 s34, s34, s35
  s_add_u32 s34, s34, 0
  s_mul_i32 s34, s34, 20480
  s_add_u32 s34, s34, 22020096
  buffer_load_dwordx4 v[176:179], v1, s[4:7], s34 offen offset:0
  buffer_load_dwordx4 v[180:183], v1, s[4:7], s34 offen offset:1024
  buffer_load_dwordx4 v[184:187], v1, s[4:7], s34 offen offset:2048
  buffer_load_dwordx4 v[188:191], v1, s[4:7], s34 offen offset:3072
  s_add_u32 s34, s34, 4096
  buffer_load_dwordx4 v[192:195], v1, s[4:7], s34 offen offset:0
  buffer_load_dwordx4 v[196:199], v1, s[4:7], s34 offen offset:1024
  buffer_load_dwordx4 v[200:203], v1, s[4:7], s34 offen offset:2048
  buffer_load_dwordx4 v[204:207], v1, s[4:7], s34 offen offset:3072
  s_add_u32 s34, s34, 4096
  buffer_load_dwordx4 v[208:211], v1, s[4:7], s34 offen offset:0
  buffer_load_dwordx4 v[212:215], v1, s[4:7], s34 offen offset:1024
  buffer_load_dwordx4 v[216:219], v1, s[4:7], s34 offen offset:2048
  buffer_load_dwordx4 v[220:223], v1, s[4:7], s34 offen offset:3072
  s_add_u32 s34, s34, 4096
  buffer_load_dwordx4 v[224:227], v1, s[4:7], s34 offen offset:0
  buffer_load_dwordx4 v[228:231], v1, s[4:7], s34 offen offset:1024
  buffer_load_dwordx4 v[232:235], v1, s[4:7], s34 offen offset:2048
  buffer_load_dwordx4 v[236:239], v1, s[4:7], s34 offen offset:3072
  s_add_u32 s34, s34, 4096
  buffer_load_dwordx4 v[240:243], v1, s[4:7], s34 offen offset:0
  buffer_load_dwordx4 v[244:247], v1, s[4:7], s34 offen offset:1024
  buffer_load_dwordx4 v[248:251], v1, s[4:7], s34 offen offset:2048
  buffer_load_dwordx4 v[252:255], v1, s[4:7], s34 offen offset:3072
  s_waitcnt vmcnt(20)
  v_and_b32 v30, 7, v0
  v_lshlrev_b32 v30, 3, v30
reca_cens230:
  buffer_load_dwordx2 v[28:29], v30, s[8:11], 0 offen sc1
  s_waitcnt vmcnt(0)
  v_sad_u8 v31, v28, 0, 0
  v_sad_u8 v31, v29, 0, v31
  v_cmp_gt_u32 vcc, 32, v31
  s_cbranch_vccz reca_censok231
  s_sleep 8
  s_sub_u32 s18, s18, 1
  s_cbranch_scc0 reca_cens230
  s_mov_b32 s18, 0
reca_censok231:
  v_and_b32 v28, 0x20202020, v28
  v_and_b32 v29, 0x20202020, v29
  v_cmp_ne_u32 s[34:35], 0, v28
  v_cmp_ne_u32 s[36:37], 0, v29
  s_nop 3
  s_and_b32 s34, s34, 0xff
  s_and_b32 s36, s36, 0xff
  s_or_b32 s35, s34, s36
  s_lshr_b32 s37, s35, s13
  s_and_b32 s37, s37, 1
  s_xor_b32 s43, s37, 1
  s_cmp_eq_u32 s57, 0
  s_cselect_b32 s58, s36, s34
  v_mov_b32 v31, 0x80000000
  s_cmp_lg_u32 s43, 0
  s_cbranch_scc1 reca_pslow232
reca_ptop233:
  s_cmp_lt_u32 s17, 6
  s_cbranch_scc1 reca_pgo234
  s_sub_u32 s36, s17, 6
reca_ppoll235:
  buffer_load_dword v28, v4, s[4:7], s25 offen sc1
  s_waitcnt vmcnt(0)
  v_readfirstlane_b32 s34, v28
  s_nop 3
  s_cmp_ge_i32 s34, s36
  s_cbranch_scc1 reca_pgo234
  s_sleep 8
  s_sub_u32 s18, s18, 1
  s_cbranch_scc0 reca_ppoll235
  s_mov_b32 s18, 0
reca_pgo234:
  s_waitcnt vmcnt(0)
  s_barrier
  v_add_u32 v7, s26, v1
  s_xor_b32 s26, s26, 40960
  s_add_u32 s37, s17, 1
  s_cmp_ge_u32 s37, 64
  s_cbranch_scc1 reca_pnodma236
  s_mul_i32 s20, s37, 40960
  s_add_u32 s20, s20, 87556096
  s_add_u32 m0, s26, 0
  s_nop 0
  buffer_load_dwordx4 v1, s[4:7], s20 offen offset:0 lds
  buffer_load_dwordx4 v1, s[4:7], s20 offen offset:1024 lds
  buffer_load_dwordx4 v1, s[4:7], s20 offen offset:2048 lds
  buffer_load_dwordx4 v1, s[4:7], s20 offen offset:3072 lds
  s_add_u32 s20, s20, 4096
  s_add_u32 m0, s26, 4096
  s_nop 0
  buffer_load_dwordx4 v1, s[4:7], s20 offen offset:0 lds
  buffer_load_dwordx4 v1, s[4:7], s20 offen offset:1024 lds
  buffer_load_dwordx4 v1, s[4:7], s20 offen offset:2048 lds
  buffer_load_dwordx4 v1, s[4:7], s20 offen offset:3072 lds
  s_add_u32 s20, s20, 4096
  s_add_u32 m0, s26, 8192
  s_nop 0
  buffer_load_dwordx4 v1, s[4:7], s20 offen offset:0 lds
  buffer_load_dwordx4 v1, s[4:7], s20 offen offset:1024 lds
  s_lshl_b32 s34, s15, 4
  s_and_b32 s35, s37, 15
  s_add_u32 s34, s34, s35
  s_mul_i32 s34, s34, 12288
  s_mul_i32 s35, s16, 3072
  s_add_u32 s35, s35, s34
  s_add_u32 s27, s35, 37748736
  s_add_u32 s30, s35, 50331648
  s_mul_i32 s35, s16, 6144
  s_add_u32 s35, s35, s34
  s_add_u32 s28, s35, 44040192
  s_add_u32 s34, s27, 0
  buffer_load_dwordx4 v[16:19], v1, s[4:7], s34 offen sc1
  s_add_u32 s34, s27, 6144
  buffer_load_dwordx4 v[16:19], v1, s[4:7], s34 offen sc1
  s_add_u32 s34, s27, 1024
  buffer_load_dwordx4 v[16:19], v1, s[4:7], s34 offen sc1
  s_add_u32 s34, s27, 7168
  buffer_load_dwordx4 v[16:19], v1, s[4:7], s34 offen sc1
  s_add_u32 s34, s28, 0
  buffer_load_dwordx4 v[16:19], v1, s[4:7], s34 offen sc1
  s_and_b32 s34, s37, 15
  s_lshl_b32 s34, s34, 5
  s_add_u32 s34, s34, s15
  s_mul_i32 s34, s34, 3072
  s_mul_i32 s35, s16, 1536
  s_add_u32 s34, s34, s35
  s_add_u32 s35, s34, 56623104
  buffer_load_dwordx4 v[16:19], v1, s[4:7], s35 offen sc1
  buffer_load_dwordx4 v[16:19], v5, s[4:7], s35 offen offset:1024 sc1
  s_add_u32 s35, s34, 58195968
  buffer_load_dwordx4 v[16:19], v1, s[4:7], s35 offen sc1
  buffer_load_dwordx4 v[16:19], v5, s[4:7], s35 offen offset:1024 sc1
reca_pnodma236:
  s_lshl_b32 s34, s15, 4
  s_and_b32 s35, s17, 15
  s_add_u32 s34, s34, s35
  s_mul_i32 s34, s34, 12288
  s_mul_i32 s35, s16, 3072
  s_add_u32 s35, s35, s34
  s_add_u32 s21, s35, 37748736
  s_add_u32 s22, s35, 50331648
  s_mul_i32 s35, s16, 6144
  s_add_u32 s35, s35, s34
  s_add_u32 s23, s35, 44040192
  ds_read_b128 v[72:75], v7 offset:0
  ds_read_b128 v[76:79], v7 offset:20480
  ds_read_b128 v[80:83], v7 offset:1024
  ds_read_b128 v[84:87], v7 offset:21504
  ds_read_b128 v[88:91], v7 offset:2048
  ds_read_b128 v[92:95], v7 offset:22528
  s_waitcnt lgkmcnt(4)
  v_mfma_f32_16x16x32_bf16 v[32:35], a[0:3], v[72:75], 0
  v_mfma_f32_16x16x32_bf16 v[36:39], a[0:3], v[76:79], 0
  v_mfma_f32_16x16x32_bf16 v[40:43], a[80:83], v[72:75], 0
  v_mfma_f32_16x16x32_bf16 v[44:47], a[80:83], v[76:79], 0
  v_mfma_f32_16x16x32_bf16 v[48:51], a[160:163], v[72:75], 0
  v_mfma_f32_16x16x32_bf16 v[52:55], a[160:163], v[76:79], 0
  v_mfma_f32_16x16x32_bf16 v[56:59], v[96:99], v[72:75], 0
  v_mfma_f32_16x16x32_bf16 v[60:63], v[96:99], v[76:79], 0
  v_mfma_f32_16x16x32_bf16 v[64:67], v[72:75], v[176:179], 0
  v_mfma_f32_16x16x32_bf16 v[68:71], v[76:79], v[176:179], 0
  ds_read_b128 v[72:75], v7 offset:3072
  ds_read_b128 v[76:79], v7 offset:23552
  s_waitcnt lgkmcnt(4)
  v_mfma_f32_16x16x32_bf16 v[32:35], a[4:7], v[80:83], v[32:35]
  v_mfma_f32_16x16x32_bf16 v[36:39], a[4:7], v[84:87], v[36:39]
  v_mfma_f32_16x16x32_bf16 v[40:43], a[84:87], v[80:83], v[40:43]
  v_mfma_f32_16x16x32_bf16 v[44:47], a[84:87], v[84:87], v[44:47]
  v_mfma_f32_16x16x32_bf16 v[48:51], a[164:167], v[80:83], v[48:51]
  v_mfma_f32_16x16x32_bf16 v[52:55], a[164:167], v[84:87], v[52:55]
  v_mfma_f32_16x16x32_bf16 v[56:59], v[100:103], v[80:83], v[56:59]
  v_mfma_f32_16x16x32_bf16 v[60:63], v[100:103], v[84:87], v[60:63]
  v_mfma_f32_16x16x32_bf16 v[64:67], v[80:83], v[180:183], v[64:67]
  v_mfma_f32_16x16x32_bf16 v[68:71], v[84:87], v[180:183], v[68:71]
  ds_read_b128 v[80:83], v7 offset:4096
  ds_read_b128 v[84:87], v7 offset:24576
  s_waitcnt lgkmcnt(4)
  v_mfma_f32_16x16x32_bf16 v[32:35], a[8:11], v[88:91], v[32:35]
  v_mfma_f32_16x16x32_bf16 v[36:39], a[8:11], v[92:95], v[36:39]
  v_mfma_f32_16x16x32_bf16 v[40:43], a[88:91], v[88:91], v[40:43]
  v_mfma_f32_16x16x32_bf16 v[44:47], a[88:91], v[92:95], v[44:47]
  v_mfma_f32_16x16x32_bf16 v[48:51], a[168:171], v[88:91], v[48:51]
  v_mfma_f32_16x16x32_bf16 v[52:55], a[168:171], v[92:95], v[52:55]
  v_mfma_f32_16x16x32_bf16 v[56:59], v[104:107], v[88:91], v[56:59]
  v_mfma_f32_16x16x32_bf16 v[60:63], v[104:107], v[92:95], v[60:63]
  v_mfma_f32_16x16x32_bf16 v[64:67], v[88:91], v[184:187], v[64:67]
  v_mfma_f32_16x16x32_bf16 v[68:71], v[92:95], v[184:187], v[68:71]
  ds_read_b128 v[88:91], v7 offset:5120
  ds_read_b128 v[92:95], v7 offset:25600
  s_waitcnt lgkmcnt(4)
  v_mfma_f32_16x16x32_bf16 v[32:35], a[12:15], v[72:75], v[32:35]
  v_mfma_f32_16x16x32_bf16 v[36:39], a[12:15], v[76:79], v[36:39]
  v_mfma_f32_16x16x32_bf16 v[40:43], a[92:95], v[72:75], v[40:43]
  v_mfma_f32_16x16x32_bf16 v[44:47], a[92:95], v[76:79], v[44:47]
  v_mfma_f32_16x16x32_bf16 v[48:51], a[172:175], v[72:75], v[48:51]
  v_mfma_f32_16x16x32_bf16 v[52:55], a[172:175], v[76:79], v[52:55]
  v_mfma_f32_16x16x32_bf16 v[56:59], v[108:111], v[72:75], v[56:59]
  v_mfma_f32_16x16x32_bf16 v[60:63], v[108:111], v[76:79], v[60:63]
  v_mfma_f32_16x16x32_bf16 v[64:67], v[72:75], v[188:191], v[64:67]
  v_mfma_f32_16x16x32_bf16 v[68:71], v[76:79], v[188:191], v[68:71]
  ds_read_b128 v[72:75], v7 offset:6144
  ds_read_b128 v[76:79], v7 offset:26624
  s_waitcnt lgkmcnt(4)
  v_mfma_f32_16x16x32_bf16 v[32:35], a[16:19], v[80:83], v[32:35]
  v_mfma_f32_16x16x32_bf16 v[36:39], a[16:19], v[84:87], v[36:39]
  v_mfma_f32_16x16x32_bf16 v[40:43], a[96:99], v[80:83], v[40:43]
  v_mfma_f32_16x16x32_bf16 v[44:47], a[96:99], v[84:87], v[44:47]
  v_mfma_f32_16x16x32_bf16 v[48:51], a[176:179], v[80:83], v[48:51]
  v_mfma_f32_16x16x32_bf16 v[52:55], a[176:179], v[84:87], v[52:55]
  v_mfma_f32_16x16x32_bf16 v[56:59], v[112:115], v[80:83], v[56:59]
  v_mfma_f32_16x16x32_bf16 v[60:63], v[112:115], v[84:87], v[60:63]
  v_mfma_f32_16x16x32_bf16 v[64:67], v[80:83], v[192:195], v[64:67]
  v_mfma_f32_16x16x32_bf16 v[68:71], v[84:87], v[192:195], v[68:71]
  ds_read_b128 v[80:83], v7 offset:7168
  ds_read_b128 v[84:87], v7 offset:27648
  s_waitcnt lgkmcnt(4)
  v_mfma_f32_16x16x32_bf16 v[32:35], a[20:23], v[88:91], v[32:35]
  v_mfma_f32_16x16x32_bf16 v[36:39], a[20:23], v[92:95], v[36:39]
  v_mfma_f32_16x16x32_bf16 v[40:43], a[100:103], v[88:91], v[40:43]
  v_mfma_f32_16x16x32_bf16 v[44:47], a[100:103], v[92:95], v[44:47]
  v_mfma_f32_16x16x32_bf16 v[48:51], a[180:183], v[88:91], v[48:51]
  v_mfma_f32_16x16x32_bf16 v[52:55], a[180:183], v[92:95], v[52:55]
  v_mfma_f32_16x16x32_bf16 v[56:59], v[116:119], v[88:91], v[56:59]
  v_mfma_f32_16x16x32_bf16 v[60:63], v[116:119], v[92:95], v[60:63]
  v_mfma_f32_16x16x32_bf16 v[64:67], v[88:91], v[196:199], v[64:67]
  v_mfma_f32_16x16x32_bf16 v[68:71], v[92:95], v[196:199], v[68:71]
  ds_read_b128 v[88:91], v7 offset:8192
  ds_read_b128 v[92:95], v7 offset:28672
  s_waitcnt lgkmcnt(4)
  v_mfma_f32_16x16x32_bf16 v[32:35], a[24:27], v[72:75], v[32:35]
  v_mfma_f32_16x16x32_bf16 v[36:39], a[24:27], v[76:79], v[36:39]
  v_mfma_f32_16x16x32_bf16 v[40:43], a[104:107], v[72:75], v[40:43]
  v_mfma_f32_16x16x32_bf16 v[44:47], a[104:107], v[76:79], v[44:47]
  v_mfma_f32_16x16x32_bf16 v[48:51], a[184:187], v[72:75], v[48:51]
  v_mfma_f32_16x16x32_bf16 v[52:55], a[184:187], v[76:79], v[52:55]
  v_mfma_f32_16x16x32_bf16 v[56:59], v[120:123], v[72:75], v[56:59]
  v_mfma_f32_16x16x32_bf16 v[60:63], v[120:123], v[76:79], v[60:63]
  v_mfma_f32_16x16x32_bf16 v[64:67], v[72:75], v[200:203], v[64:67]
  v_mfma_f32_16x16x32_bf16 v[68:71], v[76:79], v[200:203], v[68:71]
  ds_read_b128 v[72:75], v7 offset:9216
  ds_read_b128 v[76:79], v7 offset:29696
  s_waitcnt lgkmcnt(4)
  v_mfma_f32_16x16x32_bf16 v[32:35], a[28:31], v[80:83], v[32:35]
  v_mfma_f32_16x16x32_bf16 v[36:39], a[28:31], v[84:87], v[36:39]
  v_mfma_f32_16x16x32_bf16 v[40:43], a[108:111], v[80:83], v[40:43]
  v_mfma_f32_16x16x32_bf16 v[44:47], a[108:111], v[84:87], v[44:47]
  v_mfma_f32_16x16x32_bf16 v[48:51], a[188:191], v[80:83], v[48:51]
  v_mfma_f32_16x16x32_bf16 v[52:55], a[188:191], v[84:87], v[52:55]
  v_mfma_f32_16x16x32_bf16 v[56:59], v[124:127], v[80:83], v[56:59]
  v_mfma_f32_16x16x32_bf16 v[60:63], v[124:127], v[84:87], v[60:63]
  v_mfma_f32_16x16x32_bf16 v[64:67], v[80:83], v[204:207], v[64:67]
  v_mfma_f32_16x16x32_bf16 v[68:71], v[84:87], v[204:207], v[68:71]
  ds_read_b128 v[80:83], v7 offset:10240
  ds_read_b128 v[84:87], v7 offset:30720
  s_waitcnt lgkmcnt(4)
  v_mfma_f32_16x16x32_bf16 v[32:35], a[32:35], v[88:91], v[32:35]
  v_mfma_f32_16x16x32_bf16 v[36:39], a[32:35], v[92:95], v[36:39]
  v_mfma_f32_16x16x32_bf16 v[40:43], a[112:115], v[88:91], v[40:43]
  v_mfma_f32_16x16x32_bf16 v[44:47], a[112:115], v[92:95], v[44:47]
  v_mfma_f32_16x16x32_bf16 v[48:51], a[192:195], v[88:91], v[48:51]
  v_mfma_f32_16x16x32_bf16 v[52:55], a[192:195], v[92:95], v[52:55]
  v_mfma_f32_16x16x32_bf16 v[56:59], v[128:131], v[88:91], v[56:59]
  v_mfma_f32_16x16x32_bf16 v[60:63], v[128:131], v[92:95], v[60:63]
  v_mfma_f32_16x16x32_bf16 v[64:67], v[88:91], v[208:211], v[64:67]
  v_mfma_f32_16x16x32_bf16 v[68:71], v[92:95], v[208:211], v[68:71]
  ds_read_b128 v[88:91], v7 offset:11264
  ds_read_b128 v[92:95], v7 offset:31744
  s_waitcnt lgkmcnt(4)
  v_mfma_f32_16x16x32_bf16 v[32:35], a[36:39], v[72:75], v[32:35]
  v_mfma_f32_16x16x32_bf16 v[36:39], a[36:39], v[76:79], v[36:39]
  v_mfma_f32_16x16x32_bf16 v[40:43], a[116:119], v[72:75], v[40:43]
  v_mfma_f32_16x16x32_bf16 v[44:47], a[116:119], v[76:79], v[44:47]
  v_mfma_f32_16x16x32_bf16 v[48:51], a[196:199], v[72:75], v[48:51]
  v_mfma_f32_16x16x32_bf16 v[52:55], a[196:199], v[76:79], v[52:55]
  v_mfma_f32_16x16x32_bf16 v[56:59], v[132:135], v[72:75], v[56:59]
  v_mfma_f32_16x16x32_bf16 v[60:63], v[132:135], v[76:79], v[60:63]
  v_mfma_f32_16x16x32_bf16 v[64:67], v[72:75], v[212:215], v[64:67]
  v_mfma_f32_16x16x32_bf16 v[68:71], v[76:79], v[212:215], v[68:71]
  ds_read_b128 v[72:75], v7 offset:12288
  ds_read_b128 v[76:79], v7 offset:32768
  s_waitcnt lgkmcnt(4)
  v_mfma_f32_16x16x32_bf16 v[32:35], a[40:43], v[80:83], v[32:35]
  v_mfma_f32_16x16x32_bf16 v[36:39], a[40:43], v[84:87], v[36:39]
  v_mfma_f32_16x16x32_bf16 v[40:43], a[120:123], v[80:83], v[40:43]
  v_mfma_f32_16x16x32_bf16 v[44:47], a[120:123], v[84:87], v[44:47]
  v_mfma_f32_16x16x32_bf16 v[48:51], a[200:203], v[80:83], v[48:51]
  v_mfma_f32_16x16x32_bf16 v[52:55], a[200:203], v[84:87], v[52:55]
  v_mfma_f32_16x16x32_bf16 v[56:59], v[136:139], v[80:83], v[56:59]
  v_mfma_f32_16x16x32_bf16 v[60:63], v[136:139], v[84:87], v[60:63]
  v_mfma_f32_16x16x32_bf16 v[64:67], v[80:83], v[216:219], v[64:67]
  v_mfma_f32_16x16x32_bf16 v[68:71], v[84:87], v[216:219], v[68:71]
  ds_read_b128 v[80:83], v7 offset:13312
  ds_read_b128 v[84:87], v7 offset:33792
  s_waitcnt lgkmcnt(4)
  v_mfma_f32_16x16x32_bf16 v[32:35], a[44:47], v[88:91], v[32:35]
  v_mfma_f32_16x16x32_bf16 v[36:39], a[44:47], v[92:95], v[36:39]
  v_mfma_f32_16x16x32_bf16 v[40:43], a[124:127], v[88:91], v[40:43]
  v_mfma_f32_16x16x32_bf16 v[44:47], a[124:127], v[92:95], v[44:47]
  v_mfma_f32_16x16x32_bf16 v[48:51], a[204:207], v[88:91], v[48:51]
  v_mfma_f32_16x16x32_bf16 v[52:55], a[204:207], v[92:95], v[52:55]
  v_mfma_f32_16x16x32_bf16 v[56:59], v[140:143], v[88:91], v[56:59]
  v_mfma_f32_16x16x32_bf16 v[60:63], v[140:143], v[92:95], v[60:63]
  v_mfma_f32_16x16x32_bf16 v[64:67], v[88:91], v[220:223], v[64:67]
  v_mfma_f32_16x16x32_bf16 v[68:71], v[92:95], v[220:223], v[68:71]
  ds_read_b128 v[88:91], v7 offset:14336
  ds_read_b128 v[92:95], v7 offset:34816
  s_waitcnt lgkmcnt(4)
  v_mfma_f32_16x16x32_bf16 v[32:35], a[48:51], v[72:75], v[32:35]
  v_mfma_f32_16x16x32_bf16 v[36:39], a[48:51], v[76:79], v[36:39]
  v_mfma_f32_16x16x32_bf16 v[40:43], a[128:131], v[72:75], v[40:43]
  v_mfma_f32_16x16x32_bf16 v[44:47], a[128:131], v[76:79], v[44:47]
  v_mfma_f32_16x16x32_bf16 v[48:51], a[208:211], v[72:75], v[48:51]
  v_mfma_f32_16x16x32_bf16 v[52:55], a[208:211], v[76:79], v[52:55]
  v_mfma_f32_16x16x32_bf16 v[56:59], v[144:147], v[72:75], v[56:59]
  v_mfma_f32_16x16x32_bf16 v[60:63], v[144:147], v[76:79], v[60:63]
  v_mfma_f32_16x16x32_bf16 v[64:67], v[72:75], v[224:227], v[64:67]
  v_mfma_f32_16x16x32_bf16 v[68:71], v[76:79], v[224:227], v[68:71]
  ds_read_b128 v[72:75], v7 offset:15360
  ds_read_b128 v[76:79], v7 offset:35840
  s_waitcnt lgkmcnt(4)
  v_mfma_f32_16x16x32_bf16 v[32:35], a[52:55], v[80:83], v[32:35]
  v_mfma_f32_16x16x32_bf16 v[36:39], a[52:55], v[84:87], v[36:39]
  v_mfma_f32_16x16x32_bf16 v[40:43], a[132:135], v[80:83], v[40:43]
  v_mfma_f32_16x16x32_bf16 v[44:47], a[132:135], v[84:87], v[44:47]
  v_mfma_f32_16x16x32_bf16 v[48:51], a[212:215], v[80:83], v[48:51]
  v_mfma_f32_16x16x32_bf16 v[52:55], a[212:215], v[84:87], v[52:55]
  v_mfma_f32_16x16x32_bf16 v[56:59], v[148:151], v[80:83], v[56:59]
  v_mfma_f32_16x16x32_bf16 v[60:63], v[148:151], v[84:87], v[60:63]
  v_mfma_f32_16x16x32_bf16 v[64:67], v[80:83], v[228:231], v[64:67]
  v_mfma_f32_16x16x32_bf16 v[68:71], v[84:87], v[228:231], v[68:71]
  ds_read_b128 v[80:83], v7 offset:16384
  ds_read_b128 v[84:87], v7 offset:36864
  s_waitcnt lgkmcnt(4)
  v_mfma_f32_16x16x32_bf16 v[32:35], a[56:59], v[88:91], v[32:35]
  v_mfma_f32_16x16x32_bf16 v[36:39], a[56:59], v[92:95], v[36:39]
  v_mfma_f32_16x16x32_bf16 v[40:43], a[136:139], v[88:91], v[40:43]
  v_mfma_f32_16x16x32_bf16 v[44:47], a[136:139], v[92:95], v[44:47]
  v_mfma_f32_16x16x32_bf16 v[48:51], a[216:219], v[88:91], v[48:51]
  v_mfma_f32_16x16x32_bf16 v[52:55], a[216:219], v[92:95], v[52:55]
  v_mfma_f32_16x16x32_bf16 v[56:59], v[152:155], v[88:91], v[56:59]
  v_mfma_f32_16x16x32_bf16 v[60:63], v[152:155], v[92:95], v[60:63]
  v_mfma_f32_16x16x32_bf16 v[64:67], v[88:91], v[232:235], v[64:67]
  v_mfma_f32_16x16x32_bf16 v[68:71], v[92:95], v[232:235], v[68:71]
  ds_read_b128 v[88:91], v7 offset:17408
  ds_read_b128 v[92:95], v7 offset:37888
  s_waitcnt lgkmcnt(4)
  v_mfma_f32_16x16x32_bf16 v[32:35], a[60:63], v[72:75], v[32:35]
  v_mfma_f32_16x16x32_bf16 v[36:39], a[60:63], v[76:79], v[36:39]
  v_mfma_f32_16x16x32_bf16 v[40:43], a[140:143], v[72:75], v[40:43]
  v_mfma_f32_16x16x32_bf16 v[44:47], a[140:143], v[76:79], v[44:47]
  v_mfma_f32_16x16x32_bf16 v[48:51], a[220:223], v[72:75], v[48:51]
  v_mfma_f32_16x16x32_bf16 v[52:55], a[220:223], v[76:79], v[52:55]
  v_mfma_f32_16x16x32_bf16 v[56:59], v[156:159], v[72:75], v[56:59]
  v_mfma_f32_16x16x32_bf16 v[60:63], v[156:159], v[76:79], v[60:63]
  v_mfma_f32_16x16x32_bf16 v[64:67], v[72:75], v[236:239], v[64:67]
  v_mfma_f32_16x16x32_bf16 v[68:71], v[76:79], v[236:239], v[68:71]
  ds_read_b128 v[72:75], v7 offset:18432
  ds_read_b128 v[76:79], v7 offset:38912
  s_waitcnt lgkmcnt(4)
  v_mfma_f32_16x16x32_bf16 v[32:35], a[64:67], v[80:83], v[32:35]
  v_mfma_f32_16x16x32_bf16 v[36:39], a[64:67], v[84:87], v[36:39]
  v_mfma_f32_16x16x32_bf16 v[40:43], a[144:147], v[80:83], v[40:43]
  v_mfma_f32_16x16x32_bf16 v[44:47], a[144:147], v[84:87], v[44:47]
  v_mfma_f32_16x16x32_bf16 v[48:51], a[224:227], v[80:83], v[48:51]
  v_mfma_f32_16x16x32_bf16 v[52:55], a[224:227], v[84:87], v[52:55]
  v_mfma_f32_16x16x32_bf16 v[56:59], v[160:163], v[80:83], v[56:59]
  v_mfma_f32_16x16x32_bf16 v[60:63], v[160:163], v[84:87], v[60:63]
  v_mfma_f32_16x16x32_bf16 v[64:67], v[80:83], v[240:243], v[64:67]
  v_mfma_f32_16x16x32_bf16 v[68:71], v[84:87], v[240:243], v[68:71]
  ds_read_b128 v[80:83], v7 offset:19456
  ds_read_b128 v[84:87], v7 offset:39936
  s_waitcnt lgkmcnt(4)
  v_mfma_f32_16x16x32_bf16 v[32:35], a[68:71], v[88:91], v[32:35]
  v_mfma_f32_16x16x32_bf16 v[36:39], a[68:71], v[92:95], v[36:39]
  v_mfma_f32_16x16x32_bf16 v[40:43], a[148:151], v[88:91], v[40:43]
  v_mfma_f32_16x16x32_bf16 v[44:47], a[148:151], v[92:95], v[44:47]
  v_mfma_f32_16x16x32_bf16 v[48:51], a[228:231], v[88:91], v[48:51]
  v_mfma_f32_16x16x32_bf16 v[52:55], a[228:231], v[92:95], v[52:55]
  v_mfma_f32_16x16x32_bf16 v[56:59], v[164:167], v[88:91], v[56:59]
  v_mfma_f32_16x16x32_bf16 v[60:63], v[164:167], v[92:95], v[60:63]
  v_mfma_f32_16x16x32_bf16 v[64:67], v[88:91], v[244:247], v[64:67]
  v_mfma_f32_16x16x32_bf16 v[68:71], v[92:95], v[244:247], v[68:71]
  s_waitcnt lgkmcnt(2)
  v_mfma_f32_16x16x32_bf16 v[32:35], a[72:75], v[72:75], v[32:35]
  v_mfma_f32_16x16x32_bf16 v[36:39], a[72:75], v[76:79], v[36:39]
  v_mfma_f32_16x16x32_bf16 v[40:43], a[152:155], v[72:75], v[40:43]
  v_mfma_f32_16x16x32_bf16 v[44:47], a[152:155], v[76:79], v[44:47]
  v_mfma_f32_16x16x32_bf16 v[48:51], a[232:235], v[72:75], v[48:51]
  v_mfma_f32_16x16x32_bf16 v[52:55], a[232:235], v[76:79], v[52:55]
  v_mfma_f32_16x16x32_bf16 v[56:59], v[168:171], v[72:75], v[56:59]
  v_mfma_f32_16x16x32_bf16 v[60:63], v[168:171], v[76:79], v[60:63]
  v_mfma_f32_16x16x32_bf16 v[64:67], v[72:75], v[248:251], v[64:67]
  v_mfma_f32_16x16x32_bf16 v[68:71], v[76:79], v[248:251], v[68:71]
  s_waitcnt lgkmcnt(0)
  v_mfma_f32_16x16x32_bf16 v[32:35], a[76:79], v[80:83], v[32:35]
  v_mfma_f32_16x16x32_bf16 v[36:39], a[76:79], v[84:87], v[36:39]
  v_mfma_f32_16x16x32_bf16 v[40:43], a[156:159], v[80:83], v[40:43]
  v_mfma_f32_16x16x32_bf16 v[44:47], a[156:159], v[84:87], v[44:47]
  v_mfma_f32_16x16x32_bf16 v[48:51], a[236:239], v[80:83], v[48:51]
  v_mfma_f32_16x16x32_bf16 v[52:55], a[236:239], v[84:87], v[52:55]
  v_mfma_f32_16x16x32_bf16 v[56:59], v[172:175], v[80:83], v[56:59]
  v_mfma_f32_16x16x32_bf16 v[60:63], v[172:175], v[84:87], v[60:63]
  v_mfma_f32_16x16x32_bf16 v[64:67], v[80:83], v[252:255], v[64:67]
  v_mfma_f32_16x16x32_bf16 v[68:71], v[84:87], v[252:255], v[68:71]
  v_cvt_pk_bf16_f32 v8, v32, v33
  v_cvt_pk_bf16_f32 v9, v34, v35
  v_cvt_pk_bf16_f32 v10, v40, v41
  v_cvt_pk_bf16_f32 v11, v42, v43
  s_add_u32 s34, s21, 0
  buffer_store_dwordx4 v[8:11], v1, s[4:7], s34 offen
  v_cvt_pk_bf16_f32 v12, v36, v37
  v_cvt_pk_bf16_f32 v13, v38, v39
  v_cvt_pk_bf16_f32 v14, v44, v45
  v_cvt_pk_bf16_f32 v15, v46, v47
  s_add_u32 s34, s21, 6144
  buffer_store_dwordx4 v[12:15], v1, s[4:7], s34 offen
  v_cvt_pk_bf16_f32 v8, v48, v49
  v_cvt_pk_bf16_f32 v9, v50, v51
  v_cvt_pk_bf16_f32 v10, v56, v57
  v_cvt_pk_bf16_f32 v11, v58, v59
  s_add_u32 s34, s21, 1024
  buffer_store_dwordx4 v[8:11], v1, s[4:7], s34 offen
  v_cvt_pk_bf16_f32 v12, v52, v53
  v_cvt_pk_bf16_f32 v13, v54, v55
  v_cvt_pk_bf16_f32 v14, v60, v61
  v_cvt_pk_bf16_f32 v15, v62, v63
  s_add_u32 s34, s21, 7168
  buffer_store_dwordx4 v[12:15], v1, s[4:7], s34 offen
  v_cvt_pk_bf16_f32 v8, v64, v65
  v_cvt_pk_bf16_f32 v9, v66, v67
  v_cvt_pk_bf16_f32 v10, v68, v69
  v_cvt_pk_bf16_f32 v11, v70, v71
  s_add_u32 s34, s23, 0
  buffer_store_dwordx4 v[8:11], v1, s[4:7], s34 offen
  s_waitcnt vmcnt(0)
  s_barrier
  s_add_u32 s17, s17, 1
  v_mov_b32 v28, s17
  buffer_store_dword v28, v4, s[4:7], s24 offen
  s_cmp_lt_u32 s17, 64
  s_cbranch_scc1 reca_ptop233
  s_branch reca_exit1
reca_pslow232:
reca_ptop238:
  s_cmp_lt_u32 s17, 6
  s_cbranch_scc1 reca_pgo239
  s_sub_u32 s36, s17, 6
reca_ppoll240:
  buffer_load_dword v28, v4, s[4:7], s25 offen sc1
  s_waitcnt vmcnt(0)
  v_readfirstlane_b32 s34, v28
  s_nop 3
  s_cmp_ge_i32 s34, s36
  s_cbranch_scc1 reca_pgo239
  s_sleep 8
  s_sub_u32 s18, s18, 1
  s_cbranch_scc0 reca_ppoll240
  s_mov_b32 s18, 0
reca_pgo239:
  s_waitcnt vmcnt(0)
  s_barrier
  v_add_u32 v7, s26, v1
  s_xor_b32 s26, s26, 40960
  s_add_u32 s37, s17, 1
  s_cmp_ge_u32 s37, 64
  s_cbranch_scc1 reca_pnodma241
  s_mul_i32 s20, s37, 40960
  s_add_u32 s20, s20, 87556096
  s_add_u32 m0, s26, 0
  s_nop 0
  buffer_load_dwordx4 v1, s[4:7], s20 offen offset:0 lds
  buffer_load_dwordx4 v1, s[4:7], s20 offen offset:1024 lds
  buffer_load_dwordx4 v1, s[4:7], s20 offen offset:2048 lds
  buffer_load_dwordx4 v1, s[4:7], s20 offen offset:3072 lds
  s_add_u32 s20, s20, 4096
  s_add_u32 m0, s26, 4096
  s_nop 0
  buffer_load_dwordx4 v1, s[4:7], s20 offen offset:0 lds
  buffer_load_dwordx4 v1, s[4:7], s20 offen offset:1024 lds
  buffer_load_dwordx4 v1, s[4:7], s20 offen offset:2048 lds
  buffer_load_dwordx4 v1, s[4:7], s20 offen offset:3072 lds
  s_add_u32 s20, s20, 4096
  s_add_u32 m0, s26, 8192
  s_nop 0
  buffer_load_dwordx4 v1, s[4:7], s20 offen offset:0 lds
  buffer_load_dwordx4 v1, s[4:7], s20 offen offset:1024 lds
  s_lshl_b32 s34, s15, 4
  s_and_b32 s35, s37, 15
  s_add_u32 s34, s34, s35
  s_mul_i32 s34, s34, 12288
  s_mul_i32 s35, s16, 3072
  s_add_u32 s35, s35, s34
  s_add_u32 s27, s35, 37748736
  s_add_u32 s30, s35, 50331648
  s_mul_i32 s35, s16, 6144
  s_add_u32 s35, s35, s34
  s_add_u32 s28, s35, 44040192
  s_add_u32 s34, s27, 0
  buffer_load_dwordx4 v[16:19], v1, s[4:7], s34 offen sc1
  s_add_u32 s34, s27, 6144
  buffer_load_dwordx4 v[16:19], v1, s[4:7], s34 offen sc1
  s_add_u32 s34, s27, 1024
  buffer_load_dwordx4 v[16:19], v1, s[4:7], s34 offen sc1
  s_add_u32 s34, s27, 7168
  buffer_load_dwordx4 v[16:19], v1, s[4:7], s34 offen sc1
  s_add_u32 s34, s28, 0
  buffer_load_dwordx4 v[16:19], v1, s[4:7], s34 offen sc1
  s_and_b32 s34, s37, 15
  s_lshl_b32 s34, s34, 5
  s_add_u32 s34, s34, s15
  s_mul_i32 s34, s34, 3072
  s_mul_i32 s35, s16, 1536
  s_add_u32 s34, s34, s35
  s_add_u32 s35, s34, 56623104
  buffer_load_dwordx4 v[16:19], v1, s[4:7], s35 offen sc1
  buffer_load_dwordx4 v[16:19], v5, s[4:7], s35 offen offset:1024 sc1
  s_add_u32 s35, s34, 58195968
  buffer_load_dwordx4 v[16:19], v1, s[4:7], s35 offen sc1
  buffer_load_dwordx4 v[16:19], v5, s[4:7], s35 offen offset:1024 sc1
reca_pnodma241:
  s_lshl_b32 s34, s15, 4
  s_and_b32 s35, s17, 15
  s_add_u32 s34, s34, s35
  s_mul_i32 s34, s34, 12288
  s_mul_i32 s35, s16, 3072
  s_add_u32 s35, s35, s34
  s_add_u32 s21, s35, 37748736
  s_add_u32 s22, s35, 50331648
  s_mul_i32 s35, s16, 6144
  s_add_u32 s35, s35, s34
  s_add_u32 s23, s35, 44040192
  ds_read_b128 v[72:75], v7 offset:0
  ds_read_b128 v[76:79], v7 offset:20480
  ds_read_b128 v[80:83], v7 offset:1024
  ds_read_b128 v[84:87], v7 offset:21504
  ds_read_b128 v[88:91], v7 offset:2048
  ds_read_b128 v[92:95], v7 offset:22528
  s_waitcnt lgkmcnt(4)
  v_mfma_f32_16x16x32_bf16 v[32:35], a[0:3], v[72:75], 0
  v_mfma_f32_16x16x32_bf16 v[36:39], a[0:3], v[76:79], 0
  v_mfma_f32_16x16x32_bf16 v[40:43], a[80:83], v[72:75], 0
  v_mfma_f32_16x16x32_bf16 v[44:47], a[80:83], v[76:79], 0
  v_mfma_f32_16x16x32_bf16 v[48:51], a[160:163], v[72:75], 0
  v_mfma_f32_16x16x32_bf16 v[52:55], a[160:163], v[76:79], 0
  v_mfma_f32_16x16x32_bf16 v[56:59], v[96:99], v[72:75], 0
  v_mfma_f32_16x16x32_bf16 v[60:63], v[96:99], v[76:79], 0
  v_mfma_f32_16x16x32_bf16 v[64:67], v[72:75], v[176:179], 0
  v_mfma_f32_16x16x32_bf16 v[68:71], v[76:79], v[176:179], 0
  ds_read_b128 v[72:75], v7 offset:3072
  ds_read_b128 v[76:79], v7 offset:23552
  s_waitcnt lgkmcnt(4)
  v_mfma_f32_16x16x32_bf16 v[32:35], a[4:7], v[80:83], v[32:35]
  v_mfma_f32_16x16x32_bf16 v[36:39], a[4:7], v[84:87], v[36:39]
  v_mfma_f32_16x16x32_bf16 v[40:43], a[84:87], v[80:83], v[40:43]
  v_mfma_f32_16x16x32_bf16 v[44:47], a[84:87], v[84:87], v[44:47]
  v_mfma_f32_16x16x32_bf16 v[48:51], a[164:167], v[80:83], v[48:51]
  v_mfma_f32_16x16x32_bf16 v[52:55], a[164:167], v[84:87], v[52:55]
  v_mfma_f32_16x16x32_bf16 v[56:59], v[100:103], v[80:83], v[56:59]
  v_mfma_f32_16x16x32_bf16 v[60:63], v[100:103], v[84:87], v[60:63]
  v_mfma_f32_16x16x32_bf16 v[64:67], v[80:83], v[180:183], v[64:67]
  v_mfma_f32_16x16x32_bf16 v[68:71], v[84:87], v[180:183], v[68:71]
  ds_read_b128 v[80:83], v7 offset:4096
  ds_read_b128 v[84:87], v7 offset:24576
  s_waitcnt lgkmcnt(4)
  v_mfma_f32_16x16x32_bf16 v[32:35], a[8:11], v[88:91], v[32:35]
  v_mfma_f32_16x16x32_bf16 v[36:39], a[8:11], v[92:95], v[36:39]
  v_mfma_f32_16x16x32_bf16 v[40:43], a[88:91], v[88:91], v[40:43]
  v_mfma_f32_16x16x32_bf16 v[44:47], a[88:91], v[92:95], v[44:47]
  v_mfma_f32_16x16x32_bf16 v[48:51], a[168:171], v[88:91], v[48:51]
  v_mfma_f32_16x16x32_bf16 v[52:55], a[168:171], v[92:95], v[52:55]
  v_mfma_f32_16x16x32_bf16 v[56:59], v[104:107], v[88:91], v[56:59]
  v_mfma_f32_16x16x32_bf16 v[60:63], v[104:107], v[92:95], v[60:63]
  v_mfma_f32_16x16x32_bf16 v[64:67], v[88:91], v[184:187], v[64:67]
  v_mfma_f32_16x16x32_bf16 v[68:71], v[92:95], v[184:187], v[68:71]
  ds_read_b128 v[88:91], v7 offset:5120
  ds_read_b128 v[92:95], v7 offset:25600
  s_waitcnt lgkmcnt(4)
  v_mfma_f32_16x16x32_bf16 v[32:35], a[12:15], v[72:75], v[32:35]
  v_mfma_f32_16x16x32_bf16 v[36:39], a[12:15], v[76:79], v[36:39]
  v_mfma_f32_16x16x32_bf16 v[40:43], a[92:95], v[72:75], v[40:43]
  v_mfma_f32_16x16x32_bf16 v[44:47], a[92:95], v[76:79], v[44:47]
  v_mfma_f32_16x16x32_bf16 v[48:51], a[172:175], v[72:75], v[48:51]
  v_mfma_f32_16x16x32_bf16 v[52:55], a[172:175], v[76:79], v[52:55]
  v_mfma_f32_16x16x32_bf16 v[56:59], v[108:111], v[72:75], v[56:59]
  v_mfma_f32_16x16x32_bf16 v[60:63], v[108:111], v[76:79], v[60:63]
  v_mfma_f32_16x16x32_bf16 v[64:67], v[72:75], v[188:191], v[64:67]
  v_mfma_f32_16x16x32_bf16 v[68:71], v[76:79], v[188:191], v[68:71]
  ds_read_b128 v[72:75], v7 offset:6144
  ds_read_b128 v[76:79], v7 offset:26624
  s_waitcnt lgkmcnt(4)
  v_mfma_f32_16x16x32_bf16 v[32:35], a[16:19], v[80:83], v[32:35]
  v_mfma_f32_16x16x32_bf16 v[36:39], a[16:19], v[84:87], v[36:39]
  v_mfma_f32_16x16x32_bf16 v[40:43], a[96:99], v[80:83], v[40:43]
  v_mfma_f32_16x16x32_bf16 v[44:47], a[96:99], v[84:87], v[44:47]
  v_mfma_f32_16x16x32_bf16 v[48:51], a[176:179], v[80:83], v[48:51]
  v_mfma_f32_16x16x32_bf16 v[52:55], a[176:179], v[84:87], v[52:55]
  v_mfma_f32_16x16x32_bf16 v[56:59], v[112:115], v[80:83], v[56:59]
  v_mfma_f32_16x16x32_bf16 v[60:63], v[112:115], v[84:87], v[60:63]
  v_mfma_f32_16x16x32_bf16 v[64:67], v[80:83], v[192:195], v[64:67]
  v_mfma_f32_16x16x32_bf16 v[68:71], v[84:87], v[192:195], v[68:71]
  ds_read_b128 v[80:83], v7 offset:7168
  ds_read_b128 v[84:87], v7 offset:27648
  s_waitcnt lgkmcnt(4)
  v_mfma_f32_16x16x32_bf16 v[32:35], a[20:23], v[88:91], v[32:35]
  v_mfma_f32_16x16x32_bf16 v[36:39], a[20:23], v[92:95], v[36:39]
  v_mfma_f32_16x16x32_bf16 v[40:43], a[100:103], v[88:91], v[40:43]
  v_mfma_f32_16x16x32_bf16 v[44:47], a[100:103], v[92:95], v[44:47]
  v_mfma_f32_16x16x32_bf16 v[48:51], a[180:183], v[88:91], v[48:51]
  v_mfma_f32_16x16x32_bf16 v[52:55], a[180:183], v[92:95], v[52:55]
  v_mfma_f32_16x16x32_bf16 v[56:59], v[116:119], v[88:91], v[56:59]
  v_mfma_f32_16x16x32_bf16 v[60:63], v[116:119], v[92:95], v[60:63]
  v_mfma_f32_16x16x32_bf16 v[64:67], v[88:91], v[196:199], v[64:67]
  v_mfma_f32_16x16x32_bf16 v[68:71], v[92:95], v[196:199], v[68:71]
  ds_read_b128 v[88:91], v7 offset:8192
  ds_read_b128 v[92:95], v7 offset:28672
  s_waitcnt lgkmcnt(4)
  v_mfma_f32_16x16x32_bf16 v[32:35], a[24:27], v[72:75], v[32:35]
  v_mfma_f32_16x16x32_bf16 v[36:39], a[24:27], v[76:79], v[36:39]
  v_mfma_f32_16x16x32_bf16 v[40:43], a[104:107], v[72:75], v[40:43]
  v_mfma_f32_16x16x32_bf16 v[44:47], a[104:107], v[76:79], v[44:47]
  v_mfma_f32_16x16x32_bf16 v[48:51], a[184:187], v[72:75], v[48:51]
  v_mfma_f32_16x16x32_bf16 v[52:55], a[184:187], v[76:79], v[52:55]
  v_mfma_f32_16x16x32_bf16 v[56:59], v[120:123], v[72:75], v[56:59]
  v_mfma_f32_16x16x32_bf16 v[60:63], v[120:123], v[76:79], v[60:63]
  v_mfma_f32_16x16x32_bf16 v[64:67], v[72:75], v[200:203], v[64:67]
  v_mfma_f32_16x16x32_bf16 v[68:71], v[76:79], v[200:203], v[68:71]
  ds_read_b128 v[72:75], v7 offset:9216
  ds_read_b128 v[76:79], v7 offset:29696
  s_waitcnt lgkmcnt(4)
  v_mfma_f32_16x16x32_bf16 v[32:35], a[28:31], v[80:83], v[32:35]
  v_mfma_f32_16x16x32_bf16 v[36:39], a[28:31], v[84:87], v[36:39]
  v_mfma_f32_16x16x32_bf16 v[40:43], a[108:111], v[80:83], v[40:43]
  v_mfma_f32_16x16x32_bf16 v[44:47], a[108:111], v[84:87], v[44:47]
  v_mfma_f32_16x16x32_bf16 v[48:51], a[188:191], v[80:83], v[48:51]
  v_mfma_f32_16x16x32_bf16 v[52:55], a[188:191], v[84:87], v[52:55]
  v_mfma_f32_16x16x32_bf16 v[56:59], v[124:127], v[80:83], v[56:59]
  v_mfma_f32_16x16x32_bf16 v[60:63], v[124:127], v[84:87], v[60:63]
  v_mfma_f32_16x16x32_bf16 v[64:67], v[80:83], v[204:207], v[64:67]
  v_mfma_f32_16x16x32_bf16 v[68:71], v[84:87], v[204:207], v[68:71]
  ds_read_b128 v[80:83], v7 offset:10240
  ds_read_b128 v[84:87], v7 offset:30720
  s_waitcnt lgkmcnt(4)
  v_mfma_f32_16x16x32_bf16 v[32:35], a[32:35], v[88:91], v[32:35]
  v_mfma_f32_16x16x32_bf16 v[36:39], a[32:35], v[92:95], v[36:39]
  v_mfma_f32_16x16x32_bf16 v[40:43], a[112:115], v[88:91], v[40:43]
  v_mfma_f32_16x16x32_bf16 v[44:47], a[112:115], v[92:95], v[44:47]
  v_mfma_f32_16x16x32_bf16 v[48:51], a[192:195], v[88:91], v[48:51]
  v_mfma_f32_16x16x32_bf16 v[52:55], a[192:195], v[92:95], v[52:55]
  v_mfma_f32_16x16x32_bf16 v[56:59], v[128:131], v[88:91], v[56:59]
  v_mfma_f32_16x16x32_bf16 v[60:63], v[128:131], v[92:95], v[60:63]
  v_mfma_f32_16x16x32_bf16 v[64:67], v[88:91], v[208:211], v[64:67]
  v_mfma_f32_16x16x32_bf16 v[68:71], v[92:95], v[208:211], v[68:71]
  ds_read_b128 v[88:91], v7 offset:11264
  ds_read_b128 v[92:95], v7 offset:31744
  s_waitcnt lgkmcnt(4)
  v_mfma_f32_16x16x32_bf16 v[32:35], a[36:39], v[72:75], v[32:35]
  v_mfma_f32_16x16x32_bf16 v[36:39], a[36:39], v[76:79], v[36:39]
  v_mfma_f32_16x16x32_bf16 v[40:43], a[116:119], v[72:75], v[40:43]
  v_mfma_f32_16x16x32_bf16 v[44:47], a[116:119], v[76:79], v[44:47]
  v_mfma_f32_16x16x32_bf16 v[48:51], a[196:199], v[72:75], v[48:51]
  v_mfma_f32_16x16x32_bf16 v[52:55], a[196:199], v[76:79], v[52:55]
  v_mfma_f32_16x16x32_bf16 v[56:59], v[132:135], v[72:75], v[56:59]
  v_mfma_f32_16x16x32_bf16 v[60:63], v[132:135], v[76:79], v[60:63]
  v_mfma_f32_16x16x32_bf16 v[64:67], v[72:75], v[212:215], v[64:67]
  v_mfma_f32_16x16x32_bf16 v[68:71], v[76:79], v[212:215], v[68:71]
  ds_read_b128 v[72:75], v7 offset:12288
  ds_read_b128 v[76:79], v7 offset:32768
  s_waitcnt lgkmcnt(4)
  v_mfma_f32_16x16x32_bf16 v[32:35], a[40:43], v[80:83], v[32:35]
  v_mfma_f32_16x16x32_bf16 v[36:39], a[40:43], v[84:87], v[36:39]
  v_mfma_f32_16x16x32_bf16 v[40:43], a[120:123], v[80:83], v[40:43]
  v_mfma_f32_16x16x32_bf16 v[44:47], a[120:123], v[84:87], v[44:47]
  v_mfma_f32_16x16x32_bf16 v[48:51], a[200:203], v[80:83], v[48:51]
  v_mfma_f32_16x16x32_bf16 v[52:55], a[200:203], v[84:87], v[52:55]
  v_mfma_f32_16x16x32_bf16 v[56:59], v[136:139], v[80:83], v[56:59]
  v_mfma_f32_16x16x32_bf16 v[60:63], v[136:139], v[84:87], v[60:63]
  v_mfma_f32_16x16x32_bf16 v[64:67], v[80:83], v[216:219], v[64:67]
  v_mfma_f32_16x16x32_bf16 v[68:71], v[84:87], v[216:219], v[68:71]
  ds_read_b128 v[80:83], v7 offset:13312
  ds_read_b128 v[84:87], v7 offset:33792
  s_waitcnt lgkmcnt(4)
  v_mfma_f32_16x16x32_bf16 v[32:35], a[44:47], v[88:91], v[32:35]
  v_mfma_f32_16x16x32_bf16 v[36:39], a[44:47], v[92:95], v[36:39]
  v_mfma_f32_16x16x32_bf16 v[40:43], a[124:127], v[88:91], v[40:43]
  v_mfma_f32_16x16x32_bf16 v[44:47], a[124:127], v[92:95], v[44:47]
  v_mfma_f32_16x16x32_bf16 v[48:51], a[204:207], v[88:91], v[48:51]
  v_mfma_f32_16x16x32_bf16 v[52:55], a[204:207], v[92:95], v[52:55]
  v_mfma_f32_16x16x32_bf16 v[56:59], v[140:143], v[88:91], v[56:59]
  v_mfma_f32_16x16x32_bf16 v[60:63], v[140:143], v[92:95], v[60:63]
  v_mfma_f32_16x16x32_bf16 v[64:67], v[88:91], v[220:223], v[64:67]
  v_mfma_f32_16x16x32_bf16 v[68:71], v[92:95], v[220:223], v[68:71]
  ds_read_b128 v[88:91], v7 offset:14336
  ds_read_b128 v[92:95], v7 offset:34816
  s_waitcnt lgkmcnt(4)
  v_mfma_f32_16x16x32_bf16 v[32:35], a[48:51], v[72:75], v[32:35]
  v_mfma_f32_16x16x32_bf16 v[36:39], a[48:51], v[76:79], v[36:39]
  v_mfma_f32_16x16x32_bf16 v[40:43], a[128:131], v[72:75], v[40:43]
  v_mfma_f32_16x16x32_bf16 v[44:47], a[128:131], v[76:79], v[44:47]
  v_mfma_f32_16x16x32_bf16 v[48:51], a[208:211], v[72:75], v[48:51]
  v_mfma_f32_16x16x32_bf16 v[52:55], a[208:211], v[76:79], v[52:55]
  v_mfma_f32_16x16x32_bf16 v[56:59], v[144:147], v[72:75], v[56:59]
  v_mfma_f32_16x16x32_bf16 v[60:63], v[144:147], v[76:79], v[60:63]
  v_mfma_f32_16x16x32_bf16 v[64:67], v[72:75], v[224:227], v[64:67]
  v_mfma_f32_16x16x32_bf16 v[68:71], v[76:79], v[224:227], v[68:71]
  ds_read_b128 v[72:75], v7 offset:15360
  ds_read_b128 v[76:79], v7 offset:35840
  s_waitcnt lgkmcnt(4)
  v_mfma_f32_16x16x32_bf16 v[32:35], a[52:55], v[80:83], v[32:35]
  v_mfma_f32_16x16x32_bf16 v[36:39], a[52:55], v[84:87], v[36:39]
  v_mfma_f32_16x16x32_bf16 v[40:43], a[132:135], v[80:83], v[40:43]
  v_mfma_f32_16x16x32_bf16 v[44:47], a[132:135], v[84:87], v[44:47]
  v_mfma_f32_16x16x32_bf16 v[48:51], a[212:215], v[80:83], v[48:51]
  v_mfma_f32_16x16x32_bf16 v[52:55], a[212:215], v[84:87], v[52:55]
  v_mfma_f32_16x16x32_bf16 v[56:59], v[148:151], v[80:83], v[56:59]
  v_mfma_f32_16x16x32_bf16 v[60:63], v[148:151], v[84:87], v[60:63]
  v_mfma_f32_16x16x32_bf16 v[64:67], v[80:83], v[228:231], v[64:67]
  v_mfma_f32_16x16x32_bf16 v[68:71], v[84:87], v[228:231], v[68:71]
  ds_read_b128 v[80:83], v7 offset:16384
  ds_read_b128 v[84:87], v7 offset:36864
  s_waitcnt lgkmcnt(4)
  v_mfma_f32_16x16x32_bf16 v[32:35], a[56:59], v[88:91], v[32:35]
  v_mfma_f32_16x16x32_bf16 v[36:39], a[56:59], v[92:95], v[36:39]
  v_mfma_f32_16x16x32_bf16 v[40:43], a[136:139], v[88:91], v[40:43]
  v_mfma_f32_16x16x32_bf16 v[44:47], a[136:139], v[92:95], v[44:47]
  v_mfma_f32_16x16x32_bf16 v[48:51], a[216:219], v[88:91], v[48:51]
  v_mfma_f32_16x16x32_bf16 v[52:55], a[216:219], v[92:95], v[52:55]
  v_mfma_f32_16x16x32_bf16 v[56:59], v[152:155], v[88:91], v[56:59]
  v_mfma_f32_16x16x32_bf16 v[60:63], v[152:155], v[92:95], v[60:63]
  v_mfma_f32_16x16x32_bf16 v[64:67], v[88:91], v[232:235], v[64:67]
  v_mfma_f32_16x16x32_bf16 v[68:71], v[92:95], v[232:235], v[68:71]
  ds_read_b128 v[88:91], v7 offset:17408
  ds_read_b128 v[92:95], v7 offset:37888
  s_waitcnt lgkmcnt(4)
  v_mfma_f32_16x16x32_bf16 v[32:35], a[60:63], v[72:75], v[32:35]
  v_mfma_f32_16x16x32_bf16 v[36:39], a[60:63], v[76:79], v[36:39]
  v_mfma_f32_16x16x32_bf16 v[40:43], a[140:143], v[72:75], v[40:43]
  v_mfma_f32_16x16x32_bf16 v[44:47], a[140:143], v[76:79], v[44:47]
  v_mfma_f32_16x16x32_bf16 v[48:51], a[220:223], v[72:75], v[48:51]
  v_mfma_f32_16x16x32_bf16 v[52:55], a[220:223], v[76:79], v[52:55]
  v_mfma_f32_16x16x32_bf16 v[56:59], v[156:159], v[72:75], v[56:59]
  v_mfma_f32_16x16x32_bf16 v[60:63], v[156:159], v[76:79], v[60:63]
  v_mfma_f32_16x16x32_bf16 v[64:67], v[72:75], v[236:239], v[64:67]
  v_mfma_f32_16x16x32_bf16 v[68:71], v[76:79], v[236:239], v[68:71]
  ds_read_b128 v[72:75], v7 offset:18432
  ds_read_b128 v[76:79], v7 offset:38912
  s_waitcnt lgkmcnt(4)
  v_mfma_f32_16x16x32_bf16 v[32:35], a[64:67], v[80:83], v[32:35]
  v_mfma_f32_16x16x32_bf16 v[36:39], a[64:67], v[84:87], v[36:39]
  v_mfma_f32_16x16x32_bf16 v[40:43], a[144:147], v[80:83], v[40:43]
  v_mfma_f32_16x16x32_bf16 v[44:47], a[144:147], v[84:87], v[44:47]
  v_mfma_f32_16x16x32_bf16 v[48:51], a[224:227], v[80:83], v[48:51]
  v_mfma_f32_16x16x32_bf16 v[52:55], a[224:227], v[84:87], v[52:55]
  v_mfma_f32_16x16x32_bf16 v[56:59], v[160:163], v[80:83], v[56:59]
  v_mfma_f32_16x16x32_bf16 v[60:63], v[160:163], v[84:87], v[60:63]
  v_mfma_f32_16x16x32_bf16 v[64:67], v[80:83], v[240:243], v[64:67]
  v_mfma_f32_16x16x32_bf16 v[68:71], v[84:87], v[240:243], v[68:71]
  ds_read_b128 v[80:83], v7 offset:19456
  ds_read_b128 v[84:87], v7 offset:39936
  s_waitcnt lgkmcnt(4)
  v_mfma_f32_16x16x32_bf16 v[32:35], a[68:71], v[88:91], v[32:35]
  v_mfma_f32_16x16x32_bf16 v[36:39], a[68:71], v[92:95], v[36:39]
  v_mfma_f32_16x16x32_bf16 v[40:43], a[148:151], v[88:91], v[40:43]
  v_mfma_f32_16x16x32_bf16 v[44:47], a[148:151], v[92:95], v[44:47]
  v_mfma_f32_16x16x32_bf16 v[48:51], a[228:231], v[88:91], v[48:51]
  v_mfma_f32_16x16x32_bf16 v[52:55], a[228:231], v[92:95], v[52:55]
  v_mfma_f32_16x16x32_bf16 v[56:59], v[164:167], v[88:91], v[56:59]
  v_mfma_f32_16x16x32_bf16 v[60:63], v[164:167], v[92:95], v[60:63]
  v_mfma_f32_16x16x32_bf16 v[64:67], v[88:91], v[244:247], v[64:67]
  v_mfma_f32_16x16x32_bf16 v[68:71], v[92:95], v[244:247], v[68:71]
  s_waitcnt lgkmcnt(2)
  v_mfma_f32_16x16x32_bf16 v[32:35], a[72:75], v[72:75], v[32:35]
  v_mfma_f32_16x16x32_bf16 v[36:39], a[72:75], v[76:79], v[36:39]
  v_mfma_f32_16x16x32_bf16 v[40:43], a[152:155], v[72:75], v[40:43]
  v_mfma_f32_16x16x32_bf16 v[44:47], a[152:155], v[76:79], v[44:47]
  v_mfma_f32_16x16x32_bf16 v[48:51], a[232:235], v[72:75], v[48:51]
  v_mfma_f32_16x16x32_bf16 v[52:55], a[232:235], v[76:79], v[52:55]
  v_mfma_f32_16x16x32_bf16 v[56:59], v[168:171], v[72:75], v[56:59]
  v_mfma_f32_16x16x32_bf16 v[60:63], v[168:171], v[76:79], v[60:63]
  v_mfma_f32_16x16x32_bf16 v[64:67], v[72:75], v[248:251], v[64:67]
  v_mfma_f32_16x16x32_bf16 v[68:71], v[76:79], v[248:251], v[68:71]
  s_waitcnt lgkmcnt(0)
  v_mfma_f32_16x16x32_bf16 v[32:35], a[76:79], v[80:83], v[32:35]
  v_mfma_f32_16x16x32_bf16 v[36:39], a[76:79], v[84:87], v[36:39]
  v_mfma_f32_16x16x32_bf16 v[40:43], a[156:159], v[80:83], v[40:43]
  v_mfma_f32_16x16x32_bf16 v[44:47], a[156:159], v[84:87], v[44:47]
  v_mfma_f32_16x16x32_bf16 v[48:51], a[236:239], v[80:83], v[48:51]
  v_mfma_f32_16x16x32_bf16 v[52:55], a[236:239], v[84:87], v[52:55]
  v_mfma_f32_16x16x32_bf16 v[56:59], v[172:175], v[80:83], v[56:59]
  v_mfma_f32_16x16x32_bf16 v[60:63], v[172:175], v[84:87], v[60:63]
  v_mfma_f32_16x16x32_bf16 v[64:67], v[80:83], v[252:255], v[64:67]
  v_mfma_f32_16x16x32_bf16 v[68:71], v[84:87], v[252:255], v[68:71]
  v_cvt_pk_bf16_f32 v8, v32, v33
  v_cvt_pk_bf16_f32 v9, v34, v35
  v_cvt_pk_bf16_f32 v10, v40, v41
  v_cvt_pk_bf16_f32 v11, v42, v43
  s_add_u32 s34, s21, 0
  buffer_store_dwordx4 v[8:11], v1, s[4:7], s34 offen sc1
  v_cvt_pk_bf16_f32 v12, v36, v37
  v_cvt_pk_bf16_f32 v13, v38, v39
  v_cvt_pk_bf16_f32 v14, v44, v45
  v_cvt_pk_bf16_f32 v15, v46, v47
  s_add_u32 s34, s21, 6144
  buffer_store_dwordx4 v[12:15], v1, s[4:7], s34 offen sc1
  v_cvt_pk_bf16_f32 v8, v48, v49
  v_cvt_pk_bf16_f32 v9, v50, v51
  v_cvt_pk_bf16_f32 v10, v56, v57
  v_cvt_pk_bf16_f32 v11, v58, v59
  s_add_u32 s34, s21, 1024
  buffer_store_dwordx4 v[8:11], v1, s[4:7], s34 offen sc1
  v_cvt_pk_bf16_f32 v12, v52, v53
  v_cvt_pk_bf16_f32 v13, v54, v55
  v_cvt_pk_bf16_f32 v14, v60, v61
  v_cvt_pk_bf16_f32 v15, v62, v63
  s_add_u32 s34, s21, 7168
  buffer_store_dwordx4 v[12:15], v1, s[4:7], s34 offen sc1
  v_cvt_pk_bf16_f32 v8, v64, v65
  v_cvt_pk_bf16_f32 v9, v66, v67
  v_cvt_pk_bf16_f32 v10, v68, v69
  v_cvt_pk_bf16_f32 v11, v70, v71
  s_add_u32 s34, s23, 0
  buffer_store_dwordx4 v[8:11], v1, s[4:7], s34 offen sc1
  s_waitcnt vmcnt(0)
  s_barrier
  s_add_u32 s17, s17, 1
  v_mov_b32 v28, s17
  buffer_store_dword v28, v4, s[4:7], s24 offen sc1
  s_cmp_lt_u32 s17, 64
  s_cbranch_scc1 reca_ptop238
  s_branch reca_exit1
reca_pw1_227:
  s_mov_b32 s17, 0
  s_mov_b32 s26, 0
  s_mul_i32 s20, s17, 40960
  s_add_u32 s20, s20, 87566336
  s_add_u32 m0, s26, 10240
  s_nop 0
  buffer_load_dwordx4 v1, s[4:7], s20 offen offset:0 lds
  buffer_load_dwordx4 v1, s[4:7], s20 offen offset:1024 lds
  buffer_load_dwordx4 v1, s[4:7], s20 offen offset:2048 lds
  buffer_load_dwordx4 v1, s[4:7], s20 offen offset:3072 lds
  s_add_u32 s20, s20, 4096
  s_add_u32 m0, s26, 14336
  s_nop 0
  buffer_load_dwordx4 v1, s[4:7], s20 offen offset:0 lds
  buffer_load_dwordx4 v1, s[4:7], s20 offen offset:1024 lds
  buffer_load_dwordx4 v1, s[4:7], s20 offen offset:2048 lds
  buffer_load_dwordx4 v1, s[4:7], s20 offen offset:3072 lds
  s_add_u32 s20, s20, 4096
  s_add_u32 m0, s26, 18432
  s_nop 0
  buffer_load_dwordx4 v1, s[4:7], s20 offen offset:0 lds
  buffer_load_dwordx4 v1, s[4:7], s20 offen offset:1024 lds
  s_lshl_b32 s34, s15, 4
  s_and_b32 s35, s17, 15
  s_add_u32 s34, s34, s35
  s_mul_i32 s34, s34, 12288
  s_mul_i32 s35, s16, 3072
  s_add_u32 s35, s35, s34
  s_add_u32 s27, s35, 37748736
  s_add_u32 s30, s35, 50331648
  s_mul_i32 s35, s16, 6144
  s_add_u32 s35, s35, s34
  s_add_u32 s28, s35, 44040192
  s_add_u32 s34, s27, 2048
  buffer_load_dwordx4 v[16:19], v1, s[4:7], s34 offen sc1
  s_add_u32 s34, s27, 8192
  buffer_load_dwordx4 v[16:19], v1, s[4:7], s34 offen sc1
  s_add_u32 s34, s28, 1024
  buffer_load_dwordx4 v[16:19], v1, s[4:7], s34 offen sc1
  s_add_u32 s34, s28, 2048
  buffer_load_dwordx4 v[16:19], v1, s[4:7], s34 offen sc1
  s_add_u32 s34, s28, 3072
  buffer_load_dwordx4 v[16:19], v1, s[4:7], s34 offen sc1
  s_lshl_b32 s34, s17, 1
  s_add_u32 s34, s34, s16
  s_mul_i32 s34, s34, 196608
  s_mul_i32 s35, s15, 6144
  s_add_u32 s34, s34, s35
  s_add_u32 s34, s34, 59768832
  buffer_load_dwordx4 v[16:19], v1, s[4:7], s34 offen sc1
  buffer_load_dwordx4 v[16:19], v1, s[4:7], s34 offen offset:1024 sc1
  s_mul_i32 s34, s15, 12
  s_mul_i32 s35, s16, 6
  s_add_u32 s34, s34, s35
  s_add_u32 s34, s34, 4
  s_mul_i32 s34, s34, 20480
  s_add_u32 s34, s34, 14155776
  buffer_load_dwordx4 a[0:3], v1, s[4:7], s34 offen offset:0
  buffer_load_dwordx4 a[4:7], v1, s[4:7], s34 offen offset:1024
  buffer_load_dwordx4 a[8:11], v1, s[4:7], s34 offen offset:2048
  buffer_load_dwordx4 a[12:15], v1, s[4:7], s34 offen offset:3072
  s_add_u32 s34, s34, 4096
  buffer_load_dwordx4 a[16:19], v1, s[4:7], s34 offen offset:0
  buffer_load_dwordx4 a[20:23], v1, s[4:7], s34 offen offset:1024
  buffer_load_dwordx4 a[24:27], v1, s[4:7], s34 offen offset:2048
  buffer_load_dwordx4 a[28:31], v1, s[4:7], s34 offen offset:3072
  s_add_u32 s34, s34, 4096
  buffer_load_dwordx4 a[32:35], v1, s[4:7], s34 offen offset:0
  buffer_load_dwordx4 a[36:39], v1, s[4:7], s34 offen offset:1024
  buffer_load_dwordx4 a[40:43], v1, s[4:7], s34 offen offset:2048
  buffer_load_dwordx4 a[44:47], v1, s[4:7], s34 offen offset:3072
  s_add_u32 s34, s34, 4096
  buffer_load_dwordx4 a[48:51], v1, s[4:7], s34 offen offset:0
  buffer_load_dwordx4 a[52:55], v1, s[4:7], s34 offen offset:1024
  buffer_load_dwordx4 a[56:59], v1, s[4:7], s34 offen offset:2048
  buffer_load_dwordx4 a[60:63], v1, s[4:7], s34 offen offset:3072
  s_add_u32 s34, s34, 4096
  buffer_load_dwordx4 a[64:67], v1, s[4:7], s34 offen offset:0
  buffer_load_dwordx4 a[68:71], v1, s[4:7], s34 offen offset:1024
  buffer_load_dwordx4 a[72:75], v1, s[4:7], s34 offen offset:2048
  buffer_load_dwordx4 a[76:79], v1, s[4:7], s34 offen offset:3072
  s_mul_i32 s34, s15, 12
  s_mul_i32 s35, s16, 6
  s_add_u32 s34, s34, s35
  s_add_u32 s34, s34, 5
  s_mul_i32 s34, s34, 20480
  s_add_u32 s34, s34, 14155776
  buffer_load_dwordx4 a[80:83], v1, s[4:7], s34 offen offset:0
  buffer_load_dwordx4 a[84:87], v1, s[4:7], s34 offen offset:1024
  buffer_load_dwordx4 a[88:91], v1, s[4:7], s34 offen offset:2048
  buffer_load_dwordx4 a[92:95], v1, s[4:7], s34 offen offset:3072
  s_add_u32 s34, s34, 4096
  buffer_load_dwordx4 a[96:99], v1, s[4:7], s34 offen offset:0
  buffer_load_dwordx4 a[100:103], v1, s[4:7], s34 offen offset:1024
  buffer_load_dwordx4 a[104:107], v1, s[4:7], s34 offen offset:2048
  buffer_load_dwordx4 a[108:111], v1, s[4:7], s34 offen offset:3072
  s_add_u32 s34, s34, 4096
  buffer_load_dwordx4 a[112:115], v1, s[4:7], s34 offen offset:0
  buffer_load_dwordx4 a[116:119], v1, s[4:7], s34 offen offset:1024
  buffer_load_dwordx4 a[120:123], v1, s[4:7], s34 offen offset:2048
  buffer_load_dwordx4 a[124:127], v1, s[4:7], s34 offen offset:3072
  s_add_u32 s34, s34, 4096
  buffer_load_dwordx4 a[128:131], v1, s[4:7], s34 offen offset:0
  buffer_load_dwordx4 a[132:135], v1, s[4:7], s34 offen offset:1024
  buffer_load_dwordx4 a[136:139], v1, s[4:7], s34 offen offset:2048
  buffer_load_dwordx4 a[140:143], v1, s[4:7], s34 offen offset:3072
  s_add_u32 s34, s34, 4096
  buffer_load_dwordx4 a[144:147], v1, s[4:7], s34 offen offset:0
  buffer_load_dwordx4 a[148:151], v1, s[4:7], s34 offen offset:1024
  buffer_load_dwordx4 a[152:155], v1, s[4:7], s34 offen offset:2048
  buffer_load_dwordx4 a[156:159], v1, s[4:7], s34 offen offset:3072
  s_waitcnt vmcnt(20)
  s_mul_i32 s34, s15, 12
  s_mul_i32 s35, s16, 6
  s_add_u32 s34, s34, s35
  s_add_u32 s34, s34, 1
  s_mul_i32 s34, s34, 20480
  s_add_u32 s34, s34, 22020096
  buffer_load_dwordx4 a[160:163], v1, s[4:7], s34 offen offset:0
  buffer_load_dwordx4 a[164:167], v1, s[4:7], s34 offen offset:1024
  buffer_load_dwordx4 a[168:171], v1, s[4:7], s34 offen offset:2048
  buffer_load_dwordx4 a[172:175], v1, s[4:7], s34 offen offset:3072
  s_add_u32 s34, s34, 4096
  buffer_load_dwordx4 a[176:179], v1, s[4:7], s34 offen offset:0
  buffer_load_dwordx4 a[180:183], v1, s[4:7], s34 offen offset:1024
  buffer_load_dwordx4 a[184:187], v1, s[4:7], s34 offen offset:2048
  buffer_load_dwordx4 a[188:191], v1, s[4:7], s34 offen offset:3072
  s_add_u32 s34, s34, 4096
  buffer_load_dwordx4 a[192:195], v1, s[4:7], s34 offen offset:0
  buffer_load_dwordx4 a[196:199], v1, s[4:7], s34 offen offset:1024
  buffer_load_dwordx4 a[200:203], v1, s[4:7], s34 offen offset:2048
  buffer_load_dwordx4 a[204:207], v1, s[4:7], s34 offen offset:3072
  s_add_u32 s34, s34, 4096
  buffer_load_dwordx4 a[208:211], v1, s[4:7], s34 offen offset:0
  buffer_load_dwordx4 a[212:215], v1, s[4:7], s34 offen offset:1024
  buffer_load_dwordx4 a[216:219], v1, s[4:7], s34 offen offset:2048
  buffer_load_dwordx4 a[220:223], v1, s[4:7], s34 offen offset:3072
  s_add_u32 s34, s34, 4096
  buffer_load_dwordx4 a[224:227], v1, s[4:7], s34 offen offset:0
  buffer_load_dwordx4 a[228:231], v1, s[4:7], s34 offen offset:1024
  buffer_load_dwordx4 a[232:235], v1, s[4:7], s34 offen offset:2048
  buffer_load_dwordx4 a[236:239], v1, s[4:7], s34 offen offset:3072
  s_waitcnt vmcnt(20)
  s_mul_i32 s34, s15, 12
  s_mul_i32 s35, s16, 6
  s_add_u32 s34, s34, s35
  s_add_u32 s34, s34, 2
  s_mul_i32 s34, s34, 20480
  s_add_u32 s34, s34, 22020096
  buffer_load_dwordx4 v[96:99], v1, s[4:7], s34 offen offset:0
  buffer_load_dwordx4 v[100:103], v1, s[4:7], s34 offen offset:1024
  buffer_load_dwordx4 v[104:107], v1, s[4:7], s34 offen offset:2048
  buffer_load_dwordx4 v[108:111], v1, s[4:7], s34 offen offset:3072
  s_add_u32 s34, s34, 4096
  buffer_load_dwordx4 v[112:115], v1, s[4:7], s34 offen offset:0
  buffer_load_dwordx4 v[116:119], v1, s[4:7], s34 offen offset:1024
  buffer_load_dwordx4 v[120:123], v1, s[4:7], s34 offen offset:2048
  buffer_load_dwordx4 v[124:127], v1, s[4:7], s34 offen offset:3072
  s_add_u32 s34, s34, 4096
  buffer_load_dwordx4 v[128:131], v1, s[4:7], s34 offen offset:0
  buffer_load_dwordx4 v[132:135], v1, s[4:7], s34 offen offset:1024
  buffer_load_dwordx4 v[136:139], v1, s[4:7], s34 offen offset:2048
  buffer_load_dwordx4 v[140:143], v1, s[4:7], s34 offen offset:3072
  s_add_u32 s34, s34, 4096
  buffer_load_dwordx4 v[144:147], v1, s[4:7], s34 offen offset:0
  buffer_load_dwordx4 v[148:151], v1, s[4:7], s34 offen offset:1024
  buffer_load_dwordx4 v[152:155], v1, s[4:7], s34 offen offset:2048
  buffer_load_dwordx4 v[156:159], v1, s[4:7], s34 offen offset:3072
  s_add_u32 s34, s34, 4096
  buffer_load_dwordx4 v[160:163], v1, s[4:7], s34 offen offset:0
  buffer_load_dwordx4 v[164:167], v1, s[4:7], s34 offen offset:1024
  buffer_load_dwordx4 v[168:171], v1, s[4:7], s34 offen offset:2048
  buffer_load_dwordx4 v[172:175], v1, s[4:7], s34 offen offset:3072
  s_waitcnt vmcnt(20)
  s_mul_i32 s34, s15, 12
  s_mul_i32 s35, s16, 6
  s_add_u32 s34, s34, s35
  s_add_u32 s34, s34, 3
  s_mul_i32 s34, s34, 20480
  s_add_u32 s34, s34, 22020096
  buffer_load_dwordx4 v[176:179], v1, s[4:7], s34 offen offset:0
  buffer_load_dwordx4 v[180:183], v1, s[4:7], s34 offen offset:1024
  buffer_load_dwordx4 v[184:187], v1, s[4:7], s34 offen offset:2048
  buffer_load_dwordx4 v[188:191], v1, s[4:7], s34 offen offset:3072
  s_add_u32 s34, s34, 4096
  buffer_load_dwordx4 v[192:195], v1, s[4:7], s34 offen offset:0
  buffer_load_dwordx4 v[196:199], v1, s[4:7], s34 offen offset:1024
  buffer_load_dwordx4 v[200:203], v1, s[4:7], s34 offen offset:2048
  buffer_load_dwordx4 v[204:207], v1, s[4:7], s34 offen offset:3072
  s_add_u32 s34, s34, 4096
  buffer_load_dwordx4 v[208:211], v1, s[4:7], s34 offen offset:0
  buffer_load_dwordx4 v[212:215], v1, s[4:7], s34 offen offset:1024
  buffer_load_dwordx4 v[216:219], v1, s[4:7], s34 offen offset:2048
  buffer_load_dwordx4 v[220:223], v1, s[4:7], s34 offen offset:3072
  s_add_u32 s34, s34, 4096
  buffer_load_dwordx4 v[224:227], v1, s[4:7], s34 offen offset:0
  buffer_load_dwordx4 v[228:231], v1, s[4:7], s34 offen offset:1024
  buffer_load_dwordx4 v[232:235], v1, s[4:7], s34 offen offset:2048
  buffer_load_dwordx4 v[236:239], v1, s[4:7], s34 offen offset:3072
  s_add_u32 s34, s34, 4096
  buffer_load_dwordx4 v[240:243], v1, s[4:7], s34 offen offset:0
  buffer_load_dwordx4 v[244:247], v1, s[4:7], s34 offen offset:1024
  buffer_load_dwordx4 v[248:251], v1, s[4:7], s34 offen offset:2048
  buffer_load_dwordx4 v[252:255], v1, s[4:7], s34 offen offset:3072
  s_waitcnt vmcnt(20)
  v_and_b32 v30, 7, v0
  v_lshlrev_b32 v30, 3, v30
reca_cens243:
  buffer_load_dwordx2 v[28:29], v30, s[8:11], 0 offen sc1
  s_waitcnt vmcnt(0)
  v_sad_u8 v31, v28, 0, 0
  v_sad_u8 v31, v29, 0, v31
  v_cmp_gt_u32 vcc, 32, v31
  s_cbranch_vccz reca_censok244
  s_sleep 8
  s_sub_u32 s18, s18, 1
  s_cbranch_scc0 reca_cens243
  s_mov_b32 s18, 0
reca_censok244:
  v_and_b32 v28, 0x20202020, v28
  v_and_b32 v29, 0x20202020, v29
  v_cmp_ne_u32 s[34:35], 0, v28
  v_cmp_ne_u32 s[36:37], 0, v29
  s_nop 3
  s_and_b32 s34, s34, 0xff
  s_and_b32 s36, s36, 0xff
  s_or_b32 s35, s34, s36
  s_lshr_b32 s37, s35, s13
  s_and_b32 s37, s37, 1
  s_xor_b32 s43, s37, 1
  s_cmp_eq_u32 s57, 0
  s_cselect_b32 s58, s36, s34
  v_mov_b32 v31, 0x80000000
  s_cmp_lg_u32 s43, 0
  s_cbranch_scc1 reca_pslow245
reca_ptop246:
  s_cmp_lt_u32 s17, 6
  s_cbranch_scc1 reca_pgo247
  s_sub_u32 s36, s17, 6
reca_ppoll248:
  buffer_load_dword v28, v4, s[4:7], s25 offen sc1
  s_waitcnt vmcnt(0)
  v_readfirstlane_b32 s34, v28
  s_nop 3
  s_cmp_ge_i32 s34, s36
  s_cbranch_scc1 reca_pgo247
  s_sleep 8
  s_sub_u32 s18, s18, 1
  s_cbranch_scc0 reca_ppoll248
  s_mov_b32 s18, 0
reca_pgo247:
  s_waitcnt vmcnt(0)
  s_barrier
  v_add_u32 v7, s26, v1
  s_xor_b32 s26, s26, 40960
  s_add_u32 s37, s17, 1
  s_cmp_ge_u32 s37, 64
  s_cbranch_scc1 reca_pnodma249
  s_mul_i32 s20, s37, 40960
  s_add_u32 s20, s20, 87566336
  s_add_u32 m0, s26, 10240
  s_nop 0
  buffer_load_dwordx4 v1, s[4:7], s20 offen offset:0 lds
  buffer_load_dwordx4 v1, s[4:7], s20 offen offset:1024 lds
  buffer_load_dwordx4 v1, s[4:7], s20 offen offset:2048 lds
  buffer_load_dwordx4 v1, s[4:7], s20 offen offset:3072 lds
  s_add_u32 s20, s20, 4096
  s_add_u32 m0, s26, 14336
  s_nop 0
  buffer_load_dwordx4 v1, s[4:7], s20 offen offset:0 lds
  buffer_load_dwordx4 v1, s[4:7], s20 offen offset:1024 lds
  buffer_load_dwordx4 v1, s[4:7], s20 offen offset:2048 lds
  buffer_load_dwordx4 v1, s[4:7], s20 offen offset:3072 lds
  s_add_u32 s20, s20, 4096
  s_add_u32 m0, s26, 18432
  s_nop 0
  buffer_load_dwordx4 v1, s[4:7], s20 offen offset:0 lds
  buffer_load_dwordx4 v1, s[4:7], s20 offen offset:1024 lds
  s_lshl_b32 s34, s15, 4
  s_and_b32 s35, s37, 15
  s_add_u32 s34, s34, s35
  s_mul_i32 s34, s34, 12288
  s_mul_i32 s35, s16, 3072
  s_add_u32 s35, s35, s34
  s_add_u32 s27, s35, 37748736
  s_add_u32 s30, s35, 50331648
  s_mul_i32 s35, s16, 6144
  s_add_u32 s35, s35, s34
  s_add_u32 s28, s35, 44040192
  s_add_u32 s34, s27, 2048
  buffer_load_dwordx4 v[16:19], v1, s[4:7], s34 offen sc1
  s_add_u32 s34, s27, 8192
  buffer_load_dwordx4 v[16:19], v1, s[4:7], s34 offen sc1
  s_add_u32 s34, s28, 1024
  buffer_load_dwordx4 v[16:19], v1, s[4:7], s34 offen sc1
  s_add_u32 s34, s28, 2048
  buffer_load_dwordx4 v[16:19], v1, s[4:7], s34 offen sc1
  s_add_u32 s34, s28, 3072
  buffer_load_dwordx4 v[16:19], v1, s[4:7], s34 offen sc1
  s_lshl_b32 s34, s37, 1
  s_add_u32 s34, s34, s16
  s_mul_i32 s34, s34, 196608
  s_mul_i32 s35, s15, 6144
  s_add_u32 s34, s34, s35
  s_add_u32 s34, s34, 59768832
  buffer_load_dwordx4 v[16:19], v1, s[4:7], s34 offen sc1
  buffer_load_dwordx4 v[16:19], v1, s[4:7], s34 offen offset:1024 sc1
reca_pnodma249:
  s_lshl_b32 s34, s15, 4
  s_and_b32 s35, s17, 15
  s_add_u32 s34, s34, s35
  s_mul_i32 s34, s34, 12288
  s_mul_i32 s35, s16, 3072
  s_add_u32 s35, s35, s34
  s_add_u32 s21, s35, 37748736
  s_add_u32 s22, s35, 50331648
  s_mul_i32 s35, s16, 6144
  s_add_u32 s35, s35, s34
  s_add_u32 s23, s35, 44040192
  ds_read_b128 v[72:75], v7 offset:0
  ds_read_b128 v[76:79], v7 offset:20480
  ds_read_b128 v[80:83], v7 offset:1024
  ds_read_b128 v[84:87], v7 offset:21504
  ds_read_b128 v[88:91], v7 offset:2048
  ds_read_b128 v[92:95], v7 offset:22528
  s_waitcnt lgkmcnt(4)
  v_mfma_f32_16x16x32_bf16 v[32:35], a[0:3], v[72:75], 0
  v_mfma_f32_16x16x32_bf16 v[36:39], a[0:3], v[76:79], 0
  v_mfma_f32_16x16x32_bf16 v[40:43], a[80:83], v[72:75], 0
  v_mfma_f32_16x16x32_bf16 v[44:47], a[80:83], v[76:79], 0
  v_mfma_f32_16x16x32_bf16 v[48:51], v[72:75], a[160:163], 0
  v_mfma_f32_16x16x32_bf16 v[52:55], v[76:79], a[160:163], 0
  v_mfma_f32_16x16x32_bf16 v[56:59], v[72:75], v[96:99], 0
  v_mfma_f32_16x16x32_bf16 v[60:63], v[76:79], v[96:99], 0
  v_mfma_f32_16x16x32_bf16 v[64:67], v[72:75], v[176:179], 0
  v_mfma_f32_16x16x32_bf16 v[68:71], v[76:79], v[176:179], 0
  ds_read_b128 v[72:75], v7 offset:3072
  ds_read_b128 v[76:79], v7 offset:23552
  s_waitcnt lgkmcnt(4)
  v_mfma_f32_16x16x32_bf16 v[32:35], a[4:7], v[80:83], v[32:35]
  v_mfma_f32_16x16x32_bf16 v[36:39], a[4:7], v[84:87], v[36:39]
  v_mfma_f32_16x16x32_bf16 v[40:43], a[84:87], v[80:83], v[40:43]
  v_mfma_f32_16x16x32_bf16 v[44:47], a[84:87], v[84:87], v[44:47]
  v_mfma_f32_16x16x32_bf16 v[48:51], v[80:83], a[164:167], v[48:51]
  v_mfma_f32_16x16x32_bf16 v[52:55], v[84:87], a[164:167], v[52:55]
  v_mfma_f32_16x16x32_bf16 v[56:59], v[80:83], v[100:103], v[56:59]
  v_mfma_f32_16x16x32_bf16 v[60:63], v[84:87], v[100:103], v[60:63]
  v_mfma_f32_16x16x32_bf16 v[64:67], v[80:83], v[180:183], v[64:67]
  v_mfma_f32_16x16x32_bf16 v[68:71], v[84:87], v[180:183], v[68:71]
  ds_read_b128 v[80:83], v7 offset:4096
  ds_read_b128 v[84:87], v7 offset:24576
  s_waitcnt lgkmcnt(4)
  v_mfma_f32_16x16x32_bf16 v[32:35], a[8:11], v[88:91], v[32:35]
  v_mfma_f32_16x16x32_bf16 v[36:39], a[8:11], v[92:95], v[36:39]
  v_mfma_f32_16x16x32_bf16 v[40:43], a[88:91], v[88:91], v[40:43]
  v_mfma_f32_16x16x32_bf16 v[44:47], a[88:91], v[92:95], v[44:47]
  v_mfma_f32_16x16x32_bf16 v[48:51], v[88:91], a[168:171], v[48:51]
  v_mfma_f32_16x16x32_bf16 v[52:55], v[92:95], a[168:171], v[52:55]
  v_mfma_f32_16x16x32_bf16 v[56:59], v[88:91], v[104:107], v[56:59]
  v_mfma_f32_16x16x32_bf16 v[60:63], v[92:95], v[104:107], v[60:63]
  v_mfma_f32_16x16x32_bf16 v[64:67], v[88:91], v[184:187], v[64:67]
  v_mfma_f32_16x16x32_bf16 v[68:71], v[92:95], v[184:187], v[68:71]
  ds_read_b128 v[88:91], v7 offset:5120
  ds_read_b128 v[92:95], v7 offset:25600
  s_waitcnt lgkmcnt(4)
  v_mfma_f32_16x16x32_bf16 v[32:35], a[12:15], v[72:75], v[32:35]
  v_mfma_f32_16x16x32_bf16 v[36:39], a[12:15], v[76:79], v[36:39]
  v_mfma_f32_16x16x32_bf16 v[40:43], a[92:95], v[72:75], v[40:43]
  v_mfma_f32_16x16x32_bf16 v[44:47], a[92:95], v[76:79], v[44:47]
  v_mfma_f32_16x16x32_bf16 v[48:51], v[72:75], a[172:175], v[48:51]
  v_mfma_f32_16x16x32_bf16 v[52:55], v[76:79], a[172:175], v[52:55]
  v_mfma_f32_16x16x32_bf16 v[56:59], v[72:75], v[108:111], v[56:59]
  v_mfma_f32_16x16x32_bf16 v[60:63], v[76:79], v[108:111], v[60:63]
  v_mfma_f32_16x16x32_bf16 v[64:67], v[72:75], v[188:191], v[64:67]
  v_mfma_f32_16x16x32_bf16 v[68:71], v[76:79], v[188:191], v[68:71]
  ds_read_b128 v[72:75], v7 offset:6144
  ds_read_b128 v[76:79], v7 offset:26624
  s_waitcnt lgkmcnt(4)
  v_mfma_f32_16x16x32_bf16 v[32:35], a[16:19], v[80:83], v[32:35]
  v_mfma_f32_16x16x32_bf16 v[36:39], a[16:19], v[84:87], v[36:39]
  v_mfma_f32_16x16x32_bf16 v[40:43], a[96:99], v[80:83], v[40:43]
  v_mfma_f32_16x16x32_bf16 v[44:47], a[96:99], v[84:87], v[44:47]
  v_mfma_f32_16x16x32_bf16 v[48:51], v[80:83], a[176:179], v[48:51]
  v_mfma_f32_16x16x32_bf16 v[52:55], v[84:87], a[176:179], v[52:55]
  v_mfma_f32_16x16x32_bf16 v[56:59], v[80:83], v[112:115], v[56:59]
  v_mfma_f32_16x16x32_bf16 v[60:63], v[84:87], v[112:115], v[60:63]
  v_mfma_f32_16x16x32_bf16 v[64:67], v[80:83], v[192:195], v[64:67]
  v_mfma_f32_16x16x32_bf16 v[68:71], v[84:87], v[192:195], v[68:71]
  ds_read_b128 v[80:83], v7 offset:7168
  ds_read_b128 v[84:87], v7 offset:27648
  s_waitcnt lgkmcnt(4)
  v_mfma_f32_16x16x32_bf16 v[32:35], a[20:23], v[88:91], v[32:35]
  v_mfma_f32_16x16x32_bf16 v[36:39], a[20:23], v[92:95], v[36:39]
  v_mfma_f32_16x16x32_bf16 v[40:43], a[100:103], v[88:91], v[40:43]
  v_mfma_f32_16x16x32_bf16 v[44:47], a[100:103], v[92:95], v[44:47]
  v_mfma_f32_16x16x32_bf16 v[48:51], v[88:91], a[180:183], v[48:51]
  v_mfma_f32_16x16x32_bf16 v[52:55], v[92:95], a[180:183], v[52:55]
  v_mfma_f32_16x16x32_bf16 v[56:59], v[88:91], v[116:119], v[56:59]
  v_mfma_f32_16x16x32_bf16 v[60:63], v[92:95], v[116:119], v[60:63]
  v_mfma_f32_16x16x32_bf16 v[64:67], v[88:91], v[196:199], v[64:67]
  v_mfma_f32_16x16x32_bf16 v[68:71], v[92:95], v[196:199], v[68:71]
  ds_read_b128 v[88:91], v7 offset:8192
  ds_read_b128 v[92:95], v7 offset:28672
  s_waitcnt lgkmcnt(4)
  v_mfma_f32_16x16x32_bf16 v[32:35], a[24:27], v[72:75], v[32:35]
  v_mfma_f32_16x16x32_bf16 v[36:39], a[24:27], v[76:79], v[36:39]
  v_mfma_f32_16x16x32_bf16 v[40:43], a[104:107], v[72:75], v[40:43]
  v_mfma_f32_16x16x32_bf16 v[44:47], a[104:107], v[76:79], v[44:47]
  v_mfma_f32_16x16x32_bf16 v[48:51], v[72:75], a[184:187], v[48:51]
  v_mfma_f32_16x16x32_bf16 v[52:55], v[76:79], a[184:187], v[52:55]
  v_mfma_f32_16x16x32_bf16 v[56:59], v[72:75], v[120:123], v[56:59]
  v_mfma_f32_16x16x32_bf16 v[60:63], v[76:79], v[120:123], v[60:63]
  v_mfma_f32_16x16x32_bf16 v[64:67], v[72:75], v[200:203], v[64:67]
  v_mfma_f32_16x16x32_bf16 v[68:71], v[76:79], v[200:203], v[68:71]
  ds_read_b128 v[72:75], v7 offset:9216
  ds_read_b128 v[76:79], v7 offset:29696
  s_waitcnt lgkmcnt(4)
  v_mfma_f32_16x16x32_bf16 v[32:35], a[28:31], v[80:83], v[32:35]
  v_mfma_f32_16x16x32_bf16 v[36:39], a[28:31], v[84:87], v[36:39]
  v_mfma_f32_16x16x32_bf16 v[40:43], a[108:111], v[80:83], v[40:43]
  v_mfma_f32_16x16x32_bf16 v[44:47], a[108:111], v[84:87], v[44:47]
  v_mfma_f32_16x16x32_bf16 v[48:51], v[80:83], a[188:191], v[48:51]
  v_mfma_f32_16x16x32_bf16 v[52:55], v[84:87], a[188:191], v[52:55]
  v_mfma_f32_16x16x32_bf16 v[56:59], v[80:83], v[124:127], v[56:59]
  v_mfma_f32_16x16x32_bf16 v[60:63], v[84:87], v[124:127], v[60:63]
  v_mfma_f32_16x16x32_bf16 v[64:67], v[80:83], v[204:207], v[64:67]
  v_mfma_f32_16x16x32_bf16 v[68:71], v[84:87], v[204:207], v[68:71]
  ds_read_b128 v[80:83], v7 offset:10240
  ds_read_b128 v[84:87], v7 offset:30720
  s_waitcnt lgkmcnt(4)
  v_mfma_f32_16x16x32_bf16 v[32:35], a[32:35], v[88:91], v[32:35]
  v_mfma_f32_16x16x32_bf16 v[36:39], a[32:35], v[92:95], v[36:39]
  v_mfma_f32_16x16x32_bf16 v[40:43], a[112:115], v[88:91], v[40:43]
  v_mfma_f32_16x16x32_bf16 v[44:47], a[112:115], v[92:95], v[44:47]
  v_mfma_f32_16x16x32_bf16 v[48:51], v[88:91], a[192:195], v[48:51]
  v_mfma_f32_16x16x32_bf16 v[52:55], v[92:95], a[192:195], v[52:55]
  v_mfma_f32_16x16x32_bf16 v[56:59], v[88:91], v[128:131], v[56:59]
  v_mfma_f32_16x16x32_bf16 v[60:63], v[92:95], v[128:131], v[60:63]
  v_mfma_f32_16x16x32_bf16 v[64:67], v[88:91], v[208:211], v[64:67]
  v_mfma_f32_16x16x32_bf16 v[68:71], v[92:95], v[208:211], v[68:71]
  ds_read_b128 v[88:91], v7 offset:11264
  ds_read_b128 v[92:95], v7 offset:31744
  s_waitcnt lgkmcnt(4)
  v_mfma_f32_16x16x32_bf16 v[32:35], a[36:39], v[72:75], v[32:35]
  v_mfma_f32_16x16x32_bf16 v[36:39], a[36:39], v[76:79], v[36:39]
  v_mfma_f32_16x16x32_bf16 v[40:43], a[116:119], v[72:75], v[40:43]
  v_mfma_f32_16x16x32_bf16 v[44:47], a[116:119], v[76:79], v[44:47]
  v_mfma_f32_16x16x32_bf16 v[48:51], v[72:75], a[196:199], v[48:51]
  v_mfma_f32_16x16x32_bf16 v[52:55], v[76:79], a[196:199], v[52:55]
  v_mfma_f32_16x16x32_bf16 v[56:59], v[72:75], v[132:135], v[56:59]
  v_mfma_f32_16x16x32_bf16 v[60:63], v[76:79], v[132:135], v[60:63]
  v_mfma_f32_16x16x32_bf16 v[64:67], v[72:75], v[212:215], v[64:67]
  v_mfma_f32_16x16x32_bf16 v[68:71], v[76:79], v[212:215], v[68:71]
  ds_read_b128 v[72:75], v7 offset:12288
  ds_read_b128 v[76:79], v7 offset:32768
  s_waitcnt lgkmcnt(4)
  v_mfma_f32_16x16x32_bf16 v[32:35], a[40:43], v[80:83], v[32:35]
  v_mfma_f32_16x16x32_bf16 v[36:39], a[40:43], v[84:87], v[36:39]
  v_mfma_f32_16x16x32_bf16 v[40:43], a[120:123], v[80:83], v[40:43]
  v_mfma_f32_16x16x32_bf16 v[44:47], a[120:123], v[84:87], v[44:47]
  v_mfma_f32_16x16x32_bf16 v[48:51], v[80:83], a[200:203], v[48:51]
  v_mfma_f32_16x16x32_bf16 v[52:55], v[84:87], a[200:203], v[52:55]
  v_mfma_f32_16x16x32_bf16 v[56:59], v[80:83], v[136:139], v[56:59]
  v_mfma_f32_16x16x32_bf16 v[60:63], v[84:87], v[136:139], v[60:63]
  v_mfma_f32_16x16x32_bf16 v[64:67], v[80:83], v[216:219], v[64:67]
  v_mfma_f32_16x16x32_bf16 v[68:71], v[84:87], v[216:219], v[68:71]
  ds_read_b128 v[80:83], v7 offset:13312
  ds_read_b128 v[84:87], v7 offset:33792
  s_waitcnt lgkmcnt(4)
  v_mfma_f32_16x16x32_bf16 v[32:35], a[44:47], v[88:91], v[32:35]
  v_mfma_f32_16x16x32_bf16 v[36:39], a[44:47], v[92:95], v[36:39]
  v_mfma_f32_16x16x32_bf16 v[40:43], a[124:127], v[88:91], v[40:43]
  v_mfma_f32_16x16x32_bf16 v[44:47], a[124:127], v[92:95], v[44:47]
  v_mfma_f32_16x16x32_bf16 v[48:51], v[88:91], a[204:207], v[48:51]
  v_mfma_f32_16x16x32_bf16 v[52:55], v[92:95], a[204:207], v[52:55]
  v_mfma_f32_16x16x32_bf16 v[56:59], v[88:91], v[140:143], v[56:59]
  v_mfma_f32_16x16x32_bf16 v[60:63], v[92:95], v[140:143], v[60:63]
  v_mfma_f32_16x16x32_bf16 v[64:67], v[88:91], v[220:223], v[64:67]
  v_mfma_f32_16x16x32_bf16 v[68:71], v[92:95], v[220:223], v[68:71]
  ds_read_b128 v[88:91], v7 offset:14336
  ds_read_b128 v[92:95], v7 offset:34816
  s_waitcnt lgkmcnt(4)
  v_mfma_f32_16x16x32_bf16 v[32:35], a[48:51], v[72:75], v[32:35]
  v_mfma_f32_16x16x32_bf16 v[36:39], a[48:51], v[76:79], v[36:39]
  v_mfma_f32_16x16x32_bf16 v[40:43], a[128:131], v[72:75], v[40:43]
  v_mfma_f32_16x16x32_bf16 v[44:47], a[128:131], v[76:79], v[44:47]
  v_mfma_f32_16x16x32_bf16 v[48:51], v[72:75], a[208:211], v[48:51]
  v_mfma_f32_16x16x32_bf16 v[52:55], v[76:79], a[208:211], v[52:55]
  v_mfma_f32_16x16x32_bf16 v[56:59], v[72:75], v[144:147], v[56:59]
  v_mfma_f32_16x16x32_bf16 v[60:63], v[76:79], v[144:147], v[60:63]
  v_mfma_f32_16x16x32_bf16 v[64:67], v[72:75], v[224:227], v[64:67]
  v_mfma_f32_16x16x32_bf16 v[68:71], v[76:79], v[224:227], v[68:71]
  ds_read_b128 v[72:75], v7 offset:15360
  ds_read_b128 v[76:79], v7 offset:35840
  s_waitcnt lgkmcnt(4)
  v_mfma_f32_16x16x32_bf16 v[32:35], a[52:55], v[80:83], v[32:35]
  v_mfma_f32_16x16x32_bf16 v[36:39], a[52:55], v[84:87], v[36:39]
  v_mfma_f32_16x16x32_bf16 v[40:43], a[132:135], v[80:83], v[40:43]
  v_mfma_f32_16x16x32_bf16 v[44:47], a[132:135], v[84:87], v[44:47]
  v_mfma_f32_16x16x32_bf16 v[48:51], v[80:83], a[212:215], v[48:51]
  v_mfma_f32_16x16x32_bf16 v[52:55], v[84:87], a[212:215], v[52:55]
  v_mfma_f32_16x16x32_bf16 v[56:59], v[80:83], v[148:151], v[56:59]
  v_mfma_f32_16x16x32_bf16 v[60:63], v[84:87], v[148:151], v[60:63]
  v_mfma_f32_16x16x32_bf16 v[64:67], v[80:83], v[228:231], v[64:67]
  v_mfma_f32_16x16x32_bf16 v[68:71], v[84:87], v[228:231], v[68:71]
  ds_read_b128 v[80:83], v7 offset:16384
  ds_read_b128 v[84:87], v7 offset:36864
  s_waitcnt lgkmcnt(4)
  v_mfma_f32_16x16x32_bf16 v[32:35], a[56:59], v[88:91], v[32:35]
  v_mfma_f32_16x16x32_bf16 v[36:39], a[56:59], v[92:95], v[36:39]
  v_mfma_f32_16x16x32_bf16 v[40:43], a[136:139], v[88:91], v[40:43]
  v_mfma_f32_16x16x32_bf16 v[44:47], a[136:139], v[92:95], v[44:47]
  v_mfma_f32_16x16x32_bf16 v[48:51], v[88:91], a[216:219], v[48:51]
  v_mfma_f32_16x16x32_bf16 v[52:55], v[92:95], a[216:219], v[52:55]
  v_mfma_f32_16x16x32_bf16 v[56:59], v[88:91], v[152:155], v[56:59]
  v_mfma_f32_16x16x32_bf16 v[60:63], v[92:95], v[152:155], v[60:63]
  v_mfma_f32_16x16x32_bf16 v[64:67], v[88:91], v[232:235], v[64:67]
  v_mfma_f32_16x16x32_bf16 v[68:71], v[92:95], v[232:235], v[68:71]
  ds_read_b128 v[88:91], v7 offset:17408
  ds_read_b128 v[92:95], v7 offset:37888
  s_waitcnt lgkmcnt(4)
  v_mfma_f32_16x16x32_bf16 v[32:35], a[60:63], v[72:75], v[32:35]
  v_mfma_f32_16x16x32_bf16 v[36:39], a[60:63], v[76:79], v[36:39]
  v_mfma_f32_16x16x32_bf16 v[40:43], a[140:143], v[72:75], v[40:43]
  v_mfma_f32_16x16x32_bf16 v[44:47], a[140:143], v[76:79], v[44:47]
  v_mfma_f32_16x16x32_bf16 v[48:51], v[72:75], a[220:223], v[48:51]
  v_mfma_f32_16x16x32_bf16 v[52:55], v[76:79], a[220:223], v[52:55]
  v_mfma_f32_16x16x32_bf16 v[56:59], v[72:75], v[156:159], v[56:59]
  v_mfma_f32_16x16x32_bf16 v[60:63], v[76:79], v[156:159], v[60:63]
  v_mfma_f32_16x16x32_bf16 v[64:67], v[72:75], v[236:239], v[64:67]
  v_mfma_f32_16x16x32_bf16 v[68:71], v[76:79], v[236:239], v[68:71]
  ds_read_b128 v[72:75], v7 offset:18432
  ds_read_b128 v[76:79], v7 offset:38912
  s_waitcnt lgkmcnt(4)
  v_mfma_f32_16x16x32_bf16 v[32:35], a[64:67], v[80:83], v[32:35]
  v_mfma_f32_16x16x32_bf16 v[36:39], a[64:67], v[84:87], v[36:39]
  v_mfma_f32_16x16x32_bf16 v[40:43], a[144:147], v[80:83], v[40:43]
  v_mfma_f32_16x16x32_bf16 v[44:47], a[144:147], v[84:87], v[44:47]
  v_mfma_f32_16x16x32_bf16 v[48:51], v[80:83], a[224:227], v[48:51]
  v_mfma_f32_16x16x32_bf16 v[52:55], v[84:87], a[224:227], v[52:55]
  v_mfma_f32_16x16x32_bf16 v[56:59], v[80:83], v[160:163], v[56:59]
  v_mfma_f32_16x16x32_bf16 v[60:63], v[84:87], v[160:163], v[60:63]
  v_mfma_f32_16x16x32_bf16 v[64:67], v[80:83], v[240:243], v[64:67]
  v_mfma_f32_16x16x32_bf16 v[68:71], v[84:87], v[240:243], v[68:71]
  ds_read_b128 v[80:83], v7 offset:19456
  ds_read_b128 v[84:87], v7 offset:39936
  s_waitcnt lgkmcnt(4)
  v_mfma_f32_16x16x32_bf16 v[32:35], a[68:71], v[88:91], v[32:35]
  v_mfma_f32_16x16x32_bf16 v[36:39], a[68:71], v[92:95], v[36:39]
  v_mfma_f32_16x16x32_bf16 v[40:43], a[148:151], v[88:91], v[40:43]
  v_mfma_f32_16x16x32_bf16 v[44:47], a[148:151], v[92:95], v[44:47]
  v_mfma_f32_16x16x32_bf16 v[48:51], v[88:91], a[228:231], v[48:51]
  v_mfma_f32_16x16x32_bf16 v[52:55], v[92:95], a[228:231], v[52:55]
  v_mfma_f32_16x16x32_bf16 v[56:59], v[88:91], v[164:167], v[56:59]
  v_mfma_f32_16x16x32_bf16 v[60:63], v[92:95], v[164:167], v[60:63]
  v_mfma_f32_16x16x32_bf16 v[64:67], v[88:91], v[244:247], v[64:67]
  v_mfma_f32_16x16x32_bf16 v[68:71], v[92:95], v[244:247], v[68:71]
  s_waitcnt lgkmcnt(2)
  v_mfma_f32_16x16x32_bf16 v[32:35], a[72:75], v[72:75], v[32:35]
  v_mfma_f32_16x16x32_bf16 v[36:39], a[72:75], v[76:79], v[36:39]
  v_mfma_f32_16x16x32_bf16 v[40:43], a[152:155], v[72:75], v[40:43]
  v_mfma_f32_16x16x32_bf16 v[44:47], a[152:155], v[76:79], v[44:47]
  v_mfma_f32_16x16x32_bf16 v[48:51], v[72:75], a[232:235], v[48:51]
  v_mfma_f32_16x16x32_bf16 v[52:55], v[76:79], a[232:235], v[52:55]
  v_mfma_f32_16x16x32_bf16 v[56:59], v[72:75], v[168:171], v[56:59]
  v_mfma_f32_16x16x32_bf16 v[60:63], v[76:79], v[168:171], v[60:63]
  v_mfma_f32_16x16x32_bf16 v[64:67], v[72:75], v[248:251], v[64:67]
  v_mfma_f32_16x16x32_bf16 v[68:71], v[76:79], v[248:251], v[68:71]
  s_waitcnt lgkmcnt(0)
  v_mfma_f32_16x16x32_bf16 v[32:35], a[76:79], v[80:83], v[32:35]
  v_mfma_f32_16x16x32_bf16 v[36:39], a[76:79], v[84:87], v[36:39]
  v_mfma_f32_16x16x32_bf16 v[40:43], a[156:159], v[80:83], v[40:43]
  v_mfma_f32_16x16x32_bf16 v[44:47], a[156:159], v[84:87], v[44:47]
  v_mfma_f32_16x16x32_bf16 v[48:51], v[80:83], a[236:239], v[48:51]
  v_mfma_f32_16x16x32_bf16 v[52:55], v[84:87], a[236:239], v[52:55]
  v_mfma_f32_16x16x32_bf16 v[56:59], v[80:83], v[172:175], v[56:59]
  v_mfma_f32_16x16x32_bf16 v[60:63], v[84:87], v[172:175], v[60:63]
  v_mfma_f32_16x16x32_bf16 v[64:67], v[80:83], v[252:255], v[64:67]
  v_mfma_f32_16x16x32_bf16 v[68:71], v[84:87], v[252:255], v[68:71]
  v_cvt_pk_bf16_f32 v8, v32, v33
  v_cvt_pk_bf16_f32 v9, v34, v35
  v_cvt_pk_bf16_f32 v10, v40, v41
  v_cvt_pk_bf16_f32 v11, v42, v43
  s_add_u32 s34, s21, 2048
  buffer_store_dwordx4 v[8:11], v1, s[4:7], s34 offen
  v_cvt_pk_bf16_f32 v12, v36, v37
  v_cvt_pk_bf16_f32 v13, v38, v39
  v_cvt_pk_bf16_f32 v14, v44, v45
  v_cvt_pk_bf16_f32 v15, v46, v47
  s_add_u32 s34, s21, 8192
  buffer_store_dwordx4 v[12:15], v1, s[4:7], s34 offen
  v_cvt_pk_bf16_f32 v8, v48, v49
  v_cvt_pk_bf16_f32 v9, v50, v51
  v_cvt_pk_bf16_f32 v10, v52, v53
  v_cvt_pk_bf16_f32 v11, v54, v55
  s_add_u32 s34, s23, 1024
  buffer_store_dwordx4 v[8:11], v1, s[4:7], s34 offen
  v_cvt_pk_bf16_f32 v12, v56, v57
  v_cvt_pk_bf16_f32 v13, v58, v59
  v_cvt_pk_bf16_f32 v14, v60, v61
  v_cvt_pk_bf16_f32 v15, v62, v63
  s_add_u32 s34, s23, 2048
  buffer_store_dwordx4 v[12:15], v1, s[4:7], s34 offen
  v_cvt_pk_bf16_f32 v8, v64, v65
  v_cvt_pk_bf16_f32 v9, v66, v67
  v_cvt_pk_bf16_f32 v10, v68, v69
  v_cvt_pk_bf16_f32 v11, v70, v71
  s_add_u32 s34, s23, 3072
  buffer_store_dwordx4 v[8:11], v1, s[4:7], s34 offen
  s_waitcnt vmcnt(0)
  s_barrier
  s_add_u32 s17, s17, 1
  s_cmp_lt_u32 s17, 64
  s_cbranch_scc1 reca_ptop246
  s_branch reca_exit1
reca_pslow245:
reca_ptop251:
  s_cmp_lt_u32 s17, 6
  s_cbranch_scc1 reca_pgo252
  s_sub_u32 s36, s17, 6
reca_ppoll253:
  buffer_load_dword v28, v4, s[4:7], s25 offen sc1
  s_waitcnt vmcnt(0)
  v_readfirstlane_b32 s34, v28
  s_nop 3
  s_cmp_ge_i32 s34, s36
  s_cbranch_scc1 reca_pgo252
  s_sleep 8
  s_sub_u32 s18, s18, 1
  s_cbranch_scc0 reca_ppoll253
  s_mov_b32 s18, 0
reca_pgo252:
  s_waitcnt vmcnt(0)
  s_barrier
  v_add_u32 v7, s26, v1
  s_xor_b32 s26, s26, 40960
  s_add_u32 s37, s17, 1
  s_cmp_ge_u32 s37, 64
  s_cbranch_scc1 reca_pnodma254
  s_mul_i32 s20, s37, 40960
  s_add_u32 s20, s20, 87566336
  s_add_u32 m0, s26, 10240
  s_nop 0
  buffer_load_dwordx4 v1, s[4:7], s20 offen offset:0 lds
  buffer_load_dwordx4 v1, s[4:7], s20 offen offset:1024 lds
  buffer_load_dwordx4 v1, s[4:7], s20 offen offset:2048 lds
  buffer_load_dwordx4 v1, s[4:7], s20 offen offset:3072 lds
  s_add_u32 s20, s20, 4096
  s_add_u32 m0, s26, 14336
  s_nop 0
  buffer_load_dwordx4 v1, s[4:7], s20 offen offset:0 lds
  buffer_load_dwordx4 v1, s[4:7], s20 offen offset:1024 lds
  buffer_load_dwordx4 v1, s[4:7], s20 offen offset:2048 lds
  buffer_load_dwordx4 v1, s[4:7], s20 offen offset:3072 lds
  s_add_u32 s20, s20, 4096
  s_add_u32 m0, s26, 18432
  s_nop 0
  buffer_load_dwordx4 v1, s[4:7], s20 offen offset:0 lds
  buffer_load_dwordx4 v1, s[4:7], s20 offen offset:1024 lds
  s_lshl_b32 s34, s15, 4
  s_and_b32 s35, s37, 15
  s_add_u32 s34, s34, s35
  s_mul_i32 s34, s34, 12288
  s_mul_i32 s35, s16, 3072
  s_add_u32 s35, s35, s34
  s_add_u32 s27, s35, 37748736
  s_add_u32 s30, s35, 50331648
  s_mul_i32 s35, s16, 6144
  s_add_u32 s35, s35, s34
  s_add_u32 s28, s35, 44040192
  s_add_u32 s34, s27, 2048
  buffer_load_dwordx4 v[16:19], v1, s[4:7], s34 offen sc1
  s_add_u32 s34, s27, 8192
  buffer_load_dwordx4 v[16:19], v1, s[4:7], s34 offen sc1
  s_add_u32 s34, s28, 1024
  buffer_load_dwordx4 v[16:19], v1, s[4:7], s34 offen sc1
  s_add_u32 s34, s28, 2048
  buffer_load_dwordx4 v[16:19], v1, s[4:7], s34 offen sc1
  s_add_u32 s34, s28, 3072
  buffer_load_dwordx4 v[16:19], v1, s[4:7], s34 offen sc1
  s_lshl_b32 s34, s37, 1
  s_add_u32 s34, s34, s16
  s_mul_i32 s34, s34, 196608
  s_mul_i32 s35, s15, 6144
  s_add_u32 s34, s34, s35
  s_add_u32 s34, s34, 59768832
  buffer_load_dwordx4 v[16:19], v1, s[4:7], s34 offen sc1
  buffer_load_dwordx4 v[16:19], v1, s[4:7], s34 offen offset:1024 sc1
reca_pnodma254:
  s_lshl_b32 s34, s15, 4
  s_and_b32 s35, s17, 15
  s_add_u32 s34, s34, s35
  s_mul_i32 s34, s34, 12288
  s_mul_i32 s35, s16, 3072
  s_add_u32 s35, s35, s34
  s_add_u32 s21, s35, 37748736
  s_add_u32 s22, s35, 50331648
  s_mul_i32 s35, s16, 6144
  s_add_u32 s35, s35, s34
  s_add_u32 s23, s35, 44040192
  ds_read_b128 v[72:75], v7 offset:0
  ds_read_b128 v[76:79], v7 offset:20480
  ds_read_b128 v[80:83], v7 offset:1024
  ds_read_b128 v[84:87], v7 offset:21504
  ds_read_b128 v[88:91], v7 offset:2048
  ds_read_b128 v[92:95], v7 offset:22528
  s_waitcnt lgkmcnt(4)
  v_mfma_f32_16x16x32_bf16 v[32:35], a[0:3], v[72:75], 0
  v_mfma_f32_16x16x32_bf16 v[36:39], a[0:3], v[76:79], 0
  v_mfma_f32_16x16x32_bf16 v[40:43], a[80:83], v[72:75], 0
  v_mfma_f32_16x16x32_bf16 v[44:47], a[80:83], v[76:79], 0
  v_mfma_f32_16x16x32_bf16 v[48:51], v[72:75], a[160:163], 0
  v_mfma_f32_16x16x32_bf16 v[52:55], v[76:79], a[160:163], 0
  v_mfma_f32_16x16x32_bf16 v[56:59], v[72:75], v[96:99], 0
  v_mfma_f32_16x16x32_bf16 v[60:63], v[76:79], v[96:99], 0
  v_mfma_f32_16x16x32_bf16 v[64:67], v[72:75], v[176:179], 0
  v_mfma_f32_16x16x32_bf16 v[68:71], v[76:79], v[176:179], 0
  ds_read_b128 v[72:75], v7 offset:3072
  ds_read_b128 v[76:79], v7 offset:23552
  s_waitcnt lgkmcnt(4)
  v_mfma_f32_16x16x32_bf16 v[32:35], a[4:7], v[80:83], v[32:35]
  v_mfma_f32_16x16x32_bf16 v[36:39], a[4:7], v[84:87], v[36:39]
  v_mfma_f32_16x16x32_bf16 v[40:43], a[84:87], v[80:83], v[40:43]
  v_mfma_f32_16x16x32_bf16 v[44:47], a[84:87], v[84:87], v[44:47]
  v_mfma_f32_16x16x32_bf16 v[48:51], v[80:83], a[164:167], v[48:51]
  v_mfma_f32_16x16x32_bf16 v[52:55], v[84:87], a[164:167], v[52:55]
  v_mfma_f32_16x16x32_bf16 v[56:59], v[80:83], v[100:103], v[56:59]
  v_mfma_f32_16x16x32_bf16 v[60:63], v[84:87], v[100:103], v[60:63]
  v_mfma_f32_16x16x32_bf16 v[64:67], v[80:83], v[180:183], v[64:67]
  v_mfma_f32_16x16x32_bf16 v[68:71], v[84:87], v[180:183], v[68:71]
  ds_read_b128 v[80:83], v7 offset:4096
  ds_read_b128 v[84:87], v7 offset:24576
  s_waitcnt lgkmcnt(4)
  v_mfma_f32_16x16x32_bf16 v[32:35], a[8:11], v[88:91], v[32:35]
  v_mfma_f32_16x16x32_bf16 v[36:39], a[8:11], v[92:95], v[36:39]
  v_mfma_f32_16x16x32_bf16 v[40:43], a[88:91], v[88:91], v[40:43]
  v_mfma_f32_16x16x32_bf16 v[44:47], a[88:91], v[92:95], v[44:47]
  v_mfma_f32_16x16x32_bf16 v[48:51], v[88:91], a[168:171], v[48:51]
  v_mfma_f32_16x16x32_bf16 v[52:55], v[92:95], a[168:171], v[52:55]
  v_mfma_f32_16x16x32_bf16 v[56:59], v[88:91], v[104:107], v[56:59]
  v_mfma_f32_16x16x32_bf16 v[60:63], v[92:95], v[104:107], v[60:63]
  v_mfma_f32_16x16x32_bf16 v[64:67], v[88:91], v[184:187], v[64:67]
  v_mfma_f32_16x16x32_bf16 v[68:71], v[92:95], v[184:187], v[68:71]
  ds_read_b128 v[88:91], v7 offset:5120
  ds_read_b128 v[92:95], v7 offset:25600
  s_waitcnt lgkmcnt(4)
  v_mfma_f32_16x16x32_bf16 v[32:35], a[12:15], v[72:75], v[32:35]
  v_mfma_f32_16x16x32_bf16 v[36:39], a[12:15], v[76:79], v[36:39]
  v_mfma_f32_16x16x32_bf16 v[40:43], a[92:95], v[72:75], v[40:43]
  v_mfma_f32_16x16x32_bf16 v[44:47], a[92:95], v[76:79], v[44:47]
  v_mfma_f32_16x16x32_bf16 v[48:51], v[72:75], a[172:175], v[48:51]
  v_mfma_f32_16x16x32_bf16 v[52:55], v[76:79], a[172:175], v[52:55]
  v_mfma_f32_16x16x32_bf16 v[56:59], v[72:75], v[108:111], v[56:59]
  v_mfma_f32_16x16x32_bf16 v[60:63], v[76:79], v[108:111], v[60:63]
  v_mfma_f32_16x16x32_bf16 v[64:67], v[72:75], v[188:191], v[64:67]
  v_mfma_f32_16x16x32_bf16 v[68:71], v[76:79], v[188:191], v[68:71]
  ds_read_b128 v[72:75], v7 offset:6144
  ds_read_b128 v[76:79], v7 offset:26624
  s_waitcnt lgkmcnt(4)
  v_mfma_f32_16x16x32_bf16 v[32:35], a[16:19], v[80:83], v[32:35]
  v_mfma_f32_16x16x32_bf16 v[36:39], a[16:19], v[84:87], v[36:39]
  v_mfma_f32_16x16x32_bf16 v[40:43], a[96:99], v[80:83], v[40:43]
  v_mfma_f32_16x16x32_bf16 v[44:47], a[96:99], v[84:87], v[44:47]
  v_mfma_f32_16x16x32_bf16 v[48:51], v[80:83], a[176:179], v[48:51]
  v_mfma_f32_16x16x32_bf16 v[52:55], v[84:87], a[176:179], v[52:55]
  v_mfma_f32_16x16x32_bf16 v[56:59], v[80:83], v[112:115], v[56:59]
  v_mfma_f32_16x16x32_bf16 v[60:63], v[84:87], v[112:115], v[60:63]
  v_mfma_f32_16x16x32_bf16 v[64:67], v[80:83], v[192:195], v[64:67]
  v_mfma_f32_16x16x32_bf16 v[68:71], v[84:87], v[192:195], v[68:71]
  ds_read_b128 v[80:83], v7 offset:7168
  ds_read_b128 v[84:87], v7 offset:27648
  s_waitcnt lgkmcnt(4)
  v_mfma_f32_16x16x32_bf16 v[32:35], a[20:23], v[88:91], v[32:35]
  v_mfma_f32_16x16x32_bf16 v[36:39], a[20:23], v[92:95], v[36:39]
  v_mfma_f32_16x16x32_bf16 v[40:43], a[100:103], v[88:91], v[40:43]
  v_mfma_f32_16x16x32_bf16 v[44:47], a[100:103], v[92:95], v[44:47]
  v_mfma_f32_16x16x32_bf16 v[48:51], v[88:91], a[180:183], v[48:51]
  v_mfma_f32_16x16x32_bf16 v[52:55], v[92:95], a[180:183], v[52:55]
  v_mfma_f32_16x16x32_bf16 v[56:59], v[88:91], v[116:119], v[56:59]
  v_mfma_f32_16x16x32_bf16 v[60:63], v[92:95], v[116:119], v[60:63]
  v_mfma_f32_16x16x32_bf16 v[64:67], v[88:91], v[196:199], v[64:67]
  v_mfma_f32_16x16x32_bf16 v[68:71], v[92:95], v[196:199], v[68:71]
  ds_read_b128 v[88:91], v7 offset:8192
  ds_read_b128 v[92:95], v7 offset:28672
  s_waitcnt lgkmcnt(4)
  v_mfma_f32_16x16x32_bf16 v[32:35], a[24:27], v[72:75], v[32:35]
  v_mfma_f32_16x16x32_bf16 v[36:39], a[24:27], v[76:79], v[36:39]
  v_mfma_f32_16x16x32_bf16 v[40:43], a[104:107], v[72:75], v[40:43]
  v_mfma_f32_16x16x32_bf16 v[44:47], a[104:107], v[76:79], v[44:47]
  v_mfma_f32_16x16x32_bf16 v[48:51], v[72:75], a[184:187], v[48:51]
  v_mfma_f32_16x16x32_bf16 v[52:55], v[76:79], a[184:187], v[52:55]
  v_mfma_f32_16x16x32_bf16 v[56:59], v[72:75], v[120:123], v[56:59]
  v_mfma_f32_16x16x32_bf16 v[60:63], v[76:79], v[120:123], v[60:63]
  v_mfma_f32_16x16x32_bf16 v[64:67], v[72:75], v[200:203], v[64:67]
  v_mfma_f32_16x16x32_bf16 v[68:71], v[76:79], v[200:203], v[68:71]
  ds_read_b128 v[72:75], v7 offset:9216
  ds_read_b128 v[76:79], v7 offset:29696
  s_waitcnt lgkmcnt(4)
  v_mfma_f32_16x16x32_bf16 v[32:35], a[28:31], v[80:83], v[32:35]
  v_mfma_f32_16x16x32_bf16 v[36:39], a[28:31], v[84:87], v[36:39]
  v_mfma_f32_16x16x32_bf16 v[40:43], a[108:111], v[80:83], v[40:43]
  v_mfma_f32_16x16x32_bf16 v[44:47], a[108:111], v[84:87], v[44:47]
  v_mfma_f32_16x16x32_bf16 v[48:51], v[80:83], a[188:191], v[48:51]
  v_mfma_f32_16x16x32_bf16 v[52:55], v[84:87], a[188:191], v[52:55]
  v_mfma_f32_16x16x32_bf16 v[56:59], v[80:83], v[124:127], v[56:59]
  v_mfma_f32_16x16x32_bf16 v[60:63], v[84:87], v[124:127], v[60:63]
  v_mfma_f32_16x16x32_bf16 v[64:67], v[80:83], v[204:207], v[64:67]
  v_mfma_f32_16x16x32_bf16 v[68:71], v[84:87], v[204:207], v[68:71]
  ds_read_b128 v[80:83], v7 offset:10240
  ds_read_b128 v[84:87], v7 offset:30720
  s_waitcnt lgkmcnt(4)
  v_mfma_f32_16x16x32_bf16 v[32:35], a[32:35], v[88:91], v[32:35]
  v_mfma_f32_16x16x32_bf16 v[36:39], a[32:35], v[92:95], v[36:39]
  v_mfma_f32_16x16x32_bf16 v[40:43], a[112:115], v[88:91], v[40:43]
  v_mfma_f32_16x16x32_bf16 v[44:47], a[112:115], v[92:95], v[44:47]
  v_mfma_f32_16x16x32_bf16 v[48:51], v[88:91], a[192:195], v[48:51]
  v_mfma_f32_16x16x32_bf16 v[52:55], v[92:95], a[192:195], v[52:55]
  v_mfma_f32_16x16x32_bf16 v[56:59], v[88:91], v[128:131], v[56:59]
  v_mfma_f32_16x16x32_bf16 v[60:63], v[92:95], v[128:131], v[60:63]
  v_mfma_f32_16x16x32_bf16 v[64:67], v[88:91], v[208:211], v[64:67]
  v_mfma_f32_16x16x32_bf16 v[68:71], v[92:95], v[208:211], v[68:71]
  ds_read_b128 v[88:91], v7 offset:11264
  ds_read_b128 v[92:95], v7 offset:31744
  s_waitcnt lgkmcnt(4)
  v_mfma_f32_16x16x32_bf16 v[32:35], a[36:39], v[72:75], v[32:35]
  v_mfma_f32_16x16x32_bf16 v[36:39], a[36:39], v[76:79], v[36:39]
  v_mfma_f32_16x16x32_bf16 v[40:43], a[116:119], v[72:75], v[40:43]
  v_mfma_f32_16x16x32_bf16 v[44:47], a[116:119], v[76:79], v[44:47]
  v_mfma_f32_16x16x32_bf16 v[48:51], v[72:75], a[196:199], v[48:51]
  v_mfma_f32_16x16x32_bf16 v[52:55], v[76:79], a[196:199], v[52:55]
  v_mfma_f32_16x16x32_bf16 v[56:59], v[72:75], v[132:135], v[56:59]
  v_mfma_f32_16x16x32_bf16 v[60:63], v[76:79], v[132:135], v[60:63]
  v_mfma_f32_16x16x32_bf16 v[64:67], v[72:75], v[212:215], v[64:67]
  v_mfma_f32_16x16x32_bf16 v[68:71], v[76:79], v[212:215], v[68:71]
  ds_read_b128 v[72:75], v7 offset:12288
  ds_read_b128 v[76:79], v7 offset:32768
  s_waitcnt lgkmcnt(4)
  v_mfma_f32_16x16x32_bf16 v[32:35], a[40:43], v[80:83], v[32:35]
  v_mfma_f32_16x16x32_bf16 v[36:39], a[40:43], v[84:87], v[36:39]
  v_mfma_f32_16x16x32_bf16 v[40:43], a[120:123], v[80:83], v[40:43]
  v_mfma_f32_16x16x32_bf16 v[44:47], a[120:123], v[84:87], v[44:47]
  v_mfma_f32_16x16x32_bf16 v[48:51], v[80:83], a[200:203], v[48:51]
  v_mfma_f32_16x16x32_bf16 v[52:55], v[84:87], a[200:203], v[52:55]
  v_mfma_f32_16x16x32_bf16 v[56:59], v[80:83], v[136:139], v[56:59]
  v_mfma_f32_16x16x32_bf16 v[60:63], v[84:87], v[136:139], v[60:63]
  v_mfma_f32_16x16x32_bf16 v[64:67], v[80:83], v[216:219], v[64:67]
  v_mfma_f32_16x16x32_bf16 v[68:71], v[84:87], v[216:219], v[68:71]
  ds_read_b128 v[80:83], v7 offset:13312
  ds_read_b128 v[84:87], v7 offset:33792
  s_waitcnt lgkmcnt(4)
  v_mfma_f32_16x16x32_bf16 v[32:35], a[44:47], v[88:91], v[32:35]
  v_mfma_f32_16x16x32_bf16 v[36:39], a[44:47], v[92:95], v[36:39]
  v_mfma_f32_16x16x32_bf16 v[40:43], a[124:127], v[88:91], v[40:43]
  v_mfma_f32_16x16x32_bf16 v[44:47], a[124:127], v[92:95], v[44:47]
  v_mfma_f32_16x16x32_bf16 v[48:51], v[88:91], a[204:207], v[48:51]
  v_mfma_f32_16x16x32_bf16 v[52:55], v[92:95], a[204:207], v[52:55]
  v_mfma_f32_16x16x32_bf16 v[56:59], v[88:91], v[140:143], v[56:59]
  v_mfma_f32_16x16x32_bf16 v[60:63], v[92:95], v[140:143], v[60:63]
  v_mfma_f32_16x16x32_bf16 v[64:67], v[88:91], v[220:223], v[64:67]
  v_mfma_f32_16x16x32_bf16 v[68:71], v[92:95], v[220:223], v[68:71]
  ds_read_b128 v[88:91], v7 offset:14336
  ds_read_b128 v[92:95], v7 offset:34816
  s_waitcnt lgkmcnt(4)
  v_mfma_f32_16x16x32_bf16 v[32:35], a[48:51], v[72:75], v[32:35]
  v_mfma_f32_16x16x32_bf16 v[36:39], a[48:51], v[76:79], v[36:39]
  v_mfma_f32_16x16x32_bf16 v[40:43], a[128:131], v[72:75], v[40:43]
  v_mfma_f32_16x16x32_bf16 v[44:47], a[128:131], v[76:79], v[44:47]
  v_mfma_f32_16x16x32_bf16 v[48:51], v[72:75], a[208:211], v[48:51]
  v_mfma_f32_16x16x32_bf16 v[52:55], v[76:79], a[208:211], v[52:55]
  v_mfma_f32_16x16x32_bf16 v[56:59], v[72:75], v[144:147], v[56:59]
  v_mfma_f32_16x16x32_bf16 v[60:63], v[76:79], v[144:147], v[60:63]
  v_mfma_f32_16x16x32_bf16 v[64:67], v[72:75], v[224:227], v[64:67]
  v_mfma_f32_16x16x32_bf16 v[68:71], v[76:79], v[224:227], v[68:71]
  ds_read_b128 v[72:75], v7 offset:15360
  ds_read_b128 v[76:79], v7 offset:35840
  s_waitcnt lgkmcnt(4)
  v_mfma_f32_16x16x32_bf16 v[32:35], a[52:55], v[80:83], v[32:35]
  v_mfma_f32_16x16x32_bf16 v[36:39], a[52:55], v[84:87], v[36:39]
  v_mfma_f32_16x16x32_bf16 v[40:43], a[132:135], v[80:83], v[40:43]
  v_mfma_f32_16x16x32_bf16 v[44:47], a[132:135], v[84:87], v[44:47]
  v_mfma_f32_16x16x32_bf16 v[48:51], v[80:83], a[212:215], v[48:51]
  v_mfma_f32_16x16x32_bf16 v[52:55], v[84:87], a[212:215], v[52:55]
  v_mfma_f32_16x16x32_bf16 v[56:59], v[80:83], v[148:151], v[56:59]
  v_mfma_f32_16x16x32_bf16 v[60:63], v[84:87], v[148:151], v[60:63]
  v_mfma_f32_16x16x32_bf16 v[64:67], v[80:83], v[228:231], v[64:67]
  v_mfma_f32_16x16x32_bf16 v[68:71], v[84:87], v[228:231], v[68:71]
  ds_read_b128 v[80:83], v7 offset:16384
  ds_read_b128 v[84:87], v7 offset:36864
  s_waitcnt lgkmcnt(4)
  v_mfma_f32_16x16x32_bf16 v[32:35], a[56:59], v[88:91], v[32:35]
  v_mfma_f32_16x16x32_bf16 v[36:39], a[56:59], v[92:95], v[36:39]
  v_mfma_f32_16x16x32_bf16 v[40:43], a[136:139], v[88:91], v[40:43]
  v_mfma_f32_16x16x32_bf16 v[44:47], a[136:139], v[92:95], v[44:47]
  v_mfma_f32_16x16x32_bf16 v[48:51], v[88:91], a[216:219], v[48:51]
  v_mfma_f32_16x16x32_bf16 v[52:55], v[92:95], a[216:219], v[52:55]
  v_mfma_f32_16x16x32_bf16 v[56:59], v[88:91], v[152:155], v[56:59]
  v_mfma_f32_16x16x32_bf16 v[60:63], v[92:95], v[152:155], v[60:63]
  v_mfma_f32_16x16x32_bf16 v[64:67], v[88:91], v[232:235], v[64:67]
  v_mfma_f32_16x16x32_bf16 v[68:71], v[92:95], v[232:235], v[68:71]
  ds_read_b128 v[88:91], v7 offset:17408
  ds_read_b128 v[92:95], v7 offset:37888
  s_waitcnt lgkmcnt(4)
  v_mfma_f32_16x16x32_bf16 v[32:35], a[60:63], v[72:75], v[32:35]
  v_mfma_f32_16x16x32_bf16 v[36:39], a[60:63], v[76:79], v[36:39]
  v_mfma_f32_16x16x32_bf16 v[40:43], a[140:143], v[72:75], v[40:43]
  v_mfma_f32_16x16x32_bf16 v[44:47], a[140:143], v[76:79], v[44:47]
  v_mfma_f32_16x16x32_bf16 v[48:51], v[72:75], a[220:223], v[48:51]
  v_mfma_f32_16x16x32_bf16 v[52:55], v[76:79], a[220:223], v[52:55]
  v_mfma_f32_16x16x32_bf16 v[56:59], v[72:75], v[156:159], v[56:59]
  v_mfma_f32_16x16x32_bf16 v[60:63], v[76:79], v[156:159], v[60:63]
  v_mfma_f32_16x16x32_bf16 v[64:67], v[72:75], v[236:239], v[64:67]
  v_mfma_f32_16x16x32_bf16 v[68:71], v[76:79], v[236:239], v[68:71]
  ds_read_b128 v[72:75], v7 offset:18432
  ds_read_b128 v[76:79], v7 offset:38912
  s_waitcnt lgkmcnt(4)
  v_mfma_f32_16x16x32_bf16 v[32:35], a[64:67], v[80:83], v[32:35]
  v_mfma_f32_16x16x32_bf16 v[36:39], a[64:67], v[84:87], v[36:39]
  v_mfma_f32_16x16x32_bf16 v[40:43], a[144:147], v[80:83], v[40:43]
  v_mfma_f32_16x16x32_bf16 v[44:47], a[144:147], v[84:87], v[44:47]
  v_mfma_f32_16x16x32_bf16 v[48:51], v[80:83], a[224:227], v[48:51]
  v_mfma_f32_16x16x32_bf16 v[52:55], v[84:87], a[224:227], v[52:55]
  v_mfma_f32_16x16x32_bf16 v[56:59], v[80:83], v[160:163], v[56:59]
  v_mfma_f32_16x16x32_bf16 v[60:63], v[84:87], v[160:163], v[60:63]
  v_mfma_f32_16x16x32_bf16 v[64:67], v[80:83], v[240:243], v[64:67]
  v_mfma_f32_16x16x32_bf16 v[68:71], v[84:87], v[240:243], v[68:71]
  ds_read_b128 v[80:83], v7 offset:19456
  ds_read_b128 v[84:87], v7 offset:39936
  s_waitcnt lgkmcnt(4)
  v_mfma_f32_16x16x32_bf16 v[32:35], a[68:71], v[88:91], v[32:35]
  v_mfma_f32_16x16x32_bf16 v[36:39], a[68:71], v[92:95], v[36:39]
  v_mfma_f32_16x16x32_bf16 v[40:43], a[148:151], v[88:91], v[40:43]
  v_mfma_f32_16x16x32_bf16 v[44:47], a[148:151], v[92:95], v[44:47]
  v_mfma_f32_16x16x32_bf16 v[48:51], v[88:91], a[228:231], v[48:51]
  v_mfma_f32_16x16x32_bf16 v[52:55], v[92:95], a[228:231], v[52:55]
  v_mfma_f32_16x16x32_bf16 v[56:59], v[88:91], v[164:167], v[56:59]
  v_mfma_f32_16x16x32_bf16 v[60:63], v[92:95], v[164:167], v[60:63]
  v_mfma_f32_16x16x32_bf16 v[64:67], v[88:91], v[244:247], v[64:67]
  v_mfma_f32_16x16x32_bf16 v[68:71], v[92:95], v[244:247], v[68:71]
  s_waitcnt lgkmcnt(2)
  v_mfma_f32_16x16x32_bf16 v[32:35], a[72:75], v[72:75], v[32:35]
  v_mfma_f32_16x16x32_bf16 v[36:39], a[72:75], v[76:79], v[36:39]
  v_mfma_f32_16x16x32_bf16 v[40:43], a[152:155], v[72:75], v[40:43]
  v_mfma_f32_16x16x32_bf16 v[44:47], a[152:155], v[76:79], v[44:47]
  v_mfma_f32_16x16x32_bf16 v[48:51], v[72:75], a[232:235], v[48:51]
  v_mfma_f32_16x16x32_bf16 v[52:55], v[76:79], a[232:235], v[52:55]
  v_mfma_f32_16x16x32_bf16 v[56:59], v[72:75], v[168:171], v[56:59]
  v_mfma_f32_16x16x32_bf16 v[60:63], v[76:79], v[168:171], v[60:63]
  v_mfma_f32_16x16x32_bf16 v[64:67], v[72:75], v[248:251], v[64:67]
  v_mfma_f32_16x16x32_bf16 v[68:71], v[76:79], v[248:251], v[68:71]
  s_waitcnt lgkmcnt(0)
  v_mfma_f32_16x16x32_bf16 v[32:35], a[76:79], v[80:83], v[32:35]
  v_mfma_f32_16x16x32_bf16 v[36:39], a[76:79], v[84:87], v[36:39]
  v_mfma_f32_16x16x32_bf16 v[40:43], a[156:159], v[80:83], v[40:43]
  v_mfma_f32_16x16x32_bf16 v[44:47], a[156:159], v[84:87], v[44:47]
  v_mfma_f32_16x16x32_bf16 v[48:51], v[80:83], a[236:239], v[48:51]
  v_mfma_f32_16x16x32_bf16 v[52:55], v[84:87], a[236:239], v[52:55]
  v_mfma_f32_16x16x32_bf16 v[56:59], v[80:83], v[172:175], v[56:59]
  v_mfma_f32_16x16x32_bf16 v[60:63], v[84:87], v[172:175], v[60:63]
  v_mfma_f32_16x16x32_bf16 v[64:67], v[80:83], v[252:255], v[64:67]
  v_mfma_f32_16x16x32_bf16 v[68:71], v[84:87], v[252:255], v[68:71]
  v_cvt_pk_bf16_f32 v8, v32, v33
  v_cvt_pk_bf16_f32 v9, v34, v35
  v_cvt_pk_bf16_f32 v10, v40, v41
  v_cvt_pk_bf16_f32 v11, v42, v43
  s_add_u32 s34, s21, 2048
  buffer_store_dwordx4 v[8:11], v1, s[4:7], s34 offen sc1
  v_cvt_pk_bf16_f32 v12, v36, v37
  v_cvt_pk_bf16_f32 v13, v38, v39
  v_cvt_pk_bf16_f32 v14, v44, v45
  v_cvt_pk_bf16_f32 v15, v46, v47
  s_add_u32 s34, s21, 8192
  buffer_store_dwordx4 v[12:15], v1, s[4:7], s34 offen sc1
  v_cvt_pk_bf16_f32 v8, v48, v49
  v_cvt_pk_bf16_f32 v9, v50, v51
  v_cvt_pk_bf16_f32 v10, v52, v53
  v_cvt_pk_bf16_f32 v11, v54, v55
  s_add_u32 s34, s23, 1024
  buffer_store_dwordx4 v[8:11], v1, s[4:7], s34 offen sc1
  v_cvt_pk_bf16_f32 v12, v56, v57
  v_cvt_pk_bf16_f32 v13, v58, v59
  v_cvt_pk_bf16_f32 v14, v60, v61
  v_cvt_pk_bf16_f32 v15, v62, v63
  s_add_u32 s34, s23, 2048
  buffer_store_dwordx4 v[12:15], v1, s[4:7], s34 offen sc1
  v_cvt_pk_bf16_f32 v8, v64, v65
  v_cvt_pk_bf16_f32 v9, v66, v67
  v_cvt_pk_bf16_f32 v10, v68, v69
  v_cvt_pk_bf16_f32 v11, v70, v71
  s_add_u32 s34, s23, 3072
  buffer_store_dwordx4 v[8:11], v1, s[4:7], s34 offen sc1
  s_waitcnt vmcnt(0)
  s_barrier
  s_add_u32 s17, s17, 1
  s_cmp_lt_u32 s17, 64
  s_cbranch_scc1 reca_ptop251
  s_branch reca_exit1
reca_pw2_228:
  s_mov_b32 s17, 0
  s_mov_b32 s26, 0
  s_mul_i32 s20, s17, 40960
  s_add_u32 s20, s20, 87576576
  s_add_u32 m0, s26, 20480
  s_nop 0
  buffer_load_dwordx4 v1, s[4:7], s20 offen offset:0 lds
  buffer_load_dwordx4 v1, s[4:7], s20 offen offset:1024 lds
  buffer_load_dwordx4 v1, s[4:7], s20 offen offset:2048 lds
  buffer_load_dwordx4 v1, s[4:7], s20 offen offset:3072 lds
  s_add_u32 s20, s20, 4096
  s_add_u32 m0, s26, 24576
  s_nop 0
  buffer_load_dwordx4 v1, s[4:7], s20 offen offset:0 lds
  buffer_load_dwordx4 v1, s[4:7], s20 offen offset:1024 lds
  buffer_load_dwordx4 v1, s[4:7], s20 offen offset:2048 lds
  buffer_load_dwordx4 v1, s[4:7], s20 offen offset:3072 lds
  s_add_u32 s20, s20, 4096
  s_add_u32 m0, s26, 28672
  s_nop 0
  buffer_load_dwordx4 v1, s[4:7], s20 offen offset:0 lds
  buffer_load_dwordx4 v1, s[4:7], s20 offen offset:1024 lds
  s_lshl_b32 s34, s15, 4
  s_and_b32 s35, s17, 15
  s_add_u32 s34, s34, s35
  s_mul_i32 s34, s34, 12288
  s_mul_i32 s35, s16, 3072
  s_add_u32 s35, s35, s34
  s_add_u32 s27, s35, 37748736
  s_add_u32 s30, s35, 50331648
  s_mul_i32 s35, s16, 6144
  s_add_u32 s35, s35, s34
  s_add_u32 s28, s35, 44040192
  s_add_u32 s34, s30, 0
  buffer_load_dwordx4 v[16:19], v1, s[4:7], s34 offen sc1
  s_add_u32 s34, s30, 6144
  buffer_load_dwordx4 v[16:19], v1, s[4:7], s34 offen sc1
  s_add_u32 s34, s28, 4096
  buffer_load_dwordx4 v[16:19], v1, s[4:7], s34 offen sc1
  s_add_u32 s34, s28, 5120
  buffer_load_dwordx4 v[16:19], v1, s[4:7], s34 offen sc1
  s_lshl_b32 s34, s17, 1
  s_add_u32 s34, s34, s16
  s_mul_i32 s34, s34, 196608
  s_mul_i32 s35, s15, 6144
  s_add_u32 s34, s34, s35
  s_add_u32 s34, s34, 59770880
  buffer_load_dwordx4 v[16:19], v1, s[4:7], s34 offen sc1
  buffer_load_dwordx4 v[16:19], v1, s[4:7], s34 offen offset:1024 sc1
  s_mul_i32 s34, s15, 12
  s_mul_i32 s35, s16, 6
  s_add_u32 s34, s34, s35
  s_add_u32 s34, s34, 0
  s_mul_i32 s34, s34, 20480
  s_add_u32 s34, s34, 6291456
  buffer_load_dwordx4 a[0:3], v1, s[4:7], s34 offen offset:0
  buffer_load_dwordx4 a[4:7], v1, s[4:7], s34 offen offset:1024
  buffer_load_dwordx4 a[8:11], v1, s[4:7], s34 offen offset:2048
  buffer_load_dwordx4 a[12:15], v1, s[4:7], s34 offen offset:3072
  s_add_u32 s34, s34, 4096
  buffer_load_dwordx4 a[16:19], v1, s[4:7], s34 offen offset:0
  buffer_load_dwordx4 a[20:23], v1, s[4:7], s34 offen offset:1024
  buffer_load_dwordx4 a[24:27], v1, s[4:7], s34 offen offset:2048
  buffer_load_dwordx4 a[28:31], v1, s[4:7], s34 offen offset:3072
  s_add_u32 s34, s34, 4096
  buffer_load_dwordx4 a[32:35], v1, s[4:7], s34 offen offset:0
  buffer_load_dwordx4 a[36:39], v1, s[4:7], s34 offen offset:1024
  buffer_load_dwordx4 a[40:43], v1, s[4:7], s34 offen offset:2048
  buffer_load_dwordx4 a[44:47], v1, s[4:7], s34 offen offset:3072
  s_add_u32 s34, s34, 4096
  buffer_load_dwordx4 a[48:51], v1, s[4:7], s34 offen offset:0
  buffer_load_dwordx4 a[52:55], v1, s[4:7], s34 offen offset:1024
  buffer_load_dwordx4 a[56:59], v1, s[4:7], s34 offen offset:2048
  buffer_load_dwordx4 a[60:63], v1, s[4:7], s34 offen offset:3072
  s_add_u32 s34, s34, 4096
  buffer_load_dwordx4 a[64:67], v1, s[4:7], s34 offen offset:0
  buffer_load_dwordx4 a[68:71], v1, s[4:7], s34 offen offset:1024
  buffer_load_dwordx4 a[72:75], v1, s[4:7], s34 offen offset:2048
  buffer_load_dwordx4 a[76:79], v1, s[4:7], s34 offen offset:3072
  s_mul_i32 s34, s15, 12
  s_mul_i32 s35, s16, 6
  s_add_u32 s34, s34, s35
  s_add_u32 s34, s34, 1
  s_mul_i32 s34, s34, 20480
  s_add_u32 s34, s34, 6291456
  buffer_load_dwordx4 a[80:83], v1, s[4:7], s34 offen offset:0
  buffer_load_dwordx4 a[84:87], v1, s[4:7], s34 offen offset:1024
  buffer_load_dwordx4 a[88:91], v1, s[4:7], s34 offen offset:2048
  buffer_load_dwordx4 a[92:95], v1, s[4:7], s34 offen offset:3072
  s_add_u32 s34, s34, 4096
  buffer_load_dwordx4 a[96:99], v1, s[4:7], s34 offen offset:0
  buffer_load_dwordx4 a[100:103], v1, s[4:7], s34 offen offset:1024
  buffer_load_dwordx4 a[104:107], v1, s[4:7], s34 offen offset:2048
  buffer_load_dwordx4 a[108:111], v1, s[4:7], s34 offen offset:3072
  s_add_u32 s34, s34, 4096
  buffer_load_dwordx4 a[112:115], v1, s[4:7], s34 offen offset:0
  buffer_load_dwordx4 a[116:119], v1, s[4:7], s34 offen offset:1024
  buffer_load_dwordx4 a[120:123], v1, s[4:7], s34 offen offset:2048
  buffer_load_dwordx4 a[124:127], v1, s[4:7], s34 offen offset:3072
  s_add_u32 s34, s34, 4096
  buffer_load_dwordx4 a[128:131], v1, s[4:7], s34 offen offset:0
  buffer_load_dwordx4 a[132:135], v1, s[4:7], s34 offen offset:1024
  buffer_load_dwordx4 a[136:139], v1, s[4:7], s34 offen offset:2048
  buffer_load_dwordx4 a[140:143], v1, s[4:7], s34 offen offset:3072
  s_add_u32 s34, s34, 4096
  buffer_load_dwordx4 a[144:147], v1, s[4:7], s34 offen offset:0
  buffer_load_dwordx4 a[148:151], v1, s[4:7], s34 offen offset:1024
  buffer_load_dwordx4 a[152:155], v1, s[4:7], s34 offen offset:2048
  buffer_load_dwordx4 a[156:159], v1, s[4:7], s34 offen offset:3072
  s_waitcnt vmcnt(20)
  s_mul_i32 s34, s15, 12
  s_mul_i32 s35, s16, 6
  s_add_u32 s34, s34, s35
  s_add_u32 s34, s34, 4
  s_mul_i32 s34, s34, 20480
  s_add_u32 s34, s34, 22020096
  buffer_load_dwordx4 a[160:163], v1, s[4:7], s34 offen offset:0
  buffer_load_dwordx4 a[164:167], v1, s[4:7], s34 offen offset:1024
  buffer_load_dwordx4 a[168:171], v1, s[4:7], s34 offen offset:2048
  buffer_load_dwordx4 a[172:175], v1, s[4:7], s34 offen offset:3072
  s_add_u32 s34, s34, 4096
  buffer_load_dwordx4 a[176:179], v1, s[4:7], s34 offen offset:0
  buffer_load_dwordx4 a[180:183], v1, s[4:7], s34 offen offset:1024
  buffer_load_dwordx4 a[184:187], v1, s[4:7], s34 offen offset:2048
  buffer_load_dwordx4 a[188:191], v1, s[4:7], s34 offen offset:3072
  s_add_u32 s34, s34, 4096
  buffer_load_dwordx4 a[192:195], v1, s[4:7], s34 offen offset:0
  buffer_load_dwordx4 a[196:199], v1, s[4:7], s34 offen offset:1024
  buffer_load_dwordx4 a[200:203], v1, s[4:7], s34 offen offset:2048
  buffer_load_dwordx4 a[204:207], v1, s[4:7], s34 offen offset:3072
  s_add_u32 s34, s34, 4096
  buffer_load_dwordx4 a[208:211], v1, s[4:7], s34 offen offset:0
  buffer_load_dwordx4 a[212:215], v1, s[4:7], s34 offen offset:1024
  buffer_load_dwordx4 a[216:219], v1, s[4:7], s34 offen offset:2048
  buffer_load_dwordx4 a[220:223], v1, s[4:7], s34 offen offset:3072
  s_add_u32 s34, s34, 4096
  buffer_load_dwordx4 a[224:227], v1, s[4:7], s34 offen offset:0
  buffer_load_dwordx4 a[228:231], v1, s[4:7], s34 offen offset:1024
  buffer_load_dwordx4 a[232:235], v1, s[4:7], s34 offen offset:2048
  buffer_load_dwordx4 a[236:239], v1, s[4:7], s34 offen offset:3072
  s_waitcnt vmcnt(20)
  s_mul_i32 s34, s15, 12
  s_mul_i32 s35, s16, 6
  s_add_u32 s34, s34, s35
  s_add_u32 s34, s34, 5
  s_mul_i32 s34, s34, 20480
  s_add_u32 s34, s34, 22020096
  buffer_load_dwordx4 v[96:99], v1, s[4:7], s34 offen offset:0
  buffer_load_dwordx4 v[100:103], v1, s[4:7], s34 offen offset:1024
  buffer_load_dwordx4 v[104:107], v1, s[4:7], s34 offen offset:2048
  buffer_load_dwordx4 v[108:111], v1, s[4:7], s34 offen offset:3072
  s_add_u32 s34, s34, 4096
  buffer_load_dwordx4 v[112:115], v1, s[4:7], s34 offen offset:0
  buffer_load_dwordx4 v[116:119], v1, s[4:7], s34 offen offset:1024
  buffer_load_dwordx4 v[120:123], v1, s[4:7], s34 offen offset:2048
  buffer_load_dwordx4 v[124:127], v1, s[4:7], s34 offen offset:3072
  s_add_u32 s34, s34, 4096
  buffer_load_dwordx4 v[128:131], v1, s[4:7], s34 offen offset:0
  buffer_load_dwordx4 v[132:135], v1, s[4:7], s34 offen offset:1024
  buffer_load_dwordx4 v[136:139], v1, s[4:7], s34 offen offset:2048
  buffer_load_dwordx4 v[140:143], v1, s[4:7], s34 offen offset:3072
  s_add_u32 s34, s34, 4096
  buffer_load_dwordx4 v[144:147], v1, s[4:7], s34 offen offset:0
  buffer_load_dwordx4 v[148:151], v1, s[4:7], s34 offen offset:1024
  buffer_load_dwordx4 v[152:155], v1, s[4:7], s34 offen offset:2048
  buffer_load_dwordx4 v[156:159], v1, s[4:7], s34 offen offset:3072
  s_add_u32 s34, s34, 4096
  buffer_load_dwordx4 v[160:163], v1, s[4:7], s34 offen offset:0
  buffer_load_dwordx4 v[164:167], v1, s[4:7], s34 offen offset:1024
  buffer_load_dwordx4 v[168:171], v1, s[4:7], s34 offen offset:2048
  buffer_load_dwordx4 v[172:175], v1, s[4:7], s34 offen offset:3072
  s_waitcnt vmcnt(20)
  v_and_b32 v30, 7, v0
  v_lshlrev_b32 v30, 3, v30
reca_cens256:
  buffer_load_dwordx2 v[28:29], v30, s[8:11], 0 offen sc1
  s_waitcnt vmcnt(0)
  v_sad_u8 v31, v28, 0, 0
  v_sad_u8 v31, v29, 0, v31
  v_cmp_gt_u32 vcc, 32, v31
  s_cbranch_vccz reca_censok257
  s_sleep 8
  s_sub_u32 s18, s18, 1
  s_cbranch_scc0 reca_cens256
  s_mov_b32 s18, 0
reca_censok257:
  v_and_b32 v28, 0x20202020, v28
  v_and_b32 v29, 0x20202020, v29
  v_cmp_ne_u32 s[34:35], 0, v28
  v_cmp_ne_u32 s[36:37], 0, v29
  s_nop 3
  s_and_b32 s34, s34, 0xff
  s_and_b32 s36, s36, 0xff
  s_or_b32 s35, s34, s36
  s_lshr_b32 s37, s35, s13
  s_and_b32 s37, s37, 1
  s_xor_b32 s43, s37, 1
  s_cmp_eq_u32 s57, 0
  s_cselect_b32 s58, s36, s34
  v_mov_b32 v31, 0x80000000
  s_cmp_lg_u32 s43, 0
  s_cbranch_scc1 reca_pslow258
reca_ptop259:
  s_cmp_lt_u32 s17, 6
  s_cbranch_scc1 reca_pgo260
  s_sub_u32 s36, s17, 6
reca_ppoll261:
  buffer_load_dword v28, v4, s[4:7], s25 offen sc1
  s_waitcnt vmcnt(0)
  v_readfirstlane_b32 s34, v28
  s_nop 3
  s_cmp_ge_i32 s34, s36
  s_cbranch_scc1 reca_pgo260
  s_sleep 8
  s_sub_u32 s18, s18, 1
  s_cbranch_scc0 reca_ppoll261
  s_mov_b32 s18, 0
reca_pgo260:
  s_waitcnt vmcnt(0)
  s_barrier
  v_add_u32 v7, s26, v1
  s_xor_b32 s26, s26, 40960
  s_add_u32 s37, s17, 1
  s_cmp_ge_u32 s37, 64
  s_cbranch_scc1 reca_pnodma262
  s_mul_i32 s20, s37, 40960
  s_add_u32 s20, s20, 87576576
  s_add_u32 m0, s26, 20480
  s_nop 0
  buffer_load_dwordx4 v1, s[4:7], s20 offen offset:0 lds
  buffer_load_dwordx4 v1, s[4:7], s20 offen offset:1024 lds
  buffer_load_dwordx4 v1, s[4:7], s20 offen offset:2048 lds
  buffer_load_dwordx4 v1, s[4:7], s20 offen offset:3072 lds
  s_add_u32 s20, s20, 4096
  s_add_u32 m0, s26, 24576
  s_nop 0
  buffer_load_dwordx4 v1, s[4:7], s20 offen offset:0 lds
  buffer_load_dwordx4 v1, s[4:7], s20 offen offset:1024 lds
  buffer_load_dwordx4 v1, s[4:7], s20 offen offset:2048 lds
  buffer_load_dwordx4 v1, s[4:7], s20 offen offset:3072 lds
  s_add_u32 s20, s20, 4096
  s_add_u32 m0, s26, 28672
  s_nop 0
  buffer_load_dwordx4 v1, s[4:7], s20 offen offset:0 lds
  buffer_load_dwordx4 v1, s[4:7], s20 offen offset:1024 lds
  s_lshl_b32 s34, s15, 4
  s_and_b32 s35, s37, 15
  s_add_u32 s34, s34, s35
  s_mul_i32 s34, s34, 12288
  s_mul_i32 s35, s16, 3072
  s_add_u32 s35, s35, s34
  s_add_u32 s27, s35, 37748736
  s_add_u32 s30, s35, 50331648
  s_mul_i32 s35, s16, 6144
  s_add_u32 s35, s35, s34
  s_add_u32 s28, s35, 44040192
  s_add_u32 s34, s30, 0
  buffer_load_dwordx4 v[16:19], v1, s[4:7], s34 offen sc1
  s_add_u32 s34, s30, 6144
  buffer_load_dwordx4 v[16:19], v1, s[4:7], s34 offen sc1
  s_add_u32 s34, s28, 4096
  buffer_load_dwordx4 v[16:19], v1, s[4:7], s34 offen sc1
  s_add_u32 s34, s28, 5120
  buffer_load_dwordx4 v[16:19], v1, s[4:7], s34 offen sc1
  s_lshl_b32 s34, s37, 1
  s_add_u32 s34, s34, s16
  s_mul_i32 s34, s34, 196608
  s_mul_i32 s35, s15, 6144
  s_add_u32 s34, s34, s35
  s_add_u32 s34, s34, 59770880
  buffer_load_dwordx4 v[16:19], v1, s[4:7], s34 offen sc1
  buffer_load_dwordx4 v[16:19], v1, s[4:7], s34 offen offset:1024 sc1
reca_pnodma262:
  s_lshl_b32 s34, s15, 4
  s_and_b32 s35, s17, 15
  s_add_u32 s34, s34, s35
  s_mul_i32 s34, s34, 12288
  s_mul_i32 s35, s16, 3072
  s_add_u32 s35, s35, s34
  s_add_u32 s21, s35, 37748736
  s_add_u32 s22, s35, 50331648
  s_mul_i32 s35, s16, 6144
  s_add_u32 s35, s35, s34
  s_add_u32 s23, s35, 44040192
  ds_read_b128 v[72:75], v7 offset:0
  ds_read_b128 v[76:79], v7 offset:20480
  ds_read_b128 v[80:83], v7 offset:1024
  ds_read_b128 v[84:87], v7 offset:21504
  ds_read_b128 v[88:91], v7 offset:2048
  ds_read_b128 v[92:95], v7 offset:22528
  s_waitcnt lgkmcnt(4)
  v_mfma_f32_16x16x32_bf16 v[32:35], a[0:3], v[72:75], 0
  v_mfma_f32_16x16x32_bf16 v[36:39], a[0:3], v[76:79], 0
  v_mfma_f32_16x16x32_bf16 v[40:43], a[80:83], v[72:75], 0
  v_mfma_f32_16x16x32_bf16 v[44:47], a[80:83], v[76:79], 0
  v_mfma_f32_16x16x32_bf16 v[48:51], v[72:75], a[160:163], 0
  v_mfma_f32_16x16x32_bf16 v[52:55], v[76:79], a[160:163], 0
  v_mfma_f32_16x16x32_bf16 v[56:59], v[72:75], v[96:99], 0
  v_mfma_f32_16x16x32_bf16 v[60:63], v[76:79], v[96:99], 0
  ds_read_b128 v[72:75], v7 offset:3072
  ds_read_b128 v[76:79], v7 offset:23552
  s_waitcnt lgkmcnt(4)
  v_mfma_f32_16x16x32_bf16 v[32:35], a[4:7], v[80:83], v[32:35]
  v_mfma_f32_16x16x32_bf16 v[36:39], a[4:7], v[84:87], v[36:39]
  v_mfma_f32_16x16x32_bf16 v[40:43], a[84:87], v[80:83], v[40:43]
  v_mfma_f32_16x16x32_bf16 v[44:47], a[84:87], v[84:87], v[44:47]
  v_mfma_f32_16x16x32_bf16 v[48:51], v[80:83], a[164:167], v[48:51]
  v_mfma_f32_16x16x32_bf16 v[52:55], v[84:87], a[164:167], v[52:55]
  v_mfma_f32_16x16x32_bf16 v[56:59], v[80:83], v[100:103], v[56:59]
  v_mfma_f32_16x16x32_bf16 v[60:63], v[84:87], v[100:103], v[60:63]
  ds_read_b128 v[80:83], v7 offset:4096
  ds_read_b128 v[84:87], v7 offset:24576
  s_waitcnt lgkmcnt(4)
  v_mfma_f32_16x16x32_bf16 v[32:35], a[8:11], v[88:91], v[32:35]
  v_mfma_f32_16x16x32_bf16 v[36:39], a[8:11], v[92:95], v[36:39]
  v_mfma_f32_16x16x32_bf16 v[40:43], a[88:91], v[88:91], v[40:43]
  v_mfma_f32_16x16x32_bf16 v[44:47], a[88:91], v[92:95], v[44:47]
  v_mfma_f32_16x16x32_bf16 v[48:51], v[88:91], a[168:171], v[48:51]
  v_mfma_f32_16x16x32_bf16 v[52:55], v[92:95], a[168:171], v[52:55]
  v_mfma_f32_16x16x32_bf16 v[56:59], v[88:91], v[104:107], v[56:59]
  v_mfma_f32_16x16x32_bf16 v[60:63], v[92:95], v[104:107], v[60:63]
  ds_read_b128 v[88:91], v7 offset:5120
  ds_read_b128 v[92:95], v7 offset:25600
  s_waitcnt lgkmcnt(4)
  v_mfma_f32_16x16x32_bf16 v[32:35], a[12:15], v[72:75], v[32:35]
  v_mfma_f32_16x16x32_bf16 v[36:39], a[12:15], v[76:79], v[36:39]
  v_mfma_f32_16x16x32_bf16 v[40:43], a[92:95], v[72:75], v[40:43]
  v_mfma_f32_16x16x32_bf16 v[44:47], a[92:95], v[76:79], v[44:47]
  v_mfma_f32_16x16x32_bf16 v[48:51], v[72:75], a[172:175], v[48:51]
  v_mfma_f32_16x16x32_bf16 v[52:55], v[76:79], a[172:175], v[52:55]
  v_mfma_f32_16x16x32_bf16 v[56:59], v[72:75], v[108:111], v[56:59]
  v_mfma_f32_16x16x32_bf16 v[60:63], v[76:79], v[108:111], v[60:63]
  ds_read_b128 v[72:75], v7 offset:6144
  ds_read_b128 v[76:79], v7 offset:26624
  s_waitcnt lgkmcnt(4)
  v_mfma_f32_16x16x32_bf16 v[32:35], a[16:19], v[80:83], v[32:35]
  v_mfma_f32_16x16x32_bf16 v[36:39], a[16:19], v[84:87], v[36:39]
  v_mfma_f32_16x16x32_bf16 v[40:43], a[96:99], v[80:83], v[40:43]
  v_mfma_f32_16x16x32_bf16 v[44:47], a[96:99], v[84:87], v[44:47]
  v_mfma_f32_16x16x32_bf16 v[48:51], v[80:83], a[176:179], v[48:51]
  v_mfma_f32_16x16x32_bf16 v[52:55], v[84:87], a[176:179], v[52:55]
  v_mfma_f32_16x16x32_bf16 v[56:59], v[80:83], v[112:115], v[56:59]
  v_mfma_f32_16x16x32_bf16 v[60:63], v[84:87], v[112:115], v[60:63]
  ds_read_b128 v[80:83], v7 offset:7168
  ds_read_b128 v[84:87], v7 offset:27648
  s_waitcnt lgkmcnt(4)
  v_mfma_f32_16x16x32_bf16 v[32:35], a[20:23], v[88:91], v[32:35]
  v_mfma_f32_16x16x32_bf16 v[36:39], a[20:23], v[92:95], v[36:39]
  v_mfma_f32_16x16x32_bf16 v[40:43], a[100:103], v[88:91], v[40:43]
  v_mfma_f32_16x16x32_bf16 v[44:47], a[100:103], v[92:95], v[44:47]
  v_mfma_f32_16x16x32_bf16 v[48:51], v[88:91], a[180:183], v[48:51]
  v_mfma_f32_16x16x32_bf16 v[52:55], v[92:95], a[180:183], v[52:55]
  v_mfma_f32_16x16x32_bf16 v[56:59], v[88:91], v[116:119], v[56:59]
  v_mfma_f32_16x16x32_bf16 v[60:63], v[92:95], v[116:119], v[60:63]
  ds_read_b128 v[88:91], v7 offset:8192
  ds_read_b128 v[92:95], v7 offset:28672
  s_waitcnt lgkmcnt(4)
  v_mfma_f32_16x16x32_bf16 v[32:35], a[24:27], v[72:75], v[32:35]
  v_mfma_f32_16x16x32_bf16 v[36:39], a[24:27], v[76:79], v[36:39]
  v_mfma_f32_16x16x32_bf16 v[40:43], a[104:107], v[72:75], v[40:43]
  v_mfma_f32_16x16x32_bf16 v[44:47], a[104:107], v[76:79], v[44:47]
  v_mfma_f32_16x16x32_bf16 v[48:51], v[72:75], a[184:187], v[48:51]
  v_mfma_f32_16x16x32_bf16 v[52:55], v[76:79], a[184:187], v[52:55]
  v_mfma_f32_16x16x32_bf16 v[56:59], v[72:75], v[120:123], v[56:59]
  v_mfma_f32_16x16x32_bf16 v[60:63], v[76:79], v[120:123], v[60:63]
  ds_read_b128 v[72:75], v7 offset:9216
  ds_read_b128 v[76:79], v7 offset:29696
  s_waitcnt lgkmcnt(4)
  v_mfma_f32_16x16x32_bf16 v[32:35], a[28:31], v[80:83], v[32:35]
  v_mfma_f32_16x16x32_bf16 v[36:39], a[28:31], v[84:87], v[36:39]
  v_mfma_f32_16x16x32_bf16 v[40:43], a[108:111], v[80:83], v[40:43]
  v_mfma_f32_16x16x32_bf16 v[44:47], a[108:111], v[84:87], v[44:47]
  v_mfma_f32_16x16x32_bf16 v[48:51], v[80:83], a[188:191], v[48:51]
  v_mfma_f32_16x16x32_bf16 v[52:55], v[84:87], a[188:191], v[52:55]
  v_mfma_f32_16x16x32_bf16 v[56:59], v[80:83], v[124:127], v[56:59]
  v_mfma_f32_16x16x32_bf16 v[60:63], v[84:87], v[124:127], v[60:63]
  ds_read_b128 v[80:83], v7 offset:10240
  ds_read_b128 v[84:87], v7 offset:30720
  s_waitcnt lgkmcnt(4)
  v_mfma_f32_16x16x32_bf16 v[32:35], a[32:35], v[88:91], v[32:35]
  v_mfma_f32_16x16x32_bf16 v[36:39], a[32:35], v[92:95], v[36:39]
  v_mfma_f32_16x16x32_bf16 v[40:43], a[112:115], v[88:91], v[40:43]
  v_mfma_f32_16x16x32_bf16 v[44:47], a[112:115], v[92:95], v[44:47]
  v_mfma_f32_16x16x32_bf16 v[48:51], v[88:91], a[192:195], v[48:51]
  v_mfma_f32_16x16x32_bf16 v[52:55], v[92:95], a[192:195], v[52:55]
  v_mfma_f32_16x16x32_bf16 v[56:59], v[88:91], v[128:131], v[56:59]
  v_mfma_f32_16x16x32_bf16 v[60:63], v[92:95], v[128:131], v[60:63]
  ds_read_b128 v[88:91], v7 offset:11264
  ds_read_b128 v[92:95], v7 offset:31744
  s_waitcnt lgkmcnt(4)
  v_mfma_f32_16x16x32_bf16 v[32:35], a[36:39], v[72:75], v[32:35]
  v_mfma_f32_16x16x32_bf16 v[36:39], a[36:39], v[76:79], v[36:39]
  v_mfma_f32_16x16x32_bf16 v[40:43], a[116:119], v[72:75], v[40:43]
  v_mfma_f32_16x16x32_bf16 v[44:47], a[116:119], v[76:79], v[44:47]
  v_mfma_f32_16x16x32_bf16 v[48:51], v[72:75], a[196:199], v[48:51]
  v_mfma_f32_16x16x32_bf16 v[52:55], v[76:79], a[196:199], v[52:55]
  v_mfma_f32_16x16x32_bf16 v[56:59], v[72:75], v[132:135], v[56:59]
  v_mfma_f32_16x16x32_bf16 v[60:63], v[76:79], v[132:135], v[60:63]
  ds_read_b128 v[72:75], v7 offset:12288
  ds_read_b128 v[76:79], v7 offset:32768
  s_waitcnt lgkmcnt(4)
  v_mfma_f32_16x16x32_bf16 v[32:35], a[40:43], v[80:83], v[32:35]
  v_mfma_f32_16x16x32_bf16 v[36:39], a[40:43], v[84:87], v[36:39]
  v_mfma_f32_16x16x32_bf16 v[40:43], a[120:123], v[80:83], v[40:43]
  v_mfma_f32_16x16x32_bf16 v[44:47], a[120:123], v[84:87], v[44:47]
  v_mfma_f32_16x16x32_bf16 v[48:51], v[80:83], a[200:203], v[48:51]
  v_mfma_f32_16x16x32_bf16 v[52:55], v[84:87], a[200:203], v[52:55]
  v_mfma_f32_16x16x32_bf16 v[56:59], v[80:83], v[136:139], v[56:59]
  v_mfma_f32_16x16x32_bf16 v[60:63], v[84:87], v[136:139], v[60:63]
  ds_read_b128 v[80:83], v7 offset:13312
  ds_read_b128 v[84:87], v7 offset:33792
  s_waitcnt lgkmcnt(4)
  v_mfma_f32_16x16x32_bf16 v[32:35], a[44:47], v[88:91], v[32:35]
  v_mfma_f32_16x16x32_bf16 v[36:39], a[44:47], v[92:95], v[36:39]
  v_mfma_f32_16x16x32_bf16 v[40:43], a[124:127], v[88:91], v[40:43]
  v_mfma_f32_16x16x32_bf16 v[44:47], a[124:127], v[92:95], v[44:47]
  v_mfma_f32_16x16x32_bf16 v[48:51], v[88:91], a[204:207], v[48:51]
  v_mfma_f32_16x16x32_bf16 v[52:55], v[92:95], a[204:207], v[52:55]
  v_mfma_f32_16x16x32_bf16 v[56:59], v[88:91], v[140:143], v[56:59]
  v_mfma_f32_16x16x32_bf16 v[60:63], v[92:95], v[140:143], v[60:63]
  ds_read_b128 v[88:91], v7 offset:14336
  ds_read_b128 v[92:95], v7 offset:34816
  s_waitcnt lgkmcnt(4)
  v_mfma_f32_16x16x32_bf16 v[32:35], a[48:51], v[72:75], v[32:35]
  v_mfma_f32_16x16x32_bf16 v[36:39], a[48:51], v[76:79], v[36:39]
  v_mfma_f32_16x16x32_bf16 v[40:43], a[128:131], v[72:75], v[40:43]
  v_mfma_f32_16x16x32_bf16 v[44:47], a[128:131], v[76:79], v[44:47]
  v_mfma_f32_16x16x32_bf16 v[48:51], v[72:75], a[208:211], v[48:51]
  v_mfma_f32_16x16x32_bf16 v[52:55], v[76:79], a[208:211], v[52:55]
  v_mfma_f32_16x16x32_bf16 v[56:59], v[72:75], v[144:147], v[56:59]
  v_mfma_f32_16x16x32_bf16 v[60:63], v[76:79], v[144:147], v[60:63]
  ds_read_b128 v[72:75], v7 offset:15360
  ds_read_b128 v[76:79], v7 offset:35840
  s_waitcnt lgkmcnt(4)
  v_mfma_f32_16x16x32_bf16 v[32:35], a[52:55], v[80:83], v[32:35]
  v_mfma_f32_16x16x32_bf16 v[36:39], a[52:55], v[84:87], v[36:39]
  v_mfma_f32_16x16x32_bf16 v[40:43], a[132:135], v[80:83], v[40:43]
  v_mfma_f32_16x16x32_bf16 v[44:47], a[132:135], v[84:87], v[44:47]
  v_mfma_f32_16x16x32_bf16 v[48:51], v[80:83], a[212:215], v[48:51]
  v_mfma_f32_16x16x32_bf16 v[52:55], v[84:87], a[212:215], v[52:55]
  v_mfma_f32_16x16x32_bf16 v[56:59], v[80:83], v[148:151], v[56:59]
  v_mfma_f32_16x16x32_bf16 v[60:63], v[84:87], v[148:151], v[60:63]
  ds_read_b128 v[80:83], v7 offset:16384
  ds_read_b128 v[84:87], v7 offset:36864
  s_waitcnt lgkmcnt(4)
  v_mfma_f32_16x16x32_bf16 v[32:35], a[56:59], v[88:91], v[32:35]
  v_mfma_f32_16x16x32_bf16 v[36:39], a[56:59], v[92:95], v[36:39]
  v_mfma_f32_16x16x32_bf16 v[40:43], a[136:139], v[88:91], v[40:43]
  v_mfma_f32_16x16x32_bf16 v[44:47], a[136:139], v[92:95], v[44:47]
  v_mfma_f32_16x16x32_bf16 v[48:51], v[88:91], a[216:219], v[48:51]
  v_mfma_f32_16x16x32_bf16 v[52:55], v[92:95], a[216:219], v[52:55]
  v_mfma_f32_16x16x32_bf16 v[56:59], v[88:91], v[152:155], v[56:59]
  v_mfma_f32_16x16x32_bf16 v[60:63], v[92:95], v[152:155], v[60:63]
  ds_read_b128 v[88:91], v7 offset:17408
  ds_read_b128 v[92:95], v7 offset:37888
  s_waitcnt lgkmcnt(4)
  v_mfma_f32_16x16x32_bf16 v[32:35], a[60:63], v[72:75], v[32:35]
  v_mfma_f32_16x16x32_bf16 v[36:39], a[60:63], v[76:79], v[36:39]
  v_mfma_f32_16x16x32_bf16 v[40:43], a[140:143], v[72:75], v[40:43]
  v_mfma_f32_16x16x32_bf16 v[44:47], a[140:143], v[76:79], v[44:47]
  v_mfma_f32_16x16x32_bf16 v[48:51], v[72:75], a[220:223], v[48:51]
  v_mfma_f32_16x16x32_bf16 v[52:55], v[76:79], a[220:223], v[52:55]
  v_mfma_f32_16x16x32_bf16 v[56:59], v[72:75], v[156:159], v[56:59]
  v_mfma_f32_16x16x32_bf16 v[60:63], v[76:79], v[156:159], v[60:63]
  ds_read_b128 v[72:75], v7 offset:18432
  ds_read_b128 v[76:79], v7 offset:38912
  s_waitcnt lgkmcnt(4)
  v_mfma_f32_16x16x32_bf16 v[32:35], a[64:67], v[80:83], v[32:35]
  v_mfma_f32_16x16x32_bf16 v[36:39], a[64:67], v[84:87], v[36:39]
  v_mfma_f32_16x16x32_bf16 v[40:43], a[144:147], v[80:83], v[40:43]
  v_mfma_f32_16x16x32_bf16 v[44:47], a[144:147], v[84:87], v[44:47]
  v_mfma_f32_16x16x32_bf16 v[48:51], v[80:83], a[224:227], v[48:51]
  v_mfma_f32_16x16x32_bf16 v[52:55], v[84:87], a[224:227], v[52:55]
  v_mfma_f32_16x16x32_bf16 v[56:59], v[80:83], v[160:163], v[56:59]
  v_mfma_f32_16x16x32_bf16 v[60:63], v[84:87], v[160:163], v[60:63]
  ds_read_b128 v[80:83], v7 offset:19456
  ds_read_b128 v[84:87], v7 offset:39936
  s_waitcnt lgkmcnt(4)
  v_mfma_f32_16x16x32_bf16 v[32:35], a[68:71], v[88:91], v[32:35]
  v_mfma_f32_16x16x32_bf16 v[36:39], a[68:71], v[92:95], v[36:39]
  v_mfma_f32_16x16x32_bf16 v[40:43], a[148:151], v[88:91], v[40:43]
  v_mfma_f32_16x16x32_bf16 v[44:47], a[148:151], v[92:95], v[44:47]
  v_mfma_f32_16x16x32_bf16 v[48:51], v[88:91], a[228:231], v[48:51]
  v_mfma_f32_16x16x32_bf16 v[52:55], v[92:95], a[228:231], v[52:55]
  v_mfma_f32_16x16x32_bf16 v[56:59], v[88:91], v[164:167], v[56:59]
  v_mfma_f32_16x16x32_bf16 v[60:63], v[92:95], v[164:167], v[60:63]
  s_waitcnt lgkmcnt(2)
  v_mfma_f32_16x16x32_bf16 v[32:35], a[72:75], v[72:75], v[32:35]
  v_mfma_f32_16x16x32_bf16 v[36:39], a[72:75], v[76:79], v[36:39]
  v_mfma_f32_16x16x32_bf16 v[40:43], a[152:155], v[72:75], v[40:43]
  v_mfma_f32_16x16x32_bf16 v[44:47], a[152:155], v[76:79], v[44:47]
  v_mfma_f32_16x16x32_bf16 v[48:51], v[72:75], a[232:235], v[48:51]
  v_mfma_f32_16x16x32_bf16 v[52:55], v[76:79], a[232:235], v[52:55]
  v_mfma_f32_16x16x32_bf16 v[56:59], v[72:75], v[168:171], v[56:59]
  v_mfma_f32_16x16x32_bf16 v[60:63], v[76:79], v[168:171], v[60:63]
  s_waitcnt lgkmcnt(0)
  v_mfma_f32_16x16x32_bf16 v[32:35], a[76:79], v[80:83], v[32:35]
  v_mfma_f32_16x16x32_bf16 v[36:39], a[76:79], v[84:87], v[36:39]
  v_mfma_f32_16x16x32_bf16 v[40:43], a[156:159], v[80:83], v[40:43]
  v_mfma_f32_16x16x32_bf16 v[44:47], a[156:159], v[84:87], v[44:47]
  v_mfma_f32_16x16x32_bf16 v[48:51], v[80:83], a[236:239], v[48:51]
  v_mfma_f32_16x16x32_bf16 v[52:55], v[84:87], a[236:239], v[52:55]
  v_mfma_f32_16x16x32_bf16 v[56:59], v[80:83], v[172:175], v[56:59]
  v_mfma_f32_16x16x32_bf16 v[60:63], v[84:87], v[172:175], v[60:63]
  s_nop 0
  v_cvt_pk_bf16_f32 v8, v32, v33
  v_cvt_pk_bf16_f32 v9, v34, v35
  v_cvt_pk_bf16_f32 v10, v40, v41
  v_cvt_pk_bf16_f32 v11, v42, v43
  s_add_u32 s34, s22, 0
  buffer_store_dwordx4 v[8:11], v1, s[4:7], s34 offen
  v_cvt_pk_bf16_f32 v12, v36, v37
  v_cvt_pk_bf16_f32 v13, v38, v39
  v_cvt_pk_bf16_f32 v14, v44, v45
  v_cvt_pk_bf16_f32 v15, v46, v47
  s_add_u32 s34, s22, 6144
  buffer_store_dwordx4 v[12:15], v1, s[4:7], s34 offen
  v_cvt_pk_bf16_f32 v8, v48, v49
  v_cvt_pk_bf16_f32 v9, v50, v51
  v_cvt_pk_bf16_f32 v10, v52, v53
  v_cvt_pk_bf16_f32 v11, v54, v55
  s_add_u32 s34, s23, 4096
  buffer_store_dwordx4 v[8:11], v1, s[4:7], s34 offen
  v_cvt_pk_bf16_f32 v12, v56, v57
  v_cvt_pk_bf16_f32 v13, v58, v59
  v_cvt_pk_bf16_f32 v14, v60, v61
  v_cvt_pk_bf16_f32 v15, v62, v63
  s_add_u32 s34, s23, 5120
  buffer_store_dwordx4 v[12:15], v1, s[4:7], s34 offen
  s_waitcnt vmcnt(0)
  s_barrier
  s_add_u32 s17, s17, 1
  s_cmp_lt_u32 s17, 64
  s_cbranch_scc1 reca_ptop259
  s_branch reca_exit1
reca_pslow258:
reca_ptop264:
  s_cmp_lt_u32 s17, 6
  s_cbranch_scc1 reca_pgo265
  s_sub_u32 s36, s17, 6
reca_ppoll266:
  buffer_load_dword v28, v4, s[4:7], s25 offen sc1
  s_waitcnt vmcnt(0)
  v_readfirstlane_b32 s34, v28
  s_nop 3
  s_cmp_ge_i32 s34, s36
  s_cbranch_scc1 reca_pgo265
  s_sleep 8
  s_sub_u32 s18, s18, 1
  s_cbranch_scc0 reca_ppoll266
  s_mov_b32 s18, 0
reca_pgo265:
  s_waitcnt vmcnt(0)
  s_barrier
  v_add_u32 v7, s26, v1
  s_xor_b32 s26, s26, 40960
  s_add_u32 s37, s17, 1
  s_cmp_ge_u32 s37, 64
  s_cbranch_scc1 reca_pnodma267
  s_mul_i32 s20, s37, 40960
  s_add_u32 s20, s20, 87576576
  s_add_u32 m0, s26, 20480
  s_nop 0
  buffer_load_dwordx4 v1, s[4:7], s20 offen offset:0 lds
  buffer_load_dwordx4 v1, s[4:7], s20 offen offset:1024 lds
  buffer_load_dwordx4 v1, s[4:7], s20 offen offset:2048 lds
  buffer_load_dwordx4 v1, s[4:7], s20 offen offset:3072 lds
  s_add_u32 s20, s20, 4096
  s_add_u32 m0, s26, 24576
  s_nop 0
  buffer_load_dwordx4 v1, s[4:7], s20 offen offset:0 lds
  buffer_load_dwordx4 v1, s[4:7], s20 offen offset:1024 lds
  buffer_load_dwordx4 v1, s[4:7], s20 offen offset:2048 lds
  buffer_load_dwordx4 v1, s[4:7], s20 offen offset:3072 lds
  s_add_u32 s20, s20, 4096
  s_add_u32 m0, s26, 28672
  s_nop 0
  buffer_load_dwordx4 v1, s[4:7], s20 offen offset:0 lds
  buffer_load_dwordx4 v1, s[4:7], s20 offen offset:1024 lds
  s_lshl_b32 s34, s15, 4
  s_and_b32 s35, s37, 15
  s_add_u32 s34, s34, s35
  s_mul_i32 s34, s34, 12288
  s_mul_i32 s35, s16, 3072
  s_add_u32 s35, s35, s34
  s_add_u32 s27, s35, 37748736
  s_add_u32 s30, s35, 50331648
  s_mul_i32 s35, s16, 6144
  s_add_u32 s35, s35, s34
  s_add_u32 s28, s35, 44040192
  s_add_u32 s34, s30, 0
  buffer_load_dwordx4 v[16:19], v1, s[4:7], s34 offen sc1
  s_add_u32 s34, s30, 6144
  buffer_load_dwordx4 v[16:19], v1, s[4:7], s34 offen sc1
  s_add_u32 s34, s28, 4096
  buffer_load_dwordx4 v[16:19], v1, s[4:7], s34 offen sc1
  s_add_u32 s34, s28, 5120
  buffer_load_dwordx4 v[16:19], v1, s[4:7], s34 offen sc1
  s_lshl_b32 s34, s37, 1
  s_add_u32 s34, s34, s16
  s_mul_i32 s34, s34, 196608
  s_mul_i32 s35, s15, 6144
  s_add_u32 s34, s34, s35
  s_add_u32 s34, s34, 59770880
  buffer_load_dwordx4 v[16:19], v1, s[4:7], s34 offen sc1
  buffer_load_dwordx4 v[16:19], v1, s[4:7], s34 offen offset:1024 sc1
reca_pnodma267:
  s_lshl_b32 s34, s15, 4
  s_and_b32 s35, s17, 15
  s_add_u32 s34, s34, s35
  s_mul_i32 s34, s34, 12288
  s_mul_i32 s35, s16, 3072
  s_add_u32 s35, s35, s34
  s_add_u32 s21, s35, 37748736
  s_add_u32 s22, s35, 50331648
  s_mul_i32 s35, s16, 6144
  s_add_u32 s35, s35, s34
  s_add_u32 s23, s35, 44040192
  ds_read_b128 v[72:75], v7 offset:0
  ds_read_b128 v[76:79], v7 offset:20480
  ds_read_b128 v[80:83], v7 offset:1024
  ds_read_b128 v[84:87], v7 offset:21504
  ds_read_b128 v[88:91], v7 offset:2048
  ds_read_b128 v[92:95], v7 offset:22528
  s_waitcnt lgkmcnt(4)
  v_mfma_f32_16x16x32_bf16 v[32:35], a[0:3], v[72:75], 0
  v_mfma_f32_16x16x32_bf16 v[36:39], a[0:3], v[76:79], 0
  v_mfma_f32_16x16x32_bf16 v[40:43], a[80:83], v[72:75], 0
  v_mfma_f32_16x16x32_bf16 v[44:47], a[80:83], v[76:79], 0
  v_mfma_f32_16x16x32_bf16 v[48:51], v[72:75], a[160:163], 0
  v_mfma_f32_16x16x32_bf16 v[52:55], v[76:79], a[160:163], 0
  v_mfma_f32_16x16x32_bf16 v[56:59], v[72:75], v[96:99], 0
  v_mfma_f32_16x16x32_bf16 v[60:63], v[76:79], v[96:99], 0
  ds_read_b128 v[72:75], v7 offset:3072
  ds_read_b128 v[76:79], v7 offset:23552
  s_waitcnt lgkmcnt(4)
  v_mfma_f32_16x16x32_bf16 v[32:35], a[4:7], v[80:83], v[32:35]
  v_mfma_f32_16x16x32_bf16 v[36:39], a[4:7], v[84:87], v[36:39]
  v_mfma_f32_16x16x32_bf16 v[40:43], a[84:87], v[80:83], v[40:43]
  v_mfma_f32_16x16x32_bf16 v[44:47], a[84:87], v[84:87], v[44:47]
  v_mfma_f32_16x16x32_bf16 v[48:51], v[80:83], a[164:167], v[48:51]
  v_mfma_f32_16x16x32_bf16 v[52:55], v[84:87], a[164:167], v[52:55]
  v_mfma_f32_16x16x32_bf16 v[56:59], v[80:83], v[100:103], v[56:59]
  v_mfma_f32_16x16x32_bf16 v[60:63], v[84:87], v[100:103], v[60:63]
  ds_read_b128 v[80:83], v7 offset:4096
  ds_read_b128 v[84:87], v7 offset:24576
  s_waitcnt lgkmcnt(4)
  v_mfma_f32_16x16x32_bf16 v[32:35], a[8:11], v[88:91], v[32:35]
  v_mfma_f32_16x16x32_bf16 v[36:39], a[8:11], v[92:95], v[36:39]
  v_mfma_f32_16x16x32_bf16 v[40:43], a[88:91], v[88:91], v[40:43]
  v_mfma_f32_16x16x32_bf16 v[44:47], a[88:91], v[92:95], v[44:47]
  v_mfma_f32_16x16x32_bf16 v[48:51], v[88:91], a[168:171], v[48:51]
  v_mfma_f32_16x16x32_bf16 v[52:55], v[92:95], a[168:171], v[52:55]
  v_mfma_f32_16x16x32_bf16 v[56:59], v[88:91], v[104:107], v[56:59]
  v_mfma_f32_16x16x32_bf16 v[60:63], v[92:95], v[104:107], v[60:63]
  ds_read_b128 v[88:91], v7 offset:5120
  ds_read_b128 v[92:95], v7 offset:25600
  s_waitcnt lgkmcnt(4)
  v_mfma_f32_16x16x32_bf16 v[32:35], a[12:15], v[72:75], v[32:35]
  v_mfma_f32_16x16x32_bf16 v[36:39], a[12:15], v[76:79], v[36:39]
  v_mfma_f32_16x16x32_bf16 v[40:43], a[92:95], v[72:75], v[40:43]
  v_mfma_f32_16x16x32_bf16 v[44:47], a[92:95], v[76:79], v[44:47]
  v_mfma_f32_16x16x32_bf16 v[48:51], v[72:75], a[172:175], v[48:51]
  v_mfma_f32_16x16x32_bf16 v[52:55], v[76:79], a[172:175], v[52:55]
  v_mfma_f32_16x16x32_bf16 v[56:59], v[72:75], v[108:111], v[56:59]
  v_mfma_f32_16x16x32_bf16 v[60:63], v[76:79], v[108:111], v[60:63]
  ds_read_b128 v[72:75], v7 offset:6144
  ds_read_b128 v[76:79], v7 offset:26624
  s_waitcnt lgkmcnt(4)
  v_mfma_f32_16x16x32_bf16 v[32:35], a[16:19], v[80:83], v[32:35]
  v_mfma_f32_16x16x32_bf16 v[36:39], a[16:19], v[84:87], v[36:39]
  v_mfma_f32_16x16x32_bf16 v[40:43], a[96:99], v[80:83], v[40:43]
  v_mfma_f32_16x16x32_bf16 v[44:47], a[96:99], v[84:87], v[44:47]
  v_mfma_f32_16x16x32_bf16 v[48:51], v[80:83], a[176:179], v[48:51]
  v_mfma_f32_16x16x32_bf16 v[52:55], v[84:87], a[176:179], v[52:55]
  v_mfma_f32_16x16x32_bf16 v[56:59], v[80:83], v[112:115], v[56:59]
  v_mfma_f32_16x16x32_bf16 v[60:63], v[84:87], v[112:115], v[60:63]
  ds_read_b128 v[80:83], v7 offset:7168
  ds_read_b128 v[84:87], v7 offset:27648
  s_waitcnt lgkmcnt(4)
  v_mfma_f32_16x16x32_bf16 v[32:35], a[20:23], v[88:91], v[32:35]
  v_mfma_f32_16x16x32_bf16 v[36:39], a[20:23], v[92:95], v[36:39]
  v_mfma_f32_16x16x32_bf16 v[40:43], a[100:103], v[88:91], v[40:43]
  v_mfma_f32_16x16x32_bf16 v[44:47], a[100:103], v[92:95], v[44:47]
  v_mfma_f32_16x16x32_bf16 v[48:51], v[88:91], a[180:183], v[48:51]
  v_mfma_f32_16x16x32_bf16 v[52:55], v[92:95], a[180:183], v[52:55]
  v_mfma_f32_16x16x32_bf16 v[56:59], v[88:91], v[116:119], v[56:59]
  v_mfma_f32_16x16x32_bf16 v[60:63], v[92:95], v[116:119], v[60:63]
  ds_read_b128 v[88:91], v7 offset:8192
  ds_read_b128 v[92:95], v7 offset:28672
  s_waitcnt lgkmcnt(4)
  v_mfma_f32_16x16x32_bf16 v[32:35], a[24:27], v[72:75], v[32:35]
  v_mfma_f32_16x16x32_bf16 v[36:39], a[24:27], v[76:79], v[36:39]
  v_mfma_f32_16x16x32_bf16 v[40:43], a[104:107], v[72:75], v[40:43]
  v_mfma_f32_16x16x32_bf16 v[44:47], a[104:107], v[76:79], v[44:47]
  v_mfma_f32_16x16x32_bf16 v[48:51], v[72:75], a[184:187], v[48:51]
  v_mfma_f32_16x16x32_bf16 v[52:55], v[76:79], a[184:187], v[52:55]
  v_mfma_f32_16x16x32_bf16 v[56:59], v[72:75], v[120:123], v[56:59]
  v_mfma_f32_16x16x32_bf16 v[60:63], v[76:79], v[120:123], v[60:63]
  ds_read_b128 v[72:75], v7 offset:9216
  ds_read_b128 v[76:79], v7 offset:29696
  s_waitcnt lgkmcnt(4)
  v_mfma_f32_16x16x32_bf16 v[32:35], a[28:31], v[80:83], v[32:35]
  v_mfma_f32_16x16x32_bf16 v[36:39], a[28:31], v[84:87], v[36:39]
  v_mfma_f32_16x16x32_bf16 v[40:43], a[108:111], v[80:83], v[40:43]
  v_mfma_f32_16x16x32_bf16 v[44:47], a[108:111], v[84:87], v[44:47]
  v_mfma_f32_16x16x32_bf16 v[48:51], v[80:83], a[188:191], v[48:51]
  v_mfma_f32_16x16x32_bf16 v[52:55], v[84:87], a[188:191], v[52:55]
  v_mfma_f32_16x16x32_bf16 v[56:59], v[80:83], v[124:127], v[56:59]
  v_mfma_f32_16x16x32_bf16 v[60:63], v[84:87], v[124:127], v[60:63]
  ds_read_b128 v[80:83], v7 offset:10240
  ds_read_b128 v[84:87], v7 offset:30720
  s_waitcnt lgkmcnt(4)
  v_mfma_f32_16x16x32_bf16 v[32:35], a[32:35], v[88:91], v[32:35]
  v_mfma_f32_16x16x32_bf16 v[36:39], a[32:35], v[92:95], v[36:39]
  v_mfma_f32_16x16x32_bf16 v[40:43], a[112:115], v[88:91], v[40:43]
  v_mfma_f32_16x16x32_bf16 v[44:47], a[112:115], v[92:95], v[44:47]
  v_mfma_f32_16x16x32_bf16 v[48:51], v[88:91], a[192:195], v[48:51]
  v_mfma_f32_16x16x32_bf16 v[52:55], v[92:95], a[192:195], v[52:55]
  v_mfma_f32_16x16x32_bf16 v[56:59], v[88:91], v[128:131], v[56:59]
  v_mfma_f32_16x16x32_bf16 v[60:63], v[92:95], v[128:131], v[60:63]
  ds_read_b128 v[88:91], v7 offset:11264
  ds_read_b128 v[92:95], v7 offset:31744
  s_waitcnt lgkmcnt(4)
  v_mfma_f32_16x16x32_bf16 v[32:35], a[36:39], v[72:75], v[32:35]
  v_mfma_f32_16x16x32_bf16 v[36:39], a[36:39], v[76:79], v[36:39]
  v_mfma_f32_16x16x32_bf16 v[40:43], a[116:119], v[72:75], v[40:43]
  v_mfma_f32_16x16x32_bf16 v[44:47], a[116:119], v[76:79], v[44:47]
  v_mfma_f32_16x16x32_bf16 v[48:51], v[72:75], a[196:199], v[48:51]
  v_mfma_f32_16x16x32_bf16 v[52:55], v[76:79], a[196:199], v[52:55]
  v_mfma_f32_16x16x32_bf16 v[56:59], v[72:75], v[132:135], v[56:59]
  v_mfma_f32_16x16x32_bf16 v[60:63], v[76:79], v[132:135], v[60:63]
  ds_read_b128 v[72:75], v7 offset:12288
  ds_read_b128 v[76:79], v7 offset:32768
  s_waitcnt lgkmcnt(4)
  v_mfma_f32_16x16x32_bf16 v[32:35], a[40:43], v[80:83], v[32:35]
  v_mfma_f32_16x16x32_bf16 v[36:39], a[40:43], v[84:87], v[36:39]
  v_mfma_f32_16x16x32_bf16 v[40:43], a[120:123], v[80:83], v[40:43]
  v_mfma_f32_16x16x32_bf16 v[44:47], a[120:123], v[84:87], v[44:47]
  v_mfma_f32_16x16x32_bf16 v[48:51], v[80:83], a[200:203], v[48:51]
  v_mfma_f32_16x16x32_bf16 v[52:55], v[84:87], a[200:203], v[52:55]
  v_mfma_f32_16x16x32_bf16 v[56:59], v[80:83], v[136:139], v[56:59]
  v_mfma_f32_16x16x32_bf16 v[60:63], v[84:87], v[136:139], v[60:63]
  ds_read_b128 v[80:83], v7 offset:13312
  ds_read_b128 v[84:87], v7 offset:33792
  s_waitcnt lgkmcnt(4)
  v_mfma_f32_16x16x32_bf16 v[32:35], a[44:47], v[88:91], v[32:35]
  v_mfma_f32_16x16x32_bf16 v[36:39], a[44:47], v[92:95], v[36:39]
  v_mfma_f32_16x16x32_bf16 v[40:43], a[124:127], v[88:91], v[40:43]
  v_mfma_f32_16x16x32_bf16 v[44:47], a[124:127], v[92:95], v[44:47]
  v_mfma_f32_16x16x32_bf16 v[48:51], v[88:91], a[204:207], v[48:51]
  v_mfma_f32_16x16x32_bf16 v[52:55], v[92:95], a[204:207], v[52:55]
  v_mfma_f32_16x16x32_bf16 v[56:59], v[88:91], v[140:143], v[56:59]
  v_mfma_f32_16x16x32_bf16 v[60:63], v[92:95], v[140:143], v[60:63]
  ds_read_b128 v[88:91], v7 offset:14336
  ds_read_b128 v[92:95], v7 offset:34816
  s_waitcnt lgkmcnt(4)
  v_mfma_f32_16x16x32_bf16 v[32:35], a[48:51], v[72:75], v[32:35]
  v_mfma_f32_16x16x32_bf16 v[36:39], a[48:51], v[76:79], v[36:39]
  v_mfma_f32_16x16x32_bf16 v[40:43], a[128:131], v[72:75], v[40:43]
  v_mfma_f32_16x16x32_bf16 v[44:47], a[128:131], v[76:79], v[44:47]
  v_mfma_f32_16x16x32_bf16 v[48:51], v[72:75], a[208:211], v[48:51]
  v_mfma_f32_16x16x32_bf16 v[52:55], v[76:79], a[208:211], v[52:55]
  v_mfma_f32_16x16x32_bf16 v[56:59], v[72:75], v[144:147], v[56:59]
  v_mfma_f32_16x16x32_bf16 v[60:63], v[76:79], v[144:147], v[60:63]
  ds_read_b128 v[72:75], v7 offset:15360
  ds_read_b128 v[76:79], v7 offset:35840
  s_waitcnt lgkmcnt(4)
  v_mfma_f32_16x16x32_bf16 v[32:35], a[52:55], v[80:83], v[32:35]
  v_mfma_f32_16x16x32_bf16 v[36:39], a[52:55], v[84:87], v[36:39]
  v_mfma_f32_16x16x32_bf16 v[40:43], a[132:135], v[80:83], v[40:43]
  v_mfma_f32_16x16x32_bf16 v[44:47], a[132:135], v[84:87], v[44:47]
  v_mfma_f32_16x16x32_bf16 v[48:51], v[80:83], a[212:215], v[48:51]
  v_mfma_f32_16x16x32_bf16 v[52:55], v[84:87], a[212:215], v[52:55]
  v_mfma_f32_16x16x32_bf16 v[56:59], v[80:83], v[148:151], v[56:59]
  v_mfma_f32_16x16x32_bf16 v[60:63], v[84:87], v[148:151], v[60:63]
  ds_read_b128 v[80:83], v7 offset:16384
  ds_read_b128 v[84:87], v7 offset:36864
  s_waitcnt lgkmcnt(4)
  v_mfma_f32_16x16x32_bf16 v[32:35], a[56:59], v[88:91], v[32:35]
  v_mfma_f32_16x16x32_bf16 v[36:39], a[56:59], v[92:95], v[36:39]
  v_mfma_f32_16x16x32_bf16 v[40:43], a[136:139], v[88:91], v[40:43]
  v_mfma_f32_16x16x32_bf16 v[44:47], a[136:139], v[92:95], v[44:47]
  v_mfma_f32_16x16x32_bf16 v[48:51], v[88:91], a[216:219], v[48:51]
  v_mfma_f32_16x16x32_bf16 v[52:55], v[92:95], a[216:219], v[52:55]
  v_mfma_f32_16x16x32_bf16 v[56:59], v[88:91], v[152:155], v[56:59]
  v_mfma_f32_16x16x32_bf16 v[60:63], v[92:95], v[152:155], v[60:63]
  ds_read_b128 v[88:91], v7 offset:17408
  ds_read_b128 v[92:95], v7 offset:37888
  s_waitcnt lgkmcnt(4)
  v_mfma_f32_16x16x32_bf16 v[32:35], a[60:63], v[72:75], v[32:35]
  v_mfma_f32_16x16x32_bf16 v[36:39], a[60:63], v[76:79], v[36:39]
  v_mfma_f32_16x16x32_bf16 v[40:43], a[140:143], v[72:75], v[40:43]
  v_mfma_f32_16x16x32_bf16 v[44:47], a[140:143], v[76:79], v[44:47]
  v_mfma_f32_16x16x32_bf16 v[48:51], v[72:75], a[220:223], v[48:51]
  v_mfma_f32_16x16x32_bf16 v[52:55], v[76:79], a[220:223], v[52:55]
  v_mfma_f32_16x16x32_bf16 v[56:59], v[72:75], v[156:159], v[56:59]
  v_mfma_f32_16x16x32_bf16 v[60:63], v[76:79], v[156:159], v[60:63]
  ds_read_b128 v[72:75], v7 offset:18432
  ds_read_b128 v[76:79], v7 offset:38912
  s_waitcnt lgkmcnt(4)
  v_mfma_f32_16x16x32_bf16 v[32:35], a[64:67], v[80:83], v[32:35]
  v_mfma_f32_16x16x32_bf16 v[36:39], a[64:67], v[84:87], v[36:39]
  v_mfma_f32_16x16x32_bf16 v[40:43], a[144:147], v[80:83], v[40:43]
  v_mfma_f32_16x16x32_bf16 v[44:47], a[144:147], v[84:87], v[44:47]
  v_mfma_f32_16x16x32_bf16 v[48:51], v[80:83], a[224:227], v[48:51]
  v_mfma_f32_16x16x32_bf16 v[52:55], v[84:87], a[224:227], v[52:55]
  v_mfma_f32_16x16x32_bf16 v[56:59], v[80:83], v[160:163], v[56:59]
  v_mfma_f32_16x16x32_bf16 v[60:63], v[84:87], v[160:163], v[60:63]
  ds_read_b128 v[80:83], v7 offset:19456
  ds_read_b128 v[84:87], v7 offset:39936
  s_waitcnt lgkmcnt(4)
  v_mfma_f32_16x16x32_bf16 v[32:35], a[68:71], v[88:91], v[32:35]
  v_mfma_f32_16x16x32_bf16 v[36:39], a[68:71], v[92:95], v[36:39]
  v_mfma_f32_16x16x32_bf16 v[40:43], a[148:151], v[88:91], v[40:43]
  v_mfma_f32_16x16x32_bf16 v[44:47], a[148:151], v[92:95], v[44:47]
  v_mfma_f32_16x16x32_bf16 v[48:51], v[88:91], a[228:231], v[48:51]
  v_mfma_f32_16x16x32_bf16 v[52:55], v[92:95], a[228:231], v[52:55]
  v_mfma_f32_16x16x32_bf16 v[56:59], v[88:91], v[164:167], v[56:59]
  v_mfma_f32_16x16x32_bf16 v[60:63], v[92:95], v[164:167], v[60:63]
  s_waitcnt lgkmcnt(2)
  v_mfma_f32_16x16x32_bf16 v[32:35], a[72:75], v[72:75], v[32:35]
  v_mfma_f32_16x16x32_bf16 v[36:39], a[72:75], v[76:79], v[36:39]
  v_mfma_f32_16x16x32_bf16 v[40:43], a[152:155], v[72:75], v[40:43]
  v_mfma_f32_16x16x32_bf16 v[44:47], a[152:155], v[76:79], v[44:47]
  v_mfma_f32_16x16x32_bf16 v[48:51], v[72:75], a[232:235], v[48:51]
  v_mfma_f32_16x16x32_bf16 v[52:55], v[76:79], a[232:235], v[52:55]
  v_mfma_f32_16x16x32_bf16 v[56:59], v[72:75], v[168:171], v[56:59]
  v_mfma_f32_16x16x32_bf16 v[60:63], v[76:79], v[168:171], v[60:63]
  s_waitcnt lgkmcnt(0)
  v_mfma_f32_16x16x32_bf16 v[32:35], a[76:79], v[80:83], v[32:35]
  v_mfma_f32_16x16x32_bf16 v[36:39], a[76:79], v[84:87], v[36:39]
  v_mfma_f32_16x16x32_bf16 v[40:43], a[156:159], v[80:83], v[40:43]
  v_mfma_f32_16x16x32_bf16 v[44:47], a[156:159], v[84:87], v[44:47]
  v_mfma_f32_16x16x32_bf16 v[48:51], v[80:83], a[236:239], v[48:51]
  v_mfma_f32_16x16x32_bf16 v[52:55], v[84:87], a[236:239], v[52:55]
  v_mfma_f32_16x16x32_bf16 v[56:59], v[80:83], v[172:175], v[56:59]
  v_mfma_f32_16x16x32_bf16 v[60:63], v[84:87], v[172:175], v[60:63]
  s_nop 0
  v_cvt_pk_bf16_f32 v8, v32, v33
  v_cvt_pk_bf16_f32 v9, v34, v35
  v_cvt_pk_bf16_f32 v10, v40, v41
  v_cvt_pk_bf16_f32 v11, v42, v43
  s_add_u32 s34, s22, 0
  buffer_store_dwordx4 v[8:11], v1, s[4:7], s34 offen sc1
  v_cvt_pk_bf16_f32 v12, v36, v37
  v_cvt_pk_bf16_f32 v13, v38, v39
  v_cvt_pk_bf16_f32 v14, v44, v45
  v_cvt_pk_bf16_f32 v15, v46, v47
  s_add_u32 s34, s22, 6144
  buffer_store_dwordx4 v[12:15], v1, s[4:7], s34 offen sc1
  v_cvt_pk_bf16_f32 v8, v48, v49
  v_cvt_pk_bf16_f32 v9, v50, v51
  v_cvt_pk_bf16_f32 v10, v52, v53
  v_cvt_pk_bf16_f32 v11, v54, v55
  s_add_u32 s34, s23, 4096
  buffer_store_dwordx4 v[8:11], v1, s[4:7], s34 offen sc1
  v_cvt_pk_bf16_f32 v12, v56, v57
  v_cvt_pk_bf16_f32 v13, v58, v59
  v_cvt_pk_bf16_f32 v14, v60, v61
  v_cvt_pk_bf16_f32 v15, v62, v63
  s_add_u32 s34, s23, 5120
  buffer_store_dwordx4 v[12:15], v1, s[4:7], s34 offen sc1
  s_waitcnt vmcnt(0)
  s_barrier
  s_add_u32 s17, s17, 1
  s_cmp_lt_u32 s17, 64
  s_cbranch_scc1 reca_ptop264
  s_branch reca_exit1
reca_pw3_229:
  s_mov_b32 s17, 0
  s_mov_b32 s26, 0
  s_mul_i32 s20, s17, 40960
  s_add_u32 s20, s20, 87586816
  s_add_u32 m0, s26, 30720
  s_nop 0
  buffer_load_dwordx4 v1, s[4:7], s20 offen offset:0 lds
  buffer_load_dwordx4 v1, s[4:7], s20 offen offset:1024 lds
  buffer_load_dwordx4 v1, s[4:7], s20 offen offset:2048 lds
  buffer_load_dwordx4 v1, s[4:7], s20 offen offset:3072 lds
  s_add_u32 s20, s20, 4096
  s_add_u32 m0, s26, 34816
  s_nop 0
  buffer_load_dwordx4 v1, s[4:7], s20 offen offset:0 lds
  buffer_load_dwordx4 v1, s[4:7], s20 offen offset:1024 lds
  buffer_load_dwordx4 v1, s[4:7], s20 offen offset:2048 lds
  buffer_load_dwordx4 v1, s[4:7], s20 offen offset:3072 lds
  s_add_u32 s20, s20, 4096
  s_add_u32 m0, s26, 38912
  s_nop 0
  buffer_load_dwordx4 v1, s[4:7], s20 offen offset:0 lds
  buffer_load_dwordx4 v1, s[4:7], s20 offen offset:1024 lds
  s_lshl_b32 s34, s15, 4
  s_and_b32 s35, s17, 15
  s_add_u32 s34, s34, s35
  s_mul_i32 s34, s34, 12288
  s_mul_i32 s35, s16, 3072
  s_add_u32 s35, s35, s34
  s_add_u32 s27, s35, 37748736
  s_add_u32 s30, s35, 50331648
  s_mul_i32 s35, s16, 6144
  s_add_u32 s35, s35, s34
  s_add_u32 s28, s35, 44040192
  s_add_u32 s34, s30, 1024
  buffer_load_dwordx4 v[16:19], v1, s[4:7], s34 offen sc1
  s_add_u32 s34, s30, 7168
  buffer_load_dwordx4 v[16:19], v1, s[4:7], s34 offen sc1
  s_add_u32 s34, s30, 2048
  buffer_load_dwordx4 v[16:19], v1, s[4:7], s34 offen sc1
  s_add_u32 s34, s30, 8192
  buffer_load_dwordx4 v[16:19], v1, s[4:7], s34 offen sc1
  s_lshl_b32 s34, s17, 1
  s_add_u32 s34, s34, s16
  s_mul_i32 s34, s34, 196608
  s_mul_i32 s35, s15, 6144
  s_add_u32 s34, s34, s35
  s_add_u32 s34, s34, 59772928
  buffer_load_dwordx4 v[16:19], v1, s[4:7], s34 offen sc1
  buffer_load_dwordx4 v[16:19], v1, s[4:7], s34 offen offset:1024 sc1
  s_mul_i32 s34, s15, 12
  s_mul_i32 s35, s16, 6
  s_add_u32 s34, s34, s35
  s_add_u32 s34, s34, 2
  s_mul_i32 s34, s34, 20480
  s_add_u32 s34, s34, 6291456
  buffer_load_dwordx4 a[0:3], v1, s[4:7], s34 offen offset:0
  buffer_load_dwordx4 a[4:7], v1, s[4:7], s34 offen offset:1024
  buffer_load_dwordx4 a[8:11], v1, s[4:7], s34 offen offset:2048
  buffer_load_dwordx4 a[12:15], v1, s[4:7], s34 offen offset:3072
  s_add_u32 s34, s34, 4096
  buffer_load_dwordx4 a[16:19], v1, s[4:7], s34 offen offset:0
  buffer_load_dwordx4 a[20:23], v1, s[4:7], s34 offen offset:1024
  buffer_load_dwordx4 a[24:27], v1, s[4:7], s34 offen offset:2048
  buffer_load_dwordx4 a[28:31], v1, s[4:7], s34 offen offset:3072
  s_add_u32 s34, s34, 4096
  buffer_load_dwordx4 a[32:35], v1, s[4:7], s34 offen offset:0
  buffer_load_dwordx4 a[36:39], v1, s[4:7], s34 offen offset:1024
  buffer_load_dwordx4 a[40:43], v1, s[4:7], s34 offen offset:2048
  buffer_load_dwordx4 a[44:47], v1, s[4:7], s34 offen offset:3072
  s_add_u32 s34, s34, 4096
  buffer_load_dwordx4 a[48:51], v1, s[4:7], s34 offen offset:0
  buffer_load_dwordx4 a[52:55], v1, s[4:7], s34 offen offset:1024
  buffer_load_dwordx4 a[56:59], v1, s[4:7], s34 offen offset:2048
  buffer_load_dwordx4 a[60:63], v1, s[4:7], s34 offen offset:3072
  s_add_u32 s34, s34, 4096
  buffer_load_dwordx4 a[64:67], v1, s[4:7], s34 offen offset:0
  buffer_load_dwordx4 a[68:71], v1, s[4:7], s34 offen offset:1024
  buffer_load_dwordx4 a[72:75], v1, s[4:7], s34 offen offset:2048
  buffer_load_dwordx4 a[76:79], v1, s[4:7], s34 offen offset:3072
  s_mul_i32 s34, s15, 12
  s_mul_i32 s35, s16, 6
  s_add_u32 s34, s34, s35
  s_add_u32 s34, s34, 3
  s_mul_i32 s34, s34, 20480
  s_add_u32 s34, s34, 6291456
  buffer_load_dwordx4 a[80:83], v1, s[4:7], s34 offen offset:0
  buffer_load_dwordx4 a[84:87], v1, s[4:7], s34 offen offset:1024
  buffer_load_dwordx4 a[88:91], v1, s[4:7], s34 offen offset:2048
  buffer_load_dwordx4 a[92:95], v1, s[4:7], s34 offen offset:3072
  s_add_u32 s34, s34, 4096
  buffer_load_dwordx4 a[96:99], v1, s[4:7], s34 offen offset:0
  buffer_load_dwordx4 a[100:103], v1, s[4:7], s34 offen offset:1024
  buffer_load_dwordx4 a[104:107], v1, s[4:7], s34 offen offset:2048
  buffer_load_dwordx4 a[108:111], v1, s[4:7], s34 offen offset:3072
  s_add_u32 s34, s34, 4096
  buffer_load_dwordx4 a[112:115], v1, s[4:7], s34 offen offset:0
  buffer_load_dwordx4 a[116:119], v1, s[4:7], s34 offen offset:1024
  buffer_load_dwordx4 a[120:123], v1, s[4:7], s34 offen offset:2048
  buffer_load_dwordx4 a[124:127], v1, s[4:7], s34 offen offset:3072
  s_add_u32 s34, s34, 4096
  buffer_load_dwordx4 a[128:131], v1, s[4:7], s34 offen offset:0
  buffer_load_dwordx4 a[132:135], v1, s[4:7], s34 offen offset:1024
  buffer_load_dwordx4 a[136:139], v1, s[4:7], s34 offen offset:2048
  buffer_load_dwordx4 a[140:143], v1, s[4:7], s34 offen offset:3072
  s_add_u32 s34, s34, 4096
  buffer_load_dwordx4 a[144:147], v1, s[4:7], s34 offen offset:0
  buffer_load_dwordx4 a[148:151], v1, s[4:7], s34 offen offset:1024
  buffer_load_dwordx4 a[152:155], v1, s[4:7], s34 offen offset:2048
  buffer_load_dwordx4 a[156:159], v1, s[4:7], s34 offen offset:3072
  s_waitcnt vmcnt(20)
  s_mul_i32 s34, s15, 12
  s_mul_i32 s35, s16, 6
  s_add_u32 s34, s34, s35
  s_add_u32 s34, s34, 4
  s_mul_i32 s34, s34, 20480
  s_add_u32 s34, s34, 6291456
  buffer_load_dwordx4 a[160:163], v1, s[4:7], s34 offen offset:0
  buffer_load_dwordx4 a[164:167], v1, s[4:7], s34 offen offset:1024
  buffer_load_dwordx4 a[168:171], v1, s[4:7], s34 offen offset:2048
  buffer_load_dwordx4 a[172:175], v1, s[4:7], s34 offen offset:3072
  s_add_u32 s34, s34, 4096
  buffer_load_dwordx4 a[176:179], v1, s[4:7], s34 offen offset:0
  buffer_load_dwordx4 a[180:183], v1, s[4:7], s34 offen offset:1024
  buffer_load_dwordx4 a[184:187], v1, s[4:7], s34 offen offset:2048
  buffer_load_dwordx4 a[188:191], v1, s[4:7], s34 offen offset:3072
  s_add_u32 s34, s34, 4096
  buffer_load_dwordx4 a[192:195], v1, s[4:7], s34 offen offset:0
  buffer_load_dwordx4 a[196:199], v1, s[4:7], s34 offen offset:1024
  buffer_load_dwordx4 a[200:203], v1, s[4:7], s34 offen offset:2048
  buffer_load_dwordx4 a[204:207], v1, s[4:7], s34 offen offset:3072
  s_add_u32 s34, s34, 4096
  buffer_load_dwordx4 a[208:211], v1, s[4:7], s34 offen offset:0
  buffer_load_dwordx4 a[212:215], v1, s[4:7], s34 offen offset:1024
  buffer_load_dwordx4 a[216:219], v1, s[4:7], s34 offen offset:2048
  buffer_load_dwordx4 a[220:223], v1, s[4:7], s34 offen offset:3072
  s_add_u32 s34, s34, 4096
  buffer_load_dwordx4 a[224:227], v1, s[4:7], s34 offen offset:0
  buffer_load_dwordx4 a[228:231], v1, s[4:7], s34 offen offset:1024
  buffer_load_dwordx4 a[232:235], v1, s[4:7], s34 offen offset:2048
  buffer_load_dwordx4 a[236:239], v1, s[4:7], s34 offen offset:3072
  s_waitcnt vmcnt(20)
  s_mul_i32 s34, s15, 12
  s_mul_i32 s35, s16, 6
  s_add_u32 s34, s34, s35
  s_add_u32 s34, s34, 5
  s_mul_i32 s34, s34, 20480
  s_add_u32 s34, s34, 6291456
  buffer_load_dwordx4 v[96:99], v1, s[4:7], s34 offen offset:0
  buffer_load_dwordx4 v[100:103], v1, s[4:7], s34 offen offset:1024
  buffer_load_dwordx4 v[104:107], v1, s[4:7], s34 offen offset:2048
  buffer_load_dwordx4 v[108:111], v1, s[4:7], s34 offen offset:3072
  s_add_u32 s34, s34, 4096
  buffer_load_dwordx4 v[112:115], v1, s[4:7], s34 offen offset:0
  buffer_load_dwordx4 v[116:119], v1, s[4:7], s34 offen offset:1024
  buffer_load_dwordx4 v[120:123], v1, s[4:7], s34 offen offset:2048
  buffer_load_dwordx4 v[124:127], v1, s[4:7], s34 offen offset:3072
  s_add_u32 s34, s34, 4096
  buffer_load_dwordx4 v[128:131], v1, s[4:7], s34 offen offset:0
  buffer_load_dwordx4 v[132:135], v1, s[4:7], s34 offen offset:1024
  buffer_load_dwordx4 v[136:139], v1, s[4:7], s34 offen offset:2048
  buffer_load_dwordx4 v[140:143], v1, s[4:7], s34 offen offset:3072
  s_add_u32 s34, s34, 4096
  buffer_load_dwordx4 v[144:147], v1, s[4:7], s34 offen offset:0
  buffer_load_dwordx4 v[148:151], v1, s[4:7], s34 offen offset:1024
  buffer_load_dwordx4 v[152:155], v1, s[4:7], s34 offen offset:2048
  buffer_load_dwordx4 v[156:159], v1, s[4:7], s34 offen offset:3072
  s_add_u32 s34, s34, 4096
  buffer_load_dwordx4 v[160:163], v1, s[4:7], s34 offen offset:0
  buffer_load_dwordx4 v[164:167], v1, s[4:7], s34 offen offset:1024
  buffer_load_dwordx4 v[168:171], v1, s[4:7], s34 offen offset:2048
  buffer_load_dwordx4 v[172:175], v1, s[4:7], s34 offen offset:3072
  s_waitcnt vmcnt(20)
  v_and_b32 v30, 7, v0
  v_lshlrev_b32 v30, 3, v30
reca_cens269:
  buffer_load_dwordx2 v[28:29], v30, s[8:11], 0 offen sc1
  s_waitcnt vmcnt(0)
  v_sad_u8 v31, v28, 0, 0
  v_sad_u8 v31, v29, 0, v31
  v_cmp_gt_u32 vcc, 32, v31
  s_cbranch_vccz reca_censok270
  s_sleep 8
  s_sub_u32 s18, s18, 1
  s_cbranch_scc0 reca_cens269
  s_mov_b32 s18, 0
reca_censok270:
  v_and_b32 v28, 0x20202020, v28
  v_and_b32 v29, 0x20202020, v29
  v_cmp_ne_u32 s[34:35], 0, v28
  v_cmp_ne_u32 s[36:37], 0, v29
  s_nop 3
  s_and_b32 s34, s34, 0xff
  s_and_b32 s36, s36, 0xff
  s_or_b32 s35, s34, s36
  s_lshr_b32 s37, s35, s13
  s_and_b32 s37, s37, 1
  s_xor_b32 s43, s37, 1
  s_cmp_eq_u32 s57, 0
  s_cselect_b32 s58, s36, s34
  v_mov_b32 v31, 0x80000000
  s_cmp_lg_u32 s43, 0
  s_cbranch_scc1 reca_pslow271
reca_ptop272:
  s_cmp_lt_u32 s17, 6
  s_cbranch_scc1 reca_pgo273
  s_sub_u32 s36, s17, 6
reca_ppoll274:
  buffer_load_dword v28, v4, s[4:7], s25 offen sc1
  s_waitcnt vmcnt(0)
  v_readfirstlane_b32 s34, v28
  s_nop 3
  s_cmp_ge_i32 s34, s36
  s_cbranch_scc1 reca_pgo273
  s_sleep 8
  s_sub_u32 s18, s18, 1
  s_cbranch_scc0 reca_ppoll274
  s_mov_b32 s18, 0
reca_pgo273:
  s_waitcnt vmcnt(0)
  s_barrier
  v_add_u32 v7, s26, v1
  s_xor_b32 s26, s26, 40960
  s_add_u32 s37, s17, 1
  s_cmp_ge_u32 s37, 64
  s_cbranch_scc1 reca_pnodma275
  s_mul_i32 s20, s37, 40960
  s_add_u32 s20, s20, 87586816
  s_add_u32 m0, s26, 30720
  s_nop 0
  buffer_load_dwordx4 v1, s[4:7], s20 offen offset:0 lds
  buffer_load_dwordx4 v1, s[4:7], s20 offen offset:1024 lds
  buffer_load_dwordx4 v1, s[4:7], s20 offen offset:2048 lds
  buffer_load_dwordx4 v1, s[4:7], s20 offen offset:3072 lds
  s_add_u32 s20, s20, 4096
  s_add_u32 m0, s26, 34816
  s_nop 0
  buffer_load_dwordx4 v1, s[4:7], s20 offen offset:0 lds
  buffer_load_dwordx4 v1, s[4:7], s20 offen offset:1024 lds
  buffer_load_dwordx4 v1, s[4:7], s20 offen offset:2048 lds
  buffer_load_dwordx4 v1, s[4:7], s20 offen offset:3072 lds
  s_add_u32 s20, s20, 4096
  s_add_u32 m0, s26, 38912
  s_nop 0
  buffer_load_dwordx4 v1, s[4:7], s20 offen offset:0 lds
  buffer_load_dwordx4 v1, s[4:7], s20 offen offset:1024 lds
  s_lshl_b32 s34, s15, 4
  s_and_b32 s35, s37, 15
  s_add_u32 s34, s34, s35
  s_mul_i32 s34, s34, 12288
  s_mul_i32 s35, s16, 3072
  s_add_u32 s35, s35, s34
  s_add_u32 s27, s35, 37748736
  s_add_u32 s30, s35, 50331648
  s_mul_i32 s35, s16, 6144
  s_add_u32 s35, s35, s34
  s_add_u32 s28, s35, 44040192
  s_add_u32 s34, s30, 1024
  buffer_load_dwordx4 v[16:19], v1, s[4:7], s34 offen sc1
  s_add_u32 s34, s30, 7168
  buffer_load_dwordx4 v[16:19], v1, s[4:7], s34 offen sc1
  s_add_u32 s34, s30, 2048
  buffer_load_dwordx4 v[16:19], v1, s[4:7], s34 offen sc1
  s_add_u32 s34, s30, 8192
  buffer_load_dwordx4 v[16:19], v1, s[4:7], s34 offen sc1
  s_lshl_b32 s34, s37, 1
  s_add_u32 s34, s34, s16
  s_mul_i32 s34, s34, 196608
  s_mul_i32 s35, s15, 6144
  s_add_u32 s34, s34, s35
  s_add_u32 s34, s34, 59772928
  buffer_load_dwordx4 v[16:19], v1, s[4:7], s34 offen sc1
  buffer_load_dwordx4 v[16:19], v1, s[4:7], s34 offen offset:1024 sc1
reca_pnodma275:
  s_lshl_b32 s34, s15, 4
  s_and_b32 s35, s17, 15
  s_add_u32 s34, s34, s35
  s_mul_i32 s34, s34, 12288
  s_mul_i32 s35, s16, 3072
  s_add_u32 s35, s35, s34
  s_add_u32 s21, s35, 37748736
  s_add_u32 s22, s35, 50331648
  s_mul_i32 s35, s16, 6144
  s_add_u32 s35, s35, s34
  s_add_u32 s23, s35, 44040192
  ds_read_b128 v[72:75], v7 offset:0
  ds_read_b128 v[76:79], v7 offset:20480
  ds_read_b128 v[80:83], v7 offset:1024
  ds_read_b128 v[84:87], v7 offset:21504
  ds_read_b128 v[88:91], v7 offset:2048
  ds_read_b128 v[92:95], v7 offset:22528
  s_waitcnt lgkmcnt(4)
  v_mfma_f32_16x16x32_bf16 v[32:35], a[0:3], v[72:75], 0
  v_mfma_f32_16x16x32_bf16 v[36:39], a[0:3], v[76:79], 0
  v_mfma_f32_16x16x32_bf16 v[40:43], a[80:83], v[72:75], 0
  v_mfma_f32_16x16x32_bf16 v[44:47], a[80:83], v[76:79], 0
  v_mfma_f32_16x16x32_bf16 v[48:51], a[160:163], v[72:75], 0
  v_mfma_f32_16x16x32_bf16 v[52:55], a[160:163], v[76:79], 0
  v_mfma_f32_16x16x32_bf16 v[56:59], v[96:99], v[72:75], 0
  v_mfma_f32_16x16x32_bf16 v[60:63], v[96:99], v[76:79], 0
  ds_read_b128 v[72:75], v7 offset:3072
  ds_read_b128 v[76:79], v7 offset:23552
  s_waitcnt lgkmcnt(4)
  v_mfma_f32_16x16x32_bf16 v[32:35], a[4:7], v[80:83], v[32:35]
  v_mfma_f32_16x16x32_bf16 v[36:39], a[4:7], v[84:87], v[36:39]
  v_mfma_f32_16x16x32_bf16 v[40:43], a[84:87], v[80:83], v[40:43]
  v_mfma_f32_16x16x32_bf16 v[44:47], a[84:87], v[84:87], v[44:47]
  v_mfma_f32_16x16x32_bf16 v[48:51], a[164:167], v[80:83], v[48:51]
  v_mfma_f32_16x16x32_bf16 v[52:55], a[164:167], v[84:87], v[52:55]
  v_mfma_f32_16x16x32_bf16 v[56:59], v[100:103], v[80:83], v[56:59]
  v_mfma_f32_16x16x32_bf16 v[60:63], v[100:103], v[84:87], v[60:63]
  ds_read_b128 v[80:83], v7 offset:4096
  ds_read_b128 v[84:87], v7 offset:24576
  s_waitcnt lgkmcnt(4)
  v_mfma_f32_16x16x32_bf16 v[32:35], a[8:11], v[88:91], v[32:35]
  v_mfma_f32_16x16x32_bf16 v[36:39], a[8:11], v[92:95], v[36:39]
  v_mfma_f32_16x16x32_bf16 v[40:43], a[88:91], v[88:91], v[40:43]
  v_mfma_f32_16x16x32_bf16 v[44:47], a[88:91], v[92:95], v[44:47]
  v_mfma_f32_16x16x32_bf16 v[48:51], a[168:171], v[88:91], v[48:51]
  v_mfma_f32_16x16x32_bf16 v[52:55], a[168:171], v[92:95], v[52:55]
  v_mfma_f32_16x16x32_bf16 v[56:59], v[104:107], v[88:91], v[56:59]
  v_mfma_f32_16x16x32_bf16 v[60:63], v[104:107], v[92:95], v[60:63]
  ds_read_b128 v[88:91], v7 offset:5120
  ds_read_b128 v[92:95], v7 offset:25600
  s_waitcnt lgkmcnt(4)
  v_mfma_f32_16x16x32_bf16 v[32:35], a[12:15], v[72:75], v[32:35]
  v_mfma_f32_16x16x32_bf16 v[36:39], a[12:15], v[76:79], v[36:39]
  v_mfma_f32_16x16x32_bf16 v[40:43], a[92:95], v[72:75], v[40:43]
  v_mfma_f32_16x16x32_bf16 v[44:47], a[92:95], v[76:79], v[44:47]
  v_mfma_f32_16x16x32_bf16 v[48:51], a[172:175], v[72:75], v[48:51]
  v_mfma_f32_16x16x32_bf16 v[52:55], a[172:175], v[76:79], v[52:55]
  v_mfma_f32_16x16x32_bf16 v[56:59], v[108:111], v[72:75], v[56:59]
  v_mfma_f32_16x16x32_bf16 v[60:63], v[108:111], v[76:79], v[60:63]
  ds_read_b128 v[72:75], v7 offset:6144
  ds_read_b128 v[76:79], v7 offset:26624
  s_waitcnt lgkmcnt(4)
  v_mfma_f32_16x16x32_bf16 v[32:35], a[16:19], v[80:83], v[32:35]
  v_mfma_f32_16x16x32_bf16 v[36:39], a[16:19], v[84:87], v[36:39]
  v_mfma_f32_16x16x32_bf16 v[40:43], a[96:99], v[80:83], v[40:43]
  v_mfma_f32_16x16x32_bf16 v[44:47], a[96:99], v[84:87], v[44:47]
  v_mfma_f32_16x16x32_bf16 v[48:51], a[176:179], v[80:83], v[48:51]
  v_mfma_f32_16x16x32_bf16 v[52:55], a[176:179], v[84:87], v[52:55]
  v_mfma_f32_16x16x32_bf16 v[56:59], v[112:115], v[80:83], v[56:59]
  v_mfma_f32_16x16x32_bf16 v[60:63], v[112:115], v[84:87], v[60:63]
  ds_read_b128 v[80:83], v7 offset:7168
  ds_read_b128 v[84:87], v7 offset:27648
  s_waitcnt lgkmcnt(4)
  v_mfma_f32_16x16x32_bf16 v[32:35], a[20:23], v[88:91], v[32:35]
  v_mfma_f32_16x16x32_bf16 v[36:39], a[20:23], v[92:95], v[36:39]
  v_mfma_f32_16x16x32_bf16 v[40:43], a[100:103], v[88:91], v[40:43]
  v_mfma_f32_16x16x32_bf16 v[44:47], a[100:103], v[92:95], v[44:47]
  v_mfma_f32_16x16x32_bf16 v[48:51], a[180:183], v[88:91], v[48:51]
  v_mfma_f32_16x16x32_bf16 v[52:55], a[180:183], v[92:95], v[52:55]
  v_mfma_f32_16x16x32_bf16 v[56:59], v[116:119], v[88:91], v[56:59]
  v_mfma_f32_16x16x32_bf16 v[60:63], v[116:119], v[92:95], v[60:63]
  ds_read_b128 v[88:91], v7 offset:8192
  ds_read_b128 v[92:95], v7 offset:28672
  s_waitcnt lgkmcnt(4)
  v_mfma_f32_16x16x32_bf16 v[32:35], a[24:27], v[72:75], v[32:35]
  v_mfma_f32_16x16x32_bf16 v[36:39], a[24:27], v[76:79], v[36:39]
  v_mfma_f32_16x16x32_bf16 v[40:43], a[104:107], v[72:75], v[40:43]
  v_mfma_f32_16x16x32_bf16 v[44:47], a[104:107], v[76:79], v[44:47]
  v_mfma_f32_16x16x32_bf16 v[48:51], a[184:187], v[72:75], v[48:51]
  v_mfma_f32_16x16x32_bf16 v[52:55], a[184:187], v[76:79], v[52:55]
  v_mfma_f32_16x16x32_bf16 v[56:59], v[120:123], v[72:75], v[56:59]
  v_mfma_f32_16x16x32_bf16 v[60:63], v[120:123], v[76:79], v[60:63]
  ds_read_b128 v[72:75], v7 offset:9216
  ds_read_b128 v[76:79], v7 offset:29696
  s_waitcnt lgkmcnt(4)
  v_mfma_f32_16x16x32_bf16 v[32:35], a[28:31], v[80:83], v[32:35]
  v_mfma_f32_16x16x32_bf16 v[36:39], a[28:31], v[84:87], v[36:39]
  v_mfma_f32_16x16x32_bf16 v[40:43], a[108:111], v[80:83], v[40:43]
  v_mfma_f32_16x16x32_bf16 v[44:47], a[108:111], v[84:87], v[44:47]
  v_mfma_f32_16x16x32_bf16 v[48:51], a[188:191], v[80:83], v[48:51]
  v_mfma_f32_16x16x32_bf16 v[52:55], a[188:191], v[84:87], v[52:55]
  v_mfma_f32_16x16x32_bf16 v[56:59], v[124:127], v[80:83], v[56:59]
  v_mfma_f32_16x16x32_bf16 v[60:63], v[124:127], v[84:87], v[60:63]
  ds_read_b128 v[80:83], v7 offset:10240
  ds_read_b128 v[84:87], v7 offset:30720
  s_waitcnt lgkmcnt(4)
  v_mfma_f32_16x16x32_bf16 v[32:35], a[32:35], v[88:91], v[32:35]
  v_mfma_f32_16x16x32_bf16 v[36:39], a[32:35], v[92:95], v[36:39]
  v_mfma_f32_16x16x32_bf16 v[40:43], a[112:115], v[88:91], v[40:43]
  v_mfma_f32_16x16x32_bf16 v[44:47], a[112:115], v[92:95], v[44:47]
  v_mfma_f32_16x16x32_bf16 v[48:51], a[192:195], v[88:91], v[48:51]
  v_mfma_f32_16x16x32_bf16 v[52:55], a[192:195], v[92:95], v[52:55]
  v_mfma_f32_16x16x32_bf16 v[56:59], v[128:131], v[88:91], v[56:59]
  v_mfma_f32_16x16x32_bf16 v[60:63], v[128:131], v[92:95], v[60:63]
  ds_read_b128 v[88:91], v7 offset:11264
  ds_read_b128 v[92:95], v7 offset:31744
  s_waitcnt lgkmcnt(4)
  v_mfma_f32_16x16x32_bf16 v[32:35], a[36:39], v[72:75], v[32:35]
  v_mfma_f32_16x16x32_bf16 v[36:39], a[36:39], v[76:79], v[36:39]
  v_mfma_f32_16x16x32_bf16 v[40:43], a[116:119], v[72:75], v[40:43]
  v_mfma_f32_16x16x32_bf16 v[44:47], a[116:119], v[76:79], v[44:47]
  v_mfma_f32_16x16x32_bf16 v[48:51], a[196:199], v[72:75], v[48:51]
  v_mfma_f32_16x16x32_bf16 v[52:55], a[196:199], v[76:79], v[52:55]
  v_mfma_f32_16x16x32_bf16 v[56:59], v[132:135], v[72:75], v[56:59]
  v_mfma_f32_16x16x32_bf16 v[60:63], v[132:135], v[76:79], v[60:63]
  ds_read_b128 v[72:75], v7 offset:12288
  ds_read_b128 v[76:79], v7 offset:32768
  s_waitcnt lgkmcnt(4)
  v_mfma_f32_16x16x32_bf16 v[32:35], a[40:43], v[80:83], v[32:35]
  v_mfma_f32_16x16x32_bf16 v[36:39], a[40:43], v[84:87], v[36:39]
  v_mfma_f32_16x16x32_bf16 v[40:43], a[120:123], v[80:83], v[40:43]
  v_mfma_f32_16x16x32_bf16 v[44:47], a[120:123], v[84:87], v[44:47]
  v_mfma_f32_16x16x32_bf16 v[48:51], a[200:203], v[80:83], v[48:51]
  v_mfma_f32_16x16x32_bf16 v[52:55], a[200:203], v[84:87], v[52:55]
  v_mfma_f32_16x16x32_bf16 v[56:59], v[136:139], v[80:83], v[56:59]
  v_mfma_f32_16x16x32_bf16 v[60:63], v[136:139], v[84:87], v[60:63]
  ds_read_b128 v[80:83], v7 offset:13312
  ds_read_b128 v[84:87], v7 offset:33792
  s_waitcnt lgkmcnt(4)
  v_mfma_f32_16x16x32_bf16 v[32:35], a[44:47], v[88:91], v[32:35]
  v_mfma_f32_16x16x32_bf16 v[36:39], a[44:47], v[92:95], v[36:39]
  v_mfma_f32_16x16x32_bf16 v[40:43], a[124:127], v[88:91], v[40:43]
  v_mfma_f32_16x16x32_bf16 v[44:47], a[124:127], v[92:95], v[44:47]
  v_mfma_f32_16x16x32_bf16 v[48:51], a[204:207], v[88:91], v[48:51]
  v_mfma_f32_16x16x32_bf16 v[52:55], a[204:207], v[92:95], v[52:55]
  v_mfma_f32_16x16x32_bf16 v[56:59], v[140:143], v[88:91], v[56:59]
  v_mfma_f32_16x16x32_bf16 v[60:63], v[140:143], v[92:95], v[60:63]
  ds_read_b128 v[88:91], v7 offset:14336
  ds_read_b128 v[92:95], v7 offset:34816
  s_waitcnt lgkmcnt(4)
  v_mfma_f32_16x16x32_bf16 v[32:35], a[48:51], v[72:75], v[32:35]
  v_mfma_f32_16x16x32_bf16 v[36:39], a[48:51], v[76:79], v[36:39]
  v_mfma_f32_16x16x32_bf16 v[40:43], a[128:131], v[72:75], v[40:43]
  v_mfma_f32_16x16x32_bf16 v[44:47], a[128:131], v[76:79], v[44:47]
  v_mfma_f32_16x16x32_bf16 v[48:51], a[208:211], v[72:75], v[48:51]
  v_mfma_f32_16x16x32_bf16 v[52:55], a[208:211], v[76:79], v[52:55]
  v_mfma_f32_16x16x32_bf16 v[56:59], v[144:147], v[72:75], v[56:59]
  v_mfma_f32_16x16x32_bf16 v[60:63], v[144:147], v[76:79], v[60:63]
  ds_read_b128 v[72:75], v7 offset:15360
  ds_read_b128 v[76:79], v7 offset:35840
  s_waitcnt lgkmcnt(4)
  v_mfma_f32_16x16x32_bf16 v[32:35], a[52:55], v[80:83], v[32:35]
  v_mfma_f32_16x16x32_bf16 v[36:39], a[52:55], v[84:87], v[36:39]
  v_mfma_f32_16x16x32_bf16 v[40:43], a[132:135], v[80:83], v[40:43]
  v_mfma_f32_16x16x32_bf16 v[44:47], a[132:135], v[84:87], v[44:47]
  v_mfma_f32_16x16x32_bf16 v[48:51], a[212:215], v[80:83], v[48:51]
  v_mfma_f32_16x16x32_bf16 v[52:55], a[212:215], v[84:87], v[52:55]
  v_mfma_f32_16x16x32_bf16 v[56:59], v[148:151], v[80:83], v[56:59]
  v_mfma_f32_16x16x32_bf16 v[60:63], v[148:151], v[84:87], v[60:63]
  ds_read_b128 v[80:83], v7 offset:16384
  ds_read_b128 v[84:87], v7 offset:36864
  s_waitcnt lgkmcnt(4)
  v_mfma_f32_16x16x32_bf16 v[32:35], a[56:59], v[88:91], v[32:35]
  v_mfma_f32_16x16x32_bf16 v[36:39], a[56:59], v[92:95], v[36:39]
  v_mfma_f32_16x16x32_bf16 v[40:43], a[136:139], v[88:91], v[40:43]
  v_mfma_f32_16x16x32_bf16 v[44:47], a[136:139], v[92:95], v[44:47]
  v_mfma_f32_16x16x32_bf16 v[48:51], a[216:219], v[88:91], v[48:51]
  v_mfma_f32_16x16x32_bf16 v[52:55], a[216:219], v[92:95], v[52:55]
  v_mfma_f32_16x16x32_bf16 v[56:59], v[152:155], v[88:91], v[56:59]
  v_mfma_f32_16x16x32_bf16 v[60:63], v[152:155], v[92:95], v[60:63]
  ds_read_b128 v[88:91], v7 offset:17408
  ds_read_b128 v[92:95], v7 offset:37888
  s_waitcnt lgkmcnt(4)
  v_mfma_f32_16x16x32_bf16 v[32:35], a[60:63], v[72:75], v[32:35]
  v_mfma_f32_16x16x32_bf16 v[36:39], a[60:63], v[76:79], v[36:39]
  v_mfma_f32_16x16x32_bf16 v[40:43], a[140:143], v[72:75], v[40:43]
  v_mfma_f32_16x16x32_bf16 v[44:47], a[140:143], v[76:79], v[44:47]
  v_mfma_f32_16x16x32_bf16 v[48:51], a[220:223], v[72:75], v[48:51]
  v_mfma_f32_16x16x32_bf16 v[52:55], a[220:223], v[76:79], v[52:55]
  v_mfma_f32_16x16x32_bf16 v[56:59], v[156:159], v[72:75], v[56:59]
  v_mfma_f32_16x16x32_bf16 v[60:63], v[156:159], v[76:79], v[60:63]
  ds_read_b128 v[72:75], v7 offset:18432
  ds_read_b128 v[76:79], v7 offset:38912
  s_waitcnt lgkmcnt(4)
  v_mfma_f32_16x16x32_bf16 v[32:35], a[64:67], v[80:83], v[32:35]
  v_mfma_f32_16x16x32_bf16 v[36:39], a[64:67], v[84:87], v[36:39]
  v_mfma_f32_16x16x32_bf16 v[40:43], a[144:147], v[80:83], v[40:43]
  v_mfma_f32_16x16x32_bf16 v[44:47], a[144:147], v[84:87], v[44:47]
  v_mfma_f32_16x16x32_bf16 v[48:51], a[224:227], v[80:83], v[48:51]
  v_mfma_f32_16x16x32_bf16 v[52:55], a[224:227], v[84:87], v[52:55]
  v_mfma_f32_16x16x32_bf16 v[56:59], v[160:163], v[80:83], v[56:59]
  v_mfma_f32_16x16x32_bf16 v[60:63], v[160:163], v[84:87], v[60:63]
  ds_read_b128 v[80:83], v7 offset:19456
  ds_read_b128 v[84:87], v7 offset:39936
  s_waitcnt lgkmcnt(4)
  v_mfma_f32_16x16x32_bf16 v[32:35], a[68:71], v[88:91], v[32:35]
  v_mfma_f32_16x16x32_bf16 v[36:39], a[68:71], v[92:95], v[36:39]
  v_mfma_f32_16x16x32_bf16 v[40:43], a[148:151], v[88:91], v[40:43]
  v_mfma_f32_16x16x32_bf16 v[44:47], a[148:151], v[92:95], v[44:47]
  v_mfma_f32_16x16x32_bf16 v[48:51], a[228:231], v[88:91], v[48:51]
  v_mfma_f32_16x16x32_bf16 v[52:55], a[228:231], v[92:95], v[52:55]
  v_mfma_f32_16x16x32_bf16 v[56:59], v[164:167], v[88:91], v[56:59]
  v_mfma_f32_16x16x32_bf16 v[60:63], v[164:167], v[92:95], v[60:63]
  s_waitcnt lgkmcnt(2)
  v_mfma_f32_16x16x32_bf16 v[32:35], a[72:75], v[72:75], v[32:35]
  v_mfma_f32_16x16x32_bf16 v[36:39], a[72:75], v[76:79], v[36:39]
  v_mfma_f32_16x16x32_bf16 v[40:43], a[152:155], v[72:75], v[40:43]
  v_mfma_f32_16x16x32_bf16 v[44:47], a[152:155], v[76:79], v[44:47]
  v_mfma_f32_16x16x32_bf16 v[48:51], a[232:235], v[72:75], v[48:51]
  v_mfma_f32_16x16x32_bf16 v[52:55], a[232:235], v[76:79], v[52:55]
  v_mfma_f32_16x16x32_bf16 v[56:59], v[168:171], v[72:75], v[56:59]
  v_mfma_f32_16x16x32_bf16 v[60:63], v[168:171], v[76:79], v[60:63]
  s_waitcnt lgkmcnt(0)
  v_mfma_f32_16x16x32_bf16 v[32:35], a[76:79], v[80:83], v[32:35]
  v_mfma_f32_16x16x32_bf16 v[36:39], a[76:79], v[84:87], v[36:39]
  v_mfma_f32_16x16x32_bf16 v[40:43], a[156:159], v[80:83], v[40:43]
  v_mfma_f32_16x16x32_bf16 v[44:47], a[156:159], v[84:87], v[44:47]
  v_mfma_f32_16x16x32_bf16 v[48:51], a[236:239], v[80:83], v[48:51]
  v_mfma_f32_16x16x32_bf16 v[52:55], a[236:239], v[84:87], v[52:55]
  v_mfma_f32_16x16x32_bf16 v[56:59], v[172:175], v[80:83], v[56:59]
  v_mfma_f32_16x16x32_bf16 v[60:63], v[172:175], v[84:87], v[60:63]
  s_nop 0
  v_cvt_pk_bf16_f32 v8, v32, v33
  v_cvt_pk_bf16_f32 v9, v34, v35
  v_cvt_pk_bf16_f32 v10, v40, v41
  v_cvt_pk_bf16_f32 v11, v42, v43
  s_add_u32 s34, s22, 1024
  buffer_store_dwordx4 v[8:11], v1, s[4:7], s34 offen
  v_cvt_pk_bf16_f32 v12, v36, v37
  v_cvt_pk_bf16_f32 v13, v38, v39
  v_cvt_pk_bf16_f32 v14, v44, v45
  v_cvt_pk_bf16_f32 v15, v46, v47
  s_add_u32 s34, s22, 7168
  buffer_store_dwordx4 v[12:15], v1, s[4:7], s34 offen
  v_cvt_pk_bf16_f32 v8, v48, v49
  v_cvt_pk_bf16_f32 v9, v50, v51
  v_cvt_pk_bf16_f32 v10, v56, v57
  v_cvt_pk_bf16_f32 v11, v58, v59
  s_add_u32 s34, s22, 2048
  buffer_store_dwordx4 v[8:11], v1, s[4:7], s34 offen
  v_cvt_pk_bf16_f32 v12, v52, v53
  v_cvt_pk_bf16_f32 v13, v54, v55
  v_cvt_pk_bf16_f32 v14, v60, v61
  v_cvt_pk_bf16_f32 v15, v62, v63
  s_add_u32 s34, s22, 8192
  buffer_store_dwordx4 v[12:15], v1, s[4:7], s34 offen
  s_waitcnt vmcnt(0)
  s_barrier
  s_add_u32 s17, s17, 1
  s_cmp_lt_u32 s17, 64
  s_cbranch_scc1 reca_ptop272
  s_branch reca_exit1
reca_pslow271:
reca_ptop277:
  s_cmp_lt_u32 s17, 6
  s_cbranch_scc1 reca_pgo278
  s_sub_u32 s36, s17, 6
reca_ppoll279:
  buffer_load_dword v28, v4, s[4:7], s25 offen sc1
  s_waitcnt vmcnt(0)
  v_readfirstlane_b32 s34, v28
  s_nop 3
  s_cmp_ge_i32 s34, s36
  s_cbranch_scc1 reca_pgo278
  s_sleep 8
  s_sub_u32 s18, s18, 1
  s_cbranch_scc0 reca_ppoll279
  s_mov_b32 s18, 0
reca_pgo278:
  s_waitcnt vmcnt(0)
  s_barrier
  v_add_u32 v7, s26, v1
  s_xor_b32 s26, s26, 40960
  s_add_u32 s37, s17, 1
  s_cmp_ge_u32 s37, 64
  s_cbranch_scc1 reca_pnodma280
  s_mul_i32 s20, s37, 40960
  s_add_u32 s20, s20, 87586816
  s_add_u32 m0, s26, 30720
  s_nop 0
  buffer_load_dwordx4 v1, s[4:7], s20 offen offset:0 lds
  buffer_load_dwordx4 v1, s[4:7], s20 offen offset:1024 lds
  buffer_load_dwordx4 v1, s[4:7], s20 offen offset:2048 lds
  buffer_load_dwordx4 v1, s[4:7], s20 offen offset:3072 lds
  s_add_u32 s20, s20, 4096
  s_add_u32 m0, s26, 34816
  s_nop 0
  buffer_load_dwordx4 v1, s[4:7], s20 offen offset:0 lds
  buffer_load_dwordx4 v1, s[4:7], s20 offen offset:1024 lds
  buffer_load_dwordx4 v1, s[4:7], s20 offen offset:2048 lds
  buffer_load_dwordx4 v1, s[4:7], s20 offen offset:3072 lds
  s_add_u32 s20, s20, 4096
  s_add_u32 m0, s26, 38912
  s_nop 0
  buffer_load_dwordx4 v1, s[4:7], s20 offen offset:0 lds
  buffer_load_dwordx4 v1, s[4:7], s20 offen offset:1024 lds
  s_lshl_b32 s34, s15, 4
  s_and_b32 s35, s37, 15
  s_add_u32 s34, s34, s35
  s_mul_i32 s34, s34, 12288
  s_mul_i32 s35, s16, 3072
  s_add_u32 s35, s35, s34
  s_add_u32 s27, s35, 37748736
  s_add_u32 s30, s35, 50331648
  s_mul_i32 s35, s16, 6144
  s_add_u32 s35, s35, s34
  s_add_u32 s28, s35, 44040192
  s_add_u32 s34, s30, 1024
  buffer_load_dwordx4 v[16:19], v1, s[4:7], s34 offen sc1
  s_add_u32 s34, s30, 7168
  buffer_load_dwordx4 v[16:19], v1, s[4:7], s34 offen sc1
  s_add_u32 s34, s30, 2048
  buffer_load_dwordx4 v[16:19], v1, s[4:7], s34 offen sc1
  s_add_u32 s34, s30, 8192
  buffer_load_dwordx4 v[16:19], v1, s[4:7], s34 offen sc1
  s_lshl_b32 s34, s37, 1
  s_add_u32 s34, s34, s16
  s_mul_i32 s34, s34, 196608
  s_mul_i32 s35, s15, 6144
  s_add_u32 s34, s34, s35
  s_add_u32 s34, s34, 59772928
  buffer_load_dwordx4 v[16:19], v1, s[4:7], s34 offen sc1
  buffer_load_dwordx4 v[16:19], v1, s[4:7], s34 offen offset:1024 sc1
reca_pnodma280:
  s_lshl_b32 s34, s15, 4
  s_and_b32 s35, s17, 15
  s_add_u32 s34, s34, s35
  s_mul_i32 s34, s34, 12288
  s_mul_i32 s35, s16, 3072
  s_add_u32 s35, s35, s34
  s_add_u32 s21, s35, 37748736
  s_add_u32 s22, s35, 50331648
  s_mul_i32 s35, s16, 6144
  s_add_u32 s35, s35, s34
  s_add_u32 s23, s35, 44040192
  ds_read_b128 v[72:75], v7 offset:0
  ds_read_b128 v[76:79], v7 offset:20480
  ds_read_b128 v[80:83], v7 offset:1024
  ds_read_b128 v[84:87], v7 offset:21504
  ds_read_b128 v[88:91], v7 offset:2048
  ds_read_b128 v[92:95], v7 offset:22528
  s_waitcnt lgkmcnt(4)
  v_mfma_f32_16x16x32_bf16 v[32:35], a[0:3], v[72:75], 0
  v_mfma_f32_16x16x32_bf16 v[36:39], a[0:3], v[76:79], 0
  v_mfma_f32_16x16x32_bf16 v[40:43], a[80:83], v[72:75], 0
  v_mfma_f32_16x16x32_bf16 v[44:47], a[80:83], v[76:79], 0
  v_mfma_f32_16x16x32_bf16 v[48:51], a[160:163], v[72:75], 0
  v_mfma_f32_16x16x32_bf16 v[52:55], a[160:163], v[76:79], 0
  v_mfma_f32_16x16x32_bf16 v[56:59], v[96:99], v[72:75], 0
  v_mfma_f32_16x16x32_bf16 v[60:63], v[96:99], v[76:79], 0
  ds_read_b128 v[72:75], v7 offset:3072
  ds_read_b128 v[76:79], v7 offset:23552
  s_waitcnt lgkmcnt(4)
  v_mfma_f32_16x16x32_bf16 v[32:35], a[4:7], v[80:83], v[32:35]
  v_mfma_f32_16x16x32_bf16 v[36:39], a[4:7], v[84:87], v[36:39]
  v_mfma_f32_16x16x32_bf16 v[40:43], a[84:87], v[80:83], v[40:43]
  v_mfma_f32_16x16x32_bf16 v[44:47], a[84:87], v[84:87], v[44:47]
  v_mfma_f32_16x16x32_bf16 v[48:51], a[164:167], v[80:83], v[48:51]
  v_mfma_f32_16x16x32_bf16 v[52:55], a[164:167], v[84:87], v[52:55]
  v_mfma_f32_16x16x32_bf16 v[56:59], v[100:103], v[80:83], v[56:59]
  v_mfma_f32_16x16x32_bf16 v[60:63], v[100:103], v[84:87], v[60:63]
  ds_read_b128 v[80:83], v7 offset:4096
  ds_read_b128 v[84:87], v7 offset:24576
  s_waitcnt lgkmcnt(4)
  v_mfma_f32_16x16x32_bf16 v[32:35], a[8:11], v[88:91], v[32:35]
  v_mfma_f32_16x16x32_bf16 v[36:39], a[8:11], v[92:95], v[36:39]
  v_mfma_f32_16x16x32_bf16 v[40:43], a[88:91], v[88:91], v[40:43]
  v_mfma_f32_16x16x32_bf16 v[44:47], a[88:91], v[92:95], v[44:47]
  v_mfma_f32_16x16x32_bf16 v[48:51], a[168:171], v[88:91], v[48:51]
  v_mfma_f32_16x16x32_bf16 v[52:55], a[168:171], v[92:95], v[52:55]
  v_mfma_f32_16x16x32_bf16 v[56:59], v[104:107], v[88:91], v[56:59]
  v_mfma_f32_16x16x32_bf16 v[60:63], v[104:107], v[92:95], v[60:63]
  ds_read_b128 v[88:91], v7 offset:5120
  ds_read_b128 v[92:95], v7 offset:25600
  s_waitcnt lgkmcnt(4)
  v_mfma_f32_16x16x32_bf16 v[32:35], a[12:15], v[72:75], v[32:35]
  v_mfma_f32_16x16x32_bf16 v[36:39], a[12:15], v[76:79], v[36:39]
  v_mfma_f32_16x16x32_bf16 v[40:43], a[92:95], v[72:75], v[40:43]
  v_mfma_f32_16x16x32_bf16 v[44:47], a[92:95], v[76:79], v[44:47]
  v_mfma_f32_16x16x32_bf16 v[48:51], a[172:175], v[72:75], v[48:51]
  v_mfma_f32_16x16x32_bf16 v[52:55], a[172:175], v[76:79], v[52:55]
  v_mfma_f32_16x16x32_bf16 v[56:59], v[108:111], v[72:75], v[56:59]
  v_mfma_f32_16x16x32_bf16 v[60:63], v[108:111], v[76:79], v[60:63]
  ds_read_b128 v[72:75], v7 offset:6144
  ds_read_b128 v[76:79], v7 offset:26624
  s_waitcnt lgkmcnt(4)
  v_mfma_f32_16x16x32_bf16 v[32:35], a[16:19], v[80:83], v[32:35]
  v_mfma_f32_16x16x32_bf16 v[36:39], a[16:19], v[84:87], v[36:39]
  v_mfma_f32_16x16x32_bf16 v[40:43], a[96:99], v[80:83], v[40:43]
  v_mfma_f32_16x16x32_bf16 v[44:47], a[96:99], v[84:87], v[44:47]
  v_mfma_f32_16x16x32_bf16 v[48:51], a[176:179], v[80:83], v[48:51]
  v_mfma_f32_16x16x32_bf16 v[52:55], a[176:179], v[84:87], v[52:55]
  v_mfma_f32_16x16x32_bf16 v[56:59], v[112:115], v[80:83], v[56:59]
  v_mfma_f32_16x16x32_bf16 v[60:63], v[112:115], v[84:87], v[60:63]
  ds_read_b128 v[80:83], v7 offset:7168
  ds_read_b128 v[84:87], v7 offset:27648
  s_waitcnt lgkmcnt(4)
  v_mfma_f32_16x16x32_bf16 v[32:35], a[20:23], v[88:91], v[32:35]
  v_mfma_f32_16x16x32_bf16 v[36:39], a[20:23], v[92:95], v[36:39]
  v_mfma_f32_16x16x32_bf16 v[40:43], a[100:103], v[88:91], v[40:43]
  v_mfma_f32_16x16x32_bf16 v[44:47], a[100:103], v[92:95], v[44:47]
  v_mfma_f32_16x16x32_bf16 v[48:51], a[180:183], v[88:91], v[48:51]
  v_mfma_f32_16x16x32_bf16 v[52:55], a[180:183], v[92:95], v[52:55]
  v_mfma_f32_16x16x32_bf16 v[56:59], v[116:119], v[88:91], v[56:59]
  v_mfma_f32_16x16x32_bf16 v[60:63], v[116:119], v[92:95], v[60:63]
  ds_read_b128 v[88:91], v7 offset:8192
  ds_read_b128 v[92:95], v7 offset:28672
  s_waitcnt lgkmcnt(4)
  v_mfma_f32_16x16x32_bf16 v[32:35], a[24:27], v[72:75], v[32:35]
  v_mfma_f32_16x16x32_bf16 v[36:39], a[24:27], v[76:79], v[36:39]
  v_mfma_f32_16x16x32_bf16 v[40:43], a[104:107], v[72:75], v[40:43]
  v_mfma_f32_16x16x32_bf16 v[44:47], a[104:107], v[76:79], v[44:47]
  v_mfma_f32_16x16x32_bf16 v[48:51], a[184:187], v[72:75], v[48:51]
  v_mfma_f32_16x16x32_bf16 v[52:55], a[184:187], v[76:79], v[52:55]
  v_mfma_f32_16x16x32_bf16 v[56:59], v[120:123], v[72:75], v[56:59]
  v_mfma_f32_16x16x32_bf16 v[60:63], v[120:123], v[76:79], v[60:63]
  ds_read_b128 v[72:75], v7 offset:9216
  ds_read_b128 v[76:79], v7 offset:29696
  s_waitcnt lgkmcnt(4)
  v_mfma_f32_16x16x32_bf16 v[32:35], a[28:31], v[80:83], v[32:35]
  v_mfma_f32_16x16x32_bf16 v[36:39], a[28:31], v[84:87], v[36:39]
  v_mfma_f32_16x16x32_bf16 v[40:43], a[108:111], v[80:83], v[40:43]
  v_mfma_f32_16x16x32_bf16 v[44:47], a[108:111], v[84:87], v[44:47]
  v_mfma_f32_16x16x32_bf16 v[48:51], a[188:191], v[80:83], v[48:51]
  v_mfma_f32_16x16x32_bf16 v[52:55], a[188:191], v[84:87], v[52:55]
  v_mfma_f32_16x16x32_bf16 v[56:59], v[124:127], v[80:83], v[56:59]
  v_mfma_f32_16x16x32_bf16 v[60:63], v[124:127], v[84:87], v[60:63]
  ds_read_b128 v[80:83], v7 offset:10240
  ds_read_b128 v[84:87], v7 offset:30720
  s_waitcnt lgkmcnt(4)
  v_mfma_f32_16x16x32_bf16 v[32:35], a[32:35], v[88:91], v[32:35]
  v_mfma_f32_16x16x32_bf16 v[36:39], a[32:35], v[92:95], v[36:39]
  v_mfma_f32_16x16x32_bf16 v[40:43], a[112:115], v[88:91], v[40:43]
  v_mfma_f32_16x16x32_bf16 v[44:47], a[112:115], v[92:95], v[44:47]
  v_mfma_f32_16x16x32_bf16 v[48:51], a[192:195], v[88:91], v[48:51]
  v_mfma_f32_16x16x32_bf16 v[52:55], a[192:195], v[92:95], v[52:55]
  v_mfma_f32_16x16x32_bf16 v[56:59], v[128:131], v[88:91], v[56:59]
  v_mfma_f32_16x16x32_bf16 v[60:63], v[128:131], v[92:95], v[60:63]
  ds_read_b128 v[88:91], v7 offset:11264
  ds_read_b128 v[92:95], v7 offset:31744
  s_waitcnt lgkmcnt(4)
  v_mfma_f32_16x16x32_bf16 v[32:35], a[36:39], v[72:75], v[32:35]
  v_mfma_f32_16x16x32_bf16 v[36:39], a[36:39], v[76:79], v[36:39]
  v_mfma_f32_16x16x32_bf16 v[40:43], a[116:119], v[72:75], v[40:43]
  v_mfma_f32_16x16x32_bf16 v[44:47], a[116:119], v[76:79], v[44:47]
  v_mfma_f32_16x16x32_bf16 v[48:51], a[196:199], v[72:75], v[48:51]
  v_mfma_f32_16x16x32_bf16 v[52:55], a[196:199], v[76:79], v[52:55]
  v_mfma_f32_16x16x32_bf16 v[56:59], v[132:135], v[72:75], v[56:59]
  v_mfma_f32_16x16x32_bf16 v[60:63], v[132:135], v[76:79], v[60:63]
  ds_read_b128 v[72:75], v7 offset:12288
  ds_read_b128 v[76:79], v7 offset:32768
  s_waitcnt lgkmcnt(4)
  v_mfma_f32_16x16x32_bf16 v[32:35], a[40:43], v[80:83], v[32:35]
  v_mfma_f32_16x16x32_bf16 v[36:39], a[40:43], v[84:87], v[36:39]
  v_mfma_f32_16x16x32_bf16 v[40:43], a[120:123], v[80:83], v[40:43]
  v_mfma_f32_16x16x32_bf16 v[44:47], a[120:123], v[84:87], v[44:47]
  v_mfma_f32_16x16x32_bf16 v[48:51], a[200:203], v[80:83], v[48:51]
  v_mfma_f32_16x16x32_bf16 v[52:55], a[200:203], v[84:87], v[52:55]
  v_mfma_f32_16x16x32_bf16 v[56:59], v[136:139], v[80:83], v[56:59]
  v_mfma_f32_16x16x32_bf16 v[60:63], v[136:139], v[84:87], v[60:63]
  ds_read_b128 v[80:83], v7 offset:13312
  ds_read_b128 v[84:87], v7 offset:33792
  s_waitcnt lgkmcnt(4)
  v_mfma_f32_16x16x32_bf16 v[32:35], a[44:47], v[88:91], v[32:35]
  v_mfma_f32_16x16x32_bf16 v[36:39], a[44:47], v[92:95], v[36:39]
  v_mfma_f32_16x16x32_bf16 v[40:43], a[124:127], v[88:91], v[40:43]
  v_mfma_f32_16x16x32_bf16 v[44:47], a[124:127], v[92:95], v[44:47]
  v_mfma_f32_16x16x32_bf16 v[48:51], a[204:207], v[88:91], v[48:51]
  v_mfma_f32_16x16x32_bf16 v[52:55], a[204:207], v[92:95], v[52:55]
  v_mfma_f32_16x16x32_bf16 v[56:59], v[140:143], v[88:91], v[56:59]
  v_mfma_f32_16x16x32_bf16 v[60:63], v[140:143], v[92:95], v[60:63]
  ds_read_b128 v[88:91], v7 offset:14336
  ds_read_b128 v[92:95], v7 offset:34816
  s_waitcnt lgkmcnt(4)
  v_mfma_f32_16x16x32_bf16 v[32:35], a[48:51], v[72:75], v[32:35]
  v_mfma_f32_16x16x32_bf16 v[36:39], a[48:51], v[76:79], v[36:39]
  v_mfma_f32_16x16x32_bf16 v[40:43], a[128:131], v[72:75], v[40:43]
  v_mfma_f32_16x16x32_bf16 v[44:47], a[128:131], v[76:79], v[44:47]
  v_mfma_f32_16x16x32_bf16 v[48:51], a[208:211], v[72:75], v[48:51]
  v_mfma_f32_16x16x32_bf16 v[52:55], a[208:211], v[76:79], v[52:55]
  v_mfma_f32_16x16x32_bf16 v[56:59], v[144:147], v[72:75], v[56:59]
  v_mfma_f32_16x16x32_bf16 v[60:63], v[144:147], v[76:79], v[60:63]
  ds_read_b128 v[72:75], v7 offset:15360
  ds_read_b128 v[76:79], v7 offset:35840
  s_waitcnt lgkmcnt(4)
  v_mfma_f32_16x16x32_bf16 v[32:35], a[52:55], v[80:83], v[32:35]
  v_mfma_f32_16x16x32_bf16 v[36:39], a[52:55], v[84:87], v[36:39]
  v_mfma_f32_16x16x32_bf16 v[40:43], a[132:135], v[80:83], v[40:43]
  v_mfma_f32_16x16x32_bf16 v[44:47], a[132:135], v[84:87], v[44:47]
  v_mfma_f32_16x16x32_bf16 v[48:51], a[212:215], v[80:83], v[48:51]
  v_mfma_f32_16x16x32_bf16 v[52:55], a[212:215], v[84:87], v[52:55]
  v_mfma_f32_16x16x32_bf16 v[56:59], v[148:151], v[80:83], v[56:59]
  v_mfma_f32_16x16x32_bf16 v[60:63], v[148:151], v[84:87], v[60:63]
  ds_read_b128 v[80:83], v7 offset:16384
  ds_read_b128 v[84:87], v7 offset:36864
  s_waitcnt lgkmcnt(4)
  v_mfma_f32_16x16x32_bf16 v[32:35], a[56:59], v[88:91], v[32:35]
  v_mfma_f32_16x16x32_bf16 v[36:39], a[56:59], v[92:95], v[36:39]
  v_mfma_f32_16x16x32_bf16 v[40:43], a[136:139], v[88:91], v[40:43]
  v_mfma_f32_16x16x32_bf16 v[44:47], a[136:139], v[92:95], v[44:47]
  v_mfma_f32_16x16x32_bf16 v[48:51], a[216:219], v[88:91], v[48:51]
  v_mfma_f32_16x16x32_bf16 v[52:55], a[216:219], v[92:95], v[52:55]
  v_mfma_f32_16x16x32_bf16 v[56:59], v[152:155], v[88:91], v[56:59]
  v_mfma_f32_16x16x32_bf16 v[60:63], v[152:155], v[92:95], v[60:63]
  ds_read_b128 v[88:91], v7 offset:17408
  ds_read_b128 v[92:95], v7 offset:37888
  s_waitcnt lgkmcnt(4)
  v_mfma_f32_16x16x32_bf16 v[32:35], a[60:63], v[72:75], v[32:35]
  v_mfma_f32_16x16x32_bf16 v[36:39], a[60:63], v[76:79], v[36:39]
  v_mfma_f32_16x16x32_bf16 v[40:43], a[140:143], v[72:75], v[40:43]
  v_mfma_f32_16x16x32_bf16 v[44:47], a[140:143], v[76:79], v[44:47]
  v_mfma_f32_16x16x32_bf16 v[48:51], a[220:223], v[72:75], v[48:51]
  v_mfma_f32_16x16x32_bf16 v[52:55], a[220:223], v[76:79], v[52:55]
  v_mfma_f32_16x16x32_bf16 v[56:59], v[156:159], v[72:75], v[56:59]
  v_mfma_f32_16x16x32_bf16 v[60:63], v[156:159], v[76:79], v[60:63]
  ds_read_b128 v[72:75], v7 offset:18432
  ds_read_b128 v[76:79], v7 offset:38912
  s_waitcnt lgkmcnt(4)
  v_mfma_f32_16x16x32_bf16 v[32:35], a[64:67], v[80:83], v[32:35]
  v_mfma_f32_16x16x32_bf16 v[36:39], a[64:67], v[84:87], v[36:39]
  v_mfma_f32_16x16x32_bf16 v[40:43], a[144:147], v[80:83], v[40:43]
  v_mfma_f32_16x16x32_bf16 v[44:47], a[144:147], v[84:87], v[44:47]
  v_mfma_f32_16x16x32_bf16 v[48:51], a[224:227], v[80:83], v[48:51]
  v_mfma_f32_16x16x32_bf16 v[52:55], a[224:227], v[84:87], v[52:55]
  v_mfma_f32_16x16x32_bf16 v[56:59], v[160:163], v[80:83], v[56:59]
  v_mfma_f32_16x16x32_bf16 v[60:63], v[160:163], v[84:87], v[60:63]
  ds_read_b128 v[80:83], v7 offset:19456
  ds_read_b128 v[84:87], v7 offset:39936
  s_waitcnt lgkmcnt(4)
  v_mfma_f32_16x16x32_bf16 v[32:35], a[68:71], v[88:91], v[32:35]
  v_mfma_f32_16x16x32_bf16 v[36:39], a[68:71], v[92:95], v[36:39]
  v_mfma_f32_16x16x32_bf16 v[40:43], a[148:151], v[88:91], v[40:43]
  v_mfma_f32_16x16x32_bf16 v[44:47], a[148:151], v[92:95], v[44:47]
  v_mfma_f32_16x16x32_bf16 v[48:51], a[228:231], v[88:91], v[48:51]
  v_mfma_f32_16x16x32_bf16 v[52:55], a[228:231], v[92:95], v[52:55]
  v_mfma_f32_16x16x32_bf16 v[56:59], v[164:167], v[88:91], v[56:59]
  v_mfma_f32_16x16x32_bf16 v[60:63], v[164:167], v[92:95], v[60:63]
  s_waitcnt lgkmcnt(2)
  v_mfma_f32_16x16x32_bf16 v[32:35], a[72:75], v[72:75], v[32:35]
  v_mfma_f32_16x16x32_bf16 v[36:39], a[72:75], v[76:79], v[36:39]
  v_mfma_f32_16x16x32_bf16 v[40:43], a[152:155], v[72:75], v[40:43]
  v_mfma_f32_16x16x32_bf16 v[44:47], a[152:155], v[76:79], v[44:47]
  v_mfma_f32_16x16x32_bf16 v[48:51], a[232:235], v[72:75], v[48:51]
  v_mfma_f32_16x16x32_bf16 v[52:55], a[232:235], v[76:79], v[52:55]
  v_mfma_f32_16x16x32_bf16 v[56:59], v[168:171], v[72:75], v[56:59]
  v_mfma_f32_16x16x32_bf16 v[60:63], v[168:171], v[76:79], v[60:63]
  s_waitcnt lgkmcnt(0)
  v_mfma_f32_16x16x32_bf16 v[32:35], a[76:79], v[80:83], v[32:35]
  v_mfma_f32_16x16x32_bf16 v[36:39], a[76:79], v[84:87], v[36:39]
  v_mfma_f32_16x16x32_bf16 v[40:43], a[156:159], v[80:83], v[40:43]
  v_mfma_f32_16x16x32_bf16 v[44:47], a[156:159], v[84:87], v[44:47]
  v_mfma_f32_16x16x32_bf16 v[48:51], a[236:239], v[80:83], v[48:51]
  v_mfma_f32_16x16x32_bf16 v[52:55], a[236:239], v[84:87], v[52:55]
  v_mfma_f32_16x16x32_bf16 v[56:59], v[172:175], v[80:83], v[56:59]
  v_mfma_f32_16x16x32_bf16 v[60:63], v[172:175], v[84:87], v[60:63]
  s_nop 0
  v_cvt_pk_bf16_f32 v8, v32, v33
  v_cvt_pk_bf16_f32 v9, v34, v35
  v_cvt_pk_bf16_f32 v10, v40, v41
  v_cvt_pk_bf16_f32 v11, v42, v43
  s_add_u32 s34, s22, 1024
  buffer_store_dwordx4 v[8:11], v1, s[4:7], s34 offen sc1
  v_cvt_pk_bf16_f32 v12, v36, v37
  v_cvt_pk_bf16_f32 v13, v38, v39
  v_cvt_pk_bf16_f32 v14, v44, v45
  v_cvt_pk_bf16_f32 v15, v46, v47
  s_add_u32 s34, s22, 7168
  buffer_store_dwordx4 v[12:15], v1, s[4:7], s34 offen sc1
  v_cvt_pk_bf16_f32 v8, v48, v49
  v_cvt_pk_bf16_f32 v9, v50, v51
  v_cvt_pk_bf16_f32 v10, v56, v57
  v_cvt_pk_bf16_f32 v11, v58, v59
  s_add_u32 s34, s22, 2048
  buffer_store_dwordx4 v[8:11], v1, s[4:7], s34 offen sc1
  v_cvt_pk_bf16_f32 v12, v52, v53
  v_cvt_pk_bf16_f32 v13, v54, v55
  v_cvt_pk_bf16_f32 v14, v60, v61
  v_cvt_pk_bf16_f32 v15, v62, v63
  s_add_u32 s34, s22, 8192
  buffer_store_dwordx4 v[12:15], v1, s[4:7], s34 offen sc1
  s_waitcnt vmcnt(0)
  s_barrier
  s_add_u32 s17, s17, 1
  s_cmp_lt_u32 s17, 64
  s_cbranch_scc1 reca_ptop277
  s_branch reca_exit1
reca_exit1:
reca_exitb3:
  s_endpgm
.globl fin_kernel
.p2align 8
.type fin_kernel,@function
fin_kernel:
  s_cmp_ge_u32 s2, 256
  s_cbranch_scc1 fin_exit1
  s_load_dwordx2 s[8:9], s[0:1], 96
  v_lshrrev_b32 v6, 6, v0
  v_and_b32 v7, 63, v0
  s_and_b32 s13, s2, 7
  v_readfirstlane_b32 s12, v6
  v_lshlrev_b32 v1, 4, v7
  v_add_u32 v2, 0x1000, v1
  v_add_u32 v3, 0x2000, v1
  s_lshr_b32 s14, s2, 3
  s_lshl_b32 s15, s13, 2
  s_add_u32 s15, s15, s12
  s_waitcnt lgkmcnt(0)
  s_mov_b32 s4, s8
  s_mov_b32 s5, s9
  s_mov_b32 s6, 0x10000000
  s_mov_b32 s7, 0x20000
  s_mov_b32 s27, 0x3dd53b95
  v_and_b32 v6, 15, v7
  v_lshrrev_b32 v8, 4, v7
  v_mov_b32 v9, 0x80000000
  v_lshlrev_b32 v10, 4, v6
  v_lshl_add_u32 v10, v8, 7, v10
  v_cmp_gt_u32 vcc, 8, v6
  s_nop 1
  v_cndmask_b32 v4, v9, v10, vcc
  v_lshlrev_b32 v10, 3, v7
  v_cmp_gt_u32 vcc, 32, v7
  s_nop 1
  v_cndmask_b32 v5, v9, v10, vcc
  v_mov_b32 v10, 0xf149f2ca
  v_cmp_le_u32 vcc, 2, v8
  s_nop 1
  v_cndmask_b32 v12, 0, v10, vcc
  v_mov_b32 v13, v12
  v_mov_b32 v14, v12
  v_mov_b32 v15, v12
  v_lshlrev_b32 v11, 2, v8
  v_add_u32 v7, 0, v11
  v_cmp_gt_u32 vcc, v7, v6
  s_nop 1
  v_cndmask_b32 v16, 0, v10, vcc
  v_add_u32 v7, 1, v11
  v_cmp_gt_u32 vcc, v7, v6
  s_nop 1
  v_cndmask_b32 v17, 0, v10, vcc
  v_add_u32 v7, 2, v11
  v_cmp_gt_u32 vcc, v7, v6
  s_nop 1
  v_cndmask_b32 v18, 0, v10, vcc
  v_add_u32 v7, 3, v11
  v_cmp_gt_u32 vcc, v7, v6
  s_nop 1
  v_cndmask_b32 v19, 0, v10, vcc
  v_mov_b32 v20, 0x3f803f80
  v_mov_b32 v21, 0x3f803f80
  v_mov_b32 v22, 0x3f803f80
  v_mov_b32 v23, 0x3f803f80
  s_mul_i32 s16, s12, 6144
  v_add_u32 v240, s16, v1
  v_add_u32 v241, 49152, v240
  s_mul_i32 s16, s12, 10
  s_mul_i32 s16, s16, 192
  s_mul_i32 s17, s13, 24
  s_add_u32 s16, s16, s17
  s_lshl_b32 s16, s16, 10
  s_add_u32 s16, s16, 29884416
  s_add_u32 s30, s16, 0
  s_add_u32 s31, s16, 196608
  s_add_u32 s32, s16, 393216
  s_add_u32 s33, s16, 589824
  s_add_u32 s34, s16, 786432
  s_add_u32 s35, s16, 983040
  s_add_u32 s36, s16, 1179648
  s_add_u32 s37, s16, 1376256
  s_add_u32 s38, s16, 1572864
  s_add_u32 s39, s16, 1769472
  s_cmp_lt_u32 s14, 30
  s_cbranch_scc1 fin_odma3
  s_lshl_b32 s17, s14, 1
  s_add_u32 s17, s17, 0
  s_and_b32 s17, s17, 15
  s_lshl_b32 s16, s15, 4
  s_add_u32 s16, s16, s17
  s_mul_i32 s16, s16, 12288
  s_add_u32 s20, s16, 50331648
  s_add_u32 s21, s16, 37748736
  s_add_u32 s22, s16, 44040192
  s_lshl_b32 s17, s17, 5
  s_add_u32 s17, s17, s15
  s_mul_i32 s17, s17, 3072
  s_add_u32 s23, s17, 56623104
  s_add_u32 s24, s17, 58195968
  buffer_load_dwordx4 v[136:139], v1, s[4:7], s21 offen offset:0
  buffer_load_dwordx4 v[140:143], v1, s[4:7], s21 offen offset:1024
  buffer_load_dwordx4 v[144:147], v1, s[4:7], s21 offen offset:2048
  buffer_load_dwordx4 v[148:151], v1, s[4:7], s21 offen offset:3072
  buffer_load_dwordx4 v[152:155], v2, s[4:7], s21 offen offset:0
  buffer_load_dwordx4 v[156:159], v2, s[4:7], s21 offen offset:1024
  buffer_load_dwordx4 v[160:163], v2, s[4:7], s21 offen offset:2048
  buffer_load_dwordx4 v[164:167], v2, s[4:7], s21 offen offset:3072
  buffer_load_dwordx4 v[168:171], v3, s[4:7], s21 offen offset:0
  buffer_load_dwordx4 v[172:175], v3, s[4:7], s21 offen offset:1024
  buffer_load_dwordx4 v[176:179], v3, s[4:7], s21 offen offset:2048
  buffer_load_dwordx4 v[180:183], v3, s[4:7], s21 offen offset:3072
  buffer_load_dwordx4 v[184:187], v4, s[4:7], s23 offen offset:0
  buffer_load_dwordx4 v[188:191], v4, s[4:7], s23 offen offset:512
  buffer_load_dwordx4 v[192:195], v4, s[4:7], s23 offen offset:1024
  buffer_load_dwordx4 v[196:199], v4, s[4:7], s23 offen offset:1536
  buffer_load_dwordx4 v[200:203], v4, s[4:7], s23 offen offset:2048
  buffer_load_dwordx4 v[204:207], v4, s[4:7], s23 offen offset:2560
  buffer_load_dwordx4 v[88:91], v1, s[4:7], s20 offen offset:0
  buffer_load_dwordx4 v[92:95], v1, s[4:7], s20 offen offset:1024
  buffer_load_dwordx4 v[96:99], v1, s[4:7], s20 offen offset:2048
  buffer_load_dwordx4 v[100:103], v1, s[4:7], s20 offen offset:3072
  buffer_load_dwordx4 v[104:107], v2, s[4:7], s20 offen offset:0
  buffer_load_dwordx4 v[108:111], v2, s[4:7], s20 offen offset:1024
  buffer_load_dwordx4 v[112:115], v2, s[4:7], s20 offen offset:2048
  buffer_load_dwordx4 v[116:119], v2, s[4:7], s20 offen offset:3072
  buffer_load_dwordx4 v[120:123], v3, s[4:7], s20 offen offset:0
  buffer_load_dwordx4 v[124:127], v3, s[4:7], s20 offen offset:1024
  buffer_load_dwordx4 v[128:131], v3, s[4:7], s20 offen offset:2048
  buffer_load_dwordx4 v[132:135], v3, s[4:7], s20 offen offset:3072
  s_waitcnt vmcnt(5)
  v_mfma_f32_16x16x32_bf16 v[24:27], v[184:187], v[88:91], v[12:15]
  v_mfma_f32_16x16x32_bf16 v[28:31], v[136:139], v[88:91], v[16:19]
  v_mfma_f32_16x16x32_bf16 v[32:35], v[184:187], v[112:115], v[12:15]
  v_mfma_f32_16x16x32_bf16 v[36:39], v[136:139], v[112:115], 0
  v_mfma_f32_16x16x32_bf16 v[40:43], v[160:163], v[112:115], v[16:19]
  s_waitcnt vmcnt(4)
  v_mfma_f32_16x16x32_bf16 v[24:27], v[188:191], v[92:95], v[24:27]
  v_mfma_f32_16x16x32_bf16 v[28:31], v[140:143], v[92:95], v[28:31]
  v_mfma_f32_16x16x32_bf16 v[32:35], v[188:191], v[116:119], v[32:35]
  v_mfma_f32_16x16x32_bf16 v[36:39], v[140:143], v[116:119], v[36:39]
  v_mfma_f32_16x16x32_bf16 v[40:43], v[164:167], v[116:119], v[40:43]
  s_waitcnt vmcnt(3)
  v_mfma_f32_16x16x32_bf16 v[24:27], v[192:195], v[96:99], v[24:27]
  v_mfma_f32_16x16x32_bf16 v[28:31], v[144:147], v[96:99], v[28:31]
  v_mfma_f32_16x16x32_bf16 v[32:35], v[192:195], v[120:123], v[32:35]
  v_mfma_f32_16x16x32_bf16 v[36:39], v[144:147], v[120:123], v[36:39]
  v_mfma_f32_16x16x32_bf16 v[40:43], v[168:171], v[120:123], v[40:43]
  s_waitcnt vmcnt(2)
  v_mfma_f32_16x16x32_bf16 v[24:27], v[196:199], v[100:103], v[24:27]
  v_mfma_f32_16x16x32_bf16 v[28:31], v[148:151], v[100:103], v[28:31]
  v_mfma_f32_16x16x32_bf16 v[32:35], v[196:199], v[124:127], v[32:35]
  v_mfma_f32_16x16x32_bf16 v[36:39], v[148:151], v[124:127], v[36:39]
  v_mfma_f32_16x16x32_bf16 v[40:43], v[172:175], v[124:127], v[40:43]
  s_waitcnt vmcnt(1)
  v_mfma_f32_16x16x32_bf16 v[24:27], v[200:203], v[104:107], v[24:27]
  v_mfma_f32_16x16x32_bf16 v[28:31], v[152:155], v[104:107], v[28:31]
  v_mfma_f32_16x16x32_bf16 v[32:35], v[200:203], v[128:131], v[32:35]
  v_mfma_f32_16x16x32_bf16 v[36:39], v[152:155], v[128:131], v[36:39]
  v_mfma_f32_16x16x32_bf16 v[40:43], v[176:179], v[128:131], v[40:43]
  s_waitcnt vmcnt(0)
  v_mfma_f32_16x16x32_bf16 v[24:27], v[204:207], v[108:111], v[24:27]
  v_mfma_f32_16x16x32_bf16 v[28:31], v[156:159], v[108:111], v[28:31]
  v_mfma_f32_16x16x32_bf16 v[32:35], v[204:207], v[132:135], v[32:35]
  v_mfma_f32_16x16x32_bf16 v[36:39], v[156:159], v[132:135], v[36:39]
  v_mfma_f32_16x16x32_bf16 v[40:43], v[180:183], v[132:135], v[40:43]
  buffer_load_dwordx4 v[88:91], v1, s[4:7], s22 offen offset:0
  buffer_load_dwordx4 v[92:95], v1, s[4:7], s22 offen offset:1024
  buffer_load_dwordx4 v[96:99], v1, s[4:7], s22 offen offset:2048
  buffer_load_dwordx4 v[100:103], v1, s[4:7], s22 offen offset:3072
  buffer_load_dwordx4 v[104:107], v2, s[4:7], s22 offen offset:0
  buffer_load_dwordx4 v[108:111], v2, s[4:7], s22 offen offset:1024
  buffer_load_dwordx4 v[112:115], v2, s[4:7], s22 offen offset:2048
  buffer_load_dwordx4 v[116:119], v2, s[4:7], s22 offen offset:3072
  buffer_load_dwordx4 v[120:123], v3, s[4:7], s22 offen offset:0
  buffer_load_dwordx4 v[124:127], v3, s[4:7], s22 offen offset:1024
  buffer_load_dwordx4 v[128:131], v3, s[4:7], s22 offen offset:2048
  buffer_load_dwordx4 v[132:135], v3, s[4:7], s22 offen offset:3072
  buffer_load_dwordx2 v[136:137], v5, s[4:7], s24 offen offset:0
  buffer_load_dwordx2 v[138:139], v5, s[4:7], s24 offen offset:256
  buffer_load_dwordx2 v[140:141], v5, s[4:7], s24 offen offset:512
  buffer_load_dwordx2 v[142:143], v5, s[4:7], s24 offen offset:768
  buffer_load_dwordx2 v[144:145], v5, s[4:7], s24 offen offset:1024
  buffer_load_dwordx2 v[146:147], v5, s[4:7], s24 offen offset:1280
  buffer_load_dwordx2 v[148:149], v5, s[4:7], s24 offen offset:1536
  buffer_load_dwordx2 v[150:151], v5, s[4:7], s24 offen offset:1792
  buffer_load_dwordx2 v[152:153], v5, s[4:7], s24 offen offset:2048
  buffer_load_dwordx2 v[154:155], v5, s[4:7], s24 offen offset:2304
  buffer_load_dwordx2 v[156:157], v5, s[4:7], s24 offen offset:2560
  buffer_load_dwordx2 v[158:159], v5, s[4:7], s24 offen offset:2816
  v_max3_f32 v6, v24, v25, v26
  v_max3_f32 v6, v6, v27, v28
  v_max3_f32 v6, v6, v29, v30
  v_max_f32 v6, v6, v31
  v_mov_b32 v7, v6
  s_nop 1
  v_permlane32_swap_b32 v6, v7
  v_max_f32 v6, v6, v7
  v_mov_b32 v7, v6
  s_nop 1
  v_permlane16_swap_b32 v6, v7
  v_max_f32 v6, v6, v7
  v_mul_f32 v6, s27, v6
  v_fma_f32 v24, v24, s27, -v6
  v_fma_f32 v25, v25, s27, -v6
  v_fma_f32 v26, v26, s27, -v6
  v_fma_f32 v27, v27, s27, -v6
  v_fma_f32 v28, v28, s27, -v6
  v_fma_f32 v29, v29, s27, -v6
  v_fma_f32 v30, v30, s27, -v6
  v_fma_f32 v31, v31, s27, -v6
  v_exp_f32 v24, v24
  v_exp_f32 v25, v25
  v_exp_f32 v26, v26
  v_exp_f32 v27, v27
  v_exp_f32 v28, v28
  v_exp_f32 v29, v29
  v_exp_f32 v30, v30
  v_exp_f32 v31, v31
  v_max3_f32 v8, v32, v33, v34
  v_max3_f32 v8, v8, v35, v36
  v_max3_f32 v8, v8, v37, v38
  v_max3_f32 v8, v8, v39, v40
  v_max3_f32 v8, v8, v41, v42
  v_max_f32 v8, v8, v43
  v_mov_b32 v10, v8
  s_nop 1
  v_permlane32_swap_b32 v8, v10
  v_max_f32 v8, v8, v10
  v_mov_b32 v10, v8
  s_nop 1
  v_permlane16_swap_b32 v8, v10
  v_max_f32 v8, v8, v10
  v_mul_f32 v8, s27, v8
  v_fma_f32 v32, v32, s27, -v8
  v_fma_f32 v33, v33, s27, -v8
  v_fma_f32 v34, v34, s27, -v8
  v_fma_f32 v35, v35, s27, -v8
  v_fma_f32 v36, v36, s27, -v8
  v_fma_f32 v37, v37, s27, -v8
  v_fma_f32 v38, v38, s27, -v8
  v_fma_f32 v39, v39, s27, -v8
  v_fma_f32 v40, v40, s27, -v8
  v_fma_f32 v41, v41, s27, -v8
  v_fma_f32 v42, v42, s27, -v8
  v_fma_f32 v43, v43, s27, -v8
  v_exp_f32 v32, v32
  v_exp_f32 v33, v33
  v_exp_f32 v34, v34
  v_exp_f32 v35, v35
  v_exp_f32 v36, v36
  v_exp_f32 v37, v37
  v_exp_f32 v38, v38
  v_exp_f32 v39, v39
  v_exp_f32 v40, v40
  v_exp_f32 v41, v41
  v_exp_f32 v42, v42
  v_exp_f32 v43, v43
  v_cvt_pk_bf16_f32 v44, v24, v25
  v_cvt_pk_bf16_f32 v45, v26, v27
  v_cvt_pk_bf16_f32 v46, v28, v29
  v_cvt_pk_bf16_f32 v47, v30, v31
  v_cvt_pk_bf16_f32 v48, v32, v33
  v_cvt_pk_bf16_f32 v49, v34, v35
  v_cvt_pk_bf16_f32 v50, v36, v37
  v_cvt_pk_bf16_f32 v51, v38, v39
  v_cvt_pk_bf16_f32 v52, v40, v41
  v_cvt_pk_bf16_f32 v53, v42, v43
  v_mfma_f32_16x16x16_bf16 v[56:59], v[20:21], v[44:45], 0
  v_mfma_f32_16x16x16_bf16 v[60:63], v[20:21], v[48:49], 0
  v_mfma_f32_16x16x16_bf16 v[56:59], v[20:21], v[46:47], v[56:59]
  v_mfma_f32_16x16x32_bf16 v[60:63], v[20:23], v[50:53], v[60:63]
  s_nop 6
  v_rcp_f32 v10, v56
  v_rcp_f32 v11, v60
  s_waitcnt vmcnt(0)
  v_mfma_f32_16x16x16_bf16 v[64:67], v[136:137], v[44:45], 0
  v_mfma_f32_16x16x16_bf16 v[68:71], v[136:137], v[48:49], 0
  v_mfma_f32_16x16x16_bf16 v[64:67], v[88:89], v[46:47], v[64:67]
  v_mfma_f32_16x16x32_bf16 v[68:71], v[88:91], v[50:53], v[68:71]
  v_mfma_f32_16x16x16_bf16 v[72:75], v[138:139], v[44:45], 0
  v_mfma_f32_16x16x16_bf16 v[76:79], v[138:139], v[48:49], 0
  v_mfma_f32_16x16x16_bf16 v[72:75], v[92:93], v[46:47], v[72:75]
  v_mfma_f32_16x16x32_bf16 v[76:79], v[92:95], v[50:53], v[76:79]
  s_nop 2
  v_mul_f32 v64, v64, v10
  v_mul_f32 v65, v65, v10
  v_mul_f32 v66, v66, v10
  v_mul_f32 v67, v67, v10
  v_cvt_pk_bf16_f32 v80, v64, v65
  v_cvt_pk_bf16_f32 v81, v66, v67
  v_mul_f32 v72, v72, v10
  v_mul_f32 v73, v73, v10
  v_mul_f32 v74, v74, v10
  v_mul_f32 v75, v75, v10
  v_cvt_pk_bf16_f32 v82, v72, v73
  v_cvt_pk_bf16_f32 v83, v74, v75
  ds_write_b128 v240, v[80:83] offset:0
  v_mul_f32 v68, v68, v11
  v_mul_f32 v69, v69, v11
  v_mul_f32 v70, v70, v11
  v_mul_f32 v71, v71, v11
  v_cvt_pk_bf16_f32 v84, v68, v69
  v_cvt_pk_bf16_f32 v85, v70, v71
  v_mul_f32 v76, v76, v11
  v_mul_f32 v77, v77, v11
  v_mul_f32 v78, v78, v11
  v_mul_f32 v79, v79, v11
  v_cvt_pk_bf16_f32 v86, v76, v77
  v_cvt_pk_bf16_f32 v87, v78, v79
  ds_write_b128 v240, v[84:87] offset:24576
  v_mfma_f32_16x16x16_bf16 v[64:67], v[140:141], v[44:45], 0
  v_mfma_f32_16x16x16_bf16 v[68:71], v[140:141], v[48:49], 0
  v_mfma_f32_16x16x16_bf16 v[64:67], v[96:97], v[46:47], v[64:67]
  v_mfma_f32_16x16x32_bf16 v[68:71], v[96:99], v[50:53], v[68:71]
  v_mfma_f32_16x16x16_bf16 v[72:75], v[142:143], v[44:45], 0
  v_mfma_f32_16x16x16_bf16 v[76:79], v[142:143], v[48:49], 0
  v_mfma_f32_16x16x16_bf16 v[72:75], v[100:101], v[46:47], v[72:75]
  v_mfma_f32_16x16x32_bf16 v[76:79], v[100:103], v[50:53], v[76:79]
  s_nop 2
  v_mul_f32 v64, v64, v10
  v_mul_f32 v65, v65, v10
  v_mul_f32 v66, v66, v10
  v_mul_f32 v67, v67, v10
  v_cvt_pk_bf16_f32 v80, v64, v65
  v_cvt_pk_bf16_f32 v81, v66, v67
  v_mul_f32 v72, v72, v10
  v_mul_f32 v73, v73, v10
  v_mul_f32 v74, v74, v10
  v_mul_f32 v75, v75, v10
  v_cvt_pk_bf16_f32 v82, v72, v73
  v_cvt_pk_bf16_f32 v83, v74, v75
  ds_write_b128 v240, v[80:83] offset:1024
  v_mul_f32 v68, v68, v11
  v_mul_f32 v69, v69, v11
  v_mul_f32 v70, v70, v11
  v_mul_f32 v71, v71, v11
  v_cvt_pk_bf16_f32 v84, v68, v69
  v_cvt_pk_bf16_f32 v85, v70, v71
  v_mul_f32 v76, v76, v11
  v_mul_f32 v77, v77, v11
  v_mul_f32 v78, v78, v11
  v_mul_f32 v79, v79, v11
  v_cvt_pk_bf16_f32 v86, v76, v77
  v_cvt_pk_bf16_f32 v87, v78, v79
  ds_write_b128 v240, v[84:87] offset:25600
  v_mfma_f32_16x16x16_bf16 v[64:67], v[144:145], v[44:45], 0
  v_mfma_f32_16x16x16_bf16 v[68:71], v[144:145], v[48:49], 0
  v_mfma_f32_16x16x16_bf16 v[64:67], v[104:105], v[46:47], v[64:67]
  v_mfma_f32_16x16x32_bf16 v[68:71], v[104:107], v[50:53], v[68:71]
  v_mfma_f32_16x16x16_bf16 v[72:75], v[146:147], v[44:45], 0
  v_mfma_f32_16x16x16_bf16 v[76:79], v[146:147], v[48:49], 0
  v_mfma_f32_16x16x16_bf16 v[72:75], v[108:109], v[46:47], v[72:75]
  v_mfma_f32_16x16x32_bf16 v[76:79], v[108:111], v[50:53], v[76:79]
  s_nop 2
  v_mul_f32 v64, v64, v10
  v_mul_f32 v65, v65, v10
  v_mul_f32 v66, v66, v10
  v_mul_f32 v67, v67, v10
  v_cvt_pk_bf16_f32 v80, v64, v65
  v_cvt_pk_bf16_f32 v81, v66, v67
  v_mul_f32 v72, v72, v10
  v_mul_f32 v73, v73, v10
  v_mul_f32 v74, v74, v10
  v_mul_f32 v75, v75, v10
  v_cvt_pk_bf16_f32 v82, v72, v73
  v_cvt_pk_bf16_f32 v83, v74, v75
  ds_write_b128 v240, v[80:83] offset:2048
  v_mul_f32 v68, v68, v11
  v_mul_f32 v69, v69, v11
  v_mul_f32 v70, v70, v11
  v_mul_f32 v71, v71, v11
  v_cvt_pk_bf16_f32 v84, v68, v69
  v_cvt_pk_bf16_f32 v85, v70, v71
  v_mul_f32 v76, v76, v11
  v_mul_f32 v77, v77, v11
  v_mul_f32 v78, v78, v11
  v_mul_f32 v79, v79, v11
  v_cvt_pk_bf16_f32 v86, v76, v77
  v_cvt_pk_bf16_f32 v87, v78, v79
  ds_write_b128 v240, v[84:87] offset:26624
  v_mfma_f32_16x16x16_bf16 v[64:67], v[148:149], v[44:45], 0
  v_mfma_f32_16x16x16_bf16 v[68:71], v[148:149], v[48:49], 0
  v_mfma_f32_16x16x16_bf16 v[64:67], v[112:113], v[46:47], v[64:67]
  v_mfma_f32_16x16x32_bf16 v[68:71], v[112:115], v[50:53], v[68:71]
  v_mfma_f32_16x16x16_bf16 v[72:75], v[150:151], v[44:45], 0
  v_mfma_f32_16x16x16_bf16 v[76:79], v[150:151], v[48:49], 0
  v_mfma_f32_16x16x16_bf16 v[72:75], v[116:117], v[46:47], v[72:75]
  v_mfma_f32_16x16x32_bf16 v[76:79], v[116:119], v[50:53], v[76:79]
  s_nop 2
  v_mul_f32 v64, v64, v10
  v_mul_f32 v65, v65, v10
  v_mul_f32 v66, v66, v10
  v_mul_f32 v67, v67, v10
  v_cvt_pk_bf16_f32 v80, v64, v65
  v_cvt_pk_bf16_f32 v81, v66, v67
  v_mul_f32 v72, v72, v10
  v_mul_f32 v73, v73, v10
  v_mul_f32 v74, v74, v10
  v_mul_f32 v75, v75, v10
  v_cvt_pk_bf16_f32 v82, v72, v73
  v_cvt_pk_bf16_f32 v83, v74, v75
  ds_write_b128 v240, v[80:83] offset:3072
  v_mul_f32 v68, v68, v11
  v_mul_f32 v69, v69, v11
  v_mul_f32 v70, v70, v11
  v_mul_f32 v71, v71, v11
  v_cvt_pk_bf16_f32 v84, v68, v69
  v_cvt_pk_bf16_f32 v85, v70, v71
  v_mul_f32 v76, v76, v11
  v_mul_f32 v77, v77, v11
  v_mul_f32 v78, v78, v11
  v_mul_f32 v79, v79, v11
  v_cvt_pk_bf16_f32 v86, v76, v77
  v_cvt_pk_bf16_f32 v87, v78, v79
  ds_write_b128 v240, v[84:87] offset:27648
  v_mfma_f32_16x16x16_bf16 v[64:67], v[152:153], v[44:45], 0
  v_mfma_f32_16x16x16_bf16 v[68:71], v[152:153], v[48:49], 0
  v_mfma_f32_16x16x16_bf16 v[64:67], v[120:121], v[46:47], v[64:67]
  v_mfma_f32_16x16x32_bf16 v[68:71], v[120:123], v[50:53], v[68:71]
  v_mfma_f32_16x16x16_bf16 v[72:75], v[154:155], v[44:45], 0
  v_mfma_f32_16x16x16_bf16 v[76:79], v[154:155], v[48:49], 0
  v_mfma_f32_16x16x16_bf16 v[72:75], v[124:125], v[46:47], v[72:75]
  v_mfma_f32_16x16x32_bf16 v[76:79], v[124:127], v[50:53], v[76:79]
  s_nop 2
  v_mul_f32 v64, v64, v10
  v_mul_f32 v65, v65, v10
  v_mul_f32 v66, v66, v10
  v_mul_f32 v67, v67, v10
  v_cvt_pk_bf16_f32 v80, v64, v65
  v_cvt_pk_bf16_f32 v81, v66, v67
  v_mul_f32 v72, v72, v10
  v_mul_f32 v73, v73, v10
  v_mul_f32 v74, v74, v10
  v_mul_f32 v75, v75, v10
  v_cvt_pk_bf16_f32 v82, v72, v73
  v_cvt_pk_bf16_f32 v83, v74, v75
  ds_write_b128 v240, v[80:83] offset:4096
  v_mul_f32 v68, v68, v11
  v_mul_f32 v69, v69, v11
  v_mul_f32 v70, v70, v11
  v_mul_f32 v71, v71, v11
  v_cvt_pk_bf16_f32 v84, v68, v69
  v_cvt_pk_bf16_f32 v85, v70, v71
  v_mul_f32 v76, v76, v11
  v_mul_f32 v77, v77, v11
  v_mul_f32 v78, v78, v11
  v_mul_f32 v79, v79, v11
  v_cvt_pk_bf16_f32 v86, v76, v77
  v_cvt_pk_bf16_f32 v87, v78, v79
  ds_write_b128 v240, v[84:87] offset:28672
  v_mfma_f32_16x16x16_bf16 v[64:67], v[156:157], v[44:45], 0
  v_mfma_f32_16x16x16_bf16 v[68:71], v[156:157], v[48:49], 0
  v_mfma_f32_16x16x16_bf16 v[64:67], v[128:129], v[46:47], v[64:67]
  v_mfma_f32_16x16x32_bf16 v[68:71], v[128:131], v[50:53], v[68:71]
  v_mfma_f32_16x16x16_bf16 v[72:75], v[158:159], v[44:45], 0
  v_mfma_f32_16x16x16_bf16 v[76:79], v[158:159], v[48:49], 0
  v_mfma_f32_16x16x16_bf16 v[72:75], v[132:133], v[46:47], v[72:75]
  v_mfma_f32_16x16x32_bf16 v[76:79], v[132:135], v[50:53], v[76:79]
  s_nop 2
  v_mul_f32 v64, v64, v10
  v_mul_f32 v65, v65, v10
  v_mul_f32 v66, v66, v10
  v_mul_f32 v67, v67, v10
  v_cvt_pk_bf16_f32 v80, v64, v65
  v_cvt_pk_bf16_f32 v81, v66, v67
  v_mul_f32 v72, v72, v10
  v_mul_f32 v73, v73, v10
  v_mul_f32 v74, v74, v10
  v_mul_f32 v75, v75, v10
  v_cvt_pk_bf16_f32 v82, v72, v73
  v_cvt_pk_bf16_f32 v83, v74, v75
  ds_write_b128 v240, v[80:83] offset:5120
  v_mul_f32 v68, v68, v11
  v_mul_f32 v69, v69, v11
  v_mul_f32 v70, v70, v11
  v_mul_f32 v71, v71, v11
  v_cvt_pk_bf16_f32 v84, v68, v69
  v_cvt_pk_bf16_f32 v85, v70, v71
  v_mul_f32 v76, v76, v11
  v_mul_f32 v77, v77, v11
  v_mul_f32 v78, v78, v11
  v_mul_f32 v79, v79, v11
  v_cvt_pk_bf16_f32 v86, v76, v77
  v_cvt_pk_bf16_f32 v87, v78, v79
  ds_write_b128 v240, v[84:87] offset:29696
  s_lshl_b32 s17, s14, 1
  s_add_u32 s17, s17, 1
  s_and_b32 s17, s17, 15
  s_lshl_b32 s16, s15, 4
  s_add_u32 s16, s16, s17
  s_mul_i32 s16, s16, 12288
  s_add_u32 s20, s16, 50331648
  s_add_u32 s21, s16, 37748736
  s_add_u32 s22, s16, 44040192
  s_lshl_b32 s17, s17, 5
  s_add_u32 s17, s17, s15
  s_mul_i32 s17, s17, 3072
  s_add_u32 s23, s17, 56623104
  s_add_u32 s24, s17, 58195968
  buffer_load_dwordx4 v[136:139], v1, s[4:7], s21 offen offset:0
  buffer_load_dwordx4 v[140:143], v1, s[4:7], s21 offen offset:1024
  buffer_load_dwordx4 v[144:147], v1, s[4:7], s21 offen offset:2048
  buffer_load_dwordx4 v[148:151], v1, s[4:7], s21 offen offset:3072
  buffer_load_dwordx4 v[152:155], v2, s[4:7], s21 offen offset:0
  buffer_load_dwordx4 v[156:159], v2, s[4:7], s21 offen offset:1024
  buffer_load_dwordx4 v[160:163], v2, s[4:7], s21 offen offset:2048
  buffer_load_dwordx4 v[164:167], v2, s[4:7], s21 offen offset:3072
  buffer_load_dwordx4 v[168:171], v3, s[4:7], s21 offen offset:0
  buffer_load_dwordx4 v[172:175], v3, s[4:7], s21 offen offset:1024
  buffer_load_dwordx4 v[176:179], v3, s[4:7], s21 offen offset:2048
  buffer_load_dwordx4 v[180:183], v3, s[4:7], s21 offen offset:3072
  buffer_load_dwordx4 v[184:187], v4, s[4:7], s23 offen offset:0
  buffer_load_dwordx4 v[188:191], v4, s[4:7], s23 offen offset:512
  buffer_load_dwordx4 v[192:195], v4, s[4:7], s23 offen offset:1024
  buffer_load_dwordx4 v[196:199], v4, s[4:7], s23 offen offset:1536
  buffer_load_dwordx4 v[200:203], v4, s[4:7], s23 offen offset:2048
  buffer_load_dwordx4 v[204:207], v4, s[4:7], s23 offen offset:2560
  buffer_load_dwordx4 v[88:91], v1, s[4:7], s20 offen offset:0
  buffer_load_dwordx4 v[92:95], v1, s[4:7], s20 offen offset:1024
  buffer_load_dwordx4 v[96:99], v1, s[4:7], s20 offen offset:2048
  buffer_load_dwordx4 v[100:103], v1, s[4:7], s20 offen offset:3072
  buffer_load_dwordx4 v[104:107], v2, s[4:7], s20 offen offset:0
  buffer_load_dwordx4 v[108:111], v2, s[4:7], s20 offen offset:1024
  buffer_load_dwordx4 v[112:115], v2, s[4:7], s20 offen offset:2048
  buffer_load_dwordx4 v[116:119], v2, s[4:7], s20 offen offset:3072
  buffer_load_dwordx4 v[120:123], v3, s[4:7], s20 offen offset:0
  buffer_load_dwordx4 v[124:127], v3, s[4:7], s20 offen offset:1024
  buffer_load_dwordx4 v[128:131], v3, s[4:7], s20 offen offset:2048
  buffer_load_dwordx4 v[132:135], v3, s[4:7], s20 offen offset:3072
  s_waitcnt vmcnt(5)
  v_mfma_f32_16x16x32_bf16 v[24:27], v[184:187], v[88:91], v[12:15]
  v_mfma_f32_16x16x32_bf16 v[28:31], v[136:139], v[88:91], v[16:19]
  v_mfma_f32_16x16x32_bf16 v[32:35], v[184:187], v[112:115], v[12:15]
  v_mfma_f32_16x16x32_bf16 v[36:39], v[136:139], v[112:115], 0
  v_mfma_f32_16x16x32_bf16 v[40:43], v[160:163], v[112:115], v[16:19]
  s_waitcnt vmcnt(4)
  v_mfma_f32_16x16x32_bf16 v[24:27], v[188:191], v[92:95], v[24:27]
  v_mfma_f32_16x16x32_bf16 v[28:31], v[140:143], v[92:95], v[28:31]
  v_mfma_f32_16x16x32_bf16 v[32:35], v[188:191], v[116:119], v[32:35]
  v_mfma_f32_16x16x32_bf16 v[36:39], v[140:143], v[116:119], v[36:39]
  v_mfma_f32_16x16x32_bf16 v[40:43], v[164:167], v[116:119], v[40:43]
  s_waitcnt vmcnt(3)
  v_mfma_f32_16x16x32_bf16 v[24:27], v[192:195], v[96:99], v[24:27]
  v_mfma_f32_16x16x32_bf16 v[28:31], v[144:147], v[96:99], v[28:31]
  v_mfma_f32_16x16x32_bf16 v[32:35], v[192:195], v[120:123], v[32:35]
  v_mfma_f32_16x16x32_bf16 v[36:39], v[144:147], v[120:123], v[36:39]
  v_mfma_f32_16x16x32_bf16 v[40:43], v[168:171], v[120:123], v[40:43]
  s_waitcnt vmcnt(2)
  v_mfma_f32_16x16x32_bf16 v[24:27], v[196:199], v[100:103], v[24:27]
  v_mfma_f32_16x16x32_bf16 v[28:31], v[148:151], v[100:103], v[28:31]
  v_mfma_f32_16x16x32_bf16 v[32:35], v[196:199], v[124:127], v[32:35]
  v_mfma_f32_16x16x32_bf16 v[36:39], v[148:151], v[124:127], v[36:39]
  v_mfma_f32_16x16x32_bf16 v[40:43], v[172:175], v[124:127], v[40:43]
  s_waitcnt vmcnt(1)
  v_mfma_f32_16x16x32_bf16 v[24:27], v[200:203], v[104:107], v[24:27]
  v_mfma_f32_16x16x32_bf16 v[28:31], v[152:155], v[104:107], v[28:31]
  v_mfma_f32_16x16x32_bf16 v[32:35], v[200:203], v[128:131], v[32:35]
  v_mfma_f32_16x16x32_bf16 v[36:39], v[152:155], v[128:131], v[36:39]
  v_mfma_f32_16x16x32_bf16 v[40:43], v[176:179], v[128:131], v[40:43]
  s_waitcnt vmcnt(0)
  v_mfma_f32_16x16x32_bf16 v[24:27], v[204:207], v[108:111], v[24:27]
  v_mfma_f32_16x16x32_bf16 v[28:31], v[156:159], v[108:111], v[28:31]
  v_mfma_f32_16x16x32_bf16 v[32:35], v[204:207], v[132:135], v[32:35]
  v_mfma_f32_16x16x32_bf16 v[36:39], v[156:159], v[132:135], v[36:39]
  v_mfma_f32_16x16x32_bf16 v[40:43], v[180:183], v[132:135], v[40:43]
  buffer_load_dwordx4 v[88:91], v1, s[4:7], s22 offen offset:0
  buffer_load_dwordx4 v[92:95], v1, s[4:7], s22 offen offset:1024
  buffer_load_dwordx4 v[96:99], v1, s[4:7], s22 offen offset:2048
  buffer_load_dwordx4 v[100:103], v1, s[4:7], s22 offen offset:3072
  buffer_load_dwordx4 v[104:107], v2, s[4:7], s22 offen offset:0
  buffer_load_dwordx4 v[108:111], v2, s[4:7], s22 offen offset:1024
  buffer_load_dwordx4 v[112:115], v2, s[4:7], s22 offen offset:2048
  buffer_load_dwordx4 v[116:119], v2, s[4:7], s22 offen offset:3072
  buffer_load_dwordx4 v[120:123], v3, s[4:7], s22 offen offset:0
  buffer_load_dwordx4 v[124:127], v3, s[4:7], s22 offen offset:1024
  buffer_load_dwordx4 v[128:131], v3, s[4:7], s22 offen offset:2048
  buffer_load_dwordx4 v[132:135], v3, s[4:7], s22 offen offset:3072
  buffer_load_dwordx2 v[136:137], v5, s[4:7], s24 offen offset:0
  buffer_load_dwordx2 v[138:139], v5, s[4:7], s24 offen offset:256
  buffer_load_dwordx2 v[140:141], v5, s[4:7], s24 offen offset:512
  buffer_load_dwordx2 v[142:143], v5, s[4:7], s24 offen offset:768
  buffer_load_dwordx2 v[144:145], v5, s[4:7], s24 offen offset:1024
  buffer_load_dwordx2 v[146:147], v5, s[4:7], s24 offen offset:1280
  buffer_load_dwordx2 v[148:149], v5, s[4:7], s24 offen offset:1536
  buffer_load_dwordx2 v[150:151], v5, s[4:7], s24 offen offset:1792
  buffer_load_dwordx2 v[152:153], v5, s[4:7], s24 offen offset:2048
  buffer_load_dwordx2 v[154:155], v5, s[4:7], s24 offen offset:2304
  buffer_load_dwordx2 v[156:157], v5, s[4:7], s24 offen offset:2560
  buffer_load_dwordx2 v[158:159], v5, s[4:7], s24 offen offset:2816
  v_max3_f32 v6, v24, v25, v26
  v_max3_f32 v6, v6, v27, v28
  v_max3_f32 v6, v6, v29, v30
  v_max_f32 v6, v6, v31
  v_mov_b32 v7, v6
  s_nop 1
  v_permlane32_swap_b32 v6, v7
  v_max_f32 v6, v6, v7
  v_mov_b32 v7, v6
  s_nop 1
  v_permlane16_swap_b32 v6, v7
  v_max_f32 v6, v6, v7
  v_mul_f32 v6, s27, v6
  v_fma_f32 v24, v24, s27, -v6
  v_fma_f32 v25, v25, s27, -v6
  v_fma_f32 v26, v26, s27, -v6
  v_fma_f32 v27, v27, s27, -v6
  v_fma_f32 v28, v28, s27, -v6
  v_fma_f32 v29, v29, s27, -v6
  v_fma_f32 v30, v30, s27, -v6
  v_fma_f32 v31, v31, s27, -v6
  v_exp_f32 v24, v24
  v_exp_f32 v25, v25
  v_exp_f32 v26, v26
  v_exp_f32 v27, v27
  v_exp_f32 v28, v28
  v_exp_f32 v29, v29
  v_exp_f32 v30, v30
  v_exp_f32 v31, v31
  v_max3_f32 v8, v32, v33, v34
  v_max3_f32 v8, v8, v35, v36
  v_max3_f32 v8, v8, v37, v38
  v_max3_f32 v8, v8, v39, v40
  v_max3_f32 v8, v8, v41, v42
  v_max_f32 v8, v8, v43
  v_mov_b32 v10, v8
  s_nop 1
  v_permlane32_swap_b32 v8, v10
  v_max_f32 v8, v8, v10
  v_mov_b32 v10, v8
  s_nop 1
  v_permlane16_swap_b32 v8, v10
  v_max_f32 v8, v8, v10
  v_mul_f32 v8, s27, v8
  v_fma_f32 v32, v32, s27, -v8
  v_fma_f32 v33, v33, s27, -v8
  v_fma_f32 v34, v34, s27, -v8
  v_fma_f32 v35, v35, s27, -v8
  v_fma_f32 v36, v36, s27, -v8
  v_fma_f32 v37, v37, s27, -v8
  v_fma_f32 v38, v38, s27, -v8
  v_fma_f32 v39, v39, s27, -v8
  v_fma_f32 v40, v40, s27, -v8
  v_fma_f32 v41, v41, s27, -v8
  v_fma_f32 v42, v42, s27, -v8
  v_fma_f32 v43, v43, s27, -v8
  v_exp_f32 v32, v32
  v_exp_f32 v33, v33
  v_exp_f32 v34, v34
  v_exp_f32 v35, v35
  v_exp_f32 v36, v36
  v_exp_f32 v37, v37
  v_exp_f32 v38, v38
  v_exp_f32 v39, v39
  v_exp_f32 v40, v40
  v_exp_f32 v41, v41
  v_exp_f32 v42, v42
  v_exp_f32 v43, v43
  v_cvt_pk_bf16_f32 v44, v24, v25
  v_cvt_pk_bf16_f32 v45, v26, v27
  v_cvt_pk_bf16_f32 v46, v28, v29
  v_cvt_pk_bf16_f32 v47, v30, v31
  v_cvt_pk_bf16_f32 v48, v32, v33
  v_cvt_pk_bf16_f32 v49, v34, v35
  v_cvt_pk_bf16_f32 v50, v36, v37
  v_cvt_pk_bf16_f32 v51, v38, v39
  v_cvt_pk_bf16_f32 v52, v40, v41
  v_cvt_pk_bf16_f32 v53, v42, v43
  v_mfma_f32_16x16x16_bf16 v[56:59], v[20:21], v[44:45], 0
  v_mfma_f32_16x16x16_bf16 v[60:63], v[20:21], v[48:49], 0
  v_mfma_f32_16x16x16_bf16 v[56:59], v[20:21], v[46:47], v[56:59]
  v_mfma_f32_16x16x32_bf16 v[60:63], v[20:23], v[50:53], v[60:63]
  s_nop 6
  v_rcp_f32 v10, v56
  v_rcp_f32 v11, v60
  s_waitcnt vmcnt(0)
  buffer_load_dwordx4 a[160:163], v1, s[4:7], s30 offen offset:0
  buffer_load_dwordx4 a[164:167], v1, s[4:7], s31 offen offset:0
  buffer_load_dwordx4 a[168:171], v1, s[4:7], s32 offen offset:0
  buffer_load_dwordx4 a[172:175], v1, s[4:7], s33 offen offset:0
  buffer_load_dwordx4 a[176:179], v1, s[4:7], s34 offen offset:0
  buffer_load_dwordx4 a[180:183], v1, s[4:7], s35 offen offset:0
  buffer_load_dwordx4 a[184:187], v1, s[4:7], s36 offen offset:0
  buffer_load_dwordx4 a[188:191], v1, s[4:7], s37 offen offset:0
  buffer_load_dwordx4 a[192:195], v1, s[4:7], s38 offen offset:0
  buffer_load_dwordx4 a[196:199], v1, s[4:7], s39 offen offset:0
  buffer_load_dwordx4 a[200:203], v1, s[4:7], s30 offen offset:1024
  buffer_load_dwordx4 a[204:207], v1, s[4:7], s31 offen offset:1024
  buffer_load_dwordx4 a[208:211], v1, s[4:7], s32 offen offset:1024
  buffer_load_dwordx4 a[212:215], v1, s[4:7], s33 offen offset:1024
  buffer_load_dwordx4 a[216:219], v1, s[4:7], s34 offen offset:1024
  buffer_load_dwordx4 a[220:223], v1, s[4:7], s35 offen offset:1024
  buffer_load_dwordx4 a[224:227], v1, s[4:7], s36 offen offset:1024
  buffer_load_dwordx4 a[228:231], v1, s[4:7], s37 offen offset:1024
  buffer_load_dwordx4 a[232:235], v1, s[4:7], s38 offen offset:1024
  buffer_load_dwordx4 a[236:239], v1, s[4:7], s39 offen offset:1024
  v_mfma_f32_16x16x16_bf16 v[64:67], v[136:137], v[44:45], 0
  v_mfma_f32_16x16x16_bf16 v[68:71], v[136:137], v[48:49], 0
  v_mfma_f32_16x16x16_bf16 v[64:67], v[88:89], v[46:47], v[64:67]
  v_mfma_f32_16x16x32_bf16 v[68:71], v[88:91], v[50:53], v[68:71]
  v_mfma_f32_16x16x16_bf16 v[72:75], v[138:139], v[44:45], 0
  v_mfma_f32_16x16x16_bf16 v[76:79], v[138:139], v[48:49], 0
  v_mfma_f32_16x16x16_bf16 v[72:75], v[92:93], v[46:47], v[72:75]
  v_mfma_f32_16x16x32_bf16 v[76:79], v[92:95], v[50:53], v[76:79]
  s_nop 2
  v_mul_f32 v64, v64, v10
  v_mul_f32 v65, v65, v10
  v_mul_f32 v66, v66, v10
  v_mul_f32 v67, v67, v10
  v_cvt_pk_bf16_f32 v80, v64, v65
  v_cvt_pk_bf16_f32 v81, v66, v67
  v_mul_f32 v72, v72, v10
  v_mul_f32 v73, v73, v10
  v_mul_f32 v74, v74, v10
  v_mul_f32 v75, v75, v10
  v_cvt_pk_bf16_f32 v82, v72, v73
  v_cvt_pk_bf16_f32 v83, v74, v75
  ds_write_b128 v241, v[80:83] offset:0
  v_mul_f32 v68, v68, v11
  v_mul_f32 v69, v69, v11
  v_mul_f32 v70, v70, v11
  v_mul_f32 v71, v71, v11
  v_cvt_pk_bf16_f32 v84, v68, v69
  v_cvt_pk_bf16_f32 v85, v70, v71
  v_mul_f32 v76, v76, v11
  v_mul_f32 v77, v77, v11
  v_mul_f32 v78, v78, v11
  v_mul_f32 v79, v79, v11
  v_cvt_pk_bf16_f32 v86, v76, v77
  v_cvt_pk_bf16_f32 v87, v78, v79
  ds_write_b128 v241, v[84:87] offset:24576
  v_mfma_f32_16x16x16_bf16 v[64:67], v[140:141], v[44:45], 0
  v_mfma_f32_16x16x16_bf16 v[68:71], v[140:141], v[48:49], 0
  v_mfma_f32_16x16x16_bf16 v[64:67], v[96:97], v[46:47], v[64:67]
  v_mfma_f32_16x16x32_bf16 v[68:71], v[96:99], v[50:53], v[68:71]
  v_mfma_f32_16x16x16_bf16 v[72:75], v[142:143], v[44:45], 0
  v_mfma_f32_16x16x16_bf16 v[76:79], v[142:143], v[48:49], 0
  v_mfma_f32_16x16x16_bf16 v[72:75], v[100:101], v[46:47], v[72:75]
  v_mfma_f32_16x16x32_bf16 v[76:79], v[100:103], v[50:53], v[76:79]
  s_nop 2
  v_mul_f32 v64, v64, v10
  v_mul_f32 v65, v65, v10
  v_mul_f32 v66, v66, v10
  v_mul_f32 v67, v67, v10
  v_cvt_pk_bf16_f32 v80, v64, v65
  v_cvt_pk_bf16_f32 v81, v66, v67
  v_mul_f32 v72, v72, v10
  v_mul_f32 v73, v73, v10
  v_mul_f32 v74, v74, v10
  v_mul_f32 v75, v75, v10
  v_cvt_pk_bf16_f32 v82, v72, v73
  v_cvt_pk_bf16_f32 v83, v74, v75
  ds_write_b128 v241, v[80:83] offset:1024
  v_mul_f32 v68, v68, v11
  v_mul_f32 v69, v69, v11
  v_mul_f32 v70, v70, v11
  v_mul_f32 v71, v71, v11
  v_cvt_pk_bf16_f32 v84, v68, v69
  v_cvt_pk_bf16_f32 v85, v70, v71
  v_mul_f32 v76, v76, v11
  v_mul_f32 v77, v77, v11
  v_mul_f32 v78, v78, v11
  v_mul_f32 v79, v79, v11
  v_cvt_pk_bf16_f32 v86, v76, v77
  v_cvt_pk_bf16_f32 v87, v78, v79
  ds_write_b128 v241, v[84:87] offset:25600
  v_mfma_f32_16x16x16_bf16 v[64:67], v[144:145], v[44:45], 0
  v_mfma_f32_16x16x16_bf16 v[68:71], v[144:145], v[48:49], 0
  v_mfma_f32_16x16x16_bf16 v[64:67], v[104:105], v[46:47], v[64:67]
  v_mfma_f32_16x16x32_bf16 v[68:71], v[104:107], v[50:53], v[68:71]
  v_mfma_f32_16x16x16_bf16 v[72:75], v[146:147], v[44:45], 0
  v_mfma_f32_16x16x16_bf16 v[76:79], v[146:147], v[48:49], 0
  v_mfma_f32_16x16x16_bf16 v[72:75], v[108:109], v[46:47], v[72:75]
  v_mfma_f32_16x16x32_bf16 v[76:79], v[108:111], v[50:53], v[76:79]
  s_nop 2
  v_mul_f32 v64, v64, v10
  v_mul_f32 v65, v65, v10
  v_mul_f32 v66, v66, v10
  v_mul_f32 v67, v67, v10
  v_cvt_pk_bf16_f32 v80, v64, v65
  v_cvt_pk_bf16_f32 v81, v66, v67
  v_mul_f32 v72, v72, v10
  v_mul_f32 v73, v73, v10
  v_mul_f32 v74, v74, v10
  v_mul_f32 v75, v75, v10
  v_cvt_pk_bf16_f32 v82, v72, v73
  v_cvt_pk_bf16_f32 v83, v74, v75
  ds_write_b128 v241, v[80:83] offset:2048
  v_mul_f32 v68, v68, v11
  v_mul_f32 v69, v69, v11
  v_mul_f32 v70, v70, v11
  v_mul_f32 v71, v71, v11
  v_cvt_pk_bf16_f32 v84, v68, v69
  v_cvt_pk_bf16_f32 v85, v70, v71
  v_mul_f32 v76, v76, v11
  v_mul_f32 v77, v77, v11
  v_mul_f32 v78, v78, v11
  v_mul_f32 v79, v79, v11
  v_cvt_pk_bf16_f32 v86, v76, v77
  v_cvt_pk_bf16_f32 v87, v78, v79
  ds_write_b128 v241, v[84:87] offset:26624
  v_mfma_f32_16x16x16_bf16 v[64:67], v[148:149], v[44:45], 0
  v_mfma_f32_16x16x16_bf16 v[68:71], v[148:149], v[48:49], 0
  v_mfma_f32_16x16x16_bf16 v[64:67], v[112:113], v[46:47], v[64:67]
  v_mfma_f32_16x16x32_bf16 v[68:71], v[112:115], v[50:53], v[68:71]
  v_mfma_f32_16x16x16_bf16 v[72:75], v[150:151], v[44:45], 0
  v_mfma_f32_16x16x16_bf16 v[76:79], v[150:151], v[48:49], 0
  v_mfma_f32_16x16x16_bf16 v[72:75], v[116:117], v[46:47], v[72:75]
  v_mfma_f32_16x16x32_bf16 v[76:79], v[116:119], v[50:53], v[76:79]
  s_nop 2
  v_mul_f32 v64, v64, v10
  v_mul_f32 v65, v65, v10
  v_mul_f32 v66, v66, v10
  v_mul_f32 v67, v67, v10
  v_cvt_pk_bf16_f32 v80, v64, v65
  v_cvt_pk_bf16_f32 v81, v66, v67
  v_mul_f32 v72, v72, v10
  v_mul_f32 v73, v73, v10
  v_mul_f32 v74, v74, v10
  v_mul_f32 v75, v75, v10
  v_cvt_pk_bf16_f32 v82, v72, v73
  v_cvt_pk_bf16_f32 v83, v74, v75
  ds_write_b128 v241, v[80:83] offset:3072
  v_mul_f32 v68, v68, v11
  v_mul_f32 v69, v69, v11
  v_mul_f32 v70, v70, v11
  v_mul_f32 v71, v71, v11
  v_cvt_pk_bf16_f32 v84, v68, v69
  v_cvt_pk_bf16_f32 v85, v70, v71
  v_mul_f32 v76, v76, v11
  v_mul_f32 v77, v77, v11
  v_mul_f32 v78, v78, v11
  v_mul_f32 v79, v79, v11
  v_cvt_pk_bf16_f32 v86, v76, v77
  v_cvt_pk_bf16_f32 v87, v78, v79
  ds_write_b128 v241, v[84:87] offset:27648
  v_mfma_f32_16x16x16_bf16 v[64:67], v[152:153], v[44:45], 0
  v_mfma_f32_16x16x16_bf16 v[68:71], v[152:153], v[48:49], 0
  v_mfma_f32_16x16x16_bf16 v[64:67], v[120:121], v[46:47], v[64:67]
  v_mfma_f32_16x16x32_bf16 v[68:71], v[120:123], v[50:53], v[68:71]
  v_mfma_f32_16x16x16_bf16 v[72:75], v[154:155], v[44:45], 0
  v_mfma_f32_16x16x16_bf16 v[76:79], v[154:155], v[48:49], 0
  v_mfma_f32_16x16x16_bf16 v[72:75], v[124:125], v[46:47], v[72:75]
  v_mfma_f32_16x16x32_bf16 v[76:79], v[124:127], v[50:53], v[76:79]
  s_nop 2
  v_mul_f32 v64, v64, v10
  v_mul_f32 v65, v65, v10
  v_mul_f32 v66, v66, v10
  v_mul_f32 v67, v67, v10
  v_cvt_pk_bf16_f32 v80, v64, v65
  v_cvt_pk_bf16_f32 v81, v66, v67
  v_mul_f32 v72, v72, v10
  v_mul_f32 v73, v73, v10
  v_mul_f32 v74, v74, v10
  v_mul_f32 v75, v75, v10
  v_cvt_pk_bf16_f32 v82, v72, v73
  v_cvt_pk_bf16_f32 v83, v74, v75
  ds_write_b128 v241, v[80:83] offset:4096
  v_mul_f32 v68, v68, v11
  v_mul_f32 v69, v69, v11
  v_mul_f32 v70, v70, v11
  v_mul_f32 v71, v71, v11
  v_cvt_pk_bf16_f32 v84, v68, v69
  v_cvt_pk_bf16_f32 v85, v70, v71
  v_mul_f32 v76, v76, v11
  v_mul_f32 v77, v77, v11
  v_mul_f32 v78, v78, v11
  v_mul_f32 v79, v79, v11
  v_cvt_pk_bf16_f32 v86, v76, v77
  v_cvt_pk_bf16_f32 v87, v78, v79
  ds_write_b128 v241, v[84:87] offset:28672
  v_mfma_f32_16x16x16_bf16 v[64:67], v[156:157], v[44:45], 0
  v_mfma_f32_16x16x16_bf16 v[68:71], v[156:157], v[48:49], 0
  v_mfma_f32_16x16x16_bf16 v[64:67], v[128:129], v[46:47], v[64:67]
  v_mfma_f32_16x16x32_bf16 v[68:71], v[128:131], v[50:53], v[68:71]
  v_mfma_f32_16x16x16_bf16 v[72:75], v[158:159], v[44:45], 0
  v_mfma_f32_16x16x16_bf16 v[76:79], v[158:159], v[48:49], 0
  v_mfma_f32_16x16x16_bf16 v[72:75], v[132:133], v[46:47], v[72:75]
  v_mfma_f32_16x16x32_bf16 v[76:79], v[132:135], v[50:53], v[76:79]
  s_nop 2
  v_mul_f32 v64, v64, v10
  v_mul_f32 v65, v65, v10
  v_mul_f32 v66, v66, v10
  v_mul_f32 v67, v67, v10
  v_cvt_pk_bf16_f32 v80, v64, v65
  v_cvt_pk_bf16_f32 v81, v66, v67
  v_mul_f32 v72, v72, v10
  v_mul_f32 v73, v73, v10
  v_mul_f32 v74, v74, v10
  v_mul_f32 v75, v75, v10
  v_cvt_pk_bf16_f32 v82, v72, v73
  v_cvt_pk_bf16_f32 v83, v74, v75
  ds_write_b128 v241, v[80:83] offset:5120
  v_mul_f32 v68, v68, v11
  v_mul_f32 v69, v69, v11
  v_mul_f32 v70, v70, v11
  v_mul_f32 v71, v71, v11
  v_cvt_pk_bf16_f32 v84, v68, v69
  v_cvt_pk_bf16_f32 v85, v70, v71
  v_mul_f32 v76, v76, v11
  v_mul_f32 v77, v77, v11
  v_mul_f32 v78, v78, v11
  v_mul_f32 v79, v79, v11
  v_cvt_pk_bf16_f32 v86, v76, v77
  v_cvt_pk_bf16_f32 v87, v78, v79
  ds_write_b128 v241, v[84:87] offset:29696
  s_branch fin_phase22
fin_odma3:
  s_lshl_b32 s16, s14, 2
  s_add_u32 s16, s16, s12
  s_mul_i32 s16, s16, 192
  s_mul_i32 s17, s13, 24
  s_add_u32 s16, s16, s17
  s_lshl_b32 s16, s16, 10
  s_add_u32 s16, s16, 59768832
  s_mul_i32 s17, s12, 24576
  s_add_u32 m0, s17, 0
  s_nop 0
  buffer_load_dwordx4 v1, s[4:7], s16 offen offset:0 lds
  buffer_load_dwordx4 v1, s[4:7], s16 offen offset:1024 lds
  buffer_load_dwordx4 v1, s[4:7], s16 offen offset:2048 lds
  buffer_load_dwordx4 v1, s[4:7], s16 offen offset:3072 lds
  s_add_u32 s16, s16, 4096
  s_add_u32 m0, s17, 4096
  s_nop 0
  buffer_load_dwordx4 v1, s[4:7], s16 offen offset:0 lds
  buffer_load_dwordx4 v1, s[4:7], s16 offen offset:1024 lds
  buffer_load_dwordx4 v1, s[4:7], s16 offen offset:2048 lds
  buffer_load_dwordx4 v1, s[4:7], s16 offen offset:3072 lds
  s_add_u32 s16, s16, 4096
  s_add_u32 m0, s17, 8192
  s_nop 0
  buffer_load_dwordx4 v1, s[4:7], s16 offen offset:0 lds
  buffer_load_dwordx4 v1, s[4:7], s16 offen offset:1024 lds
  buffer_load_dwordx4 v1, s[4:7], s16 offen offset:2048 lds
  buffer_load_dwordx4 v1, s[4:7], s16 offen offset:3072 lds
  s_add_u32 s16, s16, 4096
  s_add_u32 m0, s17, 12288
  s_nop 0
  buffer_load_dwordx4 v1, s[4:7], s16 offen offset:0 lds
  buffer_load_dwordx4 v1, s[4:7], s16 offen offset:1024 lds
  buffer_load_dwordx4 v1, s[4:7], s16 offen offset:2048 lds
  buffer_load_dwordx4 v1, s[4:7], s16 offen offset:3072 lds
  s_add_u32 s16, s16, 4096
  s_add_u32 m0, s17, 16384
  s_nop 0
  buffer_load_dwordx4 v1, s[4:7], s16 offen offset:0 lds
  buffer_load_dwordx4 v1, s[4:7], s16 offen offset:1024 lds
  buffer_load_dwordx4 v1, s[4:7], s16 offen offset:2048 lds
  buffer_load_dwordx4 v1, s[4:7], s16 offen offset:3072 lds
  s_add_u32 s16, s16, 4096
  s_add_u32 m0, s17, 20480
  s_nop 0
  buffer_load_dwordx4 v1, s[4:7], s16 offen offset:0 lds
  buffer_load_dwordx4 v1, s[4:7], s16 offen offset:1024 lds
  buffer_load_dwordx4 v1, s[4:7], s16 offen offset:2048 lds
  buffer_load_dwordx4 v1, s[4:7], s16 offen offset:3072 lds
  s_add_u32 s16, s16, 4096
  buffer_load_dwordx4 a[160:163], v1, s[4:7], s30 offen offset:0
  buffer_load_dwordx4 a[164:167], v1, s[4:7], s31 offen offset:0
  buffer_load_dwordx4 a[168:171], v1, s[4:7], s32 offen offset:0
  buffer_load_dwordx4 a[172:175], v1, s[4:7], s33 offen offset:0
  buffer_load_dwordx4 a[176:179], v1, s[4:7], s34 offen offset:0
  buffer_load_dwordx4 a[180:183], v1, s[4:7], s35 offen offset:0
  buffer_load_dwordx4 a[184:187], v1, s[4:7], s36 offen offset:0
  buffer_load_dwordx4 a[188:191], v1, s[4:7], s37 offen offset:0
  buffer_load_dwordx4 a[192:195], v1, s[4:7], s38 offen offset:0
  buffer_load_dwordx4 a[196:199], v1, s[4:7], s39 offen offset:0
  buffer_load_dwordx4 a[200:203], v1, s[4:7], s30 offen offset:1024
  buffer_load_dwordx4 a[204:207], v1, s[4:7], s31 offen offset:1024
  buffer_load_dwordx4 a[208:211], v1, s[4:7], s32 offen offset:1024
  buffer_load_dwordx4 a[212:215], v1, s[4:7], s33 offen offset:1024
  buffer_load_dwordx4 a[216:219], v1, s[4:7], s34 offen offset:1024
  buffer_load_dwordx4 a[220:223], v1, s[4:7], s35 offen offset:1024
  buffer_load_dwordx4 a[224:227], v1, s[4:7], s36 offen offset:1024
  buffer_load_dwordx4 a[228:231], v1, s[4:7], s37 offen offset:1024
  buffer_load_dwordx4 a[232:235], v1, s[4:7], s38 offen offset:1024
  buffer_load_dwordx4 a[236:239], v1, s[4:7], s39 offen offset:1024
  s_waitcnt vmcnt(20)
fin_phase22:
  s_waitcnt lgkmcnt(0)
  buffer_load_dwordx4 v[104:107], v1, s[4:7], s30 offen offset:2048
  buffer_load_dwordx4 v[108:111], v1, s[4:7], s31 offen offset:2048
  buffer_load_dwordx4 v[112:115], v1, s[4:7], s32 offen offset:2048
  buffer_load_dwordx4 v[116:119], v1, s[4:7], s33 offen offset:2048
  buffer_load_dwordx4 v[120:123], v1, s[4:7], s34 offen offset:2048
  buffer_load_dwordx4 v[124:127], v1, s[4:7], s35 offen offset:2048
  buffer_load_dwordx4 v[128:131], v1, s[4:7], s36 offen offset:2048
  buffer_load_dwordx4 v[132:135], v1, s[4:7], s37 offen offset:2048
  buffer_load_dwordx4 v[136:139], v1, s[4:7], s38 offen offset:2048
  buffer_load_dwordx4 v[140:143], v1, s[4:7], s39 offen offset:2048
  buffer_load_dwordx4 v[144:147], v1, s[4:7], s30 offen offset:3072
  buffer_load_dwordx4 v[148:151], v1, s[4:7], s31 offen offset:3072
  buffer_load_dwordx4 v[152:155], v1, s[4:7], s32 offen offset:3072
  buffer_load_dwordx4 v[156:159], v1, s[4:7], s33 offen offset:3072
  buffer_load_dwordx4 v[160:163], v1, s[4:7], s34 offen offset:3072
  buffer_load_dwordx4 v[164:167], v1, s[4:7], s35 offen offset:3072
  buffer_load_dwordx4 v[168:171], v1, s[4:7], s36 offen offset:3072
  buffer_load_dwordx4 v[172:175], v1, s[4:7], s37 offen offset:3072
  buffer_load_dwordx4 v[176:179], v1, s[4:7], s38 offen offset:3072
  buffer_load_dwordx4 v[180:183], v1, s[4:7], s39 offen offset:3072
  s_add_u32 s30, s30, 4096
  s_add_u32 s31, s31, 4096
  s_add_u32 s32, s32, 4096
  s_add_u32 s33, s33, 4096
  s_add_u32 s34, s34, 4096
  s_add_u32 s35, s35, 4096
  s_add_u32 s36, s36, 4096
  s_add_u32 s37, s37, 4096
  s_add_u32 s38, s38, 4096
  s_add_u32 s39, s39, 4096
  v_add_u32 v6, 49152, v1
  s_barrier
  ds_read_b128 v[184:187], v1 offset:0
  ds_read_b128 v[188:191], v1 offset:24576
  ds_read_b128 v[192:195], v6 offset:0
  ds_read_b128 v[196:199], v6 offset:24576
  s_waitcnt vmcnt(30)
  ds_read_b128 v[200:203], v1 offset:1024
  ds_read_b128 v[204:207], v1 offset:25600
  ds_read_b128 v[208:211], v6 offset:1024
  ds_read_b128 v[212:215], v6 offset:25600
  s_waitcnt lgkmcnt(4)
  v_mfma_f32_16x16x32_bf16 a[0:3], a[160:163], v[184:187], 0
  v_mfma_f32_16x16x32_bf16 a[4:7], a[160:163], v[188:191], 0
  v_mfma_f32_16x16x32_bf16 a[8:11], a[160:163], v[192:195], 0
  v_mfma_f32_16x16x32_bf16 a[12:15], a[160:163], v[196:199], 0
  v_mfma_f32_16x16x32_bf16 a[16:19], a[164:167], v[184:187], 0
  v_mfma_f32_16x16x32_bf16 a[20:23], a[164:167], v[188:191], 0
  v_mfma_f32_16x16x32_bf16 a[24:27], a[164:167], v[192:195], 0
  v_mfma_f32_16x16x32_bf16 a[28:31], a[164:167], v[196:199], 0
  v_mfma_f32_16x16x32_bf16 a[32:35], a[168:171], v[184:187], 0
  v_mfma_f32_16x16x32_bf16 a[36:39], a[168:171], v[188:191], 0
  v_mfma_f32_16x16x32_bf16 a[40:43], a[168:171], v[192:195], 0
  v_mfma_f32_16x16x32_bf16 a[44:47], a[168:171], v[196:199], 0
  v_mfma_f32_16x16x32_bf16 a[48:51], a[172:175], v[184:187], 0
  v_mfma_f32_16x16x32_bf16 a[52:55], a[172:175], v[188:191], 0
  v_mfma_f32_16x16x32_bf16 a[56:59], a[172:175], v[192:195], 0
  v_mfma_f32_16x16x32_bf16 a[60:63], a[172:175], v[196:199], 0
  v_mfma_f32_16x16x32_bf16 a[64:67], a[176:179], v[184:187], 0
  v_mfma_f32_16x16x32_bf16 a[68:71], a[176:179], v[188:191], 0
  v_mfma_f32_16x16x32_bf16 a[72:75], a[176:179], v[192:195], 0
  v_mfma_f32_16x16x32_bf16 a[76:79], a[176:179], v[196:199], 0
  v_mfma_f32_16x16x32_bf16 a[80:83], a[180:183], v[184:187], 0
  v_mfma_f32_16x16x32_bf16 a[84:87], a[180:183], v[188:191], 0
  v_mfma_f32_16x16x32_bf16 a[88:91], a[180:183], v[192:195], 0
  v_mfma_f32_16x16x32_bf16 a[92:95], a[180:183], v[196:199], 0
  v_mfma_f32_16x16x32_bf16 a[96:99], a[184:187], v[184:187], 0
  v_mfma_f32_16x16x32_bf16 a[100:103], a[184:187], v[188:191], 0
  v_mfma_f32_16x16x32_bf16 a[104:107], a[184:187], v[192:195], 0
  v_mfma_f32_16x16x32_bf16 a[108:111], a[184:187], v[196:199], 0
  v_mfma_f32_16x16x32_bf16 a[112:115], a[188:191], v[184:187], 0
  v_mfma_f32_16x16x32_bf16 a[116:119], a[188:191], v[188:191], 0
  v_mfma_f32_16x16x32_bf16 a[120:123], a[188:191], v[192:195], 0
  v_mfma_f32_16x16x32_bf16 a[124:127], a[188:191], v[196:199], 0
  v_mfma_f32_16x16x32_bf16 a[128:131], a[192:195], v[184:187], 0
  v_mfma_f32_16x16x32_bf16 a[132:135], a[192:195], v[188:191], 0
  v_mfma_f32_16x16x32_bf16 a[136:139], a[192:195], v[192:195], 0
  v_mfma_f32_16x16x32_bf16 a[140:143], a[192:195], v[196:199], 0
  v_mfma_f32_16x16x32_bf16 a[144:147], a[196:199], v[184:187], 0
  v_mfma_f32_16x16x32_bf16 a[148:151], a[196:199], v[188:191], 0
  v_mfma_f32_16x16x32_bf16 a[152:155], a[196:199], v[192:195], 0
  v_mfma_f32_16x16x32_bf16 a[156:159], a[196:199], v[196:199], 0
  buffer_load_dwordx4 v[24:27], v1, s[4:7], s30 offen offset:0
  buffer_load_dwordx4 v[28:31], v1, s[4:7], s31 offen offset:0
  buffer_load_dwordx4 v[32:35], v1, s[4:7], s32 offen offset:0
  buffer_load_dwordx4 v[36:39], v1, s[4:7], s33 offen offset:0
  buffer_load_dwordx4 v[40:43], v1, s[4:7], s34 offen offset:0
  buffer_load_dwordx4 v[44:47], v1, s[4:7], s35 offen offset:0
  buffer_load_dwordx4 v[48:51], v1, s[4:7], s36 offen offset:0
  buffer_load_dwordx4 v[52:55], v1, s[4:7], s37 offen offset:0
  buffer_load_dwordx4 v[56:59], v1, s[4:7], s38 offen offset:0
  buffer_load_dwordx4 v[60:63], v1, s[4:7], s39 offen offset:0
  s_waitcnt vmcnt(30)
  ds_read_b128 v[184:187], v1 offset:2048
  ds_read_b128 v[188:191], v1 offset:26624
  ds_read_b128 v[192:195], v6 offset:2048
  ds_read_b128 v[196:199], v6 offset:26624
  s_waitcnt lgkmcnt(4)
  v_mfma_f32_16x16x32_bf16 a[0:3], a[200:203], v[200:203], a[0:3]
  v_mfma_f32_16x16x32_bf16 a[4:7], a[200:203], v[204:207], a[4:7]
  v_mfma_f32_16x16x32_bf16 a[8:11], a[200:203], v[208:211], a[8:11]
  v_mfma_f32_16x16x32_bf16 a[12:15], a[200:203], v[212:215], a[12:15]
  v_mfma_f32_16x16x32_bf16 a[16:19], a[204:207], v[200:203], a[16:19]
  v_mfma_f32_16x16x32_bf16 a[20:23], a[204:207], v[204:207], a[20:23]
  v_mfma_f32_16x16x32_bf16 a[24:27], a[204:207], v[208:211], a[24:27]
  v_mfma_f32_16x16x32_bf16 a[28:31], a[204:207], v[212:215], a[28:31]
  v_mfma_f32_16x16x32_bf16 a[32:35], a[208:211], v[200:203], a[32:35]
  v_mfma_f32_16x16x32_bf16 a[36:39], a[208:211], v[204:207], a[36:39]
  v_mfma_f32_16x16x32_bf16 a[40:43], a[208:211], v[208:211], a[40:43]
  v_mfma_f32_16x16x32_bf16 a[44:47], a[208:211], v[212:215], a[44:47]
  v_mfma_f32_16x16x32_bf16 a[48:51], a[212:215], v[200:203], a[48:51]
  v_mfma_f32_16x16x32_bf16 a[52:55], a[212:215], v[204:207], a[52:55]
  v_mfma_f32_16x16x32_bf16 a[56:59], a[212:215], v[208:211], a[56:59]
  v_mfma_f32_16x16x32_bf16 a[60:63], a[212:215], v[212:215], a[60:63]
  v_mfma_f32_16x16x32_bf16 a[64:67], a[216:219], v[200:203], a[64:67]
  v_mfma_f32_16x16x32_bf16 a[68:71], a[216:219], v[204:207], a[68:71]
  v_mfma_f32_16x16x32_bf16 a[72:75], a[216:219], v[208:211], a[72:75]
  v_mfma_f32_16x16x32_bf16 a[76:79], a[216:219], v[212:215], a[76:79]
  v_mfma_f32_16x16x32_bf16 a[80:83], a[220:223], v[200:203], a[80:83]
  v_mfma_f32_16x16x32_bf16 a[84:87], a[220:223], v[204:207], a[84:87]
  v_mfma_f32_16x16x32_bf16 a[88:91], a[220:223], v[208:211], a[88:91]
  v_mfma_f32_16x16x32_bf16 a[92:95], a[220:223], v[212:215], a[92:95]
  v_mfma_f32_16x16x32_bf16 a[96:99], a[224:227], v[200:203], a[96:99]
  v_mfma_f32_16x16x32_bf16 a[100:103], a[224:227], v[204:207], a[100:103]
  v_mfma_f32_16x16x32_bf16 a[104:107], a[224:227], v[208:211], a[104:107]
  v_mfma_f32_16x16x32_bf16 a[108:111], a[224:227], v[212:215], a[108:111]
  v_mfma_f32_16x16x32_bf16 a[112:115], a[228:231], v[200:203], a[112:115]
  v_mfma_f32_16x16x32_bf16 a[116:119], a[228:231], v[204:207], a[116:119]
  v_mfma_f32_16x16x32_bf16 a[120:123], a[228:231], v[208:211], a[120:123]
  v_mfma_f32_16x16x32_bf16 a[124:127], a[228:231], v[212:215], a[124:127]
  v_mfma_f32_16x16x32_bf16 a[128:131], a[232:235], v[200:203], a[128:131]
  v_mfma_f32_16x16x32_bf16 a[132:135], a[232:235], v[204:207], a[132:135]
  v_mfma_f32_16x16x32_bf16 a[136:139], a[232:235], v[208:211], a[136:139]
  v_mfma_f32_16x16x32_bf16 a[140:143], a[232:235], v[212:215], a[140:143]
  v_mfma_f32_16x16x32_bf16 a[144:147], a[236:239], v[200:203], a[144:147]
  v_mfma_f32_16x16x32_bf16 a[148:151], a[236:239], v[204:207], a[148:151]
  v_mfma_f32_16x16x32_bf16 a[152:155], a[236:239], v[208:211], a[152:155]
  v_mfma_f32_16x16x32_bf16 a[156:159], a[236:239], v[212:215], a[156:159]
  buffer_load_dwordx4 v[64:67], v1, s[4:7], s30 offen offset:1024
  buffer_load_dwordx4 v[68:71], v1, s[4:7], s31 offen offset:1024
  buffer_load_dwordx4 v[72:75], v1, s[4:7], s32 offen offset:1024
  buffer_load_dwordx4 v[76:79], v1, s[4:7], s33 offen offset:1024
  buffer_load_dwordx4 v[80:83], v1, s[4:7], s34 offen offset:1024
  buffer_load_dwordx4 v[84:87], v1, s[4:7], s35 offen offset:1024
  buffer_load_dwordx4 v[88:91], v1, s[4:7], s36 offen offset:1024
  buffer_load_dwordx4 v[92:95], v1, s[4:7], s37 offen offset:1024
  buffer_load_dwordx4 v[96:99], v1, s[4:7], s38 offen offset:1024
  buffer_load_dwordx4 v[100:103], v1, s[4:7], s39 offen offset:1024
  s_waitcnt vmcnt(30)
  ds_read_b128 v[200:203], v1 offset:3072
  ds_read_b128 v[204:207], v1 offset:27648
  ds_read_b128 v[208:211], v6 offset:3072
  ds_read_b128 v[212:215], v6 offset:27648
  s_waitcnt lgkmcnt(4)
  v_mfma_f32_16x16x32_bf16 a[0:3], v[104:107], v[184:187], a[0:3]
  v_mfma_f32_16x16x32_bf16 a[4:7], v[104:107], v[188:191], a[4:7]
  v_mfma_f32_16x16x32_bf16 a[8:11], v[104:107], v[192:195], a[8:11]
  v_mfma_f32_16x16x32_bf16 a[12:15], v[104:107], v[196:199], a[12:15]
  v_mfma_f32_16x16x32_bf16 a[16:19], v[108:111], v[184:187], a[16:19]
  v_mfma_f32_16x16x32_bf16 a[20:23], v[108:111], v[188:191], a[20:23]
  v_mfma_f32_16x16x32_bf16 a[24:27], v[108:111], v[192:195], a[24:27]
  v_mfma_f32_16x16x32_bf16 a[28:31], v[108:111], v[196:199], a[28:31]
  v_mfma_f32_16x16x32_bf16 a[32:35], v[112:115], v[184:187], a[32:35]
  v_mfma_f32_16x16x32_bf16 a[36:39], v[112:115], v[188:191], a[36:39]
  v_mfma_f32_16x16x32_bf16 a[40:43], v[112:115], v[192:195], a[40:43]
  v_mfma_f32_16x16x32_bf16 a[44:47], v[112:115], v[196:199], a[44:47]
  v_mfma_f32_16x16x32_bf16 a[48:51], v[116:119], v[184:187], a[48:51]
  v_mfma_f32_16x16x32_bf16 a[52:55], v[116:119], v[188:191], a[52:55]
  v_mfma_f32_16x16x32_bf16 a[56:59], v[116:119], v[192:195], a[56:59]
  v_mfma_f32_16x16x32_bf16 a[60:63], v[116:119], v[196:199], a[60:63]
  v_mfma_f32_16x16x32_bf16 a[64:67], v[120:123], v[184:187], a[64:67]
  v_mfma_f32_16x16x32_bf16 a[68:71], v[120:123], v[188:191], a[68:71]
  v_mfma_f32_16x16x32_bf16 a[72:75], v[120:123], v[192:195], a[72:75]
  v_mfma_f32_16x16x32_bf16 a[76:79], v[120:123], v[196:199], a[76:79]
  v_mfma_f32_16x16x32_bf16 a[80:83], v[124:127], v[184:187], a[80:83]
  v_mfma_f32_16x16x32_bf16 a[84:87], v[124:127], v[188:191], a[84:87]
  v_mfma_f32_16x16x32_bf16 a[88:91], v[124:127], v[192:195], a[88:91]
  v_mfma_f32_16x16x32_bf16 a[92:95], v[124:127], v[196:199], a[92:95]
  v_mfma_f32_16x16x32_bf16 a[96:99], v[128:131], v[184:187], a[96:99]
  v_mfma_f32_16x16x32_bf16 a[100:103], v[128:131], v[188:191], a[100:103]
  v_mfma_f32_16x16x32_bf16 a[104:107], v[128:131], v[192:195], a[104:107]
  v_mfma_f32_16x16x32_bf16 a[108:111], v[128:131], v[196:199], a[108:111]
  v_mfma_f32_16x16x32_bf16 a[112:115], v[132:135], v[184:187], a[112:115]
  v_mfma_f32_16x16x32_bf16 a[116:119], v[132:135], v[188:191], a[116:119]
  v_mfma_f32_16x16x32_bf16 a[120:123], v[132:135], v[192:195], a[120:123]
  v_mfma_f32_16x16x32_bf16 a[124:127], v[132:135], v[196:199], a[124:127]
  v_mfma_f32_16x16x32_bf16 a[128:131], v[136:139], v[184:187], a[128:131]
  v_mfma_f32_16x16x32_bf16 a[132:135], v[136:139], v[188:191], a[132:135]
  v_mfma_f32_16x16x32_bf16 a[136:139], v[136:139], v[192:195], a[136:139]
  v_mfma_f32_16x16x32_bf16 a[140:143], v[136:139], v[196:199], a[140:143]
  v_mfma_f32_16x16x32_bf16 a[144:147], v[140:143], v[184:187], a[144:147]
  v_mfma_f32_16x16x32_bf16 a[148:151], v[140:143], v[188:191], a[148:151]
  v_mfma_f32_16x16x32_bf16 a[152:155], v[140:143], v[192:195], a[152:155]
  v_mfma_f32_16x16x32_bf16 a[156:159], v[140:143], v[196:199], a[156:159]
  buffer_load_dwordx4 v[104:107], v1, s[4:7], s30 offen offset:2048
  buffer_load_dwordx4 v[108:111], v1, s[4:7], s31 offen offset:2048
  buffer_load_dwordx4 v[112:115], v1, s[4:7], s32 offen offset:2048
  buffer_load_dwordx4 v[116:119], v1, s[4:7], s33 offen offset:2048
  buffer_load_dwordx4 v[120:123], v1, s[4:7], s34 offen offset:2048
  buffer_load_dwordx4 v[124:127], v1, s[4:7], s35 offen offset:2048
  buffer_load_dwordx4 v[128:131], v1, s[4:7], s36 offen offset:2048
  buffer_load_dwordx4 v[132:135], v1, s[4:7], s37 offen offset:2048
  buffer_load_dwordx4 v[136:139], v1, s[4:7], s38 offen offset:2048
  buffer_load_dwordx4 v[140:143], v1, s[4:7], s39 offen offset:2048
  s_waitcnt vmcnt(30)
  ds_read_b128 v[184:187], v1 offset:4096
  ds_read_b128 v[188:191], v1 offset:28672
  ds_read_b128 v[192:195], v6 offset:4096
  ds_read_b128 v[196:199], v6 offset:28672
  s_waitcnt lgkmcnt(4)
  v_mfma_f32_16x16x32_bf16 a[0:3], v[144:147], v[200:203], a[0:3]
  v_mfma_f32_16x16x32_bf16 a[4:7], v[144:147], v[204:207], a[4:7]
  v_mfma_f32_16x16x32_bf16 a[8:11], v[144:147], v[208:211], a[8:11]
  v_mfma_f32_16x16x32_bf16 a[12:15], v[144:147], v[212:215], a[12:15]
  v_mfma_f32_16x16x32_bf16 a[16:19], v[148:151], v[200:203], a[16:19]
  v_mfma_f32_16x16x32_bf16 a[20:23], v[148:151], v[204:207], a[20:23]
  v_mfma_f32_16x16x32_bf16 a[24:27], v[148:151], v[208:211], a[24:27]
  v_mfma_f32_16x16x32_bf16 a[28:31], v[148:151], v[212:215], a[28:31]
  v_mfma_f32_16x16x32_bf16 a[32:35], v[152:155], v[200:203], a[32:35]
  v_mfma_f32_16x16x32_bf16 a[36:39], v[152:155], v[204:207], a[36:39]
  v_mfma_f32_16x16x32_bf16 a[40:43], v[152:155], v[208:211], a[40:43]
  v_mfma_f32_16x16x32_bf16 a[44:47], v[152:155], v[212:215], a[44:47]
  v_mfma_f32_16x16x32_bf16 a[48:51], v[156:159], v[200:203], a[48:51]
  v_mfma_f32_16x16x32_bf16 a[52:55], v[156:159], v[204:207], a[52:55]
  v_mfma_f32_16x16x32_bf16 a[56:59], v[156:159], v[208:211], a[56:59]
  v_mfma_f32_16x16x32_bf16 a[60:63], v[156:159], v[212:215], a[60:63]
  v_mfma_f32_16x16x32_bf16 a[64:67], v[160:163], v[200:203], a[64:67]
  v_mfma_f32_16x16x32_bf16 a[68:71], v[160:163], v[204:207], a[68:71]
  v_mfma_f32_16x16x32_bf16 a[72:75], v[160:163], v[208:211], a[72:75]
  v_mfma_f32_16x16x32_bf16 a[76:79], v[160:163], v[212:215], a[76:79]
  v_mfma_f32_16x16x32_bf16 a[80:83], v[164:167], v[200:203], a[80:83]
  v_mfma_f32_16x16x32_bf16 a[84:87], v[164:167], v[204:207], a[84:87]
  v_mfma_f32_16x16x32_bf16 a[88:91], v[164:167], v[208:211], a[88:91]
  v_mfma_f32_16x16x32_bf16 a[92:95], v[164:167], v[212:215], a[92:95]
  v_mfma_f32_16x16x32_bf16 a[96:99], v[168:171], v[200:203], a[96:99]
  v_mfma_f32_16x16x32_bf16 a[100:103], v[168:171], v[204:207], a[100:103]
  v_mfma_f32_16x16x32_bf16 a[104:107], v[168:171], v[208:211], a[104:107]
  v_mfma_f32_16x16x32_bf16 a[108:111], v[168:171], v[212:215], a[108:111]
  v_mfma_f32_16x16x32_bf16 a[112:115], v[172:175], v[200:203], a[112:115]
  v_mfma_f32_16x16x32_bf16 a[116:119], v[172:175], v[204:207], a[116:119]
  v_mfma_f32_16x16x32_bf16 a[120:123], v[172:175], v[208:211], a[120:123]
  v_mfma_f32_16x16x32_bf16 a[124:127], v[172:175], v[212:215], a[124:127]
  v_mfma_f32_16x16x32_bf16 a[128:131], v[176:179], v[200:203], a[128:131]
  v_mfma_f32_16x16x32_bf16 a[132:135], v[176:179], v[204:207], a[132:135]
  v_mfma_f32_16x16x32_bf16 a[136:139], v[176:179], v[208:211], a[136:139]
  v_mfma_f32_16x16x32_bf16 a[140:143], v[176:179], v[212:215], a[140:143]
  v_mfma_f32_16x16x32_bf16 a[144:147], v[180:183], v[200:203], a[144:147]
  v_mfma_f32_16x16x32_bf16 a[148:151], v[180:183], v[204:207], a[148:151]
  v_mfma_f32_16x16x32_bf16 a[152:155], v[180:183], v[208:211], a[152:155]
  v_mfma_f32_16x16x32_bf16 a[156:159], v[180:183], v[212:215], a[156:159]
  buffer_load_dwordx4 v[144:147], v1, s[4:7], s30 offen offset:3072
  buffer_load_dwordx4 v[148:151], v1, s[4:7], s31 offen offset:3072
  buffer_load_dwordx4 v[152:155], v1, s[4:7], s32 offen offset:3072
  buffer_load_dwordx4 v[156:159], v1, s[4:7], s33 offen offset:3072
  buffer_load_dwordx4 v[160:163], v1, s[4:7], s34 offen offset:3072
  buffer_load_dwordx4 v[164:167], v1, s[4:7], s35 offen offset:3072
  buffer_load_dwordx4 v[168:171], v1, s[4:7], s36 offen offset:3072
  buffer_load_dwordx4 v[172:175], v1, s[4:7], s37 offen offset:3072
  buffer_load_dwordx4 v[176:179], v1, s[4:7], s38 offen offset:3072
  buffer_load_dwordx4 v[180:183], v1, s[4:7], s39 offen offset:3072
  s_add_u32 s30, s30, 4096
  s_add_u32 s31, s31, 4096
  s_add_u32 s32, s32, 4096
  s_add_u32 s33, s33, 4096
  s_add_u32 s34, s34, 4096
  s_add_u32 s35, s35, 4096
  s_add_u32 s36, s36, 4096
  s_add_u32 s37, s37, 4096
  s_add_u32 s38, s38, 4096
  s_add_u32 s39, s39, 4096
  s_waitcnt vmcnt(30)
  ds_read_b128 v[200:203], v1 offset:5120
  ds_read_b128 v[204:207], v1 offset:29696
  ds_read_b128 v[208:211], v6 offset:5120
  ds_read_b128 v[212:215], v6 offset:29696
  s_waitcnt lgkmcnt(4)
  v_mfma_f32_16x16x32_bf16 a[0:3], v[24:27], v[184:187], a[0:3]
  v_mfma_f32_16x16x32_bf16 a[4:7], v[24:27], v[188:191], a[4:7]
  v_mfma_f32_16x16x32_bf16 a[8:11], v[24:27], v[192:195], a[8:11]
  v_mfma_f32_16x16x32_bf16 a[12:15], v[24:27], v[196:199], a[12:15]
  v_mfma_f32_16x16x32_bf16 a[16:19], v[28:31], v[184:187], a[16:19]
  v_mfma_f32_16x16x32_bf16 a[20:23], v[28:31], v[188:191], a[20:23]
  v_mfma_f32_16x16x32_bf16 a[24:27], v[28:31], v[192:195], a[24:27]
  v_mfma_f32_16x16x32_bf16 a[28:31], v[28:31], v[196:199], a[28:31]
  v_mfma_f32_16x16x32_bf16 a[32:35], v[32:35], v[184:187], a[32:35]
  v_mfma_f32_16x16x32_bf16 a[36:39], v[32:35], v[188:191], a[36:39]
  v_mfma_f32_16x16x32_bf16 a[40:43], v[32:35], v[192:195], a[40:43]
  v_mfma_f32_16x16x32_bf16 a[44:47], v[32:35], v[196:199], a[44:47]
  v_mfma_f32_16x16x32_bf16 a[48:51], v[36:39], v[184:187], a[48:51]
  v_mfma_f32_16x16x32_bf16 a[52:55], v[36:39], v[188:191], a[52:55]
  v_mfma_f32_16x16x32_bf16 a[56:59], v[36:39], v[192:195], a[56:59]
  v_mfma_f32_16x16x32_bf16 a[60:63], v[36:39], v[196:199], a[60:63]
  v_mfma_f32_16x16x32_bf16 a[64:67], v[40:43], v[184:187], a[64:67]
  v_mfma_f32_16x16x32_bf16 a[68:71], v[40:43], v[188:191], a[68:71]
  v_mfma_f32_16x16x32_bf16 a[72:75], v[40:43], v[192:195], a[72:75]
  v_mfma_f32_16x16x32_bf16 a[76:79], v[40:43], v[196:199], a[76:79]
  v_mfma_f32_16x16x32_bf16 a[80:83], v[44:47], v[184:187], a[80:83]
  v_mfma_f32_16x16x32_bf16 a[84:87], v[44:47], v[188:191], a[84:87]
  v_mfma_f32_16x16x32_bf16 a[88:91], v[44:47], v[192:195], a[88:91]
  v_mfma_f32_16x16x32_bf16 a[92:95], v[44:47], v[196:199], a[92:95]
  v_mfma_f32_16x16x32_bf16 a[96:99], v[48:51], v[184:187], a[96:99]
  v_mfma_f32_16x16x32_bf16 a[100:103], v[48:51], v[188:191], a[100:103]
  v_mfma_f32_16x16x32_bf16 a[104:107], v[48:51], v[192:195], a[104:107]
  v_mfma_f32_16x16x32_bf16 a[108:111], v[48:51], v[196:199], a[108:111]
  v_mfma_f32_16x16x32_bf16 a[112:115], v[52:55], v[184:187], a[112:115]
  v_mfma_f32_16x16x32_bf16 a[116:119], v[52:55], v[188:191], a[116:119]
  v_mfma_f32_16x16x32_bf16 a[120:123], v[52:55], v[192:195], a[120:123]
  v_mfma_f32_16x16x32_bf16 a[124:127], v[52:55], v[196:199], a[124:127]
  v_mfma_f32_16x16x32_bf16 a[128:131], v[56:59], v[184:187], a[128:131]
  v_mfma_f32_16x16x32_bf16 a[132:135], v[56:59], v[188:191], a[132:135]
  v_mfma_f32_16x16x32_bf16 a[136:139], v[56:59], v[192:195], a[136:139]
  v_mfma_f32_16x16x32_bf16 a[140:143], v[56:59], v[196:199], a[140:143]
  v_mfma_f32_16x16x32_bf16 a[144:147], v[60:63], v[184:187], a[144:147]
  v_mfma_f32_16x16x32_bf16 a[148:151], v[60:63], v[188:191], a[148:151]
  v_mfma_f32_16x16x32_bf16 a[152:155], v[60:63], v[192:195], a[152:155]
  v_mfma_f32_16x16x32_bf16 a[156:159], v[60:63], v[196:199], a[156:159]
  buffer_load_dwordx4 v[24:27], v1, s[4:7], s30 offen offset:0
  buffer_load_dwordx4 v[28:31], v1, s[4:7], s31 offen offset:0
  buffer_load_dwordx4 v[32:35], v1, s[4:7], s32 offen offset:0
  buffer_load_dwordx4 v[36:39], v1, s[4:7], s33 offen offset:0
  buffer_load_dwordx4 v[40:43], v1, s[4:7], s34 offen offset:0
  buffer_load_dwordx4 v[44:47], v1, s[4:7], s35 offen offset:0
  buffer_load_dwordx4 v[48:51], v1, s[4:7], s36 offen offset:0
  buffer_load_dwordx4 v[52:55], v1, s[4:7], s37 offen offset:0
  buffer_load_dwordx4 v[56:59], v1, s[4:7], s38 offen offset:0
  buffer_load_dwordx4 v[60:63], v1, s[4:7], s39 offen offset:0
  s_waitcnt vmcnt(30)
  ds_read_b128 v[184:187], v1 offset:6144
  ds_read_b128 v[188:191], v1 offset:30720
  ds_read_b128 v[192:195], v6 offset:6144
  ds_read_b128 v[196:199], v6 offset:30720
  s_waitcnt lgkmcnt(4)
  v_mfma_f32_16x16x32_bf16 a[0:3], v[64:67], v[200:203], a[0:3]
  v_mfma_f32_16x16x32_bf16 a[4:7], v[64:67], v[204:207], a[4:7]
  v_mfma_f32_16x16x32_bf16 a[8:11], v[64:67], v[208:211], a[8:11]
  v_mfma_f32_16x16x32_bf16 a[12:15], v[64:67], v[212:215], a[12:15]
  v_mfma_f32_16x16x32_bf16 a[16:19], v[68:71], v[200:203], a[16:19]
  v_mfma_f32_16x16x32_bf16 a[20:23], v[68:71], v[204:207], a[20:23]
  v_mfma_f32_16x16x32_bf16 a[24:27], v[68:71], v[208:211], a[24:27]
  v_mfma_f32_16x16x32_bf16 a[28:31], v[68:71], v[212:215], a[28:31]
  v_mfma_f32_16x16x32_bf16 a[32:35], v[72:75], v[200:203], a[32:35]
  v_mfma_f32_16x16x32_bf16 a[36:39], v[72:75], v[204:207], a[36:39]
  v_mfma_f32_16x16x32_bf16 a[40:43], v[72:75], v[208:211], a[40:43]
  v_mfma_f32_16x16x32_bf16 a[44:47], v[72:75], v[212:215], a[44:47]
  v_mfma_f32_16x16x32_bf16 a[48:51], v[76:79], v[200:203], a[48:51]
  v_mfma_f32_16x16x32_bf16 a[52:55], v[76:79], v[204:207], a[52:55]
  v_mfma_f32_16x16x32_bf16 a[56:59], v[76:79], v[208:211], a[56:59]
  v_mfma_f32_16x16x32_bf16 a[60:63], v[76:79], v[212:215], a[60:63]
  v_mfma_f32_16x16x32_bf16 a[64:67], v[80:83], v[200:203], a[64:67]
  v_mfma_f32_16x16x32_bf16 a[68:71], v[80:83], v[204:207], a[68:71]
  v_mfma_f32_16x16x32_bf16 a[72:75], v[80:83], v[208:211], a[72:75]
  v_mfma_f32_16x16x32_bf16 a[76:79], v[80:83], v[212:215], a[76:79]
  v_mfma_f32_16x16x32_bf16 a[80:83], v[84:87], v[200:203], a[80:83]
  v_mfma_f32_16x16x32_bf16 a[84:87], v[84:87], v[204:207], a[84:87]
  v_mfma_f32_16x16x32_bf16 a[88:91], v[84:87], v[208:211], a[88:91]
  v_mfma_f32_16x16x32_bf16 a[92:95], v[84:87], v[212:215], a[92:95]
  v_mfma_f32_16x16x32_bf16 a[96:99], v[88:91], v[200:203], a[96:99]
  v_mfma_f32_16x16x32_bf16 a[100:103], v[88:91], v[204:207], a[100:103]
  v_mfma_f32_16x16x32_bf16 a[104:107], v[88:91], v[208:211], a[104:107]
  v_mfma_f32_16x16x32_bf16 a[108:111], v[88:91], v[212:215], a[108:111]
  v_mfma_f32_16x16x32_bf16 a[112:115], v[92:95], v[200:203], a[112:115]
  v_mfma_f32_16x16x32_bf16 a[116:119], v[92:95], v[204:207], a[116:119]
  v_mfma_f32_16x16x32_bf16 a[120:123], v[92:95], v[208:211], a[120:123]
  v_mfma_f32_16x16x32_bf16 a[124:127], v[92:95], v[212:215], a[124:127]
  v_mfma_f32_16x16x32_bf16 a[128:131], v[96:99], v[200:203], a[128:131]
  v_mfma_f32_16x16x32_bf16 a[132:135], v[96:99], v[204:207], a[132:135]
  v_mfma_f32_16x16x32_bf16 a[136:139], v[96:99], v[208:211], a[136:139]
  v_mfma_f32_16x16x32_bf16 a[140:143], v[96:99], v[212:215], a[140:143]
  v_mfma_f32_16x16x32_bf16 a[144:147], v[100:103], v[200:203], a[144:147]
  v_mfma_f32_16x16x32_bf16 a[148:151], v[100:103], v[204:207], a[148:151]
  v_mfma_f32_16x16x32_bf16 a[152:155], v[100:103], v[208:211], a[152:155]
  v_mfma_f32_16x16x32_bf16 a[156:159], v[100:103], v[212:215], a[156:159]
  buffer_load_dwordx4 v[64:67], v1, s[4:7], s30 offen offset:1024
  buffer_load_dwordx4 v[68:71], v1, s[4:7], s31 offen offset:1024
  buffer_load_dwordx4 v[72:75], v1, s[4:7], s32 offen offset:1024
  buffer_load_dwordx4 v[76:79], v1, s[4:7], s33 offen offset:1024
  buffer_load_dwordx4 v[80:83], v1, s[4:7], s34 offen offset:1024
  buffer_load_dwordx4 v[84:87], v1, s[4:7], s35 offen offset:1024
  buffer_load_dwordx4 v[88:91], v1, s[4:7], s36 offen offset:1024
  buffer_load_dwordx4 v[92:95], v1, s[4:7], s37 offen offset:1024
  buffer_load_dwordx4 v[96:99], v1, s[4:7], s38 offen offset:1024
  buffer_load_dwordx4 v[100:103], v1, s[4:7], s39 offen offset:1024
  s_waitcnt vmcnt(30)
  ds_read_b128 v[200:203], v1 offset:7168
  ds_read_b128 v[204:207], v1 offset:31744
  ds_read_b128 v[208:211], v6 offset:7168
  ds_read_b128 v[212:215], v6 offset:31744
  s_waitcnt lgkmcnt(4)
  v_mfma_f32_16x16x32_bf16 a[0:3], v[104:107], v[184:187], a[0:3]
  v_mfma_f32_16x16x32_bf16 a[4:7], v[104:107], v[188:191], a[4:7]
  v_mfma_f32_16x16x32_bf16 a[8:11], v[104:107], v[192:195], a[8:11]
  v_mfma_f32_16x16x32_bf16 a[12:15], v[104:107], v[196:199], a[12:15]
  v_mfma_f32_16x16x32_bf16 a[16:19], v[108:111], v[184:187], a[16:19]
  v_mfma_f32_16x16x32_bf16 a[20:23], v[108:111], v[188:191], a[20:23]
  v_mfma_f32_16x16x32_bf16 a[24:27], v[108:111], v[192:195], a[24:27]
  v_mfma_f32_16x16x32_bf16 a[28:31], v[108:111], v[196:199], a[28:31]
  v_mfma_f32_16x16x32_bf16 a[32:35], v[112:115], v[184:187], a[32:35]
  v_mfma_f32_16x16x32_bf16 a[36:39], v[112:115], v[188:191], a[36:39]
  v_mfma_f32_16x16x32_bf16 a[40:43], v[112:115], v[192:195], a[40:43]
  v_mfma_f32_16x16x32_bf16 a[44:47], v[112:115], v[196:199], a[44:47]
  v_mfma_f32_16x16x32_bf16 a[48:51], v[116:119], v[184:187], a[48:51]
  v_mfma_f32_16x16x32_bf16 a[52:55], v[116:119], v[188:191], a[52:55]
  v_mfma_f32_16x16x32_bf16 a[56:59], v[116:119], v[192:195], a[56:59]
  v_mfma_f32_16x16x32_bf16 a[60:63], v[116:119], v[196:199], a[60:63]
  v_mfma_f32_16x16x32_bf16 a[64:67], v[120:123], v[184:187], a[64:67]
  v_mfma_f32_16x16x32_bf16 a[68:71], v[120:123], v[188:191], a[68:71]
  v_mfma_f32_16x16x32_bf16 a[72:75], v[120:123], v[192:195], a[72:75]
  v_mfma_f32_16x16x32_bf16 a[76:79], v[120:123], v[196:199], a[76:79]
  v_mfma_f32_16x16x32_bf16 a[80:83], v[124:127], v[184:187], a[80:83]
  v_mfma_f32_16x16x32_bf16 a[84:87], v[124:127], v[188:191], a[84:87]
  v_mfma_f32_16x16x32_bf16 a[88:91], v[124:127], v[192:195], a[88:91]
  v_mfma_f32_16x16x32_bf16 a[92:95], v[124:127], v[196:199], a[92:95]
  v_mfma_f32_16x16x32_bf16 a[96:99], v[128:131], v[184:187], a[96:99]
  v_mfma_f32_16x16x32_bf16 a[100:103], v[128:131], v[188:191], a[100:103]
  v_mfma_f32_16x16x32_bf16 a[104:107], v[128:131], v[192:195], a[104:107]
  v_mfma_f32_16x16x32_bf16 a[108:111], v[128:131], v[196:199], a[108:111]
  v_mfma_f32_16x16x32_bf16 a[112:115], v[132:135], v[184:187], a[112:115]
  v_mfma_f32_16x16x32_bf16 a[116:119], v[132:135], v[188:191], a[116:119]
  v_mfma_f32_16x16x32_bf16 a[120:123], v[132:135], v[192:195], a[120:123]
  v_mfma_f32_16x16x32_bf16 a[124:127], v[132:135], v[196:199], a[124:127]
  v_mfma_f32_16x16x32_bf16 a[128:131], v[136:139], v[184:187], a[128:131]
  v_mfma_f32_16x16x32_bf16 a[132:135], v[136:139], v[188:191], a[132:135]
  v_mfma_f32_16x16x32_bf16 a[136:139], v[136:139], v[192:195], a[136:139]
  v_mfma_f32_16x16x32_bf16 a[140:143], v[136:139], v[196:199], a[140:143]
  v_mfma_f32_16x16x32_bf16 a[144:147], v[140:143], v[184:187], a[144:147]
  v_mfma_f32_16x16x32_bf16 a[148:151], v[140:143], v[188:191], a[148:151]
  v_mfma_f32_16x16x32_bf16 a[152:155], v[140:143], v[192:195], a[152:155]
  v_mfma_f32_16x16x32_bf16 a[156:159], v[140:143], v[196:199], a[156:159]
  buffer_load_dwordx4 v[104:107], v1, s[4:7], s30 offen offset:2048
  buffer_load_dwordx4 v[108:111], v1, s[4:7], s31 offen offset:2048
  buffer_load_dwordx4 v[112:115], v1, s[4:7], s32 offen offset:2048
  buffer_load_dwordx4 v[116:119], v1, s[4:7], s33 offen offset:2048
  buffer_load_dwordx4 v[120:123], v1, s[4:7], s34 offen offset:2048
  buffer_load_dwordx4 v[124:127], v1, s[4:7], s35 offen offset:2048
  buffer_load_dwordx4 v[128:131], v1, s[4:7], s36 offen offset:2048
  buffer_load_dwordx4 v[132:135], v1, s[4:7], s37 offen offset:2048
  buffer_load_dwordx4 v[136:139], v1, s[4:7], s38 offen offset:2048
  buffer_load_dwordx4 v[140:143], v1, s[4:7], s39 offen offset:2048
  s_waitcnt vmcnt(30)
  ds_read_b128 v[184:187], v1 offset:8192
  ds_read_b128 v[188:191], v1 offset:32768
  ds_read_b128 v[192:195], v6 offset:8192
  ds_read_b128 v[196:199], v6 offset:32768
  s_waitcnt lgkmcnt(4)
  v_mfma_f32_16x16x32_bf16 a[0:3], v[144:147], v[200:203], a[0:3]
  v_mfma_f32_16x16x32_bf16 a[4:7], v[144:147], v[204:207], a[4:7]
  v_mfma_f32_16x16x32_bf16 a[8:11], v[144:147], v[208:211], a[8:11]
  v_mfma_f32_16x16x32_bf16 a[12:15], v[144:147], v[212:215], a[12:15]
  v_mfma_f32_16x16x32_bf16 a[16:19], v[148:151], v[200:203], a[16:19]
  v_mfma_f32_16x16x32_bf16 a[20:23], v[148:151], v[204:207], a[20:23]
  v_mfma_f32_16x16x32_bf16 a[24:27], v[148:151], v[208:211], a[24:27]
  v_mfma_f32_16x16x32_bf16 a[28:31], v[148:151], v[212:215], a[28:31]
  v_mfma_f32_16x16x32_bf16 a[32:35], v[152:155], v[200:203], a[32:35]
  v_mfma_f32_16x16x32_bf16 a[36:39], v[152:155], v[204:207], a[36:39]
  v_mfma_f32_16x16x32_bf16 a[40:43], v[152:155], v[208:211], a[40:43]
  v_mfma_f32_16x16x32_bf16 a[44:47], v[152:155], v[212:215], a[44:47]
  v_mfma_f32_16x16x32_bf16 a[48:51], v[156:159], v[200:203], a[48:51]
  v_mfma_f32_16x16x32_bf16 a[52:55], v[156:159], v[204:207], a[52:55]
  v_mfma_f32_16x16x32_bf16 a[56:59], v[156:159], v[208:211], a[56:59]
  v_mfma_f32_16x16x32_bf16 a[60:63], v[156:159], v[212:215], a[60:63]
  v_mfma_f32_16x16x32_bf16 a[64:67], v[160:163], v[200:203], a[64:67]
  v_mfma_f32_16x16x32_bf16 a[68:71], v[160:163], v[204:207], a[68:71]
  v_mfma_f32_16x16x32_bf16 a[72:75], v[160:163], v[208:211], a[72:75]
  v_mfma_f32_16x16x32_bf16 a[76:79], v[160:163], v[212:215], a[76:79]
  v_mfma_f32_16x16x32_bf16 a[80:83], v[164:167], v[200:203], a[80:83]
  v_mfma_f32_16x16x32_bf16 a[84:87], v[164:167], v[204:207], a[84:87]
  v_mfma_f32_16x16x32_bf16 a[88:91], v[164:167], v[208:211], a[88:91]
  v_mfma_f32_16x16x32_bf16 a[92:95], v[164:167], v[212:215], a[92:95]
  v_mfma_f32_16x16x32_bf16 a[96:99], v[168:171], v[200:203], a[96:99]
  v_mfma_f32_16x16x32_bf16 a[100:103], v[168:171], v[204:207], a[100:103]
  v_mfma_f32_16x16x32_bf16 a[104:107], v[168:171], v[208:211], a[104:107]
  v_mfma_f32_16x16x32_bf16 a[108:111], v[168:171], v[212:215], a[108:111]
  v_mfma_f32_16x16x32_bf16 a[112:115], v[172:175], v[200:203], a[112:115]
  v_mfma_f32_16x16x32_bf16 a[116:119], v[172:175], v[204:207], a[116:119]
  v_mfma_f32_16x16x32_bf16 a[120:123], v[172:175], v[208:211], a[120:123]
  v_mfma_f32_16x16x32_bf16 a[124:127], v[172:175], v[212:215], a[124:127]
  v_mfma_f32_16x16x32_bf16 a[128:131], v[176:179], v[200:203], a[128:131]
  v_mfma_f32_16x16x32_bf16 a[132:135], v[176:179], v[204:207], a[132:135]
  v_mfma_f32_16x16x32_bf16 a[136:139], v[176:179], v[208:211], a[136:139]
  v_mfma_f32_16x16x32_bf16 a[140:143], v[176:179], v[212:215], a[140:143]
  v_mfma_f32_16x16x32_bf16 a[144:147], v[180:183], v[200:203], a[144:147]
  v_mfma_f32_16x16x32_bf16 a[148:151], v[180:183], v[204:207], a[148:151]
  v_mfma_f32_16x16x32_bf16 a[152:155], v[180:183], v[208:211], a[152:155]
  v_mfma_f32_16x16x32_bf16 a[156:159], v[180:183], v[212:215], a[156:159]
  buffer_load_dwordx4 v[144:147], v1, s[4:7], s30 offen offset:3072
  buffer_load_dwordx4 v[148:151], v1, s[4:7], s31 offen offset:3072
  buffer_load_dwordx4 v[152:155], v1, s[4:7], s32 offen offset:3072
  buffer_load_dwordx4 v[156:159], v1, s[4:7], s33 offen offset:3072
  buffer_load_dwordx4 v[160:163], v1, s[4:7], s34 offen offset:3072
  buffer_load_dwordx4 v[164:167], v1, s[4:7], s35 offen offset:3072
  buffer_load_dwordx4 v[168:171], v1, s[4:7], s36 offen offset:3072
  buffer_load_dwordx4 v[172:175], v1, s[4:7], s37 offen offset:3072
  buffer_load_dwordx4 v[176:179], v1, s[4:7], s38 offen offset:3072
  buffer_load_dwordx4 v[180:183], v1, s[4:7], s39 offen offset:3072
  s_add_u32 s30, s30, 4096
  s_add_u32 s31, s31, 4096
  s_add_u32 s32, s32, 4096
  s_add_u32 s33, s33, 4096
  s_add_u32 s34, s34, 4096
  s_add_u32 s35, s35, 4096
  s_add_u32 s36, s36, 4096
  s_add_u32 s37, s37, 4096
  s_add_u32 s38, s38, 4096
  s_add_u32 s39, s39, 4096
  s_waitcnt vmcnt(30)
  ds_read_b128 v[200:203], v1 offset:9216
  ds_read_b128 v[204:207], v1 offset:33792
  ds_read_b128 v[208:211], v6 offset:9216
  ds_read_b128 v[212:215], v6 offset:33792
  s_waitcnt lgkmcnt(4)
  v_mfma_f32_16x16x32_bf16 a[0:3], v[24:27], v[184:187], a[0:3]
  v_mfma_f32_16x16x32_bf16 a[4:7], v[24:27], v[188:191], a[4:7]
  v_mfma_f32_16x16x32_bf16 a[8:11], v[24:27], v[192:195], a[8:11]
  v_mfma_f32_16x16x32_bf16 a[12:15], v[24:27], v[196:199], a[12:15]
  v_mfma_f32_16x16x32_bf16 a[16:19], v[28:31], v[184:187], a[16:19]
  v_mfma_f32_16x16x32_bf16 a[20:23], v[28:31], v[188:191], a[20:23]
  v_mfma_f32_16x16x32_bf16 a[24:27], v[28:31], v[192:195], a[24:27]
  v_mfma_f32_16x16x32_bf16 a[28:31], v[28:31], v[196:199], a[28:31]
  v_mfma_f32_16x16x32_bf16 a[32:35], v[32:35], v[184:187], a[32:35]
  v_mfma_f32_16x16x32_bf16 a[36:39], v[32:35], v[188:191], a[36:39]
  v_mfma_f32_16x16x32_bf16 a[40:43], v[32:35], v[192:195], a[40:43]
  v_mfma_f32_16x16x32_bf16 a[44:47], v[32:35], v[196:199], a[44:47]
  v_mfma_f32_16x16x32_bf16 a[48:51], v[36:39], v[184:187], a[48:51]
  v_mfma_f32_16x16x32_bf16 a[52:55], v[36:39], v[188:191], a[52:55]
  v_mfma_f32_16x16x32_bf16 a[56:59], v[36:39], v[192:195], a[56:59]
  v_mfma_f32_16x16x32_bf16 a[60:63], v[36:39], v[196:199], a[60:63]
  v_mfma_f32_16x16x32_bf16 a[64:67], v[40:43], v[184:187], a[64:67]
  v_mfma_f32_16x16x32_bf16 a[68:71], v[40:43], v[188:191], a[68:71]
  v_mfma_f32_16x16x32_bf16 a[72:75], v[40:43], v[192:195], a[72:75]
  v_mfma_f32_16x16x32_bf16 a[76:79], v[40:43], v[196:199], a[76:79]
  v_mfma_f32_16x16x32_bf16 a[80:83], v[44:47], v[184:187], a[80:83]
  v_mfma_f32_16x16x32_bf16 a[84:87], v[44:47], v[188:191], a[84:87]
  v_mfma_f32_16x16x32_bf16 a[88:91], v[44:47], v[192:195], a[88:91]
  v_mfma_f32_16x16x32_bf16 a[92:95], v[44:47], v[196:199], a[92:95]
  v_mfma_f32_16x16x32_bf16 a[96:99], v[48:51], v[184:187], a[96:99]
  v_mfma_f32_16x16x32_bf16 a[100:103], v[48:51], v[188:191], a[100:103]
  v_mfma_f32_16x16x32_bf16 a[104:107], v[48:51], v[192:195], a[104:107]
  v_mfma_f32_16x16x32_bf16 a[108:111], v[48:51], v[196:199], a[108:111]
  v_mfma_f32_16x16x32_bf16 a[112:115], v[52:55], v[184:187], a[112:115]
  v_mfma_f32_16x16x32_bf16 a[116:119], v[52:55], v[188:191], a[116:119]
  v_mfma_f32_16x16x32_bf16 a[120:123], v[52:55], v[192:195], a[120:123]
  v_mfma_f32_16x16x32_bf16 a[124:127], v[52:55], v[196:199], a[124:127]
  v_mfma_f32_16x16x32_bf16 a[128:131], v[56:59], v[184:187], a[128:131]
  v_mfma_f32_16x16x32_bf16 a[132:135], v[56:59], v[188:191], a[132:135]
  v_mfma_f32_16x16x32_bf16 a[136:139], v[56:59], v[192:195], a[136:139]
  v_mfma_f32_16x16x32_bf16 a[140:143], v[56:59], v[196:199], a[140:143]
  v_mfma_f32_16x16x32_bf16 a[144:147], v[60:63], v[184:187], a[144:147]
  v_mfma_f32_16x16x32_bf16 a[148:151], v[60:63], v[188:191], a[148:151]
  v_mfma_f32_16x16x32_bf16 a[152:155], v[60:63], v[192:195], a[152:155]
  v_mfma_f32_16x16x32_bf16 a[156:159], v[60:63], v[196:199], a[156:159]
  buffer_load_dwordx4 v[24:27], v1, s[4:7], s30 offen offset:0
  buffer_load_dwordx4 v[28:31], v1, s[4:7], s31 offen offset:0
  buffer_load_dwordx4 v[32:35], v1, s[4:7], s32 offen offset:0
  buffer_load_dwordx4 v[36:39], v1, s[4:7], s33 offen offset:0
  buffer_load_dwordx4 v[40:43], v1, s[4:7], s34 offen offset:0
  buffer_load_dwordx4 v[44:47], v1, s[4:7], s35 offen offset:0
  buffer_load_dwordx4 v[48:51], v1, s[4:7], s36 offen offset:0
  buffer_load_dwordx4 v[52:55], v1, s[4:7], s37 offen offset:0
  buffer_load_dwordx4 v[56:59], v1, s[4:7], s38 offen offset:0
  buffer_load_dwordx4 v[60:63], v1, s[4:7], s39 offen offset:0
  s_waitcnt vmcnt(30)
  ds_read_b128 v[184:187], v1 offset:10240
  ds_read_b128 v[188:191], v1 offset:34816
  ds_read_b128 v[192:195], v6 offset:10240
  ds_read_b128 v[196:199], v6 offset:34816
  s_waitcnt lgkmcnt(4)
  v_mfma_f32_16x16x32_bf16 a[0:3], v[64:67], v[200:203], a[0:3]
  v_mfma_f32_16x16x32_bf16 a[4:7], v[64:67], v[204:207], a[4:7]
  v_mfma_f32_16x16x32_bf16 a[8:11], v[64:67], v[208:211], a[8:11]
  v_mfma_f32_16x16x32_bf16 a[12:15], v[64:67], v[212:215], a[12:15]
  v_mfma_f32_16x16x32_bf16 a[16:19], v[68:71], v[200:203], a[16:19]
  v_mfma_f32_16x16x32_bf16 a[20:23], v[68:71], v[204:207], a[20:23]
  v_mfma_f32_16x16x32_bf16 a[24:27], v[68:71], v[208:211], a[24:27]
  v_mfma_f32_16x16x32_bf16 a[28:31], v[68:71], v[212:215], a[28:31]
  v_mfma_f32_16x16x32_bf16 a[32:35], v[72:75], v[200:203], a[32:35]
  v_mfma_f32_16x16x32_bf16 a[36:39], v[72:75], v[204:207], a[36:39]
  v_mfma_f32_16x16x32_bf16 a[40:43], v[72:75], v[208:211], a[40:43]
  v_mfma_f32_16x16x32_bf16 a[44:47], v[72:75], v[212:215], a[44:47]
  v_mfma_f32_16x16x32_bf16 a[48:51], v[76:79], v[200:203], a[48:51]
  v_mfma_f32_16x16x32_bf16 a[52:55], v[76:79], v[204:207], a[52:55]
  v_mfma_f32_16x16x32_bf16 a[56:59], v[76:79], v[208:211], a[56:59]
  v_mfma_f32_16x16x32_bf16 a[60:63], v[76:79], v[212:215], a[60:63]
  v_mfma_f32_16x16x32_bf16 a[64:67], v[80:83], v[200:203], a[64:67]
  v_mfma_f32_16x16x32_bf16 a[68:71], v[80:83], v[204:207], a[68:71]
  v_mfma_f32_16x16x32_bf16 a[72:75], v[80:83], v[208:211], a[72:75]
  v_mfma_f32_16x16x32_bf16 a[76:79], v[80:83], v[212:215], a[76:79]
  v_mfma_f32_16x16x32_bf16 a[80:83], v[84:87], v[200:203], a[80:83]
  v_mfma_f32_16x16x32_bf16 a[84:87], v[84:87], v[204:207], a[84:87]
  v_mfma_f32_16x16x32_bf16 a[88:91], v[84:87], v[208:211], a[88:91]
  v_mfma_f32_16x16x32_bf16 a[92:95], v[84:87], v[212:215], a[92:95]
  v_mfma_f32_16x16x32_bf16 a[96:99], v[88:91], v[200:203], a[96:99]
  v_mfma_f32_16x16x32_bf16 a[100:103], v[88:91], v[204:207], a[100:103]
  v_mfma_f32_16x16x32_bf16 a[104:107], v[88:91], v[208:211], a[104:107]
  v_mfma_f32_16x16x32_bf16 a[108:111], v[88:91], v[212:215], a[108:111]
  v_mfma_f32_16x16x32_bf16 a[112:115], v[92:95], v[200:203], a[112:115]
  v_mfma_f32_16x16x32_bf16 a[116:119], v[92:95], v[204:207], a[116:119]
  v_mfma_f32_16x16x32_bf16 a[120:123], v[92:95], v[208:211], a[120:123]
  v_mfma_f32_16x16x32_bf16 a[124:127], v[92:95], v[212:215], a[124:127]
  v_mfma_f32_16x16x32_bf16 a[128:131], v[96:99], v[200:203], a[128:131]
  v_mfma_f32_16x16x32_bf16 a[132:135], v[96:99], v[204:207], a[132:135]
  v_mfma_f32_16x16x32_bf16 a[136:139], v[96:99], v[208:211], a[136:139]
  v_mfma_f32_16x16x32_bf16 a[140:143], v[96:99], v[212:215], a[140:143]
  v_mfma_f32_16x16x32_bf16 a[144:147], v[100:103], v[200:203], a[144:147]
  v_mfma_f32_16x16x32_bf16 a[148:151], v[100:103], v[204:207], a[148:151]
  v_mfma_f32_16x16x32_bf16 a[152:155], v[100:103], v[208:211], a[152:155]
  v_mfma_f32_16x16x32_bf16 a[156:159], v[100:103], v[212:215], a[156:159]
  buffer_load_dwordx4 v[64:67], v1, s[4:7], s30 offen offset:1024
  buffer_load_dwordx4 v[68:71], v1, s[4:7], s31 offen offset:1024
  buffer_load_dwordx4 v[72:75], v1, s[4:7], s32 offen offset:1024
  buffer_load_dwordx4 v[76:79], v1, s[4:7], s33 offen offset:1024
  buffer_load_dwordx4 v[80:83], v1, s[4:7], s34 offen offset:1024
  buffer_load_dwordx4 v[84:87], v1, s[4:7], s35 offen offset:1024
  buffer_load_dwordx4 v[88:91], v1, s[4:7], s36 offen offset:1024
  buffer_load_dwordx4 v[92:95], v1, s[4:7], s37 offen offset:1024
  buffer_load_dwordx4 v[96:99], v1, s[4:7], s38 offen offset:1024
  buffer_load_dwordx4 v[100:103], v1, s[4:7], s39 offen offset:1024
  s_waitcnt vmcnt(30)
  ds_read_b128 v[200:203], v1 offset:11264
  ds_read_b128 v[204:207], v1 offset:35840
  ds_read_b128 v[208:211], v6 offset:11264
  ds_read_b128 v[212:215], v6 offset:35840
  s_waitcnt lgkmcnt(4)
  v_mfma_f32_16x16x32_bf16 a[0:3], v[104:107], v[184:187], a[0:3]
  v_mfma_f32_16x16x32_bf16 a[4:7], v[104:107], v[188:191], a[4:7]
  v_mfma_f32_16x16x32_bf16 a[8:11], v[104:107], v[192:195], a[8:11]
  v_mfma_f32_16x16x32_bf16 a[12:15], v[104:107], v[196:199], a[12:15]
  v_mfma_f32_16x16x32_bf16 a[16:19], v[108:111], v[184:187], a[16:19]
  v_mfma_f32_16x16x32_bf16 a[20:23], v[108:111], v[188:191], a[20:23]
  v_mfma_f32_16x16x32_bf16 a[24:27], v[108:111], v[192:195], a[24:27]
  v_mfma_f32_16x16x32_bf16 a[28:31], v[108:111], v[196:199], a[28:31]
  v_mfma_f32_16x16x32_bf16 a[32:35], v[112:115], v[184:187], a[32:35]
  v_mfma_f32_16x16x32_bf16 a[36:39], v[112:115], v[188:191], a[36:39]
  v_mfma_f32_16x16x32_bf16 a[40:43], v[112:115], v[192:195], a[40:43]
  v_mfma_f32_16x16x32_bf16 a[44:47], v[112:115], v[196:199], a[44:47]
  v_mfma_f32_16x16x32_bf16 a[48:51], v[116:119], v[184:187], a[48:51]
  v_mfma_f32_16x16x32_bf16 a[52:55], v[116:119], v[188:191], a[52:55]
  v_mfma_f32_16x16x32_bf16 a[56:59], v[116:119], v[192:195], a[56:59]
  v_mfma_f32_16x16x32_bf16 a[60:63], v[116:119], v[196:199], a[60:63]
  v_mfma_f32_16x16x32_bf16 a[64:67], v[120:123], v[184:187], a[64:67]
  v_mfma_f32_16x16x32_bf16 a[68:71], v[120:123], v[188:191], a[68:71]
  v_mfma_f32_16x16x32_bf16 a[72:75], v[120:123], v[192:195], a[72:75]
  v_mfma_f32_16x16x32_bf16 a[76:79], v[120:123], v[196:199], a[76:79]
  v_mfma_f32_16x16x32_bf16 a[80:83], v[124:127], v[184:187], a[80:83]
  v_mfma_f32_16x16x32_bf16 a[84:87], v[124:127], v[188:191], a[84:87]
  v_mfma_f32_16x16x32_bf16 a[88:91], v[124:127], v[192:195], a[88:91]
  v_mfma_f32_16x16x32_bf16 a[92:95], v[124:127], v[196:199], a[92:95]
  v_mfma_f32_16x16x32_bf16 a[96:99], v[128:131], v[184:187], a[96:99]
  v_mfma_f32_16x16x32_bf16 a[100:103], v[128:131], v[188:191], a[100:103]
  v_mfma_f32_16x16x32_bf16 a[104:107], v[128:131], v[192:195], a[104:107]
  v_mfma_f32_16x16x32_bf16 a[108:111], v[128:131], v[196:199], a[108:111]
  v_mfma_f32_16x16x32_bf16 a[112:115], v[132:135], v[184:187], a[112:115]
  v_mfma_f32_16x16x32_bf16 a[116:119], v[132:135], v[188:191], a[116:119]
  v_mfma_f32_16x16x32_bf16 a[120:123], v[132:135], v[192:195], a[120:123]
  v_mfma_f32_16x16x32_bf16 a[124:127], v[132:135], v[196:199], a[124:127]
  v_mfma_f32_16x16x32_bf16 a[128:131], v[136:139], v[184:187], a[128:131]
  v_mfma_f32_16x16x32_bf16 a[132:135], v[136:139], v[188:191], a[132:135]
  v_mfma_f32_16x16x32_bf16 a[136:139], v[136:139], v[192:195], a[136:139]
  v_mfma_f32_16x16x32_bf16 a[140:143], v[136:139], v[196:199], a[140:143]
  v_mfma_f32_16x16x32_bf16 a[144:147], v[140:143], v[184:187], a[144:147]
  v_mfma_f32_16x16x32_bf16 a[148:151], v[140:143], v[188:191], a[148:151]
  v_mfma_f32_16x16x32_bf16 a[152:155], v[140:143], v[192:195], a[152:155]
  v_mfma_f32_16x16x32_bf16 a[156:159], v[140:143], v[196:199], a[156:159]
  buffer_load_dwordx4 v[104:107], v1, s[4:7], s30 offen offset:2048
  buffer_load_dwordx4 v[108:111], v1, s[4:7], s31 offen offset:2048
  buffer_load_dwordx4 v[112:115], v1, s[4:7], s32 offen offset:2048
  buffer_load_dwordx4 v[116:119], v1, s[4:7], s33 offen offset:2048
  buffer_load_dwordx4 v[120:123], v1, s[4:7], s34 offen offset:2048
  buffer_load_dwordx4 v[124:127], v1, s[4:7], s35 offen offset:2048
  buffer_load_dwordx4 v[128:131], v1, s[4:7], s36 offen offset:2048
  buffer_load_dwordx4 v[132:135], v1, s[4:7], s37 offen offset:2048
  buffer_load_dwordx4 v[136:139], v1, s[4:7], s38 offen offset:2048
  buffer_load_dwordx4 v[140:143], v1, s[4:7], s39 offen offset:2048
  s_waitcnt vmcnt(30)
  ds_read_b128 v[184:187], v1 offset:12288
  ds_read_b128 v[188:191], v1 offset:36864
  ds_read_b128 v[192:195], v6 offset:12288
  ds_read_b128 v[196:199], v6 offset:36864
  s_waitcnt lgkmcnt(4)
  v_mfma_f32_16x16x32_bf16 a[0:3], v[144:147], v[200:203], a[0:3]
  v_mfma_f32_16x16x32_bf16 a[4:7], v[144:147], v[204:207], a[4:7]
  v_mfma_f32_16x16x32_bf16 a[8:11], v[144:147], v[208:211], a[8:11]
  v_mfma_f32_16x16x32_bf16 a[12:15], v[144:147], v[212:215], a[12:15]
  v_mfma_f32_16x16x32_bf16 a[16:19], v[148:151], v[200:203], a[16:19]
  v_mfma_f32_16x16x32_bf16 a[20:23], v[148:151], v[204:207], a[20:23]
  v_mfma_f32_16x16x32_bf16 a[24:27], v[148:151], v[208:211], a[24:27]
  v_mfma_f32_16x16x32_bf16 a[28:31], v[148:151], v[212:215], a[28:31]
  v_mfma_f32_16x16x32_bf16 a[32:35], v[152:155], v[200:203], a[32:35]
  v_mfma_f32_16x16x32_bf16 a[36:39], v[152:155], v[204:207], a[36:39]
  v_mfma_f32_16x16x32_bf16 a[40:43], v[152:155], v[208:211], a[40:43]
  v_mfma_f32_16x16x32_bf16 a[44:47], v[152:155], v[212:215], a[44:47]
  v_mfma_f32_16x16x32_bf16 a[48:51], v[156:159], v[200:203], a[48:51]
  v_mfma_f32_16x16x32_bf16 a[52:55], v[156:159], v[204:207], a[52:55]
  v_mfma_f32_16x16x32_bf16 a[56:59], v[156:159], v[208:211], a[56:59]
  v_mfma_f32_16x16x32_bf16 a[60:63], v[156:159], v[212:215], a[60:63]
  v_mfma_f32_16x16x32_bf16 a[64:67], v[160:163], v[200:203], a[64:67]
  v_mfma_f32_16x16x32_bf16 a[68:71], v[160:163], v[204:207], a[68:71]
  v_mfma_f32_16x16x32_bf16 a[72:75], v[160:163], v[208:211], a[72:75]
  v_mfma_f32_16x16x32_bf16 a[76:79], v[160:163], v[212:215], a[76:79]
  v_mfma_f32_16x16x32_bf16 a[80:83], v[164:167], v[200:203], a[80:83]
  v_mfma_f32_16x16x32_bf16 a[84:87], v[164:167], v[204:207], a[84:87]
  v_mfma_f32_16x16x32_bf16 a[88:91], v[164:167], v[208:211], a[88:91]
  v_mfma_f32_16x16x32_bf16 a[92:95], v[164:167], v[212:215], a[92:95]
  v_mfma_f32_16x16x32_bf16 a[96:99], v[168:171], v[200:203], a[96:99]
  v_mfma_f32_16x16x32_bf16 a[100:103], v[168:171], v[204:207], a[100:103]
  v_mfma_f32_16x16x32_bf16 a[104:107], v[168:171], v[208:211], a[104:107]
  v_mfma_f32_16x16x32_bf16 a[108:111], v[168:171], v[212:215], a[108:111]
  v_mfma_f32_16x16x32_bf16 a[112:115], v[172:175], v[200:203], a[112:115]
  v_mfma_f32_16x16x32_bf16 a[116:119], v[172:175], v[204:207], a[116:119]
  v_mfma_f32_16x16x32_bf16 a[120:123], v[172:175], v[208:211], a[120:123]
  v_mfma_f32_16x16x32_bf16 a[124:127], v[172:175], v[212:215], a[124:127]
  v_mfma_f32_16x16x32_bf16 a[128:131], v[176:179], v[200:203], a[128:131]
  v_mfma_f32_16x16x32_bf16 a[132:135], v[176:179], v[204:207], a[132:135]
  v_mfma_f32_16x16x32_bf16 a[136:139], v[176:179], v[208:211], a[136:139]
  v_mfma_f32_16x16x32_bf16 a[140:143], v[176:179], v[212:215], a[140:143]
  v_mfma_f32_16x16x32_bf16 a[144:147], v[180:183], v[200:203], a[144:147]
  v_mfma_f32_16x16x32_bf16 a[148:151], v[180:183], v[204:207], a[148:151]
  v_mfma_f32_16x16x32_bf16 a[152:155], v[180:183], v[208:211], a[152:155]
  v_mfma_f32_16x16x32_bf16 a[156:159], v[180:183], v[212:215], a[156:159]
  buffer_load_dwordx4 v[144:147], v1, s[4:7], s30 offen offset:3072
  buffer_load_dwordx4 v[148:151], v1, s[4:7], s31 offen offset:3072
  buffer_load_dwordx4 v[152:155], v1, s[4:7], s32 offen offset:3072
  buffer_load_dwordx4 v[156:159], v1, s[4:7], s33 offen offset:3072
  buffer_load_dwordx4 v[160:163], v1, s[4:7], s34 offen offset:3072
  buffer_load_dwordx4 v[164:167], v1, s[4:7], s35 offen offset:3072
  buffer_load_dwordx4 v[168:171], v1, s[4:7], s36 offen offset:3072
  buffer_load_dwordx4 v[172:175], v1, s[4:7], s37 offen offset:3072
  buffer_load_dwordx4 v[176:179], v1, s[4:7], s38 offen offset:3072
  buffer_load_dwordx4 v[180:183], v1, s[4:7], s39 offen offset:3072
  s_add_u32 s30, s30, 4096
  s_add_u32 s31, s31, 4096
  s_add_u32 s32, s32, 4096
  s_add_u32 s33, s33, 4096
  s_add_u32 s34, s34, 4096
  s_add_u32 s35, s35, 4096
  s_add_u32 s36, s36, 4096
  s_add_u32 s37, s37, 4096
  s_add_u32 s38, s38, 4096
  s_add_u32 s39, s39, 4096
  s_waitcnt vmcnt(30)
  ds_read_b128 v[200:203], v1 offset:13312
  ds_read_b128 v[204:207], v1 offset:37888
  ds_read_b128 v[208:211], v6 offset:13312
  ds_read_b128 v[212:215], v6 offset:37888
  s_waitcnt lgkmcnt(4)
  v_mfma_f32_16x16x32_bf16 a[0:3], v[24:27], v[184:187], a[0:3]
  v_mfma_f32_16x16x32_bf16 a[4:7], v[24:27], v[188:191], a[4:7]
  v_mfma_f32_16x16x32_bf16 a[8:11], v[24:27], v[192:195], a[8:11]
  v_mfma_f32_16x16x32_bf16 a[12:15], v[24:27], v[196:199], a[12:15]
  v_mfma_f32_16x16x32_bf16 a[16:19], v[28:31], v[184:187], a[16:19]
  v_mfma_f32_16x16x32_bf16 a[20:23], v[28:31], v[188:191], a[20:23]
  v_mfma_f32_16x16x32_bf16 a[24:27], v[28:31], v[192:195], a[24:27]
  v_mfma_f32_16x16x32_bf16 a[28:31], v[28:31], v[196:199], a[28:31]
  v_mfma_f32_16x16x32_bf16 a[32:35], v[32:35], v[184:187], a[32:35]
  v_mfma_f32_16x16x32_bf16 a[36:39], v[32:35], v[188:191], a[36:39]
  v_mfma_f32_16x16x32_bf16 a[40:43], v[32:35], v[192:195], a[40:43]
  v_mfma_f32_16x16x32_bf16 a[44:47], v[32:35], v[196:199], a[44:47]
  v_mfma_f32_16x16x32_bf16 a[48:51], v[36:39], v[184:187], a[48:51]
  v_mfma_f32_16x16x32_bf16 a[52:55], v[36:39], v[188:191], a[52:55]
  v_mfma_f32_16x16x32_bf16 a[56:59], v[36:39], v[192:195], a[56:59]
  v_mfma_f32_16x16x32_bf16 a[60:63], v[36:39], v[196:199], a[60:63]
  v_mfma_f32_16x16x32_bf16 a[64:67], v[40:43], v[184:187], a[64:67]
  v_mfma_f32_16x16x32_bf16 a[68:71], v[40:43], v[188:191], a[68:71]
  v_mfma_f32_16x16x32_bf16 a[72:75], v[40:43], v[192:195], a[72:75]
  v_mfma_f32_16x16x32_bf16 a[76:79], v[40:43], v[196:199], a[76:79]
  v_mfma_f32_16x16x32_bf16 a[80:83], v[44:47], v[184:187], a[80:83]
  v_mfma_f32_16x16x32_bf16 a[84:87], v[44:47], v[188:191], a[84:87]
  v_mfma_f32_16x16x32_bf16 a[88:91], v[44:47], v[192:195], a[88:91]
  v_mfma_f32_16x16x32_bf16 a[92:95], v[44:47], v[196:199], a[92:95]
  v_mfma_f32_16x16x32_bf16 a[96:99], v[48:51], v[184:187], a[96:99]
  v_mfma_f32_16x16x32_bf16 a[100:103], v[48:51], v[188:191], a[100:103]
  v_mfma_f32_16x16x32_bf16 a[104:107], v[48:51], v[192:195], a[104:107]
  v_mfma_f32_16x16x32_bf16 a[108:111], v[48:51], v[196:199], a[108:111]
  v_mfma_f32_16x16x32_bf16 a[112:115], v[52:55], v[184:187], a[112:115]
  v_mfma_f32_16x16x32_bf16 a[116:119], v[52:55], v[188:191], a[116:119]
  v_mfma_f32_16x16x32_bf16 a[120:123], v[52:55], v[192:195], a[120:123]
  v_mfma_f32_16x16x32_bf16 a[124:127], v[52:55], v[196:199], a[124:127]
  v_mfma_f32_16x16x32_bf16 a[128:131], v[56:59], v[184:187], a[128:131]
  v_mfma_f32_16x16x32_bf16 a[132:135], v[56:59], v[188:191], a[132:135]
  v_mfma_f32_16x16x32_bf16 a[136:139], v[56:59], v[192:195], a[136:139]
  v_mfma_f32_16x16x32_bf16 a[140:143], v[56:59], v[196:199], a[140:143]
  v_mfma_f32_16x16x32_bf16 a[144:147], v[60:63], v[184:187], a[144:147]
  v_mfma_f32_16x16x32_bf16 a[148:151], v[60:63], v[188:191], a[148:151]
  v_mfma_f32_16x16x32_bf16 a[152:155], v[60:63], v[192:195], a[152:155]
  v_mfma_f32_16x16x32_bf16 a[156:159], v[60:63], v[196:199], a[156:159]
  buffer_load_dwordx4 v[24:27], v1, s[4:7], s30 offen offset:0
  buffer_load_dwordx4 v[28:31], v1, s[4:7], s31 offen offset:0
  buffer_load_dwordx4 v[32:35], v1, s[4:7], s32 offen offset:0
  buffer_load_dwordx4 v[36:39], v1, s[4:7], s33 offen offset:0
  buffer_load_dwordx4 v[40:43], v1, s[4:7], s34 offen offset:0
  buffer_load_dwordx4 v[44:47], v1, s[4:7], s35 offen offset:0
  buffer_load_dwordx4 v[48:51], v1, s[4:7], s36 offen offset:0
  buffer_load_dwordx4 v[52:55], v1, s[4:7], s37 offen offset:0
  buffer_load_dwordx4 v[56:59], v1, s[4:7], s38 offen offset:0
  buffer_load_dwordx4 v[60:63], v1, s[4:7], s39 offen offset:0
  s_waitcnt vmcnt(30)
  ds_read_b128 v[184:187], v1 offset:14336
  ds_read_b128 v[188:191], v1 offset:38912
  ds_read_b128 v[192:195], v6 offset:14336
  ds_read_b128 v[196:199], v6 offset:38912
  s_waitcnt lgkmcnt(4)
  v_mfma_f32_16x16x32_bf16 a[0:3], v[64:67], v[200:203], a[0:3]
  v_mfma_f32_16x16x32_bf16 a[4:7], v[64:67], v[204:207], a[4:7]
  v_mfma_f32_16x16x32_bf16 a[8:11], v[64:67], v[208:211], a[8:11]
  v_mfma_f32_16x16x32_bf16 a[12:15], v[64:67], v[212:215], a[12:15]
  v_mfma_f32_16x16x32_bf16 a[16:19], v[68:71], v[200:203], a[16:19]
  v_mfma_f32_16x16x32_bf16 a[20:23], v[68:71], v[204:207], a[20:23]
  v_mfma_f32_16x16x32_bf16 a[24:27], v[68:71], v[208:211], a[24:27]
  v_mfma_f32_16x16x32_bf16 a[28:31], v[68:71], v[212:215], a[28:31]
  v_mfma_f32_16x16x32_bf16 a[32:35], v[72:75], v[200:203], a[32:35]
  v_mfma_f32_16x16x32_bf16 a[36:39], v[72:75], v[204:207], a[36:39]
  v_mfma_f32_16x16x32_bf16 a[40:43], v[72:75], v[208:211], a[40:43]
  v_mfma_f32_16x16x32_bf16 a[44:47], v[72:75], v[212:215], a[44:47]
  v_mfma_f32_16x16x32_bf16 a[48:51], v[76:79], v[200:203], a[48:51]
  v_mfma_f32_16x16x32_bf16 a[52:55], v[76:79], v[204:207], a[52:55]
  v_mfma_f32_16x16x32_bf16 a[56:59], v[76:79], v[208:211], a[56:59]
  v_mfma_f32_16x16x32_bf16 a[60:63], v[76:79], v[212:215], a[60:63]
  v_mfma_f32_16x16x32_bf16 a[64:67], v[80:83], v[200:203], a[64:67]
  v_mfma_f32_16x16x32_bf16 a[68:71], v[80:83], v[204:207], a[68:71]
  v_mfma_f32_16x16x32_bf16 a[72:75], v[80:83], v[208:211], a[72:75]
  v_mfma_f32_16x16x32_bf16 a[76:79], v[80:83], v[212:215], a[76:79]
  v_mfma_f32_16x16x32_bf16 a[80:83], v[84:87], v[200:203], a[80:83]
  v_mfma_f32_16x16x32_bf16 a[84:87], v[84:87], v[204:207], a[84:87]
  v_mfma_f32_16x16x32_bf16 a[88:91], v[84:87], v[208:211], a[88:91]
  v_mfma_f32_16x16x32_bf16 a[92:95], v[84:87], v[212:215], a[92:95]
  v_mfma_f32_16x16x32_bf16 a[96:99], v[88:91], v[200:203], a[96:99]
  v_mfma_f32_16x16x32_bf16 a[100:103], v[88:91], v[204:207], a[100:103]
  v_mfma_f32_16x16x32_bf16 a[104:107], v[88:91], v[208:211], a[104:107]
  v_mfma_f32_16x16x32_bf16 a[108:111], v[88:91], v[212:215], a[108:111]
  v_mfma_f32_16x16x32_bf16 a[112:115], v[92:95], v[200:203], a[112:115]
  v_mfma_f32_16x16x32_bf16 a[116:119], v[92:95], v[204:207], a[116:119]
  v_mfma_f32_16x16x32_bf16 a[120:123], v[92:95], v[208:211], a[120:123]
  v_mfma_f32_16x16x32_bf16 a[124:127], v[92:95], v[212:215], a[124:127]
  v_mfma_f32_16x16x32_bf16 a[128:131], v[96:99], v[200:203], a[128:131]
  v_mfma_f32_16x16x32_bf16 a[132:135], v[96:99], v[204:207], a[132:135]
  v_mfma_f32_16x16x32_bf16 a[136:139], v[96:99], v[208:211], a[136:139]
  v_mfma_f32_16x16x32_bf16 a[140:143], v[96:99], v[212:215], a[140:143]
  v_mfma_f32_16x16x32_bf16 a[144:147], v[100:103], v[200:203], a[144:147]
  v_mfma_f32_16x16x32_bf16 a[148:151], v[100:103], v[204:207], a[148:151]
  v_mfma_f32_16x16x32_bf16 a[152:155], v[100:103], v[208:211], a[152:155]
  v_mfma_f32_16x16x32_bf16 a[156:159], v[100:103], v[212:215], a[156:159]
  buffer_load_dwordx4 v[64:67], v1, s[4:7], s30 offen offset:1024
  buffer_load_dwordx4 v[68:71], v1, s[4:7], s31 offen offset:1024
  buffer_load_dwordx4 v[72:75], v1, s[4:7], s32 offen offset:1024
  buffer_load_dwordx4 v[76:79], v1, s[4:7], s33 offen offset:1024
  buffer_load_dwordx4 v[80:83], v1, s[4:7], s34 offen offset:1024
  buffer_load_dwordx4 v[84:87], v1, s[4:7], s35 offen offset:1024
  buffer_load_dwordx4 v[88:91], v1, s[4:7], s36 offen offset:1024
  buffer_load_dwordx4 v[92:95], v1, s[4:7], s37 offen offset:1024
  buffer_load_dwordx4 v[96:99], v1, s[4:7], s38 offen offset:1024
  buffer_load_dwordx4 v[100:103], v1, s[4:7], s39 offen offset:1024
  s_waitcnt vmcnt(30)
  ds_read_b128 v[200:203], v1 offset:15360
  ds_read_b128 v[204:207], v1 offset:39936
  ds_read_b128 v[208:211], v6 offset:15360
  ds_read_b128 v[212:215], v6 offset:39936
  s_waitcnt lgkmcnt(4)
  v_mfma_f32_16x16x32_bf16 a[0:3], v[104:107], v[184:187], a[0:3]
  v_mfma_f32_16x16x32_bf16 a[4:7], v[104:107], v[188:191], a[4:7]
  v_mfma_f32_16x16x32_bf16 a[8:11], v[104:107], v[192:195], a[8:11]
  v_mfma_f32_16x16x32_bf16 a[12:15], v[104:107], v[196:199], a[12:15]
  v_mfma_f32_16x16x32_bf16 a[16:19], v[108:111], v[184:187], a[16:19]
  v_mfma_f32_16x16x32_bf16 a[20:23], v[108:111], v[188:191], a[20:23]
  v_mfma_f32_16x16x32_bf16 a[24:27], v[108:111], v[192:195], a[24:27]
  v_mfma_f32_16x16x32_bf16 a[28:31], v[108:111], v[196:199], a[28:31]
  v_mfma_f32_16x16x32_bf16 a[32:35], v[112:115], v[184:187], a[32:35]
  v_mfma_f32_16x16x32_bf16 a[36:39], v[112:115], v[188:191], a[36:39]
  v_mfma_f32_16x16x32_bf16 a[40:43], v[112:115], v[192:195], a[40:43]
  v_mfma_f32_16x16x32_bf16 a[44:47], v[112:115], v[196:199], a[44:47]
  v_mfma_f32_16x16x32_bf16 a[48:51], v[116:119], v[184:187], a[48:51]
  v_mfma_f32_16x16x32_bf16 a[52:55], v[116:119], v[188:191], a[52:55]
  v_mfma_f32_16x16x32_bf16 a[56:59], v[116:119], v[192:195], a[56:59]
  v_mfma_f32_16x16x32_bf16 a[60:63], v[116:119], v[196:199], a[60:63]
  v_mfma_f32_16x16x32_bf16 a[64:67], v[120:123], v[184:187], a[64:67]
  v_mfma_f32_16x16x32_bf16 a[68:71], v[120:123], v[188:191], a[68:71]
  v_mfma_f32_16x16x32_bf16 a[72:75], v[120:123], v[192:195], a[72:75]
  v_mfma_f32_16x16x32_bf16 a[76:79], v[120:123], v[196:199], a[76:79]
  v_mfma_f32_16x16x32_bf16 a[80:83], v[124:127], v[184:187], a[80:83]
  v_mfma_f32_16x16x32_bf16 a[84:87], v[124:127], v[188:191], a[84:87]
  v_mfma_f32_16x16x32_bf16 a[88:91], v[124:127], v[192:195], a[88:91]
  v_mfma_f32_16x16x32_bf16 a[92:95], v[124:127], v[196:199], a[92:95]
  v_mfma_f32_16x16x32_bf16 a[96:99], v[128:131], v[184:187], a[96:99]
  v_mfma_f32_16x16x32_bf16 a[100:103], v[128:131], v[188:191], a[100:103]
  v_mfma_f32_16x16x32_bf16 a[104:107], v[128:131], v[192:195], a[104:107]
  v_mfma_f32_16x16x32_bf16 a[108:111], v[128:131], v[196:199], a[108:111]
  v_mfma_f32_16x16x32_bf16 a[112:115], v[132:135], v[184:187], a[112:115]
  v_mfma_f32_16x16x32_bf16 a[116:119], v[132:135], v[188:191], a[116:119]
  v_mfma_f32_16x16x32_bf16 a[120:123], v[132:135], v[192:195], a[120:123]
  v_mfma_f32_16x16x32_bf16 a[124:127], v[132:135], v[196:199], a[124:127]
  v_mfma_f32_16x16x32_bf16 a[128:131], v[136:139], v[184:187], a[128:131]
  v_mfma_f32_16x16x32_bf16 a[132:135], v[136:139], v[188:191], a[132:135]
  v_mfma_f32_16x16x32_bf16 a[136:139], v[136:139], v[192:195], a[136:139]
  v_mfma_f32_16x16x32_bf16 a[140:143], v[136:139], v[196:199], a[140:143]
  v_mfma_f32_16x16x32_bf16 a[144:147], v[140:143], v[184:187], a[144:147]
  v_mfma_f32_16x16x32_bf16 a[148:151], v[140:143], v[188:191], a[148:151]
  v_mfma_f32_16x16x32_bf16 a[152:155], v[140:143], v[192:195], a[152:155]
  v_mfma_f32_16x16x32_bf16 a[156:159], v[140:143], v[196:199], a[156:159]
  buffer_load_dwordx4 v[104:107], v1, s[4:7], s30 offen offset:2048
  buffer_load_dwordx4 v[108:111], v1, s[4:7], s31 offen offset:2048
  buffer_load_dwordx4 v[112:115], v1, s[4:7], s32 offen offset:2048
  buffer_load_dwordx4 v[116:119], v1, s[4:7], s33 offen offset:2048
  buffer_load_dwordx4 v[120:123], v1, s[4:7], s34 offen offset:2048
  buffer_load_dwordx4 v[124:127], v1, s[4:7], s35 offen offset:2048
  buffer_load_dwordx4 v[128:131], v1, s[4:7], s36 offen offset:2048
  buffer_load_dwordx4 v[132:135], v1, s[4:7], s37 offen offset:2048
  buffer_load_dwordx4 v[136:139], v1, s[4:7], s38 offen offset:2048
  buffer_load_dwordx4 v[140:143], v1, s[4:7], s39 offen offset:2048
  s_waitcnt vmcnt(30)
  ds_read_b128 v[184:187], v1 offset:16384
  ds_read_b128 v[188:191], v1 offset:40960
  ds_read_b128 v[192:195], v6 offset:16384
  ds_read_b128 v[196:199], v6 offset:40960
  s_waitcnt lgkmcnt(4)
  v_mfma_f32_16x16x32_bf16 a[0:3], v[144:147], v[200:203], a[0:3]
  v_mfma_f32_16x16x32_bf16 a[4:7], v[144:147], v[204:207], a[4:7]
  v_mfma_f32_16x16x32_bf16 a[8:11], v[144:147], v[208:211], a[8:11]
  v_mfma_f32_16x16x32_bf16 a[12:15], v[144:147], v[212:215], a[12:15]
  v_mfma_f32_16x16x32_bf16 a[16:19], v[148:151], v[200:203], a[16:19]
  v_mfma_f32_16x16x32_bf16 a[20:23], v[148:151], v[204:207], a[20:23]
  v_mfma_f32_16x16x32_bf16 a[24:27], v[148:151], v[208:211], a[24:27]
  v_mfma_f32_16x16x32_bf16 a[28:31], v[148:151], v[212:215], a[28:31]
  v_mfma_f32_16x16x32_bf16 a[32:35], v[152:155], v[200:203], a[32:35]
  v_mfma_f32_16x16x32_bf16 a[36:39], v[152:155], v[204:207], a[36:39]
  v_mfma_f32_16x16x32_bf16 a[40:43], v[152:155], v[208:211], a[40:43]
  v_mfma_f32_16x16x32_bf16 a[44:47], v[152:155], v[212:215], a[44:47]
  v_mfma_f32_16x16x32_bf16 a[48:51], v[156:159], v[200:203], a[48:51]
  v_mfma_f32_16x16x32_bf16 a[52:55], v[156:159], v[204:207], a[52:55]
  v_mfma_f32_16x16x32_bf16 a[56:59], v[156:159], v[208:211], a[56:59]
  v_mfma_f32_16x16x32_bf16 a[60:63], v[156:159], v[212:215], a[60:63]
  v_mfma_f32_16x16x32_bf16 a[64:67], v[160:163], v[200:203], a[64:67]
  v_mfma_f32_16x16x32_bf16 a[68:71], v[160:163], v[204:207], a[68:71]
  v_mfma_f32_16x16x32_bf16 a[72:75], v[160:163], v[208:211], a[72:75]
  v_mfma_f32_16x16x32_bf16 a[76:79], v[160:163], v[212:215], a[76:79]
  v_mfma_f32_16x16x32_bf16 a[80:83], v[164:167], v[200:203], a[80:83]
  v_mfma_f32_16x16x32_bf16 a[84:87], v[164:167], v[204:207], a[84:87]
  v_mfma_f32_16x16x32_bf16 a[88:91], v[164:167], v[208:211], a[88:91]
  v_mfma_f32_16x16x32_bf16 a[92:95], v[164:167], v[212:215], a[92:95]
  v_mfma_f32_16x16x32_bf16 a[96:99], v[168:171], v[200:203], a[96:99]
  v_mfma_f32_16x16x32_bf16 a[100:103], v[168:171], v[204:207], a[100:103]
  v_mfma_f32_16x16x32_bf16 a[104:107], v[168:171], v[208:211], a[104:107]
  v_mfma_f32_16x16x32_bf16 a[108:111], v[168:171], v[212:215], a[108:111]
  v_mfma_f32_16x16x32_bf16 a[112:115], v[172:175], v[200:203], a[112:115]
  v_mfma_f32_16x16x32_bf16 a[116:119], v[172:175], v[204:207], a[116:119]
  v_mfma_f32_16x16x32_bf16 a[120:123], v[172:175], v[208:211], a[120:123]
  v_mfma_f32_16x16x32_bf16 a[124:127], v[172:175], v[212:215], a[124:127]
  v_mfma_f32_16x16x32_bf16 a[128:131], v[176:179], v[200:203], a[128:131]
  v_mfma_f32_16x16x32_bf16 a[132:135], v[176:179], v[204:207], a[132:135]
  v_mfma_f32_16x16x32_bf16 a[136:139], v[176:179], v[208:211], a[136:139]
  v_mfma_f32_16x16x32_bf16 a[140:143], v[176:179], v[212:215], a[140:143]
  v_mfma_f32_16x16x32_bf16 a[144:147], v[180:183], v[200:203], a[144:147]
  v_mfma_f32_16x16x32_bf16 a[148:151], v[180:183], v[204:207], a[148:151]
  v_mfma_f32_16x16x32_bf16 a[152:155], v[180:183], v[208:211], a[152:155]
  v_mfma_f32_16x16x32_bf16 a[156:159], v[180:183], v[212:215], a[156:159]
  buffer_load_dwordx4 v[144:147], v1, s[4:7], s30 offen offset:3072
  buffer_load_dwordx4 v[148:151], v1, s[4:7], s31 offen offset:3072
  buffer_load_dwordx4 v[152:155], v1, s[4:7], s32 offen offset:3072
  buffer_load_dwordx4 v[156:159], v1, s[4:7], s33 offen offset:3072
  buffer_load_dwordx4 v[160:163], v1, s[4:7], s34 offen offset:3072
  buffer_load_dwordx4 v[164:167], v1, s[4:7], s35 offen offset:3072
  buffer_load_dwordx4 v[168:171], v1, s[4:7], s36 offen offset:3072
  buffer_load_dwordx4 v[172:175], v1, s[4:7], s37 offen offset:3072
  buffer_load_dwordx4 v[176:179], v1, s[4:7], s38 offen offset:3072
  buffer_load_dwordx4 v[180:183], v1, s[4:7], s39 offen offset:3072
  s_add_u32 s30, s30, 4096
  s_add_u32 s31, s31, 4096
  s_add_u32 s32, s32, 4096
  s_add_u32 s33, s33, 4096
  s_add_u32 s34, s34, 4096
  s_add_u32 s35, s35, 4096
  s_add_u32 s36, s36, 4096
  s_add_u32 s37, s37, 4096
  s_add_u32 s38, s38, 4096
  s_add_u32 s39, s39, 4096
  s_waitcnt vmcnt(30)
  ds_read_b128 v[200:203], v1 offset:17408
  ds_read_b128 v[204:207], v1 offset:41984
  ds_read_b128 v[208:211], v6 offset:17408
  ds_read_b128 v[212:215], v6 offset:41984
  s_waitcnt lgkmcnt(4)
  v_mfma_f32_16x16x32_bf16 a[0:3], v[24:27], v[184:187], a[0:3]
  v_mfma_f32_16x16x32_bf16 a[4:7], v[24:27], v[188:191], a[4:7]
  v_mfma_f32_16x16x32_bf16 a[8:11], v[24:27], v[192:195], a[8:11]
  v_mfma_f32_16x16x32_bf16 a[12:15], v[24:27], v[196:199], a[12:15]
  v_mfma_f32_16x16x32_bf16 a[16:19], v[28:31], v[184:187], a[16:19]
  v_mfma_f32_16x16x32_bf16 a[20:23], v[28:31], v[188:191], a[20:23]
  v_mfma_f32_16x16x32_bf16 a[24:27], v[28:31], v[192:195], a[24:27]
  v_mfma_f32_16x16x32_bf16 a[28:31], v[28:31], v[196:199], a[28:31]
  v_mfma_f32_16x16x32_bf16 a[32:35], v[32:35], v[184:187], a[32:35]
  v_mfma_f32_16x16x32_bf16 a[36:39], v[32:35], v[188:191], a[36:39]
  v_mfma_f32_16x16x32_bf16 a[40:43], v[32:35], v[192:195], a[40:43]
  v_mfma_f32_16x16x32_bf16 a[44:47], v[32:35], v[196:199], a[44:47]
  v_mfma_f32_16x16x32_bf16 a[48:51], v[36:39], v[184:187], a[48:51]
  v_mfma_f32_16x16x32_bf16 a[52:55], v[36:39], v[188:191], a[52:55]
  v_mfma_f32_16x16x32_bf16 a[56:59], v[36:39], v[192:195], a[56:59]
  v_mfma_f32_16x16x32_bf16 a[60:63], v[36:39], v[196:199], a[60:63]
  v_mfma_f32_16x16x32_bf16 a[64:67], v[40:43], v[184:187], a[64:67]
  v_mfma_f32_16x16x32_bf16 a[68:71], v[40:43], v[188:191], a[68:71]
  v_mfma_f32_16x16x32_bf16 a[72:75], v[40:43], v[192:195], a[72:75]
  v_mfma_f32_16x16x32_bf16 a[76:79], v[40:43], v[196:199], a[76:79]
  v_mfma_f32_16x16x32_bf16 a[80:83], v[44:47], v[184:187], a[80:83]
  v_mfma_f32_16x16x32_bf16 a[84:87], v[44:47], v[188:191], a[84:87]
  v_mfma_f32_16x16x32_bf16 a[88:91], v[44:47], v[192:195], a[88:91]
  v_mfma_f32_16x16x32_bf16 a[92:95], v[44:47], v[196:199], a[92:95]
  v_mfma_f32_16x16x32_bf16 a[96:99], v[48:51], v[184:187], a[96:99]
  v_mfma_f32_16x16x32_bf16 a[100:103], v[48:51], v[188:191], a[100:103]
  v_mfma_f32_16x16x32_bf16 a[104:107], v[48:51], v[192:195], a[104:107]
  v_mfma_f32_16x16x32_bf16 a[108:111], v[48:51], v[196:199], a[108:111]
  v_mfma_f32_16x16x32_bf16 a[112:115], v[52:55], v[184:187], a[112:115]
  v_mfma_f32_16x16x32_bf16 a[116:119], v[52:55], v[188:191], a[116:119]
  v_mfma_f32_16x16x32_bf16 a[120:123], v[52:55], v[192:195], a[120:123]
  v_mfma_f32_16x16x32_bf16 a[124:127], v[52:55], v[196:199], a[124:127]
  v_mfma_f32_16x16x32_bf16 a[128:131], v[56:59], v[184:187], a[128:131]
  v_mfma_f32_16x16x32_bf16 a[132:135], v[56:59], v[188:191], a[132:135]
  v_mfma_f32_16x16x32_bf16 a[136:139], v[56:59], v[192:195], a[136:139]
  v_mfma_f32_16x16x32_bf16 a[140:143], v[56:59], v[196:199], a[140:143]
  v_mfma_f32_16x16x32_bf16 a[144:147], v[60:63], v[184:187], a[144:147]
  v_mfma_f32_16x16x32_bf16 a[148:151], v[60:63], v[188:191], a[148:151]
  v_mfma_f32_16x16x32_bf16 a[152:155], v[60:63], v[192:195], a[152:155]
  v_mfma_f32_16x16x32_bf16 a[156:159], v[60:63], v[196:199], a[156:159]
  buffer_load_dwordx4 v[24:27], v1, s[4:7], s30 offen offset:0
  buffer_load_dwordx4 v[28:31], v1, s[4:7], s31 offen offset:0
  buffer_load_dwordx4 v[32:35], v1, s[4:7], s32 offen offset:0
  buffer_load_dwordx4 v[36:39], v1, s[4:7], s33 offen offset:0
  buffer_load_dwordx4 v[40:43], v1, s[4:7], s34 offen offset:0
  buffer_load_dwordx4 v[44:47], v1, s[4:7], s35 offen offset:0
  buffer_load_dwordx4 v[48:51], v1, s[4:7], s36 offen offset:0
  buffer_load_dwordx4 v[52:55], v1, s[4:7], s37 offen offset:0
  buffer_load_dwordx4 v[56:59], v1, s[4:7], s38 offen offset:0
  buffer_load_dwordx4 v[60:63], v1, s[4:7], s39 offen offset:0
  s_waitcnt vmcnt(30)
  ds_read_b128 v[184:187], v1 offset:18432
  ds_read_b128 v[188:191], v1 offset:43008
  ds_read_b128 v[192:195], v6 offset:18432
  ds_read_b128 v[196:199], v6 offset:43008
  s_waitcnt lgkmcnt(4)
  v_mfma_f32_16x16x32_bf16 a[0:3], v[64:67], v[200:203], a[0:3]
  v_mfma_f32_16x16x32_bf16 a[4:7], v[64:67], v[204:207], a[4:7]
  v_mfma_f32_16x16x32_bf16 a[8:11], v[64:67], v[208:211], a[8:11]
  v_mfma_f32_16x16x32_bf16 a[12:15], v[64:67], v[212:215], a[12:15]
  v_mfma_f32_16x16x32_bf16 a[16:19], v[68:71], v[200:203], a[16:19]
  v_mfma_f32_16x16x32_bf16 a[20:23], v[68:71], v[204:207], a[20:23]
  v_mfma_f32_16x16x32_bf16 a[24:27], v[68:71], v[208:211], a[24:27]
  v_mfma_f32_16x16x32_bf16 a[28:31], v[68:71], v[212:215], a[28:31]
  v_mfma_f32_16x16x32_bf16 a[32:35], v[72:75], v[200:203], a[32:35]
  v_mfma_f32_16x16x32_bf16 a[36:39], v[72:75], v[204:207], a[36:39]
  v_mfma_f32_16x16x32_bf16 a[40:43], v[72:75], v[208:211], a[40:43]
  v_mfma_f32_16x16x32_bf16 a[44:47], v[72:75], v[212:215], a[44:47]
  v_mfma_f32_16x16x32_bf16 a[48:51], v[76:79], v[200:203], a[48:51]
  v_mfma_f32_16x16x32_bf16 a[52:55], v[76:79], v[204:207], a[52:55]
  v_mfma_f32_16x16x32_bf16 a[56:59], v[76:79], v[208:211], a[56:59]
  v_mfma_f32_16x16x32_bf16 a[60:63], v[76:79], v[212:215], a[60:63]
  v_mfma_f32_16x16x32_bf16 a[64:67], v[80:83], v[200:203], a[64:67]
  v_mfma_f32_16x16x32_bf16 a[68:71], v[80:83], v[204:207], a[68:71]
  v_mfma_f32_16x16x32_bf16 a[72:75], v[80:83], v[208:211], a[72:75]
  v_mfma_f32_16x16x32_bf16 a[76:79], v[80:83], v[212:215], a[76:79]
  v_mfma_f32_16x16x32_bf16 a[80:83], v[84:87], v[200:203], a[80:83]
  v_mfma_f32_16x16x32_bf16 a[84:87], v[84:87], v[204:207], a[84:87]
  v_mfma_f32_16x16x32_bf16 a[88:91], v[84:87], v[208:211], a[88:91]
  v_mfma_f32_16x16x32_bf16 a[92:95], v[84:87], v[212:215], a[92:95]
  v_mfma_f32_16x16x32_bf16 a[96:99], v[88:91], v[200:203], a[96:99]
  v_mfma_f32_16x16x32_bf16 a[100:103], v[88:91], v[204:207], a[100:103]
  v_mfma_f32_16x16x32_bf16 a[104:107], v[88:91], v[208:211], a[104:107]
  v_mfma_f32_16x16x32_bf16 a[108:111], v[88:91], v[212:215], a[108:111]
  v_mfma_f32_16x16x32_bf16 a[112:115], v[92:95], v[200:203], a[112:115]
  v_mfma_f32_16x16x32_bf16 a[116:119], v[92:95], v[204:207], a[116:119]
  v_mfma_f32_16x16x32_bf16 a[120:123], v[92:95], v[208:211], a[120:123]
  v_mfma_f32_16x16x32_bf16 a[124:127], v[92:95], v[212:215], a[124:127]
  v_mfma_f32_16x16x32_bf16 a[128:131], v[96:99], v[200:203], a[128:131]
  v_mfma_f32_16x16x32_bf16 a[132:135], v[96:99], v[204:207], a[132:135]
  v_mfma_f32_16x16x32_bf16 a[136:139], v[96:99], v[208:211], a[136:139]
  v_mfma_f32_16x16x32_bf16 a[140:143], v[96:99], v[212:215], a[140:143]
  v_mfma_f32_16x16x32_bf16 a[144:147], v[100:103], v[200:203], a[144:147]
  v_mfma_f32_16x16x32_bf16 a[148:151], v[100:103], v[204:207], a[148:151]
  v_mfma_f32_16x16x32_bf16 a[152:155], v[100:103], v[208:211], a[152:155]
  v_mfma_f32_16x16x32_bf16 a[156:159], v[100:103], v[212:215], a[156:159]
  buffer_load_dwordx4 v[64:67], v1, s[4:7], s30 offen offset:1024
  buffer_load_dwordx4 v[68:71], v1, s[4:7], s31 offen offset:1024
  buffer_load_dwordx4 v[72:75], v1, s[4:7], s32 offen offset:1024
  buffer_load_dwordx4 v[76:79], v1, s[4:7], s33 offen offset:1024
  buffer_load_dwordx4 v[80:83], v1, s[4:7], s34 offen offset:1024
  buffer_load_dwordx4 v[84:87], v1, s[4:7], s35 offen offset:1024
  buffer_load_dwordx4 v[88:91], v1, s[4:7], s36 offen offset:1024
  buffer_load_dwordx4 v[92:95], v1, s[4:7], s37 offen offset:1024
  buffer_load_dwordx4 v[96:99], v1, s[4:7], s38 offen offset:1024
  buffer_load_dwordx4 v[100:103], v1, s[4:7], s39 offen offset:1024
  s_waitcnt vmcnt(30)
  ds_read_b128 v[200:203], v1 offset:19456
  ds_read_b128 v[204:207], v1 offset:44032
  ds_read_b128 v[208:211], v6 offset:19456
  ds_read_b128 v[212:215], v6 offset:44032
  s_waitcnt lgkmcnt(4)
  v_mfma_f32_16x16x32_bf16 a[0:3], v[104:107], v[184:187], a[0:3]
  v_mfma_f32_16x16x32_bf16 a[4:7], v[104:107], v[188:191], a[4:7]
  v_mfma_f32_16x16x32_bf16 a[8:11], v[104:107], v[192:195], a[8:11]
  v_mfma_f32_16x16x32_bf16 a[12:15], v[104:107], v[196:199], a[12:15]
  v_mfma_f32_16x16x32_bf16 a[16:19], v[108:111], v[184:187], a[16:19]
  v_mfma_f32_16x16x32_bf16 a[20:23], v[108:111], v[188:191], a[20:23]
  v_mfma_f32_16x16x32_bf16 a[24:27], v[108:111], v[192:195], a[24:27]
  v_mfma_f32_16x16x32_bf16 a[28:31], v[108:111], v[196:199], a[28:31]
  v_mfma_f32_16x16x32_bf16 a[32:35], v[112:115], v[184:187], a[32:35]
  v_mfma_f32_16x16x32_bf16 a[36:39], v[112:115], v[188:191], a[36:39]
  v_mfma_f32_16x16x32_bf16 a[40:43], v[112:115], v[192:195], a[40:43]
  v_mfma_f32_16x16x32_bf16 a[44:47], v[112:115], v[196:199], a[44:47]
  v_mfma_f32_16x16x32_bf16 a[48:51], v[116:119], v[184:187], a[48:51]
  v_mfma_f32_16x16x32_bf16 a[52:55], v[116:119], v[188:191], a[52:55]
  v_mfma_f32_16x16x32_bf16 a[56:59], v[116:119], v[192:195], a[56:59]
  v_mfma_f32_16x16x32_bf16 a[60:63], v[116:119], v[196:199], a[60:63]
  v_mfma_f32_16x16x32_bf16 a[64:67], v[120:123], v[184:187], a[64:67]
  v_mfma_f32_16x16x32_bf16 a[68:71], v[120:123], v[188:191], a[68:71]
  v_mfma_f32_16x16x32_bf16 a[72:75], v[120:123], v[192:195], a[72:75]
  v_mfma_f32_16x16x32_bf16 a[76:79], v[120:123], v[196:199], a[76:79]
  v_mfma_f32_16x16x32_bf16 a[80:83], v[124:127], v[184:187], a[80:83]
  v_mfma_f32_16x16x32_bf16 a[84:87], v[124:127], v[188:191], a[84:87]
  v_mfma_f32_16x16x32_bf16 a[88:91], v[124:127], v[192:195], a[88:91]
  v_mfma_f32_16x16x32_bf16 a[92:95], v[124:127], v[196:199], a[92:95]
  v_mfma_f32_16x16x32_bf16 a[96:99], v[128:131], v[184:187], a[96:99]
  v_mfma_f32_16x16x32_bf16 a[100:103], v[128:131], v[188:191], a[100:103]
  v_mfma_f32_16x16x32_bf16 a[104:107], v[128:131], v[192:195], a[104:107]
  v_mfma_f32_16x16x32_bf16 a[108:111], v[128:131], v[196:199], a[108:111]
  v_mfma_f32_16x16x32_bf16 a[112:115], v[132:135], v[184:187], a[112:115]
  v_mfma_f32_16x16x32_bf16 a[116:119], v[132:135], v[188:191], a[116:119]
  v_mfma_f32_16x16x32_bf16 a[120:123], v[132:135], v[192:195], a[120:123]
  v_mfma_f32_16x16x32_bf16 a[124:127], v[132:135], v[196:199], a[124:127]
  v_mfma_f32_16x16x32_bf16 a[128:131], v[136:139], v[184:187], a[128:131]
  v_mfma_f32_16x16x32_bf16 a[132:135], v[136:139], v[188:191], a[132:135]
  v_mfma_f32_16x16x32_bf16 a[136:139], v[136:139], v[192:195], a[136:139]
  v_mfma_f32_16x16x32_bf16 a[140:143], v[136:139], v[196:199], a[140:143]
  v_mfma_f32_16x16x32_bf16 a[144:147], v[140:143], v[184:187], a[144:147]
  v_mfma_f32_16x16x32_bf16 a[148:151], v[140:143], v[188:191], a[148:151]
  v_mfma_f32_16x16x32_bf16 a[152:155], v[140:143], v[192:195], a[152:155]
  v_mfma_f32_16x16x32_bf16 a[156:159], v[140:143], v[196:199], a[156:159]
  buffer_load_dwordx4 v[104:107], v1, s[4:7], s30 offen offset:2048
  buffer_load_dwordx4 v[108:111], v1, s[4:7], s31 offen offset:2048
  buffer_load_dwordx4 v[112:115], v1, s[4:7], s32 offen offset:2048
  buffer_load_dwordx4 v[116:119], v1, s[4:7], s33 offen offset:2048
  buffer_load_dwordx4 v[120:123], v1, s[4:7], s34 offen offset:2048
  buffer_load_dwordx4 v[124:127], v1, s[4:7], s35 offen offset:2048
  buffer_load_dwordx4 v[128:131], v1, s[4:7], s36 offen offset:2048
  buffer_load_dwordx4 v[132:135], v1, s[4:7], s37 offen offset:2048
  buffer_load_dwordx4 v[136:139], v1, s[4:7], s38 offen offset:2048
  buffer_load_dwordx4 v[140:143], v1, s[4:7], s39 offen offset:2048
  s_waitcnt vmcnt(30)
  ds_read_b128 v[184:187], v1 offset:20480
  ds_read_b128 v[188:191], v1 offset:45056
  ds_read_b128 v[192:195], v6 offset:20480
  ds_read_b128 v[196:199], v6 offset:45056
  s_waitcnt lgkmcnt(4)
  v_mfma_f32_16x16x32_bf16 a[0:3], v[144:147], v[200:203], a[0:3]
  v_mfma_f32_16x16x32_bf16 a[4:7], v[144:147], v[204:207], a[4:7]
  v_mfma_f32_16x16x32_bf16 a[8:11], v[144:147], v[208:211], a[8:11]
  v_mfma_f32_16x16x32_bf16 a[12:15], v[144:147], v[212:215], a[12:15]
  v_mfma_f32_16x16x32_bf16 a[16:19], v[148:151], v[200:203], a[16:19]
  v_mfma_f32_16x16x32_bf16 a[20:23], v[148:151], v[204:207], a[20:23]
  v_mfma_f32_16x16x32_bf16 a[24:27], v[148:151], v[208:211], a[24:27]
  v_mfma_f32_16x16x32_bf16 a[28:31], v[148:151], v[212:215], a[28:31]
  v_mfma_f32_16x16x32_bf16 a[32:35], v[152:155], v[200:203], a[32:35]
  v_mfma_f32_16x16x32_bf16 a[36:39], v[152:155], v[204:207], a[36:39]
  v_mfma_f32_16x16x32_bf16 a[40:43], v[152:155], v[208:211], a[40:43]
  v_mfma_f32_16x16x32_bf16 a[44:47], v[152:155], v[212:215], a[44:47]
  v_mfma_f32_16x16x32_bf16 a[48:51], v[156:159], v[200:203], a[48:51]
  v_mfma_f32_16x16x32_bf16 a[52:55], v[156:159], v[204:207], a[52:55]
  v_mfma_f32_16x16x32_bf16 a[56:59], v[156:159], v[208:211], a[56:59]
  v_mfma_f32_16x16x32_bf16 a[60:63], v[156:159], v[212:215], a[60:63]
  v_mfma_f32_16x16x32_bf16 a[64:67], v[160:163], v[200:203], a[64:67]
  v_mfma_f32_16x16x32_bf16 a[68:71], v[160:163], v[204:207], a[68:71]
  v_mfma_f32_16x16x32_bf16 a[72:75], v[160:163], v[208:211], a[72:75]
  v_mfma_f32_16x16x32_bf16 a[76:79], v[160:163], v[212:215], a[76:79]
  v_mfma_f32_16x16x32_bf16 a[80:83], v[164:167], v[200:203], a[80:83]
  v_mfma_f32_16x16x32_bf16 a[84:87], v[164:167], v[204:207], a[84:87]
  v_mfma_f32_16x16x32_bf16 a[88:91], v[164:167], v[208:211], a[88:91]
  v_mfma_f32_16x16x32_bf16 a[92:95], v[164:167], v[212:215], a[92:95]
  v_mfma_f32_16x16x32_bf16 a[96:99], v[168:171], v[200:203], a[96:99]
  v_mfma_f32_16x16x32_bf16 a[100:103], v[168:171], v[204:207], a[100:103]
  v_mfma_f32_16x16x32_bf16 a[104:107], v[168:171], v[208:211], a[104:107]
  v_mfma_f32_16x16x32_bf16 a[108:111], v[168:171], v[212:215], a[108:111]
  v_mfma_f32_16x16x32_bf16 a[112:115], v[172:175], v[200:203], a[112:115]
  v_mfma_f32_16x16x32_bf16 a[116:119], v[172:175], v[204:207], a[116:119]
  v_mfma_f32_16x16x32_bf16 a[120:123], v[172:175], v[208:211], a[120:123]
  v_mfma_f32_16x16x32_bf16 a[124:127], v[172:175], v[212:215], a[124:127]
  v_mfma_f32_16x16x32_bf16 a[128:131], v[176:179], v[200:203], a[128:131]
  v_mfma_f32_16x16x32_bf16 a[132:135], v[176:179], v[204:207], a[132:135]
  v_mfma_f32_16x16x32_bf16 a[136:139], v[176:179], v[208:211], a[136:139]
  v_mfma_f32_16x16x32_bf16 a[140:143], v[176:179], v[212:215], a[140:143]
  v_mfma_f32_16x16x32_bf16 a[144:147], v[180:183], v[200:203], a[144:147]
  v_mfma_f32_16x16x32_bf16 a[148:151], v[180:183], v[204:207], a[148:151]
  v_mfma_f32_16x16x32_bf16 a[152:155], v[180:183], v[208:211], a[152:155]
  v_mfma_f32_16x16x32_bf16 a[156:159], v[180:183], v[212:215], a[156:159]
  buffer_load_dwordx4 v[144:147], v1, s[4:7], s30 offen offset:3072
  buffer_load_dwordx4 v[148:151], v1, s[4:7], s31 offen offset:3072
  buffer_load_dwordx4 v[152:155], v1, s[4:7], s32 offen offset:3072
  buffer_load_dwordx4 v[156:159], v1, s[4:7], s33 offen offset:3072
  buffer_load_dwordx4 v[160:163], v1, s[4:7], s34 offen offset:3072
  buffer_load_dwordx4 v[164:167], v1, s[4:7], s35 offen offset:3072
  buffer_load_dwordx4 v[168:171], v1, s[4:7], s36 offen offset:3072
  buffer_load_dwordx4 v[172:175], v1, s[4:7], s37 offen offset:3072
  buffer_load_dwordx4 v[176:179], v1, s[4:7], s38 offen offset:3072
  buffer_load_dwordx4 v[180:183], v1, s[4:7], s39 offen offset:3072
  s_add_u32 s30, s30, 4096
  s_add_u32 s31, s31, 4096
  s_add_u32 s32, s32, 4096
  s_add_u32 s33, s33, 4096
  s_add_u32 s34, s34, 4096
  s_add_u32 s35, s35, 4096
  s_add_u32 s36, s36, 4096
  s_add_u32 s37, s37, 4096
  s_add_u32 s38, s38, 4096
  s_add_u32 s39, s39, 4096
  s_waitcnt vmcnt(30)
  ds_read_b128 v[200:203], v1 offset:21504
  ds_read_b128 v[204:207], v1 offset:46080
  ds_read_b128 v[208:211], v6 offset:21504
  ds_read_b128 v[212:215], v6 offset:46080
  s_waitcnt lgkmcnt(4)
  v_mfma_f32_16x16x32_bf16 a[0:3], v[24:27], v[184:187], a[0:3]
  v_mfma_f32_16x16x32_bf16 a[4:7], v[24:27], v[188:191], a[4:7]
  v_mfma_f32_16x16x32_bf16 a[8:11], v[24:27], v[192:195], a[8:11]
  v_mfma_f32_16x16x32_bf16 a[12:15], v[24:27], v[196:199], a[12:15]
  v_mfma_f32_16x16x32_bf16 a[16:19], v[28:31], v[184:187], a[16:19]
  v_mfma_f32_16x16x32_bf16 a[20:23], v[28:31], v[188:191], a[20:23]
  v_mfma_f32_16x16x32_bf16 a[24:27], v[28:31], v[192:195], a[24:27]
  v_mfma_f32_16x16x32_bf16 a[28:31], v[28:31], v[196:199], a[28:31]
  v_mfma_f32_16x16x32_bf16 a[32:35], v[32:35], v[184:187], a[32:35]
  v_mfma_f32_16x16x32_bf16 a[36:39], v[32:35], v[188:191], a[36:39]
  v_mfma_f32_16x16x32_bf16 a[40:43], v[32:35], v[192:195], a[40:43]
  v_mfma_f32_16x16x32_bf16 a[44:47], v[32:35], v[196:199], a[44:47]
  v_mfma_f32_16x16x32_bf16 a[48:51], v[36:39], v[184:187], a[48:51]
  v_mfma_f32_16x16x32_bf16 a[52:55], v[36:39], v[188:191], a[52:55]
  v_mfma_f32_16x16x32_bf16 a[56:59], v[36:39], v[192:195], a[56:59]
  v_mfma_f32_16x16x32_bf16 a[60:63], v[36:39], v[196:199], a[60:63]
  v_mfma_f32_16x16x32_bf16 a[64:67], v[40:43], v[184:187], a[64:67]
  v_mfma_f32_16x16x32_bf16 a[68:71], v[40:43], v[188:191], a[68:71]
  v_mfma_f32_16x16x32_bf16 a[72:75], v[40:43], v[192:195], a[72:75]
  v_mfma_f32_16x16x32_bf16 a[76:79], v[40:43], v[196:199], a[76:79]
  v_mfma_f32_16x16x32_bf16 a[80:83], v[44:47], v[184:187], a[80:83]
  v_mfma_f32_16x16x32_bf16 a[84:87], v[44:47], v[188:191], a[84:87]
  v_mfma_f32_16x16x32_bf16 a[88:91], v[44:47], v[192:195], a[88:91]
  v_mfma_f32_16x16x32_bf16 a[92:95], v[44:47], v[196:199], a[92:95]
  v_mfma_f32_16x16x32_bf16 a[96:99], v[48:51], v[184:187], a[96:99]
  v_mfma_f32_16x16x32_bf16 a[100:103], v[48:51], v[188:191], a[100:103]
  v_mfma_f32_16x16x32_bf16 a[104:107], v[48:51], v[192:195], a[104:107]
  v_mfma_f32_16x16x32_bf16 a[108:111], v[48:51], v[196:199], a[108:111]
  v_mfma_f32_16x16x32_bf16 a[112:115], v[52:55], v[184:187], a[112:115]
  v_mfma_f32_16x16x32_bf16 a[116:119], v[52:55], v[188:191], a[116:119]
  v_mfma_f32_16x16x32_bf16 a[120:123], v[52:55], v[192:195], a[120:123]
  v_mfma_f32_16x16x32_bf16 a[124:127], v[52:55], v[196:199], a[124:127]
  v_mfma_f32_16x16x32_bf16 a[128:131], v[56:59], v[184:187], a[128:131]
  v_mfma_f32_16x16x32_bf16 a[132:135], v[56:59], v[188:191], a[132:135]
  v_mfma_f32_16x16x32_bf16 a[136:139], v[56:59], v[192:195], a[136:139]
  v_mfma_f32_16x16x32_bf16 a[140:143], v[56:59], v[196:199], a[140:143]
  v_mfma_f32_16x16x32_bf16 a[144:147], v[60:63], v[184:187], a[144:147]
  v_mfma_f32_16x16x32_bf16 a[148:151], v[60:63], v[188:191], a[148:151]
  v_mfma_f32_16x16x32_bf16 a[152:155], v[60:63], v[192:195], a[152:155]
  v_mfma_f32_16x16x32_bf16 a[156:159], v[60:63], v[196:199], a[156:159]
  s_waitcnt vmcnt(20)
  ds_read_b128 v[184:187], v1 offset:22528
  ds_read_b128 v[188:191], v1 offset:47104
  ds_read_b128 v[192:195], v6 offset:22528
  ds_read_b128 v[196:199], v6 offset:47104
  s_waitcnt lgkmcnt(4)
  v_mfma_f32_16x16x32_bf16 a[0:3], v[64:67], v[200:203], a[0:3]
  v_mfma_f32_16x16x32_bf16 a[4:7], v[64:67], v[204:207], a[4:7]
  v_mfma_f32_16x16x32_bf16 a[8:11], v[64:67], v[208:211], a[8:11]
  v_mfma_f32_16x16x32_bf16 a[12:15], v[64:67], v[212:215], a[12:15]
  v_mfma_f32_16x16x32_bf16 a[16:19], v[68:71], v[200:203], a[16:19]
  v_mfma_f32_16x16x32_bf16 a[20:23], v[68:71], v[204:207], a[20:23]
  v_mfma_f32_16x16x32_bf16 a[24:27], v[68:71], v[208:211], a[24:27]
  v_mfma_f32_16x16x32_bf16 a[28:31], v[68:71], v[212:215], a[28:31]
  v_mfma_f32_16x16x32_bf16 a[32:35], v[72:75], v[200:203], a[32:35]
  v_mfma_f32_16x16x32_bf16 a[36:39], v[72:75], v[204:207], a[36:39]
  v_mfma_f32_16x16x32_bf16 a[40:43], v[72:75], v[208:211], a[40:43]
  v_mfma_f32_16x16x32_bf16 a[44:47], v[72:75], v[212:215], a[44:47]
  v_mfma_f32_16x16x32_bf16 a[48:51], v[76:79], v[200:203], a[48:51]
  v_mfma_f32_16x16x32_bf16 a[52:55], v[76:79], v[204:207], a[52:55]
  v_mfma_f32_16x16x32_bf16 a[56:59], v[76:79], v[208:211], a[56:59]
  v_mfma_f32_16x16x32_bf16 a[60:63], v[76:79], v[212:215], a[60:63]
  v_mfma_f32_16x16x32_bf16 a[64:67], v[80:83], v[200:203], a[64:67]
  v_mfma_f32_16x16x32_bf16 a[68:71], v[80:83], v[204:207], a[68:71]
  v_mfma_f32_16x16x32_bf16 a[72:75], v[80:83], v[208:211], a[72:75]
  v_mfma_f32_16x16x32_bf16 a[76:79], v[80:83], v[212:215], a[76:79]
  v_mfma_f32_16x16x32_bf16 a[80:83], v[84:87], v[200:203], a[80:83]
  v_mfma_f32_16x16x32_bf16 a[84:87], v[84:87], v[204:207], a[84:87]
  v_mfma_f32_16x16x32_bf16 a[88:91], v[84:87], v[208:211], a[88:91]
  v_mfma_f32_16x16x32_bf16 a[92:95], v[84:87], v[212:215], a[92:95]
  v_mfma_f32_16x16x32_bf16 a[96:99], v[88:91], v[200:203], a[96:99]
  v_mfma_f32_16x16x32_bf16 a[100:103], v[88:91], v[204:207], a[100:103]
  v_mfma_f32_16x16x32_bf16 a[104:107], v[88:91], v[208:211], a[104:107]
  v_mfma_f32_16x16x32_bf16 a[108:111], v[88:91], v[212:215], a[108:111]
  v_mfma_f32_16x16x32_bf16 a[112:115], v[92:95], v[200:203], a[112:115]
  v_mfma_f32_16x16x32_bf16 a[116:119], v[92:95], v[204:207], a[116:119]
  v_mfma_f32_16x16x32_bf16 a[120:123], v[92:95], v[208:211], a[120:123]
  v_mfma_f32_16x16x32_bf16 a[124:127], v[92:95], v[212:215], a[124:127]
  v_mfma_f32_16x16x32_bf16 a[128:131], v[96:99], v[200:203], a[128:131]
  v_mfma_f32_16x16x32_bf16 a[132:135], v[96:99], v[204:207], a[132:135]
  v_mfma_f32_16x16x32_bf16 a[136:139], v[96:99], v[208:211], a[136:139]
  v_mfma_f32_16x16x32_bf16 a[140:143], v[96:99], v[212:215], a[140:143]
  v_mfma_f32_16x16x32_bf16 a[144:147], v[100:103], v[200:203], a[144:147]
  v_mfma_f32_16x16x32_bf16 a[148:151], v[100:103], v[204:207], a[148:151]
  v_mfma_f32_16x16x32_bf16 a[152:155], v[100:103], v[208:211], a[152:155]
  v_mfma_f32_16x16x32_bf16 a[156:159], v[100:103], v[212:215], a[156:159]
  s_waitcnt vmcnt(10)
  ds_read_b128 v[200:203], v1 offset:23552
  ds_read_b128 v[204:207], v1 offset:48128
  ds_read_b128 v[208:211], v6 offset:23552
  ds_read_b128 v[212:215], v6 offset:48128
  s_waitcnt lgkmcnt(4)
  v_mfma_f32_16x16x32_bf16 a[0:3], v[104:107], v[184:187], a[0:3]
  v_mfma_f32_16x16x32_bf16 a[4:7], v[104:107], v[188:191], a[4:7]
  v_mfma_f32_16x16x32_bf16 a[8:11], v[104:107], v[192:195], a[8:11]
  v_mfma_f32_16x16x32_bf16 a[12:15], v[104:107], v[196:199], a[12:15]
  v_mfma_f32_16x16x32_bf16 a[16:19], v[108:111], v[184:187], a[16:19]
  v_mfma_f32_16x16x32_bf16 a[20:23], v[108:111], v[188:191], a[20:23]
  v_mfma_f32_16x16x32_bf16 a[24:27], v[108:111], v[192:195], a[24:27]
  v_mfma_f32_16x16x32_bf16 a[28:31], v[108:111], v[196:199], a[28:31]
  v_mfma_f32_16x16x32_bf16 a[32:35], v[112:115], v[184:187], a[32:35]
  v_mfma_f32_16x16x32_bf16 a[36:39], v[112:115], v[188:191], a[36:39]
  v_mfma_f32_16x16x32_bf16 a[40:43], v[112:115], v[192:195], a[40:43]
  v_mfma_f32_16x16x32_bf16 a[44:47], v[112:115], v[196:199], a[44:47]
  v_mfma_f32_16x16x32_bf16 a[48:51], v[116:119], v[184:187], a[48:51]
  v_mfma_f32_16x16x32_bf16 a[52:55], v[116:119], v[188:191], a[52:55]
  v_mfma_f32_16x16x32_bf16 a[56:59], v[116:119], v[192:195], a[56:59]
  v_mfma_f32_16x16x32_bf16 a[60:63], v[116:119], v[196:199], a[60:63]
  v_mfma_f32_16x16x32_bf16 a[64:67], v[120:123], v[184:187], a[64:67]
  v_mfma_f32_16x16x32_bf16 a[68:71], v[120:123], v[188:191], a[68:71]
  v_mfma_f32_16x16x32_bf16 a[72:75], v[120:123], v[192:195], a[72:75]
  v_mfma_f32_16x16x32_bf16 a[76:79], v[120:123], v[196:199], a[76:79]
  v_mfma_f32_16x16x32_bf16 a[80:83], v[124:127], v[184:187], a[80:83]
  v_mfma_f32_16x16x32_bf16 a[84:87], v[124:127], v[188:191], a[84:87]
  v_mfma_f32_16x16x32_bf16 a[88:91], v[124:127], v[192:195], a[88:91]
  v_mfma_f32_16x16x32_bf16 a[92:95], v[124:127], v[196:199], a[92:95]
  v_mfma_f32_16x16x32_bf16 a[96:99], v[128:131], v[184:187], a[96:99]
  v_mfma_f32_16x16x32_bf16 a[100:103], v[128:131], v[188:191], a[100:103]
  v_mfma_f32_16x16x32_bf16 a[104:107], v[128:131], v[192:195], a[104:107]
  v_mfma_f32_16x16x32_bf16 a[108:111], v[128:131], v[196:199], a[108:111]
  v_mfma_f32_16x16x32_bf16 a[112:115], v[132:135], v[184:187], a[112:115]
  v_mfma_f32_16x16x32_bf16 a[116:119], v[132:135], v[188:191], a[116:119]
  v_mfma_f32_16x16x32_bf16 a[120:123], v[132:135], v[192:195], a[120:123]
  v_mfma_f32_16x16x32_bf16 a[124:127], v[132:135], v[196:199], a[124:127]
  v_mfma_f32_16x16x32_bf16 a[128:131], v[136:139], v[184:187], a[128:131]
  v_mfma_f32_16x16x32_bf16 a[132:135], v[136:139], v[188:191], a[132:135]
  v_mfma_f32_16x16x32_bf16 a[136:139], v[136:139], v[192:195], a[136:139]
  v_mfma_f32_16x16x32_bf16 a[140:143], v[136:139], v[196:199], a[140:143]
  v_mfma_f32_16x16x32_bf16 a[144:147], v[140:143], v[184:187], a[144:147]
  v_mfma_f32_16x16x32_bf16 a[148:151], v[140:143], v[188:191], a[148:151]
  v_mfma_f32_16x16x32_bf16 a[152:155], v[140:143], v[192:195], a[152:155]
  v_mfma_f32_16x16x32_bf16 a[156:159], v[140:143], v[196:199], a[156:159]
  s_waitcnt vmcnt(0)
  s_waitcnt lgkmcnt(0)
  v_mfma_f32_16x16x32_bf16 a[0:3], v[144:147], v[200:203], a[0:3]
  v_mfma_f32_16x16x32_bf16 a[4:7], v[144:147], v[204:207], a[4:7]
  v_mfma_f32_16x16x32_bf16 a[8:11], v[144:147], v[208:211], a[8:11]
  v_mfma_f32_16x16x32_bf16 a[12:15], v[144:147], v[212:215], a[12:15]
  v_mfma_f32_16x16x32_bf16 a[16:19], v[148:151], v[200:203], a[16:19]
  v_mfma_f32_16x16x32_bf16 a[20:23], v[148:151], v[204:207], a[20:23]
  v_mfma_f32_16x16x32_bf16 a[24:27], v[148:151], v[208:211], a[24:27]
  v_mfma_f32_16x16x32_bf16 a[28:31], v[148:151], v[212:215], a[28:31]
  v_mfma_f32_16x16x32_bf16 a[32:35], v[152:155], v[200:203], a[32:35]
  v_mfma_f32_16x16x32_bf16 a[36:39], v[152:155], v[204:207], a[36:39]
  v_mfma_f32_16x16x32_bf16 a[40:43], v[152:155], v[208:211], a[40:43]
  v_mfma_f32_16x16x32_bf16 a[44:47], v[152:155], v[212:215], a[44:47]
  v_mfma_f32_16x16x32_bf16 a[48:51], v[156:159], v[200:203], a[48:51]
  v_mfma_f32_16x16x32_bf16 a[52:55], v[156:159], v[204:207], a[52:55]
  v_mfma_f32_16x16x32_bf16 a[56:59], v[156:159], v[208:211], a[56:59]
  v_mfma_f32_16x16x32_bf16 a[60:63], v[156:159], v[212:215], a[60:63]
  v_mfma_f32_16x16x32_bf16 a[64:67], v[160:163], v[200:203], a[64:67]
  v_mfma_f32_16x16x32_bf16 a[68:71], v[160:163], v[204:207], a[68:71]
  v_mfma_f32_16x16x32_bf16 a[72:75], v[160:163], v[208:211], a[72:75]
  v_mfma_f32_16x16x32_bf16 a[76:79], v[160:163], v[212:215], a[76:79]
  v_mfma_f32_16x16x32_bf16 a[80:83], v[164:167], v[200:203], a[80:83]
  v_mfma_f32_16x16x32_bf16 a[84:87], v[164:167], v[204:207], a[84:87]
  v_mfma_f32_16x16x32_bf16 a[88:91], v[164:167], v[208:211], a[88:91]
  v_mfma_f32_16x16x32_bf16 a[92:95], v[164:167], v[212:215], a[92:95]
  v_mfma_f32_16x16x32_bf16 a[96:99], v[168:171], v[200:203], a[96:99]
  v_mfma_f32_16x16x32_bf16 a[100:103], v[168:171], v[204:207], a[100:103]
  v_mfma_f32_16x16x32_bf16 a[104:107], v[168:171], v[208:211], a[104:107]
  v_mfma_f32_16x16x32_bf16 a[108:111], v[168:171], v[212:215], a[108:111]
  v_mfma_f32_16x16x32_bf16 a[112:115], v[172:175], v[200:203], a[112:115]
  v_mfma_f32_16x16x32_bf16 a[116:119], v[172:175], v[204:207], a[116:119]
  v_mfma_f32_16x16x32_bf16 a[120:123], v[172:175], v[208:211], a[120:123]
  v_mfma_f32_16x16x32_bf16 a[124:127], v[172:175], v[212:215], a[124:127]
  v_mfma_f32_16x16x32_bf16 a[128:131], v[176:179], v[200:203], a[128:131]
  v_mfma_f32_16x16x32_bf16 a[132:135], v[176:179], v[204:207], a[132:135]
  v_mfma_f32_16x16x32_bf16 a[136:139], v[176:179], v[208:211], a[136:139]
  v_mfma_f32_16x16x32_bf16 a[140:143], v[176:179], v[212:215], a[140:143]
  v_mfma_f32_16x16x32_bf16 a[144:147], v[180:183], v[200:203], a[144:147]
  v_mfma_f32_16x16x32_bf16 a[148:151], v[180:183], v[204:207], a[148:151]
  v_mfma_f32_16x16x32_bf16 a[152:155], v[180:183], v[208:211], a[152:155]
  v_mfma_f32_16x16x32_bf16 a[156:159], v[180:183], v[212:215], a[156:159]
  s_lshl_b32 s16, s13, 7
  s_lshl_b32 s17, s14, 2
  s_add_u32 s16, s16, s17
  s_mul_i32 s16, s16, 20
  s_mul_i32 s17, s12, 5
  s_add_u32 s16, s16, s17
  s_lshl_b32 s16, s16, 10
  s_add_u32 s16, s16, 95420416
  s_nop 7
  s_add_u32 s17, s16, 0
  v_accvgpr_read_b32 v24, a0
  v_accvgpr_read_b32 v25, a1
  v_accvgpr_read_b32 v26, a2
  v_accvgpr_read_b32 v27, a3
  v_accvgpr_read_b32 v28, a16
  v_accvgpr_read_b32 v29, a17
  v_accvgpr_read_b32 v30, a18
  v_accvgpr_read_b32 v31, a19
  v_cvt_pk_bf16_f32 v32, v24, v25
  v_cvt_pk_bf16_f32 v33, v26, v27
  v_cvt_pk_bf16_f32 v34, v28, v29
  v_cvt_pk_bf16_f32 v35, v30, v31
  buffer_store_dwordx4 v[32:35], v1, s[4:7], s17 offen offset:0 sc1
  v_accvgpr_read_b32 v36, a32
  v_accvgpr_read_b32 v37, a33
  v_accvgpr_read_b32 v38, a34
  v_accvgpr_read_b32 v39, a35
  v_accvgpr_read_b32 v40, a48
  v_accvgpr_read_b32 v41, a49
  v_accvgpr_read_b32 v42, a50
  v_accvgpr_read_b32 v43, a51
  v_cvt_pk_bf16_f32 v44, v36, v37
  v_cvt_pk_bf16_f32 v45, v38, v39
  v_cvt_pk_bf16_f32 v46, v40, v41
  v_cvt_pk_bf16_f32 v47, v42, v43
  buffer_store_dwordx4 v[44:47], v1, s[4:7], s17 offen offset:1024 sc1
  v_accvgpr_read_b32 v48, a64
  v_accvgpr_read_b32 v49, a65
  v_accvgpr_read_b32 v50, a66
  v_accvgpr_read_b32 v51, a67
  v_accvgpr_read_b32 v52, a80
  v_accvgpr_read_b32 v53, a81
  v_accvgpr_read_b32 v54, a82
  v_accvgpr_read_b32 v55, a83
  v_cvt_pk_bf16_f32 v56, v48, v49
  v_cvt_pk_bf16_f32 v57, v50, v51
  v_cvt_pk_bf16_f32 v58, v52, v53
  v_cvt_pk_bf16_f32 v59, v54, v55
  buffer_store_dwordx4 v[56:59], v1, s[4:7], s17 offen offset:2048 sc1
  v_accvgpr_read_b32 v60, a96
  v_accvgpr_read_b32 v61, a97
  v_accvgpr_read_b32 v62, a98
  v_accvgpr_read_b32 v63, a99
  v_accvgpr_read_b32 v64, a112
  v_accvgpr_read_b32 v65, a113
  v_accvgpr_read_b32 v66, a114
  v_accvgpr_read_b32 v67, a115
  v_cvt_pk_bf16_f32 v68, v60, v61
  v_cvt_pk_bf16_f32 v69, v62, v63
  v_cvt_pk_bf16_f32 v70, v64, v65
  v_cvt_pk_bf16_f32 v71, v66, v67
  buffer_store_dwordx4 v[68:71], v1, s[4:7], s17 offen offset:3072 sc1
  v_accvgpr_read_b32 v24, a128
  v_accvgpr_read_b32 v25, a129
  v_accvgpr_read_b32 v26, a130
  v_accvgpr_read_b32 v27, a131
  v_accvgpr_read_b32 v28, a144
  v_accvgpr_read_b32 v29, a145
  v_accvgpr_read_b32 v30, a146
  v_accvgpr_read_b32 v31, a147
  v_cvt_pk_bf16_f32 v32, v24, v25
  v_cvt_pk_bf16_f32 v33, v26, v27
  v_cvt_pk_bf16_f32 v34, v28, v29
  v_cvt_pk_bf16_f32 v35, v30, v31
  s_add_u32 s17, s17, 4096
  buffer_store_dwordx4 v[32:35], v1, s[4:7], s17 offen offset:0 sc1
  s_add_u32 s17, s16, 20480
  v_accvgpr_read_b32 v36, a4
  v_accvgpr_read_b32 v37, a5
  v_accvgpr_read_b32 v38, a6
  v_accvgpr_read_b32 v39, a7
  v_accvgpr_read_b32 v40, a20
  v_accvgpr_read_b32 v41, a21
  v_accvgpr_read_b32 v42, a22
  v_accvgpr_read_b32 v43, a23
  v_cvt_pk_bf16_f32 v44, v36, v37
  v_cvt_pk_bf16_f32 v45, v38, v39
  v_cvt_pk_bf16_f32 v46, v40, v41
  v_cvt_pk_bf16_f32 v47, v42, v43
  buffer_store_dwordx4 v[44:47], v1, s[4:7], s17 offen offset:0 sc1
  v_accvgpr_read_b32 v48, a36
  v_accvgpr_read_b32 v49, a37
  v_accvgpr_read_b32 v50, a38
  v_accvgpr_read_b32 v51, a39
  v_accvgpr_read_b32 v52, a52
  v_accvgpr_read_b32 v53, a53
  v_accvgpr_read_b32 v54, a54
  v_accvgpr_read_b32 v55, a55
  v_cvt_pk_bf16_f32 v56, v48, v49
  v_cvt_pk_bf16_f32 v57, v50, v51
  v_cvt_pk_bf16_f32 v58, v52, v53
  v_cvt_pk_bf16_f32 v59, v54, v55
  buffer_store_dwordx4 v[56:59], v1, s[4:7], s17 offen offset:1024 sc1
  v_accvgpr_read_b32 v60, a68
  v_accvgpr_read_b32 v61, a69
  v_accvgpr_read_b32 v62, a70
  v_accvgpr_read_b32 v63, a71
  v_accvgpr_read_b32 v64, a84
  v_accvgpr_read_b32 v65, a85
  v_accvgpr_read_b32 v66, a86
  v_accvgpr_read_b32 v67, a87
  v_cvt_pk_bf16_f32 v68, v60, v61
  v_cvt_pk_bf16_f32 v69, v62, v63
  v_cvt_pk_bf16_f32 v70, v64, v65
  v_cvt_pk_bf16_f32 v71, v66, v67
  buffer_store_dwordx4 v[68:71], v1, s[4:7], s17 offen offset:2048 sc1
  v_accvgpr_read_b32 v24, a100
  v_accvgpr_read_b32 v25, a101
  v_accvgpr_read_b32 v26, a102
  v_accvgpr_read_b32 v27, a103
  v_accvgpr_read_b32 v28, a116
  v_accvgpr_read_b32 v29, a117
  v_accvgpr_read_b32 v30, a118
  v_accvgpr_read_b32 v31, a119
  v_cvt_pk_bf16_f32 v32, v24, v25
  v_cvt_pk_bf16_f32 v33, v26, v27
  v_cvt_pk_bf16_f32 v34, v28, v29
  v_cvt_pk_bf16_f32 v35, v30, v31
  buffer_store_dwordx4 v[32:35], v1, s[4:7], s17 offen offset:3072 sc1
  v_accvgpr_read_b32 v36, a132
  v_accvgpr_read_b32 v37, a133
  v_accvgpr_read_b32 v38, a134
  v_accvgpr_read_b32 v39, a135
  v_accvgpr_read_b32 v40, a148
  v_accvgpr_read_b32 v41, a149
  v_accvgpr_read_b32 v42, a150
  v_accvgpr_read_b32 v43, a151
  v_cvt_pk_bf16_f32 v44, v36, v37
  v_cvt_pk_bf16_f32 v45, v38, v39
  v_cvt_pk_bf16_f32 v46, v40, v41
  v_cvt_pk_bf16_f32 v47, v42, v43
  s_add_u32 s17, s17, 4096
  buffer_store_dwordx4 v[44:47], v1, s[4:7], s17 offen offset:0 sc1
  s_add_u32 s17, s16, 40960
  v_accvgpr_read_b32 v48, a8
  v_accvgpr_read_b32 v49, a9
  v_accvgpr_read_b32 v50, a10
  v_accvgpr_read_b32 v51, a11
  v_accvgpr_read_b32 v52, a24
  v_accvgpr_read_b32 v53, a25
  v_accvgpr_read_b32 v54, a26
  v_accvgpr_read_b32 v55, a27
  v_cvt_pk_bf16_f32 v56, v48, v49
  v_cvt_pk_bf16_f32 v57, v50, v51
  v_cvt_pk_bf16_f32 v58, v52, v53
  v_cvt_pk_bf16_f32 v59, v54, v55
  buffer_store_dwordx4 v[56:59], v1, s[4:7], s17 offen offset:0 sc1
  v_accvgpr_read_b32 v60, a40
  v_accvgpr_read_b32 v61, a41
  v_accvgpr_read_b32 v62, a42
  v_accvgpr_read_b32 v63, a43
  v_accvgpr_read_b32 v64, a56
  v_accvgpr_read_b32 v65, a57
  v_accvgpr_read_b32 v66, a58
  v_accvgpr_read_b32 v67, a59
  v_cvt_pk_bf16_f32 v68, v60, v61
  v_cvt_pk_bf16_f32 v69, v62, v63
  v_cvt_pk_bf16_f32 v70, v64, v65
  v_cvt_pk_bf16_f32 v71, v66, v67
  buffer_store_dwordx4 v[68:71], v1, s[4:7], s17 offen offset:1024 sc1
  v_accvgpr_read_b32 v24, a72
  v_accvgpr_read_b32 v25, a73
  v_accvgpr_read_b32 v26, a74
  v_accvgpr_read_b32 v27, a75
  v_accvgpr_read_b32 v28, a88
  v_accvgpr_read_b32 v29, a89
  v_accvgpr_read_b32 v30, a90
  v_accvgpr_read_b32 v31, a91
  v_cvt_pk_bf16_f32 v32, v24, v25
  v_cvt_pk_bf16_f32 v33, v26, v27
  v_cvt_pk_bf16_f32 v34, v28, v29
  v_cvt_pk_bf16_f32 v35, v30, v31
  buffer_store_dwordx4 v[32:35], v1, s[4:7], s17 offen offset:2048 sc1
  v_accvgpr_read_b32 v36, a104
  v_accvgpr_read_b32 v37, a105
  v_accvgpr_read_b32 v38, a106
  v_accvgpr_read_b32 v39, a107
  v_accvgpr_read_b32 v40, a120
  v_accvgpr_read_b32 v41, a121
  v_accvgpr_read_b32 v42, a122
  v_accvgpr_read_b32 v43, a123
  v_cvt_pk_bf16_f32 v44, v36, v37
  v_cvt_pk_bf16_f32 v45, v38, v39
  v_cvt_pk_bf16_f32 v46, v40, v41
  v_cvt_pk_bf16_f32 v47, v42, v43
  buffer_store_dwordx4 v[44:47], v1, s[4:7], s17 offen offset:3072 sc1
  v_accvgpr_read_b32 v48, a136
  v_accvgpr_read_b32 v49, a137
  v_accvgpr_read_b32 v50, a138
  v_accvgpr_read_b32 v51, a139
  v_accvgpr_read_b32 v52, a152
  v_accvgpr_read_b32 v53, a153
  v_accvgpr_read_b32 v54, a154
  v_accvgpr_read_b32 v55, a155
  v_cvt_pk_bf16_f32 v56, v48, v49
  v_cvt_pk_bf16_f32 v57, v50, v51
  v_cvt_pk_bf16_f32 v58, v52, v53
  v_cvt_pk_bf16_f32 v59, v54, v55
  s_add_u32 s17, s17, 4096
  buffer_store_dwordx4 v[56:59], v1, s[4:7], s17 offen offset:0 sc1
  s_add_u32 s17, s16, 61440
  v_accvgpr_read_b32 v60, a12
  v_accvgpr_read_b32 v61, a13
  v_accvgpr_read_b32 v62, a14
  v_accvgpr_read_b32 v63, a15
  v_accvgpr_read_b32 v64, a28
  v_accvgpr_read_b32 v65, a29
  v_accvgpr_read_b32 v66, a30
  v_accvgpr_read_b32 v67, a31
  v_cvt_pk_bf16_f32 v68, v60, v61
  v_cvt_pk_bf16_f32 v69, v62, v63
  v_cvt_pk_bf16_f32 v70, v64, v65
  v_cvt_pk_bf16_f32 v71, v66, v67
  buffer_store_dwordx4 v[68:71], v1, s[4:7], s17 offen offset:0 sc1
  v_accvgpr_read_b32 v24, a44
  v_accvgpr_read_b32 v25, a45
  v_accvgpr_read_b32 v26, a46
  v_accvgpr_read_b32 v27, a47
  v_accvgpr_read_b32 v28, a60
  v_accvgpr_read_b32 v29, a61
  v_accvgpr_read_b32 v30, a62
  v_accvgpr_read_b32 v31, a63
  v_cvt_pk_bf16_f32 v32, v24, v25
  v_cvt_pk_bf16_f32 v33, v26, v27
  v_cvt_pk_bf16_f32 v34, v28, v29
  v_cvt_pk_bf16_f32 v35, v30, v31
  buffer_store_dwordx4 v[32:35], v1, s[4:7], s17 offen offset:1024 sc1
  v_accvgpr_read_b32 v36, a76
  v_accvgpr_read_b32 v37, a77
  v_accvgpr_read_b32 v38, a78
  v_accvgpr_read_b32 v39, a79
  v_accvgpr_read_b32 v40, a92
  v_accvgpr_read_b32 v41, a93
  v_accvgpr_read_b32 v42, a94
  v_accvgpr_read_b32 v43, a95
  v_cvt_pk_bf16_f32 v44, v36, v37
  v_cvt_pk_bf16_f32 v45, v38, v39
  v_cvt_pk_bf16_f32 v46, v40, v41
  v_cvt_pk_bf16_f32 v47, v42, v43
  buffer_store_dwordx4 v[44:47], v1, s[4:7], s17 offen offset:2048 sc1
  v_accvgpr_read_b32 v48, a108
  v_accvgpr_read_b32 v49, a109
  v_accvgpr_read_b32 v50, a110
  v_accvgpr_read_b32 v51, a111
  v_accvgpr_read_b32 v52, a124
  v_accvgpr_read_b32 v53, a125
  v_accvgpr_read_b32 v54, a126
  v_accvgpr_read_b32 v55, a127
  v_cvt_pk_bf16_f32 v56, v48, v49
  v_cvt_pk_bf16_f32 v57, v50, v51
  v_cvt_pk_bf16_f32 v58, v52, v53
  v_cvt_pk_bf16_f32 v59, v54, v55
  buffer_store_dwordx4 v[56:59], v1, s[4:7], s17 offen offset:3072 sc1
  v_accvgpr_read_b32 v60, a140
  v_accvgpr_read_b32 v61, a141
  v_accvgpr_read_b32 v62, a142
  v_accvgpr_read_b32 v63, a143
  v_accvgpr_read_b32 v64, a156
  v_accvgpr_read_b32 v65, a157
  v_accvgpr_read_b32 v66, a158
  v_accvgpr_read_b32 v67, a159
  v_cvt_pk_bf16_f32 v68, v60, v61
  v_cvt_pk_bf16_f32 v69, v62, v63
  v_cvt_pk_bf16_f32 v70, v64, v65
  v_cvt_pk_bf16_f32 v71, v66, v67
  s_add_u32 s17, s17, 4096
  buffer_store_dwordx4 v[68:71], v1, s[4:7], s17 offen offset:0 sc1
fin_exit1:
  s_endpgm
.globl redln1_kernel
.p2align 8
.type redln1_kernel,@function
redln1_kernel:
  s_cmp_ge_u32 s2, 128
  s_cbranch_scc1 redln1_exit1
  s_load_dwordx2 s[12:13], s[0:1], 96
  s_load_dwordx2 s[14:15], s[0:1], 0
  v_lshrrev_b32 v2, 6, v0
  s_nop 0
  v_readfirstlane_b32 s16, v2
  s_waitcnt lgkmcnt(0)
  s_mov_b32 s4, s12
  s_mov_b32 s5, s13
  s_mov_b32 s6, 0x10000000
  s_mov_b32 s7, 0x20000
  s_mov_b32 s8, s14
  s_mov_b32 s9, s15
  s_mov_b32 s10, 2621440
  s_mov_b32 s11, 0x20000
  s_mov_b32 s20, 0
  s_mov_b32 s19, s2
  v_and_b32 v3, 63, v0
  v_lshlrev_b32 v14, 4, v3
  v_and_b32 v2, 15, v3
  v_lshrrev_b32 v4, 4, v3
  s_lshl_b32 s17, s19, 4
  v_add_u32 v15, s17, v2
  v_mul_u32_u24 v15, 1280, v15
  v_lshl_add_u32 v15, v4, 4, v15
  s_mul_i32 s17, s16, 320
  s_add_u32 s20, s20, s17
  s_add_u32 s21, s17, 84934656
  s_mul_i32 s22, s19, 20
  s_mul_i32 s23, s16, 5
  s_add_u32 s22, s22, s23
  s_lshl_b32 s22, s22, 10
  s_add_u32 s22, s22, 95420416
  s_add_u32 s24, s22, 0
  s_add_u32 s25, s22, 2621440
  s_add_u32 s26, s22, 5242880
  s_add_u32 s27, s22, 7864320
  s_add_u32 s28, s22, 10485760
  s_add_u32 s29, s22, 13107200
  s_add_u32 s30, s22, 15728640
  s_add_u32 s31, s22, 18350080
  v_add_u32 v6, 0x1000, v14
  buffer_load_dwordx4 v[16:19], v15, s[8:11], s20 offen offset:0
  buffer_load_dwordx4 v[20:23], v15, s[8:11], s20 offen offset:64
  buffer_load_dwordx4 v[24:27], v15, s[8:11], s20 offen offset:128
  buffer_load_dwordx4 v[28:31], v15, s[8:11], s20 offen offset:192
  buffer_load_dwordx4 v[32:35], v15, s[8:11], s20 offen offset:256
  buffer_load_dwordx4 v[80:83], v14, s[4:7], s24 offen offset:0
  buffer_load_dwordx4 v[84:87], v14, s[4:7], s25 offen offset:0
  buffer_load_dwordx4 v[88:91], v14, s[4:7], s26 offen offset:0
  buffer_load_dwordx4 v[92:95], v14, s[4:7], s27 offen offset:0
  buffer_load_dwordx4 v[96:99], v14, s[4:7], s28 offen offset:0
  buffer_load_dwordx4 v[100:103], v14, s[4:7], s29 offen offset:0
  buffer_load_dwordx4 v[104:107], v14, s[4:7], s30 offen offset:0
  buffer_load_dwordx4 v[108:111], v14, s[4:7], s31 offen offset:0
  buffer_load_dwordx4 v[112:115], v14, s[4:7], s24 offen offset:1024
  buffer_load_dwordx4 v[116:119], v14, s[4:7], s25 offen offset:1024
  buffer_load_dwordx4 v[120:123], v14, s[4:7], s26 offen offset:1024
  buffer_load_dwordx4 v[124:127], v14, s[4:7], s27 offen offset:1024
  buffer_load_dwordx4 v[128:131], v14, s[4:7], s28 offen offset:1024
  buffer_load_dwordx4 v[132:135], v14, s[4:7], s29 offen offset:1024
  buffer_load_dwordx4 v[136:139], v14, s[4:7], s30 offen offset:1024
  buffer_load_dwordx4 v[140:143], v14, s[4:7], s31 offen offset:1024
  buffer_load_dwordx4 v[144:147], v14, s[4:7], s24 offen offset:2048
  buffer_load_dwordx4 v[148:151], v14, s[4:7], s25 offen offset:2048
  buffer_load_dwordx4 v[152:155], v14, s[4:7], s26 offen offset:2048
  buffer_load_dwordx4 v[156:159], v14, s[4:7], s27 offen offset:2048
  buffer_load_dwordx4 v[160:163], v14, s[4:7], s28 offen offset:2048
  buffer_load_dwordx4 v[164:167], v14, s[4:7], s29 offen offset:2048
  buffer_load_dwordx4 v[168:171], v14, s[4:7], s30 offen offset:2048
  buffer_load_dwordx4 v[172:175], v14, s[4:7], s31 offen offset:2048
  buffer_load_dwordx4 v[176:179], v14, s[4:7], s24 offen offset:3072
  buffer_load_dwordx4 v[180:183], v14, s[4:7], s25 offen offset:3072
  buffer_load_dwordx4 v[184:187], v14, s[4:7], s26 offen offset:3072
  buffer_load_dwordx4 v[188:191], v14, s[4:7], s27 offen offset:3072
  buffer_load_dwordx4 v[192:195], v14, s[4:7], s28 offen offset:3072
  buffer_load_dwordx4 v[196:199], v14, s[4:7], s29 offen offset:3072
  buffer_load_dwordx4 v[200:203], v14, s[4:7], s30 offen offset:3072
  buffer_load_dwordx4 v[204:207], v14, s[4:7], s31 offen offset:3072
  buffer_load_dwordx4 v[208:211], v6, s[4:7], s24 offen offset:0
  buffer_load_dwordx4 v[212:215], v6, s[4:7], s25 offen offset:0
  buffer_load_dwordx4 v[216:219], v6, s[4:7], s26 offen offset:0
  buffer_load_dwordx4 v[220:223], v6, s[4:7], s27 offen offset:0
  buffer_load_dwordx4 v[224:227], v6, s[4:7], s28 offen offset:0
  buffer_load_dwordx4 v[228:231], v6, s[4:7], s29 offen offset:0
  buffer_load_dwordx4 v[232:235], v6, s[4:7], s30 offen offset:0
  buffer_load_dwordx4 v[236:239], v6, s[4:7], s31 offen offset:0
  s_waitcnt vmcnt(32)
  v_lshlrev_b32 v36, 16, v80
  v_and_b32 v37, 0xffff0000, v80
  v_lshlrev_b32 v38, 16, v81
  v_and_b32 v39, 0xffff0000, v81
  v_lshlrev_b32 v40, 16, v82
  v_and_b32 v41, 0xffff0000, v82
  v_lshlrev_b32 v42, 16, v83
  v_and_b32 v43, 0xffff0000, v83
  v_lshlrev_b32 v8, 16, v84
  v_and_b32 v9, 0xffff0000, v84
  v_pk_add_f32 v[36:37], v[36:37], v[8:9]
  v_lshlrev_b32 v8, 16, v85
  v_and_b32 v9, 0xffff0000, v85
  v_pk_add_f32 v[38:39], v[38:39], v[8:9]
  v_lshlrev_b32 v8, 16, v86
  v_and_b32 v9, 0xffff0000, v86
  v_pk_add_f32 v[40:41], v[40:41], v[8:9]
  v_lshlrev_b32 v8, 16, v87
  v_and_b32 v9, 0xffff0000, v87
  v_pk_add_f32 v[42:43], v[42:43], v[8:9]
  v_lshlrev_b32 v8, 16, v88
  v_and_b32 v9, 0xffff0000, v88
  v_pk_add_f32 v[36:37], v[36:37], v[8:9]
  v_lshlrev_b32 v8, 16, v89
  v_and_b32 v9, 0xffff0000, v89
  v_pk_add_f32 v[38:39], v[38:39], v[8:9]
  v_lshlrev_b32 v8, 16, v90
  v_and_b32 v9, 0xffff0000, v90
  v_pk_add_f32 v[40:41], v[40:41], v[8:9]
  v_lshlrev_b32 v8, 16, v91
  v_and_b32 v9, 0xffff0000, v91
  v_pk_add_f32 v[42:43], v[42:43], v[8:9]
  v_lshlrev_b32 v8, 16, v92
  v_and_b32 v9, 0xffff0000, v92
  v_pk_add_f32 v[36:37], v[36:37], v[8:9]
  v_lshlrev_b32 v8, 16, v93
  v_and_b32 v9, 0xffff0000, v93
  v_pk_add_f32 v[38:39], v[38:39], v[8:9]
  v_lshlrev_b32 v8, 16, v94
  v_and_b32 v9, 0xffff0000, v94
  v_pk_add_f32 v[40:41], v[40:41], v[8:9]
  v_lshlrev_b32 v8, 16, v95
  v_and_b32 v9, 0xffff0000, v95
  v_pk_add_f32 v[42:43], v[42:43], v[8:9]
  v_lshlrev_b32 v8, 16, v96
  v_and_b32 v9, 0xffff0000, v96
  v_pk_add_f32 v[36:37], v[36:37], v[8:9]
  v_lshlrev_b32 v8, 16, v97
  v_and_b32 v9, 0xffff0000, v97
  v_pk_add_f32 v[38:39], v[38:39], v[8:9]
  v_lshlrev_b32 v8, 16, v98
  v_and_b32 v9, 0xffff0000, v98
  v_pk_add_f32 v[40:41], v[40:41], v[8:9]
  v_lshlrev_b32 v8, 16, v99
  v_and_b32 v9, 0xffff0000, v99
  v_pk_add_f32 v[42:43], v[42:43], v[8:9]
  v_lshlrev_b32 v8, 16, v100
  v_and_b32 v9, 0xffff0000, v100
  v_pk_add_f32 v[36:37], v[36:37], v[8:9]
  v_lshlrev_b32 v8, 16, v101
  v_and_b32 v9, 0xffff0000, v101
  v_pk_add_f32 v[38:39], v[38:39], v[8:9]
  v_lshlrev_b32 v8, 16, v102
  v_and_b32 v9, 0xffff0000, v102
  v_pk_add_f32 v[40:41], v[40:41], v[8:9]
  v_lshlrev_b32 v8, 16, v103
  v_and_b32 v9, 0xffff0000, v103
  v_pk_add_f32 v[42:43], v[42:43], v[8:9]
  v_lshlrev_b32 v8, 16, v104
  v_and_b32 v9, 0xffff0000, v104
  v_pk_add_f32 v[36:37], v[36:37], v[8:9]
  v_lshlrev_b32 v8, 16, v105
  v_and_b32 v9, 0xffff0000, v105
  v_pk_add_f32 v[38:39], v[38:39], v[8:9]
  v_lshlrev_b32 v8, 16, v106
  v_and_b32 v9, 0xffff0000, v106
  v_pk_add_f32 v[40:41], v[40:41], v[8:9]
  v_lshlrev_b32 v8, 16, v107
  v_and_b32 v9, 0xffff0000, v107
  v_pk_add_f32 v[42:43], v[42:43], v[8:9]
  v_lshlrev_b32 v8, 16, v108
  v_and_b32 v9, 0xffff0000, v108
  v_pk_add_f32 v[36:37], v[36:37], v[8:9]
  v_lshlrev_b32 v8, 16, v109
  v_and_b32 v9, 0xffff0000, v109
  v_pk_add_f32 v[38:39], v[38:39], v[8:9]
  v_lshlrev_b32 v8, 16, v110
  v_and_b32 v9, 0xffff0000, v110
  v_pk_add_f32 v[40:41], v[40:41], v[8:9]
  v_lshlrev_b32 v8, 16, v111
  v_and_b32 v9, 0xffff0000, v111
  v_pk_add_f32 v[42:43], v[42:43], v[8:9]
  v_cvt_pk_bf16_f32 v8, v36, v37
  v_lshlrev_b32 v36, 16, v8
  v_and_b32 v37, 0xffff0000, v8
  v_lshlrev_b32 v10, 16, v16
  v_and_b32 v11, 0xffff0000, v16
  v_pk_add_f32 v[36:37], v[36:37], v[10:11]
  v_cvt_pk_bf16_f32 v16, v36, v37
  v_lshlrev_b32 v36, 16, v16
  v_and_b32 v37, 0xffff0000, v16
  v_cvt_pk_bf16_f32 v8, v38, v39
  v_lshlrev_b32 v38, 16, v8
  v_and_b32 v39, 0xffff0000, v8
  v_lshlrev_b32 v10, 16, v17
  v_and_b32 v11, 0xffff0000, v17
  v_pk_add_f32 v[38:39], v[38:39], v[10:11]
  v_cvt_pk_bf16_f32 v17, v38, v39
  v_lshlrev_b32 v38, 16, v17
  v_and_b32 v39, 0xffff0000, v17
  v_cvt_pk_bf16_f32 v8, v40, v41
  v_lshlrev_b32 v40, 16, v8
  v_and_b32 v41, 0xffff0000, v8
  v_lshlrev_b32 v10, 16, v18
  v_and_b32 v11, 0xffff0000, v18
  v_pk_add_f32 v[40:41], v[40:41], v[10:11]
  v_cvt_pk_bf16_f32 v18, v40, v41
  v_lshlrev_b32 v40, 16, v18
  v_and_b32 v41, 0xffff0000, v18
  v_cvt_pk_bf16_f32 v8, v42, v43
  v_lshlrev_b32 v42, 16, v8
  v_and_b32 v43, 0xffff0000, v8
  v_lshlrev_b32 v10, 16, v19
  v_and_b32 v11, 0xffff0000, v19
  v_pk_add_f32 v[42:43], v[42:43], v[10:11]
  v_cvt_pk_bf16_f32 v19, v42, v43
  v_lshlrev_b32 v42, 16, v19
  v_and_b32 v43, 0xffff0000, v19
  buffer_store_dwordx4 v[16:19], v15, s[4:7], s21 offen offset:0 sc1
  s_waitcnt vmcnt(25)
  v_lshlrev_b32 v44, 16, v112
  v_and_b32 v45, 0xffff0000, v112
  v_lshlrev_b32 v46, 16, v113
  v_and_b32 v47, 0xffff0000, v113
  v_lshlrev_b32 v48, 16, v114
  v_and_b32 v49, 0xffff0000, v114
  v_lshlrev_b32 v50, 16, v115
  v_and_b32 v51, 0xffff0000, v115
  v_lshlrev_b32 v8, 16, v116
  v_and_b32 v9, 0xffff0000, v116
  v_pk_add_f32 v[44:45], v[44:45], v[8:9]
  v_lshlrev_b32 v8, 16, v117
  v_and_b32 v9, 0xffff0000, v117
  v_pk_add_f32 v[46:47], v[46:47], v[8:9]
  v_lshlrev_b32 v8, 16, v118
  v_and_b32 v9, 0xffff0000, v118
  v_pk_add_f32 v[48:49], v[48:49], v[8:9]
  v_lshlrev_b32 v8, 16, v119
  v_and_b32 v9, 0xffff0000, v119
  v_pk_add_f32 v[50:51], v[50:51], v[8:9]
  v_lshlrev_b32 v8, 16, v120
  v_and_b32 v9, 0xffff0000, v120
  v_pk_add_f32 v[44:45], v[44:45], v[8:9]
  v_lshlrev_b32 v8, 16, v121
  v_and_b32 v9, 0xffff0000, v121
  v_pk_add_f32 v[46:47], v[46:47], v[8:9]
  v_lshlrev_b32 v8, 16, v122
  v_and_b32 v9, 0xffff0000, v122
  v_pk_add_f32 v[48:49], v[48:49], v[8:9]
  v_lshlrev_b32 v8, 16, v123
  v_and_b32 v9, 0xffff0000, v123
  v_pk_add_f32 v[50:51], v[50:51], v[8:9]
  v_lshlrev_b32 v8, 16, v124
  v_and_b32 v9, 0xffff0000, v124
  v_pk_add_f32 v[44:45], v[44:45], v[8:9]
  v_lshlrev_b32 v8, 16, v125
  v_and_b32 v9, 0xffff0000, v125
  v_pk_add_f32 v[46:47], v[46:47], v[8:9]
  v_lshlrev_b32 v8, 16, v126
  v_and_b32 v9, 0xffff0000, v126
  v_pk_add_f32 v[48:49], v[48:49], v[8:9]
  v_lshlrev_b32 v8, 16, v127
  v_and_b32 v9, 0xffff0000, v127
  v_pk_add_f32 v[50:51], v[50:51], v[8:9]
  v_lshlrev_b32 v8, 16, v128
  v_and_b32 v9, 0xffff0000, v128
  v_pk_add_f32 v[44:45], v[44:45], v[8:9]
  v_lshlrev_b32 v8, 16, v129
  v_and_b32 v9, 0xffff0000, v129
  v_pk_add_f32 v[46:47], v[46:47], v[8:9]
  v_lshlrev_b32 v8, 16, v130
  v_and_b32 v9, 0xffff0000, v130
  v_pk_add_f32 v[48:49], v[48:49], v[8:9]
  v_lshlrev_b32 v8, 16, v131
  v_and_b32 v9, 0xffff0000, v131
  v_pk_add_f32 v[50:51], v[50:51], v[8:9]
  v_lshlrev_b32 v8, 16, v132
  v_and_b32 v9, 0xffff0000, v132
  v_pk_add_f32 v[44:45], v[44:45], v[8:9]
  v_lshlrev_b32 v8, 16, v133
  v_and_b32 v9, 0xffff0000, v133
  v_pk_add_f32 v[46:47], v[46:47], v[8:9]
  v_lshlrev_b32 v8, 16, v134
  v_and_b32 v9, 0xffff0000, v134
  v_pk_add_f32 v[48:49], v[48:49], v[8:9]
  v_lshlrev_b32 v8, 16, v135
  v_and_b32 v9, 0xffff0000, v135
  v_pk_add_f32 v[50:51], v[50:51], v[8:9]
  v_lshlrev_b32 v8, 16, v136
  v_and_b32 v9, 0xffff0000, v136
  v_pk_add_f32 v[44:45], v[44:45], v[8:9]
  v_lshlrev_b32 v8, 16, v137
  v_and_b32 v9, 0xffff0000, v137
  v_pk_add_f32 v[46:47], v[46:47], v[8:9]
  v_lshlrev_b32 v8, 16, v138
  v_and_b32 v9, 0xffff0000, v138
  v_pk_add_f32 v[48:49], v[48:49], v[8:9]
  v_lshlrev_b32 v8, 16, v139
  v_and_b32 v9, 0xffff0000, v139
  v_pk_add_f32 v[50:51], v[50:51], v[8:9]
  v_lshlrev_b32 v8, 16, v140
  v_and_b32 v9, 0xffff0000, v140
  v_pk_add_f32 v[44:45], v[44:45], v[8:9]
  v_lshlrev_b32 v8, 16, v141
  v_and_b32 v9, 0xffff0000, v141
  v_pk_add_f32 v[46:47], v[46:47], v[8:9]
  v_lshlrev_b32 v8, 16, v142
  v_and_b32 v9, 0xffff0000, v142
  v_pk_add_f32 v[48:49], v[48:49], v[8:9]
  v_lshlrev_b32 v8, 16, v143
  v_and_b32 v9, 0xffff0000, v143
  v_pk_add_f32 v[50:51], v[50:51], v[8:9]
  v_cvt_pk_bf16_f32 v8, v44, v45
  v_lshlrev_b32 v44, 16, v8
  v_and_b32 v45, 0xffff0000, v8
  v_lshlrev_b32 v10, 16, v20
  v_and_b32 v11, 0xffff0000, v20
  v_pk_add_f32 v[44:45], v[44:45], v[10:11]
  v_cvt_pk_bf16_f32 v20, v44, v45
  v_lshlrev_b32 v44, 16, v20
  v_and_b32 v45, 0xffff0000, v20
  v_cvt_pk_bf16_f32 v8, v46, v47
  v_lshlrev_b32 v46, 16, v8
  v_and_b32 v47, 0xffff0000, v8
  v_lshlrev_b32 v10, 16, v21
  v_and_b32 v11, 0xffff0000, v21
  v_pk_add_f32 v[46:47], v[46:47], v[10:11]
  v_cvt_pk_bf16_f32 v21, v46, v47
  v_lshlrev_b32 v46, 16, v21
  v_and_b32 v47, 0xffff0000, v21
  v_cvt_pk_bf16_f32 v8, v48, v49
  v_lshlrev_b32 v48, 16, v8
  v_and_b32 v49, 0xffff0000, v8
  v_lshlrev_b32 v10, 16, v22
  v_and_b32 v11, 0xffff0000, v22
  v_pk_add_f32 v[48:49], v[48:49], v[10:11]
  v_cvt_pk_bf16_f32 v22, v48, v49
  v_lshlrev_b32 v48, 16, v22
  v_and_b32 v49, 0xffff0000, v22
  v_cvt_pk_bf16_f32 v8, v50, v51
  v_lshlrev_b32 v50, 16, v8
  v_and_b32 v51, 0xffff0000, v8
  v_lshlrev_b32 v10, 16, v23
  v_and_b32 v11, 0xffff0000, v23
  v_pk_add_f32 v[50:51], v[50:51], v[10:11]
  v_cvt_pk_bf16_f32 v23, v50, v51
  v_lshlrev_b32 v50, 16, v23
  v_and_b32 v51, 0xffff0000, v23
  buffer_store_dwordx4 v[20:23], v15, s[4:7], s21 offen offset:64 sc1
  s_waitcnt vmcnt(18)
  v_lshlrev_b32 v52, 16, v144
  v_and_b32 v53, 0xffff0000, v144
  v_lshlrev_b32 v54, 16, v145
  v_and_b32 v55, 0xffff0000, v145
  v_lshlrev_b32 v56, 16, v146
  v_and_b32 v57, 0xffff0000, v146
  v_lshlrev_b32 v58, 16, v147
  v_and_b32 v59, 0xffff0000, v147
  v_lshlrev_b32 v8, 16, v148
  v_and_b32 v9, 0xffff0000, v148
  v_pk_add_f32 v[52:53], v[52:53], v[8:9]
  v_lshlrev_b32 v8, 16, v149
  v_and_b32 v9, 0xffff0000, v149
  v_pk_add_f32 v[54:55], v[54:55], v[8:9]
  v_lshlrev_b32 v8, 16, v150
  v_and_b32 v9, 0xffff0000, v150
  v_pk_add_f32 v[56:57], v[56:57], v[8:9]
  v_lshlrev_b32 v8, 16, v151
  v_and_b32 v9, 0xffff0000, v151
  v_pk_add_f32 v[58:59], v[58:59], v[8:9]
  v_lshlrev_b32 v8, 16, v152
  v_and_b32 v9, 0xffff0000, v152
  v_pk_add_f32 v[52:53], v[52:53], v[8:9]
  v_lshlrev_b32 v8, 16, v153
  v_and_b32 v9, 0xffff0000, v153
  v_pk_add_f32 v[54:55], v[54:55], v[8:9]
  v_lshlrev_b32 v8, 16, v154
  v_and_b32 v9, 0xffff0000, v154
  v_pk_add_f32 v[56:57], v[56:57], v[8:9]
  v_lshlrev_b32 v8, 16, v155
  v_and_b32 v9, 0xffff0000, v155
  v_pk_add_f32 v[58:59], v[58:59], v[8:9]
  v_lshlrev_b32 v8, 16, v156
  v_and_b32 v9, 0xffff0000, v156
  v_pk_add_f32 v[52:53], v[52:53], v[8:9]
  v_lshlrev_b32 v8, 16, v157
  v_and_b32 v9, 0xffff0000, v157
  v_pk_add_f32 v[54:55], v[54:55], v[8:9]
  v_lshlrev_b32 v8, 16, v158
  v_and_b32 v9, 0xffff0000, v158
  v_pk_add_f32 v[56:57], v[56:57], v[8:9]
  v_lshlrev_b32 v8, 16, v159
  v_and_b32 v9, 0xffff0000, v159
  v_pk_add_f32 v[58:59], v[58:59], v[8:9]
  v_lshlrev_b32 v8, 16, v160
  v_and_b32 v9, 0xffff0000, v160
  v_pk_add_f32 v[52:53], v[52:53], v[8:9]
  v_lshlrev_b32 v8, 16, v161
  v_and_b32 v9, 0xffff0000, v161
  v_pk_add_f32 v[54:55], v[54:55], v[8:9]
  v_lshlrev_b32 v8, 16, v162
  v_and_b32 v9, 0xffff0000, v162
  v_pk_add_f32 v[56:57], v[56:57], v[8:9]
  v_lshlrev_b32 v8, 16, v163
  v_and_b32 v9, 0xffff0000, v163
  v_pk_add_f32 v[58:59], v[58:59], v[8:9]
  v_lshlrev_b32 v8, 16, v164
  v_and_b32 v9, 0xffff0000, v164
  v_pk_add_f32 v[52:53], v[52:53], v[8:9]
  v_lshlrev_b32 v8, 16, v165
  v_and_b32 v9, 0xffff0000, v165
  v_pk_add_f32 v[54:55], v[54:55], v[8:9]
  v_lshlrev_b32 v8, 16, v166
  v_and_b32 v9, 0xffff0000, v166
  v_pk_add_f32 v[56:57], v[56:57], v[8:9]
  v_lshlrev_b32 v8, 16, v167
  v_and_b32 v9, 0xffff0000, v167
  v_pk_add_f32 v[58:59], v[58:59], v[8:9]
  v_lshlrev_b32 v8, 16, v168
  v_and_b32 v9, 0xffff0000, v168
  v_pk_add_f32 v[52:53], v[52:53], v[8:9]
  v_lshlrev_b32 v8, 16, v169
  v_and_b32 v9, 0xffff0000, v169
  v_pk_add_f32 v[54:55], v[54:55], v[8:9]
  v_lshlrev_b32 v8, 16, v170
  v_and_b32 v9, 0xffff0000, v170
  v_pk_add_f32 v[56:57], v[56:57], v[8:9]
  v_lshlrev_b32 v8, 16, v171
  v_and_b32 v9, 0xffff0000, v171
  v_pk_add_f32 v[58:59], v[58:59], v[8:9]
  v_lshlrev_b32 v8, 16, v172
  v_and_b32 v9, 0xffff0000, v172
  v_pk_add_f32 v[52:53], v[52:53], v[8:9]
  v_lshlrev_b32 v8, 16, v173
  v_and_b32 v9, 0xffff0000, v173
  v_pk_add_f32 v[54:55], v[54:55], v[8:9]
  v_lshlrev_b32 v8, 16, v174
  v_and_b32 v9, 0xffff0000, v174
  v_pk_add_f32 v[56:57], v[56:57], v[8:9]
  v_lshlrev_b32 v8, 16, v175
  v_and_b32 v9, 0xffff0000, v175
  v_pk_add_f32 v[58:59], v[58:59], v[8:9]
  v_cvt_pk_bf16_f32 v8, v52, v53
  v_lshlrev_b32 v52, 16, v8
  v_and_b32 v53, 0xffff0000, v8
  v_lshlrev_b32 v10, 16, v24
  v_and_b32 v11, 0xffff0000, v24
  v_pk_add_f32 v[52:53], v[52:53], v[10:11]
  v_cvt_pk_bf16_f32 v24, v52, v53
  v_lshlrev_b32 v52, 16, v24
  v_and_b32 v53, 0xffff0000, v24
  v_cvt_pk_bf16_f32 v8, v54, v55
  v_lshlrev_b32 v54, 16, v8
  v_and_b32 v55, 0xffff0000, v8
  v_lshlrev_b32 v10, 16, v25
  v_and_b32 v11, 0xffff0000, v25
  v_pk_add_f32 v[54:55], v[54:55], v[10:11]
  v_cvt_pk_bf16_f32 v25, v54, v55
  v_lshlrev_b32 v54, 16, v25
  v_and_b32 v55, 0xffff0000, v25
  v_cvt_pk_bf16_f32 v8, v56, v57
  v_lshlrev_b32 v56, 16, v8
  v_and_b32 v57, 0xffff0000, v8
  v_lshlrev_b32 v10, 16, v26
  v_and_b32 v11, 0xffff0000, v26
  v_pk_add_f32 v[56:57], v[56:57], v[10:11]
  v_cvt_pk_bf16_f32 v26, v56, v57
  v_lshlrev_b32 v56, 16, v26
  v_and_b32 v57, 0xffff0000, v26
  v_cvt_pk_bf16_f32 v8, v58, v59
  v_lshlrev_b32 v58, 16, v8
  v_and_b32 v59, 0xffff0000, v8
  v_lshlrev_b32 v10, 16, v27
  v_and_b32 v11, 0xffff0000, v27
  v_pk_add_f32 v[58:59], v[58:59], v[10:11]
  v_cvt_pk_bf16_f32 v27, v58, v59
  v_lshlrev_b32 v58, 16, v27
  v_and_b32 v59, 0xffff0000, v27
  buffer_store_dwordx4 v[24:27], v15, s[4:7], s21 offen offset:128 sc1
  s_waitcnt vmcnt(11)
  v_lshlrev_b32 v60, 16, v176
  v_and_b32 v61, 0xffff0000, v176
  v_lshlrev_b32 v62, 16, v177
  v_and_b32 v63, 0xffff0000, v177
  v_lshlrev_b32 v64, 16, v178
  v_and_b32 v65, 0xffff0000, v178
  v_lshlrev_b32 v66, 16, v179
  v_and_b32 v67, 0xffff0000, v179
  v_lshlrev_b32 v8, 16, v180
  v_and_b32 v9, 0xffff0000, v180
  v_pk_add_f32 v[60:61], v[60:61], v[8:9]
  v_lshlrev_b32 v8, 16, v181
  v_and_b32 v9, 0xffff0000, v181
  v_pk_add_f32 v[62:63], v[62:63], v[8:9]
  v_lshlrev_b32 v8, 16, v182
  v_and_b32 v9, 0xffff0000, v182
  v_pk_add_f32 v[64:65], v[64:65], v[8:9]
  v_lshlrev_b32 v8, 16, v183
  v_and_b32 v9, 0xffff0000, v183
  v_pk_add_f32 v[66:67], v[66:67], v[8:9]
  v_lshlrev_b32 v8, 16, v184
  v_and_b32 v9, 0xffff0000, v184
  v_pk_add_f32 v[60:61], v[60:61], v[8:9]
  v_lshlrev_b32 v8, 16, v185
  v_and_b32 v9, 0xffff0000, v185
  v_pk_add_f32 v[62:63], v[62:63], v[8:9]
  v_lshlrev_b32 v8, 16, v186
  v_and_b32 v9, 0xffff0000, v186
  v_pk_add_f32 v[64:65], v[64:65], v[8:9]
  v_lshlrev_b32 v8, 16, v187
  v_and_b32 v9, 0xffff0000, v187
  v_pk_add_f32 v[66:67], v[66:67], v[8:9]
  v_lshlrev_b32 v8, 16, v188
  v_and_b32 v9, 0xffff0000, v188
  v_pk_add_f32 v[60:61], v[60:61], v[8:9]
  v_lshlrev_b32 v8, 16, v189
  v_and_b32 v9, 0xffff0000, v189
  v_pk_add_f32 v[62:63], v[62:63], v[8:9]
  v_lshlrev_b32 v8, 16, v190
  v_and_b32 v9, 0xffff0000, v190
  v_pk_add_f32 v[64:65], v[64:65], v[8:9]
  v_lshlrev_b32 v8, 16, v191
  v_and_b32 v9, 0xffff0000, v191
  v_pk_add_f32 v[66:67], v[66:67], v[8:9]
  v_lshlrev_b32 v8, 16, v192
  v_and_b32 v9, 0xffff0000, v192
  v_pk_add_f32 v[60:61], v[60:61], v[8:9]
  v_lshlrev_b32 v8, 16, v193
  v_and_b32 v9, 0xffff0000, v193
  v_pk_add_f32 v[62:63], v[62:63], v[8:9]
  v_lshlrev_b32 v8, 16, v194
  v_and_b32 v9, 0xffff0000, v194
  v_pk_add_f32 v[64:65], v[64:65], v[8:9]
  v_lshlrev_b32 v8, 16, v195
  v_and_b32 v9, 0xffff0000, v195
  v_pk_add_f32 v[66:67], v[66:67], v[8:9]
  v_lshlrev_b32 v8, 16, v196
  v_and_b32 v9, 0xffff0000, v196
  v_pk_add_f32 v[60:61], v[60:61], v[8:9]
  v_lshlrev_b32 v8, 16, v197
  v_and_b32 v9, 0xffff0000, v197
  v_pk_add_f32 v[62:63], v[62:63], v[8:9]
  v_lshlrev_b32 v8, 16, v198
  v_and_b32 v9, 0xffff0000, v198
  v_pk_add_f32 v[64:65], v[64:65], v[8:9]
  v_lshlrev_b32 v8, 16, v199
  v_and_b32 v9, 0xffff0000, v199
  v_pk_add_f32 v[66:67], v[66:67], v[8:9]
  v_lshlrev_b32 v8, 16, v200
  v_and_b32 v9, 0xffff0000, v200
  v_pk_add_f32 v[60:61], v[60:61], v[8:9]
  v_lshlrev_b32 v8, 16, v201
  v_and_b32 v9, 0xffff0000, v201
  v_pk_add_f32 v[62:63], v[62:63], v[8:9]
  v_lshlrev_b32 v8, 16, v202
  v_and_b32 v9, 0xffff0000, v202
  v_pk_add_f32 v[64:65], v[64:65], v[8:9]
  v_lshlrev_b32 v8, 16, v203
  v_and_b32 v9, 0xffff0000, v203
  v_pk_add_f32 v[66:67], v[66:67], v[8:9]
  v_lshlrev_b32 v8, 16, v204
  v_and_b32 v9, 0xffff0000, v204
  v_pk_add_f32 v[60:61], v[60:61], v[8:9]
  v_lshlrev_b32 v8, 16, v205
  v_and_b32 v9, 0xffff0000, v205
  v_pk_add_f32 v[62:63], v[62:63], v[8:9]
  v_lshlrev_b32 v8, 16, v206
  v_and_b32 v9, 0xffff0000, v206
  v_pk_add_f32 v[64:65], v[64:65], v[8:9]
  v_lshlrev_b32 v8, 16, v207
  v_and_b32 v9, 0xffff0000, v207
  v_pk_add_f32 v[66:67], v[66:67], v[8:9]
  v_cvt_pk_bf16_f32 v8, v60, v61
  v_lshlrev_b32 v60, 16, v8
  v_and_b32 v61, 0xffff0000, v8
  v_lshlrev_b32 v10, 16, v28
  v_and_b32 v11, 0xffff0000, v28
  v_pk_add_f32 v[60:61], v[60:61], v[10:11]
  v_cvt_pk_bf16_f32 v28, v60, v61
  v_lshlrev_b32 v60, 16, v28
  v_and_b32 v61, 0xffff0000, v28
  v_cvt_pk_bf16_f32 v8, v62, v63
  v_lshlrev_b32 v62, 16, v8
  v_and_b32 v63, 0xffff0000, v8
  v_lshlrev_b32 v10, 16, v29
  v_and_b32 v11, 0xffff0000, v29
  v_pk_add_f32 v[62:63], v[62:63], v[10:11]
  v_cvt_pk_bf16_f32 v29, v62, v63
  v_lshlrev_b32 v62, 16, v29
  v_and_b32 v63, 0xffff0000, v29
  v_cvt_pk_bf16_f32 v8, v64, v65
  v_lshlrev_b32 v64, 16, v8
  v_and_b32 v65, 0xffff0000, v8
  v_lshlrev_b32 v10, 16, v30
  v_and_b32 v11, 0xffff0000, v30
  v_pk_add_f32 v[64:65], v[64:65], v[10:11]
  v_cvt_pk_bf16_f32 v30, v64, v65
  v_lshlrev_b32 v64, 16, v30
  v_and_b32 v65, 0xffff0000, v30
  v_cvt_pk_bf16_f32 v8, v66, v67
  v_lshlrev_b32 v66, 16, v8
  v_and_b32 v67, 0xffff0000, v8
  v_lshlrev_b32 v10, 16, v31
  v_and_b32 v11, 0xffff0000, v31
  v_pk_add_f32 v[66:67], v[66:67], v[10:11]
  v_cvt_pk_bf16_f32 v31, v66, v67
  v_lshlrev_b32 v66, 16, v31
  v_and_b32 v67, 0xffff0000, v31
  buffer_store_dwordx4 v[28:31], v15, s[4:7], s21 offen offset:192 sc1
  s_waitcnt vmcnt(4)
  v_lshlrev_b32 v68, 16, v208
  v_and_b32 v69, 0xffff0000, v208
  v_lshlrev_b32 v70, 16, v209
  v_and_b32 v71, 0xffff0000, v209
  v_lshlrev_b32 v72, 16, v210
  v_and_b32 v73, 0xffff0000, v210
  v_lshlrev_b32 v74, 16, v211
  v_and_b32 v75, 0xffff0000, v211
  v_lshlrev_b32 v8, 16, v212
  v_and_b32 v9, 0xffff0000, v212
  v_pk_add_f32 v[68:69], v[68:69], v[8:9]
  v_lshlrev_b32 v8, 16, v213
  v_and_b32 v9, 0xffff0000, v213
  v_pk_add_f32 v[70:71], v[70:71], v[8:9]
  v_lshlrev_b32 v8, 16, v214
  v_and_b32 v9, 0xffff0000, v214
  v_pk_add_f32 v[72:73], v[72:73], v[8:9]
  v_lshlrev_b32 v8, 16, v215
  v_and_b32 v9, 0xffff0000, v215
  v_pk_add_f32 v[74:75], v[74:75], v[8:9]
  v_lshlrev_b32 v8, 16, v216
  v_and_b32 v9, 0xffff0000, v216
  v_pk_add_f32 v[68:69], v[68:69], v[8:9]
  v_lshlrev_b32 v8, 16, v217
  v_and_b32 v9, 0xffff0000, v217
  v_pk_add_f32 v[70:71], v[70:71], v[8:9]
  v_lshlrev_b32 v8, 16, v218
  v_and_b32 v9, 0xffff0000, v218
  v_pk_add_f32 v[72:73], v[72:73], v[8:9]
  v_lshlrev_b32 v8, 16, v219
  v_and_b32 v9, 0xffff0000, v219
  v_pk_add_f32 v[74:75], v[74:75], v[8:9]
  v_lshlrev_b32 v8, 16, v220
  v_and_b32 v9, 0xffff0000, v220
  v_pk_add_f32 v[68:69], v[68:69], v[8:9]
  v_lshlrev_b32 v8, 16, v221
  v_and_b32 v9, 0xffff0000, v221
  v_pk_add_f32 v[70:71], v[70:71], v[8:9]
  v_lshlrev_b32 v8, 16, v222
  v_and_b32 v9, 0xffff0000, v222
  v_pk_add_f32 v[72:73], v[72:73], v[8:9]
  v_lshlrev_b32 v8, 16, v223
  v_and_b32 v9, 0xffff0000, v223
  v_pk_add_f32 v[74:75], v[74:75], v[8:9]
  v_lshlrev_b32 v8, 16, v224
  v_and_b32 v9, 0xffff0000, v224
  v_pk_add_f32 v[68:69], v[68:69], v[8:9]
  v_lshlrev_b32 v8, 16, v225
  v_and_b32 v9, 0xffff0000, v225
  v_pk_add_f32 v[70:71], v[70:71], v[8:9]
  v_lshlrev_b32 v8, 16, v226
  v_and_b32 v9, 0xffff0000, v226
  v_pk_add_f32 v[72:73], v[72:73], v[8:9]
  v_lshlrev_b32 v8, 16, v227
  v_and_b32 v9, 0xffff0000, v227
  v_pk_add_f32 v[74:75], v[74:75], v[8:9]
  v_lshlrev_b32 v8, 16, v228
  v_and_b32 v9, 0xffff0000, v228
  v_pk_add_f32 v[68:69], v[68:69], v[8:9]
  v_lshlrev_b32 v8, 16, v229
  v_and_b32 v9, 0xffff0000, v229
  v_pk_add_f32 v[70:71], v[70:71], v[8:9]
  v_lshlrev_b32 v8, 16, v230
  v_and_b32 v9, 0xffff0000, v230
  v_pk_add_f32 v[72:73], v[72:73], v[8:9]
  v_lshlrev_b32 v8, 16, v231
  v_and_b32 v9, 0xffff0000, v231
  v_pk_add_f32 v[74:75], v[74:75], v[8:9]
  v_lshlrev_b32 v8, 16, v232
  v_and_b32 v9, 0xffff0000, v232
  v_pk_add_f32 v[68:69], v[68:69], v[8:9]
  v_lshlrev_b32 v8, 16, v233
  v_and_b32 v9, 0xffff0000, v233
  v_pk_add_f32 v[70:71], v[70:71], v[8:9]
  v_lshlrev_b32 v8, 16, v234
  v_and_b32 v9, 0xffff0000, v234
  v_pk_add_f32 v[72:73], v[72:73], v[8:9]
  v_lshlrev_b32 v8, 16, v235
  v_and_b32 v9, 0xffff0000, v235
  v_pk_add_f32 v[74:75], v[74:75], v[8:9]
  v_lshlrev_b32 v8, 16, v236
  v_and_b32 v9, 0xffff0000, v236
  v_pk_add_f32 v[68:69], v[68:69], v[8:9]
  v_lshlrev_b32 v8, 16, v237
  v_and_b32 v9, 0xffff0000, v237
  v_pk_add_f32 v[70:71], v[70:71], v[8:9]
  v_lshlrev_b32 v8, 16, v238
  v_and_b32 v9, 0xffff0000, v238
  v_pk_add_f32 v[72:73], v[72:73], v[8:9]
  v_lshlrev_b32 v8, 16, v239
  v_and_b32 v9, 0xffff0000, v239
  v_pk_add_f32 v[74:75], v[74:75], v[8:9]
  v_cvt_pk_bf16_f32 v8, v68, v69
  v_lshlrev_b32 v68, 16, v8
  v_and_b32 v69, 0xffff0000, v8
  v_lshlrev_b32 v10, 16, v32
  v_and_b32 v11, 0xffff0000, v32
  v_pk_add_f32 v[68:69], v[68:69], v[10:11]
  v_cvt_pk_bf16_f32 v32, v68, v69
  v_lshlrev_b32 v68, 16, v32
  v_and_b32 v69, 0xffff0000, v32
  v_cvt_pk_bf16_f32 v8, v70, v71
  v_lshlrev_b32 v70, 16, v8
  v_and_b32 v71, 0xffff0000, v8
  v_lshlrev_b32 v10, 16, v33
  v_and_b32 v11, 0xffff0000, v33
  v_pk_add_f32 v[70:71], v[70:71], v[10:11]
  v_cvt_pk_bf16_f32 v33, v70, v71
  v_lshlrev_b32 v70, 16, v33
  v_and_b32 v71, 0xffff0000, v33
  v_cvt_pk_bf16_f32 v8, v72, v73
  v_lshlrev_b32 v72, 16, v8
  v_and_b32 v73, 0xffff0000, v8
  v_lshlrev_b32 v10, 16, v34
  v_and_b32 v11, 0xffff0000, v34
  v_pk_add_f32 v[72:73], v[72:73], v[10:11]
  v_cvt_pk_bf16_f32 v34, v72, v73
  v_lshlrev_b32 v72, 16, v34
  v_and_b32 v73, 0xffff0000, v34
  v_cvt_pk_bf16_f32 v8, v74, v75
  v_lshlrev_b32 v74, 16, v8
  v_and_b32 v75, 0xffff0000, v8
  v_lshlrev_b32 v10, 16, v35
  v_and_b32 v11, 0xffff0000, v35
  v_pk_add_f32 v[74:75], v[74:75], v[10:11]
  v_cvt_pk_bf16_f32 v35, v74, v75
  v_lshlrev_b32 v74, 16, v35
  v_and_b32 v75, 0xffff0000, v35
  buffer_store_dwordx4 v[32:35], v15, s[4:7], s21 offen offset:256 sc1
  v_and_b32 v3, 63, v0
  v_and_b32 v2, 15, v3
  v_lshlrev_b32 v5, 2, v2
  s_lshl_b32 s17, s16, 6
  v_add_u32 v1, s17, v5
  v_pk_add_f32 v[6:7], v[36:37], v[38:39]
  v_pk_add_f32 v[6:7], v[6:7], v[40:41]
  v_pk_add_f32 v[6:7], v[6:7], v[42:43]
  v_pk_add_f32 v[6:7], v[6:7], v[44:45]
  v_pk_add_f32 v[6:7], v[6:7], v[46:47]
  v_pk_add_f32 v[6:7], v[6:7], v[48:49]
  v_pk_add_f32 v[6:7], v[6:7], v[50:51]
  v_pk_add_f32 v[6:7], v[6:7], v[52:53]
  v_pk_add_f32 v[6:7], v[6:7], v[54:55]
  v_pk_add_f32 v[6:7], v[6:7], v[56:57]
  v_pk_add_f32 v[6:7], v[6:7], v[58:59]
  v_pk_add_f32 v[6:7], v[6:7], v[60:61]
  v_pk_add_f32 v[6:7], v[6:7], v[62:63]
  v_pk_add_f32 v[6:7], v[6:7], v[64:65]
  v_pk_add_f32 v[6:7], v[6:7], v[66:67]
  v_pk_add_f32 v[6:7], v[6:7], v[68:69]
  v_pk_add_f32 v[6:7], v[6:7], v[70:71]
  v_pk_add_f32 v[6:7], v[6:7], v[72:73]
  v_pk_add_f32 v[6:7], v[6:7], v[74:75]
  v_add_f32 v4, v6, v7
  v_mov_b32 v2, v4
  s_nop 1
  v_permlane32_swap_b32 v4, v2
  v_add_f32 v4, v4, v2
  v_mov_b32 v2, v4
  s_nop 1
  v_permlane16_swap_b32 v4, v2
  v_add_f32 v4, v4, v2
  ds_write_b32 v1, v4 offset:0
  s_waitcnt lgkmcnt(0)
  s_barrier
  ds_read_b32 v4, v5 offset:0
  ds_read_b32 v2, v5 offset:64
  ds_read_b32 v3, v5 offset:128
  ds_read_b32 v6, v5 offset:192
  s_waitcnt lgkmcnt(0)
  v_add_f32 v4, v4, v2
  v_add_f32 v3, v3, v6
  v_add_f32 v4, v4, v3
  v_mul_f32 v6, 0xbacccccd, v4
  v_mov_b32 v7, v6
  v_pk_add_f32 v[36:37], v[36:37], v[6:7]
  v_pk_add_f32 v[38:39], v[38:39], v[6:7]
  v_pk_add_f32 v[40:41], v[40:41], v[6:7]
  v_pk_add_f32 v[42:43], v[42:43], v[6:7]
  v_pk_add_f32 v[44:45], v[44:45], v[6:7]
  v_pk_add_f32 v[46:47], v[46:47], v[6:7]
  v_pk_add_f32 v[48:49], v[48:49], v[6:7]
  v_pk_add_f32 v[50:51], v[50:51], v[6:7]
  v_pk_add_f32 v[52:53], v[52:53], v[6:7]
  v_pk_add_f32 v[54:55], v[54:55], v[6:7]
  v_pk_add_f32 v[56:57], v[56:57], v[6:7]
  v_pk_add_f32 v[58:59], v[58:59], v[6:7]
  v_pk_add_f32 v[60:61], v[60:61], v[6:7]
  v_pk_add_f32 v[62:63], v[62:63], v[6:7]
  v_pk_add_f32 v[64:65], v[64:65], v[6:7]
  v_pk_add_f32 v[66:67], v[66:67], v[6:7]
  v_pk_add_f32 v[68:69], v[68:69], v[6:7]
  v_pk_add_f32 v[70:71], v[70:71], v[6:7]
  v_pk_add_f32 v[72:73], v[72:73], v[6:7]
  v_pk_add_f32 v[74:75], v[74:75], v[6:7]
  v_pk_mul_f32 v[6:7], v[36:37], v[36:37]
  v_pk_fma_f32 v[6:7], v[38:39], v[38:39], v[6:7]
  v_pk_fma_f32 v[6:7], v[40:41], v[40:41], v[6:7]
  v_pk_fma_f32 v[6:7], v[42:43], v[42:43], v[6:7]
  v_pk_fma_f32 v[6:7], v[44:45], v[44:45], v[6:7]
  v_pk_fma_f32 v[6:7], v[46:47], v[46:47], v[6:7]
  v_pk_fma_f32 v[6:7], v[48:49], v[48:49], v[6:7]
  v_pk_fma_f32 v[6:7], v[50:51], v[50:51], v[6:7]
  v_pk_fma_f32 v[6:7], v[52:53], v[52:53], v[6:7]
  v_pk_fma_f32 v[6:7], v[54:55], v[54:55], v[6:7]
  v_pk_fma_f32 v[6:7], v[56:57], v[56:57], v[6:7]
  v_pk_fma_f32 v[6:7], v[58:59], v[58:59], v[6:7]
  v_pk_fma_f32 v[6:7], v[60:61], v[60:61], v[6:7]
  v_pk_fma_f32 v[6:7], v[62:63], v[62:63], v[6:7]
  v_pk_fma_f32 v[6:7], v[64:65], v[64:65], v[6:7]
  v_pk_fma_f32 v[6:7], v[66:67], v[66:67], v[6:7]
  v_pk_fma_f32 v[6:7], v[68:69], v[68:69], v[6:7]
  v_pk_fma_f32 v[6:7], v[70:71], v[70:71], v[6:7]
  v_pk_fma_f32 v[6:7], v[72:73], v[72:73], v[6:7]
  v_pk_fma_f32 v[6:7], v[74:75], v[74:75], v[6:7]
  v_add_f32 v4, v6, v7
  v_mov_b32 v2, v4
  s_nop 1
  v_permlane32_swap_b32 v4, v2
  v_add_f32 v4, v4, v2
  v_mov_b32 v2, v4
  s_nop 1
  v_permlane16_swap_b32 v4, v2
  v_add_f32 v4, v4, v2
  ds_write_b32 v1, v4 offset:256
  s_waitcnt lgkmcnt(0)
  s_barrier
  ds_read_b32 v4, v5 offset:256
  ds_read_b32 v2, v5 offset:320
  ds_read_b32 v3, v5 offset:384
  ds_read_b32 v6, v5 offset:448
  s_waitcnt lgkmcnt(0)
  v_add_f32 v4, v4, v2
  v_add_f32 v3, v3, v6
  v_add_f32 v4, v4, v3
  v_mov_b32 v2, 0x3727c5ac
  v_fmac_f32 v2, 0x3acccccd, v4
  v_rsq_f32 v6, v2
  s_nop 0
  v_mov_b32 v7, v6
  v_pk_mul_f32 v[36:37], v[36:37], v[6:7]
  v_pk_mul_f32 v[38:39], v[38:39], v[6:7]
  v_pk_mul_f32 v[40:41], v[40:41], v[6:7]
  v_pk_mul_f32 v[42:43], v[42:43], v[6:7]
  v_pk_mul_f32 v[44:45], v[44:45], v[6:7]
  v_pk_mul_f32 v[46:47], v[46:47], v[6:7]
  v_pk_mul_f32 v[48:49], v[48:49], v[6:7]
  v_pk_mul_f32 v[50:51], v[50:51], v[6:7]
  v_pk_mul_f32 v[52:53], v[52:53], v[6:7]
  v_pk_mul_f32 v[54:55], v[54:55], v[6:7]
  v_pk_mul_f32 v[56:57], v[56:57], v[6:7]
  v_pk_mul_f32 v[58:59], v[58:59], v[6:7]
  v_pk_mul_f32 v[60:61], v[60:61], v[6:7]
  v_pk_mul_f32 v[62:63], v[62:63], v[6:7]
  v_pk_mul_f32 v[64:65], v[64:65], v[6:7]
  v_pk_mul_f32 v[66:67], v[66:67], v[6:7]
  v_pk_mul_f32 v[68:69], v[68:69], v[6:7]
  v_pk_mul_f32 v[70:71], v[70:71], v[6:7]
  v_pk_mul_f32 v[72:73], v[72:73], v[6:7]
  v_pk_mul_f32 v[74:75], v[74:75], v[6:7]
  v_cvt_pk_bf16_f32 v16, v36, v37
  v_cvt_pk_bf16_f32 v17, v38, v39
  v_cvt_pk_bf16_f32 v18, v40, v41
  v_cvt_pk_bf16_f32 v19, v42, v43
  v_cvt_pk_bf16_f32 v20, v44, v45
  v_cvt_pk_bf16_f32 v21, v46, v47
  v_cvt_pk_bf16_f32 v22, v48, v49
  v_cvt_pk_bf16_f32 v23, v50, v51
  v_cvt_pk_bf16_f32 v24, v52, v53
  v_cvt_pk_bf16_f32 v25, v54, v55
  v_cvt_pk_bf16_f32 v26, v56, v57
  v_cvt_pk_bf16_f32 v27, v58, v59
  v_cvt_pk_bf16_f32 v28, v60, v61
  v_cvt_pk_bf16_f32 v29, v62, v63
  v_cvt_pk_bf16_f32 v30, v64, v65
  v_cvt_pk_bf16_f32 v31, v66, v67
  v_cvt_pk_bf16_f32 v32, v68, v69
  v_cvt_pk_bf16_f32 v33, v70, v71
  v_cvt_pk_bf16_f32 v34, v72, v73
  v_cvt_pk_bf16_f32 v35, v74, v75
  v_and_b32 v3, 63, v0
  v_and_b32 v2, 15, v3
  v_lshlrev_b32 v1, 4, v2
  v_bfe_u32 v2, v3, 4, 1
  v_lshl_add_u32 v1, v2, 9, v1
  v_lshrrev_b32 v2, 5, v3
  v_lshl_add_u32 v1, v2, 10, v1
  s_lshr_b32 s17, s19, 1
  s_mul_i32 s17, s17, 40960
  s_and_b32 s18, s19, 1
  s_lshl_b32 s18, s18, 8
  s_add_u32 s17, s17, s18
  s_mul_i32 s18, s16, 10240
  s_add_u32 s17, s17, s18
  s_add_u32 s17, s17, 54525952
  buffer_store_dwordx4 v[16:19], v1, s[4:7], s17 offen offset:0 sc1
  buffer_store_dwordx4 v[20:23], v1, s[4:7], s17 offen offset:2048 sc1
  s_add_u32 s17, s17, 4096
  buffer_store_dwordx4 v[24:27], v1, s[4:7], s17 offen offset:0 sc1
  buffer_store_dwordx4 v[28:31], v1, s[4:7], s17 offen offset:2048 sc1
  s_add_u32 s17, s17, 4096
  buffer_store_dwordx4 v[32:35], v1, s[4:7], s17 offen offset:0 sc1
redln1_exit1:
  s_endpgm
.globl redln2_kernel
.p2align 8
.type redln2_kernel,@function
redln2_kernel:
  s_cmp_ge_u32 s2, 128
  s_cbranch_scc1 redln2_exit1
  s_load_dwordx2 s[12:13], s[0:1], 96
  s_load_dwordx2 s[14:15], s[0:1], 0
  v_lshrrev_b32 v2, 6, v0
  s_nop 0
  v_readfirstlane_b32 s16, v2
  s_waitcnt lgkmcnt(0)
  s_mov_b32 s4, s12
  s_mov_b32 s5, s13
  s_mov_b32 s6, 0x10000000
  s_mov_b32 s7, 0x20000
  s_mov_b32 s8, s12
  s_mov_b32 s9, s13
  s_mov_b32 s10, 0x10000000
  s_mov_b32 s11, 0x20000
  s_mov_b32 s20, 84934656
  s_mov_b32 s19, s2
  v_and_b32 v3, 63, v0
  v_lshlrev_b32 v14, 4, v3
  v_and_b32 v2, 15, v3
  v_lshrrev_b32 v4, 4, v3
  s_lshl_b32 s17, s19, 4
  v_add_u32 v15, s17, v2
  v_mul_u32_u24 v15, 1280, v15
  v_lshl_add_u32 v15, v4, 4, v15
  s_mul_i32 s17, s16, 320
  s_add_u32 s20, s20, s17
  s_add_u32 s21, s17, 84934656
  s_mul_i32 s22, s19, 20
  s_mul_i32 s23, s16, 5
  s_add_u32 s22, s22, s23
  s_lshl_b32 s22, s22, 10
  s_add_u32 s22, s22, 95420416
  s_add_u32 s24, s22, 0
  s_add_u32 s25, s22, 2621440
  s_add_u32 s26, s22, 5242880
  s_add_u32 s27, s22, 7864320
  s_add_u32 s28, s22, 10485760
  s_add_u32 s29, s22, 13107200
  s_add_u32 s30, s22, 15728640
  s_add_u32 s31, s22, 18350080
  v_add_u32 v6, 0x1000, v14
  buffer_load_dwordx4 v[16:19], v15, s[8:11], s20 offen offset:0
  buffer_load_dwordx4 v[20:23], v15, s[8:11], s20 offen offset:64
  buffer_load_dwordx4 v[24:27], v15, s[8:11], s20 offen offset:128
  buffer_load_dwordx4 v[28:31], v15, s[8:11], s20 offen offset:192
  buffer_load_dwordx4 v[32:35], v15, s[8:11], s20 offen offset:256
  buffer_load_dwordx4 v[80:83], v14, s[4:7], s24 offen offset:0
  buffer_load_dwordx4 v[84:87], v14, s[4:7], s25 offen offset:0
  buffer_load_dwordx4 v[88:91], v14, s[4:7], s26 offen offset:0
  buffer_load_dwordx4 v[92:95], v14, s[4:7], s27 offen offset:0
  buffer_load_dwordx4 v[96:99], v14, s[4:7], s28 offen offset:0
  buffer_load_dwordx4 v[100:103], v14, s[4:7], s29 offen offset:0
  buffer_load_dwordx4 v[104:107], v14, s[4:7], s30 offen offset:0
  buffer_load_dwordx4 v[108:111], v14, s[4:7], s31 offen offset:0
  buffer_load_dwordx4 v[112:115], v14, s[4:7], s24 offen offset:1024
  buffer_load_dwordx4 v[116:119], v14, s[4:7], s25 offen offset:1024
  buffer_load_dwordx4 v[120:123], v14, s[4:7], s26 offen offset:1024
  buffer_load_dwordx4 v[124:127], v14, s[4:7], s27 offen offset:1024
  buffer_load_dwordx4 v[128:131], v14, s[4:7], s28 offen offset:1024
  buffer_load_dwordx4 v[132:135], v14, s[4:7], s29 offen offset:1024
  buffer_load_dwordx4 v[136:139], v14, s[4:7], s30 offen offset:1024
  buffer_load_dwordx4 v[140:143], v14, s[4:7], s31 offen offset:1024
  buffer_load_dwordx4 v[144:147], v14, s[4:7], s24 offen offset:2048
  buffer_load_dwordx4 v[148:151], v14, s[4:7], s25 offen offset:2048
  buffer_load_dwordx4 v[152:155], v14, s[4:7], s26 offen offset:2048
  buffer_load_dwordx4 v[156:159], v14, s[4:7], s27 offen offset:2048
  buffer_load_dwordx4 v[160:163], v14, s[4:7], s28 offen offset:2048
  buffer_load_dwordx4 v[164:167], v14, s[4:7], s29 offen offset:2048
  buffer_load_dwordx4 v[168:171], v14, s[4:7], s30 offen offset:2048
  buffer_load_dwordx4 v[172:175], v14, s[4:7], s31 offen offset:2048
  buffer_load_dwordx4 v[176:179], v14, s[4:7], s24 offen offset:3072
  buffer_load_dwordx4 v[180:183], v14, s[4:7], s25 offen offset:3072
  buffer_load_dwordx4 v[184:187], v14, s[4:7], s26 offen offset:3072
  buffer_load_dwordx4 v[188:191], v14, s[4:7], s27 offen offset:3072
  buffer_load_dwordx4 v[192:195], v14, s[4:7], s28 offen offset:3072
  buffer_load_dwordx4 v[196:199], v14, s[4:7], s29 offen offset:3072
  buffer_load_dwordx4 v[200:203], v14, s[4:7], s30 offen offset:3072
  buffer_load_dwordx4 v[204:207], v14, s[4:7], s31 offen offset:3072
  buffer_load_dwordx4 v[208:211], v6, s[4:7], s24 offen offset:0
  buffer_load_dwordx4 v[212:215], v6, s[4:7], s25 offen offset:0
  buffer_load_dwordx4 v[216:219], v6, s[4:7], s26 offen offset:0
  buffer_load_dwordx4 v[220:223], v6, s[4:7], s27 offen offset:0
  buffer_load_dwordx4 v[224:227], v6, s[4:7], s28 offen offset:0
  buffer_load_dwordx4 v[228:231], v6, s[4:7], s29 offen offset:0
  buffer_load_dwordx4 v[232:235], v6, s[4:7], s30 offen offset:0
  buffer_load_dwordx4 v[236:239], v6, s[4:7], s31 offen offset:0
  s_waitcnt vmcnt(32)
  v_lshlrev_b32 v36, 16, v80
  v_and_b32 v37, 0xffff0000, v80
  v_lshlrev_b32 v38, 16, v81
  v_and_b32 v39, 0xffff0000, v81
  v_lshlrev_b32 v40, 16, v82
  v_and_b32 v41, 0xffff0000, v82
  v_lshlrev_b32 v42, 16, v83
  v_and_b32 v43, 0xffff0000, v83
  v_lshlrev_b32 v8, 16, v84
  v_and_b32 v9, 0xffff0000, v84
  v_pk_add_f32 v[36:37], v[36:37], v[8:9]
  v_lshlrev_b32 v8, 16, v85
  v_and_b32 v9, 0xffff0000, v85
  v_pk_add_f32 v[38:39], v[38:39], v[8:9]
  v_lshlrev_b32 v8, 16, v86
  v_and_b32 v9, 0xffff0000, v86
  v_pk_add_f32 v[40:41], v[40:41], v[8:9]
  v_lshlrev_b32 v8, 16, v87
  v_and_b32 v9, 0xffff0000, v87
  v_pk_add_f32 v[42:43], v[42:43], v[8:9]
  v_lshlrev_b32 v8, 16, v88
  v_and_b32 v9, 0xffff0000, v88
  v_pk_add_f32 v[36:37], v[36:37], v[8:9]
  v_lshlrev_b32 v8, 16, v89
  v_and_b32 v9, 0xffff0000, v89
  v_pk_add_f32 v[38:39], v[38:39], v[8:9]
  v_lshlrev_b32 v8, 16, v90
  v_and_b32 v9, 0xffff0000, v90
  v_pk_add_f32 v[40:41], v[40:41], v[8:9]
  v_lshlrev_b32 v8, 16, v91
  v_and_b32 v9, 0xffff0000, v91
  v_pk_add_f32 v[42:43], v[42:43], v[8:9]
  v_lshlrev_b32 v8, 16, v92
  v_and_b32 v9, 0xffff0000, v92
  v_pk_add_f32 v[36:37], v[36:37], v[8:9]
  v_lshlrev_b32 v8, 16, v93
  v_and_b32 v9, 0xffff0000, v93
  v_pk_add_f32 v[38:39], v[38:39], v[8:9]
  v_lshlrev_b32 v8, 16, v94
  v_and_b32 v9, 0xffff0000, v94
  v_pk_add_f32 v[40:41], v[40:41], v[8:9]
  v_lshlrev_b32 v8, 16, v95
  v_and_b32 v9, 0xffff0000, v95
  v_pk_add_f32 v[42:43], v[42:43], v[8:9]
  v_lshlrev_b32 v8, 16, v96
  v_and_b32 v9, 0xffff0000, v96
  v_pk_add_f32 v[36:37], v[36:37], v[8:9]
  v_lshlrev_b32 v8, 16, v97
  v_and_b32 v9, 0xffff0000, v97
  v_pk_add_f32 v[38:39], v[38:39], v[8:9]
  v_lshlrev_b32 v8, 16, v98
  v_and_b32 v9, 0xffff0000, v98
  v_pk_add_f32 v[40:41], v[40:41], v[8:9]
  v_lshlrev_b32 v8, 16, v99
  v_and_b32 v9, 0xffff0000, v99
  v_pk_add_f32 v[42:43], v[42:43], v[8:9]
  v_lshlrev_b32 v8, 16, v100
  v_and_b32 v9, 0xffff0000, v100
  v_pk_add_f32 v[36:37], v[36:37], v[8:9]
  v_lshlrev_b32 v8, 16, v101
  v_and_b32 v9, 0xffff0000, v101
  v_pk_add_f32 v[38:39], v[38:39], v[8:9]
  v_lshlrev_b32 v8, 16, v102
  v_and_b32 v9, 0xffff0000, v102
  v_pk_add_f32 v[40:41], v[40:41], v[8:9]
  v_lshlrev_b32 v8, 16, v103
  v_and_b32 v9, 0xffff0000, v103
  v_pk_add_f32 v[42:43], v[42:43], v[8:9]
  v_lshlrev_b32 v8, 16, v104
  v_and_b32 v9, 0xffff0000, v104
  v_pk_add_f32 v[36:37], v[36:37], v[8:9]
  v_lshlrev_b32 v8, 16, v105
  v_and_b32 v9, 0xffff0000, v105
  v_pk_add_f32 v[38:39], v[38:39], v[8:9]
  v_lshlrev_b32 v8, 16, v106
  v_and_b32 v9, 0xffff0000, v106
  v_pk_add_f32 v[40:41], v[40:41], v[8:9]
  v_lshlrev_b32 v8, 16, v107
  v_and_b32 v9, 0xffff0000, v107
  v_pk_add_f32 v[42:43], v[42:43], v[8:9]
  v_lshlrev_b32 v8, 16, v108
  v_and_b32 v9, 0xffff0000, v108
  v_pk_add_f32 v[36:37], v[36:37], v[8:9]
  v_lshlrev_b32 v8, 16, v109
  v_and_b32 v9, 0xffff0000, v109
  v_pk_add_f32 v[38:39], v[38:39], v[8:9]
  v_lshlrev_b32 v8, 16, v110
  v_and_b32 v9, 0xffff0000, v110
  v_pk_add_f32 v[40:41], v[40:41], v[8:9]
  v_lshlrev_b32 v8, 16, v111
  v_and_b32 v9, 0xffff0000, v111
  v_pk_add_f32 v[42:43], v[42:43], v[8:9]
  v_cvt_pk_bf16_f32 v8, v36, v37
  v_lshlrev_b32 v36, 16, v8
  v_and_b32 v37, 0xffff0000, v8
  v_lshlrev_b32 v10, 16, v16
  v_and_b32 v11, 0xffff0000, v16
  v_pk_add_f32 v[36:37], v[36:37], v[10:11]
  v_cvt_pk_bf16_f32 v16, v36, v37
  v_lshlrev_b32 v36, 16, v16
  v_and_b32 v37, 0xffff0000, v16
  v_cvt_pk_bf16_f32 v8, v38, v39
  v_lshlrev_b32 v38, 16, v8
  v_and_b32 v39, 0xffff0000, v8
  v_lshlrev_b32 v10, 16, v17
  v_and_b32 v11, 0xffff0000, v17
  v_pk_add_f32 v[38:39], v[38:39], v[10:11]
  v_cvt_pk_bf16_f32 v17, v38, v39
  v_lshlrev_b32 v38, 16, v17
  v_and_b32 v39, 0xffff0000, v17
  v_cvt_pk_bf16_f32 v8, v40, v41
  v_lshlrev_b32 v40, 16, v8
  v_and_b32 v41, 0xffff0000, v8
  v_lshlrev_b32 v10, 16, v18
  v_and_b32 v11, 0xffff0000, v18
  v_pk_add_f32 v[40:41], v[40:41], v[10:11]
  v_cvt_pk_bf16_f32 v18, v40, v41
  v_lshlrev_b32 v40, 16, v18
  v_and_b32 v41, 0xffff0000, v18
  v_cvt_pk_bf16_f32 v8, v42, v43
  v_lshlrev_b32 v42, 16, v8
  v_and_b32 v43, 0xffff0000, v8
  v_lshlrev_b32 v10, 16, v19
  v_and_b32 v11, 0xffff0000, v19
  v_pk_add_f32 v[42:43], v[42:43], v[10:11]
  v_cvt_pk_bf16_f32 v19, v42, v43
  v_lshlrev_b32 v42, 16, v19
  v_and_b32 v43, 0xffff0000, v19
  buffer_store_dwordx4 v[16:19], v15, s[4:7], s21 offen offset:0 sc1
  s_waitcnt vmcnt(25)
  v_lshlrev_b32 v44, 16, v112
  v_and_b32 v45, 0xffff0000, v112
  v_lshlrev_b32 v46, 16, v113
  v_and_b32 v47, 0xffff0000, v113
  v_lshlrev_b32 v48, 16, v114
  v_and_b32 v49, 0xffff0000, v114
  v_lshlrev_b32 v50, 16, v115
  v_and_b32 v51, 0xffff0000, v115
  v_lshlrev_b32 v8, 16, v116
  v_and_b32 v9, 0xffff0000, v116
  v_pk_add_f32 v[44:45], v[44:45], v[8:9]
  v_lshlrev_b32 v8, 16, v117
  v_and_b32 v9, 0xffff0000, v117
  v_pk_add_f32 v[46:47], v[46:47], v[8:9]
  v_lshlrev_b32 v8, 16, v118
  v_and_b32 v9, 0xffff0000, v118
  v_pk_add_f32 v[48:49], v[48:49], v[8:9]
  v_lshlrev_b32 v8, 16, v119
  v_and_b32 v9, 0xffff0000, v119
  v_pk_add_f32 v[50:51], v[50:51], v[8:9]
  v_lshlrev_b32 v8, 16, v120
  v_and_b32 v9, 0xffff0000, v120
  v_pk_add_f32 v[44:45], v[44:45], v[8:9]
  v_lshlrev_b32 v8, 16, v121
  v_and_b32 v9, 0xffff0000, v121
  v_pk_add_f32 v[46:47], v[46:47], v[8:9]
  v_lshlrev_b32 v8, 16, v122
  v_and_b32 v9, 0xffff0000, v122
  v_pk_add_f32 v[48:49], v[48:49], v[8:9]
  v_lshlrev_b32 v8, 16, v123
  v_and_b32 v9, 0xffff0000, v123
  v_pk_add_f32 v[50:51], v[50:51], v[8:9]
  v_lshlrev_b32 v8, 16, v124
  v_and_b32 v9, 0xffff0000, v124
  v_pk_add_f32 v[44:45], v[44:45], v[8:9]
  v_lshlrev_b32 v8, 16, v125
  v_and_b32 v9, 0xffff0000, v125
  v_pk_add_f32 v[46:47], v[46:47], v[8:9]
  v_lshlrev_b32 v8, 16, v126
  v_and_b32 v9, 0xffff0000, v126
  v_pk_add_f32 v[48:49], v[48:49], v[8:9]
  v_lshlrev_b32 v8, 16, v127
  v_and_b32 v9, 0xffff0000, v127
  v_pk_add_f32 v[50:51], v[50:51], v[8:9]
  v_lshlrev_b32 v8, 16, v128
  v_and_b32 v9, 0xffff0000, v128
  v_pk_add_f32 v[44:45], v[44:45], v[8:9]
  v_lshlrev_b32 v8, 16, v129
  v_and_b32 v9, 0xffff0000, v129
  v_pk_add_f32 v[46:47], v[46:47], v[8:9]
  v_lshlrev_b32 v8, 16, v130
  v_and_b32 v9, 0xffff0000, v130
  v_pk_add_f32 v[48:49], v[48:49], v[8:9]
  v_lshlrev_b32 v8, 16, v131
  v_and_b32 v9, 0xffff0000, v131
  v_pk_add_f32 v[50:51], v[50:51], v[8:9]
  v_lshlrev_b32 v8, 16, v132
  v_and_b32 v9, 0xffff0000, v132
  v_pk_add_f32 v[44:45], v[44:45], v[8:9]
  v_lshlrev_b32 v8, 16, v133
  v_and_b32 v9, 0xffff0000, v133
  v_pk_add_f32 v[46:47], v[46:47], v[8:9]
  v_lshlrev_b32 v8, 16, v134
  v_and_b32 v9, 0xffff0000, v134
  v_pk_add_f32 v[48:49], v[48:49], v[8:9]
  v_lshlrev_b32 v8, 16, v135
  v_and_b32 v9, 0xffff0000, v135
  v_pk_add_f32 v[50:51], v[50:51], v[8:9]
  v_lshlrev_b32 v8, 16, v136
  v_and_b32 v9, 0xffff0000, v136
  v_pk_add_f32 v[44:45], v[44:45], v[8:9]
  v_lshlrev_b32 v8, 16, v137
  v_and_b32 v9, 0xffff0000, v137
  v_pk_add_f32 v[46:47], v[46:47], v[8:9]
  v_lshlrev_b32 v8, 16, v138
  v_and_b32 v9, 0xffff0000, v138
  v_pk_add_f32 v[48:49], v[48:49], v[8:9]
  v_lshlrev_b32 v8, 16, v139
  v_and_b32 v9, 0xffff0000, v139
  v_pk_add_f32 v[50:51], v[50:51], v[8:9]
  v_lshlrev_b32 v8, 16, v140
  v_and_b32 v9, 0xffff0000, v140
  v_pk_add_f32 v[44:45], v[44:45], v[8:9]
  v_lshlrev_b32 v8, 16, v141
  v_and_b32 v9, 0xffff0000, v141
  v_pk_add_f32 v[46:47], v[46:47], v[8:9]
  v_lshlrev_b32 v8, 16, v142
  v_and_b32 v9, 0xffff0000, v142
  v_pk_add_f32 v[48:49], v[48:49], v[8:9]
  v_lshlrev_b32 v8, 16, v143
  v_and_b32 v9, 0xffff0000, v143
  v_pk_add_f32 v[50:51], v[50:51], v[8:9]
  v_cvt_pk_bf16_f32 v8, v44, v45
  v_lshlrev_b32 v44, 16, v8
  v_and_b32 v45, 0xffff0000, v8
  v_lshlrev_b32 v10, 16, v20
  v_and_b32 v11, 0xffff0000, v20
  v_pk_add_f32 v[44:45], v[44:45], v[10:11]
  v_cvt_pk_bf16_f32 v20, v44, v45
  v_lshlrev_b32 v44, 16, v20
  v_and_b32 v45, 0xffff0000, v20
  v_cvt_pk_bf16_f32 v8, v46, v47
  v_lshlrev_b32 v46, 16, v8
  v_and_b32 v47, 0xffff0000, v8
  v_lshlrev_b32 v10, 16, v21
  v_and_b32 v11, 0xffff0000, v21
  v_pk_add_f32 v[46:47], v[46:47], v[10:11]
  v_cvt_pk_bf16_f32 v21, v46, v47
  v_lshlrev_b32 v46, 16, v21
  v_and_b32 v47, 0xffff0000, v21
  v_cvt_pk_bf16_f32 v8, v48, v49
  v_lshlrev_b32 v48, 16, v8
  v_and_b32 v49, 0xffff0000, v8
  v_lshlrev_b32 v10, 16, v22
  v_and_b32 v11, 0xffff0000, v22
  v_pk_add_f32 v[48:49], v[48:49], v[10:11]
  v_cvt_pk_bf16_f32 v22, v48, v49
  v_lshlrev_b32 v48, 16, v22
  v_and_b32 v49, 0xffff0000, v22
  v_cvt_pk_bf16_f32 v8, v50, v51
  v_lshlrev_b32 v50, 16, v8
  v_and_b32 v51, 0xffff0000, v8
  v_lshlrev_b32 v10, 16, v23
  v_and_b32 v11, 0xffff0000, v23
  v_pk_add_f32 v[50:51], v[50:51], v[10:11]
  v_cvt_pk_bf16_f32 v23, v50, v51
  v_lshlrev_b32 v50, 16, v23
  v_and_b32 v51, 0xffff0000, v23
  buffer_store_dwordx4 v[20:23], v15, s[4:7], s21 offen offset:64 sc1
  s_waitcnt vmcnt(18)
  v_lshlrev_b32 v52, 16, v144
  v_and_b32 v53, 0xffff0000, v144
  v_lshlrev_b32 v54, 16, v145
  v_and_b32 v55, 0xffff0000, v145
  v_lshlrev_b32 v56, 16, v146
  v_and_b32 v57, 0xffff0000, v146
  v_lshlrev_b32 v58, 16, v147
  v_and_b32 v59, 0xffff0000, v147
  v_lshlrev_b32 v8, 16, v148
  v_and_b32 v9, 0xffff0000, v148
  v_pk_add_f32 v[52:53], v[52:53], v[8:9]
  v_lshlrev_b32 v8, 16, v149
  v_and_b32 v9, 0xffff0000, v149
  v_pk_add_f32 v[54:55], v[54:55], v[8:9]
  v_lshlrev_b32 v8, 16, v150
  v_and_b32 v9, 0xffff0000, v150
  v_pk_add_f32 v[56:57], v[56:57], v[8:9]
  v_lshlrev_b32 v8, 16, v151
  v_and_b32 v9, 0xffff0000, v151
  v_pk_add_f32 v[58:59], v[58:59], v[8:9]
  v_lshlrev_b32 v8, 16, v152
  v_and_b32 v9, 0xffff0000, v152
  v_pk_add_f32 v[52:53], v[52:53], v[8:9]
  v_lshlrev_b32 v8, 16, v153
  v_and_b32 v9, 0xffff0000, v153
  v_pk_add_f32 v[54:55], v[54:55], v[8:9]
  v_lshlrev_b32 v8, 16, v154
  v_and_b32 v9, 0xffff0000, v154
  v_pk_add_f32 v[56:57], v[56:57], v[8:9]
  v_lshlrev_b32 v8, 16, v155
  v_and_b32 v9, 0xffff0000, v155
  v_pk_add_f32 v[58:59], v[58:59], v[8:9]
  v_lshlrev_b32 v8, 16, v156
  v_and_b32 v9, 0xffff0000, v156
  v_pk_add_f32 v[52:53], v[52:53], v[8:9]
  v_lshlrev_b32 v8, 16, v157
  v_and_b32 v9, 0xffff0000, v157
  v_pk_add_f32 v[54:55], v[54:55], v[8:9]
  v_lshlrev_b32 v8, 16, v158
  v_and_b32 v9, 0xffff0000, v158
  v_pk_add_f32 v[56:57], v[56:57], v[8:9]
  v_lshlrev_b32 v8, 16, v159
  v_and_b32 v9, 0xffff0000, v159
  v_pk_add_f32 v[58:59], v[58:59], v[8:9]
  v_lshlrev_b32 v8, 16, v160
  v_and_b32 v9, 0xffff0000, v160
  v_pk_add_f32 v[52:53], v[52:53], v[8:9]
  v_lshlrev_b32 v8, 16, v161
  v_and_b32 v9, 0xffff0000, v161
  v_pk_add_f32 v[54:55], v[54:55], v[8:9]
  v_lshlrev_b32 v8, 16, v162
  v_and_b32 v9, 0xffff0000, v162
  v_pk_add_f32 v[56:57], v[56:57], v[8:9]
  v_lshlrev_b32 v8, 16, v163
  v_and_b32 v9, 0xffff0000, v163
  v_pk_add_f32 v[58:59], v[58:59], v[8:9]
  v_lshlrev_b32 v8, 16, v164
  v_and_b32 v9, 0xffff0000, v164
  v_pk_add_f32 v[52:53], v[52:53], v[8:9]
  v_lshlrev_b32 v8, 16, v165
  v_and_b32 v9, 0xffff0000, v165
  v_pk_add_f32 v[54:55], v[54:55], v[8:9]
  v_lshlrev_b32 v8, 16, v166
  v_and_b32 v9, 0xffff0000, v166
  v_pk_add_f32 v[56:57], v[56:57], v[8:9]
  v_lshlrev_b32 v8, 16, v167
  v_and_b32 v9, 0xffff0000, v167
  v_pk_add_f32 v[58:59], v[58:59], v[8:9]
  v_lshlrev_b32 v8, 16, v168
  v_and_b32 v9, 0xffff0000, v168
  v_pk_add_f32 v[52:53], v[52:53], v[8:9]
  v_lshlrev_b32 v8, 16, v169
  v_and_b32 v9, 0xffff0000, v169
  v_pk_add_f32 v[54:55], v[54:55], v[8:9]
  v_lshlrev_b32 v8, 16, v170
  v_and_b32 v9, 0xffff0000, v170
  v_pk_add_f32 v[56:57], v[56:57], v[8:9]
  v_lshlrev_b32 v8, 16, v171
  v_and_b32 v9, 0xffff0000, v171
  v_pk_add_f32 v[58:59], v[58:59], v[8:9]
  v_lshlrev_b32 v8, 16, v172
  v_and_b32 v9, 0xffff0000, v172
  v_pk_add_f32 v[52:53], v[52:53], v[8:9]
  v_lshlrev_b32 v8, 16, v173
  v_and_b32 v9, 0xffff0000, v173
  v_pk_add_f32 v[54:55], v[54:55], v[8:9]
  v_lshlrev_b32 v8, 16, v174
  v_and_b32 v9, 0xffff0000, v174
  v_pk_add_f32 v[56:57], v[56:57], v[8:9]
  v_lshlrev_b32 v8, 16, v175
  v_and_b32 v9, 0xffff0000, v175
  v_pk_add_f32 v[58:59], v[58:59], v[8:9]
  v_cvt_pk_bf16_f32 v8, v52, v53
  v_lshlrev_b32 v52, 16, v8
  v_and_b32 v53, 0xffff0000, v8
  v_lshlrev_b32 v10, 16, v24
  v_and_b32 v11, 0xffff0000, v24
  v_pk_add_f32 v[52:53], v[52:53], v[10:11]
  v_cvt_pk_bf16_f32 v24, v52, v53
  v_lshlrev_b32 v52, 16, v24
  v_and_b32 v53, 0xffff0000, v24
  v_cvt_pk_bf16_f32 v8, v54, v55
  v_lshlrev_b32 v54, 16, v8
  v_and_b32 v55, 0xffff0000, v8
  v_lshlrev_b32 v10, 16, v25
  v_and_b32 v11, 0xffff0000, v25
  v_pk_add_f32 v[54:55], v[54:55], v[10:11]
  v_cvt_pk_bf16_f32 v25, v54, v55
  v_lshlrev_b32 v54, 16, v25
  v_and_b32 v55, 0xffff0000, v25
  v_cvt_pk_bf16_f32 v8, v56, v57
  v_lshlrev_b32 v56, 16, v8
  v_and_b32 v57, 0xffff0000, v8
  v_lshlrev_b32 v10, 16, v26
  v_and_b32 v11, 0xffff0000, v26
  v_pk_add_f32 v[56:57], v[56:57], v[10:11]
  v_cvt_pk_bf16_f32 v26, v56, v57
  v_lshlrev_b32 v56, 16, v26
  v_and_b32 v57, 0xffff0000, v26
  v_cvt_pk_bf16_f32 v8, v58, v59
  v_lshlrev_b32 v58, 16, v8
  v_and_b32 v59, 0xffff0000, v8
  v_lshlrev_b32 v10, 16, v27
  v_and_b32 v11, 0xffff0000, v27
  v_pk_add_f32 v[58:59], v[58:59], v[10:11]
  v_cvt_pk_bf16_f32 v27, v58, v59
  v_lshlrev_b32 v58, 16, v27
  v_and_b32 v59, 0xffff0000, v27
  buffer_store_dwordx4 v[24:27], v15, s[4:7], s21 offen offset:128 sc1
  s_waitcnt vmcnt(11)
  v_lshlrev_b32 v60, 16, v176
  v_and_b32 v61, 0xffff0000, v176
  v_lshlrev_b32 v62, 16, v177
  v_and_b32 v63, 0xffff0000, v177
  v_lshlrev_b32 v64, 16, v178
  v_and_b32 v65, 0xffff0000, v178
  v_lshlrev_b32 v66, 16, v179
  v_and_b32 v67, 0xffff0000, v179
  v_lshlrev_b32 v8, 16, v180
  v_and_b32 v9, 0xffff0000, v180
  v_pk_add_f32 v[60:61], v[60:61], v[8:9]
  v_lshlrev_b32 v8, 16, v181
  v_and_b32 v9, 0xffff0000, v181
  v_pk_add_f32 v[62:63], v[62:63], v[8:9]
  v_lshlrev_b32 v8, 16, v182
  v_and_b32 v9, 0xffff0000, v182
  v_pk_add_f32 v[64:65], v[64:65], v[8:9]
  v_lshlrev_b32 v8, 16, v183
  v_and_b32 v9, 0xffff0000, v183
  v_pk_add_f32 v[66:67], v[66:67], v[8:9]
  v_lshlrev_b32 v8, 16, v184
  v_and_b32 v9, 0xffff0000, v184
  v_pk_add_f32 v[60:61], v[60:61], v[8:9]
  v_lshlrev_b32 v8, 16, v185
  v_and_b32 v9, 0xffff0000, v185
  v_pk_add_f32 v[62:63], v[62:63], v[8:9]
  v_lshlrev_b32 v8, 16, v186
  v_and_b32 v9, 0xffff0000, v186
  v_pk_add_f32 v[64:65], v[64:65], v[8:9]
  v_lshlrev_b32 v8, 16, v187
  v_and_b32 v9, 0xffff0000, v187
  v_pk_add_f32 v[66:67], v[66:67], v[8:9]
  v_lshlrev_b32 v8, 16, v188
  v_and_b32 v9, 0xffff0000, v188
  v_pk_add_f32 v[60:61], v[60:61], v[8:9]
  v_lshlrev_b32 v8, 16, v189
  v_and_b32 v9, 0xffff0000, v189
  v_pk_add_f32 v[62:63], v[62:63], v[8:9]
  v_lshlrev_b32 v8, 16, v190
  v_and_b32 v9, 0xffff0000, v190
  v_pk_add_f32 v[64:65], v[64:65], v[8:9]
  v_lshlrev_b32 v8, 16, v191
  v_and_b32 v9, 0xffff0000, v191
  v_pk_add_f32 v[66:67], v[66:67], v[8:9]
  v_lshlrev_b32 v8, 16, v192
  v_and_b32 v9, 0xffff0000, v192
  v_pk_add_f32 v[60:61], v[60:61], v[8:9]
  v_lshlrev_b32 v8, 16, v193
  v_and_b32 v9, 0xffff0000, v193
  v_pk_add_f32 v[62:63], v[62:63], v[8:9]
  v_lshlrev_b32 v8, 16, v194
  v_and_b32 v9, 0xffff0000, v194
  v_pk_add_f32 v[64:65], v[64:65], v[8:9]
  v_lshlrev_b32 v8, 16, v195
  v_and_b32 v9, 0xffff0000, v195
  v_pk_add_f32 v[66:67], v[66:67], v[8:9]
  v_lshlrev_b32 v8, 16, v196
  v_and_b32 v9, 0xffff0000, v196
  v_pk_add_f32 v[60:61], v[60:61], v[8:9]
  v_lshlrev_b32 v8, 16, v197
  v_and_b32 v9, 0xffff0000, v197
  v_pk_add_f32 v[62:63], v[62:63], v[8:9]
  v_lshlrev_b32 v8, 16, v198
  v_and_b32 v9, 0xffff0000, v198
  v_pk_add_f32 v[64:65], v[64:65], v[8:9]
  v_lshlrev_b32 v8, 16, v199
  v_and_b32 v9, 0xffff0000, v199
  v_pk_add_f32 v[66:67], v[66:67], v[8:9]
  v_lshlrev_b32 v8, 16, v200
  v_and_b32 v9, 0xffff0000, v200
  v_pk_add_f32 v[60:61], v[60:61], v[8:9]
  v_lshlrev_b32 v8, 16, v201
  v_and_b32 v9, 0xffff0000, v201
  v_pk_add_f32 v[62:63], v[62:63], v[8:9]
  v_lshlrev_b32 v8, 16, v202
  v_and_b32 v9, 0xffff0000, v202
  v_pk_add_f32 v[64:65], v[64:65], v[8:9]
  v_lshlrev_b32 v8, 16, v203
  v_and_b32 v9, 0xffff0000, v203
  v_pk_add_f32 v[66:67], v[66:67], v[8:9]
  v_lshlrev_b32 v8, 16, v204
  v_and_b32 v9, 0xffff0000, v204
  v_pk_add_f32 v[60:61], v[60:61], v[8:9]
  v_lshlrev_b32 v8, 16, v205
  v_and_b32 v9, 0xffff0000, v205
  v_pk_add_f32 v[62:63], v[62:63], v[8:9]
  v_lshlrev_b32 v8, 16, v206
  v_and_b32 v9, 0xffff0000, v206
  v_pk_add_f32 v[64:65], v[64:65], v[8:9]
  v_lshlrev_b32 v8, 16, v207
  v_and_b32 v9, 0xffff0000, v207
  v_pk_add_f32 v[66:67], v[66:67], v[8:9]
  v_cvt_pk_bf16_f32 v8, v60, v61
  v_lshlrev_b32 v60, 16, v8
  v_and_b32 v61, 0xffff0000, v8
  v_lshlrev_b32 v10, 16, v28
  v_and_b32 v11, 0xffff0000, v28
  v_pk_add_f32 v[60:61], v[60:61], v[10:11]
  v_cvt_pk_bf16_f32 v28, v60, v61
  v_lshlrev_b32 v60, 16, v28
  v_and_b32 v61, 0xffff0000, v28
  v_cvt_pk_bf16_f32 v8, v62, v63
  v_lshlrev_b32 v62, 16, v8
  v_and_b32 v63, 0xffff0000, v8
  v_lshlrev_b32 v10, 16, v29
  v_and_b32 v11, 0xffff0000, v29
  v_pk_add_f32 v[62:63], v[62:63], v[10:11]
  v_cvt_pk_bf16_f32 v29, v62, v63
  v_lshlrev_b32 v62, 16, v29
  v_and_b32 v63, 0xffff0000, v29
  v_cvt_pk_bf16_f32 v8, v64, v65
  v_lshlrev_b32 v64, 16, v8
  v_and_b32 v65, 0xffff0000, v8
  v_lshlrev_b32 v10, 16, v30
  v_and_b32 v11, 0xffff0000, v30
  v_pk_add_f32 v[64:65], v[64:65], v[10:11]
  v_cvt_pk_bf16_f32 v30, v64, v65
  v_lshlrev_b32 v64, 16, v30
  v_and_b32 v65, 0xffff0000, v30
  v_cvt_pk_bf16_f32 v8, v66, v67
  v_lshlrev_b32 v66, 16, v8
  v_and_b32 v67, 0xffff0000, v8
  v_lshlrev_b32 v10, 16, v31
  v_and_b32 v11, 0xffff0000, v31
  v_pk_add_f32 v[66:67], v[66:67], v[10:11]
  v_cvt_pk_bf16_f32 v31, v66, v67
  v_lshlrev_b32 v66, 16, v31
  v_and_b32 v67, 0xffff0000, v31
  buffer_store_dwordx4 v[28:31], v15, s[4:7], s21 offen offset:192 sc1
  s_waitcnt vmcnt(4)
  v_lshlrev_b32 v68, 16, v208
  v_and_b32 v69, 0xffff0000, v208
  v_lshlrev_b32 v70, 16, v209
  v_and_b32 v71, 0xffff0000, v209
  v_lshlrev_b32 v72, 16, v210
  v_and_b32 v73, 0xffff0000, v210
  v_lshlrev_b32 v74, 16, v211
  v_and_b32 v75, 0xffff0000, v211
  v_lshlrev_b32 v8, 16, v212
  v_and_b32 v9, 0xffff0000, v212
  v_pk_add_f32 v[68:69], v[68:69], v[8:9]
  v_lshlrev_b32 v8, 16, v213
  v_and_b32 v9, 0xffff0000, v213
  v_pk_add_f32 v[70:71], v[70:71], v[8:9]
  v_lshlrev_b32 v8, 16, v214
  v_and_b32 v9, 0xffff0000, v214
  v_pk_add_f32 v[72:73], v[72:73], v[8:9]
  v_lshlrev_b32 v8, 16, v215
  v_and_b32 v9, 0xffff0000, v215
  v_pk_add_f32 v[74:75], v[74:75], v[8:9]
  v_lshlrev_b32 v8, 16, v216
  v_and_b32 v9, 0xffff0000, v216
  v_pk_add_f32 v[68:69], v[68:69], v[8:9]
  v_lshlrev_b32 v8, 16, v217
  v_and_b32 v9, 0xffff0000, v217
  v_pk_add_f32 v[70:71], v[70:71], v[8:9]
  v_lshlrev_b32 v8, 16, v218
  v_and_b32 v9, 0xffff0000, v218
  v_pk_add_f32 v[72:73], v[72:73], v[8:9]
  v_lshlrev_b32 v8, 16, v219
  v_and_b32 v9, 0xffff0000, v219
  v_pk_add_f32 v[74:75], v[74:75], v[8:9]
  v_lshlrev_b32 v8, 16, v220
  v_and_b32 v9, 0xffff0000, v220
  v_pk_add_f32 v[68:69], v[68:69], v[8:9]
  v_lshlrev_b32 v8, 16, v221
  v_and_b32 v9, 0xffff0000, v221
  v_pk_add_f32 v[70:71], v[70:71], v[8:9]
  v_lshlrev_b32 v8, 16, v222
  v_and_b32 v9, 0xffff0000, v222
  v_pk_add_f32 v[72:73], v[72:73], v[8:9]
  v_lshlrev_b32 v8, 16, v223
  v_and_b32 v9, 0xffff0000, v223
  v_pk_add_f32 v[74:75], v[74:75], v[8:9]
  v_lshlrev_b32 v8, 16, v224
  v_and_b32 v9, 0xffff0000, v224
  v_pk_add_f32 v[68:69], v[68:69], v[8:9]
  v_lshlrev_b32 v8, 16, v225
  v_and_b32 v9, 0xffff0000, v225
  v_pk_add_f32 v[70:71], v[70:71], v[8:9]
  v_lshlrev_b32 v8, 16, v226
  v_and_b32 v9, 0xffff0000, v226
  v_pk_add_f32 v[72:73], v[72:73], v[8:9]
  v_lshlrev_b32 v8, 16, v227
  v_and_b32 v9, 0xffff0000, v227
  v_pk_add_f32 v[74:75], v[74:75], v[8:9]
  v_lshlrev_b32 v8, 16, v228
  v_and_b32 v9, 0xffff0000, v228
  v_pk_add_f32 v[68:69], v[68:69], v[8:9]
  v_lshlrev_b32 v8, 16, v229
  v_and_b32 v9, 0xffff0000, v229
  v_pk_add_f32 v[70:71], v[70:71], v[8:9]
  v_lshlrev_b32 v8, 16, v230
  v_and_b32 v9, 0xffff0000, v230
  v_pk_add_f32 v[72:73], v[72:73], v[8:9]
  v_lshlrev_b32 v8, 16, v231
  v_and_b32 v9, 0xffff0000, v231
  v_pk_add_f32 v[74:75], v[74:75], v[8:9]
  v_lshlrev_b32 v8, 16, v232
  v_and_b32 v9, 0xffff0000, v232
  v_pk_add_f32 v[68:69], v[68:69], v[8:9]
  v_lshlrev_b32 v8, 16, v233
  v_and_b32 v9, 0xffff0000, v233
  v_pk_add_f32 v[70:71], v[70:71], v[8:9]
  v_lshlrev_b32 v8, 16, v234
  v_and_b32 v9, 0xffff0000, v234
  v_pk_add_f32 v[72:73], v[72:73], v[8:9]
  v_lshlrev_b32 v8, 16, v235
  v_and_b32 v9, 0xffff0000, v235
  v_pk_add_f32 v[74:75], v[74:75], v[8:9]
  v_lshlrev_b32 v8, 16, v236
  v_and_b32 v9, 0xffff0000, v236
  v_pk_add_f32 v[68:69], v[68:69], v[8:9]
  v_lshlrev_b32 v8, 16, v237
  v_and_b32 v9, 0xffff0000, v237
  v_pk_add_f32 v[70:71], v[70:71], v[8:9]
  v_lshlrev_b32 v8, 16, v238
  v_and_b32 v9, 0xffff0000, v238
  v_pk_add_f32 v[72:73], v[72:73], v[8:9]
  v_lshlrev_b32 v8, 16, v239
  v_and_b32 v9, 0xffff0000, v239
  v_pk_add_f32 v[74:75], v[74:75], v[8:9]
  v_cvt_pk_bf16_f32 v8, v68, v69
  v_lshlrev_b32 v68, 16, v8
  v_and_b32 v69, 0xffff0000, v8
  v_lshlrev_b32 v10, 16, v32
  v_and_b32 v11, 0xffff0000, v32
  v_pk_add_f32 v[68:69], v[68:69], v[10:11]
  v_cvt_pk_bf16_f32 v32, v68, v69
  v_lshlrev_b32 v68, 16, v32
  v_and_b32 v69, 0xffff0000, v32
  v_cvt_pk_bf16_f32 v8, v70, v71
  v_lshlrev_b32 v70, 16, v8
  v_and_b32 v71, 0xffff0000, v8
  v_lshlrev_b32 v10, 16, v33
  v_and_b32 v11, 0xffff0000, v33
  v_pk_add_f32 v[70:71], v[70:71], v[10:11]
  v_cvt_pk_bf16_f32 v33, v70, v71
  v_lshlrev_b32 v70, 16, v33
  v_and_b32 v71, 0xffff0000, v33
  v_cvt_pk_bf16_f32 v8, v72, v73
  v_lshlrev_b32 v72, 16, v8
  v_and_b32 v73, 0xffff0000, v8
  v_lshlrev_b32 v10, 16, v34
  v_and_b32 v11, 0xffff0000, v34
  v_pk_add_f32 v[72:73], v[72:73], v[10:11]
  v_cvt_pk_bf16_f32 v34, v72, v73
  v_lshlrev_b32 v72, 16, v34
  v_and_b32 v73, 0xffff0000, v34
  v_cvt_pk_bf16_f32 v8, v74, v75
  v_lshlrev_b32 v74, 16, v8
  v_and_b32 v75, 0xffff0000, v8
  v_lshlrev_b32 v10, 16, v35
  v_and_b32 v11, 0xffff0000, v35
  v_pk_add_f32 v[74:75], v[74:75], v[10:11]
  v_cvt_pk_bf16_f32 v35, v74, v75
  v_lshlrev_b32 v74, 16, v35
  v_and_b32 v75, 0xffff0000, v35
  buffer_store_dwordx4 v[32:35], v15, s[4:7], s21 offen offset:256 sc1
  v_and_b32 v3, 63, v0
  v_and_b32 v2, 15, v3
  v_lshlrev_b32 v5, 2, v2
  s_lshl_b32 s17, s16, 6
  v_add_u32 v1, s17, v5
  v_pk_add_f32 v[6:7], v[36:37], v[38:39]
  v_pk_add_f32 v[6:7], v[6:7], v[40:41]
  v_pk_add_f32 v[6:7], v[6:7], v[42:43]
  v_pk_add_f32 v[6:7], v[6:7], v[44:45]
  v_pk_add_f32 v[6:7], v[6:7], v[46:47]
  v_pk_add_f32 v[6:7], v[6:7], v[48:49]
  v_pk_add_f32 v[6:7], v[6:7], v[50:51]
  v_pk_add_f32 v[6:7], v[6:7], v[52:53]
  v_pk_add_f32 v[6:7], v[6:7], v[54:55]
  v_pk_add_f32 v[6:7], v[6:7], v[56:57]
  v_pk_add_f32 v[6:7], v[6:7], v[58:59]
  v_pk_add_f32 v[6:7], v[6:7], v[60:61]
  v_pk_add_f32 v[6:7], v[6:7], v[62:63]
  v_pk_add_f32 v[6:7], v[6:7], v[64:65]
  v_pk_add_f32 v[6:7], v[6:7], v[66:67]
  v_pk_add_f32 v[6:7], v[6:7], v[68:69]
  v_pk_add_f32 v[6:7], v[6:7], v[70:71]
  v_pk_add_f32 v[6:7], v[6:7], v[72:73]
  v_pk_add_f32 v[6:7], v[6:7], v[74:75]
  v_add_f32 v4, v6, v7
  v_mov_b32 v2, v4
  s_nop 1
  v_permlane32_swap_b32 v4, v2
  v_add_f32 v4, v4, v2
  v_mov_b32 v2, v4
  s_nop 1
  v_permlane16_swap_b32 v4, v2
  v_add_f32 v4, v4, v2
  ds_write_b32 v1, v4 offset:0
  s_waitcnt lgkmcnt(0)
  s_barrier
  ds_read_b32 v4, v5 offset:0
  ds_read_b32 v2, v5 offset:64
  ds_read_b32 v3, v5 offset:128
  ds_read_b32 v6, v5 offset:192
  s_waitcnt lgkmcnt(0)
  v_add_f32 v4, v4, v2
  v_add_f32 v3, v3, v6
  v_add_f32 v4, v4, v3
  v_mul_f32 v6, 0xbacccccd, v4
  v_mov_b32 v7, v6
  v_pk_add_f32 v[36:37], v[36:37], v[6:7]
  v_pk_add_f32 v[38:39], v[38:39], v[6:7]
  v_pk_add_f32 v[40:41], v[40:41], v[6:7]
  v_pk_add_f32 v[42:43], v[42:43], v[6:7]
  v_pk_add_f32 v[44:45], v[44:45], v[6:7]
  v_pk_add_f32 v[46:47], v[46:47], v[6:7]
  v_pk_add_f32 v[48:49], v[48:49], v[6:7]
  v_pk_add_f32 v[50:51], v[50:51], v[6:7]
  v_pk_add_f32 v[52:53], v[52:53], v[6:7]
  v_pk_add_f32 v[54:55], v[54:55], v[6:7]
  v_pk_add_f32 v[56:57], v[56:57], v[6:7]
  v_pk_add_f32 v[58:59], v[58:59], v[6:7]
  v_pk_add_f32 v[60:61], v[60:61], v[6:7]
  v_pk_add_f32 v[62:63], v[62:63], v[6:7]
  v_pk_add_f32 v[64:65], v[64:65], v[6:7]
  v_pk_add_f32 v[66:67], v[66:67], v[6:7]
  v_pk_add_f32 v[68:69], v[68:69], v[6:7]
  v_pk_add_f32 v[70:71], v[70:71], v[6:7]
  v_pk_add_f32 v[72:73], v[72:73], v[6:7]
  v_pk_add_f32 v[74:75], v[74:75], v[6:7]
  v_pk_mul_f32 v[6:7], v[36:37], v[36:37]
  v_pk_fma_f32 v[6:7], v[38:39], v[38:39], v[6:7]
  v_pk_fma_f32 v[6:7], v[40:41], v[40:41], v[6:7]
  v_pk_fma_f32 v[6:7], v[42:43], v[42:43], v[6:7]
  v_pk_fma_f32 v[6:7], v[44:45], v[44:45], v[6:7]
  v_pk_fma_f32 v[6:7], v[46:47], v[46:47], v[6:7]
  v_pk_fma_f32 v[6:7], v[48:49], v[48:49], v[6:7]
  v_pk_fma_f32 v[6:7], v[50:51], v[50:51], v[6:7]
  v_pk_fma_f32 v[6:7], v[52:53], v[52:53], v[6:7]
  v_pk_fma_f32 v[6:7], v[54:55], v[54:55], v[6:7]
  v_pk_fma_f32 v[6:7], v[56:57], v[56:57], v[6:7]
  v_pk_fma_f32 v[6:7], v[58:59], v[58:59], v[6:7]
  v_pk_fma_f32 v[6:7], v[60:61], v[60:61], v[6:7]
  v_pk_fma_f32 v[6:7], v[62:63], v[62:63], v[6:7]
  v_pk_fma_f32 v[6:7], v[64:65], v[64:65], v[6:7]
  v_pk_fma_f32 v[6:7], v[66:67], v[66:67], v[6:7]
  v_pk_fma_f32 v[6:7], v[68:69], v[68:69], v[6:7]
  v_pk_fma_f32 v[6:7], v[70:71], v[70:71], v[6:7]
  v_pk_fma_f32 v[6:7], v[72:73], v[72:73], v[6:7]
  v_pk_fma_f32 v[6:7], v[74:75], v[74:75], v[6:7]
  v_add_f32 v4, v6, v7
  v_mov_b32 v2, v4
  s_nop 1
  v_permlane32_swap_b32 v4, v2
  v_add_f32 v4, v4, v2
  v_mov_b32 v2, v4
  s_nop 1
  v_permlane16_swap_b32 v4, v2
  v_add_f32 v4, v4, v2
  ds_write_b32 v1, v4 offset:256
  s_waitcnt lgkmcnt(0)
  s_barrier
  ds_read_b32 v4, v5 offset:256
  ds_read_b32 v2, v5 offset:320
  ds_read_b32 v3, v5 offset:384
  ds_read_b32 v6, v5 offset:448
  s_waitcnt lgkmcnt(0)
  v_add_f32 v4, v4, v2
  v_add_f32 v3, v3, v6
  v_add_f32 v4, v4, v3
  v_mov_b32 v2, 0x3727c5ac
  v_fmac_f32 v2, 0x3acccccd, v4
  v_rsq_f32 v6, v2
  s_nop 0
  v_mov_b32 v7, v6
  v_pk_mul_f32 v[36:37], v[36:37], v[6:7]
  v_pk_mul_f32 v[38:39], v[38:39], v[6:7]
  v_pk_mul_f32 v[40:41], v[40:41], v[6:7]
  v_pk_mul_f32 v[42:43], v[42:43], v[6:7]
  v_pk_mul_f32 v[44:45], v[44:45], v[6:7]
  v_pk_mul_f32 v[46:47], v[46:47], v[6:7]
  v_pk_mul_f32 v[48:49], v[48:49], v[6:7]
  v_pk_mul_f32 v[50:51], v[50:51], v[6:7]
  v_pk_mul_f32 v[52:53], v[52:53], v[6:7]
  v_pk_mul_f32 v[54:55], v[54:55], v[6:7]
  v_pk_mul_f32 v[56:57], v[56:57], v[6:7]
  v_pk_mul_f32 v[58:59], v[58:59], v[6:7]
  v_pk_mul_f32 v[60:61], v[60:61], v[6:7]
  v_pk_mul_f32 v[62:63], v[62:63], v[6:7]
  v_pk_mul_f32 v[64:65], v[64:65], v[6:7]
  v_pk_mul_f32 v[66:67], v[66:67], v[6:7]
  v_pk_mul_f32 v[68:69], v[68:69], v[6:7]
  v_pk_mul_f32 v[70:71], v[70:71], v[6:7]
  v_pk_mul_f32 v[72:73], v[72:73], v[6:7]
  v_pk_mul_f32 v[74:75], v[74:75], v[6:7]
  v_cvt_pk_bf16_f32 v16, v36, v37
  v_cvt_pk_bf16_f32 v17, v38, v39
  v_cvt_pk_bf16_f32 v18, v40, v41
  v_cvt_pk_bf16_f32 v19, v42, v43
  v_cvt_pk_bf16_f32 v20, v44, v45
  v_cvt_pk_bf16_f32 v21, v46, v47
  v_cvt_pk_bf16_f32 v22, v48, v49
  v_cvt_pk_bf16_f32 v23, v50, v51
  v_cvt_pk_bf16_f32 v24, v52, v53
  v_cvt_pk_bf16_f32 v25, v54, v55
  v_cvt_pk_bf16_f32 v26, v56, v57
  v_cvt_pk_bf16_f32 v27, v58, v59
  v_cvt_pk_bf16_f32 v28, v60, v61
  v_cvt_pk_bf16_f32 v29, v62, v63
  v_cvt_pk_bf16_f32 v30, v64, v65
  v_cvt_pk_bf16_f32 v31, v66, v67
  v_cvt_pk_bf16_f32 v32, v68, v69
  v_cvt_pk_bf16_f32 v33, v70, v71
  v_cvt_pk_bf16_f32 v34, v72, v73
  v_cvt_pk_bf16_f32 v35, v74, v75
  v_and_b32 v3, 63, v0
  v_and_b32 v2, 15, v3
  v_lshlrev_b32 v1, 4, v2
  v_bfe_u32 v2, v3, 4, 1
  v_lshl_add_u32 v1, v2, 9, v1
  v_lshrrev_b32 v2, 5, v3
  v_lshl_add_u32 v1, v2, 10, v1
  s_lshr_b32 s17, s19, 1
  s_mul_i32 s17, s17, 40960
  s_and_b32 s18, s19, 1
  s_lshl_b32 s18, s18, 8
  s_add_u32 s17, s17, s18
  s_mul_i32 s18, s16, 10240
  s_add_u32 s17, s17, s18
  s_add_u32 s17, s17, 54525952
  buffer_store_dwordx4 v[16:19], v1, s[4:7], s17 offen offset:0 sc1
  buffer_store_dwordx4 v[20:23], v1, s[4:7], s17 offen offset:2048 sc1
  s_add_u32 s17, s17, 4096
  buffer_store_dwordx4 v[24:27], v1, s[4:7], s17 offen offset:0 sc1
  buffer_store_dwordx4 v[28:31], v1, s[4:7], s17 offen offset:2048 sc1
  s_add_u32 s17, s17, 4096
  buffer_store_dwordx4 v[32:35], v1, s[4:7], s17 offen offset:0 sc1
redln2_exit1:
  s_endpgm
.globl qkvb_kernel
.p2align 8
.type qkvb_kernel,@function
qkvb_kernel:
  s_cmp_ge_u32 s2, 256
  s_cbranch_scc1 qkvb_exit1
  s_load_dwordx2 s[12:13], s[0:1], 96
  v_lshrrev_b32 v2, 6, v0
  v_and_b32 v3, 63, v0
  s_nop 0
  v_readfirstlane_b32 s16, v2
  v_lshlrev_b32 v8, 4, v3
  s_and_b32 s17, s2, 7
  s_lshr_b32 s18, s2, 3
  s_waitcnt lgkmcnt(0)
  s_mov_b32 s4, s12
  s_mov_b32 s5, s13
  s_mov_b32 s6, 0x10000000
  s_mov_b32 s7, 0x20000
  s_and_b32 s19, s16, 1
  s_lshr_b32 s20, s16, 1
  s_mul_i32 s22, s19, 40960
  s_mul_i32 s21, s20, 5120
  s_add_u32 s22, s22, s21
  s_mul_i32 s21, s18, 81920
  s_add_u32 s21, s21, s22
  s_add_u32 s21, s21, 54525952
  s_lshl_b32 s23, s17, 2
  s_add_u32 s23, s23, s16
  s_mul_i32 s24, s23, 40960
  s_add_u32 s24, s24, 90177536
  s_add_u32 s25, s24, 1310720
  s_add_u32 s26, s25, 1310720
  s_add_u32 m0, s22, 0
  s_add_u32 s27, s21, 0
  buffer_load_dwordx4 v8, s[4:7], s27 offen offset:0 lds
  buffer_load_dwordx4 v8, s[4:7], s27 offen offset:1024 lds
  buffer_load_dwordx4 v8, s[4:7], s27 offen offset:2048 lds
  buffer_load_dwordx4 v8, s[4:7], s27 offen offset:3072 lds
  s_add_u32 m0, s22, 4096
  s_add_u32 s27, s21, 4096
  buffer_load_dwordx4 v8, s[4:7], s27 offen lds
  buffer_load_dwordx4 a[0:3], v8, s[4:7], s24 offen offset:0
  buffer_load_dwordx4 a[4:7], v8, s[4:7], s25 offen offset:0
  buffer_load_dwordx4 a[8:11], v8, s[4:7], s26 offen offset:0
  buffer_load_dwordx4 a[12:15], v8, s[4:7], s24 offen offset:1024
  buffer_load_dwordx4 a[16:19], v8, s[4:7], s25 offen offset:1024
  buffer_load_dwordx4 a[20:23], v8, s[4:7], s26 offen offset:1024
  buffer_load_dwordx4 a[24:27], v8, s[4:7], s24 offen offset:2048
  buffer_load_dwordx4 a[28:31], v8, s[4:7], s25 offen offset:2048
  buffer_load_dwordx4 a[32:35], v8, s[4:7], s26 offen offset:2048
  buffer_load_dwordx4 a[36:39], v8, s[4:7], s24 offen offset:3072
  buffer_load_dwordx4 a[40:43], v8, s[4:7], s25 offen offset:3072
  buffer_load_dwordx4 a[44:47], v8, s[4:7], s26 offen offset:3072
  s_add_u32 s24, s24, 4096
  s_add_u32 s25, s25, 4096
  s_add_u32 s26, s26, 4096
  s_add_u32 m0, s22, 10240
  s_add_u32 s27, s21, 10240
  buffer_load_dwordx4 v8, s[4:7], s27 offen offset:0 lds
  buffer_load_dwordx4 v8, s[4:7], s27 offen offset:1024 lds
  buffer_load_dwordx4 v8, s[4:7], s27 offen offset:2048 lds
  buffer_load_dwordx4 v8, s[4:7], s27 offen offset:3072 lds
  s_add_u32 m0, s22, 14336
  s_add_u32 s27, s21, 14336
  buffer_load_dwordx4 v8, s[4:7], s27 offen lds
  buffer_load_dwordx4 a[48:51], v8, s[4:7], s24 offen offset:0
  buffer_load_dwordx4 a[52:55], v8, s[4:7], s25 offen offset:0
  buffer_load_dwordx4 a[56:59], v8, s[4:7], s26 offen offset:0
  buffer_load_dwordx4 a[60:63], v8, s[4:7], s24 offen offset:1024
  buffer_load_dwordx4 a[64:67], v8, s[4:7], s25 offen offset:1024
  buffer_load_dwordx4 a[68:71], v8, s[4:7], s26 offen offset:1024
  buffer_load_dwordx4 a[72:75], v8, s[4:7], s24 offen offset:2048
  buffer_load_dwordx4 a[76:79], v8, s[4:7], s25 offen offset:2048
  buffer_load_dwordx4 a[80:83], v8, s[4:7], s26 offen offset:2048
  buffer_load_dwordx4 a[84:87], v8, s[4:7], s24 offen offset:3072
  buffer_load_dwordx4 a[88:91], v8, s[4:7], s25 offen offset:3072
  buffer_load_dwordx4 a[92:95], v8, s[4:7], s26 offen offset:3072
  s_add_u32 s24, s24, 4096
  s_add_u32 s25, s25, 4096
  s_add_u32 s26, s26, 4096
  s_add_u32 m0, s22, 20480
  s_add_u32 s27, s21, 20480
  buffer_load_dwordx4 v8, s[4:7], s27 offen offset:0 lds
  buffer_load_dwordx4 v8, s[4:7], s27 offen offset:1024 lds
  buffer_load_dwordx4 v8, s[4:7], s27 offen offset:2048 lds
  buffer_load_dwordx4 v8, s[4:7], s27 offen offset:3072 lds
  s_add_u32 m0, s22, 24576
  s_add_u32 s27, s21, 24576
  buffer_load_dwordx4 v8, s[4:7], s27 offen lds
  s_add_u32 m0, s22, 30720
  s_add_u32 s27, s21, 30720
  buffer_load_dwordx4 v8, s[4:7], s27 offen offset:0 lds
  buffer_load_dwordx4 v8, s[4:7], s27 offen offset:1024 lds
  buffer_load_dwordx4 v8, s[4:7], s27 offen offset:2048 lds
  buffer_load_dwordx4 v8, s[4:7], s27 offen offset:3072 lds
  s_add_u32 m0, s22, 34816
  s_add_u32 s27, s21, 34816
  buffer_load_dwordx4 v8, s[4:7], s27 offen lds
  v_add_u32 v9, 40960, v8
  s_waitcnt vmcnt(39)
  s_barrier
  ds_read_b128 v[16:19], v8 offset:0
  ds_read_b128 v[20:23], v9 offset:0
  ds_read_b128 v[24:27], v8 offset:1024
  ds_read_b128 v[28:31], v9 offset:1024
  buffer_load_dwordx4 a[96:99], v8, s[4:7], s24 offen offset:0
  buffer_load_dwordx4 a[100:103], v8, s[4:7], s25 offen offset:0
  buffer_load_dwordx4 a[104:107], v8, s[4:7], s26 offen offset:0
  buffer_load_dwordx4 a[108:111], v8, s[4:7], s24 offen offset:1024
  buffer_load_dwordx4 a[112:115], v8, s[4:7], s25 offen offset:1024
  buffer_load_dwordx4 a[116:119], v8, s[4:7], s26 offen offset:1024
  buffer_load_dwordx4 a[120:123], v8, s[4:7], s24 offen offset:2048
  buffer_load_dwordx4 a[124:127], v8, s[4:7], s25 offen offset:2048
  buffer_load_dwordx4 a[128:131], v8, s[4:7], s26 offen offset:2048
  buffer_load_dwordx4 a[132:135], v8, s[4:7], s24 offen offset:3072
  buffer_load_dwordx4 a[136:139], v8, s[4:7], s25 offen offset:3072
  buffer_load_dwordx4 a[140:143], v8, s[4:7], s26 offen offset:3072
  s_add_u32 s24, s24, 4096
  s_add_u32 s25, s25, 4096
  s_add_u32 s26, s26, 4096
  buffer_load_dwordx4 a[144:147], v8, s[4:7], s24 offen offset:0
  buffer_load_dwordx4 a[148:151], v8, s[4:7], s25 offen offset:0
  buffer_load_dwordx4 a[152:155], v8, s[4:7], s26 offen offset:0
  s_waitcnt vmcnt(51)
  ds_read_b128 v[32:35], v8 offset:2048
  ds_read_b128 v[36:39], v9 offset:2048
  s_waitcnt lgkmcnt(4)
  v_mfma_f32_32x32x16_bf16 v[96:111], a[0:3], v[16:19], 0
  v_mfma_f32_32x32x16_bf16 v[112:127], a[0:3], v[20:23], 0
  v_mfma_f32_32x32x16_bf16 v[128:143], a[4:7], v[16:19], 0
  v_mfma_f32_32x32x16_bf16 v[144:159], a[4:7], v[20:23], 0
  v_mfma_f32_32x32x16_bf16 v[160:175], v[16:19], a[8:11], 0
  v_mfma_f32_32x32x16_bf16 v[176:191], v[20:23], a[8:11], 0
  buffer_load_dwordx4 a[156:159], v8, s[4:7], s24 offen offset:1024
  buffer_load_dwordx4 a[160:163], v8, s[4:7], s25 offen offset:1024
  buffer_load_dwordx4 a[164:167], v8, s[4:7], s26 offen offset:1024
  s_waitcnt vmcnt(51)
  ds_read_b128 v[16:19], v8 offset:3072
  ds_read_b128 v[20:23], v9 offset:3072
  s_waitcnt lgkmcnt(4)
  v_mfma_f32_32x32x16_bf16 v[96:111], a[12:15], v[24:27], v[96:111]
  v_mfma_f32_32x32x16_bf16 v[112:127], a[12:15], v[28:31], v[112:127]
  v_mfma_f32_32x32x16_bf16 v[128:143], a[16:19], v[24:27], v[128:143]
  v_mfma_f32_32x32x16_bf16 v[144:159], a[16:19], v[28:31], v[144:159]
  v_mfma_f32_32x32x16_bf16 v[160:175], v[24:27], a[20:23], v[160:175]
  v_mfma_f32_32x32x16_bf16 v[176:191], v[28:31], a[20:23], v[176:191]
  buffer_load_dwordx4 a[168:171], v8, s[4:7], s24 offen offset:2048
  buffer_load_dwordx4 a[172:175], v8, s[4:7], s25 offen offset:2048
  buffer_load_dwordx4 a[176:179], v8, s[4:7], s26 offen offset:2048
  s_waitcnt vmcnt(51)
  ds_read_b128 v[24:27], v8 offset:4096
  ds_read_b128 v[28:31], v9 offset:4096
  s_waitcnt lgkmcnt(4)
  v_mfma_f32_32x32x16_bf16 v[96:111], a[24:27], v[32:35], v[96:111]
  v_mfma_f32_32x32x16_bf16 v[112:127], a[24:27], v[36:39], v[112:127]
  v_mfma_f32_32x32x16_bf16 v[128:143], a[28:31], v[32:35], v[128:143]
  v_mfma_f32_32x32x16_bf16 v[144:159], a[28:31], v[36:39], v[144:159]
  v_mfma_f32_32x32x16_bf16 v[160:175], v[32:35], a[32:35], v[160:175]
  v_mfma_f32_32x32x16_bf16 v[176:191], v[36:39], a[32:35], v[176:191]
  buffer_load_dwordx4 a[180:183], v8, s[4:7], s24 offen offset:3072
  buffer_load_dwordx4 a[184:187], v8, s[4:7], s25 offen offset:3072
  buffer_load_dwordx4 a[188:191], v8, s[4:7], s26 offen offset:3072
  s_add_u32 s24, s24, 4096
  s_add_u32 s25, s25, 4096
  s_add_u32 s26, s26, 4096
  s_waitcnt vmcnt(51)
  ds_read_b128 v[32:35], v8 offset:5120
  ds_read_b128 v[36:39], v9 offset:5120
  s_waitcnt lgkmcnt(4)
  v_mfma_f32_32x32x16_bf16 v[96:111], a[36:39], v[16:19], v[96:111]
  v_mfma_f32_32x32x16_bf16 v[112:127], a[36:39], v[20:23], v[112:127]
  v_mfma_f32_32x32x16_bf16 v[128:143], a[40:43], v[16:19], v[128:143]
  v_mfma_f32_32x32x16_bf16 v[144:159], a[40:43], v[20:23], v[144:159]
  v_mfma_f32_32x32x16_bf16 v[160:175], v[16:19], a[44:47], v[160:175]
  v_mfma_f32_32x32x16_bf16 v[176:191], v[20:23], a[44:47], v[176:191]
  buffer_load_dwordx4 a[0:3], v8, s[4:7], s24 offen offset:0
  buffer_load_dwordx4 a[4:7], v8, s[4:7], s25 offen offset:0
  buffer_load_dwordx4 a[8:11], v8, s[4:7], s26 offen offset:0
  s_waitcnt vmcnt(46)
  ds_read_b128 v[16:19], v8 offset:6144
  ds_read_b128 v[20:23], v9 offset:6144
  s_waitcnt lgkmcnt(4)
  v_mfma_f32_32x32x16_bf16 v[96:111], a[48:51], v[24:27], v[96:111]
  v_mfma_f32_32x32x16_bf16 v[112:127], a[48:51], v[28:31], v[112:127]
  v_mfma_f32_32x32x16_bf16 v[128:143], a[52:55], v[24:27], v[128:143]
  v_mfma_f32_32x32x16_bf16 v[144:159], a[52:55], v[28:31], v[144:159]
  v_mfma_f32_32x32x16_bf16 v[160:175], v[24:27], a[56:59], v[160:175]
  v_mfma_f32_32x32x16_bf16 v[176:191], v[28:31], a[56:59], v[176:191]
  buffer_load_dwordx4 a[12:15], v8, s[4:7], s24 offen offset:1024
  buffer_load_dwordx4 a[16:19], v8, s[4:7], s25 offen offset:1024
  buffer_load_dwordx4 a[20:23], v8, s[4:7], s26 offen offset:1024
  s_waitcnt vmcnt(46)
  ds_read_b128 v[24:27], v8 offset:7168
  ds_read_b128 v[28:31], v9 offset:7168
  s_waitcnt lgkmcnt(4)
  v_mfma_f32_32x32x16_bf16 v[96:111], a[60:63], v[32:35], v[96:111]
  v_mfma_f32_32x32x16_bf16 v[112:127], a[60:63], v[36:39], v[112:127]
  v_mfma_f32_32x32x16_bf16 v[128:143], a[64:67], v[32:35], v[128:143]
  v_mfma_f32_32x32x16_bf16 v[144:159], a[64:67], v[36:39], v[144:159]
  v_mfma_f32_32x32x16_bf16 v[160:175], v[32:35], a[68:71], v[160:175]
  v_mfma_f32_32x32x16_bf16 v[176:191], v[36:39], a[68:71], v[176:191]
  buffer_load_dwordx4 a[24:27], v8, s[4:7], s24 offen offset:2048
  buffer_load_dwordx4 a[28:31], v8, s[4:7], s25 offen offset:2048
  buffer_load_dwordx4 a[32:35], v8, s[4:7], s26 offen offset:2048
  s_waitcnt vmcnt(46)
  ds_read_b128 v[32:35], v8 offset:8192
  ds_read_b128 v[36:39], v9 offset:8192
  s_waitcnt lgkmcnt(4)
  v_mfma_f32_32x32x16_bf16 v[96:111], a[72:75], v[16:19], v[96:111]
  v_mfma_f32_32x32x16_bf16 v[112:127], a[72:75], v[20:23], v[112:127]
  v_mfma_f32_32x32x16_bf16 v[128:143], a[76:79], v[16:19], v[128:143]
  v_mfma_f32_32x32x16_bf16 v[144:159], a[76:79], v[20:23], v[144:159]
  v_mfma_f32_32x32x16_bf16 v[160:175], v[16:19], a[80:83], v[160:175]
  v_mfma_f32_32x32x16_bf16 v[176:191], v[20:23], a[80:83], v[176:191]
  buffer_load_dwordx4 a[36:39], v8, s[4:7], s24 offen offset:3072
  buffer_load_dwordx4 a[40:43], v8, s[4:7], s25 offen offset:3072
  buffer_load_dwordx4 a[44:47], v8, s[4:7], s26 offen offset:3072
  s_add_u32 s24, s24, 4096
  s_add_u32 s25, s25, 4096
  s_add_u32 s26, s26, 4096
  s_waitcnt vmcnt(46)
  ds_read_b128 v[16:19], v8 offset:9216
  ds_read_b128 v[20:23], v9 offset:9216
  s_waitcnt lgkmcnt(4)
  v_mfma_f32_32x32x16_bf16 v[96:111], a[84:87], v[24:27], v[96:111]
  v_mfma_f32_32x32x16_bf16 v[112:127], a[84:87], v[28:31], v[112:127]
  v_mfma_f32_32x32x16_bf16 v[128:143], a[88:91], v[24:27], v[128:143]
  v_mfma_f32_32x32x16_bf16 v[144:159], a[88:91], v[28:31], v[144:159]
  v_mfma_f32_32x32x16_bf16 v[160:175], v[24:27], a[92:95], v[160:175]
  v_mfma_f32_32x32x16_bf16 v[176:191], v[28:31], a[92:95], v[176:191]
  buffer_load_dwordx4 a[48:51], v8, s[4:7], s24 offen offset:0
  buffer_load_dwordx4 a[52:55], v8, s[4:7], s25 offen offset:0
  buffer_load_dwordx4 a[56:59], v8, s[4:7], s26 offen offset:0
  s_waitcnt vmcnt(61)
  s_barrier
  s_waitcnt vmcnt(36)
  ds_read_b128 v[24:27], v8 offset:10240
  ds_read_b128 v[28:31], v9 offset:10240
  s_waitcnt lgkmcnt(4)
  v_mfma_f32_32x32x16_bf16 v[96:111], a[96:99], v[32:35], v[96:111]
  v_mfma_f32_32x32x16_bf16 v[112:127], a[96:99], v[36:39], v[112:127]
  v_mfma_f32_32x32x16_bf16 v[128:143], a[100:103], v[32:35], v[128:143]
  v_mfma_f32_32x32x16_bf16 v[144:159], a[100:103], v[36:39], v[144:159]
  v_mfma_f32_32x32x16_bf16 v[160:175], v[32:35], a[104:107], v[160:175]
  v_mfma_f32_32x32x16_bf16 v[176:191], v[36:39], a[104:107], v[176:191]
  buffer_load_dwordx4 a[60:63], v8, s[4:7], s24 offen offset:1024
  buffer_load_dwordx4 a[64:67], v8, s[4:7], s25 offen offset:1024
  buffer_load_dwordx4 a[68:71], v8, s[4:7], s26 offen offset:1024
  s_waitcnt vmcnt(36)
  ds_read_b128 v[32:35], v8 offset:11264
  ds_read_b128 v[36:39], v9 offset:11264
  s_waitcnt lgkmcnt(4)
  v_mfma_f32_32x32x16_bf16 v[96:111], a[108:111], v[16:19], v[96:111]
  v_mfma_f32_32x32x16_bf16 v[112:127], a[108:111], v[20:23], v[112:127]
  v_mfma_f32_32x32x16_bf16 v[128:143], a[112:115], v[16:19], v[128:143]
  v_mfma_f32_32x32x16_bf16 v[144:159], a[112:115], v[20:23], v[144:159]
  v_mfma_f32_32x32x16_bf16 v[160:175], v[16:19], a[116:119], v[160:175]
  v_mfma_f32_32x32x16_bf16 v[176:191], v[20:23], a[116:119], v[176:191]
  buffer_load_dwordx4 a[72:75], v8, s[4:7], s24 offen offset:2048
  buffer_load_dwordx4 a[76:79], v8, s[4:7], s25 offen offset:2048
  buffer_load_dwordx4 a[80:83], v8, s[4:7], s26 offen offset:2048
  s_waitcnt vmcnt(36)
  ds_read_b128 v[16:19], v8 offset:12288
  ds_read_b128 v[20:23], v9 offset:12288
  s_waitcnt lgkmcnt(4)
  v_mfma_f32_32x32x16_bf16 v[96:111], a[120:123], v[24:27], v[96:111]
  v_mfma_f32_32x32x16_bf16 v[112:127], a[120:123], v[28:31], v[112:127]
  v_mfma_f32_32x32x16_bf16 v[128:143], a[124:127], v[24:27], v[128:143]
  v_mfma_f32_32x32x16_bf16 v[144:159], a[124:127], v[28:31], v[144:159]
  v_mfma_f32_32x32x16_bf16 v[160:175], v[24:27], a[128:131], v[160:175]
  v_mfma_f32_32x32x16_bf16 v[176:191], v[28:31], a[128:131], v[176:191]
  buffer_load_dwordx4 a[84:87], v8, s[4:7], s24 offen offset:3072
  buffer_load_dwordx4 a[88:91], v8, s[4:7], s25 offen offset:3072
  buffer_load_dwordx4 a[92:95], v8, s[4:7], s26 offen offset:3072
  s_add_u32 s24, s24, 4096
  s_add_u32 s25, s25, 4096
  s_add_u32 s26, s26, 4096
  s_waitcnt vmcnt(36)
  ds_read_b128 v[24:27], v8 offset:13312
  ds_read_b128 v[28:31], v9 offset:13312
  s_waitcnt lgkmcnt(4)
  v_mfma_f32_32x32x16_bf16 v[96:111], a[132:135], v[32:35], v[96:111]
  v_mfma_f32_32x32x16_bf16 v[112:127], a[132:135], v[36:39], v[112:127]
  v_mfma_f32_32x32x16_bf16 v[128:143], a[136:139], v[32:35], v[128:143]
  v_mfma_f32_32x32x16_bf16 v[144:159], a[136:139], v[36:39], v[144:159]
  v_mfma_f32_32x32x16_bf16 v[160:175], v[32:35], a[140:143], v[160:175]
  v_mfma_f32_32x32x16_bf16 v[176:191], v[36:39], a[140:143], v[176:191]
  buffer_load_dwordx4 a[96:99], v8, s[4:7], s24 offen offset:0
  buffer_load_dwordx4 a[100:103], v8, s[4:7], s25 offen offset:0
  buffer_load_dwordx4 a[104:107], v8, s[4:7], s26 offen offset:0
  s_waitcnt vmcnt(36)
  ds_read_b128 v[32:35], v8 offset:14336
  ds_read_b128 v[36:39], v9 offset:14336
  s_waitcnt lgkmcnt(4)
  v_mfma_f32_32x32x16_bf16 v[96:111], a[144:147], v[16:19], v[96:111]
  v_mfma_f32_32x32x16_bf16 v[112:127], a[144:147], v[20:23], v[112:127]
  v_mfma_f32_32x32x16_bf16 v[128:143], a[148:151], v[16:19], v[128:143]
  v_mfma_f32_32x32x16_bf16 v[144:159], a[148:151], v[20:23], v[144:159]
  v_mfma_f32_32x32x16_bf16 v[160:175], v[16:19], a[152:155], v[160:175]
  v_mfma_f32_32x32x16_bf16 v[176:191], v[20:23], a[152:155], v[176:191]
  buffer_load_dwordx4 a[108:111], v8, s[4:7], s24 offen offset:1024
  buffer_load_dwordx4 a[112:115], v8, s[4:7], s25 offen offset:1024
  buffer_load_dwordx4 a[116:119], v8, s[4:7], s26 offen offset:1024
  s_waitcnt vmcnt(36)
  ds_read_b128 v[16:19], v8 offset:15360
  ds_read_b128 v[20:23], v9 offset:15360
  s_waitcnt lgkmcnt(4)
  v_mfma_f32_32x32x16_bf16 v[96:111], a[156:159], v[24:27], v[96:111]
  v_mfma_f32_32x32x16_bf16 v[112:127], a[156:159], v[28:31], v[112:127]
  v_mfma_f32_32x32x16_bf16 v[128:143], a[160:163], v[24:27], v[128:143]
  v_mfma_f32_32x32x16_bf16 v[144:159], a[160:163], v[28:31], v[144:159]
  v_mfma_f32_32x32x16_bf16 v[160:175], v[24:27], a[164:167], v[160:175]
  v_mfma_f32_32x32x16_bf16 v[176:191], v[28:31], a[164:167], v[176:191]
  buffer_load_dwordx4 a[120:123], v8, s[4:7], s24 offen offset:2048
  buffer_load_dwordx4 a[124:127], v8, s[4:7], s25 offen offset:2048
  buffer_load_dwordx4 a[128:131], v8, s[4:7], s26 offen offset:2048
  s_waitcnt vmcnt(36)
  ds_read_b128 v[24:27], v8 offset:16384
  ds_read_b128 v[28:31], v9 offset:16384
  s_waitcnt lgkmcnt(4)
  v_mfma_f32_32x32x16_bf16 v[96:111], a[168:171], v[32:35], v[96:111]
  v_mfma_f32_32x32x16_bf16 v[112:127], a[168:171], v[36:39], v[112:127]
  v_mfma_f32_32x32x16_bf16 v[128:143], a[172:175], v[32:35], v[128:143]
  v_mfma_f32_32x32x16_bf16 v[144:159], a[172:175], v[36:39], v[144:159]
  v_mfma_f32_32x32x16_bf16 v[160:175], v[32:35], a[176:179], v[160:175]
  v_mfma_f32_32x32x16_bf16 v[176:191], v[36:39], a[176:179], v[176:191]
  buffer_load_dwordx4 a[132:135], v8, s[4:7], s24 offen offset:3072
  buffer_load_dwordx4 a[136:139], v8, s[4:7], s25 offen offset:3072
  buffer_load_dwordx4 a[140:143], v8, s[4:7], s26 offen offset:3072
  s_add_u32 s24, s24, 4096
  s_add_u32 s25, s25, 4096
  s_add_u32 s26, s26, 4096
  s_waitcnt vmcnt(36)
  ds_read_b128 v[32:35], v8 offset:17408
  ds_read_b128 v[36:39], v9 offset:17408
  s_waitcnt lgkmcnt(4)
  v_mfma_f32_32x32x16_bf16 v[96:111], a[180:183], v[16:19], v[96:111]
  v_mfma_f32_32x32x16_bf16 v[112:127], a[180:183], v[20:23], v[112:127]
  v_mfma_f32_32x32x16_bf16 v[128:143], a[184:187], v[16:19], v[128:143]
  v_mfma_f32_32x32x16_bf16 v[144:159], a[184:187], v[20:23], v[144:159]
  v_mfma_f32_32x32x16_bf16 v[160:175], v[16:19], a[188:191], v[160:175]
  v_mfma_f32_32x32x16_bf16 v[176:191], v[20:23], a[188:191], v[176:191]
  buffer_load_dwordx4 a[144:147], v8, s[4:7], s24 offen offset:0
  buffer_load_dwordx4 a[148:151], v8, s[4:7], s25 offen offset:0
  buffer_load_dwordx4 a[152:155], v8, s[4:7], s26 offen offset:0
  s_waitcnt vmcnt(36)
  ds_read_b128 v[16:19], v8 offset:18432
  ds_read_b128 v[20:23], v9 offset:18432
  s_waitcnt lgkmcnt(4)
  v_mfma_f32_32x32x16_bf16 v[96:111], a[0:3], v[24:27], v[96:111]
  v_mfma_f32_32x32x16_bf16 v[112:127], a[0:3], v[28:31], v[112:127]
  v_mfma_f32_32x32x16_bf16 v[128:143], a[4:7], v[24:27], v[128:143]
  v_mfma_f32_32x32x16_bf16 v[144:159], a[4:7], v[28:31], v[144:159]
  v_mfma_f32_32x32x16_bf16 v[160:175], v[24:27], a[8:11], v[160:175]
  v_mfma_f32_32x32x16_bf16 v[176:191], v[28:31], a[8:11], v[176:191]
  buffer_load_dwordx4 a[156:159], v8, s[4:7], s24 offen offset:1024
  buffer_load_dwordx4 a[160:163], v8, s[4:7], s25 offen offset:1024
  buffer_load_dwordx4 a[164:167], v8, s[4:7], s26 offen offset:1024
  s_waitcnt vmcnt(36)
  ds_read_b128 v[24:27], v8 offset:19456
  ds_read_b128 v[28:31], v9 offset:19456
  s_waitcnt lgkmcnt(4)
  v_mfma_f32_32x32x16_bf16 v[96:111], a[12:15], v[32:35], v[96:111]
  v_mfma_f32_32x32x16_bf16 v[112:127], a[12:15], v[36:39], v[112:127]
  v_mfma_f32_32x32x16_bf16 v[128:143], a[16:19], v[32:35], v[128:143]
  v_mfma_f32_32x32x16_bf16 v[144:159], a[16:19], v[36:39], v[144:159]
  v_mfma_f32_32x32x16_bf16 v[160:175], v[32:35], a[20:23], v[160:175]
  v_mfma_f32_32x32x16_bf16 v[176:191], v[36:39], a[20:23], v[176:191]
  buffer_load_dwordx4 a[168:171], v8, s[4:7], s24 offen offset:2048
  buffer_load_dwordx4 a[172:175], v8, s[4:7], s25 offen offset:2048
  buffer_load_dwordx4 a[176:179], v8, s[4:7], s26 offen offset:2048
  s_waitcnt vmcnt(63)
  s_barrier
  s_waitcnt vmcnt(36)
  ds_read_b128 v[32:35], v8 offset:20480
  ds_read_b128 v[36:39], v9 offset:20480
  s_waitcnt lgkmcnt(4)
  v_mfma_f32_32x32x16_bf16 v[96:111], a[24:27], v[16:19], v[96:111]
  v_mfma_f32_32x32x16_bf16 v[112:127], a[24:27], v[20:23], v[112:127]
  v_mfma_f32_32x32x16_bf16 v[128:143], a[28:31], v[16:19], v[128:143]
  v_mfma_f32_32x32x16_bf16 v[144:159], a[28:31], v[20:23], v[144:159]
  v_mfma_f32_32x32x16_bf16 v[160:175], v[16:19], a[32:35], v[160:175]
  v_mfma_f32_32x32x16_bf16 v[176:191], v[20:23], a[32:35], v[176:191]
  buffer_load_dwordx4 a[180:183], v8, s[4:7], s24 offen offset:3072
  buffer_load_dwordx4 a[184:187], v8, s[4:7], s25 offen offset:3072
  buffer_load_dwordx4 a[188:191], v8, s[4:7], s26 offen offset:3072
  s_add_u32 s24, s24, 4096
  s_add_u32 s25, s25, 4096
  s_add_u32 s26, s26, 4096
  s_waitcnt vmcnt(36)
  ds_read_b128 v[16:19], v8 offset:21504
  ds_read_b128 v[20:23], v9 offset:21504
  s_waitcnt lgkmcnt(4)
  v_mfma_f32_32x32x16_bf16 v[96:111], a[36:39], v[24:27], v[96:111]
  v_mfma_f32_32x32x16_bf16 v[112:127], a[36:39], v[28:31], v[112:127]
  v_mfma_f32_32x32x16_bf16 v[128:143], a[40:43], v[24:27], v[128:143]
  v_mfma_f32_32x32x16_bf16 v[144:159], a[40:43], v[28:31], v[144:159]
  v_mfma_f32_32x32x16_bf16 v[160:175], v[24:27], a[44:47], v[160:175]
  v_mfma_f32_32x32x16_bf16 v[176:191], v[28:31], a[44:47], v[176:191]
  buffer_load_dwordx4 a[0:3], v8, s[4:7], s24 offen offset:0
  buffer_load_dwordx4 a[4:7], v8, s[4:7], s25 offen offset:0
  buffer_load_dwordx4 a[8:11], v8, s[4:7], s26 offen offset:0
  s_waitcnt vmcnt(36)
  ds_read_b128 v[24:27], v8 offset:22528
  ds_read_b128 v[28:31], v9 offset:22528
  s_waitcnt lgkmcnt(4)
  v_mfma_f32_32x32x16_bf16 v[96:111], a[48:51], v[32:35], v[96:111]
  v_mfma_f32_32x32x16_bf16 v[112:127], a[48:51], v[36:39], v[112:127]
  v_mfma_f32_32x32x16_bf16 v[128:143], a[52:55], v[32:35], v[128:143]
  v_mfma_f32_32x32x16_bf16 v[144:159], a[52:55], v[36:39], v[144:159]
  v_mfma_f32_32x32x16_bf16 v[160:175], v[32:35], a[56:59], v[160:175]
  v_mfma_f32_32x32x16_bf16 v[176:191], v[36:39], a[56:59], v[176:191]
  buffer_load_dwordx4 a[12:15], v8, s[4:7], s24 offen offset:1024
  buffer_load_dwordx4 a[16:19], v8, s[4:7], s25 offen offset:1024
  buffer_load_dwordx4 a[20:23], v8, s[4:7], s26 offen offset:1024
  s_waitcnt vmcnt(36)
  ds_read_b128 v[32:35], v8 offset:23552
  ds_read_b128 v[36:39], v9 offset:23552
  s_waitcnt lgkmcnt(4)
  v_mfma_f32_32x32x16_bf16 v[96:111], a[60:63], v[16:19], v[96:111]
  v_mfma_f32_32x32x16_bf16 v[112:127], a[60:63], v[20:23], v[112:127]
  v_mfma_f32_32x32x16_bf16 v[128:143], a[64:67], v[16:19], v[128:143]
  v_mfma_f32_32x32x16_bf16 v[144:159], a[64:67], v[20:23], v[144:159]
  v_mfma_f32_32x32x16_bf16 v[160:175], v[16:19], a[68:71], v[160:175]
  v_mfma_f32_32x32x16_bf16 v[176:191], v[20:23], a[68:71], v[176:191]
  buffer_load_dwordx4 a[24:27], v8, s[4:7], s24 offen offset:2048
  buffer_load_dwordx4 a[28:31], v8, s[4:7], s25 offen offset:2048
  buffer_load_dwordx4 a[32:35], v8, s[4:7], s26 offen offset:2048
  s_waitcnt vmcnt(36)
  ds_read_b128 v[16:19], v8 offset:24576
  ds_read_b128 v[20:23], v9 offset:24576
  s_waitcnt lgkmcnt(4)
  v_mfma_f32_32x32x16_bf16 v[96:111], a[72:75], v[24:27], v[96:111]
  v_mfma_f32_32x32x16_bf16 v[112:127], a[72:75], v[28:31], v[112:127]
  v_mfma_f32_32x32x16_bf16 v[128:143], a[76:79], v[24:27], v[128:143]
  v_mfma_f32_32x32x16_bf16 v[144:159], a[76:79], v[28:31], v[144:159]
  v_mfma_f32_32x32x16_bf16 v[160:175], v[24:27], a[80:83], v[160:175]
  v_mfma_f32_32x32x16_bf16 v[176:191], v[28:31], a[80:83], v[176:191]
  buffer_load_dwordx4 a[36:39], v8, s[4:7], s24 offen offset:3072
  buffer_load_dwordx4 a[40:43], v8, s[4:7], s25 offen offset:3072
  buffer_load_dwordx4 a[44:47], v8, s[4:7], s26 offen offset:3072
  s_add_u32 s24, s24, 4096
  s_add_u32 s25, s25, 4096
  s_add_u32 s26, s26, 4096
  s_waitcnt vmcnt(36)
  ds_read_b128 v[24:27], v8 offset:25600
  ds_read_b128 v[28:31], v9 offset:25600
  s_waitcnt lgkmcnt(4)
  v_mfma_f32_32x32x16_bf16 v[96:111], a[84:87], v[32:35], v[96:111]
  v_mfma_f32_32x32x16_bf16 v[112:127], a[84:87], v[36:39], v[112:127]
  v_mfma_f32_32x32x16_bf16 v[128:143], a[88:91], v[32:35], v[128:143]
  v_mfma_f32_32x32x16_bf16 v[144:159], a[88:91], v[36:39], v[144:159]
  v_mfma_f32_32x32x16_bf16 v[160:175], v[32:35], a[92:95], v[160:175]
  v_mfma_f32_32x32x16_bf16 v[176:191], v[36:39], a[92:95], v[176:191]
  buffer_load_dwordx4 a[48:51], v8, s[4:7], s24 offen offset:0
  buffer_load_dwordx4 a[52:55], v8, s[4:7], s25 offen offset:0
  buffer_load_dwordx4 a[56:59], v8, s[4:7], s26 offen offset:0
  s_waitcnt vmcnt(36)
  ds_read_b128 v[32:35], v8 offset:26624
  ds_read_b128 v[36:39], v9 offset:26624
  s_waitcnt lgkmcnt(4)
  v_mfma_f32_32x32x16_bf16 v[96:111], a[96:99], v[16:19], v[96:111]
  v_mfma_f32_32x32x16_bf16 v[112:127], a[96:99], v[20:23], v[112:127]
  v_mfma_f32_32x32x16_bf16 v[128:143], a[100:103], v[16:19], v[128:143]
  v_mfma_f32_32x32x16_bf16 v[144:159], a[100:103], v[20:23], v[144:159]
  v_mfma_f32_32x32x16_bf16 v[160:175], v[16:19], a[104:107], v[160:175]
  v_mfma_f32_32x32x16_bf16 v[176:191], v[20:23], a[104:107], v[176:191]
  buffer_load_dwordx4 a[60:63], v8, s[4:7], s24 offen offset:1024
  buffer_load_dwordx4 a[64:67], v8, s[4:7], s25 offen offset:1024
  buffer_load_dwordx4 a[68:71], v8, s[4:7], s26 offen offset:1024
  s_waitcnt vmcnt(36)
  ds_read_b128 v[16:19], v8 offset:27648
  ds_read_b128 v[20:23], v9 offset:27648
  s_waitcnt lgkmcnt(4)
  v_mfma_f32_32x32x16_bf16 v[96:111], a[108:111], v[24:27], v[96:111]
  v_mfma_f32_32x32x16_bf16 v[112:127], a[108:111], v[28:31], v[112:127]
  v_mfma_f32_32x32x16_bf16 v[128:143], a[112:115], v[24:27], v[128:143]
  v_mfma_f32_32x32x16_bf16 v[144:159], a[112:115], v[28:31], v[144:159]
  v_mfma_f32_32x32x16_bf16 v[160:175], v[24:27], a[116:119], v[160:175]
  v_mfma_f32_32x32x16_bf16 v[176:191], v[28:31], a[116:119], v[176:191]
  buffer_load_dwordx4 a[72:75], v8, s[4:7], s24 offen offset:2048
  buffer_load_dwordx4 a[76:79], v8, s[4:7], s25 offen offset:2048
  buffer_load_dwordx4 a[80:83], v8, s[4:7], s26 offen offset:2048
  s_waitcnt vmcnt(36)
  ds_read_b128 v[24:27], v8 offset:28672
  ds_read_b128 v[28:31], v9 offset:28672
  s_waitcnt lgkmcnt(4)
  v_mfma_f32_32x32x16_bf16 v[96:111], a[120:123], v[32:35], v[96:111]
  v_mfma_f32_32x32x16_bf16 v[112:127], a[120:123], v[36:39], v[112:127]
  v_mfma_f32_32x32x16_bf16 v[128:143], a[124:127], v[32:35], v[128:143]
  v_mfma_f32_32x32x16_bf16 v[144:159], a[124:127], v[36:39], v[144:159]
  v_mfma_f32_32x32x16_bf16 v[160:175], v[32:35], a[128:131], v[160:175]
  v_mfma_f32_32x32x16_bf16 v[176:191], v[36:39], a[128:131], v[176:191]
  buffer_load_dwordx4 a[84:87], v8, s[4:7], s24 offen offset:3072
  buffer_load_dwordx4 a[88:91], v8, s[4:7], s25 offen offset:3072
  buffer_load_dwordx4 a[92:95], v8, s[4:7], s26 offen offset:3072
  s_add_u32 s24, s24, 4096
  s_add_u32 s25, s25, 4096
  s_add_u32 s26, s26, 4096
  s_waitcnt vmcnt(36)
  ds_read_b128 v[32:35], v8 offset:29696
  ds_read_b128 v[36:39], v9 offset:29696
  s_waitcnt lgkmcnt(4)
  v_mfma_f32_32x32x16_bf16 v[96:111], a[132:135], v[16:19], v[96:111]
  v_mfma_f32_32x32x16_bf16 v[112:127], a[132:135], v[20:23], v[112:127]
  v_mfma_f32_32x32x16_bf16 v[128:143], a[136:139], v[16:19], v[128:143]
  v_mfma_f32_32x32x16_bf16 v[144:159], a[136:139], v[20:23], v[144:159]
  v_mfma_f32_32x32x16_bf16 v[160:175], v[16:19], a[140:143], v[160:175]
  v_mfma_f32_32x32x16_bf16 v[176:191], v[20:23], a[140:143], v[176:191]
  s_waitcnt vmcnt(63)
  s_barrier
  s_waitcnt vmcnt(33)
  ds_read_b128 v[16:19], v8 offset:30720
  ds_read_b128 v[20:23], v9 offset:30720
  s_waitcnt lgkmcnt(4)
  v_mfma_f32_32x32x16_bf16 v[96:111], a[144:147], v[24:27], v[96:111]
  v_mfma_f32_32x32x16_bf16 v[112:127], a[144:147], v[28:31], v[112:127]
  v_mfma_f32_32x32x16_bf16 v[128:143], a[148:151], v[24:27], v[128:143]
  v_mfma_f32_32x32x16_bf16 v[144:159], a[148:151], v[28:31], v[144:159]
  v_mfma_f32_32x32x16_bf16 v[160:175], v[24:27], a[152:155], v[160:175]
  v_mfma_f32_32x32x16_bf16 v[176:191], v[28:31], a[152:155], v[176:191]
  s_waitcnt vmcnt(30)
  ds_read_b128 v[24:27], v8 offset:31744
  ds_read_b128 v[28:31], v9 offset:31744
  s_waitcnt lgkmcnt(4)
  v_mfma_f32_32x32x16_bf16 v[96:111], a[156:159], v[32:35], v[96:111]
  v_mfma_f32_32x32x16_bf16 v[112:127], a[156:159], v[36:39], v[112:127]
  v_mfma_f32_32x32x16_bf16 v[128:143], a[160:163], v[32:35], v[128:143]
  v_mfma_f32_32x32x16_bf16 v[144:159], a[160:163], v[36:39], v[144:159]
  v_mfma_f32_32x32x16_bf16 v[160:175], v[32:35], a[164:167], v[160:175]
  v_mfma_f32_32x32x16_bf16 v[176:191], v[36:39], a[164:167], v[176:191]
  s_waitcnt vmcnt(27)
  ds_read_b128 v[32:35], v8 offset:32768
  ds_read_b128 v[36:39], v9 offset:32768
  s_waitcnt lgkmcnt(4)
  v_mfma_f32_32x32x16_bf16 v[96:111], a[168:171], v[16:19], v[96:111]
  v_mfma_f32_32x32x16_bf16 v[112:127], a[168:171], v[20:23], v[112:127]
  v_mfma_f32_32x32x16_bf16 v[128:143], a[172:175], v[16:19], v[128:143]
  v_mfma_f32_32x32x16_bf16 v[144:159], a[172:175], v[20:23], v[144:159]
  v_mfma_f32_32x32x16_bf16 v[160:175], v[16:19], a[176:179], v[160:175]
  v_mfma_f32_32x32x16_bf16 v[176:191], v[20:23], a[176:179], v[176:191]
  s_waitcnt vmcnt(24)
  ds_read_b128 v[16:19], v8 offset:33792
  ds_read_b128 v[20:23], v9 offset:33792
  s_waitcnt lgkmcnt(4)
  v_mfma_f32_32x32x16_bf16 v[96:111], a[180:183], v[24:27], v[96:111]
  v_mfma_f32_32x32x16_bf16 v[112:127], a[180:183], v[28:31], v[112:127]
  v_mfma_f32_32x32x16_bf16 v[128:143], a[184:187], v[24:27], v[128:143]
  v_mfma_f32_32x32x16_bf16 v[144:159], a[184:187], v[28:31], v[144:159]
  v_mfma_f32_32x32x16_bf16 v[160:175], v[24:27], a[188:191], v[160:175]
  v_mfma_f32_32x32x16_bf16 v[176:191], v[28:31], a[188:191], v[176:191]
  s_waitcnt vmcnt(21)
  ds_read_b128 v[24:27], v8 offset:34816
  ds_read_b128 v[28:31], v9 offset:34816
  s_waitcnt lgkmcnt(4)
  v_mfma_f32_32x32x16_bf16 v[96:111], a[0:3], v[32:35], v[96:111]
  v_mfma_f32_32x32x16_bf16 v[112:127], a[0:3], v[36:39], v[112:127]
  v_mfma_f32_32x32x16_bf16 v[128:143], a[4:7], v[32:35], v[128:143]
  v_mfma_f32_32x32x16_bf16 v[144:159], a[4:7], v[36:39], v[144:159]
  v_mfma_f32_32x32x16_bf16 v[160:175], v[32:35], a[8:11], v[160:175]
  v_mfma_f32_32x32x16_bf16 v[176:191], v[36:39], a[8:11], v[176:191]
  s_waitcnt vmcnt(18)
  ds_read_b128 v[32:35], v8 offset:35840
  ds_read_b128 v[36:39], v9 offset:35840
  s_waitcnt lgkmcnt(4)
  v_mfma_f32_32x32x16_bf16 v[96:111], a[12:15], v[16:19], v[96:111]
  v_mfma_f32_32x32x16_bf16 v[112:127], a[12:15], v[20:23], v[112:127]
  v_mfma_f32_32x32x16_bf16 v[128:143], a[16:19], v[16:19], v[128:143]
  v_mfma_f32_32x32x16_bf16 v[144:159], a[16:19], v[20:23], v[144:159]
  v_mfma_f32_32x32x16_bf16 v[160:175], v[16:19], a[20:23], v[160:175]
  v_mfma_f32_32x32x16_bf16 v[176:191], v[20:23], a[20:23], v[176:191]
  s_waitcnt vmcnt(15)
  ds_read_b128 v[16:19], v8 offset:36864
  ds_read_b128 v[20:23], v9 offset:36864
  s_waitcnt lgkmcnt(4)
  v_mfma_f32_32x32x16_bf16 v[96:111], a[24:27], v[24:27], v[96:111]
  v_mfma_f32_32x32x16_bf16 v[112:127], a[24:27], v[28:31], v[112:127]
  v_mfma_f32_32x32x16_bf16 v[128:143], a[28:31], v[24:27], v[128:143]
  v_mfma_f32_32x32x16_bf16 v[144:159], a[28:31], v[28:31], v[144:159]
  v_mfma_f32_32x32x16_bf16 v[160:175], v[24:27], a[32:35], v[160:175]
  v_mfma_f32_32x32x16_bf16 v[176:191], v[28:31], a[32:35], v[176:191]
  s_waitcnt vmcnt(12)
  ds_read_b128 v[24:27], v8 offset:37888
  ds_read_b128 v[28:31], v9 offset:37888
  s_waitcnt lgkmcnt(4)
  v_mfma_f32_32x32x16_bf16 v[96:111], a[36:39], v[32:35], v[96:111]
  v_mfma_f32_32x32x16_bf16 v[112:127], a[36:39], v[36:39], v[112:127]
  v_mfma_f32_32x32x16_bf16 v[128:143], a[40:43], v[32:35], v[128:143]
  v_mfma_f32_32x32x16_bf16 v[144:159], a[40:43], v[36:39], v[144:159]
  v_mfma_f32_32x32x16_bf16 v[160:175], v[32:35], a[44:47], v[160:175]
  v_mfma_f32_32x32x16_bf16 v[176:191], v[36:39], a[44:47], v[176:191]
  s_waitcnt vmcnt(9)
  ds_read_b128 v[32:35], v8 offset:38912
  ds_read_b128 v[36:39], v9 offset:38912
  s_waitcnt lgkmcnt(4)
  v_mfma_f32_32x32x16_bf16 v[96:111], a[48:51], v[16:19], v[96:111]
  v_mfma_f32_32x32x16_bf16 v[112:127], a[48:51], v[20:23], v[112:127]
  v_mfma_f32_32x32x16_bf16 v[128:143], a[52:55], v[16:19], v[128:143]
  v_mfma_f32_32x32x16_bf16 v[144:159], a[52:55], v[20:23], v[144:159]
  v_mfma_f32_32x32x16_bf16 v[160:175], v[16:19], a[56:59], v[160:175]
  v_mfma_f32_32x32x16_bf16 v[176:191], v[20:23], a[56:59], v[176:191]
  s_waitcnt vmcnt(6)
  ds_read_b128 v[16:19], v8 offset:39936
  ds_read_b128 v[20:23], v9 offset:39936
  s_waitcnt lgkmcnt(4)
  v_mfma_f32_32x32x16_bf16 v[96:111], a[60:63], v[24:27], v[96:111]
  v_mfma_f32_32x32x16_bf16 v[112:127], a[60:63], v[28:31], v[112:127]
  v_mfma_f32_32x32x16_bf16 v[128:143], a[64:67], v[24:27], v[128:143]
  v_mfma_f32_32x32x16_bf16 v[144:159], a[64:67], v[28:31], v[144:159]
  v_mfma_f32_32x32x16_bf16 v[160:175], v[24:27], a[68:71], v[160:175]
  v_mfma_f32_32x32x16_bf16 v[176:191], v[28:31], a[68:71], v[176:191]
  s_waitcnt vmcnt(3)
  s_waitcnt lgkmcnt(2)
  v_mfma_f32_32x32x16_bf16 v[96:111], a[72:75], v[32:35], v[96:111]
  v_mfma_f32_32x32x16_bf16 v[112:127], a[72:75], v[36:39], v[112:127]
  v_mfma_f32_32x32x16_bf16 v[128:143], a[76:79], v[32:35], v[128:143]
  v_mfma_f32_32x32x16_bf16 v[144:159], a[76:79], v[36:39], v[144:159]
  v_mfma_f32_32x32x16_bf16 v[160:175], v[32:35], a[80:83], v[160:175]
  v_mfma_f32_32x32x16_bf16 v[176:191], v[36:39], a[80:83], v[176:191]
  s_waitcnt vmcnt(0)
  s_waitcnt lgkmcnt(0)
  v_mfma_f32_32x32x16_bf16 v[96:111], a[84:87], v[16:19], v[96:111]
  v_mfma_f32_32x32x16_bf16 v[112:127], a[84:87], v[20:23], v[112:127]
  v_mfma_f32_32x32x16_bf16 v[128:143], a[88:91], v[16:19], v[128:143]
  v_mfma_f32_32x32x16_bf16 v[144:159], a[88:91], v[20:23], v[144:159]
  v_mfma_f32_32x32x16_bf16 v[160:175], v[16:19], a[92:95], v[160:175]
  v_mfma_f32_32x32x16_bf16 v[176:191], v[20:23], a[92:95], v[176:191]
  s_lshl_b32 s21, s18, 1
  s_lshl_b32 s22, s23, 6
  s_add_u32 s21, s21, s22
  s_lshl_b32 s21, s21, 11
  s_add_u32 s27, s21, 37748736
  s_add_u32 s28, s21, 41943040
  s_add_u32 s29, s21, 46137344
  s_mov_b32 s30, 0x3ea52b5c
  v_and_b32 v2, 31, v0
  v_cmp_eq_u32 s[32:33], 20, v2
  v_mov_b32 v3, 0x3f803f80
  v_mul_f32 v96, s30, v96
  v_mul_f32 v97, s30, v97
  v_mul_f32 v98, s30, v98
  v_mul_f32 v99, s30, v99
  v_mul_f32 v100, s30, v100
  v_mul_f32 v101, s30, v101
  v_mul_f32 v102, s30, v102
  v_mul_f32 v103, s30, v103
  v_mul_f32 v104, s30, v104
  v_mul_f32 v105, s30, v105
  v_mul_f32 v106, s30, v106
  v_mul_f32 v107, s30, v107
  v_mul_f32 v108, s30, v108
  v_mul_f32 v109, s30, v109
  v_mul_f32 v110, s30, v110
  v_mul_f32 v111, s30, v111
  v_cvt_pk_bf16_f32 v16, v96, v97
  v_cvt_pk_bf16_f32 v17, v98, v99
  v_cvt_pk_bf16_f32 v18, v100, v101
  v_cvt_pk_bf16_f32 v19, v102, v103
  v_cvt_pk_bf16_f32 v20, v104, v105
  v_cvt_pk_bf16_f32 v21, v106, v107
  v_cvt_pk_bf16_f32 v22, v108, v109
  v_cvt_pk_bf16_f32 v23, v110, v111
  buffer_store_dwordx4 v[16:19], v8, s[4:7], s27 offen offset:0 sc1
  buffer_store_dwordx4 v[20:23], v8, s[4:7], s27 offen offset:1024 sc1
  v_mul_f32 v112, s30, v112
  v_mul_f32 v113, s30, v113
  v_mul_f32 v114, s30, v114
  v_mul_f32 v115, s30, v115
  v_mul_f32 v116, s30, v116
  v_mul_f32 v117, s30, v117
  v_mul_f32 v118, s30, v118
  v_mul_f32 v119, s30, v119
  v_mul_f32 v120, s30, v120
  v_mul_f32 v121, s30, v121
  v_mul_f32 v122, s30, v122
  v_mul_f32 v123, s30, v123
  v_mul_f32 v124, s30, v124
  v_mul_f32 v125, s30, v125
  v_mul_f32 v126, s30, v126
  v_mul_f32 v127, s30, v127
  v_cvt_pk_bf16_f32 v24, v112, v113
  v_cvt_pk_bf16_f32 v25, v114, v115
  v_cvt_pk_bf16_f32 v26, v116, v117
  v_cvt_pk_bf16_f32 v27, v118, v119
  v_cvt_pk_bf16_f32 v28, v120, v121
  v_cvt_pk_bf16_f32 v29, v122, v123
  v_cvt_pk_bf16_f32 v30, v124, v125
  v_cvt_pk_bf16_f32 v31, v126, v127
  buffer_store_dwordx4 v[24:27], v8, s[4:7], s27 offen offset:2048 sc1
  buffer_store_dwordx4 v[28:31], v8, s[4:7], s27 offen offset:3072 sc1
  v_cvt_pk_bf16_f32 v16, v128, v129
  v_cvt_pk_bf16_f32 v17, v130, v131
  v_cvt_pk_bf16_f32 v18, v132, v133
  v_cvt_pk_bf16_f32 v19, v134, v135
  v_cvt_pk_bf16_f32 v20, v136, v137
  v_cvt_pk_bf16_f32 v21, v138, v139
  v_cvt_pk_bf16_f32 v22, v140, v141
  v_cvt_pk_bf16_f32 v23, v142, v143
  buffer_store_dwordx4 v[16:19], v8, s[4:7], s28 offen offset:0 sc1
  buffer_store_dwordx4 v[20:23], v8, s[4:7], s28 offen offset:1024 sc1
  v_cvt_pk_bf16_f32 v24, v144, v145
  v_cvt_pk_bf16_f32 v25, v146, v147
  v_cvt_pk_bf16_f32 v26, v148, v149
  v_cvt_pk_bf16_f32 v27, v150, v151
  v_cvt_pk_bf16_f32 v28, v152, v153
  v_cvt_pk_bf16_f32 v29, v154, v155
  v_cvt_pk_bf16_f32 v30, v156, v157
  v_cvt_pk_bf16_f32 v31, v158, v159
  buffer_store_dwordx4 v[24:27], v8, s[4:7], s28 offen offset:2048 sc1
  buffer_store_dwordx4 v[28:31], v8, s[4:7], s28 offen offset:3072 sc1
  v_cvt_pk_bf16_f32 v16, v160, v161
  v_cvt_pk_bf16_f32 v17, v162, v163
  v_cvt_pk_bf16_f32 v18, v164, v165
  v_cvt_pk_bf16_f32 v19, v166, v167
  v_cvt_pk_bf16_f32 v20, v168, v169
  v_cvt_pk_bf16_f32 v21, v170, v171
  v_cvt_pk_bf16_f32 v22, v172, v173
  v_cvt_pk_bf16_f32 v23, v174, v175
  v_cndmask_b32 v16, v16, v3, s[32:33]
  v_cndmask_b32 v17, v17, v3, s[32:33]
  v_cndmask_b32 v18, v18, v3, s[32:33]
  v_cndmask_b32 v19, v19, v3, s[32:33]
  v_cndmask_b32 v20, v20, v3, s[32:33]
  v_cndmask_b32 v21, v21, v3, s[32:33]
  v_cndmask_b32 v22, v22, v3, s[32:33]
  v_cndmask_b32 v23, v23, v3, s[32:33]
  buffer_store_dwordx4 v[16:19], v8, s[4:7], s29 offen offset:0 sc1
  buffer_store_dwordx4 v[20:23], v8, s[4:7], s29 offen offset:1024 sc1
  v_cvt_pk_bf16_f32 v24, v176, v177
  v_cvt_pk_bf16_f32 v25, v178, v179
  v_cvt_pk_bf16_f32 v26, v180, v181
  v_cvt_pk_bf16_f32 v27, v182, v183
  v_cvt_pk_bf16_f32 v28, v184, v185
  v_cvt_pk_bf16_f32 v29, v186, v187
  v_cvt_pk_bf16_f32 v30, v188, v189
  v_cvt_pk_bf16_f32 v31, v190, v191
  v_cndmask_b32 v24, v24, v3, s[32:33]
  v_cndmask_b32 v25, v25, v3, s[32:33]
  v_cndmask_b32 v26, v26, v3, s[32:33]
  v_cndmask_b32 v27, v27, v3, s[32:33]
  v_cndmask_b32 v28, v28, v3, s[32:33]
  v_cndmask_b32 v29, v29, v3, s[32:33]
  v_cndmask_b32 v30, v30, v3, s[32:33]
  v_cndmask_b32 v31, v31, v3, s[32:33]
  buffer_store_dwordx4 v[24:27], v8, s[4:7], s29 offen offset:2048 sc1
  buffer_store_dwordx4 v[28:31], v8, s[4:7], s29 offen offset:3072 sc1
  s_waitcnt vmcnt(0)
qkvb_exit1:
  s_endpgm
.globl attnb_kernel
.p2align 8
.type attnb_kernel,@function
attnb_kernel:
  s_cmp_ge_u32 s2, 256
  s_cbranch_scc1 attnb_exit1
  s_load_dwordx2 s[12:13], s[0:1], 96
  v_lshrrev_b32 v2, 6, v0
  v_and_b32 v3, 63, v0
  s_nop 0
  v_readfirstlane_b32 s16, v2
  v_lshlrev_b32 v1, 4, v3
  s_and_b32 s17, s2, 7
  s_lshl_b32 s17, s17, 2
  s_lshr_b32 s18, s2, 3
  s_and_b32 s19, s18, 3
  s_add_u32 s17, s17, s19
  s_lshr_b32 s18, s18, 2
  s_waitcnt lgkmcnt(0)
  s_mov_b32 s4, s12
  s_mov_b32 s5, s13
  s_mov_b32 s6, 0x10000000
  s_mov_b32 s7, 0x20000
  s_lshl_b32 s20, s17, 17
  s_add_u32 s21, s20, 41943040
  s_add_u32 s22, s20, 46137344
  s_lshl_b32 s23, s18, 3
  s_lshl_b32 s24, s16, 1
  s_add_u32 s23, s23, s24
  s_lshl_b32 s24, s23, 11
  s_add_u32 s24, s24, s20
  s_add_u32 s24, s24, 37748736
  buffer_load_dwordx4 v[8:11], v1, s[4:7], s24 offen offset:0
  buffer_load_dwordx4 v[12:15], v1, s[4:7], s24 offen offset:1024
  buffer_load_dwordx4 v[16:19], v1, s[4:7], s24 offen offset:2048
  buffer_load_dwordx4 v[20:23], v1, s[4:7], s24 offen offset:3072
  s_mov_b32 s25, s21
  s_mov_b32 s26, s22
  buffer_load_dwordx4 v[136:139], v1, s[4:7], s25 offen
  buffer_load_dwordx4 v[140:143], v1, s[4:7], s25 offen offset:1024
  buffer_load_dwordx4 v[144:147], v1, s[4:7], s26 offen
  buffer_load_dwordx4 v[148:151], v1, s[4:7], s26 offen offset:1024
  s_add_u32 s25, s25, 2048
  s_add_u32 s26, s26, 2048
  s_waitcnt vmcnt(0)
  v_mfma_f32_32x32x16_bf16 v[88:103], v[136:139], v[8:11], 0
  v_mfma_f32_32x32x16_bf16 v[88:103], v[140:143], v[12:15], v[88:103]
  v_mfma_f32_32x32x16_bf16 v[104:119], v[136:139], v[16:19], 0
  v_mfma_f32_32x32x16_bf16 v[104:119], v[140:143], v[20:23], v[104:119]
  s_nop 9
  v_max3_f32 v2, v88, v89, v90
  v_max3_f32 v2, v2, v91, v92
  v_max3_f32 v2, v2, v93, v94
  v_max3_f32 v2, v2, v95, v96
  v_max3_f32 v2, v2, v97, v98
  v_max3_f32 v2, v2, v99, v100
  v_max3_f32 v2, v2, v101, v102
  v_max_f32 v2, v2, v103
  v_mov_b32 v4, v2
  s_nop 1
  v_permlane32_swap_b32 v2, v4
  v_max_f32 v2, v2, v4
  v_sub_f32 v24, 0, v2
  v_sub_f32 v25, 0, v2
  v_sub_f32 v26, 0, v2
  v_sub_f32 v27, 0, v2
  v_sub_f32 v28, 0, v2
  v_sub_f32 v29, 0, v2
  v_sub_f32 v30, 0, v2
  v_sub_f32 v31, 0, v2
  v_sub_f32 v32, 0, v2
  v_sub_f32 v33, 0, v2
  v_sub_f32 v34, 0, v2
  v_sub_f32 v35, 0, v2
  v_sub_f32 v36, 0, v2
  v_sub_f32 v37, 0, v2
  v_sub_f32 v38, 0, v2
  v_sub_f32 v39, 0, v2
  v_max3_f32 v3, v104, v105, v106
  v_max3_f32 v3, v3, v107, v108
  v_max3_f32 v3, v3, v109, v110
  v_max3_f32 v3, v3, v111, v112
  v_max3_f32 v3, v3, v113, v114
  v_max3_f32 v3, v3, v115, v116
  v_max3_f32 v3, v3, v117, v118
  v_max_f32 v3, v3, v119
  v_mov_b32 v4, v3
  s_nop 1
  v_permlane32_swap_b32 v3, v4
  v_max_f32 v3, v3, v4
  v_sub_f32 v40, 0, v3
  v_sub_f32 v41, 0, v3
  v_sub_f32 v42, 0, v3
  v_sub_f32 v43, 0, v3
  v_sub_f32 v44, 0, v3
  v_sub_f32 v45, 0, v3
  v_sub_f32 v46, 0, v3
  v_sub_f32 v47, 0, v3
  v_sub_f32 v48, 0, v3
  v_sub_f32 v49, 0, v3
  v_sub_f32 v50, 0, v3
  v_sub_f32 v51, 0, v3
  v_sub_f32 v52, 0, v3
  v_sub_f32 v53, 0, v3
  v_sub_f32 v54, 0, v3
  v_sub_f32 v55, 0, v3
  s_mov_b32 s28, 0
attnb_main2:
  s_mov_b32 s25, s21
  s_mov_b32 s26, s22
  buffer_load_dwordx4 v[136:139], v1, s[4:7], s25 offen
  buffer_load_dwordx4 v[140:143], v1, s[4:7], s25 offen offset:1024
  buffer_load_dwordx4 v[144:147], v1, s[4:7], s26 offen
  buffer_load_dwordx4 v[148:151], v1, s[4:7], s26 offen offset:1024
  s_add_u32 s25, s25, 2048
  s_add_u32 s26, s26, 2048
  buffer_load_dwordx4 v[152:155], v1, s[4:7], s25 offen
  buffer_load_dwordx4 v[156:159], v1, s[4:7], s25 offen offset:1024
  buffer_load_dwordx4 v[160:163], v1, s[4:7], s26 offen
  buffer_load_dwordx4 v[164:167], v1, s[4:7], s26 offen offset:1024
  s_add_u32 s25, s25, 2048
  s_add_u32 s26, s26, 2048
  v_mov_b32 v56, 0
  v_mov_b32 v57, 0
  v_mov_b32 v58, 0
  v_mov_b32 v59, 0
  v_mov_b32 v60, 0
  v_mov_b32 v61, 0
  v_mov_b32 v62, 0
  v_mov_b32 v63, 0
  v_mov_b32 v64, 0
  v_mov_b32 v65, 0
  v_mov_b32 v66, 0
  v_mov_b32 v67, 0
  v_mov_b32 v68, 0
  v_mov_b32 v69, 0
  v_mov_b32 v70, 0
  v_mov_b32 v71, 0
  v_mov_b32 v72, 0
  v_mov_b32 v73, 0
  v_mov_b32 v74, 0
  v_mov_b32 v75, 0
  v_mov_b32 v76, 0
  v_mov_b32 v77, 0
  v_mov_b32 v78, 0
  v_mov_b32 v79, 0
  v_mov_b32 v80, 0
  v_mov_b32 v81, 0
  v_mov_b32 v82, 0
  v_mov_b32 v83, 0
  v_mov_b32 v84, 0
  v_mov_b32 v85, 0
  v_mov_b32 v86, 0
  v_mov_b32 v87, 0
  s_waitcnt vmcnt(4)
  v_mfma_f32_32x32x16_bf16 v[88:103], v[136:139], v[8:11], v[24:39]
  v_mfma_f32_32x32x16_bf16 v[88:103], v[140:143], v[12:15], v[88:103]
  s_nop 11
  v_exp_f32 v88, v88
  v_exp_f32 v89, v89
  v_exp_f32 v90, v90
  v_exp_f32 v91, v91
  v_exp_f32 v92, v92
  v_exp_f32 v93, v93
  v_exp_f32 v94, v94
  v_exp_f32 v95, v95
  v_mfma_f32_32x32x16_bf16 v[104:119], v[136:139], v[16:19], v[40:55]
  v_cvt_pk_bf16_f32 v120, v88, v89
  v_cvt_pk_bf16_f32 v121, v90, v91
  v_cvt_pk_bf16_f32 v122, v92, v93
  v_cvt_pk_bf16_f32 v123, v94, v95
  v_exp_f32 v96, v96
  v_exp_f32 v97, v97
  v_mfma_f32_32x32x16_bf16 v[104:119], v[140:143], v[20:23], v[104:119]
  v_exp_f32 v98, v98
  v_exp_f32 v99, v99
  v_exp_f32 v100, v100
  v_exp_f32 v101, v101
  v_mfma_f32_32x32x16_bf16 v[56:71], v[144:147], v[120:123], v[56:71]
  v_exp_f32 v102, v102
  v_exp_f32 v103, v103
  v_cvt_pk_bf16_f32 v124, v96, v97
  v_cvt_pk_bf16_f32 v125, v98, v99
  v_cvt_pk_bf16_f32 v126, v100, v101
  v_cvt_pk_bf16_f32 v127, v102, v103
  buffer_load_dwordx4 v[168:171], v1, s[4:7], s25 offen
  buffer_load_dwordx4 v[172:175], v1, s[4:7], s25 offen offset:1024
  buffer_load_dwordx4 v[176:179], v1, s[4:7], s26 offen
  buffer_load_dwordx4 v[180:183], v1, s[4:7], s26 offen offset:1024
  s_add_u32 s25, s25, 2048
  s_add_u32 s26, s26, 2048
  s_waitcnt vmcnt(4)
  v_exp_f32 v104, v104
  v_exp_f32 v105, v105
  v_exp_f32 v106, v106
  v_exp_f32 v107, v107
  v_mfma_f32_32x32x16_bf16 v[56:71], v[148:151], v[124:127], v[56:71]
  v_exp_f32 v108, v108
  v_exp_f32 v109, v109
  v_exp_f32 v110, v110
  v_exp_f32 v111, v111
  v_mfma_f32_32x32x16_bf16 v[88:103], v[152:155], v[8:11], v[24:39]
  v_cvt_pk_bf16_f32 v128, v104, v105
  v_cvt_pk_bf16_f32 v129, v106, v107
  v_cvt_pk_bf16_f32 v130, v108, v109
  v_cvt_pk_bf16_f32 v131, v110, v111
  v_exp_f32 v112, v112
  v_exp_f32 v113, v113
  v_mfma_f32_32x32x16_bf16 v[88:103], v[156:159], v[12:15], v[88:103]
  v_exp_f32 v114, v114
  v_exp_f32 v115, v115
  v_exp_f32 v116, v116
  v_exp_f32 v117, v117
  v_mfma_f32_32x32x16_bf16 v[72:87], v[144:147], v[128:131], v[72:87]
  v_exp_f32 v118, v118
  v_exp_f32 v119, v119
  v_cvt_pk_bf16_f32 v132, v112, v113
  v_cvt_pk_bf16_f32 v133, v114, v115
  v_cvt_pk_bf16_f32 v134, v116, v117
  v_cvt_pk_bf16_f32 v135, v118, v119
  s_mov_b32 s27, 0
attnb_loop3:
  v_exp_f32 v88, v88
  v_exp_f32 v89, v89
  v_exp_f32 v90, v90
  v_exp_f32 v91, v91
  v_mfma_f32_32x32x16_bf16 v[72:87], v[148:151], v[132:135], v[72:87]
  v_exp_f32 v92, v92
  v_exp_f32 v93, v93
  v_exp_f32 v94, v94
  v_exp_f32 v95, v95
  v_mfma_f32_32x32x16_bf16 v[104:119], v[152:155], v[16:19], v[40:55]
  v_cvt_pk_bf16_f32 v120, v88, v89
  v_cvt_pk_bf16_f32 v121, v90, v91
  v_cvt_pk_bf16_f32 v122, v92, v93
  v_cvt_pk_bf16_f32 v123, v94, v95
  v_exp_f32 v96, v96
  v_exp_f32 v97, v97
  v_mfma_f32_32x32x16_bf16 v[104:119], v[156:159], v[20:23], v[104:119]
  v_exp_f32 v98, v98
  v_exp_f32 v99, v99
  v_exp_f32 v100, v100
  v_exp_f32 v101, v101
  v_mfma_f32_32x32x16_bf16 v[56:71], v[160:163], v[120:123], v[56:71]
  v_exp_f32 v102, v102
  v_exp_f32 v103, v103
  v_cvt_pk_bf16_f32 v124, v96, v97
  v_cvt_pk_bf16_f32 v125, v98, v99
  v_cvt_pk_bf16_f32 v126, v100, v101
  v_cvt_pk_bf16_f32 v127, v102, v103
  buffer_load_dwordx4 v[136:139], v1, s[4:7], s25 offen
  buffer_load_dwordx4 v[140:143], v1, s[4:7], s25 offen offset:1024
  buffer_load_dwordx4 v[144:147], v1, s[4:7], s26 offen
  buffer_load_dwordx4 v[148:151], v1, s[4:7], s26 offen offset:1024
  s_add_u32 s25, s25, 2048
  s_add_u32 s26, s26, 2048
  s_waitcnt vmcnt(4)
  v_exp_f32 v104, v104
  v_exp_f32 v105, v105
  v_exp_f32 v106, v106
  v_exp_f32 v107, v107
  v_mfma_f32_32x32x16_bf16 v[56:71], v[164:167], v[124:127], v[56:71]
  v_exp_f32 v108, v108
  v_exp_f32 v109, v109
  v_exp_f32 v110, v110
  v_exp_f32 v111, v111
  v_mfma_f32_32x32x16_bf16 v[88:103], v[168:171], v[8:11], v[24:39]
  v_cvt_pk_bf16_f32 v128, v104, v105
  v_cvt_pk_bf16_f32 v129, v106, v107
  v_cvt_pk_bf16_f32 v130, v108, v109
  v_cvt_pk_bf16_f32 v131, v110, v111
  v_exp_f32 v112, v112
  v_exp_f32 v113, v113
  v_mfma_f32_32x32x16_bf16 v[88:103], v[172:175], v[12:15], v[88:103]
  v_exp_f32 v114, v114
  v_exp_f32 v115, v115
  v_exp_f32 v116, v116
  v_exp_f32 v117, v117
  v_mfma_f32_32x32x16_bf16 v[72:87], v[160:163], v[128:131], v[72:87]
  v_exp_f32 v118, v118
  v_exp_f32 v119, v119
  v_cvt_pk_bf16_f32 v132, v112, v113
  v_cvt_pk_bf16_f32 v133, v114, v115
  v_cvt_pk_bf16_f32 v134, v116, v117
  v_cvt_pk_bf16_f32 v135, v118, v119
  s_nop 0
  v_exp_f32 v88, v88
  v_exp_f32 v89, v89
  v_exp_f32 v90, v90
  v_exp_f32 v91, v91
  v_mfma_f32_32x32x16_bf16 v[72:87], v[164:167], v[132:135], v[72:87]
  v_exp_f32 v92, v92
  v_exp_f32 v93, v93
  v_exp_f32 v94, v94
  v_exp_f32 v95, v95
  v_mfma_f32_32x32x16_bf16 v[104:119], v[168:171], v[16:19], v[40:55]
  v_cvt_pk_bf16_f32 v120, v88, v89
  v_cvt_pk_bf16_f32 v121, v90, v91
  v_cvt_pk_bf16_f32 v122, v92, v93
  v_cvt_pk_bf16_f32 v123, v94, v95
  v_exp_f32 v96, v96
  v_exp_f32 v97, v97
  v_mfma_f32_32x32x16_bf16 v[104:119], v[172:175], v[20:23], v[104:119]
  v_exp_f32 v98, v98
  v_exp_f32 v99, v99
  v_exp_f32 v100, v100
  v_exp_f32 v101, v101
  v_mfma_f32_32x32x16_bf16 v[56:71], v[176:179], v[120:123], v[56:71]
  v_exp_f32 v102, v102
  v_exp_f32 v103, v103
  v_cvt_pk_bf16_f32 v124, v96, v97
  v_cvt_pk_bf16_f32 v125, v98, v99
  v_cvt_pk_bf16_f32 v126, v100, v101
  v_cvt_pk_bf16_f32 v127, v102, v103
  buffer_load_dwordx4 v[152:155], v1, s[4:7], s25 offen
  buffer_load_dwordx4 v[156:159], v1, s[4:7], s25 offen offset:1024
  buffer_load_dwordx4 v[160:163], v1, s[4:7], s26 offen
  buffer_load_dwordx4 v[164:167], v1, s[4:7], s26 offen offset:1024
  s_add_u32 s25, s25, 2048
  s_add_u32 s26, s26, 2048
  s_waitcnt vmcnt(4)
  v_exp_f32 v104, v104
  v_exp_f32 v105, v105
  v_exp_f32 v106, v106
  v_exp_f32 v107, v107
  v_mfma_f32_32x32x16_bf16 v[56:71], v[180:183], v[124:127], v[56:71]
  v_exp_f32 v108, v108
  v_exp_f32 v109, v109
  v_exp_f32 v110, v110
  v_exp_f32 v111, v111
  v_mfma_f32_32x32x16_bf16 v[88:103], v[136:139], v[8:11], v[24:39]
  v_cvt_pk_bf16_f32 v128, v104, v105
  v_cvt_pk_bf16_f32 v129, v106, v107
  v_cvt_pk_bf16_f32 v130, v108, v109
  v_cvt_pk_bf16_f32 v131, v110, v111
  v_exp_f32 v112, v112
  v_exp_f32 v113, v113
  v_mfma_f32_32x32x16_bf16 v[88:103], v[140:143], v[12:15], v[88:103]
  v_exp_f32 v114, v114
  v_exp_f32 v115, v115
  v_exp_f32 v116, v116
  v_exp_f32 v117, v117
  v_mfma_f32_32x32x16_bf16 v[72:87], v[176:179], v[128:131], v[72:87]
  v_exp_f32 v118, v118
  v_exp_f32 v119, v119
  v_cvt_pk_bf16_f32 v132, v112, v113
  v_cvt_pk_bf16_f32 v133, v114, v115
  v_cvt_pk_bf16_f32 v134, v116, v117
  v_cvt_pk_bf16_f32 v135, v118, v119
  s_nop 0
  v_exp_f32 v88, v88
  v_exp_f32 v89, v89
  v_exp_f32 v90, v90
  v_exp_f32 v91, v91
  v_mfma_f32_32x32x16_bf16 v[72:87], v[180:183], v[132:135], v[72:87]
  v_exp_f32 v92, v92
  v_exp_f32 v93, v93
  v_exp_f32 v94, v94
  v_exp_f32 v95, v95
  v_mfma_f32_32x32x16_bf16 v[104:119], v[136:139], v[16:19], v[40:55]
  v_cvt_pk_bf16_f32 v120, v88, v89
  v_cvt_pk_bf16_f32 v121, v90, v91
  v_cvt_pk_bf16_f32 v122, v92, v93
  v_cvt_pk_bf16_f32 v123, v94, v95
  v_exp_f32 v96, v96
  v_exp_f32 v97, v97
  v_mfma_f32_32x32x16_bf16 v[104:119], v[140:143], v[20:23], v[104:119]
  v_exp_f32 v98, v98
  v_exp_f32 v99, v99
  v_exp_f32 v100, v100
  v_exp_f32 v101, v101
  v_mfma_f32_32x32x16_bf16 v[56:71], v[144:147], v[120:123], v[56:71]
  v_exp_f32 v102, v102
  v_exp_f32 v103, v103
  v_cvt_pk_bf16_f32 v124, v96, v97
  v_cvt_pk_bf16_f32 v125, v98, v99
  v_cvt_pk_bf16_f32 v126, v100, v101
  v_cvt_pk_bf16_f32 v127, v102, v103
  buffer_load_dwordx4 v[168:171], v1, s[4:7], s25 offen
  buffer_load_dwordx4 v[172:175], v1, s[4:7], s25 offen offset:1024
  buffer_load_dwordx4 v[176:179], v1, s[4:7], s26 offen
  buffer_load_dwordx4 v[180:183], v1, s[4:7], s26 offen offset:1024
  s_add_u32 s25, s25, 2048
  s_add_u32 s26, s26, 2048
  s_waitcnt vmcnt(4)
  v_exp_f32 v104, v104
  v_exp_f32 v105, v105
  v_exp_f32 v106, v106
  v_exp_f32 v107, v107
  v_mfma_f32_32x32x16_bf16 v[56:71], v[148:151], v[124:127], v[56:71]
  v_exp_f32 v108, v108
  v_exp_f32 v109, v109
  v_exp_f32 v110, v110
  v_exp_f32 v111, v111
  v_mfma_f32_32x32x16_bf16 v[88:103], v[152:155], v[8:11], v[24:39]
  v_cvt_pk_bf16_f32 v128, v104, v105
  v_cvt_pk_bf16_f32 v129, v106, v107
  v_cvt_pk_bf16_f32 v130, v108, v109
  v_cvt_pk_bf16_f32 v131, v110, v111
  v_exp_f32 v112, v112
  v_exp_f32 v113, v113
  v_mfma_f32_32x32x16_bf16 v[88:103], v[156:159], v[12:15], v[88:103]
  v_exp_f32 v114, v114
  v_exp_f32 v115, v115
  v_exp_f32 v116, v116
  v_exp_f32 v117, v117
  v_mfma_f32_32x32x16_bf16 v[72:87], v[144:147], v[128:131], v[72:87]
  v_exp_f32 v118, v118
  v_exp_f32 v119, v119
  v_cvt_pk_bf16_f32 v132, v112, v113
  v_cvt_pk_bf16_f32 v133, v114, v115
  v_cvt_pk_bf16_f32 v134, v116, v117
  v_cvt_pk_bf16_f32 v135, v118, v119
  s_add_u32 s27, s27, 1
  s_cmp_lt_u32 s27, 20
  s_cbranch_scc1 attnb_loop3
  v_exp_f32 v88, v88
  v_exp_f32 v89, v89
  v_exp_f32 v90, v90
  v_exp_f32 v91, v91
  v_mfma_f32_32x32x16_bf16 v[72:87], v[148:151], v[132:135], v[72:87]
  v_exp_f32 v92, v92
  v_exp_f32 v93, v93
  v_exp_f32 v94, v94
  v_exp_f32 v95, v95
  v_mfma_f32_32x32x16_bf16 v[104:119], v[152:155], v[16:19], v[40:55]
  v_cvt_pk_bf16_f32 v120, v88, v89
  v_cvt_pk_bf16_f32 v121, v90, v91
  v_cvt_pk_bf16_f32 v122, v92, v93
  v_cvt_pk_bf16_f32 v123, v94, v95
  v_exp_f32 v96, v96
  v_exp_f32 v97, v97
  v_mfma_f32_32x32x16_bf16 v[104:119], v[156:159], v[20:23], v[104:119]
  v_exp_f32 v98, v98
  v_exp_f32 v99, v99
  v_exp_f32 v100, v100
  v_exp_f32 v101, v101
  v_mfma_f32_32x32x16_bf16 v[56:71], v[160:163], v[120:123], v[56:71]
  v_exp_f32 v102, v102
  v_exp_f32 v103, v103
  v_cvt_pk_bf16_f32 v124, v96, v97
  v_cvt_pk_bf16_f32 v125, v98, v99
  v_cvt_pk_bf16_f32 v126, v100, v101
  v_cvt_pk_bf16_f32 v127, v102, v103
  buffer_load_dwordx4 v[136:139], v1, s[4:7], s25 offen
  buffer_load_dwordx4 v[140:143], v1, s[4:7], s25 offen offset:1024
  buffer_load_dwordx4 v[144:147], v1, s[4:7], s26 offen
  buffer_load_dwordx4 v[148:151], v1, s[4:7], s26 offen offset:1024
  s_add_u32 s25, s25, 2048
  s_add_u32 s26, s26, 2048
  s_waitcnt vmcnt(4)
  v_exp_f32 v104, v104
  v_exp_f32 v105, v105
  v_exp_f32 v106, v106
  v_exp_f32 v107, v107
  v_mfma_f32_32x32x16_bf16 v[56:71], v[164:167], v[124:127], v[56:71]
  v_exp_f32 v108, v108
  v_exp_f32 v109, v109
  v_exp_f32 v110, v110
  v_exp_f32 v111, v111
  v_mfma_f32_32x32x16_bf16 v[88:103], v[168:171], v[8:11], v[24:39]
  v_cvt_pk_bf16_f32 v128, v104, v105
  v_cvt_pk_bf16_f32 v129, v106, v107
  v_cvt_pk_bf16_f32 v130, v108, v109
  v_cvt_pk_bf16_f32 v131, v110, v111
  v_exp_f32 v112, v112
  v_exp_f32 v113, v113
  v_mfma_f32_32x32x16_bf16 v[88:103], v[172:175], v[12:15], v[88:103]
  v_exp_f32 v114, v114
  v_exp_f32 v115, v115
  v_exp_f32 v116, v116
  v_exp_f32 v117, v117
  v_mfma_f32_32x32x16_bf16 v[72:87], v[160:163], v[128:131], v[72:87]
  v_exp_f32 v118, v118
  v_exp_f32 v119, v119
  v_cvt_pk_bf16_f32 v132, v112, v113
  v_cvt_pk_bf16_f32 v133, v114, v115
  v_cvt_pk_bf16_f32 v134, v116, v117
  v_cvt_pk_bf16_f32 v135, v118, v119
  s_nop 0
  v_exp_f32 v88, v88
  v_exp_f32 v89, v89
  v_exp_f32 v90, v90
  v_exp_f32 v91, v91
  v_mfma_f32_32x32x16_bf16 v[72:87], v[164:167], v[132:135], v[72:87]
  v_exp_f32 v92, v92
  v_exp_f32 v93, v93
  v_exp_f32 v94, v94
  v_exp_f32 v95, v95
  v_mfma_f32_32x32x16_bf16 v[104:119], v[168:171], v[16:19], v[40:55]
  v_cvt_pk_bf16_f32 v120, v88, v89
  v_cvt_pk_bf16_f32 v121, v90, v91
  v_cvt_pk_bf16_f32 v122, v92, v93
  v_cvt_pk_bf16_f32 v123, v94, v95
  v_exp_f32 v96, v96
  v_exp_f32 v97, v97
  v_mfma_f32_32x32x16_bf16 v[104:119], v[172:175], v[20:23], v[104:119]
  v_exp_f32 v98, v98
  v_exp_f32 v99, v99
  v_exp_f32 v100, v100
  v_exp_f32 v101, v101
  v_mfma_f32_32x32x16_bf16 v[56:71], v[176:179], v[120:123], v[56:71]
  v_exp_f32 v102, v102
  v_exp_f32 v103, v103
  v_cvt_pk_bf16_f32 v124, v96, v97
  v_cvt_pk_bf16_f32 v125, v98, v99
  v_cvt_pk_bf16_f32 v126, v100, v101
  v_cvt_pk_bf16_f32 v127, v102, v103
  s_waitcnt vmcnt(0)
  v_exp_f32 v104, v104
  v_exp_f32 v105, v105
  v_exp_f32 v106, v106
  v_exp_f32 v107, v107
  v_mfma_f32_32x32x16_bf16 v[56:71], v[180:183], v[124:127], v[56:71]
  v_exp_f32 v108, v108
  v_exp_f32 v109, v109
  v_exp_f32 v110, v110
  v_exp_f32 v111, v111
  v_mfma_f32_32x32x16_bf16 v[88:103], v[136:139], v[8:11], v[24:39]
  v_cvt_pk_bf16_f32 v128, v104, v105
  v_cvt_pk_bf16_f32 v129, v106, v107
  v_cvt_pk_bf16_f32 v130, v108, v109
  v_cvt_pk_bf16_f32 v131, v110, v111
  v_exp_f32 v112, v112
  v_exp_f32 v113, v113
  v_mfma_f32_32x32x16_bf16 v[88:103], v[140:143], v[12:15], v[88:103]
  v_exp_f32 v114, v114
  v_exp_f32 v115, v115
  v_exp_f32 v116, v116
  v_exp_f32 v117, v117
  v_mfma_f32_32x32x16_bf16 v[72:87], v[176:179], v[128:131], v[72:87]
  v_exp_f32 v118, v118
  v_exp_f32 v119, v119
  v_cvt_pk_bf16_f32 v132, v112, v113
  v_cvt_pk_bf16_f32 v133, v114, v115
  v_cvt_pk_bf16_f32 v134, v116, v117
  v_cvt_pk_bf16_f32 v135, v118, v119
  s_nop 0
  v_exp_f32 v88, v88
  v_exp_f32 v89, v89
  v_exp_f32 v90, v90
  v_exp_f32 v91, v91
  v_mfma_f32_32x32x16_bf16 v[72:87], v[180:183], v[132:135], v[72:87]
  v_exp_f32 v92, v92
  v_exp_f32 v93, v93
  v_exp_f32 v94, v94
  v_exp_f32 v95, v95
  v_mfma_f32_32x32x16_bf16 v[104:119], v[136:139], v[16:19], v[40:55]
  v_cvt_pk_bf16_f32 v120, v88, v89
  v_cvt_pk_bf16_f32 v121, v90, v91
  v_cvt_pk_bf16_f32 v122, v92, v93
  v_cvt_pk_bf16_f32 v123, v94, v95
  v_exp_f32 v96, v96
  v_exp_f32 v97, v97
  v_mfma_f32_32x32x16_bf16 v[104:119], v[140:143], v[20:23], v[104:119]
  v_exp_f32 v98, v98
  v_exp_f32 v99, v99
  v_exp_f32 v100, v100
  v_exp_f32 v101, v101
  v_mfma_f32_32x32x16_bf16 v[56:71], v[144:147], v[120:123], v[56:71]
  v_exp_f32 v102, v102
  v_exp_f32 v103, v103
  v_cvt_pk_bf16_f32 v124, v96, v97
  v_cvt_pk_bf16_f32 v125, v98, v99
  v_cvt_pk_bf16_f32 v126, v100, v101
  v_cvt_pk_bf16_f32 v127, v102, v103
  s_nop 0
  v_exp_f32 v104, v104
  v_exp_f32 v105, v105
  v_exp_f32 v106, v106
  v_exp_f32 v107, v107
  v_mfma_f32_32x32x16_bf16 v[56:71], v[148:151], v[124:127], v[56:71]
  v_exp_f32 v108, v108
  v_exp_f32 v109, v109
  v_exp_f32 v110, v110
  v_exp_f32 v111, v111
  v_cvt_pk_bf16_f32 v128, v104, v105
  v_cvt_pk_bf16_f32 v129, v106, v107
  v_cvt_pk_bf16_f32 v130, v108, v109
  v_cvt_pk_bf16_f32 v131, v110, v111
  v_exp_f32 v112, v112
  v_exp_f32 v113, v113
  v_exp_f32 v114, v114
  v_exp_f32 v115, v115
  v_exp_f32 v116, v116
  v_exp_f32 v117, v117
  v_mfma_f32_32x32x16_bf16 v[72:87], v[144:147], v[128:131], v[72:87]
  v_exp_f32 v118, v118
  v_exp_f32 v119, v119
  v_cvt_pk_bf16_f32 v132, v112, v113
  v_cvt_pk_bf16_f32 v133, v114, v115
  v_cvt_pk_bf16_f32 v134, v116, v117
  v_cvt_pk_bf16_f32 v135, v118, v119
  s_nop 1
  v_mfma_f32_32x32x16_bf16 v[72:87], v[148:151], v[132:135], v[72:87]
  v_mov_b32 v2, v64
  v_mov_b32 v4, v2
  s_nop 1
  v_permlane32_swap_b32 v4, v2
  s_nop 6
  v_mov_b32 v3, v80
  v_mov_b32 v4, v3
  s_nop 1
  v_permlane32_swap_b32 v4, v3
  s_cmp_eq_u32 s28, 1
  s_cbranch_scc1 attnb_done5
  v_max_f32 v4, v2, v3
  v_cmp_nge_f32 vcc, 0x4e800000, v4
  v_cmp_u_f32 s[30:31], v2, v3
  s_nop 3
  s_or_b64 s[32:33], vcc, s[30:31]
  s_movk_i32 s34, 0x207
  v_cmp_class_f32 vcc, v56, s34
  s_nop 3
  s_or_b64 s[32:33], s[32:33], vcc
  v_cmp_class_f32 vcc, v57, s34
  s_nop 3
  s_or_b64 s[32:33], s[32:33], vcc
  v_cmp_class_f32 vcc, v58, s34
  s_nop 3
  s_or_b64 s[32:33], s[32:33], vcc
  v_cmp_class_f32 vcc, v59, s34
  s_nop 3
  s_or_b64 s[32:33], s[32:33], vcc
  v_cmp_class_f32 vcc, v60, s34
  s_nop 3
  s_or_b64 s[32:33], s[32:33], vcc
  v_cmp_class_f32 vcc, v61, s34
  s_nop 3
  s_or_b64 s[32:33], s[32:33], vcc
  v_cmp_class_f32 vcc, v62, s34
  s_nop 3
  s_or_b64 s[32:33], s[32:33], vcc
  v_cmp_class_f32 vcc, v63, s34
  s_nop 3
  s_or_b64 s[32:33], s[32:33], vcc
  v_cmp_class_f32 vcc, v64, s34
  s_nop 3
  s_or_b64 s[32:33], s[32:33], vcc
  v_cmp_class_f32 vcc, v65, s34
  s_nop 3
  s_or_b64 s[32:33], s[32:33], vcc
  v_cmp_class_f32 vcc, v66, s34
  s_nop 3
  s_or_b64 s[32:33], s[32:33], vcc
  v_cmp_class_f32 vcc, v67, s34
  s_nop 3
  s_or_b64 s[32:33], s[32:33], vcc
  v_cmp_class_f32 vcc, v68, s34
  s_nop 3
  s_or_b64 s[32:33], s[32:33], vcc
  v_cmp_class_f32 vcc, v69, s34
  s_nop 3
  s_or_b64 s[32:33], s[32:33], vcc
  v_cmp_class_f32 vcc, v70, s34
  s_nop 3
  s_or_b64 s[32:33], s[32:33], vcc
  v_cmp_class_f32 vcc, v71, s34
  s_nop 3
  s_or_b64 s[32:33], s[32:33], vcc
  v_cmp_class_f32 vcc, v72, s34
  s_nop 3
  s_or_b64 s[32:33], s[32:33], vcc
  v_cmp_class_f32 vcc, v73, s34
  s_nop 3
  s_or_b64 s[32:33], s[32:33], vcc
  v_cmp_class_f32 vcc, v74, s34
  s_nop 3
  s_or_b64 s[32:33], s[32:33], vcc
  v_cmp_class_f32 vcc, v75, s34
  s_nop 3
  s_or_b64 s[32:33], s[32:33], vcc
  v_cmp_class_f32 vcc, v76, s34
  s_nop 3
  s_or_b64 s[32:33], s[32:33], vcc
  v_cmp_class_f32 vcc, v77, s34
  s_nop 3
  s_or_b64 s[32:33], s[32:33], vcc
  v_cmp_class_f32 vcc, v78, s34
  s_nop 3
  s_or_b64 s[32:33], s[32:33], vcc
  v_cmp_class_f32 vcc, v79, s34
  s_nop 3
  s_or_b64 s[32:33], s[32:33], vcc
  v_cmp_class_f32 vcc, v80, s34
  s_nop 3
  s_or_b64 s[32:33], s[32:33], vcc
  v_cmp_class_f32 vcc, v81, s34
  s_nop 3
  s_or_b64 s[32:33], s[32:33], vcc
  v_cmp_class_f32 vcc, v82, s34
  s_nop 3
  s_or_b64 s[32:33], s[32:33], vcc
  v_cmp_class_f32 vcc, v83, s34
  s_nop 3
  s_or_b64 s[32:33], s[32:33], vcc
  v_cmp_class_f32 vcc, v84, s34
  s_nop 3
  s_or_b64 s[32:33], s[32:33], vcc
  v_cmp_class_f32 vcc, v85, s34
  s_nop 3
  s_or_b64 s[32:33], s[32:33], vcc
  v_cmp_class_f32 vcc, v86, s34
  s_nop 3
  s_or_b64 s[32:33], s[32:33], vcc
  v_cmp_class_f32 vcc, v87, s34
  s_nop 3
  s_or_b64 s[32:33], s[32:33], vcc
  s_mov_b64 vcc, s[32:33]
  s_cbranch_vccz attnb_done5
  s_mov_b32 s25, s21
  s_mov_b32 s27, 0
  v_mov_b32 v120, 0xff800000
  v_mov_b32 v121, 0xff800000
attnb_fb4:
  buffer_load_dwordx4 v[136:139], v1, s[4:7], s25 offen
  buffer_load_dwordx4 v[140:143], v1, s[4:7], s25 offen offset:1024
  s_add_u32 s25, s25, 2048
  s_waitcnt vmcnt(0)
  v_mfma_f32_32x32x16_bf16 v[88:103], v[136:139], v[8:11], 0
  v_mfma_f32_32x32x16_bf16 v[88:103], v[140:143], v[12:15], v[88:103]
  v_mfma_f32_32x32x16_bf16 v[104:119], v[136:139], v[16:19], 0
  v_mfma_f32_32x32x16_bf16 v[104:119], v[140:143], v[20:23], v[104:119]
  s_nop 9
  v_max3_f32 v2, v88, v89, v90
  v_max3_f32 v2, v2, v91, v92
  v_max3_f32 v2, v2, v93, v94
  v_max3_f32 v2, v2, v95, v96
  v_max3_f32 v2, v2, v97, v98
  v_max3_f32 v2, v2, v99, v100
  v_max3_f32 v2, v2, v101, v102
  v_max_f32 v2, v2, v103
  v_max_f32 v120, v120, v2
  s_nop 2
  v_max3_f32 v3, v104, v105, v106
  v_max3_f32 v3, v3, v107, v108
  v_max3_f32 v3, v3, v109, v110
  v_max3_f32 v3, v3, v111, v112
  v_max3_f32 v3, v3, v113, v114
  v_max3_f32 v3, v3, v115, v116
  v_max3_f32 v3, v3, v117, v118
  v_max_f32 v3, v3, v119
  v_max_f32 v121, v121, v3
  s_add_u32 s27, s27, 1
  s_cmp_lt_u32 s27, 64
  s_cbranch_scc1 attnb_fb4
  v_mov_b32 v4, v120
  s_nop 1
  v_permlane32_swap_b32 v120, v4
  v_max_f32 v120, v120, v4
  v_sub_f32 v24, 0, v120
  v_sub_f32 v25, 0, v120
  v_sub_f32 v26, 0, v120
  v_sub_f32 v27, 0, v120
  v_sub_f32 v28, 0, v120
  v_sub_f32 v29, 0, v120
  v_sub_f32 v30, 0, v120
  v_sub_f32 v31, 0, v120
  v_sub_f32 v32, 0, v120
  v_sub_f32 v33, 0, v120
  v_sub_f32 v34, 0, v120
  v_sub_f32 v35, 0, v120
  v_sub_f32 v36, 0, v120
  v_sub_f32 v37, 0, v120
  v_sub_f32 v38, 0, v120
  v_sub_f32 v39, 0, v120
  v_mov_b32 v4, v121
  s_nop 1
  v_permlane32_swap_b32 v121, v4
  v_max_f32 v121, v121, v4
  v_sub_f32 v40, 0, v121
  v_sub_f32 v41, 0, v121
  v_sub_f32 v42, 0, v121
  v_sub_f32 v43, 0, v121
  v_sub_f32 v44, 0, v121
  v_sub_f32 v45, 0, v121
  v_sub_f32 v46, 0, v121
  v_sub_f32 v47, 0, v121
  v_sub_f32 v48, 0, v121
  v_sub_f32 v49, 0, v121
  v_sub_f32 v50, 0, v121
  v_sub_f32 v51, 0, v121
  v_sub_f32 v52, 0, v121
  v_sub_f32 v53, 0, v121
  v_sub_f32 v54, 0, v121
  v_sub_f32 v55, 0, v121
  s_mov_b32 s28, 1
  s_branch attnb_main2
attnb_done5:
  v_and_b32 v136, 63, v0
  v_and_b32 v137, 15, v136
  v_lshlrev_b32 v137, 4, v137
  v_lshrrev_b32 v138, 5, v136
  v_lshl_add_u32 v137, v138, 8, v137
  v_bfe_u32 v138, v136, 4, 1
  v_lshl_add_u32 v137, v138, 15, v137
  s_lshl_b32 s24, s23, 16
  s_lshl_b32 s25, s17, 10
  s_add_u32 s24, s24, s25
  s_add_u32 s24, s24, 50331648
  v_rcp_f32 v4, v2
  s_nop 0
  v_mul_f32 v56, v56, v4
  v_mul_f32 v57, v57, v4
  v_mul_f32 v58, v58, v4
  v_mul_f32 v59, v59, v4
  v_mul_f32 v60, v60, v4
  v_mul_f32 v61, v61, v4
  v_mul_f32 v62, v62, v4
  v_mul_f32 v63, v63, v4
  v_mul_f32 v64, v64, v4
  v_mul_f32 v65, v65, v4
  v_mul_f32 v66, v66, v4
  v_mul_f32 v67, v67, v4
  v_mul_f32 v68, v68, v4
  v_mul_f32 v69, v69, v4
  v_mul_f32 v70, v70, v4
  v_mul_f32 v71, v71, v4
  v_cvt_pk_bf16_f32 v120, v56, v57
  v_cvt_pk_bf16_f32 v121, v58, v59
  v_cvt_pk_bf16_f32 v122, v60, v61
  v_cvt_pk_bf16_f32 v123, v62, v63
  v_cvt_pk_bf16_f32 v124, v64, v65
  v_cvt_pk_bf16_f32 v125, v66, v67
  v_cvt_pk_bf16_f32 v126, v68, v69
  v_cvt_pk_bf16_f32 v127, v70, v71
  buffer_store_dwordx4 v[120:123], v137, s[4:7], s24 offen sc1
  buffer_store_dwordx4 v[124:127], v137, s[4:7], s24 offen offset:512 sc1
  v_rcp_f32 v4, v3
  s_nop 0
  v_mul_f32 v72, v72, v4
  v_mul_f32 v73, v73, v4
  v_mul_f32 v74, v74, v4
  v_mul_f32 v75, v75, v4
  v_mul_f32 v76, v76, v4
  v_mul_f32 v77, v77, v4
  v_mul_f32 v78, v78, v4
  v_mul_f32 v79, v79, v4
  v_mul_f32 v80, v80, v4
  v_mul_f32 v81, v81, v4
  v_mul_f32 v82, v82, v4
  v_mul_f32 v83, v83, v4
  v_mul_f32 v84, v84, v4
  v_mul_f32 v85, v85, v4
  v_mul_f32 v86, v86, v4
  v_mul_f32 v87, v87, v4
  v_cvt_pk_bf16_f32 v128, v72, v73
  v_cvt_pk_bf16_f32 v129, v74, v75
  v_cvt_pk_bf16_f32 v130, v76, v77
  v_cvt_pk_bf16_f32 v131, v78, v79
  v_cvt_pk_bf16_f32 v132, v80, v81
  v_cvt_pk_bf16_f32 v133, v82, v83
  v_cvt_pk_bf16_f32 v134, v84, v85
  v_cvt_pk_bf16_f32 v135, v86, v87
  s_add_u32 s24, s24, 65536
  buffer_store_dwordx4 v[128:131], v137, s[4:7], s24 offen sc1
  buffer_store_dwordx4 v[132:135], v137, s[4:7], s24 offen offset:512 sc1
attnb_exit1:
  s_endpgm
.globl outb1_kernel
.p2align 8
.type outb1_kernel,@function
outb1_kernel:
  s_cmp_ge_u32 s2, 256
  s_cbranch_scc1 outb1_exit1
  s_load_dwordx2 s[12:13], s[0:1], 96
  s_load_dwordx2 s[14:15], s[0:1], 0
  s_load_dwordx2 s[48:49], s[0:1], 80
  v_lshrrev_b32 v3, 6, v0
  v_and_b32 v4, 63, v0
  s_nop 0
  v_readfirstlane_b32 s16, v3
  v_lshlrev_b32 v1, 4, v4
  s_and_b32 s17, s2, 7
  s_lshl_b32 s17, s17, 2
  s_lshr_b32 s18, s2, 3
  s_and_b32 s19, s18, 3
  s_add_u32 s17, s17, s19
  s_lshr_b32 s18, s18, 2
  s_waitcnt lgkmcnt(0)
  s_mov_b32 s4, s12
  s_mov_b32 s5, s13
  s_mov_b32 s6, 0x10000000
  s_mov_b32 s7, 0x20000
  s_mov_b32 s8, s12
  s_mov_b32 s9, s13
  s_mov_b32 s10, 0x10000000
  s_mov_b32 s11, 0x20000
  s_mov_b32 s20, 84934656
  s_mov_b32 s52, s48
  s_mov_b32 s53, s49
  s_mov_b32 s54, 2621440
  s_mov_b32 s55, 0x20000
  s_mul_i32 s21, s18, 5
  s_mul_i32 s21, s21, 32768
  s_add_u32 s24, s21, 94109696
  s_add_u32 s25, s24, 32768
  s_add_u32 s26, s25, 32768
  s_add_u32 s27, s26, 32768
  s_add_u32 s28, s27, 32768
  s_lshl_b32 s21, s17, 2
  s_add_u32 s21, s21, s16
  s_mul_i32 s22, s21, 32768
  s_add_u32 s22, s22, 50331648
  s_lshl_b32 s23, s16, 10
  v_add_u32 v2, s23, v1
  s_mul_i32 s29, s16, 5120
  s_add_u32 m0, s29, 0
  s_nop 0
  buffer_load_dwordx4 v2, s[4:7], s24 offen lds
  s_add_u32 m0, s29, 1024
  s_nop 0
  buffer_load_dwordx4 v2, s[4:7], s25 offen lds
  s_add_u32 m0, s29, 2048
  s_nop 0
  buffer_load_dwordx4 v2, s[4:7], s26 offen lds
  s_add_u32 m0, s29, 3072
  s_nop 0
  buffer_load_dwordx4 v2, s[4:7], s27 offen lds
  s_add_u32 m0, s29, 4096
  s_nop 0
  buffer_load_dwordx4 v2, s[4:7], s28 offen lds
  buffer_load_dwordx4 v[32:35], v1, s[4:7], s22 offen offset:0
  buffer_load_dwordx4 v[36:39], v1, s[4:7], s22 offen offset:1024
  buffer_load_dwordx4 v[40:43], v1, s[4:7], s22 offen offset:2048
  buffer_load_dwordx4 v[44:47], v1, s[4:7], s22 offen offset:3072
  v_add_u32 v2, 0x1000, v2
  s_add_u32 s22, s22, 4096
  s_add_u32 m0, s29, 20480
  s_nop 0
  buffer_load_dwordx4 v2, s[4:7], s24 offen lds
  s_add_u32 m0, s29, 21504
  s_nop 0
  buffer_load_dwordx4 v2, s[4:7], s25 offen lds
  s_add_u32 m0, s29, 22528
  s_nop 0
  buffer_load_dwordx4 v2, s[4:7], s26 offen lds
  s_add_u32 m0, s29, 23552
  s_nop 0
  buffer_load_dwordx4 v2, s[4:7], s27 offen lds
  s_add_u32 m0, s29, 24576
  s_nop 0
  buffer_load_dwordx4 v2, s[4:7], s28 offen lds
  buffer_load_dwordx4 v[48:51], v1, s[4:7], s22 offen offset:0
  buffer_load_dwordx4 v[52:55], v1, s[4:7], s22 offen offset:1024
  buffer_load_dwordx4 v[56:59], v1, s[4:7], s22 offen offset:2048
  buffer_load_dwordx4 v[60:63], v1, s[4:7], s22 offen offset:3072
  v_add_u32 v2, 0x1000, v2
  s_add_u32 s22, s22, 4096
  s_waitcnt vmcnt(9)
  s_barrier
  s_add_u32 m0, s29, 40960
  s_nop 0
  buffer_load_dwordx4 v2, s[4:7], s24 offen lds
  s_add_u32 m0, s29, 41984
  s_nop 0
  buffer_load_dwordx4 v2, s[4:7], s25 offen lds
  s_add_u32 m0, s29, 43008
  s_nop 0
  buffer_load_dwordx4 v2, s[4:7], s26 offen lds
  s_add_u32 m0, s29, 44032
  s_nop 0
  buffer_load_dwordx4 v2, s[4:7], s27 offen lds
  s_add_u32 m0, s29, 45056
  s_nop 0
  buffer_load_dwordx4 v2, s[4:7], s28 offen lds
  buffer_load_dwordx4 v[64:67], v1, s[4:7], s22 offen offset:0
  buffer_load_dwordx4 v[68:71], v1, s[4:7], s22 offen offset:1024
  buffer_load_dwordx4 v[72:75], v1, s[4:7], s22 offen offset:2048
  buffer_load_dwordx4 v[76:79], v1, s[4:7], s22 offen offset:3072
  v_add_u32 v2, 0x1000, v2
  s_add_u32 s22, s22, 4096
  ds_read_b128 v[80:83], v1 offset:0
  ds_read_b128 v[84:87], v1 offset:1024
  ds_read_b128 v[88:91], v1 offset:2048
  ds_read_b128 v[92:95], v1 offset:3072
  ds_read_b128 v[96:99], v1 offset:4096
  ds_read_b128 v[100:103], v1 offset:5120
  ds_read_b128 v[104:107], v1 offset:6144
  ds_read_b128 v[108:111], v1 offset:7168
  ds_read_b128 v[112:115], v1 offset:8192
  ds_read_b128 v[116:119], v1 offset:9216
  s_waitcnt lgkmcnt(5)
  v_mfma_f32_16x16x32_bf16 v[8:11], v[80:83], v[32:35], 0
  v_mfma_f32_16x16x32_bf16 v[12:15], v[84:87], v[32:35], 0
  v_mfma_f32_16x16x32_bf16 v[16:19], v[88:91], v[32:35], 0
  v_mfma_f32_16x16x32_bf16 v[20:23], v[92:95], v[32:35], 0
  v_mfma_f32_16x16x32_bf16 v[24:27], v[96:99], v[32:35], 0
  ds_read_b128 v[80:83], v1 offset:10240
  ds_read_b128 v[84:87], v1 offset:11264
  ds_read_b128 v[88:91], v1 offset:12288
  ds_read_b128 v[92:95], v1 offset:13312
  ds_read_b128 v[96:99], v1 offset:14336
  s_waitcnt lgkmcnt(5)
  v_mfma_f32_16x16x32_bf16 v[8:11], v[100:103], v[36:39], v[8:11]
  v_mfma_f32_16x16x32_bf16 v[12:15], v[104:107], v[36:39], v[12:15]
  v_mfma_f32_16x16x32_bf16 v[16:19], v[108:111], v[36:39], v[16:19]
  v_mfma_f32_16x16x32_bf16 v[20:23], v[112:115], v[36:39], v[20:23]
  v_mfma_f32_16x16x32_bf16 v[24:27], v[116:119], v[36:39], v[24:27]
  ds_read_b128 v[100:103], v1 offset:15360
  ds_read_b128 v[104:107], v1 offset:16384
  ds_read_b128 v[108:111], v1 offset:17408
  ds_read_b128 v[112:115], v1 offset:18432
  ds_read_b128 v[116:119], v1 offset:19456
  s_waitcnt lgkmcnt(5)
  v_mfma_f32_16x16x32_bf16 v[8:11], v[80:83], v[40:43], v[8:11]
  v_mfma_f32_16x16x32_bf16 v[12:15], v[84:87], v[40:43], v[12:15]
  v_mfma_f32_16x16x32_bf16 v[16:19], v[88:91], v[40:43], v[16:19]
  v_mfma_f32_16x16x32_bf16 v[20:23], v[92:95], v[40:43], v[20:23]
  v_mfma_f32_16x16x32_bf16 v[24:27], v[96:99], v[40:43], v[24:27]
  s_waitcnt lgkmcnt(0)
  v_mfma_f32_16x16x32_bf16 v[8:11], v[100:103], v[44:47], v[8:11]
  v_mfma_f32_16x16x32_bf16 v[12:15], v[104:107], v[44:47], v[12:15]
  v_mfma_f32_16x16x32_bf16 v[16:19], v[108:111], v[44:47], v[16:19]
  v_mfma_f32_16x16x32_bf16 v[20:23], v[112:115], v[44:47], v[20:23]
  v_mfma_f32_16x16x32_bf16 v[24:27], v[116:119], v[44:47], v[24:27]
  s_mov_b32 s30, 0
outb1_loop2:
  s_waitcnt vmcnt(9)
  s_barrier
  s_add_u32 m0, s29, 0
  s_nop 0
  buffer_load_dwordx4 v2, s[4:7], s24 offen lds
  s_add_u32 m0, s29, 1024
  s_nop 0
  buffer_load_dwordx4 v2, s[4:7], s25 offen lds
  s_add_u32 m0, s29, 2048
  s_nop 0
  buffer_load_dwordx4 v2, s[4:7], s26 offen lds
  s_add_u32 m0, s29, 3072
  s_nop 0
  buffer_load_dwordx4 v2, s[4:7], s27 offen lds
  s_add_u32 m0, s29, 4096
  s_nop 0
  buffer_load_dwordx4 v2, s[4:7], s28 offen lds
  buffer_load_dwordx4 v[32:35], v1, s[4:7], s22 offen offset:0
  buffer_load_dwordx4 v[36:39], v1, s[4:7], s22 offen offset:1024
  buffer_load_dwordx4 v[40:43], v1, s[4:7], s22 offen offset:2048
  buffer_load_dwordx4 v[44:47], v1, s[4:7], s22 offen offset:3072
  v_add_u32 v2, 0x1000, v2
  s_add_u32 s22, s22, 4096
  ds_read_b128 v[80:83], v1 offset:20480
  ds_read_b128 v[84:87], v1 offset:21504
  ds_read_b128 v[88:91], v1 offset:22528
  ds_read_b128 v[92:95], v1 offset:23552
  ds_read_b128 v[96:99], v1 offset:24576
  ds_read_b128 v[100:103], v1 offset:25600
  ds_read_b128 v[104:107], v1 offset:26624
  ds_read_b128 v[108:111], v1 offset:27648
  ds_read_b128 v[112:115], v1 offset:28672
  ds_read_b128 v[116:119], v1 offset:29696
  s_waitcnt lgkmcnt(5)
  v_mfma_f32_16x16x32_bf16 v[8:11], v[80:83], v[48:51], v[8:11]
  v_mfma_f32_16x16x32_bf16 v[12:15], v[84:87], v[48:51], v[12:15]
  v_mfma_f32_16x16x32_bf16 v[16:19], v[88:91], v[48:51], v[16:19]
  v_mfma_f32_16x16x32_bf16 v[20:23], v[92:95], v[48:51], v[20:23]
  v_mfma_f32_16x16x32_bf16 v[24:27], v[96:99], v[48:51], v[24:27]
  ds_read_b128 v[80:83], v1 offset:30720
  ds_read_b128 v[84:87], v1 offset:31744
  ds_read_b128 v[88:91], v1 offset:32768
  ds_read_b128 v[92:95], v1 offset:33792
  ds_read_b128 v[96:99], v1 offset:34816
  s_waitcnt lgkmcnt(5)
  v_mfma_f32_16x16x32_bf16 v[8:11], v[100:103], v[52:55], v[8:11]
  v_mfma_f32_16x16x32_bf16 v[12:15], v[104:107], v[52:55], v[12:15]
  v_mfma_f32_16x16x32_bf16 v[16:19], v[108:111], v[52:55], v[16:19]
  v_mfma_f32_16x16x32_bf16 v[20:23], v[112:115], v[52:55], v[20:23]
  v_mfma_f32_16x16x32_bf16 v[24:27], v[116:119], v[52:55], v[24:27]
  ds_read_b128 v[100:103], v1 offset:35840
  ds_read_b128 v[104:107], v1 offset:36864
  ds_read_b128 v[108:111], v1 offset:37888
  ds_read_b128 v[112:115], v1 offset:38912
  ds_read_b128 v[116:119], v1 offset:39936
  s_waitcnt lgkmcnt(5)
  v_mfma_f32_16x16x32_bf16 v[8:11], v[80:83], v[56:59], v[8:11]
  v_mfma_f32_16x16x32_bf16 v[12:15], v[84:87], v[56:59], v[12:15]
  v_mfma_f32_16x16x32_bf16 v[16:19], v[88:91], v[56:59], v[16:19]
  v_mfma_f32_16x16x32_bf16 v[20:23], v[92:95], v[56:59], v[20:23]
  v_mfma_f32_16x16x32_bf16 v[24:27], v[96:99], v[56:59], v[24:27]
  s_waitcnt lgkmcnt(0)
  v_mfma_f32_16x16x32_bf16 v[8:11], v[100:103], v[60:63], v[8:11]
  v_mfma_f32_16x16x32_bf16 v[12:15], v[104:107], v[60:63], v[12:15]
  v_mfma_f32_16x16x32_bf16 v[16:19], v[108:111], v[60:63], v[16:19]
  v_mfma_f32_16x16x32_bf16 v[20:23], v[112:115], v[60:63], v[20:23]
  v_mfma_f32_16x16x32_bf16 v[24:27], v[116:119], v[60:63], v[24:27]
  s_waitcnt vmcnt(9)
  s_barrier
  s_add_u32 m0, s29, 20480
  s_nop 0
  buffer_load_dwordx4 v2, s[4:7], s24 offen lds
  s_add_u32 m0, s29, 21504
  s_nop 0
  buffer_load_dwordx4 v2, s[4:7], s25 offen lds
  s_add_u32 m0, s29, 22528
  s_nop 0
  buffer_load_dwordx4 v2, s[4:7], s26 offen lds
  s_add_u32 m0, s29, 23552
  s_nop 0
  buffer_load_dwordx4 v2, s[4:7], s27 offen lds
  s_add_u32 m0, s29, 24576
  s_nop 0
  buffer_load_dwordx4 v2, s[4:7], s28 offen lds
  buffer_load_dwordx4 v[48:51], v1, s[4:7], s22 offen offset:0
  buffer_load_dwordx4 v[52:55], v1, s[4:7], s22 offen offset:1024
  buffer_load_dwordx4 v[56:59], v1, s[4:7], s22 offen offset:2048
  buffer_load_dwordx4 v[60:63], v1, s[4:7], s22 offen offset:3072
  v_add_u32 v2, 0x1000, v2
  s_add_u32 s22, s22, 4096
  ds_read_b128 v[80:83], v1 offset:40960
  ds_read_b128 v[84:87], v1 offset:41984
  ds_read_b128 v[88:91], v1 offset:43008
  ds_read_b128 v[92:95], v1 offset:44032
  ds_read_b128 v[96:99], v1 offset:45056
  ds_read_b128 v[100:103], v1 offset:46080
  ds_read_b128 v[104:107], v1 offset:47104
  ds_read_b128 v[108:111], v1 offset:48128
  ds_read_b128 v[112:115], v1 offset:49152
  ds_read_b128 v[116:119], v1 offset:50176
  s_waitcnt lgkmcnt(5)
  v_mfma_f32_16x16x32_bf16 v[8:11], v[80:83], v[64:67], v[8:11]
  v_mfma_f32_16x16x32_bf16 v[12:15], v[84:87], v[64:67], v[12:15]
  v_mfma_f32_16x16x32_bf16 v[16:19], v[88:91], v[64:67], v[16:19]
  v_mfma_f32_16x16x32_bf16 v[20:23], v[92:95], v[64:67], v[20:23]
  v_mfma_f32_16x16x32_bf16 v[24:27], v[96:99], v[64:67], v[24:27]
  ds_read_b128 v[80:83], v1 offset:51200
  ds_read_b128 v[84:87], v1 offset:52224
  ds_read_b128 v[88:91], v1 offset:53248
  ds_read_b128 v[92:95], v1 offset:54272
  ds_read_b128 v[96:99], v1 offset:55296
  s_waitcnt lgkmcnt(5)
  v_mfma_f32_16x16x32_bf16 v[8:11], v[100:103], v[68:71], v[8:11]
  v_mfma_f32_16x16x32_bf16 v[12:15], v[104:107], v[68:71], v[12:15]
  v_mfma_f32_16x16x32_bf16 v[16:19], v[108:111], v[68:71], v[16:19]
  v_mfma_f32_16x16x32_bf16 v[20:23], v[112:115], v[68:71], v[20:23]
  v_mfma_f32_16x16x32_bf16 v[24:27], v[116:119], v[68:71], v[24:27]
  ds_read_b128 v[100:103], v1 offset:56320
  ds_read_b128 v[104:107], v1 offset:57344
  ds_read_b128 v[108:111], v1 offset:58368
  ds_read_b128 v[112:115], v1 offset:59392
  ds_read_b128 v[116:119], v1 offset:60416
  s_waitcnt lgkmcnt(5)
  v_mfma_f32_16x16x32_bf16 v[8:11], v[80:83], v[72:75], v[8:11]
  v_mfma_f32_16x16x32_bf16 v[12:15], v[84:87], v[72:75], v[12:15]
  v_mfma_f32_16x16x32_bf16 v[16:19], v[88:91], v[72:75], v[16:19]
  v_mfma_f32_16x16x32_bf16 v[20:23], v[92:95], v[72:75], v[20:23]
  v_mfma_f32_16x16x32_bf16 v[24:27], v[96:99], v[72:75], v[24:27]
  s_waitcnt lgkmcnt(0)
  v_mfma_f32_16x16x32_bf16 v[8:11], v[100:103], v[76:79], v[8:11]
  v_mfma_f32_16x16x32_bf16 v[12:15], v[104:107], v[76:79], v[12:15]
  v_mfma_f32_16x16x32_bf16 v[16:19], v[108:111], v[76:79], v[16:19]
  v_mfma_f32_16x16x32_bf16 v[20:23], v[112:115], v[76:79], v[20:23]
  v_mfma_f32_16x16x32_bf16 v[24:27], v[116:119], v[76:79], v[24:27]
  s_waitcnt vmcnt(9)
  s_barrier
  s_add_u32 m0, s29, 40960
  s_nop 0
  buffer_load_dwordx4 v2, s[4:7], s24 offen lds
  s_add_u32 m0, s29, 41984
  s_nop 0
  buffer_load_dwordx4 v2, s[4:7], s25 offen lds
  s_add_u32 m0, s29, 43008
  s_nop 0
  buffer_load_dwordx4 v2, s[4:7], s26 offen lds
  s_add_u32 m0, s29, 44032
  s_nop 0
  buffer_load_dwordx4 v2, s[4:7], s27 offen lds
  s_add_u32 m0, s29, 45056
  s_nop 0
  buffer_load_dwordx4 v2, s[4:7], s28 offen lds
  buffer_load_dwordx4 v[64:67], v1, s[4:7], s22 offen offset:0
  buffer_load_dwordx4 v[68:71], v1, s[4:7], s22 offen offset:1024
  buffer_load_dwordx4 v[72:75], v1, s[4:7], s22 offen offset:2048
  buffer_load_dwordx4 v[76:79], v1, s[4:7], s22 offen offset:3072
  v_add_u32 v2, 0x1000, v2
  s_add_u32 s22, s22, 4096
  ds_read_b128 v[80:83], v1 offset:0
  ds_read_b128 v[84:87], v1 offset:1024
  ds_read_b128 v[88:91], v1 offset:2048
  ds_read_b128 v[92:95], v1 offset:3072
  ds_read_b128 v[96:99], v1 offset:4096
  ds_read_b128 v[100:103], v1 offset:5120
  ds_read_b128 v[104:107], v1 offset:6144
  ds_read_b128 v[108:111], v1 offset:7168
  ds_read_b128 v[112:115], v1 offset:8192
  ds_read_b128 v[116:119], v1 offset:9216
  s_waitcnt lgkmcnt(5)
  v_mfma_f32_16x16x32_bf16 v[8:11], v[80:83], v[32:35], v[8:11]
  v_mfma_f32_16x16x32_bf16 v[12:15], v[84:87], v[32:35], v[12:15]
  v_mfma_f32_16x16x32_bf16 v[16:19], v[88:91], v[32:35], v[16:19]
  v_mfma_f32_16x16x32_bf16 v[20:23], v[92:95], v[32:35], v[20:23]
  v_mfma_f32_16x16x32_bf16 v[24:27], v[96:99], v[32:35], v[24:27]
  ds_read_b128 v[80:83], v1 offset:10240
  ds_read_b128 v[84:87], v1 offset:11264
  ds_read_b128 v[88:91], v1 offset:12288
  ds_read_b128 v[92:95], v1 offset:13312
  ds_read_b128 v[96:99], v1 offset:14336
  s_waitcnt lgkmcnt(5)
  v_mfma_f32_16x16x32_bf16 v[8:11], v[100:103], v[36:39], v[8:11]
  v_mfma_f32_16x16x32_bf16 v[12:15], v[104:107], v[36:39], v[12:15]
  v_mfma_f32_16x16x32_bf16 v[16:19], v[108:111], v[36:39], v[16:19]
  v_mfma_f32_16x16x32_bf16 v[20:23], v[112:115], v[36:39], v[20:23]
  v_mfma_f32_16x16x32_bf16 v[24:27], v[116:119], v[36:39], v[24:27]
  ds_read_b128 v[100:103], v1 offset:15360
  ds_read_b128 v[104:107], v1 offset:16384
  ds_read_b128 v[108:111], v1 offset:17408
  ds_read_b128 v[112:115], v1 offset:18432
  ds_read_b128 v[116:119], v1 offset:19456
  s_waitcnt lgkmcnt(5)
  v_mfma_f32_16x16x32_bf16 v[8:11], v[80:83], v[40:43], v[8:11]
  v_mfma_f32_16x16x32_bf16 v[12:15], v[84:87], v[40:43], v[12:15]
  v_mfma_f32_16x16x32_bf16 v[16:19], v[88:91], v[40:43], v[16:19]
  v_mfma_f32_16x16x32_bf16 v[20:23], v[92:95], v[40:43], v[20:23]
  v_mfma_f32_16x16x32_bf16 v[24:27], v[96:99], v[40:43], v[24:27]
  s_waitcnt lgkmcnt(0)
  v_mfma_f32_16x16x32_bf16 v[8:11], v[100:103], v[44:47], v[8:11]
  v_mfma_f32_16x16x32_bf16 v[12:15], v[104:107], v[44:47], v[12:15]
  v_mfma_f32_16x16x32_bf16 v[16:19], v[108:111], v[44:47], v[16:19]
  v_mfma_f32_16x16x32_bf16 v[20:23], v[112:115], v[44:47], v[20:23]
  v_mfma_f32_16x16x32_bf16 v[24:27], v[116:119], v[44:47], v[24:27]
  s_add_u32 s30, s30, 1
  s_cmp_lt_u32 s30, 1
  s_cbranch_scc1 outb1_loop2
  s_waitcnt vmcnt(9)
  s_barrier
  s_add_u32 m0, s29, 0
  s_nop 0
  buffer_load_dwordx4 v2, s[4:7], s24 offen lds
  s_add_u32 m0, s29, 1024
  s_nop 0
  buffer_load_dwordx4 v2, s[4:7], s25 offen lds
  s_add_u32 m0, s29, 2048
  s_nop 0
  buffer_load_dwordx4 v2, s[4:7], s26 offen lds
  s_add_u32 m0, s29, 3072
  s_nop 0
  buffer_load_dwordx4 v2, s[4:7], s27 offen lds
  s_add_u32 m0, s29, 4096
  s_nop 0
  buffer_load_dwordx4 v2, s[4:7], s28 offen lds
  buffer_load_dwordx4 v[32:35], v1, s[4:7], s22 offen offset:0
  buffer_load_dwordx4 v[36:39], v1, s[4:7], s22 offen offset:1024
  buffer_load_dwordx4 v[40:43], v1, s[4:7], s22 offen offset:2048
  buffer_load_dwordx4 v[44:47], v1, s[4:7], s22 offen offset:3072
  v_add_u32 v2, 0x1000, v2
  s_add_u32 s22, s22, 4096
  ds_read_b128 v[80:83], v1 offset:20480
  ds_read_b128 v[84:87], v1 offset:21504
  ds_read_b128 v[88:91], v1 offset:22528
  ds_read_b128 v[92:95], v1 offset:23552
  ds_read_b128 v[96:99], v1 offset:24576
  ds_read_b128 v[100:103], v1 offset:25600
  ds_read_b128 v[104:107], v1 offset:26624
  ds_read_b128 v[108:111], v1 offset:27648
  ds_read_b128 v[112:115], v1 offset:28672
  ds_read_b128 v[116:119], v1 offset:29696
  s_waitcnt lgkmcnt(5)
  v_mfma_f32_16x16x32_bf16 v[8:11], v[80:83], v[48:51], v[8:11]
  v_mfma_f32_16x16x32_bf16 v[12:15], v[84:87], v[48:51], v[12:15]
  v_mfma_f32_16x16x32_bf16 v[16:19], v[88:91], v[48:51], v[16:19]
  v_mfma_f32_16x16x32_bf16 v[20:23], v[92:95], v[48:51], v[20:23]
  v_mfma_f32_16x16x32_bf16 v[24:27], v[96:99], v[48:51], v[24:27]
  ds_read_b128 v[80:83], v1 offset:30720
  ds_read_b128 v[84:87], v1 offset:31744
  ds_read_b128 v[88:91], v1 offset:32768
  ds_read_b128 v[92:95], v1 offset:33792
  ds_read_b128 v[96:99], v1 offset:34816
  s_waitcnt lgkmcnt(5)
  v_mfma_f32_16x16x32_bf16 v[8:11], v[100:103], v[52:55], v[8:11]
  v_mfma_f32_16x16x32_bf16 v[12:15], v[104:107], v[52:55], v[12:15]
  v_mfma_f32_16x16x32_bf16 v[16:19], v[108:111], v[52:55], v[16:19]
  v_mfma_f32_16x16x32_bf16 v[20:23], v[112:115], v[52:55], v[20:23]
  v_mfma_f32_16x16x32_bf16 v[24:27], v[116:119], v[52:55], v[24:27]
  ds_read_b128 v[100:103], v1 offset:35840
  ds_read_b128 v[104:107], v1 offset:36864
  ds_read_b128 v[108:111], v1 offset:37888
  ds_read_b128 v[112:115], v1 offset:38912
  ds_read_b128 v[116:119], v1 offset:39936
  s_waitcnt lgkmcnt(5)
  v_mfma_f32_16x16x32_bf16 v[8:11], v[80:83], v[56:59], v[8:11]
  v_mfma_f32_16x16x32_bf16 v[12:15], v[84:87], v[56:59], v[12:15]
  v_mfma_f32_16x16x32_bf16 v[16:19], v[88:91], v[56:59], v[16:19]
  v_mfma_f32_16x16x32_bf16 v[20:23], v[92:95], v[56:59], v[20:23]
  v_mfma_f32_16x16x32_bf16 v[24:27], v[96:99], v[56:59], v[24:27]
  s_waitcnt lgkmcnt(0)
  v_mfma_f32_16x16x32_bf16 v[8:11], v[100:103], v[60:63], v[8:11]
  v_mfma_f32_16x16x32_bf16 v[12:15], v[104:107], v[60:63], v[12:15]
  v_mfma_f32_16x16x32_bf16 v[16:19], v[108:111], v[60:63], v[16:19]
  v_mfma_f32_16x16x32_bf16 v[20:23], v[112:115], v[60:63], v[20:23]
  v_mfma_f32_16x16x32_bf16 v[24:27], v[116:119], v[60:63], v[24:27]
  s_waitcnt vmcnt(9)
  s_barrier
  s_add_u32 m0, s29, 20480
  s_nop 0
  buffer_load_dwordx4 v2, s[4:7], s24 offen lds
  s_add_u32 m0, s29, 21504
  s_nop 0
  buffer_load_dwordx4 v2, s[4:7], s25 offen lds
  s_add_u32 m0, s29, 22528
  s_nop 0
  buffer_load_dwordx4 v2, s[4:7], s26 offen lds
  s_add_u32 m0, s29, 23552
  s_nop 0
  buffer_load_dwordx4 v2, s[4:7], s27 offen lds
  s_add_u32 m0, s29, 24576
  s_nop 0
  buffer_load_dwordx4 v2, s[4:7], s28 offen lds
  buffer_load_dwordx4 v[48:51], v1, s[4:7], s22 offen offset:0
  buffer_load_dwordx4 v[52:55], v1, s[4:7], s22 offen offset:1024
  buffer_load_dwordx4 v[56:59], v1, s[4:7], s22 offen offset:2048
  buffer_load_dwordx4 v[60:63], v1, s[4:7], s22 offen offset:3072
  v_add_u32 v2, 0x1000, v2
  s_add_u32 s22, s22, 4096
  ds_read_b128 v[80:83], v1 offset:40960
  ds_read_b128 v[84:87], v1 offset:41984
  ds_read_b128 v[88:91], v1 offset:43008
  ds_read_b128 v[92:95], v1 offset:44032
  ds_read_b128 v[96:99], v1 offset:45056
  ds_read_b128 v[100:103], v1 offset:46080
  ds_read_b128 v[104:107], v1 offset:47104
  ds_read_b128 v[108:111], v1 offset:48128
  ds_read_b128 v[112:115], v1 offset:49152
  ds_read_b128 v[116:119], v1 offset:50176
  s_waitcnt lgkmcnt(5)
  v_mfma_f32_16x16x32_bf16 v[8:11], v[80:83], v[64:67], v[8:11]
  v_mfma_f32_16x16x32_bf16 v[12:15], v[84:87], v[64:67], v[12:15]
  v_mfma_f32_16x16x32_bf16 v[16:19], v[88:91], v[64:67], v[16:19]
  v_mfma_f32_16x16x32_bf16 v[20:23], v[92:95], v[64:67], v[20:23]
  v_mfma_f32_16x16x32_bf16 v[24:27], v[96:99], v[64:67], v[24:27]
  ds_read_b128 v[80:83], v1 offset:51200
  ds_read_b128 v[84:87], v1 offset:52224
  ds_read_b128 v[88:91], v1 offset:53248
  ds_read_b128 v[92:95], v1 offset:54272
  ds_read_b128 v[96:99], v1 offset:55296
  s_waitcnt lgkmcnt(5)
  v_mfma_f32_16x16x32_bf16 v[8:11], v[100:103], v[68:71], v[8:11]
  v_mfma_f32_16x16x32_bf16 v[12:15], v[104:107], v[68:71], v[12:15]
  v_mfma_f32_16x16x32_bf16 v[16:19], v[108:111], v[68:71], v[16:19]
  v_mfma_f32_16x16x32_bf16 v[20:23], v[112:115], v[68:71], v[20:23]
  v_mfma_f32_16x16x32_bf16 v[24:27], v[116:119], v[68:71], v[24:27]
  ds_read_b128 v[100:103], v1 offset:56320
  ds_read_b128 v[104:107], v1 offset:57344
  ds_read_b128 v[108:111], v1 offset:58368
  ds_read_b128 v[112:115], v1 offset:59392
  ds_read_b128 v[116:119], v1 offset:60416
  s_waitcnt lgkmcnt(5)
  v_mfma_f32_16x16x32_bf16 v[8:11], v[80:83], v[72:75], v[8:11]
  v_mfma_f32_16x16x32_bf16 v[12:15], v[84:87], v[72:75], v[12:15]
  v_mfma_f32_16x16x32_bf16 v[16:19], v[88:91], v[72:75], v[16:19]
  v_mfma_f32_16x16x32_bf16 v[20:23], v[92:95], v[72:75], v[20:23]
  v_mfma_f32_16x16x32_bf16 v[24:27], v[96:99], v[72:75], v[24:27]
  s_waitcnt lgkmcnt(0)
  v_mfma_f32_16x16x32_bf16 v[8:11], v[100:103], v[76:79], v[8:11]
  v_mfma_f32_16x16x32_bf16 v[12:15], v[104:107], v[76:79], v[12:15]
  v_mfma_f32_16x16x32_bf16 v[16:19], v[108:111], v[76:79], v[16:19]
  v_mfma_f32_16x16x32_bf16 v[20:23], v[112:115], v[76:79], v[20:23]
  v_mfma_f32_16x16x32_bf16 v[24:27], v[116:119], v[76:79], v[24:27]
  s_waitcnt vmcnt(9)
  s_barrier
  ds_read_b128 v[80:83], v1 offset:0
  ds_read_b128 v[84:87], v1 offset:1024
  ds_read_b128 v[88:91], v1 offset:2048
  ds_read_b128 v[92:95], v1 offset:3072
  ds_read_b128 v[96:99], v1 offset:4096
  ds_read_b128 v[100:103], v1 offset:5120
  ds_read_b128 v[104:107], v1 offset:6144
  ds_read_b128 v[108:111], v1 offset:7168
  ds_read_b128 v[112:115], v1 offset:8192
  ds_read_b128 v[116:119], v1 offset:9216
  s_waitcnt lgkmcnt(5)
  v_mfma_f32_16x16x32_bf16 v[8:11], v[80:83], v[32:35], v[8:11]
  v_mfma_f32_16x16x32_bf16 v[12:15], v[84:87], v[32:35], v[12:15]
  v_mfma_f32_16x16x32_bf16 v[16:19], v[88:91], v[32:35], v[16:19]
  v_mfma_f32_16x16x32_bf16 v[20:23], v[92:95], v[32:35], v[20:23]
  v_mfma_f32_16x16x32_bf16 v[24:27], v[96:99], v[32:35], v[24:27]
  ds_read_b128 v[80:83], v1 offset:10240
  ds_read_b128 v[84:87], v1 offset:11264
  ds_read_b128 v[88:91], v1 offset:12288
  ds_read_b128 v[92:95], v1 offset:13312
  ds_read_b128 v[96:99], v1 offset:14336
  s_waitcnt lgkmcnt(5)
  v_mfma_f32_16x16x32_bf16 v[8:11], v[100:103], v[36:39], v[8:11]
  v_mfma_f32_16x16x32_bf16 v[12:15], v[104:107], v[36:39], v[12:15]
  v_mfma_f32_16x16x32_bf16 v[16:19], v[108:111], v[36:39], v[16:19]
  v_mfma_f32_16x16x32_bf16 v[20:23], v[112:115], v[36:39], v[20:23]
  v_mfma_f32_16x16x32_bf16 v[24:27], v[116:119], v[36:39], v[24:27]
  ds_read_b128 v[100:103], v1 offset:15360
  ds_read_b128 v[104:107], v1 offset:16384
  ds_read_b128 v[108:111], v1 offset:17408
  ds_read_b128 v[112:115], v1 offset:18432
  ds_read_b128 v[116:119], v1 offset:19456
  s_waitcnt lgkmcnt(5)
  v_mfma_f32_16x16x32_bf16 v[8:11], v[80:83], v[40:43], v[8:11]
  v_mfma_f32_16x16x32_bf16 v[12:15], v[84:87], v[40:43], v[12:15]
  v_mfma_f32_16x16x32_bf16 v[16:19], v[88:91], v[40:43], v[16:19]
  v_mfma_f32_16x16x32_bf16 v[20:23], v[92:95], v[40:43], v[20:23]
  v_mfma_f32_16x16x32_bf16 v[24:27], v[96:99], v[40:43], v[24:27]
  s_waitcnt lgkmcnt(0)
  v_mfma_f32_16x16x32_bf16 v[8:11], v[100:103], v[44:47], v[8:11]
  v_mfma_f32_16x16x32_bf16 v[12:15], v[104:107], v[44:47], v[12:15]
  v_mfma_f32_16x16x32_bf16 v[16:19], v[108:111], v[44:47], v[16:19]
  v_mfma_f32_16x16x32_bf16 v[20:23], v[112:115], v[44:47], v[20:23]
  v_mfma_f32_16x16x32_bf16 v[24:27], v[116:119], v[44:47], v[24:27]
  s_waitcnt vmcnt(0)
  s_barrier
  ds_read_b128 v[80:83], v1 offset:20480
  ds_read_b128 v[84:87], v1 offset:21504
  ds_read_b128 v[88:91], v1 offset:22528
  ds_read_b128 v[92:95], v1 offset:23552
  ds_read_b128 v[96:99], v1 offset:24576
  ds_read_b128 v[100:103], v1 offset:25600
  ds_read_b128 v[104:107], v1 offset:26624
  ds_read_b128 v[108:111], v1 offset:27648
  ds_read_b128 v[112:115], v1 offset:28672
  ds_read_b128 v[116:119], v1 offset:29696
  s_waitcnt lgkmcnt(5)
  v_mfma_f32_16x16x32_bf16 v[8:11], v[80:83], v[48:51], v[8:11]
  v_mfma_f32_16x16x32_bf16 v[12:15], v[84:87], v[48:51], v[12:15]
  v_mfma_f32_16x16x32_bf16 v[16:19], v[88:91], v[48:51], v[16:19]
  v_mfma_f32_16x16x32_bf16 v[20:23], v[92:95], v[48:51], v[20:23]
  v_mfma_f32_16x16x32_bf16 v[24:27], v[96:99], v[48:51], v[24:27]
  ds_read_b128 v[80:83], v1 offset:30720
  ds_read_b128 v[84:87], v1 offset:31744
  ds_read_b128 v[88:91], v1 offset:32768
  ds_read_b128 v[92:95], v1 offset:33792
  ds_read_b128 v[96:99], v1 offset:34816
  s_waitcnt lgkmcnt(5)
  v_mfma_f32_16x16x32_bf16 v[8:11], v[100:103], v[52:55], v[8:11]
  v_mfma_f32_16x16x32_bf16 v[12:15], v[104:107], v[52:55], v[12:15]
  v_mfma_f32_16x16x32_bf16 v[16:19], v[108:111], v[52:55], v[16:19]
  v_mfma_f32_16x16x32_bf16 v[20:23], v[112:115], v[52:55], v[20:23]
  v_mfma_f32_16x16x32_bf16 v[24:27], v[116:119], v[52:55], v[24:27]
  ds_read_b128 v[100:103], v1 offset:35840
  ds_read_b128 v[104:107], v1 offset:36864
  ds_read_b128 v[108:111], v1 offset:37888
  ds_read_b128 v[112:115], v1 offset:38912
  ds_read_b128 v[116:119], v1 offset:39936
  s_waitcnt lgkmcnt(5)
  v_mfma_f32_16x16x32_bf16 v[8:11], v[80:83], v[56:59], v[8:11]
  v_mfma_f32_16x16x32_bf16 v[12:15], v[84:87], v[56:59], v[12:15]
  v_mfma_f32_16x16x32_bf16 v[16:19], v[88:91], v[56:59], v[16:19]
  v_mfma_f32_16x16x32_bf16 v[20:23], v[92:95], v[56:59], v[20:23]
  v_mfma_f32_16x16x32_bf16 v[24:27], v[96:99], v[56:59], v[24:27]
  s_waitcnt lgkmcnt(0)
  v_mfma_f32_16x16x32_bf16 v[8:11], v[100:103], v[60:63], v[8:11]
  v_mfma_f32_16x16x32_bf16 v[12:15], v[104:107], v[60:63], v[12:15]
  v_mfma_f32_16x16x32_bf16 v[16:19], v[108:111], v[60:63], v[16:19]
  v_mfma_f32_16x16x32_bf16 v[20:23], v[112:115], v[60:63], v[20:23]
  v_mfma_f32_16x16x32_bf16 v[24:27], v[116:119], v[60:63], v[24:27]
  v_and_b32 v3, 63, v0
  v_and_b32 v4, 15, v3
  v_lshrrev_b32 v3, 4, v3
  s_lshl_b32 s21, s17, 6
  s_lshl_b32 s23, s16, 4
  s_add_u32 s21, s21, s23
  v_add_u32 v4, s21, v4
  v_mul_u32_u24 v6, 1280, v4
  v_lshl_add_u32 v6, v3, 4, v6
  s_mul_i32 s21, s18, 5
  s_add_u32 s23, s21, 0
  s_lshr_b32 s31, s23, 1
  s_lshl_b32 s31, s31, 6
  s_and_b32 s23, s23, 1
  s_lshl_b32 s23, s23, 3
  s_add_u32 s32, s31, s23
  s_add_u32 s40, s32, s20
  buffer_load_dwordx2 v[32:33], v6, s[8:11], s40 offen
  s_add_u32 s23, s21, 1
  s_lshr_b32 s31, s23, 1
  s_lshl_b32 s31, s31, 6
  s_and_b32 s23, s23, 1
  s_lshl_b32 s23, s23, 3
  s_add_u32 s33, s31, s23
  s_add_u32 s41, s33, s20
  buffer_load_dwordx2 v[34:35], v6, s[8:11], s41 offen
  s_add_u32 s23, s21, 2
  s_lshr_b32 s31, s23, 1
  s_lshl_b32 s31, s31, 6
  s_and_b32 s23, s23, 1
  s_lshl_b32 s23, s23, 3
  s_add_u32 s34, s31, s23
  s_add_u32 s42, s34, s20
  buffer_load_dwordx2 v[36:37], v6, s[8:11], s42 offen
  s_add_u32 s23, s21, 3
  s_lshr_b32 s31, s23, 1
  s_lshl_b32 s31, s31, 6
  s_and_b32 s23, s23, 1
  s_lshl_b32 s23, s23, 3
  s_add_u32 s35, s31, s23
  s_add_u32 s43, s35, s20
  buffer_load_dwordx2 v[38:39], v6, s[8:11], s43 offen
  s_add_u32 s23, s21, 4
  s_lshr_b32 s31, s23, 1
  s_lshl_b32 s31, s31, 6
  s_and_b32 s23, s23, 1
  s_lshl_b32 s23, s23, 3
  s_add_u32 s36, s31, s23
  s_add_u32 s44, s36, s20
  buffer_load_dwordx2 v[40:41], v6, s[8:11], s44 offen
  s_waitcnt vmcnt(0)
  v_cvt_pk_bf16_f32 v80, v8, v9
  v_cvt_pk_bf16_f32 v81, v10, v11
  v_lshlrev_b32 v8, 16, v80
  v_and_b32 v9, 0xffff0000, v80
  v_lshlrev_b32 v10, 16, v81
  v_and_b32 v11, 0xffff0000, v81
  v_lshlrev_b32 v82, 16, v32
  v_and_b32 v83, 0xffff0000, v32
  v_lshlrev_b32 v84, 16, v33
  v_and_b32 v85, 0xffff0000, v33
  v_add_f32 v8, v8, v82
  v_add_f32 v9, v9, v83
  v_add_f32 v10, v10, v84
  v_add_f32 v11, v11, v85
  v_cvt_pk_bf16_f32 v32, v8, v9
  v_cvt_pk_bf16_f32 v33, v10, v11
  s_add_u32 s23, s32, 84934656
  buffer_store_dwordx2 v[32:33], v6, s[4:7], s23 offen sc1
  v_cvt_pk_bf16_f32 v80, v12, v13
  v_cvt_pk_bf16_f32 v81, v14, v15
  v_lshlrev_b32 v12, 16, v80
  v_and_b32 v13, 0xffff0000, v80
  v_lshlrev_b32 v14, 16, v81
  v_and_b32 v15, 0xffff0000, v81
  v_lshlrev_b32 v82, 16, v34
  v_and_b32 v83, 0xffff0000, v34
  v_lshlrev_b32 v84, 16, v35
  v_and_b32 v85, 0xffff0000, v35
  v_add_f32 v12, v12, v82
  v_add_f32 v13, v13, v83
  v_add_f32 v14, v14, v84
  v_add_f32 v15, v15, v85
  v_cvt_pk_bf16_f32 v34, v12, v13
  v_cvt_pk_bf16_f32 v35, v14, v15
  s_add_u32 s23, s33, 84934656
  buffer_store_dwordx2 v[34:35], v6, s[4:7], s23 offen sc1
  v_cvt_pk_bf16_f32 v80, v16, v17
  v_cvt_pk_bf16_f32 v81, v18, v19
  v_lshlrev_b32 v16, 16, v80
  v_and_b32 v17, 0xffff0000, v80
  v_lshlrev_b32 v18, 16, v81
  v_and_b32 v19, 0xffff0000, v81
  v_lshlrev_b32 v82, 16, v36
  v_and_b32 v83, 0xffff0000, v36
  v_lshlrev_b32 v84, 16, v37
  v_and_b32 v85, 0xffff0000, v37
  v_add_f32 v16, v16, v82
  v_add_f32 v17, v17, v83
  v_add_f32 v18, v18, v84
  v_add_f32 v19, v19, v85
  v_cvt_pk_bf16_f32 v36, v16, v17
  v_cvt_pk_bf16_f32 v37, v18, v19
  s_add_u32 s23, s34, 84934656
  buffer_store_dwordx2 v[36:37], v6, s[4:7], s23 offen sc1
  v_cvt_pk_bf16_f32 v80, v20, v21
  v_cvt_pk_bf16_f32 v81, v22, v23
  v_lshlrev_b32 v20, 16, v80
  v_and_b32 v21, 0xffff0000, v80
  v_lshlrev_b32 v22, 16, v81
  v_and_b32 v23, 0xffff0000, v81
  v_lshlrev_b32 v82, 16, v38
  v_and_b32 v83, 0xffff0000, v38
  v_lshlrev_b32 v84, 16, v39
  v_and_b32 v85, 0xffff0000, v39
  v_add_f32 v20, v20, v82
  v_add_f32 v21, v21, v83
  v_add_f32 v22, v22, v84
  v_add_f32 v23, v23, v85
  v_cvt_pk_bf16_f32 v38, v20, v21
  v_cvt_pk_bf16_f32 v39, v22, v23
  s_add_u32 s23, s35, 84934656
  buffer_store_dwordx2 v[38:39], v6, s[4:7], s23 offen sc1
  v_cvt_pk_bf16_f32 v80, v24, v25
  v_cvt_pk_bf16_f32 v81, v26, v27
  v_lshlrev_b32 v24, 16, v80
  v_and_b32 v25, 0xffff0000, v80
  v_lshlrev_b32 v26, 16, v81
  v_and_b32 v27, 0xffff0000, v81
  v_lshlrev_b32 v82, 16, v40
  v_and_b32 v83, 0xffff0000, v40
  v_lshlrev_b32 v84, 16, v41
  v_and_b32 v85, 0xffff0000, v41
  v_add_f32 v24, v24, v82
  v_add_f32 v25, v25, v83
  v_add_f32 v26, v26, v84
  v_add_f32 v27, v27, v85
  v_cvt_pk_bf16_f32 v40, v24, v25
  v_cvt_pk_bf16_f32 v41, v26, v27
  s_add_u32 s23, s36, 84934656
  buffer_store_dwordx2 v[40:41], v6, s[4:7], s23 offen sc1
outb1_exit1:
  s_endpgm
.globl outb2_kernel
.p2align 8
.type outb2_kernel,@function
outb2_kernel:
  s_cmp_ge_u32 s2, 256
  s_cbranch_scc1 outb2_exit1
  s_load_dwordx2 s[12:13], s[0:1], 96
  s_load_dwordx2 s[14:15], s[0:1], 0
  s_load_dwordx2 s[48:49], s[0:1], 80
  v_lshrrev_b32 v3, 6, v0
  v_and_b32 v4, 63, v0
  s_nop 0
  v_readfirstlane_b32 s16, v3
  v_lshlrev_b32 v1, 4, v4
  s_and_b32 s17, s2, 7
  s_lshl_b32 s17, s17, 2
  s_lshr_b32 s18, s2, 3
  s_and_b32 s19, s18, 3
  s_add_u32 s17, s17, s19
  s_lshr_b32 s18, s18, 2
  s_waitcnt lgkmcnt(0)
  s_mov_b32 s4, s12
  s_mov_b32 s5, s13
  s_mov_b32 s6, 0x10000000
  s_mov_b32 s7, 0x20000
  s_mov_b32 s8, s12
  s_mov_b32 s9, s13
  s_mov_b32 s10, 0x10000000
  s_mov_b32 s11, 0x20000
  s_mov_b32 s20, 84934656
  s_mov_b32 s52, s48
  s_mov_b32 s53, s49
  s_mov_b32 s54, 2621440
  s_mov_b32 s55, 0x20000
  s_mul_i32 s21, s18, 5
  s_mul_i32 s21, s21, 32768
  s_add_u32 s24, s21, 94109696
  s_add_u32 s25, s24, 32768
  s_add_u32 s26, s25, 32768
  s_add_u32 s27, s26, 32768
  s_add_u32 s28, s27, 32768
  s_lshl_b32 s21, s17, 2
  s_add_u32 s21, s21, s16
  s_mul_i32 s22, s21, 32768
  s_add_u32 s22, s22, 50331648
  s_lshl_b32 s23, s16, 10
  v_add_u32 v2, s23, v1
  s_mul_i32 s29, s16, 5120
  s_add_u32 m0, s29, 0
  s_nop 0
  buffer_load_dwordx4 v2, s[4:7], s24 offen lds
  s_add_u32 m0, s29, 1024
  s_nop 0
  buffer_load_dwordx4 v2, s[4:7], s25 offen lds
  s_add_u32 m0, s29, 2048
  s_nop 0
  buffer_load_dwordx4 v2, s[4:7], s26 offen lds
  s_add_u32 m0, s29, 3072
  s_nop 0
  buffer_load_dwordx4 v2, s[4:7], s27 offen lds
  s_add_u32 m0, s29, 4096
  s_nop 0
  buffer_load_dwordx4 v2, s[4:7], s28 offen lds
  buffer_load_dwordx4 v[32:35], v1, s[4:7], s22 offen offset:0
  buffer_load_dwordx4 v[36:39], v1, s[4:7], s22 offen offset:1024
  buffer_load_dwordx4 v[40:43], v1, s[4:7], s22 offen offset:2048
  buffer_load_dwordx4 v[44:47], v1, s[4:7], s22 offen offset:3072
  v_add_u32 v2, 0x1000, v2
  s_add_u32 s22, s22, 4096
  s_add_u32 m0, s29, 20480
  s_nop 0
  buffer_load_dwordx4 v2, s[4:7], s24 offen lds
  s_add_u32 m0, s29, 21504
  s_nop 0
  buffer_load_dwordx4 v2, s[4:7], s25 offen lds
  s_add_u32 m0, s29, 22528
  s_nop 0
  buffer_load_dwordx4 v2, s[4:7], s26 offen lds
  s_add_u32 m0, s29, 23552
  s_nop 0
  buffer_load_dwordx4 v2, s[4:7], s27 offen lds
  s_add_u32 m0, s29, 24576
  s_nop 0
  buffer_load_dwordx4 v2, s[4:7], s28 offen lds
  buffer_load_dwordx4 v[48:51], v1, s[4:7], s22 offen offset:0
  buffer_load_dwordx4 v[52:55], v1, s[4:7], s22 offen offset:1024
  buffer_load_dwordx4 v[56:59], v1, s[4:7], s22 offen offset:2048
  buffer_load_dwordx4 v[60:63], v1, s[4:7], s22 offen offset:3072
  v_add_u32 v2, 0x1000, v2
  s_add_u32 s22, s22, 4096
  s_waitcnt vmcnt(9)
  s_barrier
  s_add_u32 m0, s29, 40960
  s_nop 0
  buffer_load_dwordx4 v2, s[4:7], s24 offen lds
  s_add_u32 m0, s29, 41984
  s_nop 0
  buffer_load_dwordx4 v2, s[4:7], s25 offen lds
  s_add_u32 m0, s29, 43008
  s_nop 0
  buffer_load_dwordx4 v2, s[4:7], s26 offen lds
  s_add_u32 m0, s29, 44032
  s_nop 0
  buffer_load_dwordx4 v2, s[4:7], s27 offen lds
  s_add_u32 m0, s29, 45056
  s_nop 0
  buffer_load_dwordx4 v2, s[4:7], s28 offen lds
  buffer_load_dwordx4 v[64:67], v1, s[4:7], s22 offen offset:0
  buffer_load_dwordx4 v[68:71], v1, s[4:7], s22 offen offset:1024
  buffer_load_dwordx4 v[72:75], v1, s[4:7], s22 offen offset:2048
  buffer_load_dwordx4 v[76:79], v1, s[4:7], s22 offen offset:3072
  v_add_u32 v2, 0x1000, v2
  s_add_u32 s22, s22, 4096
  ds_read_b128 v[80:83], v1 offset:0
  ds_read_b128 v[84:87], v1 offset:1024
  ds_read_b128 v[88:91], v1 offset:2048
  ds_read_b128 v[92:95], v1 offset:3072
  ds_read_b128 v[96:99], v1 offset:4096
  ds_read_b128 v[100:103], v1 offset:5120
  ds_read_b128 v[104:107], v1 offset:6144
  ds_read_b128 v[108:111], v1 offset:7168
  ds_read_b128 v[112:115], v1 offset:8192
  ds_read_b128 v[116:119], v1 offset:9216
  s_waitcnt lgkmcnt(5)
  v_mfma_f32_16x16x32_bf16 v[8:11], v[80:83], v[32:35], 0
  v_mfma_f32_16x16x32_bf16 v[12:15], v[84:87], v[32:35], 0
  v_mfma_f32_16x16x32_bf16 v[16:19], v[88:91], v[32:35], 0
  v_mfma_f32_16x16x32_bf16 v[20:23], v[92:95], v[32:35], 0
  v_mfma_f32_16x16x32_bf16 v[24:27], v[96:99], v[32:35], 0
  ds_read_b128 v[80:83], v1 offset:10240
  ds_read_b128 v[84:87], v1 offset:11264
  ds_read_b128 v[88:91], v1 offset:12288
  ds_read_b128 v[92:95], v1 offset:13312
  ds_read_b128 v[96:99], v1 offset:14336
  s_waitcnt lgkmcnt(5)
  v_mfma_f32_16x16x32_bf16 v[8:11], v[100:103], v[36:39], v[8:11]
  v_mfma_f32_16x16x32_bf16 v[12:15], v[104:107], v[36:39], v[12:15]
  v_mfma_f32_16x16x32_bf16 v[16:19], v[108:111], v[36:39], v[16:19]
  v_mfma_f32_16x16x32_bf16 v[20:23], v[112:115], v[36:39], v[20:23]
  v_mfma_f32_16x16x32_bf16 v[24:27], v[116:119], v[36:39], v[24:27]
  ds_read_b128 v[100:103], v1 offset:15360
  ds_read_b128 v[104:107], v1 offset:16384
  ds_read_b128 v[108:111], v1 offset:17408
  ds_read_b128 v[112:115], v1 offset:18432
  ds_read_b128 v[116:119], v1 offset:19456
  s_waitcnt lgkmcnt(5)
  v_mfma_f32_16x16x32_bf16 v[8:11], v[80:83], v[40:43], v[8:11]
  v_mfma_f32_16x16x32_bf16 v[12:15], v[84:87], v[40:43], v[12:15]
  v_mfma_f32_16x16x32_bf16 v[16:19], v[88:91], v[40:43], v[16:19]
  v_mfma_f32_16x16x32_bf16 v[20:23], v[92:95], v[40:43], v[20:23]
  v_mfma_f32_16x16x32_bf16 v[24:27], v[96:99], v[40:43], v[24:27]
  s_waitcnt lgkmcnt(0)
  v_mfma_f32_16x16x32_bf16 v[8:11], v[100:103], v[44:47], v[8:11]
  v_mfma_f32_16x16x32_bf16 v[12:15], v[104:107], v[44:47], v[12:15]
  v_mfma_f32_16x16x32_bf16 v[16:19], v[108:111], v[44:47], v[16:19]
  v_mfma_f32_16x16x32_bf16 v[20:23], v[112:115], v[44:47], v[20:23]
  v_mfma_f32_16x16x32_bf16 v[24:27], v[116:119], v[44:47], v[24:27]
  s_mov_b32 s30, 0
outb2_loop2:
  s_waitcnt vmcnt(9)
  s_barrier
  s_add_u32 m0, s29, 0
  s_nop 0
  buffer_load_dwordx4 v2, s[4:7], s24 offen lds
  s_add_u32 m0, s29, 1024
  s_nop 0
  buffer_load_dwordx4 v2, s[4:7], s25 offen lds
  s_add_u32 m0, s29, 2048
  s_nop 0
  buffer_load_dwordx4 v2, s[4:7], s26 offen lds
  s_add_u32 m0, s29, 3072
  s_nop 0
  buffer_load_dwordx4 v2, s[4:7], s27 offen lds
  s_add_u32 m0, s29, 4096
  s_nop 0
  buffer_load_dwordx4 v2, s[4:7], s28 offen lds
  buffer_load_dwordx4 v[32:35], v1, s[4:7], s22 offen offset:0
  buffer_load_dwordx4 v[36:39], v1, s[4:7], s22 offen offset:1024
  buffer_load_dwordx4 v[40:43], v1, s[4:7], s22 offen offset:2048
  buffer_load_dwordx4 v[44:47], v1, s[4:7], s22 offen offset:3072
  v_add_u32 v2, 0x1000, v2
  s_add_u32 s22, s22, 4096
  ds_read_b128 v[80:83], v1 offset:20480
  ds_read_b128 v[84:87], v1 offset:21504
  ds_read_b128 v[88:91], v1 offset:22528
  ds_read_b128 v[92:95], v1 offset:23552
  ds_read_b128 v[96:99], v1 offset:24576
  ds_read_b128 v[100:103], v1 offset:25600
  ds_read_b128 v[104:107], v1 offset:26624
  ds_read_b128 v[108:111], v1 offset:27648
  ds_read_b128 v[112:115], v1 offset:28672
  ds_read_b128 v[116:119], v1 offset:29696
  s_waitcnt lgkmcnt(5)
  v_mfma_f32_16x16x32_bf16 v[8:11], v[80:83], v[48:51], v[8:11]
  v_mfma_f32_16x16x32_bf16 v[12:15], v[84:87], v[48:51], v[12:15]
  v_mfma_f32_16x16x32_bf16 v[16:19], v[88:91], v[48:51], v[16:19]
  v_mfma_f32_16x16x32_bf16 v[20:23], v[92:95], v[48:51], v[20:23]
  v_mfma_f32_16x16x32_bf16 v[24:27], v[96:99], v[48:51], v[24:27]
  ds_read_b128 v[80:83], v1 offset:30720
  ds_read_b128 v[84:87], v1 offset:31744
  ds_read_b128 v[88:91], v1 offset:32768
  ds_read_b128 v[92:95], v1 offset:33792
  ds_read_b128 v[96:99], v1 offset:34816
  s_waitcnt lgkmcnt(5)
  v_mfma_f32_16x16x32_bf16 v[8:11], v[100:103], v[52:55], v[8:11]
  v_mfma_f32_16x16x32_bf16 v[12:15], v[104:107], v[52:55], v[12:15]
  v_mfma_f32_16x16x32_bf16 v[16:19], v[108:111], v[52:55], v[16:19]
  v_mfma_f32_16x16x32_bf16 v[20:23], v[112:115], v[52:55], v[20:23]
  v_mfma_f32_16x16x32_bf16 v[24:27], v[116:119], v[52:55], v[24:27]
  ds_read_b128 v[100:103], v1 offset:35840
  ds_read_b128 v[104:107], v1 offset:36864
  ds_read_b128 v[108:111], v1 offset:37888
  ds_read_b128 v[112:115], v1 offset:38912
  ds_read_b128 v[116:119], v1 offset:39936
  s_waitcnt lgkmcnt(5)
  v_mfma_f32_16x16x32_bf16 v[8:11], v[80:83], v[56:59], v[8:11]
  v_mfma_f32_16x16x32_bf16 v[12:15], v[84:87], v[56:59], v[12:15]
  v_mfma_f32_16x16x32_bf16 v[16:19], v[88:91], v[56:59], v[16:19]
  v_mfma_f32_16x16x32_bf16 v[20:23], v[92:95], v[56:59], v[20:23]
  v_mfma_f32_16x16x32_bf16 v[24:27], v[96:99], v[56:59], v[24:27]
  s_waitcnt lgkmcnt(0)
  v_mfma_f32_16x16x32_bf16 v[8:11], v[100:103], v[60:63], v[8:11]
  v_mfma_f32_16x16x32_bf16 v[12:15], v[104:107], v[60:63], v[12:15]
  v_mfma_f32_16x16x32_bf16 v[16:19], v[108:111], v[60:63], v[16:19]
  v_mfma_f32_16x16x32_bf16 v[20:23], v[112:115], v[60:63], v[20:23]
  v_mfma_f32_16x16x32_bf16 v[24:27], v[116:119], v[60:63], v[24:27]
  s_waitcnt vmcnt(9)
  s_barrier
  s_add_u32 m0, s29, 20480
  s_nop 0
  buffer_load_dwordx4 v2, s[4:7], s24 offen lds
  s_add_u32 m0, s29, 21504
  s_nop 0
  buffer_load_dwordx4 v2, s[4:7], s25 offen lds
  s_add_u32 m0, s29, 22528
  s_nop 0
  buffer_load_dwordx4 v2, s[4:7], s26 offen lds
  s_add_u32 m0, s29, 23552
  s_nop 0
  buffer_load_dwordx4 v2, s[4:7], s27 offen lds
  s_add_u32 m0, s29, 24576
  s_nop 0
  buffer_load_dwordx4 v2, s[4:7], s28 offen lds
  buffer_load_dwordx4 v[48:51], v1, s[4:7], s22 offen offset:0
  buffer_load_dwordx4 v[52:55], v1, s[4:7], s22 offen offset:1024
  buffer_load_dwordx4 v[56:59], v1, s[4:7], s22 offen offset:2048
  buffer_load_dwordx4 v[60:63], v1, s[4:7], s22 offen offset:3072
  v_add_u32 v2, 0x1000, v2
  s_add_u32 s22, s22, 4096
  ds_read_b128 v[80:83], v1 offset:40960
  ds_read_b128 v[84:87], v1 offset:41984
  ds_read_b128 v[88:91], v1 offset:43008
  ds_read_b128 v[92:95], v1 offset:44032
  ds_read_b128 v[96:99], v1 offset:45056
  ds_read_b128 v[100:103], v1 offset:46080
  ds_read_b128 v[104:107], v1 offset:47104
  ds_read_b128 v[108:111], v1 offset:48128
  ds_read_b128 v[112:115], v1 offset:49152
  ds_read_b128 v[116:119], v1 offset:50176
  s_waitcnt lgkmcnt(5)
  v_mfma_f32_16x16x32_bf16 v[8:11], v[80:83], v[64:67], v[8:11]
  v_mfma_f32_16x16x32_bf16 v[12:15], v[84:87], v[64:67], v[12:15]
  v_mfma_f32_16x16x32_bf16 v[16:19], v[88:91], v[64:67], v[16:19]
  v_mfma_f32_16x16x32_bf16 v[20:23], v[92:95], v[64:67], v[20:23]
  v_mfma_f32_16x16x32_bf16 v[24:27], v[96:99], v[64:67], v[24:27]
  ds_read_b128 v[80:83], v1 offset:51200
  ds_read_b128 v[84:87], v1 offset:52224
  ds_read_b128 v[88:91], v1 offset:53248
  ds_read_b128 v[92:95], v1 offset:54272
  ds_read_b128 v[96:99], v1 offset:55296
  s_waitcnt lgkmcnt(5)
  v_mfma_f32_16x16x32_bf16 v[8:11], v[100:103], v[68:71], v[8:11]
  v_mfma_f32_16x16x32_bf16 v[12:15], v[104:107], v[68:71], v[12:15]
  v_mfma_f32_16x16x32_bf16 v[16:19], v[108:111], v[68:71], v[16:19]
  v_mfma_f32_16x16x32_bf16 v[20:23], v[112:115], v[68:71], v[20:23]
  v_mfma_f32_16x16x32_bf16 v[24:27], v[116:119], v[68:71], v[24:27]
  ds_read_b128 v[100:103], v1 offset:56320
  ds_read_b128 v[104:107], v1 offset:57344
  ds_read_b128 v[108:111], v1 offset:58368
  ds_read_b128 v[112:115], v1 offset:59392
  ds_read_b128 v[116:119], v1 offset:60416
  s_waitcnt lgkmcnt(5)
  v_mfma_f32_16x16x32_bf16 v[8:11], v[80:83], v[72:75], v[8:11]
  v_mfma_f32_16x16x32_bf16 v[12:15], v[84:87], v[72:75], v[12:15]
  v_mfma_f32_16x16x32_bf16 v[16:19], v[88:91], v[72:75], v[16:19]
  v_mfma_f32_16x16x32_bf16 v[20:23], v[92:95], v[72:75], v[20:23]
  v_mfma_f32_16x16x32_bf16 v[24:27], v[96:99], v[72:75], v[24:27]
  s_waitcnt lgkmcnt(0)
  v_mfma_f32_16x16x32_bf16 v[8:11], v[100:103], v[76:79], v[8:11]
  v_mfma_f32_16x16x32_bf16 v[12:15], v[104:107], v[76:79], v[12:15]
  v_mfma_f32_16x16x32_bf16 v[16:19], v[108:111], v[76:79], v[16:19]
  v_mfma_f32_16x16x32_bf16 v[20:23], v[112:115], v[76:79], v[20:23]
  v_mfma_f32_16x16x32_bf16 v[24:27], v[116:119], v[76:79], v[24:27]
  s_waitcnt vmcnt(9)
  s_barrier
  s_add_u32 m0, s29, 40960
  s_nop 0
  buffer_load_dwordx4 v2, s[4:7], s24 offen lds
  s_add_u32 m0, s29, 41984
  s_nop 0
  buffer_load_dwordx4 v2, s[4:7], s25 offen lds
  s_add_u32 m0, s29, 43008
  s_nop 0
  buffer_load_dwordx4 v2, s[4:7], s26 offen lds
  s_add_u32 m0, s29, 44032
  s_nop 0
  buffer_load_dwordx4 v2, s[4:7], s27 offen lds
  s_add_u32 m0, s29, 45056
  s_nop 0
  buffer_load_dwordx4 v2, s[4:7], s28 offen lds
  buffer_load_dwordx4 v[64:67], v1, s[4:7], s22 offen offset:0
  buffer_load_dwordx4 v[68:71], v1, s[4:7], s22 offen offset:1024
  buffer_load_dwordx4 v[72:75], v1, s[4:7], s22 offen offset:2048
  buffer_load_dwordx4 v[76:79], v1, s[4:7], s22 offen offset:3072
  v_add_u32 v2, 0x1000, v2
  s_add_u32 s22, s22, 4096
  ds_read_b128 v[80:83], v1 offset:0
  ds_read_b128 v[84:87], v1 offset:1024
  ds_read_b128 v[88:91], v1 offset:2048
  ds_read_b128 v[92:95], v1 offset:3072
  ds_read_b128 v[96:99], v1 offset:4096
  ds_read_b128 v[100:103], v1 offset:5120
  ds_read_b128 v[104:107], v1 offset:6144
  ds_read_b128 v[108:111], v1 offset:7168
  ds_read_b128 v[112:115], v1 offset:8192
  ds_read_b128 v[116:119], v1 offset:9216
  s_waitcnt lgkmcnt(5)
  v_mfma_f32_16x16x32_bf16 v[8:11], v[80:83], v[32:35], v[8:11]
  v_mfma_f32_16x16x32_bf16 v[12:15], v[84:87], v[32:35], v[12:15]
  v_mfma_f32_16x16x32_bf16 v[16:19], v[88:91], v[32:35], v[16:19]
  v_mfma_f32_16x16x32_bf16 v[20:23], v[92:95], v[32:35], v[20:23]
  v_mfma_f32_16x16x32_bf16 v[24:27], v[96:99], v[32:35], v[24:27]
  ds_read_b128 v[80:83], v1 offset:10240
  ds_read_b128 v[84:87], v1 offset:11264
  ds_read_b128 v[88:91], v1 offset:12288
  ds_read_b128 v[92:95], v1 offset:13312
  ds_read_b128 v[96:99], v1 offset:14336
  s_waitcnt lgkmcnt(5)
  v_mfma_f32_16x16x32_bf16 v[8:11], v[100:103], v[36:39], v[8:11]
  v_mfma_f32_16x16x32_bf16 v[12:15], v[104:107], v[36:39], v[12:15]
  v_mfma_f32_16x16x32_bf16 v[16:19], v[108:111], v[36:39], v[16:19]
  v_mfma_f32_16x16x32_bf16 v[20:23], v[112:115], v[36:39], v[20:23]
  v_mfma_f32_16x16x32_bf16 v[24:27], v[116:119], v[36:39], v[24:27]
  ds_read_b128 v[100:103], v1 offset:15360
  ds_read_b128 v[104:107], v1 offset:16384
  ds_read_b128 v[108:111], v1 offset:17408
  ds_read_b128 v[112:115], v1 offset:18432
  ds_read_b128 v[116:119], v1 offset:19456
  s_waitcnt lgkmcnt(5)
  v_mfma_f32_16x16x32_bf16 v[8:11], v[80:83], v[40:43], v[8:11]
  v_mfma_f32_16x16x32_bf16 v[12:15], v[84:87], v[40:43], v[12:15]
  v_mfma_f32_16x16x32_bf16 v[16:19], v[88:91], v[40:43], v[16:19]
  v_mfma_f32_16x16x32_bf16 v[20:23], v[92:95], v[40:43], v[20:23]
  v_mfma_f32_16x16x32_bf16 v[24:27], v[96:99], v[40:43], v[24:27]
  s_waitcnt lgkmcnt(0)
  v_mfma_f32_16x16x32_bf16 v[8:11], v[100:103], v[44:47], v[8:11]
  v_mfma_f32_16x16x32_bf16 v[12:15], v[104:107], v[44:47], v[12:15]
  v_mfma_f32_16x16x32_bf16 v[16:19], v[108:111], v[44:47], v[16:19]
  v_mfma_f32_16x16x32_bf16 v[20:23], v[112:115], v[44:47], v[20:23]
  v_mfma_f32_16x16x32_bf16 v[24:27], v[116:119], v[44:47], v[24:27]
  s_add_u32 s30, s30, 1
  s_cmp_lt_u32 s30, 1
  s_cbranch_scc1 outb2_loop2
  s_waitcnt vmcnt(9)
  s_barrier
  s_add_u32 m0, s29, 0
  s_nop 0
  buffer_load_dwordx4 v2, s[4:7], s24 offen lds
  s_add_u32 m0, s29, 1024
  s_nop 0
  buffer_load_dwordx4 v2, s[4:7], s25 offen lds
  s_add_u32 m0, s29, 2048
  s_nop 0
  buffer_load_dwordx4 v2, s[4:7], s26 offen lds
  s_add_u32 m0, s29, 3072
  s_nop 0
  buffer_load_dwordx4 v2, s[4:7], s27 offen lds
  s_add_u32 m0, s29, 4096
  s_nop 0
  buffer_load_dwordx4 v2, s[4:7], s28 offen lds
  buffer_load_dwordx4 v[32:35], v1, s[4:7], s22 offen offset:0
  buffer_load_dwordx4 v[36:39], v1, s[4:7], s22 offen offset:1024
  buffer_load_dwordx4 v[40:43], v1, s[4:7], s22 offen offset:2048
  buffer_load_dwordx4 v[44:47], v1, s[4:7], s22 offen offset:3072
  v_add_u32 v2, 0x1000, v2
  s_add_u32 s22, s22, 4096
  ds_read_b128 v[80:83], v1 offset:20480
  ds_read_b128 v[84:87], v1 offset:21504
  ds_read_b128 v[88:91], v1 offset:22528
  ds_read_b128 v[92:95], v1 offset:23552
  ds_read_b128 v[96:99], v1 offset:24576
  ds_read_b128 v[100:103], v1 offset:25600
  ds_read_b128 v[104:107], v1 offset:26624
  ds_read_b128 v[108:111], v1 offset:27648
  ds_read_b128 v[112:115], v1 offset:28672
  ds_read_b128 v[116:119], v1 offset:29696
  s_waitcnt lgkmcnt(5)
  v_mfma_f32_16x16x32_bf16 v[8:11], v[80:83], v[48:51], v[8:11]
  v_mfma_f32_16x16x32_bf16 v[12:15], v[84:87], v[48:51], v[12:15]
  v_mfma_f32_16x16x32_bf16 v[16:19], v[88:91], v[48:51], v[16:19]
  v_mfma_f32_16x16x32_bf16 v[20:23], v[92:95], v[48:51], v[20:23]
  v_mfma_f32_16x16x32_bf16 v[24:27], v[96:99], v[48:51], v[24:27]
  ds_read_b128 v[80:83], v1 offset:30720
  ds_read_b128 v[84:87], v1 offset:31744
  ds_read_b128 v[88:91], v1 offset:32768
  ds_read_b128 v[92:95], v1 offset:33792
  ds_read_b128 v[96:99], v1 offset:34816
  s_waitcnt lgkmcnt(5)
  v_mfma_f32_16x16x32_bf16 v[8:11], v[100:103], v[52:55], v[8:11]
  v_mfma_f32_16x16x32_bf16 v[12:15], v[104:107], v[52:55], v[12:15]
  v_mfma_f32_16x16x32_bf16 v[16:19], v[108:111], v[52:55], v[16:19]
  v_mfma_f32_16x16x32_bf16 v[20:23], v[112:115], v[52:55], v[20:23]
  v_mfma_f32_16x16x32_bf16 v[24:27], v[116:119], v[52:55], v[24:27]
  ds_read_b128 v[100:103], v1 offset:35840
  ds_read_b128 v[104:107], v1 offset:36864
  ds_read_b128 v[108:111], v1 offset:37888
  ds_read_b128 v[112:115], v1 offset:38912
  ds_read_b128 v[116:119], v1 offset:39936
  s_waitcnt lgkmcnt(5)
  v_mfma_f32_16x16x32_bf16 v[8:11], v[80:83], v[56:59], v[8:11]
  v_mfma_f32_16x16x32_bf16 v[12:15], v[84:87], v[56:59], v[12:15]
  v_mfma_f32_16x16x32_bf16 v[16:19], v[88:91], v[56:59], v[16:19]
  v_mfma_f32_16x16x32_bf16 v[20:23], v[92:95], v[56:59], v[20:23]
  v_mfma_f32_16x16x32_bf16 v[24:27], v[96:99], v[56:59], v[24:27]
  s_waitcnt lgkmcnt(0)
  v_mfma_f32_16x16x32_bf16 v[8:11], v[100:103], v[60:63], v[8:11]
  v_mfma_f32_16x16x32_bf16 v[12:15], v[104:107], v[60:63], v[12:15]
  v_mfma_f32_16x16x32_bf16 v[16:19], v[108:111], v[60:63], v[16:19]
  v_mfma_f32_16x16x32_bf16 v[20:23], v[112:115], v[60:63], v[20:23]
  v_mfma_f32_16x16x32_bf16 v[24:27], v[116:119], v[60:63], v[24:27]
  s_waitcnt vmcnt(9)
  s_barrier
  s_add_u32 m0, s29, 20480
  s_nop 0
  buffer_load_dwordx4 v2, s[4:7], s24 offen lds
  s_add_u32 m0, s29, 21504
  s_nop 0
  buffer_load_dwordx4 v2, s[4:7], s25 offen lds
  s_add_u32 m0, s29, 22528
  s_nop 0
  buffer_load_dwordx4 v2, s[4:7], s26 offen lds
  s_add_u32 m0, s29, 23552
  s_nop 0
  buffer_load_dwordx4 v2, s[4:7], s27 offen lds
  s_add_u32 m0, s29, 24576
  s_nop 0
  buffer_load_dwordx4 v2, s[4:7], s28 offen lds
  buffer_load_dwordx4 v[48:51], v1, s[4:7], s22 offen offset:0
  buffer_load_dwordx4 v[52:55], v1, s[4:7], s22 offen offset:1024
  buffer_load_dwordx4 v[56:59], v1, s[4:7], s22 offen offset:2048
  buffer_load_dwordx4 v[60:63], v1, s[4:7], s22 offen offset:3072
  v_add_u32 v2, 0x1000, v2
  s_add_u32 s22, s22, 4096
  ds_read_b128 v[80:83], v1 offset:40960
  ds_read_b128 v[84:87], v1 offset:41984
  ds_read_b128 v[88:91], v1 offset:43008
  ds_read_b128 v[92:95], v1 offset:44032
  ds_read_b128 v[96:99], v1 offset:45056
  ds_read_b128 v[100:103], v1 offset:46080
  ds_read_b128 v[104:107], v1 offset:47104
  ds_read_b128 v[108:111], v1 offset:48128
  ds_read_b128 v[112:115], v1 offset:49152
  ds_read_b128 v[116:119], v1 offset:50176
  s_waitcnt lgkmcnt(5)
  v_mfma_f32_16x16x32_bf16 v[8:11], v[80:83], v[64:67], v[8:11]
  v_mfma_f32_16x16x32_bf16 v[12:15], v[84:87], v[64:67], v[12:15]
  v_mfma_f32_16x16x32_bf16 v[16:19], v[88:91], v[64:67], v[16:19]
  v_mfma_f32_16x16x32_bf16 v[20:23], v[92:95], v[64:67], v[20:23]
  v_mfma_f32_16x16x32_bf16 v[24:27], v[96:99], v[64:67], v[24:27]
  ds_read_b128 v[80:83], v1 offset:51200
  ds_read_b128 v[84:87], v1 offset:52224
  ds_read_b128 v[88:91], v1 offset:53248
  ds_read_b128 v[92:95], v1 offset:54272
  ds_read_b128 v[96:99], v1 offset:55296
  s_waitcnt lgkmcnt(5)
  v_mfma_f32_16x16x32_bf16 v[8:11], v[100:103], v[68:71], v[8:11]
  v_mfma_f32_16x16x32_bf16 v[12:15], v[104:107], v[68:71], v[12:15]
  v_mfma_f32_16x16x32_bf16 v[16:19], v[108:111], v[68:71], v[16:19]
  v_mfma_f32_16x16x32_bf16 v[20:23], v[112:115], v[68:71], v[20:23]
  v_mfma_f32_16x16x32_bf16 v[24:27], v[116:119], v[68:71], v[24:27]
  ds_read_b128 v[100:103], v1 offset:56320
  ds_read_b128 v[104:107], v1 offset:57344
  ds_read_b128 v[108:111], v1 offset:58368
  ds_read_b128 v[112:115], v1 offset:59392
  ds_read_b128 v[116:119], v1 offset:60416
  s_waitcnt lgkmcnt(5)
  v_mfma_f32_16x16x32_bf16 v[8:11], v[80:83], v[72:75], v[8:11]
  v_mfma_f32_16x16x32_bf16 v[12:15], v[84:87], v[72:75], v[12:15]
  v_mfma_f32_16x16x32_bf16 v[16:19], v[88:91], v[72:75], v[16:19]
  v_mfma_f32_16x16x32_bf16 v[20:23], v[92:95], v[72:75], v[20:23]
  v_mfma_f32_16x16x32_bf16 v[24:27], v[96:99], v[72:75], v[24:27]
  s_waitcnt lgkmcnt(0)
  v_mfma_f32_16x16x32_bf16 v[8:11], v[100:103], v[76:79], v[8:11]
  v_mfma_f32_16x16x32_bf16 v[12:15], v[104:107], v[76:79], v[12:15]
  v_mfma_f32_16x16x32_bf16 v[16:19], v[108:111], v[76:79], v[16:19]
  v_mfma_f32_16x16x32_bf16 v[20:23], v[112:115], v[76:79], v[20:23]
  v_mfma_f32_16x16x32_bf16 v[24:27], v[116:119], v[76:79], v[24:27]
  s_waitcnt vmcnt(9)
  s_barrier
  ds_read_b128 v[80:83], v1 offset:0
  ds_read_b128 v[84:87], v1 offset:1024
  ds_read_b128 v[88:91], v1 offset:2048
  ds_read_b128 v[92:95], v1 offset:3072
  ds_read_b128 v[96:99], v1 offset:4096
  ds_read_b128 v[100:103], v1 offset:5120
  ds_read_b128 v[104:107], v1 offset:6144
  ds_read_b128 v[108:111], v1 offset:7168
  ds_read_b128 v[112:115], v1 offset:8192
  ds_read_b128 v[116:119], v1 offset:9216
  s_waitcnt lgkmcnt(5)
  v_mfma_f32_16x16x32_bf16 v[8:11], v[80:83], v[32:35], v[8:11]
  v_mfma_f32_16x16x32_bf16 v[12:15], v[84:87], v[32:35], v[12:15]
  v_mfma_f32_16x16x32_bf16 v[16:19], v[88:91], v[32:35], v[16:19]
  v_mfma_f32_16x16x32_bf16 v[20:23], v[92:95], v[32:35], v[20:23]
  v_mfma_f32_16x16x32_bf16 v[24:27], v[96:99], v[32:35], v[24:27]
  ds_read_b128 v[80:83], v1 offset:10240
  ds_read_b128 v[84:87], v1 offset:11264
  ds_read_b128 v[88:91], v1 offset:12288
  ds_read_b128 v[92:95], v1 offset:13312
  ds_read_b128 v[96:99], v1 offset:14336
  s_waitcnt lgkmcnt(5)
  v_mfma_f32_16x16x32_bf16 v[8:11], v[100:103], v[36:39], v[8:11]
  v_mfma_f32_16x16x32_bf16 v[12:15], v[104:107], v[36:39], v[12:15]
  v_mfma_f32_16x16x32_bf16 v[16:19], v[108:111], v[36:39], v[16:19]
  v_mfma_f32_16x16x32_bf16 v[20:23], v[112:115], v[36:39], v[20:23]
  v_mfma_f32_16x16x32_bf16 v[24:27], v[116:119], v[36:39], v[24:27]
  ds_read_b128 v[100:103], v1 offset:15360
  ds_read_b128 v[104:107], v1 offset:16384
  ds_read_b128 v[108:111], v1 offset:17408
  ds_read_b128 v[112:115], v1 offset:18432
  ds_read_b128 v[116:119], v1 offset:19456
  s_waitcnt lgkmcnt(5)
  v_mfma_f32_16x16x32_bf16 v[8:11], v[80:83], v[40:43], v[8:11]
  v_mfma_f32_16x16x32_bf16 v[12:15], v[84:87], v[40:43], v[12:15]
  v_mfma_f32_16x16x32_bf16 v[16:19], v[88:91], v[40:43], v[16:19]
  v_mfma_f32_16x16x32_bf16 v[20:23], v[92:95], v[40:43], v[20:23]
  v_mfma_f32_16x16x32_bf16 v[24:27], v[96:99], v[40:43], v[24:27]
  s_waitcnt lgkmcnt(0)
  v_mfma_f32_16x16x32_bf16 v[8:11], v[100:103], v[44:47], v[8:11]
  v_mfma_f32_16x16x32_bf16 v[12:15], v[104:107], v[44:47], v[12:15]
  v_mfma_f32_16x16x32_bf16 v[16:19], v[108:111], v[44:47], v[16:19]
  v_mfma_f32_16x16x32_bf16 v[20:23], v[112:115], v[44:47], v[20:23]
  v_mfma_f32_16x16x32_bf16 v[24:27], v[116:119], v[44:47], v[24:27]
  s_waitcnt vmcnt(0)
  s_barrier
  ds_read_b128 v[80:83], v1 offset:20480
  ds_read_b128 v[84:87], v1 offset:21504
  ds_read_b128 v[88:91], v1 offset:22528
  ds_read_b128 v[92:95], v1 offset:23552
  ds_read_b128 v[96:99], v1 offset:24576
  ds_read_b128 v[100:103], v1 offset:25600
  ds_read_b128 v[104:107], v1 offset:26624
  ds_read_b128 v[108:111], v1 offset:27648
  ds_read_b128 v[112:115], v1 offset:28672
  ds_read_b128 v[116:119], v1 offset:29696
  s_waitcnt lgkmcnt(5)
  v_mfma_f32_16x16x32_bf16 v[8:11], v[80:83], v[48:51], v[8:11]
  v_mfma_f32_16x16x32_bf16 v[12:15], v[84:87], v[48:51], v[12:15]
  v_mfma_f32_16x16x32_bf16 v[16:19], v[88:91], v[48:51], v[16:19]
  v_mfma_f32_16x16x32_bf16 v[20:23], v[92:95], v[48:51], v[20:23]
  v_mfma_f32_16x16x32_bf16 v[24:27], v[96:99], v[48:51], v[24:27]
  ds_read_b128 v[80:83], v1 offset:30720
  ds_read_b128 v[84:87], v1 offset:31744
  ds_read_b128 v[88:91], v1 offset:32768
  ds_read_b128 v[92:95], v1 offset:33792
  ds_read_b128 v[96:99], v1 offset:34816
  s_waitcnt lgkmcnt(5)
  v_mfma_f32_16x16x32_bf16 v[8:11], v[100:103], v[52:55], v[8:11]
  v_mfma_f32_16x16x32_bf16 v[12:15], v[104:107], v[52:55], v[12:15]
  v_mfma_f32_16x16x32_bf16 v[16:19], v[108:111], v[52:55], v[16:19]
  v_mfma_f32_16x16x32_bf16 v[20:23], v[112:115], v[52:55], v[20:23]
  v_mfma_f32_16x16x32_bf16 v[24:27], v[116:119], v[52:55], v[24:27]
  ds_read_b128 v[100:103], v1 offset:35840
  ds_read_b128 v[104:107], v1 offset:36864
  ds_read_b128 v[108:111], v1 offset:37888
  ds_read_b128 v[112:115], v1 offset:38912
  ds_read_b128 v[116:119], v1 offset:39936
  s_waitcnt lgkmcnt(5)
  v_mfma_f32_16x16x32_bf16 v[8:11], v[80:83], v[56:59], v[8:11]
  v_mfma_f32_16x16x32_bf16 v[12:15], v[84:87], v[56:59], v[12:15]
  v_mfma_f32_16x16x32_bf16 v[16:19], v[88:91], v[56:59], v[16:19]
  v_mfma_f32_16x16x32_bf16 v[20:23], v[92:95], v[56:59], v[20:23]
  v_mfma_f32_16x16x32_bf16 v[24:27], v[96:99], v[56:59], v[24:27]
  s_waitcnt lgkmcnt(0)
  v_mfma_f32_16x16x32_bf16 v[8:11], v[100:103], v[60:63], v[8:11]
  v_mfma_f32_16x16x32_bf16 v[12:15], v[104:107], v[60:63], v[12:15]
  v_mfma_f32_16x16x32_bf16 v[16:19], v[108:111], v[60:63], v[16:19]
  v_mfma_f32_16x16x32_bf16 v[20:23], v[112:115], v[60:63], v[20:23]
  v_mfma_f32_16x16x32_bf16 v[24:27], v[116:119], v[60:63], v[24:27]
  v_and_b32 v3, 63, v0
  v_and_b32 v4, 15, v3
  v_lshrrev_b32 v3, 4, v3
  s_lshl_b32 s21, s17, 6
  s_lshl_b32 s23, s16, 4
  s_add_u32 s21, s21, s23
  v_add_u32 v4, s21, v4
  v_mul_u32_u24 v6, 1280, v4
  v_lshl_add_u32 v6, v3, 4, v6
  s_mul_i32 s21, s18, 5
  s_add_u32 s23, s21, 0
  s_lshr_b32 s31, s23, 1
  s_lshl_b32 s31, s31, 6
  s_and_b32 s23, s23, 1
  s_lshl_b32 s23, s23, 3
  s_add_u32 s32, s31, s23
  s_add_u32 s40, s32, s20
  buffer_load_dwordx2 v[32:33], v6, s[8:11], s40 offen
  s_add_u32 s23, s21, 1
  s_lshr_b32 s31, s23, 1
  s_lshl_b32 s31, s31, 6
  s_and_b32 s23, s23, 1
  s_lshl_b32 s23, s23, 3
  s_add_u32 s33, s31, s23
  s_add_u32 s41, s33, s20
  buffer_load_dwordx2 v[34:35], v6, s[8:11], s41 offen
  s_add_u32 s23, s21, 2
  s_lshr_b32 s31, s23, 1
  s_lshl_b32 s31, s31, 6
  s_and_b32 s23, s23, 1
  s_lshl_b32 s23, s23, 3
  s_add_u32 s34, s31, s23
  s_add_u32 s42, s34, s20
  buffer_load_dwordx2 v[36:37], v6, s[8:11], s42 offen
  s_add_u32 s23, s21, 3
  s_lshr_b32 s31, s23, 1
  s_lshl_b32 s31, s31, 6
  s_and_b32 s23, s23, 1
  s_lshl_b32 s23, s23, 3
  s_add_u32 s35, s31, s23
  s_add_u32 s43, s35, s20
  buffer_load_dwordx2 v[38:39], v6, s[8:11], s43 offen
  s_add_u32 s23, s21, 4
  s_lshr_b32 s31, s23, 1
  s_lshl_b32 s31, s31, 6
  s_and_b32 s23, s23, 1
  s_lshl_b32 s23, s23, 3
  s_add_u32 s36, s31, s23
  s_add_u32 s44, s36, s20
  buffer_load_dwordx2 v[40:41], v6, s[8:11], s44 offen
  s_waitcnt vmcnt(0)
  v_cvt_pk_bf16_f32 v80, v8, v9
  v_cvt_pk_bf16_f32 v81, v10, v11
  v_lshlrev_b32 v8, 16, v80
  v_and_b32 v9, 0xffff0000, v80
  v_lshlrev_b32 v10, 16, v81
  v_and_b32 v11, 0xffff0000, v81
  v_lshlrev_b32 v82, 16, v32
  v_and_b32 v83, 0xffff0000, v32
  v_lshlrev_b32 v84, 16, v33
  v_and_b32 v85, 0xffff0000, v33
  v_add_f32 v8, v8, v82
  v_add_f32 v9, v9, v83
  v_add_f32 v10, v10, v84
  v_add_f32 v11, v11, v85
  v_cvt_pk_bf16_f32 v32, v8, v9
  v_cvt_pk_bf16_f32 v33, v10, v11
  buffer_store_dwordx2 v[32:33], v6, s[52:55], s32 offen sc1
  v_cvt_pk_bf16_f32 v80, v12, v13
  v_cvt_pk_bf16_f32 v81, v14, v15
  v_lshlrev_b32 v12, 16, v80
  v_and_b32 v13, 0xffff0000, v80
  v_lshlrev_b32 v14, 16, v81
  v_and_b32 v15, 0xffff0000, v81
  v_lshlrev_b32 v82, 16, v34
  v_and_b32 v83, 0xffff0000, v34
  v_lshlrev_b32 v84, 16, v35
  v_and_b32 v85, 0xffff0000, v35
  v_add_f32 v12, v12, v82
  v_add_f32 v13, v13, v83
  v_add_f32 v14, v14, v84
  v_add_f32 v15, v15, v85
  v_cvt_pk_bf16_f32 v34, v12, v13
  v_cvt_pk_bf16_f32 v35, v14, v15
  buffer_store_dwordx2 v[34:35], v6, s[52:55], s33 offen sc1
  v_cvt_pk_bf16_f32 v80, v16, v17
  v_cvt_pk_bf16_f32 v81, v18, v19
  v_lshlrev_b32 v16, 16, v80
  v_and_b32 v17, 0xffff0000, v80
  v_lshlrev_b32 v18, 16, v81
  v_and_b32 v19, 0xffff0000, v81
  v_lshlrev_b32 v82, 16, v36
  v_and_b32 v83, 0xffff0000, v36
  v_lshlrev_b32 v84, 16, v37
  v_and_b32 v85, 0xffff0000, v37
  v_add_f32 v16, v16, v82
  v_add_f32 v17, v17, v83
  v_add_f32 v18, v18, v84
  v_add_f32 v19, v19, v85
  v_cvt_pk_bf16_f32 v36, v16, v17
  v_cvt_pk_bf16_f32 v37, v18, v19
  buffer_store_dwordx2 v[36:37], v6, s[52:55], s34 offen sc1
  v_cvt_pk_bf16_f32 v80, v20, v21
  v_cvt_pk_bf16_f32 v81, v22, v23
  v_lshlrev_b32 v20, 16, v80
  v_and_b32 v21, 0xffff0000, v80
  v_lshlrev_b32 v22, 16, v81
  v_and_b32 v23, 0xffff0000, v81
  v_lshlrev_b32 v82, 16, v38
  v_and_b32 v83, 0xffff0000, v38
  v_lshlrev_b32 v84, 16, v39
  v_and_b32 v85, 0xffff0000, v39
  v_add_f32 v20, v20, v82
  v_add_f32 v21, v21, v83
  v_add_f32 v22, v22, v84
  v_add_f32 v23, v23, v85
  v_cvt_pk_bf16_f32 v38, v20, v21
  v_cvt_pk_bf16_f32 v39, v22, v23
  buffer_store_dwordx2 v[38:39], v6, s[52:55], s35 offen sc1
  v_cvt_pk_bf16_f32 v80, v24, v25
  v_cvt_pk_bf16_f32 v81, v26, v27
  v_lshlrev_b32 v24, 16, v80
  v_and_b32 v25, 0xffff0000, v80
  v_lshlrev_b32 v26, 16, v81
  v_and_b32 v27, 0xffff0000, v81
  v_lshlrev_b32 v82, 16, v40
  v_and_b32 v83, 0xffff0000, v40
  v_lshlrev_b32 v84, 16, v41
  v_and_b32 v85, 0xffff0000, v41
  v_add_f32 v24, v24, v82
  v_add_f32 v25, v25, v83
  v_add_f32 v26, v26, v84
  v_add_f32 v27, v27, v85
  v_cvt_pk_bf16_f32 v40, v24, v25
  v_cvt_pk_bf16_f32 v41, v26, v27
  buffer_store_dwordx2 v[40:41], v6, s[52:55], s36 offen sc1
outb2_exit1:
  s_endpgm
.section .rodata,"a"
.p2align 6
.amdhsa_kernel prep_kernel
  .amdhsa_next_free_vgpr 80
  .amdhsa_next_free_sgpr 64
  .amdhsa_accum_offset 80
  .amdhsa_group_segment_fixed_size 0
  .amdhsa_kernarg_size 104
  .amdhsa_user_sgpr_count 2
  .amdhsa_user_sgpr_kernarg_segment_ptr 1
  .amdhsa_system_sgpr_workgroup_id_x 1
  .amdhsa_float_denorm_mode_32 3
.end_amdhsa_kernel
.p2align 6
.amdhsa_kernel ln2_kernel
  .amdhsa_next_free_vgpr 80
  .amdhsa_next_free_sgpr 40
  .amdhsa_accum_offset 80
  .amdhsa_group_segment_fixed_size 0
  .amdhsa_kernarg_size 104
  .amdhsa_user_sgpr_count 2
  .amdhsa_user_sgpr_kernarg_segment_ptr 1
  .amdhsa_system_sgpr_workgroup_id_x 1
  .amdhsa_float_denorm_mode_32 3
.end_amdhsa_kernel
.p2align 6
.amdhsa_kernel reca_kernel
  .amdhsa_next_free_vgpr 512
  .amdhsa_next_free_sgpr 102
  .amdhsa_accum_offset 256
  .amdhsa_group_segment_fixed_size 0
  .amdhsa_kernarg_size 104
  .amdhsa_user_sgpr_count 2
  .amdhsa_user_sgpr_kernarg_segment_ptr 1
  .amdhsa_system_sgpr_workgroup_id_x 1
  .amdhsa_float_denorm_mode_32 3
.end_amdhsa_kernel
.p2align 6
.amdhsa_kernel fin_kernel
  .amdhsa_next_free_vgpr 496
  .amdhsa_next_free_sgpr 64
  .amdhsa_accum_offset 256
  .amdhsa_group_segment_fixed_size 0
  .amdhsa_kernarg_size 104
  .amdhsa_user_sgpr_count 2
  .amdhsa_user_sgpr_kernarg_segment_ptr 1
  .amdhsa_system_sgpr_workgroup_id_x 1
  .amdhsa_float_denorm_mode_32 3
.end_amdhsa_kernel
.p2align 6
.amdhsa_kernel redln1_kernel
  .amdhsa_next_free_vgpr 248
  .amdhsa_next_free_sgpr 48
  .amdhsa_accum_offset 248
  .amdhsa_group_segment_fixed_size 0
  .amdhsa_kernarg_size 104
  .amdhsa_user_sgpr_count 2
  .amdhsa_user_sgpr_kernarg_segment_ptr 1
  .amdhsa_system_sgpr_workgroup_id_x 1
  .amdhsa_float_denorm_mode_32 3
.end_amdhsa_kernel
.p2align 6
.amdhsa_kernel redln2_kernel
  .amdhsa_next_free_vgpr 248
  .amdhsa_next_free_sgpr 48
  .amdhsa_accum_offset 248
  .amdhsa_group_segment_fixed_size 0
  .amdhsa_kernarg_size 104
  .amdhsa_user_sgpr_count 2
  .amdhsa_user_sgpr_kernarg_segment_ptr 1
  .amdhsa_system_sgpr_workgroup_id_x 1
  .amdhsa_float_denorm_mode_32 3
.end_amdhsa_kernel
.p2align 6
.amdhsa_kernel qkvb_kernel
  .amdhsa_next_free_vgpr 448
  .amdhsa_next_free_sgpr 102
  .amdhsa_accum_offset 256
  .amdhsa_group_segment_fixed_size 0
  .amdhsa_kernarg_size 104
  .amdhsa_user_sgpr_count 2
  .amdhsa_user_sgpr_kernarg_segment_ptr 1
  .amdhsa_system_sgpr_workgroup_id_x 1
  .amdhsa_float_denorm_mode_32 3
.end_amdhsa_kernel
.p2align 6
.amdhsa_kernel attnb_kernel
  .amdhsa_next_free_vgpr 200
  .amdhsa_next_free_sgpr 48
  .amdhsa_accum_offset 200
  .amdhsa_group_segment_fixed_size 0
  .amdhsa_kernarg_size 104
  .amdhsa_user_sgpr_count 2
  .amdhsa_user_sgpr_kernarg_segment_ptr 1
  .amdhsa_system_sgpr_workgroup_id_x 1
  .amdhsa_float_denorm_mode_32 3
.end_amdhsa_kernel
.p2align 6
.amdhsa_kernel outb1_kernel
  .amdhsa_next_free_vgpr 128
  .amdhsa_next_free_sgpr 64
  .amdhsa_accum_offset 128
  .amdhsa_group_segment_fixed_size 0
  .amdhsa_kernarg_size 104
  .amdhsa_user_sgpr_count 2
  .amdhsa_user_sgpr_kernarg_segment_ptr 1
  .amdhsa_system_sgpr_workgroup_id_x 1
  .amdhsa_float_denorm_mode_32 3
.end_amdhsa_kernel
.p2align 6
.amdhsa_kernel outb2_kernel
  .amdhsa_next_free_vgpr 128
  .amdhsa_next_free_sgpr 64
  .amdhsa_accum_offset 128
  .amdhsa_group_segment_fixed_size 0
  .amdhsa_kernarg_size 104
  .amdhsa_user_sgpr_count 2
  .amdhsa_user_sgpr_kernarg_segment_ptr 1
  .amdhsa_system_sgpr_workgroup_id_x 1
  .amdhsa_float_denorm_mode_32 3
.end_amdhsa_kernel
```

```asm
; @launch kernel=prep_kernel grid=(2368,1,1) block=(256,1,1) lds=18944
; @launch kernel=reca_kernel grid=(256,1,1) block=(256,1,1) lds=81920
; @launch kernel=fin_kernel grid=(256,1,1) block=(256,1,1) lds=98304
; @launch kernel=redln1_kernel grid=(128,1,1) block=(256,1,1) lds=512
; @launch kernel=qkvb_kernel grid=(256,1,1) block=(256,1,1) lds=81920
; @launch kernel=attnb_kernel grid=(256,1,1) block=(256,1,1) lds=0
; @launch kernel=outb1_kernel grid=(256,1,1) block=(256,1,1) lds=61440
; @launch kernel=ln2_kernel grid=(128,1,1) block=(256,1,1) lds=512
; @launch kernel=reca_kernel grid=(256,1,1) block=(256,1,1) lds=81920
; @launch kernel=fin_kernel grid=(256,1,1) block=(256,1,1) lds=98304
; @launch kernel=redln2_kernel grid=(128,1,1) block=(256,1,1) lds=512
; @launch kernel=qkvb_kernel grid=(256,1,1) block=(256,1,1) lds=81920
; @launch kernel=attnb_kernel grid=(256,1,1) block=(256,1,1) lds=0
; @launch kernel=outb2_kernel grid=(256,1,1) block=(256,1,1) lds=61440
.amdgcn_target "amdgcn-amd-amdhsa--gfx950"
.text
.globl prep_kernel
.p2align 8
.type prep_kernel,@function
prep_kernel:
  s_cmp_ge_u32 s2, 128
  s_cbranch_scc1 prep_notln5
  s_load_dwordx2 s[12:13], s[0:1], 96
  s_load_dwordx2 s[14:15], s[0:1], 0
  v_lshrrev_b32 v2, 6, v0
  v_and_b32 v3, 63, v0
  s_nop 0
  v_readfirstlane_b32 s16, v2
  s_waitcnt lgkmcnt(0)
  s_mov_b32 s4, s12
  s_mov_b32 s5, s13
  s_mov_b32 s6, 0x10000000
  s_mov_b32 s7, 0x20000
  s_mov_b32 s8, s14
  s_mov_b32 s9, s15
  s_mov_b32 s10, 2621440
  s_mov_b32 s11, 0x20000
  s_mov_b32 s20, 0
  v_and_b32 v2, 15, v3
  v_lshrrev_b32 v4, 4, v3
  s_lshl_b32 s17, s2, 4
  v_add_u32 v1, s17, v2
  v_mul_u32_u24 v1, 1280, v1
  v_lshl_add_u32 v1, v4, 4, v1
  s_mul_i32 s17, s16, 320
  s_add_u32 s20, s20, s17
  buffer_load_dwordx4 v[8:11], v1, s[8:11], s20 offen offset:0
  buffer_load_dwordx4 v[12:15], v1, s[8:11], s20 offen offset:64
  buffer_load_dwordx4 v[16:19], v1, s[8:11], s20 offen offset:128
  buffer_load_dwordx4 v[20:23], v1, s[8:11], s20 offen offset:192
  buffer_load_dwordx4 v[24:27], v1, s[8:11], s20 offen offset:256
  s_sub_u32 s21, 0, s12
  s_and_b32 s21, s21, 0x1fffff
  s_add_u32 s21, s21, 2097152
  v_mov_b32 v68, -1
  v_mov_b32 v69, -1
  v_mov_b32 v70, -1
  v_mov_b32 v71, -1
  v_lshlrev_b32 v72, 4, v0
  s_mul_i32 s22, s2, 12096
  s_add_u32 s22, s22, 0
  s_mul_i32 s23, s2, 12288
  s_add_u32 s23, s23, s21
  buffer_store_dwordx4 v[68:71], v72, s[4:7], s22 offen sc1
  s_add_u32 s22, s22, 4096
  buffer_store_dwordx4 v[68:71], v72, s[4:7], s22 offen sc1
  s_add_u32 s22, s22, 4096
  v_mov_b32 v73, 0x80000000
  v_cmp_gt_u32 vcc, 244, v0
  s_nop 1
  v_cndmask_b32 v73, v73, v72, vcc
  buffer_store_dwordx4 v[68:71], v73, s[4:7], s22 offen
  buffer_store_dwordx4 v[68:71], v72, s[4:7], s23 offen sc1
  s_add_u32 s23, s23, 4096
  buffer_store_dwordx4 v[68:71], v72, s[4:7], s23 offen sc1
  s_add_u32 s23, s23, 4096
  buffer_store_dwordx4 v[68:71], v72, s[4:7], s23 offen sc1
  s_add_u32 s23, s23, 4096
  s_mul_i32 s23, s2, 2048
  s_add_u32 s23, s23, s21
  s_add_u32 s23, s23, 1572864
  v_mov_b32 v73, 0x80000000
  v_cmp_gt_u32 vcc, 128, v0
  s_nop 1
  v_cndmask_b32 v73, v73, v72, vcc
  buffer_store_dwordx4 v[68:71], v73, s[4:7], s23 offen sc1
  s_waitcnt vmcnt(7)
  s_mul_i32 s17, s16, 320
  s_add_u32 s17, s17, 82313216
  buffer_store_dwordx4 v[8:11], v1, s[4:7], s17 offen offset:0
  buffer_store_dwordx4 v[12:15], v1, s[4:7], s17 offen offset:64
  buffer_store_dwordx4 v[16:19], v1, s[4:7], s17 offen offset:128
  buffer_store_dwordx4 v[20:23], v1, s[4:7], s17 offen offset:192
  buffer_store_dwordx4 v[24:27], v1, s[4:7], s17 offen offset:256
  v_lshlrev_b32 v5, 2, v2
  s_lshl_b32 s17, s16, 6
  v_add_u32 v1, s17, v5
  s_waitcnt vmcnt(5)
  v_lshlrev_b32 v28, 16, v8
  v_and_b32 v29, 0xffff0000, v8
  v_lshlrev_b32 v30, 16, v9
  v_and_b32 v31, 0xffff0000, v9
  v_lshlrev_b32 v32, 16, v10
  v_and_b32 v33, 0xffff0000, v10
  v_lshlrev_b32 v34, 16, v11
  v_and_b32 v35, 0xffff0000, v11
  v_lshlrev_b32 v36, 16, v12
  v_and_b32 v37, 0xffff0000, v12
  v_lshlrev_b32 v38, 16, v13
  v_and_b32 v39, 0xffff0000, v13
  v_lshlrev_b32 v40, 16, v14
  v_and_b32 v41, 0xffff0000, v14
  v_lshlrev_b32 v42, 16, v15
  v_and_b32 v43, 0xffff0000, v15
  v_lshlrev_b32 v44, 16, v16
  v_and_b32 v45, 0xffff0000, v16
  v_lshlrev_b32 v46, 16, v17
  v_and_b32 v47, 0xffff0000, v17
  v_lshlrev_b32 v48, 16, v18
  v_and_b32 v49, 0xffff0000, v18
  v_lshlrev_b32 v50, 16, v19
  v_and_b32 v51, 0xffff0000, v19
  v_lshlrev_b32 v52, 16, v20
  v_and_b32 v53, 0xffff0000, v20
  v_lshlrev_b32 v54, 16, v21
  v_and_b32 v55, 0xffff0000, v21
  v_lshlrev_b32 v56, 16, v22
  v_and_b32 v57, 0xffff0000, v22
  v_lshlrev_b32 v58, 16, v23
  v_and_b32 v59, 0xffff0000, v23
  v_lshlrev_b32 v60, 16, v24
  v_and_b32 v61, 0xffff0000, v24
  v_lshlrev_b32 v62, 16, v25
  v_and_b32 v63, 0xffff0000, v25
  v_lshlrev_b32 v64, 16, v26
  v_and_b32 v65, 0xffff0000, v26
  v_lshlrev_b32 v66, 16, v27
  v_and_b32 v67, 0xffff0000, v27
  v_pk_add_f32 v[6:7], v[28:29], v[30:31]
  v_pk_add_f32 v[6:7], v[6:7], v[32:33]
  v_pk_add_f32 v[6:7], v[6:7], v[34:35]
  v_pk_add_f32 v[6:7], v[6:7], v[36:37]
  v_pk_add_f32 v[6:7], v[6:7], v[38:39]
  v_pk_add_f32 v[6:7], v[6:7], v[40:41]
  v_pk_add_f32 v[6:7], v[6:7], v[42:43]
  v_pk_add_f32 v[6:7], v[6:7], v[44:45]
  v_pk_add_f32 v[6:7], v[6:7], v[46:47]
  v_pk_add_f32 v[6:7], v[6:7], v[48:49]
  v_pk_add_f32 v[6:7], v[6:7], v[50:51]
  v_pk_add_f32 v[6:7], v[6:7], v[52:53]
  v_pk_add_f32 v[6:7], v[6:7], v[54:55]
  v_pk_add_f32 v[6:7], v[6:7], v[56:57]
  v_pk_add_f32 v[6:7], v[6:7], v[58:59]
  v_pk_add_f32 v[6:7], v[6:7], v[60:61]
  v_pk_add_f32 v[6:7], v[6:7], v[62:63]
  v_pk_add_f32 v[6:7], v[6:7], v[64:65]
  v_pk_add_f32 v[6:7], v[6:7], v[66:67]
  v_add_f32 v4, v6, v7
  v_mov_b32 v2, v4
  s_nop 1
  v_permlane32_swap_b32 v4, v2
  v_add_f32 v4, v4, v2
  v_mov_b32 v2, v4
  s_nop 1
  v_permlane16_swap_b32 v4, v2
  v_add_f32 v4, v4, v2
  ds_write_b32 v1, v4 offset:0
  s_waitcnt lgkmcnt(0)
  s_barrier
  ds_read_b32 v4, v5 offset:0
  ds_read_b32 v2, v5 offset:64
  ds_read_b32 v3, v5 offset:128
  ds_read_b32 v6, v5 offset:192
  s_waitcnt lgkmcnt(0)
  v_add_f32 v4, v4, v2
  v_add_f32 v3, v3, v6
  v_add_f32 v4, v4, v3
  v_mul_f32 v4, 0x3acccccd, v4
  v_sub_f32 v28, v28, v4
  v_sub_f32 v29, v29, v4
  v_sub_f32 v30, v30, v4
  v_sub_f32 v31, v31, v4
  v_sub_f32 v32, v32, v4
  v_sub_f32 v33, v33, v4
  v_sub_f32 v34, v34, v4
  v_sub_f32 v35, v35, v4
  v_sub_f32 v36, v36, v4
  v_sub_f32 v37, v37, v4
  v_sub_f32 v38, v38, v4
  v_sub_f32 v39, v39, v4
  v_sub_f32 v40, v40, v4
  v_sub_f32 v41, v41, v4
  v_sub_f32 v42, v42, v4
  v_sub_f32 v43, v43, v4
  v_sub_f32 v44, v44, v4
  v_sub_f32 v45, v45, v4
  v_sub_f32 v46, v46, v4
  v_sub_f32 v47, v47, v4
  v_sub_f32 v48, v48, v4
  v_sub_f32 v49, v49, v4
  v_sub_f32 v50, v50, v4
  v_sub_f32 v51, v51, v4
  v_sub_f32 v52, v52, v4
  v_sub_f32 v53, v53, v4
  v_sub_f32 v54, v54, v4
  v_sub_f32 v55, v55, v4
  v_sub_f32 v56, v56, v4
  v_sub_f32 v57, v57, v4
  v_sub_f32 v58, v58, v4
  v_sub_f32 v59, v59, v4
  v_sub_f32 v60, v60, v4
  v_sub_f32 v61, v61, v4
  v_sub_f32 v62, v62, v4
  v_sub_f32 v63, v63, v4
  v_sub_f32 v64, v64, v4
  v_sub_f32 v65, v65, v4
  v_sub_f32 v66, v66, v4
  v_sub_f32 v67, v67, v4
  v_mul_f32 v6, v28, v28
  v_mul_f32 v7, v29, v29
  v_fmac_f32 v6, v30, v30
  v_fmac_f32 v7, v31, v31
  v_fmac_f32 v6, v32, v32
  v_fmac_f32 v7, v33, v33
  v_fmac_f32 v6, v34, v34
  v_fmac_f32 v7, v35, v35
  v_fmac_f32 v6, v36, v36
  v_fmac_f32 v7, v37, v37
  v_fmac_f32 v6, v38, v38
  v_fmac_f32 v7, v39, v39
  v_fmac_f32 v6, v40, v40
  v_fmac_f32 v7, v41, v41
  v_fmac_f32 v6, v42, v42
  v_fmac_f32 v7, v43, v43
  v_fmac_f32 v6, v44, v44
  v_fmac_f32 v7, v45, v45
  v_fmac_f32 v6, v46, v46
  v_fmac_f32 v7, v47, v47
  v_fmac_f32 v6, v48, v48
  v_fmac_f32 v7, v49, v49
  v_fmac_f32 v6, v50, v50
  v_fmac_f32 v7, v51, v51
  v_fmac_f32 v6, v52, v52
  v_fmac_f32 v7, v53, v53
  v_fmac_f32 v6, v54, v54
  v_fmac_f32 v7, v55, v55
  v_fmac_f32 v6, v56, v56
  v_fmac_f32 v7, v57, v57
  v_fmac_f32 v6, v58, v58
  v_fmac_f32 v7, v59, v59
  v_fmac_f32 v6, v60, v60
  v_fmac_f32 v7, v61, v61
  v_fmac_f32 v6, v62, v62
  v_fmac_f32 v7, v63, v63
  v_fmac_f32 v6, v64, v64
  v_fmac_f32 v7, v65, v65
  v_fmac_f32 v6, v66, v66
  v_fmac_f32 v7, v67, v67
  v_add_f32 v4, v6, v7
  v_mov_b32 v2, v4
  s_nop 1
  v_permlane32_swap_b32 v4, v2
  v_add_f32 v4, v4, v2
  v_mov_b32 v2, v4
  s_nop 1
  v_permlane16_swap_b32 v4, v2
  v_add_f32 v4, v4, v2
  ds_write_b32 v1, v4 offset:256
  s_waitcnt lgkmcnt(0)
  s_barrier
  ds_read_b32 v4, v5 offset:256
  ds_read_b32 v2, v5 offset:320
  ds_read_b32 v3, v5 offset:384
  ds_read_b32 v6, v5 offset:448
  s_waitcnt lgkmcnt(0)
  v_add_f32 v4, v4, v2
  v_add_f32 v3, v3, v6
  v_add_f32 v4, v4, v3
  v_mov_b32 v2, 0x3727c5ac
  v_fmac_f32 v2, 0x3acccccd, v4
  v_rsq_f32 v4, v2
  s_nop 0
  v_mul_f32 v28, v28, v4
  v_mul_f32 v29, v29, v4
  v_mul_f32 v30, v30, v4
  v_mul_f32 v31, v31, v4
  v_mul_f32 v32, v32, v4
  v_mul_f32 v33, v33, v4
  v_mul_f32 v34, v34, v4
  v_mul_f32 v35, v35, v4
  v_mul_f32 v36, v36, v4
  v_mul_f32 v37, v37, v4
  v_mul_f32 v38, v38, v4
  v_mul_f32 v39, v39, v4
  v_mul_f32 v40, v40, v4
  v_mul_f32 v41, v41, v4
  v_mul_f32 v42, v42, v4
  v_mul_f32 v43, v43, v4
  v_mul_f32 v44, v44, v4
  v_mul_f32 v45, v45, v4
  v_mul_f32 v46, v46, v4
  v_mul_f32 v47, v47, v4
  v_mul_f32 v48, v48, v4
  v_mul_f32 v49, v49, v4
  v_mul_f32 v50, v50, v4
  v_mul_f32 v51, v51, v4
  v_mul_f32 v52, v52, v4
  v_mul_f32 v53, v53, v4
  v_mul_f32 v54, v54, v4
  v_mul_f32 v55, v55, v4
  v_mul_f32 v56, v56, v4
  v_mul_f32 v57, v57, v4
  v_mul_f32 v58, v58, v4
  v_mul_f32 v59, v59, v4
  v_mul_f32 v60, v60, v4
  v_mul_f32 v61, v61, v4
  v_mul_f32 v62, v62, v4
  v_mul_f32 v63, v63, v4
  v_mul_f32 v64, v64, v4
  v_mul_f32 v65, v65, v4
  v_mul_f32 v66, v66, v4
  v_mul_f32 v67, v67, v4
  v_cvt_pk_bf16_f32 v8, v28, v29
  v_cvt_pk_bf16_f32 v9, v30, v31
  v_cvt_pk_bf16_f32 v10, v32, v33
  v_cvt_pk_bf16_f32 v11, v34, v35
  v_cvt_pk_bf16_f32 v12, v36, v37
  v_cvt_pk_bf16_f32 v13, v38, v39
  v_cvt_pk_bf16_f32 v14, v40, v41
  v_cvt_pk_bf16_f32 v15, v42, v43
  v_cvt_pk_bf16_f32 v16, v44, v45
  v_cvt_pk_bf16_f32 v17, v46, v47
  v_cvt_pk_bf16_f32 v18, v48, v49
  v_cvt_pk_bf16_f32 v19, v50, v51
  v_cvt_pk_bf16_f32 v20, v52, v53
  v_cvt_pk_bf16_f32 v21, v54, v55
  v_cvt_pk_bf16_f32 v22, v56, v57
  v_cvt_pk_bf16_f32 v23, v58, v59
  v_cvt_pk_bf16_f32 v24, v60, v61
  v_cvt_pk_bf16_f32 v25, v62, v63
  v_cvt_pk_bf16_f32 v26, v64, v65
  v_cvt_pk_bf16_f32 v27, v66, v67
  v_and_b32 v3, 63, v0
  v_lshlrev_b32 v1, 4, v3
  s_mul_i32 s17, s2, 20480
  s_mul_i32 s18, s16, 5120
  s_add_u32 s17, s17, s18
  s_add_u32 s17, s17, 84934656
  buffer_store_dwordx4 v[8:11], v1, s[4:7], s17 offen offset:0 sc1
  buffer_store_dwordx4 v[12:15], v1, s[4:7], s17 offen offset:1024 sc1
  buffer_store_dwordx4 v[16:19], v1, s[4:7], s17 offen offset:2048 sc1
  buffer_store_dwordx4 v[20:23], v1, s[4:7], s17 offen offset:3072 sc1
  s_add_u32 s17, s17, 4096
  buffer_store_dwordx4 v[24:27], v1, s[4:7], s17 offen offset:0 sc1
  s_endpgm
prep_notln5:
  s_sub_u32 s2, s2, 128
  s_cmp_ge_u32 s2, 2240
  s_cbranch_scc1 prep_exit1
  s_load_dwordx2 s[12:13], s[0:1], 96
  s_load_dwordx4 s[16:19], s[0:1], 16
  s_load_dwordx4 s[20:23], s[0:1], 32
  s_load_dwordx4 s[24:27], s[0:1], 64
  v_lshrrev_b32 v6, 6, v0
  v_and_b32 v1, 63, v0
  s_nop 0
  v_readfirstlane_b32 s14, v6
  v_lshlrev_b32 v5, 4, v1
  s_lshl_b32 s15, s2, 2
  s_nop 1
  s_add_u32 s15, s15, s14
  s_add_u32 s28, s15, 7680
  s_sub_u32 s29, s15, 1280
  s_cmp_lt_u32 s15, 1280
  s_cselect_b32 s15, s28, s29
  s_waitcnt lgkmcnt(0)
  s_mov_b32 s4, s12
  s_mov_b32 s5, s13
  s_mov_b32 s6, 0x10000000
  s_mov_b32 s7, 0x20000
  s_mov_b32 s11, 0x20000
  v_and_b32 v2, 15, v1
  v_lshrrev_b32 v3, 4, v1
  s_cmp_ge_u32 s15, 5760
  s_cbranch_scc1 prep_s22
  s_mul_hi_u32 s31, s15, 2236963
  s_mul_i32 s32, s31, 1920
  s_sub_u32 s32, s15, s32
  s_mul_hi_u32 s33, s32, 214748365
  s_mul_i32 s34, s33, 20
  s_sub_u32 s34, s32, s34
  s_cmp_eq_u32 s31, 0
  s_cselect_b32 s8, s16, s18
  s_cselect_b32 s9, s17, s19
  s_cmp_eq_u32 s31, 2
  s_cselect_b32 s8, s20, s8
  s_cselect_b32 s9, s21, s9
  s_mov_b32 s10, 7864320
  s_mul_i32 s35, s31, 7864320
  s_add_u32 s35, s35, 6291456
  v_lshrrev_b32 v6, 3, v1
  s_lshl_b32 s36, s34, 5
  v_add_u32 v6, s36, v6
  s_mov_b32 s37, 12288
  v_mul_lo_u32 v4, v6, s37
  s_lshl_b32 s36, s33, 7
  v_and_b32 v6, 7, v1
  v_lshl_add_u32 v4, v6, 4, v4
  v_add_u32 v4, s36, v4
  v_lshrrev_b32 v6, 3, v1
  v_mul_u32_u24 v12, 144, v6
  v_and_b32 v6, 7, v1
  v_lshl_add_u32 v12, v6, 4, v12
  s_mul_i32 s36, s14, 4608
  s_add_u32 s36, s36, 512
  v_add_u32 v12, s36, v12
  s_mov_b32 s29, 0
  buffer_load_dwordx4 v[16:19], v4, s[8:11], s29 offen
  s_mov_b32 s29, 98304
  buffer_load_dwordx4 v[20:23], v4, s[8:11], s29 offen
  s_mov_b32 s29, 196608
  buffer_load_dwordx4 v[24:27], v4, s[8:11], s29 offen
  s_mov_b32 s29, 294912
  buffer_load_dwordx4 v[28:31], v4, s[8:11], s29 offen
  v_bfe_u32 v6, v1, 2, 2
  v_lshlrev_b32 v13, 3, v3
  v_add_u32 v13, v13, v6
  v_mul_u32_u24 v13, 144, v13
  v_and_b32 v6, 3, v1
  v_lshl_add_u32 v13, v6, 3, v13
  v_add_u32 v13, s36, v13
  s_waitcnt vmcnt(3)
  ds_write_b128 v12, v[16:19] offset:0
  s_waitcnt vmcnt(2)
  ds_write_b128 v12, v[20:23] offset:1152
  s_waitcnt vmcnt(1)
  ds_write_b128 v12, v[24:27] offset:2304
  s_waitcnt vmcnt(0)
  ds_write_b128 v12, v[28:31] offset:3456
  s_waitcnt lgkmcnt(0)
  ds_read_b64_tr_b16 v[48:49], v13 offset:0
  ds_read_b64_tr_b16 v[50:51], v13 offset:576
  ds_read_b64_tr_b16 v[52:53], v13 offset:32
  ds_read_b64_tr_b16 v[54:55], v13 offset:608
  ds_read_b64_tr_b16 v[56:57], v13 offset:64
  ds_read_b64_tr_b16 v[58:59], v13 offset:640
  ds_read_b64_tr_b16 v[60:61], v13 offset:96
  ds_read_b64_tr_b16 v[62:63], v13 offset:672
  s_waitcnt lgkmcnt(6)
  s_lshl_b32 s30, s33, 2
  s_add_u32 s30, s30, 0
  s_mul_i32 s30, s30, 20
  s_add_u32 s30, s30, s34
  s_lshl_b32 s30, s30, 10
  s_add_u32 s30, s30, s35
  buffer_store_dwordx4 v[48:51], v5, s[4:7], s30 offen sc1
  s_waitcnt lgkmcnt(4)
  s_lshl_b32 s30, s33, 2
  s_add_u32 s30, s30, 1
  s_mul_i32 s30, s30, 20
  s_add_u32 s30, s30, s34
  s_lshl_b32 s30, s30, 10
  s_add_u32 s30, s30, s35
  buffer_store_dwordx4 v[52:55], v5, s[4:7], s30 offen sc1
  s_waitcnt lgkmcnt(2)
  s_lshl_b32 s30, s33, 2
  s_add_u32 s30, s30, 2
  s_mul_i32 s30, s30, 20
  s_add_u32 s30, s30, s34
  s_lshl_b32 s30, s30, 10
  s_add_u32 s30, s30, s35
  buffer_store_dwordx4 v[56:59], v5, s[4:7], s30 offen sc1
  s_waitcnt lgkmcnt(0)
  s_lshl_b32 s30, s33, 2
  s_add_u32 s30, s30, 3
  s_mul_i32 s30, s30, 20
  s_add_u32 s30, s30, s34
  s_lshl_b32 s30, s30, 10
  s_add_u32 s30, s30, s35
  buffer_store_dwordx4 v[60:63], v5, s[4:7], s30 offen sc1
  s_branch prep_exit1
prep_s22:
  s_sub_u32 s15, s15, 5760
  s_cmp_ge_u32 s15, 1920
  s_cbranch_scc1 prep_s33
  s_mul_hi_u32 s33, s15, 22369622
  s_mul_i32 s34, s33, 192
  s_sub_u32 s34, s15, s34
  s_mov_b32 s8, s22
  s_mov_b32 s9, s23
  s_mov_b32 s10, 7864320
  v_lshrrev_b32 v6, 3, v1
  s_lshl_b32 s36, s34, 5
  v_add_u32 v6, s36, v6
  v_mul_u32_u24 v4, 1280, v6
  s_lshl_b32 s36, s33, 7
  v_and_b32 v6, 7, v1
  v_lshl_add_u32 v4, v6, 4, v4
  v_add_u32 v4, s36, v4
  v_lshrrev_b32 v6, 3, v1
  v_mul_u32_u24 v12, 144, v6
  v_and_b32 v6, 7, v1
  v_lshl_add_u32 v12, v6, 4, v12
  s_mul_i32 s36, s14, 4608
  s_add_u32 s36, s36, 512
  v_add_u32 v12, s36, v12
  s_mov_b32 s29, 0
  buffer_load_dwordx4 v[16:19], v4, s[8:11], s29 offen
  s_mov_b32 s29, 10240
  buffer_load_dwordx4 v[20:23], v4, s[8:11], s29 offen
  s_mov_b32 s29, 20480
  buffer_load_dwordx4 v[24:27], v4, s[8:11], s29 offen
  s_mov_b32 s29, 30720
  buffer_load_dwordx4 v[28:31], v4, s[8:11], s29 offen
  v_bfe_u32 v6, v1, 2, 2
  v_lshlrev_b32 v13, 2, v3
  v_add_u32 v13, v13, v6
  v_mul_u32_u24 v13, 144, v13
  v_and_b32 v6, 3, v1
  v_lshl_add_u32 v13, v6, 4, v13
  v_add_u32 v13, s36, v13
  s_waitcnt vmcnt(3)
  ds_write_b128 v12, v[16:19] offset:0
  s_waitcnt vmcnt(2)
  ds_write_b128 v12, v[20:23] offset:1152
  s_waitcnt vmcnt(1)
  ds_write_b128 v12, v[24:27] offset:2304
  s_waitcnt vmcnt(0)
  ds_write_b128 v12, v[28:31] offset:3456
  s_waitcnt lgkmcnt(0)
  ds_read_b64_tr_b16 v[48:49], v13 offset:0
  ds_read_b64_tr_b16 v[50:51], v13 offset:2304
  ds_read_b64_tr_b16 v[52:53], v13 offset:8
  ds_read_b64_tr_b16 v[54:55], v13 offset:2312
  ds_read_b64_tr_b16 v[56:57], v13 offset:64
  ds_read_b64_tr_b16 v[58:59], v13 offset:2368
  ds_read_b64_tr_b16 v[60:61], v13 offset:72
  ds_read_b64_tr_b16 v[62:63], v13 offset:2376
  s_waitcnt lgkmcnt(6)
  s_lshl_b32 s30, s33, 2
  s_add_u32 s30, s30, 0
  s_mul_i32 s30, s30, 192
  s_add_u32 s30, s30, s34
  s_lshl_b32 s30, s30, 10
  s_add_u32 s30, s30, 29884416
  buffer_store_dwordx4 v[48:51], v5, s[4:7], s30 offen sc1
  s_waitcnt lgkmcnt(4)
  s_lshl_b32 s30, s33, 2
  s_add_u32 s30, s30, 1
  s_mul_i32 s30, s30, 192
  s_add_u32 s30, s30, s34
  s_lshl_b32 s30, s30, 10
  s_add_u32 s30, s30, 29884416
  buffer_store_dwordx4 v[52:55], v5, s[4:7], s30 offen sc1
  s_waitcnt lgkmcnt(2)
  s_lshl_b32 s30, s33, 2
  s_add_u32 s30, s30, 2
  s_mul_i32 s30, s30, 192
  s_add_u32 s30, s30, s34
  s_lshl_b32 s30, s30, 10
  s_add_u32 s30, s30, 29884416
  buffer_store_dwordx4 v[56:59], v5, s[4:7], s30 offen sc1
  s_waitcnt lgkmcnt(0)
  s_lshl_b32 s30, s33, 2
  s_add_u32 s30, s30, 3
  s_mul_i32 s30, s30, 192
  s_add_u32 s30, s30, s34
  s_lshl_b32 s30, s30, 10
  s_add_u32 s30, s30, 29884416
  buffer_store_dwordx4 v[60:63], v5, s[4:7], s30 offen sc1
  s_branch prep_exit1
prep_s33:
  s_sub_u32 s15, s15, 1920
  s_cmp_ge_u32 s15, 960
  s_cbranch_scc1 prep_s44
  s_mul_hi_u32 s33, s15, 107374183
  s_mul_i32 s34, s33, 40
  s_sub_u32 s34, s15, s34
  s_mov_b32 s8, s24
  s_mov_b32 s9, s25
  s_mov_b32 s10, 2457600
  v_lshrrev_b32 v6, 5, v1
  v_lshlrev_b32 v6, 3, v6
  s_lshl_b32 s36, s34, 4
  v_add_u32 v6, s36, v6
  v_mul_u32_u24 v4, 3840, v6
  v_and_b32 v6, 31, v1
  v_lshl_add_u32 v4, v6, 1, v4
  s_mul_i32 s36, s33, 160
  v_add_u32 v4, s36, v4
  v_cmp_gt_u32 vcc, 20, v6
  v_mov_b32 v6, 0x80000000
  s_nop 0
  v_cndmask_b32 v4, v6, v4, vcc
  s_mov_b32 s29, 0
  buffer_load_ushort v16, v4, s[8:11], s29 offen
  s_mov_b32 s29, 3840
  buffer_load_ushort v17, v4, s[8:11], s29 offen
  s_mov_b32 s29, 7680
  buffer_load_ushort v18, v4, s[8:11], s29 offen
  s_mov_b32 s29, 11520
  buffer_load_ushort v19, v4, s[8:11], s29 offen
  s_mov_b32 s29, 15360
  buffer_load_ushort v20, v4, s[8:11], s29 offen
  s_mov_b32 s29, 19200
  buffer_load_ushort v21, v4, s[8:11], s29 offen
  s_mov_b32 s29, 23040
  buffer_load_ushort v22, v4, s[8:11], s29 offen
  s_mov_b32 s29, 26880
  buffer_load_ushort v23, v4, s[8:11], s29 offen
  s_mov_b32 s29, 40
  buffer_load_ushort v24, v4, s[8:11], s29 offen
  s_mov_b32 s29, 3880
  buffer_load_ushort v25, v4, s[8:11], s29 offen
  s_mov_b32 s29, 7720
  buffer_load_ushort v26, v4, s[8:11], s29 offen
  s_mov_b32 s29, 11560
  buffer_load_ushort v27, v4, s[8:11], s29 offen
  s_mov_b32 s29, 15400
  buffer_load_ushort v28, v4, s[8:11], s29 offen
  s_mov_b32 s29, 19240
  buffer_load_ushort v29, v4, s[8:11], s29 offen
  s_mov_b32 s29, 23080
  buffer_load_ushort v30, v4, s[8:11], s29 offen
  s_mov_b32 s29, 26920
  buffer_load_ushort v31, v4, s[8:11], s29 offen
  s_mov_b32 s29, 80
  buffer_load_ushort v32, v4, s[8:11], s29 offen
  s_mov_b32 s29, 3920
  buffer_load_ushort v33, v4, s[8:11], s29 offen
  s_mov_b32 s29, 7760
  buffer_load_ushort v34, v4, s[8:11], s29 offen
  s_mov_b32 s29, 11600
  buffer_load_ushort v35, v4, s[8:11], s29 offen
  s_mov_b32 s29, 15440
  buffer_load_ushort v36, v4, s[8:11], s29 offen
  s_mov_b32 s29, 19280
  buffer_load_ushort v37, v4, s[8:11], s29 offen
  s_mov_b32 s29, 23120
  buffer_load_ushort v38, v4, s[8:11], s29 offen
  s_mov_b32 s29, 26960
  buffer_load_ushort v39, v4, s[8:11], s29 offen
  s_mov_b32 s29, 120
  buffer_load_ushort v40, v4, s[8:11], s29 offen
  s_mov_b32 s29, 3960
  buffer_load_ushort v41, v4, s[8:11], s29 offen
  s_mov_b32 s29, 7800
  buffer_load_ushort v42, v4, s[8:11], s29 offen
  s_mov_b32 s29, 11640
  buffer_load_ushort v43, v4, s[8:11], s29 offen
  s_mov_b32 s29, 15480
  buffer_load_ushort v44, v4, s[8:11], s29 offen
  s_mov_b32 s29, 19320
  buffer_load_ushort v45, v4, s[8:11], s29 offen
  s_mov_b32 s29, 23160
  buffer_load_ushort v46, v4, s[8:11], s29 offen
  s_mov_b32 s29, 27000
  buffer_load_ushort v47, v4, s[8:11], s29 offen
  s_waitcnt vmcnt(24)
  v_lshl_or_b32 v48, v17, 16, v16
  v_lshl_or_b32 v49, v19, 16, v18
  v_lshl_or_b32 v50, v21, 16, v20
  v_lshl_or_b32 v51, v23, 16, v22
  s_lshl_b32 s30, s33, 2
  s_add_u32 s30, s30, 0
  s_mul_i32 s30, s30, 40
  s_add_u32 s30, s30, s34
  s_lshl_b32 s30, s30, 10
  s_add_u32 s30, s30, 87556096
  buffer_store_dwordx4 v[48:51], v5, s[4:7], s30 offen sc1
  s_waitcnt vmcnt(17)
  v_lshl_or_b32 v52, v25, 16, v24
  v_lshl_or_b32 v53, v27, 16, v26
  v_lshl_or_b32 v54, v29, 16, v28
  v_lshl_or_b32 v55, v31, 16, v30
  s_lshl_b32 s30, s33, 2
  s_add_u32 s30, s30, 1
  s_mul_i32 s30, s30, 40
  s_add_u32 s30, s30, s34
  s_lshl_b32 s30, s30, 10
  s_add_u32 s30, s30, 87556096
  buffer_store_dwordx4 v[52:55], v5, s[4:7], s30 offen sc1
  s_waitcnt vmcnt(10)
  v_lshl_or_b32 v56, v33, 16, v32
  v_lshl_or_b32 v57, v35, 16, v34
  v_lshl_or_b32 v58, v37, 16, v36
  v_lshl_or_b32 v59, v39, 16, v38
  s_lshl_b32 s30, s33, 2
  s_add_u32 s30, s30, 2
  s_mul_i32 s30, s30, 40
  s_add_u32 s30, s30, s34
  s_lshl_b32 s30, s30, 10
  s_add_u32 s30, s30, 87556096
  buffer_store_dwordx4 v[56:59], v5, s[4:7], s30 offen sc1
  s_waitcnt vmcnt(3)
  v_lshl_or_b32 v60, v41, 16, v40
  v_lshl_or_b32 v61, v43, 16, v42
  v_lshl_or_b32 v62, v45, 16, v44
  v_lshl_or_b32 v63, v47, 16, v46
  s_lshl_b32 s30, s33, 2
  s_add_u32 s30, s30, 3
  s_mul_i32 s30, s30, 40
  s_add_u32 s30, s30, s34
  s_lshl_b32 s30, s30, 10
  s_add_u32 s30, s30, 87556096
  buffer_store_dwordx4 v[60:63], v5, s[4:7], s30 offen sc1
  s_branch prep_exit1
prep_s44:
  s_sub_u32 s15, s15, 960
  s_mul_hi_u32 s33, s15, 134217728
  s_and_b32 s34, s15, 31
  s_lshr_b32 s33, s15, 5
  s_mov_b32 s8, s26
  s_mov_b32 s9, s27
  s_mov_b32 s10, 819200
  v_lshrrev_b32 v6, 1, v3
  v_lshlrev_b32 v6, 4, v6
  v_and_b32 v7, 1, v3
  v_lshl_add_u32 v6, v7, 2, v6
  v_mov_b32 v8, v6
  s_mul_i32 s36, s34, 20
  v_add_u32 v6, s36, v6
  v_mul_u32_u24 v4, 1280, v6
  v_lshrrev_b32 v6, 2, v2
  v_lshl_add_u32 v4, v6, 4, v4
  v_and_b32 v6, 3, v2
  v_lshl_add_u32 v4, v6, 1, v4
  s_lshl_b32 s36, s33, 7
  v_add_u32 v4, s36, v4
  v_mov_b32 v9, 0x80000000
  v_cmp_gt_u32 vcc, 17, v8
  s_nop 1
  v_cndmask_b32 v10, v9, v4, vcc
  v_cmp_gt_u32 vcc, 9, v8
  s_nop 1
  v_cndmask_b32 v11, v9, v4, vcc
  s_mov_b32 s29, 0
  buffer_load_ushort v16, v10, s[8:11], s29 offen
  s_mov_b32 s29, 1280
  buffer_load_ushort v17, v10, s[8:11], s29 offen
  s_mov_b32 s29, 2560
  buffer_load_ushort v18, v10, s[8:11], s29 offen
  s_mov_b32 s29, 3840
  buffer_load_ushort v19, v10, s[8:11], s29 offen
  s_mov_b32 s29, 10240
  buffer_load_ushort v20, v11, s[8:11], s29 offen
  s_mov_b32 s29, 11520
  buffer_load_ushort v21, v11, s[8:11], s29 offen
  s_mov_b32 s29, 12800
  buffer_load_ushort v22, v11, s[8:11], s29 offen
  s_mov_b32 s29, 14080
  buffer_load_ushort v23, v11, s[8:11], s29 offen
  s_mov_b32 s29, 8
  buffer_load_ushort v24, v10, s[8:11], s29 offen
  s_mov_b32 s29, 1288
  buffer_load_ushort v25, v10, s[8:11], s29 offen
  s_mov_b32 s29, 2568
  buffer_load_ushort v26, v10, s[8:11], s29 offen
  s_mov_b32 s29, 3848
  buffer_load_ushort v27, v10, s[8:11], s29 offen
  s_mov_b32 s29, 10248
  buffer_load_ushort v28, v11, s[8:11], s29 offen
  s_mov_b32 s29, 11528
  buffer_load_ushort v29, v11, s[8:11], s29 offen
  s_mov_b32 s29, 12808
  buffer_load_ushort v30, v11, s[8:11], s29 offen
  s_mov_b32 s29, 14088
  buffer_load_ushort v31, v11, s[8:11], s29 offen
  s_mov_b32 s29, 64
  buffer_load_ushort v32, v10, s[8:11], s29 offen
  s_mov_b32 s29, 1344
  buffer_load_ushort v33, v10, s[8:11], s29 offen
  s_mov_b32 s29, 2624
  buffer_load_ushort v34, v10, s[8:11], s29 offen
  s_mov_b32 s29, 3904
  buffer_load_ushort v35, v10, s[8:11], s29 offen
  s_mov_b32 s29, 10304
  buffer_load_ushort v36, v11, s[8:11], s29 offen
  s_mov_b32 s29, 11584
  buffer_load_ushort v37, v11, s[8:11], s29 offen
  s_mov_b32 s29, 12864
  buffer_load_ushort v38, v11, s[8:11], s29 offen
  s_mov_b32 s29, 14144
  buffer_load_ushort v39, v11, s[8:11], s29 offen
  s_mov_b32 s29, 72
  buffer_load_ushort v40, v10, s[8:11], s29 offen
  s_mov_b32 s29, 1352
  buffer_load_ushort v41, v10, s[8:11], s29 offen
  s_mov_b32 s29, 2632
  buffer_load_ushort v42, v10, s[8:11], s29 offen
  s_mov_b32 s29, 3912
  buffer_load_ushort v43, v10, s[8:11], s29 offen
  s_mov_b32 s29, 10312
  buffer_load_ushort v44, v11, s[8:11], s29 offen
  s_mov_b32 s29, 11592
  buffer_load_ushort v45, v11, s[8:11], s29 offen
  s_mov_b32 s29, 12872
  buffer_load_ushort v46, v11, s[8:11], s29 offen
  s_mov_b32 s29, 14152
  buffer_load_ushort v47, v11, s[8:11], s29 offen
  s_waitcnt vmcnt(24)
  v_lshl_or_b32 v48, v17, 16, v16
  v_lshl_or_b32 v49, v19, 16, v18
  v_lshl_or_b32 v50, v21, 16, v20
  v_lshl_or_b32 v51, v23, 16, v22
  s_lshl_b32 s30, s33, 2
  s_add_u32 s30, s30, 0
  s_lshl_b32 s30, s30, 5
  s_add_u32 s30, s30, s34
  s_lshl_b32 s30, s30, 10
  s_add_u32 s30, s30, 91488256
  buffer_store_dwordx4 v[48:51], v5, s[4:7], s30 offen sc1
  s_waitcnt vmcnt(17)
  v_lshl_or_b32 v52, v25, 16, v24
  v_lshl_or_b32 v53, v27, 16, v26
  v_lshl_or_b32 v54, v29, 16, v28
  v_lshl_or_b32 v55, v31, 16, v30
  s_lshl_b32 s30, s33, 2
  s_add_u32 s30, s30, 1
  s_lshl_b32 s30, s30, 5
  s_add_u32 s30, s30, s34
  s_lshl_b32 s30, s30, 10
  s_add_u32 s30, s30, 91488256
  buffer_store_dwordx4 v[52:55], v5, s[4:7], s30 offen sc1
  s_waitcnt vmcnt(10)
  v_lshl_or_b32 v56, v33, 16, v32
  v_lshl_or_b32 v57, v35, 16, v34
  v_lshl_or_b32 v58, v37, 16, v36
  v_lshl_or_b32 v59, v39, 16, v38
  s_lshl_b32 s30, s33, 2
  s_add_u32 s30, s30, 2
  s_lshl_b32 s30, s30, 5
  s_add_u32 s30, s30, s34
  s_lshl_b32 s30, s30, 10
  s_add_u32 s30, s30, 91488256
  buffer_store_dwordx4 v[56:59], v5, s[4:7], s30 offen sc1
  s_waitcnt vmcnt(3)
  v_lshl_or_b32 v60, v41, 16, v40
  v_lshl_or_b32 v61, v43, 16, v42
  v_lshl_or_b32 v62, v45, 16, v44
  v_lshl_or_b32 v63, v47, 16, v46
  s_lshl_b32 s30, s33, 2
  s_add_u32 s30, s30, 3
  s_lshl_b32 s30, s30, 5
  s_add_u32 s30, s30, s34
  s_lshl_b32 s30, s30, 10
  s_add_u32 s30, s30, 91488256
  buffer_store_dwordx4 v[60:63], v5, s[4:7], s30 offen sc1
prep_exit1:
  s_endpgm
.globl ln2_kernel
.p2align 8
.type ln2_kernel,@function
ln2_kernel:
  s_cmp_ge_u32 s2, 128
  s_cbranch_scc1 ln2_exit1
  s_load_dwordx2 s[12:13], s[0:1], 96
  s_load_dwordx2 s[14:15], s[0:1], 0
  v_lshrrev_b32 v2, 6, v0
  v_and_b32 v3, 63, v0
  s_nop 0
  v_readfirstlane_b32 s16, v2
  s_waitcnt lgkmcnt(0)
  s_mov_b32 s4, s12
  s_mov_b32 s5, s13
  s_mov_b32 s6, 0x10000000
  s_mov_b32 s7, 0x20000
  s_mov_b32 s8, s12
  s_mov_b32 s9, s13
  s_mov_b32 s10, 0x10000000
  s_mov_b32 s11, 0x20000
  s_mov_b32 s20, 82313216
  v_and_b32 v2, 15, v3
  v_lshrrev_b32 v4, 4, v3
  s_lshl_b32 s17, s2, 4
  v_add_u32 v1, s17, v2
  v_mul_u32_u24 v1, 1280, v1
  v_lshl_add_u32 v1, v4, 4, v1
  s_mul_i32 s17, s16, 320
  s_add_u32 s20, s20, s17
  buffer_load_dwordx4 v[8:11], v1, s[8:11], s20 offen offset:0
  buffer_load_dwordx4 v[12:15], v1, s[8:11], s20 offen offset:64
  buffer_load_dwordx4 v[16:19], v1, s[8:11], s20 offen offset:128
  buffer_load_dwordx4 v[20:23], v1, s[8:11], s20 offen offset:192
  buffer_load_dwordx4 v[24:27], v1, s[8:11], s20 offen offset:256
  s_sub_u32 s21, 0, s12
  s_and_b32 s21, s21, 0x1fffff
  s_add_u32 s21, s21, 2097152
  v_mov_b32 v68, -1
  v_mov_b32 v69, -1
  v_mov_b32 v70, -1
  v_mov_b32 v71, -1
  v_lshlrev_b32 v72, 4, v0
  s_mul_i32 s22, s2, 12096
  s_add_u32 s22, s22, 0
  s_mul_i32 s23, s2, 12288
  s_add_u32 s23, s23, s21
  buffer_store_dwordx4 v[68:71], v72, s[4:7], s22 offen sc1
  s_add_u32 s22, s22, 4096
  buffer_store_dwordx4 v[68:71], v72, s[4:7], s22 offen sc1
  s_add_u32 s22, s22, 4096
  v_mov_b32 v73, 0x80000000
  v_cmp_gt_u32 vcc, 244, v0
  s_nop 1
  v_cndmask_b32 v73, v73, v72, vcc
  buffer_store_dwordx4 v[68:71], v73, s[4:7], s22 offen
  buffer_store_dwordx4 v[68:71], v72, s[4:7], s23 offen sc1
  s_add_u32 s23, s23, 4096
  buffer_store_dwordx4 v[68:71], v72, s[4:7], s23 offen sc1
  s_add_u32 s23, s23, 4096
  buffer_store_dwordx4 v[68:71], v72, s[4:7], s23 offen sc1
  s_add_u32 s23, s23, 4096
  s_mul_i32 s23, s2, 2048
  s_add_u32 s23, s23, s21
  s_add_u32 s23, s23, 1572864
  v_mov_b32 v73, 0x80000000
  v_cmp_gt_u32 vcc, 128, v0
  s_nop 1
  v_cndmask_b32 v73, v73, v72, vcc
  buffer_store_dwordx4 v[68:71], v73, s[4:7], s23 offen sc1
  v_lshlrev_b32 v5, 2, v2
  s_lshl_b32 s17, s16, 6
  v_add_u32 v1, s17, v5
  s_waitcnt vmcnt(7)
  v_lshlrev_b32 v28, 16, v8
  v_and_b32 v29, 0xffff0000, v8
  v_lshlrev_b32 v30, 16, v9
  v_and_b32 v31, 0xffff0000, v9
  v_lshlrev_b32 v32, 16, v10
  v_and_b32 v33, 0xffff0000, v10
  v_lshlrev_b32 v34, 16, v11
  v_and_b32 v35, 0xffff0000, v11
  v_lshlrev_b32 v36, 16, v12
  v_and_b32 v37, 0xffff0000, v12
  v_lshlrev_b32 v38, 16, v13
  v_and_b32 v39, 0xffff0000, v13
  v_lshlrev_b32 v40, 16, v14
  v_and_b32 v41, 0xffff0000, v14
  v_lshlrev_b32 v42, 16, v15
  v_and_b32 v43, 0xffff0000, v15
  v_lshlrev_b32 v44, 16, v16
  v_and_b32 v45, 0xffff0000, v16
  v_lshlrev_b32 v46, 16, v17
  v_and_b32 v47, 0xffff0000, v17
  v_lshlrev_b32 v48, 16, v18
  v_and_b32 v49, 0xffff0000, v18
  v_lshlrev_b32 v50, 16, v19
  v_and_b32 v51, 0xffff0000, v19
  v_lshlrev_b32 v52, 16, v20
  v_and_b32 v53, 0xffff0000, v20
  v_lshlrev_b32 v54, 16, v21
  v_and_b32 v55, 0xffff0000, v21
  v_lshlrev_b32 v56, 16, v22
  v_and_b32 v57, 0xffff0000, v22
  v_lshlrev_b32 v58, 16, v23
  v_and_b32 v59, 0xffff0000, v23
  v_lshlrev_b32 v60, 16, v24
  v_and_b32 v61, 0xffff0000, v24
  v_lshlrev_b32 v62, 16, v25
  v_and_b32 v63, 0xffff0000, v25
  v_lshlrev_b32 v64, 16, v26
  v_and_b32 v65, 0xffff0000, v26
  v_lshlrev_b32 v66, 16, v27
  v_and_b32 v67, 0xffff0000, v27
  v_pk_add_f32 v[6:7], v[28:29], v[30:31]
  v_pk_add_f32 v[6:7], v[6:7], v[32:33]
  v_pk_add_f32 v[6:7], v[6:7], v[34:35]
  v_pk_add_f32 v[6:7], v[6:7], v[36:37]
  v_pk_add_f32 v[6:7], v[6:7], v[38:39]
  v_pk_add_f32 v[6:7], v[6:7], v[40:41]
  v_pk_add_f32 v[6:7], v[6:7], v[42:43]
  v_pk_add_f32 v[6:7], v[6:7], v[44:45]
  v_pk_add_f32 v[6:7], v[6:7], v[46:47]
  v_pk_add_f32 v[6:7], v[6:7], v[48:49]
  v_pk_add_f32 v[6:7], v[6:7], v[50:51]
  v_pk_add_f32 v[6:7], v[6:7], v[52:53]
  v_pk_add_f32 v[6:7], v[6:7], v[54:55]
  v_pk_add_f32 v[6:7], v[6:7], v[56:57]
  v_pk_add_f32 v[6:7], v[6:7], v[58:59]
  v_pk_add_f32 v[6:7], v[6:7], v[60:61]
  v_pk_add_f32 v[6:7], v[6:7], v[62:63]
  v_pk_add_f32 v[6:7], v[6:7], v[64:65]
  v_pk_add_f32 v[6:7], v[6:7], v[66:67]
  v_add_f32 v4, v6, v7
  v_mov_b32 v2, v4
  s_nop 1
  v_permlane32_swap_b32 v4, v2
  v_add_f32 v4, v4, v2
  v_mov_b32 v2, v4
  s_nop 1
  v_permlane16_swap_b32 v4, v2
  v_add_f32 v4, v4, v2
  ds_write_b32 v1, v4 offset:0
  s_waitcnt lgkmcnt(0)
  s_barrier
  ds_read_b32 v4, v5 offset:0
  ds_read_b32 v2, v5 offset:64
  ds_read_b32 v3, v5 offset:128
  ds_read_b32 v6, v5 offset:192
  s_waitcnt lgkmcnt(0)
  v_add_f32 v4, v4, v2
  v_add_f32 v3, v3, v6
  v_add_f32 v4, v4, v3
  v_mul_f32 v4, 0x3acccccd, v4
  v_sub_f32 v28, v28, v4
  v_sub_f32 v29, v29, v4
  v_sub_f32 v30, v30, v4
  v_sub_f32 v31, v31, v4
  v_sub_f32 v32, v32, v4
  v_sub_f32 v33, v33, v4
  v_sub_f32 v34, v34, v4
  v_sub_f32 v35, v35, v4
  v_sub_f32 v36, v36, v4
  v_sub_f32 v37, v37, v4
  v_sub_f32 v38, v38, v4
  v_sub_f32 v39, v39, v4
  v_sub_f32 v40, v40, v4
  v_sub_f32 v41, v41, v4
  v_sub_f32 v42, v42, v4
  v_sub_f32 v43, v43, v4
  v_sub_f32 v44, v44, v4
  v_sub_f32 v45, v45, v4
  v_sub_f32 v46, v46, v4
  v_sub_f32 v47, v47, v4
  v_sub_f32 v48, v48, v4
  v_sub_f32 v49, v49, v4
  v_sub_f32 v50, v50, v4
  v_sub_f32 v51, v51, v4
  v_sub_f32 v52, v52, v4
  v_sub_f32 v53, v53, v4
  v_sub_f32 v54, v54, v4
  v_sub_f32 v55, v55, v4
  v_sub_f32 v56, v56, v4
  v_sub_f32 v57, v57, v4
  v_sub_f32 v58, v58, v4
  v_sub_f32 v59, v59, v4
  v_sub_f32 v60, v60, v4
  v_sub_f32 v61, v61, v4
  v_sub_f32 v62, v62, v4
  v_sub_f32 v63, v63, v4
  v_sub_f32 v64, v64, v4
  v_sub_f32 v65, v65, v4
  v_sub_f32 v66, v66, v4
  v_sub_f32 v67, v67, v4
  v_mul_f32 v6, v28, v28
  v_mul_f32 v7, v29, v29
  v_fmac_f32 v6, v30, v30
  v_fmac_f32 v7, v31, v31
  v_fmac_f32 v6, v32, v32
  v_fmac_f32 v7, v33, v33
  v_fmac_f32 v6, v34, v34
  v_fmac_f32 v7, v35, v35
  v_fmac_f32 v6, v36, v36
  v_fmac_f32 v7, v37, v37
  v_fmac_f32 v6, v38, v38
  v_fmac_f32 v7, v39, v39
  v_fmac_f32 v6, v40, v40
  v_fmac_f32 v7, v41, v41
  v_fmac_f32 v6, v42, v42
  v_fmac_f32 v7, v43, v43
  v_fmac_f32 v6, v44, v44
  v_fmac_f32 v7, v45, v45
  v_fmac_f32 v6, v46, v46
  v_fmac_f32 v7, v47, v47
  v_fmac_f32 v6, v48, v48
  v_fmac_f32 v7, v49, v49
  v_fmac_f32 v6, v50, v50
  v_fmac_f32 v7, v51, v51
  v_fmac_f32 v6, v52, v52
  v_fmac_f32 v7, v53, v53
  v_fmac_f32 v6, v54, v54
  v_fmac_f32 v7, v55, v55
  v_fmac_f32 v6, v56, v56
  v_fmac_f32 v7, v57, v57
  v_fmac_f32 v6, v58, v58
  v_fmac_f32 v7, v59, v59
  v_fmac_f32 v6, v60, v60
  v_fmac_f32 v7, v61, v61
  v_fmac_f32 v6, v62, v62
  v_fmac_f32 v7, v63, v63
  v_fmac_f32 v6, v64, v64
  v_fmac_f32 v7, v65, v65
  v_fmac_f32 v6, v66, v66
  v_fmac_f32 v7, v67, v67
  v_add_f32 v4, v6, v7
  v_mov_b32 v2, v4
  s_nop 1
  v_permlane32_swap_b32 v4, v2
  v_add_f32 v4, v4, v2
  v_mov_b32 v2, v4
  s_nop 1
  v_permlane16_swap_b32 v4, v2
  v_add_f32 v4, v4, v2
  ds_write_b32 v1, v4 offset:256
  s_waitcnt lgkmcnt(0)
  s_barrier
  ds_read_b32 v4, v5 offset:256
  ds_read_b32 v2, v5 offset:320
  ds_read_b32 v3, v5 offset:384
  ds_read_b32 v6, v5 offset:448
  s_waitcnt lgkmcnt(0)
  v_add_f32 v4, v4, v2
  v_add_f32 v3, v3, v6
  v_add_f32 v4, v4, v3
  v_mov_b32 v2, 0x3727c5ac
  v_fmac_f32 v2, 0x3acccccd, v4
  v_rsq_f32 v4, v2
  s_nop 0
  v_mul_f32 v28, v28, v4
  v_mul_f32 v29, v29, v4
  v_mul_f32 v30, v30, v4
  v_mul_f32 v31, v31, v4
  v_mul_f32 v32, v32, v4
  v_mul_f32 v33, v33, v4
  v_mul_f32 v34, v34, v4
  v_mul_f32 v35, v35, v4
  v_mul_f32 v36, v36, v4
  v_mul_f32 v37, v37, v4
  v_mul_f32 v38, v38, v4
  v_mul_f32 v39, v39, v4
  v_mul_f32 v40, v40, v4
  v_mul_f32 v41, v41, v4
  v_mul_f32 v42, v42, v4
  v_mul_f32 v43, v43, v4
  v_mul_f32 v44, v44, v4
  v_mul_f32 v45, v45, v4
  v_mul_f32 v46, v46, v4
  v_mul_f32 v47, v47, v4
  v_mul_f32 v48, v48, v4
  v_mul_f32 v49, v49, v4
  v_mul_f32 v50, v50, v4
  v_mul_f32 v51, v51, v4
  v_mul_f32 v52, v52, v4
  v_mul_f32 v53, v53, v4
  v_mul_f32 v54, v54, v4
  v_mul_f32 v55, v55, v4
  v_mul_f32 v56, v56, v4
  v_mul_f32 v57, v57, v4
  v_mul_f32 v58, v58, v4
  v_mul_f32 v59, v59, v4
  v_mul_f32 v60, v60, v4
  v_mul_f32 v61, v61, v4
  v_mul_f32 v62, v62, v4
  v_mul_f32 v63, v63, v4
  v_mul_f32 v64, v64, v4
  v_mul_f32 v65, v65, v4
  v_mul_f32 v66, v66, v4
  v_mul_f32 v67, v67, v4
  v_cvt_pk_bf16_f32 v8, v28, v29
  v_cvt_pk_bf16_f32 v9, v30, v31
  v_cvt_pk_bf16_f32 v10, v32, v33
  v_cvt_pk_bf16_f32 v11, v34, v35
  v_cvt_pk_bf16_f32 v12, v36, v37
  v_cvt_pk_bf16_f32 v13, v38, v39
  v_cvt_pk_bf16_f32 v14, v40, v41
  v_cvt_pk_bf16_f32 v15, v42, v43
  v_cvt_pk_bf16_f32 v16, v44, v45
  v_cvt_pk_bf16_f32 v17, v46, v47
  v_cvt_pk_bf16_f32 v18, v48, v49
  v_cvt_pk_bf16_f32 v19, v50, v51
  v_cvt_pk_bf16_f32 v20, v52, v53
  v_cvt_pk_bf16_f32 v21, v54, v55
  v_cvt_pk_bf16_f32 v22, v56, v57
  v_cvt_pk_bf16_f32 v23, v58, v59
  v_cvt_pk_bf16_f32 v24, v60, v61
  v_cvt_pk_bf16_f32 v25, v62, v63
  v_cvt_pk_bf16_f32 v26, v64, v65
  v_cvt_pk_bf16_f32 v27, v66, v67
  v_and_b32 v3, 63, v0
  v_lshlrev_b32 v1, 4, v3
  s_mul_i32 s17, s2, 20480
  s_mul_i32 s18, s16, 5120
  s_add_u32 s17, s17, s18
  s_add_u32 s17, s17, 84934656
  buffer_store_dwordx4 v[8:11], v1, s[4:7], s17 offen offset:0 sc1
  buffer_store_dwordx4 v[12:15], v1, s[4:7], s17 offen offset:1024 sc1
  buffer_store_dwordx4 v[16:19], v1, s[4:7], s17 offen offset:2048 sc1
  buffer_store_dwordx4 v[20:23], v1, s[4:7], s17 offen offset:3072 sc1
  s_add_u32 s17, s17, 4096
  buffer_store_dwordx4 v[24:27], v1, s[4:7], s17 offen offset:0 sc1
ln2_exit1:
  s_endpgm
.globl reca_kernel
.p2align 8
.type reca_kernel,@function
reca_kernel:
  s_cmp_ge_u32 s2, 256
  s_cbranch_scc1 reca_exitb3
  s_load_dwordx2 s[48:49], s[0:1], 96
  s_load_dwordx2 s[50:51], s[0:1], 88
  s_load_dwordx2 s[52:53], s[0:1], 8
  s_getreg_b32 s42, hwreg(HW_REG_XCC_ID, 0, 3)
  v_lshrrev_b32 v28, 6, v0
  v_and_b32 v29, 63, v0
  s_and_b32 s13, s2, 7
  v_readfirstlane_b32 s12, v28
  v_lshlrev_b32 v1, 4, v29
  s_lshr_b32 s14, s2, 3
  s_mov_b32 s18, 0x100000
  s_waitcnt lgkmcnt(0)
  s_mov_b32 s57, 0
  s_mov_b32 s4, s48
  s_mov_b32 s5, s49
  s_mov_b32 s6, 0x10000000
  s_mov_b32 s7, 0x20000
  s_mov_b32 s8, s50
  s_mov_b32 s9, s51
  s_mov_b32 s10, 256
  s_mov_b32 s11, 0x20000
  v_add_u32 v2, 0x1000, v1
  v_add_u32 v3, 0x2000, v1
  v_mov_b32 v31, 0x80000000
  s_lshl_b32 s34, s42, 3
  s_lshl_b64 s[36:37], 1, s34
  s_lshl_b32 s34, s13, 3
  v_cmp_eq_u32 vcc, 0, v0
  v_mov_b32 v30, s34
  s_nop 0
  v_cndmask_b32 v30, v31, v30, vcc
  v_mov_b32 v44, s36
  v_mov_b32 v45, s37
  buffer_atomic_add_x2 v[44:45], v30, s[8:11], 0 offen
  s_sub_u32 s56, 0, s48
  s_and_b32 s56, s56, 0x1fffff
  s_add_u32 s56, s56, 2097152
  s_nop 0
  s_cmp_ge_u32 s14, 24
  s_cbranch_scc1 reca_proj2
  s_mul_i32 s34, s14, 43
  s_lshr_b32 s34, s34, 8
  s_mul_i32 s35, s34, 6
  s_sub_u32 s16, s14, s35
  s_lshl_b32 s15, s13, 2
  s_add_u32 s15, s15, s34
  s_lshr_b32 s19, s12, 1
  s_and_b32 s37, s12, 1
  s_mul_i32 s34, s15, 12
  s_lshl_b32 s35, s16, 1
  s_add_u32 s34, s34, s35
  s_add_u32 s34, s34, s37
  s_mul_i32 s34, s34, 20480
  s_mov_b32 s35, 14155776
  s_cmp_eq_u32 s19, 0
  s_cselect_b32 s35, 6291456, s35
  s_add_u32 s35, s35, s34
  s_mul_i32 s36, s19, 10240
  s_add_u32 s20, s35, s36
  s_sub_u32 s36, 10240, s36
  s_add_u32 s21, s35, s36
  s_add_u32 s22, s34, 22020096
  s_mul_i32 s36, s19, 10240
  s_add_u32 s22, s22, s36
  buffer_load_dwordx4 a[0:3], v1, s[4:7], s20 offen offset:0
  buffer_load_dwordx4 a[4:7], v1, s[4:7], s20 offen offset:1024
  buffer_load_dwordx4 a[8:11], v1, s[4:7], s20 offen offset:2048
  buffer_load_dwordx4 a[12:15], v1, s[4:7], s20 offen offset:3072
  buffer_load_dwordx4 a[16:19], v2, s[4:7], s20 offen offset:0
  buffer_load_dwordx4 a[20:23], v2, s[4:7], s20 offen offset:1024
  buffer_load_dwordx4 a[24:27], v2, s[4:7], s20 offen offset:2048
  buffer_load_dwordx4 a[28:31], v2, s[4:7], s20 offen offset:3072
  buffer_load_dwordx4 a[32:35], v3, s[4:7], s20 offen offset:0
  buffer_load_dwordx4 a[36:39], v3, s[4:7], s20 offen offset:1024
  buffer_load_dwordx4 a[40:43], v1, s[4:7], s21 offen offset:0
  buffer_load_dwordx4 a[44:47], v1, s[4:7], s21 offen offset:1024
  buffer_load_dwordx4 a[48:51], v1, s[4:7], s21 offen offset:2048
  buffer_load_dwordx4 a[52:55], v1, s[4:7], s21 offen offset:3072
  buffer_load_dwordx4 a[56:59], v2, s[4:7], s21 offen offset:0
  buffer_load_dwordx4 a[60:63], v2, s[4:7], s21 offen offset:1024
  buffer_load_dwordx4 a[64:67], v2, s[4:7], s21 offen offset:2048
  buffer_load_dwordx4 a[68:71], v2, s[4:7], s21 offen offset:3072
  buffer_load_dwordx4 a[72:75], v3, s[4:7], s21 offen offset:0
  buffer_load_dwordx4 a[76:79], v3, s[4:7], s21 offen offset:1024
  buffer_load_dwordx4 a[80:83], v1, s[4:7], s22 offen offset:0
  buffer_load_dwordx4 a[84:87], v1, s[4:7], s22 offen offset:1024
  buffer_load_dwordx4 a[88:91], v1, s[4:7], s22 offen offset:2048
  buffer_load_dwordx4 a[92:95], v1, s[4:7], s22 offen offset:3072
  buffer_load_dwordx4 a[96:99], v2, s[4:7], s22 offen offset:0
  buffer_load_dwordx4 a[100:103], v2, s[4:7], s22 offen offset:1024
  buffer_load_dwordx4 a[104:107], v2, s[4:7], s22 offen offset:2048
  buffer_load_dwordx4 a[108:111], v2, s[4:7], s22 offen offset:3072
  buffer_load_dwordx4 a[112:115], v3, s[4:7], s22 offen offset:0
  buffer_load_dwordx4 a[116:119], v3, s[4:7], s22 offen offset:1024
  s_cmp_ge_u32 s14, 20
  s_cbranch_scc1 reca_now24
  s_cmp_ge_u32 s12, 2
  s_cbranch_scc1 reca_now24
  s_lshl_b32 s34, s14, 1
  s_add_u32 s34, s34, s12
  s_mul_i32 s34, s34, 192
  s_mul_i32 s35, s13, 24
  s_add_u32 s34, s34, s35
  s_lshl_b32 s34, s34, 10
  s_add_u32 s34, s34, 29884416
  buffer_load_dwordx4 a[120:123], v1, s[4:7], s34 offen offset:0
  buffer_load_dwordx4 a[124:127], v1, s[4:7], s34 offen offset:1024
  buffer_load_dwordx4 a[128:131], v1, s[4:7], s34 offen offset:2048
  buffer_load_dwordx4 a[132:135], v1, s[4:7], s34 offen offset:3072
  buffer_load_dwordx4 a[136:139], v2, s[4:7], s34 offen offset:0
  buffer_load_dwordx4 a[140:143], v2, s[4:7], s34 offen offset:1024
  buffer_load_dwordx4 a[144:147], v2, s[4:7], s34 offen offset:2048
  buffer_load_dwordx4 a[148:151], v2, s[4:7], s34 offen offset:3072
  buffer_load_dwordx4 a[152:155], v3, s[4:7], s34 offen offset:0
  buffer_load_dwordx4 a[156:159], v3, s[4:7], s34 offen offset:1024
  buffer_load_dwordx4 a[160:163], v3, s[4:7], s34 offen offset:2048
  buffer_load_dwordx4 a[164:167], v3, s[4:7], s34 offen offset:3072
  s_add_u32 s34, s34, 12288
  buffer_load_dwordx4 a[168:171], v1, s[4:7], s34 offen offset:0
  buffer_load_dwordx4 a[172:175], v1, s[4:7], s34 offen offset:1024
  buffer_load_dwordx4 a[176:179], v1, s[4:7], s34 offen offset:2048
  buffer_load_dwordx4 a[180:183], v1, s[4:7], s34 offen offset:3072
  buffer_load_dwordx4 a[184:187], v2, s[4:7], s34 offen offset:0
  buffer_load_dwordx4 a[188:191], v2, s[4:7], s34 offen offset:1024
  buffer_load_dwordx4 a[192:195], v2, s[4:7], s34 offen offset:2048
  buffer_load_dwordx4 a[196:199], v2, s[4:7], s34 offen offset:3072
  buffer_load_dwordx4 a[200:203], v3, s[4:7], s34 offen offset:0
  buffer_load_dwordx4 a[204:207], v3, s[4:7], s34 offen offset:1024
  buffer_load_dwordx4 a[208:211], v3, s[4:7], s34 offen offset:2048
  buffer_load_dwordx4 a[212:215], v3, s[4:7], s34 offen offset:3072
reca_now24:
  v_and_b32 v29, 63, v0
  v_and_b32 v28, 15, v29
  v_lshrrev_b32 v30, 4, v29
  v_mov_b32 v32, -1
  v_mov_b32 v33, -1
  v_mov_b32 v34, -1
  v_mov_b32 v35, -1
  s_mul_i32 s34, s12, 2560
  v_add_u32 v4, s34, v1
  v_and_b32 v44, 31, v29
  v_lshlrev_b32 v44, 4, v44
  s_add_u32 s34, s34, 2048
  v_add_u32 v5, s34, v44
  v_and_b32 v44, 7, v29
  v_lshlrev_b32 v44, 4, v44
  v_lshl_add_u32 v44, v30, 7, v44
  s_mul_i32 s34, s19, 5120
  v_add_u32 v6, s34, v44
  s_sub_u32 s34, 5120, s34
  v_add_u32 v7, s34, v44
  v_lshrrev_b32 v45, 3, v28
  v_lshl_add_u32 v12, v45, 9, v44
  s_mul_i32 s34, s19, 5120
  v_add_u32 v236, s34, v12
  s_sub_u32 s34, 5120, s34
  v_add_u32 v237, s34, v12
  v_add_u32 v13, 0x1000, v12
  v_add_u32 v14, 0x2000, v12
  v_cmp_gt_u32 s[54:55], 8, v28
  s_lshl_b32 s34, s16, 10
  s_lshl_b32 s35, s19, 7
  s_add_u32 s34, s34, s35
  s_and_b32 s35, s12, 1
  s_lshl_b32 s36, s35, 3
  s_add_u32 s34, s34, s36
  v_lshlrev_b32 v44, 4, v28
  v_lshl_add_u32 v45, v30, 8, v44
  v_add_u32 v45, s34, v45
  v_cndmask_b32 v8, v31, v45, s[54:55]
  v_lshl_add_u32 v44, v30, 7, v44
  v_add_u32 v45, s36, v44
  v_cndmask_b32 v9, v31, v45, s[54:55]
  s_lshl_b32 s34, s14, 9
  v_add_u32 v45, s34, v44
  v_cndmask_b32 v11, v31, v45, s[54:55]
  s_mul_i32 s34, s13, 49152
  s_lshr_b32 s35, s14, 3
  s_lshl_b32 s35, s35, 14
  s_add_u32 s34, s34, s35
  s_and_b32 s35, s14, 7
  s_lshl_b32 s35, s35, 10
  s_add_u32 s34, s34, s35
  s_lshl_b32 s35, s12, 9
  s_add_u32 s34, s34, s35
  v_add_u32 v45, s34, v44
  v_cndmask_b32 v15, v31, v45, s[54:55]
  s_cmp_lt_u32 s14, 20
  s_cselect_b32 s34, 0, 0x80000000
  v_or_b32 v15, s34, v15
  v_lshlrev_b32 v45, 3, v29
  v_cmp_gt_u32 vcc, 32, v29
  s_nop 1
  v_cndmask_b32 v10, v31, v45, vcc
  s_sub_u32 s35, s14, 4
  s_cmp_lt_u32 s14, 20
  s_cselect_b32 s34, s14, s35
  s_lshr_b32 s35, s34, 3
  s_lshl_b32 s35, s35, 14
  s_and_b32 s34, s34, 7
  s_lshl_b32 s34, s34, 10
  s_add_u32 s34, s34, s35
  v_add_u32 v20, s34, v1
  v_add_u32 v21, 49152, v20
  v_add_u32 v22, 98304, v20
  v_add_u32 v23, 147456, v20
  v_add_u32 v24, 196608, v20
  v_add_u32 v25, 245760, v20
  v_add_u32 v26, 294912, v20
  v_add_u32 v27, 344064, v20
  v_lshrrev_b32 v44, 3, v29
  v_and_b32 v44, 3, v44
  v_lshlrev_b32 v44, 7, v44
  v_and_b32 v45, 7, v29
  v_lshl_add_u32 v44, v45, 4, v44
  v_lshrrev_b32 v45, 5, v29
  v_lshl_add_u32 v44, v45, 3, v44
  s_lshl_b32 s34, s14, 9
  s_cmp_lt_u32 s14, 20
  s_cselect_b32 s34, s34, 0x80000000
  v_add_u32 v16, s34, v44
  v_cmp_eq_u32 vcc, 0, v29
  v_mov_b32 v45, 0
  s_nop 0
  v_cndmask_b32 v19, v31, v45, vcc
  s_lshl_b32 s34, s15, 8
  s_add_u32 s34, s34, 1540096
  v_and_b32 v45, 1, v29
  v_lshlrev_b32 v45, 7, v45
  v_add_u32 v233, s34, v45
  s_lshl_b32 s34, s12, 10
  s_add_u32 s34, s34, 10240
  v_add_u32 v17, s34, v1
  v_mov_b32 v36, 0x3f803f80
  v_mov_b32 v37, 0x3f803f80
  v_mov_b32 v38, 0x3f803f80
  v_mov_b32 v39, 0x3f803f80
  v_mov_b32 v44, 0xf149f2ca
  v_cmp_gt_u32 vcc, 2, v30
  s_nop 1
  v_cndmask_b32 v40, 0, v44, vcc
  v_mov_b32 v41, v40
  v_mov_b32 v42, v40
  v_mov_b32 v43, v40
  v_and_b32 v44, 31, v29
  v_lshlrev_b32 v44, 4, v44
  v_add_u32 v45, 47972352, v44
  v_add_u32 v44, 47185920, v44
  v_cmp_gt_u32 vcc, 32, v29
  s_nop 1
  v_cndmask_b32 v238, v45, v44, vcc
  s_mov_b32 s41, 0x3dd53b95
  s_mul_i32 s38, s13, 40960
  s_add_u32 s38, s38, 0
  s_mul_i32 s39, s15, 24576
  s_add_u32 s39, s39, 327680
  s_mul_i32 s40, s13, 49152
  s_add_u32 s40, s40, 1114112
  s_mov_b32 s60, s52
  s_mov_b32 s61, s53
  s_mov_b32 s62, 10240
  s_mov_b32 s63, 0x20000
  v_and_b32 v29, 63, v0
  v_and_b32 v44, 7, v29
  v_mul_u32_u24 v44, 1280, v44
  v_lshrrev_b32 v45, 3, v29
  v_and_b32 v45, 3, v45
  v_lshl_add_u32 v44, v45, 4, v44
  s_mul_i32 s34, s12, 320
  v_add_u32 v44, s34, v44
  v_add_u32 v46, 256, v44
  v_lshrrev_b32 v45, 5, v29
  v_lshl_add_u32 v44, v45, 6, v44
  buffer_load_dwordx4 v[128:131], v44, s[60:63], 0 offen
  buffer_load_dwordx4 v[132:135], v44, s[60:63], 0 offen offset:128
  buffer_load_dwordx4 v[136:139], v46, s[60:63], 0 offen
  v_and_b32 v44, 63, v0
  v_and_b32 v45, 3, v44
  v_lshlrev_b32 v45, 21, v45
  v_min_u32 v45, 786368, v45
  v_add_u32 v46, 47185920, v45
  v_add_u32 v45, 47972352, v45
  v_cmp_gt_u32 vcc, 4, v44
  s_nop 1
  v_cndmask_b32 v46, v45, v46, vcc
  s_mul_i32 s34, s15, 98304
  v_and_b32 v45, 1, v44
  v_mul_u32_u24 v45, 98240, v45
  v_add_u32 v45, s34, v45
  v_add_u32 v28, 37748736, v45
  v_add_u32 v45, 40894464, v45
  v_cmp_gt_u32 vcc, 10, v44
  s_nop 1
  v_cndmask_b32 v45, v45, v28, vcc
  v_cmp_gt_u32 vcc, 8, v44
  s_nop 1
  v_cndmask_b32 v46, v45, v46, vcc
  v_cmp_gt_u32 vcc, 12, v44
  s_nop 1
  v_cndmask_b32 v46, v31, v46, vcc
  buffer_load_dword v234, v46, s[4:7], 0 offen
  v_and_b32 v44, 63, v0
  v_lshlrev_b32 v45, 21, v44
  v_min_u32 v45, 25165760, v45
  v_add_u32 v45, 57147392, v45
  s_lshl_b32 s34, s13, 2
  s_add_u32 s34, s34, s14
  s_sub_u32 s34, s34, 20
  s_and_b32 s34, s34, 31
  s_mul_i32 s34, s34, 98304
  s_add_u32 s34, s34, 44040192
  v_and_b32 v46, 1, v44
  v_mul_u32_u24 v46, 98240, v46
  v_add_u32 v46, s34, v46
  v_cmp_gt_u32 vcc, 13, v44
  s_nop 1
  v_cndmask_b32 v46, v46, v45, vcc
  v_cmp_gt_u32 vcc, 15, v44
  s_nop 1
  v_cndmask_b32 v46, v31, v46, vcc
  buffer_load_dword v235, v46, s[4:7], 0 offen
  v_and_b32 v30, 7, v0
  v_lshlrev_b32 v30, 3, v30
reca_cens5:
  buffer_load_dwordx2 v[28:29], v30, s[8:11], 0 offen sc1
  s_waitcnt vmcnt(0)
  v_sad_u8 v31, v28, 0, 0
  v_sad_u8 v31, v29, 0, v31
  v_cmp_gt_u32 vcc, 32, v31
  s_cbranch_vccz reca_censok6
  s_sleep 8
  s_sub_u32 s18, s18, 1
  s_cbranch_scc0 reca_cens5
  s_mov_b32 s18, 0
reca_censok6:
  v_and_b32 v28, 0x20202020, v28
  v_and_b32 v29, 0x20202020, v29
  v_cmp_ne_u32 s[34:35], 0, v28
  v_cmp_ne_u32 s[36:37], 0, v29
  s_nop 3
  s_and_b32 s34, s34, 0xff
  s_and_b32 s36, s36, 0xff
  s_or_b32 s35, s34, s36
  s_lshr_b32 s37, s35, s13
  s_and_b32 s37, s37, 1
  s_xor_b32 s43, s37, 1
  s_cmp_eq_u32 s57, 0
  s_cselect_b32 s58, s36, s34
  v_mov_b32 v31, 0x80000000
  v_add_u32 v232, 0x2000, v15
  s_lshr_b32 s44, s2, 4
  s_lshl_b32 s44, s44, 14
  s_and_b32 s34, s2, 15
  s_lshl_b32 s34, s34, 9
  s_add_u32 s44, s44, s34
  s_add_u32 s44, s44, 1572864
  s_add_u32 s44, s44, s56
  s_mov_b32 s45, -1
  s_mov_b32 s47, -1
  s_cmp_lg_u32 s12, 2
  s_cbranch_scc1 reca_noprobe7
  s_add_u32 s35, s44, 0
  s_memtime s[60:61]
  s_waitcnt lgkmcnt(0)
  buffer_load_dword v28, v19, s[4:7], s35 offen sc1
  s_waitcnt vmcnt(0)
  s_memtime s[62:63]
  s_waitcnt lgkmcnt(0)
  s_sub_u32 s36, s62, s60
  s_min_u32 s45, s45, s36
  s_add_u32 s35, s44, 8192
  s_memtime s[60:61]
  s_waitcnt lgkmcnt(0)
  buffer_load_dword v28, v19, s[4:7], s35 offen sc1
  s_waitcnt vmcnt(0)
  s_memtime s[62:63]
  s_waitcnt lgkmcnt(0)
  s_sub_u32 s36, s62, s60
  s_min_u32 s47, s47, s36
  s_add_u32 s35, s44, 128
  s_memtime s[60:61]
  s_waitcnt lgkmcnt(0)
  buffer_load_dword v28, v19, s[4:7], s35 offen sc1
  s_waitcnt vmcnt(0)
  s_memtime s[62:63]
  s_waitcnt lgkmcnt(0)
  s_sub_u32 s36, s62, s60
  s_min_u32 s45, s45, s36
  s_add_u32 s35, s44, 8320
  s_memtime s[60:61]
  s_waitcnt lgkmcnt(0)
  buffer_load_dword v28, v19, s[4:7], s35 offen sc1
  s_waitcnt vmcnt(0)
  s_memtime s[62:63]
  s_waitcnt lgkmcnt(0)
  s_sub_u32 s36, s62, s60
  s_min_u32 s47, s47, s36
  s_add_u32 s35, s44, 256
  s_memtime s[60:61]
  s_waitcnt lgkmcnt(0)
  buffer_load_dword v28, v19, s[4:7], s35 offen sc1
  s_waitcnt vmcnt(0)
  s_memtime s[62:63]
  s_waitcnt lgkmcnt(0)
  s_sub_u32 s36, s62, s60
  s_min_u32 s45, s45, s36
  s_add_u32 s35, s44, 8448
  s_memtime s[60:61]
  s_waitcnt lgkmcnt(0)
  buffer_load_dword v28, v19, s[4:7], s35 offen sc1
  s_waitcnt vmcnt(0)
  s_memtime s[62:63]
  s_waitcnt lgkmcnt(0)
  s_sub_u32 s36, s62, s60
  s_min_u32 s47, s47, s36
  s_cmp_lt_u32 s47, s45
  s_cbranch_scc0 reca_noprobe7
  v_add_u32 v20, 0x2000, v20
  v_add_u32 v21, 0x2000, v21
  v_add_u32 v22, 0x2000, v22
  v_add_u32 v23, 0x2000, v23
  v_add_u32 v24, 0x2000, v24
  v_add_u32 v25, 0x2000, v25
  v_add_u32 v26, 0x2000, v26
  v_add_u32 v27, 0x2000, v27
reca_noprobe7:
  s_lshl_b32 s59, s13, 2
  s_add_u32 s59, s59, s14
  s_sub_u32 s59, s59, 20
  v_and_b32 v29, 63, v0
  v_and_b32 v28, 15, v29
  v_lshrrev_b32 v30, 4, v29
  v_lshlrev_b32 v92, 4, v28
  v_lshl_add_u32 v92, v30, 7, v92
  v_cmp_gt_u32 vcc, 8, v28
  s_nop 1
  v_cndmask_b32 v92, v31, v92, vcc
  v_lshlrev_b32 v93, 3, v29
  v_cmp_gt_u32 vcc, 32, v29
  s_nop 1
  v_cndmask_b32 v93, v31, v93, vcc
  v_mov_b32 v82, 0xf149f2ca
  v_cmp_le_u32 vcc, 2, v30
  s_nop 1
  v_cndmask_b32 v84, 0, v82, vcc
  v_mov_b32 v85, v84
  v_mov_b32 v86, v84
  v_mov_b32 v87, v84
  v_lshlrev_b32 v30, 2, v30
  v_add_u32 v29, 0, v30
  v_cmp_gt_u32 vcc, v29, v28
  s_nop 1
  v_cndmask_b32 v88, 0, v82, vcc
  v_add_u32 v29, 1, v30
  v_cmp_gt_u32 vcc, v29, v28
  s_nop 1
  v_cndmask_b32 v89, 0, v82, vcc
  v_add_u32 v29, 2, v30
  v_cmp_gt_u32 vcc, v29, v28
  s_nop 1
  v_cndmask_b32 v90, 0, v82, vcc
  v_add_u32 v29, 3, v30
  v_cmp_gt_u32 vcc, v29, v28
  s_nop 1
  v_cndmask_b32 v91, 0, v82, vcc
  s_mov_b32 s17, 0
  s_cmp_lg_u32 s12, 3
  s_cbranch_scc1 reca_nopf08
  s_add_u32 s37, s17, 1
reca_pf9:
  buffer_load_dword v28, v233, s[4:7], 0 offen sc1
  s_waitcnt vmcnt(0)
  v_cmp_gt_i32 vcc, s37, v28
  s_cbranch_vccz reca_pfok10
  s_sleep 1
  s_sub_u32 s18, s18, 1
  s_cbranch_scc0 reca_pf9
  s_mov_b32 s18, 0
reca_pfok10:
  s_lshl_b32 s34, s15, 3
  s_and_b32 s35, s17, 7
  s_add_u32 s34, s34, s35
  s_mul_i32 s34, s34, 12288
  s_add_u32 s32, s34, 37748736
  s_lshl_b32 s35, s16, 11
  s_add_u32 s34, s34, s35
  s_add_u32 s33, s34, 40894464
  buffer_load_dwordx4 a[120:123], v1, s[4:7], s32 offen offset:0 sc1
  buffer_load_dwordx4 a[124:127], v1, s[4:7], s32 offen offset:1024 sc1
  buffer_load_dwordx4 a[128:131], v1, s[4:7], s32 offen offset:2048 sc1
  buffer_load_dwordx4 a[132:135], v1, s[4:7], s32 offen offset:3072 sc1
  buffer_load_dwordx4 a[136:139], v2, s[4:7], s32 offen offset:0 sc1
  buffer_load_dwordx4 a[140:143], v2, s[4:7], s32 offen offset:1024 sc1
  buffer_load_dwordx4 a[144:147], v2, s[4:7], s32 offen offset:2048 sc1
  buffer_load_dwordx4 a[148:151], v2, s[4:7], s32 offen offset:3072 sc1
  buffer_load_dwordx4 a[152:155], v3, s[4:7], s32 offen offset:0 sc1
  buffer_load_dwordx4 a[156:159], v3, s[4:7], s32 offen offset:1024 sc1
  buffer_load_dwordx4 a[160:163], v3, s[4:7], s32 offen offset:2048 sc1
  buffer_load_dwordx4 a[164:167], v3, s[4:7], s32 offen offset:3072 sc1
  buffer_load_dwordx4 a[168:171], v1, s[4:7], s33 offen offset:0 sc1
  buffer_load_dwordx4 a[172:175], v1, s[4:7], s33 offen offset:1024 sc1
  s_waitcnt vmcnt(0)
reca_nopf08:
  s_cmp_lg_u32 s43, 0
  s_cbranch_scc1 reca_slow11
  s_cmp_ge_u32 s14, 20
  s_cbranch_scc1 reca_twinf12
  s_branch reca_gotmem15
reca_step14:
  s_and_b32 s34, s17, 3
  s_mul_i32 s20, s34, 10240
  s_add_u32 s20, s20, s38
  s_sleep 2
  buffer_load_dwordx4 v[128:131], v4, s[4:7], s20 offen sc1
  buffer_load_dwordx4 v[132:135], v4, s[4:7], s20 offen offset:1024 sc1
  buffer_load_dwordx4 v[136:139], v5, s[4:7], s20 offen sc1
  s_waitcnt vmcnt(2)
  v_max_u32 v29, v128, v130
  v_cmp_eq_u32 vcc, -1, v29
  s_cbranch_vccnz reca_retry17
reca_resume18:
  s_waitcnt vmcnt(1)
  v_max_u32 v29, v132, v134
  v_cmp_eq_u32 vcc, -1, v29
  ds_write_b128 v4, v[128:131]
  s_cbranch_vccnz reca_retry19
reca_resume20:
  s_waitcnt vmcnt(0)
  v_max_u32 v29, v136, v138
  v_cmp_eq_u32 vcc, -1, v29
  ds_write_b128 v4, v[132:135] offset:1024
  s_cbranch_vccnz reca_retry21
reca_resume22:
  ds_write_b128 v5, v[136:139]
  s_branch reca_gotmem216
reca_gotmem15:
  ds_write_b128 v4, v[128:131]
  ds_write_b128 v4, v[132:135] offset:1024
  ds_write_b128 v5, v[136:139]
reca_gotmem216:
  s_and_b32 s34, s17, 3
  s_mul_i32 s21, s34, 6144
  s_add_u32 s21, s21, s39
  s_mul_i32 s22, s34, 12288
  s_add_u32 s22, s22, s40
  s_mul_i32 s25, s34, 393216
  s_add_u32 s25, s25, s56
  s_add_u32 s35, s17, 1
  s_and_b32 s35, s35, 3
  s_mul_i32 s24, s35, 10240
  s_add_u32 s24, s24, s38
  s_waitcnt lgkmcnt(0)
  s_barrier
  ds_read_b128 v[128:131], v236 offset:0
  ds_read_b128 v[132:135], v236 offset:1024
  ds_read_b128 v[136:139], v236 offset:2048
  ds_read_b128 v[140:143], v236 offset:3072
  ds_read_b128 v[144:147], v236 offset:4096
  ds_read_b128 v[148:151], v237 offset:0
  ds_read_b128 v[152:155], v237 offset:1024
  ds_read_b128 v[156:159], v237 offset:2048
  ds_read_b128 v[160:163], v237 offset:3072
  ds_read_b128 v[164:167], v237 offset:4096
  s_waitcnt lgkmcnt(9)
  v_mfma_f32_16x16x32_bf16 v[44:47], a[0:3], v[128:131], 0
  ds_read_b128 v[168:171], v6 offset:0
  v_mfma_f32_16x16x32_bf16 v[240:243], a[4:7], v[128:131], 0
  s_waitcnt lgkmcnt(9)
  v_mfma_f32_16x16x32_bf16 v[44:47], a[8:11], v[132:135], v[44:47]
  ds_read_b128 v[172:175], v6 offset:512
  v_mfma_f32_16x16x32_bf16 v[240:243], a[12:15], v[132:135], v[240:243]
  s_waitcnt lgkmcnt(9)
  v_mfma_f32_16x16x32_bf16 v[44:47], a[16:19], v[136:139], v[44:47]
  ds_read_b128 v[176:179], v6 offset:1024
  v_mfma_f32_16x16x32_bf16 v[240:243], a[20:23], v[136:139], v[240:243]
  s_waitcnt lgkmcnt(9)
  v_mfma_f32_16x16x32_bf16 v[44:47], a[24:27], v[140:143], v[44:47]
  ds_read_b128 v[180:183], v6 offset:1536
  v_mfma_f32_16x16x32_bf16 v[240:243], a[28:31], v[140:143], v[240:243]
  s_waitcnt lgkmcnt(9)
  v_mfma_f32_16x16x32_bf16 v[44:47], a[32:35], v[144:147], v[44:47]
  ds_read_b128 v[184:187], v6 offset:2048
  v_mfma_f32_16x16x32_bf16 v[240:243], a[36:39], v[144:147], v[240:243]
  s_waitcnt lgkmcnt(9)
  v_mfma_f32_16x16x32_bf16 v[44:47], a[40:43], v[148:151], v[44:47]
  ds_read_b128 v[188:191], v6 offset:2560
  v_mfma_f32_16x16x32_bf16 v[240:243], a[44:47], v[148:151], v[240:243]
  s_waitcnt lgkmcnt(9)
  v_mfma_f32_16x16x32_bf16 v[44:47], a[48:51], v[152:155], v[44:47]
  ds_read_b128 v[192:195], v6 offset:3072
  v_mfma_f32_16x16x32_bf16 v[240:243], a[52:55], v[152:155], v[240:243]
  s_waitcnt lgkmcnt(9)
  v_mfma_f32_16x16x32_bf16 v[44:47], a[56:59], v[156:159], v[44:47]
  ds_read_b128 v[196:199], v6 offset:3584
  v_mfma_f32_16x16x32_bf16 v[240:243], a[60:63], v[156:159], v[240:243]
  s_waitcnt lgkmcnt(9)
  v_mfma_f32_16x16x32_bf16 v[44:47], a[64:67], v[160:163], v[44:47]
  ds_read_b128 v[200:203], v6 offset:4096
  v_mfma_f32_16x16x32_bf16 v[240:243], a[68:71], v[160:163], v[240:243]
  s_waitcnt lgkmcnt(9)
  v_mfma_f32_16x16x32_bf16 v[44:47], a[72:75], v[164:167], v[44:47]
  ds_read_b128 v[204:207], v6 offset:4608
  v_mfma_f32_16x16x32_bf16 v[240:243], a[76:79], v[164:167], v[240:243]
  s_waitcnt lgkmcnt(9)
  v_mfma_f32_16x16x32_bf16 v[48:51], v[168:171], a[80:83], 0
  s_and_b32 s34, s17, 7
  s_lshl_b32 s34, s34, 5
  s_add_u32 s34, s34, s15
  s_mul_i32 s34, s34, 3072
  s_lshl_b32 s35, s16, 9
  s_add_u32 s34, s34, s35
  s_add_u32 s30, s34, 47185920
  s_add_u32 s31, s34, 47972352
  v_add_f32_dpp v44, v240, v44 row_ror:8 row_mask:0xf bank_mask:0xf
  v_add_f32_dpp v45, v241, v45 row_ror:8 row_mask:0xf bank_mask:0xf
  v_add_f32_dpp v46, v242, v46 row_ror:8 row_mask:0xf bank_mask:0xf
  v_add_f32_dpp v47, v243, v47 row_ror:8 row_mask:0xf bank_mask:0xf
  v_cvt_pk_bf16_f32 v52, v44, v45
  v_cvt_pk_bf16_f32 v53, v46, v47
  buffer_store_dwordx2 v[52:53], v8, s[4:7], s21 offen
  s_waitcnt lgkmcnt(8)
  v_mfma_f32_16x16x32_bf16 v[48:51], v[172:175], a[84:87], v[48:51]
  s_waitcnt lgkmcnt(7)
  v_mfma_f32_16x16x32_bf16 v[48:51], v[176:179], a[88:91], v[48:51]
  s_waitcnt lgkmcnt(6)
  v_mfma_f32_16x16x32_bf16 v[48:51], v[180:183], a[92:95], v[48:51]
  s_waitcnt lgkmcnt(5)
  v_mfma_f32_16x16x32_bf16 v[48:51], v[184:187], a[96:99], v[48:51]
  s_waitcnt lgkmcnt(4)
  v_mfma_f32_16x16x32_bf16 v[48:51], v[188:191], a[100:103], v[48:51]
  s_waitcnt lgkmcnt(3)
  v_mfma_f32_16x16x32_bf16 v[48:51], v[192:195], a[104:107], v[48:51]
  s_waitcnt lgkmcnt(2)
  v_mfma_f32_16x16x32_bf16 v[48:51], v[196:199], a[108:111], v[48:51]
  s_waitcnt lgkmcnt(1)
  v_mfma_f32_16x16x32_bf16 v[48:51], v[200:203], a[112:115], v[48:51]
  s_waitcnt lgkmcnt(0)
  v_mfma_f32_16x16x32_bf16 v[48:51], v[204:207], a[116:119], v[48:51]
  s_cmp_eq_u32 s12, 3
  s_cbranch_scc1 reca_swave23
  s_nop 5
  ds_write_b128 v17, v[48:51]
  s_add_u32 s34, s17, 2
  s_and_b32 s34, s34, 3
  s_mul_i32 s26, s34, 10240
  s_add_u32 s26, s26, s38
  s_mul_i32 s27, s34, 6144
  s_add_u32 s27, s27, s39
  s_mul_i32 s28, s34, 12288
  s_add_u32 s28, s28, s40
  s_mul_i32 s29, s34, 393216
  s_add_u32 s29, s29, s56
  s_waitcnt lgkmcnt(0)
  s_barrier
  s_cmp_eq_u32 s17, 63
  s_cbranch_scc1 reca_last25
  buffer_store_dwordx2 v[32:33], v8, s[4:7], s27 offen
  s_cmp_lg_u32 s12, 2
  s_cbranch_scc1 reca_b326
  buffer_store_dwordx2 v[52:53], v9, s[4:7], s30 offen
  buffer_store_dwordx2 v[32:33], v16, s[4:7], s26 offen
  s_cmp_lg_u32 s14, 0
  s_cbranch_scc1 reca_b326
  v_mov_b32 v28, s17
  s_lshl_b32 s34, s13, 7
  s_add_u32 s34, s34, 1507328
  buffer_store_dword v28, v19, s[4:7], s34 offen
  s_branch reca_b326
reca_last25:
  s_cmp_lg_u32 s12, 2
  s_cbranch_scc1 reca_exit1
  buffer_store_dwordx2 v[52:53], v9, s[4:7], s30 offen
  s_branch reca_exit1
reca_swave23:
  s_cmp_lg_u32 s17, 63
  s_cbranch_scc1 reca_vmst29
  s_barrier
  ds_read_b128 v[56:59], v1 offset:10240
  ds_read_b128 v[60:63], v1 offset:11264
  ds_read_b128 v[64:67], v1 offset:12288
  s_waitcnt lgkmcnt(0)
  v_add_f32 v56, v56, v64
  v_add_f32 v60, v60, v48
  v_add_f32 v57, v57, v65
  v_add_f32 v61, v61, v49
  v_add_f32 v58, v58, v66
  v_add_f32 v62, v62, v50
  v_add_f32 v59, v59, v67
  v_add_f32 v63, v63, v51
  v_cvt_pk_bf16_f32 v68, v56, v57
  v_cvt_pk_bf16_f32 v69, v58, v59
  v_cvt_pk_bf16_f32 v70, v60, v61
  v_cvt_pk_bf16_f32 v71, v62, v63
  buffer_store_dwordx2 v[52:53], v9, s[4:7], s30 offen
  buffer_store_dwordx2 v[68:69], v10, s[4:7], s31 offen
  buffer_store_dwordx2 v[70:71], v10, s[4:7], s31 offen offset:256
  s_branch reca_exit1
reca_vmst29:
  s_sleep 1
  buffer_load_dwordx4 v[208:211], v1, s[4:7], s21 offen offset:0 sc1
  buffer_load_dwordx4 v[212:215], v1, s[4:7], s21 offen offset:1024 sc1
  buffer_load_dwordx4 v[216:219], v1, s[4:7], s21 offen offset:2048 sc1
  buffer_load_dwordx4 v[220:223], v1, s[4:7], s21 offen offset:3072 sc1
  buffer_load_dwordx4 v[224:227], v2, s[4:7], s21 offen offset:0 sc1
  buffer_load_dwordx4 v[228:231], v2, s[4:7], s21 offen offset:1024 sc1
  s_waitcnt vmcnt(5)
  v_max_u32 v29, v208, v210
  v_cmp_eq_u32 vcc, -1, v29
  s_cbranch_vccnz reca_retry30
reca_resume31:
  s_waitcnt vmcnt(4)
  v_max_u32 v29, v212, v214
  v_cmp_eq_u32 vcc, -1, v29
  v_mfma_f32_16x16x32_bf16 v[76:79], a[120:123], v[208:211], 0
  v_mfma_f32_16x16x32_bf16 v[80:83], a[144:147], v[208:211], 0
  v_mfma_f32_16x16x32_bf16 v[72:75], v[208:211], v[208:211], v[40:43]
  s_cbranch_vccnz reca_retry32
reca_resume33:
  s_waitcnt vmcnt(3)
  v_max_u32 v29, v216, v218
  v_cmp_eq_u32 vcc, -1, v29
  v_mfma_f32_16x16x32_bf16 v[76:79], a[124:127], v[212:215], v[76:79]
  v_mfma_f32_16x16x32_bf16 v[80:83], a[148:151], v[212:215], v[80:83]
  v_mfma_f32_16x16x32_bf16 v[72:75], v[212:215], v[212:215], v[72:75]
  s_cbranch_vccnz reca_retry34
reca_resume35:
  s_waitcnt vmcnt(2)
  v_max_u32 v29, v220, v222
  v_cmp_eq_u32 vcc, -1, v29
  v_mfma_f32_16x16x32_bf16 v[76:79], a[128:131], v[216:219], v[76:79]
  v_mfma_f32_16x16x32_bf16 v[80:83], a[152:155], v[216:219], v[80:83]
  v_mfma_f32_16x16x32_bf16 v[72:75], v[216:219], v[216:219], v[72:75]
  s_cbranch_vccnz reca_retry36
reca_resume37:
  s_waitcnt vmcnt(1)
  v_max_u32 v29, v224, v226
  v_cmp_eq_u32 vcc, -1, v29
  v_mfma_f32_16x16x32_bf16 v[76:79], a[132:135], v[220:223], v[76:79]
  v_mfma_f32_16x16x32_bf16 v[80:83], a[156:159], v[220:223], v[80:83]
  v_mfma_f32_16x16x32_bf16 v[72:75], v[220:223], v[220:223], v[72:75]
  s_cbranch_vccnz reca_retry38
reca_resume39:
  s_waitcnt vmcnt(0)
  v_max_u32 v29, v228, v230
  v_cmp_eq_u32 vcc, -1, v29
  v_mfma_f32_16x16x32_bf16 v[76:79], a[136:139], v[224:227], v[76:79]
  v_mfma_f32_16x16x32_bf16 v[80:83], a[160:163], v[224:227], v[80:83]
  v_mfma_f32_16x16x32_bf16 v[72:75], v[224:227], v[224:227], v[72:75]
  s_cbranch_vccnz reca_retry40
reca_resume41:
  v_mfma_f32_16x16x32_bf16 v[76:79], a[140:143], v[228:231], v[76:79]
  v_mfma_f32_16x16x32_bf16 v[80:83], a[164:167], v[228:231], v[80:83]
  v_mfma_f32_16x16x32_bf16 v[72:75], v[228:231], v[228:231], v[72:75]
  s_barrier
  ds_read_b128 v[56:59], v1 offset:10240
  ds_read_b128 v[60:63], v1 offset:11264
  ds_read_b128 v[64:67], v1 offset:12288
  s_nop 1
  v_max3_f32 v28, v76, v77, v78
  v_max3_f32 v29, v80, v81, v82
  v_max3_f32 v28, v28, v79, v83
  v_max3_f32 v29, v29, v72, v73
  v_max3_f32 v28, v28, v74, v75
  v_max_f32 v28, v28, v29
  v_mov_b32 v29, v28
  s_nop 1
  v_permlane32_swap_b32 v28, v29
  v_max_f32 v28, v28, v29
  v_mov_b32 v29, v28
  s_nop 1
  v_permlane16_swap_b32 v28, v29
  v_max_f32 v28, v28, v29
  v_mul_f32 v28, s41, v28
  v_fma_f32 v76, v76, s41, -v28
  v_fma_f32 v77, v77, s41, -v28
  v_fma_f32 v78, v78, s41, -v28
  v_fma_f32 v79, v79, s41, -v28
  v_fma_f32 v80, v80, s41, -v28
  v_fma_f32 v81, v81, s41, -v28
  v_fma_f32 v82, v82, s41, -v28
  v_fma_f32 v83, v83, s41, -v28
  v_fma_f32 v72, v72, s41, -v28
  v_fma_f32 v73, v73, s41, -v28
  v_fma_f32 v74, v74, s41, -v28
  v_fma_f32 v75, v75, s41, -v28
  v_exp_f32 v76, v76
  v_exp_f32 v77, v77
  v_exp_f32 v78, v78
  v_exp_f32 v79, v79
  v_exp_f32 v80, v80
  v_exp_f32 v81, v81
  v_exp_f32 v82, v82
  v_exp_f32 v83, v83
  v_cvt_pk_bf16_f32 v84, v76, v77
  v_cvt_pk_bf16_f32 v85, v78, v79
  v_cvt_pk_bf16_f32 v86, v80, v81
  v_cvt_pk_bf16_f32 v87, v82, v83
  v_exp_f32 v72, v72
  v_exp_f32 v73, v73
  v_mfma_f32_16x16x32_bf16 v[100:103], v[36:39], v[84:87], 0
  v_exp_f32 v74, v74
  v_exp_f32 v75, v75
  v_mfma_f32_16x16x32_bf16 v[92:95], a[168:171], v[84:87], 0
  v_cvt_pk_bf16_f32 v88, v72, v73
  v_cvt_pk_bf16_f32 v89, v74, v75
  v_mfma_f32_16x16x32_bf16 v[96:99], a[172:175], v[84:87], 0
  s_waitcnt lgkmcnt(0)
  v_mfma_f32_16x16x16_bf16 v[100:103], v[36:37], v[88:89], v[100:103]
  v_add_f32 v56, v56, v64
  v_add_f32 v60, v60, v48
  v_add_f32 v57, v57, v65
  v_add_f32 v61, v61, v49
  v_add_f32 v58, v58, v66
  v_add_f32 v62, v62, v50
  v_add_f32 v59, v59, v67
  v_add_f32 v63, v63, v51
  v_cvt_pk_bf16_f32 v68, v56, v57
  v_cvt_pk_bf16_f32 v69, v58, v59
  v_cvt_pk_bf16_f32 v70, v60, v61
  v_cvt_pk_bf16_f32 v71, v62, v63
  v_mfma_f32_16x16x16_bf16 v[92:95], v[68:69], v[88:89], v[92:95]
  v_rcp_f32 v28, v100
  v_mfma_f32_16x16x16_bf16 v[96:99], v[70:71], v[88:89], v[96:99]
  v_mov_b32 v29, v28
  s_nop 4
  v_pk_mul_f32 v[92:93], v[92:93], v[28:29]
  v_pk_mul_f32 v[94:95], v[94:95], v[28:29]
  v_pk_mul_f32 v[96:97], v[96:97], v[28:29]
  v_pk_mul_f32 v[98:99], v[98:99], v[28:29]
  v_cvt_pk_bf16_f32 v104, v92, v93
  v_cvt_pk_bf16_f32 v105, v94, v95
  v_cvt_pk_bf16_f32 v106, v96, v97
  v_cvt_pk_bf16_f32 v107, v98, v99
  buffer_store_dwordx4 v[104:107], v11, s[4:7], s22 offen
reca_b326:
  s_barrier
  s_cmp_ge_u32 s12, 2
  s_cbranch_scc1 reca_notg242
  s_sleep 3
  buffer_load_dwordx4 v[128:131], v12, s[4:7], s22 offen offset:0 sc1
  buffer_load_dwordx4 v[132:135], v12, s[4:7], s22 offen offset:1024 sc1
  buffer_load_dwordx4 v[136:139], v12, s[4:7], s22 offen offset:2048 sc1
  buffer_load_dwordx4 v[140:143], v12, s[4:7], s22 offen offset:3072 sc1
  buffer_load_dwordx4 v[144:147], v13, s[4:7], s22 offen offset:0 sc1
  buffer_load_dwordx4 v[148:151], v13, s[4:7], s22 offen offset:1024 sc1
  buffer_load_dwordx4 v[152:155], v13, s[4:7], s22 offen offset:2048 sc1
  buffer_load_dwordx4 v[156:159], v13, s[4:7], s22 offen offset:3072 sc1
  buffer_load_dwordx4 v[160:163], v14, s[4:7], s22 offen offset:0 sc1
  buffer_load_dwordx4 v[164:167], v14, s[4:7], s22 offen offset:1024 sc1
  buffer_load_dwordx4 v[168:171], v14, s[4:7], s22 offen offset:2048 sc1
  buffer_load_dwordx4 v[172:175], v14, s[4:7], s22 offen offset:3072 sc1
  s_waitcnt vmcnt(11)
  v_cmp_eq_u32 vcc, -1, v128
  s_cbranch_vccnz reca_retry43
reca_resume44:
  s_waitcnt vmcnt(10)
  v_cmp_eq_u32 vcc, -1, v132
  v_mfma_f32_16x16x32_bf16 v[108:111], a[120:123], v[128:131], 0
  v_mfma_f32_16x16x32_bf16 v[112:115], a[124:127], v[128:131], 0
  s_cbranch_vccnz reca_retry45
reca_resume46:
  s_waitcnt vmcnt(9)
  v_cmp_eq_u32 vcc, -1, v136
  v_mfma_f32_16x16x32_bf16 v[108:111], a[128:131], v[132:135], v[108:111]
  v_mfma_f32_16x16x32_bf16 v[112:115], a[132:135], v[132:135], v[112:115]
  s_cbranch_vccnz reca_retry47
reca_resume48:
  s_waitcnt vmcnt(8)
  v_cmp_eq_u32 vcc, -1, v140
  v_mfma_f32_16x16x32_bf16 v[108:111], a[136:139], v[136:139], v[108:111]
  v_mfma_f32_16x16x32_bf16 v[112:115], a[140:143], v[136:139], v[112:115]
  s_cbranch_vccnz reca_retry49
reca_resume50:
  s_waitcnt vmcnt(7)
  v_cmp_eq_u32 vcc, -1, v144
  v_mfma_f32_16x16x32_bf16 v[108:111], a[144:147], v[140:143], v[108:111]
  v_mfma_f32_16x16x32_bf16 v[112:115], a[148:151], v[140:143], v[112:115]
  s_cbranch_vccnz reca_retry51
reca_resume52:
  s_waitcnt vmcnt(6)
  v_cmp_eq_u32 vcc, -1, v148
  v_mfma_f32_16x16x32_bf16 v[108:111], a[152:155], v[144:147], v[108:111]
  v_mfma_f32_16x16x32_bf16 v[112:115], a[156:159], v[144:147], v[112:115]
  s_cbranch_vccnz reca_retry53
reca_resume54:
  s_waitcnt vmcnt(5)
  v_cmp_eq_u32 vcc, -1, v152
  v_mfma_f32_16x16x32_bf16 v[108:111], a[160:163], v[148:151], v[108:111]
  v_mfma_f32_16x16x32_bf16 v[112:115], a[164:167], v[148:151], v[112:115]
  s_cbranch_vccnz reca_retry55
reca_resume56:
  s_waitcnt vmcnt(4)
  v_cmp_eq_u32 vcc, -1, v156
  v_mfma_f32_16x16x32_bf16 v[108:111], a[168:171], v[152:155], v[108:111]
  v_mfma_f32_16x16x32_bf16 v[112:115], a[172:175], v[152:155], v[112:115]
  s_cbranch_vccnz reca_retry57
reca_resume58:
  s_waitcnt vmcnt(3)
  v_cmp_eq_u32 vcc, -1, v160
  v_mfma_f32_16x16x32_bf16 v[108:111], a[176:179], v[156:159], v[108:111]
  v_mfma_f32_16x16x32_bf16 v[112:115], a[180:183], v[156:159], v[112:115]
  s_cbranch_vccnz reca_retry59
reca_resume60:
  s_waitcnt vmcnt(2)
  v_cmp_eq_u32 vcc, -1, v164
  v_mfma_f32_16x16x32_bf16 v[108:111], a[184:187], v[160:163], v[108:111]
  v_mfma_f32_16x16x32_bf16 v[112:115], a[188:191], v[160:163], v[112:115]
  s_cbranch_vccnz reca_retry61
reca_resume62:
  s_waitcnt vmcnt(1)
  v_cmp_eq_u32 vcc, -1, v168
  v_mfma_f32_16x16x32_bf16 v[108:111], a[192:195], v[164:167], v[108:111]
  v_mfma_f32_16x16x32_bf16 v[112:115], a[196:199], v[164:167], v[112:115]
  s_cbranch_vccnz reca_retry63
reca_resume64:
  s_waitcnt vmcnt(0)
  v_cmp_eq_u32 vcc, -1, v172
  v_mfma_f32_16x16x32_bf16 v[108:111], a[200:203], v[168:171], v[108:111]
  v_mfma_f32_16x16x32_bf16 v[112:115], a[204:207], v[168:171], v[112:115]
  s_cbranch_vccnz reca_retry65
reca_resume66:
  v_mfma_f32_16x16x32_bf16 v[108:111], a[208:211], v[172:175], v[108:111]
  v_mfma_f32_16x16x32_bf16 v[112:115], a[212:215], v[172:175], v[112:115]
  s_nop 7
  v_add_f32_dpp v116, v112, v108 row_ror:8 row_mask:0xf bank_mask:0xf
  v_add_f32_dpp v117, v113, v109 row_ror:8 row_mask:0xf bank_mask:0xf
  v_add_f32_dpp v118, v114, v110 row_ror:8 row_mask:0xf bank_mask:0xf
  v_add_f32_dpp v119, v115, v111 row_ror:8 row_mask:0xf bank_mask:0xf
  buffer_store_dwordx4 v[116:119], v15, s[4:7], s25 offen sc1
  buffer_store_dwordx4 v[116:119], v232, s[4:7], s25 offen sc1
  buffer_store_dwordx4 v[32:35], v15, s[4:7], s29 offen sc1
  buffer_store_dwordx4 v[32:35], v232, s[4:7], s29 offen sc1
  s_branch reca_b427
reca_notg242:
  s_cmp_lg_u32 s12, 3
  s_cbranch_scc1 reca_b427
  s_add_u32 s34, s17, 2
  s_and_b32 s34, s34, 3
  s_mul_i32 s26, s34, 10240
  s_add_u32 s26, s26, s38
  s_mul_i32 s27, s34, 6144
  s_add_u32 s27, s27, s39
  s_mul_i32 s28, s34, 12288
  s_add_u32 s28, s28, s40
  s_mul_i32 s29, s34, 393216
  s_add_u32 s29, s29, s56
  buffer_store_dwordx2 v[32:33], v8, s[4:7], s27 offen
  buffer_store_dwordx4 v[32:35], v11, s[4:7], s28 offen
reca_b427:
  s_barrier
  s_cmp_lg_u32 s12, 2
  s_cbranch_scc1 reca_not267
  s_sleep 8
  buffer_load_dwordx4 v[128:131], v20, s[4:7], s25 offen sc1
  buffer_load_dwordx4 v[132:135], v21, s[4:7], s25 offen sc1
  buffer_load_dwordx4 v[136:139], v22, s[4:7], s25 offen sc1
  buffer_load_dwordx4 v[140:143], v23, s[4:7], s25 offen sc1
  buffer_load_dwordx4 v[144:147], v24, s[4:7], s25 offen sc1
  buffer_load_dwordx4 v[148:151], v25, s[4:7], s25 offen sc1
  buffer_load_dwordx4 v[152:155], v26, s[4:7], s25 offen sc1
  buffer_load_dwordx4 v[156:159], v27, s[4:7], s25 offen sc1
  s_waitcnt vmcnt(7)
  v_cmp_eq_u32 vcc, -1, v128
  s_cbranch_vccnz reca_retry68
reca_resume69:
  s_waitcnt vmcnt(6)
  v_cmp_eq_u32 vcc, -1, v132
  s_cbranch_vccnz reca_retry70
reca_resume71:
  s_waitcnt vmcnt(5)
  v_cmp_eq_u32 vcc, -1, v136
  v_pk_add_f32 v[116:117], v[128:129], v[132:133]
  v_pk_add_f32 v[118:119], v[130:131], v[134:135]
  s_cbranch_vccnz reca_retry72
reca_resume73:
  s_waitcnt vmcnt(4)
  v_cmp_eq_u32 vcc, -1, v140
  v_pk_add_f32 v[116:117], v[116:117], v[136:137]
  v_pk_add_f32 v[118:119], v[118:119], v[138:139]
  s_cbranch_vccnz reca_retry74
reca_resume75:
  s_waitcnt vmcnt(3)
  v_cmp_eq_u32 vcc, -1, v144
  v_pk_add_f32 v[116:117], v[116:117], v[140:141]
  v_pk_add_f32 v[118:119], v[118:119], v[142:143]
  s_cbranch_vccnz reca_retry76
reca_resume77:
  s_waitcnt vmcnt(2)
  v_cmp_eq_u32 vcc, -1, v148
  v_pk_add_f32 v[116:117], v[116:117], v[144:145]
  v_pk_add_f32 v[118:119], v[118:119], v[146:147]
  s_cbranch_vccnz reca_retry78
reca_resume79:
  s_waitcnt vmcnt(1)
  v_cmp_eq_u32 vcc, -1, v152
  v_pk_add_f32 v[116:117], v[116:117], v[148:149]
  v_pk_add_f32 v[118:119], v[118:119], v[150:151]
  s_cbranch_vccnz reca_retry80
reca_resume81:
  s_waitcnt vmcnt(0)
  v_cmp_eq_u32 vcc, -1, v156
  v_pk_add_f32 v[116:117], v[116:117], v[152:153]
  v_pk_add_f32 v[118:119], v[118:119], v[154:155]
  s_cbranch_vccnz reca_retry82
reca_resume83:
  v_pk_add_f32 v[116:117], v[116:117], v[156:157]
  v_pk_add_f32 v[118:119], v[118:119], v[158:159]
  v_cvt_pk_bf16_f32 v132, v116, v117
  v_cvt_pk_bf16_f32 v133, v118, v119
  buffer_store_dwordx2 v[132:133], v16, s[4:7], s24 offen
  s_branch reca_b528
reca_not267:
  s_cmp_lg_u32 s12, 3
  s_cbranch_scc1 reca_b528
  s_add_u32 s36, s17, 1
  s_cmp_ge_u32 s36, 63
  s_cbranch_scc1 reca_nopf84
  s_add_u32 s37, s36, 1
reca_pf85:
  buffer_load_dword v28, v233, s[4:7], 0 offen sc1
  s_waitcnt vmcnt(0)
  v_cmp_gt_i32 vcc, s37, v28
  s_cbranch_vccz reca_pfok86
  s_sleep 1
  s_sub_u32 s18, s18, 1
  s_cbranch_scc0 reca_pf85
  s_mov_b32 s18, 0
reca_pfok86:
  s_lshl_b32 s34, s15, 3
  s_and_b32 s35, s36, 7
  s_add_u32 s34, s34, s35
  s_mul_i32 s34, s34, 12288
  s_add_u32 s32, s34, 37748736
  s_lshl_b32 s35, s16, 11
  s_add_u32 s34, s34, s35
  s_add_u32 s33, s34, 40894464
  buffer_load_dwordx4 a[120:123], v1, s[4:7], s32 offen offset:0 sc1
  buffer_load_dwordx4 a[124:127], v1, s[4:7], s32 offen offset:1024 sc1
  buffer_load_dwordx4 a[128:131], v1, s[4:7], s32 offen offset:2048 sc1
  buffer_load_dwordx4 a[132:135], v1, s[4:7], s32 offen offset:3072 sc1
  buffer_load_dwordx4 a[136:139], v2, s[4:7], s32 offen offset:0 sc1
  buffer_load_dwordx4 a[140:143], v2, s[4:7], s32 offen offset:1024 sc1
  buffer_load_dwordx4 a[144:147], v2, s[4:7], s32 offen offset:2048 sc1
  buffer_load_dwordx4 a[148:151], v2, s[4:7], s32 offen offset:3072 sc1
  buffer_load_dwordx4 a[152:155], v3, s[4:7], s32 offen offset:0 sc1
  buffer_load_dwordx4 a[156:159], v3, s[4:7], s32 offen offset:1024 sc1
  buffer_load_dwordx4 a[160:163], v3, s[4:7], s32 offen offset:2048 sc1
  buffer_load_dwordx4 a[164:167], v3, s[4:7], s32 offen offset:3072 sc1
  buffer_load_dwordx4 a[168:171], v1, s[4:7], s33 offen offset:0 sc1
  buffer_load_dwordx4 a[172:175], v1, s[4:7], s33 offen offset:1024 sc1
reca_nopf84:
  buffer_store_dwordx2 v[52:53], v9, s[4:7], s30 offen
  buffer_store_dwordx2 v[68:69], v10, s[4:7], s31 offen
  buffer_store_dwordx2 v[70:71], v10, s[4:7], s31 offen offset:256
reca_b528:
  s_barrier
  s_add_u32 s17, s17, 1
  s_branch reca_step14
reca_retry17:
  s_sub_u32 s18, s18, 1
  s_cbranch_scc1 reca_retry17_to
  buffer_load_dwordx4 v[128:131], v4, s[4:7], s20 offen sc1
  buffer_load_dwordx4 v[132:135], v4, s[4:7], s20 offen offset:1024 sc1
  buffer_load_dwordx4 v[136:139], v5, s[4:7], s20 offen sc1
  s_waitcnt vmcnt(2)
  v_max_u32 v29, v128, v130
  v_cmp_eq_u32 vcc, -1, v29
  s_cbranch_vccnz reca_retry17
  s_branch reca_resume18
reca_retry17_to:
  s_mov_b32 s18, 0
  s_waitcnt vmcnt(0)
  s_branch reca_resume18
reca_retry19:
  s_sub_u32 s18, s18, 1
  s_cbranch_scc1 reca_retry19_to
  buffer_load_dwordx4 v[132:135], v4, s[4:7], s20 offen offset:1024 sc1
  buffer_load_dwordx4 v[136:139], v5, s[4:7], s20 offen sc1
  s_waitcnt vmcnt(1)
  v_max_u32 v29, v132, v134
  v_cmp_eq_u32 vcc, -1, v29
  s_cbranch_vccnz reca_retry19
  s_branch reca_resume20
reca_retry19_to:
  s_mov_b32 s18, 0
  s_waitcnt vmcnt(0)
  s_branch reca_resume20
reca_retry21:
  s_sub_u32 s18, s18, 1
  s_cbranch_scc1 reca_retry21_to
  buffer_load_dwordx4 v[136:139], v5, s[4:7], s20 offen sc1
  s_waitcnt vmcnt(0)
  v_max_u32 v29, v136, v138
  v_cmp_eq_u32 vcc, -1, v29
  s_cbranch_vccnz reca_retry21
  s_branch reca_resume22
reca_retry21_to:
  s_mov_b32 s18, 0
  s_waitcnt vmcnt(0)
  s_branch reca_resume22
reca_retry30:
  s_sub_u32 s18, s18, 1
  s_cbranch_scc1 reca_retry30_to
  buffer_load_dwordx4 v[208:211], v1, s[4:7], s21 offen offset:0 sc1
  buffer_load_dwordx4 v[212:215], v1, s[4:7], s21 offen offset:1024 sc1
  buffer_load_dwordx4 v[216:219], v1, s[4:7], s21 offen offset:2048 sc1
  buffer_load_dwordx4 v[220:223], v1, s[4:7], s21 offen offset:3072 sc1
  buffer_load_dwordx4 v[224:227], v2, s[4:7], s21 offen offset:0 sc1
  buffer_load_dwordx4 v[228:231], v2, s[4:7], s21 offen offset:1024 sc1
  s_waitcnt vmcnt(5)
  v_max_u32 v29, v208, v210
  v_cmp_eq_u32 vcc, -1, v29
  s_cbranch_vccnz reca_retry30
  s_branch reca_resume31
reca_retry30_to:
  s_mov_b32 s18, 0
  s_waitcnt vmcnt(0)
  s_branch reca_resume31
reca_retry32:
  s_sub_u32 s18, s18, 1
  s_cbranch_scc1 reca_retry32_to
  buffer_load_dwordx4 v[212:215], v1, s[4:7], s21 offen offset:1024 sc1
  buffer_load_dwordx4 v[216:219], v1, s[4:7], s21 offen offset:2048 sc1
  buffer_load_dwordx4 v[220:223], v1, s[4:7], s21 offen offset:3072 sc1
  buffer_load_dwordx4 v[224:227], v2, s[4:7], s21 offen offset:0 sc1
  buffer_load_dwordx4 v[228:231], v2, s[4:7], s21 offen offset:1024 sc1
  s_waitcnt vmcnt(4)
  v_max_u32 v29, v212, v214
  v_cmp_eq_u32 vcc, -1, v29
  s_cbranch_vccnz reca_retry32
  s_branch reca_resume33
reca_retry32_to:
  s_mov_b32 s18, 0
  s_waitcnt vmcnt(0)
  s_branch reca_resume33
reca_retry34:
  s_sub_u32 s18, s18, 1
  s_cbranch_scc1 reca_retry34_to
  buffer_load_dwordx4 v[216:219], v1, s[4:7], s21 offen offset:2048 sc1
  buffer_load_dwordx4 v[220:223], v1, s[4:7], s21 offen offset:3072 sc1
  buffer_load_dwordx4 v[224:227], v2, s[4:7], s21 offen offset:0 sc1
  buffer_load_dwordx4 v[228:231], v2, s[4:7], s21 offen offset:1024 sc1
  s_waitcnt vmcnt(3)
  v_max_u32 v29, v216, v218
  v_cmp_eq_u32 vcc, -1, v29
  s_cbranch_vccnz reca_retry34
  s_branch reca_resume35
reca_retry34_to:
  s_mov_b32 s18, 0
  s_waitcnt vmcnt(0)
  s_branch reca_resume35
reca_retry36:
  s_sub_u32 s18, s18, 1
  s_cbranch_scc1 reca_retry36_to
  buffer_load_dwordx4 v[220:223], v1, s[4:7], s21 offen offset:3072 sc1
  buffer_load_dwordx4 v[224:227], v2, s[4:7], s21 offen offset:0 sc1
  buffer_load_dwordx4 v[228:231], v2, s[4:7], s21 offen offset:1024 sc1
  s_waitcnt vmcnt(2)
  v_max_u32 v29, v220, v222
  v_cmp_eq_u32 vcc, -1, v29
  s_cbranch_vccnz reca_retry36
  s_branch reca_resume37
reca_retry36_to:
  s_mov_b32 s18, 0
  s_waitcnt vmcnt(0)
  s_branch reca_resume37
reca_retry38:
  s_sub_u32 s18, s18, 1
  s_cbranch_scc1 reca_retry38_to
  buffer_load_dwordx4 v[224:227], v2, s[4:7], s21 offen offset:0 sc1
  buffer_load_dwordx4 v[228:231], v2, s[4:7], s21 offen offset:1024 sc1
  s_waitcnt vmcnt(1)
  v_max_u32 v29, v224, v226
  v_cmp_eq_u32 vcc, -1, v29
  s_cbranch_vccnz reca_retry38
  s_branch reca_resume39
reca_retry38_to:
  s_mov_b32 s18, 0
  s_waitcnt vmcnt(0)
  s_branch reca_resume39
reca_retry40:
  s_sub_u32 s18, s18, 1
  s_cbranch_scc1 reca_retry40_to
  buffer_load_dwordx4 v[228:231], v2, s[4:7], s21 offen offset:1024 sc1
  s_waitcnt vmcnt(0)
  v_max_u32 v29, v228, v230
  v_cmp_eq_u32 vcc, -1, v29
  s_cbranch_vccnz reca_retry40
  s_branch reca_resume41
reca_retry40_to:
  s_mov_b32 s18, 0
  s_waitcnt vmcnt(0)
  s_branch reca_resume41
reca_retry43:
  s_sub_u32 s18, s18, 1
  s_cbranch_scc1 reca_retry43_to
  buffer_load_dwordx4 v[128:131], v12, s[4:7], s22 offen offset:0 sc1
  buffer_load_dwordx4 v[132:135], v12, s[4:7], s22 offen offset:1024 sc1
  buffer_load_dwordx4 v[136:139], v12, s[4:7], s22 offen offset:2048 sc1
  buffer_load_dwordx4 v[140:143], v12, s[4:7], s22 offen offset:3072 sc1
  buffer_load_dwordx4 v[144:147], v13, s[4:7], s22 offen offset:0 sc1
  buffer_load_dwordx4 v[148:151], v13, s[4:7], s22 offen offset:1024 sc1
  buffer_load_dwordx4 v[152:155], v13, s[4:7], s22 offen offset:2048 sc1
  buffer_load_dwordx4 v[156:159], v13, s[4:7], s22 offen offset:3072 sc1
  buffer_load_dwordx4 v[160:163], v14, s[4:7], s22 offen offset:0 sc1
  buffer_load_dwordx4 v[164:167], v14, s[4:7], s22 offen offset:1024 sc1
  buffer_load_dwordx4 v[168:171], v14, s[4:7], s22 offen offset:2048 sc1
  buffer_load_dwordx4 v[172:175], v14, s[4:7], s22 offen offset:3072 sc1
  s_waitcnt vmcnt(11)
  v_cmp_eq_u32 vcc, -1, v128
  s_cbranch_vccnz reca_retry43
  s_branch reca_resume44
reca_retry43_to:
  s_mov_b32 s18, 0
  s_waitcnt vmcnt(0)
  s_branch reca_resume44
reca_retry45:
  s_sub_u32 s18, s18, 1
  s_cbranch_scc1 reca_retry45_to
  buffer_load_dwordx4 v[132:135], v12, s[4:7], s22 offen offset:1024 sc1
  buffer_load_dwordx4 v[136:139], v12, s[4:7], s22 offen offset:2048 sc1
  buffer_load_dwordx4 v[140:143], v12, s[4:7], s22 offen offset:3072 sc1
  buffer_load_dwordx4 v[144:147], v13, s[4:7], s22 offen offset:0 sc1
  buffer_load_dwordx4 v[148:151], v13, s[4:7], s22 offen offset:1024 sc1
  buffer_load_dwordx4 v[152:155], v13, s[4:7], s22 offen offset:2048 sc1
  buffer_load_dwordx4 v[156:159], v13, s[4:7], s22 offen offset:3072 sc1
  buffer_load_dwordx4 v[160:163], v14, s[4:7], s22 offen offset:0 sc1
  buffer_load_dwordx4 v[164:167], v14, s[4:7], s22 offen offset:1024 sc1
  buffer_load_dwordx4 v[168:171], v14, s[4:7], s22 offen offset:2048 sc1
  buffer_load_dwordx4 v[172:175], v14, s[4:7], s22 offen offset:3072 sc1
  s_waitcnt vmcnt(10)
  v_cmp_eq_u32 vcc, -1, v132
  s_cbranch_vccnz reca_retry45
  s_branch reca_resume46
reca_retry45_to:
  s_mov_b32 s18, 0
  s_waitcnt vmcnt(0)
  s_branch reca_resume46
reca_retry47:
  s_sub_u32 s18, s18, 1
  s_cbranch_scc1 reca_retry47_to
  buffer_load_dwordx4 v[136:139], v12, s[4:7], s22 offen offset:2048 sc1
  buffer_load_dwordx4 v[140:143], v12, s[4:7], s22 offen offset:3072 sc1
  buffer_load_dwordx4 v[144:147], v13, s[4:7], s22 offen offset:0 sc1
  buffer_load_dwordx4 v[148:151], v13, s[4:7], s22 offen offset:1024 sc1
  buffer_load_dwordx4 v[152:155], v13, s[4:7], s22 offen offset:2048 sc1
  buffer_load_dwordx4 v[156:159], v13, s[4:7], s22 offen offset:3072 sc1
  buffer_load_dwordx4 v[160:163], v14, s[4:7], s22 offen offset:0 sc1
  buffer_load_dwordx4 v[164:167], v14, s[4:7], s22 offen offset:1024 sc1
  buffer_load_dwordx4 v[168:171], v14, s[4:7], s22 offen offset:2048 sc1
  buffer_load_dwordx4 v[172:175], v14, s[4:7], s22 offen offset:3072 sc1
  s_waitcnt vmcnt(9)
  v_cmp_eq_u32 vcc, -1, v136
  s_cbranch_vccnz reca_retry47
  s_branch reca_resume48
reca_retry47_to:
  s_mov_b32 s18, 0
  s_waitcnt vmcnt(0)
  s_branch reca_resume48
reca_retry49:
  s_sub_u32 s18, s18, 1
  s_cbranch_scc1 reca_retry49_to
  buffer_load_dwordx4 v[140:143], v12, s[4:7], s22 offen offset:3072 sc1
  buffer_load_dwordx4 v[144:147], v13, s[4:7], s22 offen offset:0 sc1
  buffer_load_dwordx4 v[148:151], v13, s[4:7], s22 offen offset:1024 sc1
  buffer_load_dwordx4 v[152:155], v13, s[4:7], s22 offen offset:2048 sc1
  buffer_load_dwordx4 v[156:159], v13, s[4:7], s22 offen offset:3072 sc1
  buffer_load_dwordx4 v[160:163], v14, s[4:7], s22 offen offset:0 sc1
  buffer_load_dwordx4 v[164:167], v14, s[4:7], s22 offen offset:1024 sc1
  buffer_load_dwordx4 v[168:171], v14, s[4:7], s22 offen offset:2048 sc1
  buffer_load_dwordx4 v[172:175], v14, s[4:7], s22 offen offset:3072 sc1
  s_waitcnt vmcnt(8)
  v_cmp_eq_u32 vcc, -1, v140
  s_cbranch_vccnz reca_retry49
  s_branch reca_resume50
reca_retry49_to:
  s_mov_b32 s18, 0
  s_waitcnt vmcnt(0)
  s_branch reca_resume50
reca_retry51:
  s_sub_u32 s18, s18, 1
  s_cbranch_scc1 reca_retry51_to
  buffer_load_dwordx4 v[144:147], v13, s[4:7], s22 offen offset:0 sc1
  buffer_load_dwordx4 v[148:151], v13, s[4:7], s22 offen offset:1024 sc1
  buffer_load_dwordx4 v[152:155], v13, s[4:7], s22 offen offset:2048 sc1
  buffer_load_dwordx4 v[156:159], v13, s[4:7], s22 offen offset:3072 sc1
  buffer_load_dwordx4 v[160:163], v14, s[4:7], s22 offen offset:0 sc1
  buffer_load_dwordx4 v[164:167], v14, s[4:7], s22 offen offset:1024 sc1
  buffer_load_dwordx4 v[168:171], v14, s[4:7], s22 offen offset:2048 sc1
  buffer_load_dwordx4 v[172:175], v14, s[4:7], s22 offen offset:3072 sc1
  s_waitcnt vmcnt(7)
  v_cmp_eq_u32 vcc, -1, v144
  s_cbranch_vccnz reca_retry51
  s_branch reca_resume52
reca_retry51_to:
  s_mov_b32 s18, 0
  s_waitcnt vmcnt(0)
  s_branch reca_resume52
reca_retry53:
  s_sub_u32 s18, s18, 1
  s_cbranch_scc1 reca_retry53_to
  buffer_load_dwordx4 v[148:151], v13, s[4:7], s22 offen offset:1024 sc1
  buffer_load_dwordx4 v[152:155], v13, s[4:7], s22 offen offset:2048 sc1
  buffer_load_dwordx4 v[156:159], v13, s[4:7], s22 offen offset:3072 sc1
  buffer_load_dwordx4 v[160:163], v14, s[4:7], s22 offen offset:0 sc1
  buffer_load_dwordx4 v[164:167], v14, s[4:7], s22 offen offset:1024 sc1
  buffer_load_dwordx4 v[168:171], v14, s[4:7], s22 offen offset:2048 sc1
  buffer_load_dwordx4 v[172:175], v14, s[4:7], s22 offen offset:3072 sc1
  s_waitcnt vmcnt(6)
  v_cmp_eq_u32 vcc, -1, v148
  s_cbranch_vccnz reca_retry53
  s_branch reca_resume54
reca_retry53_to:
  s_mov_b32 s18, 0
  s_waitcnt vmcnt(0)
  s_branch reca_resume54
reca_retry55:
  s_sub_u32 s18, s18, 1
  s_cbranch_scc1 reca_retry55_to
  buffer_load_dwordx4 v[152:155], v13, s[4:7], s22 offen offset:2048 sc1
  buffer_load_dwordx4 v[156:159], v13, s[4:7], s22 offen offset:3072 sc1
  buffer_load_dwordx4 v[160:163], v14, s[4:7], s22 offen offset:0 sc1
  buffer_load_dwordx4 v[164:167], v14, s[4:7], s22 offen offset:1024 sc1
  buffer_load_dwordx4 v[168:171], v14, s[4:7], s22 offen offset:2048 sc1
  buffer_load_dwordx4 v[172:175], v14, s[4:7], s22 offen offset:3072 sc1
  s_waitcnt vmcnt(5)
  v_cmp_eq_u32 vcc, -1, v152
  s_cbranch_vccnz reca_retry55
  s_branch reca_resume56
reca_retry55_to:
  s_mov_b32 s18, 0
  s_waitcnt vmcnt(0)
  s_branch reca_resume56
reca_retry57:
  s_sub_u32 s18, s18, 1
  s_cbranch_scc1 reca_retry57_to
  buffer_load_dwordx4 v[156:159], v13, s[4:7], s22 offen offset:3072 sc1
  buffer_load_dwordx4 v[160:163], v14, s[4:7], s22 offen offset:0 sc1
  buffer_load_dwordx4 v[164:167], v14, s[4:7], s22 offen offset:1024 sc1
  buffer_load_dwordx4 v[168:171], v14, s[4:7], s22 offen offset:2048 sc1
  buffer_load_dwordx4 v[172:175], v14, s[4:7], s22 offen offset:3072 sc1
  s_waitcnt vmcnt(4)
  v_cmp_eq_u32 vcc, -1, v156
  s_cbranch_vccnz reca_retry57
  s_branch reca_resume58
reca_retry57_to:
  s_mov_b32 s18, 0
  s_waitcnt vmcnt(0)
  s_branch reca_resume58
reca_retry59:
  s_sub_u32 s18, s18, 1
  s_cbranch_scc1 reca_retry59_to
  buffer_load_dwordx4 v[160:163], v14, s[4:7], s22 offen offset:0 sc1
  buffer_load_dwordx4 v[164:167], v14, s[4:7], s22 offen offset:1024 sc1
  buffer_load_dwordx4 v[168:171], v14, s[4:7], s22 offen offset:2048 sc1
  buffer_load_dwordx4 v[172:175], v14, s[4:7], s22 offen offset:3072 sc1
  s_waitcnt vmcnt(3)
  v_cmp_eq_u32 vcc, -1, v160
  s_cbranch_vccnz reca_retry59
  s_branch reca_resume60
reca_retry59_to:
  s_mov_b32 s18, 0
  s_waitcnt vmcnt(0)
  s_branch reca_resume60
reca_retry61:
  s_sub_u32 s18, s18, 1
  s_cbranch_scc1 reca_retry61_to
  buffer_load_dwordx4 v[164:167], v14, s[4:7], s22 offen offset:1024 sc1
  buffer_load_dwordx4 v[168:171], v14, s[4:7], s22 offen offset:2048 sc1
  buffer_load_dwordx4 v[172:175], v14, s[4:7], s22 offen offset:3072 sc1
  s_waitcnt vmcnt(2)
  v_cmp_eq_u32 vcc, -1, v164
  s_cbranch_vccnz reca_retry61
  s_branch reca_resume62
reca_retry61_to:
  s_mov_b32 s18, 0
  s_waitcnt vmcnt(0)
  s_branch reca_resume62
reca_retry63:
  s_sub_u32 s18, s18, 1
  s_cbranch_scc1 reca_retry63_to
  buffer_load_dwordx4 v[168:171], v14, s[4:7], s22 offen offset:2048 sc1
  buffer_load_dwordx4 v[172:175], v14, s[4:7], s22 offen offset:3072 sc1
  s_waitcnt vmcnt(1)
  v_cmp_eq_u32 vcc, -1, v168
  s_cbranch_vccnz reca_retry63
  s_branch reca_resume64
reca_retry63_to:
  s_mov_b32 s18, 0
  s_waitcnt vmcnt(0)
  s_branch reca_resume64
reca_retry65:
  s_sub_u32 s18, s18, 1
  s_cbranch_scc1 reca_retry65_to
  buffer_load_dwordx4 v[172:175], v14, s[4:7], s22 offen offset:3072 sc1
  s_waitcnt vmcnt(0)
  v_cmp_eq_u32 vcc, -1, v172
  s_cbranch_vccnz reca_retry65
  s_branch reca_resume66
reca_retry65_to:
  s_mov_b32 s18, 0
  s_waitcnt vmcnt(0)
  s_branch reca_resume66
reca_retry68:
  s_sub_u32 s18, s18, 1
  s_cbranch_scc1 reca_retry68_to
  buffer_load_dwordx4 v[128:131], v20, s[4:7], s25 offen sc1
  buffer_load_dwordx4 v[132:135], v21, s[4:7], s25 offen sc1
  buffer_load_dwordx4 v[136:139], v22, s[4:7], s25 offen sc1
  buffer_load_dwordx4 v[140:143], v23, s[4:7], s25 offen sc1
  buffer_load_dwordx4 v[144:147], v24, s[4:7], s25 offen sc1
  buffer_load_dwordx4 v[148:151], v25, s[4:7], s25 offen sc1
  buffer_load_dwordx4 v[152:155], v26, s[4:7], s25 offen sc1
  buffer_load_dwordx4 v[156:159], v27, s[4:7], s25 offen sc1
  s_waitcnt vmcnt(7)
  v_cmp_eq_u32 vcc, -1, v128
  s_cbranch_vccnz reca_retry68
  s_branch reca_resume69
reca_retry68_to:
  s_mov_b32 s18, 0
  s_waitcnt vmcnt(0)
  s_branch reca_resume69
reca_retry70:
  s_sub_u32 s18, s18, 1
  s_cbranch_scc1 reca_retry70_to
  buffer_load_dwordx4 v[132:135], v21, s[4:7], s25 offen sc1
  buffer_load_dwordx4 v[136:139], v22, s[4:7], s25 offen sc1
  buffer_load_dwordx4 v[140:143], v23, s[4:7], s25 offen sc1
  buffer_load_dwordx4 v[144:147], v24, s[4:7], s25 offen sc1
  buffer_load_dwordx4 v[148:151], v25, s[4:7], s25 offen sc1
  buffer_load_dwordx4 v[152:155], v26, s[4:7], s25 offen sc1
  buffer_load_dwordx4 v[156:159], v27, s[4:7], s25 offen sc1
  s_waitcnt vmcnt(6)
  v_cmp_eq_u32 vcc, -1, v132
  s_cbranch_vccnz reca_retry70
  s_branch reca_resume71
reca_retry70_to:
  s_mov_b32 s18, 0
  s_waitcnt vmcnt(0)
  s_branch reca_resume71
reca_retry72:
  s_sub_u32 s18, s18, 1
  s_cbranch_scc1 reca_retry72_to
  buffer_load_dwordx4 v[136:139], v22, s[4:7], s25 offen sc1
  buffer_load_dwordx4 v[140:143], v23, s[4:7], s25 offen sc1
  buffer_load_dwordx4 v[144:147], v24, s[4:7], s25 offen sc1
  buffer_load_dwordx4 v[148:151], v25, s[4:7], s25 offen sc1
  buffer_load_dwordx4 v[152:155], v26, s[4:7], s25 offen sc1
  buffer_load_dwordx4 v[156:159], v27, s[4:7], s25 offen sc1
  s_waitcnt vmcnt(5)
  v_cmp_eq_u32 vcc, -1, v136
  s_cbranch_vccnz reca_retry72
  s_branch reca_resume73
reca_retry72_to:
  s_mov_b32 s18, 0
  s_waitcnt vmcnt(0)
  s_branch reca_resume73
reca_retry74:
  s_sub_u32 s18, s18, 1
  s_cbranch_scc1 reca_retry74_to
  buffer_load_dwordx4 v[140:143], v23, s[4:7], s25 offen sc1
  buffer_load_dwordx4 v[144:147], v24, s[4:7], s25 offen sc1
  buffer_load_dwordx4 v[148:151], v25, s[4:7], s25 offen sc1
  buffer_load_dwordx4 v[152:155], v26, s[4:7], s25 offen sc1
  buffer_load_dwordx4 v[156:159], v27, s[4:7], s25 offen sc1
  s_waitcnt vmcnt(4)
  v_cmp_eq_u32 vcc, -1, v140
  s_cbranch_vccnz reca_retry74
  s_branch reca_resume75
reca_retry74_to:
  s_mov_b32 s18, 0
  s_waitcnt vmcnt(0)
  s_branch reca_resume75
reca_retry76:
  s_sub_u32 s18, s18, 1
  s_cbranch_scc1 reca_retry76_to
  buffer_load_dwordx4 v[144:147], v24, s[4:7], s25 offen sc1
  buffer_load_dwordx4 v[148:151], v25, s[4:7], s25 offen sc1
  buffer_load_dwordx4 v[152:155], v26, s[4:7], s25 offen sc1
  buffer_load_dwordx4 v[156:159], v27, s[4:7], s25 offen sc1
  s_waitcnt vmcnt(3)
  v_cmp_eq_u32 vcc, -1, v144
  s_cbranch_vccnz reca_retry76
  s_branch reca_resume77
reca_retry76_to:
  s_mov_b32 s18, 0
  s_waitcnt vmcnt(0)
  s_branch reca_resume77
reca_retry78:
  s_sub_u32 s18, s18, 1
  s_cbranch_scc1 reca_retry78_to
  buffer_load_dwordx4 v[148:151], v25, s[4:7], s25 offen sc1
  buffer_load_dwordx4 v[152:155], v26, s[4:7], s25 offen sc1
  buffer_load_dwordx4 v[156:159], v27, s[4:7], s25 offen sc1
  s_waitcnt vmcnt(2)
  v_cmp_eq_u32 vcc, -1, v148
  s_cbranch_vccnz reca_retry78
  s_branch reca_resume79
reca_retry78_to:
  s_mov_b32 s18, 0
  s_waitcnt vmcnt(0)
  s_branch reca_resume79
reca_retry80:
  s_sub_u32 s18, s18, 1
  s_cbranch_scc1 reca_retry80_to
  buffer_load_dwordx4 v[152:155], v26, s[4:7], s25 offen sc1
  buffer_load_dwordx4 v[156:159], v27, s[4:7], s25 offen sc1
  s_waitcnt vmcnt(1)
  v_cmp_eq_u32 vcc, -1, v152
  s_cbranch_vccnz reca_retry80
  s_branch reca_resume81
reca_retry80_to:
  s_mov_b32 s18, 0
  s_waitcnt vmcnt(0)
  s_branch reca_resume81
reca_retry82:
  s_sub_u32 s18, s18, 1
  s_cbranch_scc1 reca_retry82_to
  buffer_load_dwordx4 v[156:159], v27, s[4:7], s25 offen sc1
  s_waitcnt vmcnt(0)
  v_cmp_eq_u32 vcc, -1, v156
  s_cbranch_vccnz reca_retry82
  s_branch reca_resume83
reca_retry82_to:
  s_mov_b32 s18, 0
  s_waitcnt vmcnt(0)
  s_branch reca_resume83
reca_twinf12:
  s_branch reca_gotmem88
reca_step87:
  s_and_b32 s34, s17, 3
  s_mul_i32 s20, s34, 10240
  s_add_u32 s20, s20, s38
  s_sleep 5
  buffer_load_dwordx4 v[128:131], v4, s[4:7], s20 offen sc1
  buffer_load_dwordx4 v[132:135], v4, s[4:7], s20 offen offset:1024 sc1
  buffer_load_dwordx4 v[136:139], v5, s[4:7], s20 offen sc1
  s_waitcnt vmcnt(2)
  v_max_u32 v29, v128, v130
  v_cmp_eq_u32 vcc, -1, v29
  s_cbranch_vccnz reca_retry90
reca_resume91:
  s_waitcnt vmcnt(1)
  v_max_u32 v29, v132, v134
  v_cmp_eq_u32 vcc, -1, v29
  ds_write_b128 v4, v[128:131]
  s_cbranch_vccnz reca_retry92
reca_resume93:
  s_waitcnt vmcnt(0)
  v_max_u32 v29, v136, v138
  v_cmp_eq_u32 vcc, -1, v29
  ds_write_b128 v4, v[132:135] offset:1024
  s_cbranch_vccnz reca_retry94
reca_resume95:
  ds_write_b128 v5, v[136:139]
  s_branch reca_gotmem289
reca_gotmem88:
  ds_write_b128 v4, v[128:131]
  ds_write_b128 v4, v[132:135] offset:1024
  ds_write_b128 v5, v[136:139]
reca_gotmem289:
  s_and_b32 s34, s17, 3
  s_mul_i32 s21, s34, 6144
  s_add_u32 s21, s21, s39
  s_mul_i32 s22, s34, 12288
  s_add_u32 s22, s22, s40
  s_mul_i32 s25, s34, 393216
  s_add_u32 s25, s25, s56
  s_add_u32 s35, s17, 1
  s_and_b32 s35, s35, 3
  s_mul_i32 s24, s35, 10240
  s_add_u32 s24, s24, s38
  s_waitcnt lgkmcnt(0)
  s_barrier
  ds_read_b128 v[128:131], v236 offset:0
  ds_read_b128 v[132:135], v236 offset:1024
  ds_read_b128 v[136:139], v236 offset:2048
  ds_read_b128 v[140:143], v236 offset:3072
  ds_read_b128 v[144:147], v236 offset:4096
  ds_read_b128 v[148:151], v237 offset:0
  ds_read_b128 v[152:155], v237 offset:1024
  ds_read_b128 v[156:159], v237 offset:2048
  ds_read_b128 v[160:163], v237 offset:3072
  ds_read_b128 v[164:167], v237 offset:4096
  s_waitcnt lgkmcnt(9)
  v_mfma_f32_16x16x32_bf16 v[44:47], a[0:3], v[128:131], 0
  ds_read_b128 v[168:171], v6 offset:0
  v_mfma_f32_16x16x32_bf16 v[240:243], a[4:7], v[128:131], 0
  s_waitcnt lgkmcnt(9)
  v_mfma_f32_16x16x32_bf16 v[44:47], a[8:11], v[132:135], v[44:47]
  ds_read_b128 v[172:175], v6 offset:512
  v_mfma_f32_16x16x32_bf16 v[240:243], a[12:15], v[132:135], v[240:243]
  s_waitcnt lgkmcnt(9)
  v_mfma_f32_16x16x32_bf16 v[44:47], a[16:19], v[136:139], v[44:47]
  ds_read_b128 v[176:179], v6 offset:1024
  v_mfma_f32_16x16x32_bf16 v[240:243], a[20:23], v[136:139], v[240:243]
  s_waitcnt lgkmcnt(9)
  v_mfma_f32_16x16x32_bf16 v[44:47], a[24:27], v[140:143], v[44:47]
  ds_read_b128 v[180:183], v6 offset:1536
  v_mfma_f32_16x16x32_bf16 v[240:243], a[28:31], v[140:143], v[240:243]
  s_waitcnt lgkmcnt(9)
  v_mfma_f32_16x16x32_bf16 v[44:47], a[32:35], v[144:147], v[44:47]
  ds_read_b128 v[184:187], v6 offset:2048
  v_mfma_f32_16x16x32_bf16 v[240:243], a[36:39], v[144:147], v[240:243]
  s_waitcnt lgkmcnt(9)
  v_mfma_f32_16x16x32_bf16 v[44:47], a[40:43], v[148:151], v[44:47]
  ds_read_b128 v[188:191], v6 offset:2560
  v_mfma_f32_16x16x32_bf16 v[240:243], a[44:47], v[148:151], v[240:243]
  s_waitcnt lgkmcnt(9)
  v_mfma_f32_16x16x32_bf16 v[44:47], a[48:51], v[152:155], v[44:47]
  ds_read_b128 v[192:195], v6 offset:3072
  v_mfma_f32_16x16x32_bf16 v[240:243], a[52:55], v[152:155], v[240:243]
  s_waitcnt lgkmcnt(9)
  v_mfma_f32_16x16x32_bf16 v[44:47], a[56:59], v[156:159], v[44:47]
  ds_read_b128 v[196:199], v6 offset:3584
  v_mfma_f32_16x16x32_bf16 v[240:243], a[60:63], v[156:159], v[240:243]
  s_waitcnt lgkmcnt(9)
  v_mfma_f32_16x16x32_bf16 v[44:47], a[64:67], v[160:163], v[44:47]
  ds_read_b128 v[200:203], v6 offset:4096
  v_mfma_f32_16x16x32_bf16 v[240:243], a[68:71], v[160:163], v[240:243]
  s_waitcnt lgkmcnt(9)
  v_mfma_f32_16x16x32_bf16 v[44:47], a[72:75], v[164:167], v[44:47]
  ds_read_b128 v[204:207], v6 offset:4608
  v_mfma_f32_16x16x32_bf16 v[240:243], a[76:79], v[164:167], v[240:243]
  s_waitcnt lgkmcnt(9)
  v_mfma_f32_16x16x32_bf16 v[48:51], v[168:171], a[80:83], 0
  s_and_b32 s34, s17, 7
  s_lshl_b32 s34, s34, 5
  s_add_u32 s34, s34, s15
  s_mul_i32 s34, s34, 3072
  s_lshl_b32 s35, s16, 9
  s_add_u32 s34, s34, s35
  s_add_u32 s30, s34, 47185920
  s_add_u32 s31, s34, 47972352
  v_add_f32_dpp v44, v240, v44 row_ror:8 row_mask:0xf bank_mask:0xf
  v_add_f32_dpp v45, v241, v45 row_ror:8 row_mask:0xf bank_mask:0xf
  v_add_f32_dpp v46, v242, v46 row_ror:8 row_mask:0xf bank_mask:0xf
  v_add_f32_dpp v47, v243, v47 row_ror:8 row_mask:0xf bank_mask:0xf
  v_cvt_pk_bf16_f32 v52, v44, v45
  v_cvt_pk_bf16_f32 v53, v46, v47
  buffer_store_dwordx2 v[52:53], v8, s[4:7], s21 offen
  s_waitcnt lgkmcnt(8)
  v_mfma_f32_16x16x32_bf16 v[48:51], v[172:175], a[84:87], v[48:51]
  s_waitcnt lgkmcnt(7)
  v_mfma_f32_16x16x32_bf16 v[48:51], v[176:179], a[88:91], v[48:51]
  s_waitcnt lgkmcnt(6)
  v_mfma_f32_16x16x32_bf16 v[48:51], v[180:183], a[92:95], v[48:51]
  s_waitcnt lgkmcnt(5)
  v_mfma_f32_16x16x32_bf16 v[48:51], v[184:187], a[96:99], v[48:51]
  s_waitcnt lgkmcnt(4)
  v_mfma_f32_16x16x32_bf16 v[48:51], v[188:191], a[100:103], v[48:51]
  s_waitcnt lgkmcnt(3)
  v_mfma_f32_16x16x32_bf16 v[48:51], v[192:195], a[104:107], v[48:51]
  s_waitcnt lgkmcnt(2)
  v_mfma_f32_16x16x32_bf16 v[48:51], v[196:199], a[108:111], v[48:51]
  s_waitcnt lgkmcnt(1)
  v_mfma_f32_16x16x32_bf16 v[48:51], v[200:203], a[112:115], v[48:51]
  s_waitcnt lgkmcnt(0)
  v_mfma_f32_16x16x32_bf16 v[48:51], v[204:207], a[116:119], v[48:51]
  s_cmp_eq_u32 s12, 3
  s_cbranch_scc1 reca_swave96
  s_nop 5
  ds_write_b128 v17, v[48:51]
  s_add_u32 s34, s17, 2
  s_and_b32 s34, s34, 3
  s_mul_i32 s26, s34, 10240
  s_add_u32 s26, s26, s38
  s_mul_i32 s27, s34, 6144
  s_add_u32 s27, s27, s39
  s_mul_i32 s28, s34, 12288
  s_add_u32 s28, s28, s40
  s_mul_i32 s29, s34, 393216
  s_add_u32 s29, s29, s56
  s_waitcnt lgkmcnt(0)
  s_barrier
  s_cmp_eq_u32 s17, 63
  s_cbranch_scc1 reca_last98
  buffer_store_dwordx2 v[32:33], v8, s[4:7], s27 offen
  s_cmp_lg_u32 s12, 2
  s_cbranch_scc1 reca_tw1102_n
  buffer_store_dwordx2 v[52:53], v9, s[4:7], s30 offen
reca_tw1102_n:
  s_barrier
  s_cmp_eq_u32 s12, 1
  s_cbranch_scc1 reca_tw1102
  s_cmp_eq_u32 s12, 2
  s_cbranch_scc1 reca_tw2103
  s_cmp_lt_u32 s17, 2
  s_cbranch_scc1 reca_b5101
  s_cmp_gt_u32 s17, 61
  s_cbranch_scc1 reca_b5101
  s_sub_u32 s36, s17, 2
  s_and_b32 s36, s36, 7
  s_lshl_b32 s34, s59, 3
  s_add_u32 s34, s34, s36
  s_mul_i32 s34, s34, 12288
  s_add_u32 s23, s34, 37748736
  s_add_u32 s60, s34, 44040192
  s_lshl_b32 s35, s36, 5
  s_add_u32 s35, s35, s59
  s_mul_i32 s35, s35, 3072
  s_add_u32 s61, s35, 47185920
  buffer_load_dwordx4 a[120:123], v1, s[4:7], s23 offen offset:0 sc1
  buffer_load_dwordx4 a[124:127], v1, s[4:7], s23 offen offset:1024 sc1
  buffer_load_dwordx4 a[128:131], v1, s[4:7], s23 offen offset:2048 sc1
  buffer_load_dwordx4 a[132:135], v1, s[4:7], s23 offen offset:3072 sc1
  buffer_load_dwordx4 a[136:139], v2, s[4:7], s23 offen offset:0 sc1
  buffer_load_dwordx4 a[140:143], v2, s[4:7], s23 offen offset:1024 sc1
  buffer_load_dwordx4 a[144:147], v2, s[4:7], s23 offen offset:2048 sc1
  buffer_load_dwordx4 a[148:151], v2, s[4:7], s23 offen offset:3072 sc1
  buffer_load_dwordx4 a[152:155], v3, s[4:7], s23 offen offset:0 sc1
  buffer_load_dwordx4 a[156:159], v3, s[4:7], s23 offen offset:1024 sc1
  buffer_load_dwordx4 a[160:163], v3, s[4:7], s23 offen offset:2048 sc1
  buffer_load_dwordx4 a[164:167], v3, s[4:7], s23 offen offset:3072 sc1
  buffer_load_dwordx4 a[216:219], v92, s[4:7], s61 offen offset:0 sc1
  buffer_load_dwordx4 a[220:223], v92, s[4:7], s61 offen offset:512 sc1
  buffer_load_dwordx4 a[224:227], v92, s[4:7], s61 offen offset:1024 sc1
  buffer_load_dwordx4 a[228:231], v92, s[4:7], s61 offen offset:1536 sc1
  buffer_load_dwordx4 a[232:235], v92, s[4:7], s61 offen offset:2048 sc1
  buffer_load_dwordx4 a[236:239], v92, s[4:7], s61 offen offset:2560 sc1
  buffer_load_dwordx4 a[168:171], v1, s[4:7], s60 offen offset:0 sc1
  buffer_load_dwordx4 a[172:175], v1, s[4:7], s60 offen offset:1024 sc1
  buffer_load_dwordx4 a[176:179], v1, s[4:7], s60 offen offset:2048 sc1
  buffer_load_dwordx4 a[180:183], v1, s[4:7], s60 offen offset:3072 sc1
  buffer_load_dwordx4 a[184:187], v2, s[4:7], s60 offen offset:0 sc1
  buffer_load_dwordx4 a[188:191], v2, s[4:7], s60 offen offset:1024 sc1
  buffer_load_dwordx4 a[192:195], v2, s[4:7], s60 offen offset:2048 sc1
  buffer_load_dwordx4 a[196:199], v2, s[4:7], s60 offen offset:3072 sc1
  buffer_load_dwordx4 a[200:203], v3, s[4:7], s60 offen offset:0 sc1
  buffer_load_dwordx4 a[204:207], v3, s[4:7], s60 offen offset:1024 sc1
  buffer_load_dwordx4 a[208:211], v3, s[4:7], s60 offen offset:2048 sc1
  buffer_load_dwordx4 a[212:215], v3, s[4:7], s60 offen offset:3072 sc1
  s_waitcnt vmcnt(5)
  v_mfma_f32_16x16x32_bf16 v[128:131], a[216:219], a[168:171], v[84:87]
  v_mfma_f32_16x16x32_bf16 v[132:135], a[120:123], a[168:171], v[88:91]
  v_mfma_f32_16x16x32_bf16 v[136:139], a[216:219], a[192:195], v[84:87]
  v_mfma_f32_16x16x32_bf16 v[140:143], a[120:123], a[192:195], 0
  v_mfma_f32_16x16x32_bf16 v[144:147], a[144:147], a[192:195], v[88:91]
  s_waitcnt vmcnt(4)
  v_mfma_f32_16x16x32_bf16 v[128:131], a[220:223], a[172:175], v[128:131]
  v_mfma_f32_16x16x32_bf16 v[132:135], a[124:127], a[172:175], v[132:135]
  v_mfma_f32_16x16x32_bf16 v[136:139], a[220:223], a[196:199], v[136:139]
  v_mfma_f32_16x16x32_bf16 v[140:143], a[124:127], a[196:199], v[140:143]
  v_mfma_f32_16x16x32_bf16 v[144:147], a[148:151], a[196:199], v[144:147]
  s_waitcnt vmcnt(3)
  v_mfma_f32_16x16x32_bf16 v[128:131], a[224:227], a[176:179], v[128:131]
  v_mfma_f32_16x16x32_bf16 v[132:135], a[128:131], a[176:179], v[132:135]
  v_mfma_f32_16x16x32_bf16 v[136:139], a[224:227], a[200:203], v[136:139]
  v_mfma_f32_16x16x32_bf16 v[140:143], a[128:131], a[200:203], v[140:143]
  v_mfma_f32_16x16x32_bf16 v[144:147], a[152:155], a[200:203], v[144:147]
  s_waitcnt vmcnt(2)
  v_mfma_f32_16x16x32_bf16 v[128:131], a[228:231], a[180:183], v[128:131]
  v_mfma_f32_16x16x32_bf16 v[132:135], a[132:135], a[180:183], v[132:135]
  v_mfma_f32_16x16x32_bf16 v[136:139], a[228:231], a[204:207], v[136:139]
  v_mfma_f32_16x16x32_bf16 v[140:143], a[132:135], a[204:207], v[140:143]
  v_mfma_f32_16x16x32_bf16 v[144:147], a[156:159], a[204:207], v[144:147]
  s_waitcnt vmcnt(1)
  v_mfma_f32_16x16x32_bf16 v[128:131], a[232:235], a[184:187], v[128:131]
  v_mfma_f32_16x16x32_bf16 v[132:135], a[136:139], a[184:187], v[132:135]
  v_mfma_f32_16x16x32_bf16 v[136:139], a[232:235], a[208:211], v[136:139]
  v_mfma_f32_16x16x32_bf16 v[140:143], a[136:139], a[208:211], v[140:143]
  v_mfma_f32_16x16x32_bf16 v[144:147], a[160:163], a[208:211], v[144:147]
  s_waitcnt vmcnt(0)
  v_mfma_f32_16x16x32_bf16 v[128:131], a[236:239], a[188:191], v[128:131]
  v_mfma_f32_16x16x32_bf16 v[132:135], a[140:143], a[188:191], v[132:135]
  v_mfma_f32_16x16x32_bf16 v[136:139], a[236:239], a[212:215], v[136:139]
  v_mfma_f32_16x16x32_bf16 v[140:143], a[140:143], a[212:215], v[140:143]
  v_mfma_f32_16x16x32_bf16 v[144:147], a[164:167], a[212:215], v[144:147]
  s_nop 3
  v_max3_f32 v28, v128, v129, v130
  v_max3_f32 v28, v28, v131, v132
  v_max3_f32 v28, v28, v133, v134
  v_max_f32 v28, v28, v135
  v_mov_b32 v29, v28
  s_nop 1
  v_permlane32_swap_b32 v28, v29
  v_max_f32 v28, v28, v29
  v_mov_b32 v29, v28
  s_nop 1
  v_permlane16_swap_b32 v28, v29
  v_max_f32 v28, v28, v29
  v_mul_f32 v28, s41, v28
  v_fma_f32 v128, v128, s41, -v28
  v_fma_f32 v129, v129, s41, -v28
  v_fma_f32 v130, v130, s41, -v28
  v_fma_f32 v131, v131, s41, -v28
  v_fma_f32 v132, v132, s41, -v28
  v_fma_f32 v133, v133, s41, -v28
  v_fma_f32 v134, v134, s41, -v28
  v_fma_f32 v135, v135, s41, -v28
  v_exp_f32 v128, v128
  v_exp_f32 v129, v129
  v_exp_f32 v130, v130
  v_exp_f32 v131, v131
  v_exp_f32 v132, v132
  v_exp_f32 v133, v133
  v_exp_f32 v134, v134
  v_exp_f32 v135, v135
  v_max3_f32 v30, v136, v137, v138
  v_max3_f32 v30, v30, v139, v140
  v_max3_f32 v30, v30, v141, v142
  v_max3_f32 v30, v30, v143, v144
  v_max3_f32 v30, v30, v145, v146
  v_max_f32 v30, v30, v147
  v_mov_b32 v29, v30
  s_nop 1
  v_permlane32_swap_b32 v30, v29
  v_max_f32 v30, v30, v29
  v_mov_b32 v29, v30
  s_nop 1
  v_permlane16_swap_b32 v30, v29
  v_max_f32 v30, v30, v29
  v_mul_f32 v30, s41, v30
  v_fma_f32 v136, v136, s41, -v30
  v_fma_f32 v137, v137, s41, -v30
  v_fma_f32 v138, v138, s41, -v30
  v_fma_f32 v139, v139, s41, -v30
  v_fma_f32 v140, v140, s41, -v30
  v_fma_f32 v141, v141, s41, -v30
  v_fma_f32 v142, v142, s41, -v30
  v_fma_f32 v143, v143, s41, -v30
  v_fma_f32 v144, v144, s41, -v30
  v_fma_f32 v145, v145, s41, -v30
  v_fma_f32 v146, v146, s41, -v30
  v_fma_f32 v147, v147, s41, -v30
  v_exp_f32 v136, v136
  v_exp_f32 v137, v137
  v_exp_f32 v138, v138
  v_exp_f32 v139, v139
  v_exp_f32 v140, v140
  v_exp_f32 v141, v141
  v_exp_f32 v142, v142
  v_exp_f32 v143, v143
  v_exp_f32 v144, v144
  v_exp_f32 v145, v145
  v_exp_f32 v146, v146
  v_exp_f32 v147, v147
  v_cvt_pk_bf16_f32 v72, v128, v129
  v_cvt_pk_bf16_f32 v73, v130, v131
  v_cvt_pk_bf16_f32 v74, v132, v133
  v_cvt_pk_bf16_f32 v75, v134, v135
  v_cvt_pk_bf16_f32 v76, v136, v137
  v_cvt_pk_bf16_f32 v77, v138, v139
  v_cvt_pk_bf16_f32 v78, v140, v141
  v_cvt_pk_bf16_f32 v79, v142, v143
  v_cvt_pk_bf16_f32 v80, v144, v145
  v_cvt_pk_bf16_f32 v81, v146, v147
  v_mfma_f32_16x16x16_bf16 v[148:151], v[36:37], v[72:73], 0
  v_mfma_f32_16x16x16_bf16 v[152:155], v[36:37], v[76:77], 0
  v_mfma_f32_16x16x16_bf16 v[148:151], v[36:37], v[74:75], v[148:151]
  v_mfma_f32_16x16x32_bf16 v[152:155], v[36:39], v[78:81], v[152:155]
  s_nop 6
  v_rcp_f32 v82, v148
  v_rcp_f32 v83, v152
  s_and_b32 s34, s17, 1
  s_mul_i32 s34, s34, 3072
  v_add_u32 v28, s34, v1
  ds_write_b128 v28, v[72:75] offset:16384
  ds_write_b128 v28, v[76:79] offset:17408
  ds_write_b128 v28, v[80:83] offset:18432
  s_waitcnt lgkmcnt(0)
  s_branch reca_b5101
reca_tw1102:
  s_cmp_lt_u32 s17, 3
  s_cbranch_scc1 reca_b5101
  s_sub_u32 s36, s17, 3
  s_and_b32 s37, s36, 7
  s_lshl_b32 s34, s59, 3
  s_add_u32 s34, s34, s37
  s_mul_i32 s34, s34, 12288
  s_add_u32 s23, s34, 40894464
  s_lshl_b32 s35, s37, 5
  s_add_u32 s35, s35, s59
  s_mul_i32 s35, s35, 3072
  s_add_u32 s61, s35, 47972352
  s_mul_i32 s34, s36, 393216
  s_mul_i32 s35, s59, 6144
  s_add_u32 s34, s34, s35
  s_add_u32 s60, s34, 57147392
  s_add_u32 s34, s17, 1
  s_and_b32 s34, s34, 1
  s_mul_i32 s34, s34, 3072
  v_add_u32 v28, s34, v1
  ds_read_b128 v[72:75], v28 offset:16384
  ds_read_b128 v[76:79], v28 offset:17408
  ds_read_b128 v[80:83], v28 offset:18432
  buffer_load_dwordx2 a[168:169], v93, s[4:7], s61 offen offset:0 sc1
  buffer_load_dwordx4 a[120:123], v1, s[4:7], s23 offen offset:0 sc1
  buffer_load_dwordx2 a[170:171], v93, s[4:7], s61 offen offset:256 sc1
  buffer_load_dwordx4 a[124:127], v1, s[4:7], s23 offen offset:1024 sc1
  buffer_load_dwordx2 a[172:173], v93, s[4:7], s61 offen offset:512 sc1
  buffer_load_dwordx4 a[128:131], v1, s[4:7], s23 offen offset:2048 sc1
  buffer_load_dwordx2 a[174:175], v93, s[4:7], s61 offen offset:768 sc1
  buffer_load_dwordx4 a[132:135], v1, s[4:7], s23 offen offset:3072 sc1
  buffer_load_dwordx2 a[176:177], v93, s[4:7], s61 offen offset:1024 sc1
  buffer_load_dwordx4 a[136:139], v2, s[4:7], s23 offen offset:0 sc1
  buffer_load_dwordx2 a[178:179], v93, s[4:7], s61 offen offset:1280 sc1
  buffer_load_dwordx4 a[140:143], v2, s[4:7], s23 offen offset:1024 sc1
  s_waitcnt lgkmcnt(0)
  s_waitcnt vmcnt(8)
  v_mfma_f32_16x16x16_bf16 v[156:159], a[168:169], v[72:73], 0
  v_mfma_f32_16x16x16_bf16 v[160:163], a[168:169], v[76:77], 0
  v_mfma_f32_16x16x16_bf16 v[156:159], a[120:121], v[74:75], v[156:159]
  v_mfma_f32_16x16x32_bf16 v[160:163], a[120:123], v[78:81], v[160:163]
  v_mfma_f32_16x16x16_bf16 v[164:167], a[170:171], v[72:73], 0
  v_mfma_f32_16x16x16_bf16 v[168:171], a[170:171], v[76:77], 0
  v_mfma_f32_16x16x16_bf16 v[164:167], a[124:125], v[74:75], v[164:167]
  v_mfma_f32_16x16x32_bf16 v[168:171], a[124:127], v[78:81], v[168:171]
  s_nop 2
  v_mul_f32 v156, v156, v82
  v_mul_f32 v157, v157, v82
  v_mul_f32 v158, v158, v82
  v_mul_f32 v159, v159, v82
  v_cvt_pk_bf16_f32 v172, v156, v157
  v_cvt_pk_bf16_f32 v173, v158, v159
  v_mul_f32 v164, v164, v82
  v_mul_f32 v165, v165, v82
  v_mul_f32 v166, v166, v82
  v_mul_f32 v167, v167, v82
  v_cvt_pk_bf16_f32 v174, v164, v165
  v_cvt_pk_bf16_f32 v175, v166, v167
  buffer_store_dwordx4 v[172:175], v1, s[4:7], s60 offen offset:0 sc1
  v_mul_f32 v160, v160, v83
  v_mul_f32 v161, v161, v83
  v_mul_f32 v162, v162, v83
  v_mul_f32 v163, v163, v83
  v_cvt_pk_bf16_f32 v176, v160, v161
  v_cvt_pk_bf16_f32 v177, v162, v163
  v_mul_f32 v168, v168, v83
  v_mul_f32 v169, v169, v83
  v_mul_f32 v170, v170, v83
  v_mul_f32 v171, v171, v83
  v_cvt_pk_bf16_f32 v178, v168, v169
  v_cvt_pk_bf16_f32 v179, v170, v171
  s_add_u32 s34, s60, 196608
  buffer_store_dwordx4 v[176:179], v1, s[4:7], s34 offen offset:0 sc1
  s_waitcnt vmcnt(6)
  v_mfma_f32_16x16x16_bf16 v[156:159], a[172:173], v[72:73], 0
  v_mfma_f32_16x16x16_bf16 v[160:163], a[172:173], v[76:77], 0
  v_mfma_f32_16x16x16_bf16 v[156:159], a[128:129], v[74:75], v[156:159]
  v_mfma_f32_16x16x32_bf16 v[160:163], a[128:131], v[78:81], v[160:163]
  v_mfma_f32_16x16x16_bf16 v[164:167], a[174:175], v[72:73], 0
  v_mfma_f32_16x16x16_bf16 v[168:171], a[174:175], v[76:77], 0
  v_mfma_f32_16x16x16_bf16 v[164:167], a[132:133], v[74:75], v[164:167]
  v_mfma_f32_16x16x32_bf16 v[168:171], a[132:135], v[78:81], v[168:171]
  s_nop 2
  v_mul_f32 v156, v156, v82
  v_mul_f32 v157, v157, v82
  v_mul_f32 v158, v158, v82
  v_mul_f32 v159, v159, v82
  v_cvt_pk_bf16_f32 v172, v156, v157
  v_cvt_pk_bf16_f32 v173, v158, v159
  v_mul_f32 v164, v164, v82
  v_mul_f32 v165, v165, v82
  v_mul_f32 v166, v166, v82
  v_mul_f32 v167, v167, v82
  v_cvt_pk_bf16_f32 v174, v164, v165
  v_cvt_pk_bf16_f32 v175, v166, v167
  buffer_store_dwordx4 v[172:175], v1, s[4:7], s60 offen offset:1024 sc1
  v_mul_f32 v160, v160, v83
  v_mul_f32 v161, v161, v83
  v_mul_f32 v162, v162, v83
  v_mul_f32 v163, v163, v83
  v_cvt_pk_bf16_f32 v176, v160, v161
  v_cvt_pk_bf16_f32 v177, v162, v163
  v_mul_f32 v168, v168, v83
  v_mul_f32 v169, v169, v83
  v_mul_f32 v170, v170, v83
  v_mul_f32 v171, v171, v83
  v_cvt_pk_bf16_f32 v178, v168, v169
  v_cvt_pk_bf16_f32 v179, v170, v171
  s_add_u32 s34, s60, 196608
  buffer_store_dwordx4 v[176:179], v1, s[4:7], s34 offen offset:1024 sc1
  s_waitcnt vmcnt(4)
  v_mfma_f32_16x16x16_bf16 v[156:159], a[176:177], v[72:73], 0
  v_mfma_f32_16x16x16_bf16 v[160:163], a[176:177], v[76:77], 0
  v_mfma_f32_16x16x16_bf16 v[156:159], a[136:137], v[74:75], v[156:159]
  v_mfma_f32_16x16x32_bf16 v[160:163], a[136:139], v[78:81], v[160:163]
  v_mfma_f32_16x16x16_bf16 v[164:167], a[178:179], v[72:73], 0
  v_mfma_f32_16x16x16_bf16 v[168:171], a[178:179], v[76:77], 0
  v_mfma_f32_16x16x16_bf16 v[164:167], a[140:141], v[74:75], v[164:167]
  v_mfma_f32_16x16x32_bf16 v[168:171], a[140:143], v[78:81], v[168:171]
  s_nop 2
  v_mul_f32 v156, v156, v82
  v_mul_f32 v157, v157, v82
  v_mul_f32 v158, v158, v82
  v_mul_f32 v159, v159, v82
  v_cvt_pk_bf16_f32 v172, v156, v157
  v_cvt_pk_bf16_f32 v173, v158, v159
  v_mul_f32 v164, v164, v82
  v_mul_f32 v165, v165, v82
  v_mul_f32 v166, v166, v82
  v_mul_f32 v167, v167, v82
  v_cvt_pk_bf16_f32 v174, v164, v165
  v_cvt_pk_bf16_f32 v175, v166, v167
  buffer_store_dwordx4 v[172:175], v1, s[4:7], s60 offen offset:2048 sc1
  v_mul_f32 v160, v160, v83
  v_mul_f32 v161, v161, v83
  v_mul_f32 v162, v162, v83
  v_mul_f32 v163, v163, v83
  v_cvt_pk_bf16_f32 v176, v160, v161
  v_cvt_pk_bf16_f32 v177, v162, v163
  v_mul_f32 v168, v168, v83
  v_mul_f32 v169, v169, v83
  v_mul_f32 v170, v170, v83
  v_mul_f32 v171, v171, v83
  v_cvt_pk_bf16_f32 v178, v168, v169
  v_cvt_pk_bf16_f32 v179, v170, v171
  s_add_u32 s34, s60, 196608
  buffer_store_dwordx4 v[176:179], v1, s[4:7], s34 offen offset:2048 sc1
  s_branch reca_b5101
reca_tw2103:
  s_cmp_lt_u32 s17, 3
  s_cbranch_scc1 reca_b5101
  s_sub_u32 s36, s17, 3
  s_and_b32 s37, s36, 7
  s_lshl_b32 s34, s59, 3
  s_add_u32 s34, s34, s37
  s_mul_i32 s34, s34, 12288
  s_add_u32 s23, s34, 40894464
  s_lshl_b32 s35, s37, 5
  s_add_u32 s35, s35, s59
  s_mul_i32 s35, s35, 3072
  s_add_u32 s61, s35, 47972352
  s_mul_i32 s34, s36, 393216
  s_mul_i32 s35, s59, 6144
  s_add_u32 s34, s34, s35
  s_add_u32 s60, s34, 57147392
  s_add_u32 s34, s17, 1
  s_and_b32 s34, s34, 1
  s_mul_i32 s34, s34, 3072
  v_add_u32 v28, s34, v1
  ds_read_b128 v[72:75], v28 offset:16384
  ds_read_b128 v[76:79], v28 offset:17408
  ds_read_b128 v[80:83], v28 offset:18432
  buffer_load_dwordx2 a[180:181], v93, s[4:7], s61 offen offset:1536 sc1
  buffer_load_dwordx4 a[144:147], v2, s[4:7], s23 offen offset:2048 sc1
  buffer_load_dwordx2 a[182:183], v93, s[4:7], s61 offen offset:1792 sc1
  buffer_load_dwordx4 a[148:151], v2, s[4:7], s23 offen offset:3072 sc1
  buffer_load_dwordx2 a[184:185], v93, s[4:7], s61 offen offset:2048 sc1
  buffer_load_dwordx4 a[152:155], v3, s[4:7], s23 offen offset:0 sc1
  buffer_load_dwordx2 a[186:187], v93, s[4:7], s61 offen offset:2304 sc1
  buffer_load_dwordx4 a[156:159], v3, s[4:7], s23 offen offset:1024 sc1
  buffer_load_dwordx2 a[188:189], v93, s[4:7], s61 offen offset:2560 sc1
  buffer_load_dwordx4 a[160:163], v3, s[4:7], s23 offen offset:2048 sc1
  buffer_load_dwordx2 a[190:191], v93, s[4:7], s61 offen offset:2816 sc1
  buffer_load_dwordx4 a[164:167], v3, s[4:7], s23 offen offset:3072 sc1
  s_waitcnt lgkmcnt(0)
  s_waitcnt vmcnt(8)
  v_mfma_f32_16x16x16_bf16 v[156:159], a[180:181], v[72:73], 0
  v_mfma_f32_16x16x16_bf16 v[160:163], a[180:181], v[76:77], 0
  v_mfma_f32_16x16x16_bf16 v[156:159], a[144:145], v[74:75], v[156:159]
  v_mfma_f32_16x16x32_bf16 v[160:163], a[144:147], v[78:81], v[160:163]
  v_mfma_f32_16x16x16_bf16 v[164:167], a[182:183], v[72:73], 0
  v_mfma_f32_16x16x16_bf16 v[168:171], a[182:183], v[76:77], 0
  v_mfma_f32_16x16x16_bf16 v[164:167], a[148:149], v[74:75], v[164:167]
  v_mfma_f32_16x16x32_bf16 v[168:171], a[148:151], v[78:81], v[168:171]
  s_nop 2
  v_mul_f32 v156, v156, v82
  v_mul_f32 v157, v157, v82
  v_mul_f32 v158, v158, v82
  v_mul_f32 v159, v159, v82
  v_cvt_pk_bf16_f32 v172, v156, v157
  v_cvt_pk_bf16_f32 v173, v158, v159
  v_mul_f32 v164, v164, v82
  v_mul_f32 v165, v165, v82
  v_mul_f32 v166, v166, v82
  v_mul_f32 v167, v167, v82
  v_cvt_pk_bf16_f32 v174, v164, v165
  v_cvt_pk_bf16_f32 v175, v166, v167
  buffer_store_dwordx4 v[172:175], v1, s[4:7], s60 offen offset:3072 sc1
  v_mul_f32 v160, v160, v83
  v_mul_f32 v161, v161, v83
  v_mul_f32 v162, v162, v83
  v_mul_f32 v163, v163, v83
  v_cvt_pk_bf16_f32 v176, v160, v161
  v_cvt_pk_bf16_f32 v177, v162, v163
  v_mul_f32 v168, v168, v83
  v_mul_f32 v169, v169, v83
  v_mul_f32 v170, v170, v83
  v_mul_f32 v171, v171, v83
  v_cvt_pk_bf16_f32 v178, v168, v169
  v_cvt_pk_bf16_f32 v179, v170, v171
  s_add_u32 s34, s60, 196608
  buffer_store_dwordx4 v[176:179], v1, s[4:7], s34 offen offset:3072 sc1
  s_waitcnt vmcnt(6)
  v_mfma_f32_16x16x16_bf16 v[156:159], a[184:185], v[72:73], 0
  v_mfma_f32_16x16x16_bf16 v[160:163], a[184:185], v[76:77], 0
  v_mfma_f32_16x16x16_bf16 v[156:159], a[152:153], v[74:75], v[156:159]
  v_mfma_f32_16x16x32_bf16 v[160:163], a[152:155], v[78:81], v[160:163]
  v_mfma_f32_16x16x16_bf16 v[164:167], a[186:187], v[72:73], 0
  v_mfma_f32_16x16x16_bf16 v[168:171], a[186:187], v[76:77], 0
  v_mfma_f32_16x16x16_bf16 v[164:167], a[156:157], v[74:75], v[164:167]
  v_mfma_f32_16x16x32_bf16 v[168:171], a[156:159], v[78:81], v[168:171]
  s_nop 2
  v_mul_f32 v156, v156, v82
  v_mul_f32 v157, v157, v82
  v_mul_f32 v158, v158, v82
  v_mul_f32 v159, v159, v82
  v_cvt_pk_bf16_f32 v172, v156, v157
  v_cvt_pk_bf16_f32 v173, v158, v159
  v_mul_f32 v164, v164, v82
  v_mul_f32 v165, v165, v82
  v_mul_f32 v166, v166, v82
  v_mul_f32 v167, v167, v82
  v_cvt_pk_bf16_f32 v174, v164, v165
  v_cvt_pk_bf16_f32 v175, v166, v167
  buffer_store_dwordx4 v[172:175], v2, s[4:7], s60 offen offset:0 sc1
  v_mul_f32 v160, v160, v83
  v_mul_f32 v161, v161, v83
  v_mul_f32 v162, v162, v83
  v_mul_f32 v163, v163, v83
  v_cvt_pk_bf16_f32 v176, v160, v161
  v_cvt_pk_bf16_f32 v177, v162, v163
  v_mul_f32 v168, v168, v83
  v_mul_f32 v169, v169, v83
  v_mul_f32 v170, v170, v83
  v_mul_f32 v171, v171, v83
  v_cvt_pk_bf16_f32 v178, v168, v169
  v_cvt_pk_bf16_f32 v179, v170, v171
  s_add_u32 s34, s60, 196608
  buffer_store_dwordx4 v[176:179], v2, s[4:7], s34 offen offset:0 sc1
  s_waitcnt vmcnt(4)
  v_mfma_f32_16x16x16_bf16 v[156:159], a[188:189], v[72:73], 0
  v_mfma_f32_16x16x16_bf16 v[160:163], a[188:189], v[76:77], 0
  v_mfma_f32_16x16x16_bf16 v[156:159], a[160:161], v[74:75], v[156:159]
  v_mfma_f32_16x16x32_bf16 v[160:163], a[160:163], v[78:81], v[160:163]
  v_mfma_f32_16x16x16_bf16 v[164:167], a[190:191], v[72:73], 0
  v_mfma_f32_16x16x16_bf16 v[168:171], a[190:191], v[76:77], 0
  v_mfma_f32_16x16x16_bf16 v[164:167], a[164:165], v[74:75], v[164:167]
  v_mfma_f32_16x16x32_bf16 v[168:171], a[164:167], v[78:81], v[168:171]
  s_nop 2
  v_mul_f32 v156, v156, v82
  v_mul_f32 v157, v157, v82
  v_mul_f32 v158, v158, v82
  v_mul_f32 v159, v159, v82
  v_cvt_pk_bf16_f32 v172, v156, v157
  v_cvt_pk_bf16_f32 v173, v158, v159
  v_mul_f32 v164, v164, v82
  v_mul_f32 v165, v165, v82
  v_mul_f32 v166, v166, v82
  v_mul_f32 v167, v167, v82
  v_cvt_pk_bf16_f32 v174, v164, v165
  v_cvt_pk_bf16_f32 v175, v166, v167
  buffer_store_dwordx4 v[172:175], v2, s[4:7], s60 offen offset:1024 sc1
  v_mul_f32 v160, v160, v83
  v_mul_f32 v161, v161, v83
  v_mul_f32 v162, v162, v83
  v_mul_f32 v163, v163, v83
  v_cvt_pk_bf16_f32 v176, v160, v161
  v_cvt_pk_bf16_f32 v177, v162, v163
  v_mul_f32 v168, v168, v83
  v_mul_f32 v169, v169, v83
  v_mul_f32 v170, v170, v83
  v_mul_f32 v171, v171, v83
  v_cvt_pk_bf16_f32 v178, v168, v169
  v_cvt_pk_bf16_f32 v179, v170, v171
  s_add_u32 s34, s60, 196608
  buffer_store_dwordx4 v[176:179], v2, s[4:7], s34 offen offset:1024 sc1
  s_branch reca_b5101
  s_cmp_lg_u32 s12, 2
  s_cbranch_scc1 reca_b399
  buffer_store_dwordx2 v[52:53], v9, s[4:7], s30 offen
  buffer_store_dwordx2 v[32:33], v16, s[4:7], s26 offen
  s_cmp_lg_u32 s14, 0
  s_cbranch_scc1 reca_b399
  v_mov_b32 v28, s17
  s_lshl_b32 s34, s13, 7
  s_add_u32 s34, s34, 1507328
  buffer_store_dword v28, v19, s[4:7], s34 offen
  s_branch reca_b399
reca_last98:
  s_cmp_lg_u32 s12, 2
  s_cbranch_scc1 reca_exit1
  buffer_store_dwordx2 v[52:53], v9, s[4:7], s30 offen
  s_branch reca_exit1
reca_swave96:
  s_cmp_lg_u32 s17, 63
  s_cbranch_scc1 reca_vmst104
  s_barrier
  ds_read_b128 v[56:59], v1 offset:10240
  ds_read_b128 v[60:63], v1 offset:11264
  ds_read_b128 v[64:67], v1 offset:12288
  s_waitcnt lgkmcnt(0)
  v_add_f32 v56, v56, v64
  v_add_f32 v60, v60, v48
  v_add_f32 v57, v57, v65
  v_add_f32 v61, v61, v49
  v_add_f32 v58, v58, v66
  v_add_f32 v62, v62, v50
  v_add_f32 v59, v59, v67
  v_add_f32 v63, v63, v51
  v_cvt_pk_bf16_f32 v68, v56, v57
  v_cvt_pk_bf16_f32 v69, v58, v59
  v_cvt_pk_bf16_f32 v70, v60, v61
  v_cvt_pk_bf16_f32 v71, v62, v63
  buffer_store_dwordx2 v[52:53], v9, s[4:7], s30 offen
  buffer_store_dwordx2 v[68:69], v10, s[4:7], s31 offen
  buffer_store_dwordx2 v[70:71], v10, s[4:7], s31 offen offset:256
  s_branch reca_exit1
reca_vmst104:
  s_sleep 1
  buffer_load_dwordx4 v[208:211], v1, s[4:7], s21 offen offset:0 sc1
  buffer_load_dwordx4 v[212:215], v1, s[4:7], s21 offen offset:1024 sc1
  buffer_load_dwordx4 v[216:219], v1, s[4:7], s21 offen offset:2048 sc1
  buffer_load_dwordx4 v[220:223], v1, s[4:7], s21 offen offset:3072 sc1
  buffer_load_dwordx4 v[224:227], v2, s[4:7], s21 offen offset:0 sc1
  buffer_load_dwordx4 v[228:231], v2, s[4:7], s21 offen offset:1024 sc1
  s_waitcnt vmcnt(5)
  v_max_u32 v29, v208, v210
  v_cmp_eq_u32 vcc, -1, v29
  s_cbranch_vccnz reca_retry105
reca_resume106:
  s_waitcnt vmcnt(4)
  v_max_u32 v29, v212, v214
  v_cmp_eq_u32 vcc, -1, v29
  v_mfma_f32_16x16x32_bf16 v[76:79], a[120:123], v[208:211], 0
  v_mfma_f32_16x16x32_bf16 v[80:83], a[144:147], v[208:211], 0
  v_mfma_f32_16x16x32_bf16 v[72:75], v[208:211], v[208:211], v[40:43]
  s_cbranch_vccnz reca_retry107
reca_resume108:
  s_waitcnt vmcnt(3)
  v_max_u32 v29, v216, v218
  v_cmp_eq_u32 vcc, -1, v29
  v_mfma_f32_16x16x32_bf16 v[76:79], a[124:127], v[212:215], v[76:79]
  v_mfma_f32_16x16x32_bf16 v[80:83], a[148:151], v[212:215], v[80:83]
  v_mfma_f32_16x16x32_bf16 v[72:75], v[212:215], v[212:215], v[72:75]
  s_cbranch_vccnz reca_retry109
reca_resume110:
  s_waitcnt vmcnt(2)
  v_max_u32 v29, v220, v222
  v_cmp_eq_u32 vcc, -1, v29
  v_mfma_f32_16x16x32_bf16 v[76:79], a[128:131], v[216:219], v[76:79]
  v_mfma_f32_16x16x32_bf16 v[80:83], a[152:155], v[216:219], v[80:83]
  v_mfma_f32_16x16x32_bf16 v[72:75], v[216:219], v[216:219], v[72:75]
  s_cbranch_vccnz reca_retry111
reca_resume112:
  s_waitcnt vmcnt(1)
  v_max_u32 v29, v224, v226
  v_cmp_eq_u32 vcc, -1, v29
  v_mfma_f32_16x16x32_bf16 v[76:79], a[132:135], v[220:223], v[76:79]
  v_mfma_f32_16x16x32_bf16 v[80:83], a[156:159], v[220:223], v[80:83]
  v_mfma_f32_16x16x32_bf16 v[72:75], v[220:223], v[220:223], v[72:75]
  s_cbranch_vccnz reca_retry113
reca_resume114:
  s_waitcnt vmcnt(0)
  v_max_u32 v29, v228, v230
  v_cmp_eq_u32 vcc, -1, v29
  v_mfma_f32_16x16x32_bf16 v[76:79], a[136:139], v[224:227], v[76:79]
  v_mfma_f32_16x16x32_bf16 v[80:83], a[160:163], v[224:227], v[80:83]
  v_mfma_f32_16x16x32_bf16 v[72:75], v[224:227], v[224:227], v[72:75]
  s_cbranch_vccnz reca_retry115
reca_resume116:
  v_mfma_f32_16x16x32_bf16 v[76:79], a[140:143], v[228:231], v[76:79]
  v_mfma_f32_16x16x32_bf16 v[80:83], a[164:167], v[228:231], v[80:83]
  v_mfma_f32_16x16x32_bf16 v[72:75], v[228:231], v[228:231], v[72:75]
  s_barrier
  ds_read_b128 v[56:59], v1 offset:10240
  ds_read_b128 v[60:63], v1 offset:11264
  ds_read_b128 v[64:67], v1 offset:12288
  s_nop 1
  v_max3_f32 v28, v76, v77, v78
  v_max3_f32 v29, v80, v81, v82
  v_max3_f32 v28, v28, v79, v83
  v_max3_f32 v29, v29, v72, v73
  v_max3_f32 v28, v28, v74, v75
  v_max_f32 v28, v28, v29
  v_mov_b32 v29, v28
  s_nop 1
  v_permlane32_swap_b32 v28, v29
  v_max_f32 v28, v28, v29
  v_mov_b32 v29, v28
  s_nop 1
  v_permlane16_swap_b32 v28, v29
  v_max_f32 v28, v28, v29
  v_mul_f32 v28, s41, v28
  v_fma_f32 v76, v76, s41, -v28
  v_fma_f32 v77, v77, s41, -v28
  v_fma_f32 v78, v78, s41, -v28
  v_fma_f32 v79, v79, s41, -v28
  v_fma_f32 v80, v80, s41, -v28
  v_fma_f32 v81, v81, s41, -v28
  v_fma_f32 v82, v82, s41, -v28
  v_fma_f32 v83, v83, s41, -v28
  v_fma_f32 v72, v72, s41, -v28
  v_fma_f32 v73, v73, s41, -v28
  v_fma_f32 v74, v74, s41, -v28
  v_fma_f32 v75, v75, s41, -v28
  v_exp_f32 v76, v76
  v_exp_f32 v77, v77
  v_exp_f32 v78, v78
  v_exp_f32 v79, v79
  v_exp_f32 v80, v80
  v_exp_f32 v81, v81
  v_exp_f32 v82, v82
  v_exp_f32 v83, v83
  v_cvt_pk_bf16_f32 v84, v76, v77
  v_cvt_pk_bf16_f32 v85, v78, v79
  v_cvt_pk_bf16_f32 v86, v80, v81
  v_cvt_pk_bf16_f32 v87, v82, v83
  v_exp_f32 v72, v72
  v_exp_f32 v73, v73
  v_mfma_f32_16x16x32_bf16 v[100:103], v[36:39], v[84:87], 0
  v_exp_f32 v74, v74
  v_exp_f32 v75, v75
  v_mfma_f32_16x16x32_bf16 v[92:95], a[168:171], v[84:87], 0
  v_cvt_pk_bf16_f32 v88, v72, v73
  v_cvt_pk_bf16_f32 v89, v74, v75
  v_mfma_f32_16x16x32_bf16 v[96:99], a[172:175], v[84:87], 0
  s_waitcnt lgkmcnt(0)
  v_mfma_f32_16x16x16_bf16 v[100:103], v[36:37], v[88:89], v[100:103]
  v_add_f32 v56, v56, v64
  v_add_f32 v60, v60, v48
  v_add_f32 v57, v57, v65
  v_add_f32 v61, v61, v49
  v_add_f32 v58, v58, v66
  v_add_f32 v62, v62, v50
  v_add_f32 v59, v59, v67
  v_add_f32 v63, v63, v51
  v_cvt_pk_bf16_f32 v68, v56, v57
  v_cvt_pk_bf16_f32 v69, v58, v59
  v_cvt_pk_bf16_f32 v70, v60, v61
  v_cvt_pk_bf16_f32 v71, v62, v63
  v_mfma_f32_16x16x16_bf16 v[92:95], v[68:69], v[88:89], v[92:95]
  v_rcp_f32 v28, v100
  v_mfma_f32_16x16x16_bf16 v[96:99], v[70:71], v[88:89], v[96:99]
  v_mov_b32 v29, v28
  s_nop 4
  v_pk_mul_f32 v[92:93], v[92:93], v[28:29]
  v_pk_mul_f32 v[94:95], v[94:95], v[28:29]
  v_pk_mul_f32 v[96:97], v[96:97], v[28:29]
  v_pk_mul_f32 v[98:99], v[98:99], v[28:29]
  v_cvt_pk_bf16_f32 v104, v92, v93
  v_cvt_pk_bf16_f32 v105, v94, v95
  v_cvt_pk_bf16_f32 v106, v96, v97
  v_cvt_pk_bf16_f32 v107, v98, v99
  buffer_store_dwordx4 v[104:107], v11, s[4:7], s22 offen
  s_barrier
  s_add_u32 s34, s17, 2
  s_and_b32 s34, s34, 3
  s_mul_i32 s26, s34, 10240
  s_add_u32 s26, s26, s38
  s_mul_i32 s27, s34, 6144
  s_add_u32 s27, s27, s39
  s_mul_i32 s28, s34, 12288
  s_add_u32 s28, s28, s40
  s_mul_i32 s29, s34, 393216
  s_add_u32 s29, s29, s56
  buffer_store_dwordx2 v[32:33], v8, s[4:7], s27 offen
  buffer_store_dwordx4 v[32:35], v11, s[4:7], s28 offen
  s_add_u32 s36, s17, 1
  s_cmp_ge_u32 s36, 63
  s_cbranch_scc1 reca_nopf117
  s_add_u32 s37, s36, 1
reca_pf118:
  buffer_load_dword v28, v233, s[4:7], 0 offen sc1
  s_waitcnt vmcnt(0)
  v_cmp_gt_i32 vcc, s37, v28
  s_cbranch_vccz reca_pfok119
  s_sleep 1
  s_sub_u32 s18, s18, 1
  s_cbranch_scc0 reca_pf118
  s_mov_b32 s18, 0
reca_pfok119:
  s_lshl_b32 s34, s15, 3
  s_and_b32 s35, s36, 7
  s_add_u32 s34, s34, s35
  s_mul_i32 s34, s34, 12288
  s_add_u32 s32, s34, 37748736
  s_lshl_b32 s35, s16, 11
  s_add_u32 s34, s34, s35
  s_add_u32 s33, s34, 40894464
  buffer_load_dwordx4 a[120:123], v1, s[4:7], s32 offen offset:0 sc1
  buffer_load_dwordx4 a[124:127], v1, s[4:7], s32 offen offset:1024 sc1
  buffer_load_dwordx4 a[128:131], v1, s[4:7], s32 offen offset:2048 sc1
  buffer_load_dwordx4 a[132:135], v1, s[4:7], s32 offen offset:3072 sc1
  buffer_load_dwordx4 a[136:139], v2, s[4:7], s32 offen offset:0 sc1
  buffer_load_dwordx4 a[140:143], v2, s[4:7], s32 offen offset:1024 sc1
  buffer_load_dwordx4 a[144:147], v2, s[4:7], s32 offen offset:2048 sc1
  buffer_load_dwordx4 a[148:151], v2, s[4:7], s32 offen offset:3072 sc1
  buffer_load_dwordx4 a[152:155], v3, s[4:7], s32 offen offset:0 sc1
  buffer_load_dwordx4 a[156:159], v3, s[4:7], s32 offen offset:1024 sc1
  buffer_load_dwordx4 a[160:163], v3, s[4:7], s32 offen offset:2048 sc1
  buffer_load_dwordx4 a[164:167], v3, s[4:7], s32 offen offset:3072 sc1
  buffer_load_dwordx4 a[168:171], v1, s[4:7], s33 offen offset:0 sc1
  buffer_load_dwordx4 a[172:175], v1, s[4:7], s33 offen offset:1024 sc1
reca_nopf117:
  buffer_store_dwordx2 v[52:53], v9, s[4:7], s30 offen
  buffer_store_dwordx2 v[68:69], v10, s[4:7], s31 offen
  buffer_store_dwordx2 v[70:71], v10, s[4:7], s31 offen offset:256
reca_b5101:
  s_barrier
  s_add_u32 s17, s17, 1
  s_branch reca_step87
reca_b399:
  s_endpgm
reca_retry90:
  s_sub_u32 s18, s18, 1
  s_cbranch_scc1 reca_retry90_to
  buffer_load_dwordx4 v[128:131], v4, s[4:7], s20 offen sc1
  buffer_load_dwordx4 v[132:135], v4, s[4:7], s20 offen offset:1024 sc1
  buffer_load_dwordx4 v[136:139], v5, s[4:7], s20 offen sc1
  s_waitcnt vmcnt(2)
  v_max_u32 v29, v128, v130
  v_cmp_eq_u32 vcc, -1, v29
  s_cbranch_vccnz reca_retry90
  s_branch reca_resume91
reca_retry90_to:
  s_mov_b32 s18, 0
  s_waitcnt vmcnt(0)
  s_branch reca_resume91
reca_retry92:
  s_sub_u32 s18, s18, 1
  s_cbranch_scc1 reca_retry92_to
  buffer_load_dwordx4 v[132:135], v4, s[4:7], s20 offen offset:1024 sc1
  buffer_load_dwordx4 v[136:139], v5, s[4:7], s20 offen sc1
  s_waitcnt vmcnt(1)
  v_max_u32 v29, v132, v134
  v_cmp_eq_u32 vcc, -1, v29
  s_cbranch_vccnz reca_retry92
  s_branch reca_resume93
reca_retry92_to:
  s_mov_b32 s18, 0
  s_waitcnt vmcnt(0)
  s_branch reca_resume93
reca_retry94:
  s_sub_u32 s18, s18, 1
  s_cbranch_scc1 reca_retry94_to
  buffer_load_dwordx4 v[136:139], v5, s[4:7], s20 offen sc1
  s_waitcnt vmcnt(0)
  v_max_u32 v29, v136, v138
  v_cmp_eq_u32 vcc, -1, v29
  s_cbranch_vccnz reca_retry94
  s_branch reca_resume95
reca_retry94_to:
  s_mov_b32 s18, 0
  s_waitcnt vmcnt(0)
  s_branch reca_resume95
reca_retry105:
  s_sub_u32 s18, s18, 1
  s_cbranch_scc1 reca_retry105_to
  buffer_load_dwordx4 v[208:211], v1, s[4:7], s21 offen offset:0 sc1
  buffer_load_dwordx4 v[212:215], v1, s[4:7], s21 offen offset:1024 sc1
  buffer_load_dwordx4 v[216:219], v1, s[4:7], s21 offen offset:2048 sc1
  buffer_load_dwordx4 v[220:223], v1, s[4:7], s21 offen offset:3072 sc1
  buffer_load_dwordx4 v[224:227], v2, s[4:7], s21 offen offset:0 sc1
  buffer_load_dwordx4 v[228:231], v2, s[4:7], s21 offen offset:1024 sc1
  s_waitcnt vmcnt(5)
  v_max_u32 v29, v208, v210
  v_cmp_eq_u32 vcc, -1, v29
  s_cbranch_vccnz reca_retry105
  s_branch reca_resume106
reca_retry105_to:
  s_mov_b32 s18, 0
  s_waitcnt vmcnt(0)
  s_branch reca_resume106
reca_retry107:
  s_sub_u32 s18, s18, 1
  s_cbranch_scc1 reca_retry107_to
  buffer_load_dwordx4 v[212:215], v1, s[4:7], s21 offen offset:1024 sc1
  buffer_load_dwordx4 v[216:219], v1, s[4:7], s21 offen offset:2048 sc1
  buffer_load_dwordx4 v[220:223], v1, s[4:7], s21 offen offset:3072 sc1
  buffer_load_dwordx4 v[224:227], v2, s[4:7], s21 offen offset:0 sc1
  buffer_load_dwordx4 v[228:231], v2, s[4:7], s21 offen offset:1024 sc1
  s_waitcnt vmcnt(4)
  v_max_u32 v29, v212, v214
  v_cmp_eq_u32 vcc, -1, v29
  s_cbranch_vccnz reca_retry107
  s_branch reca_resume108
reca_retry107_to:
  s_mov_b32 s18, 0
  s_waitcnt vmcnt(0)
  s_branch reca_resume108
reca_retry109:
  s_sub_u32 s18, s18, 1
  s_cbranch_scc1 reca_retry109_to
  buffer_load_dwordx4 v[216:219], v1, s[4:7], s21 offen offset:2048 sc1
  buffer_load_dwordx4 v[220:223], v1, s[4:7], s21 offen offset:3072 sc1
  buffer_load_dwordx4 v[224:227], v2, s[4:7], s21 offen offset:0 sc1
  buffer_load_dwordx4 v[228:231], v2, s[4:7], s21 offen offset:1024 sc1
  s_waitcnt vmcnt(3)
  v_max_u32 v29, v216, v218
  v_cmp_eq_u32 vcc, -1, v29
  s_cbranch_vccnz reca_retry109
  s_branch reca_resume110
reca_retry109_to:
  s_mov_b32 s18, 0
  s_waitcnt vmcnt(0)
  s_branch reca_resume110
reca_retry111:
  s_sub_u32 s18, s18, 1
  s_cbranch_scc1 reca_retry111_to
  buffer_load_dwordx4 v[220:223], v1, s[4:7], s21 offen offset:3072 sc1
  buffer_load_dwordx4 v[224:227], v2, s[4:7], s21 offen offset:0 sc1
  buffer_load_dwordx4 v[228:231], v2, s[4:7], s21 offen offset:1024 sc1
  s_waitcnt vmcnt(2)
  v_max_u32 v29, v220, v222
  v_cmp_eq_u32 vcc, -1, v29
  s_cbranch_vccnz reca_retry111
  s_branch reca_resume112
reca_retry111_to:
  s_mov_b32 s18, 0
  s_waitcnt vmcnt(0)
  s_branch reca_resume112
reca_retry113:
  s_sub_u32 s18, s18, 1
  s_cbranch_scc1 reca_retry113_to
  buffer_load_dwordx4 v[224:227], v2, s[4:7], s21 offen offset:0 sc1
  buffer_load_dwordx4 v[228:231], v2, s[4:7], s21 offen offset:1024 sc1
  s_waitcnt vmcnt(1)
  v_max_u32 v29, v224, v226
  v_cmp_eq_u32 vcc, -1, v29
  s_cbranch_vccnz reca_retry113
  s_branch reca_resume114
reca_retry113_to:
  s_mov_b32 s18, 0
  s_waitcnt vmcnt(0)
  s_branch reca_resume114
reca_retry115:
  s_sub_u32 s18, s18, 1
  s_cbranch_scc1 reca_retry115_to
  buffer_load_dwordx4 v[228:231], v2, s[4:7], s21 offen offset:1024 sc1
  s_waitcnt vmcnt(0)
  v_max_u32 v29, v228, v230
  v_cmp_eq_u32 vcc, -1, v29
  s_cbranch_vccnz reca_retry115
  s_branch reca_resume116
reca_retry115_to:
  s_mov_b32 s18, 0
  s_waitcnt vmcnt(0)
  s_branch reca_resume116
reca_slow11:
  s_cmp_ge_u32 s14, 20
  s_cbranch_scc1 reca_twins13
  s_branch reca_gotmem121
reca_step120:
  s_and_b32 s34, s17, 3
  s_mul_i32 s20, s34, 10240
  s_add_u32 s20, s20, s38
  s_sleep 2
  buffer_load_dwordx4 v[128:131], v4, s[4:7], s20 offen sc1
  buffer_load_dwordx4 v[132:135], v4, s[4:7], s20 offen offset:1024 sc1
  buffer_load_dwordx4 v[136:139], v5, s[4:7], s20 offen sc1
  s_waitcnt vmcnt(2)
  v_max_u32 v29, v128, v130
  v_cmp_eq_u32 vcc, -1, v29
  s_cbranch_vccnz reca_retry123
reca_resume124:
  s_waitcnt vmcnt(1)
  v_max_u32 v29, v132, v134
  v_cmp_eq_u32 vcc, -1, v29
  ds_write_b128 v4, v[128:131]
  s_cbranch_vccnz reca_retry125
reca_resume126:
  s_waitcnt vmcnt(0)
  v_max_u32 v29, v136, v138
  v_cmp_eq_u32 vcc, -1, v29
  ds_write_b128 v4, v[132:135] offset:1024
  s_cbranch_vccnz reca_retry127
reca_resume128:
  ds_write_b128 v5, v[136:139]
  s_branch reca_gotmem2122
reca_gotmem121:
  ds_write_b128 v4, v[128:131]
  ds_write_b128 v4, v[132:135] offset:1024
  ds_write_b128 v5, v[136:139]
reca_gotmem2122:
  s_and_b32 s34, s17, 3
  s_mul_i32 s21, s34, 6144
  s_add_u32 s21, s21, s39
  s_mul_i32 s22, s34, 12288
  s_add_u32 s22, s22, s40
  s_mul_i32 s25, s34, 393216
  s_add_u32 s25, s25, s56
  s_add_u32 s35, s17, 1
  s_and_b32 s35, s35, 3
  s_mul_i32 s24, s35, 10240
  s_add_u32 s24, s24, s38
  s_waitcnt lgkmcnt(0)
  s_barrier
  ds_read_b128 v[128:131], v236 offset:0
  ds_read_b128 v[132:135], v236 offset:1024
  ds_read_b128 v[136:139], v236 offset:2048
  ds_read_b128 v[140:143], v236 offset:3072
  ds_read_b128 v[144:147], v236 offset:4096
  ds_read_b128 v[148:151], v237 offset:0
  ds_read_b128 v[152:155], v237 offset:1024
  ds_read_b128 v[156:159], v237 offset:2048
  ds_read_b128 v[160:163], v237 offset:3072
  ds_read_b128 v[164:167], v237 offset:4096
  s_waitcnt lgkmcnt(9)
  v_mfma_f32_16x16x32_bf16 v[44:47], a[0:3], v[128:131], 0
  ds_read_b128 v[168:171], v6 offset:0
  v_mfma_f32_16x16x32_bf16 v[240:243], a[4:7], v[128:131], 0
  s_waitcnt lgkmcnt(9)
  v_mfma_f32_16x16x32_bf16 v[44:47], a[8:11], v[132:135], v[44:47]
  ds_read_b128 v[172:175], v6 offset:512
  v_mfma_f32_16x16x32_bf16 v[240:243], a[12:15], v[132:135], v[240:243]
  s_waitcnt lgkmcnt(9)
  v_mfma_f32_16x16x32_bf16 v[44:47], a[16:19], v[136:139], v[44:47]
  ds_read_b128 v[176:179], v6 offset:1024
  v_mfma_f32_16x16x32_bf16 v[240:243], a[20:23], v[136:139], v[240:243]
  s_waitcnt lgkmcnt(9)
  v_mfma_f32_16x16x32_bf16 v[44:47], a[24:27], v[140:143], v[44:47]
  ds_read_b128 v[180:183], v6 offset:1536
  v_mfma_f32_16x16x32_bf16 v[240:243], a[28:31], v[140:143], v[240:243]
  s_waitcnt lgkmcnt(9)
  v_mfma_f32_16x16x32_bf16 v[44:47], a[32:35], v[144:147], v[44:47]
  ds_read_b128 v[184:187], v6 offset:2048
  v_mfma_f32_16x16x32_bf16 v[240:243], a[36:39], v[144:147], v[240:243]
  s_waitcnt lgkmcnt(9)
  v_mfma_f32_16x16x32_bf16 v[44:47], a[40:43], v[148:151], v[44:47]
  ds_read_b128 v[188:191], v6 offset:2560
  v_mfma_f32_16x16x32_bf16 v[240:243], a[44:47], v[148:151], v[240:243]
  s_waitcnt lgkmcnt(9)
  v_mfma_f32_16x16x32_bf16 v[44:47], a[48:51], v[152:155], v[44:47]
  ds_read_b128 v[192:195], v6 offset:3072
  v_mfma_f32_16x16x32_bf16 v[240:243], a[52:55], v[152:155], v[240:243]
  s_waitcnt lgkmcnt(9)
  v_mfma_f32_16x16x32_bf16 v[44:47], a[56:59], v[156:159], v[44:47]
  ds_read_b128 v[196:199], v6 offset:3584
  v_mfma_f32_16x16x32_bf16 v[240:243], a[60:63], v[156:159], v[240:243]
  s_waitcnt lgkmcnt(9)
  v_mfma_f32_16x16x32_bf16 v[44:47], a[64:67], v[160:163], v[44:47]
  ds_read_b128 v[200:203], v6 offset:4096
  v_mfma_f32_16x16x32_bf16 v[240:243], a[68:71], v[160:163], v[240:243]
  s_waitcnt lgkmcnt(9)
  v_mfma_f32_16x16x32_bf16 v[44:47], a[72:75], v[164:167], v[44:47]
  ds_read_b128 v[204:207], v6 offset:4608
  v_mfma_f32_16x16x32_bf16 v[240:243], a[76:79], v[164:167], v[240:243]
  s_waitcnt lgkmcnt(9)
  v_mfma_f32_16x16x32_bf16 v[48:51], v[168:171], a[80:83], 0
  s_and_b32 s34, s17, 7
  s_lshl_b32 s34, s34, 5
  s_add_u32 s34, s34, s15
  s_mul_i32 s34, s34, 3072
  s_lshl_b32 s35, s16, 9
  s_add_u32 s34, s34, s35
  s_add_u32 s30, s34, 47185920
  s_add_u32 s31, s34, 47972352
  v_add_f32_dpp v44, v240, v44 row_ror:8 row_mask:0xf bank_mask:0xf
  v_add_f32_dpp v45, v241, v45 row_ror:8 row_mask:0xf bank_mask:0xf
  v_add_f32_dpp v46, v242, v46 row_ror:8 row_mask:0xf bank_mask:0xf
  v_add_f32_dpp v47, v243, v47 row_ror:8 row_mask:0xf bank_mask:0xf
  v_cvt_pk_bf16_f32 v52, v44, v45
  v_cvt_pk_bf16_f32 v53, v46, v47
  buffer_store_dwordx2 v[52:53], v8, s[4:7], s21 offen sc1
  s_waitcnt lgkmcnt(8)
  v_mfma_f32_16x16x32_bf16 v[48:51], v[172:175], a[84:87], v[48:51]
  s_waitcnt lgkmcnt(7)
  v_mfma_f32_16x16x32_bf16 v[48:51], v[176:179], a[88:91], v[48:51]
  s_waitcnt lgkmcnt(6)
  v_mfma_f32_16x16x32_bf16 v[48:51], v[180:183], a[92:95], v[48:51]
  s_waitcnt lgkmcnt(5)
  v_mfma_f32_16x16x32_bf16 v[48:51], v[184:187], a[96:99], v[48:51]
  s_waitcnt lgkmcnt(4)
  v_mfma_f32_16x16x32_bf16 v[48:51], v[188:191], a[100:103], v[48:51]
  s_waitcnt lgkmcnt(3)
  v_mfma_f32_16x16x32_bf16 v[48:51], v[192:195], a[104:107], v[48:51]
  s_waitcnt lgkmcnt(2)
  v_mfma_f32_16x16x32_bf16 v[48:51], v[196:199], a[108:111], v[48:51]
  s_waitcnt lgkmcnt(1)
  v_mfma_f32_16x16x32_bf16 v[48:51], v[200:203], a[112:115], v[48:51]
  s_waitcnt lgkmcnt(0)
  v_mfma_f32_16x16x32_bf16 v[48:51], v[204:207], a[116:119], v[48:51]
  s_cmp_eq_u32 s12, 3
  s_cbranch_scc1 reca_swave129
  s_nop 5
  ds_write_b128 v17, v[48:51]
  s_add_u32 s34, s17, 2
  s_and_b32 s34, s34, 3
  s_mul_i32 s26, s34, 10240
  s_add_u32 s26, s26, s38
  s_mul_i32 s27, s34, 6144
  s_add_u32 s27, s27, s39
  s_mul_i32 s28, s34, 12288
  s_add_u32 s28, s28, s40
  s_mul_i32 s29, s34, 393216
  s_add_u32 s29, s29, s56
  s_waitcnt lgkmcnt(0)
  s_barrier
  s_cmp_eq_u32 s17, 63
  s_cbranch_scc1 reca_last131
  buffer_store_dwordx2 v[32:33], v8, s[4:7], s27 offen sc1
  s_cmp_lg_u32 s12, 2
  s_cbranch_scc1 reca_b3132
  buffer_store_dwordx2 v[52:53], v9, s[4:7], s30 offen sc1
  buffer_store_dwordx2 v[32:33], v16, s[4:7], s26 offen sc1
  s_cmp_lg_u32 s14, 0
  s_cbranch_scc1 reca_b3132
  v_mov_b32 v28, s17
  s_lshl_b32 s34, s13, 7
  s_add_u32 s34, s34, 1507328
  buffer_store_dword v28, v19, s[4:7], s34 offen sc1
  s_branch reca_b3132
reca_last131:
  s_cmp_lg_u32 s12, 2
  s_cbranch_scc1 reca_exit1
  buffer_store_dwordx2 v[52:53], v9, s[4:7], s30 offen
  s_branch reca_exit1
reca_swave129:
  s_cmp_lg_u32 s17, 63
  s_cbranch_scc1 reca_vmst135
  s_barrier
  ds_read_b128 v[56:59], v1 offset:10240
  ds_read_b128 v[60:63], v1 offset:11264
  ds_read_b128 v[64:67], v1 offset:12288
  s_waitcnt lgkmcnt(0)
  v_add_f32 v56, v56, v64
  v_add_f32 v60, v60, v48
  v_add_f32 v57, v57, v65
  v_add_f32 v61, v61, v49
  v_add_f32 v58, v58, v66
  v_add_f32 v62, v62, v50
  v_add_f32 v59, v59, v67
  v_add_f32 v63, v63, v51
  v_cvt_pk_bf16_f32 v68, v56, v57
  v_cvt_pk_bf16_f32 v69, v58, v59
  v_cvt_pk_bf16_f32 v70, v60, v61
  v_cvt_pk_bf16_f32 v71, v62, v63
  buffer_store_dwordx2 v[52:53], v9, s[4:7], s30 offen
  buffer_store_dwordx2 v[68:69], v10, s[4:7], s31 offen
  buffer_store_dwordx2 v[70:71], v10, s[4:7], s31 offen offset:256
  s_branch reca_exit1
reca_vmst135:
  s_sleep 1
  buffer_load_dwordx4 v[208:211], v1, s[4:7], s21 offen offset:0 sc1
  buffer_load_dwordx4 v[212:215], v1, s[4:7], s21 offen offset:1024 sc1
  buffer_load_dwordx4 v[216:219], v1, s[4:7], s21 offen offset:2048 sc1
  buffer_load_dwordx4 v[220:223], v1, s[4:7], s21 offen offset:3072 sc1
  buffer_load_dwordx4 v[224:227], v2, s[4:7], s21 offen offset:0 sc1
  buffer_load_dwordx4 v[228:231], v2, s[4:7], s21 offen offset:1024 sc1
  s_waitcnt vmcnt(5)
  v_max_u32 v29, v208, v210
  v_cmp_eq_u32 vcc, -1, v29
  s_cbranch_vccnz reca_retry136
reca_resume137:
  s_waitcnt vmcnt(4)
  v_max_u32 v29, v212, v214
  v_cmp_eq_u32 vcc, -1, v29
  v_mfma_f32_16x16x32_bf16 v[76:79], a[120:123], v[208:211], 0
  v_mfma_f32_16x16x32_bf16 v[80:83], a[144:147], v[208:211], 0
  v_mfma_f32_16x16x32_bf16 v[72:75], v[208:211], v[208:211], v[40:43]
  s_cbranch_vccnz reca_retry138
reca_resume139:
  s_waitcnt vmcnt(3)
  v_max_u32 v29, v216, v218
  v_cmp_eq_u32 vcc, -1, v29
  v_mfma_f32_16x16x32_bf16 v[76:79], a[124:127], v[212:215], v[76:79]
  v_mfma_f32_16x16x32_bf16 v[80:83], a[148:151], v[212:215], v[80:83]
  v_mfma_f32_16x16x32_bf16 v[72:75], v[212:215], v[212:215], v[72:75]
  s_cbranch_vccnz reca_retry140
reca_resume141:
  s_waitcnt vmcnt(2)
  v_max_u32 v29, v220, v222
  v_cmp_eq_u32 vcc, -1, v29
  v_mfma_f32_16x16x32_bf16 v[76:79], a[128:131], v[216:219], v[76:79]
  v_mfma_f32_16x16x32_bf16 v[80:83], a[152:155], v[216:219], v[80:83]
  v_mfma_f32_16x16x32_bf16 v[72:75], v[216:219], v[216:219], v[72:75]
  s_cbranch_vccnz reca_retry142
reca_resume143:
  s_waitcnt vmcnt(1)
  v_max_u32 v29, v224, v226
  v_cmp_eq_u32 vcc, -1, v29
  v_mfma_f32_16x16x32_bf16 v[76:79], a[132:135], v[220:223], v[76:79]
  v_mfma_f32_16x16x32_bf16 v[80:83], a[156:159], v[220:223], v[80:83]
  v_mfma_f32_16x16x32_bf16 v[72:75], v[220:223], v[220:223], v[72:75]
  s_cbranch_vccnz reca_retry144
reca_resume145:
  s_waitcnt vmcnt(0)
  v_max_u32 v29, v228, v230
  v_cmp_eq_u32 vcc, -1, v29
  v_mfma_f32_16x16x32_bf16 v[76:79], a[136:139], v[224:227], v[76:79]
  v_mfma_f32_16x16x32_bf16 v[80:83], a[160:163], v[224:227], v[80:83]
  v_mfma_f32_16x16x32_bf16 v[72:75], v[224:227], v[224:227], v[72:75]
  s_cbranch_vccnz reca_retry146
reca_resume147:
  v_mfma_f32_16x16x32_bf16 v[76:79], a[140:143], v[228:231], v[76:79]
  v_mfma_f32_16x16x32_bf16 v[80:83], a[164:167], v[228:231], v[80:83]
  v_mfma_f32_16x16x32_bf16 v[72:75], v[228:231], v[228:231], v[72:75]
  s_barrier
  ds_read_b128 v[56:59], v1 offset:10240
  ds_read_b128 v[60:63], v1 offset:11264
  ds_read_b128 v[64:67], v1 offset:12288
  s_nop 1
  v_max3_f32 v28, v76, v77, v78
  v_max3_f32 v29, v80, v81, v82
  v_max3_f32 v28, v28, v79, v83
  v_max3_f32 v29, v29, v72, v73
  v_max3_f32 v28, v28, v74, v75
  v_max_f32 v28, v28, v29
  v_mov_b32 v29, v28
  s_nop 1
  v_permlane32_swap_b32 v28, v29
  v_max_f32 v28, v28, v29
  v_mov_b32 v29, v28
  s_nop 1
  v_permlane16_swap_b32 v28, v29
  v_max_f32 v28, v28, v29
  v_mul_f32 v28, s41, v28
  v_fma_f32 v76, v76, s41, -v28
  v_fma_f32 v77, v77, s41, -v28
  v_fma_f32 v78, v78, s41, -v28
  v_fma_f32 v79, v79, s41, -v28
  v_fma_f32 v80, v80, s41, -v28
  v_fma_f32 v81, v81, s41, -v28
  v_fma_f32 v82, v82, s41, -v28
  v_fma_f32 v83, v83, s41, -v28
  v_fma_f32 v72, v72, s41, -v28
  v_fma_f32 v73, v73, s41, -v28
  v_fma_f32 v74, v74, s41, -v28
  v_fma_f32 v75, v75, s41, -v28
  v_exp_f32 v76, v76
  v_exp_f32 v77, v77
  v_exp_f32 v78, v78
  v_exp_f32 v79, v79
  v_exp_f32 v80, v80
  v_exp_f32 v81, v81
  v_exp_f32 v82, v82
  v_exp_f32 v83, v83
  v_cvt_pk_bf16_f32 v84, v76, v77
  v_cvt_pk_bf16_f32 v85, v78, v79
  v_cvt_pk_bf16_f32 v86, v80, v81
  v_cvt_pk_bf16_f32 v87, v82, v83
  v_exp_f32 v72, v72
  v_exp_f32 v73, v73
  v_mfma_f32_16x16x32_bf16 v[100:103], v[36:39], v[84:87], 0
  v_exp_f32 v74, v74
  v_exp_f32 v75, v75
  v_mfma_f32_16x16x32_bf16 v[92:95], a[168:171], v[84:87], 0
  v_cvt_pk_bf16_f32 v88, v72, v73
  v_cvt_pk_bf16_f32 v89, v74, v75
  v_mfma_f32_16x16x32_bf16 v[96:99], a[172:175], v[84:87], 0
  s_waitcnt lgkmcnt(0)
  v_mfma_f32_16x16x16_bf16 v[100:103], v[36:37], v[88:89], v[100:103]
  v_add_f32 v56, v56, v64
  v_add_f32 v60, v60, v48
  v_add_f32 v57, v57, v65
  v_add_f32 v61, v61, v49
  v_add_f32 v58, v58, v66
  v_add_f32 v62, v62, v50
  v_add_f32 v59, v59, v67
  v_add_f32 v63, v63, v51
  v_cvt_pk_bf16_f32 v68, v56, v57
  v_cvt_pk_bf16_f32 v69, v58, v59
  v_cvt_pk_bf16_f32 v70, v60, v61
  v_cvt_pk_bf16_f32 v71, v62, v63
  v_mfma_f32_16x16x16_bf16 v[92:95], v[68:69], v[88:89], v[92:95]
  v_rcp_f32 v28, v100
  v_mfma_f32_16x16x16_bf16 v[96:99], v[70:71], v[88:89], v[96:99]
  v_mov_b32 v29, v28
  s_nop 4
  v_pk_mul_f32 v[92:93], v[92:93], v[28:29]
  v_pk_mul_f32 v[94:95], v[94:95], v[28:29]
  v_pk_mul_f32 v[96:97], v[96:97], v[28:29]
  v_pk_mul_f32 v[98:99], v[98:99], v[28:29]
  v_cvt_pk_bf16_f32 v104, v92, v93
  v_cvt_pk_bf16_f32 v105, v94, v95
  v_cvt_pk_bf16_f32 v106, v96, v97
  v_cvt_pk_bf16_f32 v107, v98, v99
  buffer_store_dwordx4 v[104:107], v11, s[4:7], s22 offen sc1
reca_b3132:
  s_barrier
  s_cmp_ge_u32 s12, 2
  s_cbranch_scc1 reca_notg2148
  s_sleep 3
  buffer_load_dwordx4 v[128:131], v12, s[4:7], s22 offen offset:0 sc1
  buffer_load_dwordx4 v[132:135], v12, s[4:7], s22 offen offset:1024 sc1
  buffer_load_dwordx4 v[136:139], v12, s[4:7], s22 offen offset:2048 sc1
  buffer_load_dwordx4 v[140:143], v12, s[4:7], s22 offen offset:3072 sc1
  buffer_load_dwordx4 v[144:147], v13, s[4:7], s22 offen offset:0 sc1
  buffer_load_dwordx4 v[148:151], v13, s[4:7], s22 offen offset:1024 sc1
  buffer_load_dwordx4 v[152:155], v13, s[4:7], s22 offen offset:2048 sc1
  buffer_load_dwordx4 v[156:159], v13, s[4:7], s22 offen offset:3072 sc1
  buffer_load_dwordx4 v[160:163], v14, s[4:7], s22 offen offset:0 sc1
  buffer_load_dwordx4 v[164:167], v14, s[4:7], s22 offen offset:1024 sc1
  buffer_load_dwordx4 v[168:171], v14, s[4:7], s22 offen offset:2048 sc1
  buffer_load_dwordx4 v[172:175], v14, s[4:7], s22 offen offset:3072 sc1
  s_waitcnt vmcnt(11)
  v_cmp_eq_u32 vcc, -1, v128
  s_cbranch_vccnz reca_retry149
reca_resume150:
  s_waitcnt vmcnt(10)
  v_cmp_eq_u32 vcc, -1, v132
  v_mfma_f32_16x16x32_bf16 v[108:111], a[120:123], v[128:131], 0
  v_mfma_f32_16x16x32_bf16 v[112:115], a[124:127], v[128:131], 0
  s_cbranch_vccnz reca_retry151
reca_resume152:
  s_waitcnt vmcnt(9)
  v_cmp_eq_u32 vcc, -1, v136
  v_mfma_f32_16x16x32_bf16 v[108:111], a[128:131], v[132:135], v[108:111]
  v_mfma_f32_16x16x32_bf16 v[112:115], a[132:135], v[132:135], v[112:115]
  s_cbranch_vccnz reca_retry153
reca_resume154:
  s_waitcnt vmcnt(8)
  v_cmp_eq_u32 vcc, -1, v140
  v_mfma_f32_16x16x32_bf16 v[108:111], a[136:139], v[136:139], v[108:111]
  v_mfma_f32_16x16x32_bf16 v[112:115], a[140:143], v[136:139], v[112:115]
  s_cbranch_vccnz reca_retry155
reca_resume156:
  s_waitcnt vmcnt(7)
  v_cmp_eq_u32 vcc, -1, v144
  v_mfma_f32_16x16x32_bf16 v[108:111], a[144:147], v[140:143], v[108:111]
  v_mfma_f32_16x16x32_bf16 v[112:115], a[148:151], v[140:143], v[112:115]
  s_cbranch_vccnz reca_retry157
reca_resume158:
  s_waitcnt vmcnt(6)
  v_cmp_eq_u32 vcc, -1, v148
  v_mfma_f32_16x16x32_bf16 v[108:111], a[152:155], v[144:147], v[108:111]
  v_mfma_f32_16x16x32_bf16 v[112:115], a[156:159], v[144:147], v[112:115]
  s_cbranch_vccnz reca_retry159
reca_resume160:
  s_waitcnt vmcnt(5)
  v_cmp_eq_u32 vcc, -1, v152
  v_mfma_f32_16x16x32_bf16 v[108:111], a[160:163], v[148:151], v[108:111]
  v_mfma_f32_16x16x32_bf16 v[112:115], a[164:167], v[148:151], v[112:115]
  s_cbranch_vccnz reca_retry161
reca_resume162:
  s_waitcnt vmcnt(4)
  v_cmp_eq_u32 vcc, -1, v156
  v_mfma_f32_16x16x32_bf16 v[108:111], a[168:171], v[152:155], v[108:111]
  v_mfma_f32_16x16x32_bf16 v[112:115], a[172:175], v[152:155], v[112:115]
  s_cbranch_vccnz reca_retry163
reca_resume164:
  s_waitcnt vmcnt(3)
  v_cmp_eq_u32 vcc, -1, v160
  v_mfma_f32_16x16x32_bf16 v[108:111], a[176:179], v[156:159], v[108:111]
  v_mfma_f32_16x16x32_bf16 v[112:115], a[180:183], v[156:159], v[112:115]
  s_cbranch_vccnz reca_retry165
reca_resume166:
  s_waitcnt vmcnt(2)
  v_cmp_eq_u32 vcc, -1, v164
  v_mfma_f32_16x16x32_bf16 v[108:111], a[184:187], v[160:163], v[108:111]
  v_mfma_f32_16x16x32_bf16 v[112:115], a[188:191], v[160:163], v[112:115]
  s_cbranch_vccnz reca_retry167
reca_resume168:
  s_waitcnt vmcnt(1)
  v_cmp_eq_u32 vcc, -1, v168
  v_mfma_f32_16x16x32_bf16 v[108:111], a[192:195], v[164:167], v[108:111]
  v_mfma_f32_16x16x32_bf16 v[112:115], a[196:199], v[164:167], v[112:115]
  s_cbranch_vccnz reca_retry169
reca_resume170:
  s_waitcnt vmcnt(0)
  v_cmp_eq_u32 vcc, -1, v172
  v_mfma_f32_16x16x32_bf16 v[108:111], a[200:203], v[168:171], v[108:111]
  v_mfma_f32_16x16x32_bf16 v[112:115], a[204:207], v[168:171], v[112:115]
  s_cbranch_vccnz reca_retry171
reca_resume172:
  v_mfma_f32_16x16x32_bf16 v[108:111], a[208:211], v[172:175], v[108:111]
  v_mfma_f32_16x16x32_bf16 v[112:115], a[212:215], v[172:175], v[112:115]
  s_nop 7
  v_add_f32_dpp v116, v112, v108 row_ror:8 row_mask:0xf bank_mask:0xf
  v_add_f32_dpp v117, v113, v109 row_ror:8 row_mask:0xf bank_mask:0xf
  v_add_f32_dpp v118, v114, v110 row_ror:8 row_mask:0xf bank_mask:0xf
  v_add_f32_dpp v119, v115, v111 row_ror:8 row_mask:0xf bank_mask:0xf
  buffer_store_dwordx4 v[116:119], v15, s[4:7], s25 offen sc1
  buffer_store_dwordx4 v[116:119], v232, s[4:7], s25 offen sc1
  buffer_store_dwordx4 v[32:35], v15, s[4:7], s29 offen sc1
  buffer_store_dwordx4 v[32:35], v232, s[4:7], s29 offen sc1
  s_branch reca_b4133
reca_notg2148:
  s_cmp_lg_u32 s12, 3
  s_cbranch_scc1 reca_b4133
  s_add_u32 s34, s17, 2
  s_and_b32 s34, s34, 3
  s_mul_i32 s26, s34, 10240
  s_add_u32 s26, s26, s38
  s_mul_i32 s27, s34, 6144
  s_add_u32 s27, s27, s39
  s_mul_i32 s28, s34, 12288
  s_add_u32 s28, s28, s40
  s_mul_i32 s29, s34, 393216
  s_add_u32 s29, s29, s56
  buffer_store_dwordx2 v[32:33], v8, s[4:7], s27 offen sc1
  buffer_store_dwordx4 v[32:35], v11, s[4:7], s28 offen sc1
reca_b4133:
  s_barrier
  s_cmp_lg_u32 s12, 2
  s_cbranch_scc1 reca_not2173
  s_sleep 8
  buffer_load_dwordx4 v[128:131], v20, s[4:7], s25 offen sc1
  buffer_load_dwordx4 v[132:135], v21, s[4:7], s25 offen sc1
  buffer_load_dwordx4 v[136:139], v22, s[4:7], s25 offen sc1
  buffer_load_dwordx4 v[140:143], v23, s[4:7], s25 offen sc1
  buffer_load_dwordx4 v[144:147], v24, s[4:7], s25 offen sc1
  buffer_load_dwordx4 v[148:151], v25, s[4:7], s25 offen sc1
  buffer_load_dwordx4 v[152:155], v26, s[4:7], s25 offen sc1
  buffer_load_dwordx4 v[156:159], v27, s[4:7], s25 offen sc1
  s_waitcnt vmcnt(7)
  v_cmp_eq_u32 vcc, -1, v128
  s_cbranch_vccnz reca_retry174
reca_resume175:
  s_waitcnt vmcnt(6)
  v_cmp_eq_u32 vcc, -1, v132
  s_cbranch_vccnz reca_retry176
reca_resume177:
  s_waitcnt vmcnt(5)
  v_cmp_eq_u32 vcc, -1, v136
  v_pk_add_f32 v[116:117], v[128:129], v[132:133]
  v_pk_add_f32 v[118:119], v[130:131], v[134:135]
  s_cbranch_vccnz reca_retry178
reca_resume179:
  s_waitcnt vmcnt(4)
  v_cmp_eq_u32 vcc, -1, v140
  v_pk_add_f32 v[116:117], v[116:117], v[136:137]
  v_pk_add_f32 v[118:119], v[118:119], v[138:139]
  s_cbranch_vccnz reca_retry180
reca_resume181:
  s_waitcnt vmcnt(3)
  v_cmp_eq_u32 vcc, -1, v144
  v_pk_add_f32 v[116:117], v[116:117], v[140:141]
  v_pk_add_f32 v[118:119], v[118:119], v[142:143]
  s_cbranch_vccnz reca_retry182
reca_resume183:
  s_waitcnt vmcnt(2)
  v_cmp_eq_u32 vcc, -1, v148
  v_pk_add_f32 v[116:117], v[116:117], v[144:145]
  v_pk_add_f32 v[118:119], v[118:119], v[146:147]
  s_cbranch_vccnz reca_retry184
reca_resume185:
  s_waitcnt vmcnt(1)
  v_cmp_eq_u32 vcc, -1, v152
  v_pk_add_f32 v[116:117], v[116:117], v[148:149]
  v_pk_add_f32 v[118:119], v[118:119], v[150:151]
  s_cbranch_vccnz reca_retry186
reca_resume187:
  s_waitcnt vmcnt(0)
  v_cmp_eq_u32 vcc, -1, v156
  v_pk_add_f32 v[116:117], v[116:117], v[152:153]
  v_pk_add_f32 v[118:119], v[118:119], v[154:155]
  s_cbranch_vccnz reca_retry188
reca_resume189:
  v_pk_add_f32 v[116:117], v[116:117], v[156:157]
  v_pk_add_f32 v[118:119], v[118:119], v[158:159]
  v_cvt_pk_bf16_f32 v132, v116, v117
  v_cvt_pk_bf16_f32 v133, v118, v119
  buffer_store_dwordx2 v[132:133], v16, s[4:7], s24 offen sc1
  s_branch reca_b5134
reca_not2173:
  s_cmp_lg_u32 s12, 3
  s_cbranch_scc1 reca_b5134
  s_add_u32 s36, s17, 1
  s_cmp_ge_u32 s36, 63
  s_cbranch_scc1 reca_nopf190
  s_add_u32 s37, s36, 1
reca_pf191:
  buffer_load_dword v28, v233, s[4:7], 0 offen sc1
  s_waitcnt vmcnt(0)
  v_cmp_gt_i32 vcc, s37, v28
  s_cbranch_vccz reca_pfok192
  s_sleep 1
  s_sub_u32 s18, s18, 1
  s_cbranch_scc0 reca_pf191
  s_mov_b32 s18, 0
reca_pfok192:
  s_lshl_b32 s34, s15, 3
  s_and_b32 s35, s36, 7
  s_add_u32 s34, s34, s35
  s_mul_i32 s34, s34, 12288
  s_add_u32 s32, s34, 37748736
  s_lshl_b32 s35, s16, 11
  s_add_u32 s34, s34, s35
  s_add_u32 s33, s34, 40894464
  buffer_load_dwordx4 a[120:123], v1, s[4:7], s32 offen offset:0 sc1
  buffer_load_dwordx4 a[124:127], v1, s[4:7], s32 offen offset:1024 sc1
  buffer_load_dwordx4 a[128:131], v1, s[4:7], s32 offen offset:2048 sc1
  buffer_load_dwordx4 a[132:135], v1, s[4:7], s32 offen offset:3072 sc1
  buffer_load_dwordx4 a[136:139], v2, s[4:7], s32 offen offset:0 sc1
  buffer_load_dwordx4 a[140:143], v2, s[4:7], s32 offen offset:1024 sc1
  buffer_load_dwordx4 a[144:147], v2, s[4:7], s32 offen offset:2048 sc1
  buffer_load_dwordx4 a[148:151], v2, s[4:7], s32 offen offset:3072 sc1
  buffer_load_dwordx4 a[152:155], v3, s[4:7], s32 offen offset:0 sc1
  buffer_load_dwordx4 a[156:159], v3, s[4:7], s32 offen offset:1024 sc1
  buffer_load_dwordx4 a[160:163], v3, s[4:7], s32 offen offset:2048 sc1
  buffer_load_dwordx4 a[164:167], v3, s[4:7], s32 offen offset:3072 sc1
  buffer_load_dwordx4 a[168:171], v1, s[4:7], s33 offen offset:0 sc1
  buffer_load_dwordx4 a[172:175], v1, s[4:7], s33 offen offset:1024 sc1
reca_nopf190:
  buffer_store_dwordx2 v[52:53], v9, s[4:7], s30 offen sc1
  buffer_store_dwordx2 v[68:69], v10, s[4:7], s31 offen sc1
  buffer_store_dwordx2 v[70:71], v10, s[4:7], s31 offen offset:256 sc1
reca_b5134:
  s_barrier
  s_add_u32 s17, s17, 1
  s_branch reca_step120
reca_retry123:
  s_sub_u32 s18, s18, 1
  s_cbranch_scc1 reca_retry123_to
  buffer_load_dwordx4 v[128:131], v4, s[4:7], s20 offen sc1
  buffer_load_dwordx4 v[132:135], v4, s[4:7], s20 offen offset:1024 sc1
  buffer_load_dwordx4 v[136:139], v5, s[4:7], s20 offen sc1
  s_waitcnt vmcnt(2)
  v_max_u32 v29, v128, v130
  v_cmp_eq_u32 vcc, -1, v29
  s_cbranch_vccnz reca_retry123
  s_branch reca_resume124
reca_retry123_to:
  s_mov_b32 s18, 0
  s_waitcnt vmcnt(0)
  s_branch reca_resume124
reca_retry125:
  s_sub_u32 s18, s18, 1
  s_cbranch_scc1 reca_retry125_to
  buffer_load_dwordx4 v[132:135], v4, s[4:7], s20 offen offset:1024 sc1
  buffer_load_dwordx4 v[136:139], v5, s[4:7], s20 offen sc1
  s_waitcnt vmcnt(1)
  v_max_u32 v29, v132, v134
  v_cmp_eq_u32 vcc, -1, v29
  s_cbranch_vccnz reca_retry125
  s_branch reca_resume126
reca_retry125_to:
  s_mov_b32 s18, 0
  s_waitcnt vmcnt(0)
  s_branch reca_resume126
reca_retry127:
  s_sub_u32 s18, s18, 1
  s_cbranch_scc1 reca_retry127_to
  buffer_load_dwordx4 v[136:139], v5, s[4:7], s20 offen sc1
  s_waitcnt vmcnt(0)
  v_max_u32 v29, v136, v138
  v_cmp_eq_u32 vcc, -1, v29
  s_cbranch_vccnz reca_retry127
  s_branch reca_resume128
reca_retry127_to:
  s_mov_b32 s18, 0
  s_waitcnt vmcnt(0)
  s_branch reca_resume128
reca_retry136:
  s_sub_u32 s18, s18, 1
  s_cbranch_scc1 reca_retry136_to
  buffer_load_dwordx4 v[208:211], v1, s[4:7], s21 offen offset:0 sc1
  buffer_load_dwordx4 v[212:215], v1, s[4:7], s21 offen offset:1024 sc1
  buffer_load_dwordx4 v[216:219], v1, s[4:7], s21 offen offset:2048 sc1
  buffer_load_dwordx4 v[220:223], v1, s[4:7], s21 offen offset:3072 sc1
  buffer_load_dwordx4 v[224:227], v2, s[4:7], s21 offen offset:0 sc1
  buffer_load_dwordx4 v[228:231], v2, s[4:7], s21 offen offset:1024 sc1
  s_waitcnt vmcnt(5)
  v_max_u32 v29, v208, v210
  v_cmp_eq_u32 vcc, -1, v29
  s_cbranch_vccnz reca_retry136
  s_branch reca_resume137
reca_retry136_to:
  s_mov_b32 s18, 0
  s_waitcnt vmcnt(0)
  s_branch reca_resume137
reca_retry138:
  s_sub_u32 s18, s18, 1
  s_cbranch_scc1 reca_retry138_to
  buffer_load_dwordx4 v[212:215], v1, s[4:7], s21 offen offset:1024 sc1
  buffer_load_dwordx4 v[216:219], v1, s[4:7], s21 offen offset:2048 sc1
  buffer_load_dwordx4 v[220:223], v1, s[4:7], s21 offen offset:3072 sc1
  buffer_load_dwordx4 v[224:227], v2, s[4:7], s21 offen offset:0 sc1
  buffer_load_dwordx4 v[228:231], v2, s[4:7], s21 offen offset:1024 sc1
  s_waitcnt vmcnt(4)
  v_max_u32 v29, v212, v214
  v_cmp_eq_u32 vcc, -1, v29
  s_cbranch_vccnz reca_retry138
  s_branch reca_resume139
reca_retry138_to:
  s_mov_b32 s18, 0
  s_waitcnt vmcnt(0)
  s_branch reca_resume139
reca_retry140:
  s_sub_u32 s18, s18, 1
  s_cbranch_scc1 reca_retry140_to
  buffer_load_dwordx4 v[216:219], v1, s[4:7], s21 offen offset:2048 sc1
  buffer_load_dwordx4 v[220:223], v1, s[4:7], s21 offen offset:3072 sc1
  buffer_load_dwordx4 v[224:227], v2, s[4:7], s21 offen offset:0 sc1
  buffer_load_dwordx4 v[228:231], v2, s[4:7], s21 offen offset:1024 sc1
  s_waitcnt vmcnt(3)
  v_max_u32 v29, v216, v218
  v_cmp_eq_u32 vcc, -1, v29
  s_cbranch_vccnz reca_retry140
  s_branch reca_resume141
reca_retry140_to:
  s_mov_b32 s18, 0
  s_waitcnt vmcnt(0)
  s_branch reca_resume141
reca_retry142:
  s_sub_u32 s18, s18, 1
  s_cbranch_scc1 reca_retry142_to
  buffer_load_dwordx4 v[220:223], v1, s[4:7], s21 offen offset:3072 sc1
  buffer_load_dwordx4 v[224:227], v2, s[4:7], s21 offen offset:0 sc1
  buffer_load_dwordx4 v[228:231], v2, s[4:7], s21 offen offset:1024 sc1
  s_waitcnt vmcnt(2)
  v_max_u32 v29, v220, v222
  v_cmp_eq_u32 vcc, -1, v29
  s_cbranch_vccnz reca_retry142
  s_branch reca_resume143
reca_retry142_to:
  s_mov_b32 s18, 0
  s_waitcnt vmcnt(0)
  s_branch reca_resume143
reca_retry144:
  s_sub_u32 s18, s18, 1
  s_cbranch_scc1 reca_retry144_to
  buffer_load_dwordx4 v[224:227], v2, s[4:7], s21 offen offset:0 sc1
  buffer_load_dwordx4 v[228:231], v2, s[4:7], s21 offen offset:1024 sc1
  s_waitcnt vmcnt(1)
  v_max_u32 v29, v224, v226
  v_cmp_eq_u32 vcc, -1, v29
  s_cbranch_vccnz reca_retry144
  s_branch reca_resume145
reca_retry144_to:
  s_mov_b32 s18, 0
  s_waitcnt vmcnt(0)
  s_branch reca_resume145
reca_retry146:
  s_sub_u32 s18, s18, 1
  s_cbranch_scc1 reca_retry146_to
  buffer_load_dwordx4 v[228:231], v2, s[4:7], s21 offen offset:1024 sc1
  s_waitcnt vmcnt(0)
  v_max_u32 v29, v228, v230
  v_cmp_eq_u32 vcc, -1, v29
  s_cbranch_vccnz reca_retry146
  s_branch reca_resume147
reca_retry146_to:
  s_mov_b32 s18, 0
  s_waitcnt vmcnt(0)
  s_branch reca_resume147
reca_retry149:
  s_sub_u32 s18, s18, 1
  s_cbranch_scc1 reca_retry149_to
  buffer_load_dwordx4 v[128:131], v12, s[4:7], s22 offen offset:0 sc1
  buffer_load_dwordx4 v[132:135], v12, s[4:7], s22 offen offset:1024 sc1
  buffer_load_dwordx4 v[136:139], v12, s[4:7], s22 offen offset:2048 sc1
  buffer_load_dwordx4 v[140:143], v12, s[4:7], s22 offen offset:3072 sc1
  buffer_load_dwordx4 v[144:147], v13, s[4:7], s22 offen offset:0 sc1
  buffer_load_dwordx4 v[148:151], v13, s[4:7], s22 offen offset:1024 sc1
  buffer_load_dwordx4 v[152:155], v13, s[4:7], s22 offen offset:2048 sc1
  buffer_load_dwordx4 v[156:159], v13, s[4:7], s22 offen offset:3072 sc1
  buffer_load_dwordx4 v[160:163], v14, s[4:7], s22 offen offset:0 sc1
  buffer_load_dwordx4 v[164:167], v14, s[4:7], s22 offen offset:1024 sc1
  buffer_load_dwordx4 v[168:171], v14, s[4:7], s22 offen offset:2048 sc1
  buffer_load_dwordx4 v[172:175], v14, s[4:7], s22 offen offset:3072 sc1
  s_waitcnt vmcnt(11)
  v_cmp_eq_u32 vcc, -1, v128
  s_cbranch_vccnz reca_retry149
  s_branch reca_resume150
reca_retry149_to:
  s_mov_b32 s18, 0
  s_waitcnt vmcnt(0)
  s_branch reca_resume150
reca_retry151:
  s_sub_u32 s18, s18, 1
  s_cbranch_scc1 reca_retry151_to
  buffer_load_dwordx4 v[132:135], v12, s[4:7], s22 offen offset:1024 sc1
  buffer_load_dwordx4 v[136:139], v12, s[4:7], s22 offen offset:2048 sc1
  buffer_load_dwordx4 v[140:143], v12, s[4:7], s22 offen offset:3072 sc1
  buffer_load_dwordx4 v[144:147], v13, s[4:7], s22 offen offset:0 sc1
  buffer_load_dwordx4 v[148:151], v13, s[4:7], s22 offen offset:1024 sc1
  buffer_load_dwordx4 v[152:155], v13, s[4:7], s22 offen offset:2048 sc1
  buffer_load_dwordx4 v[156:159], v13, s[4:7], s22 offen offset:3072 sc1
  buffer_load_dwordx4 v[160:163], v14, s[4:7], s22 offen offset:0 sc1
  buffer_load_dwordx4 v[164:167], v14, s[4:7], s22 offen offset:1024 sc1
  buffer_load_dwordx4 v[168:171], v14, s[4:7], s22 offen offset:2048 sc1
  buffer_load_dwordx4 v[172:175], v14, s[4:7], s22 offen offset:3072 sc1
  s_waitcnt vmcnt(10)
  v_cmp_eq_u32 vcc, -1, v132
  s_cbranch_vccnz reca_retry151
  s_branch reca_resume152
reca_retry151_to:
  s_mov_b32 s18, 0
  s_waitcnt vmcnt(0)
  s_branch reca_resume152
reca_retry153:
  s_sub_u32 s18, s18, 1
  s_cbranch_scc1 reca_retry153_to
  buffer_load_dwordx4 v[136:139], v12, s[4:7], s22 offen offset:2048 sc1
  buffer_load_dwordx4 v[140:143], v12, s[4:7], s22 offen offset:3072 sc1
  buffer_load_dwordx4 v[144:147], v13, s[4:7], s22 offen offset:0 sc1
  buffer_load_dwordx4 v[148:151], v13, s[4:7], s22 offen offset:1024 sc1
  buffer_load_dwordx4 v[152:155], v13, s[4:7], s22 offen offset:2048 sc1
  buffer_load_dwordx4 v[156:159], v13, s[4:7], s22 offen offset:3072 sc1
  buffer_load_dwordx4 v[160:163], v14, s[4:7], s22 offen offset:0 sc1
  buffer_load_dwordx4 v[164:167], v14, s[4:7], s22 offen offset:1024 sc1
  buffer_load_dwordx4 v[168:171], v14, s[4:7], s22 offen offset:2048 sc1
  buffer_load_dwordx4 v[172:175], v14, s[4:7], s22 offen offset:3072 sc1
  s_waitcnt vmcnt(9)
  v_cmp_eq_u32 vcc, -1, v136
  s_cbranch_vccnz reca_retry153
  s_branch reca_resume154
reca_retry153_to:
  s_mov_b32 s18, 0
  s_waitcnt vmcnt(0)
  s_branch reca_resume154
reca_retry155:
  s_sub_u32 s18, s18, 1
  s_cbranch_scc1 reca_retry155_to
  buffer_load_dwordx4 v[140:143], v12, s[4:7], s22 offen offset:3072 sc1
  buffer_load_dwordx4 v[144:147], v13, s[4:7], s22 offen offset:0 sc1
  buffer_load_dwordx4 v[148:151], v13, s[4:7], s22 offen offset:1024 sc1
  buffer_load_dwordx4 v[152:155], v13, s[4:7], s22 offen offset:2048 sc1
  buffer_load_dwordx4 v[156:159], v13, s[4:7], s22 offen offset:3072 sc1
  buffer_load_dwordx4 v[160:163], v14, s[4:7], s22 offen offset:0 sc1
  buffer_load_dwordx4 v[164:167], v14, s[4:7], s22 offen offset:1024 sc1
  buffer_load_dwordx4 v[168:171], v14, s[4:7], s22 offen offset:2048 sc1
  buffer_load_dwordx4 v[172:175], v14, s[4:7], s22 offen offset:3072 sc1
  s_waitcnt vmcnt(8)
  v_cmp_eq_u32 vcc, -1, v140
  s_cbranch_vccnz reca_retry155
  s_branch reca_resume156
reca_retry155_to:
  s_mov_b32 s18, 0
  s_waitcnt vmcnt(0)
  s_branch reca_resume156
reca_retry157:
  s_sub_u32 s18, s18, 1
  s_cbranch_scc1 reca_retry157_to
  buffer_load_dwordx4 v[144:147], v13, s[4:7], s22 offen offset:0 sc1
  buffer_load_dwordx4 v[148:151], v13, s[4:7], s22 offen offset:1024 sc1
  buffer_load_dwordx4 v[152:155], v13, s[4:7], s22 offen offset:2048 sc1
  buffer_load_dwordx4 v[156:159], v13, s[4:7], s22 offen offset:3072 sc1
  buffer_load_dwordx4 v[160:163], v14, s[4:7], s22 offen offset:0 sc1
  buffer_load_dwordx4 v[164:167], v14, s[4:7], s22 offen offset:1024 sc1
  buffer_load_dwordx4 v[168:171], v14, s[4:7], s22 offen offset:2048 sc1
  buffer_load_dwordx4 v[172:175], v14, s[4:7], s22 offen offset:3072 sc1
  s_waitcnt vmcnt(7)
  v_cmp_eq_u32 vcc, -1, v144
  s_cbranch_vccnz reca_retry157
  s_branch reca_resume158
reca_retry157_to:
  s_mov_b32 s18, 0
  s_waitcnt vmcnt(0)
  s_branch reca_resume158
reca_retry159:
  s_sub_u32 s18, s18, 1
  s_cbranch_scc1 reca_retry159_to
  buffer_load_dwordx4 v[148:151], v13, s[4:7], s22 offen offset:1024 sc1
  buffer_load_dwordx4 v[152:155], v13, s[4:7], s22 offen offset:2048 sc1
  buffer_load_dwordx4 v[156:159], v13, s[4:7], s22 offen offset:3072 sc1
  buffer_load_dwordx4 v[160:163], v14, s[4:7], s22 offen offset:0 sc1
  buffer_load_dwordx4 v[164:167], v14, s[4:7], s22 offen offset:1024 sc1
  buffer_load_dwordx4 v[168:171], v14, s[4:7], s22 offen offset:2048 sc1
  buffer_load_dwordx4 v[172:175], v14, s[4:7], s22 offen offset:3072 sc1
  s_waitcnt vmcnt(6)
  v_cmp_eq_u32 vcc, -1, v148
  s_cbranch_vccnz reca_retry159
  s_branch reca_resume160
reca_retry159_to:
  s_mov_b32 s18, 0
  s_waitcnt vmcnt(0)
  s_branch reca_resume160
reca_retry161:
  s_sub_u32 s18, s18, 1
  s_cbranch_scc1 reca_retry161_to
  buffer_load_dwordx4 v[152:155], v13, s[4:7], s22 offen offset:2048 sc1
  buffer_load_dwordx4 v[156:159], v13, s[4:7], s22 offen offset:3072 sc1
  buffer_load_dwordx4 v[160:163], v14, s[4:7], s22 offen offset:0 sc1
  buffer_load_dwordx4 v[164:167], v14, s[4:7], s22 offen offset:1024 sc1
  buffer_load_dwordx4 v[168:171], v14, s[4:7], s22 offen offset:2048 sc1
  buffer_load_dwordx4 v[172:175], v14, s[4:7], s22 offen offset:3072 sc1
  s_waitcnt vmcnt(5)
  v_cmp_eq_u32 vcc, -1, v152
  s_cbranch_vccnz reca_retry161
  s_branch reca_resume162
reca_retry161_to:
  s_mov_b32 s18, 0
  s_waitcnt vmcnt(0)
  s_branch reca_resume162
reca_retry163:
  s_sub_u32 s18, s18, 1
  s_cbranch_scc1 reca_retry163_to
  buffer_load_dwordx4 v[156:159], v13, s[4:7], s22 offen offset:3072 sc1
  buffer_load_dwordx4 v[160:163], v14, s[4:7], s22 offen offset:0 sc1
  buffer_load_dwordx4 v[164:167], v14, s[4:7], s22 offen offset:1024 sc1
  buffer_load_dwordx4 v[168:171], v14, s[4:7], s22 offen offset:2048 sc1
  buffer_load_dwordx4 v[172:175], v14, s[4:7], s22 offen offset:3072 sc1
  s_waitcnt vmcnt(4)
  v_cmp_eq_u32 vcc, -1, v156
  s_cbranch_vccnz reca_retry163
  s_branch reca_resume164
reca_retry163_to:
  s_mov_b32 s18, 0
  s_waitcnt vmcnt(0)
  s_branch reca_resume164
reca_retry165:
  s_sub_u32 s18, s18, 1
  s_cbranch_scc1 reca_retry165_to
  buffer_load_dwordx4 v[160:163], v14, s[4:7], s22 offen offset:0 sc1
  buffer_load_dwordx4 v[164:167], v14, s[4:7], s22 offen offset:1024 sc1
  buffer_load_dwordx4 v[168:171], v14, s[4:7], s22 offen offset:2048 sc1
  buffer_load_dwordx4 v[172:175], v14, s[4:7], s22 offen offset:3072 sc1
  s_waitcnt vmcnt(3)
  v_cmp_eq_u32 vcc, -1, v160
  s_cbranch_vccnz reca_retry165
  s_branch reca_resume166
reca_retry165_to:
  s_mov_b32 s18, 0
  s_waitcnt vmcnt(0)
  s_branch reca_resume166
reca_retry167:
  s_sub_u32 s18, s18, 1
  s_cbranch_scc1 reca_retry167_to
  buffer_load_dwordx4 v[164:167], v14, s[4:7], s22 offen offset:1024 sc1
  buffer_load_dwordx4 v[168:171], v14, s[4:7], s22 offen offset:2048 sc1
  buffer_load_dwordx4 v[172:175], v14, s[4:7], s22 offen offset:3072 sc1
  s_waitcnt vmcnt(2)
  v_cmp_eq_u32 vcc, -1, v164
  s_cbranch_vccnz reca_retry167
  s_branch reca_resume168
reca_retry167_to:
  s_mov_b32 s18, 0
  s_waitcnt vmcnt(0)
  s_branch reca_resume168
reca_retry169:
  s_sub_u32 s18, s18, 1
  s_cbranch_scc1 reca_retry169_to
  buffer_load_dwordx4 v[168:171], v14, s[4:7], s22 offen offset:2048 sc1
  buffer_load_dwordx4 v[172:175], v14, s[4:7], s22 offen offset:3072 sc1
  s_waitcnt vmcnt(1)
  v_cmp_eq_u32 vcc, -1, v168
  s_cbranch_vccnz reca_retry169
  s_branch reca_resume170
reca_retry169_to:
  s_mov_b32 s18, 0
  s_waitcnt vmcnt(0)
  s_branch reca_resume170
reca_retry171:
  s_sub_u32 s18, s18, 1
  s_cbranch_scc1 reca_retry171_to
  buffer_load_dwordx4 v[172:175], v14, s[4:7], s22 offen offset:3072 sc1
  s_waitcnt vmcnt(0)
  v_cmp_eq_u32 vcc, -1, v172
  s_cbranch_vccnz reca_retry171
  s_branch reca_resume172
reca_retry171_to:
  s_mov_b32 s18, 0
  s_waitcnt vmcnt(0)
  s_branch reca_resume172
reca_retry174:
  s_sub_u32 s18, s18, 1
  s_cbranch_scc1 reca_retry174_to
  buffer_load_dwordx4 v[128:131], v20, s[4:7], s25 offen sc1
  buffer_load_dwordx4 v[132:135], v21, s[4:7], s25 offen sc1
  buffer_load_dwordx4 v[136:139], v22, s[4:7], s25 offen sc1
  buffer_load_dwordx4 v[140:143], v23, s[4:7], s25 offen sc1
  buffer_load_dwordx4 v[144:147], v24, s[4:7], s25 offen sc1
  buffer_load_dwordx4 v[148:151], v25, s[4:7], s25 offen sc1
  buffer_load_dwordx4 v[152:155], v26, s[4:7], s25 offen sc1
  buffer_load_dwordx4 v[156:159], v27, s[4:7], s25 offen sc1
  s_waitcnt vmcnt(7)
  v_cmp_eq_u32 vcc, -1, v128
  s_cbranch_vccnz reca_retry174
  s_branch reca_resume175
reca_retry174_to:
  s_mov_b32 s18, 0
  s_waitcnt vmcnt(0)
  s_branch reca_resume175
reca_retry176:
  s_sub_u32 s18, s18, 1
  s_cbranch_scc1 reca_retry176_to
  buffer_load_dwordx4 v[132:135], v21, s[4:7], s25 offen sc1
  buffer_load_dwordx4 v[136:139], v22, s[4:7], s25 offen sc1
  buffer_load_dwordx4 v[140:143], v23, s[4:7], s25 offen sc1
  buffer_load_dwordx4 v[144:147], v24, s[4:7], s25 offen sc1
  buffer_load_dwordx4 v[148:151], v25, s[4:7], s25 offen sc1
  buffer_load_dwordx4 v[152:155], v26, s[4:7], s25 offen sc1
  buffer_load_dwordx4 v[156:159], v27, s[4:7], s25 offen sc1
  s_waitcnt vmcnt(6)
  v_cmp_eq_u32 vcc, -1, v132
  s_cbranch_vccnz reca_retry176
  s_branch reca_resume177
reca_retry176_to:
  s_mov_b32 s18, 0
  s_waitcnt vmcnt(0)
  s_branch reca_resume177
reca_retry178:
  s_sub_u32 s18, s18, 1
  s_cbranch_scc1 reca_retry178_to
  buffer_load_dwordx4 v[136:139], v22, s[4:7], s25 offen sc1
  buffer_load_dwordx4 v[140:143], v23, s[4:7], s25 offen sc1
  buffer_load_dwordx4 v[144:147], v24, s[4:7], s25 offen sc1
  buffer_load_dwordx4 v[148:151], v25, s[4:7], s25 offen sc1
  buffer_load_dwordx4 v[152:155], v26, s[4:7], s25 offen sc1
  buffer_load_dwordx4 v[156:159], v27, s[4:7], s25 offen sc1
  s_waitcnt vmcnt(5)
  v_cmp_eq_u32 vcc, -1, v136
  s_cbranch_vccnz reca_retry178
  s_branch reca_resume179
reca_retry178_to:
  s_mov_b32 s18, 0
  s_waitcnt vmcnt(0)
  s_branch reca_resume179
reca_retry180:
  s_sub_u32 s18, s18, 1
  s_cbranch_scc1 reca_retry180_to
  buffer_load_dwordx4 v[140:143], v23, s[4:7], s25 offen sc1
  buffer_load_dwordx4 v[144:147], v24, s[4:7], s25 offen sc1
  buffer_load_dwordx4 v[148:151], v25, s[4:7], s25 offen sc1
  buffer_load_dwordx4 v[152:155], v26, s[4:7], s25 offen sc1
  buffer_load_dwordx4 v[156:159], v27, s[4:7], s25 offen sc1
  s_waitcnt vmcnt(4)
  v_cmp_eq_u32 vcc, -1, v140
  s_cbranch_vccnz reca_retry180
  s_branch reca_resume181
reca_retry180_to:
  s_mov_b32 s18, 0
  s_waitcnt vmcnt(0)
  s_branch reca_resume181
reca_retry182:
  s_sub_u32 s18, s18, 1
  s_cbranch_scc1 reca_retry182_to
  buffer_load_dwordx4 v[144:147], v24, s[4:7], s25 offen sc1
  buffer_load_dwordx4 v[148:151], v25, s[4:7], s25 offen sc1
  buffer_load_dwordx4 v[152:155], v26, s[4:7], s25 offen sc1
  buffer_load_dwordx4 v[156:159], v27, s[4:7], s25 offen sc1
  s_waitcnt vmcnt(3)
  v_cmp_eq_u32 vcc, -1, v144
  s_cbranch_vccnz reca_retry182
  s_branch reca_resume183
reca_retry182_to:
  s_mov_b32 s18, 0
  s_waitcnt vmcnt(0)
  s_branch reca_resume183
reca_retry184:
  s_sub_u32 s18, s18, 1
  s_cbranch_scc1 reca_retry184_to
  buffer_load_dwordx4 v[148:151], v25, s[4:7], s25 offen sc1
  buffer_load_dwordx4 v[152:155], v26, s[4:7], s25 offen sc1
  buffer_load_dwordx4 v[156:159], v27, s[4:7], s25 offen sc1
  s_waitcnt vmcnt(2)
  v_cmp_eq_u32 vcc, -1, v148
  s_cbranch_vccnz reca_retry184
  s_branch reca_resume185
reca_retry184_to:
  s_mov_b32 s18, 0
  s_waitcnt vmcnt(0)
  s_branch reca_resume185
reca_retry186:
  s_sub_u32 s18, s18, 1
  s_cbranch_scc1 reca_retry186_to
  buffer_load_dwordx4 v[152:155], v26, s[4:7], s25 offen sc1
  buffer_load_dwordx4 v[156:159], v27, s[4:7], s25 offen sc1
  s_waitcnt vmcnt(1)
  v_cmp_eq_u32 vcc, -1, v152
  s_cbranch_vccnz reca_retry186
  s_branch reca_resume187
reca_retry186_to:
  s_mov_b32 s18, 0
  s_waitcnt vmcnt(0)
  s_branch reca_resume187
reca_retry188:
  s_sub_u32 s18, s18, 1
  s_cbranch_scc1 reca_retry188_to
  buffer_load_dwordx4 v[156:159], v27, s[4:7], s25 offen sc1
  s_waitcnt vmcnt(0)
  v_cmp_eq_u32 vcc, -1, v156
  s_cbranch_vccnz reca_retry188
  s_branch reca_resume189
reca_retry188_to:
  s_mov_b32 s18, 0
  s_waitcnt vmcnt(0)
  s_branch reca_resume189
reca_twins13:
  s_branch reca_gotmem194
reca_step193:
  s_and_b32 s34, s17, 3
  s_mul_i32 s20, s34, 10240
  s_add_u32 s20, s20, s38
  s_sleep 5
  buffer_load_dwordx4 v[128:131], v4, s[4:7], s20 offen sc1
  buffer_load_dwordx4 v[132:135], v4, s[4:7], s20 offen offset:1024 sc1
  buffer_load_dwordx4 v[136:139], v5, s[4:7], s20 offen sc1
  s_waitcnt vmcnt(2)
  v_max_u32 v29, v128, v130
  v_cmp_eq_u32 vcc, -1, v29
  s_cbranch_vccnz reca_retry196
reca_resume197:
  s_waitcnt vmcnt(1)
  v_max_u32 v29, v132, v134
  v_cmp_eq_u32 vcc, -1, v29
  ds_write_b128 v4, v[128:131]
  s_cbranch_vccnz reca_retry198
reca_resume199:
  s_waitcnt vmcnt(0)
  v_max_u32 v29, v136, v138
  v_cmp_eq_u32 vcc, -1, v29
  ds_write_b128 v4, v[132:135] offset:1024
  s_cbranch_vccnz reca_retry200
reca_resume201:
  ds_write_b128 v5, v[136:139]
  s_branch reca_gotmem2195
reca_gotmem194:
  ds_write_b128 v4, v[128:131]
  ds_write_b128 v4, v[132:135] offset:1024
  ds_write_b128 v5, v[136:139]
reca_gotmem2195:
  s_and_b32 s34, s17, 3
  s_mul_i32 s21, s34, 6144
  s_add_u32 s21, s21, s39
  s_mul_i32 s22, s34, 12288
  s_add_u32 s22, s22, s40
  s_mul_i32 s25, s34, 393216
  s_add_u32 s25, s25, s56
  s_add_u32 s35, s17, 1
  s_and_b32 s35, s35, 3
  s_mul_i32 s24, s35, 10240
  s_add_u32 s24, s24, s38
  s_waitcnt lgkmcnt(0)
  s_barrier
  ds_read_b128 v[128:131], v236 offset:0
  ds_read_b128 v[132:135], v236 offset:1024
  ds_read_b128 v[136:139], v236 offset:2048
  ds_read_b128 v[140:143], v236 offset:3072
  ds_read_b128 v[144:147], v236 offset:4096
  ds_read_b128 v[148:151], v237 offset:0
  ds_read_b128 v[152:155], v237 offset:1024
  ds_read_b128 v[156:159], v237 offset:2048
  ds_read_b128 v[160:163], v237 offset:3072
  ds_read_b128 v[164:167], v237 offset:4096
  s_waitcnt lgkmcnt(9)
  v_mfma_f32_16x16x32_bf16 v[44:47], a[0:3], v[128:131], 0
  ds_read_b128 v[168:171], v6 offset:0
  v_mfma_f32_16x16x32_bf16 v[240:243], a[4:7], v[128:131], 0
  s_waitcnt lgkmcnt(9)
  v_mfma_f32_16x16x32_bf16 v[44:47], a[8:11], v[132:135], v[44:47]
  ds_read_b128 v[172:175], v6 offset:512
  v_mfma_f32_16x16x32_bf16 v[240:243], a[12:15], v[132:135], v[240:243]
  s_waitcnt lgkmcnt(9)
  v_mfma_f32_16x16x32_bf16 v[44:47], a[16:19], v[136:139], v[44:47]
  ds_read_b128 v[176:179], v6 offset:1024
  v_mfma_f32_16x16x32_bf16 v[240:243], a[20:23], v[136:139], v[240:243]
  s_waitcnt lgkmcnt(9)
  v_mfma_f32_16x16x32_bf16 v[44:47], a[24:27], v[140:143], v[44:47]
  ds_read_b128 v[180:183], v6 offset:1536
  v_mfma_f32_16x16x32_bf16 v[240:243], a[28:31], v[140:143], v[240:243]
  s_waitcnt lgkmcnt(9)
  v_mfma_f32_16x16x32_bf16 v[44:47], a[32:35], v[144:147], v[44:47]
  ds_read_b128 v[184:187], v6 offset:2048
  v_mfma_f32_16x16x32_bf16 v[240:243], a[36:39], v[144:147], v[240:243]
  s_waitcnt lgkmcnt(9)
  v_mfma_f32_16x16x32_bf16 v[44:47], a[40:43], v[148:151], v[44:47]
  ds_read_b128 v[188:191], v6 offset:2560
  v_mfma_f32_16x16x32_bf16 v[240:243], a[44:47], v[148:151], v[240:243]
  s_waitcnt lgkmcnt(9)
  v_mfma_f32_16x16x32_bf16 v[44:47], a[48:51], v[152:155], v[44:47]
  ds_read_b128 v[192:195], v6 offset:3072
  v_mfma_f32_16x16x32_bf16 v[240:243], a[52:55], v[152:155], v[240:243]
  s_waitcnt lgkmcnt(9)
  v_mfma_f32_16x16x32_bf16 v[44:47], a[56:59], v[156:159], v[44:47]
  ds_read_b128 v[196:199], v6 offset:3584
  v_mfma_f32_16x16x32_bf16 v[240:243], a[60:63], v[156:159], v[240:243]
  s_waitcnt lgkmcnt(9)
  v_mfma_f32_16x16x32_bf16 v[44:47], a[64:67], v[160:163], v[44:47]
  ds_read_b128 v[200:203], v6 offset:4096
  v_mfma_f32_16x16x32_bf16 v[240:243], a[68:71], v[160:163], v[240:243]
  s_waitcnt lgkmcnt(9)
  v_mfma_f32_16x16x32_bf16 v[44:47], a[72:75], v[164:167], v[44:47]
  ds_read_b128 v[204:207], v6 offset:4608
  v_mfma_f32_16x16x32_bf16 v[240:243], a[76:79], v[164:167], v[240:243]
  s_waitcnt lgkmcnt(9)
  v_mfma_f32_16x16x32_bf16 v[48:51], v[168:171], a[80:83], 0
  s_and_b32 s34, s17, 7
  s_lshl_b32 s34, s34, 5
  s_add_u32 s34, s34, s15
  s_mul_i32 s34, s34, 3072
  s_lshl_b32 s35, s16, 9
  s_add_u32 s34, s34, s35
  s_add_u32 s30, s34, 47185920
  s_add_u32 s31, s34, 47972352
  v_add_f32_dpp v44, v240, v44 row_ror:8 row_mask:0xf bank_mask:0xf
  v_add_f32_dpp v45, v241, v45 row_ror:8 row_mask:0xf bank_mask:0xf
  v_add_f32_dpp v46, v242, v46 row_ror:8 row_mask:0xf bank_mask:0xf
  v_add_f32_dpp v47, v243, v47 row_ror:8 row_mask:0xf bank_mask:0xf
  v_cvt_pk_bf16_f32 v52, v44, v45
  v_cvt_pk_bf16_f32 v53, v46, v47
  buffer_store_dwordx2 v[52:53], v8, s[4:7], s21 offen sc1
  s_waitcnt lgkmcnt(8)
  v_mfma_f32_16x16x32_bf16 v[48:51], v[172:175], a[84:87], v[48:51]
  s_waitcnt lgkmcnt(7)
  v_mfma_f32_16x16x32_bf16 v[48:51], v[176:179], a[88:91], v[48:51]
  s_waitcnt lgkmcnt(6)
  v_mfma_f32_16x16x32_bf16 v[48:51], v[180:183], a[92:95], v[48:51]
  s_waitcnt lgkmcnt(5)
  v_mfma_f32_16x16x32_bf16 v[48:51], v[184:187], a[96:99], v[48:51]
  s_waitcnt lgkmcnt(4)
  v_mfma_f32_16x16x32_bf16 v[48:51], v[188:191], a[100:103], v[48:51]
  s_waitcnt lgkmcnt(3)
  v_mfma_f32_16x16x32_bf16 v[48:51], v[192:195], a[104:107], v[48:51]
  s_waitcnt lgkmcnt(2)
  v_mfma_f32_16x16x32_bf16 v[48:51], v[196:199], a[108:111], v[48:51]
  s_waitcnt lgkmcnt(1)
  v_mfma_f32_16x16x32_bf16 v[48:51], v[200:203], a[112:115], v[48:51]
  s_waitcnt lgkmcnt(0)
  v_mfma_f32_16x16x32_bf16 v[48:51], v[204:207], a[116:119], v[48:51]
  s_cmp_eq_u32 s12, 3
  s_cbranch_scc1 reca_swave202
  s_nop 5
  ds_write_b128 v17, v[48:51]
  s_add_u32 s34, s17, 2
  s_and_b32 s34, s34, 3
  s_mul_i32 s26, s34, 10240
  s_add_u32 s26, s26, s38
  s_mul_i32 s27, s34, 6144
  s_add_u32 s27, s27, s39
  s_mul_i32 s28, s34, 12288
  s_add_u32 s28, s28, s40
  s_mul_i32 s29, s34, 393216
  s_add_u32 s29, s29, s56
  s_waitcnt lgkmcnt(0)
  s_barrier
  s_cmp_eq_u32 s17, 63
  s_cbranch_scc1 reca_last204
  buffer_store_dwordx2 v[32:33], v8, s[4:7], s27 offen sc1
  s_cmp_lg_u32 s12, 2
  s_cbranch_scc1 reca_tw1208_n
  buffer_store_dwordx2 v[52:53], v9, s[4:7], s30 offen sc1
reca_tw1208_n:
  s_barrier
  s_cmp_eq_u32 s12, 1
  s_cbranch_scc1 reca_tw1208
  s_cmp_eq_u32 s12, 2
  s_cbranch_scc1 reca_tw2209
  s_cmp_lt_u32 s17, 2
  s_cbranch_scc1 reca_b5207
  s_cmp_gt_u32 s17, 61
  s_cbranch_scc1 reca_b5207
  s_sub_u32 s36, s17, 2
  s_and_b32 s36, s36, 7
  s_lshl_b32 s34, s59, 3
  s_add_u32 s34, s34, s36
  s_mul_i32 s34, s34, 12288
  s_add_u32 s23, s34, 37748736
  s_add_u32 s60, s34, 44040192
  s_lshl_b32 s35, s36, 5
  s_add_u32 s35, s35, s59
  s_mul_i32 s35, s35, 3072
  s_add_u32 s61, s35, 47185920
  buffer_load_dwordx4 a[120:123], v1, s[4:7], s23 offen offset:0 sc1
  buffer_load_dwordx4 a[124:127], v1, s[4:7], s23 offen offset:1024 sc1
  buffer_load_dwordx4 a[128:131], v1, s[4:7], s23 offen offset:2048 sc1
  buffer_load_dwordx4 a[132:135], v1, s[4:7], s23 offen offset:3072 sc1
  buffer_load_dwordx4 a[136:139], v2, s[4:7], s23 offen offset:0 sc1
  buffer_load_dwordx4 a[140:143], v2, s[4:7], s23 offen offset:1024 sc1
  buffer_load_dwordx4 a[144:147], v2, s[4:7], s23 offen offset:2048 sc1
  buffer_load_dwordx4 a[148:151], v2, s[4:7], s23 offen offset:3072 sc1
  buffer_load_dwordx4 a[152:155], v3, s[4:7], s23 offen offset:0 sc1
  buffer_load_dwordx4 a[156:159], v3, s[4:7], s23 offen offset:1024 sc1
  buffer_load_dwordx4 a[160:163], v3, s[4:7], s23 offen offset:2048 sc1
  buffer_load_dwordx4 a[164:167], v3, s[4:7], s23 offen offset:3072 sc1
  buffer_load_dwordx4 a[216:219], v92, s[4:7], s61 offen offset:0 sc1
  buffer_load_dwordx4 a[220:223], v92, s[4:7], s61 offen offset:512 sc1
  buffer_load_dwordx4 a[224:227], v92, s[4:7], s61 offen offset:1024 sc1
  buffer_load_dwordx4 a[228:231], v92, s[4:7], s61 offen offset:1536 sc1
  buffer_load_dwordx4 a[232:235], v92, s[4:7], s61 offen offset:2048 sc1
  buffer_load_dwordx4 a[236:239], v92, s[4:7], s61 offen offset:2560 sc1
  buffer_load_dwordx4 a[168:171], v1, s[4:7], s60 offen offset:0 sc1
  buffer_load_dwordx4 a[172:175], v1, s[4:7], s60 offen offset:1024 sc1
  buffer_load_dwordx4 a[176:179], v1, s[4:7], s60 offen offset:2048 sc1
  buffer_load_dwordx4 a[180:183], v1, s[4:7], s60 offen offset:3072 sc1
  buffer_load_dwordx4 a[184:187], v2, s[4:7], s60 offen offset:0 sc1
  buffer_load_dwordx4 a[188:191], v2, s[4:7], s60 offen offset:1024 sc1
  buffer_load_dwordx4 a[192:195], v2, s[4:7], s60 offen offset:2048 sc1
  buffer_load_dwordx4 a[196:199], v2, s[4:7], s60 offen offset:3072 sc1
  buffer_load_dwordx4 a[200:203], v3, s[4:7], s60 offen offset:0 sc1
  buffer_load_dwordx4 a[204:207], v3, s[4:7], s60 offen offset:1024 sc1
  buffer_load_dwordx4 a[208:211], v3, s[4:7], s60 offen offset:2048 sc1
  buffer_load_dwordx4 a[212:215], v3, s[4:7], s60 offen offset:3072 sc1
  s_waitcnt vmcnt(5)
  v_mfma_f32_16x16x32_bf16 v[128:131], a[216:219], a[168:171], v[84:87]
  v_mfma_f32_16x16x32_bf16 v[132:135], a[120:123], a[168:171], v[88:91]
  v_mfma_f32_16x16x32_bf16 v[136:139], a[216:219], a[192:195], v[84:87]
  v_mfma_f32_16x16x32_bf16 v[140:143], a[120:123], a[192:195], 0
  v_mfma_f32_16x16x32_bf16 v[144:147], a[144:147], a[192:195], v[88:91]
  s_waitcnt vmcnt(4)
  v_mfma_f32_16x16x32_bf16 v[128:131], a[220:223], a[172:175], v[128:131]
  v_mfma_f32_16x16x32_bf16 v[132:135], a[124:127], a[172:175], v[132:135]
  v_mfma_f32_16x16x32_bf16 v[136:139], a[220:223], a[196:199], v[136:139]
  v_mfma_f32_16x16x32_bf16 v[140:143], a[124:127], a[196:199], v[140:143]
  v_mfma_f32_16x16x32_bf16 v[144:147], a[148:151], a[196:199], v[144:147]
  s_waitcnt vmcnt(3)
  v_mfma_f32_16x16x32_bf16 v[128:131], a[224:227], a[176:179], v[128:131]
  v_mfma_f32_16x16x32_bf16 v[132:135], a[128:131], a[176:179], v[132:135]
  v_mfma_f32_16x16x32_bf16 v[136:139], a[224:227], a[200:203], v[136:139]
  v_mfma_f32_16x16x32_bf16 v[140:143], a[128:131], a[200:203], v[140:143]
  v_mfma_f32_16x16x32_bf16 v[144:147], a[152:155], a[200:203], v[144:147]
  s_waitcnt vmcnt(2)
  v_mfma_f32_16x16x32_bf16 v[128:131], a[228:231], a[180:183], v[128:131]
  v_mfma_f32_16x16x32_bf16 v[132:135], a[132:135], a[180:183], v[132:135]
  v_mfma_f32_16x16x32_bf16 v[136:139], a[228:231], a[204:207], v[136:139]
  v_mfma_f32_16x16x32_bf16 v[140:143], a[132:135], a[204:207], v[140:143]
  v_mfma_f32_16x16x32_bf16 v[144:147], a[156:159], a[204:207], v[144:147]
  s_waitcnt vmcnt(1)
  v_mfma_f32_16x16x32_bf16 v[128:131], a[232:235], a[184:187], v[128:131]
  v_mfma_f32_16x16x32_bf16 v[132:135], a[136:139], a[184:187], v[132:135]
  v_mfma_f32_16x16x32_bf16 v[136:139], a[232:235], a[208:211], v[136:139]
  v_mfma_f32_16x16x32_bf16 v[140:143], a[136:139], a[208:211], v[140:143]
  v_mfma_f32_16x16x32_bf16 v[144:147], a[160:163], a[208:211], v[144:147]
  s_waitcnt vmcnt(0)
  v_mfma_f32_16x16x32_bf16 v[128:131], a[236:239], a[188:191], v[128:131]
  v_mfma_f32_16x16x32_bf16 v[132:135], a[140:143], a[188:191], v[132:135]
  v_mfma_f32_16x16x32_bf16 v[136:139], a[236:239], a[212:215], v[136:139]
  v_mfma_f32_16x16x32_bf16 v[140:143], a[140:143], a[212:215], v[140:143]
  v_mfma_f32_16x16x32_bf16 v[144:147], a[164:167], a[212:215], v[144:147]
  s_nop 3
  v_max3_f32 v28, v128, v129, v130
  v_max3_f32 v28, v28, v131, v132
  v_max3_f32 v28, v28, v133, v134
  v_max_f32 v28, v28, v135
  v_mov_b32 v29, v28
  s_nop 1
  v_permlane32_swap_b32 v28, v29
  v_max_f32 v28, v28, v29
  v_mov_b32 v29, v28
  s_nop 1
  v_permlane16_swap_b32 v28, v29
  v_max_f32 v28, v28, v29
  v_mul_f32 v28, s41, v28
  v_fma_f32 v128, v128, s41, -v28
  v_fma_f32 v129, v129, s41, -v28
  v_fma_f32 v130, v130, s41, -v28
  v_fma_f32 v131, v131, s41, -v28
  v_fma_f32 v132, v132, s41, -v28
  v_fma_f32 v133, v133, s41, -v28
  v_fma_f32 v134, v134, s41, -v28
  v_fma_f32 v135, v135, s41, -v28
  v_exp_f32 v128, v128
  v_exp_f32 v129, v129
  v_exp_f32 v130, v130
  v_exp_f32 v131, v131
  v_exp_f32 v132, v132
  v_exp_f32 v133, v133
  v_exp_f32 v134, v134
  v_exp_f32 v135, v135
  v_max3_f32 v30, v136, v137, v138
  v_max3_f32 v30, v30, v139, v140
  v_max3_f32 v30, v30, v141, v142
  v_max3_f32 v30, v30, v143, v144
  v_max3_f32 v30, v30, v145, v146
  v_max_f32 v30, v30, v147
  v_mov_b32 v29, v30
  s_nop 1
  v_permlane32_swap_b32 v30, v29
  v_max_f32 v30, v30, v29
  v_mov_b32 v29, v30
  s_nop 1
  v_permlane16_swap_b32 v30, v29
  v_max_f32 v30, v30, v29
  v_mul_f32 v30, s41, v30
  v_fma_f32 v136, v136, s41, -v30
  v_fma_f32 v137, v137, s41, -v30
  v_fma_f32 v138, v138, s41, -v30
  v_fma_f32 v139, v139, s41, -v30
  v_fma_f32 v140, v140, s41, -v30
  v_fma_f32 v141, v141, s41, -v30
  v_fma_f32 v142, v142, s41, -v30
  v_fma_f32 v143, v143, s41, -v30
  v_fma_f32 v144, v144, s41, -v30
  v_fma_f32 v145, v145, s41, -v30
  v_fma_f32 v146, v146, s41, -v30
  v_fma_f32 v147, v147, s41, -v30
  v_exp_f32 v136, v136
  v_exp_f32 v137, v137
  v_exp_f32 v138, v138
  v_exp_f32 v139, v139
  v_exp_f32 v140, v140
  v_exp_f32 v141, v141
  v_exp_f32 v142, v142
  v_exp_f32 v143, v143
  v_exp_f32 v144, v144
  v_exp_f32 v145, v145
  v_exp_f32 v146, v146
  v_exp_f32 v147, v147
  v_cvt_pk_bf16_f32 v72, v128, v129
  v_cvt_pk_bf16_f32 v73, v130, v131
  v_cvt_pk_bf16_f32 v74, v132, v133
  v_cvt_pk_bf16_f32 v75, v134, v135
  v_cvt_pk_bf16_f32 v76, v136, v137
  v_cvt_pk_bf16_f32 v77, v138, v139
  v_cvt_pk_bf16_f32 v78, v140, v141
  v_cvt_pk_bf16_f32 v79, v142, v143
  v_cvt_pk_bf16_f32 v80, v144, v145
  v_cvt_pk_bf16_f32 v81, v146, v147
  v_mfma_f32_16x16x16_bf16 v[148:151], v[36:37], v[72:73], 0
  v_mfma_f32_16x16x16_bf16 v[152:155], v[36:37], v[76:77], 0
  v_mfma_f32_16x16x16_bf16 v[148:151], v[36:37], v[74:75], v[148:151]
  v_mfma_f32_16x16x32_bf16 v[152:155], v[36:39], v[78:81], v[152:155]
  s_nop 6
  v_rcp_f32 v82, v148
  v_rcp_f32 v83, v152
  s_and_b32 s34, s17, 1
  s_mul_i32 s34, s34, 3072
  v_add_u32 v28, s34, v1
  ds_write_b128 v28, v[72:75] offset:16384
  ds_write_b128 v28, v[76:79] offset:17408
  ds_write_b128 v28, v[80:83] offset:18432
  s_waitcnt lgkmcnt(0)
  s_branch reca_b5207
reca_tw1208:
  s_cmp_lt_u32 s17, 3
  s_cbranch_scc1 reca_b5207
  s_sub_u32 s36, s17, 3
  s_and_b32 s37, s36, 7
  s_lshl_b32 s34, s59, 3
  s_add_u32 s34, s34, s37
  s_mul_i32 s34, s34, 12288
  s_add_u32 s23, s34, 40894464
  s_lshl_b32 s35, s37, 5
  s_add_u32 s35, s35, s59
  s_mul_i32 s35, s35, 3072
  s_add_u32 s61, s35, 47972352
  s_mul_i32 s34, s36, 393216
  s_mul_i32 s35, s59, 6144
  s_add_u32 s34, s34, s35
  s_add_u32 s60, s34, 57147392
  s_add_u32 s34, s17, 1
  s_and_b32 s34, s34, 1
  s_mul_i32 s34, s34, 3072
  v_add_u32 v28, s34, v1
  ds_read_b128 v[72:75], v28 offset:16384
  ds_read_b128 v[76:79], v28 offset:17408
  ds_read_b128 v[80:83], v28 offset:18432
  buffer_load_dwordx2 a[168:169], v93, s[4:7], s61 offen offset:0 sc1
  buffer_load_dwordx4 a[120:123], v1, s[4:7], s23 offen offset:0 sc1
  buffer_load_dwordx2 a[170:171], v93, s[4:7], s61 offen offset:256 sc1
  buffer_load_dwordx4 a[124:127], v1, s[4:7], s23 offen offset:1024 sc1
  buffer_load_dwordx2 a[172:173], v93, s[4:7], s61 offen offset:512 sc1
  buffer_load_dwordx4 a[128:131], v1, s[4:7], s23 offen offset:2048 sc1
  buffer_load_dwordx2 a[174:175], v93, s[4:7], s61 offen offset:768 sc1
  buffer_load_dwordx4 a[132:135], v1, s[4:7], s23 offen offset:3072 sc1
  buffer_load_dwordx2 a[176:177], v93, s[4:7], s61 offen offset:1024 sc1
  buffer_load_dwordx4 a[136:139], v2, s[4:7], s23 offen offset:0 sc1
  buffer_load_dwordx2 a[178:179], v93, s[4:7], s61 offen offset:1280 sc1
  buffer_load_dwordx4 a[140:143], v2, s[4:7], s23 offen offset:1024 sc1
  s_waitcnt lgkmcnt(0)
  s_waitcnt vmcnt(8)
  v_mfma_f32_16x16x16_bf16 v[156:159], a[168:169], v[72:73], 0
  v_mfma_f32_16x16x16_bf16 v[160:163], a[168:169], v[76:77], 0
  v_mfma_f32_16x16x16_bf16 v[156:159], a[120:121], v[74:75], v[156:159]
  v_mfma_f32_16x16x32_bf16 v[160:163], a[120:123], v[78:81], v[160:163]
  v_mfma_f32_16x16x16_bf16 v[164:167], a[170:171], v[72:73], 0
  v_mfma_f32_16x16x16_bf16 v[168:171], a[170:171], v[76:77], 0
  v_mfma_f32_16x16x16_bf16 v[164:167], a[124:125], v[74:75], v[164:167]
  v_mfma_f32_16x16x32_bf16 v[168:171], a[124:127], v[78:81], v[168:171]
  s_nop 2
  v_mul_f32 v156, v156, v82
  v_mul_f32 v157, v157, v82
  v_mul_f32 v158, v158, v82
  v_mul_f32 v159, v159, v82
  v_cvt_pk_bf16_f32 v172, v156, v157
  v_cvt_pk_bf16_f32 v173, v158, v159
  v_mul_f32 v164, v164, v82
  v_mul_f32 v165, v165, v82
  v_mul_f32 v166, v166, v82
  v_mul_f32 v167, v167, v82
  v_cvt_pk_bf16_f32 v174, v164, v165
  v_cvt_pk_bf16_f32 v175, v166, v167
  buffer_store_dwordx4 v[172:175], v1, s[4:7], s60 offen offset:0 sc1
  v_mul_f32 v160, v160, v83
  v_mul_f32 v161, v161, v83
  v_mul_f32 v162, v162, v83
  v_mul_f32 v163, v163, v83
  v_cvt_pk_bf16_f32 v176, v160, v161
  v_cvt_pk_bf16_f32 v177, v162, v163
  v_mul_f32 v168, v168, v83
  v_mul_f32 v169, v169, v83
  v_mul_f32 v170, v170, v83
  v_mul_f32 v171, v171, v83
  v_cvt_pk_bf16_f32 v178, v168, v169
  v_cvt_pk_bf16_f32 v179, v170, v171
  s_add_u32 s34, s60, 196608
  buffer_store_dwordx4 v[176:179], v1, s[4:7], s34 offen offset:0 sc1
  s_waitcnt vmcnt(6)
  v_mfma_f32_16x16x16_bf16 v[156:159], a[172:173], v[72:73], 0
  v_mfma_f32_16x16x16_bf16 v[160:163], a[172:173], v[76:77], 0
  v_mfma_f32_16x16x16_bf16 v[156:159], a[128:129], v[74:75], v[156:159]
  v_mfma_f32_16x16x32_bf16 v[160:163], a[128:131], v[78:81], v[160:163]
  v_mfma_f32_16x16x16_bf16 v[164:167], a[174:175], v[72:73], 0
  v_mfma_f32_16x16x16_bf16 v[168:171], a[174:175], v[76:77], 0
  v_mfma_f32_16x16x16_bf16 v[164:167], a[132:133], v[74:75], v[164:167]
  v_mfma_f32_16x16x32_bf16 v[168:171], a[132:135], v[78:81], v[168:171]
  s_nop 2
  v_mul_f32 v156, v156, v82
  v_mul_f32 v157, v157, v82
  v_mul_f32 v158, v158, v82
  v_mul_f32 v159, v159, v82
  v_cvt_pk_bf16_f32 v172, v156, v157
  v_cvt_pk_bf16_f32 v173, v158, v159
  v_mul_f32 v164, v164, v82
  v_mul_f32 v165, v165, v82
  v_mul_f32 v166, v166, v82
  v_mul_f32 v167, v167, v82
  v_cvt_pk_bf16_f32 v174, v164, v165
  v_cvt_pk_bf16_f32 v175, v166, v167
  buffer_store_dwordx4 v[172:175], v1, s[4:7], s60 offen offset:1024 sc1
  v_mul_f32 v160, v160, v83
  v_mul_f32 v161, v161, v83
  v_mul_f32 v162, v162, v83
  v_mul_f32 v163, v163, v83
  v_cvt_pk_bf16_f32 v176, v160, v161
  v_cvt_pk_bf16_f32 v177, v162, v163
  v_mul_f32 v168, v168, v83
  v_mul_f32 v169, v169, v83
  v_mul_f32 v170, v170, v83
  v_mul_f32 v171, v171, v83
  v_cvt_pk_bf16_f32 v178, v168, v169
  v_cvt_pk_bf16_f32 v179, v170, v171
  s_add_u32 s34, s60, 196608
  buffer_store_dwordx4 v[176:179], v1, s[4:7], s34 offen offset:1024 sc1
  s_waitcnt vmcnt(4)
  v_mfma_f32_16x16x16_bf16 v[156:159], a[176:177], v[72:73], 0
  v_mfma_f32_16x16x16_bf16 v[160:163], a[176:177], v[76:77], 0
  v_mfma_f32_16x16x16_bf16 v[156:159], a[136:137], v[74:75], v[156:159]
  v_mfma_f32_16x16x32_bf16 v[160:163], a[136:139], v[78:81], v[160:163]
  v_mfma_f32_16x16x16_bf16 v[164:167], a[178:179], v[72:73], 0
  v_mfma_f32_16x16x16_bf16 v[168:171], a[178:179], v[76:77], 0
  v_mfma_f32_16x16x16_bf16 v[164:167], a[140:141], v[74:75], v[164:167]
  v_mfma_f32_16x16x32_bf16 v[168:171], a[140:143], v[78:81], v[168:171]
  s_nop 2
  v_mul_f32 v156, v156, v82
  v_mul_f32 v157, v157, v82
  v_mul_f32 v158, v158, v82
  v_mul_f32 v159, v159, v82
  v_cvt_pk_bf16_f32 v172, v156, v157
  v_cvt_pk_bf16_f32 v173, v158, v159
  v_mul_f32 v164, v164, v82
  v_mul_f32 v165, v165, v82
  v_mul_f32 v166, v166, v82
  v_mul_f32 v167, v167, v82
  v_cvt_pk_bf16_f32 v174, v164, v165
  v_cvt_pk_bf16_f32 v175, v166, v167
  buffer_store_dwordx4 v[172:175], v1, s[4:7], s60 offen offset:2048 sc1
  v_mul_f32 v160, v160, v83
  v_mul_f32 v161, v161, v83
  v_mul_f32 v162, v162, v83
  v_mul_f32 v163, v163, v83
  v_cvt_pk_bf16_f32 v176, v160, v161
  v_cvt_pk_bf16_f32 v177, v162, v163
  v_mul_f32 v168, v168, v83
  v_mul_f32 v169, v169, v83
  v_mul_f32 v170, v170, v83
  v_mul_f32 v171, v171, v83
  v_cvt_pk_bf16_f32 v178, v168, v169
  v_cvt_pk_bf16_f32 v179, v170, v171
  s_add_u32 s34, s60, 196608
  buffer_store_dwordx4 v[176:179], v1, s[4:7], s34 offen offset:2048 sc1
  s_branch reca_b5207
reca_tw2209:
  s_cmp_lt_u32 s17, 3
  s_cbranch_scc1 reca_b5207
  s_sub_u32 s36, s17, 3
  s_and_b32 s37, s36, 7
  s_lshl_b32 s34, s59, 3
  s_add_u32 s34, s34, s37
  s_mul_i32 s34, s34, 12288
  s_add_u32 s23, s34, 40894464
  s_lshl_b32 s35, s37, 5
  s_add_u32 s35, s35, s59
  s_mul_i32 s35, s35, 3072
  s_add_u32 s61, s35, 47972352
  s_mul_i32 s34, s36, 393216
  s_mul_i32 s35, s59, 6144
  s_add_u32 s34, s34, s35
  s_add_u32 s60, s34, 57147392
  s_add_u32 s34, s17, 1
  s_and_b32 s34, s34, 1
  s_mul_i32 s34, s34, 3072
  v_add_u32 v28, s34, v1
  ds_read_b128 v[72:75], v28 offset:16384
  ds_read_b128 v[76:79], v28 offset:17408
  ds_read_b128 v[80:83], v28 offset:18432
  buffer_load_dwordx2 a[180:181], v93, s[4:7], s61 offen offset:1536 sc1
  buffer_load_dwordx4 a[144:147], v2, s[4:7], s23 offen offset:2048 sc1
  buffer_load_dwordx2 a[182:183], v93, s[4:7], s61 offen offset:1792 sc1
  buffer_load_dwordx4 a[148:151], v2, s[4:7], s23 offen offset:3072 sc1
  buffer_load_dwordx2 a[184:185], v93, s[4:7], s61 offen offset:2048 sc1
  buffer_load_dwordx4 a[152:155], v3, s[4:7], s23 offen offset:0 sc1
  buffer_load_dwordx2 a[186:187], v93, s[4:7], s61 offen offset:2304 sc1
  buffer_load_dwordx4 a[156:159], v3, s[4:7], s23 offen offset:1024 sc1
  buffer_load_dwordx2 a[188:189], v93, s[4:7], s61 offen offset:2560 sc1
  buffer_load_dwordx4 a[160:163], v3, s[4:7], s23 offen offset:2048 sc1
  buffer_load_dwordx2 a[190:191], v93, s[4:7], s61 offen offset:2816 sc1
  buffer_load_dwordx4 a[164:167], v3, s[4:7], s23 offen offset:3072 sc1
  s_waitcnt lgkmcnt(0)
  s_waitcnt vmcnt(8)
  v_mfma_f32_16x16x16_bf16 v[156:159], a[180:181], v[72:73], 0
  v_mfma_f32_16x16x16_bf16 v[160:163], a[180:181], v[76:77], 0
  v_mfma_f32_16x16x16_bf16 v[156:159], a[144:145], v[74:75], v[156:159]
  v_mfma_f32_16x16x32_bf16 v[160:163], a[144:147], v[78:81], v[160:163]
  v_mfma_f32_16x16x16_bf16 v[164:167], a[182:183], v[72:73], 0
  v_mfma_f32_16x16x16_bf16 v[168:171], a[182:183], v[76:77], 0
  v_mfma_f32_16x16x16_bf16 v[164:167], a[148:149], v[74:75], v[164:167]
  v_mfma_f32_16x16x32_bf16 v[168:171], a[148:151], v[78:81], v[168:171]
  s_nop 2
  v_mul_f32 v156, v156, v82
  v_mul_f32 v157, v157, v82
  v_mul_f32 v158, v158, v82
  v_mul_f32 v159, v159, v82
  v_cvt_pk_bf16_f32 v172, v156, v157
  v_cvt_pk_bf16_f32 v173, v158, v159
  v_mul_f32 v164, v164, v82
  v_mul_f32 v165, v165, v82
  v_mul_f32 v166, v166, v82
  v_mul_f32 v167, v167, v82
  v_cvt_pk_bf16_f32 v174, v164, v165
  v_cvt_pk_bf16_f32 v175, v166, v167
  buffer_store_dwordx4 v[172:175], v1, s[4:7], s60 offen offset:3072 sc1
  v_mul_f32 v160, v160, v83
  v_mul_f32 v161, v161, v83
  v_mul_f32 v162, v162, v83
  v_mul_f32 v163, v163, v83
  v_cvt_pk_bf16_f32 v176, v160, v161
  v_cvt_pk_bf16_f32 v177, v162, v163
  v_mul_f32 v168, v168, v83
  v_mul_f32 v169, v169, v83
  v_mul_f32 v170, v170, v83
  v_mul_f32 v171, v171, v83
  v_cvt_pk_bf16_f32 v178, v168, v169
  v_cvt_pk_bf16_f32 v179, v170, v171
  s_add_u32 s34, s60, 196608
  buffer_store_dwordx4 v[176:179], v1, s[4:7], s34 offen offset:3072 sc1
  s_waitcnt vmcnt(6)
  v_mfma_f32_16x16x16_bf16 v[156:159], a[184:185], v[72:73], 0
  v_mfma_f32_16x16x16_bf16 v[160:163], a[184:185], v[76:77], 0
  v_mfma_f32_16x16x16_bf16 v[156:159], a[152:153], v[74:75], v[156:159]
  v_mfma_f32_16x16x32_bf16 v[160:163], a[152:155], v[78:81], v[160:163]
  v_mfma_f32_16x16x16_bf16 v[164:167], a[186:187], v[72:73], 0
  v_mfma_f32_16x16x16_bf16 v[168:171], a[186:187], v[76:77], 0
  v_mfma_f32_16x16x16_bf16 v[164:167], a[156:157], v[74:75], v[164:167]
  v_mfma_f32_16x16x32_bf16 v[168:171], a[156:159], v[78:81], v[168:171]
  s_nop 2
  v_mul_f32 v156, v156, v82
  v_mul_f32 v157, v157, v82
  v_mul_f32 v158, v158, v82
  v_mul_f32 v159, v159, v82
  v_cvt_pk_bf16_f32 v172, v156, v157
  v_cvt_pk_bf16_f32 v173, v158, v159
  v_mul_f32 v164, v164, v82
  v_mul_f32 v165, v165, v82
  v_mul_f32 v166, v166, v82
  v_mul_f32 v167, v167, v82
  v_cvt_pk_bf16_f32 v174, v164, v165
  v_cvt_pk_bf16_f32 v175, v166, v167
  buffer_store_dwordx4 v[172:175], v2, s[4:7], s60 offen offset:0 sc1
  v_mul_f32 v160, v160, v83
  v_mul_f32 v161, v161, v83
  v_mul_f32 v162, v162, v83
  v_mul_f32 v163, v163, v83
  v_cvt_pk_bf16_f32 v176, v160, v161
  v_cvt_pk_bf16_f32 v177, v162, v163
  v_mul_f32 v168, v168, v83
  v_mul_f32 v169, v169, v83
  v_mul_f32 v170, v170, v83
  v_mul_f32 v171, v171, v83
  v_cvt_pk_bf16_f32 v178, v168, v169
  v_cvt_pk_bf16_f32 v179, v170, v171
  s_add_u32 s34, s60, 196608
  buffer_store_dwordx4 v[176:179], v2, s[4:7], s34 offen offset:0 sc1
  s_waitcnt vmcnt(4)
  v_mfma_f32_16x16x16_bf16 v[156:159], a[188:189], v[72:73], 0
  v_mfma_f32_16x16x16_bf16 v[160:163], a[188:189], v[76:77], 0
  v_mfma_f32_16x16x16_bf16 v[156:159], a[160:161], v[74:75], v[156:159]
  v_mfma_f32_16x16x32_bf16 v[160:163], a[160:163], v[78:81], v[160:163]
  v_mfma_f32_16x16x16_bf16 v[164:167], a[190:191], v[72:73], 0
  v_mfma_f32_16x16x16_bf16 v[168:171], a[190:191], v[76:77], 0
  v_mfma_f32_16x16x16_bf16 v[164:167], a[164:165], v[74:75], v[164:167]
  v_mfma_f32_16x16x32_bf16 v[168:171], a[164:167], v[78:81], v[168:171]
  s_nop 2
  v_mul_f32 v156, v156, v82
  v_mul_f32 v157, v157, v82
  v_mul_f32 v158, v158, v82
  v_mul_f32 v159, v159, v82
  v_cvt_pk_bf16_f32 v172, v156, v157
  v_cvt_pk_bf16_f32 v173, v158, v159
  v_mul_f32 v164, v164, v82
  v_mul_f32 v165, v165, v82
  v_mul_f32 v166, v166, v82
  v_mul_f32 v167, v167, v82
  v_cvt_pk_bf16_f32 v174, v164, v165
  v_cvt_pk_bf16_f32 v175, v166, v167
  buffer_store_dwordx4 v[172:175], v2, s[4:7], s60 offen offset:1024 sc1
  v_mul_f32 v160, v160, v83
  v_mul_f32 v161, v161, v83
  v_mul_f32 v162, v162, v83
  v_mul_f32 v163, v163, v83
  v_cvt_pk_bf16_f32 v176, v160, v161
  v_cvt_pk_bf16_f32 v177, v162, v163
  v_mul_f32 v168, v168, v83
  v_mul_f32 v169, v169, v83
  v_mul_f32 v170, v170, v83
  v_mul_f32 v171, v171, v83
  v_cvt_pk_bf16_f32 v178, v168, v169
  v_cvt_pk_bf16_f32 v179, v170, v171
  s_add_u32 s34, s60, 196608
  buffer_store_dwordx4 v[176:179], v2, s[4:7], s34 offen offset:1024 sc1
  s_branch reca_b5207
  s_cmp_lg_u32 s12, 2
  s_cbranch_scc1 reca_b3205
  buffer_store_dwordx2 v[52:53], v9, s[4:7], s30 offen sc1
  buffer_store_dwordx2 v[32:33], v16, s[4:7], s26 offen sc1
  s_cmp_lg_u32 s14, 0
  s_cbranch_scc1 reca_b3205
  v_mov_b32 v28, s17
  s_lshl_b32 s34, s13, 7
  s_add_u32 s34, s34, 1507328
  buffer_store_dword v28, v19, s[4:7], s34 offen sc1
  s_branch reca_b3205
reca_last204:
  s_cmp_lg_u32 s12, 2
  s_cbranch_scc1 reca_exit1
  buffer_store_dwordx2 v[52:53], v9, s[4:7], s30 offen
  s_branch reca_exit1
reca_swave202:
  s_cmp_lg_u32 s17, 63
  s_cbranch_scc1 reca_vmst210
  s_barrier
  ds_read_b128 v[56:59], v1 offset:10240
  ds_read_b128 v[60:63], v1 offset:11264
  ds_read_b128 v[64:67], v1 offset:12288
  s_waitcnt lgkmcnt(0)
  v_add_f32 v56, v56, v64
  v_add_f32 v60, v60, v48
  v_add_f32 v57, v57, v65
  v_add_f32 v61, v61, v49
  v_add_f32 v58, v58, v66
  v_add_f32 v62, v62, v50
  v_add_f32 v59, v59, v67
  v_add_f32 v63, v63, v51
  v_cvt_pk_bf16_f32 v68, v56, v57
  v_cvt_pk_bf16_f32 v69, v58, v59
  v_cvt_pk_bf16_f32 v70, v60, v61
  v_cvt_pk_bf16_f32 v71, v62, v63
  buffer_store_dwordx2 v[52:53], v9, s[4:7], s30 offen
  buffer_store_dwordx2 v[68:69], v10, s[4:7], s31 offen
  buffer_store_dwordx2 v[70:71], v10, s[4:7], s31 offen offset:256
  s_branch reca_exit1
reca_vmst210:
  s_sleep 1
  buffer_load_dwordx4 v[208:211], v1, s[4:7], s21 offen offset:0 sc1
  buffer_load_dwordx4 v[212:215], v1, s[4:7], s21 offen offset:1024 sc1
  buffer_load_dwordx4 v[216:219], v1, s[4:7], s21 offen offset:2048 sc1
  buffer_load_dwordx4 v[220:223], v1, s[4:7], s21 offen offset:3072 sc1
  buffer_load_dwordx4 v[224:227], v2, s[4:7], s21 offen offset:0 sc1
  buffer_load_dwordx4 v[228:231], v2, s[4:7], s21 offen offset:1024 sc1
  s_waitcnt vmcnt(5)
  v_max_u32 v29, v208, v210
  v_cmp_eq_u32 vcc, -1, v29
  s_cbranch_vccnz reca_retry211
reca_resume212:
  s_waitcnt vmcnt(4)
  v_max_u32 v29, v212, v214
  v_cmp_eq_u32 vcc, -1, v29
  v_mfma_f32_16x16x32_bf16 v[76:79], a[120:123], v[208:211], 0
  v_mfma_f32_16x16x32_bf16 v[80:83], a[144:147], v[208:211], 0
  v_mfma_f32_16x16x32_bf16 v[72:75], v[208:211], v[208:211], v[40:43]
  s_cbranch_vccnz reca_retry213
reca_resume214:
  s_waitcnt vmcnt(3)
  v_max_u32 v29, v216, v218
  v_cmp_eq_u32 vcc, -1, v29
  v_mfma_f32_16x16x32_bf16 v[76:79], a[124:127], v[212:215], v[76:79]
  v_mfma_f32_16x16x32_bf16 v[80:83], a[148:151], v[212:215], v[80:83]
  v_mfma_f32_16x16x32_bf16 v[72:75], v[212:215], v[212:215], v[72:75]
  s_cbranch_vccnz reca_retry215
reca_resume216:
  s_waitcnt vmcnt(2)
  v_max_u32 v29, v220, v222
  v_cmp_eq_u32 vcc, -1, v29
  v_mfma_f32_16x16x32_bf16 v[76:79], a[128:131], v[216:219], v[76:79]
  v_mfma_f32_16x16x32_bf16 v[80:83], a[152:155], v[216:219], v[80:83]
  v_mfma_f32_16x16x32_bf16 v[72:75], v[216:219], v[216:219], v[72:75]
  s_cbranch_vccnz reca_retry217
reca_resume218:
  s_waitcnt vmcnt(1)
  v_max_u32 v29, v224, v226
  v_cmp_eq_u32 vcc, -1, v29
  v_mfma_f32_16x16x32_bf16 v[76:79], a[132:135], v[220:223], v[76:79]
  v_mfma_f32_16x16x32_bf16 v[80:83], a[156:159], v[220:223], v[80:83]
  v_mfma_f32_16x16x32_bf16 v[72:75], v[220:223], v[220:223], v[72:75]
  s_cbranch_vccnz reca_retry219
reca_resume220:
  s_waitcnt vmcnt(0)
  v_max_u32 v29, v228, v230
  v_cmp_eq_u32 vcc, -1, v29
  v_mfma_f32_16x16x32_bf16 v[76:79], a[136:139], v[224:227], v[76:79]
  v_mfma_f32_16x16x32_bf16 v[80:83], a[160:163], v[224:227], v[80:83]
  v_mfma_f32_16x16x32_bf16 v[72:75], v[224:227], v[224:227], v[72:75]
  s_cbranch_vccnz reca_retry221
reca_resume222:
  v_mfma_f32_16x16x32_bf16 v[76:79], a[140:143], v[228:231], v[76:79]
  v_mfma_f32_16x16x32_bf16 v[80:83], a[164:167], v[228:231], v[80:83]
  v_mfma_f32_16x16x32_bf16 v[72:75], v[228:231], v[228:231], v[72:75]
  s_barrier
  ds_read_b128 v[56:59], v1 offset:10240
  ds_read_b128 v[60:63], v1 offset:11264
  ds_read_b128 v[64:67], v1 offset:12288
  s_nop 1
  v_max3_f32 v28, v76, v77, v78
  v_max3_f32 v29, v80, v81, v82
  v_max3_f32 v28, v28, v79, v83
  v_max3_f32 v29, v29, v72, v73
  v_max3_f32 v28, v28, v74, v75
  v_max_f32 v28, v28, v29
  v_mov_b32 v29, v28
  s_nop 1
  v_permlane32_swap_b32 v28, v29
  v_max_f32 v28, v28, v29
  v_mov_b32 v29, v28
  s_nop 1
  v_permlane16_swap_b32 v28, v29
  v_max_f32 v28, v28, v29
  v_mul_f32 v28, s41, v28
  v_fma_f32 v76, v76, s41, -v28
  v_fma_f32 v77, v77, s41, -v28
  v_fma_f32 v78, v78, s41, -v28
  v_fma_f32 v79, v79, s41, -v28
  v_fma_f32 v80, v80, s41, -v28
  v_fma_f32 v81, v81, s41, -v28
  v_fma_f32 v82, v82, s41, -v28
  v_fma_f32 v83, v83, s41, -v28
  v_fma_f32 v72, v72, s41, -v28
  v_fma_f32 v73, v73, s41, -v28
  v_fma_f32 v74, v74, s41, -v28
  v_fma_f32 v75, v75, s41, -v28
  v_exp_f32 v76, v76
  v_exp_f32 v77, v77
  v_exp_f32 v78, v78
  v_exp_f32 v79, v79
  v_exp_f32 v80, v80
  v_exp_f32 v81, v81
  v_exp_f32 v82, v82
  v_exp_f32 v83, v83
  v_cvt_pk_bf16_f32 v84, v76, v77
  v_cvt_pk_bf16_f32 v85, v78, v79
  v_cvt_pk_bf16_f32 v86, v80, v81
  v_cvt_pk_bf16_f32 v87, v82, v83
  v_exp_f32 v72, v72
  v_exp_f32 v73, v73
  v_mfma_f32_16x16x32_bf16 v[100:103], v[36:39], v[84:87], 0
  v_exp_f32 v74, v74
  v_exp_f32 v75, v75
  v_mfma_f32_16x16x32_bf16 v[92:95], a[168:171], v[84:87], 0
  v_cvt_pk_bf16_f32 v88, v72, v73
  v_cvt_pk_bf16_f32 v89, v74, v75
  v_mfma_f32_16x16x32_bf16 v[96:99], a[172:175], v[84:87], 0
  s_waitcnt lgkmcnt(0)
  v_mfma_f32_16x16x16_bf16 v[100:103], v[36:37], v[88:89], v[100:103]
  v_add_f32 v56, v56, v64
  v_add_f32 v60, v60, v48
  v_add_f32 v57, v57, v65
  v_add_f32 v61, v61, v49
  v_add_f32 v58, v58, v66
  v_add_f32 v62, v62, v50
  v_add_f32 v59, v59, v67
  v_add_f32 v63, v63, v51
  v_cvt_pk_bf16_f32 v68, v56, v57
  v_cvt_pk_bf16_f32 v69, v58, v59
  v_cvt_pk_bf16_f32 v70, v60, v61
  v_cvt_pk_bf16_f32 v71, v62, v63
  v_mfma_f32_16x16x16_bf16 v[92:95], v[68:69], v[88:89], v[92:95]
  v_rcp_f32 v28, v100
  v_mfma_f32_16x16x16_bf16 v[96:99], v[70:71], v[88:89], v[96:99]
  v_mov_b32 v29, v28
  s_nop 4
  v_pk_mul_f32 v[92:93], v[92:93], v[28:29]
  v_pk_mul_f32 v[94:95], v[94:95], v[28:29]
  v_pk_mul_f32 v[96:97], v[96:97], v[28:29]
  v_pk_mul_f32 v[98:99], v[98:99], v[28:29]
  v_cvt_pk_bf16_f32 v104, v92, v93
  v_cvt_pk_bf16_f32 v105, v94, v95
  v_cvt_pk_bf16_f32 v106, v96, v97
  v_cvt_pk_bf16_f32 v107, v98, v99
  buffer_store_dwordx4 v[104:107], v11, s[4:7], s22 offen sc1
  s_barrier
  s_add_u32 s34, s17, 2
  s_and_b32 s34, s34, 3
  s_mul_i32 s26, s34, 10240
  s_add_u32 s26, s26, s38
  s_mul_i32 s27, s34, 6144
  s_add_u32 s27, s27, s39
  s_mul_i32 s28, s34, 12288
  s_add_u32 s28, s28, s40
  s_mul_i32 s29, s34, 393216
  s_add_u32 s29, s29, s56
  buffer_store_dwordx2 v[32:33], v8, s[4:7], s27 offen sc1
  buffer_store_dwordx4 v[32:35], v11, s[4:7], s28 offen sc1
  s_add_u32 s36, s17, 1
  s_cmp_ge_u32 s36, 63
  s_cbranch_scc1 reca_nopf223
  s_add_u32 s37, s36, 1
reca_pf224:
  buffer_load_dword v28, v233, s[4:7], 0 offen sc1
  s_waitcnt vmcnt(0)
  v_cmp_gt_i32 vcc, s37, v28
  s_cbranch_vccz reca_pfok225
  s_sleep 1
  s_sub_u32 s18, s18, 1
  s_cbranch_scc0 reca_pf224
  s_mov_b32 s18, 0
reca_pfok225:
  s_lshl_b32 s34, s15, 3
  s_and_b32 s35, s36, 7
  s_add_u32 s34, s34, s35
  s_mul_i32 s34, s34, 12288
  s_add_u32 s32, s34, 37748736
  s_lshl_b32 s35, s16, 11
  s_add_u32 s34, s34, s35
  s_add_u32 s33, s34, 40894464
  buffer_load_dwordx4 a[120:123], v1, s[4:7], s32 offen offset:0 sc1
  buffer_load_dwordx4 a[124:127], v1, s[4:7], s32 offen offset:1024 sc1
  buffer_load_dwordx4 a[128:131], v1, s[4:7], s32 offen offset:2048 sc1
  buffer_load_dwordx4 a[132:135], v1, s[4:7], s32 offen offset:3072 sc1
  buffer_load_dwordx4 a[136:139], v2, s[4:7], s32 offen offset:0 sc1
  buffer_load_dwordx4 a[140:143], v2, s[4:7], s32 offen offset:1024 sc1
  buffer_load_dwordx4 a[144:147], v2, s[4:7], s32 offen offset:2048 sc1
  buffer_load_dwordx4 a[148:151], v2, s[4:7], s32 offen offset:3072 sc1
  buffer_load_dwordx4 a[152:155], v3, s[4:7], s32 offen offset:0 sc1
  buffer_load_dwordx4 a[156:159], v3, s[4:7], s32 offen offset:1024 sc1
  buffer_load_dwordx4 a[160:163], v3, s[4:7], s32 offen offset:2048 sc1
  buffer_load_dwordx4 a[164:167], v3, s[4:7], s32 offen offset:3072 sc1
  buffer_load_dwordx4 a[168:171], v1, s[4:7], s33 offen offset:0 sc1
  buffer_load_dwordx4 a[172:175], v1, s[4:7], s33 offen offset:1024 sc1
reca_nopf223:
  buffer_store_dwordx2 v[52:53], v9, s[4:7], s30 offen sc1
  buffer_store_dwordx2 v[68:69], v10, s[4:7], s31 offen sc1
  buffer_store_dwordx2 v[70:71], v10, s[4:7], s31 offen offset:256 sc1
reca_b5207:
  s_barrier
  s_add_u32 s17, s17, 1
  s_branch reca_step193
reca_b3205:
  s_endpgm
reca_retry196:
  s_sub_u32 s18, s18, 1
  s_cbranch_scc1 reca_retry196_to
  buffer_load_dwordx4 v[128:131], v4, s[4:7], s20 offen sc1
  buffer_load_dwordx4 v[132:135], v4, s[4:7], s20 offen offset:1024 sc1
  buffer_load_dwordx4 v[136:139], v5, s[4:7], s20 offen sc1
  s_waitcnt vmcnt(2)
  v_max_u32 v29, v128, v130
  v_cmp_eq_u32 vcc, -1, v29
  s_cbranch_vccnz reca_retry196
  s_branch reca_resume197
reca_retry196_to:
  s_mov_b32 s18, 0
  s_waitcnt vmcnt(0)
  s_branch reca_resume197
reca_retry198:
  s_sub_u32 s18, s18, 1
  s_cbranch_scc1 reca_retry198_to
  buffer_load_dwordx4 v[132:135], v4, s[4:7], s20 offen offset:1024 sc1
  buffer_load_dwordx4 v[136:139], v5, s[4:7], s20 offen sc1
  s_waitcnt vmcnt(1)
  v_max_u32 v29, v132, v134
  v_cmp_eq_u32 vcc, -1, v29
  s_cbranch_vccnz reca_retry198
  s_branch reca_resume199
reca_retry198_to:
  s_mov_b32 s18, 0
  s_waitcnt vmcnt(0)
  s_branch reca_resume199
reca_retry200:
  s_sub_u32 s18, s18, 1
  s_cbranch_scc1 reca_retry200_to
  buffer_load_dwordx4 v[136:139], v5, s[4:7], s20 offen sc1
  s_waitcnt vmcnt(0)
  v_max_u32 v29, v136, v138
  v_cmp_eq_u32 vcc, -1, v29
  s_cbranch_vccnz reca_retry200
  s_branch reca_resume201
reca_retry200_to:
  s_mov_b32 s18, 0
  s_waitcnt vmcnt(0)
  s_branch reca_resume201
reca_retry211:
  s_sub_u32 s18, s18, 1
  s_cbranch_scc1 reca_retry211_to
  buffer_load_dwordx4 v[208:211], v1, s[4:7], s21 offen offset:0 sc1
  buffer_load_dwordx4 v[212:215], v1, s[4:7], s21 offen offset:1024 sc1
  buffer_load_dwordx4 v[216:219], v1, s[4:7], s21 offen offset:2048 sc1
  buffer_load_dwordx4 v[220:223], v1, s[4:7], s21 offen offset:3072 sc1
  buffer_load_dwordx4 v[224:227], v2, s[4:7], s21 offen offset:0 sc1
  buffer_load_dwordx4 v[228:231], v2, s[4:7], s21 offen offset:1024 sc1
  s_waitcnt vmcnt(5)
  v_max_u32 v29, v208, v210
  v_cmp_eq_u32 vcc, -1, v29
  s_cbranch_vccnz reca_retry211
  s_branch reca_resume212
reca_retry211_to:
  s_mov_b32 s18, 0
  s_waitcnt vmcnt(0)
  s_branch reca_resume212
reca_retry213:
  s_sub_u32 s18, s18, 1
  s_cbranch_scc1 reca_retry213_to
  buffer_load_dwordx4 v[212:215], v1, s[4:7], s21 offen offset:1024 sc1
  buffer_load_dwordx4 v[216:219], v1, s[4:7], s21 offen offset:2048 sc1
  buffer_load_dwordx4 v[220:223], v1, s[4:7], s21 offen offset:3072 sc1
  buffer_load_dwordx4 v[224:227], v2, s[4:7], s21 offen offset:0 sc1
  buffer_load_dwordx4 v[228:231], v2, s[4:7], s21 offen offset:1024 sc1
  s_waitcnt vmcnt(4)
  v_max_u32 v29, v212, v214
  v_cmp_eq_u32 vcc, -1, v29
  s_cbranch_vccnz reca_retry213
  s_branch reca_resume214
reca_retry213_to:
  s_mov_b32 s18, 0
  s_waitcnt vmcnt(0)
  s_branch reca_resume214
reca_retry215:
  s_sub_u32 s18, s18, 1
  s_cbranch_scc1 reca_retry215_to
  buffer_load_dwordx4 v[216:219], v1, s[4:7], s21 offen offset:2048 sc1
  buffer_load_dwordx4 v[220:223], v1, s[4:7], s21 offen offset:3072 sc1
  buffer_load_dwordx4 v[224:227], v2, s[4:7], s21 offen offset:0 sc1
  buffer_load_dwordx4 v[228:231], v2, s[4:7], s21 offen offset:1024 sc1
  s_waitcnt vmcnt(3)
  v_max_u32 v29, v216, v218
  v_cmp_eq_u32 vcc, -1, v29
  s_cbranch_vccnz reca_retry215
  s_branch reca_resume216
reca_retry215_to:
  s_mov_b32 s18, 0
  s_waitcnt vmcnt(0)
  s_branch reca_resume216
reca_retry217:
  s_sub_u32 s18, s18, 1
  s_cbranch_scc1 reca_retry217_to
  buffer_load_dwordx4 v[220:223], v1, s[4:7], s21 offen offset:3072 sc1
  buffer_load_dwordx4 v[224:227], v2, s[4:7], s21 offen offset:0 sc1
  buffer_load_dwordx4 v[228:231], v2, s[4:7], s21 offen offset:1024 sc1
  s_waitcnt vmcnt(2)
  v_max_u32 v29, v220, v222
  v_cmp_eq_u32 vcc, -1, v29
  s_cbranch_vccnz reca_retry217
  s_branch reca_resume218
reca_retry217_to:
  s_mov_b32 s18, 0
  s_waitcnt vmcnt(0)
  s_branch reca_resume218
reca_retry219:
  s_sub_u32 s18, s18, 1
  s_cbranch_scc1 reca_retry219_to
  buffer_load_dwordx4 v[224:227], v2, s[4:7], s21 offen offset:0 sc1
  buffer_load_dwordx4 v[228:231], v2, s[4:7], s21 offen offset:1024 sc1
  s_waitcnt vmcnt(1)
  v_max_u32 v29, v224, v226
  v_cmp_eq_u32 vcc, -1, v29
  s_cbranch_vccnz reca_retry219
  s_branch reca_resume220
reca_retry219_to:
  s_mov_b32 s18, 0
  s_waitcnt vmcnt(0)
  s_branch reca_resume220
reca_retry221:
  s_sub_u32 s18, s18, 1
  s_cbranch_scc1 reca_retry221_to
  buffer_load_dwordx4 v[228:231], v2, s[4:7], s21 offen offset:1024 sc1
  s_waitcnt vmcnt(0)
  v_max_u32 v29, v228, v230
  v_cmp_eq_u32 vcc, -1, v29
  s_cbranch_vccnz reca_retry221
  s_branch reca_resume222
reca_retry221_to:
  s_mov_b32 s18, 0
  s_waitcnt vmcnt(0)
  s_branch reca_resume222
reca_proj2:
  s_sub_u32 s34, s14, 24
  s_lshr_b32 s35, s34, 1
  s_and_b32 s16, s34, 1
  s_lshl_b32 s15, s13, 2
  s_add_u32 s15, s15, s35
  s_lshl_b32 s24, s13, 3
  s_add_u32 s24, s24, s34
  s_lshl_b32 s24, s24, 7
  s_add_u32 s24, s24, 1540096
  s_lshl_b32 s25, s13, 7
  s_add_u32 s25, s25, 1507328
  v_and_b32 v28, 63, v0
  v_lshlrev_b32 v1, 4, v28
  v_mov_b32 v29, 0x80000000
  v_cmp_eq_u32 vcc, 0, v28
  v_mov_b32 v4, 0
  s_nop 0
  v_cndmask_b32 v4, v29, v4, vcc
  v_cmp_gt_u32 vcc, 32, v28
  s_nop 1
  v_cndmask_b32 v5, v29, v1, vcc
  s_cmp_eq_u32 s12, 0
  s_cbranch_scc1 reca_pw0_226
  s_cmp_eq_u32 s12, 1
  s_cbranch_scc1 reca_pw1_227
  s_cmp_eq_u32 s12, 2
  s_cbranch_scc1 reca_pw2_228
  s_branch reca_pw3_229
reca_pw0_226:
  s_mov_b32 s17, 0
  s_mov_b32 s26, 0
  s_mul_i32 s20, s17, 40960
  s_add_u32 s20, s20, 84934656
  s_add_u32 m0, s26, 0
  s_nop 0
  buffer_load_dwordx4 v1, s[4:7], s20 offen offset:0 lds
  buffer_load_dwordx4 v1, s[4:7], s20 offen offset:1024 lds
  buffer_load_dwordx4 v1, s[4:7], s20 offen offset:2048 lds
  buffer_load_dwordx4 v1, s[4:7], s20 offen offset:3072 lds
  s_add_u32 s20, s20, 4096
  s_add_u32 m0, s26, 4096
  s_nop 0
  buffer_load_dwordx4 v1, s[4:7], s20 offen offset:0 lds
  buffer_load_dwordx4 v1, s[4:7], s20 offen offset:1024 lds
  buffer_load_dwordx4 v1, s[4:7], s20 offen offset:2048 lds
  buffer_load_dwordx4 v1, s[4:7], s20 offen offset:3072 lds
  s_add_u32 s20, s20, 4096
  s_add_u32 m0, s26, 8192
  s_nop 0
  buffer_load_dwordx4 v1, s[4:7], s20 offen offset:0 lds
  buffer_load_dwordx4 v1, s[4:7], s20 offen offset:1024 lds
  s_mul_i32 s34, s15, 12
  s_mul_i32 s35, s16, 6
  s_add_u32 s34, s34, s35
  s_add_u32 s34, s34, 0
  s_mul_i32 s34, s34, 20480
  s_add_u32 s34, s34, 14155776
  buffer_load_dwordx4 a[0:3], v1, s[4:7], s34 offen offset:0
  buffer_load_dwordx4 a[4:7], v1, s[4:7], s34 offen offset:1024
  buffer_load_dwordx4 a[8:11], v1, s[4:7], s34 offen offset:2048
  buffer_load_dwordx4 a[12:15], v1, s[4:7], s34 offen offset:3072
  s_add_u32 s34, s34, 4096
  buffer_load_dwordx4 a[16:19], v1, s[4:7], s34 offen offset:0
  buffer_load_dwordx4 a[20:23], v1, s[4:7], s34 offen offset:1024
  buffer_load_dwordx4 a[24:27], v1, s[4:7], s34 offen offset:2048
  buffer_load_dwordx4 a[28:31], v1, s[4:7], s34 offen offset:3072
  s_add_u32 s34, s34, 4096
  buffer_load_dwordx4 a[32:35], v1, s[4:7], s34 offen offset:0
  buffer_load_dwordx4 a[36:39], v1, s[4:7], s34 offen offset:1024
  buffer_load_dwordx4 a[40:43], v1, s[4:7], s34 offen offset:2048
  buffer_load_dwordx4 a[44:47], v1, s[4:7], s34 offen offset:3072
  s_add_u32 s34, s34, 4096
  buffer_load_dwordx4 a[48:51], v1, s[4:7], s34 offen offset:0
  buffer_load_dwordx4 a[52:55], v1, s[4:7], s34 offen offset:1024
  buffer_load_dwordx4 a[56:59], v1, s[4:7], s34 offen offset:2048
  buffer_load_dwordx4 a[60:63], v1, s[4:7], s34 offen offset:3072
  s_add_u32 s34, s34, 4096
  buffer_load_dwordx4 a[64:67], v1, s[4:7], s34 offen offset:0
  buffer_load_dwordx4 a[68:71], v1, s[4:7], s34 offen offset:1024
  buffer_load_dwordx4 a[72:75], v1, s[4:7], s34 offen offset:2048
  buffer_load_dwordx4 a[76:79], v1, s[4:7], s34 offen offset:3072
  s_mul_i32 s34, s15, 12
  s_mul_i32 s35, s16, 6
  s_add_u32 s34, s34, s35
  s_add_u32 s34, s34, 1
  s_mul_i32 s34, s34, 20480
  s_add_u32 s34, s34, 14155776
  buffer_load_dwordx4 a[80:83], v1, s[4:7], s34 offen offset:0
  buffer_load_dwordx4 a[84:87], v1, s[4:7], s34 offen offset:1024
  buffer_load_dwordx4 a[88:91], v1, s[4:7], s34 offen offset:2048
  buffer_load_dwordx4 a[92:95], v1, s[4:7], s34 offen offset:3072
  s_add_u32 s34, s34, 4096
  buffer_load_dwordx4 a[96:99], v1, s[4:7], s34 offen offset:0
  buffer_load_dwordx4 a[100:103], v1, s[4:7], s34 offen offset:1024
  buffer_load_dwordx4 a[104:107], v1, s[4:7], s34 offen offset:2048
  buffer_load_dwordx4 a[108:111], v1, s[4:7], s34 offen offset:3072
  s_add_u32 s34, s34, 4096
  buffer_load_dwordx4 a[112:115], v1, s[4:7], s34 offen offset:0
  buffer_load_dwordx4 a[116:119], v1, s[4:7], s34 offen offset:1024
  buffer_load_dwordx4 a[120:123], v1, s[4:7], s34 offen offset:2048
  buffer_load_dwordx4 a[124:127], v1, s[4:7], s34 offen offset:3072
  s_add_u32 s34, s34, 4096
  buffer_load_dwordx4 a[128:131], v1, s[4:7], s34 offen offset:0
  buffer_load_dwordx4 a[132:135], v1, s[4:7], s34 offen offset:1024
  buffer_load_dwordx4 a[136:139], v1, s[4:7], s34 offen offset:2048
  buffer_load_dwordx4 a[140:143], v1, s[4:7], s34 offen offset:3072
  s_add_u32 s34, s34, 4096
  buffer_load_dwordx4 a[144:147], v1, s[4:7], s34 offen offset:0
  buffer_load_dwordx4 a[148:151], v1, s[4:7], s34 offen offset:1024
  buffer_load_dwordx4 a[152:155], v1, s[4:7], s34 offen offset:2048
  buffer_load_dwordx4 a[156:159], v1, s[4:7], s34 offen offset:3072
  s_waitcnt vmcnt(20)
  s_mul_i32 s34, s15, 12
  s_mul_i32 s35, s16, 6
  s_add_u32 s34, s34, s35
  s_add_u32 s34, s34, 2
  s_mul_i32 s34, s34, 20480
  s_add_u32 s34, s34, 14155776
  buffer_load_dwordx4 a[160:163], v1, s[4:7], s34 offen offset:0
  buffer_load_dwordx4 a[164:167], v1, s[4:7], s34 offen offset:1024
  buffer_load_dwordx4 a[168:171], v1, s[4:7], s34 offen offset:2048
  buffer_load_dwordx4 a[172:175], v1, s[4:7], s34 offen offset:3072
  s_add_u32 s34, s34, 4096
  buffer_load_dwordx4 a[176:179], v1, s[4:7], s34 offen offset:0
  buffer_load_dwordx4 a[180:183], v1, s[4:7], s34 offen offset:1024
  buffer_load_dwordx4 a[184:187], v1, s[4:7], s34 offen offset:2048
  buffer_load_dwordx4 a[188:191], v1, s[4:7], s34 offen offset:3072
  s_add_u32 s34, s34, 4096
  buffer_load_dwordx4 a[192:195], v1, s[4:7], s34 offen offset:0
  buffer_load_dwordx4 a[196:199], v1, s[4:7], s34 offen offset:1024
  buffer_load_dwordx4 a[200:203], v1, s[4:7], s34 offen offset:2048
  buffer_load_dwordx4 a[204:207], v1, s[4:7], s34 offen offset:3072
  s_add_u32 s34, s34, 4096
  buffer_load_dwordx4 a[208:211], v1, s[4:7], s34 offen offset:0
  buffer_load_dwordx4 a[212:215], v1, s[4:7], s34 offen offset:1024
  buffer_load_dwordx4 a[216:219], v1, s[4:7], s34 offen offset:2048
  buffer_load_dwordx4 a[220:223], v1, s[4:7], s34 offen offset:3072
  s_add_u32 s34, s34, 4096
  buffer_load_dwordx4 a[224:227], v1, s[4:7], s34 offen offset:0
  buffer_load_dwordx4 a[228:231], v1, s[4:7], s34 offen offset:1024
  buffer_load_dwordx4 a[232:235], v1, s[4:7], s34 offen offset:2048
  buffer_load_dwordx4 a[236:239], v1, s[4:7], s34 offen offset:3072
  s_waitcnt vmcnt(20)
  s_mul_i32 s34, s15, 12
  s_mul_i32 s35, s16, 6
  s_add_u32 s34, s34, s35
  s_add_u32 s34, s34, 3
  s_mul_i32 s34, s34, 20480
  s_add_u32 s34, s34, 14155776
  buffer_load_dwordx4 v[96:99], v1, s[4:7], s34 offen offset:0
  buffer_load_dwordx4 v[100:103], v1, s[4:7], s34 offen offset:1024
  buffer_load_dwordx4 v[104:107], v1, s[4:7], s34 offen offset:2048
  buffer_load_dwordx4 v[108:111], v1, s[4:7], s34 offen offset:3072
  s_add_u32 s34, s34, 4096
  buffer_load_dwordx4 v[112:115], v1, s[4:7], s34 offen offset:0
  buffer_load_dwordx4 v[116:119], v1, s[4:7], s34 offen offset:1024
  buffer_load_dwordx4 v[120:123], v1, s[4:7], s34 offen offset:2048
  buffer_load_dwordx4 v[124:127], v1, s[4:7], s34 offen offset:3072
  s_add_u32 s34, s34, 4096
  buffer_load_dwordx4 v[128:131], v1, s[4:7], s34 offen offset:0
  buffer_load_dwordx4 v[132:135], v1, s[4:7], s34 offen offset:1024
  buffer_load_dwordx4 v[136:139], v1, s[4:7], s34 offen offset:2048
  buffer_load_dwordx4 v[140:143], v1, s[4:7], s34 offen offset:3072
  s_add_u32 s34, s34, 4096
  buffer_load_dwordx4 v[144:147], v1, s[4:7], s34 offen offset:0
  buffer_load_dwordx4 v[148:151], v1, s[4:7], s34 offen offset:1024
  buffer_load_dwordx4 v[152:155], v1, s[4:7], s34 offen offset:2048
  buffer_load_dwordx4 v[156:159], v1, s[4:7], s34 offen offset:3072
  s_add_u32 s34, s34, 4096
  buffer_load_dwordx4 v[160:163], v1, s[4:7], s34 offen offset:0
  buffer_load_dwordx4 v[164:167], v1, s[4:7], s34 offen offset:1024
  buffer_load_dwordx4 v[168:171], v1, s[4:7], s34 offen offset:2048
  buffer_load_dwordx4 v[172:175], v1, s[4:7], s34 offen offset:3072
  s_waitcnt vmcnt(20)
  s_mul_i32 s34, s15, 12
  s_mul_i32 s35, s16, 6
  s_add_u32 s34, s34, s35
  s_add_u32 s34, s34, 0
  s_mul_i32 s34, s34, 20480
  s_add_u32 s34, s34, 22020096
  buffer_load_dwordx4 v[176:179], v1, s[4:7], s34 offen offset:0
  buffer_load_dwordx4 v[180:183], v1, s[4:7], s34 offen offset:1024
  buffer_load_dwordx4 v[184:187], v1, s[4:7], s34 offen offset:2048
  buffer_load_dwordx4 v[188:191], v1, s[4:7], s34 offen offset:3072
  s_add_u32 s34, s34, 4096
  buffer_load_dwordx4 v[192:195], v1, s[4:7], s34 offen offset:0
  buffer_load_dwordx4 v[196:199], v1, s[4:7], s34 offen offset:1024
  buffer_load_dwordx4 v[200:203], v1, s[4:7], s34 offen offset:2048
  buffer_load_dwordx4 v[204:207], v1, s[4:7], s34 offen offset:3072
  s_add_u32 s34, s34, 4096
  buffer_load_dwordx4 v[208:211], v1, s[4:7], s34 offen offset:0
  buffer_load_dwordx4 v[212:215], v1, s[4:7], s34 offen offset:1024
  buffer_load_dwordx4 v[216:219], v1, s[4:7], s34 offen offset:2048
  buffer_load_dwordx4 v[220:223], v1, s[4:7], s34 offen offset:3072
  s_add_u32 s34, s34, 4096
  buffer_load_dwordx4 v[224:227], v1, s[4:7], s34 offen offset:0
  buffer_load_dwordx4 v[228:231], v1, s[4:7], s34 offen offset:1024
  buffer_load_dwordx4 v[232:235], v1, s[4:7], s34 offen offset:2048
  buffer_load_dwordx4 v[236:239], v1, s[4:7], s34 offen offset:3072
  s_add_u32 s34, s34, 4096
  buffer_load_dwordx4 v[240:243], v1, s[4:7], s34 offen offset:0
  buffer_load_dwordx4 v[244:247], v1, s[4:7], s34 offen offset:1024
  buffer_load_dwordx4 v[248:251], v1, s[4:7], s34 offen offset:2048
  buffer_load_dwordx4 v[252:255], v1, s[4:7], s34 offen offset:3072
  s_waitcnt vmcnt(20)
  v_and_b32 v30, 7, v0
  v_lshlrev_b32 v30, 3, v30
reca_cens230:
  buffer_load_dwordx2 v[28:29], v30, s[8:11], 0 offen sc1
  s_waitcnt vmcnt(0)
  v_sad_u8 v31, v28, 0, 0
  v_sad_u8 v31, v29, 0, v31
  v_cmp_gt_u32 vcc, 32, v31
  s_cbranch_vccz reca_censok231
  s_sleep 8
  s_sub_u32 s18, s18, 1
  s_cbranch_scc0 reca_cens230
  s_mov_b32 s18, 0
reca_censok231:
  v_and_b32 v28, 0x20202020, v28
  v_and_b32 v29, 0x20202020, v29
  v_cmp_ne_u32 s[34:35], 0, v28
  v_cmp_ne_u32 s[36:37], 0, v29
  s_nop 3
  s_and_b32 s34, s34, 0xff
  s_and_b32 s36, s36, 0xff
  s_or_b32 s35, s34, s36
  s_lshr_b32 s37, s35, s13
  s_and_b32 s37, s37, 1
  s_xor_b32 s43, s37, 1
  s_cmp_eq_u32 s57, 0
  s_cselect_b32 s58, s36, s34
  v_mov_b32 v31, 0x80000000
  s_cmp_lg_u32 s43, 0
  s_cbranch_scc1 reca_pslow232
reca_ptop233:
  s_cmp_lt_u32 s17, 3
  s_cbranch_scc1 reca_pgo234
  s_sub_u32 s36, s17, 3
reca_ppoll235:
  buffer_load_dword v28, v4, s[4:7], s25 offen sc1
  s_waitcnt vmcnt(0)
  v_readfirstlane_b32 s34, v28
  s_nop 3
  s_cmp_ge_i32 s34, s36
  s_cbranch_scc1 reca_pgo234
  s_sleep 8
  s_sub_u32 s18, s18, 1
  s_cbranch_scc0 reca_ppoll235
  s_mov_b32 s18, 0
reca_pgo234:
  s_waitcnt vmcnt(0)
  s_barrier
  v_add_u32 v7, s26, v1
  s_xor_b32 s26, s26, 40960
  s_add_u32 s37, s17, 1
  s_cmp_ge_u32 s37, 64
  s_cbranch_scc1 reca_pnodma236
  s_mul_i32 s20, s37, 40960
  s_add_u32 s20, s20, 84934656
  s_add_u32 m0, s26, 0
  s_nop 0
  buffer_load_dwordx4 v1, s[4:7], s20 offen offset:0 lds
  buffer_load_dwordx4 v1, s[4:7], s20 offen offset:1024 lds
  buffer_load_dwordx4 v1, s[4:7], s20 offen offset:2048 lds
  buffer_load_dwordx4 v1, s[4:7], s20 offen offset:3072 lds
  s_add_u32 s20, s20, 4096
  s_add_u32 m0, s26, 4096
  s_nop 0
  buffer_load_dwordx4 v1, s[4:7], s20 offen offset:0 lds
  buffer_load_dwordx4 v1, s[4:7], s20 offen offset:1024 lds
  buffer_load_dwordx4 v1, s[4:7], s20 offen offset:2048 lds
  buffer_load_dwordx4 v1, s[4:7], s20 offen offset:3072 lds
  s_add_u32 s20, s20, 4096
  s_add_u32 m0, s26, 8192
  s_nop 0
  buffer_load_dwordx4 v1, s[4:7], s20 offen offset:0 lds
  buffer_load_dwordx4 v1, s[4:7], s20 offen offset:1024 lds
reca_pnodma236:
  s_lshl_b32 s34, s15, 3
  s_and_b32 s35, s17, 7
  s_add_u32 s34, s34, s35
  s_mul_i32 s34, s34, 12288
  s_mul_i32 s35, s16, 3072
  s_add_u32 s35, s35, s34
  s_add_u32 s21, s35, 37748736
  s_add_u32 s22, s35, 44040192
  s_mul_i32 s35, s16, 6144
  s_add_u32 s35, s35, s34
  s_add_u32 s23, s35, 40894464
  ds_read_b128 v[72:75], v7 offset:0
  ds_read_b128 v[76:79], v7 offset:20480
  ds_read_b128 v[80:83], v7 offset:1024
  ds_read_b128 v[84:87], v7 offset:21504
  ds_read_b128 v[88:91], v7 offset:2048
  ds_read_b128 v[92:95], v7 offset:22528
  s_waitcnt lgkmcnt(4)
  v_mfma_f32_16x16x32_bf16 v[32:35], a[0:3], v[72:75], 0
  v_mfma_f32_16x16x32_bf16 v[36:39], a[0:3], v[76:79], 0
  v_mfma_f32_16x16x32_bf16 v[40:43], a[80:83], v[72:75], 0
  v_mfma_f32_16x16x32_bf16 v[44:47], a[80:83], v[76:79], 0
  v_mfma_f32_16x16x32_bf16 v[48:51], a[160:163], v[72:75], 0
  v_mfma_f32_16x16x32_bf16 v[52:55], a[160:163], v[76:79], 0
  v_mfma_f32_16x16x32_bf16 v[56:59], v[96:99], v[72:75], 0
  v_mfma_f32_16x16x32_bf16 v[60:63], v[96:99], v[76:79], 0
  v_mfma_f32_16x16x32_bf16 v[64:67], v[72:75], v[176:179], 0
  v_mfma_f32_16x16x32_bf16 v[68:71], v[76:79], v[176:179], 0
  ds_read_b128 v[72:75], v7 offset:3072
  ds_read_b128 v[76:79], v7 offset:23552
  s_waitcnt lgkmcnt(4)
  v_mfma_f32_16x16x32_bf16 v[32:35], a[4:7], v[80:83], v[32:35]
  v_mfma_f32_16x16x32_bf16 v[36:39], a[4:7], v[84:87], v[36:39]
  v_mfma_f32_16x16x32_bf16 v[40:43], a[84:87], v[80:83], v[40:43]
  v_mfma_f32_16x16x32_bf16 v[44:47], a[84:87], v[84:87], v[44:47]
  v_mfma_f32_16x16x32_bf16 v[48:51], a[164:167], v[80:83], v[48:51]
  v_mfma_f32_16x16x32_bf16 v[52:55], a[164:167], v[84:87], v[52:55]
  v_mfma_f32_16x16x32_bf16 v[56:59], v[100:103], v[80:83], v[56:59]
  v_mfma_f32_16x16x32_bf16 v[60:63], v[100:103], v[84:87], v[60:63]
  v_mfma_f32_16x16x32_bf16 v[64:67], v[80:83], v[180:183], v[64:67]
  v_mfma_f32_16x16x32_bf16 v[68:71], v[84:87], v[180:183], v[68:71]
  ds_read_b128 v[80:83], v7 offset:4096
  ds_read_b128 v[84:87], v7 offset:24576
  s_waitcnt lgkmcnt(4)
  v_mfma_f32_16x16x32_bf16 v[32:35], a[8:11], v[88:91], v[32:35]
  v_mfma_f32_16x16x32_bf16 v[36:39], a[8:11], v[92:95], v[36:39]
  v_mfma_f32_16x16x32_bf16 v[40:43], a[88:91], v[88:91], v[40:43]
  v_mfma_f32_16x16x32_bf16 v[44:47], a[88:91], v[92:95], v[44:47]
  v_mfma_f32_16x16x32_bf16 v[48:51], a[168:171], v[88:91], v[48:51]
  v_mfma_f32_16x16x32_bf16 v[52:55], a[168:171], v[92:95], v[52:55]
  v_mfma_f32_16x16x32_bf16 v[56:59], v[104:107], v[88:91], v[56:59]
  v_mfma_f32_16x16x32_bf16 v[60:63], v[104:107], v[92:95], v[60:63]
  v_mfma_f32_16x16x32_bf16 v[64:67], v[88:91], v[184:187], v[64:67]
  v_mfma_f32_16x16x32_bf16 v[68:71], v[92:95], v[184:187], v[68:71]
  ds_read_b128 v[88:91], v7 offset:5120
  ds_read_b128 v[92:95], v7 offset:25600
  s_waitcnt lgkmcnt(4)
  v_mfma_f32_16x16x32_bf16 v[32:35], a[12:15], v[72:75], v[32:35]
  v_mfma_f32_16x16x32_bf16 v[36:39], a[12:15], v[76:79], v[36:39]
  v_mfma_f32_16x16x32_bf16 v[40:43], a[92:95], v[72:75], v[40:43]
  v_mfma_f32_16x16x32_bf16 v[44:47], a[92:95], v[76:79], v[44:47]
  v_mfma_f32_16x16x32_bf16 v[48:51], a[172:175], v[72:75], v[48:51]
  v_mfma_f32_16x16x32_bf16 v[52:55], a[172:175], v[76:79], v[52:55]
  v_mfma_f32_16x16x32_bf16 v[56:59], v[108:111], v[72:75], v[56:59]
  v_mfma_f32_16x16x32_bf16 v[60:63], v[108:111], v[76:79], v[60:63]
  v_mfma_f32_16x16x32_bf16 v[64:67], v[72:75], v[188:191], v[64:67]
  v_mfma_f32_16x16x32_bf16 v[68:71], v[76:79], v[188:191], v[68:71]
  ds_read_b128 v[72:75], v7 offset:6144
  ds_read_b128 v[76:79], v7 offset:26624
  s_waitcnt lgkmcnt(4)
  v_mfma_f32_16x16x32_bf16 v[32:35], a[16:19], v[80:83], v[32:35]
  v_mfma_f32_16x16x32_bf16 v[36:39], a[16:19], v[84:87], v[36:39]
  v_mfma_f32_16x16x32_bf16 v[40:43], a[96:99], v[80:83], v[40:43]
  v_mfma_f32_16x16x32_bf16 v[44:47], a[96:99], v[84:87], v[44:47]
  v_mfma_f32_16x16x32_bf16 v[48:51], a[176:179], v[80:83], v[48:51]
  v_mfma_f32_16x16x32_bf16 v[52:55], a[176:179], v[84:87], v[52:55]
  v_mfma_f32_16x16x32_bf16 v[56:59], v[112:115], v[80:83], v[56:59]
  v_mfma_f32_16x16x32_bf16 v[60:63], v[112:115], v[84:87], v[60:63]
  v_mfma_f32_16x16x32_bf16 v[64:67], v[80:83], v[192:195], v[64:67]
  v_mfma_f32_16x16x32_bf16 v[68:71], v[84:87], v[192:195], v[68:71]
  ds_read_b128 v[80:83], v7 offset:7168
  ds_read_b128 v[84:87], v7 offset:27648
  s_waitcnt lgkmcnt(4)
  v_mfma_f32_16x16x32_bf16 v[32:35], a[20:23], v[88:91], v[32:35]
  v_mfma_f32_16x16x32_bf16 v[36:39], a[20:23], v[92:95], v[36:39]
  v_mfma_f32_16x16x32_bf16 v[40:43], a[100:103], v[88:91], v[40:43]
  v_mfma_f32_16x16x32_bf16 v[44:47], a[100:103], v[92:95], v[44:47]
  v_mfma_f32_16x16x32_bf16 v[48:51], a[180:183], v[88:91], v[48:51]
  v_mfma_f32_16x16x32_bf16 v[52:55], a[180:183], v[92:95], v[52:55]
  v_mfma_f32_16x16x32_bf16 v[56:59], v[116:119], v[88:91], v[56:59]
  v_mfma_f32_16x16x32_bf16 v[60:63], v[116:119], v[92:95], v[60:63]
  v_mfma_f32_16x16x32_bf16 v[64:67], v[88:91], v[196:199], v[64:67]
  v_mfma_f32_16x16x32_bf16 v[68:71], v[92:95], v[196:199], v[68:71]
  ds_read_b128 v[88:91], v7 offset:8192
  ds_read_b128 v[92:95], v7 offset:28672
  s_waitcnt lgkmcnt(4)
  v_mfma_f32_16x16x32_bf16 v[32:35], a[24:27], v[72:75], v[32:35]
  v_mfma_f32_16x16x32_bf16 v[36:39], a[24:27], v[76:79], v[36:39]
  v_mfma_f32_16x16x32_bf16 v[40:43], a[104:107], v[72:75], v[40:43]
  v_mfma_f32_16x16x32_bf16 v[44:47], a[104:107], v[76:79], v[44:47]
  v_mfma_f32_16x16x32_bf16 v[48:51], a[184:187], v[72:75], v[48:51]
  v_mfma_f32_16x16x32_bf16 v[52:55], a[184:187], v[76:79], v[52:55]
  v_mfma_f32_16x16x32_bf16 v[56:59], v[120:123], v[72:75], v[56:59]
  v_mfma_f32_16x16x32_bf16 v[60:63], v[120:123], v[76:79], v[60:63]
  v_mfma_f32_16x16x32_bf16 v[64:67], v[72:75], v[200:203], v[64:67]
  v_mfma_f32_16x16x32_bf16 v[68:71], v[76:79], v[200:203], v[68:71]
  ds_read_b128 v[72:75], v7 offset:9216
  ds_read_b128 v[76:79], v7 offset:29696
  s_waitcnt lgkmcnt(4)
  v_mfma_f32_16x16x32_bf16 v[32:35], a[28:31], v[80:83], v[32:35]
  v_mfma_f32_16x16x32_bf16 v[36:39], a[28:31], v[84:87], v[36:39]
  v_mfma_f32_16x16x32_bf16 v[40:43], a[108:111], v[80:83], v[40:43]
  v_mfma_f32_16x16x32_bf16 v[44:47], a[108:111], v[84:87], v[44:47]
  v_mfma_f32_16x16x32_bf16 v[48:51], a[188:191], v[80:83], v[48:51]
  v_mfma_f32_16x16x32_bf16 v[52:55], a[188:191], v[84:87], v[52:55]
  v_mfma_f32_16x16x32_bf16 v[56:59], v[124:127], v[80:83], v[56:59]
  v_mfma_f32_16x16x32_bf16 v[60:63], v[124:127], v[84:87], v[60:63]
  v_mfma_f32_16x16x32_bf16 v[64:67], v[80:83], v[204:207], v[64:67]
  v_mfma_f32_16x16x32_bf16 v[68:71], v[84:87], v[204:207], v[68:71]
  ds_read_b128 v[80:83], v7 offset:10240
  ds_read_b128 v[84:87], v7 offset:30720
  s_waitcnt lgkmcnt(4)
  v_mfma_f32_16x16x32_bf16 v[32:35], a[32:35], v[88:91], v[32:35]
  v_mfma_f32_16x16x32_bf16 v[36:39], a[32:35], v[92:95], v[36:39]
  v_mfma_f32_16x16x32_bf16 v[40:43], a[112:115], v[88:91], v[40:43]
  v_mfma_f32_16x16x32_bf16 v[44:47], a[112:115], v[92:95], v[44:47]
  v_mfma_f32_16x16x32_bf16 v[48:51], a[192:195], v[88:91], v[48:51]
  v_mfma_f32_16x16x32_bf16 v[52:55], a[192:195], v[92:95], v[52:55]
  v_mfma_f32_16x16x32_bf16 v[56:59], v[128:131], v[88:91], v[56:59]
  v_mfma_f32_16x16x32_bf16 v[60:63], v[128:131], v[92:95], v[60:63]
  v_mfma_f32_16x16x32_bf16 v[64:67], v[88:91], v[208:211], v[64:67]
  v_mfma_f32_16x16x32_bf16 v[68:71], v[92:95], v[208:211], v[68:71]
  ds_read_b128 v[88:91], v7 offset:11264
  ds_read_b128 v[92:95], v7 offset:31744
  s_waitcnt lgkmcnt(4)
  v_mfma_f32_16x16x32_bf16 v[32:35], a[36:39], v[72:75], v[32:35]
  v_mfma_f32_16x16x32_bf16 v[36:39], a[36:39], v[76:79], v[36:39]
  v_mfma_f32_16x16x32_bf16 v[40:43], a[116:119], v[72:75], v[40:43]
  v_mfma_f32_16x16x32_bf16 v[44:47], a[116:119], v[76:79], v[44:47]
  v_mfma_f32_16x16x32_bf16 v[48:51], a[196:199], v[72:75], v[48:51]
  v_mfma_f32_16x16x32_bf16 v[52:55], a[196:199], v[76:79], v[52:55]
  v_mfma_f32_16x16x32_bf16 v[56:59], v[132:135], v[72:75], v[56:59]
  v_mfma_f32_16x16x32_bf16 v[60:63], v[132:135], v[76:79], v[60:63]
  v_mfma_f32_16x16x32_bf16 v[64:67], v[72:75], v[212:215], v[64:67]
  v_mfma_f32_16x16x32_bf16 v[68:71], v[76:79], v[212:215], v[68:71]
  ds_read_b128 v[72:75], v7 offset:12288
  ds_read_b128 v[76:79], v7 offset:32768
  s_waitcnt lgkmcnt(4)
  v_mfma_f32_16x16x32_bf16 v[32:35], a[40:43], v[80:83], v[32:35]
  v_mfma_f32_16x16x32_bf16 v[36:39], a[40:43], v[84:87], v[36:39]
  v_mfma_f32_16x16x32_bf16 v[40:43], a[120:123], v[80:83], v[40:43]
  v_mfma_f32_16x16x32_bf16 v[44:47], a[120:123], v[84:87], v[44:47]
  v_mfma_f32_16x16x32_bf16 v[48:51], a[200:203], v[80:83], v[48:51]
  v_mfma_f32_16x16x32_bf16 v[52:55], a[200:203], v[84:87], v[52:55]
  v_mfma_f32_16x16x32_bf16 v[56:59], v[136:139], v[80:83], v[56:59]
  v_mfma_f32_16x16x32_bf16 v[60:63], v[136:139], v[84:87], v[60:63]
  v_mfma_f32_16x16x32_bf16 v[64:67], v[80:83], v[216:219], v[64:67]
  v_mfma_f32_16x16x32_bf16 v[68:71], v[84:87], v[216:219], v[68:71]
  ds_read_b128 v[80:83], v7 offset:13312
  ds_read_b128 v[84:87], v7 offset:33792
  s_waitcnt lgkmcnt(4)
  v_mfma_f32_16x16x32_bf16 v[32:35], a[44:47], v[88:91], v[32:35]
  v_mfma_f32_16x16x32_bf16 v[36:39], a[44:47], v[92:95], v[36:39]
  v_mfma_f32_16x16x32_bf16 v[40:43], a[124:127], v[88:91], v[40:43]
  v_mfma_f32_16x16x32_bf16 v[44:47], a[124:127], v[92:95], v[44:47]
  v_mfma_f32_16x16x32_bf16 v[48:51], a[204:207], v[88:91], v[48:51]
  v_mfma_f32_16x16x32_bf16 v[52:55], a[204:207], v[92:95], v[52:55]
  v_mfma_f32_16x16x32_bf16 v[56:59], v[140:143], v[88:91], v[56:59]
  v_mfma_f32_16x16x32_bf16 v[60:63], v[140:143], v[92:95], v[60:63]
  v_mfma_f32_16x16x32_bf16 v[64:67], v[88:91], v[220:223], v[64:67]
  v_mfma_f32_16x16x32_bf16 v[68:71], v[92:95], v[220:223], v[68:71]
  ds_read_b128 v[88:91], v7 offset:14336
  ds_read_b128 v[92:95], v7 offset:34816
  s_waitcnt lgkmcnt(4)
  v_mfma_f32_16x16x32_bf16 v[32:35], a[48:51], v[72:75], v[32:35]
  v_mfma_f32_16x16x32_bf16 v[36:39], a[48:51], v[76:79], v[36:39]
  v_mfma_f32_16x16x32_bf16 v[40:43], a[128:131], v[72:75], v[40:43]
  v_mfma_f32_16x16x32_bf16 v[44:47], a[128:131], v[76:79], v[44:47]
  v_mfma_f32_16x16x32_bf16 v[48:51], a[208:211], v[72:75], v[48:51]
  v_mfma_f32_16x16x32_bf16 v[52:55], a[208:211], v[76:79], v[52:55]
  v_mfma_f32_16x16x32_bf16 v[56:59], v[144:147], v[72:75], v[56:59]
  v_mfma_f32_16x16x32_bf16 v[60:63], v[144:147], v[76:79], v[60:63]
  v_mfma_f32_16x16x32_bf16 v[64:67], v[72:75], v[224:227], v[64:67]
  v_mfma_f32_16x16x32_bf16 v[68:71], v[76:79], v[224:227], v[68:71]
  ds_read_b128 v[72:75], v7 offset:15360
  ds_read_b128 v[76:79], v7 offset:35840
  s_waitcnt lgkmcnt(4)
  v_mfma_f32_16x16x32_bf16 v[32:35], a[52:55], v[80:83], v[32:35]
  v_mfma_f32_16x16x32_bf16 v[36:39], a[52:55], v[84:87], v[36:39]
  v_mfma_f32_16x16x32_bf16 v[40:43], a[132:135], v[80:83], v[40:43]
  v_mfma_f32_16x16x32_bf16 v[44:47], a[132:135], v[84:87], v[44:47]
  v_mfma_f32_16x16x32_bf16 v[48:51], a[212:215], v[80:83], v[48:51]
  v_mfma_f32_16x16x32_bf16 v[52:55], a[212:215], v[84:87], v[52:55]
  v_mfma_f32_16x16x32_bf16 v[56:59], v[148:151], v[80:83], v[56:59]
  v_mfma_f32_16x16x32_bf16 v[60:63], v[148:151], v[84:87], v[60:63]
  v_mfma_f32_16x16x32_bf16 v[64:67], v[80:83], v[228:231], v[64:67]
  v_mfma_f32_16x16x32_bf16 v[68:71], v[84:87], v[228:231], v[68:71]
  ds_read_b128 v[80:83], v7 offset:16384
  ds_read_b128 v[84:87], v7 offset:36864
  s_waitcnt lgkmcnt(4)
  v_mfma_f32_16x16x32_bf16 v[32:35], a[56:59], v[88:91], v[32:35]
  v_mfma_f32_16x16x32_bf16 v[36:39], a[56:59], v[92:95], v[36:39]
  v_mfma_f32_16x16x32_bf16 v[40:43], a[136:139], v[88:91], v[40:43]
  v_mfma_f32_16x16x32_bf16 v[44:47], a[136:139], v[92:95], v[44:47]
  v_mfma_f32_16x16x32_bf16 v[48:51], a[216:219], v[88:91], v[48:51]
  v_mfma_f32_16x16x32_bf16 v[52:55], a[216:219], v[92:95], v[52:55]
  v_mfma_f32_16x16x32_bf16 v[56:59], v[152:155], v[88:91], v[56:59]
  v_mfma_f32_16x16x32_bf16 v[60:63], v[152:155], v[92:95], v[60:63]
  v_mfma_f32_16x16x32_bf16 v[64:67], v[88:91], v[232:235], v[64:67]
  v_mfma_f32_16x16x32_bf16 v[68:71], v[92:95], v[232:235], v[68:71]
  ds_read_b128 v[88:91], v7 offset:17408
  ds_read_b128 v[92:95], v7 offset:37888
  s_waitcnt lgkmcnt(4)
  v_mfma_f32_16x16x32_bf16 v[32:35], a[60:63], v[72:75], v[32:35]
  v_mfma_f32_16x16x32_bf16 v[36:39], a[60:63], v[76:79], v[36:39]
  v_mfma_f32_16x16x32_bf16 v[40:43], a[140:143], v[72:75], v[40:43]
  v_mfma_f32_16x16x32_bf16 v[44:47], a[140:143], v[76:79], v[44:47]
  v_mfma_f32_16x16x32_bf16 v[48:51], a[220:223], v[72:75], v[48:51]
  v_mfma_f32_16x16x32_bf16 v[52:55], a[220:223], v[76:79], v[52:55]
  v_mfma_f32_16x16x32_bf16 v[56:59], v[156:159], v[72:75], v[56:59]
  v_mfma_f32_16x16x32_bf16 v[60:63], v[156:159], v[76:79], v[60:63]
  v_mfma_f32_16x16x32_bf16 v[64:67], v[72:75], v[236:239], v[64:67]
  v_mfma_f32_16x16x32_bf16 v[68:71], v[76:79], v[236:239], v[68:71]
  ds_read_b128 v[72:75], v7 offset:18432
  ds_read_b128 v[76:79], v7 offset:38912
  s_waitcnt lgkmcnt(4)
  v_mfma_f32_16x16x32_bf16 v[32:35], a[64:67], v[80:83], v[32:35]
  v_mfma_f32_16x16x32_bf16 v[36:39], a[64:67], v[84:87], v[36:39]
  v_mfma_f32_16x16x32_bf16 v[40:43], a[144:147], v[80:83], v[40:43]
  v_mfma_f32_16x16x32_bf16 v[44:47], a[144:147], v[84:87], v[44:47]
  v_mfma_f32_16x16x32_bf16 v[48:51], a[224:227], v[80:83], v[48:51]
  v_mfma_f32_16x16x32_bf16 v[52:55], a[224:227], v[84:87], v[52:55]
  v_mfma_f32_16x16x32_bf16 v[56:59], v[160:163], v[80:83], v[56:59]
  v_mfma_f32_16x16x32_bf16 v[60:63], v[160:163], v[84:87], v[60:63]
  v_mfma_f32_16x16x32_bf16 v[64:67], v[80:83], v[240:243], v[64:67]
  v_mfma_f32_16x16x32_bf16 v[68:71], v[84:87], v[240:243], v[68:71]
  ds_read_b128 v[80:83], v7 offset:19456
  ds_read_b128 v[84:87], v7 offset:39936
  s_waitcnt lgkmcnt(4)
  v_mfma_f32_16x16x32_bf16 v[32:35], a[68:71], v[88:91], v[32:35]
  v_mfma_f32_16x16x32_bf16 v[36:39], a[68:71], v[92:95], v[36:39]
  v_mfma_f32_16x16x32_bf16 v[40:43], a[148:151], v[88:91], v[40:43]
  v_mfma_f32_16x16x32_bf16 v[44:47], a[148:151], v[92:95], v[44:47]
  v_mfma_f32_16x16x32_bf16 v[48:51], a[228:231], v[88:91], v[48:51]
  v_mfma_f32_16x16x32_bf16 v[52:55], a[228:231], v[92:95], v[52:55]
  v_mfma_f32_16x16x32_bf16 v[56:59], v[164:167], v[88:91], v[56:59]
  v_mfma_f32_16x16x32_bf16 v[60:63], v[164:167], v[92:95], v[60:63]
  v_mfma_f32_16x16x32_bf16 v[64:67], v[88:91], v[244:247], v[64:67]
  v_mfma_f32_16x16x32_bf16 v[68:71], v[92:95], v[244:247], v[68:71]
  s_waitcnt lgkmcnt(2)
  v_mfma_f32_16x16x32_bf16 v[32:35], a[72:75], v[72:75], v[32:35]
  v_mfma_f32_16x16x32_bf16 v[36:39], a[72:75], v[76:79], v[36:39]
  v_mfma_f32_16x16x32_bf16 v[40:43], a[152:155], v[72:75], v[40:43]
  v_mfma_f32_16x16x32_bf16 v[44:47], a[152:155], v[76:79], v[44:47]
  v_mfma_f32_16x16x32_bf16 v[48:51], a[232:235], v[72:75], v[48:51]
  v_mfma_f32_16x16x32_bf16 v[52:55], a[232:235], v[76:79], v[52:55]
  v_mfma_f32_16x16x32_bf16 v[56:59], v[168:171], v[72:75], v[56:59]
  v_mfma_f32_16x16x32_bf16 v[60:63], v[168:171], v[76:79], v[60:63]
  v_mfma_f32_16x16x32_bf16 v[64:67], v[72:75], v[248:251], v[64:67]
  v_mfma_f32_16x16x32_bf16 v[68:71], v[76:79], v[248:251], v[68:71]
  s_waitcnt lgkmcnt(0)
  v_mfma_f32_16x16x32_bf16 v[32:35], a[76:79], v[80:83], v[32:35]
  v_mfma_f32_16x16x32_bf16 v[36:39], a[76:79], v[84:87], v[36:39]
  v_mfma_f32_16x16x32_bf16 v[40:43], a[156:159], v[80:83], v[40:43]
  v_mfma_f32_16x16x32_bf16 v[44:47], a[156:159], v[84:87], v[44:47]
  v_mfma_f32_16x16x32_bf16 v[48:51], a[236:239], v[80:83], v[48:51]
  v_mfma_f32_16x16x32_bf16 v[52:55], a[236:239], v[84:87], v[52:55]
  v_mfma_f32_16x16x32_bf16 v[56:59], v[172:175], v[80:83], v[56:59]
  v_mfma_f32_16x16x32_bf16 v[60:63], v[172:175], v[84:87], v[60:63]
  v_mfma_f32_16x16x32_bf16 v[64:67], v[80:83], v[252:255], v[64:67]
  v_mfma_f32_16x16x32_bf16 v[68:71], v[84:87], v[252:255], v[68:71]
  v_cvt_pk_bf16_f32 v8, v32, v33
  v_cvt_pk_bf16_f32 v9, v34, v35
  v_cvt_pk_bf16_f32 v10, v40, v41
  v_cvt_pk_bf16_f32 v11, v42, v43
  s_add_u32 s34, s21, 0
  buffer_store_dwordx4 v[8:11], v1, s[4:7], s34 offen
  v_cvt_pk_bf16_f32 v12, v36, v37
  v_cvt_pk_bf16_f32 v13, v38, v39
  v_cvt_pk_bf16_f32 v14, v44, v45
  v_cvt_pk_bf16_f32 v15, v46, v47
  s_add_u32 s34, s21, 6144
  buffer_store_dwordx4 v[12:15], v1, s[4:7], s34 offen
  v_cvt_pk_bf16_f32 v8, v48, v49
  v_cvt_pk_bf16_f32 v9, v50, v51
  v_cvt_pk_bf16_f32 v10, v56, v57
  v_cvt_pk_bf16_f32 v11, v58, v59
  s_add_u32 s34, s21, 1024
  buffer_store_dwordx4 v[8:11], v1, s[4:7], s34 offen
  v_cvt_pk_bf16_f32 v12, v52, v53
  v_cvt_pk_bf16_f32 v13, v54, v55
  v_cvt_pk_bf16_f32 v14, v60, v61
  v_cvt_pk_bf16_f32 v15, v62, v63
  s_add_u32 s34, s21, 7168
  buffer_store_dwordx4 v[12:15], v1, s[4:7], s34 offen
  v_cvt_pk_bf16_f32 v8, v64, v65
  v_cvt_pk_bf16_f32 v9, v66, v67
  v_cvt_pk_bf16_f32 v10, v68, v69
  v_cvt_pk_bf16_f32 v11, v70, v71
  s_add_u32 s34, s23, 0
  buffer_store_dwordx4 v[8:11], v1, s[4:7], s34 offen
  s_waitcnt vmcnt(0)
  s_barrier
  s_add_u32 s17, s17, 1
  v_mov_b32 v28, s17
  buffer_store_dword v28, v4, s[4:7], s24 offen
  s_cmp_lt_u32 s17, 64
  s_cbranch_scc1 reca_ptop233
  s_branch reca_exit1
reca_pslow232:
reca_ptop238:
  s_cmp_lt_u32 s17, 3
  s_cbranch_scc1 reca_pgo239
  s_sub_u32 s36, s17, 3
reca_ppoll240:
  buffer_load_dword v28, v4, s[4:7], s25 offen sc1
  s_waitcnt vmcnt(0)
  v_readfirstlane_b32 s34, v28
  s_nop 3
  s_cmp_ge_i32 s34, s36
  s_cbranch_scc1 reca_pgo239
  s_sleep 8
  s_sub_u32 s18, s18, 1
  s_cbranch_scc0 reca_ppoll240
  s_mov_b32 s18, 0
reca_pgo239:
  s_waitcnt vmcnt(0)
  s_barrier
  v_add_u32 v7, s26, v1
  s_xor_b32 s26, s26, 40960
  s_add_u32 s37, s17, 1
  s_cmp_ge_u32 s37, 64
  s_cbranch_scc1 reca_pnodma241
  s_mul_i32 s20, s37, 40960
  s_add_u32 s20, s20, 84934656
  s_add_u32 m0, s26, 0
  s_nop 0
  buffer_load_dwordx4 v1, s[4:7], s20 offen offset:0 lds
  buffer_load_dwordx4 v1, s[4:7], s20 offen offset:1024 lds
  buffer_load_dwordx4 v1, s[4:7], s20 offen offset:2048 lds
  buffer_load_dwordx4 v1, s[4:7], s20 offen offset:3072 lds
  s_add_u32 s20, s20, 4096
  s_add_u32 m0, s26, 4096
  s_nop 0
  buffer_load_dwordx4 v1, s[4:7], s20 offen offset:0 lds
  buffer_load_dwordx4 v1, s[4:7], s20 offen offset:1024 lds
  buffer_load_dwordx4 v1, s[4:7], s20 offen offset:2048 lds
  buffer_load_dwordx4 v1, s[4:7], s20 offen offset:3072 lds
  s_add_u32 s20, s20, 4096
  s_add_u32 m0, s26, 8192
  s_nop 0
  buffer_load_dwordx4 v1, s[4:7], s20 offen offset:0 lds
  buffer_load_dwordx4 v1, s[4:7], s20 offen offset:1024 lds
reca_pnodma241:
  s_lshl_b32 s34, s15, 3
  s_and_b32 s35, s17, 7
  s_add_u32 s34, s34, s35
  s_mul_i32 s34, s34, 12288
  s_mul_i32 s35, s16, 3072
  s_add_u32 s35, s35, s34
  s_add_u32 s21, s35, 37748736
  s_add_u32 s22, s35, 44040192
  s_mul_i32 s35, s16, 6144
  s_add_u32 s35, s35, s34
  s_add_u32 s23, s35, 40894464
  ds_read_b128 v[72:75], v7 offset:0
  ds_read_b128 v[76:79], v7 offset:20480
  ds_read_b128 v[80:83], v7 offset:1024
  ds_read_b128 v[84:87], v7 offset:21504
  ds_read_b128 v[88:91], v7 offset:2048
  ds_read_b128 v[92:95], v7 offset:22528
  s_waitcnt lgkmcnt(4)
  v_mfma_f32_16x16x32_bf16 v[32:35], a[0:3], v[72:75], 0
  v_mfma_f32_16x16x32_bf16 v[36:39], a[0:3], v[76:79], 0
  v_mfma_f32_16x16x32_bf16 v[40:43], a[80:83], v[72:75], 0
  v_mfma_f32_16x16x32_bf16 v[44:47], a[80:83], v[76:79], 0
  v_mfma_f32_16x16x32_bf16 v[48:51], a[160:163], v[72:75], 0
  v_mfma_f32_16x16x32_bf16 v[52:55], a[160:163], v[76:79], 0
  v_mfma_f32_16x16x32_bf16 v[56:59], v[96:99], v[72:75], 0
  v_mfma_f32_16x16x32_bf16 v[60:63], v[96:99], v[76:79], 0
  v_mfma_f32_16x16x32_bf16 v[64:67], v[72:75], v[176:179], 0
  v_mfma_f32_16x16x32_bf16 v[68:71], v[76:79], v[176:179], 0
  ds_read_b128 v[72:75], v7 offset:3072
  ds_read_b128 v[76:79], v7 offset:23552
  s_waitcnt lgkmcnt(4)
  v_mfma_f32_16x16x32_bf16 v[32:35], a[4:7], v[80:83], v[32:35]
  v_mfma_f32_16x16x32_bf16 v[36:39], a[4:7], v[84:87], v[36:39]
  v_mfma_f32_16x16x32_bf16 v[40:43], a[84:87], v[80:83], v[40:43]
  v_mfma_f32_16x16x32_bf16 v[44:47], a[84:87], v[84:87], v[44:47]
  v_mfma_f32_16x16x32_bf16 v[48:51], a[164:167], v[80:83], v[48:51]
  v_mfma_f32_16x16x32_bf16 v[52:55], a[164:167], v[84:87], v[52:55]
  v_mfma_f32_16x16x32_bf16 v[56:59], v[100:103], v[80:83], v[56:59]
  v_mfma_f32_16x16x32_bf16 v[60:63], v[100:103], v[84:87], v[60:63]
  v_mfma_f32_16x16x32_bf16 v[64:67], v[80:83], v[180:183], v[64:67]
  v_mfma_f32_16x16x32_bf16 v[68:71], v[84:87], v[180:183], v[68:71]
  ds_read_b128 v[80:83], v7 offset:4096
  ds_read_b128 v[84:87], v7 offset:24576
  s_waitcnt lgkmcnt(4)
  v_mfma_f32_16x16x32_bf16 v[32:35], a[8:11], v[88:91], v[32:35]
  v_mfma_f32_16x16x32_bf16 v[36:39], a[8:11], v[92:95], v[36:39]
  v_mfma_f32_16x16x32_bf16 v[40:43], a[88:91], v[88:91], v[40:43]
  v_mfma_f32_16x16x32_bf16 v[44:47], a[88:91], v[92:95], v[44:47]
  v_mfma_f32_16x16x32_bf16 v[48:51], a[168:171], v[88:91], v[48:51]
  v_mfma_f32_16x16x32_bf16 v[52:55], a[168:171], v[92:95], v[52:55]
  v_mfma_f32_16x16x32_bf16 v[56:59], v[104:107], v[88:91], v[56:59]
  v_mfma_f32_16x16x32_bf16 v[60:63], v[104:107], v[92:95], v[60:63]
  v_mfma_f32_16x16x32_bf16 v[64:67], v[88:91], v[184:187], v[64:67]
  v_mfma_f32_16x16x32_bf16 v[68:71], v[92:95], v[184:187], v[68:71]
  ds_read_b128 v[88:91], v7 offset:5120
  ds_read_b128 v[92:95], v7 offset:25600
  s_waitcnt lgkmcnt(4)
  v_mfma_f32_16x16x32_bf16 v[32:35], a[12:15], v[72:75], v[32:35]
  v_mfma_f32_16x16x32_bf16 v[36:39], a[12:15], v[76:79], v[36:39]
  v_mfma_f32_16x16x32_bf16 v[40:43], a[92:95], v[72:75], v[40:43]
  v_mfma_f32_16x16x32_bf16 v[44:47], a[92:95], v[76:79], v[44:47]
  v_mfma_f32_16x16x32_bf16 v[48:51], a[172:175], v[72:75], v[48:51]
  v_mfma_f32_16x16x32_bf16 v[52:55], a[172:175], v[76:79], v[52:55]
  v_mfma_f32_16x16x32_bf16 v[56:59], v[108:111], v[72:75], v[56:59]
  v_mfma_f32_16x16x32_bf16 v[60:63], v[108:111], v[76:79], v[60:63]
  v_mfma_f32_16x16x32_bf16 v[64:67], v[72:75], v[188:191], v[64:67]
  v_mfma_f32_16x16x32_bf16 v[68:71], v[76:79], v[188:191], v[68:71]
  ds_read_b128 v[72:75], v7 offset:6144
  ds_read_b128 v[76:79], v7 offset:26624
  s_waitcnt lgkmcnt(4)
  v_mfma_f32_16x16x32_bf16 v[32:35], a[16:19], v[80:83], v[32:35]
  v_mfma_f32_16x16x32_bf16 v[36:39], a[16:19], v[84:87], v[36:39]
  v_mfma_f32_16x16x32_bf16 v[40:43], a[96:99], v[80:83], v[40:43]
  v_mfma_f32_16x16x32_bf16 v[44:47], a[96:99], v[84:87], v[44:47]
  v_mfma_f32_16x16x32_bf16 v[48:51], a[176:179], v[80:83], v[48:51]
  v_mfma_f32_16x16x32_bf16 v[52:55], a[176:179], v[84:87], v[52:55]
  v_mfma_f32_16x16x32_bf16 v[56:59], v[112:115], v[80:83], v[56:59]
  v_mfma_f32_16x16x32_bf16 v[60:63], v[112:115], v[84:87], v[60:63]
  v_mfma_f32_16x16x32_bf16 v[64:67], v[80:83], v[192:195], v[64:67]
  v_mfma_f32_16x16x32_bf16 v[68:71], v[84:87], v[192:195], v[68:71]
  ds_read_b128 v[80:83], v7 offset:7168
  ds_read_b128 v[84:87], v7 offset:27648
  s_waitcnt lgkmcnt(4)
  v_mfma_f32_16x16x32_bf16 v[32:35], a[20:23], v[88:91], v[32:35]
  v_mfma_f32_16x16x32_bf16 v[36:39], a[20:23], v[92:95], v[36:39]
  v_mfma_f32_16x16x32_bf16 v[40:43], a[100:103], v[88:91], v[40:43]
  v_mfma_f32_16x16x32_bf16 v[44:47], a[100:103], v[92:95], v[44:47]
  v_mfma_f32_16x16x32_bf16 v[48:51], a[180:183], v[88:91], v[48:51]
  v_mfma_f32_16x16x32_bf16 v[52:55], a[180:183], v[92:95], v[52:55]
  v_mfma_f32_16x16x32_bf16 v[56:59], v[116:119], v[88:91], v[56:59]
  v_mfma_f32_16x16x32_bf16 v[60:63], v[116:119], v[92:95], v[60:63]
  v_mfma_f32_16x16x32_bf16 v[64:67], v[88:91], v[196:199], v[64:67]
  v_mfma_f32_16x16x32_bf16 v[68:71], v[92:95], v[196:199], v[68:71]
  ds_read_b128 v[88:91], v7 offset:8192
  ds_read_b128 v[92:95], v7 offset:28672
  s_waitcnt lgkmcnt(4)
  v_mfma_f32_16x16x32_bf16 v[32:35], a[24:27], v[72:75], v[32:35]
  v_mfma_f32_16x16x32_bf16 v[36:39], a[24:27], v[76:79], v[36:39]
  v_mfma_f32_16x16x32_bf16 v[40:43], a[104:107], v[72:75], v[40:43]
  v_mfma_f32_16x16x32_bf16 v[44:47], a[104:107], v[76:79], v[44:47]
  v_mfma_f32_16x16x32_bf16 v[48:51], a[184:187], v[72:75], v[48:51]
  v_mfma_f32_16x16x32_bf16 v[52:55], a[184:187], v[76:79], v[52:55]
  v_mfma_f32_16x16x32_bf16 v[56:59], v[120:123], v[72:75], v[56:59]
  v_mfma_f32_16x16x32_bf16 v[60:63], v[120:123], v[76:79], v[60:63]
  v_mfma_f32_16x16x32_bf16 v[64:67], v[72:75], v[200:203], v[64:67]
  v_mfma_f32_16x16x32_bf16 v[68:71], v[76:79], v[200:203], v[68:71]
  ds_read_b128 v[72:75], v7 offset:9216
  ds_read_b128 v[76:79], v7 offset:29696
  s_waitcnt lgkmcnt(4)
  v_mfma_f32_16x16x32_bf16 v[32:35], a[28:31], v[80:83], v[32:35]
  v_mfma_f32_16x16x32_bf16 v[36:39], a[28:31], v[84:87], v[36:39]
  v_mfma_f32_16x16x32_bf16 v[40:43], a[108:111], v[80:83], v[40:43]
  v_mfma_f32_16x16x32_bf16 v[44:47], a[108:111], v[84:87], v[44:47]
  v_mfma_f32_16x16x32_bf16 v[48:51], a[188:191], v[80:83], v[48:51]
  v_mfma_f32_16x16x32_bf16 v[52:55], a[188:191], v[84:87], v[52:55]
  v_mfma_f32_16x16x32_bf16 v[56:59], v[124:127], v[80:83], v[56:59]
  v_mfma_f32_16x16x32_bf16 v[60:63], v[124:127], v[84:87], v[60:63]
  v_mfma_f32_16x16x32_bf16 v[64:67], v[80:83], v[204:207], v[64:67]
  v_mfma_f32_16x16x32_bf16 v[68:71], v[84:87], v[204:207], v[68:71]
  ds_read_b128 v[80:83], v7 offset:10240
  ds_read_b128 v[84:87], v7 offset:30720
  s_waitcnt lgkmcnt(4)
  v_mfma_f32_16x16x32_bf16 v[32:35], a[32:35], v[88:91], v[32:35]
  v_mfma_f32_16x16x32_bf16 v[36:39], a[32:35], v[92:95], v[36:39]
  v_mfma_f32_16x16x32_bf16 v[40:43], a[112:115], v[88:91], v[40:43]
  v_mfma_f32_16x16x32_bf16 v[44:47], a[112:115], v[92:95], v[44:47]
  v_mfma_f32_16x16x32_bf16 v[48:51], a[192:195], v[88:91], v[48:51]
  v_mfma_f32_16x16x32_bf16 v[52:55], a[192:195], v[92:95], v[52:55]
  v_mfma_f32_16x16x32_bf16 v[56:59], v[128:131], v[88:91], v[56:59]
  v_mfma_f32_16x16x32_bf16 v[60:63], v[128:131], v[92:95], v[60:63]
  v_mfma_f32_16x16x32_bf16 v[64:67], v[88:91], v[208:211], v[64:67]
  v_mfma_f32_16x16x32_bf16 v[68:71], v[92:95], v[208:211], v[68:71]
  ds_read_b128 v[88:91], v7 offset:11264
  ds_read_b128 v[92:95], v7 offset:31744
  s_waitcnt lgkmcnt(4)
  v_mfma_f32_16x16x32_bf16 v[32:35], a[36:39], v[72:75], v[32:35]
  v_mfma_f32_16x16x32_bf16 v[36:39], a[36:39], v[76:79], v[36:39]
  v_mfma_f32_16x16x32_bf16 v[40:43], a[116:119], v[72:75], v[40:43]
  v_mfma_f32_16x16x32_bf16 v[44:47], a[116:119], v[76:79], v[44:47]
  v_mfma_f32_16x16x32_bf16 v[48:51], a[196:199], v[72:75], v[48:51]
  v_mfma_f32_16x16x32_bf16 v[52:55], a[196:199], v[76:79], v[52:55]
  v_mfma_f32_16x16x32_bf16 v[56:59], v[132:135], v[72:75], v[56:59]
  v_mfma_f32_16x16x32_bf16 v[60:63], v[132:135], v[76:79], v[60:63]
  v_mfma_f32_16x16x32_bf16 v[64:67], v[72:75], v[212:215], v[64:67]
  v_mfma_f32_16x16x32_bf16 v[68:71], v[76:79], v[212:215], v[68:71]
  ds_read_b128 v[72:75], v7 offset:12288
  ds_read_b128 v[76:79], v7 offset:32768
  s_waitcnt lgkmcnt(4)
  v_mfma_f32_16x16x32_bf16 v[32:35], a[40:43], v[80:83], v[32:35]
  v_mfma_f32_16x16x32_bf16 v[36:39], a[40:43], v[84:87], v[36:39]
  v_mfma_f32_16x16x32_bf16 v[40:43], a[120:123], v[80:83], v[40:43]
  v_mfma_f32_16x16x32_bf16 v[44:47], a[120:123], v[84:87], v[44:47]
  v_mfma_f32_16x16x32_bf16 v[48:51], a[200:203], v[80:83], v[48:51]
  v_mfma_f32_16x16x32_bf16 v[52:55], a[200:203], v[84:87], v[52:55]
  v_mfma_f32_16x16x32_bf16 v[56:59], v[136:139], v[80:83], v[56:59]
  v_mfma_f32_16x16x32_bf16 v[60:63], v[136:139], v[84:87], v[60:63]
  v_mfma_f32_16x16x32_bf16 v[64:67], v[80:83], v[216:219], v[64:67]
  v_mfma_f32_16x16x32_bf16 v[68:71], v[84:87], v[216:219], v[68:71]
  ds_read_b128 v[80:83], v7 offset:13312
  ds_read_b128 v[84:87], v7 offset:33792
  s_waitcnt lgkmcnt(4)
  v_mfma_f32_16x16x32_bf16 v[32:35], a[44:47], v[88:91], v[32:35]
  v_mfma_f32_16x16x32_bf16 v[36:39], a[44:47], v[92:95], v[36:39]
  v_mfma_f32_16x16x32_bf16 v[40:43], a[124:127], v[88:91], v[40:43]
  v_mfma_f32_16x16x32_bf16 v[44:47], a[124:127], v[92:95], v[44:47]
  v_mfma_f32_16x16x32_bf16 v[48:51], a[204:207], v[88:91], v[48:51]
  v_mfma_f32_16x16x32_bf16 v[52:55], a[204:207], v[92:95], v[52:55]
  v_mfma_f32_16x16x32_bf16 v[56:59], v[140:143], v[88:91], v[56:59]
  v_mfma_f32_16x16x32_bf16 v[60:63], v[140:143], v[92:95], v[60:63]
  v_mfma_f32_16x16x32_bf16 v[64:67], v[88:91], v[220:223], v[64:67]
  v_mfma_f32_16x16x32_bf16 v[68:71], v[92:95], v[220:223], v[68:71]
  ds_read_b128 v[88:91], v7 offset:14336
  ds_read_b128 v[92:95], v7 offset:34816
  s_waitcnt lgkmcnt(4)
  v_mfma_f32_16x16x32_bf16 v[32:35], a[48:51], v[72:75], v[32:35]
  v_mfma_f32_16x16x32_bf16 v[36:39], a[48:51], v[76:79], v[36:39]
  v_mfma_f32_16x16x32_bf16 v[40:43], a[128:131], v[72:75], v[40:43]
  v_mfma_f32_16x16x32_bf16 v[44:47], a[128:131], v[76:79], v[44:47]
  v_mfma_f32_16x16x32_bf16 v[48:51], a[208:211], v[72:75], v[48:51]
  v_mfma_f32_16x16x32_bf16 v[52:55], a[208:211], v[76:79], v[52:55]
  v_mfma_f32_16x16x32_bf16 v[56:59], v[144:147], v[72:75], v[56:59]
  v_mfma_f32_16x16x32_bf16 v[60:63], v[144:147], v[76:79], v[60:63]
  v_mfma_f32_16x16x32_bf16 v[64:67], v[72:75], v[224:227], v[64:67]
  v_mfma_f32_16x16x32_bf16 v[68:71], v[76:79], v[224:227], v[68:71]
  ds_read_b128 v[72:75], v7 offset:15360
  ds_read_b128 v[76:79], v7 offset:35840
  s_waitcnt lgkmcnt(4)
  v_mfma_f32_16x16x32_bf16 v[32:35], a[52:55], v[80:83], v[32:35]
  v_mfma_f32_16x16x32_bf16 v[36:39], a[52:55], v[84:87], v[36:39]
  v_mfma_f32_16x16x32_bf16 v[40:43], a[132:135], v[80:83], v[40:43]
  v_mfma_f32_16x16x32_bf16 v[44:47], a[132:135], v[84:87], v[44:47]
  v_mfma_f32_16x16x32_bf16 v[48:51], a[212:215], v[80:83], v[48:51]
  v_mfma_f32_16x16x32_bf16 v[52:55], a[212:215], v[84:87], v[52:55]
  v_mfma_f32_16x16x32_bf16 v[56:59], v[148:151], v[80:83], v[56:59]
  v_mfma_f32_16x16x32_bf16 v[60:63], v[148:151], v[84:87], v[60:63]
  v_mfma_f32_16x16x32_bf16 v[64:67], v[80:83], v[228:231], v[64:67]
  v_mfma_f32_16x16x32_bf16 v[68:71], v[84:87], v[228:231], v[68:71]
  ds_read_b128 v[80:83], v7 offset:16384
  ds_read_b128 v[84:87], v7 offset:36864
  s_waitcnt lgkmcnt(4)
  v_mfma_f32_16x16x32_bf16 v[32:35], a[56:59], v[88:91], v[32:35]
  v_mfma_f32_16x16x32_bf16 v[36:39], a[56:59], v[92:95], v[36:39]
  v_mfma_f32_16x16x32_bf16 v[40:43], a[136:139], v[88:91], v[40:43]
  v_mfma_f32_16x16x32_bf16 v[44:47], a[136:139], v[92:95], v[44:47]
  v_mfma_f32_16x16x32_bf16 v[48:51], a[216:219], v[88:91], v[48:51]
  v_mfma_f32_16x16x32_bf16 v[52:55], a[216:219], v[92:95], v[52:55]
  v_mfma_f32_16x16x32_bf16 v[56:59], v[152:155], v[88:91], v[56:59]
  v_mfma_f32_16x16x32_bf16 v[60:63], v[152:155], v[92:95], v[60:63]
  v_mfma_f32_16x16x32_bf16 v[64:67], v[88:91], v[232:235], v[64:67]
  v_mfma_f32_16x16x32_bf16 v[68:71], v[92:95], v[232:235], v[68:71]
  ds_read_b128 v[88:91], v7 offset:17408
  ds_read_b128 v[92:95], v7 offset:37888
  s_waitcnt lgkmcnt(4)
  v_mfma_f32_16x16x32_bf16 v[32:35], a[60:63], v[72:75], v[32:35]
  v_mfma_f32_16x16x32_bf16 v[36:39], a[60:63], v[76:79], v[36:39]
  v_mfma_f32_16x16x32_bf16 v[40:43], a[140:143], v[72:75], v[40:43]
  v_mfma_f32_16x16x32_bf16 v[44:47], a[140:143], v[76:79], v[44:47]
  v_mfma_f32_16x16x32_bf16 v[48:51], a[220:223], v[72:75], v[48:51]
  v_mfma_f32_16x16x32_bf16 v[52:55], a[220:223], v[76:79], v[52:55]
  v_mfma_f32_16x16x32_bf16 v[56:59], v[156:159], v[72:75], v[56:59]
  v_mfma_f32_16x16x32_bf16 v[60:63], v[156:159], v[76:79], v[60:63]
  v_mfma_f32_16x16x32_bf16 v[64:67], v[72:75], v[236:239], v[64:67]
  v_mfma_f32_16x16x32_bf16 v[68:71], v[76:79], v[236:239], v[68:71]
  ds_read_b128 v[72:75], v7 offset:18432
  ds_read_b128 v[76:79], v7 offset:38912
  s_waitcnt lgkmcnt(4)
  v_mfma_f32_16x16x32_bf16 v[32:35], a[64:67], v[80:83], v[32:35]
  v_mfma_f32_16x16x32_bf16 v[36:39], a[64:67], v[84:87], v[36:39]
  v_mfma_f32_16x16x32_bf16 v[40:43], a[144:147], v[80:83], v[40:43]
  v_mfma_f32_16x16x32_bf16 v[44:47], a[144:147], v[84:87], v[44:47]
  v_mfma_f32_16x16x32_bf16 v[48:51], a[224:227], v[80:83], v[48:51]
  v_mfma_f32_16x16x32_bf16 v[52:55], a[224:227], v[84:87], v[52:55]
  v_mfma_f32_16x16x32_bf16 v[56:59], v[160:163], v[80:83], v[56:59]
  v_mfma_f32_16x16x32_bf16 v[60:63], v[160:163], v[84:87], v[60:63]
  v_mfma_f32_16x16x32_bf16 v[64:67], v[80:83], v[240:243], v[64:67]
  v_mfma_f32_16x16x32_bf16 v[68:71], v[84:87], v[240:243], v[68:71]
  ds_read_b128 v[80:83], v7 offset:19456
  ds_read_b128 v[84:87], v7 offset:39936
  s_waitcnt lgkmcnt(4)
  v_mfma_f32_16x16x32_bf16 v[32:35], a[68:71], v[88:91], v[32:35]
  v_mfma_f32_16x16x32_bf16 v[36:39], a[68:71], v[92:95], v[36:39]
  v_mfma_f32_16x16x32_bf16 v[40:43], a[148:151], v[88:91], v[40:43]
  v_mfma_f32_16x16x32_bf16 v[44:47], a[148:151], v[92:95], v[44:47]
  v_mfma_f32_16x16x32_bf16 v[48:51], a[228:231], v[88:91], v[48:51]
  v_mfma_f32_16x16x32_bf16 v[52:55], a[228:231], v[92:95], v[52:55]
  v_mfma_f32_16x16x32_bf16 v[56:59], v[164:167], v[88:91], v[56:59]
  v_mfma_f32_16x16x32_bf16 v[60:63], v[164:167], v[92:95], v[60:63]
  v_mfma_f32_16x16x32_bf16 v[64:67], v[88:91], v[244:247], v[64:67]
  v_mfma_f32_16x16x32_bf16 v[68:71], v[92:95], v[244:247], v[68:71]
  s_waitcnt lgkmcnt(2)
  v_mfma_f32_16x16x32_bf16 v[32:35], a[72:75], v[72:75], v[32:35]
  v_mfma_f32_16x16x32_bf16 v[36:39], a[72:75], v[76:79], v[36:39]
  v_mfma_f32_16x16x32_bf16 v[40:43], a[152:155], v[72:75], v[40:43]
  v_mfma_f32_16x16x32_bf16 v[44:47], a[152:155], v[76:79], v[44:47]
  v_mfma_f32_16x16x32_bf16 v[48:51], a[232:235], v[72:75], v[48:51]
  v_mfma_f32_16x16x32_bf16 v[52:55], a[232:235], v[76:79], v[52:55]
  v_mfma_f32_16x16x32_bf16 v[56:59], v[168:171], v[72:75], v[56:59]
  v_mfma_f32_16x16x32_bf16 v[60:63], v[168:171], v[76:79], v[60:63]
  v_mfma_f32_16x16x32_bf16 v[64:67], v[72:75], v[248:251], v[64:67]
  v_mfma_f32_16x16x32_bf16 v[68:71], v[76:79], v[248:251], v[68:71]
  s_waitcnt lgkmcnt(0)
  v_mfma_f32_16x16x32_bf16 v[32:35], a[76:79], v[80:83], v[32:35]
  v_mfma_f32_16x16x32_bf16 v[36:39], a[76:79], v[84:87], v[36:39]
  v_mfma_f32_16x16x32_bf16 v[40:43], a[156:159], v[80:83], v[40:43]
  v_mfma_f32_16x16x32_bf16 v[44:47], a[156:159], v[84:87], v[44:47]
  v_mfma_f32_16x16x32_bf16 v[48:51], a[236:239], v[80:83], v[48:51]
  v_mfma_f32_16x16x32_bf16 v[52:55], a[236:239], v[84:87], v[52:55]
  v_mfma_f32_16x16x32_bf16 v[56:59], v[172:175], v[80:83], v[56:59]
  v_mfma_f32_16x16x32_bf16 v[60:63], v[172:175], v[84:87], v[60:63]
  v_mfma_f32_16x16x32_bf16 v[64:67], v[80:83], v[252:255], v[64:67]
  v_mfma_f32_16x16x32_bf16 v[68:71], v[84:87], v[252:255], v[68:71]
  v_cvt_pk_bf16_f32 v8, v32, v33
  v_cvt_pk_bf16_f32 v9, v34, v35
  v_cvt_pk_bf16_f32 v10, v40, v41
  v_cvt_pk_bf16_f32 v11, v42, v43
  s_add_u32 s34, s21, 0
  buffer_store_dwordx4 v[8:11], v1, s[4:7], s34 offen sc1
  v_cvt_pk_bf16_f32 v12, v36, v37
  v_cvt_pk_bf16_f32 v13, v38, v39
  v_cvt_pk_bf16_f32 v14, v44, v45
  v_cvt_pk_bf16_f32 v15, v46, v47
  s_add_u32 s34, s21, 6144
  buffer_store_dwordx4 v[12:15], v1, s[4:7], s34 offen sc1
  v_cvt_pk_bf16_f32 v8, v48, v49
  v_cvt_pk_bf16_f32 v9, v50, v51
  v_cvt_pk_bf16_f32 v10, v56, v57
  v_cvt_pk_bf16_f32 v11, v58, v59
  s_add_u32 s34, s21, 1024
  buffer_store_dwordx4 v[8:11], v1, s[4:7], s34 offen sc1
  v_cvt_pk_bf16_f32 v12, v52, v53
  v_cvt_pk_bf16_f32 v13, v54, v55
  v_cvt_pk_bf16_f32 v14, v60, v61
  v_cvt_pk_bf16_f32 v15, v62, v63
  s_add_u32 s34, s21, 7168
  buffer_store_dwordx4 v[12:15], v1, s[4:7], s34 offen sc1
  v_cvt_pk_bf16_f32 v8, v64, v65
  v_cvt_pk_bf16_f32 v9, v66, v67
  v_cvt_pk_bf16_f32 v10, v68, v69
  v_cvt_pk_bf16_f32 v11, v70, v71
  s_add_u32 s34, s23, 0
  buffer_store_dwordx4 v[8:11], v1, s[4:7], s34 offen sc1
  s_waitcnt vmcnt(0)
  s_barrier
  s_add_u32 s17, s17, 1
  v_mov_b32 v28, s17
  buffer_store_dword v28, v4, s[4:7], s24 offen sc1
  s_cmp_lt_u32 s17, 64
  s_cbranch_scc1 reca_ptop238
  s_branch reca_exit1
reca_pw1_227:
  s_mov_b32 s17, 0
  s_mov_b32 s26, 0
  s_mul_i32 s20, s17, 40960
  s_add_u32 s20, s20, 84944896
  s_add_u32 m0, s26, 10240
  s_nop 0
  buffer_load_dwordx4 v1, s[4:7], s20 offen offset:0 lds
  buffer_load_dwordx4 v1, s[4:7], s20 offen offset:1024 lds
  buffer_load_dwordx4 v1, s[4:7], s20 offen offset:2048 lds
  buffer_load_dwordx4 v1, s[4:7], s20 offen offset:3072 lds
  s_add_u32 s20, s20, 4096
  s_add_u32 m0, s26, 14336
  s_nop 0
  buffer_load_dwordx4 v1, s[4:7], s20 offen offset:0 lds
  buffer_load_dwordx4 v1, s[4:7], s20 offen offset:1024 lds
  buffer_load_dwordx4 v1, s[4:7], s20 offen offset:2048 lds
  buffer_load_dwordx4 v1, s[4:7], s20 offen offset:3072 lds
  s_add_u32 s20, s20, 4096
  s_add_u32 m0, s26, 18432
  s_nop 0
  buffer_load_dwordx4 v1, s[4:7], s20 offen offset:0 lds
  buffer_load_dwordx4 v1, s[4:7], s20 offen offset:1024 lds
  s_mul_i32 s34, s15, 12
  s_mul_i32 s35, s16, 6
  s_add_u32 s34, s34, s35
  s_add_u32 s34, s34, 4
  s_mul_i32 s34, s34, 20480
  s_add_u32 s34, s34, 14155776
  buffer_load_dwordx4 a[0:3], v1, s[4:7], s34 offen offset:0
  buffer_load_dwordx4 a[4:7], v1, s[4:7], s34 offen offset:1024
  buffer_load_dwordx4 a[8:11], v1, s[4:7], s34 offen offset:2048
  buffer_load_dwordx4 a[12:15], v1, s[4:7], s34 offen offset:3072
  s_add_u32 s34, s34, 4096
  buffer_load_dwordx4 a[16:19], v1, s[4:7], s34 offen offset:0
  buffer_load_dwordx4 a[20:23], v1, s[4:7], s34 offen offset:1024
  buffer_load_dwordx4 a[24:27], v1, s[4:7], s34 offen offset:2048
  buffer_load_dwordx4 a[28:31], v1, s[4:7], s34 offen offset:3072
  s_add_u32 s34, s34, 4096
  buffer_load_dwordx4 a[32:35], v1, s[4:7], s34 offen offset:0
  buffer_load_dwordx4 a[36:39], v1, s[4:7], s34 offen offset:1024
  buffer_load_dwordx4 a[40:43], v1, s[4:7], s34 offen offset:2048
  buffer_load_dwordx4 a[44:47], v1, s[4:7], s34 offen offset:3072
  s_add_u32 s34, s34, 4096
  buffer_load_dwordx4 a[48:51], v1, s[4:7], s34 offen offset:0
  buffer_load_dwordx4 a[52:55], v1, s[4:7], s34 offen offset:1024
  buffer_load_dwordx4 a[56:59], v1, s[4:7], s34 offen offset:2048
  buffer_load_dwordx4 a[60:63], v1, s[4:7], s34 offen offset:3072
  s_add_u32 s34, s34, 4096
  buffer_load_dwordx4 a[64:67], v1, s[4:7], s34 offen offset:0
  buffer_load_dwordx4 a[68:71], v1, s[4:7], s34 offen offset:1024
  buffer_load_dwordx4 a[72:75], v1, s[4:7], s34 offen offset:2048
  buffer_load_dwordx4 a[76:79], v1, s[4:7], s34 offen offset:3072
  s_mul_i32 s34, s15, 12
  s_mul_i32 s35, s16, 6
  s_add_u32 s34, s34, s35
  s_add_u32 s34, s34, 5
  s_mul_i32 s34, s34, 20480
  s_add_u32 s34, s34, 14155776
  buffer_load_dwordx4 a[80:83], v1, s[4:7], s34 offen offset:0
  buffer_load_dwordx4 a[84:87], v1, s[4:7], s34 offen offset:1024
  buffer_load_dwordx4 a[88:91], v1, s[4:7], s34 offen offset:2048
  buffer_load_dwordx4 a[92:95], v1, s[4:7], s34 offen offset:3072
  s_add_u32 s34, s34, 4096
  buffer_load_dwordx4 a[96:99], v1, s[4:7], s34 offen offset:0
  buffer_load_dwordx4 a[100:103], v1, s[4:7], s34 offen offset:1024
  buffer_load_dwordx4 a[104:107], v1, s[4:7], s34 offen offset:2048
  buffer_load_dwordx4 a[108:111], v1, s[4:7], s34 offen offset:3072
  s_add_u32 s34, s34, 4096
  buffer_load_dwordx4 a[112:115], v1, s[4:7], s34 offen offset:0
  buffer_load_dwordx4 a[116:119], v1, s[4:7], s34 offen offset:1024
  buffer_load_dwordx4 a[120:123], v1, s[4:7], s34 offen offset:2048
  buffer_load_dwordx4 a[124:127], v1, s[4:7], s34 offen offset:3072
  s_add_u32 s34, s34, 4096
  buffer_load_dwordx4 a[128:131], v1, s[4:7], s34 offen offset:0
  buffer_load_dwordx4 a[132:135], v1, s[4:7], s34 offen offset:1024
  buffer_load_dwordx4 a[136:139], v1, s[4:7], s34 offen offset:2048
  buffer_load_dwordx4 a[140:143], v1, s[4:7], s34 offen offset:3072
  s_add_u32 s34, s34, 4096
  buffer_load_dwordx4 a[144:147], v1, s[4:7], s34 offen offset:0
  buffer_load_dwordx4 a[148:151], v1, s[4:7], s34 offen offset:1024
  buffer_load_dwordx4 a[152:155], v1, s[4:7], s34 offen offset:2048
  buffer_load_dwordx4 a[156:159], v1, s[4:7], s34 offen offset:3072
  s_waitcnt vmcnt(20)
  s_mul_i32 s34, s15, 12
  s_mul_i32 s35, s16, 6
  s_add_u32 s34, s34, s35
  s_add_u32 s34, s34, 1
  s_mul_i32 s34, s34, 20480
  s_add_u32 s34, s34, 22020096
  buffer_load_dwordx4 a[160:163], v1, s[4:7], s34 offen offset:0
  buffer_load_dwordx4 a[164:167], v1, s[4:7], s34 offen offset:1024
  buffer_load_dwordx4 a[168:171], v1, s[4:7], s34 offen offset:2048
  buffer_load_dwordx4 a[172:175], v1, s[4:7], s34 offen offset:3072
  s_add_u32 s34, s34, 4096
  buffer_load_dwordx4 a[176:179], v1, s[4:7], s34 offen offset:0
  buffer_load_dwordx4 a[180:183], v1, s[4:7], s34 offen offset:1024
  buffer_load_dwordx4 a[184:187], v1, s[4:7], s34 offen offset:2048
  buffer_load_dwordx4 a[188:191], v1, s[4:7], s34 offen offset:3072
  s_add_u32 s34, s34, 4096
  buffer_load_dwordx4 a[192:195], v1, s[4:7], s34 offen offset:0
  buffer_load_dwordx4 a[196:199], v1, s[4:7], s34 offen offset:1024
  buffer_load_dwordx4 a[200:203], v1, s[4:7], s34 offen offset:2048
  buffer_load_dwordx4 a[204:207], v1, s[4:7], s34 offen offset:3072
  s_add_u32 s34, s34, 4096
  buffer_load_dwordx4 a[208:211], v1, s[4:7], s34 offen offset:0
  buffer_load_dwordx4 a[212:215], v1, s[4:7], s34 offen offset:1024
  buffer_load_dwordx4 a[216:219], v1, s[4:7], s34 offen offset:2048
  buffer_load_dwordx4 a[220:223], v1, s[4:7], s34 offen offset:3072
  s_add_u32 s34, s34, 4096
  buffer_load_dwordx4 a[224:227], v1, s[4:7], s34 offen offset:0
  buffer_load_dwordx4 a[228:231], v1, s[4:7], s34 offen offset:1024
  buffer_load_dwordx4 a[232:235], v1, s[4:7], s34 offen offset:2048
  buffer_load_dwordx4 a[236:239], v1, s[4:7], s34 offen offset:3072
  s_waitcnt vmcnt(20)
  s_mul_i32 s34, s15, 12
  s_mul_i32 s35, s16, 6
  s_add_u32 s34, s34, s35
  s_add_u32 s34, s34, 2
  s_mul_i32 s34, s34, 20480
  s_add_u32 s34, s34, 22020096
  buffer_load_dwordx4 v[96:99], v1, s[4:7], s34 offen offset:0
  buffer_load_dwordx4 v[100:103], v1, s[4:7], s34 offen offset:1024
  buffer_load_dwordx4 v[104:107], v1, s[4:7], s34 offen offset:2048
  buffer_load_dwordx4 v[108:111], v1, s[4:7], s34 offen offset:3072
  s_add_u32 s34, s34, 4096
  buffer_load_dwordx4 v[112:115], v1, s[4:7], s34 offen offset:0
  buffer_load_dwordx4 v[116:119], v1, s[4:7], s34 offen offset:1024
  buffer_load_dwordx4 v[120:123], v1, s[4:7], s34 offen offset:2048
  buffer_load_dwordx4 v[124:127], v1, s[4:7], s34 offen offset:3072
  s_add_u32 s34, s34, 4096
  buffer_load_dwordx4 v[128:131], v1, s[4:7], s34 offen offset:0
  buffer_load_dwordx4 v[132:135], v1, s[4:7], s34 offen offset:1024
  buffer_load_dwordx4 v[136:139], v1, s[4:7], s34 offen offset:2048
  buffer_load_dwordx4 v[140:143], v1, s[4:7], s34 offen offset:3072
  s_add_u32 s34, s34, 4096
  buffer_load_dwordx4 v[144:147], v1, s[4:7], s34 offen offset:0
  buffer_load_dwordx4 v[148:151], v1, s[4:7], s34 offen offset:1024
  buffer_load_dwordx4 v[152:155], v1, s[4:7], s34 offen offset:2048
  buffer_load_dwordx4 v[156:159], v1, s[4:7], s34 offen offset:3072
  s_add_u32 s34, s34, 4096
  buffer_load_dwordx4 v[160:163], v1, s[4:7], s34 offen offset:0
  buffer_load_dwordx4 v[164:167], v1, s[4:7], s34 offen offset:1024
  buffer_load_dwordx4 v[168:171], v1, s[4:7], s34 offen offset:2048
  buffer_load_dwordx4 v[172:175], v1, s[4:7], s34 offen offset:3072
  s_waitcnt vmcnt(20)
  s_mul_i32 s34, s15, 12
  s_mul_i32 s35, s16, 6
  s_add_u32 s34, s34, s35
  s_add_u32 s34, s34, 3
  s_mul_i32 s34, s34, 20480
  s_add_u32 s34, s34, 22020096
  buffer_load_dwordx4 v[176:179], v1, s[4:7], s34 offen offset:0
  buffer_load_dwordx4 v[180:183], v1, s[4:7], s34 offen offset:1024
  buffer_load_dwordx4 v[184:187], v1, s[4:7], s34 offen offset:2048
  buffer_load_dwordx4 v[188:191], v1, s[4:7], s34 offen offset:3072
  s_add_u32 s34, s34, 4096
  buffer_load_dwordx4 v[192:195], v1, s[4:7], s34 offen offset:0
  buffer_load_dwordx4 v[196:199], v1, s[4:7], s34 offen offset:1024
  buffer_load_dwordx4 v[200:203], v1, s[4:7], s34 offen offset:2048
  buffer_load_dwordx4 v[204:207], v1, s[4:7], s34 offen offset:3072
  s_add_u32 s34, s34, 4096
  buffer_load_dwordx4 v[208:211], v1, s[4:7], s34 offen offset:0
  buffer_load_dwordx4 v[212:215], v1, s[4:7], s34 offen offset:1024
  buffer_load_dwordx4 v[216:219], v1, s[4:7], s34 offen offset:2048
  buffer_load_dwordx4 v[220:223], v1, s[4:7], s34 offen offset:3072
  s_add_u32 s34, s34, 4096
  buffer_load_dwordx4 v[224:227], v1, s[4:7], s34 offen offset:0
  buffer_load_dwordx4 v[228:231], v1, s[4:7], s34 offen offset:1024
  buffer_load_dwordx4 v[232:235], v1, s[4:7], s34 offen offset:2048
  buffer_load_dwordx4 v[236:239], v1, s[4:7], s34 offen offset:3072
  s_add_u32 s34, s34, 4096
  buffer_load_dwordx4 v[240:243], v1, s[4:7], s34 offen offset:0
  buffer_load_dwordx4 v[244:247], v1, s[4:7], s34 offen offset:1024
  buffer_load_dwordx4 v[248:251], v1, s[4:7], s34 offen offset:2048
  buffer_load_dwordx4 v[252:255], v1, s[4:7], s34 offen offset:3072
  s_waitcnt vmcnt(20)
  v_and_b32 v30, 7, v0
  v_lshlrev_b32 v30, 3, v30
reca_cens243:
  buffer_load_dwordx2 v[28:29], v30, s[8:11], 0 offen sc1
  s_waitcnt vmcnt(0)
  v_sad_u8 v31, v28, 0, 0
  v_sad_u8 v31, v29, 0, v31
  v_cmp_gt_u32 vcc, 32, v31
  s_cbranch_vccz reca_censok244
  s_sleep 8
  s_sub_u32 s18, s18, 1
  s_cbranch_scc0 reca_cens243
  s_mov_b32 s18, 0
reca_censok244:
  v_and_b32 v28, 0x20202020, v28
  v_and_b32 v29, 0x20202020, v29
  v_cmp_ne_u32 s[34:35], 0, v28
  v_cmp_ne_u32 s[36:37], 0, v29
  s_nop 3
  s_and_b32 s34, s34, 0xff
  s_and_b32 s36, s36, 0xff
  s_or_b32 s35, s34, s36
  s_lshr_b32 s37, s35, s13
  s_and_b32 s37, s37, 1
  s_xor_b32 s43, s37, 1
  s_cmp_eq_u32 s57, 0
  s_cselect_b32 s58, s36, s34
  v_mov_b32 v31, 0x80000000
  s_cmp_lg_u32 s43, 0
  s_cbranch_scc1 reca_pslow245
reca_ptop246:
  s_cmp_lt_u32 s17, 3
  s_cbranch_scc1 reca_pgo247
  s_sub_u32 s36, s17, 3
reca_ppoll248:
  buffer_load_dword v28, v4, s[4:7], s25 offen sc1
  s_waitcnt vmcnt(0)
  v_readfirstlane_b32 s34, v28
  s_nop 3
  s_cmp_ge_i32 s34, s36
  s_cbranch_scc1 reca_pgo247
  s_sleep 8
  s_sub_u32 s18, s18, 1
  s_cbranch_scc0 reca_ppoll248
  s_mov_b32 s18, 0
reca_pgo247:
  s_waitcnt vmcnt(0)
  s_barrier
  v_add_u32 v7, s26, v1
  s_xor_b32 s26, s26, 40960
  s_add_u32 s37, s17, 1
  s_cmp_ge_u32 s37, 64
  s_cbranch_scc1 reca_pnodma249
  s_mul_i32 s20, s37, 40960
  s_add_u32 s20, s20, 84944896
  s_add_u32 m0, s26, 10240
  s_nop 0
  buffer_load_dwordx4 v1, s[4:7], s20 offen offset:0 lds
  buffer_load_dwordx4 v1, s[4:7], s20 offen offset:1024 lds
  buffer_load_dwordx4 v1, s[4:7], s20 offen offset:2048 lds
  buffer_load_dwordx4 v1, s[4:7], s20 offen offset:3072 lds
  s_add_u32 s20, s20, 4096
  s_add_u32 m0, s26, 14336
  s_nop 0
  buffer_load_dwordx4 v1, s[4:7], s20 offen offset:0 lds
  buffer_load_dwordx4 v1, s[4:7], s20 offen offset:1024 lds
  buffer_load_dwordx4 v1, s[4:7], s20 offen offset:2048 lds
  buffer_load_dwordx4 v1, s[4:7], s20 offen offset:3072 lds
  s_add_u32 s20, s20, 4096
  s_add_u32 m0, s26, 18432
  s_nop 0
  buffer_load_dwordx4 v1, s[4:7], s20 offen offset:0 lds
  buffer_load_dwordx4 v1, s[4:7], s20 offen offset:1024 lds
reca_pnodma249:
  s_lshl_b32 s34, s15, 3
  s_and_b32 s35, s17, 7
  s_add_u32 s34, s34, s35
  s_mul_i32 s34, s34, 12288
  s_mul_i32 s35, s16, 3072
  s_add_u32 s35, s35, s34
  s_add_u32 s21, s35, 37748736
  s_add_u32 s22, s35, 44040192
  s_mul_i32 s35, s16, 6144
  s_add_u32 s35, s35, s34
  s_add_u32 s23, s35, 40894464
  ds_read_b128 v[72:75], v7 offset:0
  ds_read_b128 v[76:79], v7 offset:20480
  ds_read_b128 v[80:83], v7 offset:1024
  ds_read_b128 v[84:87], v7 offset:21504
  ds_read_b128 v[88:91], v7 offset:2048
  ds_read_b128 v[92:95], v7 offset:22528
  s_waitcnt lgkmcnt(4)
  v_mfma_f32_16x16x32_bf16 v[32:35], a[0:3], v[72:75], 0
  v_mfma_f32_16x16x32_bf16 v[36:39], a[0:3], v[76:79], 0
  v_mfma_f32_16x16x32_bf16 v[40:43], a[80:83], v[72:75], 0
  v_mfma_f32_16x16x32_bf16 v[44:47], a[80:83], v[76:79], 0
  v_mfma_f32_16x16x32_bf16 v[48:51], v[72:75], a[160:163], 0
  v_mfma_f32_16x16x32_bf16 v[52:55], v[76:79], a[160:163], 0
  v_mfma_f32_16x16x32_bf16 v[56:59], v[72:75], v[96:99], 0
  v_mfma_f32_16x16x32_bf16 v[60:63], v[76:79], v[96:99], 0
  v_mfma_f32_16x16x32_bf16 v[64:67], v[72:75], v[176:179], 0
  v_mfma_f32_16x16x32_bf16 v[68:71], v[76:79], v[176:179], 0
  ds_read_b128 v[72:75], v7 offset:3072
  ds_read_b128 v[76:79], v7 offset:23552
  s_waitcnt lgkmcnt(4)
  v_mfma_f32_16x16x32_bf16 v[32:35], a[4:7], v[80:83], v[32:35]
  v_mfma_f32_16x16x32_bf16 v[36:39], a[4:7], v[84:87], v[36:39]
  v_mfma_f32_16x16x32_bf16 v[40:43], a[84:87], v[80:83], v[40:43]
  v_mfma_f32_16x16x32_bf16 v[44:47], a[84:87], v[84:87], v[44:47]
  v_mfma_f32_16x16x32_bf16 v[48:51], v[80:83], a[164:167], v[48:51]
  v_mfma_f32_16x16x32_bf16 v[52:55], v[84:87], a[164:167], v[52:55]
  v_mfma_f32_16x16x32_bf16 v[56:59], v[80:83], v[100:103], v[56:59]
  v_mfma_f32_16x16x32_bf16 v[60:63], v[84:87], v[100:103], v[60:63]
  v_mfma_f32_16x16x32_bf16 v[64:67], v[80:83], v[180:183], v[64:67]
  v_mfma_f32_16x16x32_bf16 v[68:71], v[84:87], v[180:183], v[68:71]
  ds_read_b128 v[80:83], v7 offset:4096
  ds_read_b128 v[84:87], v7 offset:24576
  s_waitcnt lgkmcnt(4)
  v_mfma_f32_16x16x32_bf16 v[32:35], a[8:11], v[88:91], v[32:35]
  v_mfma_f32_16x16x32_bf16 v[36:39], a[8:11], v[92:95], v[36:39]
  v_mfma_f32_16x16x32_bf16 v[40:43], a[88:91], v[88:91], v[40:43]
  v_mfma_f32_16x16x32_bf16 v[44:47], a[88:91], v[92:95], v[44:47]
  v_mfma_f32_16x16x32_bf16 v[48:51], v[88:91], a[168:171], v[48:51]
  v_mfma_f32_16x16x32_bf16 v[52:55], v[92:95], a[168:171], v[52:55]
  v_mfma_f32_16x16x32_bf16 v[56:59], v[88:91], v[104:107], v[56:59]
  v_mfma_f32_16x16x32_bf16 v[60:63], v[92:95], v[104:107], v[60:63]
  v_mfma_f32_16x16x32_bf16 v[64:67], v[88:91], v[184:187], v[64:67]
  v_mfma_f32_16x16x32_bf16 v[68:71], v[92:95], v[184:187], v[68:71]
  ds_read_b128 v[88:91], v7 offset:5120
  ds_read_b128 v[92:95], v7 offset:25600
  s_waitcnt lgkmcnt(4)
  v_mfma_f32_16x16x32_bf16 v[32:35], a[12:15], v[72:75], v[32:35]
  v_mfma_f32_16x16x32_bf16 v[36:39], a[12:15], v[76:79], v[36:39]
  v_mfma_f32_16x16x32_bf16 v[40:43], a[92:95], v[72:75], v[40:43]
  v_mfma_f32_16x16x32_bf16 v[44:47], a[92:95], v[76:79], v[44:47]
  v_mfma_f32_16x16x32_bf16 v[48:51], v[72:75], a[172:175], v[48:51]
  v_mfma_f32_16x16x32_bf16 v[52:55], v[76:79], a[172:175], v[52:55]
  v_mfma_f32_16x16x32_bf16 v[56:59], v[72:75], v[108:111], v[56:59]
  v_mfma_f32_16x16x32_bf16 v[60:63], v[76:79], v[108:111], v[60:63]
  v_mfma_f32_16x16x32_bf16 v[64:67], v[72:75], v[188:191], v[64:67]
  v_mfma_f32_16x16x32_bf16 v[68:71], v[76:79], v[188:191], v[68:71]
  ds_read_b128 v[72:75], v7 offset:6144
  ds_read_b128 v[76:79], v7 offset:26624
  s_waitcnt lgkmcnt(4)
  v_mfma_f32_16x16x32_bf16 v[32:35], a[16:19], v[80:83], v[32:35]
  v_mfma_f32_16x16x32_bf16 v[36:39], a[16:19], v[84:87], v[36:39]
  v_mfma_f32_16x16x32_bf16 v[40:43], a[96:99], v[80:83], v[40:43]
  v_mfma_f32_16x16x32_bf16 v[44:47], a[96:99], v[84:87], v[44:47]
  v_mfma_f32_16x16x32_bf16 v[48:51], v[80:83], a[176:179], v[48:51]
  v_mfma_f32_16x16x32_bf16 v[52:55], v[84:87], a[176:179], v[52:55]
  v_mfma_f32_16x16x32_bf16 v[56:59], v[80:83], v[112:115], v[56:59]
  v_mfma_f32_16x16x32_bf16 v[60:63], v[84:87], v[112:115], v[60:63]
  v_mfma_f32_16x16x32_bf16 v[64:67], v[80:83], v[192:195], v[64:67]
  v_mfma_f32_16x16x32_bf16 v[68:71], v[84:87], v[192:195], v[68:71]
  ds_read_b128 v[80:83], v7 offset:7168
  ds_read_b128 v[84:87], v7 offset:27648
  s_waitcnt lgkmcnt(4)
  v_mfma_f32_16x16x32_bf16 v[32:35], a[20:23], v[88:91], v[32:35]
  v_mfma_f32_16x16x32_bf16 v[36:39], a[20:23], v[92:95], v[36:39]
  v_mfma_f32_16x16x32_bf16 v[40:43], a[100:103], v[88:91], v[40:43]
  v_mfma_f32_16x16x32_bf16 v[44:47], a[100:103], v[92:95], v[44:47]
  v_mfma_f32_16x16x32_bf16 v[48:51], v[88:91], a[180:183], v[48:51]
  v_mfma_f32_16x16x32_bf16 v[52:55], v[92:95], a[180:183], v[52:55]
  v_mfma_f32_16x16x32_bf16 v[56:59], v[88:91], v[116:119], v[56:59]
  v_mfma_f32_16x16x32_bf16 v[60:63], v[92:95], v[116:119], v[60:63]
  v_mfma_f32_16x16x32_bf16 v[64:67], v[88:91], v[196:199], v[64:67]
  v_mfma_f32_16x16x32_bf16 v[68:71], v[92:95], v[196:199], v[68:71]
  ds_read_b128 v[88:91], v7 offset:8192
  ds_read_b128 v[92:95], v7 offset:28672
  s_waitcnt lgkmcnt(4)
  v_mfma_f32_16x16x32_bf16 v[32:35], a[24:27], v[72:75], v[32:35]
  v_mfma_f32_16x16x32_bf16 v[36:39], a[24:27], v[76:79], v[36:39]
  v_mfma_f32_16x16x32_bf16 v[40:43], a[104:107], v[72:75], v[40:43]
  v_mfma_f32_16x16x32_bf16 v[44:47], a[104:107], v[76:79], v[44:47]
  v_mfma_f32_16x16x32_bf16 v[48:51], v[72:75], a[184:187], v[48:51]
  v_mfma_f32_16x16x32_bf16 v[52:55], v[76:79], a[184:187], v[52:55]
  v_mfma_f32_16x16x32_bf16 v[56:59], v[72:75], v[120:123], v[56:59]
  v_mfma_f32_16x16x32_bf16 v[60:63], v[76:79], v[120:123], v[60:63]
  v_mfma_f32_16x16x32_bf16 v[64:67], v[72:75], v[200:203], v[64:67]
  v_mfma_f32_16x16x32_bf16 v[68:71], v[76:79], v[200:203], v[68:71]
  ds_read_b128 v[72:75], v7 offset:9216
  ds_read_b128 v[76:79], v7 offset:29696
  s_waitcnt lgkmcnt(4)
  v_mfma_f32_16x16x32_bf16 v[32:35], a[28:31], v[80:83], v[32:35]
  v_mfma_f32_16x16x32_bf16 v[36:39], a[28:31], v[84:87], v[36:39]
  v_mfma_f32_16x16x32_bf16 v[40:43], a[108:111], v[80:83], v[40:43]
  v_mfma_f32_16x16x32_bf16 v[44:47], a[108:111], v[84:87], v[44:47]
  v_mfma_f32_16x16x32_bf16 v[48:51], v[80:83], a[188:191], v[48:51]
  v_mfma_f32_16x16x32_bf16 v[52:55], v[84:87], a[188:191], v[52:55]
  v_mfma_f32_16x16x32_bf16 v[56:59], v[80:83], v[124:127], v[56:59]
  v_mfma_f32_16x16x32_bf16 v[60:63], v[84:87], v[124:127], v[60:63]
  v_mfma_f32_16x16x32_bf16 v[64:67], v[80:83], v[204:207], v[64:67]
  v_mfma_f32_16x16x32_bf16 v[68:71], v[84:87], v[204:207], v[68:71]
  ds_read_b128 v[80:83], v7 offset:10240
  ds_read_b128 v[84:87], v7 offset:30720
  s_waitcnt lgkmcnt(4)
  v_mfma_f32_16x16x32_bf16 v[32:35], a[32:35], v[88:91], v[32:35]
  v_mfma_f32_16x16x32_bf16 v[36:39], a[32:35], v[92:95], v[36:39]
  v_mfma_f32_16x16x32_bf16 v[40:43], a[112:115], v[88:91], v[40:43]
  v_mfma_f32_16x16x32_bf16 v[44:47], a[112:115], v[92:95], v[44:47]
  v_mfma_f32_16x16x32_bf16 v[48:51], v[88:91], a[192:195], v[48:51]
  v_mfma_f32_16x16x32_bf16 v[52:55], v[92:95], a[192:195], v[52:55]
  v_mfma_f32_16x16x32_bf16 v[56:59], v[88:91], v[128:131], v[56:59]
  v_mfma_f32_16x16x32_bf16 v[60:63], v[92:95], v[128:131], v[60:63]
  v_mfma_f32_16x16x32_bf16 v[64:67], v[88:91], v[208:211], v[64:67]
  v_mfma_f32_16x16x32_bf16 v[68:71], v[92:95], v[208:211], v[68:71]
  ds_read_b128 v[88:91], v7 offset:11264
  ds_read_b128 v[92:95], v7 offset:31744
  s_waitcnt lgkmcnt(4)
  v_mfma_f32_16x16x32_bf16 v[32:35], a[36:39], v[72:75], v[32:35]
  v_mfma_f32_16x16x32_bf16 v[36:39], a[36:39], v[76:79], v[36:39]
  v_mfma_f32_16x16x32_bf16 v[40:43], a[116:119], v[72:75], v[40:43]
  v_mfma_f32_16x16x32_bf16 v[44:47], a[116:119], v[76:79], v[44:47]
  v_mfma_f32_16x16x32_bf16 v[48:51], v[72:75], a[196:199], v[48:51]
  v_mfma_f32_16x16x32_bf16 v[52:55], v[76:79], a[196:199], v[52:55]
  v_mfma_f32_16x16x32_bf16 v[56:59], v[72:75], v[132:135], v[56:59]
  v_mfma_f32_16x16x32_bf16 v[60:63], v[76:79], v[132:135], v[60:63]
  v_mfma_f32_16x16x32_bf16 v[64:67], v[72:75], v[212:215], v[64:67]
  v_mfma_f32_16x16x32_bf16 v[68:71], v[76:79], v[212:215], v[68:71]
  ds_read_b128 v[72:75], v7 offset:12288
  ds_read_b128 v[76:79], v7 offset:32768
  s_waitcnt lgkmcnt(4)
  v_mfma_f32_16x16x32_bf16 v[32:35], a[40:43], v[80:83], v[32:35]
  v_mfma_f32_16x16x32_bf16 v[36:39], a[40:43], v[84:87], v[36:39]
  v_mfma_f32_16x16x32_bf16 v[40:43], a[120:123], v[80:83], v[40:43]
  v_mfma_f32_16x16x32_bf16 v[44:47], a[120:123], v[84:87], v[44:47]
  v_mfma_f32_16x16x32_bf16 v[48:51], v[80:83], a[200:203], v[48:51]
  v_mfma_f32_16x16x32_bf16 v[52:55], v[84:87], a[200:203], v[52:55]
  v_mfma_f32_16x16x32_bf16 v[56:59], v[80:83], v[136:139], v[56:59]
  v_mfma_f32_16x16x32_bf16 v[60:63], v[84:87], v[136:139], v[60:63]
  v_mfma_f32_16x16x32_bf16 v[64:67], v[80:83], v[216:219], v[64:67]
  v_mfma_f32_16x16x32_bf16 v[68:71], v[84:87], v[216:219], v[68:71]
  ds_read_b128 v[80:83], v7 offset:13312
  ds_read_b128 v[84:87], v7 offset:33792
  s_waitcnt lgkmcnt(4)
  v_mfma_f32_16x16x32_bf16 v[32:35], a[44:47], v[88:91], v[32:35]
  v_mfma_f32_16x16x32_bf16 v[36:39], a[44:47], v[92:95], v[36:39]
  v_mfma_f32_16x16x32_bf16 v[40:43], a[124:127], v[88:91], v[40:43]
  v_mfma_f32_16x16x32_bf16 v[44:47], a[124:127], v[92:95], v[44:47]
  v_mfma_f32_16x16x32_bf16 v[48:51], v[88:91], a[204:207], v[48:51]
  v_mfma_f32_16x16x32_bf16 v[52:55], v[92:95], a[204:207], v[52:55]
  v_mfma_f32_16x16x32_bf16 v[56:59], v[88:91], v[140:143], v[56:59]
  v_mfma_f32_16x16x32_bf16 v[60:63], v[92:95], v[140:143], v[60:63]
  v_mfma_f32_16x16x32_bf16 v[64:67], v[88:91], v[220:223], v[64:67]
  v_mfma_f32_16x16x32_bf16 v[68:71], v[92:95], v[220:223], v[68:71]
  ds_read_b128 v[88:91], v7 offset:14336
  ds_read_b128 v[92:95], v7 offset:34816
  s_waitcnt lgkmcnt(4)
  v_mfma_f32_16x16x32_bf16 v[32:35], a[48:51], v[72:75], v[32:35]
  v_mfma_f32_16x16x32_bf16 v[36:39], a[48:51], v[76:79], v[36:39]
  v_mfma_f32_16x16x32_bf16 v[40:43], a[128:131], v[72:75], v[40:43]
  v_mfma_f32_16x16x32_bf16 v[44:47], a[128:131], v[76:79], v[44:47]
  v_mfma_f32_16x16x32_bf16 v[48:51], v[72:75], a[208:211], v[48:51]
  v_mfma_f32_16x16x32_bf16 v[52:55], v[76:79], a[208:211], v[52:55]
  v_mfma_f32_16x16x32_bf16 v[56:59], v[72:75], v[144:147], v[56:59]
  v_mfma_f32_16x16x32_bf16 v[60:63], v[76:79], v[144:147], v[60:63]
  v_mfma_f32_16x16x32_bf16 v[64:67], v[72:75], v[224:227], v[64:67]
  v_mfma_f32_16x16x32_bf16 v[68:71], v[76:79], v[224:227], v[68:71]
  ds_read_b128 v[72:75], v7 offset:15360
  ds_read_b128 v[76:79], v7 offset:35840
  s_waitcnt lgkmcnt(4)
  v_mfma_f32_16x16x32_bf16 v[32:35], a[52:55], v[80:83], v[32:35]
  v_mfma_f32_16x16x32_bf16 v[36:39], a[52:55], v[84:87], v[36:39]
  v_mfma_f32_16x16x32_bf16 v[40:43], a[132:135], v[80:83], v[40:43]
  v_mfma_f32_16x16x32_bf16 v[44:47], a[132:135], v[84:87], v[44:47]
  v_mfma_f32_16x16x32_bf16 v[48:51], v[80:83], a[212:215], v[48:51]
  v_mfma_f32_16x16x32_bf16 v[52:55], v[84:87], a[212:215], v[52:55]
  v_mfma_f32_16x16x32_bf16 v[56:59], v[80:83], v[148:151], v[56:59]
  v_mfma_f32_16x16x32_bf16 v[60:63], v[84:87], v[148:151], v[60:63]
  v_mfma_f32_16x16x32_bf16 v[64:67], v[80:83], v[228:231], v[64:67]
  v_mfma_f32_16x16x32_bf16 v[68:71], v[84:87], v[228:231], v[68:71]
  ds_read_b128 v[80:83], v7 offset:16384
  ds_read_b128 v[84:87], v7 offset:36864
  s_waitcnt lgkmcnt(4)
  v_mfma_f32_16x16x32_bf16 v[32:35], a[56:59], v[88:91], v[32:35]
  v_mfma_f32_16x16x32_bf16 v[36:39], a[56:59], v[92:95], v[36:39]
  v_mfma_f32_16x16x32_bf16 v[40:43], a[136:139], v[88:91], v[40:43]
  v_mfma_f32_16x16x32_bf16 v[44:47], a[136:139], v[92:95], v[44:47]
  v_mfma_f32_16x16x32_bf16 v[48:51], v[88:91], a[216:219], v[48:51]
  v_mfma_f32_16x16x32_bf16 v[52:55], v[92:95], a[216:219], v[52:55]
  v_mfma_f32_16x16x32_bf16 v[56:59], v[88:91], v[152:155], v[56:59]
  v_mfma_f32_16x16x32_bf16 v[60:63], v[92:95], v[152:155], v[60:63]
  v_mfma_f32_16x16x32_bf16 v[64:67], v[88:91], v[232:235], v[64:67]
  v_mfma_f32_16x16x32_bf16 v[68:71], v[92:95], v[232:235], v[68:71]
  ds_read_b128 v[88:91], v7 offset:17408
  ds_read_b128 v[92:95], v7 offset:37888
  s_waitcnt lgkmcnt(4)
  v_mfma_f32_16x16x32_bf16 v[32:35], a[60:63], v[72:75], v[32:35]
  v_mfma_f32_16x16x32_bf16 v[36:39], a[60:63], v[76:79], v[36:39]
  v_mfma_f32_16x16x32_bf16 v[40:43], a[140:143], v[72:75], v[40:43]
  v_mfma_f32_16x16x32_bf16 v[44:47], a[140:143], v[76:79], v[44:47]
  v_mfma_f32_16x16x32_bf16 v[48:51], v[72:75], a[220:223], v[48:51]
  v_mfma_f32_16x16x32_bf16 v[52:55], v[76:79], a[220:223], v[52:55]
  v_mfma_f32_16x16x32_bf16 v[56:59], v[72:75], v[156:159], v[56:59]
  v_mfma_f32_16x16x32_bf16 v[60:63], v[76:79], v[156:159], v[60:63]
  v_mfma_f32_16x16x32_bf16 v[64:67], v[72:75], v[236:239], v[64:67]
  v_mfma_f32_16x16x32_bf16 v[68:71], v[76:79], v[236:239], v[68:71]
  ds_read_b128 v[72:75], v7 offset:18432
  ds_read_b128 v[76:79], v7 offset:38912
  s_waitcnt lgkmcnt(4)
  v_mfma_f32_16x16x32_bf16 v[32:35], a[64:67], v[80:83], v[32:35]
  v_mfma_f32_16x16x32_bf16 v[36:39], a[64:67], v[84:87], v[36:39]
  v_mfma_f32_16x16x32_bf16 v[40:43], a[144:147], v[80:83], v[40:43]
  v_mfma_f32_16x16x32_bf16 v[44:47], a[144:147], v[84:87], v[44:47]
  v_mfma_f32_16x16x32_bf16 v[48:51], v[80:83], a[224:227], v[48:51]
  v_mfma_f32_16x16x32_bf16 v[52:55], v[84:87], a[224:227], v[52:55]
  v_mfma_f32_16x16x32_bf16 v[56:59], v[80:83], v[160:163], v[56:59]
  v_mfma_f32_16x16x32_bf16 v[60:63], v[84:87], v[160:163], v[60:63]
  v_mfma_f32_16x16x32_bf16 v[64:67], v[80:83], v[240:243], v[64:67]
  v_mfma_f32_16x16x32_bf16 v[68:71], v[84:87], v[240:243], v[68:71]
  ds_read_b128 v[80:83], v7 offset:19456
  ds_read_b128 v[84:87], v7 offset:39936
  s_waitcnt lgkmcnt(4)
  v_mfma_f32_16x16x32_bf16 v[32:35], a[68:71], v[88:91], v[32:35]
  v_mfma_f32_16x16x32_bf16 v[36:39], a[68:71], v[92:95], v[36:39]
  v_mfma_f32_16x16x32_bf16 v[40:43], a[148:151], v[88:91], v[40:43]
  v_mfma_f32_16x16x32_bf16 v[44:47], a[148:151], v[92:95], v[44:47]
  v_mfma_f32_16x16x32_bf16 v[48:51], v[88:91], a[228:231], v[48:51]
  v_mfma_f32_16x16x32_bf16 v[52:55], v[92:95], a[228:231], v[52:55]
  v_mfma_f32_16x16x32_bf16 v[56:59], v[88:91], v[164:167], v[56:59]
  v_mfma_f32_16x16x32_bf16 v[60:63], v[92:95], v[164:167], v[60:63]
  v_mfma_f32_16x16x32_bf16 v[64:67], v[88:91], v[244:247], v[64:67]
  v_mfma_f32_16x16x32_bf16 v[68:71], v[92:95], v[244:247], v[68:71]
  s_waitcnt lgkmcnt(2)
  v_mfma_f32_16x16x32_bf16 v[32:35], a[72:75], v[72:75], v[32:35]
  v_mfma_f32_16x16x32_bf16 v[36:39], a[72:75], v[76:79], v[36:39]
  v_mfma_f32_16x16x32_bf16 v[40:43], a[152:155], v[72:75], v[40:43]
  v_mfma_f32_16x16x32_bf16 v[44:47], a[152:155], v[76:79], v[44:47]
  v_mfma_f32_16x16x32_bf16 v[48:51], v[72:75], a[232:235], v[48:51]
  v_mfma_f32_16x16x32_bf16 v[52:55], v[76:79], a[232:235], v[52:55]
  v_mfma_f32_16x16x32_bf16 v[56:59], v[72:75], v[168:171], v[56:59]
  v_mfma_f32_16x16x32_bf16 v[60:63], v[76:79], v[168:171], v[60:63]
  v_mfma_f32_16x16x32_bf16 v[64:67], v[72:75], v[248:251], v[64:67]
  v_mfma_f32_16x16x32_bf16 v[68:71], v[76:79], v[248:251], v[68:71]
  s_waitcnt lgkmcnt(0)
  v_mfma_f32_16x16x32_bf16 v[32:35], a[76:79], v[80:83], v[32:35]
  v_mfma_f32_16x16x32_bf16 v[36:39], a[76:79], v[84:87], v[36:39]
  v_mfma_f32_16x16x32_bf16 v[40:43], a[156:159], v[80:83], v[40:43]
  v_mfma_f32_16x16x32_bf16 v[44:47], a[156:159], v[84:87], v[44:47]
  v_mfma_f32_16x16x32_bf16 v[48:51], v[80:83], a[236:239], v[48:51]
  v_mfma_f32_16x16x32_bf16 v[52:55], v[84:87], a[236:239], v[52:55]
  v_mfma_f32_16x16x32_bf16 v[56:59], v[80:83], v[172:175], v[56:59]
  v_mfma_f32_16x16x32_bf16 v[60:63], v[84:87], v[172:175], v[60:63]
  v_mfma_f32_16x16x32_bf16 v[64:67], v[80:83], v[252:255], v[64:67]
  v_mfma_f32_16x16x32_bf16 v[68:71], v[84:87], v[252:255], v[68:71]
  v_cvt_pk_bf16_f32 v8, v32, v33
  v_cvt_pk_bf16_f32 v9, v34, v35
  v_cvt_pk_bf16_f32 v10, v40, v41
  v_cvt_pk_bf16_f32 v11, v42, v43
  s_add_u32 s34, s21, 2048
  buffer_store_dwordx4 v[8:11], v1, s[4:7], s34 offen
  v_cvt_pk_bf16_f32 v12, v36, v37
  v_cvt_pk_bf16_f32 v13, v38, v39
  v_cvt_pk_bf16_f32 v14, v44, v45
  v_cvt_pk_bf16_f32 v15, v46, v47
  s_add_u32 s34, s21, 8192
  buffer_store_dwordx4 v[12:15], v1, s[4:7], s34 offen
  v_cvt_pk_bf16_f32 v8, v48, v49
  v_cvt_pk_bf16_f32 v9, v50, v51
  v_cvt_pk_bf16_f32 v10, v52, v53
  v_cvt_pk_bf16_f32 v11, v54, v55
  s_add_u32 s34, s23, 1024
  buffer_store_dwordx4 v[8:11], v1, s[4:7], s34 offen
  v_cvt_pk_bf16_f32 v12, v56, v57
  v_cvt_pk_bf16_f32 v13, v58, v59
  v_cvt_pk_bf16_f32 v14, v60, v61
  v_cvt_pk_bf16_f32 v15, v62, v63
  s_add_u32 s34, s23, 2048
  buffer_store_dwordx4 v[12:15], v1, s[4:7], s34 offen
  v_cvt_pk_bf16_f32 v8, v64, v65
  v_cvt_pk_bf16_f32 v9, v66, v67
  v_cvt_pk_bf16_f32 v10, v68, v69
  v_cvt_pk_bf16_f32 v11, v70, v71
  s_add_u32 s34, s23, 3072
  buffer_store_dwordx4 v[8:11], v1, s[4:7], s34 offen
  s_waitcnt vmcnt(0)
  s_barrier
  s_add_u32 s17, s17, 1
  s_cmp_lt_u32 s17, 64
  s_cbranch_scc1 reca_ptop246
  s_branch reca_exit1
reca_pslow245:
reca_ptop251:
  s_cmp_lt_u32 s17, 3
  s_cbranch_scc1 reca_pgo252
  s_sub_u32 s36, s17, 3
reca_ppoll253:
  buffer_load_dword v28, v4, s[4:7], s25 offen sc1
  s_waitcnt vmcnt(0)
  v_readfirstlane_b32 s34, v28
  s_nop 3
  s_cmp_ge_i32 s34, s36
  s_cbranch_scc1 reca_pgo252
  s_sleep 8
  s_sub_u32 s18, s18, 1
  s_cbranch_scc0 reca_ppoll253
  s_mov_b32 s18, 0
reca_pgo252:
  s_waitcnt vmcnt(0)
  s_barrier
  v_add_u32 v7, s26, v1
  s_xor_b32 s26, s26, 40960
  s_add_u32 s37, s17, 1
  s_cmp_ge_u32 s37, 64
  s_cbranch_scc1 reca_pnodma254
  s_mul_i32 s20, s37, 40960
  s_add_u32 s20, s20, 84944896
  s_add_u32 m0, s26, 10240
  s_nop 0
  buffer_load_dwordx4 v1, s[4:7], s20 offen offset:0 lds
  buffer_load_dwordx4 v1, s[4:7], s20 offen offset:1024 lds
  buffer_load_dwordx4 v1, s[4:7], s20 offen offset:2048 lds
  buffer_load_dwordx4 v1, s[4:7], s20 offen offset:3072 lds
  s_add_u32 s20, s20, 4096
  s_add_u32 m0, s26, 14336
  s_nop 0
  buffer_load_dwordx4 v1, s[4:7], s20 offen offset:0 lds
  buffer_load_dwordx4 v1, s[4:7], s20 offen offset:1024 lds
  buffer_load_dwordx4 v1, s[4:7], s20 offen offset:2048 lds
  buffer_load_dwordx4 v1, s[4:7], s20 offen offset:3072 lds
  s_add_u32 s20, s20, 4096
  s_add_u32 m0, s26, 18432
  s_nop 0
  buffer_load_dwordx4 v1, s[4:7], s20 offen offset:0 lds
  buffer_load_dwordx4 v1, s[4:7], s20 offen offset:1024 lds
reca_pnodma254:
  s_lshl_b32 s34, s15, 3
  s_and_b32 s35, s17, 7
  s_add_u32 s34, s34, s35
  s_mul_i32 s34, s34, 12288
  s_mul_i32 s35, s16, 3072
  s_add_u32 s35, s35, s34
  s_add_u32 s21, s35, 37748736
  s_add_u32 s22, s35, 44040192
  s_mul_i32 s35, s16, 6144
  s_add_u32 s35, s35, s34
  s_add_u32 s23, s35, 40894464
  ds_read_b128 v[72:75], v7 offset:0
  ds_read_b128 v[76:79], v7 offset:20480
  ds_read_b128 v[80:83], v7 offset:1024
  ds_read_b128 v[84:87], v7 offset:21504
  ds_read_b128 v[88:91], v7 offset:2048
  ds_read_b128 v[92:95], v7 offset:22528
  s_waitcnt lgkmcnt(4)
  v_mfma_f32_16x16x32_bf16 v[32:35], a[0:3], v[72:75], 0
  v_mfma_f32_16x16x32_bf16 v[36:39], a[0:3], v[76:79], 0
  v_mfma_f32_16x16x32_bf16 v[40:43], a[80:83], v[72:75], 0
  v_mfma_f32_16x16x32_bf16 v[44:47], a[80:83], v[76:79], 0
  v_mfma_f32_16x16x32_bf16 v[48:51], v[72:75], a[160:163], 0
  v_mfma_f32_16x16x32_bf16 v[52:55], v[76:79], a[160:163], 0
  v_mfma_f32_16x16x32_bf16 v[56:59], v[72:75], v[96:99], 0
  v_mfma_f32_16x16x32_bf16 v[60:63], v[76:79], v[96:99], 0
  v_mfma_f32_16x16x32_bf16 v[64:67], v[72:75], v[176:179], 0
  v_mfma_f32_16x16x32_bf16 v[68:71], v[76:79], v[176:179], 0
  ds_read_b128 v[72:75], v7 offset:3072
  ds_read_b128 v[76:79], v7 offset:23552
  s_waitcnt lgkmcnt(4)
  v_mfma_f32_16x16x32_bf16 v[32:35], a[4:7], v[80:83], v[32:35]
  v_mfma_f32_16x16x32_bf16 v[36:39], a[4:7], v[84:87], v[36:39]
  v_mfma_f32_16x16x32_bf16 v[40:43], a[84:87], v[80:83], v[40:43]
  v_mfma_f32_16x16x32_bf16 v[44:47], a[84:87], v[84:87], v[44:47]
  v_mfma_f32_16x16x32_bf16 v[48:51], v[80:83], a[164:167], v[48:51]
  v_mfma_f32_16x16x32_bf16 v[52:55], v[84:87], a[164:167], v[52:55]
  v_mfma_f32_16x16x32_bf16 v[56:59], v[80:83], v[100:103], v[56:59]
  v_mfma_f32_16x16x32_bf16 v[60:63], v[84:87], v[100:103], v[60:63]
  v_mfma_f32_16x16x32_bf16 v[64:67], v[80:83], v[180:183], v[64:67]
  v_mfma_f32_16x16x32_bf16 v[68:71], v[84:87], v[180:183], v[68:71]
  ds_read_b128 v[80:83], v7 offset:4096
  ds_read_b128 v[84:87], v7 offset:24576
  s_waitcnt lgkmcnt(4)
  v_mfma_f32_16x16x32_bf16 v[32:35], a[8:11], v[88:91], v[32:35]
  v_mfma_f32_16x16x32_bf16 v[36:39], a[8:11], v[92:95], v[36:39]
  v_mfma_f32_16x16x32_bf16 v[40:43], a[88:91], v[88:91], v[40:43]
  v_mfma_f32_16x16x32_bf16 v[44:47], a[88:91], v[92:95], v[44:47]
  v_mfma_f32_16x16x32_bf16 v[48:51], v[88:91], a[168:171], v[48:51]
  v_mfma_f32_16x16x32_bf16 v[52:55], v[92:95], a[168:171], v[52:55]
  v_mfma_f32_16x16x32_bf16 v[56:59], v[88:91], v[104:107], v[56:59]
  v_mfma_f32_16x16x32_bf16 v[60:63], v[92:95], v[104:107], v[60:63]
  v_mfma_f32_16x16x32_bf16 v[64:67], v[88:91], v[184:187], v[64:67]
  v_mfma_f32_16x16x32_bf16 v[68:71], v[92:95], v[184:187], v[68:71]
  ds_read_b128 v[88:91], v7 offset:5120
  ds_read_b128 v[92:95], v7 offset:25600
  s_waitcnt lgkmcnt(4)
  v_mfma_f32_16x16x32_bf16 v[32:35], a[12:15], v[72:75], v[32:35]
  v_mfma_f32_16x16x32_bf16 v[36:39], a[12:15], v[76:79], v[36:39]
  v_mfma_f32_16x16x32_bf16 v[40:43], a[92:95], v[72:75], v[40:43]
  v_mfma_f32_16x16x32_bf16 v[44:47], a[92:95], v[76:79], v[44:47]
  v_mfma_f32_16x16x32_bf16 v[48:51], v[72:75], a[172:175], v[48:51]
  v_mfma_f32_16x16x32_bf16 v[52:55], v[76:79], a[172:175], v[52:55]
  v_mfma_f32_16x16x32_bf16 v[56:59], v[72:75], v[108:111], v[56:59]
  v_mfma_f32_16x16x32_bf16 v[60:63], v[76:79], v[108:111], v[60:63]
  v_mfma_f32_16x16x32_bf16 v[64:67], v[72:75], v[188:191], v[64:67]
  v_mfma_f32_16x16x32_bf16 v[68:71], v[76:79], v[188:191], v[68:71]
  ds_read_b128 v[72:75], v7 offset:6144
  ds_read_b128 v[76:79], v7 offset:26624
  s_waitcnt lgkmcnt(4)
  v_mfma_f32_16x16x32_bf16 v[32:35], a[16:19], v[80:83], v[32:35]
  v_mfma_f32_16x16x32_bf16 v[36:39], a[16:19], v[84:87], v[36:39]
  v_mfma_f32_16x16x32_bf16 v[40:43], a[96:99], v[80:83], v[40:43]
  v_mfma_f32_16x16x32_bf16 v[44:47], a[96:99], v[84:87], v[44:47]
  v_mfma_f32_16x16x32_bf16 v[48:51], v[80:83], a[176:179], v[48:51]
  v_mfma_f32_16x16x32_bf16 v[52:55], v[84:87], a[176:179], v[52:55]
  v_mfma_f32_16x16x32_bf16 v[56:59], v[80:83], v[112:115], v[56:59]
  v_mfma_f32_16x16x32_bf16 v[60:63], v[84:87], v[112:115], v[60:63]
  v_mfma_f32_16x16x32_bf16 v[64:67], v[80:83], v[192:195], v[64:67]
  v_mfma_f32_16x16x32_bf16 v[68:71], v[84:87], v[192:195], v[68:71]
  ds_read_b128 v[80:83], v7 offset:7168
  ds_read_b128 v[84:87], v7 offset:27648
  s_waitcnt lgkmcnt(4)
  v_mfma_f32_16x16x32_bf16 v[32:35], a[20:23], v[88:91], v[32:35]
  v_mfma_f32_16x16x32_bf16 v[36:39], a[20:23], v[92:95], v[36:39]
  v_mfma_f32_16x16x32_bf16 v[40:43], a[100:103], v[88:91], v[40:43]
  v_mfma_f32_16x16x32_bf16 v[44:47], a[100:103], v[92:95], v[44:47]
  v_mfma_f32_16x16x32_bf16 v[48:51], v[88:91], a[180:183], v[48:51]
  v_mfma_f32_16x16x32_bf16 v[52:55], v[92:95], a[180:183], v[52:55]
  v_mfma_f32_16x16x32_bf16 v[56:59], v[88:91], v[116:119], v[56:59]
  v_mfma_f32_16x16x32_bf16 v[60:63], v[92:95], v[116:119], v[60:63]
  v_mfma_f32_16x16x32_bf16 v[64:67], v[88:91], v[196:199], v[64:67]
  v_mfma_f32_16x16x32_bf16 v[68:71], v[92:95], v[196:199], v[68:71]
  ds_read_b128 v[88:91], v7 offset:8192
  ds_read_b128 v[92:95], v7 offset:28672
  s_waitcnt lgkmcnt(4)
  v_mfma_f32_16x16x32_bf16 v[32:35], a[24:27], v[72:75], v[32:35]
  v_mfma_f32_16x16x32_bf16 v[36:39], a[24:27], v[76:79], v[36:39]
  v_mfma_f32_16x16x32_bf16 v[40:43], a[104:107], v[72:75], v[40:43]
  v_mfma_f32_16x16x32_bf16 v[44:47], a[104:107], v[76:79], v[44:47]
  v_mfma_f32_16x16x32_bf16 v[48:51], v[72:75], a[184:187], v[48:51]
  v_mfma_f32_16x16x32_bf16 v[52:55], v[76:79], a[184:187], v[52:55]
  v_mfma_f32_16x16x32_bf16 v[56:59], v[72:75], v[120:123], v[56:59]
  v_mfma_f32_16x16x32_bf16 v[60:63], v[76:79], v[120:123], v[60:63]
  v_mfma_f32_16x16x32_bf16 v[64:67], v[72:75], v[200:203], v[64:67]
  v_mfma_f32_16x16x32_bf16 v[68:71], v[76:79], v[200:203], v[68:71]
  ds_read_b128 v[72:75], v7 offset:9216
  ds_read_b128 v[76:79], v7 offset:29696
  s_waitcnt lgkmcnt(4)
  v_mfma_f32_16x16x32_bf16 v[32:35], a[28:31], v[80:83], v[32:35]
  v_mfma_f32_16x16x32_bf16 v[36:39], a[28:31], v[84:87], v[36:39]
  v_mfma_f32_16x16x32_bf16 v[40:43], a[108:111], v[80:83], v[40:43]
  v_mfma_f32_16x16x32_bf16 v[44:47], a[108:111], v[84:87], v[44:47]
  v_mfma_f32_16x16x32_bf16 v[48:51], v[80:83], a[188:191], v[48:51]
  v_mfma_f32_16x16x32_bf16 v[52:55], v[84:87], a[188:191], v[52:55]
  v_mfma_f32_16x16x32_bf16 v[56:59], v[80:83], v[124:127], v[56:59]
  v_mfma_f32_16x16x32_bf16 v[60:63], v[84:87], v[124:127], v[60:63]
  v_mfma_f32_16x16x32_bf16 v[64:67], v[80:83], v[204:207], v[64:67]
  v_mfma_f32_16x16x32_bf16 v[68:71], v[84:87], v[204:207], v[68:71]
  ds_read_b128 v[80:83], v7 offset:10240
  ds_read_b128 v[84:87], v7 offset:30720
  s_waitcnt lgkmcnt(4)
  v_mfma_f32_16x16x32_bf16 v[32:35], a[32:35], v[88:91], v[32:35]
  v_mfma_f32_16x16x32_bf16 v[36:39], a[32:35], v[92:95], v[36:39]
  v_mfma_f32_16x16x32_bf16 v[40:43], a[112:115], v[88:91], v[40:43]
  v_mfma_f32_16x16x32_bf16 v[44:47], a[112:115], v[92:95], v[44:47]
  v_mfma_f32_16x16x32_bf16 v[48:51], v[88:91], a[192:195], v[48:51]
  v_mfma_f32_16x16x32_bf16 v[52:55], v[92:95], a[192:195], v[52:55]
  v_mfma_f32_16x16x32_bf16 v[56:59], v[88:91], v[128:131], v[56:59]
  v_mfma_f32_16x16x32_bf16 v[60:63], v[92:95], v[128:131], v[60:63]
  v_mfma_f32_16x16x32_bf16 v[64:67], v[88:91], v[208:211], v[64:67]
  v_mfma_f32_16x16x32_bf16 v[68:71], v[92:95], v[208:211], v[68:71]
  ds_read_b128 v[88:91], v7 offset:11264
  ds_read_b128 v[92:95], v7 offset:31744
  s_waitcnt lgkmcnt(4)
  v_mfma_f32_16x16x32_bf16 v[32:35], a[36:39], v[72:75], v[32:35]
  v_mfma_f32_16x16x32_bf16 v[36:39], a[36:39], v[76:79], v[36:39]
  v_mfma_f32_16x16x32_bf16 v[40:43], a[116:119], v[72:75], v[40:43]
  v_mfma_f32_16x16x32_bf16 v[44:47], a[116:119], v[76:79], v[44:47]
  v_mfma_f32_16x16x32_bf16 v[48:51], v[72:75], a[196:199], v[48:51]
  v_mfma_f32_16x16x32_bf16 v[52:55], v[76:79], a[196:199], v[52:55]
  v_mfma_f32_16x16x32_bf16 v[56:59], v[72:75], v[132:135], v[56:59]
  v_mfma_f32_16x16x32_bf16 v[60:63], v[76:79], v[132:135], v[60:63]
  v_mfma_f32_16x16x32_bf16 v[64:67], v[72:75], v[212:215], v[64:67]
  v_mfma_f32_16x16x32_bf16 v[68:71], v[76:79], v[212:215], v[68:71]
  ds_read_b128 v[72:75], v7 offset:12288
  ds_read_b128 v[76:79], v7 offset:32768
  s_waitcnt lgkmcnt(4)
  v_mfma_f32_16x16x32_bf16 v[32:35], a[40:43], v[80:83], v[32:35]
  v_mfma_f32_16x16x32_bf16 v[36:39], a[40:43], v[84:87], v[36:39]
  v_mfma_f32_16x16x32_bf16 v[40:43], a[120:123], v[80:83], v[40:43]
  v_mfma_f32_16x16x32_bf16 v[44:47], a[120:123], v[84:87], v[44:47]
  v_mfma_f32_16x16x32_bf16 v[48:51], v[80:83], a[200:203], v[48:51]
  v_mfma_f32_16x16x32_bf16 v[52:55], v[84:87], a[200:203], v[52:55]
  v_mfma_f32_16x16x32_bf16 v[56:59], v[80:83], v[136:139], v[56:59]
  v_mfma_f32_16x16x32_bf16 v[60:63], v[84:87], v[136:139], v[60:63]
  v_mfma_f32_16x16x32_bf16 v[64:67], v[80:83], v[216:219], v[64:67]
  v_mfma_f32_16x16x32_bf16 v[68:71], v[84:87], v[216:219], v[68:71]
  ds_read_b128 v[80:83], v7 offset:13312
  ds_read_b128 v[84:87], v7 offset:33792
  s_waitcnt lgkmcnt(4)
  v_mfma_f32_16x16x32_bf16 v[32:35], a[44:47], v[88:91], v[32:35]
  v_mfma_f32_16x16x32_bf16 v[36:39], a[44:47], v[92:95], v[36:39]
  v_mfma_f32_16x16x32_bf16 v[40:43], a[124:127], v[88:91], v[40:43]
  v_mfma_f32_16x16x32_bf16 v[44:47], a[124:127], v[92:95], v[44:47]
  v_mfma_f32_16x16x32_bf16 v[48:51], v[88:91], a[204:207], v[48:51]
  v_mfma_f32_16x16x32_bf16 v[52:55], v[92:95], a[204:207], v[52:55]
  v_mfma_f32_16x16x32_bf16 v[56:59], v[88:91], v[140:143], v[56:59]
  v_mfma_f32_16x16x32_bf16 v[60:63], v[92:95], v[140:143], v[60:63]
  v_mfma_f32_16x16x32_bf16 v[64:67], v[88:91], v[220:223], v[64:67]
  v_mfma_f32_16x16x32_bf16 v[68:71], v[92:95], v[220:223], v[68:71]
  ds_read_b128 v[88:91], v7 offset:14336
  ds_read_b128 v[92:95], v7 offset:34816
  s_waitcnt lgkmcnt(4)
  v_mfma_f32_16x16x32_bf16 v[32:35], a[48:51], v[72:75], v[32:35]
  v_mfma_f32_16x16x32_bf16 v[36:39], a[48:51], v[76:79], v[36:39]
  v_mfma_f32_16x16x32_bf16 v[40:43], a[128:131], v[72:75], v[40:43]
  v_mfma_f32_16x16x32_bf16 v[44:47], a[128:131], v[76:79], v[44:47]
  v_mfma_f32_16x16x32_bf16 v[48:51], v[72:75], a[208:211], v[48:51]
  v_mfma_f32_16x16x32_bf16 v[52:55], v[76:79], a[208:211], v[52:55]
  v_mfma_f32_16x16x32_bf16 v[56:59], v[72:75], v[144:147], v[56:59]
  v_mfma_f32_16x16x32_bf16 v[60:63], v[76:79], v[144:147], v[60:63]
  v_mfma_f32_16x16x32_bf16 v[64:67], v[72:75], v[224:227], v[64:67]
  v_mfma_f32_16x16x32_bf16 v[68:71], v[76:79], v[224:227], v[68:71]
  ds_read_b128 v[72:75], v7 offset:15360
  ds_read_b128 v[76:79], v7 offset:35840
  s_waitcnt lgkmcnt(4)
  v_mfma_f32_16x16x32_bf16 v[32:35], a[52:55], v[80:83], v[32:35]
  v_mfma_f32_16x16x32_bf16 v[36:39], a[52:55], v[84:87], v[36:39]
  v_mfma_f32_16x16x32_bf16 v[40:43], a[132:135], v[80:83], v[40:43]
  v_mfma_f32_16x16x32_bf16 v[44:47], a[132:135], v[84:87], v[44:47]
  v_mfma_f32_16x16x32_bf16 v[48:51], v[80:83], a[212:215], v[48:51]
  v_mfma_f32_16x16x32_bf16 v[52:55], v[84:87], a[212:215], v[52:55]
  v_mfma_f32_16x16x32_bf16 v[56:59], v[80:83], v[148:151], v[56:59]
  v_mfma_f32_16x16x32_bf16 v[60:63], v[84:87], v[148:151], v[60:63]
  v_mfma_f32_16x16x32_bf16 v[64:67], v[80:83], v[228:231], v[64:67]
  v_mfma_f32_16x16x32_bf16 v[68:71], v[84:87], v[228:231], v[68:71]
  ds_read_b128 v[80:83], v7 offset:16384
  ds_read_b128 v[84:87], v7 offset:36864
  s_waitcnt lgkmcnt(4)
  v_mfma_f32_16x16x32_bf16 v[32:35], a[56:59], v[88:91], v[32:35]
  v_mfma_f32_16x16x32_bf16 v[36:39], a[56:59], v[92:95], v[36:39]
  v_mfma_f32_16x16x32_bf16 v[40:43], a[136:139], v[88:91], v[40:43]
  v_mfma_f32_16x16x32_bf16 v[44:47], a[136:139], v[92:95], v[44:47]
  v_mfma_f32_16x16x32_bf16 v[48:51], v[88:91], a[216:219], v[48:51]
  v_mfma_f32_16x16x32_bf16 v[52:55], v[92:95], a[216:219], v[52:55]
  v_mfma_f32_16x16x32_bf16 v[56:59], v[88:91], v[152:155], v[56:59]
  v_mfma_f32_16x16x32_bf16 v[60:63], v[92:95], v[152:155], v[60:63]
  v_mfma_f32_16x16x32_bf16 v[64:67], v[88:91], v[232:235], v[64:67]
  v_mfma_f32_16x16x32_bf16 v[68:71], v[92:95], v[232:235], v[68:71]
  ds_read_b128 v[88:91], v7 offset:17408
  ds_read_b128 v[92:95], v7 offset:37888
  s_waitcnt lgkmcnt(4)
  v_mfma_f32_16x16x32_bf16 v[32:35], a[60:63], v[72:75], v[32:35]
  v_mfma_f32_16x16x32_bf16 v[36:39], a[60:63], v[76:79], v[36:39]
  v_mfma_f32_16x16x32_bf16 v[40:43], a[140:143], v[72:75], v[40:43]
  v_mfma_f32_16x16x32_bf16 v[44:47], a[140:143], v[76:79], v[44:47]
  v_mfma_f32_16x16x32_bf16 v[48:51], v[72:75], a[220:223], v[48:51]
  v_mfma_f32_16x16x32_bf16 v[52:55], v[76:79], a[220:223], v[52:55]
  v_mfma_f32_16x16x32_bf16 v[56:59], v[72:75], v[156:159], v[56:59]
  v_mfma_f32_16x16x32_bf16 v[60:63], v[76:79], v[156:159], v[60:63]
  v_mfma_f32_16x16x32_bf16 v[64:67], v[72:75], v[236:239], v[64:67]
  v_mfma_f32_16x16x32_bf16 v[68:71], v[76:79], v[236:239], v[68:71]
  ds_read_b128 v[72:75], v7 offset:18432
  ds_read_b128 v[76:79], v7 offset:38912
  s_waitcnt lgkmcnt(4)
  v_mfma_f32_16x16x32_bf16 v[32:35], a[64:67], v[80:83], v[32:35]
  v_mfma_f32_16x16x32_bf16 v[36:39], a[64:67], v[84:87], v[36:39]
  v_mfma_f32_16x16x32_bf16 v[40:43], a[144:147], v[80:83], v[40:43]
  v_mfma_f32_16x16x32_bf16 v[44:47], a[144:147], v[84:87], v[44:47]
  v_mfma_f32_16x16x32_bf16 v[48:51], v[80:83], a[224:227], v[48:51]
  v_mfma_f32_16x16x32_bf16 v[52:55], v[84:87], a[224:227], v[52:55]
  v_mfma_f32_16x16x32_bf16 v[56:59], v[80:83], v[160:163], v[56:59]
  v_mfma_f32_16x16x32_bf16 v[60:63], v[84:87], v[160:163], v[60:63]
  v_mfma_f32_16x16x32_bf16 v[64:67], v[80:83], v[240:243], v[64:67]
  v_mfma_f32_16x16x32_bf16 v[68:71], v[84:87], v[240:243], v[68:71]
  ds_read_b128 v[80:83], v7 offset:19456
  ds_read_b128 v[84:87], v7 offset:39936
  s_waitcnt lgkmcnt(4)
  v_mfma_f32_16x16x32_bf16 v[32:35], a[68:71], v[88:91], v[32:35]
  v_mfma_f32_16x16x32_bf16 v[36:39], a[68:71], v[92:95], v[36:39]
  v_mfma_f32_16x16x32_bf16 v[40:43], a[148:151], v[88:91], v[40:43]
  v_mfma_f32_16x16x32_bf16 v[44:47], a[148:151], v[92:95], v[44:47]
  v_mfma_f32_16x16x32_bf16 v[48:51], v[88:91], a[228:231], v[48:51]
  v_mfma_f32_16x16x32_bf16 v[52:55], v[92:95], a[228:231], v[52:55]
  v_mfma_f32_16x16x32_bf16 v[56:59], v[88:91], v[164:167], v[56:59]
  v_mfma_f32_16x16x32_bf16 v[60:63], v[92:95], v[164:167], v[60:63]
  v_mfma_f32_16x16x32_bf16 v[64:67], v[88:91], v[244:247], v[64:67]
  v_mfma_f32_16x16x32_bf16 v[68:71], v[92:95], v[244:247], v[68:71]
  s_waitcnt lgkmcnt(2)
  v_mfma_f32_16x16x32_bf16 v[32:35], a[72:75], v[72:75], v[32:35]
  v_mfma_f32_16x16x32_bf16 v[36:39], a[72:75], v[76:79], v[36:39]
  v_mfma_f32_16x16x32_bf16 v[40:43], a[152:155], v[72:75], v[40:43]
  v_mfma_f32_16x16x32_bf16 v[44:47], a[152:155], v[76:79], v[44:47]
  v_mfma_f32_16x16x32_bf16 v[48:51], v[72:75], a[232:235], v[48:51]
  v_mfma_f32_16x16x32_bf16 v[52:55], v[76:79], a[232:235], v[52:55]
  v_mfma_f32_16x16x32_bf16 v[56:59], v[72:75], v[168:171], v[56:59]
  v_mfma_f32_16x16x32_bf16 v[60:63], v[76:79], v[168:171], v[60:63]
  v_mfma_f32_16x16x32_bf16 v[64:67], v[72:75], v[248:251], v[64:67]
  v_mfma_f32_16x16x32_bf16 v[68:71], v[76:79], v[248:251], v[68:71]
  s_waitcnt lgkmcnt(0)
  v_mfma_f32_16x16x32_bf16 v[32:35], a[76:79], v[80:83], v[32:35]
  v_mfma_f32_16x16x32_bf16 v[36:39], a[76:79], v[84:87], v[36:39]
  v_mfma_f32_16x16x32_bf16 v[40:43], a[156:159], v[80:83], v[40:43]
  v_mfma_f32_16x16x32_bf16 v[44:47], a[156:159], v[84:87], v[44:47]
  v_mfma_f32_16x16x32_bf16 v[48:51], v[80:83], a[236:239], v[48:51]
  v_mfma_f32_16x16x32_bf16 v[52:55], v[84:87], a[236:239], v[52:55]
  v_mfma_f32_16x16x32_bf16 v[56:59], v[80:83], v[172:175], v[56:59]
  v_mfma_f32_16x16x32_bf16 v[60:63], v[84:87], v[172:175], v[60:63]
  v_mfma_f32_16x16x32_bf16 v[64:67], v[80:83], v[252:255], v[64:67]
  v_mfma_f32_16x16x32_bf16 v[68:71], v[84:87], v[252:255], v[68:71]
  v_cvt_pk_bf16_f32 v8, v32, v33
  v_cvt_pk_bf16_f32 v9, v34, v35
  v_cvt_pk_bf16_f32 v10, v40, v41
  v_cvt_pk_bf16_f32 v11, v42, v43
  s_add_u32 s34, s21, 2048
  buffer_store_dwordx4 v[8:11], v1, s[4:7], s34 offen sc1
  v_cvt_pk_bf16_f32 v12, v36, v37
  v_cvt_pk_bf16_f32 v13, v38, v39
  v_cvt_pk_bf16_f32 v14, v44, v45
  v_cvt_pk_bf16_f32 v15, v46, v47
  s_add_u32 s34, s21, 8192
  buffer_store_dwordx4 v[12:15], v1, s[4:7], s34 offen sc1
  v_cvt_pk_bf16_f32 v8, v48, v49
  v_cvt_pk_bf16_f32 v9, v50, v51
  v_cvt_pk_bf16_f32 v10, v52, v53
  v_cvt_pk_bf16_f32 v11, v54, v55
  s_add_u32 s34, s23, 1024
  buffer_store_dwordx4 v[8:11], v1, s[4:7], s34 offen sc1
  v_cvt_pk_bf16_f32 v12, v56, v57
  v_cvt_pk_bf16_f32 v13, v58, v59
  v_cvt_pk_bf16_f32 v14, v60, v61
  v_cvt_pk_bf16_f32 v15, v62, v63
  s_add_u32 s34, s23, 2048
  buffer_store_dwordx4 v[12:15], v1, s[4:7], s34 offen sc1
  v_cvt_pk_bf16_f32 v8, v64, v65
  v_cvt_pk_bf16_f32 v9, v66, v67
  v_cvt_pk_bf16_f32 v10, v68, v69
  v_cvt_pk_bf16_f32 v11, v70, v71
  s_add_u32 s34, s23, 3072
  buffer_store_dwordx4 v[8:11], v1, s[4:7], s34 offen sc1
  s_waitcnt vmcnt(0)
  s_barrier
  s_add_u32 s17, s17, 1
  s_cmp_lt_u32 s17, 64
  s_cbranch_scc1 reca_ptop251
  s_branch reca_exit1
reca_pw2_228:
  s_mov_b32 s17, 0
  s_mov_b32 s26, 0
  s_mul_i32 s20, s17, 40960
  s_add_u32 s20, s20, 84955136
  s_add_u32 m0, s26, 20480
  s_nop 0
  buffer_load_dwordx4 v1, s[4:7], s20 offen offset:0 lds
  buffer_load_dwordx4 v1, s[4:7], s20 offen offset:1024 lds
  buffer_load_dwordx4 v1, s[4:7], s20 offen offset:2048 lds
  buffer_load_dwordx4 v1, s[4:7], s20 offen offset:3072 lds
  s_add_u32 s20, s20, 4096
  s_add_u32 m0, s26, 24576
  s_nop 0
  buffer_load_dwordx4 v1, s[4:7], s20 offen offset:0 lds
  buffer_load_dwordx4 v1, s[4:7], s20 offen offset:1024 lds
  buffer_load_dwordx4 v1, s[4:7], s20 offen offset:2048 lds
  buffer_load_dwordx4 v1, s[4:7], s20 offen offset:3072 lds
  s_add_u32 s20, s20, 4096
  s_add_u32 m0, s26, 28672
  s_nop 0
  buffer_load_dwordx4 v1, s[4:7], s20 offen offset:0 lds
  buffer_load_dwordx4 v1, s[4:7], s20 offen offset:1024 lds
  s_mul_i32 s34, s15, 12
  s_mul_i32 s35, s16, 6
  s_add_u32 s34, s34, s35
  s_add_u32 s34, s34, 0
  s_mul_i32 s34, s34, 20480
  s_add_u32 s34, s34, 6291456
  buffer_load_dwordx4 a[0:3], v1, s[4:7], s34 offen offset:0
  buffer_load_dwordx4 a[4:7], v1, s[4:7], s34 offen offset:1024
  buffer_load_dwordx4 a[8:11], v1, s[4:7], s34 offen offset:2048
  buffer_load_dwordx4 a[12:15], v1, s[4:7], s34 offen offset:3072
  s_add_u32 s34, s34, 4096
  buffer_load_dwordx4 a[16:19], v1, s[4:7], s34 offen offset:0
  buffer_load_dwordx4 a[20:23], v1, s[4:7], s34 offen offset:1024
  buffer_load_dwordx4 a[24:27], v1, s[4:7], s34 offen offset:2048
  buffer_load_dwordx4 a[28:31], v1, s[4:7], s34 offen offset:3072
  s_add_u32 s34, s34, 4096
  buffer_load_dwordx4 a[32:35], v1, s[4:7], s34 offen offset:0
  buffer_load_dwordx4 a[36:39], v1, s[4:7], s34 offen offset:1024
  buffer_load_dwordx4 a[40:43], v1, s[4:7], s34 offen offset:2048
  buffer_load_dwordx4 a[44:47], v1, s[4:7], s34 offen offset:3072
  s_add_u32 s34, s34, 4096
  buffer_load_dwordx4 a[48:51], v1, s[4:7], s34 offen offset:0
  buffer_load_dwordx4 a[52:55], v1, s[4:7], s34 offen offset:1024
  buffer_load_dwordx4 a[56:59], v1, s[4:7], s34 offen offset:2048
  buffer_load_dwordx4 a[60:63], v1, s[4:7], s34 offen offset:3072
  s_add_u32 s34, s34, 4096
  buffer_load_dwordx4 a[64:67], v1, s[4:7], s34 offen offset:0
  buffer_load_dwordx4 a[68:71], v1, s[4:7], s34 offen offset:1024
  buffer_load_dwordx4 a[72:75], v1, s[4:7], s34 offen offset:2048
  buffer_load_dwordx4 a[76:79], v1, s[4:7], s34 offen offset:3072
  s_mul_i32 s34, s15, 12
  s_mul_i32 s35, s16, 6
  s_add_u32 s34, s34, s35
  s_add_u32 s34, s34, 1
  s_mul_i32 s34, s34, 20480
  s_add_u32 s34, s34, 6291456
  buffer_load_dwordx4 a[80:83], v1, s[4:7], s34 offen offset:0
  buffer_load_dwordx4 a[84:87], v1, s[4:7], s34 offen offset:1024
  buffer_load_dwordx4 a[88:91], v1, s[4:7], s34 offen offset:2048
  buffer_load_dwordx4 a[92:95], v1, s[4:7], s34 offen offset:3072
  s_add_u32 s34, s34, 4096
  buffer_load_dwordx4 a[96:99], v1, s[4:7], s34 offen offset:0
  buffer_load_dwordx4 a[100:103], v1, s[4:7], s34 offen offset:1024
  buffer_load_dwordx4 a[104:107], v1, s[4:7], s34 offen offset:2048
  buffer_load_dwordx4 a[108:111], v1, s[4:7], s34 offen offset:3072
  s_add_u32 s34, s34, 4096
  buffer_load_dwordx4 a[112:115], v1, s[4:7], s34 offen offset:0
  buffer_load_dwordx4 a[116:119], v1, s[4:7], s34 offen offset:1024
  buffer_load_dwordx4 a[120:123], v1, s[4:7], s34 offen offset:2048
  buffer_load_dwordx4 a[124:127], v1, s[4:7], s34 offen offset:3072
  s_add_u32 s34, s34, 4096
  buffer_load_dwordx4 a[128:131], v1, s[4:7], s34 offen offset:0
  buffer_load_dwordx4 a[132:135], v1, s[4:7], s34 offen offset:1024
  buffer_load_dwordx4 a[136:139], v1, s[4:7], s34 offen offset:2048
  buffer_load_dwordx4 a[140:143], v1, s[4:7], s34 offen offset:3072
  s_add_u32 s34, s34, 4096
  buffer_load_dwordx4 a[144:147], v1, s[4:7], s34 offen offset:0
  buffer_load_dwordx4 a[148:151], v1, s[4:7], s34 offen offset:1024
  buffer_load_dwordx4 a[152:155], v1, s[4:7], s34 offen offset:2048
  buffer_load_dwordx4 a[156:159], v1, s[4:7], s34 offen offset:3072
  s_waitcnt vmcnt(20)
  s_mul_i32 s34, s15, 12
  s_mul_i32 s35, s16, 6
  s_add_u32 s34, s34, s35
  s_add_u32 s34, s34, 4
  s_mul_i32 s34, s34, 20480
  s_add_u32 s34, s34, 22020096
  buffer_load_dwordx4 a[160:163], v1, s[4:7], s34 offen offset:0
  buffer_load_dwordx4 a[164:167], v1, s[4:7], s34 offen offset:1024
  buffer_load_dwordx4 a[168:171], v1, s[4:7], s34 offen offset:2048
  buffer_load_dwordx4 a[172:175], v1, s[4:7], s34 offen offset:3072
  s_add_u32 s34, s34, 4096
  buffer_load_dwordx4 a[176:179], v1, s[4:7], s34 offen offset:0
  buffer_load_dwordx4 a[180:183], v1, s[4:7], s34 offen offset:1024
  buffer_load_dwordx4 a[184:187], v1, s[4:7], s34 offen offset:2048
  buffer_load_dwordx4 a[188:191], v1, s[4:7], s34 offen offset:3072
  s_add_u32 s34, s34, 4096
  buffer_load_dwordx4 a[192:195], v1, s[4:7], s34 offen offset:0
  buffer_load_dwordx4 a[196:199], v1, s[4:7], s34 offen offset:1024
  buffer_load_dwordx4 a[200:203], v1, s[4:7], s34 offen offset:2048
  buffer_load_dwordx4 a[204:207], v1, s[4:7], s34 offen offset:3072
  s_add_u32 s34, s34, 4096
  buffer_load_dwordx4 a[208:211], v1, s[4:7], s34 offen offset:0
  buffer_load_dwordx4 a[212:215], v1, s[4:7], s34 offen offset:1024
  buffer_load_dwordx4 a[216:219], v1, s[4:7], s34 offen offset:2048
  buffer_load_dwordx4 a[220:223], v1, s[4:7], s34 offen offset:3072
  s_add_u32 s34, s34, 4096
  buffer_load_dwordx4 a[224:227], v1, s[4:7], s34 offen offset:0
  buffer_load_dwordx4 a[228:231], v1, s[4:7], s34 offen offset:1024
  buffer_load_dwordx4 a[232:235], v1, s[4:7], s34 offen offset:2048
  buffer_load_dwordx4 a[236:239], v1, s[4:7], s34 offen offset:3072
  s_waitcnt vmcnt(20)
  s_mul_i32 s34, s15, 12
  s_mul_i32 s35, s16, 6
  s_add_u32 s34, s34, s35
  s_add_u32 s34, s34, 5
  s_mul_i32 s34, s34, 20480
  s_add_u32 s34, s34, 22020096
  buffer_load_dwordx4 v[96:99], v1, s[4:7], s34 offen offset:0
  buffer_load_dwordx4 v[100:103], v1, s[4:7], s34 offen offset:1024
  buffer_load_dwordx4 v[104:107], v1, s[4:7], s34 offen offset:2048
  buffer_load_dwordx4 v[108:111], v1, s[4:7], s34 offen offset:3072
  s_add_u32 s34, s34, 4096
  buffer_load_dwordx4 v[112:115], v1, s[4:7], s34 offen offset:0
  buffer_load_dwordx4 v[116:119], v1, s[4:7], s34 offen offset:1024
  buffer_load_dwordx4 v[120:123], v1, s[4:7], s34 offen offset:2048
  buffer_load_dwordx4 v[124:127], v1, s[4:7], s34 offen offset:3072
  s_add_u32 s34, s34, 4096
  buffer_load_dwordx4 v[128:131], v1, s[4:7], s34 offen offset:0
  buffer_load_dwordx4 v[132:135], v1, s[4:7], s34 offen offset:1024
  buffer_load_dwordx4 v[136:139], v1, s[4:7], s34 offen offset:2048
  buffer_load_dwordx4 v[140:143], v1, s[4:7], s34 offen offset:3072
  s_add_u32 s34, s34, 4096
  buffer_load_dwordx4 v[144:147], v1, s[4:7], s34 offen offset:0
  buffer_load_dwordx4 v[148:151], v1, s[4:7], s34 offen offset:1024
  buffer_load_dwordx4 v[152:155], v1, s[4:7], s34 offen offset:2048
  buffer_load_dwordx4 v[156:159], v1, s[4:7], s34 offen offset:3072
  s_add_u32 s34, s34, 4096
  buffer_load_dwordx4 v[160:163], v1, s[4:7], s34 offen offset:0
  buffer_load_dwordx4 v[164:167], v1, s[4:7], s34 offen offset:1024
  buffer_load_dwordx4 v[168:171], v1, s[4:7], s34 offen offset:2048
  buffer_load_dwordx4 v[172:175], v1, s[4:7], s34 offen offset:3072
  s_waitcnt vmcnt(20)
  v_and_b32 v30, 7, v0
  v_lshlrev_b32 v30, 3, v30
reca_cens256:
  buffer_load_dwordx2 v[28:29], v30, s[8:11], 0 offen sc1
  s_waitcnt vmcnt(0)
  v_sad_u8 v31, v28, 0, 0
  v_sad_u8 v31, v29, 0, v31
  v_cmp_gt_u32 vcc, 32, v31
  s_cbranch_vccz reca_censok257
  s_sleep 8
  s_sub_u32 s18, s18, 1
  s_cbranch_scc0 reca_cens256
  s_mov_b32 s18, 0
reca_censok257:
  v_and_b32 v28, 0x20202020, v28
  v_and_b32 v29, 0x20202020, v29
  v_cmp_ne_u32 s[34:35], 0, v28
  v_cmp_ne_u32 s[36:37], 0, v29
  s_nop 3
  s_and_b32 s34, s34, 0xff
  s_and_b32 s36, s36, 0xff
  s_or_b32 s35, s34, s36
  s_lshr_b32 s37, s35, s13
  s_and_b32 s37, s37, 1
  s_xor_b32 s43, s37, 1
  s_cmp_eq_u32 s57, 0
  s_cselect_b32 s58, s36, s34
  v_mov_b32 v31, 0x80000000
  s_cmp_lg_u32 s43, 0
  s_cbranch_scc1 reca_pslow258
reca_ptop259:
  s_cmp_lt_u32 s17, 3
  s_cbranch_scc1 reca_pgo260
  s_sub_u32 s36, s17, 3
reca_ppoll261:
  buffer_load_dword v28, v4, s[4:7], s25 offen sc1
  s_waitcnt vmcnt(0)
  v_readfirstlane_b32 s34, v28
  s_nop 3
  s_cmp_ge_i32 s34, s36
  s_cbranch_scc1 reca_pgo260
  s_sleep 8
  s_sub_u32 s18, s18, 1
  s_cbranch_scc0 reca_ppoll261
  s_mov_b32 s18, 0
reca_pgo260:
  s_waitcnt vmcnt(0)
  s_barrier
  v_add_u32 v7, s26, v1
  s_xor_b32 s26, s26, 40960
  s_add_u32 s37, s17, 1
  s_cmp_ge_u32 s37, 64
  s_cbranch_scc1 reca_pnodma262
  s_mul_i32 s20, s37, 40960
  s_add_u32 s20, s20, 84955136
  s_add_u32 m0, s26, 20480
  s_nop 0
  buffer_load_dwordx4 v1, s[4:7], s20 offen offset:0 lds
  buffer_load_dwordx4 v1, s[4:7], s20 offen offset:1024 lds
  buffer_load_dwordx4 v1, s[4:7], s20 offen offset:2048 lds
  buffer_load_dwordx4 v1, s[4:7], s20 offen offset:3072 lds
  s_add_u32 s20, s20, 4096
  s_add_u32 m0, s26, 24576
  s_nop 0
  buffer_load_dwordx4 v1, s[4:7], s20 offen offset:0 lds
  buffer_load_dwordx4 v1, s[4:7], s20 offen offset:1024 lds
  buffer_load_dwordx4 v1, s[4:7], s20 offen offset:2048 lds
  buffer_load_dwordx4 v1, s[4:7], s20 offen offset:3072 lds
  s_add_u32 s20, s20, 4096
  s_add_u32 m0, s26, 28672
  s_nop 0
  buffer_load_dwordx4 v1, s[4:7], s20 offen offset:0 lds
  buffer_load_dwordx4 v1, s[4:7], s20 offen offset:1024 lds
reca_pnodma262:
  s_lshl_b32 s34, s15, 3
  s_and_b32 s35, s17, 7
  s_add_u32 s34, s34, s35
  s_mul_i32 s34, s34, 12288
  s_mul_i32 s35, s16, 3072
  s_add_u32 s35, s35, s34
  s_add_u32 s21, s35, 37748736
  s_add_u32 s22, s35, 44040192
  s_mul_i32 s35, s16, 6144
  s_add_u32 s35, s35, s34
  s_add_u32 s23, s35, 40894464
  ds_read_b128 v[72:75], v7 offset:0
  ds_read_b128 v[76:79], v7 offset:20480
  ds_read_b128 v[80:83], v7 offset:1024
  ds_read_b128 v[84:87], v7 offset:21504
  ds_read_b128 v[88:91], v7 offset:2048
  ds_read_b128 v[92:95], v7 offset:22528
  s_waitcnt lgkmcnt(4)
  v_mfma_f32_16x16x32_bf16 v[32:35], a[0:3], v[72:75], 0
  v_mfma_f32_16x16x32_bf16 v[36:39], a[0:3], v[76:79], 0
  v_mfma_f32_16x16x32_bf16 v[40:43], a[80:83], v[72:75], 0
  v_mfma_f32_16x16x32_bf16 v[44:47], a[80:83], v[76:79], 0
  v_mfma_f32_16x16x32_bf16 v[48:51], v[72:75], a[160:163], 0
  v_mfma_f32_16x16x32_bf16 v[52:55], v[76:79], a[160:163], 0
  v_mfma_f32_16x16x32_bf16 v[56:59], v[72:75], v[96:99], 0
  v_mfma_f32_16x16x32_bf16 v[60:63], v[76:79], v[96:99], 0
  ds_read_b128 v[72:75], v7 offset:3072
  ds_read_b128 v[76:79], v7 offset:23552
  s_waitcnt lgkmcnt(4)
  v_mfma_f32_16x16x32_bf16 v[32:35], a[4:7], v[80:83], v[32:35]
  v_mfma_f32_16x16x32_bf16 v[36:39], a[4:7], v[84:87], v[36:39]
  v_mfma_f32_16x16x32_bf16 v[40:43], a[84:87], v[80:83], v[40:43]
  v_mfma_f32_16x16x32_bf16 v[44:47], a[84:87], v[84:87], v[44:47]
  v_mfma_f32_16x16x32_bf16 v[48:51], v[80:83], a[164:167], v[48:51]
  v_mfma_f32_16x16x32_bf16 v[52:55], v[84:87], a[164:167], v[52:55]
  v_mfma_f32_16x16x32_bf16 v[56:59], v[80:83], v[100:103], v[56:59]
  v_mfma_f32_16x16x32_bf16 v[60:63], v[84:87], v[100:103], v[60:63]
  ds_read_b128 v[80:83], v7 offset:4096
  ds_read_b128 v[84:87], v7 offset:24576
  s_waitcnt lgkmcnt(4)
  v_mfma_f32_16x16x32_bf16 v[32:35], a[8:11], v[88:91], v[32:35]
  v_mfma_f32_16x16x32_bf16 v[36:39], a[8:11], v[92:95], v[36:39]
  v_mfma_f32_16x16x32_bf16 v[40:43], a[88:91], v[88:91], v[40:43]
  v_mfma_f32_16x16x32_bf16 v[44:47], a[88:91], v[92:95], v[44:47]
  v_mfma_f32_16x16x32_bf16 v[48:51], v[88:91], a[168:171], v[48:51]
  v_mfma_f32_16x16x32_bf16 v[52:55], v[92:95], a[168:171], v[52:55]
  v_mfma_f32_16x16x32_bf16 v[56:59], v[88:91], v[104:107], v[56:59]
  v_mfma_f32_16x16x32_bf16 v[60:63], v[92:95], v[104:107], v[60:63]
  ds_read_b128 v[88:91], v7 offset:5120
  ds_read_b128 v[92:95], v7 offset:25600
  s_waitcnt lgkmcnt(4)
  v_mfma_f32_16x16x32_bf16 v[32:35], a[12:15], v[72:75], v[32:35]
  v_mfma_f32_16x16x32_bf16 v[36:39], a[12:15], v[76:79], v[36:39]
  v_mfma_f32_16x16x32_bf16 v[40:43], a[92:95], v[72:75], v[40:43]
  v_mfma_f32_16x16x32_bf16 v[44:47], a[92:95], v[76:79], v[44:47]
  v_mfma_f32_16x16x32_bf16 v[48:51], v[72:75], a[172:175], v[48:51]
  v_mfma_f32_16x16x32_bf16 v[52:55], v[76:79], a[172:175], v[52:55]
  v_mfma_f32_16x16x32_bf16 v[56:59], v[72:75], v[108:111], v[56:59]
  v_mfma_f32_16x16x32_bf16 v[60:63], v[76:79], v[108:111], v[60:63]
  ds_read_b128 v[72:75], v7 offset:6144
  ds_read_b128 v[76:79], v7 offset:26624
  s_waitcnt lgkmcnt(4)
  v_mfma_f32_16x16x32_bf16 v[32:35], a[16:19], v[80:83], v[32:35]
  v_mfma_f32_16x16x32_bf16 v[36:39], a[16:19], v[84:87], v[36:39]
  v_mfma_f32_16x16x32_bf16 v[40:43], a[96:99], v[80:83], v[40:43]
  v_mfma_f32_16x16x32_bf16 v[44:47], a[96:99], v[84:87], v[44:47]
  v_mfma_f32_16x16x32_bf16 v[48:51], v[80:83], a[176:179], v[48:51]
  v_mfma_f32_16x16x32_bf16 v[52:55], v[84:87], a[176:179], v[52:55]
  v_mfma_f32_16x16x32_bf16 v[56:59], v[80:83], v[112:115], v[56:59]
  v_mfma_f32_16x16x32_bf16 v[60:63], v[84:87], v[112:115], v[60:63]
  ds_read_b128 v[80:83], v7 offset:7168
  ds_read_b128 v[84:87], v7 offset:27648
  s_waitcnt lgkmcnt(4)
  v_mfma_f32_16x16x32_bf16 v[32:35], a[20:23], v[88:91], v[32:35]
  v_mfma_f32_16x16x32_bf16 v[36:39], a[20:23], v[92:95], v[36:39]
  v_mfma_f32_16x16x32_bf16 v[40:43], a[100:103], v[88:91], v[40:43]
  v_mfma_f32_16x16x32_bf16 v[44:47], a[100:103], v[92:95], v[44:47]
  v_mfma_f32_16x16x32_bf16 v[48:51], v[88:91], a[180:183], v[48:51]
  v_mfma_f32_16x16x32_bf16 v[52:55], v[92:95], a[180:183], v[52:55]
  v_mfma_f32_16x16x32_bf16 v[56:59], v[88:91], v[116:119], v[56:59]
  v_mfma_f32_16x16x32_bf16 v[60:63], v[92:95], v[116:119], v[60:63]
  ds_read_b128 v[88:91], v7 offset:8192
  ds_read_b128 v[92:95], v7 offset:28672
  s_waitcnt lgkmcnt(4)
  v_mfma_f32_16x16x32_bf16 v[32:35], a[24:27], v[72:75], v[32:35]
  v_mfma_f32_16x16x32_bf16 v[36:39], a[24:27], v[76:79], v[36:39]
  v_mfma_f32_16x16x32_bf16 v[40:43], a[104:107], v[72:75], v[40:43]
  v_mfma_f32_16x16x32_bf16 v[44:47], a[104:107], v[76:79], v[44:47]
  v_mfma_f32_16x16x32_bf16 v[48:51], v[72:75], a[184:187], v[48:51]
  v_mfma_f32_16x16x32_bf16 v[52:55], v[76:79], a[184:187], v[52:55]
  v_mfma_f32_16x16x32_bf16 v[56:59], v[72:75], v[120:123], v[56:59]
  v_mfma_f32_16x16x32_bf16 v[60:63], v[76:79], v[120:123], v[60:63]
  ds_read_b128 v[72:75], v7 offset:9216
  ds_read_b128 v[76:79], v7 offset:29696
  s_waitcnt lgkmcnt(4)
  v_mfma_f32_16x16x32_bf16 v[32:35], a[28:31], v[80:83], v[32:35]
  v_mfma_f32_16x16x32_bf16 v[36:39], a[28:31], v[84:87], v[36:39]
  v_mfma_f32_16x16x32_bf16 v[40:43], a[108:111], v[80:83], v[40:43]
  v_mfma_f32_16x16x32_bf16 v[44:47], a[108:111], v[84:87], v[44:47]
  v_mfma_f32_16x16x32_bf16 v[48:51], v[80:83], a[188:191], v[48:51]
  v_mfma_f32_16x16x32_bf16 v[52:55], v[84:87], a[188:191], v[52:55]
  v_mfma_f32_16x16x32_bf16 v[56:59], v[80:83], v[124:127], v[56:59]
  v_mfma_f32_16x16x32_bf16 v[60:63], v[84:87], v[124:127], v[60:63]
  ds_read_b128 v[80:83], v7 offset:10240
  ds_read_b128 v[84:87], v7 offset:30720
  s_waitcnt lgkmcnt(4)
  v_mfma_f32_16x16x32_bf16 v[32:35], a[32:35], v[88:91], v[32:35]
  v_mfma_f32_16x16x32_bf16 v[36:39], a[32:35], v[92:95], v[36:39]
  v_mfma_f32_16x16x32_bf16 v[40:43], a[112:115], v[88:91], v[40:43]
  v_mfma_f32_16x16x32_bf16 v[44:47], a[112:115], v[92:95], v[44:47]
  v_mfma_f32_16x16x32_bf16 v[48:51], v[88:91], a[192:195], v[48:51]
  v_mfma_f32_16x16x32_bf16 v[52:55], v[92:95], a[192:195], v[52:55]
  v_mfma_f32_16x16x32_bf16 v[56:59], v[88:91], v[128:131], v[56:59]
  v_mfma_f32_16x16x32_bf16 v[60:63], v[92:95], v[128:131], v[60:63]
  ds_read_b128 v[88:91], v7 offset:11264
  ds_read_b128 v[92:95], v7 offset:31744
  s_waitcnt lgkmcnt(4)
  v_mfma_f32_16x16x32_bf16 v[32:35], a[36:39], v[72:75], v[32:35]
  v_mfma_f32_16x16x32_bf16 v[36:39], a[36:39], v[76:79], v[36:39]
  v_mfma_f32_16x16x32_bf16 v[40:43], a[116:119], v[72:75], v[40:43]
  v_mfma_f32_16x16x32_bf16 v[44:47], a[116:119], v[76:79], v[44:47]
  v_mfma_f32_16x16x32_bf16 v[48:51], v[72:75], a[196:199], v[48:51]
  v_mfma_f32_16x16x32_bf16 v[52:55], v[76:79], a[196:199], v[52:55]
  v_mfma_f32_16x16x32_bf16 v[56:59], v[72:75], v[132:135], v[56:59]
  v_mfma_f32_16x16x32_bf16 v[60:63], v[76:79], v[132:135], v[60:63]
  ds_read_b128 v[72:75], v7 offset:12288
  ds_read_b128 v[76:79], v7 offset:32768
  s_waitcnt lgkmcnt(4)
  v_mfma_f32_16x16x32_bf16 v[32:35], a[40:43], v[80:83], v[32:35]
  v_mfma_f32_16x16x32_bf16 v[36:39], a[40:43], v[84:87], v[36:39]
  v_mfma_f32_16x16x32_bf16 v[40:43], a[120:123], v[80:83], v[40:43]
  v_mfma_f32_16x16x32_bf16 v[44:47], a[120:123], v[84:87], v[44:47]
  v_mfma_f32_16x16x32_bf16 v[48:51], v[80:83], a[200:203], v[48:51]
  v_mfma_f32_16x16x32_bf16 v[52:55], v[84:87], a[200:203], v[52:55]
  v_mfma_f32_16x16x32_bf16 v[56:59], v[80:83], v[136:139], v[56:59]
  v_mfma_f32_16x16x32_bf16 v[60:63], v[84:87], v[136:139], v[60:63]
  ds_read_b128 v[80:83], v7 offset:13312
  ds_read_b128 v[84:87], v7 offset:33792
  s_waitcnt lgkmcnt(4)
  v_mfma_f32_16x16x32_bf16 v[32:35], a[44:47], v[88:91], v[32:35]
  v_mfma_f32_16x16x32_bf16 v[36:39], a[44:47], v[92:95], v[36:39]
  v_mfma_f32_16x16x32_bf16 v[40:43], a[124:127], v[88:91], v[40:43]
  v_mfma_f32_16x16x32_bf16 v[44:47], a[124:127], v[92:95], v[44:47]
  v_mfma_f32_16x16x32_bf16 v[48:51], v[88:91], a[204:207], v[48:51]
  v_mfma_f32_16x16x32_bf16 v[52:55], v[92:95], a[204:207], v[52:55]
  v_mfma_f32_16x16x32_bf16 v[56:59], v[88:91], v[140:143], v[56:59]
  v_mfma_f32_16x16x32_bf16 v[60:63], v[92:95], v[140:143], v[60:63]
  ds_read_b128 v[88:91], v7 offset:14336
  ds_read_b128 v[92:95], v7 offset:34816
  s_waitcnt lgkmcnt(4)
  v_mfma_f32_16x16x32_bf16 v[32:35], a[48:51], v[72:75], v[32:35]
  v_mfma_f32_16x16x32_bf16 v[36:39], a[48:51], v[76:79], v[36:39]
  v_mfma_f32_16x16x32_bf16 v[40:43], a[128:131], v[72:75], v[40:43]
  v_mfma_f32_16x16x32_bf16 v[44:47], a[128:131], v[76:79], v[44:47]
  v_mfma_f32_16x16x32_bf16 v[48:51], v[72:75], a[208:211], v[48:51]
  v_mfma_f32_16x16x32_bf16 v[52:55], v[76:79], a[208:211], v[52:55]
  v_mfma_f32_16x16x32_bf16 v[56:59], v[72:75], v[144:147], v[56:59]
  v_mfma_f32_16x16x32_bf16 v[60:63], v[76:79], v[144:147], v[60:63]
  ds_read_b128 v[72:75], v7 offset:15360
  ds_read_b128 v[76:79], v7 offset:35840
  s_waitcnt lgkmcnt(4)
  v_mfma_f32_16x16x32_bf16 v[32:35], a[52:55], v[80:83], v[32:35]
  v_mfma_f32_16x16x32_bf16 v[36:39], a[52:55], v[84:87], v[36:39]
  v_mfma_f32_16x16x32_bf16 v[40:43], a[132:135], v[80:83], v[40:43]
  v_mfma_f32_16x16x32_bf16 v[44:47], a[132:135], v[84:87], v[44:47]
  v_mfma_f32_16x16x32_bf16 v[48:51], v[80:83], a[212:215], v[48:51]
  v_mfma_f32_16x16x32_bf16 v[52:55], v[84:87], a[212:215], v[52:55]
  v_mfma_f32_16x16x32_bf16 v[56:59], v[80:83], v[148:151], v[56:59]
  v_mfma_f32_16x16x32_bf16 v[60:63], v[84:87], v[148:151], v[60:63]
  ds_read_b128 v[80:83], v7 offset:16384
  ds_read_b128 v[84:87], v7 offset:36864
  s_waitcnt lgkmcnt(4)
  v_mfma_f32_16x16x32_bf16 v[32:35], a[56:59], v[88:91], v[32:35]
  v_mfma_f32_16x16x32_bf16 v[36:39], a[56:59], v[92:95], v[36:39]
  v_mfma_f32_16x16x32_bf16 v[40:43], a[136:139], v[88:91], v[40:43]
  v_mfma_f32_16x16x32_bf16 v[44:47], a[136:139], v[92:95], v[44:47]
  v_mfma_f32_16x16x32_bf16 v[48:51], v[88:91], a[216:219], v[48:51]
  v_mfma_f32_16x16x32_bf16 v[52:55], v[92:95], a[216:219], v[52:55]
  v_mfma_f32_16x16x32_bf16 v[56:59], v[88:91], v[152:155], v[56:59]
  v_mfma_f32_16x16x32_bf16 v[60:63], v[92:95], v[152:155], v[60:63]
  ds_read_b128 v[88:91], v7 offset:17408
  ds_read_b128 v[92:95], v7 offset:37888
  s_waitcnt lgkmcnt(4)
  v_mfma_f32_16x16x32_bf16 v[32:35], a[60:63], v[72:75], v[32:35]
  v_mfma_f32_16x16x32_bf16 v[36:39], a[60:63], v[76:79], v[36:39]
  v_mfma_f32_16x16x32_bf16 v[40:43], a[140:143], v[72:75], v[40:43]
  v_mfma_f32_16x16x32_bf16 v[44:47], a[140:143], v[76:79], v[44:47]
  v_mfma_f32_16x16x32_bf16 v[48:51], v[72:75], a[220:223], v[48:51]
  v_mfma_f32_16x16x32_bf16 v[52:55], v[76:79], a[220:223], v[52:55]
  v_mfma_f32_16x16x32_bf16 v[56:59], v[72:75], v[156:159], v[56:59]
  v_mfma_f32_16x16x32_bf16 v[60:63], v[76:79], v[156:159], v[60:63]
  ds_read_b128 v[72:75], v7 offset:18432
  ds_read_b128 v[76:79], v7 offset:38912
  s_waitcnt lgkmcnt(4)
  v_mfma_f32_16x16x32_bf16 v[32:35], a[64:67], v[80:83], v[32:35]
  v_mfma_f32_16x16x32_bf16 v[36:39], a[64:67], v[84:87], v[36:39]
  v_mfma_f32_16x16x32_bf16 v[40:43], a[144:147], v[80:83], v[40:43]
  v_mfma_f32_16x16x32_bf16 v[44:47], a[144:147], v[84:87], v[44:47]
  v_mfma_f32_16x16x32_bf16 v[48:51], v[80:83], a[224:227], v[48:51]
  v_mfma_f32_16x16x32_bf16 v[52:55], v[84:87], a[224:227], v[52:55]
  v_mfma_f32_16x16x32_bf16 v[56:59], v[80:83], v[160:163], v[56:59]
  v_mfma_f32_16x16x32_bf16 v[60:63], v[84:87], v[160:163], v[60:63]
  ds_read_b128 v[80:83], v7 offset:19456
  ds_read_b128 v[84:87], v7 offset:39936
  s_waitcnt lgkmcnt(4)
  v_mfma_f32_16x16x32_bf16 v[32:35], a[68:71], v[88:91], v[32:35]
  v_mfma_f32_16x16x32_bf16 v[36:39], a[68:71], v[92:95], v[36:39]
  v_mfma_f32_16x16x32_bf16 v[40:43], a[148:151], v[88:91], v[40:43]
  v_mfma_f32_16x16x32_bf16 v[44:47], a[148:151], v[92:95], v[44:47]
  v_mfma_f32_16x16x32_bf16 v[48:51], v[88:91], a[228:231], v[48:51]
  v_mfma_f32_16x16x32_bf16 v[52:55], v[92:95], a[228:231], v[52:55]
  v_mfma_f32_16x16x32_bf16 v[56:59], v[88:91], v[164:167], v[56:59]
  v_mfma_f32_16x16x32_bf16 v[60:63], v[92:95], v[164:167], v[60:63]
  s_waitcnt lgkmcnt(2)
  v_mfma_f32_16x16x32_bf16 v[32:35], a[72:75], v[72:75], v[32:35]
  v_mfma_f32_16x16x32_bf16 v[36:39], a[72:75], v[76:79], v[36:39]
  v_mfma_f32_16x16x32_bf16 v[40:43], a[152:155], v[72:75], v[40:43]
  v_mfma_f32_16x16x32_bf16 v[44:47], a[152:155], v[76:79], v[44:47]
  v_mfma_f32_16x16x32_bf16 v[48:51], v[72:75], a[232:235], v[48:51]
  v_mfma_f32_16x16x32_bf16 v[52:55], v[76:79], a[232:235], v[52:55]
  v_mfma_f32_16x16x32_bf16 v[56:59], v[72:75], v[168:171], v[56:59]
  v_mfma_f32_16x16x32_bf16 v[60:63], v[76:79], v[168:171], v[60:63]
  s_waitcnt lgkmcnt(0)
  v_mfma_f32_16x16x32_bf16 v[32:35], a[76:79], v[80:83], v[32:35]
  v_mfma_f32_16x16x32_bf16 v[36:39], a[76:79], v[84:87], v[36:39]
  v_mfma_f32_16x16x32_bf16 v[40:43], a[156:159], v[80:83], v[40:43]
  v_mfma_f32_16x16x32_bf16 v[44:47], a[156:159], v[84:87], v[44:47]
  v_mfma_f32_16x16x32_bf16 v[48:51], v[80:83], a[236:239], v[48:51]
  v_mfma_f32_16x16x32_bf16 v[52:55], v[84:87], a[236:239], v[52:55]
  v_mfma_f32_16x16x32_bf16 v[56:59], v[80:83], v[172:175], v[56:59]
  v_mfma_f32_16x16x32_bf16 v[60:63], v[84:87], v[172:175], v[60:63]
  s_nop 0
  v_cvt_pk_bf16_f32 v8, v32, v33
  v_cvt_pk_bf16_f32 v9, v34, v35
  v_cvt_pk_bf16_f32 v10, v40, v41
  v_cvt_pk_bf16_f32 v11, v42, v43
  s_add_u32 s34, s22, 0
  buffer_store_dwordx4 v[8:11], v1, s[4:7], s34 offen
  v_cvt_pk_bf16_f32 v12, v36, v37
  v_cvt_pk_bf16_f32 v13, v38, v39
  v_cvt_pk_bf16_f32 v14, v44, v45
  v_cvt_pk_bf16_f32 v15, v46, v47
  s_add_u32 s34, s22, 6144
  buffer_store_dwordx4 v[12:15], v1, s[4:7], s34 offen
  v_cvt_pk_bf16_f32 v8, v48, v49
  v_cvt_pk_bf16_f32 v9, v50, v51
  v_cvt_pk_bf16_f32 v10, v52, v53
  v_cvt_pk_bf16_f32 v11, v54, v55
  s_add_u32 s34, s23, 4096
  buffer_store_dwordx4 v[8:11], v1, s[4:7], s34 offen
  v_cvt_pk_bf16_f32 v12, v56, v57
  v_cvt_pk_bf16_f32 v13, v58, v59
  v_cvt_pk_bf16_f32 v14, v60, v61
  v_cvt_pk_bf16_f32 v15, v62, v63
  s_add_u32 s34, s23, 5120
  buffer_store_dwordx4 v[12:15], v1, s[4:7], s34 offen
  s_waitcnt vmcnt(0)
  s_barrier
  s_add_u32 s17, s17, 1
  s_cmp_lt_u32 s17, 64
  s_cbranch_scc1 reca_ptop259
  s_branch reca_exit1
reca_pslow258:
reca_ptop264:
  s_cmp_lt_u32 s17, 3
  s_cbranch_scc1 reca_pgo265
  s_sub_u32 s36, s17, 3
reca_ppoll266:
  buffer_load_dword v28, v4, s[4:7], s25 offen sc1
  s_waitcnt vmcnt(0)
  v_readfirstlane_b32 s34, v28
  s_nop 3
  s_cmp_ge_i32 s34, s36
  s_cbranch_scc1 reca_pgo265
  s_sleep 8
  s_sub_u32 s18, s18, 1
  s_cbranch_scc0 reca_ppoll266
  s_mov_b32 s18, 0
reca_pgo265:
  s_waitcnt vmcnt(0)
  s_barrier
  v_add_u32 v7, s26, v1
  s_xor_b32 s26, s26, 40960
  s_add_u32 s37, s17, 1
  s_cmp_ge_u32 s37, 64
  s_cbranch_scc1 reca_pnodma267
  s_mul_i32 s20, s37, 40960
  s_add_u32 s20, s20, 84955136
  s_add_u32 m0, s26, 20480
  s_nop 0
  buffer_load_dwordx4 v1, s[4:7], s20 offen offset:0 lds
  buffer_load_dwordx4 v1, s[4:7], s20 offen offset:1024 lds
  buffer_load_dwordx4 v1, s[4:7], s20 offen offset:2048 lds
  buffer_load_dwordx4 v1, s[4:7], s20 offen offset:3072 lds
  s_add_u32 s20, s20, 4096
  s_add_u32 m0, s26, 24576
  s_nop 0
  buffer_load_dwordx4 v1, s[4:7], s20 offen offset:0 lds
  buffer_load_dwordx4 v1, s[4:7], s20 offen offset:1024 lds
  buffer_load_dwordx4 v1, s[4:7], s20 offen offset:2048 lds
  buffer_load_dwordx4 v1, s[4:7], s20 offen offset:3072 lds
  s_add_u32 s20, s20, 4096
  s_add_u32 m0, s26, 28672
  s_nop 0
  buffer_load_dwordx4 v1, s[4:7], s20 offen offset:0 lds
  buffer_load_dwordx4 v1, s[4:7], s20 offen offset:1024 lds
reca_pnodma267:
  s_lshl_b32 s34, s15, 3
  s_and_b32 s35, s17, 7
  s_add_u32 s34, s34, s35
  s_mul_i32 s34, s34, 12288
  s_mul_i32 s35, s16, 3072
  s_add_u32 s35, s35, s34
  s_add_u32 s21, s35, 37748736
  s_add_u32 s22, s35, 44040192
  s_mul_i32 s35, s16, 6144
  s_add_u32 s35, s35, s34
  s_add_u32 s23, s35, 40894464
  ds_read_b128 v[72:75], v7 offset:0
  ds_read_b128 v[76:79], v7 offset:20480
  ds_read_b128 v[80:83], v7 offset:1024
  ds_read_b128 v[84:87], v7 offset:21504
  ds_read_b128 v[88:91], v7 offset:2048
  ds_read_b128 v[92:95], v7 offset:22528
  s_waitcnt lgkmcnt(4)
  v_mfma_f32_16x16x32_bf16 v[32:35], a[0:3], v[72:75], 0
  v_mfma_f32_16x16x32_bf16 v[36:39], a[0:3], v[76:79], 0
  v_mfma_f32_16x16x32_bf16 v[40:43], a[80:83], v[72:75], 0
  v_mfma_f32_16x16x32_bf16 v[44:47], a[80:83], v[76:79], 0
  v_mfma_f32_16x16x32_bf16 v[48:51], v[72:75], a[160:163], 0
  v_mfma_f32_16x16x32_bf16 v[52:55], v[76:79], a[160:163], 0
  v_mfma_f32_16x16x32_bf16 v[56:59], v[72:75], v[96:99], 0
  v_mfma_f32_16x16x32_bf16 v[60:63], v[76:79], v[96:99], 0
  ds_read_b128 v[72:75], v7 offset:3072
  ds_read_b128 v[76:79], v7 offset:23552
  s_waitcnt lgkmcnt(4)
  v_mfma_f32_16x16x32_bf16 v[32:35], a[4:7], v[80:83], v[32:35]
  v_mfma_f32_16x16x32_bf16 v[36:39], a[4:7], v[84:87], v[36:39]
  v_mfma_f32_16x16x32_bf16 v[40:43], a[84:87], v[80:83], v[40:43]
  v_mfma_f32_16x16x32_bf16 v[44:47], a[84:87], v[84:87], v[44:47]
  v_mfma_f32_16x16x32_bf16 v[48:51], v[80:83], a[164:167], v[48:51]
  v_mfma_f32_16x16x32_bf16 v[52:55], v[84:87], a[164:167], v[52:55]
  v_mfma_f32_16x16x32_bf16 v[56:59], v[80:83], v[100:103], v[56:59]
  v_mfma_f32_16x16x32_bf16 v[60:63], v[84:87], v[100:103], v[60:63]
  ds_read_b128 v[80:83], v7 offset:4096
  ds_read_b128 v[84:87], v7 offset:24576
  s_waitcnt lgkmcnt(4)
  v_mfma_f32_16x16x32_bf16 v[32:35], a[8:11], v[88:91], v[32:35]
  v_mfma_f32_16x16x32_bf16 v[36:39], a[8:11], v[92:95], v[36:39]
  v_mfma_f32_16x16x32_bf16 v[40:43], a[88:91], v[88:91], v[40:43]
  v_mfma_f32_16x16x32_bf16 v[44:47], a[88:91], v[92:95], v[44:47]
  v_mfma_f32_16x16x32_bf16 v[48:51], v[88:91], a[168:171], v[48:51]
  v_mfma_f32_16x16x32_bf16 v[52:55], v[92:95], a[168:171], v[52:55]
  v_mfma_f32_16x16x32_bf16 v[56:59], v[88:91], v[104:107], v[56:59]
  v_mfma_f32_16x16x32_bf16 v[60:63], v[92:95], v[104:107], v[60:63]
  ds_read_b128 v[88:91], v7 offset:5120
  ds_read_b128 v[92:95], v7 offset:25600
  s_waitcnt lgkmcnt(4)
  v_mfma_f32_16x16x32_bf16 v[32:35], a[12:15], v[72:75], v[32:35]
  v_mfma_f32_16x16x32_bf16 v[36:39], a[12:15], v[76:79], v[36:39]
  v_mfma_f32_16x16x32_bf16 v[40:43], a[92:95], v[72:75], v[40:43]
  v_mfma_f32_16x16x32_bf16 v[44:47], a[92:95], v[76:79], v[44:47]
  v_mfma_f32_16x16x32_bf16 v[48:51], v[72:75], a[172:175], v[48:51]
  v_mfma_f32_16x16x32_bf16 v[52:55], v[76:79], a[172:175], v[52:55]
  v_mfma_f32_16x16x32_bf16 v[56:59], v[72:75], v[108:111], v[56:59]
  v_mfma_f32_16x16x32_bf16 v[60:63], v[76:79], v[108:111], v[60:63]
  ds_read_b128 v[72:75], v7 offset:6144
  ds_read_b128 v[76:79], v7 offset:26624
  s_waitcnt lgkmcnt(4)
  v_mfma_f32_16x16x32_bf16 v[32:35], a[16:19], v[80:83], v[32:35]
  v_mfma_f32_16x16x32_bf16 v[36:39], a[16:19], v[84:87], v[36:39]
  v_mfma_f32_16x16x32_bf16 v[40:43], a[96:99], v[80:83], v[40:43]
  v_mfma_f32_16x16x32_bf16 v[44:47], a[96:99], v[84:87], v[44:47]
  v_mfma_f32_16x16x32_bf16 v[48:51], v[80:83], a[176:179], v[48:51]
  v_mfma_f32_16x16x32_bf16 v[52:55], v[84:87], a[176:179], v[52:55]
  v_mfma_f32_16x16x32_bf16 v[56:59], v[80:83], v[112:115], v[56:59]
  v_mfma_f32_16x16x32_bf16 v[60:63], v[84:87], v[112:115], v[60:63]
  ds_read_b128 v[80:83], v7 offset:7168
  ds_read_b128 v[84:87], v7 offset:27648
  s_waitcnt lgkmcnt(4)
  v_mfma_f32_16x16x32_bf16 v[32:35], a[20:23], v[88:91], v[32:35]
  v_mfma_f32_16x16x32_bf16 v[36:39], a[20:23], v[92:95], v[36:39]
  v_mfma_f32_16x16x32_bf16 v[40:43], a[100:103], v[88:91], v[40:43]
  v_mfma_f32_16x16x32_bf16 v[44:47], a[100:103], v[92:95], v[44:47]
  v_mfma_f32_16x16x32_bf16 v[48:51], v[88:91], a[180:183], v[48:51]
  v_mfma_f32_16x16x32_bf16 v[52:55], v[92:95], a[180:183], v[52:55]
  v_mfma_f32_16x16x32_bf16 v[56:59], v[88:91], v[116:119], v[56:59]
  v_mfma_f32_16x16x32_bf16 v[60:63], v[92:95], v[116:119], v[60:63]
  ds_read_b128 v[88:91], v7 offset:8192
  ds_read_b128 v[92:95], v7 offset:28672
  s_waitcnt lgkmcnt(4)
  v_mfma_f32_16x16x32_bf16 v[32:35], a[24:27], v[72:75], v[32:35]
  v_mfma_f32_16x16x32_bf16 v[36:39], a[24:27], v[76:79], v[36:39]
  v_mfma_f32_16x16x32_bf16 v[40:43], a[104:107], v[72:75], v[40:43]
  v_mfma_f32_16x16x32_bf16 v[44:47], a[104:107], v[76:79], v[44:47]
  v_mfma_f32_16x16x32_bf16 v[48:51], v[72:75], a[184:187], v[48:51]
  v_mfma_f32_16x16x32_bf16 v[52:55], v[76:79], a[184:187], v[52:55]
  v_mfma_f32_16x16x32_bf16 v[56:59], v[72:75], v[120:123], v[56:59]
  v_mfma_f32_16x16x32_bf16 v[60:63], v[76:79], v[120:123], v[60:63]
  ds_read_b128 v[72:75], v7 offset:9216
  ds_read_b128 v[76:79], v7 offset:29696
  s_waitcnt lgkmcnt(4)
  v_mfma_f32_16x16x32_bf16 v[32:35], a[28:31], v[80:83], v[32:35]
  v_mfma_f32_16x16x32_bf16 v[36:39], a[28:31], v[84:87], v[36:39]
  v_mfma_f32_16x16x32_bf16 v[40:43], a[108:111], v[80:83], v[40:43]
  v_mfma_f32_16x16x32_bf16 v[44:47], a[108:111], v[84:87], v[44:47]
  v_mfma_f32_16x16x32_bf16 v[48:51], v[80:83], a[188:191], v[48:51]
  v_mfma_f32_16x16x32_bf16 v[52:55], v[84:87], a[188:191], v[52:55]
  v_mfma_f32_16x16x32_bf16 v[56:59], v[80:83], v[124:127], v[56:59]
  v_mfma_f32_16x16x32_bf16 v[60:63], v[84:87], v[124:127], v[60:63]
  ds_read_b128 v[80:83], v7 offset:10240
  ds_read_b128 v[84:87], v7 offset:30720
  s_waitcnt lgkmcnt(4)
  v_mfma_f32_16x16x32_bf16 v[32:35], a[32:35], v[88:91], v[32:35]
  v_mfma_f32_16x16x32_bf16 v[36:39], a[32:35], v[92:95], v[36:39]
  v_mfma_f32_16x16x32_bf16 v[40:43], a[112:115], v[88:91], v[40:43]
  v_mfma_f32_16x16x32_bf16 v[44:47], a[112:115], v[92:95], v[44:47]
  v_mfma_f32_16x16x32_bf16 v[48:51], v[88:91], a[192:195], v[48:51]
  v_mfma_f32_16x16x32_bf16 v[52:55], v[92:95], a[192:195], v[52:55]
  v_mfma_f32_16x16x32_bf16 v[56:59], v[88:91], v[128:131], v[56:59]
  v_mfma_f32_16x16x32_bf16 v[60:63], v[92:95], v[128:131], v[60:63]
  ds_read_b128 v[88:91], v7 offset:11264
  ds_read_b128 v[92:95], v7 offset:31744
  s_waitcnt lgkmcnt(4)
  v_mfma_f32_16x16x32_bf16 v[32:35], a[36:39], v[72:75], v[32:35]
  v_mfma_f32_16x16x32_bf16 v[36:39], a[36:39], v[76:79], v[36:39]
  v_mfma_f32_16x16x32_bf16 v[40:43], a[116:119], v[72:75], v[40:43]
  v_mfma_f32_16x16x32_bf16 v[44:47], a[116:119], v[76:79], v[44:47]
  v_mfma_f32_16x16x32_bf16 v[48:51], v[72:75], a[196:199], v[48:51]
  v_mfma_f32_16x16x32_bf16 v[52:55], v[76:79], a[196:199], v[52:55]
  v_mfma_f32_16x16x32_bf16 v[56:59], v[72:75], v[132:135], v[56:59]
  v_mfma_f32_16x16x32_bf16 v[60:63], v[76:79], v[132:135], v[60:63]
  ds_read_b128 v[72:75], v7 offset:12288
  ds_read_b128 v[76:79], v7 offset:32768
  s_waitcnt lgkmcnt(4)
  v_mfma_f32_16x16x32_bf16 v[32:35], a[40:43], v[80:83], v[32:35]
  v_mfma_f32_16x16x32_bf16 v[36:39], a[40:43], v[84:87], v[36:39]
  v_mfma_f32_16x16x32_bf16 v[40:43], a[120:123], v[80:83], v[40:43]
  v_mfma_f32_16x16x32_bf16 v[44:47], a[120:123], v[84:87], v[44:47]
  v_mfma_f32_16x16x32_bf16 v[48:51], v[80:83], a[200:203], v[48:51]
  v_mfma_f32_16x16x32_bf16 v[52:55], v[84:87], a[200:203], v[52:55]
  v_mfma_f32_16x16x32_bf16 v[56:59], v[80:83], v[136:139], v[56:59]
  v_mfma_f32_16x16x32_bf16 v[60:63], v[84:87], v[136:139], v[60:63]
  ds_read_b128 v[80:83], v7 offset:13312
  ds_read_b128 v[84:87], v7 offset:33792
  s_waitcnt lgkmcnt(4)
  v_mfma_f32_16x16x32_bf16 v[32:35], a[44:47], v[88:91], v[32:35]
  v_mfma_f32_16x16x32_bf16 v[36:39], a[44:47], v[92:95], v[36:39]
  v_mfma_f32_16x16x32_bf16 v[40:43], a[124:127], v[88:91], v[40:43]
  v_mfma_f32_16x16x32_bf16 v[44:47], a[124:127], v[92:95], v[44:47]
  v_mfma_f32_16x16x32_bf16 v[48:51], v[88:91], a[204:207], v[48:51]
  v_mfma_f32_16x16x32_bf16 v[52:55], v[92:95], a[204:207], v[52:55]
  v_mfma_f32_16x16x32_bf16 v[56:59], v[88:91], v[140:143], v[56:59]
  v_mfma_f32_16x16x32_bf16 v[60:63], v[92:95], v[140:143], v[60:63]
  ds_read_b128 v[88:91], v7 offset:14336
  ds_read_b128 v[92:95], v7 offset:34816
  s_waitcnt lgkmcnt(4)
  v_mfma_f32_16x16x32_bf16 v[32:35], a[48:51], v[72:75], v[32:35]
  v_mfma_f32_16x16x32_bf16 v[36:39], a[48:51], v[76:79], v[36:39]
  v_mfma_f32_16x16x32_bf16 v[40:43], a[128:131], v[72:75], v[40:43]
  v_mfma_f32_16x16x32_bf16 v[44:47], a[128:131], v[76:79], v[44:47]
  v_mfma_f32_16x16x32_bf16 v[48:51], v[72:75], a[208:211], v[48:51]
  v_mfma_f32_16x16x32_bf16 v[52:55], v[76:79], a[208:211], v[52:55]
  v_mfma_f32_16x16x32_bf16 v[56:59], v[72:75], v[144:147], v[56:59]
  v_mfma_f32_16x16x32_bf16 v[60:63], v[76:79], v[144:147], v[60:63]
  ds_read_b128 v[72:75], v7 offset:15360
  ds_read_b128 v[76:79], v7 offset:35840
  s_waitcnt lgkmcnt(4)
  v_mfma_f32_16x16x32_bf16 v[32:35], a[52:55], v[80:83], v[32:35]
  v_mfma_f32_16x16x32_bf16 v[36:39], a[52:55], v[84:87], v[36:39]
  v_mfma_f32_16x16x32_bf16 v[40:43], a[132:135], v[80:83], v[40:43]
  v_mfma_f32_16x16x32_bf16 v[44:47], a[132:135], v[84:87], v[44:47]
  v_mfma_f32_16x16x32_bf16 v[48:51], v[80:83], a[212:215], v[48:51]
  v_mfma_f32_16x16x32_bf16 v[52:55], v[84:87], a[212:215], v[52:55]
  v_mfma_f32_16x16x32_bf16 v[56:59], v[80:83], v[148:151], v[56:59]
  v_mfma_f32_16x16x32_bf16 v[60:63], v[84:87], v[148:151], v[60:63]
  ds_read_b128 v[80:83], v7 offset:16384
  ds_read_b128 v[84:87], v7 offset:36864
  s_waitcnt lgkmcnt(4)
  v_mfma_f32_16x16x32_bf16 v[32:35], a[56:59], v[88:91], v[32:35]
  v_mfma_f32_16x16x32_bf16 v[36:39], a[56:59], v[92:95], v[36:39]
  v_mfma_f32_16x16x32_bf16 v[40:43], a[136:139], v[88:91], v[40:43]
  v_mfma_f32_16x16x32_bf16 v[44:47], a[136:139], v[92:95], v[44:47]
  v_mfma_f32_16x16x32_bf16 v[48:51], v[88:91], a[216:219], v[48:51]
  v_mfma_f32_16x16x32_bf16 v[52:55], v[92:95], a[216:219], v[52:55]
  v_mfma_f32_16x16x32_bf16 v[56:59], v[88:91], v[152:155], v[56:59]
  v_mfma_f32_16x16x32_bf16 v[60:63], v[92:95], v[152:155], v[60:63]
  ds_read_b128 v[88:91], v7 offset:17408
  ds_read_b128 v[92:95], v7 offset:37888
  s_waitcnt lgkmcnt(4)
  v_mfma_f32_16x16x32_bf16 v[32:35], a[60:63], v[72:75], v[32:35]
  v_mfma_f32_16x16x32_bf16 v[36:39], a[60:63], v[76:79], v[36:39]
  v_mfma_f32_16x16x32_bf16 v[40:43], a[140:143], v[72:75], v[40:43]
  v_mfma_f32_16x16x32_bf16 v[44:47], a[140:143], v[76:79], v[44:47]
  v_mfma_f32_16x16x32_bf16 v[48:51], v[72:75], a[220:223], v[48:51]
  v_mfma_f32_16x16x32_bf16 v[52:55], v[76:79], a[220:223], v[52:55]
  v_mfma_f32_16x16x32_bf16 v[56:59], v[72:75], v[156:159], v[56:59]
  v_mfma_f32_16x16x32_bf16 v[60:63], v[76:79], v[156:159], v[60:63]
  ds_read_b128 v[72:75], v7 offset:18432
  ds_read_b128 v[76:79], v7 offset:38912
  s_waitcnt lgkmcnt(4)
  v_mfma_f32_16x16x32_bf16 v[32:35], a[64:67], v[80:83], v[32:35]
  v_mfma_f32_16x16x32_bf16 v[36:39], a[64:67], v[84:87], v[36:39]
  v_mfma_f32_16x16x32_bf16 v[40:43], a[144:147], v[80:83], v[40:43]
  v_mfma_f32_16x16x32_bf16 v[44:47], a[144:147], v[84:87], v[44:47]
  v_mfma_f32_16x16x32_bf16 v[48:51], v[80:83], a[224:227], v[48:51]
  v_mfma_f32_16x16x32_bf16 v[52:55], v[84:87], a[224:227], v[52:55]
  v_mfma_f32_16x16x32_bf16 v[56:59], v[80:83], v[160:163], v[56:59]
  v_mfma_f32_16x16x32_bf16 v[60:63], v[84:87], v[160:163], v[60:63]
  ds_read_b128 v[80:83], v7 offset:19456
  ds_read_b128 v[84:87], v7 offset:39936
  s_waitcnt lgkmcnt(4)
  v_mfma_f32_16x16x32_bf16 v[32:35], a[68:71], v[88:91], v[32:35]
  v_mfma_f32_16x16x32_bf16 v[36:39], a[68:71], v[92:95], v[36:39]
  v_mfma_f32_16x16x32_bf16 v[40:43], a[148:151], v[88:91], v[40:43]
  v_mfma_f32_16x16x32_bf16 v[44:47], a[148:151], v[92:95], v[44:47]
  v_mfma_f32_16x16x32_bf16 v[48:51], v[88:91], a[228:231], v[48:51]
  v_mfma_f32_16x16x32_bf16 v[52:55], v[92:95], a[228:231], v[52:55]
  v_mfma_f32_16x16x32_bf16 v[56:59], v[88:91], v[164:167], v[56:59]
  v_mfma_f32_16x16x32_bf16 v[60:63], v[92:95], v[164:167], v[60:63]
  s_waitcnt lgkmcnt(2)
  v_mfma_f32_16x16x32_bf16 v[32:35], a[72:75], v[72:75], v[32:35]
  v_mfma_f32_16x16x32_bf16 v[36:39], a[72:75], v[76:79], v[36:39]
  v_mfma_f32_16x16x32_bf16 v[40:43], a[152:155], v[72:75], v[40:43]
  v_mfma_f32_16x16x32_bf16 v[44:47], a[152:155], v[76:79], v[44:47]
  v_mfma_f32_16x16x32_bf16 v[48:51], v[72:75], a[232:235], v[48:51]
  v_mfma_f32_16x16x32_bf16 v[52:55], v[76:79], a[232:235], v[52:55]
  v_mfma_f32_16x16x32_bf16 v[56:59], v[72:75], v[168:171], v[56:59]
  v_mfma_f32_16x16x32_bf16 v[60:63], v[76:79], v[168:171], v[60:63]
  s_waitcnt lgkmcnt(0)
  v_mfma_f32_16x16x32_bf16 v[32:35], a[76:79], v[80:83], v[32:35]
  v_mfma_f32_16x16x32_bf16 v[36:39], a[76:79], v[84:87], v[36:39]
  v_mfma_f32_16x16x32_bf16 v[40:43], a[156:159], v[80:83], v[40:43]
  v_mfma_f32_16x16x32_bf16 v[44:47], a[156:159], v[84:87], v[44:47]
  v_mfma_f32_16x16x32_bf16 v[48:51], v[80:83], a[236:239], v[48:51]
  v_mfma_f32_16x16x32_bf16 v[52:55], v[84:87], a[236:239], v[52:55]
  v_mfma_f32_16x16x32_bf16 v[56:59], v[80:83], v[172:175], v[56:59]
  v_mfma_f32_16x16x32_bf16 v[60:63], v[84:87], v[172:175], v[60:63]
  s_nop 0
  v_cvt_pk_bf16_f32 v8, v32, v33
  v_cvt_pk_bf16_f32 v9, v34, v35
  v_cvt_pk_bf16_f32 v10, v40, v41
  v_cvt_pk_bf16_f32 v11, v42, v43
  s_add_u32 s34, s22, 0
  buffer_store_dwordx4 v[8:11], v1, s[4:7], s34 offen sc1
  v_cvt_pk_bf16_f32 v12, v36, v37
  v_cvt_pk_bf16_f32 v13, v38, v39
  v_cvt_pk_bf16_f32 v14, v44, v45
  v_cvt_pk_bf16_f32 v15, v46, v47
  s_add_u32 s34, s22, 6144
  buffer_store_dwordx4 v[12:15], v1, s[4:7], s34 offen sc1
  v_cvt_pk_bf16_f32 v8, v48, v49
  v_cvt_pk_bf16_f32 v9, v50, v51
  v_cvt_pk_bf16_f32 v10, v52, v53
  v_cvt_pk_bf16_f32 v11, v54, v55
  s_add_u32 s34, s23, 4096
  buffer_store_dwordx4 v[8:11], v1, s[4:7], s34 offen sc1
  v_cvt_pk_bf16_f32 v12, v56, v57
  v_cvt_pk_bf16_f32 v13, v58, v59
  v_cvt_pk_bf16_f32 v14, v60, v61
  v_cvt_pk_bf16_f32 v15, v62, v63
  s_add_u32 s34, s23, 5120
  buffer_store_dwordx4 v[12:15], v1, s[4:7], s34 offen sc1
  s_waitcnt vmcnt(0)
  s_barrier
  s_add_u32 s17, s17, 1
  s_cmp_lt_u32 s17, 64
  s_cbranch_scc1 reca_ptop264
  s_branch reca_exit1
reca_pw3_229:
  s_mov_b32 s17, 0
  s_mov_b32 s26, 0
  s_mul_i32 s20, s17, 40960
  s_add_u32 s20, s20, 84965376
  s_add_u32 m0, s26, 30720
  s_nop 0
  buffer_load_dwordx4 v1, s[4:7], s20 offen offset:0 lds
  buffer_load_dwordx4 v1, s[4:7], s20 offen offset:1024 lds
  buffer_load_dwordx4 v1, s[4:7], s20 offen offset:2048 lds
  buffer_load_dwordx4 v1, s[4:7], s20 offen offset:3072 lds
  s_add_u32 s20, s20, 4096
  s_add_u32 m0, s26, 34816
  s_nop 0
  buffer_load_dwordx4 v1, s[4:7], s20 offen offset:0 lds
  buffer_load_dwordx4 v1, s[4:7], s20 offen offset:1024 lds
  buffer_load_dwordx4 v1, s[4:7], s20 offen offset:2048 lds
  buffer_load_dwordx4 v1, s[4:7], s20 offen offset:3072 lds
  s_add_u32 s20, s20, 4096
  s_add_u32 m0, s26, 38912
  s_nop 0
  buffer_load_dwordx4 v1, s[4:7], s20 offen offset:0 lds
  buffer_load_dwordx4 v1, s[4:7], s20 offen offset:1024 lds
  s_mul_i32 s34, s15, 12
  s_mul_i32 s35, s16, 6
  s_add_u32 s34, s34, s35
  s_add_u32 s34, s34, 2
  s_mul_i32 s34, s34, 20480
  s_add_u32 s34, s34, 6291456
  buffer_load_dwordx4 a[0:3], v1, s[4:7], s34 offen offset:0
  buffer_load_dwordx4 a[4:7], v1, s[4:7], s34 offen offset:1024
  buffer_load_dwordx4 a[8:11], v1, s[4:7], s34 offen offset:2048
  buffer_load_dwordx4 a[12:15], v1, s[4:7], s34 offen offset:3072
  s_add_u32 s34, s34, 4096
  buffer_load_dwordx4 a[16:19], v1, s[4:7], s34 offen offset:0
  buffer_load_dwordx4 a[20:23], v1, s[4:7], s34 offen offset:1024
  buffer_load_dwordx4 a[24:27], v1, s[4:7], s34 offen offset:2048
  buffer_load_dwordx4 a[28:31], v1, s[4:7], s34 offen offset:3072
  s_add_u32 s34, s34, 4096
  buffer_load_dwordx4 a[32:35], v1, s[4:7], s34 offen offset:0
  buffer_load_dwordx4 a[36:39], v1, s[4:7], s34 offen offset:1024
  buffer_load_dwordx4 a[40:43], v1, s[4:7], s34 offen offset:2048
  buffer_load_dwordx4 a[44:47], v1, s[4:7], s34 offen offset:3072
  s_add_u32 s34, s34, 4096
  buffer_load_dwordx4 a[48:51], v1, s[4:7], s34 offen offset:0
  buffer_load_dwordx4 a[52:55], v1, s[4:7], s34 offen offset:1024
  buffer_load_dwordx4 a[56:59], v1, s[4:7], s34 offen offset:2048
  buffer_load_dwordx4 a[60:63], v1, s[4:7], s34 offen offset:3072
  s_add_u32 s34, s34, 4096
  buffer_load_dwordx4 a[64:67], v1, s[4:7], s34 offen offset:0
  buffer_load_dwordx4 a[68:71], v1, s[4:7], s34 offen offset:1024
  buffer_load_dwordx4 a[72:75], v1, s[4:7], s34 offen offset:2048
  buffer_load_dwordx4 a[76:79], v1, s[4:7], s34 offen offset:3072
  s_mul_i32 s34, s15, 12
  s_mul_i32 s35, s16, 6
  s_add_u32 s34, s34, s35
  s_add_u32 s34, s34, 3
  s_mul_i32 s34, s34, 20480
  s_add_u32 s34, s34, 6291456
  buffer_load_dwordx4 a[80:83], v1, s[4:7], s34 offen offset:0
  buffer_load_dwordx4 a[84:87], v1, s[4:7], s34 offen offset:1024
  buffer_load_dwordx4 a[88:91], v1, s[4:7], s34 offen offset:2048
  buffer_load_dwordx4 a[92:95], v1, s[4:7], s34 offen offset:3072
  s_add_u32 s34, s34, 4096
  buffer_load_dwordx4 a[96:99], v1, s[4:7], s34 offen offset:0
  buffer_load_dwordx4 a[100:103], v1, s[4:7], s34 offen offset:1024
  buffer_load_dwordx4 a[104:107], v1, s[4:7], s34 offen offset:2048
  buffer_load_dwordx4 a[108:111], v1, s[4:7], s34 offen offset:3072
  s_add_u32 s34, s34, 4096
  buffer_load_dwordx4 a[112:115], v1, s[4:7], s34 offen offset:0
  buffer_load_dwordx4 a[116:119], v1, s[4:7], s34 offen offset:1024
  buffer_load_dwordx4 a[120:123], v1, s[4:7], s34 offen offset:2048
  buffer_load_dwordx4 a[124:127], v1, s[4:7], s34 offen offset:3072
  s_add_u32 s34, s34, 4096
  buffer_load_dwordx4 a[128:131], v1, s[4:7], s34 offen offset:0
  buffer_load_dwordx4 a[132:135], v1, s[4:7], s34 offen offset:1024
  buffer_load_dwordx4 a[136:139], v1, s[4:7], s34 offen offset:2048
  buffer_load_dwordx4 a[140:143], v1, s[4:7], s34 offen offset:3072
  s_add_u32 s34, s34, 4096
  buffer_load_dwordx4 a[144:147], v1, s[4:7], s34 offen offset:0
  buffer_load_dwordx4 a[148:151], v1, s[4:7], s34 offen offset:1024
  buffer_load_dwordx4 a[152:155], v1, s[4:7], s34 offen offset:2048
  buffer_load_dwordx4 a[156:159], v1, s[4:7], s34 offen offset:3072
  s_waitcnt vmcnt(20)
  s_mul_i32 s34, s15, 12
  s_mul_i32 s35, s16, 6
  s_add_u32 s34, s34, s35
  s_add_u32 s34, s34, 4
  s_mul_i32 s34, s34, 20480
  s_add_u32 s34, s34, 6291456
  buffer_load_dwordx4 a[160:163], v1, s[4:7], s34 offen offset:0
  buffer_load_dwordx4 a[164:167], v1, s[4:7], s34 offen offset:1024
  buffer_load_dwordx4 a[168:171], v1, s[4:7], s34 offen offset:2048
  buffer_load_dwordx4 a[172:175], v1, s[4:7], s34 offen offset:3072
  s_add_u32 s34, s34, 4096
  buffer_load_dwordx4 a[176:179], v1, s[4:7], s34 offen offset:0
  buffer_load_dwordx4 a[180:183], v1, s[4:7], s34 offen offset:1024
  buffer_load_dwordx4 a[184:187], v1, s[4:7], s34 offen offset:2048
  buffer_load_dwordx4 a[188:191], v1, s[4:7], s34 offen offset:3072
  s_add_u32 s34, s34, 4096
  buffer_load_dwordx4 a[192:195], v1, s[4:7], s34 offen offset:0
  buffer_load_dwordx4 a[196:199], v1, s[4:7], s34 offen offset:1024
  buffer_load_dwordx4 a[200:203], v1, s[4:7], s34 offen offset:2048
  buffer_load_dwordx4 a[204:207], v1, s[4:7], s34 offen offset:3072
  s_add_u32 s34, s34, 4096
  buffer_load_dwordx4 a[208:211], v1, s[4:7], s34 offen offset:0
  buffer_load_dwordx4 a[212:215], v1, s[4:7], s34 offen offset:1024
  buffer_load_dwordx4 a[216:219], v1, s[4:7], s34 offen offset:2048
  buffer_load_dwordx4 a[220:223], v1, s[4:7], s34 offen offset:3072
  s_add_u32 s34, s34, 4096
  buffer_load_dwordx4 a[224:227], v1, s[4:7], s34 offen offset:0
  buffer_load_dwordx4 a[228:231], v1, s[4:7], s34 offen offset:1024
  buffer_load_dwordx4 a[232:235], v1, s[4:7], s34 offen offset:2048
  buffer_load_dwordx4 a[236:239], v1, s[4:7], s34 offen offset:3072
  s_waitcnt vmcnt(20)
  s_mul_i32 s34, s15, 12
  s_mul_i32 s35, s16, 6
  s_add_u32 s34, s34, s35
  s_add_u32 s34, s34, 5
  s_mul_i32 s34, s34, 20480
  s_add_u32 s34, s34, 6291456
  buffer_load_dwordx4 v[96:99], v1, s[4:7], s34 offen offset:0
  buffer_load_dwordx4 v[100:103], v1, s[4:7], s34 offen offset:1024
  buffer_load_dwordx4 v[104:107], v1, s[4:7], s34 offen offset:2048
  buffer_load_dwordx4 v[108:111], v1, s[4:7], s34 offen offset:3072
  s_add_u32 s34, s34, 4096
  buffer_load_dwordx4 v[112:115], v1, s[4:7], s34 offen offset:0
  buffer_load_dwordx4 v[116:119], v1, s[4:7], s34 offen offset:1024
  buffer_load_dwordx4 v[120:123], v1, s[4:7], s34 offen offset:2048
  buffer_load_dwordx4 v[124:127], v1, s[4:7], s34 offen offset:3072
  s_add_u32 s34, s34, 4096
  buffer_load_dwordx4 v[128:131], v1, s[4:7], s34 offen offset:0
  buffer_load_dwordx4 v[132:135], v1, s[4:7], s34 offen offset:1024
  buffer_load_dwordx4 v[136:139], v1, s[4:7], s34 offen offset:2048
  buffer_load_dwordx4 v[140:143], v1, s[4:7], s34 offen offset:3072
  s_add_u32 s34, s34, 4096
  buffer_load_dwordx4 v[144:147], v1, s[4:7], s34 offen offset:0
  buffer_load_dwordx4 v[148:151], v1, s[4:7], s34 offen offset:1024
  buffer_load_dwordx4 v[152:155], v1, s[4:7], s34 offen offset:2048
  buffer_load_dwordx4 v[156:159], v1, s[4:7], s34 offen offset:3072
  s_add_u32 s34, s34, 4096
  buffer_load_dwordx4 v[160:163], v1, s[4:7], s34 offen offset:0
  buffer_load_dwordx4 v[164:167], v1, s[4:7], s34 offen offset:1024
  buffer_load_dwordx4 v[168:171], v1, s[4:7], s34 offen offset:2048
  buffer_load_dwordx4 v[172:175], v1, s[4:7], s34 offen offset:3072
  s_waitcnt vmcnt(20)
  v_and_b32 v30, 7, v0
  v_lshlrev_b32 v30, 3, v30
reca_cens269:
  buffer_load_dwordx2 v[28:29], v30, s[8:11], 0 offen sc1
  s_waitcnt vmcnt(0)
  v_sad_u8 v31, v28, 0, 0
  v_sad_u8 v31, v29, 0, v31
  v_cmp_gt_u32 vcc, 32, v31
  s_cbranch_vccz reca_censok270
  s_sleep 8
  s_sub_u32 s18, s18, 1
  s_cbranch_scc0 reca_cens269
  s_mov_b32 s18, 0
reca_censok270:
  v_and_b32 v28, 0x20202020, v28
  v_and_b32 v29, 0x20202020, v29
  v_cmp_ne_u32 s[34:35], 0, v28
  v_cmp_ne_u32 s[36:37], 0, v29
  s_nop 3
  s_and_b32 s34, s34, 0xff
  s_and_b32 s36, s36, 0xff
  s_or_b32 s35, s34, s36
  s_lshr_b32 s37, s35, s13
  s_and_b32 s37, s37, 1
  s_xor_b32 s43, s37, 1
  s_cmp_eq_u32 s57, 0
  s_cselect_b32 s58, s36, s34
  v_mov_b32 v31, 0x80000000
  s_cmp_lg_u32 s43, 0
  s_cbranch_scc1 reca_pslow271
reca_ptop272:
  s_cmp_lt_u32 s17, 3
  s_cbranch_scc1 reca_pgo273
  s_sub_u32 s36, s17, 3
reca_ppoll274:
  buffer_load_dword v28, v4, s[4:7], s25 offen sc1
  s_waitcnt vmcnt(0)
  v_readfirstlane_b32 s34, v28
  s_nop 3
  s_cmp_ge_i32 s34, s36
  s_cbranch_scc1 reca_pgo273
  s_sleep 8
  s_sub_u32 s18, s18, 1
  s_cbranch_scc0 reca_ppoll274
  s_mov_b32 s18, 0
reca_pgo273:
  s_waitcnt vmcnt(0)
  s_barrier
  v_add_u32 v7, s26, v1
  s_xor_b32 s26, s26, 40960
  s_add_u32 s37, s17, 1
  s_cmp_ge_u32 s37, 64
  s_cbranch_scc1 reca_pnodma275
  s_mul_i32 s20, s37, 40960
  s_add_u32 s20, s20, 84965376
  s_add_u32 m0, s26, 30720
  s_nop 0
  buffer_load_dwordx4 v1, s[4:7], s20 offen offset:0 lds
  buffer_load_dwordx4 v1, s[4:7], s20 offen offset:1024 lds
  buffer_load_dwordx4 v1, s[4:7], s20 offen offset:2048 lds
  buffer_load_dwordx4 v1, s[4:7], s20 offen offset:3072 lds
  s_add_u32 s20, s20, 4096
  s_add_u32 m0, s26, 34816
  s_nop 0
  buffer_load_dwordx4 v1, s[4:7], s20 offen offset:0 lds
  buffer_load_dwordx4 v1, s[4:7], s20 offen offset:1024 lds
  buffer_load_dwordx4 v1, s[4:7], s20 offen offset:2048 lds
  buffer_load_dwordx4 v1, s[4:7], s20 offen offset:3072 lds
  s_add_u32 s20, s20, 4096
  s_add_u32 m0, s26, 38912
  s_nop 0
  buffer_load_dwordx4 v1, s[4:7], s20 offen offset:0 lds
  buffer_load_dwordx4 v1, s[4:7], s20 offen offset:1024 lds
reca_pnodma275:
  s_lshl_b32 s34, s15, 3
  s_and_b32 s35, s17, 7
  s_add_u32 s34, s34, s35
  s_mul_i32 s34, s34, 12288
  s_mul_i32 s35, s16, 3072
  s_add_u32 s35, s35, s34
  s_add_u32 s21, s35, 37748736
  s_add_u32 s22, s35, 44040192
  s_mul_i32 s35, s16, 6144
  s_add_u32 s35, s35, s34
  s_add_u32 s23, s35, 40894464
  ds_read_b128 v[72:75], v7 offset:0
  ds_read_b128 v[76:79], v7 offset:20480
  ds_read_b128 v[80:83], v7 offset:1024
  ds_read_b128 v[84:87], v7 offset:21504
  ds_read_b128 v[88:91], v7 offset:2048
  ds_read_b128 v[92:95], v7 offset:22528
  s_waitcnt lgkmcnt(4)
  v_mfma_f32_16x16x32_bf16 v[32:35], a[0:3], v[72:75], 0
  v_mfma_f32_16x16x32_bf16 v[36:39], a[0:3], v[76:79], 0
  v_mfma_f32_16x16x32_bf16 v[40:43], a[80:83], v[72:75], 0
  v_mfma_f32_16x16x32_bf16 v[44:47], a[80:83], v[76:79], 0
  v_mfma_f32_16x16x32_bf16 v[48:51], a[160:163], v[72:75], 0
  v_mfma_f32_16x16x32_bf16 v[52:55], a[160:163], v[76:79], 0
  v_mfma_f32_16x16x32_bf16 v[56:59], v[96:99], v[72:75], 0
  v_mfma_f32_16x16x32_bf16 v[60:63], v[96:99], v[76:79], 0
  ds_read_b128 v[72:75], v7 offset:3072
  ds_read_b128 v[76:79], v7 offset:23552
  s_waitcnt lgkmcnt(4)
  v_mfma_f32_16x16x32_bf16 v[32:35], a[4:7], v[80:83], v[32:35]
  v_mfma_f32_16x16x32_bf16 v[36:39], a[4:7], v[84:87], v[36:39]
  v_mfma_f32_16x16x32_bf16 v[40:43], a[84:87], v[80:83], v[40:43]
  v_mfma_f32_16x16x32_bf16 v[44:47], a[84:87], v[84:87], v[44:47]
  v_mfma_f32_16x16x32_bf16 v[48:51], a[164:167], v[80:83], v[48:51]
  v_mfma_f32_16x16x32_bf16 v[52:55], a[164:167], v[84:87], v[52:55]
  v_mfma_f32_16x16x32_bf16 v[56:59], v[100:103], v[80:83], v[56:59]
  v_mfma_f32_16x16x32_bf16 v[60:63], v[100:103], v[84:87], v[60:63]
  ds_read_b128 v[80:83], v7 offset:4096
  ds_read_b128 v[84:87], v7 offset:24576
  s_waitcnt lgkmcnt(4)
  v_mfma_f32_16x16x32_bf16 v[32:35], a[8:11], v[88:91], v[32:35]
  v_mfma_f32_16x16x32_bf16 v[36:39], a[8:11], v[92:95], v[36:39]
  v_mfma_f32_16x16x32_bf16 v[40:43], a[88:91], v[88:91], v[40:43]
  v_mfma_f32_16x16x32_bf16 v[44:47], a[88:91], v[92:95], v[44:47]
  v_mfma_f32_16x16x32_bf16 v[48:51], a[168:171], v[88:91], v[48:51]
  v_mfma_f32_16x16x32_bf16 v[52:55], a[168:171], v[92:95], v[52:55]
  v_mfma_f32_16x16x32_bf16 v[56:59], v[104:107], v[88:91], v[56:59]
  v_mfma_f32_16x16x32_bf16 v[60:63], v[104:107], v[92:95], v[60:63]
  ds_read_b128 v[88:91], v7 offset:5120
  ds_read_b128 v[92:95], v7 offset:25600
  s_waitcnt lgkmcnt(4)
  v_mfma_f32_16x16x32_bf16 v[32:35], a[12:15], v[72:75], v[32:35]
  v_mfma_f32_16x16x32_bf16 v[36:39], a[12:15], v[76:79], v[36:39]
  v_mfma_f32_16x16x32_bf16 v[40:43], a[92:95], v[72:75], v[40:43]
  v_mfma_f32_16x16x32_bf16 v[44:47], a[92:95], v[76:79], v[44:47]
  v_mfma_f32_16x16x32_bf16 v[48:51], a[172:175], v[72:75], v[48:51]
  v_mfma_f32_16x16x32_bf16 v[52:55], a[172:175], v[76:79], v[52:55]
  v_mfma_f32_16x16x32_bf16 v[56:59], v[108:111], v[72:75], v[56:59]
  v_mfma_f32_16x16x32_bf16 v[60:63], v[108:111], v[76:79], v[60:63]
  ds_read_b128 v[72:75], v7 offset:6144
  ds_read_b128 v[76:79], v7 offset:26624
  s_waitcnt lgkmcnt(4)
  v_mfma_f32_16x16x32_bf16 v[32:35], a[16:19], v[80:83], v[32:35]
  v_mfma_f32_16x16x32_bf16 v[36:39], a[16:19], v[84:87], v[36:39]
  v_mfma_f32_16x16x32_bf16 v[40:43], a[96:99], v[80:83], v[40:43]
  v_mfma_f32_16x16x32_bf16 v[44:47], a[96:99], v[84:87], v[44:47]
  v_mfma_f32_16x16x32_bf16 v[48:51], a[176:179], v[80:83], v[48:51]
  v_mfma_f32_16x16x32_bf16 v[52:55], a[176:179], v[84:87], v[52:55]
  v_mfma_f32_16x16x32_bf16 v[56:59], v[112:115], v[80:83], v[56:59]
  v_mfma_f32_16x16x32_bf16 v[60:63], v[112:115], v[84:87], v[60:63]
  ds_read_b128 v[80:83], v7 offset:7168
  ds_read_b128 v[84:87], v7 offset:27648
  s_waitcnt lgkmcnt(4)
  v_mfma_f32_16x16x32_bf16 v[32:35], a[20:23], v[88:91], v[32:35]
  v_mfma_f32_16x16x32_bf16 v[36:39], a[20:23], v[92:95], v[36:39]
  v_mfma_f32_16x16x32_bf16 v[40:43], a[100:103], v[88:91], v[40:43]
  v_mfma_f32_16x16x32_bf16 v[44:47], a[100:103], v[92:95], v[44:47]
  v_mfma_f32_16x16x32_bf16 v[48:51], a[180:183], v[88:91], v[48:51]
  v_mfma_f32_16x16x32_bf16 v[52:55], a[180:183], v[92:95], v[52:55]
  v_mfma_f32_16x16x32_bf16 v[56:59], v[116:119], v[88:91], v[56:59]
  v_mfma_f32_16x16x32_bf16 v[60:63], v[116:119], v[92:95], v[60:63]
  ds_read_b128 v[88:91], v7 offset:8192
  ds_read_b128 v[92:95], v7 offset:28672
  s_waitcnt lgkmcnt(4)
  v_mfma_f32_16x16x32_bf16 v[32:35], a[24:27], v[72:75], v[32:35]
  v_mfma_f32_16x16x32_bf16 v[36:39], a[24:27], v[76:79], v[36:39]
  v_mfma_f32_16x16x32_bf16 v[40:43], a[104:107], v[72:75], v[40:43]
  v_mfma_f32_16x16x32_bf16 v[44:47], a[104:107], v[76:79], v[44:47]
  v_mfma_f32_16x16x32_bf16 v[48:51], a[184:187], v[72:75], v[48:51]
  v_mfma_f32_16x16x32_bf16 v[52:55], a[184:187], v[76:79], v[52:55]
  v_mfma_f32_16x16x32_bf16 v[56:59], v[120:123], v[72:75], v[56:59]
  v_mfma_f32_16x16x32_bf16 v[60:63], v[120:123], v[76:79], v[60:63]
  ds_read_b128 v[72:75], v7 offset:9216
  ds_read_b128 v[76:79], v7 offset:29696
  s_waitcnt lgkmcnt(4)
  v_mfma_f32_16x16x32_bf16 v[32:35], a[28:31], v[80:83], v[32:35]
  v_mfma_f32_16x16x32_bf16 v[36:39], a[28:31], v[84:87], v[36:39]
  v_mfma_f32_16x16x32_bf16 v[40:43], a[108:111], v[80:83], v[40:43]
  v_mfma_f32_16x16x32_bf16 v[44:47], a[108:111], v[84:87], v[44:47]
  v_mfma_f32_16x16x32_bf16 v[48:51], a[188:191], v[80:83], v[48:51]
  v_mfma_f32_16x16x32_bf16 v[52:55], a[188:191], v[84:87], v[52:55]
  v_mfma_f32_16x16x32_bf16 v[56:59], v[124:127], v[80:83], v[56:59]
  v_mfma_f32_16x16x32_bf16 v[60:63], v[124:127], v[84:87], v[60:63]
  ds_read_b128 v[80:83], v7 offset:10240
  ds_read_b128 v[84:87], v7 offset:30720
  s_waitcnt lgkmcnt(4)
  v_mfma_f32_16x16x32_bf16 v[32:35], a[32:35], v[88:91], v[32:35]
  v_mfma_f32_16x16x32_bf16 v[36:39], a[32:35], v[92:95], v[36:39]
  v_mfma_f32_16x16x32_bf16 v[40:43], a[112:115], v[88:91], v[40:43]
  v_mfma_f32_16x16x32_bf16 v[44:47], a[112:115], v[92:95], v[44:47]
  v_mfma_f32_16x16x32_bf16 v[48:51], a[192:195], v[88:91], v[48:51]
  v_mfma_f32_16x16x32_bf16 v[52:55], a[192:195], v[92:95], v[52:55]
  v_mfma_f32_16x16x32_bf16 v[56:59], v[128:131], v[88:91], v[56:59]
  v_mfma_f32_16x16x32_bf16 v[60:63], v[128:131], v[92:95], v[60:63]
  ds_read_b128 v[88:91], v7 offset:11264
  ds_read_b128 v[92:95], v7 offset:31744
  s_waitcnt lgkmcnt(4)
  v_mfma_f32_16x16x32_bf16 v[32:35], a[36:39], v[72:75], v[32:35]
  v_mfma_f32_16x16x32_bf16 v[36:39], a[36:39], v[76:79], v[36:39]
  v_mfma_f32_16x16x32_bf16 v[40:43], a[116:119], v[72:75], v[40:43]
  v_mfma_f32_16x16x32_bf16 v[44:47], a[116:119], v[76:79], v[44:47]
  v_mfma_f32_16x16x32_bf16 v[48:51], a[196:199], v[72:75], v[48:51]
  v_mfma_f32_16x16x32_bf16 v[52:55], a[196:199], v[76:79], v[52:55]
  v_mfma_f32_16x16x32_bf16 v[56:59], v[132:135], v[72:75], v[56:59]
  v_mfma_f32_16x16x32_bf16 v[60:63], v[132:135], v[76:79], v[60:63]
  ds_read_b128 v[72:75], v7 offset:12288
  ds_read_b128 v[76:79], v7 offset:32768
  s_waitcnt lgkmcnt(4)
  v_mfma_f32_16x16x32_bf16 v[32:35], a[40:43], v[80:83], v[32:35]
  v_mfma_f32_16x16x32_bf16 v[36:39], a[40:43], v[84:87], v[36:39]
  v_mfma_f32_16x16x32_bf16 v[40:43], a[120:123], v[80:83], v[40:43]
  v_mfma_f32_16x16x32_bf16 v[44:47], a[120:123], v[84:87], v[44:47]
  v_mfma_f32_16x16x32_bf16 v[48:51], a[200:203], v[80:83], v[48:51]
  v_mfma_f32_16x16x32_bf16 v[52:55], a[200:203], v[84:87], v[52:55]
  v_mfma_f32_16x16x32_bf16 v[56:59], v[136:139], v[80:83], v[56:59]
  v_mfma_f32_16x16x32_bf16 v[60:63], v[136:139], v[84:87], v[60:63]
  ds_read_b128 v[80:83], v7 offset:13312
  ds_read_b128 v[84:87], v7 offset:33792
  s_waitcnt lgkmcnt(4)
  v_mfma_f32_16x16x32_bf16 v[32:35], a[44:47], v[88:91], v[32:35]
  v_mfma_f32_16x16x32_bf16 v[36:39], a[44:47], v[92:95], v[36:39]
  v_mfma_f32_16x16x32_bf16 v[40:43], a[124:127], v[88:91], v[40:43]
  v_mfma_f32_16x16x32_bf16 v[44:47], a[124:127], v[92:95], v[44:47]
  v_mfma_f32_16x16x32_bf16 v[48:51], a[204:207], v[88:91], v[48:51]
  v_mfma_f32_16x16x32_bf16 v[52:55], a[204:207], v[92:95], v[52:55]
  v_mfma_f32_16x16x32_bf16 v[56:59], v[140:143], v[88:91], v[56:59]
  v_mfma_f32_16x16x32_bf16 v[60:63], v[140:143], v[92:95], v[60:63]
  ds_read_b128 v[88:91], v7 offset:14336
  ds_read_b128 v[92:95], v7 offset:34816
  s_waitcnt lgkmcnt(4)
  v_mfma_f32_16x16x32_bf16 v[32:35], a[48:51], v[72:75], v[32:35]
  v_mfma_f32_16x16x32_bf16 v[36:39], a[48:51], v[76:79], v[36:39]
  v_mfma_f32_16x16x32_bf16 v[40:43], a[128:131], v[72:75], v[40:43]
  v_mfma_f32_16x16x32_bf16 v[44:47], a[128:131], v[76:79], v[44:47]
  v_mfma_f32_16x16x32_bf16 v[48:51], a[208:211], v[72:75], v[48:51]
  v_mfma_f32_16x16x32_bf16 v[52:55], a[208:211], v[76:79], v[52:55]
  v_mfma_f32_16x16x32_bf16 v[56:59], v[144:147], v[72:75], v[56:59]
  v_mfma_f32_16x16x32_bf16 v[60:63], v[144:147], v[76:79], v[60:63]
  ds_read_b128 v[72:75], v7 offset:15360
  ds_read_b128 v[76:79], v7 offset:35840
  s_waitcnt lgkmcnt(4)
  v_mfma_f32_16x16x32_bf16 v[32:35], a[52:55], v[80:83], v[32:35]
  v_mfma_f32_16x16x32_bf16 v[36:39], a[52:55], v[84:87], v[36:39]
  v_mfma_f32_16x16x32_bf16 v[40:43], a[132:135], v[80:83], v[40:43]
  v_mfma_f32_16x16x32_bf16 v[44:47], a[132:135], v[84:87], v[44:47]
  v_mfma_f32_16x16x32_bf16 v[48:51], a[212:215], v[80:83], v[48:51]
  v_mfma_f32_16x16x32_bf16 v[52:55], a[212:215], v[84:87], v[52:55]
  v_mfma_f32_16x16x32_bf16 v[56:59], v[148:151], v[80:83], v[56:59]
  v_mfma_f32_16x16x32_bf16 v[60:63], v[148:151], v[84:87], v[60:63]
  ds_read_b128 v[80:83], v7 offset:16384
  ds_read_b128 v[84:87], v7 offset:36864
  s_waitcnt lgkmcnt(4)
  v_mfma_f32_16x16x32_bf16 v[32:35], a[56:59], v[88:91], v[32:35]
  v_mfma_f32_16x16x32_bf16 v[36:39], a[56:59], v[92:95], v[36:39]
  v_mfma_f32_16x16x32_bf16 v[40:43], a[136:139], v[88:91], v[40:43]
  v_mfma_f32_16x16x32_bf16 v[44:47], a[136:139], v[92:95], v[44:47]
  v_mfma_f32_16x16x32_bf16 v[48:51], a[216:219], v[88:91], v[48:51]
  v_mfma_f32_16x16x32_bf16 v[52:55], a[216:219], v[92:95], v[52:55]
  v_mfma_f32_16x16x32_bf16 v[56:59], v[152:155], v[88:91], v[56:59]
  v_mfma_f32_16x16x32_bf16 v[60:63], v[152:155], v[92:95], v[60:63]
  ds_read_b128 v[88:91], v7 offset:17408
  ds_read_b128 v[92:95], v7 offset:37888
  s_waitcnt lgkmcnt(4)
  v_mfma_f32_16x16x32_bf16 v[32:35], a[60:63], v[72:75], v[32:35]
  v_mfma_f32_16x16x32_bf16 v[36:39], a[60:63], v[76:79], v[36:39]
  v_mfma_f32_16x16x32_bf16 v[40:43], a[140:143], v[72:75], v[40:43]
  v_mfma_f32_16x16x32_bf16 v[44:47], a[140:143], v[76:79], v[44:47]
  v_mfma_f32_16x16x32_bf16 v[48:51], a[220:223], v[72:75], v[48:51]
  v_mfma_f32_16x16x32_bf16 v[52:55], a[220:223], v[76:79], v[52:55]
  v_mfma_f32_16x16x32_bf16 v[56:59], v[156:159], v[72:75], v[56:59]
  v_mfma_f32_16x16x32_bf16 v[60:63], v[156:159], v[76:79], v[60:63]
  ds_read_b128 v[72:75], v7 offset:18432
  ds_read_b128 v[76:79], v7 offset:38912
  s_waitcnt lgkmcnt(4)
  v_mfma_f32_16x16x32_bf16 v[32:35], a[64:67], v[80:83], v[32:35]
  v_mfma_f32_16x16x32_bf16 v[36:39], a[64:67], v[84:87], v[36:39]
  v_mfma_f32_16x16x32_bf16 v[40:43], a[144:147], v[80:83], v[40:43]
  v_mfma_f32_16x16x32_bf16 v[44:47], a[144:147], v[84:87], v[44:47]
  v_mfma_f32_16x16x32_bf16 v[48:51], a[224:227], v[80:83], v[48:51]
  v_mfma_f32_16x16x32_bf16 v[52:55], a[224:227], v[84:87], v[52:55]
  v_mfma_f32_16x16x32_bf16 v[56:59], v[160:163], v[80:83], v[56:59]
  v_mfma_f32_16x16x32_bf16 v[60:63], v[160:163], v[84:87], v[60:63]
  ds_read_b128 v[80:83], v7 offset:19456
  ds_read_b128 v[84:87], v7 offset:39936
  s_waitcnt lgkmcnt(4)
  v_mfma_f32_16x16x32_bf16 v[32:35], a[68:71], v[88:91], v[32:35]
  v_mfma_f32_16x16x32_bf16 v[36:39], a[68:71], v[92:95], v[36:39]
  v_mfma_f32_16x16x32_bf16 v[40:43], a[148:151], v[88:91], v[40:43]
  v_mfma_f32_16x16x32_bf16 v[44:47], a[148:151], v[92:95], v[44:47]
  v_mfma_f32_16x16x32_bf16 v[48:51], a[228:231], v[88:91], v[48:51]
  v_mfma_f32_16x16x32_bf16 v[52:55], a[228:231], v[92:95], v[52:55]
  v_mfma_f32_16x16x32_bf16 v[56:59], v[164:167], v[88:91], v[56:59]
  v_mfma_f32_16x16x32_bf16 v[60:63], v[164:167], v[92:95], v[60:63]
  s_waitcnt lgkmcnt(2)
  v_mfma_f32_16x16x32_bf16 v[32:35], a[72:75], v[72:75], v[32:35]
  v_mfma_f32_16x16x32_bf16 v[36:39], a[72:75], v[76:79], v[36:39]
  v_mfma_f32_16x16x32_bf16 v[40:43], a[152:155], v[72:75], v[40:43]
  v_mfma_f32_16x16x32_bf16 v[44:47], a[152:155], v[76:79], v[44:47]
  v_mfma_f32_16x16x32_bf16 v[48:51], a[232:235], v[72:75], v[48:51]
  v_mfma_f32_16x16x32_bf16 v[52:55], a[232:235], v[76:79], v[52:55]
  v_mfma_f32_16x16x32_bf16 v[56:59], v[168:171], v[72:75], v[56:59]
  v_mfma_f32_16x16x32_bf16 v[60:63], v[168:171], v[76:79], v[60:63]
  s_waitcnt lgkmcnt(0)
  v_mfma_f32_16x16x32_bf16 v[32:35], a[76:79], v[80:83], v[32:35]
  v_mfma_f32_16x16x32_bf16 v[36:39], a[76:79], v[84:87], v[36:39]
  v_mfma_f32_16x16x32_bf16 v[40:43], a[156:159], v[80:83], v[40:43]
  v_mfma_f32_16x16x32_bf16 v[44:47], a[156:159], v[84:87], v[44:47]
  v_mfma_f32_16x16x32_bf16 v[48:51], a[236:239], v[80:83], v[48:51]
  v_mfma_f32_16x16x32_bf16 v[52:55], a[236:239], v[84:87], v[52:55]
  v_mfma_f32_16x16x32_bf16 v[56:59], v[172:175], v[80:83], v[56:59]
  v_mfma_f32_16x16x32_bf16 v[60:63], v[172:175], v[84:87], v[60:63]
  s_nop 0
  v_cvt_pk_bf16_f32 v8, v32, v33
  v_cvt_pk_bf16_f32 v9, v34, v35
  v_cvt_pk_bf16_f32 v10, v40, v41
  v_cvt_pk_bf16_f32 v11, v42, v43
  s_add_u32 s34, s22, 1024
  buffer_store_dwordx4 v[8:11], v1, s[4:7], s34 offen
  v_cvt_pk_bf16_f32 v12, v36, v37
  v_cvt_pk_bf16_f32 v13, v38, v39
  v_cvt_pk_bf16_f32 v14, v44, v45
  v_cvt_pk_bf16_f32 v15, v46, v47
  s_add_u32 s34, s22, 7168
  buffer_store_dwordx4 v[12:15], v1, s[4:7], s34 offen
  v_cvt_pk_bf16_f32 v8, v48, v49
  v_cvt_pk_bf16_f32 v9, v50, v51
  v_cvt_pk_bf16_f32 v10, v56, v57
  v_cvt_pk_bf16_f32 v11, v58, v59
  s_add_u32 s34, s22, 2048
  buffer_store_dwordx4 v[8:11], v1, s[4:7], s34 offen
  v_cvt_pk_bf16_f32 v12, v52, v53
  v_cvt_pk_bf16_f32 v13, v54, v55
  v_cvt_pk_bf16_f32 v14, v60, v61
  v_cvt_pk_bf16_f32 v15, v62, v63
  s_add_u32 s34, s22, 8192
  buffer_store_dwordx4 v[12:15], v1, s[4:7], s34 offen
  s_waitcnt vmcnt(0)
  s_barrier
  s_add_u32 s17, s17, 1
  s_cmp_lt_u32 s17, 64
  s_cbranch_scc1 reca_ptop272
  s_branch reca_exit1
reca_pslow271:
reca_ptop277:
  s_cmp_lt_u32 s17, 3
  s_cbranch_scc1 reca_pgo278
  s_sub_u32 s36, s17, 3
reca_ppoll279:
  buffer_load_dword v28, v4, s[4:7], s25 offen sc1
  s_waitcnt vmcnt(0)
  v_readfirstlane_b32 s34, v28
  s_nop 3
  s_cmp_ge_i32 s34, s36
  s_cbranch_scc1 reca_pgo278
  s_sleep 8
  s_sub_u32 s18, s18, 1
  s_cbranch_scc0 reca_ppoll279
  s_mov_b32 s18, 0
reca_pgo278:
  s_waitcnt vmcnt(0)
  s_barrier
  v_add_u32 v7, s26, v1
  s_xor_b32 s26, s26, 40960
  s_add_u32 s37, s17, 1
  s_cmp_ge_u32 s37, 64
  s_cbranch_scc1 reca_pnodma280
  s_mul_i32 s20, s37, 40960
  s_add_u32 s20, s20, 84965376
  s_add_u32 m0, s26, 30720
  s_nop 0
  buffer_load_dwordx4 v1, s[4:7], s20 offen offset:0 lds
  buffer_load_dwordx4 v1, s[4:7], s20 offen offset:1024 lds
  buffer_load_dwordx4 v1, s[4:7], s20 offen offset:2048 lds
  buffer_load_dwordx4 v1, s[4:7], s20 offen offset:3072 lds
  s_add_u32 s20, s20, 4096
  s_add_u32 m0, s26, 34816
  s_nop 0
  buffer_load_dwordx4 v1, s[4:7], s20 offen offset:0 lds
  buffer_load_dwordx4 v1, s[4:7], s20 offen offset:1024 lds
  buffer_load_dwordx4 v1, s[4:7], s20 offen offset:2048 lds
  buffer_load_dwordx4 v1, s[4:7], s20 offen offset:3072 lds
  s_add_u32 s20, s20, 4096
  s_add_u32 m0, s26, 38912
  s_nop 0
  buffer_load_dwordx4 v1, s[4:7], s20 offen offset:0 lds
  buffer_load_dwordx4 v1, s[4:7], s20 offen offset:1024 lds
reca_pnodma280:
  s_lshl_b32 s34, s15, 3
  s_and_b32 s35, s17, 7
  s_add_u32 s34, s34, s35
  s_mul_i32 s34, s34, 12288
  s_mul_i32 s35, s16, 3072
  s_add_u32 s35, s35, s34
  s_add_u32 s21, s35, 37748736
  s_add_u32 s22, s35, 44040192
  s_mul_i32 s35, s16, 6144
  s_add_u32 s35, s35, s34
  s_add_u32 s23, s35, 40894464
  ds_read_b128 v[72:75], v7 offset:0
  ds_read_b128 v[76:79], v7 offset:20480
  ds_read_b128 v[80:83], v7 offset:1024
  ds_read_b128 v[84:87], v7 offset:21504
  ds_read_b128 v[88:91], v7 offset:2048
  ds_read_b128 v[92:95], v7 offset:22528
  s_waitcnt lgkmcnt(4)
  v_mfma_f32_16x16x32_bf16 v[32:35], a[0:3], v[72:75], 0
  v_mfma_f32_16x16x32_bf16 v[36:39], a[0:3], v[76:79], 0
  v_mfma_f32_16x16x32_bf16 v[40:43], a[80:83], v[72:75], 0
  v_mfma_f32_16x16x32_bf16 v[44:47], a[80:83], v[76:79], 0
  v_mfma_f32_16x16x32_bf16 v[48:51], a[160:163], v[72:75], 0
  v_mfma_f32_16x16x32_bf16 v[52:55], a[160:163], v[76:79], 0
  v_mfma_f32_16x16x32_bf16 v[56:59], v[96:99], v[72:75], 0
  v_mfma_f32_16x16x32_bf16 v[60:63], v[96:99], v[76:79], 0
  ds_read_b128 v[72:75], v7 offset:3072
  ds_read_b128 v[76:79], v7 offset:23552
  s_waitcnt lgkmcnt(4)
  v_mfma_f32_16x16x32_bf16 v[32:35], a[4:7], v[80:83], v[32:35]
  v_mfma_f32_16x16x32_bf16 v[36:39], a[4:7], v[84:87], v[36:39]
  v_mfma_f32_16x16x32_bf16 v[40:43], a[84:87], v[80:83], v[40:43]
  v_mfma_f32_16x16x32_bf16 v[44:47], a[84:87], v[84:87], v[44:47]
  v_mfma_f32_16x16x32_bf16 v[48:51], a[164:167], v[80:83], v[48:51]
  v_mfma_f32_16x16x32_bf16 v[52:55], a[164:167], v[84:87], v[52:55]
  v_mfma_f32_16x16x32_bf16 v[56:59], v[100:103], v[80:83], v[56:59]
  v_mfma_f32_16x16x32_bf16 v[60:63], v[100:103], v[84:87], v[60:63]
  ds_read_b128 v[80:83], v7 offset:4096
  ds_read_b128 v[84:87], v7 offset:24576
  s_waitcnt lgkmcnt(4)
  v_mfma_f32_16x16x32_bf16 v[32:35], a[8:11], v[88:91], v[32:35]
  v_mfma_f32_16x16x32_bf16 v[36:39], a[8:11], v[92:95], v[36:39]
  v_mfma_f32_16x16x32_bf16 v[40:43], a[88:91], v[88:91], v[40:43]
  v_mfma_f32_16x16x32_bf16 v[44:47], a[88:91], v[92:95], v[44:47]
  v_mfma_f32_16x16x32_bf16 v[48:51], a[168:171], v[88:91], v[48:51]
  v_mfma_f32_16x16x32_bf16 v[52:55], a[168:171], v[92:95], v[52:55]
  v_mfma_f32_16x16x32_bf16 v[56:59], v[104:107], v[88:91], v[56:59]
  v_mfma_f32_16x16x32_bf16 v[60:63], v[104:107], v[92:95], v[60:63]
  ds_read_b128 v[88:91], v7 offset:5120
  ds_read_b128 v[92:95], v7 offset:25600
  s_waitcnt lgkmcnt(4)
  v_mfma_f32_16x16x32_bf16 v[32:35], a[12:15], v[72:75], v[32:35]
  v_mfma_f32_16x16x32_bf16 v[36:39], a[12:15], v[76:79], v[36:39]
  v_mfma_f32_16x16x32_bf16 v[40:43], a[92:95], v[72:75], v[40:43]
  v_mfma_f32_16x16x32_bf16 v[44:47], a[92:95], v[76:79], v[44:47]
  v_mfma_f32_16x16x32_bf16 v[48:51], a[172:175], v[72:75], v[48:51]
  v_mfma_f32_16x16x32_bf16 v[52:55], a[172:175], v[76:79], v[52:55]
  v_mfma_f32_16x16x32_bf16 v[56:59], v[108:111], v[72:75], v[56:59]
  v_mfma_f32_16x16x32_bf16 v[60:63], v[108:111], v[76:79], v[60:63]
  ds_read_b128 v[72:75], v7 offset:6144
  ds_read_b128 v[76:79], v7 offset:26624
  s_waitcnt lgkmcnt(4)
  v_mfma_f32_16x16x32_bf16 v[32:35], a[16:19], v[80:83], v[32:35]
  v_mfma_f32_16x16x32_bf16 v[36:39], a[16:19], v[84:87], v[36:39]
  v_mfma_f32_16x16x32_bf16 v[40:43], a[96:99], v[80:83], v[40:43]
  v_mfma_f32_16x16x32_bf16 v[44:47], a[96:99], v[84:87], v[44:47]
  v_mfma_f32_16x16x32_bf16 v[48:51], a[176:179], v[80:83], v[48:51]
  v_mfma_f32_16x16x32_bf16 v[52:55], a[176:179], v[84:87], v[52:55]
  v_mfma_f32_16x16x32_bf16 v[56:59], v[112:115], v[80:83], v[56:59]
  v_mfma_f32_16x16x32_bf16 v[60:63], v[112:115], v[84:87], v[60:63]
  ds_read_b128 v[80:83], v7 offset:7168
  ds_read_b128 v[84:87], v7 offset:27648
  s_waitcnt lgkmcnt(4)
  v_mfma_f32_16x16x32_bf16 v[32:35], a[20:23], v[88:91], v[32:35]
  v_mfma_f32_16x16x32_bf16 v[36:39], a[20:23], v[92:95], v[36:39]
  v_mfma_f32_16x16x32_bf16 v[40:43], a[100:103], v[88:91], v[40:43]
  v_mfma_f32_16x16x32_bf16 v[44:47], a[100:103], v[92:95], v[44:47]
  v_mfma_f32_16x16x32_bf16 v[48:51], a[180:183], v[88:91], v[48:51]
  v_mfma_f32_16x16x32_bf16 v[52:55], a[180:183], v[92:95], v[52:55]
  v_mfma_f32_16x16x32_bf16 v[56:59], v[116:119], v[88:91], v[56:59]
  v_mfma_f32_16x16x32_bf16 v[60:63], v[116:119], v[92:95], v[60:63]
  ds_read_b128 v[88:91], v7 offset:8192
  ds_read_b128 v[92:95], v7 offset:28672
  s_waitcnt lgkmcnt(4)
  v_mfma_f32_16x16x32_bf16 v[32:35], a[24:27], v[72:75], v[32:35]
  v_mfma_f32_16x16x32_bf16 v[36:39], a[24:27], v[76:79], v[36:39]
  v_mfma_f32_16x16x32_bf16 v[40:43], a[104:107], v[72:75], v[40:43]
  v_mfma_f32_16x16x32_bf16 v[44:47], a[104:107], v[76:79], v[44:47]
  v_mfma_f32_16x16x32_bf16 v[48:51], a[184:187], v[72:75], v[48:51]
  v_mfma_f32_16x16x32_bf16 v[52:55], a[184:187], v[76:79], v[52:55]
  v_mfma_f32_16x16x32_bf16 v[56:59], v[120:123], v[72:75], v[56:59]
  v_mfma_f32_16x16x32_bf16 v[60:63], v[120:123], v[76:79], v[60:63]
  ds_read_b128 v[72:75], v7 offset:9216
  ds_read_b128 v[76:79], v7 offset:29696
  s_waitcnt lgkmcnt(4)
  v_mfma_f32_16x16x32_bf16 v[32:35], a[28:31], v[80:83], v[32:35]
  v_mfma_f32_16x16x32_bf16 v[36:39], a[28:31], v[84:87], v[36:39]
  v_mfma_f32_16x16x32_bf16 v[40:43], a[108:111], v[80:83], v[40:43]
  v_mfma_f32_16x16x32_bf16 v[44:47], a[108:111], v[84:87], v[44:47]
  v_mfma_f32_16x16x32_bf16 v[48:51], a[188:191], v[80:83], v[48:51]
  v_mfma_f32_16x16x32_bf16 v[52:55], a[188:191], v[84:87], v[52:55]
  v_mfma_f32_16x16x32_bf16 v[56:59], v[124:127], v[80:83], v[56:59]
  v_mfma_f32_16x16x32_bf16 v[60:63], v[124:127], v[84:87], v[60:63]
  ds_read_b128 v[80:83], v7 offset:10240
  ds_read_b128 v[84:87], v7 offset:30720
  s_waitcnt lgkmcnt(4)
  v_mfma_f32_16x16x32_bf16 v[32:35], a[32:35], v[88:91], v[32:35]
  v_mfma_f32_16x16x32_bf16 v[36:39], a[32:35], v[92:95], v[36:39]
  v_mfma_f32_16x16x32_bf16 v[40:43], a[112:115], v[88:91], v[40:43]
  v_mfma_f32_16x16x32_bf16 v[44:47], a[112:115], v[92:95], v[44:47]
  v_mfma_f32_16x16x32_bf16 v[48:51], a[192:195], v[88:91], v[48:51]
  v_mfma_f32_16x16x32_bf16 v[52:55], a[192:195], v[92:95], v[52:55]
  v_mfma_f32_16x16x32_bf16 v[56:59], v[128:131], v[88:91], v[56:59]
  v_mfma_f32_16x16x32_bf16 v[60:63], v[128:131], v[92:95], v[60:63]
  ds_read_b128 v[88:91], v7 offset:11264
  ds_read_b128 v[92:95], v7 offset:31744
  s_waitcnt lgkmcnt(4)
  v_mfma_f32_16x16x32_bf16 v[32:35], a[36:39], v[72:75], v[32:35]
  v_mfma_f32_16x16x32_bf16 v[36:39], a[36:39], v[76:79], v[36:39]
  v_mfma_f32_16x16x32_bf16 v[40:43], a[116:119], v[72:75], v[40:43]
  v_mfma_f32_16x16x32_bf16 v[44:47], a[116:119], v[76:79], v[44:47]
  v_mfma_f32_16x16x32_bf16 v[48:51], a[196:199], v[72:75], v[48:51]
  v_mfma_f32_16x16x32_bf16 v[52:55], a[196:199], v[76:79], v[52:55]
  v_mfma_f32_16x16x32_bf16 v[56:59], v[132:135], v[72:75], v[56:59]
  v_mfma_f32_16x16x32_bf16 v[60:63], v[132:135], v[76:79], v[60:63]
  ds_read_b128 v[72:75], v7 offset:12288
  ds_read_b128 v[76:79], v7 offset:32768
  s_waitcnt lgkmcnt(4)
  v_mfma_f32_16x16x32_bf16 v[32:35], a[40:43], v[80:83], v[32:35]
  v_mfma_f32_16x16x32_bf16 v[36:39], a[40:43], v[84:87], v[36:39]
  v_mfma_f32_16x16x32_bf16 v[40:43], a[120:123], v[80:83], v[40:43]
  v_mfma_f32_16x16x32_bf16 v[44:47], a[120:123], v[84:87], v[44:47]
  v_mfma_f32_16x16x32_bf16 v[48:51], a[200:203], v[80:83], v[48:51]
  v_mfma_f32_16x16x32_bf16 v[52:55], a[200:203], v[84:87], v[52:55]
  v_mfma_f32_16x16x32_bf16 v[56:59], v[136:139], v[80:83], v[56:59]
  v_mfma_f32_16x16x32_bf16 v[60:63], v[136:139], v[84:87], v[60:63]
  ds_read_b128 v[80:83], v7 offset:13312
  ds_read_b128 v[84:87], v7 offset:33792
  s_waitcnt lgkmcnt(4)
  v_mfma_f32_16x16x32_bf16 v[32:35], a[44:47], v[88:91], v[32:35]
  v_mfma_f32_16x16x32_bf16 v[36:39], a[44:47], v[92:95], v[36:39]
  v_mfma_f32_16x16x32_bf16 v[40:43], a[124:127], v[88:91], v[40:43]
  v_mfma_f32_16x16x32_bf16 v[44:47], a[124:127], v[92:95], v[44:47]
  v_mfma_f32_16x16x32_bf16 v[48:51], a[204:207], v[88:91], v[48:51]
  v_mfma_f32_16x16x32_bf16 v[52:55], a[204:207], v[92:95], v[52:55]
  v_mfma_f32_16x16x32_bf16 v[56:59], v[140:143], v[88:91], v[56:59]
  v_mfma_f32_16x16x32_bf16 v[60:63], v[140:143], v[92:95], v[60:63]
  ds_read_b128 v[88:91], v7 offset:14336
  ds_read_b128 v[92:95], v7 offset:34816
  s_waitcnt lgkmcnt(4)
  v_mfma_f32_16x16x32_bf16 v[32:35], a[48:51], v[72:75], v[32:35]
  v_mfma_f32_16x16x32_bf16 v[36:39], a[48:51], v[76:79], v[36:39]
  v_mfma_f32_16x16x32_bf16 v[40:43], a[128:131], v[72:75], v[40:43]
  v_mfma_f32_16x16x32_bf16 v[44:47], a[128:131], v[76:79], v[44:47]
  v_mfma_f32_16x16x32_bf16 v[48:51], a[208:211], v[72:75], v[48:51]
  v_mfma_f32_16x16x32_bf16 v[52:55], a[208:211], v[76:79], v[52:55]
  v_mfma_f32_16x16x32_bf16 v[56:59], v[144:147], v[72:75], v[56:59]
  v_mfma_f32_16x16x32_bf16 v[60:63], v[144:147], v[76:79], v[60:63]
  ds_read_b128 v[72:75], v7 offset:15360
  ds_read_b128 v[76:79], v7 offset:35840
  s_waitcnt lgkmcnt(4)
  v_mfma_f32_16x16x32_bf16 v[32:35], a[52:55], v[80:83], v[32:35]
  v_mfma_f32_16x16x32_bf16 v[36:39], a[52:55], v[84:87], v[36:39]
  v_mfma_f32_16x16x32_bf16 v[40:43], a[132:135], v[80:83], v[40:43]
  v_mfma_f32_16x16x32_bf16 v[44:47], a[132:135], v[84:87], v[44:47]
  v_mfma_f32_16x16x32_bf16 v[48:51], a[212:215], v[80:83], v[48:51]
  v_mfma_f32_16x16x32_bf16 v[52:55], a[212:215], v[84:87], v[52:55]
  v_mfma_f32_16x16x32_bf16 v[56:59], v[148:151], v[80:83], v[56:59]
  v_mfma_f32_16x16x32_bf16 v[60:63], v[148:151], v[84:87], v[60:63]
  ds_read_b128 v[80:83], v7 offset:16384
  ds_read_b128 v[84:87], v7 offset:36864
  s_waitcnt lgkmcnt(4)
  v_mfma_f32_16x16x32_bf16 v[32:35], a[56:59], v[88:91], v[32:35]
  v_mfma_f32_16x16x32_bf16 v[36:39], a[56:59], v[92:95], v[36:39]
  v_mfma_f32_16x16x32_bf16 v[40:43], a[136:139], v[88:91], v[40:43]
  v_mfma_f32_16x16x32_bf16 v[44:47], a[136:139], v[92:95], v[44:47]
  v_mfma_f32_16x16x32_bf16 v[48:51], a[216:219], v[88:91], v[48:51]
  v_mfma_f32_16x16x32_bf16 v[52:55], a[216:219], v[92:95], v[52:55]
  v_mfma_f32_16x16x32_bf16 v[56:59], v[152:155], v[88:91], v[56:59]
  v_mfma_f32_16x16x32_bf16 v[60:63], v[152:155], v[92:95], v[60:63]
  ds_read_b128 v[88:91], v7 offset:17408
  ds_read_b128 v[92:95], v7 offset:37888
  s_waitcnt lgkmcnt(4)
  v_mfma_f32_16x16x32_bf16 v[32:35], a[60:63], v[72:75], v[32:35]
  v_mfma_f32_16x16x32_bf16 v[36:39], a[60:63], v[76:79], v[36:39]
  v_mfma_f32_16x16x32_bf16 v[40:43], a[140:143], v[72:75], v[40:43]
  v_mfma_f32_16x16x32_bf16 v[44:47], a[140:143], v[76:79], v[44:47]
  v_mfma_f32_16x16x32_bf16 v[48:51], a[220:223], v[72:75], v[48:51]
  v_mfma_f32_16x16x32_bf16 v[52:55], a[220:223], v[76:79], v[52:55]
  v_mfma_f32_16x16x32_bf16 v[56:59], v[156:159], v[72:75], v[56:59]
  v_mfma_f32_16x16x32_bf16 v[60:63], v[156:159], v[76:79], v[60:63]
  ds_read_b128 v[72:75], v7 offset:18432
  ds_read_b128 v[76:79], v7 offset:38912
  s_waitcnt lgkmcnt(4)
  v_mfma_f32_16x16x32_bf16 v[32:35], a[64:67], v[80:83], v[32:35]
  v_mfma_f32_16x16x32_bf16 v[36:39], a[64:67], v[84:87], v[36:39]
  v_mfma_f32_16x16x32_bf16 v[40:43], a[144:147], v[80:83], v[40:43]
  v_mfma_f32_16x16x32_bf16 v[44:47], a[144:147], v[84:87], v[44:47]
  v_mfma_f32_16x16x32_bf16 v[48:51], a[224:227], v[80:83], v[48:51]
  v_mfma_f32_16x16x32_bf16 v[52:55], a[224:227], v[84:87], v[52:55]
  v_mfma_f32_16x16x32_bf16 v[56:59], v[160:163], v[80:83], v[56:59]
  v_mfma_f32_16x16x32_bf16 v[60:63], v[160:163], v[84:87], v[60:63]
  ds_read_b128 v[80:83], v7 offset:19456
  ds_read_b128 v[84:87], v7 offset:39936
  s_waitcnt lgkmcnt(4)
  v_mfma_f32_16x16x32_bf16 v[32:35], a[68:71], v[88:91], v[32:35]
  v_mfma_f32_16x16x32_bf16 v[36:39], a[68:71], v[92:95], v[36:39]
  v_mfma_f32_16x16x32_bf16 v[40:43], a[148:151], v[88:91], v[40:43]
  v_mfma_f32_16x16x32_bf16 v[44:47], a[148:151], v[92:95], v[44:47]
  v_mfma_f32_16x16x32_bf16 v[48:51], a[228:231], v[88:91], v[48:51]
  v_mfma_f32_16x16x32_bf16 v[52:55], a[228:231], v[92:95], v[52:55]
  v_mfma_f32_16x16x32_bf16 v[56:59], v[164:167], v[88:91], v[56:59]
  v_mfma_f32_16x16x32_bf16 v[60:63], v[164:167], v[92:95], v[60:63]
  s_waitcnt lgkmcnt(2)
  v_mfma_f32_16x16x32_bf16 v[32:35], a[72:75], v[72:75], v[32:35]
  v_mfma_f32_16x16x32_bf16 v[36:39], a[72:75], v[76:79], v[36:39]
  v_mfma_f32_16x16x32_bf16 v[40:43], a[152:155], v[72:75], v[40:43]
  v_mfma_f32_16x16x32_bf16 v[44:47], a[152:155], v[76:79], v[44:47]
  v_mfma_f32_16x16x32_bf16 v[48:51], a[232:235], v[72:75], v[48:51]
  v_mfma_f32_16x16x32_bf16 v[52:55], a[232:235], v[76:79], v[52:55]
  v_mfma_f32_16x16x32_bf16 v[56:59], v[168:171], v[72:75], v[56:59]
  v_mfma_f32_16x16x32_bf16 v[60:63], v[168:171], v[76:79], v[60:63]
  s_waitcnt lgkmcnt(0)
  v_mfma_f32_16x16x32_bf16 v[32:35], a[76:79], v[80:83], v[32:35]
  v_mfma_f32_16x16x32_bf16 v[36:39], a[76:79], v[84:87], v[36:39]
  v_mfma_f32_16x16x32_bf16 v[40:43], a[156:159], v[80:83], v[40:43]
  v_mfma_f32_16x16x32_bf16 v[44:47], a[156:159], v[84:87], v[44:47]
  v_mfma_f32_16x16x32_bf16 v[48:51], a[236:239], v[80:83], v[48:51]
  v_mfma_f32_16x16x32_bf16 v[52:55], a[236:239], v[84:87], v[52:55]
  v_mfma_f32_16x16x32_bf16 v[56:59], v[172:175], v[80:83], v[56:59]
  v_mfma_f32_16x16x32_bf16 v[60:63], v[172:175], v[84:87], v[60:63]
  s_nop 0
  v_cvt_pk_bf16_f32 v8, v32, v33
  v_cvt_pk_bf16_f32 v9, v34, v35
  v_cvt_pk_bf16_f32 v10, v40, v41
  v_cvt_pk_bf16_f32 v11, v42, v43
  s_add_u32 s34, s22, 1024
  buffer_store_dwordx4 v[8:11], v1, s[4:7], s34 offen sc1
  v_cvt_pk_bf16_f32 v12, v36, v37
  v_cvt_pk_bf16_f32 v13, v38, v39
  v_cvt_pk_bf16_f32 v14, v44, v45
  v_cvt_pk_bf16_f32 v15, v46, v47
  s_add_u32 s34, s22, 7168
  buffer_store_dwordx4 v[12:15], v1, s[4:7], s34 offen sc1
  v_cvt_pk_bf16_f32 v8, v48, v49
  v_cvt_pk_bf16_f32 v9, v50, v51
  v_cvt_pk_bf16_f32 v10, v56, v57
  v_cvt_pk_bf16_f32 v11, v58, v59
  s_add_u32 s34, s22, 2048
  buffer_store_dwordx4 v[8:11], v1, s[4:7], s34 offen sc1
  v_cvt_pk_bf16_f32 v12, v52, v53
  v_cvt_pk_bf16_f32 v13, v54, v55
  v_cvt_pk_bf16_f32 v14, v60, v61
  v_cvt_pk_bf16_f32 v15, v62, v63
  s_add_u32 s34, s22, 8192
  buffer_store_dwordx4 v[12:15], v1, s[4:7], s34 offen sc1
  s_waitcnt vmcnt(0)
  s_barrier
  s_add_u32 s17, s17, 1
  s_cmp_lt_u32 s17, 64
  s_cbranch_scc1 reca_ptop277
  s_branch reca_exit1
reca_exit1:
reca_exitb3:
  s_endpgm
.globl fin_kernel
.p2align 8
.type fin_kernel,@function
fin_kernel:
  s_cmp_ge_u32 s2, 256
  s_cbranch_scc1 fin_exit1
  s_load_dwordx2 s[8:9], s[0:1], 96
  v_lshrrev_b32 v6, 6, v0
  v_and_b32 v7, 63, v0
  s_and_b32 s13, s2, 7
  v_readfirstlane_b32 s12, v6
  v_lshlrev_b32 v1, 4, v7
  v_add_u32 v2, 0x1000, v1
  v_add_u32 v3, 0x2000, v1
  s_lshr_b32 s14, s2, 3
  s_lshl_b32 s15, s13, 2
  s_add_u32 s15, s15, s12
  s_waitcnt lgkmcnt(0)
  s_mov_b32 s4, s8
  s_mov_b32 s5, s9
  s_mov_b32 s6, 0x10000000
  s_mov_b32 s7, 0x20000
  s_mov_b32 s27, 0x3dd53b95
  v_and_b32 v6, 15, v7
  v_lshrrev_b32 v8, 4, v7
  v_mov_b32 v9, 0x80000000
  v_lshlrev_b32 v10, 4, v6
  v_lshl_add_u32 v10, v8, 7, v10
  v_cmp_gt_u32 vcc, 8, v6
  s_nop 1
  v_cndmask_b32 v4, v9, v10, vcc
  v_lshlrev_b32 v10, 3, v7
  v_cmp_gt_u32 vcc, 32, v7
  s_nop 1
  v_cndmask_b32 v5, v9, v10, vcc
  v_mov_b32 v10, 0xf149f2ca
  v_cmp_le_u32 vcc, 2, v8
  s_nop 1
  v_cndmask_b32 v12, 0, v10, vcc
  v_mov_b32 v13, v12
  v_mov_b32 v14, v12
  v_mov_b32 v15, v12
  v_lshlrev_b32 v11, 2, v8
  v_add_u32 v7, 0, v11
  v_cmp_gt_u32 vcc, v7, v6
  s_nop 1
  v_cndmask_b32 v16, 0, v10, vcc
  v_add_u32 v7, 1, v11
  v_cmp_gt_u32 vcc, v7, v6
  s_nop 1
  v_cndmask_b32 v17, 0, v10, vcc
  v_add_u32 v7, 2, v11
  v_cmp_gt_u32 vcc, v7, v6
  s_nop 1
  v_cndmask_b32 v18, 0, v10, vcc
  v_add_u32 v7, 3, v11
  v_cmp_gt_u32 vcc, v7, v6
  s_nop 1
  v_cndmask_b32 v19, 0, v10, vcc
  v_mov_b32 v20, 0x3f803f80
  v_mov_b32 v21, 0x3f803f80
  v_mov_b32 v22, 0x3f803f80
  v_mov_b32 v23, 0x3f803f80
  s_mul_i32 s16, s12, 6144
  v_add_u32 v240, s16, v1
  v_add_u32 v241, 49152, v240
  s_mul_i32 s16, s12, 10
  s_mul_i32 s16, s16, 192
  s_mul_i32 s17, s13, 24
  s_add_u32 s16, s16, s17
  s_lshl_b32 s16, s16, 10
  s_add_u32 s16, s16, 29884416
  s_add_u32 s30, s16, 0
  s_add_u32 s31, s16, 196608
  s_add_u32 s32, s16, 393216
  s_add_u32 s33, s16, 589824
  s_add_u32 s34, s16, 786432
  s_add_u32 s35, s16, 983040
  s_add_u32 s36, s16, 1179648
  s_add_u32 s37, s16, 1376256
  s_add_u32 s38, s16, 1572864
  s_add_u32 s39, s16, 1769472
  s_cmp_lt_u32 s14, 30
  s_cbranch_scc1 fin_odma3
  s_lshl_b32 s17, s14, 1
  s_add_u32 s17, s17, 0
  s_and_b32 s17, s17, 7
  s_lshl_b32 s16, s15, 3
  s_add_u32 s16, s16, s17
  s_mul_i32 s16, s16, 12288
  s_add_u32 s20, s16, 44040192
  s_add_u32 s21, s16, 37748736
  s_add_u32 s22, s16, 40894464
  s_lshl_b32 s17, s17, 5
  s_add_u32 s17, s17, s15
  s_mul_i32 s17, s17, 3072
  s_add_u32 s23, s17, 47185920
  s_add_u32 s24, s17, 47972352
  buffer_load_dwordx4 v[136:139], v1, s[4:7], s21 offen offset:0
  buffer_load_dwordx4 v[140:143], v1, s[4:7], s21 offen offset:1024
  buffer_load_dwordx4 v[144:147], v1, s[4:7], s21 offen offset:2048
  buffer_load_dwordx4 v[148:151], v1, s[4:7], s21 offen offset:3072
  buffer_load_dwordx4 v[152:155], v2, s[4:7], s21 offen offset:0
  buffer_load_dwordx4 v[156:159], v2, s[4:7], s21 offen offset:1024
  buffer_load_dwordx4 v[160:163], v2, s[4:7], s21 offen offset:2048
  buffer_load_dwordx4 v[164:167], v2, s[4:7], s21 offen offset:3072
  buffer_load_dwordx4 v[168:171], v3, s[4:7], s21 offen offset:0
  buffer_load_dwordx4 v[172:175], v3, s[4:7], s21 offen offset:1024
  buffer_load_dwordx4 v[176:179], v3, s[4:7], s21 offen offset:2048
  buffer_load_dwordx4 v[180:183], v3, s[4:7], s21 offen offset:3072
  buffer_load_dwordx4 v[184:187], v4, s[4:7], s23 offen offset:0
  buffer_load_dwordx4 v[188:191], v4, s[4:7], s23 offen offset:512
  buffer_load_dwordx4 v[192:195], v4, s[4:7], s23 offen offset:1024
  buffer_load_dwordx4 v[196:199], v4, s[4:7], s23 offen offset:1536
  buffer_load_dwordx4 v[200:203], v4, s[4:7], s23 offen offset:2048
  buffer_load_dwordx4 v[204:207], v4, s[4:7], s23 offen offset:2560
  buffer_load_dwordx4 v[88:91], v1, s[4:7], s20 offen offset:0
  buffer_load_dwordx4 v[92:95], v1, s[4:7], s20 offen offset:1024
  buffer_load_dwordx4 v[96:99], v1, s[4:7], s20 offen offset:2048
  buffer_load_dwordx4 v[100:103], v1, s[4:7], s20 offen offset:3072
  buffer_load_dwordx4 v[104:107], v2, s[4:7], s20 offen offset:0
  buffer_load_dwordx4 v[108:111], v2, s[4:7], s20 offen offset:1024
  buffer_load_dwordx4 v[112:115], v2, s[4:7], s20 offen offset:2048
  buffer_load_dwordx4 v[116:119], v2, s[4:7], s20 offen offset:3072
  buffer_load_dwordx4 v[120:123], v3, s[4:7], s20 offen offset:0
  buffer_load_dwordx4 v[124:127], v3, s[4:7], s20 offen offset:1024
  buffer_load_dwordx4 v[128:131], v3, s[4:7], s20 offen offset:2048
  buffer_load_dwordx4 v[132:135], v3, s[4:7], s20 offen offset:3072
  s_waitcnt vmcnt(5)
  v_mfma_f32_16x16x32_bf16 v[24:27], v[184:187], v[88:91], v[12:15]
  v_mfma_f32_16x16x32_bf16 v[28:31], v[136:139], v[88:91], v[16:19]
  v_mfma_f32_16x16x32_bf16 v[32:35], v[184:187], v[112:115], v[12:15]
  v_mfma_f32_16x16x32_bf16 v[36:39], v[136:139], v[112:115], 0
  v_mfma_f32_16x16x32_bf16 v[40:43], v[160:163], v[112:115], v[16:19]
  s_waitcnt vmcnt(4)
  v_mfma_f32_16x16x32_bf16 v[24:27], v[188:191], v[92:95], v[24:27]
  v_mfma_f32_16x16x32_bf16 v[28:31], v[140:143], v[92:95], v[28:31]
  v_mfma_f32_16x16x32_bf16 v[32:35], v[188:191], v[116:119], v[32:35]
  v_mfma_f32_16x16x32_bf16 v[36:39], v[140:143], v[116:119], v[36:39]
  v_mfma_f32_16x16x32_bf16 v[40:43], v[164:167], v[116:119], v[40:43]
  s_waitcnt vmcnt(3)
  v_mfma_f32_16x16x32_bf16 v[24:27], v[192:195], v[96:99], v[24:27]
  v_mfma_f32_16x16x32_bf16 v[28:31], v[144:147], v[96:99], v[28:31]
  v_mfma_f32_16x16x32_bf16 v[32:35], v[192:195], v[120:123], v[32:35]
  v_mfma_f32_16x16x32_bf16 v[36:39], v[144:147], v[120:123], v[36:39]
  v_mfma_f32_16x16x32_bf16 v[40:43], v[168:171], v[120:123], v[40:43]
  s_waitcnt vmcnt(2)
  v_mfma_f32_16x16x32_bf16 v[24:27], v[196:199], v[100:103], v[24:27]
  v_mfma_f32_16x16x32_bf16 v[28:31], v[148:151], v[100:103], v[28:31]
  v_mfma_f32_16x16x32_bf16 v[32:35], v[196:199], v[124:127], v[32:35]
  v_mfma_f32_16x16x32_bf16 v[36:39], v[148:151], v[124:127], v[36:39]
  v_mfma_f32_16x16x32_bf16 v[40:43], v[172:175], v[124:127], v[40:43]
  s_waitcnt vmcnt(1)
  v_mfma_f32_16x16x32_bf16 v[24:27], v[200:203], v[104:107], v[24:27]
  v_mfma_f32_16x16x32_bf16 v[28:31], v[152:155], v[104:107], v[28:31]
  v_mfma_f32_16x16x32_bf16 v[32:35], v[200:203], v[128:131], v[32:35]
  v_mfma_f32_16x16x32_bf16 v[36:39], v[152:155], v[128:131], v[36:39]
  v_mfma_f32_16x16x32_bf16 v[40:43], v[176:179], v[128:131], v[40:43]
  s_waitcnt vmcnt(0)
  v_mfma_f32_16x16x32_bf16 v[24:27], v[204:207], v[108:111], v[24:27]
  v_mfma_f32_16x16x32_bf16 v[28:31], v[156:159], v[108:111], v[28:31]
  v_mfma_f32_16x16x32_bf16 v[32:35], v[204:207], v[132:135], v[32:35]
  v_mfma_f32_16x16x32_bf16 v[36:39], v[156:159], v[132:135], v[36:39]
  v_mfma_f32_16x16x32_bf16 v[40:43], v[180:183], v[132:135], v[40:43]
  buffer_load_dwordx4 v[88:91], v1, s[4:7], s22 offen offset:0
  buffer_load_dwordx4 v[92:95], v1, s[4:7], s22 offen offset:1024
  buffer_load_dwordx4 v[96:99], v1, s[4:7], s22 offen offset:2048
  buffer_load_dwordx4 v[100:103], v1, s[4:7], s22 offen offset:3072
  buffer_load_dwordx4 v[104:107], v2, s[4:7], s22 offen offset:0
  buffer_load_dwordx4 v[108:111], v2, s[4:7], s22 offen offset:1024
  buffer_load_dwordx4 v[112:115], v2, s[4:7], s22 offen offset:2048
  buffer_load_dwordx4 v[116:119], v2, s[4:7], s22 offen offset:3072
  buffer_load_dwordx4 v[120:123], v3, s[4:7], s22 offen offset:0
  buffer_load_dwordx4 v[124:127], v3, s[4:7], s22 offen offset:1024
  buffer_load_dwordx4 v[128:131], v3, s[4:7], s22 offen offset:2048
  buffer_load_dwordx4 v[132:135], v3, s[4:7], s22 offen offset:3072
  buffer_load_dwordx2 v[136:137], v5, s[4:7], s24 offen offset:0
  buffer_load_dwordx2 v[138:139], v5, s[4:7], s24 offen offset:256
  buffer_load_dwordx2 v[140:141], v5, s[4:7], s24 offen offset:512
  buffer_load_dwordx2 v[142:143], v5, s[4:7], s24 offen offset:768
  buffer_load_dwordx2 v[144:145], v5, s[4:7], s24 offen offset:1024
  buffer_load_dwordx2 v[146:147], v5, s[4:7], s24 offen offset:1280
  buffer_load_dwordx2 v[148:149], v5, s[4:7], s24 offen offset:1536
  buffer_load_dwordx2 v[150:151], v5, s[4:7], s24 offen offset:1792
  buffer_load_dwordx2 v[152:153], v5, s[4:7], s24 offen offset:2048
  buffer_load_dwordx2 v[154:155], v5, s[4:7], s24 offen offset:2304
  buffer_load_dwordx2 v[156:157], v5, s[4:7], s24 offen offset:2560
  buffer_load_dwordx2 v[158:159], v5, s[4:7], s24 offen offset:2816
  v_max3_f32 v6, v24, v25, v26
  v_max3_f32 v6, v6, v27, v28
  v_max3_f32 v6, v6, v29, v30
  v_max_f32 v6, v6, v31
  v_mov_b32 v7, v6
  s_nop 1
  v_permlane32_swap_b32 v6, v7
  v_max_f32 v6, v6, v7
  v_mov_b32 v7, v6
  s_nop 1
  v_permlane16_swap_b32 v6, v7
  v_max_f32 v6, v6, v7
  v_mul_f32 v6, s27, v6
  v_fma_f32 v24, v24, s27, -v6
  v_fma_f32 v25, v25, s27, -v6
  v_fma_f32 v26, v26, s27, -v6
  v_fma_f32 v27, v27, s27, -v6
  v_fma_f32 v28, v28, s27, -v6
  v_fma_f32 v29, v29, s27, -v6
  v_fma_f32 v30, v30, s27, -v6
  v_fma_f32 v31, v31, s27, -v6
  v_exp_f32 v24, v24
  v_exp_f32 v25, v25
  v_exp_f32 v26, v26
  v_exp_f32 v27, v27
  v_exp_f32 v28, v28
  v_exp_f32 v29, v29
  v_exp_f32 v30, v30
  v_exp_f32 v31, v31
  v_max3_f32 v8, v32, v33, v34
  v_max3_f32 v8, v8, v35, v36
  v_max3_f32 v8, v8, v37, v38
  v_max3_f32 v8, v8, v39, v40
  v_max3_f32 v8, v8, v41, v42
  v_max_f32 v8, v8, v43
  v_mov_b32 v10, v8
  s_nop 1
  v_permlane32_swap_b32 v8, v10
  v_max_f32 v8, v8, v10
  v_mov_b32 v10, v8
  s_nop 1
  v_permlane16_swap_b32 v8, v10
  v_max_f32 v8, v8, v10
  v_mul_f32 v8, s27, v8
  v_fma_f32 v32, v32, s27, -v8
  v_fma_f32 v33, v33, s27, -v8
  v_fma_f32 v34, v34, s27, -v8
  v_fma_f32 v35, v35, s27, -v8
  v_fma_f32 v36, v36, s27, -v8
  v_fma_f32 v37, v37, s27, -v8
  v_fma_f32 v38, v38, s27, -v8
  v_fma_f32 v39, v39, s27, -v8
  v_fma_f32 v40, v40, s27, -v8
  v_fma_f32 v41, v41, s27, -v8
  v_fma_f32 v42, v42, s27, -v8
  v_fma_f32 v43, v43, s27, -v8
  v_exp_f32 v32, v32
  v_exp_f32 v33, v33
  v_exp_f32 v34, v34
  v_exp_f32 v35, v35
  v_exp_f32 v36, v36
  v_exp_f32 v37, v37
  v_exp_f32 v38, v38
  v_exp_f32 v39, v39
  v_exp_f32 v40, v40
  v_exp_f32 v41, v41
  v_exp_f32 v42, v42
  v_exp_f32 v43, v43
  v_cvt_pk_bf16_f32 v44, v24, v25
  v_cvt_pk_bf16_f32 v45, v26, v27
  v_cvt_pk_bf16_f32 v46, v28, v29
  v_cvt_pk_bf16_f32 v47, v30, v31
  v_cvt_pk_bf16_f32 v48, v32, v33
  v_cvt_pk_bf16_f32 v49, v34, v35
  v_cvt_pk_bf16_f32 v50, v36, v37
  v_cvt_pk_bf16_f32 v51, v38, v39
  v_cvt_pk_bf16_f32 v52, v40, v41
  v_cvt_pk_bf16_f32 v53, v42, v43
  v_mfma_f32_16x16x16_bf16 v[56:59], v[20:21], v[44:45], 0
  v_mfma_f32_16x16x16_bf16 v[60:63], v[20:21], v[48:49], 0
  v_mfma_f32_16x16x16_bf16 v[56:59], v[20:21], v[46:47], v[56:59]
  v_mfma_f32_16x16x32_bf16 v[60:63], v[20:23], v[50:53], v[60:63]
  s_nop 6
  v_rcp_f32 v10, v56
  v_rcp_f32 v11, v60
  s_waitcnt vmcnt(0)
  v_mfma_f32_16x16x16_bf16 v[64:67], v[136:137], v[44:45], 0
  v_mfma_f32_16x16x16_bf16 v[68:71], v[136:137], v[48:49], 0
  v_mfma_f32_16x16x16_bf16 v[64:67], v[88:89], v[46:47], v[64:67]
  v_mfma_f32_16x16x32_bf16 v[68:71], v[88:91], v[50:53], v[68:71]
  v_mfma_f32_16x16x16_bf16 v[72:75], v[138:139], v[44:45], 0
  v_mfma_f32_16x16x16_bf16 v[76:79], v[138:139], v[48:49], 0
  v_mfma_f32_16x16x16_bf16 v[72:75], v[92:93], v[46:47], v[72:75]
  v_mfma_f32_16x16x32_bf16 v[76:79], v[92:95], v[50:53], v[76:79]
  s_nop 2
  v_mul_f32 v64, v64, v10
  v_mul_f32 v65, v65, v10
  v_mul_f32 v66, v66, v10
  v_mul_f32 v67, v67, v10
  v_cvt_pk_bf16_f32 v80, v64, v65
  v_cvt_pk_bf16_f32 v81, v66, v67
  v_mul_f32 v72, v72, v10
  v_mul_f32 v73, v73, v10
  v_mul_f32 v74, v74, v10
  v_mul_f32 v75, v75, v10
  v_cvt_pk_bf16_f32 v82, v72, v73
  v_cvt_pk_bf16_f32 v83, v74, v75
  ds_write_b128 v240, v[80:83] offset:0
  v_mul_f32 v68, v68, v11
  v_mul_f32 v69, v69, v11
  v_mul_f32 v70, v70, v11
  v_mul_f32 v71, v71, v11
  v_cvt_pk_bf16_f32 v84, v68, v69
  v_cvt_pk_bf16_f32 v85, v70, v71
  v_mul_f32 v76, v76, v11
  v_mul_f32 v77, v77, v11
  v_mul_f32 v78, v78, v11
  v_mul_f32 v79, v79, v11
  v_cvt_pk_bf16_f32 v86, v76, v77
  v_cvt_pk_bf16_f32 v87, v78, v79
  ds_write_b128 v240, v[84:87] offset:24576
  v_mfma_f32_16x16x16_bf16 v[64:67], v[140:141], v[44:45], 0
  v_mfma_f32_16x16x16_bf16 v[68:71], v[140:141], v[48:49], 0
  v_mfma_f32_16x16x16_bf16 v[64:67], v[96:97], v[46:47], v[64:67]
  v_mfma_f32_16x16x32_bf16 v[68:71], v[96:99], v[50:53], v[68:71]
  v_mfma_f32_16x16x16_bf16 v[72:75], v[142:143], v[44:45], 0
  v_mfma_f32_16x16x16_bf16 v[76:79], v[142:143], v[48:49], 0
  v_mfma_f32_16x16x16_bf16 v[72:75], v[100:101], v[46:47], v[72:75]
  v_mfma_f32_16x16x32_bf16 v[76:79], v[100:103], v[50:53], v[76:79]
  s_nop 2
  v_mul_f32 v64, v64, v10
  v_mul_f32 v65, v65, v10
  v_mul_f32 v66, v66, v10
  v_mul_f32 v67, v67, v10
  v_cvt_pk_bf16_f32 v80, v64, v65
  v_cvt_pk_bf16_f32 v81, v66, v67
  v_mul_f32 v72, v72, v10
  v_mul_f32 v73, v73, v10
  v_mul_f32 v74, v74, v10
  v_mul_f32 v75, v75, v10
  v_cvt_pk_bf16_f32 v82, v72, v73
  v_cvt_pk_bf16_f32 v83, v74, v75
  ds_write_b128 v240, v[80:83] offset:1024
  v_mul_f32 v68, v68, v11
  v_mul_f32 v69, v69, v11
  v_mul_f32 v70, v70, v11
  v_mul_f32 v71, v71, v11
  v_cvt_pk_bf16_f32 v84, v68, v69
  v_cvt_pk_bf16_f32 v85, v70, v71
  v_mul_f32 v76, v76, v11
  v_mul_f32 v77, v77, v11
  v_mul_f32 v78, v78, v11
  v_mul_f32 v79, v79, v11
  v_cvt_pk_bf16_f32 v86, v76, v77
  v_cvt_pk_bf16_f32 v87, v78, v79
  ds_write_b128 v240, v[84:87] offset:25600
  v_mfma_f32_16x16x16_bf16 v[64:67], v[144:145], v[44:45], 0
  v_mfma_f32_16x16x16_bf16 v[68:71], v[144:145], v[48:49], 0
  v_mfma_f32_16x16x16_bf16 v[64:67], v[104:105], v[46:47], v[64:67]
  v_mfma_f32_16x16x32_bf16 v[68:71], v[104:107], v[50:53], v[68:71]
  v_mfma_f32_16x16x16_bf16 v[72:75], v[146:147], v[44:45], 0
  v_mfma_f32_16x16x16_bf16 v[76:79], v[146:147], v[48:49], 0
  v_mfma_f32_16x16x16_bf16 v[72:75], v[108:109], v[46:47], v[72:75]
  v_mfma_f32_16x16x32_bf16 v[76:79], v[108:111], v[50:53], v[76:79]
  s_nop 2
  v_mul_f32 v64, v64, v10
  v_mul_f32 v65, v65, v10
  v_mul_f32 v66, v66, v10
  v_mul_f32 v67, v67, v10
  v_cvt_pk_bf16_f32 v80, v64, v65
  v_cvt_pk_bf16_f32 v81, v66, v67
  v_mul_f32 v72, v72, v10
  v_mul_f32 v73, v73, v10
  v_mul_f32 v74, v74, v10
  v_mul_f32 v75, v75, v10
  v_cvt_pk_bf16_f32 v82, v72, v73
  v_cvt_pk_bf16_f32 v83, v74, v75
  ds_write_b128 v240, v[80:83] offset:2048
  v_mul_f32 v68, v68, v11
  v_mul_f32 v69, v69, v11
  v_mul_f32 v70, v70, v11
  v_mul_f32 v71, v71, v11
  v_cvt_pk_bf16_f32 v84, v68, v69
  v_cvt_pk_bf16_f32 v85, v70, v71
  v_mul_f32 v76, v76, v11
  v_mul_f32 v77, v77, v11
  v_mul_f32 v78, v78, v11
  v_mul_f32 v79, v79, v11
  v_cvt_pk_bf16_f32 v86, v76, v77
  v_cvt_pk_bf16_f32 v87, v78, v79
  ds_write_b128 v240, v[84:87] offset:26624
  v_mfma_f32_16x16x16_bf16 v[64:67], v[148:149], v[44:45], 0
  v_mfma_f32_16x16x16_bf16 v[68:71], v[148:149], v[48:49], 0
  v_mfma_f32_16x16x16_bf16 v[64:67], v[112:113], v[46:47], v[64:67]
  v_mfma_f32_16x16x32_bf16 v[68:71], v[112:115], v[50:53], v[68:71]
  v_mfma_f32_16x16x16_bf16 v[72:75], v[150:151], v[44:45], 0
  v_mfma_f32_16x16x16_bf16 v[76:79], v[150:151], v[48:49], 0
  v_mfma_f32_16x16x16_bf16 v[72:75], v[116:117], v[46:47], v[72:75]
  v_mfma_f32_16x16x32_bf16 v[76:79], v[116:119], v[50:53], v[76:79]
  s_nop 2
  v_mul_f32 v64, v64, v10
  v_mul_f32 v65, v65, v10
  v_mul_f32 v66, v66, v10
  v_mul_f32 v67, v67, v10
  v_cvt_pk_bf16_f32 v80, v64, v65
  v_cvt_pk_bf16_f32 v81, v66, v67
  v_mul_f32 v72, v72, v10
  v_mul_f32 v73, v73, v10
  v_mul_f32 v74, v74, v10
  v_mul_f32 v75, v75, v10
  v_cvt_pk_bf16_f32 v82, v72, v73
  v_cvt_pk_bf16_f32 v83, v74, v75
  ds_write_b128 v240, v[80:83] offset:3072
  v_mul_f32 v68, v68, v11
  v_mul_f32 v69, v69, v11
  v_mul_f32 v70, v70, v11
  v_mul_f32 v71, v71, v11
  v_cvt_pk_bf16_f32 v84, v68, v69
  v_cvt_pk_bf16_f32 v85, v70, v71
  v_mul_f32 v76, v76, v11
  v_mul_f32 v77, v77, v11
  v_mul_f32 v78, v78, v11
  v_mul_f32 v79, v79, v11
  v_cvt_pk_bf16_f32 v86, v76, v77
  v_cvt_pk_bf16_f32 v87, v78, v79
  ds_write_b128 v240, v[84:87] offset:27648
  v_mfma_f32_16x16x16_bf16 v[64:67], v[152:153], v[44:45], 0
  v_mfma_f32_16x16x16_bf16 v[68:71], v[152:153], v[48:49], 0
  v_mfma_f32_16x16x16_bf16 v[64:67], v[120:121], v[46:47], v[64:67]
  v_mfma_f32_16x16x32_bf16 v[68:71], v[120:123], v[50:53], v[68:71]
  v_mfma_f32_16x16x16_bf16 v[72:75], v[154:155], v[44:45], 0
  v_mfma_f32_16x16x16_bf16 v[76:79], v[154:155], v[48:49], 0
  v_mfma_f32_16x16x16_bf16 v[72:75], v[124:125], v[46:47], v[72:75]
  v_mfma_f32_16x16x32_bf16 v[76:79], v[124:127], v[50:53], v[76:79]
  s_nop 2
  v_mul_f32 v64, v64, v10
  v_mul_f32 v65, v65, v10
  v_mul_f32 v66, v66, v10
  v_mul_f32 v67, v67, v10
  v_cvt_pk_bf16_f32 v80, v64, v65
  v_cvt_pk_bf16_f32 v81, v66, v67
  v_mul_f32 v72, v72, v10
  v_mul_f32 v73, v73, v10
  v_mul_f32 v74, v74, v10
  v_mul_f32 v75, v75, v10
  v_cvt_pk_bf16_f32 v82, v72, v73
  v_cvt_pk_bf16_f32 v83, v74, v75
  ds_write_b128 v240, v[80:83] offset:4096
  v_mul_f32 v68, v68, v11
  v_mul_f32 v69, v69, v11
  v_mul_f32 v70, v70, v11
  v_mul_f32 v71, v71, v11
  v_cvt_pk_bf16_f32 v84, v68, v69
  v_cvt_pk_bf16_f32 v85, v70, v71
  v_mul_f32 v76, v76, v11
  v_mul_f32 v77, v77, v11
  v_mul_f32 v78, v78, v11
  v_mul_f32 v79, v79, v11
  v_cvt_pk_bf16_f32 v86, v76, v77
  v_cvt_pk_bf16_f32 v87, v78, v79
  ds_write_b128 v240, v[84:87] offset:28672
  v_mfma_f32_16x16x16_bf16 v[64:67], v[156:157], v[44:45], 0
  v_mfma_f32_16x16x16_bf16 v[68:71], v[156:157], v[48:49], 0
  v_mfma_f32_16x16x16_bf16 v[64:67], v[128:129], v[46:47], v[64:67]
  v_mfma_f32_16x16x32_bf16 v[68:71], v[128:131], v[50:53], v[68:71]
  v_mfma_f32_16x16x16_bf16 v[72:75], v[158:159], v[44:45], 0
  v_mfma_f32_16x16x16_bf16 v[76:79], v[158:159], v[48:49], 0
  v_mfma_f32_16x16x16_bf16 v[72:75], v[132:133], v[46:47], v[72:75]
  v_mfma_f32_16x16x32_bf16 v[76:79], v[132:135], v[50:53], v[76:79]
  s_nop 2
  v_mul_f32 v64, v64, v10
  v_mul_f32 v65, v65, v10
  v_mul_f32 v66, v66, v10
  v_mul_f32 v67, v67, v10
  v_cvt_pk_bf16_f32 v80, v64, v65
  v_cvt_pk_bf16_f32 v81, v66, v67
  v_mul_f32 v72, v72, v10
  v_mul_f32 v73, v73, v10
  v_mul_f32 v74, v74, v10
  v_mul_f32 v75, v75, v10
  v_cvt_pk_bf16_f32 v82, v72, v73
  v_cvt_pk_bf16_f32 v83, v74, v75
  ds_write_b128 v240, v[80:83] offset:5120
  v_mul_f32 v68, v68, v11
  v_mul_f32 v69, v69, v11
  v_mul_f32 v70, v70, v11
  v_mul_f32 v71, v71, v11
  v_cvt_pk_bf16_f32 v84, v68, v69
  v_cvt_pk_bf16_f32 v85, v70, v71
  v_mul_f32 v76, v76, v11
  v_mul_f32 v77, v77, v11
  v_mul_f32 v78, v78, v11
  v_mul_f32 v79, v79, v11
  v_cvt_pk_bf16_f32 v86, v76, v77
  v_cvt_pk_bf16_f32 v87, v78, v79
  ds_write_b128 v240, v[84:87] offset:29696
  s_lshl_b32 s17, s14, 1
  s_add_u32 s17, s17, 1
  s_and_b32 s17, s17, 7
  s_lshl_b32 s16, s15, 3
  s_add_u32 s16, s16, s17
  s_mul_i32 s16, s16, 12288
  s_add_u32 s20, s16, 44040192
  s_add_u32 s21, s16, 37748736
  s_add_u32 s22, s16, 40894464
  s_lshl_b32 s17, s17, 5
  s_add_u32 s17, s17, s15
  s_mul_i32 s17, s17, 3072
  s_add_u32 s23, s17, 47185920
  s_add_u32 s24, s17, 47972352
  buffer_load_dwordx4 v[136:139], v1, s[4:7], s21 offen offset:0
  buffer_load_dwordx4 v[140:143], v1, s[4:7], s21 offen offset:1024
  buffer_load_dwordx4 v[144:147], v1, s[4:7], s21 offen offset:2048
  buffer_load_dwordx4 v[148:151], v1, s[4:7], s21 offen offset:3072
  buffer_load_dwordx4 v[152:155], v2, s[4:7], s21 offen offset:0
  buffer_load_dwordx4 v[156:159], v2, s[4:7], s21 offen offset:1024
  buffer_load_dwordx4 v[160:163], v2, s[4:7], s21 offen offset:2048
  buffer_load_dwordx4 v[164:167], v2, s[4:7], s21 offen offset:3072
  buffer_load_dwordx4 v[168:171], v3, s[4:7], s21 offen offset:0
  buffer_load_dwordx4 v[172:175], v3, s[4:7], s21 offen offset:1024
  buffer_load_dwordx4 v[176:179], v3, s[4:7], s21 offen offset:2048
  buffer_load_dwordx4 v[180:183], v3, s[4:7], s21 offen offset:3072
  buffer_load_dwordx4 v[184:187], v4, s[4:7], s23 offen offset:0
  buffer_load_dwordx4 v[188:191], v4, s[4:7], s23 offen offset:512
  buffer_load_dwordx4 v[192:195], v4, s[4:7], s23 offen offset:1024
  buffer_load_dwordx4 v[196:199], v4, s[4:7], s23 offen offset:1536
  buffer_load_dwordx4 v[200:203], v4, s[4:7], s23 offen offset:2048
  buffer_load_dwordx4 v[204:207], v4, s[4:7], s23 offen offset:2560
  buffer_load_dwordx4 v[88:91], v1, s[4:7], s20 offen offset:0
  buffer_load_dwordx4 v[92:95], v1, s[4:7], s20 offen offset:1024
  buffer_load_dwordx4 v[96:99], v1, s[4:7], s20 offen offset:2048
  buffer_load_dwordx4 v[100:103], v1, s[4:7], s20 offen offset:3072
  buffer_load_dwordx4 v[104:107], v2, s[4:7], s20 offen offset:0
  buffer_load_dwordx4 v[108:111], v2, s[4:7], s20 offen offset:1024
  buffer_load_dwordx4 v[112:115], v2, s[4:7], s20 offen offset:2048
  buffer_load_dwordx4 v[116:119], v2, s[4:7], s20 offen offset:3072
  buffer_load_dwordx4 v[120:123], v3, s[4:7], s20 offen offset:0
  buffer_load_dwordx4 v[124:127], v3, s[4:7], s20 offen offset:1024
  buffer_load_dwordx4 v[128:131], v3, s[4:7], s20 offen offset:2048
  buffer_load_dwordx4 v[132:135], v3, s[4:7], s20 offen offset:3072
  s_waitcnt vmcnt(5)
  v_mfma_f32_16x16x32_bf16 v[24:27], v[184:187], v[88:91], v[12:15]
  v_mfma_f32_16x16x32_bf16 v[28:31], v[136:139], v[88:91], v[16:19]
  v_mfma_f32_16x16x32_bf16 v[32:35], v[184:187], v[112:115], v[12:15]
  v_mfma_f32_16x16x32_bf16 v[36:39], v[136:139], v[112:115], 0
  v_mfma_f32_16x16x32_bf16 v[40:43], v[160:163], v[112:115], v[16:19]
  s_waitcnt vmcnt(4)
  v_mfma_f32_16x16x32_bf16 v[24:27], v[188:191], v[92:95], v[24:27]
  v_mfma_f32_16x16x32_bf16 v[28:31], v[140:143], v[92:95], v[28:31]
  v_mfma_f32_16x16x32_bf16 v[32:35], v[188:191], v[116:119], v[32:35]
  v_mfma_f32_16x16x32_bf16 v[36:39], v[140:143], v[116:119], v[36:39]
  v_mfma_f32_16x16x32_bf16 v[40:43], v[164:167], v[116:119], v[40:43]
  s_waitcnt vmcnt(3)
  v_mfma_f32_16x16x32_bf16 v[24:27], v[192:195], v[96:99], v[24:27]
  v_mfma_f32_16x16x32_bf16 v[28:31], v[144:147], v[96:99], v[28:31]
  v_mfma_f32_16x16x32_bf16 v[32:35], v[192:195], v[120:123], v[32:35]
  v_mfma_f32_16x16x32_bf16 v[36:39], v[144:147], v[120:123], v[36:39]
  v_mfma_f32_16x16x32_bf16 v[40:43], v[168:171], v[120:123], v[40:43]
  s_waitcnt vmcnt(2)
  v_mfma_f32_16x16x32_bf16 v[24:27], v[196:199], v[100:103], v[24:27]
  v_mfma_f32_16x16x32_bf16 v[28:31], v[148:151], v[100:103], v[28:31]
  v_mfma_f32_16x16x32_bf16 v[32:35], v[196:199], v[124:127], v[32:35]
  v_mfma_f32_16x16x32_bf16 v[36:39], v[148:151], v[124:127], v[36:39]
  v_mfma_f32_16x16x32_bf16 v[40:43], v[172:175], v[124:127], v[40:43]
  s_waitcnt vmcnt(1)
  v_mfma_f32_16x16x32_bf16 v[24:27], v[200:203], v[104:107], v[24:27]
  v_mfma_f32_16x16x32_bf16 v[28:31], v[152:155], v[104:107], v[28:31]
  v_mfma_f32_16x16x32_bf16 v[32:35], v[200:203], v[128:131], v[32:35]
  v_mfma_f32_16x16x32_bf16 v[36:39], v[152:155], v[128:131], v[36:39]
  v_mfma_f32_16x16x32_bf16 v[40:43], v[176:179], v[128:131], v[40:43]
  s_waitcnt vmcnt(0)
  v_mfma_f32_16x16x32_bf16 v[24:27], v[204:207], v[108:111], v[24:27]
  v_mfma_f32_16x16x32_bf16 v[28:31], v[156:159], v[108:111], v[28:31]
  v_mfma_f32_16x16x32_bf16 v[32:35], v[204:207], v[132:135], v[32:35]
  v_mfma_f32_16x16x32_bf16 v[36:39], v[156:159], v[132:135], v[36:39]
  v_mfma_f32_16x16x32_bf16 v[40:43], v[180:183], v[132:135], v[40:43]
  buffer_load_dwordx4 v[88:91], v1, s[4:7], s22 offen offset:0
  buffer_load_dwordx4 v[92:95], v1, s[4:7], s22 offen offset:1024
  buffer_load_dwordx4 v[96:99], v1, s[4:7], s22 offen offset:2048
  buffer_load_dwordx4 v[100:103], v1, s[4:7], s22 offen offset:3072
  buffer_load_dwordx4 v[104:107], v2, s[4:7], s22 offen offset:0
  buffer_load_dwordx4 v[108:111], v2, s[4:7], s22 offen offset:1024
  buffer_load_dwordx4 v[112:115], v2, s[4:7], s22 offen offset:2048
  buffer_load_dwordx4 v[116:119], v2, s[4:7], s22 offen offset:3072
  buffer_load_dwordx4 v[120:123], v3, s[4:7], s22 offen offset:0
  buffer_load_dwordx4 v[124:127], v3, s[4:7], s22 offen offset:1024
  buffer_load_dwordx4 v[128:131], v3, s[4:7], s22 offen offset:2048
  buffer_load_dwordx4 v[132:135], v3, s[4:7], s22 offen offset:3072
  buffer_load_dwordx2 v[136:137], v5, s[4:7], s24 offen offset:0
  buffer_load_dwordx2 v[138:139], v5, s[4:7], s24 offen offset:256
  buffer_load_dwordx2 v[140:141], v5, s[4:7], s24 offen offset:512
  buffer_load_dwordx2 v[142:143], v5, s[4:7], s24 offen offset:768
  buffer_load_dwordx2 v[144:145], v5, s[4:7], s24 offen offset:1024
  buffer_load_dwordx2 v[146:147], v5, s[4:7], s24 offen offset:1280
  buffer_load_dwordx2 v[148:149], v5, s[4:7], s24 offen offset:1536
  buffer_load_dwordx2 v[150:151], v5, s[4:7], s24 offen offset:1792
  buffer_load_dwordx2 v[152:153], v5, s[4:7], s24 offen offset:2048
  buffer_load_dwordx2 v[154:155], v5, s[4:7], s24 offen offset:2304
  buffer_load_dwordx2 v[156:157], v5, s[4:7], s24 offen offset:2560
  buffer_load_dwordx2 v[158:159], v5, s[4:7], s24 offen offset:2816
  v_max3_f32 v6, v24, v25, v26
  v_max3_f32 v6, v6, v27, v28
  v_max3_f32 v6, v6, v29, v30
  v_max_f32 v6, v6, v31
  v_mov_b32 v7, v6
  s_nop 1
  v_permlane32_swap_b32 v6, v7
  v_max_f32 v6, v6, v7
  v_mov_b32 v7, v6
  s_nop 1
  v_permlane16_swap_b32 v6, v7
  v_max_f32 v6, v6, v7
  v_mul_f32 v6, s27, v6
  v_fma_f32 v24, v24, s27, -v6
  v_fma_f32 v25, v25, s27, -v6
  v_fma_f32 v26, v26, s27, -v6
  v_fma_f32 v27, v27, s27, -v6
  v_fma_f32 v28, v28, s27, -v6
  v_fma_f32 v29, v29, s27, -v6
  v_fma_f32 v30, v30, s27, -v6
  v_fma_f32 v31, v31, s27, -v6
  v_exp_f32 v24, v24
  v_exp_f32 v25, v25
  v_exp_f32 v26, v26
  v_exp_f32 v27, v27
  v_exp_f32 v28, v28
  v_exp_f32 v29, v29
  v_exp_f32 v30, v30
  v_exp_f32 v31, v31
  v_max3_f32 v8, v32, v33, v34
  v_max3_f32 v8, v8, v35, v36
  v_max3_f32 v8, v8, v37, v38
  v_max3_f32 v8, v8, v39, v40
  v_max3_f32 v8, v8, v41, v42
  v_max_f32 v8, v8, v43
  v_mov_b32 v10, v8
  s_nop 1
  v_permlane32_swap_b32 v8, v10
  v_max_f32 v8, v8, v10
  v_mov_b32 v10, v8
  s_nop 1
  v_permlane16_swap_b32 v8, v10
  v_max_f32 v8, v8, v10
  v_mul_f32 v8, s27, v8
  v_fma_f32 v32, v32, s27, -v8
  v_fma_f32 v33, v33, s27, -v8
  v_fma_f32 v34, v34, s27, -v8
  v_fma_f32 v35, v35, s27, -v8
  v_fma_f32 v36, v36, s27, -v8
  v_fma_f32 v37, v37, s27, -v8
  v_fma_f32 v38, v38, s27, -v8
  v_fma_f32 v39, v39, s27, -v8
  v_fma_f32 v40, v40, s27, -v8
  v_fma_f32 v41, v41, s27, -v8
  v_fma_f32 v42, v42, s27, -v8
  v_fma_f32 v43, v43, s27, -v8
  v_exp_f32 v32, v32
  v_exp_f32 v33, v33
  v_exp_f32 v34, v34
  v_exp_f32 v35, v35
  v_exp_f32 v36, v36
  v_exp_f32 v37, v37
  v_exp_f32 v38, v38
  v_exp_f32 v39, v39
  v_exp_f32 v40, v40
  v_exp_f32 v41, v41
  v_exp_f32 v42, v42
  v_exp_f32 v43, v43
  v_cvt_pk_bf16_f32 v44, v24, v25
  v_cvt_pk_bf16_f32 v45, v26, v27
  v_cvt_pk_bf16_f32 v46, v28, v29
  v_cvt_pk_bf16_f32 v47, v30, v31
  v_cvt_pk_bf16_f32 v48, v32, v33
  v_cvt_pk_bf16_f32 v49, v34, v35
  v_cvt_pk_bf16_f32 v50, v36, v37
  v_cvt_pk_bf16_f32 v51, v38, v39
  v_cvt_pk_bf16_f32 v52, v40, v41
  v_cvt_pk_bf16_f32 v53, v42, v43
  v_mfma_f32_16x16x16_bf16 v[56:59], v[20:21], v[44:45], 0
  v_mfma_f32_16x16x16_bf16 v[60:63], v[20:21], v[48:49], 0
  v_mfma_f32_16x16x16_bf16 v[56:59], v[20:21], v[46:47], v[56:59]
  v_mfma_f32_16x16x32_bf16 v[60:63], v[20:23], v[50:53], v[60:63]
  s_nop 6
  v_rcp_f32 v10, v56
  v_rcp_f32 v11, v60
  s_waitcnt vmcnt(0)
  buffer_load_dwordx4 a[160:163], v1, s[4:7], s30 offen offset:0
  buffer_load_dwordx4 a[164:167], v1, s[4:7], s31 offen offset:0
  buffer_load_dwordx4 a[168:171], v1, s[4:7], s32 offen offset:0
  buffer_load_dwordx4 a[172:175], v1, s[4:7], s33 offen offset:0
  buffer_load_dwordx4 a[176:179], v1, s[4:7], s34 offen offset:0
  buffer_load_dwordx4 a[180:183], v1, s[4:7], s35 offen offset:0
  buffer_load_dwordx4 a[184:187], v1, s[4:7], s36 offen offset:0
  buffer_load_dwordx4 a[188:191], v1, s[4:7], s37 offen offset:0
  buffer_load_dwordx4 a[192:195], v1, s[4:7], s38 offen offset:0
  buffer_load_dwordx4 a[196:199], v1, s[4:7], s39 offen offset:0
  buffer_load_dwordx4 a[200:203], v1, s[4:7], s30 offen offset:1024
  buffer_load_dwordx4 a[204:207], v1, s[4:7], s31 offen offset:1024
  buffer_load_dwordx4 a[208:211], v1, s[4:7], s32 offen offset:1024
  buffer_load_dwordx4 a[212:215], v1, s[4:7], s33 offen offset:1024
  buffer_load_dwordx4 a[216:219], v1, s[4:7], s34 offen offset:1024
  buffer_load_dwordx4 a[220:223], v1, s[4:7], s35 offen offset:1024
  buffer_load_dwordx4 a[224:227], v1, s[4:7], s36 offen offset:1024
  buffer_load_dwordx4 a[228:231], v1, s[4:7], s37 offen offset:1024
  buffer_load_dwordx4 a[232:235], v1, s[4:7], s38 offen offset:1024
  buffer_load_dwordx4 a[236:239], v1, s[4:7], s39 offen offset:1024
  v_mfma_f32_16x16x16_bf16 v[64:67], v[136:137], v[44:45], 0
  v_mfma_f32_16x16x16_bf16 v[68:71], v[136:137], v[48:49], 0
  v_mfma_f32_16x16x16_bf16 v[64:67], v[88:89], v[46:47], v[64:67]
  v_mfma_f32_16x16x32_bf16 v[68:71], v[88:91], v[50:53], v[68:71]
  v_mfma_f32_16x16x16_bf16 v[72:75], v[138:139], v[44:45], 0
  v_mfma_f32_16x16x16_bf16 v[76:79], v[138:139], v[48:49], 0
  v_mfma_f32_16x16x16_bf16 v[72:75], v[92:93], v[46:47], v[72:75]
  v_mfma_f32_16x16x32_bf16 v[76:79], v[92:95], v[50:53], v[76:79]
  s_nop 2
  v_mul_f32 v64, v64, v10
  v_mul_f32 v65, v65, v10
  v_mul_f32 v66, v66, v10
  v_mul_f32 v67, v67, v10
  v_cvt_pk_bf16_f32 v80, v64, v65
  v_cvt_pk_bf16_f32 v81, v66, v67
  v_mul_f32 v72, v72, v10
  v_mul_f32 v73, v73, v10
  v_mul_f32 v74, v74, v10
  v_mul_f32 v75, v75, v10
  v_cvt_pk_bf16_f32 v82, v72, v73
  v_cvt_pk_bf16_f32 v83, v74, v75
  ds_write_b128 v241, v[80:83] offset:0
  v_mul_f32 v68, v68, v11
  v_mul_f32 v69, v69, v11
  v_mul_f32 v70, v70, v11
  v_mul_f32 v71, v71, v11
  v_cvt_pk_bf16_f32 v84, v68, v69
  v_cvt_pk_bf16_f32 v85, v70, v71
  v_mul_f32 v76, v76, v11
  v_mul_f32 v77, v77, v11
  v_mul_f32 v78, v78, v11
  v_mul_f32 v79, v79, v11
  v_cvt_pk_bf16_f32 v86, v76, v77
  v_cvt_pk_bf16_f32 v87, v78, v79
  ds_write_b128 v241, v[84:87] offset:24576
  v_mfma_f32_16x16x16_bf16 v[64:67], v[140:141], v[44:45], 0
  v_mfma_f32_16x16x16_bf16 v[68:71], v[140:141], v[48:49], 0
  v_mfma_f32_16x16x16_bf16 v[64:67], v[96:97], v[46:47], v[64:67]
  v_mfma_f32_16x16x32_bf16 v[68:71], v[96:99], v[50:53], v[68:71]
  v_mfma_f32_16x16x16_bf16 v[72:75], v[142:143], v[44:45], 0
  v_mfma_f32_16x16x16_bf16 v[76:79], v[142:143], v[48:49], 0
  v_mfma_f32_16x16x16_bf16 v[72:75], v[100:101], v[46:47], v[72:75]
  v_mfma_f32_16x16x32_bf16 v[76:79], v[100:103], v[50:53], v[76:79]
  s_nop 2
  v_mul_f32 v64, v64, v10
  v_mul_f32 v65, v65, v10
  v_mul_f32 v66, v66, v10
  v_mul_f32 v67, v67, v10
  v_cvt_pk_bf16_f32 v80, v64, v65
  v_cvt_pk_bf16_f32 v81, v66, v67
  v_mul_f32 v72, v72, v10
  v_mul_f32 v73, v73, v10
  v_mul_f32 v74, v74, v10
  v_mul_f32 v75, v75, v10
  v_cvt_pk_bf16_f32 v82, v72, v73
  v_cvt_pk_bf16_f32 v83, v74, v75
  ds_write_b128 v241, v[80:83] offset:1024
  v_mul_f32 v68, v68, v11
  v_mul_f32 v69, v69, v11
  v_mul_f32 v70, v70, v11
  v_mul_f32 v71, v71, v11
  v_cvt_pk_bf16_f32 v84, v68, v69
  v_cvt_pk_bf16_f32 v85, v70, v71
  v_mul_f32 v76, v76, v11
  v_mul_f32 v77, v77, v11
  v_mul_f32 v78, v78, v11
  v_mul_f32 v79, v79, v11
  v_cvt_pk_bf16_f32 v86, v76, v77
  v_cvt_pk_bf16_f32 v87, v78, v79
  ds_write_b128 v241, v[84:87] offset:25600
  v_mfma_f32_16x16x16_bf16 v[64:67], v[144:145], v[44:45], 0
  v_mfma_f32_16x16x16_bf16 v[68:71], v[144:145], v[48:49], 0
  v_mfma_f32_16x16x16_bf16 v[64:67], v[104:105], v[46:47], v[64:67]
  v_mfma_f32_16x16x32_bf16 v[68:71], v[104:107], v[50:53], v[68:71]
  v_mfma_f32_16x16x16_bf16 v[72:75], v[146:147], v[44:45], 0
  v_mfma_f32_16x16x16_bf16 v[76:79], v[146:147], v[48:49], 0
  v_mfma_f32_16x16x16_bf16 v[72:75], v[108:109], v[46:47], v[72:75]
  v_mfma_f32_16x16x32_bf16 v[76:79], v[108:111], v[50:53], v[76:79]
  s_nop 2
  v_mul_f32 v64, v64, v10
  v_mul_f32 v65, v65, v10
  v_mul_f32 v66, v66, v10
  v_mul_f32 v67, v67, v10
  v_cvt_pk_bf16_f32 v80, v64, v65
  v_cvt_pk_bf16_f32 v81, v66, v67
  v_mul_f32 v72, v72, v10
  v_mul_f32 v73, v73, v10
  v_mul_f32 v74, v74, v10
  v_mul_f32 v75, v75, v10
  v_cvt_pk_bf16_f32 v82, v72, v73
  v_cvt_pk_bf16_f32 v83, v74, v75
  ds_write_b128 v241, v[80:83] offset:2048
  v_mul_f32 v68, v68, v11
  v_mul_f32 v69, v69, v11
  v_mul_f32 v70, v70, v11
  v_mul_f32 v71, v71, v11
  v_cvt_pk_bf16_f32 v84, v68, v69
  v_cvt_pk_bf16_f32 v85, v70, v71
  v_mul_f32 v76, v76, v11
  v_mul_f32 v77, v77, v11
  v_mul_f32 v78, v78, v11
  v_mul_f32 v79, v79, v11
  v_cvt_pk_bf16_f32 v86, v76, v77
  v_cvt_pk_bf16_f32 v87, v78, v79
  ds_write_b128 v241, v[84:87] offset:26624
  v_mfma_f32_16x16x16_bf16 v[64:67], v[148:149], v[44:45], 0
  v_mfma_f32_16x16x16_bf16 v[68:71], v[148:149], v[48:49], 0
  v_mfma_f32_16x16x16_bf16 v[64:67], v[112:113], v[46:47], v[64:67]
  v_mfma_f32_16x16x32_bf16 v[68:71], v[112:115], v[50:53], v[68:71]
  v_mfma_f32_16x16x16_bf16 v[72:75], v[150:151], v[44:45], 0
  v_mfma_f32_16x16x16_bf16 v[76:79], v[150:151], v[48:49], 0
  v_mfma_f32_16x16x16_bf16 v[72:75], v[116:117], v[46:47], v[72:75]
  v_mfma_f32_16x16x32_bf16 v[76:79], v[116:119], v[50:53], v[76:79]
  s_nop 2
  v_mul_f32 v64, v64, v10
  v_mul_f32 v65, v65, v10
  v_mul_f32 v66, v66, v10
  v_mul_f32 v67, v67, v10
  v_cvt_pk_bf16_f32 v80, v64, v65
  v_cvt_pk_bf16_f32 v81, v66, v67
  v_mul_f32 v72, v72, v10
  v_mul_f32 v73, v73, v10
  v_mul_f32 v74, v74, v10
  v_mul_f32 v75, v75, v10
  v_cvt_pk_bf16_f32 v82, v72, v73
  v_cvt_pk_bf16_f32 v83, v74, v75
  ds_write_b128 v241, v[80:83] offset:3072
  v_mul_f32 v68, v68, v11
  v_mul_f32 v69, v69, v11
  v_mul_f32 v70, v70, v11
  v_mul_f32 v71, v71, v11
  v_cvt_pk_bf16_f32 v84, v68, v69
  v_cvt_pk_bf16_f32 v85, v70, v71
  v_mul_f32 v76, v76, v11
  v_mul_f32 v77, v77, v11
  v_mul_f32 v78, v78, v11
  v_mul_f32 v79, v79, v11
  v_cvt_pk_bf16_f32 v86, v76, v77
  v_cvt_pk_bf16_f32 v87, v78, v79
  ds_write_b128 v241, v[84:87] offset:27648
  v_mfma_f32_16x16x16_bf16 v[64:67], v[152:153], v[44:45], 0
  v_mfma_f32_16x16x16_bf16 v[68:71], v[152:153], v[48:49], 0
  v_mfma_f32_16x16x16_bf16 v[64:67], v[120:121], v[46:47], v[64:67]
  v_mfma_f32_16x16x32_bf16 v[68:71], v[120:123], v[50:53], v[68:71]
  v_mfma_f32_16x16x16_bf16 v[72:75], v[154:155], v[44:45], 0
  v_mfma_f32_16x16x16_bf16 v[76:79], v[154:155], v[48:49], 0
  v_mfma_f32_16x16x16_bf16 v[72:75], v[124:125], v[46:47], v[72:75]
  v_mfma_f32_16x16x32_bf16 v[76:79], v[124:127], v[50:53], v[76:79]
  s_nop 2
  v_mul_f32 v64, v64, v10
  v_mul_f32 v65, v65, v10
  v_mul_f32 v66, v66, v10
  v_mul_f32 v67, v67, v10
  v_cvt_pk_bf16_f32 v80, v64, v65
  v_cvt_pk_bf16_f32 v81, v66, v67
  v_mul_f32 v72, v72, v10
  v_mul_f32 v73, v73, v10
  v_mul_f32 v74, v74, v10
  v_mul_f32 v75, v75, v10
  v_cvt_pk_bf16_f32 v82, v72, v73
  v_cvt_pk_bf16_f32 v83, v74, v75
  ds_write_b128 v241, v[80:83] offset:4096
  v_mul_f32 v68, v68, v11
  v_mul_f32 v69, v69, v11
  v_mul_f32 v70, v70, v11
  v_mul_f32 v71, v71, v11
  v_cvt_pk_bf16_f32 v84, v68, v69
  v_cvt_pk_bf16_f32 v85, v70, v71
  v_mul_f32 v76, v76, v11
  v_mul_f32 v77, v77, v11
  v_mul_f32 v78, v78, v11
  v_mul_f32 v79, v79, v11
  v_cvt_pk_bf16_f32 v86, v76, v77
  v_cvt_pk_bf16_f32 v87, v78, v79
  ds_write_b128 v241, v[84:87] offset:28672
  v_mfma_f32_16x16x16_bf16 v[64:67], v[156:157], v[44:45], 0
  v_mfma_f32_16x16x16_bf16 v[68:71], v[156:157], v[48:49], 0
  v_mfma_f32_16x16x16_bf16 v[64:67], v[128:129], v[46:47], v[64:67]
  v_mfma_f32_16x16x32_bf16 v[68:71], v[128:131], v[50:53], v[68:71]
  v_mfma_f32_16x16x16_bf16 v[72:75], v[158:159], v[44:45], 0
  v_mfma_f32_16x16x16_bf16 v[76:79], v[158:159], v[48:49], 0
  v_mfma_f32_16x16x16_bf16 v[72:75], v[132:133], v[46:47], v[72:75]
  v_mfma_f32_16x16x32_bf16 v[76:79], v[132:135], v[50:53], v[76:79]
  s_nop 2
  v_mul_f32 v64, v64, v10
  v_mul_f32 v65, v65, v10
  v_mul_f32 v66, v66, v10
  v_mul_f32 v67, v67, v10
  v_cvt_pk_bf16_f32 v80, v64, v65
  v_cvt_pk_bf16_f32 v81, v66, v67
  v_mul_f32 v72, v72, v10
  v_mul_f32 v73, v73, v10
  v_mul_f32 v74, v74, v10
  v_mul_f32 v75, v75, v10
  v_cvt_pk_bf16_f32 v82, v72, v73
  v_cvt_pk_bf16_f32 v83, v74, v75
  ds_write_b128 v241, v[80:83] offset:5120
  v_mul_f32 v68, v68, v11
  v_mul_f32 v69, v69, v11
  v_mul_f32 v70, v70, v11
  v_mul_f32 v71, v71, v11
  v_cvt_pk_bf16_f32 v84, v68, v69
  v_cvt_pk_bf16_f32 v85, v70, v71
  v_mul_f32 v76, v76, v11
  v_mul_f32 v77, v77, v11
  v_mul_f32 v78, v78, v11
  v_mul_f32 v79, v79, v11
  v_cvt_pk_bf16_f32 v86, v76, v77
  v_cvt_pk_bf16_f32 v87, v78, v79
  ds_write_b128 v241, v[84:87] offset:29696
  s_branch fin_phase22
fin_odma3:
  s_lshl_b32 s16, s14, 2
  s_add_u32 s16, s16, s12
  s_mul_i32 s16, s16, 192
  s_mul_i32 s17, s13, 24
  s_add_u32 s16, s16, s17
  s_lshl_b32 s16, s16, 10
  s_add_u32 s16, s16, 57147392
  s_mul_i32 s17, s12, 24576
  s_add_u32 m0, s17, 0
  s_nop 0
  buffer_load_dwordx4 v1, s[4:7], s16 offen offset:0 lds
  buffer_load_dwordx4 v1, s[4:7], s16 offen offset:1024 lds
  buffer_load_dwordx4 v1, s[4:7], s16 offen offset:2048 lds
  buffer_load_dwordx4 v1, s[4:7], s16 offen offset:3072 lds
  s_add_u32 s16, s16, 4096
  s_add_u32 m0, s17, 4096
  s_nop 0
  buffer_load_dwordx4 v1, s[4:7], s16 offen offset:0 lds
  buffer_load_dwordx4 v1, s[4:7], s16 offen offset:1024 lds
  buffer_load_dwordx4 v1, s[4:7], s16 offen offset:2048 lds
  buffer_load_dwordx4 v1, s[4:7], s16 offen offset:3072 lds
  s_add_u32 s16, s16, 4096
  s_add_u32 m0, s17, 8192
  s_nop 0
  buffer_load_dwordx4 v1, s[4:7], s16 offen offset:0 lds
  buffer_load_dwordx4 v1, s[4:7], s16 offen offset:1024 lds
  buffer_load_dwordx4 v1, s[4:7], s16 offen offset:2048 lds
  buffer_load_dwordx4 v1, s[4:7], s16 offen offset:3072 lds
  s_add_u32 s16, s16, 4096
  s_add_u32 m0, s17, 12288
  s_nop 0
  buffer_load_dwordx4 v1, s[4:7], s16 offen offset:0 lds
  buffer_load_dwordx4 v1, s[4:7], s16 offen offset:1024 lds
  buffer_load_dwordx4 v1, s[4:7], s16 offen offset:2048 lds
  buffer_load_dwordx4 v1, s[4:7], s16 offen offset:3072 lds
  s_add_u32 s16, s16, 4096
  s_add_u32 m0, s17, 16384
  s_nop 0
  buffer_load_dwordx4 v1, s[4:7], s16 offen offset:0 lds
  buffer_load_dwordx4 v1, s[4:7], s16 offen offset:1024 lds
  buffer_load_dwordx4 v1, s[4:7], s16 offen offset:2048 lds
  buffer_load_dwordx4 v1, s[4:7], s16 offen offset:3072 lds
  s_add_u32 s16, s16, 4096
  s_add_u32 m0, s17, 20480
  s_nop 0
  buffer_load_dwordx4 v1, s[4:7], s16 offen offset:0 lds
  buffer_load_dwordx4 v1, s[4:7], s16 offen offset:1024 lds
  buffer_load_dwordx4 v1, s[4:7], s16 offen offset:2048 lds
  buffer_load_dwordx4 v1, s[4:7], s16 offen offset:3072 lds
  s_add_u32 s16, s16, 4096
  buffer_load_dwordx4 a[160:163], v1, s[4:7], s30 offen offset:0
  buffer_load_dwordx4 a[164:167], v1, s[4:7], s31 offen offset:0
  buffer_load_dwordx4 a[168:171], v1, s[4:7], s32 offen offset:0
  buffer_load_dwordx4 a[172:175], v1, s[4:7], s33 offen offset:0
  buffer_load_dwordx4 a[176:179], v1, s[4:7], s34 offen offset:0
  buffer_load_dwordx4 a[180:183], v1, s[4:7], s35 offen offset:0
  buffer_load_dwordx4 a[184:187], v1, s[4:7], s36 offen offset:0
  buffer_load_dwordx4 a[188:191], v1, s[4:7], s37 offen offset:0
  buffer_load_dwordx4 a[192:195], v1, s[4:7], s38 offen offset:0
  buffer_load_dwordx4 a[196:199], v1, s[4:7], s39 offen offset:0
  buffer_load_dwordx4 a[200:203], v1, s[4:7], s30 offen offset:1024
  buffer_load_dwordx4 a[204:207], v1, s[4:7], s31 offen offset:1024
  buffer_load_dwordx4 a[208:211], v1, s[4:7], s32 offen offset:1024
  buffer_load_dwordx4 a[212:215], v1, s[4:7], s33 offen offset:1024
  buffer_load_dwordx4 a[216:219], v1, s[4:7], s34 offen offset:1024
  buffer_load_dwordx4 a[220:223], v1, s[4:7], s35 offen offset:1024
  buffer_load_dwordx4 a[224:227], v1, s[4:7], s36 offen offset:1024
  buffer_load_dwordx4 a[228:231], v1, s[4:7], s37 offen offset:1024
  buffer_load_dwordx4 a[232:235], v1, s[4:7], s38 offen offset:1024
  buffer_load_dwordx4 a[236:239], v1, s[4:7], s39 offen offset:1024
  s_waitcnt vmcnt(20)
fin_phase22:
  s_waitcnt lgkmcnt(0)
  buffer_load_dwordx4 v[104:107], v1, s[4:7], s30 offen offset:2048
  buffer_load_dwordx4 v[108:111], v1, s[4:7], s31 offen offset:2048
  buffer_load_dwordx4 v[112:115], v1, s[4:7], s32 offen offset:2048
  buffer_load_dwordx4 v[116:119], v1, s[4:7], s33 offen offset:2048
  buffer_load_dwordx4 v[120:123], v1, s[4:7], s34 offen offset:2048
  buffer_load_dwordx4 v[124:127], v1, s[4:7], s35 offen offset:2048
  buffer_load_dwordx4 v[128:131], v1, s[4:7], s36 offen offset:2048
  buffer_load_dwordx4 v[132:135], v1, s[4:7], s37 offen offset:2048
  buffer_load_dwordx4 v[136:139], v1, s[4:7], s38 offen offset:2048
  buffer_load_dwordx4 v[140:143], v1, s[4:7], s39 offen offset:2048
  buffer_load_dwordx4 v[144:147], v1, s[4:7], s30 offen offset:3072
  buffer_load_dwordx4 v[148:151], v1, s[4:7], s31 offen offset:3072
  buffer_load_dwordx4 v[152:155], v1, s[4:7], s32 offen offset:3072
  buffer_load_dwordx4 v[156:159], v1, s[4:7], s33 offen offset:3072
  buffer_load_dwordx4 v[160:163], v1, s[4:7], s34 offen offset:3072
  buffer_load_dwordx4 v[164:167], v1, s[4:7], s35 offen offset:3072
  buffer_load_dwordx4 v[168:171], v1, s[4:7], s36 offen offset:3072
  buffer_load_dwordx4 v[172:175], v1, s[4:7], s37 offen offset:3072
  buffer_load_dwordx4 v[176:179], v1, s[4:7], s38 offen offset:3072
  buffer_load_dwordx4 v[180:183], v1, s[4:7], s39 offen offset:3072
  s_add_u32 s30, s30, 4096
  s_add_u32 s31, s31, 4096
  s_add_u32 s32, s32, 4096
  s_add_u32 s33, s33, 4096
  s_add_u32 s34, s34, 4096
  s_add_u32 s35, s35, 4096
  s_add_u32 s36, s36, 4096
  s_add_u32 s37, s37, 4096
  s_add_u32 s38, s38, 4096
  s_add_u32 s39, s39, 4096
  v_add_u32 v6, 49152, v1
  s_barrier
  ds_read_b128 v[184:187], v1 offset:0
  ds_read_b128 v[188:191], v1 offset:24576
  ds_read_b128 v[192:195], v6 offset:0
  ds_read_b128 v[196:199], v6 offset:24576
  s_waitcnt vmcnt(30)
  ds_read_b128 v[200:203], v1 offset:1024
  ds_read_b128 v[204:207], v1 offset:25600
  ds_read_b128 v[208:211], v6 offset:1024
  ds_read_b128 v[212:215], v6 offset:25600
  s_waitcnt lgkmcnt(4)
  v_mfma_f32_16x16x32_bf16 a[0:3], a[160:163], v[184:187], 0
  v_mfma_f32_16x16x32_bf16 a[4:7], a[160:163], v[188:191], 0
  v_mfma_f32_16x16x32_bf16 a[8:11], a[160:163], v[192:195], 0
  v_mfma_f32_16x16x32_bf16 a[12:15], a[160:163], v[196:199], 0
  v_mfma_f32_16x16x32_bf16 a[16:19], a[164:167], v[184:187], 0
  v_mfma_f32_16x16x32_bf16 a[20:23], a[164:167], v[188:191], 0
  v_mfma_f32_16x16x32_bf16 a[24:27], a[164:167], v[192:195], 0
  v_mfma_f32_16x16x32_bf16 a[28:31], a[164:167], v[196:199], 0
  v_mfma_f32_16x16x32_bf16 a[32:35], a[168:171], v[184:187], 0
  v_mfma_f32_16x16x32_bf16 a[36:39], a[168:171], v[188:191], 0
  v_mfma_f32_16x16x32_bf16 a[40:43], a[168:171], v[192:195], 0
  v_mfma_f32_16x16x32_bf16 a[44:47], a[168:171], v[196:199], 0
  v_mfma_f32_16x16x32_bf16 a[48:51], a[172:175], v[184:187], 0
  v_mfma_f32_16x16x32_bf16 a[52:55], a[172:175], v[188:191], 0
  v_mfma_f32_16x16x32_bf16 a[56:59], a[172:175], v[192:195], 0
  v_mfma_f32_16x16x32_bf16 a[60:63], a[172:175], v[196:199], 0
  v_mfma_f32_16x16x32_bf16 a[64:67], a[176:179], v[184:187], 0
  v_mfma_f32_16x16x32_bf16 a[68:71], a[176:179], v[188:191], 0
  v_mfma_f32_16x16x32_bf16 a[72:75], a[176:179], v[192:195], 0
  v_mfma_f32_16x16x32_bf16 a[76:79], a[176:179], v[196:199], 0
  v_mfma_f32_16x16x32_bf16 a[80:83], a[180:183], v[184:187], 0
  v_mfma_f32_16x16x32_bf16 a[84:87], a[180:183], v[188:191], 0
  v_mfma_f32_16x16x32_bf16 a[88:91], a[180:183], v[192:195], 0
  v_mfma_f32_16x16x32_bf16 a[92:95], a[180:183], v[196:199], 0
  v_mfma_f32_16x16x32_bf16 a[96:99], a[184:187], v[184:187], 0
  v_mfma_f32_16x16x32_bf16 a[100:103], a[184:187], v[188:191], 0
  v_mfma_f32_16x16x32_bf16 a[104:107], a[184:187], v[192:195], 0
  v_mfma_f32_16x16x32_bf16 a[108:111], a[184:187], v[196:199], 0
  v_mfma_f32_16x16x32_bf16 a[112:115], a[188:191], v[184:187], 0
  v_mfma_f32_16x16x32_bf16 a[116:119], a[188:191], v[188:191], 0
  v_mfma_f32_16x16x32_bf16 a[120:123], a[188:191], v[192:195], 0
  v_mfma_f32_16x16x32_bf16 a[124:127], a[188:191], v[196:199], 0
  v_mfma_f32_16x16x32_bf16 a[128:131], a[192:195], v[184:187], 0
  v_mfma_f32_16x16x32_bf16 a[132:135], a[192:195], v[188:191], 0
  v_mfma_f32_16x16x32_bf16 a[136:139], a[192:195], v[192:195], 0
  v_mfma_f32_16x16x32_bf16 a[140:143], a[192:195], v[196:199], 0
  v_mfma_f32_16x16x32_bf16 a[144:147], a[196:199], v[184:187], 0
  v_mfma_f32_16x16x32_bf16 a[148:151], a[196:199], v[188:191], 0
  v_mfma_f32_16x16x32_bf16 a[152:155], a[196:199], v[192:195], 0
  v_mfma_f32_16x16x32_bf16 a[156:159], a[196:199], v[196:199], 0
  buffer_load_dwordx4 v[24:27], v1, s[4:7], s30 offen offset:0
  buffer_load_dwordx4 v[28:31], v1, s[4:7], s31 offen offset:0
  buffer_load_dwordx4 v[32:35], v1, s[4:7], s32 offen offset:0
  buffer_load_dwordx4 v[36:39], v1, s[4:7], s33 offen offset:0
  buffer_load_dwordx4 v[40:43], v1, s[4:7], s34 offen offset:0
  buffer_load_dwordx4 v[44:47], v1, s[4:7], s35 offen offset:0
  buffer_load_dwordx4 v[48:51], v1, s[4:7], s36 offen offset:0
  buffer_load_dwordx4 v[52:55], v1, s[4:7], s37 offen offset:0
  buffer_load_dwordx4 v[56:59], v1, s[4:7], s38 offen offset:0
  buffer_load_dwordx4 v[60:63], v1, s[4:7], s39 offen offset:0
  s_waitcnt vmcnt(30)
  ds_read_b128 v[184:187], v1 offset:2048
  ds_read_b128 v[188:191], v1 offset:26624
  ds_read_b128 v[192:195], v6 offset:2048
  ds_read_b128 v[196:199], v6 offset:26624
  s_waitcnt lgkmcnt(4)
  v_mfma_f32_16x16x32_bf16 a[0:3], a[200:203], v[200:203], a[0:3]
  v_mfma_f32_16x16x32_bf16 a[4:7], a[200:203], v[204:207], a[4:7]
  v_mfma_f32_16x16x32_bf16 a[8:11], a[200:203], v[208:211], a[8:11]
  v_mfma_f32_16x16x32_bf16 a[12:15], a[200:203], v[212:215], a[12:15]
  v_mfma_f32_16x16x32_bf16 a[16:19], a[204:207], v[200:203], a[16:19]
  v_mfma_f32_16x16x32_bf16 a[20:23], a[204:207], v[204:207], a[20:23]
  v_mfma_f32_16x16x32_bf16 a[24:27], a[204:207], v[208:211], a[24:27]
  v_mfma_f32_16x16x32_bf16 a[28:31], a[204:207], v[212:215], a[28:31]
  v_mfma_f32_16x16x32_bf16 a[32:35], a[208:211], v[200:203], a[32:35]
  v_mfma_f32_16x16x32_bf16 a[36:39], a[208:211], v[204:207], a[36:39]
  v_mfma_f32_16x16x32_bf16 a[40:43], a[208:211], v[208:211], a[40:43]
  v_mfma_f32_16x16x32_bf16 a[44:47], a[208:211], v[212:215], a[44:47]
  v_mfma_f32_16x16x32_bf16 a[48:51], a[212:215], v[200:203], a[48:51]
  v_mfma_f32_16x16x32_bf16 a[52:55], a[212:215], v[204:207], a[52:55]
  v_mfma_f32_16x16x32_bf16 a[56:59], a[212:215], v[208:211], a[56:59]
  v_mfma_f32_16x16x32_bf16 a[60:63], a[212:215], v[212:215], a[60:63]
  v_mfma_f32_16x16x32_bf16 a[64:67], a[216:219], v[200:203], a[64:67]
  v_mfma_f32_16x16x32_bf16 a[68:71], a[216:219], v[204:207], a[68:71]
  v_mfma_f32_16x16x32_bf16 a[72:75], a[216:219], v[208:211], a[72:75]
  v_mfma_f32_16x16x32_bf16 a[76:79], a[216:219], v[212:215], a[76:79]
  v_mfma_f32_16x16x32_bf16 a[80:83], a[220:223], v[200:203], a[80:83]
  v_mfma_f32_16x16x32_bf16 a[84:87], a[220:223], v[204:207], a[84:87]
  v_mfma_f32_16x16x32_bf16 a[88:91], a[220:223], v[208:211], a[88:91]
  v_mfma_f32_16x16x32_bf16 a[92:95], a[220:223], v[212:215], a[92:95]
  v_mfma_f32_16x16x32_bf16 a[96:99], a[224:227], v[200:203], a[96:99]
  v_mfma_f32_16x16x32_bf16 a[100:103], a[224:227], v[204:207], a[100:103]
  v_mfma_f32_16x16x32_bf16 a[104:107], a[224:227], v[208:211], a[104:107]
  v_mfma_f32_16x16x32_bf16 a[108:111], a[224:227], v[212:215], a[108:111]
  v_mfma_f32_16x16x32_bf16 a[112:115], a[228:231], v[200:203], a[112:115]
  v_mfma_f32_16x16x32_bf16 a[116:119], a[228:231], v[204:207], a[116:119]
  v_mfma_f32_16x16x32_bf16 a[120:123], a[228:231], v[208:211], a[120:123]
  v_mfma_f32_16x16x32_bf16 a[124:127], a[228:231], v[212:215], a[124:127]
  v_mfma_f32_16x16x32_bf16 a[128:131], a[232:235], v[200:203], a[128:131]
  v_mfma_f32_16x16x32_bf16 a[132:135], a[232:235], v[204:207], a[132:135]
  v_mfma_f32_16x16x32_bf16 a[136:139], a[232:235], v[208:211], a[136:139]
  v_mfma_f32_16x16x32_bf16 a[140:143], a[232:235], v[212:215], a[140:143]
  v_mfma_f32_16x16x32_bf16 a[144:147], a[236:239], v[200:203], a[144:147]
  v_mfma_f32_16x16x32_bf16 a[148:151], a[236:239], v[204:207], a[148:151]
  v_mfma_f32_16x16x32_bf16 a[152:155], a[236:239], v[208:211], a[152:155]
  v_mfma_f32_16x16x32_bf16 a[156:159], a[236:239], v[212:215], a[156:159]
  buffer_load_dwordx4 v[64:67], v1, s[4:7], s30 offen offset:1024
  buffer_load_dwordx4 v[68:71], v1, s[4:7], s31 offen offset:1024
  buffer_load_dwordx4 v[72:75], v1, s[4:7], s32 offen offset:1024
  buffer_load_dwordx4 v[76:79], v1, s[4:7], s33 offen offset:1024
  buffer_load_dwordx4 v[80:83], v1, s[4:7], s34 offen offset:1024
  buffer_load_dwordx4 v[84:87], v1, s[4:7], s35 offen offset:1024
  buffer_load_dwordx4 v[88:91], v1, s[4:7], s36 offen offset:1024
  buffer_load_dwordx4 v[92:95], v1, s[4:7], s37 offen offset:1024
  buffer_load_dwordx4 v[96:99], v1, s[4:7], s38 offen offset:1024
  buffer_load_dwordx4 v[100:103], v1, s[4:7], s39 offen offset:1024
  s_waitcnt vmcnt(30)
  ds_read_b128 v[200:203], v1 offset:3072
  ds_read_b128 v[204:207], v1 offset:27648
  ds_read_b128 v[208:211], v6 offset:3072
  ds_read_b128 v[212:215], v6 offset:27648
  s_waitcnt lgkmcnt(4)
  v_mfma_f32_16x16x32_bf16 a[0:3], v[104:107], v[184:187], a[0:3]
  v_mfma_f32_16x16x32_bf16 a[4:7], v[104:107], v[188:191], a[4:7]
  v_mfma_f32_16x16x32_bf16 a[8:11], v[104:107], v[192:195], a[8:11]
  v_mfma_f32_16x16x32_bf16 a[12:15], v[104:107], v[196:199], a[12:15]
  v_mfma_f32_16x16x32_bf16 a[16:19], v[108:111], v[184:187], a[16:19]
  v_mfma_f32_16x16x32_bf16 a[20:23], v[108:111], v[188:191], a[20:23]
  v_mfma_f32_16x16x32_bf16 a[24:27], v[108:111], v[192:195], a[24:27]
  v_mfma_f32_16x16x32_bf16 a[28:31], v[108:111], v[196:199], a[28:31]
  v_mfma_f32_16x16x32_bf16 a[32:35], v[112:115], v[184:187], a[32:35]
  v_mfma_f32_16x16x32_bf16 a[36:39], v[112:115], v[188:191], a[36:39]
  v_mfma_f32_16x16x32_bf16 a[40:43], v[112:115], v[192:195], a[40:43]
  v_mfma_f32_16x16x32_bf16 a[44:47], v[112:115], v[196:199], a[44:47]
  v_mfma_f32_16x16x32_bf16 a[48:51], v[116:119], v[184:187], a[48:51]
  v_mfma_f32_16x16x32_bf16 a[52:55], v[116:119], v[188:191], a[52:55]
  v_mfma_f32_16x16x32_bf16 a[56:59], v[116:119], v[192:195], a[56:59]
  v_mfma_f32_16x16x32_bf16 a[60:63], v[116:119], v[196:199], a[60:63]
  v_mfma_f32_16x16x32_bf16 a[64:67], v[120:123], v[184:187], a[64:67]
  v_mfma_f32_16x16x32_bf16 a[68:71], v[120:123], v[188:191], a[68:71]
  v_mfma_f32_16x16x32_bf16 a[72:75], v[120:123], v[192:195], a[72:75]
  v_mfma_f32_16x16x32_bf16 a[76:79], v[120:123], v[196:199], a[76:79]
  v_mfma_f32_16x16x32_bf16 a[80:83], v[124:127], v[184:187], a[80:83]
  v_mfma_f32_16x16x32_bf16 a[84:87], v[124:127], v[188:191], a[84:87]
  v_mfma_f32_16x16x32_bf16 a[88:91], v[124:127], v[192:195], a[88:91]
  v_mfma_f32_16x16x32_bf16 a[92:95], v[124:127], v[196:199], a[92:95]
  v_mfma_f32_16x16x32_bf16 a[96:99], v[128:131], v[184:187], a[96:99]
  v_mfma_f32_16x16x32_bf16 a[100:103], v[128:131], v[188:191], a[100:103]
  v_mfma_f32_16x16x32_bf16 a[104:107], v[128:131], v[192:195], a[104:107]
  v_mfma_f32_16x16x32_bf16 a[108:111], v[128:131], v[196:199], a[108:111]
  v_mfma_f32_16x16x32_bf16 a[112:115], v[132:135], v[184:187], a[112:115]
  v_mfma_f32_16x16x32_bf16 a[116:119], v[132:135], v[188:191], a[116:119]
  v_mfma_f32_16x16x32_bf16 a[120:123], v[132:135], v[192:195], a[120:123]
  v_mfma_f32_16x16x32_bf16 a[124:127], v[132:135], v[196:199], a[124:127]
  v_mfma_f32_16x16x32_bf16 a[128:131], v[136:139], v[184:187], a[128:131]
  v_mfma_f32_16x16x32_bf16 a[132:135], v[136:139], v[188:191], a[132:135]
  v_mfma_f32_16x16x32_bf16 a[136:139], v[136:139], v[192:195], a[136:139]
  v_mfma_f32_16x16x32_bf16 a[140:143], v[136:139], v[196:199], a[140:143]
  v_mfma_f32_16x16x32_bf16 a[144:147], v[140:143], v[184:187], a[144:147]
  v_mfma_f32_16x16x32_bf16 a[148:151], v[140:143], v[188:191], a[148:151]
  v_mfma_f32_16x16x32_bf16 a[152:155], v[140:143], v[192:195], a[152:155]
  v_mfma_f32_16x16x32_bf16 a[156:159], v[140:143], v[196:199], a[156:159]
  buffer_load_dwordx4 v[104:107], v1, s[4:7], s30 offen offset:2048
  buffer_load_dwordx4 v[108:111], v1, s[4:7], s31 offen offset:2048
  buffer_load_dwordx4 v[112:115], v1, s[4:7], s32 offen offset:2048
  buffer_load_dwordx4 v[116:119], v1, s[4:7], s33 offen offset:2048
  buffer_load_dwordx4 v[120:123], v1, s[4:7], s34 offen offset:2048
  buffer_load_dwordx4 v[124:127], v1, s[4:7], s35 offen offset:2048
  buffer_load_dwordx4 v[128:131], v1, s[4:7], s36 offen offset:2048
  buffer_load_dwordx4 v[132:135], v1, s[4:7], s37 offen offset:2048
  buffer_load_dwordx4 v[136:139], v1, s[4:7], s38 offen offset:2048
  buffer_load_dwordx4 v[140:143], v1, s[4:7], s39 offen offset:2048
  s_waitcnt vmcnt(30)
  ds_read_b128 v[184:187], v1 offset:4096
  ds_read_b128 v[188:191], v1 offset:28672
  ds_read_b128 v[192:195], v6 offset:4096
  ds_read_b128 v[196:199], v6 offset:28672
  s_waitcnt lgkmcnt(4)
  v_mfma_f32_16x16x32_bf16 a[0:3], v[144:147], v[200:203], a[0:3]
  v_mfma_f32_16x16x32_bf16 a[4:7], v[144:147], v[204:207], a[4:7]
  v_mfma_f32_16x16x32_bf16 a[8:11], v[144:147], v[208:211], a[8:11]
  v_mfma_f32_16x16x32_bf16 a[12:15], v[144:147], v[212:215], a[12:15]
  v_mfma_f32_16x16x32_bf16 a[16:19], v[148:151], v[200:203], a[16:19]
  v_mfma_f32_16x16x32_bf16 a[20:23], v[148:151], v[204:207], a[20:23]
  v_mfma_f32_16x16x32_bf16 a[24:27], v[148:151], v[208:211], a[24:27]
  v_mfma_f32_16x16x32_bf16 a[28:31], v[148:151], v[212:215], a[28:31]
  v_mfma_f32_16x16x32_bf16 a[32:35], v[152:155], v[200:203], a[32:35]
  v_mfma_f32_16x16x32_bf16 a[36:39], v[152:155], v[204:207], a[36:39]
  v_mfma_f32_16x16x32_bf16 a[40:43], v[152:155], v[208:211], a[40:43]
  v_mfma_f32_16x16x32_bf16 a[44:47], v[152:155], v[212:215], a[44:47]
  v_mfma_f32_16x16x32_bf16 a[48:51], v[156:159], v[200:203], a[48:51]
  v_mfma_f32_16x16x32_bf16 a[52:55], v[156:159], v[204:207], a[52:55]
  v_mfma_f32_16x16x32_bf16 a[56:59], v[156:159], v[208:211], a[56:59]
  v_mfma_f32_16x16x32_bf16 a[60:63], v[156:159], v[212:215], a[60:63]
  v_mfma_f32_16x16x32_bf16 a[64:67], v[160:163], v[200:203], a[64:67]
  v_mfma_f32_16x16x32_bf16 a[68:71], v[160:163], v[204:207], a[68:71]
  v_mfma_f32_16x16x32_bf16 a[72:75], v[160:163], v[208:211], a[72:75]
  v_mfma_f32_16x16x32_bf16 a[76:79], v[160:163], v[212:215], a[76:79]
  v_mfma_f32_16x16x32_bf16 a[80:83], v[164:167], v[200:203], a[80:83]
  v_mfma_f32_16x16x32_bf16 a[84:87], v[164:167], v[204:207], a[84:87]
  v_mfma_f32_16x16x32_bf16 a[88:91], v[164:167], v[208:211], a[88:91]
  v_mfma_f32_16x16x32_bf16 a[92:95], v[164:167], v[212:215], a[92:95]
  v_mfma_f32_16x16x32_bf16 a[96:99], v[168:171], v[200:203], a[96:99]
  v_mfma_f32_16x16x32_bf16 a[100:103], v[168:171], v[204:207], a[100:103]
  v_mfma_f32_16x16x32_bf16 a[104:107], v[168:171], v[208:211], a[104:107]
  v_mfma_f32_16x16x32_bf16 a[108:111], v[168:171], v[212:215], a[108:111]
  v_mfma_f32_16x16x32_bf16 a[112:115], v[172:175], v[200:203], a[112:115]
  v_mfma_f32_16x16x32_bf16 a[116:119], v[172:175], v[204:207], a[116:119]
  v_mfma_f32_16x16x32_bf16 a[120:123], v[172:175], v[208:211], a[120:123]
  v_mfma_f32_16x16x32_bf16 a[124:127], v[172:175], v[212:215], a[124:127]
  v_mfma_f32_16x16x32_bf16 a[128:131], v[176:179], v[200:203], a[128:131]
  v_mfma_f32_16x16x32_bf16 a[132:135], v[176:179], v[204:207], a[132:135]
  v_mfma_f32_16x16x32_bf16 a[136:139], v[176:179], v[208:211], a[136:139]
  v_mfma_f32_16x16x32_bf16 a[140:143], v[176:179], v[212:215], a[140:143]
  v_mfma_f32_16x16x32_bf16 a[144:147], v[180:183], v[200:203], a[144:147]
  v_mfma_f32_16x16x32_bf16 a[148:151], v[180:183], v[204:207], a[148:151]
  v_mfma_f32_16x16x32_bf16 a[152:155], v[180:183], v[208:211], a[152:155]
  v_mfma_f32_16x16x32_bf16 a[156:159], v[180:183], v[212:215], a[156:159]
  buffer_load_dwordx4 v[144:147], v1, s[4:7], s30 offen offset:3072
  buffer_load_dwordx4 v[148:151], v1, s[4:7], s31 offen offset:3072
  buffer_load_dwordx4 v[152:155], v1, s[4:7], s32 offen offset:3072
  buffer_load_dwordx4 v[156:159], v1, s[4:7], s33 offen offset:3072
  buffer_load_dwordx4 v[160:163], v1, s[4:7], s34 offen offset:3072
  buffer_load_dwordx4 v[164:167], v1, s[4:7], s35 offen offset:3072
  buffer_load_dwordx4 v[168:171], v1, s[4:7], s36 offen offset:3072
  buffer_load_dwordx4 v[172:175], v1, s[4:7], s37 offen offset:3072
  buffer_load_dwordx4 v[176:179], v1, s[4:7], s38 offen offset:3072
  buffer_load_dwordx4 v[180:183], v1, s[4:7], s39 offen offset:3072
  s_add_u32 s30, s30, 4096
  s_add_u32 s31, s31, 4096
  s_add_u32 s32, s32, 4096
  s_add_u32 s33, s33, 4096
  s_add_u32 s34, s34, 4096
  s_add_u32 s35, s35, 4096
  s_add_u32 s36, s36, 4096
  s_add_u32 s37, s37, 4096
  s_add_u32 s38, s38, 4096
  s_add_u32 s39, s39, 4096
  s_waitcnt vmcnt(30)
  ds_read_b128 v[200:203], v1 offset:5120
  ds_read_b128 v[204:207], v1 offset:29696
  ds_read_b128 v[208:211], v6 offset:5120
  ds_read_b128 v[212:215], v6 offset:29696
  s_waitcnt lgkmcnt(4)
  v_mfma_f32_16x16x32_bf16 a[0:3], v[24:27], v[184:187], a[0:3]
  v_mfma_f32_16x16x32_bf16 a[4:7], v[24:27], v[188:191], a[4:7]
  v_mfma_f32_16x16x32_bf16 a[8:11], v[24:27], v[192:195], a[8:11]
  v_mfma_f32_16x16x32_bf16 a[12:15], v[24:27], v[196:199], a[12:15]
  v_mfma_f32_16x16x32_bf16 a[16:19], v[28:31], v[184:187], a[16:19]
  v_mfma_f32_16x16x32_bf16 a[20:23], v[28:31], v[188:191], a[20:23]
  v_mfma_f32_16x16x32_bf16 a[24:27], v[28:31], v[192:195], a[24:27]
  v_mfma_f32_16x16x32_bf16 a[28:31], v[28:31], v[196:199], a[28:31]
  v_mfma_f32_16x16x32_bf16 a[32:35], v[32:35], v[184:187], a[32:35]
  v_mfma_f32_16x16x32_bf16 a[36:39], v[32:35], v[188:191], a[36:39]
  v_mfma_f32_16x16x32_bf16 a[40:43], v[32:35], v[192:195], a[40:43]
  v_mfma_f32_16x16x32_bf16 a[44:47], v[32:35], v[196:199], a[44:47]
  v_mfma_f32_16x16x32_bf16 a[48:51], v[36:39], v[184:187], a[48:51]
  v_mfma_f32_16x16x32_bf16 a[52:55], v[36:39], v[188:191], a[52:55]
  v_mfma_f32_16x16x32_bf16 a[56:59], v[36:39], v[192:195], a[56:59]
  v_mfma_f32_16x16x32_bf16 a[60:63], v[36:39], v[196:199], a[60:63]
  v_mfma_f32_16x16x32_bf16 a[64:67], v[40:43], v[184:187], a[64:67]
  v_mfma_f32_16x16x32_bf16 a[68:71], v[40:43], v[188:191], a[68:71]
  v_mfma_f32_16x16x32_bf16 a[72:75], v[40:43], v[192:195], a[72:75]
  v_mfma_f32_16x16x32_bf16 a[76:79], v[40:43], v[196:199], a[76:79]
  v_mfma_f32_16x16x32_bf16 a[80:83], v[44:47], v[184:187], a[80:83]
  v_mfma_f32_16x16x32_bf16 a[84:87], v[44:47], v[188:191], a[84:87]
  v_mfma_f32_16x16x32_bf16 a[88:91], v[44:47], v[192:195], a[88:91]
  v_mfma_f32_16x16x32_bf16 a[92:95], v[44:47], v[196:199], a[92:95]
  v_mfma_f32_16x16x32_bf16 a[96:99], v[48:51], v[184:187], a[96:99]
  v_mfma_f32_16x16x32_bf16 a[100:103], v[48:51], v[188:191], a[100:103]
  v_mfma_f32_16x16x32_bf16 a[104:107], v[48:51], v[192:195], a[104:107]
  v_mfma_f32_16x16x32_bf16 a[108:111], v[48:51], v[196:199], a[108:111]
  v_mfma_f32_16x16x32_bf16 a[112:115], v[52:55], v[184:187], a[112:115]
  v_mfma_f32_16x16x32_bf16 a[116:119], v[52:55], v[188:191], a[116:119]
  v_mfma_f32_16x16x32_bf16 a[120:123], v[52:55], v[192:195], a[120:123]
  v_mfma_f32_16x16x32_bf16 a[124:127], v[52:55], v[196:199], a[124:127]
  v_mfma_f32_16x16x32_bf16 a[128:131], v[56:59], v[184:187], a[128:131]
  v_mfma_f32_16x16x32_bf16 a[132:135], v[56:59], v[188:191], a[132:135]
  v_mfma_f32_16x16x32_bf16 a[136:139], v[56:59], v[192:195], a[136:139]
  v_mfma_f32_16x16x32_bf16 a[140:143], v[56:59], v[196:199], a[140:143]
  v_mfma_f32_16x16x32_bf16 a[144:147], v[60:63], v[184:187], a[144:147]
  v_mfma_f32_16x16x32_bf16 a[148:151], v[60:63], v[188:191], a[148:151]
  v_mfma_f32_16x16x32_bf16 a[152:155], v[60:63], v[192:195], a[152:155]
  v_mfma_f32_16x16x32_bf16 a[156:159], v[60:63], v[196:199], a[156:159]
  buffer_load_dwordx4 v[24:27], v1, s[4:7], s30 offen offset:0
  buffer_load_dwordx4 v[28:31], v1, s[4:7], s31 offen offset:0
  buffer_load_dwordx4 v[32:35], v1, s[4:7], s32 offen offset:0
  buffer_load_dwordx4 v[36:39], v1, s[4:7], s33 offen offset:0
  buffer_load_dwordx4 v[40:43], v1, s[4:7], s34 offen offset:0
  buffer_load_dwordx4 v[44:47], v1, s[4:7], s35 offen offset:0
  buffer_load_dwordx4 v[48:51], v1, s[4:7], s36 offen offset:0
  buffer_load_dwordx4 v[52:55], v1, s[4:7], s37 offen offset:0
  buffer_load_dwordx4 v[56:59], v1, s[4:7], s38 offen offset:0
  buffer_load_dwordx4 v[60:63], v1, s[4:7], s39 offen offset:0
  s_waitcnt vmcnt(30)
  ds_read_b128 v[184:187], v1 offset:6144
  ds_read_b128 v[188:191], v1 offset:30720
  ds_read_b128 v[192:195], v6 offset:6144
  ds_read_b128 v[196:199], v6 offset:30720
  s_waitcnt lgkmcnt(4)
  v_mfma_f32_16x16x32_bf16 a[0:3], v[64:67], v[200:203], a[0:3]
  v_mfma_f32_16x16x32_bf16 a[4:7], v[64:67], v[204:207], a[4:7]
  v_mfma_f32_16x16x32_bf16 a[8:11], v[64:67], v[208:211], a[8:11]
  v_mfma_f32_16x16x32_bf16 a[12:15], v[64:67], v[212:215], a[12:15]
  v_mfma_f32_16x16x32_bf16 a[16:19], v[68:71], v[200:203], a[16:19]
  v_mfma_f32_16x16x32_bf16 a[20:23], v[68:71], v[204:207], a[20:23]
  v_mfma_f32_16x16x32_bf16 a[24:27], v[68:71], v[208:211], a[24:27]
  v_mfma_f32_16x16x32_bf16 a[28:31], v[68:71], v[212:215], a[28:31]
  v_mfma_f32_16x16x32_bf16 a[32:35], v[72:75], v[200:203], a[32:35]
  v_mfma_f32_16x16x32_bf16 a[36:39], v[72:75], v[204:207], a[36:39]
  v_mfma_f32_16x16x32_bf16 a[40:43], v[72:75], v[208:211], a[40:43]
  v_mfma_f32_16x16x32_bf16 a[44:47], v[72:75], v[212:215], a[44:47]
  v_mfma_f32_16x16x32_bf16 a[48:51], v[76:79], v[200:203], a[48:51]
  v_mfma_f32_16x16x32_bf16 a[52:55], v[76:79], v[204:207], a[52:55]
  v_mfma_f32_16x16x32_bf16 a[56:59], v[76:79], v[208:211], a[56:59]
  v_mfma_f32_16x16x32_bf16 a[60:63], v[76:79], v[212:215], a[60:63]
  v_mfma_f32_16x16x32_bf16 a[64:67], v[80:83], v[200:203], a[64:67]
  v_mfma_f32_16x16x32_bf16 a[68:71], v[80:83], v[204:207], a[68:71]
  v_mfma_f32_16x16x32_bf16 a[72:75], v[80:83], v[208:211], a[72:75]
  v_mfma_f32_16x16x32_bf16 a[76:79], v[80:83], v[212:215], a[76:79]
  v_mfma_f32_16x16x32_bf16 a[80:83], v[84:87], v[200:203], a[80:83]
  v_mfma_f32_16x16x32_bf16 a[84:87], v[84:87], v[204:207], a[84:87]
  v_mfma_f32_16x16x32_bf16 a[88:91], v[84:87], v[208:211], a[88:91]
  v_mfma_f32_16x16x32_bf16 a[92:95], v[84:87], v[212:215], a[92:95]
  v_mfma_f32_16x16x32_bf16 a[96:99], v[88:91], v[200:203], a[96:99]
  v_mfma_f32_16x16x32_bf16 a[100:103], v[88:91], v[204:207], a[100:103]
  v_mfma_f32_16x16x32_bf16 a[104:107], v[88:91], v[208:211], a[104:107]
  v_mfma_f32_16x16x32_bf16 a[108:111], v[88:91], v[212:215], a[108:111]
  v_mfma_f32_16x16x32_bf16 a[112:115], v[92:95], v[200:203], a[112:115]
  v_mfma_f32_16x16x32_bf16 a[116:119], v[92:95], v[204:207], a[116:119]
  v_mfma_f32_16x16x32_bf16 a[120:123], v[92:95], v[208:211], a[120:123]
  v_mfma_f32_16x16x32_bf16 a[124:127], v[92:95], v[212:215], a[124:127]
  v_mfma_f32_16x16x32_bf16 a[128:131], v[96:99], v[200:203], a[128:131]
  v_mfma_f32_16x16x32_bf16 a[132:135], v[96:99], v[204:207], a[132:135]
  v_mfma_f32_16x16x32_bf16 a[136:139], v[96:99], v[208:211], a[136:139]
  v_mfma_f32_16x16x32_bf16 a[140:143], v[96:99], v[212:215], a[140:143]
  v_mfma_f32_16x16x32_bf16 a[144:147], v[100:103], v[200:203], a[144:147]
  v_mfma_f32_16x16x32_bf16 a[148:151], v[100:103], v[204:207], a[148:151]
  v_mfma_f32_16x16x32_bf16 a[152:155], v[100:103], v[208:211], a[152:155]
  v_mfma_f32_16x16x32_bf16 a[156:159], v[100:103], v[212:215], a[156:159]
  buffer_load_dwordx4 v[64:67], v1, s[4:7], s30 offen offset:1024
  buffer_load_dwordx4 v[68:71], v1, s[4:7], s31 offen offset:1024
  buffer_load_dwordx4 v[72:75], v1, s[4:7], s32 offen offset:1024
  buffer_load_dwordx4 v[76:79], v1, s[4:7], s33 offen offset:1024
  buffer_load_dwordx4 v[80:83], v1, s[4:7], s34 offen offset:1024
  buffer_load_dwordx4 v[84:87], v1, s[4:7], s35 offen offset:1024
  buffer_load_dwordx4 v[88:91], v1, s[4:7], s36 offen offset:1024
  buffer_load_dwordx4 v[92:95], v1, s[4:7], s37 offen offset:1024
  buffer_load_dwordx4 v[96:99], v1, s[4:7], s38 offen offset:1024
  buffer_load_dwordx4 v[100:103], v1, s[4:7], s39 offen offset:1024
  s_waitcnt vmcnt(30)
  ds_read_b128 v[200:203], v1 offset:7168
  ds_read_b128 v[204:207], v1 offset:31744
  ds_read_b128 v[208:211], v6 offset:7168
  ds_read_b128 v[212:215], v6 offset:31744
  s_waitcnt lgkmcnt(4)
  v_mfma_f32_16x16x32_bf16 a[0:3], v[104:107], v[184:187], a[0:3]
  v_mfma_f32_16x16x32_bf16 a[4:7], v[104:107], v[188:191], a[4:7]
  v_mfma_f32_16x16x32_bf16 a[8:11], v[104:107], v[192:195], a[8:11]
  v_mfma_f32_16x16x32_bf16 a[12:15], v[104:107], v[196:199], a[12:15]
  v_mfma_f32_16x16x32_bf16 a[16:19], v[108:111], v[184:187], a[16:19]
  v_mfma_f32_16x16x32_bf16 a[20:23], v[108:111], v[188:191], a[20:23]
  v_mfma_f32_16x16x32_bf16 a[24:27], v[108:111], v[192:195], a[24:27]
  v_mfma_f32_16x16x32_bf16 a[28:31], v[108:111], v[196:199], a[28:31]
  v_mfma_f32_16x16x32_bf16 a[32:35], v[112:115], v[184:187], a[32:35]
  v_mfma_f32_16x16x32_bf16 a[36:39], v[112:115], v[188:191], a[36:39]
  v_mfma_f32_16x16x32_bf16 a[40:43], v[112:115], v[192:195], a[40:43]
  v_mfma_f32_16x16x32_bf16 a[44:47], v[112:115], v[196:199], a[44:47]
  v_mfma_f32_16x16x32_bf16 a[48:51], v[116:119], v[184:187], a[48:51]
  v_mfma_f32_16x16x32_bf16 a[52:55], v[116:119], v[188:191], a[52:55]
  v_mfma_f32_16x16x32_bf16 a[56:59], v[116:119], v[192:195], a[56:59]
  v_mfma_f32_16x16x32_bf16 a[60:63], v[116:119], v[196:199], a[60:63]
  v_mfma_f32_16x16x32_bf16 a[64:67], v[120:123], v[184:187], a[64:67]
  v_mfma_f32_16x16x32_bf16 a[68:71], v[120:123], v[188:191], a[68:71]
  v_mfma_f32_16x16x32_bf16 a[72:75], v[120:123], v[192:195], a[72:75]
  v_mfma_f32_16x16x32_bf16 a[76:79], v[120:123], v[196:199], a[76:79]
  v_mfma_f32_16x16x32_bf16 a[80:83], v[124:127], v[184:187], a[80:83]
  v_mfma_f32_16x16x32_bf16 a[84:87], v[124:127], v[188:191], a[84:87]
  v_mfma_f32_16x16x32_bf16 a[88:91], v[124:127], v[192:195], a[88:91]
  v_mfma_f32_16x16x32_bf16 a[92:95], v[124:127], v[196:199], a[92:95]
  v_mfma_f32_16x16x32_bf16 a[96:99], v[128:131], v[184:187], a[96:99]
  v_mfma_f32_16x16x32_bf16 a[100:103], v[128:131], v[188:191], a[100:103]
  v_mfma_f32_16x16x32_bf16 a[104:107], v[128:131], v[192:195], a[104:107]
  v_mfma_f32_16x16x32_bf16 a[108:111], v[128:131], v[196:199], a[108:111]
  v_mfma_f32_16x16x32_bf16 a[112:115], v[132:135], v[184:187], a[112:115]
  v_mfma_f32_16x16x32_bf16 a[116:119], v[132:135], v[188:191], a[116:119]
  v_mfma_f32_16x16x32_bf16 a[120:123], v[132:135], v[192:195], a[120:123]
  v_mfma_f32_16x16x32_bf16 a[124:127], v[132:135], v[196:199], a[124:127]
  v_mfma_f32_16x16x32_bf16 a[128:131], v[136:139], v[184:187], a[128:131]
  v_mfma_f32_16x16x32_bf16 a[132:135], v[136:139], v[188:191], a[132:135]
  v_mfma_f32_16x16x32_bf16 a[136:139], v[136:139], v[192:195], a[136:139]
  v_mfma_f32_16x16x32_bf16 a[140:143], v[136:139], v[196:199], a[140:143]
  v_mfma_f32_16x16x32_bf16 a[144:147], v[140:143], v[184:187], a[144:147]
  v_mfma_f32_16x16x32_bf16 a[148:151], v[140:143], v[188:191], a[148:151]
  v_mfma_f32_16x16x32_bf16 a[152:155], v[140:143], v[192:195], a[152:155]
  v_mfma_f32_16x16x32_bf16 a[156:159], v[140:143], v[196:199], a[156:159]
  buffer_load_dwordx4 v[104:107], v1, s[4:7], s30 offen offset:2048
  buffer_load_dwordx4 v[108:111], v1, s[4:7], s31 offen offset:2048
  buffer_load_dwordx4 v[112:115], v1, s[4:7], s32 offen offset:2048
  buffer_load_dwordx4 v[116:119], v1, s[4:7], s33 offen offset:2048
  buffer_load_dwordx4 v[120:123], v1, s[4:7], s34 offen offset:2048
  buffer_load_dwordx4 v[124:127], v1, s[4:7], s35 offen offset:2048
  buffer_load_dwordx4 v[128:131], v1, s[4:7], s36 offen offset:2048
  buffer_load_dwordx4 v[132:135], v1, s[4:7], s37 offen offset:2048
  buffer_load_dwordx4 v[136:139], v1, s[4:7], s38 offen offset:2048
  buffer_load_dwordx4 v[140:143], v1, s[4:7], s39 offen offset:2048
  s_waitcnt vmcnt(30)
  ds_read_b128 v[184:187], v1 offset:8192
  ds_read_b128 v[188:191], v1 offset:32768
  ds_read_b128 v[192:195], v6 offset:8192
  ds_read_b128 v[196:199], v6 offset:32768
  s_waitcnt lgkmcnt(4)
  v_mfma_f32_16x16x32_bf16 a[0:3], v[144:147], v[200:203], a[0:3]
  v_mfma_f32_16x16x32_bf16 a[4:7], v[144:147], v[204:207], a[4:7]
  v_mfma_f32_16x16x32_bf16 a[8:11], v[144:147], v[208:211], a[8:11]
  v_mfma_f32_16x16x32_bf16 a[12:15], v[144:147], v[212:215], a[12:15]
  v_mfma_f32_16x16x32_bf16 a[16:19], v[148:151], v[200:203], a[16:19]
  v_mfma_f32_16x16x32_bf16 a[20:23], v[148:151], v[204:207], a[20:23]
  v_mfma_f32_16x16x32_bf16 a[24:27], v[148:151], v[208:211], a[24:27]
  v_mfma_f32_16x16x32_bf16 a[28:31], v[148:151], v[212:215], a[28:31]
  v_mfma_f32_16x16x32_bf16 a[32:35], v[152:155], v[200:203], a[32:35]
  v_mfma_f32_16x16x32_bf16 a[36:39], v[152:155], v[204:207], a[36:39]
  v_mfma_f32_16x16x32_bf16 a[40:43], v[152:155], v[208:211], a[40:43]
  v_mfma_f32_16x16x32_bf16 a[44:47], v[152:155], v[212:215], a[44:47]
  v_mfma_f32_16x16x32_bf16 a[48:51], v[156:159], v[200:203], a[48:51]
  v_mfma_f32_16x16x32_bf16 a[52:55], v[156:159], v[204:207], a[52:55]
  v_mfma_f32_16x16x32_bf16 a[56:59], v[156:159], v[208:211], a[56:59]
  v_mfma_f32_16x16x32_bf16 a[60:63], v[156:159], v[212:215], a[60:63]
  v_mfma_f32_16x16x32_bf16 a[64:67], v[160:163], v[200:203], a[64:67]
  v_mfma_f32_16x16x32_bf16 a[68:71], v[160:163], v[204:207], a[68:71]
  v_mfma_f32_16x16x32_bf16 a[72:75], v[160:163], v[208:211], a[72:75]
  v_mfma_f32_16x16x32_bf16 a[76:79], v[160:163], v[212:215], a[76:79]
  v_mfma_f32_16x16x32_bf16 a[80:83], v[164:167], v[200:203], a[80:83]
  v_mfma_f32_16x16x32_bf16 a[84:87], v[164:167], v[204:207], a[84:87]
  v_mfma_f32_16x16x32_bf16 a[88:91], v[164:167], v[208:211], a[88:91]
  v_mfma_f32_16x16x32_bf16 a[92:95], v[164:167], v[212:215], a[92:95]
  v_mfma_f32_16x16x32_bf16 a[96:99], v[168:171], v[200:203], a[96:99]
  v_mfma_f32_16x16x32_bf16 a[100:103], v[168:171], v[204:207], a[100:103]
  v_mfma_f32_16x16x32_bf16 a[104:107], v[168:171], v[208:211], a[104:107]
  v_mfma_f32_16x16x32_bf16 a[108:111], v[168:171], v[212:215], a[108:111]
  v_mfma_f32_16x16x32_bf16 a[112:115], v[172:175], v[200:203], a[112:115]
  v_mfma_f32_16x16x32_bf16 a[116:119], v[172:175], v[204:207], a[116:119]
  v_mfma_f32_16x16x32_bf16 a[120:123], v[172:175], v[208:211], a[120:123]
  v_mfma_f32_16x16x32_bf16 a[124:127], v[172:175], v[212:215], a[124:127]
  v_mfma_f32_16x16x32_bf16 a[128:131], v[176:179], v[200:203], a[128:131]
  v_mfma_f32_16x16x32_bf16 a[132:135], v[176:179], v[204:207], a[132:135]
  v_mfma_f32_16x16x32_bf16 a[136:139], v[176:179], v[208:211], a[136:139]
  v_mfma_f32_16x16x32_bf16 a[140:143], v[176:179], v[212:215], a[140:143]
  v_mfma_f32_16x16x32_bf16 a[144:147], v[180:183], v[200:203], a[144:147]
  v_mfma_f32_16x16x32_bf16 a[148:151], v[180:183], v[204:207], a[148:151]
  v_mfma_f32_16x16x32_bf16 a[152:155], v[180:183], v[208:211], a[152:155]
  v_mfma_f32_16x16x32_bf16 a[156:159], v[180:183], v[212:215], a[156:159]
  buffer_load_dwordx4 v[144:147], v1, s[4:7], s30 offen offset:3072
  buffer_load_dwordx4 v[148:151], v1, s[4:7], s31 offen offset:3072
  buffer_load_dwordx4 v[152:155], v1, s[4:7], s32 offen offset:3072
  buffer_load_dwordx4 v[156:159], v1, s[4:7], s33 offen offset:3072
  buffer_load_dwordx4 v[160:163], v1, s[4:7], s34 offen offset:3072
  buffer_load_dwordx4 v[164:167], v1, s[4:7], s35 offen offset:3072
  buffer_load_dwordx4 v[168:171], v1, s[4:7], s36 offen offset:3072
  buffer_load_dwordx4 v[172:175], v1, s[4:7], s37 offen offset:3072
  buffer_load_dwordx4 v[176:179], v1, s[4:7], s38 offen offset:3072
  buffer_load_dwordx4 v[180:183], v1, s[4:7], s39 offen offset:3072
  s_add_u32 s30, s30, 4096
  s_add_u32 s31, s31, 4096
  s_add_u32 s32, s32, 4096
  s_add_u32 s33, s33, 4096
  s_add_u32 s34, s34, 4096
  s_add_u32 s35, s35, 4096
  s_add_u32 s36, s36, 4096
  s_add_u32 s37, s37, 4096
  s_add_u32 s38, s38, 4096
  s_add_u32 s39, s39, 4096
  s_waitcnt vmcnt(30)
  ds_read_b128 v[200:203], v1 offset:9216
  ds_read_b128 v[204:207], v1 offset:33792
  ds_read_b128 v[208:211], v6 offset:9216
  ds_read_b128 v[212:215], v6 offset:33792
  s_waitcnt lgkmcnt(4)
  v_mfma_f32_16x16x32_bf16 a[0:3], v[24:27], v[184:187], a[0:3]
  v_mfma_f32_16x16x32_bf16 a[4:7], v[24:27], v[188:191], a[4:7]
  v_mfma_f32_16x16x32_bf16 a[8:11], v[24:27], v[192:195], a[8:11]
  v_mfma_f32_16x16x32_bf16 a[12:15], v[24:27], v[196:199], a[12:15]
  v_mfma_f32_16x16x32_bf16 a[16:19], v[28:31], v[184:187], a[16:19]
  v_mfma_f32_16x16x32_bf16 a[20:23], v[28:31], v[188:191], a[20:23]
  v_mfma_f32_16x16x32_bf16 a[24:27], v[28:31], v[192:195], a[24:27]
  v_mfma_f32_16x16x32_bf16 a[28:31], v[28:31], v[196:199], a[28:31]
  v_mfma_f32_16x16x32_bf16 a[32:35], v[32:35], v[184:187], a[32:35]
  v_mfma_f32_16x16x32_bf16 a[36:39], v[32:35], v[188:191], a[36:39]
  v_mfma_f32_16x16x32_bf16 a[40:43], v[32:35], v[192:195], a[40:43]
  v_mfma_f32_16x16x32_bf16 a[44:47], v[32:35], v[196:199], a[44:47]
  v_mfma_f32_16x16x32_bf16 a[48:51], v[36:39], v[184:187], a[48:51]
  v_mfma_f32_16x16x32_bf16 a[52:55], v[36:39], v[188:191], a[52:55]
  v_mfma_f32_16x16x32_bf16 a[56:59], v[36:39], v[192:195], a[56:59]
  v_mfma_f32_16x16x32_bf16 a[60:63], v[36:39], v[196:199], a[60:63]
  v_mfma_f32_16x16x32_bf16 a[64:67], v[40:43], v[184:187], a[64:67]
  v_mfma_f32_16x16x32_bf16 a[68:71], v[40:43], v[188:191], a[68:71]
  v_mfma_f32_16x16x32_bf16 a[72:75], v[40:43], v[192:195], a[72:75]
  v_mfma_f32_16x16x32_bf16 a[76:79], v[40:43], v[196:199], a[76:79]
  v_mfma_f32_16x16x32_bf16 a[80:83], v[44:47], v[184:187], a[80:83]
  v_mfma_f32_16x16x32_bf16 a[84:87], v[44:47], v[188:191], a[84:87]
  v_mfma_f32_16x16x32_bf16 a[88:91], v[44:47], v[192:195], a[88:91]
  v_mfma_f32_16x16x32_bf16 a[92:95], v[44:47], v[196:199], a[92:95]
  v_mfma_f32_16x16x32_bf16 a[96:99], v[48:51], v[184:187], a[96:99]
  v_mfma_f32_16x16x32_bf16 a[100:103], v[48:51], v[188:191], a[100:103]
  v_mfma_f32_16x16x32_bf16 a[104:107], v[48:51], v[192:195], a[104:107]
  v_mfma_f32_16x16x32_bf16 a[108:111], v[48:51], v[196:199], a[108:111]
  v_mfma_f32_16x16x32_bf16 a[112:115], v[52:55], v[184:187], a[112:115]
  v_mfma_f32_16x16x32_bf16 a[116:119], v[52:55], v[188:191], a[116:119]
  v_mfma_f32_16x16x32_bf16 a[120:123], v[52:55], v[192:195], a[120:123]
  v_mfma_f32_16x16x32_bf16 a[124:127], v[52:55], v[196:199], a[124:127]
  v_mfma_f32_16x16x32_bf16 a[128:131], v[56:59], v[184:187], a[128:131]
  v_mfma_f32_16x16x32_bf16 a[132:135], v[56:59], v[188:191], a[132:135]
  v_mfma_f32_16x16x32_bf16 a[136:139], v[56:59], v[192:195], a[136:139]
  v_mfma_f32_16x16x32_bf16 a[140:143], v[56:59], v[196:199], a[140:143]
  v_mfma_f32_16x16x32_bf16 a[144:147], v[60:63], v[184:187], a[144:147]
  v_mfma_f32_16x16x32_bf16 a[148:151], v[60:63], v[188:191], a[148:151]
  v_mfma_f32_16x16x32_bf16 a[152:155], v[60:63], v[192:195], a[152:155]
  v_mfma_f32_16x16x32_bf16 a[156:159], v[60:63], v[196:199], a[156:159]
  buffer_load_dwordx4 v[24:27], v1, s[4:7], s30 offen offset:0
  buffer_load_dwordx4 v[28:31], v1, s[4:7], s31 offen offset:0
  buffer_load_dwordx4 v[32:35], v1, s[4:7], s32 offen offset:0
  buffer_load_dwordx4 v[36:39], v1, s[4:7], s33 offen offset:0
  buffer_load_dwordx4 v[40:43], v1, s[4:7], s34 offen offset:0
  buffer_load_dwordx4 v[44:47], v1, s[4:7], s35 offen offset:0
  buffer_load_dwordx4 v[48:51], v1, s[4:7], s36 offen offset:0
  buffer_load_dwordx4 v[52:55], v1, s[4:7], s37 offen offset:0
  buffer_load_dwordx4 v[56:59], v1, s[4:7], s38 offen offset:0
  buffer_load_dwordx4 v[60:63], v1, s[4:7], s39 offen offset:0
  s_waitcnt vmcnt(30)
  ds_read_b128 v[184:187], v1 offset:10240
  ds_read_b128 v[188:191], v1 offset:34816
  ds_read_b128 v[192:195], v6 offset:10240
  ds_read_b128 v[196:199], v6 offset:34816
  s_waitcnt lgkmcnt(4)
  v_mfma_f32_16x16x32_bf16 a[0:3], v[64:67], v[200:203], a[0:3]
  v_mfma_f32_16x16x32_bf16 a[4:7], v[64:67], v[204:207], a[4:7]
  v_mfma_f32_16x16x32_bf16 a[8:11], v[64:67], v[208:211], a[8:11]
  v_mfma_f32_16x16x32_bf16 a[12:15], v[64:67], v[212:215], a[12:15]
  v_mfma_f32_16x16x32_bf16 a[16:19], v[68:71], v[200:203], a[16:19]
  v_mfma_f32_16x16x32_bf16 a[20:23], v[68:71], v[204:207], a[20:23]
  v_mfma_f32_16x16x32_bf16 a[24:27], v[68:71], v[208:211], a[24:27]
  v_mfma_f32_16x16x32_bf16 a[28:31], v[68:71], v[212:215], a[28:31]
  v_mfma_f32_16x16x32_bf16 a[32:35], v[72:75], v[200:203], a[32:35]
  v_mfma_f32_16x16x32_bf16 a[36:39], v[72:75], v[204:207], a[36:39]
  v_mfma_f32_16x16x32_bf16 a[40:43], v[72:75], v[208:211], a[40:43]
  v_mfma_f32_16x16x32_bf16 a[44:47], v[72:75], v[212:215], a[44:47]
  v_mfma_f32_16x16x32_bf16 a[48:51], v[76:79], v[200:203], a[48:51]
  v_mfma_f32_16x16x32_bf16 a[52:55], v[76:79], v[204:207], a[52:55]
  v_mfma_f32_16x16x32_bf16 a[56:59], v[76:79], v[208:211], a[56:59]
  v_mfma_f32_16x16x32_bf16 a[60:63], v[76:79], v[212:215], a[60:63]
  v_mfma_f32_16x16x32_bf16 a[64:67], v[80:83], v[200:203], a[64:67]
  v_mfma_f32_16x16x32_bf16 a[68:71], v[80:83], v[204:207], a[68:71]
  v_mfma_f32_16x16x32_bf16 a[72:75], v[80:83], v[208:211], a[72:75]
  v_mfma_f32_16x16x32_bf16 a[76:79], v[80:83], v[212:215], a[76:79]
  v_mfma_f32_16x16x32_bf16 a[80:83], v[84:87], v[200:203], a[80:83]
  v_mfma_f32_16x16x32_bf16 a[84:87], v[84:87], v[204:207], a[84:87]
  v_mfma_f32_16x16x32_bf16 a[88:91], v[84:87], v[208:211], a[88:91]
  v_mfma_f32_16x16x32_bf16 a[92:95], v[84:87], v[212:215], a[92:95]
  v_mfma_f32_16x16x32_bf16 a[96:99], v[88:91], v[200:203], a[96:99]
  v_mfma_f32_16x16x32_bf16 a[100:103], v[88:91], v[204:207], a[100:103]
  v_mfma_f32_16x16x32_bf16 a[104:107], v[88:91], v[208:211], a[104:107]
  v_mfma_f32_16x16x32_bf16 a[108:111], v[88:91], v[212:215], a[108:111]
  v_mfma_f32_16x16x32_bf16 a[112:115], v[92:95], v[200:203], a[112:115]
  v_mfma_f32_16x16x32_bf16 a[116:119], v[92:95], v[204:207], a[116:119]
  v_mfma_f32_16x16x32_bf16 a[120:123], v[92:95], v[208:211], a[120:123]
  v_mfma_f32_16x16x32_bf16 a[124:127], v[92:95], v[212:215], a[124:127]
  v_mfma_f32_16x16x32_bf16 a[128:131], v[96:99], v[200:203], a[128:131]
  v_mfma_f32_16x16x32_bf16 a[132:135], v[96:99], v[204:207], a[132:135]
  v_mfma_f32_16x16x32_bf16 a[136:139], v[96:99], v[208:211], a[136:139]
  v_mfma_f32_16x16x32_bf16 a[140:143], v[96:99], v[212:215], a[140:143]
  v_mfma_f32_16x16x32_bf16 a[144:147], v[100:103], v[200:203], a[144:147]
  v_mfma_f32_16x16x32_bf16 a[148:151], v[100:103], v[204:207], a[148:151]
  v_mfma_f32_16x16x32_bf16 a[152:155], v[100:103], v[208:211], a[152:155]
  v_mfma_f32_16x16x32_bf16 a[156:159], v[100:103], v[212:215], a[156:159]
  buffer_load_dwordx4 v[64:67], v1, s[4:7], s30 offen offset:1024
  buffer_load_dwordx4 v[68:71], v1, s[4:7], s31 offen offset:1024
  buffer_load_dwordx4 v[72:75], v1, s[4:7], s32 offen offset:1024
  buffer_load_dwordx4 v[76:79], v1, s[4:7], s33 offen offset:1024
  buffer_load_dwordx4 v[80:83], v1, s[4:7], s34 offen offset:1024
  buffer_load_dwordx4 v[84:87], v1, s[4:7], s35 offen offset:1024
  buffer_load_dwordx4 v[88:91], v1, s[4:7], s36 offen offset:1024
  buffer_load_dwordx4 v[92:95], v1, s[4:7], s37 offen offset:1024
  buffer_load_dwordx4 v[96:99], v1, s[4:7], s38 offen offset:1024
  buffer_load_dwordx4 v[100:103], v1, s[4:7], s39 offen offset:1024
  s_waitcnt vmcnt(30)
  ds_read_b128 v[200:203], v1 offset:11264
  ds_read_b128 v[204:207], v1 offset:35840
  ds_read_b128 v[208:211], v6 offset:11264
  ds_read_b128 v[212:215], v6 offset:35840
  s_waitcnt lgkmcnt(4)
  v_mfma_f32_16x16x32_bf16 a[0:3], v[104:107], v[184:187], a[0:3]
  v_mfma_f32_16x16x32_bf16 a[4:7], v[104:107], v[188:191], a[4:7]
  v_mfma_f32_16x16x32_bf16 a[8:11], v[104:107], v[192:195], a[8:11]
  v_mfma_f32_16x16x32_bf16 a[12:15], v[104:107], v[196:199], a[12:15]
  v_mfma_f32_16x16x32_bf16 a[16:19], v[108:111], v[184:187], a[16:19]
  v_mfma_f32_16x16x32_bf16 a[20:23], v[108:111], v[188:191], a[20:23]
  v_mfma_f32_16x16x32_bf16 a[24:27], v[108:111], v[192:195], a[24:27]
  v_mfma_f32_16x16x32_bf16 a[28:31], v[108:111], v[196:199], a[28:31]
  v_mfma_f32_16x16x32_bf16 a[32:35], v[112:115], v[184:187], a[32:35]
  v_mfma_f32_16x16x32_bf16 a[36:39], v[112:115], v[188:191], a[36:39]
  v_mfma_f32_16x16x32_bf16 a[40:43], v[112:115], v[192:195], a[40:43]
  v_mfma_f32_16x16x32_bf16 a[44:47], v[112:115], v[196:199], a[44:47]
  v_mfma_f32_16x16x32_bf16 a[48:51], v[116:119], v[184:187], a[48:51]
  v_mfma_f32_16x16x32_bf16 a[52:55], v[116:119], v[188:191], a[52:55]
  v_mfma_f32_16x16x32_bf16 a[56:59], v[116:119], v[192:195], a[56:59]
  v_mfma_f32_16x16x32_bf16 a[60:63], v[116:119], v[196:199], a[60:63]
  v_mfma_f32_16x16x32_bf16 a[64:67], v[120:123], v[184:187], a[64:67]
  v_mfma_f32_16x16x32_bf16 a[68:71], v[120:123], v[188:191], a[68:71]
  v_mfma_f32_16x16x32_bf16 a[72:75], v[120:123], v[192:195], a[72:75]
  v_mfma_f32_16x16x32_bf16 a[76:79], v[120:123], v[196:199], a[76:79]
  v_mfma_f32_16x16x32_bf16 a[80:83], v[124:127], v[184:187], a[80:83]
  v_mfma_f32_16x16x32_bf16 a[84:87], v[124:127], v[188:191], a[84:87]
  v_mfma_f32_16x16x32_bf16 a[88:91], v[124:127], v[192:195], a[88:91]
  v_mfma_f32_16x16x32_bf16 a[92:95], v[124:127], v[196:199], a[92:95]
  v_mfma_f32_16x16x32_bf16 a[96:99], v[128:131], v[184:187], a[96:99]
  v_mfma_f32_16x16x32_bf16 a[100:103], v[128:131], v[188:191], a[100:103]
  v_mfma_f32_16x16x32_bf16 a[104:107], v[128:131], v[192:195], a[104:107]
  v_mfma_f32_16x16x32_bf16 a[108:111], v[128:131], v[196:199], a[108:111]
  v_mfma_f32_16x16x32_bf16 a[112:115], v[132:135], v[184:187], a[112:115]
  v_mfma_f32_16x16x32_bf16 a[116:119], v[132:135], v[188:191], a[116:119]
  v_mfma_f32_16x16x32_bf16 a[120:123], v[132:135], v[192:195], a[120:123]
  v_mfma_f32_16x16x32_bf16 a[124:127], v[132:135], v[196:199], a[124:127]
  v_mfma_f32_16x16x32_bf16 a[128:131], v[136:139], v[184:187], a[128:131]
  v_mfma_f32_16x16x32_bf16 a[132:135], v[136:139], v[188:191], a[132:135]
  v_mfma_f32_16x16x32_bf16 a[136:139], v[136:139], v[192:195], a[136:139]
  v_mfma_f32_16x16x32_bf16 a[140:143], v[136:139], v[196:199], a[140:143]
  v_mfma_f32_16x16x32_bf16 a[144:147], v[140:143], v[184:187], a[144:147]
  v_mfma_f32_16x16x32_bf16 a[148:151], v[140:143], v[188:191], a[148:151]
  v_mfma_f32_16x16x32_bf16 a[152:155], v[140:143], v[192:195], a[152:155]
  v_mfma_f32_16x16x32_bf16 a[156:159], v[140:143], v[196:199], a[156:159]
  buffer_load_dwordx4 v[104:107], v1, s[4:7], s30 offen offset:2048
  buffer_load_dwordx4 v[108:111], v1, s[4:7], s31 offen offset:2048
  buffer_load_dwordx4 v[112:115], v1, s[4:7], s32 offen offset:2048
  buffer_load_dwordx4 v[116:119], v1, s[4:7], s33 offen offset:2048
  buffer_load_dwordx4 v[120:123], v1, s[4:7], s34 offen offset:2048
  buffer_load_dwordx4 v[124:127], v1, s[4:7], s35 offen offset:2048
  buffer_load_dwordx4 v[128:131], v1, s[4:7], s36 offen offset:2048
  buffer_load_dwordx4 v[132:135], v1, s[4:7], s37 offen offset:2048
  buffer_load_dwordx4 v[136:139], v1, s[4:7], s38 offen offset:2048
  buffer_load_dwordx4 v[140:143], v1, s[4:7], s39 offen offset:2048
  s_waitcnt vmcnt(30)
  ds_read_b128 v[184:187], v1 offset:12288
  ds_read_b128 v[188:191], v1 offset:36864
  ds_read_b128 v[192:195], v6 offset:12288
  ds_read_b128 v[196:199], v6 offset:36864
  s_waitcnt lgkmcnt(4)
  v_mfma_f32_16x16x32_bf16 a[0:3], v[144:147], v[200:203], a[0:3]
  v_mfma_f32_16x16x32_bf16 a[4:7], v[144:147], v[204:207], a[4:7]
  v_mfma_f32_16x16x32_bf16 a[8:11], v[144:147], v[208:211], a[8:11]
  v_mfma_f32_16x16x32_bf16 a[12:15], v[144:147], v[212:215], a[12:15]
  v_mfma_f32_16x16x32_bf16 a[16:19], v[148:151], v[200:203], a[16:19]
  v_mfma_f32_16x16x32_bf16 a[20:23], v[148:151], v[204:207], a[20:23]
  v_mfma_f32_16x16x32_bf16 a[24:27], v[148:151], v[208:211], a[24:27]
  v_mfma_f32_16x16x32_bf16 a[28:31], v[148:151], v[212:215], a[28:31]
  v_mfma_f32_16x16x32_bf16 a[32:35], v[152:155], v[200:203], a[32:35]
  v_mfma_f32_16x16x32_bf16 a[36:39], v[152:155], v[204:207], a[36:39]
  v_mfma_f32_16x16x32_bf16 a[40:43], v[152:155], v[208:211], a[40:43]
  v_mfma_f32_16x16x32_bf16 a[44:47], v[152:155], v[212:215], a[44:47]
  v_mfma_f32_16x16x32_bf16 a[48:51], v[156:159], v[200:203], a[48:51]
  v_mfma_f32_16x16x32_bf16 a[52:55], v[156:159], v[204:207], a[52:55]
  v_mfma_f32_16x16x32_bf16 a[56:59], v[156:159], v[208:211], a[56:59]
  v_mfma_f32_16x16x32_bf16 a[60:63], v[156:159], v[212:215], a[60:63]
  v_mfma_f32_16x16x32_bf16 a[64:67], v[160:163], v[200:203], a[64:67]
  v_mfma_f32_16x16x32_bf16 a[68:71], v[160:163], v[204:207], a[68:71]
  v_mfma_f32_16x16x32_bf16 a[72:75], v[160:163], v[208:211], a[72:75]
  v_mfma_f32_16x16x32_bf16 a[76:79], v[160:163], v[212:215], a[76:79]
  v_mfma_f32_16x16x32_bf16 a[80:83], v[164:167], v[200:203], a[80:83]
  v_mfma_f32_16x16x32_bf16 a[84:87], v[164:167], v[204:207], a[84:87]
  v_mfma_f32_16x16x32_bf16 a[88:91], v[164:167], v[208:211], a[88:91]
  v_mfma_f32_16x16x32_bf16 a[92:95], v[164:167], v[212:215], a[92:95]
  v_mfma_f32_16x16x32_bf16 a[96:99], v[168:171], v[200:203], a[96:99]
  v_mfma_f32_16x16x32_bf16 a[100:103], v[168:171], v[204:207], a[100:103]
  v_mfma_f32_16x16x32_bf16 a[104:107], v[168:171], v[208:211], a[104:107]
  v_mfma_f32_16x16x32_bf16 a[108:111], v[168:171], v[212:215], a[108:111]
  v_mfma_f32_16x16x32_bf16 a[112:115], v[172:175], v[200:203], a[112:115]
  v_mfma_f32_16x16x32_bf16 a[116:119], v[172:175], v[204:207], a[116:119]
  v_mfma_f32_16x16x32_bf16 a[120:123], v[172:175], v[208:211], a[120:123]
  v_mfma_f32_16x16x32_bf16 a[124:127], v[172:175], v[212:215], a[124:127]
  v_mfma_f32_16x16x32_bf16 a[128:131], v[176:179], v[200:203], a[128:131]
  v_mfma_f32_16x16x32_bf16 a[132:135], v[176:179], v[204:207], a[132:135]
  v_mfma_f32_16x16x32_bf16 a[136:139], v[176:179], v[208:211], a[136:139]
  v_mfma_f32_16x16x32_bf16 a[140:143], v[176:179], v[212:215], a[140:143]
  v_mfma_f32_16x16x32_bf16 a[144:147], v[180:183], v[200:203], a[144:147]
  v_mfma_f32_16x16x32_bf16 a[148:151], v[180:183], v[204:207], a[148:151]
  v_mfma_f32_16x16x32_bf16 a[152:155], v[180:183], v[208:211], a[152:155]
  v_mfma_f32_16x16x32_bf16 a[156:159], v[180:183], v[212:215], a[156:159]
  buffer_load_dwordx4 v[144:147], v1, s[4:7], s30 offen offset:3072
  buffer_load_dwordx4 v[148:151], v1, s[4:7], s31 offen offset:3072
  buffer_load_dwordx4 v[152:155], v1, s[4:7], s32 offen offset:3072
  buffer_load_dwordx4 v[156:159], v1, s[4:7], s33 offen offset:3072
  buffer_load_dwordx4 v[160:163], v1, s[4:7], s34 offen offset:3072
  buffer_load_dwordx4 v[164:167], v1, s[4:7], s35 offen offset:3072
  buffer_load_dwordx4 v[168:171], v1, s[4:7], s36 offen offset:3072
  buffer_load_dwordx4 v[172:175], v1, s[4:7], s37 offen offset:3072
  buffer_load_dwordx4 v[176:179], v1, s[4:7], s38 offen offset:3072
  buffer_load_dwordx4 v[180:183], v1, s[4:7], s39 offen offset:3072
  s_add_u32 s30, s30, 4096
  s_add_u32 s31, s31, 4096
  s_add_u32 s32, s32, 4096
  s_add_u32 s33, s33, 4096
  s_add_u32 s34, s34, 4096
  s_add_u32 s35, s35, 4096
  s_add_u32 s36, s36, 4096
  s_add_u32 s37, s37, 4096
  s_add_u32 s38, s38, 4096
  s_add_u32 s39, s39, 4096
  s_waitcnt vmcnt(30)
  ds_read_b128 v[200:203], v1 offset:13312
  ds_read_b128 v[204:207], v1 offset:37888
  ds_read_b128 v[208:211], v6 offset:13312
  ds_read_b128 v[212:215], v6 offset:37888
  s_waitcnt lgkmcnt(4)
  v_mfma_f32_16x16x32_bf16 a[0:3], v[24:27], v[184:187], a[0:3]
  v_mfma_f32_16x16x32_bf16 a[4:7], v[24:27], v[188:191], a[4:7]
  v_mfma_f32_16x16x32_bf16 a[8:11], v[24:27], v[192:195], a[8:11]
  v_mfma_f32_16x16x32_bf16 a[12:15], v[24:27], v[196:199], a[12:15]
  v_mfma_f32_16x16x32_bf16 a[16:19], v[28:31], v[184:187], a[16:19]
  v_mfma_f32_16x16x32_bf16 a[20:23], v[28:31], v[188:191], a[20:23]
  v_mfma_f32_16x16x32_bf16 a[24:27], v[28:31], v[192:195], a[24:27]
  v_mfma_f32_16x16x32_bf16 a[28:31], v[28:31], v[196:199], a[28:31]
  v_mfma_f32_16x16x32_bf16 a[32:35], v[32:35], v[184:187], a[32:35]
  v_mfma_f32_16x16x32_bf16 a[36:39], v[32:35], v[188:191], a[36:39]
  v_mfma_f32_16x16x32_bf16 a[40:43], v[32:35], v[192:195], a[40:43]
  v_mfma_f32_16x16x32_bf16 a[44:47], v[32:35], v[196:199], a[44:47]
  v_mfma_f32_16x16x32_bf16 a[48:51], v[36:39], v[184:187], a[48:51]
  v_mfma_f32_16x16x32_bf16 a[52:55], v[36:39], v[188:191], a[52:55]
  v_mfma_f32_16x16x32_bf16 a[56:59], v[36:39], v[192:195], a[56:59]
  v_mfma_f32_16x16x32_bf16 a[60:63], v[36:39], v[196:199], a[60:63]
  v_mfma_f32_16x16x32_bf16 a[64:67], v[40:43], v[184:187], a[64:67]
  v_mfma_f32_16x16x32_bf16 a[68:71], v[40:43], v[188:191], a[68:71]
  v_mfma_f32_16x16x32_bf16 a[72:75], v[40:43], v[192:195], a[72:75]
  v_mfma_f32_16x16x32_bf16 a[76:79], v[40:43], v[196:199], a[76:79]
  v_mfma_f32_16x16x32_bf16 a[80:83], v[44:47], v[184:187], a[80:83]
  v_mfma_f32_16x16x32_bf16 a[84:87], v[44:47], v[188:191], a[84:87]
  v_mfma_f32_16x16x32_bf16 a[88:91], v[44:47], v[192:195], a[88:91]
  v_mfma_f32_16x16x32_bf16 a[92:95], v[44:47], v[196:199], a[92:95]
  v_mfma_f32_16x16x32_bf16 a[96:99], v[48:51], v[184:187], a[96:99]
  v_mfma_f32_16x16x32_bf16 a[100:103], v[48:51], v[188:191], a[100:103]
  v_mfma_f32_16x16x32_bf16 a[104:107], v[48:51], v[192:195], a[104:107]
  v_mfma_f32_16x16x32_bf16 a[108:111], v[48:51], v[196:199], a[108:111]
  v_mfma_f32_16x16x32_bf16 a[112:115], v[52:55], v[184:187], a[112:115]
  v_mfma_f32_16x16x32_bf16 a[116:119], v[52:55], v[188:191], a[116:119]
  v_mfma_f32_16x16x32_bf16 a[120:123], v[52:55], v[192:195], a[120:123]
  v_mfma_f32_16x16x32_bf16 a[124:127], v[52:55], v[196:199], a[124:127]
  v_mfma_f32_16x16x32_bf16 a[128:131], v[56:59], v[184:187], a[128:131]
  v_mfma_f32_16x16x32_bf16 a[132:135], v[56:59], v[188:191], a[132:135]
  v_mfma_f32_16x16x32_bf16 a[136:139], v[56:59], v[192:195], a[136:139]
  v_mfma_f32_16x16x32_bf16 a[140:143], v[56:59], v[196:199], a[140:143]
  v_mfma_f32_16x16x32_bf16 a[144:147], v[60:63], v[184:187], a[144:147]
  v_mfma_f32_16x16x32_bf16 a[148:151], v[60:63], v[188:191], a[148:151]
  v_mfma_f32_16x16x32_bf16 a[152:155], v[60:63], v[192:195], a[152:155]
  v_mfma_f32_16x16x32_bf16 a[156:159], v[60:63], v[196:199], a[156:159]
  buffer_load_dwordx4 v[24:27], v1, s[4:7], s30 offen offset:0
  buffer_load_dwordx4 v[28:31], v1, s[4:7], s31 offen offset:0
  buffer_load_dwordx4 v[32:35], v1, s[4:7], s32 offen offset:0
  buffer_load_dwordx4 v[36:39], v1, s[4:7], s33 offen offset:0
  buffer_load_dwordx4 v[40:43], v1, s[4:7], s34 offen offset:0
  buffer_load_dwordx4 v[44:47], v1, s[4:7], s35 offen offset:0
  buffer_load_dwordx4 v[48:51], v1, s[4:7], s36 offen offset:0
  buffer_load_dwordx4 v[52:55], v1, s[4:7], s37 offen offset:0
  buffer_load_dwordx4 v[56:59], v1, s[4:7], s38 offen offset:0
  buffer_load_dwordx4 v[60:63], v1, s[4:7], s39 offen offset:0
  s_waitcnt vmcnt(30)
  ds_read_b128 v[184:187], v1 offset:14336
  ds_read_b128 v[188:191], v1 offset:38912
  ds_read_b128 v[192:195], v6 offset:14336
  ds_read_b128 v[196:199], v6 offset:38912
  s_waitcnt lgkmcnt(4)
  v_mfma_f32_16x16x32_bf16 a[0:3], v[64:67], v[200:203], a[0:3]
  v_mfma_f32_16x16x32_bf16 a[4:7], v[64:67], v[204:207], a[4:7]
  v_mfma_f32_16x16x32_bf16 a[8:11], v[64:67], v[208:211], a[8:11]
  v_mfma_f32_16x16x32_bf16 a[12:15], v[64:67], v[212:215], a[12:15]
  v_mfma_f32_16x16x32_bf16 a[16:19], v[68:71], v[200:203], a[16:19]
  v_mfma_f32_16x16x32_bf16 a[20:23], v[68:71], v[204:207], a[20:23]
  v_mfma_f32_16x16x32_bf16 a[24:27], v[68:71], v[208:211], a[24:27]
  v_mfma_f32_16x16x32_bf16 a[28:31], v[68:71], v[212:215], a[28:31]
  v_mfma_f32_16x16x32_bf16 a[32:35], v[72:75], v[200:203], a[32:35]
  v_mfma_f32_16x16x32_bf16 a[36:39], v[72:75], v[204:207], a[36:39]
  v_mfma_f32_16x16x32_bf16 a[40:43], v[72:75], v[208:211], a[40:43]
  v_mfma_f32_16x16x32_bf16 a[44:47], v[72:75], v[212:215], a[44:47]
  v_mfma_f32_16x16x32_bf16 a[48:51], v[76:79], v[200:203], a[48:51]
  v_mfma_f32_16x16x32_bf16 a[52:55], v[76:79], v[204:207], a[52:55]
  v_mfma_f32_16x16x32_bf16 a[56:59], v[76:79], v[208:211], a[56:59]
  v_mfma_f32_16x16x32_bf16 a[60:63], v[76:79], v[212:215], a[60:63]
  v_mfma_f32_16x16x32_bf16 a[64:67], v[80:83], v[200:203], a[64:67]
  v_mfma_f32_16x16x32_bf16 a[68:71], v[80:83], v[204:207], a[68:71]
  v_mfma_f32_16x16x32_bf16 a[72:75], v[80:83], v[208:211], a[72:75]
  v_mfma_f32_16x16x32_bf16 a[76:79], v[80:83], v[212:215], a[76:79]
  v_mfma_f32_16x16x32_bf16 a[80:83], v[84:87], v[200:203], a[80:83]
  v_mfma_f32_16x16x32_bf16 a[84:87], v[84:87], v[204:207], a[84:87]
  v_mfma_f32_16x16x32_bf16 a[88:91], v[84:87], v[208:211], a[88:91]
  v_mfma_f32_16x16x32_bf16 a[92:95], v[84:87], v[212:215], a[92:95]
  v_mfma_f32_16x16x32_bf16 a[96:99], v[88:91], v[200:203], a[96:99]
  v_mfma_f32_16x16x32_bf16 a[100:103], v[88:91], v[204:207], a[100:103]
  v_mfma_f32_16x16x32_bf16 a[104:107], v[88:91], v[208:211], a[104:107]
  v_mfma_f32_16x16x32_bf16 a[108:111], v[88:91], v[212:215], a[108:111]
  v_mfma_f32_16x16x32_bf16 a[112:115], v[92:95], v[200:203], a[112:115]
  v_mfma_f32_16x16x32_bf16 a[116:119], v[92:95], v[204:207], a[116:119]
  v_mfma_f32_16x16x32_bf16 a[120:123], v[92:95], v[208:211], a[120:123]
  v_mfma_f32_16x16x32_bf16 a[124:127], v[92:95], v[212:215], a[124:127]
  v_mfma_f32_16x16x32_bf16 a[128:131], v[96:99], v[200:203], a[128:131]
  v_mfma_f32_16x16x32_bf16 a[132:135], v[96:99], v[204:207], a[132:135]
  v_mfma_f32_16x16x32_bf16 a[136:139], v[96:99], v[208:211], a[136:139]
  v_mfma_f32_16x16x32_bf16 a[140:143], v[96:99], v[212:215], a[140:143]
  v_mfma_f32_16x16x32_bf16 a[144:147], v[100:103], v[200:203], a[144:147]
  v_mfma_f32_16x16x32_bf16 a[148:151], v[100:103], v[204:207], a[148:151]
  v_mfma_f32_16x16x32_bf16 a[152:155], v[100:103], v[208:211], a[152:155]
  v_mfma_f32_16x16x32_bf16 a[156:159], v[100:103], v[212:215], a[156:159]
  buffer_load_dwordx4 v[64:67], v1, s[4:7], s30 offen offset:1024
  buffer_load_dwordx4 v[68:71], v1, s[4:7], s31 offen offset:1024
  buffer_load_dwordx4 v[72:75], v1, s[4:7], s32 offen offset:1024
  buffer_load_dwordx4 v[76:79], v1, s[4:7], s33 offen offset:1024
  buffer_load_dwordx4 v[80:83], v1, s[4:7], s34 offen offset:1024
  buffer_load_dwordx4 v[84:87], v1, s[4:7], s35 offen offset:1024
  buffer_load_dwordx4 v[88:91], v1, s[4:7], s36 offen offset:1024
  buffer_load_dwordx4 v[92:95], v1, s[4:7], s37 offen offset:1024
  buffer_load_dwordx4 v[96:99], v1, s[4:7], s38 offen offset:1024
  buffer_load_dwordx4 v[100:103], v1, s[4:7], s39 offen offset:1024
  s_waitcnt vmcnt(30)
  ds_read_b128 v[200:203], v1 offset:15360
  ds_read_b128 v[204:207], v1 offset:39936
  ds_read_b128 v[208:211], v6 offset:15360
  ds_read_b128 v[212:215], v6 offset:39936
  s_waitcnt lgkmcnt(4)
  v_mfma_f32_16x16x32_bf16 a[0:3], v[104:107], v[184:187], a[0:3]
  v_mfma_f32_16x16x32_bf16 a[4:7], v[104:107], v[188:191], a[4:7]
  v_mfma_f32_16x16x32_bf16 a[8:11], v[104:107], v[192:195], a[8:11]
  v_mfma_f32_16x16x32_bf16 a[12:15], v[104:107], v[196:199], a[12:15]
  v_mfma_f32_16x16x32_bf16 a[16:19], v[108:111], v[184:187], a[16:19]
  v_mfma_f32_16x16x32_bf16 a[20:23], v[108:111], v[188:191], a[20:23]
  v_mfma_f32_16x16x32_bf16 a[24:27], v[108:111], v[192:195], a[24:27]
  v_mfma_f32_16x16x32_bf16 a[28:31], v[108:111], v[196:199], a[28:31]
  v_mfma_f32_16x16x32_bf16 a[32:35], v[112:115], v[184:187], a[32:35]
  v_mfma_f32_16x16x32_bf16 a[36:39], v[112:115], v[188:191], a[36:39]
  v_mfma_f32_16x16x32_bf16 a[40:43], v[112:115], v[192:195], a[40:43]
  v_mfma_f32_16x16x32_bf16 a[44:47], v[112:115], v[196:199], a[44:47]
  v_mfma_f32_16x16x32_bf16 a[48:51], v[116:119], v[184:187], a[48:51]
  v_mfma_f32_16x16x32_bf16 a[52:55], v[116:119], v[188:191], a[52:55]
  v_mfma_f32_16x16x32_bf16 a[56:59], v[116:119], v[192:195], a[56:59]
  v_mfma_f32_16x16x32_bf16 a[60:63], v[116:119], v[196:199], a[60:63]
  v_mfma_f32_16x16x32_bf16 a[64:67], v[120:123], v[184:187], a[64:67]
  v_mfma_f32_16x16x32_bf16 a[68:71], v[120:123], v[188:191], a[68:71]
  v_mfma_f32_16x16x32_bf16 a[72:75], v[120:123], v[192:195], a[72:75]
  v_mfma_f32_16x16x32_bf16 a[76:79], v[120:123], v[196:199], a[76:79]
  v_mfma_f32_16x16x32_bf16 a[80:83], v[124:127], v[184:187], a[80:83]
  v_mfma_f32_16x16x32_bf16 a[84:87], v[124:127], v[188:191], a[84:87]
  v_mfma_f32_16x16x32_bf16 a[88:91], v[124:127], v[192:195], a[88:91]
  v_mfma_f32_16x16x32_bf16 a[92:95], v[124:127], v[196:199], a[92:95]
  v_mfma_f32_16x16x32_bf16 a[96:99], v[128:131], v[184:187], a[96:99]
  v_mfma_f32_16x16x32_bf16 a[100:103], v[128:131], v[188:191], a[100:103]
  v_mfma_f32_16x16x32_bf16 a[104:107], v[128:131], v[192:195], a[104:107]
  v_mfma_f32_16x16x32_bf16 a[108:111], v[128:131], v[196:199], a[108:111]
  v_mfma_f32_16x16x32_bf16 a[112:115], v[132:135], v[184:187], a[112:115]
  v_mfma_f32_16x16x32_bf16 a[116:119], v[132:135], v[188:191], a[116:119]
  v_mfma_f32_16x16x32_bf16 a[120:123], v[132:135], v[192:195], a[120:123]
  v_mfma_f32_16x16x32_bf16 a[124:127], v[132:135], v[196:199], a[124:127]
  v_mfma_f32_16x16x32_bf16 a[128:131], v[136:139], v[184:187], a[128:131]
  v_mfma_f32_16x16x32_bf16 a[132:135], v[136:139], v[188:191], a[132:135]
  v_mfma_f32_16x16x32_bf16 a[136:139], v[136:139], v[192:195], a[136:139]
  v_mfma_f32_16x16x32_bf16 a[140:143], v[136:139], v[196:199], a[140:143]
  v_mfma_f32_16x16x32_bf16 a[144:147], v[140:143], v[184:187], a[144:147]
  v_mfma_f32_16x16x32_bf16 a[148:151], v[140:143], v[188:191], a[148:151]
  v_mfma_f32_16x16x32_bf16 a[152:155], v[140:143], v[192:195], a[152:155]
  v_mfma_f32_16x16x32_bf16 a[156:159], v[140:143], v[196:199], a[156:159]
  buffer_load_dwordx4 v[104:107], v1, s[4:7], s30 offen offset:2048
  buffer_load_dwordx4 v[108:111], v1, s[4:7], s31 offen offset:2048
  buffer_load_dwordx4 v[112:115], v1, s[4:7], s32 offen offset:2048
  buffer_load_dwordx4 v[116:119], v1, s[4:7], s33 offen offset:2048
  buffer_load_dwordx4 v[120:123], v1, s[4:7], s34 offen offset:2048
  buffer_load_dwordx4 v[124:127], v1, s[4:7], s35 offen offset:2048
  buffer_load_dwordx4 v[128:131], v1, s[4:7], s36 offen offset:2048
  buffer_load_dwordx4 v[132:135], v1, s[4:7], s37 offen offset:2048
  buffer_load_dwordx4 v[136:139], v1, s[4:7], s38 offen offset:2048
  buffer_load_dwordx4 v[140:143], v1, s[4:7], s39 offen offset:2048
  s_waitcnt vmcnt(30)
  ds_read_b128 v[184:187], v1 offset:16384
  ds_read_b128 v[188:191], v1 offset:40960
  ds_read_b128 v[192:195], v6 offset:16384
  ds_read_b128 v[196:199], v6 offset:40960
  s_waitcnt lgkmcnt(4)
  v_mfma_f32_16x16x32_bf16 a[0:3], v[144:147], v[200:203], a[0:3]
  v_mfma_f32_16x16x32_bf16 a[4:7], v[144:147], v[204:207], a[4:7]
  v_mfma_f32_16x16x32_bf16 a[8:11], v[144:147], v[208:211], a[8:11]
  v_mfma_f32_16x16x32_bf16 a[12:15], v[144:147], v[212:215], a[12:15]
  v_mfma_f32_16x16x32_bf16 a[16:19], v[148:151], v[200:203], a[16:19]
  v_mfma_f32_16x16x32_bf16 a[20:23], v[148:151], v[204:207], a[20:23]
  v_mfma_f32_16x16x32_bf16 a[24:27], v[148:151], v[208:211], a[24:27]
  v_mfma_f32_16x16x32_bf16 a[28:31], v[148:151], v[212:215], a[28:31]
  v_mfma_f32_16x16x32_bf16 a[32:35], v[152:155], v[200:203], a[32:35]
  v_mfma_f32_16x16x32_bf16 a[36:39], v[152:155], v[204:207], a[36:39]
  v_mfma_f32_16x16x32_bf16 a[40:43], v[152:155], v[208:211], a[40:43]
  v_mfma_f32_16x16x32_bf16 a[44:47], v[152:155], v[212:215], a[44:47]
  v_mfma_f32_16x16x32_bf16 a[48:51], v[156:159], v[200:203], a[48:51]
  v_mfma_f32_16x16x32_bf16 a[52:55], v[156:159], v[204:207], a[52:55]
  v_mfma_f32_16x16x32_bf16 a[56:59], v[156:159], v[208:211], a[56:59]
  v_mfma_f32_16x16x32_bf16 a[60:63], v[156:159], v[212:215], a[60:63]
  v_mfma_f32_16x16x32_bf16 a[64:67], v[160:163], v[200:203], a[64:67]
  v_mfma_f32_16x16x32_bf16 a[68:71], v[160:163], v[204:207], a[68:71]
  v_mfma_f32_16x16x32_bf16 a[72:75], v[160:163], v[208:211], a[72:75]
  v_mfma_f32_16x16x32_bf16 a[76:79], v[160:163], v[212:215], a[76:79]
  v_mfma_f32_16x16x32_bf16 a[80:83], v[164:167], v[200:203], a[80:83]
  v_mfma_f32_16x16x32_bf16 a[84:87], v[164:167], v[204:207], a[84:87]
  v_mfma_f32_16x16x32_bf16 a[88:91], v[164:167], v[208:211], a[88:91]
  v_mfma_f32_16x16x32_bf16 a[92:95], v[164:167], v[212:215], a[92:95]
  v_mfma_f32_16x16x32_bf16 a[96:99], v[168:171], v[200:203], a[96:99]
  v_mfma_f32_16x16x32_bf16 a[100:103], v[168:171], v[204:207], a[100:103]
  v_mfma_f32_16x16x32_bf16 a[104:107], v[168:171], v[208:211], a[104:107]
  v_mfma_f32_16x16x32_bf16 a[108:111], v[168:171], v[212:215], a[108:111]
  v_mfma_f32_16x16x32_bf16 a[112:115], v[172:175], v[200:203], a[112:115]
  v_mfma_f32_16x16x32_bf16 a[116:119], v[172:175], v[204:207], a[116:119]
  v_mfma_f32_16x16x32_bf16 a[120:123], v[172:175], v[208:211], a[120:123]
  v_mfma_f32_16x16x32_bf16 a[124:127], v[172:175], v[212:215], a[124:127]
  v_mfma_f32_16x16x32_bf16 a[128:131], v[176:179], v[200:203], a[128:131]
  v_mfma_f32_16x16x32_bf16 a[132:135], v[176:179], v[204:207], a[132:135]
  v_mfma_f32_16x16x32_bf16 a[136:139], v[176:179], v[208:211], a[136:139]
  v_mfma_f32_16x16x32_bf16 a[140:143], v[176:179], v[212:215], a[140:143]
  v_mfma_f32_16x16x32_bf16 a[144:147], v[180:183], v[200:203], a[144:147]
  v_mfma_f32_16x16x32_bf16 a[148:151], v[180:183], v[204:207], a[148:151]
  v_mfma_f32_16x16x32_bf16 a[152:155], v[180:183], v[208:211], a[152:155]
  v_mfma_f32_16x16x32_bf16 a[156:159], v[180:183], v[212:215], a[156:159]
  buffer_load_dwordx4 v[144:147], v1, s[4:7], s30 offen offset:3072
  buffer_load_dwordx4 v[148:151], v1, s[4:7], s31 offen offset:3072
  buffer_load_dwordx4 v[152:155], v1, s[4:7], s32 offen offset:3072
  buffer_load_dwordx4 v[156:159], v1, s[4:7], s33 offen offset:3072
  buffer_load_dwordx4 v[160:163], v1, s[4:7], s34 offen offset:3072
  buffer_load_dwordx4 v[164:167], v1, s[4:7], s35 offen offset:3072
  buffer_load_dwordx4 v[168:171], v1, s[4:7], s36 offen offset:3072
  buffer_load_dwordx4 v[172:175], v1, s[4:7], s37 offen offset:3072
  buffer_load_dwordx4 v[176:179], v1, s[4:7], s38 offen offset:3072
  buffer_load_dwordx4 v[180:183], v1, s[4:7], s39 offen offset:3072
  s_add_u32 s30, s30, 4096
  s_add_u32 s31, s31, 4096
  s_add_u32 s32, s32, 4096
  s_add_u32 s33, s33, 4096
  s_add_u32 s34, s34, 4096
  s_add_u32 s35, s35, 4096
  s_add_u32 s36, s36, 4096
  s_add_u32 s37, s37, 4096
  s_add_u32 s38, s38, 4096
  s_add_u32 s39, s39, 4096
  s_waitcnt vmcnt(30)
  ds_read_b128 v[200:203], v1 offset:17408
  ds_read_b128 v[204:207], v1 offset:41984
  ds_read_b128 v[208:211], v6 offset:17408
  ds_read_b128 v[212:215], v6 offset:41984
  s_waitcnt lgkmcnt(4)
  v_mfma_f32_16x16x32_bf16 a[0:3], v[24:27], v[184:187], a[0:3]
  v_mfma_f32_16x16x32_bf16 a[4:7], v[24:27], v[188:191], a[4:7]
  v_mfma_f32_16x16x32_bf16 a[8:11], v[24:27], v[192:195], a[8:11]
  v_mfma_f32_16x16x32_bf16 a[12:15], v[24:27], v[196:199], a[12:15]
  v_mfma_f32_16x16x32_bf16 a[16:19], v[28:31], v[184:187], a[16:19]
  v_mfma_f32_16x16x32_bf16 a[20:23], v[28:31], v[188:191], a[20:23]
  v_mfma_f32_16x16x32_bf16 a[24:27], v[28:31], v[192:195], a[24:27]
  v_mfma_f32_16x16x32_bf16 a[28:31], v[28:31], v[196:199], a[28:31]
  v_mfma_f32_16x16x32_bf16 a[32:35], v[32:35], v[184:187], a[32:35]
  v_mfma_f32_16x16x32_bf16 a[36:39], v[32:35], v[188:191], a[36:39]
  v_mfma_f32_16x16x32_bf16 a[40:43], v[32:35], v[192:195], a[40:43]
  v_mfma_f32_16x16x32_bf16 a[44:47], v[32:35], v[196:199], a[44:47]
  v_mfma_f32_16x16x32_bf16 a[48:51], v[36:39], v[184:187], a[48:51]
  v_mfma_f32_16x16x32_bf16 a[52:55], v[36:39], v[188:191], a[52:55]
  v_mfma_f32_16x16x32_bf16 a[56:59], v[36:39], v[192:195], a[56:59]
  v_mfma_f32_16x16x32_bf16 a[60:63], v[36:39], v[196:199], a[60:63]
  v_mfma_f32_16x16x32_bf16 a[64:67], v[40:43], v[184:187], a[64:67]
  v_mfma_f32_16x16x32_bf16 a[68:71], v[40:43], v[188:191], a[68:71]
  v_mfma_f32_16x16x32_bf16 a[72:75], v[40:43], v[192:195], a[72:75]
  v_mfma_f32_16x16x32_bf16 a[76:79], v[40:43], v[196:199], a[76:79]
  v_mfma_f32_16x16x32_bf16 a[80:83], v[44:47], v[184:187], a[80:83]
  v_mfma_f32_16x16x32_bf16 a[84:87], v[44:47], v[188:191], a[84:87]
  v_mfma_f32_16x16x32_bf16 a[88:91], v[44:47], v[192:195], a[88:91]
  v_mfma_f32_16x16x32_bf16 a[92:95], v[44:47], v[196:199], a[92:95]
  v_mfma_f32_16x16x32_bf16 a[96:99], v[48:51], v[184:187], a[96:99]
  v_mfma_f32_16x16x32_bf16 a[100:103], v[48:51], v[188:191], a[100:103]
  v_mfma_f32_16x16x32_bf16 a[104:107], v[48:51], v[192:195], a[104:107]
  v_mfma_f32_16x16x32_bf16 a[108:111], v[48:51], v[196:199], a[108:111]
  v_mfma_f32_16x16x32_bf16 a[112:115], v[52:55], v[184:187], a[112:115]
  v_mfma_f32_16x16x32_bf16 a[116:119], v[52:55], v[188:191], a[116:119]
  v_mfma_f32_16x16x32_bf16 a[120:123], v[52:55], v[192:195], a[120:123]
  v_mfma_f32_16x16x32_bf16 a[124:127], v[52:55], v[196:199], a[124:127]
  v_mfma_f32_16x16x32_bf16 a[128:131], v[56:59], v[184:187], a[128:131]
  v_mfma_f32_16x16x32_bf16 a[132:135], v[56:59], v[188:191], a[132:135]
  v_mfma_f32_16x16x32_bf16 a[136:139], v[56:59], v[192:195], a[136:139]
  v_mfma_f32_16x16x32_bf16 a[140:143], v[56:59], v[196:199], a[140:143]
  v_mfma_f32_16x16x32_bf16 a[144:147], v[60:63], v[184:187], a[144:147]
  v_mfma_f32_16x16x32_bf16 a[148:151], v[60:63], v[188:191], a[148:151]
  v_mfma_f32_16x16x32_bf16 a[152:155], v[60:63], v[192:195], a[152:155]
  v_mfma_f32_16x16x32_bf16 a[156:159], v[60:63], v[196:199], a[156:159]
  buffer_load_dwordx4 v[24:27], v1, s[4:7], s30 offen offset:0
  buffer_load_dwordx4 v[28:31], v1, s[4:7], s31 offen offset:0
  buffer_load_dwordx4 v[32:35], v1, s[4:7], s32 offen offset:0
  buffer_load_dwordx4 v[36:39], v1, s[4:7], s33 offen offset:0
  buffer_load_dwordx4 v[40:43], v1, s[4:7], s34 offen offset:0
  buffer_load_dwordx4 v[44:47], v1, s[4:7], s35 offen offset:0
  buffer_load_dwordx4 v[48:51], v1, s[4:7], s36 offen offset:0
  buffer_load_dwordx4 v[52:55], v1, s[4:7], s37 offen offset:0
  buffer_load_dwordx4 v[56:59], v1, s[4:7], s38 offen offset:0
  buffer_load_dwordx4 v[60:63], v1, s[4:7], s39 offen offset:0
  s_waitcnt vmcnt(30)
  ds_read_b128 v[184:187], v1 offset:18432
  ds_read_b128 v[188:191], v1 offset:43008
  ds_read_b128 v[192:195], v6 offset:18432
  ds_read_b128 v[196:199], v6 offset:43008
  s_waitcnt lgkmcnt(4)
  v_mfma_f32_16x16x32_bf16 a[0:3], v[64:67], v[200:203], a[0:3]
  v_mfma_f32_16x16x32_bf16 a[4:7], v[64:67], v[204:207], a[4:7]
  v_mfma_f32_16x16x32_bf16 a[8:11], v[64:67], v[208:211], a[8:11]
  v_mfma_f32_16x16x32_bf16 a[12:15], v[64:67], v[212:215], a[12:15]
  v_mfma_f32_16x16x32_bf16 a[16:19], v[68:71], v[200:203], a[16:19]
  v_mfma_f32_16x16x32_bf16 a[20:23], v[68:71], v[204:207], a[20:23]
  v_mfma_f32_16x16x32_bf16 a[24:27], v[68:71], v[208:211], a[24:27]
  v_mfma_f32_16x16x32_bf16 a[28:31], v[68:71], v[212:215], a[28:31]
  v_mfma_f32_16x16x32_bf16 a[32:35], v[72:75], v[200:203], a[32:35]
  v_mfma_f32_16x16x32_bf16 a[36:39], v[72:75], v[204:207], a[36:39]
  v_mfma_f32_16x16x32_bf16 a[40:43], v[72:75], v[208:211], a[40:43]
  v_mfma_f32_16x16x32_bf16 a[44:47], v[72:75], v[212:215], a[44:47]
  v_mfma_f32_16x16x32_bf16 a[48:51], v[76:79], v[200:203], a[48:51]
  v_mfma_f32_16x16x32_bf16 a[52:55], v[76:79], v[204:207], a[52:55]
  v_mfma_f32_16x16x32_bf16 a[56:59], v[76:79], v[208:211], a[56:59]
  v_mfma_f32_16x16x32_bf16 a[60:63], v[76:79], v[212:215], a[60:63]
  v_mfma_f32_16x16x32_bf16 a[64:67], v[80:83], v[200:203], a[64:67]
  v_mfma_f32_16x16x32_bf16 a[68:71], v[80:83], v[204:207], a[68:71]
  v_mfma_f32_16x16x32_bf16 a[72:75], v[80:83], v[208:211], a[72:75]
  v_mfma_f32_16x16x32_bf16 a[76:79], v[80:83], v[212:215], a[76:79]
  v_mfma_f32_16x16x32_bf16 a[80:83], v[84:87], v[200:203], a[80:83]
  v_mfma_f32_16x16x32_bf16 a[84:87], v[84:87], v[204:207], a[84:87]
  v_mfma_f32_16x16x32_bf16 a[88:91], v[84:87], v[208:211], a[88:91]
  v_mfma_f32_16x16x32_bf16 a[92:95], v[84:87], v[212:215], a[92:95]
  v_mfma_f32_16x16x32_bf16 a[96:99], v[88:91], v[200:203], a[96:99]
  v_mfma_f32_16x16x32_bf16 a[100:103], v[88:91], v[204:207], a[100:103]
  v_mfma_f32_16x16x32_bf16 a[104:107], v[88:91], v[208:211], a[104:107]
  v_mfma_f32_16x16x32_bf16 a[108:111], v[88:91], v[212:215], a[108:111]
  v_mfma_f32_16x16x32_bf16 a[112:115], v[92:95], v[200:203], a[112:115]
  v_mfma_f32_16x16x32_bf16 a[116:119], v[92:95], v[204:207], a[116:119]
  v_mfma_f32_16x16x32_bf16 a[120:123], v[92:95], v[208:211], a[120:123]
  v_mfma_f32_16x16x32_bf16 a[124:127], v[92:95], v[212:215], a[124:127]
  v_mfma_f32_16x16x32_bf16 a[128:131], v[96:99], v[200:203], a[128:131]
  v_mfma_f32_16x16x32_bf16 a[132:135], v[96:99], v[204:207], a[132:135]
  v_mfma_f32_16x16x32_bf16 a[136:139], v[96:99], v[208:211], a[136:139]
  v_mfma_f32_16x16x32_bf16 a[140:143], v[96:99], v[212:215], a[140:143]
  v_mfma_f32_16x16x32_bf16 a[144:147], v[100:103], v[200:203], a[144:147]
  v_mfma_f32_16x16x32_bf16 a[148:151], v[100:103], v[204:207], a[148:151]
  v_mfma_f32_16x16x32_bf16 a[152:155], v[100:103], v[208:211], a[152:155]
  v_mfma_f32_16x16x32_bf16 a[156:159], v[100:103], v[212:215], a[156:159]
  buffer_load_dwordx4 v[64:67], v1, s[4:7], s30 offen offset:1024
  buffer_load_dwordx4 v[68:71], v1, s[4:7], s31 offen offset:1024
  buffer_load_dwordx4 v[72:75], v1, s[4:7], s32 offen offset:1024
  buffer_load_dwordx4 v[76:79], v1, s[4:7], s33 offen offset:1024
  buffer_load_dwordx4 v[80:83], v1, s[4:7], s34 offen offset:1024
  buffer_load_dwordx4 v[84:87], v1, s[4:7], s35 offen offset:1024
  buffer_load_dwordx4 v[88:91], v1, s[4:7], s36 offen offset:1024
  buffer_load_dwordx4 v[92:95], v1, s[4:7], s37 offen offset:1024
  buffer_load_dwordx4 v[96:99], v1, s[4:7], s38 offen offset:1024
  buffer_load_dwordx4 v[100:103], v1, s[4:7], s39 offen offset:1024
  s_waitcnt vmcnt(30)
  ds_read_b128 v[200:203], v1 offset:19456
  ds_read_b128 v[204:207], v1 offset:44032
  ds_read_b128 v[208:211], v6 offset:19456
  ds_read_b128 v[212:215], v6 offset:44032
  s_waitcnt lgkmcnt(4)
  v_mfma_f32_16x16x32_bf16 a[0:3], v[104:107], v[184:187], a[0:3]
  v_mfma_f32_16x16x32_bf16 a[4:7], v[104:107], v[188:191], a[4:7]
  v_mfma_f32_16x16x32_bf16 a[8:11], v[104:107], v[192:195], a[8:11]
  v_mfma_f32_16x16x32_bf16 a[12:15], v[104:107], v[196:199], a[12:15]
  v_mfma_f32_16x16x32_bf16 a[16:19], v[108:111], v[184:187], a[16:19]
  v_mfma_f32_16x16x32_bf16 a[20:23], v[108:111], v[188:191], a[20:23]
  v_mfma_f32_16x16x32_bf16 a[24:27], v[108:111], v[192:195], a[24:27]
  v_mfma_f32_16x16x32_bf16 a[28:31], v[108:111], v[196:199], a[28:31]
  v_mfma_f32_16x16x32_bf16 a[32:35], v[112:115], v[184:187], a[32:35]
  v_mfma_f32_16x16x32_bf16 a[36:39], v[112:115], v[188:191], a[36:39]
  v_mfma_f32_16x16x32_bf16 a[40:43], v[112:115], v[192:195], a[40:43]
  v_mfma_f32_16x16x32_bf16 a[44:47], v[112:115], v[196:199], a[44:47]
  v_mfma_f32_16x16x32_bf16 a[48:51], v[116:119], v[184:187], a[48:51]
  v_mfma_f32_16x16x32_bf16 a[52:55], v[116:119], v[188:191], a[52:55]
  v_mfma_f32_16x16x32_bf16 a[56:59], v[116:119], v[192:195], a[56:59]
  v_mfma_f32_16x16x32_bf16 a[60:63], v[116:119], v[196:199], a[60:63]
  v_mfma_f32_16x16x32_bf16 a[64:67], v[120:123], v[184:187], a[64:67]
  v_mfma_f32_16x16x32_bf16 a[68:71], v[120:123], v[188:191], a[68:71]
  v_mfma_f32_16x16x32_bf16 a[72:75], v[120:123], v[192:195], a[72:75]
  v_mfma_f32_16x16x32_bf16 a[76:79], v[120:123], v[196:199], a[76:79]
  v_mfma_f32_16x16x32_bf16 a[80:83], v[124:127], v[184:187], a[80:83]
  v_mfma_f32_16x16x32_bf16 a[84:87], v[124:127], v[188:191], a[84:87]
  v_mfma_f32_16x16x32_bf16 a[88:91], v[124:127], v[192:195], a[88:91]
  v_mfma_f32_16x16x32_bf16 a[92:95], v[124:127], v[196:199], a[92:95]
  v_mfma_f32_16x16x32_bf16 a[96:99], v[128:131], v[184:187], a[96:99]
  v_mfma_f32_16x16x32_bf16 a[100:103], v[128:131], v[188:191], a[100:103]
  v_mfma_f32_16x16x32_bf16 a[104:107], v[128:131], v[192:195], a[104:107]
  v_mfma_f32_16x16x32_bf16 a[108:111], v[128:131], v[196:199], a[108:111]
  v_mfma_f32_16x16x32_bf16 a[112:115], v[132:135], v[184:187], a[112:115]
  v_mfma_f32_16x16x32_bf16 a[116:119], v[132:135], v[188:191], a[116:119]
  v_mfma_f32_16x16x32_bf16 a[120:123], v[132:135], v[192:195], a[120:123]
  v_mfma_f32_16x16x32_bf16 a[124:127], v[132:135], v[196:199], a[124:127]
  v_mfma_f32_16x16x32_bf16 a[128:131], v[136:139], v[184:187], a[128:131]
  v_mfma_f32_16x16x32_bf16 a[132:135], v[136:139], v[188:191], a[132:135]
  v_mfma_f32_16x16x32_bf16 a[136:139], v[136:139], v[192:195], a[136:139]
  v_mfma_f32_16x16x32_bf16 a[140:143], v[136:139], v[196:199], a[140:143]
  v_mfma_f32_16x16x32_bf16 a[144:147], v[140:143], v[184:187], a[144:147]
  v_mfma_f32_16x16x32_bf16 a[148:151], v[140:143], v[188:191], a[148:151]
  v_mfma_f32_16x16x32_bf16 a[152:155], v[140:143], v[192:195], a[152:155]
  v_mfma_f32_16x16x32_bf16 a[156:159], v[140:143], v[196:199], a[156:159]
  buffer_load_dwordx4 v[104:107], v1, s[4:7], s30 offen offset:2048
  buffer_load_dwordx4 v[108:111], v1, s[4:7], s31 offen offset:2048
  buffer_load_dwordx4 v[112:115], v1, s[4:7], s32 offen offset:2048
  buffer_load_dwordx4 v[116:119], v1, s[4:7], s33 offen offset:2048
  buffer_load_dwordx4 v[120:123], v1, s[4:7], s34 offen offset:2048
  buffer_load_dwordx4 v[124:127], v1, s[4:7], s35 offen offset:2048
  buffer_load_dwordx4 v[128:131], v1, s[4:7], s36 offen offset:2048
  buffer_load_dwordx4 v[132:135], v1, s[4:7], s37 offen offset:2048
  buffer_load_dwordx4 v[136:139], v1, s[4:7], s38 offen offset:2048
  buffer_load_dwordx4 v[140:143], v1, s[4:7], s39 offen offset:2048
  s_waitcnt vmcnt(30)
  ds_read_b128 v[184:187], v1 offset:20480
  ds_read_b128 v[188:191], v1 offset:45056
  ds_read_b128 v[192:195], v6 offset:20480
  ds_read_b128 v[196:199], v6 offset:45056
  s_waitcnt lgkmcnt(4)
  v_mfma_f32_16x16x32_bf16 a[0:3], v[144:147], v[200:203], a[0:3]
  v_mfma_f32_16x16x32_bf16 a[4:7], v[144:147], v[204:207], a[4:7]
  v_mfma_f32_16x16x32_bf16 a[8:11], v[144:147], v[208:211], a[8:11]
  v_mfma_f32_16x16x32_bf16 a[12:15], v[144:147], v[212:215], a[12:15]
  v_mfma_f32_16x16x32_bf16 a[16:19], v[148:151], v[200:203], a[16:19]
  v_mfma_f32_16x16x32_bf16 a[20:23], v[148:151], v[204:207], a[20:23]
  v_mfma_f32_16x16x32_bf16 a[24:27], v[148:151], v[208:211], a[24:27]
  v_mfma_f32_16x16x32_bf16 a[28:31], v[148:151], v[212:215], a[28:31]
  v_mfma_f32_16x16x32_bf16 a[32:35], v[152:155], v[200:203], a[32:35]
  v_mfma_f32_16x16x32_bf16 a[36:39], v[152:155], v[204:207], a[36:39]
  v_mfma_f32_16x16x32_bf16 a[40:43], v[152:155], v[208:211], a[40:43]
  v_mfma_f32_16x16x32_bf16 a[44:47], v[152:155], v[212:215], a[44:47]
  v_mfma_f32_16x16x32_bf16 a[48:51], v[156:159], v[200:203], a[48:51]
  v_mfma_f32_16x16x32_bf16 a[52:55], v[156:159], v[204:207], a[52:55]
  v_mfma_f32_16x16x32_bf16 a[56:59], v[156:159], v[208:211], a[56:59]
  v_mfma_f32_16x16x32_bf16 a[60:63], v[156:159], v[212:215], a[60:63]
  v_mfma_f32_16x16x32_bf16 a[64:67], v[160:163], v[200:203], a[64:67]
  v_mfma_f32_16x16x32_bf16 a[68:71], v[160:163], v[204:207], a[68:71]
  v_mfma_f32_16x16x32_bf16 a[72:75], v[160:163], v[208:211], a[72:75]
  v_mfma_f32_16x16x32_bf16 a[76:79], v[160:163], v[212:215], a[76:79]
  v_mfma_f32_16x16x32_bf16 a[80:83], v[164:167], v[200:203], a[80:83]
  v_mfma_f32_16x16x32_bf16 a[84:87], v[164:167], v[204:207], a[84:87]
  v_mfma_f32_16x16x32_bf16 a[88:91], v[164:167], v[208:211], a[88:91]
  v_mfma_f32_16x16x32_bf16 a[92:95], v[164:167], v[212:215], a[92:95]
  v_mfma_f32_16x16x32_bf16 a[96:99], v[168:171], v[200:203], a[96:99]
  v_mfma_f32_16x16x32_bf16 a[100:103], v[168:171], v[204:207], a[100:103]
  v_mfma_f32_16x16x32_bf16 a[104:107], v[168:171], v[208:211], a[104:107]
  v_mfma_f32_16x16x32_bf16 a[108:111], v[168:171], v[212:215], a[108:111]
  v_mfma_f32_16x16x32_bf16 a[112:115], v[172:175], v[200:203], a[112:115]
  v_mfma_f32_16x16x32_bf16 a[116:119], v[172:175], v[204:207], a[116:119]
  v_mfma_f32_16x16x32_bf16 a[120:123], v[172:175], v[208:211], a[120:123]
  v_mfma_f32_16x16x32_bf16 a[124:127], v[172:175], v[212:215], a[124:127]
  v_mfma_f32_16x16x32_bf16 a[128:131], v[176:179], v[200:203], a[128:131]
  v_mfma_f32_16x16x32_bf16 a[132:135], v[176:179], v[204:207], a[132:135]
  v_mfma_f32_16x16x32_bf16 a[136:139], v[176:179], v[208:211], a[136:139]
  v_mfma_f32_16x16x32_bf16 a[140:143], v[176:179], v[212:215], a[140:143]
  v_mfma_f32_16x16x32_bf16 a[144:147], v[180:183], v[200:203], a[144:147]
  v_mfma_f32_16x16x32_bf16 a[148:151], v[180:183], v[204:207], a[148:151]
  v_mfma_f32_16x16x32_bf16 a[152:155], v[180:183], v[208:211], a[152:155]
  v_mfma_f32_16x16x32_bf16 a[156:159], v[180:183], v[212:215], a[156:159]
  buffer_load_dwordx4 v[144:147], v1, s[4:7], s30 offen offset:3072
  buffer_load_dwordx4 v[148:151], v1, s[4:7], s31 offen offset:3072
  buffer_load_dwordx4 v[152:155], v1, s[4:7], s32 offen offset:3072
  buffer_load_dwordx4 v[156:159], v1, s[4:7], s33 offen offset:3072
  buffer_load_dwordx4 v[160:163], v1, s[4:7], s34 offen offset:3072
  buffer_load_dwordx4 v[164:167], v1, s[4:7], s35 offen offset:3072
  buffer_load_dwordx4 v[168:171], v1, s[4:7], s36 offen offset:3072
  buffer_load_dwordx4 v[172:175], v1, s[4:7], s37 offen offset:3072
  buffer_load_dwordx4 v[176:179], v1, s[4:7], s38 offen offset:3072
  buffer_load_dwordx4 v[180:183], v1, s[4:7], s39 offen offset:3072
  s_add_u32 s30, s30, 4096
  s_add_u32 s31, s31, 4096
  s_add_u32 s32, s32, 4096
  s_add_u32 s33, s33, 4096
  s_add_u32 s34, s34, 4096
  s_add_u32 s35, s35, 4096
  s_add_u32 s36, s36, 4096
  s_add_u32 s37, s37, 4096
  s_add_u32 s38, s38, 4096
  s_add_u32 s39, s39, 4096
  s_waitcnt vmcnt(30)
  ds_read_b128 v[200:203], v1 offset:21504
  ds_read_b128 v[204:207], v1 offset:46080
  ds_read_b128 v[208:211], v6 offset:21504
  ds_read_b128 v[212:215], v6 offset:46080
  s_waitcnt lgkmcnt(4)
  v_mfma_f32_16x16x32_bf16 a[0:3], v[24:27], v[184:187], a[0:3]
  v_mfma_f32_16x16x32_bf16 a[4:7], v[24:27], v[188:191], a[4:7]
  v_mfma_f32_16x16x32_bf16 a[8:11], v[24:27], v[192:195], a[8:11]
  v_mfma_f32_16x16x32_bf16 a[12:15], v[24:27], v[196:199], a[12:15]
  v_mfma_f32_16x16x32_bf16 a[16:19], v[28:31], v[184:187], a[16:19]
  v_mfma_f32_16x16x32_bf16 a[20:23], v[28:31], v[188:191], a[20:23]
  v_mfma_f32_16x16x32_bf16 a[24:27], v[28:31], v[192:195], a[24:27]
  v_mfma_f32_16x16x32_bf16 a[28:31], v[28:31], v[196:199], a[28:31]
  v_mfma_f32_16x16x32_bf16 a[32:35], v[32:35], v[184:187], a[32:35]
  v_mfma_f32_16x16x32_bf16 a[36:39], v[32:35], v[188:191], a[36:39]
  v_mfma_f32_16x16x32_bf16 a[40:43], v[32:35], v[192:195], a[40:43]
  v_mfma_f32_16x16x32_bf16 a[44:47], v[32:35], v[196:199], a[44:47]
  v_mfma_f32_16x16x32_bf16 a[48:51], v[36:39], v[184:187], a[48:51]
  v_mfma_f32_16x16x32_bf16 a[52:55], v[36:39], v[188:191], a[52:55]
  v_mfma_f32_16x16x32_bf16 a[56:59], v[36:39], v[192:195], a[56:59]
  v_mfma_f32_16x16x32_bf16 a[60:63], v[36:39], v[196:199], a[60:63]
  v_mfma_f32_16x16x32_bf16 a[64:67], v[40:43], v[184:187], a[64:67]
  v_mfma_f32_16x16x32_bf16 a[68:71], v[40:43], v[188:191], a[68:71]
  v_mfma_f32_16x16x32_bf16 a[72:75], v[40:43], v[192:195], a[72:75]
  v_mfma_f32_16x16x32_bf16 a[76:79], v[40:43], v[196:199], a[76:79]
  v_mfma_f32_16x16x32_bf16 a[80:83], v[44:47], v[184:187], a[80:83]
  v_mfma_f32_16x16x32_bf16 a[84:87], v[44:47], v[188:191], a[84:87]
  v_mfma_f32_16x16x32_bf16 a[88:91], v[44:47], v[192:195], a[88:91]
  v_mfma_f32_16x16x32_bf16 a[92:95], v[44:47], v[196:199], a[92:95]
  v_mfma_f32_16x16x32_bf16 a[96:99], v[48:51], v[184:187], a[96:99]
  v_mfma_f32_16x16x32_bf16 a[100:103], v[48:51], v[188:191], a[100:103]
  v_mfma_f32_16x16x32_bf16 a[104:107], v[48:51], v[192:195], a[104:107]
  v_mfma_f32_16x16x32_bf16 a[108:111], v[48:51], v[196:199], a[108:111]
  v_mfma_f32_16x16x32_bf16 a[112:115], v[52:55], v[184:187], a[112:115]
  v_mfma_f32_16x16x32_bf16 a[116:119], v[52:55], v[188:191], a[116:119]
  v_mfma_f32_16x16x32_bf16 a[120:123], v[52:55], v[192:195], a[120:123]
  v_mfma_f32_16x16x32_bf16 a[124:127], v[52:55], v[196:199], a[124:127]
  v_mfma_f32_16x16x32_bf16 a[128:131], v[56:59], v[184:187], a[128:131]
  v_mfma_f32_16x16x32_bf16 a[132:135], v[56:59], v[188:191], a[132:135]
  v_mfma_f32_16x16x32_bf16 a[136:139], v[56:59], v[192:195], a[136:139]
  v_mfma_f32_16x16x32_bf16 a[140:143], v[56:59], v[196:199], a[140:143]
  v_mfma_f32_16x16x32_bf16 a[144:147], v[60:63], v[184:187], a[144:147]
  v_mfma_f32_16x16x32_bf16 a[148:151], v[60:63], v[188:191], a[148:151]
  v_mfma_f32_16x16x32_bf16 a[152:155], v[60:63], v[192:195], a[152:155]
  v_mfma_f32_16x16x32_bf16 a[156:159], v[60:63], v[196:199], a[156:159]
  s_waitcnt vmcnt(20)
  ds_read_b128 v[184:187], v1 offset:22528
  ds_read_b128 v[188:191], v1 offset:47104
  ds_read_b128 v[192:195], v6 offset:22528
  ds_read_b128 v[196:199], v6 offset:47104
  s_waitcnt lgkmcnt(4)
  v_mfma_f32_16x16x32_bf16 a[0:3], v[64:67], v[200:203], a[0:3]
  v_mfma_f32_16x16x32_bf16 a[4:7], v[64:67], v[204:207], a[4:7]
  v_mfma_f32_16x16x32_bf16 a[8:11], v[64:67], v[208:211], a[8:11]
  v_mfma_f32_16x16x32_bf16 a[12:15], v[64:67], v[212:215], a[12:15]
  v_mfma_f32_16x16x32_bf16 a[16:19], v[68:71], v[200:203], a[16:19]
  v_mfma_f32_16x16x32_bf16 a[20:23], v[68:71], v[204:207], a[20:23]
  v_mfma_f32_16x16x32_bf16 a[24:27], v[68:71], v[208:211], a[24:27]
  v_mfma_f32_16x16x32_bf16 a[28:31], v[68:71], v[212:215], a[28:31]
  v_mfma_f32_16x16x32_bf16 a[32:35], v[72:75], v[200:203], a[32:35]
  v_mfma_f32_16x16x32_bf16 a[36:39], v[72:75], v[204:207], a[36:39]
  v_mfma_f32_16x16x32_bf16 a[40:43], v[72:75], v[208:211], a[40:43]
  v_mfma_f32_16x16x32_bf16 a[44:47], v[72:75], v[212:215], a[44:47]
  v_mfma_f32_16x16x32_bf16 a[48:51], v[76:79], v[200:203], a[48:51]
  v_mfma_f32_16x16x32_bf16 a[52:55], v[76:79], v[204:207], a[52:55]
  v_mfma_f32_16x16x32_bf16 a[56:59], v[76:79], v[208:211], a[56:59]
  v_mfma_f32_16x16x32_bf16 a[60:63], v[76:79], v[212:215], a[60:63]
  v_mfma_f32_16x16x32_bf16 a[64:67], v[80:83], v[200:203], a[64:67]
  v_mfma_f32_16x16x32_bf16 a[68:71], v[80:83], v[204:207], a[68:71]
  v_mfma_f32_16x16x32_bf16 a[72:75], v[80:83], v[208:211], a[72:75]
  v_mfma_f32_16x16x32_bf16 a[76:79], v[80:83], v[212:215], a[76:79]
  v_mfma_f32_16x16x32_bf16 a[80:83], v[84:87], v[200:203], a[80:83]
  v_mfma_f32_16x16x32_bf16 a[84:87], v[84:87], v[204:207], a[84:87]
  v_mfma_f32_16x16x32_bf16 a[88:91], v[84:87], v[208:211], a[88:91]
  v_mfma_f32_16x16x32_bf16 a[92:95], v[84:87], v[212:215], a[92:95]
  v_mfma_f32_16x16x32_bf16 a[96:99], v[88:91], v[200:203], a[96:99]
  v_mfma_f32_16x16x32_bf16 a[100:103], v[88:91], v[204:207], a[100:103]
  v_mfma_f32_16x16x32_bf16 a[104:107], v[88:91], v[208:211], a[104:107]
  v_mfma_f32_16x16x32_bf16 a[108:111], v[88:91], v[212:215], a[108:111]
  v_mfma_f32_16x16x32_bf16 a[112:115], v[92:95], v[200:203], a[112:115]
  v_mfma_f32_16x16x32_bf16 a[116:119], v[92:95], v[204:207], a[116:119]
  v_mfma_f32_16x16x32_bf16 a[120:123], v[92:95], v[208:211], a[120:123]
  v_mfma_f32_16x16x32_bf16 a[124:127], v[92:95], v[212:215], a[124:127]
  v_mfma_f32_16x16x32_bf16 a[128:131], v[96:99], v[200:203], a[128:131]
  v_mfma_f32_16x16x32_bf16 a[132:135], v[96:99], v[204:207], a[132:135]
  v_mfma_f32_16x16x32_bf16 a[136:139], v[96:99], v[208:211], a[136:139]
  v_mfma_f32_16x16x32_bf16 a[140:143], v[96:99], v[212:215], a[140:143]
  v_mfma_f32_16x16x32_bf16 a[144:147], v[100:103], v[200:203], a[144:147]
  v_mfma_f32_16x16x32_bf16 a[148:151], v[100:103], v[204:207], a[148:151]
  v_mfma_f32_16x16x32_bf16 a[152:155], v[100:103], v[208:211], a[152:155]
  v_mfma_f32_16x16x32_bf16 a[156:159], v[100:103], v[212:215], a[156:159]
  s_waitcnt vmcnt(10)
  ds_read_b128 v[200:203], v1 offset:23552
  ds_read_b128 v[204:207], v1 offset:48128
  ds_read_b128 v[208:211], v6 offset:23552
  ds_read_b128 v[212:215], v6 offset:48128
  s_waitcnt lgkmcnt(4)
  v_mfma_f32_16x16x32_bf16 a[0:3], v[104:107], v[184:187], a[0:3]
  v_mfma_f32_16x16x32_bf16 a[4:7], v[104:107], v[188:191], a[4:7]
  v_mfma_f32_16x16x32_bf16 a[8:11], v[104:107], v[192:195], a[8:11]
  v_mfma_f32_16x16x32_bf16 a[12:15], v[104:107], v[196:199], a[12:15]
  v_mfma_f32_16x16x32_bf16 a[16:19], v[108:111], v[184:187], a[16:19]
  v_mfma_f32_16x16x32_bf16 a[20:23], v[108:111], v[188:191], a[20:23]
  v_mfma_f32_16x16x32_bf16 a[24:27], v[108:111], v[192:195], a[24:27]
  v_mfma_f32_16x16x32_bf16 a[28:31], v[108:111], v[196:199], a[28:31]
  v_mfma_f32_16x16x32_bf16 a[32:35], v[112:115], v[184:187], a[32:35]
  v_mfma_f32_16x16x32_bf16 a[36:39], v[112:115], v[188:191], a[36:39]
  v_mfma_f32_16x16x32_bf16 a[40:43], v[112:115], v[192:195], a[40:43]
  v_mfma_f32_16x16x32_bf16 a[44:47], v[112:115], v[196:199], a[44:47]
  v_mfma_f32_16x16x32_bf16 a[48:51], v[116:119], v[184:187], a[48:51]
  v_mfma_f32_16x16x32_bf16 a[52:55], v[116:119], v[188:191], a[52:55]
  v_mfma_f32_16x16x32_bf16 a[56:59], v[116:119], v[192:195], a[56:59]
  v_mfma_f32_16x16x32_bf16 a[60:63], v[116:119], v[196:199], a[60:63]
  v_mfma_f32_16x16x32_bf16 a[64:67], v[120:123], v[184:187], a[64:67]
  v_mfma_f32_16x16x32_bf16 a[68:71], v[120:123], v[188:191], a[68:71]
  v_mfma_f32_16x16x32_bf16 a[72:75], v[120:123], v[192:195], a[72:75]
  v_mfma_f32_16x16x32_bf16 a[76:79], v[120:123], v[196:199], a[76:79]
  v_mfma_f32_16x16x32_bf16 a[80:83], v[124:127], v[184:187], a[80:83]
  v_mfma_f32_16x16x32_bf16 a[84:87], v[124:127], v[188:191], a[84:87]
  v_mfma_f32_16x16x32_bf16 a[88:91], v[124:127], v[192:195], a[88:91]
  v_mfma_f32_16x16x32_bf16 a[92:95], v[124:127], v[196:199], a[92:95]
  v_mfma_f32_16x16x32_bf16 a[96:99], v[128:131], v[184:187], a[96:99]
  v_mfma_f32_16x16x32_bf16 a[100:103], v[128:131], v[188:191], a[100:103]
  v_mfma_f32_16x16x32_bf16 a[104:107], v[128:131], v[192:195], a[104:107]
  v_mfma_f32_16x16x32_bf16 a[108:111], v[128:131], v[196:199], a[108:111]
  v_mfma_f32_16x16x32_bf16 a[112:115], v[132:135], v[184:187], a[112:115]
  v_mfma_f32_16x16x32_bf16 a[116:119], v[132:135], v[188:191], a[116:119]
  v_mfma_f32_16x16x32_bf16 a[120:123], v[132:135], v[192:195], a[120:123]
  v_mfma_f32_16x16x32_bf16 a[124:127], v[132:135], v[196:199], a[124:127]
  v_mfma_f32_16x16x32_bf16 a[128:131], v[136:139], v[184:187], a[128:131]
  v_mfma_f32_16x16x32_bf16 a[132:135], v[136:139], v[188:191], a[132:135]
  v_mfma_f32_16x16x32_bf16 a[136:139], v[136:139], v[192:195], a[136:139]
  v_mfma_f32_16x16x32_bf16 a[140:143], v[136:139], v[196:199], a[140:143]
  v_mfma_f32_16x16x32_bf16 a[144:147], v[140:143], v[184:187], a[144:147]
  v_mfma_f32_16x16x32_bf16 a[148:151], v[140:143], v[188:191], a[148:151]
  v_mfma_f32_16x16x32_bf16 a[152:155], v[140:143], v[192:195], a[152:155]
  v_mfma_f32_16x16x32_bf16 a[156:159], v[140:143], v[196:199], a[156:159]
  s_waitcnt vmcnt(0)
  s_waitcnt lgkmcnt(0)
  v_mfma_f32_16x16x32_bf16 a[0:3], v[144:147], v[200:203], a[0:3]
  v_mfma_f32_16x16x32_bf16 a[4:7], v[144:147], v[204:207], a[4:7]
  v_mfma_f32_16x16x32_bf16 a[8:11], v[144:147], v[208:211], a[8:11]
  v_mfma_f32_16x16x32_bf16 a[12:15], v[144:147], v[212:215], a[12:15]
  v_mfma_f32_16x16x32_bf16 a[16:19], v[148:151], v[200:203], a[16:19]
  v_mfma_f32_16x16x32_bf16 a[20:23], v[148:151], v[204:207], a[20:23]
  v_mfma_f32_16x16x32_bf16 a[24:27], v[148:151], v[208:211], a[24:27]
  v_mfma_f32_16x16x32_bf16 a[28:31], v[148:151], v[212:215], a[28:31]
  v_mfma_f32_16x16x32_bf16 a[32:35], v[152:155], v[200:203], a[32:35]
  v_mfma_f32_16x16x32_bf16 a[36:39], v[152:155], v[204:207], a[36:39]
  v_mfma_f32_16x16x32_bf16 a[40:43], v[152:155], v[208:211], a[40:43]
  v_mfma_f32_16x16x32_bf16 a[44:47], v[152:155], v[212:215], a[44:47]
  v_mfma_f32_16x16x32_bf16 a[48:51], v[156:159], v[200:203], a[48:51]
  v_mfma_f32_16x16x32_bf16 a[52:55], v[156:159], v[204:207], a[52:55]
  v_mfma_f32_16x16x32_bf16 a[56:59], v[156:159], v[208:211], a[56:59]
  v_mfma_f32_16x16x32_bf16 a[60:63], v[156:159], v[212:215], a[60:63]
  v_mfma_f32_16x16x32_bf16 a[64:67], v[160:163], v[200:203], a[64:67]
  v_mfma_f32_16x16x32_bf16 a[68:71], v[160:163], v[204:207], a[68:71]
  v_mfma_f32_16x16x32_bf16 a[72:75], v[160:163], v[208:211], a[72:75]
  v_mfma_f32_16x16x32_bf16 a[76:79], v[160:163], v[212:215], a[76:79]
  v_mfma_f32_16x16x32_bf16 a[80:83], v[164:167], v[200:203], a[80:83]
  v_mfma_f32_16x16x32_bf16 a[84:87], v[164:167], v[204:207], a[84:87]
  v_mfma_f32_16x16x32_bf16 a[88:91], v[164:167], v[208:211], a[88:91]
  v_mfma_f32_16x16x32_bf16 a[92:95], v[164:167], v[212:215], a[92:95]
  v_mfma_f32_16x16x32_bf16 a[96:99], v[168:171], v[200:203], a[96:99]
  v_mfma_f32_16x16x32_bf16 a[100:103], v[168:171], v[204:207], a[100:103]
  v_mfma_f32_16x16x32_bf16 a[104:107], v[168:171], v[208:211], a[104:107]
  v_mfma_f32_16x16x32_bf16 a[108:111], v[168:171], v[212:215], a[108:111]
  v_mfma_f32_16x16x32_bf16 a[112:115], v[172:175], v[200:203], a[112:115]
  v_mfma_f32_16x16x32_bf16 a[116:119], v[172:175], v[204:207], a[116:119]
  v_mfma_f32_16x16x32_bf16 a[120:123], v[172:175], v[208:211], a[120:123]
  v_mfma_f32_16x16x32_bf16 a[124:127], v[172:175], v[212:215], a[124:127]
  v_mfma_f32_16x16x32_bf16 a[128:131], v[176:179], v[200:203], a[128:131]
  v_mfma_f32_16x16x32_bf16 a[132:135], v[176:179], v[204:207], a[132:135]
  v_mfma_f32_16x16x32_bf16 a[136:139], v[176:179], v[208:211], a[136:139]
  v_mfma_f32_16x16x32_bf16 a[140:143], v[176:179], v[212:215], a[140:143]
  v_mfma_f32_16x16x32_bf16 a[144:147], v[180:183], v[200:203], a[144:147]
  v_mfma_f32_16x16x32_bf16 a[148:151], v[180:183], v[204:207], a[148:151]
  v_mfma_f32_16x16x32_bf16 a[152:155], v[180:183], v[208:211], a[152:155]
  v_mfma_f32_16x16x32_bf16 a[156:159], v[180:183], v[212:215], a[156:159]
  s_lshl_b32 s16, s13, 7
  s_lshl_b32 s17, s14, 2
  s_add_u32 s16, s16, s17
  s_mul_i32 s16, s16, 20
  s_mul_i32 s17, s12, 5
  s_add_u32 s16, s16, s17
  s_lshl_b32 s16, s16, 10
  s_add_u32 s16, s16, 92798976
  s_nop 7
  s_add_u32 s17, s16, 0
  v_accvgpr_read_b32 v24, a0
  v_accvgpr_read_b32 v25, a1
  v_accvgpr_read_b32 v26, a2
  v_accvgpr_read_b32 v27, a3
  v_accvgpr_read_b32 v28, a16
  v_accvgpr_read_b32 v29, a17
  v_accvgpr_read_b32 v30, a18
  v_accvgpr_read_b32 v31, a19
  v_cvt_pk_bf16_f32 v32, v24, v25
  v_cvt_pk_bf16_f32 v33, v26, v27
  v_cvt_pk_bf16_f32 v34, v28, v29
  v_cvt_pk_bf16_f32 v35, v30, v31
  buffer_store_dwordx4 v[32:35], v1, s[4:7], s17 offen offset:0 sc1
  v_accvgpr_read_b32 v36, a32
  v_accvgpr_read_b32 v37, a33
  v_accvgpr_read_b32 v38, a34
  v_accvgpr_read_b32 v39, a35
  v_accvgpr_read_b32 v40, a48
  v_accvgpr_read_b32 v41, a49
  v_accvgpr_read_b32 v42, a50
  v_accvgpr_read_b32 v43, a51
  v_cvt_pk_bf16_f32 v44, v36, v37
  v_cvt_pk_bf16_f32 v45, v38, v39
  v_cvt_pk_bf16_f32 v46, v40, v41
  v_cvt_pk_bf16_f32 v47, v42, v43
  buffer_store_dwordx4 v[44:47], v1, s[4:7], s17 offen offset:1024 sc1
  v_accvgpr_read_b32 v48, a64
  v_accvgpr_read_b32 v49, a65
  v_accvgpr_read_b32 v50, a66
  v_accvgpr_read_b32 v51, a67
  v_accvgpr_read_b32 v52, a80
  v_accvgpr_read_b32 v53, a81
  v_accvgpr_read_b32 v54, a82
  v_accvgpr_read_b32 v55, a83
  v_cvt_pk_bf16_f32 v56, v48, v49
  v_cvt_pk_bf16_f32 v57, v50, v51
  v_cvt_pk_bf16_f32 v58, v52, v53
  v_cvt_pk_bf16_f32 v59, v54, v55
  buffer_store_dwordx4 v[56:59], v1, s[4:7], s17 offen offset:2048 sc1
  v_accvgpr_read_b32 v60, a96
  v_accvgpr_read_b32 v61, a97
  v_accvgpr_read_b32 v62, a98
  v_accvgpr_read_b32 v63, a99
  v_accvgpr_read_b32 v64, a112
  v_accvgpr_read_b32 v65, a113
  v_accvgpr_read_b32 v66, a114
  v_accvgpr_read_b32 v67, a115
  v_cvt_pk_bf16_f32 v68, v60, v61
  v_cvt_pk_bf16_f32 v69, v62, v63
  v_cvt_pk_bf16_f32 v70, v64, v65
  v_cvt_pk_bf16_f32 v71, v66, v67
  buffer_store_dwordx4 v[68:71], v1, s[4:7], s17 offen offset:3072 sc1
  v_accvgpr_read_b32 v24, a128
  v_accvgpr_read_b32 v25, a129
  v_accvgpr_read_b32 v26, a130
  v_accvgpr_read_b32 v27, a131
  v_accvgpr_read_b32 v28, a144
  v_accvgpr_read_b32 v29, a145
  v_accvgpr_read_b32 v30, a146
  v_accvgpr_read_b32 v31, a147
  v_cvt_pk_bf16_f32 v32, v24, v25
  v_cvt_pk_bf16_f32 v33, v26, v27
  v_cvt_pk_bf16_f32 v34, v28, v29
  v_cvt_pk_bf16_f32 v35, v30, v31
  s_add_u32 s17, s17, 4096
  buffer_store_dwordx4 v[32:35], v1, s[4:7], s17 offen offset:0 sc1
  s_add_u32 s17, s16, 20480
  v_accvgpr_read_b32 v36, a4
  v_accvgpr_read_b32 v37, a5
  v_accvgpr_read_b32 v38, a6
  v_accvgpr_read_b32 v39, a7
  v_accvgpr_read_b32 v40, a20
  v_accvgpr_read_b32 v41, a21
  v_accvgpr_read_b32 v42, a22
  v_accvgpr_read_b32 v43, a23
  v_cvt_pk_bf16_f32 v44, v36, v37
  v_cvt_pk_bf16_f32 v45, v38, v39
  v_cvt_pk_bf16_f32 v46, v40, v41
  v_cvt_pk_bf16_f32 v47, v42, v43
  buffer_store_dwordx4 v[44:47], v1, s[4:7], s17 offen offset:0 sc1
  v_accvgpr_read_b32 v48, a36
  v_accvgpr_read_b32 v49, a37
  v_accvgpr_read_b32 v50, a38
  v_accvgpr_read_b32 v51, a39
  v_accvgpr_read_b32 v52, a52
  v_accvgpr_read_b32 v53, a53
  v_accvgpr_read_b32 v54, a54
  v_accvgpr_read_b32 v55, a55
  v_cvt_pk_bf16_f32 v56, v48, v49
  v_cvt_pk_bf16_f32 v57, v50, v51
  v_cvt_pk_bf16_f32 v58, v52, v53
  v_cvt_pk_bf16_f32 v59, v54, v55
  buffer_store_dwordx4 v[56:59], v1, s[4:7], s17 offen offset:1024 sc1
  v_accvgpr_read_b32 v60, a68
  v_accvgpr_read_b32 v61, a69
  v_accvgpr_read_b32 v62, a70
  v_accvgpr_read_b32 v63, a71
  v_accvgpr_read_b32 v64, a84
  v_accvgpr_read_b32 v65, a85
  v_accvgpr_read_b32 v66, a86
  v_accvgpr_read_b32 v67, a87
  v_cvt_pk_bf16_f32 v68, v60, v61
  v_cvt_pk_bf16_f32 v69, v62, v63
  v_cvt_pk_bf16_f32 v70, v64, v65
  v_cvt_pk_bf16_f32 v71, v66, v67
  buffer_store_dwordx4 v[68:71], v1, s[4:7], s17 offen offset:2048 sc1
  v_accvgpr_read_b32 v24, a100
  v_accvgpr_read_b32 v25, a101
  v_accvgpr_read_b32 v26, a102
  v_accvgpr_read_b32 v27, a103
  v_accvgpr_read_b32 v28, a116
  v_accvgpr_read_b32 v29, a117
  v_accvgpr_read_b32 v30, a118
  v_accvgpr_read_b32 v31, a119
  v_cvt_pk_bf16_f32 v32, v24, v25
  v_cvt_pk_bf16_f32 v33, v26, v27
  v_cvt_pk_bf16_f32 v34, v28, v29
  v_cvt_pk_bf16_f32 v35, v30, v31
  buffer_store_dwordx4 v[32:35], v1, s[4:7], s17 offen offset:3072 sc1
  v_accvgpr_read_b32 v36, a132
  v_accvgpr_read_b32 v37, a133
  v_accvgpr_read_b32 v38, a134
  v_accvgpr_read_b32 v39, a135
  v_accvgpr_read_b32 v40, a148
  v_accvgpr_read_b32 v41, a149
  v_accvgpr_read_b32 v42, a150
  v_accvgpr_read_b32 v43, a151
  v_cvt_pk_bf16_f32 v44, v36, v37
  v_cvt_pk_bf16_f32 v45, v38, v39
  v_cvt_pk_bf16_f32 v46, v40, v41
  v_cvt_pk_bf16_f32 v47, v42, v43
  s_add_u32 s17, s17, 4096
  buffer_store_dwordx4 v[44:47], v1, s[4:7], s17 offen offset:0 sc1
  s_add_u32 s17, s16, 40960
  v_accvgpr_read_b32 v48, a8
  v_accvgpr_read_b32 v49, a9
  v_accvgpr_read_b32 v50, a10
  v_accvgpr_read_b32 v51, a11
  v_accvgpr_read_b32 v52, a24
  v_accvgpr_read_b32 v53, a25
  v_accvgpr_read_b32 v54, a26
  v_accvgpr_read_b32 v55, a27
  v_cvt_pk_bf16_f32 v56, v48, v49
  v_cvt_pk_bf16_f32 v57, v50, v51
  v_cvt_pk_bf16_f32 v58, v52, v53
  v_cvt_pk_bf16_f32 v59, v54, v55
  buffer_store_dwordx4 v[56:59], v1, s[4:7], s17 offen offset:0 sc1
  v_accvgpr_read_b32 v60, a40
  v_accvgpr_read_b32 v61, a41
  v_accvgpr_read_b32 v62, a42
  v_accvgpr_read_b32 v63, a43
  v_accvgpr_read_b32 v64, a56
  v_accvgpr_read_b32 v65, a57
  v_accvgpr_read_b32 v66, a58
  v_accvgpr_read_b32 v67, a59
  v_cvt_pk_bf16_f32 v68, v60, v61
  v_cvt_pk_bf16_f32 v69, v62, v63
  v_cvt_pk_bf16_f32 v70, v64, v65
  v_cvt_pk_bf16_f32 v71, v66, v67
  buffer_store_dwordx4 v[68:71], v1, s[4:7], s17 offen offset:1024 sc1
  v_accvgpr_read_b32 v24, a72
  v_accvgpr_read_b32 v25, a73
  v_accvgpr_read_b32 v26, a74
  v_accvgpr_read_b32 v27, a75
  v_accvgpr_read_b32 v28, a88
  v_accvgpr_read_b32 v29, a89
  v_accvgpr_read_b32 v30, a90
  v_accvgpr_read_b32 v31, a91
  v_cvt_pk_bf16_f32 v32, v24, v25
  v_cvt_pk_bf16_f32 v33, v26, v27
  v_cvt_pk_bf16_f32 v34, v28, v29
  v_cvt_pk_bf16_f32 v35, v30, v31
  buffer_store_dwordx4 v[32:35], v1, s[4:7], s17 offen offset:2048 sc1
  v_accvgpr_read_b32 v36, a104
  v_accvgpr_read_b32 v37, a105
  v_accvgpr_read_b32 v38, a106
  v_accvgpr_read_b32 v39, a107
  v_accvgpr_read_b32 v40, a120
  v_accvgpr_read_b32 v41, a121
  v_accvgpr_read_b32 v42, a122
  v_accvgpr_read_b32 v43, a123
  v_cvt_pk_bf16_f32 v44, v36, v37
  v_cvt_pk_bf16_f32 v45, v38, v39
  v_cvt_pk_bf16_f32 v46, v40, v41
  v_cvt_pk_bf16_f32 v47, v42, v43
  buffer_store_dwordx4 v[44:47], v1, s[4:7], s17 offen offset:3072 sc1
  v_accvgpr_read_b32 v48, a136
  v_accvgpr_read_b32 v49, a137
  v_accvgpr_read_b32 v50, a138
  v_accvgpr_read_b32 v51, a139
  v_accvgpr_read_b32 v52, a152
  v_accvgpr_read_b32 v53, a153
  v_accvgpr_read_b32 v54, a154
  v_accvgpr_read_b32 v55, a155
  v_cvt_pk_bf16_f32 v56, v48, v49
  v_cvt_pk_bf16_f32 v57, v50, v51
  v_cvt_pk_bf16_f32 v58, v52, v53
  v_cvt_pk_bf16_f32 v59, v54, v55
  s_add_u32 s17, s17, 4096
  buffer_store_dwordx4 v[56:59], v1, s[4:7], s17 offen offset:0 sc1
  s_add_u32 s17, s16, 61440
  v_accvgpr_read_b32 v60, a12
  v_accvgpr_read_b32 v61, a13
  v_accvgpr_read_b32 v62, a14
  v_accvgpr_read_b32 v63, a15
  v_accvgpr_read_b32 v64, a28
  v_accvgpr_read_b32 v65, a29
  v_accvgpr_read_b32 v66, a30
  v_accvgpr_read_b32 v67, a31
  v_cvt_pk_bf16_f32 v68, v60, v61
  v_cvt_pk_bf16_f32 v69, v62, v63
  v_cvt_pk_bf16_f32 v70, v64, v65
  v_cvt_pk_bf16_f32 v71, v66, v67
  buffer_store_dwordx4 v[68:71], v1, s[4:7], s17 offen offset:0 sc1
  v_accvgpr_read_b32 v24, a44
  v_accvgpr_read_b32 v25, a45
  v_accvgpr_read_b32 v26, a46
  v_accvgpr_read_b32 v27, a47
  v_accvgpr_read_b32 v28, a60
  v_accvgpr_read_b32 v29, a61
  v_accvgpr_read_b32 v30, a62
  v_accvgpr_read_b32 v31, a63
  v_cvt_pk_bf16_f32 v32, v24, v25
  v_cvt_pk_bf16_f32 v33, v26, v27
  v_cvt_pk_bf16_f32 v34, v28, v29
  v_cvt_pk_bf16_f32 v35, v30, v31
  buffer_store_dwordx4 v[32:35], v1, s[4:7], s17 offen offset:1024 sc1
  v_accvgpr_read_b32 v36, a76
  v_accvgpr_read_b32 v37, a77
  v_accvgpr_read_b32 v38, a78
  v_accvgpr_read_b32 v39, a79
  v_accvgpr_read_b32 v40, a92
  v_accvgpr_read_b32 v41, a93
  v_accvgpr_read_b32 v42, a94
  v_accvgpr_read_b32 v43, a95
  v_cvt_pk_bf16_f32 v44, v36, v37
  v_cvt_pk_bf16_f32 v45, v38, v39
  v_cvt_pk_bf16_f32 v46, v40, v41
  v_cvt_pk_bf16_f32 v47, v42, v43
  buffer_store_dwordx4 v[44:47], v1, s[4:7], s17 offen offset:2048 sc1
  v_accvgpr_read_b32 v48, a108
  v_accvgpr_read_b32 v49, a109
  v_accvgpr_read_b32 v50, a110
  v_accvgpr_read_b32 v51, a111
  v_accvgpr_read_b32 v52, a124
  v_accvgpr_read_b32 v53, a125
  v_accvgpr_read_b32 v54, a126
  v_accvgpr_read_b32 v55, a127
  v_cvt_pk_bf16_f32 v56, v48, v49
  v_cvt_pk_bf16_f32 v57, v50, v51
  v_cvt_pk_bf16_f32 v58, v52, v53
  v_cvt_pk_bf16_f32 v59, v54, v55
  buffer_store_dwordx4 v[56:59], v1, s[4:7], s17 offen offset:3072 sc1
  v_accvgpr_read_b32 v60, a140
  v_accvgpr_read_b32 v61, a141
  v_accvgpr_read_b32 v62, a142
  v_accvgpr_read_b32 v63, a143
  v_accvgpr_read_b32 v64, a156
  v_accvgpr_read_b32 v65, a157
  v_accvgpr_read_b32 v66, a158
  v_accvgpr_read_b32 v67, a159
  v_cvt_pk_bf16_f32 v68, v60, v61
  v_cvt_pk_bf16_f32 v69, v62, v63
  v_cvt_pk_bf16_f32 v70, v64, v65
  v_cvt_pk_bf16_f32 v71, v66, v67
  s_add_u32 s17, s17, 4096
  buffer_store_dwordx4 v[68:71], v1, s[4:7], s17 offen offset:0 sc1
fin_exit1:
  s_endpgm
.globl redln1_kernel
.p2align 8
.type redln1_kernel,@function
redln1_kernel:
  s_cmp_ge_u32 s2, 128
  s_cbranch_scc1 redln1_exit1
  s_load_dwordx2 s[12:13], s[0:1], 96
  s_load_dwordx2 s[14:15], s[0:1], 0
  v_lshrrev_b32 v2, 6, v0
  s_nop 0
  v_readfirstlane_b32 s16, v2
  s_waitcnt lgkmcnt(0)
  s_mov_b32 s4, s12
  s_mov_b32 s5, s13
  s_mov_b32 s6, 0x10000000
  s_mov_b32 s7, 0x20000
  s_mov_b32 s8, s14
  s_mov_b32 s9, s15
  s_mov_b32 s10, 2621440
  s_mov_b32 s11, 0x20000
  s_mov_b32 s20, 0
  s_mov_b32 s19, s2
  v_and_b32 v3, 63, v0
  v_lshlrev_b32 v14, 4, v3
  v_and_b32 v2, 15, v3
  v_lshrrev_b32 v4, 4, v3
  s_lshl_b32 s17, s19, 4
  v_add_u32 v15, s17, v2
  v_mul_u32_u24 v15, 1280, v15
  v_lshl_add_u32 v15, v4, 4, v15
  s_mul_i32 s17, s16, 320
  s_add_u32 s20, s20, s17
  s_add_u32 s21, s17, 82313216
  s_mul_i32 s22, s19, 20
  s_mul_i32 s23, s16, 5
  s_add_u32 s22, s22, s23
  s_lshl_b32 s22, s22, 10
  s_add_u32 s22, s22, 92798976
  s_add_u32 s24, s22, 0
  s_add_u32 s25, s22, 2621440
  s_add_u32 s26, s22, 5242880
  s_add_u32 s27, s22, 7864320
  s_add_u32 s28, s22, 10485760
  s_add_u32 s29, s22, 13107200
  s_add_u32 s30, s22, 15728640
  s_add_u32 s31, s22, 18350080
  v_add_u32 v6, 0x1000, v14
  buffer_load_dwordx4 v[16:19], v15, s[8:11], s20 offen offset:0
  buffer_load_dwordx4 v[20:23], v15, s[8:11], s20 offen offset:64
  buffer_load_dwordx4 v[24:27], v15, s[8:11], s20 offen offset:128
  buffer_load_dwordx4 v[28:31], v15, s[8:11], s20 offen offset:192
  buffer_load_dwordx4 v[32:35], v15, s[8:11], s20 offen offset:256
  buffer_load_dwordx4 v[80:83], v14, s[4:7], s24 offen offset:0
  buffer_load_dwordx4 v[84:87], v14, s[4:7], s25 offen offset:0
  buffer_load_dwordx4 v[88:91], v14, s[4:7], s26 offen offset:0
  buffer_load_dwordx4 v[92:95], v14, s[4:7], s27 offen offset:0
  buffer_load_dwordx4 v[96:99], v14, s[4:7], s28 offen offset:0
  buffer_load_dwordx4 v[100:103], v14, s[4:7], s29 offen offset:0
  buffer_load_dwordx4 v[104:107], v14, s[4:7], s30 offen offset:0
  buffer_load_dwordx4 v[108:111], v14, s[4:7], s31 offen offset:0
  buffer_load_dwordx4 v[112:115], v14, s[4:7], s24 offen offset:1024
  buffer_load_dwordx4 v[116:119], v14, s[4:7], s25 offen offset:1024
  buffer_load_dwordx4 v[120:123], v14, s[4:7], s26 offen offset:1024
  buffer_load_dwordx4 v[124:127], v14, s[4:7], s27 offen offset:1024
  buffer_load_dwordx4 v[128:131], v14, s[4:7], s28 offen offset:1024
  buffer_load_dwordx4 v[132:135], v14, s[4:7], s29 offen offset:1024
  buffer_load_dwordx4 v[136:139], v14, s[4:7], s30 offen offset:1024
  buffer_load_dwordx4 v[140:143], v14, s[4:7], s31 offen offset:1024
  buffer_load_dwordx4 v[144:147], v14, s[4:7], s24 offen offset:2048
  buffer_load_dwordx4 v[148:151], v14, s[4:7], s25 offen offset:2048
  buffer_load_dwordx4 v[152:155], v14, s[4:7], s26 offen offset:2048
  buffer_load_dwordx4 v[156:159], v14, s[4:7], s27 offen offset:2048
  buffer_load_dwordx4 v[160:163], v14, s[4:7], s28 offen offset:2048
  buffer_load_dwordx4 v[164:167], v14, s[4:7], s29 offen offset:2048
  buffer_load_dwordx4 v[168:171], v14, s[4:7], s30 offen offset:2048
  buffer_load_dwordx4 v[172:175], v14, s[4:7], s31 offen offset:2048
  buffer_load_dwordx4 v[176:179], v14, s[4:7], s24 offen offset:3072
  buffer_load_dwordx4 v[180:183], v14, s[4:7], s25 offen offset:3072
  buffer_load_dwordx4 v[184:187], v14, s[4:7], s26 offen offset:3072
  buffer_load_dwordx4 v[188:191], v14, s[4:7], s27 offen offset:3072
  buffer_load_dwordx4 v[192:195], v14, s[4:7], s28 offen offset:3072
  buffer_load_dwordx4 v[196:199], v14, s[4:7], s29 offen offset:3072
  buffer_load_dwordx4 v[200:203], v14, s[4:7], s30 offen offset:3072
  buffer_load_dwordx4 v[204:207], v14, s[4:7], s31 offen offset:3072
  buffer_load_dwordx4 v[208:211], v6, s[4:7], s24 offen offset:0
  buffer_load_dwordx4 v[212:215], v6, s[4:7], s25 offen offset:0
  buffer_load_dwordx4 v[216:219], v6, s[4:7], s26 offen offset:0
  buffer_load_dwordx4 v[220:223], v6, s[4:7], s27 offen offset:0
  buffer_load_dwordx4 v[224:227], v6, s[4:7], s28 offen offset:0
  buffer_load_dwordx4 v[228:231], v6, s[4:7], s29 offen offset:0
  buffer_load_dwordx4 v[232:235], v6, s[4:7], s30 offen offset:0
  buffer_load_dwordx4 v[236:239], v6, s[4:7], s31 offen offset:0
  s_waitcnt vmcnt(32)
  v_lshlrev_b32 v36, 16, v80
  v_and_b32 v37, 0xffff0000, v80
  v_lshlrev_b32 v38, 16, v81
  v_and_b32 v39, 0xffff0000, v81
  v_lshlrev_b32 v40, 16, v82
  v_and_b32 v41, 0xffff0000, v82
  v_lshlrev_b32 v42, 16, v83
  v_and_b32 v43, 0xffff0000, v83
  v_lshlrev_b32 v8, 16, v84
  v_and_b32 v9, 0xffff0000, v84
  v_pk_add_f32 v[36:37], v[36:37], v[8:9]
  v_lshlrev_b32 v8, 16, v85
  v_and_b32 v9, 0xffff0000, v85
  v_pk_add_f32 v[38:39], v[38:39], v[8:9]
  v_lshlrev_b32 v8, 16, v86
  v_and_b32 v9, 0xffff0000, v86
  v_pk_add_f32 v[40:41], v[40:41], v[8:9]
  v_lshlrev_b32 v8, 16, v87
  v_and_b32 v9, 0xffff0000, v87
  v_pk_add_f32 v[42:43], v[42:43], v[8:9]
  v_lshlrev_b32 v8, 16, v88
  v_and_b32 v9, 0xffff0000, v88
  v_pk_add_f32 v[36:37], v[36:37], v[8:9]
  v_lshlrev_b32 v8, 16, v89
  v_and_b32 v9, 0xffff0000, v89
  v_pk_add_f32 v[38:39], v[38:39], v[8:9]
  v_lshlrev_b32 v8, 16, v90
  v_and_b32 v9, 0xffff0000, v90
  v_pk_add_f32 v[40:41], v[40:41], v[8:9]
  v_lshlrev_b32 v8, 16, v91
  v_and_b32 v9, 0xffff0000, v91
  v_pk_add_f32 v[42:43], v[42:43], v[8:9]
  v_lshlrev_b32 v8, 16, v92
  v_and_b32 v9, 0xffff0000, v92
  v_pk_add_f32 v[36:37], v[36:37], v[8:9]
  v_lshlrev_b32 v8, 16, v93
  v_and_b32 v9, 0xffff0000, v93
  v_pk_add_f32 v[38:39], v[38:39], v[8:9]
  v_lshlrev_b32 v8, 16, v94
  v_and_b32 v9, 0xffff0000, v94
  v_pk_add_f32 v[40:41], v[40:41], v[8:9]
  v_lshlrev_b32 v8, 16, v95
  v_and_b32 v9, 0xffff0000, v95
  v_pk_add_f32 v[42:43], v[42:43], v[8:9]
  v_lshlrev_b32 v8, 16, v96
  v_and_b32 v9, 0xffff0000, v96
  v_pk_add_f32 v[36:37], v[36:37], v[8:9]
  v_lshlrev_b32 v8, 16, v97
  v_and_b32 v9, 0xffff0000, v97
  v_pk_add_f32 v[38:39], v[38:39], v[8:9]
  v_lshlrev_b32 v8, 16, v98
  v_and_b32 v9, 0xffff0000, v98
  v_pk_add_f32 v[40:41], v[40:41], v[8:9]
  v_lshlrev_b32 v8, 16, v99
  v_and_b32 v9, 0xffff0000, v99
  v_pk_add_f32 v[42:43], v[42:43], v[8:9]
  v_lshlrev_b32 v8, 16, v100
  v_and_b32 v9, 0xffff0000, v100
  v_pk_add_f32 v[36:37], v[36:37], v[8:9]
  v_lshlrev_b32 v8, 16, v101
  v_and_b32 v9, 0xffff0000, v101
  v_pk_add_f32 v[38:39], v[38:39], v[8:9]
  v_lshlrev_b32 v8, 16, v102
  v_and_b32 v9, 0xffff0000, v102
  v_pk_add_f32 v[40:41], v[40:41], v[8:9]
  v_lshlrev_b32 v8, 16, v103
  v_and_b32 v9, 0xffff0000, v103
  v_pk_add_f32 v[42:43], v[42:43], v[8:9]
  v_lshlrev_b32 v8, 16, v104
  v_and_b32 v9, 0xffff0000, v104
  v_pk_add_f32 v[36:37], v[36:37], v[8:9]
  v_lshlrev_b32 v8, 16, v105
  v_and_b32 v9, 0xffff0000, v105
  v_pk_add_f32 v[38:39], v[38:39], v[8:9]
  v_lshlrev_b32 v8, 16, v106
  v_and_b32 v9, 0xffff0000, v106
  v_pk_add_f32 v[40:41], v[40:41], v[8:9]
  v_lshlrev_b32 v8, 16, v107
  v_and_b32 v9, 0xffff0000, v107
  v_pk_add_f32 v[42:43], v[42:43], v[8:9]
  v_lshlrev_b32 v8, 16, v108
  v_and_b32 v9, 0xffff0000, v108
  v_pk_add_f32 v[36:37], v[36:37], v[8:9]
  v_lshlrev_b32 v8, 16, v109
  v_and_b32 v9, 0xffff0000, v109
  v_pk_add_f32 v[38:39], v[38:39], v[8:9]
  v_lshlrev_b32 v8, 16, v110
  v_and_b32 v9, 0xffff0000, v110
  v_pk_add_f32 v[40:41], v[40:41], v[8:9]
  v_lshlrev_b32 v8, 16, v111
  v_and_b32 v9, 0xffff0000, v111
  v_pk_add_f32 v[42:43], v[42:43], v[8:9]
  v_cvt_pk_bf16_f32 v8, v36, v37
  v_lshlrev_b32 v36, 16, v8
  v_and_b32 v37, 0xffff0000, v8
  v_lshlrev_b32 v10, 16, v16
  v_and_b32 v11, 0xffff0000, v16
  v_pk_add_f32 v[36:37], v[36:37], v[10:11]
  v_cvt_pk_bf16_f32 v16, v36, v37
  v_lshlrev_b32 v36, 16, v16
  v_and_b32 v37, 0xffff0000, v16
  v_cvt_pk_bf16_f32 v8, v38, v39
  v_lshlrev_b32 v38, 16, v8
  v_and_b32 v39, 0xffff0000, v8
  v_lshlrev_b32 v10, 16, v17
  v_and_b32 v11, 0xffff0000, v17
  v_pk_add_f32 v[38:39], v[38:39], v[10:11]
  v_cvt_pk_bf16_f32 v17, v38, v39
  v_lshlrev_b32 v38, 16, v17
  v_and_b32 v39, 0xffff0000, v17
  v_cvt_pk_bf16_f32 v8, v40, v41
  v_lshlrev_b32 v40, 16, v8
  v_and_b32 v41, 0xffff0000, v8
  v_lshlrev_b32 v10, 16, v18
  v_and_b32 v11, 0xffff0000, v18
  v_pk_add_f32 v[40:41], v[40:41], v[10:11]
  v_cvt_pk_bf16_f32 v18, v40, v41
  v_lshlrev_b32 v40, 16, v18
  v_and_b32 v41, 0xffff0000, v18
  v_cvt_pk_bf16_f32 v8, v42, v43
  v_lshlrev_b32 v42, 16, v8
  v_and_b32 v43, 0xffff0000, v8
  v_lshlrev_b32 v10, 16, v19
  v_and_b32 v11, 0xffff0000, v19
  v_pk_add_f32 v[42:43], v[42:43], v[10:11]
  v_cvt_pk_bf16_f32 v19, v42, v43
  v_lshlrev_b32 v42, 16, v19
  v_and_b32 v43, 0xffff0000, v19
  buffer_store_dwordx4 v[16:19], v15, s[4:7], s21 offen offset:0 sc1
  s_waitcnt vmcnt(25)
  v_lshlrev_b32 v44, 16, v112
  v_and_b32 v45, 0xffff0000, v112
  v_lshlrev_b32 v46, 16, v113
  v_and_b32 v47, 0xffff0000, v113
  v_lshlrev_b32 v48, 16, v114
  v_and_b32 v49, 0xffff0000, v114
  v_lshlrev_b32 v50, 16, v115
  v_and_b32 v51, 0xffff0000, v115
  v_lshlrev_b32 v8, 16, v116
  v_and_b32 v9, 0xffff0000, v116
  v_pk_add_f32 v[44:45], v[44:45], v[8:9]
  v_lshlrev_b32 v8, 16, v117
  v_and_b32 v9, 0xffff0000, v117
  v_pk_add_f32 v[46:47], v[46:47], v[8:9]
  v_lshlrev_b32 v8, 16, v118
  v_and_b32 v9, 0xffff0000, v118
  v_pk_add_f32 v[48:49], v[48:49], v[8:9]
  v_lshlrev_b32 v8, 16, v119
  v_and_b32 v9, 0xffff0000, v119
  v_pk_add_f32 v[50:51], v[50:51], v[8:9]
  v_lshlrev_b32 v8, 16, v120
  v_and_b32 v9, 0xffff0000, v120
  v_pk_add_f32 v[44:45], v[44:45], v[8:9]
  v_lshlrev_b32 v8, 16, v121
  v_and_b32 v9, 0xffff0000, v121
  v_pk_add_f32 v[46:47], v[46:47], v[8:9]
  v_lshlrev_b32 v8, 16, v122
  v_and_b32 v9, 0xffff0000, v122
  v_pk_add_f32 v[48:49], v[48:49], v[8:9]
  v_lshlrev_b32 v8, 16, v123
  v_and_b32 v9, 0xffff0000, v123
  v_pk_add_f32 v[50:51], v[50:51], v[8:9]
  v_lshlrev_b32 v8, 16, v124
  v_and_b32 v9, 0xffff0000, v124
  v_pk_add_f32 v[44:45], v[44:45], v[8:9]
  v_lshlrev_b32 v8, 16, v125
  v_and_b32 v9, 0xffff0000, v125
  v_pk_add_f32 v[46:47], v[46:47], v[8:9]
  v_lshlrev_b32 v8, 16, v126
  v_and_b32 v9, 0xffff0000, v126
  v_pk_add_f32 v[48:49], v[48:49], v[8:9]
  v_lshlrev_b32 v8, 16, v127
  v_and_b32 v9, 0xffff0000, v127
  v_pk_add_f32 v[50:51], v[50:51], v[8:9]
  v_lshlrev_b32 v8, 16, v128
  v_and_b32 v9, 0xffff0000, v128
  v_pk_add_f32 v[44:45], v[44:45], v[8:9]
  v_lshlrev_b32 v8, 16, v129
  v_and_b32 v9, 0xffff0000, v129
  v_pk_add_f32 v[46:47], v[46:47], v[8:9]
  v_lshlrev_b32 v8, 16, v130
  v_and_b32 v9, 0xffff0000, v130
  v_pk_add_f32 v[48:49], v[48:49], v[8:9]
  v_lshlrev_b32 v8, 16, v131
  v_and_b32 v9, 0xffff0000, v131
  v_pk_add_f32 v[50:51], v[50:51], v[8:9]
  v_lshlrev_b32 v8, 16, v132
  v_and_b32 v9, 0xffff0000, v132
  v_pk_add_f32 v[44:45], v[44:45], v[8:9]
  v_lshlrev_b32 v8, 16, v133
  v_and_b32 v9, 0xffff0000, v133
  v_pk_add_f32 v[46:47], v[46:47], v[8:9]
  v_lshlrev_b32 v8, 16, v134
  v_and_b32 v9, 0xffff0000, v134
  v_pk_add_f32 v[48:49], v[48:49], v[8:9]
  v_lshlrev_b32 v8, 16, v135
  v_and_b32 v9, 0xffff0000, v135
  v_pk_add_f32 v[50:51], v[50:51], v[8:9]
  v_lshlrev_b32 v8, 16, v136
  v_and_b32 v9, 0xffff0000, v136
  v_pk_add_f32 v[44:45], v[44:45], v[8:9]
  v_lshlrev_b32 v8, 16, v137
  v_and_b32 v9, 0xffff0000, v137
  v_pk_add_f32 v[46:47], v[46:47], v[8:9]
  v_lshlrev_b32 v8, 16, v138
  v_and_b32 v9, 0xffff0000, v138
  v_pk_add_f32 v[48:49], v[48:49], v[8:9]
  v_lshlrev_b32 v8, 16, v139
  v_and_b32 v9, 0xffff0000, v139
  v_pk_add_f32 v[50:51], v[50:51], v[8:9]
  v_lshlrev_b32 v8, 16, v140
  v_and_b32 v9, 0xffff0000, v140
  v_pk_add_f32 v[44:45], v[44:45], v[8:9]
  v_lshlrev_b32 v8, 16, v141
  v_and_b32 v9, 0xffff0000, v141
  v_pk_add_f32 v[46:47], v[46:47], v[8:9]
  v_lshlrev_b32 v8, 16, v142
  v_and_b32 v9, 0xffff0000, v142
  v_pk_add_f32 v[48:49], v[48:49], v[8:9]
  v_lshlrev_b32 v8, 16, v143
  v_and_b32 v9, 0xffff0000, v143
  v_pk_add_f32 v[50:51], v[50:51], v[8:9]
  v_cvt_pk_bf16_f32 v8, v44, v45
  v_lshlrev_b32 v44, 16, v8
  v_and_b32 v45, 0xffff0000, v8
  v_lshlrev_b32 v10, 16, v20
  v_and_b32 v11, 0xffff0000, v20
  v_pk_add_f32 v[44:45], v[44:45], v[10:11]
  v_cvt_pk_bf16_f32 v20, v44, v45
  v_lshlrev_b32 v44, 16, v20
  v_and_b32 v45, 0xffff0000, v20
  v_cvt_pk_bf16_f32 v8, v46, v47
  v_lshlrev_b32 v46, 16, v8
  v_and_b32 v47, 0xffff0000, v8
  v_lshlrev_b32 v10, 16, v21
  v_and_b32 v11, 0xffff0000, v21
  v_pk_add_f32 v[46:47], v[46:47], v[10:11]
  v_cvt_pk_bf16_f32 v21, v46, v47
  v_lshlrev_b32 v46, 16, v21
  v_and_b32 v47, 0xffff0000, v21
  v_cvt_pk_bf16_f32 v8, v48, v49
  v_lshlrev_b32 v48, 16, v8
  v_and_b32 v49, 0xffff0000, v8
  v_lshlrev_b32 v10, 16, v22
  v_and_b32 v11, 0xffff0000, v22
  v_pk_add_f32 v[48:49], v[48:49], v[10:11]
  v_cvt_pk_bf16_f32 v22, v48, v49
  v_lshlrev_b32 v48, 16, v22
  v_and_b32 v49, 0xffff0000, v22
  v_cvt_pk_bf16_f32 v8, v50, v51
  v_lshlrev_b32 v50, 16, v8
  v_and_b32 v51, 0xffff0000, v8
  v_lshlrev_b32 v10, 16, v23
  v_and_b32 v11, 0xffff0000, v23
  v_pk_add_f32 v[50:51], v[50:51], v[10:11]
  v_cvt_pk_bf16_f32 v23, v50, v51
  v_lshlrev_b32 v50, 16, v23
  v_and_b32 v51, 0xffff0000, v23
  buffer_store_dwordx4 v[20:23], v15, s[4:7], s21 offen offset:64 sc1
  s_waitcnt vmcnt(18)
  v_lshlrev_b32 v52, 16, v144
  v_and_b32 v53, 0xffff0000, v144
  v_lshlrev_b32 v54, 16, v145
  v_and_b32 v55, 0xffff0000, v145
  v_lshlrev_b32 v56, 16, v146
  v_and_b32 v57, 0xffff0000, v146
  v_lshlrev_b32 v58, 16, v147
  v_and_b32 v59, 0xffff0000, v147
  v_lshlrev_b32 v8, 16, v148
  v_and_b32 v9, 0xffff0000, v148
  v_pk_add_f32 v[52:53], v[52:53], v[8:9]
  v_lshlrev_b32 v8, 16, v149
  v_and_b32 v9, 0xffff0000, v149
  v_pk_add_f32 v[54:55], v[54:55], v[8:9]
  v_lshlrev_b32 v8, 16, v150
  v_and_b32 v9, 0xffff0000, v150
  v_pk_add_f32 v[56:57], v[56:57], v[8:9]
  v_lshlrev_b32 v8, 16, v151
  v_and_b32 v9, 0xffff0000, v151
  v_pk_add_f32 v[58:59], v[58:59], v[8:9]
  v_lshlrev_b32 v8, 16, v152
  v_and_b32 v9, 0xffff0000, v152
  v_pk_add_f32 v[52:53], v[52:53], v[8:9]
  v_lshlrev_b32 v8, 16, v153
  v_and_b32 v9, 0xffff0000, v153
  v_pk_add_f32 v[54:55], v[54:55], v[8:9]
  v_lshlrev_b32 v8, 16, v154
  v_and_b32 v9, 0xffff0000, v154
  v_pk_add_f32 v[56:57], v[56:57], v[8:9]
  v_lshlrev_b32 v8, 16, v155
  v_and_b32 v9, 0xffff0000, v155
  v_pk_add_f32 v[58:59], v[58:59], v[8:9]
  v_lshlrev_b32 v8, 16, v156
  v_and_b32 v9, 0xffff0000, v156
  v_pk_add_f32 v[52:53], v[52:53], v[8:9]
  v_lshlrev_b32 v8, 16, v157
  v_and_b32 v9, 0xffff0000, v157
  v_pk_add_f32 v[54:55], v[54:55], v[8:9]
  v_lshlrev_b32 v8, 16, v158
  v_and_b32 v9, 0xffff0000, v158
  v_pk_add_f32 v[56:57], v[56:57], v[8:9]
  v_lshlrev_b32 v8, 16, v159
  v_and_b32 v9, 0xffff0000, v159
  v_pk_add_f32 v[58:59], v[58:59], v[8:9]
  v_lshlrev_b32 v8, 16, v160
  v_and_b32 v9, 0xffff0000, v160
  v_pk_add_f32 v[52:53], v[52:53], v[8:9]
  v_lshlrev_b32 v8, 16, v161
  v_and_b32 v9, 0xffff0000, v161
  v_pk_add_f32 v[54:55], v[54:55], v[8:9]
  v_lshlrev_b32 v8, 16, v162
  v_and_b32 v9, 0xffff0000, v162
  v_pk_add_f32 v[56:57], v[56:57], v[8:9]
  v_lshlrev_b32 v8, 16, v163
  v_and_b32 v9, 0xffff0000, v163
  v_pk_add_f32 v[58:59], v[58:59], v[8:9]
  v_lshlrev_b32 v8, 16, v164
  v_and_b32 v9, 0xffff0000, v164
  v_pk_add_f32 v[52:53], v[52:53], v[8:9]
  v_lshlrev_b32 v8, 16, v165
  v_and_b32 v9, 0xffff0000, v165
  v_pk_add_f32 v[54:55], v[54:55], v[8:9]
  v_lshlrev_b32 v8, 16, v166
  v_and_b32 v9, 0xffff0000, v166
  v_pk_add_f32 v[56:57], v[56:57], v[8:9]
  v_lshlrev_b32 v8, 16, v167
  v_and_b32 v9, 0xffff0000, v167
  v_pk_add_f32 v[58:59], v[58:59], v[8:9]
  v_lshlrev_b32 v8, 16, v168
  v_and_b32 v9, 0xffff0000, v168
  v_pk_add_f32 v[52:53], v[52:53], v[8:9]
  v_lshlrev_b32 v8, 16, v169
  v_and_b32 v9, 0xffff0000, v169
  v_pk_add_f32 v[54:55], v[54:55], v[8:9]
  v_lshlrev_b32 v8, 16, v170
  v_and_b32 v9, 0xffff0000, v170
  v_pk_add_f32 v[56:57], v[56:57], v[8:9]
  v_lshlrev_b32 v8, 16, v171
  v_and_b32 v9, 0xffff0000, v171
  v_pk_add_f32 v[58:59], v[58:59], v[8:9]
  v_lshlrev_b32 v8, 16, v172
  v_and_b32 v9, 0xffff0000, v172
  v_pk_add_f32 v[52:53], v[52:53], v[8:9]
  v_lshlrev_b32 v8, 16, v173
  v_and_b32 v9, 0xffff0000, v173
  v_pk_add_f32 v[54:55], v[54:55], v[8:9]
  v_lshlrev_b32 v8, 16, v174
  v_and_b32 v9, 0xffff0000, v174
  v_pk_add_f32 v[56:57], v[56:57], v[8:9]
  v_lshlrev_b32 v8, 16, v175
  v_and_b32 v9, 0xffff0000, v175
  v_pk_add_f32 v[58:59], v[58:59], v[8:9]
  v_cvt_pk_bf16_f32 v8, v52, v53
  v_lshlrev_b32 v52, 16, v8
  v_and_b32 v53, 0xffff0000, v8
  v_lshlrev_b32 v10, 16, v24
  v_and_b32 v11, 0xffff0000, v24
  v_pk_add_f32 v[52:53], v[52:53], v[10:11]
  v_cvt_pk_bf16_f32 v24, v52, v53
  v_lshlrev_b32 v52, 16, v24
  v_and_b32 v53, 0xffff0000, v24
  v_cvt_pk_bf16_f32 v8, v54, v55
  v_lshlrev_b32 v54, 16, v8
  v_and_b32 v55, 0xffff0000, v8
  v_lshlrev_b32 v10, 16, v25
  v_and_b32 v11, 0xffff0000, v25
  v_pk_add_f32 v[54:55], v[54:55], v[10:11]
  v_cvt_pk_bf16_f32 v25, v54, v55
  v_lshlrev_b32 v54, 16, v25
  v_and_b32 v55, 0xffff0000, v25
  v_cvt_pk_bf16_f32 v8, v56, v57
  v_lshlrev_b32 v56, 16, v8
  v_and_b32 v57, 0xffff0000, v8
  v_lshlrev_b32 v10, 16, v26
  v_and_b32 v11, 0xffff0000, v26
  v_pk_add_f32 v[56:57], v[56:57], v[10:11]
  v_cvt_pk_bf16_f32 v26, v56, v57
  v_lshlrev_b32 v56, 16, v26
  v_and_b32 v57, 0xffff0000, v26
  v_cvt_pk_bf16_f32 v8, v58, v59
  v_lshlrev_b32 v58, 16, v8
  v_and_b32 v59, 0xffff0000, v8
  v_lshlrev_b32 v10, 16, v27
  v_and_b32 v11, 0xffff0000, v27
  v_pk_add_f32 v[58:59], v[58:59], v[10:11]
  v_cvt_pk_bf16_f32 v27, v58, v59
  v_lshlrev_b32 v58, 16, v27
  v_and_b32 v59, 0xffff0000, v27
  buffer_store_dwordx4 v[24:27], v15, s[4:7], s21 offen offset:128 sc1
  s_waitcnt vmcnt(11)
  v_lshlrev_b32 v60, 16, v176
  v_and_b32 v61, 0xffff0000, v176
  v_lshlrev_b32 v62, 16, v177
  v_and_b32 v63, 0xffff0000, v177
  v_lshlrev_b32 v64, 16, v178
  v_and_b32 v65, 0xffff0000, v178
  v_lshlrev_b32 v66, 16, v179
  v_and_b32 v67, 0xffff0000, v179
  v_lshlrev_b32 v8, 16, v180
  v_and_b32 v9, 0xffff0000, v180
  v_pk_add_f32 v[60:61], v[60:61], v[8:9]
  v_lshlrev_b32 v8, 16, v181
  v_and_b32 v9, 0xffff0000, v181
  v_pk_add_f32 v[62:63], v[62:63], v[8:9]
  v_lshlrev_b32 v8, 16, v182
  v_and_b32 v9, 0xffff0000, v182
  v_pk_add_f32 v[64:65], v[64:65], v[8:9]
  v_lshlrev_b32 v8, 16, v183
  v_and_b32 v9, 0xffff0000, v183
  v_pk_add_f32 v[66:67], v[66:67], v[8:9]
  v_lshlrev_b32 v8, 16, v184
  v_and_b32 v9, 0xffff0000, v184
  v_pk_add_f32 v[60:61], v[60:61], v[8:9]
  v_lshlrev_b32 v8, 16, v185
  v_and_b32 v9, 0xffff0000, v185
  v_pk_add_f32 v[62:63], v[62:63], v[8:9]
  v_lshlrev_b32 v8, 16, v186
  v_and_b32 v9, 0xffff0000, v186
  v_pk_add_f32 v[64:65], v[64:65], v[8:9]
  v_lshlrev_b32 v8, 16, v187
  v_and_b32 v9, 0xffff0000, v187
  v_pk_add_f32 v[66:67], v[66:67], v[8:9]
  v_lshlrev_b32 v8, 16, v188
  v_and_b32 v9, 0xffff0000, v188
  v_pk_add_f32 v[60:61], v[60:61], v[8:9]
  v_lshlrev_b32 v8, 16, v189
  v_and_b32 v9, 0xffff0000, v189
  v_pk_add_f32 v[62:63], v[62:63], v[8:9]
  v_lshlrev_b32 v8, 16, v190
  v_and_b32 v9, 0xffff0000, v190
  v_pk_add_f32 v[64:65], v[64:65], v[8:9]
  v_lshlrev_b32 v8, 16, v191
  v_and_b32 v9, 0xffff0000, v191
  v_pk_add_f32 v[66:67], v[66:67], v[8:9]
  v_lshlrev_b32 v8, 16, v192
  v_and_b32 v9, 0xffff0000, v192
  v_pk_add_f32 v[60:61], v[60:61], v[8:9]
  v_lshlrev_b32 v8, 16, v193
  v_and_b32 v9, 0xffff0000, v193
  v_pk_add_f32 v[62:63], v[62:63], v[8:9]
  v_lshlrev_b32 v8, 16, v194
  v_and_b32 v9, 0xffff0000, v194
  v_pk_add_f32 v[64:65], v[64:65], v[8:9]
  v_lshlrev_b32 v8, 16, v195
  v_and_b32 v9, 0xffff0000, v195
  v_pk_add_f32 v[66:67], v[66:67], v[8:9]
  v_lshlrev_b32 v8, 16, v196
  v_and_b32 v9, 0xffff0000, v196
  v_pk_add_f32 v[60:61], v[60:61], v[8:9]
  v_lshlrev_b32 v8, 16, v197
  v_and_b32 v9, 0xffff0000, v197
  v_pk_add_f32 v[62:63], v[62:63], v[8:9]
  v_lshlrev_b32 v8, 16, v198
  v_and_b32 v9, 0xffff0000, v198
  v_pk_add_f32 v[64:65], v[64:65], v[8:9]
  v_lshlrev_b32 v8, 16, v199
  v_and_b32 v9, 0xffff0000, v199
  v_pk_add_f32 v[66:67], v[66:67], v[8:9]
  v_lshlrev_b32 v8, 16, v200
  v_and_b32 v9, 0xffff0000, v200
  v_pk_add_f32 v[60:61], v[60:61], v[8:9]
  v_lshlrev_b32 v8, 16, v201
  v_and_b32 v9, 0xffff0000, v201
  v_pk_add_f32 v[62:63], v[62:63], v[8:9]
  v_lshlrev_b32 v8, 16, v202
  v_and_b32 v9, 0xffff0000, v202
  v_pk_add_f32 v[64:65], v[64:65], v[8:9]
  v_lshlrev_b32 v8, 16, v203
  v_and_b32 v9, 0xffff0000, v203
  v_pk_add_f32 v[66:67], v[66:67], v[8:9]
  v_lshlrev_b32 v8, 16, v204
  v_and_b32 v9, 0xffff0000, v204
  v_pk_add_f32 v[60:61], v[60:61], v[8:9]
  v_lshlrev_b32 v8, 16, v205
  v_and_b32 v9, 0xffff0000, v205
  v_pk_add_f32 v[62:63], v[62:63], v[8:9]
  v_lshlrev_b32 v8, 16, v206
  v_and_b32 v9, 0xffff0000, v206
  v_pk_add_f32 v[64:65], v[64:65], v[8:9]
  v_lshlrev_b32 v8, 16, v207
  v_and_b32 v9, 0xffff0000, v207
  v_pk_add_f32 v[66:67], v[66:67], v[8:9]
  v_cvt_pk_bf16_f32 v8, v60, v61
  v_lshlrev_b32 v60, 16, v8
  v_and_b32 v61, 0xffff0000, v8
  v_lshlrev_b32 v10, 16, v28
  v_and_b32 v11, 0xffff0000, v28
  v_pk_add_f32 v[60:61], v[60:61], v[10:11]
  v_cvt_pk_bf16_f32 v28, v60, v61
  v_lshlrev_b32 v60, 16, v28
  v_and_b32 v61, 0xffff0000, v28
  v_cvt_pk_bf16_f32 v8, v62, v63
  v_lshlrev_b32 v62, 16, v8
  v_and_b32 v63, 0xffff0000, v8
  v_lshlrev_b32 v10, 16, v29
  v_and_b32 v11, 0xffff0000, v29
  v_pk_add_f32 v[62:63], v[62:63], v[10:11]
  v_cvt_pk_bf16_f32 v29, v62, v63
  v_lshlrev_b32 v62, 16, v29
  v_and_b32 v63, 0xffff0000, v29
  v_cvt_pk_bf16_f32 v8, v64, v65
  v_lshlrev_b32 v64, 16, v8
  v_and_b32 v65, 0xffff0000, v8
  v_lshlrev_b32 v10, 16, v30
  v_and_b32 v11, 0xffff0000, v30
  v_pk_add_f32 v[64:65], v[64:65], v[10:11]
  v_cvt_pk_bf16_f32 v30, v64, v65
  v_lshlrev_b32 v64, 16, v30
  v_and_b32 v65, 0xffff0000, v30
  v_cvt_pk_bf16_f32 v8, v66, v67
  v_lshlrev_b32 v66, 16, v8
  v_and_b32 v67, 0xffff0000, v8
  v_lshlrev_b32 v10, 16, v31
  v_and_b32 v11, 0xffff0000, v31
  v_pk_add_f32 v[66:67], v[66:67], v[10:11]
  v_cvt_pk_bf16_f32 v31, v66, v67
  v_lshlrev_b32 v66, 16, v31
  v_and_b32 v67, 0xffff0000, v31
  buffer_store_dwordx4 v[28:31], v15, s[4:7], s21 offen offset:192 sc1
  s_waitcnt vmcnt(4)
  v_lshlrev_b32 v68, 16, v208
  v_and_b32 v69, 0xffff0000, v208
  v_lshlrev_b32 v70, 16, v209
  v_and_b32 v71, 0xffff0000, v209
  v_lshlrev_b32 v72, 16, v210
  v_and_b32 v73, 0xffff0000, v210
  v_lshlrev_b32 v74, 16, v211
  v_and_b32 v75, 0xffff0000, v211
  v_lshlrev_b32 v8, 16, v212
  v_and_b32 v9, 0xffff0000, v212
  v_pk_add_f32 v[68:69], v[68:69], v[8:9]
  v_lshlrev_b32 v8, 16, v213
  v_and_b32 v9, 0xffff0000, v213
  v_pk_add_f32 v[70:71], v[70:71], v[8:9]
  v_lshlrev_b32 v8, 16, v214
  v_and_b32 v9, 0xffff0000, v214
  v_pk_add_f32 v[72:73], v[72:73], v[8:9]
  v_lshlrev_b32 v8, 16, v215
  v_and_b32 v9, 0xffff0000, v215
  v_pk_add_f32 v[74:75], v[74:75], v[8:9]
  v_lshlrev_b32 v8, 16, v216
  v_and_b32 v9, 0xffff0000, v216
  v_pk_add_f32 v[68:69], v[68:69], v[8:9]
  v_lshlrev_b32 v8, 16, v217
  v_and_b32 v9, 0xffff0000, v217
  v_pk_add_f32 v[70:71], v[70:71], v[8:9]
  v_lshlrev_b32 v8, 16, v218
  v_and_b32 v9, 0xffff0000, v218
  v_pk_add_f32 v[72:73], v[72:73], v[8:9]
  v_lshlrev_b32 v8, 16, v219
  v_and_b32 v9, 0xffff0000, v219
  v_pk_add_f32 v[74:75], v[74:75], v[8:9]
  v_lshlrev_b32 v8, 16, v220
  v_and_b32 v9, 0xffff0000, v220
  v_pk_add_f32 v[68:69], v[68:69], v[8:9]
  v_lshlrev_b32 v8, 16, v221
  v_and_b32 v9, 0xffff0000, v221
  v_pk_add_f32 v[70:71], v[70:71], v[8:9]
  v_lshlrev_b32 v8, 16, v222
  v_and_b32 v9, 0xffff0000, v222
  v_pk_add_f32 v[72:73], v[72:73], v[8:9]
  v_lshlrev_b32 v8, 16, v223
  v_and_b32 v9, 0xffff0000, v223
  v_pk_add_f32 v[74:75], v[74:75], v[8:9]
  v_lshlrev_b32 v8, 16, v224
  v_and_b32 v9, 0xffff0000, v224
  v_pk_add_f32 v[68:69], v[68:69], v[8:9]
  v_lshlrev_b32 v8, 16, v225
  v_and_b32 v9, 0xffff0000, v225
  v_pk_add_f32 v[70:71], v[70:71], v[8:9]
  v_lshlrev_b32 v8, 16, v226
  v_and_b32 v9, 0xffff0000, v226
  v_pk_add_f32 v[72:73], v[72:73], v[8:9]
  v_lshlrev_b32 v8, 16, v227
  v_and_b32 v9, 0xffff0000, v227
  v_pk_add_f32 v[74:75], v[74:75], v[8:9]
  v_lshlrev_b32 v8, 16, v228
  v_and_b32 v9, 0xffff0000, v228
  v_pk_add_f32 v[68:69], v[68:69], v[8:9]
  v_lshlrev_b32 v8, 16, v229
  v_and_b32 v9, 0xffff0000, v229
  v_pk_add_f32 v[70:71], v[70:71], v[8:9]
  v_lshlrev_b32 v8, 16, v230
  v_and_b32 v9, 0xffff0000, v230
  v_pk_add_f32 v[72:73], v[72:73], v[8:9]
  v_lshlrev_b32 v8, 16, v231
  v_and_b32 v9, 0xffff0000, v231
  v_pk_add_f32 v[74:75], v[74:75], v[8:9]
  v_lshlrev_b32 v8, 16, v232
  v_and_b32 v9, 0xffff0000, v232
  v_pk_add_f32 v[68:69], v[68:69], v[8:9]
  v_lshlrev_b32 v8, 16, v233
  v_and_b32 v9, 0xffff0000, v233
  v_pk_add_f32 v[70:71], v[70:71], v[8:9]
  v_lshlrev_b32 v8, 16, v234
  v_and_b32 v9, 0xffff0000, v234
  v_pk_add_f32 v[72:73], v[72:73], v[8:9]
  v_lshlrev_b32 v8, 16, v235
  v_and_b32 v9, 0xffff0000, v235
  v_pk_add_f32 v[74:75], v[74:75], v[8:9]
  v_lshlrev_b32 v8, 16, v236
  v_and_b32 v9, 0xffff0000, v236
  v_pk_add_f32 v[68:69], v[68:69], v[8:9]
  v_lshlrev_b32 v8, 16, v237
  v_and_b32 v9, 0xffff0000, v237
  v_pk_add_f32 v[70:71], v[70:71], v[8:9]
  v_lshlrev_b32 v8, 16, v238
  v_and_b32 v9, 0xffff0000, v238
  v_pk_add_f32 v[72:73], v[72:73], v[8:9]
  v_lshlrev_b32 v8, 16, v239
  v_and_b32 v9, 0xffff0000, v239
  v_pk_add_f32 v[74:75], v[74:75], v[8:9]
  v_cvt_pk_bf16_f32 v8, v68, v69
  v_lshlrev_b32 v68, 16, v8
  v_and_b32 v69, 0xffff0000, v8
  v_lshlrev_b32 v10, 16, v32
  v_and_b32 v11, 0xffff0000, v32
  v_pk_add_f32 v[68:69], v[68:69], v[10:11]
  v_cvt_pk_bf16_f32 v32, v68, v69
  v_lshlrev_b32 v68, 16, v32
  v_and_b32 v69, 0xffff0000, v32
  v_cvt_pk_bf16_f32 v8, v70, v71
  v_lshlrev_b32 v70, 16, v8
  v_and_b32 v71, 0xffff0000, v8
  v_lshlrev_b32 v10, 16, v33
  v_and_b32 v11, 0xffff0000, v33
  v_pk_add_f32 v[70:71], v[70:71], v[10:11]
  v_cvt_pk_bf16_f32 v33, v70, v71
  v_lshlrev_b32 v70, 16, v33
  v_and_b32 v71, 0xffff0000, v33
  v_cvt_pk_bf16_f32 v8, v72, v73
  v_lshlrev_b32 v72, 16, v8
  v_and_b32 v73, 0xffff0000, v8
  v_lshlrev_b32 v10, 16, v34
  v_and_b32 v11, 0xffff0000, v34
  v_pk_add_f32 v[72:73], v[72:73], v[10:11]
  v_cvt_pk_bf16_f32 v34, v72, v73
  v_lshlrev_b32 v72, 16, v34
  v_and_b32 v73, 0xffff0000, v34
  v_cvt_pk_bf16_f32 v8, v74, v75
  v_lshlrev_b32 v74, 16, v8
  v_and_b32 v75, 0xffff0000, v8
  v_lshlrev_b32 v10, 16, v35
  v_and_b32 v11, 0xffff0000, v35
  v_pk_add_f32 v[74:75], v[74:75], v[10:11]
  v_cvt_pk_bf16_f32 v35, v74, v75
  v_lshlrev_b32 v74, 16, v35
  v_and_b32 v75, 0xffff0000, v35
  buffer_store_dwordx4 v[32:35], v15, s[4:7], s21 offen offset:256 sc1
  v_and_b32 v3, 63, v0
  v_and_b32 v2, 15, v3
  v_lshlrev_b32 v5, 2, v2
  s_lshl_b32 s17, s16, 6
  v_add_u32 v1, s17, v5
  v_pk_add_f32 v[6:7], v[36:37], v[38:39]
  v_pk_add_f32 v[6:7], v[6:7], v[40:41]
  v_pk_add_f32 v[6:7], v[6:7], v[42:43]
  v_pk_add_f32 v[6:7], v[6:7], v[44:45]
  v_pk_add_f32 v[6:7], v[6:7], v[46:47]
  v_pk_add_f32 v[6:7], v[6:7], v[48:49]
  v_pk_add_f32 v[6:7], v[6:7], v[50:51]
  v_pk_add_f32 v[6:7], v[6:7], v[52:53]
  v_pk_add_f32 v[6:7], v[6:7], v[54:55]
  v_pk_add_f32 v[6:7], v[6:7], v[56:57]
  v_pk_add_f32 v[6:7], v[6:7], v[58:59]
  v_pk_add_f32 v[6:7], v[6:7], v[60:61]
  v_pk_add_f32 v[6:7], v[6:7], v[62:63]
  v_pk_add_f32 v[6:7], v[6:7], v[64:65]
  v_pk_add_f32 v[6:7], v[6:7], v[66:67]
  v_pk_add_f32 v[6:7], v[6:7], v[68:69]
  v_pk_add_f32 v[6:7], v[6:7], v[70:71]
  v_pk_add_f32 v[6:7], v[6:7], v[72:73]
  v_pk_add_f32 v[6:7], v[6:7], v[74:75]
  v_add_f32 v4, v6, v7
  v_mov_b32 v2, v4
  s_nop 1
  v_permlane32_swap_b32 v4, v2
  v_add_f32 v4, v4, v2
  v_mov_b32 v2, v4
  s_nop 1
  v_permlane16_swap_b32 v4, v2
  v_add_f32 v4, v4, v2
  ds_write_b32 v1, v4 offset:0
  s_waitcnt lgkmcnt(0)
  s_barrier
  ds_read_b32 v4, v5 offset:0
  ds_read_b32 v2, v5 offset:64
  ds_read_b32 v3, v5 offset:128
  ds_read_b32 v6, v5 offset:192
  s_waitcnt lgkmcnt(0)
  v_add_f32 v4, v4, v2
  v_add_f32 v3, v3, v6
  v_add_f32 v4, v4, v3
  v_mul_f32 v6, 0xbacccccd, v4
  v_mov_b32 v7, v6
  v_pk_add_f32 v[36:37], v[36:37], v[6:7]
  v_pk_add_f32 v[38:39], v[38:39], v[6:7]
  v_pk_add_f32 v[40:41], v[40:41], v[6:7]
  v_pk_add_f32 v[42:43], v[42:43], v[6:7]
  v_pk_add_f32 v[44:45], v[44:45], v[6:7]
  v_pk_add_f32 v[46:47], v[46:47], v[6:7]
  v_pk_add_f32 v[48:49], v[48:49], v[6:7]
  v_pk_add_f32 v[50:51], v[50:51], v[6:7]
  v_pk_add_f32 v[52:53], v[52:53], v[6:7]
  v_pk_add_f32 v[54:55], v[54:55], v[6:7]
  v_pk_add_f32 v[56:57], v[56:57], v[6:7]
  v_pk_add_f32 v[58:59], v[58:59], v[6:7]
  v_pk_add_f32 v[60:61], v[60:61], v[6:7]
  v_pk_add_f32 v[62:63], v[62:63], v[6:7]
  v_pk_add_f32 v[64:65], v[64:65], v[6:7]
  v_pk_add_f32 v[66:67], v[66:67], v[6:7]
  v_pk_add_f32 v[68:69], v[68:69], v[6:7]
  v_pk_add_f32 v[70:71], v[70:71], v[6:7]
  v_pk_add_f32 v[72:73], v[72:73], v[6:7]
  v_pk_add_f32 v[74:75], v[74:75], v[6:7]
  v_pk_mul_f32 v[6:7], v[36:37], v[36:37]
  v_pk_fma_f32 v[6:7], v[38:39], v[38:39], v[6:7]
  v_pk_fma_f32 v[6:7], v[40:41], v[40:41], v[6:7]
  v_pk_fma_f32 v[6:7], v[42:43], v[42:43], v[6:7]
  v_pk_fma_f32 v[6:7], v[44:45], v[44:45], v[6:7]
  v_pk_fma_f32 v[6:7], v[46:47], v[46:47], v[6:7]
  v_pk_fma_f32 v[6:7], v[48:49], v[48:49], v[6:7]
  v_pk_fma_f32 v[6:7], v[50:51], v[50:51], v[6:7]
  v_pk_fma_f32 v[6:7], v[52:53], v[52:53], v[6:7]
  v_pk_fma_f32 v[6:7], v[54:55], v[54:55], v[6:7]
  v_pk_fma_f32 v[6:7], v[56:57], v[56:57], v[6:7]
  v_pk_fma_f32 v[6:7], v[58:59], v[58:59], v[6:7]
  v_pk_fma_f32 v[6:7], v[60:61], v[60:61], v[6:7]
  v_pk_fma_f32 v[6:7], v[62:63], v[62:63], v[6:7]
  v_pk_fma_f32 v[6:7], v[64:65], v[64:65], v[6:7]
  v_pk_fma_f32 v[6:7], v[66:67], v[66:67], v[6:7]
  v_pk_fma_f32 v[6:7], v[68:69], v[68:69], v[6:7]
  v_pk_fma_f32 v[6:7], v[70:71], v[70:71], v[6:7]
  v_pk_fma_f32 v[6:7], v[72:73], v[72:73], v[6:7]
  v_pk_fma_f32 v[6:7], v[74:75], v[74:75], v[6:7]
  v_add_f32 v4, v6, v7
  v_mov_b32 v2, v4
  s_nop 1
  v_permlane32_swap_b32 v4, v2
  v_add_f32 v4, v4, v2
  v_mov_b32 v2, v4
  s_nop 1
  v_permlane16_swap_b32 v4, v2
  v_add_f32 v4, v4, v2
  ds_write_b32 v1, v4 offset:256
  s_waitcnt lgkmcnt(0)
  s_barrier
  ds_read_b32 v4, v5 offset:256
  ds_read_b32 v2, v5 offset:320
  ds_read_b32 v3, v5 offset:384
  ds_read_b32 v6, v5 offset:448
  s_waitcnt lgkmcnt(0)
  v_add_f32 v4, v4, v2
  v_add_f32 v3, v3, v6
  v_add_f32 v4, v4, v3
  v_mov_b32 v2, 0x3727c5ac
  v_fmac_f32 v2, 0x3acccccd, v4
  v_rsq_f32 v6, v2
  s_nop 0
  v_mov_b32 v7, v6
  v_pk_mul_f32 v[36:37], v[36:37], v[6:7]
  v_pk_mul_f32 v[38:39], v[38:39], v[6:7]
  v_pk_mul_f32 v[40:41], v[40:41], v[6:7]
  v_pk_mul_f32 v[42:43], v[42:43], v[6:7]
  v_pk_mul_f32 v[44:45], v[44:45], v[6:7]
  v_pk_mul_f32 v[46:47], v[46:47], v[6:7]
  v_pk_mul_f32 v[48:49], v[48:49], v[6:7]
  v_pk_mul_f32 v[50:51], v[50:51], v[6:7]
  v_pk_mul_f32 v[52:53], v[52:53], v[6:7]
  v_pk_mul_f32 v[54:55], v[54:55], v[6:7]
  v_pk_mul_f32 v[56:57], v[56:57], v[6:7]
  v_pk_mul_f32 v[58:59], v[58:59], v[6:7]
  v_pk_mul_f32 v[60:61], v[60:61], v[6:7]
  v_pk_mul_f32 v[62:63], v[62:63], v[6:7]
  v_pk_mul_f32 v[64:65], v[64:65], v[6:7]
  v_pk_mul_f32 v[66:67], v[66:67], v[6:7]
  v_pk_mul_f32 v[68:69], v[68:69], v[6:7]
  v_pk_mul_f32 v[70:71], v[70:71], v[6:7]
  v_pk_mul_f32 v[72:73], v[72:73], v[6:7]
  v_pk_mul_f32 v[74:75], v[74:75], v[6:7]
  v_cvt_pk_bf16_f32 v16, v36, v37
  v_cvt_pk_bf16_f32 v17, v38, v39
  v_cvt_pk_bf16_f32 v18, v40, v41
  v_cvt_pk_bf16_f32 v19, v42, v43
  v_cvt_pk_bf16_f32 v20, v44, v45
  v_cvt_pk_bf16_f32 v21, v46, v47
  v_cvt_pk_bf16_f32 v22, v48, v49
  v_cvt_pk_bf16_f32 v23, v50, v51
  v_cvt_pk_bf16_f32 v24, v52, v53
  v_cvt_pk_bf16_f32 v25, v54, v55
  v_cvt_pk_bf16_f32 v26, v56, v57
  v_cvt_pk_bf16_f32 v27, v58, v59
  v_cvt_pk_bf16_f32 v28, v60, v61
  v_cvt_pk_bf16_f32 v29, v62, v63
  v_cvt_pk_bf16_f32 v30, v64, v65
  v_cvt_pk_bf16_f32 v31, v66, v67
  v_cvt_pk_bf16_f32 v32, v68, v69
  v_cvt_pk_bf16_f32 v33, v70, v71
  v_cvt_pk_bf16_f32 v34, v72, v73
  v_cvt_pk_bf16_f32 v35, v74, v75
  v_and_b32 v3, 63, v0
  v_and_b32 v2, 15, v3
  v_lshlrev_b32 v1, 4, v2
  v_bfe_u32 v2, v3, 4, 1
  v_lshl_add_u32 v1, v2, 9, v1
  v_lshrrev_b32 v2, 5, v3
  v_lshl_add_u32 v1, v2, 10, v1
  s_lshr_b32 s17, s19, 1
  s_mul_i32 s17, s17, 40960
  s_and_b32 s18, s19, 1
  s_lshl_b32 s18, s18, 8
  s_add_u32 s17, s17, s18
  s_mul_i32 s18, s16, 10240
  s_add_u32 s17, s17, s18
  s_add_u32 s17, s17, 54525952
  buffer_store_dwordx4 v[16:19], v1, s[4:7], s17 offen offset:0 sc1
  buffer_store_dwordx4 v[20:23], v1, s[4:7], s17 offen offset:2048 sc1
  s_add_u32 s17, s17, 4096
  buffer_store_dwordx4 v[24:27], v1, s[4:7], s17 offen offset:0 sc1
  buffer_store_dwordx4 v[28:31], v1, s[4:7], s17 offen offset:2048 sc1
  s_add_u32 s17, s17, 4096
  buffer_store_dwordx4 v[32:35], v1, s[4:7], s17 offen offset:0 sc1
redln1_exit1:
  s_endpgm
.globl redln2_kernel
.p2align 8
.type redln2_kernel,@function
redln2_kernel:
  s_cmp_ge_u32 s2, 128
  s_cbranch_scc1 redln2_exit1
  s_load_dwordx2 s[12:13], s[0:1], 96
  s_load_dwordx2 s[14:15], s[0:1], 0
  v_lshrrev_b32 v2, 6, v0
  s_nop 0
  v_readfirstlane_b32 s16, v2
  s_waitcnt lgkmcnt(0)
  s_mov_b32 s4, s12
  s_mov_b32 s5, s13
  s_mov_b32 s6, 0x10000000
  s_mov_b32 s7, 0x20000
  s_mov_b32 s8, s12
  s_mov_b32 s9, s13
  s_mov_b32 s10, 0x10000000
  s_mov_b32 s11, 0x20000
  s_mov_b32 s20, 82313216
  s_mov_b32 s19, s2
  v_and_b32 v3, 63, v0
  v_lshlrev_b32 v14, 4, v3
  v_and_b32 v2, 15, v3
  v_lshrrev_b32 v4, 4, v3
  s_lshl_b32 s17, s19, 4
  v_add_u32 v15, s17, v2
  v_mul_u32_u24 v15, 1280, v15
  v_lshl_add_u32 v15, v4, 4, v15
  s_mul_i32 s17, s16, 320
  s_add_u32 s20, s20, s17
  s_add_u32 s21, s17, 82313216
  s_mul_i32 s22, s19, 20
  s_mul_i32 s23, s16, 5
  s_add_u32 s22, s22, s23
  s_lshl_b32 s22, s22, 10
  s_add_u32 s22, s22, 92798976
  s_add_u32 s24, s22, 0
  s_add_u32 s25, s22, 2621440
  s_add_u32 s26, s22, 5242880
  s_add_u32 s27, s22, 7864320
  s_add_u32 s28, s22, 10485760
  s_add_u32 s29, s22, 13107200
  s_add_u32 s30, s22, 15728640
  s_add_u32 s31, s22, 18350080
  v_add_u32 v6, 0x1000, v14
  buffer_load_dwordx4 v[16:19], v15, s[8:11], s20 offen offset:0
  buffer_load_dwordx4 v[20:23], v15, s[8:11], s20 offen offset:64
  buffer_load_dwordx4 v[24:27], v15, s[8:11], s20 offen offset:128
  buffer_load_dwordx4 v[28:31], v15, s[8:11], s20 offen offset:192
  buffer_load_dwordx4 v[32:35], v15, s[8:11], s20 offen offset:256
  buffer_load_dwordx4 v[80:83], v14, s[4:7], s24 offen offset:0
  buffer_load_dwordx4 v[84:87], v14, s[4:7], s25 offen offset:0
  buffer_load_dwordx4 v[88:91], v14, s[4:7], s26 offen offset:0
  buffer_load_dwordx4 v[92:95], v14, s[4:7], s27 offen offset:0
  buffer_load_dwordx4 v[96:99], v14, s[4:7], s28 offen offset:0
  buffer_load_dwordx4 v[100:103], v14, s[4:7], s29 offen offset:0
  buffer_load_dwordx4 v[104:107], v14, s[4:7], s30 offen offset:0
  buffer_load_dwordx4 v[108:111], v14, s[4:7], s31 offen offset:0
  buffer_load_dwordx4 v[112:115], v14, s[4:7], s24 offen offset:1024
  buffer_load_dwordx4 v[116:119], v14, s[4:7], s25 offen offset:1024
  buffer_load_dwordx4 v[120:123], v14, s[4:7], s26 offen offset:1024
  buffer_load_dwordx4 v[124:127], v14, s[4:7], s27 offen offset:1024
  buffer_load_dwordx4 v[128:131], v14, s[4:7], s28 offen offset:1024
  buffer_load_dwordx4 v[132:135], v14, s[4:7], s29 offen offset:1024
  buffer_load_dwordx4 v[136:139], v14, s[4:7], s30 offen offset:1024
  buffer_load_dwordx4 v[140:143], v14, s[4:7], s31 offen offset:1024
  buffer_load_dwordx4 v[144:147], v14, s[4:7], s24 offen offset:2048
  buffer_load_dwordx4 v[148:151], v14, s[4:7], s25 offen offset:2048
  buffer_load_dwordx4 v[152:155], v14, s[4:7], s26 offen offset:2048
  buffer_load_dwordx4 v[156:159], v14, s[4:7], s27 offen offset:2048
  buffer_load_dwordx4 v[160:163], v14, s[4:7], s28 offen offset:2048
  buffer_load_dwordx4 v[164:167], v14, s[4:7], s29 offen offset:2048
  buffer_load_dwordx4 v[168:171], v14, s[4:7], s30 offen offset:2048
  buffer_load_dwordx4 v[172:175], v14, s[4:7], s31 offen offset:2048
  buffer_load_dwordx4 v[176:179], v14, s[4:7], s24 offen offset:3072
  buffer_load_dwordx4 v[180:183], v14, s[4:7], s25 offen offset:3072
  buffer_load_dwordx4 v[184:187], v14, s[4:7], s26 offen offset:3072
  buffer_load_dwordx4 v[188:191], v14, s[4:7], s27 offen offset:3072
  buffer_load_dwordx4 v[192:195], v14, s[4:7], s28 offen offset:3072
  buffer_load_dwordx4 v[196:199], v14, s[4:7], s29 offen offset:3072
  buffer_load_dwordx4 v[200:203], v14, s[4:7], s30 offen offset:3072
  buffer_load_dwordx4 v[204:207], v14, s[4:7], s31 offen offset:3072
  buffer_load_dwordx4 v[208:211], v6, s[4:7], s24 offen offset:0
  buffer_load_dwordx4 v[212:215], v6, s[4:7], s25 offen offset:0
  buffer_load_dwordx4 v[216:219], v6, s[4:7], s26 offen offset:0
  buffer_load_dwordx4 v[220:223], v6, s[4:7], s27 offen offset:0
  buffer_load_dwordx4 v[224:227], v6, s[4:7], s28 offen offset:0
  buffer_load_dwordx4 v[228:231], v6, s[4:7], s29 offen offset:0
  buffer_load_dwordx4 v[232:235], v6, s[4:7], s30 offen offset:0
  buffer_load_dwordx4 v[236:239], v6, s[4:7], s31 offen offset:0
  s_waitcnt vmcnt(32)
  v_lshlrev_b32 v36, 16, v80
  v_and_b32 v37, 0xffff0000, v80
  v_lshlrev_b32 v38, 16, v81
  v_and_b32 v39, 0xffff0000, v81
  v_lshlrev_b32 v40, 16, v82
  v_and_b32 v41, 0xffff0000, v82
  v_lshlrev_b32 v42, 16, v83
  v_and_b32 v43, 0xffff0000, v83
  v_lshlrev_b32 v8, 16, v84
  v_and_b32 v9, 0xffff0000, v84
  v_pk_add_f32 v[36:37], v[36:37], v[8:9]
  v_lshlrev_b32 v8, 16, v85
  v_and_b32 v9, 0xffff0000, v85
  v_pk_add_f32 v[38:39], v[38:39], v[8:9]
  v_lshlrev_b32 v8, 16, v86
  v_and_b32 v9, 0xffff0000, v86
  v_pk_add_f32 v[40:41], v[40:41], v[8:9]
  v_lshlrev_b32 v8, 16, v87
  v_and_b32 v9, 0xffff0000, v87
  v_pk_add_f32 v[42:43], v[42:43], v[8:9]
  v_lshlrev_b32 v8, 16, v88
  v_and_b32 v9, 0xffff0000, v88
  v_pk_add_f32 v[36:37], v[36:37], v[8:9]
  v_lshlrev_b32 v8, 16, v89
  v_and_b32 v9, 0xffff0000, v89
  v_pk_add_f32 v[38:39], v[38:39], v[8:9]
  v_lshlrev_b32 v8, 16, v90
  v_and_b32 v9, 0xffff0000, v90
  v_pk_add_f32 v[40:41], v[40:41], v[8:9]
  v_lshlrev_b32 v8, 16, v91
  v_and_b32 v9, 0xffff0000, v91
  v_pk_add_f32 v[42:43], v[42:43], v[8:9]
  v_lshlrev_b32 v8, 16, v92
  v_and_b32 v9, 0xffff0000, v92
  v_pk_add_f32 v[36:37], v[36:37], v[8:9]
  v_lshlrev_b32 v8, 16, v93
  v_and_b32 v9, 0xffff0000, v93
  v_pk_add_f32 v[38:39], v[38:39], v[8:9]
  v_lshlrev_b32 v8, 16, v94
  v_and_b32 v9, 0xffff0000, v94
  v_pk_add_f32 v[40:41], v[40:41], v[8:9]
  v_lshlrev_b32 v8, 16, v95
  v_and_b32 v9, 0xffff0000, v95
  v_pk_add_f32 v[42:43], v[42:43], v[8:9]
  v_lshlrev_b32 v8, 16, v96
  v_and_b32 v9, 0xffff0000, v96
  v_pk_add_f32 v[36:37], v[36:37], v[8:9]
  v_lshlrev_b32 v8, 16, v97
  v_and_b32 v9, 0xffff0000, v97
  v_pk_add_f32 v[38:39], v[38:39], v[8:9]
  v_lshlrev_b32 v8, 16, v98
  v_and_b32 v9, 0xffff0000, v98
  v_pk_add_f32 v[40:41], v[40:41], v[8:9]
  v_lshlrev_b32 v8, 16, v99
  v_and_b32 v9, 0xffff0000, v99
  v_pk_add_f32 v[42:43], v[42:43], v[8:9]
  v_lshlrev_b32 v8, 16, v100
  v_and_b32 v9, 0xffff0000, v100
  v_pk_add_f32 v[36:37], v[36:37], v[8:9]
  v_lshlrev_b32 v8, 16, v101
  v_and_b32 v9, 0xffff0000, v101
  v_pk_add_f32 v[38:39], v[38:39], v[8:9]
  v_lshlrev_b32 v8, 16, v102
  v_and_b32 v9, 0xffff0000, v102
  v_pk_add_f32 v[40:41], v[40:41], v[8:9]
  v_lshlrev_b32 v8, 16, v103
  v_and_b32 v9, 0xffff0000, v103
  v_pk_add_f32 v[42:43], v[42:43], v[8:9]
  v_lshlrev_b32 v8, 16, v104
  v_and_b32 v9, 0xffff0000, v104
  v_pk_add_f32 v[36:37], v[36:37], v[8:9]
  v_lshlrev_b32 v8, 16, v105
  v_and_b32 v9, 0xffff0000, v105
  v_pk_add_f32 v[38:39], v[38:39], v[8:9]
  v_lshlrev_b32 v8, 16, v106
  v_and_b32 v9, 0xffff0000, v106
  v_pk_add_f32 v[40:41], v[40:41], v[8:9]
  v_lshlrev_b32 v8, 16, v107
  v_and_b32 v9, 0xffff0000, v107
  v_pk_add_f32 v[42:43], v[42:43], v[8:9]
  v_lshlrev_b32 v8, 16, v108
  v_and_b32 v9, 0xffff0000, v108
  v_pk_add_f32 v[36:37], v[36:37], v[8:9]
  v_lshlrev_b32 v8, 16, v109
  v_and_b32 v9, 0xffff0000, v109
  v_pk_add_f32 v[38:39], v[38:39], v[8:9]
  v_lshlrev_b32 v8, 16, v110
  v_and_b32 v9, 0xffff0000, v110
  v_pk_add_f32 v[40:41], v[40:41], v[8:9]
  v_lshlrev_b32 v8, 16, v111
  v_and_b32 v9, 0xffff0000, v111
  v_pk_add_f32 v[42:43], v[42:43], v[8:9]
  v_cvt_pk_bf16_f32 v8, v36, v37
  v_lshlrev_b32 v36, 16, v8
  v_and_b32 v37, 0xffff0000, v8
  v_lshlrev_b32 v10, 16, v16
  v_and_b32 v11, 0xffff0000, v16
  v_pk_add_f32 v[36:37], v[36:37], v[10:11]
  v_cvt_pk_bf16_f32 v16, v36, v37
  v_lshlrev_b32 v36, 16, v16
  v_and_b32 v37, 0xffff0000, v16
  v_cvt_pk_bf16_f32 v8, v38, v39
  v_lshlrev_b32 v38, 16, v8
  v_and_b32 v39, 0xffff0000, v8
  v_lshlrev_b32 v10, 16, v17
  v_and_b32 v11, 0xffff0000, v17
  v_pk_add_f32 v[38:39], v[38:39], v[10:11]
  v_cvt_pk_bf16_f32 v17, v38, v39
  v_lshlrev_b32 v38, 16, v17
  v_and_b32 v39, 0xffff0000, v17
  v_cvt_pk_bf16_f32 v8, v40, v41
  v_lshlrev_b32 v40, 16, v8
  v_and_b32 v41, 0xffff0000, v8
  v_lshlrev_b32 v10, 16, v18
  v_and_b32 v11, 0xffff0000, v18
  v_pk_add_f32 v[40:41], v[40:41], v[10:11]
  v_cvt_pk_bf16_f32 v18, v40, v41
  v_lshlrev_b32 v40, 16, v18
  v_and_b32 v41, 0xffff0000, v18
  v_cvt_pk_bf16_f32 v8, v42, v43
  v_lshlrev_b32 v42, 16, v8
  v_and_b32 v43, 0xffff0000, v8
  v_lshlrev_b32 v10, 16, v19
  v_and_b32 v11, 0xffff0000, v19
  v_pk_add_f32 v[42:43], v[42:43], v[10:11]
  v_cvt_pk_bf16_f32 v19, v42, v43
  v_lshlrev_b32 v42, 16, v19
  v_and_b32 v43, 0xffff0000, v19
  buffer_store_dwordx4 v[16:19], v15, s[4:7], s21 offen offset:0 sc1
  s_waitcnt vmcnt(25)
  v_lshlrev_b32 v44, 16, v112
  v_and_b32 v45, 0xffff0000, v112
  v_lshlrev_b32 v46, 16, v113
  v_and_b32 v47, 0xffff0000, v113
  v_lshlrev_b32 v48, 16, v114
  v_and_b32 v49, 0xffff0000, v114
  v_lshlrev_b32 v50, 16, v115
  v_and_b32 v51, 0xffff0000, v115
  v_lshlrev_b32 v8, 16, v116
  v_and_b32 v9, 0xffff0000, v116
  v_pk_add_f32 v[44:45], v[44:45], v[8:9]
  v_lshlrev_b32 v8, 16, v117
  v_and_b32 v9, 0xffff0000, v117
  v_pk_add_f32 v[46:47], v[46:47], v[8:9]
  v_lshlrev_b32 v8, 16, v118
  v_and_b32 v9, 0xffff0000, v118
  v_pk_add_f32 v[48:49], v[48:49], v[8:9]
  v_lshlrev_b32 v8, 16, v119
  v_and_b32 v9, 0xffff0000, v119
  v_pk_add_f32 v[50:51], v[50:51], v[8:9]
  v_lshlrev_b32 v8, 16, v120
  v_and_b32 v9, 0xffff0000, v120
  v_pk_add_f32 v[44:45], v[44:45], v[8:9]
  v_lshlrev_b32 v8, 16, v121
  v_and_b32 v9, 0xffff0000, v121
  v_pk_add_f32 v[46:47], v[46:47], v[8:9]
  v_lshlrev_b32 v8, 16, v122
  v_and_b32 v9, 0xffff0000, v122
  v_pk_add_f32 v[48:49], v[48:49], v[8:9]
  v_lshlrev_b32 v8, 16, v123
  v_and_b32 v9, 0xffff0000, v123
  v_pk_add_f32 v[50:51], v[50:51], v[8:9]
  v_lshlrev_b32 v8, 16, v124
  v_and_b32 v9, 0xffff0000, v124
  v_pk_add_f32 v[44:45], v[44:45], v[8:9]
  v_lshlrev_b32 v8, 16, v125
  v_and_b32 v9, 0xffff0000, v125
  v_pk_add_f32 v[46:47], v[46:47], v[8:9]
  v_lshlrev_b32 v8, 16, v126
  v_and_b32 v9, 0xffff0000, v126
  v_pk_add_f32 v[48:49], v[48:49], v[8:9]
  v_lshlrev_b32 v8, 16, v127
  v_and_b32 v9, 0xffff0000, v127
  v_pk_add_f32 v[50:51], v[50:51], v[8:9]
  v_lshlrev_b32 v8, 16, v128
  v_and_b32 v9, 0xffff0000, v128
  v_pk_add_f32 v[44:45], v[44:45], v[8:9]
  v_lshlrev_b32 v8, 16, v129
  v_and_b32 v9, 0xffff0000, v129
  v_pk_add_f32 v[46:47], v[46:47], v[8:9]
  v_lshlrev_b32 v8, 16, v130
  v_and_b32 v9, 0xffff0000, v130
  v_pk_add_f32 v[48:49], v[48:49], v[8:9]
  v_lshlrev_b32 v8, 16, v131
  v_and_b32 v9, 0xffff0000, v131
  v_pk_add_f32 v[50:51], v[50:51], v[8:9]
  v_lshlrev_b32 v8, 16, v132
  v_and_b32 v9, 0xffff0000, v132
  v_pk_add_f32 v[44:45], v[44:45], v[8:9]
  v_lshlrev_b32 v8, 16, v133
  v_and_b32 v9, 0xffff0000, v133
  v_pk_add_f32 v[46:47], v[46:47], v[8:9]
  v_lshlrev_b32 v8, 16, v134
  v_and_b32 v9, 0xffff0000, v134
  v_pk_add_f32 v[48:49], v[48:49], v[8:9]
  v_lshlrev_b32 v8, 16, v135
  v_and_b32 v9, 0xffff0000, v135
  v_pk_add_f32 v[50:51], v[50:51], v[8:9]
  v_lshlrev_b32 v8, 16, v136
  v_and_b32 v9, 0xffff0000, v136
  v_pk_add_f32 v[44:45], v[44:45], v[8:9]
  v_lshlrev_b32 v8, 16, v137
  v_and_b32 v9, 0xffff0000, v137
  v_pk_add_f32 v[46:47], v[46:47], v[8:9]
  v_lshlrev_b32 v8, 16, v138
  v_and_b32 v9, 0xffff0000, v138
  v_pk_add_f32 v[48:49], v[48:49], v[8:9]
  v_lshlrev_b32 v8, 16, v139
  v_and_b32 v9, 0xffff0000, v139
  v_pk_add_f32 v[50:51], v[50:51], v[8:9]
  v_lshlrev_b32 v8, 16, v140
  v_and_b32 v9, 0xffff0000, v140
  v_pk_add_f32 v[44:45], v[44:45], v[8:9]
  v_lshlrev_b32 v8, 16, v141
  v_and_b32 v9, 0xffff0000, v141
  v_pk_add_f32 v[46:47], v[46:47], v[8:9]
  v_lshlrev_b32 v8, 16, v142
  v_and_b32 v9, 0xffff0000, v142
  v_pk_add_f32 v[48:49], v[48:49], v[8:9]
  v_lshlrev_b32 v8, 16, v143
  v_and_b32 v9, 0xffff0000, v143
  v_pk_add_f32 v[50:51], v[50:51], v[8:9]
  v_cvt_pk_bf16_f32 v8, v44, v45
  v_lshlrev_b32 v44, 16, v8
  v_and_b32 v45, 0xffff0000, v8
  v_lshlrev_b32 v10, 16, v20
  v_and_b32 v11, 0xffff0000, v20
  v_pk_add_f32 v[44:45], v[44:45], v[10:11]
  v_cvt_pk_bf16_f32 v20, v44, v45
  v_lshlrev_b32 v44, 16, v20
  v_and_b32 v45, 0xffff0000, v20
  v_cvt_pk_bf16_f32 v8, v46, v47
  v_lshlrev_b32 v46, 16, v8
  v_and_b32 v47, 0xffff0000, v8
  v_lshlrev_b32 v10, 16, v21
  v_and_b32 v11, 0xffff0000, v21
  v_pk_add_f32 v[46:47], v[46:47], v[10:11]
  v_cvt_pk_bf16_f32 v21, v46, v47
  v_lshlrev_b32 v46, 16, v21
  v_and_b32 v47, 0xffff0000, v21
  v_cvt_pk_bf16_f32 v8, v48, v49
  v_lshlrev_b32 v48, 16, v8
  v_and_b32 v49, 0xffff0000, v8
  v_lshlrev_b32 v10, 16, v22
  v_and_b32 v11, 0xffff0000, v22
  v_pk_add_f32 v[48:49], v[48:49], v[10:11]
  v_cvt_pk_bf16_f32 v22, v48, v49
  v_lshlrev_b32 v48, 16, v22
  v_and_b32 v49, 0xffff0000, v22
  v_cvt_pk_bf16_f32 v8, v50, v51
  v_lshlrev_b32 v50, 16, v8
  v_and_b32 v51, 0xffff0000, v8
  v_lshlrev_b32 v10, 16, v23
  v_and_b32 v11, 0xffff0000, v23
  v_pk_add_f32 v[50:51], v[50:51], v[10:11]
  v_cvt_pk_bf16_f32 v23, v50, v51
  v_lshlrev_b32 v50, 16, v23
  v_and_b32 v51, 0xffff0000, v23
  buffer_store_dwordx4 v[20:23], v15, s[4:7], s21 offen offset:64 sc1
  s_waitcnt vmcnt(18)
  v_lshlrev_b32 v52, 16, v144
  v_and_b32 v53, 0xffff0000, v144
  v_lshlrev_b32 v54, 16, v145
  v_and_b32 v55, 0xffff0000, v145
  v_lshlrev_b32 v56, 16, v146
  v_and_b32 v57, 0xffff0000, v146
  v_lshlrev_b32 v58, 16, v147
  v_and_b32 v59, 0xffff0000, v147
  v_lshlrev_b32 v8, 16, v148
  v_and_b32 v9, 0xffff0000, v148
  v_pk_add_f32 v[52:53], v[52:53], v[8:9]
  v_lshlrev_b32 v8, 16, v149
  v_and_b32 v9, 0xffff0000, v149
  v_pk_add_f32 v[54:55], v[54:55], v[8:9]
  v_lshlrev_b32 v8, 16, v150
  v_and_b32 v9, 0xffff0000, v150
  v_pk_add_f32 v[56:57], v[56:57], v[8:9]
  v_lshlrev_b32 v8, 16, v151
  v_and_b32 v9, 0xffff0000, v151
  v_pk_add_f32 v[58:59], v[58:59], v[8:9]
  v_lshlrev_b32 v8, 16, v152
  v_and_b32 v9, 0xffff0000, v152
  v_pk_add_f32 v[52:53], v[52:53], v[8:9]
  v_lshlrev_b32 v8, 16, v153
  v_and_b32 v9, 0xffff0000, v153
  v_pk_add_f32 v[54:55], v[54:55], v[8:9]
  v_lshlrev_b32 v8, 16, v154
  v_and_b32 v9, 0xffff0000, v154
  v_pk_add_f32 v[56:57], v[56:57], v[8:9]
  v_lshlrev_b32 v8, 16, v155
  v_and_b32 v9, 0xffff0000, v155
  v_pk_add_f32 v[58:59], v[58:59], v[8:9]
  v_lshlrev_b32 v8, 16, v156
  v_and_b32 v9, 0xffff0000, v156
  v_pk_add_f32 v[52:53], v[52:53], v[8:9]
  v_lshlrev_b32 v8, 16, v157
  v_and_b32 v9, 0xffff0000, v157
  v_pk_add_f32 v[54:55], v[54:55], v[8:9]
  v_lshlrev_b32 v8, 16, v158
  v_and_b32 v9, 0xffff0000, v158
  v_pk_add_f32 v[56:57], v[56:57], v[8:9]
  v_lshlrev_b32 v8, 16, v159
  v_and_b32 v9, 0xffff0000, v159
  v_pk_add_f32 v[58:59], v[58:59], v[8:9]
  v_lshlrev_b32 v8, 16, v160
  v_and_b32 v9, 0xffff0000, v160
  v_pk_add_f32 v[52:53], v[52:53], v[8:9]
  v_lshlrev_b32 v8, 16, v161
  v_and_b32 v9, 0xffff0000, v161
  v_pk_add_f32 v[54:55], v[54:55], v[8:9]
  v_lshlrev_b32 v8, 16, v162
  v_and_b32 v9, 0xffff0000, v162
  v_pk_add_f32 v[56:57], v[56:57], v[8:9]
  v_lshlrev_b32 v8, 16, v163
  v_and_b32 v9, 0xffff0000, v163
  v_pk_add_f32 v[58:59], v[58:59], v[8:9]
  v_lshlrev_b32 v8, 16, v164
  v_and_b32 v9, 0xffff0000, v164
  v_pk_add_f32 v[52:53], v[52:53], v[8:9]
  v_lshlrev_b32 v8, 16, v165
  v_and_b32 v9, 0xffff0000, v165
  v_pk_add_f32 v[54:55], v[54:55], v[8:9]
  v_lshlrev_b32 v8, 16, v166
  v_and_b32 v9, 0xffff0000, v166
  v_pk_add_f32 v[56:57], v[56:57], v[8:9]
  v_lshlrev_b32 v8, 16, v167
  v_and_b32 v9, 0xffff0000, v167
  v_pk_add_f32 v[58:59], v[58:59], v[8:9]
  v_lshlrev_b32 v8, 16, v168
  v_and_b32 v9, 0xffff0000, v168
  v_pk_add_f32 v[52:53], v[52:53], v[8:9]
  v_lshlrev_b32 v8, 16, v169
  v_and_b32 v9, 0xffff0000, v169
  v_pk_add_f32 v[54:55], v[54:55], v[8:9]
  v_lshlrev_b32 v8, 16, v170
  v_and_b32 v9, 0xffff0000, v170
  v_pk_add_f32 v[56:57], v[56:57], v[8:9]
  v_lshlrev_b32 v8, 16, v171
  v_and_b32 v9, 0xffff0000, v171
  v_pk_add_f32 v[58:59], v[58:59], v[8:9]
  v_lshlrev_b32 v8, 16, v172
  v_and_b32 v9, 0xffff0000, v172
  v_pk_add_f32 v[52:53], v[52:53], v[8:9]
  v_lshlrev_b32 v8, 16, v173
  v_and_b32 v9, 0xffff0000, v173
  v_pk_add_f32 v[54:55], v[54:55], v[8:9]
  v_lshlrev_b32 v8, 16, v174
  v_and_b32 v9, 0xffff0000, v174
  v_pk_add_f32 v[56:57], v[56:57], v[8:9]
  v_lshlrev_b32 v8, 16, v175
  v_and_b32 v9, 0xffff0000, v175
  v_pk_add_f32 v[58:59], v[58:59], v[8:9]
  v_cvt_pk_bf16_f32 v8, v52, v53
  v_lshlrev_b32 v52, 16, v8
  v_and_b32 v53, 0xffff0000, v8
  v_lshlrev_b32 v10, 16, v24
  v_and_b32 v11, 0xffff0000, v24
  v_pk_add_f32 v[52:53], v[52:53], v[10:11]
  v_cvt_pk_bf16_f32 v24, v52, v53
  v_lshlrev_b32 v52, 16, v24
  v_and_b32 v53, 0xffff0000, v24
  v_cvt_pk_bf16_f32 v8, v54, v55
  v_lshlrev_b32 v54, 16, v8
  v_and_b32 v55, 0xffff0000, v8
  v_lshlrev_b32 v10, 16, v25
  v_and_b32 v11, 0xffff0000, v25
  v_pk_add_f32 v[54:55], v[54:55], v[10:11]
  v_cvt_pk_bf16_f32 v25, v54, v55
  v_lshlrev_b32 v54, 16, v25
  v_and_b32 v55, 0xffff0000, v25
  v_cvt_pk_bf16_f32 v8, v56, v57
  v_lshlrev_b32 v56, 16, v8
  v_and_b32 v57, 0xffff0000, v8
  v_lshlrev_b32 v10, 16, v26
  v_and_b32 v11, 0xffff0000, v26
  v_pk_add_f32 v[56:57], v[56:57], v[10:11]
  v_cvt_pk_bf16_f32 v26, v56, v57
  v_lshlrev_b32 v56, 16, v26
  v_and_b32 v57, 0xffff0000, v26
  v_cvt_pk_bf16_f32 v8, v58, v59
  v_lshlrev_b32 v58, 16, v8
  v_and_b32 v59, 0xffff0000, v8
  v_lshlrev_b32 v10, 16, v27
  v_and_b32 v11, 0xffff0000, v27
  v_pk_add_f32 v[58:59], v[58:59], v[10:11]
  v_cvt_pk_bf16_f32 v27, v58, v59
  v_lshlrev_b32 v58, 16, v27
  v_and_b32 v59, 0xffff0000, v27
  buffer_store_dwordx4 v[24:27], v15, s[4:7], s21 offen offset:128 sc1
  s_waitcnt vmcnt(11)
  v_lshlrev_b32 v60, 16, v176
  v_and_b32 v61, 0xffff0000, v176
  v_lshlrev_b32 v62, 16, v177
  v_and_b32 v63, 0xffff0000, v177
  v_lshlrev_b32 v64, 16, v178
  v_and_b32 v65, 0xffff0000, v178
  v_lshlrev_b32 v66, 16, v179
  v_and_b32 v67, 0xffff0000, v179
  v_lshlrev_b32 v8, 16, v180
  v_and_b32 v9, 0xffff0000, v180
  v_pk_add_f32 v[60:61], v[60:61], v[8:9]
  v_lshlrev_b32 v8, 16, v181
  v_and_b32 v9, 0xffff0000, v181
  v_pk_add_f32 v[62:63], v[62:63], v[8:9]
  v_lshlrev_b32 v8, 16, v182
  v_and_b32 v9, 0xffff0000, v182
  v_pk_add_f32 v[64:65], v[64:65], v[8:9]
  v_lshlrev_b32 v8, 16, v183
  v_and_b32 v9, 0xffff0000, v183
  v_pk_add_f32 v[66:67], v[66:67], v[8:9]
  v_lshlrev_b32 v8, 16, v184
  v_and_b32 v9, 0xffff0000, v184
  v_pk_add_f32 v[60:61], v[60:61], v[8:9]
  v_lshlrev_b32 v8, 16, v185
  v_and_b32 v9, 0xffff0000, v185
  v_pk_add_f32 v[62:63], v[62:63], v[8:9]
  v_lshlrev_b32 v8, 16, v186
  v_and_b32 v9, 0xffff0000, v186
  v_pk_add_f32 v[64:65], v[64:65], v[8:9]
  v_lshlrev_b32 v8, 16, v187
  v_and_b32 v9, 0xffff0000, v187
  v_pk_add_f32 v[66:67], v[66:67], v[8:9]
  v_lshlrev_b32 v8, 16, v188
  v_and_b32 v9, 0xffff0000, v188
  v_pk_add_f32 v[60:61], v[60:61], v[8:9]
  v_lshlrev_b32 v8, 16, v189
  v_and_b32 v9, 0xffff0000, v189
  v_pk_add_f32 v[62:63], v[62:63], v[8:9]
  v_lshlrev_b32 v8, 16, v190
  v_and_b32 v9, 0xffff0000, v190
  v_pk_add_f32 v[64:65], v[64:65], v[8:9]
  v_lshlrev_b32 v8, 16, v191
  v_and_b32 v9, 0xffff0000, v191
  v_pk_add_f32 v[66:67], v[66:67], v[8:9]
  v_lshlrev_b32 v8, 16, v192
  v_and_b32 v9, 0xffff0000, v192
  v_pk_add_f32 v[60:61], v[60:61], v[8:9]
  v_lshlrev_b32 v8, 16, v193
  v_and_b32 v9, 0xffff0000, v193
  v_pk_add_f32 v[62:63], v[62:63], v[8:9]
  v_lshlrev_b32 v8, 16, v194
  v_and_b32 v9, 0xffff0000, v194
  v_pk_add_f32 v[64:65], v[64:65], v[8:9]
  v_lshlrev_b32 v8, 16, v195
  v_and_b32 v9, 0xffff0000, v195
  v_pk_add_f32 v[66:67], v[66:67], v[8:9]
  v_lshlrev_b32 v8, 16, v196
  v_and_b32 v9, 0xffff0000, v196
  v_pk_add_f32 v[60:61], v[60:61], v[8:9]
  v_lshlrev_b32 v8, 16, v197
  v_and_b32 v9, 0xffff0000, v197
  v_pk_add_f32 v[62:63], v[62:63], v[8:9]
  v_lshlrev_b32 v8, 16, v198
  v_and_b32 v9, 0xffff0000, v198
  v_pk_add_f32 v[64:65], v[64:65], v[8:9]
  v_lshlrev_b32 v8, 16, v199
  v_and_b32 v9, 0xffff0000, v199
  v_pk_add_f32 v[66:67], v[66:67], v[8:9]
  v_lshlrev_b32 v8, 16, v200
  v_and_b32 v9, 0xffff0000, v200
  v_pk_add_f32 v[60:61], v[60:61], v[8:9]
  v_lshlrev_b32 v8, 16, v201
  v_and_b32 v9, 0xffff0000, v201
  v_pk_add_f32 v[62:63], v[62:63], v[8:9]
  v_lshlrev_b32 v8, 16, v202
  v_and_b32 v9, 0xffff0000, v202
  v_pk_add_f32 v[64:65], v[64:65], v[8:9]
  v_lshlrev_b32 v8, 16, v203
  v_and_b32 v9, 0xffff0000, v203
  v_pk_add_f32 v[66:67], v[66:67], v[8:9]
  v_lshlrev_b32 v8, 16, v204
  v_and_b32 v9, 0xffff0000, v204
  v_pk_add_f32 v[60:61], v[60:61], v[8:9]
  v_lshlrev_b32 v8, 16, v205
  v_and_b32 v9, 0xffff0000, v205
  v_pk_add_f32 v[62:63], v[62:63], v[8:9]
  v_lshlrev_b32 v8, 16, v206
  v_and_b32 v9, 0xffff0000, v206
  v_pk_add_f32 v[64:65], v[64:65], v[8:9]
  v_lshlrev_b32 v8, 16, v207
  v_and_b32 v9, 0xffff0000, v207
  v_pk_add_f32 v[66:67], v[66:67], v[8:9]
  v_cvt_pk_bf16_f32 v8, v60, v61
  v_lshlrev_b32 v60, 16, v8
  v_and_b32 v61, 0xffff0000, v8
  v_lshlrev_b32 v10, 16, v28
  v_and_b32 v11, 0xffff0000, v28
  v_pk_add_f32 v[60:61], v[60:61], v[10:11]
  v_cvt_pk_bf16_f32 v28, v60, v61
  v_lshlrev_b32 v60, 16, v28
  v_and_b32 v61, 0xffff0000, v28
  v_cvt_pk_bf16_f32 v8, v62, v63
  v_lshlrev_b32 v62, 16, v8
  v_and_b32 v63, 0xffff0000, v8
  v_lshlrev_b32 v10, 16, v29
  v_and_b32 v11, 0xffff0000, v29
  v_pk_add_f32 v[62:63], v[62:63], v[10:11]
  v_cvt_pk_bf16_f32 v29, v62, v63
  v_lshlrev_b32 v62, 16, v29
  v_and_b32 v63, 0xffff0000, v29
  v_cvt_pk_bf16_f32 v8, v64, v65
  v_lshlrev_b32 v64, 16, v8
  v_and_b32 v65, 0xffff0000, v8
  v_lshlrev_b32 v10, 16, v30
  v_and_b32 v11, 0xffff0000, v30
  v_pk_add_f32 v[64:65], v[64:65], v[10:11]
  v_cvt_pk_bf16_f32 v30, v64, v65
  v_lshlrev_b32 v64, 16, v30
  v_and_b32 v65, 0xffff0000, v30
  v_cvt_pk_bf16_f32 v8, v66, v67
  v_lshlrev_b32 v66, 16, v8
  v_and_b32 v67, 0xffff0000, v8
  v_lshlrev_b32 v10, 16, v31
  v_and_b32 v11, 0xffff0000, v31
  v_pk_add_f32 v[66:67], v[66:67], v[10:11]
  v_cvt_pk_bf16_f32 v31, v66, v67
  v_lshlrev_b32 v66, 16, v31
  v_and_b32 v67, 0xffff0000, v31
  buffer_store_dwordx4 v[28:31], v15, s[4:7], s21 offen offset:192 sc1
  s_waitcnt vmcnt(4)
  v_lshlrev_b32 v68, 16, v208
  v_and_b32 v69, 0xffff0000, v208
  v_lshlrev_b32 v70, 16, v209
  v_and_b32 v71, 0xffff0000, v209
  v_lshlrev_b32 v72, 16, v210
  v_and_b32 v73, 0xffff0000, v210
  v_lshlrev_b32 v74, 16, v211
  v_and_b32 v75, 0xffff0000, v211
  v_lshlrev_b32 v8, 16, v212
  v_and_b32 v9, 0xffff0000, v212
  v_pk_add_f32 v[68:69], v[68:69], v[8:9]
  v_lshlrev_b32 v8, 16, v213
  v_and_b32 v9, 0xffff0000, v213
  v_pk_add_f32 v[70:71], v[70:71], v[8:9]
  v_lshlrev_b32 v8, 16, v214
  v_and_b32 v9, 0xffff0000, v214
  v_pk_add_f32 v[72:73], v[72:73], v[8:9]
  v_lshlrev_b32 v8, 16, v215
  v_and_b32 v9, 0xffff0000, v215
  v_pk_add_f32 v[74:75], v[74:75], v[8:9]
  v_lshlrev_b32 v8, 16, v216
  v_and_b32 v9, 0xffff0000, v216
  v_pk_add_f32 v[68:69], v[68:69], v[8:9]
  v_lshlrev_b32 v8, 16, v217
  v_and_b32 v9, 0xffff0000, v217
  v_pk_add_f32 v[70:71], v[70:71], v[8:9]
  v_lshlrev_b32 v8, 16, v218
  v_and_b32 v9, 0xffff0000, v218
  v_pk_add_f32 v[72:73], v[72:73], v[8:9]
  v_lshlrev_b32 v8, 16, v219
  v_and_b32 v9, 0xffff0000, v219
  v_pk_add_f32 v[74:75], v[74:75], v[8:9]
  v_lshlrev_b32 v8, 16, v220
  v_and_b32 v9, 0xffff0000, v220
  v_pk_add_f32 v[68:69], v[68:69], v[8:9]
  v_lshlrev_b32 v8, 16, v221
  v_and_b32 v9, 0xffff0000, v221
  v_pk_add_f32 v[70:71], v[70:71], v[8:9]
  v_lshlrev_b32 v8, 16, v222
  v_and_b32 v9, 0xffff0000, v222
  v_pk_add_f32 v[72:73], v[72:73], v[8:9]
  v_lshlrev_b32 v8, 16, v223
  v_and_b32 v9, 0xffff0000, v223
  v_pk_add_f32 v[74:75], v[74:75], v[8:9]
  v_lshlrev_b32 v8, 16, v224
  v_and_b32 v9, 0xffff0000, v224
  v_pk_add_f32 v[68:69], v[68:69], v[8:9]
  v_lshlrev_b32 v8, 16, v225
  v_and_b32 v9, 0xffff0000, v225
  v_pk_add_f32 v[70:71], v[70:71], v[8:9]
  v_lshlrev_b32 v8, 16, v226
  v_and_b32 v9, 0xffff0000, v226
  v_pk_add_f32 v[72:73], v[72:73], v[8:9]
  v_lshlrev_b32 v8, 16, v227
  v_and_b32 v9, 0xffff0000, v227
  v_pk_add_f32 v[74:75], v[74:75], v[8:9]
  v_lshlrev_b32 v8, 16, v228
  v_and_b32 v9, 0xffff0000, v228
  v_pk_add_f32 v[68:69], v[68:69], v[8:9]
  v_lshlrev_b32 v8, 16, v229
  v_and_b32 v9, 0xffff0000, v229
  v_pk_add_f32 v[70:71], v[70:71], v[8:9]
  v_lshlrev_b32 v8, 16, v230
  v_and_b32 v9, 0xffff0000, v230
  v_pk_add_f32 v[72:73], v[72:73], v[8:9]
  v_lshlrev_b32 v8, 16, v231
  v_and_b32 v9, 0xffff0000, v231
  v_pk_add_f32 v[74:75], v[74:75], v[8:9]
  v_lshlrev_b32 v8, 16, v232
  v_and_b32 v9, 0xffff0000, v232
  v_pk_add_f32 v[68:69], v[68:69], v[8:9]
  v_lshlrev_b32 v8, 16, v233
  v_and_b32 v9, 0xffff0000, v233
  v_pk_add_f32 v[70:71], v[70:71], v[8:9]
  v_lshlrev_b32 v8, 16, v234
  v_and_b32 v9, 0xffff0000, v234
  v_pk_add_f32 v[72:73], v[72:73], v[8:9]
  v_lshlrev_b32 v8, 16, v235
  v_and_b32 v9, 0xffff0000, v235
  v_pk_add_f32 v[74:75], v[74:75], v[8:9]
  v_lshlrev_b32 v8, 16, v236
  v_and_b32 v9, 0xffff0000, v236
  v_pk_add_f32 v[68:69], v[68:69], v[8:9]
  v_lshlrev_b32 v8, 16, v237
  v_and_b32 v9, 0xffff0000, v237
  v_pk_add_f32 v[70:71], v[70:71], v[8:9]
  v_lshlrev_b32 v8, 16, v238
  v_and_b32 v9, 0xffff0000, v238
  v_pk_add_f32 v[72:73], v[72:73], v[8:9]
  v_lshlrev_b32 v8, 16, v239
  v_and_b32 v9, 0xffff0000, v239
  v_pk_add_f32 v[74:75], v[74:75], v[8:9]
  v_cvt_pk_bf16_f32 v8, v68, v69
  v_lshlrev_b32 v68, 16, v8
  v_and_b32 v69, 0xffff0000, v8
  v_lshlrev_b32 v10, 16, v32
  v_and_b32 v11, 0xffff0000, v32
  v_pk_add_f32 v[68:69], v[68:69], v[10:11]
  v_cvt_pk_bf16_f32 v32, v68, v69
  v_lshlrev_b32 v68, 16, v32
  v_and_b32 v69, 0xffff0000, v32
  v_cvt_pk_bf16_f32 v8, v70, v71
  v_lshlrev_b32 v70, 16, v8
  v_and_b32 v71, 0xffff0000, v8
  v_lshlrev_b32 v10, 16, v33
  v_and_b32 v11, 0xffff0000, v33
  v_pk_add_f32 v[70:71], v[70:71], v[10:11]
  v_cvt_pk_bf16_f32 v33, v70, v71
  v_lshlrev_b32 v70, 16, v33
  v_and_b32 v71, 0xffff0000, v33
  v_cvt_pk_bf16_f32 v8, v72, v73
  v_lshlrev_b32 v72, 16, v8
  v_and_b32 v73, 0xffff0000, v8
  v_lshlrev_b32 v10, 16, v34
  v_and_b32 v11, 0xffff0000, v34
  v_pk_add_f32 v[72:73], v[72:73], v[10:11]
  v_cvt_pk_bf16_f32 v34, v72, v73
  v_lshlrev_b32 v72, 16, v34
  v_and_b32 v73, 0xffff0000, v34
  v_cvt_pk_bf16_f32 v8, v74, v75
  v_lshlrev_b32 v74, 16, v8
  v_and_b32 v75, 0xffff0000, v8
  v_lshlrev_b32 v10, 16, v35
  v_and_b32 v11, 0xffff0000, v35
  v_pk_add_f32 v[74:75], v[74:75], v[10:11]
  v_cvt_pk_bf16_f32 v35, v74, v75
  v_lshlrev_b32 v74, 16, v35
  v_and_b32 v75, 0xffff0000, v35
  buffer_store_dwordx4 v[32:35], v15, s[4:7], s21 offen offset:256 sc1
  v_and_b32 v3, 63, v0
  v_and_b32 v2, 15, v3
  v_lshlrev_b32 v5, 2, v2
  s_lshl_b32 s17, s16, 6
  v_add_u32 v1, s17, v5
  v_pk_add_f32 v[6:7], v[36:37], v[38:39]
  v_pk_add_f32 v[6:7], v[6:7], v[40:41]
  v_pk_add_f32 v[6:7], v[6:7], v[42:43]
  v_pk_add_f32 v[6:7], v[6:7], v[44:45]
  v_pk_add_f32 v[6:7], v[6:7], v[46:47]
  v_pk_add_f32 v[6:7], v[6:7], v[48:49]
  v_pk_add_f32 v[6:7], v[6:7], v[50:51]
  v_pk_add_f32 v[6:7], v[6:7], v[52:53]
  v_pk_add_f32 v[6:7], v[6:7], v[54:55]
  v_pk_add_f32 v[6:7], v[6:7], v[56:57]
  v_pk_add_f32 v[6:7], v[6:7], v[58:59]
  v_pk_add_f32 v[6:7], v[6:7], v[60:61]
  v_pk_add_f32 v[6:7], v[6:7], v[62:63]
  v_pk_add_f32 v[6:7], v[6:7], v[64:65]
  v_pk_add_f32 v[6:7], v[6:7], v[66:67]
  v_pk_add_f32 v[6:7], v[6:7], v[68:69]
  v_pk_add_f32 v[6:7], v[6:7], v[70:71]
  v_pk_add_f32 v[6:7], v[6:7], v[72:73]
  v_pk_add_f32 v[6:7], v[6:7], v[74:75]
  v_add_f32 v4, v6, v7
  v_mov_b32 v2, v4
  s_nop 1
  v_permlane32_swap_b32 v4, v2
  v_add_f32 v4, v4, v2
  v_mov_b32 v2, v4
  s_nop 1
  v_permlane16_swap_b32 v4, v2
  v_add_f32 v4, v4, v2
  ds_write_b32 v1, v4 offset:0
  s_waitcnt lgkmcnt(0)
  s_barrier
  ds_read_b32 v4, v5 offset:0
  ds_read_b32 v2, v5 offset:64
  ds_read_b32 v3, v5 offset:128
  ds_read_b32 v6, v5 offset:192
  s_waitcnt lgkmcnt(0)
  v_add_f32 v4, v4, v2
  v_add_f32 v3, v3, v6
  v_add_f32 v4, v4, v3
  v_mul_f32 v6, 0xbacccccd, v4
  v_mov_b32 v7, v6
  v_pk_add_f32 v[36:37], v[36:37], v[6:7]
  v_pk_add_f32 v[38:39], v[38:39], v[6:7]
  v_pk_add_f32 v[40:41], v[40:41], v[6:7]
  v_pk_add_f32 v[42:43], v[42:43], v[6:7]
  v_pk_add_f32 v[44:45], v[44:45], v[6:7]
  v_pk_add_f32 v[46:47], v[46:47], v[6:7]
  v_pk_add_f32 v[48:49], v[48:49], v[6:7]
  v_pk_add_f32 v[50:51], v[50:51], v[6:7]
  v_pk_add_f32 v[52:53], v[52:53], v[6:7]
  v_pk_add_f32 v[54:55], v[54:55], v[6:7]
  v_pk_add_f32 v[56:57], v[56:57], v[6:7]
  v_pk_add_f32 v[58:59], v[58:59], v[6:7]
  v_pk_add_f32 v[60:61], v[60:61], v[6:7]
  v_pk_add_f32 v[62:63], v[62:63], v[6:7]
  v_pk_add_f32 v[64:65], v[64:65], v[6:7]
  v_pk_add_f32 v[66:67], v[66:67], v[6:7]
  v_pk_add_f32 v[68:69], v[68:69], v[6:7]
  v_pk_add_f32 v[70:71], v[70:71], v[6:7]
  v_pk_add_f32 v[72:73], v[72:73], v[6:7]
  v_pk_add_f32 v[74:75], v[74:75], v[6:7]
  v_pk_mul_f32 v[6:7], v[36:37], v[36:37]
  v_pk_fma_f32 v[6:7], v[38:39], v[38:39], v[6:7]
  v_pk_fma_f32 v[6:7], v[40:41], v[40:41], v[6:7]
  v_pk_fma_f32 v[6:7], v[42:43], v[42:43], v[6:7]
  v_pk_fma_f32 v[6:7], v[44:45], v[44:45], v[6:7]
  v_pk_fma_f32 v[6:7], v[46:47], v[46:47], v[6:7]
  v_pk_fma_f32 v[6:7], v[48:49], v[48:49], v[6:7]
  v_pk_fma_f32 v[6:7], v[50:51], v[50:51], v[6:7]
  v_pk_fma_f32 v[6:7], v[52:53], v[52:53], v[6:7]
  v_pk_fma_f32 v[6:7], v[54:55], v[54:55], v[6:7]
  v_pk_fma_f32 v[6:7], v[56:57], v[56:57], v[6:7]
  v_pk_fma_f32 v[6:7], v[58:59], v[58:59], v[6:7]
  v_pk_fma_f32 v[6:7], v[60:61], v[60:61], v[6:7]
  v_pk_fma_f32 v[6:7], v[62:63], v[62:63], v[6:7]
  v_pk_fma_f32 v[6:7], v[64:65], v[64:65], v[6:7]
  v_pk_fma_f32 v[6:7], v[66:67], v[66:67], v[6:7]
  v_pk_fma_f32 v[6:7], v[68:69], v[68:69], v[6:7]
  v_pk_fma_f32 v[6:7], v[70:71], v[70:71], v[6:7]
  v_pk_fma_f32 v[6:7], v[72:73], v[72:73], v[6:7]
  v_pk_fma_f32 v[6:7], v[74:75], v[74:75], v[6:7]
  v_add_f32 v4, v6, v7
  v_mov_b32 v2, v4
  s_nop 1
  v_permlane32_swap_b32 v4, v2
  v_add_f32 v4, v4, v2
  v_mov_b32 v2, v4
  s_nop 1
  v_permlane16_swap_b32 v4, v2
  v_add_f32 v4, v4, v2
  ds_write_b32 v1, v4 offset:256
  s_waitcnt lgkmcnt(0)
  s_barrier
  ds_read_b32 v4, v5 offset:256
  ds_read_b32 v2, v5 offset:320
  ds_read_b32 v3, v5 offset:384
  ds_read_b32 v6, v5 offset:448
  s_waitcnt lgkmcnt(0)
  v_add_f32 v4, v4, v2
  v_add_f32 v3, v3, v6
  v_add_f32 v4, v4, v3
  v_mov_b32 v2, 0x3727c5ac
  v_fmac_f32 v2, 0x3acccccd, v4
  v_rsq_f32 v6, v2
  s_nop 0
  v_mov_b32 v7, v6
  v_pk_mul_f32 v[36:37], v[36:37], v[6:7]
  v_pk_mul_f32 v[38:39], v[38:39], v[6:7]
  v_pk_mul_f32 v[40:41], v[40:41], v[6:7]
  v_pk_mul_f32 v[42:43], v[42:43], v[6:7]
  v_pk_mul_f32 v[44:45], v[44:45], v[6:7]
  v_pk_mul_f32 v[46:47], v[46:47], v[6:7]
  v_pk_mul_f32 v[48:49], v[48:49], v[6:7]
  v_pk_mul_f32 v[50:51], v[50:51], v[6:7]
  v_pk_mul_f32 v[52:53], v[52:53], v[6:7]
  v_pk_mul_f32 v[54:55], v[54:55], v[6:7]
  v_pk_mul_f32 v[56:57], v[56:57], v[6:7]
  v_pk_mul_f32 v[58:59], v[58:59], v[6:7]
  v_pk_mul_f32 v[60:61], v[60:61], v[6:7]
  v_pk_mul_f32 v[62:63], v[62:63], v[6:7]
  v_pk_mul_f32 v[64:65], v[64:65], v[6:7]
  v_pk_mul_f32 v[66:67], v[66:67], v[6:7]
  v_pk_mul_f32 v[68:69], v[68:69], v[6:7]
  v_pk_mul_f32 v[70:71], v[70:71], v[6:7]
  v_pk_mul_f32 v[72:73], v[72:73], v[6:7]
  v_pk_mul_f32 v[74:75], v[74:75], v[6:7]
  v_cvt_pk_bf16_f32 v16, v36, v37
  v_cvt_pk_bf16_f32 v17, v38, v39
  v_cvt_pk_bf16_f32 v18, v40, v41
  v_cvt_pk_bf16_f32 v19, v42, v43
  v_cvt_pk_bf16_f32 v20, v44, v45
  v_cvt_pk_bf16_f32 v21, v46, v47
  v_cvt_pk_bf16_f32 v22, v48, v49
  v_cvt_pk_bf16_f32 v23, v50, v51
  v_cvt_pk_bf16_f32 v24, v52, v53
  v_cvt_pk_bf16_f32 v25, v54, v55
  v_cvt_pk_bf16_f32 v26, v56, v57
  v_cvt_pk_bf16_f32 v27, v58, v59
  v_cvt_pk_bf16_f32 v28, v60, v61
  v_cvt_pk_bf16_f32 v29, v62, v63
  v_cvt_pk_bf16_f32 v30, v64, v65
  v_cvt_pk_bf16_f32 v31, v66, v67
  v_cvt_pk_bf16_f32 v32, v68, v69
  v_cvt_pk_bf16_f32 v33, v70, v71
  v_cvt_pk_bf16_f32 v34, v72, v73
  v_cvt_pk_bf16_f32 v35, v74, v75
  v_and_b32 v3, 63, v0
  v_and_b32 v2, 15, v3
  v_lshlrev_b32 v1, 4, v2
  v_bfe_u32 v2, v3, 4, 1
  v_lshl_add_u32 v1, v2, 9, v1
  v_lshrrev_b32 v2, 5, v3
  v_lshl_add_u32 v1, v2, 10, v1
  s_lshr_b32 s17, s19, 1
  s_mul_i32 s17, s17, 40960
  s_and_b32 s18, s19, 1
  s_lshl_b32 s18, s18, 8
  s_add_u32 s17, s17, s18
  s_mul_i32 s18, s16, 10240
  s_add_u32 s17, s17, s18
  s_add_u32 s17, s17, 54525952
  buffer_store_dwordx4 v[16:19], v1, s[4:7], s17 offen offset:0 sc1
  buffer_store_dwordx4 v[20:23], v1, s[4:7], s17 offen offset:2048 sc1
  s_add_u32 s17, s17, 4096
  buffer_store_dwordx4 v[24:27], v1, s[4:7], s17 offen offset:0 sc1
  buffer_store_dwordx4 v[28:31], v1, s[4:7], s17 offen offset:2048 sc1
  s_add_u32 s17, s17, 4096
  buffer_store_dwordx4 v[32:35], v1, s[4:7], s17 offen offset:0 sc1
redln2_exit1:
  s_endpgm
.globl qkvb_kernel
.p2align 8
.type qkvb_kernel,@function
qkvb_kernel:
  s_cmp_ge_u32 s2, 256
  s_cbranch_scc1 qkvb_exit1
  s_load_dwordx2 s[12:13], s[0:1], 96
  v_lshrrev_b32 v2, 6, v0
  v_and_b32 v3, 63, v0
  s_nop 0
  v_readfirstlane_b32 s16, v2
  v_lshlrev_b32 v8, 4, v3
  s_and_b32 s17, s2, 7
  s_lshr_b32 s18, s2, 3
  s_waitcnt lgkmcnt(0)
  s_mov_b32 s4, s12
  s_mov_b32 s5, s13
  s_mov_b32 s6, 0x10000000
  s_mov_b32 s7, 0x20000
  s_and_b32 s19, s16, 1
  s_lshr_b32 s20, s16, 1
  s_mul_i32 s22, s19, 40960
  s_mul_i32 s21, s20, 5120
  s_add_u32 s22, s22, s21
  s_mul_i32 s21, s18, 81920
  s_add_u32 s21, s21, s22
  s_add_u32 s21, s21, 54525952
  s_lshl_b32 s23, s17, 2
  s_add_u32 s23, s23, s16
  s_mul_i32 s24, s23, 40960
  s_add_u32 s24, s24, 87556096
  s_add_u32 s25, s24, 1310720
  s_add_u32 s26, s25, 1310720
  s_add_u32 m0, s22, 0
  s_add_u32 s27, s21, 0
  buffer_load_dwordx4 v8, s[4:7], s27 offen offset:0 lds
  buffer_load_dwordx4 v8, s[4:7], s27 offen offset:1024 lds
  buffer_load_dwordx4 v8, s[4:7], s27 offen offset:2048 lds
  buffer_load_dwordx4 v8, s[4:7], s27 offen offset:3072 lds
  s_add_u32 m0, s22, 4096
  s_add_u32 s27, s21, 4096
  buffer_load_dwordx4 v8, s[4:7], s27 offen lds
  buffer_load_dwordx4 a[0:3], v8, s[4:7], s24 offen offset:0
  buffer_load_dwordx4 a[4:7], v8, s[4:7], s25 offen offset:0
  buffer_load_dwordx4 a[8:11], v8, s[4:7], s26 offen offset:0
  buffer_load_dwordx4 a[12:15], v8, s[4:7], s24 offen offset:1024
  buffer_load_dwordx4 a[16:19], v8, s[4:7], s25 offen offset:1024
  buffer_load_dwordx4 a[20:23], v8, s[4:7], s26 offen offset:1024
  buffer_load_dwordx4 a[24:27], v8, s[4:7], s24 offen offset:2048
  buffer_load_dwordx4 a[28:31], v8, s[4:7], s25 offen offset:2048
  buffer_load_dwordx4 a[32:35], v8, s[4:7], s26 offen offset:2048
  buffer_load_dwordx4 a[36:39], v8, s[4:7], s24 offen offset:3072
  buffer_load_dwordx4 a[40:43], v8, s[4:7], s25 offen offset:3072
  buffer_load_dwordx4 a[44:47], v8, s[4:7], s26 offen offset:3072
  s_add_u32 s24, s24, 4096
  s_add_u32 s25, s25, 4096
  s_add_u32 s26, s26, 4096
  s_add_u32 m0, s22, 10240
  s_add_u32 s27, s21, 10240
  buffer_load_dwordx4 v8, s[4:7], s27 offen offset:0 lds
  buffer_load_dwordx4 v8, s[4:7], s27 offen offset:1024 lds
  buffer_load_dwordx4 v8, s[4:7], s27 offen offset:2048 lds
  buffer_load_dwordx4 v8, s[4:7], s27 offen offset:3072 lds
  s_add_u32 m0, s22, 14336
  s_add_u32 s27, s21, 14336
  buffer_load_dwordx4 v8, s[4:7], s27 offen lds
  buffer_load_dwordx4 a[48:51], v8, s[4:7], s24 offen offset:0
  buffer_load_dwordx4 a[52:55], v8, s[4:7], s25 offen offset:0
  buffer_load_dwordx4 a[56:59], v8, s[4:7], s26 offen offset:0
  buffer_load_dwordx4 a[60:63], v8, s[4:7], s24 offen offset:1024
  buffer_load_dwordx4 a[64:67], v8, s[4:7], s25 offen offset:1024
  buffer_load_dwordx4 a[68:71], v8, s[4:7], s26 offen offset:1024
  buffer_load_dwordx4 a[72:75], v8, s[4:7], s24 offen offset:2048
  buffer_load_dwordx4 a[76:79], v8, s[4:7], s25 offen offset:2048
  buffer_load_dwordx4 a[80:83], v8, s[4:7], s26 offen offset:2048
  buffer_load_dwordx4 a[84:87], v8, s[4:7], s24 offen offset:3072
  buffer_load_dwordx4 a[88:91], v8, s[4:7], s25 offen offset:3072
  buffer_load_dwordx4 a[92:95], v8, s[4:7], s26 offen offset:3072
  s_add_u32 s24, s24, 4096
  s_add_u32 s25, s25, 4096
  s_add_u32 s26, s26, 4096
  s_add_u32 m0, s22, 20480
  s_add_u32 s27, s21, 20480
  buffer_load_dwordx4 v8, s[4:7], s27 offen offset:0 lds
  buffer_load_dwordx4 v8, s[4:7], s27 offen offset:1024 lds
  buffer_load_dwordx4 v8, s[4:7], s27 offen offset:2048 lds
  buffer_load_dwordx4 v8, s[4:7], s27 offen offset:3072 lds
  s_add_u32 m0, s22, 24576
  s_add_u32 s27, s21, 24576
  buffer_load_dwordx4 v8, s[4:7], s27 offen lds
  s_add_u32 m0, s22, 30720
  s_add_u32 s27, s21, 30720
  buffer_load_dwordx4 v8, s[4:7], s27 offen offset:0 lds
  buffer_load_dwordx4 v8, s[4:7], s27 offen offset:1024 lds
  buffer_load_dwordx4 v8, s[4:7], s27 offen offset:2048 lds
  buffer_load_dwordx4 v8, s[4:7], s27 offen offset:3072 lds
  s_add_u32 m0, s22, 34816
  s_add_u32 s27, s21, 34816
  buffer_load_dwordx4 v8, s[4:7], s27 offen lds
  v_add_u32 v9, 40960, v8
  s_waitcnt vmcnt(39)
  s_barrier
  ds_read_b128 v[16:19], v8 offset:0
  ds_read_b128 v[20:23], v9 offset:0
  ds_read_b128 v[24:27], v8 offset:1024
  ds_read_b128 v[28:31], v9 offset:1024
  buffer_load_dwordx4 a[96:99], v8, s[4:7], s24 offen offset:0
  buffer_load_dwordx4 a[100:103], v8, s[4:7], s25 offen offset:0
  buffer_load_dwordx4 a[104:107], v8, s[4:7], s26 offen offset:0
  buffer_load_dwordx4 a[108:111], v8, s[4:7], s24 offen offset:1024
  buffer_load_dwordx4 a[112:115], v8, s[4:7], s25 offen offset:1024
  buffer_load_dwordx4 a[116:119], v8, s[4:7], s26 offen offset:1024
  buffer_load_dwordx4 a[120:123], v8, s[4:7], s24 offen offset:2048
  buffer_load_dwordx4 a[124:127], v8, s[4:7], s25 offen offset:2048
  buffer_load_dwordx4 a[128:131], v8, s[4:7], s26 offen offset:2048
  buffer_load_dwordx4 a[132:135], v8, s[4:7], s24 offen offset:3072
  buffer_load_dwordx4 a[136:139], v8, s[4:7], s25 offen offset:3072
  buffer_load_dwordx4 a[140:143], v8, s[4:7], s26 offen offset:3072
  s_add_u32 s24, s24, 4096
  s_add_u32 s25, s25, 4096
  s_add_u32 s26, s26, 4096
  buffer_load_dwordx4 a[144:147], v8, s[4:7], s24 offen offset:0
  buffer_load_dwordx4 a[148:151], v8, s[4:7], s25 offen offset:0
  buffer_load_dwordx4 a[152:155], v8, s[4:7], s26 offen offset:0
  s_waitcnt vmcnt(51)
  ds_read_b128 v[32:35], v8 offset:2048
  ds_read_b128 v[36:39], v9 offset:2048
  s_waitcnt lgkmcnt(4)
  v_mfma_f32_32x32x16_bf16 v[96:111], a[0:3], v[16:19], 0
  v_mfma_f32_32x32x16_bf16 v[112:127], a[0:3], v[20:23], 0
  v_mfma_f32_32x32x16_bf16 v[128:143], a[4:7], v[16:19], 0
  v_mfma_f32_32x32x16_bf16 v[144:159], a[4:7], v[20:23], 0
  v_mfma_f32_32x32x16_bf16 v[160:175], v[16:19], a[8:11], 0
  v_mfma_f32_32x32x16_bf16 v[176:191], v[20:23], a[8:11], 0
  buffer_load_dwordx4 a[156:159], v8, s[4:7], s24 offen offset:1024
  buffer_load_dwordx4 a[160:163], v8, s[4:7], s25 offen offset:1024
  buffer_load_dwordx4 a[164:167], v8, s[4:7], s26 offen offset:1024
  s_waitcnt vmcnt(51)
  ds_read_b128 v[16:19], v8 offset:3072
  ds_read_b128 v[20:23], v9 offset:3072
  s_waitcnt lgkmcnt(4)
  v_mfma_f32_32x32x16_bf16 v[96:111], a[12:15], v[24:27], v[96:111]
  v_mfma_f32_32x32x16_bf16 v[112:127], a[12:15], v[28:31], v[112:127]
  v_mfma_f32_32x32x16_bf16 v[128:143], a[16:19], v[24:27], v[128:143]
  v_mfma_f32_32x32x16_bf16 v[144:159], a[16:19], v[28:31], v[144:159]
  v_mfma_f32_32x32x16_bf16 v[160:175], v[24:27], a[20:23], v[160:175]
  v_mfma_f32_32x32x16_bf16 v[176:191], v[28:31], a[20:23], v[176:191]
  buffer_load_dwordx4 a[168:171], v8, s[4:7], s24 offen offset:2048
  buffer_load_dwordx4 a[172:175], v8, s[4:7], s25 offen offset:2048
  buffer_load_dwordx4 a[176:179], v8, s[4:7], s26 offen offset:2048
  s_waitcnt vmcnt(51)
  ds_read_b128 v[24:27], v8 offset:4096
  ds_read_b128 v[28:31], v9 offset:4096
  s_waitcnt lgkmcnt(4)
  v_mfma_f32_32x32x16_bf16 v[96:111], a[24:27], v[32:35], v[96:111]
  v_mfma_f32_32x32x16_bf16 v[112:127], a[24:27], v[36:39], v[112:127]
  v_mfma_f32_32x32x16_bf16 v[128:143], a[28:31], v[32:35], v[128:143]
  v_mfma_f32_32x32x16_bf16 v[144:159], a[28:31], v[36:39], v[144:159]
  v_mfma_f32_32x32x16_bf16 v[160:175], v[32:35], a[32:35], v[160:175]
  v_mfma_f32_32x32x16_bf16 v[176:191], v[36:39], a[32:35], v[176:191]
  buffer_load_dwordx4 a[180:183], v8, s[4:7], s24 offen offset:3072
  buffer_load_dwordx4 a[184:187], v8, s[4:7], s25 offen offset:3072
  buffer_load_dwordx4 a[188:191], v8, s[4:7], s26 offen offset:3072
  s_add_u32 s24, s24, 4096
  s_add_u32 s25, s25, 4096
  s_add_u32 s26, s26, 4096
  s_waitcnt vmcnt(51)
  ds_read_b128 v[32:35], v8 offset:5120
  ds_read_b128 v[36:39], v9 offset:5120
  s_waitcnt lgkmcnt(4)
  v_mfma_f32_32x32x16_bf16 v[96:111], a[36:39], v[16:19], v[96:111]
  v_mfma_f32_32x32x16_bf16 v[112:127], a[36:39], v[20:23], v[112:127]
  v_mfma_f32_32x32x16_bf16 v[128:143], a[40:43], v[16:19], v[128:143]
  v_mfma_f32_32x32x16_bf16 v[144:159], a[40:43], v[20:23], v[144:159]
  v_mfma_f32_32x32x16_bf16 v[160:175], v[16:19], a[44:47], v[160:175]
  v_mfma_f32_32x32x16_bf16 v[176:191], v[20:23], a[44:47], v[176:191]
  buffer_load_dwordx4 a[0:3], v8, s[4:7], s24 offen offset:0
  buffer_load_dwordx4 a[4:7], v8, s[4:7], s25 offen offset:0
  buffer_load_dwordx4 a[8:11], v8, s[4:7], s26 offen offset:0
  s_waitcnt vmcnt(46)
  ds_read_b128 v[16:19], v8 offset:6144
  ds_read_b128 v[20:23], v9 offset:6144
  s_waitcnt lgkmcnt(4)
  v_mfma_f32_32x32x16_bf16 v[96:111], a[48:51], v[24:27], v[96:111]
  v_mfma_f32_32x32x16_bf16 v[112:127], a[48:51], v[28:31], v[112:127]
  v_mfma_f32_32x32x16_bf16 v[128:143], a[52:55], v[24:27], v[128:143]
  v_mfma_f32_32x32x16_bf16 v[144:159], a[52:55], v[28:31], v[144:159]
  v_mfma_f32_32x32x16_bf16 v[160:175], v[24:27], a[56:59], v[160:175]
  v_mfma_f32_32x32x16_bf16 v[176:191], v[28:31], a[56:59], v[176:191]
  buffer_load_dwordx4 a[12:15], v8, s[4:7], s24 offen offset:1024
  buffer_load_dwordx4 a[16:19], v8, s[4:7], s25 offen offset:1024
  buffer_load_dwordx4 a[20:23], v8, s[4:7], s26 offen offset:1024
  s_waitcnt vmcnt(46)
  ds_read_b128 v[24:27], v8 offset:7168
  ds_read_b128 v[28:31], v9 offset:7168
  s_waitcnt lgkmcnt(4)
  v_mfma_f32_32x32x16_bf16 v[96:111], a[60:63], v[32:35], v[96:111]
  v_mfma_f32_32x32x16_bf16 v[112:127], a[60:63], v[36:39], v[112:127]
  v_mfma_f32_32x32x16_bf16 v[128:143], a[64:67], v[32:35], v[128:143]
  v_mfma_f32_32x32x16_bf16 v[144:159], a[64:67], v[36:39], v[144:159]
  v_mfma_f32_32x32x16_bf16 v[160:175], v[32:35], a[68:71], v[160:175]
  v_mfma_f32_32x32x16_bf16 v[176:191], v[36:39], a[68:71], v[176:191]
  buffer_load_dwordx4 a[24:27], v8, s[4:7], s24 offen offset:2048
  buffer_load_dwordx4 a[28:31], v8, s[4:7], s25 offen offset:2048
  buffer_load_dwordx4 a[32:35], v8, s[4:7], s26 offen offset:2048
  s_waitcnt vmcnt(46)
  ds_read_b128 v[32:35], v8 offset:8192
  ds_read_b128 v[36:39], v9 offset:8192
  s_waitcnt lgkmcnt(4)
  v_mfma_f32_32x32x16_bf16 v[96:111], a[72:75], v[16:19], v[96:111]
  v_mfma_f32_32x32x16_bf16 v[112:127], a[72:75], v[20:23], v[112:127]
  v_mfma_f32_32x32x16_bf16 v[128:143], a[76:79], v[16:19], v[128:143]
  v_mfma_f32_32x32x16_bf16 v[144:159], a[76:79], v[20:23], v[144:159]
  v_mfma_f32_32x32x16_bf16 v[160:175], v[16:19], a[80:83], v[160:175]
  v_mfma_f32_32x32x16_bf16 v[176:191], v[20:23], a[80:83], v[176:191]
  buffer_load_dwordx4 a[36:39], v8, s[4:7], s24 offen offset:3072
  buffer_load_dwordx4 a[40:43], v8, s[4:7], s25 offen offset:3072
  buffer_load_dwordx4 a[44:47], v8, s[4:7], s26 offen offset:3072
  s_add_u32 s24, s24, 4096
  s_add_u32 s25, s25, 4096
  s_add_u32 s26, s26, 4096
  s_waitcnt vmcnt(46)
  ds_read_b128 v[16:19], v8 offset:9216
  ds_read_b128 v[20:23], v9 offset:9216
  s_waitcnt lgkmcnt(4)
  v_mfma_f32_32x32x16_bf16 v[96:111], a[84:87], v[24:27], v[96:111]
  v_mfma_f32_32x32x16_bf16 v[112:127], a[84:87], v[28:31], v[112:127]
  v_mfma_f32_32x32x16_bf16 v[128:143], a[88:91], v[24:27], v[128:143]
  v_mfma_f32_32x32x16_bf16 v[144:159], a[88:91], v[28:31], v[144:159]
  v_mfma_f32_32x32x16_bf16 v[160:175], v[24:27], a[92:95], v[160:175]
  v_mfma_f32_32x32x16_bf16 v[176:191], v[28:31], a[92:95], v[176:191]
  buffer_load_dwordx4 a[48:51], v8, s[4:7], s24 offen offset:0
  buffer_load_dwordx4 a[52:55], v8, s[4:7], s25 offen offset:0
  buffer_load_dwordx4 a[56:59], v8, s[4:7], s26 offen offset:0
  s_waitcnt vmcnt(61)
  s_barrier
  s_waitcnt vmcnt(36)
  ds_read_b128 v[24:27], v8 offset:10240
  ds_read_b128 v[28:31], v9 offset:10240
  s_waitcnt lgkmcnt(4)
  v_mfma_f32_32x32x16_bf16 v[96:111], a[96:99], v[32:35], v[96:111]
  v_mfma_f32_32x32x16_bf16 v[112:127], a[96:99], v[36:39], v[112:127]
  v_mfma_f32_32x32x16_bf16 v[128:143], a[100:103], v[32:35], v[128:143]
  v_mfma_f32_32x32x16_bf16 v[144:159], a[100:103], v[36:39], v[144:159]
  v_mfma_f32_32x32x16_bf16 v[160:175], v[32:35], a[104:107], v[160:175]
  v_mfma_f32_32x32x16_bf16 v[176:191], v[36:39], a[104:107], v[176:191]
  buffer_load_dwordx4 a[60:63], v8, s[4:7], s24 offen offset:1024
  buffer_load_dwordx4 a[64:67], v8, s[4:7], s25 offen offset:1024
  buffer_load_dwordx4 a[68:71], v8, s[4:7], s26 offen offset:1024
  s_waitcnt vmcnt(36)
  ds_read_b128 v[32:35], v8 offset:11264
  ds_read_b128 v[36:39], v9 offset:11264
  s_waitcnt lgkmcnt(4)
  v_mfma_f32_32x32x16_bf16 v[96:111], a[108:111], v[16:19], v[96:111]
  v_mfma_f32_32x32x16_bf16 v[112:127], a[108:111], v[20:23], v[112:127]
  v_mfma_f32_32x32x16_bf16 v[128:143], a[112:115], v[16:19], v[128:143]
  v_mfma_f32_32x32x16_bf16 v[144:159], a[112:115], v[20:23], v[144:159]
  v_mfma_f32_32x32x16_bf16 v[160:175], v[16:19], a[116:119], v[160:175]
  v_mfma_f32_32x32x16_bf16 v[176:191], v[20:23], a[116:119], v[176:191]
  buffer_load_dwordx4 a[72:75], v8, s[4:7], s24 offen offset:2048
  buffer_load_dwordx4 a[76:79], v8, s[4:7], s25 offen offset:2048
  buffer_load_dwordx4 a[80:83], v8, s[4:7], s26 offen offset:2048
  s_waitcnt vmcnt(36)
  ds_read_b128 v[16:19], v8 offset:12288
  ds_read_b128 v[20:23], v9 offset:12288
  s_waitcnt lgkmcnt(4)
  v_mfma_f32_32x32x16_bf16 v[96:111], a[120:123], v[24:27], v[96:111]
  v_mfma_f32_32x32x16_bf16 v[112:127], a[120:123], v[28:31], v[112:127]
  v_mfma_f32_32x32x16_bf16 v[128:143], a[124:127], v[24:27], v[128:143]
  v_mfma_f32_32x32x16_bf16 v[144:159], a[124:127], v[28:31], v[144:159]
  v_mfma_f32_32x32x16_bf16 v[160:175], v[24:27], a[128:131], v[160:175]
  v_mfma_f32_32x32x16_bf16 v[176:191], v[28:31], a[128:131], v[176:191]
  buffer_load_dwordx4 a[84:87], v8, s[4:7], s24 offen offset:3072
  buffer_load_dwordx4 a[88:91], v8, s[4:7], s25 offen offset:3072
  buffer_load_dwordx4 a[92:95], v8, s[4:7], s26 offen offset:3072
  s_add_u32 s24, s24, 4096
  s_add_u32 s25, s25, 4096
  s_add_u32 s26, s26, 4096
  s_waitcnt vmcnt(36)
  ds_read_b128 v[24:27], v8 offset:13312
  ds_read_b128 v[28:31], v9 offset:13312
  s_waitcnt lgkmcnt(4)
  v_mfma_f32_32x32x16_bf16 v[96:111], a[132:135], v[32:35], v[96:111]
  v_mfma_f32_32x32x16_bf16 v[112:127], a[132:135], v[36:39], v[112:127]
  v_mfma_f32_32x32x16_bf16 v[128:143], a[136:139], v[32:35], v[128:143]
  v_mfma_f32_32x32x16_bf16 v[144:159], a[136:139], v[36:39], v[144:159]
  v_mfma_f32_32x32x16_bf16 v[160:175], v[32:35], a[140:143], v[160:175]
  v_mfma_f32_32x32x16_bf16 v[176:191], v[36:39], a[140:143], v[176:191]
  buffer_load_dwordx4 a[96:99], v8, s[4:7], s24 offen offset:0
  buffer_load_dwordx4 a[100:103], v8, s[4:7], s25 offen offset:0
  buffer_load_dwordx4 a[104:107], v8, s[4:7], s26 offen offset:0
  s_waitcnt vmcnt(36)
  ds_read_b128 v[32:35], v8 offset:14336
  ds_read_b128 v[36:39], v9 offset:14336
  s_waitcnt lgkmcnt(4)
  v_mfma_f32_32x32x16_bf16 v[96:111], a[144:147], v[16:19], v[96:111]
  v_mfma_f32_32x32x16_bf16 v[112:127], a[144:147], v[20:23], v[112:127]
  v_mfma_f32_32x32x16_bf16 v[128:143], a[148:151], v[16:19], v[128:143]
  v_mfma_f32_32x32x16_bf16 v[144:159], a[148:151], v[20:23], v[144:159]
  v_mfma_f32_32x32x16_bf16 v[160:175], v[16:19], a[152:155], v[160:175]
  v_mfma_f32_32x32x16_bf16 v[176:191], v[20:23], a[152:155], v[176:191]
  buffer_load_dwordx4 a[108:111], v8, s[4:7], s24 offen offset:1024
  buffer_load_dwordx4 a[112:115], v8, s[4:7], s25 offen offset:1024
  buffer_load_dwordx4 a[116:119], v8, s[4:7], s26 offen offset:1024
  s_waitcnt vmcnt(36)
  ds_read_b128 v[16:19], v8 offset:15360
  ds_read_b128 v[20:23], v9 offset:15360
  s_waitcnt lgkmcnt(4)
  v_mfma_f32_32x32x16_bf16 v[96:111], a[156:159], v[24:27], v[96:111]
  v_mfma_f32_32x32x16_bf16 v[112:127], a[156:159], v[28:31], v[112:127]
  v_mfma_f32_32x32x16_bf16 v[128:143], a[160:163], v[24:27], v[128:143]
  v_mfma_f32_32x32x16_bf16 v[144:159], a[160:163], v[28:31], v[144:159]
  v_mfma_f32_32x32x16_bf16 v[160:175], v[24:27], a[164:167], v[160:175]
  v_mfma_f32_32x32x16_bf16 v[176:191], v[28:31], a[164:167], v[176:191]
  buffer_load_dwordx4 a[120:123], v8, s[4:7], s24 offen offset:2048
  buffer_load_dwordx4 a[124:127], v8, s[4:7], s25 offen offset:2048
  buffer_load_dwordx4 a[128:131], v8, s[4:7], s26 offen offset:2048
  s_waitcnt vmcnt(36)
  ds_read_b128 v[24:27], v8 offset:16384
  ds_read_b128 v[28:31], v9 offset:16384
  s_waitcnt lgkmcnt(4)
  v_mfma_f32_32x32x16_bf16 v[96:111], a[168:171], v[32:35], v[96:111]
  v_mfma_f32_32x32x16_bf16 v[112:127], a[168:171], v[36:39], v[112:127]
  v_mfma_f32_32x32x16_bf16 v[128:143], a[172:175], v[32:35], v[128:143]
  v_mfma_f32_32x32x16_bf16 v[144:159], a[172:175], v[36:39], v[144:159]
  v_mfma_f32_32x32x16_bf16 v[160:175], v[32:35], a[176:179], v[160:175]
  v_mfma_f32_32x32x16_bf16 v[176:191], v[36:39], a[176:179], v[176:191]
  buffer_load_dwordx4 a[132:135], v8, s[4:7], s24 offen offset:3072
  buffer_load_dwordx4 a[136:139], v8, s[4:7], s25 offen offset:3072
  buffer_load_dwordx4 a[140:143], v8, s[4:7], s26 offen offset:3072
  s_add_u32 s24, s24, 4096
  s_add_u32 s25, s25, 4096
  s_add_u32 s26, s26, 4096
  s_waitcnt vmcnt(36)
  ds_read_b128 v[32:35], v8 offset:17408
  ds_read_b128 v[36:39], v9 offset:17408
  s_waitcnt lgkmcnt(4)
  v_mfma_f32_32x32x16_bf16 v[96:111], a[180:183], v[16:19], v[96:111]
  v_mfma_f32_32x32x16_bf16 v[112:127], a[180:183], v[20:23], v[112:127]
  v_mfma_f32_32x32x16_bf16 v[128:143], a[184:187], v[16:19], v[128:143]
  v_mfma_f32_32x32x16_bf16 v[144:159], a[184:187], v[20:23], v[144:159]
  v_mfma_f32_32x32x16_bf16 v[160:175], v[16:19], a[188:191], v[160:175]
  v_mfma_f32_32x32x16_bf16 v[176:191], v[20:23], a[188:191], v[176:191]
  buffer_load_dwordx4 a[144:147], v8, s[4:7], s24 offen offset:0
  buffer_load_dwordx4 a[148:151], v8, s[4:7], s25 offen offset:0
  buffer_load_dwordx4 a[152:155], v8, s[4:7], s26 offen offset:0
  s_waitcnt vmcnt(36)
  ds_read_b128 v[16:19], v8 offset:18432
  ds_read_b128 v[20:23], v9 offset:18432
  s_waitcnt lgkmcnt(4)
  v_mfma_f32_32x32x16_bf16 v[96:111], a[0:3], v[24:27], v[96:111]
  v_mfma_f32_32x32x16_bf16 v[112:127], a[0:3], v[28:31], v[112:127]
  v_mfma_f32_32x32x16_bf16 v[128:143], a[4:7], v[24:27], v[128:143]
  v_mfma_f32_32x32x16_bf16 v[144:159], a[4:7], v[28:31], v[144:159]
  v_mfma_f32_32x32x16_bf16 v[160:175], v[24:27], a[8:11], v[160:175]
  v_mfma_f32_32x32x16_bf16 v[176:191], v[28:31], a[8:11], v[176:191]
  buffer_load_dwordx4 a[156:159], v8, s[4:7], s24 offen offset:1024
  buffer_load_dwordx4 a[160:163], v8, s[4:7], s25 offen offset:1024
  buffer_load_dwordx4 a[164:167], v8, s[4:7], s26 offen offset:1024
  s_waitcnt vmcnt(36)
  ds_read_b128 v[24:27], v8 offset:19456
  ds_read_b128 v[28:31], v9 offset:19456
  s_waitcnt lgkmcnt(4)
  v_mfma_f32_32x32x16_bf16 v[96:111], a[12:15], v[32:35], v[96:111]
  v_mfma_f32_32x32x16_bf16 v[112:127], a[12:15], v[36:39], v[112:127]
  v_mfma_f32_32x32x16_bf16 v[128:143], a[16:19], v[32:35], v[128:143]
  v_mfma_f32_32x32x16_bf16 v[144:159], a[16:19], v[36:39], v[144:159]
  v_mfma_f32_32x32x16_bf16 v[160:175], v[32:35], a[20:23], v[160:175]
  v_mfma_f32_32x32x16_bf16 v[176:191], v[36:39], a[20:23], v[176:191]
  buffer_load_dwordx4 a[168:171], v8, s[4:7], s24 offen offset:2048
  buffer_load_dwordx4 a[172:175], v8, s[4:7], s25 offen offset:2048
  buffer_load_dwordx4 a[176:179], v8, s[4:7], s26 offen offset:2048
  s_waitcnt vmcnt(63)
  s_barrier
  s_waitcnt vmcnt(36)
  ds_read_b128 v[32:35], v8 offset:20480
  ds_read_b128 v[36:39], v9 offset:20480
  s_waitcnt lgkmcnt(4)
  v_mfma_f32_32x32x16_bf16 v[96:111], a[24:27], v[16:19], v[96:111]
  v_mfma_f32_32x32x16_bf16 v[112:127], a[24:27], v[20:23], v[112:127]
  v_mfma_f32_32x32x16_bf16 v[128:143], a[28:31], v[16:19], v[128:143]
  v_mfma_f32_32x32x16_bf16 v[144:159], a[28:31], v[20:23], v[144:159]
  v_mfma_f32_32x32x16_bf16 v[160:175], v[16:19], a[32:35], v[160:175]
  v_mfma_f32_32x32x16_bf16 v[176:191], v[20:23], a[32:35], v[176:191]
  buffer_load_dwordx4 a[180:183], v8, s[4:7], s24 offen offset:3072
  buffer_load_dwordx4 a[184:187], v8, s[4:7], s25 offen offset:3072
  buffer_load_dwordx4 a[188:191], v8, s[4:7], s26 offen offset:3072
  s_add_u32 s24, s24, 4096
  s_add_u32 s25, s25, 4096
  s_add_u32 s26, s26, 4096
  s_waitcnt vmcnt(36)
  ds_read_b128 v[16:19], v8 offset:21504
  ds_read_b128 v[20:23], v9 offset:21504
  s_waitcnt lgkmcnt(4)
  v_mfma_f32_32x32x16_bf16 v[96:111], a[36:39], v[24:27], v[96:111]
  v_mfma_f32_32x32x16_bf16 v[112:127], a[36:39], v[28:31], v[112:127]
  v_mfma_f32_32x32x16_bf16 v[128:143], a[40:43], v[24:27], v[128:143]
  v_mfma_f32_32x32x16_bf16 v[144:159], a[40:43], v[28:31], v[144:159]
  v_mfma_f32_32x32x16_bf16 v[160:175], v[24:27], a[44:47], v[160:175]
  v_mfma_f32_32x32x16_bf16 v[176:191], v[28:31], a[44:47], v[176:191]
  buffer_load_dwordx4 a[0:3], v8, s[4:7], s24 offen offset:0
  buffer_load_dwordx4 a[4:7], v8, s[4:7], s25 offen offset:0
  buffer_load_dwordx4 a[8:11], v8, s[4:7], s26 offen offset:0
  s_waitcnt vmcnt(36)
  ds_read_b128 v[24:27], v8 offset:22528
  ds_read_b128 v[28:31], v9 offset:22528
  s_waitcnt lgkmcnt(4)
  v_mfma_f32_32x32x16_bf16 v[96:111], a[48:51], v[32:35], v[96:111]
  v_mfma_f32_32x32x16_bf16 v[112:127], a[48:51], v[36:39], v[112:127]
  v_mfma_f32_32x32x16_bf16 v[128:143], a[52:55], v[32:35], v[128:143]
  v_mfma_f32_32x32x16_bf16 v[144:159], a[52:55], v[36:39], v[144:159]
  v_mfma_f32_32x32x16_bf16 v[160:175], v[32:35], a[56:59], v[160:175]
  v_mfma_f32_32x32x16_bf16 v[176:191], v[36:39], a[56:59], v[176:191]
  buffer_load_dwordx4 a[12:15], v8, s[4:7], s24 offen offset:1024
  buffer_load_dwordx4 a[16:19], v8, s[4:7], s25 offen offset:1024
  buffer_load_dwordx4 a[20:23], v8, s[4:7], s26 offen offset:1024
  s_waitcnt vmcnt(36)
  ds_read_b128 v[32:35], v8 offset:23552
  ds_read_b128 v[36:39], v9 offset:23552
  s_waitcnt lgkmcnt(4)
  v_mfma_f32_32x32x16_bf16 v[96:111], a[60:63], v[16:19], v[96:111]
  v_mfma_f32_32x32x16_bf16 v[112:127], a[60:63], v[20:23], v[112:127]
  v_mfma_f32_32x32x16_bf16 v[128:143], a[64:67], v[16:19], v[128:143]
  v_mfma_f32_32x32x16_bf16 v[144:159], a[64:67], v[20:23], v[144:159]
  v_mfma_f32_32x32x16_bf16 v[160:175], v[16:19], a[68:71], v[160:175]
  v_mfma_f32_32x32x16_bf16 v[176:191], v[20:23], a[68:71], v[176:191]
  buffer_load_dwordx4 a[24:27], v8, s[4:7], s24 offen offset:2048
  buffer_load_dwordx4 a[28:31], v8, s[4:7], s25 offen offset:2048
  buffer_load_dwordx4 a[32:35], v8, s[4:7], s26 offen offset:2048
  s_waitcnt vmcnt(36)
  ds_read_b128 v[16:19], v8 offset:24576
  ds_read_b128 v[20:23], v9 offset:24576
  s_waitcnt lgkmcnt(4)
  v_mfma_f32_32x32x16_bf16 v[96:111], a[72:75], v[24:27], v[96:111]
  v_mfma_f32_32x32x16_bf16 v[112:127], a[72:75], v[28:31], v[112:127]
  v_mfma_f32_32x32x16_bf16 v[128:143], a[76:79], v[24:27], v[128:143]
  v_mfma_f32_32x32x16_bf16 v[144:159], a[76:79], v[28:31], v[144:159]
  v_mfma_f32_32x32x16_bf16 v[160:175], v[24:27], a[80:83], v[160:175]
  v_mfma_f32_32x32x16_bf16 v[176:191], v[28:31], a[80:83], v[176:191]
  buffer_load_dwordx4 a[36:39], v8, s[4:7], s24 offen offset:3072
  buffer_load_dwordx4 a[40:43], v8, s[4:7], s25 offen offset:3072
  buffer_load_dwordx4 a[44:47], v8, s[4:7], s26 offen offset:3072
  s_add_u32 s24, s24, 4096
  s_add_u32 s25, s25, 4096
  s_add_u32 s26, s26, 4096
  s_waitcnt vmcnt(36)
  ds_read_b128 v[24:27], v8 offset:25600
  ds_read_b128 v[28:31], v9 offset:25600
  s_waitcnt lgkmcnt(4)
  v_mfma_f32_32x32x16_bf16 v[96:111], a[84:87], v[32:35], v[96:111]
  v_mfma_f32_32x32x16_bf16 v[112:127], a[84:87], v[36:39], v[112:127]
  v_mfma_f32_32x32x16_bf16 v[128:143], a[88:91], v[32:35], v[128:143]
  v_mfma_f32_32x32x16_bf16 v[144:159], a[88:91], v[36:39], v[144:159]
  v_mfma_f32_32x32x16_bf16 v[160:175], v[32:35], a[92:95], v[160:175]
  v_mfma_f32_32x32x16_bf16 v[176:191], v[36:39], a[92:95], v[176:191]
  buffer_load_dwordx4 a[48:51], v8, s[4:7], s24 offen offset:0
  buffer_load_dwordx4 a[52:55], v8, s[4:7], s25 offen offset:0
  buffer_load_dwordx4 a[56:59], v8, s[4:7], s26 offen offset:0
  s_waitcnt vmcnt(36)
  ds_read_b128 v[32:35], v8 offset:26624
  ds_read_b128 v[36:39], v9 offset:26624
  s_waitcnt lgkmcnt(4)
  v_mfma_f32_32x32x16_bf16 v[96:111], a[96:99], v[16:19], v[96:111]
  v_mfma_f32_32x32x16_bf16 v[112:127], a[96:99], v[20:23], v[112:127]
  v_mfma_f32_32x32x16_bf16 v[128:143], a[100:103], v[16:19], v[128:143]
  v_mfma_f32_32x32x16_bf16 v[144:159], a[100:103], v[20:23], v[144:159]
  v_mfma_f32_32x32x16_bf16 v[160:175], v[16:19], a[104:107], v[160:175]
  v_mfma_f32_32x32x16_bf16 v[176:191], v[20:23], a[104:107], v[176:191]
  buffer_load_dwordx4 a[60:63], v8, s[4:7], s24 offen offset:1024
  buffer_load_dwordx4 a[64:67], v8, s[4:7], s25 offen offset:1024
  buffer_load_dwordx4 a[68:71], v8, s[4:7], s26 offen offset:1024
  s_waitcnt vmcnt(36)
  ds_read_b128 v[16:19], v8 offset:27648
  ds_read_b128 v[20:23], v9 offset:27648
  s_waitcnt lgkmcnt(4)
  v_mfma_f32_32x32x16_bf16 v[96:111], a[108:111], v[24:27], v[96:111]
  v_mfma_f32_32x32x16_bf16 v[112:127], a[108:111], v[28:31], v[112:127]
  v_mfma_f32_32x32x16_bf16 v[128:143], a[112:115], v[24:27], v[128:143]
  v_mfma_f32_32x32x16_bf16 v[144:159], a[112:115], v[28:31], v[144:159]
  v_mfma_f32_32x32x16_bf16 v[160:175], v[24:27], a[116:119], v[160:175]
  v_mfma_f32_32x32x16_bf16 v[176:191], v[28:31], a[116:119], v[176:191]
  buffer_load_dwordx4 a[72:75], v8, s[4:7], s24 offen offset:2048
  buffer_load_dwordx4 a[76:79], v8, s[4:7], s25 offen offset:2048
  buffer_load_dwordx4 a[80:83], v8, s[4:7], s26 offen offset:2048
  s_waitcnt vmcnt(36)
  ds_read_b128 v[24:27], v8 offset:28672
  ds_read_b128 v[28:31], v9 offset:28672
  s_waitcnt lgkmcnt(4)
  v_mfma_f32_32x32x16_bf16 v[96:111], a[120:123], v[32:35], v[96:111]
  v_mfma_f32_32x32x16_bf16 v[112:127], a[120:123], v[36:39], v[112:127]
  v_mfma_f32_32x32x16_bf16 v[128:143], a[124:127], v[32:35], v[128:143]
  v_mfma_f32_32x32x16_bf16 v[144:159], a[124:127], v[36:39], v[144:159]
  v_mfma_f32_32x32x16_bf16 v[160:175], v[32:35], a[128:131], v[160:175]
  v_mfma_f32_32x32x16_bf16 v[176:191], v[36:39], a[128:131], v[176:191]
  buffer_load_dwordx4 a[84:87], v8, s[4:7], s24 offen offset:3072
  buffer_load_dwordx4 a[88:91], v8, s[4:7], s25 offen offset:3072
  buffer_load_dwordx4 a[92:95], v8, s[4:7], s26 offen offset:3072
  s_add_u32 s24, s24, 4096
  s_add_u32 s25, s25, 4096
  s_add_u32 s26, s26, 4096
  s_waitcnt vmcnt(36)
  ds_read_b128 v[32:35], v8 offset:29696
  ds_read_b128 v[36:39], v9 offset:29696
  s_waitcnt lgkmcnt(4)
  v_mfma_f32_32x32x16_bf16 v[96:111], a[132:135], v[16:19], v[96:111]
  v_mfma_f32_32x32x16_bf16 v[112:127], a[132:135], v[20:23], v[112:127]
  v_mfma_f32_32x32x16_bf16 v[128:143], a[136:139], v[16:19], v[128:143]
  v_mfma_f32_32x32x16_bf16 v[144:159], a[136:139], v[20:23], v[144:159]
  v_mfma_f32_32x32x16_bf16 v[160:175], v[16:19], a[140:143], v[160:175]
  v_mfma_f32_32x32x16_bf16 v[176:191], v[20:23], a[140:143], v[176:191]
  s_waitcnt vmcnt(63)
  s_barrier
  s_waitcnt vmcnt(33)
  ds_read_b128 v[16:19], v8 offset:30720
  ds_read_b128 v[20:23], v9 offset:30720
  s_waitcnt lgkmcnt(4)
  v_mfma_f32_32x32x16_bf16 v[96:111], a[144:147], v[24:27], v[96:111]
  v_mfma_f32_32x32x16_bf16 v[112:127], a[144:147], v[28:31], v[112:127]
  v_mfma_f32_32x32x16_bf16 v[128:143], a[148:151], v[24:27], v[128:143]
  v_mfma_f32_32x32x16_bf16 v[144:159], a[148:151], v[28:31], v[144:159]
  v_mfma_f32_32x32x16_bf16 v[160:175], v[24:27], a[152:155], v[160:175]
  v_mfma_f32_32x32x16_bf16 v[176:191], v[28:31], a[152:155], v[176:191]
  s_waitcnt vmcnt(30)
  ds_read_b128 v[24:27], v8 offset:31744
  ds_read_b128 v[28:31], v9 offset:31744
  s_waitcnt lgkmcnt(4)
  v_mfma_f32_32x32x16_bf16 v[96:111], a[156:159], v[32:35], v[96:111]
  v_mfma_f32_32x32x16_bf16 v[112:127], a[156:159], v[36:39], v[112:127]
  v_mfma_f32_32x32x16_bf16 v[128:143], a[160:163], v[32:35], v[128:143]
  v_mfma_f32_32x32x16_bf16 v[144:159], a[160:163], v[36:39], v[144:159]
  v_mfma_f32_32x32x16_bf16 v[160:175], v[32:35], a[164:167], v[160:175]
  v_mfma_f32_32x32x16_bf16 v[176:191], v[36:39], a[164:167], v[176:191]
  s_waitcnt vmcnt(27)
  ds_read_b128 v[32:35], v8 offset:32768
  ds_read_b128 v[36:39], v9 offset:32768
  s_waitcnt lgkmcnt(4)
  v_mfma_f32_32x32x16_bf16 v[96:111], a[168:171], v[16:19], v[96:111]
  v_mfma_f32_32x32x16_bf16 v[112:127], a[168:171], v[20:23], v[112:127]
  v_mfma_f32_32x32x16_bf16 v[128:143], a[172:175], v[16:19], v[128:143]
  v_mfma_f32_32x32x16_bf16 v[144:159], a[172:175], v[20:23], v[144:159]
  v_mfma_f32_32x32x16_bf16 v[160:175], v[16:19], a[176:179], v[160:175]
  v_mfma_f32_32x32x16_bf16 v[176:191], v[20:23], a[176:179], v[176:191]
  s_waitcnt vmcnt(24)
  ds_read_b128 v[16:19], v8 offset:33792
  ds_read_b128 v[20:23], v9 offset:33792
  s_waitcnt lgkmcnt(4)
  v_mfma_f32_32x32x16_bf16 v[96:111], a[180:183], v[24:27], v[96:111]
  v_mfma_f32_32x32x16_bf16 v[112:127], a[180:183], v[28:31], v[112:127]
  v_mfma_f32_32x32x16_bf16 v[128:143], a[184:187], v[24:27], v[128:143]
  v_mfma_f32_32x32x16_bf16 v[144:159], a[184:187], v[28:31], v[144:159]
  v_mfma_f32_32x32x16_bf16 v[160:175], v[24:27], a[188:191], v[160:175]
  v_mfma_f32_32x32x16_bf16 v[176:191], v[28:31], a[188:191], v[176:191]
  s_waitcnt vmcnt(21)
  ds_read_b128 v[24:27], v8 offset:34816
  ds_read_b128 v[28:31], v9 offset:34816
  s_waitcnt lgkmcnt(4)
  v_mfma_f32_32x32x16_bf16 v[96:111], a[0:3], v[32:35], v[96:111]
  v_mfma_f32_32x32x16_bf16 v[112:127], a[0:3], v[36:39], v[112:127]
  v_mfma_f32_32x32x16_bf16 v[128:143], a[4:7], v[32:35], v[128:143]
  v_mfma_f32_32x32x16_bf16 v[144:159], a[4:7], v[36:39], v[144:159]
  v_mfma_f32_32x32x16_bf16 v[160:175], v[32:35], a[8:11], v[160:175]
  v_mfma_f32_32x32x16_bf16 v[176:191], v[36:39], a[8:11], v[176:191]
  s_waitcnt vmcnt(18)
  ds_read_b128 v[32:35], v8 offset:35840
  ds_read_b128 v[36:39], v9 offset:35840
  s_waitcnt lgkmcnt(4)
  v_mfma_f32_32x32x16_bf16 v[96:111], a[12:15], v[16:19], v[96:111]
  v_mfma_f32_32x32x16_bf16 v[112:127], a[12:15], v[20:23], v[112:127]
  v_mfma_f32_32x32x16_bf16 v[128:143], a[16:19], v[16:19], v[128:143]
  v_mfma_f32_32x32x16_bf16 v[144:159], a[16:19], v[20:23], v[144:159]
  v_mfma_f32_32x32x16_bf16 v[160:175], v[16:19], a[20:23], v[160:175]
  v_mfma_f32_32x32x16_bf16 v[176:191], v[20:23], a[20:23], v[176:191]
  s_waitcnt vmcnt(15)
  ds_read_b128 v[16:19], v8 offset:36864
  ds_read_b128 v[20:23], v9 offset:36864
  s_waitcnt lgkmcnt(4)
  v_mfma_f32_32x32x16_bf16 v[96:111], a[24:27], v[24:27], v[96:111]
  v_mfma_f32_32x32x16_bf16 v[112:127], a[24:27], v[28:31], v[112:127]
  v_mfma_f32_32x32x16_bf16 v[128:143], a[28:31], v[24:27], v[128:143]
  v_mfma_f32_32x32x16_bf16 v[144:159], a[28:31], v[28:31], v[144:159]
  v_mfma_f32_32x32x16_bf16 v[160:175], v[24:27], a[32:35], v[160:175]
  v_mfma_f32_32x32x16_bf16 v[176:191], v[28:31], a[32:35], v[176:191]
  s_waitcnt vmcnt(12)
  ds_read_b128 v[24:27], v8 offset:37888
  ds_read_b128 v[28:31], v9 offset:37888
  s_waitcnt lgkmcnt(4)
  v_mfma_f32_32x32x16_bf16 v[96:111], a[36:39], v[32:35], v[96:111]
  v_mfma_f32_32x32x16_bf16 v[112:127], a[36:39], v[36:39], v[112:127]
  v_mfma_f32_32x32x16_bf16 v[128:143], a[40:43], v[32:35], v[128:143]
  v_mfma_f32_32x32x16_bf16 v[144:159], a[40:43], v[36:39], v[144:159]
  v_mfma_f32_32x32x16_bf16 v[160:175], v[32:35], a[44:47], v[160:175]
  v_mfma_f32_32x32x16_bf16 v[176:191], v[36:39], a[44:47], v[176:191]
  s_waitcnt vmcnt(9)
  ds_read_b128 v[32:35], v8 offset:38912
  ds_read_b128 v[36:39], v9 offset:38912
  s_waitcnt lgkmcnt(4)
  v_mfma_f32_32x32x16_bf16 v[96:111], a[48:51], v[16:19], v[96:111]
  v_mfma_f32_32x32x16_bf16 v[112:127], a[48:51], v[20:23], v[112:127]
  v_mfma_f32_32x32x16_bf16 v[128:143], a[52:55], v[16:19], v[128:143]
  v_mfma_f32_32x32x16_bf16 v[144:159], a[52:55], v[20:23], v[144:159]
  v_mfma_f32_32x32x16_bf16 v[160:175], v[16:19], a[56:59], v[160:175]
  v_mfma_f32_32x32x16_bf16 v[176:191], v[20:23], a[56:59], v[176:191]
  s_waitcnt vmcnt(6)
  ds_read_b128 v[16:19], v8 offset:39936
  ds_read_b128 v[20:23], v9 offset:39936
  s_waitcnt lgkmcnt(4)
  v_mfma_f32_32x32x16_bf16 v[96:111], a[60:63], v[24:27], v[96:111]
  v_mfma_f32_32x32x16_bf16 v[112:127], a[60:63], v[28:31], v[112:127]
  v_mfma_f32_32x32x16_bf16 v[128:143], a[64:67], v[24:27], v[128:143]
  v_mfma_f32_32x32x16_bf16 v[144:159], a[64:67], v[28:31], v[144:159]
  v_mfma_f32_32x32x16_bf16 v[160:175], v[24:27], a[68:71], v[160:175]
  v_mfma_f32_32x32x16_bf16 v[176:191], v[28:31], a[68:71], v[176:191]
  s_waitcnt vmcnt(3)
  s_waitcnt lgkmcnt(2)
  v_mfma_f32_32x32x16_bf16 v[96:111], a[72:75], v[32:35], v[96:111]
  v_mfma_f32_32x32x16_bf16 v[112:127], a[72:75], v[36:39], v[112:127]
  v_mfma_f32_32x32x16_bf16 v[128:143], a[76:79], v[32:35], v[128:143]
  v_mfma_f32_32x32x16_bf16 v[144:159], a[76:79], v[36:39], v[144:159]
  v_mfma_f32_32x32x16_bf16 v[160:175], v[32:35], a[80:83], v[160:175]
  v_mfma_f32_32x32x16_bf16 v[176:191], v[36:39], a[80:83], v[176:191]
  s_waitcnt vmcnt(0)
  s_waitcnt lgkmcnt(0)
  v_mfma_f32_32x32x16_bf16 v[96:111], a[84:87], v[16:19], v[96:111]
  v_mfma_f32_32x32x16_bf16 v[112:127], a[84:87], v[20:23], v[112:127]
  v_mfma_f32_32x32x16_bf16 v[128:143], a[88:91], v[16:19], v[128:143]
  v_mfma_f32_32x32x16_bf16 v[144:159], a[88:91], v[20:23], v[144:159]
  v_mfma_f32_32x32x16_bf16 v[160:175], v[16:19], a[92:95], v[160:175]
  v_mfma_f32_32x32x16_bf16 v[176:191], v[20:23], a[92:95], v[176:191]
  s_lshl_b32 s21, s18, 1
  s_lshl_b32 s22, s23, 6
  s_add_u32 s21, s21, s22
  s_lshl_b32 s21, s21, 11
  s_add_u32 s27, s21, 37748736
  s_add_u32 s28, s21, 41943040
  s_add_u32 s29, s21, 46137344
  s_mov_b32 s30, 0x3ea52b5c
  v_and_b32 v2, 31, v0
  v_cmp_eq_u32 s[32:33], 20, v2
  v_mov_b32 v3, 0x3f803f80
  v_mul_f32 v96, s30, v96
  v_mul_f32 v97, s30, v97
  v_mul_f32 v98, s30, v98
  v_mul_f32 v99, s30, v99
  v_mul_f32 v100, s30, v100
  v_mul_f32 v101, s30, v101
  v_mul_f32 v102, s30, v102
  v_mul_f32 v103, s30, v103
  v_mul_f32 v104, s30, v104
  v_mul_f32 v105, s30, v105
  v_mul_f32 v106, s30, v106
  v_mul_f32 v107, s30, v107
  v_mul_f32 v108, s30, v108
  v_mul_f32 v109, s30, v109
  v_mul_f32 v110, s30, v110
  v_mul_f32 v111, s30, v111
  v_cvt_pk_bf16_f32 v16, v96, v97
  v_cvt_pk_bf16_f32 v17, v98, v99
  v_cvt_pk_bf16_f32 v18, v100, v101
  v_cvt_pk_bf16_f32 v19, v102, v103
  v_cvt_pk_bf16_f32 v20, v104, v105
  v_cvt_pk_bf16_f32 v21, v106, v107
  v_cvt_pk_bf16_f32 v22, v108, v109
  v_cvt_pk_bf16_f32 v23, v110, v111
  buffer_store_dwordx4 v[16:19], v8, s[4:7], s27 offen offset:0 sc1
  buffer_store_dwordx4 v[20:23], v8, s[4:7], s27 offen offset:1024 sc1
  v_mul_f32 v112, s30, v112
  v_mul_f32 v113, s30, v113
  v_mul_f32 v114, s30, v114
  v_mul_f32 v115, s30, v115
  v_mul_f32 v116, s30, v116
  v_mul_f32 v117, s30, v117
  v_mul_f32 v118, s30, v118
  v_mul_f32 v119, s30, v119
  v_mul_f32 v120, s30, v120
  v_mul_f32 v121, s30, v121
  v_mul_f32 v122, s30, v122
  v_mul_f32 v123, s30, v123
  v_mul_f32 v124, s30, v124
  v_mul_f32 v125, s30, v125
  v_mul_f32 v126, s30, v126
  v_mul_f32 v127, s30, v127
  v_cvt_pk_bf16_f32 v24, v112, v113
  v_cvt_pk_bf16_f32 v25, v114, v115
  v_cvt_pk_bf16_f32 v26, v116, v117
  v_cvt_pk_bf16_f32 v27, v118, v119
  v_cvt_pk_bf16_f32 v28, v120, v121
  v_cvt_pk_bf16_f32 v29, v122, v123
  v_cvt_pk_bf16_f32 v30, v124, v125
  v_cvt_pk_bf16_f32 v31, v126, v127
  buffer_store_dwordx4 v[24:27], v8, s[4:7], s27 offen offset:2048 sc1
  buffer_store_dwordx4 v[28:31], v8, s[4:7], s27 offen offset:3072 sc1
  v_cvt_pk_bf16_f32 v16, v128, v129
  v_cvt_pk_bf16_f32 v17, v130, v131
  v_cvt_pk_bf16_f32 v18, v132, v133
  v_cvt_pk_bf16_f32 v19, v134, v135
  v_cvt_pk_bf16_f32 v20, v136, v137
  v_cvt_pk_bf16_f32 v21, v138, v139
  v_cvt_pk_bf16_f32 v22, v140, v141
  v_cvt_pk_bf16_f32 v23, v142, v143
  buffer_store_dwordx4 v[16:19], v8, s[4:7], s28 offen offset:0 sc1
  buffer_store_dwordx4 v[20:23], v8, s[4:7], s28 offen offset:1024 sc1
  v_cvt_pk_bf16_f32 v24, v144, v145
  v_cvt_pk_bf16_f32 v25, v146, v147
  v_cvt_pk_bf16_f32 v26, v148, v149
  v_cvt_pk_bf16_f32 v27, v150, v151
  v_cvt_pk_bf16_f32 v28, v152, v153
  v_cvt_pk_bf16_f32 v29, v154, v155
  v_cvt_pk_bf16_f32 v30, v156, v157
  v_cvt_pk_bf16_f32 v31, v158, v159
  buffer_store_dwordx4 v[24:27], v8, s[4:7], s28 offen offset:2048 sc1
  buffer_store_dwordx4 v[28:31], v8, s[4:7], s28 offen offset:3072 sc1
  v_cvt_pk_bf16_f32 v16, v160, v161
  v_cvt_pk_bf16_f32 v17, v162, v163
  v_cvt_pk_bf16_f32 v18, v164, v165
  v_cvt_pk_bf16_f32 v19, v166, v167
  v_cvt_pk_bf16_f32 v20, v168, v169
  v_cvt_pk_bf16_f32 v21, v170, v171
  v_cvt_pk_bf16_f32 v22, v172, v173
  v_cvt_pk_bf16_f32 v23, v174, v175
  v_cndmask_b32 v16, v16, v3, s[32:33]
  v_cndmask_b32 v17, v17, v3, s[32:33]
  v_cndmask_b32 v18, v18, v3, s[32:33]
  v_cndmask_b32 v19, v19, v3, s[32:33]
  v_cndmask_b32 v20, v20, v3, s[32:33]
  v_cndmask_b32 v21, v21, v3, s[32:33]
  v_cndmask_b32 v22, v22, v3, s[32:33]
  v_cndmask_b32 v23, v23, v3, s[32:33]
  buffer_store_dwordx4 v[16:19], v8, s[4:7], s29 offen offset:0 sc1
  buffer_store_dwordx4 v[20:23], v8, s[4:7], s29 offen offset:1024 sc1
  v_cvt_pk_bf16_f32 v24, v176, v177
  v_cvt_pk_bf16_f32 v25, v178, v179
  v_cvt_pk_bf16_f32 v26, v180, v181
  v_cvt_pk_bf16_f32 v27, v182, v183
  v_cvt_pk_bf16_f32 v28, v184, v185
  v_cvt_pk_bf16_f32 v29, v186, v187
  v_cvt_pk_bf16_f32 v30, v188, v189
  v_cvt_pk_bf16_f32 v31, v190, v191
  v_cndmask_b32 v24, v24, v3, s[32:33]
  v_cndmask_b32 v25, v25, v3, s[32:33]
  v_cndmask_b32 v26, v26, v3, s[32:33]
  v_cndmask_b32 v27, v27, v3, s[32:33]
  v_cndmask_b32 v28, v28, v3, s[32:33]
  v_cndmask_b32 v29, v29, v3, s[32:33]
  v_cndmask_b32 v30, v30, v3, s[32:33]
  v_cndmask_b32 v31, v31, v3, s[32:33]
  buffer_store_dwordx4 v[24:27], v8, s[4:7], s29 offen offset:2048 sc1
  buffer_store_dwordx4 v[28:31], v8, s[4:7], s29 offen offset:3072 sc1
  s_waitcnt vmcnt(0)
qkvb_exit1:
  s_endpgm
.globl attnb_kernel
.p2align 8
.type attnb_kernel,@function
attnb_kernel:
  s_cmp_ge_u32 s2, 256
  s_cbranch_scc1 attnb_exit1
  s_load_dwordx2 s[12:13], s[0:1], 96
  v_lshrrev_b32 v2, 6, v0
  v_and_b32 v3, 63, v0
  s_nop 0
  v_readfirstlane_b32 s16, v2
  v_lshlrev_b32 v1, 4, v3
  s_and_b32 s17, s2, 7
  s_lshl_b32 s17, s17, 2
  s_lshr_b32 s18, s2, 3
  s_and_b32 s19, s18, 3
  s_add_u32 s17, s17, s19
  s_lshr_b32 s18, s18, 2
  s_waitcnt lgkmcnt(0)
  s_mov_b32 s4, s12
  s_mov_b32 s5, s13
  s_mov_b32 s6, 0x10000000
  s_mov_b32 s7, 0x20000
  s_lshl_b32 s20, s17, 17
  s_add_u32 s21, s20, 41943040
  s_add_u32 s22, s20, 46137344
  s_lshl_b32 s23, s18, 3
  s_lshl_b32 s24, s16, 1
  s_add_u32 s23, s23, s24
  s_lshl_b32 s24, s23, 11
  s_add_u32 s24, s24, s20
  s_add_u32 s24, s24, 37748736
  buffer_load_dwordx4 v[8:11], v1, s[4:7], s24 offen offset:0
  buffer_load_dwordx4 v[12:15], v1, s[4:7], s24 offen offset:1024
  buffer_load_dwordx4 v[16:19], v1, s[4:7], s24 offen offset:2048
  buffer_load_dwordx4 v[20:23], v1, s[4:7], s24 offen offset:3072
  s_mov_b32 s25, s21
  s_mov_b32 s26, s22
  buffer_load_dwordx4 v[136:139], v1, s[4:7], s25 offen
  buffer_load_dwordx4 v[140:143], v1, s[4:7], s25 offen offset:1024
  buffer_load_dwordx4 v[144:147], v1, s[4:7], s26 offen
  buffer_load_dwordx4 v[148:151], v1, s[4:7], s26 offen offset:1024
  s_add_u32 s25, s25, 2048
  s_add_u32 s26, s26, 2048
  s_waitcnt vmcnt(0)
  v_mfma_f32_32x32x16_bf16 v[88:103], v[136:139], v[8:11], 0
  v_mfma_f32_32x32x16_bf16 v[88:103], v[140:143], v[12:15], v[88:103]
  v_mfma_f32_32x32x16_bf16 v[104:119], v[136:139], v[16:19], 0
  v_mfma_f32_32x32x16_bf16 v[104:119], v[140:143], v[20:23], v[104:119]
  s_nop 9
  v_max3_f32 v2, v88, v89, v90
  v_max3_f32 v2, v2, v91, v92
  v_max3_f32 v2, v2, v93, v94
  v_max3_f32 v2, v2, v95, v96
  v_max3_f32 v2, v2, v97, v98
  v_max3_f32 v2, v2, v99, v100
  v_max3_f32 v2, v2, v101, v102
  v_max_f32 v2, v2, v103
  v_mov_b32 v4, v2
  s_nop 1
  v_permlane32_swap_b32 v2, v4
  v_max_f32 v2, v2, v4
  v_sub_f32 v24, 0, v2
  v_sub_f32 v25, 0, v2
  v_sub_f32 v26, 0, v2
  v_sub_f32 v27, 0, v2
  v_sub_f32 v28, 0, v2
  v_sub_f32 v29, 0, v2
  v_sub_f32 v30, 0, v2
  v_sub_f32 v31, 0, v2
  v_sub_f32 v32, 0, v2
  v_sub_f32 v33, 0, v2
  v_sub_f32 v34, 0, v2
  v_sub_f32 v35, 0, v2
  v_sub_f32 v36, 0, v2
  v_sub_f32 v37, 0, v2
  v_sub_f32 v38, 0, v2
  v_sub_f32 v39, 0, v2
  v_max3_f32 v3, v104, v105, v106
  v_max3_f32 v3, v3, v107, v108
  v_max3_f32 v3, v3, v109, v110
  v_max3_f32 v3, v3, v111, v112
  v_max3_f32 v3, v3, v113, v114
  v_max3_f32 v3, v3, v115, v116
  v_max3_f32 v3, v3, v117, v118
  v_max_f32 v3, v3, v119
  v_mov_b32 v4, v3
  s_nop 1
  v_permlane32_swap_b32 v3, v4
  v_max_f32 v3, v3, v4
  v_sub_f32 v40, 0, v3
  v_sub_f32 v41, 0, v3
  v_sub_f32 v42, 0, v3
  v_sub_f32 v43, 0, v3
  v_sub_f32 v44, 0, v3
  v_sub_f32 v45, 0, v3
  v_sub_f32 v46, 0, v3
  v_sub_f32 v47, 0, v3
  v_sub_f32 v48, 0, v3
  v_sub_f32 v49, 0, v3
  v_sub_f32 v50, 0, v3
  v_sub_f32 v51, 0, v3
  v_sub_f32 v52, 0, v3
  v_sub_f32 v53, 0, v3
  v_sub_f32 v54, 0, v3
  v_sub_f32 v55, 0, v3
  s_mov_b32 s28, 0
attnb_main2:
  s_mov_b32 s25, s21
  s_mov_b32 s26, s22
  buffer_load_dwordx4 v[136:139], v1, s[4:7], s25 offen
  buffer_load_dwordx4 v[140:143], v1, s[4:7], s25 offen offset:1024
  buffer_load_dwordx4 v[144:147], v1, s[4:7], s26 offen
  buffer_load_dwordx4 v[148:151], v1, s[4:7], s26 offen offset:1024
  s_add_u32 s25, s25, 2048
  s_add_u32 s26, s26, 2048
  buffer_load_dwordx4 v[152:155], v1, s[4:7], s25 offen
  buffer_load_dwordx4 v[156:159], v1, s[4:7], s25 offen offset:1024
  buffer_load_dwordx4 v[160:163], v1, s[4:7], s26 offen
  buffer_load_dwordx4 v[164:167], v1, s[4:7], s26 offen offset:1024
  s_add_u32 s25, s25, 2048
  s_add_u32 s26, s26, 2048
  v_mov_b32 v56, 0
  v_mov_b32 v57, 0
  v_mov_b32 v58, 0
  v_mov_b32 v59, 0
  v_mov_b32 v60, 0
  v_mov_b32 v61, 0
  v_mov_b32 v62, 0
  v_mov_b32 v63, 0
  v_mov_b32 v64, 0
  v_mov_b32 v65, 0
  v_mov_b32 v66, 0
  v_mov_b32 v67, 0
  v_mov_b32 v68, 0
  v_mov_b32 v69, 0
  v_mov_b32 v70, 0
  v_mov_b32 v71, 0
  v_mov_b32 v72, 0
  v_mov_b32 v73, 0
  v_mov_b32 v74, 0
  v_mov_b32 v75, 0
  v_mov_b32 v76, 0
  v_mov_b32 v77, 0
  v_mov_b32 v78, 0
  v_mov_b32 v79, 0
  v_mov_b32 v80, 0
  v_mov_b32 v81, 0
  v_mov_b32 v82, 0
  v_mov_b32 v83, 0
  v_mov_b32 v84, 0
  v_mov_b32 v85, 0
  v_mov_b32 v86, 0
  v_mov_b32 v87, 0
  s_waitcnt vmcnt(4)
  v_mfma_f32_32x32x16_bf16 v[88:103], v[136:139], v[8:11], v[24:39]
  v_mfma_f32_32x32x16_bf16 v[88:103], v[140:143], v[12:15], v[88:103]
  s_nop 11
  v_exp_f32 v88, v88
  v_exp_f32 v89, v89
  v_exp_f32 v90, v90
  v_exp_f32 v91, v91
  v_exp_f32 v92, v92
  v_exp_f32 v93, v93
  v_exp_f32 v94, v94
  v_exp_f32 v95, v95
  v_mfma_f32_32x32x16_bf16 v[104:119], v[136:139], v[16:19], v[40:55]
  v_cvt_pk_bf16_f32 v120, v88, v89
  v_cvt_pk_bf16_f32 v121, v90, v91
  v_cvt_pk_bf16_f32 v122, v92, v93
  v_cvt_pk_bf16_f32 v123, v94, v95
  v_exp_f32 v96, v96
  v_exp_f32 v97, v97
  v_mfma_f32_32x32x16_bf16 v[104:119], v[140:143], v[20:23], v[104:119]
  v_exp_f32 v98, v98
  v_exp_f32 v99, v99
  v_exp_f32 v100, v100
  v_exp_f32 v101, v101
  v_mfma_f32_32x32x16_bf16 v[56:71], v[144:147], v[120:123], v[56:71]
  v_exp_f32 v102, v102
  v_exp_f32 v103, v103
  v_cvt_pk_bf16_f32 v124, v96, v97
  v_cvt_pk_bf16_f32 v125, v98, v99
  v_cvt_pk_bf16_f32 v126, v100, v101
  v_cvt_pk_bf16_f32 v127, v102, v103
  buffer_load_dwordx4 v[168:171], v1, s[4:7], s25 offen
  buffer_load_dwordx4 v[172:175], v1, s[4:7], s25 offen offset:1024
  buffer_load_dwordx4 v[176:179], v1, s[4:7], s26 offen
  buffer_load_dwordx4 v[180:183], v1, s[4:7], s26 offen offset:1024
  s_add_u32 s25, s25, 2048
  s_add_u32 s26, s26, 2048
  s_waitcnt vmcnt(4)
  v_exp_f32 v104, v104
  v_exp_f32 v105, v105
  v_exp_f32 v106, v106
  v_exp_f32 v107, v107
  v_mfma_f32_32x32x16_bf16 v[56:71], v[148:151], v[124:127], v[56:71]
  v_exp_f32 v108, v108
  v_exp_f32 v109, v109
  v_exp_f32 v110, v110
  v_exp_f32 v111, v111
  v_mfma_f32_32x32x16_bf16 v[88:103], v[152:155], v[8:11], v[24:39]
  v_cvt_pk_bf16_f32 v128, v104, v105
  v_cvt_pk_bf16_f32 v129, v106, v107
  v_cvt_pk_bf16_f32 v130, v108, v109
  v_cvt_pk_bf16_f32 v131, v110, v111
  v_exp_f32 v112, v112
  v_exp_f32 v113, v113
  v_mfma_f32_32x32x16_bf16 v[88:103], v[156:159], v[12:15], v[88:103]
  v_exp_f32 v114, v114
  v_exp_f32 v115, v115
  v_exp_f32 v116, v116
  v_exp_f32 v117, v117
  v_mfma_f32_32x32x16_bf16 v[72:87], v[144:147], v[128:131], v[72:87]
  v_exp_f32 v118, v118
  v_exp_f32 v119, v119
  v_cvt_pk_bf16_f32 v132, v112, v113
  v_cvt_pk_bf16_f32 v133, v114, v115
  v_cvt_pk_bf16_f32 v134, v116, v117
  v_cvt_pk_bf16_f32 v135, v118, v119
  s_mov_b32 s27, 0
attnb_loop3:
  v_exp_f32 v88, v88
  v_exp_f32 v89, v89
  v_exp_f32 v90, v90
  v_exp_f32 v91, v91
  v_mfma_f32_32x32x16_bf16 v[72:87], v[148:151], v[132:135], v[72:87]
  v_exp_f32 v92, v92
  v_exp_f32 v93, v93
  v_exp_f32 v94, v94
  v_exp_f32 v95, v95
  v_mfma_f32_32x32x16_bf16 v[104:119], v[152:155], v[16:19], v[40:55]
  v_cvt_pk_bf16_f32 v120, v88, v89
  v_cvt_pk_bf16_f32 v121, v90, v91
  v_cvt_pk_bf16_f32 v122, v92, v93
  v_cvt_pk_bf16_f32 v123, v94, v95
  v_exp_f32 v96, v96
  v_exp_f32 v97, v97
  v_mfma_f32_32x32x16_bf16 v[104:119], v[156:159], v[20:23], v[104:119]
  v_exp_f32 v98, v98
  v_exp_f32 v99, v99
  v_exp_f32 v100, v100
  v_exp_f32 v101, v101
  v_mfma_f32_32x32x16_bf16 v[56:71], v[160:163], v[120:123], v[56:71]
  v_exp_f32 v102, v102
  v_exp_f32 v103, v103
  v_cvt_pk_bf16_f32 v124, v96, v97
  v_cvt_pk_bf16_f32 v125, v98, v99
  v_cvt_pk_bf16_f32 v126, v100, v101
  v_cvt_pk_bf16_f32 v127, v102, v103
  buffer_load_dwordx4 v[136:139], v1, s[4:7], s25 offen
  buffer_load_dwordx4 v[140:143], v1, s[4:7], s25 offen offset:1024
  buffer_load_dwordx4 v[144:147], v1, s[4:7], s26 offen
  buffer_load_dwordx4 v[148:151], v1, s[4:7], s26 offen offset:1024
  s_add_u32 s25, s25, 2048
  s_add_u32 s26, s26, 2048
  s_waitcnt vmcnt(4)
  v_exp_f32 v104, v104
  v_exp_f32 v105, v105
  v_exp_f32 v106, v106
  v_exp_f32 v107, v107
  v_mfma_f32_32x32x16_bf16 v[56:71], v[164:167], v[124:127], v[56:71]
  v_exp_f32 v108, v108
  v_exp_f32 v109, v109
  v_exp_f32 v110, v110
  v_exp_f32 v111, v111
  v_mfma_f32_32x32x16_bf16 v[88:103], v[168:171], v[8:11], v[24:39]
  v_cvt_pk_bf16_f32 v128, v104, v105
  v_cvt_pk_bf16_f32 v129, v106, v107
  v_cvt_pk_bf16_f32 v130, v108, v109
  v_cvt_pk_bf16_f32 v131, v110, v111
  v_exp_f32 v112, v112
  v_exp_f32 v113, v113
  v_mfma_f32_32x32x16_bf16 v[88:103], v[172:175], v[12:15], v[88:103]
  v_exp_f32 v114, v114
  v_exp_f32 v115, v115
  v_exp_f32 v116, v116
  v_exp_f32 v117, v117
  v_mfma_f32_32x32x16_bf16 v[72:87], v[160:163], v[128:131], v[72:87]
  v_exp_f32 v118, v118
  v_exp_f32 v119, v119
  v_cvt_pk_bf16_f32 v132, v112, v113
  v_cvt_pk_bf16_f32 v133, v114, v115
  v_cvt_pk_bf16_f32 v134, v116, v117
  v_cvt_pk_bf16_f32 v135, v118, v119
  s_nop 0
  v_exp_f32 v88, v88
  v_exp_f32 v89, v89
  v_exp_f32 v90, v90
  v_exp_f32 v91, v91
  v_mfma_f32_32x32x16_bf16 v[72:87], v[164:167], v[132:135], v[72:87]
  v_exp_f32 v92, v92
  v_exp_f32 v93, v93
  v_exp_f32 v94, v94
  v_exp_f32 v95, v95
  v_mfma_f32_32x32x16_bf16 v[104:119], v[168:171], v[16:19], v[40:55]
  v_cvt_pk_bf16_f32 v120, v88, v89
  v_cvt_pk_bf16_f32 v121, v90, v91
  v_cvt_pk_bf16_f32 v122, v92, v93
  v_cvt_pk_bf16_f32 v123, v94, v95
  v_exp_f32 v96, v96
  v_exp_f32 v97, v97
  v_mfma_f32_32x32x16_bf16 v[104:119], v[172:175], v[20:23], v[104:119]
  v_exp_f32 v98, v98
  v_exp_f32 v99, v99
  v_exp_f32 v100, v100
  v_exp_f32 v101, v101
  v_mfma_f32_32x32x16_bf16 v[56:71], v[176:179], v[120:123], v[56:71]
  v_exp_f32 v102, v102
  v_exp_f32 v103, v103
  v_cvt_pk_bf16_f32 v124, v96, v97
  v_cvt_pk_bf16_f32 v125, v98, v99
  v_cvt_pk_bf16_f32 v126, v100, v101
  v_cvt_pk_bf16_f32 v127, v102, v103
  buffer_load_dwordx4 v[152:155], v1, s[4:7], s25 offen
  buffer_load_dwordx4 v[156:159], v1, s[4:7], s25 offen offset:1024
  buffer_load_dwordx4 v[160:163], v1, s[4:7], s26 offen
  buffer_load_dwordx4 v[164:167], v1, s[4:7], s26 offen offset:1024
  s_add_u32 s25, s25, 2048
  s_add_u32 s26, s26, 2048
  s_waitcnt vmcnt(4)
  v_exp_f32 v104, v104
  v_exp_f32 v105, v105
  v_exp_f32 v106, v106
  v_exp_f32 v107, v107
  v_mfma_f32_32x32x16_bf16 v[56:71], v[180:183], v[124:127], v[56:71]
  v_exp_f32 v108, v108
  v_exp_f32 v109, v109
  v_exp_f32 v110, v110
  v_exp_f32 v111, v111
  v_mfma_f32_32x32x16_bf16 v[88:103], v[136:139], v[8:11], v[24:39]
  v_cvt_pk_bf16_f32 v128, v104, v105
  v_cvt_pk_bf16_f32 v129, v106, v107
  v_cvt_pk_bf16_f32 v130, v108, v109
  v_cvt_pk_bf16_f32 v131, v110, v111
  v_exp_f32 v112, v112
  v_exp_f32 v113, v113
  v_mfma_f32_32x32x16_bf16 v[88:103], v[140:143], v[12:15], v[88:103]
  v_exp_f32 v114, v114
  v_exp_f32 v115, v115
  v_exp_f32 v116, v116
  v_exp_f32 v117, v117
  v_mfma_f32_32x32x16_bf16 v[72:87], v[176:179], v[128:131], v[72:87]
  v_exp_f32 v118, v118
  v_exp_f32 v119, v119
  v_cvt_pk_bf16_f32 v132, v112, v113
  v_cvt_pk_bf16_f32 v133, v114, v115
  v_cvt_pk_bf16_f32 v134, v116, v117
  v_cvt_pk_bf16_f32 v135, v118, v119
  s_nop 0
  v_exp_f32 v88, v88
  v_exp_f32 v89, v89
  v_exp_f32 v90, v90
  v_exp_f32 v91, v91
  v_mfma_f32_32x32x16_bf16 v[72:87], v[180:183], v[132:135], v[72:87]
  v_exp_f32 v92, v92
  v_exp_f32 v93, v93
  v_exp_f32 v94, v94
  v_exp_f32 v95, v95
  v_mfma_f32_32x32x16_bf16 v[104:119], v[136:139], v[16:19], v[40:55]
  v_cvt_pk_bf16_f32 v120, v88, v89
  v_cvt_pk_bf16_f32 v121, v90, v91
  v_cvt_pk_bf16_f32 v122, v92, v93
  v_cvt_pk_bf16_f32 v123, v94, v95
  v_exp_f32 v96, v96
  v_exp_f32 v97, v97
  v_mfma_f32_32x32x16_bf16 v[104:119], v[140:143], v[20:23], v[104:119]
  v_exp_f32 v98, v98
  v_exp_f32 v99, v99
  v_exp_f32 v100, v100
  v_exp_f32 v101, v101
  v_mfma_f32_32x32x16_bf16 v[56:71], v[144:147], v[120:123], v[56:71]
  v_exp_f32 v102, v102
  v_exp_f32 v103, v103
  v_cvt_pk_bf16_f32 v124, v96, v97
  v_cvt_pk_bf16_f32 v125, v98, v99
  v_cvt_pk_bf16_f32 v126, v100, v101
  v_cvt_pk_bf16_f32 v127, v102, v103
  buffer_load_dwordx4 v[168:171], v1, s[4:7], s25 offen
  buffer_load_dwordx4 v[172:175], v1, s[4:7], s25 offen offset:1024
  buffer_load_dwordx4 v[176:179], v1, s[4:7], s26 offen
  buffer_load_dwordx4 v[180:183], v1, s[4:7], s26 offen offset:1024
  s_add_u32 s25, s25, 2048
  s_add_u32 s26, s26, 2048
  s_waitcnt vmcnt(4)
  v_exp_f32 v104, v104
  v_exp_f32 v105, v105
  v_exp_f32 v106, v106
  v_exp_f32 v107, v107
  v_mfma_f32_32x32x16_bf16 v[56:71], v[148:151], v[124:127], v[56:71]
  v_exp_f32 v108, v108
  v_exp_f32 v109, v109
  v_exp_f32 v110, v110
  v_exp_f32 v111, v111
  v_mfma_f32_32x32x16_bf16 v[88:103], v[152:155], v[8:11], v[24:39]
  v_cvt_pk_bf16_f32 v128, v104, v105
  v_cvt_pk_bf16_f32 v129, v106, v107
  v_cvt_pk_bf16_f32 v130, v108, v109
  v_cvt_pk_bf16_f32 v131, v110, v111
  v_exp_f32 v112, v112
  v_exp_f32 v113, v113
  v_mfma_f32_32x32x16_bf16 v[88:103], v[156:159], v[12:15], v[88:103]
  v_exp_f32 v114, v114
  v_exp_f32 v115, v115
  v_exp_f32 v116, v116
  v_exp_f32 v117, v117
  v_mfma_f32_32x32x16_bf16 v[72:87], v[144:147], v[128:131], v[72:87]
  v_exp_f32 v118, v118
  v_exp_f32 v119, v119
  v_cvt_pk_bf16_f32 v132, v112, v113
  v_cvt_pk_bf16_f32 v133, v114, v115
  v_cvt_pk_bf16_f32 v134, v116, v117
  v_cvt_pk_bf16_f32 v135, v118, v119
  s_add_u32 s27, s27, 1
  s_cmp_lt_u32 s27, 20
  s_cbranch_scc1 attnb_loop3
  v_exp_f32 v88, v88
  v_exp_f32 v89, v89
  v_exp_f32 v90, v90
  v_exp_f32 v91, v91
  v_mfma_f32_32x32x16_bf16 v[72:87], v[148:151], v[132:135], v[72:87]
  v_exp_f32 v92, v92
  v_exp_f32 v93, v93
  v_exp_f32 v94, v94
  v_exp_f32 v95, v95
  v_mfma_f32_32x32x16_bf16 v[104:119], v[152:155], v[16:19], v[40:55]
  v_cvt_pk_bf16_f32 v120, v88, v89
  v_cvt_pk_bf16_f32 v121, v90, v91
  v_cvt_pk_bf16_f32 v122, v92, v93
  v_cvt_pk_bf16_f32 v123, v94, v95
  v_exp_f32 v96, v96
  v_exp_f32 v97, v97
  v_mfma_f32_32x32x16_bf16 v[104:119], v[156:159], v[20:23], v[104:119]
  v_exp_f32 v98, v98
  v_exp_f32 v99, v99
  v_exp_f32 v100, v100
  v_exp_f32 v101, v101
  v_mfma_f32_32x32x16_bf16 v[56:71], v[160:163], v[120:123], v[56:71]
  v_exp_f32 v102, v102
  v_exp_f32 v103, v103
  v_cvt_pk_bf16_f32 v124, v96, v97
  v_cvt_pk_bf16_f32 v125, v98, v99
  v_cvt_pk_bf16_f32 v126, v100, v101
  v_cvt_pk_bf16_f32 v127, v102, v103
  buffer_load_dwordx4 v[136:139], v1, s[4:7], s25 offen
  buffer_load_dwordx4 v[140:143], v1, s[4:7], s25 offen offset:1024
  buffer_load_dwordx4 v[144:147], v1, s[4:7], s26 offen
  buffer_load_dwordx4 v[148:151], v1, s[4:7], s26 offen offset:1024
  s_add_u32 s25, s25, 2048
  s_add_u32 s26, s26, 2048
  s_waitcnt vmcnt(4)
  v_exp_f32 v104, v104
  v_exp_f32 v105, v105
  v_exp_f32 v106, v106
  v_exp_f32 v107, v107
  v_mfma_f32_32x32x16_bf16 v[56:71], v[164:167], v[124:127], v[56:71]
  v_exp_f32 v108, v108
  v_exp_f32 v109, v109
  v_exp_f32 v110, v110
  v_exp_f32 v111, v111
  v_mfma_f32_32x32x16_bf16 v[88:103], v[168:171], v[8:11], v[24:39]
  v_cvt_pk_bf16_f32 v128, v104, v105
  v_cvt_pk_bf16_f32 v129, v106, v107
  v_cvt_pk_bf16_f32 v130, v108, v109
  v_cvt_pk_bf16_f32 v131, v110, v111
  v_exp_f32 v112, v112
  v_exp_f32 v113, v113
  v_mfma_f32_32x32x16_bf16 v[88:103], v[172:175], v[12:15], v[88:103]
  v_exp_f32 v114, v114
  v_exp_f32 v115, v115
  v_exp_f32 v116, v116
  v_exp_f32 v117, v117
  v_mfma_f32_32x32x16_bf16 v[72:87], v[160:163], v[128:131], v[72:87]
  v_exp_f32 v118, v118
  v_exp_f32 v119, v119
  v_cvt_pk_bf16_f32 v132, v112, v113
  v_cvt_pk_bf16_f32 v133, v114, v115
  v_cvt_pk_bf16_f32 v134, v116, v117
  v_cvt_pk_bf16_f32 v135, v118, v119
  s_nop 0
  v_exp_f32 v88, v88
  v_exp_f32 v89, v89
  v_exp_f32 v90, v90
  v_exp_f32 v91, v91
  v_mfma_f32_32x32x16_bf16 v[72:87], v[164:167], v[132:135], v[72:87]
  v_exp_f32 v92, v92
  v_exp_f32 v93, v93
  v_exp_f32 v94, v94
  v_exp_f32 v95, v95
  v_mfma_f32_32x32x16_bf16 v[104:119], v[168:171], v[16:19], v[40:55]
  v_cvt_pk_bf16_f32 v120, v88, v89
  v_cvt_pk_bf16_f32 v121, v90, v91
  v_cvt_pk_bf16_f32 v122, v92, v93
  v_cvt_pk_bf16_f32 v123, v94, v95
  v_exp_f32 v96, v96
  v_exp_f32 v97, v97
  v_mfma_f32_32x32x16_bf16 v[104:119], v[172:175], v[20:23], v[104:119]
  v_exp_f32 v98, v98
  v_exp_f32 v99, v99
  v_exp_f32 v100, v100
  v_exp_f32 v101, v101
  v_mfma_f32_32x32x16_bf16 v[56:71], v[176:179], v[120:123], v[56:71]
  v_exp_f32 v102, v102
  v_exp_f32 v103, v103
  v_cvt_pk_bf16_f32 v124, v96, v97
  v_cvt_pk_bf16_f32 v125, v98, v99
  v_cvt_pk_bf16_f32 v126, v100, v101
  v_cvt_pk_bf16_f32 v127, v102, v103
  s_waitcnt vmcnt(0)
  v_exp_f32 v104, v104
  v_exp_f32 v105, v105
  v_exp_f32 v106, v106
  v_exp_f32 v107, v107
  v_mfma_f32_32x32x16_bf16 v[56:71], v[180:183], v[124:127], v[56:71]
  v_exp_f32 v108, v108
  v_exp_f32 v109, v109
  v_exp_f32 v110, v110
  v_exp_f32 v111, v111
  v_mfma_f32_32x32x16_bf16 v[88:103], v[136:139], v[8:11], v[24:39]
  v_cvt_pk_bf16_f32 v128, v104, v105
  v_cvt_pk_bf16_f32 v129, v106, v107
  v_cvt_pk_bf16_f32 v130, v108, v109
  v_cvt_pk_bf16_f32 v131, v110, v111
  v_exp_f32 v112, v112
  v_exp_f32 v113, v113
  v_mfma_f32_32x32x16_bf16 v[88:103], v[140:143], v[12:15], v[88:103]
  v_exp_f32 v114, v114
  v_exp_f32 v115, v115
  v_exp_f32 v116, v116
  v_exp_f32 v117, v117
  v_mfma_f32_32x32x16_bf16 v[72:87], v[176:179], v[128:131], v[72:87]
  v_exp_f32 v118, v118
  v_exp_f32 v119, v119
  v_cvt_pk_bf16_f32 v132, v112, v113
  v_cvt_pk_bf16_f32 v133, v114, v115
  v_cvt_pk_bf16_f32 v134, v116, v117
  v_cvt_pk_bf16_f32 v135, v118, v119
  s_nop 0
  v_exp_f32 v88, v88
  v_exp_f32 v89, v89
  v_exp_f32 v90, v90
  v_exp_f32 v91, v91
  v_mfma_f32_32x32x16_bf16 v[72:87], v[180:183], v[132:135], v[72:87]
  v_exp_f32 v92, v92
  v_exp_f32 v93, v93
  v_exp_f32 v94, v94
  v_exp_f32 v95, v95
  v_mfma_f32_32x32x16_bf16 v[104:119], v[136:139], v[16:19], v[40:55]
  v_cvt_pk_bf16_f32 v120, v88, v89
  v_cvt_pk_bf16_f32 v121, v90, v91
  v_cvt_pk_bf16_f32 v122, v92, v93
  v_cvt_pk_bf16_f32 v123, v94, v95
  v_exp_f32 v96, v96
  v_exp_f32 v97, v97
  v_mfma_f32_32x32x16_bf16 v[104:119], v[140:143], v[20:23], v[104:119]
  v_exp_f32 v98, v98
  v_exp_f32 v99, v99
  v_exp_f32 v100, v100
  v_exp_f32 v101, v101
  v_mfma_f32_32x32x16_bf16 v[56:71], v[144:147], v[120:123], v[56:71]
  v_exp_f32 v102, v102
  v_exp_f32 v103, v103
  v_cvt_pk_bf16_f32 v124, v96, v97
  v_cvt_pk_bf16_f32 v125, v98, v99
  v_cvt_pk_bf16_f32 v126, v100, v101
  v_cvt_pk_bf16_f32 v127, v102, v103
  s_nop 0
  v_exp_f32 v104, v104
  v_exp_f32 v105, v105
  v_exp_f32 v106, v106
  v_exp_f32 v107, v107
  v_mfma_f32_32x32x16_bf16 v[56:71], v[148:151], v[124:127], v[56:71]
  v_exp_f32 v108, v108
  v_exp_f32 v109, v109
  v_exp_f32 v110, v110
  v_exp_f32 v111, v111
  v_cvt_pk_bf16_f32 v128, v104, v105
  v_cvt_pk_bf16_f32 v129, v106, v107
  v_cvt_pk_bf16_f32 v130, v108, v109
  v_cvt_pk_bf16_f32 v131, v110, v111
  v_exp_f32 v112, v112
  v_exp_f32 v113, v113
  v_exp_f32 v114, v114
  v_exp_f32 v115, v115
  v_exp_f32 v116, v116
  v_exp_f32 v117, v117
  v_mfma_f32_32x32x16_bf16 v[72:87], v[144:147], v[128:131], v[72:87]
  v_exp_f32 v118, v118
  v_exp_f32 v119, v119
  v_cvt_pk_bf16_f32 v132, v112, v113
  v_cvt_pk_bf16_f32 v133, v114, v115
  v_cvt_pk_bf16_f32 v134, v116, v117
  v_cvt_pk_bf16_f32 v135, v118, v119
  s_nop 1
  v_mfma_f32_32x32x16_bf16 v[72:87], v[148:151], v[132:135], v[72:87]
  v_mov_b32 v2, v64
  v_mov_b32 v4, v2
  s_nop 1
  v_permlane32_swap_b32 v4, v2
  s_nop 6
  v_mov_b32 v3, v80
  v_mov_b32 v4, v3
  s_nop 1
  v_permlane32_swap_b32 v4, v3
  s_cmp_eq_u32 s28, 1
  s_cbranch_scc1 attnb_done5
  v_max_f32 v4, v2, v3
  v_cmp_nge_f32 vcc, 0x4e800000, v4
  v_cmp_u_f32 s[30:31], v2, v3
  s_nop 3
  s_or_b64 s[32:33], vcc, s[30:31]
  s_movk_i32 s34, 0x207
  v_cmp_class_f32 vcc, v56, s34
  s_nop 3
  s_or_b64 s[32:33], s[32:33], vcc
  v_cmp_class_f32 vcc, v57, s34
  s_nop 3
  s_or_b64 s[32:33], s[32:33], vcc
  v_cmp_class_f32 vcc, v58, s34
  s_nop 3
  s_or_b64 s[32:33], s[32:33], vcc
  v_cmp_class_f32 vcc, v59, s34
  s_nop 3
  s_or_b64 s[32:33], s[32:33], vcc
  v_cmp_class_f32 vcc, v60, s34
  s_nop 3
  s_or_b64 s[32:33], s[32:33], vcc
  v_cmp_class_f32 vcc, v61, s34
  s_nop 3
  s_or_b64 s[32:33], s[32:33], vcc
  v_cmp_class_f32 vcc, v62, s34
  s_nop 3
  s_or_b64 s[32:33], s[32:33], vcc
  v_cmp_class_f32 vcc, v63, s34
  s_nop 3
  s_or_b64 s[32:33], s[32:33], vcc
  v_cmp_class_f32 vcc, v64, s34
  s_nop 3
  s_or_b64 s[32:33], s[32:33], vcc
  v_cmp_class_f32 vcc, v65, s34
  s_nop 3
  s_or_b64 s[32:33], s[32:33], vcc
  v_cmp_class_f32 vcc, v66, s34
  s_nop 3
  s_or_b64 s[32:33], s[32:33], vcc
  v_cmp_class_f32 vcc, v67, s34
  s_nop 3
  s_or_b64 s[32:33], s[32:33], vcc
  v_cmp_class_f32 vcc, v68, s34
  s_nop 3
  s_or_b64 s[32:33], s[32:33], vcc
  v_cmp_class_f32 vcc, v69, s34
  s_nop 3
  s_or_b64 s[32:33], s[32:33], vcc
  v_cmp_class_f32 vcc, v70, s34
  s_nop 3
  s_or_b64 s[32:33], s[32:33], vcc
  v_cmp_class_f32 vcc, v71, s34
  s_nop 3
  s_or_b64 s[32:33], s[32:33], vcc
  v_cmp_class_f32 vcc, v72, s34
  s_nop 3
  s_or_b64 s[32:33], s[32:33], vcc
  v_cmp_class_f32 vcc, v73, s34
  s_nop 3
  s_or_b64 s[32:33], s[32:33], vcc
  v_cmp_class_f32 vcc, v74, s34
  s_nop 3
  s_or_b64 s[32:33], s[32:33], vcc
  v_cmp_class_f32 vcc, v75, s34
  s_nop 3
  s_or_b64 s[32:33], s[32:33], vcc
  v_cmp_class_f32 vcc, v76, s34
  s_nop 3
  s_or_b64 s[32:33], s[32:33], vcc
  v_cmp_class_f32 vcc, v77, s34
  s_nop 3
  s_or_b64 s[32:33], s[32:33], vcc
  v_cmp_class_f32 vcc, v78, s34
  s_nop 3
  s_or_b64 s[32:33], s[32:33], vcc
  v_cmp_class_f32 vcc, v79, s34
  s_nop 3
  s_or_b64 s[32:33], s[32:33], vcc
  v_cmp_class_f32 vcc, v80, s34
  s_nop 3
  s_or_b64 s[32:33], s[32:33], vcc
  v_cmp_class_f32 vcc, v81, s34
  s_nop 3
  s_or_b64 s[32:33], s[32:33], vcc
  v_cmp_class_f32 vcc, v82, s34
  s_nop 3
  s_or_b64 s[32:33], s[32:33], vcc
  v_cmp_class_f32 vcc, v83, s34
  s_nop 3
  s_or_b64 s[32:33], s[32:33], vcc
  v_cmp_class_f32 vcc, v84, s34
  s_nop 3
  s_or_b64 s[32:33], s[32:33], vcc
  v_cmp_class_f32 vcc, v85, s34
  s_nop 3
  s_or_b64 s[32:33], s[32:33], vcc
  v_cmp_class_f32 vcc, v86, s34
  s_nop 3
  s_or_b64 s[32:33], s[32:33], vcc
  v_cmp_class_f32 vcc, v87, s34
  s_nop 3
  s_or_b64 s[32:33], s[32:33], vcc
  s_mov_b64 vcc, s[32:33]
  s_cbranch_vccz attnb_done5
  s_mov_b32 s25, s21
  s_mov_b32 s27, 0
  v_mov_b32 v120, 0xff800000
  v_mov_b32 v121, 0xff800000
attnb_fb4:
  buffer_load_dwordx4 v[136:139], v1, s[4:7], s25 offen
  buffer_load_dwordx4 v[140:143], v1, s[4:7], s25 offen offset:1024
  s_add_u32 s25, s25, 2048
  s_waitcnt vmcnt(0)
  v_mfma_f32_32x32x16_bf16 v[88:103], v[136:139], v[8:11], 0
  v_mfma_f32_32x32x16_bf16 v[88:103], v[140:143], v[12:15], v[88:103]
  v_mfma_f32_32x32x16_bf16 v[104:119], v[136:139], v[16:19], 0
  v_mfma_f32_32x32x16_bf16 v[104:119], v[140:143], v[20:23], v[104:119]
  s_nop 9
  v_max3_f32 v2, v88, v89, v90
  v_max3_f32 v2, v2, v91, v92
  v_max3_f32 v2, v2, v93, v94
  v_max3_f32 v2, v2, v95, v96
  v_max3_f32 v2, v2, v97, v98
  v_max3_f32 v2, v2, v99, v100
  v_max3_f32 v2, v2, v101, v102
  v_max_f32 v2, v2, v103
  v_max_f32 v120, v120, v2
  s_nop 2
  v_max3_f32 v3, v104, v105, v106
  v_max3_f32 v3, v3, v107, v108
  v_max3_f32 v3, v3, v109, v110
  v_max3_f32 v3, v3, v111, v112
  v_max3_f32 v3, v3, v113, v114
  v_max3_f32 v3, v3, v115, v116
  v_max3_f32 v3, v3, v117, v118
  v_max_f32 v3, v3, v119
  v_max_f32 v121, v121, v3
  s_add_u32 s27, s27, 1
  s_cmp_lt_u32 s27, 64
  s_cbranch_scc1 attnb_fb4
  v_mov_b32 v4, v120
  s_nop 1
  v_permlane32_swap_b32 v120, v4
  v_max_f32 v120, v120, v4
  v_sub_f32 v24, 0, v120
  v_sub_f32 v25, 0, v120
  v_sub_f32 v26, 0, v120
  v_sub_f32 v27, 0, v120
  v_sub_f32 v28, 0, v120
  v_sub_f32 v29, 0, v120
  v_sub_f32 v30, 0, v120
  v_sub_f32 v31, 0, v120
  v_sub_f32 v32, 0, v120
  v_sub_f32 v33, 0, v120
  v_sub_f32 v34, 0, v120
  v_sub_f32 v35, 0, v120
  v_sub_f32 v36, 0, v120
  v_sub_f32 v37, 0, v120
  v_sub_f32 v38, 0, v120
  v_sub_f32 v39, 0, v120
  v_mov_b32 v4, v121
  s_nop 1
  v_permlane32_swap_b32 v121, v4
  v_max_f32 v121, v121, v4
  v_sub_f32 v40, 0, v121
  v_sub_f32 v41, 0, v121
  v_sub_f32 v42, 0, v121
  v_sub_f32 v43, 0, v121
  v_sub_f32 v44, 0, v121
  v_sub_f32 v45, 0, v121
  v_sub_f32 v46, 0, v121
  v_sub_f32 v47, 0, v121
  v_sub_f32 v48, 0, v121
  v_sub_f32 v49, 0, v121
  v_sub_f32 v50, 0, v121
  v_sub_f32 v51, 0, v121
  v_sub_f32 v52, 0, v121
  v_sub_f32 v53, 0, v121
  v_sub_f32 v54, 0, v121
  v_sub_f32 v55, 0, v121
  s_mov_b32 s28, 1
  s_branch attnb_main2
attnb_done5:
  v_and_b32 v136, 63, v0
  v_and_b32 v137, 15, v136
  v_lshlrev_b32 v137, 4, v137
  v_lshrrev_b32 v138, 5, v136
  v_lshl_add_u32 v137, v138, 8, v137
  v_bfe_u32 v138, v136, 4, 1
  v_lshl_add_u32 v137, v138, 15, v137
  s_lshl_b32 s24, s23, 16
  s_lshl_b32 s25, s17, 10
  s_add_u32 s24, s24, s25
  s_add_u32 s24, s24, 50331648
  v_rcp_f32 v4, v2
  s_nop 0
  v_mul_f32 v56, v56, v4
  v_mul_f32 v57, v57, v4
  v_mul_f32 v58, v58, v4
  v_mul_f32 v59, v59, v4
  v_mul_f32 v60, v60, v4
  v_mul_f32 v61, v61, v4
  v_mul_f32 v62, v62, v4
  v_mul_f32 v63, v63, v4
  v_mul_f32 v64, v64, v4
  v_mul_f32 v65, v65, v4
  v_mul_f32 v66, v66, v4
  v_mul_f32 v67, v67, v4
  v_mul_f32 v68, v68, v4
  v_mul_f32 v69, v69, v4
  v_mul_f32 v70, v70, v4
  v_mul_f32 v71, v71, v4
  v_cvt_pk_bf16_f32 v120, v56, v57
  v_cvt_pk_bf16_f32 v121, v58, v59
  v_cvt_pk_bf16_f32 v122, v60, v61
  v_cvt_pk_bf16_f32 v123, v62, v63
  v_cvt_pk_bf16_f32 v124, v64, v65
  v_cvt_pk_bf16_f32 v125, v66, v67
  v_cvt_pk_bf16_f32 v126, v68, v69
  v_cvt_pk_bf16_f32 v127, v70, v71
  buffer_store_dwordx4 v[120:123], v137, s[4:7], s24 offen sc1
  buffer_store_dwordx4 v[124:127], v137, s[4:7], s24 offen offset:512 sc1
  v_rcp_f32 v4, v3
  s_nop 0
  v_mul_f32 v72, v72, v4
  v_mul_f32 v73, v73, v4
  v_mul_f32 v74, v74, v4
  v_mul_f32 v75, v75, v4
  v_mul_f32 v76, v76, v4
  v_mul_f32 v77, v77, v4
  v_mul_f32 v78, v78, v4
  v_mul_f32 v79, v79, v4
  v_mul_f32 v80, v80, v4
  v_mul_f32 v81, v81, v4
  v_mul_f32 v82, v82, v4
  v_mul_f32 v83, v83, v4
  v_mul_f32 v84, v84, v4
  v_mul_f32 v85, v85, v4
  v_mul_f32 v86, v86, v4
  v_mul_f32 v87, v87, v4
  v_cvt_pk_bf16_f32 v128, v72, v73
  v_cvt_pk_bf16_f32 v129, v74, v75
  v_cvt_pk_bf16_f32 v130, v76, v77
  v_cvt_pk_bf16_f32 v131, v78, v79
  v_cvt_pk_bf16_f32 v132, v80, v81
  v_cvt_pk_bf16_f32 v133, v82, v83
  v_cvt_pk_bf16_f32 v134, v84, v85
  v_cvt_pk_bf16_f32 v135, v86, v87
  s_add_u32 s24, s24, 65536
  buffer_store_dwordx4 v[128:131], v137, s[4:7], s24 offen sc1
  buffer_store_dwordx4 v[132:135], v137, s[4:7], s24 offen offset:512 sc1
attnb_exit1:
  s_endpgm
.globl outb1_kernel
.p2align 8
.type outb1_kernel,@function
outb1_kernel:
  s_cmp_ge_u32 s2, 256
  s_cbranch_scc1 outb1_exit1
  s_load_dwordx2 s[12:13], s[0:1], 96
  s_load_dwordx2 s[14:15], s[0:1], 0
  s_load_dwordx2 s[48:49], s[0:1], 80
  v_lshrrev_b32 v3, 6, v0
  v_and_b32 v4, 63, v0
  s_nop 0
  v_readfirstlane_b32 s16, v3
  v_lshlrev_b32 v1, 4, v4
  s_and_b32 s17, s2, 7
  s_lshl_b32 s17, s17, 2
  s_lshr_b32 s18, s2, 3
  s_and_b32 s19, s18, 3
  s_add_u32 s17, s17, s19
  s_lshr_b32 s18, s18, 2
  s_waitcnt lgkmcnt(0)
  s_mov_b32 s4, s12
  s_mov_b32 s5, s13
  s_mov_b32 s6, 0x10000000
  s_mov_b32 s7, 0x20000
  s_mov_b32 s8, s12
  s_mov_b32 s9, s13
  s_mov_b32 s10, 0x10000000
  s_mov_b32 s11, 0x20000
  s_mov_b32 s20, 82313216
  s_mov_b32 s52, s48
  s_mov_b32 s53, s49
  s_mov_b32 s54, 2621440
  s_mov_b32 s55, 0x20000
  s_mul_i32 s21, s18, 5
  s_mul_i32 s21, s21, 32768
  s_add_u32 s24, s21, 91488256
  s_add_u32 s25, s24, 32768
  s_add_u32 s26, s25, 32768
  s_add_u32 s27, s26, 32768
  s_add_u32 s28, s27, 32768
  s_lshl_b32 s21, s17, 2
  s_add_u32 s21, s21, s16
  s_mul_i32 s22, s21, 32768
  s_add_u32 s22, s22, 50331648
  s_lshl_b32 s23, s16, 10
  v_add_u32 v2, s23, v1
  s_mul_i32 s29, s16, 5120
  s_add_u32 m0, s29, 0
  s_nop 0
  buffer_load_dwordx4 v2, s[4:7], s24 offen lds
  s_add_u32 m0, s29, 1024
  s_nop 0
  buffer_load_dwordx4 v2, s[4:7], s25 offen lds
  s_add_u32 m0, s29, 2048
  s_nop 0
  buffer_load_dwordx4 v2, s[4:7], s26 offen lds
  s_add_u32 m0, s29, 3072
  s_nop 0
  buffer_load_dwordx4 v2, s[4:7], s27 offen lds
  s_add_u32 m0, s29, 4096
  s_nop 0
  buffer_load_dwordx4 v2, s[4:7], s28 offen lds
  buffer_load_dwordx4 v[32:35], v1, s[4:7], s22 offen offset:0
  buffer_load_dwordx4 v[36:39], v1, s[4:7], s22 offen offset:1024
  buffer_load_dwordx4 v[40:43], v1, s[4:7], s22 offen offset:2048
  buffer_load_dwordx4 v[44:47], v1, s[4:7], s22 offen offset:3072
  v_add_u32 v2, 0x1000, v2
  s_add_u32 s22, s22, 4096
  s_add_u32 m0, s29, 20480
  s_nop 0
  buffer_load_dwordx4 v2, s[4:7], s24 offen lds
  s_add_u32 m0, s29, 21504
  s_nop 0
  buffer_load_dwordx4 v2, s[4:7], s25 offen lds
  s_add_u32 m0, s29, 22528
  s_nop 0
  buffer_load_dwordx4 v2, s[4:7], s26 offen lds
  s_add_u32 m0, s29, 23552
  s_nop 0
  buffer_load_dwordx4 v2, s[4:7], s27 offen lds
  s_add_u32 m0, s29, 24576
  s_nop 0
  buffer_load_dwordx4 v2, s[4:7], s28 offen lds
  buffer_load_dwordx4 v[48:51], v1, s[4:7], s22 offen offset:0
  buffer_load_dwordx4 v[52:55], v1, s[4:7], s22 offen offset:1024
  buffer_load_dwordx4 v[56:59], v1, s[4:7], s22 offen offset:2048
  buffer_load_dwordx4 v[60:63], v1, s[4:7], s22 offen offset:3072
  v_add_u32 v2, 0x1000, v2
  s_add_u32 s22, s22, 4096
  s_waitcnt vmcnt(9)
  s_barrier
  s_add_u32 m0, s29, 40960
  s_nop 0
  buffer_load_dwordx4 v2, s[4:7], s24 offen lds
  s_add_u32 m0, s29, 41984
  s_nop 0
  buffer_load_dwordx4 v2, s[4:7], s25 offen lds
  s_add_u32 m0, s29, 43008
  s_nop 0
  buffer_load_dwordx4 v2, s[4:7], s26 offen lds
  s_add_u32 m0, s29, 44032
  s_nop 0
  buffer_load_dwordx4 v2, s[4:7], s27 offen lds
  s_add_u32 m0, s29, 45056
  s_nop 0
  buffer_load_dwordx4 v2, s[4:7], s28 offen lds
  buffer_load_dwordx4 v[64:67], v1, s[4:7], s22 offen offset:0
  buffer_load_dwordx4 v[68:71], v1, s[4:7], s22 offen offset:1024
  buffer_load_dwordx4 v[72:75], v1, s[4:7], s22 offen offset:2048
  buffer_load_dwordx4 v[76:79], v1, s[4:7], s22 offen offset:3072
  v_add_u32 v2, 0x1000, v2
  s_add_u32 s22, s22, 4096
  ds_read_b128 v[80:83], v1 offset:0
  ds_read_b128 v[84:87], v1 offset:1024
  ds_read_b128 v[88:91], v1 offset:2048
  ds_read_b128 v[92:95], v1 offset:3072
  ds_read_b128 v[96:99], v1 offset:4096
  ds_read_b128 v[100:103], v1 offset:5120
  ds_read_b128 v[104:107], v1 offset:6144
  ds_read_b128 v[108:111], v1 offset:7168
  ds_read_b128 v[112:115], v1 offset:8192
  ds_read_b128 v[116:119], v1 offset:9216
  s_waitcnt lgkmcnt(5)
  v_mfma_f32_16x16x32_bf16 v[8:11], v[80:83], v[32:35], 0
  v_mfma_f32_16x16x32_bf16 v[12:15], v[84:87], v[32:35], 0
  v_mfma_f32_16x16x32_bf16 v[16:19], v[88:91], v[32:35], 0
  v_mfma_f32_16x16x32_bf16 v[20:23], v[92:95], v[32:35], 0
  v_mfma_f32_16x16x32_bf16 v[24:27], v[96:99], v[32:35], 0
  ds_read_b128 v[80:83], v1 offset:10240
  ds_read_b128 v[84:87], v1 offset:11264
  ds_read_b128 v[88:91], v1 offset:12288
  ds_read_b128 v[92:95], v1 offset:13312
  ds_read_b128 v[96:99], v1 offset:14336
  s_waitcnt lgkmcnt(5)
  v_mfma_f32_16x16x32_bf16 v[8:11], v[100:103], v[36:39], v[8:11]
  v_mfma_f32_16x16x32_bf16 v[12:15], v[104:107], v[36:39], v[12:15]
  v_mfma_f32_16x16x32_bf16 v[16:19], v[108:111], v[36:39], v[16:19]
  v_mfma_f32_16x16x32_bf16 v[20:23], v[112:115], v[36:39], v[20:23]
  v_mfma_f32_16x16x32_bf16 v[24:27], v[116:119], v[36:39], v[24:27]
  ds_read_b128 v[100:103], v1 offset:15360
  ds_read_b128 v[104:107], v1 offset:16384
  ds_read_b128 v[108:111], v1 offset:17408
  ds_read_b128 v[112:115], v1 offset:18432
  ds_read_b128 v[116:119], v1 offset:19456
  s_waitcnt lgkmcnt(5)
  v_mfma_f32_16x16x32_bf16 v[8:11], v[80:83], v[40:43], v[8:11]
  v_mfma_f32_16x16x32_bf16 v[12:15], v[84:87], v[40:43], v[12:15]
  v_mfma_f32_16x16x32_bf16 v[16:19], v[88:91], v[40:43], v[16:19]
  v_mfma_f32_16x16x32_bf16 v[20:23], v[92:95], v[40:43], v[20:23]
  v_mfma_f32_16x16x32_bf16 v[24:27], v[96:99], v[40:43], v[24:27]
  s_waitcnt lgkmcnt(0)
  v_mfma_f32_16x16x32_bf16 v[8:11], v[100:103], v[44:47], v[8:11]
  v_mfma_f32_16x16x32_bf16 v[12:15], v[104:107], v[44:47], v[12:15]
  v_mfma_f32_16x16x32_bf16 v[16:19], v[108:111], v[44:47], v[16:19]
  v_mfma_f32_16x16x32_bf16 v[20:23], v[112:115], v[44:47], v[20:23]
  v_mfma_f32_16x16x32_bf16 v[24:27], v[116:119], v[44:47], v[24:27]
  s_mov_b32 s30, 0
outb1_loop2:
  s_waitcnt vmcnt(9)
  s_barrier
  s_add_u32 m0, s29, 0
  s_nop 0
  buffer_load_dwordx4 v2, s[4:7], s24 offen lds
  s_add_u32 m0, s29, 1024
  s_nop 0
  buffer_load_dwordx4 v2, s[4:7], s25 offen lds
  s_add_u32 m0, s29, 2048
  s_nop 0
  buffer_load_dwordx4 v2, s[4:7], s26 offen lds
  s_add_u32 m0, s29, 3072
  s_nop 0
  buffer_load_dwordx4 v2, s[4:7], s27 offen lds
  s_add_u32 m0, s29, 4096
  s_nop 0
  buffer_load_dwordx4 v2, s[4:7], s28 offen lds
  buffer_load_dwordx4 v[32:35], v1, s[4:7], s22 offen offset:0
  buffer_load_dwordx4 v[36:39], v1, s[4:7], s22 offen offset:1024
  buffer_load_dwordx4 v[40:43], v1, s[4:7], s22 offen offset:2048
  buffer_load_dwordx4 v[44:47], v1, s[4:7], s22 offen offset:3072
  v_add_u32 v2, 0x1000, v2
  s_add_u32 s22, s22, 4096
  ds_read_b128 v[80:83], v1 offset:20480
  ds_read_b128 v[84:87], v1 offset:21504
  ds_read_b128 v[88:91], v1 offset:22528
  ds_read_b128 v[92:95], v1 offset:23552
  ds_read_b128 v[96:99], v1 offset:24576
  ds_read_b128 v[100:103], v1 offset:25600
  ds_read_b128 v[104:107], v1 offset:26624
  ds_read_b128 v[108:111], v1 offset:27648
  ds_read_b128 v[112:115], v1 offset:28672
  ds_read_b128 v[116:119], v1 offset:29696
  s_waitcnt lgkmcnt(5)
  v_mfma_f32_16x16x32_bf16 v[8:11], v[80:83], v[48:51], v[8:11]
  v_mfma_f32_16x16x32_bf16 v[12:15], v[84:87], v[48:51], v[12:15]
  v_mfma_f32_16x16x32_bf16 v[16:19], v[88:91], v[48:51], v[16:19]
  v_mfma_f32_16x16x32_bf16 v[20:23], v[92:95], v[48:51], v[20:23]
  v_mfma_f32_16x16x32_bf16 v[24:27], v[96:99], v[48:51], v[24:27]
  ds_read_b128 v[80:83], v1 offset:30720
  ds_read_b128 v[84:87], v1 offset:31744
  ds_read_b128 v[88:91], v1 offset:32768
  ds_read_b128 v[92:95], v1 offset:33792
  ds_read_b128 v[96:99], v1 offset:34816
  s_waitcnt lgkmcnt(5)
  v_mfma_f32_16x16x32_bf16 v[8:11], v[100:103], v[52:55], v[8:11]
  v_mfma_f32_16x16x32_bf16 v[12:15], v[104:107], v[52:55], v[12:15]
  v_mfma_f32_16x16x32_bf16 v[16:19], v[108:111], v[52:55], v[16:19]
  v_mfma_f32_16x16x32_bf16 v[20:23], v[112:115], v[52:55], v[20:23]
  v_mfma_f32_16x16x32_bf16 v[24:27], v[116:119], v[52:55], v[24:27]
  ds_read_b128 v[100:103], v1 offset:35840
  ds_read_b128 v[104:107], v1 offset:36864
  ds_read_b128 v[108:111], v1 offset:37888
  ds_read_b128 v[112:115], v1 offset:38912
  ds_read_b128 v[116:119], v1 offset:39936
  s_waitcnt lgkmcnt(5)
  v_mfma_f32_16x16x32_bf16 v[8:11], v[80:83], v[56:59], v[8:11]
  v_mfma_f32_16x16x32_bf16 v[12:15], v[84:87], v[56:59], v[12:15]
  v_mfma_f32_16x16x32_bf16 v[16:19], v[88:91], v[56:59], v[16:19]
  v_mfma_f32_16x16x32_bf16 v[20:23], v[92:95], v[56:59], v[20:23]
  v_mfma_f32_16x16x32_bf16 v[24:27], v[96:99], v[56:59], v[24:27]
  s_waitcnt lgkmcnt(0)
  v_mfma_f32_16x16x32_bf16 v[8:11], v[100:103], v[60:63], v[8:11]
  v_mfma_f32_16x16x32_bf16 v[12:15], v[104:107], v[60:63], v[12:15]
  v_mfma_f32_16x16x32_bf16 v[16:19], v[108:111], v[60:63], v[16:19]
  v_mfma_f32_16x16x32_bf16 v[20:23], v[112:115], v[60:63], v[20:23]
  v_mfma_f32_16x16x32_bf16 v[24:27], v[116:119], v[60:63], v[24:27]
  s_waitcnt vmcnt(9)
  s_barrier
  s_add_u32 m0, s29, 20480
  s_nop 0
  buffer_load_dwordx4 v2, s[4:7], s24 offen lds
  s_add_u32 m0, s29, 21504
  s_nop 0
  buffer_load_dwordx4 v2, s[4:7], s25 offen lds
  s_add_u32 m0, s29, 22528
  s_nop 0
  buffer_load_dwordx4 v2, s[4:7], s26 offen lds
  s_add_u32 m0, s29, 23552
  s_nop 0
  buffer_load_dwordx4 v2, s[4:7], s27 offen lds
  s_add_u32 m0, s29, 24576
  s_nop 0
  buffer_load_dwordx4 v2, s[4:7], s28 offen lds
  buffer_load_dwordx4 v[48:51], v1, s[4:7], s22 offen offset:0
  buffer_load_dwordx4 v[52:55], v1, s[4:7], s22 offen offset:1024
  buffer_load_dwordx4 v[56:59], v1, s[4:7], s22 offen offset:2048
  buffer_load_dwordx4 v[60:63], v1, s[4:7], s22 offen offset:3072
  v_add_u32 v2, 0x1000, v2
  s_add_u32 s22, s22, 4096
  ds_read_b128 v[80:83], v1 offset:40960
  ds_read_b128 v[84:87], v1 offset:41984
  ds_read_b128 v[88:91], v1 offset:43008
  ds_read_b128 v[92:95], v1 offset:44032
  ds_read_b128 v[96:99], v1 offset:45056
  ds_read_b128 v[100:103], v1 offset:46080
  ds_read_b128 v[104:107], v1 offset:47104
  ds_read_b128 v[108:111], v1 offset:48128
  ds_read_b128 v[112:115], v1 offset:49152
  ds_read_b128 v[116:119], v1 offset:50176
  s_waitcnt lgkmcnt(5)
  v_mfma_f32_16x16x32_bf16 v[8:11], v[80:83], v[64:67], v[8:11]
  v_mfma_f32_16x16x32_bf16 v[12:15], v[84:87], v[64:67], v[12:15]
  v_mfma_f32_16x16x32_bf16 v[16:19], v[88:91], v[64:67], v[16:19]
  v_mfma_f32_16x16x32_bf16 v[20:23], v[92:95], v[64:67], v[20:23]
  v_mfma_f32_16x16x32_bf16 v[24:27], v[96:99], v[64:67], v[24:27]
  ds_read_b128 v[80:83], v1 offset:51200
  ds_read_b128 v[84:87], v1 offset:52224
  ds_read_b128 v[88:91], v1 offset:53248
  ds_read_b128 v[92:95], v1 offset:54272
  ds_read_b128 v[96:99], v1 offset:55296
  s_waitcnt lgkmcnt(5)
  v_mfma_f32_16x16x32_bf16 v[8:11], v[100:103], v[68:71], v[8:11]
  v_mfma_f32_16x16x32_bf16 v[12:15], v[104:107], v[68:71], v[12:15]
  v_mfma_f32_16x16x32_bf16 v[16:19], v[108:111], v[68:71], v[16:19]
  v_mfma_f32_16x16x32_bf16 v[20:23], v[112:115], v[68:71], v[20:23]
  v_mfma_f32_16x16x32_bf16 v[24:27], v[116:119], v[68:71], v[24:27]
  ds_read_b128 v[100:103], v1 offset:56320
  ds_read_b128 v[104:107], v1 offset:57344
  ds_read_b128 v[108:111], v1 offset:58368
  ds_read_b128 v[112:115], v1 offset:59392
  ds_read_b128 v[116:119], v1 offset:60416
  s_waitcnt lgkmcnt(5)
  v_mfma_f32_16x16x32_bf16 v[8:11], v[80:83], v[72:75], v[8:11]
  v_mfma_f32_16x16x32_bf16 v[12:15], v[84:87], v[72:75], v[12:15]
  v_mfma_f32_16x16x32_bf16 v[16:19], v[88:91], v[72:75], v[16:19]
  v_mfma_f32_16x16x32_bf16 v[20:23], v[92:95], v[72:75], v[20:23]
  v_mfma_f32_16x16x32_bf16 v[24:27], v[96:99], v[72:75], v[24:27]
  s_waitcnt lgkmcnt(0)
  v_mfma_f32_16x16x32_bf16 v[8:11], v[100:103], v[76:79], v[8:11]
  v_mfma_f32_16x16x32_bf16 v[12:15], v[104:107], v[76:79], v[12:15]
  v_mfma_f32_16x16x32_bf16 v[16:19], v[108:111], v[76:79], v[16:19]
  v_mfma_f32_16x16x32_bf16 v[20:23], v[112:115], v[76:79], v[20:23]
  v_mfma_f32_16x16x32_bf16 v[24:27], v[116:119], v[76:79], v[24:27]
  s_waitcnt vmcnt(9)
  s_barrier
  s_add_u32 m0, s29, 40960
  s_nop 0
  buffer_load_dwordx4 v2, s[4:7], s24 offen lds
  s_add_u32 m0, s29, 41984
  s_nop 0
  buffer_load_dwordx4 v2, s[4:7], s25 offen lds
  s_add_u32 m0, s29, 43008
  s_nop 0
  buffer_load_dwordx4 v2, s[4:7], s26 offen lds
  s_add_u32 m0, s29, 44032
  s_nop 0
  buffer_load_dwordx4 v2, s[4:7], s27 offen lds
  s_add_u32 m0, s29, 45056
  s_nop 0
  buffer_load_dwordx4 v2, s[4:7], s28 offen lds
  buffer_load_dwordx4 v[64:67], v1, s[4:7], s22 offen offset:0
  buffer_load_dwordx4 v[68:71], v1, s[4:7], s22 offen offset:1024
  buffer_load_dwordx4 v[72:75], v1, s[4:7], s22 offen offset:2048
  buffer_load_dwordx4 v[76:79], v1, s[4:7], s22 offen offset:3072
  v_add_u32 v2, 0x1000, v2
  s_add_u32 s22, s22, 4096
  ds_read_b128 v[80:83], v1 offset:0
  ds_read_b128 v[84:87], v1 offset:1024
  ds_read_b128 v[88:91], v1 offset:2048
  ds_read_b128 v[92:95], v1 offset:3072
  ds_read_b128 v[96:99], v1 offset:4096
  ds_read_b128 v[100:103], v1 offset:5120
  ds_read_b128 v[104:107], v1 offset:6144
  ds_read_b128 v[108:111], v1 offset:7168
  ds_read_b128 v[112:115], v1 offset:8192
  ds_read_b128 v[116:119], v1 offset:9216
  s_waitcnt lgkmcnt(5)
  v_mfma_f32_16x16x32_bf16 v[8:11], v[80:83], v[32:35], v[8:11]
  v_mfma_f32_16x16x32_bf16 v[12:15], v[84:87], v[32:35], v[12:15]
  v_mfma_f32_16x16x32_bf16 v[16:19], v[88:91], v[32:35], v[16:19]
  v_mfma_f32_16x16x32_bf16 v[20:23], v[92:95], v[32:35], v[20:23]
  v_mfma_f32_16x16x32_bf16 v[24:27], v[96:99], v[32:35], v[24:27]
  ds_read_b128 v[80:83], v1 offset:10240
  ds_read_b128 v[84:87], v1 offset:11264
  ds_read_b128 v[88:91], v1 offset:12288
  ds_read_b128 v[92:95], v1 offset:13312
  ds_read_b128 v[96:99], v1 offset:14336
  s_waitcnt lgkmcnt(5)
  v_mfma_f32_16x16x32_bf16 v[8:11], v[100:103], v[36:39], v[8:11]
  v_mfma_f32_16x16x32_bf16 v[12:15], v[104:107], v[36:39], v[12:15]
  v_mfma_f32_16x16x32_bf16 v[16:19], v[108:111], v[36:39], v[16:19]
  v_mfma_f32_16x16x32_bf16 v[20:23], v[112:115], v[36:39], v[20:23]
  v_mfma_f32_16x16x32_bf16 v[24:27], v[116:119], v[36:39], v[24:27]
  ds_read_b128 v[100:103], v1 offset:15360
  ds_read_b128 v[104:107], v1 offset:16384
  ds_read_b128 v[108:111], v1 offset:17408
  ds_read_b128 v[112:115], v1 offset:18432
  ds_read_b128 v[116:119], v1 offset:19456
  s_waitcnt lgkmcnt(5)
  v_mfma_f32_16x16x32_bf16 v[8:11], v[80:83], v[40:43], v[8:11]
  v_mfma_f32_16x16x32_bf16 v[12:15], v[84:87], v[40:43], v[12:15]
  v_mfma_f32_16x16x32_bf16 v[16:19], v[88:91], v[40:43], v[16:19]
  v_mfma_f32_16x16x32_bf16 v[20:23], v[92:95], v[40:43], v[20:23]
  v_mfma_f32_16x16x32_bf16 v[24:27], v[96:99], v[40:43], v[24:27]
  s_waitcnt lgkmcnt(0)
  v_mfma_f32_16x16x32_bf16 v[8:11], v[100:103], v[44:47], v[8:11]
  v_mfma_f32_16x16x32_bf16 v[12:15], v[104:107], v[44:47], v[12:15]
  v_mfma_f32_16x16x32_bf16 v[16:19], v[108:111], v[44:47], v[16:19]
  v_mfma_f32_16x16x32_bf16 v[20:23], v[112:115], v[44:47], v[20:23]
  v_mfma_f32_16x16x32_bf16 v[24:27], v[116:119], v[44:47], v[24:27]
  s_add_u32 s30, s30, 1
  s_cmp_lt_u32 s30, 1
  s_cbranch_scc1 outb1_loop2
  s_waitcnt vmcnt(9)
  s_barrier
  s_add_u32 m0, s29, 0
  s_nop 0
  buffer_load_dwordx4 v2, s[4:7], s24 offen lds
  s_add_u32 m0, s29, 1024
  s_nop 0
  buffer_load_dwordx4 v2, s[4:7], s25 offen lds
  s_add_u32 m0, s29, 2048
  s_nop 0
  buffer_load_dwordx4 v2, s[4:7], s26 offen lds
  s_add_u32 m0, s29, 3072
  s_nop 0
  buffer_load_dwordx4 v2, s[4:7], s27 offen lds
  s_add_u32 m0, s29, 4096
  s_nop 0
  buffer_load_dwordx4 v2, s[4:7], s28 offen lds
  buffer_load_dwordx4 v[32:35], v1, s[4:7], s22 offen offset:0
  buffer_load_dwordx4 v[36:39], v1, s[4:7], s22 offen offset:1024
  buffer_load_dwordx4 v[40:43], v1, s[4:7], s22 offen offset:2048
  buffer_load_dwordx4 v[44:47], v1, s[4:7], s22 offen offset:3072
  v_add_u32 v2, 0x1000, v2
  s_add_u32 s22, s22, 4096
  ds_read_b128 v[80:83], v1 offset:20480
  ds_read_b128 v[84:87], v1 offset:21504
  ds_read_b128 v[88:91], v1 offset:22528
  ds_read_b128 v[92:95], v1 offset:23552
  ds_read_b128 v[96:99], v1 offset:24576
  ds_read_b128 v[100:103], v1 offset:25600
  ds_read_b128 v[104:107], v1 offset:26624
  ds_read_b128 v[108:111], v1 offset:27648
  ds_read_b128 v[112:115], v1 offset:28672
  ds_read_b128 v[116:119], v1 offset:29696
  s_waitcnt lgkmcnt(5)
  v_mfma_f32_16x16x32_bf16 v[8:11], v[80:83], v[48:51], v[8:11]
  v_mfma_f32_16x16x32_bf16 v[12:15], v[84:87], v[48:51], v[12:15]
  v_mfma_f32_16x16x32_bf16 v[16:19], v[88:91], v[48:51], v[16:19]
  v_mfma_f32_16x16x32_bf16 v[20:23], v[92:95], v[48:51], v[20:23]
  v_mfma_f32_16x16x32_bf16 v[24:27], v[96:99], v[48:51], v[24:27]
  ds_read_b128 v[80:83], v1 offset:30720
  ds_read_b128 v[84:87], v1 offset:31744
  ds_read_b128 v[88:91], v1 offset:32768
  ds_read_b128 v[92:95], v1 offset:33792
  ds_read_b128 v[96:99], v1 offset:34816
  s_waitcnt lgkmcnt(5)
  v_mfma_f32_16x16x32_bf16 v[8:11], v[100:103], v[52:55], v[8:11]
  v_mfma_f32_16x16x32_bf16 v[12:15], v[104:107], v[52:55], v[12:15]
  v_mfma_f32_16x16x32_bf16 v[16:19], v[108:111], v[52:55], v[16:19]
  v_mfma_f32_16x16x32_bf16 v[20:23], v[112:115], v[52:55], v[20:23]
  v_mfma_f32_16x16x32_bf16 v[24:27], v[116:119], v[52:55], v[24:27]
  ds_read_b128 v[100:103], v1 offset:35840
  ds_read_b128 v[104:107], v1 offset:36864
  ds_read_b128 v[108:111], v1 offset:37888
  ds_read_b128 v[112:115], v1 offset:38912
  ds_read_b128 v[116:119], v1 offset:39936
  s_waitcnt lgkmcnt(5)
  v_mfma_f32_16x16x32_bf16 v[8:11], v[80:83], v[56:59], v[8:11]
  v_mfma_f32_16x16x32_bf16 v[12:15], v[84:87], v[56:59], v[12:15]
  v_mfma_f32_16x16x32_bf16 v[16:19], v[88:91], v[56:59], v[16:19]
  v_mfma_f32_16x16x32_bf16 v[20:23], v[92:95], v[56:59], v[20:23]
  v_mfma_f32_16x16x32_bf16 v[24:27], v[96:99], v[56:59], v[24:27]
  s_waitcnt lgkmcnt(0)
  v_mfma_f32_16x16x32_bf16 v[8:11], v[100:103], v[60:63], v[8:11]
  v_mfma_f32_16x16x32_bf16 v[12:15], v[104:107], v[60:63], v[12:15]
  v_mfma_f32_16x16x32_bf16 v[16:19], v[108:111], v[60:63], v[16:19]
  v_mfma_f32_16x16x32_bf16 v[20:23], v[112:115], v[60:63], v[20:23]
  v_mfma_f32_16x16x32_bf16 v[24:27], v[116:119], v[60:63], v[24:27]
  s_waitcnt vmcnt(9)
  s_barrier
  s_add_u32 m0, s29, 20480
  s_nop 0
  buffer_load_dwordx4 v2, s[4:7], s24 offen lds
  s_add_u32 m0, s29, 21504
  s_nop 0
  buffer_load_dwordx4 v2, s[4:7], s25 offen lds
  s_add_u32 m0, s29, 22528
  s_nop 0
  buffer_load_dwordx4 v2, s[4:7], s26 offen lds
  s_add_u32 m0, s29, 23552
  s_nop 0
  buffer_load_dwordx4 v2, s[4:7], s27 offen lds
  s_add_u32 m0, s29, 24576
  s_nop 0
  buffer_load_dwordx4 v2, s[4:7], s28 offen lds
  buffer_load_dwordx4 v[48:51], v1, s[4:7], s22 offen offset:0
  buffer_load_dwordx4 v[52:55], v1, s[4:7], s22 offen offset:1024
  buffer_load_dwordx4 v[56:59], v1, s[4:7], s22 offen offset:2048
  buffer_load_dwordx4 v[60:63], v1, s[4:7], s22 offen offset:3072
  v_add_u32 v2, 0x1000, v2
  s_add_u32 s22, s22, 4096
  ds_read_b128 v[80:83], v1 offset:40960
  ds_read_b128 v[84:87], v1 offset:41984
  ds_read_b128 v[88:91], v1 offset:43008
  ds_read_b128 v[92:95], v1 offset:44032
  ds_read_b128 v[96:99], v1 offset:45056
  ds_read_b128 v[100:103], v1 offset:46080
  ds_read_b128 v[104:107], v1 offset:47104
  ds_read_b128 v[108:111], v1 offset:48128
  ds_read_b128 v[112:115], v1 offset:49152
  ds_read_b128 v[116:119], v1 offset:50176
  s_waitcnt lgkmcnt(5)
  v_mfma_f32_16x16x32_bf16 v[8:11], v[80:83], v[64:67], v[8:11]
  v_mfma_f32_16x16x32_bf16 v[12:15], v[84:87], v[64:67], v[12:15]
  v_mfma_f32_16x16x32_bf16 v[16:19], v[88:91], v[64:67], v[16:19]
  v_mfma_f32_16x16x32_bf16 v[20:23], v[92:95], v[64:67], v[20:23]
  v_mfma_f32_16x16x32_bf16 v[24:27], v[96:99], v[64:67], v[24:27]
  ds_read_b128 v[80:83], v1 offset:51200
  ds_read_b128 v[84:87], v1 offset:52224
  ds_read_b128 v[88:91], v1 offset:53248
  ds_read_b128 v[92:95], v1 offset:54272
  ds_read_b128 v[96:99], v1 offset:55296
  s_waitcnt lgkmcnt(5)
  v_mfma_f32_16x16x32_bf16 v[8:11], v[100:103], v[68:71], v[8:11]
  v_mfma_f32_16x16x32_bf16 v[12:15], v[104:107], v[68:71], v[12:15]
  v_mfma_f32_16x16x32_bf16 v[16:19], v[108:111], v[68:71], v[16:19]
  v_mfma_f32_16x16x32_bf16 v[20:23], v[112:115], v[68:71], v[20:23]
  v_mfma_f32_16x16x32_bf16 v[24:27], v[116:119], v[68:71], v[24:27]
  ds_read_b128 v[100:103], v1 offset:56320
  ds_read_b128 v[104:107], v1 offset:57344
  ds_read_b128 v[108:111], v1 offset:58368
  ds_read_b128 v[112:115], v1 offset:59392
  ds_read_b128 v[116:119], v1 offset:60416
  s_waitcnt lgkmcnt(5)
  v_mfma_f32_16x16x32_bf16 v[8:11], v[80:83], v[72:75], v[8:11]
  v_mfma_f32_16x16x32_bf16 v[12:15], v[84:87], v[72:75], v[12:15]
  v_mfma_f32_16x16x32_bf16 v[16:19], v[88:91], v[72:75], v[16:19]
  v_mfma_f32_16x16x32_bf16 v[20:23], v[92:95], v[72:75], v[20:23]
  v_mfma_f32_16x16x32_bf16 v[24:27], v[96:99], v[72:75], v[24:27]
  s_waitcnt lgkmcnt(0)
  v_mfma_f32_16x16x32_bf16 v[8:11], v[100:103], v[76:79], v[8:11]
  v_mfma_f32_16x16x32_bf16 v[12:15], v[104:107], v[76:79], v[12:15]
  v_mfma_f32_16x16x32_bf16 v[16:19], v[108:111], v[76:79], v[16:19]
  v_mfma_f32_16x16x32_bf16 v[20:23], v[112:115], v[76:79], v[20:23]
  v_mfma_f32_16x16x32_bf16 v[24:27], v[116:119], v[76:79], v[24:27]
  s_waitcnt vmcnt(9)
  s_barrier
  ds_read_b128 v[80:83], v1 offset:0
  ds_read_b128 v[84:87], v1 offset:1024
  ds_read_b128 v[88:91], v1 offset:2048
  ds_read_b128 v[92:95], v1 offset:3072
  ds_read_b128 v[96:99], v1 offset:4096
  ds_read_b128 v[100:103], v1 offset:5120
  ds_read_b128 v[104:107], v1 offset:6144
  ds_read_b128 v[108:111], v1 offset:7168
  ds_read_b128 v[112:115], v1 offset:8192
  ds_read_b128 v[116:119], v1 offset:9216
  s_waitcnt lgkmcnt(5)
  v_mfma_f32_16x16x32_bf16 v[8:11], v[80:83], v[32:35], v[8:11]
  v_mfma_f32_16x16x32_bf16 v[12:15], v[84:87], v[32:35], v[12:15]
  v_mfma_f32_16x16x32_bf16 v[16:19], v[88:91], v[32:35], v[16:19]
  v_mfma_f32_16x16x32_bf16 v[20:23], v[92:95], v[32:35], v[20:23]
  v_mfma_f32_16x16x32_bf16 v[24:27], v[96:99], v[32:35], v[24:27]
  ds_read_b128 v[80:83], v1 offset:10240
  ds_read_b128 v[84:87], v1 offset:11264
  ds_read_b128 v[88:91], v1 offset:12288
  ds_read_b128 v[92:95], v1 offset:13312
  ds_read_b128 v[96:99], v1 offset:14336
  s_waitcnt lgkmcnt(5)
  v_mfma_f32_16x16x32_bf16 v[8:11], v[100:103], v[36:39], v[8:11]
  v_mfma_f32_16x16x32_bf16 v[12:15], v[104:107], v[36:39], v[12:15]
  v_mfma_f32_16x16x32_bf16 v[16:19], v[108:111], v[36:39], v[16:19]
  v_mfma_f32_16x16x32_bf16 v[20:23], v[112:115], v[36:39], v[20:23]
  v_mfma_f32_16x16x32_bf16 v[24:27], v[116:119], v[36:39], v[24:27]
  ds_read_b128 v[100:103], v1 offset:15360
  ds_read_b128 v[104:107], v1 offset:16384
  ds_read_b128 v[108:111], v1 offset:17408
  ds_read_b128 v[112:115], v1 offset:18432
  ds_read_b128 v[116:119], v1 offset:19456
  s_waitcnt lgkmcnt(5)
  v_mfma_f32_16x16x32_bf16 v[8:11], v[80:83], v[40:43], v[8:11]
  v_mfma_f32_16x16x32_bf16 v[12:15], v[84:87], v[40:43], v[12:15]
  v_mfma_f32_16x16x32_bf16 v[16:19], v[88:91], v[40:43], v[16:19]
  v_mfma_f32_16x16x32_bf16 v[20:23], v[92:95], v[40:43], v[20:23]
  v_mfma_f32_16x16x32_bf16 v[24:27], v[96:99], v[40:43], v[24:27]
  s_waitcnt lgkmcnt(0)
  v_mfma_f32_16x16x32_bf16 v[8:11], v[100:103], v[44:47], v[8:11]
  v_mfma_f32_16x16x32_bf16 v[12:15], v[104:107], v[44:47], v[12:15]
  v_mfma_f32_16x16x32_bf16 v[16:19], v[108:111], v[44:47], v[16:19]
  v_mfma_f32_16x16x32_bf16 v[20:23], v[112:115], v[44:47], v[20:23]
  v_mfma_f32_16x16x32_bf16 v[24:27], v[116:119], v[44:47], v[24:27]
  s_waitcnt vmcnt(0)
  s_barrier
  ds_read_b128 v[80:83], v1 offset:20480
  ds_read_b128 v[84:87], v1 offset:21504
  ds_read_b128 v[88:91], v1 offset:22528
  ds_read_b128 v[92:95], v1 offset:23552
  ds_read_b128 v[96:99], v1 offset:24576
  ds_read_b128 v[100:103], v1 offset:25600
  ds_read_b128 v[104:107], v1 offset:26624
  ds_read_b128 v[108:111], v1 offset:27648
  ds_read_b128 v[112:115], v1 offset:28672
  ds_read_b128 v[116:119], v1 offset:29696
  s_waitcnt lgkmcnt(5)
  v_mfma_f32_16x16x32_bf16 v[8:11], v[80:83], v[48:51], v[8:11]
  v_mfma_f32_16x16x32_bf16 v[12:15], v[84:87], v[48:51], v[12:15]
  v_mfma_f32_16x16x32_bf16 v[16:19], v[88:91], v[48:51], v[16:19]
  v_mfma_f32_16x16x32_bf16 v[20:23], v[92:95], v[48:51], v[20:23]
  v_mfma_f32_16x16x32_bf16 v[24:27], v[96:99], v[48:51], v[24:27]
  ds_read_b128 v[80:83], v1 offset:30720
  ds_read_b128 v[84:87], v1 offset:31744
  ds_read_b128 v[88:91], v1 offset:32768
  ds_read_b128 v[92:95], v1 offset:33792
  ds_read_b128 v[96:99], v1 offset:34816
  s_waitcnt lgkmcnt(5)
  v_mfma_f32_16x16x32_bf16 v[8:11], v[100:103], v[52:55], v[8:11]
  v_mfma_f32_16x16x32_bf16 v[12:15], v[104:107], v[52:55], v[12:15]
  v_mfma_f32_16x16x32_bf16 v[16:19], v[108:111], v[52:55], v[16:19]
  v_mfma_f32_16x16x32_bf16 v[20:23], v[112:115], v[52:55], v[20:23]
  v_mfma_f32_16x16x32_bf16 v[24:27], v[116:119], v[52:55], v[24:27]
  ds_read_b128 v[100:103], v1 offset:35840
  ds_read_b128 v[104:107], v1 offset:36864
  ds_read_b128 v[108:111], v1 offset:37888
  ds_read_b128 v[112:115], v1 offset:38912
  ds_read_b128 v[116:119], v1 offset:39936
  s_waitcnt lgkmcnt(5)
  v_mfma_f32_16x16x32_bf16 v[8:11], v[80:83], v[56:59], v[8:11]
  v_mfma_f32_16x16x32_bf16 v[12:15], v[84:87], v[56:59], v[12:15]
  v_mfma_f32_16x16x32_bf16 v[16:19], v[88:91], v[56:59], v[16:19]
  v_mfma_f32_16x16x32_bf16 v[20:23], v[92:95], v[56:59], v[20:23]
  v_mfma_f32_16x16x32_bf16 v[24:27], v[96:99], v[56:59], v[24:27]
  s_waitcnt lgkmcnt(0)
  v_mfma_f32_16x16x32_bf16 v[8:11], v[100:103], v[60:63], v[8:11]
  v_mfma_f32_16x16x32_bf16 v[12:15], v[104:107], v[60:63], v[12:15]
  v_mfma_f32_16x16x32_bf16 v[16:19], v[108:111], v[60:63], v[16:19]
  v_mfma_f32_16x16x32_bf16 v[20:23], v[112:115], v[60:63], v[20:23]
  v_mfma_f32_16x16x32_bf16 v[24:27], v[116:119], v[60:63], v[24:27]
  v_and_b32 v3, 63, v0
  v_and_b32 v4, 15, v3
  v_lshrrev_b32 v3, 4, v3
  s_lshl_b32 s21, s17, 6
  s_lshl_b32 s23, s16, 4
  s_add_u32 s21, s21, s23
  v_add_u32 v4, s21, v4
  v_mul_u32_u24 v6, 1280, v4
  v_lshl_add_u32 v6, v3, 4, v6
  s_mul_i32 s21, s18, 5
  s_add_u32 s23, s21, 0
  s_lshr_b32 s31, s23, 1
  s_lshl_b32 s31, s31, 6
  s_and_b32 s23, s23, 1
  s_lshl_b32 s23, s23, 3
  s_add_u32 s32, s31, s23
  s_add_u32 s40, s32, s20
  buffer_load_dwordx2 v[32:33], v6, s[8:11], s40 offen
  s_add_u32 s23, s21, 1
  s_lshr_b32 s31, s23, 1
  s_lshl_b32 s31, s31, 6
  s_and_b32 s23, s23, 1
  s_lshl_b32 s23, s23, 3
  s_add_u32 s33, s31, s23
  s_add_u32 s41, s33, s20
  buffer_load_dwordx2 v[34:35], v6, s[8:11], s41 offen
  s_add_u32 s23, s21, 2
  s_lshr_b32 s31, s23, 1
  s_lshl_b32 s31, s31, 6
  s_and_b32 s23, s23, 1
  s_lshl_b32 s23, s23, 3
  s_add_u32 s34, s31, s23
  s_add_u32 s42, s34, s20
  buffer_load_dwordx2 v[36:37], v6, s[8:11], s42 offen
  s_add_u32 s23, s21, 3
  s_lshr_b32 s31, s23, 1
  s_lshl_b32 s31, s31, 6
  s_and_b32 s23, s23, 1
  s_lshl_b32 s23, s23, 3
  s_add_u32 s35, s31, s23
  s_add_u32 s43, s35, s20
  buffer_load_dwordx2 v[38:39], v6, s[8:11], s43 offen
  s_add_u32 s23, s21, 4
  s_lshr_b32 s31, s23, 1
  s_lshl_b32 s31, s31, 6
  s_and_b32 s23, s23, 1
  s_lshl_b32 s23, s23, 3
  s_add_u32 s36, s31, s23
  s_add_u32 s44, s36, s20
  buffer_load_dwordx2 v[40:41], v6, s[8:11], s44 offen
  s_waitcnt vmcnt(0)
  v_cvt_pk_bf16_f32 v80, v8, v9
  v_cvt_pk_bf16_f32 v81, v10, v11
  v_lshlrev_b32 v8, 16, v80
  v_and_b32 v9, 0xffff0000, v80
  v_lshlrev_b32 v10, 16, v81
  v_and_b32 v11, 0xffff0000, v81
  v_lshlrev_b32 v82, 16, v32
  v_and_b32 v83, 0xffff0000, v32
  v_lshlrev_b32 v84, 16, v33
  v_and_b32 v85, 0xffff0000, v33
  v_add_f32 v8, v8, v82
  v_add_f32 v9, v9, v83
  v_add_f32 v10, v10, v84
  v_add_f32 v11, v11, v85
  v_cvt_pk_bf16_f32 v32, v8, v9
  v_cvt_pk_bf16_f32 v33, v10, v11
  s_add_u32 s23, s32, 82313216
  buffer_store_dwordx2 v[32:33], v6, s[4:7], s23 offen sc1
  v_cvt_pk_bf16_f32 v80, v12, v13
  v_cvt_pk_bf16_f32 v81, v14, v15
  v_lshlrev_b32 v12, 16, v80
  v_and_b32 v13, 0xffff0000, v80
  v_lshlrev_b32 v14, 16, v81
  v_and_b32 v15, 0xffff0000, v81
  v_lshlrev_b32 v82, 16, v34
  v_and_b32 v83, 0xffff0000, v34
  v_lshlrev_b32 v84, 16, v35
  v_and_b32 v85, 0xffff0000, v35
  v_add_f32 v12, v12, v82
  v_add_f32 v13, v13, v83
  v_add_f32 v14, v14, v84
  v_add_f32 v15, v15, v85
  v_cvt_pk_bf16_f32 v34, v12, v13
  v_cvt_pk_bf16_f32 v35, v14, v15
  s_add_u32 s23, s33, 82313216
  buffer_store_dwordx2 v[34:35], v6, s[4:7], s23 offen sc1
  v_cvt_pk_bf16_f32 v80, v16, v17
  v_cvt_pk_bf16_f32 v81, v18, v19
  v_lshlrev_b32 v16, 16, v80
  v_and_b32 v17, 0xffff0000, v80
  v_lshlrev_b32 v18, 16, v81
  v_and_b32 v19, 0xffff0000, v81
  v_lshlrev_b32 v82, 16, v36
  v_and_b32 v83, 0xffff0000, v36
  v_lshlrev_b32 v84, 16, v37
  v_and_b32 v85, 0xffff0000, v37
  v_add_f32 v16, v16, v82
  v_add_f32 v17, v17, v83
  v_add_f32 v18, v18, v84
  v_add_f32 v19, v19, v85
  v_cvt_pk_bf16_f32 v36, v16, v17
  v_cvt_pk_bf16_f32 v37, v18, v19
  s_add_u32 s23, s34, 82313216
  buffer_store_dwordx2 v[36:37], v6, s[4:7], s23 offen sc1
  v_cvt_pk_bf16_f32 v80, v20, v21
  v_cvt_pk_bf16_f32 v81, v22, v23
  v_lshlrev_b32 v20, 16, v80
  v_and_b32 v21, 0xffff0000, v80
  v_lshlrev_b32 v22, 16, v81
  v_and_b32 v23, 0xffff0000, v81
  v_lshlrev_b32 v82, 16, v38
  v_and_b32 v83, 0xffff0000, v38
  v_lshlrev_b32 v84, 16, v39
  v_and_b32 v85, 0xffff0000, v39
  v_add_f32 v20, v20, v82
  v_add_f32 v21, v21, v83
  v_add_f32 v22, v22, v84
  v_add_f32 v23, v23, v85
  v_cvt_pk_bf16_f32 v38, v20, v21
  v_cvt_pk_bf16_f32 v39, v22, v23
  s_add_u32 s23, s35, 82313216
  buffer_store_dwordx2 v[38:39], v6, s[4:7], s23 offen sc1
  v_cvt_pk_bf16_f32 v80, v24, v25
  v_cvt_pk_bf16_f32 v81, v26, v27
  v_lshlrev_b32 v24, 16, v80
  v_and_b32 v25, 0xffff0000, v80
  v_lshlrev_b32 v26, 16, v81
  v_and_b32 v27, 0xffff0000, v81
  v_lshlrev_b32 v82, 16, v40
  v_and_b32 v83, 0xffff0000, v40
  v_lshlrev_b32 v84, 16, v41
  v_and_b32 v85, 0xffff0000, v41
  v_add_f32 v24, v24, v82
  v_add_f32 v25, v25, v83
  v_add_f32 v26, v26, v84
  v_add_f32 v27, v27, v85
  v_cvt_pk_bf16_f32 v40, v24, v25
  v_cvt_pk_bf16_f32 v41, v26, v27
  s_add_u32 s23, s36, 82313216
  buffer_store_dwordx2 v[40:41], v6, s[4:7], s23 offen sc1
outb1_exit1:
  s_endpgm
.globl outb2_kernel
.p2align 8
.type outb2_kernel,@function
outb2_kernel:
  s_cmp_ge_u32 s2, 256
  s_cbranch_scc1 outb2_exit1
  s_load_dwordx2 s[12:13], s[0:1], 96
  s_load_dwordx2 s[14:15], s[0:1], 0
  s_load_dwordx2 s[48:49], s[0:1], 80
  v_lshrrev_b32 v3, 6, v0
  v_and_b32 v4, 63, v0
  s_nop 0
  v_readfirstlane_b32 s16, v3
  v_lshlrev_b32 v1, 4, v4
  s_and_b32 s17, s2, 7
  s_lshl_b32 s17, s17, 2
  s_lshr_b32 s18, s2, 3
  s_and_b32 s19, s18, 3
  s_add_u32 s17, s17, s19
  s_lshr_b32 s18, s18, 2
  s_waitcnt lgkmcnt(0)
  s_mov_b32 s4, s12
  s_mov_b32 s5, s13
  s_mov_b32 s6, 0x10000000
  s_mov_b32 s7, 0x20000
  s_mov_b32 s8, s12
  s_mov_b32 s9, s13
  s_mov_b32 s10, 0x10000000
  s_mov_b32 s11, 0x20000
  s_mov_b32 s20, 82313216
  s_mov_b32 s52, s48
  s_mov_b32 s53, s49
  s_mov_b32 s54, 2621440
  s_mov_b32 s55, 0x20000
  s_mul_i32 s21, s18, 5
  s_mul_i32 s21, s21, 32768
  s_add_u32 s24, s21, 91488256
  s_add_u32 s25, s24, 32768
  s_add_u32 s26, s25, 32768
  s_add_u32 s27, s26, 32768
  s_add_u32 s28, s27, 32768
  s_lshl_b32 s21, s17, 2
  s_add_u32 s21, s21, s16
  s_mul_i32 s22, s21, 32768
  s_add_u32 s22, s22, 50331648
  s_lshl_b32 s23, s16, 10
  v_add_u32 v2, s23, v1
  s_mul_i32 s29, s16, 5120
  s_add_u32 m0, s29, 0
  s_nop 0
  buffer_load_dwordx4 v2, s[4:7], s24 offen lds
  s_add_u32 m0, s29, 1024
  s_nop 0
  buffer_load_dwordx4 v2, s[4:7], s25 offen lds
  s_add_u32 m0, s29, 2048
  s_nop 0
  buffer_load_dwordx4 v2, s[4:7], s26 offen lds
  s_add_u32 m0, s29, 3072
  s_nop 0
  buffer_load_dwordx4 v2, s[4:7], s27 offen lds
  s_add_u32 m0, s29, 4096
  s_nop 0
  buffer_load_dwordx4 v2, s[4:7], s28 offen lds
  buffer_load_dwordx4 v[32:35], v1, s[4:7], s22 offen offset:0
  buffer_load_dwordx4 v[36:39], v1, s[4:7], s22 offen offset:1024
  buffer_load_dwordx4 v[40:43], v1, s[4:7], s22 offen offset:2048
  buffer_load_dwordx4 v[44:47], v1, s[4:7], s22 offen offset:3072
  v_add_u32 v2, 0x1000, v2
  s_add_u32 s22, s22, 4096
  s_add_u32 m0, s29, 20480
  s_nop 0
  buffer_load_dwordx4 v2, s[4:7], s24 offen lds
  s_add_u32 m0, s29, 21504
  s_nop 0
  buffer_load_dwordx4 v2, s[4:7], s25 offen lds
  s_add_u32 m0, s29, 22528
  s_nop 0
  buffer_load_dwordx4 v2, s[4:7], s26 offen lds
  s_add_u32 m0, s29, 23552
  s_nop 0
  buffer_load_dwordx4 v2, s[4:7], s27 offen lds
  s_add_u32 m0, s29, 24576
  s_nop 0
  buffer_load_dwordx4 v2, s[4:7], s28 offen lds
  buffer_load_dwordx4 v[48:51], v1, s[4:7], s22 offen offset:0
  buffer_load_dwordx4 v[52:55], v1, s[4:7], s22 offen offset:1024
  buffer_load_dwordx4 v[56:59], v1, s[4:7], s22 offen offset:2048
  buffer_load_dwordx4 v[60:63], v1, s[4:7], s22 offen offset:3072
  v_add_u32 v2, 0x1000, v2
  s_add_u32 s22, s22, 4096
  s_waitcnt vmcnt(9)
  s_barrier
  s_add_u32 m0, s29, 40960
  s_nop 0
  buffer_load_dwordx4 v2, s[4:7], s24 offen lds
  s_add_u32 m0, s29, 41984
  s_nop 0
  buffer_load_dwordx4 v2, s[4:7], s25 offen lds
  s_add_u32 m0, s29, 43008
  s_nop 0
  buffer_load_dwordx4 v2, s[4:7], s26 offen lds
  s_add_u32 m0, s29, 44032
  s_nop 0
  buffer_load_dwordx4 v2, s[4:7], s27 offen lds
  s_add_u32 m0, s29, 45056
  s_nop 0
  buffer_load_dwordx4 v2, s[4:7], s28 offen lds
  buffer_load_dwordx4 v[64:67], v1, s[4:7], s22 offen offset:0
  buffer_load_dwordx4 v[68:71], v1, s[4:7], s22 offen offset:1024
  buffer_load_dwordx4 v[72:75], v1, s[4:7], s22 offen offset:2048
  buffer_load_dwordx4 v[76:79], v1, s[4:7], s22 offen offset:3072
  v_add_u32 v2, 0x1000, v2
  s_add_u32 s22, s22, 4096
  ds_read_b128 v[80:83], v1 offset:0
  ds_read_b128 v[84:87], v1 offset:1024
  ds_read_b128 v[88:91], v1 offset:2048
  ds_read_b128 v[92:95], v1 offset:3072
  ds_read_b128 v[96:99], v1 offset:4096
  ds_read_b128 v[100:103], v1 offset:5120
  ds_read_b128 v[104:107], v1 offset:6144
  ds_read_b128 v[108:111], v1 offset:7168
  ds_read_b128 v[112:115], v1 offset:8192
  ds_read_b128 v[116:119], v1 offset:9216
  s_waitcnt lgkmcnt(5)
  v_mfma_f32_16x16x32_bf16 v[8:11], v[80:83], v[32:35], 0
  v_mfma_f32_16x16x32_bf16 v[12:15], v[84:87], v[32:35], 0
  v_mfma_f32_16x16x32_bf16 v[16:19], v[88:91], v[32:35], 0
  v_mfma_f32_16x16x32_bf16 v[20:23], v[92:95], v[32:35], 0
  v_mfma_f32_16x16x32_bf16 v[24:27], v[96:99], v[32:35], 0
  ds_read_b128 v[80:83], v1 offset:10240
  ds_read_b128 v[84:87], v1 offset:11264
  ds_read_b128 v[88:91], v1 offset:12288
  ds_read_b128 v[92:95], v1 offset:13312
  ds_read_b128 v[96:99], v1 offset:14336
  s_waitcnt lgkmcnt(5)
  v_mfma_f32_16x16x32_bf16 v[8:11], v[100:103], v[36:39], v[8:11]
  v_mfma_f32_16x16x32_bf16 v[12:15], v[104:107], v[36:39], v[12:15]
  v_mfma_f32_16x16x32_bf16 v[16:19], v[108:111], v[36:39], v[16:19]
  v_mfma_f32_16x16x32_bf16 v[20:23], v[112:115], v[36:39], v[20:23]
  v_mfma_f32_16x16x32_bf16 v[24:27], v[116:119], v[36:39], v[24:27]
  ds_read_b128 v[100:103], v1 offset:15360
  ds_read_b128 v[104:107], v1 offset:16384
  ds_read_b128 v[108:111], v1 offset:17408
  ds_read_b128 v[112:115], v1 offset:18432
  ds_read_b128 v[116:119], v1 offset:19456
  s_waitcnt lgkmcnt(5)
  v_mfma_f32_16x16x32_bf16 v[8:11], v[80:83], v[40:43], v[8:11]
  v_mfma_f32_16x16x32_bf16 v[12:15], v[84:87], v[40:43], v[12:15]
  v_mfma_f32_16x16x32_bf16 v[16:19], v[88:91], v[40:43], v[16:19]
  v_mfma_f32_16x16x32_bf16 v[20:23], v[92:95], v[40:43], v[20:23]
  v_mfma_f32_16x16x32_bf16 v[24:27], v[96:99], v[40:43], v[24:27]
  s_waitcnt lgkmcnt(0)
  v_mfma_f32_16x16x32_bf16 v[8:11], v[100:103], v[44:47], v[8:11]
  v_mfma_f32_16x16x32_bf16 v[12:15], v[104:107], v[44:47], v[12:15]
  v_mfma_f32_16x16x32_bf16 v[16:19], v[108:111], v[44:47], v[16:19]
  v_mfma_f32_16x16x32_bf16 v[20:23], v[112:115], v[44:47], v[20:23]
  v_mfma_f32_16x16x32_bf16 v[24:27], v[116:119], v[44:47], v[24:27]
  s_mov_b32 s30, 0
outb2_loop2:
  s_waitcnt vmcnt(9)
  s_barrier
  s_add_u32 m0, s29, 0
  s_nop 0
  buffer_load_dwordx4 v2, s[4:7], s24 offen lds
  s_add_u32 m0, s29, 1024
  s_nop 0
  buffer_load_dwordx4 v2, s[4:7], s25 offen lds
  s_add_u32 m0, s29, 2048
  s_nop 0
  buffer_load_dwordx4 v2, s[4:7], s26 offen lds
  s_add_u32 m0, s29, 3072
  s_nop 0
  buffer_load_dwordx4 v2, s[4:7], s27 offen lds
  s_add_u32 m0, s29, 4096
  s_nop 0
  buffer_load_dwordx4 v2, s[4:7], s28 offen lds
  buffer_load_dwordx4 v[32:35], v1, s[4:7], s22 offen offset:0
  buffer_load_dwordx4 v[36:39], v1, s[4:7], s22 offen offset:1024
  buffer_load_dwordx4 v[40:43], v1, s[4:7], s22 offen offset:2048
  buffer_load_dwordx4 v[44:47], v1, s[4:7], s22 offen offset:3072
  v_add_u32 v2, 0x1000, v2
  s_add_u32 s22, s22, 4096
  ds_read_b128 v[80:83], v1 offset:20480
  ds_read_b128 v[84:87], v1 offset:21504
  ds_read_b128 v[88:91], v1 offset:22528
  ds_read_b128 v[92:95], v1 offset:23552
  ds_read_b128 v[96:99], v1 offset:24576
  ds_read_b128 v[100:103], v1 offset:25600
  ds_read_b128 v[104:107], v1 offset:26624
  ds_read_b128 v[108:111], v1 offset:27648
  ds_read_b128 v[112:115], v1 offset:28672
  ds_read_b128 v[116:119], v1 offset:29696
  s_waitcnt lgkmcnt(5)
  v_mfma_f32_16x16x32_bf16 v[8:11], v[80:83], v[48:51], v[8:11]
  v_mfma_f32_16x16x32_bf16 v[12:15], v[84:87], v[48:51], v[12:15]
  v_mfma_f32_16x16x32_bf16 v[16:19], v[88:91], v[48:51], v[16:19]
  v_mfma_f32_16x16x32_bf16 v[20:23], v[92:95], v[48:51], v[20:23]
  v_mfma_f32_16x16x32_bf16 v[24:27], v[96:99], v[48:51], v[24:27]
  ds_read_b128 v[80:83], v1 offset:30720
  ds_read_b128 v[84:87], v1 offset:31744
  ds_read_b128 v[88:91], v1 offset:32768
  ds_read_b128 v[92:95], v1 offset:33792
  ds_read_b128 v[96:99], v1 offset:34816
  s_waitcnt lgkmcnt(5)
  v_mfma_f32_16x16x32_bf16 v[8:11], v[100:103], v[52:55], v[8:11]
  v_mfma_f32_16x16x32_bf16 v[12:15], v[104:107], v[52:55], v[12:15]
  v_mfma_f32_16x16x32_bf16 v[16:19], v[108:111], v[52:55], v[16:19]
  v_mfma_f32_16x16x32_bf16 v[20:23], v[112:115], v[52:55], v[20:23]
  v_mfma_f32_16x16x32_bf16 v[24:27], v[116:119], v[52:55], v[24:27]
  ds_read_b128 v[100:103], v1 offset:35840
  ds_read_b128 v[104:107], v1 offset:36864
  ds_read_b128 v[108:111], v1 offset:37888
  ds_read_b128 v[112:115], v1 offset:38912
  ds_read_b128 v[116:119], v1 offset:39936
  s_waitcnt lgkmcnt(5)
  v_mfma_f32_16x16x32_bf16 v[8:11], v[80:83], v[56:59], v[8:11]
  v_mfma_f32_16x16x32_bf16 v[12:15], v[84:87], v[56:59], v[12:15]
  v_mfma_f32_16x16x32_bf16 v[16:19], v[88:91], v[56:59], v[16:19]
  v_mfma_f32_16x16x32_bf16 v[20:23], v[92:95], v[56:59], v[20:23]
  v_mfma_f32_16x16x32_bf16 v[24:27], v[96:99], v[56:59], v[24:27]
  s_waitcnt lgkmcnt(0)
  v_mfma_f32_16x16x32_bf16 v[8:11], v[100:103], v[60:63], v[8:11]
  v_mfma_f32_16x16x32_bf16 v[12:15], v[104:107], v[60:63], v[12:15]
  v_mfma_f32_16x16x32_bf16 v[16:19], v[108:111], v[60:63], v[16:19]
  v_mfma_f32_16x16x32_bf16 v[20:23], v[112:115], v[60:63], v[20:23]
  v_mfma_f32_16x16x32_bf16 v[24:27], v[116:119], v[60:63], v[24:27]
  s_waitcnt vmcnt(9)
  s_barrier
  s_add_u32 m0, s29, 20480
  s_nop 0
  buffer_load_dwordx4 v2, s[4:7], s24 offen lds
  s_add_u32 m0, s29, 21504
  s_nop 0
  buffer_load_dwordx4 v2, s[4:7], s25 offen lds
  s_add_u32 m0, s29, 22528
  s_nop 0
  buffer_load_dwordx4 v2, s[4:7], s26 offen lds
  s_add_u32 m0, s29, 23552
  s_nop 0
  buffer_load_dwordx4 v2, s[4:7], s27 offen lds
  s_add_u32 m0, s29, 24576
  s_nop 0
  buffer_load_dwordx4 v2, s[4:7], s28 offen lds
  buffer_load_dwordx4 v[48:51], v1, s[4:7], s22 offen offset:0
  buffer_load_dwordx4 v[52:55], v1, s[4:7], s22 offen offset:1024
  buffer_load_dwordx4 v[56:59], v1, s[4:7], s22 offen offset:2048
  buffer_load_dwordx4 v[60:63], v1, s[4:7], s22 offen offset:3072
  v_add_u32 v2, 0x1000, v2
  s_add_u32 s22, s22, 4096
  ds_read_b128 v[80:83], v1 offset:40960
  ds_read_b128 v[84:87], v1 offset:41984
  ds_read_b128 v[88:91], v1 offset:43008
  ds_read_b128 v[92:95], v1 offset:44032
  ds_read_b128 v[96:99], v1 offset:45056
  ds_read_b128 v[100:103], v1 offset:46080
  ds_read_b128 v[104:107], v1 offset:47104
  ds_read_b128 v[108:111], v1 offset:48128
  ds_read_b128 v[112:115], v1 offset:49152
  ds_read_b128 v[116:119], v1 offset:50176
  s_waitcnt lgkmcnt(5)
  v_mfma_f32_16x16x32_bf16 v[8:11], v[80:83], v[64:67], v[8:11]
  v_mfma_f32_16x16x32_bf16 v[12:15], v[84:87], v[64:67], v[12:15]
  v_mfma_f32_16x16x32_bf16 v[16:19], v[88:91], v[64:67], v[16:19]
  v_mfma_f32_16x16x32_bf16 v[20:23], v[92:95], v[64:67], v[20:23]
  v_mfma_f32_16x16x32_bf16 v[24:27], v[96:99], v[64:67], v[24:27]
  ds_read_b128 v[80:83], v1 offset:51200
  ds_read_b128 v[84:87], v1 offset:52224
  ds_read_b128 v[88:91], v1 offset:53248
  ds_read_b128 v[92:95], v1 offset:54272
  ds_read_b128 v[96:99], v1 offset:55296
  s_waitcnt lgkmcnt(5)
  v_mfma_f32_16x16x32_bf16 v[8:11], v[100:103], v[68:71], v[8:11]
  v_mfma_f32_16x16x32_bf16 v[12:15], v[104:107], v[68:71], v[12:15]
  v_mfma_f32_16x16x32_bf16 v[16:19], v[108:111], v[68:71], v[16:19]
  v_mfma_f32_16x16x32_bf16 v[20:23], v[112:115], v[68:71], v[20:23]
  v_mfma_f32_16x16x32_bf16 v[24:27], v[116:119], v[68:71], v[24:27]
  ds_read_b128 v[100:103], v1 offset:56320
  ds_read_b128 v[104:107], v1 offset:57344
  ds_read_b128 v[108:111], v1 offset:58368
  ds_read_b128 v[112:115], v1 offset:59392
  ds_read_b128 v[116:119], v1 offset:60416
  s_waitcnt lgkmcnt(5)
  v_mfma_f32_16x16x32_bf16 v[8:11], v[80:83], v[72:75], v[8:11]
  v_mfma_f32_16x16x32_bf16 v[12:15], v[84:87], v[72:75], v[12:15]
  v_mfma_f32_16x16x32_bf16 v[16:19], v[88:91], v[72:75], v[16:19]
  v_mfma_f32_16x16x32_bf16 v[20:23], v[92:95], v[72:75], v[20:23]
  v_mfma_f32_16x16x32_bf16 v[24:27], v[96:99], v[72:75], v[24:27]
  s_waitcnt lgkmcnt(0)
  v_mfma_f32_16x16x32_bf16 v[8:11], v[100:103], v[76:79], v[8:11]
  v_mfma_f32_16x16x32_bf16 v[12:15], v[104:107], v[76:79], v[12:15]
  v_mfma_f32_16x16x32_bf16 v[16:19], v[108:111], v[76:79], v[16:19]
  v_mfma_f32_16x16x32_bf16 v[20:23], v[112:115], v[76:79], v[20:23]
  v_mfma_f32_16x16x32_bf16 v[24:27], v[116:119], v[76:79], v[24:27]
  s_waitcnt vmcnt(9)
  s_barrier
  s_add_u32 m0, s29, 40960
  s_nop 0
  buffer_load_dwordx4 v2, s[4:7], s24 offen lds
  s_add_u32 m0, s29, 41984
  s_nop 0
  buffer_load_dwordx4 v2, s[4:7], s25 offen lds
  s_add_u32 m0, s29, 43008
  s_nop 0
  buffer_load_dwordx4 v2, s[4:7], s26 offen lds
  s_add_u32 m0, s29, 44032
  s_nop 0
  buffer_load_dwordx4 v2, s[4:7], s27 offen lds
  s_add_u32 m0, s29, 45056
  s_nop 0
  buffer_load_dwordx4 v2, s[4:7], s28 offen lds
  buffer_load_dwordx4 v[64:67], v1, s[4:7], s22 offen offset:0
  buffer_load_dwordx4 v[68:71], v1, s[4:7], s22 offen offset:1024
  buffer_load_dwordx4 v[72:75], v1, s[4:7], s22 offen offset:2048
  buffer_load_dwordx4 v[76:79], v1, s[4:7], s22 offen offset:3072
  v_add_u32 v2, 0x1000, v2
  s_add_u32 s22, s22, 4096
  ds_read_b128 v[80:83], v1 offset:0
  ds_read_b128 v[84:87], v1 offset:1024
  ds_read_b128 v[88:91], v1 offset:2048
  ds_read_b128 v[92:95], v1 offset:3072
  ds_read_b128 v[96:99], v1 offset:4096
  ds_read_b128 v[100:103], v1 offset:5120
  ds_read_b128 v[104:107], v1 offset:6144
  ds_read_b128 v[108:111], v1 offset:7168
  ds_read_b128 v[112:115], v1 offset:8192
  ds_read_b128 v[116:119], v1 offset:9216
  s_waitcnt lgkmcnt(5)
  v_mfma_f32_16x16x32_bf16 v[8:11], v[80:83], v[32:35], v[8:11]
  v_mfma_f32_16x16x32_bf16 v[12:15], v[84:87], v[32:35], v[12:15]
  v_mfma_f32_16x16x32_bf16 v[16:19], v[88:91], v[32:35], v[16:19]
  v_mfma_f32_16x16x32_bf16 v[20:23], v[92:95], v[32:35], v[20:23]
  v_mfma_f32_16x16x32_bf16 v[24:27], v[96:99], v[32:35], v[24:27]
  ds_read_b128 v[80:83], v1 offset:10240
  ds_read_b128 v[84:87], v1 offset:11264
  ds_read_b128 v[88:91], v1 offset:12288
  ds_read_b128 v[92:95], v1 offset:13312
  ds_read_b128 v[96:99], v1 offset:14336
  s_waitcnt lgkmcnt(5)
  v_mfma_f32_16x16x32_bf16 v[8:11], v[100:103], v[36:39], v[8:11]
  v_mfma_f32_16x16x32_bf16 v[12:15], v[104:107], v[36:39], v[12:15]
  v_mfma_f32_16x16x32_bf16 v[16:19], v[108:111], v[36:39], v[16:19]
  v_mfma_f32_16x16x32_bf16 v[20:23], v[112:115], v[36:39], v[20:23]
  v_mfma_f32_16x16x32_bf16 v[24:27], v[116:119], v[36:39], v[24:27]
  ds_read_b128 v[100:103], v1 offset:15360
  ds_read_b128 v[104:107], v1 offset:16384
  ds_read_b128 v[108:111], v1 offset:17408
  ds_read_b128 v[112:115], v1 offset:18432
  ds_read_b128 v[116:119], v1 offset:19456
  s_waitcnt lgkmcnt(5)
  v_mfma_f32_16x16x32_bf16 v[8:11], v[80:83], v[40:43], v[8:11]
  v_mfma_f32_16x16x32_bf16 v[12:15], v[84:87], v[40:43], v[12:15]
  v_mfma_f32_16x16x32_bf16 v[16:19], v[88:91], v[40:43], v[16:19]
  v_mfma_f32_16x16x32_bf16 v[20:23], v[92:95], v[40:43], v[20:23]
  v_mfma_f32_16x16x32_bf16 v[24:27], v[96:99], v[40:43], v[24:27]
  s_waitcnt lgkmcnt(0)
  v_mfma_f32_16x16x32_bf16 v[8:11], v[100:103], v[44:47], v[8:11]
  v_mfma_f32_16x16x32_bf16 v[12:15], v[104:107], v[44:47], v[12:15]
  v_mfma_f32_16x16x32_bf16 v[16:19], v[108:111], v[44:47], v[16:19]
  v_mfma_f32_16x16x32_bf16 v[20:23], v[112:115], v[44:47], v[20:23]
  v_mfma_f32_16x16x32_bf16 v[24:27], v[116:119], v[44:47], v[24:27]
  s_add_u32 s30, s30, 1
  s_cmp_lt_u32 s30, 1
  s_cbranch_scc1 outb2_loop2
  s_waitcnt vmcnt(9)
  s_barrier
  s_add_u32 m0, s29, 0
  s_nop 0
  buffer_load_dwordx4 v2, s[4:7], s24 offen lds
  s_add_u32 m0, s29, 1024
  s_nop 0
  buffer_load_dwordx4 v2, s[4:7], s25 offen lds
  s_add_u32 m0, s29, 2048
  s_nop 0
  buffer_load_dwordx4 v2, s[4:7], s26 offen lds
  s_add_u32 m0, s29, 3072
  s_nop 0
  buffer_load_dwordx4 v2, s[4:7], s27 offen lds
  s_add_u32 m0, s29, 4096
  s_nop 0
  buffer_load_dwordx4 v2, s[4:7], s28 offen lds
  buffer_load_dwordx4 v[32:35], v1, s[4:7], s22 offen offset:0
  buffer_load_dwordx4 v[36:39], v1, s[4:7], s22 offen offset:1024
  buffer_load_dwordx4 v[40:43], v1, s[4:7], s22 offen offset:2048
  buffer_load_dwordx4 v[44:47], v1, s[4:7], s22 offen offset:3072
  v_add_u32 v2, 0x1000, v2
  s_add_u32 s22, s22, 4096
  ds_read_b128 v[80:83], v1 offset:20480
  ds_read_b128 v[84:87], v1 offset:21504
  ds_read_b128 v[88:91], v1 offset:22528
  ds_read_b128 v[92:95], v1 offset:23552
  ds_read_b128 v[96:99], v1 offset:24576
  ds_read_b128 v[100:103], v1 offset:25600
  ds_read_b128 v[104:107], v1 offset:26624
  ds_read_b128 v[108:111], v1 offset:27648
  ds_read_b128 v[112:115], v1 offset:28672
  ds_read_b128 v[116:119], v1 offset:29696
  s_waitcnt lgkmcnt(5)
  v_mfma_f32_16x16x32_bf16 v[8:11], v[80:83], v[48:51], v[8:11]
  v_mfma_f32_16x16x32_bf16 v[12:15], v[84:87], v[48:51], v[12:15]
  v_mfma_f32_16x16x32_bf16 v[16:19], v[88:91], v[48:51], v[16:19]
  v_mfma_f32_16x16x32_bf16 v[20:23], v[92:95], v[48:51], v[20:23]
  v_mfma_f32_16x16x32_bf16 v[24:27], v[96:99], v[48:51], v[24:27]
  ds_read_b128 v[80:83], v1 offset:30720
  ds_read_b128 v[84:87], v1 offset:31744
  ds_read_b128 v[88:91], v1 offset:32768
  ds_read_b128 v[92:95], v1 offset:33792
  ds_read_b128 v[96:99], v1 offset:34816
  s_waitcnt lgkmcnt(5)
  v_mfma_f32_16x16x32_bf16 v[8:11], v[100:103], v[52:55], v[8:11]
  v_mfma_f32_16x16x32_bf16 v[12:15], v[104:107], v[52:55], v[12:15]
  v_mfma_f32_16x16x32_bf16 v[16:19], v[108:111], v[52:55], v[16:19]
  v_mfma_f32_16x16x32_bf16 v[20:23], v[112:115], v[52:55], v[20:23]
  v_mfma_f32_16x16x32_bf16 v[24:27], v[116:119], v[52:55], v[24:27]
  ds_read_b128 v[100:103], v1 offset:35840
  ds_read_b128 v[104:107], v1 offset:36864
  ds_read_b128 v[108:111], v1 offset:37888
  ds_read_b128 v[112:115], v1 offset:38912
  ds_read_b128 v[116:119], v1 offset:39936
  s_waitcnt lgkmcnt(5)
  v_mfma_f32_16x16x32_bf16 v[8:11], v[80:83], v[56:59], v[8:11]
  v_mfma_f32_16x16x32_bf16 v[12:15], v[84:87], v[56:59], v[12:15]
  v_mfma_f32_16x16x32_bf16 v[16:19], v[88:91], v[56:59], v[16:19]
  v_mfma_f32_16x16x32_bf16 v[20:23], v[92:95], v[56:59], v[20:23]
  v_mfma_f32_16x16x32_bf16 v[24:27], v[96:99], v[56:59], v[24:27]
  s_waitcnt lgkmcnt(0)
  v_mfma_f32_16x16x32_bf16 v[8:11], v[100:103], v[60:63], v[8:11]
  v_mfma_f32_16x16x32_bf16 v[12:15], v[104:107], v[60:63], v[12:15]
  v_mfma_f32_16x16x32_bf16 v[16:19], v[108:111], v[60:63], v[16:19]
  v_mfma_f32_16x16x32_bf16 v[20:23], v[112:115], v[60:63], v[20:23]
  v_mfma_f32_16x16x32_bf16 v[24:27], v[116:119], v[60:63], v[24:27]
  s_waitcnt vmcnt(9)
  s_barrier
  s_add_u32 m0, s29, 20480
  s_nop 0
  buffer_load_dwordx4 v2, s[4:7], s24 offen lds
  s_add_u32 m0, s29, 21504
  s_nop 0
  buffer_load_dwordx4 v2, s[4:7], s25 offen lds
  s_add_u32 m0, s29, 22528
  s_nop 0
  buffer_load_dwordx4 v2, s[4:7], s26 offen lds
  s_add_u32 m0, s29, 23552
  s_nop 0
  buffer_load_dwordx4 v2, s[4:7], s27 offen lds
  s_add_u32 m0, s29, 24576
  s_nop 0
  buffer_load_dwordx4 v2, s[4:7], s28 offen lds
  buffer_load_dwordx4 v[48:51], v1, s[4:7], s22 offen offset:0
  buffer_load_dwordx4 v[52:55], v1, s[4:7], s22 offen offset:1024
  buffer_load_dwordx4 v[56:59], v1, s[4:7], s22 offen offset:2048
  buffer_load_dwordx4 v[60:63], v1, s[4:7], s22 offen offset:3072
  v_add_u32 v2, 0x1000, v2
  s_add_u32 s22, s22, 4096
  ds_read_b128 v[80:83], v1 offset:40960
  ds_read_b128 v[84:87], v1 offset:41984
  ds_read_b128 v[88:91], v1 offset:43008
  ds_read_b128 v[92:95], v1 offset:44032
  ds_read_b128 v[96:99], v1 offset:45056
  ds_read_b128 v[100:103], v1 offset:46080
  ds_read_b128 v[104:107], v1 offset:47104
  ds_read_b128 v[108:111], v1 offset:48128
  ds_read_b128 v[112:115], v1 offset:49152
  ds_read_b128 v[116:119], v1 offset:50176
  s_waitcnt lgkmcnt(5)
  v_mfma_f32_16x16x32_bf16 v[8:11], v[80:83], v[64:67], v[8:11]
  v_mfma_f32_16x16x32_bf16 v[12:15], v[84:87], v[64:67], v[12:15]
  v_mfma_f32_16x16x32_bf16 v[16:19], v[88:91], v[64:67], v[16:19]
  v_mfma_f32_16x16x32_bf16 v[20:23], v[92:95], v[64:67], v[20:23]
  v_mfma_f32_16x16x32_bf16 v[24:27], v[96:99], v[64:67], v[24:27]
  ds_read_b128 v[80:83], v1 offset:51200
  ds_read_b128 v[84:87], v1 offset:52224
  ds_read_b128 v[88:91], v1 offset:53248
  ds_read_b128 v[92:95], v1 offset:54272
  ds_read_b128 v[96:99], v1 offset:55296
  s_waitcnt lgkmcnt(5)
  v_mfma_f32_16x16x32_bf16 v[8:11], v[100:103], v[68:71], v[8:11]
  v_mfma_f32_16x16x32_bf16 v[12:15], v[104:107], v[68:71], v[12:15]
  v_mfma_f32_16x16x32_bf16 v[16:19], v[108:111], v[68:71], v[16:19]
  v_mfma_f32_16x16x32_bf16 v[20:23], v[112:115], v[68:71], v[20:23]
  v_mfma_f32_16x16x32_bf16 v[24:27], v[116:119], v[68:71], v[24:27]
  ds_read_b128 v[100:103], v1 offset:56320
  ds_read_b128 v[104:107], v1 offset:57344
  ds_read_b128 v[108:111], v1 offset:58368
  ds_read_b128 v[112:115], v1 offset:59392
  ds_read_b128 v[116:119], v1 offset:60416
  s_waitcnt lgkmcnt(5)
  v_mfma_f32_16x16x32_bf16 v[8:11], v[80:83], v[72:75], v[8:11]
  v_mfma_f32_16x16x32_bf16 v[12:15], v[84:87], v[72:75], v[12:15]
  v_mfma_f32_16x16x32_bf16 v[16:19], v[88:91], v[72:75], v[16:19]
  v_mfma_f32_16x16x32_bf16 v[20:23], v[92:95], v[72:75], v[20:23]
  v_mfma_f32_16x16x32_bf16 v[24:27], v[96:99], v[72:75], v[24:27]
  s_waitcnt lgkmcnt(0)
  v_mfma_f32_16x16x32_bf16 v[8:11], v[100:103], v[76:79], v[8:11]
  v_mfma_f32_16x16x32_bf16 v[12:15], v[104:107], v[76:79], v[12:15]
  v_mfma_f32_16x16x32_bf16 v[16:19], v[108:111], v[76:79], v[16:19]
  v_mfma_f32_16x16x32_bf16 v[20:23], v[112:115], v[76:79], v[20:23]
  v_mfma_f32_16x16x32_bf16 v[24:27], v[116:119], v[76:79], v[24:27]
  s_waitcnt vmcnt(9)
  s_barrier
  ds_read_b128 v[80:83], v1 offset:0
  ds_read_b128 v[84:87], v1 offset:1024
  ds_read_b128 v[88:91], v1 offset:2048
  ds_read_b128 v[92:95], v1 offset:3072
  ds_read_b128 v[96:99], v1 offset:4096
  ds_read_b128 v[100:103], v1 offset:5120
  ds_read_b128 v[104:107], v1 offset:6144
  ds_read_b128 v[108:111], v1 offset:7168
  ds_read_b128 v[112:115], v1 offset:8192
  ds_read_b128 v[116:119], v1 offset:9216
  s_waitcnt lgkmcnt(5)
  v_mfma_f32_16x16x32_bf16 v[8:11], v[80:83], v[32:35], v[8:11]
  v_mfma_f32_16x16x32_bf16 v[12:15], v[84:87], v[32:35], v[12:15]
  v_mfma_f32_16x16x32_bf16 v[16:19], v[88:91], v[32:35], v[16:19]
  v_mfma_f32_16x16x32_bf16 v[20:23], v[92:95], v[32:35], v[20:23]
  v_mfma_f32_16x16x32_bf16 v[24:27], v[96:99], v[32:35], v[24:27]
  ds_read_b128 v[80:83], v1 offset:10240
  ds_read_b128 v[84:87], v1 offset:11264
  ds_read_b128 v[88:91], v1 offset:12288
  ds_read_b128 v[92:95], v1 offset:13312
  ds_read_b128 v[96:99], v1 offset:14336
  s_waitcnt lgkmcnt(5)
  v_mfma_f32_16x16x32_bf16 v[8:11], v[100:103], v[36:39], v[8:11]
  v_mfma_f32_16x16x32_bf16 v[12:15], v[104:107], v[36:39], v[12:15]
  v_mfma_f32_16x16x32_bf16 v[16:19], v[108:111], v[36:39], v[16:19]
  v_mfma_f32_16x16x32_bf16 v[20:23], v[112:115], v[36:39], v[20:23]
  v_mfma_f32_16x16x32_bf16 v[24:27], v[116:119], v[36:39], v[24:27]
  ds_read_b128 v[100:103], v1 offset:15360
  ds_read_b128 v[104:107], v1 offset:16384
  ds_read_b128 v[108:111], v1 offset:17408
  ds_read_b128 v[112:115], v1 offset:18432
  ds_read_b128 v[116:119], v1 offset:19456
  s_waitcnt lgkmcnt(5)
  v_mfma_f32_16x16x32_bf16 v[8:11], v[80:83], v[40:43], v[8:11]
  v_mfma_f32_16x16x32_bf16 v[12:15], v[84:87], v[40:43], v[12:15]
  v_mfma_f32_16x16x32_bf16 v[16:19], v[88:91], v[40:43], v[16:19]
  v_mfma_f32_16x16x32_bf16 v[20:23], v[92:95], v[40:43], v[20:23]
  v_mfma_f32_16x16x32_bf16 v[24:27], v[96:99], v[40:43], v[24:27]
  s_waitcnt lgkmcnt(0)
  v_mfma_f32_16x16x32_bf16 v[8:11], v[100:103], v[44:47], v[8:11]
  v_mfma_f32_16x16x32_bf16 v[12:15], v[104:107], v[44:47], v[12:15]
  v_mfma_f32_16x16x32_bf16 v[16:19], v[108:111], v[44:47], v[16:19]
  v_mfma_f32_16x16x32_bf16 v[20:23], v[112:115], v[44:47], v[20:23]
  v_mfma_f32_16x16x32_bf16 v[24:27], v[116:119], v[44:47], v[24:27]
  s_waitcnt vmcnt(0)
  s_barrier
  ds_read_b128 v[80:83], v1 offset:20480
  ds_read_b128 v[84:87], v1 offset:21504
  ds_read_b128 v[88:91], v1 offset:22528
  ds_read_b128 v[92:95], v1 offset:23552
  ds_read_b128 v[96:99], v1 offset:24576
  ds_read_b128 v[100:103], v1 offset:25600
  ds_read_b128 v[104:107], v1 offset:26624
  ds_read_b128 v[108:111], v1 offset:27648
  ds_read_b128 v[112:115], v1 offset:28672
  ds_read_b128 v[116:119], v1 offset:29696
  s_waitcnt lgkmcnt(5)
  v_mfma_f32_16x16x32_bf16 v[8:11], v[80:83], v[48:51], v[8:11]
  v_mfma_f32_16x16x32_bf16 v[12:15], v[84:87], v[48:51], v[12:15]
  v_mfma_f32_16x16x32_bf16 v[16:19], v[88:91], v[48:51], v[16:19]
  v_mfma_f32_16x16x32_bf16 v[20:23], v[92:95], v[48:51], v[20:23]
  v_mfma_f32_16x16x32_bf16 v[24:27], v[96:99], v[48:51], v[24:27]
  ds_read_b128 v[80:83], v1 offset:30720
  ds_read_b128 v[84:87], v1 offset:31744
  ds_read_b128 v[88:91], v1 offset:32768
  ds_read_b128 v[92:95], v1 offset:33792
  ds_read_b128 v[96:99], v1 offset:34816
  s_waitcnt lgkmcnt(5)
  v_mfma_f32_16x16x32_bf16 v[8:11], v[100:103], v[52:55], v[8:11]
  v_mfma_f32_16x16x32_bf16 v[12:15], v[104:107], v[52:55], v[12:15]
  v_mfma_f32_16x16x32_bf16 v[16:19], v[108:111], v[52:55], v[16:19]
  v_mfma_f32_16x16x32_bf16 v[20:23], v[112:115], v[52:55], v[20:23]
  v_mfma_f32_16x16x32_bf16 v[24:27], v[116:119], v[52:55], v[24:27]
  ds_read_b128 v[100:103], v1 offset:35840
  ds_read_b128 v[104:107], v1 offset:36864
  ds_read_b128 v[108:111], v1 offset:37888
  ds_read_b128 v[112:115], v1 offset:38912
  ds_read_b128 v[116:119], v1 offset:39936
  s_waitcnt lgkmcnt(5)
  v_mfma_f32_16x16x32_bf16 v[8:11], v[80:83], v[56:59], v[8:11]
  v_mfma_f32_16x16x32_bf16 v[12:15], v[84:87], v[56:59], v[12:15]
  v_mfma_f32_16x16x32_bf16 v[16:19], v[88:91], v[56:59], v[16:19]
  v_mfma_f32_16x16x32_bf16 v[20:23], v[92:95], v[56:59], v[20:23]
  v_mfma_f32_16x16x32_bf16 v[24:27], v[96:99], v[56:59], v[24:27]
  s_waitcnt lgkmcnt(0)
  v_mfma_f32_16x16x32_bf16 v[8:11], v[100:103], v[60:63], v[8:11]
  v_mfma_f32_16x16x32_bf16 v[12:15], v[104:107], v[60:63], v[12:15]
  v_mfma_f32_16x16x32_bf16 v[16:19], v[108:111], v[60:63], v[16:19]
  v_mfma_f32_16x16x32_bf16 v[20:23], v[112:115], v[60:63], v[20:23]
  v_mfma_f32_16x16x32_bf16 v[24:27], v[116:119], v[60:63], v[24:27]
  v_and_b32 v3, 63, v0
  v_and_b32 v4, 15, v3
  v_lshrrev_b32 v3, 4, v3
  s_lshl_b32 s21, s17, 6
  s_lshl_b32 s23, s16, 4
  s_add_u32 s21, s21, s23
  v_add_u32 v4, s21, v4
  v_mul_u32_u24 v6, 1280, v4
  v_lshl_add_u32 v6, v3, 4, v6
  s_mul_i32 s21, s18, 5
  s_add_u32 s23, s21, 0
  s_lshr_b32 s31, s23, 1
  s_lshl_b32 s31, s31, 6
  s_and_b32 s23, s23, 1
  s_lshl_b32 s23, s23, 3
  s_add_u32 s32, s31, s23
  s_add_u32 s40, s32, s20
  buffer_load_dwordx2 v[32:33], v6, s[8:11], s40 offen
  s_add_u32 s23, s21, 1
  s_lshr_b32 s31, s23, 1
  s_lshl_b32 s31, s31, 6
  s_and_b32 s23, s23, 1
  s_lshl_b32 s23, s23, 3
  s_add_u32 s33, s31, s23
  s_add_u32 s41, s33, s20
  buffer_load_dwordx2 v[34:35], v6, s[8:11], s41 offen
  s_add_u32 s23, s21, 2
  s_lshr_b32 s31, s23, 1
  s_lshl_b32 s31, s31, 6
  s_and_b32 s23, s23, 1
  s_lshl_b32 s23, s23, 3
  s_add_u32 s34, s31, s23
  s_add_u32 s42, s34, s20
  buffer_load_dwordx2 v[36:37], v6, s[8:11], s42 offen
  s_add_u32 s23, s21, 3
  s_lshr_b32 s31, s23, 1
  s_lshl_b32 s31, s31, 6
  s_and_b32 s23, s23, 1
  s_lshl_b32 s23, s23, 3
  s_add_u32 s35, s31, s23
  s_add_u32 s43, s35, s20
  buffer_load_dwordx2 v[38:39], v6, s[8:11], s43 offen
  s_add_u32 s23, s21, 4
  s_lshr_b32 s31, s23, 1
  s_lshl_b32 s31, s31, 6
  s_and_b32 s23, s23, 1
  s_lshl_b32 s23, s23, 3
  s_add_u32 s36, s31, s23
  s_add_u32 s44, s36, s20
  buffer_load_dwordx2 v[40:41], v6, s[8:11], s44 offen
  s_waitcnt vmcnt(0)
  v_cvt_pk_bf16_f32 v80, v8, v9
  v_cvt_pk_bf16_f32 v81, v10, v11
  v_lshlrev_b32 v8, 16, v80
  v_and_b32 v9, 0xffff0000, v80
  v_lshlrev_b32 v10, 16, v81
  v_and_b32 v11, 0xffff0000, v81
  v_lshlrev_b32 v82, 16, v32
  v_and_b32 v83, 0xffff0000, v32
  v_lshlrev_b32 v84, 16, v33
  v_and_b32 v85, 0xffff0000, v33
  v_add_f32 v8, v8, v82
  v_add_f32 v9, v9, v83
  v_add_f32 v10, v10, v84
  v_add_f32 v11, v11, v85
  v_cvt_pk_bf16_f32 v32, v8, v9
  v_cvt_pk_bf16_f32 v33, v10, v11
  buffer_store_dwordx2 v[32:33], v6, s[52:55], s32 offen sc1
  v_cvt_pk_bf16_f32 v80, v12, v13
  v_cvt_pk_bf16_f32 v81, v14, v15
  v_lshlrev_b32 v12, 16, v80
  v_and_b32 v13, 0xffff0000, v80
  v_lshlrev_b32 v14, 16, v81
  v_and_b32 v15, 0xffff0000, v81
  v_lshlrev_b32 v82, 16, v34
  v_and_b32 v83, 0xffff0000, v34
  v_lshlrev_b32 v84, 16, v35
  v_and_b32 v85, 0xffff0000, v35
  v_add_f32 v12, v12, v82
  v_add_f32 v13, v13, v83
  v_add_f32 v14, v14, v84
  v_add_f32 v15, v15, v85
  v_cvt_pk_bf16_f32 v34, v12, v13
  v_cvt_pk_bf16_f32 v35, v14, v15
  buffer_store_dwordx2 v[34:35], v6, s[52:55], s33 offen sc1
  v_cvt_pk_bf16_f32 v80, v16, v17
  v_cvt_pk_bf16_f32 v81, v18, v19
  v_lshlrev_b32 v16, 16, v80
  v_and_b32 v17, 0xffff0000, v80
  v_lshlrev_b32 v18, 16, v81
  v_and_b32 v19, 0xffff0000, v81
  v_lshlrev_b32 v82, 16, v36
  v_and_b32 v83, 0xffff0000, v36
  v_lshlrev_b32 v84, 16, v37
  v_and_b32 v85, 0xffff0000, v37
  v_add_f32 v16, v16, v82
  v_add_f32 v17, v17, v83
  v_add_f32 v18, v18, v84
  v_add_f32 v19, v19, v85
  v_cvt_pk_bf16_f32 v36, v16, v17
  v_cvt_pk_bf16_f32 v37, v18, v19
  buffer_store_dwordx2 v[36:37], v6, s[52:55], s34 offen sc1
  v_cvt_pk_bf16_f32 v80, v20, v21
  v_cvt_pk_bf16_f32 v81, v22, v23
  v_lshlrev_b32 v20, 16, v80
  v_and_b32 v21, 0xffff0000, v80
  v_lshlrev_b32 v22, 16, v81
  v_and_b32 v23, 0xffff0000, v81
  v_lshlrev_b32 v82, 16, v38
  v_and_b32 v83, 0xffff0000, v38
  v_lshlrev_b32 v84, 16, v39
  v_and_b32 v85, 0xffff0000, v39
  v_add_f32 v20, v20, v82
  v_add_f32 v21, v21, v83
  v_add_f32 v22, v22, v84
  v_add_f32 v23, v23, v85
  v_cvt_pk_bf16_f32 v38, v20, v21
  v_cvt_pk_bf16_f32 v39, v22, v23
  buffer_store_dwordx2 v[38:39], v6, s[52:55], s35 offen sc1
  v_cvt_pk_bf16_f32 v80, v24, v25
  v_cvt_pk_bf16_f32 v81, v26, v27
  v_lshlrev_b32 v24, 16, v80
  v_and_b32 v25, 0xffff0000, v80
  v_lshlrev_b32 v26, 16, v81
  v_and_b32 v27, 0xffff0000, v81
  v_lshlrev_b32 v82, 16, v40
  v_and_b32 v83, 0xffff0000, v40
  v_lshlrev_b32 v84, 16, v41
  v_and_b32 v85, 0xffff0000, v41
  v_add_f32 v24, v24, v82
  v_add_f32 v25, v25, v83
  v_add_f32 v26, v26, v84
  v_add_f32 v27, v27, v85
  v_cvt_pk_bf16_f32 v40, v24, v25
  v_cvt_pk_bf16_f32 v41, v26, v27
  buffer_store_dwordx2 v[40:41], v6, s[52:55], s36 offen sc1
outb2_exit1:
  s_endpgm
.section .rodata,"a"
.p2align 6
.amdhsa_kernel prep_kernel
  .amdhsa_next_free_vgpr 80
  .amdhsa_next_free_sgpr 64
  .amdhsa_accum_offset 80
  .amdhsa_group_segment_fixed_size 0
  .amdhsa_kernarg_size 104
  .amdhsa_user_sgpr_count 2
  .amdhsa_user_sgpr_kernarg_segment_ptr 1
  .amdhsa_system_sgpr_workgroup_id_x 1
  .amdhsa_float_denorm_mode_32 3
.end_amdhsa_kernel
.p2align 6
.amdhsa_kernel ln2_kernel
  .amdhsa_next_free_vgpr 80
  .amdhsa_next_free_sgpr 40
  .amdhsa_accum_offset 80
  .amdhsa_group_segment_fixed_size 0
  .amdhsa_kernarg_size 104
  .amdhsa_user_sgpr_count 2
  .amdhsa_user_sgpr_kernarg_segment_ptr 1
  .amdhsa_system_sgpr_workgroup_id_x 1
  .amdhsa_float_denorm_mode_32 3
.end_amdhsa_kernel
.p2align 6
.amdhsa_kernel reca_kernel
  .amdhsa_next_free_vgpr 512
  .amdhsa_next_free_sgpr 102
  .amdhsa_accum_offset 256
  .amdhsa_group_segment_fixed_size 0
  .amdhsa_kernarg_size 104
  .amdhsa_user_sgpr_count 2
  .amdhsa_user_sgpr_kernarg_segment_ptr 1
  .amdhsa_system_sgpr_workgroup_id_x 1
  .amdhsa_float_denorm_mode_32 3
.end_amdhsa_kernel
.p2align 6
.amdhsa_kernel fin_kernel
  .amdhsa_next_free_vgpr 496
  .amdhsa_next_free_sgpr 64
  .amdhsa_accum_offset 256
  .amdhsa_group_segment_fixed_size 0
  .amdhsa_kernarg_size 104
  .amdhsa_user_sgpr_count 2
  .amdhsa_user_sgpr_kernarg_segment_ptr 1
  .amdhsa_system_sgpr_workgroup_id_x 1
  .amdhsa_float_denorm_mode_32 3
.end_amdhsa_kernel
.p2align 6
.amdhsa_kernel redln1_kernel
  .amdhsa_next_free_vgpr 248
  .amdhsa_next_free_sgpr 48
  .amdhsa_accum_offset 248
  .amdhsa_group_segment_fixed_size 0
  .amdhsa_kernarg_size 104
  .amdhsa_user_sgpr_count 2
  .amdhsa_user_sgpr_kernarg_segment_ptr 1
  .amdhsa_system_sgpr_workgroup_id_x 1
  .amdhsa_float_denorm_mode_32 3
.end_amdhsa_kernel
.p2align 6
.amdhsa_kernel redln2_kernel
  .amdhsa_next_free_vgpr 248
  .amdhsa_next_free_sgpr 48
  .amdhsa_accum_offset 248
  .amdhsa_group_segment_fixed_size 0
  .amdhsa_kernarg_size 104
  .amdhsa_user_sgpr_count 2
  .amdhsa_user_sgpr_kernarg_segment_ptr 1
  .amdhsa_system_sgpr_workgroup_id_x 1
  .amdhsa_float_denorm_mode_32 3
.end_amdhsa_kernel
.p2align 6
.amdhsa_kernel qkvb_kernel
  .amdhsa_next_free_vgpr 448
  .amdhsa_next_free_sgpr 102
  .amdhsa_accum_offset 256
  .amdhsa_group_segment_fixed_size 0
  .amdhsa_kernarg_size 104
  .amdhsa_user_sgpr_count 2
  .amdhsa_user_sgpr_kernarg_segment_ptr 1
  .amdhsa_system_sgpr_workgroup_id_x 1
  .amdhsa_float_denorm_mode_32 3
.end_amdhsa_kernel
.p2align 6
.amdhsa_kernel attnb_kernel
  .amdhsa_next_free_vgpr 200
  .amdhsa_next_free_sgpr 48
  .amdhsa_accum_offset 200
  .amdhsa_group_segment_fixed_size 0
  .amdhsa_kernarg_size 104
  .amdhsa_user_sgpr_count 2
  .amdhsa_user_sgpr_kernarg_segment_ptr 1
  .amdhsa_system_sgpr_workgroup_id_x 1
  .amdhsa_float_denorm_mode_32 3
.end_amdhsa_kernel
.p2align 6
.amdhsa_kernel outb1_kernel
  .amdhsa_next_free_vgpr 128
  .amdhsa_next_free_sgpr 64
  .amdhsa_accum_offset 128
  .amdhsa_group_segment_fixed_size 0
  .amdhsa_kernarg_size 104
  .amdhsa_user_sgpr_count 2
  .amdhsa_user_sgpr_kernarg_segment_ptr 1
  .amdhsa_system_sgpr_workgroup_id_x 1
  .amdhsa_float_denorm_mode_32 3
.end_amdhsa_kernel
.p2align 6
.amdhsa_kernel outb2_kernel
  .amdhsa_next_free_vgpr 128
  .amdhsa_next_free_sgpr 64
  .amdhsa_accum_offset 128
  .amdhsa_group_segment_fixed_size 0
  .amdhsa_kernarg_size 104
  .amdhsa_user_sgpr_count 2
  .amdhsa_user_sgpr_kernarg_segment_ptr 1
  .amdhsa_system_sgpr_workgroup_id_x 1
  .amdhsa_float_denorm_mode_32 3
.end_amdhsa_kernel
```

```asm
; @launch kernel=prep_kernel grid=(2368,1,1) block=(256,1,1) lds=18944
; @launch kernel=reca_kernel grid=(256,1,1) block=(256,1,1) lds=81920
; @launch kernel=fin_kernel grid=(256,1,1) block=(256,1,1) lds=98304
; @launch kernel=redln1_kernel grid=(128,1,1) block=(256,1,1) lds=512
; @launch kernel=qkvb_kernel grid=(256,1,1) block=(256,1,1) lds=81920
; @launch kernel=attnb_kernel grid=(256,1,1) block=(256,1,1) lds=0
; @launch kernel=outb1_kernel grid=(256,1,1) block=(256,1,1) lds=61440
; @launch kernel=ln2_kernel grid=(128,1,1) block=(256,1,1) lds=512
; @launch kernel=reca_kernel grid=(256,1,1) block=(256,1,1) lds=81920
; @launch kernel=fin_kernel grid=(256,1,1) block=(256,1,1) lds=98304
; @launch kernel=redln2_kernel grid=(128,1,1) block=(256,1,1) lds=512
; @launch kernel=qkvb_kernel grid=(256,1,1) block=(256,1,1) lds=81920
; @launch kernel=attnb_kernel grid=(256,1,1) block=(256,1,1) lds=0
; @launch kernel=outb2_kernel grid=(256,1,1) block=(256,1,1) lds=61440
.amdgcn_target "amdgcn-amd-amdhsa--gfx950"
.text
.globl prep_kernel
.p2align 8
.type prep_kernel,@function
prep_kernel:
  s_cmp_ge_u32 s2, 128
  s_cbranch_scc1 prep_notln5
  s_load_dwordx2 s[12:13], s[0:1], 96
  s_load_dwordx2 s[14:15], s[0:1], 0
  v_lshrrev_b32 v2, 6, v0
  v_and_b32 v3, 63, v0
  s_nop 0
  v_readfirstlane_b32 s16, v2
  s_waitcnt lgkmcnt(0)
  s_mov_b32 s4, s12
  s_mov_b32 s5, s13
  s_mov_b32 s6, 0x10000000
  s_mov_b32 s7, 0x20000
  s_mov_b32 s8, s14
  s_mov_b32 s9, s15
  s_mov_b32 s10, 2621440
  s_mov_b32 s11, 0x20000
  s_mov_b32 s20, 0
  v_and_b32 v2, 15, v3
  v_lshrrev_b32 v4, 4, v3
  s_lshl_b32 s17, s2, 4
  v_add_u32 v1, s17, v2
  v_mul_u32_u24 v1, 1280, v1
  v_lshl_add_u32 v1, v4, 4, v1
  s_mul_i32 s17, s16, 320
  s_add_u32 s20, s20, s17
  buffer_load_dwordx4 v[8:11], v1, s[8:11], s20 offen offset:0
  buffer_load_dwordx4 v[12:15], v1, s[8:11], s20 offen offset:64
  buffer_load_dwordx4 v[16:19], v1, s[8:11], s20 offen offset:128
  buffer_load_dwordx4 v[20:23], v1, s[8:11], s20 offen offset:192
  buffer_load_dwordx4 v[24:27], v1, s[8:11], s20 offen offset:256
  s_sub_u32 s21, 0, s12
  s_and_b32 s21, s21, 0x1fffff
  s_add_u32 s21, s21, 2097152
  v_mov_b32 v68, -1
  v_mov_b32 v69, -1
  v_mov_b32 v70, -1
  v_mov_b32 v71, -1
  v_lshlrev_b32 v72, 4, v0
  s_mul_i32 s22, s2, 12096
  s_add_u32 s22, s22, 0
  s_mul_i32 s23, s2, 12288
  s_add_u32 s23, s23, s21
  buffer_store_dwordx4 v[68:71], v72, s[4:7], s22 offen sc1
  s_add_u32 s22, s22, 4096
  buffer_store_dwordx4 v[68:71], v72, s[4:7], s22 offen sc1
  s_add_u32 s22, s22, 4096
  v_mov_b32 v73, 0x80000000
  v_cmp_gt_u32 vcc, 244, v0
  s_nop 1
  v_cndmask_b32 v73, v73, v72, vcc
  buffer_store_dwordx4 v[68:71], v73, s[4:7], s22 offen
  buffer_store_dwordx4 v[68:71], v72, s[4:7], s23 offen sc1
  s_add_u32 s23, s23, 4096
  buffer_store_dwordx4 v[68:71], v72, s[4:7], s23 offen sc1
  s_add_u32 s23, s23, 4096
  buffer_store_dwordx4 v[68:71], v72, s[4:7], s23 offen sc1
  s_add_u32 s23, s23, 4096
  s_mul_i32 s23, s2, 2048
  s_add_u32 s23, s23, s21
  s_add_u32 s23, s23, 1572864
  v_mov_b32 v73, 0x80000000
  v_cmp_gt_u32 vcc, 128, v0
  s_nop 1
  v_cndmask_b32 v73, v73, v72, vcc
  buffer_store_dwordx4 v[68:71], v73, s[4:7], s23 offen sc1
  s_waitcnt vmcnt(7)
  s_mul_i32 s17, s16, 320
  s_add_u32 s17, s17, 82313216
  buffer_store_dwordx4 v[8:11], v1, s[4:7], s17 offen offset:0
  buffer_store_dwordx4 v[12:15], v1, s[4:7], s17 offen offset:64
  buffer_store_dwordx4 v[16:19], v1, s[4:7], s17 offen offset:128
  buffer_store_dwordx4 v[20:23], v1, s[4:7], s17 offen offset:192
  buffer_store_dwordx4 v[24:27], v1, s[4:7], s17 offen offset:256
  v_lshlrev_b32 v5, 2, v2
  s_lshl_b32 s17, s16, 6
  v_add_u32 v1, s17, v5
  s_waitcnt vmcnt(5)
  v_lshlrev_b32 v28, 16, v8
  v_and_b32 v29, 0xffff0000, v8
  v_lshlrev_b32 v30, 16, v9
  v_and_b32 v31, 0xffff0000, v9
  v_lshlrev_b32 v32, 16, v10
  v_and_b32 v33, 0xffff0000, v10
  v_lshlrev_b32 v34, 16, v11
  v_and_b32 v35, 0xffff0000, v11
  v_lshlrev_b32 v36, 16, v12
  v_and_b32 v37, 0xffff0000, v12
  v_lshlrev_b32 v38, 16, v13
  v_and_b32 v39, 0xffff0000, v13
  v_lshlrev_b32 v40, 16, v14
  v_and_b32 v41, 0xffff0000, v14
  v_lshlrev_b32 v42, 16, v15
  v_and_b32 v43, 0xffff0000, v15
  v_lshlrev_b32 v44, 16, v16
  v_and_b32 v45, 0xffff0000, v16
  v_lshlrev_b32 v46, 16, v17
  v_and_b32 v47, 0xffff0000, v17
  v_lshlrev_b32 v48, 16, v18
  v_and_b32 v49, 0xffff0000, v18
  v_lshlrev_b32 v50, 16, v19
  v_and_b32 v51, 0xffff0000, v19
  v_lshlrev_b32 v52, 16, v20
  v_and_b32 v53, 0xffff0000, v20
  v_lshlrev_b32 v54, 16, v21
  v_and_b32 v55, 0xffff0000, v21
  v_lshlrev_b32 v56, 16, v22
  v_and_b32 v57, 0xffff0000, v22
  v_lshlrev_b32 v58, 16, v23
  v_and_b32 v59, 0xffff0000, v23
  v_lshlrev_b32 v60, 16, v24
  v_and_b32 v61, 0xffff0000, v24
  v_lshlrev_b32 v62, 16, v25
  v_and_b32 v63, 0xffff0000, v25
  v_lshlrev_b32 v64, 16, v26
  v_and_b32 v65, 0xffff0000, v26
  v_lshlrev_b32 v66, 16, v27
  v_and_b32 v67, 0xffff0000, v27
  v_pk_add_f32 v[6:7], v[28:29], v[30:31]
  v_pk_add_f32 v[6:7], v[6:7], v[32:33]
  v_pk_add_f32 v[6:7], v[6:7], v[34:35]
  v_pk_add_f32 v[6:7], v[6:7], v[36:37]
  v_pk_add_f32 v[6:7], v[6:7], v[38:39]
  v_pk_add_f32 v[6:7], v[6:7], v[40:41]
  v_pk_add_f32 v[6:7], v[6:7], v[42:43]
  v_pk_add_f32 v[6:7], v[6:7], v[44:45]
  v_pk_add_f32 v[6:7], v[6:7], v[46:47]
  v_pk_add_f32 v[6:7], v[6:7], v[48:49]
  v_pk_add_f32 v[6:7], v[6:7], v[50:51]
  v_pk_add_f32 v[6:7], v[6:7], v[52:53]
  v_pk_add_f32 v[6:7], v[6:7], v[54:55]
  v_pk_add_f32 v[6:7], v[6:7], v[56:57]
  v_pk_add_f32 v[6:7], v[6:7], v[58:59]
  v_pk_add_f32 v[6:7], v[6:7], v[60:61]
  v_pk_add_f32 v[6:7], v[6:7], v[62:63]
  v_pk_add_f32 v[6:7], v[6:7], v[64:65]
  v_pk_add_f32 v[6:7], v[6:7], v[66:67]
  v_add_f32 v4, v6, v7
  v_mov_b32 v2, v4
  s_nop 1
  v_permlane32_swap_b32 v4, v2
  v_add_f32 v4, v4, v2
  v_mov_b32 v2, v4
  s_nop 1
  v_permlane16_swap_b32 v4, v2
  v_add_f32 v4, v4, v2
  ds_write_b32 v1, v4 offset:0
  s_waitcnt lgkmcnt(0)
  s_barrier
  ds_read_b32 v4, v5 offset:0
  ds_read_b32 v2, v5 offset:64
  ds_read_b32 v3, v5 offset:128
  ds_read_b32 v6, v5 offset:192
  s_waitcnt lgkmcnt(0)
  v_add_f32 v4, v4, v2
  v_add_f32 v3, v3, v6
  v_add_f32 v4, v4, v3
  v_mul_f32 v4, 0x3acccccd, v4
  v_sub_f32 v28, v28, v4
  v_sub_f32 v29, v29, v4
  v_sub_f32 v30, v30, v4
  v_sub_f32 v31, v31, v4
  v_sub_f32 v32, v32, v4
  v_sub_f32 v33, v33, v4
  v_sub_f32 v34, v34, v4
  v_sub_f32 v35, v35, v4
  v_sub_f32 v36, v36, v4
  v_sub_f32 v37, v37, v4
  v_sub_f32 v38, v38, v4
  v_sub_f32 v39, v39, v4
  v_sub_f32 v40, v40, v4
  v_sub_f32 v41, v41, v4
  v_sub_f32 v42, v42, v4
  v_sub_f32 v43, v43, v4
  v_sub_f32 v44, v44, v4
  v_sub_f32 v45, v45, v4
  v_sub_f32 v46, v46, v4
  v_sub_f32 v47, v47, v4
  v_sub_f32 v48, v48, v4
  v_sub_f32 v49, v49, v4
  v_sub_f32 v50, v50, v4
  v_sub_f32 v51, v51, v4
  v_sub_f32 v52, v52, v4
  v_sub_f32 v53, v53, v4
  v_sub_f32 v54, v54, v4
  v_sub_f32 v55, v55, v4
  v_sub_f32 v56, v56, v4
  v_sub_f32 v57, v57, v4
  v_sub_f32 v58, v58, v4
  v_sub_f32 v59, v59, v4
  v_sub_f32 v60, v60, v4
  v_sub_f32 v61, v61, v4
  v_sub_f32 v62, v62, v4
  v_sub_f32 v63, v63, v4
  v_sub_f32 v64, v64, v4
  v_sub_f32 v65, v65, v4
  v_sub_f32 v66, v66, v4
  v_sub_f32 v67, v67, v4
  v_mul_f32 v6, v28, v28
  v_mul_f32 v7, v29, v29
  v_fmac_f32 v6, v30, v30
  v_fmac_f32 v7, v31, v31
  v_fmac_f32 v6, v32, v32
  v_fmac_f32 v7, v33, v33
  v_fmac_f32 v6, v34, v34
  v_fmac_f32 v7, v35, v35
  v_fmac_f32 v6, v36, v36
  v_fmac_f32 v7, v37, v37
  v_fmac_f32 v6, v38, v38
  v_fmac_f32 v7, v39, v39
  v_fmac_f32 v6, v40, v40
  v_fmac_f32 v7, v41, v41
  v_fmac_f32 v6, v42, v42
  v_fmac_f32 v7, v43, v43
  v_fmac_f32 v6, v44, v44
  v_fmac_f32 v7, v45, v45
  v_fmac_f32 v6, v46, v46
  v_fmac_f32 v7, v47, v47
  v_fmac_f32 v6, v48, v48
  v_fmac_f32 v7, v49, v49
  v_fmac_f32 v6, v50, v50
  v_fmac_f32 v7, v51, v51
  v_fmac_f32 v6, v52, v52
  v_fmac_f32 v7, v53, v53
  v_fmac_f32 v6, v54, v54
  v_fmac_f32 v7, v55, v55
  v_fmac_f32 v6, v56, v56
  v_fmac_f32 v7, v57, v57
  v_fmac_f32 v6, v58, v58
  v_fmac_f32 v7, v59, v59
  v_fmac_f32 v6, v60, v60
  v_fmac_f32 v7, v61, v61
  v_fmac_f32 v6, v62, v62
  v_fmac_f32 v7, v63, v63
  v_fmac_f32 v6, v64, v64
  v_fmac_f32 v7, v65, v65
  v_fmac_f32 v6, v66, v66
  v_fmac_f32 v7, v67, v67
  v_add_f32 v4, v6, v7
  v_mov_b32 v2, v4
  s_nop 1
  v_permlane32_swap_b32 v4, v2
  v_add_f32 v4, v4, v2
  v_mov_b32 v2, v4
  s_nop 1
  v_permlane16_swap_b32 v4, v2
  v_add_f32 v4, v4, v2
  ds_write_b32 v1, v4 offset:256
  s_waitcnt lgkmcnt(0)
  s_barrier
  ds_read_b32 v4, v5 offset:256
  ds_read_b32 v2, v5 offset:320
  ds_read_b32 v3, v5 offset:384
  ds_read_b32 v6, v5 offset:448
  s_waitcnt lgkmcnt(0)
  v_add_f32 v4, v4, v2
  v_add_f32 v3, v3, v6
  v_add_f32 v4, v4, v3
  v_mov_b32 v2, 0x3727c5ac
  v_fmac_f32 v2, 0x3acccccd, v4
  v_rsq_f32 v4, v2
  s_nop 0
  v_mul_f32 v28, v28, v4
  v_mul_f32 v29, v29, v4
  v_mul_f32 v30, v30, v4
  v_mul_f32 v31, v31, v4
  v_mul_f32 v32, v32, v4
  v_mul_f32 v33, v33, v4
  v_mul_f32 v34, v34, v4
  v_mul_f32 v35, v35, v4
  v_mul_f32 v36, v36, v4
  v_mul_f32 v37, v37, v4
  v_mul_f32 v38, v38, v4
  v_mul_f32 v39, v39, v4
  v_mul_f32 v40, v40, v4
  v_mul_f32 v41, v41, v4
  v_mul_f32 v42, v42, v4
  v_mul_f32 v43, v43, v4
  v_mul_f32 v44, v44, v4
  v_mul_f32 v45, v45, v4
  v_mul_f32 v46, v46, v4
  v_mul_f32 v47, v47, v4
  v_mul_f32 v48, v48, v4
  v_mul_f32 v49, v49, v4
  v_mul_f32 v50, v50, v4
  v_mul_f32 v51, v51, v4
  v_mul_f32 v52, v52, v4
  v_mul_f32 v53, v53, v4
  v_mul_f32 v54, v54, v4
  v_mul_f32 v55, v55, v4
  v_mul_f32 v56, v56, v4
  v_mul_f32 v57, v57, v4
  v_mul_f32 v58, v58, v4
  v_mul_f32 v59, v59, v4
  v_mul_f32 v60, v60, v4
  v_mul_f32 v61, v61, v4
  v_mul_f32 v62, v62, v4
  v_mul_f32 v63, v63, v4
  v_mul_f32 v64, v64, v4
  v_mul_f32 v65, v65, v4
  v_mul_f32 v66, v66, v4
  v_mul_f32 v67, v67, v4
  v_cvt_pk_bf16_f32 v8, v28, v29
  v_cvt_pk_bf16_f32 v9, v30, v31
  v_cvt_pk_bf16_f32 v10, v32, v33
  v_cvt_pk_bf16_f32 v11, v34, v35
  v_cvt_pk_bf16_f32 v12, v36, v37
  v_cvt_pk_bf16_f32 v13, v38, v39
  v_cvt_pk_bf16_f32 v14, v40, v41
  v_cvt_pk_bf16_f32 v15, v42, v43
  v_cvt_pk_bf16_f32 v16, v44, v45
  v_cvt_pk_bf16_f32 v17, v46, v47
  v_cvt_pk_bf16_f32 v18, v48, v49
  v_cvt_pk_bf16_f32 v19, v50, v51
  v_cvt_pk_bf16_f32 v20, v52, v53
  v_cvt_pk_bf16_f32 v21, v54, v55
  v_cvt_pk_bf16_f32 v22, v56, v57
  v_cvt_pk_bf16_f32 v23, v58, v59
  v_cvt_pk_bf16_f32 v24, v60, v61
  v_cvt_pk_bf16_f32 v25, v62, v63
  v_cvt_pk_bf16_f32 v26, v64, v65
  v_cvt_pk_bf16_f32 v27, v66, v67
  v_and_b32 v3, 63, v0
  v_lshlrev_b32 v1, 4, v3
  s_mul_i32 s17, s2, 20480
  s_mul_i32 s18, s16, 5120
  s_add_u32 s17, s17, s18
  s_add_u32 s17, s17, 84934656
  buffer_store_dwordx4 v[8:11], v1, s[4:7], s17 offen offset:0 sc1
  buffer_store_dwordx4 v[12:15], v1, s[4:7], s17 offen offset:1024 sc1
  buffer_store_dwordx4 v[16:19], v1, s[4:7], s17 offen offset:2048 sc1
  buffer_store_dwordx4 v[20:23], v1, s[4:7], s17 offen offset:3072 sc1
  s_add_u32 s17, s17, 4096
  buffer_store_dwordx4 v[24:27], v1, s[4:7], s17 offen offset:0 sc1
  s_endpgm
prep_notln5:
  s_sub_u32 s2, s2, 128
  s_cmp_ge_u32 s2, 2240
  s_cbranch_scc1 prep_exit1
  s_load_dwordx2 s[12:13], s[0:1], 96
  s_load_dwordx4 s[16:19], s[0:1], 16
  s_load_dwordx4 s[20:23], s[0:1], 32
  s_load_dwordx4 s[24:27], s[0:1], 64
  v_lshrrev_b32 v6, 6, v0
  v_and_b32 v1, 63, v0
  s_nop 0
  v_readfirstlane_b32 s14, v6
  v_lshlrev_b32 v5, 4, v1
  s_lshl_b32 s15, s2, 2
  s_nop 1
  s_add_u32 s15, s15, s14
  s_add_u32 s28, s15, 7680
  s_sub_u32 s29, s15, 1280
  s_cmp_lt_u32 s15, 1280
  s_cselect_b32 s15, s28, s29
  s_waitcnt lgkmcnt(0)
  s_mov_b32 s4, s12
  s_mov_b32 s5, s13
  s_mov_b32 s6, 0x10000000
  s_mov_b32 s7, 0x20000
  s_mov_b32 s11, 0x20000
  v_and_b32 v2, 15, v1
  v_lshrrev_b32 v3, 4, v1
  s_cmp_ge_u32 s15, 5760
  s_cbranch_scc1 prep_s22
  s_mul_hi_u32 s31, s15, 2236963
  s_mul_i32 s32, s31, 1920
  s_sub_u32 s32, s15, s32
  s_mul_hi_u32 s33, s32, 214748365
  s_mul_i32 s34, s33, 20
  s_sub_u32 s34, s32, s34
  s_cmp_eq_u32 s31, 0
  s_cselect_b32 s8, s16, s18
  s_cselect_b32 s9, s17, s19
  s_cmp_eq_u32 s31, 2
  s_cselect_b32 s8, s20, s8
  s_cselect_b32 s9, s21, s9
  s_mov_b32 s10, 7864320
  s_mul_i32 s35, s31, 7864320
  s_add_u32 s35, s35, 6291456
  v_lshrrev_b32 v6, 3, v1
  s_lshl_b32 s36, s34, 5
  v_add_u32 v6, s36, v6
  s_mov_b32 s37, 12288
  v_mul_lo_u32 v4, v6, s37
  s_lshl_b32 s36, s33, 7
  v_and_b32 v6, 7, v1
  v_lshl_add_u32 v4, v6, 4, v4
  v_add_u32 v4, s36, v4
  v_lshrrev_b32 v6, 3, v1
  v_mul_u32_u24 v12, 144, v6
  v_and_b32 v6, 7, v1
  v_lshl_add_u32 v12, v6, 4, v12
  s_mul_i32 s36, s14, 4608
  s_add_u32 s36, s36, 512
  v_add_u32 v12, s36, v12
  s_mov_b32 s29, 0
  buffer_load_dwordx4 v[16:19], v4, s[8:11], s29 offen
  s_mov_b32 s29, 98304
  buffer_load_dwordx4 v[20:23], v4, s[8:11], s29 offen
  s_mov_b32 s29, 196608
  buffer_load_dwordx4 v[24:27], v4, s[8:11], s29 offen
  s_mov_b32 s29, 294912
  buffer_load_dwordx4 v[28:31], v4, s[8:11], s29 offen
  v_bfe_u32 v6, v1, 2, 2
  v_lshlrev_b32 v13, 3, v3
  v_add_u32 v13, v13, v6
  v_mul_u32_u24 v13, 144, v13
  v_and_b32 v6, 3, v1
  v_lshl_add_u32 v13, v6, 3, v13
  v_add_u32 v13, s36, v13
  s_waitcnt vmcnt(3)
  ds_write_b128 v12, v[16:19] offset:0
  s_waitcnt vmcnt(2)
  ds_write_b128 v12, v[20:23] offset:1152
  s_waitcnt vmcnt(1)
  ds_write_b128 v12, v[24:27] offset:2304
  s_waitcnt vmcnt(0)
  ds_write_b128 v12, v[28:31] offset:3456
  s_waitcnt lgkmcnt(0)
  ds_read_b64_tr_b16 v[48:49], v13 offset:0
  ds_read_b64_tr_b16 v[50:51], v13 offset:576
  ds_read_b64_tr_b16 v[52:53], v13 offset:32
  ds_read_b64_tr_b16 v[54:55], v13 offset:608
  ds_read_b64_tr_b16 v[56:57], v13 offset:64
  ds_read_b64_tr_b16 v[58:59], v13 offset:640
  ds_read_b64_tr_b16 v[60:61], v13 offset:96
  ds_read_b64_tr_b16 v[62:63], v13 offset:672
  s_waitcnt lgkmcnt(6)
  s_lshl_b32 s30, s33, 2
  s_add_u32 s30, s30, 0
  s_mul_i32 s30, s30, 20
  s_add_u32 s30, s30, s34
  s_lshl_b32 s30, s30, 10
  s_add_u32 s30, s30, s35
  buffer_store_dwordx4 v[48:51], v5, s[4:7], s30 offen sc1
  s_waitcnt lgkmcnt(4)
  s_lshl_b32 s30, s33, 2
  s_add_u32 s30, s30, 1
  s_mul_i32 s30, s30, 20
  s_add_u32 s30, s30, s34
  s_lshl_b32 s30, s30, 10
  s_add_u32 s30, s30, s35
  buffer_store_dwordx4 v[52:55], v5, s[4:7], s30 offen sc1
  s_waitcnt lgkmcnt(2)
  s_lshl_b32 s30, s33, 2
  s_add_u32 s30, s30, 2
  s_mul_i32 s30, s30, 20
  s_add_u32 s30, s30, s34
  s_lshl_b32 s30, s30, 10
  s_add_u32 s30, s30, s35
  buffer_store_dwordx4 v[56:59], v5, s[4:7], s30 offen sc1
  s_waitcnt lgkmcnt(0)
  s_lshl_b32 s30, s33, 2
  s_add_u32 s30, s30, 3
  s_mul_i32 s30, s30, 20
  s_add_u32 s30, s30, s34
  s_lshl_b32 s30, s30, 10
  s_add_u32 s30, s30, s35
  buffer_store_dwordx4 v[60:63], v5, s[4:7], s30 offen sc1
  s_branch prep_exit1
prep_s22:
  s_sub_u32 s15, s15, 5760
  s_cmp_ge_u32 s15, 1920
  s_cbranch_scc1 prep_s33
  s_mul_hi_u32 s33, s15, 22369622
  s_mul_i32 s34, s33, 192
  s_sub_u32 s34, s15, s34
  s_mov_b32 s8, s22
  s_mov_b32 s9, s23
  s_mov_b32 s10, 7864320
  v_lshrrev_b32 v6, 3, v1
  s_lshl_b32 s36, s34, 5
  v_add_u32 v6, s36, v6
  v_mul_u32_u24 v4, 1280, v6
  s_lshl_b32 s36, s33, 7
  v_and_b32 v6, 7, v1
  v_lshl_add_u32 v4, v6, 4, v4
  v_add_u32 v4, s36, v4
  v_lshrrev_b32 v6, 3, v1
  v_mul_u32_u24 v12, 144, v6
  v_and_b32 v6, 7, v1
  v_lshl_add_u32 v12, v6, 4, v12
  s_mul_i32 s36, s14, 4608
  s_add_u32 s36, s36, 512
  v_add_u32 v12, s36, v12
  s_mov_b32 s29, 0
  buffer_load_dwordx4 v[16:19], v4, s[8:11], s29 offen
  s_mov_b32 s29, 10240
  buffer_load_dwordx4 v[20:23], v4, s[8:11], s29 offen
  s_mov_b32 s29, 20480
  buffer_load_dwordx4 v[24:27], v4, s[8:11], s29 offen
  s_mov_b32 s29, 30720
  buffer_load_dwordx4 v[28:31], v4, s[8:11], s29 offen
  v_bfe_u32 v6, v1, 2, 2
  v_lshlrev_b32 v13, 2, v3
  v_add_u32 v13, v13, v6
  v_mul_u32_u24 v13, 144, v13
  v_and_b32 v6, 3, v1
  v_lshl_add_u32 v13, v6, 4, v13
  v_add_u32 v13, s36, v13
  s_waitcnt vmcnt(3)
  ds_write_b128 v12, v[16:19] offset:0
  s_waitcnt vmcnt(2)
  ds_write_b128 v12, v[20:23] offset:1152
  s_waitcnt vmcnt(1)
  ds_write_b128 v12, v[24:27] offset:2304
  s_waitcnt vmcnt(0)
  ds_write_b128 v12, v[28:31] offset:3456
  s_waitcnt lgkmcnt(0)
  ds_read_b64_tr_b16 v[48:49], v13 offset:0
  ds_read_b64_tr_b16 v[50:51], v13 offset:2304
  ds_read_b64_tr_b16 v[52:53], v13 offset:8
  ds_read_b64_tr_b16 v[54:55], v13 offset:2312
  ds_read_b64_tr_b16 v[56:57], v13 offset:64
  ds_read_b64_tr_b16 v[58:59], v13 offset:2368
  ds_read_b64_tr_b16 v[60:61], v13 offset:72
  ds_read_b64_tr_b16 v[62:63], v13 offset:2376
  s_waitcnt lgkmcnt(6)
  s_lshl_b32 s30, s33, 2
  s_add_u32 s30, s30, 0
  s_mul_i32 s30, s30, 192
  s_add_u32 s30, s30, s34
  s_lshl_b32 s30, s30, 10
  s_add_u32 s30, s30, 29884416
  buffer_store_dwordx4 v[48:51], v5, s[4:7], s30 offen sc1
  s_waitcnt lgkmcnt(4)
  s_lshl_b32 s30, s33, 2
  s_add_u32 s30, s30, 1
  s_mul_i32 s30, s30, 192
  s_add_u32 s30, s30, s34
  s_lshl_b32 s30, s30, 10
  s_add_u32 s30, s30, 29884416
  buffer_store_dwordx4 v[52:55], v5, s[4:7], s30 offen sc1
  s_waitcnt lgkmcnt(2)
  s_lshl_b32 s30, s33, 2
  s_add_u32 s30, s30, 2
  s_mul_i32 s30, s30, 192
  s_add_u32 s30, s30, s34
  s_lshl_b32 s30, s30, 10
  s_add_u32 s30, s30, 29884416
  buffer_store_dwordx4 v[56:59], v5, s[4:7], s30 offen sc1
  s_waitcnt lgkmcnt(0)
  s_lshl_b32 s30, s33, 2
  s_add_u32 s30, s30, 3
  s_mul_i32 s30, s30, 192
  s_add_u32 s30, s30, s34
  s_lshl_b32 s30, s30, 10
  s_add_u32 s30, s30, 29884416
  buffer_store_dwordx4 v[60:63], v5, s[4:7], s30 offen sc1
  s_branch prep_exit1
prep_s33:
  s_sub_u32 s15, s15, 1920
  s_cmp_ge_u32 s15, 960
  s_cbranch_scc1 prep_s44
  s_mul_hi_u32 s33, s15, 107374183
  s_mul_i32 s34, s33, 40
  s_sub_u32 s34, s15, s34
  s_mov_b32 s8, s24
  s_mov_b32 s9, s25
  s_mov_b32 s10, 2457600
  v_lshrrev_b32 v6, 5, v1
  v_lshlrev_b32 v6, 3, v6
  s_lshl_b32 s36, s34, 4
  v_add_u32 v6, s36, v6
  v_mul_u32_u24 v4, 3840, v6
  v_and_b32 v6, 31, v1
  v_lshl_add_u32 v4, v6, 1, v4
  s_mul_i32 s36, s33, 160
  v_add_u32 v4, s36, v4
  v_cmp_gt_u32 vcc, 20, v6
  v_mov_b32 v6, 0x80000000
  s_nop 0
  v_cndmask_b32 v4, v6, v4, vcc
  s_mov_b32 s29, 0
  buffer_load_ushort v16, v4, s[8:11], s29 offen
  s_mov_b32 s29, 3840
  buffer_load_ushort v17, v4, s[8:11], s29 offen
  s_mov_b32 s29, 7680
  buffer_load_ushort v18, v4, s[8:11], s29 offen
  s_mov_b32 s29, 11520
  buffer_load_ushort v19, v4, s[8:11], s29 offen
  s_mov_b32 s29, 15360
  buffer_load_ushort v20, v4, s[8:11], s29 offen
  s_mov_b32 s29, 19200
  buffer_load_ushort v21, v4, s[8:11], s29 offen
  s_mov_b32 s29, 23040
  buffer_load_ushort v22, v4, s[8:11], s29 offen
  s_mov_b32 s29, 26880
  buffer_load_ushort v23, v4, s[8:11], s29 offen
  s_mov_b32 s29, 40
  buffer_load_ushort v24, v4, s[8:11], s29 offen
  s_mov_b32 s29, 3880
  buffer_load_ushort v25, v4, s[8:11], s29 offen
  s_mov_b32 s29, 7720
  buffer_load_ushort v26, v4, s[8:11], s29 offen
  s_mov_b32 s29, 11560
  buffer_load_ushort v27, v4, s[8:11], s29 offen
  s_mov_b32 s29, 15400
  buffer_load_ushort v28, v4, s[8:11], s29 offen
  s_mov_b32 s29, 19240
  buffer_load_ushort v29, v4, s[8:11], s29 offen
  s_mov_b32 s29, 23080
  buffer_load_ushort v30, v4, s[8:11], s29 offen
  s_mov_b32 s29, 26920
  buffer_load_ushort v31, v4, s[8:11], s29 offen
  s_mov_b32 s29, 80
  buffer_load_ushort v32, v4, s[8:11], s29 offen
  s_mov_b32 s29, 3920
  buffer_load_ushort v33, v4, s[8:11], s29 offen
  s_mov_b32 s29, 7760
  buffer_load_ushort v34, v4, s[8:11], s29 offen
  s_mov_b32 s29, 11600
  buffer_load_ushort v35, v4, s[8:11], s29 offen
  s_mov_b32 s29, 15440
  buffer_load_ushort v36, v4, s[8:11], s29 offen
  s_mov_b32 s29, 19280
  buffer_load_ushort v37, v4, s[8:11], s29 offen
  s_mov_b32 s29, 23120
  buffer_load_ushort v38, v4, s[8:11], s29 offen
  s_mov_b32 s29, 26960
  buffer_load_ushort v39, v4, s[8:11], s29 offen
  s_mov_b32 s29, 120
  buffer_load_ushort v40, v4, s[8:11], s29 offen
  s_mov_b32 s29, 3960
  buffer_load_ushort v41, v4, s[8:11], s29 offen
  s_mov_b32 s29, 7800
  buffer_load_ushort v42, v4, s[8:11], s29 offen
  s_mov_b32 s29, 11640
  buffer_load_ushort v43, v4, s[8:11], s29 offen
  s_mov_b32 s29, 15480
  buffer_load_ushort v44, v4, s[8:11], s29 offen
  s_mov_b32 s29, 19320
  buffer_load_ushort v45, v4, s[8:11], s29 offen
  s_mov_b32 s29, 23160
  buffer_load_ushort v46, v4, s[8:11], s29 offen
  s_mov_b32 s29, 27000
  buffer_load_ushort v47, v4, s[8:11], s29 offen
  s_waitcnt vmcnt(24)
  v_lshl_or_b32 v48, v17, 16, v16
  v_lshl_or_b32 v49, v19, 16, v18
  v_lshl_or_b32 v50, v21, 16, v20
  v_lshl_or_b32 v51, v23, 16, v22
  s_lshl_b32 s30, s33, 2
  s_add_u32 s30, s30, 0
  s_mul_i32 s30, s30, 40
  s_add_u32 s30, s30, s34
  s_lshl_b32 s30, s30, 10
  s_add_u32 s30, s30, 87556096
  buffer_store_dwordx4 v[48:51], v5, s[4:7], s30 offen sc1
  s_waitcnt vmcnt(17)
  v_lshl_or_b32 v52, v25, 16, v24
  v_lshl_or_b32 v53, v27, 16, v26
  v_lshl_or_b32 v54, v29, 16, v28
  v_lshl_or_b32 v55, v31, 16, v30
  s_lshl_b32 s30, s33, 2
  s_add_u32 s30, s30, 1
  s_mul_i32 s30, s30, 40
  s_add_u32 s30, s30, s34
  s_lshl_b32 s30, s30, 10
  s_add_u32 s30, s30, 87556096
  buffer_store_dwordx4 v[52:55], v5, s[4:7], s30 offen sc1
  s_waitcnt vmcnt(10)
  v_lshl_or_b32 v56, v33, 16, v32
  v_lshl_or_b32 v57, v35, 16, v34
  v_lshl_or_b32 v58, v37, 16, v36
  v_lshl_or_b32 v59, v39, 16, v38
  s_lshl_b32 s30, s33, 2
  s_add_u32 s30, s30, 2
  s_mul_i32 s30, s30, 40
  s_add_u32 s30, s30, s34
  s_lshl_b32 s30, s30, 10
  s_add_u32 s30, s30, 87556096
  buffer_store_dwordx4 v[56:59], v5, s[4:7], s30 offen sc1
  s_waitcnt vmcnt(3)
  v_lshl_or_b32 v60, v41, 16, v40
  v_lshl_or_b32 v61, v43, 16, v42
  v_lshl_or_b32 v62, v45, 16, v44
  v_lshl_or_b32 v63, v47, 16, v46
  s_lshl_b32 s30, s33, 2
  s_add_u32 s30, s30, 3
  s_mul_i32 s30, s30, 40
  s_add_u32 s30, s30, s34
  s_lshl_b32 s30, s30, 10
  s_add_u32 s30, s30, 87556096
  buffer_store_dwordx4 v[60:63], v5, s[4:7], s30 offen sc1
  s_branch prep_exit1
prep_s44:
  s_sub_u32 s15, s15, 960
  s_mul_hi_u32 s33, s15, 134217728
  s_and_b32 s34, s15, 31
  s_lshr_b32 s33, s15, 5
  s_mov_b32 s8, s26
  s_mov_b32 s9, s27
  s_mov_b32 s10, 819200
  v_lshrrev_b32 v6, 1, v3
  v_lshlrev_b32 v6, 4, v6
  v_and_b32 v7, 1, v3
  v_lshl_add_u32 v6, v7, 2, v6
  v_mov_b32 v8, v6
  s_mul_i32 s36, s34, 20
  v_add_u32 v6, s36, v6
  v_mul_u32_u24 v4, 1280, v6
  v_lshrrev_b32 v6, 2, v2
  v_lshl_add_u32 v4, v6, 4, v4
  v_and_b32 v6, 3, v2
  v_lshl_add_u32 v4, v6, 1, v4
  s_lshl_b32 s36, s33, 7
  v_add_u32 v4, s36, v4
  v_mov_b32 v9, 0x80000000
  v_cmp_gt_u32 vcc, 17, v8
  s_nop 1
  v_cndmask_b32 v10, v9, v4, vcc
  v_cmp_gt_u32 vcc, 9, v8
  s_nop 1
  v_cndmask_b32 v11, v9, v4, vcc
  s_mov_b32 s29, 0
  buffer_load_ushort v16, v10, s[8:11], s29 offen
  s_mov_b32 s29, 1280
  buffer_load_ushort v17, v10, s[8:11], s29 offen
  s_mov_b32 s29, 2560
  buffer_load_ushort v18, v10, s[8:11], s29 offen
  s_mov_b32 s29, 3840
  buffer_load_ushort v19, v10, s[8:11], s29 offen
  s_mov_b32 s29, 10240
  buffer_load_ushort v20, v11, s[8:11], s29 offen
  s_mov_b32 s29, 11520
  buffer_load_ushort v21, v11, s[8:11], s29 offen
  s_mov_b32 s29, 12800
  buffer_load_ushort v22, v11, s[8:11], s29 offen
  s_mov_b32 s29, 14080
  buffer_load_ushort v23, v11, s[8:11], s29 offen
  s_mov_b32 s29, 8
  buffer_load_ushort v24, v10, s[8:11], s29 offen
  s_mov_b32 s29, 1288
  buffer_load_ushort v25, v10, s[8:11], s29 offen
  s_mov_b32 s29, 2568
  buffer_load_ushort v26, v10, s[8:11], s29 offen
  s_mov_b32 s29, 3848
  buffer_load_ushort v27, v10, s[8:11], s29 offen
  s_mov_b32 s29, 10248
  buffer_load_ushort v28, v11, s[8:11], s29 offen
  s_mov_b32 s29, 11528
  buffer_load_ushort v29, v11, s[8:11], s29 offen
  s_mov_b32 s29, 12808
  buffer_load_ushort v30, v11, s[8:11], s29 offen
  s_mov_b32 s29, 14088
  buffer_load_ushort v31, v11, s[8:11], s29 offen
  s_mov_b32 s29, 64
  buffer_load_ushort v32, v10, s[8:11], s29 offen
  s_mov_b32 s29, 1344
  buffer_load_ushort v33, v10, s[8:11], s29 offen
  s_mov_b32 s29, 2624
  buffer_load_ushort v34, v10, s[8:11], s29 offen
  s_mov_b32 s29, 3904
  buffer_load_ushort v35, v10, s[8:11], s29 offen
  s_mov_b32 s29, 10304
  buffer_load_ushort v36, v11, s[8:11], s29 offen
  s_mov_b32 s29, 11584
  buffer_load_ushort v37, v11, s[8:11], s29 offen
  s_mov_b32 s29, 12864
  buffer_load_ushort v38, v11, s[8:11], s29 offen
  s_mov_b32 s29, 14144
  buffer_load_ushort v39, v11, s[8:11], s29 offen
  s_mov_b32 s29, 72
  buffer_load_ushort v40, v10, s[8:11], s29 offen
  s_mov_b32 s29, 1352
  buffer_load_ushort v41, v10, s[8:11], s29 offen
  s_mov_b32 s29, 2632
  buffer_load_ushort v42, v10, s[8:11], s29 offen
  s_mov_b32 s29, 3912
  buffer_load_ushort v43, v10, s[8:11], s29 offen
  s_mov_b32 s29, 10312
  buffer_load_ushort v44, v11, s[8:11], s29 offen
  s_mov_b32 s29, 11592
  buffer_load_ushort v45, v11, s[8:11], s29 offen
  s_mov_b32 s29, 12872
  buffer_load_ushort v46, v11, s[8:11], s29 offen
  s_mov_b32 s29, 14152
  buffer_load_ushort v47, v11, s[8:11], s29 offen
  s_waitcnt vmcnt(24)
  v_lshl_or_b32 v48, v17, 16, v16
  v_lshl_or_b32 v49, v19, 16, v18
  v_lshl_or_b32 v50, v21, 16, v20
  v_lshl_or_b32 v51, v23, 16, v22
  s_lshl_b32 s30, s33, 2
  s_add_u32 s30, s30, 0
  s_lshl_b32 s30, s30, 5
  s_add_u32 s30, s30, s34
  s_lshl_b32 s30, s30, 10
  s_add_u32 s30, s30, 91488256
  buffer_store_dwordx4 v[48:51], v5, s[4:7], s30 offen sc1
  s_waitcnt vmcnt(17)
  v_lshl_or_b32 v52, v25, 16, v24
  v_lshl_or_b32 v53, v27, 16, v26
  v_lshl_or_b32 v54, v29, 16, v28
  v_lshl_or_b32 v55, v31, 16, v30
  s_lshl_b32 s30, s33, 2
  s_add_u32 s30, s30, 1
  s_lshl_b32 s30, s30, 5
  s_add_u32 s30, s30, s34
  s_lshl_b32 s30, s30, 10
  s_add_u32 s30, s30, 91488256
  buffer_store_dwordx4 v[52:55], v5, s[4:7], s30 offen sc1
  s_waitcnt vmcnt(10)
  v_lshl_or_b32 v56, v33, 16, v32
  v_lshl_or_b32 v57, v35, 16, v34
  v_lshl_or_b32 v58, v37, 16, v36
  v_lshl_or_b32 v59, v39, 16, v38
  s_lshl_b32 s30, s33, 2
  s_add_u32 s30, s30, 2
  s_lshl_b32 s30, s30, 5
  s_add_u32 s30, s30, s34
  s_lshl_b32 s30, s30, 10
  s_add_u32 s30, s30, 91488256
  buffer_store_dwordx4 v[56:59], v5, s[4:7], s30 offen sc1
  s_waitcnt vmcnt(3)
  v_lshl_or_b32 v60, v41, 16, v40
  v_lshl_or_b32 v61, v43, 16, v42
  v_lshl_or_b32 v62, v45, 16, v44
  v_lshl_or_b32 v63, v47, 16, v46
  s_lshl_b32 s30, s33, 2
  s_add_u32 s30, s30, 3
  s_lshl_b32 s30, s30, 5
  s_add_u32 s30, s30, s34
  s_lshl_b32 s30, s30, 10
  s_add_u32 s30, s30, 91488256
  buffer_store_dwordx4 v[60:63], v5, s[4:7], s30 offen sc1
prep_exit1:
  s_endpgm
.globl ln2_kernel
.p2align 8
.type ln2_kernel,@function
ln2_kernel:
  s_cmp_ge_u32 s2, 128
  s_cbranch_scc1 ln2_exit1
  s_load_dwordx2 s[12:13], s[0:1], 96
  s_load_dwordx2 s[14:15], s[0:1], 0
  v_lshrrev_b32 v2, 6, v0
  v_and_b32 v3, 63, v0
  s_nop 0
  v_readfirstlane_b32 s16, v2
  s_waitcnt lgkmcnt(0)
  s_mov_b32 s4, s12
  s_mov_b32 s5, s13
  s_mov_b32 s6, 0x10000000
  s_mov_b32 s7, 0x20000
  s_mov_b32 s8, s12
  s_mov_b32 s9, s13
  s_mov_b32 s10, 0x10000000
  s_mov_b32 s11, 0x20000
  s_mov_b32 s20, 82313216
  v_and_b32 v2, 15, v3
  v_lshrrev_b32 v4, 4, v3
  s_lshl_b32 s17, s2, 4
  v_add_u32 v1, s17, v2
  v_mul_u32_u24 v1, 1280, v1
  v_lshl_add_u32 v1, v4, 4, v1
  s_mul_i32 s17, s16, 320
  s_add_u32 s20, s20, s17
  buffer_load_dwordx4 v[8:11], v1, s[8:11], s20 offen offset:0
  buffer_load_dwordx4 v[12:15], v1, s[8:11], s20 offen offset:64
  buffer_load_dwordx4 v[16:19], v1, s[8:11], s20 offen offset:128
  buffer_load_dwordx4 v[20:23], v1, s[8:11], s20 offen offset:192
  buffer_load_dwordx4 v[24:27], v1, s[8:11], s20 offen offset:256
  s_sub_u32 s21, 0, s12
  s_and_b32 s21, s21, 0x1fffff
  s_add_u32 s21, s21, 2097152
  v_mov_b32 v68, -1
  v_mov_b32 v69, -1
  v_mov_b32 v70, -1
  v_mov_b32 v71, -1
  v_lshlrev_b32 v72, 4, v0
  s_mul_i32 s22, s2, 12096
  s_add_u32 s22, s22, 0
  s_mul_i32 s23, s2, 12288
  s_add_u32 s23, s23, s21
  buffer_store_dwordx4 v[68:71], v72, s[4:7], s22 offen sc1
  s_add_u32 s22, s22, 4096
  buffer_store_dwordx4 v[68:71], v72, s[4:7], s22 offen sc1
  s_add_u32 s22, s22, 4096
  v_mov_b32 v73, 0x80000000
  v_cmp_gt_u32 vcc, 244, v0
  s_nop 1
  v_cndmask_b32 v73, v73, v72, vcc
  buffer_store_dwordx4 v[68:71], v73, s[4:7], s22 offen
  buffer_store_dwordx4 v[68:71], v72, s[4:7], s23 offen sc1
  s_add_u32 s23, s23, 4096
  buffer_store_dwordx4 v[68:71], v72, s[4:7], s23 offen sc1
  s_add_u32 s23, s23, 4096
  buffer_store_dwordx4 v[68:71], v72, s[4:7], s23 offen sc1
  s_add_u32 s23, s23, 4096
  s_mul_i32 s23, s2, 2048
  s_add_u32 s23, s23, s21
  s_add_u32 s23, s23, 1572864
  v_mov_b32 v73, 0x80000000
  v_cmp_gt_u32 vcc, 128, v0
  s_nop 1
  v_cndmask_b32 v73, v73, v72, vcc
  buffer_store_dwordx4 v[68:71], v73, s[4:7], s23 offen sc1
  v_lshlrev_b32 v5, 2, v2
  s_lshl_b32 s17, s16, 6
  v_add_u32 v1, s17, v5
  s_waitcnt vmcnt(7)
  v_lshlrev_b32 v28, 16, v8
  v_and_b32 v29, 0xffff0000, v8
  v_lshlrev_b32 v30, 16, v9
  v_and_b32 v31, 0xffff0000, v9
  v_lshlrev_b32 v32, 16, v10
  v_and_b32 v33, 0xffff0000, v10
  v_lshlrev_b32 v34, 16, v11
  v_and_b32 v35, 0xffff0000, v11
  v_lshlrev_b32 v36, 16, v12
  v_and_b32 v37, 0xffff0000, v12
  v_lshlrev_b32 v38, 16, v13
  v_and_b32 v39, 0xffff0000, v13
  v_lshlrev_b32 v40, 16, v14
  v_and_b32 v41, 0xffff0000, v14
  v_lshlrev_b32 v42, 16, v15
  v_and_b32 v43, 0xffff0000, v15
  v_lshlrev_b32 v44, 16, v16
  v_and_b32 v45, 0xffff0000, v16
  v_lshlrev_b32 v46, 16, v17
  v_and_b32 v47, 0xffff0000, v17
  v_lshlrev_b32 v48, 16, v18
  v_and_b32 v49, 0xffff0000, v18
  v_lshlrev_b32 v50, 16, v19
  v_and_b32 v51, 0xffff0000, v19
  v_lshlrev_b32 v52, 16, v20
  v_and_b32 v53, 0xffff0000, v20
  v_lshlrev_b32 v54, 16, v21
  v_and_b32 v55, 0xffff0000, v21
  v_lshlrev_b32 v56, 16, v22
  v_and_b32 v57, 0xffff0000, v22
  v_lshlrev_b32 v58, 16, v23
  v_and_b32 v59, 0xffff0000, v23
  v_lshlrev_b32 v60, 16, v24
  v_and_b32 v61, 0xffff0000, v24
  v_lshlrev_b32 v62, 16, v25
  v_and_b32 v63, 0xffff0000, v25
  v_lshlrev_b32 v64, 16, v26
  v_and_b32 v65, 0xffff0000, v26
  v_lshlrev_b32 v66, 16, v27
  v_and_b32 v67, 0xffff0000, v27
  v_pk_add_f32 v[6:7], v[28:29], v[30:31]
  v_pk_add_f32 v[6:7], v[6:7], v[32:33]
  v_pk_add_f32 v[6:7], v[6:7], v[34:35]
  v_pk_add_f32 v[6:7], v[6:7], v[36:37]
  v_pk_add_f32 v[6:7], v[6:7], v[38:39]
  v_pk_add_f32 v[6:7], v[6:7], v[40:41]
  v_pk_add_f32 v[6:7], v[6:7], v[42:43]
  v_pk_add_f32 v[6:7], v[6:7], v[44:45]
  v_pk_add_f32 v[6:7], v[6:7], v[46:47]
  v_pk_add_f32 v[6:7], v[6:7], v[48:49]
  v_pk_add_f32 v[6:7], v[6:7], v[50:51]
  v_pk_add_f32 v[6:7], v[6:7], v[52:53]
  v_pk_add_f32 v[6:7], v[6:7], v[54:55]
  v_pk_add_f32 v[6:7], v[6:7], v[56:57]
  v_pk_add_f32 v[6:7], v[6:7], v[58:59]
  v_pk_add_f32 v[6:7], v[6:7], v[60:61]
  v_pk_add_f32 v[6:7], v[6:7], v[62:63]
  v_pk_add_f32 v[6:7], v[6:7], v[64:65]
  v_pk_add_f32 v[6:7], v[6:7], v[66:67]
  v_add_f32 v4, v6, v7
  v_mov_b32 v2, v4
  s_nop 1
  v_permlane32_swap_b32 v4, v2
  v_add_f32 v4, v4, v2
  v_mov_b32 v2, v4
  s_nop 1
  v_permlane16_swap_b32 v4, v2
  v_add_f32 v4, v4, v2
  ds_write_b32 v1, v4 offset:0
  s_waitcnt lgkmcnt(0)
  s_barrier
  ds_read_b32 v4, v5 offset:0
  ds_read_b32 v2, v5 offset:64
  ds_read_b32 v3, v5 offset:128
  ds_read_b32 v6, v5 offset:192
  s_waitcnt lgkmcnt(0)
  v_add_f32 v4, v4, v2
  v_add_f32 v3, v3, v6
  v_add_f32 v4, v4, v3
  v_mul_f32 v4, 0x3acccccd, v4
  v_sub_f32 v28, v28, v4
  v_sub_f32 v29, v29, v4
  v_sub_f32 v30, v30, v4
  v_sub_f32 v31, v31, v4
  v_sub_f32 v32, v32, v4
  v_sub_f32 v33, v33, v4
  v_sub_f32 v34, v34, v4
  v_sub_f32 v35, v35, v4
  v_sub_f32 v36, v36, v4
  v_sub_f32 v37, v37, v4
  v_sub_f32 v38, v38, v4
  v_sub_f32 v39, v39, v4
  v_sub_f32 v40, v40, v4
  v_sub_f32 v41, v41, v4
  v_sub_f32 v42, v42, v4
  v_sub_f32 v43, v43, v4
  v_sub_f32 v44, v44, v4
  v_sub_f32 v45, v45, v4
  v_sub_f32 v46, v46, v4
  v_sub_f32 v47, v47, v4
  v_sub_f32 v48, v48, v4
  v_sub_f32 v49, v49, v4
  v_sub_f32 v50, v50, v4
  v_sub_f32 v51, v51, v4
  v_sub_f32 v52, v52, v4
  v_sub_f32 v53, v53, v4
  v_sub_f32 v54, v54, v4
  v_sub_f32 v55, v55, v4
  v_sub_f32 v56, v56, v4
  v_sub_f32 v57, v57, v4
  v_sub_f32 v58, v58, v4
  v_sub_f32 v59, v59, v4
  v_sub_f32 v60, v60, v4
  v_sub_f32 v61, v61, v4
  v_sub_f32 v62, v62, v4
  v_sub_f32 v63, v63, v4
  v_sub_f32 v64, v64, v4
  v_sub_f32 v65, v65, v4
  v_sub_f32 v66, v66, v4
  v_sub_f32 v67, v67, v4
  v_mul_f32 v6, v28, v28
  v_mul_f32 v7, v29, v29
  v_fmac_f32 v6, v30, v30
  v_fmac_f32 v7, v31, v31
  v_fmac_f32 v6, v32, v32
  v_fmac_f32 v7, v33, v33
  v_fmac_f32 v6, v34, v34
  v_fmac_f32 v7, v35, v35
  v_fmac_f32 v6, v36, v36
  v_fmac_f32 v7, v37, v37
  v_fmac_f32 v6, v38, v38
  v_fmac_f32 v7, v39, v39
  v_fmac_f32 v6, v40, v40
  v_fmac_f32 v7, v41, v41
  v_fmac_f32 v6, v42, v42
  v_fmac_f32 v7, v43, v43
  v_fmac_f32 v6, v44, v44
  v_fmac_f32 v7, v45, v45
  v_fmac_f32 v6, v46, v46
  v_fmac_f32 v7, v47, v47
  v_fmac_f32 v6, v48, v48
  v_fmac_f32 v7, v49, v49
  v_fmac_f32 v6, v50, v50
  v_fmac_f32 v7, v51, v51
  v_fmac_f32 v6, v52, v52
  v_fmac_f32 v7, v53, v53
  v_fmac_f32 v6, v54, v54
  v_fmac_f32 v7, v55, v55
  v_fmac_f32 v6, v56, v56
  v_fmac_f32 v7, v57, v57
  v_fmac_f32 v6, v58, v58
  v_fmac_f32 v7, v59, v59
  v_fmac_f32 v6, v60, v60
  v_fmac_f32 v7, v61, v61
  v_fmac_f32 v6, v62, v62
  v_fmac_f32 v7, v63, v63
  v_fmac_f32 v6, v64, v64
  v_fmac_f32 v7, v65, v65
  v_fmac_f32 v6, v66, v66
  v_fmac_f32 v7, v67, v67
  v_add_f32 v4, v6, v7
  v_mov_b32 v2, v4
  s_nop 1
  v_permlane32_swap_b32 v4, v2
  v_add_f32 v4, v4, v2
  v_mov_b32 v2, v4
  s_nop 1
  v_permlane16_swap_b32 v4, v2
  v_add_f32 v4, v4, v2
  ds_write_b32 v1, v4 offset:256
  s_waitcnt lgkmcnt(0)
  s_barrier
  ds_read_b32 v4, v5 offset:256
  ds_read_b32 v2, v5 offset:320
  ds_read_b32 v3, v5 offset:384
  ds_read_b32 v6, v5 offset:448
  s_waitcnt lgkmcnt(0)
  v_add_f32 v4, v4, v2
  v_add_f32 v3, v3, v6
  v_add_f32 v4, v4, v3
  v_mov_b32 v2, 0x3727c5ac
  v_fmac_f32 v2, 0x3acccccd, v4
  v_rsq_f32 v4, v2
  s_nop 0
  v_mul_f32 v28, v28, v4
  v_mul_f32 v29, v29, v4
  v_mul_f32 v30, v30, v4
  v_mul_f32 v31, v31, v4
  v_mul_f32 v32, v32, v4
  v_mul_f32 v33, v33, v4
  v_mul_f32 v34, v34, v4
  v_mul_f32 v35, v35, v4
  v_mul_f32 v36, v36, v4
  v_mul_f32 v37, v37, v4
  v_mul_f32 v38, v38, v4
  v_mul_f32 v39, v39, v4
  v_mul_f32 v40, v40, v4
  v_mul_f32 v41, v41, v4
  v_mul_f32 v42, v42, v4
  v_mul_f32 v43, v43, v4
  v_mul_f32 v44, v44, v4
  v_mul_f32 v45, v45, v4
  v_mul_f32 v46, v46, v4
  v_mul_f32 v47, v47, v4
  v_mul_f32 v48, v48, v4
  v_mul_f32 v49, v49, v4
  v_mul_f32 v50, v50, v4
  v_mul_f32 v51, v51, v4
  v_mul_f32 v52, v52, v4
  v_mul_f32 v53, v53, v4
  v_mul_f32 v54, v54, v4
  v_mul_f32 v55, v55, v4
  v_mul_f32 v56, v56, v4
  v_mul_f32 v57, v57, v4
  v_mul_f32 v58, v58, v4
  v_mul_f32 v59, v59, v4
  v_mul_f32 v60, v60, v4
  v_mul_f32 v61, v61, v4
  v_mul_f32 v62, v62, v4
  v_mul_f32 v63, v63, v4
  v_mul_f32 v64, v64, v4
  v_mul_f32 v65, v65, v4
  v_mul_f32 v66, v66, v4
  v_mul_f32 v67, v67, v4
  v_cvt_pk_bf16_f32 v8, v28, v29
  v_cvt_pk_bf16_f32 v9, v30, v31
  v_cvt_pk_bf16_f32 v10, v32, v33
  v_cvt_pk_bf16_f32 v11, v34, v35
  v_cvt_pk_bf16_f32 v12, v36, v37
  v_cvt_pk_bf16_f32 v13, v38, v39
  v_cvt_pk_bf16_f32 v14, v40, v41
  v_cvt_pk_bf16_f32 v15, v42, v43
  v_cvt_pk_bf16_f32 v16, v44, v45
  v_cvt_pk_bf16_f32 v17, v46, v47
  v_cvt_pk_bf16_f32 v18, v48, v49
  v_cvt_pk_bf16_f32 v19, v50, v51
  v_cvt_pk_bf16_f32 v20, v52, v53
  v_cvt_pk_bf16_f32 v21, v54, v55
  v_cvt_pk_bf16_f32 v22, v56, v57
  v_cvt_pk_bf16_f32 v23, v58, v59
  v_cvt_pk_bf16_f32 v24, v60, v61
  v_cvt_pk_bf16_f32 v25, v62, v63
  v_cvt_pk_bf16_f32 v26, v64, v65
  v_cvt_pk_bf16_f32 v27, v66, v67
  v_and_b32 v3, 63, v0
  v_lshlrev_b32 v1, 4, v3
  s_mul_i32 s17, s2, 20480
  s_mul_i32 s18, s16, 5120
  s_add_u32 s17, s17, s18
  s_add_u32 s17, s17, 84934656
  buffer_store_dwordx4 v[8:11], v1, s[4:7], s17 offen offset:0 sc1
  buffer_store_dwordx4 v[12:15], v1, s[4:7], s17 offen offset:1024 sc1
  buffer_store_dwordx4 v[16:19], v1, s[4:7], s17 offen offset:2048 sc1
  buffer_store_dwordx4 v[20:23], v1, s[4:7], s17 offen offset:3072 sc1
  s_add_u32 s17, s17, 4096
  buffer_store_dwordx4 v[24:27], v1, s[4:7], s17 offen offset:0 sc1
ln2_exit1:
  s_endpgm
.globl reca_kernel
.p2align 8
.type reca_kernel,@function
reca_kernel:
  s_cmp_ge_u32 s2, 256
  s_cbranch_scc1 reca_exitb3
  s_load_dwordx2 s[48:49], s[0:1], 96
  s_load_dwordx2 s[50:51], s[0:1], 88
  s_load_dwordx2 s[52:53], s[0:1], 8
  s_getreg_b32 s42, hwreg(HW_REG_XCC_ID, 0, 3)
  v_lshrrev_b32 v28, 6, v0
  v_and_b32 v29, 63, v0
  s_and_b32 s13, s2, 7
  v_readfirstlane_b32 s12, v28
  v_lshlrev_b32 v1, 4, v29
  s_lshr_b32 s14, s2, 3
  s_mov_b32 s18, 0x100000
  s_waitcnt lgkmcnt(0)
  s_mov_b32 s57, 0
  s_mov_b32 s4, s48
  s_mov_b32 s5, s49
  s_mov_b32 s6, 0x10000000
  s_mov_b32 s7, 0x20000
  s_mov_b32 s8, s50
  s_mov_b32 s9, s51
  s_mov_b32 s10, 256
  s_mov_b32 s11, 0x20000
  v_add_u32 v2, 0x1000, v1
  v_add_u32 v3, 0x2000, v1
  v_mov_b32 v31, 0x80000000
  s_lshl_b32 s34, s42, 3
  s_lshl_b64 s[36:37], 1, s34
  s_lshl_b32 s34, s13, 3
  v_cmp_eq_u32 vcc, 0, v0
  v_mov_b32 v30, s34
  s_nop 0
  v_cndmask_b32 v30, v31, v30, vcc
  v_mov_b32 v44, s36
  v_mov_b32 v45, s37
  buffer_atomic_add_x2 v[44:45], v30, s[8:11], 0 offen
  s_sub_u32 s56, 0, s48
  s_and_b32 s56, s56, 0x1fffff
  s_add_u32 s56, s56, 2097152
  s_nop 0
  s_cmp_ge_u32 s14, 24
  s_cbranch_scc1 reca_proj2
  s_mul_i32 s34, s14, 43
  s_lshr_b32 s34, s34, 8
  s_mul_i32 s35, s34, 6
  s_sub_u32 s16, s14, s35
  s_lshl_b32 s15, s13, 2
  s_add_u32 s15, s15, s34
  s_lshr_b32 s19, s12, 1
  s_and_b32 s37, s12, 1
  s_mul_i32 s34, s15, 12
  s_lshl_b32 s35, s16, 1
  s_add_u32 s34, s34, s35
  s_add_u32 s34, s34, s37
  s_mul_i32 s34, s34, 20480
  s_mov_b32 s35, 14155776
  s_cmp_eq_u32 s19, 0
  s_cselect_b32 s35, 6291456, s35
  s_add_u32 s35, s35, s34
  s_mul_i32 s36, s19, 10240
  s_add_u32 s20, s35, s36
  s_sub_u32 s36, 10240, s36
  s_add_u32 s21, s35, s36
  s_add_u32 s22, s34, 22020096
  s_mul_i32 s36, s19, 10240
  s_add_u32 s22, s22, s36
  buffer_load_dwordx4 a[0:3], v1, s[4:7], s20 offen offset:0
  buffer_load_dwordx4 a[4:7], v1, s[4:7], s20 offen offset:1024
  buffer_load_dwordx4 a[8:11], v1, s[4:7], s20 offen offset:2048
  buffer_load_dwordx4 a[12:15], v1, s[4:7], s20 offen offset:3072
  buffer_load_dwordx4 a[16:19], v2, s[4:7], s20 offen offset:0
  buffer_load_dwordx4 a[20:23], v2, s[4:7], s20 offen offset:1024
  buffer_load_dwordx4 a[24:27], v2, s[4:7], s20 offen offset:2048
  buffer_load_dwordx4 a[28:31], v2, s[4:7], s20 offen offset:3072
  buffer_load_dwordx4 a[32:35], v3, s[4:7], s20 offen offset:0
  buffer_load_dwordx4 a[36:39], v3, s[4:7], s20 offen offset:1024
  buffer_load_dwordx4 a[40:43], v1, s[4:7], s21 offen offset:0
  buffer_load_dwordx4 a[44:47], v1, s[4:7], s21 offen offset:1024
  buffer_load_dwordx4 a[48:51], v1, s[4:7], s21 offen offset:2048
  buffer_load_dwordx4 a[52:55], v1, s[4:7], s21 offen offset:3072
  buffer_load_dwordx4 a[56:59], v2, s[4:7], s21 offen offset:0
  buffer_load_dwordx4 a[60:63], v2, s[4:7], s21 offen offset:1024
  buffer_load_dwordx4 a[64:67], v2, s[4:7], s21 offen offset:2048
  buffer_load_dwordx4 a[68:71], v2, s[4:7], s21 offen offset:3072
  buffer_load_dwordx4 a[72:75], v3, s[4:7], s21 offen offset:0
  buffer_load_dwordx4 a[76:79], v3, s[4:7], s21 offen offset:1024
  buffer_load_dwordx4 a[80:83], v1, s[4:7], s22 offen offset:0
  buffer_load_dwordx4 a[84:87], v1, s[4:7], s22 offen offset:1024
  buffer_load_dwordx4 a[88:91], v1, s[4:7], s22 offen offset:2048
  buffer_load_dwordx4 a[92:95], v1, s[4:7], s22 offen offset:3072
  buffer_load_dwordx4 a[96:99], v2, s[4:7], s22 offen offset:0
  buffer_load_dwordx4 a[100:103], v2, s[4:7], s22 offen offset:1024
  buffer_load_dwordx4 a[104:107], v2, s[4:7], s22 offen offset:2048
  buffer_load_dwordx4 a[108:111], v2, s[4:7], s22 offen offset:3072
  buffer_load_dwordx4 a[112:115], v3, s[4:7], s22 offen offset:0
  buffer_load_dwordx4 a[116:119], v3, s[4:7], s22 offen offset:1024
  s_cmp_ge_u32 s14, 20
  s_cbranch_scc1 reca_now24
  s_cmp_ge_u32 s12, 2
  s_cbranch_scc1 reca_now24
  s_lshl_b32 s34, s14, 1
  s_add_u32 s34, s34, s12
  s_mul_i32 s34, s34, 192
  s_mul_i32 s35, s13, 24
  s_add_u32 s34, s34, s35
  s_lshl_b32 s34, s34, 10
  s_add_u32 s34, s34, 29884416
  buffer_load_dwordx4 a[120:123], v1, s[4:7], s34 offen offset:0
  buffer_load_dwordx4 a[124:127], v1, s[4:7], s34 offen offset:1024
  buffer_load_dwordx4 a[128:131], v1, s[4:7], s34 offen offset:2048
  buffer_load_dwordx4 a[132:135], v1, s[4:7], s34 offen offset:3072
  buffer_load_dwordx4 a[136:139], v2, s[4:7], s34 offen offset:0
  buffer_load_dwordx4 a[140:143], v2, s[4:7], s34 offen offset:1024
  buffer_load_dwordx4 a[144:147], v2, s[4:7], s34 offen offset:2048
  buffer_load_dwordx4 a[148:151], v2, s[4:7], s34 offen offset:3072
  buffer_load_dwordx4 a[152:155], v3, s[4:7], s34 offen offset:0
  buffer_load_dwordx4 a[156:159], v3, s[4:7], s34 offen offset:1024
  buffer_load_dwordx4 a[160:163], v3, s[4:7], s34 offen offset:2048
  buffer_load_dwordx4 a[164:167], v3, s[4:7], s34 offen offset:3072
  s_add_u32 s34, s34, 12288
  buffer_load_dwordx4 a[168:171], v1, s[4:7], s34 offen offset:0
  buffer_load_dwordx4 a[172:175], v1, s[4:7], s34 offen offset:1024
  buffer_load_dwordx4 a[176:179], v1, s[4:7], s34 offen offset:2048
  buffer_load_dwordx4 a[180:183], v1, s[4:7], s34 offen offset:3072
  buffer_load_dwordx4 a[184:187], v2, s[4:7], s34 offen offset:0
  buffer_load_dwordx4 a[188:191], v2, s[4:7], s34 offen offset:1024
  buffer_load_dwordx4 a[192:195], v2, s[4:7], s34 offen offset:2048
  buffer_load_dwordx4 a[196:199], v2, s[4:7], s34 offen offset:3072
  buffer_load_dwordx4 a[200:203], v3, s[4:7], s34 offen offset:0
  buffer_load_dwordx4 a[204:207], v3, s[4:7], s34 offen offset:1024
  buffer_load_dwordx4 a[208:211], v3, s[4:7], s34 offen offset:2048
  buffer_load_dwordx4 a[212:215], v3, s[4:7], s34 offen offset:3072
reca_now24:
  v_and_b32 v29, 63, v0
  v_and_b32 v28, 15, v29
  v_lshrrev_b32 v30, 4, v29
  v_mov_b32 v32, -1
  v_mov_b32 v33, -1
  v_mov_b32 v34, -1
  v_mov_b32 v35, -1
  s_mul_i32 s34, s12, 2560
  v_add_u32 v4, s34, v1
  v_and_b32 v44, 31, v29
  v_lshlrev_b32 v44, 4, v44
  s_add_u32 s34, s34, 2048
  v_add_u32 v5, s34, v44
  v_and_b32 v44, 7, v29
  v_lshlrev_b32 v44, 4, v44
  v_lshl_add_u32 v44, v30, 7, v44
  s_mul_i32 s34, s19, 5120
  v_add_u32 v6, s34, v44
  s_sub_u32 s34, 5120, s34
  v_add_u32 v7, s34, v44
  v_lshrrev_b32 v45, 3, v28
  v_lshl_add_u32 v12, v45, 9, v44
  s_mul_i32 s34, s19, 5120
  v_add_u32 v236, s34, v12
  s_sub_u32 s34, 5120, s34
  v_add_u32 v237, s34, v12
  v_add_u32 v13, 0x1000, v12
  v_add_u32 v14, 0x2000, v12
  v_cmp_gt_u32 s[54:55], 8, v28
  s_lshl_b32 s34, s16, 10
  s_lshl_b32 s35, s19, 7
  s_add_u32 s34, s34, s35
  s_and_b32 s35, s12, 1
  s_lshl_b32 s36, s35, 3
  s_add_u32 s34, s34, s36
  v_lshlrev_b32 v44, 4, v28
  v_lshl_add_u32 v45, v30, 8, v44
  v_add_u32 v45, s34, v45
  v_cndmask_b32 v8, v31, v45, s[54:55]
  v_lshl_add_u32 v44, v30, 7, v44
  v_add_u32 v45, s36, v44
  v_cndmask_b32 v9, v31, v45, s[54:55]
  s_lshl_b32 s34, s14, 9
  v_add_u32 v45, s34, v44
  v_cndmask_b32 v11, v31, v45, s[54:55]
  s_mul_i32 s34, s13, 49152
  s_lshr_b32 s35, s14, 3
  s_lshl_b32 s35, s35, 14
  s_add_u32 s34, s34, s35
  s_and_b32 s35, s14, 7
  s_lshl_b32 s35, s35, 10
  s_add_u32 s34, s34, s35
  s_lshl_b32 s35, s12, 9
  s_add_u32 s34, s34, s35
  v_add_u32 v45, s34, v44
  v_cndmask_b32 v15, v31, v45, s[54:55]
  s_cmp_lt_u32 s14, 20
  s_cselect_b32 s34, 0, 0x80000000
  v_or_b32 v15, s34, v15
  v_lshlrev_b32 v45, 3, v29
  v_cmp_gt_u32 vcc, 32, v29
  s_nop 1
  v_cndmask_b32 v10, v31, v45, vcc
  s_sub_u32 s35, s14, 4
  s_cmp_lt_u32 s14, 20
  s_cselect_b32 s34, s14, s35
  s_lshr_b32 s35, s34, 3
  s_lshl_b32 s35, s35, 14
  s_and_b32 s34, s34, 7
  s_lshl_b32 s34, s34, 10
  s_add_u32 s34, s34, s35
  v_add_u32 v20, s34, v1
  v_add_u32 v21, 49152, v20
  v_add_u32 v22, 98304, v20
  v_add_u32 v23, 147456, v20
  v_add_u32 v24, 196608, v20
  v_add_u32 v25, 245760, v20
  v_add_u32 v26, 294912, v20
  v_add_u32 v27, 344064, v20
  v_lshrrev_b32 v44, 3, v29
  v_and_b32 v44, 3, v44
  v_lshlrev_b32 v44, 7, v44
  v_and_b32 v45, 7, v29
  v_lshl_add_u32 v44, v45, 4, v44
  v_lshrrev_b32 v45, 5, v29
  v_lshl_add_u32 v44, v45, 3, v44
  s_lshl_b32 s34, s14, 9
  s_cmp_lt_u32 s14, 20
  s_cselect_b32 s34, s34, 0x80000000
  v_add_u32 v16, s34, v44
  v_cmp_eq_u32 vcc, 0, v29
  v_mov_b32 v45, 0
  s_nop 0
  v_cndmask_b32 v19, v31, v45, vcc
  s_lshl_b32 s34, s15, 8
  s_add_u32 s34, s34, 1540096
  v_and_b32 v45, 1, v29
  v_lshlrev_b32 v45, 7, v45
  v_add_u32 v233, s34, v45
  s_lshl_b32 s34, s12, 10
  s_add_u32 s34, s34, 10240
  v_add_u32 v17, s34, v1
  v_mov_b32 v36, 0x3f803f80
  v_mov_b32 v37, 0x3f803f80
  v_mov_b32 v38, 0x3f803f80
  v_mov_b32 v39, 0x3f803f80
  v_mov_b32 v44, 0xf149f2ca
  v_cmp_gt_u32 vcc, 2, v30
  s_nop 1
  v_cndmask_b32 v40, 0, v44, vcc
  v_mov_b32 v41, v40
  v_mov_b32 v42, v40
  v_mov_b32 v43, v40
  v_and_b32 v44, 31, v29
  v_lshlrev_b32 v44, 4, v44
  v_add_u32 v45, 47972352, v44
  v_add_u32 v44, 47185920, v44
  v_cmp_gt_u32 vcc, 32, v29
  s_nop 1
  v_cndmask_b32 v238, v45, v44, vcc
  s_mov_b32 s41, 0x3dd53b95
  s_mul_i32 s38, s13, 40960
  s_add_u32 s38, s38, 0
  s_mul_i32 s39, s15, 24576
  s_add_u32 s39, s39, 327680
  s_mul_i32 s40, s13, 49152
  s_add_u32 s40, s40, 1114112
  s_mov_b32 s60, s52
  s_mov_b32 s61, s53
  s_mov_b32 s62, 10240
  s_mov_b32 s63, 0x20000
  v_and_b32 v29, 63, v0
  v_and_b32 v44, 7, v29
  v_mul_u32_u24 v44, 1280, v44
  v_lshrrev_b32 v45, 3, v29
  v_and_b32 v45, 3, v45
  v_lshl_add_u32 v44, v45, 4, v44
  s_mul_i32 s34, s12, 320
  v_add_u32 v44, s34, v44
  v_add_u32 v46, 256, v44
  v_lshrrev_b32 v45, 5, v29
  v_lshl_add_u32 v44, v45, 6, v44
  buffer_load_dwordx4 v[128:131], v44, s[60:63], 0 offen
  buffer_load_dwordx4 v[132:135], v44, s[60:63], 0 offen offset:128
  buffer_load_dwordx4 v[136:139], v46, s[60:63], 0 offen
  v_and_b32 v44, 63, v0
  v_and_b32 v45, 3, v44
  v_lshlrev_b32 v45, 21, v45
  v_min_u32 v45, 786368, v45
  v_add_u32 v46, 47185920, v45
  v_add_u32 v45, 47972352, v45
  v_cmp_gt_u32 vcc, 4, v44
  s_nop 1
  v_cndmask_b32 v46, v45, v46, vcc
  s_mul_i32 s34, s15, 98304
  v_and_b32 v45, 1, v44
  v_mul_u32_u24 v45, 98240, v45
  v_add_u32 v45, s34, v45
  v_add_u32 v28, 37748736, v45
  v_add_u32 v45, 40894464, v45
  v_cmp_gt_u32 vcc, 10, v44
  s_nop 1
  v_cndmask_b32 v45, v45, v28, vcc
  v_cmp_gt_u32 vcc, 8, v44
  s_nop 1
  v_cndmask_b32 v46, v45, v46, vcc
  v_cmp_gt_u32 vcc, 12, v44
  s_nop 1
  v_cndmask_b32 v46, v31, v46, vcc
  buffer_load_dword v234, v46, s[4:7], 0 offen
  v_and_b32 v44, 63, v0
  v_lshlrev_b32 v45, 21, v44
  v_min_u32 v45, 25165760, v45
  v_add_u32 v45, 57147392, v45
  s_lshl_b32 s34, s13, 2
  s_add_u32 s34, s34, s14
  s_sub_u32 s34, s34, 20
  s_and_b32 s34, s34, 31
  s_mul_i32 s34, s34, 98304
  s_add_u32 s34, s34, 44040192
  v_and_b32 v46, 1, v44
  v_mul_u32_u24 v46, 98240, v46
  v_add_u32 v46, s34, v46
  v_cmp_gt_u32 vcc, 13, v44
  s_nop 1
  v_cndmask_b32 v46, v46, v45, vcc
  v_cmp_gt_u32 vcc, 15, v44
  s_nop 1
  v_cndmask_b32 v46, v31, v46, vcc
  buffer_load_dword v235, v46, s[4:7], 0 offen
  v_and_b32 v30, 7, v0
  v_lshlrev_b32 v30, 3, v30
reca_cens5:
  buffer_load_dwordx2 v[28:29], v30, s[8:11], 0 offen sc1
  s_waitcnt vmcnt(0)
  v_sad_u8 v31, v28, 0, 0
  v_sad_u8 v31, v29, 0, v31
  v_cmp_gt_u32 vcc, 32, v31
  s_cbranch_vccz reca_censok6
  s_sleep 8
  s_sub_u32 s18, s18, 1
  s_cbranch_scc0 reca_cens5
  s_mov_b32 s18, 0
reca_censok6:
  v_and_b32 v28, 0x20202020, v28
  v_and_b32 v29, 0x20202020, v29
  v_cmp_ne_u32 s[34:35], 0, v28
  v_cmp_ne_u32 s[36:37], 0, v29
  s_nop 3
  s_and_b32 s34, s34, 0xff
  s_and_b32 s36, s36, 0xff
  s_or_b32 s35, s34, s36
  s_lshr_b32 s37, s35, s13
  s_and_b32 s37, s37, 1
  s_xor_b32 s43, s37, 1
  s_cmp_eq_u32 s57, 0
  s_cselect_b32 s58, s36, s34
  v_mov_b32 v31, 0x80000000
  v_add_u32 v232, 0x2000, v15
  s_lshr_b32 s44, s2, 4
  s_lshl_b32 s44, s44, 14
  s_and_b32 s34, s2, 15
  s_lshl_b32 s34, s34, 9
  s_add_u32 s44, s44, s34
  s_add_u32 s44, s44, 1572864
  s_add_u32 s44, s44, s56
  s_mov_b32 s45, -1
  s_mov_b32 s47, -1
  s_cmp_lg_u32 s12, 2
  s_cbranch_scc1 reca_noprobe7
  s_add_u32 s35, s44, 0
  s_memtime s[60:61]
  s_waitcnt lgkmcnt(0)
  buffer_load_dword v28, v19, s[4:7], s35 offen sc1
  s_waitcnt vmcnt(0)
  s_memtime s[62:63]
  s_waitcnt lgkmcnt(0)
  s_sub_u32 s36, s62, s60
  s_min_u32 s45, s45, s36
  s_add_u32 s35, s44, 8192
  s_memtime s[60:61]
  s_waitcnt lgkmcnt(0)
  buffer_load_dword v28, v19, s[4:7], s35 offen sc1
  s_waitcnt vmcnt(0)
  s_memtime s[62:63]
  s_waitcnt lgkmcnt(0)
  s_sub_u32 s36, s62, s60
  s_min_u32 s47, s47, s36
  s_add_u32 s35, s44, 128
  s_memtime s[60:61]
  s_waitcnt lgkmcnt(0)
  buffer_load_dword v28, v19, s[4:7], s35 offen sc1
  s_waitcnt vmcnt(0)
  s_memtime s[62:63]
  s_waitcnt lgkmcnt(0)
  s_sub_u32 s36, s62, s60
  s_min_u32 s45, s45, s36
  s_add_u32 s35, s44, 8320
  s_memtime s[60:61]
  s_waitcnt lgkmcnt(0)
  buffer_load_dword v28, v19, s[4:7], s35 offen sc1
  s_waitcnt vmcnt(0)
  s_memtime s[62:63]
  s_waitcnt lgkmcnt(0)
  s_sub_u32 s36, s62, s60
  s_min_u32 s47, s47, s36
  s_add_u32 s35, s44, 256
  s_memtime s[60:61]
  s_waitcnt lgkmcnt(0)
  buffer_load_dword v28, v19, s[4:7], s35 offen sc1
  s_waitcnt vmcnt(0)
  s_memtime s[62:63]
  s_waitcnt lgkmcnt(0)
  s_sub_u32 s36, s62, s60
  s_min_u32 s45, s45, s36
  s_add_u32 s35, s44, 8448
  s_memtime s[60:61]
  s_waitcnt lgkmcnt(0)
  buffer_load_dword v28, v19, s[4:7], s35 offen sc1
  s_waitcnt vmcnt(0)
  s_memtime s[62:63]
  s_waitcnt lgkmcnt(0)
  s_sub_u32 s36, s62, s60
  s_min_u32 s47, s47, s36
  s_cmp_lt_u32 s47, s45
  s_cbranch_scc0 reca_noprobe7
  v_add_u32 v20, 0x2000, v20
  v_add_u32 v21, 0x2000, v21
  v_add_u32 v22, 0x2000, v22
  v_add_u32 v23, 0x2000, v23
  v_add_u32 v24, 0x2000, v24
  v_add_u32 v25, 0x2000, v25
  v_add_u32 v26, 0x2000, v26
  v_add_u32 v27, 0x2000, v27
reca_noprobe7:
  s_lshl_b32 s59, s13, 2
  s_add_u32 s59, s59, s14
  s_sub_u32 s59, s59, 20
  v_and_b32 v29, 63, v0
  v_and_b32 v28, 15, v29
  v_lshrrev_b32 v30, 4, v29
  v_lshlrev_b32 v92, 4, v28
  v_lshl_add_u32 v92, v30, 7, v92
  v_cmp_gt_u32 vcc, 8, v28
  s_nop 1
  v_cndmask_b32 v92, v31, v92, vcc
  v_lshlrev_b32 v93, 3, v29
  v_cmp_gt_u32 vcc, 32, v29
  s_nop 1
  v_cndmask_b32 v93, v31, v93, vcc
  v_mov_b32 v82, 0xf149f2ca
  v_cmp_le_u32 vcc, 2, v30
  s_nop 1
  v_cndmask_b32 v84, 0, v82, vcc
  v_mov_b32 v85, v84
  v_mov_b32 v86, v84
  v_mov_b32 v87, v84
  v_lshlrev_b32 v30, 2, v30
  v_add_u32 v29, 0, v30
  v_cmp_gt_u32 vcc, v29, v28
  s_nop 1
  v_cndmask_b32 v88, 0, v82, vcc
  v_add_u32 v29, 1, v30
  v_cmp_gt_u32 vcc, v29, v28
  s_nop 1
  v_cndmask_b32 v89, 0, v82, vcc
  v_add_u32 v29, 2, v30
  v_cmp_gt_u32 vcc, v29, v28
  s_nop 1
  v_cndmask_b32 v90, 0, v82, vcc
  v_add_u32 v29, 3, v30
  v_cmp_gt_u32 vcc, v29, v28
  s_nop 1
  v_cndmask_b32 v91, 0, v82, vcc
  s_mov_b32 s17, 0
  s_cmp_lg_u32 s12, 3
  s_cbranch_scc1 reca_nopf08
  s_add_u32 s37, s17, 1
reca_pf9:
  buffer_load_dword v28, v233, s[4:7], 0 offen sc1
  s_waitcnt vmcnt(0)
  v_cmp_gt_i32 vcc, s37, v28
  s_cbranch_vccz reca_pfok10
  s_sleep 1
  s_sub_u32 s18, s18, 1
  s_cbranch_scc0 reca_pf9
  s_mov_b32 s18, 0
reca_pfok10:
  s_lshl_b32 s34, s15, 3
  s_and_b32 s35, s17, 7
  s_add_u32 s34, s34, s35
  s_mul_i32 s34, s34, 12288
  s_add_u32 s32, s34, 37748736
  s_lshl_b32 s35, s16, 11
  s_add_u32 s34, s34, s35
  s_add_u32 s33, s34, 40894464
  buffer_load_dwordx4 a[120:123], v1, s[4:7], s32 offen offset:0 sc1
  buffer_load_dwordx4 a[124:127], v1, s[4:7], s32 offen offset:1024 sc1
  buffer_load_dwordx4 a[128:131], v1, s[4:7], s32 offen offset:2048 sc1
  buffer_load_dwordx4 a[132:135], v1, s[4:7], s32 offen offset:3072 sc1
  buffer_load_dwordx4 a[136:139], v2, s[4:7], s32 offen offset:0 sc1
  buffer_load_dwordx4 a[140:143], v2, s[4:7], s32 offen offset:1024 sc1
  buffer_load_dwordx4 a[144:147], v2, s[4:7], s32 offen offset:2048 sc1
  buffer_load_dwordx4 a[148:151], v2, s[4:7], s32 offen offset:3072 sc1
  buffer_load_dwordx4 a[152:155], v3, s[4:7], s32 offen offset:0 sc1
  buffer_load_dwordx4 a[156:159], v3, s[4:7], s32 offen offset:1024 sc1
  buffer_load_dwordx4 a[160:163], v3, s[4:7], s32 offen offset:2048 sc1
  buffer_load_dwordx4 a[164:167], v3, s[4:7], s32 offen offset:3072 sc1
  buffer_load_dwordx4 a[168:171], v1, s[4:7], s33 offen offset:0 sc1
  buffer_load_dwordx4 a[172:175], v1, s[4:7], s33 offen offset:1024 sc1
  s_waitcnt vmcnt(0)
reca_nopf08:
  s_cmp_lg_u32 s43, 0
  s_cbranch_scc1 reca_slow11
  s_cmp_ge_u32 s14, 20
  s_cbranch_scc1 reca_twinf12
  s_branch reca_gotmem15
reca_step14:
  s_and_b32 s34, s17, 3
  s_mul_i32 s20, s34, 10240
  s_add_u32 s20, s20, s38
  s_sleep 2
  buffer_load_dwordx4 v[128:131], v4, s[4:7], s20 offen sc1
  buffer_load_dwordx4 v[132:135], v4, s[4:7], s20 offen offset:1024 sc1
  buffer_load_dwordx4 v[136:139], v5, s[4:7], s20 offen sc1
  s_waitcnt vmcnt(2)
  v_max_u32 v29, v128, v130
  v_cmp_eq_u32 vcc, -1, v29
  s_cbranch_vccnz reca_retry17
reca_resume18:
  s_waitcnt vmcnt(1)
  v_max_u32 v29, v132, v134
  v_cmp_eq_u32 vcc, -1, v29
  ds_write_b128 v4, v[128:131]
  s_cbranch_vccnz reca_retry19
reca_resume20:
  s_waitcnt vmcnt(0)
  v_max_u32 v29, v136, v138
  v_cmp_eq_u32 vcc, -1, v29
  ds_write_b128 v4, v[132:135] offset:1024
  s_cbranch_vccnz reca_retry21
reca_resume22:
  ds_write_b128 v5, v[136:139]
  s_branch reca_gotmem216
reca_gotmem15:
  ds_write_b128 v4, v[128:131]
  ds_write_b128 v4, v[132:135] offset:1024
  ds_write_b128 v5, v[136:139]
reca_gotmem216:
  s_and_b32 s34, s17, 3
  s_mul_i32 s21, s34, 6144
  s_add_u32 s21, s21, s39
  s_mul_i32 s22, s34, 12288
  s_add_u32 s22, s22, s40
  s_mul_i32 s25, s34, 393216
  s_add_u32 s25, s25, s56
  s_add_u32 s35, s17, 1
  s_and_b32 s35, s35, 3
  s_mul_i32 s24, s35, 10240
  s_add_u32 s24, s24, s38
  s_waitcnt lgkmcnt(0)
  s_barrier
  ds_read_b128 v[128:131], v236 offset:0
  ds_read_b128 v[132:135], v236 offset:1024
  ds_read_b128 v[136:139], v236 offset:2048
  ds_read_b128 v[140:143], v236 offset:3072
  ds_read_b128 v[144:147], v236 offset:4096
  ds_read_b128 v[148:151], v237 offset:0
  ds_read_b128 v[152:155], v237 offset:1024
  ds_read_b128 v[156:159], v237 offset:2048
  ds_read_b128 v[160:163], v237 offset:3072
  ds_read_b128 v[164:167], v237 offset:4096
  s_waitcnt lgkmcnt(9)
  v_mfma_f32_16x16x32_bf16 v[44:47], a[0:3], v[128:131], 0
  ds_read_b128 v[168:171], v6 offset:0
  v_mfma_f32_16x16x32_bf16 v[240:243], a[4:7], v[128:131], 0
  s_waitcnt lgkmcnt(9)
  v_mfma_f32_16x16x32_bf16 v[44:47], a[8:11], v[132:135], v[44:47]
  ds_read_b128 v[172:175], v6 offset:512
  v_mfma_f32_16x16x32_bf16 v[240:243], a[12:15], v[132:135], v[240:243]
  s_waitcnt lgkmcnt(9)
  v_mfma_f32_16x16x32_bf16 v[44:47], a[16:19], v[136:139], v[44:47]
  ds_read_b128 v[176:179], v6 offset:1024
  v_mfma_f32_16x16x32_bf16 v[240:243], a[20:23], v[136:139], v[240:243]
  s_waitcnt lgkmcnt(9)
  v_mfma_f32_16x16x32_bf16 v[44:47], a[24:27], v[140:143], v[44:47]
  ds_read_b128 v[180:183], v6 offset:1536
  v_mfma_f32_16x16x32_bf16 v[240:243], a[28:31], v[140:143], v[240:243]
  s_waitcnt lgkmcnt(9)
  v_mfma_f32_16x16x32_bf16 v[44:47], a[32:35], v[144:147], v[44:47]
  ds_read_b128 v[184:187], v6 offset:2048
  v_mfma_f32_16x16x32_bf16 v[240:243], a[36:39], v[144:147], v[240:243]
  s_waitcnt lgkmcnt(9)
  v_mfma_f32_16x16x32_bf16 v[44:47], a[40:43], v[148:151], v[44:47]
  ds_read_b128 v[188:191], v6 offset:2560
  v_mfma_f32_16x16x32_bf16 v[240:243], a[44:47], v[148:151], v[240:243]
  s_waitcnt lgkmcnt(9)
  v_mfma_f32_16x16x32_bf16 v[44:47], a[48:51], v[152:155], v[44:47]
  ds_read_b128 v[192:195], v6 offset:3072
  v_mfma_f32_16x16x32_bf16 v[240:243], a[52:55], v[152:155], v[240:243]
  s_waitcnt lgkmcnt(9)
  v_mfma_f32_16x16x32_bf16 v[44:47], a[56:59], v[156:159], v[44:47]
  ds_read_b128 v[196:199], v6 offset:3584
  v_mfma_f32_16x16x32_bf16 v[240:243], a[60:63], v[156:159], v[240:243]
  s_waitcnt lgkmcnt(9)
  v_mfma_f32_16x16x32_bf16 v[44:47], a[64:67], v[160:163], v[44:47]
  ds_read_b128 v[200:203], v6 offset:4096
  v_mfma_f32_16x16x32_bf16 v[240:243], a[68:71], v[160:163], v[240:243]
  s_waitcnt lgkmcnt(9)
  v_mfma_f32_16x16x32_bf16 v[44:47], a[72:75], v[164:167], v[44:47]
  ds_read_b128 v[204:207], v6 offset:4608
  v_mfma_f32_16x16x32_bf16 v[240:243], a[76:79], v[164:167], v[240:243]
  s_waitcnt lgkmcnt(9)
  v_mfma_f32_16x16x32_bf16 v[48:51], v[168:171], a[80:83], 0
  s_and_b32 s34, s17, 7
  s_lshl_b32 s34, s34, 5
  s_add_u32 s34, s34, s15
  s_mul_i32 s34, s34, 3072
  s_lshl_b32 s35, s16, 9
  s_add_u32 s34, s34, s35
  s_add_u32 s30, s34, 47185920
  s_add_u32 s31, s34, 47972352
  v_add_f32_dpp v44, v240, v44 row_ror:8 row_mask:0xf bank_mask:0xf
  v_add_f32_dpp v45, v241, v45 row_ror:8 row_mask:0xf bank_mask:0xf
  v_add_f32_dpp v46, v242, v46 row_ror:8 row_mask:0xf bank_mask:0xf
  v_add_f32_dpp v47, v243, v47 row_ror:8 row_mask:0xf bank_mask:0xf
  v_cvt_pk_bf16_f32 v52, v44, v45
  v_cvt_pk_bf16_f32 v53, v46, v47
  buffer_store_dwordx2 v[52:53], v8, s[4:7], s21 offen
  s_waitcnt lgkmcnt(8)
  v_mfma_f32_16x16x32_bf16 v[48:51], v[172:175], a[84:87], v[48:51]
  s_waitcnt lgkmcnt(7)
  v_mfma_f32_16x16x32_bf16 v[48:51], v[176:179], a[88:91], v[48:51]
  s_waitcnt lgkmcnt(6)
  v_mfma_f32_16x16x32_bf16 v[48:51], v[180:183], a[92:95], v[48:51]
  s_waitcnt lgkmcnt(5)
  v_mfma_f32_16x16x32_bf16 v[48:51], v[184:187], a[96:99], v[48:51]
  s_waitcnt lgkmcnt(4)
  v_mfma_f32_16x16x32_bf16 v[48:51], v[188:191], a[100:103], v[48:51]
  s_waitcnt lgkmcnt(3)
  v_mfma_f32_16x16x32_bf16 v[48:51], v[192:195], a[104:107], v[48:51]
  s_waitcnt lgkmcnt(2)
  v_mfma_f32_16x16x32_bf16 v[48:51], v[196:199], a[108:111], v[48:51]
  s_waitcnt lgkmcnt(1)
  v_mfma_f32_16x16x32_bf16 v[48:51], v[200:203], a[112:115], v[48:51]
  s_waitcnt lgkmcnt(0)
  v_mfma_f32_16x16x32_bf16 v[48:51], v[204:207], a[116:119], v[48:51]
  s_cmp_eq_u32 s12, 3
  s_cbranch_scc1 reca_swave23
  s_nop 5
  ds_write_b128 v17, v[48:51]
  s_add_u32 s34, s17, 2
  s_and_b32 s34, s34, 3
  s_mul_i32 s26, s34, 10240
  s_add_u32 s26, s26, s38
  s_mul_i32 s27, s34, 6144
  s_add_u32 s27, s27, s39
  s_mul_i32 s28, s34, 12288
  s_add_u32 s28, s28, s40
  s_mul_i32 s29, s34, 393216
  s_add_u32 s29, s29, s56
  s_waitcnt lgkmcnt(0)
  s_barrier
  s_cmp_eq_u32 s17, 63
  s_cbranch_scc1 reca_last25
  buffer_store_dwordx2 v[32:33], v8, s[4:7], s27 offen
  s_cmp_lg_u32 s12, 2
  s_cbranch_scc1 reca_b326
  buffer_store_dwordx2 v[52:53], v9, s[4:7], s30 offen
  buffer_store_dwordx2 v[32:33], v16, s[4:7], s26 offen
  s_cmp_lg_u32 s14, 0
  s_cbranch_scc1 reca_b326
  v_mov_b32 v28, s17
  s_lshl_b32 s34, s13, 7
  s_add_u32 s34, s34, 1507328
  buffer_store_dword v28, v19, s[4:7], s34 offen
  s_branch reca_b326
reca_last25:
  s_cmp_lg_u32 s12, 2
  s_cbranch_scc1 reca_exit1
  buffer_store_dwordx2 v[52:53], v9, s[4:7], s30 offen
  s_branch reca_exit1
reca_swave23:
  s_cmp_lg_u32 s17, 63
  s_cbranch_scc1 reca_vmst29
  s_barrier
  ds_read_b128 v[56:59], v1 offset:10240
  ds_read_b128 v[60:63], v1 offset:11264
  ds_read_b128 v[64:67], v1 offset:12288
  s_waitcnt lgkmcnt(0)
  v_add_f32 v56, v56, v64
  v_add_f32 v60, v60, v48
  v_add_f32 v57, v57, v65
  v_add_f32 v61, v61, v49
  v_add_f32 v58, v58, v66
  v_add_f32 v62, v62, v50
  v_add_f32 v59, v59, v67
  v_add_f32 v63, v63, v51
  v_cvt_pk_bf16_f32 v68, v56, v57
  v_cvt_pk_bf16_f32 v69, v58, v59
  v_cvt_pk_bf16_f32 v70, v60, v61
  v_cvt_pk_bf16_f32 v71, v62, v63
  buffer_store_dwordx2 v[52:53], v9, s[4:7], s30 offen
  buffer_store_dwordx2 v[68:69], v10, s[4:7], s31 offen
  buffer_store_dwordx2 v[70:71], v10, s[4:7], s31 offen offset:256
  s_branch reca_exit1
reca_vmst29:
  s_sleep 1
  buffer_load_dwordx4 v[208:211], v1, s[4:7], s21 offen offset:0 sc1
  buffer_load_dwordx4 v[212:215], v1, s[4:7], s21 offen offset:1024 sc1
  buffer_load_dwordx4 v[216:219], v1, s[4:7], s21 offen offset:2048 sc1
  buffer_load_dwordx4 v[220:223], v1, s[4:7], s21 offen offset:3072 sc1
  buffer_load_dwordx4 v[224:227], v2, s[4:7], s21 offen offset:0 sc1
  buffer_load_dwordx4 v[228:231], v2, s[4:7], s21 offen offset:1024 sc1
  s_waitcnt vmcnt(5)
  v_max_u32 v29, v208, v210
  v_cmp_eq_u32 vcc, -1, v29
  s_cbranch_vccnz reca_retry30
reca_resume31:
  s_waitcnt vmcnt(4)
  v_max_u32 v29, v212, v214
  v_cmp_eq_u32 vcc, -1, v29
  v_mfma_f32_16x16x32_bf16 v[76:79], a[120:123], v[208:211], 0
  v_mfma_f32_16x16x32_bf16 v[80:83], a[144:147], v[208:211], 0
  v_mfma_f32_16x16x32_bf16 v[72:75], v[208:211], v[208:211], v[40:43]
  s_cbranch_vccnz reca_retry32
reca_resume33:
  s_waitcnt vmcnt(3)
  v_max_u32 v29, v216, v218
  v_cmp_eq_u32 vcc, -1, v29
  v_mfma_f32_16x16x32_bf16 v[76:79], a[124:127], v[212:215], v[76:79]
  v_mfma_f32_16x16x32_bf16 v[80:83], a[148:151], v[212:215], v[80:83]
  v_mfma_f32_16x16x32_bf16 v[72:75], v[212:215], v[212:215], v[72:75]
  s_cbranch_vccnz reca_retry34
reca_resume35:
  s_waitcnt vmcnt(2)
  v_max_u32 v29, v220, v222
  v_cmp_eq_u32 vcc, -1, v29
  v_mfma_f32_16x16x32_bf16 v[76:79], a[128:131], v[216:219], v[76:79]
  v_mfma_f32_16x16x32_bf16 v[80:83], a[152:155], v[216:219], v[80:83]
  v_mfma_f32_16x16x32_bf16 v[72:75], v[216:219], v[216:219], v[72:75]
  s_cbranch_vccnz reca_retry36
reca_resume37:
  s_waitcnt vmcnt(1)
  v_max_u32 v29, v224, v226
  v_cmp_eq_u32 vcc, -1, v29
  v_mfma_f32_16x16x32_bf16 v[76:79], a[132:135], v[220:223], v[76:79]
  v_mfma_f32_16x16x32_bf16 v[80:83], a[156:159], v[220:223], v[80:83]
  v_mfma_f32_16x16x32_bf16 v[72:75], v[220:223], v[220:223], v[72:75]
  s_cbranch_vccnz reca_retry38
reca_resume39:
  s_waitcnt vmcnt(0)
  v_max_u32 v29, v228, v230
  v_cmp_eq_u32 vcc, -1, v29
  v_mfma_f32_16x16x32_bf16 v[76:79], a[136:139], v[224:227], v[76:79]
  v_mfma_f32_16x16x32_bf16 v[80:83], a[160:163], v[224:227], v[80:83]
  v_mfma_f32_16x16x32_bf16 v[72:75], v[224:227], v[224:227], v[72:75]
  s_cbranch_vccnz reca_retry40
reca_resume41:
  v_mfma_f32_16x16x32_bf16 v[76:79], a[140:143], v[228:231], v[76:79]
  v_mfma_f32_16x16x32_bf16 v[80:83], a[164:167], v[228:231], v[80:83]
  v_mfma_f32_16x16x32_bf16 v[72:75], v[228:231], v[228:231], v[72:75]
  s_barrier
  ds_read_b128 v[56:59], v1 offset:10240
  ds_read_b128 v[60:63], v1 offset:11264
  ds_read_b128 v[64:67], v1 offset:12288
  s_nop 1
  v_max3_f32 v28, v76, v77, v78
  v_max3_f32 v29, v80, v81, v82
  v_max3_f32 v28, v28, v79, v83
  v_max3_f32 v29, v29, v72, v73
  v_max3_f32 v28, v28, v74, v75
  v_max_f32 v28, v28, v29
  v_mov_b32 v29, v28
  s_nop 1
  v_permlane32_swap_b32 v28, v29
  v_max_f32 v28, v28, v29
  v_mov_b32 v29, v28
  s_nop 1
  v_permlane16_swap_b32 v28, v29
  v_max_f32 v28, v28, v29
  v_mul_f32 v28, s41, v28
  v_fma_f32 v76, v76, s41, -v28
  v_fma_f32 v77, v77, s41, -v28
  v_fma_f32 v78, v78, s41, -v28
  v_fma_f32 v79, v79, s41, -v28
  v_fma_f32 v80, v80, s41, -v28
  v_fma_f32 v81, v81, s41, -v28
  v_fma_f32 v82, v82, s41, -v28
  v_fma_f32 v83, v83, s41, -v28
  v_fma_f32 v72, v72, s41, -v28
  v_fma_f32 v73, v73, s41, -v28
  v_fma_f32 v74, v74, s41, -v28
  v_fma_f32 v75, v75, s41, -v28
  v_exp_f32 v76, v76
  v_exp_f32 v77, v77
  v_exp_f32 v78, v78
  v_exp_f32 v79, v79
  v_exp_f32 v80, v80
  v_exp_f32 v81, v81
  v_exp_f32 v82, v82
  v_exp_f32 v83, v83
  v_cvt_pk_bf16_f32 v84, v76, v77
  v_cvt_pk_bf16_f32 v85, v78, v79
  v_cvt_pk_bf16_f32 v86, v80, v81
  v_cvt_pk_bf16_f32 v87, v82, v83
  v_exp_f32 v72, v72
  v_exp_f32 v73, v73
  v_mfma_f32_16x16x32_bf16 v[100:103], v[36:39], v[84:87], 0
  v_exp_f32 v74, v74
  v_exp_f32 v75, v75
  v_mfma_f32_16x16x32_bf16 v[92:95], a[168:171], v[84:87], 0
  v_cvt_pk_bf16_f32 v88, v72, v73
  v_cvt_pk_bf16_f32 v89, v74, v75
  v_mfma_f32_16x16x32_bf16 v[96:99], a[172:175], v[84:87], 0
  s_waitcnt lgkmcnt(0)
  v_mfma_f32_16x16x16_bf16 v[100:103], v[36:37], v[88:89], v[100:103]
  v_add_f32 v56, v56, v64
  v_add_f32 v60, v60, v48
  v_add_f32 v57, v57, v65
  v_add_f32 v61, v61, v49
  v_add_f32 v58, v58, v66
  v_add_f32 v62, v62, v50
  v_add_f32 v59, v59, v67
  v_add_f32 v63, v63, v51
  v_cvt_pk_bf16_f32 v68, v56, v57
  v_cvt_pk_bf16_f32 v69, v58, v59
  v_cvt_pk_bf16_f32 v70, v60, v61
  v_cvt_pk_bf16_f32 v71, v62, v63
  v_mfma_f32_16x16x16_bf16 v[92:95], v[68:69], v[88:89], v[92:95]
  v_rcp_f32 v28, v100
  v_mfma_f32_16x16x16_bf16 v[96:99], v[70:71], v[88:89], v[96:99]
  v_mov_b32 v29, v28
  s_nop 4
  v_pk_mul_f32 v[92:93], v[92:93], v[28:29]
  v_pk_mul_f32 v[94:95], v[94:95], v[28:29]
  v_pk_mul_f32 v[96:97], v[96:97], v[28:29]
  v_pk_mul_f32 v[98:99], v[98:99], v[28:29]
  v_cvt_pk_bf16_f32 v104, v92, v93
  v_cvt_pk_bf16_f32 v105, v94, v95
  v_cvt_pk_bf16_f32 v106, v96, v97
  v_cvt_pk_bf16_f32 v107, v98, v99
  buffer_store_dwordx4 v[104:107], v11, s[4:7], s22 offen
reca_b326:
  s_barrier
  s_cmp_ge_u32 s12, 2
  s_cbranch_scc1 reca_notg242
  s_sleep 3
  buffer_load_dwordx4 v[128:131], v12, s[4:7], s22 offen offset:0 sc1
  buffer_load_dwordx4 v[132:135], v12, s[4:7], s22 offen offset:1024 sc1
  buffer_load_dwordx4 v[136:139], v12, s[4:7], s22 offen offset:2048 sc1
  buffer_load_dwordx4 v[140:143], v12, s[4:7], s22 offen offset:3072 sc1
  buffer_load_dwordx4 v[144:147], v13, s[4:7], s22 offen offset:0 sc1
  buffer_load_dwordx4 v[148:151], v13, s[4:7], s22 offen offset:1024 sc1
  buffer_load_dwordx4 v[152:155], v13, s[4:7], s22 offen offset:2048 sc1
  buffer_load_dwordx4 v[156:159], v13, s[4:7], s22 offen offset:3072 sc1
  buffer_load_dwordx4 v[160:163], v14, s[4:7], s22 offen offset:0 sc1
  buffer_load_dwordx4 v[164:167], v14, s[4:7], s22 offen offset:1024 sc1
  buffer_load_dwordx4 v[168:171], v14, s[4:7], s22 offen offset:2048 sc1
  buffer_load_dwordx4 v[172:175], v14, s[4:7], s22 offen offset:3072 sc1
  s_waitcnt vmcnt(11)
  v_cmp_eq_u32 vcc, -1, v128
  s_cbranch_vccnz reca_retry43
reca_resume44:
  s_waitcnt vmcnt(10)
  v_cmp_eq_u32 vcc, -1, v132
  v_mfma_f32_16x16x32_bf16 v[108:111], a[120:123], v[128:131], 0
  v_mfma_f32_16x16x32_bf16 v[112:115], a[124:127], v[128:131], 0
  s_cbranch_vccnz reca_retry45
reca_resume46:
  s_waitcnt vmcnt(9)
  v_cmp_eq_u32 vcc, -1, v136
  v_mfma_f32_16x16x32_bf16 v[108:111], a[128:131], v[132:135], v[108:111]
  v_mfma_f32_16x16x32_bf16 v[112:115], a[132:135], v[132:135], v[112:115]
  s_cbranch_vccnz reca_retry47
reca_resume48:
  s_waitcnt vmcnt(8)
  v_cmp_eq_u32 vcc, -1, v140
  v_mfma_f32_16x16x32_bf16 v[108:111], a[136:139], v[136:139], v[108:111]
  v_mfma_f32_16x16x32_bf16 v[112:115], a[140:143], v[136:139], v[112:115]
  s_cbranch_vccnz reca_retry49
reca_resume50:
  s_waitcnt vmcnt(7)
  v_cmp_eq_u32 vcc, -1, v144
  v_mfma_f32_16x16x32_bf16 v[108:111], a[144:147], v[140:143], v[108:111]
  v_mfma_f32_16x16x32_bf16 v[112:115], a[148:151], v[140:143], v[112:115]
  s_cbranch_vccnz reca_retry51
reca_resume52:
  s_waitcnt vmcnt(6)
  v_cmp_eq_u32 vcc, -1, v148
  v_mfma_f32_16x16x32_bf16 v[108:111], a[152:155], v[144:147], v[108:111]
  v_mfma_f32_16x16x32_bf16 v[112:115], a[156:159], v[144:147], v[112:115]
  s_cbranch_vccnz reca_retry53
reca_resume54:
  s_waitcnt vmcnt(5)
  v_cmp_eq_u32 vcc, -1, v152
  v_mfma_f32_16x16x32_bf16 v[108:111], a[160:163], v[148:151], v[108:111]
  v_mfma_f32_16x16x32_bf16 v[112:115], a[164:167], v[148:151], v[112:115]
  s_cbranch_vccnz reca_retry55
reca_resume56:
  s_waitcnt vmcnt(4)
  v_cmp_eq_u32 vcc, -1, v156
  v_mfma_f32_16x16x32_bf16 v[108:111], a[168:171], v[152:155], v[108:111]
  v_mfma_f32_16x16x32_bf16 v[112:115], a[172:175], v[152:155], v[112:115]
  s_cbranch_vccnz reca_retry57
reca_resume58:
  s_waitcnt vmcnt(3)
  v_cmp_eq_u32 vcc, -1, v160
  v_mfma_f32_16x16x32_bf16 v[108:111], a[176:179], v[156:159], v[108:111]
  v_mfma_f32_16x16x32_bf16 v[112:115], a[180:183], v[156:159], v[112:115]
  s_cbranch_vccnz reca_retry59
reca_resume60:
  s_waitcnt vmcnt(2)
  v_cmp_eq_u32 vcc, -1, v164
  v_mfma_f32_16x16x32_bf16 v[108:111], a[184:187], v[160:163], v[108:111]
  v_mfma_f32_16x16x32_bf16 v[112:115], a[188:191], v[160:163], v[112:115]
  s_cbranch_vccnz reca_retry61
reca_resume62:
  s_waitcnt vmcnt(1)
  v_cmp_eq_u32 vcc, -1, v168
  v_mfma_f32_16x16x32_bf16 v[108:111], a[192:195], v[164:167], v[108:111]
  v_mfma_f32_16x16x32_bf16 v[112:115], a[196:199], v[164:167], v[112:115]
  s_cbranch_vccnz reca_retry63
reca_resume64:
  s_waitcnt vmcnt(0)
  v_cmp_eq_u32 vcc, -1, v172
  v_mfma_f32_16x16x32_bf16 v[108:111], a[200:203], v[168:171], v[108:111]
  v_mfma_f32_16x16x32_bf16 v[112:115], a[204:207], v[168:171], v[112:115]
  s_cbranch_vccnz reca_retry65
reca_resume66:
  v_mfma_f32_16x16x32_bf16 v[108:111], a[208:211], v[172:175], v[108:111]
  v_mfma_f32_16x16x32_bf16 v[112:115], a[212:215], v[172:175], v[112:115]
  s_nop 7
  v_add_f32_dpp v116, v112, v108 row_ror:8 row_mask:0xf bank_mask:0xf
  v_add_f32_dpp v117, v113, v109 row_ror:8 row_mask:0xf bank_mask:0xf
  v_add_f32_dpp v118, v114, v110 row_ror:8 row_mask:0xf bank_mask:0xf
  v_add_f32_dpp v119, v115, v111 row_ror:8 row_mask:0xf bank_mask:0xf
  buffer_store_dwordx4 v[116:119], v15, s[4:7], s25 offen sc1
  buffer_store_dwordx4 v[116:119], v232, s[4:7], s25 offen sc1
  buffer_store_dwordx4 v[32:35], v15, s[4:7], s29 offen sc1
  buffer_store_dwordx4 v[32:35], v232, s[4:7], s29 offen sc1
  s_branch reca_b427
reca_notg242:
  s_cmp_lg_u32 s12, 3
  s_cbranch_scc1 reca_b427
  s_add_u32 s34, s17, 2
  s_and_b32 s34, s34, 3
  s_mul_i32 s26, s34, 10240
  s_add_u32 s26, s26, s38
  s_mul_i32 s27, s34, 6144
  s_add_u32 s27, s27, s39
  s_mul_i32 s28, s34, 12288
  s_add_u32 s28, s28, s40
  s_mul_i32 s29, s34, 393216
  s_add_u32 s29, s29, s56
  buffer_store_dwordx2 v[32:33], v8, s[4:7], s27 offen
  buffer_store_dwordx4 v[32:35], v11, s[4:7], s28 offen
reca_b427:
  s_barrier
  s_cmp_lg_u32 s12, 2
  s_cbranch_scc1 reca_not267
  s_sleep 8
  buffer_load_dwordx4 v[128:131], v20, s[4:7], s25 offen sc1
  buffer_load_dwordx4 v[132:135], v21, s[4:7], s25 offen sc1
  buffer_load_dwordx4 v[136:139], v22, s[4:7], s25 offen sc1
  buffer_load_dwordx4 v[140:143], v23, s[4:7], s25 offen sc1
  buffer_load_dwordx4 v[144:147], v24, s[4:7], s25 offen sc1
  buffer_load_dwordx4 v[148:151], v25, s[4:7], s25 offen sc1
  buffer_load_dwordx4 v[152:155], v26, s[4:7], s25 offen sc1
  buffer_load_dwordx4 v[156:159], v27, s[4:7], s25 offen sc1
  s_waitcnt vmcnt(7)
  v_cmp_eq_u32 vcc, -1, v128
  s_cbranch_vccnz reca_retry68
reca_resume69:
  s_waitcnt vmcnt(6)
  v_cmp_eq_u32 vcc, -1, v132
  s_cbranch_vccnz reca_retry70
reca_resume71:
  s_waitcnt vmcnt(5)
  v_cmp_eq_u32 vcc, -1, v136
  v_pk_add_f32 v[116:117], v[128:129], v[132:133]
  v_pk_add_f32 v[118:119], v[130:131], v[134:135]
  s_cbranch_vccnz reca_retry72
reca_resume73:
  s_waitcnt vmcnt(4)
  v_cmp_eq_u32 vcc, -1, v140
  v_pk_add_f32 v[116:117], v[116:117], v[136:137]
  v_pk_add_f32 v[118:119], v[118:119], v[138:139]
  s_cbranch_vccnz reca_retry74
reca_resume75:
  s_waitcnt vmcnt(3)
  v_cmp_eq_u32 vcc, -1, v144
  v_pk_add_f32 v[116:117], v[116:117], v[140:141]
  v_pk_add_f32 v[118:119], v[118:119], v[142:143]
  s_cbranch_vccnz reca_retry76
reca_resume77:
  s_waitcnt vmcnt(2)
  v_cmp_eq_u32 vcc, -1, v148
  v_pk_add_f32 v[116:117], v[116:117], v[144:145]
  v_pk_add_f32 v[118:119], v[118:119], v[146:147]
  s_cbranch_vccnz reca_retry78
reca_resume79:
  s_waitcnt vmcnt(1)
  v_cmp_eq_u32 vcc, -1, v152
  v_pk_add_f32 v[116:117], v[116:117], v[148:149]
  v_pk_add_f32 v[118:119], v[118:119], v[150:151]
  s_cbranch_vccnz reca_retry80
reca_resume81:
  s_waitcnt vmcnt(0)
  v_cmp_eq_u32 vcc, -1, v156
  v_pk_add_f32 v[116:117], v[116:117], v[152:153]
  v_pk_add_f32 v[118:119], v[118:119], v[154:155]
  s_cbranch_vccnz reca_retry82
reca_resume83:
  v_pk_add_f32 v[116:117], v[116:117], v[156:157]
  v_pk_add_f32 v[118:119], v[118:119], v[158:159]
  v_cvt_pk_bf16_f32 v132, v116, v117
  v_cvt_pk_bf16_f32 v133, v118, v119
  buffer_store_dwordx2 v[132:133], v16, s[4:7], s24 offen
  s_branch reca_b528
reca_not267:
  s_cmp_lg_u32 s12, 3
  s_cbranch_scc1 reca_b528
  s_add_u32 s36, s17, 1
  s_cmp_ge_u32 s36, 63
  s_cbranch_scc1 reca_nopf84
  s_add_u32 s37, s36, 1
reca_pf85:
  buffer_load_dword v28, v233, s[4:7], 0 offen sc1
  s_waitcnt vmcnt(0)
  v_cmp_gt_i32 vcc, s37, v28
  s_cbranch_vccz reca_pfok86
  s_sleep 1
  s_sub_u32 s18, s18, 1
  s_cbranch_scc0 reca_pf85
  s_mov_b32 s18, 0
reca_pfok86:
  s_lshl_b32 s34, s15, 3
  s_and_b32 s35, s36, 7
  s_add_u32 s34, s34, s35
  s_mul_i32 s34, s34, 12288
  s_add_u32 s32, s34, 37748736
  s_lshl_b32 s35, s16, 11
  s_add_u32 s34, s34, s35
  s_add_u32 s33, s34, 40894464
  buffer_load_dwordx4 a[120:123], v1, s[4:7], s32 offen offset:0 sc1
  buffer_load_dwordx4 a[124:127], v1, s[4:7], s32 offen offset:1024 sc1
  buffer_load_dwordx4 a[128:131], v1, s[4:7], s32 offen offset:2048 sc1
  buffer_load_dwordx4 a[132:135], v1, s[4:7], s32 offen offset:3072 sc1
  buffer_load_dwordx4 a[136:139], v2, s[4:7], s32 offen offset:0 sc1
  buffer_load_dwordx4 a[140:143], v2, s[4:7], s32 offen offset:1024 sc1
  buffer_load_dwordx4 a[144:147], v2, s[4:7], s32 offen offset:2048 sc1
  buffer_load_dwordx4 a[148:151], v2, s[4:7], s32 offen offset:3072 sc1
  buffer_load_dwordx4 a[152:155], v3, s[4:7], s32 offen offset:0 sc1
  buffer_load_dwordx4 a[156:159], v3, s[4:7], s32 offen offset:1024 sc1
  buffer_load_dwordx4 a[160:163], v3, s[4:7], s32 offen offset:2048 sc1
  buffer_load_dwordx4 a[164:167], v3, s[4:7], s32 offen offset:3072 sc1
  buffer_load_dwordx4 a[168:171], v1, s[4:7], s33 offen offset:0 sc1
  buffer_load_dwordx4 a[172:175], v1, s[4:7], s33 offen offset:1024 sc1
reca_nopf84:
  buffer_store_dwordx2 v[52:53], v9, s[4:7], s30 offen
  buffer_store_dwordx2 v[68:69], v10, s[4:7], s31 offen
  buffer_store_dwordx2 v[70:71], v10, s[4:7], s31 offen offset:256
reca_b528:
  s_barrier
  s_add_u32 s17, s17, 1
  s_branch reca_step14
reca_retry17:
  s_sub_u32 s18, s18, 1
  s_cbranch_scc1 reca_retry17_to
  buffer_load_dwordx4 v[128:131], v4, s[4:7], s20 offen sc1
  buffer_load_dwordx4 v[132:135], v4, s[4:7], s20 offen offset:1024 sc1
  buffer_load_dwordx4 v[136:139], v5, s[4:7], s20 offen sc1
  s_waitcnt vmcnt(2)
  v_max_u32 v29, v128, v130
  v_cmp_eq_u32 vcc, -1, v29
  s_cbranch_vccnz reca_retry17
  s_branch reca_resume18
reca_retry17_to:
  s_mov_b32 s18, 0
  s_waitcnt vmcnt(0)
  s_branch reca_resume18
reca_retry19:
  s_sub_u32 s18, s18, 1
  s_cbranch_scc1 reca_retry19_to
  buffer_load_dwordx4 v[132:135], v4, s[4:7], s20 offen offset:1024 sc1
  buffer_load_dwordx4 v[136:139], v5, s[4:7], s20 offen sc1
  s_waitcnt vmcnt(1)
  v_max_u32 v29, v132, v134
  v_cmp_eq_u32 vcc, -1, v29
  s_cbranch_vccnz reca_retry19
  s_branch reca_resume20
reca_retry19_to:
  s_mov_b32 s18, 0
  s_waitcnt vmcnt(0)
  s_branch reca_resume20
reca_retry21:
  s_sub_u32 s18, s18, 1
  s_cbranch_scc1 reca_retry21_to
  buffer_load_dwordx4 v[136:139], v5, s[4:7], s20 offen sc1
  s_waitcnt vmcnt(0)
  v_max_u32 v29, v136, v138
  v_cmp_eq_u32 vcc, -1, v29
  s_cbranch_vccnz reca_retry21
  s_branch reca_resume22
reca_retry21_to:
  s_mov_b32 s18, 0
  s_waitcnt vmcnt(0)
  s_branch reca_resume22
reca_retry30:
  s_sub_u32 s18, s18, 1
  s_cbranch_scc1 reca_retry30_to
  buffer_load_dwordx4 v[208:211], v1, s[4:7], s21 offen offset:0 sc1
  buffer_load_dwordx4 v[212:215], v1, s[4:7], s21 offen offset:1024 sc1
  buffer_load_dwordx4 v[216:219], v1, s[4:7], s21 offen offset:2048 sc1
  buffer_load_dwordx4 v[220:223], v1, s[4:7], s21 offen offset:3072 sc1
  buffer_load_dwordx4 v[224:227], v2, s[4:7], s21 offen offset:0 sc1
  buffer_load_dwordx4 v[228:231], v2, s[4:7], s21 offen offset:1024 sc1
  s_waitcnt vmcnt(5)
  v_max_u32 v29, v208, v210
  v_cmp_eq_u32 vcc, -1, v29
  s_cbranch_vccnz reca_retry30
  s_branch reca_resume31
reca_retry30_to:
  s_mov_b32 s18, 0
  s_waitcnt vmcnt(0)
  s_branch reca_resume31
reca_retry32:
  s_sub_u32 s18, s18, 1
  s_cbranch_scc1 reca_retry32_to
  buffer_load_dwordx4 v[212:215], v1, s[4:7], s21 offen offset:1024 sc1
  buffer_load_dwordx4 v[216:219], v1, s[4:7], s21 offen offset:2048 sc1
  buffer_load_dwordx4 v[220:223], v1, s[4:7], s21 offen offset:3072 sc1
  buffer_load_dwordx4 v[224:227], v2, s[4:7], s21 offen offset:0 sc1
  buffer_load_dwordx4 v[228:231], v2, s[4:7], s21 offen offset:1024 sc1
  s_waitcnt vmcnt(4)
  v_max_u32 v29, v212, v214
  v_cmp_eq_u32 vcc, -1, v29
  s_cbranch_vccnz reca_retry32
  s_branch reca_resume33
reca_retry32_to:
  s_mov_b32 s18, 0
  s_waitcnt vmcnt(0)
  s_branch reca_resume33
reca_retry34:
  s_sub_u32 s18, s18, 1
  s_cbranch_scc1 reca_retry34_to
  buffer_load_dwordx4 v[216:219], v1, s[4:7], s21 offen offset:2048 sc1
  buffer_load_dwordx4 v[220:223], v1, s[4:7], s21 offen offset:3072 sc1
  buffer_load_dwordx4 v[224:227], v2, s[4:7], s21 offen offset:0 sc1
  buffer_load_dwordx4 v[228:231], v2, s[4:7], s21 offen offset:1024 sc1
  s_waitcnt vmcnt(3)
  v_max_u32 v29, v216, v218
  v_cmp_eq_u32 vcc, -1, v29
  s_cbranch_vccnz reca_retry34
  s_branch reca_resume35
reca_retry34_to:
  s_mov_b32 s18, 0
  s_waitcnt vmcnt(0)
  s_branch reca_resume35
reca_retry36:
  s_sub_u32 s18, s18, 1
  s_cbranch_scc1 reca_retry36_to
  buffer_load_dwordx4 v[220:223], v1, s[4:7], s21 offen offset:3072 sc1
  buffer_load_dwordx4 v[224:227], v2, s[4:7], s21 offen offset:0 sc1
  buffer_load_dwordx4 v[228:231], v2, s[4:7], s21 offen offset:1024 sc1
  s_waitcnt vmcnt(2)
  v_max_u32 v29, v220, v222
  v_cmp_eq_u32 vcc, -1, v29
  s_cbranch_vccnz reca_retry36
  s_branch reca_resume37
reca_retry36_to:
  s_mov_b32 s18, 0
  s_waitcnt vmcnt(0)
  s_branch reca_resume37
reca_retry38:
  s_sub_u32 s18, s18, 1
  s_cbranch_scc1 reca_retry38_to
  buffer_load_dwordx4 v[224:227], v2, s[4:7], s21 offen offset:0 sc1
  buffer_load_dwordx4 v[228:231], v2, s[4:7], s21 offen offset:1024 sc1
  s_waitcnt vmcnt(1)
  v_max_u32 v29, v224, v226
  v_cmp_eq_u32 vcc, -1, v29
  s_cbranch_vccnz reca_retry38
  s_branch reca_resume39
reca_retry38_to:
  s_mov_b32 s18, 0
  s_waitcnt vmcnt(0)
  s_branch reca_resume39
reca_retry40:
  s_sub_u32 s18, s18, 1
  s_cbranch_scc1 reca_retry40_to
  buffer_load_dwordx4 v[228:231], v2, s[4:7], s21 offen offset:1024 sc1
  s_waitcnt vmcnt(0)
  v_max_u32 v29, v228, v230
  v_cmp_eq_u32 vcc, -1, v29
  s_cbranch_vccnz reca_retry40
  s_branch reca_resume41
reca_retry40_to:
  s_mov_b32 s18, 0
  s_waitcnt vmcnt(0)
  s_branch reca_resume41
reca_retry43:
  s_sub_u32 s18, s18, 1
  s_cbranch_scc1 reca_retry43_to
  buffer_load_dwordx4 v[128:131], v12, s[4:7], s22 offen offset:0 sc1
  buffer_load_dwordx4 v[132:135], v12, s[4:7], s22 offen offset:1024 sc1
  buffer_load_dwordx4 v[136:139], v12, s[4:7], s22 offen offset:2048 sc1
  buffer_load_dwordx4 v[140:143], v12, s[4:7], s22 offen offset:3072 sc1
  buffer_load_dwordx4 v[144:147], v13, s[4:7], s22 offen offset:0 sc1
  buffer_load_dwordx4 v[148:151], v13, s[4:7], s22 offen offset:1024 sc1
  buffer_load_dwordx4 v[152:155], v13, s[4:7], s22 offen offset:2048 sc1
  buffer_load_dwordx4 v[156:159], v13, s[4:7], s22 offen offset:3072 sc1
  buffer_load_dwordx4 v[160:163], v14, s[4:7], s22 offen offset:0 sc1
  buffer_load_dwordx4 v[164:167], v14, s[4:7], s22 offen offset:1024 sc1
  buffer_load_dwordx4 v[168:171], v14, s[4:7], s22 offen offset:2048 sc1
  buffer_load_dwordx4 v[172:175], v14, s[4:7], s22 offen offset:3072 sc1
  s_waitcnt vmcnt(11)
  v_cmp_eq_u32 vcc, -1, v128
  s_cbranch_vccnz reca_retry43
  s_branch reca_resume44
reca_retry43_to:
  s_mov_b32 s18, 0
  s_waitcnt vmcnt(0)
  s_branch reca_resume44
reca_retry45:
  s_sub_u32 s18, s18, 1
  s_cbranch_scc1 reca_retry45_to
  buffer_load_dwordx4 v[132:135], v12, s[4:7], s22 offen offset:1024 sc1
  buffer_load_dwordx4 v[136:139], v12, s[4:7], s22 offen offset:2048 sc1
  buffer_load_dwordx4 v[140:143], v12, s[4:7], s22 offen offset:3072 sc1
  buffer_load_dwordx4 v[144:147], v13, s[4:7], s22 offen offset:0 sc1
  buffer_load_dwordx4 v[148:151], v13, s[4:7], s22 offen offset:1024 sc1
  buffer_load_dwordx4 v[152:155], v13, s[4:7], s22 offen offset:2048 sc1
  buffer_load_dwordx4 v[156:159], v13, s[4:7], s22 offen offset:3072 sc1
  buffer_load_dwordx4 v[160:163], v14, s[4:7], s22 offen offset:0 sc1
  buffer_load_dwordx4 v[164:167], v14, s[4:7], s22 offen offset:1024 sc1
  buffer_load_dwordx4 v[168:171], v14, s[4:7], s22 offen offset:2048 sc1
  buffer_load_dwordx4 v[172:175], v14, s[4:7], s22 offen offset:3072 sc1
  s_waitcnt vmcnt(10)
  v_cmp_eq_u32 vcc, -1, v132
  s_cbranch_vccnz reca_retry45
  s_branch reca_resume46
reca_retry45_to:
  s_mov_b32 s18, 0
  s_waitcnt vmcnt(0)
  s_branch reca_resume46
reca_retry47:
  s_sub_u32 s18, s18, 1
  s_cbranch_scc1 reca_retry47_to
  buffer_load_dwordx4 v[136:139], v12, s[4:7], s22 offen offset:2048 sc1
  buffer_load_dwordx4 v[140:143], v12, s[4:7], s22 offen offset:3072 sc1
  buffer_load_dwordx4 v[144:147], v13, s[4:7], s22 offen offset:0 sc1
  buffer_load_dwordx4 v[148:151], v13, s[4:7], s22 offen offset:1024 sc1
  buffer_load_dwordx4 v[152:155], v13, s[4:7], s22 offen offset:2048 sc1
  buffer_load_dwordx4 v[156:159], v13, s[4:7], s22 offen offset:3072 sc1
  buffer_load_dwordx4 v[160:163], v14, s[4:7], s22 offen offset:0 sc1
  buffer_load_dwordx4 v[164:167], v14, s[4:7], s22 offen offset:1024 sc1
  buffer_load_dwordx4 v[168:171], v14, s[4:7], s22 offen offset:2048 sc1
  buffer_load_dwordx4 v[172:175], v14, s[4:7], s22 offen offset:3072 sc1
  s_waitcnt vmcnt(9)
  v_cmp_eq_u32 vcc, -1, v136
  s_cbranch_vccnz reca_retry47
  s_branch reca_resume48
reca_retry47_to:
  s_mov_b32 s18, 0
  s_waitcnt vmcnt(0)
  s_branch reca_resume48
reca_retry49:
  s_sub_u32 s18, s18, 1
  s_cbranch_scc1 reca_retry49_to
  buffer_load_dwordx4 v[140:143], v12, s[4:7], s22 offen offset:3072 sc1
  buffer_load_dwordx4 v[144:147], v13, s[4:7], s22 offen offset:0 sc1
  buffer_load_dwordx4 v[148:151], v13, s[4:7], s22 offen offset:1024 sc1
  buffer_load_dwordx4 v[152:155], v13, s[4:7], s22 offen offset:2048 sc1
  buffer_load_dwordx4 v[156:159], v13, s[4:7], s22 offen offset:3072 sc1
  buffer_load_dwordx4 v[160:163], v14, s[4:7], s22 offen offset:0 sc1
  buffer_load_dwordx4 v[164:167], v14, s[4:7], s22 offen offset:1024 sc1
  buffer_load_dwordx4 v[168:171], v14, s[4:7], s22 offen offset:2048 sc1
  buffer_load_dwordx4 v[172:175], v14, s[4:7], s22 offen offset:3072 sc1
  s_waitcnt vmcnt(8)
  v_cmp_eq_u32 vcc, -1, v140
  s_cbranch_vccnz reca_retry49
  s_branch reca_resume50
reca_retry49_to:
  s_mov_b32 s18, 0
  s_waitcnt vmcnt(0)
  s_branch reca_resume50
reca_retry51:
  s_sub_u32 s18, s18, 1
  s_cbranch_scc1 reca_retry51_to
  buffer_load_dwordx4 v[144:147], v13, s[4:7], s22 offen offset:0 sc1
  buffer_load_dwordx4 v[148:151], v13, s[4:7], s22 offen offset:1024 sc1
  buffer_load_dwordx4 v[152:155], v13, s[4:7], s22 offen offset:2048 sc1
  buffer_load_dwordx4 v[156:159], v13, s[4:7], s22 offen offset:3072 sc1
  buffer_load_dwordx4 v[160:163], v14, s[4:7], s22 offen offset:0 sc1
  buffer_load_dwordx4 v[164:167], v14, s[4:7], s22 offen offset:1024 sc1
  buffer_load_dwordx4 v[168:171], v14, s[4:7], s22 offen offset:2048 sc1
  buffer_load_dwordx4 v[172:175], v14, s[4:7], s22 offen offset:3072 sc1
  s_waitcnt vmcnt(7)
  v_cmp_eq_u32 vcc, -1, v144
  s_cbranch_vccnz reca_retry51
  s_branch reca_resume52
reca_retry51_to:
  s_mov_b32 s18, 0
  s_waitcnt vmcnt(0)
  s_branch reca_resume52
reca_retry53:
  s_sub_u32 s18, s18, 1
  s_cbranch_scc1 reca_retry53_to
  buffer_load_dwordx4 v[148:151], v13, s[4:7], s22 offen offset:1024 sc1
  buffer_load_dwordx4 v[152:155], v13, s[4:7], s22 offen offset:2048 sc1
  buffer_load_dwordx4 v[156:159], v13, s[4:7], s22 offen offset:3072 sc1
  buffer_load_dwordx4 v[160:163], v14, s[4:7], s22 offen offset:0 sc1
  buffer_load_dwordx4 v[164:167], v14, s[4:7], s22 offen offset:1024 sc1
  buffer_load_dwordx4 v[168:171], v14, s[4:7], s22 offen offset:2048 sc1
  buffer_load_dwordx4 v[172:175], v14, s[4:7], s22 offen offset:3072 sc1
  s_waitcnt vmcnt(6)
  v_cmp_eq_u32 vcc, -1, v148
  s_cbranch_vccnz reca_retry53
  s_branch reca_resume54
reca_retry53_to:
  s_mov_b32 s18, 0
  s_waitcnt vmcnt(0)
  s_branch reca_resume54
reca_retry55:
  s_sub_u32 s18, s18, 1
  s_cbranch_scc1 reca_retry55_to
  buffer_load_dwordx4 v[152:155], v13, s[4:7], s22 offen offset:2048 sc1
  buffer_load_dwordx4 v[156:159], v13, s[4:7], s22 offen offset:3072 sc1
  buffer_load_dwordx4 v[160:163], v14, s[4:7], s22 offen offset:0 sc1
  buffer_load_dwordx4 v[164:167], v14, s[4:7], s22 offen offset:1024 sc1
  buffer_load_dwordx4 v[168:171], v14, s[4:7], s22 offen offset:2048 sc1
  buffer_load_dwordx4 v[172:175], v14, s[4:7], s22 offen offset:3072 sc1
  s_waitcnt vmcnt(5)
  v_cmp_eq_u32 vcc, -1, v152
  s_cbranch_vccnz reca_retry55
  s_branch reca_resume56
reca_retry55_to:
  s_mov_b32 s18, 0
  s_waitcnt vmcnt(0)
  s_branch reca_resume56
reca_retry57:
  s_sub_u32 s18, s18, 1
  s_cbranch_scc1 reca_retry57_to
  buffer_load_dwordx4 v[156:159], v13, s[4:7], s22 offen offset:3072 sc1
  buffer_load_dwordx4 v[160:163], v14, s[4:7], s22 offen offset:0 sc1
  buffer_load_dwordx4 v[164:167], v14, s[4:7], s22 offen offset:1024 sc1
  buffer_load_dwordx4 v[168:171], v14, s[4:7], s22 offen offset:2048 sc1
  buffer_load_dwordx4 v[172:175], v14, s[4:7], s22 offen offset:3072 sc1
  s_waitcnt vmcnt(4)
  v_cmp_eq_u32 vcc, -1, v156
  s_cbranch_vccnz reca_retry57
  s_branch reca_resume58
reca_retry57_to:
  s_mov_b32 s18, 0
  s_waitcnt vmcnt(0)
  s_branch reca_resume58
reca_retry59:
  s_sub_u32 s18, s18, 1
  s_cbranch_scc1 reca_retry59_to
  buffer_load_dwordx4 v[160:163], v14, s[4:7], s22 offen offset:0 sc1
  buffer_load_dwordx4 v[164:167], v14, s[4:7], s22 offen offset:1024 sc1
  buffer_load_dwordx4 v[168:171], v14, s[4:7], s22 offen offset:2048 sc1
  buffer_load_dwordx4 v[172:175], v14, s[4:7], s22 offen offset:3072 sc1
  s_waitcnt vmcnt(3)
  v_cmp_eq_u32 vcc, -1, v160
  s_cbranch_vccnz reca_retry59
  s_branch reca_resume60
reca_retry59_to:
  s_mov_b32 s18, 0
  s_waitcnt vmcnt(0)
  s_branch reca_resume60
reca_retry61:
  s_sub_u32 s18, s18, 1
  s_cbranch_scc1 reca_retry61_to
  buffer_load_dwordx4 v[164:167], v14, s[4:7], s22 offen offset:1024 sc1
  buffer_load_dwordx4 v[168:171], v14, s[4:7], s22 offen offset:2048 sc1
  buffer_load_dwordx4 v[172:175], v14, s[4:7], s22 offen offset:3072 sc1
  s_waitcnt vmcnt(2)
  v_cmp_eq_u32 vcc, -1, v164
  s_cbranch_vccnz reca_retry61
  s_branch reca_resume62
reca_retry61_to:
  s_mov_b32 s18, 0
  s_waitcnt vmcnt(0)
  s_branch reca_resume62
reca_retry63:
  s_sub_u32 s18, s18, 1
  s_cbranch_scc1 reca_retry63_to
  buffer_load_dwordx4 v[168:171], v14, s[4:7], s22 offen offset:2048 sc1
  buffer_load_dwordx4 v[172:175], v14, s[4:7], s22 offen offset:3072 sc1
  s_waitcnt vmcnt(1)
  v_cmp_eq_u32 vcc, -1, v168
  s_cbranch_vccnz reca_retry63
  s_branch reca_resume64
reca_retry63_to:
  s_mov_b32 s18, 0
  s_waitcnt vmcnt(0)
  s_branch reca_resume64
reca_retry65:
  s_sub_u32 s18, s18, 1
  s_cbranch_scc1 reca_retry65_to
  buffer_load_dwordx4 v[172:175], v14, s[4:7], s22 offen offset:3072 sc1
  s_waitcnt vmcnt(0)
  v_cmp_eq_u32 vcc, -1, v172
  s_cbranch_vccnz reca_retry65
  s_branch reca_resume66
reca_retry65_to:
  s_mov_b32 s18, 0
  s_waitcnt vmcnt(0)
  s_branch reca_resume66
reca_retry68:
  s_sub_u32 s18, s18, 1
  s_cbranch_scc1 reca_retry68_to
  buffer_load_dwordx4 v[128:131], v20, s[4:7], s25 offen sc1
  buffer_load_dwordx4 v[132:135], v21, s[4:7], s25 offen sc1
  buffer_load_dwordx4 v[136:139], v22, s[4:7], s25 offen sc1
  buffer_load_dwordx4 v[140:143], v23, s[4:7], s25 offen sc1
  buffer_load_dwordx4 v[144:147], v24, s[4:7], s25 offen sc1
  buffer_load_dwordx4 v[148:151], v25, s[4:7], s25 offen sc1
  buffer_load_dwordx4 v[152:155], v26, s[4:7], s25 offen sc1
  buffer_load_dwordx4 v[156:159], v27, s[4:7], s25 offen sc1
  s_waitcnt vmcnt(7)
  v_cmp_eq_u32 vcc, -1, v128
  s_cbranch_vccnz reca_retry68
  s_branch reca_resume69
reca_retry68_to:
  s_mov_b32 s18, 0
  s_waitcnt vmcnt(0)
  s_branch reca_resume69
reca_retry70:
  s_sub_u32 s18, s18, 1
  s_cbranch_scc1 reca_retry70_to
  buffer_load_dwordx4 v[132:135], v21, s[4:7], s25 offen sc1
  buffer_load_dwordx4 v[136:139], v22, s[4:7], s25 offen sc1
  buffer_load_dwordx4 v[140:143], v23, s[4:7], s25 offen sc1
  buffer_load_dwordx4 v[144:147], v24, s[4:7], s25 offen sc1
  buffer_load_dwordx4 v[148:151], v25, s[4:7], s25 offen sc1
  buffer_load_dwordx4 v[152:155], v26, s[4:7], s25 offen sc1
  buffer_load_dwordx4 v[156:159], v27, s[4:7], s25 offen sc1
  s_waitcnt vmcnt(6)
  v_cmp_eq_u32 vcc, -1, v132
  s_cbranch_vccnz reca_retry70
  s_branch reca_resume71
reca_retry70_to:
  s_mov_b32 s18, 0
  s_waitcnt vmcnt(0)
  s_branch reca_resume71
reca_retry72:
  s_sub_u32 s18, s18, 1
  s_cbranch_scc1 reca_retry72_to
  buffer_load_dwordx4 v[136:139], v22, s[4:7], s25 offen sc1
  buffer_load_dwordx4 v[140:143], v23, s[4:7], s25 offen sc1
  buffer_load_dwordx4 v[144:147], v24, s[4:7], s25 offen sc1
  buffer_load_dwordx4 v[148:151], v25, s[4:7], s25 offen sc1
  buffer_load_dwordx4 v[152:155], v26, s[4:7], s25 offen sc1
  buffer_load_dwordx4 v[156:159], v27, s[4:7], s25 offen sc1
  s_waitcnt vmcnt(5)
  v_cmp_eq_u32 vcc, -1, v136
  s_cbranch_vccnz reca_retry72
  s_branch reca_resume73
reca_retry72_to:
  s_mov_b32 s18, 0
  s_waitcnt vmcnt(0)
  s_branch reca_resume73
reca_retry74:
  s_sub_u32 s18, s18, 1
  s_cbranch_scc1 reca_retry74_to
  buffer_load_dwordx4 v[140:143], v23, s[4:7], s25 offen sc1
  buffer_load_dwordx4 v[144:147], v24, s[4:7], s25 offen sc1
  buffer_load_dwordx4 v[148:151], v25, s[4:7], s25 offen sc1
  buffer_load_dwordx4 v[152:155], v26, s[4:7], s25 offen sc1
  buffer_load_dwordx4 v[156:159], v27, s[4:7], s25 offen sc1
  s_waitcnt vmcnt(4)
  v_cmp_eq_u32 vcc, -1, v140
  s_cbranch_vccnz reca_retry74
  s_branch reca_resume75
reca_retry74_to:
  s_mov_b32 s18, 0
  s_waitcnt vmcnt(0)
  s_branch reca_resume75
reca_retry76:
  s_sub_u32 s18, s18, 1
  s_cbranch_scc1 reca_retry76_to
  buffer_load_dwordx4 v[144:147], v24, s[4:7], s25 offen sc1
  buffer_load_dwordx4 v[148:151], v25, s[4:7], s25 offen sc1
  buffer_load_dwordx4 v[152:155], v26, s[4:7], s25 offen sc1
  buffer_load_dwordx4 v[156:159], v27, s[4:7], s25 offen sc1
  s_waitcnt vmcnt(3)
  v_cmp_eq_u32 vcc, -1, v144
  s_cbranch_vccnz reca_retry76
  s_branch reca_resume77
reca_retry76_to:
  s_mov_b32 s18, 0
  s_waitcnt vmcnt(0)
  s_branch reca_resume77
reca_retry78:
  s_sub_u32 s18, s18, 1
  s_cbranch_scc1 reca_retry78_to
  buffer_load_dwordx4 v[148:151], v25, s[4:7], s25 offen sc1
  buffer_load_dwordx4 v[152:155], v26, s[4:7], s25 offen sc1
  buffer_load_dwordx4 v[156:159], v27, s[4:7], s25 offen sc1
  s_waitcnt vmcnt(2)
  v_cmp_eq_u32 vcc, -1, v148
  s_cbranch_vccnz reca_retry78
  s_branch reca_resume79
reca_retry78_to:
  s_mov_b32 s18, 0
  s_waitcnt vmcnt(0)
  s_branch reca_resume79
reca_retry80:
  s_sub_u32 s18, s18, 1
  s_cbranch_scc1 reca_retry80_to
  buffer_load_dwordx4 v[152:155], v26, s[4:7], s25 offen sc1
  buffer_load_dwordx4 v[156:159], v27, s[4:7], s25 offen sc1
  s_waitcnt vmcnt(1)
  v_cmp_eq_u32 vcc, -1, v152
  s_cbranch_vccnz reca_retry80
  s_branch reca_resume81
reca_retry80_to:
  s_mov_b32 s18, 0
  s_waitcnt vmcnt(0)
  s_branch reca_resume81
reca_retry82:
  s_sub_u32 s18, s18, 1
  s_cbranch_scc1 reca_retry82_to
  buffer_load_dwordx4 v[156:159], v27, s[4:7], s25 offen sc1
  s_waitcnt vmcnt(0)
  v_cmp_eq_u32 vcc, -1, v156
  s_cbranch_vccnz reca_retry82
  s_branch reca_resume83
reca_retry82_to:
  s_mov_b32 s18, 0
  s_waitcnt vmcnt(0)
  s_branch reca_resume83
reca_twinf12:
  s_branch reca_gotmem88
reca_step87:
  s_and_b32 s34, s17, 3
  s_mul_i32 s20, s34, 10240
  s_add_u32 s20, s20, s38
  s_sleep 5
  buffer_load_dwordx4 v[128:131], v4, s[4:7], s20 offen sc1
  buffer_load_dwordx4 v[132:135], v4, s[4:7], s20 offen offset:1024 sc1
  buffer_load_dwordx4 v[136:139], v5, s[4:7], s20 offen sc1
  s_waitcnt vmcnt(2)
  v_max_u32 v29, v128, v130
  v_cmp_eq_u32 vcc, -1, v29
  s_cbranch_vccnz reca_retry90
reca_resume91:
  s_waitcnt vmcnt(1)
  v_max_u32 v29, v132, v134
  v_cmp_eq_u32 vcc, -1, v29
  ds_write_b128 v4, v[128:131]
  s_cbranch_vccnz reca_retry92
reca_resume93:
  s_waitcnt vmcnt(0)
  v_max_u32 v29, v136, v138
  v_cmp_eq_u32 vcc, -1, v29
  ds_write_b128 v4, v[132:135] offset:1024
  s_cbranch_vccnz reca_retry94
reca_resume95:
  ds_write_b128 v5, v[136:139]
  s_branch reca_gotmem289
reca_gotmem88:
  ds_write_b128 v4, v[128:131]
  ds_write_b128 v4, v[132:135] offset:1024
  ds_write_b128 v5, v[136:139]
reca_gotmem289:
  s_and_b32 s34, s17, 3
  s_mul_i32 s21, s34, 6144
  s_add_u32 s21, s21, s39
  s_mul_i32 s22, s34, 12288
  s_add_u32 s22, s22, s40
  s_mul_i32 s25, s34, 393216
  s_add_u32 s25, s25, s56
  s_add_u32 s35, s17, 1
  s_and_b32 s35, s35, 3
  s_mul_i32 s24, s35, 10240
  s_add_u32 s24, s24, s38
  s_waitcnt lgkmcnt(0)
  s_barrier
  ds_read_b128 v[128:131], v236 offset:0
  ds_read_b128 v[132:135], v236 offset:1024
  ds_read_b128 v[136:139], v236 offset:2048
  ds_read_b128 v[140:143], v236 offset:3072
  ds_read_b128 v[144:147], v236 offset:4096
  ds_read_b128 v[148:151], v237 offset:0
  ds_read_b128 v[152:155], v237 offset:1024
  ds_read_b128 v[156:159], v237 offset:2048
  ds_read_b128 v[160:163], v237 offset:3072
  ds_read_b128 v[164:167], v237 offset:4096
  s_waitcnt lgkmcnt(9)
  v_mfma_f32_16x16x32_bf16 v[44:47], a[0:3], v[128:131], 0
  ds_read_b128 v[168:171], v6 offset:0
  v_mfma_f32_16x16x32_bf16 v[240:243], a[4:7], v[128:131], 0
  s_waitcnt lgkmcnt(9)
  v_mfma_f32_16x16x32_bf16 v[44:47], a[8:11], v[132:135], v[44:47]
  ds_read_b128 v[172:175], v6 offset:512
  v_mfma_f32_16x16x32_bf16 v[240:243], a[12:15], v[132:135], v[240:243]
  s_waitcnt lgkmcnt(9)
  v_mfma_f32_16x16x32_bf16 v[44:47], a[16:19], v[136:139], v[44:47]
  ds_read_b128 v[176:179], v6 offset:1024
  v_mfma_f32_16x16x32_bf16 v[240:243], a[20:23], v[136:139], v[240:243]
  s_waitcnt lgkmcnt(9)
  v_mfma_f32_16x16x32_bf16 v[44:47], a[24:27], v[140:143], v[44:47]
  ds_read_b128 v[180:183], v6 offset:1536
  v_mfma_f32_16x16x32_bf16 v[240:243], a[28:31], v[140:143], v[240:243]
  s_waitcnt lgkmcnt(9)
  v_mfma_f32_16x16x32_bf16 v[44:47], a[32:35], v[144:147], v[44:47]
  ds_read_b128 v[184:187], v6 offset:2048
  v_mfma_f32_16x16x32_bf16 v[240:243], a[36:39], v[144:147], v[240:243]
  s_waitcnt lgkmcnt(9)
  v_mfma_f32_16x16x32_bf16 v[44:47], a[40:43], v[148:151], v[44:47]
  ds_read_b128 v[188:191], v6 offset:2560
  v_mfma_f32_16x16x32_bf16 v[240:243], a[44:47], v[148:151], v[240:243]
  s_waitcnt lgkmcnt(9)
  v_mfma_f32_16x16x32_bf16 v[44:47], a[48:51], v[152:155], v[44:47]
  ds_read_b128 v[192:195], v6 offset:3072
  v_mfma_f32_16x16x32_bf16 v[240:243], a[52:55], v[152:155], v[240:243]
  s_waitcnt lgkmcnt(9)
  v_mfma_f32_16x16x32_bf16 v[44:47], a[56:59], v[156:159], v[44:47]
  ds_read_b128 v[196:199], v6 offset:3584
  v_mfma_f32_16x16x32_bf16 v[240:243], a[60:63], v[156:159], v[240:243]
  s_waitcnt lgkmcnt(9)
  v_mfma_f32_16x16x32_bf16 v[44:47], a[64:67], v[160:163], v[44:47]
  ds_read_b128 v[200:203], v6 offset:4096
  v_mfma_f32_16x16x32_bf16 v[240:243], a[68:71], v[160:163], v[240:243]
  s_waitcnt lgkmcnt(9)
  v_mfma_f32_16x16x32_bf16 v[44:47], a[72:75], v[164:167], v[44:47]
  ds_read_b128 v[204:207], v6 offset:4608
  v_mfma_f32_16x16x32_bf16 v[240:243], a[76:79], v[164:167], v[240:243]
  s_waitcnt lgkmcnt(9)
  v_mfma_f32_16x16x32_bf16 v[48:51], v[168:171], a[80:83], 0
  s_and_b32 s34, s17, 7
  s_lshl_b32 s34, s34, 5
  s_add_u32 s34, s34, s15
  s_mul_i32 s34, s34, 3072
  s_lshl_b32 s35, s16, 9
  s_add_u32 s34, s34, s35
  s_add_u32 s30, s34, 47185920
  s_add_u32 s31, s34, 47972352
  v_add_f32_dpp v44, v240, v44 row_ror:8 row_mask:0xf bank_mask:0xf
  v_add_f32_dpp v45, v241, v45 row_ror:8 row_mask:0xf bank_mask:0xf
  v_add_f32_dpp v46, v242, v46 row_ror:8 row_mask:0xf bank_mask:0xf
  v_add_f32_dpp v47, v243, v47 row_ror:8 row_mask:0xf bank_mask:0xf
  v_cvt_pk_bf16_f32 v52, v44, v45
  v_cvt_pk_bf16_f32 v53, v46, v47
  buffer_store_dwordx2 v[52:53], v8, s[4:7], s21 offen
  s_waitcnt lgkmcnt(8)
  v_mfma_f32_16x16x32_bf16 v[48:51], v[172:175], a[84:87], v[48:51]
  s_waitcnt lgkmcnt(7)
  v_mfma_f32_16x16x32_bf16 v[48:51], v[176:179], a[88:91], v[48:51]
  s_waitcnt lgkmcnt(6)
  v_mfma_f32_16x16x32_bf16 v[48:51], v[180:183], a[92:95], v[48:51]
  s_waitcnt lgkmcnt(5)
  v_mfma_f32_16x16x32_bf16 v[48:51], v[184:187], a[96:99], v[48:51]
  s_waitcnt lgkmcnt(4)
  v_mfma_f32_16x16x32_bf16 v[48:51], v[188:191], a[100:103], v[48:51]
  s_waitcnt lgkmcnt(3)
  v_mfma_f32_16x16x32_bf16 v[48:51], v[192:195], a[104:107], v[48:51]
  s_waitcnt lgkmcnt(2)
  v_mfma_f32_16x16x32_bf16 v[48:51], v[196:199], a[108:111], v[48:51]
  s_waitcnt lgkmcnt(1)
  v_mfma_f32_16x16x32_bf16 v[48:51], v[200:203], a[112:115], v[48:51]
  s_waitcnt lgkmcnt(0)
  v_mfma_f32_16x16x32_bf16 v[48:51], v[204:207], a[116:119], v[48:51]
  s_cmp_eq_u32 s12, 3
  s_cbranch_scc1 reca_swave96
  s_nop 5
  ds_write_b128 v17, v[48:51]
  s_add_u32 s34, s17, 2
  s_and_b32 s34, s34, 3
  s_mul_i32 s26, s34, 10240
  s_add_u32 s26, s26, s38
  s_mul_i32 s27, s34, 6144
  s_add_u32 s27, s27, s39
  s_mul_i32 s28, s34, 12288
  s_add_u32 s28, s28, s40
  s_mul_i32 s29, s34, 393216
  s_add_u32 s29, s29, s56
  s_waitcnt lgkmcnt(0)
  s_barrier
  s_cmp_eq_u32 s17, 63
  s_cbranch_scc1 reca_last98
  buffer_store_dwordx2 v[32:33], v8, s[4:7], s27 offen
  s_cmp_lg_u32 s12, 2
  s_cbranch_scc1 reca_tw1102_n
  buffer_store_dwordx2 v[52:53], v9, s[4:7], s30 offen
reca_tw1102_n:
  s_barrier
  s_cmp_eq_u32 s12, 1
  s_cbranch_scc1 reca_tw1102
  s_cmp_eq_u32 s12, 2
  s_cbranch_scc1 reca_tw2103
  s_cmp_lt_u32 s17, 2
  s_cbranch_scc1 reca_b5101
  s_cmp_gt_u32 s17, 61
  s_cbranch_scc1 reca_b5101
  s_sub_u32 s36, s17, 2
  s_and_b32 s36, s36, 7
  s_lshl_b32 s34, s59, 3
  s_add_u32 s34, s34, s36
  s_mul_i32 s34, s34, 12288
  s_add_u32 s23, s34, 37748736
  s_add_u32 s60, s34, 44040192
  s_lshl_b32 s35, s36, 5
  s_add_u32 s35, s35, s59
  s_mul_i32 s35, s35, 3072
  s_add_u32 s61, s35, 47185920
  buffer_load_dwordx4 a[120:123], v1, s[4:7], s23 offen offset:0 sc1
  buffer_load_dwordx4 a[124:127], v1, s[4:7], s23 offen offset:1024 sc1
  buffer_load_dwordx4 a[128:131], v1, s[4:7], s23 offen offset:2048 sc1
  buffer_load_dwordx4 a[132:135], v1, s[4:7], s23 offen offset:3072 sc1
  buffer_load_dwordx4 a[136:139], v2, s[4:7], s23 offen offset:0 sc1
  buffer_load_dwordx4 a[140:143], v2, s[4:7], s23 offen offset:1024 sc1
  buffer_load_dwordx4 a[144:147], v2, s[4:7], s23 offen offset:2048 sc1
  buffer_load_dwordx4 a[148:151], v2, s[4:7], s23 offen offset:3072 sc1
  buffer_load_dwordx4 a[152:155], v3, s[4:7], s23 offen offset:0 sc1
  buffer_load_dwordx4 a[156:159], v3, s[4:7], s23 offen offset:1024 sc1
  buffer_load_dwordx4 a[160:163], v3, s[4:7], s23 offen offset:2048 sc1
  buffer_load_dwordx4 a[164:167], v3, s[4:7], s23 offen offset:3072 sc1
  buffer_load_dwordx4 a[216:219], v92, s[4:7], s61 offen offset:0 sc1
  buffer_load_dwordx4 a[220:223], v92, s[4:7], s61 offen offset:512 sc1
  buffer_load_dwordx4 a[224:227], v92, s[4:7], s61 offen offset:1024 sc1
  buffer_load_dwordx4 a[228:231], v92, s[4:7], s61 offen offset:1536 sc1
  buffer_load_dwordx4 a[232:235], v92, s[4:7], s61 offen offset:2048 sc1
  buffer_load_dwordx4 a[236:239], v92, s[4:7], s61 offen offset:2560 sc1
  buffer_load_dwordx4 a[168:171], v1, s[4:7], s60 offen offset:0 sc1
  buffer_load_dwordx4 a[172:175], v1, s[4:7], s60 offen offset:1024 sc1
  buffer_load_dwordx4 a[176:179], v1, s[4:7], s60 offen offset:2048 sc1
  buffer_load_dwordx4 a[180:183], v1, s[4:7], s60 offen offset:3072 sc1
  buffer_load_dwordx4 a[184:187], v2, s[4:7], s60 offen offset:0 sc1
  buffer_load_dwordx4 a[188:191], v2, s[4:7], s60 offen offset:1024 sc1
  buffer_load_dwordx4 a[192:195], v2, s[4:7], s60 offen offset:2048 sc1
  buffer_load_dwordx4 a[196:199], v2, s[4:7], s60 offen offset:3072 sc1
  buffer_load_dwordx4 a[200:203], v3, s[4:7], s60 offen offset:0 sc1
  buffer_load_dwordx4 a[204:207], v3, s[4:7], s60 offen offset:1024 sc1
  buffer_load_dwordx4 a[208:211], v3, s[4:7], s60 offen offset:2048 sc1
  buffer_load_dwordx4 a[212:215], v3, s[4:7], s60 offen offset:3072 sc1
  s_waitcnt vmcnt(5)
  v_mfma_f32_16x16x32_bf16 v[128:131], a[216:219], a[168:171], v[84:87]
  v_mfma_f32_16x16x32_bf16 v[132:135], a[120:123], a[168:171], v[88:91]
  v_mfma_f32_16x16x32_bf16 v[136:139], a[216:219], a[192:195], v[84:87]
  v_mfma_f32_16x16x32_bf16 v[140:143], a[120:123], a[192:195], 0
  v_mfma_f32_16x16x32_bf16 v[144:147], a[144:147], a[192:195], v[88:91]
  s_waitcnt vmcnt(4)
  v_mfma_f32_16x16x32_bf16 v[128:131], a[220:223], a[172:175], v[128:131]
  v_mfma_f32_16x16x32_bf16 v[132:135], a[124:127], a[172:175], v[132:135]
  v_mfma_f32_16x16x32_bf16 v[136:139], a[220:223], a[196:199], v[136:139]
  v_mfma_f32_16x16x32_bf16 v[140:143], a[124:127], a[196:199], v[140:143]
  v_mfma_f32_16x16x32_bf16 v[144:147], a[148:151], a[196:199], v[144:147]
  s_waitcnt vmcnt(3)
  v_mfma_f32_16x16x32_bf16 v[128:131], a[224:227], a[176:179], v[128:131]
  v_mfma_f32_16x16x32_bf16 v[132:135], a[128:131], a[176:179], v[132:135]
  v_mfma_f32_16x16x32_bf16 v[136:139], a[224:227], a[200:203], v[136:139]
  v_mfma_f32_16x16x32_bf16 v[140:143], a[128:131], a[200:203], v[140:143]
  v_mfma_f32_16x16x32_bf16 v[144:147], a[152:155], a[200:203], v[144:147]
  s_waitcnt vmcnt(2)
  v_mfma_f32_16x16x32_bf16 v[128:131], a[228:231], a[180:183], v[128:131]
  v_mfma_f32_16x16x32_bf16 v[132:135], a[132:135], a[180:183], v[132:135]
  v_mfma_f32_16x16x32_bf16 v[136:139], a[228:231], a[204:207], v[136:139]
  v_mfma_f32_16x16x32_bf16 v[140:143], a[132:135], a[204:207], v[140:143]
  v_mfma_f32_16x16x32_bf16 v[144:147], a[156:159], a[204:207], v[144:147]
  s_waitcnt vmcnt(1)
  v_mfma_f32_16x16x32_bf16 v[128:131], a[232:235], a[184:187], v[128:131]
  v_mfma_f32_16x16x32_bf16 v[132:135], a[136:139], a[184:187], v[132:135]
  v_mfma_f32_16x16x32_bf16 v[136:139], a[232:235], a[208:211], v[136:139]
  v_mfma_f32_16x16x32_bf16 v[140:143], a[136:139], a[208:211], v[140:143]
  v_mfma_f32_16x16x32_bf16 v[144:147], a[160:163], a[208:211], v[144:147]
  s_waitcnt vmcnt(0)
  v_mfma_f32_16x16x32_bf16 v[128:131], a[236:239], a[188:191], v[128:131]
  v_mfma_f32_16x16x32_bf16 v[132:135], a[140:143], a[188:191], v[132:135]
  v_mfma_f32_16x16x32_bf16 v[136:139], a[236:239], a[212:215], v[136:139]
  v_mfma_f32_16x16x32_bf16 v[140:143], a[140:143], a[212:215], v[140:143]
  v_mfma_f32_16x16x32_bf16 v[144:147], a[164:167], a[212:215], v[144:147]
  s_nop 3
  v_max3_f32 v28, v128, v129, v130
  v_max3_f32 v28, v28, v131, v132
  v_max3_f32 v28, v28, v133, v134
  v_max_f32 v28, v28, v135
  v_mov_b32 v29, v28
  s_nop 1
  v_permlane32_swap_b32 v28, v29
  v_max_f32 v28, v28, v29
  v_mov_b32 v29, v28
  s_nop 1
  v_permlane16_swap_b32 v28, v29
  v_max_f32 v28, v28, v29
  v_mul_f32 v28, s41, v28
  v_fma_f32 v128, v128, s41, -v28
  v_fma_f32 v129, v129, s41, -v28
  v_fma_f32 v130, v130, s41, -v28
  v_fma_f32 v131, v131, s41, -v28
  v_fma_f32 v132, v132, s41, -v28
  v_fma_f32 v133, v133, s41, -v28
  v_fma_f32 v134, v134, s41, -v28
  v_fma_f32 v135, v135, s41, -v28
  v_exp_f32 v128, v128
  v_exp_f32 v129, v129
  v_exp_f32 v130, v130
  v_exp_f32 v131, v131
  v_exp_f32 v132, v132
  v_exp_f32 v133, v133
  v_exp_f32 v134, v134
  v_exp_f32 v135, v135
  v_max3_f32 v30, v136, v137, v138
  v_max3_f32 v30, v30, v139, v140
  v_max3_f32 v30, v30, v141, v142
  v_max3_f32 v30, v30, v143, v144
  v_max3_f32 v30, v30, v145, v146
  v_max_f32 v30, v30, v147
  v_mov_b32 v29, v30
  s_nop 1
  v_permlane32_swap_b32 v30, v29
  v_max_f32 v30, v30, v29
  v_mov_b32 v29, v30
  s_nop 1
  v_permlane16_swap_b32 v30, v29
  v_max_f32 v30, v30, v29
  v_mul_f32 v30, s41, v30
  v_fma_f32 v136, v136, s41, -v30
  v_fma_f32 v137, v137, s41, -v30
  v_fma_f32 v138, v138, s41, -v30
  v_fma_f32 v139, v139, s41, -v30
  v_fma_f32 v140, v140, s41, -v30
  v_fma_f32 v141, v141, s41, -v30
  v_fma_f32 v142, v142, s41, -v30
  v_fma_f32 v143, v143, s41, -v30
  v_fma_f32 v144, v144, s41, -v30
  v_fma_f32 v145, v145, s41, -v30
  v_fma_f32 v146, v146, s41, -v30
  v_fma_f32 v147, v147, s41, -v30
  v_exp_f32 v136, v136
  v_exp_f32 v137, v137
  v_exp_f32 v138, v138
  v_exp_f32 v139, v139
  v_exp_f32 v140, v140
  v_exp_f32 v141, v141
  v_exp_f32 v142, v142
  v_exp_f32 v143, v143
  v_exp_f32 v144, v144
  v_exp_f32 v145, v145
  v_exp_f32 v146, v146
  v_exp_f32 v147, v147
  v_cvt_pk_bf16_f32 v72, v128, v129
  v_cvt_pk_bf16_f32 v73, v130, v131
  v_cvt_pk_bf16_f32 v74, v132, v133
  v_cvt_pk_bf16_f32 v75, v134, v135
  v_cvt_pk_bf16_f32 v76, v136, v137
  v_cvt_pk_bf16_f32 v77, v138, v139
  v_cvt_pk_bf16_f32 v78, v140, v141
  v_cvt_pk_bf16_f32 v79, v142, v143
  v_cvt_pk_bf16_f32 v80, v144, v145
  v_cvt_pk_bf16_f32 v81, v146, v147
  v_mfma_f32_16x16x16_bf16 v[148:151], v[36:37], v[72:73], 0
  v_mfma_f32_16x16x16_bf16 v[152:155], v[36:37], v[76:77], 0
  v_mfma_f32_16x16x16_bf16 v[148:151], v[36:37], v[74:75], v[148:151]
  v_mfma_f32_16x16x32_bf16 v[152:155], v[36:39], v[78:81], v[152:155]
  s_nop 6
  v_rcp_f32 v82, v148
  v_rcp_f32 v83, v152
  s_and_b32 s34, s17, 1
  s_mul_i32 s34, s34, 3072
  v_add_u32 v28, s34, v1
  ds_write_b128 v28, v[72:75] offset:16384
  ds_write_b128 v28, v[76:79] offset:17408
  ds_write_b128 v28, v[80:83] offset:18432
  s_waitcnt lgkmcnt(0)
  s_branch reca_b5101
reca_tw1102:
  s_cmp_lt_u32 s17, 3
  s_cbranch_scc1 reca_b5101
  s_sub_u32 s36, s17, 3
  s_and_b32 s37, s36, 7
  s_lshl_b32 s34, s59, 3
  s_add_u32 s34, s34, s37
  s_mul_i32 s34, s34, 12288
  s_add_u32 s23, s34, 40894464
  s_lshl_b32 s35, s37, 5
  s_add_u32 s35, s35, s59
  s_mul_i32 s35, s35, 3072
  s_add_u32 s61, s35, 47972352
  s_mul_i32 s34, s36, 393216
  s_mul_i32 s35, s59, 6144
  s_add_u32 s34, s34, s35
  s_add_u32 s60, s34, 57147392
  s_add_u32 s34, s17, 1
  s_and_b32 s34, s34, 1
  s_mul_i32 s34, s34, 3072
  v_add_u32 v28, s34, v1
  ds_read_b128 v[72:75], v28 offset:16384
  ds_read_b128 v[76:79], v28 offset:17408
  ds_read_b128 v[80:83], v28 offset:18432
  buffer_load_dwordx2 a[168:169], v93, s[4:7], s61 offen offset:0 sc1
  buffer_load_dwordx4 a[120:123], v1, s[4:7], s23 offen offset:0 sc1
  buffer_load_dwordx2 a[170:171], v93, s[4:7], s61 offen offset:256 sc1
  buffer_load_dwordx4 a[124:127], v1, s[4:7], s23 offen offset:1024 sc1
  buffer_load_dwordx2 a[172:173], v93, s[4:7], s61 offen offset:512 sc1
  buffer_load_dwordx4 a[128:131], v1, s[4:7], s23 offen offset:2048 sc1
  buffer_load_dwordx2 a[174:175], v93, s[4:7], s61 offen offset:768 sc1
  buffer_load_dwordx4 a[132:135], v1, s[4:7], s23 offen offset:3072 sc1
  buffer_load_dwordx2 a[176:177], v93, s[4:7], s61 offen offset:1024 sc1
  buffer_load_dwordx4 a[136:139], v2, s[4:7], s23 offen offset:0 sc1
  buffer_load_dwordx2 a[178:179], v93, s[4:7], s61 offen offset:1280 sc1
  buffer_load_dwordx4 a[140:143], v2, s[4:7], s23 offen offset:1024 sc1
  s_waitcnt lgkmcnt(0)
  s_waitcnt vmcnt(8)
  v_mfma_f32_16x16x16_bf16 v[156:159], a[168:169], v[72:73], 0
  v_mfma_f32_16x16x16_bf16 v[160:163], a[168:169], v[76:77], 0
  v_mfma_f32_16x16x16_bf16 v[156:159], a[120:121], v[74:75], v[156:159]
  v_mfma_f32_16x16x32_bf16 v[160:163], a[120:123], v[78:81], v[160:163]
  v_mfma_f32_16x16x16_bf16 v[164:167], a[170:171], v[72:73], 0
  v_mfma_f32_16x16x16_bf16 v[168:171], a[170:171], v[76:77], 0
  v_mfma_f32_16x16x16_bf16 v[164:167], a[124:125], v[74:75], v[164:167]
  v_mfma_f32_16x16x32_bf16 v[168:171], a[124:127], v[78:81], v[168:171]
  s_nop 2
  v_mul_f32 v156, v156, v82
  v_mul_f32 v157, v157, v82
  v_mul_f32 v158, v158, v82
  v_mul_f32 v159, v159, v82
  v_cvt_pk_bf16_f32 v172, v156, v157
  v_cvt_pk_bf16_f32 v173, v158, v159
  v_mul_f32 v164, v164, v82
  v_mul_f32 v165, v165, v82
  v_mul_f32 v166, v166, v82
  v_mul_f32 v167, v167, v82
  v_cvt_pk_bf16_f32 v174, v164, v165
  v_cvt_pk_bf16_f32 v175, v166, v167
  buffer_store_dwordx4 v[172:175], v1, s[4:7], s60 offen offset:0 sc1
  v_mul_f32 v160, v160, v83
  v_mul_f32 v161, v161, v83
  v_mul_f32 v162, v162, v83
  v_mul_f32 v163, v163, v83
  v_cvt_pk_bf16_f32 v176, v160, v161
  v_cvt_pk_bf16_f32 v177, v162, v163
  v_mul_f32 v168, v168, v83
  v_mul_f32 v169, v169, v83
  v_mul_f32 v170, v170, v83
  v_mul_f32 v171, v171, v83
  v_cvt_pk_bf16_f32 v178, v168, v169
  v_cvt_pk_bf16_f32 v179, v170, v171
  s_add_u32 s34, s60, 196608
  buffer_store_dwordx4 v[176:179], v1, s[4:7], s34 offen offset:0 sc1
  s_waitcnt vmcnt(6)
  v_mfma_f32_16x16x16_bf16 v[156:159], a[172:173], v[72:73], 0
  v_mfma_f32_16x16x16_bf16 v[160:163], a[172:173], v[76:77], 0
  v_mfma_f32_16x16x16_bf16 v[156:159], a[128:129], v[74:75], v[156:159]
  v_mfma_f32_16x16x32_bf16 v[160:163], a[128:131], v[78:81], v[160:163]
  v_mfma_f32_16x16x16_bf16 v[164:167], a[174:175], v[72:73], 0
  v_mfma_f32_16x16x16_bf16 v[168:171], a[174:175], v[76:77], 0
  v_mfma_f32_16x16x16_bf16 v[164:167], a[132:133], v[74:75], v[164:167]
  v_mfma_f32_16x16x32_bf16 v[168:171], a[132:135], v[78:81], v[168:171]
  s_nop 2
  v_mul_f32 v156, v156, v82
  v_mul_f32 v157, v157, v82
  v_mul_f32 v158, v158, v82
  v_mul_f32 v159, v159, v82
  v_cvt_pk_bf16_f32 v172, v156, v157
  v_cvt_pk_bf16_f32 v173, v158, v159
  v_mul_f32 v164, v164, v82
  v_mul_f32 v165, v165, v82
  v_mul_f32 v166, v166, v82
  v_mul_f32 v167, v167, v82
  v_cvt_pk_bf16_f32 v174, v164, v165
  v_cvt_pk_bf16_f32 v175, v166, v167
  buffer_store_dwordx4 v[172:175], v1, s[4:7], s60 offen offset:1024 sc1
  v_mul_f32 v160, v160, v83
  v_mul_f32 v161, v161, v83
  v_mul_f32 v162, v162, v83
  v_mul_f32 v163, v163, v83
  v_cvt_pk_bf16_f32 v176, v160, v161
  v_cvt_pk_bf16_f32 v177, v162, v163
  v_mul_f32 v168, v168, v83
  v_mul_f32 v169, v169, v83
  v_mul_f32 v170, v170, v83
  v_mul_f32 v171, v171, v83
  v_cvt_pk_bf16_f32 v178, v168, v169
  v_cvt_pk_bf16_f32 v179, v170, v171
  s_add_u32 s34, s60, 196608
  buffer_store_dwordx4 v[176:179], v1, s[4:7], s34 offen offset:1024 sc1
  s_waitcnt vmcnt(4)
  v_mfma_f32_16x16x16_bf16 v[156:159], a[176:177], v[72:73], 0
  v_mfma_f32_16x16x16_bf16 v[160:163], a[176:177], v[76:77], 0
  v_mfma_f32_16x16x16_bf16 v[156:159], a[136:137], v[74:75], v[156:159]
  v_mfma_f32_16x16x32_bf16 v[160:163], a[136:139], v[78:81], v[160:163]
  v_mfma_f32_16x16x16_bf16 v[164:167], a[178:179], v[72:73], 0
  v_mfma_f32_16x16x16_bf16 v[168:171], a[178:179], v[76:77], 0
  v_mfma_f32_16x16x16_bf16 v[164:167], a[140:141], v[74:75], v[164:167]
  v_mfma_f32_16x16x32_bf16 v[168:171], a[140:143], v[78:81], v[168:171]
  s_nop 2
  v_mul_f32 v156, v156, v82
  v_mul_f32 v157, v157, v82
  v_mul_f32 v158, v158, v82
  v_mul_f32 v159, v159, v82
  v_cvt_pk_bf16_f32 v172, v156, v157
  v_cvt_pk_bf16_f32 v173, v158, v159
  v_mul_f32 v164, v164, v82
  v_mul_f32 v165, v165, v82
  v_mul_f32 v166, v166, v82
  v_mul_f32 v167, v167, v82
  v_cvt_pk_bf16_f32 v174, v164, v165
  v_cvt_pk_bf16_f32 v175, v166, v167
  buffer_store_dwordx4 v[172:175], v1, s[4:7], s60 offen offset:2048 sc1
  v_mul_f32 v160, v160, v83
  v_mul_f32 v161, v161, v83
  v_mul_f32 v162, v162, v83
  v_mul_f32 v163, v163, v83
  v_cvt_pk_bf16_f32 v176, v160, v161
  v_cvt_pk_bf16_f32 v177, v162, v163
  v_mul_f32 v168, v168, v83
  v_mul_f32 v169, v169, v83
  v_mul_f32 v170, v170, v83
  v_mul_f32 v171, v171, v83
  v_cvt_pk_bf16_f32 v178, v168, v169
  v_cvt_pk_bf16_f32 v179, v170, v171
  s_add_u32 s34, s60, 196608
  buffer_store_dwordx4 v[176:179], v1, s[4:7], s34 offen offset:2048 sc1
  s_branch reca_b5101
reca_tw2103:
  s_cmp_lt_u32 s17, 3
  s_cbranch_scc1 reca_b5101
  s_sub_u32 s36, s17, 3
  s_and_b32 s37, s36, 7
  s_lshl_b32 s34, s59, 3
  s_add_u32 s34, s34, s37
  s_mul_i32 s34, s34, 12288
  s_add_u32 s23, s34, 40894464
  s_lshl_b32 s35, s37, 5
  s_add_u32 s35, s35, s59
  s_mul_i32 s35, s35, 3072
  s_add_u32 s61, s35, 47972352
  s_mul_i32 s34, s36, 393216
  s_mul_i32 s35, s59, 6144
  s_add_u32 s34, s34, s35
  s_add_u32 s60, s34, 57147392
  s_add_u32 s34, s17, 1
  s_and_b32 s34, s34, 1
  s_mul_i32 s34, s34, 3072
  v_add_u32 v28, s34, v1
  ds_read_b128 v[72:75], v28 offset:16384
  ds_read_b128 v[76:79], v28 offset:17408
  ds_read_b128 v[80:83], v28 offset:18432
  buffer_load_dwordx2 a[180:181], v93, s[4:7], s61 offen offset:1536 sc1
  buffer_load_dwordx4 a[144:147], v2, s[4:7], s23 offen offset:2048 sc1
  buffer_load_dwordx2 a[182:183], v93, s[4:7], s61 offen offset:1792 sc1
  buffer_load_dwordx4 a[148:151], v2, s[4:7], s23 offen offset:3072 sc1
  buffer_load_dwordx2 a[184:185], v93, s[4:7], s61 offen offset:2048 sc1
  buffer_load_dwordx4 a[152:155], v3, s[4:7], s23 offen offset:0 sc1
  buffer_load_dwordx2 a[186:187], v93, s[4:7], s61 offen offset:2304 sc1
  buffer_load_dwordx4 a[156:159], v3, s[4:7], s23 offen offset:1024 sc1
  buffer_load_dwordx2 a[188:189], v93, s[4:7], s61 offen offset:2560 sc1
  buffer_load_dwordx4 a[160:163], v3, s[4:7], s23 offen offset:2048 sc1
  buffer_load_dwordx2 a[190:191], v93, s[4:7], s61 offen offset:2816 sc1
  buffer_load_dwordx4 a[164:167], v3, s[4:7], s23 offen offset:3072 sc1
  s_waitcnt lgkmcnt(0)
  s_waitcnt vmcnt(8)
  v_mfma_f32_16x16x16_bf16 v[156:159], a[180:181], v[72:73], 0
  v_mfma_f32_16x16x16_bf16 v[160:163], a[180:181], v[76:77], 0
  v_mfma_f32_16x16x16_bf16 v[156:159], a[144:145], v[74:75], v[156:159]
  v_mfma_f32_16x16x32_bf16 v[160:163], a[144:147], v[78:81], v[160:163]
  v_mfma_f32_16x16x16_bf16 v[164:167], a[182:183], v[72:73], 0
  v_mfma_f32_16x16x16_bf16 v[168:171], a[182:183], v[76:77], 0
  v_mfma_f32_16x16x16_bf16 v[164:167], a[148:149], v[74:75], v[164:167]
  v_mfma_f32_16x16x32_bf16 v[168:171], a[148:151], v[78:81], v[168:171]
  s_nop 2
  v_mul_f32 v156, v156, v82
  v_mul_f32 v157, v157, v82
  v_mul_f32 v158, v158, v82
  v_mul_f32 v159, v159, v82
  v_cvt_pk_bf16_f32 v172, v156, v157
  v_cvt_pk_bf16_f32 v173, v158, v159
  v_mul_f32 v164, v164, v82
  v_mul_f32 v165, v165, v82
  v_mul_f32 v166, v166, v82
  v_mul_f32 v167, v167, v82
  v_cvt_pk_bf16_f32 v174, v164, v165
  v_cvt_pk_bf16_f32 v175, v166, v167
  buffer_store_dwordx4 v[172:175], v1, s[4:7], s60 offen offset:3072 sc1
  v_mul_f32 v160, v160, v83
  v_mul_f32 v161, v161, v83
  v_mul_f32 v162, v162, v83
  v_mul_f32 v163, v163, v83
  v_cvt_pk_bf16_f32 v176, v160, v161
  v_cvt_pk_bf16_f32 v177, v162, v163
  v_mul_f32 v168, v168, v83
  v_mul_f32 v169, v169, v83
  v_mul_f32 v170, v170, v83
  v_mul_f32 v171, v171, v83
  v_cvt_pk_bf16_f32 v178, v168, v169
  v_cvt_pk_bf16_f32 v179, v170, v171
  s_add_u32 s34, s60, 196608
  buffer_store_dwordx4 v[176:179], v1, s[4:7], s34 offen offset:3072 sc1
  s_waitcnt vmcnt(6)
  v_mfma_f32_16x16x16_bf16 v[156:159], a[184:185], v[72:73], 0
  v_mfma_f32_16x16x16_bf16 v[160:163], a[184:185], v[76:77], 0
  v_mfma_f32_16x16x16_bf16 v[156:159], a[152:153], v[74:75], v[156:159]
  v_mfma_f32_16x16x32_bf16 v[160:163], a[152:155], v[78:81], v[160:163]
  v_mfma_f32_16x16x16_bf16 v[164:167], a[186:187], v[72:73], 0
  v_mfma_f32_16x16x16_bf16 v[168:171], a[186:187], v[76:77], 0
  v_mfma_f32_16x16x16_bf16 v[164:167], a[156:157], v[74:75], v[164:167]
  v_mfma_f32_16x16x32_bf16 v[168:171], a[156:159], v[78:81], v[168:171]
  s_nop 2
  v_mul_f32 v156, v156, v82
  v_mul_f32 v157, v157, v82
  v_mul_f32 v158, v158, v82
  v_mul_f32 v159, v159, v82
  v_cvt_pk_bf16_f32 v172, v156, v157
  v_cvt_pk_bf16_f32 v173, v158, v159
  v_mul_f32 v164, v164, v82
  v_mul_f32 v165, v165, v82
  v_mul_f32 v166, v166, v82
  v_mul_f32 v167, v167, v82
  v_cvt_pk_bf16_f32 v174, v164, v165
  v_cvt_pk_bf16_f32 v175, v166, v167
  buffer_store_dwordx4 v[172:175], v2, s[4:7], s60 offen offset:0 sc1
  v_mul_f32 v160, v160, v83
  v_mul_f32 v161, v161, v83
  v_mul_f32 v162, v162, v83
  v_mul_f32 v163, v163, v83
  v_cvt_pk_bf16_f32 v176, v160, v161
  v_cvt_pk_bf16_f32 v177, v162, v163
  v_mul_f32 v168, v168, v83
  v_mul_f32 v169, v169, v83
  v_mul_f32 v170, v170, v83
  v_mul_f32 v171, v171, v83
  v_cvt_pk_bf16_f32 v178, v168, v169
  v_cvt_pk_bf16_f32 v179, v170, v171
  s_add_u32 s34, s60, 196608
  buffer_store_dwordx4 v[176:179], v2, s[4:7], s34 offen offset:0 sc1
  s_waitcnt vmcnt(4)
  v_mfma_f32_16x16x16_bf16 v[156:159], a[188:189], v[72:73], 0
  v_mfma_f32_16x16x16_bf16 v[160:163], a[188:189], v[76:77], 0
  v_mfma_f32_16x16x16_bf16 v[156:159], a[160:161], v[74:75], v[156:159]
  v_mfma_f32_16x16x32_bf16 v[160:163], a[160:163], v[78:81], v[160:163]
  v_mfma_f32_16x16x16_bf16 v[164:167], a[190:191], v[72:73], 0
  v_mfma_f32_16x16x16_bf16 v[168:171], a[190:191], v[76:77], 0
  v_mfma_f32_16x16x16_bf16 v[164:167], a[164:165], v[74:75], v[164:167]
  v_mfma_f32_16x16x32_bf16 v[168:171], a[164:167], v[78:81], v[168:171]
  s_nop 2
  v_mul_f32 v156, v156, v82
  v_mul_f32 v157, v157, v82
  v_mul_f32 v158, v158, v82
  v_mul_f32 v159, v159, v82
  v_cvt_pk_bf16_f32 v172, v156, v157
  v_cvt_pk_bf16_f32 v173, v158, v159
  v_mul_f32 v164, v164, v82
  v_mul_f32 v165, v165, v82
  v_mul_f32 v166, v166, v82
  v_mul_f32 v167, v167, v82
  v_cvt_pk_bf16_f32 v174, v164, v165
  v_cvt_pk_bf16_f32 v175, v166, v167
  buffer_store_dwordx4 v[172:175], v2, s[4:7], s60 offen offset:1024 sc1
  v_mul_f32 v160, v160, v83
  v_mul_f32 v161, v161, v83
  v_mul_f32 v162, v162, v83
  v_mul_f32 v163, v163, v83
  v_cvt_pk_bf16_f32 v176, v160, v161
  v_cvt_pk_bf16_f32 v177, v162, v163
  v_mul_f32 v168, v168, v83
  v_mul_f32 v169, v169, v83
  v_mul_f32 v170, v170, v83
  v_mul_f32 v171, v171, v83
  v_cvt_pk_bf16_f32 v178, v168, v169
  v_cvt_pk_bf16_f32 v179, v170, v171
  s_add_u32 s34, s60, 196608
  buffer_store_dwordx4 v[176:179], v2, s[4:7], s34 offen offset:1024 sc1
  s_branch reca_b5101
  s_cmp_lg_u32 s12, 2
  s_cbranch_scc1 reca_b399
  buffer_store_dwordx2 v[52:53], v9, s[4:7], s30 offen
  buffer_store_dwordx2 v[32:33], v16, s[4:7], s26 offen
  s_cmp_lg_u32 s14, 0
  s_cbranch_scc1 reca_b399
  v_mov_b32 v28, s17
  s_lshl_b32 s34, s13, 7
  s_add_u32 s34, s34, 1507328
  buffer_store_dword v28, v19, s[4:7], s34 offen
  s_branch reca_b399
reca_last98:
  s_cmp_lg_u32 s12, 2
  s_cbranch_scc1 reca_exit1
  buffer_store_dwordx2 v[52:53], v9, s[4:7], s30 offen
  s_branch reca_exit1
reca_swave96:
  s_cmp_lg_u32 s17, 63
  s_cbranch_scc1 reca_vmst104
  s_barrier
  ds_read_b128 v[56:59], v1 offset:10240
  ds_read_b128 v[60:63], v1 offset:11264
  ds_read_b128 v[64:67], v1 offset:12288
  s_waitcnt lgkmcnt(0)
  v_add_f32 v56, v56, v64
  v_add_f32 v60, v60, v48
  v_add_f32 v57, v57, v65
  v_add_f32 v61, v61, v49
  v_add_f32 v58, v58, v66
  v_add_f32 v62, v62, v50
  v_add_f32 v59, v59, v67
  v_add_f32 v63, v63, v51
  v_cvt_pk_bf16_f32 v68, v56, v57
  v_cvt_pk_bf16_f32 v69, v58, v59
  v_cvt_pk_bf16_f32 v70, v60, v61
  v_cvt_pk_bf16_f32 v71, v62, v63
  buffer_store_dwordx2 v[52:53], v9, s[4:7], s30 offen
  buffer_store_dwordx2 v[68:69], v10, s[4:7], s31 offen
  buffer_store_dwordx2 v[70:71], v10, s[4:7], s31 offen offset:256
  s_branch reca_exit1
reca_vmst104:
  s_sleep 1
  buffer_load_dwordx4 v[208:211], v1, s[4:7], s21 offen offset:0 sc1
  buffer_load_dwordx4 v[212:215], v1, s[4:7], s21 offen offset:1024 sc1
  buffer_load_dwordx4 v[216:219], v1, s[4:7], s21 offen offset:2048 sc1
  buffer_load_dwordx4 v[220:223], v1, s[4:7], s21 offen offset:3072 sc1
  buffer_load_dwordx4 v[224:227], v2, s[4:7], s21 offen offset:0 sc1
  buffer_load_dwordx4 v[228:231], v2, s[4:7], s21 offen offset:1024 sc1
  s_waitcnt vmcnt(5)
  v_max_u32 v29, v208, v210
  v_cmp_eq_u32 vcc, -1, v29
  s_cbranch_vccnz reca_retry105
reca_resume106:
  s_waitcnt vmcnt(4)
  v_max_u32 v29, v212, v214
  v_cmp_eq_u32 vcc, -1, v29
  v_mfma_f32_16x16x32_bf16 v[76:79], a[120:123], v[208:211], 0
  v_mfma_f32_16x16x32_bf16 v[80:83], a[144:147], v[208:211], 0
  v_mfma_f32_16x16x32_bf16 v[72:75], v[208:211], v[208:211], v[40:43]
  s_cbranch_vccnz reca_retry107
reca_resume108:
  s_waitcnt vmcnt(3)
  v_max_u32 v29, v216, v218
  v_cmp_eq_u32 vcc, -1, v29
  v_mfma_f32_16x16x32_bf16 v[76:79], a[124:127], v[212:215], v[76:79]
  v_mfma_f32_16x16x32_bf16 v[80:83], a[148:151], v[212:215], v[80:83]
  v_mfma_f32_16x16x32_bf16 v[72:75], v[212:215], v[212:215], v[72:75]
  s_cbranch_vccnz reca_retry109
reca_resume110:
  s_waitcnt vmcnt(2)
  v_max_u32 v29, v220, v222
  v_cmp_eq_u32 vcc, -1, v29
  v_mfma_f32_16x16x32_bf16 v[76:79], a[128:131], v[216:219], v[76:79]
  v_mfma_f32_16x16x32_bf16 v[80:83], a[152:155], v[216:219], v[80:83]
  v_mfma_f32_16x16x32_bf16 v[72:75], v[216:219], v[216:219], v[72:75]
  s_cbranch_vccnz reca_retry111
reca_resume112:
  s_waitcnt vmcnt(1)
  v_max_u32 v29, v224, v226
  v_cmp_eq_u32 vcc, -1, v29
  v_mfma_f32_16x16x32_bf16 v[76:79], a[132:135], v[220:223], v[76:79]
  v_mfma_f32_16x16x32_bf16 v[80:83], a[156:159], v[220:223], v[80:83]
  v_mfma_f32_16x16x32_bf16 v[72:75], v[220:223], v[220:223], v[72:75]
  s_cbranch_vccnz reca_retry113
reca_resume114:
  s_waitcnt vmcnt(0)
  v_max_u32 v29, v228, v230
  v_cmp_eq_u32 vcc, -1, v29
  v_mfma_f32_16x16x32_bf16 v[76:79], a[136:139], v[224:227], v[76:79]
  v_mfma_f32_16x16x32_bf16 v[80:83], a[160:163], v[224:227], v[80:83]
  v_mfma_f32_16x16x32_bf16 v[72:75], v[224:227], v[224:227], v[72:75]
  s_cbranch_vccnz reca_retry115
reca_resume116:
  v_mfma_f32_16x16x32_bf16 v[76:79], a[140:143], v[228:231], v[76:79]
  v_mfma_f32_16x16x32_bf16 v[80:83], a[164:167], v[228:231], v[80:83]
  v_mfma_f32_16x16x32_bf16 v[72:75], v[228:231], v[228:231], v[72:75]
  s_barrier
  ds_read_b128 v[56:59], v1 offset:10240
  ds_read_b128 v[60:63], v1 offset:11264
  ds_read_b128 v[64:67], v1 offset:12288
  s_nop 1
  v_max3_f32 v28, v76, v77, v78
  v_max3_f32 v29, v80, v81, v82
  v_max3_f32 v28, v28, v79, v83
  v_max3_f32 v29, v29, v72, v73
  v_max3_f32 v28, v28, v74, v75
  v_max_f32 v28, v28, v29
  v_mov_b32 v29, v28
  s_nop 1
  v_permlane32_swap_b32 v28, v29
  v_max_f32 v28, v28, v29
  v_mov_b32 v29, v28
  s_nop 1
  v_permlane16_swap_b32 v28, v29
  v_max_f32 v28, v28, v29
  v_mul_f32 v28, s41, v28
  v_fma_f32 v76, v76, s41, -v28
  v_fma_f32 v77, v77, s41, -v28
  v_fma_f32 v78, v78, s41, -v28
  v_fma_f32 v79, v79, s41, -v28
  v_fma_f32 v80, v80, s41, -v28
  v_fma_f32 v81, v81, s41, -v28
  v_fma_f32 v82, v82, s41, -v28
  v_fma_f32 v83, v83, s41, -v28
  v_fma_f32 v72, v72, s41, -v28
  v_fma_f32 v73, v73, s41, -v28
  v_fma_f32 v74, v74, s41, -v28
  v_fma_f32 v75, v75, s41, -v28
  v_exp_f32 v76, v76
  v_exp_f32 v77, v77
  v_exp_f32 v78, v78
  v_exp_f32 v79, v79
  v_exp_f32 v80, v80
  v_exp_f32 v81, v81
  v_exp_f32 v82, v82
  v_exp_f32 v83, v83
  v_cvt_pk_bf16_f32 v84, v76, v77
  v_cvt_pk_bf16_f32 v85, v78, v79
  v_cvt_pk_bf16_f32 v86, v80, v81
  v_cvt_pk_bf16_f32 v87, v82, v83
  v_exp_f32 v72, v72
  v_exp_f32 v73, v73
  v_mfma_f32_16x16x32_bf16 v[100:103], v[36:39], v[84:87], 0
  v_exp_f32 v74, v74
  v_exp_f32 v75, v75
  v_mfma_f32_16x16x32_bf16 v[92:95], a[168:171], v[84:87], 0
  v_cvt_pk_bf16_f32 v88, v72, v73
  v_cvt_pk_bf16_f32 v89, v74, v75
  v_mfma_f32_16x16x32_bf16 v[96:99], a[172:175], v[84:87], 0
  s_waitcnt lgkmcnt(0)
  v_mfma_f32_16x16x16_bf16 v[100:103], v[36:37], v[88:89], v[100:103]
  v_add_f32 v56, v56, v64
  v_add_f32 v60, v60, v48
  v_add_f32 v57, v57, v65
  v_add_f32 v61, v61, v49
  v_add_f32 v58, v58, v66
  v_add_f32 v62, v62, v50
  v_add_f32 v59, v59, v67
  v_add_f32 v63, v63, v51
  v_cvt_pk_bf16_f32 v68, v56, v57
  v_cvt_pk_bf16_f32 v69, v58, v59
  v_cvt_pk_bf16_f32 v70, v60, v61
  v_cvt_pk_bf16_f32 v71, v62, v63
  v_mfma_f32_16x16x16_bf16 v[92:95], v[68:69], v[88:89], v[92:95]
  v_rcp_f32 v28, v100
  v_mfma_f32_16x16x16_bf16 v[96:99], v[70:71], v[88:89], v[96:99]
  v_mov_b32 v29, v28
  s_nop 4
  v_pk_mul_f32 v[92:93], v[92:93], v[28:29]
  v_pk_mul_f32 v[94:95], v[94:95], v[28:29]
  v_pk_mul_f32 v[96:97], v[96:97], v[28:29]
  v_pk_mul_f32 v[98:99], v[98:99], v[28:29]
  v_cvt_pk_bf16_f32 v104, v92, v93
  v_cvt_pk_bf16_f32 v105, v94, v95
  v_cvt_pk_bf16_f32 v106, v96, v97
  v_cvt_pk_bf16_f32 v107, v98, v99
  buffer_store_dwordx4 v[104:107], v11, s[4:7], s22 offen
  s_barrier
  s_add_u32 s34, s17, 2
  s_and_b32 s34, s34, 3
  s_mul_i32 s26, s34, 10240
  s_add_u32 s26, s26, s38
  s_mul_i32 s27, s34, 6144
  s_add_u32 s27, s27, s39
  s_mul_i32 s28, s34, 12288
  s_add_u32 s28, s28, s40
  s_mul_i32 s29, s34, 393216
  s_add_u32 s29, s29, s56
  buffer_store_dwordx2 v[32:33], v8, s[4:7], s27 offen
  buffer_store_dwordx4 v[32:35], v11, s[4:7], s28 offen
  s_add_u32 s36, s17, 1
  s_cmp_ge_u32 s36, 63
  s_cbranch_scc1 reca_nopf117
  s_add_u32 s37, s36, 1
reca_pf118:
  buffer_load_dword v28, v233, s[4:7], 0 offen sc1
  s_waitcnt vmcnt(0)
  v_cmp_gt_i32 vcc, s37, v28
  s_cbranch_vccz reca_pfok119
  s_sleep 1
  s_sub_u32 s18, s18, 1
  s_cbranch_scc0 reca_pf118
  s_mov_b32 s18, 0
reca_pfok119:
  s_lshl_b32 s34, s15, 3
  s_and_b32 s35, s36, 7
  s_add_u32 s34, s34, s35
  s_mul_i32 s34, s34, 12288
  s_add_u32 s32, s34, 37748736
  s_lshl_b32 s35, s16, 11
  s_add_u32 s34, s34, s35
  s_add_u32 s33, s34, 40894464
  buffer_load_dwordx4 a[120:123], v1, s[4:7], s32 offen offset:0 sc1
  buffer_load_dwordx4 a[124:127], v1, s[4:7], s32 offen offset:1024 sc1
  buffer_load_dwordx4 a[128:131], v1, s[4:7], s32 offen offset:2048 sc1
  buffer_load_dwordx4 a[132:135], v1, s[4:7], s32 offen offset:3072 sc1
  buffer_load_dwordx4 a[136:139], v2, s[4:7], s32 offen offset:0 sc1
  buffer_load_dwordx4 a[140:143], v2, s[4:7], s32 offen offset:1024 sc1
  buffer_load_dwordx4 a[144:147], v2, s[4:7], s32 offen offset:2048 sc1
  buffer_load_dwordx4 a[148:151], v2, s[4:7], s32 offen offset:3072 sc1
  buffer_load_dwordx4 a[152:155], v3, s[4:7], s32 offen offset:0 sc1
  buffer_load_dwordx4 a[156:159], v3, s[4:7], s32 offen offset:1024 sc1
  buffer_load_dwordx4 a[160:163], v3, s[4:7], s32 offen offset:2048 sc1
  buffer_load_dwordx4 a[164:167], v3, s[4:7], s32 offen offset:3072 sc1
  buffer_load_dwordx4 a[168:171], v1, s[4:7], s33 offen offset:0 sc1
  buffer_load_dwordx4 a[172:175], v1, s[4:7], s33 offen offset:1024 sc1
reca_nopf117:
  buffer_store_dwordx2 v[52:53], v9, s[4:7], s30 offen
  buffer_store_dwordx2 v[68:69], v10, s[4:7], s31 offen
  buffer_store_dwordx2 v[70:71], v10, s[4:7], s31 offen offset:256
reca_b5101:
  s_barrier
  s_add_u32 s17, s17, 1
  s_branch reca_step87
reca_b399:
  s_endpgm
reca_retry90:
  s_sub_u32 s18, s18, 1
  s_cbranch_scc1 reca_retry90_to
  buffer_load_dwordx4 v[128:131], v4, s[4:7], s20 offen sc1
  buffer_load_dwordx4 v[132:135], v4, s[4:7], s20 offen offset:1024 sc1
  buffer_load_dwordx4 v[136:139], v5, s[4:7], s20 offen sc1
  s_waitcnt vmcnt(2)
  v_max_u32 v29, v128, v130
  v_cmp_eq_u32 vcc, -1, v29
  s_cbranch_vccnz reca_retry90
  s_branch reca_resume91
reca_retry90_to:
  s_mov_b32 s18, 0
  s_waitcnt vmcnt(0)
  s_branch reca_resume91
reca_retry92:
  s_sub_u32 s18, s18, 1
  s_cbranch_scc1 reca_retry92_to
  buffer_load_dwordx4 v[132:135], v4, s[4:7], s20 offen offset:1024 sc1
  buffer_load_dwordx4 v[136:139], v5, s[4:7], s20 offen sc1
  s_waitcnt vmcnt(1)
  v_max_u32 v29, v132, v134
  v_cmp_eq_u32 vcc, -1, v29
  s_cbranch_vccnz reca_retry92
  s_branch reca_resume93
reca_retry92_to:
  s_mov_b32 s18, 0
  s_waitcnt vmcnt(0)
  s_branch reca_resume93
reca_retry94:
  s_sub_u32 s18, s18, 1
  s_cbranch_scc1 reca_retry94_to
  buffer_load_dwordx4 v[136:139], v5, s[4:7], s20 offen sc1
  s_waitcnt vmcnt(0)
  v_max_u32 v29, v136, v138
  v_cmp_eq_u32 vcc, -1, v29
  s_cbranch_vccnz reca_retry94
  s_branch reca_resume95
reca_retry94_to:
  s_mov_b32 s18, 0
  s_waitcnt vmcnt(0)
  s_branch reca_resume95
reca_retry105:
  s_sub_u32 s18, s18, 1
  s_cbranch_scc1 reca_retry105_to
  buffer_load_dwordx4 v[208:211], v1, s[4:7], s21 offen offset:0 sc1
  buffer_load_dwordx4 v[212:215], v1, s[4:7], s21 offen offset:1024 sc1
  buffer_load_dwordx4 v[216:219], v1, s[4:7], s21 offen offset:2048 sc1
  buffer_load_dwordx4 v[220:223], v1, s[4:7], s21 offen offset:3072 sc1
  buffer_load_dwordx4 v[224:227], v2, s[4:7], s21 offen offset:0 sc1
  buffer_load_dwordx4 v[228:231], v2, s[4:7], s21 offen offset:1024 sc1
  s_waitcnt vmcnt(5)
  v_max_u32 v29, v208, v210
  v_cmp_eq_u32 vcc, -1, v29
  s_cbranch_vccnz reca_retry105
  s_branch reca_resume106
reca_retry105_to:
  s_mov_b32 s18, 0
  s_waitcnt vmcnt(0)
  s_branch reca_resume106
reca_retry107:
  s_sub_u32 s18, s18, 1
  s_cbranch_scc1 reca_retry107_to
  buffer_load_dwordx4 v[212:215], v1, s[4:7], s21 offen offset:1024 sc1
  buffer_load_dwordx4 v[216:219], v1, s[4:7], s21 offen offset:2048 sc1
  buffer_load_dwordx4 v[220:223], v1, s[4:7], s21 offen offset:3072 sc1
  buffer_load_dwordx4 v[224:227], v2, s[4:7], s21 offen offset:0 sc1
  buffer_load_dwordx4 v[228:231], v2, s[4:7], s21 offen offset:1024 sc1
  s_waitcnt vmcnt(4)
  v_max_u32 v29, v212, v214
  v_cmp_eq_u32 vcc, -1, v29
  s_cbranch_vccnz reca_retry107
  s_branch reca_resume108
reca_retry107_to:
  s_mov_b32 s18, 0
  s_waitcnt vmcnt(0)
  s_branch reca_resume108
reca_retry109:
  s_sub_u32 s18, s18, 1
  s_cbranch_scc1 reca_retry109_to
  buffer_load_dwordx4 v[216:219], v1, s[4:7], s21 offen offset:2048 sc1
  buffer_load_dwordx4 v[220:223], v1, s[4:7], s21 offen offset:3072 sc1
  buffer_load_dwordx4 v[224:227], v2, s[4:7], s21 offen offset:0 sc1
  buffer_load_dwordx4 v[228:231], v2, s[4:7], s21 offen offset:1024 sc1
  s_waitcnt vmcnt(3)
  v_max_u32 v29, v216, v218
  v_cmp_eq_u32 vcc, -1, v29
  s_cbranch_vccnz reca_retry109
  s_branch reca_resume110
reca_retry109_to:
  s_mov_b32 s18, 0
  s_waitcnt vmcnt(0)
  s_branch reca_resume110
reca_retry111:
  s_sub_u32 s18, s18, 1
  s_cbranch_scc1 reca_retry111_to
  buffer_load_dwordx4 v[220:223], v1, s[4:7], s21 offen offset:3072 sc1
  buffer_load_dwordx4 v[224:227], v2, s[4:7], s21 offen offset:0 sc1
  buffer_load_dwordx4 v[228:231], v2, s[4:7], s21 offen offset:1024 sc1
  s_waitcnt vmcnt(2)
  v_max_u32 v29, v220, v222
  v_cmp_eq_u32 vcc, -1, v29
  s_cbranch_vccnz reca_retry111
  s_branch reca_resume112
reca_retry111_to:
  s_mov_b32 s18, 0
  s_waitcnt vmcnt(0)
  s_branch reca_resume112
reca_retry113:
  s_sub_u32 s18, s18, 1
  s_cbranch_scc1 reca_retry113_to
  buffer_load_dwordx4 v[224:227], v2, s[4:7], s21 offen offset:0 sc1
  buffer_load_dwordx4 v[228:231], v2, s[4:7], s21 offen offset:1024 sc1
  s_waitcnt vmcnt(1)
  v_max_u32 v29, v224, v226
  v_cmp_eq_u32 vcc, -1, v29
  s_cbranch_vccnz reca_retry113
  s_branch reca_resume114
reca_retry113_to:
  s_mov_b32 s18, 0
  s_waitcnt vmcnt(0)
  s_branch reca_resume114
reca_retry115:
  s_sub_u32 s18, s18, 1
  s_cbranch_scc1 reca_retry115_to
  buffer_load_dwordx4 v[228:231], v2, s[4:7], s21 offen offset:1024 sc1
  s_waitcnt vmcnt(0)
  v_max_u32 v29, v228, v230
  v_cmp_eq_u32 vcc, -1, v29
  s_cbranch_vccnz reca_retry115
  s_branch reca_resume116
reca_retry115_to:
  s_mov_b32 s18, 0
  s_waitcnt vmcnt(0)
  s_branch reca_resume116
reca_slow11:
  s_cmp_ge_u32 s14, 20
  s_cbranch_scc1 reca_twins13
  s_branch reca_gotmem121
reca_step120:
  s_and_b32 s34, s17, 3
  s_mul_i32 s20, s34, 10240
  s_add_u32 s20, s20, s38
  s_sleep 2
  buffer_load_dwordx4 v[128:131], v4, s[4:7], s20 offen sc1
  buffer_load_dwordx4 v[132:135], v4, s[4:7], s20 offen offset:1024 sc1
  buffer_load_dwordx4 v[136:139], v5, s[4:7], s20 offen sc1
  s_waitcnt vmcnt(2)
  v_max_u32 v29, v128, v130
  v_cmp_eq_u32 vcc, -1, v29
  s_cbranch_vccnz reca_retry123
reca_resume124:
  s_waitcnt vmcnt(1)
  v_max_u32 v29, v132, v134
  v_cmp_eq_u32 vcc, -1, v29
  ds_write_b128 v4, v[128:131]
  s_cbranch_vccnz reca_retry125
reca_resume126:
  s_waitcnt vmcnt(0)
  v_max_u32 v29, v136, v138
  v_cmp_eq_u32 vcc, -1, v29
  ds_write_b128 v4, v[132:135] offset:1024
  s_cbranch_vccnz reca_retry127
reca_resume128:
  ds_write_b128 v5, v[136:139]
  s_branch reca_gotmem2122
reca_gotmem121:
  ds_write_b128 v4, v[128:131]
  ds_write_b128 v4, v[132:135] offset:1024
  ds_write_b128 v5, v[136:139]
reca_gotmem2122:
  s_and_b32 s34, s17, 3
  s_mul_i32 s21, s34, 6144
  s_add_u32 s21, s21, s39
  s_mul_i32 s22, s34, 12288
  s_add_u32 s22, s22, s40
  s_mul_i32 s25, s34, 393216
  s_add_u32 s25, s25, s56
  s_add_u32 s35, s17, 1
  s_and_b32 s35, s35, 3
  s_mul_i32 s24, s35, 10240
  s_add_u32 s24, s24, s38
  s_waitcnt lgkmcnt(0)
  s_barrier
  ds_read_b128 v[128:131], v236 offset:0
  ds_read_b128 v[132:135], v236 offset:1024
  ds_read_b128 v[136:139], v236 offset:2048
  ds_read_b128 v[140:143], v236 offset:3072
  ds_read_b128 v[144:147], v236 offset:4096
  ds_read_b128 v[148:151], v237 offset:0
  ds_read_b128 v[152:155], v237 offset:1024
  ds_read_b128 v[156:159], v237 offset:2048
  ds_read_b128 v[160:163], v237 offset:3072
  ds_read_b128 v[164:167], v237 offset:4096
  s_waitcnt lgkmcnt(9)
  v_mfma_f32_16x16x32_bf16 v[44:47], a[0:3], v[128:131], 0
  ds_read_b128 v[168:171], v6 offset:0
  v_mfma_f32_16x16x32_bf16 v[240:243], a[4:7], v[128:131], 0
  s_waitcnt lgkmcnt(9)
  v_mfma_f32_16x16x32_bf16 v[44:47], a[8:11], v[132:135], v[44:47]
  ds_read_b128 v[172:175], v6 offset:512
  v_mfma_f32_16x16x32_bf16 v[240:243], a[12:15], v[132:135], v[240:243]
  s_waitcnt lgkmcnt(9)
  v_mfma_f32_16x16x32_bf16 v[44:47], a[16:19], v[136:139], v[44:47]
  ds_read_b128 v[176:179], v6 offset:1024
  v_mfma_f32_16x16x32_bf16 v[240:243], a[20:23], v[136:139], v[240:243]
  s_waitcnt lgkmcnt(9)
  v_mfma_f32_16x16x32_bf16 v[44:47], a[24:27], v[140:143], v[44:47]
  ds_read_b128 v[180:183], v6 offset:1536
  v_mfma_f32_16x16x32_bf16 v[240:243], a[28:31], v[140:143], v[240:243]
  s_waitcnt lgkmcnt(9)
  v_mfma_f32_16x16x32_bf16 v[44:47], a[32:35], v[144:147], v[44:47]
  ds_read_b128 v[184:187], v6 offset:2048
  v_mfma_f32_16x16x32_bf16 v[240:243], a[36:39], v[144:147], v[240:243]
  s_waitcnt lgkmcnt(9)
  v_mfma_f32_16x16x32_bf16 v[44:47], a[40:43], v[148:151], v[44:47]
  ds_read_b128 v[188:191], v6 offset:2560
  v_mfma_f32_16x16x32_bf16 v[240:243], a[44:47], v[148:151], v[240:243]
  s_waitcnt lgkmcnt(9)
  v_mfma_f32_16x16x32_bf16 v[44:47], a[48:51], v[152:155], v[44:47]
  ds_read_b128 v[192:195], v6 offset:3072
  v_mfma_f32_16x16x32_bf16 v[240:243], a[52:55], v[152:155], v[240:243]
  s_waitcnt lgkmcnt(9)
  v_mfma_f32_16x16x32_bf16 v[44:47], a[56:59], v[156:159], v[44:47]
  ds_read_b128 v[196:199], v6 offset:3584
  v_mfma_f32_16x16x32_bf16 v[240:243], a[60:63], v[156:159], v[240:243]
  s_waitcnt lgkmcnt(9)
  v_mfma_f32_16x16x32_bf16 v[44:47], a[64:67], v[160:163], v[44:47]
  ds_read_b128 v[200:203], v6 offset:4096
  v_mfma_f32_16x16x32_bf16 v[240:243], a[68:71], v[160:163], v[240:243]
  s_waitcnt lgkmcnt(9)
  v_mfma_f32_16x16x32_bf16 v[44:47], a[72:75], v[164:167], v[44:47]
  ds_read_b128 v[204:207], v6 offset:4608
  v_mfma_f32_16x16x32_bf16 v[240:243], a[76:79], v[164:167], v[240:243]
  s_waitcnt lgkmcnt(9)
  v_mfma_f32_16x16x32_bf16 v[48:51], v[168:171], a[80:83], 0
  s_and_b32 s34, s17, 7
  s_lshl_b32 s34, s34, 5
  s_add_u32 s34, s34, s15
  s_mul_i32 s34, s34, 3072
  s_lshl_b32 s35, s16, 9
  s_add_u32 s34, s34, s35
  s_add_u32 s30, s34, 47185920
  s_add_u32 s31, s34, 47972352
  v_add_f32_dpp v44, v240, v44 row_ror:8 row_mask:0xf bank_mask:0xf
  v_add_f32_dpp v45, v241, v45 row_ror:8 row_mask:0xf bank_mask:0xf
  v_add_f32_dpp v46, v242, v46 row_ror:8 row_mask:0xf bank_mask:0xf
  v_add_f32_dpp v47, v243, v47 row_ror:8 row_mask:0xf bank_mask:0xf
  v_cvt_pk_bf16_f32 v52, v44, v45
  v_cvt_pk_bf16_f32 v53, v46, v47
  buffer_store_dwordx2 v[52:53], v8, s[4:7], s21 offen sc1
  s_waitcnt lgkmcnt(8)
  v_mfma_f32_16x16x32_bf16 v[48:51], v[172:175], a[84:87], v[48:51]
  s_waitcnt lgkmcnt(7)
  v_mfma_f32_16x16x32_bf16 v[48:51], v[176:179], a[88:91], v[48:51]
  s_waitcnt lgkmcnt(6)
  v_mfma_f32_16x16x32_bf16 v[48:51], v[180:183], a[92:95], v[48:51]
  s_waitcnt lgkmcnt(5)
  v_mfma_f32_16x16x32_bf16 v[48:51], v[184:187], a[96:99], v[48:51]
  s_waitcnt lgkmcnt(4)
  v_mfma_f32_16x16x32_bf16 v[48:51], v[188:191], a[100:103], v[48:51]
  s_waitcnt lgkmcnt(3)
  v_mfma_f32_16x16x32_bf16 v[48:51], v[192:195], a[104:107], v[48:51]
  s_waitcnt lgkmcnt(2)
  v_mfma_f32_16x16x32_bf16 v[48:51], v[196:199], a[108:111], v[48:51]
  s_waitcnt lgkmcnt(1)
  v_mfma_f32_16x16x32_bf16 v[48:51], v[200:203], a[112:115], v[48:51]
  s_waitcnt lgkmcnt(0)
  v_mfma_f32_16x16x32_bf16 v[48:51], v[204:207], a[116:119], v[48:51]
  s_cmp_eq_u32 s12, 3
  s_cbranch_scc1 reca_swave129
  s_nop 5
  ds_write_b128 v17, v[48:51]
  s_add_u32 s34, s17, 2
  s_and_b32 s34, s34, 3
  s_mul_i32 s26, s34, 10240
  s_add_u32 s26, s26, s38
  s_mul_i32 s27, s34, 6144
  s_add_u32 s27, s27, s39
  s_mul_i32 s28, s34, 12288
  s_add_u32 s28, s28, s40
  s_mul_i32 s29, s34, 393216
  s_add_u32 s29, s29, s56
  s_waitcnt lgkmcnt(0)
  s_barrier
  s_cmp_eq_u32 s17, 63
  s_cbranch_scc1 reca_last131
  buffer_store_dwordx2 v[32:33], v8, s[4:7], s27 offen sc1
  s_cmp_lg_u32 s12, 2
  s_cbranch_scc1 reca_b3132
  buffer_store_dwordx2 v[52:53], v9, s[4:7], s30 offen sc1
  buffer_store_dwordx2 v[32:33], v16, s[4:7], s26 offen sc1
  s_cmp_lg_u32 s14, 0
  s_cbranch_scc1 reca_b3132
  v_mov_b32 v28, s17
  s_lshl_b32 s34, s13, 7
  s_add_u32 s34, s34, 1507328
  buffer_store_dword v28, v19, s[4:7], s34 offen sc1
  s_branch reca_b3132
reca_last131:
  s_cmp_lg_u32 s12, 2
  s_cbranch_scc1 reca_exit1
  buffer_store_dwordx2 v[52:53], v9, s[4:7], s30 offen
  s_branch reca_exit1
reca_swave129:
  s_cmp_lg_u32 s17, 63
  s_cbranch_scc1 reca_vmst135
  s_barrier
  ds_read_b128 v[56:59], v1 offset:10240
  ds_read_b128 v[60:63], v1 offset:11264
  ds_read_b128 v[64:67], v1 offset:12288
  s_waitcnt lgkmcnt(0)
  v_add_f32 v56, v56, v64
  v_add_f32 v60, v60, v48
  v_add_f32 v57, v57, v65
  v_add_f32 v61, v61, v49
  v_add_f32 v58, v58, v66
  v_add_f32 v62, v62, v50
  v_add_f32 v59, v59, v67
  v_add_f32 v63, v63, v51
  v_cvt_pk_bf16_f32 v68, v56, v57
  v_cvt_pk_bf16_f32 v69, v58, v59
  v_cvt_pk_bf16_f32 v70, v60, v61
  v_cvt_pk_bf16_f32 v71, v62, v63
  buffer_store_dwordx2 v[52:53], v9, s[4:7], s30 offen
  buffer_store_dwordx2 v[68:69], v10, s[4:7], s31 offen
  buffer_store_dwordx2 v[70:71], v10, s[4:7], s31 offen offset:256
  s_branch reca_exit1
reca_vmst135:
  s_sleep 1
  buffer_load_dwordx4 v[208:211], v1, s[4:7], s21 offen offset:0 sc1
  buffer_load_dwordx4 v[212:215], v1, s[4:7], s21 offen offset:1024 sc1
  buffer_load_dwordx4 v[216:219], v1, s[4:7], s21 offen offset:2048 sc1
  buffer_load_dwordx4 v[220:223], v1, s[4:7], s21 offen offset:3072 sc1
  buffer_load_dwordx4 v[224:227], v2, s[4:7], s21 offen offset:0 sc1
  buffer_load_dwordx4 v[228:231], v2, s[4:7], s21 offen offset:1024 sc1
  s_waitcnt vmcnt(5)
  v_max_u32 v29, v208, v210
  v_cmp_eq_u32 vcc, -1, v29
  s_cbranch_vccnz reca_retry136
reca_resume137:
  s_waitcnt vmcnt(4)
  v_max_u32 v29, v212, v214
  v_cmp_eq_u32 vcc, -1, v29
  v_mfma_f32_16x16x32_bf16 v[76:79], a[120:123], v[208:211], 0
  v_mfma_f32_16x16x32_bf16 v[80:83], a[144:147], v[208:211], 0
  v_mfma_f32_16x16x32_bf16 v[72:75], v[208:211], v[208:211], v[40:43]
  s_cbranch_vccnz reca_retry138
reca_resume139:
  s_waitcnt vmcnt(3)
  v_max_u32 v29, v216, v218
  v_cmp_eq_u32 vcc, -1, v29
  v_mfma_f32_16x16x32_bf16 v[76:79], a[124:127], v[212:215], v[76:79]
  v_mfma_f32_16x16x32_bf16 v[80:83], a[148:151], v[212:215], v[80:83]
  v_mfma_f32_16x16x32_bf16 v[72:75], v[212:215], v[212:215], v[72:75]
  s_cbranch_vccnz reca_retry140
reca_resume141:
  s_waitcnt vmcnt(2)
  v_max_u32 v29, v220, v222
  v_cmp_eq_u32 vcc, -1, v29
  v_mfma_f32_16x16x32_bf16 v[76:79], a[128:131], v[216:219], v[76:79]
  v_mfma_f32_16x16x32_bf16 v[80:83], a[152:155], v[216:219], v[80:83]
  v_mfma_f32_16x16x32_bf16 v[72:75], v[216:219], v[216:219], v[72:75]
  s_cbranch_vccnz reca_retry142
reca_resume143:
  s_waitcnt vmcnt(1)
  v_max_u32 v29, v224, v226
  v_cmp_eq_u32 vcc, -1, v29
  v_mfma_f32_16x16x32_bf16 v[76:79], a[132:135], v[220:223], v[76:79]
  v_mfma_f32_16x16x32_bf16 v[80:83], a[156:159], v[220:223], v[80:83]
  v_mfma_f32_16x16x32_bf16 v[72:75], v[220:223], v[220:223], v[72:75]
  s_cbranch_vccnz reca_retry144
reca_resume145:
  s_waitcnt vmcnt(0)
  v_max_u32 v29, v228, v230
  v_cmp_eq_u32 vcc, -1, v29
  v_mfma_f32_16x16x32_bf16 v[76:79], a[136:139], v[224:227], v[76:79]
  v_mfma_f32_16x16x32_bf16 v[80:83], a[160:163], v[224:227], v[80:83]
  v_mfma_f32_16x16x32_bf16 v[72:75], v[224:227], v[224:227], v[72:75]
  s_cbranch_vccnz reca_retry146
reca_resume147:
  v_mfma_f32_16x16x32_bf16 v[76:79], a[140:143], v[228:231], v[76:79]
  v_mfma_f32_16x16x32_bf16 v[80:83], a[164:167], v[228:231], v[80:83]
  v_mfma_f32_16x16x32_bf16 v[72:75], v[228:231], v[228:231], v[72:75]
  s_barrier
  ds_read_b128 v[56:59], v1 offset:10240
  ds_read_b128 v[60:63], v1 offset:11264
  ds_read_b128 v[64:67], v1 offset:12288
  s_nop 1
  v_max3_f32 v28, v76, v77, v78
  v_max3_f32 v29, v80, v81, v82
  v_max3_f32 v28, v28, v79, v83
  v_max3_f32 v29, v29, v72, v73
  v_max3_f32 v28, v28, v74, v75
  v_max_f32 v28, v28, v29
  v_mov_b32 v29, v28
  s_nop 1
  v_permlane32_swap_b32 v28, v29
  v_max_f32 v28, v28, v29
  v_mov_b32 v29, v28
  s_nop 1
  v_permlane16_swap_b32 v28, v29
  v_max_f32 v28, v28, v29
  v_mul_f32 v28, s41, v28
  v_fma_f32 v76, v76, s41, -v28
  v_fma_f32 v77, v77, s41, -v28
  v_fma_f32 v78, v78, s41, -v28
  v_fma_f32 v79, v79, s41, -v28
  v_fma_f32 v80, v80, s41, -v28
  v_fma_f32 v81, v81, s41, -v28
  v_fma_f32 v82, v82, s41, -v28
  v_fma_f32 v83, v83, s41, -v28
  v_fma_f32 v72, v72, s41, -v28
  v_fma_f32 v73, v73, s41, -v28
  v_fma_f32 v74, v74, s41, -v28
  v_fma_f32 v75, v75, s41, -v28
  v_exp_f32 v76, v76
  v_exp_f32 v77, v77
  v_exp_f32 v78, v78
  v_exp_f32 v79, v79
  v_exp_f32 v80, v80
  v_exp_f32 v81, v81
  v_exp_f32 v82, v82
  v_exp_f32 v83, v83
  v_cvt_pk_bf16_f32 v84, v76, v77
  v_cvt_pk_bf16_f32 v85, v78, v79
  v_cvt_pk_bf16_f32 v86, v80, v81
  v_cvt_pk_bf16_f32 v87, v82, v83
  v_exp_f32 v72, v72
  v_exp_f32 v73, v73
  v_mfma_f32_16x16x32_bf16 v[100:103], v[36:39], v[84:87], 0
  v_exp_f32 v74, v74
  v_exp_f32 v75, v75
  v_mfma_f32_16x16x32_bf16 v[92:95], a[168:171], v[84:87], 0
  v_cvt_pk_bf16_f32 v88, v72, v73
  v_cvt_pk_bf16_f32 v89, v74, v75
  v_mfma_f32_16x16x32_bf16 v[96:99], a[172:175], v[84:87], 0
  s_waitcnt lgkmcnt(0)
  v_mfma_f32_16x16x16_bf16 v[100:103], v[36:37], v[88:89], v[100:103]
  v_add_f32 v56, v56, v64
  v_add_f32 v60, v60, v48
  v_add_f32 v57, v57, v65
  v_add_f32 v61, v61, v49
  v_add_f32 v58, v58, v66
  v_add_f32 v62, v62, v50
  v_add_f32 v59, v59, v67
  v_add_f32 v63, v63, v51
  v_cvt_pk_bf16_f32 v68, v56, v57
  v_cvt_pk_bf16_f32 v69, v58, v59
  v_cvt_pk_bf16_f32 v70, v60, v61
  v_cvt_pk_bf16_f32 v71, v62, v63
  v_mfma_f32_16x16x16_bf16 v[92:95], v[68:69], v[88:89], v[92:95]
  v_rcp_f32 v28, v100
  v_mfma_f32_16x16x16_bf16 v[96:99], v[70:71], v[88:89], v[96:99]
  v_mov_b32 v29, v28
  s_nop 4
  v_pk_mul_f32 v[92:93], v[92:93], v[28:29]
  v_pk_mul_f32 v[94:95], v[94:95], v[28:29]
  v_pk_mul_f32 v[96:97], v[96:97], v[28:29]
  v_pk_mul_f32 v[98:99], v[98:99], v[28:29]
  v_cvt_pk_bf16_f32 v104, v92, v93
  v_cvt_pk_bf16_f32 v105, v94, v95
  v_cvt_pk_bf16_f32 v106, v96, v97
  v_cvt_pk_bf16_f32 v107, v98, v99
  buffer_store_dwordx4 v[104:107], v11, s[4:7], s22 offen sc1
reca_b3132:
  s_barrier
  s_cmp_ge_u32 s12, 2
  s_cbranch_scc1 reca_notg2148
  s_sleep 3
  buffer_load_dwordx4 v[128:131], v12, s[4:7], s22 offen offset:0 sc1
  buffer_load_dwordx4 v[132:135], v12, s[4:7], s22 offen offset:1024 sc1
  buffer_load_dwordx4 v[136:139], v12, s[4:7], s22 offen offset:2048 sc1
  buffer_load_dwordx4 v[140:143], v12, s[4:7], s22 offen offset:3072 sc1
  buffer_load_dwordx4 v[144:147], v13, s[4:7], s22 offen offset:0 sc1
  buffer_load_dwordx4 v[148:151], v13, s[4:7], s22 offen offset:1024 sc1
  buffer_load_dwordx4 v[152:155], v13, s[4:7], s22 offen offset:2048 sc1
  buffer_load_dwordx4 v[156:159], v13, s[4:7], s22 offen offset:3072 sc1
  buffer_load_dwordx4 v[160:163], v14, s[4:7], s22 offen offset:0 sc1
  buffer_load_dwordx4 v[164:167], v14, s[4:7], s22 offen offset:1024 sc1
  buffer_load_dwordx4 v[168:171], v14, s[4:7], s22 offen offset:2048 sc1
  buffer_load_dwordx4 v[172:175], v14, s[4:7], s22 offen offset:3072 sc1
  s_waitcnt vmcnt(11)
  v_cmp_eq_u32 vcc, -1, v128
  s_cbranch_vccnz reca_retry149
reca_resume150:
  s_waitcnt vmcnt(10)
  v_cmp_eq_u32 vcc, -1, v132
  v_mfma_f32_16x16x32_bf16 v[108:111], a[120:123], v[128:131], 0
  v_mfma_f32_16x16x32_bf16 v[112:115], a[124:127], v[128:131], 0
  s_cbranch_vccnz reca_retry151
reca_resume152:
  s_waitcnt vmcnt(9)
  v_cmp_eq_u32 vcc, -1, v136
  v_mfma_f32_16x16x32_bf16 v[108:111], a[128:131], v[132:135], v[108:111]
  v_mfma_f32_16x16x32_bf16 v[112:115], a[132:135], v[132:135], v[112:115]
  s_cbranch_vccnz reca_retry153
reca_resume154:
  s_waitcnt vmcnt(8)
  v_cmp_eq_u32 vcc, -1, v140
  v_mfma_f32_16x16x32_bf16 v[108:111], a[136:139], v[136:139], v[108:111]
  v_mfma_f32_16x16x32_bf16 v[112:115], a[140:143], v[136:139], v[112:115]
  s_cbranch_vccnz reca_retry155
reca_resume156:
  s_waitcnt vmcnt(7)
  v_cmp_eq_u32 vcc, -1, v144
  v_mfma_f32_16x16x32_bf16 v[108:111], a[144:147], v[140:143], v[108:111]
  v_mfma_f32_16x16x32_bf16 v[112:115], a[148:151], v[140:143], v[112:115]
  s_cbranch_vccnz reca_retry157
reca_resume158:
  s_waitcnt vmcnt(6)
  v_cmp_eq_u32 vcc, -1, v148
  v_mfma_f32_16x16x32_bf16 v[108:111], a[152:155], v[144:147], v[108:111]
  v_mfma_f32_16x16x32_bf16 v[112:115], a[156:159], v[144:147], v[112:115]
  s_cbranch_vccnz reca_retry159
reca_resume160:
  s_waitcnt vmcnt(5)
  v_cmp_eq_u32 vcc, -1, v152
  v_mfma_f32_16x16x32_bf16 v[108:111], a[160:163], v[148:151], v[108:111]
  v_mfma_f32_16x16x32_bf16 v[112:115], a[164:167], v[148:151], v[112:115]
  s_cbranch_vccnz reca_retry161
reca_resume162:
  s_waitcnt vmcnt(4)
  v_cmp_eq_u32 vcc, -1, v156
  v_mfma_f32_16x16x32_bf16 v[108:111], a[168:171], v[152:155], v[108:111]
  v_mfma_f32_16x16x32_bf16 v[112:115], a[172:175], v[152:155], v[112:115]
  s_cbranch_vccnz reca_retry163
reca_resume164:
  s_waitcnt vmcnt(3)
  v_cmp_eq_u32 vcc, -1, v160
  v_mfma_f32_16x16x32_bf16 v[108:111], a[176:179], v[156:159], v[108:111]
  v_mfma_f32_16x16x32_bf16 v[112:115], a[180:183], v[156:159], v[112:115]
  s_cbranch_vccnz reca_retry165
reca_resume166:
  s_waitcnt vmcnt(2)
  v_cmp_eq_u32 vcc, -1, v164
  v_mfma_f32_16x16x32_bf16 v[108:111], a[184:187], v[160:163], v[108:111]
  v_mfma_f32_16x16x32_bf16 v[112:115], a[188:191], v[160:163], v[112:115]
  s_cbranch_vccnz reca_retry167
reca_resume168:
  s_waitcnt vmcnt(1)
  v_cmp_eq_u32 vcc, -1, v168
  v_mfma_f32_16x16x32_bf16 v[108:111], a[192:195], v[164:167], v[108:111]
  v_mfma_f32_16x16x32_bf16 v[112:115], a[196:199], v[164:167], v[112:115]
  s_cbranch_vccnz reca_retry169
reca_resume170:
  s_waitcnt vmcnt(0)
  v_cmp_eq_u32 vcc, -1, v172
  v_mfma_f32_16x16x32_bf16 v[108:111], a[200:203], v[168:171], v[108:111]
  v_mfma_f32_16x16x32_bf16 v[112:115], a[204:207], v[168:171], v[112:115]
  s_cbranch_vccnz reca_retry171
reca_resume172:
  v_mfma_f32_16x16x32_bf16 v[108:111], a[208:211], v[172:175], v[108:111]
  v_mfma_f32_16x16x32_bf16 v[112:115], a[212:215], v[172:175], v[112:115]
  s_nop 7
  v_add_f32_dpp v116, v112, v108 row_ror:8 row_mask:0xf bank_mask:0xf
  v_add_f32_dpp v117, v113, v109 row_ror:8 row_mask:0xf bank_mask:0xf
  v_add_f32_dpp v118, v114, v110 row_ror:8 row_mask:0xf bank_mask:0xf
  v_add_f32_dpp v119, v115, v111 row_ror:8 row_mask:0xf bank_mask:0xf
  buffer_store_dwordx4 v[116:119], v15, s[4:7], s25 offen sc1
  buffer_store_dwordx4 v[116:119], v232, s[4:7], s25 offen sc1
  buffer_store_dwordx4 v[32:35], v15, s[4:7], s29 offen sc1
  buffer_store_dwordx4 v[32:35], v232, s[4:7], s29 offen sc1
  s_branch reca_b4133
reca_notg2148:
  s_cmp_lg_u32 s12, 3
  s_cbranch_scc1 reca_b4133
  s_add_u32 s34, s17, 2
  s_and_b32 s34, s34, 3
  s_mul_i32 s26, s34, 10240
  s_add_u32 s26, s26, s38
  s_mul_i32 s27, s34, 6144
  s_add_u32 s27, s27, s39
  s_mul_i32 s28, s34, 12288
  s_add_u32 s28, s28, s40
  s_mul_i32 s29, s34, 393216
  s_add_u32 s29, s29, s56
  buffer_store_dwordx2 v[32:33], v8, s[4:7], s27 offen sc1
  buffer_store_dwordx4 v[32:35], v11, s[4:7], s28 offen sc1
reca_b4133:
  s_barrier
  s_cmp_lg_u32 s12, 2
  s_cbranch_scc1 reca_not2173
  s_sleep 8
  buffer_load_dwordx4 v[128:131], v20, s[4:7], s25 offen sc1
  buffer_load_dwordx4 v[132:135], v21, s[4:7], s25 offen sc1
  buffer_load_dwordx4 v[136:139], v22, s[4:7], s25 offen sc1
  buffer_load_dwordx4 v[140:143], v23, s[4:7], s25 offen sc1
  buffer_load_dwordx4 v[144:147], v24, s[4:7], s25 offen sc1
  buffer_load_dwordx4 v[148:151], v25, s[4:7], s25 offen sc1
  buffer_load_dwordx4 v[152:155], v26, s[4:7], s25 offen sc1
  buffer_load_dwordx4 v[156:159], v27, s[4:7], s25 offen sc1
  s_waitcnt vmcnt(7)
  v_cmp_eq_u32 vcc, -1, v128
  s_cbranch_vccnz reca_retry174
reca_resume175:
  s_waitcnt vmcnt(6)
  v_cmp_eq_u32 vcc, -1, v132
  s_cbranch_vccnz reca_retry176
reca_resume177:
  s_waitcnt vmcnt(5)
  v_cmp_eq_u32 vcc, -1, v136
  v_pk_add_f32 v[116:117], v[128:129], v[132:133]
  v_pk_add_f32 v[118:119], v[130:131], v[134:135]
  s_cbranch_vccnz reca_retry178
reca_resume179:
  s_waitcnt vmcnt(4)
  v_cmp_eq_u32 vcc, -1, v140
  v_pk_add_f32 v[116:117], v[116:117], v[136:137]
  v_pk_add_f32 v[118:119], v[118:119], v[138:139]
  s_cbranch_vccnz reca_retry180
reca_resume181:
  s_waitcnt vmcnt(3)
  v_cmp_eq_u32 vcc, -1, v144
  v_pk_add_f32 v[116:117], v[116:117], v[140:141]
  v_pk_add_f32 v[118:119], v[118:119], v[142:143]
  s_cbranch_vccnz reca_retry182
reca_resume183:
  s_waitcnt vmcnt(2)
  v_cmp_eq_u32 vcc, -1, v148
  v_pk_add_f32 v[116:117], v[116:117], v[144:145]
  v_pk_add_f32 v[118:119], v[118:119], v[146:147]
  s_cbranch_vccnz reca_retry184
reca_resume185:
  s_waitcnt vmcnt(1)
  v_cmp_eq_u32 vcc, -1, v152
  v_pk_add_f32 v[116:117], v[116:117], v[148:149]
  v_pk_add_f32 v[118:119], v[118:119], v[150:151]
  s_cbranch_vccnz reca_retry186
reca_resume187:
  s_waitcnt vmcnt(0)
  v_cmp_eq_u32 vcc, -1, v156
  v_pk_add_f32 v[116:117], v[116:117], v[152:153]
  v_pk_add_f32 v[118:119], v[118:119], v[154:155]
  s_cbranch_vccnz reca_retry188
reca_resume189:
  v_pk_add_f32 v[116:117], v[116:117], v[156:157]
  v_pk_add_f32 v[118:119], v[118:119], v[158:159]
  v_cvt_pk_bf16_f32 v132, v116, v117
  v_cvt_pk_bf16_f32 v133, v118, v119
  buffer_store_dwordx2 v[132:133], v16, s[4:7], s24 offen sc1
  s_branch reca_b5134
reca_not2173:
  s_cmp_lg_u32 s12, 3
  s_cbranch_scc1 reca_b5134
  s_add_u32 s36, s17, 1
  s_cmp_ge_u32 s36, 63
  s_cbranch_scc1 reca_nopf190
  s_add_u32 s37, s36, 1
reca_pf191:
  buffer_load_dword v28, v233, s[4:7], 0 offen sc1
  s_waitcnt vmcnt(0)
  v_cmp_gt_i32 vcc, s37, v28
  s_cbranch_vccz reca_pfok192
  s_sleep 1
  s_sub_u32 s18, s18, 1
  s_cbranch_scc0 reca_pf191
  s_mov_b32 s18, 0
reca_pfok192:
  s_lshl_b32 s34, s15, 3
  s_and_b32 s35, s36, 7
  s_add_u32 s34, s34, s35
  s_mul_i32 s34, s34, 12288
  s_add_u32 s32, s34, 37748736
  s_lshl_b32 s35, s16, 11
  s_add_u32 s34, s34, s35
  s_add_u32 s33, s34, 40894464
  buffer_load_dwordx4 a[120:123], v1, s[4:7], s32 offen offset:0 sc1
  buffer_load_dwordx4 a[124:127], v1, s[4:7], s32 offen offset:1024 sc1
  buffer_load_dwordx4 a[128:131], v1, s[4:7], s32 offen offset:2048 sc1
  buffer_load_dwordx4 a[132:135], v1, s[4:7], s32 offen offset:3072 sc1
  buffer_load_dwordx4 a[136:139], v2, s[4:7], s32 offen offset:0 sc1
  buffer_load_dwordx4 a[140:143], v2, s[4:7], s32 offen offset:1024 sc1
  buffer_load_dwordx4 a[144:147], v2, s[4:7], s32 offen offset:2048 sc1
  buffer_load_dwordx4 a[148:151], v2, s[4:7], s32 offen offset:3072 sc1
  buffer_load_dwordx4 a[152:155], v3, s[4:7], s32 offen offset:0 sc1
  buffer_load_dwordx4 a[156:159], v3, s[4:7], s32 offen offset:1024 sc1
  buffer_load_dwordx4 a[160:163], v3, s[4:7], s32 offen offset:2048 sc1
  buffer_load_dwordx4 a[164:167], v3, s[4:7], s32 offen offset:3072 sc1
  buffer_load_dwordx4 a[168:171], v1, s[4:7], s33 offen offset:0 sc1
  buffer_load_dwordx4 a[172:175], v1, s[4:7], s33 offen offset:1024 sc1
reca_nopf190:
  buffer_store_dwordx2 v[52:53], v9, s[4:7], s30 offen sc1
  buffer_store_dwordx2 v[68:69], v10, s[4:7], s31 offen sc1
  buffer_store_dwordx2 v[70:71], v10, s[4:7], s31 offen offset:256 sc1
reca_b5134:
  s_barrier
  s_add_u32 s17, s17, 1
  s_branch reca_step120
reca_retry123:
  s_sub_u32 s18, s18, 1
  s_cbranch_scc1 reca_retry123_to
  buffer_load_dwordx4 v[128:131], v4, s[4:7], s20 offen sc1
  buffer_load_dwordx4 v[132:135], v4, s[4:7], s20 offen offset:1024 sc1
  buffer_load_dwordx4 v[136:139], v5, s[4:7], s20 offen sc1
  s_waitcnt vmcnt(2)
  v_max_u32 v29, v128, v130
  v_cmp_eq_u32 vcc, -1, v29
  s_cbranch_vccnz reca_retry123
  s_branch reca_resume124
reca_retry123_to:
  s_mov_b32 s18, 0
  s_waitcnt vmcnt(0)
  s_branch reca_resume124
reca_retry125:
  s_sub_u32 s18, s18, 1
  s_cbranch_scc1 reca_retry125_to
  buffer_load_dwordx4 v[132:135], v4, s[4:7], s20 offen offset:1024 sc1
  buffer_load_dwordx4 v[136:139], v5, s[4:7], s20 offen sc1
  s_waitcnt vmcnt(1)
  v_max_u32 v29, v132, v134
  v_cmp_eq_u32 vcc, -1, v29
  s_cbranch_vccnz reca_retry125
  s_branch reca_resume126
reca_retry125_to:
  s_mov_b32 s18, 0
  s_waitcnt vmcnt(0)
  s_branch reca_resume126
reca_retry127:
  s_sub_u32 s18, s18, 1
  s_cbranch_scc1 reca_retry127_to
  buffer_load_dwordx4 v[136:139], v5, s[4:7], s20 offen sc1
  s_waitcnt vmcnt(0)
  v_max_u32 v29, v136, v138
  v_cmp_eq_u32 vcc, -1, v29
  s_cbranch_vccnz reca_retry127
  s_branch reca_resume128
reca_retry127_to:
  s_mov_b32 s18, 0
  s_waitcnt vmcnt(0)
  s_branch reca_resume128
reca_retry136:
  s_sub_u32 s18, s18, 1
  s_cbranch_scc1 reca_retry136_to
  buffer_load_dwordx4 v[208:211], v1, s[4:7], s21 offen offset:0 sc1
  buffer_load_dwordx4 v[212:215], v1, s[4:7], s21 offen offset:1024 sc1
  buffer_load_dwordx4 v[216:219], v1, s[4:7], s21 offen offset:2048 sc1
  buffer_load_dwordx4 v[220:223], v1, s[4:7], s21 offen offset:3072 sc1
  buffer_load_dwordx4 v[224:227], v2, s[4:7], s21 offen offset:0 sc1
  buffer_load_dwordx4 v[228:231], v2, s[4:7], s21 offen offset:1024 sc1
  s_waitcnt vmcnt(5)
  v_max_u32 v29, v208, v210
  v_cmp_eq_u32 vcc, -1, v29
  s_cbranch_vccnz reca_retry136
  s_branch reca_resume137
reca_retry136_to:
  s_mov_b32 s18, 0
  s_waitcnt vmcnt(0)
  s_branch reca_resume137
reca_retry138:
  s_sub_u32 s18, s18, 1
  s_cbranch_scc1 reca_retry138_to
  buffer_load_dwordx4 v[212:215], v1, s[4:7], s21 offen offset:1024 sc1
  buffer_load_dwordx4 v[216:219], v1, s[4:7], s21 offen offset:2048 sc1
  buffer_load_dwordx4 v[220:223], v1, s[4:7], s21 offen offset:3072 sc1
  buffer_load_dwordx4 v[224:227], v2, s[4:7], s21 offen offset:0 sc1
  buffer_load_dwordx4 v[228:231], v2, s[4:7], s21 offen offset:1024 sc1
  s_waitcnt vmcnt(4)
  v_max_u32 v29, v212, v214
  v_cmp_eq_u32 vcc, -1, v29
  s_cbranch_vccnz reca_retry138
  s_branch reca_resume139
reca_retry138_to:
  s_mov_b32 s18, 0
  s_waitcnt vmcnt(0)
  s_branch reca_resume139
reca_retry140:
  s_sub_u32 s18, s18, 1
  s_cbranch_scc1 reca_retry140_to
  buffer_load_dwordx4 v[216:219], v1, s[4:7], s21 offen offset:2048 sc1
  buffer_load_dwordx4 v[220:223], v1, s[4:7], s21 offen offset:3072 sc1
  buffer_load_dwordx4 v[224:227], v2, s[4:7], s21 offen offset:0 sc1
  buffer_load_dwordx4 v[228:231], v2, s[4:7], s21 offen offset:1024 sc1
  s_waitcnt vmcnt(3)
  v_max_u32 v29, v216, v218
  v_cmp_eq_u32 vcc, -1, v29
  s_cbranch_vccnz reca_retry140
  s_branch reca_resume141
reca_retry140_to:
  s_mov_b32 s18, 0
  s_waitcnt vmcnt(0)
  s_branch reca_resume141
reca_retry142:
  s_sub_u32 s18, s18, 1
  s_cbranch_scc1 reca_retry142_to
  buffer_load_dwordx4 v[220:223], v1, s[4:7], s21 offen offset:3072 sc1
  buffer_load_dwordx4 v[224:227], v2, s[4:7], s21 offen offset:0 sc1
  buffer_load_dwordx4 v[228:231], v2, s[4:7], s21 offen offset:1024 sc1
  s_waitcnt vmcnt(2)
  v_max_u32 v29, v220, v222
  v_cmp_eq_u32 vcc, -1, v29
  s_cbranch_vccnz reca_retry142
  s_branch reca_resume143
reca_retry142_to:
  s_mov_b32 s18, 0
  s_waitcnt vmcnt(0)
  s_branch reca_resume143
reca_retry144:
  s_sub_u32 s18, s18, 1
  s_cbranch_scc1 reca_retry144_to
  buffer_load_dwordx4 v[224:227], v2, s[4:7], s21 offen offset:0 sc1
  buffer_load_dwordx4 v[228:231], v2, s[4:7], s21 offen offset:1024 sc1
  s_waitcnt vmcnt(1)
  v_max_u32 v29, v224, v226
  v_cmp_eq_u32 vcc, -1, v29
  s_cbranch_vccnz reca_retry144
  s_branch reca_resume145
reca_retry144_to:
  s_mov_b32 s18, 0
  s_waitcnt vmcnt(0)
  s_branch reca_resume145
reca_retry146:
  s_sub_u32 s18, s18, 1
  s_cbranch_scc1 reca_retry146_to
  buffer_load_dwordx4 v[228:231], v2, s[4:7], s21 offen offset:1024 sc1
  s_waitcnt vmcnt(0)
  v_max_u32 v29, v228, v230
  v_cmp_eq_u32 vcc, -1, v29
  s_cbranch_vccnz reca_retry146
  s_branch reca_resume147
reca_retry146_to:
  s_mov_b32 s18, 0
  s_waitcnt vmcnt(0)
  s_branch reca_resume147
reca_retry149:
  s_sub_u32 s18, s18, 1
  s_cbranch_scc1 reca_retry149_to
  buffer_load_dwordx4 v[128:131], v12, s[4:7], s22 offen offset:0 sc1
  buffer_load_dwordx4 v[132:135], v12, s[4:7], s22 offen offset:1024 sc1
  buffer_load_dwordx4 v[136:139], v12, s[4:7], s22 offen offset:2048 sc1
  buffer_load_dwordx4 v[140:143], v12, s[4:7], s22 offen offset:3072 sc1
  buffer_load_dwordx4 v[144:147], v13, s[4:7], s22 offen offset:0 sc1
  buffer_load_dwordx4 v[148:151], v13, s[4:7], s22 offen offset:1024 sc1
  buffer_load_dwordx4 v[152:155], v13, s[4:7], s22 offen offset:2048 sc1
  buffer_load_dwordx4 v[156:159], v13, s[4:7], s22 offen offset:3072 sc1
  buffer_load_dwordx4 v[160:163], v14, s[4:7], s22 offen offset:0 sc1
  buffer_load_dwordx4 v[164:167], v14, s[4:7], s22 offen offset:1024 sc1
  buffer_load_dwordx4 v[168:171], v14, s[4:7], s22 offen offset:2048 sc1
  buffer_load_dwordx4 v[172:175], v14, s[4:7], s22 offen offset:3072 sc1
  s_waitcnt vmcnt(11)
  v_cmp_eq_u32 vcc, -1, v128
  s_cbranch_vccnz reca_retry149
  s_branch reca_resume150
reca_retry149_to:
  s_mov_b32 s18, 0
  s_waitcnt vmcnt(0)
  s_branch reca_resume150
reca_retry151:
  s_sub_u32 s18, s18, 1
  s_cbranch_scc1 reca_retry151_to
  buffer_load_dwordx4 v[132:135], v12, s[4:7], s22 offen offset:1024 sc1
  buffer_load_dwordx4 v[136:139], v12, s[4:7], s22 offen offset:2048 sc1
  buffer_load_dwordx4 v[140:143], v12, s[4:7], s22 offen offset:3072 sc1
  buffer_load_dwordx4 v[144:147], v13, s[4:7], s22 offen offset:0 sc1
  buffer_load_dwordx4 v[148:151], v13, s[4:7], s22 offen offset:1024 sc1
  buffer_load_dwordx4 v[152:155], v13, s[4:7], s22 offen offset:2048 sc1
  buffer_load_dwordx4 v[156:159], v13, s[4:7], s22 offen offset:3072 sc1
  buffer_load_dwordx4 v[160:163], v14, s[4:7], s22 offen offset:0 sc1
  buffer_load_dwordx4 v[164:167], v14, s[4:7], s22 offen offset:1024 sc1
  buffer_load_dwordx4 v[168:171], v14, s[4:7], s22 offen offset:2048 sc1
  buffer_load_dwordx4 v[172:175], v14, s[4:7], s22 offen offset:3072 sc1
  s_waitcnt vmcnt(10)
  v_cmp_eq_u32 vcc, -1, v132
  s_cbranch_vccnz reca_retry151
  s_branch reca_resume152
reca_retry151_to:
  s_mov_b32 s18, 0
  s_waitcnt vmcnt(0)
  s_branch reca_resume152
reca_retry153:
  s_sub_u32 s18, s18, 1
  s_cbranch_scc1 reca_retry153_to
  buffer_load_dwordx4 v[136:139], v12, s[4:7], s22 offen offset:2048 sc1
  buffer_load_dwordx4 v[140:143], v12, s[4:7], s22 offen offset:3072 sc1
  buffer_load_dwordx4 v[144:147], v13, s[4:7], s22 offen offset:0 sc1
  buffer_load_dwordx4 v[148:151], v13, s[4:7], s22 offen offset:1024 sc1
  buffer_load_dwordx4 v[152:155], v13, s[4:7], s22 offen offset:2048 sc1
  buffer_load_dwordx4 v[156:159], v13, s[4:7], s22 offen offset:3072 sc1
  buffer_load_dwordx4 v[160:163], v14, s[4:7], s22 offen offset:0 sc1
  buffer_load_dwordx4 v[164:167], v14, s[4:7], s22 offen offset:1024 sc1
  buffer_load_dwordx4 v[168:171], v14, s[4:7], s22 offen offset:2048 sc1
  buffer_load_dwordx4 v[172:175], v14, s[4:7], s22 offen offset:3072 sc1
  s_waitcnt vmcnt(9)
  v_cmp_eq_u32 vcc, -1, v136
  s_cbranch_vccnz reca_retry153
  s_branch reca_resume154
reca_retry153_to:
  s_mov_b32 s18, 0
  s_waitcnt vmcnt(0)
  s_branch reca_resume154
reca_retry155:
  s_sub_u32 s18, s18, 1
  s_cbranch_scc1 reca_retry155_to
  buffer_load_dwordx4 v[140:143], v12, s[4:7], s22 offen offset:3072 sc1
  buffer_load_dwordx4 v[144:147], v13, s[4:7], s22 offen offset:0 sc1
  buffer_load_dwordx4 v[148:151], v13, s[4:7], s22 offen offset:1024 sc1
  buffer_load_dwordx4 v[152:155], v13, s[4:7], s22 offen offset:2048 sc1
  buffer_load_dwordx4 v[156:159], v13, s[4:7], s22 offen offset:3072 sc1
  buffer_load_dwordx4 v[160:163], v14, s[4:7], s22 offen offset:0 sc1
  buffer_load_dwordx4 v[164:167], v14, s[4:7], s22 offen offset:1024 sc1
  buffer_load_dwordx4 v[168:171], v14, s[4:7], s22 offen offset:2048 sc1
  buffer_load_dwordx4 v[172:175], v14, s[4:7], s22 offen offset:3072 sc1
  s_waitcnt vmcnt(8)
  v_cmp_eq_u32 vcc, -1, v140
  s_cbranch_vccnz reca_retry155
  s_branch reca_resume156
reca_retry155_to:
  s_mov_b32 s18, 0
  s_waitcnt vmcnt(0)
  s_branch reca_resume156
reca_retry157:
  s_sub_u32 s18, s18, 1
  s_cbranch_scc1 reca_retry157_to
  buffer_load_dwordx4 v[144:147], v13, s[4:7], s22 offen offset:0 sc1
  buffer_load_dwordx4 v[148:151], v13, s[4:7], s22 offen offset:1024 sc1
  buffer_load_dwordx4 v[152:155], v13, s[4:7], s22 offen offset:2048 sc1
  buffer_load_dwordx4 v[156:159], v13, s[4:7], s22 offen offset:3072 sc1
  buffer_load_dwordx4 v[160:163], v14, s[4:7], s22 offen offset:0 sc1
  buffer_load_dwordx4 v[164:167], v14, s[4:7], s22 offen offset:1024 sc1
  buffer_load_dwordx4 v[168:171], v14, s[4:7], s22 offen offset:2048 sc1
  buffer_load_dwordx4 v[172:175], v14, s[4:7], s22 offen offset:3072 sc1
  s_waitcnt vmcnt(7)
  v_cmp_eq_u32 vcc, -1, v144
  s_cbranch_vccnz reca_retry157
  s_branch reca_resume158
reca_retry157_to:
  s_mov_b32 s18, 0
  s_waitcnt vmcnt(0)
  s_branch reca_resume158
reca_retry159:
  s_sub_u32 s18, s18, 1
  s_cbranch_scc1 reca_retry159_to
  buffer_load_dwordx4 v[148:151], v13, s[4:7], s22 offen offset:1024 sc1
  buffer_load_dwordx4 v[152:155], v13, s[4:7], s22 offen offset:2048 sc1
  buffer_load_dwordx4 v[156:159], v13, s[4:7], s22 offen offset:3072 sc1
  buffer_load_dwordx4 v[160:163], v14, s[4:7], s22 offen offset:0 sc1
  buffer_load_dwordx4 v[164:167], v14, s[4:7], s22 offen offset:1024 sc1
  buffer_load_dwordx4 v[168:171], v14, s[4:7], s22 offen offset:2048 sc1
  buffer_load_dwordx4 v[172:175], v14, s[4:7], s22 offen offset:3072 sc1
  s_waitcnt vmcnt(6)
  v_cmp_eq_u32 vcc, -1, v148
  s_cbranch_vccnz reca_retry159
  s_branch reca_resume160
reca_retry159_to:
  s_mov_b32 s18, 0
  s_waitcnt vmcnt(0)
  s_branch reca_resume160
reca_retry161:
  s_sub_u32 s18, s18, 1
  s_cbranch_scc1 reca_retry161_to
  buffer_load_dwordx4 v[152:155], v13, s[4:7], s22 offen offset:2048 sc1
  buffer_load_dwordx4 v[156:159], v13, s[4:7], s22 offen offset:3072 sc1
  buffer_load_dwordx4 v[160:163], v14, s[4:7], s22 offen offset:0 sc1
  buffer_load_dwordx4 v[164:167], v14, s[4:7], s22 offen offset:1024 sc1
  buffer_load_dwordx4 v[168:171], v14, s[4:7], s22 offen offset:2048 sc1
  buffer_load_dwordx4 v[172:175], v14, s[4:7], s22 offen offset:3072 sc1
  s_waitcnt vmcnt(5)
  v_cmp_eq_u32 vcc, -1, v152
  s_cbranch_vccnz reca_retry161
  s_branch reca_resume162
reca_retry161_to:
  s_mov_b32 s18, 0
  s_waitcnt vmcnt(0)
  s_branch reca_resume162
reca_retry163:
  s_sub_u32 s18, s18, 1
  s_cbranch_scc1 reca_retry163_to
  buffer_load_dwordx4 v[156:159], v13, s[4:7], s22 offen offset:3072 sc1
  buffer_load_dwordx4 v[160:163], v14, s[4:7], s22 offen offset:0 sc1
  buffer_load_dwordx4 v[164:167], v14, s[4:7], s22 offen offset:1024 sc1
  buffer_load_dwordx4 v[168:171], v14, s[4:7], s22 offen offset:2048 sc1
  buffer_load_dwordx4 v[172:175], v14, s[4:7], s22 offen offset:3072 sc1
  s_waitcnt vmcnt(4)
  v_cmp_eq_u32 vcc, -1, v156
  s_cbranch_vccnz reca_retry163
  s_branch reca_resume164
reca_retry163_to:
  s_mov_b32 s18, 0
  s_waitcnt vmcnt(0)
  s_branch reca_resume164
reca_retry165:
  s_sub_u32 s18, s18, 1
  s_cbranch_scc1 reca_retry165_to
  buffer_load_dwordx4 v[160:163], v14, s[4:7], s22 offen offset:0 sc1
  buffer_load_dwordx4 v[164:167], v14, s[4:7], s22 offen offset:1024 sc1
  buffer_load_dwordx4 v[168:171], v14, s[4:7], s22 offen offset:2048 sc1
  buffer_load_dwordx4 v[172:175], v14, s[4:7], s22 offen offset:3072 sc1
  s_waitcnt vmcnt(3)
  v_cmp_eq_u32 vcc, -1, v160
  s_cbranch_vccnz reca_retry165
  s_branch reca_resume166
reca_retry165_to:
  s_mov_b32 s18, 0
  s_waitcnt vmcnt(0)
  s_branch reca_resume166
reca_retry167:
  s_sub_u32 s18, s18, 1
  s_cbranch_scc1 reca_retry167_to
  buffer_load_dwordx4 v[164:167], v14, s[4:7], s22 offen offset:1024 sc1
  buffer_load_dwordx4 v[168:171], v14, s[4:7], s22 offen offset:2048 sc1
  buffer_load_dwordx4 v[172:175], v14, s[4:7], s22 offen offset:3072 sc1
  s_waitcnt vmcnt(2)
  v_cmp_eq_u32 vcc, -1, v164
  s_cbranch_vccnz reca_retry167
  s_branch reca_resume168
reca_retry167_to:
  s_mov_b32 s18, 0
  s_waitcnt vmcnt(0)
  s_branch reca_resume168
reca_retry169:
  s_sub_u32 s18, s18, 1
  s_cbranch_scc1 reca_retry169_to
  buffer_load_dwordx4 v[168:171], v14, s[4:7], s22 offen offset:2048 sc1
  buffer_load_dwordx4 v[172:175], v14, s[4:7], s22 offen offset:3072 sc1
  s_waitcnt vmcnt(1)
  v_cmp_eq_u32 vcc, -1, v168
  s_cbranch_vccnz reca_retry169
  s_branch reca_resume170
reca_retry169_to:
  s_mov_b32 s18, 0
  s_waitcnt vmcnt(0)
  s_branch reca_resume170
reca_retry171:
  s_sub_u32 s18, s18, 1
  s_cbranch_scc1 reca_retry171_to
  buffer_load_dwordx4 v[172:175], v14, s[4:7], s22 offen offset:3072 sc1
  s_waitcnt vmcnt(0)
  v_cmp_eq_u32 vcc, -1, v172
  s_cbranch_vccnz reca_retry171
  s_branch reca_resume172
reca_retry171_to:
  s_mov_b32 s18, 0
  s_waitcnt vmcnt(0)
  s_branch reca_resume172
reca_retry174:
  s_sub_u32 s18, s18, 1
  s_cbranch_scc1 reca_retry174_to
  buffer_load_dwordx4 v[128:131], v20, s[4:7], s25 offen sc1
  buffer_load_dwordx4 v[132:135], v21, s[4:7], s25 offen sc1
  buffer_load_dwordx4 v[136:139], v22, s[4:7], s25 offen sc1
  buffer_load_dwordx4 v[140:143], v23, s[4:7], s25 offen sc1
  buffer_load_dwordx4 v[144:147], v24, s[4:7], s25 offen sc1
  buffer_load_dwordx4 v[148:151], v25, s[4:7], s25 offen sc1
  buffer_load_dwordx4 v[152:155], v26, s[4:7], s25 offen sc1
  buffer_load_dwordx4 v[156:159], v27, s[4:7], s25 offen sc1
  s_waitcnt vmcnt(7)
  v_cmp_eq_u32 vcc, -1, v128
  s_cbranch_vccnz reca_retry174
  s_branch reca_resume175
reca_retry174_to:
  s_mov_b32 s18, 0
  s_waitcnt vmcnt(0)
  s_branch reca_resume175
reca_retry176:
  s_sub_u32 s18, s18, 1
  s_cbranch_scc1 reca_retry176_to
  buffer_load_dwordx4 v[132:135], v21, s[4:7], s25 offen sc1
  buffer_load_dwordx4 v[136:139], v22, s[4:7], s25 offen sc1
  buffer_load_dwordx4 v[140:143], v23, s[4:7], s25 offen sc1
  buffer_load_dwordx4 v[144:147], v24, s[4:7], s25 offen sc1
  buffer_load_dwordx4 v[148:151], v25, s[4:7], s25 offen sc1
  buffer_load_dwordx4 v[152:155], v26, s[4:7], s25 offen sc1
  buffer_load_dwordx4 v[156:159], v27, s[4:7], s25 offen sc1
  s_waitcnt vmcnt(6)
  v_cmp_eq_u32 vcc, -1, v132
  s_cbranch_vccnz reca_retry176
  s_branch reca_resume177
reca_retry176_to:
  s_mov_b32 s18, 0
  s_waitcnt vmcnt(0)
  s_branch reca_resume177
reca_retry178:
  s_sub_u32 s18, s18, 1
  s_cbranch_scc1 reca_retry178_to
  buffer_load_dwordx4 v[136:139], v22, s[4:7], s25 offen sc1
  buffer_load_dwordx4 v[140:143], v23, s[4:7], s25 offen sc1
  buffer_load_dwordx4 v[144:147], v24, s[4:7], s25 offen sc1
  buffer_load_dwordx4 v[148:151], v25, s[4:7], s25 offen sc1
  buffer_load_dwordx4 v[152:155], v26, s[4:7], s25 offen sc1
  buffer_load_dwordx4 v[156:159], v27, s[4:7], s25 offen sc1
  s_waitcnt vmcnt(5)
  v_cmp_eq_u32 vcc, -1, v136
  s_cbranch_vccnz reca_retry178
  s_branch reca_resume179
reca_retry178_to:
  s_mov_b32 s18, 0
  s_waitcnt vmcnt(0)
  s_branch reca_resume179
reca_retry180:
  s_sub_u32 s18, s18, 1
  s_cbranch_scc1 reca_retry180_to
  buffer_load_dwordx4 v[140:143], v23, s[4:7], s25 offen sc1
  buffer_load_dwordx4 v[144:147], v24, s[4:7], s25 offen sc1
  buffer_load_dwordx4 v[148:151], v25, s[4:7], s25 offen sc1
  buffer_load_dwordx4 v[152:155], v26, s[4:7], s25 offen sc1
  buffer_load_dwordx4 v[156:159], v27, s[4:7], s25 offen sc1
  s_waitcnt vmcnt(4)
  v_cmp_eq_u32 vcc, -1, v140
  s_cbranch_vccnz reca_retry180
  s_branch reca_resume181
reca_retry180_to:
  s_mov_b32 s18, 0
  s_waitcnt vmcnt(0)
  s_branch reca_resume181
reca_retry182:
  s_sub_u32 s18, s18, 1
  s_cbranch_scc1 reca_retry182_to
  buffer_load_dwordx4 v[144:147], v24, s[4:7], s25 offen sc1
  buffer_load_dwordx4 v[148:151], v25, s[4:7], s25 offen sc1
  buffer_load_dwordx4 v[152:155], v26, s[4:7], s25 offen sc1
  buffer_load_dwordx4 v[156:159], v27, s[4:7], s25 offen sc1
  s_waitcnt vmcnt(3)
  v_cmp_eq_u32 vcc, -1, v144
  s_cbranch_vccnz reca_retry182
  s_branch reca_resume183
reca_retry182_to:
  s_mov_b32 s18, 0
  s_waitcnt vmcnt(0)
  s_branch reca_resume183
reca_retry184:
  s_sub_u32 s18, s18, 1
  s_cbranch_scc1 reca_retry184_to
  buffer_load_dwordx4 v[148:151], v25, s[4:7], s25 offen sc1
  buffer_load_dwordx4 v[152:155], v26, s[4:7], s25 offen sc1
  buffer_load_dwordx4 v[156:159], v27, s[4:7], s25 offen sc1
  s_waitcnt vmcnt(2)
  v_cmp_eq_u32 vcc, -1, v148
  s_cbranch_vccnz reca_retry184
  s_branch reca_resume185
reca_retry184_to:
  s_mov_b32 s18, 0
  s_waitcnt vmcnt(0)
  s_branch reca_resume185
reca_retry186:
  s_sub_u32 s18, s18, 1
  s_cbranch_scc1 reca_retry186_to
  buffer_load_dwordx4 v[152:155], v26, s[4:7], s25 offen sc1
  buffer_load_dwordx4 v[156:159], v27, s[4:7], s25 offen sc1
  s_waitcnt vmcnt(1)
  v_cmp_eq_u32 vcc, -1, v152
  s_cbranch_vccnz reca_retry186
  s_branch reca_resume187
reca_retry186_to:
  s_mov_b32 s18, 0
  s_waitcnt vmcnt(0)
  s_branch reca_resume187
reca_retry188:
  s_sub_u32 s18, s18, 1
  s_cbranch_scc1 reca_retry188_to
  buffer_load_dwordx4 v[156:159], v27, s[4:7], s25 offen sc1
  s_waitcnt vmcnt(0)
  v_cmp_eq_u32 vcc, -1, v156
  s_cbranch_vccnz reca_retry188
  s_branch reca_resume189
reca_retry188_to:
  s_mov_b32 s18, 0
  s_waitcnt vmcnt(0)
  s_branch reca_resume189
reca_twins13:
  s_branch reca_gotmem194
reca_step193:
  s_and_b32 s34, s17, 3
  s_mul_i32 s20, s34, 10240
  s_add_u32 s20, s20, s38
  s_sleep 5
  buffer_load_dwordx4 v[128:131], v4, s[4:7], s20 offen sc1
  buffer_load_dwordx4 v[132:135], v4, s[4:7], s20 offen offset:1024 sc1
  buffer_load_dwordx4 v[136:139], v5, s[4:7], s20 offen sc1
  s_waitcnt vmcnt(2)
  v_max_u32 v29, v128, v130
  v_cmp_eq_u32 vcc, -1, v29
  s_cbranch_vccnz reca_retry196
reca_resume197:
  s_waitcnt vmcnt(1)
  v_max_u32 v29, v132, v134
  v_cmp_eq_u32 vcc, -1, v29
  ds_write_b128 v4, v[128:131]
  s_cbranch_vccnz reca_retry198
reca_resume199:
  s_waitcnt vmcnt(0)
  v_max_u32 v29, v136, v138
  v_cmp_eq_u32 vcc, -1, v29
  ds_write_b128 v4, v[132:135] offset:1024
  s_cbranch_vccnz reca_retry200
reca_resume201:
  ds_write_b128 v5, v[136:139]
  s_branch reca_gotmem2195
reca_gotmem194:
  ds_write_b128 v4, v[128:131]
  ds_write_b128 v4, v[132:135] offset:1024
  ds_write_b128 v5, v[136:139]
reca_gotmem2195:
  s_and_b32 s34, s17, 3
  s_mul_i32 s21, s34, 6144
  s_add_u32 s21, s21, s39
  s_mul_i32 s22, s34, 12288
  s_add_u32 s22, s22, s40
  s_mul_i32 s25, s34, 393216
  s_add_u32 s25, s25, s56
  s_add_u32 s35, s17, 1
  s_and_b32 s35, s35, 3
  s_mul_i32 s24, s35, 10240
  s_add_u32 s24, s24, s38
  s_waitcnt lgkmcnt(0)
  s_barrier
  ds_read_b128 v[128:131], v236 offset:0
  ds_read_b128 v[132:135], v236 offset:1024
  ds_read_b128 v[136:139], v236 offset:2048
  ds_read_b128 v[140:143], v236 offset:3072
  ds_read_b128 v[144:147], v236 offset:4096
  ds_read_b128 v[148:151], v237 offset:0
  ds_read_b128 v[152:155], v237 offset:1024
  ds_read_b128 v[156:159], v237 offset:2048
  ds_read_b128 v[160:163], v237 offset:3072
  ds_read_b128 v[164:167], v237 offset:4096
  s_waitcnt lgkmcnt(9)
  v_mfma_f32_16x16x32_bf16 v[44:47], a[0:3], v[128:131], 0
  ds_read_b128 v[168:171], v6 offset:0
  v_mfma_f32_16x16x32_bf16 v[240:243], a[4:7], v[128:131], 0
  s_waitcnt lgkmcnt(9)
  v_mfma_f32_16x16x32_bf16 v[44:47], a[8:11], v[132:135], v[44:47]
  ds_read_b128 v[172:175], v6 offset:512
  v_mfma_f32_16x16x32_bf16 v[240:243], a[12:15], v[132:135], v[240:243]
  s_waitcnt lgkmcnt(9)
  v_mfma_f32_16x16x32_bf16 v[44:47], a[16:19], v[136:139], v[44:47]
  ds_read_b128 v[176:179], v6 offset:1024
  v_mfma_f32_16x16x32_bf16 v[240:243], a[20:23], v[136:139], v[240:243]
  s_waitcnt lgkmcnt(9)
  v_mfma_f32_16x16x32_bf16 v[44:47], a[24:27], v[140:143], v[44:47]
  ds_read_b128 v[180:183], v6 offset:1536
  v_mfma_f32_16x16x32_bf16 v[240:243], a[28:31], v[140:143], v[240:243]
  s_waitcnt lgkmcnt(9)
  v_mfma_f32_16x16x32_bf16 v[44:47], a[32:35], v[144:147], v[44:47]
  ds_read_b128 v[184:187], v6 offset:2048
  v_mfma_f32_16x16x32_bf16 v[240:243], a[36:39], v[144:147], v[240:243]
  s_waitcnt lgkmcnt(9)
  v_mfma_f32_16x16x32_bf16 v[44:47], a[40:43], v[148:151], v[44:47]
  ds_read_b128 v[188:191], v6 offset:2560
  v_mfma_f32_16x16x32_bf16 v[240:243], a[44:47], v[148:151], v[240:243]
  s_waitcnt lgkmcnt(9)
  v_mfma_f32_16x16x32_bf16 v[44:47], a[48:51], v[152:155], v[44:47]
  ds_read_b128 v[192:195], v6 offset:3072
  v_mfma_f32_16x16x32_bf16 v[240:243], a[52:55], v[152:155], v[240:243]
  s_waitcnt lgkmcnt(9)
  v_mfma_f32_16x16x32_bf16 v[44:47], a[56:59], v[156:159], v[44:47]
  ds_read_b128 v[196:199], v6 offset:3584
  v_mfma_f32_16x16x32_bf16 v[240:243], a[60:63], v[156:159], v[240:243]
  s_waitcnt lgkmcnt(9)
  v_mfma_f32_16x16x32_bf16 v[44:47], a[64:67], v[160:163], v[44:47]
  ds_read_b128 v[200:203], v6 offset:4096
  v_mfma_f32_16x16x32_bf16 v[240:243], a[68:71], v[160:163], v[240:243]
  s_waitcnt lgkmcnt(9)
  v_mfma_f32_16x16x32_bf16 v[44:47], a[72:75], v[164:167], v[44:47]
  ds_read_b128 v[204:207], v6 offset:4608
  v_mfma_f32_16x16x32_bf16 v[240:243], a[76:79], v[164:167], v[240:243]
  s_waitcnt lgkmcnt(9)
  v_mfma_f32_16x16x32_bf16 v[48:51], v[168:171], a[80:83], 0
  s_and_b32 s34, s17, 7
  s_lshl_b32 s34, s34, 5
  s_add_u32 s34, s34, s15
  s_mul_i32 s34, s34, 3072
  s_lshl_b32 s35, s16, 9
  s_add_u32 s34, s34, s35
  s_add_u32 s30, s34, 47185920
  s_add_u32 s31, s34, 47972352
  v_add_f32_dpp v44, v240, v44 row_ror:8 row_mask:0xf bank_mask:0xf
  v_add_f32_dpp v45, v241, v45 row_ror:8 row_mask:0xf bank_mask:0xf
  v_add_f32_dpp v46, v242, v46 row_ror:8 row_mask:0xf bank_mask:0xf
  v_add_f32_dpp v47, v243, v47 row_ror:8 row_mask:0xf bank_mask:0xf
  v_cvt_pk_bf16_f32 v52, v44, v45
  v_cvt_pk_bf16_f32 v53, v46, v47
  buffer_store_dwordx2 v[52:53], v8, s[4:7], s21 offen sc1
  s_waitcnt lgkmcnt(8)
  v_mfma_f32_16x16x32_bf16 v[48:51], v[172:175], a[84:87], v[48:51]
  s_waitcnt lgkmcnt(7)
  v_mfma_f32_16x16x32_bf16 v[48:51], v[176:179], a[88:91], v[48:51]
  s_waitcnt lgkmcnt(6)
  v_mfma_f32_16x16x32_bf16 v[48:51], v[180:183], a[92:95], v[48:51]
  s_waitcnt lgkmcnt(5)
  v_mfma_f32_16x16x32_bf16 v[48:51], v[184:187], a[96:99], v[48:51]
  s_waitcnt lgkmcnt(4)
  v_mfma_f32_16x16x32_bf16 v[48:51], v[188:191], a[100:103], v[48:51]
  s_waitcnt lgkmcnt(3)
  v_mfma_f32_16x16x32_bf16 v[48:51], v[192:195], a[104:107], v[48:51]
  s_waitcnt lgkmcnt(2)
  v_mfma_f32_16x16x32_bf16 v[48:51], v[196:199], a[108:111], v[48:51]
  s_waitcnt lgkmcnt(1)
  v_mfma_f32_16x16x32_bf16 v[48:51], v[200:203], a[112:115], v[48:51]
  s_waitcnt lgkmcnt(0)
  v_mfma_f32_16x16x32_bf16 v[48:51], v[204:207], a[116:119], v[48:51]
  s_cmp_eq_u32 s12, 3
  s_cbranch_scc1 reca_swave202
  s_nop 5
  ds_write_b128 v17, v[48:51]
  s_add_u32 s34, s17, 2
  s_and_b32 s34, s34, 3
  s_mul_i32 s26, s34, 10240
  s_add_u32 s26, s26, s38
  s_mul_i32 s27, s34, 6144
  s_add_u32 s27, s27, s39
  s_mul_i32 s28, s34, 12288
  s_add_u32 s28, s28, s40
  s_mul_i32 s29, s34, 393216
  s_add_u32 s29, s29, s56
  s_waitcnt lgkmcnt(0)
  s_barrier
  s_cmp_eq_u32 s17, 63
  s_cbranch_scc1 reca_last204
  buffer_store_dwordx2 v[32:33], v8, s[4:7], s27 offen sc1
  s_cmp_lg_u32 s12, 2
  s_cbranch_scc1 reca_tw1208_n
  buffer_store_dwordx2 v[52:53], v9, s[4:7], s30 offen sc1
reca_tw1208_n:
  s_barrier
  s_cmp_eq_u32 s12, 1
  s_cbranch_scc1 reca_tw1208
  s_cmp_eq_u32 s12, 2
  s_cbranch_scc1 reca_tw2209
  s_cmp_lt_u32 s17, 2
  s_cbranch_scc1 reca_b5207
  s_cmp_gt_u32 s17, 61
  s_cbranch_scc1 reca_b5207
  s_sub_u32 s36, s17, 2
  s_and_b32 s36, s36, 7
  s_lshl_b32 s34, s59, 3
  s_add_u32 s34, s34, s36
  s_mul_i32 s34, s34, 12288
  s_add_u32 s23, s34, 37748736
  s_add_u32 s60, s34, 44040192
  s_lshl_b32 s35, s36, 5
  s_add_u32 s35, s35, s59
  s_mul_i32 s35, s35, 3072
  s_add_u32 s61, s35, 47185920
  buffer_load_dwordx4 a[120:123], v1, s[4:7], s23 offen offset:0 sc1
  buffer_load_dwordx4 a[124:127], v1, s[4:7], s23 offen offset:1024 sc1
  buffer_load_dwordx4 a[128:131], v1, s[4:7], s23 offen offset:2048 sc1
  buffer_load_dwordx4 a[132:135], v1, s[4:7], s23 offen offset:3072 sc1
  buffer_load_dwordx4 a[136:139], v2, s[4:7], s23 offen offset:0 sc1
  buffer_load_dwordx4 a[140:143], v2, s[4:7], s23 offen offset:1024 sc1
  buffer_load_dwordx4 a[144:147], v2, s[4:7], s23 offen offset:2048 sc1
  buffer_load_dwordx4 a[148:151], v2, s[4:7], s23 offen offset:3072 sc1
  buffer_load_dwordx4 a[152:155], v3, s[4:7], s23 offen offset:0 sc1
  buffer_load_dwordx4 a[156:159], v3, s[4:7], s23 offen offset:1024 sc1
  buffer_load_dwordx4 a[160:163], v3, s[4:7], s23 offen offset:2048 sc1
  buffer_load_dwordx4 a[164:167], v3, s[4:7], s23 offen offset:3072 sc1
  buffer_load_dwordx4 a[216:219], v92, s[4:7], s61 offen offset:0 sc1
  buffer_load_dwordx4 a[220:223], v92, s[4:7], s61 offen offset:512 sc1
  buffer_load_dwordx4 a[224:227], v92, s[4:7], s61 offen offset:1024 sc1
  buffer_load_dwordx4 a[228:231], v92, s[4:7], s61 offen offset:1536 sc1
  buffer_load_dwordx4 a[232:235], v92, s[4:7], s61 offen offset:2048 sc1
  buffer_load_dwordx4 a[236:239], v92, s[4:7], s61 offen offset:2560 sc1
  buffer_load_dwordx4 a[168:171], v1, s[4:7], s60 offen offset:0 sc1
  buffer_load_dwordx4 a[172:175], v1, s[4:7], s60 offen offset:1024 sc1
  buffer_load_dwordx4 a[176:179], v1, s[4:7], s60 offen offset:2048 sc1
  buffer_load_dwordx4 a[180:183], v1, s[4:7], s60 offen offset:3072 sc1
  buffer_load_dwordx4 a[184:187], v2, s[4:7], s60 offen offset:0 sc1
  buffer_load_dwordx4 a[188:191], v2, s[4:7], s60 offen offset:1024 sc1
  buffer_load_dwordx4 a[192:195], v2, s[4:7], s60 offen offset:2048 sc1
  buffer_load_dwordx4 a[196:199], v2, s[4:7], s60 offen offset:3072 sc1
  buffer_load_dwordx4 a[200:203], v3, s[4:7], s60 offen offset:0 sc1
  buffer_load_dwordx4 a[204:207], v3, s[4:7], s60 offen offset:1024 sc1
  buffer_load_dwordx4 a[208:211], v3, s[4:7], s60 offen offset:2048 sc1
  buffer_load_dwordx4 a[212:215], v3, s[4:7], s60 offen offset:3072 sc1
  s_waitcnt vmcnt(5)
  v_mfma_f32_16x16x32_bf16 v[128:131], a[216:219], a[168:171], v[84:87]
  v_mfma_f32_16x16x32_bf16 v[132:135], a[120:123], a[168:171], v[88:91]
  v_mfma_f32_16x16x32_bf16 v[136:139], a[216:219], a[192:195], v[84:87]
  v_mfma_f32_16x16x32_bf16 v[140:143], a[120:123], a[192:195], 0
  v_mfma_f32_16x16x32_bf16 v[144:147], a[144:147], a[192:195], v[88:91]
  s_waitcnt vmcnt(4)
  v_mfma_f32_16x16x32_bf16 v[128:131], a[220:223], a[172:175], v[128:131]
  v_mfma_f32_16x16x32_bf16 v[132:135], a[124:127], a[172:175], v[132:135]
  v_mfma_f32_16x16x32_bf16 v[136:139], a[220:223], a[196:199], v[136:139]
  v_mfma_f32_16x16x32_bf16 v[140:143], a[124:127], a[196:199], v[140:143]
  v_mfma_f32_16x16x32_bf16 v[144:147], a[148:151], a[196:199], v[144:147]
  s_waitcnt vmcnt(3)
  v_mfma_f32_16x16x32_bf16 v[128:131], a[224:227], a[176:179], v[128:131]
  v_mfma_f32_16x16x32_bf16 v[132:135], a[128:131], a[176:179], v[132:135]
  v_mfma_f32_16x16x32_bf16 v[136:139], a[224:227], a[200:203], v[136:139]
  v_mfma_f32_16x16x32_bf16 v[140:143], a[128:131], a[200:203], v[140:143]
  v_mfma_f32_16x16x32_bf16 v[144:147], a[152:155], a[200:203], v[144:147]
  s_waitcnt vmcnt(2)
  v_mfma_f32_16x16x32_bf16 v[128:131], a[228:231], a[180:183], v[128:131]
  v_mfma_f32_16x16x32_bf16 v[132:135], a[132:135], a[180:183], v[132:135]
  v_mfma_f32_16x16x32_bf16 v[136:139], a[228:231], a[204:207], v[136:139]
  v_mfma_f32_16x16x32_bf16 v[140:143], a[132:135], a[204:207], v[140:143]
  v_mfma_f32_16x16x32_bf16 v[144:147], a[156:159], a[204:207], v[144:147]
  s_waitcnt vmcnt(1)
  v_mfma_f32_16x16x32_bf16 v[128:131], a[232:235], a[184:187], v[128:131]
  v_mfma_f32_16x16x32_bf16 v[132:135], a[136:139], a[184:187], v[132:135]
  v_mfma_f32_16x16x32_bf16 v[136:139], a[232:235], a[208:211], v[136:139]
  v_mfma_f32_16x16x32_bf16 v[140:143], a[136:139], a[208:211], v[140:143]
  v_mfma_f32_16x16x32_bf16 v[144:147], a[160:163], a[208:211], v[144:147]
  s_waitcnt vmcnt(0)
  v_mfma_f32_16x16x32_bf16 v[128:131], a[236:239], a[188:191], v[128:131]
  v_mfma_f32_16x16x32_bf16 v[132:135], a[140:143], a[188:191], v[132:135]
  v_mfma_f32_16x16x32_bf16 v[136:139], a[236:239], a[212:215], v[136:139]
  v_mfma_f32_16x16x32_bf16 v[140:143], a[140:143], a[212:215], v[140:143]
  v_mfma_f32_16x16x32_bf16 v[144:147], a[164:167], a[212:215], v[144:147]
  s_nop 3
  v_max3_f32 v28, v128, v129, v130
  v_max3_f32 v28, v28, v131, v132
  v_max3_f32 v28, v28, v133, v134
  v_max_f32 v28, v28, v135
  v_mov_b32 v29, v28
  s_nop 1
  v_permlane32_swap_b32 v28, v29
  v_max_f32 v28, v28, v29
  v_mov_b32 v29, v28
  s_nop 1
  v_permlane16_swap_b32 v28, v29
  v_max_f32 v28, v28, v29
  v_mul_f32 v28, s41, v28
  v_fma_f32 v128, v128, s41, -v28
  v_fma_f32 v129, v129, s41, -v28
  v_fma_f32 v130, v130, s41, -v28
  v_fma_f32 v131, v131, s41, -v28
  v_fma_f32 v132, v132, s41, -v28
  v_fma_f32 v133, v133, s41, -v28
  v_fma_f32 v134, v134, s41, -v28
  v_fma_f32 v135, v135, s41, -v28
  v_exp_f32 v128, v128
  v_exp_f32 v129, v129
  v_exp_f32 v130, v130
  v_exp_f32 v131, v131
  v_exp_f32 v132, v132
  v_exp_f32 v133, v133
  v_exp_f32 v134, v134
  v_exp_f32 v135, v135
  v_max3_f32 v30, v136, v137, v138
  v_max3_f32 v30, v30, v139, v140
  v_max3_f32 v30, v30, v141, v142
  v_max3_f32 v30, v30, v143, v144
  v_max3_f32 v30, v30, v145, v146
  v_max_f32 v30, v30, v147
  v_mov_b32 v29, v30
  s_nop 1
  v_permlane32_swap_b32 v30, v29
  v_max_f32 v30, v30, v29
  v_mov_b32 v29, v30
  s_nop 1
  v_permlane16_swap_b32 v30, v29
  v_max_f32 v30, v30, v29
  v_mul_f32 v30, s41, v30
  v_fma_f32 v136, v136, s41, -v30
  v_fma_f32 v137, v137, s41, -v30
  v_fma_f32 v138, v138, s41, -v30
  v_fma_f32 v139, v139, s41, -v30
  v_fma_f32 v140, v140, s41, -v30
  v_fma_f32 v141, v141, s41, -v30
  v_fma_f32 v142, v142, s41, -v30
  v_fma_f32 v143, v143, s41, -v30
  v_fma_f32 v144, v144, s41, -v30
  v_fma_f32 v145, v145, s41, -v30
  v_fma_f32 v146, v146, s41, -v30
  v_fma_f32 v147, v147, s41, -v30
  v_exp_f32 v136, v136
  v_exp_f32 v137, v137
  v_exp_f32 v138, v138
  v_exp_f32 v139, v139
  v_exp_f32 v140, v140
  v_exp_f32 v141, v141
  v_exp_f32 v142, v142
  v_exp_f32 v143, v143
  v_exp_f32 v144, v144
  v_exp_f32 v145, v145
  v_exp_f32 v146, v146
  v_exp_f32 v147, v147
  v_cvt_pk_bf16_f32 v72, v128, v129
  v_cvt_pk_bf16_f32 v73, v130, v131
  v_cvt_pk_bf16_f32 v74, v132, v133
  v_cvt_pk_bf16_f32 v75, v134, v135
  v_cvt_pk_bf16_f32 v76, v136, v137
  v_cvt_pk_bf16_f32 v77, v138, v139
  v_cvt_pk_bf16_f32 v78, v140, v141
  v_cvt_pk_bf16_f32 v79, v142, v143
  v_cvt_pk_bf16_f32 v80, v144, v145
  v_cvt_pk_bf16_f32 v81, v146, v147
  v_mfma_f32_16x16x16_bf16 v[148:151], v[36:37], v[72:73], 0
  v_mfma_f32_16x16x16_bf16 v[152:155], v[36:37], v[76:77], 0
  v_mfma_f32_16x16x16_bf16 v[148:151], v[36:37], v[74:75], v[148:151]
  v_mfma_f32_16x16x32_bf16 v[152:155], v[36:39], v[78:81], v[152:155]
  s_nop 6
  v_rcp_f32 v82, v148
  v_rcp_f32 v83, v152
  s_and_b32 s34, s17, 1
  s_mul_i32 s34, s34, 3072
  v_add_u32 v28, s34, v1
  ds_write_b128 v28, v[72:75] offset:16384
  ds_write_b128 v28, v[76:79] offset:17408
  ds_write_b128 v28, v[80:83] offset:18432
  s_waitcnt lgkmcnt(0)
  s_branch reca_b5207
reca_tw1208:
  s_cmp_lt_u32 s17, 3
  s_cbranch_scc1 reca_b5207
  s_sub_u32 s36, s17, 3
  s_and_b32 s37, s36, 7
  s_lshl_b32 s34, s59, 3
  s_add_u32 s34, s34, s37
  s_mul_i32 s34, s34, 12288
  s_add_u32 s23, s34, 40894464
  s_lshl_b32 s35, s37, 5
  s_add_u32 s35, s35, s59
  s_mul_i32 s35, s35, 3072
  s_add_u32 s61, s35, 47972352
  s_mul_i32 s34, s36, 393216
  s_mul_i32 s35, s59, 6144
  s_add_u32 s34, s34, s35
  s_add_u32 s60, s34, 57147392
  s_add_u32 s34, s17, 1
  s_and_b32 s34, s34, 1
  s_mul_i32 s34, s34, 3072
  v_add_u32 v28, s34, v1
  ds_read_b128 v[72:75], v28 offset:16384
  ds_read_b128 v[76:79], v28 offset:17408
  ds_read_b128 v[80:83], v28 offset:18432
  buffer_load_dwordx2 a[168:169], v93, s[4:7], s61 offen offset:0 sc1
  buffer_load_dwordx4 a[120:123], v1, s[4:7], s23 offen offset:0 sc1
  buffer_load_dwordx2 a[170:171], v93, s[4:7], s61 offen offset:256 sc1
  buffer_load_dwordx4 a[124:127], v1, s[4:7], s23 offen offset:1024 sc1
  buffer_load_dwordx2 a[172:173], v93, s[4:7], s61 offen offset:512 sc1
  buffer_load_dwordx4 a[128:131], v1, s[4:7], s23 offen offset:2048 sc1
  buffer_load_dwordx2 a[174:175], v93, s[4:7], s61 offen offset:768 sc1
  buffer_load_dwordx4 a[132:135], v1, s[4:7], s23 offen offset:3072 sc1
  buffer_load_dwordx2 a[176:177], v93, s[4:7], s61 offen offset:1024 sc1
  buffer_load_dwordx4 a[136:139], v2, s[4:7], s23 offen offset:0 sc1
  buffer_load_dwordx2 a[178:179], v93, s[4:7], s61 offen offset:1280 sc1
  buffer_load_dwordx4 a[140:143], v2, s[4:7], s23 offen offset:1024 sc1
  s_waitcnt lgkmcnt(0)
  s_waitcnt vmcnt(8)
  v_mfma_f32_16x16x16_bf16 v[156:159], a[168:169], v[72:73], 0
  v_mfma_f32_16x16x16_bf16 v[160:163], a[168:169], v[76:77], 0
  v_mfma_f32_16x16x16_bf16 v[156:159], a[120:121], v[74:75], v[156:159]
  v_mfma_f32_16x16x32_bf16 v[160:163], a[120:123], v[78:81], v[160:163]
  v_mfma_f32_16x16x16_bf16 v[164:167], a[170:171], v[72:73], 0
  v_mfma_f32_16x16x16_bf16 v[168:171], a[170:171], v[76:77], 0
  v_mfma_f32_16x16x16_bf16 v[164:167], a[124:125], v[74:75], v[164:167]
  v_mfma_f32_16x16x32_bf16 v[168:171], a[124:127], v[78:81], v[168:171]
  s_nop 2
  v_mul_f32 v156, v156, v82
  v_mul_f32 v157, v157, v82
  v_mul_f32 v158, v158, v82
  v_mul_f32 v159, v159, v82
  v_cvt_pk_bf16_f32 v172, v156, v157
  v_cvt_pk_bf16_f32 v173, v158, v159
  v_mul_f32 v164, v164, v82
  v_mul_f32 v165, v165, v82
  v_mul_f32 v166, v166, v82
  v_mul_f32 v167, v167, v82
  v_cvt_pk_bf16_f32 v174, v164, v165
  v_cvt_pk_bf16_f32 v175, v166, v167
  buffer_store_dwordx4 v[172:175], v1, s[4:7], s60 offen offset:0 sc1
  v_mul_f32 v160, v160, v83
  v_mul_f32 v161, v161, v83
  v_mul_f32 v162, v162, v83
  v_mul_f32 v163, v163, v83
  v_cvt_pk_bf16_f32 v176, v160, v161
  v_cvt_pk_bf16_f32 v177, v162, v163
  v_mul_f32 v168, v168, v83
  v_mul_f32 v169, v169, v83
  v_mul_f32 v170, v170, v83
  v_mul_f32 v171, v171, v83
  v_cvt_pk_bf16_f32 v178, v168, v169
  v_cvt_pk_bf16_f32 v179, v170, v171
  s_add_u32 s34, s60, 196608
  buffer_store_dwordx4 v[176:179], v1, s[4:7], s34 offen offset:0 sc1
  s_waitcnt vmcnt(6)
  v_mfma_f32_16x16x16_bf16 v[156:159], a[172:173], v[72:73], 0
  v_mfma_f32_16x16x16_bf16 v[160:163], a[172:173], v[76:77], 0
  v_mfma_f32_16x16x16_bf16 v[156:159], a[128:129], v[74:75], v[156:159]
  v_mfma_f32_16x16x32_bf16 v[160:163], a[128:131], v[78:81], v[160:163]
  v_mfma_f32_16x16x16_bf16 v[164:167], a[174:175], v[72:73], 0
  v_mfma_f32_16x16x16_bf16 v[168:171], a[174:175], v[76:77], 0
  v_mfma_f32_16x16x16_bf16 v[164:167], a[132:133], v[74:75], v[164:167]
  v_mfma_f32_16x16x32_bf16 v[168:171], a[132:135], v[78:81], v[168:171]
  s_nop 2
  v_mul_f32 v156, v156, v82
  v_mul_f32 v157, v157, v82
  v_mul_f32 v158, v158, v82
  v_mul_f32 v159, v159, v82
  v_cvt_pk_bf16_f32 v172, v156, v157
  v_cvt_pk_bf16_f32 v173, v158, v159
  v_mul_f32 v164, v164, v82
  v_mul_f32 v165, v165, v82
  v_mul_f32 v166, v166, v82
  v_mul_f32 v167, v167, v82
  v_cvt_pk_bf16_f32 v174, v164, v165
  v_cvt_pk_bf16_f32 v175, v166, v167
  buffer_store_dwordx4 v[172:175], v1, s[4:7], s60 offen offset:1024 sc1
  v_mul_f32 v160, v160, v83
  v_mul_f32 v161, v161, v83
  v_mul_f32 v162, v162, v83
  v_mul_f32 v163, v163, v83
  v_cvt_pk_bf16_f32 v176, v160, v161
  v_cvt_pk_bf16_f32 v177, v162, v163
  v_mul_f32 v168, v168, v83
  v_mul_f32 v169, v169, v83
  v_mul_f32 v170, v170, v83
  v_mul_f32 v171, v171, v83
  v_cvt_pk_bf16_f32 v178, v168, v169
  v_cvt_pk_bf16_f32 v179, v170, v171
  s_add_u32 s34, s60, 196608
  buffer_store_dwordx4 v[176:179], v1, s[4:7], s34 offen offset:1024 sc1
  s_waitcnt vmcnt(4)
  v_mfma_f32_16x16x16_bf16 v[156:159], a[176:177], v[72:73], 0
  v_mfma_f32_16x16x16_bf16 v[160:163], a[176:177], v[76:77], 0
  v_mfma_f32_16x16x16_bf16 v[156:159], a[136:137], v[74:75], v[156:159]
  v_mfma_f32_16x16x32_bf16 v[160:163], a[136:139], v[78:81], v[160:163]
  v_mfma_f32_16x16x16_bf16 v[164:167], a[178:179], v[72:73], 0
  v_mfma_f32_16x16x16_bf16 v[168:171], a[178:179], v[76:77], 0
  v_mfma_f32_16x16x16_bf16 v[164:167], a[140:141], v[74:75], v[164:167]
  v_mfma_f32_16x16x32_bf16 v[168:171], a[140:143], v[78:81], v[168:171]
  s_nop 2
  v_mul_f32 v156, v156, v82
  v_mul_f32 v157, v157, v82
  v_mul_f32 v158, v158, v82
  v_mul_f32 v159, v159, v82
  v_cvt_pk_bf16_f32 v172, v156, v157
  v_cvt_pk_bf16_f32 v173, v158, v159
  v_mul_f32 v164, v164, v82
  v_mul_f32 v165, v165, v82
  v_mul_f32 v166, v166, v82
  v_mul_f32 v167, v167, v82
  v_cvt_pk_bf16_f32 v174, v164, v165
  v_cvt_pk_bf16_f32 v175, v166, v167
  buffer_store_dwordx4 v[172:175], v1, s[4:7], s60 offen offset:2048 sc1
  v_mul_f32 v160, v160, v83
  v_mul_f32 v161, v161, v83
  v_mul_f32 v162, v162, v83
  v_mul_f32 v163, v163, v83
  v_cvt_pk_bf16_f32 v176, v160, v161
  v_cvt_pk_bf16_f32 v177, v162, v163
  v_mul_f32 v168, v168, v83
  v_mul_f32 v169, v169, v83
  v_mul_f32 v170, v170, v83
  v_mul_f32 v171, v171, v83
  v_cvt_pk_bf16_f32 v178, v168, v169
  v_cvt_pk_bf16_f32 v179, v170, v171
  s_add_u32 s34, s60, 196608
  buffer_store_dwordx4 v[176:179], v1, s[4:7], s34 offen offset:2048 sc1
  s_branch reca_b5207
reca_tw2209:
  s_cmp_lt_u32 s17, 3
  s_cbranch_scc1 reca_b5207
  s_sub_u32 s36, s17, 3
  s_and_b32 s37, s36, 7
  s_lshl_b32 s34, s59, 3
  s_add_u32 s34, s34, s37
  s_mul_i32 s34, s34, 12288
  s_add_u32 s23, s34, 40894464
  s_lshl_b32 s35, s37, 5
  s_add_u32 s35, s35, s59
  s_mul_i32 s35, s35, 3072
  s_add_u32 s61, s35, 47972352
  s_mul_i32 s34, s36, 393216
  s_mul_i32 s35, s59, 6144
  s_add_u32 s34, s34, s35
  s_add_u32 s60, s34, 57147392
  s_add_u32 s34, s17, 1
  s_and_b32 s34, s34, 1
  s_mul_i32 s34, s34, 3072
  v_add_u32 v28, s34, v1
  ds_read_b128 v[72:75], v28 offset:16384
  ds_read_b128 v[76:79], v28 offset:17408
  ds_read_b128 v[80:83], v28 offset:18432
  buffer_load_dwordx2 a[180:181], v93, s[4:7], s61 offen offset:1536 sc1
  buffer_load_dwordx4 a[144:147], v2, s[4:7], s23 offen offset:2048 sc1
  buffer_load_dwordx2 a[182:183], v93, s[4:7], s61 offen offset:1792 sc1
  buffer_load_dwordx4 a[148:151], v2, s[4:7], s23 offen offset:3072 sc1
  buffer_load_dwordx2 a[184:185], v93, s[4:7], s61 offen offset:2048 sc1
  buffer_load_dwordx4 a[152:155], v3, s[4:7], s23 offen offset:0 sc1
  buffer_load_dwordx2 a[186:187], v93, s[4:7], s61 offen offset:2304 sc1
  buffer_load_dwordx4 a[156:159], v3, s[4:7], s23 offen offset:1024 sc1
  buffer_load_dwordx2 a[188:189], v93, s[4:7], s61 offen offset:2560 sc1
  buffer_load_dwordx4 a[160:163], v3, s[4:7], s23 offen offset:2048 sc1
  buffer_load_dwordx2 a[190:191], v93, s[4:7], s61 offen offset:2816 sc1
  buffer_load_dwordx4 a[164:167], v3, s[4:7], s23 offen offset:3072 sc1
  s_waitcnt lgkmcnt(0)
  s_waitcnt vmcnt(8)
  v_mfma_f32_16x16x16_bf16 v[156:159], a[180:181], v[72:73], 0
  v_mfma_f32_16x16x16_bf16 v[160:163], a[180:181], v[76:77], 0
  v_mfma_f32_16x16x16_bf16 v[156:159], a[144:145], v[74:75], v[156:159]
  v_mfma_f32_16x16x32_bf16 v[160:163], a[144:147], v[78:81], v[160:163]
  v_mfma_f32_16x16x16_bf16 v[164:167], a[182:183], v[72:73], 0
  v_mfma_f32_16x16x16_bf16 v[168:171], a[182:183], v[76:77], 0
  v_mfma_f32_16x16x16_bf16 v[164:167], a[148:149], v[74:75], v[164:167]
  v_mfma_f32_16x16x32_bf16 v[168:171], a[148:151], v[78:81], v[168:171]
  s_nop 2
  v_mul_f32 v156, v156, v82
  v_mul_f32 v157, v157, v82
  v_mul_f32 v158, v158, v82
  v_mul_f32 v159, v159, v82
  v_cvt_pk_bf16_f32 v172, v156, v157
  v_cvt_pk_bf16_f32 v173, v158, v159
  v_mul_f32 v164, v164, v82
  v_mul_f32 v165, v165, v82
  v_mul_f32 v166, v166, v82
  v_mul_f32 v167, v167, v82
  v_cvt_pk_bf16_f32 v174, v164, v165
  v_cvt_pk_bf16_f32 v175, v166, v167
  buffer_store_dwordx4 v[172:175], v1, s[4:7], s60 offen offset:3072 sc1
  v_mul_f32 v160, v160, v83
  v_mul_f32 v161, v161, v83
  v_mul_f32 v162, v162, v83
  v_mul_f32 v163, v163, v83
  v_cvt_pk_bf16_f32 v176, v160, v161
  v_cvt_pk_bf16_f32 v177, v162, v163
  v_mul_f32 v168, v168, v83
  v_mul_f32 v169, v169, v83
  v_mul_f32 v170, v170, v83
  v_mul_f32 v171, v171, v83
  v_cvt_pk_bf16_f32 v178, v168, v169
  v_cvt_pk_bf16_f32 v179, v170, v171
  s_add_u32 s34, s60, 196608
  buffer_store_dwordx4 v[176:179], v1, s[4:7], s34 offen offset:3072 sc1
  s_waitcnt vmcnt(6)
  v_mfma_f32_16x16x16_bf16 v[156:159], a[184:185], v[72:73], 0
  v_mfma_f32_16x16x16_bf16 v[160:163], a[184:185], v[76:77], 0
  v_mfma_f32_16x16x16_bf16 v[156:159], a[152:153], v[74:75], v[156:159]
  v_mfma_f32_16x16x32_bf16 v[160:163], a[152:155], v[78:81], v[160:163]
  v_mfma_f32_16x16x16_bf16 v[164:167], a[186:187], v[72:73], 0
  v_mfma_f32_16x16x16_bf16 v[168:171], a[186:187], v[76:77], 0
  v_mfma_f32_16x16x16_bf16 v[164:167], a[156:157], v[74:75], v[164:167]
  v_mfma_f32_16x16x32_bf16 v[168:171], a[156:159], v[78:81], v[168:171]
  s_nop 2
  v_mul_f32 v156, v156, v82
  v_mul_f32 v157, v157, v82
  v_mul_f32 v158, v158, v82
  v_mul_f32 v159, v159, v82
  v_cvt_pk_bf16_f32 v172, v156, v157
  v_cvt_pk_bf16_f32 v173, v158, v159
  v_mul_f32 v164, v164, v82
  v_mul_f32 v165, v165, v82
  v_mul_f32 v166, v166, v82
  v_mul_f32 v167, v167, v82
  v_cvt_pk_bf16_f32 v174, v164, v165
  v_cvt_pk_bf16_f32 v175, v166, v167
  buffer_store_dwordx4 v[172:175], v2, s[4:7], s60 offen offset:0 sc1
  v_mul_f32 v160, v160, v83
  v_mul_f32 v161, v161, v83
  v_mul_f32 v162, v162, v83
  v_mul_f32 v163, v163, v83
  v_cvt_pk_bf16_f32 v176, v160, v161
  v_cvt_pk_bf16_f32 v177, v162, v163
  v_mul_f32 v168, v168, v83
  v_mul_f32 v169, v169, v83
  v_mul_f32 v170, v170, v83
  v_mul_f32 v171, v171, v83
  v_cvt_pk_bf16_f32 v178, v168, v169
  v_cvt_pk_bf16_f32 v179, v170, v171
  s_add_u32 s34, s60, 196608
  buffer_store_dwordx4 v[176:179], v2, s[4:7], s34 offen offset:0 sc1
  s_waitcnt vmcnt(4)
  v_mfma_f32_16x16x16_bf16 v[156:159], a[188:189], v[72:73], 0
  v_mfma_f32_16x16x16_bf16 v[160:163], a[188:189], v[76:77], 0
  v_mfma_f32_16x16x16_bf16 v[156:159], a[160:161], v[74:75], v[156:159]
  v_mfma_f32_16x16x32_bf16 v[160:163], a[160:163], v[78:81], v[160:163]
  v_mfma_f32_16x16x16_bf16 v[164:167], a[190:191], v[72:73], 0
  v_mfma_f32_16x16x16_bf16 v[168:171], a[190:191], v[76:77], 0
  v_mfma_f32_16x16x16_bf16 v[164:167], a[164:165], v[74:75], v[164:167]
  v_mfma_f32_16x16x32_bf16 v[168:171], a[164:167], v[78:81], v[168:171]
  s_nop 2
  v_mul_f32 v156, v156, v82
  v_mul_f32 v157, v157, v82
  v_mul_f32 v158, v158, v82
  v_mul_f32 v159, v159, v82
  v_cvt_pk_bf16_f32 v172, v156, v157
  v_cvt_pk_bf16_f32 v173, v158, v159
  v_mul_f32 v164, v164, v82
  v_mul_f32 v165, v165, v82
  v_mul_f32 v166, v166, v82
  v_mul_f32 v167, v167, v82
  v_cvt_pk_bf16_f32 v174, v164, v165
  v_cvt_pk_bf16_f32 v175, v166, v167
  buffer_store_dwordx4 v[172:175], v2, s[4:7], s60 offen offset:1024 sc1
  v_mul_f32 v160, v160, v83
  v_mul_f32 v161, v161, v83
  v_mul_f32 v162, v162, v83
  v_mul_f32 v163, v163, v83
  v_cvt_pk_bf16_f32 v176, v160, v161
  v_cvt_pk_bf16_f32 v177, v162, v163
  v_mul_f32 v168, v168, v83
  v_mul_f32 v169, v169, v83
  v_mul_f32 v170, v170, v83
  v_mul_f32 v171, v171, v83
  v_cvt_pk_bf16_f32 v178, v168, v169
  v_cvt_pk_bf16_f32 v179, v170, v171
  s_add_u32 s34, s60, 196608
  buffer_store_dwordx4 v[176:179], v2, s[4:7], s34 offen offset:1024 sc1
  s_branch reca_b5207
  s_cmp_lg_u32 s12, 2
  s_cbranch_scc1 reca_b3205
  buffer_store_dwordx2 v[52:53], v9, s[4:7], s30 offen sc1
  buffer_store_dwordx2 v[32:33], v16, s[4:7], s26 offen sc1
  s_cmp_lg_u32 s14, 0
  s_cbranch_scc1 reca_b3205
  v_mov_b32 v28, s17
  s_lshl_b32 s34, s13, 7
  s_add_u32 s34, s34, 1507328
  buffer_store_dword v28, v19, s[4:7], s34 offen sc1
  s_branch reca_b3205
reca_last204:
  s_cmp_lg_u32 s12, 2
  s_cbranch_scc1 reca_exit1
  buffer_store_dwordx2 v[52:53], v9, s[4:7], s30 offen
  s_branch reca_exit1
reca_swave202:
  s_cmp_lg_u32 s17, 63
  s_cbranch_scc1 reca_vmst210
  s_barrier
  ds_read_b128 v[56:59], v1 offset:10240
  ds_read_b128 v[60:63], v1 offset:11264
  ds_read_b128 v[64:67], v1 offset:12288
  s_waitcnt lgkmcnt(0)
  v_add_f32 v56, v56, v64
  v_add_f32 v60, v60, v48
  v_add_f32 v57, v57, v65
  v_add_f32 v61, v61, v49
  v_add_f32 v58, v58, v66
  v_add_f32 v62, v62, v50
  v_add_f32 v59, v59, v67
  v_add_f32 v63, v63, v51
  v_cvt_pk_bf16_f32 v68, v56, v57
  v_cvt_pk_bf16_f32 v69, v58, v59
  v_cvt_pk_bf16_f32 v70, v60, v61
  v_cvt_pk_bf16_f32 v71, v62, v63
  buffer_store_dwordx2 v[52:53], v9, s[4:7], s30 offen
  buffer_store_dwordx2 v[68:69], v10, s[4:7], s31 offen
  buffer_store_dwordx2 v[70:71], v10, s[4:7], s31 offen offset:256
  s_branch reca_exit1
reca_vmst210:
  s_sleep 1
  buffer_load_dwordx4 v[208:211], v1, s[4:7], s21 offen offset:0 sc1
  buffer_load_dwordx4 v[212:215], v1, s[4:7], s21 offen offset:1024 sc1
  buffer_load_dwordx4 v[216:219], v1, s[4:7], s21 offen offset:2048 sc1
  buffer_load_dwordx4 v[220:223], v1, s[4:7], s21 offen offset:3072 sc1
  buffer_load_dwordx4 v[224:227], v2, s[4:7], s21 offen offset:0 sc1
  buffer_load_dwordx4 v[228:231], v2, s[4:7], s21 offen offset:1024 sc1
  s_waitcnt vmcnt(5)
  v_max_u32 v29, v208, v210
  v_cmp_eq_u32 vcc, -1, v29
  s_cbranch_vccnz reca_retry211
reca_resume212:
  s_waitcnt vmcnt(4)
  v_max_u32 v29, v212, v214
  v_cmp_eq_u32 vcc, -1, v29
  v_mfma_f32_16x16x32_bf16 v[76:79], a[120:123], v[208:211], 0
  v_mfma_f32_16x16x32_bf16 v[80:83], a[144:147], v[208:211], 0
  v_mfma_f32_16x16x32_bf16 v[72:75], v[208:211], v[208:211], v[40:43]
  s_cbranch_vccnz reca_retry213
reca_resume214:
  s_waitcnt vmcnt(3)
  v_max_u32 v29, v216, v218
  v_cmp_eq_u32 vcc, -1, v29
  v_mfma_f32_16x16x32_bf16 v[76:79], a[124:127], v[212:215], v[76:79]
  v_mfma_f32_16x16x32_bf16 v[80:83], a[148:151], v[212:215], v[80:83]
  v_mfma_f32_16x16x32_bf16 v[72:75], v[212:215], v[212:215], v[72:75]
  s_cbranch_vccnz reca_retry215
reca_resume216:
  s_waitcnt vmcnt(2)
  v_max_u32 v29, v220, v222
  v_cmp_eq_u32 vcc, -1, v29
  v_mfma_f32_16x16x32_bf16 v[76:79], a[128:131], v[216:219], v[76:79]
  v_mfma_f32_16x16x32_bf16 v[80:83], a[152:155], v[216:219], v[80:83]
  v_mfma_f32_16x16x32_bf16 v[72:75], v[216:219], v[216:219], v[72:75]
  s_cbranch_vccnz reca_retry217
reca_resume218:
  s_waitcnt vmcnt(1)
  v_max_u32 v29, v224, v226
  v_cmp_eq_u32 vcc, -1, v29
  v_mfma_f32_16x16x32_bf16 v[76:79], a[132:135], v[220:223], v[76:79]
  v_mfma_f32_16x16x32_bf16 v[80:83], a[156:159], v[220:223], v[80:83]
  v_mfma_f32_16x16x32_bf16 v[72:75], v[220:223], v[220:223], v[72:75]
  s_cbranch_vccnz reca_retry219
reca_resume220:
  s_waitcnt vmcnt(0)
  v_max_u32 v29, v228, v230
  v_cmp_eq_u32 vcc, -1, v29
  v_mfma_f32_16x16x32_bf16 v[76:79], a[136:139], v[224:227], v[76:79]
  v_mfma_f32_16x16x32_bf16 v[80:83], a[160:163], v[224:227], v[80:83]
  v_mfma_f32_16x16x32_bf16 v[72:75], v[224:227], v[224:227], v[72:75]
  s_cbranch_vccnz reca_retry221
reca_resume222:
  v_mfma_f32_16x16x32_bf16 v[76:79], a[140:143], v[228:231], v[76:79]
  v_mfma_f32_16x16x32_bf16 v[80:83], a[164:167], v[228:231], v[80:83]
  v_mfma_f32_16x16x32_bf16 v[72:75], v[228:231], v[228:231], v[72:75]
  s_barrier
  ds_read_b128 v[56:59], v1 offset:10240
  ds_read_b128 v[60:63], v1 offset:11264
  ds_read_b128 v[64:67], v1 offset:12288
  s_nop 1
  v_max3_f32 v28, v76, v77, v78
  v_max3_f32 v29, v80, v81, v82
  v_max3_f32 v28, v28, v79, v83
  v_max3_f32 v29, v29, v72, v73
  v_max3_f32 v28, v28, v74, v75
  v_max_f32 v28, v28, v29
  v_mov_b32 v29, v28
  s_nop 1
  v_permlane32_swap_b32 v28, v29
  v_max_f32 v28, v28, v29
  v_mov_b32 v29, v28
  s_nop 1
  v_permlane16_swap_b32 v28, v29
  v_max_f32 v28, v28, v29
  v_mul_f32 v28, s41, v28
  v_fma_f32 v76, v76, s41, -v28
  v_fma_f32 v77, v77, s41, -v28
  v_fma_f32 v78, v78, s41, -v28
  v_fma_f32 v79, v79, s41, -v28
  v_fma_f32 v80, v80, s41, -v28
  v_fma_f32 v81, v81, s41, -v28
  v_fma_f32 v82, v82, s41, -v28
  v_fma_f32 v83, v83, s41, -v28
  v_fma_f32 v72, v72, s41, -v28
  v_fma_f32 v73, v73, s41, -v28
  v_fma_f32 v74, v74, s41, -v28
  v_fma_f32 v75, v75, s41, -v28
  v_exp_f32 v76, v76
  v_exp_f32 v77, v77
  v_exp_f32 v78, v78
  v_exp_f32 v79, v79
  v_exp_f32 v80, v80
  v_exp_f32 v81, v81
  v_exp_f32 v82, v82
  v_exp_f32 v83, v83
  v_cvt_pk_bf16_f32 v84, v76, v77
  v_cvt_pk_bf16_f32 v85, v78, v79
  v_cvt_pk_bf16_f32 v86, v80, v81
  v_cvt_pk_bf16_f32 v87, v82, v83
  v_exp_f32 v72, v72
  v_exp_f32 v73, v73
  v_mfma_f32_16x16x32_bf16 v[100:103], v[36:39], v[84:87], 0
  v_exp_f32 v74, v74
  v_exp_f32 v75, v75
  v_mfma_f32_16x16x32_bf16 v[92:95], a[168:171], v[84:87], 0
  v_cvt_pk_bf16_f32 v88, v72, v73
  v_cvt_pk_bf16_f32 v89, v74, v75
  v_mfma_f32_16x16x32_bf16 v[96:99], a[172:175], v[84:87], 0
  s_waitcnt lgkmcnt(0)
  v_mfma_f32_16x16x16_bf16 v[100:103], v[36:37], v[88:89], v[100:103]
  v_add_f32 v56, v56, v64
  v_add_f32 v60, v60, v48
  v_add_f32 v57, v57, v65
  v_add_f32 v61, v61, v49
  v_add_f32 v58, v58, v66
  v_add_f32 v62, v62, v50
  v_add_f32 v59, v59, v67
  v_add_f32 v63, v63, v51
  v_cvt_pk_bf16_f32 v68, v56, v57
  v_cvt_pk_bf16_f32 v69, v58, v59
  v_cvt_pk_bf16_f32 v70, v60, v61
  v_cvt_pk_bf16_f32 v71, v62, v63
  v_mfma_f32_16x16x16_bf16 v[92:95], v[68:69], v[88:89], v[92:95]
  v_rcp_f32 v28, v100
  v_mfma_f32_16x16x16_bf16 v[96:99], v[70:71], v[88:89], v[96:99]
  v_mov_b32 v29, v28
  s_nop 4
  v_pk_mul_f32 v[92:93], v[92:93], v[28:29]
  v_pk_mul_f32 v[94:95], v[94:95], v[28:29]
  v_pk_mul_f32 v[96:97], v[96:97], v[28:29]
  v_pk_mul_f32 v[98:99], v[98:99], v[28:29]
  v_cvt_pk_bf16_f32 v104, v92, v93
  v_cvt_pk_bf16_f32 v105, v94, v95
  v_cvt_pk_bf16_f32 v106, v96, v97
  v_cvt_pk_bf16_f32 v107, v98, v99
  buffer_store_dwordx4 v[104:107], v11, s[4:7], s22 offen sc1
  s_barrier
  s_add_u32 s34, s17, 2
  s_and_b32 s34, s34, 3
  s_mul_i32 s26, s34, 10240
  s_add_u32 s26, s26, s38
  s_mul_i32 s27, s34, 6144
  s_add_u32 s27, s27, s39
  s_mul_i32 s28, s34, 12288
  s_add_u32 s28, s28, s40
  s_mul_i32 s29, s34, 393216
  s_add_u32 s29, s29, s56
  buffer_store_dwordx2 v[32:33], v8, s[4:7], s27 offen sc1
  buffer_store_dwordx4 v[32:35], v11, s[4:7], s28 offen sc1
  s_add_u32 s36, s17, 1
  s_cmp_ge_u32 s36, 63
  s_cbranch_scc1 reca_nopf223
  s_add_u32 s37, s36, 1
reca_pf224:
  buffer_load_dword v28, v233, s[4:7], 0 offen sc1
  s_waitcnt vmcnt(0)
  v_cmp_gt_i32 vcc, s37, v28
  s_cbranch_vccz reca_pfok225
  s_sleep 1
  s_sub_u32 s18, s18, 1
  s_cbranch_scc0 reca_pf224
  s_mov_b32 s18, 0
reca_pfok225:
  s_lshl_b32 s34, s15, 3
  s_and_b32 s35, s36, 7
  s_add_u32 s34, s34, s35
  s_mul_i32 s34, s34, 12288
  s_add_u32 s32, s34, 37748736
  s_lshl_b32 s35, s16, 11
  s_add_u32 s34, s34, s35
  s_add_u32 s33, s34, 40894464
  buffer_load_dwordx4 a[120:123], v1, s[4:7], s32 offen offset:0 sc1
  buffer_load_dwordx4 a[124:127], v1, s[4:7], s32 offen offset:1024 sc1
  buffer_load_dwordx4 a[128:131], v1, s[4:7], s32 offen offset:2048 sc1
  buffer_load_dwordx4 a[132:135], v1, s[4:7], s32 offen offset:3072 sc1
  buffer_load_dwordx4 a[136:139], v2, s[4:7], s32 offen offset:0 sc1
  buffer_load_dwordx4 a[140:143], v2, s[4:7], s32 offen offset:1024 sc1
  buffer_load_dwordx4 a[144:147], v2, s[4:7], s32 offen offset:2048 sc1
  buffer_load_dwordx4 a[148:151], v2, s[4:7], s32 offen offset:3072 sc1
  buffer_load_dwordx4 a[152:155], v3, s[4:7], s32 offen offset:0 sc1
  buffer_load_dwordx4 a[156:159], v3, s[4:7], s32 offen offset:1024 sc1
  buffer_load_dwordx4 a[160:163], v3, s[4:7], s32 offen offset:2048 sc1
  buffer_load_dwordx4 a[164:167], v3, s[4:7], s32 offen offset:3072 sc1
  buffer_load_dwordx4 a[168:171], v1, s[4:7], s33 offen offset:0 sc1
  buffer_load_dwordx4 a[172:175], v1, s[4:7], s33 offen offset:1024 sc1
reca_nopf223:
  buffer_store_dwordx2 v[52:53], v9, s[4:7], s30 offen sc1
  buffer_store_dwordx2 v[68:69], v10, s[4:7], s31 offen sc1
  buffer_store_dwordx2 v[70:71], v10, s[4:7], s31 offen offset:256 sc1
reca_b5207:
  s_barrier
  s_add_u32 s17, s17, 1
  s_branch reca_step193
reca_b3205:
  s_endpgm
reca_retry196:
  s_sub_u32 s18, s18, 1
  s_cbranch_scc1 reca_retry196_to
  buffer_load_dwordx4 v[128:131], v4, s[4:7], s20 offen sc1
  buffer_load_dwordx4 v[132:135], v4, s[4:7], s20 offen offset:1024 sc1
  buffer_load_dwordx4 v[136:139], v5, s[4:7], s20 offen sc1
  s_waitcnt vmcnt(2)
  v_max_u32 v29, v128, v130
  v_cmp_eq_u32 vcc, -1, v29
  s_cbranch_vccnz reca_retry196
  s_branch reca_resume197
reca_retry196_to:
  s_mov_b32 s18, 0
  s_waitcnt vmcnt(0)
  s_branch reca_resume197
reca_retry198:
  s_sub_u32 s18, s18, 1
  s_cbranch_scc1 reca_retry198_to
  buffer_load_dwordx4 v[132:135], v4, s[4:7], s20 offen offset:1024 sc1
  buffer_load_dwordx4 v[136:139], v5, s[4:7], s20 offen sc1
  s_waitcnt vmcnt(1)
  v_max_u32 v29, v132, v134
  v_cmp_eq_u32 vcc, -1, v29
  s_cbranch_vccnz reca_retry198
  s_branch reca_resume199
reca_retry198_to:
  s_mov_b32 s18, 0
  s_waitcnt vmcnt(0)
  s_branch reca_resume199
reca_retry200:
  s_sub_u32 s18, s18, 1
  s_cbranch_scc1 reca_retry200_to
  buffer_load_dwordx4 v[136:139], v5, s[4:7], s20 offen sc1
  s_waitcnt vmcnt(0)
  v_max_u32 v29, v136, v138
  v_cmp_eq_u32 vcc, -1, v29
  s_cbranch_vccnz reca_retry200
  s_branch reca_resume201
reca_retry200_to:
  s_mov_b32 s18, 0
  s_waitcnt vmcnt(0)
  s_branch reca_resume201
reca_retry211:
  s_sub_u32 s18, s18, 1
  s_cbranch_scc1 reca_retry211_to
  buffer_load_dwordx4 v[208:211], v1, s[4:7], s21 offen offset:0 sc1
  buffer_load_dwordx4 v[212:215], v1, s[4:7], s21 offen offset:1024 sc1
  buffer_load_dwordx4 v[216:219], v1, s[4:7], s21 offen offset:2048 sc1
  buffer_load_dwordx4 v[220:223], v1, s[4:7], s21 offen offset:3072 sc1
  buffer_load_dwordx4 v[224:227], v2, s[4:7], s21 offen offset:0 sc1
  buffer_load_dwordx4 v[228:231], v2, s[4:7], s21 offen offset:1024 sc1
  s_waitcnt vmcnt(5)
  v_max_u32 v29, v208, v210
  v_cmp_eq_u32 vcc, -1, v29
  s_cbranch_vccnz reca_retry211
  s_branch reca_resume212
reca_retry211_to:
  s_mov_b32 s18, 0
  s_waitcnt vmcnt(0)
  s_branch reca_resume212
reca_retry213:
  s_sub_u32 s18, s18, 1
  s_cbranch_scc1 reca_retry213_to
  buffer_load_dwordx4 v[212:215], v1, s[4:7], s21 offen offset:1024 sc1
  buffer_load_dwordx4 v[216:219], v1, s[4:7], s21 offen offset:2048 sc1
  buffer_load_dwordx4 v[220:223], v1, s[4:7], s21 offen offset:3072 sc1
  buffer_load_dwordx4 v[224:227], v2, s[4:7], s21 offen offset:0 sc1
  buffer_load_dwordx4 v[228:231], v2, s[4:7], s21 offen offset:1024 sc1
  s_waitcnt vmcnt(4)
  v_max_u32 v29, v212, v214
  v_cmp_eq_u32 vcc, -1, v29
  s_cbranch_vccnz reca_retry213
  s_branch reca_resume214
reca_retry213_to:
  s_mov_b32 s18, 0
  s_waitcnt vmcnt(0)
  s_branch reca_resume214
reca_retry215:
  s_sub_u32 s18, s18, 1
  s_cbranch_scc1 reca_retry215_to
  buffer_load_dwordx4 v[216:219], v1, s[4:7], s21 offen offset:2048 sc1
  buffer_load_dwordx4 v[220:223], v1, s[4:7], s21 offen offset:3072 sc1
  buffer_load_dwordx4 v[224:227], v2, s[4:7], s21 offen offset:0 sc1
  buffer_load_dwordx4 v[228:231], v2, s[4:7], s21 offen offset:1024 sc1
  s_waitcnt vmcnt(3)
  v_max_u32 v29, v216, v218
  v_cmp_eq_u32 vcc, -1, v29
  s_cbranch_vccnz reca_retry215
  s_branch reca_resume216
reca_retry215_to:
  s_mov_b32 s18, 0
  s_waitcnt vmcnt(0)
  s_branch reca_resume216
reca_retry217:
  s_sub_u32 s18, s18, 1
  s_cbranch_scc1 reca_retry217_to
  buffer_load_dwordx4 v[220:223], v1, s[4:7], s21 offen offset:3072 sc1
  buffer_load_dwordx4 v[224:227], v2, s[4:7], s21 offen offset:0 sc1
  buffer_load_dwordx4 v[228:231], v2, s[4:7], s21 offen offset:1024 sc1
  s_waitcnt vmcnt(2)
  v_max_u32 v29, v220, v222
  v_cmp_eq_u32 vcc, -1, v29
  s_cbranch_vccnz reca_retry217
  s_branch reca_resume218
reca_retry217_to:
  s_mov_b32 s18, 0
  s_waitcnt vmcnt(0)
  s_branch reca_resume218
reca_retry219:
  s_sub_u32 s18, s18, 1
  s_cbranch_scc1 reca_retry219_to
  buffer_load_dwordx4 v[224:227], v2, s[4:7], s21 offen offset:0 sc1
  buffer_load_dwordx4 v[228:231], v2, s[4:7], s21 offen offset:1024 sc1
  s_waitcnt vmcnt(1)
  v_max_u32 v29, v224, v226
  v_cmp_eq_u32 vcc, -1, v29
  s_cbranch_vccnz reca_retry219
  s_branch reca_resume220
reca_retry219_to:
  s_mov_b32 s18, 0
  s_waitcnt vmcnt(0)
  s_branch reca_resume220
reca_retry221:
  s_sub_u32 s18, s18, 1
  s_cbranch_scc1 reca_retry221_to
  buffer_load_dwordx4 v[228:231], v2, s[4:7], s21 offen offset:1024 sc1
  s_waitcnt vmcnt(0)
  v_max_u32 v29, v228, v230
  v_cmp_eq_u32 vcc, -1, v29
  s_cbranch_vccnz reca_retry221
  s_branch reca_resume222
reca_retry221_to:
  s_mov_b32 s18, 0
  s_waitcnt vmcnt(0)
  s_branch reca_resume222
reca_proj2:
  s_sub_u32 s34, s14, 24
  s_lshr_b32 s35, s34, 1
  s_and_b32 s16, s34, 1
  s_lshl_b32 s15, s13, 2
  s_add_u32 s15, s15, s35
  s_lshl_b32 s24, s13, 3
  s_add_u32 s24, s24, s34
  s_lshl_b32 s24, s24, 7
  s_add_u32 s24, s24, 1540096
  s_lshl_b32 s25, s13, 7
  s_add_u32 s25, s25, 1507328
  v_and_b32 v28, 63, v0
  v_lshlrev_b32 v1, 4, v28
  v_mov_b32 v29, 0x80000000
  v_cmp_eq_u32 vcc, 0, v28
  v_mov_b32 v4, 0
  s_nop 0
  v_cndmask_b32 v4, v29, v4, vcc
  v_cmp_gt_u32 vcc, 32, v28
  s_nop 1
  v_cndmask_b32 v5, v29, v1, vcc
  s_cmp_eq_u32 s12, 0
  s_cbranch_scc1 reca_pw0_226
  s_cmp_eq_u32 s12, 1
  s_cbranch_scc1 reca_pw1_227
  s_cmp_eq_u32 s12, 2
  s_cbranch_scc1 reca_pw2_228
  s_branch reca_pw3_229
reca_pw0_226:
  s_mov_b32 s17, 0
  s_mov_b32 s26, 0
  s_mul_i32 s20, s17, 40960
  s_add_u32 s20, s20, 84934656
  s_add_u32 m0, s26, 0
  s_nop 0
  buffer_load_dwordx4 v1, s[4:7], s20 offen offset:0 lds
  buffer_load_dwordx4 v1, s[4:7], s20 offen offset:1024 lds
  buffer_load_dwordx4 v1, s[4:7], s20 offen offset:2048 lds
  buffer_load_dwordx4 v1, s[4:7], s20 offen offset:3072 lds
  s_add_u32 s20, s20, 4096
  s_add_u32 m0, s26, 4096
  s_nop 0
  buffer_load_dwordx4 v1, s[4:7], s20 offen offset:0 lds
  buffer_load_dwordx4 v1, s[4:7], s20 offen offset:1024 lds
  buffer_load_dwordx4 v1, s[4:7], s20 offen offset:2048 lds
  buffer_load_dwordx4 v1, s[4:7], s20 offen offset:3072 lds
  s_add_u32 s20, s20, 4096
  s_add_u32 m0, s26, 8192
  s_nop 0
  buffer_load_dwordx4 v1, s[4:7], s20 offen offset:0 lds
  buffer_load_dwordx4 v1, s[4:7], s20 offen offset:1024 lds
  s_mul_i32 s34, s15, 12
  s_mul_i32 s35, s16, 6
  s_add_u32 s34, s34, s35
  s_add_u32 s34, s34, 0
  s_mul_i32 s34, s34, 20480
  s_add_u32 s34, s34, 14155776
  buffer_load_dwordx4 a[0:3], v1, s[4:7], s34 offen offset:0
  buffer_load_dwordx4 a[4:7], v1, s[4:7], s34 offen offset:1024
  buffer_load_dwordx4 a[8:11], v1, s[4:7], s34 offen offset:2048
  buffer_load_dwordx4 a[12:15], v1, s[4:7], s34 offen offset:3072
  s_add_u32 s34, s34, 4096
  buffer_load_dwordx4 a[16:19], v1, s[4:7], s34 offen offset:0
  buffer_load_dwordx4 a[20:23], v1, s[4:7], s34 offen offset:1024
  buffer_load_dwordx4 a[24:27], v1, s[4:7], s34 offen offset:2048
  buffer_load_dwordx4 a[28:31], v1, s[4:7], s34 offen offset:3072
  s_add_u32 s34, s34, 4096
  buffer_load_dwordx4 a[32:35], v1, s[4:7], s34 offen offset:0
  buffer_load_dwordx4 a[36:39], v1, s[4:7], s34 offen offset:1024
  buffer_load_dwordx4 a[40:43], v1, s[4:7], s34 offen offset:2048
  buffer_load_dwordx4 a[44:47], v1, s[4:7], s34 offen offset:3072
  s_add_u32 s34, s34, 4096
  buffer_load_dwordx4 a[48:51], v1, s[4:7], s34 offen offset:0
  buffer_load_dwordx4 a[52:55], v1, s[4:7], s34 offen offset:1024
  buffer_load_dwordx4 a[56:59], v1, s[4:7], s34 offen offset:2048
  buffer_load_dwordx4 a[60:63], v1, s[4:7], s34 offen offset:3072
  s_add_u32 s34, s34, 4096
  buffer_load_dwordx4 a[64:67], v1, s[4:7], s34 offen offset:0
  buffer_load_dwordx4 a[68:71], v1, s[4:7], s34 offen offset:1024
  buffer_load_dwordx4 a[72:75], v1, s[4:7], s34 offen offset:2048
  buffer_load_dwordx4 a[76:79], v1, s[4:7], s34 offen offset:3072
  s_mul_i32 s34, s15, 12
  s_mul_i32 s35, s16, 6
  s_add_u32 s34, s34, s35
  s_add_u32 s34, s34, 1
  s_mul_i32 s34, s34, 20480
  s_add_u32 s34, s34, 14155776
  buffer_load_dwordx4 a[80:83], v1, s[4:7], s34 offen offset:0
  buffer_load_dwordx4 a[84:87], v1, s[4:7], s34 offen offset:1024
  buffer_load_dwordx4 a[88:91], v1, s[4:7], s34 offen offset:2048
  buffer_load_dwordx4 a[92:95], v1, s[4:7], s34 offen offset:3072
  s_add_u32 s34, s34, 4096
  buffer_load_dwordx4 a[96:99], v1, s[4:7], s34 offen offset:0
  buffer_load_dwordx4 a[100:103], v1, s[4:7], s34 offen offset:1024
  buffer_load_dwordx4 a[104:107], v1, s[4:7], s34 offen offset:2048
  buffer_load_dwordx4 a[108:111], v1, s[4:7], s34 offen offset:3072
  s_add_u32 s34, s34, 4096
  buffer_load_dwordx4 a[112:115], v1, s[4:7], s34 offen offset:0
  buffer_load_dwordx4 a[116:119], v1, s[4:7], s34 offen offset:1024
  buffer_load_dwordx4 a[120:123], v1, s[4:7], s34 offen offset:2048
  buffer_load_dwordx4 a[124:127], v1, s[4:7], s34 offen offset:3072
  s_add_u32 s34, s34, 4096
  buffer_load_dwordx4 a[128:131], v1, s[4:7], s34 offen offset:0
  buffer_load_dwordx4 a[132:135], v1, s[4:7], s34 offen offset:1024
  buffer_load_dwordx4 a[136:139], v1, s[4:7], s34 offen offset:2048
  buffer_load_dwordx4 a[140:143], v1, s[4:7], s34 offen offset:3072
  s_add_u32 s34, s34, 4096
  buffer_load_dwordx4 a[144:147], v1, s[4:7], s34 offen offset:0
  buffer_load_dwordx4 a[148:151], v1, s[4:7], s34 offen offset:1024
  buffer_load_dwordx4 a[152:155], v1, s[4:7], s34 offen offset:2048
  buffer_load_dwordx4 a[156:159], v1, s[4:7], s34 offen offset:3072
  s_waitcnt vmcnt(20)
  s_mul_i32 s34, s15, 12
  s_mul_i32 s35, s16, 6
  s_add_u32 s34, s34, s35
  s_add_u32 s34, s34, 2
  s_mul_i32 s34, s34, 20480
  s_add_u32 s34, s34, 14155776
  buffer_load_dwordx4 a[160:163], v1, s[4:7], s34 offen offset:0
  buffer_load_dwordx4 a[164:167], v1, s[4:7], s34 offen offset:1024
  buffer_load_dwordx4 a[168:171], v1, s[4:7], s34 offen offset:2048
  buffer_load_dwordx4 a[172:175], v1, s[4:7], s34 offen offset:3072
  s_add_u32 s34, s34, 4096
  buffer_load_dwordx4 a[176:179], v1, s[4:7], s34 offen offset:0
  buffer_load_dwordx4 a[180:183], v1, s[4:7], s34 offen offset:1024
  buffer_load_dwordx4 a[184:187], v1, s[4:7], s34 offen offset:2048
  buffer_load_dwordx4 a[188:191], v1, s[4:7], s34 offen offset:3072
  s_add_u32 s34, s34, 4096
  buffer_load_dwordx4 a[192:195], v1, s[4:7], s34 offen offset:0
  buffer_load_dwordx4 a[196:199], v1, s[4:7], s34 offen offset:1024
  buffer_load_dwordx4 a[200:203], v1, s[4:7], s34 offen offset:2048
  buffer_load_dwordx4 a[204:207], v1, s[4:7], s34 offen offset:3072
  s_add_u32 s34, s34, 4096
  buffer_load_dwordx4 a[208:211], v1, s[4:7], s34 offen offset:0
  buffer_load_dwordx4 a[212:215], v1, s[4:7], s34 offen offset:1024
  buffer_load_dwordx4 a[216:219], v1, s[4:7], s34 offen offset:2048
  buffer_load_dwordx4 a[220:223], v1, s[4:7], s34 offen offset:3072
  s_add_u32 s34, s34, 4096
  buffer_load_dwordx4 a[224:227], v1, s[4:7], s34 offen offset:0
  buffer_load_dwordx4 a[228:231], v1, s[4:7], s34 offen offset:1024
  buffer_load_dwordx4 a[232:235], v1, s[4:7], s34 offen offset:2048
  buffer_load_dwordx4 a[236:239], v1, s[4:7], s34 offen offset:3072
  s_waitcnt vmcnt(20)
  s_mul_i32 s34, s15, 12
  s_mul_i32 s35, s16, 6
  s_add_u32 s34, s34, s35
  s_add_u32 s34, s34, 3
  s_mul_i32 s34, s34, 20480
  s_add_u32 s34, s34, 14155776
  buffer_load_dwordx4 v[96:99], v1, s[4:7], s34 offen offset:0
  buffer_load_dwordx4 v[100:103], v1, s[4:7], s34 offen offset:1024
  buffer_load_dwordx4 v[104:107], v1, s[4:7], s34 offen offset:2048
  buffer_load_dwordx4 v[108:111], v1, s[4:7], s34 offen offset:3072
  s_add_u32 s34, s34, 4096
  buffer_load_dwordx4 v[112:115], v1, s[4:7], s34 offen offset:0
  buffer_load_dwordx4 v[116:119], v1, s[4:7], s34 offen offset:1024
  buffer_load_dwordx4 v[120:123], v1, s[4:7], s34 offen offset:2048
  buffer_load_dwordx4 v[124:127], v1, s[4:7], s34 offen offset:3072
  s_add_u32 s34, s34, 4096
  buffer_load_dwordx4 v[128:131], v1, s[4:7], s34 offen offset:0
  buffer_load_dwordx4 v[132:135], v1, s[4:7], s34 offen offset:1024
  buffer_load_dwordx4 v[136:139], v1, s[4:7], s34 offen offset:2048
  buffer_load_dwordx4 v[140:143], v1, s[4:7], s34 offen offset:3072
  s_add_u32 s34, s34, 4096
  buffer_load_dwordx4 v[144:147], v1, s[4:7], s34 offen offset:0
  buffer_load_dwordx4 v[148:151], v1, s[4:7], s34 offen offset:1024
  buffer_load_dwordx4 v[152:155], v1, s[4:7], s34 offen offset:2048
  buffer_load_dwordx4 v[156:159], v1, s[4:7], s34 offen offset:3072
  s_add_u32 s34, s34, 4096
  buffer_load_dwordx4 v[160:163], v1, s[4:7], s34 offen offset:0
  buffer_load_dwordx4 v[164:167], v1, s[4:7], s34 offen offset:1024
  buffer_load_dwordx4 v[168:171], v1, s[4:7], s34 offen offset:2048
  buffer_load_dwordx4 v[172:175], v1, s[4:7], s34 offen offset:3072
  s_waitcnt vmcnt(20)
  s_mul_i32 s34, s15, 12
  s_mul_i32 s35, s16, 6
  s_add_u32 s34, s34, s35
  s_add_u32 s34, s34, 0
  s_mul_i32 s34, s34, 20480
  s_add_u32 s34, s34, 22020096
  buffer_load_dwordx4 v[176:179], v1, s[4:7], s34 offen offset:0
  buffer_load_dwordx4 v[180:183], v1, s[4:7], s34 offen offset:1024
  buffer_load_dwordx4 v[184:187], v1, s[4:7], s34 offen offset:2048
  buffer_load_dwordx4 v[188:191], v1, s[4:7], s34 offen offset:3072
  s_add_u32 s34, s34, 4096
  buffer_load_dwordx4 v[192:195], v1, s[4:7], s34 offen offset:0
  buffer_load_dwordx4 v[196:199], v1, s[4:7], s34 offen offset:1024
  buffer_load_dwordx4 v[200:203], v1, s[4:7], s34 offen offset:2048
  buffer_load_dwordx4 v[204:207], v1, s[4:7], s34 offen offset:3072
  s_add_u32 s34, s34, 4096
  buffer_load_dwordx4 v[208:211], v1, s[4:7], s34 offen offset:0
  buffer_load_dwordx4 v[212:215], v1, s[4:7], s34 offen offset:1024
  buffer_load_dwordx4 v[216:219], v1, s[4:7], s34 offen offset:2048
  buffer_load_dwordx4 v[220:223], v1, s[4:7], s34 offen offset:3072
  s_add_u32 s34, s34, 4096
  buffer_load_dwordx4 v[224:227], v1, s[4:7], s34 offen offset:0
  buffer_load_dwordx4 v[228:231], v1, s[4:7], s34 offen offset:1024
  buffer_load_dwordx4 v[232:235], v1, s[4:7], s34 offen offset:2048
  buffer_load_dwordx4 v[236:239], v1, s[4:7], s34 offen offset:3072
  s_add_u32 s34, s34, 4096
  buffer_load_dwordx4 v[240:243], v1, s[4:7], s34 offen offset:0
  buffer_load_dwordx4 v[244:247], v1, s[4:7], s34 offen offset:1024
  buffer_load_dwordx4 v[248:251], v1, s[4:7], s34 offen offset:2048
  buffer_load_dwordx4 v[252:255], v1, s[4:7], s34 offen offset:3072
  s_waitcnt vmcnt(20)
  v_and_b32 v30, 7, v0
  v_lshlrev_b32 v30, 3, v30
reca_cens230:
  buffer_load_dwordx2 v[28:29], v30, s[8:11], 0 offen sc1
  s_waitcnt vmcnt(0)
  v_sad_u8 v31, v28, 0, 0
  v_sad_u8 v31, v29, 0, v31
  v_cmp_gt_u32 vcc, 32, v31
  s_cbranch_vccz reca_censok231
  s_sleep 8
  s_sub_u32 s18, s18, 1
  s_cbranch_scc0 reca_cens230
  s_mov_b32 s18, 0
reca_censok231:
  v_and_b32 v28, 0x20202020, v28
  v_and_b32 v29, 0x20202020, v29
  v_cmp_ne_u32 s[34:35], 0, v28
  v_cmp_ne_u32 s[36:37], 0, v29
  s_nop 3
  s_and_b32 s34, s34, 0xff
  s_and_b32 s36, s36, 0xff
  s_or_b32 s35, s34, s36
  s_lshr_b32 s37, s35, s13
  s_and_b32 s37, s37, 1
  s_xor_b32 s43, s37, 1
  s_cmp_eq_u32 s57, 0
  s_cselect_b32 s58, s36, s34
  v_mov_b32 v31, 0x80000000
  s_cmp_lg_u32 s43, 0
  s_cbranch_scc1 reca_pslow232
reca_ptop233:
  s_cmp_lt_u32 s17, 3
  s_cbranch_scc1 reca_pgo234
  s_sub_u32 s36, s17, 3
reca_ppoll235:
  buffer_load_dword v28, v4, s[4:7], s25 offen sc1
  s_waitcnt vmcnt(0)
  v_readfirstlane_b32 s34, v28
  s_nop 3
  s_cmp_ge_i32 s34, s36
  s_cbranch_scc1 reca_pgo234
  s_sleep 8
  s_sub_u32 s18, s18, 1
  s_cbranch_scc0 reca_ppoll235
  s_mov_b32 s18, 0
reca_pgo234:
  s_waitcnt vmcnt(0)
  s_barrier
  v_add_u32 v7, s26, v1
  s_xor_b32 s26, s26, 40960
  s_add_u32 s37, s17, 1
  s_cmp_ge_u32 s37, 64
  s_cbranch_scc1 reca_pnodma236
  s_mul_i32 s20, s37, 40960
  s_add_u32 s20, s20, 84934656
  s_add_u32 m0, s26, 0
  s_nop 0
  buffer_load_dwordx4 v1, s[4:7], s20 offen offset:0 lds
  buffer_load_dwordx4 v1, s[4:7], s20 offen offset:1024 lds
  buffer_load_dwordx4 v1, s[4:7], s20 offen offset:2048 lds
  buffer_load_dwordx4 v1, s[4:7], s20 offen offset:3072 lds
  s_add_u32 s20, s20, 4096
  s_add_u32 m0, s26, 4096
  s_nop 0
  buffer_load_dwordx4 v1, s[4:7], s20 offen offset:0 lds
  buffer_load_dwordx4 v1, s[4:7], s20 offen offset:1024 lds
  buffer_load_dwordx4 v1, s[4:7], s20 offen offset:2048 lds
  buffer_load_dwordx4 v1, s[4:7], s20 offen offset:3072 lds
  s_add_u32 s20, s20, 4096
  s_add_u32 m0, s26, 8192
  s_nop 0
  buffer_load_dwordx4 v1, s[4:7], s20 offen offset:0 lds
  buffer_load_dwordx4 v1, s[4:7], s20 offen offset:1024 lds
reca_pnodma236:
  s_lshl_b32 s34, s15, 3
  s_and_b32 s35, s17, 7
  s_add_u32 s34, s34, s35
  s_mul_i32 s34, s34, 12288
  s_mul_i32 s35, s16, 3072
  s_add_u32 s35, s35, s34
  s_add_u32 s21, s35, 37748736
  s_add_u32 s22, s35, 44040192
  s_mul_i32 s35, s16, 6144
  s_add_u32 s35, s35, s34
  s_add_u32 s23, s35, 40894464
  ds_read_b128 v[72:75], v7 offset:0
  ds_read_b128 v[76:79], v7 offset:20480
  ds_read_b128 v[80:83], v7 offset:1024
  ds_read_b128 v[84:87], v7 offset:21504
  ds_read_b128 v[88:91], v7 offset:2048
  ds_read_b128 v[92:95], v7 offset:22528
  s_waitcnt lgkmcnt(4)
  v_mfma_f32_16x16x32_bf16 v[32:35], a[0:3], v[72:75], 0
  v_mfma_f32_16x16x32_bf16 v[36:39], a[0:3], v[76:79], 0
  v_mfma_f32_16x16x32_bf16 v[40:43], a[80:83], v[72:75], 0
  v_mfma_f32_16x16x32_bf16 v[44:47], a[80:83], v[76:79], 0
  v_mfma_f32_16x16x32_bf16 v[48:51], a[160:163], v[72:75], 0
  v_mfma_f32_16x16x32_bf16 v[52:55], a[160:163], v[76:79], 0
  v_mfma_f32_16x16x32_bf16 v[56:59], v[96:99], v[72:75], 0
  v_mfma_f32_16x16x32_bf16 v[60:63], v[96:99], v[76:79], 0
  v_mfma_f32_16x16x32_bf16 v[64:67], v[72:75], v[176:179], 0
  v_mfma_f32_16x16x32_bf16 v[68:71], v[76:79], v[176:179], 0
  ds_read_b128 v[72:75], v7 offset:3072
  ds_read_b128 v[76:79], v7 offset:23552
  s_waitcnt lgkmcnt(4)
  v_mfma_f32_16x16x32_bf16 v[32:35], a[4:7], v[80:83], v[32:35]
  v_mfma_f32_16x16x32_bf16 v[36:39], a[4:7], v[84:87], v[36:39]
  v_mfma_f32_16x16x32_bf16 v[40:43], a[84:87], v[80:83], v[40:43]
  v_mfma_f32_16x16x32_bf16 v[44:47], a[84:87], v[84:87], v[44:47]
  v_mfma_f32_16x16x32_bf16 v[48:51], a[164:167], v[80:83], v[48:51]
  v_mfma_f32_16x16x32_bf16 v[52:55], a[164:167], v[84:87], v[52:55]
  v_mfma_f32_16x16x32_bf16 v[56:59], v[100:103], v[80:83], v[56:59]
  v_mfma_f32_16x16x32_bf16 v[60:63], v[100:103], v[84:87], v[60:63]
  v_mfma_f32_16x16x32_bf16 v[64:67], v[80:83], v[180:183], v[64:67]
  v_mfma_f32_16x16x32_bf16 v[68:71], v[84:87], v[180:183], v[68:71]
  ds_read_b128 v[80:83], v7 offset:4096
  ds_read_b128 v[84:87], v7 offset:24576
  s_waitcnt lgkmcnt(4)
  v_mfma_f32_16x16x32_bf16 v[32:35], a[8:11], v[88:91], v[32:35]
  v_mfma_f32_16x16x32_bf16 v[36:39], a[8:11], v[92:95], v[36:39]
  v_mfma_f32_16x16x32_bf16 v[40:43], a[88:91], v[88:91], v[40:43]
  v_mfma_f32_16x16x32_bf16 v[44:47], a[88:91], v[92:95], v[44:47]
  v_mfma_f32_16x16x32_bf16 v[48:51], a[168:171], v[88:91], v[48:51]
  v_mfma_f32_16x16x32_bf16 v[52:55], a[168:171], v[92:95], v[52:55]
  v_mfma_f32_16x16x32_bf16 v[56:59], v[104:107], v[88:91], v[56:59]
  v_mfma_f32_16x16x32_bf16 v[60:63], v[104:107], v[92:95], v[60:63]
  v_mfma_f32_16x16x32_bf16 v[64:67], v[88:91], v[184:187], v[64:67]
  v_mfma_f32_16x16x32_bf16 v[68:71], v[92:95], v[184:187], v[68:71]
  ds_read_b128 v[88:91], v7 offset:5120
  ds_read_b128 v[92:95], v7 offset:25600
  s_waitcnt lgkmcnt(4)
  v_mfma_f32_16x16x32_bf16 v[32:35], a[12:15], v[72:75], v[32:35]
  v_mfma_f32_16x16x32_bf16 v[36:39], a[12:15], v[76:79], v[36:39]
  v_mfma_f32_16x16x32_bf16 v[40:43], a[92:95], v[72:75], v[40:43]
  v_mfma_f32_16x16x32_bf16 v[44:47], a[92:95], v[76:79], v[44:47]
  v_mfma_f32_16x16x32_bf16 v[48:51], a[172:175], v[72:75], v[48:51]
  v_mfma_f32_16x16x32_bf16 v[52:55], a[172:175], v[76:79], v[52:55]
  v_mfma_f32_16x16x32_bf16 v[56:59], v[108:111], v[72:75], v[56:59]
  v_mfma_f32_16x16x32_bf16 v[60:63], v[108:111], v[76:79], v[60:63]
  v_mfma_f32_16x16x32_bf16 v[64:67], v[72:75], v[188:191], v[64:67]
  v_mfma_f32_16x16x32_bf16 v[68:71], v[76:79], v[188:191], v[68:71]
  ds_read_b128 v[72:75], v7 offset:6144
  ds_read_b128 v[76:79], v7 offset:26624
  s_waitcnt lgkmcnt(4)
  v_mfma_f32_16x16x32_bf16 v[32:35], a[16:19], v[80:83], v[32:35]
  v_mfma_f32_16x16x32_bf16 v[36:39], a[16:19], v[84:87], v[36:39]
  v_mfma_f32_16x16x32_bf16 v[40:43], a[96:99], v[80:83], v[40:43]
  v_mfma_f32_16x16x32_bf16 v[44:47], a[96:99], v[84:87], v[44:47]
  v_mfma_f32_16x16x32_bf16 v[48:51], a[176:179], v[80:83], v[48:51]
  v_mfma_f32_16x16x32_bf16 v[52:55], a[176:179], v[84:87], v[52:55]
  v_mfma_f32_16x16x32_bf16 v[56:59], v[112:115], v[80:83], v[56:59]
  v_mfma_f32_16x16x32_bf16 v[60:63], v[112:115], v[84:87], v[60:63]
  v_mfma_f32_16x16x32_bf16 v[64:67], v[80:83], v[192:195], v[64:67]
  v_mfma_f32_16x16x32_bf16 v[68:71], v[84:87], v[192:195], v[68:71]
  ds_read_b128 v[80:83], v7 offset:7168
  ds_read_b128 v[84:87], v7 offset:27648
  s_waitcnt lgkmcnt(4)
  v_mfma_f32_16x16x32_bf16 v[32:35], a[20:23], v[88:91], v[32:35]
  v_mfma_f32_16x16x32_bf16 v[36:39], a[20:23], v[92:95], v[36:39]
  v_mfma_f32_16x16x32_bf16 v[40:43], a[100:103], v[88:91], v[40:43]
  v_mfma_f32_16x16x32_bf16 v[44:47], a[100:103], v[92:95], v[44:47]
  v_mfma_f32_16x16x32_bf16 v[48:51], a[180:183], v[88:91], v[48:51]
  v_mfma_f32_16x16x32_bf16 v[52:55], a[180:183], v[92:95], v[52:55]
  v_mfma_f32_16x16x32_bf16 v[56:59], v[116:119], v[88:91], v[56:59]
  v_mfma_f32_16x16x32_bf16 v[60:63], v[116:119], v[92:95], v[60:63]
  v_mfma_f32_16x16x32_bf16 v[64:67], v[88:91], v[196:199], v[64:67]
  v_mfma_f32_16x16x32_bf16 v[68:71], v[92:95], v[196:199], v[68:71]
  ds_read_b128 v[88:91], v7 offset:8192
  ds_read_b128 v[92:95], v7 offset:28672
  s_waitcnt lgkmcnt(4)
  v_mfma_f32_16x16x32_bf16 v[32:35], a[24:27], v[72:75], v[32:35]
  v_mfma_f32_16x16x32_bf16 v[36:39], a[24:27], v[76:79], v[36:39]
  v_mfma_f32_16x16x32_bf16 v[40:43], a[104:107], v[72:75], v[40:43]
  v_mfma_f32_16x16x32_bf16 v[44:47], a[104:107], v[76:79], v[44:47]
  v_mfma_f32_16x16x32_bf16 v[48:51], a[184:187], v[72:75], v[48:51]
  v_mfma_f32_16x16x32_bf16 v[52:55], a[184:187], v[76:79], v[52:55]
  v_mfma_f32_16x16x32_bf16 v[56:59], v[120:123], v[72:75], v[56:59]
  v_mfma_f32_16x16x32_bf16 v[60:63], v[120:123], v[76:79], v[60:63]
  v_mfma_f32_16x16x32_bf16 v[64:67], v[72:75], v[200:203], v[64:67]
  v_mfma_f32_16x16x32_bf16 v[68:71], v[76:79], v[200:203], v[68:71]
  ds_read_b128 v[72:75], v7 offset:9216
  ds_read_b128 v[76:79], v7 offset:29696
  s_waitcnt lgkmcnt(4)
  v_mfma_f32_16x16x32_bf16 v[32:35], a[28:31], v[80:83], v[32:35]
  v_mfma_f32_16x16x32_bf16 v[36:39], a[28:31], v[84:87], v[36:39]
  v_mfma_f32_16x16x32_bf16 v[40:43], a[108:111], v[80:83], v[40:43]
  v_mfma_f32_16x16x32_bf16 v[44:47], a[108:111], v[84:87], v[44:47]
  v_mfma_f32_16x16x32_bf16 v[48:51], a[188:191], v[80:83], v[48:51]
  v_mfma_f32_16x16x32_bf16 v[52:55], a[188:191], v[84:87], v[52:55]
  v_mfma_f32_16x16x32_bf16 v[56:59], v[124:127], v[80:83], v[56:59]
  v_mfma_f32_16x16x32_bf16 v[60:63], v[124:127], v[84:87], v[60:63]
  v_mfma_f32_16x16x32_bf16 v[64:67], v[80:83], v[204:207], v[64:67]
  v_mfma_f32_16x16x32_bf16 v[68:71], v[84:87], v[204:207], v[68:71]
  ds_read_b128 v[80:83], v7 offset:10240
  ds_read_b128 v[84:87], v7 offset:30720
  s_waitcnt lgkmcnt(4)
  v_mfma_f32_16x16x32_bf16 v[32:35], a[32:35], v[88:91], v[32:35]
  v_mfma_f32_16x16x32_bf16 v[36:39], a[32:35], v[92:95], v[36:39]
  v_mfma_f32_16x16x32_bf16 v[40:43], a[112:115], v[88:91], v[40:43]
  v_mfma_f32_16x16x32_bf16 v[44:47], a[112:115], v[92:95], v[44:47]
  v_mfma_f32_16x16x32_bf16 v[48:51], a[192:195], v[88:91], v[48:51]
  v_mfma_f32_16x16x32_bf16 v[52:55], a[192:195], v[92:95], v[52:55]
  v_mfma_f32_16x16x32_bf16 v[56:59], v[128:131], v[88:91], v[56:59]
  v_mfma_f32_16x16x32_bf16 v[60:63], v[128:131], v[92:95], v[60:63]
  v_mfma_f32_16x16x32_bf16 v[64:67], v[88:91], v[208:211], v[64:67]
  v_mfma_f32_16x16x32_bf16 v[68:71], v[92:95], v[208:211], v[68:71]
  ds_read_b128 v[88:91], v7 offset:11264
  ds_read_b128 v[92:95], v7 offset:31744
  s_waitcnt lgkmcnt(4)
  v_mfma_f32_16x16x32_bf16 v[32:35], a[36:39], v[72:75], v[32:35]
  v_mfma_f32_16x16x32_bf16 v[36:39], a[36:39], v[76:79], v[36:39]
  v_mfma_f32_16x16x32_bf16 v[40:43], a[116:119], v[72:75], v[40:43]
  v_mfma_f32_16x16x32_bf16 v[44:47], a[116:119], v[76:79], v[44:47]
  v_mfma_f32_16x16x32_bf16 v[48:51], a[196:199], v[72:75], v[48:51]
  v_mfma_f32_16x16x32_bf16 v[52:55], a[196:199], v[76:79], v[52:55]
  v_mfma_f32_16x16x32_bf16 v[56:59], v[132:135], v[72:75], v[56:59]
  v_mfma_f32_16x16x32_bf16 v[60:63], v[132:135], v[76:79], v[60:63]
  v_mfma_f32_16x16x32_bf16 v[64:67], v[72:75], v[212:215], v[64:67]
  v_mfma_f32_16x16x32_bf16 v[68:71], v[76:79], v[212:215], v[68:71]
  ds_read_b128 v[72:75], v7 offset:12288
  ds_read_b128 v[76:79], v7 offset:32768
  s_waitcnt lgkmcnt(4)
  v_mfma_f32_16x16x32_bf16 v[32:35], a[40:43], v[80:83], v[32:35]
  v_mfma_f32_16x16x32_bf16 v[36:39], a[40:43], v[84:87], v[36:39]
  v_mfma_f32_16x16x32_bf16 v[40:43], a[120:123], v[80:83], v[40:43]
  v_mfma_f32_16x16x32_bf16 v[44:47], a[120:123], v[84:87], v[44:47]
  v_mfma_f32_16x16x32_bf16 v[48:51], a[200:203], v[80:83], v[48:51]
  v_mfma_f32_16x16x32_bf16 v[52:55], a[200:203], v[84:87], v[52:55]
  v_mfma_f32_16x16x32_bf16 v[56:59], v[136:139], v[80:83], v[56:59]
  v_mfma_f32_16x16x32_bf16 v[60:63], v[136:139], v[84:87], v[60:63]
  v_mfma_f32_16x16x32_bf16 v[64:67], v[80:83], v[216:219], v[64:67]
  v_mfma_f32_16x16x32_bf16 v[68:71], v[84:87], v[216:219], v[68:71]
  ds_read_b128 v[80:83], v7 offset:13312
  ds_read_b128 v[84:87], v7 offset:33792
  s_waitcnt lgkmcnt(4)
  v_mfma_f32_16x16x32_bf16 v[32:35], a[44:47], v[88:91], v[32:35]
  v_mfma_f32_16x16x32_bf16 v[36:39], a[44:47], v[92:95], v[36:39]
  v_mfma_f32_16x16x32_bf16 v[40:43], a[124:127], v[88:91], v[40:43]
  v_mfma_f32_16x16x32_bf16 v[44:47], a[124:127], v[92:95], v[44:47]
  v_mfma_f32_16x16x32_bf16 v[48:51], a[204:207], v[88:91], v[48:51]
  v_mfma_f32_16x16x32_bf16 v[52:55], a[204:207], v[92:95], v[52:55]
  v_mfma_f32_16x16x32_bf16 v[56:59], v[140:143], v[88:91], v[56:59]
  v_mfma_f32_16x16x32_bf16 v[60:63], v[140:143], v[92:95], v[60:63]
  v_mfma_f32_16x16x32_bf16 v[64:67], v[88:91], v[220:223], v[64:67]
  v_mfma_f32_16x16x32_bf16 v[68:71], v[92:95], v[220:223], v[68:71]
  ds_read_b128 v[88:91], v7 offset:14336
  ds_read_b128 v[92:95], v7 offset:34816
  s_waitcnt lgkmcnt(4)
  v_mfma_f32_16x16x32_bf16 v[32:35], a[48:51], v[72:75], v[32:35]
  v_mfma_f32_16x16x32_bf16 v[36:39], a[48:51], v[76:79], v[36:39]
  v_mfma_f32_16x16x32_bf16 v[40:43], a[128:131], v[72:75], v[40:43]
  v_mfma_f32_16x16x32_bf16 v[44:47], a[128:131], v[76:79], v[44:47]
  v_mfma_f32_16x16x32_bf16 v[48:51], a[208:211], v[72:75], v[48:51]
  v_mfma_f32_16x16x32_bf16 v[52:55], a[208:211], v[76:79], v[52:55]
  v_mfma_f32_16x16x32_bf16 v[56:59], v[144:147], v[72:75], v[56:59]
  v_mfma_f32_16x16x32_bf16 v[60:63], v[144:147], v[76:79], v[60:63]
  v_mfma_f32_16x16x32_bf16 v[64:67], v[72:75], v[224:227], v[64:67]
  v_mfma_f32_16x16x32_bf16 v[68:71], v[76:79], v[224:227], v[68:71]
  ds_read_b128 v[72:75], v7 offset:15360
  ds_read_b128 v[76:79], v7 offset:35840
  s_waitcnt lgkmcnt(4)
  v_mfma_f32_16x16x32_bf16 v[32:35], a[52:55], v[80:83], v[32:35]
  v_mfma_f32_16x16x32_bf16 v[36:39], a[52:55], v[84:87], v[36:39]
  v_mfma_f32_16x16x32_bf16 v[40:43], a[132:135], v[80:83], v[40:43]
  v_mfma_f32_16x16x32_bf16 v[44:47], a[132:135], v[84:87], v[44:47]
  v_mfma_f32_16x16x32_bf16 v[48:51], a[212:215], v[80:83], v[48:51]
  v_mfma_f32_16x16x32_bf16 v[52:55], a[212:215], v[84:87], v[52:55]
  v_mfma_f32_16x16x32_bf16 v[56:59], v[148:151], v[80:83], v[56:59]
  v_mfma_f32_16x16x32_bf16 v[60:63], v[148:151], v[84:87], v[60:63]
  v_mfma_f32_16x16x32_bf16 v[64:67], v[80:83], v[228:231], v[64:67]
  v_mfma_f32_16x16x32_bf16 v[68:71], v[84:87], v[228:231], v[68:71]
  ds_read_b128 v[80:83], v7 offset:16384
  ds_read_b128 v[84:87], v7 offset:36864
  s_waitcnt lgkmcnt(4)
  v_mfma_f32_16x16x32_bf16 v[32:35], a[56:59], v[88:91], v[32:35]
  v_mfma_f32_16x16x32_bf16 v[36:39], a[56:59], v[92:95], v[36:39]
  v_mfma_f32_16x16x32_bf16 v[40:43], a[136:139], v[88:91], v[40:43]
  v_mfma_f32_16x16x32_bf16 v[44:47], a[136:139], v[92:95], v[44:47]
  v_mfma_f32_16x16x32_bf16 v[48:51], a[216:219], v[88:91], v[48:51]
  v_mfma_f32_16x16x32_bf16 v[52:55], a[216:219], v[92:95], v[52:55]
  v_mfma_f32_16x16x32_bf16 v[56:59], v[152:155], v[88:91], v[56:59]
  v_mfma_f32_16x16x32_bf16 v[60:63], v[152:155], v[92:95], v[60:63]
  v_mfma_f32_16x16x32_bf16 v[64:67], v[88:91], v[232:235], v[64:67]
  v_mfma_f32_16x16x32_bf16 v[68:71], v[92:95], v[232:235], v[68:71]
  ds_read_b128 v[88:91], v7 offset:17408
  ds_read_b128 v[92:95], v7 offset:37888
  s_waitcnt lgkmcnt(4)
  v_mfma_f32_16x16x32_bf16 v[32:35], a[60:63], v[72:75], v[32:35]
  v_mfma_f32_16x16x32_bf16 v[36:39], a[60:63], v[76:79], v[36:39]
  v_mfma_f32_16x16x32_bf16 v[40:43], a[140:143], v[72:75], v[40:43]
  v_mfma_f32_16x16x32_bf16 v[44:47], a[140:143], v[76:79], v[44:47]
  v_mfma_f32_16x16x32_bf16 v[48:51], a[220:223], v[72:75], v[48:51]
  v_mfma_f32_16x16x32_bf16 v[52:55], a[220:223], v[76:79], v[52:55]
  v_mfma_f32_16x16x32_bf16 v[56:59], v[156:159], v[72:75], v[56:59]
  v_mfma_f32_16x16x32_bf16 v[60:63], v[156:159], v[76:79], v[60:63]
  v_mfma_f32_16x16x32_bf16 v[64:67], v[72:75], v[236:239], v[64:67]
  v_mfma_f32_16x16x32_bf16 v[68:71], v[76:79], v[236:239], v[68:71]
  ds_read_b128 v[72:75], v7 offset:18432
  ds_read_b128 v[76:79], v7 offset:38912
  s_waitcnt lgkmcnt(4)
  v_mfma_f32_16x16x32_bf16 v[32:35], a[64:67], v[80:83], v[32:35]
  v_mfma_f32_16x16x32_bf16 v[36:39], a[64:67], v[84:87], v[36:39]
  v_mfma_f32_16x16x32_bf16 v[40:43], a[144:147], v[80:83], v[40:43]
  v_mfma_f32_16x16x32_bf16 v[44:47], a[144:147], v[84:87], v[44:47]
  v_mfma_f32_16x16x32_bf16 v[48:51], a[224:227], v[80:83], v[48:51]
  v_mfma_f32_16x16x32_bf16 v[52:55], a[224:227], v[84:87], v[52:55]
  v_mfma_f32_16x16x32_bf16 v[56:59], v[160:163], v[80:83], v[56:59]
  v_mfma_f32_16x16x32_bf16 v[60:63], v[160:163], v[84:87], v[60:63]
  v_mfma_f32_16x16x32_bf16 v[64:67], v[80:83], v[240:243], v[64:67]
  v_mfma_f32_16x16x32_bf16 v[68:71], v[84:87], v[240:243], v[68:71]
  ds_read_b128 v[80:83], v7 offset:19456
  ds_read_b128 v[84:87], v7 offset:39936
  s_waitcnt lgkmcnt(4)
  v_mfma_f32_16x16x32_bf16 v[32:35], a[68:71], v[88:91], v[32:35]
  v_mfma_f32_16x16x32_bf16 v[36:39], a[68:71], v[92:95], v[36:39]
  v_mfma_f32_16x16x32_bf16 v[40:43], a[148:151], v[88:91], v[40:43]
  v_mfma_f32_16x16x32_bf16 v[44:47], a[148:151], v[92:95], v[44:47]
  v_mfma_f32_16x16x32_bf16 v[48:51], a[228:231], v[88:91], v[48:51]
  v_mfma_f32_16x16x32_bf16 v[52:55], a[228:231], v[92:95], v[52:55]
  v_mfma_f32_16x16x32_bf16 v[56:59], v[164:167], v[88:91], v[56:59]
  v_mfma_f32_16x16x32_bf16 v[60:63], v[164:167], v[92:95], v[60:63]
  v_mfma_f32_16x16x32_bf16 v[64:67], v[88:91], v[244:247], v[64:67]
  v_mfma_f32_16x16x32_bf16 v[68:71], v[92:95], v[244:247], v[68:71]
  s_waitcnt lgkmcnt(2)
  v_mfma_f32_16x16x32_bf16 v[32:35], a[72:75], v[72:75], v[32:35]
  v_mfma_f32_16x16x32_bf16 v[36:39], a[72:75], v[76:79], v[36:39]
  v_mfma_f32_16x16x32_bf16 v[40:43], a[152:155], v[72:75], v[40:43]
  v_mfma_f32_16x16x32_bf16 v[44:47], a[152:155], v[76:79], v[44:47]
  v_mfma_f32_16x16x32_bf16 v[48:51], a[232:235], v[72:75], v[48:51]
  v_mfma_f32_16x16x32_bf16 v[52:55], a[232:235], v[76:79], v[52:55]
  v_mfma_f32_16x16x32_bf16 v[56:59], v[168:171], v[72:75], v[56:59]
  v_mfma_f32_16x16x32_bf16 v[60:63], v[168:171], v[76:79], v[60:63]
  v_mfma_f32_16x16x32_bf16 v[64:67], v[72:75], v[248:251], v[64:67]
  v_mfma_f32_16x16x32_bf16 v[68:71], v[76:79], v[248:251], v[68:71]
  s_waitcnt lgkmcnt(0)
  v_mfma_f32_16x16x32_bf16 v[32:35], a[76:79], v[80:83], v[32:35]
  v_mfma_f32_16x16x32_bf16 v[36:39], a[76:79], v[84:87], v[36:39]
  v_mfma_f32_16x16x32_bf16 v[40:43], a[156:159], v[80:83], v[40:43]
  v_mfma_f32_16x16x32_bf16 v[44:47], a[156:159], v[84:87], v[44:47]
  v_mfma_f32_16x16x32_bf16 v[48:51], a[236:239], v[80:83], v[48:51]
  v_mfma_f32_16x16x32_bf16 v[52:55], a[236:239], v[84:87], v[52:55]
  v_mfma_f32_16x16x32_bf16 v[56:59], v[172:175], v[80:83], v[56:59]
  v_mfma_f32_16x16x32_bf16 v[60:63], v[172:175], v[84:87], v[60:63]
  v_mfma_f32_16x16x32_bf16 v[64:67], v[80:83], v[252:255], v[64:67]
  v_mfma_f32_16x16x32_bf16 v[68:71], v[84:87], v[252:255], v[68:71]
  v_cvt_pk_bf16_f32 v8, v32, v33
  v_cvt_pk_bf16_f32 v9, v34, v35
  v_cvt_pk_bf16_f32 v10, v40, v41
  v_cvt_pk_bf16_f32 v11, v42, v43
  s_add_u32 s34, s21, 0
  buffer_store_dwordx4 v[8:11], v1, s[4:7], s34 offen
  v_cvt_pk_bf16_f32 v12, v36, v37
  v_cvt_pk_bf16_f32 v13, v38, v39
  v_cvt_pk_bf16_f32 v14, v44, v45
  v_cvt_pk_bf16_f32 v15, v46, v47
  s_add_u32 s34, s21, 6144
  buffer_store_dwordx4 v[12:15], v1, s[4:7], s34 offen
  v_cvt_pk_bf16_f32 v8, v48, v49
  v_cvt_pk_bf16_f32 v9, v50, v51
  v_cvt_pk_bf16_f32 v10, v56, v57
  v_cvt_pk_bf16_f32 v11, v58, v59
  s_add_u32 s34, s21, 1024
  buffer_store_dwordx4 v[8:11], v1, s[4:7], s34 offen
  v_cvt_pk_bf16_f32 v12, v52, v53
  v_cvt_pk_bf16_f32 v13, v54, v55
  v_cvt_pk_bf16_f32 v14, v60, v61
  v_cvt_pk_bf16_f32 v15, v62, v63
  s_add_u32 s34, s21, 7168
  buffer_store_dwordx4 v[12:15], v1, s[4:7], s34 offen
  v_cvt_pk_bf16_f32 v8, v64, v65
  v_cvt_pk_bf16_f32 v9, v66, v67
  v_cvt_pk_bf16_f32 v10, v68, v69
  v_cvt_pk_bf16_f32 v11, v70, v71
  s_add_u32 s34, s23, 0
  buffer_store_dwordx4 v[8:11], v1, s[4:7], s34 offen
  s_waitcnt vmcnt(0)
  s_barrier
  s_add_u32 s17, s17, 1
  v_mov_b32 v28, s17
  buffer_store_dword v28, v4, s[4:7], s24 offen
  s_cmp_lt_u32 s17, 64
  s_cbranch_scc1 reca_ptop233
  s_branch reca_exit1
reca_pslow232:
reca_ptop238:
  s_cmp_lt_u32 s17, 3
  s_cbranch_scc1 reca_pgo239
  s_sub_u32 s36, s17, 3
reca_ppoll240:
  buffer_load_dword v28, v4, s[4:7], s25 offen sc1
  s_waitcnt vmcnt(0)
  v_readfirstlane_b32 s34, v28
  s_nop 3
  s_cmp_ge_i32 s34, s36
  s_cbranch_scc1 reca_pgo239
  s_sleep 8
  s_sub_u32 s18, s18, 1
  s_cbranch_scc0 reca_ppoll240
  s_mov_b32 s18, 0
reca_pgo239:
  s_waitcnt vmcnt(0)
  s_barrier
  v_add_u32 v7, s26, v1
  s_xor_b32 s26, s26, 40960
  s_add_u32 s37, s17, 1
  s_cmp_ge_u32 s37, 64
  s_cbranch_scc1 reca_pnodma241
  s_mul_i32 s20, s37, 40960
  s_add_u32 s20, s20, 84934656
  s_add_u32 m0, s26, 0
  s_nop 0
  buffer_load_dwordx4 v1, s[4:7], s20 offen offset:0 lds
  buffer_load_dwordx4 v1, s[4:7], s20 offen offset:1024 lds
  buffer_load_dwordx4 v1, s[4:7], s20 offen offset:2048 lds
  buffer_load_dwordx4 v1, s[4:7], s20 offen offset:3072 lds
  s_add_u32 s20, s20, 4096
  s_add_u32 m0, s26, 4096
  s_nop 0
  buffer_load_dwordx4 v1, s[4:7], s20 offen offset:0 lds
  buffer_load_dwordx4 v1, s[4:7], s20 offen offset:1024 lds
  buffer_load_dwordx4 v1, s[4:7], s20 offen offset:2048 lds
  buffer_load_dwordx4 v1, s[4:7], s20 offen offset:3072 lds
  s_add_u32 s20, s20, 4096
  s_add_u32 m0, s26, 8192
  s_nop 0
  buffer_load_dwordx4 v1, s[4:7], s20 offen offset:0 lds
  buffer_load_dwordx4 v1, s[4:7], s20 offen offset:1024 lds
reca_pnodma241:
  s_lshl_b32 s34, s15, 3
  s_and_b32 s35, s17, 7
  s_add_u32 s34, s34, s35
  s_mul_i32 s34, s34, 12288
  s_mul_i32 s35, s16, 3072
  s_add_u32 s35, s35, s34
  s_add_u32 s21, s35, 37748736
  s_add_u32 s22, s35, 44040192
  s_mul_i32 s35, s16, 6144
  s_add_u32 s35, s35, s34
  s_add_u32 s23, s35, 40894464
  ds_read_b128 v[72:75], v7 offset:0
  ds_read_b128 v[76:79], v7 offset:20480
  ds_read_b128 v[80:83], v7 offset:1024
  ds_read_b128 v[84:87], v7 offset:21504
  ds_read_b128 v[88:91], v7 offset:2048
  ds_read_b128 v[92:95], v7 offset:22528
  s_waitcnt lgkmcnt(4)
  v_mfma_f32_16x16x32_bf16 v[32:35], a[0:3], v[72:75], 0
  v_mfma_f32_16x16x32_bf16 v[36:39], a[0:3], v[76:79], 0
  v_mfma_f32_16x16x32_bf16 v[40:43], a[80:83], v[72:75], 0
  v_mfma_f32_16x16x32_bf16 v[44:47], a[80:83], v[76:79], 0
  v_mfma_f32_16x16x32_bf16 v[48:51], a[160:163], v[72:75], 0
  v_mfma_f32_16x16x32_bf16 v[52:55], a[160:163], v[76:79], 0
  v_mfma_f32_16x16x32_bf16 v[56:59], v[96:99], v[72:75], 0
  v_mfma_f32_16x16x32_bf16 v[60:63], v[96:99], v[76:79], 0
  v_mfma_f32_16x16x32_bf16 v[64:67], v[72:75], v[176:179], 0
  v_mfma_f32_16x16x32_bf16 v[68:71], v[76:79], v[176:179], 0
  ds_read_b128 v[72:75], v7 offset:3072
  ds_read_b128 v[76:79], v7 offset:23552
  s_waitcnt lgkmcnt(4)
  v_mfma_f32_16x16x32_bf16 v[32:35], a[4:7], v[80:83], v[32:35]
  v_mfma_f32_16x16x32_bf16 v[36:39], a[4:7], v[84:87], v[36:39]
  v_mfma_f32_16x16x32_bf16 v[40:43], a[84:87], v[80:83], v[40:43]
  v_mfma_f32_16x16x32_bf16 v[44:47], a[84:87], v[84:87], v[44:47]
  v_mfma_f32_16x16x32_bf16 v[48:51], a[164:167], v[80:83], v[48:51]
  v_mfma_f32_16x16x32_bf16 v[52:55], a[164:167], v[84:87], v[52:55]
  v_mfma_f32_16x16x32_bf16 v[56:59], v[100:103], v[80:83], v[56:59]
  v_mfma_f32_16x16x32_bf16 v[60:63], v[100:103], v[84:87], v[60:63]
  v_mfma_f32_16x16x32_bf16 v[64:67], v[80:83], v[180:183], v[64:67]
  v_mfma_f32_16x16x32_bf16 v[68:71], v[84:87], v[180:183], v[68:71]
  ds_read_b128 v[80:83], v7 offset:4096
  ds_read_b128 v[84:87], v7 offset:24576
  s_waitcnt lgkmcnt(4)
  v_mfma_f32_16x16x32_bf16 v[32:35], a[8:11], v[88:91], v[32:35]
  v_mfma_f32_16x16x32_bf16 v[36:39], a[8:11], v[92:95], v[36:39]
  v_mfma_f32_16x16x32_bf16 v[40:43], a[88:91], v[88:91], v[40:43]
  v_mfma_f32_16x16x32_bf16 v[44:47], a[88:91], v[92:95], v[44:47]
  v_mfma_f32_16x16x32_bf16 v[48:51], a[168:171], v[88:91], v[48:51]
  v_mfma_f32_16x16x32_bf16 v[52:55], a[168:171], v[92:95], v[52:55]
  v_mfma_f32_16x16x32_bf16 v[56:59], v[104:107], v[88:91], v[56:59]
  v_mfma_f32_16x16x32_bf16 v[60:63], v[104:107], v[92:95], v[60:63]
  v_mfma_f32_16x16x32_bf16 v[64:67], v[88:91], v[184:187], v[64:67]
  v_mfma_f32_16x16x32_bf16 v[68:71], v[92:95], v[184:187], v[68:71]
  ds_read_b128 v[88:91], v7 offset:5120
  ds_read_b128 v[92:95], v7 offset:25600
  s_waitcnt lgkmcnt(4)
  v_mfma_f32_16x16x32_bf16 v[32:35], a[12:15], v[72:75], v[32:35]
  v_mfma_f32_16x16x32_bf16 v[36:39], a[12:15], v[76:79], v[36:39]
  v_mfma_f32_16x16x32_bf16 v[40:43], a[92:95], v[72:75], v[40:43]
  v_mfma_f32_16x16x32_bf16 v[44:47], a[92:95], v[76:79], v[44:47]
  v_mfma_f32_16x16x32_bf16 v[48:51], a[172:175], v[72:75], v[48:51]
  v_mfma_f32_16x16x32_bf16 v[52:55], a[172:175], v[76:79], v[52:55]
  v_mfma_f32_16x16x32_bf16 v[56:59], v[108:111], v[72:75], v[56:59]
  v_mfma_f32_16x16x32_bf16 v[60:63], v[108:111], v[76:79], v[60:63]
  v_mfma_f32_16x16x32_bf16 v[64:67], v[72:75], v[188:191], v[64:67]
  v_mfma_f32_16x16x32_bf16 v[68:71], v[76:79], v[188:191], v[68:71]
  ds_read_b128 v[72:75], v7 offset:6144
  ds_read_b128 v[76:79], v7 offset:26624
  s_waitcnt lgkmcnt(4)
  v_mfma_f32_16x16x32_bf16 v[32:35], a[16:19], v[80:83], v[32:35]
  v_mfma_f32_16x16x32_bf16 v[36:39], a[16:19], v[84:87], v[36:39]
  v_mfma_f32_16x16x32_bf16 v[40:43], a[96:99], v[80:83], v[40:43]
  v_mfma_f32_16x16x32_bf16 v[44:47], a[96:99], v[84:87], v[44:47]
  v_mfma_f32_16x16x32_bf16 v[48:51], a[176:179], v[80:83], v[48:51]
  v_mfma_f32_16x16x32_bf16 v[52:55], a[176:179], v[84:87], v[52:55]
  v_mfma_f32_16x16x32_bf16 v[56:59], v[112:115], v[80:83], v[56:59]
  v_mfma_f32_16x16x32_bf16 v[60:63], v[112:115], v[84:87], v[60:63]
  v_mfma_f32_16x16x32_bf16 v[64:67], v[80:83], v[192:195], v[64:67]
  v_mfma_f32_16x16x32_bf16 v[68:71], v[84:87], v[192:195], v[68:71]
  ds_read_b128 v[80:83], v7 offset:7168
  ds_read_b128 v[84:87], v7 offset:27648
  s_waitcnt lgkmcnt(4)
  v_mfma_f32_16x16x32_bf16 v[32:35], a[20:23], v[88:91], v[32:35]
  v_mfma_f32_16x16x32_bf16 v[36:39], a[20:23], v[92:95], v[36:39]
  v_mfma_f32_16x16x32_bf16 v[40:43], a[100:103], v[88:91], v[40:43]
  v_mfma_f32_16x16x32_bf16 v[44:47], a[100:103], v[92:95], v[44:47]
  v_mfma_f32_16x16x32_bf16 v[48:51], a[180:183], v[88:91], v[48:51]
  v_mfma_f32_16x16x32_bf16 v[52:55], a[180:183], v[92:95], v[52:55]
  v_mfma_f32_16x16x32_bf16 v[56:59], v[116:119], v[88:91], v[56:59]
  v_mfma_f32_16x16x32_bf16 v[60:63], v[116:119], v[92:95], v[60:63]
  v_mfma_f32_16x16x32_bf16 v[64:67], v[88:91], v[196:199], v[64:67]
  v_mfma_f32_16x16x32_bf16 v[68:71], v[92:95], v[196:199], v[68:71]
  ds_read_b128 v[88:91], v7 offset:8192
  ds_read_b128 v[92:95], v7 offset:28672
  s_waitcnt lgkmcnt(4)
  v_mfma_f32_16x16x32_bf16 v[32:35], a[24:27], v[72:75], v[32:35]
  v_mfma_f32_16x16x32_bf16 v[36:39], a[24:27], v[76:79], v[36:39]
  v_mfma_f32_16x16x32_bf16 v[40:43], a[104:107], v[72:75], v[40:43]
  v_mfma_f32_16x16x32_bf16 v[44:47], a[104:107], v[76:79], v[44:47]
  v_mfma_f32_16x16x32_bf16 v[48:51], a[184:187], v[72:75], v[48:51]
  v_mfma_f32_16x16x32_bf16 v[52:55], a[184:187], v[76:79], v[52:55]
  v_mfma_f32_16x16x32_bf16 v[56:59], v[120:123], v[72:75], v[56:59]
  v_mfma_f32_16x16x32_bf16 v[60:63], v[120:123], v[76:79], v[60:63]
  v_mfma_f32_16x16x32_bf16 v[64:67], v[72:75], v[200:203], v[64:67]
  v_mfma_f32_16x16x32_bf16 v[68:71], v[76:79], v[200:203], v[68:71]
  ds_read_b128 v[72:75], v7 offset:9216
  ds_read_b128 v[76:79], v7 offset:29696
  s_waitcnt lgkmcnt(4)
  v_mfma_f32_16x16x32_bf16 v[32:35], a[28:31], v[80:83], v[32:35]
  v_mfma_f32_16x16x32_bf16 v[36:39], a[28:31], v[84:87], v[36:39]
  v_mfma_f32_16x16x32_bf16 v[40:43], a[108:111], v[80:83], v[40:43]
  v_mfma_f32_16x16x32_bf16 v[44:47], a[108:111], v[84:87], v[44:47]
  v_mfma_f32_16x16x32_bf16 v[48:51], a[188:191], v[80:83], v[48:51]
  v_mfma_f32_16x16x32_bf16 v[52:55], a[188:191], v[84:87], v[52:55]
  v_mfma_f32_16x16x32_bf16 v[56:59], v[124:127], v[80:83], v[56:59]
  v_mfma_f32_16x16x32_bf16 v[60:63], v[124:127], v[84:87], v[60:63]
  v_mfma_f32_16x16x32_bf16 v[64:67], v[80:83], v[204:207], v[64:67]
  v_mfma_f32_16x16x32_bf16 v[68:71], v[84:87], v[204:207], v[68:71]
  ds_read_b128 v[80:83], v7 offset:10240
  ds_read_b128 v[84:87], v7 offset:30720
  s_waitcnt lgkmcnt(4)
  v_mfma_f32_16x16x32_bf16 v[32:35], a[32:35], v[88:91], v[32:35]
  v_mfma_f32_16x16x32_bf16 v[36:39], a[32:35], v[92:95], v[36:39]
  v_mfma_f32_16x16x32_bf16 v[40:43], a[112:115], v[88:91], v[40:43]
  v_mfma_f32_16x16x32_bf16 v[44:47], a[112:115], v[92:95], v[44:47]
  v_mfma_f32_16x16x32_bf16 v[48:51], a[192:195], v[88:91], v[48:51]
  v_mfma_f32_16x16x32_bf16 v[52:55], a[192:195], v[92:95], v[52:55]
  v_mfma_f32_16x16x32_bf16 v[56:59], v[128:131], v[88:91], v[56:59]
  v_mfma_f32_16x16x32_bf16 v[60:63], v[128:131], v[92:95], v[60:63]
  v_mfma_f32_16x16x32_bf16 v[64:67], v[88:91], v[208:211], v[64:67]
  v_mfma_f32_16x16x32_bf16 v[68:71], v[92:95], v[208:211], v[68:71]
  ds_read_b128 v[88:91], v7 offset:11264
  ds_read_b128 v[92:95], v7 offset:31744
  s_waitcnt lgkmcnt(4)
  v_mfma_f32_16x16x32_bf16 v[32:35], a[36:39], v[72:75], v[32:35]
  v_mfma_f32_16x16x32_bf16 v[36:39], a[36:39], v[76:79], v[36:39]
  v_mfma_f32_16x16x32_bf16 v[40:43], a[116:119], v[72:75], v[40:43]
  v_mfma_f32_16x16x32_bf16 v[44:47], a[116:119], v[76:79], v[44:47]
  v_mfma_f32_16x16x32_bf16 v[48:51], a[196:199], v[72:75], v[48:51]
  v_mfma_f32_16x16x32_bf16 v[52:55], a[196:199], v[76:79], v[52:55]
  v_mfma_f32_16x16x32_bf16 v[56:59], v[132:135], v[72:75], v[56:59]
  v_mfma_f32_16x16x32_bf16 v[60:63], v[132:135], v[76:79], v[60:63]
  v_mfma_f32_16x16x32_bf16 v[64:67], v[72:75], v[212:215], v[64:67]
  v_mfma_f32_16x16x32_bf16 v[68:71], v[76:79], v[212:215], v[68:71]
  ds_read_b128 v[72:75], v7 offset:12288
  ds_read_b128 v[76:79], v7 offset:32768
  s_waitcnt lgkmcnt(4)
  v_mfma_f32_16x16x32_bf16 v[32:35], a[40:43], v[80:83], v[32:35]
  v_mfma_f32_16x16x32_bf16 v[36:39], a[40:43], v[84:87], v[36:39]
  v_mfma_f32_16x16x32_bf16 v[40:43], a[120:123], v[80:83], v[40:43]
  v_mfma_f32_16x16x32_bf16 v[44:47], a[120:123], v[84:87], v[44:47]
  v_mfma_f32_16x16x32_bf16 v[48:51], a[200:203], v[80:83], v[48:51]
  v_mfma_f32_16x16x32_bf16 v[52:55], a[200:203], v[84:87], v[52:55]
  v_mfma_f32_16x16x32_bf16 v[56:59], v[136:139], v[80:83], v[56:59]
  v_mfma_f32_16x16x32_bf16 v[60:63], v[136:139], v[84:87], v[60:63]
  v_mfma_f32_16x16x32_bf16 v[64:67], v[80:83], v[216:219], v[64:67]
  v_mfma_f32_16x16x32_bf16 v[68:71], v[84:87], v[216:219], v[68:71]
  ds_read_b128 v[80:83], v7 offset:13312
  ds_read_b128 v[84:87], v7 offset:33792
  s_waitcnt lgkmcnt(4)
  v_mfma_f32_16x16x32_bf16 v[32:35], a[44:47], v[88:91], v[32:35]
  v_mfma_f32_16x16x32_bf16 v[36:39], a[44:47], v[92:95], v[36:39]
  v_mfma_f32_16x16x32_bf16 v[40:43], a[124:127], v[88:91], v[40:43]
  v_mfma_f32_16x16x32_bf16 v[44:47], a[124:127], v[92:95], v[44:47]
  v_mfma_f32_16x16x32_bf16 v[48:51], a[204:207], v[88:91], v[48:51]
  v_mfma_f32_16x16x32_bf16 v[52:55], a[204:207], v[92:95], v[52:55]
  v_mfma_f32_16x16x32_bf16 v[56:59], v[140:143], v[88:91], v[56:59]
  v_mfma_f32_16x16x32_bf16 v[60:63], v[140:143], v[92:95], v[60:63]
  v_mfma_f32_16x16x32_bf16 v[64:67], v[88:91], v[220:223], v[64:67]
  v_mfma_f32_16x16x32_bf16 v[68:71], v[92:95], v[220:223], v[68:71]
  ds_read_b128 v[88:91], v7 offset:14336
  ds_read_b128 v[92:95], v7 offset:34816
  s_waitcnt lgkmcnt(4)
  v_mfma_f32_16x16x32_bf16 v[32:35], a[48:51], v[72:75], v[32:35]
  v_mfma_f32_16x16x32_bf16 v[36:39], a[48:51], v[76:79], v[36:39]
  v_mfma_f32_16x16x32_bf16 v[40:43], a[128:131], v[72:75], v[40:43]
  v_mfma_f32_16x16x32_bf16 v[44:47], a[128:131], v[76:79], v[44:47]
  v_mfma_f32_16x16x32_bf16 v[48:51], a[208:211], v[72:75], v[48:51]
  v_mfma_f32_16x16x32_bf16 v[52:55], a[208:211], v[76:79], v[52:55]
  v_mfma_f32_16x16x32_bf16 v[56:59], v[144:147], v[72:75], v[56:59]
  v_mfma_f32_16x16x32_bf16 v[60:63], v[144:147], v[76:79], v[60:63]
  v_mfma_f32_16x16x32_bf16 v[64:67], v[72:75], v[224:227], v[64:67]
  v_mfma_f32_16x16x32_bf16 v[68:71], v[76:79], v[224:227], v[68:71]
  ds_read_b128 v[72:75], v7 offset:15360
  ds_read_b128 v[76:79], v7 offset:35840
  s_waitcnt lgkmcnt(4)
  v_mfma_f32_16x16x32_bf16 v[32:35], a[52:55], v[80:83], v[32:35]
  v_mfma_f32_16x16x32_bf16 v[36:39], a[52:55], v[84:87], v[36:39]
  v_mfma_f32_16x16x32_bf16 v[40:43], a[132:135], v[80:83], v[40:43]
  v_mfma_f32_16x16x32_bf16 v[44:47], a[132:135], v[84:87], v[44:47]
  v_mfma_f32_16x16x32_bf16 v[48:51], a[212:215], v[80:83], v[48:51]
  v_mfma_f32_16x16x32_bf16 v[52:55], a[212:215], v[84:87], v[52:55]
  v_mfma_f32_16x16x32_bf16 v[56:59], v[148:151], v[80:83], v[56:59]
  v_mfma_f32_16x16x32_bf16 v[60:63], v[148:151], v[84:87], v[60:63]
  v_mfma_f32_16x16x32_bf16 v[64:67], v[80:83], v[228:231], v[64:67]
  v_mfma_f32_16x16x32_bf16 v[68:71], v[84:87], v[228:231], v[68:71]
  ds_read_b128 v[80:83], v7 offset:16384
  ds_read_b128 v[84:87], v7 offset:36864
  s_waitcnt lgkmcnt(4)
  v_mfma_f32_16x16x32_bf16 v[32:35], a[56:59], v[88:91], v[32:35]
  v_mfma_f32_16x16x32_bf16 v[36:39], a[56:59], v[92:95], v[36:39]
  v_mfma_f32_16x16x32_bf16 v[40:43], a[136:139], v[88:91], v[40:43]
  v_mfma_f32_16x16x32_bf16 v[44:47], a[136:139], v[92:95], v[44:47]
  v_mfma_f32_16x16x32_bf16 v[48:51], a[216:219], v[88:91], v[48:51]
  v_mfma_f32_16x16x32_bf16 v[52:55], a[216:219], v[92:95], v[52:55]
  v_mfma_f32_16x16x32_bf16 v[56:59], v[152:155], v[88:91], v[56:59]
  v_mfma_f32_16x16x32_bf16 v[60:63], v[152:155], v[92:95], v[60:63]
  v_mfma_f32_16x16x32_bf16 v[64:67], v[88:91], v[232:235], v[64:67]
  v_mfma_f32_16x16x32_bf16 v[68:71], v[92:95], v[232:235], v[68:71]
  ds_read_b128 v[88:91], v7 offset:17408
  ds_read_b128 v[92:95], v7 offset:37888
  s_waitcnt lgkmcnt(4)
  v_mfma_f32_16x16x32_bf16 v[32:35], a[60:63], v[72:75], v[32:35]
  v_mfma_f32_16x16x32_bf16 v[36:39], a[60:63], v[76:79], v[36:39]
  v_mfma_f32_16x16x32_bf16 v[40:43], a[140:143], v[72:75], v[40:43]
  v_mfma_f32_16x16x32_bf16 v[44:47], a[140:143], v[76:79], v[44:47]
  v_mfma_f32_16x16x32_bf16 v[48:51], a[220:223], v[72:75], v[48:51]
  v_mfma_f32_16x16x32_bf16 v[52:55], a[220:223], v[76:79], v[52:55]
  v_mfma_f32_16x16x32_bf16 v[56:59], v[156:159], v[72:75], v[56:59]
  v_mfma_f32_16x16x32_bf16 v[60:63], v[156:159], v[76:79], v[60:63]
  v_mfma_f32_16x16x32_bf16 v[64:67], v[72:75], v[236:239], v[64:67]
  v_mfma_f32_16x16x32_bf16 v[68:71], v[76:79], v[236:239], v[68:71]
  ds_read_b128 v[72:75], v7 offset:18432
  ds_read_b128 v[76:79], v7 offset:38912
  s_waitcnt lgkmcnt(4)
  v_mfma_f32_16x16x32_bf16 v[32:35], a[64:67], v[80:83], v[32:35]
  v_mfma_f32_16x16x32_bf16 v[36:39], a[64:67], v[84:87], v[36:39]
  v_mfma_f32_16x16x32_bf16 v[40:43], a[144:147], v[80:83], v[40:43]
  v_mfma_f32_16x16x32_bf16 v[44:47], a[144:147], v[84:87], v[44:47]
  v_mfma_f32_16x16x32_bf16 v[48:51], a[224:227], v[80:83], v[48:51]
  v_mfma_f32_16x16x32_bf16 v[52:55], a[224:227], v[84:87], v[52:55]
  v_mfma_f32_16x16x32_bf16 v[56:59], v[160:163], v[80:83], v[56:59]
  v_mfma_f32_16x16x32_bf16 v[60:63], v[160:163], v[84:87], v[60:63]
  v_mfma_f32_16x16x32_bf16 v[64:67], v[80:83], v[240:243], v[64:67]
  v_mfma_f32_16x16x32_bf16 v[68:71], v[84:87], v[240:243], v[68:71]
  ds_read_b128 v[80:83], v7 offset:19456
  ds_read_b128 v[84:87], v7 offset:39936
  s_waitcnt lgkmcnt(4)
  v_mfma_f32_16x16x32_bf16 v[32:35], a[68:71], v[88:91], v[32:35]
  v_mfma_f32_16x16x32_bf16 v[36:39], a[68:71], v[92:95], v[36:39]
  v_mfma_f32_16x16x32_bf16 v[40:43], a[148:151], v[88:91], v[40:43]
  v_mfma_f32_16x16x32_bf16 v[44:47], a[148:151], v[92:95], v[44:47]
  v_mfma_f32_16x16x32_bf16 v[48:51], a[228:231], v[88:91], v[48:51]
  v_mfma_f32_16x16x32_bf16 v[52:55], a[228:231], v[92:95], v[52:55]
  v_mfma_f32_16x16x32_bf16 v[56:59], v[164:167], v[88:91], v[56:59]
  v_mfma_f32_16x16x32_bf16 v[60:63], v[164:167], v[92:95], v[60:63]
  v_mfma_f32_16x16x32_bf16 v[64:67], v[88:91], v[244:247], v[64:67]
  v_mfma_f32_16x16x32_bf16 v[68:71], v[92:95], v[244:247], v[68:71]
  s_waitcnt lgkmcnt(2)
  v_mfma_f32_16x16x32_bf16 v[32:35], a[72:75], v[72:75], v[32:35]
  v_mfma_f32_16x16x32_bf16 v[36:39], a[72:75], v[76:79], v[36:39]
  v_mfma_f32_16x16x32_bf16 v[40:43], a[152:155], v[72:75], v[40:43]
  v_mfma_f32_16x16x32_bf16 v[44:47], a[152:155], v[76:79], v[44:47]
  v_mfma_f32_16x16x32_bf16 v[48:51], a[232:235], v[72:75], v[48:51]
  v_mfma_f32_16x16x32_bf16 v[52:55], a[232:235], v[76:79], v[52:55]
  v_mfma_f32_16x16x32_bf16 v[56:59], v[168:171], v[72:75], v[56:59]
  v_mfma_f32_16x16x32_bf16 v[60:63], v[168:171], v[76:79], v[60:63]
  v_mfma_f32_16x16x32_bf16 v[64:67], v[72:75], v[248:251], v[64:67]
  v_mfma_f32_16x16x32_bf16 v[68:71], v[76:79], v[248:251], v[68:71]
  s_waitcnt lgkmcnt(0)
  v_mfma_f32_16x16x32_bf16 v[32:35], a[76:79], v[80:83], v[32:35]
  v_mfma_f32_16x16x32_bf16 v[36:39], a[76:79], v[84:87], v[36:39]
  v_mfma_f32_16x16x32_bf16 v[40:43], a[156:159], v[80:83], v[40:43]
  v_mfma_f32_16x16x32_bf16 v[44:47], a[156:159], v[84:87], v[44:47]
  v_mfma_f32_16x16x32_bf16 v[48:51], a[236:239], v[80:83], v[48:51]
  v_mfma_f32_16x16x32_bf16 v[52:55], a[236:239], v[84:87], v[52:55]
  v_mfma_f32_16x16x32_bf16 v[56:59], v[172:175], v[80:83], v[56:59]
  v_mfma_f32_16x16x32_bf16 v[60:63], v[172:175], v[84:87], v[60:63]
  v_mfma_f32_16x16x32_bf16 v[64:67], v[80:83], v[252:255], v[64:67]
  v_mfma_f32_16x16x32_bf16 v[68:71], v[84:87], v[252:255], v[68:71]
  v_cvt_pk_bf16_f32 v8, v32, v33
  v_cvt_pk_bf16_f32 v9, v34, v35
  v_cvt_pk_bf16_f32 v10, v40, v41
  v_cvt_pk_bf16_f32 v11, v42, v43
  s_add_u32 s34, s21, 0
  buffer_store_dwordx4 v[8:11], v1, s[4:7], s34 offen sc1
  v_cvt_pk_bf16_f32 v12, v36, v37
  v_cvt_pk_bf16_f32 v13, v38, v39
  v_cvt_pk_bf16_f32 v14, v44, v45
  v_cvt_pk_bf16_f32 v15, v46, v47
  s_add_u32 s34, s21, 6144
  buffer_store_dwordx4 v[12:15], v1, s[4:7], s34 offen sc1
  v_cvt_pk_bf16_f32 v8, v48, v49
  v_cvt_pk_bf16_f32 v9, v50, v51
  v_cvt_pk_bf16_f32 v10, v56, v57
  v_cvt_pk_bf16_f32 v11, v58, v59
  s_add_u32 s34, s21, 1024
  buffer_store_dwordx4 v[8:11], v1, s[4:7], s34 offen sc1
  v_cvt_pk_bf16_f32 v12, v52, v53
  v_cvt_pk_bf16_f32 v13, v54, v55
  v_cvt_pk_bf16_f32 v14, v60, v61
  v_cvt_pk_bf16_f32 v15, v62, v63
  s_add_u32 s34, s21, 7168
  buffer_store_dwordx4 v[12:15], v1, s[4:7], s34 offen sc1
  v_cvt_pk_bf16_f32 v8, v64, v65
  v_cvt_pk_bf16_f32 v9, v66, v67
  v_cvt_pk_bf16_f32 v10, v68, v69
  v_cvt_pk_bf16_f32 v11, v70, v71
  s_add_u32 s34, s23, 0
  buffer_store_dwordx4 v[8:11], v1, s[4:7], s34 offen sc1
  s_waitcnt vmcnt(0)
  s_barrier
  s_add_u32 s17, s17, 1
  v_mov_b32 v28, s17
  buffer_store_dword v28, v4, s[4:7], s24 offen sc1
  s_cmp_lt_u32 s17, 64
  s_cbranch_scc1 reca_ptop238
  s_branch reca_exit1
reca_pw1_227:
  s_mov_b32 s17, 0
  s_mov_b32 s26, 0
  s_mul_i32 s20, s17, 40960
  s_add_u32 s20, s20, 84944896
  s_add_u32 m0, s26, 10240
  s_nop 0
  buffer_load_dwordx4 v1, s[4:7], s20 offen offset:0 lds
  buffer_load_dwordx4 v1, s[4:7], s20 offen offset:1024 lds
  buffer_load_dwordx4 v1, s[4:7], s20 offen offset:2048 lds
  buffer_load_dwordx4 v1, s[4:7], s20 offen offset:3072 lds
  s_add_u32 s20, s20, 4096
  s_add_u32 m0, s26, 14336
  s_nop 0
  buffer_load_dwordx4 v1, s[4:7], s20 offen offset:0 lds
  buffer_load_dwordx4 v1, s[4:7], s20 offen offset:1024 lds
  buffer_load_dwordx4 v1, s[4:7], s20 offen offset:2048 lds
  buffer_load_dwordx4 v1, s[4:7], s20 offen offset:3072 lds
  s_add_u32 s20, s20, 4096
  s_add_u32 m0, s26, 18432
  s_nop 0
  buffer_load_dwordx4 v1, s[4:7], s20 offen offset:0 lds
  buffer_load_dwordx4 v1, s[4:7], s20 offen offset:1024 lds
  s_mul_i32 s34, s15, 12
  s_mul_i32 s35, s16, 6
  s_add_u32 s34, s34, s35
  s_add_u32 s34, s34, 4
  s_mul_i32 s34, s34, 20480
  s_add_u32 s34, s34, 14155776
  buffer_load_dwordx4 a[0:3], v1, s[4:7], s34 offen offset:0
  buffer_load_dwordx4 a[4:7], v1, s[4:7], s34 offen offset:1024
  buffer_load_dwordx4 a[8:11], v1, s[4:7], s34 offen offset:2048
  buffer_load_dwordx4 a[12:15], v1, s[4:7], s34 offen offset:3072
  s_add_u32 s34, s34, 4096
  buffer_load_dwordx4 a[16:19], v1, s[4:7], s34 offen offset:0
  buffer_load_dwordx4 a[20:23], v1, s[4:7], s34 offen offset:1024
  buffer_load_dwordx4 a[24:27], v1, s[4:7], s34 offen offset:2048
  buffer_load_dwordx4 a[28:31], v1, s[4:7], s34 offen offset:3072
  s_add_u32 s34, s34, 4096
  buffer_load_dwordx4 a[32:35], v1, s[4:7], s34 offen offset:0
  buffer_load_dwordx4 a[36:39], v1, s[4:7], s34 offen offset:1024
  buffer_load_dwordx4 a[40:43], v1, s[4:7], s34 offen offset:2048
  buffer_load_dwordx4 a[44:47], v1, s[4:7], s34 offen offset:3072
  s_add_u32 s34, s34, 4096
  buffer_load_dwordx4 a[48:51], v1, s[4:7], s34 offen offset:0
  buffer_load_dwordx4 a[52:55], v1, s[4:7], s34 offen offset:1024
  buffer_load_dwordx4 a[56:59], v1, s[4:7], s34 offen offset:2048
  buffer_load_dwordx4 a[60:63], v1, s[4:7], s34 offen offset:3072
  s_add_u32 s34, s34, 4096
  buffer_load_dwordx4 a[64:67], v1, s[4:7], s34 offen offset:0
  buffer_load_dwordx4 a[68:71], v1, s[4:7], s34 offen offset:1024
  buffer_load_dwordx4 a[72:75], v1, s[4:7], s34 offen offset:2048
  buffer_load_dwordx4 a[76:79], v1, s[4:7], s34 offen offset:3072
  s_mul_i32 s34, s15, 12
  s_mul_i32 s35, s16, 6
  s_add_u32 s34, s34, s35
  s_add_u32 s34, s34, 5
  s_mul_i32 s34, s34, 20480
  s_add_u32 s34, s34, 14155776
  buffer_load_dwordx4 a[80:83], v1, s[4:7], s34 offen offset:0
  buffer_load_dwordx4 a[84:87], v1, s[4:7], s34 offen offset:1024
  buffer_load_dwordx4 a[88:91], v1, s[4:7], s34 offen offset:2048
  buffer_load_dwordx4 a[92:95], v1, s[4:7], s34 offen offset:3072
  s_add_u32 s34, s34, 4096
  buffer_load_dwordx4 a[96:99], v1, s[4:7], s34 offen offset:0
  buffer_load_dwordx4 a[100:103], v1, s[4:7], s34 offen offset:1024
  buffer_load_dwordx4 a[104:107], v1, s[4:7], s34 offen offset:2048
  buffer_load_dwordx4 a[108:111], v1, s[4:7], s34 offen offset:3072
  s_add_u32 s34, s34, 4096
  buffer_load_dwordx4 a[112:115], v1, s[4:7], s34 offen offset:0
  buffer_load_dwordx4 a[116:119], v1, s[4:7], s34 offen offset:1024
  buffer_load_dwordx4 a[120:123], v1, s[4:7], s34 offen offset:2048
  buffer_load_dwordx4 a[124:127], v1, s[4:7], s34 offen offset:3072
  s_add_u32 s34, s34, 4096
  buffer_load_dwordx4 a[128:131], v1, s[4:7], s34 offen offset:0
  buffer_load_dwordx4 a[132:135], v1, s[4:7], s34 offen offset:1024
  buffer_load_dwordx4 a[136:139], v1, s[4:7], s34 offen offset:2048
  buffer_load_dwordx4 a[140:143], v1, s[4:7], s34 offen offset:3072
  s_add_u32 s34, s34, 4096
  buffer_load_dwordx4 a[144:147], v1, s[4:7], s34 offen offset:0
  buffer_load_dwordx4 a[148:151], v1, s[4:7], s34 offen offset:1024
  buffer_load_dwordx4 a[152:155], v1, s[4:7], s34 offen offset:2048
  buffer_load_dwordx4 a[156:159], v1, s[4:7], s34 offen offset:3072
  s_waitcnt vmcnt(20)
  s_mul_i32 s34, s15, 12
  s_mul_i32 s35, s16, 6
  s_add_u32 s34, s34, s35
  s_add_u32 s34, s34, 1
  s_mul_i32 s34, s34, 20480
  s_add_u32 s34, s34, 22020096
  buffer_load_dwordx4 a[160:163], v1, s[4:7], s34 offen offset:0
  buffer_load_dwordx4 a[164:167], v1, s[4:7], s34 offen offset:1024
  buffer_load_dwordx4 a[168:171], v1, s[4:7], s34 offen offset:2048
  buffer_load_dwordx4 a[172:175], v1, s[4:7], s34 offen offset:3072
  s_add_u32 s34, s34, 4096
  buffer_load_dwordx4 a[176:179], v1, s[4:7], s34 offen offset:0
  buffer_load_dwordx4 a[180:183], v1, s[4:7], s34 offen offset:1024
  buffer_load_dwordx4 a[184:187], v1, s[4:7], s34 offen offset:2048
  buffer_load_dwordx4 a[188:191], v1, s[4:7], s34 offen offset:3072
  s_add_u32 s34, s34, 4096
  buffer_load_dwordx4 a[192:195], v1, s[4:7], s34 offen offset:0
  buffer_load_dwordx4 a[196:199], v1, s[4:7], s34 offen offset:1024
  buffer_load_dwordx4 a[200:203], v1, s[4:7], s34 offen offset:2048
  buffer_load_dwordx4 a[204:207], v1, s[4:7], s34 offen offset:3072
  s_add_u32 s34, s34, 4096
  buffer_load_dwordx4 a[208:211], v1, s[4:7], s34 offen offset:0
  buffer_load_dwordx4 a[212:215], v1, s[4:7], s34 offen offset:1024
  buffer_load_dwordx4 a[216:219], v1, s[4:7], s34 offen offset:2048
  buffer_load_dwordx4 a[220:223], v1, s[4:7], s34 offen offset:3072
  s_add_u32 s34, s34, 4096
  buffer_load_dwordx4 a[224:227], v1, s[4:7], s34 offen offset:0
  buffer_load_dwordx4 a[228:231], v1, s[4:7], s34 offen offset:1024
  buffer_load_dwordx4 a[232:235], v1, s[4:7], s34 offen offset:2048
  buffer_load_dwordx4 a[236:239], v1, s[4:7], s34 offen offset:3072
  s_waitcnt vmcnt(20)
  s_mul_i32 s34, s15, 12
  s_mul_i32 s35, s16, 6
  s_add_u32 s34, s34, s35
  s_add_u32 s34, s34, 2
  s_mul_i32 s34, s34, 20480
  s_add_u32 s34, s34, 22020096
  buffer_load_dwordx4 v[96:99], v1, s[4:7], s34 offen offset:0
  buffer_load_dwordx4 v[100:103], v1, s[4:7], s34 offen offset:1024
  buffer_load_dwordx4 v[104:107], v1, s[4:7], s34 offen offset:2048
  buffer_load_dwordx4 v[108:111], v1, s[4:7], s34 offen offset:3072
  s_add_u32 s34, s34, 4096
  buffer_load_dwordx4 v[112:115], v1, s[4:7], s34 offen offset:0
  buffer_load_dwordx4 v[116:119], v1, s[4:7], s34 offen offset:1024
  buffer_load_dwordx4 v[120:123], v1, s[4:7], s34 offen offset:2048
  buffer_load_dwordx4 v[124:127], v1, s[4:7], s34 offen offset:3072
  s_add_u32 s34, s34, 4096
  buffer_load_dwordx4 v[128:131], v1, s[4:7], s34 offen offset:0
  buffer_load_dwordx4 v[132:135], v1, s[4:7], s34 offen offset:1024
  buffer_load_dwordx4 v[136:139], v1, s[4:7], s34 offen offset:2048
  buffer_load_dwordx4 v[140:143], v1, s[4:7], s34 offen offset:3072
  s_add_u32 s34, s34, 4096
  buffer_load_dwordx4 v[144:147], v1, s[4:7], s34 offen offset:0
  buffer_load_dwordx4 v[148:151], v1, s[4:7], s34 offen offset:1024
  buffer_load_dwordx4 v[152:155], v1, s[4:7], s34 offen offset:2048
  buffer_load_dwordx4 v[156:159], v1, s[4:7], s34 offen offset:3072
  s_add_u32 s34, s34, 4096
  buffer_load_dwordx4 v[160:163], v1, s[4:7], s34 offen offset:0
  buffer_load_dwordx4 v[164:167], v1, s[4:7], s34 offen offset:1024
  buffer_load_dwordx4 v[168:171], v1, s[4:7], s34 offen offset:2048
  buffer_load_dwordx4 v[172:175], v1, s[4:7], s34 offen offset:3072
  s_waitcnt vmcnt(20)
  s_mul_i32 s34, s15, 12
  s_mul_i32 s35, s16, 6
  s_add_u32 s34, s34, s35
  s_add_u32 s34, s34, 3
  s_mul_i32 s34, s34, 20480
  s_add_u32 s34, s34, 22020096
  buffer_load_dwordx4 v[176:179], v1, s[4:7], s34 offen offset:0
  buffer_load_dwordx4 v[180:183], v1, s[4:7], s34 offen offset:1024
  buffer_load_dwordx4 v[184:187], v1, s[4:7], s34 offen offset:2048
  buffer_load_dwordx4 v[188:191], v1, s[4:7], s34 offen offset:3072
  s_add_u32 s34, s34, 4096
  buffer_load_dwordx4 v[192:195], v1, s[4:7], s34 offen offset:0
  buffer_load_dwordx4 v[196:199], v1, s[4:7], s34 offen offset:1024
  buffer_load_dwordx4 v[200:203], v1, s[4:7], s34 offen offset:2048
  buffer_load_dwordx4 v[204:207], v1, s[4:7], s34 offen offset:3072
  s_add_u32 s34, s34, 4096
  buffer_load_dwordx4 v[208:211], v1, s[4:7], s34 offen offset:0
  buffer_load_dwordx4 v[212:215], v1, s[4:7], s34 offen offset:1024
  buffer_load_dwordx4 v[216:219], v1, s[4:7], s34 offen offset:2048
  buffer_load_dwordx4 v[220:223], v1, s[4:7], s34 offen offset:3072
  s_add_u32 s34, s34, 4096
  buffer_load_dwordx4 v[224:227], v1, s[4:7], s34 offen offset:0
  buffer_load_dwordx4 v[228:231], v1, s[4:7], s34 offen offset:1024
  buffer_load_dwordx4 v[232:235], v1, s[4:7], s34 offen offset:2048
  buffer_load_dwordx4 v[236:239], v1, s[4:7], s34 offen offset:3072
  s_add_u32 s34, s34, 4096
  buffer_load_dwordx4 v[240:243], v1, s[4:7], s34 offen offset:0
  buffer_load_dwordx4 v[244:247], v1, s[4:7], s34 offen offset:1024
  buffer_load_dwordx4 v[248:251], v1, s[4:7], s34 offen offset:2048
  buffer_load_dwordx4 v[252:255], v1, s[4:7], s34 offen offset:3072
  s_waitcnt vmcnt(20)
  v_and_b32 v30, 7, v0
  v_lshlrev_b32 v30, 3, v30
reca_cens243:
  buffer_load_dwordx2 v[28:29], v30, s[8:11], 0 offen sc1
  s_waitcnt vmcnt(0)
  v_sad_u8 v31, v28, 0, 0
  v_sad_u8 v31, v29, 0, v31
  v_cmp_gt_u32 vcc, 32, v31
  s_cbranch_vccz reca_censok244
  s_sleep 8
  s_sub_u32 s18, s18, 1
  s_cbranch_scc0 reca_cens243
  s_mov_b32 s18, 0
reca_censok244:
  v_and_b32 v28, 0x20202020, v28
  v_and_b32 v29, 0x20202020, v29
  v_cmp_ne_u32 s[34:35], 0, v28
  v_cmp_ne_u32 s[36:37], 0, v29
  s_nop 3
  s_and_b32 s34, s34, 0xff
  s_and_b32 s36, s36, 0xff
  s_or_b32 s35, s34, s36
  s_lshr_b32 s37, s35, s13
  s_and_b32 s37, s37, 1
  s_xor_b32 s43, s37, 1
  s_cmp_eq_u32 s57, 0
  s_cselect_b32 s58, s36, s34
  v_mov_b32 v31, 0x80000000
  s_cmp_lg_u32 s43, 0
  s_cbranch_scc1 reca_pslow245
reca_ptop246:
  s_cmp_lt_u32 s17, 3
  s_cbranch_scc1 reca_pgo247
  s_sub_u32 s36, s17, 3
reca_ppoll248:
  buffer_load_dword v28, v4, s[4:7], s25 offen sc1
  s_waitcnt vmcnt(0)
  v_readfirstlane_b32 s34, v28
  s_nop 3
  s_cmp_ge_i32 s34, s36
  s_cbranch_scc1 reca_pgo247
  s_sleep 8
  s_sub_u32 s18, s18, 1
  s_cbranch_scc0 reca_ppoll248
  s_mov_b32 s18, 0
reca_pgo247:
  s_waitcnt vmcnt(0)
  s_barrier
  v_add_u32 v7, s26, v1
  s_xor_b32 s26, s26, 40960
  s_add_u32 s37, s17, 1
  s_cmp_ge_u32 s37, 64
  s_cbranch_scc1 reca_pnodma249
  s_mul_i32 s20, s37, 40960
  s_add_u32 s20, s20, 84944896
  s_add_u32 m0, s26, 10240
  s_nop 0
  buffer_load_dwordx4 v1, s[4:7], s20 offen offset:0 lds
  buffer_load_dwordx4 v1, s[4:7], s20 offen offset:1024 lds
  buffer_load_dwordx4 v1, s[4:7], s20 offen offset:2048 lds
  buffer_load_dwordx4 v1, s[4:7], s20 offen offset:3072 lds
  s_add_u32 s20, s20, 4096
  s_add_u32 m0, s26, 14336
  s_nop 0
  buffer_load_dwordx4 v1, s[4:7], s20 offen offset:0 lds
  buffer_load_dwordx4 v1, s[4:7], s20 offen offset:1024 lds
  buffer_load_dwordx4 v1, s[4:7], s20 offen offset:2048 lds
  buffer_load_dwordx4 v1, s[4:7], s20 offen offset:3072 lds
  s_add_u32 s20, s20, 4096
  s_add_u32 m0, s26, 18432
  s_nop 0
  buffer_load_dwordx4 v1, s[4:7], s20 offen offset:0 lds
  buffer_load_dwordx4 v1, s[4:7], s20 offen offset:1024 lds
reca_pnodma249:
  s_lshl_b32 s34, s15, 3
  s_and_b32 s35, s17, 7
  s_add_u32 s34, s34, s35
  s_mul_i32 s34, s34, 12288
  s_mul_i32 s35, s16, 3072
  s_add_u32 s35, s35, s34
  s_add_u32 s21, s35, 37748736
  s_add_u32 s22, s35, 44040192
  s_mul_i32 s35, s16, 6144
  s_add_u32 s35, s35, s34
  s_add_u32 s23, s35, 40894464
  ds_read_b128 v[72:75], v7 offset:0
  ds_read_b128 v[76:79], v7 offset:20480
  ds_read_b128 v[80:83], v7 offset:1024
  ds_read_b128 v[84:87], v7 offset:21504
  ds_read_b128 v[88:91], v7 offset:2048
  ds_read_b128 v[92:95], v7 offset:22528
  s_waitcnt lgkmcnt(4)
  v_mfma_f32_16x16x32_bf16 v[32:35], a[0:3], v[72:75], 0
  v_mfma_f32_16x16x32_bf16 v[36:39], a[0:3], v[76:79], 0
  v_mfma_f32_16x16x32_bf16 v[40:43], a[80:83], v[72:75], 0
  v_mfma_f32_16x16x32_bf16 v[44:47], a[80:83], v[76:79], 0
  v_mfma_f32_16x16x32_bf16 v[48:51], v[72:75], a[160:163], 0
  v_mfma_f32_16x16x32_bf16 v[52:55], v[76:79], a[160:163], 0
  v_mfma_f32_16x16x32_bf16 v[56:59], v[72:75], v[96:99], 0
  v_mfma_f32_16x16x32_bf16 v[60:63], v[76:79], v[96:99], 0
  v_mfma_f32_16x16x32_bf16 v[64:67], v[72:75], v[176:179], 0
  v_mfma_f32_16x16x32_bf16 v[68:71], v[76:79], v[176:179], 0
  ds_read_b128 v[72:75], v7 offset:3072
  ds_read_b128 v[76:79], v7 offset:23552
  s_waitcnt lgkmcnt(4)
  v_mfma_f32_16x16x32_bf16 v[32:35], a[4:7], v[80:83], v[32:35]
  v_mfma_f32_16x16x32_bf16 v[36:39], a[4:7], v[84:87], v[36:39]
  v_mfma_f32_16x16x32_bf16 v[40:43], a[84:87], v[80:83], v[40:43]
  v_mfma_f32_16x16x32_bf16 v[44:47], a[84:87], v[84:87], v[44:47]
  v_mfma_f32_16x16x32_bf16 v[48:51], v[80:83], a[164:167], v[48:51]
  v_mfma_f32_16x16x32_bf16 v[52:55], v[84:87], a[164:167], v[52:55]
  v_mfma_f32_16x16x32_bf16 v[56:59], v[80:83], v[100:103], v[56:59]
  v_mfma_f32_16x16x32_bf16 v[60:63], v[84:87], v[100:103], v[60:63]
  v_mfma_f32_16x16x32_bf16 v[64:67], v[80:83], v[180:183], v[64:67]
  v_mfma_f32_16x16x32_bf16 v[68:71], v[84:87], v[180:183], v[68:71]
  ds_read_b128 v[80:83], v7 offset:4096
  ds_read_b128 v[84:87], v7 offset:24576
  s_waitcnt lgkmcnt(4)
  v_mfma_f32_16x16x32_bf16 v[32:35], a[8:11], v[88:91], v[32:35]
  v_mfma_f32_16x16x32_bf16 v[36:39], a[8:11], v[92:95], v[36:39]
  v_mfma_f32_16x16x32_bf16 v[40:43], a[88:91], v[88:91], v[40:43]
  v_mfma_f32_16x16x32_bf16 v[44:47], a[88:91], v[92:95], v[44:47]
  v_mfma_f32_16x16x32_bf16 v[48:51], v[88:91], a[168:171], v[48:51]
  v_mfma_f32_16x16x32_bf16 v[52:55], v[92:95], a[168:171], v[52:55]
  v_mfma_f32_16x16x32_bf16 v[56:59], v[88:91], v[104:107], v[56:59]
  v_mfma_f32_16x16x32_bf16 v[60:63], v[92:95], v[104:107], v[60:63]
  v_mfma_f32_16x16x32_bf16 v[64:67], v[88:91], v[184:187], v[64:67]
  v_mfma_f32_16x16x32_bf16 v[68:71], v[92:95], v[184:187], v[68:71]
  ds_read_b128 v[88:91], v7 offset:5120
  ds_read_b128 v[92:95], v7 offset:25600
  s_waitcnt lgkmcnt(4)
  v_mfma_f32_16x16x32_bf16 v[32:35], a[12:15], v[72:75], v[32:35]
  v_mfma_f32_16x16x32_bf16 v[36:39], a[12:15], v[76:79], v[36:39]
  v_mfma_f32_16x16x32_bf16 v[40:43], a[92:95], v[72:75], v[40:43]
  v_mfma_f32_16x16x32_bf16 v[44:47], a[92:95], v[76:79], v[44:47]
  v_mfma_f32_16x16x32_bf16 v[48:51], v[72:75], a[172:175], v[48:51]
  v_mfma_f32_16x16x32_bf16 v[52:55], v[76:79], a[172:175], v[52:55]
  v_mfma_f32_16x16x32_bf16 v[56:59], v[72:75], v[108:111], v[56:59]
  v_mfma_f32_16x16x32_bf16 v[60:63], v[76:79], v[108:111], v[60:63]
  v_mfma_f32_16x16x32_bf16 v[64:67], v[72:75], v[188:191], v[64:67]
  v_mfma_f32_16x16x32_bf16 v[68:71], v[76:79], v[188:191], v[68:71]
  ds_read_b128 v[72:75], v7 offset:6144
  ds_read_b128 v[76:79], v7 offset:26624
  s_waitcnt lgkmcnt(4)
  v_mfma_f32_16x16x32_bf16 v[32:35], a[16:19], v[80:83], v[32:35]
  v_mfma_f32_16x16x32_bf16 v[36:39], a[16:19], v[84:87], v[36:39]
  v_mfma_f32_16x16x32_bf16 v[40:43], a[96:99], v[80:83], v[40:43]
  v_mfma_f32_16x16x32_bf16 v[44:47], a[96:99], v[84:87], v[44:47]
  v_mfma_f32_16x16x32_bf16 v[48:51], v[80:83], a[176:179], v[48:51]
  v_mfma_f32_16x16x32_bf16 v[52:55], v[84:87], a[176:179], v[52:55]
  v_mfma_f32_16x16x32_bf16 v[56:59], v[80:83], v[112:115], v[56:59]
  v_mfma_f32_16x16x32_bf16 v[60:63], v[84:87], v[112:115], v[60:63]
  v_mfma_f32_16x16x32_bf16 v[64:67], v[80:83], v[192:195], v[64:67]
  v_mfma_f32_16x16x32_bf16 v[68:71], v[84:87], v[192:195], v[68:71]
  ds_read_b128 v[80:83], v7 offset:7168
  ds_read_b128 v[84:87], v7 offset:27648
  s_waitcnt lgkmcnt(4)
  v_mfma_f32_16x16x32_bf16 v[32:35], a[20:23], v[88:91], v[32:35]
  v_mfma_f32_16x16x32_bf16 v[36:39], a[20:23], v[92:95], v[36:39]
  v_mfma_f32_16x16x32_bf16 v[40:43], a[100:103], v[88:91], v[40:43]
  v_mfma_f32_16x16x32_bf16 v[44:47], a[100:103], v[92:95], v[44:47]
  v_mfma_f32_16x16x32_bf16 v[48:51], v[88:91], a[180:183], v[48:51]
  v_mfma_f32_16x16x32_bf16 v[52:55], v[92:95], a[180:183], v[52:55]
  v_mfma_f32_16x16x32_bf16 v[56:59], v[88:91], v[116:119], v[56:59]
  v_mfma_f32_16x16x32_bf16 v[60:63], v[92:95], v[116:119], v[60:63]
  v_mfma_f32_16x16x32_bf16 v[64:67], v[88:91], v[196:199], v[64:67]
  v_mfma_f32_16x16x32_bf16 v[68:71], v[92:95], v[196:199], v[68:71]
  ds_read_b128 v[88:91], v7 offset:8192
  ds_read_b128 v[92:95], v7 offset:28672
  s_waitcnt lgkmcnt(4)
  v_mfma_f32_16x16x32_bf16 v[32:35], a[24:27], v[72:75], v[32:35]
  v_mfma_f32_16x16x32_bf16 v[36:39], a[24:27], v[76:79], v[36:39]
  v_mfma_f32_16x16x32_bf16 v[40:43], a[104:107], v[72:75], v[40:43]
  v_mfma_f32_16x16x32_bf16 v[44:47], a[104:107], v[76:79], v[44:47]
  v_mfma_f32_16x16x32_bf16 v[48:51], v[72:75], a[184:187], v[48:51]
  v_mfma_f32_16x16x32_bf16 v[52:55], v[76:79], a[184:187], v[52:55]
  v_mfma_f32_16x16x32_bf16 v[56:59], v[72:75], v[120:123], v[56:59]
  v_mfma_f32_16x16x32_bf16 v[60:63], v[76:79], v[120:123], v[60:63]
  v_mfma_f32_16x16x32_bf16 v[64:67], v[72:75], v[200:203], v[64:67]
  v_mfma_f32_16x16x32_bf16 v[68:71], v[76:79], v[200:203], v[68:71]
  ds_read_b128 v[72:75], v7 offset:9216
  ds_read_b128 v[76:79], v7 offset:29696
  s_waitcnt lgkmcnt(4)
  v_mfma_f32_16x16x32_bf16 v[32:35], a[28:31], v[80:83], v[32:35]
  v_mfma_f32_16x16x32_bf16 v[36:39], a[28:31], v[84:87], v[36:39]
  v_mfma_f32_16x16x32_bf16 v[40:43], a[108:111], v[80:83], v[40:43]
  v_mfma_f32_16x16x32_bf16 v[44:47], a[108:111], v[84:87], v[44:47]
  v_mfma_f32_16x16x32_bf16 v[48:51], v[80:83], a[188:191], v[48:51]
  v_mfma_f32_16x16x32_bf16 v[52:55], v[84:87], a[188:191], v[52:55]
  v_mfma_f32_16x16x32_bf16 v[56:59], v[80:83], v[124:127], v[56:59]
  v_mfma_f32_16x16x32_bf16 v[60:63], v[84:87], v[124:127], v[60:63]
  v_mfma_f32_16x16x32_bf16 v[64:67], v[80:83], v[204:207], v[64:67]
  v_mfma_f32_16x16x32_bf16 v[68:71], v[84:87], v[204:207], v[68:71]
  ds_read_b128 v[80:83], v7 offset:10240
  ds_read_b128 v[84:87], v7 offset:30720
  s_waitcnt lgkmcnt(4)
  v_mfma_f32_16x16x32_bf16 v[32:35], a[32:35], v[88:91], v[32:35]
  v_mfma_f32_16x16x32_bf16 v[36:39], a[32:35], v[92:95], v[36:39]
  v_mfma_f32_16x16x32_bf16 v[40:43], a[112:115], v[88:91], v[40:43]
  v_mfma_f32_16x16x32_bf16 v[44:47], a[112:115], v[92:95], v[44:47]
  v_mfma_f32_16x16x32_bf16 v[48:51], v[88:91], a[192:195], v[48:51]
  v_mfma_f32_16x16x32_bf16 v[52:55], v[92:95], a[192:195], v[52:55]
  v_mfma_f32_16x16x32_bf16 v[56:59], v[88:91], v[128:131], v[56:59]
  v_mfma_f32_16x16x32_bf16 v[60:63], v[92:95], v[128:131], v[60:63]
  v_mfma_f32_16x16x32_bf16 v[64:67], v[88:91], v[208:211], v[64:67]
  v_mfma_f32_16x16x32_bf16 v[68:71], v[92:95], v[208:211], v[68:71]
  ds_read_b128 v[88:91], v7 offset:11264
  ds_read_b128 v[92:95], v7 offset:31744
  s_waitcnt lgkmcnt(4)
  v_mfma_f32_16x16x32_bf16 v[32:35], a[36:39], v[72:75], v[32:35]
  v_mfma_f32_16x16x32_bf16 v[36:39], a[36:39], v[76:79], v[36:39]
  v_mfma_f32_16x16x32_bf16 v[40:43], a[116:119], v[72:75], v[40:43]
  v_mfma_f32_16x16x32_bf16 v[44:47], a[116:119], v[76:79], v[44:47]
  v_mfma_f32_16x16x32_bf16 v[48:51], v[72:75], a[196:199], v[48:51]
  v_mfma_f32_16x16x32_bf16 v[52:55], v[76:79], a[196:199], v[52:55]
  v_mfma_f32_16x16x32_bf16 v[56:59], v[72:75], v[132:135], v[56:59]
  v_mfma_f32_16x16x32_bf16 v[60:63], v[76:79], v[132:135], v[60:63]
  v_mfma_f32_16x16x32_bf16 v[64:67], v[72:75], v[212:215], v[64:67]
  v_mfma_f32_16x16x32_bf16 v[68:71], v[76:79], v[212:215], v[68:71]
  ds_read_b128 v[72:75], v7 offset:12288
  ds_read_b128 v[76:79], v7 offset:32768
  s_waitcnt lgkmcnt(4)
  v_mfma_f32_16x16x32_bf16 v[32:35], a[40:43], v[80:83], v[32:35]
  v_mfma_f32_16x16x32_bf16 v[36:39], a[40:43], v[84:87], v[36:39]
  v_mfma_f32_16x16x32_bf16 v[40:43], a[120:123], v[80:83], v[40:43]
  v_mfma_f32_16x16x32_bf16 v[44:47], a[120:123], v[84:87], v[44:47]
  v_mfma_f32_16x16x32_bf16 v[48:51], v[80:83], a[200:203], v[48:51]
  v_mfma_f32_16x16x32_bf16 v[52:55], v[84:87], a[200:203], v[52:55]
  v_mfma_f32_16x16x32_bf16 v[56:59], v[80:83], v[136:139], v[56:59]
  v_mfma_f32_16x16x32_bf16 v[60:63], v[84:87], v[136:139], v[60:63]
  v_mfma_f32_16x16x32_bf16 v[64:67], v[80:83], v[216:219], v[64:67]
  v_mfma_f32_16x16x32_bf16 v[68:71], v[84:87], v[216:219], v[68:71]
  ds_read_b128 v[80:83], v7 offset:13312
  ds_read_b128 v[84:87], v7 offset:33792
  s_waitcnt lgkmcnt(4)
  v_mfma_f32_16x16x32_bf16 v[32:35], a[44:47], v[88:91], v[32:35]
  v_mfma_f32_16x16x32_bf16 v[36:39], a[44:47], v[92:95], v[36:39]
  v_mfma_f32_16x16x32_bf16 v[40:43], a[124:127], v[88:91], v[40:43]
  v_mfma_f32_16x16x32_bf16 v[44:47], a[124:127], v[92:95], v[44:47]
  v_mfma_f32_16x16x32_bf16 v[48:51], v[88:91], a[204:207], v[48:51]
  v_mfma_f32_16x16x32_bf16 v[52:55], v[92:95], a[204:207], v[52:55]
  v_mfma_f32_16x16x32_bf16 v[56:59], v[88:91], v[140:143], v[56:59]
  v_mfma_f32_16x16x32_bf16 v[60:63], v[92:95], v[140:143], v[60:63]
  v_mfma_f32_16x16x32_bf16 v[64:67], v[88:91], v[220:223], v[64:67]
  v_mfma_f32_16x16x32_bf16 v[68:71], v[92:95], v[220:223], v[68:71]
  ds_read_b128 v[88:91], v7 offset:14336
  ds_read_b128 v[92:95], v7 offset:34816
  s_waitcnt lgkmcnt(4)
  v_mfma_f32_16x16x32_bf16 v[32:35], a[48:51], v[72:75], v[32:35]
  v_mfma_f32_16x16x32_bf16 v[36:39], a[48:51], v[76:79], v[36:39]
  v_mfma_f32_16x16x32_bf16 v[40:43], a[128:131], v[72:75], v[40:43]
  v_mfma_f32_16x16x32_bf16 v[44:47], a[128:131], v[76:79], v[44:47]
  v_mfma_f32_16x16x32_bf16 v[48:51], v[72:75], a[208:211], v[48:51]
  v_mfma_f32_16x16x32_bf16 v[52:55], v[76:79], a[208:211], v[52:55]
  v_mfma_f32_16x16x32_bf16 v[56:59], v[72:75], v[144:147], v[56:59]
  v_mfma_f32_16x16x32_bf16 v[60:63], v[76:79], v[144:147], v[60:63]
  v_mfma_f32_16x16x32_bf16 v[64:67], v[72:75], v[224:227], v[64:67]
  v_mfma_f32_16x16x32_bf16 v[68:71], v[76:79], v[224:227], v[68:71]
  ds_read_b128 v[72:75], v7 offset:15360
  ds_read_b128 v[76:79], v7 offset:35840
  s_waitcnt lgkmcnt(4)
  v_mfma_f32_16x16x32_bf16 v[32:35], a[52:55], v[80:83], v[32:35]
  v_mfma_f32_16x16x32_bf16 v[36:39], a[52:55], v[84:87], v[36:39]
  v_mfma_f32_16x16x32_bf16 v[40:43], a[132:135], v[80:83], v[40:43]
  v_mfma_f32_16x16x32_bf16 v[44:47], a[132:135], v[84:87], v[44:47]
  v_mfma_f32_16x16x32_bf16 v[48:51], v[80:83], a[212:215], v[48:51]
  v_mfma_f32_16x16x32_bf16 v[52:55], v[84:87], a[212:215], v[52:55]
  v_mfma_f32_16x16x32_bf16 v[56:59], v[80:83], v[148:151], v[56:59]
  v_mfma_f32_16x16x32_bf16 v[60:63], v[84:87], v[148:151], v[60:63]
  v_mfma_f32_16x16x32_bf16 v[64:67], v[80:83], v[228:231], v[64:67]
  v_mfma_f32_16x16x32_bf16 v[68:71], v[84:87], v[228:231], v[68:71]
  ds_read_b128 v[80:83], v7 offset:16384
  ds_read_b128 v[84:87], v7 offset:36864
  s_waitcnt lgkmcnt(4)
  v_mfma_f32_16x16x32_bf16 v[32:35], a[56:59], v[88:91], v[32:35]
  v_mfma_f32_16x16x32_bf16 v[36:39], a[56:59], v[92:95], v[36:39]
  v_mfma_f32_16x16x32_bf16 v[40:43], a[136:139], v[88:91], v[40:43]
  v_mfma_f32_16x16x32_bf16 v[44:47], a[136:139], v[92:95], v[44:47]
  v_mfma_f32_16x16x32_bf16 v[48:51], v[88:91], a[216:219], v[48:51]
  v_mfma_f32_16x16x32_bf16 v[52:55], v[92:95], a[216:219], v[52:55]
  v_mfma_f32_16x16x32_bf16 v[56:59], v[88:91], v[152:155], v[56:59]
  v_mfma_f32_16x16x32_bf16 v[60:63], v[92:95], v[152:155], v[60:63]
  v_mfma_f32_16x16x32_bf16 v[64:67], v[88:91], v[232:235], v[64:67]
  v_mfma_f32_16x16x32_bf16 v[68:71], v[92:95], v[232:235], v[68:71]
  ds_read_b128 v[88:91], v7 offset:17408
  ds_read_b128 v[92:95], v7 offset:37888
  s_waitcnt lgkmcnt(4)
  v_mfma_f32_16x16x32_bf16 v[32:35], a[60:63], v[72:75], v[32:35]
  v_mfma_f32_16x16x32_bf16 v[36:39], a[60:63], v[76:79], v[36:39]
  v_mfma_f32_16x16x32_bf16 v[40:43], a[140:143], v[72:75], v[40:43]
  v_mfma_f32_16x16x32_bf16 v[44:47], a[140:143], v[76:79], v[44:47]
  v_mfma_f32_16x16x32_bf16 v[48:51], v[72:75], a[220:223], v[48:51]
  v_mfma_f32_16x16x32_bf16 v[52:55], v[76:79], a[220:223], v[52:55]
  v_mfma_f32_16x16x32_bf16 v[56:59], v[72:75], v[156:159], v[56:59]
  v_mfma_f32_16x16x32_bf16 v[60:63], v[76:79], v[156:159], v[60:63]
  v_mfma_f32_16x16x32_bf16 v[64:67], v[72:75], v[236:239], v[64:67]
  v_mfma_f32_16x16x32_bf16 v[68:71], v[76:79], v[236:239], v[68:71]
  ds_read_b128 v[72:75], v7 offset:18432
  ds_read_b128 v[76:79], v7 offset:38912
  s_waitcnt lgkmcnt(4)
  v_mfma_f32_16x16x32_bf16 v[32:35], a[64:67], v[80:83], v[32:35]
  v_mfma_f32_16x16x32_bf16 v[36:39], a[64:67], v[84:87], v[36:39]
  v_mfma_f32_16x16x32_bf16 v[40:43], a[144:147], v[80:83], v[40:43]
  v_mfma_f32_16x16x32_bf16 v[44:47], a[144:147], v[84:87], v[44:47]
  v_mfma_f32_16x16x32_bf16 v[48:51], v[80:83], a[224:227], v[48:51]
  v_mfma_f32_16x16x32_bf16 v[52:55], v[84:87], a[224:227], v[52:55]
  v_mfma_f32_16x16x32_bf16 v[56:59], v[80:83], v[160:163], v[56:59]
  v_mfma_f32_16x16x32_bf16 v[60:63], v[84:87], v[160:163], v[60:63]
  v_mfma_f32_16x16x32_bf16 v[64:67], v[80:83], v[240:243], v[64:67]
  v_mfma_f32_16x16x32_bf16 v[68:71], v[84:87], v[240:243], v[68:71]
  ds_read_b128 v[80:83], v7 offset:19456
  ds_read_b128 v[84:87], v7 offset:39936
  s_waitcnt lgkmcnt(4)
  v_mfma_f32_16x16x32_bf16 v[32:35], a[68:71], v[88:91], v[32:35]
  v_mfma_f32_16x16x32_bf16 v[36:39], a[68:71], v[92:95], v[36:39]
  v_mfma_f32_16x16x32_bf16 v[40:43], a[148:151], v[88:91], v[40:43]
  v_mfma_f32_16x16x32_bf16 v[44:47], a[148:151], v[92:95], v[44:47]
  v_mfma_f32_16x16x32_bf16 v[48:51], v[88:91], a[228:231], v[48:51]
  v_mfma_f32_16x16x32_bf16 v[52:55], v[92:95], a[228:231], v[52:55]
  v_mfma_f32_16x16x32_bf16 v[56:59], v[88:91], v[164:167], v[56:59]
  v_mfma_f32_16x16x32_bf16 v[60:63], v[92:95], v[164:167], v[60:63]
  v_mfma_f32_16x16x32_bf16 v[64:67], v[88:91], v[244:247], v[64:67]
  v_mfma_f32_16x16x32_bf16 v[68:71], v[92:95], v[244:247], v[68:71]
  s_waitcnt lgkmcnt(2)
  v_mfma_f32_16x16x32_bf16 v[32:35], a[72:75], v[72:75], v[32:35]
  v_mfma_f32_16x16x32_bf16 v[36:39], a[72:75], v[76:79], v[36:39]
  v_mfma_f32_16x16x32_bf16 v[40:43], a[152:155], v[72:75], v[40:43]
  v_mfma_f32_16x16x32_bf16 v[44:47], a[152:155], v[76:79], v[44:47]
  v_mfma_f32_16x16x32_bf16 v[48:51], v[72:75], a[232:235], v[48:51]
  v_mfma_f32_16x16x32_bf16 v[52:55], v[76:79], a[232:235], v[52:55]
  v_mfma_f32_16x16x32_bf16 v[56:59], v[72:75], v[168:171], v[56:59]
  v_mfma_f32_16x16x32_bf16 v[60:63], v[76:79], v[168:171], v[60:63]
  v_mfma_f32_16x16x32_bf16 v[64:67], v[72:75], v[248:251], v[64:67]
  v_mfma_f32_16x16x32_bf16 v[68:71], v[76:79], v[248:251], v[68:71]
  s_waitcnt lgkmcnt(0)
  v_mfma_f32_16x16x32_bf16 v[32:35], a[76:79], v[80:83], v[32:35]
  v_mfma_f32_16x16x32_bf16 v[36:39], a[76:79], v[84:87], v[36:39]
  v_mfma_f32_16x16x32_bf16 v[40:43], a[156:159], v[80:83], v[40:43]
  v_mfma_f32_16x16x32_bf16 v[44:47], a[156:159], v[84:87], v[44:47]
  v_mfma_f32_16x16x32_bf16 v[48:51], v[80:83], a[236:239], v[48:51]
  v_mfma_f32_16x16x32_bf16 v[52:55], v[84:87], a[236:239], v[52:55]
  v_mfma_f32_16x16x32_bf16 v[56:59], v[80:83], v[172:175], v[56:59]
  v_mfma_f32_16x16x32_bf16 v[60:63], v[84:87], v[172:175], v[60:63]
  v_mfma_f32_16x16x32_bf16 v[64:67], v[80:83], v[252:255], v[64:67]
  v_mfma_f32_16x16x32_bf16 v[68:71], v[84:87], v[252:255], v[68:71]
  v_cvt_pk_bf16_f32 v8, v32, v33
  v_cvt_pk_bf16_f32 v9, v34, v35
  v_cvt_pk_bf16_f32 v10, v40, v41
  v_cvt_pk_bf16_f32 v11, v42, v43
  s_add_u32 s34, s21, 2048
  buffer_store_dwordx4 v[8:11], v1, s[4:7], s34 offen
  v_cvt_pk_bf16_f32 v12, v36, v37
  v_cvt_pk_bf16_f32 v13, v38, v39
  v_cvt_pk_bf16_f32 v14, v44, v45
  v_cvt_pk_bf16_f32 v15, v46, v47
  s_add_u32 s34, s21, 8192
  buffer_store_dwordx4 v[12:15], v1, s[4:7], s34 offen
  v_cvt_pk_bf16_f32 v8, v48, v49
  v_cvt_pk_bf16_f32 v9, v50, v51
  v_cvt_pk_bf16_f32 v10, v52, v53
  v_cvt_pk_bf16_f32 v11, v54, v55
  s_add_u32 s34, s23, 1024
  buffer_store_dwordx4 v[8:11], v1, s[4:7], s34 offen
  v_cvt_pk_bf16_f32 v12, v56, v57
  v_cvt_pk_bf16_f32 v13, v58, v59
  v_cvt_pk_bf16_f32 v14, v60, v61
  v_cvt_pk_bf16_f32 v15, v62, v63
  s_add_u32 s34, s23, 2048
  buffer_store_dwordx4 v[12:15], v1, s[4:7], s34 offen
  v_cvt_pk_bf16_f32 v8, v64, v65
  v_cvt_pk_bf16_f32 v9, v66, v67
  v_cvt_pk_bf16_f32 v10, v68, v69
  v_cvt_pk_bf16_f32 v11, v70, v71
  s_add_u32 s34, s23, 3072
  buffer_store_dwordx4 v[8:11], v1, s[4:7], s34 offen
  s_waitcnt vmcnt(0)
  s_barrier
  s_add_u32 s17, s17, 1
  s_cmp_lt_u32 s17, 64
  s_cbranch_scc1 reca_ptop246
  s_branch reca_exit1
reca_pslow245:
reca_ptop251:
  s_cmp_lt_u32 s17, 3
  s_cbranch_scc1 reca_pgo252
  s_sub_u32 s36, s17, 3
reca_ppoll253:
  buffer_load_dword v28, v4, s[4:7], s25 offen sc1
  s_waitcnt vmcnt(0)
  v_readfirstlane_b32 s34, v28
  s_nop 3
  s_cmp_ge_i32 s34, s36
  s_cbranch_scc1 reca_pgo252
  s_sleep 8
  s_sub_u32 s18, s18, 1
  s_cbranch_scc0 reca_ppoll253
  s_mov_b32 s18, 0
reca_pgo252:
  s_waitcnt vmcnt(0)
  s_barrier
  v_add_u32 v7, s26, v1
  s_xor_b32 s26, s26, 40960
  s_add_u32 s37, s17, 1
  s_cmp_ge_u32 s37, 64
  s_cbranch_scc1 reca_pnodma254
  s_mul_i32 s20, s37, 40960
  s_add_u32 s20, s20, 84944896
  s_add_u32 m0, s26, 10240
  s_nop 0
  buffer_load_dwordx4 v1, s[4:7], s20 offen offset:0 lds
  buffer_load_dwordx4 v1, s[4:7], s20 offen offset:1024 lds
  buffer_load_dwordx4 v1, s[4:7], s20 offen offset:2048 lds
  buffer_load_dwordx4 v1, s[4:7], s20 offen offset:3072 lds
  s_add_u32 s20, s20, 4096
  s_add_u32 m0, s26, 14336
  s_nop 0
  buffer_load_dwordx4 v1, s[4:7], s20 offen offset:0 lds
  buffer_load_dwordx4 v1, s[4:7], s20 offen offset:1024 lds
  buffer_load_dwordx4 v1, s[4:7], s20 offen offset:2048 lds
  buffer_load_dwordx4 v1, s[4:7], s20 offen offset:3072 lds
  s_add_u32 s20, s20, 4096
  s_add_u32 m0, s26, 18432
  s_nop 0
  buffer_load_dwordx4 v1, s[4:7], s20 offen offset:0 lds
  buffer_load_dwordx4 v1, s[4:7], s20 offen offset:1024 lds
reca_pnodma254:
  s_lshl_b32 s34, s15, 3
  s_and_b32 s35, s17, 7
  s_add_u32 s34, s34, s35
  s_mul_i32 s34, s34, 12288
  s_mul_i32 s35, s16, 3072
  s_add_u32 s35, s35, s34
  s_add_u32 s21, s35, 37748736
  s_add_u32 s22, s35, 44040192
  s_mul_i32 s35, s16, 6144
  s_add_u32 s35, s35, s34
  s_add_u32 s23, s35, 40894464
  ds_read_b128 v[72:75], v7 offset:0
  ds_read_b128 v[76:79], v7 offset:20480
  ds_read_b128 v[80:83], v7 offset:1024
  ds_read_b128 v[84:87], v7 offset:21504
  ds_read_b128 v[88:91], v7 offset:2048
  ds_read_b128 v[92:95], v7 offset:22528
  s_waitcnt lgkmcnt(4)
  v_mfma_f32_16x16x32_bf16 v[32:35], a[0:3], v[72:75], 0
  v_mfma_f32_16x16x32_bf16 v[36:39], a[0:3], v[76:79], 0
  v_mfma_f32_16x16x32_bf16 v[40:43], a[80:83], v[72:75], 0
  v_mfma_f32_16x16x32_bf16 v[44:47], a[80:83], v[76:79], 0
  v_mfma_f32_16x16x32_bf16 v[48:51], v[72:75], a[160:163], 0
  v_mfma_f32_16x16x32_bf16 v[52:55], v[76:79], a[160:163], 0
  v_mfma_f32_16x16x32_bf16 v[56:59], v[72:75], v[96:99], 0
  v_mfma_f32_16x16x32_bf16 v[60:63], v[76:79], v[96:99], 0
  v_mfma_f32_16x16x32_bf16 v[64:67], v[72:75], v[176:179], 0
  v_mfma_f32_16x16x32_bf16 v[68:71], v[76:79], v[176:179], 0
  ds_read_b128 v[72:75], v7 offset:3072
  ds_read_b128 v[76:79], v7 offset:23552
  s_waitcnt lgkmcnt(4)
  v_mfma_f32_16x16x32_bf16 v[32:35], a[4:7], v[80:83], v[32:35]
  v_mfma_f32_16x16x32_bf16 v[36:39], a[4:7], v[84:87], v[36:39]
  v_mfma_f32_16x16x32_bf16 v[40:43], a[84:87], v[80:83], v[40:43]
  v_mfma_f32_16x16x32_bf16 v[44:47], a[84:87], v[84:87], v[44:47]
  v_mfma_f32_16x16x32_bf16 v[48:51], v[80:83], a[164:167], v[48:51]
  v_mfma_f32_16x16x32_bf16 v[52:55], v[84:87], a[164:167], v[52:55]
  v_mfma_f32_16x16x32_bf16 v[56:59], v[80:83], v[100:103], v[56:59]
  v_mfma_f32_16x16x32_bf16 v[60:63], v[84:87], v[100:103], v[60:63]
  v_mfma_f32_16x16x32_bf16 v[64:67], v[80:83], v[180:183], v[64:67]
  v_mfma_f32_16x16x32_bf16 v[68:71], v[84:87], v[180:183], v[68:71]
  ds_read_b128 v[80:83], v7 offset:4096
  ds_read_b128 v[84:87], v7 offset:24576
  s_waitcnt lgkmcnt(4)
  v_mfma_f32_16x16x32_bf16 v[32:35], a[8:11], v[88:91], v[32:35]
  v_mfma_f32_16x16x32_bf16 v[36:39], a[8:11], v[92:95], v[36:39]
  v_mfma_f32_16x16x32_bf16 v[40:43], a[88:91], v[88:91], v[40:43]
  v_mfma_f32_16x16x32_bf16 v[44:47], a[88:91], v[92:95], v[44:47]
  v_mfma_f32_16x16x32_bf16 v[48:51], v[88:91], a[168:171], v[48:51]
  v_mfma_f32_16x16x32_bf16 v[52:55], v[92:95], a[168:171], v[52:55]
  v_mfma_f32_16x16x32_bf16 v[56:59], v[88:91], v[104:107], v[56:59]
  v_mfma_f32_16x16x32_bf16 v[60:63], v[92:95], v[104:107], v[60:63]
  v_mfma_f32_16x16x32_bf16 v[64:67], v[88:91], v[184:187], v[64:67]
  v_mfma_f32_16x16x32_bf16 v[68:71], v[92:95], v[184:187], v[68:71]
  ds_read_b128 v[88:91], v7 offset:5120
  ds_read_b128 v[92:95], v7 offset:25600
  s_waitcnt lgkmcnt(4)
  v_mfma_f32_16x16x32_bf16 v[32:35], a[12:15], v[72:75], v[32:35]
  v_mfma_f32_16x16x32_bf16 v[36:39], a[12:15], v[76:79], v[36:39]
  v_mfma_f32_16x16x32_bf16 v[40:43], a[92:95], v[72:75], v[40:43]
  v_mfma_f32_16x16x32_bf16 v[44:47], a[92:95], v[76:79], v[44:47]
  v_mfma_f32_16x16x32_bf16 v[48:51], v[72:75], a[172:175], v[48:51]
  v_mfma_f32_16x16x32_bf16 v[52:55], v[76:79], a[172:175], v[52:55]
  v_mfma_f32_16x16x32_bf16 v[56:59], v[72:75], v[108:111], v[56:59]
  v_mfma_f32_16x16x32_bf16 v[60:63], v[76:79], v[108:111], v[60:63]
  v_mfma_f32_16x16x32_bf16 v[64:67], v[72:75], v[188:191], v[64:67]
  v_mfma_f32_16x16x32_bf16 v[68:71], v[76:79], v[188:191], v[68:71]
  ds_read_b128 v[72:75], v7 offset:6144
  ds_read_b128 v[76:79], v7 offset:26624
  s_waitcnt lgkmcnt(4)
  v_mfma_f32_16x16x32_bf16 v[32:35], a[16:19], v[80:83], v[32:35]
  v_mfma_f32_16x16x32_bf16 v[36:39], a[16:19], v[84:87], v[36:39]
  v_mfma_f32_16x16x32_bf16 v[40:43], a[96:99], v[80:83], v[40:43]
  v_mfma_f32_16x16x32_bf16 v[44:47], a[96:99], v[84:87], v[44:47]
  v_mfma_f32_16x16x32_bf16 v[48:51], v[80:83], a[176:179], v[48:51]
  v_mfma_f32_16x16x32_bf16 v[52:55], v[84:87], a[176:179], v[52:55]
  v_mfma_f32_16x16x32_bf16 v[56:59], v[80:83], v[112:115], v[56:59]
  v_mfma_f32_16x16x32_bf16 v[60:63], v[84:87], v[112:115], v[60:63]
  v_mfma_f32_16x16x32_bf16 v[64:67], v[80:83], v[192:195], v[64:67]
  v_mfma_f32_16x16x32_bf16 v[68:71], v[84:87], v[192:195], v[68:71]
  ds_read_b128 v[80:83], v7 offset:7168
  ds_read_b128 v[84:87], v7 offset:27648
  s_waitcnt lgkmcnt(4)
  v_mfma_f32_16x16x32_bf16 v[32:35], a[20:23], v[88:91], v[32:35]
  v_mfma_f32_16x16x32_bf16 v[36:39], a[20:23], v[92:95], v[36:39]
  v_mfma_f32_16x16x32_bf16 v[40:43], a[100:103], v[88:91], v[40:43]
  v_mfma_f32_16x16x32_bf16 v[44:47], a[100:103], v[92:95], v[44:47]
  v_mfma_f32_16x16x32_bf16 v[48:51], v[88:91], a[180:183], v[48:51]
  v_mfma_f32_16x16x32_bf16 v[52:55], v[92:95], a[180:183], v[52:55]
  v_mfma_f32_16x16x32_bf16 v[56:59], v[88:91], v[116:119], v[56:59]
  v_mfma_f32_16x16x32_bf16 v[60:63], v[92:95], v[116:119], v[60:63]
  v_mfma_f32_16x16x32_bf16 v[64:67], v[88:91], v[196:199], v[64:67]
  v_mfma_f32_16x16x32_bf16 v[68:71], v[92:95], v[196:199], v[68:71]
  ds_read_b128 v[88:91], v7 offset:8192
  ds_read_b128 v[92:95], v7 offset:28672
  s_waitcnt lgkmcnt(4)
  v_mfma_f32_16x16x32_bf16 v[32:35], a[24:27], v[72:75], v[32:35]
  v_mfma_f32_16x16x32_bf16 v[36:39], a[24:27], v[76:79], v[36:39]
  v_mfma_f32_16x16x32_bf16 v[40:43], a[104:107], v[72:75], v[40:43]
  v_mfma_f32_16x16x32_bf16 v[44:47], a[104:107], v[76:79], v[44:47]
  v_mfma_f32_16x16x32_bf16 v[48:51], v[72:75], a[184:187], v[48:51]
  v_mfma_f32_16x16x32_bf16 v[52:55], v[76:79], a[184:187], v[52:55]
  v_mfma_f32_16x16x32_bf16 v[56:59], v[72:75], v[120:123], v[56:59]
  v_mfma_f32_16x16x32_bf16 v[60:63], v[76:79], v[120:123], v[60:63]
  v_mfma_f32_16x16x32_bf16 v[64:67], v[72:75], v[200:203], v[64:67]
  v_mfma_f32_16x16x32_bf16 v[68:71], v[76:79], v[200:203], v[68:71]
  ds_read_b128 v[72:75], v7 offset:9216
  ds_read_b128 v[76:79], v7 offset:29696
  s_waitcnt lgkmcnt(4)
  v_mfma_f32_16x16x32_bf16 v[32:35], a[28:31], v[80:83], v[32:35]
  v_mfma_f32_16x16x32_bf16 v[36:39], a[28:31], v[84:87], v[36:39]
  v_mfma_f32_16x16x32_bf16 v[40:43], a[108:111], v[80:83], v[40:43]
  v_mfma_f32_16x16x32_bf16 v[44:47], a[108:111], v[84:87], v[44:47]
  v_mfma_f32_16x16x32_bf16 v[48:51], v[80:83], a[188:191], v[48:51]
  v_mfma_f32_16x16x32_bf16 v[52:55], v[84:87], a[188:191], v[52:55]
  v_mfma_f32_16x16x32_bf16 v[56:59], v[80:83], v[124:127], v[56:59]
  v_mfma_f32_16x16x32_bf16 v[60:63], v[84:87], v[124:127], v[60:63]
  v_mfma_f32_16x16x32_bf16 v[64:67], v[80:83], v[204:207], v[64:67]
  v_mfma_f32_16x16x32_bf16 v[68:71], v[84:87], v[204:207], v[68:71]
  ds_read_b128 v[80:83], v7 offset:10240
  ds_read_b128 v[84:87], v7 offset:30720
  s_waitcnt lgkmcnt(4)
  v_mfma_f32_16x16x32_bf16 v[32:35], a[32:35], v[88:91], v[32:35]
  v_mfma_f32_16x16x32_bf16 v[36:39], a[32:35], v[92:95], v[36:39]
  v_mfma_f32_16x16x32_bf16 v[40:43], a[112:115], v[88:91], v[40:43]
  v_mfma_f32_16x16x32_bf16 v[44:47], a[112:115], v[92:95], v[44:47]
  v_mfma_f32_16x16x32_bf16 v[48:51], v[88:91], a[192:195], v[48:51]
  v_mfma_f32_16x16x32_bf16 v[52:55], v[92:95], a[192:195], v[52:55]
  v_mfma_f32_16x16x32_bf16 v[56:59], v[88:91], v[128:131], v[56:59]
  v_mfma_f32_16x16x32_bf16 v[60:63], v[92:95], v[128:131], v[60:63]
  v_mfma_f32_16x16x32_bf16 v[64:67], v[88:91], v[208:211], v[64:67]
  v_mfma_f32_16x16x32_bf16 v[68:71], v[92:95], v[208:211], v[68:71]
  ds_read_b128 v[88:91], v7 offset:11264
  ds_read_b128 v[92:95], v7 offset:31744
  s_waitcnt lgkmcnt(4)
  v_mfma_f32_16x16x32_bf16 v[32:35], a[36:39], v[72:75], v[32:35]
  v_mfma_f32_16x16x32_bf16 v[36:39], a[36:39], v[76:79], v[36:39]
  v_mfma_f32_16x16x32_bf16 v[40:43], a[116:119], v[72:75], v[40:43]
  v_mfma_f32_16x16x32_bf16 v[44:47], a[116:119], v[76:79], v[44:47]
  v_mfma_f32_16x16x32_bf16 v[48:51], v[72:75], a[196:199], v[48:51]
  v_mfma_f32_16x16x32_bf16 v[52:55], v[76:79], a[196:199], v[52:55]
  v_mfma_f32_16x16x32_bf16 v[56:59], v[72:75], v[132:135], v[56:59]
  v_mfma_f32_16x16x32_bf16 v[60:63], v[76:79], v[132:135], v[60:63]
  v_mfma_f32_16x16x32_bf16 v[64:67], v[72:75], v[212:215], v[64:67]
  v_mfma_f32_16x16x32_bf16 v[68:71], v[76:79], v[212:215], v[68:71]
  ds_read_b128 v[72:75], v7 offset:12288
  ds_read_b128 v[76:79], v7 offset:32768
  s_waitcnt lgkmcnt(4)
  v_mfma_f32_16x16x32_bf16 v[32:35], a[40:43], v[80:83], v[32:35]
  v_mfma_f32_16x16x32_bf16 v[36:39], a[40:43], v[84:87], v[36:39]
  v_mfma_f32_16x16x32_bf16 v[40:43], a[120:123], v[80:83], v[40:43]
  v_mfma_f32_16x16x32_bf16 v[44:47], a[120:123], v[84:87], v[44:47]
  v_mfma_f32_16x16x32_bf16 v[48:51], v[80:83], a[200:203], v[48:51]
  v_mfma_f32_16x16x32_bf16 v[52:55], v[84:87], a[200:203], v[52:55]
  v_mfma_f32_16x16x32_bf16 v[56:59], v[80:83], v[136:139], v[56:59]
  v_mfma_f32_16x16x32_bf16 v[60:63], v[84:87], v[136:139], v[60:63]
  v_mfma_f32_16x16x32_bf16 v[64:67], v[80:83], v[216:219], v[64:67]
  v_mfma_f32_16x16x32_bf16 v[68:71], v[84:87], v[216:219], v[68:71]
  ds_read_b128 v[80:83], v7 offset:13312
  ds_read_b128 v[84:87], v7 offset:33792
  s_waitcnt lgkmcnt(4)
  v_mfma_f32_16x16x32_bf16 v[32:35], a[44:47], v[88:91], v[32:35]
  v_mfma_f32_16x16x32_bf16 v[36:39], a[44:47], v[92:95], v[36:39]
  v_mfma_f32_16x16x32_bf16 v[40:43], a[124:127], v[88:91], v[40:43]
  v_mfma_f32_16x16x32_bf16 v[44:47], a[124:127], v[92:95], v[44:47]
  v_mfma_f32_16x16x32_bf16 v[48:51], v[88:91], a[204:207], v[48:51]
  v_mfma_f32_16x16x32_bf16 v[52:55], v[92:95], a[204:207], v[52:55]
  v_mfma_f32_16x16x32_bf16 v[56:59], v[88:91], v[140:143], v[56:59]
  v_mfma_f32_16x16x32_bf16 v[60:63], v[92:95], v[140:143], v[60:63]
  v_mfma_f32_16x16x32_bf16 v[64:67], v[88:91], v[220:223], v[64:67]
  v_mfma_f32_16x16x32_bf16 v[68:71], v[92:95], v[220:223], v[68:71]
  ds_read_b128 v[88:91], v7 offset:14336
  ds_read_b128 v[92:95], v7 offset:34816
  s_waitcnt lgkmcnt(4)
  v_mfma_f32_16x16x32_bf16 v[32:35], a[48:51], v[72:75], v[32:35]
  v_mfma_f32_16x16x32_bf16 v[36:39], a[48:51], v[76:79], v[36:39]
  v_mfma_f32_16x16x32_bf16 v[40:43], a[128:131], v[72:75], v[40:43]
  v_mfma_f32_16x16x32_bf16 v[44:47], a[128:131], v[76:79], v[44:47]
  v_mfma_f32_16x16x32_bf16 v[48:51], v[72:75], a[208:211], v[48:51]
  v_mfma_f32_16x16x32_bf16 v[52:55], v[76:79], a[208:211], v[52:55]
  v_mfma_f32_16x16x32_bf16 v[56:59], v[72:75], v[144:147], v[56:59]
  v_mfma_f32_16x16x32_bf16 v[60:63], v[76:79], v[144:147], v[60:63]
  v_mfma_f32_16x16x32_bf16 v[64:67], v[72:75], v[224:227], v[64:67]
  v_mfma_f32_16x16x32_bf16 v[68:71], v[76:79], v[224:227], v[68:71]
  ds_read_b128 v[72:75], v7 offset:15360
  ds_read_b128 v[76:79], v7 offset:35840
  s_waitcnt lgkmcnt(4)
  v_mfma_f32_16x16x32_bf16 v[32:35], a[52:55], v[80:83], v[32:35]
  v_mfma_f32_16x16x32_bf16 v[36:39], a[52:55], v[84:87], v[36:39]
  v_mfma_f32_16x16x32_bf16 v[40:43], a[132:135], v[80:83], v[40:43]
  v_mfma_f32_16x16x32_bf16 v[44:47], a[132:135], v[84:87], v[44:47]
  v_mfma_f32_16x16x32_bf16 v[48:51], v[80:83], a[212:215], v[48:51]
  v_mfma_f32_16x16x32_bf16 v[52:55], v[84:87], a[212:215], v[52:55]
  v_mfma_f32_16x16x32_bf16 v[56:59], v[80:83], v[148:151], v[56:59]
  v_mfma_f32_16x16x32_bf16 v[60:63], v[84:87], v[148:151], v[60:63]
  v_mfma_f32_16x16x32_bf16 v[64:67], v[80:83], v[228:231], v[64:67]
  v_mfma_f32_16x16x32_bf16 v[68:71], v[84:87], v[228:231], v[68:71]
  ds_read_b128 v[80:83], v7 offset:16384
  ds_read_b128 v[84:87], v7 offset:36864
  s_waitcnt lgkmcnt(4)
  v_mfma_f32_16x16x32_bf16 v[32:35], a[56:59], v[88:91], v[32:35]
  v_mfma_f32_16x16x32_bf16 v[36:39], a[56:59], v[92:95], v[36:39]
  v_mfma_f32_16x16x32_bf16 v[40:43], a[136:139], v[88:91], v[40:43]
  v_mfma_f32_16x16x32_bf16 v[44:47], a[136:139], v[92:95], v[44:47]
  v_mfma_f32_16x16x32_bf16 v[48:51], v[88:91], a[216:219], v[48:51]
  v_mfma_f32_16x16x32_bf16 v[52:55], v[92:95], a[216:219], v[52:55]
  v_mfma_f32_16x16x32_bf16 v[56:59], v[88:91], v[152:155], v[56:59]
  v_mfma_f32_16x16x32_bf16 v[60:63], v[92:95], v[152:155], v[60:63]
  v_mfma_f32_16x16x32_bf16 v[64:67], v[88:91], v[232:235], v[64:67]
  v_mfma_f32_16x16x32_bf16 v[68:71], v[92:95], v[232:235], v[68:71]
  ds_read_b128 v[88:91], v7 offset:17408
  ds_read_b128 v[92:95], v7 offset:37888
  s_waitcnt lgkmcnt(4)
  v_mfma_f32_16x16x32_bf16 v[32:35], a[60:63], v[72:75], v[32:35]
  v_mfma_f32_16x16x32_bf16 v[36:39], a[60:63], v[76:79], v[36:39]
  v_mfma_f32_16x16x32_bf16 v[40:43], a[140:143], v[72:75], v[40:43]
  v_mfma_f32_16x16x32_bf16 v[44:47], a[140:143], v[76:79], v[44:47]
  v_mfma_f32_16x16x32_bf16 v[48:51], v[72:75], a[220:223], v[48:51]
  v_mfma_f32_16x16x32_bf16 v[52:55], v[76:79], a[220:223], v[52:55]
  v_mfma_f32_16x16x32_bf16 v[56:59], v[72:75], v[156:159], v[56:59]
  v_mfma_f32_16x16x32_bf16 v[60:63], v[76:79], v[156:159], v[60:63]
  v_mfma_f32_16x16x32_bf16 v[64:67], v[72:75], v[236:239], v[64:67]
  v_mfma_f32_16x16x32_bf16 v[68:71], v[76:79], v[236:239], v[68:71]
  ds_read_b128 v[72:75], v7 offset:18432
  ds_read_b128 v[76:79], v7 offset:38912
  s_waitcnt lgkmcnt(4)
  v_mfma_f32_16x16x32_bf16 v[32:35], a[64:67], v[80:83], v[32:35]
  v_mfma_f32_16x16x32_bf16 v[36:39], a[64:67], v[84:87], v[36:39]
  v_mfma_f32_16x16x32_bf16 v[40:43], a[144:147], v[80:83], v[40:43]
  v_mfma_f32_16x16x32_bf16 v[44:47], a[144:147], v[84:87], v[44:47]
  v_mfma_f32_16x16x32_bf16 v[48:51], v[80:83], a[224:227], v[48:51]
  v_mfma_f32_16x16x32_bf16 v[52:55], v[84:87], a[224:227], v[52:55]
  v_mfma_f32_16x16x32_bf16 v[56:59], v[80:83], v[160:163], v[56:59]
  v_mfma_f32_16x16x32_bf16 v[60:63], v[84:87], v[160:163], v[60:63]
  v_mfma_f32_16x16x32_bf16 v[64:67], v[80:83], v[240:243], v[64:67]
  v_mfma_f32_16x16x32_bf16 v[68:71], v[84:87], v[240:243], v[68:71]
  ds_read_b128 v[80:83], v7 offset:19456
  ds_read_b128 v[84:87], v7 offset:39936
  s_waitcnt lgkmcnt(4)
  v_mfma_f32_16x16x32_bf16 v[32:35], a[68:71], v[88:91], v[32:35]
  v_mfma_f32_16x16x32_bf16 v[36:39], a[68:71], v[92:95], v[36:39]
  v_mfma_f32_16x16x32_bf16 v[40:43], a[148:151], v[88:91], v[40:43]
  v_mfma_f32_16x16x32_bf16 v[44:47], a[148:151], v[92:95], v[44:47]
  v_mfma_f32_16x16x32_bf16 v[48:51], v[88:91], a[228:231], v[48:51]
  v_mfma_f32_16x16x32_bf16 v[52:55], v[92:95], a[228:231], v[52:55]
  v_mfma_f32_16x16x32_bf16 v[56:59], v[88:91], v[164:167], v[56:59]
  v_mfma_f32_16x16x32_bf16 v[60:63], v[92:95], v[164:167], v[60:63]
  v_mfma_f32_16x16x32_bf16 v[64:67], v[88:91], v[244:247], v[64:67]
  v_mfma_f32_16x16x32_bf16 v[68:71], v[92:95], v[244:247], v[68:71]
  s_waitcnt lgkmcnt(2)
  v_mfma_f32_16x16x32_bf16 v[32:35], a[72:75], v[72:75], v[32:35]
  v_mfma_f32_16x16x32_bf16 v[36:39], a[72:75], v[76:79], v[36:39]
  v_mfma_f32_16x16x32_bf16 v[40:43], a[152:155], v[72:75], v[40:43]
  v_mfma_f32_16x16x32_bf16 v[44:47], a[152:155], v[76:79], v[44:47]
  v_mfma_f32_16x16x32_bf16 v[48:51], v[72:75], a[232:235], v[48:51]
  v_mfma_f32_16x16x32_bf16 v[52:55], v[76:79], a[232:235], v[52:55]
  v_mfma_f32_16x16x32_bf16 v[56:59], v[72:75], v[168:171], v[56:59]
  v_mfma_f32_16x16x32_bf16 v[60:63], v[76:79], v[168:171], v[60:63]
  v_mfma_f32_16x16x32_bf16 v[64:67], v[72:75], v[248:251], v[64:67]
  v_mfma_f32_16x16x32_bf16 v[68:71], v[76:79], v[248:251], v[68:71]
  s_waitcnt lgkmcnt(0)
  v_mfma_f32_16x16x32_bf16 v[32:35], a[76:79], v[80:83], v[32:35]
  v_mfma_f32_16x16x32_bf16 v[36:39], a[76:79], v[84:87], v[36:39]
  v_mfma_f32_16x16x32_bf16 v[40:43], a[156:159], v[80:83], v[40:43]
  v_mfma_f32_16x16x32_bf16 v[44:47], a[156:159], v[84:87], v[44:47]
  v_mfma_f32_16x16x32_bf16 v[48:51], v[80:83], a[236:239], v[48:51]
  v_mfma_f32_16x16x32_bf16 v[52:55], v[84:87], a[236:239], v[52:55]
  v_mfma_f32_16x16x32_bf16 v[56:59], v[80:83], v[172:175], v[56:59]
  v_mfma_f32_16x16x32_bf16 v[60:63], v[84:87], v[172:175], v[60:63]
  v_mfma_f32_16x16x32_bf16 v[64:67], v[80:83], v[252:255], v[64:67]
  v_mfma_f32_16x16x32_bf16 v[68:71], v[84:87], v[252:255], v[68:71]
  v_cvt_pk_bf16_f32 v8, v32, v33
  v_cvt_pk_bf16_f32 v9, v34, v35
  v_cvt_pk_bf16_f32 v10, v40, v41
  v_cvt_pk_bf16_f32 v11, v42, v43
  s_add_u32 s34, s21, 2048
  buffer_store_dwordx4 v[8:11], v1, s[4:7], s34 offen sc1
  v_cvt_pk_bf16_f32 v12, v36, v37
  v_cvt_pk_bf16_f32 v13, v38, v39
  v_cvt_pk_bf16_f32 v14, v44, v45
  v_cvt_pk_bf16_f32 v15, v46, v47
  s_add_u32 s34, s21, 8192
  buffer_store_dwordx4 v[12:15], v1, s[4:7], s34 offen sc1
  v_cvt_pk_bf16_f32 v8, v48, v49
  v_cvt_pk_bf16_f32 v9, v50, v51
  v_cvt_pk_bf16_f32 v10, v52, v53
  v_cvt_pk_bf16_f32 v11, v54, v55
  s_add_u32 s34, s23, 1024
  buffer_store_dwordx4 v[8:11], v1, s[4:7], s34 offen sc1
  v_cvt_pk_bf16_f32 v12, v56, v57
  v_cvt_pk_bf16_f32 v13, v58, v59
  v_cvt_pk_bf16_f32 v14, v60, v61
  v_cvt_pk_bf16_f32 v15, v62, v63
  s_add_u32 s34, s23, 2048
  buffer_store_dwordx4 v[12:15], v1, s[4:7], s34 offen sc1
  v_cvt_pk_bf16_f32 v8, v64, v65
  v_cvt_pk_bf16_f32 v9, v66, v67
  v_cvt_pk_bf16_f32 v10, v68, v69
  v_cvt_pk_bf16_f32 v11, v70, v71
  s_add_u32 s34, s23, 3072
  buffer_store_dwordx4 v[8:11], v1, s[4:7], s34 offen sc1
  s_waitcnt vmcnt(0)
  s_barrier
  s_add_u32 s17, s17, 1
  s_cmp_lt_u32 s17, 64
  s_cbranch_scc1 reca_ptop251
  s_branch reca_exit1
reca_pw2_228:
  s_mov_b32 s17, 0
  s_mov_b32 s26, 0
  s_mul_i32 s20, s17, 40960
  s_add_u32 s20, s20, 84955136
  s_add_u32 m0, s26, 20480
  s_nop 0
  buffer_load_dwordx4 v1, s[4:7], s20 offen offset:0 lds
  buffer_load_dwordx4 v1, s[4:7], s20 offen offset:1024 lds
  buffer_load_dwordx4 v1, s[4:7], s20 offen offset:2048 lds
  buffer_load_dwordx4 v1, s[4:7], s20 offen offset:3072 lds
  s_add_u32 s20, s20, 4096
  s_add_u32 m0, s26, 24576
  s_nop 0
  buffer_load_dwordx4 v1, s[4:7], s20 offen offset:0 lds
  buffer_load_dwordx4 v1, s[4:7], s20 offen offset:1024 lds
  buffer_load_dwordx4 v1, s[4:7], s20 offen offset:2048 lds
  buffer_load_dwordx4 v1, s[4:7], s20 offen offset:3072 lds
  s_add_u32 s20, s20, 4096
  s_add_u32 m0, s26, 28672
  s_nop 0
  buffer_load_dwordx4 v1, s[4:7], s20 offen offset:0 lds
  buffer_load_dwordx4 v1, s[4:7], s20 offen offset:1024 lds
  s_mul_i32 s34, s15, 12
  s_mul_i32 s35, s16, 6
  s_add_u32 s34, s34, s35
  s_add_u32 s34, s34, 0
  s_mul_i32 s34, s34, 20480
  s_add_u32 s34, s34, 6291456
  buffer_load_dwordx4 a[0:3], v1, s[4:7], s34 offen offset:0
  buffer_load_dwordx4 a[4:7], v1, s[4:7], s34 offen offset:1024
  buffer_load_dwordx4 a[8:11], v1, s[4:7], s34 offen offset:2048
  buffer_load_dwordx4 a[12:15], v1, s[4:7], s34 offen offset:3072
  s_add_u32 s34, s34, 4096
  buffer_load_dwordx4 a[16:19], v1, s[4:7], s34 offen offset:0
  buffer_load_dwordx4 a[20:23], v1, s[4:7], s34 offen offset:1024
  buffer_load_dwordx4 a[24:27], v1, s[4:7], s34 offen offset:2048
  buffer_load_dwordx4 a[28:31], v1, s[4:7], s34 offen offset:3072
  s_add_u32 s34, s34, 4096
  buffer_load_dwordx4 a[32:35], v1, s[4:7], s34 offen offset:0
  buffer_load_dwordx4 a[36:39], v1, s[4:7], s34 offen offset:1024
  buffer_load_dwordx4 a[40:43], v1, s[4:7], s34 offen offset:2048
  buffer_load_dwordx4 a[44:47], v1, s[4:7], s34 offen offset:3072
  s_add_u32 s34, s34, 4096
  buffer_load_dwordx4 a[48:51], v1, s[4:7], s34 offen offset:0
  buffer_load_dwordx4 a[52:55], v1, s[4:7], s34 offen offset:1024
  buffer_load_dwordx4 a[56:59], v1, s[4:7], s34 offen offset:2048
  buffer_load_dwordx4 a[60:63], v1, s[4:7], s34 offen offset:3072
  s_add_u32 s34, s34, 4096
  buffer_load_dwordx4 a[64:67], v1, s[4:7], s34 offen offset:0
  buffer_load_dwordx4 a[68:71], v1, s[4:7], s34 offen offset:1024
  buffer_load_dwordx4 a[72:75], v1, s[4:7], s34 offen offset:2048
  buffer_load_dwordx4 a[76:79], v1, s[4:7], s34 offen offset:3072
  s_mul_i32 s34, s15, 12
  s_mul_i32 s35, s16, 6
  s_add_u32 s34, s34, s35
  s_add_u32 s34, s34, 1
  s_mul_i32 s34, s34, 20480
  s_add_u32 s34, s34, 6291456
  buffer_load_dwordx4 a[80:83], v1, s[4:7], s34 offen offset:0
  buffer_load_dwordx4 a[84:87], v1, s[4:7], s34 offen offset:1024
  buffer_load_dwordx4 a[88:91], v1, s[4:7], s34 offen offset:2048
  buffer_load_dwordx4 a[92:95], v1, s[4:7], s34 offen offset:3072
  s_add_u32 s34, s34, 4096
  buffer_load_dwordx4 a[96:99], v1, s[4:7], s34 offen offset:0
  buffer_load_dwordx4 a[100:103], v1, s[4:7], s34 offen offset:1024
  buffer_load_dwordx4 a[104:107], v1, s[4:7], s34 offen offset:2048
  buffer_load_dwordx4 a[108:111], v1, s[4:7], s34 offen offset:3072
  s_add_u32 s34, s34, 4096
  buffer_load_dwordx4 a[112:115], v1, s[4:7], s34 offen offset:0
  buffer_load_dwordx4 a[116:119], v1, s[4:7], s34 offen offset:1024
  buffer_load_dwordx4 a[120:123], v1, s[4:7], s34 offen offset:2048
  buffer_load_dwordx4 a[124:127], v1, s[4:7], s34 offen offset:3072
  s_add_u32 s34, s34, 4096
  buffer_load_dwordx4 a[128:131], v1, s[4:7], s34 offen offset:0
  buffer_load_dwordx4 a[132:135], v1, s[4:7], s34 offen offset:1024
  buffer_load_dwordx4 a[136:139], v1, s[4:7], s34 offen offset:2048
  buffer_load_dwordx4 a[140:143], v1, s[4:7], s34 offen offset:3072
  s_add_u32 s34, s34, 4096
  buffer_load_dwordx4 a[144:147], v1, s[4:7], s34 offen offset:0
  buffer_load_dwordx4 a[148:151], v1, s[4:7], s34 offen offset:1024
  buffer_load_dwordx4 a[152:155], v1, s[4:7], s34 offen offset:2048
  buffer_load_dwordx4 a[156:159], v1, s[4:7], s34 offen offset:3072
  s_waitcnt vmcnt(20)
  s_mul_i32 s34, s15, 12
  s_mul_i32 s35, s16, 6
  s_add_u32 s34, s34, s35
  s_add_u32 s34, s34, 4
  s_mul_i32 s34, s34, 20480
  s_add_u32 s34, s34, 22020096
  buffer_load_dwordx4 a[160:163], v1, s[4:7], s34 offen offset:0
  buffer_load_dwordx4 a[164:167], v1, s[4:7], s34 offen offset:1024
  buffer_load_dwordx4 a[168:171], v1, s[4:7], s34 offen offset:2048
  buffer_load_dwordx4 a[172:175], v1, s[4:7], s34 offen offset:3072
  s_add_u32 s34, s34, 4096
  buffer_load_dwordx4 a[176:179], v1, s[4:7], s34 offen offset:0
  buffer_load_dwordx4 a[180:183], v1, s[4:7], s34 offen offset:1024
  buffer_load_dwordx4 a[184:187], v1, s[4:7], s34 offen offset:2048
  buffer_load_dwordx4 a[188:191], v1, s[4:7], s34 offen offset:3072
  s_add_u32 s34, s34, 4096
  buffer_load_dwordx4 a[192:195], v1, s[4:7], s34 offen offset:0
  buffer_load_dwordx4 a[196:199], v1, s[4:7], s34 offen offset:1024
  buffer_load_dwordx4 a[200:203], v1, s[4:7], s34 offen offset:2048
  buffer_load_dwordx4 a[204:207], v1, s[4:7], s34 offen offset:3072
  s_add_u32 s34, s34, 4096
  buffer_load_dwordx4 a[208:211], v1, s[4:7], s34 offen offset:0
  buffer_load_dwordx4 a[212:215], v1, s[4:7], s34 offen offset:1024
  buffer_load_dwordx4 a[216:219], v1, s[4:7], s34 offen offset:2048
  buffer_load_dwordx4 a[220:223], v1, s[4:7], s34 offen offset:3072
  s_add_u32 s34, s34, 4096
  buffer_load_dwordx4 a[224:227], v1, s[4:7], s34 offen offset:0
  buffer_load_dwordx4 a[228:231], v1, s[4:7], s34 offen offset:1024
  buffer_load_dwordx4 a[232:235], v1, s[4:7], s34 offen offset:2048
  buffer_load_dwordx4 a[236:239], v1, s[4:7], s34 offen offset:3072
  s_waitcnt vmcnt(20)
  s_mul_i32 s34, s15, 12
  s_mul_i32 s35, s16, 6
  s_add_u32 s34, s34, s35
  s_add_u32 s34, s34, 5
  s_mul_i32 s34, s34, 20480
  s_add_u32 s34, s34, 22020096
  buffer_load_dwordx4 v[96:99], v1, s[4:7], s34 offen offset:0
  buffer_load_dwordx4 v[100:103], v1, s[4:7], s34 offen offset:1024
  buffer_load_dwordx4 v[104:107], v1, s[4:7], s34 offen offset:2048
  buffer_load_dwordx4 v[108:111], v1, s[4:7], s34 offen offset:3072
  s_add_u32 s34, s34, 4096
  buffer_load_dwordx4 v[112:115], v1, s[4:7], s34 offen offset:0
  buffer_load_dwordx4 v[116:119], v1, s[4:7], s34 offen offset:1024
  buffer_load_dwordx4 v[120:123], v1, s[4:7], s34 offen offset:2048
  buffer_load_dwordx4 v[124:127], v1, s[4:7], s34 offen offset:3072
  s_add_u32 s34, s34, 4096
  buffer_load_dwordx4 v[128:131], v1, s[4:7], s34 offen offset:0
  buffer_load_dwordx4 v[132:135], v1, s[4:7], s34 offen offset:1024
  buffer_load_dwordx4 v[136:139], v1, s[4:7], s34 offen offset:2048
  buffer_load_dwordx4 v[140:143], v1, s[4:7], s34 offen offset:3072
  s_add_u32 s34, s34, 4096
  buffer_load_dwordx4 v[144:147], v1, s[4:7], s34 offen offset:0
  buffer_load_dwordx4 v[148:151], v1, s[4:7], s34 offen offset:1024
  buffer_load_dwordx4 v[152:155], v1, s[4:7], s34 offen offset:2048
  buffer_load_dwordx4 v[156:159], v1, s[4:7], s34 offen offset:3072
  s_add_u32 s34, s34, 4096
  buffer_load_dwordx4 v[160:163], v1, s[4:7], s34 offen offset:0
  buffer_load_dwordx4 v[164:167], v1, s[4:7], s34 offen offset:1024
  buffer_load_dwordx4 v[168:171], v1, s[4:7], s34 offen offset:2048
  buffer_load_dwordx4 v[172:175], v1, s[4:7], s34 offen offset:3072
  s_waitcnt vmcnt(20)
  v_and_b32 v30, 7, v0
  v_lshlrev_b32 v30, 3, v30
reca_cens256:
  buffer_load_dwordx2 v[28:29], v30, s[8:11], 0 offen sc1
  s_waitcnt vmcnt(0)
  v_sad_u8 v31, v28, 0, 0
  v_sad_u8 v31, v29, 0, v31
  v_cmp_gt_u32 vcc, 32, v31
  s_cbranch_vccz reca_censok257
  s_sleep 8
  s_sub_u32 s18, s18, 1
  s_cbranch_scc0 reca_cens256
  s_mov_b32 s18, 0
reca_censok257:
  v_and_b32 v28, 0x20202020, v28
  v_and_b32 v29, 0x20202020, v29
  v_cmp_ne_u32 s[34:35], 0, v28
  v_cmp_ne_u32 s[36:37], 0, v29
  s_nop 3
  s_and_b32 s34, s34, 0xff
  s_and_b32 s36, s36, 0xff
  s_or_b32 s35, s34, s36
  s_lshr_b32 s37, s35, s13
  s_and_b32 s37, s37, 1
  s_xor_b32 s43, s37, 1
  s_cmp_eq_u32 s57, 0
  s_cselect_b32 s58, s36, s34
  v_mov_b32 v31, 0x80000000
  s_cmp_lg_u32 s43, 0
  s_cbranch_scc1 reca_pslow258
reca_ptop259:
  s_cmp_lt_u32 s17, 3
  s_cbranch_scc1 reca_pgo260
  s_sub_u32 s36, s17, 3
reca_ppoll261:
  buffer_load_dword v28, v4, s[4:7], s25 offen sc1
  s_waitcnt vmcnt(0)
  v_readfirstlane_b32 s34, v28
  s_nop 3
  s_cmp_ge_i32 s34, s36
  s_cbranch_scc1 reca_pgo260
  s_sleep 8
  s_sub_u32 s18, s18, 1
  s_cbranch_scc0 reca_ppoll261
  s_mov_b32 s18, 0
reca_pgo260:
  s_waitcnt vmcnt(0)
  s_barrier
  v_add_u32 v7, s26, v1
  s_xor_b32 s26, s26, 40960
  s_add_u32 s37, s17, 1
  s_cmp_ge_u32 s37, 64
  s_cbranch_scc1 reca_pnodma262
  s_mul_i32 s20, s37, 40960
  s_add_u32 s20, s20, 84955136
  s_add_u32 m0, s26, 20480
  s_nop 0
  buffer_load_dwordx4 v1, s[4:7], s20 offen offset:0 lds
  buffer_load_dwordx4 v1, s[4:7], s20 offen offset:1024 lds
  buffer_load_dwordx4 v1, s[4:7], s20 offen offset:2048 lds
  buffer_load_dwordx4 v1, s[4:7], s20 offen offset:3072 lds
  s_add_u32 s20, s20, 4096
  s_add_u32 m0, s26, 24576
  s_nop 0
  buffer_load_dwordx4 v1, s[4:7], s20 offen offset:0 lds
  buffer_load_dwordx4 v1, s[4:7], s20 offen offset:1024 lds
  buffer_load_dwordx4 v1, s[4:7], s20 offen offset:2048 lds
  buffer_load_dwordx4 v1, s[4:7], s20 offen offset:3072 lds
  s_add_u32 s20, s20, 4096
  s_add_u32 m0, s26, 28672
  s_nop 0
  buffer_load_dwordx4 v1, s[4:7], s20 offen offset:0 lds
  buffer_load_dwordx4 v1, s[4:7], s20 offen offset:1024 lds
reca_pnodma262:
  s_lshl_b32 s34, s15, 3
  s_and_b32 s35, s17, 7
  s_add_u32 s34, s34, s35
  s_mul_i32 s34, s34, 12288
  s_mul_i32 s35, s16, 3072
  s_add_u32 s35, s35, s34
  s_add_u32 s21, s35, 37748736
  s_add_u32 s22, s35, 44040192
  s_mul_i32 s35, s16, 6144
  s_add_u32 s35, s35, s34
  s_add_u32 s23, s35, 40894464
  ds_read_b128 v[72:75], v7 offset:0
  ds_read_b128 v[76:79], v7 offset:20480
  ds_read_b128 v[80:83], v7 offset:1024
  ds_read_b128 v[84:87], v7 offset:21504
  ds_read_b128 v[88:91], v7 offset:2048
  ds_read_b128 v[92:95], v7 offset:22528
  s_waitcnt lgkmcnt(4)
  v_mfma_f32_16x16x32_bf16 v[32:35], a[0:3], v[72:75], 0
  v_mfma_f32_16x16x32_bf16 v[36:39], a[0:3], v[76:79], 0
  v_mfma_f32_16x16x32_bf16 v[40:43], a[80:83], v[72:75], 0
  v_mfma_f32_16x16x32_bf16 v[44:47], a[80:83], v[76:79], 0
  v_mfma_f32_16x16x32_bf16 v[48:51], v[72:75], a[160:163], 0
  v_mfma_f32_16x16x32_bf16 v[52:55], v[76:79], a[160:163], 0
  v_mfma_f32_16x16x32_bf16 v[56:59], v[72:75], v[96:99], 0
  v_mfma_f32_16x16x32_bf16 v[60:63], v[76:79], v[96:99], 0
  ds_read_b128 v[72:75], v7 offset:3072
  ds_read_b128 v[76:79], v7 offset:23552
  s_waitcnt lgkmcnt(4)
  v_mfma_f32_16x16x32_bf16 v[32:35], a[4:7], v[80:83], v[32:35]
  v_mfma_f32_16x16x32_bf16 v[36:39], a[4:7], v[84:87], v[36:39]
  v_mfma_f32_16x16x32_bf16 v[40:43], a[84:87], v[80:83], v[40:43]
  v_mfma_f32_16x16x32_bf16 v[44:47], a[84:87], v[84:87], v[44:47]
  v_mfma_f32_16x16x32_bf16 v[48:51], v[80:83], a[164:167], v[48:51]
  v_mfma_f32_16x16x32_bf16 v[52:55], v[84:87], a[164:167], v[52:55]
  v_mfma_f32_16x16x32_bf16 v[56:59], v[80:83], v[100:103], v[56:59]
  v_mfma_f32_16x16x32_bf16 v[60:63], v[84:87], v[100:103], v[60:63]
  ds_read_b128 v[80:83], v7 offset:4096
  ds_read_b128 v[84:87], v7 offset:24576
  s_waitcnt lgkmcnt(4)
  v_mfma_f32_16x16x32_bf16 v[32:35], a[8:11], v[88:91], v[32:35]
  v_mfma_f32_16x16x32_bf16 v[36:39], a[8:11], v[92:95], v[36:39]
  v_mfma_f32_16x16x32_bf16 v[40:43], a[88:91], v[88:91], v[40:43]
  v_mfma_f32_16x16x32_bf16 v[44:47], a[88:91], v[92:95], v[44:47]
  v_mfma_f32_16x16x32_bf16 v[48:51], v[88:91], a[168:171], v[48:51]
  v_mfma_f32_16x16x32_bf16 v[52:55], v[92:95], a[168:171], v[52:55]
  v_mfma_f32_16x16x32_bf16 v[56:59], v[88:91], v[104:107], v[56:59]
  v_mfma_f32_16x16x32_bf16 v[60:63], v[92:95], v[104:107], v[60:63]
  ds_read_b128 v[88:91], v7 offset:5120
  ds_read_b128 v[92:95], v7 offset:25600
  s_waitcnt lgkmcnt(4)
  v_mfma_f32_16x16x32_bf16 v[32:35], a[12:15], v[72:75], v[32:35]
  v_mfma_f32_16x16x32_bf16 v[36:39], a[12:15], v[76:79], v[36:39]
  v_mfma_f32_16x16x32_bf16 v[40:43], a[92:95], v[72:75], v[40:43]
  v_mfma_f32_16x16x32_bf16 v[44:47], a[92:95], v[76:79], v[44:47]
  v_mfma_f32_16x16x32_bf16 v[48:51], v[72:75], a[172:175], v[48:51]
  v_mfma_f32_16x16x32_bf16 v[52:55], v[76:79], a[172:175], v[52:55]
  v_mfma_f32_16x16x32_bf16 v[56:59], v[72:75], v[108:111], v[56:59]
  v_mfma_f32_16x16x32_bf16 v[60:63], v[76:79], v[108:111], v[60:63]
  ds_read_b128 v[72:75], v7 offset:6144
  ds_read_b128 v[76:79], v7 offset:26624
  s_waitcnt lgkmcnt(4)
  v_mfma_f32_16x16x32_bf16 v[32:35], a[16:19], v[80:83], v[32:35]
  v_mfma_f32_16x16x32_bf16 v[36:39], a[16:19], v[84:87], v[36:39]
  v_mfma_f32_16x16x32_bf16 v[40:43], a[96:99], v[80:83], v[40:43]
  v_mfma_f32_16x16x32_bf16 v[44:47], a[96:99], v[84:87], v[44:47]
  v_mfma_f32_16x16x32_bf16 v[48:51], v[80:83], a[176:179], v[48:51]
  v_mfma_f32_16x16x32_bf16 v[52:55], v[84:87], a[176:179], v[52:55]
  v_mfma_f32_16x16x32_bf16 v[56:59], v[80:83], v[112:115], v[56:59]
  v_mfma_f32_16x16x32_bf16 v[60:63], v[84:87], v[112:115], v[60:63]
  ds_read_b128 v[80:83], v7 offset:7168
  ds_read_b128 v[84:87], v7 offset:27648
  s_waitcnt lgkmcnt(4)
  v_mfma_f32_16x16x32_bf16 v[32:35], a[20:23], v[88:91], v[32:35]
  v_mfma_f32_16x16x32_bf16 v[36:39], a[20:23], v[92:95], v[36:39]
  v_mfma_f32_16x16x32_bf16 v[40:43], a[100:103], v[88:91], v[40:43]
  v_mfma_f32_16x16x32_bf16 v[44:47], a[100:103], v[92:95], v[44:47]
  v_mfma_f32_16x16x32_bf16 v[48:51], v[88:91], a[180:183], v[48:51]
  v_mfma_f32_16x16x32_bf16 v[52:55], v[92:95], a[180:183], v[52:55]
  v_mfma_f32_16x16x32_bf16 v[56:59], v[88:91], v[116:119], v[56:59]
  v_mfma_f32_16x16x32_bf16 v[60:63], v[92:95], v[116:119], v[60:63]
  ds_read_b128 v[88:91], v7 offset:8192
  ds_read_b128 v[92:95], v7 offset:28672
  s_waitcnt lgkmcnt(4)
  v_mfma_f32_16x16x32_bf16 v[32:35], a[24:27], v[72:75], v[32:35]
  v_mfma_f32_16x16x32_bf16 v[36:39], a[24:27], v[76:79], v[36:39]
  v_mfma_f32_16x16x32_bf16 v[40:43], a[104:107], v[72:75], v[40:43]
  v_mfma_f32_16x16x32_bf16 v[44:47], a[104:107], v[76:79], v[44:47]
  v_mfma_f32_16x16x32_bf16 v[48:51], v[72:75], a[184:187], v[48:51]
  v_mfma_f32_16x16x32_bf16 v[52:55], v[76:79], a[184:187], v[52:55]
  v_mfma_f32_16x16x32_bf16 v[56:59], v[72:75], v[120:123], v[56:59]
  v_mfma_f32_16x16x32_bf16 v[60:63], v[76:79], v[120:123], v[60:63]
  ds_read_b128 v[72:75], v7 offset:9216
  ds_read_b128 v[76:79], v7 offset:29696
  s_waitcnt lgkmcnt(4)
  v_mfma_f32_16x16x32_bf16 v[32:35], a[28:31], v[80:83], v[32:35]
  v_mfma_f32_16x16x32_bf16 v[36:39], a[28:31], v[84:87], v[36:39]
  v_mfma_f32_16x16x32_bf16 v[40:43], a[108:111], v[80:83], v[40:43]
  v_mfma_f32_16x16x32_bf16 v[44:47], a[108:111], v[84:87], v[44:47]
  v_mfma_f32_16x16x32_bf16 v[48:51], v[80:83], a[188:191], v[48:51]
  v_mfma_f32_16x16x32_bf16 v[52:55], v[84:87], a[188:191], v[52:55]
  v_mfma_f32_16x16x32_bf16 v[56:59], v[80:83], v[124:127], v[56:59]
  v_mfma_f32_16x16x32_bf16 v[60:63], v[84:87], v[124:127], v[60:63]
  ds_read_b128 v[80:83], v7 offset:10240
  ds_read_b128 v[84:87], v7 offset:30720
  s_waitcnt lgkmcnt(4)
  v_mfma_f32_16x16x32_bf16 v[32:35], a[32:35], v[88:91], v[32:35]
  v_mfma_f32_16x16x32_bf16 v[36:39], a[32:35], v[92:95], v[36:39]
  v_mfma_f32_16x16x32_bf16 v[40:43], a[112:115], v[88:91], v[40:43]
  v_mfma_f32_16x16x32_bf16 v[44:47], a[112:115], v[92:95], v[44:47]
  v_mfma_f32_16x16x32_bf16 v[48:51], v[88:91], a[192:195], v[48:51]
  v_mfma_f32_16x16x32_bf16 v[52:55], v[92:95], a[192:195], v[52:55]
  v_mfma_f32_16x16x32_bf16 v[56:59], v[88:91], v[128:131], v[56:59]
  v_mfma_f32_16x16x32_bf16 v[60:63], v[92:95], v[128:131], v[60:63]
  ds_read_b128 v[88:91], v7 offset:11264
  ds_read_b128 v[92:95], v7 offset:31744
  s_waitcnt lgkmcnt(4)
  v_mfma_f32_16x16x32_bf16 v[32:35], a[36:39], v[72:75], v[32:35]
  v_mfma_f32_16x16x32_bf16 v[36:39], a[36:39], v[76:79], v[36:39]
  v_mfma_f32_16x16x32_bf16 v[40:43], a[116:119], v[72:75], v[40:43]
  v_mfma_f32_16x16x32_bf16 v[44:47], a[116:119], v[76:79], v[44:47]
  v_mfma_f32_16x16x32_bf16 v[48:51], v[72:75], a[196:199], v[48:51]
  v_mfma_f32_16x16x32_bf16 v[52:55], v[76:79], a[196:199], v[52:55]
  v_mfma_f32_16x16x32_bf16 v[56:59], v[72:75], v[132:135], v[56:59]
  v_mfma_f32_16x16x32_bf16 v[60:63], v[76:79], v[132:135], v[60:63]
  ds_read_b128 v[72:75], v7 offset:12288
  ds_read_b128 v[76:79], v7 offset:32768
  s_waitcnt lgkmcnt(4)
  v_mfma_f32_16x16x32_bf16 v[32:35], a[40:43], v[80:83], v[32:35]
  v_mfma_f32_16x16x32_bf16 v[36:39], a[40:43], v[84:87], v[36:39]
  v_mfma_f32_16x16x32_bf16 v[40:43], a[120:123], v[80:83], v[40:43]
  v_mfma_f32_16x16x32_bf16 v[44:47], a[120:123], v[84:87], v[44:47]
  v_mfma_f32_16x16x32_bf16 v[48:51], v[80:83], a[200:203], v[48:51]
  v_mfma_f32_16x16x32_bf16 v[52:55], v[84:87], a[200:203], v[52:55]
  v_mfma_f32_16x16x32_bf16 v[56:59], v[80:83], v[136:139], v[56:59]
  v_mfma_f32_16x16x32_bf16 v[60:63], v[84:87], v[136:139], v[60:63]
  ds_read_b128 v[80:83], v7 offset:13312
  ds_read_b128 v[84:87], v7 offset:33792
  s_waitcnt lgkmcnt(4)
  v_mfma_f32_16x16x32_bf16 v[32:35], a[44:47], v[88:91], v[32:35]
  v_mfma_f32_16x16x32_bf16 v[36:39], a[44:47], v[92:95], v[36:39]
  v_mfma_f32_16x16x32_bf16 v[40:43], a[124:127], v[88:91], v[40:43]
  v_mfma_f32_16x16x32_bf16 v[44:47], a[124:127], v[92:95], v[44:47]
  v_mfma_f32_16x16x32_bf16 v[48:51], v[88:91], a[204:207], v[48:51]
  v_mfma_f32_16x16x32_bf16 v[52:55], v[92:95], a[204:207], v[52:55]
  v_mfma_f32_16x16x32_bf16 v[56:59], v[88:91], v[140:143], v[56:59]
  v_mfma_f32_16x16x32_bf16 v[60:63], v[92:95], v[140:143], v[60:63]
  ds_read_b128 v[88:91], v7 offset:14336
  ds_read_b128 v[92:95], v7 offset:34816
  s_waitcnt lgkmcnt(4)
  v_mfma_f32_16x16x32_bf16 v[32:35], a[48:51], v[72:75], v[32:35]
  v_mfma_f32_16x16x32_bf16 v[36:39], a[48:51], v[76:79], v[36:39]
  v_mfma_f32_16x16x32_bf16 v[40:43], a[128:131], v[72:75], v[40:43]
  v_mfma_f32_16x16x32_bf16 v[44:47], a[128:131], v[76:79], v[44:47]
  v_mfma_f32_16x16x32_bf16 v[48:51], v[72:75], a[208:211], v[48:51]
  v_mfma_f32_16x16x32_bf16 v[52:55], v[76:79], a[208:211], v[52:55]
  v_mfma_f32_16x16x32_bf16 v[56:59], v[72:75], v[144:147], v[56:59]
  v_mfma_f32_16x16x32_bf16 v[60:63], v[76:79], v[144:147], v[60:63]
  ds_read_b128 v[72:75], v7 offset:15360
  ds_read_b128 v[76:79], v7 offset:35840
  s_waitcnt lgkmcnt(4)
  v_mfma_f32_16x16x32_bf16 v[32:35], a[52:55], v[80:83], v[32:35]
  v_mfma_f32_16x16x32_bf16 v[36:39], a[52:55], v[84:87], v[36:39]
  v_mfma_f32_16x16x32_bf16 v[40:43], a[132:135], v[80:83], v[40:43]
  v_mfma_f32_16x16x32_bf16 v[44:47], a[132:135], v[84:87], v[44:47]
  v_mfma_f32_16x16x32_bf16 v[48:51], v[80:83], a[212:215], v[48:51]
  v_mfma_f32_16x16x32_bf16 v[52:55], v[84:87], a[212:215], v[52:55]
  v_mfma_f32_16x16x32_bf16 v[56:59], v[80:83], v[148:151], v[56:59]
  v_mfma_f32_16x16x32_bf16 v[60:63], v[84:87], v[148:151], v[60:63]
  ds_read_b128 v[80:83], v7 offset:16384
  ds_read_b128 v[84:87], v7 offset:36864
  s_waitcnt lgkmcnt(4)
  v_mfma_f32_16x16x32_bf16 v[32:35], a[56:59], v[88:91], v[32:35]
  v_mfma_f32_16x16x32_bf16 v[36:39], a[56:59], v[92:95], v[36:39]
  v_mfma_f32_16x16x32_bf16 v[40:43], a[136:139], v[88:91], v[40:43]
  v_mfma_f32_16x16x32_bf16 v[44:47], a[136:139], v[92:95], v[44:47]
  v_mfma_f32_16x16x32_bf16 v[48:51], v[88:91], a[216:219], v[48:51]
  v_mfma_f32_16x16x32_bf16 v[52:55], v[92:95], a[216:219], v[52:55]
  v_mfma_f32_16x16x32_bf16 v[56:59], v[88:91], v[152:155], v[56:59]
  v_mfma_f32_16x16x32_bf16 v[60:63], v[92:95], v[152:155], v[60:63]
  ds_read_b128 v[88:91], v7 offset:17408
  ds_read_b128 v[92:95], v7 offset:37888
  s_waitcnt lgkmcnt(4)
  v_mfma_f32_16x16x32_bf16 v[32:35], a[60:63], v[72:75], v[32:35]
  v_mfma_f32_16x16x32_bf16 v[36:39], a[60:63], v[76:79], v[36:39]
  v_mfma_f32_16x16x32_bf16 v[40:43], a[140:143], v[72:75], v[40:43]
  v_mfma_f32_16x16x32_bf16 v[44:47], a[140:143], v[76:79], v[44:47]
  v_mfma_f32_16x16x32_bf16 v[48:51], v[72:75], a[220:223], v[48:51]
  v_mfma_f32_16x16x32_bf16 v[52:55], v[76:79], a[220:223], v[52:55]
  v_mfma_f32_16x16x32_bf16 v[56:59], v[72:75], v[156:159], v[56:59]
  v_mfma_f32_16x16x32_bf16 v[60:63], v[76:79], v[156:159], v[60:63]
  ds_read_b128 v[72:75], v7 offset:18432
  ds_read_b128 v[76:79], v7 offset:38912
  s_waitcnt lgkmcnt(4)
  v_mfma_f32_16x16x32_bf16 v[32:35], a[64:67], v[80:83], v[32:35]
  v_mfma_f32_16x16x32_bf16 v[36:39], a[64:67], v[84:87], v[36:39]
  v_mfma_f32_16x16x32_bf16 v[40:43], a[144:147], v[80:83], v[40:43]
  v_mfma_f32_16x16x32_bf16 v[44:47], a[144:147], v[84:87], v[44:47]
  v_mfma_f32_16x16x32_bf16 v[48:51], v[80:83], a[224:227], v[48:51]
  v_mfma_f32_16x16x32_bf16 v[52:55], v[84:87], a[224:227], v[52:55]
  v_mfma_f32_16x16x32_bf16 v[56:59], v[80:83], v[160:163], v[56:59]
  v_mfma_f32_16x16x32_bf16 v[60:63], v[84:87], v[160:163], v[60:63]
  ds_read_b128 v[80:83], v7 offset:19456
  ds_read_b128 v[84:87], v7 offset:39936
  s_waitcnt lgkmcnt(4)
  v_mfma_f32_16x16x32_bf16 v[32:35], a[68:71], v[88:91], v[32:35]
  v_mfma_f32_16x16x32_bf16 v[36:39], a[68:71], v[92:95], v[36:39]
  v_mfma_f32_16x16x32_bf16 v[40:43], a[148:151], v[88:91], v[40:43]
  v_mfma_f32_16x16x32_bf16 v[44:47], a[148:151], v[92:95], v[44:47]
  v_mfma_f32_16x16x32_bf16 v[48:51], v[88:91], a[228:231], v[48:51]
  v_mfma_f32_16x16x32_bf16 v[52:55], v[92:95], a[228:231], v[52:55]
  v_mfma_f32_16x16x32_bf16 v[56:59], v[88:91], v[164:167], v[56:59]
  v_mfma_f32_16x16x32_bf16 v[60:63], v[92:95], v[164:167], v[60:63]
  s_waitcnt lgkmcnt(2)
  v_mfma_f32_16x16x32_bf16 v[32:35], a[72:75], v[72:75], v[32:35]
  v_mfma_f32_16x16x32_bf16 v[36:39], a[72:75], v[76:79], v[36:39]
  v_mfma_f32_16x16x32_bf16 v[40:43], a[152:155], v[72:75], v[40:43]
  v_mfma_f32_16x16x32_bf16 v[44:47], a[152:155], v[76:79], v[44:47]
  v_mfma_f32_16x16x32_bf16 v[48:51], v[72:75], a[232:235], v[48:51]
  v_mfma_f32_16x16x32_bf16 v[52:55], v[76:79], a[232:235], v[52:55]
  v_mfma_f32_16x16x32_bf16 v[56:59], v[72:75], v[168:171], v[56:59]
  v_mfma_f32_16x16x32_bf16 v[60:63], v[76:79], v[168:171], v[60:63]
  s_waitcnt lgkmcnt(0)
  v_mfma_f32_16x16x32_bf16 v[32:35], a[76:79], v[80:83], v[32:35]
  v_mfma_f32_16x16x32_bf16 v[36:39], a[76:79], v[84:87], v[36:39]
  v_mfma_f32_16x16x32_bf16 v[40:43], a[156:159], v[80:83], v[40:43]
  v_mfma_f32_16x16x32_bf16 v[44:47], a[156:159], v[84:87], v[44:47]
  v_mfma_f32_16x16x32_bf16 v[48:51], v[80:83], a[236:239], v[48:51]
  v_mfma_f32_16x16x32_bf16 v[52:55], v[84:87], a[236:239], v[52:55]
  v_mfma_f32_16x16x32_bf16 v[56:59], v[80:83], v[172:175], v[56:59]
  v_mfma_f32_16x16x32_bf16 v[60:63], v[84:87], v[172:175], v[60:63]
  s_nop 0
  v_cvt_pk_bf16_f32 v8, v32, v33
  v_cvt_pk_bf16_f32 v9, v34, v35
  v_cvt_pk_bf16_f32 v10, v40, v41
  v_cvt_pk_bf16_f32 v11, v42, v43
  s_add_u32 s34, s22, 0
  buffer_store_dwordx4 v[8:11], v1, s[4:7], s34 offen
  v_cvt_pk_bf16_f32 v12, v36, v37
  v_cvt_pk_bf16_f32 v13, v38, v39
  v_cvt_pk_bf16_f32 v14, v44, v45
  v_cvt_pk_bf16_f32 v15, v46, v47
  s_add_u32 s34, s22, 6144
  buffer_store_dwordx4 v[12:15], v1, s[4:7], s34 offen
  v_cvt_pk_bf16_f32 v8, v48, v49
  v_cvt_pk_bf16_f32 v9, v50, v51
  v_cvt_pk_bf16_f32 v10, v52, v53
  v_cvt_pk_bf16_f32 v11, v54, v55
  s_add_u32 s34, s23, 4096
  buffer_store_dwordx4 v[8:11], v1, s[4:7], s34 offen
  v_cvt_pk_bf16_f32 v12, v56, v57
  v_cvt_pk_bf16_f32 v13, v58, v59
  v_cvt_pk_bf16_f32 v14, v60, v61
  v_cvt_pk_bf16_f32 v15, v62, v63
  s_add_u32 s34, s23, 5120
  buffer_store_dwordx4 v[12:15], v1, s[4:7], s34 offen
  s_waitcnt vmcnt(0)
  s_barrier
  s_add_u32 s17, s17, 1
  s_cmp_lt_u32 s17, 64
  s_cbranch_scc1 reca_ptop259
  s_branch reca_exit1
reca_pslow258:
reca_ptop264:
  s_cmp_lt_u32 s17, 3
  s_cbranch_scc1 reca_pgo265
  s_sub_u32 s36, s17, 3
reca_ppoll266:
  buffer_load_dword v28, v4, s[4:7], s25 offen sc1
  s_waitcnt vmcnt(0)
  v_readfirstlane_b32 s34, v28
  s_nop 3
  s_cmp_ge_i32 s34, s36
  s_cbranch_scc1 reca_pgo265
  s_sleep 8
  s_sub_u32 s18, s18, 1
  s_cbranch_scc0 reca_ppoll266
  s_mov_b32 s18, 0
reca_pgo265:
  s_waitcnt vmcnt(0)
  s_barrier
  v_add_u32 v7, s26, v1
  s_xor_b32 s26, s26, 40960
  s_add_u32 s37, s17, 1
  s_cmp_ge_u32 s37, 64
  s_cbranch_scc1 reca_pnodma267
  s_mul_i32 s20, s37, 40960
  s_add_u32 s20, s20, 84955136
  s_add_u32 m0, s26, 20480
  s_nop 0
  buffer_load_dwordx4 v1, s[4:7], s20 offen offset:0 lds
  buffer_load_dwordx4 v1, s[4:7], s20 offen offset:1024 lds
  buffer_load_dwordx4 v1, s[4:7], s20 offen offset:2048 lds
  buffer_load_dwordx4 v1, s[4:7], s20 offen offset:3072 lds
  s_add_u32 s20, s20, 4096
  s_add_u32 m0, s26, 24576
  s_nop 0
  buffer_load_dwordx4 v1, s[4:7], s20 offen offset:0 lds
  buffer_load_dwordx4 v1, s[4:7], s20 offen offset:1024 lds
  buffer_load_dwordx4 v1, s[4:7], s20 offen offset:2048 lds
  buffer_load_dwordx4 v1, s[4:7], s20 offen offset:3072 lds
  s_add_u32 s20, s20, 4096
  s_add_u32 m0, s26, 28672
  s_nop 0
  buffer_load_dwordx4 v1, s[4:7], s20 offen offset:0 lds
  buffer_load_dwordx4 v1, s[4:7], s20 offen offset:1024 lds
reca_pnodma267:
  s_lshl_b32 s34, s15, 3
  s_and_b32 s35, s17, 7
  s_add_u32 s34, s34, s35
  s_mul_i32 s34, s34, 12288
  s_mul_i32 s35, s16, 3072
  s_add_u32 s35, s35, s34
  s_add_u32 s21, s35, 37748736
  s_add_u32 s22, s35, 44040192
  s_mul_i32 s35, s16, 6144
  s_add_u32 s35, s35, s34
  s_add_u32 s23, s35, 40894464
  ds_read_b128 v[72:75], v7 offset:0
  ds_read_b128 v[76:79], v7 offset:20480
  ds_read_b128 v[80:83], v7 offset:1024
  ds_read_b128 v[84:87], v7 offset:21504
  ds_read_b128 v[88:91], v7 offset:2048
  ds_read_b128 v[92:95], v7 offset:22528
  s_waitcnt lgkmcnt(4)
  v_mfma_f32_16x16x32_bf16 v[32:35], a[0:3], v[72:75], 0
  v_mfma_f32_16x16x32_bf16 v[36:39], a[0:3], v[76:79], 0
  v_mfma_f32_16x16x32_bf16 v[40:43], a[80:83], v[72:75], 0
  v_mfma_f32_16x16x32_bf16 v[44:47], a[80:83], v[76:79], 0
  v_mfma_f32_16x16x32_bf16 v[48:51], v[72:75], a[160:163], 0
  v_mfma_f32_16x16x32_bf16 v[52:55], v[76:79], a[160:163], 0
  v_mfma_f32_16x16x32_bf16 v[56:59], v[72:75], v[96:99], 0
  v_mfma_f32_16x16x32_bf16 v[60:63], v[76:79], v[96:99], 0
  ds_read_b128 v[72:75], v7 offset:3072
  ds_read_b128 v[76:79], v7 offset:23552
  s_waitcnt lgkmcnt(4)
  v_mfma_f32_16x16x32_bf16 v[32:35], a[4:7], v[80:83], v[32:35]
  v_mfma_f32_16x16x32_bf16 v[36:39], a[4:7], v[84:87], v[36:39]
  v_mfma_f32_16x16x32_bf16 v[40:43], a[84:87], v[80:83], v[40:43]
  v_mfma_f32_16x16x32_bf16 v[44:47], a[84:87], v[84:87], v[44:47]
  v_mfma_f32_16x16x32_bf16 v[48:51], v[80:83], a[164:167], v[48:51]
  v_mfma_f32_16x16x32_bf16 v[52:55], v[84:87], a[164:167], v[52:55]
  v_mfma_f32_16x16x32_bf16 v[56:59], v[80:83], v[100:103], v[56:59]
  v_mfma_f32_16x16x32_bf16 v[60:63], v[84:87], v[100:103], v[60:63]
  ds_read_b128 v[80:83], v7 offset:4096
  ds_read_b128 v[84:87], v7 offset:24576
  s_waitcnt lgkmcnt(4)
  v_mfma_f32_16x16x32_bf16 v[32:35], a[8:11], v[88:91], v[32:35]
  v_mfma_f32_16x16x32_bf16 v[36:39], a[8:11], v[92:95], v[36:39]
  v_mfma_f32_16x16x32_bf16 v[40:43], a[88:91], v[88:91], v[40:43]
  v_mfma_f32_16x16x32_bf16 v[44:47], a[88:91], v[92:95], v[44:47]
  v_mfma_f32_16x16x32_bf16 v[48:51], v[88:91], a[168:171], v[48:51]
  v_mfma_f32_16x16x32_bf16 v[52:55], v[92:95], a[168:171], v[52:55]
  v_mfma_f32_16x16x32_bf16 v[56:59], v[88:91], v[104:107], v[56:59]
  v_mfma_f32_16x16x32_bf16 v[60:63], v[92:95], v[104:107], v[60:63]
  ds_read_b128 v[88:91], v7 offset:5120
  ds_read_b128 v[92:95], v7 offset:25600
  s_waitcnt lgkmcnt(4)
  v_mfma_f32_16x16x32_bf16 v[32:35], a[12:15], v[72:75], v[32:35]
  v_mfma_f32_16x16x32_bf16 v[36:39], a[12:15], v[76:79], v[36:39]
  v_mfma_f32_16x16x32_bf16 v[40:43], a[92:95], v[72:75], v[40:43]
  v_mfma_f32_16x16x32_bf16 v[44:47], a[92:95], v[76:79], v[44:47]
  v_mfma_f32_16x16x32_bf16 v[48:51], v[72:75], a[172:175], v[48:51]
  v_mfma_f32_16x16x32_bf16 v[52:55], v[76:79], a[172:175], v[52:55]
  v_mfma_f32_16x16x32_bf16 v[56:59], v[72:75], v[108:111], v[56:59]
  v_mfma_f32_16x16x32_bf16 v[60:63], v[76:79], v[108:111], v[60:63]
  ds_read_b128 v[72:75], v7 offset:6144
  ds_read_b128 v[76:79], v7 offset:26624
  s_waitcnt lgkmcnt(4)
  v_mfma_f32_16x16x32_bf16 v[32:35], a[16:19], v[80:83], v[32:35]
  v_mfma_f32_16x16x32_bf16 v[36:39], a[16:19], v[84:87], v[36:39]
  v_mfma_f32_16x16x32_bf16 v[40:43], a[96:99], v[80:83], v[40:43]
  v_mfma_f32_16x16x32_bf16 v[44:47], a[96:99], v[84:87], v[44:47]
  v_mfma_f32_16x16x32_bf16 v[48:51], v[80:83], a[176:179], v[48:51]
  v_mfma_f32_16x16x32_bf16 v[52:55], v[84:87], a[176:179], v[52:55]
  v_mfma_f32_16x16x32_bf16 v[56:59], v[80:83], v[112:115], v[56:59]
  v_mfma_f32_16x16x32_bf16 v[60:63], v[84:87], v[112:115], v[60:63]
  ds_read_b128 v[80:83], v7 offset:7168
  ds_read_b128 v[84:87], v7 offset:27648
  s_waitcnt lgkmcnt(4)
  v_mfma_f32_16x16x32_bf16 v[32:35], a[20:23], v[88:91], v[32:35]
  v_mfma_f32_16x16x32_bf16 v[36:39], a[20:23], v[92:95], v[36:39]
  v_mfma_f32_16x16x32_bf16 v[40:43], a[100:103], v[88:91], v[40:43]
  v_mfma_f32_16x16x32_bf16 v[44:47], a[100:103], v[92:95], v[44:47]
  v_mfma_f32_16x16x32_bf16 v[48:51], v[88:91], a[180:183], v[48:51]
  v_mfma_f32_16x16x32_bf16 v[52:55], v[92:95], a[180:183], v[52:55]
  v_mfma_f32_16x16x32_bf16 v[56:59], v[88:91], v[116:119], v[56:59]
  v_mfma_f32_16x16x32_bf16 v[60:63], v[92:95], v[116:119], v[60:63]
  ds_read_b128 v[88:91], v7 offset:8192
  ds_read_b128 v[92:95], v7 offset:28672
  s_waitcnt lgkmcnt(4)
  v_mfma_f32_16x16x32_bf16 v[32:35], a[24:27], v[72:75], v[32:35]
  v_mfma_f32_16x16x32_bf16 v[36:39], a[24:27], v[76:79], v[36:39]
  v_mfma_f32_16x16x32_bf16 v[40:43], a[104:107], v[72:75], v[40:43]
  v_mfma_f32_16x16x32_bf16 v[44:47], a[104:107], v[76:79], v[44:47]
  v_mfma_f32_16x16x32_bf16 v[48:51], v[72:75], a[184:187], v[48:51]
  v_mfma_f32_16x16x32_bf16 v[52:55], v[76:79], a[184:187], v[52:55]
  v_mfma_f32_16x16x32_bf16 v[56:59], v[72:75], v[120:123], v[56:59]
  v_mfma_f32_16x16x32_bf16 v[60:63], v[76:79], v[120:123], v[60:63]
  ds_read_b128 v[72:75], v7 offset:9216
  ds_read_b128 v[76:79], v7 offset:29696
  s_waitcnt lgkmcnt(4)
  v_mfma_f32_16x16x32_bf16 v[32:35], a[28:31], v[80:83], v[32:35]
  v_mfma_f32_16x16x32_bf16 v[36:39], a[28:31], v[84:87], v[36:39]
  v_mfma_f32_16x16x32_bf16 v[40:43], a[108:111], v[80:83], v[40:43]
  v_mfma_f32_16x16x32_bf16 v[44:47], a[108:111], v[84:87], v[44:47]
  v_mfma_f32_16x16x32_bf16 v[48:51], v[80:83], a[188:191], v[48:51]
  v_mfma_f32_16x16x32_bf16 v[52:55], v[84:87], a[188:191], v[52:55]
  v_mfma_f32_16x16x32_bf16 v[56:59], v[80:83], v[124:127], v[56:59]
  v_mfma_f32_16x16x32_bf16 v[60:63], v[84:87], v[124:127], v[60:63]
  ds_read_b128 v[80:83], v7 offset:10240
  ds_read_b128 v[84:87], v7 offset:30720
  s_waitcnt lgkmcnt(4)
  v_mfma_f32_16x16x32_bf16 v[32:35], a[32:35], v[88:91], v[32:35]
  v_mfma_f32_16x16x32_bf16 v[36:39], a[32:35], v[92:95], v[36:39]
  v_mfma_f32_16x16x32_bf16 v[40:43], a[112:115], v[88:91], v[40:43]
  v_mfma_f32_16x16x32_bf16 v[44:47], a[112:115], v[92:95], v[44:47]
  v_mfma_f32_16x16x32_bf16 v[48:51], v[88:91], a[192:195], v[48:51]
  v_mfma_f32_16x16x32_bf16 v[52:55], v[92:95], a[192:195], v[52:55]
  v_mfma_f32_16x16x32_bf16 v[56:59], v[88:91], v[128:131], v[56:59]
  v_mfma_f32_16x16x32_bf16 v[60:63], v[92:95], v[128:131], v[60:63]
  ds_read_b128 v[88:91], v7 offset:11264
  ds_read_b128 v[92:95], v7 offset:31744
  s_waitcnt lgkmcnt(4)
  v_mfma_f32_16x16x32_bf16 v[32:35], a[36:39], v[72:75], v[32:35]
  v_mfma_f32_16x16x32_bf16 v[36:39], a[36:39], v[76:79], v[36:39]
  v_mfma_f32_16x16x32_bf16 v[40:43], a[116:119], v[72:75], v[40:43]
  v_mfma_f32_16x16x32_bf16 v[44:47], a[116:119], v[76:79], v[44:47]
  v_mfma_f32_16x16x32_bf16 v[48:51], v[72:75], a[196:199], v[48:51]
  v_mfma_f32_16x16x32_bf16 v[52:55], v[76:79], a[196:199], v[52:55]
  v_mfma_f32_16x16x32_bf16 v[56:59], v[72:75], v[132:135], v[56:59]
  v_mfma_f32_16x16x32_bf16 v[60:63], v[76:79], v[132:135], v[60:63]
  ds_read_b128 v[72:75], v7 offset:12288
  ds_read_b128 v[76:79], v7 offset:32768
  s_waitcnt lgkmcnt(4)
  v_mfma_f32_16x16x32_bf16 v[32:35], a[40:43], v[80:83], v[32:35]
  v_mfma_f32_16x16x32_bf16 v[36:39], a[40:43], v[84:87], v[36:39]
  v_mfma_f32_16x16x32_bf16 v[40:43], a[120:123], v[80:83], v[40:43]
  v_mfma_f32_16x16x32_bf16 v[44:47], a[120:123], v[84:87], v[44:47]
  v_mfma_f32_16x16x32_bf16 v[48:51], v[80:83], a[200:203], v[48:51]
  v_mfma_f32_16x16x32_bf16 v[52:55], v[84:87], a[200:203], v[52:55]
  v_mfma_f32_16x16x32_bf16 v[56:59], v[80:83], v[136:139], v[56:59]
  v_mfma_f32_16x16x32_bf16 v[60:63], v[84:87], v[136:139], v[60:63]
  ds_read_b128 v[80:83], v7 offset:13312
  ds_read_b128 v[84:87], v7 offset:33792
  s_waitcnt lgkmcnt(4)
  v_mfma_f32_16x16x32_bf16 v[32:35], a[44:47], v[88:91], v[32:35]
  v_mfma_f32_16x16x32_bf16 v[36:39], a[44:47], v[92:95], v[36:39]
  v_mfma_f32_16x16x32_bf16 v[40:43], a[124:127], v[88:91], v[40:43]
  v_mfma_f32_16x16x32_bf16 v[44:47], a[124:127], v[92:95], v[44:47]
  v_mfma_f32_16x16x32_bf16 v[48:51], v[88:91], a[204:207], v[48:51]
  v_mfma_f32_16x16x32_bf16 v[52:55], v[92:95], a[204:207], v[52:55]
  v_mfma_f32_16x16x32_bf16 v[56:59], v[88:91], v[140:143], v[56:59]
  v_mfma_f32_16x16x32_bf16 v[60:63], v[92:95], v[140:143], v[60:63]
  ds_read_b128 v[88:91], v7 offset:14336
  ds_read_b128 v[92:95], v7 offset:34816
  s_waitcnt lgkmcnt(4)
  v_mfma_f32_16x16x32_bf16 v[32:35], a[48:51], v[72:75], v[32:35]
  v_mfma_f32_16x16x32_bf16 v[36:39], a[48:51], v[76:79], v[36:39]
  v_mfma_f32_16x16x32_bf16 v[40:43], a[128:131], v[72:75], v[40:43]
  v_mfma_f32_16x16x32_bf16 v[44:47], a[128:131], v[76:79], v[44:47]
  v_mfma_f32_16x16x32_bf16 v[48:51], v[72:75], a[208:211], v[48:51]
  v_mfma_f32_16x16x32_bf16 v[52:55], v[76:79], a[208:211], v[52:55]
  v_mfma_f32_16x16x32_bf16 v[56:59], v[72:75], v[144:147], v[56:59]
  v_mfma_f32_16x16x32_bf16 v[60:63], v[76:79], v[144:147], v[60:63]
  ds_read_b128 v[72:75], v7 offset:15360
  ds_read_b128 v[76:79], v7 offset:35840
  s_waitcnt lgkmcnt(4)
  v_mfma_f32_16x16x32_bf16 v[32:35], a[52:55], v[80:83], v[32:35]
  v_mfma_f32_16x16x32_bf16 v[36:39], a[52:55], v[84:87], v[36:39]
  v_mfma_f32_16x16x32_bf16 v[40:43], a[132:135], v[80:83], v[40:43]
  v_mfma_f32_16x16x32_bf16 v[44:47], a[132:135], v[84:87], v[44:47]
  v_mfma_f32_16x16x32_bf16 v[48:51], v[80:83], a[212:215], v[48:51]
  v_mfma_f32_16x16x32_bf16 v[52:55], v[84:87], a[212:215], v[52:55]
  v_mfma_f32_16x16x32_bf16 v[56:59], v[80:83], v[148:151], v[56:59]
  v_mfma_f32_16x16x32_bf16 v[60:63], v[84:87], v[148:151], v[60:63]
  ds_read_b128 v[80:83], v7 offset:16384
  ds_read_b128 v[84:87], v7 offset:36864
  s_waitcnt lgkmcnt(4)
  v_mfma_f32_16x16x32_bf16 v[32:35], a[56:59], v[88:91], v[32:35]
  v_mfma_f32_16x16x32_bf16 v[36:39], a[56:59], v[92:95], v[36:39]
  v_mfma_f32_16x16x32_bf16 v[40:43], a[136:139], v[88:91], v[40:43]
  v_mfma_f32_16x16x32_bf16 v[44:47], a[136:139], v[92:95], v[44:47]
  v_mfma_f32_16x16x32_bf16 v[48:51], v[88:91], a[216:219], v[48:51]
  v_mfma_f32_16x16x32_bf16 v[52:55], v[92:95], a[216:219], v[52:55]
  v_mfma_f32_16x16x32_bf16 v[56:59], v[88:91], v[152:155], v[56:59]
  v_mfma_f32_16x16x32_bf16 v[60:63], v[92:95], v[152:155], v[60:63]
  ds_read_b128 v[88:91], v7 offset:17408
  ds_read_b128 v[92:95], v7 offset:37888
  s_waitcnt lgkmcnt(4)
  v_mfma_f32_16x16x32_bf16 v[32:35], a[60:63], v[72:75], v[32:35]
  v_mfma_f32_16x16x32_bf16 v[36:39], a[60:63], v[76:79], v[36:39]
  v_mfma_f32_16x16x32_bf16 v[40:43], a[140:143], v[72:75], v[40:43]
  v_mfma_f32_16x16x32_bf16 v[44:47], a[140:143], v[76:79], v[44:47]
  v_mfma_f32_16x16x32_bf16 v[48:51], v[72:75], a[220:223], v[48:51]
  v_mfma_f32_16x16x32_bf16 v[52:55], v[76:79], a[220:223], v[52:55]
  v_mfma_f32_16x16x32_bf16 v[56:59], v[72:75], v[156:159], v[56:59]
  v_mfma_f32_16x16x32_bf16 v[60:63], v[76:79], v[156:159], v[60:63]
  ds_read_b128 v[72:75], v7 offset:18432
  ds_read_b128 v[76:79], v7 offset:38912
  s_waitcnt lgkmcnt(4)
  v_mfma_f32_16x16x32_bf16 v[32:35], a[64:67], v[80:83], v[32:35]
  v_mfma_f32_16x16x32_bf16 v[36:39], a[64:67], v[84:87], v[36:39]
  v_mfma_f32_16x16x32_bf16 v[40:43], a[144:147], v[80:83], v[40:43]
  v_mfma_f32_16x16x32_bf16 v[44:47], a[144:147], v[84:87], v[44:47]
  v_mfma_f32_16x16x32_bf16 v[48:51], v[80:83], a[224:227], v[48:51]
  v_mfma_f32_16x16x32_bf16 v[52:55], v[84:87], a[224:227], v[52:55]
  v_mfma_f32_16x16x32_bf16 v[56:59], v[80:83], v[160:163], v[56:59]
  v_mfma_f32_16x16x32_bf16 v[60:63], v[84:87], v[160:163], v[60:63]
  ds_read_b128 v[80:83], v7 offset:19456
  ds_read_b128 v[84:87], v7 offset:39936
  s_waitcnt lgkmcnt(4)
  v_mfma_f32_16x16x32_bf16 v[32:35], a[68:71], v[88:91], v[32:35]
  v_mfma_f32_16x16x32_bf16 v[36:39], a[68:71], v[92:95], v[36:39]
  v_mfma_f32_16x16x32_bf16 v[40:43], a[148:151], v[88:91], v[40:43]
  v_mfma_f32_16x16x32_bf16 v[44:47], a[148:151], v[92:95], v[44:47]
  v_mfma_f32_16x16x32_bf16 v[48:51], v[88:91], a[228:231], v[48:51]
  v_mfma_f32_16x16x32_bf16 v[52:55], v[92:95], a[228:231], v[52:55]
  v_mfma_f32_16x16x32_bf16 v[56:59], v[88:91], v[164:167], v[56:59]
  v_mfma_f32_16x16x32_bf16 v[60:63], v[92:95], v[164:167], v[60:63]
  s_waitcnt lgkmcnt(2)
  v_mfma_f32_16x16x32_bf16 v[32:35], a[72:75], v[72:75], v[32:35]
  v_mfma_f32_16x16x32_bf16 v[36:39], a[72:75], v[76:79], v[36:39]
  v_mfma_f32_16x16x32_bf16 v[40:43], a[152:155], v[72:75], v[40:43]
  v_mfma_f32_16x16x32_bf16 v[44:47], a[152:155], v[76:79], v[44:47]
  v_mfma_f32_16x16x32_bf16 v[48:51], v[72:75], a[232:235], v[48:51]
  v_mfma_f32_16x16x32_bf16 v[52:55], v[76:79], a[232:235], v[52:55]
  v_mfma_f32_16x16x32_bf16 v[56:59], v[72:75], v[168:171], v[56:59]
  v_mfma_f32_16x16x32_bf16 v[60:63], v[76:79], v[168:171], v[60:63]
  s_waitcnt lgkmcnt(0)
  v_mfma_f32_16x16x32_bf16 v[32:35], a[76:79], v[80:83], v[32:35]
  v_mfma_f32_16x16x32_bf16 v[36:39], a[76:79], v[84:87], v[36:39]
  v_mfma_f32_16x16x32_bf16 v[40:43], a[156:159], v[80:83], v[40:43]
  v_mfma_f32_16x16x32_bf16 v[44:47], a[156:159], v[84:87], v[44:47]
  v_mfma_f32_16x16x32_bf16 v[48:51], v[80:83], a[236:239], v[48:51]
  v_mfma_f32_16x16x32_bf16 v[52:55], v[84:87], a[236:239], v[52:55]
  v_mfma_f32_16x16x32_bf16 v[56:59], v[80:83], v[172:175], v[56:59]
  v_mfma_f32_16x16x32_bf16 v[60:63], v[84:87], v[172:175], v[60:63]
  s_nop 0
  v_cvt_pk_bf16_f32 v8, v32, v33
  v_cvt_pk_bf16_f32 v9, v34, v35
  v_cvt_pk_bf16_f32 v10, v40, v41
  v_cvt_pk_bf16_f32 v11, v42, v43
  s_add_u32 s34, s22, 0
  buffer_store_dwordx4 v[8:11], v1, s[4:7], s34 offen sc1
  v_cvt_pk_bf16_f32 v12, v36, v37
  v_cvt_pk_bf16_f32 v13, v38, v39
  v_cvt_pk_bf16_f32 v14, v44, v45
  v_cvt_pk_bf16_f32 v15, v46, v47
  s_add_u32 s34, s22, 6144
  buffer_store_dwordx4 v[12:15], v1, s[4:7], s34 offen sc1
  v_cvt_pk_bf16_f32 v8, v48, v49
  v_cvt_pk_bf16_f32 v9, v50, v51
  v_cvt_pk_bf16_f32 v10, v52, v53
  v_cvt_pk_bf16_f32 v11, v54, v55
  s_add_u32 s34, s23, 4096
  buffer_store_dwordx4 v[8:11], v1, s[4:7], s34 offen sc1
  v_cvt_pk_bf16_f32 v12, v56, v57
  v_cvt_pk_bf16_f32 v13, v58, v59
  v_cvt_pk_bf16_f32 v14, v60, v61
  v_cvt_pk_bf16_f32 v15, v62, v63
  s_add_u32 s34, s23, 5120
  buffer_store_dwordx4 v[12:15], v1, s[4:7], s34 offen sc1
  s_waitcnt vmcnt(0)
  s_barrier
  s_add_u32 s17, s17, 1
  s_cmp_lt_u32 s17, 64
  s_cbranch_scc1 reca_ptop264
  s_branch reca_exit1
reca_pw3_229:
  s_mov_b32 s17, 0
  s_mov_b32 s26, 0
  s_mul_i32 s20, s17, 40960
  s_add_u32 s20, s20, 84965376
  s_add_u32 m0, s26, 30720
  s_nop 0
  buffer_load_dwordx4 v1, s[4:7], s20 offen offset:0 lds
  buffer_load_dwordx4 v1, s[4:7], s20 offen offset:1024 lds
  buffer_load_dwordx4 v1, s[4:7], s20 offen offset:2048 lds
  buffer_load_dwordx4 v1, s[4:7], s20 offen offset:3072 lds
  s_add_u32 s20, s20, 4096
  s_add_u32 m0, s26, 34816
  s_nop 0
  buffer_load_dwordx4 v1, s[4:7], s20 offen offset:0 lds
  buffer_load_dwordx4 v1, s[4:7], s20 offen offset:1024 lds
  buffer_load_dwordx4 v1, s[4:7], s20 offen offset:2048 lds
  buffer_load_dwordx4 v1, s[4:7], s20 offen offset:3072 lds
  s_add_u32 s20, s20, 4096
  s_add_u32 m0, s26, 38912
  s_nop 0
  buffer_load_dwordx4 v1, s[4:7], s20 offen offset:0 lds
  buffer_load_dwordx4 v1, s[4:7], s20 offen offset:1024 lds
  s_mul_i32 s34, s15, 12
  s_mul_i32 s35, s16, 6
  s_add_u32 s34, s34, s35
  s_add_u32 s34, s34, 2
  s_mul_i32 s34, s34, 20480
  s_add_u32 s34, s34, 6291456
  buffer_load_dwordx4 a[0:3], v1, s[4:7], s34 offen offset:0
  buffer_load_dwordx4 a[4:7], v1, s[4:7], s34 offen offset:1024
  buffer_load_dwordx4 a[8:11], v1, s[4:7], s34 offen offset:2048
  buffer_load_dwordx4 a[12:15], v1, s[4:7], s34 offen offset:3072
  s_add_u32 s34, s34, 4096
  buffer_load_dwordx4 a[16:19], v1, s[4:7], s34 offen offset:0
  buffer_load_dwordx4 a[20:23], v1, s[4:7], s34 offen offset:1024
  buffer_load_dwordx4 a[24:27], v1, s[4:7], s34 offen offset:2048
  buffer_load_dwordx4 a[28:31], v1, s[4:7], s34 offen offset:3072
  s_add_u32 s34, s34, 4096
  buffer_load_dwordx4 a[32:35], v1, s[4:7], s34 offen offset:0
  buffer_load_dwordx4 a[36:39], v1, s[4:7], s34 offen offset:1024
  buffer_load_dwordx4 a[40:43], v1, s[4:7], s34 offen offset:2048
  buffer_load_dwordx4 a[44:47], v1, s[4:7], s34 offen offset:3072
  s_add_u32 s34, s34, 4096
  buffer_load_dwordx4 a[48:51], v1, s[4:7], s34 offen offset:0
  buffer_load_dwordx4 a[52:55], v1, s[4:7], s34 offen offset:1024
  buffer_load_dwordx4 a[56:59], v1, s[4:7], s34 offen offset:2048
  buffer_load_dwordx4 a[60:63], v1, s[4:7], s34 offen offset:3072
  s_add_u32 s34, s34, 4096
  buffer_load_dwordx4 a[64:67], v1, s[4:7], s34 offen offset:0
  buffer_load_dwordx4 a[68:71], v1, s[4:7], s34 offen offset:1024
  buffer_load_dwordx4 a[72:75], v1, s[4:7], s34 offen offset:2048
  buffer_load_dwordx4 a[76:79], v1, s[4:7], s34 offen offset:3072
  s_mul_i32 s34, s15, 12
  s_mul_i32 s35, s16, 6
  s_add_u32 s34, s34, s35
  s_add_u32 s34, s34, 3
  s_mul_i32 s34, s34, 20480
  s_add_u32 s34, s34, 6291456
  buffer_load_dwordx4 a[80:83], v1, s[4:7], s34 offen offset:0
  buffer_load_dwordx4 a[84:87], v1, s[4:7], s34 offen offset:1024
  buffer_load_dwordx4 a[88:91], v1, s[4:7], s34 offen offset:2048
  buffer_load_dwordx4 a[92:95], v1, s[4:7], s34 offen offset:3072
  s_add_u32 s34, s34, 4096
  buffer_load_dwordx4 a[96:99], v1, s[4:7], s34 offen offset:0
  buffer_load_dwordx4 a[100:103], v1, s[4:7], s34 offen offset:1024
  buffer_load_dwordx4 a[104:107], v1, s[4:7], s34 offen offset:2048
  buffer_load_dwordx4 a[108:111], v1, s[4:7], s34 offen offset:3072
  s_add_u32 s34, s34, 4096
  buffer_load_dwordx4 a[112:115], v1, s[4:7], s34 offen offset:0
  buffer_load_dwordx4 a[116:119], v1, s[4:7], s34 offen offset:1024
  buffer_load_dwordx4 a[120:123], v1, s[4:7], s34 offen offset:2048
  buffer_load_dwordx4 a[124:127], v1, s[4:7], s34 offen offset:3072
  s_add_u32 s34, s34, 4096
  buffer_load_dwordx4 a[128:131], v1, s[4:7], s34 offen offset:0
  buffer_load_dwordx4 a[132:135], v1, s[4:7], s34 offen offset:1024
  buffer_load_dwordx4 a[136:139], v1, s[4:7], s34 offen offset:2048
  buffer_load_dwordx4 a[140:143], v1, s[4:7], s34 offen offset:3072
  s_add_u32 s34, s34, 4096
  buffer_load_dwordx4 a[144:147], v1, s[4:7], s34 offen offset:0
  buffer_load_dwordx4 a[148:151], v1, s[4:7], s34 offen offset:1024
  buffer_load_dwordx4 a[152:155], v1, s[4:7], s34 offen offset:2048
  buffer_load_dwordx4 a[156:159], v1, s[4:7], s34 offen offset:3072
  s_waitcnt vmcnt(20)
  s_mul_i32 s34, s15, 12
  s_mul_i32 s35, s16, 6
  s_add_u32 s34, s34, s35
  s_add_u32 s34, s34, 4
  s_mul_i32 s34, s34, 20480
  s_add_u32 s34, s34, 6291456
  buffer_load_dwordx4 a[160:163], v1, s[4:7], s34 offen offset:0
  buffer_load_dwordx4 a[164:167], v1, s[4:7], s34 offen offset:1024
  buffer_load_dwordx4 a[168:171], v1, s[4:7], s34 offen offset:2048
  buffer_load_dwordx4 a[172:175], v1, s[4:7], s34 offen offset:3072
  s_add_u32 s34, s34, 4096
  buffer_load_dwordx4 a[176:179], v1, s[4:7], s34 offen offset:0
  buffer_load_dwordx4 a[180:183], v1, s[4:7], s34 offen offset:1024
  buffer_load_dwordx4 a[184:187], v1, s[4:7], s34 offen offset:2048
  buffer_load_dwordx4 a[188:191], v1, s[4:7], s34 offen offset:3072
  s_add_u32 s34, s34, 4096
  buffer_load_dwordx4 a[192:195], v1, s[4:7], s34 offen offset:0
  buffer_load_dwordx4 a[196:199], v1, s[4:7], s34 offen offset:1024
  buffer_load_dwordx4 a[200:203], v1, s[4:7], s34 offen offset:2048
  buffer_load_dwordx4 a[204:207], v1, s[4:7], s34 offen offset:3072
  s_add_u32 s34, s34, 4096
  buffer_load_dwordx4 a[208:211], v1, s[4:7], s34 offen offset:0
  buffer_load_dwordx4 a[212:215], v1, s[4:7], s34 offen offset:1024
  buffer_load_dwordx4 a[216:219], v1, s[4:7], s34 offen offset:2048
  buffer_load_dwordx4 a[220:223], v1, s[4:7], s34 offen offset:3072
  s_add_u32 s34, s34, 4096
  buffer_load_dwordx4 a[224:227], v1, s[4:7], s34 offen offset:0
  buffer_load_dwordx4 a[228:231], v1, s[4:7], s34 offen offset:1024
  buffer_load_dwordx4 a[232:235], v1, s[4:7], s34 offen offset:2048
  buffer_load_dwordx4 a[236:239], v1, s[4:7], s34 offen offset:3072
  s_waitcnt vmcnt(20)
  s_mul_i32 s34, s15, 12
  s_mul_i32 s35, s16, 6
  s_add_u32 s34, s34, s35
  s_add_u32 s34, s34, 5
  s_mul_i32 s34, s34, 20480
  s_add_u32 s34, s34, 6291456
  buffer_load_dwordx4 v[96:99], v1, s[4:7], s34 offen offset:0
  buffer_load_dwordx4 v[100:103], v1, s[4:7], s34 offen offset:1024
  buffer_load_dwordx4 v[104:107], v1, s[4:7], s34 offen offset:2048
  buffer_load_dwordx4 v[108:111], v1, s[4:7], s34 offen offset:3072
  s_add_u32 s34, s34, 4096
  buffer_load_dwordx4 v[112:115], v1, s[4:7], s34 offen offset:0
  buffer_load_dwordx4 v[116:119], v1, s[4:7], s34 offen offset:1024
  buffer_load_dwordx4 v[120:123], v1, s[4:7], s34 offen offset:2048
  buffer_load_dwordx4 v[124:127], v1, s[4:7], s34 offen offset:3072
  s_add_u32 s34, s34, 4096
  buffer_load_dwordx4 v[128:131], v1, s[4:7], s34 offen offset:0
  buffer_load_dwordx4 v[132:135], v1, s[4:7], s34 offen offset:1024
  buffer_load_dwordx4 v[136:139], v1, s[4:7], s34 offen offset:2048
  buffer_load_dwordx4 v[140:143], v1, s[4:7], s34 offen offset:3072
  s_add_u32 s34, s34, 4096
  buffer_load_dwordx4 v[144:147], v1, s[4:7], s34 offen offset:0
  buffer_load_dwordx4 v[148:151], v1, s[4:7], s34 offen offset:1024
  buffer_load_dwordx4 v[152:155], v1, s[4:7], s34 offen offset:2048
  buffer_load_dwordx4 v[156:159], v1, s[4:7], s34 offen offset:3072
  s_add_u32 s34, s34, 4096
  buffer_load_dwordx4 v[160:163], v1, s[4:7], s34 offen offset:0
  buffer_load_dwordx4 v[164:167], v1, s[4:7], s34 offen offset:1024
  buffer_load_dwordx4 v[168:171], v1, s[4:7], s34 offen offset:2048
  buffer_load_dwordx4 v[172:175], v1, s[4:7], s34 offen offset:3072
  s_waitcnt vmcnt(20)
  v_and_b32 v30, 7, v0
  v_lshlrev_b32 v30, 3, v30
reca_cens269:
  buffer_load_dwordx2 v[28:29], v30, s[8:11], 0 offen sc1
  s_waitcnt vmcnt(0)
  v_sad_u8 v31, v28, 0, 0
  v_sad_u8 v31, v29, 0, v31
  v_cmp_gt_u32 vcc, 32, v31
  s_cbranch_vccz reca_censok270
  s_sleep 8
  s_sub_u32 s18, s18, 1
  s_cbranch_scc0 reca_cens269
  s_mov_b32 s18, 0
reca_censok270:
  v_and_b32 v28, 0x20202020, v28
  v_and_b32 v29, 0x20202020, v29
  v_cmp_ne_u32 s[34:35], 0, v28
  v_cmp_ne_u32 s[36:37], 0, v29
  s_nop 3
  s_and_b32 s34, s34, 0xff
  s_and_b32 s36, s36, 0xff
  s_or_b32 s35, s34, s36
  s_lshr_b32 s37, s35, s13
  s_and_b32 s37, s37, 1
  s_xor_b32 s43, s37, 1
  s_cmp_eq_u32 s57, 0
  s_cselect_b32 s58, s36, s34
  v_mov_b32 v31, 0x80000000
  s_cmp_lg_u32 s43, 0
  s_cbranch_scc1 reca_pslow271
reca_ptop272:
  s_cmp_lt_u32 s17, 3
  s_cbranch_scc1 reca_pgo273
  s_sub_u32 s36, s17, 3
reca_ppoll274:
  buffer_load_dword v28, v4, s[4:7], s25 offen sc1
  s_waitcnt vmcnt(0)
  v_readfirstlane_b32 s34, v28
  s_nop 3
  s_cmp_ge_i32 s34, s36
  s_cbranch_scc1 reca_pgo273
  s_sleep 8
  s_sub_u32 s18, s18, 1
  s_cbranch_scc0 reca_ppoll274
  s_mov_b32 s18, 0
reca_pgo273:
  s_waitcnt vmcnt(0)
  s_barrier
  v_add_u32 v7, s26, v1
  s_xor_b32 s26, s26, 40960
  s_add_u32 s37, s17, 1
  s_cmp_ge_u32 s37, 64
  s_cbranch_scc1 reca_pnodma275
  s_mul_i32 s20, s37, 40960
  s_add_u32 s20, s20, 84965376
  s_add_u32 m0, s26, 30720
  s_nop 0
  buffer_load_dwordx4 v1, s[4:7], s20 offen offset:0 lds
  buffer_load_dwordx4 v1, s[4:7], s20 offen offset:1024 lds
  buffer_load_dwordx4 v1, s[4:7], s20 offen offset:2048 lds
  buffer_load_dwordx4 v1, s[4:7], s20 offen offset:3072 lds
  s_add_u32 s20, s20, 4096
  s_add_u32 m0, s26, 34816
  s_nop 0
  buffer_load_dwordx4 v1, s[4:7], s20 offen offset:0 lds
  buffer_load_dwordx4 v1, s[4:7], s20 offen offset:1024 lds
  buffer_load_dwordx4 v1, s[4:7], s20 offen offset:2048 lds
  buffer_load_dwordx4 v1, s[4:7], s20 offen offset:3072 lds
  s_add_u32 s20, s20, 4096
  s_add_u32 m0, s26, 38912
  s_nop 0
  buffer_load_dwordx4 v1, s[4:7], s20 offen offset:0 lds
  buffer_load_dwordx4 v1, s[4:7], s20 offen offset:1024 lds
reca_pnodma275:
  s_lshl_b32 s34, s15, 3
  s_and_b32 s35, s17, 7
  s_add_u32 s34, s34, s35
  s_mul_i32 s34, s34, 12288
  s_mul_i32 s35, s16, 3072
  s_add_u32 s35, s35, s34
  s_add_u32 s21, s35, 37748736
  s_add_u32 s22, s35, 44040192
  s_mul_i32 s35, s16, 6144
  s_add_u32 s35, s35, s34
  s_add_u32 s23, s35, 40894464
  ds_read_b128 v[72:75], v7 offset:0
  ds_read_b128 v[76:79], v7 offset:20480
  ds_read_b128 v[80:83], v7 offset:1024
  ds_read_b128 v[84:87], v7 offset:21504
  ds_read_b128 v[88:91], v7 offset:2048
  ds_read_b128 v[92:95], v7 offset:22528
  s_waitcnt lgkmcnt(4)
  v_mfma_f32_16x16x32_bf16 v[32:35], a[0:3], v[72:75], 0
  v_mfma_f32_16x16x32_bf16 v[36:39], a[0:3], v[76:79], 0
  v_mfma_f32_16x16x32_bf16 v[40:43], a[80:83], v[72:75], 0
  v_mfma_f32_16x16x32_bf16 v[44:47], a[80:83], v[76:79], 0
  v_mfma_f32_16x16x32_bf16 v[48:51], a[160:163], v[72:75], 0
  v_mfma_f32_16x16x32_bf16 v[52:55], a[160:163], v[76:79], 0
  v_mfma_f32_16x16x32_bf16 v[56:59], v[96:99], v[72:75], 0
  v_mfma_f32_16x16x32_bf16 v[60:63], v[96:99], v[76:79], 0
  ds_read_b128 v[72:75], v7 offset:3072
  ds_read_b128 v[76:79], v7 offset:23552
  s_waitcnt lgkmcnt(4)
  v_mfma_f32_16x16x32_bf16 v[32:35], a[4:7], v[80:83], v[32:35]
  v_mfma_f32_16x16x32_bf16 v[36:39], a[4:7], v[84:87], v[36:39]
  v_mfma_f32_16x16x32_bf16 v[40:43], a[84:87], v[80:83], v[40:43]
  v_mfma_f32_16x16x32_bf16 v[44:47], a[84:87], v[84:87], v[44:47]
  v_mfma_f32_16x16x32_bf16 v[48:51], a[164:167], v[80:83], v[48:51]
  v_mfma_f32_16x16x32_bf16 v[52:55], a[164:167], v[84:87], v[52:55]
  v_mfma_f32_16x16x32_bf16 v[56:59], v[100:103], v[80:83], v[56:59]
  v_mfma_f32_16x16x32_bf16 v[60:63], v[100:103], v[84:87], v[60:63]
  ds_read_b128 v[80:83], v7 offset:4096
  ds_read_b128 v[84:87], v7 offset:24576
  s_waitcnt lgkmcnt(4)
  v_mfma_f32_16x16x32_bf16 v[32:35], a[8:11], v[88:91], v[32:35]
  v_mfma_f32_16x16x32_bf16 v[36:39], a[8:11], v[92:95], v[36:39]
  v_mfma_f32_16x16x32_bf16 v[40:43], a[88:91], v[88:91], v[40:43]
  v_mfma_f32_16x16x32_bf16 v[44:47], a[88:91], v[92:95], v[44:47]
  v_mfma_f32_16x16x32_bf16 v[48:51], a[168:171], v[88:91], v[48:51]
  v_mfma_f32_16x16x32_bf16 v[52:55], a[168:171], v[92:95], v[52:55]
  v_mfma_f32_16x16x32_bf16 v[56:59], v[104:107], v[88:91], v[56:59]
  v_mfma_f32_16x16x32_bf16 v[60:63], v[104:107], v[92:95], v[60:63]
  ds_read_b128 v[88:91], v7 offset:5120
  ds_read_b128 v[92:95], v7 offset:25600
  s_waitcnt lgkmcnt(4)
  v_mfma_f32_16x16x32_bf16 v[32:35], a[12:15], v[72:75], v[32:35]
  v_mfma_f32_16x16x32_bf16 v[36:39], a[12:15], v[76:79], v[36:39]
  v_mfma_f32_16x16x32_bf16 v[40:43], a[92:95], v[72:75], v[40:43]
  v_mfma_f32_16x16x32_bf16 v[44:47], a[92:95], v[76:79], v[44:47]
  v_mfma_f32_16x16x32_bf16 v[48:51], a[172:175], v[72:75], v[48:51]
  v_mfma_f32_16x16x32_bf16 v[52:55], a[172:175], v[76:79], v[52:55]
  v_mfma_f32_16x16x32_bf16 v[56:59], v[108:111], v[72:75], v[56:59]
  v_mfma_f32_16x16x32_bf16 v[60:63], v[108:111], v[76:79], v[60:63]
  ds_read_b128 v[72:75], v7 offset:6144
  ds_read_b128 v[76:79], v7 offset:26624
  s_waitcnt lgkmcnt(4)
  v_mfma_f32_16x16x32_bf16 v[32:35], a[16:19], v[80:83], v[32:35]
  v_mfma_f32_16x16x32_bf16 v[36:39], a[16:19], v[84:87], v[36:39]
  v_mfma_f32_16x16x32_bf16 v[40:43], a[96:99], v[80:83], v[40:43]
  v_mfma_f32_16x16x32_bf16 v[44:47], a[96:99], v[84:87], v[44:47]
  v_mfma_f32_16x16x32_bf16 v[48:51], a[176:179], v[80:83], v[48:51]
  v_mfma_f32_16x16x32_bf16 v[52:55], a[176:179], v[84:87], v[52:55]
  v_mfma_f32_16x16x32_bf16 v[56:59], v[112:115], v[80:83], v[56:59]
  v_mfma_f32_16x16x32_bf16 v[60:63], v[112:115], v[84:87], v[60:63]
  ds_read_b128 v[80:83], v7 offset:7168
  ds_read_b128 v[84:87], v7 offset:27648
  s_waitcnt lgkmcnt(4)
  v_mfma_f32_16x16x32_bf16 v[32:35], a[20:23], v[88:91], v[32:35]
  v_mfma_f32_16x16x32_bf16 v[36:39], a[20:23], v[92:95], v[36:39]
  v_mfma_f32_16x16x32_bf16 v[40:43], a[100:103], v[88:91], v[40:43]
  v_mfma_f32_16x16x32_bf16 v[44:47], a[100:103], v[92:95], v[44:47]
  v_mfma_f32_16x16x32_bf16 v[48:51], a[180:183], v[88:91], v[48:51]
  v_mfma_f32_16x16x32_bf16 v[52:55], a[180:183], v[92:95], v[52:55]
  v_mfma_f32_16x16x32_bf16 v[56:59], v[116:119], v[88:91], v[56:59]
  v_mfma_f32_16x16x32_bf16 v[60:63], v[116:119], v[92:95], v[60:63]
  ds_read_b128 v[88:91], v7 offset:8192
  ds_read_b128 v[92:95], v7 offset:28672
  s_waitcnt lgkmcnt(4)
  v_mfma_f32_16x16x32_bf16 v[32:35], a[24:27], v[72:75], v[32:35]
  v_mfma_f32_16x16x32_bf16 v[36:39], a[24:27], v[76:79], v[36:39]
  v_mfma_f32_16x16x32_bf16 v[40:43], a[104:107], v[72:75], v[40:43]
  v_mfma_f32_16x16x32_bf16 v[44:47], a[104:107], v[76:79], v[44:47]
  v_mfma_f32_16x16x32_bf16 v[48:51], a[184:187], v[72:75], v[48:51]
  v_mfma_f32_16x16x32_bf16 v[52:55], a[184:187], v[76:79], v[52:55]
  v_mfma_f32_16x16x32_bf16 v[56:59], v[120:123], v[72:75], v[56:59]
  v_mfma_f32_16x16x32_bf16 v[60:63], v[120:123], v[76:79], v[60:63]
  ds_read_b128 v[72:75], v7 offset:9216
  ds_read_b128 v[76:79], v7 offset:29696
  s_waitcnt lgkmcnt(4)
  v_mfma_f32_16x16x32_bf16 v[32:35], a[28:31], v[80:83], v[32:35]
  v_mfma_f32_16x16x32_bf16 v[36:39], a[28:31], v[84:87], v[36:39]
  v_mfma_f32_16x16x32_bf16 v[40:43], a[108:111], v[80:83], v[40:43]
  v_mfma_f32_16x16x32_bf16 v[44:47], a[108:111], v[84:87], v[44:47]
  v_mfma_f32_16x16x32_bf16 v[48:51], a[188:191], v[80:83], v[48:51]
  v_mfma_f32_16x16x32_bf16 v[52:55], a[188:191], v[84:87], v[52:55]
  v_mfma_f32_16x16x32_bf16 v[56:59], v[124:127], v[80:83], v[56:59]
  v_mfma_f32_16x16x32_bf16 v[60:63], v[124:127], v[84:87], v[60:63]
  ds_read_b128 v[80:83], v7 offset:10240
  ds_read_b128 v[84:87], v7 offset:30720
  s_waitcnt lgkmcnt(4)
  v_mfma_f32_16x16x32_bf16 v[32:35], a[32:35], v[88:91], v[32:35]
  v_mfma_f32_16x16x32_bf16 v[36:39], a[32:35], v[92:95], v[36:39]
  v_mfma_f32_16x16x32_bf16 v[40:43], a[112:115], v[88:91], v[40:43]
  v_mfma_f32_16x16x32_bf16 v[44:47], a[112:115], v[92:95], v[44:47]
  v_mfma_f32_16x16x32_bf16 v[48:51], a[192:195], v[88:91], v[48:51]
  v_mfma_f32_16x16x32_bf16 v[52:55], a[192:195], v[92:95], v[52:55]
  v_mfma_f32_16x16x32_bf16 v[56:59], v[128:131], v[88:91], v[56:59]
  v_mfma_f32_16x16x32_bf16 v[60:63], v[128:131], v[92:95], v[60:63]
  ds_read_b128 v[88:91], v7 offset:11264
  ds_read_b128 v[92:95], v7 offset:31744
  s_waitcnt lgkmcnt(4)
  v_mfma_f32_16x16x32_bf16 v[32:35], a[36:39], v[72:75], v[32:35]
  v_mfma_f32_16x16x32_bf16 v[36:39], a[36:39], v[76:79], v[36:39]
  v_mfma_f32_16x16x32_bf16 v[40:43], a[116:119], v[72:75], v[40:43]
  v_mfma_f32_16x16x32_bf16 v[44:47], a[116:119], v[76:79], v[44:47]
  v_mfma_f32_16x16x32_bf16 v[48:51], a[196:199], v[72:75], v[48:51]
  v_mfma_f32_16x16x32_bf16 v[52:55], a[196:199], v[76:79], v[52:55]
  v_mfma_f32_16x16x32_bf16 v[56:59], v[132:135], v[72:75], v[56:59]
  v_mfma_f32_16x16x32_bf16 v[60:63], v[132:135], v[76:79], v[60:63]
  ds_read_b128 v[72:75], v7 offset:12288
  ds_read_b128 v[76:79], v7 offset:32768
  s_waitcnt lgkmcnt(4)
  v_mfma_f32_16x16x32_bf16 v[32:35], a[40:43], v[80:83], v[32:35]
  v_mfma_f32_16x16x32_bf16 v[36:39], a[40:43], v[84:87], v[36:39]
  v_mfma_f32_16x16x32_bf16 v[40:43], a[120:123], v[80:83], v[40:43]
  v_mfma_f32_16x16x32_bf16 v[44:47], a[120:123], v[84:87], v[44:47]
  v_mfma_f32_16x16x32_bf16 v[48:51], a[200:203], v[80:83], v[48:51]
  v_mfma_f32_16x16x32_bf16 v[52:55], a[200:203], v[84:87], v[52:55]
  v_mfma_f32_16x16x32_bf16 v[56:59], v[136:139], v[80:83], v[56:59]
  v_mfma_f32_16x16x32_bf16 v[60:63], v[136:139], v[84:87], v[60:63]
  ds_read_b128 v[80:83], v7 offset:13312
  ds_read_b128 v[84:87], v7 offset:33792
  s_waitcnt lgkmcnt(4)
  v_mfma_f32_16x16x32_bf16 v[32:35], a[44:47], v[88:91], v[32:35]
  v_mfma_f32_16x16x32_bf16 v[36:39], a[44:47], v[92:95], v[36:39]
  v_mfma_f32_16x16x32_bf16 v[40:43], a[124:127], v[88:91], v[40:43]
  v_mfma_f32_16x16x32_bf16 v[44:47], a[124:127], v[92:95], v[44:47]
  v_mfma_f32_16x16x32_bf16 v[48:51], a[204:207], v[88:91], v[48:51]
  v_mfma_f32_16x16x32_bf16 v[52:55], a[204:207], v[92:95], v[52:55]
  v_mfma_f32_16x16x32_bf16 v[56:59], v[140:143], v[88:91], v[56:59]
  v_mfma_f32_16x16x32_bf16 v[60:63], v[140:143], v[92:95], v[60:63]
  ds_read_b128 v[88:91], v7 offset:14336
  ds_read_b128 v[92:95], v7 offset:34816
  s_waitcnt lgkmcnt(4)
  v_mfma_f32_16x16x32_bf16 v[32:35], a[48:51], v[72:75], v[32:35]
  v_mfma_f32_16x16x32_bf16 v[36:39], a[48:51], v[76:79], v[36:39]
  v_mfma_f32_16x16x32_bf16 v[40:43], a[128:131], v[72:75], v[40:43]
  v_mfma_f32_16x16x32_bf16 v[44:47], a[128:131], v[76:79], v[44:47]
  v_mfma_f32_16x16x32_bf16 v[48:51], a[208:211], v[72:75], v[48:51]
  v_mfma_f32_16x16x32_bf16 v[52:55], a[208:211], v[76:79], v[52:55]
  v_mfma_f32_16x16x32_bf16 v[56:59], v[144:147], v[72:75], v[56:59]
  v_mfma_f32_16x16x32_bf16 v[60:63], v[144:147], v[76:79], v[60:63]
  ds_read_b128 v[72:75], v7 offset:15360
  ds_read_b128 v[76:79], v7 offset:35840
  s_waitcnt lgkmcnt(4)
  v_mfma_f32_16x16x32_bf16 v[32:35], a[52:55], v[80:83], v[32:35]
  v_mfma_f32_16x16x32_bf16 v[36:39], a[52:55], v[84:87], v[36:39]
  v_mfma_f32_16x16x32_bf16 v[40:43], a[132:135], v[80:83], v[40:43]
  v_mfma_f32_16x16x32_bf16 v[44:47], a[132:135], v[84:87], v[44:47]
  v_mfma_f32_16x16x32_bf16 v[48:51], a[212:215], v[80:83], v[48:51]
  v_mfma_f32_16x16x32_bf16 v[52:55], a[212:215], v[84:87], v[52:55]
  v_mfma_f32_16x16x32_bf16 v[56:59], v[148:151], v[80:83], v[56:59]
  v_mfma_f32_16x16x32_bf16 v[60:63], v[148:151], v[84:87], v[60:63]
  ds_read_b128 v[80:83], v7 offset:16384
  ds_read_b128 v[84:87], v7 offset:36864
  s_waitcnt lgkmcnt(4)
  v_mfma_f32_16x16x32_bf16 v[32:35], a[56:59], v[88:91], v[32:35]
  v_mfma_f32_16x16x32_bf16 v[36:39], a[56:59], v[92:95], v[36:39]
  v_mfma_f32_16x16x32_bf16 v[40:43], a[136:139], v[88:91], v[40:43]
  v_mfma_f32_16x16x32_bf16 v[44:47], a[136:139], v[92:95], v[44:47]
  v_mfma_f32_16x16x32_bf16 v[48:51], a[216:219], v[88:91], v[48:51]
  v_mfma_f32_16x16x32_bf16 v[52:55], a[216:219], v[92:95], v[52:55]
  v_mfma_f32_16x16x32_bf16 v[56:59], v[152:155], v[88:91], v[56:59]
  v_mfma_f32_16x16x32_bf16 v[60:63], v[152:155], v[92:95], v[60:63]
  ds_read_b128 v[88:91], v7 offset:17408
  ds_read_b128 v[92:95], v7 offset:37888
  s_waitcnt lgkmcnt(4)
  v_mfma_f32_16x16x32_bf16 v[32:35], a[60:63], v[72:75], v[32:35]
  v_mfma_f32_16x16x32_bf16 v[36:39], a[60:63], v[76:79], v[36:39]
  v_mfma_f32_16x16x32_bf16 v[40:43], a[140:143], v[72:75], v[40:43]
  v_mfma_f32_16x16x32_bf16 v[44:47], a[140:143], v[76:79], v[44:47]
  v_mfma_f32_16x16x32_bf16 v[48:51], a[220:223], v[72:75], v[48:51]
  v_mfma_f32_16x16x32_bf16 v[52:55], a[220:223], v[76:79], v[52:55]
  v_mfma_f32_16x16x32_bf16 v[56:59], v[156:159], v[72:75], v[56:59]
  v_mfma_f32_16x16x32_bf16 v[60:63], v[156:159], v[76:79], v[60:63]
  ds_read_b128 v[72:75], v7 offset:18432
  ds_read_b128 v[76:79], v7 offset:38912
  s_waitcnt lgkmcnt(4)
  v_mfma_f32_16x16x32_bf16 v[32:35], a[64:67], v[80:83], v[32:35]
  v_mfma_f32_16x16x32_bf16 v[36:39], a[64:67], v[84:87], v[36:39]
  v_mfma_f32_16x16x32_bf16 v[40:43], a[144:147], v[80:83], v[40:43]
  v_mfma_f32_16x16x32_bf16 v[44:47], a[144:147], v[84:87], v[44:47]
  v_mfma_f32_16x16x32_bf16 v[48:51], a[224:227], v[80:83], v[48:51]
  v_mfma_f32_16x16x32_bf16 v[52:55], a[224:227], v[84:87], v[52:55]
  v_mfma_f32_16x16x32_bf16 v[56:59], v[160:163], v[80:83], v[56:59]
  v_mfma_f32_16x16x32_bf16 v[60:63], v[160:163], v[84:87], v[60:63]
  ds_read_b128 v[80:83], v7 offset:19456
  ds_read_b128 v[84:87], v7 offset:39936
  s_waitcnt lgkmcnt(4)
  v_mfma_f32_16x16x32_bf16 v[32:35], a[68:71], v[88:91], v[32:35]
  v_mfma_f32_16x16x32_bf16 v[36:39], a[68:71], v[92:95], v[36:39]
  v_mfma_f32_16x16x32_bf16 v[40:43], a[148:151], v[88:91], v[40:43]
  v_mfma_f32_16x16x32_bf16 v[44:47], a[148:151], v[92:95], v[44:47]
  v_mfma_f32_16x16x32_bf16 v[48:51], a[228:231], v[88:91], v[48:51]
  v_mfma_f32_16x16x32_bf16 v[52:55], a[228:231], v[92:95], v[52:55]
  v_mfma_f32_16x16x32_bf16 v[56:59], v[164:167], v[88:91], v[56:59]
  v_mfma_f32_16x16x32_bf16 v[60:63], v[164:167], v[92:95], v[60:63]
  s_waitcnt lgkmcnt(2)
  v_mfma_f32_16x16x32_bf16 v[32:35], a[72:75], v[72:75], v[32:35]
  v_mfma_f32_16x16x32_bf16 v[36:39], a[72:75], v[76:79], v[36:39]
  v_mfma_f32_16x16x32_bf16 v[40:43], a[152:155], v[72:75], v[40:43]
  v_mfma_f32_16x16x32_bf16 v[44:47], a[152:155], v[76:79], v[44:47]
  v_mfma_f32_16x16x32_bf16 v[48:51], a[232:235], v[72:75], v[48:51]
  v_mfma_f32_16x16x32_bf16 v[52:55], a[232:235], v[76:79], v[52:55]
  v_mfma_f32_16x16x32_bf16 v[56:59], v[168:171], v[72:75], v[56:59]
  v_mfma_f32_16x16x32_bf16 v[60:63], v[168:171], v[76:79], v[60:63]
  s_waitcnt lgkmcnt(0)
  v_mfma_f32_16x16x32_bf16 v[32:35], a[76:79], v[80:83], v[32:35]
  v_mfma_f32_16x16x32_bf16 v[36:39], a[76:79], v[84:87], v[36:39]
  v_mfma_f32_16x16x32_bf16 v[40:43], a[156:159], v[80:83], v[40:43]
  v_mfma_f32_16x16x32_bf16 v[44:47], a[156:159], v[84:87], v[44:47]
  v_mfma_f32_16x16x32_bf16 v[48:51], a[236:239], v[80:83], v[48:51]
  v_mfma_f32_16x16x32_bf16 v[52:55], a[236:239], v[84:87], v[52:55]
  v_mfma_f32_16x16x32_bf16 v[56:59], v[172:175], v[80:83], v[56:59]
  v_mfma_f32_16x16x32_bf16 v[60:63], v[172:175], v[84:87], v[60:63]
  s_nop 0
  v_cvt_pk_bf16_f32 v8, v32, v33
  v_cvt_pk_bf16_f32 v9, v34, v35
  v_cvt_pk_bf16_f32 v10, v40, v41
  v_cvt_pk_bf16_f32 v11, v42, v43
  s_add_u32 s34, s22, 1024
  buffer_store_dwordx4 v[8:11], v1, s[4:7], s34 offen
  v_cvt_pk_bf16_f32 v12, v36, v37
  v_cvt_pk_bf16_f32 v13, v38, v39
  v_cvt_pk_bf16_f32 v14, v44, v45
  v_cvt_pk_bf16_f32 v15, v46, v47
  s_add_u32 s34, s22, 7168
  buffer_store_dwordx4 v[12:15], v1, s[4:7], s34 offen
  v_cvt_pk_bf16_f32 v8, v48, v49
  v_cvt_pk_bf16_f32 v9, v50, v51
  v_cvt_pk_bf16_f32 v10, v56, v57
  v_cvt_pk_bf16_f32 v11, v58, v59
  s_add_u32 s34, s22, 2048
  buffer_store_dwordx4 v[8:11], v1, s[4:7], s34 offen
  v_cvt_pk_bf16_f32 v12, v52, v53
  v_cvt_pk_bf16_f32 v13, v54, v55
  v_cvt_pk_bf16_f32 v14, v60, v61
  v_cvt_pk_bf16_f32 v15, v62, v63
  s_add_u32 s34, s22, 8192
  buffer_store_dwordx4 v[12:15], v1, s[4:7], s34 offen
  s_waitcnt vmcnt(0)
  s_barrier
  s_add_u32 s17, s17, 1
  s_cmp_lt_u32 s17, 64
  s_cbranch_scc1 reca_ptop272
  s_branch reca_exit1
reca_pslow271:
reca_ptop277:
  s_cmp_lt_u32 s17, 3
  s_cbranch_scc1 reca_pgo278
  s_sub_u32 s36, s17, 3
reca_ppoll279:
  buffer_load_dword v28, v4, s[4:7], s25 offen sc1
  s_waitcnt vmcnt(0)
  v_readfirstlane_b32 s34, v28
  s_nop 3
  s_cmp_ge_i32 s34, s36
  s_cbranch_scc1 reca_pgo278
  s_sleep 8
  s_sub_u32 s18, s18, 1
  s_cbranch_scc0 reca_ppoll279
  s_mov_b32 s18, 0
reca_pgo278:
  s_waitcnt vmcnt(0)
  s_barrier
  v_add_u32 v7, s26, v1
  s_xor_b32 s26, s26, 40960
  s_add_u32 s37, s17, 1
  s_cmp_ge_u32 s37, 64
  s_cbranch_scc1 reca_pnodma280
  s_mul_i32 s20, s37, 40960
  s_add_u32 s20, s20, 84965376
  s_add_u32 m0, s26, 30720
  s_nop 0
  buffer_load_dwordx4 v1, s[4:7], s20 offen offset:0 lds
  buffer_load_dwordx4 v1, s[4:7], s20 offen offset:1024 lds
  buffer_load_dwordx4 v1, s[4:7], s20 offen offset:2048 lds
  buffer_load_dwordx4 v1, s[4:7], s20 offen offset:3072 lds
  s_add_u32 s20, s20, 4096
  s_add_u32 m0, s26, 34816
  s_nop 0
  buffer_load_dwordx4 v1, s[4:7], s20 offen offset:0 lds
  buffer_load_dwordx4 v1, s[4:7], s20 offen offset:1024 lds
  buffer_load_dwordx4 v1, s[4:7], s20 offen offset:2048 lds
  buffer_load_dwordx4 v1, s[4:7], s20 offen offset:3072 lds
  s_add_u32 s20, s20, 4096
  s_add_u32 m0, s26, 38912
  s_nop 0
  buffer_load_dwordx4 v1, s[4:7], s20 offen offset:0 lds
  buffer_load_dwordx4 v1, s[4:7], s20 offen offset:1024 lds
reca_pnodma280:
  s_lshl_b32 s34, s15, 3
  s_and_b32 s35, s17, 7
  s_add_u32 s34, s34, s35
  s_mul_i32 s34, s34, 12288
  s_mul_i32 s35, s16, 3072
  s_add_u32 s35, s35, s34
  s_add_u32 s21, s35, 37748736
  s_add_u32 s22, s35, 44040192
  s_mul_i32 s35, s16, 6144
  s_add_u32 s35, s35, s34
  s_add_u32 s23, s35, 40894464
  ds_read_b128 v[72:75], v7 offset:0
  ds_read_b128 v[76:79], v7 offset:20480
  ds_read_b128 v[80:83], v7 offset:1024
  ds_read_b128 v[84:87], v7 offset:21504
  ds_read_b128 v[88:91], v7 offset:2048
  ds_read_b128 v[92:95], v7 offset:22528
  s_waitcnt lgkmcnt(4)
  v_mfma_f32_16x16x32_bf16 v[32:35], a[0:3], v[72:75], 0
  v_mfma_f32_16x16x32_bf16 v[36:39], a[0:3], v[76:79], 0
  v_mfma_f32_16x16x32_bf16 v[40:43], a[80:83], v[72:75], 0
  v_mfma_f32_16x16x32_bf16 v[44:47], a[80:83], v[76:79], 0
  v_mfma_f32_16x16x32_bf16 v[48:51], a[160:163], v[72:75], 0
  v_mfma_f32_16x16x32_bf16 v[52:55], a[160:163], v[76:79], 0
  v_mfma_f32_16x16x32_bf16 v[56:59], v[96:99], v[72:75], 0
  v_mfma_f32_16x16x32_bf16 v[60:63], v[96:99], v[76:79], 0
  ds_read_b128 v[72:75], v7 offset:3072
  ds_read_b128 v[76:79], v7 offset:23552
  s_waitcnt lgkmcnt(4)
  v_mfma_f32_16x16x32_bf16 v[32:35], a[4:7], v[80:83], v[32:35]
  v_mfma_f32_16x16x32_bf16 v[36:39], a[4:7], v[84:87], v[36:39]
  v_mfma_f32_16x16x32_bf16 v[40:43], a[84:87], v[80:83], v[40:43]
  v_mfma_f32_16x16x32_bf16 v[44:47], a[84:87], v[84:87], v[44:47]
  v_mfma_f32_16x16x32_bf16 v[48:51], a[164:167], v[80:83], v[48:51]
  v_mfma_f32_16x16x32_bf16 v[52:55], a[164:167], v[84:87], v[52:55]
  v_mfma_f32_16x16x32_bf16 v[56:59], v[100:103], v[80:83], v[56:59]
  v_mfma_f32_16x16x32_bf16 v[60:63], v[100:103], v[84:87], v[60:63]
  ds_read_b128 v[80:83], v7 offset:4096
  ds_read_b128 v[84:87], v7 offset:24576
  s_waitcnt lgkmcnt(4)
  v_mfma_f32_16x16x32_bf16 v[32:35], a[8:11], v[88:91], v[32:35]
  v_mfma_f32_16x16x32_bf16 v[36:39], a[8:11], v[92:95], v[36:39]
  v_mfma_f32_16x16x32_bf16 v[40:43], a[88:91], v[88:91], v[40:43]
  v_mfma_f32_16x16x32_bf16 v[44:47], a[88:91], v[92:95], v[44:47]
  v_mfma_f32_16x16x32_bf16 v[48:51], a[168:171], v[88:91], v[48:51]
  v_mfma_f32_16x16x32_bf16 v[52:55], a[168:171], v[92:95], v[52:55]
  v_mfma_f32_16x16x32_bf16 v[56:59], v[104:107], v[88:91], v[56:59]
  v_mfma_f32_16x16x32_bf16 v[60:63], v[104:107], v[92:95], v[60:63]
  ds_read_b128 v[88:91], v7 offset:5120
  ds_read_b128 v[92:95], v7 offset:25600
  s_waitcnt lgkmcnt(4)
  v_mfma_f32_16x16x32_bf16 v[32:35], a[12:15], v[72:75], v[32:35]
  v_mfma_f32_16x16x32_bf16 v[36:39], a[12:15], v[76:79], v[36:39]
  v_mfma_f32_16x16x32_bf16 v[40:43], a[92:95], v[72:75], v[40:43]
  v_mfma_f32_16x16x32_bf16 v[44:47], a[92:95], v[76:79], v[44:47]
  v_mfma_f32_16x16x32_bf16 v[48:51], a[172:175], v[72:75], v[48:51]
  v_mfma_f32_16x16x32_bf16 v[52:55], a[172:175], v[76:79], v[52:55]
  v_mfma_f32_16x16x32_bf16 v[56:59], v[108:111], v[72:75], v[56:59]
  v_mfma_f32_16x16x32_bf16 v[60:63], v[108:111], v[76:79], v[60:63]
  ds_read_b128 v[72:75], v7 offset:6144
  ds_read_b128 v[76:79], v7 offset:26624
  s_waitcnt lgkmcnt(4)
  v_mfma_f32_16x16x32_bf16 v[32:35], a[16:19], v[80:83], v[32:35]
  v_mfma_f32_16x16x32_bf16 v[36:39], a[16:19], v[84:87], v[36:39]
  v_mfma_f32_16x16x32_bf16 v[40:43], a[96:99], v[80:83], v[40:43]
  v_mfma_f32_16x16x32_bf16 v[44:47], a[96:99], v[84:87], v[44:47]
  v_mfma_f32_16x16x32_bf16 v[48:51], a[176:179], v[80:83], v[48:51]
  v_mfma_f32_16x16x32_bf16 v[52:55], a[176:179], v[84:87], v[52:55]
  v_mfma_f32_16x16x32_bf16 v[56:59], v[112:115], v[80:83], v[56:59]
  v_mfma_f32_16x16x32_bf16 v[60:63], v[112:115], v[84:87], v[60:63]
  ds_read_b128 v[80:83], v7 offset:7168
  ds_read_b128 v[84:87], v7 offset:27648
  s_waitcnt lgkmcnt(4)
  v_mfma_f32_16x16x32_bf16 v[32:35], a[20:23], v[88:91], v[32:35]
  v_mfma_f32_16x16x32_bf16 v[36:39], a[20:23], v[92:95], v[36:39]
  v_mfma_f32_16x16x32_bf16 v[40:43], a[100:103], v[88:91], v[40:43]
  v_mfma_f32_16x16x32_bf16 v[44:47], a[100:103], v[92:95], v[44:47]
  v_mfma_f32_16x16x32_bf16 v[48:51], a[180:183], v[88:91], v[48:51]
  v_mfma_f32_16x16x32_bf16 v[52:55], a[180:183], v[92:95], v[52:55]
  v_mfma_f32_16x16x32_bf16 v[56:59], v[116:119], v[88:91], v[56:59]
  v_mfma_f32_16x16x32_bf16 v[60:63], v[116:119], v[92:95], v[60:63]
  ds_read_b128 v[88:91], v7 offset:8192
  ds_read_b128 v[92:95], v7 offset:28672
  s_waitcnt lgkmcnt(4)
  v_mfma_f32_16x16x32_bf16 v[32:35], a[24:27], v[72:75], v[32:35]
  v_mfma_f32_16x16x32_bf16 v[36:39], a[24:27], v[76:79], v[36:39]
  v_mfma_f32_16x16x32_bf16 v[40:43], a[104:107], v[72:75], v[40:43]
  v_mfma_f32_16x16x32_bf16 v[44:47], a[104:107], v[76:79], v[44:47]
  v_mfma_f32_16x16x32_bf16 v[48:51], a[184:187], v[72:75], v[48:51]
  v_mfma_f32_16x16x32_bf16 v[52:55], a[184:187], v[76:79], v[52:55]
  v_mfma_f32_16x16x32_bf16 v[56:59], v[120:123], v[72:75], v[56:59]
  v_mfma_f32_16x16x32_bf16 v[60:63], v[120:123], v[76:79], v[60:63]
  ds_read_b128 v[72:75], v7 offset:9216
  ds_read_b128 v[76:79], v7 offset:29696
  s_waitcnt lgkmcnt(4)
  v_mfma_f32_16x16x32_bf16 v[32:35], a[28:31], v[80:83], v[32:35]
  v_mfma_f32_16x16x32_bf16 v[36:39], a[28:31], v[84:87], v[36:39]
  v_mfma_f32_16x16x32_bf16 v[40:43], a[108:111], v[80:83], v[40:43]
  v_mfma_f32_16x16x32_bf16 v[44:47], a[108:111], v[84:87], v[44:47]
  v_mfma_f32_16x16x32_bf16 v[48:51], a[188:191], v[80:83], v[48:51]
  v_mfma_f32_16x16x32_bf16 v[52:55], a[188:191], v[84:87], v[52:55]
  v_mfma_f32_16x16x32_bf16 v[56:59], v[124:127], v[80:83], v[56:59]
  v_mfma_f32_16x16x32_bf16 v[60:63], v[124:127], v[84:87], v[60:63]
  ds_read_b128 v[80:83], v7 offset:10240
  ds_read_b128 v[84:87], v7 offset:30720
  s_waitcnt lgkmcnt(4)
  v_mfma_f32_16x16x32_bf16 v[32:35], a[32:35], v[88:91], v[32:35]
  v_mfma_f32_16x16x32_bf16 v[36:39], a[32:35], v[92:95], v[36:39]
  v_mfma_f32_16x16x32_bf16 v[40:43], a[112:115], v[88:91], v[40:43]
  v_mfma_f32_16x16x32_bf16 v[44:47], a[112:115], v[92:95], v[44:47]
  v_mfma_f32_16x16x32_bf16 v[48:51], a[192:195], v[88:91], v[48:51]
  v_mfma_f32_16x16x32_bf16 v[52:55], a[192:195], v[92:95], v[52:55]
  v_mfma_f32_16x16x32_bf16 v[56:59], v[128:131], v[88:91], v[56:59]
  v_mfma_f32_16x16x32_bf16 v[60:63], v[128:131], v[92:95], v[60:63]
  ds_read_b128 v[88:91], v7 offset:11264
  ds_read_b128 v[92:95], v7 offset:31744
  s_waitcnt lgkmcnt(4)
  v_mfma_f32_16x16x32_bf16 v[32:35], a[36:39], v[72:75], v[32:35]
  v_mfma_f32_16x16x32_bf16 v[36:39], a[36:39], v[76:79], v[36:39]
  v_mfma_f32_16x16x32_bf16 v[40:43], a[116:119], v[72:75], v[40:43]
  v_mfma_f32_16x16x32_bf16 v[44:47], a[116:119], v[76:79], v[44:47]
  v_mfma_f32_16x16x32_bf16 v[48:51], a[196:199], v[72:75], v[48:51]
  v_mfma_f32_16x16x32_bf16 v[52:55], a[196:199], v[76:79], v[52:55]
  v_mfma_f32_16x16x32_bf16 v[56:59], v[132:135], v[72:75], v[56:59]
  v_mfma_f32_16x16x32_bf16 v[60:63], v[132:135], v[76:79], v[60:63]
  ds_read_b128 v[72:75], v7 offset:12288
  ds_read_b128 v[76:79], v7 offset:32768
  s_waitcnt lgkmcnt(4)
  v_mfma_f32_16x16x32_bf16 v[32:35], a[40:43], v[80:83], v[32:35]
  v_mfma_f32_16x16x32_bf16 v[36:39], a[40:43], v[84:87], v[36:39]
  v_mfma_f32_16x16x32_bf16 v[40:43], a[120:123], v[80:83], v[40:43]
  v_mfma_f32_16x16x32_bf16 v[44:47], a[120:123], v[84:87], v[44:47]
  v_mfma_f32_16x16x32_bf16 v[48:51], a[200:203], v[80:83], v[48:51]
  v_mfma_f32_16x16x32_bf16 v[52:55], a[200:203], v[84:87], v[52:55]
  v_mfma_f32_16x16x32_bf16 v[56:59], v[136:139], v[80:83], v[56:59]
  v_mfma_f32_16x16x32_bf16 v[60:63], v[136:139], v[84:87], v[60:63]
  ds_read_b128 v[80:83], v7 offset:13312
  ds_read_b128 v[84:87], v7 offset:33792
  s_waitcnt lgkmcnt(4)
  v_mfma_f32_16x16x32_bf16 v[32:35], a[44:47], v[88:91], v[32:35]
  v_mfma_f32_16x16x32_bf16 v[36:39], a[44:47], v[92:95], v[36:39]
  v_mfma_f32_16x16x32_bf16 v[40:43], a[124:127], v[88:91], v[40:43]
  v_mfma_f32_16x16x32_bf16 v[44:47], a[124:127], v[92:95], v[44:47]
  v_mfma_f32_16x16x32_bf16 v[48:51], a[204:207], v[88:91], v[48:51]
  v_mfma_f32_16x16x32_bf16 v[52:55], a[204:207], v[92:95], v[52:55]
  v_mfma_f32_16x16x32_bf16 v[56:59], v[140:143], v[88:91], v[56:59]
  v_mfma_f32_16x16x32_bf16 v[60:63], v[140:143], v[92:95], v[60:63]
  ds_read_b128 v[88:91], v7 offset:14336
  ds_read_b128 v[92:95], v7 offset:34816
  s_waitcnt lgkmcnt(4)
  v_mfma_f32_16x16x32_bf16 v[32:35], a[48:51], v[72:75], v[32:35]
  v_mfma_f32_16x16x32_bf16 v[36:39], a[48:51], v[76:79], v[36:39]
  v_mfma_f32_16x16x32_bf16 v[40:43], a[128:131], v[72:75], v[40:43]
  v_mfma_f32_16x16x32_bf16 v[44:47], a[128:131], v[76:79], v[44:47]
  v_mfma_f32_16x16x32_bf16 v[48:51], a[208:211], v[72:75], v[48:51]
  v_mfma_f32_16x16x32_bf16 v[52:55], a[208:211], v[76:79], v[52:55]
  v_mfma_f32_16x16x32_bf16 v[56:59], v[144:147], v[72:75], v[56:59]
  v_mfma_f32_16x16x32_bf16 v[60:63], v[144:147], v[76:79], v[60:63]
  ds_read_b128 v[72:75], v7 offset:15360
  ds_read_b128 v[76:79], v7 offset:35840
  s_waitcnt lgkmcnt(4)
  v_mfma_f32_16x16x32_bf16 v[32:35], a[52:55], v[80:83], v[32:35]
  v_mfma_f32_16x16x32_bf16 v[36:39], a[52:55], v[84:87], v[36:39]
  v_mfma_f32_16x16x32_bf16 v[40:43], a[132:135], v[80:83], v[40:43]
  v_mfma_f32_16x16x32_bf16 v[44:47], a[132:135], v[84:87], v[44:47]
  v_mfma_f32_16x16x32_bf16 v[48:51], a[212:215], v[80:83], v[48:51]
  v_mfma_f32_16x16x32_bf16 v[52:55], a[212:215], v[84:87], v[52:55]
  v_mfma_f32_16x16x32_bf16 v[56:59], v[148:151], v[80:83], v[56:59]
  v_mfma_f32_16x16x32_bf16 v[60:63], v[148:151], v[84:87], v[60:63]
  ds_read_b128 v[80:83], v7 offset:16384
  ds_read_b128 v[84:87], v7 offset:36864
  s_waitcnt lgkmcnt(4)
  v_mfma_f32_16x16x32_bf16 v[32:35], a[56:59], v[88:91], v[32:35]
  v_mfma_f32_16x16x32_bf16 v[36:39], a[56:59], v[92:95], v[36:39]
  v_mfma_f32_16x16x32_bf16 v[40:43], a[136:139], v[88:91], v[40:43]
  v_mfma_f32_16x16x32_bf16 v[44:47], a[136:139], v[92:95], v[44:47]
  v_mfma_f32_16x16x32_bf16 v[48:51], a[216:219], v[88:91], v[48:51]
  v_mfma_f32_16x16x32_bf16 v[52:55], a[216:219], v[92:95], v[52:55]
  v_mfma_f32_16x16x32_bf16 v[56:59], v[152:155], v[88:91], v[56:59]
  v_mfma_f32_16x16x32_bf16 v[60:63], v[152:155], v[92:95], v[60:63]
  ds_read_b128 v[88:91], v7 offset:17408
  ds_read_b128 v[92:95], v7 offset:37888
  s_waitcnt lgkmcnt(4)
  v_mfma_f32_16x16x32_bf16 v[32:35], a[60:63], v[72:75], v[32:35]
  v_mfma_f32_16x16x32_bf16 v[36:39], a[60:63], v[76:79], v[36:39]
  v_mfma_f32_16x16x32_bf16 v[40:43], a[140:143], v[72:75], v[40:43]
  v_mfma_f32_16x16x32_bf16 v[44:47], a[140:143], v[76:79], v[44:47]
  v_mfma_f32_16x16x32_bf16 v[48:51], a[220:223], v[72:75], v[48:51]
  v_mfma_f32_16x16x32_bf16 v[52:55], a[220:223], v[76:79], v[52:55]
  v_mfma_f32_16x16x32_bf16 v[56:59], v[156:159], v[72:75], v[56:59]
  v_mfma_f32_16x16x32_bf16 v[60:63], v[156:159], v[76:79], v[60:63]
  ds_read_b128 v[72:75], v7 offset:18432
  ds_read_b128 v[76:79], v7 offset:38912
  s_waitcnt lgkmcnt(4)
  v_mfma_f32_16x16x32_bf16 v[32:35], a[64:67], v[80:83], v[32:35]
  v_mfma_f32_16x16x32_bf16 v[36:39], a[64:67], v[84:87], v[36:39]
  v_mfma_f32_16x16x32_bf16 v[40:43], a[144:147], v[80:83], v[40:43]
  v_mfma_f32_16x16x32_bf16 v[44:47], a[144:147], v[84:87], v[44:47]
  v_mfma_f32_16x16x32_bf16 v[48:51], a[224:227], v[80:83], v[48:51]
  v_mfma_f32_16x16x32_bf16 v[52:55], a[224:227], v[84:87], v[52:55]
  v_mfma_f32_16x16x32_bf16 v[56:59], v[160:163], v[80:83], v[56:59]
  v_mfma_f32_16x16x32_bf16 v[60:63], v[160:163], v[84:87], v[60:63]
  ds_read_b128 v[80:83], v7 offset:19456
  ds_read_b128 v[84:87], v7 offset:39936
  s_waitcnt lgkmcnt(4)
  v_mfma_f32_16x16x32_bf16 v[32:35], a[68:71], v[88:91], v[32:35]
  v_mfma_f32_16x16x32_bf16 v[36:39], a[68:71], v[92:95], v[36:39]
  v_mfma_f32_16x16x32_bf16 v[40:43], a[148:151], v[88:91], v[40:43]
  v_mfma_f32_16x16x32_bf16 v[44:47], a[148:151], v[92:95], v[44:47]
  v_mfma_f32_16x16x32_bf16 v[48:51], a[228:231], v[88:91], v[48:51]
  v_mfma_f32_16x16x32_bf16 v[52:55], a[228:231], v[92:95], v[52:55]
  v_mfma_f32_16x16x32_bf16 v[56:59], v[164:167], v[88:91], v[56:59]
  v_mfma_f32_16x16x32_bf16 v[60:63], v[164:167], v[92:95], v[60:63]
  s_waitcnt lgkmcnt(2)
  v_mfma_f32_16x16x32_bf16 v[32:35], a[72:75], v[72:75], v[32:35]
  v_mfma_f32_16x16x32_bf16 v[36:39], a[72:75], v[76:79], v[36:39]
  v_mfma_f32_16x16x32_bf16 v[40:43], a[152:155], v[72:75], v[40:43]
  v_mfma_f32_16x16x32_bf16 v[44:47], a[152:155], v[76:79], v[44:47]
  v_mfma_f32_16x16x32_bf16 v[48:51], a[232:235], v[72:75], v[48:51]
  v_mfma_f32_16x16x32_bf16 v[52:55], a[232:235], v[76:79], v[52:55]
  v_mfma_f32_16x16x32_bf16 v[56:59], v[168:171], v[72:75], v[56:59]
  v_mfma_f32_16x16x32_bf16 v[60:63], v[168:171], v[76:79], v[60:63]
  s_waitcnt lgkmcnt(0)
  v_mfma_f32_16x16x32_bf16 v[32:35], a[76:79], v[80:83], v[32:35]
  v_mfma_f32_16x16x32_bf16 v[36:39], a[76:79], v[84:87], v[36:39]
  v_mfma_f32_16x16x32_bf16 v[40:43], a[156:159], v[80:83], v[40:43]
  v_mfma_f32_16x16x32_bf16 v[44:47], a[156:159], v[84:87], v[44:47]
  v_mfma_f32_16x16x32_bf16 v[48:51], a[236:239], v[80:83], v[48:51]
  v_mfma_f32_16x16x32_bf16 v[52:55], a[236:239], v[84:87], v[52:55]
  v_mfma_f32_16x16x32_bf16 v[56:59], v[172:175], v[80:83], v[56:59]
  v_mfma_f32_16x16x32_bf16 v[60:63], v[172:175], v[84:87], v[60:63]
  s_nop 0
  v_cvt_pk_bf16_f32 v8, v32, v33
  v_cvt_pk_bf16_f32 v9, v34, v35
  v_cvt_pk_bf16_f32 v10, v40, v41
  v_cvt_pk_bf16_f32 v11, v42, v43
  s_add_u32 s34, s22, 1024
  buffer_store_dwordx4 v[8:11], v1, s[4:7], s34 offen sc1
  v_cvt_pk_bf16_f32 v12, v36, v37
  v_cvt_pk_bf16_f32 v13, v38, v39
  v_cvt_pk_bf16_f32 v14, v44, v45
  v_cvt_pk_bf16_f32 v15, v46, v47
  s_add_u32 s34, s22, 7168
  buffer_store_dwordx4 v[12:15], v1, s[4:7], s34 offen sc1
  v_cvt_pk_bf16_f32 v8, v48, v49
  v_cvt_pk_bf16_f32 v9, v50, v51
  v_cvt_pk_bf16_f32 v10, v56, v57
  v_cvt_pk_bf16_f32 v11, v58, v59
  s_add_u32 s34, s22, 2048
  buffer_store_dwordx4 v[8:11], v1, s[4:7], s34 offen sc1
  v_cvt_pk_bf16_f32 v12, v52, v53
  v_cvt_pk_bf16_f32 v13, v54, v55
  v_cvt_pk_bf16_f32 v14, v60, v61
  v_cvt_pk_bf16_f32 v15, v62, v63
  s_add_u32 s34, s22, 8192
  buffer_store_dwordx4 v[12:15], v1, s[4:7], s34 offen sc1
  s_waitcnt vmcnt(0)
  s_barrier
  s_add_u32 s17, s17, 1
  s_cmp_lt_u32 s17, 64
  s_cbranch_scc1 reca_ptop277
  s_branch reca_exit1
reca_exit1:
reca_exitb3:
  s_endpgm
.globl fin_kernel
.p2align 8
.type fin_kernel,@function
fin_kernel:
  s_cmp_ge_u32 s2, 256
  s_cbranch_scc1 fin_exit1
  s_load_dwordx2 s[8:9], s[0:1], 96
  v_lshrrev_b32 v6, 6, v0
  v_and_b32 v7, 63, v0
  s_and_b32 s13, s2, 7
  v_readfirstlane_b32 s12, v6
  v_lshlrev_b32 v1, 4, v7
  v_add_u32 v2, 0x1000, v1
  v_add_u32 v3, 0x2000, v1
  s_lshr_b32 s14, s2, 3
  s_lshl_b32 s15, s13, 2
  s_add_u32 s15, s15, s12
  s_waitcnt lgkmcnt(0)
  s_mov_b32 s4, s8
  s_mov_b32 s5, s9
  s_mov_b32 s6, 0x10000000
  s_mov_b32 s7, 0x20000
  s_mov_b32 s27, 0x3dd53b95
  v_and_b32 v6, 15, v7
  v_lshrrev_b32 v8, 4, v7
  v_mov_b32 v9, 0x80000000
  v_lshlrev_b32 v10, 4, v6
  v_lshl_add_u32 v10, v8, 7, v10
  v_cmp_gt_u32 vcc, 8, v6
  s_nop 1
  v_cndmask_b32 v4, v9, v10, vcc
  v_lshlrev_b32 v10, 3, v7
  v_cmp_gt_u32 vcc, 32, v7
  s_nop 1
  v_cndmask_b32 v5, v9, v10, vcc
  v_mov_b32 v10, 0xf149f2ca
  v_cmp_le_u32 vcc, 2, v8
  s_nop 1
  v_cndmask_b32 v12, 0, v10, vcc
  v_mov_b32 v13, v12
  v_mov_b32 v14, v12
  v_mov_b32 v15, v12
  v_lshlrev_b32 v11, 2, v8
  v_add_u32 v7, 0, v11
  v_cmp_gt_u32 vcc, v7, v6
  s_nop 1
  v_cndmask_b32 v16, 0, v10, vcc
  v_add_u32 v7, 1, v11
  v_cmp_gt_u32 vcc, v7, v6
  s_nop 1
  v_cndmask_b32 v17, 0, v10, vcc
  v_add_u32 v7, 2, v11
  v_cmp_gt_u32 vcc, v7, v6
  s_nop 1
  v_cndmask_b32 v18, 0, v10, vcc
  v_add_u32 v7, 3, v11
  v_cmp_gt_u32 vcc, v7, v6
  s_nop 1
  v_cndmask_b32 v19, 0, v10, vcc
  v_mov_b32 v20, 0x3f803f80
  v_mov_b32 v21, 0x3f803f80
  v_mov_b32 v22, 0x3f803f80
  v_mov_b32 v23, 0x3f803f80
  s_mul_i32 s16, s12, 6144
  v_add_u32 v240, s16, v1
  v_add_u32 v241, 49152, v240
  s_mul_i32 s16, s12, 10
  s_mul_i32 s16, s16, 192
  s_mul_i32 s17, s13, 24
  s_add_u32 s16, s16, s17
  s_lshl_b32 s16, s16, 10
  s_add_u32 s16, s16, 29884416
  s_add_u32 s30, s16, 0
  s_add_u32 s31, s16, 196608
  s_add_u32 s32, s16, 393216
  s_add_u32 s33, s16, 589824
  s_add_u32 s34, s16, 786432
  s_add_u32 s35, s16, 983040
  s_add_u32 s36, s16, 1179648
  s_add_u32 s37, s16, 1376256
  s_add_u32 s38, s16, 1572864
  s_add_u32 s39, s16, 1769472
  s_cmp_lt_u32 s14, 30
  s_cbranch_scc1 fin_odma3
  s_lshl_b32 s17, s14, 1
  s_add_u32 s17, s17, 0
  s_and_b32 s17, s17, 7
  s_lshl_b32 s16, s15, 3
  s_add_u32 s16, s16, s17
  s_mul_i32 s16, s16, 12288
  s_add_u32 s20, s16, 44040192
  s_add_u32 s21, s16, 37748736
  s_add_u32 s22, s16, 40894464
  s_lshl_b32 s17, s17, 5
  s_add_u32 s17, s17, s15
  s_mul_i32 s17, s17, 3072
  s_add_u32 s23, s17, 47185920
  s_add_u32 s24, s17, 47972352
  s_lshl_b32 s17, s14, 1
  s_add_u32 s17, s17, 1
  s_and_b32 s17, s17, 7
  s_lshl_b32 s16, s15, 3
  s_add_u32 s16, s16, s17
  s_mul_i32 s16, s16, 12288
  s_add_u32 s40, s16, 44040192
  s_add_u32 s41, s16, 37748736
  s_add_u32 s42, s16, 40894464
  s_lshl_b32 s17, s17, 5
  s_add_u32 s17, s17, s15
  s_mul_i32 s17, s17, 3072
  s_add_u32 s43, s17, 47185920
  s_add_u32 s44, s17, 47972352
  buffer_load_dwordx4 v[136:139], v1, s[4:7], s21 offen offset:0
  buffer_load_dwordx4 v[140:143], v1, s[4:7], s21 offen offset:1024
  buffer_load_dwordx4 v[144:147], v1, s[4:7], s21 offen offset:2048
  buffer_load_dwordx4 v[148:151], v1, s[4:7], s21 offen offset:3072
  buffer_load_dwordx4 v[152:155], v2, s[4:7], s21 offen offset:0
  buffer_load_dwordx4 v[156:159], v2, s[4:7], s21 offen offset:1024
  buffer_load_dwordx4 v[160:163], v2, s[4:7], s21 offen offset:2048
  buffer_load_dwordx4 v[164:167], v2, s[4:7], s21 offen offset:3072
  buffer_load_dwordx4 v[168:171], v3, s[4:7], s21 offen offset:0
  buffer_load_dwordx4 v[172:175], v3, s[4:7], s21 offen offset:1024
  buffer_load_dwordx4 v[176:179], v3, s[4:7], s21 offen offset:2048
  buffer_load_dwordx4 v[180:183], v3, s[4:7], s21 offen offset:3072
  buffer_load_dwordx4 v[184:187], v4, s[4:7], s23 offen offset:0
  buffer_load_dwordx4 v[188:191], v4, s[4:7], s23 offen offset:512
  buffer_load_dwordx4 v[192:195], v4, s[4:7], s23 offen offset:1024
  buffer_load_dwordx4 v[196:199], v4, s[4:7], s23 offen offset:1536
  buffer_load_dwordx4 v[200:203], v4, s[4:7], s23 offen offset:2048
  buffer_load_dwordx4 v[204:207], v4, s[4:7], s23 offen offset:2560
  buffer_load_dwordx4 v[88:91], v1, s[4:7], s20 offen offset:0
  buffer_load_dwordx4 v[92:95], v1, s[4:7], s20 offen offset:1024
  buffer_load_dwordx4 v[96:99], v1, s[4:7], s20 offen offset:2048
  buffer_load_dwordx4 v[100:103], v1, s[4:7], s20 offen offset:3072
  buffer_load_dwordx4 v[104:107], v2, s[4:7], s20 offen offset:0
  buffer_load_dwordx4 v[108:111], v2, s[4:7], s20 offen offset:1024
  buffer_load_dwordx4 v[112:115], v2, s[4:7], s20 offen offset:2048
  buffer_load_dwordx4 v[116:119], v2, s[4:7], s20 offen offset:3072
  buffer_load_dwordx4 v[120:123], v3, s[4:7], s20 offen offset:0
  buffer_load_dwordx4 v[124:127], v3, s[4:7], s20 offen offset:1024
  buffer_load_dwordx4 v[128:131], v3, s[4:7], s20 offen offset:2048
  buffer_load_dwordx4 v[132:135], v3, s[4:7], s20 offen offset:3072
  buffer_load_dwordx4 a[0:3], v1, s[4:7], s41 offen offset:0
  buffer_load_dwordx4 a[4:7], v1, s[4:7], s41 offen offset:1024
  buffer_load_dwordx4 a[8:11], v1, s[4:7], s41 offen offset:2048
  buffer_load_dwordx4 a[12:15], v1, s[4:7], s41 offen offset:3072
  buffer_load_dwordx4 a[16:19], v2, s[4:7], s41 offen offset:0
  buffer_load_dwordx4 a[20:23], v2, s[4:7], s41 offen offset:1024
  buffer_load_dwordx4 a[24:27], v2, s[4:7], s41 offen offset:2048
  buffer_load_dwordx4 a[28:31], v2, s[4:7], s41 offen offset:3072
  buffer_load_dwordx4 a[32:35], v3, s[4:7], s41 offen offset:0
  buffer_load_dwordx4 a[36:39], v3, s[4:7], s41 offen offset:1024
  buffer_load_dwordx4 a[40:43], v3, s[4:7], s41 offen offset:2048
  buffer_load_dwordx4 a[44:47], v3, s[4:7], s41 offen offset:3072
  buffer_load_dwordx4 a[48:51], v4, s[4:7], s43 offen offset:0
  buffer_load_dwordx4 a[52:55], v4, s[4:7], s43 offen offset:512
  buffer_load_dwordx4 a[56:59], v4, s[4:7], s43 offen offset:1024
  buffer_load_dwordx4 a[60:63], v4, s[4:7], s43 offen offset:1536
  buffer_load_dwordx4 a[64:67], v4, s[4:7], s43 offen offset:2048
  buffer_load_dwordx4 a[68:71], v4, s[4:7], s43 offen offset:2560
  buffer_load_dwordx4 a[72:75], v1, s[4:7], s40 offen offset:0
  buffer_load_dwordx4 a[76:79], v1, s[4:7], s40 offen offset:1024
  buffer_load_dwordx4 a[80:83], v1, s[4:7], s40 offen offset:2048
  buffer_load_dwordx4 a[84:87], v1, s[4:7], s40 offen offset:3072
  buffer_load_dwordx4 a[88:91], v2, s[4:7], s40 offen offset:0
  buffer_load_dwordx4 a[92:95], v2, s[4:7], s40 offen offset:1024
  buffer_load_dwordx4 a[96:99], v2, s[4:7], s40 offen offset:2048
  buffer_load_dwordx4 a[100:103], v2, s[4:7], s40 offen offset:3072
  buffer_load_dwordx4 a[104:107], v3, s[4:7], s40 offen offset:0
  buffer_load_dwordx4 a[108:111], v3, s[4:7], s40 offen offset:1024
  buffer_load_dwordx4 a[112:115], v3, s[4:7], s40 offen offset:2048
  buffer_load_dwordx4 a[116:119], v3, s[4:7], s40 offen offset:3072
  s_waitcnt vmcnt(35)
  v_mfma_f32_16x16x32_bf16 v[24:27], v[184:187], v[88:91], v[12:15]
  v_mfma_f32_16x16x32_bf16 v[28:31], v[136:139], v[88:91], v[16:19]
  v_mfma_f32_16x16x32_bf16 v[32:35], v[184:187], v[112:115], v[12:15]
  v_mfma_f32_16x16x32_bf16 v[36:39], v[136:139], v[112:115], 0
  v_mfma_f32_16x16x32_bf16 v[40:43], v[160:163], v[112:115], v[16:19]
  s_waitcnt vmcnt(34)
  v_mfma_f32_16x16x32_bf16 v[24:27], v[188:191], v[92:95], v[24:27]
  v_mfma_f32_16x16x32_bf16 v[28:31], v[140:143], v[92:95], v[28:31]
  v_mfma_f32_16x16x32_bf16 v[32:35], v[188:191], v[116:119], v[32:35]
  v_mfma_f32_16x16x32_bf16 v[36:39], v[140:143], v[116:119], v[36:39]
  v_mfma_f32_16x16x32_bf16 v[40:43], v[164:167], v[116:119], v[40:43]
  s_waitcnt vmcnt(33)
  v_mfma_f32_16x16x32_bf16 v[24:27], v[192:195], v[96:99], v[24:27]
  v_mfma_f32_16x16x32_bf16 v[28:31], v[144:147], v[96:99], v[28:31]
  v_mfma_f32_16x16x32_bf16 v[32:35], v[192:195], v[120:123], v[32:35]
  v_mfma_f32_16x16x32_bf16 v[36:39], v[144:147], v[120:123], v[36:39]
  v_mfma_f32_16x16x32_bf16 v[40:43], v[168:171], v[120:123], v[40:43]
  s_waitcnt vmcnt(32)
  v_mfma_f32_16x16x32_bf16 v[24:27], v[196:199], v[100:103], v[24:27]
  v_mfma_f32_16x16x32_bf16 v[28:31], v[148:151], v[100:103], v[28:31]
  v_mfma_f32_16x16x32_bf16 v[32:35], v[196:199], v[124:127], v[32:35]
  v_mfma_f32_16x16x32_bf16 v[36:39], v[148:151], v[124:127], v[36:39]
  v_mfma_f32_16x16x32_bf16 v[40:43], v[172:175], v[124:127], v[40:43]
  s_waitcnt vmcnt(31)
  v_mfma_f32_16x16x32_bf16 v[24:27], v[200:203], v[104:107], v[24:27]
  v_mfma_f32_16x16x32_bf16 v[28:31], v[152:155], v[104:107], v[28:31]
  v_mfma_f32_16x16x32_bf16 v[32:35], v[200:203], v[128:131], v[32:35]
  v_mfma_f32_16x16x32_bf16 v[36:39], v[152:155], v[128:131], v[36:39]
  v_mfma_f32_16x16x32_bf16 v[40:43], v[176:179], v[128:131], v[40:43]
  s_waitcnt vmcnt(30)
  v_mfma_f32_16x16x32_bf16 v[24:27], v[204:207], v[108:111], v[24:27]
  v_mfma_f32_16x16x32_bf16 v[28:31], v[156:159], v[108:111], v[28:31]
  v_mfma_f32_16x16x32_bf16 v[32:35], v[204:207], v[132:135], v[32:35]
  v_mfma_f32_16x16x32_bf16 v[36:39], v[156:159], v[132:135], v[36:39]
  v_mfma_f32_16x16x32_bf16 v[40:43], v[180:183], v[132:135], v[40:43]
  buffer_load_dwordx4 v[88:91], v1, s[4:7], s22 offen offset:0
  buffer_load_dwordx4 v[92:95], v1, s[4:7], s22 offen offset:1024
  buffer_load_dwordx4 v[96:99], v1, s[4:7], s22 offen offset:2048
  buffer_load_dwordx4 v[100:103], v1, s[4:7], s22 offen offset:3072
  buffer_load_dwordx4 v[104:107], v2, s[4:7], s22 offen offset:0
  buffer_load_dwordx4 v[108:111], v2, s[4:7], s22 offen offset:1024
  buffer_load_dwordx4 v[112:115], v2, s[4:7], s22 offen offset:2048
  buffer_load_dwordx4 v[116:119], v2, s[4:7], s22 offen offset:3072
  buffer_load_dwordx4 v[120:123], v3, s[4:7], s22 offen offset:0
  buffer_load_dwordx4 v[124:127], v3, s[4:7], s22 offen offset:1024
  buffer_load_dwordx4 v[128:131], v3, s[4:7], s22 offen offset:2048
  buffer_load_dwordx4 v[132:135], v3, s[4:7], s22 offen offset:3072
  buffer_load_dwordx2 v[136:137], v5, s[4:7], s24 offen offset:0
  buffer_load_dwordx2 v[138:139], v5, s[4:7], s24 offen offset:256
  buffer_load_dwordx2 v[140:141], v5, s[4:7], s24 offen offset:512
  buffer_load_dwordx2 v[142:143], v5, s[4:7], s24 offen offset:768
  buffer_load_dwordx2 v[144:145], v5, s[4:7], s24 offen offset:1024
  buffer_load_dwordx2 v[146:147], v5, s[4:7], s24 offen offset:1280
  buffer_load_dwordx2 v[148:149], v5, s[4:7], s24 offen offset:1536
  buffer_load_dwordx2 v[150:151], v5, s[4:7], s24 offen offset:1792
  buffer_load_dwordx2 v[152:153], v5, s[4:7], s24 offen offset:2048
  buffer_load_dwordx2 v[154:155], v5, s[4:7], s24 offen offset:2304
  buffer_load_dwordx2 v[156:157], v5, s[4:7], s24 offen offset:2560
  buffer_load_dwordx2 v[158:159], v5, s[4:7], s24 offen offset:2816
  v_max3_f32 v6, v24, v25, v26
  v_max3_f32 v6, v6, v27, v28
  v_max3_f32 v6, v6, v29, v30
  v_max_f32 v6, v6, v31
  v_mov_b32 v7, v6
  s_nop 1
  v_permlane32_swap_b32 v6, v7
  v_max_f32 v6, v6, v7
  v_mov_b32 v7, v6
  s_nop 1
  v_permlane16_swap_b32 v6, v7
  v_max_f32 v6, v6, v7
  v_mul_f32 v6, s27, v6
  v_fma_f32 v24, v24, s27, -v6
  v_fma_f32 v25, v25, s27, -v6
  v_fma_f32 v26, v26, s27, -v6
  v_fma_f32 v27, v27, s27, -v6
  v_fma_f32 v28, v28, s27, -v6
  v_fma_f32 v29, v29, s27, -v6
  v_fma_f32 v30, v30, s27, -v6
  v_fma_f32 v31, v31, s27, -v6
  v_exp_f32 v24, v24
  v_exp_f32 v25, v25
  v_exp_f32 v26, v26
  v_exp_f32 v27, v27
  v_exp_f32 v28, v28
  v_exp_f32 v29, v29
  v_exp_f32 v30, v30
  v_exp_f32 v31, v31
  v_max3_f32 v8, v32, v33, v34
  v_max3_f32 v8, v8, v35, v36
  v_max3_f32 v8, v8, v37, v38
  v_max3_f32 v8, v8, v39, v40
  v_max3_f32 v8, v8, v41, v42
  v_max_f32 v8, v8, v43
  v_mov_b32 v10, v8
  s_nop 1
  v_permlane32_swap_b32 v8, v10
  v_max_f32 v8, v8, v10
  v_mov_b32 v10, v8
  s_nop 1
  v_permlane16_swap_b32 v8, v10
  v_max_f32 v8, v8, v10
  v_mul_f32 v8, s27, v8
  v_fma_f32 v32, v32, s27, -v8
  v_fma_f32 v33, v33, s27, -v8
  v_fma_f32 v34, v34, s27, -v8
  v_fma_f32 v35, v35, s27, -v8
  v_fma_f32 v36, v36, s27, -v8
  v_fma_f32 v37, v37, s27, -v8
  v_fma_f32 v38, v38, s27, -v8
  v_fma_f32 v39, v39, s27, -v8
  v_fma_f32 v40, v40, s27, -v8
  v_fma_f32 v41, v41, s27, -v8
  v_fma_f32 v42, v42, s27, -v8
  v_fma_f32 v43, v43, s27, -v8
  v_exp_f32 v32, v32
  v_exp_f32 v33, v33
  v_exp_f32 v34, v34
  v_exp_f32 v35, v35
  v_exp_f32 v36, v36
  v_exp_f32 v37, v37
  v_exp_f32 v38, v38
  v_exp_f32 v39, v39
  v_exp_f32 v40, v40
  v_exp_f32 v41, v41
  v_exp_f32 v42, v42
  v_exp_f32 v43, v43
  v_cvt_pk_bf16_f32 v44, v24, v25
  v_cvt_pk_bf16_f32 v45, v26, v27
  v_cvt_pk_bf16_f32 v46, v28, v29
  v_cvt_pk_bf16_f32 v47, v30, v31
  v_cvt_pk_bf16_f32 v48, v32, v33
  v_cvt_pk_bf16_f32 v49, v34, v35
  v_cvt_pk_bf16_f32 v50, v36, v37
  v_cvt_pk_bf16_f32 v51, v38, v39
  v_cvt_pk_bf16_f32 v52, v40, v41
  v_cvt_pk_bf16_f32 v53, v42, v43
  v_mfma_f32_16x16x16_bf16 v[56:59], v[20:21], v[44:45], 0
  v_mfma_f32_16x16x16_bf16 v[60:63], v[20:21], v[48:49], 0
  v_mfma_f32_16x16x16_bf16 v[56:59], v[20:21], v[46:47], v[56:59]
  v_mfma_f32_16x16x32_bf16 v[60:63], v[20:23], v[50:53], v[60:63]
  s_nop 6
  v_rcp_f32 v10, v56
  v_rcp_f32 v11, v60
  s_waitcnt vmcnt(0)
  v_mfma_f32_16x16x16_bf16 v[64:67], v[136:137], v[44:45], 0
  v_mfma_f32_16x16x16_bf16 v[68:71], v[136:137], v[48:49], 0
  v_mfma_f32_16x16x16_bf16 v[64:67], v[88:89], v[46:47], v[64:67]
  v_mfma_f32_16x16x32_bf16 v[68:71], v[88:91], v[50:53], v[68:71]
  v_mfma_f32_16x16x16_bf16 v[72:75], v[138:139], v[44:45], 0
  v_mfma_f32_16x16x16_bf16 v[76:79], v[138:139], v[48:49], 0
  v_mfma_f32_16x16x16_bf16 v[72:75], v[92:93], v[46:47], v[72:75]
  v_mfma_f32_16x16x32_bf16 v[76:79], v[92:95], v[50:53], v[76:79]
  s_nop 2
  v_mul_f32 v64, v64, v10
  v_mul_f32 v65, v65, v10
  v_mul_f32 v66, v66, v10
  v_mul_f32 v67, v67, v10
  v_cvt_pk_bf16_f32 v80, v64, v65
  v_cvt_pk_bf16_f32 v81, v66, v67
  v_mul_f32 v72, v72, v10
  v_mul_f32 v73, v73, v10
  v_mul_f32 v74, v74, v10
  v_mul_f32 v75, v75, v10
  v_cvt_pk_bf16_f32 v82, v72, v73
  v_cvt_pk_bf16_f32 v83, v74, v75
  ds_write_b128 v240, v[80:83] offset:0
  v_mul_f32 v68, v68, v11
  v_mul_f32 v69, v69, v11
  v_mul_f32 v70, v70, v11
  v_mul_f32 v71, v71, v11
  v_cvt_pk_bf16_f32 v84, v68, v69
  v_cvt_pk_bf16_f32 v85, v70, v71
  v_mul_f32 v76, v76, v11
  v_mul_f32 v77, v77, v11
  v_mul_f32 v78, v78, v11
  v_mul_f32 v79, v79, v11
  v_cvt_pk_bf16_f32 v86, v76, v77
  v_cvt_pk_bf16_f32 v87, v78, v79
  ds_write_b128 v240, v[84:87] offset:24576
  v_mfma_f32_16x16x16_bf16 v[64:67], v[140:141], v[44:45], 0
  v_mfma_f32_16x16x16_bf16 v[68:71], v[140:141], v[48:49], 0
  v_mfma_f32_16x16x16_bf16 v[64:67], v[96:97], v[46:47], v[64:67]
  v_mfma_f32_16x16x32_bf16 v[68:71], v[96:99], v[50:53], v[68:71]
  v_mfma_f32_16x16x16_bf16 v[72:75], v[142:143], v[44:45], 0
  v_mfma_f32_16x16x16_bf16 v[76:79], v[142:143], v[48:49], 0
  v_mfma_f32_16x16x16_bf16 v[72:75], v[100:101], v[46:47], v[72:75]
  v_mfma_f32_16x16x32_bf16 v[76:79], v[100:103], v[50:53], v[76:79]
  s_nop 2
  v_mul_f32 v64, v64, v10
  v_mul_f32 v65, v65, v10
  v_mul_f32 v66, v66, v10
  v_mul_f32 v67, v67, v10
  v_cvt_pk_bf16_f32 v80, v64, v65
  v_cvt_pk_bf16_f32 v81, v66, v67
  v_mul_f32 v72, v72, v10
  v_mul_f32 v73, v73, v10
  v_mul_f32 v74, v74, v10
  v_mul_f32 v75, v75, v10
  v_cvt_pk_bf16_f32 v82, v72, v73
  v_cvt_pk_bf16_f32 v83, v74, v75
  ds_write_b128 v240, v[80:83] offset:1024
  v_mul_f32 v68, v68, v11
  v_mul_f32 v69, v69, v11
  v_mul_f32 v70, v70, v11
  v_mul_f32 v71, v71, v11
  v_cvt_pk_bf16_f32 v84, v68, v69
  v_cvt_pk_bf16_f32 v85, v70, v71
  v_mul_f32 v76, v76, v11
  v_mul_f32 v77, v77, v11
  v_mul_f32 v78, v78, v11
  v_mul_f32 v79, v79, v11
  v_cvt_pk_bf16_f32 v86, v76, v77
  v_cvt_pk_bf16_f32 v87, v78, v79
  ds_write_b128 v240, v[84:87] offset:25600
  v_mfma_f32_16x16x16_bf16 v[64:67], v[144:145], v[44:45], 0
  v_mfma_f32_16x16x16_bf16 v[68:71], v[144:145], v[48:49], 0
  v_mfma_f32_16x16x16_bf16 v[64:67], v[104:105], v[46:47], v[64:67]
  v_mfma_f32_16x16x32_bf16 v[68:71], v[104:107], v[50:53], v[68:71]
  v_mfma_f32_16x16x16_bf16 v[72:75], v[146:147], v[44:45], 0
  v_mfma_f32_16x16x16_bf16 v[76:79], v[146:147], v[48:49], 0
  v_mfma_f32_16x16x16_bf16 v[72:75], v[108:109], v[46:47], v[72:75]
  v_mfma_f32_16x16x32_bf16 v[76:79], v[108:111], v[50:53], v[76:79]
  s_nop 2
  v_mul_f32 v64, v64, v10
  v_mul_f32 v65, v65, v10
  v_mul_f32 v66, v66, v10
  v_mul_f32 v67, v67, v10
  v_cvt_pk_bf16_f32 v80, v64, v65
  v_cvt_pk_bf16_f32 v81, v66, v67
  v_mul_f32 v72, v72, v10
  v_mul_f32 v73, v73, v10
  v_mul_f32 v74, v74, v10
  v_mul_f32 v75, v75, v10
  v_cvt_pk_bf16_f32 v82, v72, v73
  v_cvt_pk_bf16_f32 v83, v74, v75
  ds_write_b128 v240, v[80:83] offset:2048
  v_mul_f32 v68, v68, v11
  v_mul_f32 v69, v69, v11
  v_mul_f32 v70, v70, v11
  v_mul_f32 v71, v71, v11
  v_cvt_pk_bf16_f32 v84, v68, v69
  v_cvt_pk_bf16_f32 v85, v70, v71
  v_mul_f32 v76, v76, v11
  v_mul_f32 v77, v77, v11
  v_mul_f32 v78, v78, v11
  v_mul_f32 v79, v79, v11
  v_cvt_pk_bf16_f32 v86, v76, v77
  v_cvt_pk_bf16_f32 v87, v78, v79
  ds_write_b128 v240, v[84:87] offset:26624
  v_mfma_f32_16x16x16_bf16 v[64:67], v[148:149], v[44:45], 0
  v_mfma_f32_16x16x16_bf16 v[68:71], v[148:149], v[48:49], 0
  v_mfma_f32_16x16x16_bf16 v[64:67], v[112:113], v[46:47], v[64:67]
  v_mfma_f32_16x16x32_bf16 v[68:71], v[112:115], v[50:53], v[68:71]
  v_mfma_f32_16x16x16_bf16 v[72:75], v[150:151], v[44:45], 0
  v_mfma_f32_16x16x16_bf16 v[76:79], v[150:151], v[48:49], 0
  v_mfma_f32_16x16x16_bf16 v[72:75], v[116:117], v[46:47], v[72:75]
  v_mfma_f32_16x16x32_bf16 v[76:79], v[116:119], v[50:53], v[76:79]
  s_nop 2
  v_mul_f32 v64, v64, v10
  v_mul_f32 v65, v65, v10
  v_mul_f32 v66, v66, v10
  v_mul_f32 v67, v67, v10
  v_cvt_pk_bf16_f32 v80, v64, v65
  v_cvt_pk_bf16_f32 v81, v66, v67
  v_mul_f32 v72, v72, v10
  v_mul_f32 v73, v73, v10
  v_mul_f32 v74, v74, v10
  v_mul_f32 v75, v75, v10
  v_cvt_pk_bf16_f32 v82, v72, v73
  v_cvt_pk_bf16_f32 v83, v74, v75
  ds_write_b128 v240, v[80:83] offset:3072
  v_mul_f32 v68, v68, v11
  v_mul_f32 v69, v69, v11
  v_mul_f32 v70, v70, v11
  v_mul_f32 v71, v71, v11
  v_cvt_pk_bf16_f32 v84, v68, v69
  v_cvt_pk_bf16_f32 v85, v70, v71
  v_mul_f32 v76, v76, v11
  v_mul_f32 v77, v77, v11
  v_mul_f32 v78, v78, v11
  v_mul_f32 v79, v79, v11
  v_cvt_pk_bf16_f32 v86, v76, v77
  v_cvt_pk_bf16_f32 v87, v78, v79
  ds_write_b128 v240, v[84:87] offset:27648
  v_mfma_f32_16x16x16_bf16 v[64:67], v[152:153], v[44:45], 0
  v_mfma_f32_16x16x16_bf16 v[68:71], v[152:153], v[48:49], 0
  v_mfma_f32_16x16x16_bf16 v[64:67], v[120:121], v[46:47], v[64:67]
  v_mfma_f32_16x16x32_bf16 v[68:71], v[120:123], v[50:53], v[68:71]
  v_mfma_f32_16x16x16_bf16 v[72:75], v[154:155], v[44:45], 0
  v_mfma_f32_16x16x16_bf16 v[76:79], v[154:155], v[48:49], 0
  v_mfma_f32_16x16x16_bf16 v[72:75], v[124:125], v[46:47], v[72:75]
  v_mfma_f32_16x16x32_bf16 v[76:79], v[124:127], v[50:53], v[76:79]
  s_nop 2
  v_mul_f32 v64, v64, v10
  v_mul_f32 v65, v65, v10
  v_mul_f32 v66, v66, v10
  v_mul_f32 v67, v67, v10
  v_cvt_pk_bf16_f32 v80, v64, v65
  v_cvt_pk_bf16_f32 v81, v66, v67
  v_mul_f32 v72, v72, v10
  v_mul_f32 v73, v73, v10
  v_mul_f32 v74, v74, v10
  v_mul_f32 v75, v75, v10
  v_cvt_pk_bf16_f32 v82, v72, v73
  v_cvt_pk_bf16_f32 v83, v74, v75
  ds_write_b128 v240, v[80:83] offset:4096
  v_mul_f32 v68, v68, v11
  v_mul_f32 v69, v69, v11
  v_mul_f32 v70, v70, v11
  v_mul_f32 v71, v71, v11
  v_cvt_pk_bf16_f32 v84, v68, v69
  v_cvt_pk_bf16_f32 v85, v70, v71
  v_mul_f32 v76, v76, v11
  v_mul_f32 v77, v77, v11
  v_mul_f32 v78, v78, v11
  v_mul_f32 v79, v79, v11
  v_cvt_pk_bf16_f32 v86, v76, v77
  v_cvt_pk_bf16_f32 v87, v78, v79
  ds_write_b128 v240, v[84:87] offset:28672
  v_mfma_f32_16x16x16_bf16 v[64:67], v[156:157], v[44:45], 0
  v_mfma_f32_16x16x16_bf16 v[68:71], v[156:157], v[48:49], 0
  v_mfma_f32_16x16x16_bf16 v[64:67], v[128:129], v[46:47], v[64:67]
  v_mfma_f32_16x16x32_bf16 v[68:71], v[128:131], v[50:53], v[68:71]
  v_mfma_f32_16x16x16_bf16 v[72:75], v[158:159], v[44:45], 0
  v_mfma_f32_16x16x16_bf16 v[76:79], v[158:159], v[48:49], 0
  v_mfma_f32_16x16x16_bf16 v[72:75], v[132:133], v[46:47], v[72:75]
  v_mfma_f32_16x16x32_bf16 v[76:79], v[132:135], v[50:53], v[76:79]
  s_nop 2
  v_mul_f32 v64, v64, v10
  v_mul_f32 v65, v65, v10
  v_mul_f32 v66, v66, v10
  v_mul_f32 v67, v67, v10
  v_cvt_pk_bf16_f32 v80, v64, v65
  v_cvt_pk_bf16_f32 v81, v66, v67
  v_mul_f32 v72, v72, v10
  v_mul_f32 v73, v73, v10
  v_mul_f32 v74, v74, v10
  v_mul_f32 v75, v75, v10
  v_cvt_pk_bf16_f32 v82, v72, v73
  v_cvt_pk_bf16_f32 v83, v74, v75
  ds_write_b128 v240, v[80:83] offset:5120
  v_mul_f32 v68, v68, v11
  v_mul_f32 v69, v69, v11
  v_mul_f32 v70, v70, v11
  v_mul_f32 v71, v71, v11
  v_cvt_pk_bf16_f32 v84, v68, v69
  v_cvt_pk_bf16_f32 v85, v70, v71
  v_mul_f32 v76, v76, v11
  v_mul_f32 v77, v77, v11
  v_mul_f32 v78, v78, v11
  v_mul_f32 v79, v79, v11
  v_cvt_pk_bf16_f32 v86, v76, v77
  v_cvt_pk_bf16_f32 v87, v78, v79
  ds_write_b128 v240, v[84:87] offset:29696
  v_mfma_f32_16x16x32_bf16 v[24:27], a[48:51], a[72:75], v[12:15]
  v_mfma_f32_16x16x32_bf16 v[28:31], a[0:3], a[72:75], v[16:19]
  v_mfma_f32_16x16x32_bf16 v[32:35], a[48:51], a[96:99], v[12:15]
  v_mfma_f32_16x16x32_bf16 v[36:39], a[0:3], a[96:99], 0
  v_mfma_f32_16x16x32_bf16 v[40:43], a[24:27], a[96:99], v[16:19]
  v_mfma_f32_16x16x32_bf16 v[24:27], a[52:55], a[76:79], v[24:27]
  v_mfma_f32_16x16x32_bf16 v[28:31], a[4:7], a[76:79], v[28:31]
  v_mfma_f32_16x16x32_bf16 v[32:35], a[52:55], a[100:103], v[32:35]
  v_mfma_f32_16x16x32_bf16 v[36:39], a[4:7], a[100:103], v[36:39]
  v_mfma_f32_16x16x32_bf16 v[40:43], a[28:31], a[100:103], v[40:43]
  v_mfma_f32_16x16x32_bf16 v[24:27], a[56:59], a[80:83], v[24:27]
  v_mfma_f32_16x16x32_bf16 v[28:31], a[8:11], a[80:83], v[28:31]
  v_mfma_f32_16x16x32_bf16 v[32:35], a[56:59], a[104:107], v[32:35]
  v_mfma_f32_16x16x32_bf16 v[36:39], a[8:11], a[104:107], v[36:39]
  v_mfma_f32_16x16x32_bf16 v[40:43], a[32:35], a[104:107], v[40:43]
  v_mfma_f32_16x16x32_bf16 v[24:27], a[60:63], a[84:87], v[24:27]
  v_mfma_f32_16x16x32_bf16 v[28:31], a[12:15], a[84:87], v[28:31]
  v_mfma_f32_16x16x32_bf16 v[32:35], a[60:63], a[108:111], v[32:35]
  v_mfma_f32_16x16x32_bf16 v[36:39], a[12:15], a[108:111], v[36:39]
  v_mfma_f32_16x16x32_bf16 v[40:43], a[36:39], a[108:111], v[40:43]
  v_mfma_f32_16x16x32_bf16 v[24:27], a[64:67], a[88:91], v[24:27]
  v_mfma_f32_16x16x32_bf16 v[28:31], a[16:19], a[88:91], v[28:31]
  v_mfma_f32_16x16x32_bf16 v[32:35], a[64:67], a[112:115], v[32:35]
  v_mfma_f32_16x16x32_bf16 v[36:39], a[16:19], a[112:115], v[36:39]
  v_mfma_f32_16x16x32_bf16 v[40:43], a[40:43], a[112:115], v[40:43]
  v_mfma_f32_16x16x32_bf16 v[24:27], a[68:71], a[92:95], v[24:27]
  v_mfma_f32_16x16x32_bf16 v[28:31], a[20:23], a[92:95], v[28:31]
  v_mfma_f32_16x16x32_bf16 v[32:35], a[68:71], a[116:119], v[32:35]
  v_mfma_f32_16x16x32_bf16 v[36:39], a[20:23], a[116:119], v[36:39]
  v_mfma_f32_16x16x32_bf16 v[40:43], a[44:47], a[116:119], v[40:43]
  buffer_load_dwordx4 v[88:91], v1, s[4:7], s42 offen offset:0
  buffer_load_dwordx4 v[92:95], v1, s[4:7], s42 offen offset:1024
  buffer_load_dwordx4 v[96:99], v1, s[4:7], s42 offen offset:2048
  buffer_load_dwordx4 v[100:103], v1, s[4:7], s42 offen offset:3072
  buffer_load_dwordx4 v[104:107], v2, s[4:7], s42 offen offset:0
  buffer_load_dwordx4 v[108:111], v2, s[4:7], s42 offen offset:1024
  buffer_load_dwordx4 v[112:115], v2, s[4:7], s42 offen offset:2048
  buffer_load_dwordx4 v[116:119], v2, s[4:7], s42 offen offset:3072
  buffer_load_dwordx4 v[120:123], v3, s[4:7], s42 offen offset:0
  buffer_load_dwordx4 v[124:127], v3, s[4:7], s42 offen offset:1024
  buffer_load_dwordx4 v[128:131], v3, s[4:7], s42 offen offset:2048
  buffer_load_dwordx4 v[132:135], v3, s[4:7], s42 offen offset:3072
  buffer_load_dwordx2 v[136:137], v5, s[4:7], s44 offen offset:0
  buffer_load_dwordx2 v[138:139], v5, s[4:7], s44 offen offset:256
  buffer_load_dwordx2 v[140:141], v5, s[4:7], s44 offen offset:512
  buffer_load_dwordx2 v[142:143], v5, s[4:7], s44 offen offset:768
  buffer_load_dwordx2 v[144:145], v5, s[4:7], s44 offen offset:1024
  buffer_load_dwordx2 v[146:147], v5, s[4:7], s44 offen offset:1280
  buffer_load_dwordx2 v[148:149], v5, s[4:7], s44 offen offset:1536
  buffer_load_dwordx2 v[150:151], v5, s[4:7], s44 offen offset:1792
  buffer_load_dwordx2 v[152:153], v5, s[4:7], s44 offen offset:2048
  buffer_load_dwordx2 v[154:155], v5, s[4:7], s44 offen offset:2304
  buffer_load_dwordx2 v[156:157], v5, s[4:7], s44 offen offset:2560
  buffer_load_dwordx2 v[158:159], v5, s[4:7], s44 offen offset:2816
  v_max3_f32 v6, v24, v25, v26
  v_max3_f32 v6, v6, v27, v28
  v_max3_f32 v6, v6, v29, v30
  v_max_f32 v6, v6, v31
  v_mov_b32 v7, v6
  s_nop 1
  v_permlane32_swap_b32 v6, v7
  v_max_f32 v6, v6, v7
  v_mov_b32 v7, v6
  s_nop 1
  v_permlane16_swap_b32 v6, v7
  v_max_f32 v6, v6, v7
  v_mul_f32 v6, s27, v6
  v_fma_f32 v24, v24, s27, -v6
  v_fma_f32 v25, v25, s27, -v6
  v_fma_f32 v26, v26, s27, -v6
  v_fma_f32 v27, v27, s27, -v6
  v_fma_f32 v28, v28, s27, -v6
  v_fma_f32 v29, v29, s27, -v6
  v_fma_f32 v30, v30, s27, -v6
  v_fma_f32 v31, v31, s27, -v6
  v_exp_f32 v24, v24
  v_exp_f32 v25, v25
  v_exp_f32 v26, v26
  v_exp_f32 v27, v27
  v_exp_f32 v28, v28
  v_exp_f32 v29, v29
  v_exp_f32 v30, v30
  v_exp_f32 v31, v31
  v_max3_f32 v8, v32, v33, v34
  v_max3_f32 v8, v8, v35, v36
  v_max3_f32 v8, v8, v37, v38
  v_max3_f32 v8, v8, v39, v40
  v_max3_f32 v8, v8, v41, v42
  v_max_f32 v8, v8, v43
  v_mov_b32 v10, v8
  s_nop 1
  v_permlane32_swap_b32 v8, v10
  v_max_f32 v8, v8, v10
  v_mov_b32 v10, v8
  s_nop 1
  v_permlane16_swap_b32 v8, v10
  v_max_f32 v8, v8, v10
  v_mul_f32 v8, s27, v8
  v_fma_f32 v32, v32, s27, -v8
  v_fma_f32 v33, v33, s27, -v8
  v_fma_f32 v34, v34, s27, -v8
  v_fma_f32 v35, v35, s27, -v8
  v_fma_f32 v36, v36, s27, -v8
  v_fma_f32 v37, v37, s27, -v8
  v_fma_f32 v38, v38, s27, -v8
  v_fma_f32 v39, v39, s27, -v8
  v_fma_f32 v40, v40, s27, -v8
  v_fma_f32 v41, v41, s27, -v8
  v_fma_f32 v42, v42, s27, -v8
  v_fma_f32 v43, v43, s27, -v8
  v_exp_f32 v32, v32
  v_exp_f32 v33, v33
  v_exp_f32 v34, v34
  v_exp_f32 v35, v35
  v_exp_f32 v36, v36
  v_exp_f32 v37, v37
  v_exp_f32 v38, v38
  v_exp_f32 v39, v39
  v_exp_f32 v40, v40
  v_exp_f32 v41, v41
  v_exp_f32 v42, v42
  v_exp_f32 v43, v43
  v_cvt_pk_bf16_f32 v44, v24, v25
  v_cvt_pk_bf16_f32 v45, v26, v27
  v_cvt_pk_bf16_f32 v46, v28, v29
  v_cvt_pk_bf16_f32 v47, v30, v31
  v_cvt_pk_bf16_f32 v48, v32, v33
  v_cvt_pk_bf16_f32 v49, v34, v35
  v_cvt_pk_bf16_f32 v50, v36, v37
  v_cvt_pk_bf16_f32 v51, v38, v39
  v_cvt_pk_bf16_f32 v52, v40, v41
  v_cvt_pk_bf16_f32 v53, v42, v43
  v_mfma_f32_16x16x16_bf16 v[56:59], v[20:21], v[44:45], 0
  v_mfma_f32_16x16x16_bf16 v[60:63], v[20:21], v[48:49], 0
  v_mfma_f32_16x16x16_bf16 v[56:59], v[20:21], v[46:47], v[56:59]
  v_mfma_f32_16x16x32_bf16 v[60:63], v[20:23], v[50:53], v[60:63]
  s_nop 6
  v_rcp_f32 v10, v56
  v_rcp_f32 v11, v60
  s_waitcnt vmcnt(0)
  buffer_load_dwordx4 a[160:163], v1, s[4:7], s30 offen offset:0
  buffer_load_dwordx4 a[164:167], v1, s[4:7], s31 offen offset:0
  buffer_load_dwordx4 a[168:171], v1, s[4:7], s32 offen offset:0
  buffer_load_dwordx4 a[172:175], v1, s[4:7], s33 offen offset:0
  buffer_load_dwordx4 a[176:179], v1, s[4:7], s34 offen offset:0
  buffer_load_dwordx4 a[180:183], v1, s[4:7], s35 offen offset:0
  buffer_load_dwordx4 a[184:187], v1, s[4:7], s36 offen offset:0
  buffer_load_dwordx4 a[188:191], v1, s[4:7], s37 offen offset:0
  buffer_load_dwordx4 a[192:195], v1, s[4:7], s38 offen offset:0
  buffer_load_dwordx4 a[196:199], v1, s[4:7], s39 offen offset:0
  buffer_load_dwordx4 a[200:203], v1, s[4:7], s30 offen offset:1024
  buffer_load_dwordx4 a[204:207], v1, s[4:7], s31 offen offset:1024
  buffer_load_dwordx4 a[208:211], v1, s[4:7], s32 offen offset:1024
  buffer_load_dwordx4 a[212:215], v1, s[4:7], s33 offen offset:1024
  buffer_load_dwordx4 a[216:219], v1, s[4:7], s34 offen offset:1024
  buffer_load_dwordx4 a[220:223], v1, s[4:7], s35 offen offset:1024
  buffer_load_dwordx4 a[224:227], v1, s[4:7], s36 offen offset:1024
  buffer_load_dwordx4 a[228:231], v1, s[4:7], s37 offen offset:1024
  buffer_load_dwordx4 a[232:235], v1, s[4:7], s38 offen offset:1024
  buffer_load_dwordx4 a[236:239], v1, s[4:7], s39 offen offset:1024
  v_mfma_f32_16x16x16_bf16 v[64:67], v[136:137], v[44:45], 0
  v_mfma_f32_16x16x16_bf16 v[68:71], v[136:137], v[48:49], 0
  v_mfma_f32_16x16x16_bf16 v[64:67], v[88:89], v[46:47], v[64:67]
  v_mfma_f32_16x16x32_bf16 v[68:71], v[88:91], v[50:53], v[68:71]
  v_mfma_f32_16x16x16_bf16 v[72:75], v[138:139], v[44:45], 0
  v_mfma_f32_16x16x16_bf16 v[76:79], v[138:139], v[48:49], 0
  v_mfma_f32_16x16x16_bf16 v[72:75], v[92:93], v[46:47], v[72:75]
  v_mfma_f32_16x16x32_bf16 v[76:79], v[92:95], v[50:53], v[76:79]
  s_nop 2
  v_mul_f32 v64, v64, v10
  v_mul_f32 v65, v65, v10
  v_mul_f32 v66, v66, v10
  v_mul_f32 v67, v67, v10
  v_cvt_pk_bf16_f32 v80, v64, v65
  v_cvt_pk_bf16_f32 v81, v66, v67
  v_mul_f32 v72, v72, v10
  v_mul_f32 v73, v73, v10
  v_mul_f32 v74, v74, v10
  v_mul_f32 v75, v75, v10
  v_cvt_pk_bf16_f32 v82, v72, v73
  v_cvt_pk_bf16_f32 v83, v74, v75
  ds_write_b128 v241, v[80:83] offset:0
  v_mul_f32 v68, v68, v11
  v_mul_f32 v69, v69, v11
  v_mul_f32 v70, v70, v11
  v_mul_f32 v71, v71, v11
  v_cvt_pk_bf16_f32 v84, v68, v69
  v_cvt_pk_bf16_f32 v85, v70, v71
  v_mul_f32 v76, v76, v11
  v_mul_f32 v77, v77, v11
  v_mul_f32 v78, v78, v11
  v_mul_f32 v79, v79, v11
  v_cvt_pk_bf16_f32 v86, v76, v77
  v_cvt_pk_bf16_f32 v87, v78, v79
  ds_write_b128 v241, v[84:87] offset:24576
  v_mfma_f32_16x16x16_bf16 v[64:67], v[140:141], v[44:45], 0
  v_mfma_f32_16x16x16_bf16 v[68:71], v[140:141], v[48:49], 0
  v_mfma_f32_16x16x16_bf16 v[64:67], v[96:97], v[46:47], v[64:67]
  v_mfma_f32_16x16x32_bf16 v[68:71], v[96:99], v[50:53], v[68:71]
  v_mfma_f32_16x16x16_bf16 v[72:75], v[142:143], v[44:45], 0
  v_mfma_f32_16x16x16_bf16 v[76:79], v[142:143], v[48:49], 0
  v_mfma_f32_16x16x16_bf16 v[72:75], v[100:101], v[46:47], v[72:75]
  v_mfma_f32_16x16x32_bf16 v[76:79], v[100:103], v[50:53], v[76:79]
  s_nop 2
  v_mul_f32 v64, v64, v10
  v_mul_f32 v65, v65, v10
  v_mul_f32 v66, v66, v10
  v_mul_f32 v67, v67, v10
  v_cvt_pk_bf16_f32 v80, v64, v65
  v_cvt_pk_bf16_f32 v81, v66, v67
  v_mul_f32 v72, v72, v10
  v_mul_f32 v73, v73, v10
  v_mul_f32 v74, v74, v10
  v_mul_f32 v75, v75, v10
  v_cvt_pk_bf16_f32 v82, v72, v73
  v_cvt_pk_bf16_f32 v83, v74, v75
  ds_write_b128 v241, v[80:83] offset:1024
  v_mul_f32 v68, v68, v11
  v_mul_f32 v69, v69, v11
  v_mul_f32 v70, v70, v11
  v_mul_f32 v71, v71, v11
  v_cvt_pk_bf16_f32 v84, v68, v69
  v_cvt_pk_bf16_f32 v85, v70, v71
  v_mul_f32 v76, v76, v11
  v_mul_f32 v77, v77, v11
  v_mul_f32 v78, v78, v11
  v_mul_f32 v79, v79, v11
  v_cvt_pk_bf16_f32 v86, v76, v77
  v_cvt_pk_bf16_f32 v87, v78, v79
  ds_write_b128 v241, v[84:87] offset:25600
  v_mfma_f32_16x16x16_bf16 v[64:67], v[144:145], v[44:45], 0
  v_mfma_f32_16x16x16_bf16 v[68:71], v[144:145], v[48:49], 0
  v_mfma_f32_16x16x16_bf16 v[64:67], v[104:105], v[46:47], v[64:67]
  v_mfma_f32_16x16x32_bf16 v[68:71], v[104:107], v[50:53], v[68:71]
  v_mfma_f32_16x16x16_bf16 v[72:75], v[146:147], v[44:45], 0
  v_mfma_f32_16x16x16_bf16 v[76:79], v[146:147], v[48:49], 0
  v_mfma_f32_16x16x16_bf16 v[72:75], v[108:109], v[46:47], v[72:75]
  v_mfma_f32_16x16x32_bf16 v[76:79], v[108:111], v[50:53], v[76:79]
  s_nop 2
  v_mul_f32 v64, v64, v10
  v_mul_f32 v65, v65, v10
  v_mul_f32 v66, v66, v10
  v_mul_f32 v67, v67, v10
  v_cvt_pk_bf16_f32 v80, v64, v65
  v_cvt_pk_bf16_f32 v81, v66, v67
  v_mul_f32 v72, v72, v10
  v_mul_f32 v73, v73, v10
  v_mul_f32 v74, v74, v10
  v_mul_f32 v75, v75, v10
  v_cvt_pk_bf16_f32 v82, v72, v73
  v_cvt_pk_bf16_f32 v83, v74, v75
  ds_write_b128 v241, v[80:83] offset:2048
  v_mul_f32 v68, v68, v11
  v_mul_f32 v69, v69, v11
  v_mul_f32 v70, v70, v11
  v_mul_f32 v71, v71, v11
  v_cvt_pk_bf16_f32 v84, v68, v69
  v_cvt_pk_bf16_f32 v85, v70, v71
  v_mul_f32 v76, v76, v11
  v_mul_f32 v77, v77, v11
  v_mul_f32 v78, v78, v11
  v_mul_f32 v79, v79, v11
  v_cvt_pk_bf16_f32 v86, v76, v77
  v_cvt_pk_bf16_f32 v87, v78, v79
  ds_write_b128 v241, v[84:87] offset:26624
  v_mfma_f32_16x16x16_bf16 v[64:67], v[148:149], v[44:45], 0
  v_mfma_f32_16x16x16_bf16 v[68:71], v[148:149], v[48:49], 0
  v_mfma_f32_16x16x16_bf16 v[64:67], v[112:113], v[46:47], v[64:67]
  v_mfma_f32_16x16x32_bf16 v[68:71], v[112:115], v[50:53], v[68:71]
  v_mfma_f32_16x16x16_bf16 v[72:75], v[150:151], v[44:45], 0
  v_mfma_f32_16x16x16_bf16 v[76:79], v[150:151], v[48:49], 0
  v_mfma_f32_16x16x16_bf16 v[72:75], v[116:117], v[46:47], v[72:75]
  v_mfma_f32_16x16x32_bf16 v[76:79], v[116:119], v[50:53], v[76:79]
  s_nop 2
  v_mul_f32 v64, v64, v10
  v_mul_f32 v65, v65, v10
  v_mul_f32 v66, v66, v10
  v_mul_f32 v67, v67, v10
  v_cvt_pk_bf16_f32 v80, v64, v65
  v_cvt_pk_bf16_f32 v81, v66, v67
  v_mul_f32 v72, v72, v10
  v_mul_f32 v73, v73, v10
  v_mul_f32 v74, v74, v10
  v_mul_f32 v75, v75, v10
  v_cvt_pk_bf16_f32 v82, v72, v73
  v_cvt_pk_bf16_f32 v83, v74, v75
  ds_write_b128 v241, v[80:83] offset:3072
  v_mul_f32 v68, v68, v11
  v_mul_f32 v69, v69, v11
  v_mul_f32 v70, v70, v11
  v_mul_f32 v71, v71, v11
  v_cvt_pk_bf16_f32 v84, v68, v69
  v_cvt_pk_bf16_f32 v85, v70, v71
  v_mul_f32 v76, v76, v11
  v_mul_f32 v77, v77, v11
  v_mul_f32 v78, v78, v11
  v_mul_f32 v79, v79, v11
  v_cvt_pk_bf16_f32 v86, v76, v77
  v_cvt_pk_bf16_f32 v87, v78, v79
  ds_write_b128 v241, v[84:87] offset:27648
  v_mfma_f32_16x16x16_bf16 v[64:67], v[152:153], v[44:45], 0
  v_mfma_f32_16x16x16_bf16 v[68:71], v[152:153], v[48:49], 0
  v_mfma_f32_16x16x16_bf16 v[64:67], v[120:121], v[46:47], v[64:67]
  v_mfma_f32_16x16x32_bf16 v[68:71], v[120:123], v[50:53], v[68:71]
  v_mfma_f32_16x16x16_bf16 v[72:75], v[154:155], v[44:45], 0
  v_mfma_f32_16x16x16_bf16 v[76:79], v[154:155], v[48:49], 0
  v_mfma_f32_16x16x16_bf16 v[72:75], v[124:125], v[46:47], v[72:75]
  v_mfma_f32_16x16x32_bf16 v[76:79], v[124:127], v[50:53], v[76:79]
  s_nop 2
  v_mul_f32 v64, v64, v10
  v_mul_f32 v65, v65, v10
  v_mul_f32 v66, v66, v10
  v_mul_f32 v67, v67, v10
  v_cvt_pk_bf16_f32 v80, v64, v65
  v_cvt_pk_bf16_f32 v81, v66, v67
  v_mul_f32 v72, v72, v10
  v_mul_f32 v73, v73, v10
  v_mul_f32 v74, v74, v10
  v_mul_f32 v75, v75, v10
  v_cvt_pk_bf16_f32 v82, v72, v73
  v_cvt_pk_bf16_f32 v83, v74, v75
  ds_write_b128 v241, v[80:83] offset:4096
  v_mul_f32 v68, v68, v11
  v_mul_f32 v69, v69, v11
  v_mul_f32 v70, v70, v11
  v_mul_f32 v71, v71, v11
  v_cvt_pk_bf16_f32 v84, v68, v69
  v_cvt_pk_bf16_f32 v85, v70, v71
  v_mul_f32 v76, v76, v11
  v_mul_f32 v77, v77, v11
  v_mul_f32 v78, v78, v11
  v_mul_f32 v79, v79, v11
  v_cvt_pk_bf16_f32 v86, v76, v77
  v_cvt_pk_bf16_f32 v87, v78, v79
  ds_write_b128 v241, v[84:87] offset:28672
  v_mfma_f32_16x16x16_bf16 v[64:67], v[156:157], v[44:45], 0
  v_mfma_f32_16x16x16_bf16 v[68:71], v[156:157], v[48:49], 0
  v_mfma_f32_16x16x16_bf16 v[64:67], v[128:129], v[46:47], v[64:67]
  v_mfma_f32_16x16x32_bf16 v[68:71], v[128:131], v[50:53], v[68:71]
  v_mfma_f32_16x16x16_bf16 v[72:75], v[158:159], v[44:45], 0
  v_mfma_f32_16x16x16_bf16 v[76:79], v[158:159], v[48:49], 0
  v_mfma_f32_16x16x16_bf16 v[72:75], v[132:133], v[46:47], v[72:75]
  v_mfma_f32_16x16x32_bf16 v[76:79], v[132:135], v[50:53], v[76:79]
  s_nop 2
  v_mul_f32 v64, v64, v10
  v_mul_f32 v65, v65, v10
  v_mul_f32 v66, v66, v10
  v_mul_f32 v67, v67, v10
  v_cvt_pk_bf16_f32 v80, v64, v65
  v_cvt_pk_bf16_f32 v81, v66, v67
  v_mul_f32 v72, v72, v10
  v_mul_f32 v73, v73, v10
  v_mul_f32 v74, v74, v10
  v_mul_f32 v75, v75, v10
  v_cvt_pk_bf16_f32 v82, v72, v73
  v_cvt_pk_bf16_f32 v83, v74, v75
  ds_write_b128 v241, v[80:83] offset:5120
  v_mul_f32 v68, v68, v11
  v_mul_f32 v69, v69, v11
  v_mul_f32 v70, v70, v11
  v_mul_f32 v71, v71, v11
  v_cvt_pk_bf16_f32 v84, v68, v69
  v_cvt_pk_bf16_f32 v85, v70, v71
  v_mul_f32 v76, v76, v11
  v_mul_f32 v77, v77, v11
  v_mul_f32 v78, v78, v11
  v_mul_f32 v79, v79, v11
  v_cvt_pk_bf16_f32 v86, v76, v77
  v_cvt_pk_bf16_f32 v87, v78, v79
  ds_write_b128 v241, v[84:87] offset:29696
  s_branch fin_phase22
fin_odma3:
  s_lshl_b32 s16, s14, 2
  s_add_u32 s16, s16, s12
  s_mul_i32 s16, s16, 192
  s_mul_i32 s17, s13, 24
  s_add_u32 s16, s16, s17
  s_lshl_b32 s16, s16, 10
  s_add_u32 s16, s16, 57147392
  s_mul_i32 s17, s12, 24576
  s_add_u32 m0, s17, 0
  s_nop 0
  buffer_load_dwordx4 v1, s[4:7], s16 offen offset:0 lds
  buffer_load_dwordx4 v1, s[4:7], s16 offen offset:1024 lds
  buffer_load_dwordx4 v1, s[4:7], s16 offen offset:2048 lds
  buffer_load_dwordx4 v1, s[4:7], s16 offen offset:3072 lds
  s_add_u32 s16, s16, 4096
  s_add_u32 m0, s17, 4096
  s_nop 0
  buffer_load_dwordx4 v1, s[4:7], s16 offen offset:0 lds
  buffer_load_dwordx4 v1, s[4:7], s16 offen offset:1024 lds
  buffer_load_dwordx4 v1, s[4:7], s16 offen offset:2048 lds
  buffer_load_dwordx4 v1, s[4:7], s16 offen offset:3072 lds
  s_add_u32 s16, s16, 4096
  s_add_u32 m0, s17, 8192
  s_nop 0
  buffer_load_dwordx4 v1, s[4:7], s16 offen offset:0 lds
  buffer_load_dwordx4 v1, s[4:7], s16 offen offset:1024 lds
  buffer_load_dwordx4 v1, s[4:7], s16 offen offset:2048 lds
  buffer_load_dwordx4 v1, s[4:7], s16 offen offset:3072 lds
  s_add_u32 s16, s16, 4096
  s_add_u32 m0, s17, 12288
  s_nop 0
  buffer_load_dwordx4 v1, s[4:7], s16 offen offset:0 lds
  buffer_load_dwordx4 v1, s[4:7], s16 offen offset:1024 lds
  buffer_load_dwordx4 v1, s[4:7], s16 offen offset:2048 lds
  buffer_load_dwordx4 v1, s[4:7], s16 offen offset:3072 lds
  s_add_u32 s16, s16, 4096
  s_add_u32 m0, s17, 16384
  s_nop 0
  buffer_load_dwordx4 v1, s[4:7], s16 offen offset:0 lds
  buffer_load_dwordx4 v1, s[4:7], s16 offen offset:1024 lds
  buffer_load_dwordx4 v1, s[4:7], s16 offen offset:2048 lds
  buffer_load_dwordx4 v1, s[4:7], s16 offen offset:3072 lds
  s_add_u32 s16, s16, 4096
  s_add_u32 m0, s17, 20480
  s_nop 0
  buffer_load_dwordx4 v1, s[4:7], s16 offen offset:0 lds
  buffer_load_dwordx4 v1, s[4:7], s16 offen offset:1024 lds
  buffer_load_dwordx4 v1, s[4:7], s16 offen offset:2048 lds
  buffer_load_dwordx4 v1, s[4:7], s16 offen offset:3072 lds
  s_add_u32 s16, s16, 4096
  buffer_load_dwordx4 a[160:163], v1, s[4:7], s30 offen offset:0
  buffer_load_dwordx4 a[164:167], v1, s[4:7], s31 offen offset:0
  buffer_load_dwordx4 a[168:171], v1, s[4:7], s32 offen offset:0
  buffer_load_dwordx4 a[172:175], v1, s[4:7], s33 offen offset:0
  buffer_load_dwordx4 a[176:179], v1, s[4:7], s34 offen offset:0
  buffer_load_dwordx4 a[180:183], v1, s[4:7], s35 offen offset:0
  buffer_load_dwordx4 a[184:187], v1, s[4:7], s36 offen offset:0
  buffer_load_dwordx4 a[188:191], v1, s[4:7], s37 offen offset:0
  buffer_load_dwordx4 a[192:195], v1, s[4:7], s38 offen offset:0
  buffer_load_dwordx4 a[196:199], v1, s[4:7], s39 offen offset:0
  buffer_load_dwordx4 a[200:203], v1, s[4:7], s30 offen offset:1024
  buffer_load_dwordx4 a[204:207], v1, s[4:7], s31 offen offset:1024
  buffer_load_dwordx4 a[208:211], v1, s[4:7], s32 offen offset:1024
  buffer_load_dwordx4 a[212:215], v1, s[4:7], s33 offen offset:1024
  buffer_load_dwordx4 a[216:219], v1, s[4:7], s34 offen offset:1024
  buffer_load_dwordx4 a[220:223], v1, s[4:7], s35 offen offset:1024
  buffer_load_dwordx4 a[224:227], v1, s[4:7], s36 offen offset:1024
  buffer_load_dwordx4 a[228:231], v1, s[4:7], s37 offen offset:1024
  buffer_load_dwordx4 a[232:235], v1, s[4:7], s38 offen offset:1024
  buffer_load_dwordx4 a[236:239], v1, s[4:7], s39 offen offset:1024
  s_waitcnt vmcnt(20)
fin_phase22:
  s_waitcnt lgkmcnt(0)
  buffer_load_dwordx4 v[104:107], v1, s[4:7], s30 offen offset:2048
  buffer_load_dwordx4 v[108:111], v1, s[4:7], s31 offen offset:2048
  buffer_load_dwordx4 v[112:115], v1, s[4:7], s32 offen offset:2048
  buffer_load_dwordx4 v[116:119], v1, s[4:7], s33 offen offset:2048
  buffer_load_dwordx4 v[120:123], v1, s[4:7], s34 offen offset:2048
  buffer_load_dwordx4 v[124:127], v1, s[4:7], s35 offen offset:2048
  buffer_load_dwordx4 v[128:131], v1, s[4:7], s36 offen offset:2048
  buffer_load_dwordx4 v[132:135], v1, s[4:7], s37 offen offset:2048
  buffer_load_dwordx4 v[136:139], v1, s[4:7], s38 offen offset:2048
  buffer_load_dwordx4 v[140:143], v1, s[4:7], s39 offen offset:2048
  buffer_load_dwordx4 v[144:147], v1, s[4:7], s30 offen offset:3072
  buffer_load_dwordx4 v[148:151], v1, s[4:7], s31 offen offset:3072
  buffer_load_dwordx4 v[152:155], v1, s[4:7], s32 offen offset:3072
  buffer_load_dwordx4 v[156:159], v1, s[4:7], s33 offen offset:3072
  buffer_load_dwordx4 v[160:163], v1, s[4:7], s34 offen offset:3072
  buffer_load_dwordx4 v[164:167], v1, s[4:7], s35 offen offset:3072
  buffer_load_dwordx4 v[168:171], v1, s[4:7], s36 offen offset:3072
  buffer_load_dwordx4 v[172:175], v1, s[4:7], s37 offen offset:3072
  buffer_load_dwordx4 v[176:179], v1, s[4:7], s38 offen offset:3072
  buffer_load_dwordx4 v[180:183], v1, s[4:7], s39 offen offset:3072
  s_add_u32 s30, s30, 4096
  s_add_u32 s31, s31, 4096
  s_add_u32 s32, s32, 4096
  s_add_u32 s33, s33, 4096
  s_add_u32 s34, s34, 4096
  s_add_u32 s35, s35, 4096
  s_add_u32 s36, s36, 4096
  s_add_u32 s37, s37, 4096
  s_add_u32 s38, s38, 4096
  s_add_u32 s39, s39, 4096
  v_add_u32 v6, 49152, v1
  s_barrier
  ds_read_b128 v[184:187], v1 offset:0
  ds_read_b128 v[188:191], v1 offset:24576
  ds_read_b128 v[192:195], v6 offset:0
  ds_read_b128 v[196:199], v6 offset:24576
  s_waitcnt vmcnt(30)
  ds_read_b128 v[200:203], v1 offset:1024
  ds_read_b128 v[204:207], v1 offset:25600
  ds_read_b128 v[208:211], v6 offset:1024
  ds_read_b128 v[212:215], v6 offset:25600
  s_waitcnt lgkmcnt(4)
  v_mfma_f32_16x16x32_bf16 a[0:3], a[160:163], v[184:187], 0
  v_mfma_f32_16x16x32_bf16 a[4:7], a[160:163], v[188:191], 0
  v_mfma_f32_16x16x32_bf16 a[8:11], a[160:163], v[192:195], 0
  v_mfma_f32_16x16x32_bf16 a[12:15], a[160:163], v[196:199], 0
  v_mfma_f32_16x16x32_bf16 a[16:19], a[164:167], v[184:187], 0
  v_mfma_f32_16x16x32_bf16 a[20:23], a[164:167], v[188:191], 0
  v_mfma_f32_16x16x32_bf16 a[24:27], a[164:167], v[192:195], 0
  v_mfma_f32_16x16x32_bf16 a[28:31], a[164:167], v[196:199], 0
  v_mfma_f32_16x16x32_bf16 a[32:35], a[168:171], v[184:187], 0
  v_mfma_f32_16x16x32_bf16 a[36:39], a[168:171], v[188:191], 0
  v_mfma_f32_16x16x32_bf16 a[40:43], a[168:171], v[192:195], 0
  v_mfma_f32_16x16x32_bf16 a[44:47], a[168:171], v[196:199], 0
  v_mfma_f32_16x16x32_bf16 a[48:51], a[172:175], v[184:187], 0
  v_mfma_f32_16x16x32_bf16 a[52:55], a[172:175], v[188:191], 0
  v_mfma_f32_16x16x32_bf16 a[56:59], a[172:175], v[192:195], 0
  v_mfma_f32_16x16x32_bf16 a[60:63], a[172:175], v[196:199], 0
  v_mfma_f32_16x16x32_bf16 a[64:67], a[176:179], v[184:187], 0
  v_mfma_f32_16x16x32_bf16 a[68:71], a[176:179], v[188:191], 0
  v_mfma_f32_16x16x32_bf16 a[72:75], a[176:179], v[192:195], 0
  v_mfma_f32_16x16x32_bf16 a[76:79], a[176:179], v[196:199], 0
  v_mfma_f32_16x16x32_bf16 a[80:83], a[180:183], v[184:187], 0
  v_mfma_f32_16x16x32_bf16 a[84:87], a[180:183], v[188:191], 0
  v_mfma_f32_16x16x32_bf16 a[88:91], a[180:183], v[192:195], 0
  v_mfma_f32_16x16x32_bf16 a[92:95], a[180:183], v[196:199], 0
  v_mfma_f32_16x16x32_bf16 a[96:99], a[184:187], v[184:187], 0
  v_mfma_f32_16x16x32_bf16 a[100:103], a[184:187], v[188:191], 0
  v_mfma_f32_16x16x32_bf16 a[104:107], a[184:187], v[192:195], 0
  v_mfma_f32_16x16x32_bf16 a[108:111], a[184:187], v[196:199], 0
  v_mfma_f32_16x16x32_bf16 a[112:115], a[188:191], v[184:187], 0
  v_mfma_f32_16x16x32_bf16 a[116:119], a[188:191], v[188:191], 0
  v_mfma_f32_16x16x32_bf16 a[120:123], a[188:191], v[192:195], 0
  v_mfma_f32_16x16x32_bf16 a[124:127], a[188:191], v[196:199], 0
  v_mfma_f32_16x16x32_bf16 a[128:131], a[192:195], v[184:187], 0
  v_mfma_f32_16x16x32_bf16 a[132:135], a[192:195], v[188:191], 0
  v_mfma_f32_16x16x32_bf16 a[136:139], a[192:195], v[192:195], 0
  v_mfma_f32_16x16x32_bf16 a[140:143], a[192:195], v[196:199], 0
  v_mfma_f32_16x16x32_bf16 a[144:147], a[196:199], v[184:187], 0
  v_mfma_f32_16x16x32_bf16 a[148:151], a[196:199], v[188:191], 0
  v_mfma_f32_16x16x32_bf16 a[152:155], a[196:199], v[192:195], 0
  v_mfma_f32_16x16x32_bf16 a[156:159], a[196:199], v[196:199], 0
  buffer_load_dwordx4 v[24:27], v1, s[4:7], s30 offen offset:0
  buffer_load_dwordx4 v[28:31], v1, s[4:7], s31 offen offset:0
  buffer_load_dwordx4 v[32:35], v1, s[4:7], s32 offen offset:0
  buffer_load_dwordx4 v[36:39], v1, s[4:7], s33 offen offset:0
  buffer_load_dwordx4 v[40:43], v1, s[4:7], s34 offen offset:0
  buffer_load_dwordx4 v[44:47], v1, s[4:7], s35 offen offset:0
  buffer_load_dwordx4 v[48:51], v1, s[4:7], s36 offen offset:0
  buffer_load_dwordx4 v[52:55], v1, s[4:7], s37 offen offset:0
  buffer_load_dwordx4 v[56:59], v1, s[4:7], s38 offen offset:0
  buffer_load_dwordx4 v[60:63], v1, s[4:7], s39 offen offset:0
  s_waitcnt vmcnt(30)
  ds_read_b128 v[184:187], v1 offset:2048
  ds_read_b128 v[188:191], v1 offset:26624
  ds_read_b128 v[192:195], v6 offset:2048
  ds_read_b128 v[196:199], v6 offset:26624
  s_waitcnt lgkmcnt(4)
  v_mfma_f32_16x16x32_bf16 a[0:3], a[200:203], v[200:203], a[0:3]
  v_mfma_f32_16x16x32_bf16 a[4:7], a[200:203], v[204:207], a[4:7]
  v_mfma_f32_16x16x32_bf16 a[8:11], a[200:203], v[208:211], a[8:11]
  v_mfma_f32_16x16x32_bf16 a[12:15], a[200:203], v[212:215], a[12:15]
  v_mfma_f32_16x16x32_bf16 a[16:19], a[204:207], v[200:203], a[16:19]
  v_mfma_f32_16x16x32_bf16 a[20:23], a[204:207], v[204:207], a[20:23]
  v_mfma_f32_16x16x32_bf16 a[24:27], a[204:207], v[208:211], a[24:27]
  v_mfma_f32_16x16x32_bf16 a[28:31], a[204:207], v[212:215], a[28:31]
  v_mfma_f32_16x16x32_bf16 a[32:35], a[208:211], v[200:203], a[32:35]
  v_mfma_f32_16x16x32_bf16 a[36:39], a[208:211], v[204:207], a[36:39]
  v_mfma_f32_16x16x32_bf16 a[40:43], a[208:211], v[208:211], a[40:43]
  v_mfma_f32_16x16x32_bf16 a[44:47], a[208:211], v[212:215], a[44:47]
  v_mfma_f32_16x16x32_bf16 a[48:51], a[212:215], v[200:203], a[48:51]
  v_mfma_f32_16x16x32_bf16 a[52:55], a[212:215], v[204:207], a[52:55]
  v_mfma_f32_16x16x32_bf16 a[56:59], a[212:215], v[208:211], a[56:59]
  v_mfma_f32_16x16x32_bf16 a[60:63], a[212:215], v[212:215], a[60:63]
  v_mfma_f32_16x16x32_bf16 a[64:67], a[216:219], v[200:203], a[64:67]
  v_mfma_f32_16x16x32_bf16 a[68:71], a[216:219], v[204:207], a[68:71]
  v_mfma_f32_16x16x32_bf16 a[72:75], a[216:219], v[208:211], a[72:75]
  v_mfma_f32_16x16x32_bf16 a[76:79], a[216:219], v[212:215], a[76:79]
  v_mfma_f32_16x16x32_bf16 a[80:83], a[220:223], v[200:203], a[80:83]
  v_mfma_f32_16x16x32_bf16 a[84:87], a[220:223], v[204:207], a[84:87]
  v_mfma_f32_16x16x32_bf16 a[88:91], a[220:223], v[208:211], a[88:91]
  v_mfma_f32_16x16x32_bf16 a[92:95], a[220:223], v[212:215], a[92:95]
  v_mfma_f32_16x16x32_bf16 a[96:99], a[224:227], v[200:203], a[96:99]
  v_mfma_f32_16x16x32_bf16 a[100:103], a[224:227], v[204:207], a[100:103]
  v_mfma_f32_16x16x32_bf16 a[104:107], a[224:227], v[208:211], a[104:107]
  v_mfma_f32_16x16x32_bf16 a[108:111], a[224:227], v[212:215], a[108:111]
  v_mfma_f32_16x16x32_bf16 a[112:115], a[228:231], v[200:203], a[112:115]
  v_mfma_f32_16x16x32_bf16 a[116:119], a[228:231], v[204:207], a[116:119]
  v_mfma_f32_16x16x32_bf16 a[120:123], a[228:231], v[208:211], a[120:123]
  v_mfma_f32_16x16x32_bf16 a[124:127], a[228:231], v[212:215], a[124:127]
  v_mfma_f32_16x16x32_bf16 a[128:131], a[232:235], v[200:203], a[128:131]
  v_mfma_f32_16x16x32_bf16 a[132:135], a[232:235], v[204:207], a[132:135]
  v_mfma_f32_16x16x32_bf16 a[136:139], a[232:235], v[208:211], a[136:139]
  v_mfma_f32_16x16x32_bf16 a[140:143], a[232:235], v[212:215], a[140:143]
  v_mfma_f32_16x16x32_bf16 a[144:147], a[236:239], v[200:203], a[144:147]
  v_mfma_f32_16x16x32_bf16 a[148:151], a[236:239], v[204:207], a[148:151]
  v_mfma_f32_16x16x32_bf16 a[152:155], a[236:239], v[208:211], a[152:155]
  v_mfma_f32_16x16x32_bf16 a[156:159], a[236:239], v[212:215], a[156:159]
  buffer_load_dwordx4 v[64:67], v1, s[4:7], s30 offen offset:1024
  buffer_load_dwordx4 v[68:71], v1, s[4:7], s31 offen offset:1024
  buffer_load_dwordx4 v[72:75], v1, s[4:7], s32 offen offset:1024
  buffer_load_dwordx4 v[76:79], v1, s[4:7], s33 offen offset:1024
  buffer_load_dwordx4 v[80:83], v1, s[4:7], s34 offen offset:1024
  buffer_load_dwordx4 v[84:87], v1, s[4:7], s35 offen offset:1024
  buffer_load_dwordx4 v[88:91], v1, s[4:7], s36 offen offset:1024
  buffer_load_dwordx4 v[92:95], v1, s[4:7], s37 offen offset:1024
  buffer_load_dwordx4 v[96:99], v1, s[4:7], s38 offen offset:1024
  buffer_load_dwordx4 v[100:103], v1, s[4:7], s39 offen offset:1024
  s_waitcnt vmcnt(30)
  ds_read_b128 v[200:203], v1 offset:3072
  ds_read_b128 v[204:207], v1 offset:27648
  ds_read_b128 v[208:211], v6 offset:3072
  ds_read_b128 v[212:215], v6 offset:27648
  s_waitcnt lgkmcnt(4)
  v_mfma_f32_16x16x32_bf16 a[0:3], v[104:107], v[184:187], a[0:3]
  v_mfma_f32_16x16x32_bf16 a[4:7], v[104:107], v[188:191], a[4:7]
  v_mfma_f32_16x16x32_bf16 a[8:11], v[104:107], v[192:195], a[8:11]
  v_mfma_f32_16x16x32_bf16 a[12:15], v[104:107], v[196:199], a[12:15]
  v_mfma_f32_16x16x32_bf16 a[16:19], v[108:111], v[184:187], a[16:19]
  v_mfma_f32_16x16x32_bf16 a[20:23], v[108:111], v[188:191], a[20:23]
  v_mfma_f32_16x16x32_bf16 a[24:27], v[108:111], v[192:195], a[24:27]
  v_mfma_f32_16x16x32_bf16 a[28:31], v[108:111], v[196:199], a[28:31]
  v_mfma_f32_16x16x32_bf16 a[32:35], v[112:115], v[184:187], a[32:35]
  v_mfma_f32_16x16x32_bf16 a[36:39], v[112:115], v[188:191], a[36:39]
  v_mfma_f32_16x16x32_bf16 a[40:43], v[112:115], v[192:195], a[40:43]
  v_mfma_f32_16x16x32_bf16 a[44:47], v[112:115], v[196:199], a[44:47]
  v_mfma_f32_16x16x32_bf16 a[48:51], v[116:119], v[184:187], a[48:51]
  v_mfma_f32_16x16x32_bf16 a[52:55], v[116:119], v[188:191], a[52:55]
  v_mfma_f32_16x16x32_bf16 a[56:59], v[116:119], v[192:195], a[56:59]
  v_mfma_f32_16x16x32_bf16 a[60:63], v[116:119], v[196:199], a[60:63]
  v_mfma_f32_16x16x32_bf16 a[64:67], v[120:123], v[184:187], a[64:67]
  v_mfma_f32_16x16x32_bf16 a[68:71], v[120:123], v[188:191], a[68:71]
  v_mfma_f32_16x16x32_bf16 a[72:75], v[120:123], v[192:195], a[72:75]
  v_mfma_f32_16x16x32_bf16 a[76:79], v[120:123], v[196:199], a[76:79]
  v_mfma_f32_16x16x32_bf16 a[80:83], v[124:127], v[184:187], a[80:83]
  v_mfma_f32_16x16x32_bf16 a[84:87], v[124:127], v[188:191], a[84:87]
  v_mfma_f32_16x16x32_bf16 a[88:91], v[124:127], v[192:195], a[88:91]
  v_mfma_f32_16x16x32_bf16 a[92:95], v[124:127], v[196:199], a[92:95]
  v_mfma_f32_16x16x32_bf16 a[96:99], v[128:131], v[184:187], a[96:99]
  v_mfma_f32_16x16x32_bf16 a[100:103], v[128:131], v[188:191], a[100:103]
  v_mfma_f32_16x16x32_bf16 a[104:107], v[128:131], v[192:195], a[104:107]
  v_mfma_f32_16x16x32_bf16 a[108:111], v[128:131], v[196:199], a[108:111]
  v_mfma_f32_16x16x32_bf16 a[112:115], v[132:135], v[184:187], a[112:115]
  v_mfma_f32_16x16x32_bf16 a[116:119], v[132:135], v[188:191], a[116:119]
  v_mfma_f32_16x16x32_bf16 a[120:123], v[132:135], v[192:195], a[120:123]
  v_mfma_f32_16x16x32_bf16 a[124:127], v[132:135], v[196:199], a[124:127]
  v_mfma_f32_16x16x32_bf16 a[128:131], v[136:139], v[184:187], a[128:131]
  v_mfma_f32_16x16x32_bf16 a[132:135], v[136:139], v[188:191], a[132:135]
  v_mfma_f32_16x16x32_bf16 a[136:139], v[136:139], v[192:195], a[136:139]
  v_mfma_f32_16x16x32_bf16 a[140:143], v[136:139], v[196:199], a[140:143]
  v_mfma_f32_16x16x32_bf16 a[144:147], v[140:143], v[184:187], a[144:147]
  v_mfma_f32_16x16x32_bf16 a[148:151], v[140:143], v[188:191], a[148:151]
  v_mfma_f32_16x16x32_bf16 a[152:155], v[140:143], v[192:195], a[152:155]
  v_mfma_f32_16x16x32_bf16 a[156:159], v[140:143], v[196:199], a[156:159]
  buffer_load_dwordx4 v[104:107], v1, s[4:7], s30 offen offset:2048
  buffer_load_dwordx4 v[108:111], v1, s[4:7], s31 offen offset:2048
  buffer_load_dwordx4 v[112:115], v1, s[4:7], s32 offen offset:2048
  buffer_load_dwordx4 v[116:119], v1, s[4:7], s33 offen offset:2048
  buffer_load_dwordx4 v[120:123], v1, s[4:7], s34 offen offset:2048
  buffer_load_dwordx4 v[124:127], v1, s[4:7], s35 offen offset:2048
  buffer_load_dwordx4 v[128:131], v1, s[4:7], s36 offen offset:2048
  buffer_load_dwordx4 v[132:135], v1, s[4:7], s37 offen offset:2048
  buffer_load_dwordx4 v[136:139], v1, s[4:7], s38 offen offset:2048
  buffer_load_dwordx4 v[140:143], v1, s[4:7], s39 offen offset:2048
  s_waitcnt vmcnt(30)
  ds_read_b128 v[184:187], v1 offset:4096
  ds_read_b128 v[188:191], v1 offset:28672
  ds_read_b128 v[192:195], v6 offset:4096
  ds_read_b128 v[196:199], v6 offset:28672
  s_waitcnt lgkmcnt(4)
  v_mfma_f32_16x16x32_bf16 a[0:3], v[144:147], v[200:203], a[0:3]
  v_mfma_f32_16x16x32_bf16 a[4:7], v[144:147], v[204:207], a[4:7]
  v_mfma_f32_16x16x32_bf16 a[8:11], v[144:147], v[208:211], a[8:11]
  v_mfma_f32_16x16x32_bf16 a[12:15], v[144:147], v[212:215], a[12:15]
  v_mfma_f32_16x16x32_bf16 a[16:19], v[148:151], v[200:203], a[16:19]
  v_mfma_f32_16x16x32_bf16 a[20:23], v[148:151], v[204:207], a[20:23]
  v_mfma_f32_16x16x32_bf16 a[24:27], v[148:151], v[208:211], a[24:27]
  v_mfma_f32_16x16x32_bf16 a[28:31], v[148:151], v[212:215], a[28:31]
  v_mfma_f32_16x16x32_bf16 a[32:35], v[152:155], v[200:203], a[32:35]
  v_mfma_f32_16x16x32_bf16 a[36:39], v[152:155], v[204:207], a[36:39]
  v_mfma_f32_16x16x32_bf16 a[40:43], v[152:155], v[208:211], a[40:43]
  v_mfma_f32_16x16x32_bf16 a[44:47], v[152:155], v[212:215], a[44:47]
  v_mfma_f32_16x16x32_bf16 a[48:51], v[156:159], v[200:203], a[48:51]
  v_mfma_f32_16x16x32_bf16 a[52:55], v[156:159], v[204:207], a[52:55]
  v_mfma_f32_16x16x32_bf16 a[56:59], v[156:159], v[208:211], a[56:59]
  v_mfma_f32_16x16x32_bf16 a[60:63], v[156:159], v[212:215], a[60:63]
  v_mfma_f32_16x16x32_bf16 a[64:67], v[160:163], v[200:203], a[64:67]
  v_mfma_f32_16x16x32_bf16 a[68:71], v[160:163], v[204:207], a[68:71]
  v_mfma_f32_16x16x32_bf16 a[72:75], v[160:163], v[208:211], a[72:75]
  v_mfma_f32_16x16x32_bf16 a[76:79], v[160:163], v[212:215], a[76:79]
  v_mfma_f32_16x16x32_bf16 a[80:83], v[164:167], v[200:203], a[80:83]
  v_mfma_f32_16x16x32_bf16 a[84:87], v[164:167], v[204:207], a[84:87]
  v_mfma_f32_16x16x32_bf16 a[88:91], v[164:167], v[208:211], a[88:91]
  v_mfma_f32_16x16x32_bf16 a[92:95], v[164:167], v[212:215], a[92:95]
  v_mfma_f32_16x16x32_bf16 a[96:99], v[168:171], v[200:203], a[96:99]
  v_mfma_f32_16x16x32_bf16 a[100:103], v[168:171], v[204:207], a[100:103]
  v_mfma_f32_16x16x32_bf16 a[104:107], v[168:171], v[208:211], a[104:107]
  v_mfma_f32_16x16x32_bf16 a[108:111], v[168:171], v[212:215], a[108:111]
  v_mfma_f32_16x16x32_bf16 a[112:115], v[172:175], v[200:203], a[112:115]
  v_mfma_f32_16x16x32_bf16 a[116:119], v[172:175], v[204:207], a[116:119]
  v_mfma_f32_16x16x32_bf16 a[120:123], v[172:175], v[208:211], a[120:123]
  v_mfma_f32_16x16x32_bf16 a[124:127], v[172:175], v[212:215], a[124:127]
  v_mfma_f32_16x16x32_bf16 a[128:131], v[176:179], v[200:203], a[128:131]
  v_mfma_f32_16x16x32_bf16 a[132:135], v[176:179], v[204:207], a[132:135]
  v_mfma_f32_16x16x32_bf16 a[136:139], v[176:179], v[208:211], a[136:139]
  v_mfma_f32_16x16x32_bf16 a[140:143], v[176:179], v[212:215], a[140:143]
  v_mfma_f32_16x16x32_bf16 a[144:147], v[180:183], v[200:203], a[144:147]
  v_mfma_f32_16x16x32_bf16 a[148:151], v[180:183], v[204:207], a[148:151]
  v_mfma_f32_16x16x32_bf16 a[152:155], v[180:183], v[208:211], a[152:155]
  v_mfma_f32_16x16x32_bf16 a[156:159], v[180:183], v[212:215], a[156:159]
  buffer_load_dwordx4 v[144:147], v1, s[4:7], s30 offen offset:3072
  buffer_load_dwordx4 v[148:151], v1, s[4:7], s31 offen offset:3072
  buffer_load_dwordx4 v[152:155], v1, s[4:7], s32 offen offset:3072
  buffer_load_dwordx4 v[156:159], v1, s[4:7], s33 offen offset:3072
  buffer_load_dwordx4 v[160:163], v1, s[4:7], s34 offen offset:3072
  buffer_load_dwordx4 v[164:167], v1, s[4:7], s35 offen offset:3072
  buffer_load_dwordx4 v[168:171], v1, s[4:7], s36 offen offset:3072
  buffer_load_dwordx4 v[172:175], v1, s[4:7], s37 offen offset:3072
  buffer_load_dwordx4 v[176:179], v1, s[4:7], s38 offen offset:3072
  buffer_load_dwordx4 v[180:183], v1, s[4:7], s39 offen offset:3072
  s_add_u32 s30, s30, 4096
  s_add_u32 s31, s31, 4096
  s_add_u32 s32, s32, 4096
  s_add_u32 s33, s33, 4096
  s_add_u32 s34, s34, 4096
  s_add_u32 s35, s35, 4096
  s_add_u32 s36, s36, 4096
  s_add_u32 s37, s37, 4096
  s_add_u32 s38, s38, 4096
  s_add_u32 s39, s39, 4096
  s_waitcnt vmcnt(30)
  ds_read_b128 v[200:203], v1 offset:5120
  ds_read_b128 v[204:207], v1 offset:29696
  ds_read_b128 v[208:211], v6 offset:5120
  ds_read_b128 v[212:215], v6 offset:29696
  s_waitcnt lgkmcnt(4)
  v_mfma_f32_16x16x32_bf16 a[0:3], v[24:27], v[184:187], a[0:3]
  v_mfma_f32_16x16x32_bf16 a[4:7], v[24:27], v[188:191], a[4:7]
  v_mfma_f32_16x16x32_bf16 a[8:11], v[24:27], v[192:195], a[8:11]
  v_mfma_f32_16x16x32_bf16 a[12:15], v[24:27], v[196:199], a[12:15]
  v_mfma_f32_16x16x32_bf16 a[16:19], v[28:31], v[184:187], a[16:19]
  v_mfma_f32_16x16x32_bf16 a[20:23], v[28:31], v[188:191], a[20:23]
  v_mfma_f32_16x16x32_bf16 a[24:27], v[28:31], v[192:195], a[24:27]
  v_mfma_f32_16x16x32_bf16 a[28:31], v[28:31], v[196:199], a[28:31]
  v_mfma_f32_16x16x32_bf16 a[32:35], v[32:35], v[184:187], a[32:35]
  v_mfma_f32_16x16x32_bf16 a[36:39], v[32:35], v[188:191], a[36:39]
  v_mfma_f32_16x16x32_bf16 a[40:43], v[32:35], v[192:195], a[40:43]
  v_mfma_f32_16x16x32_bf16 a[44:47], v[32:35], v[196:199], a[44:47]
  v_mfma_f32_16x16x32_bf16 a[48:51], v[36:39], v[184:187], a[48:51]
  v_mfma_f32_16x16x32_bf16 a[52:55], v[36:39], v[188:191], a[52:55]
  v_mfma_f32_16x16x32_bf16 a[56:59], v[36:39], v[192:195], a[56:59]
  v_mfma_f32_16x16x32_bf16 a[60:63], v[36:39], v[196:199], a[60:63]
  v_mfma_f32_16x16x32_bf16 a[64:67], v[40:43], v[184:187], a[64:67]
  v_mfma_f32_16x16x32_bf16 a[68:71], v[40:43], v[188:191], a[68:71]
  v_mfma_f32_16x16x32_bf16 a[72:75], v[40:43], v[192:195], a[72:75]
  v_mfma_f32_16x16x32_bf16 a[76:79], v[40:43], v[196:199], a[76:79]
  v_mfma_f32_16x16x32_bf16 a[80:83], v[44:47], v[184:187], a[80:83]
  v_mfma_f32_16x16x32_bf16 a[84:87], v[44:47], v[188:191], a[84:87]
  v_mfma_f32_16x16x32_bf16 a[88:91], v[44:47], v[192:195], a[88:91]
  v_mfma_f32_16x16x32_bf16 a[92:95], v[44:47], v[196:199], a[92:95]
  v_mfma_f32_16x16x32_bf16 a[96:99], v[48:51], v[184:187], a[96:99]
  v_mfma_f32_16x16x32_bf16 a[100:103], v[48:51], v[188:191], a[100:103]
  v_mfma_f32_16x16x32_bf16 a[104:107], v[48:51], v[192:195], a[104:107]
  v_mfma_f32_16x16x32_bf16 a[108:111], v[48:51], v[196:199], a[108:111]
  v_mfma_f32_16x16x32_bf16 a[112:115], v[52:55], v[184:187], a[112:115]
  v_mfma_f32_16x16x32_bf16 a[116:119], v[52:55], v[188:191], a[116:119]
  v_mfma_f32_16x16x32_bf16 a[120:123], v[52:55], v[192:195], a[120:123]
  v_mfma_f32_16x16x32_bf16 a[124:127], v[52:55], v[196:199], a[124:127]
  v_mfma_f32_16x16x32_bf16 a[128:131], v[56:59], v[184:187], a[128:131]
  v_mfma_f32_16x16x32_bf16 a[132:135], v[56:59], v[188:191], a[132:135]
  v_mfma_f32_16x16x32_bf16 a[136:139], v[56:59], v[192:195], a[136:139]
  v_mfma_f32_16x16x32_bf16 a[140:143], v[56:59], v[196:199], a[140:143]
  v_mfma_f32_16x16x32_bf16 a[144:147], v[60:63], v[184:187], a[144:147]
  v_mfma_f32_16x16x32_bf16 a[148:151], v[60:63], v[188:191], a[148:151]
  v_mfma_f32_16x16x32_bf16 a[152:155], v[60:63], v[192:195], a[152:155]
  v_mfma_f32_16x16x32_bf16 a[156:159], v[60:63], v[196:199], a[156:159]
  buffer_load_dwordx4 v[24:27], v1, s[4:7], s30 offen offset:0
  buffer_load_dwordx4 v[28:31], v1, s[4:7], s31 offen offset:0
  buffer_load_dwordx4 v[32:35], v1, s[4:7], s32 offen offset:0
  buffer_load_dwordx4 v[36:39], v1, s[4:7], s33 offen offset:0
  buffer_load_dwordx4 v[40:43], v1, s[4:7], s34 offen offset:0
  buffer_load_dwordx4 v[44:47], v1, s[4:7], s35 offen offset:0
  buffer_load_dwordx4 v[48:51], v1, s[4:7], s36 offen offset:0
  buffer_load_dwordx4 v[52:55], v1, s[4:7], s37 offen offset:0
  buffer_load_dwordx4 v[56:59], v1, s[4:7], s38 offen offset:0
  buffer_load_dwordx4 v[60:63], v1, s[4:7], s39 offen offset:0
  s_waitcnt vmcnt(30)
  ds_read_b128 v[184:187], v1 offset:6144
  ds_read_b128 v[188:191], v1 offset:30720
  ds_read_b128 v[192:195], v6 offset:6144
  ds_read_b128 v[196:199], v6 offset:30720
  s_waitcnt lgkmcnt(4)
  v_mfma_f32_16x16x32_bf16 a[0:3], v[64:67], v[200:203], a[0:3]
  v_mfma_f32_16x16x32_bf16 a[4:7], v[64:67], v[204:207], a[4:7]
  v_mfma_f32_16x16x32_bf16 a[8:11], v[64:67], v[208:211], a[8:11]
  v_mfma_f32_16x16x32_bf16 a[12:15], v[64:67], v[212:215], a[12:15]
  v_mfma_f32_16x16x32_bf16 a[16:19], v[68:71], v[200:203], a[16:19]
  v_mfma_f32_16x16x32_bf16 a[20:23], v[68:71], v[204:207], a[20:23]
  v_mfma_f32_16x16x32_bf16 a[24:27], v[68:71], v[208:211], a[24:27]
  v_mfma_f32_16x16x32_bf16 a[28:31], v[68:71], v[212:215], a[28:31]
  v_mfma_f32_16x16x32_bf16 a[32:35], v[72:75], v[200:203], a[32:35]
  v_mfma_f32_16x16x32_bf16 a[36:39], v[72:75], v[204:207], a[36:39]
  v_mfma_f32_16x16x32_bf16 a[40:43], v[72:75], v[208:211], a[40:43]
  v_mfma_f32_16x16x32_bf16 a[44:47], v[72:75], v[212:215], a[44:47]
  v_mfma_f32_16x16x32_bf16 a[48:51], v[76:79], v[200:203], a[48:51]
  v_mfma_f32_16x16x32_bf16 a[52:55], v[76:79], v[204:207], a[52:55]
  v_mfma_f32_16x16x32_bf16 a[56:59], v[76:79], v[208:211], a[56:59]
  v_mfma_f32_16x16x32_bf16 a[60:63], v[76:79], v[212:215], a[60:63]
  v_mfma_f32_16x16x32_bf16 a[64:67], v[80:83], v[200:203], a[64:67]
  v_mfma_f32_16x16x32_bf16 a[68:71], v[80:83], v[204:207], a[68:71]
  v_mfma_f32_16x16x32_bf16 a[72:75], v[80:83], v[208:211], a[72:75]
  v_mfma_f32_16x16x32_bf16 a[76:79], v[80:83], v[212:215], a[76:79]
  v_mfma_f32_16x16x32_bf16 a[80:83], v[84:87], v[200:203], a[80:83]
  v_mfma_f32_16x16x32_bf16 a[84:87], v[84:87], v[204:207], a[84:87]
  v_mfma_f32_16x16x32_bf16 a[88:91], v[84:87], v[208:211], a[88:91]
  v_mfma_f32_16x16x32_bf16 a[92:95], v[84:87], v[212:215], a[92:95]
  v_mfma_f32_16x16x32_bf16 a[96:99], v[88:91], v[200:203], a[96:99]
  v_mfma_f32_16x16x32_bf16 a[100:103], v[88:91], v[204:207], a[100:103]
  v_mfma_f32_16x16x32_bf16 a[104:107], v[88:91], v[208:211], a[104:107]
  v_mfma_f32_16x16x32_bf16 a[108:111], v[88:91], v[212:215], a[108:111]
  v_mfma_f32_16x16x32_bf16 a[112:115], v[92:95], v[200:203], a[112:115]
  v_mfma_f32_16x16x32_bf16 a[116:119], v[92:95], v[204:207], a[116:119]
  v_mfma_f32_16x16x32_bf16 a[120:123], v[92:95], v[208:211], a[120:123]
  v_mfma_f32_16x16x32_bf16 a[124:127], v[92:95], v[212:215], a[124:127]
  v_mfma_f32_16x16x32_bf16 a[128:131], v[96:99], v[200:203], a[128:131]
  v_mfma_f32_16x16x32_bf16 a[132:135], v[96:99], v[204:207], a[132:135]
  v_mfma_f32_16x16x32_bf16 a[136:139], v[96:99], v[208:211], a[136:139]
  v_mfma_f32_16x16x32_bf16 a[140:143], v[96:99], v[212:215], a[140:143]
  v_mfma_f32_16x16x32_bf16 a[144:147], v[100:103], v[200:203], a[144:147]
  v_mfma_f32_16x16x32_bf16 a[148:151], v[100:103], v[204:207], a[148:151]
  v_mfma_f32_16x16x32_bf16 a[152:155], v[100:103], v[208:211], a[152:155]
  v_mfma_f32_16x16x32_bf16 a[156:159], v[100:103], v[212:215], a[156:159]
  buffer_load_dwordx4 v[64:67], v1, s[4:7], s30 offen offset:1024
  buffer_load_dwordx4 v[68:71], v1, s[4:7], s31 offen offset:1024
  buffer_load_dwordx4 v[72:75], v1, s[4:7], s32 offen offset:1024
  buffer_load_dwordx4 v[76:79], v1, s[4:7], s33 offen offset:1024
  buffer_load_dwordx4 v[80:83], v1, s[4:7], s34 offen offset:1024
  buffer_load_dwordx4 v[84:87], v1, s[4:7], s35 offen offset:1024
  buffer_load_dwordx4 v[88:91], v1, s[4:7], s36 offen offset:1024
  buffer_load_dwordx4 v[92:95], v1, s[4:7], s37 offen offset:1024
  buffer_load_dwordx4 v[96:99], v1, s[4:7], s38 offen offset:1024
  buffer_load_dwordx4 v[100:103], v1, s[4:7], s39 offen offset:1024
  s_waitcnt vmcnt(30)
  ds_read_b128 v[200:203], v1 offset:7168
  ds_read_b128 v[204:207], v1 offset:31744
  ds_read_b128 v[208:211], v6 offset:7168
  ds_read_b128 v[212:215], v6 offset:31744
  s_waitcnt lgkmcnt(4)
  v_mfma_f32_16x16x32_bf16 a[0:3], v[104:107], v[184:187], a[0:3]
  v_mfma_f32_16x16x32_bf16 a[4:7], v[104:107], v[188:191], a[4:7]
  v_mfma_f32_16x16x32_bf16 a[8:11], v[104:107], v[192:195], a[8:11]
  v_mfma_f32_16x16x32_bf16 a[12:15], v[104:107], v[196:199], a[12:15]
  v_mfma_f32_16x16x32_bf16 a[16:19], v[108:111], v[184:187], a[16:19]
  v_mfma_f32_16x16x32_bf16 a[20:23], v[108:111], v[188:191], a[20:23]
  v_mfma_f32_16x16x32_bf16 a[24:27], v[108:111], v[192:195], a[24:27]
  v_mfma_f32_16x16x32_bf16 a[28:31], v[108:111], v[196:199], a[28:31]
  v_mfma_f32_16x16x32_bf16 a[32:35], v[112:115], v[184:187], a[32:35]
  v_mfma_f32_16x16x32_bf16 a[36:39], v[112:115], v[188:191], a[36:39]
  v_mfma_f32_16x16x32_bf16 a[40:43], v[112:115], v[192:195], a[40:43]
  v_mfma_f32_16x16x32_bf16 a[44:47], v[112:115], v[196:199], a[44:47]
  v_mfma_f32_16x16x32_bf16 a[48:51], v[116:119], v[184:187], a[48:51]
  v_mfma_f32_16x16x32_bf16 a[52:55], v[116:119], v[188:191], a[52:55]
  v_mfma_f32_16x16x32_bf16 a[56:59], v[116:119], v[192:195], a[56:59]
  v_mfma_f32_16x16x32_bf16 a[60:63], v[116:119], v[196:199], a[60:63]
  v_mfma_f32_16x16x32_bf16 a[64:67], v[120:123], v[184:187], a[64:67]
  v_mfma_f32_16x16x32_bf16 a[68:71], v[120:123], v[188:191], a[68:71]
  v_mfma_f32_16x16x32_bf16 a[72:75], v[120:123], v[192:195], a[72:75]
  v_mfma_f32_16x16x32_bf16 a[76:79], v[120:123], v[196:199], a[76:79]
  v_mfma_f32_16x16x32_bf16 a[80:83], v[124:127], v[184:187], a[80:83]
  v_mfma_f32_16x16x32_bf16 a[84:87], v[124:127], v[188:191], a[84:87]
  v_mfma_f32_16x16x32_bf16 a[88:91], v[124:127], v[192:195], a[88:91]
  v_mfma_f32_16x16x32_bf16 a[92:95], v[124:127], v[196:199], a[92:95]
  v_mfma_f32_16x16x32_bf16 a[96:99], v[128:131], v[184:187], a[96:99]
  v_mfma_f32_16x16x32_bf16 a[100:103], v[128:131], v[188:191], a[100:103]
  v_mfma_f32_16x16x32_bf16 a[104:107], v[128:131], v[192:195], a[104:107]
  v_mfma_f32_16x16x32_bf16 a[108:111], v[128:131], v[196:199], a[108:111]
  v_mfma_f32_16x16x32_bf16 a[112:115], v[132:135], v[184:187], a[112:115]
  v_mfma_f32_16x16x32_bf16 a[116:119], v[132:135], v[188:191], a[116:119]
  v_mfma_f32_16x16x32_bf16 a[120:123], v[132:135], v[192:195], a[120:123]
  v_mfma_f32_16x16x32_bf16 a[124:127], v[132:135], v[196:199], a[124:127]
  v_mfma_f32_16x16x32_bf16 a[128:131], v[136:139], v[184:187], a[128:131]
  v_mfma_f32_16x16x32_bf16 a[132:135], v[136:139], v[188:191], a[132:135]
  v_mfma_f32_16x16x32_bf16 a[136:139], v[136:139], v[192:195], a[136:139]
  v_mfma_f32_16x16x32_bf16 a[140:143], v[136:139], v[196:199], a[140:143]
  v_mfma_f32_16x16x32_bf16 a[144:147], v[140:143], v[184:187], a[144:147]
  v_mfma_f32_16x16x32_bf16 a[148:151], v[140:143], v[188:191], a[148:151]
  v_mfma_f32_16x16x32_bf16 a[152:155], v[140:143], v[192:195], a[152:155]
  v_mfma_f32_16x16x32_bf16 a[156:159], v[140:143], v[196:199], a[156:159]
  buffer_load_dwordx4 v[104:107], v1, s[4:7], s30 offen offset:2048
  buffer_load_dwordx4 v[108:111], v1, s[4:7], s31 offen offset:2048
  buffer_load_dwordx4 v[112:115], v1, s[4:7], s32 offen offset:2048
  buffer_load_dwordx4 v[116:119], v1, s[4:7], s33 offen offset:2048
  buffer_load_dwordx4 v[120:123], v1, s[4:7], s34 offen offset:2048
  buffer_load_dwordx4 v[124:127], v1, s[4:7], s35 offen offset:2048
  buffer_load_dwordx4 v[128:131], v1, s[4:7], s36 offen offset:2048
  buffer_load_dwordx4 v[132:135], v1, s[4:7], s37 offen offset:2048
  buffer_load_dwordx4 v[136:139], v1, s[4:7], s38 offen offset:2048
  buffer_load_dwordx4 v[140:143], v1, s[4:7], s39 offen offset:2048
  s_waitcnt vmcnt(30)
  ds_read_b128 v[184:187], v1 offset:8192
  ds_read_b128 v[188:191], v1 offset:32768
  ds_read_b128 v[192:195], v6 offset:8192
  ds_read_b128 v[196:199], v6 offset:32768
  s_waitcnt lgkmcnt(4)
  v_mfma_f32_16x16x32_bf16 a[0:3], v[144:147], v[200:203], a[0:3]
  v_mfma_f32_16x16x32_bf16 a[4:7], v[144:147], v[204:207], a[4:7]
  v_mfma_f32_16x16x32_bf16 a[8:11], v[144:147], v[208:211], a[8:11]
  v_mfma_f32_16x16x32_bf16 a[12:15], v[144:147], v[212:215], a[12:15]
  v_mfma_f32_16x16x32_bf16 a[16:19], v[148:151], v[200:203], a[16:19]
  v_mfma_f32_16x16x32_bf16 a[20:23], v[148:151], v[204:207], a[20:23]
  v_mfma_f32_16x16x32_bf16 a[24:27], v[148:151], v[208:211], a[24:27]
  v_mfma_f32_16x16x32_bf16 a[28:31], v[148:151], v[212:215], a[28:31]
  v_mfma_f32_16x16x32_bf16 a[32:35], v[152:155], v[200:203], a[32:35]
  v_mfma_f32_16x16x32_bf16 a[36:39], v[152:155], v[204:207], a[36:39]
  v_mfma_f32_16x16x32_bf16 a[40:43], v[152:155], v[208:211], a[40:43]
  v_mfma_f32_16x16x32_bf16 a[44:47], v[152:155], v[212:215], a[44:47]
  v_mfma_f32_16x16x32_bf16 a[48:51], v[156:159], v[200:203], a[48:51]
  v_mfma_f32_16x16x32_bf16 a[52:55], v[156:159], v[204:207], a[52:55]
  v_mfma_f32_16x16x32_bf16 a[56:59], v[156:159], v[208:211], a[56:59]
  v_mfma_f32_16x16x32_bf16 a[60:63], v[156:159], v[212:215], a[60:63]
  v_mfma_f32_16x16x32_bf16 a[64:67], v[160:163], v[200:203], a[64:67]
  v_mfma_f32_16x16x32_bf16 a[68:71], v[160:163], v[204:207], a[68:71]
  v_mfma_f32_16x16x32_bf16 a[72:75], v[160:163], v[208:211], a[72:75]
  v_mfma_f32_16x16x32_bf16 a[76:79], v[160:163], v[212:215], a[76:79]
  v_mfma_f32_16x16x32_bf16 a[80:83], v[164:167], v[200:203], a[80:83]
  v_mfma_f32_16x16x32_bf16 a[84:87], v[164:167], v[204:207], a[84:87]
  v_mfma_f32_16x16x32_bf16 a[88:91], v[164:167], v[208:211], a[88:91]
  v_mfma_f32_16x16x32_bf16 a[92:95], v[164:167], v[212:215], a[92:95]
  v_mfma_f32_16x16x32_bf16 a[96:99], v[168:171], v[200:203], a[96:99]
  v_mfma_f32_16x16x32_bf16 a[100:103], v[168:171], v[204:207], a[100:103]
  v_mfma_f32_16x16x32_bf16 a[104:107], v[168:171], v[208:211], a[104:107]
  v_mfma_f32_16x16x32_bf16 a[108:111], v[168:171], v[212:215], a[108:111]
  v_mfma_f32_16x16x32_bf16 a[112:115], v[172:175], v[200:203], a[112:115]
  v_mfma_f32_16x16x32_bf16 a[116:119], v[172:175], v[204:207], a[116:119]
  v_mfma_f32_16x16x32_bf16 a[120:123], v[172:175], v[208:211], a[120:123]
  v_mfma_f32_16x16x32_bf16 a[124:127], v[172:175], v[212:215], a[124:127]
  v_mfma_f32_16x16x32_bf16 a[128:131], v[176:179], v[200:203], a[128:131]
  v_mfma_f32_16x16x32_bf16 a[132:135], v[176:179], v[204:207], a[132:135]
  v_mfma_f32_16x16x32_bf16 a[136:139], v[176:179], v[208:211], a[136:139]
  v_mfma_f32_16x16x32_bf16 a[140:143], v[176:179], v[212:215], a[140:143]
  v_mfma_f32_16x16x32_bf16 a[144:147], v[180:183], v[200:203], a[144:147]
  v_mfma_f32_16x16x32_bf16 a[148:151], v[180:183], v[204:207], a[148:151]
  v_mfma_f32_16x16x32_bf16 a[152:155], v[180:183], v[208:211], a[152:155]
  v_mfma_f32_16x16x32_bf16 a[156:159], v[180:183], v[212:215], a[156:159]
  buffer_load_dwordx4 v[144:147], v1, s[4:7], s30 offen offset:3072
  buffer_load_dwordx4 v[148:151], v1, s[4:7], s31 offen offset:3072
  buffer_load_dwordx4 v[152:155], v1, s[4:7], s32 offen offset:3072
  buffer_load_dwordx4 v[156:159], v1, s[4:7], s33 offen offset:3072
  buffer_load_dwordx4 v[160:163], v1, s[4:7], s34 offen offset:3072
  buffer_load_dwordx4 v[164:167], v1, s[4:7], s35 offen offset:3072
  buffer_load_dwordx4 v[168:171], v1, s[4:7], s36 offen offset:3072
  buffer_load_dwordx4 v[172:175], v1, s[4:7], s37 offen offset:3072
  buffer_load_dwordx4 v[176:179], v1, s[4:7], s38 offen offset:3072
  buffer_load_dwordx4 v[180:183], v1, s[4:7], s39 offen offset:3072
  s_add_u32 s30, s30, 4096
  s_add_u32 s31, s31, 4096
  s_add_u32 s32, s32, 4096
  s_add_u32 s33, s33, 4096
  s_add_u32 s34, s34, 4096
  s_add_u32 s35, s35, 4096
  s_add_u32 s36, s36, 4096
  s_add_u32 s37, s37, 4096
  s_add_u32 s38, s38, 4096
  s_add_u32 s39, s39, 4096
  s_waitcnt vmcnt(30)
  ds_read_b128 v[200:203], v1 offset:9216
  ds_read_b128 v[204:207], v1 offset:33792
  ds_read_b128 v[208:211], v6 offset:9216
  ds_read_b128 v[212:215], v6 offset:33792
  s_waitcnt lgkmcnt(4)
  v_mfma_f32_16x16x32_bf16 a[0:3], v[24:27], v[184:187], a[0:3]
  v_mfma_f32_16x16x32_bf16 a[4:7], v[24:27], v[188:191], a[4:7]
  v_mfma_f32_16x16x32_bf16 a[8:11], v[24:27], v[192:195], a[8:11]
  v_mfma_f32_16x16x32_bf16 a[12:15], v[24:27], v[196:199], a[12:15]
  v_mfma_f32_16x16x32_bf16 a[16:19], v[28:31], v[184:187], a[16:19]
  v_mfma_f32_16x16x32_bf16 a[20:23], v[28:31], v[188:191], a[20:23]
  v_mfma_f32_16x16x32_bf16 a[24:27], v[28:31], v[192:195], a[24:27]
  v_mfma_f32_16x16x32_bf16 a[28:31], v[28:31], v[196:199], a[28:31]
  v_mfma_f32_16x16x32_bf16 a[32:35], v[32:35], v[184:187], a[32:35]
  v_mfma_f32_16x16x32_bf16 a[36:39], v[32:35], v[188:191], a[36:39]
  v_mfma_f32_16x16x32_bf16 a[40:43], v[32:35], v[192:195], a[40:43]
  v_mfma_f32_16x16x32_bf16 a[44:47], v[32:35], v[196:199], a[44:47]
  v_mfma_f32_16x16x32_bf16 a[48:51], v[36:39], v[184:187], a[48:51]
  v_mfma_f32_16x16x32_bf16 a[52:55], v[36:39], v[188:191], a[52:55]
  v_mfma_f32_16x16x32_bf16 a[56:59], v[36:39], v[192:195], a[56:59]
  v_mfma_f32_16x16x32_bf16 a[60:63], v[36:39], v[196:199], a[60:63]
  v_mfma_f32_16x16x32_bf16 a[64:67], v[40:43], v[184:187], a[64:67]
  v_mfma_f32_16x16x32_bf16 a[68:71], v[40:43], v[188:191], a[68:71]
  v_mfma_f32_16x16x32_bf16 a[72:75], v[40:43], v[192:195], a[72:75]
  v_mfma_f32_16x16x32_bf16 a[76:79], v[40:43], v[196:199], a[76:79]
  v_mfma_f32_16x16x32_bf16 a[80:83], v[44:47], v[184:187], a[80:83]
  v_mfma_f32_16x16x32_bf16 a[84:87], v[44:47], v[188:191], a[84:87]
  v_mfma_f32_16x16x32_bf16 a[88:91], v[44:47], v[192:195], a[88:91]
  v_mfma_f32_16x16x32_bf16 a[92:95], v[44:47], v[196:199], a[92:95]
  v_mfma_f32_16x16x32_bf16 a[96:99], v[48:51], v[184:187], a[96:99]
  v_mfma_f32_16x16x32_bf16 a[100:103], v[48:51], v[188:191], a[100:103]
  v_mfma_f32_16x16x32_bf16 a[104:107], v[48:51], v[192:195], a[104:107]
  v_mfma_f32_16x16x32_bf16 a[108:111], v[48:51], v[196:199], a[108:111]
  v_mfma_f32_16x16x32_bf16 a[112:115], v[52:55], v[184:187], a[112:115]
  v_mfma_f32_16x16x32_bf16 a[116:119], v[52:55], v[188:191], a[116:119]
  v_mfma_f32_16x16x32_bf16 a[120:123], v[52:55], v[192:195], a[120:123]
  v_mfma_f32_16x16x32_bf16 a[124:127], v[52:55], v[196:199], a[124:127]
  v_mfma_f32_16x16x32_bf16 a[128:131], v[56:59], v[184:187], a[128:131]
  v_mfma_f32_16x16x32_bf16 a[132:135], v[56:59], v[188:191], a[132:135]
  v_mfma_f32_16x16x32_bf16 a[136:139], v[56:59], v[192:195], a[136:139]
  v_mfma_f32_16x16x32_bf16 a[140:143], v[56:59], v[196:199], a[140:143]
  v_mfma_f32_16x16x32_bf16 a[144:147], v[60:63], v[184:187], a[144:147]
  v_mfma_f32_16x16x32_bf16 a[148:151], v[60:63], v[188:191], a[148:151]
  v_mfma_f32_16x16x32_bf16 a[152:155], v[60:63], v[192:195], a[152:155]
  v_mfma_f32_16x16x32_bf16 a[156:159], v[60:63], v[196:199], a[156:159]
  buffer_load_dwordx4 v[24:27], v1, s[4:7], s30 offen offset:0
  buffer_load_dwordx4 v[28:31], v1, s[4:7], s31 offen offset:0
  buffer_load_dwordx4 v[32:35], v1, s[4:7], s32 offen offset:0
  buffer_load_dwordx4 v[36:39], v1, s[4:7], s33 offen offset:0
  buffer_load_dwordx4 v[40:43], v1, s[4:7], s34 offen offset:0
  buffer_load_dwordx4 v[44:47], v1, s[4:7], s35 offen offset:0
  buffer_load_dwordx4 v[48:51], v1, s[4:7], s36 offen offset:0
  buffer_load_dwordx4 v[52:55], v1, s[4:7], s37 offen offset:0
  buffer_load_dwordx4 v[56:59], v1, s[4:7], s38 offen offset:0
  buffer_load_dwordx4 v[60:63], v1, s[4:7], s39 offen offset:0
  s_waitcnt vmcnt(30)
  ds_read_b128 v[184:187], v1 offset:10240
  ds_read_b128 v[188:191], v1 offset:34816
  ds_read_b128 v[192:195], v6 offset:10240
  ds_read_b128 v[196:199], v6 offset:34816
  s_waitcnt lgkmcnt(4)
  v_mfma_f32_16x16x32_bf16 a[0:3], v[64:67], v[200:203], a[0:3]
  v_mfma_f32_16x16x32_bf16 a[4:7], v[64:67], v[204:207], a[4:7]
  v_mfma_f32_16x16x32_bf16 a[8:11], v[64:67], v[208:211], a[8:11]
  v_mfma_f32_16x16x32_bf16 a[12:15], v[64:67], v[212:215], a[12:15]
  v_mfma_f32_16x16x32_bf16 a[16:19], v[68:71], v[200:203], a[16:19]
  v_mfma_f32_16x16x32_bf16 a[20:23], v[68:71], v[204:207], a[20:23]
  v_mfma_f32_16x16x32_bf16 a[24:27], v[68:71], v[208:211], a[24:27]
  v_mfma_f32_16x16x32_bf16 a[28:31], v[68:71], v[212:215], a[28:31]
  v_mfma_f32_16x16x32_bf16 a[32:35], v[72:75], v[200:203], a[32:35]
  v_mfma_f32_16x16x32_bf16 a[36:39], v[72:75], v[204:207], a[36:39]
  v_mfma_f32_16x16x32_bf16 a[40:43], v[72:75], v[208:211], a[40:43]
  v_mfma_f32_16x16x32_bf16 a[44:47], v[72:75], v[212:215], a[44:47]
  v_mfma_f32_16x16x32_bf16 a[48:51], v[76:79], v[200:203], a[48:51]
  v_mfma_f32_16x16x32_bf16 a[52:55], v[76:79], v[204:207], a[52:55]
  v_mfma_f32_16x16x32_bf16 a[56:59], v[76:79], v[208:211], a[56:59]
  v_mfma_f32_16x16x32_bf16 a[60:63], v[76:79], v[212:215], a[60:63]
  v_mfma_f32_16x16x32_bf16 a[64:67], v[80:83], v[200:203], a[64:67]
  v_mfma_f32_16x16x32_bf16 a[68:71], v[80:83], v[204:207], a[68:71]
  v_mfma_f32_16x16x32_bf16 a[72:75], v[80:83], v[208:211], a[72:75]
  v_mfma_f32_16x16x32_bf16 a[76:79], v[80:83], v[212:215], a[76:79]
  v_mfma_f32_16x16x32_bf16 a[80:83], v[84:87], v[200:203], a[80:83]
  v_mfma_f32_16x16x32_bf16 a[84:87], v[84:87], v[204:207], a[84:87]
  v_mfma_f32_16x16x32_bf16 a[88:91], v[84:87], v[208:211], a[88:91]
  v_mfma_f32_16x16x32_bf16 a[92:95], v[84:87], v[212:215], a[92:95]
  v_mfma_f32_16x16x32_bf16 a[96:99], v[88:91], v[200:203], a[96:99]
  v_mfma_f32_16x16x32_bf16 a[100:103], v[88:91], v[204:207], a[100:103]
  v_mfma_f32_16x16x32_bf16 a[104:107], v[88:91], v[208:211], a[104:107]
  v_mfma_f32_16x16x32_bf16 a[108:111], v[88:91], v[212:215], a[108:111]
  v_mfma_f32_16x16x32_bf16 a[112:115], v[92:95], v[200:203], a[112:115]
  v_mfma_f32_16x16x32_bf16 a[116:119], v[92:95], v[204:207], a[116:119]
  v_mfma_f32_16x16x32_bf16 a[120:123], v[92:95], v[208:211], a[120:123]
  v_mfma_f32_16x16x32_bf16 a[124:127], v[92:95], v[212:215], a[124:127]
  v_mfma_f32_16x16x32_bf16 a[128:131], v[96:99], v[200:203], a[128:131]
  v_mfma_f32_16x16x32_bf16 a[132:135], v[96:99], v[204:207], a[132:135]
  v_mfma_f32_16x16x32_bf16 a[136:139], v[96:99], v[208:211], a[136:139]
  v_mfma_f32_16x16x32_bf16 a[140:143], v[96:99], v[212:215], a[140:143]
  v_mfma_f32_16x16x32_bf16 a[144:147], v[100:103], v[200:203], a[144:147]
  v_mfma_f32_16x16x32_bf16 a[148:151], v[100:103], v[204:207], a[148:151]
  v_mfma_f32_16x16x32_bf16 a[152:155], v[100:103], v[208:211], a[152:155]
  v_mfma_f32_16x16x32_bf16 a[156:159], v[100:103], v[212:215], a[156:159]
  buffer_load_dwordx4 v[64:67], v1, s[4:7], s30 offen offset:1024
  buffer_load_dwordx4 v[68:71], v1, s[4:7], s31 offen offset:1024
  buffer_load_dwordx4 v[72:75], v1, s[4:7], s32 offen offset:1024
  buffer_load_dwordx4 v[76:79], v1, s[4:7], s33 offen offset:1024
  buffer_load_dwordx4 v[80:83], v1, s[4:7], s34 offen offset:1024
  buffer_load_dwordx4 v[84:87], v1, s[4:7], s35 offen offset:1024
  buffer_load_dwordx4 v[88:91], v1, s[4:7], s36 offen offset:1024
  buffer_load_dwordx4 v[92:95], v1, s[4:7], s37 offen offset:1024
  buffer_load_dwordx4 v[96:99], v1, s[4:7], s38 offen offset:1024
  buffer_load_dwordx4 v[100:103], v1, s[4:7], s39 offen offset:1024
  s_waitcnt vmcnt(30)
  ds_read_b128 v[200:203], v1 offset:11264
  ds_read_b128 v[204:207], v1 offset:35840
  ds_read_b128 v[208:211], v6 offset:11264
  ds_read_b128 v[212:215], v6 offset:35840
  s_waitcnt lgkmcnt(4)
  v_mfma_f32_16x16x32_bf16 a[0:3], v[104:107], v[184:187], a[0:3]
  v_mfma_f32_16x16x32_bf16 a[4:7], v[104:107], v[188:191], a[4:7]
  v_mfma_f32_16x16x32_bf16 a[8:11], v[104:107], v[192:195], a[8:11]
  v_mfma_f32_16x16x32_bf16 a[12:15], v[104:107], v[196:199], a[12:15]
  v_mfma_f32_16x16x32_bf16 a[16:19], v[108:111], v[184:187], a[16:19]
  v_mfma_f32_16x16x32_bf16 a[20:23], v[108:111], v[188:191], a[20:23]
  v_mfma_f32_16x16x32_bf16 a[24:27], v[108:111], v[192:195], a[24:27]
  v_mfma_f32_16x16x32_bf16 a[28:31], v[108:111], v[196:199], a[28:31]
  v_mfma_f32_16x16x32_bf16 a[32:35], v[112:115], v[184:187], a[32:35]
  v_mfma_f32_16x16x32_bf16 a[36:39], v[112:115], v[188:191], a[36:39]
  v_mfma_f32_16x16x32_bf16 a[40:43], v[112:115], v[192:195], a[40:43]
  v_mfma_f32_16x16x32_bf16 a[44:47], v[112:115], v[196:199], a[44:47]
  v_mfma_f32_16x16x32_bf16 a[48:51], v[116:119], v[184:187], a[48:51]
  v_mfma_f32_16x16x32_bf16 a[52:55], v[116:119], v[188:191], a[52:55]
  v_mfma_f32_16x16x32_bf16 a[56:59], v[116:119], v[192:195], a[56:59]
  v_mfma_f32_16x16x32_bf16 a[60:63], v[116:119], v[196:199], a[60:63]
  v_mfma_f32_16x16x32_bf16 a[64:67], v[120:123], v[184:187], a[64:67]
  v_mfma_f32_16x16x32_bf16 a[68:71], v[120:123], v[188:191], a[68:71]
  v_mfma_f32_16x16x32_bf16 a[72:75], v[120:123], v[192:195], a[72:75]
  v_mfma_f32_16x16x32_bf16 a[76:79], v[120:123], v[196:199], a[76:79]
  v_mfma_f32_16x16x32_bf16 a[80:83], v[124:127], v[184:187], a[80:83]
  v_mfma_f32_16x16x32_bf16 a[84:87], v[124:127], v[188:191], a[84:87]
  v_mfma_f32_16x16x32_bf16 a[88:91], v[124:127], v[192:195], a[88:91]
  v_mfma_f32_16x16x32_bf16 a[92:95], v[124:127], v[196:199], a[92:95]
  v_mfma_f32_16x16x32_bf16 a[96:99], v[128:131], v[184:187], a[96:99]
  v_mfma_f32_16x16x32_bf16 a[100:103], v[128:131], v[188:191], a[100:103]
  v_mfma_f32_16x16x32_bf16 a[104:107], v[128:131], v[192:195], a[104:107]
  v_mfma_f32_16x16x32_bf16 a[108:111], v[128:131], v[196:199], a[108:111]
  v_mfma_f32_16x16x32_bf16 a[112:115], v[132:135], v[184:187], a[112:115]
  v_mfma_f32_16x16x32_bf16 a[116:119], v[132:135], v[188:191], a[116:119]
  v_mfma_f32_16x16x32_bf16 a[120:123], v[132:135], v[192:195], a[120:123]
  v_mfma_f32_16x16x32_bf16 a[124:127], v[132:135], v[196:199], a[124:127]
  v_mfma_f32_16x16x32_bf16 a[128:131], v[136:139], v[184:187], a[128:131]
  v_mfma_f32_16x16x32_bf16 a[132:135], v[136:139], v[188:191], a[132:135]
  v_mfma_f32_16x16x32_bf16 a[136:139], v[136:139], v[192:195], a[136:139]
  v_mfma_f32_16x16x32_bf16 a[140:143], v[136:139], v[196:199], a[140:143]
  v_mfma_f32_16x16x32_bf16 a[144:147], v[140:143], v[184:187], a[144:147]
  v_mfma_f32_16x16x32_bf16 a[148:151], v[140:143], v[188:191], a[148:151]
  v_mfma_f32_16x16x32_bf16 a[152:155], v[140:143], v[192:195], a[152:155]
  v_mfma_f32_16x16x32_bf16 a[156:159], v[140:143], v[196:199], a[156:159]
  buffer_load_dwordx4 v[104:107], v1, s[4:7], s30 offen offset:2048
  buffer_load_dwordx4 v[108:111], v1, s[4:7], s31 offen offset:2048
  buffer_load_dwordx4 v[112:115], v1, s[4:7], s32 offen offset:2048
  buffer_load_dwordx4 v[116:119], v1, s[4:7], s33 offen offset:2048
  buffer_load_dwordx4 v[120:123], v1, s[4:7], s34 offen offset:2048
  buffer_load_dwordx4 v[124:127], v1, s[4:7], s35 offen offset:2048
  buffer_load_dwordx4 v[128:131], v1, s[4:7], s36 offen offset:2048
  buffer_load_dwordx4 v[132:135], v1, s[4:7], s37 offen offset:2048
  buffer_load_dwordx4 v[136:139], v1, s[4:7], s38 offen offset:2048
  buffer_load_dwordx4 v[140:143], v1, s[4:7], s39 offen offset:2048
  s_waitcnt vmcnt(30)
  ds_read_b128 v[184:187], v1 offset:12288
  ds_read_b128 v[188:191], v1 offset:36864
  ds_read_b128 v[192:195], v6 offset:12288
  ds_read_b128 v[196:199], v6 offset:36864
  s_waitcnt lgkmcnt(4)
  v_mfma_f32_16x16x32_bf16 a[0:3], v[144:147], v[200:203], a[0:3]
  v_mfma_f32_16x16x32_bf16 a[4:7], v[144:147], v[204:207], a[4:7]
  v_mfma_f32_16x16x32_bf16 a[8:11], v[144:147], v[208:211], a[8:11]
  v_mfma_f32_16x16x32_bf16 a[12:15], v[144:147], v[212:215], a[12:15]
  v_mfma_f32_16x16x32_bf16 a[16:19], v[148:151], v[200:203], a[16:19]
  v_mfma_f32_16x16x32_bf16 a[20:23], v[148:151], v[204:207], a[20:23]
  v_mfma_f32_16x16x32_bf16 a[24:27], v[148:151], v[208:211], a[24:27]
  v_mfma_f32_16x16x32_bf16 a[28:31], v[148:151], v[212:215], a[28:31]
  v_mfma_f32_16x16x32_bf16 a[32:35], v[152:155], v[200:203], a[32:35]
  v_mfma_f32_16x16x32_bf16 a[36:39], v[152:155], v[204:207], a[36:39]
  v_mfma_f32_16x16x32_bf16 a[40:43], v[152:155], v[208:211], a[40:43]
  v_mfma_f32_16x16x32_bf16 a[44:47], v[152:155], v[212:215], a[44:47]
  v_mfma_f32_16x16x32_bf16 a[48:51], v[156:159], v[200:203], a[48:51]
  v_mfma_f32_16x16x32_bf16 a[52:55], v[156:159], v[204:207], a[52:55]
  v_mfma_f32_16x16x32_bf16 a[56:59], v[156:159], v[208:211], a[56:59]
  v_mfma_f32_16x16x32_bf16 a[60:63], v[156:159], v[212:215], a[60:63]
  v_mfma_f32_16x16x32_bf16 a[64:67], v[160:163], v[200:203], a[64:67]
  v_mfma_f32_16x16x32_bf16 a[68:71], v[160:163], v[204:207], a[68:71]
  v_mfma_f32_16x16x32_bf16 a[72:75], v[160:163], v[208:211], a[72:75]
  v_mfma_f32_16x16x32_bf16 a[76:79], v[160:163], v[212:215], a[76:79]
  v_mfma_f32_16x16x32_bf16 a[80:83], v[164:167], v[200:203], a[80:83]
  v_mfma_f32_16x16x32_bf16 a[84:87], v[164:167], v[204:207], a[84:87]
  v_mfma_f32_16x16x32_bf16 a[88:91], v[164:167], v[208:211], a[88:91]
  v_mfma_f32_16x16x32_bf16 a[92:95], v[164:167], v[212:215], a[92:95]
  v_mfma_f32_16x16x32_bf16 a[96:99], v[168:171], v[200:203], a[96:99]
  v_mfma_f32_16x16x32_bf16 a[100:103], v[168:171], v[204:207], a[100:103]
  v_mfma_f32_16x16x32_bf16 a[104:107], v[168:171], v[208:211], a[104:107]
  v_mfma_f32_16x16x32_bf16 a[108:111], v[168:171], v[212:215], a[108:111]
  v_mfma_f32_16x16x32_bf16 a[112:115], v[172:175], v[200:203], a[112:115]
  v_mfma_f32_16x16x32_bf16 a[116:119], v[172:175], v[204:207], a[116:119]
  v_mfma_f32_16x16x32_bf16 a[120:123], v[172:175], v[208:211], a[120:123]
  v_mfma_f32_16x16x32_bf16 a[124:127], v[172:175], v[212:215], a[124:127]
  v_mfma_f32_16x16x32_bf16 a[128:131], v[176:179], v[200:203], a[128:131]
  v_mfma_f32_16x16x32_bf16 a[132:135], v[176:179], v[204:207], a[132:135]
  v_mfma_f32_16x16x32_bf16 a[136:139], v[176:179], v[208:211], a[136:139]
  v_mfma_f32_16x16x32_bf16 a[140:143], v[176:179], v[212:215], a[140:143]
  v_mfma_f32_16x16x32_bf16 a[144:147], v[180:183], v[200:203], a[144:147]
  v_mfma_f32_16x16x32_bf16 a[148:151], v[180:183], v[204:207], a[148:151]
  v_mfma_f32_16x16x32_bf16 a[152:155], v[180:183], v[208:211], a[152:155]
  v_mfma_f32_16x16x32_bf16 a[156:159], v[180:183], v[212:215], a[156:159]
  buffer_load_dwordx4 v[144:147], v1, s[4:7], s30 offen offset:3072
  buffer_load_dwordx4 v[148:151], v1, s[4:7], s31 offen offset:3072
  buffer_load_dwordx4 v[152:155], v1, s[4:7], s32 offen offset:3072
  buffer_load_dwordx4 v[156:159], v1, s[4:7], s33 offen offset:3072
  buffer_load_dwordx4 v[160:163], v1, s[4:7], s34 offen offset:3072
  buffer_load_dwordx4 v[164:167], v1, s[4:7], s35 offen offset:3072
  buffer_load_dwordx4 v[168:171], v1, s[4:7], s36 offen offset:3072
  buffer_load_dwordx4 v[172:175], v1, s[4:7], s37 offen offset:3072
  buffer_load_dwordx4 v[176:179], v1, s[4:7], s38 offen offset:3072
  buffer_load_dwordx4 v[180:183], v1, s[4:7], s39 offen offset:3072
  s_add_u32 s30, s30, 4096
  s_add_u32 s31, s31, 4096
  s_add_u32 s32, s32, 4096
  s_add_u32 s33, s33, 4096
  s_add_u32 s34, s34, 4096
  s_add_u32 s35, s35, 4096
  s_add_u32 s36, s36, 4096
  s_add_u32 s37, s37, 4096
  s_add_u32 s38, s38, 4096
  s_add_u32 s39, s39, 4096
  s_waitcnt vmcnt(30)
  ds_read_b128 v[200:203], v1 offset:13312
  ds_read_b128 v[204:207], v1 offset:37888
  ds_read_b128 v[208:211], v6 offset:13312
  ds_read_b128 v[212:215], v6 offset:37888
  s_waitcnt lgkmcnt(4)
  v_mfma_f32_16x16x32_bf16 a[0:3], v[24:27], v[184:187], a[0:3]
  v_mfma_f32_16x16x32_bf16 a[4:7], v[24:27], v[188:191], a[4:7]
  v_mfma_f32_16x16x32_bf16 a[8:11], v[24:27], v[192:195], a[8:11]
  v_mfma_f32_16x16x32_bf16 a[12:15], v[24:27], v[196:199], a[12:15]
  v_mfma_f32_16x16x32_bf16 a[16:19], v[28:31], v[184:187], a[16:19]
  v_mfma_f32_16x16x32_bf16 a[20:23], v[28:31], v[188:191], a[20:23]
  v_mfma_f32_16x16x32_bf16 a[24:27], v[28:31], v[192:195], a[24:27]
  v_mfma_f32_16x16x32_bf16 a[28:31], v[28:31], v[196:199], a[28:31]
  v_mfma_f32_16x16x32_bf16 a[32:35], v[32:35], v[184:187], a[32:35]
  v_mfma_f32_16x16x32_bf16 a[36:39], v[32:35], v[188:191], a[36:39]
  v_mfma_f32_16x16x32_bf16 a[40:43], v[32:35], v[192:195], a[40:43]
  v_mfma_f32_16x16x32_bf16 a[44:47], v[32:35], v[196:199], a[44:47]
  v_mfma_f32_16x16x32_bf16 a[48:51], v[36:39], v[184:187], a[48:51]
  v_mfma_f32_16x16x32_bf16 a[52:55], v[36:39], v[188:191], a[52:55]
  v_mfma_f32_16x16x32_bf16 a[56:59], v[36:39], v[192:195], a[56:59]
  v_mfma_f32_16x16x32_bf16 a[60:63], v[36:39], v[196:199], a[60:63]
  v_mfma_f32_16x16x32_bf16 a[64:67], v[40:43], v[184:187], a[64:67]
  v_mfma_f32_16x16x32_bf16 a[68:71], v[40:43], v[188:191], a[68:71]
  v_mfma_f32_16x16x32_bf16 a[72:75], v[40:43], v[192:195], a[72:75]
  v_mfma_f32_16x16x32_bf16 a[76:79], v[40:43], v[196:199], a[76:79]
  v_mfma_f32_16x16x32_bf16 a[80:83], v[44:47], v[184:187], a[80:83]
  v_mfma_f32_16x16x32_bf16 a[84:87], v[44:47], v[188:191], a[84:87]
  v_mfma_f32_16x16x32_bf16 a[88:91], v[44:47], v[192:195], a[88:91]
  v_mfma_f32_16x16x32_bf16 a[92:95], v[44:47], v[196:199], a[92:95]
  v_mfma_f32_16x16x32_bf16 a[96:99], v[48:51], v[184:187], a[96:99]
  v_mfma_f32_16x16x32_bf16 a[100:103], v[48:51], v[188:191], a[100:103]
  v_mfma_f32_16x16x32_bf16 a[104:107], v[48:51], v[192:195], a[104:107]
  v_mfma_f32_16x16x32_bf16 a[108:111], v[48:51], v[196:199], a[108:111]
  v_mfma_f32_16x16x32_bf16 a[112:115], v[52:55], v[184:187], a[112:115]
  v_mfma_f32_16x16x32_bf16 a[116:119], v[52:55], v[188:191], a[116:119]
  v_mfma_f32_16x16x32_bf16 a[120:123], v[52:55], v[192:195], a[120:123]
  v_mfma_f32_16x16x32_bf16 a[124:127], v[52:55], v[196:199], a[124:127]
  v_mfma_f32_16x16x32_bf16 a[128:131], v[56:59], v[184:187], a[128:131]
  v_mfma_f32_16x16x32_bf16 a[132:135], v[56:59], v[188:191], a[132:135]
  v_mfma_f32_16x16x32_bf16 a[136:139], v[56:59], v[192:195], a[136:139]
  v_mfma_f32_16x16x32_bf16 a[140:143], v[56:59], v[196:199], a[140:143]
  v_mfma_f32_16x16x32_bf16 a[144:147], v[60:63], v[184:187], a[144:147]
  v_mfma_f32_16x16x32_bf16 a[148:151], v[60:63], v[188:191], a[148:151]
  v_mfma_f32_16x16x32_bf16 a[152:155], v[60:63], v[192:195], a[152:155]
  v_mfma_f32_16x16x32_bf16 a[156:159], v[60:63], v[196:199], a[156:159]
  buffer_load_dwordx4 v[24:27], v1, s[4:7], s30 offen offset:0
  buffer_load_dwordx4 v[28:31], v1, s[4:7], s31 offen offset:0
  buffer_load_dwordx4 v[32:35], v1, s[4:7], s32 offen offset:0
  buffer_load_dwordx4 v[36:39], v1, s[4:7], s33 offen offset:0
  buffer_load_dwordx4 v[40:43], v1, s[4:7], s34 offen offset:0
  buffer_load_dwordx4 v[44:47], v1, s[4:7], s35 offen offset:0
  buffer_load_dwordx4 v[48:51], v1, s[4:7], s36 offen offset:0
  buffer_load_dwordx4 v[52:55], v1, s[4:7], s37 offen offset:0
  buffer_load_dwordx4 v[56:59], v1, s[4:7], s38 offen offset:0
  buffer_load_dwordx4 v[60:63], v1, s[4:7], s39 offen offset:0
  s_waitcnt vmcnt(30)
  ds_read_b128 v[184:187], v1 offset:14336
  ds_read_b128 v[188:191], v1 offset:38912
  ds_read_b128 v[192:195], v6 offset:14336
  ds_read_b128 v[196:199], v6 offset:38912
  s_waitcnt lgkmcnt(4)
  v_mfma_f32_16x16x32_bf16 a[0:3], v[64:67], v[200:203], a[0:3]
  v_mfma_f32_16x16x32_bf16 a[4:7], v[64:67], v[204:207], a[4:7]
  v_mfma_f32_16x16x32_bf16 a[8:11], v[64:67], v[208:211], a[8:11]
  v_mfma_f32_16x16x32_bf16 a[12:15], v[64:67], v[212:215], a[12:15]
  v_mfma_f32_16x16x32_bf16 a[16:19], v[68:71], v[200:203], a[16:19]
  v_mfma_f32_16x16x32_bf16 a[20:23], v[68:71], v[204:207], a[20:23]
  v_mfma_f32_16x16x32_bf16 a[24:27], v[68:71], v[208:211], a[24:27]
  v_mfma_f32_16x16x32_bf16 a[28:31], v[68:71], v[212:215], a[28:31]
  v_mfma_f32_16x16x32_bf16 a[32:35], v[72:75], v[200:203], a[32:35]
  v_mfma_f32_16x16x32_bf16 a[36:39], v[72:75], v[204:207], a[36:39]
  v_mfma_f32_16x16x32_bf16 a[40:43], v[72:75], v[208:211], a[40:43]
  v_mfma_f32_16x16x32_bf16 a[44:47], v[72:75], v[212:215], a[44:47]
  v_mfma_f32_16x16x32_bf16 a[48:51], v[76:79], v[200:203], a[48:51]
  v_mfma_f32_16x16x32_bf16 a[52:55], v[76:79], v[204:207], a[52:55]
  v_mfma_f32_16x16x32_bf16 a[56:59], v[76:79], v[208:211], a[56:59]
  v_mfma_f32_16x16x32_bf16 a[60:63], v[76:79], v[212:215], a[60:63]
  v_mfma_f32_16x16x32_bf16 a[64:67], v[80:83], v[200:203], a[64:67]
  v_mfma_f32_16x16x32_bf16 a[68:71], v[80:83], v[204:207], a[68:71]
  v_mfma_f32_16x16x32_bf16 a[72:75], v[80:83], v[208:211], a[72:75]
  v_mfma_f32_16x16x32_bf16 a[76:79], v[80:83], v[212:215], a[76:79]
  v_mfma_f32_16x16x32_bf16 a[80:83], v[84:87], v[200:203], a[80:83]
  v_mfma_f32_16x16x32_bf16 a[84:87], v[84:87], v[204:207], a[84:87]
  v_mfma_f32_16x16x32_bf16 a[88:91], v[84:87], v[208:211], a[88:91]
  v_mfma_f32_16x16x32_bf16 a[92:95], v[84:87], v[212:215], a[92:95]
  v_mfma_f32_16x16x32_bf16 a[96:99], v[88:91], v[200:203], a[96:99]
  v_mfma_f32_16x16x32_bf16 a[100:103], v[88:91], v[204:207], a[100:103]
  v_mfma_f32_16x16x32_bf16 a[104:107], v[88:91], v[208:211], a[104:107]
  v_mfma_f32_16x16x32_bf16 a[108:111], v[88:91], v[212:215], a[108:111]
  v_mfma_f32_16x16x32_bf16 a[112:115], v[92:95], v[200:203], a[112:115]
  v_mfma_f32_16x16x32_bf16 a[116:119], v[92:95], v[204:207], a[116:119]
  v_mfma_f32_16x16x32_bf16 a[120:123], v[92:95], v[208:211], a[120:123]
  v_mfma_f32_16x16x32_bf16 a[124:127], v[92:95], v[212:215], a[124:127]
  v_mfma_f32_16x16x32_bf16 a[128:131], v[96:99], v[200:203], a[128:131]
  v_mfma_f32_16x16x32_bf16 a[132:135], v[96:99], v[204:207], a[132:135]
  v_mfma_f32_16x16x32_bf16 a[136:139], v[96:99], v[208:211], a[136:139]
  v_mfma_f32_16x16x32_bf16 a[140:143], v[96:99], v[212:215], a[140:143]
  v_mfma_f32_16x16x32_bf16 a[144:147], v[100:103], v[200:203], a[144:147]
  v_mfma_f32_16x16x32_bf16 a[148:151], v[100:103], v[204:207], a[148:151]
  v_mfma_f32_16x16x32_bf16 a[152:155], v[100:103], v[208:211], a[152:155]
  v_mfma_f32_16x16x32_bf16 a[156:159], v[100:103], v[212:215], a[156:159]
  buffer_load_dwordx4 v[64:67], v1, s[4:7], s30 offen offset:1024
  buffer_load_dwordx4 v[68:71], v1, s[4:7], s31 offen offset:1024
  buffer_load_dwordx4 v[72:75], v1, s[4:7], s32 offen offset:1024
  buffer_load_dwordx4 v[76:79], v1, s[4:7], s33 offen offset:1024
  buffer_load_dwordx4 v[80:83], v1, s[4:7], s34 offen offset:1024
  buffer_load_dwordx4 v[84:87], v1, s[4:7], s35 offen offset:1024
  buffer_load_dwordx4 v[88:91], v1, s[4:7], s36 offen offset:1024
  buffer_load_dwordx4 v[92:95], v1, s[4:7], s37 offen offset:1024
  buffer_load_dwordx4 v[96:99], v1, s[4:7], s38 offen offset:1024
  buffer_load_dwordx4 v[100:103], v1, s[4:7], s39 offen offset:1024
  s_waitcnt vmcnt(30)
  ds_read_b128 v[200:203], v1 offset:15360
  ds_read_b128 v[204:207], v1 offset:39936
  ds_read_b128 v[208:211], v6 offset:15360
  ds_read_b128 v[212:215], v6 offset:39936
  s_waitcnt lgkmcnt(4)
  v_mfma_f32_16x16x32_bf16 a[0:3], v[104:107], v[184:187], a[0:3]
  v_mfma_f32_16x16x32_bf16 a[4:7], v[104:107], v[188:191], a[4:7]
  v_mfma_f32_16x16x32_bf16 a[8:11], v[104:107], v[192:195], a[8:11]
  v_mfma_f32_16x16x32_bf16 a[12:15], v[104:107], v[196:199], a[12:15]
  v_mfma_f32_16x16x32_bf16 a[16:19], v[108:111], v[184:187], a[16:19]
  v_mfma_f32_16x16x32_bf16 a[20:23], v[108:111], v[188:191], a[20:23]
  v_mfma_f32_16x16x32_bf16 a[24:27], v[108:111], v[192:195], a[24:27]
  v_mfma_f32_16x16x32_bf16 a[28:31], v[108:111], v[196:199], a[28:31]
  v_mfma_f32_16x16x32_bf16 a[32:35], v[112:115], v[184:187], a[32:35]
  v_mfma_f32_16x16x32_bf16 a[36:39], v[112:115], v[188:191], a[36:39]
  v_mfma_f32_16x16x32_bf16 a[40:43], v[112:115], v[192:195], a[40:43]
  v_mfma_f32_16x16x32_bf16 a[44:47], v[112:115], v[196:199], a[44:47]
  v_mfma_f32_16x16x32_bf16 a[48:51], v[116:119], v[184:187], a[48:51]
  v_mfma_f32_16x16x32_bf16 a[52:55], v[116:119], v[188:191], a[52:55]
  v_mfma_f32_16x16x32_bf16 a[56:59], v[116:119], v[192:195], a[56:59]
  v_mfma_f32_16x16x32_bf16 a[60:63], v[116:119], v[196:199], a[60:63]
  v_mfma_f32_16x16x32_bf16 a[64:67], v[120:123], v[184:187], a[64:67]
  v_mfma_f32_16x16x32_bf16 a[68:71], v[120:123], v[188:191], a[68:71]
  v_mfma_f32_16x16x32_bf16 a[72:75], v[120:123], v[192:195], a[72:75]
  v_mfma_f32_16x16x32_bf16 a[76:79], v[120:123], v[196:199], a[76:79]
  v_mfma_f32_16x16x32_bf16 a[80:83], v[124:127], v[184:187], a[80:83]
  v_mfma_f32_16x16x32_bf16 a[84:87], v[124:127], v[188:191], a[84:87]
  v_mfma_f32_16x16x32_bf16 a[88:91], v[124:127], v[192:195], a[88:91]
  v_mfma_f32_16x16x32_bf16 a[92:95], v[124:127], v[196:199], a[92:95]
  v_mfma_f32_16x16x32_bf16 a[96:99], v[128:131], v[184:187], a[96:99]
  v_mfma_f32_16x16x32_bf16 a[100:103], v[128:131], v[188:191], a[100:103]
  v_mfma_f32_16x16x32_bf16 a[104:107], v[128:131], v[192:195], a[104:107]
  v_mfma_f32_16x16x32_bf16 a[108:111], v[128:131], v[196:199], a[108:111]
  v_mfma_f32_16x16x32_bf16 a[112:115], v[132:135], v[184:187], a[112:115]
  v_mfma_f32_16x16x32_bf16 a[116:119], v[132:135], v[188:191], a[116:119]
  v_mfma_f32_16x16x32_bf16 a[120:123], v[132:135], v[192:195], a[120:123]
  v_mfma_f32_16x16x32_bf16 a[124:127], v[132:135], v[196:199], a[124:127]
  v_mfma_f32_16x16x32_bf16 a[128:131], v[136:139], v[184:187], a[128:131]
  v_mfma_f32_16x16x32_bf16 a[132:135], v[136:139], v[188:191], a[132:135]
  v_mfma_f32_16x16x32_bf16 a[136:139], v[136:139], v[192:195], a[136:139]
  v_mfma_f32_16x16x32_bf16 a[140:143], v[136:139], v[196:199], a[140:143]
  v_mfma_f32_16x16x32_bf16 a[144:147], v[140:143], v[184:187], a[144:147]
  v_mfma_f32_16x16x32_bf16 a[148:151], v[140:143], v[188:191], a[148:151]
  v_mfma_f32_16x16x32_bf16 a[152:155], v[140:143], v[192:195], a[152:155]
  v_mfma_f32_16x16x32_bf16 a[156:159], v[140:143], v[196:199], a[156:159]
  buffer_load_dwordx4 v[104:107], v1, s[4:7], s30 offen offset:2048
  buffer_load_dwordx4 v[108:111], v1, s[4:7], s31 offen offset:2048
  buffer_load_dwordx4 v[112:115], v1, s[4:7], s32 offen offset:2048
  buffer_load_dwordx4 v[116:119], v1, s[4:7], s33 offen offset:2048
  buffer_load_dwordx4 v[120:123], v1, s[4:7], s34 offen offset:2048
  buffer_load_dwordx4 v[124:127], v1, s[4:7], s35 offen offset:2048
  buffer_load_dwordx4 v[128:131], v1, s[4:7], s36 offen offset:2048
  buffer_load_dwordx4 v[132:135], v1, s[4:7], s37 offen offset:2048
  buffer_load_dwordx4 v[136:139], v1, s[4:7], s38 offen offset:2048
  buffer_load_dwordx4 v[140:143], v1, s[4:7], s39 offen offset:2048
  s_waitcnt vmcnt(30)
  ds_read_b128 v[184:187], v1 offset:16384
  ds_read_b128 v[188:191], v1 offset:40960
  ds_read_b128 v[192:195], v6 offset:16384
  ds_read_b128 v[196:199], v6 offset:40960
  s_waitcnt lgkmcnt(4)
  v_mfma_f32_16x16x32_bf16 a[0:3], v[144:147], v[200:203], a[0:3]
  v_mfma_f32_16x16x32_bf16 a[4:7], v[144:147], v[204:207], a[4:7]
  v_mfma_f32_16x16x32_bf16 a[8:11], v[144:147], v[208:211], a[8:11]
  v_mfma_f32_16x16x32_bf16 a[12:15], v[144:147], v[212:215], a[12:15]
  v_mfma_f32_16x16x32_bf16 a[16:19], v[148:151], v[200:203], a[16:19]
  v_mfma_f32_16x16x32_bf16 a[20:23], v[148:151], v[204:207], a[20:23]
  v_mfma_f32_16x16x32_bf16 a[24:27], v[148:151], v[208:211], a[24:27]
  v_mfma_f32_16x16x32_bf16 a[28:31], v[148:151], v[212:215], a[28:31]
  v_mfma_f32_16x16x32_bf16 a[32:35], v[152:155], v[200:203], a[32:35]
  v_mfma_f32_16x16x32_bf16 a[36:39], v[152:155], v[204:207], a[36:39]
  v_mfma_f32_16x16x32_bf16 a[40:43], v[152:155], v[208:211], a[40:43]
  v_mfma_f32_16x16x32_bf16 a[44:47], v[152:155], v[212:215], a[44:47]
  v_mfma_f32_16x16x32_bf16 a[48:51], v[156:159], v[200:203], a[48:51]
  v_mfma_f32_16x16x32_bf16 a[52:55], v[156:159], v[204:207], a[52:55]
  v_mfma_f32_16x16x32_bf16 a[56:59], v[156:159], v[208:211], a[56:59]
  v_mfma_f32_16x16x32_bf16 a[60:63], v[156:159], v[212:215], a[60:63]
  v_mfma_f32_16x16x32_bf16 a[64:67], v[160:163], v[200:203], a[64:67]
  v_mfma_f32_16x16x32_bf16 a[68:71], v[160:163], v[204:207], a[68:71]
  v_mfma_f32_16x16x32_bf16 a[72:75], v[160:163], v[208:211], a[72:75]
  v_mfma_f32_16x16x32_bf16 a[76:79], v[160:163], v[212:215], a[76:79]
  v_mfma_f32_16x16x32_bf16 a[80:83], v[164:167], v[200:203], a[80:83]
  v_mfma_f32_16x16x32_bf16 a[84:87], v[164:167], v[204:207], a[84:87]
  v_mfma_f32_16x16x32_bf16 a[88:91], v[164:167], v[208:211], a[88:91]
  v_mfma_f32_16x16x32_bf16 a[92:95], v[164:167], v[212:215], a[92:95]
  v_mfma_f32_16x16x32_bf16 a[96:99], v[168:171], v[200:203], a[96:99]
  v_mfma_f32_16x16x32_bf16 a[100:103], v[168:171], v[204:207], a[100:103]
  v_mfma_f32_16x16x32_bf16 a[104:107], v[168:171], v[208:211], a[104:107]
  v_mfma_f32_16x16x32_bf16 a[108:111], v[168:171], v[212:215], a[108:111]
  v_mfma_f32_16x16x32_bf16 a[112:115], v[172:175], v[200:203], a[112:115]
  v_mfma_f32_16x16x32_bf16 a[116:119], v[172:175], v[204:207], a[116:119]
  v_mfma_f32_16x16x32_bf16 a[120:123], v[172:175], v[208:211], a[120:123]
  v_mfma_f32_16x16x32_bf16 a[124:127], v[172:175], v[212:215], a[124:127]
  v_mfma_f32_16x16x32_bf16 a[128:131], v[176:179], v[200:203], a[128:131]
  v_mfma_f32_16x16x32_bf16 a[132:135], v[176:179], v[204:207], a[132:135]
  v_mfma_f32_16x16x32_bf16 a[136:139], v[176:179], v[208:211], a[136:139]
  v_mfma_f32_16x16x32_bf16 a[140:143], v[176:179], v[212:215], a[140:143]
  v_mfma_f32_16x16x32_bf16 a[144:147], v[180:183], v[200:203], a[144:147]
  v_mfma_f32_16x16x32_bf16 a[148:151], v[180:183], v[204:207], a[148:151]
  v_mfma_f32_16x16x32_bf16 a[152:155], v[180:183], v[208:211], a[152:155]
  v_mfma_f32_16x16x32_bf16 a[156:159], v[180:183], v[212:215], a[156:159]
  buffer_load_dwordx4 v[144:147], v1, s[4:7], s30 offen offset:3072
  buffer_load_dwordx4 v[148:151], v1, s[4:7], s31 offen offset:3072
  buffer_load_dwordx4 v[152:155], v1, s[4:7], s32 offen offset:3072
  buffer_load_dwordx4 v[156:159], v1, s[4:7], s33 offen offset:3072
  buffer_load_dwordx4 v[160:163], v1, s[4:7], s34 offen offset:3072
  buffer_load_dwordx4 v[164:167], v1, s[4:7], s35 offen offset:3072
  buffer_load_dwordx4 v[168:171], v1, s[4:7], s36 offen offset:3072
  buffer_load_dwordx4 v[172:175], v1, s[4:7], s37 offen offset:3072
  buffer_load_dwordx4 v[176:179], v1, s[4:7], s38 offen offset:3072
  buffer_load_dwordx4 v[180:183], v1, s[4:7], s39 offen offset:3072
  s_add_u32 s30, s30, 4096
  s_add_u32 s31, s31, 4096
  s_add_u32 s32, s32, 4096
  s_add_u32 s33, s33, 4096
  s_add_u32 s34, s34, 4096
  s_add_u32 s35, s35, 4096
  s_add_u32 s36, s36, 4096
  s_add_u32 s37, s37, 4096
  s_add_u32 s38, s38, 4096
  s_add_u32 s39, s39, 4096
  s_waitcnt vmcnt(30)
  ds_read_b128 v[200:203], v1 offset:17408
  ds_read_b128 v[204:207], v1 offset:41984
  ds_read_b128 v[208:211], v6 offset:17408
  ds_read_b128 v[212:215], v6 offset:41984
  s_waitcnt lgkmcnt(4)
  v_mfma_f32_16x16x32_bf16 a[0:3], v[24:27], v[184:187], a[0:3]
  v_mfma_f32_16x16x32_bf16 a[4:7], v[24:27], v[188:191], a[4:7]
  v_mfma_f32_16x16x32_bf16 a[8:11], v[24:27], v[192:195], a[8:11]
  v_mfma_f32_16x16x32_bf16 a[12:15], v[24:27], v[196:199], a[12:15]
  v_mfma_f32_16x16x32_bf16 a[16:19], v[28:31], v[184:187], a[16:19]
  v_mfma_f32_16x16x32_bf16 a[20:23], v[28:31], v[188:191], a[20:23]
  v_mfma_f32_16x16x32_bf16 a[24:27], v[28:31], v[192:195], a[24:27]
  v_mfma_f32_16x16x32_bf16 a[28:31], v[28:31], v[196:199], a[28:31]
  v_mfma_f32_16x16x32_bf16 a[32:35], v[32:35], v[184:187], a[32:35]
  v_mfma_f32_16x16x32_bf16 a[36:39], v[32:35], v[188:191], a[36:39]
  v_mfma_f32_16x16x32_bf16 a[40:43], v[32:35], v[192:195], a[40:43]
  v_mfma_f32_16x16x32_bf16 a[44:47], v[32:35], v[196:199], a[44:47]
  v_mfma_f32_16x16x32_bf16 a[48:51], v[36:39], v[184:187], a[48:51]
  v_mfma_f32_16x16x32_bf16 a[52:55], v[36:39], v[188:191], a[52:55]
  v_mfma_f32_16x16x32_bf16 a[56:59], v[36:39], v[192:195], a[56:59]
  v_mfma_f32_16x16x32_bf16 a[60:63], v[36:39], v[196:199], a[60:63]
  v_mfma_f32_16x16x32_bf16 a[64:67], v[40:43], v[184:187], a[64:67]
  v_mfma_f32_16x16x32_bf16 a[68:71], v[40:43], v[188:191], a[68:71]
  v_mfma_f32_16x16x32_bf16 a[72:75], v[40:43], v[192:195], a[72:75]
  v_mfma_f32_16x16x32_bf16 a[76:79], v[40:43], v[196:199], a[76:79]
  v_mfma_f32_16x16x32_bf16 a[80:83], v[44:47], v[184:187], a[80:83]
  v_mfma_f32_16x16x32_bf16 a[84:87], v[44:47], v[188:191], a[84:87]
  v_mfma_f32_16x16x32_bf16 a[88:91], v[44:47], v[192:195], a[88:91]
  v_mfma_f32_16x16x32_bf16 a[92:95], v[44:47], v[196:199], a[92:95]
  v_mfma_f32_16x16x32_bf16 a[96:99], v[48:51], v[184:187], a[96:99]
  v_mfma_f32_16x16x32_bf16 a[100:103], v[48:51], v[188:191], a[100:103]
  v_mfma_f32_16x16x32_bf16 a[104:107], v[48:51], v[192:195], a[104:107]
  v_mfma_f32_16x16x32_bf16 a[108:111], v[48:51], v[196:199], a[108:111]
  v_mfma_f32_16x16x32_bf16 a[112:115], v[52:55], v[184:187], a[112:115]
  v_mfma_f32_16x16x32_bf16 a[116:119], v[52:55], v[188:191], a[116:119]
  v_mfma_f32_16x16x32_bf16 a[120:123], v[52:55], v[192:195], a[120:123]
  v_mfma_f32_16x16x32_bf16 a[124:127], v[52:55], v[196:199], a[124:127]
  v_mfma_f32_16x16x32_bf16 a[128:131], v[56:59], v[184:187], a[128:131]
  v_mfma_f32_16x16x32_bf16 a[132:135], v[56:59], v[188:191], a[132:135]
  v_mfma_f32_16x16x32_bf16 a[136:139], v[56:59], v[192:195], a[136:139]
  v_mfma_f32_16x16x32_bf16 a[140:143], v[56:59], v[196:199], a[140:143]
  v_mfma_f32_16x16x32_bf16 a[144:147], v[60:63], v[184:187], a[144:147]
  v_mfma_f32_16x16x32_bf16 a[148:151], v[60:63], v[188:191], a[148:151]
  v_mfma_f32_16x16x32_bf16 a[152:155], v[60:63], v[192:195], a[152:155]
  v_mfma_f32_16x16x32_bf16 a[156:159], v[60:63], v[196:199], a[156:159]
  buffer_load_dwordx4 v[24:27], v1, s[4:7], s30 offen offset:0
  buffer_load_dwordx4 v[28:31], v1, s[4:7], s31 offen offset:0
  buffer_load_dwordx4 v[32:35], v1, s[4:7], s32 offen offset:0
  buffer_load_dwordx4 v[36:39], v1, s[4:7], s33 offen offset:0
  buffer_load_dwordx4 v[40:43], v1, s[4:7], s34 offen offset:0
  buffer_load_dwordx4 v[44:47], v1, s[4:7], s35 offen offset:0
  buffer_load_dwordx4 v[48:51], v1, s[4:7], s36 offen offset:0
  buffer_load_dwordx4 v[52:55], v1, s[4:7], s37 offen offset:0
  buffer_load_dwordx4 v[56:59], v1, s[4:7], s38 offen offset:0
  buffer_load_dwordx4 v[60:63], v1, s[4:7], s39 offen offset:0
  s_waitcnt vmcnt(30)
  ds_read_b128 v[184:187], v1 offset:18432
  ds_read_b128 v[188:191], v1 offset:43008
  ds_read_b128 v[192:195], v6 offset:18432
  ds_read_b128 v[196:199], v6 offset:43008
  s_waitcnt lgkmcnt(4)
  v_mfma_f32_16x16x32_bf16 a[0:3], v[64:67], v[200:203], a[0:3]
  v_mfma_f32_16x16x32_bf16 a[4:7], v[64:67], v[204:207], a[4:7]
  v_mfma_f32_16x16x32_bf16 a[8:11], v[64:67], v[208:211], a[8:11]
  v_mfma_f32_16x16x32_bf16 a[12:15], v[64:67], v[212:215], a[12:15]
  v_mfma_f32_16x16x32_bf16 a[16:19], v[68:71], v[200:203], a[16:19]
  v_mfma_f32_16x16x32_bf16 a[20:23], v[68:71], v[204:207], a[20:23]
  v_mfma_f32_16x16x32_bf16 a[24:27], v[68:71], v[208:211], a[24:27]
  v_mfma_f32_16x16x32_bf16 a[28:31], v[68:71], v[212:215], a[28:31]
  v_mfma_f32_16x16x32_bf16 a[32:35], v[72:75], v[200:203], a[32:35]
  v_mfma_f32_16x16x32_bf16 a[36:39], v[72:75], v[204:207], a[36:39]
  v_mfma_f32_16x16x32_bf16 a[40:43], v[72:75], v[208:211], a[40:43]
  v_mfma_f32_16x16x32_bf16 a[44:47], v[72:75], v[212:215], a[44:47]
  v_mfma_f32_16x16x32_bf16 a[48:51], v[76:79], v[200:203], a[48:51]
  v_mfma_f32_16x16x32_bf16 a[52:55], v[76:79], v[204:207], a[52:55]
  v_mfma_f32_16x16x32_bf16 a[56:59], v[76:79], v[208:211], a[56:59]
  v_mfma_f32_16x16x32_bf16 a[60:63], v[76:79], v[212:215], a[60:63]
  v_mfma_f32_16x16x32_bf16 a[64:67], v[80:83], v[200:203], a[64:67]
  v_mfma_f32_16x16x32_bf16 a[68:71], v[80:83], v[204:207], a[68:71]
  v_mfma_f32_16x16x32_bf16 a[72:75], v[80:83], v[208:211], a[72:75]
  v_mfma_f32_16x16x32_bf16 a[76:79], v[80:83], v[212:215], a[76:79]
  v_mfma_f32_16x16x32_bf16 a[80:83], v[84:87], v[200:203], a[80:83]
  v_mfma_f32_16x16x32_bf16 a[84:87], v[84:87], v[204:207], a[84:87]
  v_mfma_f32_16x16x32_bf16 a[88:91], v[84:87], v[208:211], a[88:91]
  v_mfma_f32_16x16x32_bf16 a[92:95], v[84:87], v[212:215], a[92:95]
  v_mfma_f32_16x16x32_bf16 a[96:99], v[88:91], v[200:203], a[96:99]
  v_mfma_f32_16x16x32_bf16 a[100:103], v[88:91], v[204:207], a[100:103]
  v_mfma_f32_16x16x32_bf16 a[104:107], v[88:91], v[208:211], a[104:107]
  v_mfma_f32_16x16x32_bf16 a[108:111], v[88:91], v[212:215], a[108:111]
  v_mfma_f32_16x16x32_bf16 a[112:115], v[92:95], v[200:203], a[112:115]
  v_mfma_f32_16x16x32_bf16 a[116:119], v[92:95], v[204:207], a[116:119]
  v_mfma_f32_16x16x32_bf16 a[120:123], v[92:95], v[208:211], a[120:123]
  v_mfma_f32_16x16x32_bf16 a[124:127], v[92:95], v[212:215], a[124:127]
  v_mfma_f32_16x16x32_bf16 a[128:131], v[96:99], v[200:203], a[128:131]
  v_mfma_f32_16x16x32_bf16 a[132:135], v[96:99], v[204:207], a[132:135]
  v_mfma_f32_16x16x32_bf16 a[136:139], v[96:99], v[208:211], a[136:139]
  v_mfma_f32_16x16x32_bf16 a[140:143], v[96:99], v[212:215], a[140:143]
  v_mfma_f32_16x16x32_bf16 a[144:147], v[100:103], v[200:203], a[144:147]
  v_mfma_f32_16x16x32_bf16 a[148:151], v[100:103], v[204:207], a[148:151]
  v_mfma_f32_16x16x32_bf16 a[152:155], v[100:103], v[208:211], a[152:155]
  v_mfma_f32_16x16x32_bf16 a[156:159], v[100:103], v[212:215], a[156:159]
  buffer_load_dwordx4 v[64:67], v1, s[4:7], s30 offen offset:1024
  buffer_load_dwordx4 v[68:71], v1, s[4:7], s31 offen offset:1024
  buffer_load_dwordx4 v[72:75], v1, s[4:7], s32 offen offset:1024
  buffer_load_dwordx4 v[76:79], v1, s[4:7], s33 offen offset:1024
  buffer_load_dwordx4 v[80:83], v1, s[4:7], s34 offen offset:1024
  buffer_load_dwordx4 v[84:87], v1, s[4:7], s35 offen offset:1024
  buffer_load_dwordx4 v[88:91], v1, s[4:7], s36 offen offset:1024
  buffer_load_dwordx4 v[92:95], v1, s[4:7], s37 offen offset:1024
  buffer_load_dwordx4 v[96:99], v1, s[4:7], s38 offen offset:1024
  buffer_load_dwordx4 v[100:103], v1, s[4:7], s39 offen offset:1024
  s_waitcnt vmcnt(30)
  ds_read_b128 v[200:203], v1 offset:19456
  ds_read_b128 v[204:207], v1 offset:44032
  ds_read_b128 v[208:211], v6 offset:19456
  ds_read_b128 v[212:215], v6 offset:44032
  s_waitcnt lgkmcnt(4)
  v_mfma_f32_16x16x32_bf16 a[0:3], v[104:107], v[184:187], a[0:3]
  v_mfma_f32_16x16x32_bf16 a[4:7], v[104:107], v[188:191], a[4:7]
  v_mfma_f32_16x16x32_bf16 a[8:11], v[104:107], v[192:195], a[8:11]
  v_mfma_f32_16x16x32_bf16 a[12:15], v[104:107], v[196:199], a[12:15]
  v_mfma_f32_16x16x32_bf16 a[16:19], v[108:111], v[184:187], a[16:19]
  v_mfma_f32_16x16x32_bf16 a[20:23], v[108:111], v[188:191], a[20:23]
  v_mfma_f32_16x16x32_bf16 a[24:27], v[108:111], v[192:195], a[24:27]
  v_mfma_f32_16x16x32_bf16 a[28:31], v[108:111], v[196:199], a[28:31]
  v_mfma_f32_16x16x32_bf16 a[32:35], v[112:115], v[184:187], a[32:35]
  v_mfma_f32_16x16x32_bf16 a[36:39], v[112:115], v[188:191], a[36:39]
  v_mfma_f32_16x16x32_bf16 a[40:43], v[112:115], v[192:195], a[40:43]
  v_mfma_f32_16x16x32_bf16 a[44:47], v[112:115], v[196:199], a[44:47]
  v_mfma_f32_16x16x32_bf16 a[48:51], v[116:119], v[184:187], a[48:51]
  v_mfma_f32_16x16x32_bf16 a[52:55], v[116:119], v[188:191], a[52:55]
  v_mfma_f32_16x16x32_bf16 a[56:59], v[116:119], v[192:195], a[56:59]
  v_mfma_f32_16x16x32_bf16 a[60:63], v[116:119], v[196:199], a[60:63]
  v_mfma_f32_16x16x32_bf16 a[64:67], v[120:123], v[184:187], a[64:67]
  v_mfma_f32_16x16x32_bf16 a[68:71], v[120:123], v[188:191], a[68:71]
  v_mfma_f32_16x16x32_bf16 a[72:75], v[120:123], v[192:195], a[72:75]
  v_mfma_f32_16x16x32_bf16 a[76:79], v[120:123], v[196:199], a[76:79]
  v_mfma_f32_16x16x32_bf16 a[80:83], v[124:127], v[184:187], a[80:83]
  v_mfma_f32_16x16x32_bf16 a[84:87], v[124:127], v[188:191], a[84:87]
  v_mfma_f32_16x16x32_bf16 a[88:91], v[124:127], v[192:195], a[88:91]
  v_mfma_f32_16x16x32_bf16 a[92:95], v[124:127], v[196:199], a[92:95]
  v_mfma_f32_16x16x32_bf16 a[96:99], v[128:131], v[184:187], a[96:99]
  v_mfma_f32_16x16x32_bf16 a[100:103], v[128:131], v[188:191], a[100:103]
  v_mfma_f32_16x16x32_bf16 a[104:107], v[128:131], v[192:195], a[104:107]
  v_mfma_f32_16x16x32_bf16 a[108:111], v[128:131], v[196:199], a[108:111]
  v_mfma_f32_16x16x32_bf16 a[112:115], v[132:135], v[184:187], a[112:115]
  v_mfma_f32_16x16x32_bf16 a[116:119], v[132:135], v[188:191], a[116:119]
  v_mfma_f32_16x16x32_bf16 a[120:123], v[132:135], v[192:195], a[120:123]
  v_mfma_f32_16x16x32_bf16 a[124:127], v[132:135], v[196:199], a[124:127]
  v_mfma_f32_16x16x32_bf16 a[128:131], v[136:139], v[184:187], a[128:131]
  v_mfma_f32_16x16x32_bf16 a[132:135], v[136:139], v[188:191], a[132:135]
  v_mfma_f32_16x16x32_bf16 a[136:139], v[136:139], v[192:195], a[136:139]
  v_mfma_f32_16x16x32_bf16 a[140:143], v[136:139], v[196:199], a[140:143]
  v_mfma_f32_16x16x32_bf16 a[144:147], v[140:143], v[184:187], a[144:147]
  v_mfma_f32_16x16x32_bf16 a[148:151], v[140:143], v[188:191], a[148:151]
  v_mfma_f32_16x16x32_bf16 a[152:155], v[140:143], v[192:195], a[152:155]
  v_mfma_f32_16x16x32_bf16 a[156:159], v[140:143], v[196:199], a[156:159]
  buffer_load_dwordx4 v[104:107], v1, s[4:7], s30 offen offset:2048
  buffer_load_dwordx4 v[108:111], v1, s[4:7], s31 offen offset:2048
  buffer_load_dwordx4 v[112:115], v1, s[4:7], s32 offen offset:2048
  buffer_load_dwordx4 v[116:119], v1, s[4:7], s33 offen offset:2048
  buffer_load_dwordx4 v[120:123], v1, s[4:7], s34 offen offset:2048
  buffer_load_dwordx4 v[124:127], v1, s[4:7], s35 offen offset:2048
  buffer_load_dwordx4 v[128:131], v1, s[4:7], s36 offen offset:2048
  buffer_load_dwordx4 v[132:135], v1, s[4:7], s37 offen offset:2048
  buffer_load_dwordx4 v[136:139], v1, s[4:7], s38 offen offset:2048
  buffer_load_dwordx4 v[140:143], v1, s[4:7], s39 offen offset:2048
  s_waitcnt vmcnt(30)
  ds_read_b128 v[184:187], v1 offset:20480
  ds_read_b128 v[188:191], v1 offset:45056
  ds_read_b128 v[192:195], v6 offset:20480
  ds_read_b128 v[196:199], v6 offset:45056
  s_waitcnt lgkmcnt(4)
  v_mfma_f32_16x16x32_bf16 a[0:3], v[144:147], v[200:203], a[0:3]
  v_mfma_f32_16x16x32_bf16 a[4:7], v[144:147], v[204:207], a[4:7]
  v_mfma_f32_16x16x32_bf16 a[8:11], v[144:147], v[208:211], a[8:11]
  v_mfma_f32_16x16x32_bf16 a[12:15], v[144:147], v[212:215], a[12:15]
  v_mfma_f32_16x16x32_bf16 a[16:19], v[148:151], v[200:203], a[16:19]
  v_mfma_f32_16x16x32_bf16 a[20:23], v[148:151], v[204:207], a[20:23]
  v_mfma_f32_16x16x32_bf16 a[24:27], v[148:151], v[208:211], a[24:27]
  v_mfma_f32_16x16x32_bf16 a[28:31], v[148:151], v[212:215], a[28:31]
  v_mfma_f32_16x16x32_bf16 a[32:35], v[152:155], v[200:203], a[32:35]
  v_mfma_f32_16x16x32_bf16 a[36:39], v[152:155], v[204:207], a[36:39]
  v_mfma_f32_16x16x32_bf16 a[40:43], v[152:155], v[208:211], a[40:43]
  v_mfma_f32_16x16x32_bf16 a[44:47], v[152:155], v[212:215], a[44:47]
  v_mfma_f32_16x16x32_bf16 a[48:51], v[156:159], v[200:203], a[48:51]
  v_mfma_f32_16x16x32_bf16 a[52:55], v[156:159], v[204:207], a[52:55]
  v_mfma_f32_16x16x32_bf16 a[56:59], v[156:159], v[208:211], a[56:59]
  v_mfma_f32_16x16x32_bf16 a[60:63], v[156:159], v[212:215], a[60:63]
  v_mfma_f32_16x16x32_bf16 a[64:67], v[160:163], v[200:203], a[64:67]
  v_mfma_f32_16x16x32_bf16 a[68:71], v[160:163], v[204:207], a[68:71]
  v_mfma_f32_16x16x32_bf16 a[72:75], v[160:163], v[208:211], a[72:75]
  v_mfma_f32_16x16x32_bf16 a[76:79], v[160:163], v[212:215], a[76:79]
  v_mfma_f32_16x16x32_bf16 a[80:83], v[164:167], v[200:203], a[80:83]
  v_mfma_f32_16x16x32_bf16 a[84:87], v[164:167], v[204:207], a[84:87]
  v_mfma_f32_16x16x32_bf16 a[88:91], v[164:167], v[208:211], a[88:91]
  v_mfma_f32_16x16x32_bf16 a[92:95], v[164:167], v[212:215], a[92:95]
  v_mfma_f32_16x16x32_bf16 a[96:99], v[168:171], v[200:203], a[96:99]
  v_mfma_f32_16x16x32_bf16 a[100:103], v[168:171], v[204:207], a[100:103]
  v_mfma_f32_16x16x32_bf16 a[104:107], v[168:171], v[208:211], a[104:107]
  v_mfma_f32_16x16x32_bf16 a[108:111], v[168:171], v[212:215], a[108:111]
  v_mfma_f32_16x16x32_bf16 a[112:115], v[172:175], v[200:203], a[112:115]
  v_mfma_f32_16x16x32_bf16 a[116:119], v[172:175], v[204:207], a[116:119]
  v_mfma_f32_16x16x32_bf16 a[120:123], v[172:175], v[208:211], a[120:123]
  v_mfma_f32_16x16x32_bf16 a[124:127], v[172:175], v[212:215], a[124:127]
  v_mfma_f32_16x16x32_bf16 a[128:131], v[176:179], v[200:203], a[128:131]
  v_mfma_f32_16x16x32_bf16 a[132:135], v[176:179], v[204:207], a[132:135]
  v_mfma_f32_16x16x32_bf16 a[136:139], v[176:179], v[208:211], a[136:139]
  v_mfma_f32_16x16x32_bf16 a[140:143], v[176:179], v[212:215], a[140:143]
  v_mfma_f32_16x16x32_bf16 a[144:147], v[180:183], v[200:203], a[144:147]
  v_mfma_f32_16x16x32_bf16 a[148:151], v[180:183], v[204:207], a[148:151]
  v_mfma_f32_16x16x32_bf16 a[152:155], v[180:183], v[208:211], a[152:155]
  v_mfma_f32_16x16x32_bf16 a[156:159], v[180:183], v[212:215], a[156:159]
  buffer_load_dwordx4 v[144:147], v1, s[4:7], s30 offen offset:3072
  buffer_load_dwordx4 v[148:151], v1, s[4:7], s31 offen offset:3072
  buffer_load_dwordx4 v[152:155], v1, s[4:7], s32 offen offset:3072
  buffer_load_dwordx4 v[156:159], v1, s[4:7], s33 offen offset:3072
  buffer_load_dwordx4 v[160:163], v1, s[4:7], s34 offen offset:3072
  buffer_load_dwordx4 v[164:167], v1, s[4:7], s35 offen offset:3072
  buffer_load_dwordx4 v[168:171], v1, s[4:7], s36 offen offset:3072
  buffer_load_dwordx4 v[172:175], v1, s[4:7], s37 offen offset:3072
  buffer_load_dwordx4 v[176:179], v1, s[4:7], s38 offen offset:3072
  buffer_load_dwordx4 v[180:183], v1, s[4:7], s39 offen offset:3072
  s_add_u32 s30, s30, 4096
  s_add_u32 s31, s31, 4096
  s_add_u32 s32, s32, 4096
  s_add_u32 s33, s33, 4096
  s_add_u32 s34, s34, 4096
  s_add_u32 s35, s35, 4096
  s_add_u32 s36, s36, 4096
  s_add_u32 s37, s37, 4096
  s_add_u32 s38, s38, 4096
  s_add_u32 s39, s39, 4096
  s_waitcnt vmcnt(30)
  ds_read_b128 v[200:203], v1 offset:21504
  ds_read_b128 v[204:207], v1 offset:46080
  ds_read_b128 v[208:211], v6 offset:21504
  ds_read_b128 v[212:215], v6 offset:46080
  s_waitcnt lgkmcnt(4)
  v_mfma_f32_16x16x32_bf16 a[0:3], v[24:27], v[184:187], a[0:3]
  v_mfma_f32_16x16x32_bf16 a[4:7], v[24:27], v[188:191], a[4:7]
  v_mfma_f32_16x16x32_bf16 a[8:11], v[24:27], v[192:195], a[8:11]
  v_mfma_f32_16x16x32_bf16 a[12:15], v[24:27], v[196:199], a[12:15]
  v_mfma_f32_16x16x32_bf16 a[16:19], v[28:31], v[184:187], a[16:19]
  v_mfma_f32_16x16x32_bf16 a[20:23], v[28:31], v[188:191], a[20:23]
  v_mfma_f32_16x16x32_bf16 a[24:27], v[28:31], v[192:195], a[24:27]
  v_mfma_f32_16x16x32_bf16 a[28:31], v[28:31], v[196:199], a[28:31]
  v_mfma_f32_16x16x32_bf16 a[32:35], v[32:35], v[184:187], a[32:35]
  v_mfma_f32_16x16x32_bf16 a[36:39], v[32:35], v[188:191], a[36:39]
  v_mfma_f32_16x16x32_bf16 a[40:43], v[32:35], v[192:195], a[40:43]
  v_mfma_f32_16x16x32_bf16 a[44:47], v[32:35], v[196:199], a[44:47]
  v_mfma_f32_16x16x32_bf16 a[48:51], v[36:39], v[184:187], a[48:51]
  v_mfma_f32_16x16x32_bf16 a[52:55], v[36:39], v[188:191], a[52:55]
  v_mfma_f32_16x16x32_bf16 a[56:59], v[36:39], v[192:195], a[56:59]
  v_mfma_f32_16x16x32_bf16 a[60:63], v[36:39], v[196:199], a[60:63]
  v_mfma_f32_16x16x32_bf16 a[64:67], v[40:43], v[184:187], a[64:67]
  v_mfma_f32_16x16x32_bf16 a[68:71], v[40:43], v[188:191], a[68:71]
  v_mfma_f32_16x16x32_bf16 a[72:75], v[40:43], v[192:195], a[72:75]
  v_mfma_f32_16x16x32_bf16 a[76:79], v[40:43], v[196:199], a[76:79]
  v_mfma_f32_16x16x32_bf16 a[80:83], v[44:47], v[184:187], a[80:83]
  v_mfma_f32_16x16x32_bf16 a[84:87], v[44:47], v[188:191], a[84:87]
  v_mfma_f32_16x16x32_bf16 a[88:91], v[44:47], v[192:195], a[88:91]
  v_mfma_f32_16x16x32_bf16 a[92:95], v[44:47], v[196:199], a[92:95]
  v_mfma_f32_16x16x32_bf16 a[96:99], v[48:51], v[184:187], a[96:99]
  v_mfma_f32_16x16x32_bf16 a[100:103], v[48:51], v[188:191], a[100:103]
  v_mfma_f32_16x16x32_bf16 a[104:107], v[48:51], v[192:195], a[104:107]
  v_mfma_f32_16x16x32_bf16 a[108:111], v[48:51], v[196:199], a[108:111]
  v_mfma_f32_16x16x32_bf16 a[112:115], v[52:55], v[184:187], a[112:115]
  v_mfma_f32_16x16x32_bf16 a[116:119], v[52:55], v[188:191], a[116:119]
  v_mfma_f32_16x16x32_bf16 a[120:123], v[52:55], v[192:195], a[120:123]
  v_mfma_f32_16x16x32_bf16 a[124:127], v[52:55], v[196:199], a[124:127]
  v_mfma_f32_16x16x32_bf16 a[128:131], v[56:59], v[184:187], a[128:131]
  v_mfma_f32_16x16x32_bf16 a[132:135], v[56:59], v[188:191], a[132:135]
  v_mfma_f32_16x16x32_bf16 a[136:139], v[56:59], v[192:195], a[136:139]
  v_mfma_f32_16x16x32_bf16 a[140:143], v[56:59], v[196:199], a[140:143]
  v_mfma_f32_16x16x32_bf16 a[144:147], v[60:63], v[184:187], a[144:147]
  v_mfma_f32_16x16x32_bf16 a[148:151], v[60:63], v[188:191], a[148:151]
  v_mfma_f32_16x16x32_bf16 a[152:155], v[60:63], v[192:195], a[152:155]
  v_mfma_f32_16x16x32_bf16 a[156:159], v[60:63], v[196:199], a[156:159]
  s_waitcnt vmcnt(20)
  ds_read_b128 v[184:187], v1 offset:22528
  ds_read_b128 v[188:191], v1 offset:47104
  ds_read_b128 v[192:195], v6 offset:22528
  ds_read_b128 v[196:199], v6 offset:47104
  s_waitcnt lgkmcnt(4)
  v_mfma_f32_16x16x32_bf16 a[0:3], v[64:67], v[200:203], a[0:3]
  v_mfma_f32_16x16x32_bf16 a[4:7], v[64:67], v[204:207], a[4:7]
  v_mfma_f32_16x16x32_bf16 a[8:11], v[64:67], v[208:211], a[8:11]
  v_mfma_f32_16x16x32_bf16 a[12:15], v[64:67], v[212:215], a[12:15]
  v_mfma_f32_16x16x32_bf16 a[16:19], v[68:71], v[200:203], a[16:19]
  v_mfma_f32_16x16x32_bf16 a[20:23], v[68:71], v[204:207], a[20:23]
  v_mfma_f32_16x16x32_bf16 a[24:27], v[68:71], v[208:211], a[24:27]
  v_mfma_f32_16x16x32_bf16 a[28:31], v[68:71], v[212:215], a[28:31]
  v_mfma_f32_16x16x32_bf16 a[32:35], v[72:75], v[200:203], a[32:35]
  v_mfma_f32_16x16x32_bf16 a[36:39], v[72:75], v[204:207], a[36:39]
  v_mfma_f32_16x16x32_bf16 a[40:43], v[72:75], v[208:211], a[40:43]
  v_mfma_f32_16x16x32_bf16 a[44:47], v[72:75], v[212:215], a[44:47]
  v_mfma_f32_16x16x32_bf16 a[48:51], v[76:79], v[200:203], a[48:51]
  v_mfma_f32_16x16x32_bf16 a[52:55], v[76:79], v[204:207], a[52:55]
  v_mfma_f32_16x16x32_bf16 a[56:59], v[76:79], v[208:211], a[56:59]
  v_mfma_f32_16x16x32_bf16 a[60:63], v[76:79], v[212:215], a[60:63]
  v_mfma_f32_16x16x32_bf16 a[64:67], v[80:83], v[200:203], a[64:67]
  v_mfma_f32_16x16x32_bf16 a[68:71], v[80:83], v[204:207], a[68:71]
  v_mfma_f32_16x16x32_bf16 a[72:75], v[80:83], v[208:211], a[72:75]
  v_mfma_f32_16x16x32_bf16 a[76:79], v[80:83], v[212:215], a[76:79]
  v_mfma_f32_16x16x32_bf16 a[80:83], v[84:87], v[200:203], a[80:83]
  v_mfma_f32_16x16x32_bf16 a[84:87], v[84:87], v[204:207], a[84:87]
  v_mfma_f32_16x16x32_bf16 a[88:91], v[84:87], v[208:211], a[88:91]
  v_mfma_f32_16x16x32_bf16 a[92:95], v[84:87], v[212:215], a[92:95]
  v_mfma_f32_16x16x32_bf16 a[96:99], v[88:91], v[200:203], a[96:99]
  v_mfma_f32_16x16x32_bf16 a[100:103], v[88:91], v[204:207], a[100:103]
  v_mfma_f32_16x16x32_bf16 a[104:107], v[88:91], v[208:211], a[104:107]
  v_mfma_f32_16x16x32_bf16 a[108:111], v[88:91], v[212:215], a[108:111]
  v_mfma_f32_16x16x32_bf16 a[112:115], v[92:95], v[200:203], a[112:115]
  v_mfma_f32_16x16x32_bf16 a[116:119], v[92:95], v[204:207], a[116:119]
  v_mfma_f32_16x16x32_bf16 a[120:123], v[92:95], v[208:211], a[120:123]
  v_mfma_f32_16x16x32_bf16 a[124:127], v[92:95], v[212:215], a[124:127]
  v_mfma_f32_16x16x32_bf16 a[128:131], v[96:99], v[200:203], a[128:131]
  v_mfma_f32_16x16x32_bf16 a[132:135], v[96:99], v[204:207], a[132:135]
  v_mfma_f32_16x16x32_bf16 a[136:139], v[96:99], v[208:211], a[136:139]
  v_mfma_f32_16x16x32_bf16 a[140:143], v[96:99], v[212:215], a[140:143]
  v_mfma_f32_16x16x32_bf16 a[144:147], v[100:103], v[200:203], a[144:147]
  v_mfma_f32_16x16x32_bf16 a[148:151], v[100:103], v[204:207], a[148:151]
  v_mfma_f32_16x16x32_bf16 a[152:155], v[100:103], v[208:211], a[152:155]
  v_mfma_f32_16x16x32_bf16 a[156:159], v[100:103], v[212:215], a[156:159]
  s_waitcnt vmcnt(10)
  ds_read_b128 v[200:203], v1 offset:23552
  ds_read_b128 v[204:207], v1 offset:48128
  ds_read_b128 v[208:211], v6 offset:23552
  ds_read_b128 v[212:215], v6 offset:48128
  s_waitcnt lgkmcnt(4)
  v_mfma_f32_16x16x32_bf16 a[0:3], v[104:107], v[184:187], a[0:3]
  v_mfma_f32_16x16x32_bf16 a[4:7], v[104:107], v[188:191], a[4:7]
  v_mfma_f32_16x16x32_bf16 a[8:11], v[104:107], v[192:195], a[8:11]
  v_mfma_f32_16x16x32_bf16 a[12:15], v[104:107], v[196:199], a[12:15]
  v_mfma_f32_16x16x32_bf16 a[16:19], v[108:111], v[184:187], a[16:19]
  v_mfma_f32_16x16x32_bf16 a[20:23], v[108:111], v[188:191], a[20:23]
  v_mfma_f32_16x16x32_bf16 a[24:27], v[108:111], v[192:195], a[24:27]
  v_mfma_f32_16x16x32_bf16 a[28:31], v[108:111], v[196:199], a[28:31]
  v_mfma_f32_16x16x32_bf16 a[32:35], v[112:115], v[184:187], a[32:35]
  v_mfma_f32_16x16x32_bf16 a[36:39], v[112:115], v[188:191], a[36:39]
  v_mfma_f32_16x16x32_bf16 a[40:43], v[112:115], v[192:195], a[40:43]
  v_mfma_f32_16x16x32_bf16 a[44:47], v[112:115], v[196:199], a[44:47]
  v_mfma_f32_16x16x32_bf16 a[48:51], v[116:119], v[184:187], a[48:51]
  v_mfma_f32_16x16x32_bf16 a[52:55], v[116:119], v[188:191], a[52:55]
  v_mfma_f32_16x16x32_bf16 a[56:59], v[116:119], v[192:195], a[56:59]
  v_mfma_f32_16x16x32_bf16 a[60:63], v[116:119], v[196:199], a[60:63]
  v_mfma_f32_16x16x32_bf16 a[64:67], v[120:123], v[184:187], a[64:67]
  v_mfma_f32_16x16x32_bf16 a[68:71], v[120:123], v[188:191], a[68:71]
  v_mfma_f32_16x16x32_bf16 a[72:75], v[120:123], v[192:195], a[72:75]
  v_mfma_f32_16x16x32_bf16 a[76:79], v[120:123], v[196:199], a[76:79]
  v_mfma_f32_16x16x32_bf16 a[80:83], v[124:127], v[184:187], a[80:83]
  v_mfma_f32_16x16x32_bf16 a[84:87], v[124:127], v[188:191], a[84:87]
  v_mfma_f32_16x16x32_bf16 a[88:91], v[124:127], v[192:195], a[88:91]
  v_mfma_f32_16x16x32_bf16 a[92:95], v[124:127], v[196:199], a[92:95]
  v_mfma_f32_16x16x32_bf16 a[96:99], v[128:131], v[184:187], a[96:99]
  v_mfma_f32_16x16x32_bf16 a[100:103], v[128:131], v[188:191], a[100:103]
  v_mfma_f32_16x16x32_bf16 a[104:107], v[128:131], v[192:195], a[104:107]
  v_mfma_f32_16x16x32_bf16 a[108:111], v[128:131], v[196:199], a[108:111]
  v_mfma_f32_16x16x32_bf16 a[112:115], v[132:135], v[184:187], a[112:115]
  v_mfma_f32_16x16x32_bf16 a[116:119], v[132:135], v[188:191], a[116:119]
  v_mfma_f32_16x16x32_bf16 a[120:123], v[132:135], v[192:195], a[120:123]
  v_mfma_f32_16x16x32_bf16 a[124:127], v[132:135], v[196:199], a[124:127]
  v_mfma_f32_16x16x32_bf16 a[128:131], v[136:139], v[184:187], a[128:131]
  v_mfma_f32_16x16x32_bf16 a[132:135], v[136:139], v[188:191], a[132:135]
  v_mfma_f32_16x16x32_bf16 a[136:139], v[136:139], v[192:195], a[136:139]
  v_mfma_f32_16x16x32_bf16 a[140:143], v[136:139], v[196:199], a[140:143]
  v_mfma_f32_16x16x32_bf16 a[144:147], v[140:143], v[184:187], a[144:147]
  v_mfma_f32_16x16x32_bf16 a[148:151], v[140:143], v[188:191], a[148:151]
  v_mfma_f32_16x16x32_bf16 a[152:155], v[140:143], v[192:195], a[152:155]
  v_mfma_f32_16x16x32_bf16 a[156:159], v[140:143], v[196:199], a[156:159]
  s_waitcnt vmcnt(0)
  s_waitcnt lgkmcnt(0)
  v_mfma_f32_16x16x32_bf16 a[0:3], v[144:147], v[200:203], a[0:3]
  v_mfma_f32_16x16x32_bf16 a[4:7], v[144:147], v[204:207], a[4:7]
  v_mfma_f32_16x16x32_bf16 a[8:11], v[144:147], v[208:211], a[8:11]
  v_mfma_f32_16x16x32_bf16 a[12:15], v[144:147], v[212:215], a[12:15]
  v_mfma_f32_16x16x32_bf16 a[16:19], v[148:151], v[200:203], a[16:19]
  v_mfma_f32_16x16x32_bf16 a[20:23], v[148:151], v[204:207], a[20:23]
  v_mfma_f32_16x16x32_bf16 a[24:27], v[148:151], v[208:211], a[24:27]
  v_mfma_f32_16x16x32_bf16 a[28:31], v[148:151], v[212:215], a[28:31]
  v_mfma_f32_16x16x32_bf16 a[32:35], v[152:155], v[200:203], a[32:35]
  v_mfma_f32_16x16x32_bf16 a[36:39], v[152:155], v[204:207], a[36:39]
  v_mfma_f32_16x16x32_bf16 a[40:43], v[152:155], v[208:211], a[40:43]
  v_mfma_f32_16x16x32_bf16 a[44:47], v[152:155], v[212:215], a[44:47]
  v_mfma_f32_16x16x32_bf16 a[48:51], v[156:159], v[200:203], a[48:51]
  v_mfma_f32_16x16x32_bf16 a[52:55], v[156:159], v[204:207], a[52:55]
  v_mfma_f32_16x16x32_bf16 a[56:59], v[156:159], v[208:211], a[56:59]
  v_mfma_f32_16x16x32_bf16 a[60:63], v[156:159], v[212:215], a[60:63]
  v_mfma_f32_16x16x32_bf16 a[64:67], v[160:163], v[200:203], a[64:67]
  v_mfma_f32_16x16x32_bf16 a[68:71], v[160:163], v[204:207], a[68:71]
  v_mfma_f32_16x16x32_bf16 a[72:75], v[160:163], v[208:211], a[72:75]
  v_mfma_f32_16x16x32_bf16 a[76:79], v[160:163], v[212:215], a[76:79]
  v_mfma_f32_16x16x32_bf16 a[80:83], v[164:167], v[200:203], a[80:83]
  v_mfma_f32_16x16x32_bf16 a[84:87], v[164:167], v[204:207], a[84:87]
  v_mfma_f32_16x16x32_bf16 a[88:91], v[164:167], v[208:211], a[88:91]
  v_mfma_f32_16x16x32_bf16 a[92:95], v[164:167], v[212:215], a[92:95]
  v_mfma_f32_16x16x32_bf16 a[96:99], v[168:171], v[200:203], a[96:99]
  v_mfma_f32_16x16x32_bf16 a[100:103], v[168:171], v[204:207], a[100:103]
  v_mfma_f32_16x16x32_bf16 a[104:107], v[168:171], v[208:211], a[104:107]
  v_mfma_f32_16x16x32_bf16 a[108:111], v[168:171], v[212:215], a[108:111]
  v_mfma_f32_16x16x32_bf16 a[112:115], v[172:175], v[200:203], a[112:115]
  v_mfma_f32_16x16x32_bf16 a[116:119], v[172:175], v[204:207], a[116:119]
  v_mfma_f32_16x16x32_bf16 a[120:123], v[172:175], v[208:211], a[120:123]
  v_mfma_f32_16x16x32_bf16 a[124:127], v[172:175], v[212:215], a[124:127]
  v_mfma_f32_16x16x32_bf16 a[128:131], v[176:179], v[200:203], a[128:131]
  v_mfma_f32_16x16x32_bf16 a[132:135], v[176:179], v[204:207], a[132:135]
  v_mfma_f32_16x16x32_bf16 a[136:139], v[176:179], v[208:211], a[136:139]
  v_mfma_f32_16x16x32_bf16 a[140:143], v[176:179], v[212:215], a[140:143]
  v_mfma_f32_16x16x32_bf16 a[144:147], v[180:183], v[200:203], a[144:147]
  v_mfma_f32_16x16x32_bf16 a[148:151], v[180:183], v[204:207], a[148:151]
  v_mfma_f32_16x16x32_bf16 a[152:155], v[180:183], v[208:211], a[152:155]
  v_mfma_f32_16x16x32_bf16 a[156:159], v[180:183], v[212:215], a[156:159]
  s_lshl_b32 s16, s13, 7
  s_lshl_b32 s17, s14, 2
  s_add_u32 s16, s16, s17
  s_mul_i32 s16, s16, 20
  s_mul_i32 s17, s12, 5
  s_add_u32 s16, s16, s17
  s_lshl_b32 s16, s16, 10
  s_add_u32 s16, s16, 92798976
  s_nop 7
  s_add_u32 s17, s16, 0
  v_accvgpr_read_b32 v24, a0
  v_accvgpr_read_b32 v25, a1
  v_accvgpr_read_b32 v26, a2
  v_accvgpr_read_b32 v27, a3
  v_accvgpr_read_b32 v28, a16
  v_accvgpr_read_b32 v29, a17
  v_accvgpr_read_b32 v30, a18
  v_accvgpr_read_b32 v31, a19
  v_cvt_pk_bf16_f32 v32, v24, v25
  v_cvt_pk_bf16_f32 v33, v26, v27
  v_cvt_pk_bf16_f32 v34, v28, v29
  v_cvt_pk_bf16_f32 v35, v30, v31
  buffer_store_dwordx4 v[32:35], v1, s[4:7], s17 offen offset:0 sc1
  v_accvgpr_read_b32 v36, a32
  v_accvgpr_read_b32 v37, a33
  v_accvgpr_read_b32 v38, a34
  v_accvgpr_read_b32 v39, a35
  v_accvgpr_read_b32 v40, a48
  v_accvgpr_read_b32 v41, a49
  v_accvgpr_read_b32 v42, a50
  v_accvgpr_read_b32 v43, a51
  v_cvt_pk_bf16_f32 v44, v36, v37
  v_cvt_pk_bf16_f32 v45, v38, v39
  v_cvt_pk_bf16_f32 v46, v40, v41
  v_cvt_pk_bf16_f32 v47, v42, v43
  buffer_store_dwordx4 v[44:47], v1, s[4:7], s17 offen offset:1024 sc1
  v_accvgpr_read_b32 v48, a64
  v_accvgpr_read_b32 v49, a65
  v_accvgpr_read_b32 v50, a66
  v_accvgpr_read_b32 v51, a67
  v_accvgpr_read_b32 v52, a80
  v_accvgpr_read_b32 v53, a81
  v_accvgpr_read_b32 v54, a82
  v_accvgpr_read_b32 v55, a83
  v_cvt_pk_bf16_f32 v56, v48, v49
  v_cvt_pk_bf16_f32 v57, v50, v51
  v_cvt_pk_bf16_f32 v58, v52, v53
  v_cvt_pk_bf16_f32 v59, v54, v55
  buffer_store_dwordx4 v[56:59], v1, s[4:7], s17 offen offset:2048 sc1
  v_accvgpr_read_b32 v60, a96
  v_accvgpr_read_b32 v61, a97
  v_accvgpr_read_b32 v62, a98
  v_accvgpr_read_b32 v63, a99
  v_accvgpr_read_b32 v64, a112
  v_accvgpr_read_b32 v65, a113
  v_accvgpr_read_b32 v66, a114
  v_accvgpr_read_b32 v67, a115
  v_cvt_pk_bf16_f32 v68, v60, v61
  v_cvt_pk_bf16_f32 v69, v62, v63
  v_cvt_pk_bf16_f32 v70, v64, v65
  v_cvt_pk_bf16_f32 v71, v66, v67
  buffer_store_dwordx4 v[68:71], v1, s[4:7], s17 offen offset:3072 sc1
  v_accvgpr_read_b32 v24, a128
  v_accvgpr_read_b32 v25, a129
  v_accvgpr_read_b32 v26, a130
  v_accvgpr_read_b32 v27, a131
  v_accvgpr_read_b32 v28, a144
  v_accvgpr_read_b32 v29, a145
  v_accvgpr_read_b32 v30, a146
  v_accvgpr_read_b32 v31, a147
  v_cvt_pk_bf16_f32 v32, v24, v25
  v_cvt_pk_bf16_f32 v33, v26, v27
  v_cvt_pk_bf16_f32 v34, v28, v29
  v_cvt_pk_bf16_f32 v35, v30, v31
  s_add_u32 s17, s17, 4096
  buffer_store_dwordx4 v[32:35], v1, s[4:7], s17 offen offset:0 sc1
  s_add_u32 s17, s16, 20480
  v_accvgpr_read_b32 v36, a4
  v_accvgpr_read_b32 v37, a5
  v_accvgpr_read_b32 v38, a6
  v_accvgpr_read_b32 v39, a7
  v_accvgpr_read_b32 v40, a20
  v_accvgpr_read_b32 v41, a21
  v_accvgpr_read_b32 v42, a22
  v_accvgpr_read_b32 v43, a23
  v_cvt_pk_bf16_f32 v44, v36, v37
  v_cvt_pk_bf16_f32 v45, v38, v39
  v_cvt_pk_bf16_f32 v46, v40, v41
  v_cvt_pk_bf16_f32 v47, v42, v43
  buffer_store_dwordx4 v[44:47], v1, s[4:7], s17 offen offset:0 sc1
  v_accvgpr_read_b32 v48, a36
  v_accvgpr_read_b32 v49, a37
  v_accvgpr_read_b32 v50, a38
  v_accvgpr_read_b32 v51, a39
  v_accvgpr_read_b32 v52, a52
  v_accvgpr_read_b32 v53, a53
  v_accvgpr_read_b32 v54, a54
  v_accvgpr_read_b32 v55, a55
  v_cvt_pk_bf16_f32 v56, v48, v49
  v_cvt_pk_bf16_f32 v57, v50, v51
  v_cvt_pk_bf16_f32 v58, v52, v53
  v_cvt_pk_bf16_f32 v59, v54, v55
  buffer_store_dwordx4 v[56:59], v1, s[4:7], s17 offen offset:1024 sc1
  v_accvgpr_read_b32 v60, a68
  v_accvgpr_read_b32 v61, a69
  v_accvgpr_read_b32 v62, a70
  v_accvgpr_read_b32 v63, a71
  v_accvgpr_read_b32 v64, a84
  v_accvgpr_read_b32 v65, a85
  v_accvgpr_read_b32 v66, a86
  v_accvgpr_read_b32 v67, a87
  v_cvt_pk_bf16_f32 v68, v60, v61
  v_cvt_pk_bf16_f32 v69, v62, v63
  v_cvt_pk_bf16_f32 v70, v64, v65
  v_cvt_pk_bf16_f32 v71, v66, v67
  buffer_store_dwordx4 v[68:71], v1, s[4:7], s17 offen offset:2048 sc1
  v_accvgpr_read_b32 v24, a100
  v_accvgpr_read_b32 v25, a101
  v_accvgpr_read_b32 v26, a102
  v_accvgpr_read_b32 v27, a103
  v_accvgpr_read_b32 v28, a116
  v_accvgpr_read_b32 v29, a117
  v_accvgpr_read_b32 v30, a118
  v_accvgpr_read_b32 v31, a119
  v_cvt_pk_bf16_f32 v32, v24, v25
  v_cvt_pk_bf16_f32 v33, v26, v27
  v_cvt_pk_bf16_f32 v34, v28, v29
  v_cvt_pk_bf16_f32 v35, v30, v31
  buffer_store_dwordx4 v[32:35], v1, s[4:7], s17 offen offset:3072 sc1
  v_accvgpr_read_b32 v36, a132
  v_accvgpr_read_b32 v37, a133
  v_accvgpr_read_b32 v38, a134
  v_accvgpr_read_b32 v39, a135
  v_accvgpr_read_b32 v40, a148
  v_accvgpr_read_b32 v41, a149
  v_accvgpr_read_b32 v42, a150
  v_accvgpr_read_b32 v43, a151
  v_cvt_pk_bf16_f32 v44, v36, v37
  v_cvt_pk_bf16_f32 v45, v38, v39
  v_cvt_pk_bf16_f32 v46, v40, v41
  v_cvt_pk_bf16_f32 v47, v42, v43
  s_add_u32 s17, s17, 4096
  buffer_store_dwordx4 v[44:47], v1, s[4:7], s17 offen offset:0 sc1
  s_add_u32 s17, s16, 40960
  v_accvgpr_read_b32 v48, a8
  v_accvgpr_read_b32 v49, a9
  v_accvgpr_read_b32 v50, a10
  v_accvgpr_read_b32 v51, a11
  v_accvgpr_read_b32 v52, a24
  v_accvgpr_read_b32 v53, a25
  v_accvgpr_read_b32 v54, a26
  v_accvgpr_read_b32 v55, a27
  v_cvt_pk_bf16_f32 v56, v48, v49
  v_cvt_pk_bf16_f32 v57, v50, v51
  v_cvt_pk_bf16_f32 v58, v52, v53
  v_cvt_pk_bf16_f32 v59, v54, v55
  buffer_store_dwordx4 v[56:59], v1, s[4:7], s17 offen offset:0 sc1
  v_accvgpr_read_b32 v60, a40
  v_accvgpr_read_b32 v61, a41
  v_accvgpr_read_b32 v62, a42
  v_accvgpr_read_b32 v63, a43
  v_accvgpr_read_b32 v64, a56
  v_accvgpr_read_b32 v65, a57
  v_accvgpr_read_b32 v66, a58
  v_accvgpr_read_b32 v67, a59
  v_cvt_pk_bf16_f32 v68, v60, v61
  v_cvt_pk_bf16_f32 v69, v62, v63
  v_cvt_pk_bf16_f32 v70, v64, v65
  v_cvt_pk_bf16_f32 v71, v66, v67
  buffer_store_dwordx4 v[68:71], v1, s[4:7], s17 offen offset:1024 sc1
  v_accvgpr_read_b32 v24, a72
  v_accvgpr_read_b32 v25, a73
  v_accvgpr_read_b32 v26, a74
  v_accvgpr_read_b32 v27, a75
  v_accvgpr_read_b32 v28, a88
  v_accvgpr_read_b32 v29, a89
  v_accvgpr_read_b32 v30, a90
  v_accvgpr_read_b32 v31, a91
  v_cvt_pk_bf16_f32 v32, v24, v25
  v_cvt_pk_bf16_f32 v33, v26, v27
  v_cvt_pk_bf16_f32 v34, v28, v29
  v_cvt_pk_bf16_f32 v35, v30, v31
  buffer_store_dwordx4 v[32:35], v1, s[4:7], s17 offen offset:2048 sc1
  v_accvgpr_read_b32 v36, a104
  v_accvgpr_read_b32 v37, a105
  v_accvgpr_read_b32 v38, a106
  v_accvgpr_read_b32 v39, a107
  v_accvgpr_read_b32 v40, a120
  v_accvgpr_read_b32 v41, a121
  v_accvgpr_read_b32 v42, a122
  v_accvgpr_read_b32 v43, a123
  v_cvt_pk_bf16_f32 v44, v36, v37
  v_cvt_pk_bf16_f32 v45, v38, v39
  v_cvt_pk_bf16_f32 v46, v40, v41
  v_cvt_pk_bf16_f32 v47, v42, v43
  buffer_store_dwordx4 v[44:47], v1, s[4:7], s17 offen offset:3072 sc1
  v_accvgpr_read_b32 v48, a136
  v_accvgpr_read_b32 v49, a137
  v_accvgpr_read_b32 v50, a138
  v_accvgpr_read_b32 v51, a139
  v_accvgpr_read_b32 v52, a152
  v_accvgpr_read_b32 v53, a153
  v_accvgpr_read_b32 v54, a154
  v_accvgpr_read_b32 v55, a155
  v_cvt_pk_bf16_f32 v56, v48, v49
  v_cvt_pk_bf16_f32 v57, v50, v51
  v_cvt_pk_bf16_f32 v58, v52, v53
  v_cvt_pk_bf16_f32 v59, v54, v55
  s_add_u32 s17, s17, 4096
  buffer_store_dwordx4 v[56:59], v1, s[4:7], s17 offen offset:0 sc1
  s_add_u32 s17, s16, 61440
  v_accvgpr_read_b32 v60, a12
  v_accvgpr_read_b32 v61, a13
  v_accvgpr_read_b32 v62, a14
  v_accvgpr_read_b32 v63, a15
  v_accvgpr_read_b32 v64, a28
  v_accvgpr_read_b32 v65, a29
  v_accvgpr_read_b32 v66, a30
  v_accvgpr_read_b32 v67, a31
  v_cvt_pk_bf16_f32 v68, v60, v61
  v_cvt_pk_bf16_f32 v69, v62, v63
  v_cvt_pk_bf16_f32 v70, v64, v65
  v_cvt_pk_bf16_f32 v71, v66, v67
  buffer_store_dwordx4 v[68:71], v1, s[4:7], s17 offen offset:0 sc1
  v_accvgpr_read_b32 v24, a44
  v_accvgpr_read_b32 v25, a45
  v_accvgpr_read_b32 v26, a46
  v_accvgpr_read_b32 v27, a47
  v_accvgpr_read_b32 v28, a60
  v_accvgpr_read_b32 v29, a61
  v_accvgpr_read_b32 v30, a62
  v_accvgpr_read_b32 v31, a63
  v_cvt_pk_bf16_f32 v32, v24, v25
  v_cvt_pk_bf16_f32 v33, v26, v27
  v_cvt_pk_bf16_f32 v34, v28, v29
  v_cvt_pk_bf16_f32 v35, v30, v31
  buffer_store_dwordx4 v[32:35], v1, s[4:7], s17 offen offset:1024 sc1
  v_accvgpr_read_b32 v36, a76
  v_accvgpr_read_b32 v37, a77
  v_accvgpr_read_b32 v38, a78
  v_accvgpr_read_b32 v39, a79
  v_accvgpr_read_b32 v40, a92
  v_accvgpr_read_b32 v41, a93
  v_accvgpr_read_b32 v42, a94
  v_accvgpr_read_b32 v43, a95
  v_cvt_pk_bf16_f32 v44, v36, v37
  v_cvt_pk_bf16_f32 v45, v38, v39
  v_cvt_pk_bf16_f32 v46, v40, v41
  v_cvt_pk_bf16_f32 v47, v42, v43
  buffer_store_dwordx4 v[44:47], v1, s[4:7], s17 offen offset:2048 sc1
  v_accvgpr_read_b32 v48, a108
  v_accvgpr_read_b32 v49, a109
  v_accvgpr_read_b32 v50, a110
  v_accvgpr_read_b32 v51, a111
  v_accvgpr_read_b32 v52, a124
  v_accvgpr_read_b32 v53, a125
  v_accvgpr_read_b32 v54, a126
  v_accvgpr_read_b32 v55, a127
  v_cvt_pk_bf16_f32 v56, v48, v49
  v_cvt_pk_bf16_f32 v57, v50, v51
  v_cvt_pk_bf16_f32 v58, v52, v53
  v_cvt_pk_bf16_f32 v59, v54, v55
  buffer_store_dwordx4 v[56:59], v1, s[4:7], s17 offen offset:3072 sc1
  v_accvgpr_read_b32 v60, a140
  v_accvgpr_read_b32 v61, a141
  v_accvgpr_read_b32 v62, a142
  v_accvgpr_read_b32 v63, a143
  v_accvgpr_read_b32 v64, a156
  v_accvgpr_read_b32 v65, a157
  v_accvgpr_read_b32 v66, a158
  v_accvgpr_read_b32 v67, a159
  v_cvt_pk_bf16_f32 v68, v60, v61
  v_cvt_pk_bf16_f32 v69, v62, v63
  v_cvt_pk_bf16_f32 v70, v64, v65
  v_cvt_pk_bf16_f32 v71, v66, v67
  s_add_u32 s17, s17, 4096
  buffer_store_dwordx4 v[68:71], v1, s[4:7], s17 offen offset:0 sc1
fin_exit1:
  s_endpgm
.globl redln1_kernel
.p2align 8
.type redln1_kernel,@function
redln1_kernel:
  s_cmp_ge_u32 s2, 128
  s_cbranch_scc1 redln1_exit1
  s_load_dwordx2 s[12:13], s[0:1], 96
  s_load_dwordx2 s[14:15], s[0:1], 0
  v_lshrrev_b32 v2, 6, v0
  s_nop 0
  v_readfirstlane_b32 s16, v2
  s_waitcnt lgkmcnt(0)
  s_mov_b32 s4, s12
  s_mov_b32 s5, s13
  s_mov_b32 s6, 0x10000000
  s_mov_b32 s7, 0x20000
  s_mov_b32 s8, s14
  s_mov_b32 s9, s15
  s_mov_b32 s10, 2621440
  s_mov_b32 s11, 0x20000
  s_mov_b32 s20, 0
  s_mov_b32 s19, s2
  v_and_b32 v3, 63, v0
  v_lshlrev_b32 v14, 4, v3
  v_and_b32 v2, 15, v3
  v_lshrrev_b32 v4, 4, v3
  s_lshl_b32 s17, s19, 4
  v_add_u32 v15, s17, v2
  v_mul_u32_u24 v15, 1280, v15
  v_lshl_add_u32 v15, v4, 4, v15
  s_mul_i32 s17, s16, 320
  s_add_u32 s20, s20, s17
  s_add_u32 s21, s17, 82313216
  s_mul_i32 s22, s19, 20
  s_mul_i32 s23, s16, 5
  s_add_u32 s22, s22, s23
  s_lshl_b32 s22, s22, 10
  s_add_u32 s22, s22, 92798976
  s_add_u32 s24, s22, 0
  s_add_u32 s25, s22, 2621440
  s_add_u32 s26, s22, 5242880
  s_add_u32 s27, s22, 7864320
  s_add_u32 s28, s22, 10485760
  s_add_u32 s29, s22, 13107200
  s_add_u32 s30, s22, 15728640
  s_add_u32 s31, s22, 18350080
  v_add_u32 v6, 0x1000, v14
  buffer_load_dwordx4 v[16:19], v15, s[8:11], s20 offen offset:0
  buffer_load_dwordx4 v[20:23], v15, s[8:11], s20 offen offset:64
  buffer_load_dwordx4 v[24:27], v15, s[8:11], s20 offen offset:128
  buffer_load_dwordx4 v[28:31], v15, s[8:11], s20 offen offset:192
  buffer_load_dwordx4 v[32:35], v15, s[8:11], s20 offen offset:256
  buffer_load_dwordx4 v[80:83], v14, s[4:7], s24 offen offset:0
  buffer_load_dwordx4 v[84:87], v14, s[4:7], s25 offen offset:0
  buffer_load_dwordx4 v[88:91], v14, s[4:7], s26 offen offset:0
  buffer_load_dwordx4 v[92:95], v14, s[4:7], s27 offen offset:0
  buffer_load_dwordx4 v[96:99], v14, s[4:7], s28 offen offset:0
  buffer_load_dwordx4 v[100:103], v14, s[4:7], s29 offen offset:0
  buffer_load_dwordx4 v[104:107], v14, s[4:7], s30 offen offset:0
  buffer_load_dwordx4 v[108:111], v14, s[4:7], s31 offen offset:0
  buffer_load_dwordx4 v[112:115], v14, s[4:7], s24 offen offset:1024
  buffer_load_dwordx4 v[116:119], v14, s[4:7], s25 offen offset:1024
  buffer_load_dwordx4 v[120:123], v14, s[4:7], s26 offen offset:1024
  buffer_load_dwordx4 v[124:127], v14, s[4:7], s27 offen offset:1024
  buffer_load_dwordx4 v[128:131], v14, s[4:7], s28 offen offset:1024
  buffer_load_dwordx4 v[132:135], v14, s[4:7], s29 offen offset:1024
  buffer_load_dwordx4 v[136:139], v14, s[4:7], s30 offen offset:1024
  buffer_load_dwordx4 v[140:143], v14, s[4:7], s31 offen offset:1024
  buffer_load_dwordx4 v[144:147], v14, s[4:7], s24 offen offset:2048
  buffer_load_dwordx4 v[148:151], v14, s[4:7], s25 offen offset:2048
  buffer_load_dwordx4 v[152:155], v14, s[4:7], s26 offen offset:2048
  buffer_load_dwordx4 v[156:159], v14, s[4:7], s27 offen offset:2048
  buffer_load_dwordx4 v[160:163], v14, s[4:7], s28 offen offset:2048
  buffer_load_dwordx4 v[164:167], v14, s[4:7], s29 offen offset:2048
  buffer_load_dwordx4 v[168:171], v14, s[4:7], s30 offen offset:2048
  buffer_load_dwordx4 v[172:175], v14, s[4:7], s31 offen offset:2048
  buffer_load_dwordx4 v[176:179], v14, s[4:7], s24 offen offset:3072
  buffer_load_dwordx4 v[180:183], v14, s[4:7], s25 offen offset:3072
  buffer_load_dwordx4 v[184:187], v14, s[4:7], s26 offen offset:3072
  buffer_load_dwordx4 v[188:191], v14, s[4:7], s27 offen offset:3072
  buffer_load_dwordx4 v[192:195], v14, s[4:7], s28 offen offset:3072
  buffer_load_dwordx4 v[196:199], v14, s[4:7], s29 offen offset:3072
  buffer_load_dwordx4 v[200:203], v14, s[4:7], s30 offen offset:3072
  buffer_load_dwordx4 v[204:207], v14, s[4:7], s31 offen offset:3072
  buffer_load_dwordx4 v[208:211], v6, s[4:7], s24 offen offset:0
  buffer_load_dwordx4 v[212:215], v6, s[4:7], s25 offen offset:0
  buffer_load_dwordx4 v[216:219], v6, s[4:7], s26 offen offset:0
  buffer_load_dwordx4 v[220:223], v6, s[4:7], s27 offen offset:0
  buffer_load_dwordx4 v[224:227], v6, s[4:7], s28 offen offset:0
  buffer_load_dwordx4 v[228:231], v6, s[4:7], s29 offen offset:0
  buffer_load_dwordx4 v[232:235], v6, s[4:7], s30 offen offset:0
  buffer_load_dwordx4 v[236:239], v6, s[4:7], s31 offen offset:0
  s_waitcnt vmcnt(32)
  v_lshlrev_b32 v36, 16, v80
  v_and_b32 v37, 0xffff0000, v80
  v_lshlrev_b32 v38, 16, v81
  v_and_b32 v39, 0xffff0000, v81
  v_lshlrev_b32 v40, 16, v82
  v_and_b32 v41, 0xffff0000, v82
  v_lshlrev_b32 v42, 16, v83
  v_and_b32 v43, 0xffff0000, v83
  v_lshlrev_b32 v8, 16, v84
  v_and_b32 v9, 0xffff0000, v84
  v_pk_add_f32 v[36:37], v[36:37], v[8:9]
  v_lshlrev_b32 v8, 16, v85
  v_and_b32 v9, 0xffff0000, v85
  v_pk_add_f32 v[38:39], v[38:39], v[8:9]
  v_lshlrev_b32 v8, 16, v86
  v_and_b32 v9, 0xffff0000, v86
  v_pk_add_f32 v[40:41], v[40:41], v[8:9]
  v_lshlrev_b32 v8, 16, v87
  v_and_b32 v9, 0xffff0000, v87
  v_pk_add_f32 v[42:43], v[42:43], v[8:9]
  v_lshlrev_b32 v8, 16, v88
  v_and_b32 v9, 0xffff0000, v88
  v_pk_add_f32 v[36:37], v[36:37], v[8:9]
  v_lshlrev_b32 v8, 16, v89
  v_and_b32 v9, 0xffff0000, v89
  v_pk_add_f32 v[38:39], v[38:39], v[8:9]
  v_lshlrev_b32 v8, 16, v90
  v_and_b32 v9, 0xffff0000, v90
  v_pk_add_f32 v[40:41], v[40:41], v[8:9]
  v_lshlrev_b32 v8, 16, v91
  v_and_b32 v9, 0xffff0000, v91
  v_pk_add_f32 v[42:43], v[42:43], v[8:9]
  v_lshlrev_b32 v8, 16, v92
  v_and_b32 v9, 0xffff0000, v92
  v_pk_add_f32 v[36:37], v[36:37], v[8:9]
  v_lshlrev_b32 v8, 16, v93
  v_and_b32 v9, 0xffff0000, v93
  v_pk_add_f32 v[38:39], v[38:39], v[8:9]
  v_lshlrev_b32 v8, 16, v94
  v_and_b32 v9, 0xffff0000, v94
  v_pk_add_f32 v[40:41], v[40:41], v[8:9]
  v_lshlrev_b32 v8, 16, v95
  v_and_b32 v9, 0xffff0000, v95
  v_pk_add_f32 v[42:43], v[42:43], v[8:9]
  v_lshlrev_b32 v8, 16, v96
  v_and_b32 v9, 0xffff0000, v96
  v_pk_add_f32 v[36:37], v[36:37], v[8:9]
  v_lshlrev_b32 v8, 16, v97
  v_and_b32 v9, 0xffff0000, v97
  v_pk_add_f32 v[38:39], v[38:39], v[8:9]
  v_lshlrev_b32 v8, 16, v98
  v_and_b32 v9, 0xffff0000, v98
  v_pk_add_f32 v[40:41], v[40:41], v[8:9]
  v_lshlrev_b32 v8, 16, v99
  v_and_b32 v9, 0xffff0000, v99
  v_pk_add_f32 v[42:43], v[42:43], v[8:9]
  v_lshlrev_b32 v8, 16, v100
  v_and_b32 v9, 0xffff0000, v100
  v_pk_add_f32 v[36:37], v[36:37], v[8:9]
  v_lshlrev_b32 v8, 16, v101
  v_and_b32 v9, 0xffff0000, v101
  v_pk_add_f32 v[38:39], v[38:39], v[8:9]
  v_lshlrev_b32 v8, 16, v102
  v_and_b32 v9, 0xffff0000, v102
  v_pk_add_f32 v[40:41], v[40:41], v[8:9]
  v_lshlrev_b32 v8, 16, v103
  v_and_b32 v9, 0xffff0000, v103
  v_pk_add_f32 v[42:43], v[42:43], v[8:9]
  v_lshlrev_b32 v8, 16, v104
  v_and_b32 v9, 0xffff0000, v104
  v_pk_add_f32 v[36:37], v[36:37], v[8:9]
  v_lshlrev_b32 v8, 16, v105
  v_and_b32 v9, 0xffff0000, v105
  v_pk_add_f32 v[38:39], v[38:39], v[8:9]
  v_lshlrev_b32 v8, 16, v106
  v_and_b32 v9, 0xffff0000, v106
  v_pk_add_f32 v[40:41], v[40:41], v[8:9]
  v_lshlrev_b32 v8, 16, v107
  v_and_b32 v9, 0xffff0000, v107
  v_pk_add_f32 v[42:43], v[42:43], v[8:9]
  v_lshlrev_b32 v8, 16, v108
  v_and_b32 v9, 0xffff0000, v108
  v_pk_add_f32 v[36:37], v[36:37], v[8:9]
  v_lshlrev_b32 v8, 16, v109
  v_and_b32 v9, 0xffff0000, v109
  v_pk_add_f32 v[38:39], v[38:39], v[8:9]
  v_lshlrev_b32 v8, 16, v110
  v_and_b32 v9, 0xffff0000, v110
  v_pk_add_f32 v[40:41], v[40:41], v[8:9]
  v_lshlrev_b32 v8, 16, v111
  v_and_b32 v9, 0xffff0000, v111
  v_pk_add_f32 v[42:43], v[42:43], v[8:9]
  v_cvt_pk_bf16_f32 v8, v36, v37
  v_lshlrev_b32 v36, 16, v8
  v_and_b32 v37, 0xffff0000, v8
  v_lshlrev_b32 v10, 16, v16
  v_and_b32 v11, 0xffff0000, v16
  v_pk_add_f32 v[36:37], v[36:37], v[10:11]
  v_cvt_pk_bf16_f32 v16, v36, v37
  v_lshlrev_b32 v36, 16, v16
  v_and_b32 v37, 0xffff0000, v16
  v_cvt_pk_bf16_f32 v8, v38, v39
  v_lshlrev_b32 v38, 16, v8
  v_and_b32 v39, 0xffff0000, v8
  v_lshlrev_b32 v10, 16, v17
  v_and_b32 v11, 0xffff0000, v17
  v_pk_add_f32 v[38:39], v[38:39], v[10:11]
  v_cvt_pk_bf16_f32 v17, v38, v39
  v_lshlrev_b32 v38, 16, v17
  v_and_b32 v39, 0xffff0000, v17
  v_cvt_pk_bf16_f32 v8, v40, v41
  v_lshlrev_b32 v40, 16, v8
  v_and_b32 v41, 0xffff0000, v8
  v_lshlrev_b32 v10, 16, v18
  v_and_b32 v11, 0xffff0000, v18
  v_pk_add_f32 v[40:41], v[40:41], v[10:11]
  v_cvt_pk_bf16_f32 v18, v40, v41
  v_lshlrev_b32 v40, 16, v18
  v_and_b32 v41, 0xffff0000, v18
  v_cvt_pk_bf16_f32 v8, v42, v43
  v_lshlrev_b32 v42, 16, v8
  v_and_b32 v43, 0xffff0000, v8
  v_lshlrev_b32 v10, 16, v19
  v_and_b32 v11, 0xffff0000, v19
  v_pk_add_f32 v[42:43], v[42:43], v[10:11]
  v_cvt_pk_bf16_f32 v19, v42, v43
  v_lshlrev_b32 v42, 16, v19
  v_and_b32 v43, 0xffff0000, v19
  buffer_store_dwordx4 v[16:19], v15, s[4:7], s21 offen offset:0 sc1
  s_waitcnt vmcnt(25)
  v_lshlrev_b32 v44, 16, v112
  v_and_b32 v45, 0xffff0000, v112
  v_lshlrev_b32 v46, 16, v113
  v_and_b32 v47, 0xffff0000, v113
  v_lshlrev_b32 v48, 16, v114
  v_and_b32 v49, 0xffff0000, v114
  v_lshlrev_b32 v50, 16, v115
  v_and_b32 v51, 0xffff0000, v115
  v_lshlrev_b32 v8, 16, v116
  v_and_b32 v9, 0xffff0000, v116
  v_pk_add_f32 v[44:45], v[44:45], v[8:9]
  v_lshlrev_b32 v8, 16, v117
  v_and_b32 v9, 0xffff0000, v117
  v_pk_add_f32 v[46:47], v[46:47], v[8:9]
  v_lshlrev_b32 v8, 16, v118
  v_and_b32 v9, 0xffff0000, v118
  v_pk_add_f32 v[48:49], v[48:49], v[8:9]
  v_lshlrev_b32 v8, 16, v119
  v_and_b32 v9, 0xffff0000, v119
  v_pk_add_f32 v[50:51], v[50:51], v[8:9]
  v_lshlrev_b32 v8, 16, v120
  v_and_b32 v9, 0xffff0000, v120
  v_pk_add_f32 v[44:45], v[44:45], v[8:9]
  v_lshlrev_b32 v8, 16, v121
  v_and_b32 v9, 0xffff0000, v121
  v_pk_add_f32 v[46:47], v[46:47], v[8:9]
  v_lshlrev_b32 v8, 16, v122
  v_and_b32 v9, 0xffff0000, v122
  v_pk_add_f32 v[48:49], v[48:49], v[8:9]
  v_lshlrev_b32 v8, 16, v123
  v_and_b32 v9, 0xffff0000, v123
  v_pk_add_f32 v[50:51], v[50:51], v[8:9]
  v_lshlrev_b32 v8, 16, v124
  v_and_b32 v9, 0xffff0000, v124
  v_pk_add_f32 v[44:45], v[44:45], v[8:9]
  v_lshlrev_b32 v8, 16, v125
  v_and_b32 v9, 0xffff0000, v125
  v_pk_add_f32 v[46:47], v[46:47], v[8:9]
  v_lshlrev_b32 v8, 16, v126
  v_and_b32 v9, 0xffff0000, v126
  v_pk_add_f32 v[48:49], v[48:49], v[8:9]
  v_lshlrev_b32 v8, 16, v127
  v_and_b32 v9, 0xffff0000, v127
  v_pk_add_f32 v[50:51], v[50:51], v[8:9]
  v_lshlrev_b32 v8, 16, v128
  v_and_b32 v9, 0xffff0000, v128
  v_pk_add_f32 v[44:45], v[44:45], v[8:9]
  v_lshlrev_b32 v8, 16, v129
  v_and_b32 v9, 0xffff0000, v129
  v_pk_add_f32 v[46:47], v[46:47], v[8:9]
  v_lshlrev_b32 v8, 16, v130
  v_and_b32 v9, 0xffff0000, v130
  v_pk_add_f32 v[48:49], v[48:49], v[8:9]
  v_lshlrev_b32 v8, 16, v131
  v_and_b32 v9, 0xffff0000, v131
  v_pk_add_f32 v[50:51], v[50:51], v[8:9]
  v_lshlrev_b32 v8, 16, v132
  v_and_b32 v9, 0xffff0000, v132
  v_pk_add_f32 v[44:45], v[44:45], v[8:9]
  v_lshlrev_b32 v8, 16, v133
  v_and_b32 v9, 0xffff0000, v133
  v_pk_add_f32 v[46:47], v[46:47], v[8:9]
  v_lshlrev_b32 v8, 16, v134
  v_and_b32 v9, 0xffff0000, v134
  v_pk_add_f32 v[48:49], v[48:49], v[8:9]
  v_lshlrev_b32 v8, 16, v135
  v_and_b32 v9, 0xffff0000, v135
  v_pk_add_f32 v[50:51], v[50:51], v[8:9]
  v_lshlrev_b32 v8, 16, v136
  v_and_b32 v9, 0xffff0000, v136
  v_pk_add_f32 v[44:45], v[44:45], v[8:9]
  v_lshlrev_b32 v8, 16, v137
  v_and_b32 v9, 0xffff0000, v137
  v_pk_add_f32 v[46:47], v[46:47], v[8:9]
  v_lshlrev_b32 v8, 16, v138
  v_and_b32 v9, 0xffff0000, v138
  v_pk_add_f32 v[48:49], v[48:49], v[8:9]
  v_lshlrev_b32 v8, 16, v139
  v_and_b32 v9, 0xffff0000, v139
  v_pk_add_f32 v[50:51], v[50:51], v[8:9]
  v_lshlrev_b32 v8, 16, v140
  v_and_b32 v9, 0xffff0000, v140
  v_pk_add_f32 v[44:45], v[44:45], v[8:9]
  v_lshlrev_b32 v8, 16, v141
  v_and_b32 v9, 0xffff0000, v141
  v_pk_add_f32 v[46:47], v[46:47], v[8:9]
  v_lshlrev_b32 v8, 16, v142
  v_and_b32 v9, 0xffff0000, v142
  v_pk_add_f32 v[48:49], v[48:49], v[8:9]
  v_lshlrev_b32 v8, 16, v143
  v_and_b32 v9, 0xffff0000, v143
  v_pk_add_f32 v[50:51], v[50:51], v[8:9]
  v_cvt_pk_bf16_f32 v8, v44, v45
  v_lshlrev_b32 v44, 16, v8
  v_and_b32 v45, 0xffff0000, v8
  v_lshlrev_b32 v10, 16, v20
  v_and_b32 v11, 0xffff0000, v20
  v_pk_add_f32 v[44:45], v[44:45], v[10:11]
  v_cvt_pk_bf16_f32 v20, v44, v45
  v_lshlrev_b32 v44, 16, v20
  v_and_b32 v45, 0xffff0000, v20
  v_cvt_pk_bf16_f32 v8, v46, v47
  v_lshlrev_b32 v46, 16, v8
  v_and_b32 v47, 0xffff0000, v8
  v_lshlrev_b32 v10, 16, v21
  v_and_b32 v11, 0xffff0000, v21
  v_pk_add_f32 v[46:47], v[46:47], v[10:11]
  v_cvt_pk_bf16_f32 v21, v46, v47
  v_lshlrev_b32 v46, 16, v21
  v_and_b32 v47, 0xffff0000, v21
  v_cvt_pk_bf16_f32 v8, v48, v49
  v_lshlrev_b32 v48, 16, v8
  v_and_b32 v49, 0xffff0000, v8
  v_lshlrev_b32 v10, 16, v22
  v_and_b32 v11, 0xffff0000, v22
  v_pk_add_f32 v[48:49], v[48:49], v[10:11]
  v_cvt_pk_bf16_f32 v22, v48, v49
  v_lshlrev_b32 v48, 16, v22
  v_and_b32 v49, 0xffff0000, v22
  v_cvt_pk_bf16_f32 v8, v50, v51
  v_lshlrev_b32 v50, 16, v8
  v_and_b32 v51, 0xffff0000, v8
  v_lshlrev_b32 v10, 16, v23
  v_and_b32 v11, 0xffff0000, v23
  v_pk_add_f32 v[50:51], v[50:51], v[10:11]
  v_cvt_pk_bf16_f32 v23, v50, v51
  v_lshlrev_b32 v50, 16, v23
  v_and_b32 v51, 0xffff0000, v23
  buffer_store_dwordx4 v[20:23], v15, s[4:7], s21 offen offset:64 sc1
  s_waitcnt vmcnt(18)
  v_lshlrev_b32 v52, 16, v144
  v_and_b32 v53, 0xffff0000, v144
  v_lshlrev_b32 v54, 16, v145
  v_and_b32 v55, 0xffff0000, v145
  v_lshlrev_b32 v56, 16, v146
  v_and_b32 v57, 0xffff0000, v146
  v_lshlrev_b32 v58, 16, v147
  v_and_b32 v59, 0xffff0000, v147
  v_lshlrev_b32 v8, 16, v148
  v_and_b32 v9, 0xffff0000, v148
  v_pk_add_f32 v[52:53], v[52:53], v[8:9]
  v_lshlrev_b32 v8, 16, v149
  v_and_b32 v9, 0xffff0000, v149
  v_pk_add_f32 v[54:55], v[54:55], v[8:9]
  v_lshlrev_b32 v8, 16, v150
  v_and_b32 v9, 0xffff0000, v150
  v_pk_add_f32 v[56:57], v[56:57], v[8:9]
  v_lshlrev_b32 v8, 16, v151
  v_and_b32 v9, 0xffff0000, v151
  v_pk_add_f32 v[58:59], v[58:59], v[8:9]
  v_lshlrev_b32 v8, 16, v152
  v_and_b32 v9, 0xffff0000, v152
  v_pk_add_f32 v[52:53], v[52:53], v[8:9]
  v_lshlrev_b32 v8, 16, v153
  v_and_b32 v9, 0xffff0000, v153
  v_pk_add_f32 v[54:55], v[54:55], v[8:9]
  v_lshlrev_b32 v8, 16, v154
  v_and_b32 v9, 0xffff0000, v154
  v_pk_add_f32 v[56:57], v[56:57], v[8:9]
  v_lshlrev_b32 v8, 16, v155
  v_and_b32 v9, 0xffff0000, v155
  v_pk_add_f32 v[58:59], v[58:59], v[8:9]
  v_lshlrev_b32 v8, 16, v156
  v_and_b32 v9, 0xffff0000, v156
  v_pk_add_f32 v[52:53], v[52:53], v[8:9]
  v_lshlrev_b32 v8, 16, v157
  v_and_b32 v9, 0xffff0000, v157
  v_pk_add_f32 v[54:55], v[54:55], v[8:9]
  v_lshlrev_b32 v8, 16, v158
  v_and_b32 v9, 0xffff0000, v158
  v_pk_add_f32 v[56:57], v[56:57], v[8:9]
  v_lshlrev_b32 v8, 16, v159
  v_and_b32 v9, 0xffff0000, v159
  v_pk_add_f32 v[58:59], v[58:59], v[8:9]
  v_lshlrev_b32 v8, 16, v160
  v_and_b32 v9, 0xffff0000, v160
  v_pk_add_f32 v[52:53], v[52:53], v[8:9]
  v_lshlrev_b32 v8, 16, v161
  v_and_b32 v9, 0xffff0000, v161
  v_pk_add_f32 v[54:55], v[54:55], v[8:9]
  v_lshlrev_b32 v8, 16, v162
  v_and_b32 v9, 0xffff0000, v162
  v_pk_add_f32 v[56:57], v[56:57], v[8:9]
  v_lshlrev_b32 v8, 16, v163
  v_and_b32 v9, 0xffff0000, v163
  v_pk_add_f32 v[58:59], v[58:59], v[8:9]
  v_lshlrev_b32 v8, 16, v164
  v_and_b32 v9, 0xffff0000, v164
  v_pk_add_f32 v[52:53], v[52:53], v[8:9]
  v_lshlrev_b32 v8, 16, v165
  v_and_b32 v9, 0xffff0000, v165
  v_pk_add_f32 v[54:55], v[54:55], v[8:9]
  v_lshlrev_b32 v8, 16, v166
  v_and_b32 v9, 0xffff0000, v166
  v_pk_add_f32 v[56:57], v[56:57], v[8:9]
  v_lshlrev_b32 v8, 16, v167
  v_and_b32 v9, 0xffff0000, v167
  v_pk_add_f32 v[58:59], v[58:59], v[8:9]
  v_lshlrev_b32 v8, 16, v168
  v_and_b32 v9, 0xffff0000, v168
  v_pk_add_f32 v[52:53], v[52:53], v[8:9]
  v_lshlrev_b32 v8, 16, v169
  v_and_b32 v9, 0xffff0000, v169
  v_pk_add_f32 v[54:55], v[54:55], v[8:9]
  v_lshlrev_b32 v8, 16, v170
  v_and_b32 v9, 0xffff0000, v170
  v_pk_add_f32 v[56:57], v[56:57], v[8:9]
  v_lshlrev_b32 v8, 16, v171
  v_and_b32 v9, 0xffff0000, v171
  v_pk_add_f32 v[58:59], v[58:59], v[8:9]
  v_lshlrev_b32 v8, 16, v172
  v_and_b32 v9, 0xffff0000, v172
  v_pk_add_f32 v[52:53], v[52:53], v[8:9]
  v_lshlrev_b32 v8, 16, v173
  v_and_b32 v9, 0xffff0000, v173
  v_pk_add_f32 v[54:55], v[54:55], v[8:9]
  v_lshlrev_b32 v8, 16, v174
  v_and_b32 v9, 0xffff0000, v174
  v_pk_add_f32 v[56:57], v[56:57], v[8:9]
  v_lshlrev_b32 v8, 16, v175
  v_and_b32 v9, 0xffff0000, v175
  v_pk_add_f32 v[58:59], v[58:59], v[8:9]
  v_cvt_pk_bf16_f32 v8, v52, v53
  v_lshlrev_b32 v52, 16, v8
  v_and_b32 v53, 0xffff0000, v8
  v_lshlrev_b32 v10, 16, v24
  v_and_b32 v11, 0xffff0000, v24
  v_pk_add_f32 v[52:53], v[52:53], v[10:11]
  v_cvt_pk_bf16_f32 v24, v52, v53
  v_lshlrev_b32 v52, 16, v24
  v_and_b32 v53, 0xffff0000, v24
  v_cvt_pk_bf16_f32 v8, v54, v55
  v_lshlrev_b32 v54, 16, v8
  v_and_b32 v55, 0xffff0000, v8
  v_lshlrev_b32 v10, 16, v25
  v_and_b32 v11, 0xffff0000, v25
  v_pk_add_f32 v[54:55], v[54:55], v[10:11]
  v_cvt_pk_bf16_f32 v25, v54, v55
  v_lshlrev_b32 v54, 16, v25
  v_and_b32 v55, 0xffff0000, v25
  v_cvt_pk_bf16_f32 v8, v56, v57
  v_lshlrev_b32 v56, 16, v8
  v_and_b32 v57, 0xffff0000, v8
  v_lshlrev_b32 v10, 16, v26
  v_and_b32 v11, 0xffff0000, v26
  v_pk_add_f32 v[56:57], v[56:57], v[10:11]
  v_cvt_pk_bf16_f32 v26, v56, v57
  v_lshlrev_b32 v56, 16, v26
  v_and_b32 v57, 0xffff0000, v26
  v_cvt_pk_bf16_f32 v8, v58, v59
  v_lshlrev_b32 v58, 16, v8
  v_and_b32 v59, 0xffff0000, v8
  v_lshlrev_b32 v10, 16, v27
  v_and_b32 v11, 0xffff0000, v27
  v_pk_add_f32 v[58:59], v[58:59], v[10:11]
  v_cvt_pk_bf16_f32 v27, v58, v59
  v_lshlrev_b32 v58, 16, v27
  v_and_b32 v59, 0xffff0000, v27
  buffer_store_dwordx4 v[24:27], v15, s[4:7], s21 offen offset:128 sc1
  s_waitcnt vmcnt(11)
  v_lshlrev_b32 v60, 16, v176
  v_and_b32 v61, 0xffff0000, v176
  v_lshlrev_b32 v62, 16, v177
  v_and_b32 v63, 0xffff0000, v177
  v_lshlrev_b32 v64, 16, v178
  v_and_b32 v65, 0xffff0000, v178
  v_lshlrev_b32 v66, 16, v179
  v_and_b32 v67, 0xffff0000, v179
  v_lshlrev_b32 v8, 16, v180
  v_and_b32 v9, 0xffff0000, v180
  v_pk_add_f32 v[60:61], v[60:61], v[8:9]
  v_lshlrev_b32 v8, 16, v181
  v_and_b32 v9, 0xffff0000, v181
  v_pk_add_f32 v[62:63], v[62:63], v[8:9]
  v_lshlrev_b32 v8, 16, v182
  v_and_b32 v9, 0xffff0000, v182
  v_pk_add_f32 v[64:65], v[64:65], v[8:9]
  v_lshlrev_b32 v8, 16, v183
  v_and_b32 v9, 0xffff0000, v183
  v_pk_add_f32 v[66:67], v[66:67], v[8:9]
  v_lshlrev_b32 v8, 16, v184
  v_and_b32 v9, 0xffff0000, v184
  v_pk_add_f32 v[60:61], v[60:61], v[8:9]
  v_lshlrev_b32 v8, 16, v185
  v_and_b32 v9, 0xffff0000, v185
  v_pk_add_f32 v[62:63], v[62:63], v[8:9]
  v_lshlrev_b32 v8, 16, v186
  v_and_b32 v9, 0xffff0000, v186
  v_pk_add_f32 v[64:65], v[64:65], v[8:9]
  v_lshlrev_b32 v8, 16, v187
  v_and_b32 v9, 0xffff0000, v187
  v_pk_add_f32 v[66:67], v[66:67], v[8:9]
  v_lshlrev_b32 v8, 16, v188
  v_and_b32 v9, 0xffff0000, v188
  v_pk_add_f32 v[60:61], v[60:61], v[8:9]
  v_lshlrev_b32 v8, 16, v189
  v_and_b32 v9, 0xffff0000, v189
  v_pk_add_f32 v[62:63], v[62:63], v[8:9]
  v_lshlrev_b32 v8, 16, v190
  v_and_b32 v9, 0xffff0000, v190
  v_pk_add_f32 v[64:65], v[64:65], v[8:9]
  v_lshlrev_b32 v8, 16, v191
  v_and_b32 v9, 0xffff0000, v191
  v_pk_add_f32 v[66:67], v[66:67], v[8:9]
  v_lshlrev_b32 v8, 16, v192
  v_and_b32 v9, 0xffff0000, v192
  v_pk_add_f32 v[60:61], v[60:61], v[8:9]
  v_lshlrev_b32 v8, 16, v193
  v_and_b32 v9, 0xffff0000, v193
  v_pk_add_f32 v[62:63], v[62:63], v[8:9]
  v_lshlrev_b32 v8, 16, v194
  v_and_b32 v9, 0xffff0000, v194
  v_pk_add_f32 v[64:65], v[64:65], v[8:9]
  v_lshlrev_b32 v8, 16, v195
  v_and_b32 v9, 0xffff0000, v195
  v_pk_add_f32 v[66:67], v[66:67], v[8:9]
  v_lshlrev_b32 v8, 16, v196
  v_and_b32 v9, 0xffff0000, v196
  v_pk_add_f32 v[60:61], v[60:61], v[8:9]
  v_lshlrev_b32 v8, 16, v197
  v_and_b32 v9, 0xffff0000, v197
  v_pk_add_f32 v[62:63], v[62:63], v[8:9]
  v_lshlrev_b32 v8, 16, v198
  v_and_b32 v9, 0xffff0000, v198
  v_pk_add_f32 v[64:65], v[64:65], v[8:9]
  v_lshlrev_b32 v8, 16, v199
  v_and_b32 v9, 0xffff0000, v199
  v_pk_add_f32 v[66:67], v[66:67], v[8:9]
  v_lshlrev_b32 v8, 16, v200
  v_and_b32 v9, 0xffff0000, v200
  v_pk_add_f32 v[60:61], v[60:61], v[8:9]
  v_lshlrev_b32 v8, 16, v201
  v_and_b32 v9, 0xffff0000, v201
  v_pk_add_f32 v[62:63], v[62:63], v[8:9]
  v_lshlrev_b32 v8, 16, v202
  v_and_b32 v9, 0xffff0000, v202
  v_pk_add_f32 v[64:65], v[64:65], v[8:9]
  v_lshlrev_b32 v8, 16, v203
  v_and_b32 v9, 0xffff0000, v203
  v_pk_add_f32 v[66:67], v[66:67], v[8:9]
  v_lshlrev_b32 v8, 16, v204
  v_and_b32 v9, 0xffff0000, v204
  v_pk_add_f32 v[60:61], v[60:61], v[8:9]
  v_lshlrev_b32 v8, 16, v205
  v_and_b32 v9, 0xffff0000, v205
  v_pk_add_f32 v[62:63], v[62:63], v[8:9]
  v_lshlrev_b32 v8, 16, v206
  v_and_b32 v9, 0xffff0000, v206
  v_pk_add_f32 v[64:65], v[64:65], v[8:9]
  v_lshlrev_b32 v8, 16, v207
  v_and_b32 v9, 0xffff0000, v207
  v_pk_add_f32 v[66:67], v[66:67], v[8:9]
  v_cvt_pk_bf16_f32 v8, v60, v61
  v_lshlrev_b32 v60, 16, v8
  v_and_b32 v61, 0xffff0000, v8
  v_lshlrev_b32 v10, 16, v28
  v_and_b32 v11, 0xffff0000, v28
  v_pk_add_f32 v[60:61], v[60:61], v[10:11]
  v_cvt_pk_bf16_f32 v28, v60, v61
  v_lshlrev_b32 v60, 16, v28
  v_and_b32 v61, 0xffff0000, v28
  v_cvt_pk_bf16_f32 v8, v62, v63
  v_lshlrev_b32 v62, 16, v8
  v_and_b32 v63, 0xffff0000, v8
  v_lshlrev_b32 v10, 16, v29
  v_and_b32 v11, 0xffff0000, v29
  v_pk_add_f32 v[62:63], v[62:63], v[10:11]
  v_cvt_pk_bf16_f32 v29, v62, v63
  v_lshlrev_b32 v62, 16, v29
  v_and_b32 v63, 0xffff0000, v29
  v_cvt_pk_bf16_f32 v8, v64, v65
  v_lshlrev_b32 v64, 16, v8
  v_and_b32 v65, 0xffff0000, v8
  v_lshlrev_b32 v10, 16, v30
  v_and_b32 v11, 0xffff0000, v30
  v_pk_add_f32 v[64:65], v[64:65], v[10:11]
  v_cvt_pk_bf16_f32 v30, v64, v65
  v_lshlrev_b32 v64, 16, v30
  v_and_b32 v65, 0xffff0000, v30
  v_cvt_pk_bf16_f32 v8, v66, v67
  v_lshlrev_b32 v66, 16, v8
  v_and_b32 v67, 0xffff0000, v8
  v_lshlrev_b32 v10, 16, v31
  v_and_b32 v11, 0xffff0000, v31
  v_pk_add_f32 v[66:67], v[66:67], v[10:11]
  v_cvt_pk_bf16_f32 v31, v66, v67
  v_lshlrev_b32 v66, 16, v31
  v_and_b32 v67, 0xffff0000, v31
  buffer_store_dwordx4 v[28:31], v15, s[4:7], s21 offen offset:192 sc1
  s_waitcnt vmcnt(4)
  v_lshlrev_b32 v68, 16, v208
  v_and_b32 v69, 0xffff0000, v208
  v_lshlrev_b32 v70, 16, v209
  v_and_b32 v71, 0xffff0000, v209
  v_lshlrev_b32 v72, 16, v210
  v_and_b32 v73, 0xffff0000, v210
  v_lshlrev_b32 v74, 16, v211
  v_and_b32 v75, 0xffff0000, v211
  v_lshlrev_b32 v8, 16, v212
  v_and_b32 v9, 0xffff0000, v212
  v_pk_add_f32 v[68:69], v[68:69], v[8:9]
  v_lshlrev_b32 v8, 16, v213
  v_and_b32 v9, 0xffff0000, v213
  v_pk_add_f32 v[70:71], v[70:71], v[8:9]
  v_lshlrev_b32 v8, 16, v214
  v_and_b32 v9, 0xffff0000, v214
  v_pk_add_f32 v[72:73], v[72:73], v[8:9]
  v_lshlrev_b32 v8, 16, v215
  v_and_b32 v9, 0xffff0000, v215
  v_pk_add_f32 v[74:75], v[74:75], v[8:9]
  v_lshlrev_b32 v8, 16, v216
  v_and_b32 v9, 0xffff0000, v216
  v_pk_add_f32 v[68:69], v[68:69], v[8:9]
  v_lshlrev_b32 v8, 16, v217
  v_and_b32 v9, 0xffff0000, v217
  v_pk_add_f32 v[70:71], v[70:71], v[8:9]
  v_lshlrev_b32 v8, 16, v218
  v_and_b32 v9, 0xffff0000, v218
  v_pk_add_f32 v[72:73], v[72:73], v[8:9]
  v_lshlrev_b32 v8, 16, v219
  v_and_b32 v9, 0xffff0000, v219
  v_pk_add_f32 v[74:75], v[74:75], v[8:9]
  v_lshlrev_b32 v8, 16, v220
  v_and_b32 v9, 0xffff0000, v220
  v_pk_add_f32 v[68:69], v[68:69], v[8:9]
  v_lshlrev_b32 v8, 16, v221
  v_and_b32 v9, 0xffff0000, v221
  v_pk_add_f32 v[70:71], v[70:71], v[8:9]
  v_lshlrev_b32 v8, 16, v222
  v_and_b32 v9, 0xffff0000, v222
  v_pk_add_f32 v[72:73], v[72:73], v[8:9]
  v_lshlrev_b32 v8, 16, v223
  v_and_b32 v9, 0xffff0000, v223
  v_pk_add_f32 v[74:75], v[74:75], v[8:9]
  v_lshlrev_b32 v8, 16, v224
  v_and_b32 v9, 0xffff0000, v224
  v_pk_add_f32 v[68:69], v[68:69], v[8:9]
  v_lshlrev_b32 v8, 16, v225
  v_and_b32 v9, 0xffff0000, v225
  v_pk_add_f32 v[70:71], v[70:71], v[8:9]
  v_lshlrev_b32 v8, 16, v226
  v_and_b32 v9, 0xffff0000, v226
  v_pk_add_f32 v[72:73], v[72:73], v[8:9]
  v_lshlrev_b32 v8, 16, v227
  v_and_b32 v9, 0xffff0000, v227
  v_pk_add_f32 v[74:75], v[74:75], v[8:9]
  v_lshlrev_b32 v8, 16, v228
  v_and_b32 v9, 0xffff0000, v228
  v_pk_add_f32 v[68:69], v[68:69], v[8:9]
  v_lshlrev_b32 v8, 16, v229
  v_and_b32 v9, 0xffff0000, v229
  v_pk_add_f32 v[70:71], v[70:71], v[8:9]
  v_lshlrev_b32 v8, 16, v230
  v_and_b32 v9, 0xffff0000, v230
  v_pk_add_f32 v[72:73], v[72:73], v[8:9]
  v_lshlrev_b32 v8, 16, v231
  v_and_b32 v9, 0xffff0000, v231
  v_pk_add_f32 v[74:75], v[74:75], v[8:9]
  v_lshlrev_b32 v8, 16, v232
  v_and_b32 v9, 0xffff0000, v232
  v_pk_add_f32 v[68:69], v[68:69], v[8:9]
  v_lshlrev_b32 v8, 16, v233
  v_and_b32 v9, 0xffff0000, v233
  v_pk_add_f32 v[70:71], v[70:71], v[8:9]
  v_lshlrev_b32 v8, 16, v234
  v_and_b32 v9, 0xffff0000, v234
  v_pk_add_f32 v[72:73], v[72:73], v[8:9]
  v_lshlrev_b32 v8, 16, v235
  v_and_b32 v9, 0xffff0000, v235
  v_pk_add_f32 v[74:75], v[74:75], v[8:9]
  v_lshlrev_b32 v8, 16, v236
  v_and_b32 v9, 0xffff0000, v236
  v_pk_add_f32 v[68:69], v[68:69], v[8:9]
  v_lshlrev_b32 v8, 16, v237
  v_and_b32 v9, 0xffff0000, v237
  v_pk_add_f32 v[70:71], v[70:71], v[8:9]
  v_lshlrev_b32 v8, 16, v238
  v_and_b32 v9, 0xffff0000, v238
  v_pk_add_f32 v[72:73], v[72:73], v[8:9]
  v_lshlrev_b32 v8, 16, v239
  v_and_b32 v9, 0xffff0000, v239
  v_pk_add_f32 v[74:75], v[74:75], v[8:9]
  v_cvt_pk_bf16_f32 v8, v68, v69
  v_lshlrev_b32 v68, 16, v8
  v_and_b32 v69, 0xffff0000, v8
  v_lshlrev_b32 v10, 16, v32
  v_and_b32 v11, 0xffff0000, v32
  v_pk_add_f32 v[68:69], v[68:69], v[10:11]
  v_cvt_pk_bf16_f32 v32, v68, v69
  v_lshlrev_b32 v68, 16, v32
  v_and_b32 v69, 0xffff0000, v32
  v_cvt_pk_bf16_f32 v8, v70, v71
  v_lshlrev_b32 v70, 16, v8
  v_and_b32 v71, 0xffff0000, v8
  v_lshlrev_b32 v10, 16, v33
  v_and_b32 v11, 0xffff0000, v33
  v_pk_add_f32 v[70:71], v[70:71], v[10:11]
  v_cvt_pk_bf16_f32 v33, v70, v71
  v_lshlrev_b32 v70, 16, v33
  v_and_b32 v71, 0xffff0000, v33
  v_cvt_pk_bf16_f32 v8, v72, v73
  v_lshlrev_b32 v72, 16, v8
  v_and_b32 v73, 0xffff0000, v8
  v_lshlrev_b32 v10, 16, v34
  v_and_b32 v11, 0xffff0000, v34
  v_pk_add_f32 v[72:73], v[72:73], v[10:11]
  v_cvt_pk_bf16_f32 v34, v72, v73
  v_lshlrev_b32 v72, 16, v34
  v_and_b32 v73, 0xffff0000, v34
  v_cvt_pk_bf16_f32 v8, v74, v75
  v_lshlrev_b32 v74, 16, v8
  v_and_b32 v75, 0xffff0000, v8
  v_lshlrev_b32 v10, 16, v35
  v_and_b32 v11, 0xffff0000, v35
  v_pk_add_f32 v[74:75], v[74:75], v[10:11]
  v_cvt_pk_bf16_f32 v35, v74, v75
  v_lshlrev_b32 v74, 16, v35
  v_and_b32 v75, 0xffff0000, v35
  buffer_store_dwordx4 v[32:35], v15, s[4:7], s21 offen offset:256 sc1
  v_and_b32 v3, 63, v0
  v_and_b32 v2, 15, v3
  v_lshlrev_b32 v5, 2, v2
  s_lshl_b32 s17, s16, 6
  v_add_u32 v1, s17, v5
  v_pk_add_f32 v[6:7], v[36:37], v[38:39]
  v_pk_add_f32 v[6:7], v[6:7], v[40:41]
  v_pk_add_f32 v[6:7], v[6:7], v[42:43]
  v_pk_add_f32 v[6:7], v[6:7], v[44:45]
  v_pk_add_f32 v[6:7], v[6:7], v[46:47]
  v_pk_add_f32 v[6:7], v[6:7], v[48:49]
  v_pk_add_f32 v[6:7], v[6:7], v[50:51]
  v_pk_add_f32 v[6:7], v[6:7], v[52:53]
  v_pk_add_f32 v[6:7], v[6:7], v[54:55]
  v_pk_add_f32 v[6:7], v[6:7], v[56:57]
  v_pk_add_f32 v[6:7], v[6:7], v[58:59]
  v_pk_add_f32 v[6:7], v[6:7], v[60:61]
  v_pk_add_f32 v[6:7], v[6:7], v[62:63]
  v_pk_add_f32 v[6:7], v[6:7], v[64:65]
  v_pk_add_f32 v[6:7], v[6:7], v[66:67]
  v_pk_add_f32 v[6:7], v[6:7], v[68:69]
  v_pk_add_f32 v[6:7], v[6:7], v[70:71]
  v_pk_add_f32 v[6:7], v[6:7], v[72:73]
  v_pk_add_f32 v[6:7], v[6:7], v[74:75]
  v_add_f32 v4, v6, v7
  v_mov_b32 v2, v4
  s_nop 1
  v_permlane32_swap_b32 v4, v2
  v_add_f32 v4, v4, v2
  v_mov_b32 v2, v4
  s_nop 1
  v_permlane16_swap_b32 v4, v2
  v_add_f32 v4, v4, v2
  ds_write_b32 v1, v4 offset:0
  s_waitcnt lgkmcnt(0)
  s_barrier
  ds_read_b32 v4, v5 offset:0
  ds_read_b32 v2, v5 offset:64
  ds_read_b32 v3, v5 offset:128
  ds_read_b32 v6, v5 offset:192
  s_waitcnt lgkmcnt(0)
  v_add_f32 v4, v4, v2
  v_add_f32 v3, v3, v6
  v_add_f32 v4, v4, v3
  v_mul_f32 v6, 0xbacccccd, v4
  v_mov_b32 v7, v6
  v_pk_add_f32 v[36:37], v[36:37], v[6:7]
  v_pk_add_f32 v[38:39], v[38:39], v[6:7]
  v_pk_add_f32 v[40:41], v[40:41], v[6:7]
  v_pk_add_f32 v[42:43], v[42:43], v[6:7]
  v_pk_add_f32 v[44:45], v[44:45], v[6:7]
  v_pk_add_f32 v[46:47], v[46:47], v[6:7]
  v_pk_add_f32 v[48:49], v[48:49], v[6:7]
  v_pk_add_f32 v[50:51], v[50:51], v[6:7]
  v_pk_add_f32 v[52:53], v[52:53], v[6:7]
  v_pk_add_f32 v[54:55], v[54:55], v[6:7]
  v_pk_add_f32 v[56:57], v[56:57], v[6:7]
  v_pk_add_f32 v[58:59], v[58:59], v[6:7]
  v_pk_add_f32 v[60:61], v[60:61], v[6:7]
  v_pk_add_f32 v[62:63], v[62:63], v[6:7]
  v_pk_add_f32 v[64:65], v[64:65], v[6:7]
  v_pk_add_f32 v[66:67], v[66:67], v[6:7]
  v_pk_add_f32 v[68:69], v[68:69], v[6:7]
  v_pk_add_f32 v[70:71], v[70:71], v[6:7]
  v_pk_add_f32 v[72:73], v[72:73], v[6:7]
  v_pk_add_f32 v[74:75], v[74:75], v[6:7]
  v_pk_mul_f32 v[6:7], v[36:37], v[36:37]
  v_pk_fma_f32 v[6:7], v[38:39], v[38:39], v[6:7]
  v_pk_fma_f32 v[6:7], v[40:41], v[40:41], v[6:7]
  v_pk_fma_f32 v[6:7], v[42:43], v[42:43], v[6:7]
  v_pk_fma_f32 v[6:7], v[44:45], v[44:45], v[6:7]
  v_pk_fma_f32 v[6:7], v[46:47], v[46:47], v[6:7]
  v_pk_fma_f32 v[6:7], v[48:49], v[48:49], v[6:7]
  v_pk_fma_f32 v[6:7], v[50:51], v[50:51], v[6:7]
  v_pk_fma_f32 v[6:7], v[52:53], v[52:53], v[6:7]
  v_pk_fma_f32 v[6:7], v[54:55], v[54:55], v[6:7]
  v_pk_fma_f32 v[6:7], v[56:57], v[56:57], v[6:7]
  v_pk_fma_f32 v[6:7], v[58:59], v[58:59], v[6:7]
  v_pk_fma_f32 v[6:7], v[60:61], v[60:61], v[6:7]
  v_pk_fma_f32 v[6:7], v[62:63], v[62:63], v[6:7]
  v_pk_fma_f32 v[6:7], v[64:65], v[64:65], v[6:7]
  v_pk_fma_f32 v[6:7], v[66:67], v[66:67], v[6:7]
  v_pk_fma_f32 v[6:7], v[68:69], v[68:69], v[6:7]
  v_pk_fma_f32 v[6:7], v[70:71], v[70:71], v[6:7]
  v_pk_fma_f32 v[6:7], v[72:73], v[72:73], v[6:7]
  v_pk_fma_f32 v[6:7], v[74:75], v[74:75], v[6:7]
  v_add_f32 v4, v6, v7
  v_mov_b32 v2, v4
  s_nop 1
  v_permlane32_swap_b32 v4, v2
  v_add_f32 v4, v4, v2
  v_mov_b32 v2, v4
  s_nop 1
  v_permlane16_swap_b32 v4, v2
  v_add_f32 v4, v4, v2
  ds_write_b32 v1, v4 offset:256
  s_waitcnt lgkmcnt(0)
  s_barrier
  ds_read_b32 v4, v5 offset:256
  ds_read_b32 v2, v5 offset:320
  ds_read_b32 v3, v5 offset:384
  ds_read_b32 v6, v5 offset:448
  s_waitcnt lgkmcnt(0)
  v_add_f32 v4, v4, v2
  v_add_f32 v3, v3, v6
  v_add_f32 v4, v4, v3
  v_mov_b32 v2, 0x3727c5ac
  v_fmac_f32 v2, 0x3acccccd, v4
  v_rsq_f32 v6, v2
  s_nop 0
  v_mov_b32 v7, v6
  v_pk_mul_f32 v[36:37], v[36:37], v[6:7]
  v_pk_mul_f32 v[38:39], v[38:39], v[6:7]
  v_pk_mul_f32 v[40:41], v[40:41], v[6:7]
  v_pk_mul_f32 v[42:43], v[42:43], v[6:7]
  v_pk_mul_f32 v[44:45], v[44:45], v[6:7]
  v_pk_mul_f32 v[46:47], v[46:47], v[6:7]
  v_pk_mul_f32 v[48:49], v[48:49], v[6:7]
  v_pk_mul_f32 v[50:51], v[50:51], v[6:7]
  v_pk_mul_f32 v[52:53], v[52:53], v[6:7]
  v_pk_mul_f32 v[54:55], v[54:55], v[6:7]
  v_pk_mul_f32 v[56:57], v[56:57], v[6:7]
  v_pk_mul_f32 v[58:59], v[58:59], v[6:7]
  v_pk_mul_f32 v[60:61], v[60:61], v[6:7]
  v_pk_mul_f32 v[62:63], v[62:63], v[6:7]
  v_pk_mul_f32 v[64:65], v[64:65], v[6:7]
  v_pk_mul_f32 v[66:67], v[66:67], v[6:7]
  v_pk_mul_f32 v[68:69], v[68:69], v[6:7]
  v_pk_mul_f32 v[70:71], v[70:71], v[6:7]
  v_pk_mul_f32 v[72:73], v[72:73], v[6:7]
  v_pk_mul_f32 v[74:75], v[74:75], v[6:7]
  v_cvt_pk_bf16_f32 v16, v36, v37
  v_cvt_pk_bf16_f32 v17, v38, v39
  v_cvt_pk_bf16_f32 v18, v40, v41
  v_cvt_pk_bf16_f32 v19, v42, v43
  v_cvt_pk_bf16_f32 v20, v44, v45
  v_cvt_pk_bf16_f32 v21, v46, v47
  v_cvt_pk_bf16_f32 v22, v48, v49
  v_cvt_pk_bf16_f32 v23, v50, v51
  v_cvt_pk_bf16_f32 v24, v52, v53
  v_cvt_pk_bf16_f32 v25, v54, v55
  v_cvt_pk_bf16_f32 v26, v56, v57
  v_cvt_pk_bf16_f32 v27, v58, v59
  v_cvt_pk_bf16_f32 v28, v60, v61
  v_cvt_pk_bf16_f32 v29, v62, v63
  v_cvt_pk_bf16_f32 v30, v64, v65
  v_cvt_pk_bf16_f32 v31, v66, v67
  v_cvt_pk_bf16_f32 v32, v68, v69
  v_cvt_pk_bf16_f32 v33, v70, v71
  v_cvt_pk_bf16_f32 v34, v72, v73
  v_cvt_pk_bf16_f32 v35, v74, v75
  v_and_b32 v3, 63, v0
  v_and_b32 v2, 15, v3
  v_lshlrev_b32 v1, 4, v2
  v_bfe_u32 v2, v3, 4, 1
  v_lshl_add_u32 v1, v2, 9, v1
  v_lshrrev_b32 v2, 5, v3
  v_lshl_add_u32 v1, v2, 10, v1
  s_lshr_b32 s17, s19, 1
  s_mul_i32 s17, s17, 40960
  s_and_b32 s18, s19, 1
  s_lshl_b32 s18, s18, 8
  s_add_u32 s17, s17, s18
  s_mul_i32 s18, s16, 10240
  s_add_u32 s17, s17, s18
  s_add_u32 s17, s17, 54525952
  buffer_store_dwordx4 v[16:19], v1, s[4:7], s17 offen offset:0 sc1
  buffer_store_dwordx4 v[20:23], v1, s[4:7], s17 offen offset:2048 sc1
  s_add_u32 s17, s17, 4096
  buffer_store_dwordx4 v[24:27], v1, s[4:7], s17 offen offset:0 sc1
  buffer_store_dwordx4 v[28:31], v1, s[4:7], s17 offen offset:2048 sc1
  s_add_u32 s17, s17, 4096
  buffer_store_dwordx4 v[32:35], v1, s[4:7], s17 offen offset:0 sc1
redln1_exit1:
  s_endpgm
.globl redln2_kernel
.p2align 8
.type redln2_kernel,@function
redln2_kernel:
  s_cmp_ge_u32 s2, 128
  s_cbranch_scc1 redln2_exit1
  s_load_dwordx2 s[12:13], s[0:1], 96
  s_load_dwordx2 s[14:15], s[0:1], 0
  v_lshrrev_b32 v2, 6, v0
  s_nop 0
  v_readfirstlane_b32 s16, v2
  s_waitcnt lgkmcnt(0)
  s_mov_b32 s4, s12
  s_mov_b32 s5, s13
  s_mov_b32 s6, 0x10000000
  s_mov_b32 s7, 0x20000
  s_mov_b32 s8, s12
  s_mov_b32 s9, s13
  s_mov_b32 s10, 0x10000000
  s_mov_b32 s11, 0x20000
  s_mov_b32 s20, 82313216
  s_mov_b32 s19, s2
  v_and_b32 v3, 63, v0
  v_lshlrev_b32 v14, 4, v3
  v_and_b32 v2, 15, v3
  v_lshrrev_b32 v4, 4, v3
  s_lshl_b32 s17, s19, 4
  v_add_u32 v15, s17, v2
  v_mul_u32_u24 v15, 1280, v15
  v_lshl_add_u32 v15, v4, 4, v15
  s_mul_i32 s17, s16, 320
  s_add_u32 s20, s20, s17
  s_add_u32 s21, s17, 82313216
  s_mul_i32 s22, s19, 20
  s_mul_i32 s23, s16, 5
  s_add_u32 s22, s22, s23
  s_lshl_b32 s22, s22, 10
  s_add_u32 s22, s22, 92798976
  s_add_u32 s24, s22, 0
  s_add_u32 s25, s22, 2621440
  s_add_u32 s26, s22, 5242880
  s_add_u32 s27, s22, 7864320
  s_add_u32 s28, s22, 10485760
  s_add_u32 s29, s22, 13107200
  s_add_u32 s30, s22, 15728640
  s_add_u32 s31, s22, 18350080
  v_add_u32 v6, 0x1000, v14
  buffer_load_dwordx4 v[16:19], v15, s[8:11], s20 offen offset:0
  buffer_load_dwordx4 v[20:23], v15, s[8:11], s20 offen offset:64
  buffer_load_dwordx4 v[24:27], v15, s[8:11], s20 offen offset:128
  buffer_load_dwordx4 v[28:31], v15, s[8:11], s20 offen offset:192
  buffer_load_dwordx4 v[32:35], v15, s[8:11], s20 offen offset:256
  buffer_load_dwordx4 v[80:83], v14, s[4:7], s24 offen offset:0
  buffer_load_dwordx4 v[84:87], v14, s[4:7], s25 offen offset:0
  buffer_load_dwordx4 v[88:91], v14, s[4:7], s26 offen offset:0
  buffer_load_dwordx4 v[92:95], v14, s[4:7], s27 offen offset:0
  buffer_load_dwordx4 v[96:99], v14, s[4:7], s28 offen offset:0
  buffer_load_dwordx4 v[100:103], v14, s[4:7], s29 offen offset:0
  buffer_load_dwordx4 v[104:107], v14, s[4:7], s30 offen offset:0
  buffer_load_dwordx4 v[108:111], v14, s[4:7], s31 offen offset:0
  buffer_load_dwordx4 v[112:115], v14, s[4:7], s24 offen offset:1024
  buffer_load_dwordx4 v[116:119], v14, s[4:7], s25 offen offset:1024
  buffer_load_dwordx4 v[120:123], v14, s[4:7], s26 offen offset:1024
  buffer_load_dwordx4 v[124:127], v14, s[4:7], s27 offen offset:1024
  buffer_load_dwordx4 v[128:131], v14, s[4:7], s28 offen offset:1024
  buffer_load_dwordx4 v[132:135], v14, s[4:7], s29 offen offset:1024
  buffer_load_dwordx4 v[136:139], v14, s[4:7], s30 offen offset:1024
  buffer_load_dwordx4 v[140:143], v14, s[4:7], s31 offen offset:1024
  buffer_load_dwordx4 v[144:147], v14, s[4:7], s24 offen offset:2048
  buffer_load_dwordx4 v[148:151], v14, s[4:7], s25 offen offset:2048
  buffer_load_dwordx4 v[152:155], v14, s[4:7], s26 offen offset:2048
  buffer_load_dwordx4 v[156:159], v14, s[4:7], s27 offen offset:2048
  buffer_load_dwordx4 v[160:163], v14, s[4:7], s28 offen offset:2048
  buffer_load_dwordx4 v[164:167], v14, s[4:7], s29 offen offset:2048
  buffer_load_dwordx4 v[168:171], v14, s[4:7], s30 offen offset:2048
  buffer_load_dwordx4 v[172:175], v14, s[4:7], s31 offen offset:2048
  buffer_load_dwordx4 v[176:179], v14, s[4:7], s24 offen offset:3072
  buffer_load_dwordx4 v[180:183], v14, s[4:7], s25 offen offset:3072
  buffer_load_dwordx4 v[184:187], v14, s[4:7], s26 offen offset:3072
  buffer_load_dwordx4 v[188:191], v14, s[4:7], s27 offen offset:3072
  buffer_load_dwordx4 v[192:195], v14, s[4:7], s28 offen offset:3072
  buffer_load_dwordx4 v[196:199], v14, s[4:7], s29 offen offset:3072
  buffer_load_dwordx4 v[200:203], v14, s[4:7], s30 offen offset:3072
  buffer_load_dwordx4 v[204:207], v14, s[4:7], s31 offen offset:3072
  buffer_load_dwordx4 v[208:211], v6, s[4:7], s24 offen offset:0
  buffer_load_dwordx4 v[212:215], v6, s[4:7], s25 offen offset:0
  buffer_load_dwordx4 v[216:219], v6, s[4:7], s26 offen offset:0
  buffer_load_dwordx4 v[220:223], v6, s[4:7], s27 offen offset:0
  buffer_load_dwordx4 v[224:227], v6, s[4:7], s28 offen offset:0
  buffer_load_dwordx4 v[228:231], v6, s[4:7], s29 offen offset:0
  buffer_load_dwordx4 v[232:235], v6, s[4:7], s30 offen offset:0
  buffer_load_dwordx4 v[236:239], v6, s[4:7], s31 offen offset:0
  s_waitcnt vmcnt(32)
  v_lshlrev_b32 v36, 16, v80
  v_and_b32 v37, 0xffff0000, v80
  v_lshlrev_b32 v38, 16, v81
  v_and_b32 v39, 0xffff0000, v81
  v_lshlrev_b32 v40, 16, v82
  v_and_b32 v41, 0xffff0000, v82
  v_lshlrev_b32 v42, 16, v83
  v_and_b32 v43, 0xffff0000, v83
  v_lshlrev_b32 v8, 16, v84
  v_and_b32 v9, 0xffff0000, v84
  v_pk_add_f32 v[36:37], v[36:37], v[8:9]
  v_lshlrev_b32 v8, 16, v85
  v_and_b32 v9, 0xffff0000, v85
  v_pk_add_f32 v[38:39], v[38:39], v[8:9]
  v_lshlrev_b32 v8, 16, v86
  v_and_b32 v9, 0xffff0000, v86
  v_pk_add_f32 v[40:41], v[40:41], v[8:9]
  v_lshlrev_b32 v8, 16, v87
  v_and_b32 v9, 0xffff0000, v87
  v_pk_add_f32 v[42:43], v[42:43], v[8:9]
  v_lshlrev_b32 v8, 16, v88
  v_and_b32 v9, 0xffff0000, v88
  v_pk_add_f32 v[36:37], v[36:37], v[8:9]
  v_lshlrev_b32 v8, 16, v89
  v_and_b32 v9, 0xffff0000, v89
  v_pk_add_f32 v[38:39], v[38:39], v[8:9]
  v_lshlrev_b32 v8, 16, v90
  v_and_b32 v9, 0xffff0000, v90
  v_pk_add_f32 v[40:41], v[40:41], v[8:9]
  v_lshlrev_b32 v8, 16, v91
  v_and_b32 v9, 0xffff0000, v91
  v_pk_add_f32 v[42:43], v[42:43], v[8:9]
  v_lshlrev_b32 v8, 16, v92
  v_and_b32 v9, 0xffff0000, v92
  v_pk_add_f32 v[36:37], v[36:37], v[8:9]
  v_lshlrev_b32 v8, 16, v93
  v_and_b32 v9, 0xffff0000, v93
  v_pk_add_f32 v[38:39], v[38:39], v[8:9]
  v_lshlrev_b32 v8, 16, v94
  v_and_b32 v9, 0xffff0000, v94
  v_pk_add_f32 v[40:41], v[40:41], v[8:9]
  v_lshlrev_b32 v8, 16, v95
  v_and_b32 v9, 0xffff0000, v95
  v_pk_add_f32 v[42:43], v[42:43], v[8:9]
  v_lshlrev_b32 v8, 16, v96
  v_and_b32 v9, 0xffff0000, v96
  v_pk_add_f32 v[36:37], v[36:37], v[8:9]
  v_lshlrev_b32 v8, 16, v97
  v_and_b32 v9, 0xffff0000, v97
  v_pk_add_f32 v[38:39], v[38:39], v[8:9]
  v_lshlrev_b32 v8, 16, v98
  v_and_b32 v9, 0xffff0000, v98
  v_pk_add_f32 v[40:41], v[40:41], v[8:9]
  v_lshlrev_b32 v8, 16, v99
  v_and_b32 v9, 0xffff0000, v99
  v_pk_add_f32 v[42:43], v[42:43], v[8:9]
  v_lshlrev_b32 v8, 16, v100
  v_and_b32 v9, 0xffff0000, v100
  v_pk_add_f32 v[36:37], v[36:37], v[8:9]
  v_lshlrev_b32 v8, 16, v101
  v_and_b32 v9, 0xffff0000, v101
  v_pk_add_f32 v[38:39], v[38:39], v[8:9]
  v_lshlrev_b32 v8, 16, v102
  v_and_b32 v9, 0xffff0000, v102
  v_pk_add_f32 v[40:41], v[40:41], v[8:9]
  v_lshlrev_b32 v8, 16, v103
  v_and_b32 v9, 0xffff0000, v103
  v_pk_add_f32 v[42:43], v[42:43], v[8:9]
  v_lshlrev_b32 v8, 16, v104
  v_and_b32 v9, 0xffff0000, v104
  v_pk_add_f32 v[36:37], v[36:37], v[8:9]
  v_lshlrev_b32 v8, 16, v105
  v_and_b32 v9, 0xffff0000, v105
  v_pk_add_f32 v[38:39], v[38:39], v[8:9]
  v_lshlrev_b32 v8, 16, v106
  v_and_b32 v9, 0xffff0000, v106
  v_pk_add_f32 v[40:41], v[40:41], v[8:9]
  v_lshlrev_b32 v8, 16, v107
  v_and_b32 v9, 0xffff0000, v107
  v_pk_add_f32 v[42:43], v[42:43], v[8:9]
  v_lshlrev_b32 v8, 16, v108
  v_and_b32 v9, 0xffff0000, v108
  v_pk_add_f32 v[36:37], v[36:37], v[8:9]
  v_lshlrev_b32 v8, 16, v109
  v_and_b32 v9, 0xffff0000, v109
  v_pk_add_f32 v[38:39], v[38:39], v[8:9]
  v_lshlrev_b32 v8, 16, v110
  v_and_b32 v9, 0xffff0000, v110
  v_pk_add_f32 v[40:41], v[40:41], v[8:9]
  v_lshlrev_b32 v8, 16, v111
  v_and_b32 v9, 0xffff0000, v111
  v_pk_add_f32 v[42:43], v[42:43], v[8:9]
  v_cvt_pk_bf16_f32 v8, v36, v37
  v_lshlrev_b32 v36, 16, v8
  v_and_b32 v37, 0xffff0000, v8
  v_lshlrev_b32 v10, 16, v16
  v_and_b32 v11, 0xffff0000, v16
  v_pk_add_f32 v[36:37], v[36:37], v[10:11]
  v_cvt_pk_bf16_f32 v16, v36, v37
  v_lshlrev_b32 v36, 16, v16
  v_and_b32 v37, 0xffff0000, v16
  v_cvt_pk_bf16_f32 v8, v38, v39
  v_lshlrev_b32 v38, 16, v8
  v_and_b32 v39, 0xffff0000, v8
  v_lshlrev_b32 v10, 16, v17
  v_and_b32 v11, 0xffff0000, v17
  v_pk_add_f32 v[38:39], v[38:39], v[10:11]
  v_cvt_pk_bf16_f32 v17, v38, v39
  v_lshlrev_b32 v38, 16, v17
  v_and_b32 v39, 0xffff0000, v17
  v_cvt_pk_bf16_f32 v8, v40, v41
  v_lshlrev_b32 v40, 16, v8
  v_and_b32 v41, 0xffff0000, v8
  v_lshlrev_b32 v10, 16, v18
  v_and_b32 v11, 0xffff0000, v18
  v_pk_add_f32 v[40:41], v[40:41], v[10:11]
  v_cvt_pk_bf16_f32 v18, v40, v41
  v_lshlrev_b32 v40, 16, v18
  v_and_b32 v41, 0xffff0000, v18
  v_cvt_pk_bf16_f32 v8, v42, v43
  v_lshlrev_b32 v42, 16, v8
  v_and_b32 v43, 0xffff0000, v8
  v_lshlrev_b32 v10, 16, v19
  v_and_b32 v11, 0xffff0000, v19
  v_pk_add_f32 v[42:43], v[42:43], v[10:11]
  v_cvt_pk_bf16_f32 v19, v42, v43
  v_lshlrev_b32 v42, 16, v19
  v_and_b32 v43, 0xffff0000, v19
  buffer_store_dwordx4 v[16:19], v15, s[4:7], s21 offen offset:0 sc1
  s_waitcnt vmcnt(25)
  v_lshlrev_b32 v44, 16, v112
  v_and_b32 v45, 0xffff0000, v112
  v_lshlrev_b32 v46, 16, v113
  v_and_b32 v47, 0xffff0000, v113
  v_lshlrev_b32 v48, 16, v114
  v_and_b32 v49, 0xffff0000, v114
  v_lshlrev_b32 v50, 16, v115
  v_and_b32 v51, 0xffff0000, v115
  v_lshlrev_b32 v8, 16, v116
  v_and_b32 v9, 0xffff0000, v116
  v_pk_add_f32 v[44:45], v[44:45], v[8:9]
  v_lshlrev_b32 v8, 16, v117
  v_and_b32 v9, 0xffff0000, v117
  v_pk_add_f32 v[46:47], v[46:47], v[8:9]
  v_lshlrev_b32 v8, 16, v118
  v_and_b32 v9, 0xffff0000, v118
  v_pk_add_f32 v[48:49], v[48:49], v[8:9]
  v_lshlrev_b32 v8, 16, v119
  v_and_b32 v9, 0xffff0000, v119
  v_pk_add_f32 v[50:51], v[50:51], v[8:9]
  v_lshlrev_b32 v8, 16, v120
  v_and_b32 v9, 0xffff0000, v120
  v_pk_add_f32 v[44:45], v[44:45], v[8:9]
  v_lshlrev_b32 v8, 16, v121
  v_and_b32 v9, 0xffff0000, v121
  v_pk_add_f32 v[46:47], v[46:47], v[8:9]
  v_lshlrev_b32 v8, 16, v122
  v_and_b32 v9, 0xffff0000, v122
  v_pk_add_f32 v[48:49], v[48:49], v[8:9]
  v_lshlrev_b32 v8, 16, v123
  v_and_b32 v9, 0xffff0000, v123
  v_pk_add_f32 v[50:51], v[50:51], v[8:9]
  v_lshlrev_b32 v8, 16, v124
  v_and_b32 v9, 0xffff0000, v124
  v_pk_add_f32 v[44:45], v[44:45], v[8:9]
  v_lshlrev_b32 v8, 16, v125
  v_and_b32 v9, 0xffff0000, v125
  v_pk_add_f32 v[46:47], v[46:47], v[8:9]
  v_lshlrev_b32 v8, 16, v126
  v_and_b32 v9, 0xffff0000, v126
  v_pk_add_f32 v[48:49], v[48:49], v[8:9]
  v_lshlrev_b32 v8, 16, v127
  v_and_b32 v9, 0xffff0000, v127
  v_pk_add_f32 v[50:51], v[50:51], v[8:9]
  v_lshlrev_b32 v8, 16, v128
  v_and_b32 v9, 0xffff0000, v128
  v_pk_add_f32 v[44:45], v[44:45], v[8:9]
  v_lshlrev_b32 v8, 16, v129
  v_and_b32 v9, 0xffff0000, v129
  v_pk_add_f32 v[46:47], v[46:47], v[8:9]
  v_lshlrev_b32 v8, 16, v130
  v_and_b32 v9, 0xffff0000, v130
  v_pk_add_f32 v[48:49], v[48:49], v[8:9]
  v_lshlrev_b32 v8, 16, v131
  v_and_b32 v9, 0xffff0000, v131
  v_pk_add_f32 v[50:51], v[50:51], v[8:9]
  v_lshlrev_b32 v8, 16, v132
  v_and_b32 v9, 0xffff0000, v132
  v_pk_add_f32 v[44:45], v[44:45], v[8:9]
  v_lshlrev_b32 v8, 16, v133
  v_and_b32 v9, 0xffff0000, v133
  v_pk_add_f32 v[46:47], v[46:47], v[8:9]
  v_lshlrev_b32 v8, 16, v134
  v_and_b32 v9, 0xffff0000, v134
  v_pk_add_f32 v[48:49], v[48:49], v[8:9]
  v_lshlrev_b32 v8, 16, v135
  v_and_b32 v9, 0xffff0000, v135
  v_pk_add_f32 v[50:51], v[50:51], v[8:9]
  v_lshlrev_b32 v8, 16, v136
  v_and_b32 v9, 0xffff0000, v136
  v_pk_add_f32 v[44:45], v[44:45], v[8:9]
  v_lshlrev_b32 v8, 16, v137
  v_and_b32 v9, 0xffff0000, v137
  v_pk_add_f32 v[46:47], v[46:47], v[8:9]
  v_lshlrev_b32 v8, 16, v138
  v_and_b32 v9, 0xffff0000, v138
  v_pk_add_f32 v[48:49], v[48:49], v[8:9]
  v_lshlrev_b32 v8, 16, v139
  v_and_b32 v9, 0xffff0000, v139
  v_pk_add_f32 v[50:51], v[50:51], v[8:9]
  v_lshlrev_b32 v8, 16, v140
  v_and_b32 v9, 0xffff0000, v140
  v_pk_add_f32 v[44:45], v[44:45], v[8:9]
  v_lshlrev_b32 v8, 16, v141
  v_and_b32 v9, 0xffff0000, v141
  v_pk_add_f32 v[46:47], v[46:47], v[8:9]
  v_lshlrev_b32 v8, 16, v142
  v_and_b32 v9, 0xffff0000, v142
  v_pk_add_f32 v[48:49], v[48:49], v[8:9]
  v_lshlrev_b32 v8, 16, v143
  v_and_b32 v9, 0xffff0000, v143
  v_pk_add_f32 v[50:51], v[50:51], v[8:9]
  v_cvt_pk_bf16_f32 v8, v44, v45
  v_lshlrev_b32 v44, 16, v8
  v_and_b32 v45, 0xffff0000, v8
  v_lshlrev_b32 v10, 16, v20
  v_and_b32 v11, 0xffff0000, v20
  v_pk_add_f32 v[44:45], v[44:45], v[10:11]
  v_cvt_pk_bf16_f32 v20, v44, v45
  v_lshlrev_b32 v44, 16, v20
  v_and_b32 v45, 0xffff0000, v20
  v_cvt_pk_bf16_f32 v8, v46, v47
  v_lshlrev_b32 v46, 16, v8
  v_and_b32 v47, 0xffff0000, v8
  v_lshlrev_b32 v10, 16, v21
  v_and_b32 v11, 0xffff0000, v21
  v_pk_add_f32 v[46:47], v[46:47], v[10:11]
  v_cvt_pk_bf16_f32 v21, v46, v47
  v_lshlrev_b32 v46, 16, v21
  v_and_b32 v47, 0xffff0000, v21
  v_cvt_pk_bf16_f32 v8, v48, v49
  v_lshlrev_b32 v48, 16, v8
  v_and_b32 v49, 0xffff0000, v8
  v_lshlrev_b32 v10, 16, v22
  v_and_b32 v11, 0xffff0000, v22
  v_pk_add_f32 v[48:49], v[48:49], v[10:11]
  v_cvt_pk_bf16_f32 v22, v48, v49
  v_lshlrev_b32 v48, 16, v22
  v_and_b32 v49, 0xffff0000, v22
  v_cvt_pk_bf16_f32 v8, v50, v51
  v_lshlrev_b32 v50, 16, v8
  v_and_b32 v51, 0xffff0000, v8
  v_lshlrev_b32 v10, 16, v23
  v_and_b32 v11, 0xffff0000, v23
  v_pk_add_f32 v[50:51], v[50:51], v[10:11]
  v_cvt_pk_bf16_f32 v23, v50, v51
  v_lshlrev_b32 v50, 16, v23
  v_and_b32 v51, 0xffff0000, v23
  buffer_store_dwordx4 v[20:23], v15, s[4:7], s21 offen offset:64 sc1
  s_waitcnt vmcnt(18)
  v_lshlrev_b32 v52, 16, v144
  v_and_b32 v53, 0xffff0000, v144
  v_lshlrev_b32 v54, 16, v145
  v_and_b32 v55, 0xffff0000, v145
  v_lshlrev_b32 v56, 16, v146
  v_and_b32 v57, 0xffff0000, v146
  v_lshlrev_b32 v58, 16, v147
  v_and_b32 v59, 0xffff0000, v147
  v_lshlrev_b32 v8, 16, v148
  v_and_b32 v9, 0xffff0000, v148
  v_pk_add_f32 v[52:53], v[52:53], v[8:9]
  v_lshlrev_b32 v8, 16, v149
  v_and_b32 v9, 0xffff0000, v149
  v_pk_add_f32 v[54:55], v[54:55], v[8:9]
  v_lshlrev_b32 v8, 16, v150
  v_and_b32 v9, 0xffff0000, v150
  v_pk_add_f32 v[56:57], v[56:57], v[8:9]
  v_lshlrev_b32 v8, 16, v151
  v_and_b32 v9, 0xffff0000, v151
  v_pk_add_f32 v[58:59], v[58:59], v[8:9]
  v_lshlrev_b32 v8, 16, v152
  v_and_b32 v9, 0xffff0000, v152
  v_pk_add_f32 v[52:53], v[52:53], v[8:9]
  v_lshlrev_b32 v8, 16, v153
  v_and_b32 v9, 0xffff0000, v153
  v_pk_add_f32 v[54:55], v[54:55], v[8:9]
  v_lshlrev_b32 v8, 16, v154
  v_and_b32 v9, 0xffff0000, v154
  v_pk_add_f32 v[56:57], v[56:57], v[8:9]
  v_lshlrev_b32 v8, 16, v155
  v_and_b32 v9, 0xffff0000, v155
  v_pk_add_f32 v[58:59], v[58:59], v[8:9]
  v_lshlrev_b32 v8, 16, v156
  v_and_b32 v9, 0xffff0000, v156
  v_pk_add_f32 v[52:53], v[52:53], v[8:9]
  v_lshlrev_b32 v8, 16, v157
  v_and_b32 v9, 0xffff0000, v157
  v_pk_add_f32 v[54:55], v[54:55], v[8:9]
  v_lshlrev_b32 v8, 16, v158
  v_and_b32 v9, 0xffff0000, v158
  v_pk_add_f32 v[56:57], v[56:57], v[8:9]
  v_lshlrev_b32 v8, 16, v159
  v_and_b32 v9, 0xffff0000, v159
  v_pk_add_f32 v[58:59], v[58:59], v[8:9]
  v_lshlrev_b32 v8, 16, v160
  v_and_b32 v9, 0xffff0000, v160
  v_pk_add_f32 v[52:53], v[52:53], v[8:9]
  v_lshlrev_b32 v8, 16, v161
  v_and_b32 v9, 0xffff0000, v161
  v_pk_add_f32 v[54:55], v[54:55], v[8:9]
  v_lshlrev_b32 v8, 16, v162
  v_and_b32 v9, 0xffff0000, v162
  v_pk_add_f32 v[56:57], v[56:57], v[8:9]
  v_lshlrev_b32 v8, 16, v163
  v_and_b32 v9, 0xffff0000, v163
  v_pk_add_f32 v[58:59], v[58:59], v[8:9]
  v_lshlrev_b32 v8, 16, v164
  v_and_b32 v9, 0xffff0000, v164
  v_pk_add_f32 v[52:53], v[52:53], v[8:9]
  v_lshlrev_b32 v8, 16, v165
  v_and_b32 v9, 0xffff0000, v165
  v_pk_add_f32 v[54:55], v[54:55], v[8:9]
  v_lshlrev_b32 v8, 16, v166
  v_and_b32 v9, 0xffff0000, v166
  v_pk_add_f32 v[56:57], v[56:57], v[8:9]
  v_lshlrev_b32 v8, 16, v167
  v_and_b32 v9, 0xffff0000, v167
  v_pk_add_f32 v[58:59], v[58:59], v[8:9]
  v_lshlrev_b32 v8, 16, v168
  v_and_b32 v9, 0xffff0000, v168
  v_pk_add_f32 v[52:53], v[52:53], v[8:9]
  v_lshlrev_b32 v8, 16, v169
  v_and_b32 v9, 0xffff0000, v169
  v_pk_add_f32 v[54:55], v[54:55], v[8:9]
  v_lshlrev_b32 v8, 16, v170
  v_and_b32 v9, 0xffff0000, v170
  v_pk_add_f32 v[56:57], v[56:57], v[8:9]
  v_lshlrev_b32 v8, 16, v171
  v_and_b32 v9, 0xffff0000, v171
  v_pk_add_f32 v[58:59], v[58:59], v[8:9]
  v_lshlrev_b32 v8, 16, v172
  v_and_b32 v9, 0xffff0000, v172
  v_pk_add_f32 v[52:53], v[52:53], v[8:9]
  v_lshlrev_b32 v8, 16, v173
  v_and_b32 v9, 0xffff0000, v173
  v_pk_add_f32 v[54:55], v[54:55], v[8:9]
  v_lshlrev_b32 v8, 16, v174
  v_and_b32 v9, 0xffff0000, v174
  v_pk_add_f32 v[56:57], v[56:57], v[8:9]
  v_lshlrev_b32 v8, 16, v175
  v_and_b32 v9, 0xffff0000, v175
  v_pk_add_f32 v[58:59], v[58:59], v[8:9]
  v_cvt_pk_bf16_f32 v8, v52, v53
  v_lshlrev_b32 v52, 16, v8
  v_and_b32 v53, 0xffff0000, v8
  v_lshlrev_b32 v10, 16, v24
  v_and_b32 v11, 0xffff0000, v24
  v_pk_add_f32 v[52:53], v[52:53], v[10:11]
  v_cvt_pk_bf16_f32 v24, v52, v53
  v_lshlrev_b32 v52, 16, v24
  v_and_b32 v53, 0xffff0000, v24
  v_cvt_pk_bf16_f32 v8, v54, v55
  v_lshlrev_b32 v54, 16, v8
  v_and_b32 v55, 0xffff0000, v8
  v_lshlrev_b32 v10, 16, v25
  v_and_b32 v11, 0xffff0000, v25
  v_pk_add_f32 v[54:55], v[54:55], v[10:11]
  v_cvt_pk_bf16_f32 v25, v54, v55
  v_lshlrev_b32 v54, 16, v25
  v_and_b32 v55, 0xffff0000, v25
  v_cvt_pk_bf16_f32 v8, v56, v57
  v_lshlrev_b32 v56, 16, v8
  v_and_b32 v57, 0xffff0000, v8
  v_lshlrev_b32 v10, 16, v26
  v_and_b32 v11, 0xffff0000, v26
  v_pk_add_f32 v[56:57], v[56:57], v[10:11]
  v_cvt_pk_bf16_f32 v26, v56, v57
  v_lshlrev_b32 v56, 16, v26
  v_and_b32 v57, 0xffff0000, v26
  v_cvt_pk_bf16_f32 v8, v58, v59
  v_lshlrev_b32 v58, 16, v8
  v_and_b32 v59, 0xffff0000, v8
  v_lshlrev_b32 v10, 16, v27
  v_and_b32 v11, 0xffff0000, v27
  v_pk_add_f32 v[58:59], v[58:59], v[10:11]
  v_cvt_pk_bf16_f32 v27, v58, v59
  v_lshlrev_b32 v58, 16, v27
  v_and_b32 v59, 0xffff0000, v27
  buffer_store_dwordx4 v[24:27], v15, s[4:7], s21 offen offset:128 sc1
  s_waitcnt vmcnt(11)
  v_lshlrev_b32 v60, 16, v176
  v_and_b32 v61, 0xffff0000, v176
  v_lshlrev_b32 v62, 16, v177
  v_and_b32 v63, 0xffff0000, v177
  v_lshlrev_b32 v64, 16, v178
  v_and_b32 v65, 0xffff0000, v178
  v_lshlrev_b32 v66, 16, v179
  v_and_b32 v67, 0xffff0000, v179
  v_lshlrev_b32 v8, 16, v180
  v_and_b32 v9, 0xffff0000, v180
  v_pk_add_f32 v[60:61], v[60:61], v[8:9]
  v_lshlrev_b32 v8, 16, v181
  v_and_b32 v9, 0xffff0000, v181
  v_pk_add_f32 v[62:63], v[62:63], v[8:9]
  v_lshlrev_b32 v8, 16, v182
  v_and_b32 v9, 0xffff0000, v182
  v_pk_add_f32 v[64:65], v[64:65], v[8:9]
  v_lshlrev_b32 v8, 16, v183
  v_and_b32 v9, 0xffff0000, v183
  v_pk_add_f32 v[66:67], v[66:67], v[8:9]
  v_lshlrev_b32 v8, 16, v184
  v_and_b32 v9, 0xffff0000, v184
  v_pk_add_f32 v[60:61], v[60:61], v[8:9]
  v_lshlrev_b32 v8, 16, v185
  v_and_b32 v9, 0xffff0000, v185
  v_pk_add_f32 v[62:63], v[62:63], v[8:9]
  v_lshlrev_b32 v8, 16, v186
  v_and_b32 v9, 0xffff0000, v186
  v_pk_add_f32 v[64:65], v[64:65], v[8:9]
  v_lshlrev_b32 v8, 16, v187
  v_and_b32 v9, 0xffff0000, v187
  v_pk_add_f32 v[66:67], v[66:67], v[8:9]
  v_lshlrev_b32 v8, 16, v188
  v_and_b32 v9, 0xffff0000, v188
  v_pk_add_f32 v[60:61], v[60:61], v[8:9]
  v_lshlrev_b32 v8, 16, v189
  v_and_b32 v9, 0xffff0000, v189
  v_pk_add_f32 v[62:63], v[62:63], v[8:9]
  v_lshlrev_b32 v8, 16, v190
  v_and_b32 v9, 0xffff0000, v190
  v_pk_add_f32 v[64:65], v[64:65], v[8:9]
  v_lshlrev_b32 v8, 16, v191
  v_and_b32 v9, 0xffff0000, v191
  v_pk_add_f32 v[66:67], v[66:67], v[8:9]
  v_lshlrev_b32 v8, 16, v192
  v_and_b32 v9, 0xffff0000, v192
  v_pk_add_f32 v[60:61], v[60:61], v[8:9]
  v_lshlrev_b32 v8, 16, v193
  v_and_b32 v9, 0xffff0000, v193
  v_pk_add_f32 v[62:63], v[62:63], v[8:9]
  v_lshlrev_b32 v8, 16, v194
  v_and_b32 v9, 0xffff0000, v194
  v_pk_add_f32 v[64:65], v[64:65], v[8:9]
  v_lshlrev_b32 v8, 16, v195
  v_and_b32 v9, 0xffff0000, v195
  v_pk_add_f32 v[66:67], v[66:67], v[8:9]
  v_lshlrev_b32 v8, 16, v196
  v_and_b32 v9, 0xffff0000, v196
  v_pk_add_f32 v[60:61], v[60:61], v[8:9]
  v_lshlrev_b32 v8, 16, v197
  v_and_b32 v9, 0xffff0000, v197
  v_pk_add_f32 v[62:63], v[62:63], v[8:9]
  v_lshlrev_b32 v8, 16, v198
  v_and_b32 v9, 0xffff0000, v198
  v_pk_add_f32 v[64:65], v[64:65], v[8:9]
  v_lshlrev_b32 v8, 16, v199
  v_and_b32 v9, 0xffff0000, v199
  v_pk_add_f32 v[66:67], v[66:67], v[8:9]
  v_lshlrev_b32 v8, 16, v200
  v_and_b32 v9, 0xffff0000, v200
  v_pk_add_f32 v[60:61], v[60:61], v[8:9]
  v_lshlrev_b32 v8, 16, v201
  v_and_b32 v9, 0xffff0000, v201
  v_pk_add_f32 v[62:63], v[62:63], v[8:9]
  v_lshlrev_b32 v8, 16, v202
  v_and_b32 v9, 0xffff0000, v202
  v_pk_add_f32 v[64:65], v[64:65], v[8:9]
  v_lshlrev_b32 v8, 16, v203
  v_and_b32 v9, 0xffff0000, v203
  v_pk_add_f32 v[66:67], v[66:67], v[8:9]
  v_lshlrev_b32 v8, 16, v204
  v_and_b32 v9, 0xffff0000, v204
  v_pk_add_f32 v[60:61], v[60:61], v[8:9]
  v_lshlrev_b32 v8, 16, v205
  v_and_b32 v9, 0xffff0000, v205
  v_pk_add_f32 v[62:63], v[62:63], v[8:9]
  v_lshlrev_b32 v8, 16, v206
  v_and_b32 v9, 0xffff0000, v206
  v_pk_add_f32 v[64:65], v[64:65], v[8:9]
  v_lshlrev_b32 v8, 16, v207
  v_and_b32 v9, 0xffff0000, v207
  v_pk_add_f32 v[66:67], v[66:67], v[8:9]
  v_cvt_pk_bf16_f32 v8, v60, v61
  v_lshlrev_b32 v60, 16, v8
  v_and_b32 v61, 0xffff0000, v8
  v_lshlrev_b32 v10, 16, v28
  v_and_b32 v11, 0xffff0000, v28
  v_pk_add_f32 v[60:61], v[60:61], v[10:11]
  v_cvt_pk_bf16_f32 v28, v60, v61
  v_lshlrev_b32 v60, 16, v28
  v_and_b32 v61, 0xffff0000, v28
  v_cvt_pk_bf16_f32 v8, v62, v63
  v_lshlrev_b32 v62, 16, v8
  v_and_b32 v63, 0xffff0000, v8
  v_lshlrev_b32 v10, 16, v29
  v_and_b32 v11, 0xffff0000, v29
  v_pk_add_f32 v[62:63], v[62:63], v[10:11]
  v_cvt_pk_bf16_f32 v29, v62, v63
  v_lshlrev_b32 v62, 16, v29
  v_and_b32 v63, 0xffff0000, v29
  v_cvt_pk_bf16_f32 v8, v64, v65
  v_lshlrev_b32 v64, 16, v8
  v_and_b32 v65, 0xffff0000, v8
  v_lshlrev_b32 v10, 16, v30
  v_and_b32 v11, 0xffff0000, v30
  v_pk_add_f32 v[64:65], v[64:65], v[10:11]
  v_cvt_pk_bf16_f32 v30, v64, v65
  v_lshlrev_b32 v64, 16, v30
  v_and_b32 v65, 0xffff0000, v30
  v_cvt_pk_bf16_f32 v8, v66, v67
  v_lshlrev_b32 v66, 16, v8
  v_and_b32 v67, 0xffff0000, v8
  v_lshlrev_b32 v10, 16, v31
  v_and_b32 v11, 0xffff0000, v31
  v_pk_add_f32 v[66:67], v[66:67], v[10:11]
  v_cvt_pk_bf16_f32 v31, v66, v67
  v_lshlrev_b32 v66, 16, v31
  v_and_b32 v67, 0xffff0000, v31
  buffer_store_dwordx4 v[28:31], v15, s[4:7], s21 offen offset:192 sc1
  s_waitcnt vmcnt(4)
  v_lshlrev_b32 v68, 16, v208
  v_and_b32 v69, 0xffff0000, v208
  v_lshlrev_b32 v70, 16, v209
  v_and_b32 v71, 0xffff0000, v209
  v_lshlrev_b32 v72, 16, v210
  v_and_b32 v73, 0xffff0000, v210
  v_lshlrev_b32 v74, 16, v211
  v_and_b32 v75, 0xffff0000, v211
  v_lshlrev_b32 v8, 16, v212
  v_and_b32 v9, 0xffff0000, v212
  v_pk_add_f32 v[68:69], v[68:69], v[8:9]
  v_lshlrev_b32 v8, 16, v213
  v_and_b32 v9, 0xffff0000, v213
  v_pk_add_f32 v[70:71], v[70:71], v[8:9]
  v_lshlrev_b32 v8, 16, v214
  v_and_b32 v9, 0xffff0000, v214
  v_pk_add_f32 v[72:73], v[72:73], v[8:9]
  v_lshlrev_b32 v8, 16, v215
  v_and_b32 v9, 0xffff0000, v215
  v_pk_add_f32 v[74:75], v[74:75], v[8:9]
  v_lshlrev_b32 v8, 16, v216
  v_and_b32 v9, 0xffff0000, v216
  v_pk_add_f32 v[68:69], v[68:69], v[8:9]
  v_lshlrev_b32 v8, 16, v217
  v_and_b32 v9, 0xffff0000, v217
  v_pk_add_f32 v[70:71], v[70:71], v[8:9]
  v_lshlrev_b32 v8, 16, v218
  v_and_b32 v9, 0xffff0000, v218
  v_pk_add_f32 v[72:73], v[72:73], v[8:9]
  v_lshlrev_b32 v8, 16, v219
  v_and_b32 v9, 0xffff0000, v219
  v_pk_add_f32 v[74:75], v[74:75], v[8:9]
  v_lshlrev_b32 v8, 16, v220
  v_and_b32 v9, 0xffff0000, v220
  v_pk_add_f32 v[68:69], v[68:69], v[8:9]
  v_lshlrev_b32 v8, 16, v221
  v_and_b32 v9, 0xffff0000, v221
  v_pk_add_f32 v[70:71], v[70:71], v[8:9]
  v_lshlrev_b32 v8, 16, v222
  v_and_b32 v9, 0xffff0000, v222
  v_pk_add_f32 v[72:73], v[72:73], v[8:9]
  v_lshlrev_b32 v8, 16, v223
  v_and_b32 v9, 0xffff0000, v223
  v_pk_add_f32 v[74:75], v[74:75], v[8:9]
  v_lshlrev_b32 v8, 16, v224
  v_and_b32 v9, 0xffff0000, v224
  v_pk_add_f32 v[68:69], v[68:69], v[8:9]
  v_lshlrev_b32 v8, 16, v225
  v_and_b32 v9, 0xffff0000, v225
  v_pk_add_f32 v[70:71], v[70:71], v[8:9]
  v_lshlrev_b32 v8, 16, v226
  v_and_b32 v9, 0xffff0000, v226
  v_pk_add_f32 v[72:73], v[72:73], v[8:9]
  v_lshlrev_b32 v8, 16, v227
  v_and_b32 v9, 0xffff0000, v227
  v_pk_add_f32 v[74:75], v[74:75], v[8:9]
  v_lshlrev_b32 v8, 16, v228
  v_and_b32 v9, 0xffff0000, v228
  v_pk_add_f32 v[68:69], v[68:69], v[8:9]
  v_lshlrev_b32 v8, 16, v229
  v_and_b32 v9, 0xffff0000, v229
  v_pk_add_f32 v[70:71], v[70:71], v[8:9]
  v_lshlrev_b32 v8, 16, v230
  v_and_b32 v9, 0xffff0000, v230
  v_pk_add_f32 v[72:73], v[72:73], v[8:9]
  v_lshlrev_b32 v8, 16, v231
  v_and_b32 v9, 0xffff0000, v231
  v_pk_add_f32 v[74:75], v[74:75], v[8:9]
  v_lshlrev_b32 v8, 16, v232
  v_and_b32 v9, 0xffff0000, v232
  v_pk_add_f32 v[68:69], v[68:69], v[8:9]
  v_lshlrev_b32 v8, 16, v233
  v_and_b32 v9, 0xffff0000, v233
  v_pk_add_f32 v[70:71], v[70:71], v[8:9]
  v_lshlrev_b32 v8, 16, v234
  v_and_b32 v9, 0xffff0000, v234
  v_pk_add_f32 v[72:73], v[72:73], v[8:9]
  v_lshlrev_b32 v8, 16, v235
  v_and_b32 v9, 0xffff0000, v235
  v_pk_add_f32 v[74:75], v[74:75], v[8:9]
  v_lshlrev_b32 v8, 16, v236
  v_and_b32 v9, 0xffff0000, v236
  v_pk_add_f32 v[68:69], v[68:69], v[8:9]
  v_lshlrev_b32 v8, 16, v237
  v_and_b32 v9, 0xffff0000, v237
  v_pk_add_f32 v[70:71], v[70:71], v[8:9]
  v_lshlrev_b32 v8, 16, v238
  v_and_b32 v9, 0xffff0000, v238
  v_pk_add_f32 v[72:73], v[72:73], v[8:9]
  v_lshlrev_b32 v8, 16, v239
  v_and_b32 v9, 0xffff0000, v239
  v_pk_add_f32 v[74:75], v[74:75], v[8:9]
  v_cvt_pk_bf16_f32 v8, v68, v69
  v_lshlrev_b32 v68, 16, v8
  v_and_b32 v69, 0xffff0000, v8
  v_lshlrev_b32 v10, 16, v32
  v_and_b32 v11, 0xffff0000, v32
  v_pk_add_f32 v[68:69], v[68:69], v[10:11]
  v_cvt_pk_bf16_f32 v32, v68, v69
  v_lshlrev_b32 v68, 16, v32
  v_and_b32 v69, 0xffff0000, v32
  v_cvt_pk_bf16_f32 v8, v70, v71
  v_lshlrev_b32 v70, 16, v8
  v_and_b32 v71, 0xffff0000, v8
  v_lshlrev_b32 v10, 16, v33
  v_and_b32 v11, 0xffff0000, v33
  v_pk_add_f32 v[70:71], v[70:71], v[10:11]
  v_cvt_pk_bf16_f32 v33, v70, v71
  v_lshlrev_b32 v70, 16, v33
  v_and_b32 v71, 0xffff0000, v33
  v_cvt_pk_bf16_f32 v8, v72, v73
  v_lshlrev_b32 v72, 16, v8
  v_and_b32 v73, 0xffff0000, v8
  v_lshlrev_b32 v10, 16, v34
  v_and_b32 v11, 0xffff0000, v34
  v_pk_add_f32 v[72:73], v[72:73], v[10:11]
  v_cvt_pk_bf16_f32 v34, v72, v73
  v_lshlrev_b32 v72, 16, v34
  v_and_b32 v73, 0xffff0000, v34
  v_cvt_pk_bf16_f32 v8, v74, v75
  v_lshlrev_b32 v74, 16, v8
  v_and_b32 v75, 0xffff0000, v8
  v_lshlrev_b32 v10, 16, v35
  v_and_b32 v11, 0xffff0000, v35
  v_pk_add_f32 v[74:75], v[74:75], v[10:11]
  v_cvt_pk_bf16_f32 v35, v74, v75
  v_lshlrev_b32 v74, 16, v35
  v_and_b32 v75, 0xffff0000, v35
  buffer_store_dwordx4 v[32:35], v15, s[4:7], s21 offen offset:256 sc1
  v_and_b32 v3, 63, v0
  v_and_b32 v2, 15, v3
  v_lshlrev_b32 v5, 2, v2
  s_lshl_b32 s17, s16, 6
  v_add_u32 v1, s17, v5
  v_pk_add_f32 v[6:7], v[36:37], v[38:39]
  v_pk_add_f32 v[6:7], v[6:7], v[40:41]
  v_pk_add_f32 v[6:7], v[6:7], v[42:43]
  v_pk_add_f32 v[6:7], v[6:7], v[44:45]
  v_pk_add_f32 v[6:7], v[6:7], v[46:47]
  v_pk_add_f32 v[6:7], v[6:7], v[48:49]
  v_pk_add_f32 v[6:7], v[6:7], v[50:51]
  v_pk_add_f32 v[6:7], v[6:7], v[52:53]
  v_pk_add_f32 v[6:7], v[6:7], v[54:55]
  v_pk_add_f32 v[6:7], v[6:7], v[56:57]
  v_pk_add_f32 v[6:7], v[6:7], v[58:59]
  v_pk_add_f32 v[6:7], v[6:7], v[60:61]
  v_pk_add_f32 v[6:7], v[6:7], v[62:63]
  v_pk_add_f32 v[6:7], v[6:7], v[64:65]
  v_pk_add_f32 v[6:7], v[6:7], v[66:67]
  v_pk_add_f32 v[6:7], v[6:7], v[68:69]
  v_pk_add_f32 v[6:7], v[6:7], v[70:71]
  v_pk_add_f32 v[6:7], v[6:7], v[72:73]
  v_pk_add_f32 v[6:7], v[6:7], v[74:75]
  v_add_f32 v4, v6, v7
  v_mov_b32 v2, v4
  s_nop 1
  v_permlane32_swap_b32 v4, v2
  v_add_f32 v4, v4, v2
  v_mov_b32 v2, v4
  s_nop 1
  v_permlane16_swap_b32 v4, v2
  v_add_f32 v4, v4, v2
  ds_write_b32 v1, v4 offset:0
  s_waitcnt lgkmcnt(0)
  s_barrier
  ds_read_b32 v4, v5 offset:0
  ds_read_b32 v2, v5 offset:64
  ds_read_b32 v3, v5 offset:128
  ds_read_b32 v6, v5 offset:192
  s_waitcnt lgkmcnt(0)
  v_add_f32 v4, v4, v2
  v_add_f32 v3, v3, v6
  v_add_f32 v4, v4, v3
  v_mul_f32 v6, 0xbacccccd, v4
  v_mov_b32 v7, v6
  v_pk_add_f32 v[36:37], v[36:37], v[6:7]
  v_pk_add_f32 v[38:39], v[38:39], v[6:7]
  v_pk_add_f32 v[40:41], v[40:41], v[6:7]
  v_pk_add_f32 v[42:43], v[42:43], v[6:7]
  v_pk_add_f32 v[44:45], v[44:45], v[6:7]
  v_pk_add_f32 v[46:47], v[46:47], v[6:7]
  v_pk_add_f32 v[48:49], v[48:49], v[6:7]
  v_pk_add_f32 v[50:51], v[50:51], v[6:7]
  v_pk_add_f32 v[52:53], v[52:53], v[6:7]
  v_pk_add_f32 v[54:55], v[54:55], v[6:7]
  v_pk_add_f32 v[56:57], v[56:57], v[6:7]
  v_pk_add_f32 v[58:59], v[58:59], v[6:7]
  v_pk_add_f32 v[60:61], v[60:61], v[6:7]
  v_pk_add_f32 v[62:63], v[62:63], v[6:7]
  v_pk_add_f32 v[64:65], v[64:65], v[6:7]
  v_pk_add_f32 v[66:67], v[66:67], v[6:7]
  v_pk_add_f32 v[68:69], v[68:69], v[6:7]
  v_pk_add_f32 v[70:71], v[70:71], v[6:7]
  v_pk_add_f32 v[72:73], v[72:73], v[6:7]
  v_pk_add_f32 v[74:75], v[74:75], v[6:7]
  v_pk_mul_f32 v[6:7], v[36:37], v[36:37]
  v_pk_fma_f32 v[6:7], v[38:39], v[38:39], v[6:7]
  v_pk_fma_f32 v[6:7], v[40:41], v[40:41], v[6:7]
  v_pk_fma_f32 v[6:7], v[42:43], v[42:43], v[6:7]
  v_pk_fma_f32 v[6:7], v[44:45], v[44:45], v[6:7]
  v_pk_fma_f32 v[6:7], v[46:47], v[46:47], v[6:7]
  v_pk_fma_f32 v[6:7], v[48:49], v[48:49], v[6:7]
  v_pk_fma_f32 v[6:7], v[50:51], v[50:51], v[6:7]
  v_pk_fma_f32 v[6:7], v[52:53], v[52:53], v[6:7]
  v_pk_fma_f32 v[6:7], v[54:55], v[54:55], v[6:7]
  v_pk_fma_f32 v[6:7], v[56:57], v[56:57], v[6:7]
  v_pk_fma_f32 v[6:7], v[58:59], v[58:59], v[6:7]
  v_pk_fma_f32 v[6:7], v[60:61], v[60:61], v[6:7]
  v_pk_fma_f32 v[6:7], v[62:63], v[62:63], v[6:7]
  v_pk_fma_f32 v[6:7], v[64:65], v[64:65], v[6:7]
  v_pk_fma_f32 v[6:7], v[66:67], v[66:67], v[6:7]
  v_pk_fma_f32 v[6:7], v[68:69], v[68:69], v[6:7]
  v_pk_fma_f32 v[6:7], v[70:71], v[70:71], v[6:7]
  v_pk_fma_f32 v[6:7], v[72:73], v[72:73], v[6:7]
  v_pk_fma_f32 v[6:7], v[74:75], v[74:75], v[6:7]
  v_add_f32 v4, v6, v7
  v_mov_b32 v2, v4
  s_nop 1
  v_permlane32_swap_b32 v4, v2
  v_add_f32 v4, v4, v2
  v_mov_b32 v2, v4
  s_nop 1
  v_permlane16_swap_b32 v4, v2
  v_add_f32 v4, v4, v2
  ds_write_b32 v1, v4 offset:256
  s_waitcnt lgkmcnt(0)
  s_barrier
  ds_read_b32 v4, v5 offset:256
  ds_read_b32 v2, v5 offset:320
  ds_read_b32 v3, v5 offset:384
  ds_read_b32 v6, v5 offset:448
  s_waitcnt lgkmcnt(0)
  v_add_f32 v4, v4, v2
  v_add_f32 v3, v3, v6
  v_add_f32 v4, v4, v3
  v_mov_b32 v2, 0x3727c5ac
  v_fmac_f32 v2, 0x3acccccd, v4
  v_rsq_f32 v6, v2
  s_nop 0
  v_mov_b32 v7, v6
  v_pk_mul_f32 v[36:37], v[36:37], v[6:7]
  v_pk_mul_f32 v[38:39], v[38:39], v[6:7]
  v_pk_mul_f32 v[40:41], v[40:41], v[6:7]
  v_pk_mul_f32 v[42:43], v[42:43], v[6:7]
  v_pk_mul_f32 v[44:45], v[44:45], v[6:7]
  v_pk_mul_f32 v[46:47], v[46:47], v[6:7]
  v_pk_mul_f32 v[48:49], v[48:49], v[6:7]
  v_pk_mul_f32 v[50:51], v[50:51], v[6:7]
  v_pk_mul_f32 v[52:53], v[52:53], v[6:7]
  v_pk_mul_f32 v[54:55], v[54:55], v[6:7]
  v_pk_mul_f32 v[56:57], v[56:57], v[6:7]
  v_pk_mul_f32 v[58:59], v[58:59], v[6:7]
  v_pk_mul_f32 v[60:61], v[60:61], v[6:7]
  v_pk_mul_f32 v[62:63], v[62:63], v[6:7]
  v_pk_mul_f32 v[64:65], v[64:65], v[6:7]
  v_pk_mul_f32 v[66:67], v[66:67], v[6:7]
  v_pk_mul_f32 v[68:69], v[68:69], v[6:7]
  v_pk_mul_f32 v[70:71], v[70:71], v[6:7]
  v_pk_mul_f32 v[72:73], v[72:73], v[6:7]
  v_pk_mul_f32 v[74:75], v[74:75], v[6:7]
  v_cvt_pk_bf16_f32 v16, v36, v37
  v_cvt_pk_bf16_f32 v17, v38, v39
  v_cvt_pk_bf16_f32 v18, v40, v41
  v_cvt_pk_bf16_f32 v19, v42, v43
  v_cvt_pk_bf16_f32 v20, v44, v45
  v_cvt_pk_bf16_f32 v21, v46, v47
  v_cvt_pk_bf16_f32 v22, v48, v49
  v_cvt_pk_bf16_f32 v23, v50, v51
  v_cvt_pk_bf16_f32 v24, v52, v53
  v_cvt_pk_bf16_f32 v25, v54, v55
  v_cvt_pk_bf16_f32 v26, v56, v57
  v_cvt_pk_bf16_f32 v27, v58, v59
  v_cvt_pk_bf16_f32 v28, v60, v61
  v_cvt_pk_bf16_f32 v29, v62, v63
  v_cvt_pk_bf16_f32 v30, v64, v65
  v_cvt_pk_bf16_f32 v31, v66, v67
  v_cvt_pk_bf16_f32 v32, v68, v69
  v_cvt_pk_bf16_f32 v33, v70, v71
  v_cvt_pk_bf16_f32 v34, v72, v73
  v_cvt_pk_bf16_f32 v35, v74, v75
  v_and_b32 v3, 63, v0
  v_and_b32 v2, 15, v3
  v_lshlrev_b32 v1, 4, v2
  v_bfe_u32 v2, v3, 4, 1
  v_lshl_add_u32 v1, v2, 9, v1
  v_lshrrev_b32 v2, 5, v3
  v_lshl_add_u32 v1, v2, 10, v1
  s_lshr_b32 s17, s19, 1
  s_mul_i32 s17, s17, 40960
  s_and_b32 s18, s19, 1
  s_lshl_b32 s18, s18, 8
  s_add_u32 s17, s17, s18
  s_mul_i32 s18, s16, 10240
  s_add_u32 s17, s17, s18
  s_add_u32 s17, s17, 54525952
  buffer_store_dwordx4 v[16:19], v1, s[4:7], s17 offen offset:0 sc1
  buffer_store_dwordx4 v[20:23], v1, s[4:7], s17 offen offset:2048 sc1
  s_add_u32 s17, s17, 4096
  buffer_store_dwordx4 v[24:27], v1, s[4:7], s17 offen offset:0 sc1
  buffer_store_dwordx4 v[28:31], v1, s[4:7], s17 offen offset:2048 sc1
  s_add_u32 s17, s17, 4096
  buffer_store_dwordx4 v[32:35], v1, s[4:7], s17 offen offset:0 sc1
redln2_exit1:
  s_endpgm
.globl qkvb_kernel
.p2align 8
.type qkvb_kernel,@function
qkvb_kernel:
  s_cmp_ge_u32 s2, 256
  s_cbranch_scc1 qkvb_exit1
  s_load_dwordx2 s[12:13], s[0:1], 96
  v_lshrrev_b32 v2, 6, v0
  v_and_b32 v3, 63, v0
  s_nop 0
  v_readfirstlane_b32 s16, v2
  v_lshlrev_b32 v8, 4, v3
  s_and_b32 s17, s2, 7
  s_lshr_b32 s18, s2, 3
  s_waitcnt lgkmcnt(0)
  s_mov_b32 s4, s12
  s_mov_b32 s5, s13
  s_mov_b32 s6, 0x10000000
  s_mov_b32 s7, 0x20000
  s_and_b32 s19, s16, 1
  s_lshr_b32 s20, s16, 1
  s_mul_i32 s22, s19, 40960
  s_mul_i32 s21, s20, 5120
  s_add_u32 s22, s22, s21
  s_mul_i32 s21, s18, 81920
  s_add_u32 s21, s21, s22
  s_add_u32 s21, s21, 54525952
  s_lshl_b32 s23, s17, 2
  s_add_u32 s23, s23, s16
  s_mul_i32 s24, s23, 40960
  s_add_u32 s24, s24, 87556096
  s_add_u32 s25, s24, 1310720
  s_add_u32 s26, s25, 1310720
  s_add_u32 m0, s22, 0
  s_add_u32 s27, s21, 0
  buffer_load_dwordx4 v8, s[4:7], s27 offen offset:0 lds
  buffer_load_dwordx4 v8, s[4:7], s27 offen offset:1024 lds
  buffer_load_dwordx4 v8, s[4:7], s27 offen offset:2048 lds
  buffer_load_dwordx4 v8, s[4:7], s27 offen offset:3072 lds
  s_add_u32 m0, s22, 4096
  s_add_u32 s27, s21, 4096
  buffer_load_dwordx4 v8, s[4:7], s27 offen lds
  buffer_load_dwordx4 a[0:3], v8, s[4:7], s24 offen offset:0
  buffer_load_dwordx4 a[4:7], v8, s[4:7], s25 offen offset:0
  buffer_load_dwordx4 a[8:11], v8, s[4:7], s26 offen offset:0
  buffer_load_dwordx4 a[12:15], v8, s[4:7], s24 offen offset:1024
  buffer_load_dwordx4 a[16:19], v8, s[4:7], s25 offen offset:1024
  buffer_load_dwordx4 a[20:23], v8, s[4:7], s26 offen offset:1024
  buffer_load_dwordx4 a[24:27], v8, s[4:7], s24 offen offset:2048
  buffer_load_dwordx4 a[28:31], v8, s[4:7], s25 offen offset:2048
  buffer_load_dwordx4 a[32:35], v8, s[4:7], s26 offen offset:2048
  buffer_load_dwordx4 a[36:39], v8, s[4:7], s24 offen offset:3072
  buffer_load_dwordx4 a[40:43], v8, s[4:7], s25 offen offset:3072
  buffer_load_dwordx4 a[44:47], v8, s[4:7], s26 offen offset:3072
  s_add_u32 s24, s24, 4096
  s_add_u32 s25, s25, 4096
  s_add_u32 s26, s26, 4096
  s_add_u32 m0, s22, 10240
  s_add_u32 s27, s21, 10240
  buffer_load_dwordx4 v8, s[4:7], s27 offen offset:0 lds
  buffer_load_dwordx4 v8, s[4:7], s27 offen offset:1024 lds
  buffer_load_dwordx4 v8, s[4:7], s27 offen offset:2048 lds
  buffer_load_dwordx4 v8, s[4:7], s27 offen offset:3072 lds
  s_add_u32 m0, s22, 14336
  s_add_u32 s27, s21, 14336
  buffer_load_dwordx4 v8, s[4:7], s27 offen lds
  buffer_load_dwordx4 a[48:51], v8, s[4:7], s24 offen offset:0
  buffer_load_dwordx4 a[52:55], v8, s[4:7], s25 offen offset:0
  buffer_load_dwordx4 a[56:59], v8, s[4:7], s26 offen offset:0
  buffer_load_dwordx4 a[60:63], v8, s[4:7], s24 offen offset:1024
  buffer_load_dwordx4 a[64:67], v8, s[4:7], s25 offen offset:1024
  buffer_load_dwordx4 a[68:71], v8, s[4:7], s26 offen offset:1024
  buffer_load_dwordx4 a[72:75], v8, s[4:7], s24 offen offset:2048
  buffer_load_dwordx4 a[76:79], v8, s[4:7], s25 offen offset:2048
  buffer_load_dwordx4 a[80:83], v8, s[4:7], s26 offen offset:2048
  buffer_load_dwordx4 a[84:87], v8, s[4:7], s24 offen offset:3072
  buffer_load_dwordx4 a[88:91], v8, s[4:7], s25 offen offset:3072
  buffer_load_dwordx4 a[92:95], v8, s[4:7], s26 offen offset:3072
  s_add_u32 s24, s24, 4096
  s_add_u32 s25, s25, 4096
  s_add_u32 s26, s26, 4096
  s_add_u32 m0, s22, 20480
  s_add_u32 s27, s21, 20480
  buffer_load_dwordx4 v8, s[4:7], s27 offen offset:0 lds
  buffer_load_dwordx4 v8, s[4:7], s27 offen offset:1024 lds
  buffer_load_dwordx4 v8, s[4:7], s27 offen offset:2048 lds
  buffer_load_dwordx4 v8, s[4:7], s27 offen offset:3072 lds
  s_add_u32 m0, s22, 24576
  s_add_u32 s27, s21, 24576
  buffer_load_dwordx4 v8, s[4:7], s27 offen lds
  s_add_u32 m0, s22, 30720
  s_add_u32 s27, s21, 30720
  buffer_load_dwordx4 v8, s[4:7], s27 offen offset:0 lds
  buffer_load_dwordx4 v8, s[4:7], s27 offen offset:1024 lds
  buffer_load_dwordx4 v8, s[4:7], s27 offen offset:2048 lds
  buffer_load_dwordx4 v8, s[4:7], s27 offen offset:3072 lds
  s_add_u32 m0, s22, 34816
  s_add_u32 s27, s21, 34816
  buffer_load_dwordx4 v8, s[4:7], s27 offen lds
  v_add_u32 v9, 40960, v8
  s_waitcnt vmcnt(39)
  s_barrier
  ds_read_b128 v[16:19], v8 offset:0
  ds_read_b128 v[20:23], v9 offset:0
  ds_read_b128 v[24:27], v8 offset:1024
  ds_read_b128 v[28:31], v9 offset:1024
  buffer_load_dwordx4 a[96:99], v8, s[4:7], s24 offen offset:0
  buffer_load_dwordx4 a[100:103], v8, s[4:7], s25 offen offset:0
  buffer_load_dwordx4 a[104:107], v8, s[4:7], s26 offen offset:0
  buffer_load_dwordx4 a[108:111], v8, s[4:7], s24 offen offset:1024
  buffer_load_dwordx4 a[112:115], v8, s[4:7], s25 offen offset:1024
  buffer_load_dwordx4 a[116:119], v8, s[4:7], s26 offen offset:1024
  buffer_load_dwordx4 a[120:123], v8, s[4:7], s24 offen offset:2048
  buffer_load_dwordx4 a[124:127], v8, s[4:7], s25 offen offset:2048
  buffer_load_dwordx4 a[128:131], v8, s[4:7], s26 offen offset:2048
  buffer_load_dwordx4 a[132:135], v8, s[4:7], s24 offen offset:3072
  buffer_load_dwordx4 a[136:139], v8, s[4:7], s25 offen offset:3072
  buffer_load_dwordx4 a[140:143], v8, s[4:7], s26 offen offset:3072
  s_add_u32 s24, s24, 4096
  s_add_u32 s25, s25, 4096
  s_add_u32 s26, s26, 4096
  buffer_load_dwordx4 a[144:147], v8, s[4:7], s24 offen offset:0
  buffer_load_dwordx4 a[148:151], v8, s[4:7], s25 offen offset:0
  buffer_load_dwordx4 a[152:155], v8, s[4:7], s26 offen offset:0
  s_waitcnt vmcnt(51)
  ds_read_b128 v[32:35], v8 offset:2048
  ds_read_b128 v[36:39], v9 offset:2048
  s_waitcnt lgkmcnt(4)
  v_mfma_f32_32x32x16_bf16 v[96:111], a[0:3], v[16:19], 0
  v_mfma_f32_32x32x16_bf16 v[112:127], a[0:3], v[20:23], 0
  v_mfma_f32_32x32x16_bf16 v[128:143], a[4:7], v[16:19], 0
  v_mfma_f32_32x32x16_bf16 v[144:159], a[4:7], v[20:23], 0
  v_mfma_f32_32x32x16_bf16 v[160:175], v[16:19], a[8:11], 0
  v_mfma_f32_32x32x16_bf16 v[176:191], v[20:23], a[8:11], 0
  buffer_load_dwordx4 a[156:159], v8, s[4:7], s24 offen offset:1024
  buffer_load_dwordx4 a[160:163], v8, s[4:7], s25 offen offset:1024
  buffer_load_dwordx4 a[164:167], v8, s[4:7], s26 offen offset:1024
  s_waitcnt vmcnt(51)
  ds_read_b128 v[16:19], v8 offset:3072
  ds_read_b128 v[20:23], v9 offset:3072
  s_waitcnt lgkmcnt(4)
  v_mfma_f32_32x32x16_bf16 v[96:111], a[12:15], v[24:27], v[96:111]
  v_mfma_f32_32x32x16_bf16 v[112:127], a[12:15], v[28:31], v[112:127]
  v_mfma_f32_32x32x16_bf16 v[128:143], a[16:19], v[24:27], v[128:143]
  v_mfma_f32_32x32x16_bf16 v[144:159], a[16:19], v[28:31], v[144:159]
  v_mfma_f32_32x32x16_bf16 v[160:175], v[24:27], a[20:23], v[160:175]
  v_mfma_f32_32x32x16_bf16 v[176:191], v[28:31], a[20:23], v[176:191]
  buffer_load_dwordx4 a[168:171], v8, s[4:7], s24 offen offset:2048
  buffer_load_dwordx4 a[172:175], v8, s[4:7], s25 offen offset:2048
  buffer_load_dwordx4 a[176:179], v8, s[4:7], s26 offen offset:2048
  s_waitcnt vmcnt(51)
  ds_read_b128 v[24:27], v8 offset:4096
  ds_read_b128 v[28:31], v9 offset:4096
  s_waitcnt lgkmcnt(4)
  v_mfma_f32_32x32x16_bf16 v[96:111], a[24:27], v[32:35], v[96:111]
  v_mfma_f32_32x32x16_bf16 v[112:127], a[24:27], v[36:39], v[112:127]
  v_mfma_f32_32x32x16_bf16 v[128:143], a[28:31], v[32:35], v[128:143]
  v_mfma_f32_32x32x16_bf16 v[144:159], a[28:31], v[36:39], v[144:159]
  v_mfma_f32_32x32x16_bf16 v[160:175], v[32:35], a[32:35], v[160:175]
  v_mfma_f32_32x32x16_bf16 v[176:191], v[36:39], a[32:35], v[176:191]
  buffer_load_dwordx4 a[180:183], v8, s[4:7], s24 offen offset:3072
  buffer_load_dwordx4 a[184:187], v8, s[4:7], s25 offen offset:3072
  buffer_load_dwordx4 a[188:191], v8, s[4:7], s26 offen offset:3072
  s_add_u32 s24, s24, 4096
  s_add_u32 s25, s25, 4096
  s_add_u32 s26, s26, 4096
  s_waitcnt vmcnt(51)
  ds_read_b128 v[32:35], v8 offset:5120
  ds_read_b128 v[36:39], v9 offset:5120
  s_waitcnt lgkmcnt(4)
  v_mfma_f32_32x32x16_bf16 v[96:111], a[36:39], v[16:19], v[96:111]
  v_mfma_f32_32x32x16_bf16 v[112:127], a[36:39], v[20:23], v[112:127]
  v_mfma_f32_32x32x16_bf16 v[128:143], a[40:43], v[16:19], v[128:143]
  v_mfma_f32_32x32x16_bf16 v[144:159], a[40:43], v[20:23], v[144:159]
  v_mfma_f32_32x32x16_bf16 v[160:175], v[16:19], a[44:47], v[160:175]
  v_mfma_f32_32x32x16_bf16 v[176:191], v[20:23], a[44:47], v[176:191]
  buffer_load_dwordx4 a[0:3], v8, s[4:7], s24 offen offset:0
  buffer_load_dwordx4 a[4:7], v8, s[4:7], s25 offen offset:0
  buffer_load_dwordx4 a[8:11], v8, s[4:7], s26 offen offset:0
  s_waitcnt vmcnt(46)
  ds_read_b128 v[16:19], v8 offset:6144
  ds_read_b128 v[20:23], v9 offset:6144
  s_waitcnt lgkmcnt(4)
  v_mfma_f32_32x32x16_bf16 v[96:111], a[48:51], v[24:27], v[96:111]
  v_mfma_f32_32x32x16_bf16 v[112:127], a[48:51], v[28:31], v[112:127]
  v_mfma_f32_32x32x16_bf16 v[128:143], a[52:55], v[24:27], v[128:143]
  v_mfma_f32_32x32x16_bf16 v[144:159], a[52:55], v[28:31], v[144:159]
  v_mfma_f32_32x32x16_bf16 v[160:175], v[24:27], a[56:59], v[160:175]
  v_mfma_f32_32x32x16_bf16 v[176:191], v[28:31], a[56:59], v[176:191]
  buffer_load_dwordx4 a[12:15], v8, s[4:7], s24 offen offset:1024
  buffer_load_dwordx4 a[16:19], v8, s[4:7], s25 offen offset:1024
  buffer_load_dwordx4 a[20:23], v8, s[4:7], s26 offen offset:1024
  s_waitcnt vmcnt(46)
  ds_read_b128 v[24:27], v8 offset:7168
  ds_read_b128 v[28:31], v9 offset:7168
  s_waitcnt lgkmcnt(4)
  v_mfma_f32_32x32x16_bf16 v[96:111], a[60:63], v[32:35], v[96:111]
  v_mfma_f32_32x32x16_bf16 v[112:127], a[60:63], v[36:39], v[112:127]
  v_mfma_f32_32x32x16_bf16 v[128:143], a[64:67], v[32:35], v[128:143]
  v_mfma_f32_32x32x16_bf16 v[144:159], a[64:67], v[36:39], v[144:159]
  v_mfma_f32_32x32x16_bf16 v[160:175], v[32:35], a[68:71], v[160:175]
  v_mfma_f32_32x32x16_bf16 v[176:191], v[36:39], a[68:71], v[176:191]
  buffer_load_dwordx4 a[24:27], v8, s[4:7], s24 offen offset:2048
  buffer_load_dwordx4 a[28:31], v8, s[4:7], s25 offen offset:2048
  buffer_load_dwordx4 a[32:35], v8, s[4:7], s26 offen offset:2048
  s_waitcnt vmcnt(46)
  ds_read_b128 v[32:35], v8 offset:8192
  ds_read_b128 v[36:39], v9 offset:8192
  s_waitcnt lgkmcnt(4)
  v_mfma_f32_32x32x16_bf16 v[96:111], a[72:75], v[16:19], v[96:111]
  v_mfma_f32_32x32x16_bf16 v[112:127], a[72:75], v[20:23], v[112:127]
  v_mfma_f32_32x32x16_bf16 v[128:143], a[76:79], v[16:19], v[128:143]
  v_mfma_f32_32x32x16_bf16 v[144:159], a[76:79], v[20:23], v[144:159]
  v_mfma_f32_32x32x16_bf16 v[160:175], v[16:19], a[80:83], v[160:175]
  v_mfma_f32_32x32x16_bf16 v[176:191], v[20:23], a[80:83], v[176:191]
  buffer_load_dwordx4 a[36:39], v8, s[4:7], s24 offen offset:3072
  buffer_load_dwordx4 a[40:43], v8, s[4:7], s25 offen offset:3072
  buffer_load_dwordx4 a[44:47], v8, s[4:7], s26 offen offset:3072
  s_add_u32 s24, s24, 4096
  s_add_u32 s25, s25, 4096
  s_add_u32 s26, s26, 4096
  s_waitcnt vmcnt(46)
  ds_read_b128 v[16:19], v8 offset:9216
  ds_read_b128 v[20:23], v9 offset:9216
  s_waitcnt lgkmcnt(4)
  v_mfma_f32_32x32x16_bf16 v[96:111], a[84:87], v[24:27], v[96:111]
  v_mfma_f32_32x32x16_bf16 v[112:127], a[84:87], v[28:31], v[112:127]
  v_mfma_f32_32x32x16_bf16 v[128:143], a[88:91], v[24:27], v[128:143]
  v_mfma_f32_32x32x16_bf16 v[144:159], a[88:91], v[28:31], v[144:159]
  v_mfma_f32_32x32x16_bf16 v[160:175], v[24:27], a[92:95], v[160:175]
  v_mfma_f32_32x32x16_bf16 v[176:191], v[28:31], a[92:95], v[176:191]
  buffer_load_dwordx4 a[48:51], v8, s[4:7], s24 offen offset:0
  buffer_load_dwordx4 a[52:55], v8, s[4:7], s25 offen offset:0
  buffer_load_dwordx4 a[56:59], v8, s[4:7], s26 offen offset:0
  s_waitcnt vmcnt(61)
  s_barrier
  s_waitcnt vmcnt(36)
  ds_read_b128 v[24:27], v8 offset:10240
  ds_read_b128 v[28:31], v9 offset:10240
  s_waitcnt lgkmcnt(4)
  v_mfma_f32_32x32x16_bf16 v[96:111], a[96:99], v[32:35], v[96:111]
  v_mfma_f32_32x32x16_bf16 v[112:127], a[96:99], v[36:39], v[112:127]
  v_mfma_f32_32x32x16_bf16 v[128:143], a[100:103], v[32:35], v[128:143]
  v_mfma_f32_32x32x16_bf16 v[144:159], a[100:103], v[36:39], v[144:159]
  v_mfma_f32_32x32x16_bf16 v[160:175], v[32:35], a[104:107], v[160:175]
  v_mfma_f32_32x32x16_bf16 v[176:191], v[36:39], a[104:107], v[176:191]
  buffer_load_dwordx4 a[60:63], v8, s[4:7], s24 offen offset:1024
  buffer_load_dwordx4 a[64:67], v8, s[4:7], s25 offen offset:1024
  buffer_load_dwordx4 a[68:71], v8, s[4:7], s26 offen offset:1024
  s_waitcnt vmcnt(36)
  ds_read_b128 v[32:35], v8 offset:11264
  ds_read_b128 v[36:39], v9 offset:11264
  s_waitcnt lgkmcnt(4)
  v_mfma_f32_32x32x16_bf16 v[96:111], a[108:111], v[16:19], v[96:111]
  v_mfma_f32_32x32x16_bf16 v[112:127], a[108:111], v[20:23], v[112:127]
  v_mfma_f32_32x32x16_bf16 v[128:143], a[112:115], v[16:19], v[128:143]
  v_mfma_f32_32x32x16_bf16 v[144:159], a[112:115], v[20:23], v[144:159]
  v_mfma_f32_32x32x16_bf16 v[160:175], v[16:19], a[116:119], v[160:175]
  v_mfma_f32_32x32x16_bf16 v[176:191], v[20:23], a[116:119], v[176:191]
  buffer_load_dwordx4 a[72:75], v8, s[4:7], s24 offen offset:2048
  buffer_load_dwordx4 a[76:79], v8, s[4:7], s25 offen offset:2048
  buffer_load_dwordx4 a[80:83], v8, s[4:7], s26 offen offset:2048
  s_waitcnt vmcnt(36)
  ds_read_b128 v[16:19], v8 offset:12288
  ds_read_b128 v[20:23], v9 offset:12288
  s_waitcnt lgkmcnt(4)
  v_mfma_f32_32x32x16_bf16 v[96:111], a[120:123], v[24:27], v[96:111]
  v_mfma_f32_32x32x16_bf16 v[112:127], a[120:123], v[28:31], v[112:127]
  v_mfma_f32_32x32x16_bf16 v[128:143], a[124:127], v[24:27], v[128:143]
  v_mfma_f32_32x32x16_bf16 v[144:159], a[124:127], v[28:31], v[144:159]
  v_mfma_f32_32x32x16_bf16 v[160:175], v[24:27], a[128:131], v[160:175]
  v_mfma_f32_32x32x16_bf16 v[176:191], v[28:31], a[128:131], v[176:191]
  buffer_load_dwordx4 a[84:87], v8, s[4:7], s24 offen offset:3072
  buffer_load_dwordx4 a[88:91], v8, s[4:7], s25 offen offset:3072
  buffer_load_dwordx4 a[92:95], v8, s[4:7], s26 offen offset:3072
  s_add_u32 s24, s24, 4096
  s_add_u32 s25, s25, 4096
  s_add_u32 s26, s26, 4096
  s_waitcnt vmcnt(36)
  ds_read_b128 v[24:27], v8 offset:13312
  ds_read_b128 v[28:31], v9 offset:13312
  s_waitcnt lgkmcnt(4)
  v_mfma_f32_32x32x16_bf16 v[96:111], a[132:135], v[32:35], v[96:111]
  v_mfma_f32_32x32x16_bf16 v[112:127], a[132:135], v[36:39], v[112:127]
  v_mfma_f32_32x32x16_bf16 v[128:143], a[136:139], v[32:35], v[128:143]
  v_mfma_f32_32x32x16_bf16 v[144:159], a[136:139], v[36:39], v[144:159]
  v_mfma_f32_32x32x16_bf16 v[160:175], v[32:35], a[140:143], v[160:175]
  v_mfma_f32_32x32x16_bf16 v[176:191], v[36:39], a[140:143], v[176:191]
  buffer_load_dwordx4 a[96:99], v8, s[4:7], s24 offen offset:0
  buffer_load_dwordx4 a[100:103], v8, s[4:7], s25 offen offset:0
  buffer_load_dwordx4 a[104:107], v8, s[4:7], s26 offen offset:0
  s_waitcnt vmcnt(36)
  ds_read_b128 v[32:35], v8 offset:14336
  ds_read_b128 v[36:39], v9 offset:14336
  s_waitcnt lgkmcnt(4)
  v_mfma_f32_32x32x16_bf16 v[96:111], a[144:147], v[16:19], v[96:111]
  v_mfma_f32_32x32x16_bf16 v[112:127], a[144:147], v[20:23], v[112:127]
  v_mfma_f32_32x32x16_bf16 v[128:143], a[148:151], v[16:19], v[128:143]
  v_mfma_f32_32x32x16_bf16 v[144:159], a[148:151], v[20:23], v[144:159]
  v_mfma_f32_32x32x16_bf16 v[160:175], v[16:19], a[152:155], v[160:175]
  v_mfma_f32_32x32x16_bf16 v[176:191], v[20:23], a[152:155], v[176:191]
  buffer_load_dwordx4 a[108:111], v8, s[4:7], s24 offen offset:1024
  buffer_load_dwordx4 a[112:115], v8, s[4:7], s25 offen offset:1024
  buffer_load_dwordx4 a[116:119], v8, s[4:7], s26 offen offset:1024
  s_waitcnt vmcnt(36)
  ds_read_b128 v[16:19], v8 offset:15360
  ds_read_b128 v[20:23], v9 offset:15360
  s_waitcnt lgkmcnt(4)
  v_mfma_f32_32x32x16_bf16 v[96:111], a[156:159], v[24:27], v[96:111]
  v_mfma_f32_32x32x16_bf16 v[112:127], a[156:159], v[28:31], v[112:127]
  v_mfma_f32_32x32x16_bf16 v[128:143], a[160:163], v[24:27], v[128:143]
  v_mfma_f32_32x32x16_bf16 v[144:159], a[160:163], v[28:31], v[144:159]
  v_mfma_f32_32x32x16_bf16 v[160:175], v[24:27], a[164:167], v[160:175]
  v_mfma_f32_32x32x16_bf16 v[176:191], v[28:31], a[164:167], v[176:191]
  buffer_load_dwordx4 a[120:123], v8, s[4:7], s24 offen offset:2048
  buffer_load_dwordx4 a[124:127], v8, s[4:7], s25 offen offset:2048
  buffer_load_dwordx4 a[128:131], v8, s[4:7], s26 offen offset:2048
  s_waitcnt vmcnt(36)
  ds_read_b128 v[24:27], v8 offset:16384
  ds_read_b128 v[28:31], v9 offset:16384
  s_waitcnt lgkmcnt(4)
  v_mfma_f32_32x32x16_bf16 v[96:111], a[168:171], v[32:35], v[96:111]
  v_mfma_f32_32x32x16_bf16 v[112:127], a[168:171], v[36:39], v[112:127]
  v_mfma_f32_32x32x16_bf16 v[128:143], a[172:175], v[32:35], v[128:143]
  v_mfma_f32_32x32x16_bf16 v[144:159], a[172:175], v[36:39], v[144:159]
  v_mfma_f32_32x32x16_bf16 v[160:175], v[32:35], a[176:179], v[160:175]
  v_mfma_f32_32x32x16_bf16 v[176:191], v[36:39], a[176:179], v[176:191]
  buffer_load_dwordx4 a[132:135], v8, s[4:7], s24 offen offset:3072
  buffer_load_dwordx4 a[136:139], v8, s[4:7], s25 offen offset:3072
  buffer_load_dwordx4 a[140:143], v8, s[4:7], s26 offen offset:3072
  s_add_u32 s24, s24, 4096
  s_add_u32 s25, s25, 4096
  s_add_u32 s26, s26, 4096
  s_waitcnt vmcnt(36)
  ds_read_b128 v[32:35], v8 offset:17408
  ds_read_b128 v[36:39], v9 offset:17408
  s_waitcnt lgkmcnt(4)
  v_mfma_f32_32x32x16_bf16 v[96:111], a[180:183], v[16:19], v[96:111]
  v_mfma_f32_32x32x16_bf16 v[112:127], a[180:183], v[20:23], v[112:127]
  v_mfma_f32_32x32x16_bf16 v[128:143], a[184:187], v[16:19], v[128:143]
  v_mfma_f32_32x32x16_bf16 v[144:159], a[184:187], v[20:23], v[144:159]
  v_mfma_f32_32x32x16_bf16 v[160:175], v[16:19], a[188:191], v[160:175]
  v_mfma_f32_32x32x16_bf16 v[176:191], v[20:23], a[188:191], v[176:191]
  buffer_load_dwordx4 a[144:147], v8, s[4:7], s24 offen offset:0
  buffer_load_dwordx4 a[148:151], v8, s[4:7], s25 offen offset:0
  buffer_load_dwordx4 a[152:155], v8, s[4:7], s26 offen offset:0
  s_waitcnt vmcnt(36)
  ds_read_b128 v[16:19], v8 offset:18432
  ds_read_b128 v[20:23], v9 offset:18432
  s_waitcnt lgkmcnt(4)
  v_mfma_f32_32x32x16_bf16 v[96:111], a[0:3], v[24:27], v[96:111]
  v_mfma_f32_32x32x16_bf16 v[112:127], a[0:3], v[28:31], v[112:127]
  v_mfma_f32_32x32x16_bf16 v[128:143], a[4:7], v[24:27], v[128:143]
  v_mfma_f32_32x32x16_bf16 v[144:159], a[4:7], v[28:31], v[144:159]
  v_mfma_f32_32x32x16_bf16 v[160:175], v[24:27], a[8:11], v[160:175]
  v_mfma_f32_32x32x16_bf16 v[176:191], v[28:31], a[8:11], v[176:191]
  buffer_load_dwordx4 a[156:159], v8, s[4:7], s24 offen offset:1024
  buffer_load_dwordx4 a[160:163], v8, s[4:7], s25 offen offset:1024
  buffer_load_dwordx4 a[164:167], v8, s[4:7], s26 offen offset:1024
  s_waitcnt vmcnt(36)
  ds_read_b128 v[24:27], v8 offset:19456
  ds_read_b128 v[28:31], v9 offset:19456
  s_waitcnt lgkmcnt(4)
  v_mfma_f32_32x32x16_bf16 v[96:111], a[12:15], v[32:35], v[96:111]
  v_mfma_f32_32x32x16_bf16 v[112:127], a[12:15], v[36:39], v[112:127]
  v_mfma_f32_32x32x16_bf16 v[128:143], a[16:19], v[32:35], v[128:143]
  v_mfma_f32_32x32x16_bf16 v[144:159], a[16:19], v[36:39], v[144:159]
  v_mfma_f32_32x32x16_bf16 v[160:175], v[32:35], a[20:23], v[160:175]
  v_mfma_f32_32x32x16_bf16 v[176:191], v[36:39], a[20:23], v[176:191]
  buffer_load_dwordx4 a[168:171], v8, s[4:7], s24 offen offset:2048
  buffer_load_dwordx4 a[172:175], v8, s[4:7], s25 offen offset:2048
  buffer_load_dwordx4 a[176:179], v8, s[4:7], s26 offen offset:2048
  s_waitcnt vmcnt(63)
  s_barrier
  s_waitcnt vmcnt(36)
  ds_read_b128 v[32:35], v8 offset:20480
  ds_read_b128 v[36:39], v9 offset:20480
  s_waitcnt lgkmcnt(4)
  v_mfma_f32_32x32x16_bf16 v[96:111], a[24:27], v[16:19], v[96:111]
  v_mfma_f32_32x32x16_bf16 v[112:127], a[24:27], v[20:23], v[112:127]
  v_mfma_f32_32x32x16_bf16 v[128:143], a[28:31], v[16:19], v[128:143]
  v_mfma_f32_32x32x16_bf16 v[144:159], a[28:31], v[20:23], v[144:159]
  v_mfma_f32_32x32x16_bf16 v[160:175], v[16:19], a[32:35], v[160:175]
  v_mfma_f32_32x32x16_bf16 v[176:191], v[20:23], a[32:35], v[176:191]
  buffer_load_dwordx4 a[180:183], v8, s[4:7], s24 offen offset:3072
  buffer_load_dwordx4 a[184:187], v8, s[4:7], s25 offen offset:3072
  buffer_load_dwordx4 a[188:191], v8, s[4:7], s26 offen offset:3072
  s_add_u32 s24, s24, 4096
  s_add_u32 s25, s25, 4096
  s_add_u32 s26, s26, 4096
  s_waitcnt vmcnt(36)
  ds_read_b128 v[16:19], v8 offset:21504
  ds_read_b128 v[20:23], v9 offset:21504
  s_waitcnt lgkmcnt(4)
  v_mfma_f32_32x32x16_bf16 v[96:111], a[36:39], v[24:27], v[96:111]
  v_mfma_f32_32x32x16_bf16 v[112:127], a[36:39], v[28:31], v[112:127]
  v_mfma_f32_32x32x16_bf16 v[128:143], a[40:43], v[24:27], v[128:143]
  v_mfma_f32_32x32x16_bf16 v[144:159], a[40:43], v[28:31], v[144:159]
  v_mfma_f32_32x32x16_bf16 v[160:175], v[24:27], a[44:47], v[160:175]
  v_mfma_f32_32x32x16_bf16 v[176:191], v[28:31], a[44:47], v[176:191]
  buffer_load_dwordx4 a[0:3], v8, s[4:7], s24 offen offset:0
  buffer_load_dwordx4 a[4:7], v8, s[4:7], s25 offen offset:0
  buffer_load_dwordx4 a[8:11], v8, s[4:7], s26 offen offset:0
  s_waitcnt vmcnt(36)
  ds_read_b128 v[24:27], v8 offset:22528
  ds_read_b128 v[28:31], v9 offset:22528
  s_waitcnt lgkmcnt(4)
  v_mfma_f32_32x32x16_bf16 v[96:111], a[48:51], v[32:35], v[96:111]
  v_mfma_f32_32x32x16_bf16 v[112:127], a[48:51], v[36:39], v[112:127]
  v_mfma_f32_32x32x16_bf16 v[128:143], a[52:55], v[32:35], v[128:143]
  v_mfma_f32_32x32x16_bf16 v[144:159], a[52:55], v[36:39], v[144:159]
  v_mfma_f32_32x32x16_bf16 v[160:175], v[32:35], a[56:59], v[160:175]
  v_mfma_f32_32x32x16_bf16 v[176:191], v[36:39], a[56:59], v[176:191]
  buffer_load_dwordx4 a[12:15], v8, s[4:7], s24 offen offset:1024
  buffer_load_dwordx4 a[16:19], v8, s[4:7], s25 offen offset:1024
  buffer_load_dwordx4 a[20:23], v8, s[4:7], s26 offen offset:1024
  s_waitcnt vmcnt(36)
  ds_read_b128 v[32:35], v8 offset:23552
  ds_read_b128 v[36:39], v9 offset:23552
  s_waitcnt lgkmcnt(4)
  v_mfma_f32_32x32x16_bf16 v[96:111], a[60:63], v[16:19], v[96:111]
  v_mfma_f32_32x32x16_bf16 v[112:127], a[60:63], v[20:23], v[112:127]
  v_mfma_f32_32x32x16_bf16 v[128:143], a[64:67], v[16:19], v[128:143]
  v_mfma_f32_32x32x16_bf16 v[144:159], a[64:67], v[20:23], v[144:159]
  v_mfma_f32_32x32x16_bf16 v[160:175], v[16:19], a[68:71], v[160:175]
  v_mfma_f32_32x32x16_bf16 v[176:191], v[20:23], a[68:71], v[176:191]
  buffer_load_dwordx4 a[24:27], v8, s[4:7], s24 offen offset:2048
  buffer_load_dwordx4 a[28:31], v8, s[4:7], s25 offen offset:2048
  buffer_load_dwordx4 a[32:35], v8, s[4:7], s26 offen offset:2048
  s_waitcnt vmcnt(36)
  ds_read_b128 v[16:19], v8 offset:24576
  ds_read_b128 v[20:23], v9 offset:24576
  s_waitcnt lgkmcnt(4)
  v_mfma_f32_32x32x16_bf16 v[96:111], a[72:75], v[24:27], v[96:111]
  v_mfma_f32_32x32x16_bf16 v[112:127], a[72:75], v[28:31], v[112:127]
  v_mfma_f32_32x32x16_bf16 v[128:143], a[76:79], v[24:27], v[128:143]
  v_mfma_f32_32x32x16_bf16 v[144:159], a[76:79], v[28:31], v[144:159]
  v_mfma_f32_32x32x16_bf16 v[160:175], v[24:27], a[80:83], v[160:175]
  v_mfma_f32_32x32x16_bf16 v[176:191], v[28:31], a[80:83], v[176:191]
  buffer_load_dwordx4 a[36:39], v8, s[4:7], s24 offen offset:3072
  buffer_load_dwordx4 a[40:43], v8, s[4:7], s25 offen offset:3072
  buffer_load_dwordx4 a[44:47], v8, s[4:7], s26 offen offset:3072
  s_add_u32 s24, s24, 4096
  s_add_u32 s25, s25, 4096
  s_add_u32 s26, s26, 4096
  s_waitcnt vmcnt(36)
  ds_read_b128 v[24:27], v8 offset:25600
  ds_read_b128 v[28:31], v9 offset:25600
  s_waitcnt lgkmcnt(4)
  v_mfma_f32_32x32x16_bf16 v[96:111], a[84:87], v[32:35], v[96:111]
  v_mfma_f32_32x32x16_bf16 v[112:127], a[84:87], v[36:39], v[112:127]
  v_mfma_f32_32x32x16_bf16 v[128:143], a[88:91], v[32:35], v[128:143]
  v_mfma_f32_32x32x16_bf16 v[144:159], a[88:91], v[36:39], v[144:159]
  v_mfma_f32_32x32x16_bf16 v[160:175], v[32:35], a[92:95], v[160:175]
  v_mfma_f32_32x32x16_bf16 v[176:191], v[36:39], a[92:95], v[176:191]
  buffer_load_dwordx4 a[48:51], v8, s[4:7], s24 offen offset:0
  buffer_load_dwordx4 a[52:55], v8, s[4:7], s25 offen offset:0
  buffer_load_dwordx4 a[56:59], v8, s[4:7], s26 offen offset:0
  s_waitcnt vmcnt(36)
  ds_read_b128 v[32:35], v8 offset:26624
  ds_read_b128 v[36:39], v9 offset:26624
  s_waitcnt lgkmcnt(4)
  v_mfma_f32_32x32x16_bf16 v[96:111], a[96:99], v[16:19], v[96:111]
  v_mfma_f32_32x32x16_bf16 v[112:127], a[96:99], v[20:23], v[112:127]
  v_mfma_f32_32x32x16_bf16 v[128:143], a[100:103], v[16:19], v[128:143]
  v_mfma_f32_32x32x16_bf16 v[144:159], a[100:103], v[20:23], v[144:159]
  v_mfma_f32_32x32x16_bf16 v[160:175], v[16:19], a[104:107], v[160:175]
  v_mfma_f32_32x32x16_bf16 v[176:191], v[20:23], a[104:107], v[176:191]
  buffer_load_dwordx4 a[60:63], v8, s[4:7], s24 offen offset:1024
  buffer_load_dwordx4 a[64:67], v8, s[4:7], s25 offen offset:1024
  buffer_load_dwordx4 a[68:71], v8, s[4:7], s26 offen offset:1024
  s_waitcnt vmcnt(36)
  ds_read_b128 v[16:19], v8 offset:27648
  ds_read_b128 v[20:23], v9 offset:27648
  s_waitcnt lgkmcnt(4)
  v_mfma_f32_32x32x16_bf16 v[96:111], a[108:111], v[24:27], v[96:111]
  v_mfma_f32_32x32x16_bf16 v[112:127], a[108:111], v[28:31], v[112:127]
  v_mfma_f32_32x32x16_bf16 v[128:143], a[112:115], v[24:27], v[128:143]
  v_mfma_f32_32x32x16_bf16 v[144:159], a[112:115], v[28:31], v[144:159]
  v_mfma_f32_32x32x16_bf16 v[160:175], v[24:27], a[116:119], v[160:175]
  v_mfma_f32_32x32x16_bf16 v[176:191], v[28:31], a[116:119], v[176:191]
  buffer_load_dwordx4 a[72:75], v8, s[4:7], s24 offen offset:2048
  buffer_load_dwordx4 a[76:79], v8, s[4:7], s25 offen offset:2048
  buffer_load_dwordx4 a[80:83], v8, s[4:7], s26 offen offset:2048
  s_waitcnt vmcnt(36)
  ds_read_b128 v[24:27], v8 offset:28672
  ds_read_b128 v[28:31], v9 offset:28672
  s_waitcnt lgkmcnt(4)
  v_mfma_f32_32x32x16_bf16 v[96:111], a[120:123], v[32:35], v[96:111]
  v_mfma_f32_32x32x16_bf16 v[112:127], a[120:123], v[36:39], v[112:127]
  v_mfma_f32_32x32x16_bf16 v[128:143], a[124:127], v[32:35], v[128:143]
  v_mfma_f32_32x32x16_bf16 v[144:159], a[124:127], v[36:39], v[144:159]
  v_mfma_f32_32x32x16_bf16 v[160:175], v[32:35], a[128:131], v[160:175]
  v_mfma_f32_32x32x16_bf16 v[176:191], v[36:39], a[128:131], v[176:191]
  buffer_load_dwordx4 a[84:87], v8, s[4:7], s24 offen offset:3072
  buffer_load_dwordx4 a[88:91], v8, s[4:7], s25 offen offset:3072
  buffer_load_dwordx4 a[92:95], v8, s[4:7], s26 offen offset:3072
  s_add_u32 s24, s24, 4096
  s_add_u32 s25, s25, 4096
  s_add_u32 s26, s26, 4096
  s_waitcnt vmcnt(36)
  ds_read_b128 v[32:35], v8 offset:29696
  ds_read_b128 v[36:39], v9 offset:29696
  s_waitcnt lgkmcnt(4)
  v_mfma_f32_32x32x16_bf16 v[96:111], a[132:135], v[16:19], v[96:111]
  v_mfma_f32_32x32x16_bf16 v[112:127], a[132:135], v[20:23], v[112:127]
  v_mfma_f32_32x32x16_bf16 v[128:143], a[136:139], v[16:19], v[128:143]
  v_mfma_f32_32x32x16_bf16 v[144:159], a[136:139], v[20:23], v[144:159]
  v_mfma_f32_32x32x16_bf16 v[160:175], v[16:19], a[140:143], v[160:175]
  v_mfma_f32_32x32x16_bf16 v[176:191], v[20:23], a[140:143], v[176:191]
  s_waitcnt vmcnt(63)
  s_barrier
  s_waitcnt vmcnt(33)
  ds_read_b128 v[16:19], v8 offset:30720
  ds_read_b128 v[20:23], v9 offset:30720
  s_waitcnt lgkmcnt(4)
  v_mfma_f32_32x32x16_bf16 v[96:111], a[144:147], v[24:27], v[96:111]
  v_mfma_f32_32x32x16_bf16 v[112:127], a[144:147], v[28:31], v[112:127]
  v_mfma_f32_32x32x16_bf16 v[128:143], a[148:151], v[24:27], v[128:143]
  v_mfma_f32_32x32x16_bf16 v[144:159], a[148:151], v[28:31], v[144:159]
  v_mfma_f32_32x32x16_bf16 v[160:175], v[24:27], a[152:155], v[160:175]
  v_mfma_f32_32x32x16_bf16 v[176:191], v[28:31], a[152:155], v[176:191]
  s_waitcnt vmcnt(30)
  ds_read_b128 v[24:27], v8 offset:31744
  ds_read_b128 v[28:31], v9 offset:31744
  s_waitcnt lgkmcnt(4)
  v_mfma_f32_32x32x16_bf16 v[96:111], a[156:159], v[32:35], v[96:111]
  v_mfma_f32_32x32x16_bf16 v[112:127], a[156:159], v[36:39], v[112:127]
  v_mfma_f32_32x32x16_bf16 v[128:143], a[160:163], v[32:35], v[128:143]
  v_mfma_f32_32x32x16_bf16 v[144:159], a[160:163], v[36:39], v[144:159]
  v_mfma_f32_32x32x16_bf16 v[160:175], v[32:35], a[164:167], v[160:175]
  v_mfma_f32_32x32x16_bf16 v[176:191], v[36:39], a[164:167], v[176:191]
  s_waitcnt vmcnt(27)
  ds_read_b128 v[32:35], v8 offset:32768
  ds_read_b128 v[36:39], v9 offset:32768
  s_waitcnt lgkmcnt(4)
  v_mfma_f32_32x32x16_bf16 v[96:111], a[168:171], v[16:19], v[96:111]
  v_mfma_f32_32x32x16_bf16 v[112:127], a[168:171], v[20:23], v[112:127]
  v_mfma_f32_32x32x16_bf16 v[128:143], a[172:175], v[16:19], v[128:143]
  v_mfma_f32_32x32x16_bf16 v[144:159], a[172:175], v[20:23], v[144:159]
  v_mfma_f32_32x32x16_bf16 v[160:175], v[16:19], a[176:179], v[160:175]
  v_mfma_f32_32x32x16_bf16 v[176:191], v[20:23], a[176:179], v[176:191]
  s_waitcnt vmcnt(24)
  ds_read_b128 v[16:19], v8 offset:33792
  ds_read_b128 v[20:23], v9 offset:33792
  s_waitcnt lgkmcnt(4)
  v_mfma_f32_32x32x16_bf16 v[96:111], a[180:183], v[24:27], v[96:111]
  v_mfma_f32_32x32x16_bf16 v[112:127], a[180:183], v[28:31], v[112:127]
  v_mfma_f32_32x32x16_bf16 v[128:143], a[184:187], v[24:27], v[128:143]
  v_mfma_f32_32x32x16_bf16 v[144:159], a[184:187], v[28:31], v[144:159]
  v_mfma_f32_32x32x16_bf16 v[160:175], v[24:27], a[188:191], v[160:175]
  v_mfma_f32_32x32x16_bf16 v[176:191], v[28:31], a[188:191], v[176:191]
  s_waitcnt vmcnt(21)
  ds_read_b128 v[24:27], v8 offset:34816
  ds_read_b128 v[28:31], v9 offset:34816
  s_waitcnt lgkmcnt(4)
  v_mfma_f32_32x32x16_bf16 v[96:111], a[0:3], v[32:35], v[96:111]
  v_mfma_f32_32x32x16_bf16 v[112:127], a[0:3], v[36:39], v[112:127]
  v_mfma_f32_32x32x16_bf16 v[128:143], a[4:7], v[32:35], v[128:143]
  v_mfma_f32_32x32x16_bf16 v[144:159], a[4:7], v[36:39], v[144:159]
  v_mfma_f32_32x32x16_bf16 v[160:175], v[32:35], a[8:11], v[160:175]
  v_mfma_f32_32x32x16_bf16 v[176:191], v[36:39], a[8:11], v[176:191]
  s_waitcnt vmcnt(18)
  ds_read_b128 v[32:35], v8 offset:35840
  ds_read_b128 v[36:39], v9 offset:35840
  s_waitcnt lgkmcnt(4)
  v_mfma_f32_32x32x16_bf16 v[96:111], a[12:15], v[16:19], v[96:111]
  v_mfma_f32_32x32x16_bf16 v[112:127], a[12:15], v[20:23], v[112:127]
  v_mfma_f32_32x32x16_bf16 v[128:143], a[16:19], v[16:19], v[128:143]
  v_mfma_f32_32x32x16_bf16 v[144:159], a[16:19], v[20:23], v[144:159]
  v_mfma_f32_32x32x16_bf16 v[160:175], v[16:19], a[20:23], v[160:175]
  v_mfma_f32_32x32x16_bf16 v[176:191], v[20:23], a[20:23], v[176:191]
  s_waitcnt vmcnt(15)
  ds_read_b128 v[16:19], v8 offset:36864
  ds_read_b128 v[20:23], v9 offset:36864
  s_waitcnt lgkmcnt(4)
  v_mfma_f32_32x32x16_bf16 v[96:111], a[24:27], v[24:27], v[96:111]
  v_mfma_f32_32x32x16_bf16 v[112:127], a[24:27], v[28:31], v[112:127]
  v_mfma_f32_32x32x16_bf16 v[128:143], a[28:31], v[24:27], v[128:143]
  v_mfma_f32_32x32x16_bf16 v[144:159], a[28:31], v[28:31], v[144:159]
  v_mfma_f32_32x32x16_bf16 v[160:175], v[24:27], a[32:35], v[160:175]
  v_mfma_f32_32x32x16_bf16 v[176:191], v[28:31], a[32:35], v[176:191]
  s_waitcnt vmcnt(12)
  ds_read_b128 v[24:27], v8 offset:37888
  ds_read_b128 v[28:31], v9 offset:37888
  s_waitcnt lgkmcnt(4)
  v_mfma_f32_32x32x16_bf16 v[96:111], a[36:39], v[32:35], v[96:111]
  v_mfma_f32_32x32x16_bf16 v[112:127], a[36:39], v[36:39], v[112:127]
  v_mfma_f32_32x32x16_bf16 v[128:143], a[40:43], v[32:35], v[128:143]
  v_mfma_f32_32x32x16_bf16 v[144:159], a[40:43], v[36:39], v[144:159]
  v_mfma_f32_32x32x16_bf16 v[160:175], v[32:35], a[44:47], v[160:175]
  v_mfma_f32_32x32x16_bf16 v[176:191], v[36:39], a[44:47], v[176:191]
  s_waitcnt vmcnt(9)
  ds_read_b128 v[32:35], v8 offset:38912
  ds_read_b128 v[36:39], v9 offset:38912
  s_waitcnt lgkmcnt(4)
  v_mfma_f32_32x32x16_bf16 v[96:111], a[48:51], v[16:19], v[96:111]
  v_mfma_f32_32x32x16_bf16 v[112:127], a[48:51], v[20:23], v[112:127]
  v_mfma_f32_32x32x16_bf16 v[128:143], a[52:55], v[16:19], v[128:143]
  v_mfma_f32_32x32x16_bf16 v[144:159], a[52:55], v[20:23], v[144:159]
  v_mfma_f32_32x32x16_bf16 v[160:175], v[16:19], a[56:59], v[160:175]
  v_mfma_f32_32x32x16_bf16 v[176:191], v[20:23], a[56:59], v[176:191]
  s_waitcnt vmcnt(6)
  ds_read_b128 v[16:19], v8 offset:39936
  ds_read_b128 v[20:23], v9 offset:39936
  s_waitcnt lgkmcnt(4)
  v_mfma_f32_32x32x16_bf16 v[96:111], a[60:63], v[24:27], v[96:111]
  v_mfma_f32_32x32x16_bf16 v[112:127], a[60:63], v[28:31], v[112:127]
  v_mfma_f32_32x32x16_bf16 v[128:143], a[64:67], v[24:27], v[128:143]
  v_mfma_f32_32x32x16_bf16 v[144:159], a[64:67], v[28:31], v[144:159]
  v_mfma_f32_32x32x16_bf16 v[160:175], v[24:27], a[68:71], v[160:175]
  v_mfma_f32_32x32x16_bf16 v[176:191], v[28:31], a[68:71], v[176:191]
  s_waitcnt vmcnt(3)
  s_waitcnt lgkmcnt(2)
  v_mfma_f32_32x32x16_bf16 v[96:111], a[72:75], v[32:35], v[96:111]
  v_mfma_f32_32x32x16_bf16 v[112:127], a[72:75], v[36:39], v[112:127]
  v_mfma_f32_32x32x16_bf16 v[128:143], a[76:79], v[32:35], v[128:143]
  v_mfma_f32_32x32x16_bf16 v[144:159], a[76:79], v[36:39], v[144:159]
  v_mfma_f32_32x32x16_bf16 v[160:175], v[32:35], a[80:83], v[160:175]
  v_mfma_f32_32x32x16_bf16 v[176:191], v[36:39], a[80:83], v[176:191]
  s_waitcnt vmcnt(0)
  s_waitcnt lgkmcnt(0)
  v_mfma_f32_32x32x16_bf16 v[96:111], a[84:87], v[16:19], v[96:111]
  v_mfma_f32_32x32x16_bf16 v[112:127], a[84:87], v[20:23], v[112:127]
  v_mfma_f32_32x32x16_bf16 v[128:143], a[88:91], v[16:19], v[128:143]
  v_mfma_f32_32x32x16_bf16 v[144:159], a[88:91], v[20:23], v[144:159]
  v_mfma_f32_32x32x16_bf16 v[160:175], v[16:19], a[92:95], v[160:175]
  v_mfma_f32_32x32x16_bf16 v[176:191], v[20:23], a[92:95], v[176:191]
  s_lshl_b32 s21, s18, 1
  s_lshl_b32 s22, s23, 6
  s_add_u32 s21, s21, s22
  s_lshl_b32 s21, s21, 11
  s_add_u32 s27, s21, 37748736
  s_add_u32 s28, s21, 41943040
  s_add_u32 s29, s21, 46137344
  s_mov_b32 s30, 0x3ea52b5c
  v_and_b32 v2, 31, v0
  v_cmp_eq_u32 s[32:33], 20, v2
  v_mov_b32 v3, 0x3f803f80
  v_mul_f32 v96, s30, v96
  v_mul_f32 v97, s30, v97
  v_mul_f32 v98, s30, v98
  v_mul_f32 v99, s30, v99
  v_mul_f32 v100, s30, v100
  v_mul_f32 v101, s30, v101
  v_mul_f32 v102, s30, v102
  v_mul_f32 v103, s30, v103
  v_mul_f32 v104, s30, v104
  v_mul_f32 v105, s30, v105
  v_mul_f32 v106, s30, v106
  v_mul_f32 v107, s30, v107
  v_mul_f32 v108, s30, v108
  v_mul_f32 v109, s30, v109
  v_mul_f32 v110, s30, v110
  v_mul_f32 v111, s30, v111
  v_cvt_pk_bf16_f32 v16, v96, v97
  v_cvt_pk_bf16_f32 v17, v98, v99
  v_cvt_pk_bf16_f32 v18, v100, v101
  v_cvt_pk_bf16_f32 v19, v102, v103
  v_cvt_pk_bf16_f32 v20, v104, v105
  v_cvt_pk_bf16_f32 v21, v106, v107
  v_cvt_pk_bf16_f32 v22, v108, v109
  v_cvt_pk_bf16_f32 v23, v110, v111
  buffer_store_dwordx4 v[16:19], v8, s[4:7], s27 offen offset:0 sc1
  buffer_store_dwordx4 v[20:23], v8, s[4:7], s27 offen offset:1024 sc1
  v_mul_f32 v112, s30, v112
  v_mul_f32 v113, s30, v113
  v_mul_f32 v114, s30, v114
  v_mul_f32 v115, s30, v115
  v_mul_f32 v116, s30, v116
  v_mul_f32 v117, s30, v117
  v_mul_f32 v118, s30, v118
  v_mul_f32 v119, s30, v119
  v_mul_f32 v120, s30, v120
  v_mul_f32 v121, s30, v121
  v_mul_f32 v122, s30, v122
  v_mul_f32 v123, s30, v123
  v_mul_f32 v124, s30, v124
  v_mul_f32 v125, s30, v125
  v_mul_f32 v126, s30, v126
  v_mul_f32 v127, s30, v127
  v_cvt_pk_bf16_f32 v24, v112, v113
  v_cvt_pk_bf16_f32 v25, v114, v115
  v_cvt_pk_bf16_f32 v26, v116, v117
  v_cvt_pk_bf16_f32 v27, v118, v119
  v_cvt_pk_bf16_f32 v28, v120, v121
  v_cvt_pk_bf16_f32 v29, v122, v123
  v_cvt_pk_bf16_f32 v30, v124, v125
  v_cvt_pk_bf16_f32 v31, v126, v127
  buffer_store_dwordx4 v[24:27], v8, s[4:7], s27 offen offset:2048 sc1
  buffer_store_dwordx4 v[28:31], v8, s[4:7], s27 offen offset:3072 sc1
  v_cvt_pk_bf16_f32 v16, v128, v129
  v_cvt_pk_bf16_f32 v17, v130, v131
  v_cvt_pk_bf16_f32 v18, v132, v133
  v_cvt_pk_bf16_f32 v19, v134, v135
  v_cvt_pk_bf16_f32 v20, v136, v137
  v_cvt_pk_bf16_f32 v21, v138, v139
  v_cvt_pk_bf16_f32 v22, v140, v141
  v_cvt_pk_bf16_f32 v23, v142, v143
  buffer_store_dwordx4 v[16:19], v8, s[4:7], s28 offen offset:0 sc1
  buffer_store_dwordx4 v[20:23], v8, s[4:7], s28 offen offset:1024 sc1
  v_cvt_pk_bf16_f32 v24, v144, v145
  v_cvt_pk_bf16_f32 v25, v146, v147
  v_cvt_pk_bf16_f32 v26, v148, v149
  v_cvt_pk_bf16_f32 v27, v150, v151
  v_cvt_pk_bf16_f32 v28, v152, v153
  v_cvt_pk_bf16_f32 v29, v154, v155
  v_cvt_pk_bf16_f32 v30, v156, v157
  v_cvt_pk_bf16_f32 v31, v158, v159
  buffer_store_dwordx4 v[24:27], v8, s[4:7], s28 offen offset:2048 sc1
  buffer_store_dwordx4 v[28:31], v8, s[4:7], s28 offen offset:3072 sc1
  v_cvt_pk_bf16_f32 v16, v160, v161
  v_cvt_pk_bf16_f32 v17, v162, v163
  v_cvt_pk_bf16_f32 v18, v164, v165
  v_cvt_pk_bf16_f32 v19, v166, v167
  v_cvt_pk_bf16_f32 v20, v168, v169
  v_cvt_pk_bf16_f32 v21, v170, v171
  v_cvt_pk_bf16_f32 v22, v172, v173
  v_cvt_pk_bf16_f32 v23, v174, v175
  v_cndmask_b32 v16, v16, v3, s[32:33]
  v_cndmask_b32 v17, v17, v3, s[32:33]
  v_cndmask_b32 v18, v18, v3, s[32:33]
  v_cndmask_b32 v19, v19, v3, s[32:33]
  v_cndmask_b32 v20, v20, v3, s[32:33]
  v_cndmask_b32 v21, v21, v3, s[32:33]
  v_cndmask_b32 v22, v22, v3, s[32:33]
  v_cndmask_b32 v23, v23, v3, s[32:33]
  buffer_store_dwordx4 v[16:19], v8, s[4:7], s29 offen offset:0 sc1
  buffer_store_dwordx4 v[20:23], v8, s[4:7], s29 offen offset:1024 sc1
  v_cvt_pk_bf16_f32 v24, v176, v177
  v_cvt_pk_bf16_f32 v25, v178, v179
  v_cvt_pk_bf16_f32 v26, v180, v181
  v_cvt_pk_bf16_f32 v27, v182, v183
  v_cvt_pk_bf16_f32 v28, v184, v185
  v_cvt_pk_bf16_f32 v29, v186, v187
  v_cvt_pk_bf16_f32 v30, v188, v189
  v_cvt_pk_bf16_f32 v31, v190, v191
  v_cndmask_b32 v24, v24, v3, s[32:33]
  v_cndmask_b32 v25, v25, v3, s[32:33]
  v_cndmask_b32 v26, v26, v3, s[32:33]
  v_cndmask_b32 v27, v27, v3, s[32:33]
  v_cndmask_b32 v28, v28, v3, s[32:33]
  v_cndmask_b32 v29, v29, v3, s[32:33]
  v_cndmask_b32 v30, v30, v3, s[32:33]
  v_cndmask_b32 v31, v31, v3, s[32:33]
  buffer_store_dwordx4 v[24:27], v8, s[4:7], s29 offen offset:2048 sc1
  buffer_store_dwordx4 v[28:31], v8, s[4:7], s29 offen offset:3072 sc1
  s_waitcnt vmcnt(0)
qkvb_exit1:
  s_endpgm
.globl attnb_kernel
.p2align 8
.type attnb_kernel,@function
attnb_kernel:
  s_cmp_ge_u32 s2, 256
  s_cbranch_scc1 attnb_exit1
  s_load_dwordx2 s[12:13], s[0:1], 96
  v_lshrrev_b32 v2, 6, v0
  v_and_b32 v3, 63, v0
  s_nop 0
  v_readfirstlane_b32 s16, v2
  v_lshlrev_b32 v1, 4, v3
  s_and_b32 s17, s2, 7
  s_lshl_b32 s17, s17, 2
  s_lshr_b32 s18, s2, 3
  s_and_b32 s19, s18, 3
  s_add_u32 s17, s17, s19
  s_lshr_b32 s18, s18, 2
  s_waitcnt lgkmcnt(0)
  s_mov_b32 s4, s12
  s_mov_b32 s5, s13
  s_mov_b32 s6, 0x10000000
  s_mov_b32 s7, 0x20000
  s_lshl_b32 s20, s17, 17
  s_add_u32 s21, s20, 41943040
  s_add_u32 s22, s20, 46137344
  s_lshl_b32 s23, s18, 3
  s_lshl_b32 s24, s16, 1
  s_add_u32 s23, s23, s24
  s_lshl_b32 s24, s23, 11
  s_add_u32 s24, s24, s20
  s_add_u32 s24, s24, 37748736
  buffer_load_dwordx4 v[8:11], v1, s[4:7], s24 offen offset:0
  buffer_load_dwordx4 v[12:15], v1, s[4:7], s24 offen offset:1024
  buffer_load_dwordx4 v[16:19], v1, s[4:7], s24 offen offset:2048
  buffer_load_dwordx4 v[20:23], v1, s[4:7], s24 offen offset:3072
  s_mov_b32 s25, s21
  s_mov_b32 s26, s22
  buffer_load_dwordx4 v[136:139], v1, s[4:7], s25 offen
  buffer_load_dwordx4 v[140:143], v1, s[4:7], s25 offen offset:1024
  buffer_load_dwordx4 v[144:147], v1, s[4:7], s26 offen
  buffer_load_dwordx4 v[148:151], v1, s[4:7], s26 offen offset:1024
  s_add_u32 s25, s25, 2048
  s_add_u32 s26, s26, 2048
  s_waitcnt vmcnt(0)
  v_mfma_f32_32x32x16_bf16 v[88:103], v[136:139], v[8:11], 0
  v_mfma_f32_32x32x16_bf16 v[88:103], v[140:143], v[12:15], v[88:103]
  v_mfma_f32_32x32x16_bf16 v[104:119], v[136:139], v[16:19], 0
  v_mfma_f32_32x32x16_bf16 v[104:119], v[140:143], v[20:23], v[104:119]
  s_nop 9
  v_max3_f32 v2, v88, v89, v90
  v_max3_f32 v2, v2, v91, v92
  v_max3_f32 v2, v2, v93, v94
  v_max3_f32 v2, v2, v95, v96
  v_max3_f32 v2, v2, v97, v98
  v_max3_f32 v2, v2, v99, v100
  v_max3_f32 v2, v2, v101, v102
  v_max_f32 v2, v2, v103
  v_mov_b32 v4, v2
  s_nop 1
  v_permlane32_swap_b32 v2, v4
  v_max_f32 v2, v2, v4
  v_sub_f32 v24, 0, v2
  v_sub_f32 v25, 0, v2
  v_sub_f32 v26, 0, v2
  v_sub_f32 v27, 0, v2
  v_sub_f32 v28, 0, v2
  v_sub_f32 v29, 0, v2
  v_sub_f32 v30, 0, v2
  v_sub_f32 v31, 0, v2
  v_sub_f32 v32, 0, v2
  v_sub_f32 v33, 0, v2
  v_sub_f32 v34, 0, v2
  v_sub_f32 v35, 0, v2
  v_sub_f32 v36, 0, v2
  v_sub_f32 v37, 0, v2
  v_sub_f32 v38, 0, v2
  v_sub_f32 v39, 0, v2
  v_max3_f32 v3, v104, v105, v106
  v_max3_f32 v3, v3, v107, v108
  v_max3_f32 v3, v3, v109, v110
  v_max3_f32 v3, v3, v111, v112
  v_max3_f32 v3, v3, v113, v114
  v_max3_f32 v3, v3, v115, v116
  v_max3_f32 v3, v3, v117, v118
  v_max_f32 v3, v3, v119
  v_mov_b32 v4, v3
  s_nop 1
  v_permlane32_swap_b32 v3, v4
  v_max_f32 v3, v3, v4
  v_sub_f32 v40, 0, v3
  v_sub_f32 v41, 0, v3
  v_sub_f32 v42, 0, v3
  v_sub_f32 v43, 0, v3
  v_sub_f32 v44, 0, v3
  v_sub_f32 v45, 0, v3
  v_sub_f32 v46, 0, v3
  v_sub_f32 v47, 0, v3
  v_sub_f32 v48, 0, v3
  v_sub_f32 v49, 0, v3
  v_sub_f32 v50, 0, v3
  v_sub_f32 v51, 0, v3
  v_sub_f32 v52, 0, v3
  v_sub_f32 v53, 0, v3
  v_sub_f32 v54, 0, v3
  v_sub_f32 v55, 0, v3
  s_mov_b32 s28, 0
attnb_main2:
  s_mov_b32 s25, s21
  s_mov_b32 s26, s22
  buffer_load_dwordx4 v[136:139], v1, s[4:7], s25 offen
  buffer_load_dwordx4 v[140:143], v1, s[4:7], s25 offen offset:1024
  buffer_load_dwordx4 v[144:147], v1, s[4:7], s26 offen
  buffer_load_dwordx4 v[148:151], v1, s[4:7], s26 offen offset:1024
  s_add_u32 s25, s25, 2048
  s_add_u32 s26, s26, 2048
  buffer_load_dwordx4 v[152:155], v1, s[4:7], s25 offen
  buffer_load_dwordx4 v[156:159], v1, s[4:7], s25 offen offset:1024
  buffer_load_dwordx4 v[160:163], v1, s[4:7], s26 offen
  buffer_load_dwordx4 v[164:167], v1, s[4:7], s26 offen offset:1024
  s_add_u32 s25, s25, 2048
  s_add_u32 s26, s26, 2048
  v_mov_b32 v56, 0
  v_mov_b32 v57, 0
  v_mov_b32 v58, 0
  v_mov_b32 v59, 0
  v_mov_b32 v60, 0
  v_mov_b32 v61, 0
  v_mov_b32 v62, 0
  v_mov_b32 v63, 0
  v_mov_b32 v64, 0
  v_mov_b32 v65, 0
  v_mov_b32 v66, 0
  v_mov_b32 v67, 0
  v_mov_b32 v68, 0
  v_mov_b32 v69, 0
  v_mov_b32 v70, 0
  v_mov_b32 v71, 0
  v_mov_b32 v72, 0
  v_mov_b32 v73, 0
  v_mov_b32 v74, 0
  v_mov_b32 v75, 0
  v_mov_b32 v76, 0
  v_mov_b32 v77, 0
  v_mov_b32 v78, 0
  v_mov_b32 v79, 0
  v_mov_b32 v80, 0
  v_mov_b32 v81, 0
  v_mov_b32 v82, 0
  v_mov_b32 v83, 0
  v_mov_b32 v84, 0
  v_mov_b32 v85, 0
  v_mov_b32 v86, 0
  v_mov_b32 v87, 0
  s_waitcnt vmcnt(4)
  v_mfma_f32_32x32x16_bf16 v[88:103], v[136:139], v[8:11], v[24:39]
  v_mfma_f32_32x32x16_bf16 v[88:103], v[140:143], v[12:15], v[88:103]
  s_nop 11
  v_exp_f32 v88, v88
  v_exp_f32 v89, v89
  v_exp_f32 v90, v90
  v_exp_f32 v91, v91
  v_exp_f32 v92, v92
  v_exp_f32 v93, v93
  v_exp_f32 v94, v94
  v_exp_f32 v95, v95
  v_mfma_f32_32x32x16_bf16 v[104:119], v[136:139], v[16:19], v[40:55]
  v_cvt_pk_bf16_f32 v120, v88, v89
  v_cvt_pk_bf16_f32 v121, v90, v91
  v_cvt_pk_bf16_f32 v122, v92, v93
  v_cvt_pk_bf16_f32 v123, v94, v95
  v_exp_f32 v96, v96
  v_exp_f32 v97, v97
  v_mfma_f32_32x32x16_bf16 v[104:119], v[140:143], v[20:23], v[104:119]
  v_exp_f32 v98, v98
  v_exp_f32 v99, v99
  v_exp_f32 v100, v100
  v_exp_f32 v101, v101
  v_mfma_f32_32x32x16_bf16 v[56:71], v[144:147], v[120:123], v[56:71]
  v_exp_f32 v102, v102
  v_exp_f32 v103, v103
  v_cvt_pk_bf16_f32 v124, v96, v97
  v_cvt_pk_bf16_f32 v125, v98, v99
  v_cvt_pk_bf16_f32 v126, v100, v101
  v_cvt_pk_bf16_f32 v127, v102, v103
  buffer_load_dwordx4 v[168:171], v1, s[4:7], s25 offen
  buffer_load_dwordx4 v[172:175], v1, s[4:7], s25 offen offset:1024
  buffer_load_dwordx4 v[176:179], v1, s[4:7], s26 offen
  buffer_load_dwordx4 v[180:183], v1, s[4:7], s26 offen offset:1024
  s_add_u32 s25, s25, 2048
  s_add_u32 s26, s26, 2048
  s_waitcnt vmcnt(4)
  v_exp_f32 v104, v104
  v_exp_f32 v105, v105
  v_exp_f32 v106, v106
  v_exp_f32 v107, v107
  v_mfma_f32_32x32x16_bf16 v[56:71], v[148:151], v[124:127], v[56:71]
  v_exp_f32 v108, v108
  v_exp_f32 v109, v109
  v_exp_f32 v110, v110
  v_exp_f32 v111, v111
  v_mfma_f32_32x32x16_bf16 v[88:103], v[152:155], v[8:11], v[24:39]
  v_cvt_pk_bf16_f32 v128, v104, v105
  v_cvt_pk_bf16_f32 v129, v106, v107
  v_cvt_pk_bf16_f32 v130, v108, v109
  v_cvt_pk_bf16_f32 v131, v110, v111
  v_exp_f32 v112, v112
  v_exp_f32 v113, v113
  v_mfma_f32_32x32x16_bf16 v[88:103], v[156:159], v[12:15], v[88:103]
  v_exp_f32 v114, v114
  v_exp_f32 v115, v115
  v_exp_f32 v116, v116
  v_exp_f32 v117, v117
  v_mfma_f32_32x32x16_bf16 v[72:87], v[144:147], v[128:131], v[72:87]
  v_exp_f32 v118, v118
  v_exp_f32 v119, v119
  v_cvt_pk_bf16_f32 v132, v112, v113
  v_cvt_pk_bf16_f32 v133, v114, v115
  v_cvt_pk_bf16_f32 v134, v116, v117
  v_cvt_pk_bf16_f32 v135, v118, v119
  s_mov_b32 s27, 0
attnb_loop3:
  v_exp_f32 v88, v88
  v_exp_f32 v89, v89
  v_exp_f32 v90, v90
  v_exp_f32 v91, v91
  v_mfma_f32_32x32x16_bf16 v[72:87], v[148:151], v[132:135], v[72:87]
  v_exp_f32 v92, v92
  v_exp_f32 v93, v93
  v_exp_f32 v94, v94
  v_exp_f32 v95, v95
  v_mfma_f32_32x32x16_bf16 v[104:119], v[152:155], v[16:19], v[40:55]
  v_cvt_pk_bf16_f32 v120, v88, v89
  v_cvt_pk_bf16_f32 v121, v90, v91
  v_cvt_pk_bf16_f32 v122, v92, v93
  v_cvt_pk_bf16_f32 v123, v94, v95
  v_exp_f32 v96, v96
  v_exp_f32 v97, v97
  v_mfma_f32_32x32x16_bf16 v[104:119], v[156:159], v[20:23], v[104:119]
  v_exp_f32 v98, v98
  v_exp_f32 v99, v99
  v_exp_f32 v100, v100
  v_exp_f32 v101, v101
  v_mfma_f32_32x32x16_bf16 v[56:71], v[160:163], v[120:123], v[56:71]
  v_exp_f32 v102, v102
  v_exp_f32 v103, v103
  v_cvt_pk_bf16_f32 v124, v96, v97
  v_cvt_pk_bf16_f32 v125, v98, v99
  v_cvt_pk_bf16_f32 v126, v100, v101
  v_cvt_pk_bf16_f32 v127, v102, v103
  buffer_load_dwordx4 v[136:139], v1, s[4:7], s25 offen
  buffer_load_dwordx4 v[140:143], v1, s[4:7], s25 offen offset:1024
  buffer_load_dwordx4 v[144:147], v1, s[4:7], s26 offen
  buffer_load_dwordx4 v[148:151], v1, s[4:7], s26 offen offset:1024
  s_add_u32 s25, s25, 2048
  s_add_u32 s26, s26, 2048
  s_waitcnt vmcnt(4)
  v_exp_f32 v104, v104
  v_exp_f32 v105, v105
  v_exp_f32 v106, v106
  v_exp_f32 v107, v107
  v_mfma_f32_32x32x16_bf16 v[56:71], v[164:167], v[124:127], v[56:71]
  v_exp_f32 v108, v108
  v_exp_f32 v109, v109
  v_exp_f32 v110, v110
  v_exp_f32 v111, v111
  v_mfma_f32_32x32x16_bf16 v[88:103], v[168:171], v[8:11], v[24:39]
  v_cvt_pk_bf16_f32 v128, v104, v105
  v_cvt_pk_bf16_f32 v129, v106, v107
  v_cvt_pk_bf16_f32 v130, v108, v109
  v_cvt_pk_bf16_f32 v131, v110, v111
  v_exp_f32 v112, v112
  v_exp_f32 v113, v113
  v_mfma_f32_32x32x16_bf16 v[88:103], v[172:175], v[12:15], v[88:103]
  v_exp_f32 v114, v114
  v_exp_f32 v115, v115
  v_exp_f32 v116, v116
  v_exp_f32 v117, v117
  v_mfma_f32_32x32x16_bf16 v[72:87], v[160:163], v[128:131], v[72:87]
  v_exp_f32 v118, v118
  v_exp_f32 v119, v119
  v_cvt_pk_bf16_f32 v132, v112, v113
  v_cvt_pk_bf16_f32 v133, v114, v115
  v_cvt_pk_bf16_f32 v134, v116, v117
  v_cvt_pk_bf16_f32 v135, v118, v119
  s_nop 0
  v_exp_f32 v88, v88
  v_exp_f32 v89, v89
  v_exp_f32 v90, v90
  v_exp_f32 v91, v91
  v_mfma_f32_32x32x16_bf16 v[72:87], v[164:167], v[132:135], v[72:87]
  v_exp_f32 v92, v92
  v_exp_f32 v93, v93
  v_exp_f32 v94, v94
  v_exp_f32 v95, v95
  v_mfma_f32_32x32x16_bf16 v[104:119], v[168:171], v[16:19], v[40:55]
  v_cvt_pk_bf16_f32 v120, v88, v89
  v_cvt_pk_bf16_f32 v121, v90, v91
  v_cvt_pk_bf16_f32 v122, v92, v93
  v_cvt_pk_bf16_f32 v123, v94, v95
  v_exp_f32 v96, v96
  v_exp_f32 v97, v97
  v_mfma_f32_32x32x16_bf16 v[104:119], v[172:175], v[20:23], v[104:119]
  v_exp_f32 v98, v98
  v_exp_f32 v99, v99
  v_exp_f32 v100, v100
  v_exp_f32 v101, v101
  v_mfma_f32_32x32x16_bf16 v[56:71], v[176:179], v[120:123], v[56:71]
  v_exp_f32 v102, v102
  v_exp_f32 v103, v103
  v_cvt_pk_bf16_f32 v124, v96, v97
  v_cvt_pk_bf16_f32 v125, v98, v99
  v_cvt_pk_bf16_f32 v126, v100, v101
  v_cvt_pk_bf16_f32 v127, v102, v103
  buffer_load_dwordx4 v[152:155], v1, s[4:7], s25 offen
  buffer_load_dwordx4 v[156:159], v1, s[4:7], s25 offen offset:1024
  buffer_load_dwordx4 v[160:163], v1, s[4:7], s26 offen
  buffer_load_dwordx4 v[164:167], v1, s[4:7], s26 offen offset:1024
  s_add_u32 s25, s25, 2048
  s_add_u32 s26, s26, 2048
  s_waitcnt vmcnt(4)
  v_exp_f32 v104, v104
  v_exp_f32 v105, v105
  v_exp_f32 v106, v106
  v_exp_f32 v107, v107
  v_mfma_f32_32x32x16_bf16 v[56:71], v[180:183], v[124:127], v[56:71]
  v_exp_f32 v108, v108
  v_exp_f32 v109, v109
  v_exp_f32 v110, v110
  v_exp_f32 v111, v111
  v_mfma_f32_32x32x16_bf16 v[88:103], v[136:139], v[8:11], v[24:39]
  v_cvt_pk_bf16_f32 v128, v104, v105
  v_cvt_pk_bf16_f32 v129, v106, v107
  v_cvt_pk_bf16_f32 v130, v108, v109
  v_cvt_pk_bf16_f32 v131, v110, v111
  v_exp_f32 v112, v112
  v_exp_f32 v113, v113
  v_mfma_f32_32x32x16_bf16 v[88:103], v[140:143], v[12:15], v[88:103]
  v_exp_f32 v114, v114
  v_exp_f32 v115, v115
  v_exp_f32 v116, v116
  v_exp_f32 v117, v117
  v_mfma_f32_32x32x16_bf16 v[72:87], v[176:179], v[128:131], v[72:87]
  v_exp_f32 v118, v118
  v_exp_f32 v119, v119
  v_cvt_pk_bf16_f32 v132, v112, v113
  v_cvt_pk_bf16_f32 v133, v114, v115
  v_cvt_pk_bf16_f32 v134, v116, v117
  v_cvt_pk_bf16_f32 v135, v118, v119
  s_nop 0
  v_exp_f32 v88, v88
  v_exp_f32 v89, v89
  v_exp_f32 v90, v90
  v_exp_f32 v91, v91
  v_mfma_f32_32x32x16_bf16 v[72:87], v[180:183], v[132:135], v[72:87]
  v_exp_f32 v92, v92
  v_exp_f32 v93, v93
  v_exp_f32 v94, v94
  v_exp_f32 v95, v95
  v_mfma_f32_32x32x16_bf16 v[104:119], v[136:139], v[16:19], v[40:55]
  v_cvt_pk_bf16_f32 v120, v88, v89
  v_cvt_pk_bf16_f32 v121, v90, v91
  v_cvt_pk_bf16_f32 v122, v92, v93
  v_cvt_pk_bf16_f32 v123, v94, v95
  v_exp_f32 v96, v96
  v_exp_f32 v97, v97
  v_mfma_f32_32x32x16_bf16 v[104:119], v[140:143], v[20:23], v[104:119]
  v_exp_f32 v98, v98
  v_exp_f32 v99, v99
  v_exp_f32 v100, v100
  v_exp_f32 v101, v101
  v_mfma_f32_32x32x16_bf16 v[56:71], v[144:147], v[120:123], v[56:71]
  v_exp_f32 v102, v102
  v_exp_f32 v103, v103
  v_cvt_pk_bf16_f32 v124, v96, v97
  v_cvt_pk_bf16_f32 v125, v98, v99
  v_cvt_pk_bf16_f32 v126, v100, v101
  v_cvt_pk_bf16_f32 v127, v102, v103
  buffer_load_dwordx4 v[168:171], v1, s[4:7], s25 offen
  buffer_load_dwordx4 v[172:175], v1, s[4:7], s25 offen offset:1024
  buffer_load_dwordx4 v[176:179], v1, s[4:7], s26 offen
  buffer_load_dwordx4 v[180:183], v1, s[4:7], s26 offen offset:1024
  s_add_u32 s25, s25, 2048
  s_add_u32 s26, s26, 2048
  s_waitcnt vmcnt(4)
  v_exp_f32 v104, v104
  v_exp_f32 v105, v105
  v_exp_f32 v106, v106
  v_exp_f32 v107, v107
  v_mfma_f32_32x32x16_bf16 v[56:71], v[148:151], v[124:127], v[56:71]
  v_exp_f32 v108, v108
  v_exp_f32 v109, v109
  v_exp_f32 v110, v110
  v_exp_f32 v111, v111
  v_mfma_f32_32x32x16_bf16 v[88:103], v[152:155], v[8:11], v[24:39]
  v_cvt_pk_bf16_f32 v128, v104, v105
  v_cvt_pk_bf16_f32 v129, v106, v107
  v_cvt_pk_bf16_f32 v130, v108, v109
  v_cvt_pk_bf16_f32 v131, v110, v111
  v_exp_f32 v112, v112
  v_exp_f32 v113, v113
  v_mfma_f32_32x32x16_bf16 v[88:103], v[156:159], v[12:15], v[88:103]
  v_exp_f32 v114, v114
  v_exp_f32 v115, v115
  v_exp_f32 v116, v116
  v_exp_f32 v117, v117
  v_mfma_f32_32x32x16_bf16 v[72:87], v[144:147], v[128:131], v[72:87]
  v_exp_f32 v118, v118
  v_exp_f32 v119, v119
  v_cvt_pk_bf16_f32 v132, v112, v113
  v_cvt_pk_bf16_f32 v133, v114, v115
  v_cvt_pk_bf16_f32 v134, v116, v117
  v_cvt_pk_bf16_f32 v135, v118, v119
  s_add_u32 s27, s27, 1
  s_cmp_lt_u32 s27, 20
  s_cbranch_scc1 attnb_loop3
  v_exp_f32 v88, v88
  v_exp_f32 v89, v89
  v_exp_f32 v90, v90
  v_exp_f32 v91, v91
  v_mfma_f32_32x32x16_bf16 v[72:87], v[148:151], v[132:135], v[72:87]
  v_exp_f32 v92, v92
  v_exp_f32 v93, v93
  v_exp_f32 v94, v94
  v_exp_f32 v95, v95
  v_mfma_f32_32x32x16_bf16 v[104:119], v[152:155], v[16:19], v[40:55]
  v_cvt_pk_bf16_f32 v120, v88, v89
  v_cvt_pk_bf16_f32 v121, v90, v91
  v_cvt_pk_bf16_f32 v122, v92, v93
  v_cvt_pk_bf16_f32 v123, v94, v95
  v_exp_f32 v96, v96
  v_exp_f32 v97, v97
  v_mfma_f32_32x32x16_bf16 v[104:119], v[156:159], v[20:23], v[104:119]
  v_exp_f32 v98, v98
  v_exp_f32 v99, v99
  v_exp_f32 v100, v100
  v_exp_f32 v101, v101
  v_mfma_f32_32x32x16_bf16 v[56:71], v[160:163], v[120:123], v[56:71]
  v_exp_f32 v102, v102
  v_exp_f32 v103, v103
  v_cvt_pk_bf16_f32 v124, v96, v97
  v_cvt_pk_bf16_f32 v125, v98, v99
  v_cvt_pk_bf16_f32 v126, v100, v101
  v_cvt_pk_bf16_f32 v127, v102, v103
  buffer_load_dwordx4 v[136:139], v1, s[4:7], s25 offen
  buffer_load_dwordx4 v[140:143], v1, s[4:7], s25 offen offset:1024
  buffer_load_dwordx4 v[144:147], v1, s[4:7], s26 offen
  buffer_load_dwordx4 v[148:151], v1, s[4:7], s26 offen offset:1024
  s_add_u32 s25, s25, 2048
  s_add_u32 s26, s26, 2048
  s_waitcnt vmcnt(4)
  v_exp_f32 v104, v104
  v_exp_f32 v105, v105
  v_exp_f32 v106, v106
  v_exp_f32 v107, v107
  v_mfma_f32_32x32x16_bf16 v[56:71], v[164:167], v[124:127], v[56:71]
  v_exp_f32 v108, v108
  v_exp_f32 v109, v109
  v_exp_f32 v110, v110
  v_exp_f32 v111, v111
  v_mfma_f32_32x32x16_bf16 v[88:103], v[168:171], v[8:11], v[24:39]
  v_cvt_pk_bf16_f32 v128, v104, v105
  v_cvt_pk_bf16_f32 v129, v106, v107
  v_cvt_pk_bf16_f32 v130, v108, v109
  v_cvt_pk_bf16_f32 v131, v110, v111
  v_exp_f32 v112, v112
  v_exp_f32 v113, v113
  v_mfma_f32_32x32x16_bf16 v[88:103], v[172:175], v[12:15], v[88:103]
  v_exp_f32 v114, v114
  v_exp_f32 v115, v115
  v_exp_f32 v116, v116
  v_exp_f32 v117, v117
  v_mfma_f32_32x32x16_bf16 v[72:87], v[160:163], v[128:131], v[72:87]
  v_exp_f32 v118, v118
  v_exp_f32 v119, v119
  v_cvt_pk_bf16_f32 v132, v112, v113
  v_cvt_pk_bf16_f32 v133, v114, v115
  v_cvt_pk_bf16_f32 v134, v116, v117
  v_cvt_pk_bf16_f32 v135, v118, v119
  s_nop 0
  v_exp_f32 v88, v88
  v_exp_f32 v89, v89
  v_exp_f32 v90, v90
  v_exp_f32 v91, v91
  v_mfma_f32_32x32x16_bf16 v[72:87], v[164:167], v[132:135], v[72:87]
  v_exp_f32 v92, v92
  v_exp_f32 v93, v93
  v_exp_f32 v94, v94
  v_exp_f32 v95, v95
  v_mfma_f32_32x32x16_bf16 v[104:119], v[168:171], v[16:19], v[40:55]
  v_cvt_pk_bf16_f32 v120, v88, v89
  v_cvt_pk_bf16_f32 v121, v90, v91
  v_cvt_pk_bf16_f32 v122, v92, v93
  v_cvt_pk_bf16_f32 v123, v94, v95
  v_exp_f32 v96, v96
  v_exp_f32 v97, v97
  v_mfma_f32_32x32x16_bf16 v[104:119], v[172:175], v[20:23], v[104:119]
  v_exp_f32 v98, v98
  v_exp_f32 v99, v99
  v_exp_f32 v100, v100
  v_exp_f32 v101, v101
  v_mfma_f32_32x32x16_bf16 v[56:71], v[176:179], v[120:123], v[56:71]
  v_exp_f32 v102, v102
  v_exp_f32 v103, v103
  v_cvt_pk_bf16_f32 v124, v96, v97
  v_cvt_pk_bf16_f32 v125, v98, v99
  v_cvt_pk_bf16_f32 v126, v100, v101
  v_cvt_pk_bf16_f32 v127, v102, v103
  s_waitcnt vmcnt(0)
  v_exp_f32 v104, v104
  v_exp_f32 v105, v105
  v_exp_f32 v106, v106
  v_exp_f32 v107, v107
  v_mfma_f32_32x32x16_bf16 v[56:71], v[180:183], v[124:127], v[56:71]
  v_exp_f32 v108, v108
  v_exp_f32 v109, v109
  v_exp_f32 v110, v110
  v_exp_f32 v111, v111
  v_mfma_f32_32x32x16_bf16 v[88:103], v[136:139], v[8:11], v[24:39]
  v_cvt_pk_bf16_f32 v128, v104, v105
  v_cvt_pk_bf16_f32 v129, v106, v107
  v_cvt_pk_bf16_f32 v130, v108, v109
  v_cvt_pk_bf16_f32 v131, v110, v111
  v_exp_f32 v112, v112
  v_exp_f32 v113, v113
  v_mfma_f32_32x32x16_bf16 v[88:103], v[140:143], v[12:15], v[88:103]
  v_exp_f32 v114, v114
  v_exp_f32 v115, v115
  v_exp_f32 v116, v116
  v_exp_f32 v117, v117
  v_mfma_f32_32x32x16_bf16 v[72:87], v[176:179], v[128:131], v[72:87]
  v_exp_f32 v118, v118
  v_exp_f32 v119, v119
  v_cvt_pk_bf16_f32 v132, v112, v113
  v_cvt_pk_bf16_f32 v133, v114, v115
  v_cvt_pk_bf16_f32 v134, v116, v117
  v_cvt_pk_bf16_f32 v135, v118, v119
  s_nop 0
  v_exp_f32 v88, v88
  v_exp_f32 v89, v89
  v_exp_f32 v90, v90
  v_exp_f32 v91, v91
  v_mfma_f32_32x32x16_bf16 v[72:87], v[180:183], v[132:135], v[72:87]
  v_exp_f32 v92, v92
  v_exp_f32 v93, v93
  v_exp_f32 v94, v94
  v_exp_f32 v95, v95
  v_mfma_f32_32x32x16_bf16 v[104:119], v[136:139], v[16:19], v[40:55]
  v_cvt_pk_bf16_f32 v120, v88, v89
  v_cvt_pk_bf16_f32 v121, v90, v91
  v_cvt_pk_bf16_f32 v122, v92, v93
  v_cvt_pk_bf16_f32 v123, v94, v95
  v_exp_f32 v96, v96
  v_exp_f32 v97, v97
  v_mfma_f32_32x32x16_bf16 v[104:119], v[140:143], v[20:23], v[104:119]
  v_exp_f32 v98, v98
  v_exp_f32 v99, v99
  v_exp_f32 v100, v100
  v_exp_f32 v101, v101
  v_mfma_f32_32x32x16_bf16 v[56:71], v[144:147], v[120:123], v[56:71]
  v_exp_f32 v102, v102
  v_exp_f32 v103, v103
  v_cvt_pk_bf16_f32 v124, v96, v97
  v_cvt_pk_bf16_f32 v125, v98, v99
  v_cvt_pk_bf16_f32 v126, v100, v101
  v_cvt_pk_bf16_f32 v127, v102, v103
  s_nop 0
  v_exp_f32 v104, v104
  v_exp_f32 v105, v105
  v_exp_f32 v106, v106
  v_exp_f32 v107, v107
  v_mfma_f32_32x32x16_bf16 v[56:71], v[148:151], v[124:127], v[56:71]
  v_exp_f32 v108, v108
  v_exp_f32 v109, v109
  v_exp_f32 v110, v110
  v_exp_f32 v111, v111
  v_cvt_pk_bf16_f32 v128, v104, v105
  v_cvt_pk_bf16_f32 v129, v106, v107
  v_cvt_pk_bf16_f32 v130, v108, v109
  v_cvt_pk_bf16_f32 v131, v110, v111
  v_exp_f32 v112, v112
  v_exp_f32 v113, v113
  v_exp_f32 v114, v114
  v_exp_f32 v115, v115
  v_exp_f32 v116, v116
  v_exp_f32 v117, v117
  v_mfma_f32_32x32x16_bf16 v[72:87], v[144:147], v[128:131], v[72:87]
  v_exp_f32 v118, v118
  v_exp_f32 v119, v119
  v_cvt_pk_bf16_f32 v132, v112, v113
  v_cvt_pk_bf16_f32 v133, v114, v115
  v_cvt_pk_bf16_f32 v134, v116, v117
  v_cvt_pk_bf16_f32 v135, v118, v119
  s_nop 1
  v_mfma_f32_32x32x16_bf16 v[72:87], v[148:151], v[132:135], v[72:87]
  v_mov_b32 v2, v64
  v_mov_b32 v4, v2
  s_nop 1
  v_permlane32_swap_b32 v4, v2
  s_nop 6
  v_mov_b32 v3, v80
  v_mov_b32 v4, v3
  s_nop 1
  v_permlane32_swap_b32 v4, v3
  s_cmp_eq_u32 s28, 1
  s_cbranch_scc1 attnb_done5
  v_max_f32 v4, v2, v3
  v_cmp_nge_f32 vcc, 0x4e800000, v4
  v_cmp_u_f32 s[30:31], v2, v3
  s_nop 3
  s_or_b64 s[32:33], vcc, s[30:31]
  s_movk_i32 s34, 0x207
  v_cmp_class_f32 vcc, v56, s34
  s_nop 3
  s_or_b64 s[32:33], s[32:33], vcc
  v_cmp_class_f32 vcc, v57, s34
  s_nop 3
  s_or_b64 s[32:33], s[32:33], vcc
  v_cmp_class_f32 vcc, v58, s34
  s_nop 3
  s_or_b64 s[32:33], s[32:33], vcc
  v_cmp_class_f32 vcc, v59, s34
  s_nop 3
  s_or_b64 s[32:33], s[32:33], vcc
  v_cmp_class_f32 vcc, v60, s34
  s_nop 3
  s_or_b64 s[32:33], s[32:33], vcc
  v_cmp_class_f32 vcc, v61, s34
  s_nop 3
  s_or_b64 s[32:33], s[32:33], vcc
  v_cmp_class_f32 vcc, v62, s34
  s_nop 3
  s_or_b64 s[32:33], s[32:33], vcc
  v_cmp_class_f32 vcc, v63, s34
  s_nop 3
  s_or_b64 s[32:33], s[32:33], vcc
  v_cmp_class_f32 vcc, v64, s34
  s_nop 3
  s_or_b64 s[32:33], s[32:33], vcc
  v_cmp_class_f32 vcc, v65, s34
  s_nop 3
  s_or_b64 s[32:33], s[32:33], vcc
  v_cmp_class_f32 vcc, v66, s34
  s_nop 3
  s_or_b64 s[32:33], s[32:33], vcc
  v_cmp_class_f32 vcc, v67, s34
  s_nop 3
  s_or_b64 s[32:33], s[32:33], vcc
  v_cmp_class_f32 vcc, v68, s34
  s_nop 3
  s_or_b64 s[32:33], s[32:33], vcc
  v_cmp_class_f32 vcc, v69, s34
  s_nop 3
  s_or_b64 s[32:33], s[32:33], vcc
  v_cmp_class_f32 vcc, v70, s34
  s_nop 3
  s_or_b64 s[32:33], s[32:33], vcc
  v_cmp_class_f32 vcc, v71, s34
  s_nop 3
  s_or_b64 s[32:33], s[32:33], vcc
  v_cmp_class_f32 vcc, v72, s34
  s_nop 3
  s_or_b64 s[32:33], s[32:33], vcc
  v_cmp_class_f32 vcc, v73, s34
  s_nop 3
  s_or_b64 s[32:33], s[32:33], vcc
  v_cmp_class_f32 vcc, v74, s34
  s_nop 3
  s_or_b64 s[32:33], s[32:33], vcc
  v_cmp_class_f32 vcc, v75, s34
  s_nop 3
  s_or_b64 s[32:33], s[32:33], vcc
  v_cmp_class_f32 vcc, v76, s34
  s_nop 3
  s_or_b64 s[32:33], s[32:33], vcc
  v_cmp_class_f32 vcc, v77, s34
  s_nop 3
  s_or_b64 s[32:33], s[32:33], vcc
  v_cmp_class_f32 vcc, v78, s34
  s_nop 3
  s_or_b64 s[32:33], s[32:33], vcc
  v_cmp_class_f32 vcc, v79, s34
  s_nop 3
  s_or_b64 s[32:33], s[32:33], vcc
  v_cmp_class_f32 vcc, v80, s34
  s_nop 3
  s_or_b64 s[32:33], s[32:33], vcc
  v_cmp_class_f32 vcc, v81, s34
  s_nop 3
  s_or_b64 s[32:33], s[32:33], vcc
  v_cmp_class_f32 vcc, v82, s34
  s_nop 3
  s_or_b64 s[32:33], s[32:33], vcc
  v_cmp_class_f32 vcc, v83, s34
  s_nop 3
  s_or_b64 s[32:33], s[32:33], vcc
  v_cmp_class_f32 vcc, v84, s34
  s_nop 3
  s_or_b64 s[32:33], s[32:33], vcc
  v_cmp_class_f32 vcc, v85, s34
  s_nop 3
  s_or_b64 s[32:33], s[32:33], vcc
  v_cmp_class_f32 vcc, v86, s34
  s_nop 3
  s_or_b64 s[32:33], s[32:33], vcc
  v_cmp_class_f32 vcc, v87, s34
  s_nop 3
  s_or_b64 s[32:33], s[32:33], vcc
  s_mov_b64 vcc, s[32:33]
  s_cbranch_vccz attnb_done5
  s_mov_b32 s25, s21
  s_mov_b32 s27, 0
  v_mov_b32 v120, 0xff800000
  v_mov_b32 v121, 0xff800000
attnb_fb4:
  buffer_load_dwordx4 v[136:139], v1, s[4:7], s25 offen
  buffer_load_dwordx4 v[140:143], v1, s[4:7], s25 offen offset:1024
  s_add_u32 s25, s25, 2048
  s_waitcnt vmcnt(0)
  v_mfma_f32_32x32x16_bf16 v[88:103], v[136:139], v[8:11], 0
  v_mfma_f32_32x32x16_bf16 v[88:103], v[140:143], v[12:15], v[88:103]
  v_mfma_f32_32x32x16_bf16 v[104:119], v[136:139], v[16:19], 0
  v_mfma_f32_32x32x16_bf16 v[104:119], v[140:143], v[20:23], v[104:119]
  s_nop 9
  v_max3_f32 v2, v88, v89, v90
  v_max3_f32 v2, v2, v91, v92
  v_max3_f32 v2, v2, v93, v94
  v_max3_f32 v2, v2, v95, v96
  v_max3_f32 v2, v2, v97, v98
  v_max3_f32 v2, v2, v99, v100
  v_max3_f32 v2, v2, v101, v102
  v_max_f32 v2, v2, v103
  v_max_f32 v120, v120, v2
  s_nop 2
  v_max3_f32 v3, v104, v105, v106
  v_max3_f32 v3, v3, v107, v108
  v_max3_f32 v3, v3, v109, v110
  v_max3_f32 v3, v3, v111, v112
  v_max3_f32 v3, v3, v113, v114
  v_max3_f32 v3, v3, v115, v116
  v_max3_f32 v3, v3, v117, v118
  v_max_f32 v3, v3, v119
  v_max_f32 v121, v121, v3
  s_add_u32 s27, s27, 1
  s_cmp_lt_u32 s27, 64
  s_cbranch_scc1 attnb_fb4
  v_mov_b32 v4, v120
  s_nop 1
  v_permlane32_swap_b32 v120, v4
  v_max_f32 v120, v120, v4
  v_sub_f32 v24, 0, v120
  v_sub_f32 v25, 0, v120
  v_sub_f32 v26, 0, v120
  v_sub_f32 v27, 0, v120
  v_sub_f32 v28, 0, v120
  v_sub_f32 v29, 0, v120
  v_sub_f32 v30, 0, v120
  v_sub_f32 v31, 0, v120
  v_sub_f32 v32, 0, v120
  v_sub_f32 v33, 0, v120
  v_sub_f32 v34, 0, v120
  v_sub_f32 v35, 0, v120
  v_sub_f32 v36, 0, v120
  v_sub_f32 v37, 0, v120
  v_sub_f32 v38, 0, v120
  v_sub_f32 v39, 0, v120
  v_mov_b32 v4, v121
  s_nop 1
  v_permlane32_swap_b32 v121, v4
  v_max_f32 v121, v121, v4
  v_sub_f32 v40, 0, v121
  v_sub_f32 v41, 0, v121
  v_sub_f32 v42, 0, v121
  v_sub_f32 v43, 0, v121
  v_sub_f32 v44, 0, v121
  v_sub_f32 v45, 0, v121
  v_sub_f32 v46, 0, v121
  v_sub_f32 v47, 0, v121
  v_sub_f32 v48, 0, v121
  v_sub_f32 v49, 0, v121
  v_sub_f32 v50, 0, v121
  v_sub_f32 v51, 0, v121
  v_sub_f32 v52, 0, v121
  v_sub_f32 v53, 0, v121
  v_sub_f32 v54, 0, v121
  v_sub_f32 v55, 0, v121
  s_mov_b32 s28, 1
  s_branch attnb_main2
attnb_done5:
  v_and_b32 v136, 63, v0
  v_and_b32 v137, 15, v136
  v_lshlrev_b32 v137, 4, v137
  v_lshrrev_b32 v138, 5, v136
  v_lshl_add_u32 v137, v138, 8, v137
  v_bfe_u32 v138, v136, 4, 1
  v_lshl_add_u32 v137, v138, 15, v137
  s_lshl_b32 s24, s23, 16
  s_lshl_b32 s25, s17, 10
  s_add_u32 s24, s24, s25
  s_add_u32 s24, s24, 50331648
  v_rcp_f32 v4, v2
  s_nop 0
  v_mul_f32 v56, v56, v4
  v_mul_f32 v57, v57, v4
  v_mul_f32 v58, v58, v4
  v_mul_f32 v59, v59, v4
  v_mul_f32 v60, v60, v4
  v_mul_f32 v61, v61, v4
  v_mul_f32 v62, v62, v4
  v_mul_f32 v63, v63, v4
  v_mul_f32 v64, v64, v4
  v_mul_f32 v65, v65, v4
  v_mul_f32 v66, v66, v4
  v_mul_f32 v67, v67, v4
  v_mul_f32 v68, v68, v4
  v_mul_f32 v69, v69, v4
  v_mul_f32 v70, v70, v4
  v_mul_f32 v71, v71, v4
  v_cvt_pk_bf16_f32 v120, v56, v57
  v_cvt_pk_bf16_f32 v121, v58, v59
  v_cvt_pk_bf16_f32 v122, v60, v61
  v_cvt_pk_bf16_f32 v123, v62, v63
  v_cvt_pk_bf16_f32 v124, v64, v65
  v_cvt_pk_bf16_f32 v125, v66, v67
  v_cvt_pk_bf16_f32 v126, v68, v69
  v_cvt_pk_bf16_f32 v127, v70, v71
  buffer_store_dwordx4 v[120:123], v137, s[4:7], s24 offen sc1
  buffer_store_dwordx4 v[124:127], v137, s[4:7], s24 offen offset:512 sc1
  v_rcp_f32 v4, v3
  s_nop 0
  v_mul_f32 v72, v72, v4
  v_mul_f32 v73, v73, v4
  v_mul_f32 v74, v74, v4
  v_mul_f32 v75, v75, v4
  v_mul_f32 v76, v76, v4
  v_mul_f32 v77, v77, v4
  v_mul_f32 v78, v78, v4
  v_mul_f32 v79, v79, v4
  v_mul_f32 v80, v80, v4
  v_mul_f32 v81, v81, v4
  v_mul_f32 v82, v82, v4
  v_mul_f32 v83, v83, v4
  v_mul_f32 v84, v84, v4
  v_mul_f32 v85, v85, v4
  v_mul_f32 v86, v86, v4
  v_mul_f32 v87, v87, v4
  v_cvt_pk_bf16_f32 v128, v72, v73
  v_cvt_pk_bf16_f32 v129, v74, v75
  v_cvt_pk_bf16_f32 v130, v76, v77
  v_cvt_pk_bf16_f32 v131, v78, v79
  v_cvt_pk_bf16_f32 v132, v80, v81
  v_cvt_pk_bf16_f32 v133, v82, v83
  v_cvt_pk_bf16_f32 v134, v84, v85
  v_cvt_pk_bf16_f32 v135, v86, v87
  s_add_u32 s24, s24, 65536
  buffer_store_dwordx4 v[128:131], v137, s[4:7], s24 offen sc1
  buffer_store_dwordx4 v[132:135], v137, s[4:7], s24 offen offset:512 sc1
attnb_exit1:
  s_endpgm
.globl outb1_kernel
.p2align 8
.type outb1_kernel,@function
outb1_kernel:
  s_cmp_ge_u32 s2, 256
  s_cbranch_scc1 outb1_exit1
  s_load_dwordx2 s[12:13], s[0:1], 96
  s_load_dwordx2 s[14:15], s[0:1], 0
  s_load_dwordx2 s[48:49], s[0:1], 80
  v_lshrrev_b32 v3, 6, v0
  v_and_b32 v4, 63, v0
  s_nop 0
  v_readfirstlane_b32 s16, v3
  v_lshlrev_b32 v1, 4, v4
  s_and_b32 s17, s2, 7
  s_lshl_b32 s17, s17, 2
  s_lshr_b32 s18, s2, 3
  s_and_b32 s19, s18, 3
  s_add_u32 s17, s17, s19
  s_lshr_b32 s18, s18, 2
  s_waitcnt lgkmcnt(0)
  s_mov_b32 s4, s12
  s_mov_b32 s5, s13
  s_mov_b32 s6, 0x10000000
  s_mov_b32 s7, 0x20000
  s_mov_b32 s8, s12
  s_mov_b32 s9, s13
  s_mov_b32 s10, 0x10000000
  s_mov_b32 s11, 0x20000
  s_mov_b32 s20, 82313216
  s_mov_b32 s52, s48
  s_mov_b32 s53, s49
  s_mov_b32 s54, 2621440
  s_mov_b32 s55, 0x20000
  s_mul_i32 s21, s18, 5
  s_mul_i32 s21, s21, 32768
  s_add_u32 s24, s21, 91488256
  s_add_u32 s25, s24, 32768
  s_add_u32 s26, s25, 32768
  s_add_u32 s27, s26, 32768
  s_add_u32 s28, s27, 32768
  s_lshl_b32 s21, s17, 2
  s_add_u32 s21, s21, s16
  s_mul_i32 s22, s21, 32768
  s_add_u32 s22, s22, 50331648
  s_lshl_b32 s23, s16, 10
  v_add_u32 v2, s23, v1
  s_mul_i32 s29, s16, 5120
  s_add_u32 m0, s29, 0
  s_nop 0
  buffer_load_dwordx4 v2, s[4:7], s24 offen lds
  s_add_u32 m0, s29, 1024
  s_nop 0
  buffer_load_dwordx4 v2, s[4:7], s25 offen lds
  s_add_u32 m0, s29, 2048
  s_nop 0
  buffer_load_dwordx4 v2, s[4:7], s26 offen lds
  s_add_u32 m0, s29, 3072
  s_nop 0
  buffer_load_dwordx4 v2, s[4:7], s27 offen lds
  s_add_u32 m0, s29, 4096
  s_nop 0
  buffer_load_dwordx4 v2, s[4:7], s28 offen lds
  buffer_load_dwordx4 v[32:35], v1, s[4:7], s22 offen offset:0
  buffer_load_dwordx4 v[36:39], v1, s[4:7], s22 offen offset:1024
  buffer_load_dwordx4 v[40:43], v1, s[4:7], s22 offen offset:2048
  buffer_load_dwordx4 v[44:47], v1, s[4:7], s22 offen offset:3072
  v_add_u32 v2, 0x1000, v2
  s_add_u32 s22, s22, 4096
  s_add_u32 m0, s29, 20480
  s_nop 0
  buffer_load_dwordx4 v2, s[4:7], s24 offen lds
  s_add_u32 m0, s29, 21504
  s_nop 0
  buffer_load_dwordx4 v2, s[4:7], s25 offen lds
  s_add_u32 m0, s29, 22528
  s_nop 0
  buffer_load_dwordx4 v2, s[4:7], s26 offen lds
  s_add_u32 m0, s29, 23552
  s_nop 0
  buffer_load_dwordx4 v2, s[4:7], s27 offen lds
  s_add_u32 m0, s29, 24576
  s_nop 0
  buffer_load_dwordx4 v2, s[4:7], s28 offen lds
  buffer_load_dwordx4 v[48:51], v1, s[4:7], s22 offen offset:0
  buffer_load_dwordx4 v[52:55], v1, s[4:7], s22 offen offset:1024
  buffer_load_dwordx4 v[56:59], v1, s[4:7], s22 offen offset:2048
  buffer_load_dwordx4 v[60:63], v1, s[4:7], s22 offen offset:3072
  v_add_u32 v2, 0x1000, v2
  s_add_u32 s22, s22, 4096
  s_waitcnt vmcnt(9)
  s_barrier
  s_add_u32 m0, s29, 40960
  s_nop 0
  buffer_load_dwordx4 v2, s[4:7], s24 offen lds
  s_add_u32 m0, s29, 41984
  s_nop 0
  buffer_load_dwordx4 v2, s[4:7], s25 offen lds
  s_add_u32 m0, s29, 43008
  s_nop 0
  buffer_load_dwordx4 v2, s[4:7], s26 offen lds
  s_add_u32 m0, s29, 44032
  s_nop 0
  buffer_load_dwordx4 v2, s[4:7], s27 offen lds
  s_add_u32 m0, s29, 45056
  s_nop 0
  buffer_load_dwordx4 v2, s[4:7], s28 offen lds
  buffer_load_dwordx4 v[64:67], v1, s[4:7], s22 offen offset:0
  buffer_load_dwordx4 v[68:71], v1, s[4:7], s22 offen offset:1024
  buffer_load_dwordx4 v[72:75], v1, s[4:7], s22 offen offset:2048
  buffer_load_dwordx4 v[76:79], v1, s[4:7], s22 offen offset:3072
  v_add_u32 v2, 0x1000, v2
  s_add_u32 s22, s22, 4096
  ds_read_b128 v[80:83], v1 offset:0
  ds_read_b128 v[84:87], v1 offset:1024
  ds_read_b128 v[88:91], v1 offset:2048
  ds_read_b128 v[92:95], v1 offset:3072
  ds_read_b128 v[96:99], v1 offset:4096
  ds_read_b128 v[100:103], v1 offset:5120
  ds_read_b128 v[104:107], v1 offset:6144
  ds_read_b128 v[108:111], v1 offset:7168
  ds_read_b128 v[112:115], v1 offset:8192
  ds_read_b128 v[116:119], v1 offset:9216
  s_waitcnt lgkmcnt(5)
  v_mfma_f32_16x16x32_bf16 v[8:11], v[80:83], v[32:35], 0
  v_mfma_f32_16x16x32_bf16 v[12:15], v[84:87], v[32:35], 0
  v_mfma_f32_16x16x32_bf16 v[16:19], v[88:91], v[32:35], 0
  v_mfma_f32_16x16x32_bf16 v[20:23], v[92:95], v[32:35], 0
  v_mfma_f32_16x16x32_bf16 v[24:27], v[96:99], v[32:35], 0
  ds_read_b128 v[80:83], v1 offset:10240
  ds_read_b128 v[84:87], v1 offset:11264
  ds_read_b128 v[88:91], v1 offset:12288
  ds_read_b128 v[92:95], v1 offset:13312
  ds_read_b128 v[96:99], v1 offset:14336
  s_waitcnt lgkmcnt(5)
  v_mfma_f32_16x16x32_bf16 v[8:11], v[100:103], v[36:39], v[8:11]
  v_mfma_f32_16x16x32_bf16 v[12:15], v[104:107], v[36:39], v[12:15]
  v_mfma_f32_16x16x32_bf16 v[16:19], v[108:111], v[36:39], v[16:19]
  v_mfma_f32_16x16x32_bf16 v[20:23], v[112:115], v[36:39], v[20:23]
  v_mfma_f32_16x16x32_bf16 v[24:27], v[116:119], v[36:39], v[24:27]
  ds_read_b128 v[100:103], v1 offset:15360
  ds_read_b128 v[104:107], v1 offset:16384
  ds_read_b128 v[108:111], v1 offset:17408
  ds_read_b128 v[112:115], v1 offset:18432
  ds_read_b128 v[116:119], v1 offset:19456
  s_waitcnt lgkmcnt(5)
  v_mfma_f32_16x16x32_bf16 v[8:11], v[80:83], v[40:43], v[8:11]
  v_mfma_f32_16x16x32_bf16 v[12:15], v[84:87], v[40:43], v[12:15]
  v_mfma_f32_16x16x32_bf16 v[16:19], v[88:91], v[40:43], v[16:19]
  v_mfma_f32_16x16x32_bf16 v[20:23], v[92:95], v[40:43], v[20:23]
  v_mfma_f32_16x16x32_bf16 v[24:27], v[96:99], v[40:43], v[24:27]
  s_waitcnt lgkmcnt(0)
  v_mfma_f32_16x16x32_bf16 v[8:11], v[100:103], v[44:47], v[8:11]
  v_mfma_f32_16x16x32_bf16 v[12:15], v[104:107], v[44:47], v[12:15]
  v_mfma_f32_16x16x32_bf16 v[16:19], v[108:111], v[44:47], v[16:19]
  v_mfma_f32_16x16x32_bf16 v[20:23], v[112:115], v[44:47], v[20:23]
  v_mfma_f32_16x16x32_bf16 v[24:27], v[116:119], v[44:47], v[24:27]
  s_mov_b32 s30, 0
outb1_loop2:
  s_waitcnt vmcnt(9)
  s_barrier
  s_add_u32 m0, s29, 0
  s_nop 0
  buffer_load_dwordx4 v2, s[4:7], s24 offen lds
  s_add_u32 m0, s29, 1024
  s_nop 0
  buffer_load_dwordx4 v2, s[4:7], s25 offen lds
  s_add_u32 m0, s29, 2048
  s_nop 0
  buffer_load_dwordx4 v2, s[4:7], s26 offen lds
  s_add_u32 m0, s29, 3072
  s_nop 0
  buffer_load_dwordx4 v2, s[4:7], s27 offen lds
  s_add_u32 m0, s29, 4096
  s_nop 0
  buffer_load_dwordx4 v2, s[4:7], s28 offen lds
  buffer_load_dwordx4 v[32:35], v1, s[4:7], s22 offen offset:0
  buffer_load_dwordx4 v[36:39], v1, s[4:7], s22 offen offset:1024
  buffer_load_dwordx4 v[40:43], v1, s[4:7], s22 offen offset:2048
  buffer_load_dwordx4 v[44:47], v1, s[4:7], s22 offen offset:3072
  v_add_u32 v2, 0x1000, v2
  s_add_u32 s22, s22, 4096
  ds_read_b128 v[80:83], v1 offset:20480
  ds_read_b128 v[84:87], v1 offset:21504
  ds_read_b128 v[88:91], v1 offset:22528
  ds_read_b128 v[92:95], v1 offset:23552
  ds_read_b128 v[96:99], v1 offset:24576
  ds_read_b128 v[100:103], v1 offset:25600
  ds_read_b128 v[104:107], v1 offset:26624
  ds_read_b128 v[108:111], v1 offset:27648
  ds_read_b128 v[112:115], v1 offset:28672
  ds_read_b128 v[116:119], v1 offset:29696
  s_waitcnt lgkmcnt(5)
  v_mfma_f32_16x16x32_bf16 v[8:11], v[80:83], v[48:51], v[8:11]
  v_mfma_f32_16x16x32_bf16 v[12:15], v[84:87], v[48:51], v[12:15]
  v_mfma_f32_16x16x32_bf16 v[16:19], v[88:91], v[48:51], v[16:19]
  v_mfma_f32_16x16x32_bf16 v[20:23], v[92:95], v[48:51], v[20:23]
  v_mfma_f32_16x16x32_bf16 v[24:27], v[96:99], v[48:51], v[24:27]
  ds_read_b128 v[80:83], v1 offset:30720
  ds_read_b128 v[84:87], v1 offset:31744
  ds_read_b128 v[88:91], v1 offset:32768
  ds_read_b128 v[92:95], v1 offset:33792
  ds_read_b128 v[96:99], v1 offset:34816
  s_waitcnt lgkmcnt(5)
  v_mfma_f32_16x16x32_bf16 v[8:11], v[100:103], v[52:55], v[8:11]
  v_mfma_f32_16x16x32_bf16 v[12:15], v[104:107], v[52:55], v[12:15]
  v_mfma_f32_16x16x32_bf16 v[16:19], v[108:111], v[52:55], v[16:19]
  v_mfma_f32_16x16x32_bf16 v[20:23], v[112:115], v[52:55], v[20:23]
  v_mfma_f32_16x16x32_bf16 v[24:27], v[116:119], v[52:55], v[24:27]
  ds_read_b128 v[100:103], v1 offset:35840
  ds_read_b128 v[104:107], v1 offset:36864
  ds_read_b128 v[108:111], v1 offset:37888
  ds_read_b128 v[112:115], v1 offset:38912
  ds_read_b128 v[116:119], v1 offset:39936
  s_waitcnt lgkmcnt(5)
  v_mfma_f32_16x16x32_bf16 v[8:11], v[80:83], v[56:59], v[8:11]
  v_mfma_f32_16x16x32_bf16 v[12:15], v[84:87], v[56:59], v[12:15]
  v_mfma_f32_16x16x32_bf16 v[16:19], v[88:91], v[56:59], v[16:19]
  v_mfma_f32_16x16x32_bf16 v[20:23], v[92:95], v[56:59], v[20:23]
  v_mfma_f32_16x16x32_bf16 v[24:27], v[96:99], v[56:59], v[24:27]
  s_waitcnt lgkmcnt(0)
  v_mfma_f32_16x16x32_bf16 v[8:11], v[100:103], v[60:63], v[8:11]
  v_mfma_f32_16x16x32_bf16 v[12:15], v[104:107], v[60:63], v[12:15]
  v_mfma_f32_16x16x32_bf16 v[16:19], v[108:111], v[60:63], v[16:19]
  v_mfma_f32_16x16x32_bf16 v[20:23], v[112:115], v[60:63], v[20:23]
  v_mfma_f32_16x16x32_bf16 v[24:27], v[116:119], v[60:63], v[24:27]
  s_waitcnt vmcnt(9)
  s_barrier
  s_add_u32 m0, s29, 20480
  s_nop 0
  buffer_load_dwordx4 v2, s[4:7], s24 offen lds
  s_add_u32 m0, s29, 21504
  s_nop 0
  buffer_load_dwordx4 v2, s[4:7], s25 offen lds
  s_add_u32 m0, s29, 22528
  s_nop 0
  buffer_load_dwordx4 v2, s[4:7], s26 offen lds
  s_add_u32 m0, s29, 23552
  s_nop 0
  buffer_load_dwordx4 v2, s[4:7], s27 offen lds
  s_add_u32 m0, s29, 24576
  s_nop 0
  buffer_load_dwordx4 v2, s[4:7], s28 offen lds
  buffer_load_dwordx4 v[48:51], v1, s[4:7], s22 offen offset:0
  buffer_load_dwordx4 v[52:55], v1, s[4:7], s22 offen offset:1024
  buffer_load_dwordx4 v[56:59], v1, s[4:7], s22 offen offset:2048
  buffer_load_dwordx4 v[60:63], v1, s[4:7], s22 offen offset:3072
  v_add_u32 v2, 0x1000, v2
  s_add_u32 s22, s22, 4096
  ds_read_b128 v[80:83], v1 offset:40960
  ds_read_b128 v[84:87], v1 offset:41984
  ds_read_b128 v[88:91], v1 offset:43008
  ds_read_b128 v[92:95], v1 offset:44032
  ds_read_b128 v[96:99], v1 offset:45056
  ds_read_b128 v[100:103], v1 offset:46080
  ds_read_b128 v[104:107], v1 offset:47104
  ds_read_b128 v[108:111], v1 offset:48128
  ds_read_b128 v[112:115], v1 offset:49152
  ds_read_b128 v[116:119], v1 offset:50176
  s_waitcnt lgkmcnt(5)
  v_mfma_f32_16x16x32_bf16 v[8:11], v[80:83], v[64:67], v[8:11]
  v_mfma_f32_16x16x32_bf16 v[12:15], v[84:87], v[64:67], v[12:15]
  v_mfma_f32_16x16x32_bf16 v[16:19], v[88:91], v[64:67], v[16:19]
  v_mfma_f32_16x16x32_bf16 v[20:23], v[92:95], v[64:67], v[20:23]
  v_mfma_f32_16x16x32_bf16 v[24:27], v[96:99], v[64:67], v[24:27]
  ds_read_b128 v[80:83], v1 offset:51200
  ds_read_b128 v[84:87], v1 offset:52224
  ds_read_b128 v[88:91], v1 offset:53248
  ds_read_b128 v[92:95], v1 offset:54272
  ds_read_b128 v[96:99], v1 offset:55296
  s_waitcnt lgkmcnt(5)
  v_mfma_f32_16x16x32_bf16 v[8:11], v[100:103], v[68:71], v[8:11]
  v_mfma_f32_16x16x32_bf16 v[12:15], v[104:107], v[68:71], v[12:15]
  v_mfma_f32_16x16x32_bf16 v[16:19], v[108:111], v[68:71], v[16:19]
  v_mfma_f32_16x16x32_bf16 v[20:23], v[112:115], v[68:71], v[20:23]
  v_mfma_f32_16x16x32_bf16 v[24:27], v[116:119], v[68:71], v[24:27]
  ds_read_b128 v[100:103], v1 offset:56320
  ds_read_b128 v[104:107], v1 offset:57344
  ds_read_b128 v[108:111], v1 offset:58368
  ds_read_b128 v[112:115], v1 offset:59392
  ds_read_b128 v[116:119], v1 offset:60416
  s_waitcnt lgkmcnt(5)
  v_mfma_f32_16x16x32_bf16 v[8:11], v[80:83], v[72:75], v[8:11]
  v_mfma_f32_16x16x32_bf16 v[12:15], v[84:87], v[72:75], v[12:15]
  v_mfma_f32_16x16x32_bf16 v[16:19], v[88:91], v[72:75], v[16:19]
  v_mfma_f32_16x16x32_bf16 v[20:23], v[92:95], v[72:75], v[20:23]
  v_mfma_f32_16x16x32_bf16 v[24:27], v[96:99], v[72:75], v[24:27]
  s_waitcnt lgkmcnt(0)
  v_mfma_f32_16x16x32_bf16 v[8:11], v[100:103], v[76:79], v[8:11]
  v_mfma_f32_16x16x32_bf16 v[12:15], v[104:107], v[76:79], v[12:15]
  v_mfma_f32_16x16x32_bf16 v[16:19], v[108:111], v[76:79], v[16:19]
  v_mfma_f32_16x16x32_bf16 v[20:23], v[112:115], v[76:79], v[20:23]
  v_mfma_f32_16x16x32_bf16 v[24:27], v[116:119], v[76:79], v[24:27]
  s_waitcnt vmcnt(9)
  s_barrier
  s_add_u32 m0, s29, 40960
  s_nop 0
  buffer_load_dwordx4 v2, s[4:7], s24 offen lds
  s_add_u32 m0, s29, 41984
  s_nop 0
  buffer_load_dwordx4 v2, s[4:7], s25 offen lds
  s_add_u32 m0, s29, 43008
  s_nop 0
  buffer_load_dwordx4 v2, s[4:7], s26 offen lds
  s_add_u32 m0, s29, 44032
  s_nop 0
  buffer_load_dwordx4 v2, s[4:7], s27 offen lds
  s_add_u32 m0, s29, 45056
  s_nop 0
  buffer_load_dwordx4 v2, s[4:7], s28 offen lds
  buffer_load_dwordx4 v[64:67], v1, s[4:7], s22 offen offset:0
  buffer_load_dwordx4 v[68:71], v1, s[4:7], s22 offen offset:1024
  buffer_load_dwordx4 v[72:75], v1, s[4:7], s22 offen offset:2048
  buffer_load_dwordx4 v[76:79], v1, s[4:7], s22 offen offset:3072
  v_add_u32 v2, 0x1000, v2
  s_add_u32 s22, s22, 4096
  ds_read_b128 v[80:83], v1 offset:0
  ds_read_b128 v[84:87], v1 offset:1024
  ds_read_b128 v[88:91], v1 offset:2048
  ds_read_b128 v[92:95], v1 offset:3072
  ds_read_b128 v[96:99], v1 offset:4096
  ds_read_b128 v[100:103], v1 offset:5120
  ds_read_b128 v[104:107], v1 offset:6144
  ds_read_b128 v[108:111], v1 offset:7168
  ds_read_b128 v[112:115], v1 offset:8192
  ds_read_b128 v[116:119], v1 offset:9216
  s_waitcnt lgkmcnt(5)
  v_mfma_f32_16x16x32_bf16 v[8:11], v[80:83], v[32:35], v[8:11]
  v_mfma_f32_16x16x32_bf16 v[12:15], v[84:87], v[32:35], v[12:15]
  v_mfma_f32_16x16x32_bf16 v[16:19], v[88:91], v[32:35], v[16:19]
  v_mfma_f32_16x16x32_bf16 v[20:23], v[92:95], v[32:35], v[20:23]
  v_mfma_f32_16x16x32_bf16 v[24:27], v[96:99], v[32:35], v[24:27]
  ds_read_b128 v[80:83], v1 offset:10240
  ds_read_b128 v[84:87], v1 offset:11264
  ds_read_b128 v[88:91], v1 offset:12288
  ds_read_b128 v[92:95], v1 offset:13312
  ds_read_b128 v[96:99], v1 offset:14336
  s_waitcnt lgkmcnt(5)
  v_mfma_f32_16x16x32_bf16 v[8:11], v[100:103], v[36:39], v[8:11]
  v_mfma_f32_16x16x32_bf16 v[12:15], v[104:107], v[36:39], v[12:15]
  v_mfma_f32_16x16x32_bf16 v[16:19], v[108:111], v[36:39], v[16:19]
  v_mfma_f32_16x16x32_bf16 v[20:23], v[112:115], v[36:39], v[20:23]
  v_mfma_f32_16x16x32_bf16 v[24:27], v[116:119], v[36:39], v[24:27]
  ds_read_b128 v[100:103], v1 offset:15360
  ds_read_b128 v[104:107], v1 offset:16384
  ds_read_b128 v[108:111], v1 offset:17408
  ds_read_b128 v[112:115], v1 offset:18432
  ds_read_b128 v[116:119], v1 offset:19456
  s_waitcnt lgkmcnt(5)
  v_mfma_f32_16x16x32_bf16 v[8:11], v[80:83], v[40:43], v[8:11]
  v_mfma_f32_16x16x32_bf16 v[12:15], v[84:87], v[40:43], v[12:15]
  v_mfma_f32_16x16x32_bf16 v[16:19], v[88:91], v[40:43], v[16:19]
  v_mfma_f32_16x16x32_bf16 v[20:23], v[92:95], v[40:43], v[20:23]
  v_mfma_f32_16x16x32_bf16 v[24:27], v[96:99], v[40:43], v[24:27]
  s_waitcnt lgkmcnt(0)
  v_mfma_f32_16x16x32_bf16 v[8:11], v[100:103], v[44:47], v[8:11]
  v_mfma_f32_16x16x32_bf16 v[12:15], v[104:107], v[44:47], v[12:15]
  v_mfma_f32_16x16x32_bf16 v[16:19], v[108:111], v[44:47], v[16:19]
  v_mfma_f32_16x16x32_bf16 v[20:23], v[112:115], v[44:47], v[20:23]
  v_mfma_f32_16x16x32_bf16 v[24:27], v[116:119], v[44:47], v[24:27]
  s_add_u32 s30, s30, 1
  s_cmp_lt_u32 s30, 1
  s_cbranch_scc1 outb1_loop2
  s_waitcnt vmcnt(9)
  s_barrier
  s_add_u32 m0, s29, 0
  s_nop 0
  buffer_load_dwordx4 v2, s[4:7], s24 offen lds
  s_add_u32 m0, s29, 1024
  s_nop 0
  buffer_load_dwordx4 v2, s[4:7], s25 offen lds
  s_add_u32 m0, s29, 2048
  s_nop 0
  buffer_load_dwordx4 v2, s[4:7], s26 offen lds
  s_add_u32 m0, s29, 3072
  s_nop 0
  buffer_load_dwordx4 v2, s[4:7], s27 offen lds
  s_add_u32 m0, s29, 4096
  s_nop 0
  buffer_load_dwordx4 v2, s[4:7], s28 offen lds
  buffer_load_dwordx4 v[32:35], v1, s[4:7], s22 offen offset:0
  buffer_load_dwordx4 v[36:39], v1, s[4:7], s22 offen offset:1024
  buffer_load_dwordx4 v[40:43], v1, s[4:7], s22 offen offset:2048
  buffer_load_dwordx4 v[44:47], v1, s[4:7], s22 offen offset:3072
  v_add_u32 v2, 0x1000, v2
  s_add_u32 s22, s22, 4096
  ds_read_b128 v[80:83], v1 offset:20480
  ds_read_b128 v[84:87], v1 offset:21504
  ds_read_b128 v[88:91], v1 offset:22528
  ds_read_b128 v[92:95], v1 offset:23552
  ds_read_b128 v[96:99], v1 offset:24576
  ds_read_b128 v[100:103], v1 offset:25600
  ds_read_b128 v[104:107], v1 offset:26624
  ds_read_b128 v[108:111], v1 offset:27648
  ds_read_b128 v[112:115], v1 offset:28672
  ds_read_b128 v[116:119], v1 offset:29696
  s_waitcnt lgkmcnt(5)
  v_mfma_f32_16x16x32_bf16 v[8:11], v[80:83], v[48:51], v[8:11]
  v_mfma_f32_16x16x32_bf16 v[12:15], v[84:87], v[48:51], v[12:15]
  v_mfma_f32_16x16x32_bf16 v[16:19], v[88:91], v[48:51], v[16:19]
  v_mfma_f32_16x16x32_bf16 v[20:23], v[92:95], v[48:51], v[20:23]
  v_mfma_f32_16x16x32_bf16 v[24:27], v[96:99], v[48:51], v[24:27]
  ds_read_b128 v[80:83], v1 offset:30720
  ds_read_b128 v[84:87], v1 offset:31744
  ds_read_b128 v[88:91], v1 offset:32768
  ds_read_b128 v[92:95], v1 offset:33792
  ds_read_b128 v[96:99], v1 offset:34816
  s_waitcnt lgkmcnt(5)
  v_mfma_f32_16x16x32_bf16 v[8:11], v[100:103], v[52:55], v[8:11]
  v_mfma_f32_16x16x32_bf16 v[12:15], v[104:107], v[52:55], v[12:15]
  v_mfma_f32_16x16x32_bf16 v[16:19], v[108:111], v[52:55], v[16:19]
  v_mfma_f32_16x16x32_bf16 v[20:23], v[112:115], v[52:55], v[20:23]
  v_mfma_f32_16x16x32_bf16 v[24:27], v[116:119], v[52:55], v[24:27]
  ds_read_b128 v[100:103], v1 offset:35840
  ds_read_b128 v[104:107], v1 offset:36864
  ds_read_b128 v[108:111], v1 offset:37888
  ds_read_b128 v[112:115], v1 offset:38912
  ds_read_b128 v[116:119], v1 offset:39936
  s_waitcnt lgkmcnt(5)
  v_mfma_f32_16x16x32_bf16 v[8:11], v[80:83], v[56:59], v[8:11]
  v_mfma_f32_16x16x32_bf16 v[12:15], v[84:87], v[56:59], v[12:15]
  v_mfma_f32_16x16x32_bf16 v[16:19], v[88:91], v[56:59], v[16:19]
  v_mfma_f32_16x16x32_bf16 v[20:23], v[92:95], v[56:59], v[20:23]
  v_mfma_f32_16x16x32_bf16 v[24:27], v[96:99], v[56:59], v[24:27]
  s_waitcnt lgkmcnt(0)
  v_mfma_f32_16x16x32_bf16 v[8:11], v[100:103], v[60:63], v[8:11]
  v_mfma_f32_16x16x32_bf16 v[12:15], v[104:107], v[60:63], v[12:15]
  v_mfma_f32_16x16x32_bf16 v[16:19], v[108:111], v[60:63], v[16:19]
  v_mfma_f32_16x16x32_bf16 v[20:23], v[112:115], v[60:63], v[20:23]
  v_mfma_f32_16x16x32_bf16 v[24:27], v[116:119], v[60:63], v[24:27]
  s_waitcnt vmcnt(9)
  s_barrier
  s_add_u32 m0, s29, 20480
  s_nop 0
  buffer_load_dwordx4 v2, s[4:7], s24 offen lds
  s_add_u32 m0, s29, 21504
  s_nop 0
  buffer_load_dwordx4 v2, s[4:7], s25 offen lds
  s_add_u32 m0, s29, 22528
  s_nop 0
  buffer_load_dwordx4 v2, s[4:7], s26 offen lds
  s_add_u32 m0, s29, 23552
  s_nop 0
  buffer_load_dwordx4 v2, s[4:7], s27 offen lds
  s_add_u32 m0, s29, 24576
  s_nop 0
  buffer_load_dwordx4 v2, s[4:7], s28 offen lds
  buffer_load_dwordx4 v[48:51], v1, s[4:7], s22 offen offset:0
  buffer_load_dwordx4 v[52:55], v1, s[4:7], s22 offen offset:1024
  buffer_load_dwordx4 v[56:59], v1, s[4:7], s22 offen offset:2048
  buffer_load_dwordx4 v[60:63], v1, s[4:7], s22 offen offset:3072
  v_add_u32 v2, 0x1000, v2
  s_add_u32 s22, s22, 4096
  ds_read_b128 v[80:83], v1 offset:40960
  ds_read_b128 v[84:87], v1 offset:41984
  ds_read_b128 v[88:91], v1 offset:43008
  ds_read_b128 v[92:95], v1 offset:44032
  ds_read_b128 v[96:99], v1 offset:45056
  ds_read_b128 v[100:103], v1 offset:46080
  ds_read_b128 v[104:107], v1 offset:47104
  ds_read_b128 v[108:111], v1 offset:48128
  ds_read_b128 v[112:115], v1 offset:49152
  ds_read_b128 v[116:119], v1 offset:50176
  s_waitcnt lgkmcnt(5)
  v_mfma_f32_16x16x32_bf16 v[8:11], v[80:83], v[64:67], v[8:11]
  v_mfma_f32_16x16x32_bf16 v[12:15], v[84:87], v[64:67], v[12:15]
  v_mfma_f32_16x16x32_bf16 v[16:19], v[88:91], v[64:67], v[16:19]
  v_mfma_f32_16x16x32_bf16 v[20:23], v[92:95], v[64:67], v[20:23]
  v_mfma_f32_16x16x32_bf16 v[24:27], v[96:99], v[64:67], v[24:27]
  ds_read_b128 v[80:83], v1 offset:51200
  ds_read_b128 v[84:87], v1 offset:52224
  ds_read_b128 v[88:91], v1 offset:53248
  ds_read_b128 v[92:95], v1 offset:54272
  ds_read_b128 v[96:99], v1 offset:55296
  s_waitcnt lgkmcnt(5)
  v_mfma_f32_16x16x32_bf16 v[8:11], v[100:103], v[68:71], v[8:11]
  v_mfma_f32_16x16x32_bf16 v[12:15], v[104:107], v[68:71], v[12:15]
  v_mfma_f32_16x16x32_bf16 v[16:19], v[108:111], v[68:71], v[16:19]
  v_mfma_f32_16x16x32_bf16 v[20:23], v[112:115], v[68:71], v[20:23]
  v_mfma_f32_16x16x32_bf16 v[24:27], v[116:119], v[68:71], v[24:27]
  ds_read_b128 v[100:103], v1 offset:56320
  ds_read_b128 v[104:107], v1 offset:57344
  ds_read_b128 v[108:111], v1 offset:58368
  ds_read_b128 v[112:115], v1 offset:59392
  ds_read_b128 v[116:119], v1 offset:60416
  s_waitcnt lgkmcnt(5)
  v_mfma_f32_16x16x32_bf16 v[8:11], v[80:83], v[72:75], v[8:11]
  v_mfma_f32_16x16x32_bf16 v[12:15], v[84:87], v[72:75], v[12:15]
  v_mfma_f32_16x16x32_bf16 v[16:19], v[88:91], v[72:75], v[16:19]
  v_mfma_f32_16x16x32_bf16 v[20:23], v[92:95], v[72:75], v[20:23]
  v_mfma_f32_16x16x32_bf16 v[24:27], v[96:99], v[72:75], v[24:27]
  s_waitcnt lgkmcnt(0)
  v_mfma_f32_16x16x32_bf16 v[8:11], v[100:103], v[76:79], v[8:11]
  v_mfma_f32_16x16x32_bf16 v[12:15], v[104:107], v[76:79], v[12:15]
  v_mfma_f32_16x16x32_bf16 v[16:19], v[108:111], v[76:79], v[16:19]
  v_mfma_f32_16x16x32_bf16 v[20:23], v[112:115], v[76:79], v[20:23]
  v_mfma_f32_16x16x32_bf16 v[24:27], v[116:119], v[76:79], v[24:27]
  s_waitcnt vmcnt(9)
  s_barrier
  ds_read_b128 v[80:83], v1 offset:0
  ds_read_b128 v[84:87], v1 offset:1024
  ds_read_b128 v[88:91], v1 offset:2048
  ds_read_b128 v[92:95], v1 offset:3072
  ds_read_b128 v[96:99], v1 offset:4096
  ds_read_b128 v[100:103], v1 offset:5120
  ds_read_b128 v[104:107], v1 offset:6144
  ds_read_b128 v[108:111], v1 offset:7168
  ds_read_b128 v[112:115], v1 offset:8192
  ds_read_b128 v[116:119], v1 offset:9216
  s_waitcnt lgkmcnt(5)
  v_mfma_f32_16x16x32_bf16 v[8:11], v[80:83], v[32:35], v[8:11]
  v_mfma_f32_16x16x32_bf16 v[12:15], v[84:87], v[32:35], v[12:15]
  v_mfma_f32_16x16x32_bf16 v[16:19], v[88:91], v[32:35], v[16:19]
  v_mfma_f32_16x16x32_bf16 v[20:23], v[92:95], v[32:35], v[20:23]
  v_mfma_f32_16x16x32_bf16 v[24:27], v[96:99], v[32:35], v[24:27]
  ds_read_b128 v[80:83], v1 offset:10240
  ds_read_b128 v[84:87], v1 offset:11264
  ds_read_b128 v[88:91], v1 offset:12288
  ds_read_b128 v[92:95], v1 offset:13312
  ds_read_b128 v[96:99], v1 offset:14336
  s_waitcnt lgkmcnt(5)
  v_mfma_f32_16x16x32_bf16 v[8:11], v[100:103], v[36:39], v[8:11]
  v_mfma_f32_16x16x32_bf16 v[12:15], v[104:107], v[36:39], v[12:15]
  v_mfma_f32_16x16x32_bf16 v[16:19], v[108:111], v[36:39], v[16:19]
  v_mfma_f32_16x16x32_bf16 v[20:23], v[112:115], v[36:39], v[20:23]
  v_mfma_f32_16x16x32_bf16 v[24:27], v[116:119], v[36:39], v[24:27]
  ds_read_b128 v[100:103], v1 offset:15360
  ds_read_b128 v[104:107], v1 offset:16384
  ds_read_b128 v[108:111], v1 offset:17408
  ds_read_b128 v[112:115], v1 offset:18432
  ds_read_b128 v[116:119], v1 offset:19456
  s_waitcnt lgkmcnt(5)
  v_mfma_f32_16x16x32_bf16 v[8:11], v[80:83], v[40:43], v[8:11]
  v_mfma_f32_16x16x32_bf16 v[12:15], v[84:87], v[40:43], v[12:15]
  v_mfma_f32_16x16x32_bf16 v[16:19], v[88:91], v[40:43], v[16:19]
  v_mfma_f32_16x16x32_bf16 v[20:23], v[92:95], v[40:43], v[20:23]
  v_mfma_f32_16x16x32_bf16 v[24:27], v[96:99], v[40:43], v[24:27]
  s_waitcnt lgkmcnt(0)
  v_mfma_f32_16x16x32_bf16 v[8:11], v[100:103], v[44:47], v[8:11]
  v_mfma_f32_16x16x32_bf16 v[12:15], v[104:107], v[44:47], v[12:15]
  v_mfma_f32_16x16x32_bf16 v[16:19], v[108:111], v[44:47], v[16:19]
  v_mfma_f32_16x16x32_bf16 v[20:23], v[112:115], v[44:47], v[20:23]
  v_mfma_f32_16x16x32_bf16 v[24:27], v[116:119], v[44:47], v[24:27]
  s_waitcnt vmcnt(0)
  s_barrier
  ds_read_b128 v[80:83], v1 offset:20480
  ds_read_b128 v[84:87], v1 offset:21504
  ds_read_b128 v[88:91], v1 offset:22528
  ds_read_b128 v[92:95], v1 offset:23552
  ds_read_b128 v[96:99], v1 offset:24576
  ds_read_b128 v[100:103], v1 offset:25600
  ds_read_b128 v[104:107], v1 offset:26624
  ds_read_b128 v[108:111], v1 offset:27648
  ds_read_b128 v[112:115], v1 offset:28672
  ds_read_b128 v[116:119], v1 offset:29696
  s_waitcnt lgkmcnt(5)
  v_mfma_f32_16x16x32_bf16 v[8:11], v[80:83], v[48:51], v[8:11]
  v_mfma_f32_16x16x32_bf16 v[12:15], v[84:87], v[48:51], v[12:15]
  v_mfma_f32_16x16x32_bf16 v[16:19], v[88:91], v[48:51], v[16:19]
  v_mfma_f32_16x16x32_bf16 v[20:23], v[92:95], v[48:51], v[20:23]
  v_mfma_f32_16x16x32_bf16 v[24:27], v[96:99], v[48:51], v[24:27]
  ds_read_b128 v[80:83], v1 offset:30720
  ds_read_b128 v[84:87], v1 offset:31744
  ds_read_b128 v[88:91], v1 offset:32768
  ds_read_b128 v[92:95], v1 offset:33792
  ds_read_b128 v[96:99], v1 offset:34816
  s_waitcnt lgkmcnt(5)
  v_mfma_f32_16x16x32_bf16 v[8:11], v[100:103], v[52:55], v[8:11]
  v_mfma_f32_16x16x32_bf16 v[12:15], v[104:107], v[52:55], v[12:15]
  v_mfma_f32_16x16x32_bf16 v[16:19], v[108:111], v[52:55], v[16:19]
  v_mfma_f32_16x16x32_bf16 v[20:23], v[112:115], v[52:55], v[20:23]
  v_mfma_f32_16x16x32_bf16 v[24:27], v[116:119], v[52:55], v[24:27]
  ds_read_b128 v[100:103], v1 offset:35840
  ds_read_b128 v[104:107], v1 offset:36864
  ds_read_b128 v[108:111], v1 offset:37888
  ds_read_b128 v[112:115], v1 offset:38912
  ds_read_b128 v[116:119], v1 offset:39936
  s_waitcnt lgkmcnt(5)
  v_mfma_f32_16x16x32_bf16 v[8:11], v[80:83], v[56:59], v[8:11]
  v_mfma_f32_16x16x32_bf16 v[12:15], v[84:87], v[56:59], v[12:15]
  v_mfma_f32_16x16x32_bf16 v[16:19], v[88:91], v[56:59], v[16:19]
  v_mfma_f32_16x16x32_bf16 v[20:23], v[92:95], v[56:59], v[20:23]
  v_mfma_f32_16x16x32_bf16 v[24:27], v[96:99], v[56:59], v[24:27]
  s_waitcnt lgkmcnt(0)
  v_mfma_f32_16x16x32_bf16 v[8:11], v[100:103], v[60:63], v[8:11]
  v_mfma_f32_16x16x32_bf16 v[12:15], v[104:107], v[60:63], v[12:15]
  v_mfma_f32_16x16x32_bf16 v[16:19], v[108:111], v[60:63], v[16:19]
  v_mfma_f32_16x16x32_bf16 v[20:23], v[112:115], v[60:63], v[20:23]
  v_mfma_f32_16x16x32_bf16 v[24:27], v[116:119], v[60:63], v[24:27]
  v_and_b32 v3, 63, v0
  v_and_b32 v4, 15, v3
  v_lshrrev_b32 v3, 4, v3
  s_lshl_b32 s21, s17, 6
  s_lshl_b32 s23, s16, 4
  s_add_u32 s21, s21, s23
  v_add_u32 v4, s21, v4
  v_mul_u32_u24 v6, 1280, v4
  v_lshl_add_u32 v6, v3, 4, v6
  s_mul_i32 s21, s18, 5
  s_add_u32 s23, s21, 0
  s_lshr_b32 s31, s23, 1
  s_lshl_b32 s31, s31, 6
  s_and_b32 s23, s23, 1
  s_lshl_b32 s23, s23, 3
  s_add_u32 s32, s31, s23
  s_add_u32 s40, s32, s20
  buffer_load_dwordx2 v[32:33], v6, s[8:11], s40 offen
  s_add_u32 s23, s21, 1
  s_lshr_b32 s31, s23, 1
  s_lshl_b32 s31, s31, 6
  s_and_b32 s23, s23, 1
  s_lshl_b32 s23, s23, 3
  s_add_u32 s33, s31, s23
  s_add_u32 s41, s33, s20
  buffer_load_dwordx2 v[34:35], v6, s[8:11], s41 offen
  s_add_u32 s23, s21, 2
  s_lshr_b32 s31, s23, 1
  s_lshl_b32 s31, s31, 6
  s_and_b32 s23, s23, 1
  s_lshl_b32 s23, s23, 3
  s_add_u32 s34, s31, s23
  s_add_u32 s42, s34, s20
  buffer_load_dwordx2 v[36:37], v6, s[8:11], s42 offen
  s_add_u32 s23, s21, 3
  s_lshr_b32 s31, s23, 1
  s_lshl_b32 s31, s31, 6
  s_and_b32 s23, s23, 1
  s_lshl_b32 s23, s23, 3
  s_add_u32 s35, s31, s23
  s_add_u32 s43, s35, s20
  buffer_load_dwordx2 v[38:39], v6, s[8:11], s43 offen
  s_add_u32 s23, s21, 4
  s_lshr_b32 s31, s23, 1
  s_lshl_b32 s31, s31, 6
  s_and_b32 s23, s23, 1
  s_lshl_b32 s23, s23, 3
  s_add_u32 s36, s31, s23
  s_add_u32 s44, s36, s20
  buffer_load_dwordx2 v[40:41], v6, s[8:11], s44 offen
  s_waitcnt vmcnt(0)
  v_cvt_pk_bf16_f32 v80, v8, v9
  v_cvt_pk_bf16_f32 v81, v10, v11
  v_lshlrev_b32 v8, 16, v80
  v_and_b32 v9, 0xffff0000, v80
  v_lshlrev_b32 v10, 16, v81
  v_and_b32 v11, 0xffff0000, v81
  v_lshlrev_b32 v82, 16, v32
  v_and_b32 v83, 0xffff0000, v32
  v_lshlrev_b32 v84, 16, v33
  v_and_b32 v85, 0xffff0000, v33
  v_add_f32 v8, v8, v82
  v_add_f32 v9, v9, v83
  v_add_f32 v10, v10, v84
  v_add_f32 v11, v11, v85
  v_cvt_pk_bf16_f32 v32, v8, v9
  v_cvt_pk_bf16_f32 v33, v10, v11
  s_add_u32 s23, s32, 82313216
  buffer_store_dwordx2 v[32:33], v6, s[4:7], s23 offen sc1
  v_cvt_pk_bf16_f32 v80, v12, v13
  v_cvt_pk_bf16_f32 v81, v14, v15
  v_lshlrev_b32 v12, 16, v80
  v_and_b32 v13, 0xffff0000, v80
  v_lshlrev_b32 v14, 16, v81
  v_and_b32 v15, 0xffff0000, v81
  v_lshlrev_b32 v82, 16, v34
  v_and_b32 v83, 0xffff0000, v34
  v_lshlrev_b32 v84, 16, v35
  v_and_b32 v85, 0xffff0000, v35
  v_add_f32 v12, v12, v82
  v_add_f32 v13, v13, v83
  v_add_f32 v14, v14, v84
  v_add_f32 v15, v15, v85
  v_cvt_pk_bf16_f32 v34, v12, v13
  v_cvt_pk_bf16_f32 v35, v14, v15
  s_add_u32 s23, s33, 82313216
  buffer_store_dwordx2 v[34:35], v6, s[4:7], s23 offen sc1
  v_cvt_pk_bf16_f32 v80, v16, v17
  v_cvt_pk_bf16_f32 v81, v18, v19
  v_lshlrev_b32 v16, 16, v80
  v_and_b32 v17, 0xffff0000, v80
  v_lshlrev_b32 v18, 16, v81
  v_and_b32 v19, 0xffff0000, v81
  v_lshlrev_b32 v82, 16, v36
  v_and_b32 v83, 0xffff0000, v36
  v_lshlrev_b32 v84, 16, v37
  v_and_b32 v85, 0xffff0000, v37
  v_add_f32 v16, v16, v82
  v_add_f32 v17, v17, v83
  v_add_f32 v18, v18, v84
  v_add_f32 v19, v19, v85
  v_cvt_pk_bf16_f32 v36, v16, v17
  v_cvt_pk_bf16_f32 v37, v18, v19
  s_add_u32 s23, s34, 82313216
  buffer_store_dwordx2 v[36:37], v6, s[4:7], s23 offen sc1
  v_cvt_pk_bf16_f32 v80, v20, v21
  v_cvt_pk_bf16_f32 v81, v22, v23
  v_lshlrev_b32 v20, 16, v80
  v_and_b32 v21, 0xffff0000, v80
  v_lshlrev_b32 v22, 16, v81
  v_and_b32 v23, 0xffff0000, v81
  v_lshlrev_b32 v82, 16, v38
  v_and_b32 v83, 0xffff0000, v38
  v_lshlrev_b32 v84, 16, v39
  v_and_b32 v85, 0xffff0000, v39
  v_add_f32 v20, v20, v82
  v_add_f32 v21, v21, v83
  v_add_f32 v22, v22, v84
  v_add_f32 v23, v23, v85
  v_cvt_pk_bf16_f32 v38, v20, v21
  v_cvt_pk_bf16_f32 v39, v22, v23
  s_add_u32 s23, s35, 82313216
  buffer_store_dwordx2 v[38:39], v6, s[4:7], s23 offen sc1
  v_cvt_pk_bf16_f32 v80, v24, v25
  v_cvt_pk_bf16_f32 v81, v26, v27
  v_lshlrev_b32 v24, 16, v80
  v_and_b32 v25, 0xffff0000, v80
  v_lshlrev_b32 v26, 16, v81
  v_and_b32 v27, 0xffff0000, v81
  v_lshlrev_b32 v82, 16, v40
  v_and_b32 v83, 0xffff0000, v40
  v_lshlrev_b32 v84, 16, v41
  v_and_b32 v85, 0xffff0000, v41
  v_add_f32 v24, v24, v82
  v_add_f32 v25, v25, v83
  v_add_f32 v26, v26, v84
  v_add_f32 v27, v27, v85
  v_cvt_pk_bf16_f32 v40, v24, v25
  v_cvt_pk_bf16_f32 v41, v26, v27
  s_add_u32 s23, s36, 82313216
  buffer_store_dwordx2 v[40:41], v6, s[4:7], s23 offen sc1
outb1_exit1:
  s_endpgm
.globl outb2_kernel
.p2align 8
.type outb2_kernel,@function
outb2_kernel:
  s_cmp_ge_u32 s2, 256
  s_cbranch_scc1 outb2_exit1
  s_load_dwordx2 s[12:13], s[0:1], 96
  s_load_dwordx2 s[14:15], s[0:1], 0
  s_load_dwordx2 s[48:49], s[0:1], 80
  v_lshrrev_b32 v3, 6, v0
  v_and_b32 v4, 63, v0
  s_nop 0
  v_readfirstlane_b32 s16, v3
  v_lshlrev_b32 v1, 4, v4
  s_and_b32 s17, s2, 7
  s_lshl_b32 s17, s17, 2
  s_lshr_b32 s18, s2, 3
  s_and_b32 s19, s18, 3
  s_add_u32 s17, s17, s19
  s_lshr_b32 s18, s18, 2
  s_waitcnt lgkmcnt(0)
  s_mov_b32 s4, s12
  s_mov_b32 s5, s13
  s_mov_b32 s6, 0x10000000
  s_mov_b32 s7, 0x20000
  s_mov_b32 s8, s12
  s_mov_b32 s9, s13
  s_mov_b32 s10, 0x10000000
  s_mov_b32 s11, 0x20000
  s_mov_b32 s20, 82313216
  s_mov_b32 s52, s48
  s_mov_b32 s53, s49
  s_mov_b32 s54, 2621440
  s_mov_b32 s55, 0x20000
  s_mul_i32 s21, s18, 5
  s_mul_i32 s21, s21, 32768
  s_add_u32 s24, s21, 91488256
  s_add_u32 s25, s24, 32768
  s_add_u32 s26, s25, 32768
  s_add_u32 s27, s26, 32768
  s_add_u32 s28, s27, 32768
  s_lshl_b32 s21, s17, 2
  s_add_u32 s21, s21, s16
  s_mul_i32 s22, s21, 32768
  s_add_u32 s22, s22, 50331648
  s_lshl_b32 s23, s16, 10
  v_add_u32 v2, s23, v1
  s_mul_i32 s29, s16, 5120
  s_add_u32 m0, s29, 0
  s_nop 0
  buffer_load_dwordx4 v2, s[4:7], s24 offen lds
  s_add_u32 m0, s29, 1024
  s_nop 0
  buffer_load_dwordx4 v2, s[4:7], s25 offen lds
  s_add_u32 m0, s29, 2048
  s_nop 0
  buffer_load_dwordx4 v2, s[4:7], s26 offen lds
  s_add_u32 m0, s29, 3072
  s_nop 0
  buffer_load_dwordx4 v2, s[4:7], s27 offen lds
  s_add_u32 m0, s29, 4096
  s_nop 0
  buffer_load_dwordx4 v2, s[4:7], s28 offen lds
  buffer_load_dwordx4 v[32:35], v1, s[4:7], s22 offen offset:0
  buffer_load_dwordx4 v[36:39], v1, s[4:7], s22 offen offset:1024
  buffer_load_dwordx4 v[40:43], v1, s[4:7], s22 offen offset:2048
  buffer_load_dwordx4 v[44:47], v1, s[4:7], s22 offen offset:3072
  v_add_u32 v2, 0x1000, v2
  s_add_u32 s22, s22, 4096
  s_add_u32 m0, s29, 20480
  s_nop 0
  buffer_load_dwordx4 v2, s[4:7], s24 offen lds
  s_add_u32 m0, s29, 21504
  s_nop 0
  buffer_load_dwordx4 v2, s[4:7], s25 offen lds
  s_add_u32 m0, s29, 22528
  s_nop 0
  buffer_load_dwordx4 v2, s[4:7], s26 offen lds
  s_add_u32 m0, s29, 23552
  s_nop 0
  buffer_load_dwordx4 v2, s[4:7], s27 offen lds
  s_add_u32 m0, s29, 24576
  s_nop 0
  buffer_load_dwordx4 v2, s[4:7], s28 offen lds
  buffer_load_dwordx4 v[48:51], v1, s[4:7], s22 offen offset:0
  buffer_load_dwordx4 v[52:55], v1, s[4:7], s22 offen offset:1024
  buffer_load_dwordx4 v[56:59], v1, s[4:7], s22 offen offset:2048
  buffer_load_dwordx4 v[60:63], v1, s[4:7], s22 offen offset:3072
  v_add_u32 v2, 0x1000, v2
  s_add_u32 s22, s22, 4096
  s_waitcnt vmcnt(9)
  s_barrier
  s_add_u32 m0, s29, 40960
  s_nop 0
  buffer_load_dwordx4 v2, s[4:7], s24 offen lds
  s_add_u32 m0, s29, 41984
  s_nop 0
  buffer_load_dwordx4 v2, s[4:7], s25 offen lds
  s_add_u32 m0, s29, 43008
  s_nop 0
  buffer_load_dwordx4 v2, s[4:7], s26 offen lds
  s_add_u32 m0, s29, 44032
  s_nop 0
  buffer_load_dwordx4 v2, s[4:7], s27 offen lds
  s_add_u32 m0, s29, 45056
  s_nop 0
  buffer_load_dwordx4 v2, s[4:7], s28 offen lds
  buffer_load_dwordx4 v[64:67], v1, s[4:7], s22 offen offset:0
  buffer_load_dwordx4 v[68:71], v1, s[4:7], s22 offen offset:1024
  buffer_load_dwordx4 v[72:75], v1, s[4:7], s22 offen offset:2048
  buffer_load_dwordx4 v[76:79], v1, s[4:7], s22 offen offset:3072
  v_add_u32 v2, 0x1000, v2
  s_add_u32 s22, s22, 4096
  ds_read_b128 v[80:83], v1 offset:0
  ds_read_b128 v[84:87], v1 offset:1024
  ds_read_b128 v[88:91], v1 offset:2048
  ds_read_b128 v[92:95], v1 offset:3072
  ds_read_b128 v[96:99], v1 offset:4096
  ds_read_b128 v[100:103], v1 offset:5120
  ds_read_b128 v[104:107], v1 offset:6144
  ds_read_b128 v[108:111], v1 offset:7168
  ds_read_b128 v[112:115], v1 offset:8192
  ds_read_b128 v[116:119], v1 offset:9216
  s_waitcnt lgkmcnt(5)
  v_mfma_f32_16x16x32_bf16 v[8:11], v[80:83], v[32:35], 0
  v_mfma_f32_16x16x32_bf16 v[12:15], v[84:87], v[32:35], 0
  v_mfma_f32_16x16x32_bf16 v[16:19], v[88:91], v[32:35], 0
  v_mfma_f32_16x16x32_bf16 v[20:23], v[92:95], v[32:35], 0
  v_mfma_f32_16x16x32_bf16 v[24:27], v[96:99], v[32:35], 0
  ds_read_b128 v[80:83], v1 offset:10240
  ds_read_b128 v[84:87], v1 offset:11264
  ds_read_b128 v[88:91], v1 offset:12288
  ds_read_b128 v[92:95], v1 offset:13312
  ds_read_b128 v[96:99], v1 offset:14336
  s_waitcnt lgkmcnt(5)
  v_mfma_f32_16x16x32_bf16 v[8:11], v[100:103], v[36:39], v[8:11]
  v_mfma_f32_16x16x32_bf16 v[12:15], v[104:107], v[36:39], v[12:15]
  v_mfma_f32_16x16x32_bf16 v[16:19], v[108:111], v[36:39], v[16:19]
  v_mfma_f32_16x16x32_bf16 v[20:23], v[112:115], v[36:39], v[20:23]
  v_mfma_f32_16x16x32_bf16 v[24:27], v[116:119], v[36:39], v[24:27]
  ds_read_b128 v[100:103], v1 offset:15360
  ds_read_b128 v[104:107], v1 offset:16384
  ds_read_b128 v[108:111], v1 offset:17408
  ds_read_b128 v[112:115], v1 offset:18432
  ds_read_b128 v[116:119], v1 offset:19456
  s_waitcnt lgkmcnt(5)
  v_mfma_f32_16x16x32_bf16 v[8:11], v[80:83], v[40:43], v[8:11]
  v_mfma_f32_16x16x32_bf16 v[12:15], v[84:87], v[40:43], v[12:15]
  v_mfma_f32_16x16x32_bf16 v[16:19], v[88:91], v[40:43], v[16:19]
  v_mfma_f32_16x16x32_bf16 v[20:23], v[92:95], v[40:43], v[20:23]
  v_mfma_f32_16x16x32_bf16 v[24:27], v[96:99], v[40:43], v[24:27]
  s_waitcnt lgkmcnt(0)
  v_mfma_f32_16x16x32_bf16 v[8:11], v[100:103], v[44:47], v[8:11]
  v_mfma_f32_16x16x32_bf16 v[12:15], v[104:107], v[44:47], v[12:15]
  v_mfma_f32_16x16x32_bf16 v[16:19], v[108:111], v[44:47], v[16:19]
  v_mfma_f32_16x16x32_bf16 v[20:23], v[112:115], v[44:47], v[20:23]
  v_mfma_f32_16x16x32_bf16 v[24:27], v[116:119], v[44:47], v[24:27]
  s_mov_b32 s30, 0
outb2_loop2:
  s_waitcnt vmcnt(9)
  s_barrier
  s_add_u32 m0, s29, 0
  s_nop 0
  buffer_load_dwordx4 v2, s[4:7], s24 offen lds
  s_add_u32 m0, s29, 1024
  s_nop 0
  buffer_load_dwordx4 v2, s[4:7], s25 offen lds
  s_add_u32 m0, s29, 2048
  s_nop 0
  buffer_load_dwordx4 v2, s[4:7], s26 offen lds
  s_add_u32 m0, s29, 3072
  s_nop 0
  buffer_load_dwordx4 v2, s[4:7], s27 offen lds
  s_add_u32 m0, s29, 4096
  s_nop 0
  buffer_load_dwordx4 v2, s[4:7], s28 offen lds
  buffer_load_dwordx4 v[32:35], v1, s[4:7], s22 offen offset:0
  buffer_load_dwordx4 v[36:39], v1, s[4:7], s22 offen offset:1024
  buffer_load_dwordx4 v[40:43], v1, s[4:7], s22 offen offset:2048
  buffer_load_dwordx4 v[44:47], v1, s[4:7], s22 offen offset:3072
  v_add_u32 v2, 0x1000, v2
  s_add_u32 s22, s22, 4096
  ds_read_b128 v[80:83], v1 offset:20480
  ds_read_b128 v[84:87], v1 offset:21504
  ds_read_b128 v[88:91], v1 offset:22528
  ds_read_b128 v[92:95], v1 offset:23552
  ds_read_b128 v[96:99], v1 offset:24576
  ds_read_b128 v[100:103], v1 offset:25600
  ds_read_b128 v[104:107], v1 offset:26624
  ds_read_b128 v[108:111], v1 offset:27648
  ds_read_b128 v[112:115], v1 offset:28672
  ds_read_b128 v[116:119], v1 offset:29696
  s_waitcnt lgkmcnt(5)
  v_mfma_f32_16x16x32_bf16 v[8:11], v[80:83], v[48:51], v[8:11]
  v_mfma_f32_16x16x32_bf16 v[12:15], v[84:87], v[48:51], v[12:15]
  v_mfma_f32_16x16x32_bf16 v[16:19], v[88:91], v[48:51], v[16:19]
  v_mfma_f32_16x16x32_bf16 v[20:23], v[92:95], v[48:51], v[20:23]
  v_mfma_f32_16x16x32_bf16 v[24:27], v[96:99], v[48:51], v[24:27]
  ds_read_b128 v[80:83], v1 offset:30720
  ds_read_b128 v[84:87], v1 offset:31744
  ds_read_b128 v[88:91], v1 offset:32768
  ds_read_b128 v[92:95], v1 offset:33792
  ds_read_b128 v[96:99], v1 offset:34816
  s_waitcnt lgkmcnt(5)
  v_mfma_f32_16x16x32_bf16 v[8:11], v[100:103], v[52:55], v[8:11]
  v_mfma_f32_16x16x32_bf16 v[12:15], v[104:107], v[52:55], v[12:15]
  v_mfma_f32_16x16x32_bf16 v[16:19], v[108:111], v[52:55], v[16:19]
  v_mfma_f32_16x16x32_bf16 v[20:23], v[112:115], v[52:55], v[20:23]
  v_mfma_f32_16x16x32_bf16 v[24:27], v[116:119], v[52:55], v[24:27]
  ds_read_b128 v[100:103], v1 offset:35840
  ds_read_b128 v[104:107], v1 offset:36864
  ds_read_b128 v[108:111], v1 offset:37888
  ds_read_b128 v[112:115], v1 offset:38912
  ds_read_b128 v[116:119], v1 offset:39936
  s_waitcnt lgkmcnt(5)
  v_mfma_f32_16x16x32_bf16 v[8:11], v[80:83], v[56:59], v[8:11]
  v_mfma_f32_16x16x32_bf16 v[12:15], v[84:87], v[56:59], v[12:15]
  v_mfma_f32_16x16x32_bf16 v[16:19], v[88:91], v[56:59], v[16:19]
  v_mfma_f32_16x16x32_bf16 v[20:23], v[92:95], v[56:59], v[20:23]
  v_mfma_f32_16x16x32_bf16 v[24:27], v[96:99], v[56:59], v[24:27]
  s_waitcnt lgkmcnt(0)
  v_mfma_f32_16x16x32_bf16 v[8:11], v[100:103], v[60:63], v[8:11]
  v_mfma_f32_16x16x32_bf16 v[12:15], v[104:107], v[60:63], v[12:15]
  v_mfma_f32_16x16x32_bf16 v[16:19], v[108:111], v[60:63], v[16:19]
  v_mfma_f32_16x16x32_bf16 v[20:23], v[112:115], v[60:63], v[20:23]
  v_mfma_f32_16x16x32_bf16 v[24:27], v[116:119], v[60:63], v[24:27]
  s_waitcnt vmcnt(9)
  s_barrier
  s_add_u32 m0, s29, 20480
  s_nop 0
  buffer_load_dwordx4 v2, s[4:7], s24 offen lds
  s_add_u32 m0, s29, 21504
  s_nop 0
  buffer_load_dwordx4 v2, s[4:7], s25 offen lds
  s_add_u32 m0, s29, 22528
  s_nop 0
  buffer_load_dwordx4 v2, s[4:7], s26 offen lds
  s_add_u32 m0, s29, 23552
  s_nop 0
  buffer_load_dwordx4 v2, s[4:7], s27 offen lds
  s_add_u32 m0, s29, 24576
  s_nop 0
  buffer_load_dwordx4 v2, s[4:7], s28 offen lds
  buffer_load_dwordx4 v[48:51], v1, s[4:7], s22 offen offset:0
  buffer_load_dwordx4 v[52:55], v1, s[4:7], s22 offen offset:1024
  buffer_load_dwordx4 v[56:59], v1, s[4:7], s22 offen offset:2048
  buffer_load_dwordx4 v[60:63], v1, s[4:7], s22 offen offset:3072
  v_add_u32 v2, 0x1000, v2
  s_add_u32 s22, s22, 4096
  ds_read_b128 v[80:83], v1 offset:40960
  ds_read_b128 v[84:87], v1 offset:41984
  ds_read_b128 v[88:91], v1 offset:43008
  ds_read_b128 v[92:95], v1 offset:44032
  ds_read_b128 v[96:99], v1 offset:45056
  ds_read_b128 v[100:103], v1 offset:46080
  ds_read_b128 v[104:107], v1 offset:47104
  ds_read_b128 v[108:111], v1 offset:48128
  ds_read_b128 v[112:115], v1 offset:49152
  ds_read_b128 v[116:119], v1 offset:50176
  s_waitcnt lgkmcnt(5)
  v_mfma_f32_16x16x32_bf16 v[8:11], v[80:83], v[64:67], v[8:11]
  v_mfma_f32_16x16x32_bf16 v[12:15], v[84:87], v[64:67], v[12:15]
  v_mfma_f32_16x16x32_bf16 v[16:19], v[88:91], v[64:67], v[16:19]
  v_mfma_f32_16x16x32_bf16 v[20:23], v[92:95], v[64:67], v[20:23]
  v_mfma_f32_16x16x32_bf16 v[24:27], v[96:99], v[64:67], v[24:27]
  ds_read_b128 v[80:83], v1 offset:51200
  ds_read_b128 v[84:87], v1 offset:52224
  ds_read_b128 v[88:91], v1 offset:53248
  ds_read_b128 v[92:95], v1 offset:54272
  ds_read_b128 v[96:99], v1 offset:55296
  s_waitcnt lgkmcnt(5)
  v_mfma_f32_16x16x32_bf16 v[8:11], v[100:103], v[68:71], v[8:11]
  v_mfma_f32_16x16x32_bf16 v[12:15], v[104:107], v[68:71], v[12:15]
  v_mfma_f32_16x16x32_bf16 v[16:19], v[108:111], v[68:71], v[16:19]
  v_mfma_f32_16x16x32_bf16 v[20:23], v[112:115], v[68:71], v[20:23]
  v_mfma_f32_16x16x32_bf16 v[24:27], v[116:119], v[68:71], v[24:27]
  ds_read_b128 v[100:103], v1 offset:56320
  ds_read_b128 v[104:107], v1 offset:57344
  ds_read_b128 v[108:111], v1 offset:58368
  ds_read_b128 v[112:115], v1 offset:59392
  ds_read_b128 v[116:119], v1 offset:60416
  s_waitcnt lgkmcnt(5)
  v_mfma_f32_16x16x32_bf16 v[8:11], v[80:83], v[72:75], v[8:11]
  v_mfma_f32_16x16x32_bf16 v[12:15], v[84:87], v[72:75], v[12:15]
  v_mfma_f32_16x16x32_bf16 v[16:19], v[88:91], v[72:75], v[16:19]
  v_mfma_f32_16x16x32_bf16 v[20:23], v[92:95], v[72:75], v[20:23]
  v_mfma_f32_16x16x32_bf16 v[24:27], v[96:99], v[72:75], v[24:27]
  s_waitcnt lgkmcnt(0)
  v_mfma_f32_16x16x32_bf16 v[8:11], v[100:103], v[76:79], v[8:11]
  v_mfma_f32_16x16x32_bf16 v[12:15], v[104:107], v[76:79], v[12:15]
  v_mfma_f32_16x16x32_bf16 v[16:19], v[108:111], v[76:79], v[16:19]
  v_mfma_f32_16x16x32_bf16 v[20:23], v[112:115], v[76:79], v[20:23]
  v_mfma_f32_16x16x32_bf16 v[24:27], v[116:119], v[76:79], v[24:27]
  s_waitcnt vmcnt(9)
  s_barrier
  s_add_u32 m0, s29, 40960
  s_nop 0
  buffer_load_dwordx4 v2, s[4:7], s24 offen lds
  s_add_u32 m0, s29, 41984
  s_nop 0
  buffer_load_dwordx4 v2, s[4:7], s25 offen lds
  s_add_u32 m0, s29, 43008
  s_nop 0
  buffer_load_dwordx4 v2, s[4:7], s26 offen lds
  s_add_u32 m0, s29, 44032
  s_nop 0
  buffer_load_dwordx4 v2, s[4:7], s27 offen lds
  s_add_u32 m0, s29, 45056
  s_nop 0
  buffer_load_dwordx4 v2, s[4:7], s28 offen lds
  buffer_load_dwordx4 v[64:67], v1, s[4:7], s22 offen offset:0
  buffer_load_dwordx4 v[68:71], v1, s[4:7], s22 offen offset:1024
  buffer_load_dwordx4 v[72:75], v1, s[4:7], s22 offen offset:2048
  buffer_load_dwordx4 v[76:79], v1, s[4:7], s22 offen offset:3072
  v_add_u32 v2, 0x1000, v2
  s_add_u32 s22, s22, 4096
  ds_read_b128 v[80:83], v1 offset:0
  ds_read_b128 v[84:87], v1 offset:1024
  ds_read_b128 v[88:91], v1 offset:2048
  ds_read_b128 v[92:95], v1 offset:3072
  ds_read_b128 v[96:99], v1 offset:4096
  ds_read_b128 v[100:103], v1 offset:5120
  ds_read_b128 v[104:107], v1 offset:6144
  ds_read_b128 v[108:111], v1 offset:7168
  ds_read_b128 v[112:115], v1 offset:8192
  ds_read_b128 v[116:119], v1 offset:9216
  s_waitcnt lgkmcnt(5)
  v_mfma_f32_16x16x32_bf16 v[8:11], v[80:83], v[32:35], v[8:11]
  v_mfma_f32_16x16x32_bf16 v[12:15], v[84:87], v[32:35], v[12:15]
  v_mfma_f32_16x16x32_bf16 v[16:19], v[88:91], v[32:35], v[16:19]
  v_mfma_f32_16x16x32_bf16 v[20:23], v[92:95], v[32:35], v[20:23]
  v_mfma_f32_16x16x32_bf16 v[24:27], v[96:99], v[32:35], v[24:27]
  ds_read_b128 v[80:83], v1 offset:10240
  ds_read_b128 v[84:87], v1 offset:11264
  ds_read_b128 v[88:91], v1 offset:12288
  ds_read_b128 v[92:95], v1 offset:13312
  ds_read_b128 v[96:99], v1 offset:14336
  s_waitcnt lgkmcnt(5)
  v_mfma_f32_16x16x32_bf16 v[8:11], v[100:103], v[36:39], v[8:11]
  v_mfma_f32_16x16x32_bf16 v[12:15], v[104:107], v[36:39], v[12:15]
  v_mfma_f32_16x16x32_bf16 v[16:19], v[108:111], v[36:39], v[16:19]
  v_mfma_f32_16x16x32_bf16 v[20:23], v[112:115], v[36:39], v[20:23]
  v_mfma_f32_16x16x32_bf16 v[24:27], v[116:119], v[36:39], v[24:27]
  ds_read_b128 v[100:103], v1 offset:15360
  ds_read_b128 v[104:107], v1 offset:16384
  ds_read_b128 v[108:111], v1 offset:17408
  ds_read_b128 v[112:115], v1 offset:18432
  ds_read_b128 v[116:119], v1 offset:19456
  s_waitcnt lgkmcnt(5)
  v_mfma_f32_16x16x32_bf16 v[8:11], v[80:83], v[40:43], v[8:11]
  v_mfma_f32_16x16x32_bf16 v[12:15], v[84:87], v[40:43], v[12:15]
  v_mfma_f32_16x16x32_bf16 v[16:19], v[88:91], v[40:43], v[16:19]
  v_mfma_f32_16x16x32_bf16 v[20:23], v[92:95], v[40:43], v[20:23]
  v_mfma_f32_16x16x32_bf16 v[24:27], v[96:99], v[40:43], v[24:27]
  s_waitcnt lgkmcnt(0)
  v_mfma_f32_16x16x32_bf16 v[8:11], v[100:103], v[44:47], v[8:11]
  v_mfma_f32_16x16x32_bf16 v[12:15], v[104:107], v[44:47], v[12:15]
  v_mfma_f32_16x16x32_bf16 v[16:19], v[108:111], v[44:47], v[16:19]
  v_mfma_f32_16x16x32_bf16 v[20:23], v[112:115], v[44:47], v[20:23]
  v_mfma_f32_16x16x32_bf16 v[24:27], v[116:119], v[44:47], v[24:27]
  s_add_u32 s30, s30, 1
  s_cmp_lt_u32 s30, 1
  s_cbranch_scc1 outb2_loop2
  s_waitcnt vmcnt(9)
  s_barrier
  s_add_u32 m0, s29, 0
  s_nop 0
  buffer_load_dwordx4 v2, s[4:7], s24 offen lds
  s_add_u32 m0, s29, 1024
  s_nop 0
  buffer_load_dwordx4 v2, s[4:7], s25 offen lds
  s_add_u32 m0, s29, 2048
  s_nop 0
  buffer_load_dwordx4 v2, s[4:7], s26 offen lds
  s_add_u32 m0, s29, 3072
  s_nop 0
  buffer_load_dwordx4 v2, s[4:7], s27 offen lds
  s_add_u32 m0, s29, 4096
  s_nop 0
  buffer_load_dwordx4 v2, s[4:7], s28 offen lds
  buffer_load_dwordx4 v[32:35], v1, s[4:7], s22 offen offset:0
  buffer_load_dwordx4 v[36:39], v1, s[4:7], s22 offen offset:1024
  buffer_load_dwordx4 v[40:43], v1, s[4:7], s22 offen offset:2048
  buffer_load_dwordx4 v[44:47], v1, s[4:7], s22 offen offset:3072
  v_add_u32 v2, 0x1000, v2
  s_add_u32 s22, s22, 4096
  ds_read_b128 v[80:83], v1 offset:20480
  ds_read_b128 v[84:87], v1 offset:21504
  ds_read_b128 v[88:91], v1 offset:22528
  ds_read_b128 v[92:95], v1 offset:23552
  ds_read_b128 v[96:99], v1 offset:24576
  ds_read_b128 v[100:103], v1 offset:25600
  ds_read_b128 v[104:107], v1 offset:26624
  ds_read_b128 v[108:111], v1 offset:27648
  ds_read_b128 v[112:115], v1 offset:28672
  ds_read_b128 v[116:119], v1 offset:29696
  s_waitcnt lgkmcnt(5)
  v_mfma_f32_16x16x32_bf16 v[8:11], v[80:83], v[48:51], v[8:11]
  v_mfma_f32_16x16x32_bf16 v[12:15], v[84:87], v[48:51], v[12:15]
  v_mfma_f32_16x16x32_bf16 v[16:19], v[88:91], v[48:51], v[16:19]
  v_mfma_f32_16x16x32_bf16 v[20:23], v[92:95], v[48:51], v[20:23]
  v_mfma_f32_16x16x32_bf16 v[24:27], v[96:99], v[48:51], v[24:27]
  ds_read_b128 v[80:83], v1 offset:30720
  ds_read_b128 v[84:87], v1 offset:31744
  ds_read_b128 v[88:91], v1 offset:32768
  ds_read_b128 v[92:95], v1 offset:33792
  ds_read_b128 v[96:99], v1 offset:34816
  s_waitcnt lgkmcnt(5)
  v_mfma_f32_16x16x32_bf16 v[8:11], v[100:103], v[52:55], v[8:11]
  v_mfma_f32_16x16x32_bf16 v[12:15], v[104:107], v[52:55], v[12:15]
  v_mfma_f32_16x16x32_bf16 v[16:19], v[108:111], v[52:55], v[16:19]
  v_mfma_f32_16x16x32_bf16 v[20:23], v[112:115], v[52:55], v[20:23]
  v_mfma_f32_16x16x32_bf16 v[24:27], v[116:119], v[52:55], v[24:27]
  ds_read_b128 v[100:103], v1 offset:35840
  ds_read_b128 v[104:107], v1 offset:36864
  ds_read_b128 v[108:111], v1 offset:37888
  ds_read_b128 v[112:115], v1 offset:38912
  ds_read_b128 v[116:119], v1 offset:39936
  s_waitcnt lgkmcnt(5)
  v_mfma_f32_16x16x32_bf16 v[8:11], v[80:83], v[56:59], v[8:11]
  v_mfma_f32_16x16x32_bf16 v[12:15], v[84:87], v[56:59], v[12:15]
  v_mfma_f32_16x16x32_bf16 v[16:19], v[88:91], v[56:59], v[16:19]
  v_mfma_f32_16x16x32_bf16 v[20:23], v[92:95], v[56:59], v[20:23]
  v_mfma_f32_16x16x32_bf16 v[24:27], v[96:99], v[56:59], v[24:27]
  s_waitcnt lgkmcnt(0)
  v_mfma_f32_16x16x32_bf16 v[8:11], v[100:103], v[60:63], v[8:11]
  v_mfma_f32_16x16x32_bf16 v[12:15], v[104:107], v[60:63], v[12:15]
  v_mfma_f32_16x16x32_bf16 v[16:19], v[108:111], v[60:63], v[16:19]
  v_mfma_f32_16x16x32_bf16 v[20:23], v[112:115], v[60:63], v[20:23]
  v_mfma_f32_16x16x32_bf16 v[24:27], v[116:119], v[60:63], v[24:27]
  s_waitcnt vmcnt(9)
  s_barrier
  s_add_u32 m0, s29, 20480
  s_nop 0
  buffer_load_dwordx4 v2, s[4:7], s24 offen lds
  s_add_u32 m0, s29, 21504
  s_nop 0
  buffer_load_dwordx4 v2, s[4:7], s25 offen lds
  s_add_u32 m0, s29, 22528
  s_nop 0
  buffer_load_dwordx4 v2, s[4:7], s26 offen lds
  s_add_u32 m0, s29, 23552
  s_nop 0
  buffer_load_dwordx4 v2, s[4:7], s27 offen lds
  s_add_u32 m0, s29, 24576
  s_nop 0
  buffer_load_dwordx4 v2, s[4:7], s28 offen lds
  buffer_load_dwordx4 v[48:51], v1, s[4:7], s22 offen offset:0
  buffer_load_dwordx4 v[52:55], v1, s[4:7], s22 offen offset:1024
  buffer_load_dwordx4 v[56:59], v1, s[4:7], s22 offen offset:2048
  buffer_load_dwordx4 v[60:63], v1, s[4:7], s22 offen offset:3072
  v_add_u32 v2, 0x1000, v2
  s_add_u32 s22, s22, 4096
  ds_read_b128 v[80:83], v1 offset:40960
  ds_read_b128 v[84:87], v1 offset:41984
  ds_read_b128 v[88:91], v1 offset:43008
  ds_read_b128 v[92:95], v1 offset:44032
  ds_read_b128 v[96:99], v1 offset:45056
  ds_read_b128 v[100:103], v1 offset:46080
  ds_read_b128 v[104:107], v1 offset:47104
  ds_read_b128 v[108:111], v1 offset:48128
  ds_read_b128 v[112:115], v1 offset:49152
  ds_read_b128 v[116:119], v1 offset:50176
  s_waitcnt lgkmcnt(5)
  v_mfma_f32_16x16x32_bf16 v[8:11], v[80:83], v[64:67], v[8:11]
  v_mfma_f32_16x16x32_bf16 v[12:15], v[84:87], v[64:67], v[12:15]
  v_mfma_f32_16x16x32_bf16 v[16:19], v[88:91], v[64:67], v[16:19]
  v_mfma_f32_16x16x32_bf16 v[20:23], v[92:95], v[64:67], v[20:23]
  v_mfma_f32_16x16x32_bf16 v[24:27], v[96:99], v[64:67], v[24:27]
  ds_read_b128 v[80:83], v1 offset:51200
  ds_read_b128 v[84:87], v1 offset:52224
  ds_read_b128 v[88:91], v1 offset:53248
  ds_read_b128 v[92:95], v1 offset:54272
  ds_read_b128 v[96:99], v1 offset:55296
  s_waitcnt lgkmcnt(5)
  v_mfma_f32_16x16x32_bf16 v[8:11], v[100:103], v[68:71], v[8:11]
  v_mfma_f32_16x16x32_bf16 v[12:15], v[104:107], v[68:71], v[12:15]
  v_mfma_f32_16x16x32_bf16 v[16:19], v[108:111], v[68:71], v[16:19]
  v_mfma_f32_16x16x32_bf16 v[20:23], v[112:115], v[68:71], v[20:23]
  v_mfma_f32_16x16x32_bf16 v[24:27], v[116:119], v[68:71], v[24:27]
  ds_read_b128 v[100:103], v1 offset:56320
  ds_read_b128 v[104:107], v1 offset:57344
  ds_read_b128 v[108:111], v1 offset:58368
  ds_read_b128 v[112:115], v1 offset:59392
  ds_read_b128 v[116:119], v1 offset:60416
  s_waitcnt lgkmcnt(5)
  v_mfma_f32_16x16x32_bf16 v[8:11], v[80:83], v[72:75], v[8:11]
  v_mfma_f32_16x16x32_bf16 v[12:15], v[84:87], v[72:75], v[12:15]
  v_mfma_f32_16x16x32_bf16 v[16:19], v[88:91], v[72:75], v[16:19]
  v_mfma_f32_16x16x32_bf16 v[20:23], v[92:95], v[72:75], v[20:23]
  v_mfma_f32_16x16x32_bf16 v[24:27], v[96:99], v[72:75], v[24:27]
  s_waitcnt lgkmcnt(0)
  v_mfma_f32_16x16x32_bf16 v[8:11], v[100:103], v[76:79], v[8:11]
  v_mfma_f32_16x16x32_bf16 v[12:15], v[104:107], v[76:79], v[12:15]
  v_mfma_f32_16x16x32_bf16 v[16:19], v[108:111], v[76:79], v[16:19]
  v_mfma_f32_16x16x32_bf16 v[20:23], v[112:115], v[76:79], v[20:23]
  v_mfma_f32_16x16x32_bf16 v[24:27], v[116:119], v[76:79], v[24:27]
  s_waitcnt vmcnt(9)
  s_barrier
  ds_read_b128 v[80:83], v1 offset:0
  ds_read_b128 v[84:87], v1 offset:1024
  ds_read_b128 v[88:91], v1 offset:2048
  ds_read_b128 v[92:95], v1 offset:3072
  ds_read_b128 v[96:99], v1 offset:4096
  ds_read_b128 v[100:103], v1 offset:5120
  ds_read_b128 v[104:107], v1 offset:6144
  ds_read_b128 v[108:111], v1 offset:7168
  ds_read_b128 v[112:115], v1 offset:8192
  ds_read_b128 v[116:119], v1 offset:9216
  s_waitcnt lgkmcnt(5)
  v_mfma_f32_16x16x32_bf16 v[8:11], v[80:83], v[32:35], v[8:11]
  v_mfma_f32_16x16x32_bf16 v[12:15], v[84:87], v[32:35], v[12:15]
  v_mfma_f32_16x16x32_bf16 v[16:19], v[88:91], v[32:35], v[16:19]
  v_mfma_f32_16x16x32_bf16 v[20:23], v[92:95], v[32:35], v[20:23]
  v_mfma_f32_16x16x32_bf16 v[24:27], v[96:99], v[32:35], v[24:27]
  ds_read_b128 v[80:83], v1 offset:10240
  ds_read_b128 v[84:87], v1 offset:11264
  ds_read_b128 v[88:91], v1 offset:12288
  ds_read_b128 v[92:95], v1 offset:13312
  ds_read_b128 v[96:99], v1 offset:14336
  s_waitcnt lgkmcnt(5)
  v_mfma_f32_16x16x32_bf16 v[8:11], v[100:103], v[36:39], v[8:11]
  v_mfma_f32_16x16x32_bf16 v[12:15], v[104:107], v[36:39], v[12:15]
  v_mfma_f32_16x16x32_bf16 v[16:19], v[108:111], v[36:39], v[16:19]
  v_mfma_f32_16x16x32_bf16 v[20:23], v[112:115], v[36:39], v[20:23]
  v_mfma_f32_16x16x32_bf16 v[24:27], v[116:119], v[36:39], v[24:27]
  ds_read_b128 v[100:103], v1 offset:15360
  ds_read_b128 v[104:107], v1 offset:16384
  ds_read_b128 v[108:111], v1 offset:17408
  ds_read_b128 v[112:115], v1 offset:18432
  ds_read_b128 v[116:119], v1 offset:19456
  s_waitcnt lgkmcnt(5)
  v_mfma_f32_16x16x32_bf16 v[8:11], v[80:83], v[40:43], v[8:11]
  v_mfma_f32_16x16x32_bf16 v[12:15], v[84:87], v[40:43], v[12:15]
  v_mfma_f32_16x16x32_bf16 v[16:19], v[88:91], v[40:43], v[16:19]
  v_mfma_f32_16x16x32_bf16 v[20:23], v[92:95], v[40:43], v[20:23]
  v_mfma_f32_16x16x32_bf16 v[24:27], v[96:99], v[40:43], v[24:27]
  s_waitcnt lgkmcnt(0)
  v_mfma_f32_16x16x32_bf16 v[8:11], v[100:103], v[44:47], v[8:11]
  v_mfma_f32_16x16x32_bf16 v[12:15], v[104:107], v[44:47], v[12:15]
  v_mfma_f32_16x16x32_bf16 v[16:19], v[108:111], v[44:47], v[16:19]
  v_mfma_f32_16x16x32_bf16 v[20:23], v[112:115], v[44:47], v[20:23]
  v_mfma_f32_16x16x32_bf16 v[24:27], v[116:119], v[44:47], v[24:27]
  s_waitcnt vmcnt(0)
  s_barrier
  ds_read_b128 v[80:83], v1 offset:20480
  ds_read_b128 v[84:87], v1 offset:21504
  ds_read_b128 v[88:91], v1 offset:22528
  ds_read_b128 v[92:95], v1 offset:23552
  ds_read_b128 v[96:99], v1 offset:24576
  ds_read_b128 v[100:103], v1 offset:25600
  ds_read_b128 v[104:107], v1 offset:26624
  ds_read_b128 v[108:111], v1 offset:27648
  ds_read_b128 v[112:115], v1 offset:28672
  ds_read_b128 v[116:119], v1 offset:29696
  s_waitcnt lgkmcnt(5)
  v_mfma_f32_16x16x32_bf16 v[8:11], v[80:83], v[48:51], v[8:11]
  v_mfma_f32_16x16x32_bf16 v[12:15], v[84:87], v[48:51], v[12:15]
  v_mfma_f32_16x16x32_bf16 v[16:19], v[88:91], v[48:51], v[16:19]
  v_mfma_f32_16x16x32_bf16 v[20:23], v[92:95], v[48:51], v[20:23]
  v_mfma_f32_16x16x32_bf16 v[24:27], v[96:99], v[48:51], v[24:27]
  ds_read_b128 v[80:83], v1 offset:30720
  ds_read_b128 v[84:87], v1 offset:31744
  ds_read_b128 v[88:91], v1 offset:32768
  ds_read_b128 v[92:95], v1 offset:33792
  ds_read_b128 v[96:99], v1 offset:34816
  s_waitcnt lgkmcnt(5)
  v_mfma_f32_16x16x32_bf16 v[8:11], v[100:103], v[52:55], v[8:11]
  v_mfma_f32_16x16x32_bf16 v[12:15], v[104:107], v[52:55], v[12:15]
  v_mfma_f32_16x16x32_bf16 v[16:19], v[108:111], v[52:55], v[16:19]
  v_mfma_f32_16x16x32_bf16 v[20:23], v[112:115], v[52:55], v[20:23]
  v_mfma_f32_16x16x32_bf16 v[24:27], v[116:119], v[52:55], v[24:27]
  ds_read_b128 v[100:103], v1 offset:35840
  ds_read_b128 v[104:107], v1 offset:36864
  ds_read_b128 v[108:111], v1 offset:37888
  ds_read_b128 v[112:115], v1 offset:38912
  ds_read_b128 v[116:119], v1 offset:39936
  s_waitcnt lgkmcnt(5)
  v_mfma_f32_16x16x32_bf16 v[8:11], v[80:83], v[56:59], v[8:11]
  v_mfma_f32_16x16x32_bf16 v[12:15], v[84:87], v[56:59], v[12:15]
  v_mfma_f32_16x16x32_bf16 v[16:19], v[88:91], v[56:59], v[16:19]
  v_mfma_f32_16x16x32_bf16 v[20:23], v[92:95], v[56:59], v[20:23]
  v_mfma_f32_16x16x32_bf16 v[24:27], v[96:99], v[56:59], v[24:27]
  s_waitcnt lgkmcnt(0)
  v_mfma_f32_16x16x32_bf16 v[8:11], v[100:103], v[60:63], v[8:11]
  v_mfma_f32_16x16x32_bf16 v[12:15], v[104:107], v[60:63], v[12:15]
  v_mfma_f32_16x16x32_bf16 v[16:19], v[108:111], v[60:63], v[16:19]
  v_mfma_f32_16x16x32_bf16 v[20:23], v[112:115], v[60:63], v[20:23]
  v_mfma_f32_16x16x32_bf16 v[24:27], v[116:119], v[60:63], v[24:27]
  v_and_b32 v3, 63, v0
  v_and_b32 v4, 15, v3
  v_lshrrev_b32 v3, 4, v3
  s_lshl_b32 s21, s17, 6
  s_lshl_b32 s23, s16, 4
  s_add_u32 s21, s21, s23
  v_add_u32 v4, s21, v4
  v_mul_u32_u24 v6, 1280, v4
  v_lshl_add_u32 v6, v3, 4, v6
  s_mul_i32 s21, s18, 5
  s_add_u32 s23, s21, 0
  s_lshr_b32 s31, s23, 1
  s_lshl_b32 s31, s31, 6
  s_and_b32 s23, s23, 1
  s_lshl_b32 s23, s23, 3
  s_add_u32 s32, s31, s23
  s_add_u32 s40, s32, s20
  buffer_load_dwordx2 v[32:33], v6, s[8:11], s40 offen
  s_add_u32 s23, s21, 1
  s_lshr_b32 s31, s23, 1
  s_lshl_b32 s31, s31, 6
  s_and_b32 s23, s23, 1
  s_lshl_b32 s23, s23, 3
  s_add_u32 s33, s31, s23
  s_add_u32 s41, s33, s20
  buffer_load_dwordx2 v[34:35], v6, s[8:11], s41 offen
  s_add_u32 s23, s21, 2
  s_lshr_b32 s31, s23, 1
  s_lshl_b32 s31, s31, 6
  s_and_b32 s23, s23, 1
  s_lshl_b32 s23, s23, 3
  s_add_u32 s34, s31, s23
  s_add_u32 s42, s34, s20
  buffer_load_dwordx2 v[36:37], v6, s[8:11], s42 offen
  s_add_u32 s23, s21, 3
  s_lshr_b32 s31, s23, 1
  s_lshl_b32 s31, s31, 6
  s_and_b32 s23, s23, 1
  s_lshl_b32 s23, s23, 3
  s_add_u32 s35, s31, s23
  s_add_u32 s43, s35, s20
  buffer_load_dwordx2 v[38:39], v6, s[8:11], s43 offen
  s_add_u32 s23, s21, 4
  s_lshr_b32 s31, s23, 1
  s_lshl_b32 s31, s31, 6
  s_and_b32 s23, s23, 1
  s_lshl_b32 s23, s23, 3
  s_add_u32 s36, s31, s23
  s_add_u32 s44, s36, s20
  buffer_load_dwordx2 v[40:41], v6, s[8:11], s44 offen
  s_waitcnt vmcnt(0)
  v_cvt_pk_bf16_f32 v80, v8, v9
  v_cvt_pk_bf16_f32 v81, v10, v11
  v_lshlrev_b32 v8, 16, v80
  v_and_b32 v9, 0xffff0000, v80
  v_lshlrev_b32 v10, 16, v81
  v_and_b32 v11, 0xffff0000, v81
  v_lshlrev_b32 v82, 16, v32
  v_and_b32 v83, 0xffff0000, v32
  v_lshlrev_b32 v84, 16, v33
  v_and_b32 v85, 0xffff0000, v33
  v_add_f32 v8, v8, v82
  v_add_f32 v9, v9, v83
  v_add_f32 v10, v10, v84
  v_add_f32 v11, v11, v85
  v_cvt_pk_bf16_f32 v32, v8, v9
  v_cvt_pk_bf16_f32 v33, v10, v11
  buffer_store_dwordx2 v[32:33], v6, s[52:55], s32 offen sc1
  v_cvt_pk_bf16_f32 v80, v12, v13
  v_cvt_pk_bf16_f32 v81, v14, v15
  v_lshlrev_b32 v12, 16, v80
  v_and_b32 v13, 0xffff0000, v80
  v_lshlrev_b32 v14, 16, v81
  v_and_b32 v15, 0xffff0000, v81
  v_lshlrev_b32 v82, 16, v34
  v_and_b32 v83, 0xffff0000, v34
  v_lshlrev_b32 v84, 16, v35
  v_and_b32 v85, 0xffff0000, v35
  v_add_f32 v12, v12, v82
  v_add_f32 v13, v13, v83
  v_add_f32 v14, v14, v84
  v_add_f32 v15, v15, v85
  v_cvt_pk_bf16_f32 v34, v12, v13
  v_cvt_pk_bf16_f32 v35, v14, v15
  buffer_store_dwordx2 v[34:35], v6, s[52:55], s33 offen sc1
  v_cvt_pk_bf16_f32 v80, v16, v17
  v_cvt_pk_bf16_f32 v81, v18, v19
  v_lshlrev_b32 v16, 16, v80
  v_and_b32 v17, 0xffff0000, v80
  v_lshlrev_b32 v18, 16, v81
  v_and_b32 v19, 0xffff0000, v81
  v_lshlrev_b32 v82, 16, v36
  v_and_b32 v83, 0xffff0000, v36
  v_lshlrev_b32 v84, 16, v37
  v_and_b32 v85, 0xffff0000, v37
  v_add_f32 v16, v16, v82
  v_add_f32 v17, v17, v83
  v_add_f32 v18, v18, v84
  v_add_f32 v19, v19, v85
  v_cvt_pk_bf16_f32 v36, v16, v17
  v_cvt_pk_bf16_f32 v37, v18, v19
  buffer_store_dwordx2 v[36:37], v6, s[52:55], s34 offen sc1
  v_cvt_pk_bf16_f32 v80, v20, v21
  v_cvt_pk_bf16_f32 v81, v22, v23
  v_lshlrev_b32 v20, 16, v80
  v_and_b32 v21, 0xffff0000, v80
  v_lshlrev_b32 v22, 16, v81
  v_and_b32 v23, 0xffff0000, v81
  v_lshlrev_b32 v82, 16, v38
  v_and_b32 v83, 0xffff0000, v38
  v_lshlrev_b32 v84, 16, v39
  v_and_b32 v85, 0xffff0000, v39
  v_add_f32 v20, v20, v82
  v_add_f32 v21, v21, v83
  v_add_f32 v22, v22, v84
  v_add_f32 v23, v23, v85
  v_cvt_pk_bf16_f32 v38, v20, v21
  v_cvt_pk_bf16_f32 v39, v22, v23
  buffer_store_dwordx2 v[38:39], v6, s[52:55], s35 offen sc1
  v_cvt_pk_bf16_f32 v80, v24, v25
  v_cvt_pk_bf16_f32 v81, v26, v27
  v_lshlrev_b32 v24, 16, v80
  v_and_b32 v25, 0xffff0000, v80
  v_lshlrev_b32 v26, 16, v81
  v_and_b32 v27, 0xffff0000, v81
  v_lshlrev_b32 v82, 16, v40
  v_and_b32 v83, 0xffff0000, v40
  v_lshlrev_b32 v84, 16, v41
  v_and_b32 v85, 0xffff0000, v41
  v_add_f32 v24, v24, v82
  v_add_f32 v25, v25, v83
  v_add_f32 v26, v26, v84
  v_add_f32 v27, v27, v85
  v_cvt_pk_bf16_f32 v40, v24, v25
  v_cvt_pk_bf16_f32 v41, v26, v27
  buffer_store_dwordx2 v[40:41], v6, s[52:55], s36 offen sc1
outb2_exit1:
  s_endpgm
.section .rodata,"a"
.p2align 6
.amdhsa_kernel prep_kernel
  .amdhsa_next_free_vgpr 80
  .amdhsa_next_free_sgpr 64
  .amdhsa_accum_offset 80
  .amdhsa_group_segment_fixed_size 0
  .amdhsa_kernarg_size 104
  .amdhsa_user_sgpr_count 2
  .amdhsa_user_sgpr_kernarg_segment_ptr 1
  .amdhsa_system_sgpr_workgroup_id_x 1
  .amdhsa_float_denorm_mode_32 3
.end_amdhsa_kernel
.p2align 6
.amdhsa_kernel ln2_kernel
  .amdhsa_next_free_vgpr 80
  .amdhsa_next_free_sgpr 40
  .amdhsa_accum_offset 80
  .amdhsa_group_segment_fixed_size 0
  .amdhsa_kernarg_size 104
  .amdhsa_user_sgpr_count 2
  .amdhsa_user_sgpr_kernarg_segment_ptr 1
  .amdhsa_system_sgpr_workgroup_id_x 1
  .amdhsa_float_denorm_mode_32 3
.end_amdhsa_kernel
.p2align 6
.amdhsa_kernel reca_kernel
  .amdhsa_next_free_vgpr 512
  .amdhsa_next_free_sgpr 102
  .amdhsa_accum_offset 256
  .amdhsa_group_segment_fixed_size 0
  .amdhsa_kernarg_size 104
  .amdhsa_user_sgpr_count 2
  .amdhsa_user_sgpr_kernarg_segment_ptr 1
  .amdhsa_system_sgpr_workgroup_id_x 1
  .amdhsa_float_denorm_mode_32 3
.end_amdhsa_kernel
.p2align 6
.amdhsa_kernel fin_kernel
  .amdhsa_next_free_vgpr 496
  .amdhsa_next_free_sgpr 64
  .amdhsa_accum_offset 256
  .amdhsa_group_segment_fixed_size 0
  .amdhsa_kernarg_size 104
  .amdhsa_user_sgpr_count 2
  .amdhsa_user_sgpr_kernarg_segment_ptr 1
  .amdhsa_system_sgpr_workgroup_id_x 1
  .amdhsa_float_denorm_mode_32 3
.end_amdhsa_kernel
.p2align 6
.amdhsa_kernel redln1_kernel
  .amdhsa_next_free_vgpr 248
  .amdhsa_next_free_sgpr 48
  .amdhsa_accum_offset 248
  .amdhsa_group_segment_fixed_size 0
  .amdhsa_kernarg_size 104
  .amdhsa_user_sgpr_count 2
  .amdhsa_user_sgpr_kernarg_segment_ptr 1
  .amdhsa_system_sgpr_workgroup_id_x 1
  .amdhsa_float_denorm_mode_32 3
.end_amdhsa_kernel
.p2align 6
.amdhsa_kernel redln2_kernel
  .amdhsa_next_free_vgpr 248
  .amdhsa_next_free_sgpr 48
  .amdhsa_accum_offset 248
  .amdhsa_group_segment_fixed_size 0
  .amdhsa_kernarg_size 104
  .amdhsa_user_sgpr_count 2
  .amdhsa_user_sgpr_kernarg_segment_ptr 1
  .amdhsa_system_sgpr_workgroup_id_x 1
  .amdhsa_float_denorm_mode_32 3
.end_amdhsa_kernel
.p2align 6
.amdhsa_kernel qkvb_kernel
  .amdhsa_next_free_vgpr 448
  .amdhsa_next_free_sgpr 102
  .amdhsa_accum_offset 256
  .amdhsa_group_segment_fixed_size 0
  .amdhsa_kernarg_size 104
  .amdhsa_user_sgpr_count 2
  .amdhsa_user_sgpr_kernarg_segment_ptr 1
  .amdhsa_system_sgpr_workgroup_id_x 1
  .amdhsa_float_denorm_mode_32 3
.end_amdhsa_kernel
.p2align 6
.amdhsa_kernel attnb_kernel
  .amdhsa_next_free_vgpr 200
  .amdhsa_next_free_sgpr 48
  .amdhsa_accum_offset 200
  .amdhsa_group_segment_fixed_size 0
  .amdhsa_kernarg_size 104
  .amdhsa_user_sgpr_count 2
  .amdhsa_user_sgpr_kernarg_segment_ptr 1
  .amdhsa_system_sgpr_workgroup_id_x 1
  .amdhsa_float_denorm_mode_32 3
.end_amdhsa_kernel
.p2align 6
.amdhsa_kernel outb1_kernel
  .amdhsa_next_free_vgpr 128
  .amdhsa_next_free_sgpr 64
  .amdhsa_accum_offset 128
  .amdhsa_group_segment_fixed_size 0
  .amdhsa_kernarg_size 104
  .amdhsa_user_sgpr_count 2
  .amdhsa_user_sgpr_kernarg_segment_ptr 1
  .amdhsa_system_sgpr_workgroup_id_x 1
  .amdhsa_float_denorm_mode_32 3
.end_amdhsa_kernel
.p2align 6
.amdhsa_kernel outb2_kernel
  .amdhsa_next_free_vgpr 128
  .amdhsa_next_free_sgpr 64
  .amdhsa_accum_offset 128
  .amdhsa_group_segment_fixed_size 0
  .amdhsa_kernarg_size 104
  .amdhsa_user_sgpr_count 2
  .amdhsa_user_sgpr_kernarg_segment_ptr 1
  .amdhsa_system_sgpr_workgroup_id_x 1
  .amdhsa_float_denorm_mode_32 3
.end_amdhsa_kernel
```

```asm
; @launch kernel=prep_kernel grid=(2248,1,1) block=(256,1,1) lds=18944
; @launch kernel=reca_kernel grid=(256,1,1) block=(256,1,1) lds=81920
; @launch kernel=fin_kernel grid=(256,1,1) block=(256,1,1) lds=98304
; @launch kernel=redln1_kernel grid=(128,1,1) block=(256,1,1) lds=512
; @launch kernel=qkvb_kernel grid=(256,1,1) block=(256,1,1) lds=81920
; @launch kernel=attnb_kernel grid=(256,1,1) block=(256,1,1) lds=0
; @launch kernel=outb1_kernel grid=(256,1,1) block=(256,1,1) lds=61440
; @launch kernel=ln2_kernel grid=(128,1,1) block=(256,1,1) lds=512
; @launch kernel=reca_kernel grid=(256,1,1) block=(256,1,1) lds=81920
; @launch kernel=fin_kernel grid=(256,1,1) block=(256,1,1) lds=98304
; @launch kernel=redln2_kernel grid=(128,1,1) block=(256,1,1) lds=512
; @launch kernel=qkvb_kernel grid=(256,1,1) block=(256,1,1) lds=81920
; @launch kernel=attnb_kernel grid=(256,1,1) block=(256,1,1) lds=0
; @launch kernel=outb2_kernel grid=(256,1,1) block=(256,1,1) lds=61440
.amdgcn_target "amdgcn-amd-amdhsa--gfx950"
.text
.globl prep_kernel
.p2align 8
.type prep_kernel,@function
prep_kernel:
  s_cmp_ge_u32 s2, 128
  s_cbranch_scc1 prep_notln5
  s_load_dwordx2 s[12:13], s[0:1], 96
  s_load_dwordx2 s[14:15], s[0:1], 0
  v_lshrrev_b32 v2, 6, v0
  v_and_b32 v3, 63, v0
  s_nop 0
  v_readfirstlane_b32 s16, v2
  s_waitcnt lgkmcnt(0)
  s_mov_b32 s4, s12
  s_mov_b32 s5, s13
  s_mov_b32 s6, 0x10000000
  s_mov_b32 s7, 0x20000
  s_mov_b32 s8, s14
  s_mov_b32 s9, s15
  s_mov_b32 s10, 2621440
  s_mov_b32 s11, 0x20000
  s_mov_b32 s20, 0
  v_and_b32 v2, 15, v3
  v_lshrrev_b32 v4, 4, v3
  s_lshl_b32 s17, s2, 4
  v_add_u32 v1, s17, v2
  v_mul_u32_u24 v1, 1280, v1
  v_lshl_add_u32 v1, v4, 4, v1
  s_mul_i32 s17, s16, 320
  s_add_u32 s20, s20, s17
  buffer_load_dwordx4 v[8:11], v1, s[8:11], s20 offen offset:0
  buffer_load_dwordx4 v[12:15], v1, s[8:11], s20 offen offset:64
  buffer_load_dwordx4 v[16:19], v1, s[8:11], s20 offen offset:128
  buffer_load_dwordx4 v[20:23], v1, s[8:11], s20 offen offset:192
  buffer_load_dwordx4 v[24:27], v1, s[8:11], s20 offen offset:256
  s_sub_u32 s21, 0, s12
  s_and_b32 s21, s21, 0x1fffff
  s_add_u32 s21, s21, 2097152
  v_mov_b32 v68, -1
  v_mov_b32 v69, -1
  v_mov_b32 v70, -1
  v_mov_b32 v71, -1
  v_lshlrev_b32 v72, 4, v0
  s_mul_i32 s22, s2, 12096
  s_add_u32 s22, s22, 0
  s_mul_i32 s23, s2, 12288
  s_add_u32 s23, s23, s21
  buffer_store_dwordx4 v[68:71], v72, s[4:7], s22 offen sc1
  s_add_u32 s22, s22, 4096
  buffer_store_dwordx4 v[68:71], v72, s[4:7], s22 offen sc1
  s_add_u32 s22, s22, 4096
  v_mov_b32 v73, 0x80000000
  v_cmp_gt_u32 vcc, 244, v0
  s_nop 1
  v_cndmask_b32 v73, v73, v72, vcc
  buffer_store_dwordx4 v[68:71], v73, s[4:7], s22 offen
  buffer_store_dwordx4 v[68:71], v72, s[4:7], s23 offen sc1
  s_add_u32 s23, s23, 4096
  buffer_store_dwordx4 v[68:71], v72, s[4:7], s23 offen sc1
  s_add_u32 s23, s23, 4096
  buffer_store_dwordx4 v[68:71], v72, s[4:7], s23 offen sc1
  s_add_u32 s23, s23, 4096
  s_mul_i32 s23, s2, 2048
  s_add_u32 s23, s23, s21
  s_add_u32 s23, s23, 1572864
  v_mov_b32 v73, 0x80000000
  v_cmp_gt_u32 vcc, 128, v0
  s_nop 1
  v_cndmask_b32 v73, v73, v72, vcc
  buffer_store_dwordx4 v[68:71], v73, s[4:7], s23 offen sc1
  s_waitcnt vmcnt(7)
  s_mul_i32 s17, s16, 320
  s_add_u32 s17, s17, 82313216
  buffer_store_dwordx4 v[8:11], v1, s[4:7], s17 offen offset:0
  buffer_store_dwordx4 v[12:15], v1, s[4:7], s17 offen offset:64
  buffer_store_dwordx4 v[16:19], v1, s[4:7], s17 offen offset:128
  buffer_store_dwordx4 v[20:23], v1, s[4:7], s17 offen offset:192
  buffer_store_dwordx4 v[24:27], v1, s[4:7], s17 offen offset:256
  v_lshlrev_b32 v5, 2, v2
  s_lshl_b32 s17, s16, 6
  v_add_u32 v1, s17, v5
  s_waitcnt vmcnt(5)
  v_lshlrev_b32 v28, 16, v8
  v_and_b32 v29, 0xffff0000, v8
  v_lshlrev_b32 v30, 16, v9
  v_and_b32 v31, 0xffff0000, v9
  v_lshlrev_b32 v32, 16, v10
  v_and_b32 v33, 0xffff0000, v10
  v_lshlrev_b32 v34, 16, v11
  v_and_b32 v35, 0xffff0000, v11
  v_lshlrev_b32 v36, 16, v12
  v_and_b32 v37, 0xffff0000, v12
  v_lshlrev_b32 v38, 16, v13
  v_and_b32 v39, 0xffff0000, v13
  v_lshlrev_b32 v40, 16, v14
  v_and_b32 v41, 0xffff0000, v14
  v_lshlrev_b32 v42, 16, v15
  v_and_b32 v43, 0xffff0000, v15
  v_lshlrev_b32 v44, 16, v16
  v_and_b32 v45, 0xffff0000, v16
  v_lshlrev_b32 v46, 16, v17
  v_and_b32 v47, 0xffff0000, v17
  v_lshlrev_b32 v48, 16, v18
  v_and_b32 v49, 0xffff0000, v18
  v_lshlrev_b32 v50, 16, v19
  v_and_b32 v51, 0xffff0000, v19
  v_lshlrev_b32 v52, 16, v20
  v_and_b32 v53, 0xffff0000, v20
  v_lshlrev_b32 v54, 16, v21
  v_and_b32 v55, 0xffff0000, v21
  v_lshlrev_b32 v56, 16, v22
  v_and_b32 v57, 0xffff0000, v22
  v_lshlrev_b32 v58, 16, v23
  v_and_b32 v59, 0xffff0000, v23
  v_lshlrev_b32 v60, 16, v24
  v_and_b32 v61, 0xffff0000, v24
  v_lshlrev_b32 v62, 16, v25
  v_and_b32 v63, 0xffff0000, v25
  v_lshlrev_b32 v64, 16, v26
  v_and_b32 v65, 0xffff0000, v26
  v_lshlrev_b32 v66, 16, v27
  v_and_b32 v67, 0xffff0000, v27
  v_pk_add_f32 v[6:7], v[28:29], v[30:31]
  v_pk_add_f32 v[6:7], v[6:7], v[32:33]
  v_pk_add_f32 v[6:7], v[6:7], v[34:35]
  v_pk_add_f32 v[6:7], v[6:7], v[36:37]
  v_pk_add_f32 v[6:7], v[6:7], v[38:39]
  v_pk_add_f32 v[6:7], v[6:7], v[40:41]
  v_pk_add_f32 v[6:7], v[6:7], v[42:43]
  v_pk_add_f32 v[6:7], v[6:7], v[44:45]
  v_pk_add_f32 v[6:7], v[6:7], v[46:47]
  v_pk_add_f32 v[6:7], v[6:7], v[48:49]
  v_pk_add_f32 v[6:7], v[6:7], v[50:51]
  v_pk_add_f32 v[6:7], v[6:7], v[52:53]
  v_pk_add_f32 v[6:7], v[6:7], v[54:55]
  v_pk_add_f32 v[6:7], v[6:7], v[56:57]
  v_pk_add_f32 v[6:7], v[6:7], v[58:59]
  v_pk_add_f32 v[6:7], v[6:7], v[60:61]
  v_pk_add_f32 v[6:7], v[6:7], v[62:63]
  v_pk_add_f32 v[6:7], v[6:7], v[64:65]
  v_pk_add_f32 v[6:7], v[6:7], v[66:67]
  v_add_f32 v4, v6, v7
  v_mov_b32 v2, v4
  s_nop 1
  v_permlane32_swap_b32 v4, v2
  v_add_f32 v4, v4, v2
  v_mov_b32 v2, v4
  s_nop 1
  v_permlane16_swap_b32 v4, v2
  v_add_f32 v4, v4, v2
  ds_write_b32 v1, v4 offset:0
  s_waitcnt lgkmcnt(0)
  s_barrier
  ds_read_b32 v4, v5 offset:0
  ds_read_b32 v2, v5 offset:64
  ds_read_b32 v3, v5 offset:128
  ds_read_b32 v6, v5 offset:192
  s_waitcnt lgkmcnt(0)
  v_add_f32 v4, v4, v2
  v_add_f32 v3, v3, v6
  v_add_f32 v4, v4, v3
  v_mul_f32 v4, 0x3acccccd, v4
  v_sub_f32 v28, v28, v4
  v_sub_f32 v29, v29, v4
  v_sub_f32 v30, v30, v4
  v_sub_f32 v31, v31, v4
  v_sub_f32 v32, v32, v4
  v_sub_f32 v33, v33, v4
  v_sub_f32 v34, v34, v4
  v_sub_f32 v35, v35, v4
  v_sub_f32 v36, v36, v4
  v_sub_f32 v37, v37, v4
  v_sub_f32 v38, v38, v4
  v_sub_f32 v39, v39, v4
  v_sub_f32 v40, v40, v4
  v_sub_f32 v41, v41, v4
  v_sub_f32 v42, v42, v4
  v_sub_f32 v43, v43, v4
  v_sub_f32 v44, v44, v4
  v_sub_f32 v45, v45, v4
  v_sub_f32 v46, v46, v4
  v_sub_f32 v47, v47, v4
  v_sub_f32 v48, v48, v4
  v_sub_f32 v49, v49, v4
  v_sub_f32 v50, v50, v4
  v_sub_f32 v51, v51, v4
  v_sub_f32 v52, v52, v4
  v_sub_f32 v53, v53, v4
  v_sub_f32 v54, v54, v4
  v_sub_f32 v55, v55, v4
  v_sub_f32 v56, v56, v4
  v_sub_f32 v57, v57, v4
  v_sub_f32 v58, v58, v4
  v_sub_f32 v59, v59, v4
  v_sub_f32 v60, v60, v4
  v_sub_f32 v61, v61, v4
  v_sub_f32 v62, v62, v4
  v_sub_f32 v63, v63, v4
  v_sub_f32 v64, v64, v4
  v_sub_f32 v65, v65, v4
  v_sub_f32 v66, v66, v4
  v_sub_f32 v67, v67, v4
  v_mul_f32 v6, v28, v28
  v_mul_f32 v7, v29, v29
  v_fmac_f32 v6, v30, v30
  v_fmac_f32 v7, v31, v31
  v_fmac_f32 v6, v32, v32
  v_fmac_f32 v7, v33, v33
  v_fmac_f32 v6, v34, v34
  v_fmac_f32 v7, v35, v35
  v_fmac_f32 v6, v36, v36
  v_fmac_f32 v7, v37, v37
  v_fmac_f32 v6, v38, v38
  v_fmac_f32 v7, v39, v39
  v_fmac_f32 v6, v40, v40
  v_fmac_f32 v7, v41, v41
  v_fmac_f32 v6, v42, v42
  v_fmac_f32 v7, v43, v43
  v_fmac_f32 v6, v44, v44
  v_fmac_f32 v7, v45, v45
  v_fmac_f32 v6, v46, v46
  v_fmac_f32 v7, v47, v47
  v_fmac_f32 v6, v48, v48
  v_fmac_f32 v7, v49, v49
  v_fmac_f32 v6, v50, v50
  v_fmac_f32 v7, v51, v51
  v_fmac_f32 v6, v52, v52
  v_fmac_f32 v7, v53, v53
  v_fmac_f32 v6, v54, v54
  v_fmac_f32 v7, v55, v55
  v_fmac_f32 v6, v56, v56
  v_fmac_f32 v7, v57, v57
  v_fmac_f32 v6, v58, v58
  v_fmac_f32 v7, v59, v59
  v_fmac_f32 v6, v60, v60
  v_fmac_f32 v7, v61, v61
  v_fmac_f32 v6, v62, v62
  v_fmac_f32 v7, v63, v63
  v_fmac_f32 v6, v64, v64
  v_fmac_f32 v7, v65, v65
  v_fmac_f32 v6, v66, v66
  v_fmac_f32 v7, v67, v67
  v_add_f32 v4, v6, v7
  v_mov_b32 v2, v4
  s_nop 1
  v_permlane32_swap_b32 v4, v2
  v_add_f32 v4, v4, v2
  v_mov_b32 v2, v4
  s_nop 1
  v_permlane16_swap_b32 v4, v2
  v_add_f32 v4, v4, v2
  ds_write_b32 v1, v4 offset:256
  s_waitcnt lgkmcnt(0)
  s_barrier
  ds_read_b32 v4, v5 offset:256
  ds_read_b32 v2, v5 offset:320
  ds_read_b32 v3, v5 offset:384
  ds_read_b32 v6, v5 offset:448
  s_waitcnt lgkmcnt(0)
  v_add_f32 v4, v4, v2
  v_add_f32 v3, v3, v6
  v_add_f32 v4, v4, v3
  v_mov_b32 v2, 0x3727c5ac
  v_fmac_f32 v2, 0x3acccccd, v4
  v_rsq_f32 v4, v2
  s_nop 0
  v_mul_f32 v28, v28, v4
  v_mul_f32 v29, v29, v4
  v_mul_f32 v30, v30, v4
  v_mul_f32 v31, v31, v4
  v_mul_f32 v32, v32, v4
  v_mul_f32 v33, v33, v4
  v_mul_f32 v34, v34, v4
  v_mul_f32 v35, v35, v4
  v_mul_f32 v36, v36, v4
  v_mul_f32 v37, v37, v4
  v_mul_f32 v38, v38, v4
  v_mul_f32 v39, v39, v4
  v_mul_f32 v40, v40, v4
  v_mul_f32 v41, v41, v4
  v_mul_f32 v42, v42, v4
  v_mul_f32 v43, v43, v4
  v_mul_f32 v44, v44, v4
  v_mul_f32 v45, v45, v4
  v_mul_f32 v46, v46, v4
  v_mul_f32 v47, v47, v4
  v_mul_f32 v48, v48, v4
  v_mul_f32 v49, v49, v4
  v_mul_f32 v50, v50, v4
  v_mul_f32 v51, v51, v4
  v_mul_f32 v52, v52, v4
  v_mul_f32 v53, v53, v4
  v_mul_f32 v54, v54, v4
  v_mul_f32 v55, v55, v4
  v_mul_f32 v56, v56, v4
  v_mul_f32 v57, v57, v4
  v_mul_f32 v58, v58, v4
  v_mul_f32 v59, v59, v4
  v_mul_f32 v60, v60, v4
  v_mul_f32 v61, v61, v4
  v_mul_f32 v62, v62, v4
  v_mul_f32 v63, v63, v4
  v_mul_f32 v64, v64, v4
  v_mul_f32 v65, v65, v4
  v_mul_f32 v66, v66, v4
  v_mul_f32 v67, v67, v4
  v_cvt_pk_bf16_f32 v8, v28, v29
  v_cvt_pk_bf16_f32 v9, v30, v31
  v_cvt_pk_bf16_f32 v10, v32, v33
  v_cvt_pk_bf16_f32 v11, v34, v35
  v_cvt_pk_bf16_f32 v12, v36, v37
  v_cvt_pk_bf16_f32 v13, v38, v39
  v_cvt_pk_bf16_f32 v14, v40, v41
  v_cvt_pk_bf16_f32 v15, v42, v43
  v_cvt_pk_bf16_f32 v16, v44, v45
  v_cvt_pk_bf16_f32 v17, v46, v47
  v_cvt_pk_bf16_f32 v18, v48, v49
  v_cvt_pk_bf16_f32 v19, v50, v51
  v_cvt_pk_bf16_f32 v20, v52, v53
  v_cvt_pk_bf16_f32 v21, v54, v55
  v_cvt_pk_bf16_f32 v22, v56, v57
  v_cvt_pk_bf16_f32 v23, v58, v59
  v_cvt_pk_bf16_f32 v24, v60, v61
  v_cvt_pk_bf16_f32 v25, v62, v63
  v_cvt_pk_bf16_f32 v26, v64, v65
  v_cvt_pk_bf16_f32 v27, v66, v67
  v_and_b32 v3, 63, v0
  v_lshlrev_b32 v1, 4, v3
  s_mul_i32 s17, s2, 20480
  s_mul_i32 s18, s16, 5120
  s_add_u32 s17, s17, s18
  s_add_u32 s17, s17, 84934656
  buffer_store_dwordx4 v[8:11], v1, s[4:7], s17 offen offset:0 sc1
  buffer_store_dwordx4 v[12:15], v1, s[4:7], s17 offen offset:1024 sc1
  buffer_store_dwordx4 v[16:19], v1, s[4:7], s17 offen offset:2048 sc1
  buffer_store_dwordx4 v[20:23], v1, s[4:7], s17 offen offset:3072 sc1
  s_add_u32 s17, s17, 4096
  buffer_store_dwordx4 v[24:27], v1, s[4:7], s17 offen offset:0 sc1
  s_endpgm
prep_notln5:
  s_sub_u32 s2, s2, 128
  s_cmp_ge_u32 s2, 2120
  s_cbranch_scc1 prep_exit1
  s_load_dwordx2 s[12:13], s[0:1], 96
  s_load_dwordx4 s[16:19], s[0:1], 16
  s_load_dwordx4 s[20:23], s[0:1], 32
  s_load_dwordx4 s[24:27], s[0:1], 64
  v_lshrrev_b32 v6, 6, v0
  v_and_b32 v1, 63, v0
  s_nop 0
  v_readfirstlane_b32 s14, v6
  v_lshlrev_b32 v5, 4, v1
  s_lshl_b32 s15, s2, 2
  s_nop 1
  s_add_u32 s15, s15, s14
  s_add_u32 s28, s15, 7680
  s_sub_u32 s29, s15, 800
  s_cmp_lt_u32 s15, 800
  s_cselect_b32 s15, s28, s29
  s_waitcnt lgkmcnt(0)
  s_mov_b32 s4, s12
  s_mov_b32 s5, s13
  s_mov_b32 s6, 0x10000000
  s_mov_b32 s7, 0x20000
  s_mov_b32 s11, 0x20000
  v_and_b32 v2, 15, v1
  v_lshrrev_b32 v3, 4, v1
  s_cmp_ge_u32 s15, 5760
  s_cbranch_scc1 prep_s22
  s_mul_hi_u32 s31, s15, 2236963
  s_mul_i32 s32, s31, 1920
  s_sub_u32 s32, s15, s32
  s_mul_hi_u32 s33, s32, 214748365
  s_mul_i32 s34, s33, 20
  s_sub_u32 s34, s32, s34
  s_cmp_eq_u32 s31, 0
  s_cselect_b32 s8, s16, s18
  s_cselect_b32 s9, s17, s19
  s_cmp_eq_u32 s31, 2
  s_cselect_b32 s8, s20, s8
  s_cselect_b32 s9, s21, s9
  s_mov_b32 s10, 7864320
  s_mul_i32 s35, s31, 7864320
  s_add_u32 s35, s35, 6291456
  v_lshrrev_b32 v6, 3, v1
  s_lshl_b32 s36, s34, 5
  v_add_u32 v6, s36, v6
  s_mov_b32 s37, 12288
  v_mul_lo_u32 v4, v6, s37
  s_lshl_b32 s36, s33, 7
  v_and_b32 v6, 7, v1
  v_lshl_add_u32 v4, v6, 4, v4
  v_add_u32 v4, s36, v4
  v_lshrrev_b32 v6, 3, v1
  v_mul_u32_u24 v12, 144, v6
  v_and_b32 v6, 7, v1
  v_lshl_add_u32 v12, v6, 4, v12
  s_mul_i32 s36, s14, 4608
  s_add_u32 s36, s36, 512
  v_add_u32 v12, s36, v12
  s_mov_b32 s29, 0
  buffer_load_dwordx4 v[16:19], v4, s[8:11], s29 offen
  s_mov_b32 s29, 98304
  buffer_load_dwordx4 v[20:23], v4, s[8:11], s29 offen
  s_mov_b32 s29, 196608
  buffer_load_dwordx4 v[24:27], v4, s[8:11], s29 offen
  s_mov_b32 s29, 294912
  buffer_load_dwordx4 v[28:31], v4, s[8:11], s29 offen
  v_bfe_u32 v6, v1, 2, 2
  v_lshlrev_b32 v13, 3, v3
  v_add_u32 v13, v13, v6
  v_mul_u32_u24 v13, 144, v13
  v_and_b32 v6, 3, v1
  v_lshl_add_u32 v13, v6, 3, v13
  v_add_u32 v13, s36, v13
  s_waitcnt vmcnt(3)
  ds_write_b128 v12, v[16:19] offset:0
  s_waitcnt vmcnt(2)
  ds_write_b128 v12, v[20:23] offset:1152
  s_waitcnt vmcnt(1)
  ds_write_b128 v12, v[24:27] offset:2304
  s_waitcnt vmcnt(0)
  ds_write_b128 v12, v[28:31] offset:3456
  s_waitcnt lgkmcnt(0)
  ds_read_b64_tr_b16 v[48:49], v13 offset:0
  ds_read_b64_tr_b16 v[50:51], v13 offset:576
  ds_read_b64_tr_b16 v[52:53], v13 offset:32
  ds_read_b64_tr_b16 v[54:55], v13 offset:608
  ds_read_b64_tr_b16 v[56:57], v13 offset:64
  ds_read_b64_tr_b16 v[58:59], v13 offset:640
  ds_read_b64_tr_b16 v[60:61], v13 offset:96
  ds_read_b64_tr_b16 v[62:63], v13 offset:672
  s_waitcnt lgkmcnt(6)
  s_lshl_b32 s30, s33, 2
  s_add_u32 s30, s30, 0
  s_mul_i32 s30, s30, 20
  s_add_u32 s30, s30, s34
  s_lshl_b32 s30, s30, 10
  s_add_u32 s30, s30, s35
  buffer_store_dwordx4 v[48:51], v5, s[4:7], s30 offen sc1
  s_waitcnt lgkmcnt(4)
  s_lshl_b32 s30, s33, 2
  s_add_u32 s30, s30, 1
  s_mul_i32 s30, s30, 20
  s_add_u32 s30, s30, s34
  s_lshl_b32 s30, s30, 10
  s_add_u32 s30, s30, s35
  buffer_store_dwordx4 v[52:55], v5, s[4:7], s30 offen sc1
  s_waitcnt lgkmcnt(2)
  s_lshl_b32 s30, s33, 2
  s_add_u32 s30, s30, 2
  s_mul_i32 s30, s30, 20
  s_add_u32 s30, s30, s34
  s_lshl_b32 s30, s30, 10
  s_add_u32 s30, s30, s35
  buffer_store_dwordx4 v[56:59], v5, s[4:7], s30 offen sc1
  s_waitcnt lgkmcnt(0)
  s_lshl_b32 s30, s33, 2
  s_add_u32 s30, s30, 3
  s_mul_i32 s30, s30, 20
  s_add_u32 s30, s30, s34
  s_lshl_b32 s30, s30, 10
  s_add_u32 s30, s30, s35
  buffer_store_dwordx4 v[60:63], v5, s[4:7], s30 offen sc1
  s_branch prep_exit1
prep_s22:
  s_sub_u32 s15, s15, 5760
  s_cmp_ge_u32 s15, 1920
  s_cbranch_scc1 prep_s33
  s_mul_hi_u32 s33, s15, 22369622
  s_mul_i32 s34, s33, 192
  s_sub_u32 s34, s15, s34
  s_mov_b32 s8, s22
  s_mov_b32 s9, s23
  s_mov_b32 s10, 7864320
  v_lshrrev_b32 v6, 3, v1
  s_lshl_b32 s36, s34, 5
  v_add_u32 v6, s36, v6
  v_mul_u32_u24 v4, 1280, v6
  s_lshl_b32 s36, s33, 7
  v_and_b32 v6, 7, v1
  v_lshl_add_u32 v4, v6, 4, v4
  v_add_u32 v4, s36, v4
  v_lshrrev_b32 v6, 3, v1
  v_mul_u32_u24 v12, 144, v6
  v_and_b32 v6, 7, v1
  v_lshl_add_u32 v12, v6, 4, v12
  s_mul_i32 s36, s14, 4608
  s_add_u32 s36, s36, 512
  v_add_u32 v12, s36, v12
  s_mov_b32 s29, 0
  buffer_load_dwordx4 v[16:19], v4, s[8:11], s29 offen
  s_mov_b32 s29, 10240
  buffer_load_dwordx4 v[20:23], v4, s[8:11], s29 offen
  s_mov_b32 s29, 20480
  buffer_load_dwordx4 v[24:27], v4, s[8:11], s29 offen
  s_mov_b32 s29, 30720
  buffer_load_dwordx4 v[28:31], v4, s[8:11], s29 offen
  v_bfe_u32 v6, v1, 2, 2
  v_lshlrev_b32 v13, 2, v3
  v_add_u32 v13, v13, v6
  v_mul_u32_u24 v13, 144, v13
  v_and_b32 v6, 3, v1
  v_lshl_add_u32 v13, v6, 4, v13
  v_add_u32 v13, s36, v13
  s_waitcnt vmcnt(3)
  ds_write_b128 v12, v[16:19] offset:0
  s_waitcnt vmcnt(2)
  ds_write_b128 v12, v[20:23] offset:1152
  s_waitcnt vmcnt(1)
  ds_write_b128 v12, v[24:27] offset:2304
  s_waitcnt vmcnt(0)
  ds_write_b128 v12, v[28:31] offset:3456
  s_waitcnt lgkmcnt(0)
  ds_read_b64_tr_b16 v[48:49], v13 offset:0
  ds_read_b64_tr_b16 v[50:51], v13 offset:2304
  ds_read_b64_tr_b16 v[52:53], v13 offset:8
  ds_read_b64_tr_b16 v[54:55], v13 offset:2312
  ds_read_b64_tr_b16 v[56:57], v13 offset:64
  ds_read_b64_tr_b16 v[58:59], v13 offset:2368
  ds_read_b64_tr_b16 v[60:61], v13 offset:72
  ds_read_b64_tr_b16 v[62:63], v13 offset:2376
  s_waitcnt lgkmcnt(6)
  s_lshl_b32 s30, s33, 2
  s_add_u32 s30, s30, 0
  s_mul_i32 s30, s30, 192
  s_add_u32 s30, s30, s34
  s_lshl_b32 s30, s30, 10
  s_add_u32 s30, s30, 29884416
  buffer_store_dwordx4 v[48:51], v5, s[4:7], s30 offen sc1
  s_waitcnt lgkmcnt(4)
  s_lshl_b32 s30, s33, 2
  s_add_u32 s30, s30, 1
  s_mul_i32 s30, s30, 192
  s_add_u32 s30, s30, s34
  s_lshl_b32 s30, s30, 10
  s_add_u32 s30, s30, 29884416
  buffer_store_dwordx4 v[52:55], v5, s[4:7], s30 offen sc1
  s_waitcnt lgkmcnt(2)
  s_lshl_b32 s30, s33, 2
  s_add_u32 s30, s30, 2
  s_mul_i32 s30, s30, 192
  s_add_u32 s30, s30, s34
  s_lshl_b32 s30, s30, 10
  s_add_u32 s30, s30, 29884416
  buffer_store_dwordx4 v[56:59], v5, s[4:7], s30 offen sc1
  s_waitcnt lgkmcnt(0)
  s_lshl_b32 s30, s33, 2
  s_add_u32 s30, s30, 3
  s_mul_i32 s30, s30, 192
  s_add_u32 s30, s30, s34
  s_lshl_b32 s30, s30, 10
  s_add_u32 s30, s30, 29884416
  buffer_store_dwordx4 v[60:63], v5, s[4:7], s30 offen sc1
  s_branch prep_exit1
prep_s33:
  s_sub_u32 s15, s15, 1920
  s_cmp_ge_u32 s15, 600
  s_cbranch_scc1 prep_s44
  s_mul_hi_u32 s33, s15, 214748365
  s_mul_i32 s34, s33, 20
  s_sub_u32 s34, s15, s34
  s_mov_b32 s8, s24
  s_mov_b32 s9, s25
  s_mov_b32 s10, 2457600
  v_lshrrev_b32 v6, 3, v1
  s_lshl_b32 s36, s34, 5
  v_add_u32 v6, s36, v6
  v_mul_u32_u24 v4, 3840, v6
  s_lshl_b32 s36, s33, 7
  v_and_b32 v6, 7, v1
  v_lshl_add_u32 v4, v6, 4, v4
  v_add_u32 v4, s36, v4
  v_lshrrev_b32 v6, 3, v1
  v_mul_u32_u24 v12, 144, v6
  v_and_b32 v6, 7, v1
  v_lshl_add_u32 v12, v6, 4, v12
  s_mul_i32 s36, s14, 4608
  s_add_u32 s36, s36, 512
  v_add_u32 v12, s36, v12
  s_mov_b32 s29, 0
  buffer_load_dwordx4 v[16:19], v4, s[8:11], s29 offen
  s_mov_b32 s29, 30720
  buffer_load_dwordx4 v[20:23], v4, s[8:11], s29 offen
  s_mov_b32 s29, 61440
  buffer_load_dwordx4 v[24:27], v4, s[8:11], s29 offen
  s_mov_b32 s29, 92160
  buffer_load_dwordx4 v[28:31], v4, s[8:11], s29 offen
  v_bfe_u32 v6, v1, 2, 2
  v_lshlrev_b32 v13, 3, v3
  v_add_u32 v13, v13, v6
  v_mul_u32_u24 v13, 144, v13
  v_and_b32 v6, 3, v1
  v_lshl_add_u32 v13, v6, 3, v13
  v_add_u32 v13, s36, v13
  s_waitcnt vmcnt(3)
  ds_write_b128 v12, v[16:19] offset:0
  s_waitcnt vmcnt(2)
  ds_write_b128 v12, v[20:23] offset:1152
  s_waitcnt vmcnt(1)
  ds_write_b128 v12, v[24:27] offset:2304
  s_waitcnt vmcnt(0)
  ds_write_b128 v12, v[28:31] offset:3456
  s_waitcnt lgkmcnt(0)
  ds_read_b64_tr_b16 v[48:49], v13 offset:0
  ds_read_b64_tr_b16 v[50:51], v13 offset:576
  ds_read_b64_tr_b16 v[52:53], v13 offset:32
  ds_read_b64_tr_b16 v[54:55], v13 offset:608
  ds_read_b64_tr_b16 v[56:57], v13 offset:64
  ds_read_b64_tr_b16 v[58:59], v13 offset:640
  ds_read_b64_tr_b16 v[60:61], v13 offset:96
  ds_read_b64_tr_b16 v[62:63], v13 offset:672
  s_waitcnt lgkmcnt(6)
  s_lshl_b32 s30, s33, 2
  s_add_u32 s30, s30, 0
  s_mul_i32 s30, s30, 20
  s_add_u32 s30, s30, s34
  s_lshl_b32 s30, s30, 10
  s_add_u32 s30, s30, 87556096
  buffer_store_dwordx4 v[48:51], v5, s[4:7], s30 offen sc1
  s_waitcnt lgkmcnt(4)
  s_lshl_b32 s30, s33, 2
  s_add_u32 s30, s30, 1
  s_mul_i32 s30, s30, 20
  s_add_u32 s30, s30, s34
  s_lshl_b32 s30, s30, 10
  s_add_u32 s30, s30, 87556096
  buffer_store_dwordx4 v[52:55], v5, s[4:7], s30 offen sc1
  s_waitcnt lgkmcnt(2)
  s_lshl_b32 s30, s33, 2
  s_add_u32 s30, s30, 2
  s_mul_i32 s30, s30, 20
  s_add_u32 s30, s30, s34
  s_lshl_b32 s30, s30, 10
  s_add_u32 s30, s30, 87556096
  buffer_store_dwordx4 v[56:59], v5, s[4:7], s30 offen sc1
  s_waitcnt lgkmcnt(0)
  s_lshl_b32 s30, s33, 2
  s_add_u32 s30, s30, 3
  s_mul_i32 s30, s30, 20
  s_add_u32 s30, s30, s34
  s_lshl_b32 s30, s30, 10
  s_add_u32 s30, s30, 87556096
  buffer_store_dwordx4 v[60:63], v5, s[4:7], s30 offen sc1
  s_branch prep_exit1
prep_s44:
  s_sub_u32 s15, s15, 600
  s_mul_hi_u32 s33, s15, 214748365
  s_mul_i32 s34, s33, 20
  s_sub_u32 s34, s15, s34
  s_mov_b32 s8, s26
  s_mov_b32 s9, s27
  s_mov_b32 s10, 819200
  v_lshrrev_b32 v6, 3, v1
  s_lshl_b32 s36, s34, 5
  v_add_u32 v6, s36, v6
  v_mul_u32_u24 v4, 1280, v6
  s_lshl_b32 s36, s33, 7
  v_and_b32 v6, 7, v1
  v_lshl_add_u32 v4, v6, 4, v4
  v_add_u32 v4, s36, v4
  v_lshrrev_b32 v6, 3, v1
  v_mul_u32_u24 v12, 144, v6
  v_and_b32 v6, 7, v1
  v_lshl_add_u32 v12, v6, 4, v12
  s_mul_i32 s36, s14, 4608
  s_add_u32 s36, s36, 512
  v_add_u32 v12, s36, v12
  s_mov_b32 s29, 0
  buffer_load_dwordx4 v[16:19], v4, s[8:11], s29 offen
  s_mov_b32 s29, 10240
  buffer_load_dwordx4 v[20:23], v4, s[8:11], s29 offen
  s_mov_b32 s29, 20480
  buffer_load_dwordx4 v[24:27], v4, s[8:11], s29 offen
  s_mov_b32 s29, 30720
  buffer_load_dwordx4 v[28:31], v4, s[8:11], s29 offen
  v_bfe_u32 v6, v1, 2, 2
  v_lshlrev_b32 v13, 3, v3
  v_add_u32 v13, v13, v6
  v_mul_u32_u24 v13, 144, v13
  v_and_b32 v6, 3, v1
  v_lshl_add_u32 v13, v6, 4, v13
  v_add_u32 v13, s36, v13
  s_waitcnt vmcnt(3)
  ds_write_b128 v12, v[16:19] offset:0
  s_waitcnt vmcnt(2)
  ds_write_b128 v12, v[20:23] offset:1152
  s_waitcnt vmcnt(1)
  ds_write_b128 v12, v[24:27] offset:2304
  s_waitcnt vmcnt(0)
  ds_write_b128 v12, v[28:31] offset:3456
  s_waitcnt lgkmcnt(0)
  ds_read_b64_tr_b16 v[48:49], v13 offset:0
  ds_read_b64_tr_b16 v[50:51], v13 offset:576
  ds_read_b64_tr_b16 v[52:53], v13 offset:8
  ds_read_b64_tr_b16 v[54:55], v13 offset:584
  ds_read_b64_tr_b16 v[56:57], v13 offset:64
  ds_read_b64_tr_b16 v[58:59], v13 offset:640
  ds_read_b64_tr_b16 v[60:61], v13 offset:72
  ds_read_b64_tr_b16 v[62:63], v13 offset:648
  s_waitcnt lgkmcnt(6)
  s_lshl_b32 s30, s33, 2
  s_add_u32 s30, s30, 0
  s_mul_i32 s30, s30, 20
  s_add_u32 s30, s30, s34
  s_lshl_b32 s30, s30, 10
  s_add_u32 s30, s30, 90013696
  buffer_store_dwordx4 v[48:51], v5, s[4:7], s30 offen sc1
  s_waitcnt lgkmcnt(4)
  s_lshl_b32 s30, s33, 2
  s_add_u32 s30, s30, 1
  s_mul_i32 s30, s30, 20
  s_add_u32 s30, s30, s34
  s_lshl_b32 s30, s30, 10
  s_add_u32 s30, s30, 90013696
  buffer_store_dwordx4 v[52:55], v5, s[4:7], s30 offen sc1
  s_waitcnt lgkmcnt(2)
  s_lshl_b32 s30, s33, 2
  s_add_u32 s30, s30, 2
  s_mul_i32 s30, s30, 20
  s_add_u32 s30, s30, s34
  s_lshl_b32 s30, s30, 10
  s_add_u32 s30, s30, 90013696
  buffer_store_dwordx4 v[56:59], v5, s[4:7], s30 offen sc1
  s_waitcnt lgkmcnt(0)
  s_lshl_b32 s30, s33, 2
  s_add_u32 s30, s30, 3
  s_mul_i32 s30, s30, 20
  s_add_u32 s30, s30, s34
  s_lshl_b32 s30, s30, 10
  s_add_u32 s30, s30, 90013696
  buffer_store_dwordx4 v[60:63], v5, s[4:7], s30 offen sc1
prep_exit1:
  s_endpgm
.globl ln2_kernel
.p2align 8
.type ln2_kernel,@function
ln2_kernel:
  s_cmp_ge_u32 s2, 128
  s_cbranch_scc1 ln2_exit1
  s_load_dwordx2 s[12:13], s[0:1], 96
  s_load_dwordx2 s[14:15], s[0:1], 0
  v_lshrrev_b32 v2, 6, v0
  v_and_b32 v3, 63, v0
  s_nop 0
  v_readfirstlane_b32 s16, v2
  s_waitcnt lgkmcnt(0)
  s_mov_b32 s4, s12
  s_mov_b32 s5, s13
  s_mov_b32 s6, 0x10000000
  s_mov_b32 s7, 0x20000
  s_mov_b32 s8, s12
  s_mov_b32 s9, s13
  s_mov_b32 s10, 0x10000000
  s_mov_b32 s11, 0x20000
  s_mov_b32 s20, 82313216
  v_and_b32 v2, 15, v3
  v_lshrrev_b32 v4, 4, v3
  s_lshl_b32 s17, s2, 4
  v_add_u32 v1, s17, v2
  v_mul_u32_u24 v1, 1280, v1
  v_lshl_add_u32 v1, v4, 4, v1
  s_mul_i32 s17, s16, 320
  s_add_u32 s20, s20, s17
  buffer_load_dwordx4 v[8:11], v1, s[8:11], s20 offen offset:0
  buffer_load_dwordx4 v[12:15], v1, s[8:11], s20 offen offset:64
  buffer_load_dwordx4 v[16:19], v1, s[8:11], s20 offen offset:128
  buffer_load_dwordx4 v[20:23], v1, s[8:11], s20 offen offset:192
  buffer_load_dwordx4 v[24:27], v1, s[8:11], s20 offen offset:256
  s_sub_u32 s21, 0, s12
  s_and_b32 s21, s21, 0x1fffff
  s_add_u32 s21, s21, 2097152
  v_mov_b32 v68, -1
  v_mov_b32 v69, -1
  v_mov_b32 v70, -1
  v_mov_b32 v71, -1
  v_lshlrev_b32 v72, 4, v0
  s_mul_i32 s22, s2, 12096
  s_add_u32 s22, s22, 0
  s_mul_i32 s23, s2, 12288
  s_add_u32 s23, s23, s21
  buffer_store_dwordx4 v[68:71], v72, s[4:7], s22 offen sc1
  s_add_u32 s22, s22, 4096
  buffer_store_dwordx4 v[68:71], v72, s[4:7], s22 offen sc1
  s_add_u32 s22, s22, 4096
  v_mov_b32 v73, 0x80000000
  v_cmp_gt_u32 vcc, 244, v0
  s_nop 1
  v_cndmask_b32 v73, v73, v72, vcc
  buffer_store_dwordx4 v[68:71], v73, s[4:7], s22 offen
  buffer_store_dwordx4 v[68:71], v72, s[4:7], s23 offen sc1
  s_add_u32 s23, s23, 4096
  buffer_store_dwordx4 v[68:71], v72, s[4:7], s23 offen sc1
  s_add_u32 s23, s23, 4096
  buffer_store_dwordx4 v[68:71], v72, s[4:7], s23 offen sc1
  s_add_u32 s23, s23, 4096
  s_mul_i32 s23, s2, 2048
  s_add_u32 s23, s23, s21
  s_add_u32 s23, s23, 1572864
  v_mov_b32 v73, 0x80000000
  v_cmp_gt_u32 vcc, 128, v0
  s_nop 1
  v_cndmask_b32 v73, v73, v72, vcc
  buffer_store_dwordx4 v[68:71], v73, s[4:7], s23 offen sc1
  v_lshlrev_b32 v5, 2, v2
  s_lshl_b32 s17, s16, 6
  v_add_u32 v1, s17, v5
  s_waitcnt vmcnt(7)
  v_lshlrev_b32 v28, 16, v8
  v_and_b32 v29, 0xffff0000, v8
  v_lshlrev_b32 v30, 16, v9
  v_and_b32 v31, 0xffff0000, v9
  v_lshlrev_b32 v32, 16, v10
  v_and_b32 v33, 0xffff0000, v10
  v_lshlrev_b32 v34, 16, v11
  v_and_b32 v35, 0xffff0000, v11
  v_lshlrev_b32 v36, 16, v12
  v_and_b32 v37, 0xffff0000, v12
  v_lshlrev_b32 v38, 16, v13
  v_and_b32 v39, 0xffff0000, v13
  v_lshlrev_b32 v40, 16, v14
  v_and_b32 v41, 0xffff0000, v14
  v_lshlrev_b32 v42, 16, v15
  v_and_b32 v43, 0xffff0000, v15
  v_lshlrev_b32 v44, 16, v16
  v_and_b32 v45, 0xffff0000, v16
  v_lshlrev_b32 v46, 16, v17
  v_and_b32 v47, 0xffff0000, v17
  v_lshlrev_b32 v48, 16, v18
  v_and_b32 v49, 0xffff0000, v18
  v_lshlrev_b32 v50, 16, v19
  v_and_b32 v51, 0xffff0000, v19
  v_lshlrev_b32 v52, 16, v20
  v_and_b32 v53, 0xffff0000, v20
  v_lshlrev_b32 v54, 16, v21
  v_and_b32 v55, 0xffff0000, v21
  v_lshlrev_b32 v56, 16, v22
  v_and_b32 v57, 0xffff0000, v22
  v_lshlrev_b32 v58, 16, v23
  v_and_b32 v59, 0xffff0000, v23
  v_lshlrev_b32 v60, 16, v24
  v_and_b32 v61, 0xffff0000, v24
  v_lshlrev_b32 v62, 16, v25
  v_and_b32 v63, 0xffff0000, v25
  v_lshlrev_b32 v64, 16, v26
  v_and_b32 v65, 0xffff0000, v26
  v_lshlrev_b32 v66, 16, v27
  v_and_b32 v67, 0xffff0000, v27
  v_pk_add_f32 v[6:7], v[28:29], v[30:31]
  v_pk_add_f32 v[6:7], v[6:7], v[32:33]
  v_pk_add_f32 v[6:7], v[6:7], v[34:35]
  v_pk_add_f32 v[6:7], v[6:7], v[36:37]
  v_pk_add_f32 v[6:7], v[6:7], v[38:39]
  v_pk_add_f32 v[6:7], v[6:7], v[40:41]
  v_pk_add_f32 v[6:7], v[6:7], v[42:43]
  v_pk_add_f32 v[6:7], v[6:7], v[44:45]
  v_pk_add_f32 v[6:7], v[6:7], v[46:47]
  v_pk_add_f32 v[6:7], v[6:7], v[48:49]
  v_pk_add_f32 v[6:7], v[6:7], v[50:51]
  v_pk_add_f32 v[6:7], v[6:7], v[52:53]
  v_pk_add_f32 v[6:7], v[6:7], v[54:55]
  v_pk_add_f32 v[6:7], v[6:7], v[56:57]
  v_pk_add_f32 v[6:7], v[6:7], v[58:59]
  v_pk_add_f32 v[6:7], v[6:7], v[60:61]
  v_pk_add_f32 v[6:7], v[6:7], v[62:63]
  v_pk_add_f32 v[6:7], v[6:7], v[64:65]
  v_pk_add_f32 v[6:7], v[6:7], v[66:67]
  v_add_f32 v4, v6, v7
  v_mov_b32 v2, v4
  s_nop 1
  v_permlane32_swap_b32 v4, v2
  v_add_f32 v4, v4, v2
  v_mov_b32 v2, v4
  s_nop 1
  v_permlane16_swap_b32 v4, v2
  v_add_f32 v4, v4, v2
  ds_write_b32 v1, v4 offset:0
  s_waitcnt lgkmcnt(0)
  s_barrier
  ds_read_b32 v4, v5 offset:0
  ds_read_b32 v2, v5 offset:64
  ds_read_b32 v3, v5 offset:128
  ds_read_b32 v6, v5 offset:192
  s_waitcnt lgkmcnt(0)
  v_add_f32 v4, v4, v2
  v_add_f32 v3, v3, v6
  v_add_f32 v4, v4, v3
  v_mul_f32 v4, 0x3acccccd, v4
  v_sub_f32 v28, v28, v4
  v_sub_f32 v29, v29, v4
  v_sub_f32 v30, v30, v4
  v_sub_f32 v31, v31, v4
  v_sub_f32 v32, v32, v4
  v_sub_f32 v33, v33, v4
  v_sub_f32 v34, v34, v4
  v_sub_f32 v35, v35, v4
  v_sub_f32 v36, v36, v4
  v_sub_f32 v37, v37, v4
  v_sub_f32 v38, v38, v4
  v_sub_f32 v39, v39, v4
  v_sub_f32 v40, v40, v4
  v_sub_f32 v41, v41, v4
  v_sub_f32 v42, v42, v4
  v_sub_f32 v43, v43, v4
  v_sub_f32 v44, v44, v4
  v_sub_f32 v45, v45, v4
  v_sub_f32 v46, v46, v4
  v_sub_f32 v47, v47, v4
  v_sub_f32 v48, v48, v4
  v_sub_f32 v49, v49, v4
  v_sub_f32 v50, v50, v4
  v_sub_f32 v51, v51, v4
  v_sub_f32 v52, v52, v4
  v_sub_f32 v53, v53, v4
  v_sub_f32 v54, v54, v4
  v_sub_f32 v55, v55, v4
  v_sub_f32 v56, v56, v4
  v_sub_f32 v57, v57, v4
  v_sub_f32 v58, v58, v4
  v_sub_f32 v59, v59, v4
  v_sub_f32 v60, v60, v4
  v_sub_f32 v61, v61, v4
  v_sub_f32 v62, v62, v4
  v_sub_f32 v63, v63, v4
  v_sub_f32 v64, v64, v4
  v_sub_f32 v65, v65, v4
  v_sub_f32 v66, v66, v4
  v_sub_f32 v67, v67, v4
  v_mul_f32 v6, v28, v28
  v_mul_f32 v7, v29, v29
  v_fmac_f32 v6, v30, v30
  v_fmac_f32 v7, v31, v31
  v_fmac_f32 v6, v32, v32
  v_fmac_f32 v7, v33, v33
  v_fmac_f32 v6, v34, v34
  v_fmac_f32 v7, v35, v35
  v_fmac_f32 v6, v36, v36
  v_fmac_f32 v7, v37, v37
  v_fmac_f32 v6, v38, v38
  v_fmac_f32 v7, v39, v39
  v_fmac_f32 v6, v40, v40
  v_fmac_f32 v7, v41, v41
  v_fmac_f32 v6, v42, v42
  v_fmac_f32 v7, v43, v43
  v_fmac_f32 v6, v44, v44
  v_fmac_f32 v7, v45, v45
  v_fmac_f32 v6, v46, v46
  v_fmac_f32 v7, v47, v47
  v_fmac_f32 v6, v48, v48
  v_fmac_f32 v7, v49, v49
  v_fmac_f32 v6, v50, v50
  v_fmac_f32 v7, v51, v51
  v_fmac_f32 v6, v52, v52
  v_fmac_f32 v7, v53, v53
  v_fmac_f32 v6, v54, v54
  v_fmac_f32 v7, v55, v55
  v_fmac_f32 v6, v56, v56
  v_fmac_f32 v7, v57, v57
  v_fmac_f32 v6, v58, v58
  v_fmac_f32 v7, v59, v59
  v_fmac_f32 v6, v60, v60
  v_fmac_f32 v7, v61, v61
  v_fmac_f32 v6, v62, v62
  v_fmac_f32 v7, v63, v63
  v_fmac_f32 v6, v64, v64
  v_fmac_f32 v7, v65, v65
  v_fmac_f32 v6, v66, v66
  v_fmac_f32 v7, v67, v67
  v_add_f32 v4, v6, v7
  v_mov_b32 v2, v4
  s_nop 1
  v_permlane32_swap_b32 v4, v2
  v_add_f32 v4, v4, v2
  v_mov_b32 v2, v4
  s_nop 1
  v_permlane16_swap_b32 v4, v2
  v_add_f32 v4, v4, v2
  ds_write_b32 v1, v4 offset:256
  s_waitcnt lgkmcnt(0)
  s_barrier
  ds_read_b32 v4, v5 offset:256
  ds_read_b32 v2, v5 offset:320
  ds_read_b32 v3, v5 offset:384
  ds_read_b32 v6, v5 offset:448
  s_waitcnt lgkmcnt(0)
  v_add_f32 v4, v4, v2
  v_add_f32 v3, v3, v6
  v_add_f32 v4, v4, v3
  v_mov_b32 v2, 0x3727c5ac
  v_fmac_f32 v2, 0x3acccccd, v4
  v_rsq_f32 v4, v2
  s_nop 0
  v_mul_f32 v28, v28, v4
  v_mul_f32 v29, v29, v4
  v_mul_f32 v30, v30, v4
  v_mul_f32 v31, v31, v4
  v_mul_f32 v32, v32, v4
  v_mul_f32 v33, v33, v4
  v_mul_f32 v34, v34, v4
  v_mul_f32 v35, v35, v4
  v_mul_f32 v36, v36, v4
  v_mul_f32 v37, v37, v4
  v_mul_f32 v38, v38, v4
  v_mul_f32 v39, v39, v4
  v_mul_f32 v40, v40, v4
  v_mul_f32 v41, v41, v4
  v_mul_f32 v42, v42, v4
  v_mul_f32 v43, v43, v4
  v_mul_f32 v44, v44, v4
  v_mul_f32 v45, v45, v4
  v_mul_f32 v46, v46, v4
  v_mul_f32 v47, v47, v4
  v_mul_f32 v48, v48, v4
  v_mul_f32 v49, v49, v4
  v_mul_f32 v50, v50, v4
  v_mul_f32 v51, v51, v4
  v_mul_f32 v52, v52, v4
  v_mul_f32 v53, v53, v4
  v_mul_f32 v54, v54, v4
  v_mul_f32 v55, v55, v4
  v_mul_f32 v56, v56, v4
  v_mul_f32 v57, v57, v4
  v_mul_f32 v58, v58, v4
  v_mul_f32 v59, v59, v4
  v_mul_f32 v60, v60, v4
  v_mul_f32 v61, v61, v4
  v_mul_f32 v62, v62, v4
  v_mul_f32 v63, v63, v4
  v_mul_f32 v64, v64, v4
  v_mul_f32 v65, v65, v4
  v_mul_f32 v66, v66, v4
  v_mul_f32 v67, v67, v4
  v_cvt_pk_bf16_f32 v8, v28, v29
  v_cvt_pk_bf16_f32 v9, v30, v31
  v_cvt_pk_bf16_f32 v10, v32, v33
  v_cvt_pk_bf16_f32 v11, v34, v35
  v_cvt_pk_bf16_f32 v12, v36, v37
  v_cvt_pk_bf16_f32 v13, v38, v39
  v_cvt_pk_bf16_f32 v14, v40, v41
  v_cvt_pk_bf16_f32 v15, v42, v43
  v_cvt_pk_bf16_f32 v16, v44, v45
  v_cvt_pk_bf16_f32 v17, v46, v47
  v_cvt_pk_bf16_f32 v18, v48, v49
  v_cvt_pk_bf16_f32 v19, v50, v51
  v_cvt_pk_bf16_f32 v20, v52, v53
  v_cvt_pk_bf16_f32 v21, v54, v55
  v_cvt_pk_bf16_f32 v22, v56, v57
  v_cvt_pk_bf16_f32 v23, v58, v59
  v_cvt_pk_bf16_f32 v24, v60, v61
  v_cvt_pk_bf16_f32 v25, v62, v63
  v_cvt_pk_bf16_f32 v26, v64, v65
  v_cvt_pk_bf16_f32 v27, v66, v67
  v_and_b32 v3, 63, v0
  v_lshlrev_b32 v1, 4, v3
  s_mul_i32 s17, s2, 20480
  s_mul_i32 s18, s16, 5120
  s_add_u32 s17, s17, s18
  s_add_u32 s17, s17, 84934656
  buffer_store_dwordx4 v[8:11], v1, s[4:7], s17 offen offset:0 sc1
  buffer_store_dwordx4 v[12:15], v1, s[4:7], s17 offen offset:1024 sc1
  buffer_store_dwordx4 v[16:19], v1, s[4:7], s17 offen offset:2048 sc1
  buffer_store_dwordx4 v[20:23], v1, s[4:7], s17 offen offset:3072 sc1
  s_add_u32 s17, s17, 4096
  buffer_store_dwordx4 v[24:27], v1, s[4:7], s17 offen offset:0 sc1
ln2_exit1:
  s_endpgm
.globl reca_kernel
.p2align 8
.type reca_kernel,@function
reca_kernel:
  s_cmp_ge_u32 s2, 256
  s_cbranch_scc1 reca_exitb3
  s_load_dwordx2 s[48:49], s[0:1], 96
  s_load_dwordx2 s[50:51], s[0:1], 88
  s_load_dwordx2 s[52:53], s[0:1], 8
  s_getreg_b32 s42, hwreg(HW_REG_XCC_ID, 0, 3)
  v_lshrrev_b32 v28, 6, v0
  v_and_b32 v29, 63, v0
  s_and_b32 s13, s2, 7
  v_readfirstlane_b32 s12, v28
  v_lshlrev_b32 v1, 4, v29
  s_lshr_b32 s14, s2, 3
  s_mov_b32 s18, 0x100000
  s_waitcnt lgkmcnt(0)
  s_mov_b32 s57, 0
  s_mov_b32 s4, s48
  s_mov_b32 s5, s49
  s_mov_b32 s6, 0x10000000
  s_mov_b32 s7, 0x20000
  s_mov_b32 s8, s50
  s_mov_b32 s9, s51
  s_mov_b32 s10, 256
  s_mov_b32 s11, 0x20000
  v_add_u32 v2, 0x1000, v1
  v_add_u32 v3, 0x2000, v1
  v_mov_b32 v31, 0x80000000
  s_lshl_b32 s34, s42, 3
  s_lshl_b64 s[36:37], 1, s34
  s_lshl_b32 s34, s13, 3
  v_cmp_eq_u32 vcc, 0, v0
  v_mov_b32 v30, s34
  s_nop 0
  v_cndmask_b32 v30, v31, v30, vcc
  v_mov_b32 v44, s36
  v_mov_b32 v45, s37
  buffer_atomic_add_x2 v[44:45], v30, s[8:11], 0 offen
  s_sub_u32 s56, 0, s48
  s_and_b32 s56, s56, 0x1fffff
  s_add_u32 s56, s56, 2097152
  s_nop 0
  s_cmp_ge_u32 s14, 24
  s_cbranch_scc1 reca_proj2
  s_mul_i32 s34, s14, 43
  s_lshr_b32 s34, s34, 8
  s_mul_i32 s35, s34, 6
  s_sub_u32 s16, s14, s35
  s_lshl_b32 s15, s13, 2
  s_add_u32 s15, s15, s34
  s_lshr_b32 s19, s12, 1
  s_and_b32 s37, s12, 1
  s_mul_i32 s34, s15, 12
  s_lshl_b32 s35, s16, 1
  s_add_u32 s34, s34, s35
  s_add_u32 s34, s34, s37
  s_mul_i32 s34, s34, 20480
  s_mov_b32 s35, 14155776
  s_cmp_eq_u32 s19, 0
  s_cselect_b32 s35, 6291456, s35
  s_add_u32 s35, s35, s34
  s_mul_i32 s36, s19, 10240
  s_add_u32 s20, s35, s36
  s_sub_u32 s36, 10240, s36
  s_add_u32 s21, s35, s36
  s_add_u32 s22, s34, 22020096
  s_mul_i32 s36, s19, 10240
  s_add_u32 s22, s22, s36
  buffer_load_dwordx4 a[0:3], v1, s[4:7], s20 offen offset:0
  buffer_load_dwordx4 a[4:7], v1, s[4:7], s20 offen offset:1024
  buffer_load_dwordx4 a[8:11], v1, s[4:7], s20 offen offset:2048
  buffer_load_dwordx4 a[12:15], v1, s[4:7], s20 offen offset:3072
  buffer_load_dwordx4 a[16:19], v2, s[4:7], s20 offen offset:0
  buffer_load_dwordx4 a[20:23], v2, s[4:7], s20 offen offset:1024
  buffer_load_dwordx4 a[24:27], v2, s[4:7], s20 offen offset:2048
  buffer_load_dwordx4 a[28:31], v2, s[4:7], s20 offen offset:3072
  buffer_load_dwordx4 a[32:35], v3, s[4:7], s20 offen offset:0
  buffer_load_dwordx4 a[36:39], v3, s[4:7], s20 offen offset:1024
  buffer_load_dwordx4 a[40:43], v1, s[4:7], s21 offen offset:0
  buffer_load_dwordx4 a[44:47], v1, s[4:7], s21 offen offset:1024
  buffer_load_dwordx4 a[48:51], v1, s[4:7], s21 offen offset:2048
  buffer_load_dwordx4 a[52:55], v1, s[4:7], s21 offen offset:3072
  buffer_load_dwordx4 a[56:59], v2, s[4:7], s21 offen offset:0
  buffer_load_dwordx4 a[60:63], v2, s[4:7], s21 offen offset:1024
  buffer_load_dwordx4 a[64:67], v2, s[4:7], s21 offen offset:2048
  buffer_load_dwordx4 a[68:71], v2, s[4:7], s21 offen offset:3072
  buffer_load_dwordx4 a[72:75], v3, s[4:7], s21 offen offset:0
  buffer_load_dwordx4 a[76:79], v3, s[4:7], s21 offen offset:1024
  buffer_load_dwordx4 a[80:83], v1, s[4:7], s22 offen offset:0
  buffer_load_dwordx4 a[84:87], v1, s[4:7], s22 offen offset:1024
  buffer_load_dwordx4 a[88:91], v1, s[4:7], s22 offen offset:2048
  buffer_load_dwordx4 a[92:95], v1, s[4:7], s22 offen offset:3072
  buffer_load_dwordx4 a[96:99], v2, s[4:7], s22 offen offset:0
  buffer_load_dwordx4 a[100:103], v2, s[4:7], s22 offen offset:1024
  buffer_load_dwordx4 a[104:107], v2, s[4:7], s22 offen offset:2048
  buffer_load_dwordx4 a[108:111], v2, s[4:7], s22 offen offset:3072
  buffer_load_dwordx4 a[112:115], v3, s[4:7], s22 offen offset:0
  buffer_load_dwordx4 a[116:119], v3, s[4:7], s22 offen offset:1024
  s_cmp_ge_u32 s14, 20
  s_cbranch_scc1 reca_now24
  s_cmp_ge_u32 s12, 2
  s_cbranch_scc1 reca_now24
  s_lshl_b32 s34, s14, 1
  s_add_u32 s34, s34, s12
  s_mul_i32 s34, s34, 192
  s_mul_i32 s35, s13, 24
  s_add_u32 s34, s34, s35
  s_lshl_b32 s34, s34, 10
  s_add_u32 s34, s34, 29884416
  buffer_load_dwordx4 a[120:123], v1, s[4:7], s34 offen offset:0
  buffer_load_dwordx4 a[124:127], v1, s[4:7], s34 offen offset:1024
  buffer_load_dwordx4 a[128:131], v1, s[4:7], s34 offen offset:2048
  buffer_load_dwordx4 a[132:135], v1, s[4:7], s34 offen offset:3072
  buffer_load_dwordx4 a[136:139], v2, s[4:7], s34 offen offset:0
  buffer_load_dwordx4 a[140:143], v2, s[4:7], s34 offen offset:1024
  buffer_load_dwordx4 a[144:147], v2, s[4:7], s34 offen offset:2048
  buffer_load_dwordx4 a[148:151], v2, s[4:7], s34 offen offset:3072
  buffer_load_dwordx4 a[152:155], v3, s[4:7], s34 offen offset:0
  buffer_load_dwordx4 a[156:159], v3, s[4:7], s34 offen offset:1024
  buffer_load_dwordx4 a[160:163], v3, s[4:7], s34 offen offset:2048
  buffer_load_dwordx4 a[164:167], v3, s[4:7], s34 offen offset:3072
  s_add_u32 s34, s34, 12288
  buffer_load_dwordx4 a[168:171], v1, s[4:7], s34 offen offset:0
  buffer_load_dwordx4 a[172:175], v1, s[4:7], s34 offen offset:1024
  buffer_load_dwordx4 a[176:179], v1, s[4:7], s34 offen offset:2048
  buffer_load_dwordx4 a[180:183], v1, s[4:7], s34 offen offset:3072
  buffer_load_dwordx4 a[184:187], v2, s[4:7], s34 offen offset:0
  buffer_load_dwordx4 a[188:191], v2, s[4:7], s34 offen offset:1024
  buffer_load_dwordx4 a[192:195], v2, s[4:7], s34 offen offset:2048
  buffer_load_dwordx4 a[196:199], v2, s[4:7], s34 offen offset:3072
  buffer_load_dwordx4 a[200:203], v3, s[4:7], s34 offen offset:0
  buffer_load_dwordx4 a[204:207], v3, s[4:7], s34 offen offset:1024
  buffer_load_dwordx4 a[208:211], v3, s[4:7], s34 offen offset:2048
  buffer_load_dwordx4 a[212:215], v3, s[4:7], s34 offen offset:3072
reca_now24:
  v_and_b32 v29, 63, v0
  v_and_b32 v28, 15, v29
  v_lshrrev_b32 v30, 4, v29
  v_mov_b32 v32, -1
  v_mov_b32 v33, -1
  v_mov_b32 v34, -1
  v_mov_b32 v35, -1
  s_mul_i32 s34, s12, 2560
  v_add_u32 v4, s34, v1
  v_and_b32 v44, 31, v29
  v_lshlrev_b32 v44, 4, v44
  s_add_u32 s34, s34, 2048
  v_add_u32 v5, s34, v44
  v_and_b32 v44, 7, v29
  v_lshlrev_b32 v44, 4, v44
  v_lshl_add_u32 v44, v30, 7, v44
  s_mul_i32 s34, s19, 5120
  v_add_u32 v6, s34, v44
  s_sub_u32 s34, 5120, s34
  v_add_u32 v7, s34, v44
  v_lshrrev_b32 v45, 3, v28
  v_lshl_add_u32 v12, v45, 9, v44
  s_mul_i32 s34, s19, 5120
  v_add_u32 v236, s34, v12
  s_sub_u32 s34, 5120, s34
  v_add_u32 v237, s34, v12
  v_add_u32 v13, 0x1000, v12
  v_add_u32 v14, 0x2000, v12
  v_cmp_gt_u32 s[54:55], 8, v28
  s_lshl_b32 s34, s16, 10
  s_lshl_b32 s35, s19, 7
  s_add_u32 s34, s34, s35
  s_and_b32 s35, s12, 1
  s_lshl_b32 s36, s35, 3
  s_add_u32 s34, s34, s36
  v_lshlrev_b32 v44, 4, v28
  v_lshl_add_u32 v45, v30, 8, v44
  v_add_u32 v45, s34, v45
  v_cndmask_b32 v8, v31, v45, s[54:55]
  v_lshl_add_u32 v44, v30, 7, v44
  v_add_u32 v45, s36, v44
  v_cndmask_b32 v9, v31, v45, s[54:55]
  s_lshl_b32 s34, s14, 9
  v_add_u32 v45, s34, v44
  v_cndmask_b32 v11, v31, v45, s[54:55]
  s_mul_i32 s34, s13, 49152
  s_lshr_b32 s35, s14, 3
  s_lshl_b32 s35, s35, 14
  s_add_u32 s34, s34, s35
  s_and_b32 s35, s14, 7
  s_lshl_b32 s35, s35, 10
  s_add_u32 s34, s34, s35
  s_lshl_b32 s35, s12, 9
  s_add_u32 s34, s34, s35
  v_add_u32 v45, s34, v44
  v_cndmask_b32 v15, v31, v45, s[54:55]
  s_cmp_lt_u32 s14, 20
  s_cselect_b32 s34, 0, 0x80000000
  v_or_b32 v15, s34, v15
  v_lshlrev_b32 v45, 3, v29
  v_cmp_gt_u32 vcc, 32, v29
  s_nop 1
  v_cndmask_b32 v10, v31, v45, vcc
  s_sub_u32 s35, s14, 4
  s_cmp_lt_u32 s14, 20
  s_cselect_b32 s34, s14, s35
  s_lshr_b32 s35, s34, 3
  s_lshl_b32 s35, s35, 14
  s_and_b32 s34, s34, 7
  s_lshl_b32 s34, s34, 10
  s_add_u32 s34, s34, s35
  v_add_u32 v20, s34, v1
  v_add_u32 v21, 49152, v20
  v_add_u32 v22, 98304, v20
  v_add_u32 v23, 147456, v20
  v_add_u32 v24, 196608, v20
  v_add_u32 v25, 245760, v20
  v_add_u32 v26, 294912, v20
  v_add_u32 v27, 344064, v20
  v_lshrrev_b32 v44, 3, v29
  v_and_b32 v44, 3, v44
  v_lshlrev_b32 v44, 7, v44
  v_and_b32 v45, 7, v29
  v_lshl_add_u32 v44, v45, 4, v44
  v_lshrrev_b32 v45, 5, v29
  v_lshl_add_u32 v44, v45, 3, v44
  s_lshl_b32 s34, s14, 9
  s_cmp_lt_u32 s14, 20
  s_cselect_b32 s34, s34, 0x80000000
  v_add_u32 v16, s34, v44
  v_cmp_eq_u32 vcc, 0, v29
  v_mov_b32 v45, 0
  s_nop 0
  v_cndmask_b32 v19, v31, v45, vcc
  s_lshl_b32 s34, s15, 8
  s_add_u32 s34, s34, 1540096
  v_and_b32 v45, 1, v29
  v_lshlrev_b32 v45, 7, v45
  v_add_u32 v233, s34, v45
  s_lshl_b32 s34, s12, 10
  s_add_u32 s34, s34, 10240
  v_add_u32 v17, s34, v1
  v_mov_b32 v36, 0x3f803f80
  v_mov_b32 v37, 0x3f803f80
  v_mov_b32 v38, 0x3f803f80
  v_mov_b32 v39, 0x3f803f80
  v_mov_b32 v44, 0xf149f2ca
  v_cmp_gt_u32 vcc, 2, v30
  s_nop 1
  v_cndmask_b32 v40, 0, v44, vcc
  v_mov_b32 v41, v40
  v_mov_b32 v42, v40
  v_mov_b32 v43, v40
  v_and_b32 v44, 31, v29
  v_lshlrev_b32 v44, 4, v44
  v_add_u32 v45, 47972352, v44
  v_add_u32 v44, 47185920, v44
  v_cmp_gt_u32 vcc, 32, v29
  s_nop 1
  v_cndmask_b32 v238, v45, v44, vcc
  s_mov_b32 s41, 0x3dd53b95
  s_mul_i32 s38, s13, 40960
  s_add_u32 s38, s38, 0
  s_mul_i32 s39, s15, 24576
  s_add_u32 s39, s39, 327680
  s_mul_i32 s40, s13, 49152
  s_add_u32 s40, s40, 1114112
  s_mov_b32 s60, s52
  s_mov_b32 s61, s53
  s_mov_b32 s62, 10240
  s_mov_b32 s63, 0x20000
  v_and_b32 v29, 63, v0
  v_and_b32 v44, 7, v29
  v_mul_u32_u24 v44, 1280, v44
  v_lshrrev_b32 v45, 3, v29
  v_and_b32 v45, 3, v45
  v_lshl_add_u32 v44, v45, 4, v44
  s_mul_i32 s34, s12, 320
  v_add_u32 v44, s34, v44
  v_add_u32 v46, 256, v44
  v_lshrrev_b32 v45, 5, v29
  v_lshl_add_u32 v44, v45, 6, v44
  buffer_load_dwordx4 v[128:131], v44, s[60:63], 0 offen
  buffer_load_dwordx4 v[132:135], v44, s[60:63], 0 offen offset:128
  buffer_load_dwordx4 v[136:139], v46, s[60:63], 0 offen
  v_and_b32 v44, 63, v0
  v_and_b32 v45, 3, v44
  v_lshlrev_b32 v45, 21, v45
  v_min_u32 v45, 786368, v45
  v_add_u32 v46, 47185920, v45
  v_add_u32 v45, 47972352, v45
  v_cmp_gt_u32 vcc, 4, v44
  s_nop 1
  v_cndmask_b32 v46, v45, v46, vcc
  s_mul_i32 s34, s15, 98304
  v_and_b32 v45, 1, v44
  v_mul_u32_u24 v45, 98240, v45
  v_add_u32 v45, s34, v45
  v_add_u32 v28, 37748736, v45
  v_add_u32 v45, 40894464, v45
  v_cmp_gt_u32 vcc, 10, v44
  s_nop 1
  v_cndmask_b32 v45, v45, v28, vcc
  v_cmp_gt_u32 vcc, 8, v44
  s_nop 1
  v_cndmask_b32 v46, v45, v46, vcc
  v_cmp_gt_u32 vcc, 12, v44
  s_nop 1
  v_cndmask_b32 v46, v31, v46, vcc
  buffer_load_dword v234, v46, s[4:7], 0 offen
  v_and_b32 v44, 63, v0
  v_lshlrev_b32 v45, 21, v44
  v_min_u32 v45, 25165760, v45
  v_add_u32 v45, 57147392, v45
  s_lshl_b32 s34, s13, 2
  s_add_u32 s34, s34, s14
  s_sub_u32 s34, s34, 20
  s_and_b32 s34, s34, 31
  s_mul_i32 s34, s34, 98304
  s_add_u32 s34, s34, 44040192
  v_and_b32 v46, 1, v44
  v_mul_u32_u24 v46, 98240, v46
  v_add_u32 v46, s34, v46
  v_cmp_gt_u32 vcc, 13, v44
  s_nop 1
  v_cndmask_b32 v46, v46, v45, vcc
  v_cmp_gt_u32 vcc, 15, v44
  s_nop 1
  v_cndmask_b32 v46, v31, v46, vcc
  buffer_load_dword v235, v46, s[4:7], 0 offen
  v_and_b32 v30, 7, v0
  v_lshlrev_b32 v30, 3, v30
reca_cens5:
  buffer_load_dwordx2 v[28:29], v30, s[8:11], 0 offen sc1
  s_waitcnt vmcnt(0)
  v_sad_u8 v31, v28, 0, 0
  v_sad_u8 v31, v29, 0, v31
  v_cmp_gt_u32 vcc, 32, v31
  s_cbranch_vccz reca_censok6
  s_sleep 8
  s_sub_u32 s18, s18, 1
  s_cbranch_scc0 reca_cens5
  s_mov_b32 s18, 0
reca_censok6:
  v_and_b32 v28, 0x20202020, v28
  v_and_b32 v29, 0x20202020, v29
  v_cmp_ne_u32 s[34:35], 0, v28
  v_cmp_ne_u32 s[36:37], 0, v29
  s_nop 3
  s_and_b32 s34, s34, 0xff
  s_and_b32 s36, s36, 0xff
  s_or_b32 s35, s34, s36
  s_lshr_b32 s37, s35, s13
  s_and_b32 s37, s37, 1
  s_xor_b32 s43, s37, 1
  s_cmp_eq_u32 s57, 0
  s_cselect_b32 s58, s36, s34
  v_mov_b32 v31, 0x80000000
  v_add_u32 v232, 0x2000, v15
  s_lshr_b32 s44, s2, 4
  s_lshl_b32 s44, s44, 14
  s_and_b32 s34, s2, 15
  s_lshl_b32 s34, s34, 9
  s_add_u32 s44, s44, s34
  s_add_u32 s44, s44, 1572864
  s_add_u32 s44, s44, s56
  s_mov_b32 s45, -1
  s_mov_b32 s47, -1
  s_cmp_lg_u32 s12, 2
  s_cbranch_scc1 reca_noprobe7
  s_add_u32 s35, s44, 0
  s_memtime s[60:61]
  s_waitcnt lgkmcnt(0)
  buffer_load_dword v28, v19, s[4:7], s35 offen sc1
  s_waitcnt vmcnt(0)
  s_memtime s[62:63]
  s_waitcnt lgkmcnt(0)
  s_sub_u32 s36, s62, s60
  s_min_u32 s45, s45, s36
  s_add_u32 s35, s44, 8192
  s_memtime s[60:61]
  s_waitcnt lgkmcnt(0)
  buffer_load_dword v28, v19, s[4:7], s35 offen sc1
  s_waitcnt vmcnt(0)
  s_memtime s[62:63]
  s_waitcnt lgkmcnt(0)
  s_sub_u32 s36, s62, s60
  s_min_u32 s47, s47, s36
  s_add_u32 s35, s44, 128
  s_memtime s[60:61]
  s_waitcnt lgkmcnt(0)
  buffer_load_dword v28, v19, s[4:7], s35 offen sc1
  s_waitcnt vmcnt(0)
  s_memtime s[62:63]
  s_waitcnt lgkmcnt(0)
  s_sub_u32 s36, s62, s60
  s_min_u32 s45, s45, s36
  s_add_u32 s35, s44, 8320
  s_memtime s[60:61]
  s_waitcnt lgkmcnt(0)
  buffer_load_dword v28, v19, s[4:7], s35 offen sc1
  s_waitcnt vmcnt(0)
  s_memtime s[62:63]
  s_waitcnt lgkmcnt(0)
  s_sub_u32 s36, s62, s60
  s_min_u32 s47, s47, s36
  s_add_u32 s35, s44, 256
  s_memtime s[60:61]
  s_waitcnt lgkmcnt(0)
  buffer_load_dword v28, v19, s[4:7], s35 offen sc1
  s_waitcnt vmcnt(0)
  s_memtime s[62:63]
  s_waitcnt lgkmcnt(0)
  s_sub_u32 s36, s62, s60
  s_min_u32 s45, s45, s36
  s_add_u32 s35, s44, 8448
  s_memtime s[60:61]
  s_waitcnt lgkmcnt(0)
  buffer_load_dword v28, v19, s[4:7], s35 offen sc1
  s_waitcnt vmcnt(0)
  s_memtime s[62:63]
  s_waitcnt lgkmcnt(0)
  s_sub_u32 s36, s62, s60
  s_min_u32 s47, s47, s36
  s_cmp_lt_u32 s47, s45
  s_cbranch_scc0 reca_noprobe7
  v_add_u32 v20, 0x2000, v20
  v_add_u32 v21, 0x2000, v21
  v_add_u32 v22, 0x2000, v22
  v_add_u32 v23, 0x2000, v23
  v_add_u32 v24, 0x2000, v24
  v_add_u32 v25, 0x2000, v25
  v_add_u32 v26, 0x2000, v26
  v_add_u32 v27, 0x2000, v27
reca_noprobe7:
  s_lshl_b32 s59, s13, 2
  s_add_u32 s59, s59, s14
  s_sub_u32 s59, s59, 20
  v_and_b32 v29, 63, v0
  v_and_b32 v28, 15, v29
  v_lshrrev_b32 v30, 4, v29
  v_lshlrev_b32 v92, 4, v28
  v_lshl_add_u32 v92, v30, 7, v92
  v_cmp_gt_u32 vcc, 8, v28
  s_nop 1
  v_cndmask_b32 v92, v31, v92, vcc
  v_lshlrev_b32 v93, 3, v29
  v_cmp_gt_u32 vcc, 32, v29
  s_nop 1
  v_cndmask_b32 v93, v31, v93, vcc
  v_mov_b32 v82, 0xf149f2ca
  v_cmp_le_u32 vcc, 2, v30
  s_nop 1
  v_cndmask_b32 v84, 0, v82, vcc
  v_mov_b32 v85, v84
  v_mov_b32 v86, v84
  v_mov_b32 v87, v84
  v_lshlrev_b32 v30, 2, v30
  v_add_u32 v29, 0, v30
  v_cmp_gt_u32 vcc, v29, v28
  s_nop 1
  v_cndmask_b32 v88, 0, v82, vcc
  v_add_u32 v29, 1, v30
  v_cmp_gt_u32 vcc, v29, v28
  s_nop 1
  v_cndmask_b32 v89, 0, v82, vcc
  v_add_u32 v29, 2, v30
  v_cmp_gt_u32 vcc, v29, v28
  s_nop 1
  v_cndmask_b32 v90, 0, v82, vcc
  v_add_u32 v29, 3, v30
  v_cmp_gt_u32 vcc, v29, v28
  s_nop 1
  v_cndmask_b32 v91, 0, v82, vcc
  s_mov_b32 s17, 0
  s_cmp_lg_u32 s12, 3
  s_cbranch_scc1 reca_nopf08
  s_add_u32 s37, s17, 1
reca_pf9:
  buffer_load_dword v28, v233, s[4:7], 0 offen sc1
  s_waitcnt vmcnt(0)
  v_cmp_gt_i32 vcc, s37, v28
  s_cbranch_vccz reca_pfok10
  s_sleep 1
  s_sub_u32 s18, s18, 1
  s_cbranch_scc0 reca_pf9
  s_mov_b32 s18, 0
reca_pfok10:
  s_lshl_b32 s34, s15, 3
  s_and_b32 s35, s17, 7
  s_add_u32 s34, s34, s35
  s_mul_i32 s34, s34, 12288
  s_add_u32 s32, s34, 37748736
  s_lshl_b32 s35, s16, 11
  s_add_u32 s34, s34, s35
  s_add_u32 s33, s34, 40894464
  buffer_load_dwordx4 a[120:123], v1, s[4:7], s32 offen offset:0 sc1
  buffer_load_dwordx4 a[124:127], v1, s[4:7], s32 offen offset:1024 sc1
  buffer_load_dwordx4 a[128:131], v1, s[4:7], s32 offen offset:2048 sc1
  buffer_load_dwordx4 a[132:135], v1, s[4:7], s32 offen offset:3072 sc1
  buffer_load_dwordx4 a[136:139], v2, s[4:7], s32 offen offset:0 sc1
  buffer_load_dwordx4 a[140:143], v2, s[4:7], s32 offen offset:1024 sc1
  buffer_load_dwordx4 a[144:147], v2, s[4:7], s32 offen offset:2048 sc1
  buffer_load_dwordx4 a[148:151], v2, s[4:7], s32 offen offset:3072 sc1
  buffer_load_dwordx4 a[152:155], v3, s[4:7], s32 offen offset:0 sc1
  buffer_load_dwordx4 a[156:159], v3, s[4:7], s32 offen offset:1024 sc1
  buffer_load_dwordx4 a[160:163], v3, s[4:7], s32 offen offset:2048 sc1
  buffer_load_dwordx4 a[164:167], v3, s[4:7], s32 offen offset:3072 sc1
  buffer_load_dwordx4 a[168:171], v1, s[4:7], s33 offen offset:0 sc1
  buffer_load_dwordx4 a[172:175], v1, s[4:7], s33 offen offset:1024 sc1
  s_waitcnt vmcnt(0)
reca_nopf08:
  s_cmp_lg_u32 s43, 0
  s_cbranch_scc1 reca_slow11
  s_cmp_ge_u32 s14, 20
  s_cbranch_scc1 reca_twinf12
  s_branch reca_gotmem15
reca_step14:
  s_and_b32 s34, s17, 3
  s_mul_i32 s20, s34, 10240
  s_add_u32 s20, s20, s38
  s_sleep 2
  buffer_load_dwordx4 v[128:131], v4, s[4:7], s20 offen sc1
  buffer_load_dwordx4 v[132:135], v4, s[4:7], s20 offen offset:1024 sc1
  buffer_load_dwordx4 v[136:139], v5, s[4:7], s20 offen sc1
  s_waitcnt vmcnt(2)
  v_max_u32 v29, v128, v130
  v_cmp_eq_u32 vcc, -1, v29
  s_cbranch_vccnz reca_retry17
reca_resume18:
  s_waitcnt vmcnt(1)
  v_max_u32 v29, v132, v134
  v_cmp_eq_u32 vcc, -1, v29
  ds_write_b128 v4, v[128:131]
  s_cbranch_vccnz reca_retry19
reca_resume20:
  s_waitcnt vmcnt(0)
  v_max_u32 v29, v136, v138
  v_cmp_eq_u32 vcc, -1, v29
  ds_write_b128 v4, v[132:135] offset:1024
  s_cbranch_vccnz reca_retry21
reca_resume22:
  ds_write_b128 v5, v[136:139]
  s_branch reca_gotmem216
reca_gotmem15:
  ds_write_b128 v4, v[128:131]
  ds_write_b128 v4, v[132:135] offset:1024
  ds_write_b128 v5, v[136:139]
reca_gotmem216:
  s_and_b32 s34, s17, 3
  s_mul_i32 s21, s34, 6144
  s_add_u32 s21, s21, s39
  s_mul_i32 s22, s34, 12288
  s_add_u32 s22, s22, s40
  s_mul_i32 s25, s34, 393216
  s_add_u32 s25, s25, s56
  s_add_u32 s35, s17, 1
  s_and_b32 s35, s35, 3
  s_mul_i32 s24, s35, 10240
  s_add_u32 s24, s24, s38
  s_waitcnt lgkmcnt(0)
  s_barrier
  ds_read_b128 v[128:131], v236 offset:0
  ds_read_b128 v[132:135], v236 offset:1024
  ds_read_b128 v[136:139], v236 offset:2048
  ds_read_b128 v[140:143], v236 offset:3072
  ds_read_b128 v[144:147], v236 offset:4096
  ds_read_b128 v[148:151], v237 offset:0
  ds_read_b128 v[152:155], v237 offset:1024
  ds_read_b128 v[156:159], v237 offset:2048
  ds_read_b128 v[160:163], v237 offset:3072
  ds_read_b128 v[164:167], v237 offset:4096
  s_waitcnt lgkmcnt(9)
  v_mfma_f32_16x16x32_bf16 v[44:47], a[0:3], v[128:131], 0
  ds_read_b128 v[168:171], v6 offset:0
  v_mfma_f32_16x16x32_bf16 v[240:243], a[4:7], v[128:131], 0
  s_waitcnt lgkmcnt(9)
  v_mfma_f32_16x16x32_bf16 v[44:47], a[8:11], v[132:135], v[44:47]
  ds_read_b128 v[172:175], v6 offset:512
  v_mfma_f32_16x16x32_bf16 v[240:243], a[12:15], v[132:135], v[240:243]
  s_waitcnt lgkmcnt(9)
  v_mfma_f32_16x16x32_bf16 v[44:47], a[16:19], v[136:139], v[44:47]
  ds_read_b128 v[176:179], v6 offset:1024
  v_mfma_f32_16x16x32_bf16 v[240:243], a[20:23], v[136:139], v[240:243]
  s_waitcnt lgkmcnt(9)
  v_mfma_f32_16x16x32_bf16 v[44:47], a[24:27], v[140:143], v[44:47]
  ds_read_b128 v[180:183], v6 offset:1536
  v_mfma_f32_16x16x32_bf16 v[240:243], a[28:31], v[140:143], v[240:243]
  s_waitcnt lgkmcnt(9)
  v_mfma_f32_16x16x32_bf16 v[44:47], a[32:35], v[144:147], v[44:47]
  ds_read_b128 v[184:187], v6 offset:2048
  v_mfma_f32_16x16x32_bf16 v[240:243], a[36:39], v[144:147], v[240:243]
  s_waitcnt lgkmcnt(9)
  v_mfma_f32_16x16x32_bf16 v[44:47], a[40:43], v[148:151], v[44:47]
  ds_read_b128 v[188:191], v6 offset:2560
  v_mfma_f32_16x16x32_bf16 v[240:243], a[44:47], v[148:151], v[240:243]
  s_waitcnt lgkmcnt(9)
  v_mfma_f32_16x16x32_bf16 v[44:47], a[48:51], v[152:155], v[44:47]
  ds_read_b128 v[192:195], v6 offset:3072
  v_mfma_f32_16x16x32_bf16 v[240:243], a[52:55], v[152:155], v[240:243]
  s_waitcnt lgkmcnt(9)
  v_mfma_f32_16x16x32_bf16 v[44:47], a[56:59], v[156:159], v[44:47]
  ds_read_b128 v[196:199], v6 offset:3584
  v_mfma_f32_16x16x32_bf16 v[240:243], a[60:63], v[156:159], v[240:243]
  s_waitcnt lgkmcnt(9)
  v_mfma_f32_16x16x32_bf16 v[44:47], a[64:67], v[160:163], v[44:47]
  ds_read_b128 v[200:203], v6 offset:4096
  v_mfma_f32_16x16x32_bf16 v[240:243], a[68:71], v[160:163], v[240:243]
  s_waitcnt lgkmcnt(9)
  v_mfma_f32_16x16x32_bf16 v[44:47], a[72:75], v[164:167], v[44:47]
  ds_read_b128 v[204:207], v6 offset:4608
  v_mfma_f32_16x16x32_bf16 v[240:243], a[76:79], v[164:167], v[240:243]
  s_waitcnt lgkmcnt(9)
  v_mfma_f32_16x16x32_bf16 v[48:51], v[168:171], a[80:83], 0
  s_and_b32 s34, s17, 7
  s_lshl_b32 s34, s34, 5
  s_add_u32 s34, s34, s15
  s_mul_i32 s34, s34, 3072
  s_lshl_b32 s35, s16, 9
  s_add_u32 s34, s34, s35
  s_add_u32 s30, s34, 47185920
  s_add_u32 s31, s34, 47972352
  v_add_f32_dpp v44, v240, v44 row_ror:8 row_mask:0xf bank_mask:0xf
  v_add_f32_dpp v45, v241, v45 row_ror:8 row_mask:0xf bank_mask:0xf
  v_add_f32_dpp v46, v242, v46 row_ror:8 row_mask:0xf bank_mask:0xf
  v_add_f32_dpp v47, v243, v47 row_ror:8 row_mask:0xf bank_mask:0xf
  v_cvt_pk_bf16_f32 v52, v44, v45
  v_cvt_pk_bf16_f32 v53, v46, v47
  buffer_store_dwordx2 v[52:53], v8, s[4:7], s21 offen
  s_waitcnt lgkmcnt(8)
  v_mfma_f32_16x16x32_bf16 v[48:51], v[172:175], a[84:87], v[48:51]
  s_waitcnt lgkmcnt(7)
  v_mfma_f32_16x16x32_bf16 v[48:51], v[176:179], a[88:91], v[48:51]
  s_waitcnt lgkmcnt(6)
  v_mfma_f32_16x16x32_bf16 v[48:51], v[180:183], a[92:95], v[48:51]
  s_waitcnt lgkmcnt(5)
  v_mfma_f32_16x16x32_bf16 v[48:51], v[184:187], a[96:99], v[48:51]
  s_waitcnt lgkmcnt(4)
  v_mfma_f32_16x16x32_bf16 v[48:51], v[188:191], a[100:103], v[48:51]
  s_waitcnt lgkmcnt(3)
  v_mfma_f32_16x16x32_bf16 v[48:51], v[192:195], a[104:107], v[48:51]
  s_waitcnt lgkmcnt(2)
  v_mfma_f32_16x16x32_bf16 v[48:51], v[196:199], a[108:111], v[48:51]
  s_waitcnt lgkmcnt(1)
  v_mfma_f32_16x16x32_bf16 v[48:51], v[200:203], a[112:115], v[48:51]
  s_waitcnt lgkmcnt(0)
  v_mfma_f32_16x16x32_bf16 v[48:51], v[204:207], a[116:119], v[48:51]
  s_cmp_eq_u32 s12, 3
  s_cbranch_scc1 reca_swave23
  s_nop 5
  ds_write_b128 v17, v[48:51]
  s_add_u32 s34, s17, 2
  s_and_b32 s34, s34, 3
  s_mul_i32 s26, s34, 10240
  s_add_u32 s26, s26, s38
  s_mul_i32 s27, s34, 6144
  s_add_u32 s27, s27, s39
  s_mul_i32 s28, s34, 12288
  s_add_u32 s28, s28, s40
  s_mul_i32 s29, s34, 393216
  s_add_u32 s29, s29, s56
  s_waitcnt lgkmcnt(0)
  s_barrier
  s_cmp_eq_u32 s17, 63
  s_cbranch_scc1 reca_last25
  buffer_store_dwordx2 v[32:33], v8, s[4:7], s27 offen
  s_cmp_lg_u32 s12, 2
  s_cbranch_scc1 reca_b326
  buffer_store_dwordx2 v[52:53], v9, s[4:7], s30 offen
  buffer_store_dwordx2 v[32:33], v16, s[4:7], s26 offen
  s_cmp_lg_u32 s14, 0
  s_cbranch_scc1 reca_b326
  v_mov_b32 v28, s17
  s_lshl_b32 s34, s13, 7
  s_add_u32 s34, s34, 1507328
  buffer_store_dword v28, v19, s[4:7], s34 offen
  s_branch reca_b326
reca_last25:
  s_cmp_lg_u32 s12, 2
  s_cbranch_scc1 reca_exit1
  buffer_store_dwordx2 v[52:53], v9, s[4:7], s30 offen
  s_branch reca_exit1
reca_swave23:
  s_cmp_lg_u32 s17, 63
  s_cbranch_scc1 reca_vmst29
  s_barrier
  ds_read_b128 v[56:59], v1 offset:10240
  ds_read_b128 v[60:63], v1 offset:11264
  ds_read_b128 v[64:67], v1 offset:12288
  s_waitcnt lgkmcnt(0)
  v_add_f32 v56, v56, v64
  v_add_f32 v60, v60, v48
  v_add_f32 v57, v57, v65
  v_add_f32 v61, v61, v49
  v_add_f32 v58, v58, v66
  v_add_f32 v62, v62, v50
  v_add_f32 v59, v59, v67
  v_add_f32 v63, v63, v51
  v_cvt_pk_bf16_f32 v68, v56, v57
  v_cvt_pk_bf16_f32 v69, v58, v59
  v_cvt_pk_bf16_f32 v70, v60, v61
  v_cvt_pk_bf16_f32 v71, v62, v63
  buffer_store_dwordx2 v[52:53], v9, s[4:7], s30 offen
  buffer_store_dwordx2 v[68:69], v10, s[4:7], s31 offen
  buffer_store_dwordx2 v[70:71], v10, s[4:7], s31 offen offset:256
  s_branch reca_exit1
reca_vmst29:
  s_sleep 1
  buffer_load_dwordx4 v[208:211], v1, s[4:7], s21 offen offset:0 sc1
  buffer_load_dwordx4 v[212:215], v1, s[4:7], s21 offen offset:1024 sc1
  buffer_load_dwordx4 v[216:219], v1, s[4:7], s21 offen offset:2048 sc1
  buffer_load_dwordx4 v[220:223], v1, s[4:7], s21 offen offset:3072 sc1
  buffer_load_dwordx4 v[224:227], v2, s[4:7], s21 offen offset:0 sc1
  buffer_load_dwordx4 v[228:231], v2, s[4:7], s21 offen offset:1024 sc1
  s_waitcnt vmcnt(5)
  v_max_u32 v29, v208, v210
  v_cmp_eq_u32 vcc, -1, v29
  s_cbranch_vccnz reca_retry30
reca_resume31:
  s_waitcnt vmcnt(4)
  v_max_u32 v29, v212, v214
  v_cmp_eq_u32 vcc, -1, v29
  v_mfma_f32_16x16x32_bf16 v[76:79], a[120:123], v[208:211], 0
  v_mfma_f32_16x16x32_bf16 v[80:83], a[144:147], v[208:211], 0
  v_mfma_f32_16x16x32_bf16 v[72:75], v[208:211], v[208:211], v[40:43]
  s_cbranch_vccnz reca_retry32
reca_resume33:
  s_waitcnt vmcnt(3)
  v_max_u32 v29, v216, v218
  v_cmp_eq_u32 vcc, -1, v29
  v_mfma_f32_16x16x32_bf16 v[76:79], a[124:127], v[212:215], v[76:79]
  v_mfma_f32_16x16x32_bf16 v[80:83], a[148:151], v[212:215], v[80:83]
  v_mfma_f32_16x16x32_bf16 v[72:75], v[212:215], v[212:215], v[72:75]
  s_cbranch_vccnz reca_retry34
reca_resume35:
  s_waitcnt vmcnt(2)
  v_max_u32 v29, v220, v222
  v_cmp_eq_u32 vcc, -1, v29
  v_mfma_f32_16x16x32_bf16 v[76:79], a[128:131], v[216:219], v[76:79]
  v_mfma_f32_16x16x32_bf16 v[80:83], a[152:155], v[216:219], v[80:83]
  v_mfma_f32_16x16x32_bf16 v[72:75], v[216:219], v[216:219], v[72:75]
  s_cbranch_vccnz reca_retry36
reca_resume37:
  s_waitcnt vmcnt(1)
  v_max_u32 v29, v224, v226
  v_cmp_eq_u32 vcc, -1, v29
  v_mfma_f32_16x16x32_bf16 v[76:79], a[132:135], v[220:223], v[76:79]
  v_mfma_f32_16x16x32_bf16 v[80:83], a[156:159], v[220:223], v[80:83]
  v_mfma_f32_16x16x32_bf16 v[72:75], v[220:223], v[220:223], v[72:75]
  s_cbranch_vccnz reca_retry38
reca_resume39:
  s_waitcnt vmcnt(0)
  v_max_u32 v29, v228, v230
  v_cmp_eq_u32 vcc, -1, v29
  v_mfma_f32_16x16x32_bf16 v[76:79], a[136:139], v[224:227], v[76:79]
  v_mfma_f32_16x16x32_bf16 v[80:83], a[160:163], v[224:227], v[80:83]
  v_mfma_f32_16x16x32_bf16 v[72:75], v[224:227], v[224:227], v[72:75]
  s_cbranch_vccnz reca_retry40
reca_resume41:
  v_mfma_f32_16x16x32_bf16 v[76:79], a[140:143], v[228:231], v[76:79]
  v_mfma_f32_16x16x32_bf16 v[80:83], a[164:167], v[228:231], v[80:83]
  v_mfma_f32_16x16x32_bf16 v[72:75], v[228:231], v[228:231], v[72:75]
  s_barrier
  ds_read_b128 v[56:59], v1 offset:10240
  ds_read_b128 v[60:63], v1 offset:11264
  ds_read_b128 v[64:67], v1 offset:12288
  s_nop 1
  v_max3_f32 v28, v76, v77, v78
  v_max3_f32 v29, v80, v81, v82
  v_max3_f32 v28, v28, v79, v83
  v_max3_f32 v29, v29, v72, v73
  v_max3_f32 v28, v28, v74, v75
  v_max_f32 v28, v28, v29
  v_mov_b32 v29, v28
  s_nop 1
  v_permlane32_swap_b32 v28, v29
  v_max_f32 v28, v28, v29
  v_mov_b32 v29, v28
  s_nop 1
  v_permlane16_swap_b32 v28, v29
  v_max_f32 v28, v28, v29
  v_mul_f32 v28, s41, v28
  v_fma_f32 v76, v76, s41, -v28
  v_fma_f32 v77, v77, s41, -v28
  v_fma_f32 v78, v78, s41, -v28
  v_fma_f32 v79, v79, s41, -v28
  v_fma_f32 v80, v80, s41, -v28
  v_fma_f32 v81, v81, s41, -v28
  v_fma_f32 v82, v82, s41, -v28
  v_fma_f32 v83, v83, s41, -v28
  v_fma_f32 v72, v72, s41, -v28
  v_fma_f32 v73, v73, s41, -v28
  v_fma_f32 v74, v74, s41, -v28
  v_fma_f32 v75, v75, s41, -v28
  v_exp_f32 v76, v76
  v_exp_f32 v77, v77
  v_exp_f32 v78, v78
  v_exp_f32 v79, v79
  v_exp_f32 v80, v80
  v_exp_f32 v81, v81
  v_exp_f32 v82, v82
  v_exp_f32 v83, v83
  v_cvt_pk_bf16_f32 v84, v76, v77
  v_cvt_pk_bf16_f32 v85, v78, v79
  v_cvt_pk_bf16_f32 v86, v80, v81
  v_cvt_pk_bf16_f32 v87, v82, v83
  v_exp_f32 v72, v72
  v_exp_f32 v73, v73
  v_mfma_f32_16x16x32_bf16 v[100:103], v[36:39], v[84:87], 0
  v_exp_f32 v74, v74
  v_exp_f32 v75, v75
  v_mfma_f32_16x16x32_bf16 v[92:95], a[168:171], v[84:87], 0
  v_cvt_pk_bf16_f32 v88, v72, v73
  v_cvt_pk_bf16_f32 v89, v74, v75
  v_mfma_f32_16x16x32_bf16 v[96:99], a[172:175], v[84:87], 0
  s_waitcnt lgkmcnt(0)
  v_mfma_f32_16x16x16_bf16 v[100:103], v[36:37], v[88:89], v[100:103]
  v_add_f32 v56, v56, v64
  v_add_f32 v60, v60, v48
  v_add_f32 v57, v57, v65
  v_add_f32 v61, v61, v49
  v_add_f32 v58, v58, v66
  v_add_f32 v62, v62, v50
  v_add_f32 v59, v59, v67
  v_add_f32 v63, v63, v51
  v_cvt_pk_bf16_f32 v68, v56, v57
  v_cvt_pk_bf16_f32 v69, v58, v59
  v_cvt_pk_bf16_f32 v70, v60, v61
  v_cvt_pk_bf16_f32 v71, v62, v63
  v_mfma_f32_16x16x16_bf16 v[92:95], v[68:69], v[88:89], v[92:95]
  v_rcp_f32 v28, v100
  v_mfma_f32_16x16x16_bf16 v[96:99], v[70:71], v[88:89], v[96:99]
  v_mov_b32 v29, v28
  s_nop 4
  v_pk_mul_f32 v[92:93], v[92:93], v[28:29]
  v_pk_mul_f32 v[94:95], v[94:95], v[28:29]
  v_pk_mul_f32 v[96:97], v[96:97], v[28:29]
  v_pk_mul_f32 v[98:99], v[98:99], v[28:29]
  v_cvt_pk_bf16_f32 v104, v92, v93
  v_cvt_pk_bf16_f32 v105, v94, v95
  v_cvt_pk_bf16_f32 v106, v96, v97
  v_cvt_pk_bf16_f32 v107, v98, v99
  buffer_store_dwordx4 v[104:107], v11, s[4:7], s22 offen
reca_b326:
  s_barrier
  s_cmp_ge_u32 s12, 2
  s_cbranch_scc1 reca_notg242
  s_sleep 3
  buffer_load_dwordx4 v[128:131], v12, s[4:7], s22 offen offset:0 sc1
  buffer_load_dwordx4 v[132:135], v12, s[4:7], s22 offen offset:1024 sc1
  buffer_load_dwordx4 v[136:139], v12, s[4:7], s22 offen offset:2048 sc1
  buffer_load_dwordx4 v[140:143], v12, s[4:7], s22 offen offset:3072 sc1
  buffer_load_dwordx4 v[144:147], v13, s[4:7], s22 offen offset:0 sc1
  buffer_load_dwordx4 v[148:151], v13, s[4:7], s22 offen offset:1024 sc1
  buffer_load_dwordx4 v[152:155], v13, s[4:7], s22 offen offset:2048 sc1
  buffer_load_dwordx4 v[156:159], v13, s[4:7], s22 offen offset:3072 sc1
  buffer_load_dwordx4 v[160:163], v14, s[4:7], s22 offen offset:0 sc1
  buffer_load_dwordx4 v[164:167], v14, s[4:7], s22 offen offset:1024 sc1
  buffer_load_dwordx4 v[168:171], v14, s[4:7], s22 offen offset:2048 sc1
  buffer_load_dwordx4 v[172:175], v14, s[4:7], s22 offen offset:3072 sc1
  s_waitcnt vmcnt(11)
  v_cmp_eq_u32 vcc, -1, v128
  s_cbranch_vccnz reca_retry43
reca_resume44:
  s_waitcnt vmcnt(10)
  v_cmp_eq_u32 vcc, -1, v132
  v_mfma_f32_16x16x32_bf16 v[108:111], a[120:123], v[128:131], 0
  v_mfma_f32_16x16x32_bf16 v[112:115], a[124:127], v[128:131], 0
  s_cbranch_vccnz reca_retry45
reca_resume46:
  s_waitcnt vmcnt(9)
  v_cmp_eq_u32 vcc, -1, v136
  v_mfma_f32_16x16x32_bf16 v[108:111], a[128:131], v[132:135], v[108:111]
  v_mfma_f32_16x16x32_bf16 v[112:115], a[132:135], v[132:135], v[112:115]
  s_cbranch_vccnz reca_retry47
reca_resume48:
  s_waitcnt vmcnt(8)
  v_cmp_eq_u32 vcc, -1, v140
  v_mfma_f32_16x16x32_bf16 v[108:111], a[136:139], v[136:139], v[108:111]
  v_mfma_f32_16x16x32_bf16 v[112:115], a[140:143], v[136:139], v[112:115]
  s_cbranch_vccnz reca_retry49
reca_resume50:
  s_waitcnt vmcnt(7)
  v_cmp_eq_u32 vcc, -1, v144
  v_mfma_f32_16x16x32_bf16 v[108:111], a[144:147], v[140:143], v[108:111]
  v_mfma_f32_16x16x32_bf16 v[112:115], a[148:151], v[140:143], v[112:115]
  s_cbranch_vccnz reca_retry51
reca_resume52:
  s_waitcnt vmcnt(6)
  v_cmp_eq_u32 vcc, -1, v148
  v_mfma_f32_16x16x32_bf16 v[108:111], a[152:155], v[144:147], v[108:111]
  v_mfma_f32_16x16x32_bf16 v[112:115], a[156:159], v[144:147], v[112:115]
  s_cbranch_vccnz reca_retry53
reca_resume54:
  s_waitcnt vmcnt(5)
  v_cmp_eq_u32 vcc, -1, v152
  v_mfma_f32_16x16x32_bf16 v[108:111], a[160:163], v[148:151], v[108:111]
  v_mfma_f32_16x16x32_bf16 v[112:115], a[164:167], v[148:151], v[112:115]
  s_cbranch_vccnz reca_retry55
reca_resume56:
  s_waitcnt vmcnt(4)
  v_cmp_eq_u32 vcc, -1, v156
  v_mfma_f32_16x16x32_bf16 v[108:111], a[168:171], v[152:155], v[108:111]
  v_mfma_f32_16x16x32_bf16 v[112:115], a[172:175], v[152:155], v[112:115]
  s_cbranch_vccnz reca_retry57
reca_resume58:
  s_waitcnt vmcnt(3)
  v_cmp_eq_u32 vcc, -1, v160
  v_mfma_f32_16x16x32_bf16 v[108:111], a[176:179], v[156:159], v[108:111]
  v_mfma_f32_16x16x32_bf16 v[112:115], a[180:183], v[156:159], v[112:115]
  s_cbranch_vccnz reca_retry59
reca_resume60:
  s_waitcnt vmcnt(2)
  v_cmp_eq_u32 vcc, -1, v164
  v_mfma_f32_16x16x32_bf16 v[108:111], a[184:187], v[160:163], v[108:111]
  v_mfma_f32_16x16x32_bf16 v[112:115], a[188:191], v[160:163], v[112:115]
  s_cbranch_vccnz reca_retry61
reca_resume62:
  s_waitcnt vmcnt(1)
  v_cmp_eq_u32 vcc, -1, v168
  v_mfma_f32_16x16x32_bf16 v[108:111], a[192:195], v[164:167], v[108:111]
  v_mfma_f32_16x16x32_bf16 v[112:115], a[196:199], v[164:167], v[112:115]
  s_cbranch_vccnz reca_retry63
reca_resume64:
  s_waitcnt vmcnt(0)
  v_cmp_eq_u32 vcc, -1, v172
  v_mfma_f32_16x16x32_bf16 v[108:111], a[200:203], v[168:171], v[108:111]
  v_mfma_f32_16x16x32_bf16 v[112:115], a[204:207], v[168:171], v[112:115]
  s_cbranch_vccnz reca_retry65
reca_resume66:
  v_mfma_f32_16x16x32_bf16 v[108:111], a[208:211], v[172:175], v[108:111]
  v_mfma_f32_16x16x32_bf16 v[112:115], a[212:215], v[172:175], v[112:115]
  s_nop 7
  v_add_f32_dpp v116, v112, v108 row_ror:8 row_mask:0xf bank_mask:0xf
  v_add_f32_dpp v117, v113, v109 row_ror:8 row_mask:0xf bank_mask:0xf
  v_add_f32_dpp v118, v114, v110 row_ror:8 row_mask:0xf bank_mask:0xf
  v_add_f32_dpp v119, v115, v111 row_ror:8 row_mask:0xf bank_mask:0xf
  buffer_store_dwordx4 v[116:119], v15, s[4:7], s25 offen sc1
  buffer_store_dwordx4 v[116:119], v232, s[4:7], s25 offen sc1
  buffer_store_dwordx4 v[32:35], v15, s[4:7], s29 offen sc1
  buffer_store_dwordx4 v[32:35], v232, s[4:7], s29 offen sc1
  s_branch reca_b427
reca_notg242:
  s_cmp_lg_u32 s12, 3
  s_cbranch_scc1 reca_b427
  s_add_u32 s34, s17, 2
  s_and_b32 s34, s34, 3
  s_mul_i32 s26, s34, 10240
  s_add_u32 s26, s26, s38
  s_mul_i32 s27, s34, 6144
  s_add_u32 s27, s27, s39
  s_mul_i32 s28, s34, 12288
  s_add_u32 s28, s28, s40
  s_mul_i32 s29, s34, 393216
  s_add_u32 s29, s29, s56
  buffer_store_dwordx2 v[32:33], v8, s[4:7], s27 offen
  buffer_store_dwordx4 v[32:35], v11, s[4:7], s28 offen
reca_b427:
  s_barrier
  s_cmp_lg_u32 s12, 2
  s_cbranch_scc1 reca_not267
  s_sleep 8
  buffer_load_dwordx4 v[128:131], v20, s[4:7], s25 offen sc1
  buffer_load_dwordx4 v[132:135], v21, s[4:7], s25 offen sc1
  buffer_load_dwordx4 v[136:139], v22, s[4:7], s25 offen sc1
  buffer_load_dwordx4 v[140:143], v23, s[4:7], s25 offen sc1
  buffer_load_dwordx4 v[144:147], v24, s[4:7], s25 offen sc1
  buffer_load_dwordx4 v[148:151], v25, s[4:7], s25 offen sc1
  buffer_load_dwordx4 v[152:155], v26, s[4:7], s25 offen sc1
  buffer_load_dwordx4 v[156:159], v27, s[4:7], s25 offen sc1
  s_waitcnt vmcnt(7)
  v_cmp_eq_u32 vcc, -1, v128
  s_cbranch_vccnz reca_retry68
reca_resume69:
  s_waitcnt vmcnt(6)
  v_cmp_eq_u32 vcc, -1, v132
  s_cbranch_vccnz reca_retry70
reca_resume71:
  s_waitcnt vmcnt(5)
  v_cmp_eq_u32 vcc, -1, v136
  v_pk_add_f32 v[116:117], v[128:129], v[132:133]
  v_pk_add_f32 v[118:119], v[130:131], v[134:135]
  s_cbranch_vccnz reca_retry72
reca_resume73:
  s_waitcnt vmcnt(4)
  v_cmp_eq_u32 vcc, -1, v140
  v_pk_add_f32 v[116:117], v[116:117], v[136:137]
  v_pk_add_f32 v[118:119], v[118:119], v[138:139]
  s_cbranch_vccnz reca_retry74
reca_resume75:
  s_waitcnt vmcnt(3)
  v_cmp_eq_u32 vcc, -1, v144
  v_pk_add_f32 v[116:117], v[116:117], v[140:141]
  v_pk_add_f32 v[118:119], v[118:119], v[142:143]
  s_cbranch_vccnz reca_retry76
reca_resume77:
  s_waitcnt vmcnt(2)
  v_cmp_eq_u32 vcc, -1, v148
  v_pk_add_f32 v[116:117], v[116:117], v[144:145]
  v_pk_add_f32 v[118:119], v[118:119], v[146:147]
  s_cbranch_vccnz reca_retry78
reca_resume79:
  s_waitcnt vmcnt(1)
  v_cmp_eq_u32 vcc, -1, v152
  v_pk_add_f32 v[116:117], v[116:117], v[148:149]
  v_pk_add_f32 v[118:119], v[118:119], v[150:151]
  s_cbranch_vccnz reca_retry80
reca_resume81:
  s_waitcnt vmcnt(0)
  v_cmp_eq_u32 vcc, -1, v156
  v_pk_add_f32 v[116:117], v[116:117], v[152:153]
  v_pk_add_f32 v[118:119], v[118:119], v[154:155]
  s_cbranch_vccnz reca_retry82
reca_resume83:
  v_pk_add_f32 v[116:117], v[116:117], v[156:157]
  v_pk_add_f32 v[118:119], v[118:119], v[158:159]
  v_cvt_pk_bf16_f32 v132, v116, v117
  v_cvt_pk_bf16_f32 v133, v118, v119
  buffer_store_dwordx2 v[132:133], v16, s[4:7], s24 offen
  s_branch reca_b528
reca_not267:
  s_cmp_lg_u32 s12, 3
  s_cbranch_scc1 reca_b528
  s_add_u32 s36, s17, 1
  s_cmp_ge_u32 s36, 63
  s_cbranch_scc1 reca_nopf84
  s_add_u32 s37, s36, 1
reca_pf85:
  buffer_load_dword v28, v233, s[4:7], 0 offen sc1
  s_waitcnt vmcnt(0)
  v_cmp_gt_i32 vcc, s37, v28
  s_cbranch_vccz reca_pfok86
  s_sleep 1
  s_sub_u32 s18, s18, 1
  s_cbranch_scc0 reca_pf85
  s_mov_b32 s18, 0
reca_pfok86:
  s_lshl_b32 s34, s15, 3
  s_and_b32 s35, s36, 7
  s_add_u32 s34, s34, s35
  s_mul_i32 s34, s34, 12288
  s_add_u32 s32, s34, 37748736
  s_lshl_b32 s35, s16, 11
  s_add_u32 s34, s34, s35
  s_add_u32 s33, s34, 40894464
  buffer_load_dwordx4 a[120:123], v1, s[4:7], s32 offen offset:0 sc1
  buffer_load_dwordx4 a[124:127], v1, s[4:7], s32 offen offset:1024 sc1
  buffer_load_dwordx4 a[128:131], v1, s[4:7], s32 offen offset:2048 sc1
  buffer_load_dwordx4 a[132:135], v1, s[4:7], s32 offen offset:3072 sc1
  buffer_load_dwordx4 a[136:139], v2, s[4:7], s32 offen offset:0 sc1
  buffer_load_dwordx4 a[140:143], v2, s[4:7], s32 offen offset:1024 sc1
  buffer_load_dwordx4 a[144:147], v2, s[4:7], s32 offen offset:2048 sc1
  buffer_load_dwordx4 a[148:151], v2, s[4:7], s32 offen offset:3072 sc1
  buffer_load_dwordx4 a[152:155], v3, s[4:7], s32 offen offset:0 sc1
  buffer_load_dwordx4 a[156:159], v3, s[4:7], s32 offen offset:1024 sc1
  buffer_load_dwordx4 a[160:163], v3, s[4:7], s32 offen offset:2048 sc1
  buffer_load_dwordx4 a[164:167], v3, s[4:7], s32 offen offset:3072 sc1
  buffer_load_dwordx4 a[168:171], v1, s[4:7], s33 offen offset:0 sc1
  buffer_load_dwordx4 a[172:175], v1, s[4:7], s33 offen offset:1024 sc1
reca_nopf84:
  buffer_store_dwordx2 v[52:53], v9, s[4:7], s30 offen
  buffer_store_dwordx2 v[68:69], v10, s[4:7], s31 offen
  buffer_store_dwordx2 v[70:71], v10, s[4:7], s31 offen offset:256
reca_b528:
  s_barrier
  s_add_u32 s17, s17, 1
  s_branch reca_step14
reca_retry17:
  s_sub_u32 s18, s18, 1
  s_cbranch_scc1 reca_retry17_to
  buffer_load_dwordx4 v[128:131], v4, s[4:7], s20 offen sc1
  buffer_load_dwordx4 v[132:135], v4, s[4:7], s20 offen offset:1024 sc1
  buffer_load_dwordx4 v[136:139], v5, s[4:7], s20 offen sc1
  s_waitcnt vmcnt(2)
  v_max_u32 v29, v128, v130
  v_cmp_eq_u32 vcc, -1, v29
  s_cbranch_vccnz reca_retry17
  s_branch reca_resume18
reca_retry17_to:
  s_mov_b32 s18, 0
  s_waitcnt vmcnt(0)
  s_branch reca_resume18
reca_retry19:
  s_sub_u32 s18, s18, 1
  s_cbranch_scc1 reca_retry19_to
  buffer_load_dwordx4 v[132:135], v4, s[4:7], s20 offen offset:1024 sc1
  buffer_load_dwordx4 v[136:139], v5, s[4:7], s20 offen sc1
  s_waitcnt vmcnt(1)
  v_max_u32 v29, v132, v134
  v_cmp_eq_u32 vcc, -1, v29
  s_cbranch_vccnz reca_retry19
  s_branch reca_resume20
reca_retry19_to:
  s_mov_b32 s18, 0
  s_waitcnt vmcnt(0)
  s_branch reca_resume20
reca_retry21:
  s_sub_u32 s18, s18, 1
  s_cbranch_scc1 reca_retry21_to
  buffer_load_dwordx4 v[136:139], v5, s[4:7], s20 offen sc1
  s_waitcnt vmcnt(0)
  v_max_u32 v29, v136, v138
  v_cmp_eq_u32 vcc, -1, v29
  s_cbranch_vccnz reca_retry21
  s_branch reca_resume22
reca_retry21_to:
  s_mov_b32 s18, 0
  s_waitcnt vmcnt(0)
  s_branch reca_resume22
reca_retry30:
  s_sub_u32 s18, s18, 1
  s_cbranch_scc1 reca_retry30_to
  buffer_load_dwordx4 v[208:211], v1, s[4:7], s21 offen offset:0 sc1
  buffer_load_dwordx4 v[212:215], v1, s[4:7], s21 offen offset:1024 sc1
  buffer_load_dwordx4 v[216:219], v1, s[4:7], s21 offen offset:2048 sc1
  buffer_load_dwordx4 v[220:223], v1, s[4:7], s21 offen offset:3072 sc1
  buffer_load_dwordx4 v[224:227], v2, s[4:7], s21 offen offset:0 sc1
  buffer_load_dwordx4 v[228:231], v2, s[4:7], s21 offen offset:1024 sc1
  s_waitcnt vmcnt(5)
  v_max_u32 v29, v208, v210
  v_cmp_eq_u32 vcc, -1, v29
  s_cbranch_vccnz reca_retry30
  s_branch reca_resume31
reca_retry30_to:
  s_mov_b32 s18, 0
  s_waitcnt vmcnt(0)
  s_branch reca_resume31
reca_retry32:
  s_sub_u32 s18, s18, 1
  s_cbranch_scc1 reca_retry32_to
  buffer_load_dwordx4 v[212:215], v1, s[4:7], s21 offen offset:1024 sc1
  buffer_load_dwordx4 v[216:219], v1, s[4:7], s21 offen offset:2048 sc1
  buffer_load_dwordx4 v[220:223], v1, s[4:7], s21 offen offset:3072 sc1
  buffer_load_dwordx4 v[224:227], v2, s[4:7], s21 offen offset:0 sc1
  buffer_load_dwordx4 v[228:231], v2, s[4:7], s21 offen offset:1024 sc1
  s_waitcnt vmcnt(4)
  v_max_u32 v29, v212, v214
  v_cmp_eq_u32 vcc, -1, v29
  s_cbranch_vccnz reca_retry32
  s_branch reca_resume33
reca_retry32_to:
  s_mov_b32 s18, 0
  s_waitcnt vmcnt(0)
  s_branch reca_resume33
reca_retry34:
  s_sub_u32 s18, s18, 1
  s_cbranch_scc1 reca_retry34_to
  buffer_load_dwordx4 v[216:219], v1, s[4:7], s21 offen offset:2048 sc1
  buffer_load_dwordx4 v[220:223], v1, s[4:7], s21 offen offset:3072 sc1
  buffer_load_dwordx4 v[224:227], v2, s[4:7], s21 offen offset:0 sc1
  buffer_load_dwordx4 v[228:231], v2, s[4:7], s21 offen offset:1024 sc1
  s_waitcnt vmcnt(3)
  v_max_u32 v29, v216, v218
  v_cmp_eq_u32 vcc, -1, v29
  s_cbranch_vccnz reca_retry34
  s_branch reca_resume35
reca_retry34_to:
  s_mov_b32 s18, 0
  s_waitcnt vmcnt(0)
  s_branch reca_resume35
reca_retry36:
  s_sub_u32 s18, s18, 1
  s_cbranch_scc1 reca_retry36_to
  buffer_load_dwordx4 v[220:223], v1, s[4:7], s21 offen offset:3072 sc1
  buffer_load_dwordx4 v[224:227], v2, s[4:7], s21 offen offset:0 sc1
  buffer_load_dwordx4 v[228:231], v2, s[4:7], s21 offen offset:1024 sc1
  s_waitcnt vmcnt(2)
  v_max_u32 v29, v220, v222
  v_cmp_eq_u32 vcc, -1, v29
  s_cbranch_vccnz reca_retry36
  s_branch reca_resume37
reca_retry36_to:
  s_mov_b32 s18, 0
  s_waitcnt vmcnt(0)
  s_branch reca_resume37
reca_retry38:
  s_sub_u32 s18, s18, 1
  s_cbranch_scc1 reca_retry38_to
  buffer_load_dwordx4 v[224:227], v2, s[4:7], s21 offen offset:0 sc1
  buffer_load_dwordx4 v[228:231], v2, s[4:7], s21 offen offset:1024 sc1
  s_waitcnt vmcnt(1)
  v_max_u32 v29, v224, v226
  v_cmp_eq_u32 vcc, -1, v29
  s_cbranch_vccnz reca_retry38
  s_branch reca_resume39
reca_retry38_to:
  s_mov_b32 s18, 0
  s_waitcnt vmcnt(0)
  s_branch reca_resume39
reca_retry40:
  s_sub_u32 s18, s18, 1
  s_cbranch_scc1 reca_retry40_to
  buffer_load_dwordx4 v[228:231], v2, s[4:7], s21 offen offset:1024 sc1
  s_waitcnt vmcnt(0)
  v_max_u32 v29, v228, v230
  v_cmp_eq_u32 vcc, -1, v29
  s_cbranch_vccnz reca_retry40
  s_branch reca_resume41
reca_retry40_to:
  s_mov_b32 s18, 0
  s_waitcnt vmcnt(0)
  s_branch reca_resume41
reca_retry43:
  s_sub_u32 s18, s18, 1
  s_cbranch_scc1 reca_retry43_to
  buffer_load_dwordx4 v[128:131], v12, s[4:7], s22 offen offset:0 sc1
  buffer_load_dwordx4 v[132:135], v12, s[4:7], s22 offen offset:1024 sc1
  buffer_load_dwordx4 v[136:139], v12, s[4:7], s22 offen offset:2048 sc1
  buffer_load_dwordx4 v[140:143], v12, s[4:7], s22 offen offset:3072 sc1
  buffer_load_dwordx4 v[144:147], v13, s[4:7], s22 offen offset:0 sc1
  buffer_load_dwordx4 v[148:151], v13, s[4:7], s22 offen offset:1024 sc1
  buffer_load_dwordx4 v[152:155], v13, s[4:7], s22 offen offset:2048 sc1
  buffer_load_dwordx4 v[156:159], v13, s[4:7], s22 offen offset:3072 sc1
  buffer_load_dwordx4 v[160:163], v14, s[4:7], s22 offen offset:0 sc1
  buffer_load_dwordx4 v[164:167], v14, s[4:7], s22 offen offset:1024 sc1
  buffer_load_dwordx4 v[168:171], v14, s[4:7], s22 offen offset:2048 sc1
  buffer_load_dwordx4 v[172:175], v14, s[4:7], s22 offen offset:3072 sc1
  s_waitcnt vmcnt(11)
  v_cmp_eq_u32 vcc, -1, v128
  s_cbranch_vccnz reca_retry43
  s_branch reca_resume44
reca_retry43_to:
  s_mov_b32 s18, 0
  s_waitcnt vmcnt(0)
  s_branch reca_resume44
reca_retry45:
  s_sub_u32 s18, s18, 1
  s_cbranch_scc1 reca_retry45_to
  buffer_load_dwordx4 v[132:135], v12, s[4:7], s22 offen offset:1024 sc1
  buffer_load_dwordx4 v[136:139], v12, s[4:7], s22 offen offset:2048 sc1
  buffer_load_dwordx4 v[140:143], v12, s[4:7], s22 offen offset:3072 sc1
  buffer_load_dwordx4 v[144:147], v13, s[4:7], s22 offen offset:0 sc1
  buffer_load_dwordx4 v[148:151], v13, s[4:7], s22 offen offset:1024 sc1
  buffer_load_dwordx4 v[152:155], v13, s[4:7], s22 offen offset:2048 sc1
  buffer_load_dwordx4 v[156:159], v13, s[4:7], s22 offen offset:3072 sc1
  buffer_load_dwordx4 v[160:163], v14, s[4:7], s22 offen offset:0 sc1
  buffer_load_dwordx4 v[164:167], v14, s[4:7], s22 offen offset:1024 sc1
  buffer_load_dwordx4 v[168:171], v14, s[4:7], s22 offen offset:2048 sc1
  buffer_load_dwordx4 v[172:175], v14, s[4:7], s22 offen offset:3072 sc1
  s_waitcnt vmcnt(10)
  v_cmp_eq_u32 vcc, -1, v132
  s_cbranch_vccnz reca_retry45
  s_branch reca_resume46
reca_retry45_to:
  s_mov_b32 s18, 0
  s_waitcnt vmcnt(0)
  s_branch reca_resume46
reca_retry47:
  s_sub_u32 s18, s18, 1
  s_cbranch_scc1 reca_retry47_to
  buffer_load_dwordx4 v[136:139], v12, s[4:7], s22 offen offset:2048 sc1
  buffer_load_dwordx4 v[140:143], v12, s[4:7], s22 offen offset:3072 sc1
  buffer_load_dwordx4 v[144:147], v13, s[4:7], s22 offen offset:0 sc1
  buffer_load_dwordx4 v[148:151], v13, s[4:7], s22 offen offset:1024 sc1
  buffer_load_dwordx4 v[152:155], v13, s[4:7], s22 offen offset:2048 sc1
  buffer_load_dwordx4 v[156:159], v13, s[4:7], s22 offen offset:3072 sc1
  buffer_load_dwordx4 v[160:163], v14, s[4:7], s22 offen offset:0 sc1
  buffer_load_dwordx4 v[164:167], v14, s[4:7], s22 offen offset:1024 sc1
  buffer_load_dwordx4 v[168:171], v14, s[4:7], s22 offen offset:2048 sc1
  buffer_load_dwordx4 v[172:175], v14, s[4:7], s22 offen offset:3072 sc1
  s_waitcnt vmcnt(9)
  v_cmp_eq_u32 vcc, -1, v136
  s_cbranch_vccnz reca_retry47
  s_branch reca_resume48
reca_retry47_to:
  s_mov_b32 s18, 0
  s_waitcnt vmcnt(0)
  s_branch reca_resume48
reca_retry49:
  s_sub_u32 s18, s18, 1
  s_cbranch_scc1 reca_retry49_to
  buffer_load_dwordx4 v[140:143], v12, s[4:7], s22 offen offset:3072 sc1
  buffer_load_dwordx4 v[144:147], v13, s[4:7], s22 offen offset:0 sc1
  buffer_load_dwordx4 v[148:151], v13, s[4:7], s22 offen offset:1024 sc1
  buffer_load_dwordx4 v[152:155], v13, s[4:7], s22 offen offset:2048 sc1
  buffer_load_dwordx4 v[156:159], v13, s[4:7], s22 offen offset:3072 sc1
  buffer_load_dwordx4 v[160:163], v14, s[4:7], s22 offen offset:0 sc1
  buffer_load_dwordx4 v[164:167], v14, s[4:7], s22 offen offset:1024 sc1
  buffer_load_dwordx4 v[168:171], v14, s[4:7], s22 offen offset:2048 sc1
  buffer_load_dwordx4 v[172:175], v14, s[4:7], s22 offen offset:3072 sc1
  s_waitcnt vmcnt(8)
  v_cmp_eq_u32 vcc, -1, v140
  s_cbranch_vccnz reca_retry49
  s_branch reca_resume50
reca_retry49_to:
  s_mov_b32 s18, 0
  s_waitcnt vmcnt(0)
  s_branch reca_resume50
reca_retry51:
  s_sub_u32 s18, s18, 1
  s_cbranch_scc1 reca_retry51_to
  buffer_load_dwordx4 v[144:147], v13, s[4:7], s22 offen offset:0 sc1
  buffer_load_dwordx4 v[148:151], v13, s[4:7], s22 offen offset:1024 sc1
  buffer_load_dwordx4 v[152:155], v13, s[4:7], s22 offen offset:2048 sc1
  buffer_load_dwordx4 v[156:159], v13, s[4:7], s22 offen offset:3072 sc1
  buffer_load_dwordx4 v[160:163], v14, s[4:7], s22 offen offset:0 sc1
  buffer_load_dwordx4 v[164:167], v14, s[4:7], s22 offen offset:1024 sc1
  buffer_load_dwordx4 v[168:171], v14, s[4:7], s22 offen offset:2048 sc1
  buffer_load_dwordx4 v[172:175], v14, s[4:7], s22 offen offset:3072 sc1
  s_waitcnt vmcnt(7)
  v_cmp_eq_u32 vcc, -1, v144
  s_cbranch_vccnz reca_retry51
  s_branch reca_resume52
reca_retry51_to:
  s_mov_b32 s18, 0
  s_waitcnt vmcnt(0)
  s_branch reca_resume52
reca_retry53:
  s_sub_u32 s18, s18, 1
  s_cbranch_scc1 reca_retry53_to
  buffer_load_dwordx4 v[148:151], v13, s[4:7], s22 offen offset:1024 sc1
  buffer_load_dwordx4 v[152:155], v13, s[4:7], s22 offen offset:2048 sc1
  buffer_load_dwordx4 v[156:159], v13, s[4:7], s22 offen offset:3072 sc1
  buffer_load_dwordx4 v[160:163], v14, s[4:7], s22 offen offset:0 sc1
  buffer_load_dwordx4 v[164:167], v14, s[4:7], s22 offen offset:1024 sc1
  buffer_load_dwordx4 v[168:171], v14, s[4:7], s22 offen offset:2048 sc1
  buffer_load_dwordx4 v[172:175], v14, s[4:7], s22 offen offset:3072 sc1
  s_waitcnt vmcnt(6)
  v_cmp_eq_u32 vcc, -1, v148
  s_cbranch_vccnz reca_retry53
  s_branch reca_resume54
reca_retry53_to:
  s_mov_b32 s18, 0
  s_waitcnt vmcnt(0)
  s_branch reca_resume54
reca_retry55:
  s_sub_u32 s18, s18, 1
  s_cbranch_scc1 reca_retry55_to
  buffer_load_dwordx4 v[152:155], v13, s[4:7], s22 offen offset:2048 sc1
  buffer_load_dwordx4 v[156:159], v13, s[4:7], s22 offen offset:3072 sc1
  buffer_load_dwordx4 v[160:163], v14, s[4:7], s22 offen offset:0 sc1
  buffer_load_dwordx4 v[164:167], v14, s[4:7], s22 offen offset:1024 sc1
  buffer_load_dwordx4 v[168:171], v14, s[4:7], s22 offen offset:2048 sc1
  buffer_load_dwordx4 v[172:175], v14, s[4:7], s22 offen offset:3072 sc1
  s_waitcnt vmcnt(5)
  v_cmp_eq_u32 vcc, -1, v152
  s_cbranch_vccnz reca_retry55
  s_branch reca_resume56
reca_retry55_to:
  s_mov_b32 s18, 0
  s_waitcnt vmcnt(0)
  s_branch reca_resume56
reca_retry57:
  s_sub_u32 s18, s18, 1
  s_cbranch_scc1 reca_retry57_to
  buffer_load_dwordx4 v[156:159], v13, s[4:7], s22 offen offset:3072 sc1
  buffer_load_dwordx4 v[160:163], v14, s[4:7], s22 offen offset:0 sc1
  buffer_load_dwordx4 v[164:167], v14, s[4:7], s22 offen offset:1024 sc1
  buffer_load_dwordx4 v[168:171], v14, s[4:7], s22 offen offset:2048 sc1
  buffer_load_dwordx4 v[172:175], v14, s[4:7], s22 offen offset:3072 sc1
  s_waitcnt vmcnt(4)
  v_cmp_eq_u32 vcc, -1, v156
  s_cbranch_vccnz reca_retry57
  s_branch reca_resume58
reca_retry57_to:
  s_mov_b32 s18, 0
  s_waitcnt vmcnt(0)
  s_branch reca_resume58
reca_retry59:
  s_sub_u32 s18, s18, 1
  s_cbranch_scc1 reca_retry59_to
  buffer_load_dwordx4 v[160:163], v14, s[4:7], s22 offen offset:0 sc1
  buffer_load_dwordx4 v[164:167], v14, s[4:7], s22 offen offset:1024 sc1
  buffer_load_dwordx4 v[168:171], v14, s[4:7], s22 offen offset:2048 sc1
  buffer_load_dwordx4 v[172:175], v14, s[4:7], s22 offen offset:3072 sc1
  s_waitcnt vmcnt(3)
  v_cmp_eq_u32 vcc, -1, v160
  s_cbranch_vccnz reca_retry59
  s_branch reca_resume60
reca_retry59_to:
  s_mov_b32 s18, 0
  s_waitcnt vmcnt(0)
  s_branch reca_resume60
reca_retry61:
  s_sub_u32 s18, s18, 1
  s_cbranch_scc1 reca_retry61_to
  buffer_load_dwordx4 v[164:167], v14, s[4:7], s22 offen offset:1024 sc1
  buffer_load_dwordx4 v[168:171], v14, s[4:7], s22 offen offset:2048 sc1
  buffer_load_dwordx4 v[172:175], v14, s[4:7], s22 offen offset:3072 sc1
  s_waitcnt vmcnt(2)
  v_cmp_eq_u32 vcc, -1, v164
  s_cbranch_vccnz reca_retry61
  s_branch reca_resume62
reca_retry61_to:
  s_mov_b32 s18, 0
  s_waitcnt vmcnt(0)
  s_branch reca_resume62
reca_retry63:
  s_sub_u32 s18, s18, 1
  s_cbranch_scc1 reca_retry63_to
  buffer_load_dwordx4 v[168:171], v14, s[4:7], s22 offen offset:2048 sc1
  buffer_load_dwordx4 v[172:175], v14, s[4:7], s22 offen offset:3072 sc1
  s_waitcnt vmcnt(1)
  v_cmp_eq_u32 vcc, -1, v168
  s_cbranch_vccnz reca_retry63
  s_branch reca_resume64
reca_retry63_to:
  s_mov_b32 s18, 0
  s_waitcnt vmcnt(0)
  s_branch reca_resume64
reca_retry65:
  s_sub_u32 s18, s18, 1
  s_cbranch_scc1 reca_retry65_to
  buffer_load_dwordx4 v[172:175], v14, s[4:7], s22 offen offset:3072 sc1
  s_waitcnt vmcnt(0)
  v_cmp_eq_u32 vcc, -1, v172
  s_cbranch_vccnz reca_retry65
  s_branch reca_resume66
reca_retry65_to:
  s_mov_b32 s18, 0
  s_waitcnt vmcnt(0)
  s_branch reca_resume66
reca_retry68:
  s_sub_u32 s18, s18, 1
  s_cbranch_scc1 reca_retry68_to
  buffer_load_dwordx4 v[128:131], v20, s[4:7], s25 offen sc1
  buffer_load_dwordx4 v[132:135], v21, s[4:7], s25 offen sc1
  buffer_load_dwordx4 v[136:139], v22, s[4:7], s25 offen sc1
  buffer_load_dwordx4 v[140:143], v23, s[4:7], s25 offen sc1
  buffer_load_dwordx4 v[144:147], v24, s[4:7], s25 offen sc1
  buffer_load_dwordx4 v[148:151], v25, s[4:7], s25 offen sc1
  buffer_load_dwordx4 v[152:155], v26, s[4:7], s25 offen sc1
  buffer_load_dwordx4 v[156:159], v27, s[4:7], s25 offen sc1
  s_waitcnt vmcnt(7)
  v_cmp_eq_u32 vcc, -1, v128
  s_cbranch_vccnz reca_retry68
  s_branch reca_resume69
reca_retry68_to:
  s_mov_b32 s18, 0
  s_waitcnt vmcnt(0)
  s_branch reca_resume69
reca_retry70:
  s_sub_u32 s18, s18, 1
  s_cbranch_scc1 reca_retry70_to
  buffer_load_dwordx4 v[132:135], v21, s[4:7], s25 offen sc1
  buffer_load_dwordx4 v[136:139], v22, s[4:7], s25 offen sc1
  buffer_load_dwordx4 v[140:143], v23, s[4:7], s25 offen sc1
  buffer_load_dwordx4 v[144:147], v24, s[4:7], s25 offen sc1
  buffer_load_dwordx4 v[148:151], v25, s[4:7], s25 offen sc1
  buffer_load_dwordx4 v[152:155], v26, s[4:7], s25 offen sc1
  buffer_load_dwordx4 v[156:159], v27, s[4:7], s25 offen sc1
  s_waitcnt vmcnt(6)
  v_cmp_eq_u32 vcc, -1, v132
  s_cbranch_vccnz reca_retry70
  s_branch reca_resume71
reca_retry70_to:
  s_mov_b32 s18, 0
  s_waitcnt vmcnt(0)
  s_branch reca_resume71
reca_retry72:
  s_sub_u32 s18, s18, 1
  s_cbranch_scc1 reca_retry72_to
  buffer_load_dwordx4 v[136:139], v22, s[4:7], s25 offen sc1
  buffer_load_dwordx4 v[140:143], v23, s[4:7], s25 offen sc1
  buffer_load_dwordx4 v[144:147], v24, s[4:7], s25 offen sc1
  buffer_load_dwordx4 v[148:151], v25, s[4:7], s25 offen sc1
  buffer_load_dwordx4 v[152:155], v26, s[4:7], s25 offen sc1
  buffer_load_dwordx4 v[156:159], v27, s[4:7], s25 offen sc1
  s_waitcnt vmcnt(5)
  v_cmp_eq_u32 vcc, -1, v136
  s_cbranch_vccnz reca_retry72
  s_branch reca_resume73
reca_retry72_to:
  s_mov_b32 s18, 0
  s_waitcnt vmcnt(0)
  s_branch reca_resume73
reca_retry74:
  s_sub_u32 s18, s18, 1
  s_cbranch_scc1 reca_retry74_to
  buffer_load_dwordx4 v[140:143], v23, s[4:7], s25 offen sc1
  buffer_load_dwordx4 v[144:147], v24, s[4:7], s25 offen sc1
  buffer_load_dwordx4 v[148:151], v25, s[4:7], s25 offen sc1
  buffer_load_dwordx4 v[152:155], v26, s[4:7], s25 offen sc1
  buffer_load_dwordx4 v[156:159], v27, s[4:7], s25 offen sc1
  s_waitcnt vmcnt(4)
  v_cmp_eq_u32 vcc, -1, v140
  s_cbranch_vccnz reca_retry74
  s_branch reca_resume75
reca_retry74_to:
  s_mov_b32 s18, 0
  s_waitcnt vmcnt(0)
  s_branch reca_resume75
reca_retry76:
  s_sub_u32 s18, s18, 1
  s_cbranch_scc1 reca_retry76_to
  buffer_load_dwordx4 v[144:147], v24, s[4:7], s25 offen sc1
  buffer_load_dwordx4 v[148:151], v25, s[4:7], s25 offen sc1
  buffer_load_dwordx4 v[152:155], v26, s[4:7], s25 offen sc1
  buffer_load_dwordx4 v[156:159], v27, s[4:7], s25 offen sc1
  s_waitcnt vmcnt(3)
  v_cmp_eq_u32 vcc, -1, v144
  s_cbranch_vccnz reca_retry76
  s_branch reca_resume77
reca_retry76_to:
  s_mov_b32 s18, 0
  s_waitcnt vmcnt(0)
  s_branch reca_resume77
reca_retry78:
  s_sub_u32 s18, s18, 1
  s_cbranch_scc1 reca_retry78_to
  buffer_load_dwordx4 v[148:151], v25, s[4:7], s25 offen sc1
  buffer_load_dwordx4 v[152:155], v26, s[4:7], s25 offen sc1
  buffer_load_dwordx4 v[156:159], v27, s[4:7], s25 offen sc1
  s_waitcnt vmcnt(2)
  v_cmp_eq_u32 vcc, -1, v148
  s_cbranch_vccnz reca_retry78
  s_branch reca_resume79
reca_retry78_to:
  s_mov_b32 s18, 0
  s_waitcnt vmcnt(0)
  s_branch reca_resume79
reca_retry80:
  s_sub_u32 s18, s18, 1
  s_cbranch_scc1 reca_retry80_to
  buffer_load_dwordx4 v[152:155], v26, s[4:7], s25 offen sc1
  buffer_load_dwordx4 v[156:159], v27, s[4:7], s25 offen sc1
  s_waitcnt vmcnt(1)
  v_cmp_eq_u32 vcc, -1, v152
  s_cbranch_vccnz reca_retry80
  s_branch reca_resume81
reca_retry80_to:
  s_mov_b32 s18, 0
  s_waitcnt vmcnt(0)
  s_branch reca_resume81
reca_retry82:
  s_sub_u32 s18, s18, 1
  s_cbranch_scc1 reca_retry82_to
  buffer_load_dwordx4 v[156:159], v27, s[4:7], s25 offen sc1
  s_waitcnt vmcnt(0)
  v_cmp_eq_u32 vcc, -1, v156
  s_cbranch_vccnz reca_retry82
  s_branch reca_resume83
reca_retry82_to:
  s_mov_b32 s18, 0
  s_waitcnt vmcnt(0)
  s_branch reca_resume83
reca_twinf12:
  s_branch reca_gotmem88
reca_step87:
  s_and_b32 s34, s17, 3
  s_mul_i32 s20, s34, 10240
  s_add_u32 s20, s20, s38
  s_sleep 5
  buffer_load_dwordx4 v[128:131], v4, s[4:7], s20 offen sc1
  buffer_load_dwordx4 v[132:135], v4, s[4:7], s20 offen offset:1024 sc1
  buffer_load_dwordx4 v[136:139], v5, s[4:7], s20 offen sc1
  s_waitcnt vmcnt(2)
  v_max_u32 v29, v128, v130
  v_cmp_eq_u32 vcc, -1, v29
  s_cbranch_vccnz reca_retry90
reca_resume91:
  s_waitcnt vmcnt(1)
  v_max_u32 v29, v132, v134
  v_cmp_eq_u32 vcc, -1, v29
  ds_write_b128 v4, v[128:131]
  s_cbranch_vccnz reca_retry92
reca_resume93:
  s_waitcnt vmcnt(0)
  v_max_u32 v29, v136, v138
  v_cmp_eq_u32 vcc, -1, v29
  ds_write_b128 v4, v[132:135] offset:1024
  s_cbranch_vccnz reca_retry94
reca_resume95:
  ds_write_b128 v5, v[136:139]
  s_branch reca_gotmem289
reca_gotmem88:
  ds_write_b128 v4, v[128:131]
  ds_write_b128 v4, v[132:135] offset:1024
  ds_write_b128 v5, v[136:139]
reca_gotmem289:
  s_and_b32 s34, s17, 3
  s_mul_i32 s21, s34, 6144
  s_add_u32 s21, s21, s39
  s_mul_i32 s22, s34, 12288
  s_add_u32 s22, s22, s40
  s_mul_i32 s25, s34, 393216
  s_add_u32 s25, s25, s56
  s_add_u32 s35, s17, 1
  s_and_b32 s35, s35, 3
  s_mul_i32 s24, s35, 10240
  s_add_u32 s24, s24, s38
  s_waitcnt lgkmcnt(0)
  s_barrier
  ds_read_b128 v[128:131], v236 offset:0
  ds_read_b128 v[132:135], v236 offset:1024
  ds_read_b128 v[136:139], v236 offset:2048
  ds_read_b128 v[140:143], v236 offset:3072
  ds_read_b128 v[144:147], v236 offset:4096
  ds_read_b128 v[148:151], v237 offset:0
  ds_read_b128 v[152:155], v237 offset:1024
  ds_read_b128 v[156:159], v237 offset:2048
  ds_read_b128 v[160:163], v237 offset:3072
  ds_read_b128 v[164:167], v237 offset:4096
  s_waitcnt lgkmcnt(9)
  v_mfma_f32_16x16x32_bf16 v[44:47], a[0:3], v[128:131], 0
  ds_read_b128 v[168:171], v6 offset:0
  v_mfma_f32_16x16x32_bf16 v[240:243], a[4:7], v[128:131], 0
  s_waitcnt lgkmcnt(9)
  v_mfma_f32_16x16x32_bf16 v[44:47], a[8:11], v[132:135], v[44:47]
  ds_read_b128 v[172:175], v6 offset:512
  v_mfma_f32_16x16x32_bf16 v[240:243], a[12:15], v[132:135], v[240:243]
  s_waitcnt lgkmcnt(9)
  v_mfma_f32_16x16x32_bf16 v[44:47], a[16:19], v[136:139], v[44:47]
  ds_read_b128 v[176:179], v6 offset:1024
  v_mfma_f32_16x16x32_bf16 v[240:243], a[20:23], v[136:139], v[240:243]
  s_waitcnt lgkmcnt(9)
  v_mfma_f32_16x16x32_bf16 v[44:47], a[24:27], v[140:143], v[44:47]
  ds_read_b128 v[180:183], v6 offset:1536
  v_mfma_f32_16x16x32_bf16 v[240:243], a[28:31], v[140:143], v[240:243]
  s_waitcnt lgkmcnt(9)
  v_mfma_f32_16x16x32_bf16 v[44:47], a[32:35], v[144:147], v[44:47]
  ds_read_b128 v[184:187], v6 offset:2048
  v_mfma_f32_16x16x32_bf16 v[240:243], a[36:39], v[144:147], v[240:243]
  s_waitcnt lgkmcnt(9)
  v_mfma_f32_16x16x32_bf16 v[44:47], a[40:43], v[148:151], v[44:47]
  ds_read_b128 v[188:191], v6 offset:2560
  v_mfma_f32_16x16x32_bf16 v[240:243], a[44:47], v[148:151], v[240:243]
  s_waitcnt lgkmcnt(9)
  v_mfma_f32_16x16x32_bf16 v[44:47], a[48:51], v[152:155], v[44:47]
  ds_read_b128 v[192:195], v6 offset:3072
  v_mfma_f32_16x16x32_bf16 v[240:243], a[52:55], v[152:155], v[240:243]
  s_waitcnt lgkmcnt(9)
  v_mfma_f32_16x16x32_bf16 v[44:47], a[56:59], v[156:159], v[44:47]
  ds_read_b128 v[196:199], v6 offset:3584
  v_mfma_f32_16x16x32_bf16 v[240:243], a[60:63], v[156:159], v[240:243]
  s_waitcnt lgkmcnt(9)
  v_mfma_f32_16x16x32_bf16 v[44:47], a[64:67], v[160:163], v[44:47]
  ds_read_b128 v[200:203], v6 offset:4096
  v_mfma_f32_16x16x32_bf16 v[240:243], a[68:71], v[160:163], v[240:243]
  s_waitcnt lgkmcnt(9)
  v_mfma_f32_16x16x32_bf16 v[44:47], a[72:75], v[164:167], v[44:47]
  ds_read_b128 v[204:207], v6 offset:4608
  v_mfma_f32_16x16x32_bf16 v[240:243], a[76:79], v[164:167], v[240:243]
  s_waitcnt lgkmcnt(9)
  v_mfma_f32_16x16x32_bf16 v[48:51], v[168:171], a[80:83], 0
  s_and_b32 s34, s17, 7
  s_lshl_b32 s34, s34, 5
  s_add_u32 s34, s34, s15
  s_mul_i32 s34, s34, 3072
  s_lshl_b32 s35, s16, 9
  s_add_u32 s34, s34, s35
  s_add_u32 s30, s34, 47185920
  s_add_u32 s31, s34, 47972352
  v_add_f32_dpp v44, v240, v44 row_ror:8 row_mask:0xf bank_mask:0xf
  v_add_f32_dpp v45, v241, v45 row_ror:8 row_mask:0xf bank_mask:0xf
  v_add_f32_dpp v46, v242, v46 row_ror:8 row_mask:0xf bank_mask:0xf
  v_add_f32_dpp v47, v243, v47 row_ror:8 row_mask:0xf bank_mask:0xf
  v_cvt_pk_bf16_f32 v52, v44, v45
  v_cvt_pk_bf16_f32 v53, v46, v47
  buffer_store_dwordx2 v[52:53], v8, s[4:7], s21 offen
  s_waitcnt lgkmcnt(8)
  v_mfma_f32_16x16x32_bf16 v[48:51], v[172:175], a[84:87], v[48:51]
  s_waitcnt lgkmcnt(7)
  v_mfma_f32_16x16x32_bf16 v[48:51], v[176:179], a[88:91], v[48:51]
  s_waitcnt lgkmcnt(6)
  v_mfma_f32_16x16x32_bf16 v[48:51], v[180:183], a[92:95], v[48:51]
  s_waitcnt lgkmcnt(5)
  v_mfma_f32_16x16x32_bf16 v[48:51], v[184:187], a[96:99], v[48:51]
  s_waitcnt lgkmcnt(4)
  v_mfma_f32_16x16x32_bf16 v[48:51], v[188:191], a[100:103], v[48:51]
  s_waitcnt lgkmcnt(3)
  v_mfma_f32_16x16x32_bf16 v[48:51], v[192:195], a[104:107], v[48:51]
  s_waitcnt lgkmcnt(2)
  v_mfma_f32_16x16x32_bf16 v[48:51], v[196:199], a[108:111], v[48:51]
  s_waitcnt lgkmcnt(1)
  v_mfma_f32_16x16x32_bf16 v[48:51], v[200:203], a[112:115], v[48:51]
  s_waitcnt lgkmcnt(0)
  v_mfma_f32_16x16x32_bf16 v[48:51], v[204:207], a[116:119], v[48:51]
  s_cmp_eq_u32 s12, 3
  s_cbranch_scc1 reca_swave96
  s_nop 5
  ds_write_b128 v17, v[48:51]
  s_add_u32 s34, s17, 2
  s_and_b32 s34, s34, 3
  s_mul_i32 s26, s34, 10240
  s_add_u32 s26, s26, s38
  s_mul_i32 s27, s34, 6144
  s_add_u32 s27, s27, s39
  s_mul_i32 s28, s34, 12288
  s_add_u32 s28, s28, s40
  s_mul_i32 s29, s34, 393216
  s_add_u32 s29, s29, s56
  s_waitcnt lgkmcnt(0)
  s_barrier
  s_cmp_eq_u32 s17, 63
  s_cbranch_scc1 reca_last98
  buffer_store_dwordx2 v[32:33], v8, s[4:7], s27 offen
  s_cmp_lg_u32 s12, 2
  s_cbranch_scc1 reca_tw1102_n
  buffer_store_dwordx2 v[52:53], v9, s[4:7], s30 offen
reca_tw1102_n:
  s_barrier
  s_cmp_eq_u32 s12, 1
  s_cbranch_scc1 reca_tw1102
  s_cmp_eq_u32 s12, 2
  s_cbranch_scc1 reca_tw2103
  s_cmp_lt_u32 s17, 2
  s_cbranch_scc1 reca_b5101
  s_cmp_gt_u32 s17, 61
  s_cbranch_scc1 reca_b5101
  s_sub_u32 s36, s17, 2
  s_and_b32 s36, s36, 7
  s_lshl_b32 s34, s59, 3
  s_add_u32 s34, s34, s36
  s_mul_i32 s34, s34, 12288
  s_add_u32 s23, s34, 37748736
  s_add_u32 s60, s34, 44040192
  s_lshl_b32 s35, s36, 5
  s_add_u32 s35, s35, s59
  s_mul_i32 s35, s35, 3072
  s_add_u32 s61, s35, 47185920
  buffer_load_dwordx4 a[120:123], v1, s[4:7], s23 offen offset:0 sc1
  buffer_load_dwordx4 a[124:127], v1, s[4:7], s23 offen offset:1024 sc1
  buffer_load_dwordx4 a[128:131], v1, s[4:7], s23 offen offset:2048 sc1
  buffer_load_dwordx4 a[132:135], v1, s[4:7], s23 offen offset:3072 sc1
  buffer_load_dwordx4 a[136:139], v2, s[4:7], s23 offen offset:0 sc1
  buffer_load_dwordx4 a[140:143], v2, s[4:7], s23 offen offset:1024 sc1
  buffer_load_dwordx4 a[144:147], v2, s[4:7], s23 offen offset:2048 sc1
  buffer_load_dwordx4 a[148:151], v2, s[4:7], s23 offen offset:3072 sc1
  buffer_load_dwordx4 a[152:155], v3, s[4:7], s23 offen offset:0 sc1
  buffer_load_dwordx4 a[156:159], v3, s[4:7], s23 offen offset:1024 sc1
  buffer_load_dwordx4 a[160:163], v3, s[4:7], s23 offen offset:2048 sc1
  buffer_load_dwordx4 a[164:167], v3, s[4:7], s23 offen offset:3072 sc1
  buffer_load_dwordx4 a[216:219], v92, s[4:7], s61 offen offset:0 sc1
  buffer_load_dwordx4 a[220:223], v92, s[4:7], s61 offen offset:512 sc1
  buffer_load_dwordx4 a[224:227], v92, s[4:7], s61 offen offset:1024 sc1
  buffer_load_dwordx4 a[228:231], v92, s[4:7], s61 offen offset:1536 sc1
  buffer_load_dwordx4 a[232:235], v92, s[4:7], s61 offen offset:2048 sc1
  buffer_load_dwordx4 a[236:239], v92, s[4:7], s61 offen offset:2560 sc1
  buffer_load_dwordx4 a[168:171], v1, s[4:7], s60 offen offset:0 sc1
  buffer_load_dwordx4 a[172:175], v1, s[4:7], s60 offen offset:1024 sc1
  buffer_load_dwordx4 a[176:179], v1, s[4:7], s60 offen offset:2048 sc1
  buffer_load_dwordx4 a[180:183], v1, s[4:7], s60 offen offset:3072 sc1
  buffer_load_dwordx4 a[184:187], v2, s[4:7], s60 offen offset:0 sc1
  buffer_load_dwordx4 a[188:191], v2, s[4:7], s60 offen offset:1024 sc1
  buffer_load_dwordx4 a[192:195], v2, s[4:7], s60 offen offset:2048 sc1
  buffer_load_dwordx4 a[196:199], v2, s[4:7], s60 offen offset:3072 sc1
  buffer_load_dwordx4 a[200:203], v3, s[4:7], s60 offen offset:0 sc1
  buffer_load_dwordx4 a[204:207], v3, s[4:7], s60 offen offset:1024 sc1
  buffer_load_dwordx4 a[208:211], v3, s[4:7], s60 offen offset:2048 sc1
  buffer_load_dwordx4 a[212:215], v3, s[4:7], s60 offen offset:3072 sc1
  s_waitcnt vmcnt(5)
  v_mfma_f32_16x16x32_bf16 v[128:131], a[216:219], a[168:171], v[84:87]
  v_mfma_f32_16x16x32_bf16 v[132:135], a[120:123], a[168:171], v[88:91]
  v_mfma_f32_16x16x32_bf16 v[136:139], a[216:219], a[192:195], v[84:87]
  v_mfma_f32_16x16x32_bf16 v[140:143], a[120:123], a[192:195], 0
  v_mfma_f32_16x16x32_bf16 v[144:147], a[144:147], a[192:195], v[88:91]
  s_waitcnt vmcnt(4)
  v_mfma_f32_16x16x32_bf16 v[128:131], a[220:223], a[172:175], v[128:131]
  v_mfma_f32_16x16x32_bf16 v[132:135], a[124:127], a[172:175], v[132:135]
  v_mfma_f32_16x16x32_bf16 v[136:139], a[220:223], a[196:199], v[136:139]
  v_mfma_f32_16x16x32_bf16 v[140:143], a[124:127], a[196:199], v[140:143]
  v_mfma_f32_16x16x32_bf16 v[144:147], a[148:151], a[196:199], v[144:147]
  s_waitcnt vmcnt(3)
  v_mfma_f32_16x16x32_bf16 v[128:131], a[224:227], a[176:179], v[128:131]
  v_mfma_f32_16x16x32_bf16 v[132:135], a[128:131], a[176:179], v[132:135]
  v_mfma_f32_16x16x32_bf16 v[136:139], a[224:227], a[200:203], v[136:139]
  v_mfma_f32_16x16x32_bf16 v[140:143], a[128:131], a[200:203], v[140:143]
  v_mfma_f32_16x16x32_bf16 v[144:147], a[152:155], a[200:203], v[144:147]
  s_waitcnt vmcnt(2)
  v_mfma_f32_16x16x32_bf16 v[128:131], a[228:231], a[180:183], v[128:131]
  v_mfma_f32_16x16x32_bf16 v[132:135], a[132:135], a[180:183], v[132:135]
  v_mfma_f32_16x16x32_bf16 v[136:139], a[228:231], a[204:207], v[136:139]
  v_mfma_f32_16x16x32_bf16 v[140:143], a[132:135], a[204:207], v[140:143]
  v_mfma_f32_16x16x32_bf16 v[144:147], a[156:159], a[204:207], v[144:147]
  s_waitcnt vmcnt(1)
  v_mfma_f32_16x16x32_bf16 v[128:131], a[232:235], a[184:187], v[128:131]
  v_mfma_f32_16x16x32_bf16 v[132:135], a[136:139], a[184:187], v[132:135]
  v_mfma_f32_16x16x32_bf16 v[136:139], a[232:235], a[208:211], v[136:139]
  v_mfma_f32_16x16x32_bf16 v[140:143], a[136:139], a[208:211], v[140:143]
  v_mfma_f32_16x16x32_bf16 v[144:147], a[160:163], a[208:211], v[144:147]
  s_waitcnt vmcnt(0)
  v_mfma_f32_16x16x32_bf16 v[128:131], a[236:239], a[188:191], v[128:131]
  v_mfma_f32_16x16x32_bf16 v[132:135], a[140:143], a[188:191], v[132:135]
  v_mfma_f32_16x16x32_bf16 v[136:139], a[236:239], a[212:215], v[136:139]
  v_mfma_f32_16x16x32_bf16 v[140:143], a[140:143], a[212:215], v[140:143]
  v_mfma_f32_16x16x32_bf16 v[144:147], a[164:167], a[212:215], v[144:147]
  s_nop 3
  v_max3_f32 v28, v128, v129, v130
  v_max3_f32 v28, v28, v131, v132
  v_max3_f32 v28, v28, v133, v134
  v_max_f32 v28, v28, v135
  v_mov_b32 v29, v28
  s_nop 1
  v_permlane32_swap_b32 v28, v29
  v_max_f32 v28, v28, v29
  v_mov_b32 v29, v28
  s_nop 1
  v_permlane16_swap_b32 v28, v29
  v_max_f32 v28, v28, v29
  v_mul_f32 v28, s41, v28
  v_fma_f32 v128, v128, s41, -v28
  v_fma_f32 v129, v129, s41, -v28
  v_fma_f32 v130, v130, s41, -v28
  v_fma_f32 v131, v131, s41, -v28
  v_fma_f32 v132, v132, s41, -v28
  v_fma_f32 v133, v133, s41, -v28
  v_fma_f32 v134, v134, s41, -v28
  v_fma_f32 v135, v135, s41, -v28
  v_exp_f32 v128, v128
  v_exp_f32 v129, v129
  v_exp_f32 v130, v130
  v_exp_f32 v131, v131
  v_exp_f32 v132, v132
  v_exp_f32 v133, v133
  v_exp_f32 v134, v134
  v_exp_f32 v135, v135
  v_max3_f32 v30, v136, v137, v138
  v_max3_f32 v30, v30, v139, v140
  v_max3_f32 v30, v30, v141, v142
  v_max3_f32 v30, v30, v143, v144
  v_max3_f32 v30, v30, v145, v146
  v_max_f32 v30, v30, v147
  v_mov_b32 v29, v30
  s_nop 1
  v_permlane32_swap_b32 v30, v29
  v_max_f32 v30, v30, v29
  v_mov_b32 v29, v30
  s_nop 1
  v_permlane16_swap_b32 v30, v29
  v_max_f32 v30, v30, v29
  v_mul_f32 v30, s41, v30
  v_fma_f32 v136, v136, s41, -v30
  v_fma_f32 v137, v137, s41, -v30
  v_fma_f32 v138, v138, s41, -v30
  v_fma_f32 v139, v139, s41, -v30
  v_fma_f32 v140, v140, s41, -v30
  v_fma_f32 v141, v141, s41, -v30
  v_fma_f32 v142, v142, s41, -v30
  v_fma_f32 v143, v143, s41, -v30
  v_fma_f32 v144, v144, s41, -v30
  v_fma_f32 v145, v145, s41, -v30
  v_fma_f32 v146, v146, s41, -v30
  v_fma_f32 v147, v147, s41, -v30
  v_exp_f32 v136, v136
  v_exp_f32 v137, v137
  v_exp_f32 v138, v138
  v_exp_f32 v139, v139
  v_exp_f32 v140, v140
  v_exp_f32 v141, v141
  v_exp_f32 v142, v142
  v_exp_f32 v143, v143
  v_exp_f32 v144, v144
  v_exp_f32 v145, v145
  v_exp_f32 v146, v146
  v_exp_f32 v147, v147
  v_cvt_pk_bf16_f32 v72, v128, v129
  v_cvt_pk_bf16_f32 v73, v130, v131
  v_cvt_pk_bf16_f32 v74, v132, v133
  v_cvt_pk_bf16_f32 v75, v134, v135
  v_cvt_pk_bf16_f32 v76, v136, v137
  v_cvt_pk_bf16_f32 v77, v138, v139
  v_cvt_pk_bf16_f32 v78, v140, v141
  v_cvt_pk_bf16_f32 v79, v142, v143
  v_cvt_pk_bf16_f32 v80, v144, v145
  v_cvt_pk_bf16_f32 v81, v146, v147
  v_mfma_f32_16x16x16_bf16 v[148:151], v[36:37], v[72:73], 0
  v_mfma_f32_16x16x16_bf16 v[152:155], v[36:37], v[76:77], 0
  v_mfma_f32_16x16x16_bf16 v[148:151], v[36:37], v[74:75], v[148:151]
  v_mfma_f32_16x16x32_bf16 v[152:155], v[36:39], v[78:81], v[152:155]
  s_nop 6
  v_rcp_f32 v82, v148
  v_rcp_f32 v83, v152
  s_and_b32 s34, s17, 1
  s_mul_i32 s34, s34, 3072
  v_add_u32 v28, s34, v1
  ds_write_b128 v28, v[72:75] offset:16384
  ds_write_b128 v28, v[76:79] offset:17408
  ds_write_b128 v28, v[80:83] offset:18432
  s_waitcnt lgkmcnt(0)
  s_branch reca_b5101
reca_tw1102:
  s_cmp_lt_u32 s17, 3
  s_cbranch_scc1 reca_b5101
  s_sub_u32 s36, s17, 3
  s_and_b32 s37, s36, 7
  s_lshl_b32 s34, s59, 3
  s_add_u32 s34, s34, s37
  s_mul_i32 s34, s34, 12288
  s_add_u32 s23, s34, 40894464
  s_lshl_b32 s35, s37, 5
  s_add_u32 s35, s35, s59
  s_mul_i32 s35, s35, 3072
  s_add_u32 s61, s35, 47972352
  s_mul_i32 s34, s36, 393216
  s_mul_i32 s35, s59, 6144
  s_add_u32 s34, s34, s35
  s_add_u32 s60, s34, 57147392
  s_add_u32 s34, s17, 1
  s_and_b32 s34, s34, 1
  s_mul_i32 s34, s34, 3072
  v_add_u32 v28, s34, v1
  ds_read_b128 v[72:75], v28 offset:16384
  ds_read_b128 v[76:79], v28 offset:17408
  ds_read_b128 v[80:83], v28 offset:18432
  buffer_load_dwordx2 a[168:169], v93, s[4:7], s61 offen offset:0 sc1
  buffer_load_dwordx4 a[120:123], v1, s[4:7], s23 offen offset:0 sc1
  buffer_load_dwordx2 a[170:171], v93, s[4:7], s61 offen offset:256 sc1
  buffer_load_dwordx4 a[124:127], v1, s[4:7], s23 offen offset:1024 sc1
  buffer_load_dwordx2 a[172:173], v93, s[4:7], s61 offen offset:512 sc1
  buffer_load_dwordx4 a[128:131], v1, s[4:7], s23 offen offset:2048 sc1
  buffer_load_dwordx2 a[174:175], v93, s[4:7], s61 offen offset:768 sc1
  buffer_load_dwordx4 a[132:135], v1, s[4:7], s23 offen offset:3072 sc1
  buffer_load_dwordx2 a[176:177], v93, s[4:7], s61 offen offset:1024 sc1
  buffer_load_dwordx4 a[136:139], v2, s[4:7], s23 offen offset:0 sc1
  buffer_load_dwordx2 a[178:179], v93, s[4:7], s61 offen offset:1280 sc1
  buffer_load_dwordx4 a[140:143], v2, s[4:7], s23 offen offset:1024 sc1
  s_waitcnt lgkmcnt(0)
  s_waitcnt vmcnt(8)
  v_mfma_f32_16x16x16_bf16 v[156:159], a[168:169], v[72:73], 0
  v_mfma_f32_16x16x16_bf16 v[160:163], a[168:169], v[76:77], 0
  v_mfma_f32_16x16x16_bf16 v[156:159], a[120:121], v[74:75], v[156:159]
  v_mfma_f32_16x16x32_bf16 v[160:163], a[120:123], v[78:81], v[160:163]
  v_mfma_f32_16x16x16_bf16 v[164:167], a[170:171], v[72:73], 0
  v_mfma_f32_16x16x16_bf16 v[168:171], a[170:171], v[76:77], 0
  v_mfma_f32_16x16x16_bf16 v[164:167], a[124:125], v[74:75], v[164:167]
  v_mfma_f32_16x16x32_bf16 v[168:171], a[124:127], v[78:81], v[168:171]
  s_nop 2
  v_mul_f32 v156, v156, v82
  v_mul_f32 v157, v157, v82
  v_mul_f32 v158, v158, v82
  v_mul_f32 v159, v159, v82
  v_cvt_pk_bf16_f32 v172, v156, v157
  v_cvt_pk_bf16_f32 v173, v158, v159
  v_mul_f32 v164, v164, v82
  v_mul_f32 v165, v165, v82
  v_mul_f32 v166, v166, v82
  v_mul_f32 v167, v167, v82
  v_cvt_pk_bf16_f32 v174, v164, v165
  v_cvt_pk_bf16_f32 v175, v166, v167
  buffer_store_dwordx4 v[172:175], v1, s[4:7], s60 offen offset:0 sc1
  v_mul_f32 v160, v160, v83
  v_mul_f32 v161, v161, v83
  v_mul_f32 v162, v162, v83
  v_mul_f32 v163, v163, v83
  v_cvt_pk_bf16_f32 v176, v160, v161
  v_cvt_pk_bf16_f32 v177, v162, v163
  v_mul_f32 v168, v168, v83
  v_mul_f32 v169, v169, v83
  v_mul_f32 v170, v170, v83
  v_mul_f32 v171, v171, v83
  v_cvt_pk_bf16_f32 v178, v168, v169
  v_cvt_pk_bf16_f32 v179, v170, v171
  s_add_u32 s34, s60, 196608
  buffer_store_dwordx4 v[176:179], v1, s[4:7], s34 offen offset:0 sc1
  s_waitcnt vmcnt(6)
  v_mfma_f32_16x16x16_bf16 v[156:159], a[172:173], v[72:73], 0
  v_mfma_f32_16x16x16_bf16 v[160:163], a[172:173], v[76:77], 0
  v_mfma_f32_16x16x16_bf16 v[156:159], a[128:129], v[74:75], v[156:159]
  v_mfma_f32_16x16x32_bf16 v[160:163], a[128:131], v[78:81], v[160:163]
  v_mfma_f32_16x16x16_bf16 v[164:167], a[174:175], v[72:73], 0
  v_mfma_f32_16x16x16_bf16 v[168:171], a[174:175], v[76:77], 0
  v_mfma_f32_16x16x16_bf16 v[164:167], a[132:133], v[74:75], v[164:167]
  v_mfma_f32_16x16x32_bf16 v[168:171], a[132:135], v[78:81], v[168:171]
  s_nop 2
  v_mul_f32 v156, v156, v82
  v_mul_f32 v157, v157, v82
  v_mul_f32 v158, v158, v82
  v_mul_f32 v159, v159, v82
  v_cvt_pk_bf16_f32 v172, v156, v157
  v_cvt_pk_bf16_f32 v173, v158, v159
  v_mul_f32 v164, v164, v82
  v_mul_f32 v165, v165, v82
  v_mul_f32 v166, v166, v82
  v_mul_f32 v167, v167, v82
  v_cvt_pk_bf16_f32 v174, v164, v165
  v_cvt_pk_bf16_f32 v175, v166, v167
  buffer_store_dwordx4 v[172:175], v1, s[4:7], s60 offen offset:1024 sc1
  v_mul_f32 v160, v160, v83
  v_mul_f32 v161, v161, v83
  v_mul_f32 v162, v162, v83
  v_mul_f32 v163, v163, v83
  v_cvt_pk_bf16_f32 v176, v160, v161
  v_cvt_pk_bf16_f32 v177, v162, v163
  v_mul_f32 v168, v168, v83
  v_mul_f32 v169, v169, v83
  v_mul_f32 v170, v170, v83
  v_mul_f32 v171, v171, v83
  v_cvt_pk_bf16_f32 v178, v168, v169
  v_cvt_pk_bf16_f32 v179, v170, v171
  s_add_u32 s34, s60, 196608
  buffer_store_dwordx4 v[176:179], v1, s[4:7], s34 offen offset:1024 sc1
  s_waitcnt vmcnt(4)
  v_mfma_f32_16x16x16_bf16 v[156:159], a[176:177], v[72:73], 0
  v_mfma_f32_16x16x16_bf16 v[160:163], a[176:177], v[76:77], 0
  v_mfma_f32_16x16x16_bf16 v[156:159], a[136:137], v[74:75], v[156:159]
  v_mfma_f32_16x16x32_bf16 v[160:163], a[136:139], v[78:81], v[160:163]
  v_mfma_f32_16x16x16_bf16 v[164:167], a[178:179], v[72:73], 0
  v_mfma_f32_16x16x16_bf16 v[168:171], a[178:179], v[76:77], 0
  v_mfma_f32_16x16x16_bf16 v[164:167], a[140:141], v[74:75], v[164:167]
  v_mfma_f32_16x16x32_bf16 v[168:171], a[140:143], v[78:81], v[168:171]
  s_nop 2
  v_mul_f32 v156, v156, v82
  v_mul_f32 v157, v157, v82
  v_mul_f32 v158, v158, v82
  v_mul_f32 v159, v159, v82
  v_cvt_pk_bf16_f32 v172, v156, v157
  v_cvt_pk_bf16_f32 v173, v158, v159
  v_mul_f32 v164, v164, v82
  v_mul_f32 v165, v165, v82
  v_mul_f32 v166, v166, v82
  v_mul_f32 v167, v167, v82
  v_cvt_pk_bf16_f32 v174, v164, v165
  v_cvt_pk_bf16_f32 v175, v166, v167
  buffer_store_dwordx4 v[172:175], v1, s[4:7], s60 offen offset:2048 sc1
  v_mul_f32 v160, v160, v83
  v_mul_f32 v161, v161, v83
  v_mul_f32 v162, v162, v83
  v_mul_f32 v163, v163, v83
  v_cvt_pk_bf16_f32 v176, v160, v161
  v_cvt_pk_bf16_f32 v177, v162, v163
  v_mul_f32 v168, v168, v83
  v_mul_f32 v169, v169, v83
  v_mul_f32 v170, v170, v83
  v_mul_f32 v171, v171, v83
  v_cvt_pk_bf16_f32 v178, v168, v169
  v_cvt_pk_bf16_f32 v179, v170, v171
  s_add_u32 s34, s60, 196608
  buffer_store_dwordx4 v[176:179], v1, s[4:7], s34 offen offset:2048 sc1
  s_branch reca_b5101
reca_tw2103:
  s_cmp_lt_u32 s17, 3
  s_cbranch_scc1 reca_b5101
  s_sub_u32 s36, s17, 3
  s_and_b32 s37, s36, 7
  s_lshl_b32 s34, s59, 3
  s_add_u32 s34, s34, s37
  s_mul_i32 s34, s34, 12288
  s_add_u32 s23, s34, 40894464
  s_lshl_b32 s35, s37, 5
  s_add_u32 s35, s35, s59
  s_mul_i32 s35, s35, 3072
  s_add_u32 s61, s35, 47972352
  s_mul_i32 s34, s36, 393216
  s_mul_i32 s35, s59, 6144
  s_add_u32 s34, s34, s35
  s_add_u32 s60, s34, 57147392
  s_add_u32 s34, s17, 1
  s_and_b32 s34, s34, 1
  s_mul_i32 s34, s34, 3072
  v_add_u32 v28, s34, v1
  ds_read_b128 v[72:75], v28 offset:16384
  ds_read_b128 v[76:79], v28 offset:17408
  ds_read_b128 v[80:83], v28 offset:18432
  buffer_load_dwordx2 a[180:181], v93, s[4:7], s61 offen offset:1536 sc1
  buffer_load_dwordx4 a[144:147], v2, s[4:7], s23 offen offset:2048 sc1
  buffer_load_dwordx2 a[182:183], v93, s[4:7], s61 offen offset:1792 sc1
  buffer_load_dwordx4 a[148:151], v2, s[4:7], s23 offen offset:3072 sc1
  buffer_load_dwordx2 a[184:185], v93, s[4:7], s61 offen offset:2048 sc1
  buffer_load_dwordx4 a[152:155], v3, s[4:7], s23 offen offset:0 sc1
  buffer_load_dwordx2 a[186:187], v93, s[4:7], s61 offen offset:2304 sc1
  buffer_load_dwordx4 a[156:159], v3, s[4:7], s23 offen offset:1024 sc1
  buffer_load_dwordx2 a[188:189], v93, s[4:7], s61 offen offset:2560 sc1
  buffer_load_dwordx4 a[160:163], v3, s[4:7], s23 offen offset:2048 sc1
  buffer_load_dwordx2 a[190:191], v93, s[4:7], s61 offen offset:2816 sc1
  buffer_load_dwordx4 a[164:167], v3, s[4:7], s23 offen offset:3072 sc1
  s_waitcnt lgkmcnt(0)
  s_waitcnt vmcnt(8)
  v_mfma_f32_16x16x16_bf16 v[156:159], a[180:181], v[72:73], 0
  v_mfma_f32_16x16x16_bf16 v[160:163], a[180:181], v[76:77], 0
  v_mfma_f32_16x16x16_bf16 v[156:159], a[144:145], v[74:75], v[156:159]
  v_mfma_f32_16x16x32_bf16 v[160:163], a[144:147], v[78:81], v[160:163]
  v_mfma_f32_16x16x16_bf16 v[164:167], a[182:183], v[72:73], 0
  v_mfma_f32_16x16x16_bf16 v[168:171], a[182:183], v[76:77], 0
  v_mfma_f32_16x16x16_bf16 v[164:167], a[148:149], v[74:75], v[164:167]
  v_mfma_f32_16x16x32_bf16 v[168:171], a[148:151], v[78:81], v[168:171]
  s_nop 2
  v_mul_f32 v156, v156, v82
  v_mul_f32 v157, v157, v82
  v_mul_f32 v158, v158, v82
  v_mul_f32 v159, v159, v82
  v_cvt_pk_bf16_f32 v172, v156, v157
  v_cvt_pk_bf16_f32 v173, v158, v159
  v_mul_f32 v164, v164, v82
  v_mul_f32 v165, v165, v82
  v_mul_f32 v166, v166, v82
  v_mul_f32 v167, v167, v82
  v_cvt_pk_bf16_f32 v174, v164, v165
  v_cvt_pk_bf16_f32 v175, v166, v167
  buffer_store_dwordx4 v[172:175], v1, s[4:7], s60 offen offset:3072 sc1
  v_mul_f32 v160, v160, v83
  v_mul_f32 v161, v161, v83
  v_mul_f32 v162, v162, v83
  v_mul_f32 v163, v163, v83
  v_cvt_pk_bf16_f32 v176, v160, v161
  v_cvt_pk_bf16_f32 v177, v162, v163
  v_mul_f32 v168, v168, v83
  v_mul_f32 v169, v169, v83
  v_mul_f32 v170, v170, v83
  v_mul_f32 v171, v171, v83
  v_cvt_pk_bf16_f32 v178, v168, v169
  v_cvt_pk_bf16_f32 v179, v170, v171
  s_add_u32 s34, s60, 196608
  buffer_store_dwordx4 v[176:179], v1, s[4:7], s34 offen offset:3072 sc1
  s_waitcnt vmcnt(6)
  v_mfma_f32_16x16x16_bf16 v[156:159], a[184:185], v[72:73], 0
  v_mfma_f32_16x16x16_bf16 v[160:163], a[184:185], v[76:77], 0
  v_mfma_f32_16x16x16_bf16 v[156:159], a[152:153], v[74:75], v[156:159]
  v_mfma_f32_16x16x32_bf16 v[160:163], a[152:155], v[78:81], v[160:163]
  v_mfma_f32_16x16x16_bf16 v[164:167], a[186:187], v[72:73], 0
  v_mfma_f32_16x16x16_bf16 v[168:171], a[186:187], v[76:77], 0
  v_mfma_f32_16x16x16_bf16 v[164:167], a[156:157], v[74:75], v[164:167]
  v_mfma_f32_16x16x32_bf16 v[168:171], a[156:159], v[78:81], v[168:171]
  s_nop 2
  v_mul_f32 v156, v156, v82
  v_mul_f32 v157, v157, v82
  v_mul_f32 v158, v158, v82
  v_mul_f32 v159, v159, v82
  v_cvt_pk_bf16_f32 v172, v156, v157
  v_cvt_pk_bf16_f32 v173, v158, v159
  v_mul_f32 v164, v164, v82
  v_mul_f32 v165, v165, v82
  v_mul_f32 v166, v166, v82
  v_mul_f32 v167, v167, v82
  v_cvt_pk_bf16_f32 v174, v164, v165
  v_cvt_pk_bf16_f32 v175, v166, v167
  buffer_store_dwordx4 v[172:175], v2, s[4:7], s60 offen offset:0 sc1
  v_mul_f32 v160, v160, v83
  v_mul_f32 v161, v161, v83
  v_mul_f32 v162, v162, v83
  v_mul_f32 v163, v163, v83
  v_cvt_pk_bf16_f32 v176, v160, v161
  v_cvt_pk_bf16_f32 v177, v162, v163
  v_mul_f32 v168, v168, v83
  v_mul_f32 v169, v169, v83
  v_mul_f32 v170, v170, v83
  v_mul_f32 v171, v171, v83
  v_cvt_pk_bf16_f32 v178, v168, v169
  v_cvt_pk_bf16_f32 v179, v170, v171
  s_add_u32 s34, s60, 196608
  buffer_store_dwordx4 v[176:179], v2, s[4:7], s34 offen offset:0 sc1
  s_waitcnt vmcnt(4)
  v_mfma_f32_16x16x16_bf16 v[156:159], a[188:189], v[72:73], 0
  v_mfma_f32_16x16x16_bf16 v[160:163], a[188:189], v[76:77], 0
  v_mfma_f32_16x16x16_bf16 v[156:159], a[160:161], v[74:75], v[156:159]
  v_mfma_f32_16x16x32_bf16 v[160:163], a[160:163], v[78:81], v[160:163]
  v_mfma_f32_16x16x16_bf16 v[164:167], a[190:191], v[72:73], 0
  v_mfma_f32_16x16x16_bf16 v[168:171], a[190:191], v[76:77], 0
  v_mfma_f32_16x16x16_bf16 v[164:167], a[164:165], v[74:75], v[164:167]
  v_mfma_f32_16x16x32_bf16 v[168:171], a[164:167], v[78:81], v[168:171]
  s_nop 2
  v_mul_f32 v156, v156, v82
  v_mul_f32 v157, v157, v82
  v_mul_f32 v158, v158, v82
  v_mul_f32 v159, v159, v82
  v_cvt_pk_bf16_f32 v172, v156, v157
  v_cvt_pk_bf16_f32 v173, v158, v159
  v_mul_f32 v164, v164, v82
  v_mul_f32 v165, v165, v82
  v_mul_f32 v166, v166, v82
  v_mul_f32 v167, v167, v82
  v_cvt_pk_bf16_f32 v174, v164, v165
  v_cvt_pk_bf16_f32 v175, v166, v167
  buffer_store_dwordx4 v[172:175], v2, s[4:7], s60 offen offset:1024 sc1
  v_mul_f32 v160, v160, v83
  v_mul_f32 v161, v161, v83
  v_mul_f32 v162, v162, v83
  v_mul_f32 v163, v163, v83
  v_cvt_pk_bf16_f32 v176, v160, v161
  v_cvt_pk_bf16_f32 v177, v162, v163
  v_mul_f32 v168, v168, v83
  v_mul_f32 v169, v169, v83
  v_mul_f32 v170, v170, v83
  v_mul_f32 v171, v171, v83
  v_cvt_pk_bf16_f32 v178, v168, v169
  v_cvt_pk_bf16_f32 v179, v170, v171
  s_add_u32 s34, s60, 196608
  buffer_store_dwordx4 v[176:179], v2, s[4:7], s34 offen offset:1024 sc1
  s_branch reca_b5101
  s_cmp_lg_u32 s12, 2
  s_cbranch_scc1 reca_b399
  buffer_store_dwordx2 v[52:53], v9, s[4:7], s30 offen
  buffer_store_dwordx2 v[32:33], v16, s[4:7], s26 offen
  s_cmp_lg_u32 s14, 0
  s_cbranch_scc1 reca_b399
  v_mov_b32 v28, s17
  s_lshl_b32 s34, s13, 7
  s_add_u32 s34, s34, 1507328
  buffer_store_dword v28, v19, s[4:7], s34 offen
  s_branch reca_b399
reca_last98:
  s_cmp_lg_u32 s12, 2
  s_cbranch_scc1 reca_exit1
  buffer_store_dwordx2 v[52:53], v9, s[4:7], s30 offen
  s_branch reca_exit1
reca_swave96:
  s_cmp_lg_u32 s17, 63
  s_cbranch_scc1 reca_vmst104
  s_barrier
  ds_read_b128 v[56:59], v1 offset:10240
  ds_read_b128 v[60:63], v1 offset:11264
  ds_read_b128 v[64:67], v1 offset:12288
  s_waitcnt lgkmcnt(0)
  v_add_f32 v56, v56, v64
  v_add_f32 v60, v60, v48
  v_add_f32 v57, v57, v65
  v_add_f32 v61, v61, v49
  v_add_f32 v58, v58, v66
  v_add_f32 v62, v62, v50
  v_add_f32 v59, v59, v67
  v_add_f32 v63, v63, v51
  v_cvt_pk_bf16_f32 v68, v56, v57
  v_cvt_pk_bf16_f32 v69, v58, v59
  v_cvt_pk_bf16_f32 v70, v60, v61
  v_cvt_pk_bf16_f32 v71, v62, v63
  buffer_store_dwordx2 v[52:53], v9, s[4:7], s30 offen
  buffer_store_dwordx2 v[68:69], v10, s[4:7], s31 offen
  buffer_store_dwordx2 v[70:71], v10, s[4:7], s31 offen offset:256
  s_branch reca_exit1
reca_vmst104:
  s_sleep 1
  buffer_load_dwordx4 v[208:211], v1, s[4:7], s21 offen offset:0 sc1
  buffer_load_dwordx4 v[212:215], v1, s[4:7], s21 offen offset:1024 sc1
  buffer_load_dwordx4 v[216:219], v1, s[4:7], s21 offen offset:2048 sc1
  buffer_load_dwordx4 v[220:223], v1, s[4:7], s21 offen offset:3072 sc1
  buffer_load_dwordx4 v[224:227], v2, s[4:7], s21 offen offset:0 sc1
  buffer_load_dwordx4 v[228:231], v2, s[4:7], s21 offen offset:1024 sc1
  s_waitcnt vmcnt(5)
  v_max_u32 v29, v208, v210
  v_cmp_eq_u32 vcc, -1, v29
  s_cbranch_vccnz reca_retry105
reca_resume106:
  s_waitcnt vmcnt(4)
  v_max_u32 v29, v212, v214
  v_cmp_eq_u32 vcc, -1, v29
  v_mfma_f32_16x16x32_bf16 v[76:79], a[120:123], v[208:211], 0
  v_mfma_f32_16x16x32_bf16 v[80:83], a[144:147], v[208:211], 0
  v_mfma_f32_16x16x32_bf16 v[72:75], v[208:211], v[208:211], v[40:43]
  s_cbranch_vccnz reca_retry107
reca_resume108:
  s_waitcnt vmcnt(3)
  v_max_u32 v29, v216, v218
  v_cmp_eq_u32 vcc, -1, v29
  v_mfma_f32_16x16x32_bf16 v[76:79], a[124:127], v[212:215], v[76:79]
  v_mfma_f32_16x16x32_bf16 v[80:83], a[148:151], v[212:215], v[80:83]
  v_mfma_f32_16x16x32_bf16 v[72:75], v[212:215], v[212:215], v[72:75]
  s_cbranch_vccnz reca_retry109
reca_resume110:
  s_waitcnt vmcnt(2)
  v_max_u32 v29, v220, v222
  v_cmp_eq_u32 vcc, -1, v29
  v_mfma_f32_16x16x32_bf16 v[76:79], a[128:131], v[216:219], v[76:79]
  v_mfma_f32_16x16x32_bf16 v[80:83], a[152:155], v[216:219], v[80:83]
  v_mfma_f32_16x16x32_bf16 v[72:75], v[216:219], v[216:219], v[72:75]
  s_cbranch_vccnz reca_retry111
reca_resume112:
  s_waitcnt vmcnt(1)
  v_max_u32 v29, v224, v226
  v_cmp_eq_u32 vcc, -1, v29
  v_mfma_f32_16x16x32_bf16 v[76:79], a[132:135], v[220:223], v[76:79]
  v_mfma_f32_16x16x32_bf16 v[80:83], a[156:159], v[220:223], v[80:83]
  v_mfma_f32_16x16x32_bf16 v[72:75], v[220:223], v[220:223], v[72:75]
  s_cbranch_vccnz reca_retry113
reca_resume114:
  s_waitcnt vmcnt(0)
  v_max_u32 v29, v228, v230
  v_cmp_eq_u32 vcc, -1, v29
  v_mfma_f32_16x16x32_bf16 v[76:79], a[136:139], v[224:227], v[76:79]
  v_mfma_f32_16x16x32_bf16 v[80:83], a[160:163], v[224:227], v[80:83]
  v_mfma_f32_16x16x32_bf16 v[72:75], v[224:227], v[224:227], v[72:75]
  s_cbranch_vccnz reca_retry115
reca_resume116:
  v_mfma_f32_16x16x32_bf16 v[76:79], a[140:143], v[228:231], v[76:79]
  v_mfma_f32_16x16x32_bf16 v[80:83], a[164:167], v[228:231], v[80:83]
  v_mfma_f32_16x16x32_bf16 v[72:75], v[228:231], v[228:231], v[72:75]
  s_barrier
  ds_read_b128 v[56:59], v1 offset:10240
  ds_read_b128 v[60:63], v1 offset:11264
  ds_read_b128 v[64:67], v1 offset:12288
  s_nop 1
  v_max3_f32 v28, v76, v77, v78
  v_max3_f32 v29, v80, v81, v82
  v_max3_f32 v28, v28, v79, v83
  v_max3_f32 v29, v29, v72, v73
  v_max3_f32 v28, v28, v74, v75
  v_max_f32 v28, v28, v29
  v_mov_b32 v29, v28
  s_nop 1
  v_permlane32_swap_b32 v28, v29
  v_max_f32 v28, v28, v29
  v_mov_b32 v29, v28
  s_nop 1
  v_permlane16_swap_b32 v28, v29
  v_max_f32 v28, v28, v29
  v_mul_f32 v28, s41, v28
  v_fma_f32 v76, v76, s41, -v28
  v_fma_f32 v77, v77, s41, -v28
  v_fma_f32 v78, v78, s41, -v28
  v_fma_f32 v79, v79, s41, -v28
  v_fma_f32 v80, v80, s41, -v28
  v_fma_f32 v81, v81, s41, -v28
  v_fma_f32 v82, v82, s41, -v28
  v_fma_f32 v83, v83, s41, -v28
  v_fma_f32 v72, v72, s41, -v28
  v_fma_f32 v73, v73, s41, -v28
  v_fma_f32 v74, v74, s41, -v28
  v_fma_f32 v75, v75, s41, -v28
  v_exp_f32 v76, v76
  v_exp_f32 v77, v77
  v_exp_f32 v78, v78
  v_exp_f32 v79, v79
  v_exp_f32 v80, v80
  v_exp_f32 v81, v81
  v_exp_f32 v82, v82
  v_exp_f32 v83, v83
  v_cvt_pk_bf16_f32 v84, v76, v77
  v_cvt_pk_bf16_f32 v85, v78, v79
  v_cvt_pk_bf16_f32 v86, v80, v81
  v_cvt_pk_bf16_f32 v87, v82, v83
  v_exp_f32 v72, v72
  v_exp_f32 v73, v73
  v_mfma_f32_16x16x32_bf16 v[100:103], v[36:39], v[84:87], 0
  v_exp_f32 v74, v74
  v_exp_f32 v75, v75
  v_mfma_f32_16x16x32_bf16 v[92:95], a[168:171], v[84:87], 0
  v_cvt_pk_bf16_f32 v88, v72, v73
  v_cvt_pk_bf16_f32 v89, v74, v75
  v_mfma_f32_16x16x32_bf16 v[96:99], a[172:175], v[84:87], 0
  s_waitcnt lgkmcnt(0)
  v_mfma_f32_16x16x16_bf16 v[100:103], v[36:37], v[88:89], v[100:103]
  v_add_f32 v56, v56, v64
  v_add_f32 v60, v60, v48
  v_add_f32 v57, v57, v65
  v_add_f32 v61, v61, v49
  v_add_f32 v58, v58, v66
  v_add_f32 v62, v62, v50
  v_add_f32 v59, v59, v67
  v_add_f32 v63, v63, v51
  v_cvt_pk_bf16_f32 v68, v56, v57
  v_cvt_pk_bf16_f32 v69, v58, v59
  v_cvt_pk_bf16_f32 v70, v60, v61
  v_cvt_pk_bf16_f32 v71, v62, v63
  v_mfma_f32_16x16x16_bf16 v[92:95], v[68:69], v[88:89], v[92:95]
  v_rcp_f32 v28, v100
  v_mfma_f32_16x16x16_bf16 v[96:99], v[70:71], v[88:89], v[96:99]
  v_mov_b32 v29, v28
  s_nop 4
  v_pk_mul_f32 v[92:93], v[92:93], v[28:29]
  v_pk_mul_f32 v[94:95], v[94:95], v[28:29]
  v_pk_mul_f32 v[96:97], v[96:97], v[28:29]
  v_pk_mul_f32 v[98:99], v[98:99], v[28:29]
  v_cvt_pk_bf16_f32 v104, v92, v93
  v_cvt_pk_bf16_f32 v105, v94, v95
  v_cvt_pk_bf16_f32 v106, v96, v97
  v_cvt_pk_bf16_f32 v107, v98, v99
  buffer_store_dwordx4 v[104:107], v11, s[4:7], s22 offen
  s_barrier
  s_add_u32 s34, s17, 2
  s_and_b32 s34, s34, 3
  s_mul_i32 s26, s34, 10240
  s_add_u32 s26, s26, s38
  s_mul_i32 s27, s34, 6144
  s_add_u32 s27, s27, s39
  s_mul_i32 s28, s34, 12288
  s_add_u32 s28, s28, s40
  s_mul_i32 s29, s34, 393216
  s_add_u32 s29, s29, s56
  buffer_store_dwordx2 v[32:33], v8, s[4:7], s27 offen
  buffer_store_dwordx4 v[32:35], v11, s[4:7], s28 offen
  s_add_u32 s36, s17, 1
  s_cmp_ge_u32 s36, 63
  s_cbranch_scc1 reca_nopf117
  s_add_u32 s37, s36, 1
reca_pf118:
  buffer_load_dword v28, v233, s[4:7], 0 offen sc1
  s_waitcnt vmcnt(0)
  v_cmp_gt_i32 vcc, s37, v28
  s_cbranch_vccz reca_pfok119
  s_sleep 1
  s_sub_u32 s18, s18, 1
  s_cbranch_scc0 reca_pf118
  s_mov_b32 s18, 0
reca_pfok119:
  s_lshl_b32 s34, s15, 3
  s_and_b32 s35, s36, 7
  s_add_u32 s34, s34, s35
  s_mul_i32 s34, s34, 12288
  s_add_u32 s32, s34, 37748736
  s_lshl_b32 s35, s16, 11
  s_add_u32 s34, s34, s35
  s_add_u32 s33, s34, 40894464
  buffer_load_dwordx4 a[120:123], v1, s[4:7], s32 offen offset:0 sc1
  buffer_load_dwordx4 a[124:127], v1, s[4:7], s32 offen offset:1024 sc1
  buffer_load_dwordx4 a[128:131], v1, s[4:7], s32 offen offset:2048 sc1
  buffer_load_dwordx4 a[132:135], v1, s[4:7], s32 offen offset:3072 sc1
  buffer_load_dwordx4 a[136:139], v2, s[4:7], s32 offen offset:0 sc1
  buffer_load_dwordx4 a[140:143], v2, s[4:7], s32 offen offset:1024 sc1
  buffer_load_dwordx4 a[144:147], v2, s[4:7], s32 offen offset:2048 sc1
  buffer_load_dwordx4 a[148:151], v2, s[4:7], s32 offen offset:3072 sc1
  buffer_load_dwordx4 a[152:155], v3, s[4:7], s32 offen offset:0 sc1
  buffer_load_dwordx4 a[156:159], v3, s[4:7], s32 offen offset:1024 sc1
  buffer_load_dwordx4 a[160:163], v3, s[4:7], s32 offen offset:2048 sc1
  buffer_load_dwordx4 a[164:167], v3, s[4:7], s32 offen offset:3072 sc1
  buffer_load_dwordx4 a[168:171], v1, s[4:7], s33 offen offset:0 sc1
  buffer_load_dwordx4 a[172:175], v1, s[4:7], s33 offen offset:1024 sc1
reca_nopf117:
  buffer_store_dwordx2 v[52:53], v9, s[4:7], s30 offen
  buffer_store_dwordx2 v[68:69], v10, s[4:7], s31 offen
  buffer_store_dwordx2 v[70:71], v10, s[4:7], s31 offen offset:256
reca_b5101:
  s_barrier
  s_add_u32 s17, s17, 1
  s_branch reca_step87
reca_b399:
  s_endpgm
reca_retry90:
  s_sub_u32 s18, s18, 1
  s_cbranch_scc1 reca_retry90_to
  buffer_load_dwordx4 v[128:131], v4, s[4:7], s20 offen sc1
  buffer_load_dwordx4 v[132:135], v4, s[4:7], s20 offen offset:1024 sc1
  buffer_load_dwordx4 v[136:139], v5, s[4:7], s20 offen sc1
  s_waitcnt vmcnt(2)
  v_max_u32 v29, v128, v130
  v_cmp_eq_u32 vcc, -1, v29
  s_cbranch_vccnz reca_retry90
  s_branch reca_resume91
reca_retry90_to:
  s_mov_b32 s18, 0
  s_waitcnt vmcnt(0)
  s_branch reca_resume91
reca_retry92:
  s_sub_u32 s18, s18, 1
  s_cbranch_scc1 reca_retry92_to
  buffer_load_dwordx4 v[132:135], v4, s[4:7], s20 offen offset:1024 sc1
  buffer_load_dwordx4 v[136:139], v5, s[4:7], s20 offen sc1
  s_waitcnt vmcnt(1)
  v_max_u32 v29, v132, v134
  v_cmp_eq_u32 vcc, -1, v29
  s_cbranch_vccnz reca_retry92
  s_branch reca_resume93
reca_retry92_to:
  s_mov_b32 s18, 0
  s_waitcnt vmcnt(0)
  s_branch reca_resume93
reca_retry94:
  s_sub_u32 s18, s18, 1
  s_cbranch_scc1 reca_retry94_to
  buffer_load_dwordx4 v[136:139], v5, s[4:7], s20 offen sc1
  s_waitcnt vmcnt(0)
  v_max_u32 v29, v136, v138
  v_cmp_eq_u32 vcc, -1, v29
  s_cbranch_vccnz reca_retry94
  s_branch reca_resume95
reca_retry94_to:
  s_mov_b32 s18, 0
  s_waitcnt vmcnt(0)
  s_branch reca_resume95
reca_retry105:
  s_sub_u32 s18, s18, 1
  s_cbranch_scc1 reca_retry105_to
  buffer_load_dwordx4 v[208:211], v1, s[4:7], s21 offen offset:0 sc1
  buffer_load_dwordx4 v[212:215], v1, s[4:7], s21 offen offset:1024 sc1
  buffer_load_dwordx4 v[216:219], v1, s[4:7], s21 offen offset:2048 sc1
  buffer_load_dwordx4 v[220:223], v1, s[4:7], s21 offen offset:3072 sc1
  buffer_load_dwordx4 v[224:227], v2, s[4:7], s21 offen offset:0 sc1
  buffer_load_dwordx4 v[228:231], v2, s[4:7], s21 offen offset:1024 sc1
  s_waitcnt vmcnt(5)
  v_max_u32 v29, v208, v210
  v_cmp_eq_u32 vcc, -1, v29
  s_cbranch_vccnz reca_retry105
  s_branch reca_resume106
reca_retry105_to:
  s_mov_b32 s18, 0
  s_waitcnt vmcnt(0)
  s_branch reca_resume106
reca_retry107:
  s_sub_u32 s18, s18, 1
  s_cbranch_scc1 reca_retry107_to
  buffer_load_dwordx4 v[212:215], v1, s[4:7], s21 offen offset:1024 sc1
  buffer_load_dwordx4 v[216:219], v1, s[4:7], s21 offen offset:2048 sc1
  buffer_load_dwordx4 v[220:223], v1, s[4:7], s21 offen offset:3072 sc1
  buffer_load_dwordx4 v[224:227], v2, s[4:7], s21 offen offset:0 sc1
  buffer_load_dwordx4 v[228:231], v2, s[4:7], s21 offen offset:1024 sc1
  s_waitcnt vmcnt(4)
  v_max_u32 v29, v212, v214
  v_cmp_eq_u32 vcc, -1, v29
  s_cbranch_vccnz reca_retry107
  s_branch reca_resume108
reca_retry107_to:
  s_mov_b32 s18, 0
  s_waitcnt vmcnt(0)
  s_branch reca_resume108
reca_retry109:
  s_sub_u32 s18, s18, 1
  s_cbranch_scc1 reca_retry109_to
  buffer_load_dwordx4 v[216:219], v1, s[4:7], s21 offen offset:2048 sc1
  buffer_load_dwordx4 v[220:223], v1, s[4:7], s21 offen offset:3072 sc1
  buffer_load_dwordx4 v[224:227], v2, s[4:7], s21 offen offset:0 sc1
  buffer_load_dwordx4 v[228:231], v2, s[4:7], s21 offen offset:1024 sc1
  s_waitcnt vmcnt(3)
  v_max_u32 v29, v216, v218
  v_cmp_eq_u32 vcc, -1, v29
  s_cbranch_vccnz reca_retry109
  s_branch reca_resume110
reca_retry109_to:
  s_mov_b32 s18, 0
  s_waitcnt vmcnt(0)
  s_branch reca_resume110
reca_retry111:
  s_sub_u32 s18, s18, 1
  s_cbranch_scc1 reca_retry111_to
  buffer_load_dwordx4 v[220:223], v1, s[4:7], s21 offen offset:3072 sc1
  buffer_load_dwordx4 v[224:227], v2, s[4:7], s21 offen offset:0 sc1
  buffer_load_dwordx4 v[228:231], v2, s[4:7], s21 offen offset:1024 sc1
  s_waitcnt vmcnt(2)
  v_max_u32 v29, v220, v222
  v_cmp_eq_u32 vcc, -1, v29
  s_cbranch_vccnz reca_retry111
  s_branch reca_resume112
reca_retry111_to:
  s_mov_b32 s18, 0
  s_waitcnt vmcnt(0)
  s_branch reca_resume112
reca_retry113:
  s_sub_u32 s18, s18, 1
  s_cbranch_scc1 reca_retry113_to
  buffer_load_dwordx4 v[224:227], v2, s[4:7], s21 offen offset:0 sc1
  buffer_load_dwordx4 v[228:231], v2, s[4:7], s21 offen offset:1024 sc1
  s_waitcnt vmcnt(1)
  v_max_u32 v29, v224, v226
  v_cmp_eq_u32 vcc, -1, v29
  s_cbranch_vccnz reca_retry113
  s_branch reca_resume114
reca_retry113_to:
  s_mov_b32 s18, 0
  s_waitcnt vmcnt(0)
  s_branch reca_resume114
reca_retry115:
  s_sub_u32 s18, s18, 1
  s_cbranch_scc1 reca_retry115_to
  buffer_load_dwordx4 v[228:231], v2, s[4:7], s21 offen offset:1024 sc1
  s_waitcnt vmcnt(0)
  v_max_u32 v29, v228, v230
  v_cmp_eq_u32 vcc, -1, v29
  s_cbranch_vccnz reca_retry115
  s_branch reca_resume116
reca_retry115_to:
  s_mov_b32 s18, 0
  s_waitcnt vmcnt(0)
  s_branch reca_resume116
reca_slow11:
  s_cmp_ge_u32 s14, 20
  s_cbranch_scc1 reca_twins13
  s_branch reca_gotmem121
reca_step120:
  s_and_b32 s34, s17, 3
  s_mul_i32 s20, s34, 10240
  s_add_u32 s20, s20, s38
  s_sleep 2
  buffer_load_dwordx4 v[128:131], v4, s[4:7], s20 offen sc1
  buffer_load_dwordx4 v[132:135], v4, s[4:7], s20 offen offset:1024 sc1
  buffer_load_dwordx4 v[136:139], v5, s[4:7], s20 offen sc1
  s_waitcnt vmcnt(2)
  v_max_u32 v29, v128, v130
  v_cmp_eq_u32 vcc, -1, v29
  s_cbranch_vccnz reca_retry123
reca_resume124:
  s_waitcnt vmcnt(1)
  v_max_u32 v29, v132, v134
  v_cmp_eq_u32 vcc, -1, v29
  ds_write_b128 v4, v[128:131]
  s_cbranch_vccnz reca_retry125
reca_resume126:
  s_waitcnt vmcnt(0)
  v_max_u32 v29, v136, v138
  v_cmp_eq_u32 vcc, -1, v29
  ds_write_b128 v4, v[132:135] offset:1024
  s_cbranch_vccnz reca_retry127
reca_resume128:
  ds_write_b128 v5, v[136:139]
  s_branch reca_gotmem2122
reca_gotmem121:
  ds_write_b128 v4, v[128:131]
  ds_write_b128 v4, v[132:135] offset:1024
  ds_write_b128 v5, v[136:139]
reca_gotmem2122:
  s_and_b32 s34, s17, 3
  s_mul_i32 s21, s34, 6144
  s_add_u32 s21, s21, s39
  s_mul_i32 s22, s34, 12288
  s_add_u32 s22, s22, s40
  s_mul_i32 s25, s34, 393216
  s_add_u32 s25, s25, s56
  s_add_u32 s35, s17, 1
  s_and_b32 s35, s35, 3
  s_mul_i32 s24, s35, 10240
  s_add_u32 s24, s24, s38
  s_waitcnt lgkmcnt(0)
  s_barrier
  ds_read_b128 v[128:131], v236 offset:0
  ds_read_b128 v[132:135], v236 offset:1024
  ds_read_b128 v[136:139], v236 offset:2048
  ds_read_b128 v[140:143], v236 offset:3072
  ds_read_b128 v[144:147], v236 offset:4096
  ds_read_b128 v[148:151], v237 offset:0
  ds_read_b128 v[152:155], v237 offset:1024
  ds_read_b128 v[156:159], v237 offset:2048
  ds_read_b128 v[160:163], v237 offset:3072
  ds_read_b128 v[164:167], v237 offset:4096
  s_waitcnt lgkmcnt(9)
  v_mfma_f32_16x16x32_bf16 v[44:47], a[0:3], v[128:131], 0
  ds_read_b128 v[168:171], v6 offset:0
  v_mfma_f32_16x16x32_bf16 v[240:243], a[4:7], v[128:131], 0
  s_waitcnt lgkmcnt(9)
  v_mfma_f32_16x16x32_bf16 v[44:47], a[8:11], v[132:135], v[44:47]
  ds_read_b128 v[172:175], v6 offset:512
  v_mfma_f32_16x16x32_bf16 v[240:243], a[12:15], v[132:135], v[240:243]
  s_waitcnt lgkmcnt(9)
  v_mfma_f32_16x16x32_bf16 v[44:47], a[16:19], v[136:139], v[44:47]
  ds_read_b128 v[176:179], v6 offset:1024
  v_mfma_f32_16x16x32_bf16 v[240:243], a[20:23], v[136:139], v[240:243]
  s_waitcnt lgkmcnt(9)
  v_mfma_f32_16x16x32_bf16 v[44:47], a[24:27], v[140:143], v[44:47]
  ds_read_b128 v[180:183], v6 offset:1536
  v_mfma_f32_16x16x32_bf16 v[240:243], a[28:31], v[140:143], v[240:243]
  s_waitcnt lgkmcnt(9)
  v_mfma_f32_16x16x32_bf16 v[44:47], a[32:35], v[144:147], v[44:47]
  ds_read_b128 v[184:187], v6 offset:2048
  v_mfma_f32_16x16x32_bf16 v[240:243], a[36:39], v[144:147], v[240:243]
  s_waitcnt lgkmcnt(9)
  v_mfma_f32_16x16x32_bf16 v[44:47], a[40:43], v[148:151], v[44:47]
  ds_read_b128 v[188:191], v6 offset:2560
  v_mfma_f32_16x16x32_bf16 v[240:243], a[44:47], v[148:151], v[240:243]
  s_waitcnt lgkmcnt(9)
  v_mfma_f32_16x16x32_bf16 v[44:47], a[48:51], v[152:155], v[44:47]
  ds_read_b128 v[192:195], v6 offset:3072
  v_mfma_f32_16x16x32_bf16 v[240:243], a[52:55], v[152:155], v[240:243]
  s_waitcnt lgkmcnt(9)
  v_mfma_f32_16x16x32_bf16 v[44:47], a[56:59], v[156:159], v[44:47]
  ds_read_b128 v[196:199], v6 offset:3584
  v_mfma_f32_16x16x32_bf16 v[240:243], a[60:63], v[156:159], v[240:243]
  s_waitcnt lgkmcnt(9)
  v_mfma_f32_16x16x32_bf16 v[44:47], a[64:67], v[160:163], v[44:47]
  ds_read_b128 v[200:203], v6 offset:4096
  v_mfma_f32_16x16x32_bf16 v[240:243], a[68:71], v[160:163], v[240:243]
  s_waitcnt lgkmcnt(9)
  v_mfma_f32_16x16x32_bf16 v[44:47], a[72:75], v[164:167], v[44:47]
  ds_read_b128 v[204:207], v6 offset:4608
  v_mfma_f32_16x16x32_bf16 v[240:243], a[76:79], v[164:167], v[240:243]
  s_waitcnt lgkmcnt(9)
  v_mfma_f32_16x16x32_bf16 v[48:51], v[168:171], a[80:83], 0
  s_and_b32 s34, s17, 7
  s_lshl_b32 s34, s34, 5
  s_add_u32 s34, s34, s15
  s_mul_i32 s34, s34, 3072
  s_lshl_b32 s35, s16, 9
  s_add_u32 s34, s34, s35
  s_add_u32 s30, s34, 47185920
  s_add_u32 s31, s34, 47972352
  v_add_f32_dpp v44, v240, v44 row_ror:8 row_mask:0xf bank_mask:0xf
  v_add_f32_dpp v45, v241, v45 row_ror:8 row_mask:0xf bank_mask:0xf
  v_add_f32_dpp v46, v242, v46 row_ror:8 row_mask:0xf bank_mask:0xf
  v_add_f32_dpp v47, v243, v47 row_ror:8 row_mask:0xf bank_mask:0xf
  v_cvt_pk_bf16_f32 v52, v44, v45
  v_cvt_pk_bf16_f32 v53, v46, v47
  buffer_store_dwordx2 v[52:53], v8, s[4:7], s21 offen sc1
  s_waitcnt lgkmcnt(8)
  v_mfma_f32_16x16x32_bf16 v[48:51], v[172:175], a[84:87], v[48:51]
  s_waitcnt lgkmcnt(7)
  v_mfma_f32_16x16x32_bf16 v[48:51], v[176:179], a[88:91], v[48:51]
  s_waitcnt lgkmcnt(6)
  v_mfma_f32_16x16x32_bf16 v[48:51], v[180:183], a[92:95], v[48:51]
  s_waitcnt lgkmcnt(5)
  v_mfma_f32_16x16x32_bf16 v[48:51], v[184:187], a[96:99], v[48:51]
  s_waitcnt lgkmcnt(4)
  v_mfma_f32_16x16x32_bf16 v[48:51], v[188:191], a[100:103], v[48:51]
  s_waitcnt lgkmcnt(3)
  v_mfma_f32_16x16x32_bf16 v[48:51], v[192:195], a[104:107], v[48:51]
  s_waitcnt lgkmcnt(2)
  v_mfma_f32_16x16x32_bf16 v[48:51], v[196:199], a[108:111], v[48:51]
  s_waitcnt lgkmcnt(1)
  v_mfma_f32_16x16x32_bf16 v[48:51], v[200:203], a[112:115], v[48:51]
  s_waitcnt lgkmcnt(0)
  v_mfma_f32_16x16x32_bf16 v[48:51], v[204:207], a[116:119], v[48:51]
  s_cmp_eq_u32 s12, 3
  s_cbranch_scc1 reca_swave129
  s_nop 5
  ds_write_b128 v17, v[48:51]
  s_add_u32 s34, s17, 2
  s_and_b32 s34, s34, 3
  s_mul_i32 s26, s34, 10240
  s_add_u32 s26, s26, s38
  s_mul_i32 s27, s34, 6144
  s_add_u32 s27, s27, s39
  s_mul_i32 s28, s34, 12288
  s_add_u32 s28, s28, s40
  s_mul_i32 s29, s34, 393216
  s_add_u32 s29, s29, s56
  s_waitcnt lgkmcnt(0)
  s_barrier
  s_cmp_eq_u32 s17, 63
  s_cbranch_scc1 reca_last131
  buffer_store_dwordx2 v[32:33], v8, s[4:7], s27 offen sc1
  s_cmp_lg_u32 s12, 2
  s_cbranch_scc1 reca_b3132
  buffer_store_dwordx2 v[52:53], v9, s[4:7], s30 offen sc1
  buffer_store_dwordx2 v[32:33], v16, s[4:7], s26 offen sc1
  s_cmp_lg_u32 s14, 0
  s_cbranch_scc1 reca_b3132
  v_mov_b32 v28, s17
  s_lshl_b32 s34, s13, 7
  s_add_u32 s34, s34, 1507328
  buffer_store_dword v28, v19, s[4:7], s34 offen sc1
  s_branch reca_b3132
reca_last131:
  s_cmp_lg_u32 s12, 2
  s_cbranch_scc1 reca_exit1
  buffer_store_dwordx2 v[52:53], v9, s[4:7], s30 offen
  s_branch reca_exit1
reca_swave129:
  s_cmp_lg_u32 s17, 63
  s_cbranch_scc1 reca_vmst135
  s_barrier
  ds_read_b128 v[56:59], v1 offset:10240
  ds_read_b128 v[60:63], v1 offset:11264
  ds_read_b128 v[64:67], v1 offset:12288
  s_waitcnt lgkmcnt(0)
  v_add_f32 v56, v56, v64
  v_add_f32 v60, v60, v48
  v_add_f32 v57, v57, v65
  v_add_f32 v61, v61, v49
  v_add_f32 v58, v58, v66
  v_add_f32 v62, v62, v50
  v_add_f32 v59, v59, v67
  v_add_f32 v63, v63, v51
  v_cvt_pk_bf16_f32 v68, v56, v57
  v_cvt_pk_bf16_f32 v69, v58, v59
  v_cvt_pk_bf16_f32 v70, v60, v61
  v_cvt_pk_bf16_f32 v71, v62, v63
  buffer_store_dwordx2 v[52:53], v9, s[4:7], s30 offen
  buffer_store_dwordx2 v[68:69], v10, s[4:7], s31 offen
  buffer_store_dwordx2 v[70:71], v10, s[4:7], s31 offen offset:256
  s_branch reca_exit1
reca_vmst135:
  s_sleep 1
  buffer_load_dwordx4 v[208:211], v1, s[4:7], s21 offen offset:0 sc1
  buffer_load_dwordx4 v[212:215], v1, s[4:7], s21 offen offset:1024 sc1
  buffer_load_dwordx4 v[216:219], v1, s[4:7], s21 offen offset:2048 sc1
  buffer_load_dwordx4 v[220:223], v1, s[4:7], s21 offen offset:3072 sc1
  buffer_load_dwordx4 v[224:227], v2, s[4:7], s21 offen offset:0 sc1
  buffer_load_dwordx4 v[228:231], v2, s[4:7], s21 offen offset:1024 sc1
  s_waitcnt vmcnt(5)
  v_max_u32 v29, v208, v210
  v_cmp_eq_u32 vcc, -1, v29
  s_cbranch_vccnz reca_retry136
reca_resume137:
  s_waitcnt vmcnt(4)
  v_max_u32 v29, v212, v214
  v_cmp_eq_u32 vcc, -1, v29
  v_mfma_f32_16x16x32_bf16 v[76:79], a[120:123], v[208:211], 0
  v_mfma_f32_16x16x32_bf16 v[80:83], a[144:147], v[208:211], 0
  v_mfma_f32_16x16x32_bf16 v[72:75], v[208:211], v[208:211], v[40:43]
  s_cbranch_vccnz reca_retry138
reca_resume139:
  s_waitcnt vmcnt(3)
  v_max_u32 v29, v216, v218
  v_cmp_eq_u32 vcc, -1, v29
  v_mfma_f32_16x16x32_bf16 v[76:79], a[124:127], v[212:215], v[76:79]
  v_mfma_f32_16x16x32_bf16 v[80:83], a[148:151], v[212:215], v[80:83]
  v_mfma_f32_16x16x32_bf16 v[72:75], v[212:215], v[212:215], v[72:75]
  s_cbranch_vccnz reca_retry140
reca_resume141:
  s_waitcnt vmcnt(2)
  v_max_u32 v29, v220, v222
  v_cmp_eq_u32 vcc, -1, v29
  v_mfma_f32_16x16x32_bf16 v[76:79], a[128:131], v[216:219], v[76:79]
  v_mfma_f32_16x16x32_bf16 v[80:83], a[152:155], v[216:219], v[80:83]
  v_mfma_f32_16x16x32_bf16 v[72:75], v[216:219], v[216:219], v[72:75]
  s_cbranch_vccnz reca_retry142
reca_resume143:
  s_waitcnt vmcnt(1)
  v_max_u32 v29, v224, v226
  v_cmp_eq_u32 vcc, -1, v29
  v_mfma_f32_16x16x32_bf16 v[76:79], a[132:135], v[220:223], v[76:79]
  v_mfma_f32_16x16x32_bf16 v[80:83], a[156:159], v[220:223], v[80:83]
  v_mfma_f32_16x16x32_bf16 v[72:75], v[220:223], v[220:223], v[72:75]
  s_cbranch_vccnz reca_retry144
reca_resume145:
  s_waitcnt vmcnt(0)
  v_max_u32 v29, v228, v230
  v_cmp_eq_u32 vcc, -1, v29
  v_mfma_f32_16x16x32_bf16 v[76:79], a[136:139], v[224:227], v[76:79]
  v_mfma_f32_16x16x32_bf16 v[80:83], a[160:163], v[224:227], v[80:83]
  v_mfma_f32_16x16x32_bf16 v[72:75], v[224:227], v[224:227], v[72:75]
  s_cbranch_vccnz reca_retry146
reca_resume147:
  v_mfma_f32_16x16x32_bf16 v[76:79], a[140:143], v[228:231], v[76:79]
  v_mfma_f32_16x16x32_bf16 v[80:83], a[164:167], v[228:231], v[80:83]
  v_mfma_f32_16x16x32_bf16 v[72:75], v[228:231], v[228:231], v[72:75]
  s_barrier
  ds_read_b128 v[56:59], v1 offset:10240
  ds_read_b128 v[60:63], v1 offset:11264
  ds_read_b128 v[64:67], v1 offset:12288
  s_nop 1
  v_max3_f32 v28, v76, v77, v78
  v_max3_f32 v29, v80, v81, v82
  v_max3_f32 v28, v28, v79, v83
  v_max3_f32 v29, v29, v72, v73
  v_max3_f32 v28, v28, v74, v75
  v_max_f32 v28, v28, v29
  v_mov_b32 v29, v28
  s_nop 1
  v_permlane32_swap_b32 v28, v29
  v_max_f32 v28, v28, v29
  v_mov_b32 v29, v28
  s_nop 1
  v_permlane16_swap_b32 v28, v29
  v_max_f32 v28, v28, v29
  v_mul_f32 v28, s41, v28
  v_fma_f32 v76, v76, s41, -v28
  v_fma_f32 v77, v77, s41, -v28
  v_fma_f32 v78, v78, s41, -v28
  v_fma_f32 v79, v79, s41, -v28
  v_fma_f32 v80, v80, s41, -v28
  v_fma_f32 v81, v81, s41, -v28
  v_fma_f32 v82, v82, s41, -v28
  v_fma_f32 v83, v83, s41, -v28
  v_fma_f32 v72, v72, s41, -v28
  v_fma_f32 v73, v73, s41, -v28
  v_fma_f32 v74, v74, s41, -v28
  v_fma_f32 v75, v75, s41, -v28
  v_exp_f32 v76, v76
  v_exp_f32 v77, v77
  v_exp_f32 v78, v78
  v_exp_f32 v79, v79
  v_exp_f32 v80, v80
  v_exp_f32 v81, v81
  v_exp_f32 v82, v82
  v_exp_f32 v83, v83
  v_cvt_pk_bf16_f32 v84, v76, v77
  v_cvt_pk_bf16_f32 v85, v78, v79
  v_cvt_pk_bf16_f32 v86, v80, v81
  v_cvt_pk_bf16_f32 v87, v82, v83
  v_exp_f32 v72, v72
  v_exp_f32 v73, v73
  v_mfma_f32_16x16x32_bf16 v[100:103], v[36:39], v[84:87], 0
  v_exp_f32 v74, v74
  v_exp_f32 v75, v75
  v_mfma_f32_16x16x32_bf16 v[92:95], a[168:171], v[84:87], 0
  v_cvt_pk_bf16_f32 v88, v72, v73
  v_cvt_pk_bf16_f32 v89, v74, v75
  v_mfma_f32_16x16x32_bf16 v[96:99], a[172:175], v[84:87], 0
  s_waitcnt lgkmcnt(0)
  v_mfma_f32_16x16x16_bf16 v[100:103], v[36:37], v[88:89], v[100:103]
  v_add_f32 v56, v56, v64
  v_add_f32 v60, v60, v48
  v_add_f32 v57, v57, v65
  v_add_f32 v61, v61, v49
  v_add_f32 v58, v58, v66
  v_add_f32 v62, v62, v50
  v_add_f32 v59, v59, v67
  v_add_f32 v63, v63, v51
  v_cvt_pk_bf16_f32 v68, v56, v57
  v_cvt_pk_bf16_f32 v69, v58, v59
  v_cvt_pk_bf16_f32 v70, v60, v61
  v_cvt_pk_bf16_f32 v71, v62, v63
  v_mfma_f32_16x16x16_bf16 v[92:95], v[68:69], v[88:89], v[92:95]
  v_rcp_f32 v28, v100
  v_mfma_f32_16x16x16_bf16 v[96:99], v[70:71], v[88:89], v[96:99]
  v_mov_b32 v29, v28
  s_nop 4
  v_pk_mul_f32 v[92:93], v[92:93], v[28:29]
  v_pk_mul_f32 v[94:95], v[94:95], v[28:29]
  v_pk_mul_f32 v[96:97], v[96:97], v[28:29]
  v_pk_mul_f32 v[98:99], v[98:99], v[28:29]
  v_cvt_pk_bf16_f32 v104, v92, v93
  v_cvt_pk_bf16_f32 v105, v94, v95
  v_cvt_pk_bf16_f32 v106, v96, v97
  v_cvt_pk_bf16_f32 v107, v98, v99
  buffer_store_dwordx4 v[104:107], v11, s[4:7], s22 offen sc1
reca_b3132:
  s_barrier
  s_cmp_ge_u32 s12, 2
  s_cbranch_scc1 reca_notg2148
  s_sleep 3
  buffer_load_dwordx4 v[128:131], v12, s[4:7], s22 offen offset:0 sc1
  buffer_load_dwordx4 v[132:135], v12, s[4:7], s22 offen offset:1024 sc1
  buffer_load_dwordx4 v[136:139], v12, s[4:7], s22 offen offset:2048 sc1
  buffer_load_dwordx4 v[140:143], v12, s[4:7], s22 offen offset:3072 sc1
  buffer_load_dwordx4 v[144:147], v13, s[4:7], s22 offen offset:0 sc1
  buffer_load_dwordx4 v[148:151], v13, s[4:7], s22 offen offset:1024 sc1
  buffer_load_dwordx4 v[152:155], v13, s[4:7], s22 offen offset:2048 sc1
  buffer_load_dwordx4 v[156:159], v13, s[4:7], s22 offen offset:3072 sc1
  buffer_load_dwordx4 v[160:163], v14, s[4:7], s22 offen offset:0 sc1
  buffer_load_dwordx4 v[164:167], v14, s[4:7], s22 offen offset:1024 sc1
  buffer_load_dwordx4 v[168:171], v14, s[4:7], s22 offen offset:2048 sc1
  buffer_load_dwordx4 v[172:175], v14, s[4:7], s22 offen offset:3072 sc1
  s_waitcnt vmcnt(11)
  v_cmp_eq_u32 vcc, -1, v128
  s_cbranch_vccnz reca_retry149
reca_resume150:
  s_waitcnt vmcnt(10)
  v_cmp_eq_u32 vcc, -1, v132
  v_mfma_f32_16x16x32_bf16 v[108:111], a[120:123], v[128:131], 0
  v_mfma_f32_16x16x32_bf16 v[112:115], a[124:127], v[128:131], 0
  s_cbranch_vccnz reca_retry151
reca_resume152:
  s_waitcnt vmcnt(9)
  v_cmp_eq_u32 vcc, -1, v136
  v_mfma_f32_16x16x32_bf16 v[108:111], a[128:131], v[132:135], v[108:111]
  v_mfma_f32_16x16x32_bf16 v[112:115], a[132:135], v[132:135], v[112:115]
  s_cbranch_vccnz reca_retry153
reca_resume154:
  s_waitcnt vmcnt(8)
  v_cmp_eq_u32 vcc, -1, v140
  v_mfma_f32_16x16x32_bf16 v[108:111], a[136:139], v[136:139], v[108:111]
  v_mfma_f32_16x16x32_bf16 v[112:115], a[140:143], v[136:139], v[112:115]
  s_cbranch_vccnz reca_retry155
reca_resume156:
  s_waitcnt vmcnt(7)
  v_cmp_eq_u32 vcc, -1, v144
  v_mfma_f32_16x16x32_bf16 v[108:111], a[144:147], v[140:143], v[108:111]
  v_mfma_f32_16x16x32_bf16 v[112:115], a[148:151], v[140:143], v[112:115]
  s_cbranch_vccnz reca_retry157
reca_resume158:
  s_waitcnt vmcnt(6)
  v_cmp_eq_u32 vcc, -1, v148
  v_mfma_f32_16x16x32_bf16 v[108:111], a[152:155], v[144:147], v[108:111]
  v_mfma_f32_16x16x32_bf16 v[112:115], a[156:159], v[144:147], v[112:115]
  s_cbranch_vccnz reca_retry159
reca_resume160:
  s_waitcnt vmcnt(5)
  v_cmp_eq_u32 vcc, -1, v152
  v_mfma_f32_16x16x32_bf16 v[108:111], a[160:163], v[148:151], v[108:111]
  v_mfma_f32_16x16x32_bf16 v[112:115], a[164:167], v[148:151], v[112:115]
  s_cbranch_vccnz reca_retry161
reca_resume162:
  s_waitcnt vmcnt(4)
  v_cmp_eq_u32 vcc, -1, v156
  v_mfma_f32_16x16x32_bf16 v[108:111], a[168:171], v[152:155], v[108:111]
  v_mfma_f32_16x16x32_bf16 v[112:115], a[172:175], v[152:155], v[112:115]
  s_cbranch_vccnz reca_retry163
reca_resume164:
  s_waitcnt vmcnt(3)
  v_cmp_eq_u32 vcc, -1, v160
  v_mfma_f32_16x16x32_bf16 v[108:111], a[176:179], v[156:159], v[108:111]
  v_mfma_f32_16x16x32_bf16 v[112:115], a[180:183], v[156:159], v[112:115]
  s_cbranch_vccnz reca_retry165
reca_resume166:
  s_waitcnt vmcnt(2)
  v_cmp_eq_u32 vcc, -1, v164
  v_mfma_f32_16x16x32_bf16 v[108:111], a[184:187], v[160:163], v[108:111]
  v_mfma_f32_16x16x32_bf16 v[112:115], a[188:191], v[160:163], v[112:115]
  s_cbranch_vccnz reca_retry167
reca_resume168:
  s_waitcnt vmcnt(1)
  v_cmp_eq_u32 vcc, -1, v168
  v_mfma_f32_16x16x32_bf16 v[108:111], a[192:195], v[164:167], v[108:111]
  v_mfma_f32_16x16x32_bf16 v[112:115], a[196:199], v[164:167], v[112:115]
  s_cbranch_vccnz reca_retry169
reca_resume170:
  s_waitcnt vmcnt(0)
  v_cmp_eq_u32 vcc, -1, v172
  v_mfma_f32_16x16x32_bf16 v[108:111], a[200:203], v[168:171], v[108:111]
  v_mfma_f32_16x16x32_bf16 v[112:115], a[204:207], v[168:171], v[112:115]
  s_cbranch_vccnz reca_retry171
reca_resume172:
  v_mfma_f32_16x16x32_bf16 v[108:111], a[208:211], v[172:175], v[108:111]
  v_mfma_f32_16x16x32_bf16 v[112:115], a[212:215], v[172:175], v[112:115]
  s_nop 7
  v_add_f32_dpp v116, v112, v108 row_ror:8 row_mask:0xf bank_mask:0xf
  v_add_f32_dpp v117, v113, v109 row_ror:8 row_mask:0xf bank_mask:0xf
  v_add_f32_dpp v118, v114, v110 row_ror:8 row_mask:0xf bank_mask:0xf
  v_add_f32_dpp v119, v115, v111 row_ror:8 row_mask:0xf bank_mask:0xf
  buffer_store_dwordx4 v[116:119], v15, s[4:7], s25 offen sc1
  buffer_store_dwordx4 v[116:119], v232, s[4:7], s25 offen sc1
  buffer_store_dwordx4 v[32:35], v15, s[4:7], s29 offen sc1
  buffer_store_dwordx4 v[32:35], v232, s[4:7], s29 offen sc1
  s_branch reca_b4133
reca_notg2148:
  s_cmp_lg_u32 s12, 3
  s_cbranch_scc1 reca_b4133
  s_add_u32 s34, s17, 2
  s_and_b32 s34, s34, 3
  s_mul_i32 s26, s34, 10240
  s_add_u32 s26, s26, s38
  s_mul_i32 s27, s34, 6144
  s_add_u32 s27, s27, s39
  s_mul_i32 s28, s34, 12288
  s_add_u32 s28, s28, s40
  s_mul_i32 s29, s34, 393216
  s_add_u32 s29, s29, s56
  buffer_store_dwordx2 v[32:33], v8, s[4:7], s27 offen sc1
  buffer_store_dwordx4 v[32:35], v11, s[4:7], s28 offen sc1
reca_b4133:
  s_barrier
  s_cmp_lg_u32 s12, 2
  s_cbranch_scc1 reca_not2173
  s_sleep 8
  buffer_load_dwordx4 v[128:131], v20, s[4:7], s25 offen sc1
  buffer_load_dwordx4 v[132:135], v21, s[4:7], s25 offen sc1
  buffer_load_dwordx4 v[136:139], v22, s[4:7], s25 offen sc1
  buffer_load_dwordx4 v[140:143], v23, s[4:7], s25 offen sc1
  buffer_load_dwordx4 v[144:147], v24, s[4:7], s25 offen sc1
  buffer_load_dwordx4 v[148:151], v25, s[4:7], s25 offen sc1
  buffer_load_dwordx4 v[152:155], v26, s[4:7], s25 offen sc1
  buffer_load_dwordx4 v[156:159], v27, s[4:7], s25 offen sc1
  s_waitcnt vmcnt(7)
  v_cmp_eq_u32 vcc, -1, v128
  s_cbranch_vccnz reca_retry174
reca_resume175:
  s_waitcnt vmcnt(6)
  v_cmp_eq_u32 vcc, -1, v132
  s_cbranch_vccnz reca_retry176
reca_resume177:
  s_waitcnt vmcnt(5)
  v_cmp_eq_u32 vcc, -1, v136
  v_pk_add_f32 v[116:117], v[128:129], v[132:133]
  v_pk_add_f32 v[118:119], v[130:131], v[134:135]
  s_cbranch_vccnz reca_retry178
reca_resume179:
  s_waitcnt vmcnt(4)
  v_cmp_eq_u32 vcc, -1, v140
  v_pk_add_f32 v[116:117], v[116:117], v[136:137]
  v_pk_add_f32 v[118:119], v[118:119], v[138:139]
  s_cbranch_vccnz reca_retry180
reca_resume181:
  s_waitcnt vmcnt(3)
  v_cmp_eq_u32 vcc, -1, v144
  v_pk_add_f32 v[116:117], v[116:117], v[140:141]
  v_pk_add_f32 v[118:119], v[118:119], v[142:143]
  s_cbranch_vccnz reca_retry182
reca_resume183:
  s_waitcnt vmcnt(2)
  v_cmp_eq_u32 vcc, -1, v148
  v_pk_add_f32 v[116:117], v[116:117], v[144:145]
  v_pk_add_f32 v[118:119], v[118:119], v[146:147]
  s_cbranch_vccnz reca_retry184
reca_resume185:
  s_waitcnt vmcnt(1)
  v_cmp_eq_u32 vcc, -1, v152
  v_pk_add_f32 v[116:117], v[116:117], v[148:149]
  v_pk_add_f32 v[118:119], v[118:119], v[150:151]
  s_cbranch_vccnz reca_retry186
reca_resume187:
  s_waitcnt vmcnt(0)
  v_cmp_eq_u32 vcc, -1, v156
  v_pk_add_f32 v[116:117], v[116:117], v[152:153]
  v_pk_add_f32 v[118:119], v[118:119], v[154:155]
  s_cbranch_vccnz reca_retry188
reca_resume189:
  v_pk_add_f32 v[116:117], v[116:117], v[156:157]
  v_pk_add_f32 v[118:119], v[118:119], v[158:159]
  v_cvt_pk_bf16_f32 v132, v116, v117
  v_cvt_pk_bf16_f32 v133, v118, v119
  buffer_store_dwordx2 v[132:133], v16, s[4:7], s24 offen sc1
  s_branch reca_b5134
reca_not2173:
  s_cmp_lg_u32 s12, 3
  s_cbranch_scc1 reca_b5134
  s_add_u32 s36, s17, 1
  s_cmp_ge_u32 s36, 63
  s_cbranch_scc1 reca_nopf190
  s_add_u32 s37, s36, 1
reca_pf191:
  buffer_load_dword v28, v233, s[4:7], 0 offen sc1
  s_waitcnt vmcnt(0)
  v_cmp_gt_i32 vcc, s37, v28
  s_cbranch_vccz reca_pfok192
  s_sleep 1
  s_sub_u32 s18, s18, 1
  s_cbranch_scc0 reca_pf191
  s_mov_b32 s18, 0
reca_pfok192:
  s_lshl_b32 s34, s15, 3
  s_and_b32 s35, s36, 7
  s_add_u32 s34, s34, s35
  s_mul_i32 s34, s34, 12288
  s_add_u32 s32, s34, 37748736
  s_lshl_b32 s35, s16, 11
  s_add_u32 s34, s34, s35
  s_add_u32 s33, s34, 40894464
  buffer_load_dwordx4 a[120:123], v1, s[4:7], s32 offen offset:0 sc1
  buffer_load_dwordx4 a[124:127], v1, s[4:7], s32 offen offset:1024 sc1
  buffer_load_dwordx4 a[128:131], v1, s[4:7], s32 offen offset:2048 sc1
  buffer_load_dwordx4 a[132:135], v1, s[4:7], s32 offen offset:3072 sc1
  buffer_load_dwordx4 a[136:139], v2, s[4:7], s32 offen offset:0 sc1
  buffer_load_dwordx4 a[140:143], v2, s[4:7], s32 offen offset:1024 sc1
  buffer_load_dwordx4 a[144:147], v2, s[4:7], s32 offen offset:2048 sc1
  buffer_load_dwordx4 a[148:151], v2, s[4:7], s32 offen offset:3072 sc1
  buffer_load_dwordx4 a[152:155], v3, s[4:7], s32 offen offset:0 sc1
  buffer_load_dwordx4 a[156:159], v3, s[4:7], s32 offen offset:1024 sc1
  buffer_load_dwordx4 a[160:163], v3, s[4:7], s32 offen offset:2048 sc1
  buffer_load_dwordx4 a[164:167], v3, s[4:7], s32 offen offset:3072 sc1
  buffer_load_dwordx4 a[168:171], v1, s[4:7], s33 offen offset:0 sc1
  buffer_load_dwordx4 a[172:175], v1, s[4:7], s33 offen offset:1024 sc1
reca_nopf190:
  buffer_store_dwordx2 v[52:53], v9, s[4:7], s30 offen sc1
  buffer_store_dwordx2 v[68:69], v10, s[4:7], s31 offen sc1
  buffer_store_dwordx2 v[70:71], v10, s[4:7], s31 offen offset:256 sc1
reca_b5134:
  s_barrier
  s_add_u32 s17, s17, 1
  s_branch reca_step120
reca_retry123:
  s_sub_u32 s18, s18, 1
  s_cbranch_scc1 reca_retry123_to
  buffer_load_dwordx4 v[128:131], v4, s[4:7], s20 offen sc1
  buffer_load_dwordx4 v[132:135], v4, s[4:7], s20 offen offset:1024 sc1
  buffer_load_dwordx4 v[136:139], v5, s[4:7], s20 offen sc1
  s_waitcnt vmcnt(2)
  v_max_u32 v29, v128, v130
  v_cmp_eq_u32 vcc, -1, v29
  s_cbranch_vccnz reca_retry123
  s_branch reca_resume124
reca_retry123_to:
  s_mov_b32 s18, 0
  s_waitcnt vmcnt(0)
  s_branch reca_resume124
reca_retry125:
  s_sub_u32 s18, s18, 1
  s_cbranch_scc1 reca_retry125_to
  buffer_load_dwordx4 v[132:135], v4, s[4:7], s20 offen offset:1024 sc1
  buffer_load_dwordx4 v[136:139], v5, s[4:7], s20 offen sc1
  s_waitcnt vmcnt(1)
  v_max_u32 v29, v132, v134
  v_cmp_eq_u32 vcc, -1, v29
  s_cbranch_vccnz reca_retry125
  s_branch reca_resume126
reca_retry125_to:
  s_mov_b32 s18, 0
  s_waitcnt vmcnt(0)
  s_branch reca_resume126
reca_retry127:
  s_sub_u32 s18, s18, 1
  s_cbranch_scc1 reca_retry127_to
  buffer_load_dwordx4 v[136:139], v5, s[4:7], s20 offen sc1
  s_waitcnt vmcnt(0)
  v_max_u32 v29, v136, v138
  v_cmp_eq_u32 vcc, -1, v29
  s_cbranch_vccnz reca_retry127
  s_branch reca_resume128
reca_retry127_to:
  s_mov_b32 s18, 0
  s_waitcnt vmcnt(0)
  s_branch reca_resume128
reca_retry136:
  s_sub_u32 s18, s18, 1
  s_cbranch_scc1 reca_retry136_to
  buffer_load_dwordx4 v[208:211], v1, s[4:7], s21 offen offset:0 sc1
  buffer_load_dwordx4 v[212:215], v1, s[4:7], s21 offen offset:1024 sc1
  buffer_load_dwordx4 v[216:219], v1, s[4:7], s21 offen offset:2048 sc1
  buffer_load_dwordx4 v[220:223], v1, s[4:7], s21 offen offset:3072 sc1
  buffer_load_dwordx4 v[224:227], v2, s[4:7], s21 offen offset:0 sc1
  buffer_load_dwordx4 v[228:231], v2, s[4:7], s21 offen offset:1024 sc1
  s_waitcnt vmcnt(5)
  v_max_u32 v29, v208, v210
  v_cmp_eq_u32 vcc, -1, v29
  s_cbranch_vccnz reca_retry136
  s_branch reca_resume137
reca_retry136_to:
  s_mov_b32 s18, 0
  s_waitcnt vmcnt(0)
  s_branch reca_resume137
reca_retry138:
  s_sub_u32 s18, s18, 1
  s_cbranch_scc1 reca_retry138_to
  buffer_load_dwordx4 v[212:215], v1, s[4:7], s21 offen offset:1024 sc1
  buffer_load_dwordx4 v[216:219], v1, s[4:7], s21 offen offset:2048 sc1
  buffer_load_dwordx4 v[220:223], v1, s[4:7], s21 offen offset:3072 sc1
  buffer_load_dwordx4 v[224:227], v2, s[4:7], s21 offen offset:0 sc1
  buffer_load_dwordx4 v[228:231], v2, s[4:7], s21 offen offset:1024 sc1
  s_waitcnt vmcnt(4)
  v_max_u32 v29, v212, v214
  v_cmp_eq_u32 vcc, -1, v29
  s_cbranch_vccnz reca_retry138
  s_branch reca_resume139
reca_retry138_to:
  s_mov_b32 s18, 0
  s_waitcnt vmcnt(0)
  s_branch reca_resume139
reca_retry140:
  s_sub_u32 s18, s18, 1
  s_cbranch_scc1 reca_retry140_to
  buffer_load_dwordx4 v[216:219], v1, s[4:7], s21 offen offset:2048 sc1
  buffer_load_dwordx4 v[220:223], v1, s[4:7], s21 offen offset:3072 sc1
  buffer_load_dwordx4 v[224:227], v2, s[4:7], s21 offen offset:0 sc1
  buffer_load_dwordx4 v[228:231], v2, s[4:7], s21 offen offset:1024 sc1
  s_waitcnt vmcnt(3)
  v_max_u32 v29, v216, v218
  v_cmp_eq_u32 vcc, -1, v29
  s_cbranch_vccnz reca_retry140
  s_branch reca_resume141
reca_retry140_to:
  s_mov_b32 s18, 0
  s_waitcnt vmcnt(0)
  s_branch reca_resume141
reca_retry142:
  s_sub_u32 s18, s18, 1
  s_cbranch_scc1 reca_retry142_to
  buffer_load_dwordx4 v[220:223], v1, s[4:7], s21 offen offset:3072 sc1
  buffer_load_dwordx4 v[224:227], v2, s[4:7], s21 offen offset:0 sc1
  buffer_load_dwordx4 v[228:231], v2, s[4:7], s21 offen offset:1024 sc1
  s_waitcnt vmcnt(2)
  v_max_u32 v29, v220, v222
  v_cmp_eq_u32 vcc, -1, v29
  s_cbranch_vccnz reca_retry142
  s_branch reca_resume143
reca_retry142_to:
  s_mov_b32 s18, 0
  s_waitcnt vmcnt(0)
  s_branch reca_resume143
reca_retry144:
  s_sub_u32 s18, s18, 1
  s_cbranch_scc1 reca_retry144_to
  buffer_load_dwordx4 v[224:227], v2, s[4:7], s21 offen offset:0 sc1
  buffer_load_dwordx4 v[228:231], v2, s[4:7], s21 offen offset:1024 sc1
  s_waitcnt vmcnt(1)
  v_max_u32 v29, v224, v226
  v_cmp_eq_u32 vcc, -1, v29
  s_cbranch_vccnz reca_retry144
  s_branch reca_resume145
reca_retry144_to:
  s_mov_b32 s18, 0
  s_waitcnt vmcnt(0)
  s_branch reca_resume145
reca_retry146:
  s_sub_u32 s18, s18, 1
  s_cbranch_scc1 reca_retry146_to
  buffer_load_dwordx4 v[228:231], v2, s[4:7], s21 offen offset:1024 sc1
  s_waitcnt vmcnt(0)
  v_max_u32 v29, v228, v230
  v_cmp_eq_u32 vcc, -1, v29
  s_cbranch_vccnz reca_retry146
  s_branch reca_resume147
reca_retry146_to:
  s_mov_b32 s18, 0
  s_waitcnt vmcnt(0)
  s_branch reca_resume147
reca_retry149:
  s_sub_u32 s18, s18, 1
  s_cbranch_scc1 reca_retry149_to
  buffer_load_dwordx4 v[128:131], v12, s[4:7], s22 offen offset:0 sc1
  buffer_load_dwordx4 v[132:135], v12, s[4:7], s22 offen offset:1024 sc1
  buffer_load_dwordx4 v[136:139], v12, s[4:7], s22 offen offset:2048 sc1
  buffer_load_dwordx4 v[140:143], v12, s[4:7], s22 offen offset:3072 sc1
  buffer_load_dwordx4 v[144:147], v13, s[4:7], s22 offen offset:0 sc1
  buffer_load_dwordx4 v[148:151], v13, s[4:7], s22 offen offset:1024 sc1
  buffer_load_dwordx4 v[152:155], v13, s[4:7], s22 offen offset:2048 sc1
  buffer_load_dwordx4 v[156:159], v13, s[4:7], s22 offen offset:3072 sc1
  buffer_load_dwordx4 v[160:163], v14, s[4:7], s22 offen offset:0 sc1
  buffer_load_dwordx4 v[164:167], v14, s[4:7], s22 offen offset:1024 sc1
  buffer_load_dwordx4 v[168:171], v14, s[4:7], s22 offen offset:2048 sc1
  buffer_load_dwordx4 v[172:175], v14, s[4:7], s22 offen offset:3072 sc1
  s_waitcnt vmcnt(11)
  v_cmp_eq_u32 vcc, -1, v128
  s_cbranch_vccnz reca_retry149
  s_branch reca_resume150
reca_retry149_to:
  s_mov_b32 s18, 0
  s_waitcnt vmcnt(0)
  s_branch reca_resume150
reca_retry151:
  s_sub_u32 s18, s18, 1
  s_cbranch_scc1 reca_retry151_to
  buffer_load_dwordx4 v[132:135], v12, s[4:7], s22 offen offset:1024 sc1
  buffer_load_dwordx4 v[136:139], v12, s[4:7], s22 offen offset:2048 sc1
  buffer_load_dwordx4 v[140:143], v12, s[4:7], s22 offen offset:3072 sc1
  buffer_load_dwordx4 v[144:147], v13, s[4:7], s22 offen offset:0 sc1
  buffer_load_dwordx4 v[148:151], v13, s[4:7], s22 offen offset:1024 sc1
  buffer_load_dwordx4 v[152:155], v13, s[4:7], s22 offen offset:2048 sc1
  buffer_load_dwordx4 v[156:159], v13, s[4:7], s22 offen offset:3072 sc1
  buffer_load_dwordx4 v[160:163], v14, s[4:7], s22 offen offset:0 sc1
  buffer_load_dwordx4 v[164:167], v14, s[4:7], s22 offen offset:1024 sc1
  buffer_load_dwordx4 v[168:171], v14, s[4:7], s22 offen offset:2048 sc1
  buffer_load_dwordx4 v[172:175], v14, s[4:7], s22 offen offset:3072 sc1
  s_waitcnt vmcnt(10)
  v_cmp_eq_u32 vcc, -1, v132
  s_cbranch_vccnz reca_retry151
  s_branch reca_resume152
reca_retry151_to:
  s_mov_b32 s18, 0
  s_waitcnt vmcnt(0)
  s_branch reca_resume152
reca_retry153:
  s_sub_u32 s18, s18, 1
  s_cbranch_scc1 reca_retry153_to
  buffer_load_dwordx4 v[136:139], v12, s[4:7], s22 offen offset:2048 sc1
  buffer_load_dwordx4 v[140:143], v12, s[4:7], s22 offen offset:3072 sc1
  buffer_load_dwordx4 v[144:147], v13, s[4:7], s22 offen offset:0 sc1
  buffer_load_dwordx4 v[148:151], v13, s[4:7], s22 offen offset:1024 sc1
  buffer_load_dwordx4 v[152:155], v13, s[4:7], s22 offen offset:2048 sc1
  buffer_load_dwordx4 v[156:159], v13, s[4:7], s22 offen offset:3072 sc1
  buffer_load_dwordx4 v[160:163], v14, s[4:7], s22 offen offset:0 sc1
  buffer_load_dwordx4 v[164:167], v14, s[4:7], s22 offen offset:1024 sc1
  buffer_load_dwordx4 v[168:171], v14, s[4:7], s22 offen offset:2048 sc1
  buffer_load_dwordx4 v[172:175], v14, s[4:7], s22 offen offset:3072 sc1
  s_waitcnt vmcnt(9)
  v_cmp_eq_u32 vcc, -1, v136
  s_cbranch_vccnz reca_retry153
  s_branch reca_resume154
reca_retry153_to:
  s_mov_b32 s18, 0
  s_waitcnt vmcnt(0)
  s_branch reca_resume154
reca_retry155:
  s_sub_u32 s18, s18, 1
  s_cbranch_scc1 reca_retry155_to
  buffer_load_dwordx4 v[140:143], v12, s[4:7], s22 offen offset:3072 sc1
  buffer_load_dwordx4 v[144:147], v13, s[4:7], s22 offen offset:0 sc1
  buffer_load_dwordx4 v[148:151], v13, s[4:7], s22 offen offset:1024 sc1
  buffer_load_dwordx4 v[152:155], v13, s[4:7], s22 offen offset:2048 sc1
  buffer_load_dwordx4 v[156:159], v13, s[4:7], s22 offen offset:3072 sc1
  buffer_load_dwordx4 v[160:163], v14, s[4:7], s22 offen offset:0 sc1
  buffer_load_dwordx4 v[164:167], v14, s[4:7], s22 offen offset:1024 sc1
  buffer_load_dwordx4 v[168:171], v14, s[4:7], s22 offen offset:2048 sc1
  buffer_load_dwordx4 v[172:175], v14, s[4:7], s22 offen offset:3072 sc1
  s_waitcnt vmcnt(8)
  v_cmp_eq_u32 vcc, -1, v140
  s_cbranch_vccnz reca_retry155
  s_branch reca_resume156
reca_retry155_to:
  s_mov_b32 s18, 0
  s_waitcnt vmcnt(0)
  s_branch reca_resume156
reca_retry157:
  s_sub_u32 s18, s18, 1
  s_cbranch_scc1 reca_retry157_to
  buffer_load_dwordx4 v[144:147], v13, s[4:7], s22 offen offset:0 sc1
  buffer_load_dwordx4 v[148:151], v13, s[4:7], s22 offen offset:1024 sc1
  buffer_load_dwordx4 v[152:155], v13, s[4:7], s22 offen offset:2048 sc1
  buffer_load_dwordx4 v[156:159], v13, s[4:7], s22 offen offset:3072 sc1
  buffer_load_dwordx4 v[160:163], v14, s[4:7], s22 offen offset:0 sc1
  buffer_load_dwordx4 v[164:167], v14, s[4:7], s22 offen offset:1024 sc1
  buffer_load_dwordx4 v[168:171], v14, s[4:7], s22 offen offset:2048 sc1
  buffer_load_dwordx4 v[172:175], v14, s[4:7], s22 offen offset:3072 sc1
  s_waitcnt vmcnt(7)
  v_cmp_eq_u32 vcc, -1, v144
  s_cbranch_vccnz reca_retry157
  s_branch reca_resume158
reca_retry157_to:
  s_mov_b32 s18, 0
  s_waitcnt vmcnt(0)
  s_branch reca_resume158
reca_retry159:
  s_sub_u32 s18, s18, 1
  s_cbranch_scc1 reca_retry159_to
  buffer_load_dwordx4 v[148:151], v13, s[4:7], s22 offen offset:1024 sc1
  buffer_load_dwordx4 v[152:155], v13, s[4:7], s22 offen offset:2048 sc1
  buffer_load_dwordx4 v[156:159], v13, s[4:7], s22 offen offset:3072 sc1
  buffer_load_dwordx4 v[160:163], v14, s[4:7], s22 offen offset:0 sc1
  buffer_load_dwordx4 v[164:167], v14, s[4:7], s22 offen offset:1024 sc1
  buffer_load_dwordx4 v[168:171], v14, s[4:7], s22 offen offset:2048 sc1
  buffer_load_dwordx4 v[172:175], v14, s[4:7], s22 offen offset:3072 sc1
  s_waitcnt vmcnt(6)
  v_cmp_eq_u32 vcc, -1, v148
  s_cbranch_vccnz reca_retry159
  s_branch reca_resume160
reca_retry159_to:
  s_mov_b32 s18, 0
  s_waitcnt vmcnt(0)
  s_branch reca_resume160
reca_retry161:
  s_sub_u32 s18, s18, 1
  s_cbranch_scc1 reca_retry161_to
  buffer_load_dwordx4 v[152:155], v13, s[4:7], s22 offen offset:2048 sc1
  buffer_load_dwordx4 v[156:159], v13, s[4:7], s22 offen offset:3072 sc1
  buffer_load_dwordx4 v[160:163], v14, s[4:7], s22 offen offset:0 sc1
  buffer_load_dwordx4 v[164:167], v14, s[4:7], s22 offen offset:1024 sc1
  buffer_load_dwordx4 v[168:171], v14, s[4:7], s22 offen offset:2048 sc1
  buffer_load_dwordx4 v[172:175], v14, s[4:7], s22 offen offset:3072 sc1
  s_waitcnt vmcnt(5)
  v_cmp_eq_u32 vcc, -1, v152
  s_cbranch_vccnz reca_retry161
  s_branch reca_resume162
reca_retry161_to:
  s_mov_b32 s18, 0
  s_waitcnt vmcnt(0)
  s_branch reca_resume162
reca_retry163:
  s_sub_u32 s18, s18, 1
  s_cbranch_scc1 reca_retry163_to
  buffer_load_dwordx4 v[156:159], v13, s[4:7], s22 offen offset:3072 sc1
  buffer_load_dwordx4 v[160:163], v14, s[4:7], s22 offen offset:0 sc1
  buffer_load_dwordx4 v[164:167], v14, s[4:7], s22 offen offset:1024 sc1
  buffer_load_dwordx4 v[168:171], v14, s[4:7], s22 offen offset:2048 sc1
  buffer_load_dwordx4 v[172:175], v14, s[4:7], s22 offen offset:3072 sc1
  s_waitcnt vmcnt(4)
  v_cmp_eq_u32 vcc, -1, v156
  s_cbranch_vccnz reca_retry163
  s_branch reca_resume164
reca_retry163_to:
  s_mov_b32 s18, 0
  s_waitcnt vmcnt(0)
  s_branch reca_resume164
reca_retry165:
  s_sub_u32 s18, s18, 1
  s_cbranch_scc1 reca_retry165_to
  buffer_load_dwordx4 v[160:163], v14, s[4:7], s22 offen offset:0 sc1
  buffer_load_dwordx4 v[164:167], v14, s[4:7], s22 offen offset:1024 sc1
  buffer_load_dwordx4 v[168:171], v14, s[4:7], s22 offen offset:2048 sc1
  buffer_load_dwordx4 v[172:175], v14, s[4:7], s22 offen offset:3072 sc1
  s_waitcnt vmcnt(3)
  v_cmp_eq_u32 vcc, -1, v160
  s_cbranch_vccnz reca_retry165
  s_branch reca_resume166
reca_retry165_to:
  s_mov_b32 s18, 0
  s_waitcnt vmcnt(0)
  s_branch reca_resume166
reca_retry167:
  s_sub_u32 s18, s18, 1
  s_cbranch_scc1 reca_retry167_to
  buffer_load_dwordx4 v[164:167], v14, s[4:7], s22 offen offset:1024 sc1
  buffer_load_dwordx4 v[168:171], v14, s[4:7], s22 offen offset:2048 sc1
  buffer_load_dwordx4 v[172:175], v14, s[4:7], s22 offen offset:3072 sc1
  s_waitcnt vmcnt(2)
  v_cmp_eq_u32 vcc, -1, v164
  s_cbranch_vccnz reca_retry167
  s_branch reca_resume168
reca_retry167_to:
  s_mov_b32 s18, 0
  s_waitcnt vmcnt(0)
  s_branch reca_resume168
reca_retry169:
  s_sub_u32 s18, s18, 1
  s_cbranch_scc1 reca_retry169_to
  buffer_load_dwordx4 v[168:171], v14, s[4:7], s22 offen offset:2048 sc1
  buffer_load_dwordx4 v[172:175], v14, s[4:7], s22 offen offset:3072 sc1
  s_waitcnt vmcnt(1)
  v_cmp_eq_u32 vcc, -1, v168
  s_cbranch_vccnz reca_retry169
  s_branch reca_resume170
reca_retry169_to:
  s_mov_b32 s18, 0
  s_waitcnt vmcnt(0)
  s_branch reca_resume170
reca_retry171:
  s_sub_u32 s18, s18, 1
  s_cbranch_scc1 reca_retry171_to
  buffer_load_dwordx4 v[172:175], v14, s[4:7], s22 offen offset:3072 sc1
  s_waitcnt vmcnt(0)
  v_cmp_eq_u32 vcc, -1, v172
  s_cbranch_vccnz reca_retry171
  s_branch reca_resume172
reca_retry171_to:
  s_mov_b32 s18, 0
  s_waitcnt vmcnt(0)
  s_branch reca_resume172
reca_retry174:
  s_sub_u32 s18, s18, 1
  s_cbranch_scc1 reca_retry174_to
  buffer_load_dwordx4 v[128:131], v20, s[4:7], s25 offen sc1
  buffer_load_dwordx4 v[132:135], v21, s[4:7], s25 offen sc1
  buffer_load_dwordx4 v[136:139], v22, s[4:7], s25 offen sc1
  buffer_load_dwordx4 v[140:143], v23, s[4:7], s25 offen sc1
  buffer_load_dwordx4 v[144:147], v24, s[4:7], s25 offen sc1
  buffer_load_dwordx4 v[148:151], v25, s[4:7], s25 offen sc1
  buffer_load_dwordx4 v[152:155], v26, s[4:7], s25 offen sc1
  buffer_load_dwordx4 v[156:159], v27, s[4:7], s25 offen sc1
  s_waitcnt vmcnt(7)
  v_cmp_eq_u32 vcc, -1, v128
  s_cbranch_vccnz reca_retry174
  s_branch reca_resume175
reca_retry174_to:
  s_mov_b32 s18, 0
  s_waitcnt vmcnt(0)
  s_branch reca_resume175
reca_retry176:
  s_sub_u32 s18, s18, 1
  s_cbranch_scc1 reca_retry176_to
  buffer_load_dwordx4 v[132:135], v21, s[4:7], s25 offen sc1
  buffer_load_dwordx4 v[136:139], v22, s[4:7], s25 offen sc1
  buffer_load_dwordx4 v[140:143], v23, s[4:7], s25 offen sc1
  buffer_load_dwordx4 v[144:147], v24, s[4:7], s25 offen sc1
  buffer_load_dwordx4 v[148:151], v25, s[4:7], s25 offen sc1
  buffer_load_dwordx4 v[152:155], v26, s[4:7], s25 offen sc1
  buffer_load_dwordx4 v[156:159], v27, s[4:7], s25 offen sc1
  s_waitcnt vmcnt(6)
  v_cmp_eq_u32 vcc, -1, v132
  s_cbranch_vccnz reca_retry176
  s_branch reca_resume177
reca_retry176_to:
  s_mov_b32 s18, 0
  s_waitcnt vmcnt(0)
  s_branch reca_resume177
reca_retry178:
  s_sub_u32 s18, s18, 1
  s_cbranch_scc1 reca_retry178_to
  buffer_load_dwordx4 v[136:139], v22, s[4:7], s25 offen sc1
  buffer_load_dwordx4 v[140:143], v23, s[4:7], s25 offen sc1
  buffer_load_dwordx4 v[144:147], v24, s[4:7], s25 offen sc1
  buffer_load_dwordx4 v[148:151], v25, s[4:7], s25 offen sc1
  buffer_load_dwordx4 v[152:155], v26, s[4:7], s25 offen sc1
  buffer_load_dwordx4 v[156:159], v27, s[4:7], s25 offen sc1
  s_waitcnt vmcnt(5)
  v_cmp_eq_u32 vcc, -1, v136
  s_cbranch_vccnz reca_retry178
  s_branch reca_resume179
reca_retry178_to:
  s_mov_b32 s18, 0
  s_waitcnt vmcnt(0)
  s_branch reca_resume179
reca_retry180:
  s_sub_u32 s18, s18, 1
  s_cbranch_scc1 reca_retry180_to
  buffer_load_dwordx4 v[140:143], v23, s[4:7], s25 offen sc1
  buffer_load_dwordx4 v[144:147], v24, s[4:7], s25 offen sc1
  buffer_load_dwordx4 v[148:151], v25, s[4:7], s25 offen sc1
  buffer_load_dwordx4 v[152:155], v26, s[4:7], s25 offen sc1
  buffer_load_dwordx4 v[156:159], v27, s[4:7], s25 offen sc1
  s_waitcnt vmcnt(4)
  v_cmp_eq_u32 vcc, -1, v140
  s_cbranch_vccnz reca_retry180
  s_branch reca_resume181
reca_retry180_to:
  s_mov_b32 s18, 0
  s_waitcnt vmcnt(0)
  s_branch reca_resume181
reca_retry182:
  s_sub_u32 s18, s18, 1
  s_cbranch_scc1 reca_retry182_to
  buffer_load_dwordx4 v[144:147], v24, s[4:7], s25 offen sc1
  buffer_load_dwordx4 v[148:151], v25, s[4:7], s25 offen sc1
  buffer_load_dwordx4 v[152:155], v26, s[4:7], s25 offen sc1
  buffer_load_dwordx4 v[156:159], v27, s[4:7], s25 offen sc1
  s_waitcnt vmcnt(3)
  v_cmp_eq_u32 vcc, -1, v144
  s_cbranch_vccnz reca_retry182
  s_branch reca_resume183
reca_retry182_to:
  s_mov_b32 s18, 0
  s_waitcnt vmcnt(0)
  s_branch reca_resume183
reca_retry184:
  s_sub_u32 s18, s18, 1
  s_cbranch_scc1 reca_retry184_to
  buffer_load_dwordx4 v[148:151], v25, s[4:7], s25 offen sc1
  buffer_load_dwordx4 v[152:155], v26, s[4:7], s25 offen sc1
  buffer_load_dwordx4 v[156:159], v27, s[4:7], s25 offen sc1
  s_waitcnt vmcnt(2)
  v_cmp_eq_u32 vcc, -1, v148
  s_cbranch_vccnz reca_retry184
  s_branch reca_resume185
reca_retry184_to:
  s_mov_b32 s18, 0
  s_waitcnt vmcnt(0)
  s_branch reca_resume185
reca_retry186:
  s_sub_u32 s18, s18, 1
  s_cbranch_scc1 reca_retry186_to
  buffer_load_dwordx4 v[152:155], v26, s[4:7], s25 offen sc1
  buffer_load_dwordx4 v[156:159], v27, s[4:7], s25 offen sc1
  s_waitcnt vmcnt(1)
  v_cmp_eq_u32 vcc, -1, v152
  s_cbranch_vccnz reca_retry186
  s_branch reca_resume187
reca_retry186_to:
  s_mov_b32 s18, 0
  s_waitcnt vmcnt(0)
  s_branch reca_resume187
reca_retry188:
  s_sub_u32 s18, s18, 1
  s_cbranch_scc1 reca_retry188_to
  buffer_load_dwordx4 v[156:159], v27, s[4:7], s25 offen sc1
  s_waitcnt vmcnt(0)
  v_cmp_eq_u32 vcc, -1, v156
  s_cbranch_vccnz reca_retry188
  s_branch reca_resume189
reca_retry188_to:
  s_mov_b32 s18, 0
  s_waitcnt vmcnt(0)
  s_branch reca_resume189
reca_twins13:
  s_branch reca_gotmem194
reca_step193:
  s_and_b32 s34, s17, 3
  s_mul_i32 s20, s34, 10240
  s_add_u32 s20, s20, s38
  s_sleep 5
  buffer_load_dwordx4 v[128:131], v4, s[4:7], s20 offen sc1
  buffer_load_dwordx4 v[132:135], v4, s[4:7], s20 offen offset:1024 sc1
  buffer_load_dwordx4 v[136:139], v5, s[4:7], s20 offen sc1
  s_waitcnt vmcnt(2)
  v_max_u32 v29, v128, v130
  v_cmp_eq_u32 vcc, -1, v29
  s_cbranch_vccnz reca_retry196
reca_resume197:
  s_waitcnt vmcnt(1)
  v_max_u32 v29, v132, v134
  v_cmp_eq_u32 vcc, -1, v29
  ds_write_b128 v4, v[128:131]
  s_cbranch_vccnz reca_retry198
reca_resume199:
  s_waitcnt vmcnt(0)
  v_max_u32 v29, v136, v138
  v_cmp_eq_u32 vcc, -1, v29
  ds_write_b128 v4, v[132:135] offset:1024
  s_cbranch_vccnz reca_retry200
reca_resume201:
  ds_write_b128 v5, v[136:139]
  s_branch reca_gotmem2195
reca_gotmem194:
  ds_write_b128 v4, v[128:131]
  ds_write_b128 v4, v[132:135] offset:1024
  ds_write_b128 v5, v[136:139]
reca_gotmem2195:
  s_and_b32 s34, s17, 3
  s_mul_i32 s21, s34, 6144
  s_add_u32 s21, s21, s39
  s_mul_i32 s22, s34, 12288
  s_add_u32 s22, s22, s40
  s_mul_i32 s25, s34, 393216
  s_add_u32 s25, s25, s56
  s_add_u32 s35, s17, 1
  s_and_b32 s35, s35, 3
  s_mul_i32 s24, s35, 10240
  s_add_u32 s24, s24, s38
  s_waitcnt lgkmcnt(0)
  s_barrier
  ds_read_b128 v[128:131], v236 offset:0
  ds_read_b128 v[132:135], v236 offset:1024
  ds_read_b128 v[136:139], v236 offset:2048
  ds_read_b128 v[140:143], v236 offset:3072
  ds_read_b128 v[144:147], v236 offset:4096
  ds_read_b128 v[148:151], v237 offset:0
  ds_read_b128 v[152:155], v237 offset:1024
  ds_read_b128 v[156:159], v237 offset:2048
  ds_read_b128 v[160:163], v237 offset:3072
  ds_read_b128 v[164:167], v237 offset:4096
  s_waitcnt lgkmcnt(9)
  v_mfma_f32_16x16x32_bf16 v[44:47], a[0:3], v[128:131], 0
  ds_read_b128 v[168:171], v6 offset:0
  v_mfma_f32_16x16x32_bf16 v[240:243], a[4:7], v[128:131], 0
  s_waitcnt lgkmcnt(9)
  v_mfma_f32_16x16x32_bf16 v[44:47], a[8:11], v[132:135], v[44:47]
  ds_read_b128 v[172:175], v6 offset:512
  v_mfma_f32_16x16x32_bf16 v[240:243], a[12:15], v[132:135], v[240:243]
  s_waitcnt lgkmcnt(9)
  v_mfma_f32_16x16x32_bf16 v[44:47], a[16:19], v[136:139], v[44:47]
  ds_read_b128 v[176:179], v6 offset:1024
  v_mfma_f32_16x16x32_bf16 v[240:243], a[20:23], v[136:139], v[240:243]
  s_waitcnt lgkmcnt(9)
  v_mfma_f32_16x16x32_bf16 v[44:47], a[24:27], v[140:143], v[44:47]
  ds_read_b128 v[180:183], v6 offset:1536
  v_mfma_f32_16x16x32_bf16 v[240:243], a[28:31], v[140:143], v[240:243]
  s_waitcnt lgkmcnt(9)
  v_mfma_f32_16x16x32_bf16 v[44:47], a[32:35], v[144:147], v[44:47]
  ds_read_b128 v[184:187], v6 offset:2048
  v_mfma_f32_16x16x32_bf16 v[240:243], a[36:39], v[144:147], v[240:243]
  s_waitcnt lgkmcnt(9)
  v_mfma_f32_16x16x32_bf16 v[44:47], a[40:43], v[148:151], v[44:47]
  ds_read_b128 v[188:191], v6 offset:2560
  v_mfma_f32_16x16x32_bf16 v[240:243], a[44:47], v[148:151], v[240:243]
  s_waitcnt lgkmcnt(9)
  v_mfma_f32_16x16x32_bf16 v[44:47], a[48:51], v[152:155], v[44:47]
  ds_read_b128 v[192:195], v6 offset:3072
  v_mfma_f32_16x16x32_bf16 v[240:243], a[52:55], v[152:155], v[240:243]
  s_waitcnt lgkmcnt(9)
  v_mfma_f32_16x16x32_bf16 v[44:47], a[56:59], v[156:159], v[44:47]
  ds_read_b128 v[196:199], v6 offset:3584
  v_mfma_f32_16x16x32_bf16 v[240:243], a[60:63], v[156:159], v[240:243]
  s_waitcnt lgkmcnt(9)
  v_mfma_f32_16x16x32_bf16 v[44:47], a[64:67], v[160:163], v[44:47]
  ds_read_b128 v[200:203], v6 offset:4096
  v_mfma_f32_16x16x32_bf16 v[240:243], a[68:71], v[160:163], v[240:243]
  s_waitcnt lgkmcnt(9)
  v_mfma_f32_16x16x32_bf16 v[44:47], a[72:75], v[164:167], v[44:47]
  ds_read_b128 v[204:207], v6 offset:4608
  v_mfma_f32_16x16x32_bf16 v[240:243], a[76:79], v[164:167], v[240:243]
  s_waitcnt lgkmcnt(9)
  v_mfma_f32_16x16x32_bf16 v[48:51], v[168:171], a[80:83], 0
  s_and_b32 s34, s17, 7
  s_lshl_b32 s34, s34, 5
  s_add_u32 s34, s34, s15
  s_mul_i32 s34, s34, 3072
  s_lshl_b32 s35, s16, 9
  s_add_u32 s34, s34, s35
  s_add_u32 s30, s34, 47185920
  s_add_u32 s31, s34, 47972352
  v_add_f32_dpp v44, v240, v44 row_ror:8 row_mask:0xf bank_mask:0xf
  v_add_f32_dpp v45, v241, v45 row_ror:8 row_mask:0xf bank_mask:0xf
  v_add_f32_dpp v46, v242, v46 row_ror:8 row_mask:0xf bank_mask:0xf
  v_add_f32_dpp v47, v243, v47 row_ror:8 row_mask:0xf bank_mask:0xf
  v_cvt_pk_bf16_f32 v52, v44, v45
  v_cvt_pk_bf16_f32 v53, v46, v47
  buffer_store_dwordx2 v[52:53], v8, s[4:7], s21 offen sc1
  s_waitcnt lgkmcnt(8)
  v_mfma_f32_16x16x32_bf16 v[48:51], v[172:175], a[84:87], v[48:51]
  s_waitcnt lgkmcnt(7)
  v_mfma_f32_16x16x32_bf16 v[48:51], v[176:179], a[88:91], v[48:51]
  s_waitcnt lgkmcnt(6)
  v_mfma_f32_16x16x32_bf16 v[48:51], v[180:183], a[92:95], v[48:51]
  s_waitcnt lgkmcnt(5)
  v_mfma_f32_16x16x32_bf16 v[48:51], v[184:187], a[96:99], v[48:51]
  s_waitcnt lgkmcnt(4)
  v_mfma_f32_16x16x32_bf16 v[48:51], v[188:191], a[100:103], v[48:51]
  s_waitcnt lgkmcnt(3)
  v_mfma_f32_16x16x32_bf16 v[48:51], v[192:195], a[104:107], v[48:51]
  s_waitcnt lgkmcnt(2)
  v_mfma_f32_16x16x32_bf16 v[48:51], v[196:199], a[108:111], v[48:51]
  s_waitcnt lgkmcnt(1)
  v_mfma_f32_16x16x32_bf16 v[48:51], v[200:203], a[112:115], v[48:51]
  s_waitcnt lgkmcnt(0)
  v_mfma_f32_16x16x32_bf16 v[48:51], v[204:207], a[116:119], v[48:51]
  s_cmp_eq_u32 s12, 3
  s_cbranch_scc1 reca_swave202
  s_nop 5
  ds_write_b128 v17, v[48:51]
  s_add_u32 s34, s17, 2
  s_and_b32 s34, s34, 3
  s_mul_i32 s26, s34, 10240
  s_add_u32 s26, s26, s38
  s_mul_i32 s27, s34, 6144
  s_add_u32 s27, s27, s39
  s_mul_i32 s28, s34, 12288
  s_add_u32 s28, s28, s40
  s_mul_i32 s29, s34, 393216
  s_add_u32 s29, s29, s56
  s_waitcnt lgkmcnt(0)
  s_barrier
  s_cmp_eq_u32 s17, 63
  s_cbranch_scc1 reca_last204
  buffer_store_dwordx2 v[32:33], v8, s[4:7], s27 offen sc1
  s_cmp_lg_u32 s12, 2
  s_cbranch_scc1 reca_tw1208_n
  buffer_store_dwordx2 v[52:53], v9, s[4:7], s30 offen sc1
reca_tw1208_n:
  s_barrier
  s_cmp_eq_u32 s12, 1
  s_cbranch_scc1 reca_tw1208
  s_cmp_eq_u32 s12, 2
  s_cbranch_scc1 reca_tw2209
  s_cmp_lt_u32 s17, 2
  s_cbranch_scc1 reca_b5207
  s_cmp_gt_u32 s17, 61
  s_cbranch_scc1 reca_b5207
  s_sub_u32 s36, s17, 2
  s_and_b32 s36, s36, 7
  s_lshl_b32 s34, s59, 3
  s_add_u32 s34, s34, s36
  s_mul_i32 s34, s34, 12288
  s_add_u32 s23, s34, 37748736
  s_add_u32 s60, s34, 44040192
  s_lshl_b32 s35, s36, 5
  s_add_u32 s35, s35, s59
  s_mul_i32 s35, s35, 3072
  s_add_u32 s61, s35, 47185920
  buffer_load_dwordx4 a[120:123], v1, s[4:7], s23 offen offset:0 sc1
  buffer_load_dwordx4 a[124:127], v1, s[4:7], s23 offen offset:1024 sc1
  buffer_load_dwordx4 a[128:131], v1, s[4:7], s23 offen offset:2048 sc1
  buffer_load_dwordx4 a[132:135], v1, s[4:7], s23 offen offset:3072 sc1
  buffer_load_dwordx4 a[136:139], v2, s[4:7], s23 offen offset:0 sc1
  buffer_load_dwordx4 a[140:143], v2, s[4:7], s23 offen offset:1024 sc1
  buffer_load_dwordx4 a[144:147], v2, s[4:7], s23 offen offset:2048 sc1
  buffer_load_dwordx4 a[148:151], v2, s[4:7], s23 offen offset:3072 sc1
  buffer_load_dwordx4 a[152:155], v3, s[4:7], s23 offen offset:0 sc1
  buffer_load_dwordx4 a[156:159], v3, s[4:7], s23 offen offset:1024 sc1
  buffer_load_dwordx4 a[160:163], v3, s[4:7], s23 offen offset:2048 sc1
  buffer_load_dwordx4 a[164:167], v3, s[4:7], s23 offen offset:3072 sc1
  buffer_load_dwordx4 a[216:219], v92, s[4:7], s61 offen offset:0 sc1
  buffer_load_dwordx4 a[220:223], v92, s[4:7], s61 offen offset:512 sc1
  buffer_load_dwordx4 a[224:227], v92, s[4:7], s61 offen offset:1024 sc1
  buffer_load_dwordx4 a[228:231], v92, s[4:7], s61 offen offset:1536 sc1
  buffer_load_dwordx4 a[232:235], v92, s[4:7], s61 offen offset:2048 sc1
  buffer_load_dwordx4 a[236:239], v92, s[4:7], s61 offen offset:2560 sc1
  buffer_load_dwordx4 a[168:171], v1, s[4:7], s60 offen offset:0 sc1
  buffer_load_dwordx4 a[172:175], v1, s[4:7], s60 offen offset:1024 sc1
  buffer_load_dwordx4 a[176:179], v1, s[4:7], s60 offen offset:2048 sc1
  buffer_load_dwordx4 a[180:183], v1, s[4:7], s60 offen offset:3072 sc1
  buffer_load_dwordx4 a[184:187], v2, s[4:7], s60 offen offset:0 sc1
  buffer_load_dwordx4 a[188:191], v2, s[4:7], s60 offen offset:1024 sc1
  buffer_load_dwordx4 a[192:195], v2, s[4:7], s60 offen offset:2048 sc1
  buffer_load_dwordx4 a[196:199], v2, s[4:7], s60 offen offset:3072 sc1
  buffer_load_dwordx4 a[200:203], v3, s[4:7], s60 offen offset:0 sc1
  buffer_load_dwordx4 a[204:207], v3, s[4:7], s60 offen offset:1024 sc1
  buffer_load_dwordx4 a[208:211], v3, s[4:7], s60 offen offset:2048 sc1
  buffer_load_dwordx4 a[212:215], v3, s[4:7], s60 offen offset:3072 sc1
  s_waitcnt vmcnt(5)
  v_mfma_f32_16x16x32_bf16 v[128:131], a[216:219], a[168:171], v[84:87]
  v_mfma_f32_16x16x32_bf16 v[132:135], a[120:123], a[168:171], v[88:91]
  v_mfma_f32_16x16x32_bf16 v[136:139], a[216:219], a[192:195], v[84:87]
  v_mfma_f32_16x16x32_bf16 v[140:143], a[120:123], a[192:195], 0
  v_mfma_f32_16x16x32_bf16 v[144:147], a[144:147], a[192:195], v[88:91]
  s_waitcnt vmcnt(4)
  v_mfma_f32_16x16x32_bf16 v[128:131], a[220:223], a[172:175], v[128:131]
  v_mfma_f32_16x16x32_bf16 v[132:135], a[124:127], a[172:175], v[132:135]
  v_mfma_f32_16x16x32_bf16 v[136:139], a[220:223], a[196:199], v[136:139]
  v_mfma_f32_16x16x32_bf16 v[140:143], a[124:127], a[196:199], v[140:143]
  v_mfma_f32_16x16x32_bf16 v[144:147], a[148:151], a[196:199], v[144:147]
  s_waitcnt vmcnt(3)
  v_mfma_f32_16x16x32_bf16 v[128:131], a[224:227], a[176:179], v[128:131]
  v_mfma_f32_16x16x32_bf16 v[132:135], a[128:131], a[176:179], v[132:135]
  v_mfma_f32_16x16x32_bf16 v[136:139], a[224:227], a[200:203], v[136:139]
  v_mfma_f32_16x16x32_bf16 v[140:143], a[128:131], a[200:203], v[140:143]
  v_mfma_f32_16x16x32_bf16 v[144:147], a[152:155], a[200:203], v[144:147]
  s_waitcnt vmcnt(2)
  v_mfma_f32_16x16x32_bf16 v[128:131], a[228:231], a[180:183], v[128:131]
  v_mfma_f32_16x16x32_bf16 v[132:135], a[132:135], a[180:183], v[132:135]
  v_mfma_f32_16x16x32_bf16 v[136:139], a[228:231], a[204:207], v[136:139]
  v_mfma_f32_16x16x32_bf16 v[140:143], a[132:135], a[204:207], v[140:143]
  v_mfma_f32_16x16x32_bf16 v[144:147], a[156:159], a[204:207], v[144:147]
  s_waitcnt vmcnt(1)
  v_mfma_f32_16x16x32_bf16 v[128:131], a[232:235], a[184:187], v[128:131]
  v_mfma_f32_16x16x32_bf16 v[132:135], a[136:139], a[184:187], v[132:135]
  v_mfma_f32_16x16x32_bf16 v[136:139], a[232:235], a[208:211], v[136:139]
  v_mfma_f32_16x16x32_bf16 v[140:143], a[136:139], a[208:211], v[140:143]
  v_mfma_f32_16x16x32_bf16 v[144:147], a[160:163], a[208:211], v[144:147]
  s_waitcnt vmcnt(0)
  v_mfma_f32_16x16x32_bf16 v[128:131], a[236:239], a[188:191], v[128:131]
  v_mfma_f32_16x16x32_bf16 v[132:135], a[140:143], a[188:191], v[132:135]
  v_mfma_f32_16x16x32_bf16 v[136:139], a[236:239], a[212:215], v[136:139]
  v_mfma_f32_16x16x32_bf16 v[140:143], a[140:143], a[212:215], v[140:143]
  v_mfma_f32_16x16x32_bf16 v[144:147], a[164:167], a[212:215], v[144:147]
  s_nop 3
  v_max3_f32 v28, v128, v129, v130
  v_max3_f32 v28, v28, v131, v132
  v_max3_f32 v28, v28, v133, v134
  v_max_f32 v28, v28, v135
  v_mov_b32 v29, v28
  s_nop 1
  v_permlane32_swap_b32 v28, v29
  v_max_f32 v28, v28, v29
  v_mov_b32 v29, v28
  s_nop 1
  v_permlane16_swap_b32 v28, v29
  v_max_f32 v28, v28, v29
  v_mul_f32 v28, s41, v28
  v_fma_f32 v128, v128, s41, -v28
  v_fma_f32 v129, v129, s41, -v28
  v_fma_f32 v130, v130, s41, -v28
  v_fma_f32 v131, v131, s41, -v28
  v_fma_f32 v132, v132, s41, -v28
  v_fma_f32 v133, v133, s41, -v28
  v_fma_f32 v134, v134, s41, -v28
  v_fma_f32 v135, v135, s41, -v28
  v_exp_f32 v128, v128
  v_exp_f32 v129, v129
  v_exp_f32 v130, v130
  v_exp_f32 v131, v131
  v_exp_f32 v132, v132
  v_exp_f32 v133, v133
  v_exp_f32 v134, v134
  v_exp_f32 v135, v135
  v_max3_f32 v30, v136, v137, v138
  v_max3_f32 v30, v30, v139, v140
  v_max3_f32 v30, v30, v141, v142
  v_max3_f32 v30, v30, v143, v144
  v_max3_f32 v30, v30, v145, v146
  v_max_f32 v30, v30, v147
  v_mov_b32 v29, v30
  s_nop 1
  v_permlane32_swap_b32 v30, v29
  v_max_f32 v30, v30, v29
  v_mov_b32 v29, v30
  s_nop 1
  v_permlane16_swap_b32 v30, v29
  v_max_f32 v30, v30, v29
  v_mul_f32 v30, s41, v30
  v_fma_f32 v136, v136, s41, -v30
  v_fma_f32 v137, v137, s41, -v30
  v_fma_f32 v138, v138, s41, -v30
  v_fma_f32 v139, v139, s41, -v30
  v_fma_f32 v140, v140, s41, -v30
  v_fma_f32 v141, v141, s41, -v30
  v_fma_f32 v142, v142, s41, -v30
  v_fma_f32 v143, v143, s41, -v30
  v_fma_f32 v144, v144, s41, -v30
  v_fma_f32 v145, v145, s41, -v30
  v_fma_f32 v146, v146, s41, -v30
  v_fma_f32 v147, v147, s41, -v30
  v_exp_f32 v136, v136
  v_exp_f32 v137, v137
  v_exp_f32 v138, v138
  v_exp_f32 v139, v139
  v_exp_f32 v140, v140
  v_exp_f32 v141, v141
  v_exp_f32 v142, v142
  v_exp_f32 v143, v143
  v_exp_f32 v144, v144
  v_exp_f32 v145, v145
  v_exp_f32 v146, v146
  v_exp_f32 v147, v147
  v_cvt_pk_bf16_f32 v72, v128, v129
  v_cvt_pk_bf16_f32 v73, v130, v131
  v_cvt_pk_bf16_f32 v74, v132, v133
  v_cvt_pk_bf16_f32 v75, v134, v135
  v_cvt_pk_bf16_f32 v76, v136, v137
  v_cvt_pk_bf16_f32 v77, v138, v139
  v_cvt_pk_bf16_f32 v78, v140, v141
  v_cvt_pk_bf16_f32 v79, v142, v143
  v_cvt_pk_bf16_f32 v80, v144, v145
  v_cvt_pk_bf16_f32 v81, v146, v147
  v_mfma_f32_16x16x16_bf16 v[148:151], v[36:37], v[72:73], 0
  v_mfma_f32_16x16x16_bf16 v[152:155], v[36:37], v[76:77], 0
  v_mfma_f32_16x16x16_bf16 v[148:151], v[36:37], v[74:75], v[148:151]
  v_mfma_f32_16x16x32_bf16 v[152:155], v[36:39], v[78:81], v[152:155]
  s_nop 6
  v_rcp_f32 v82, v148
  v_rcp_f32 v83, v152
  s_and_b32 s34, s17, 1
  s_mul_i32 s34, s34, 3072
  v_add_u32 v28, s34, v1
  ds_write_b128 v28, v[72:75] offset:16384
  ds_write_b128 v28, v[76:79] offset:17408
  ds_write_b128 v28, v[80:83] offset:18432
  s_waitcnt lgkmcnt(0)
  s_branch reca_b5207
reca_tw1208:
  s_cmp_lt_u32 s17, 3
  s_cbranch_scc1 reca_b5207
  s_sub_u32 s36, s17, 3
  s_and_b32 s37, s36, 7
  s_lshl_b32 s34, s59, 3
  s_add_u32 s34, s34, s37
  s_mul_i32 s34, s34, 12288
  s_add_u32 s23, s34, 40894464
  s_lshl_b32 s35, s37, 5
  s_add_u32 s35, s35, s59
  s_mul_i32 s35, s35, 3072
  s_add_u32 s61, s35, 47972352
  s_mul_i32 s34, s36, 393216
  s_mul_i32 s35, s59, 6144
  s_add_u32 s34, s34, s35
  s_add_u32 s60, s34, 57147392
  s_add_u32 s34, s17, 1
  s_and_b32 s34, s34, 1
  s_mul_i32 s34, s34, 3072
  v_add_u32 v28, s34, v1
  ds_read_b128 v[72:75], v28 offset:16384
  ds_read_b128 v[76:79], v28 offset:17408
  ds_read_b128 v[80:83], v28 offset:18432
  buffer_load_dwordx2 a[168:169], v93, s[4:7], s61 offen offset:0 sc1
  buffer_load_dwordx4 a[120:123], v1, s[4:7], s23 offen offset:0 sc1
  buffer_load_dwordx2 a[170:171], v93, s[4:7], s61 offen offset:256 sc1
  buffer_load_dwordx4 a[124:127], v1, s[4:7], s23 offen offset:1024 sc1
  buffer_load_dwordx2 a[172:173], v93, s[4:7], s61 offen offset:512 sc1
  buffer_load_dwordx4 a[128:131], v1, s[4:7], s23 offen offset:2048 sc1
  buffer_load_dwordx2 a[174:175], v93, s[4:7], s61 offen offset:768 sc1
  buffer_load_dwordx4 a[132:135], v1, s[4:7], s23 offen offset:3072 sc1
  buffer_load_dwordx2 a[176:177], v93, s[4:7], s61 offen offset:1024 sc1
  buffer_load_dwordx4 a[136:139], v2, s[4:7], s23 offen offset:0 sc1
  buffer_load_dwordx2 a[178:179], v93, s[4:7], s61 offen offset:1280 sc1
  buffer_load_dwordx4 a[140:143], v2, s[4:7], s23 offen offset:1024 sc1
  s_waitcnt lgkmcnt(0)
  s_waitcnt vmcnt(8)
  v_mfma_f32_16x16x16_bf16 v[156:159], a[168:169], v[72:73], 0
  v_mfma_f32_16x16x16_bf16 v[160:163], a[168:169], v[76:77], 0
  v_mfma_f32_16x16x16_bf16 v[156:159], a[120:121], v[74:75], v[156:159]
  v_mfma_f32_16x16x32_bf16 v[160:163], a[120:123], v[78:81], v[160:163]
  v_mfma_f32_16x16x16_bf16 v[164:167], a[170:171], v[72:73], 0
  v_mfma_f32_16x16x16_bf16 v[168:171], a[170:171], v[76:77], 0
  v_mfma_f32_16x16x16_bf16 v[164:167], a[124:125], v[74:75], v[164:167]
  v_mfma_f32_16x16x32_bf16 v[168:171], a[124:127], v[78:81], v[168:171]
  s_nop 2
  v_mul_f32 v156, v156, v82
  v_mul_f32 v157, v157, v82
  v_mul_f32 v158, v158, v82
  v_mul_f32 v159, v159, v82
  v_cvt_pk_bf16_f32 v172, v156, v157
  v_cvt_pk_bf16_f32 v173, v158, v159
  v_mul_f32 v164, v164, v82
  v_mul_f32 v165, v165, v82
  v_mul_f32 v166, v166, v82
  v_mul_f32 v167, v167, v82
  v_cvt_pk_bf16_f32 v174, v164, v165
  v_cvt_pk_bf16_f32 v175, v166, v167
  buffer_store_dwordx4 v[172:175], v1, s[4:7], s60 offen offset:0 sc1
  v_mul_f32 v160, v160, v83
  v_mul_f32 v161, v161, v83
  v_mul_f32 v162, v162, v83
  v_mul_f32 v163, v163, v83
  v_cvt_pk_bf16_f32 v176, v160, v161
  v_cvt_pk_bf16_f32 v177, v162, v163
  v_mul_f32 v168, v168, v83
  v_mul_f32 v169, v169, v83
  v_mul_f32 v170, v170, v83
  v_mul_f32 v171, v171, v83
  v_cvt_pk_bf16_f32 v178, v168, v169
  v_cvt_pk_bf16_f32 v179, v170, v171
  s_add_u32 s34, s60, 196608
  buffer_store_dwordx4 v[176:179], v1, s[4:7], s34 offen offset:0 sc1
  s_waitcnt vmcnt(6)
  v_mfma_f32_16x16x16_bf16 v[156:159], a[172:173], v[72:73], 0
  v_mfma_f32_16x16x16_bf16 v[160:163], a[172:173], v[76:77], 0
  v_mfma_f32_16x16x16_bf16 v[156:159], a[128:129], v[74:75], v[156:159]
  v_mfma_f32_16x16x32_bf16 v[160:163], a[128:131], v[78:81], v[160:163]
  v_mfma_f32_16x16x16_bf16 v[164:167], a[174:175], v[72:73], 0
  v_mfma_f32_16x16x16_bf16 v[168:171], a[174:175], v[76:77], 0
  v_mfma_f32_16x16x16_bf16 v[164:167], a[132:133], v[74:75], v[164:167]
  v_mfma_f32_16x16x32_bf16 v[168:171], a[132:135], v[78:81], v[168:171]
  s_nop 2
  v_mul_f32 v156, v156, v82
  v_mul_f32 v157, v157, v82
  v_mul_f32 v158, v158, v82
  v_mul_f32 v159, v159, v82
  v_cvt_pk_bf16_f32 v172, v156, v157
  v_cvt_pk_bf16_f32 v173, v158, v159
  v_mul_f32 v164, v164, v82
  v_mul_f32 v165, v165, v82
  v_mul_f32 v166, v166, v82
  v_mul_f32 v167, v167, v82
  v_cvt_pk_bf16_f32 v174, v164, v165
  v_cvt_pk_bf16_f32 v175, v166, v167
  buffer_store_dwordx4 v[172:175], v1, s[4:7], s60 offen offset:1024 sc1
  v_mul_f32 v160, v160, v83
  v_mul_f32 v161, v161, v83
  v_mul_f32 v162, v162, v83
  v_mul_f32 v163, v163, v83
  v_cvt_pk_bf16_f32 v176, v160, v161
  v_cvt_pk_bf16_f32 v177, v162, v163
  v_mul_f32 v168, v168, v83
  v_mul_f32 v169, v169, v83
  v_mul_f32 v170, v170, v83
  v_mul_f32 v171, v171, v83
  v_cvt_pk_bf16_f32 v178, v168, v169
  v_cvt_pk_bf16_f32 v179, v170, v171
  s_add_u32 s34, s60, 196608
  buffer_store_dwordx4 v[176:179], v1, s[4:7], s34 offen offset:1024 sc1
  s_waitcnt vmcnt(4)
  v_mfma_f32_16x16x16_bf16 v[156:159], a[176:177], v[72:73], 0
  v_mfma_f32_16x16x16_bf16 v[160:163], a[176:177], v[76:77], 0
  v_mfma_f32_16x16x16_bf16 v[156:159], a[136:137], v[74:75], v[156:159]
  v_mfma_f32_16x16x32_bf16 v[160:163], a[136:139], v[78:81], v[160:163]
  v_mfma_f32_16x16x16_bf16 v[164:167], a[178:179], v[72:73], 0
  v_mfma_f32_16x16x16_bf16 v[168:171], a[178:179], v[76:77], 0
  v_mfma_f32_16x16x16_bf16 v[164:167], a[140:141], v[74:75], v[164:167]
  v_mfma_f32_16x16x32_bf16 v[168:171], a[140:143], v[78:81], v[168:171]
  s_nop 2
  v_mul_f32 v156, v156, v82
  v_mul_f32 v157, v157, v82
  v_mul_f32 v158, v158, v82
  v_mul_f32 v159, v159, v82
  v_cvt_pk_bf16_f32 v172, v156, v157
  v_cvt_pk_bf16_f32 v173, v158, v159
  v_mul_f32 v164, v164, v82
  v_mul_f32 v165, v165, v82
  v_mul_f32 v166, v166, v82
  v_mul_f32 v167, v167, v82
  v_cvt_pk_bf16_f32 v174, v164, v165
  v_cvt_pk_bf16_f32 v175, v166, v167
  buffer_store_dwordx4 v[172:175], v1, s[4:7], s60 offen offset:2048 sc1
  v_mul_f32 v160, v160, v83
  v_mul_f32 v161, v161, v83
  v_mul_f32 v162, v162, v83
  v_mul_f32 v163, v163, v83
  v_cvt_pk_bf16_f32 v176, v160, v161
  v_cvt_pk_bf16_f32 v177, v162, v163
  v_mul_f32 v168, v168, v83
  v_mul_f32 v169, v169, v83
  v_mul_f32 v170, v170, v83
  v_mul_f32 v171, v171, v83
  v_cvt_pk_bf16_f32 v178, v168, v169
  v_cvt_pk_bf16_f32 v179, v170, v171
  s_add_u32 s34, s60, 196608
  buffer_store_dwordx4 v[176:179], v1, s[4:7], s34 offen offset:2048 sc1
  s_branch reca_b5207
reca_tw2209:
  s_cmp_lt_u32 s17, 3
  s_cbranch_scc1 reca_b5207
  s_sub_u32 s36, s17, 3
  s_and_b32 s37, s36, 7
  s_lshl_b32 s34, s59, 3
  s_add_u32 s34, s34, s37
  s_mul_i32 s34, s34, 12288
  s_add_u32 s23, s34, 40894464
  s_lshl_b32 s35, s37, 5
  s_add_u32 s35, s35, s59
  s_mul_i32 s35, s35, 3072
  s_add_u32 s61, s35, 47972352
  s_mul_i32 s34, s36, 393216
  s_mul_i32 s35, s59, 6144
  s_add_u32 s34, s34, s35
  s_add_u32 s60, s34, 57147392
  s_add_u32 s34, s17, 1
  s_and_b32 s34, s34, 1
  s_mul_i32 s34, s34, 3072
  v_add_u32 v28, s34, v1
  ds_read_b128 v[72:75], v28 offset:16384
  ds_read_b128 v[76:79], v28 offset:17408
  ds_read_b128 v[80:83], v28 offset:18432
  buffer_load_dwordx2 a[180:181], v93, s[4:7], s61 offen offset:1536 sc1
  buffer_load_dwordx4 a[144:147], v2, s[4:7], s23 offen offset:2048 sc1
  buffer_load_dwordx2 a[182:183], v93, s[4:7], s61 offen offset:1792 sc1
  buffer_load_dwordx4 a[148:151], v2, s[4:7], s23 offen offset:3072 sc1
  buffer_load_dwordx2 a[184:185], v93, s[4:7], s61 offen offset:2048 sc1
  buffer_load_dwordx4 a[152:155], v3, s[4:7], s23 offen offset:0 sc1
  buffer_load_dwordx2 a[186:187], v93, s[4:7], s61 offen offset:2304 sc1
  buffer_load_dwordx4 a[156:159], v3, s[4:7], s23 offen offset:1024 sc1
  buffer_load_dwordx2 a[188:189], v93, s[4:7], s61 offen offset:2560 sc1
  buffer_load_dwordx4 a[160:163], v3, s[4:7], s23 offen offset:2048 sc1
  buffer_load_dwordx2 a[190:191], v93, s[4:7], s61 offen offset:2816 sc1
  buffer_load_dwordx4 a[164:167], v3, s[4:7], s23 offen offset:3072 sc1
  s_waitcnt lgkmcnt(0)
  s_waitcnt vmcnt(8)
  v_mfma_f32_16x16x16_bf16 v[156:159], a[180:181], v[72:73], 0
  v_mfma_f32_16x16x16_bf16 v[160:163], a[180:181], v[76:77], 0
  v_mfma_f32_16x16x16_bf16 v[156:159], a[144:145], v[74:75], v[156:159]
  v_mfma_f32_16x16x32_bf16 v[160:163], a[144:147], v[78:81], v[160:163]
  v_mfma_f32_16x16x16_bf16 v[164:167], a[182:183], v[72:73], 0
  v_mfma_f32_16x16x16_bf16 v[168:171], a[182:183], v[76:77], 0
  v_mfma_f32_16x16x16_bf16 v[164:167], a[148:149], v[74:75], v[164:167]
  v_mfma_f32_16x16x32_bf16 v[168:171], a[148:151], v[78:81], v[168:171]
  s_nop 2
  v_mul_f32 v156, v156, v82
  v_mul_f32 v157, v157, v82
  v_mul_f32 v158, v158, v82
  v_mul_f32 v159, v159, v82
  v_cvt_pk_bf16_f32 v172, v156, v157
  v_cvt_pk_bf16_f32 v173, v158, v159
  v_mul_f32 v164, v164, v82
  v_mul_f32 v165, v165, v82
  v_mul_f32 v166, v166, v82
  v_mul_f32 v167, v167, v82
  v_cvt_pk_bf16_f32 v174, v164, v165
  v_cvt_pk_bf16_f32 v175, v166, v167
  buffer_store_dwordx4 v[172:175], v1, s[4:7], s60 offen offset:3072 sc1
  v_mul_f32 v160, v160, v83
  v_mul_f32 v161, v161, v83
  v_mul_f32 v162, v162, v83
  v_mul_f32 v163, v163, v83
  v_cvt_pk_bf16_f32 v176, v160, v161
  v_cvt_pk_bf16_f32 v177, v162, v163
  v_mul_f32 v168, v168, v83
  v_mul_f32 v169, v169, v83
  v_mul_f32 v170, v170, v83
  v_mul_f32 v171, v171, v83
  v_cvt_pk_bf16_f32 v178, v168, v169
  v_cvt_pk_bf16_f32 v179, v170, v171
  s_add_u32 s34, s60, 196608
  buffer_store_dwordx4 v[176:179], v1, s[4:7], s34 offen offset:3072 sc1
  s_waitcnt vmcnt(6)
  v_mfma_f32_16x16x16_bf16 v[156:159], a[184:185], v[72:73], 0
  v_mfma_f32_16x16x16_bf16 v[160:163], a[184:185], v[76:77], 0
  v_mfma_f32_16x16x16_bf16 v[156:159], a[152:153], v[74:75], v[156:159]
  v_mfma_f32_16x16x32_bf16 v[160:163], a[152:155], v[78:81], v[160:163]
  v_mfma_f32_16x16x16_bf16 v[164:167], a[186:187], v[72:73], 0
  v_mfma_f32_16x16x16_bf16 v[168:171], a[186:187], v[76:77], 0
  v_mfma_f32_16x16x16_bf16 v[164:167], a[156:157], v[74:75], v[164:167]
  v_mfma_f32_16x16x32_bf16 v[168:171], a[156:159], v[78:81], v[168:171]
  s_nop 2
  v_mul_f32 v156, v156, v82
  v_mul_f32 v157, v157, v82
  v_mul_f32 v158, v158, v82
  v_mul_f32 v159, v159, v82
  v_cvt_pk_bf16_f32 v172, v156, v157
  v_cvt_pk_bf16_f32 v173, v158, v159
  v_mul_f32 v164, v164, v82
  v_mul_f32 v165, v165, v82
  v_mul_f32 v166, v166, v82
  v_mul_f32 v167, v167, v82
  v_cvt_pk_bf16_f32 v174, v164, v165
  v_cvt_pk_bf16_f32 v175, v166, v167
  buffer_store_dwordx4 v[172:175], v2, s[4:7], s60 offen offset:0 sc1
  v_mul_f32 v160, v160, v83
  v_mul_f32 v161, v161, v83
  v_mul_f32 v162, v162, v83
  v_mul_f32 v163, v163, v83
  v_cvt_pk_bf16_f32 v176, v160, v161
  v_cvt_pk_bf16_f32 v177, v162, v163
  v_mul_f32 v168, v168, v83
  v_mul_f32 v169, v169, v83
  v_mul_f32 v170, v170, v83
  v_mul_f32 v171, v171, v83
  v_cvt_pk_bf16_f32 v178, v168, v169
  v_cvt_pk_bf16_f32 v179, v170, v171
  s_add_u32 s34, s60, 196608
  buffer_store_dwordx4 v[176:179], v2, s[4:7], s34 offen offset:0 sc1
  s_waitcnt vmcnt(4)
  v_mfma_f32_16x16x16_bf16 v[156:159], a[188:189], v[72:73], 0
  v_mfma_f32_16x16x16_bf16 v[160:163], a[188:189], v[76:77], 0
  v_mfma_f32_16x16x16_bf16 v[156:159], a[160:161], v[74:75], v[156:159]
  v_mfma_f32_16x16x32_bf16 v[160:163], a[160:163], v[78:81], v[160:163]
  v_mfma_f32_16x16x16_bf16 v[164:167], a[190:191], v[72:73], 0
  v_mfma_f32_16x16x16_bf16 v[168:171], a[190:191], v[76:77], 0
  v_mfma_f32_16x16x16_bf16 v[164:167], a[164:165], v[74:75], v[164:167]
  v_mfma_f32_16x16x32_bf16 v[168:171], a[164:167], v[78:81], v[168:171]
  s_nop 2
  v_mul_f32 v156, v156, v82
  v_mul_f32 v157, v157, v82
  v_mul_f32 v158, v158, v82
  v_mul_f32 v159, v159, v82
  v_cvt_pk_bf16_f32 v172, v156, v157
  v_cvt_pk_bf16_f32 v173, v158, v159
  v_mul_f32 v164, v164, v82
  v_mul_f32 v165, v165, v82
  v_mul_f32 v166, v166, v82
  v_mul_f32 v167, v167, v82
  v_cvt_pk_bf16_f32 v174, v164, v165
  v_cvt_pk_bf16_f32 v175, v166, v167
  buffer_store_dwordx4 v[172:175], v2, s[4:7], s60 offen offset:1024 sc1
  v_mul_f32 v160, v160, v83
  v_mul_f32 v161, v161, v83
  v_mul_f32 v162, v162, v83
  v_mul_f32 v163, v163, v83
  v_cvt_pk_bf16_f32 v176, v160, v161
  v_cvt_pk_bf16_f32 v177, v162, v163
  v_mul_f32 v168, v168, v83
  v_mul_f32 v169, v169, v83
  v_mul_f32 v170, v170, v83
  v_mul_f32 v171, v171, v83
  v_cvt_pk_bf16_f32 v178, v168, v169
  v_cvt_pk_bf16_f32 v179, v170, v171
  s_add_u32 s34, s60, 196608
  buffer_store_dwordx4 v[176:179], v2, s[4:7], s34 offen offset:1024 sc1
  s_branch reca_b5207
  s_cmp_lg_u32 s12, 2
  s_cbranch_scc1 reca_b3205
  buffer_store_dwordx2 v[52:53], v9, s[4:7], s30 offen sc1
  buffer_store_dwordx2 v[32:33], v16, s[4:7], s26 offen sc1
  s_cmp_lg_u32 s14, 0
  s_cbranch_scc1 reca_b3205
  v_mov_b32 v28, s17
  s_lshl_b32 s34, s13, 7
  s_add_u32 s34, s34, 1507328
  buffer_store_dword v28, v19, s[4:7], s34 offen sc1
  s_branch reca_b3205
reca_last204:
  s_cmp_lg_u32 s12, 2
  s_cbranch_scc1 reca_exit1
  buffer_store_dwordx2 v[52:53], v9, s[4:7], s30 offen
  s_branch reca_exit1
reca_swave202:
  s_cmp_lg_u32 s17, 63
  s_cbranch_scc1 reca_vmst210
  s_barrier
  ds_read_b128 v[56:59], v1 offset:10240
  ds_read_b128 v[60:63], v1 offset:11264
  ds_read_b128 v[64:67], v1 offset:12288
  s_waitcnt lgkmcnt(0)
  v_add_f32 v56, v56, v64
  v_add_f32 v60, v60, v48
  v_add_f32 v57, v57, v65
  v_add_f32 v61, v61, v49
  v_add_f32 v58, v58, v66
  v_add_f32 v62, v62, v50
  v_add_f32 v59, v59, v67
  v_add_f32 v63, v63, v51
  v_cvt_pk_bf16_f32 v68, v56, v57
  v_cvt_pk_bf16_f32 v69, v58, v59
  v_cvt_pk_bf16_f32 v70, v60, v61
  v_cvt_pk_bf16_f32 v71, v62, v63
  buffer_store_dwordx2 v[52:53], v9, s[4:7], s30 offen
  buffer_store_dwordx2 v[68:69], v10, s[4:7], s31 offen
  buffer_store_dwordx2 v[70:71], v10, s[4:7], s31 offen offset:256
  s_branch reca_exit1
reca_vmst210:
  s_sleep 1
  buffer_load_dwordx4 v[208:211], v1, s[4:7], s21 offen offset:0 sc1
  buffer_load_dwordx4 v[212:215], v1, s[4:7], s21 offen offset:1024 sc1
  buffer_load_dwordx4 v[216:219], v1, s[4:7], s21 offen offset:2048 sc1
  buffer_load_dwordx4 v[220:223], v1, s[4:7], s21 offen offset:3072 sc1
  buffer_load_dwordx4 v[224:227], v2, s[4:7], s21 offen offset:0 sc1
  buffer_load_dwordx4 v[228:231], v2, s[4:7], s21 offen offset:1024 sc1
  s_waitcnt vmcnt(5)
  v_max_u32 v29, v208, v210
  v_cmp_eq_u32 vcc, -1, v29
  s_cbranch_vccnz reca_retry211
reca_resume212:
  s_waitcnt vmcnt(4)
  v_max_u32 v29, v212, v214
  v_cmp_eq_u32 vcc, -1, v29
  v_mfma_f32_16x16x32_bf16 v[76:79], a[120:123], v[208:211], 0
  v_mfma_f32_16x16x32_bf16 v[80:83], a[144:147], v[208:211], 0
  v_mfma_f32_16x16x32_bf16 v[72:75], v[208:211], v[208:211], v[40:43]
  s_cbranch_vccnz reca_retry213
reca_resume214:
  s_waitcnt vmcnt(3)
  v_max_u32 v29, v216, v218
  v_cmp_eq_u32 vcc, -1, v29
  v_mfma_f32_16x16x32_bf16 v[76:79], a[124:127], v[212:215], v[76:79]
  v_mfma_f32_16x16x32_bf16 v[80:83], a[148:151], v[212:215], v[80:83]
  v_mfma_f32_16x16x32_bf16 v[72:75], v[212:215], v[212:215], v[72:75]
  s_cbranch_vccnz reca_retry215
reca_resume216:
  s_waitcnt vmcnt(2)
  v_max_u32 v29, v220, v222
  v_cmp_eq_u32 vcc, -1, v29
  v_mfma_f32_16x16x32_bf16 v[76:79], a[128:131], v[216:219], v[76:79]
  v_mfma_f32_16x16x32_bf16 v[80:83], a[152:155], v[216:219], v[80:83]
  v_mfma_f32_16x16x32_bf16 v[72:75], v[216:219], v[216:219], v[72:75]
  s_cbranch_vccnz reca_retry217
reca_resume218:
  s_waitcnt vmcnt(1)
  v_max_u32 v29, v224, v226
  v_cmp_eq_u32 vcc, -1, v29
  v_mfma_f32_16x16x32_bf16 v[76:79], a[132:135], v[220:223], v[76:79]
  v_mfma_f32_16x16x32_bf16 v[80:83], a[156:159], v[220:223], v[80:83]
  v_mfma_f32_16x16x32_bf16 v[72:75], v[220:223], v[220:223], v[72:75]
  s_cbranch_vccnz reca_retry219
reca_resume220:
  s_waitcnt vmcnt(0)
  v_max_u32 v29, v228, v230
  v_cmp_eq_u32 vcc, -1, v29
  v_mfma_f32_16x16x32_bf16 v[76:79], a[136:139], v[224:227], v[76:79]
  v_mfma_f32_16x16x32_bf16 v[80:83], a[160:163], v[224:227], v[80:83]
  v_mfma_f32_16x16x32_bf16 v[72:75], v[224:227], v[224:227], v[72:75]
  s_cbranch_vccnz reca_retry221
reca_resume222:
  v_mfma_f32_16x16x32_bf16 v[76:79], a[140:143], v[228:231], v[76:79]
  v_mfma_f32_16x16x32_bf16 v[80:83], a[164:167], v[228:231], v[80:83]
  v_mfma_f32_16x16x32_bf16 v[72:75], v[228:231], v[228:231], v[72:75]
  s_barrier
  ds_read_b128 v[56:59], v1 offset:10240
  ds_read_b128 v[60:63], v1 offset:11264
  ds_read_b128 v[64:67], v1 offset:12288
  s_nop 1
  v_max3_f32 v28, v76, v77, v78
  v_max3_f32 v29, v80, v81, v82
  v_max3_f32 v28, v28, v79, v83
  v_max3_f32 v29, v29, v72, v73
  v_max3_f32 v28, v28, v74, v75
  v_max_f32 v28, v28, v29
  v_mov_b32 v29, v28
  s_nop 1
  v_permlane32_swap_b32 v28, v29
  v_max_f32 v28, v28, v29
  v_mov_b32 v29, v28
  s_nop 1
  v_permlane16_swap_b32 v28, v29
  v_max_f32 v28, v28, v29
  v_mul_f32 v28, s41, v28
  v_fma_f32 v76, v76, s41, -v28
  v_fma_f32 v77, v77, s41, -v28
  v_fma_f32 v78, v78, s41, -v28
  v_fma_f32 v79, v79, s41, -v28
  v_fma_f32 v80, v80, s41, -v28
  v_fma_f32 v81, v81, s41, -v28
  v_fma_f32 v82, v82, s41, -v28
  v_fma_f32 v83, v83, s41, -v28
  v_fma_f32 v72, v72, s41, -v28
  v_fma_f32 v73, v73, s41, -v28
  v_fma_f32 v74, v74, s41, -v28
  v_fma_f32 v75, v75, s41, -v28
  v_exp_f32 v76, v76
  v_exp_f32 v77, v77
  v_exp_f32 v78, v78
  v_exp_f32 v79, v79
  v_exp_f32 v80, v80
  v_exp_f32 v81, v81
  v_exp_f32 v82, v82
  v_exp_f32 v83, v83
  v_cvt_pk_bf16_f32 v84, v76, v77
  v_cvt_pk_bf16_f32 v85, v78, v79
  v_cvt_pk_bf16_f32 v86, v80, v81
  v_cvt_pk_bf16_f32 v87, v82, v83
  v_exp_f32 v72, v72
  v_exp_f32 v73, v73
  v_mfma_f32_16x16x32_bf16 v[100:103], v[36:39], v[84:87], 0
  v_exp_f32 v74, v74
  v_exp_f32 v75, v75
  v_mfma_f32_16x16x32_bf16 v[92:95], a[168:171], v[84:87], 0
  v_cvt_pk_bf16_f32 v88, v72, v73
  v_cvt_pk_bf16_f32 v89, v74, v75
  v_mfma_f32_16x16x32_bf16 v[96:99], a[172:175], v[84:87], 0
  s_waitcnt lgkmcnt(0)
  v_mfma_f32_16x16x16_bf16 v[100:103], v[36:37], v[88:89], v[100:103]
  v_add_f32 v56, v56, v64
  v_add_f32 v60, v60, v48
  v_add_f32 v57, v57, v65
  v_add_f32 v61, v61, v49
  v_add_f32 v58, v58, v66
  v_add_f32 v62, v62, v50
  v_add_f32 v59, v59, v67
  v_add_f32 v63, v63, v51
  v_cvt_pk_bf16_f32 v68, v56, v57
  v_cvt_pk_bf16_f32 v69, v58, v59
  v_cvt_pk_bf16_f32 v70, v60, v61
  v_cvt_pk_bf16_f32 v71, v62, v63
  v_mfma_f32_16x16x16_bf16 v[92:95], v[68:69], v[88:89], v[92:95]
  v_rcp_f32 v28, v100
  v_mfma_f32_16x16x16_bf16 v[96:99], v[70:71], v[88:89], v[96:99]
  v_mov_b32 v29, v28
  s_nop 4
  v_pk_mul_f32 v[92:93], v[92:93], v[28:29]
  v_pk_mul_f32 v[94:95], v[94:95], v[28:29]
  v_pk_mul_f32 v[96:97], v[96:97], v[28:29]
  v_pk_mul_f32 v[98:99], v[98:99], v[28:29]
  v_cvt_pk_bf16_f32 v104, v92, v93
  v_cvt_pk_bf16_f32 v105, v94, v95
  v_cvt_pk_bf16_f32 v106, v96, v97
  v_cvt_pk_bf16_f32 v107, v98, v99
  buffer_store_dwordx4 v[104:107], v11, s[4:7], s22 offen sc1
  s_barrier
  s_add_u32 s34, s17, 2
  s_and_b32 s34, s34, 3
  s_mul_i32 s26, s34, 10240
  s_add_u32 s26, s26, s38
  s_mul_i32 s27, s34, 6144
  s_add_u32 s27, s27, s39
  s_mul_i32 s28, s34, 12288
  s_add_u32 s28, s28, s40
  s_mul_i32 s29, s34, 393216
  s_add_u32 s29, s29, s56
  buffer_store_dwordx2 v[32:33], v8, s[4:7], s27 offen sc1
  buffer_store_dwordx4 v[32:35], v11, s[4:7], s28 offen sc1
  s_add_u32 s36, s17, 1
  s_cmp_ge_u32 s36, 63
  s_cbranch_scc1 reca_nopf223
  s_add_u32 s37, s36, 1
reca_pf224:
  buffer_load_dword v28, v233, s[4:7], 0 offen sc1
  s_waitcnt vmcnt(0)
  v_cmp_gt_i32 vcc, s37, v28
  s_cbranch_vccz reca_pfok225
  s_sleep 1
  s_sub_u32 s18, s18, 1
  s_cbranch_scc0 reca_pf224
  s_mov_b32 s18, 0
reca_pfok225:
  s_lshl_b32 s34, s15, 3
  s_and_b32 s35, s36, 7
  s_add_u32 s34, s34, s35
  s_mul_i32 s34, s34, 12288
  s_add_u32 s32, s34, 37748736
  s_lshl_b32 s35, s16, 11
  s_add_u32 s34, s34, s35
  s_add_u32 s33, s34, 40894464
  buffer_load_dwordx4 a[120:123], v1, s[4:7], s32 offen offset:0 sc1
  buffer_load_dwordx4 a[124:127], v1, s[4:7], s32 offen offset:1024 sc1
  buffer_load_dwordx4 a[128:131], v1, s[4:7], s32 offen offset:2048 sc1
  buffer_load_dwordx4 a[132:135], v1, s[4:7], s32 offen offset:3072 sc1
  buffer_load_dwordx4 a[136:139], v2, s[4:7], s32 offen offset:0 sc1
  buffer_load_dwordx4 a[140:143], v2, s[4:7], s32 offen offset:1024 sc1
  buffer_load_dwordx4 a[144:147], v2, s[4:7], s32 offen offset:2048 sc1
  buffer_load_dwordx4 a[148:151], v2, s[4:7], s32 offen offset:3072 sc1
  buffer_load_dwordx4 a[152:155], v3, s[4:7], s32 offen offset:0 sc1
  buffer_load_dwordx4 a[156:159], v3, s[4:7], s32 offen offset:1024 sc1
  buffer_load_dwordx4 a[160:163], v3, s[4:7], s32 offen offset:2048 sc1
  buffer_load_dwordx4 a[164:167], v3, s[4:7], s32 offen offset:3072 sc1
  buffer_load_dwordx4 a[168:171], v1, s[4:7], s33 offen offset:0 sc1
  buffer_load_dwordx4 a[172:175], v1, s[4:7], s33 offen offset:1024 sc1
reca_nopf223:
  buffer_store_dwordx2 v[52:53], v9, s[4:7], s30 offen sc1
  buffer_store_dwordx2 v[68:69], v10, s[4:7], s31 offen sc1
  buffer_store_dwordx2 v[70:71], v10, s[4:7], s31 offen offset:256 sc1
reca_b5207:
  s_barrier
  s_add_u32 s17, s17, 1
  s_branch reca_step193
reca_b3205:
  s_endpgm
reca_retry196:
  s_sub_u32 s18, s18, 1
  s_cbranch_scc1 reca_retry196_to
  buffer_load_dwordx4 v[128:131], v4, s[4:7], s20 offen sc1
  buffer_load_dwordx4 v[132:135], v4, s[4:7], s20 offen offset:1024 sc1
  buffer_load_dwordx4 v[136:139], v5, s[4:7], s20 offen sc1
  s_waitcnt vmcnt(2)
  v_max_u32 v29, v128, v130
  v_cmp_eq_u32 vcc, -1, v29
  s_cbranch_vccnz reca_retry196
  s_branch reca_resume197
reca_retry196_to:
  s_mov_b32 s18, 0
  s_waitcnt vmcnt(0)
  s_branch reca_resume197
reca_retry198:
  s_sub_u32 s18, s18, 1
  s_cbranch_scc1 reca_retry198_to
  buffer_load_dwordx4 v[132:135], v4, s[4:7], s20 offen offset:1024 sc1
  buffer_load_dwordx4 v[136:139], v5, s[4:7], s20 offen sc1
  s_waitcnt vmcnt(1)
  v_max_u32 v29, v132, v134
  v_cmp_eq_u32 vcc, -1, v29
  s_cbranch_vccnz reca_retry198
  s_branch reca_resume199
reca_retry198_to:
  s_mov_b32 s18, 0
  s_waitcnt vmcnt(0)
  s_branch reca_resume199
reca_retry200:
  s_sub_u32 s18, s18, 1
  s_cbranch_scc1 reca_retry200_to
  buffer_load_dwordx4 v[136:139], v5, s[4:7], s20 offen sc1
  s_waitcnt vmcnt(0)
  v_max_u32 v29, v136, v138
  v_cmp_eq_u32 vcc, -1, v29
  s_cbranch_vccnz reca_retry200
  s_branch reca_resume201
reca_retry200_to:
  s_mov_b32 s18, 0
  s_waitcnt vmcnt(0)
  s_branch reca_resume201
reca_retry211:
  s_sub_u32 s18, s18, 1
  s_cbranch_scc1 reca_retry211_to
  buffer_load_dwordx4 v[208:211], v1, s[4:7], s21 offen offset:0 sc1
  buffer_load_dwordx4 v[212:215], v1, s[4:7], s21 offen offset:1024 sc1
  buffer_load_dwordx4 v[216:219], v1, s[4:7], s21 offen offset:2048 sc1
  buffer_load_dwordx4 v[220:223], v1, s[4:7], s21 offen offset:3072 sc1
  buffer_load_dwordx4 v[224:227], v2, s[4:7], s21 offen offset:0 sc1
  buffer_load_dwordx4 v[228:231], v2, s[4:7], s21 offen offset:1024 sc1
  s_waitcnt vmcnt(5)
  v_max_u32 v29, v208, v210
  v_cmp_eq_u32 vcc, -1, v29
  s_cbranch_vccnz reca_retry211
  s_branch reca_resume212
reca_retry211_to:
  s_mov_b32 s18, 0
  s_waitcnt vmcnt(0)
  s_branch reca_resume212
reca_retry213:
  s_sub_u32 s18, s18, 1
  s_cbranch_scc1 reca_retry213_to
  buffer_load_dwordx4 v[212:215], v1, s[4:7], s21 offen offset:1024 sc1
  buffer_load_dwordx4 v[216:219], v1, s[4:7], s21 offen offset:2048 sc1
  buffer_load_dwordx4 v[220:223], v1, s[4:7], s21 offen offset:3072 sc1
  buffer_load_dwordx4 v[224:227], v2, s[4:7], s21 offen offset:0 sc1
  buffer_load_dwordx4 v[228:231], v2, s[4:7], s21 offen offset:1024 sc1
  s_waitcnt vmcnt(4)
  v_max_u32 v29, v212, v214
  v_cmp_eq_u32 vcc, -1, v29
  s_cbranch_vccnz reca_retry213
  s_branch reca_resume214
reca_retry213_to:
  s_mov_b32 s18, 0
  s_waitcnt vmcnt(0)
  s_branch reca_resume214
reca_retry215:
  s_sub_u32 s18, s18, 1
  s_cbranch_scc1 reca_retry215_to
  buffer_load_dwordx4 v[216:219], v1, s[4:7], s21 offen offset:2048 sc1
  buffer_load_dwordx4 v[220:223], v1, s[4:7], s21 offen offset:3072 sc1
  buffer_load_dwordx4 v[224:227], v2, s[4:7], s21 offen offset:0 sc1
  buffer_load_dwordx4 v[228:231], v2, s[4:7], s21 offen offset:1024 sc1
  s_waitcnt vmcnt(3)
  v_max_u32 v29, v216, v218
  v_cmp_eq_u32 vcc, -1, v29
  s_cbranch_vccnz reca_retry215
  s_branch reca_resume216
reca_retry215_to:
  s_mov_b32 s18, 0
  s_waitcnt vmcnt(0)
  s_branch reca_resume216
reca_retry217:
  s_sub_u32 s18, s18, 1
  s_cbranch_scc1 reca_retry217_to
  buffer_load_dwordx4 v[220:223], v1, s[4:7], s21 offen offset:3072 sc1
  buffer_load_dwordx4 v[224:227], v2, s[4:7], s21 offen offset:0 sc1
  buffer_load_dwordx4 v[228:231], v2, s[4:7], s21 offen offset:1024 sc1
  s_waitcnt vmcnt(2)
  v_max_u32 v29, v220, v222
  v_cmp_eq_u32 vcc, -1, v29
  s_cbranch_vccnz reca_retry217
  s_branch reca_resume218
reca_retry217_to:
  s_mov_b32 s18, 0
  s_waitcnt vmcnt(0)
  s_branch reca_resume218
reca_retry219:
  s_sub_u32 s18, s18, 1
  s_cbranch_scc1 reca_retry219_to
  buffer_load_dwordx4 v[224:227], v2, s[4:7], s21 offen offset:0 sc1
  buffer_load_dwordx4 v[228:231], v2, s[4:7], s21 offen offset:1024 sc1
  s_waitcnt vmcnt(1)
  v_max_u32 v29, v224, v226
  v_cmp_eq_u32 vcc, -1, v29
  s_cbranch_vccnz reca_retry219
  s_branch reca_resume220
reca_retry219_to:
  s_mov_b32 s18, 0
  s_waitcnt vmcnt(0)
  s_branch reca_resume220
reca_retry221:
  s_sub_u32 s18, s18, 1
  s_cbranch_scc1 reca_retry221_to
  buffer_load_dwordx4 v[228:231], v2, s[4:7], s21 offen offset:1024 sc1
  s_waitcnt vmcnt(0)
  v_max_u32 v29, v228, v230
  v_cmp_eq_u32 vcc, -1, v29
  s_cbranch_vccnz reca_retry221
  s_branch reca_resume222
reca_retry221_to:
  s_mov_b32 s18, 0
  s_waitcnt vmcnt(0)
  s_branch reca_resume222
reca_proj2:
  s_sub_u32 s34, s14, 24
  s_lshr_b32 s35, s34, 1
  s_and_b32 s16, s34, 1
  s_lshl_b32 s15, s13, 2
  s_add_u32 s15, s15, s35
  s_lshl_b32 s24, s13, 3
  s_add_u32 s24, s24, s34
  s_lshl_b32 s24, s24, 7
  s_add_u32 s24, s24, 1540096
  s_lshl_b32 s25, s13, 7
  s_add_u32 s25, s25, 1507328
  v_and_b32 v28, 63, v0
  v_lshlrev_b32 v1, 4, v28
  v_mov_b32 v29, 0x80000000
  v_cmp_eq_u32 vcc, 0, v28
  v_mov_b32 v4, 0
  s_nop 0
  v_cndmask_b32 v4, v29, v4, vcc
  v_cmp_gt_u32 vcc, 32, v28
  s_nop 1
  v_cndmask_b32 v5, v29, v1, vcc
  s_cmp_eq_u32 s12, 0
  s_cbranch_scc1 reca_pw0_226
  s_cmp_eq_u32 s12, 1
  s_cbranch_scc1 reca_pw1_227
  s_cmp_eq_u32 s12, 2
  s_cbranch_scc1 reca_pw2_228
  s_branch reca_pw3_229
reca_pw0_226:
  s_mov_b32 s17, 0
  s_mov_b32 s26, 0
  s_mul_i32 s20, s17, 40960
  s_add_u32 s20, s20, 84934656
  s_add_u32 m0, s26, 0
  s_nop 0
  buffer_load_dwordx4 v1, s[4:7], s20 offen offset:0 lds
  buffer_load_dwordx4 v1, s[4:7], s20 offen offset:1024 lds
  buffer_load_dwordx4 v1, s[4:7], s20 offen offset:2048 lds
  buffer_load_dwordx4 v1, s[4:7], s20 offen offset:3072 lds
  s_add_u32 s20, s20, 4096
  s_add_u32 m0, s26, 4096
  s_nop 0
  buffer_load_dwordx4 v1, s[4:7], s20 offen offset:0 lds
  buffer_load_dwordx4 v1, s[4:7], s20 offen offset:1024 lds
  buffer_load_dwordx4 v1, s[4:7], s20 offen offset:2048 lds
  buffer_load_dwordx4 v1, s[4:7], s20 offen offset:3072 lds
  s_add_u32 s20, s20, 4096
  s_add_u32 m0, s26, 8192
  s_nop 0
  buffer_load_dwordx4 v1, s[4:7], s20 offen offset:0 lds
  buffer_load_dwordx4 v1, s[4:7], s20 offen offset:1024 lds
  s_mul_i32 s34, s15, 12
  s_mul_i32 s35, s16, 6
  s_add_u32 s34, s34, s35
  s_add_u32 s34, s34, 0
  s_mul_i32 s34, s34, 20480
  s_add_u32 s34, s34, 14155776
  buffer_load_dwordx4 a[0:3], v1, s[4:7], s34 offen offset:0
  buffer_load_dwordx4 a[4:7], v1, s[4:7], s34 offen offset:1024
  buffer_load_dwordx4 a[8:11], v1, s[4:7], s34 offen offset:2048
  buffer_load_dwordx4 a[12:15], v1, s[4:7], s34 offen offset:3072
  s_add_u32 s34, s34, 4096
  buffer_load_dwordx4 a[16:19], v1, s[4:7], s34 offen offset:0
  buffer_load_dwordx4 a[20:23], v1, s[4:7], s34 offen offset:1024
  buffer_load_dwordx4 a[24:27], v1, s[4:7], s34 offen offset:2048
  buffer_load_dwordx4 a[28:31], v1, s[4:7], s34 offen offset:3072
  s_add_u32 s34, s34, 4096
  buffer_load_dwordx4 a[32:35], v1, s[4:7], s34 offen offset:0
  buffer_load_dwordx4 a[36:39], v1, s[4:7], s34 offen offset:1024
  buffer_load_dwordx4 a[40:43], v1, s[4:7], s34 offen offset:2048
  buffer_load_dwordx4 a[44:47], v1, s[4:7], s34 offen offset:3072
  s_add_u32 s34, s34, 4096
  buffer_load_dwordx4 a[48:51], v1, s[4:7], s34 offen offset:0
  buffer_load_dwordx4 a[52:55], v1, s[4:7], s34 offen offset:1024
  buffer_load_dwordx4 a[56:59], v1, s[4:7], s34 offen offset:2048
  buffer_load_dwordx4 a[60:63], v1, s[4:7], s34 offen offset:3072
  s_add_u32 s34, s34, 4096
  buffer_load_dwordx4 a[64:67], v1, s[4:7], s34 offen offset:0
  buffer_load_dwordx4 a[68:71], v1, s[4:7], s34 offen offset:1024
  buffer_load_dwordx4 a[72:75], v1, s[4:7], s34 offen offset:2048
  buffer_load_dwordx4 a[76:79], v1, s[4:7], s34 offen offset:3072
  s_mul_i32 s34, s15, 12
  s_mul_i32 s35, s16, 6
  s_add_u32 s34, s34, s35
  s_add_u32 s34, s34, 1
  s_mul_i32 s34, s34, 20480
  s_add_u32 s34, s34, 14155776
  buffer_load_dwordx4 a[80:83], v1, s[4:7], s34 offen offset:0
  buffer_load_dwordx4 a[84:87], v1, s[4:7], s34 offen offset:1024
  buffer_load_dwordx4 a[88:91], v1, s[4:7], s34 offen offset:2048
  buffer_load_dwordx4 a[92:95], v1, s[4:7], s34 offen offset:3072
  s_add_u32 s34, s34, 4096
  buffer_load_dwordx4 a[96:99], v1, s[4:7], s34 offen offset:0
  buffer_load_dwordx4 a[100:103], v1, s[4:7], s34 offen offset:1024
  buffer_load_dwordx4 a[104:107], v1, s[4:7], s34 offen offset:2048
  buffer_load_dwordx4 a[108:111], v1, s[4:7], s34 offen offset:3072
  s_add_u32 s34, s34, 4096
  buffer_load_dwordx4 a[112:115], v1, s[4:7], s34 offen offset:0
  buffer_load_dwordx4 a[116:119], v1, s[4:7], s34 offen offset:1024
  buffer_load_dwordx4 a[120:123], v1, s[4:7], s34 offen offset:2048
  buffer_load_dwordx4 a[124:127], v1, s[4:7], s34 offen offset:3072
  s_add_u32 s34, s34, 4096
  buffer_load_dwordx4 a[128:131], v1, s[4:7], s34 offen offset:0
  buffer_load_dwordx4 a[132:135], v1, s[4:7], s34 offen offset:1024
  buffer_load_dwordx4 a[136:139], v1, s[4:7], s34 offen offset:2048
  buffer_load_dwordx4 a[140:143], v1, s[4:7], s34 offen offset:3072
  s_add_u32 s34, s34, 4096
  buffer_load_dwordx4 a[144:147], v1, s[4:7], s34 offen offset:0
  buffer_load_dwordx4 a[148:151], v1, s[4:7], s34 offen offset:1024
  buffer_load_dwordx4 a[152:155], v1, s[4:7], s34 offen offset:2048
  buffer_load_dwordx4 a[156:159], v1, s[4:7], s34 offen offset:3072
  s_waitcnt vmcnt(20)
  s_mul_i32 s34, s15, 12
  s_mul_i32 s35, s16, 6
  s_add_u32 s34, s34, s35
  s_add_u32 s34, s34, 2
  s_mul_i32 s34, s34, 20480
  s_add_u32 s34, s34, 14155776
  buffer_load_dwordx4 a[160:163], v1, s[4:7], s34 offen offset:0
  buffer_load_dwordx4 a[164:167], v1, s[4:7], s34 offen offset:1024
  buffer_load_dwordx4 a[168:171], v1, s[4:7], s34 offen offset:2048
  buffer_load_dwordx4 a[172:175], v1, s[4:7], s34 offen offset:3072
  s_add_u32 s34, s34, 4096
  buffer_load_dwordx4 a[176:179], v1, s[4:7], s34 offen offset:0
  buffer_load_dwordx4 a[180:183], v1, s[4:7], s34 offen offset:1024
  buffer_load_dwordx4 a[184:187], v1, s[4:7], s34 offen offset:2048
  buffer_load_dwordx4 a[188:191], v1, s[4:7], s34 offen offset:3072
  s_add_u32 s34, s34, 4096
  buffer_load_dwordx4 a[192:195], v1, s[4:7], s34 offen offset:0
  buffer_load_dwordx4 a[196:199], v1, s[4:7], s34 offen offset:1024
  buffer_load_dwordx4 a[200:203], v1, s[4:7], s34 offen offset:2048
  buffer_load_dwordx4 a[204:207], v1, s[4:7], s34 offen offset:3072
  s_add_u32 s34, s34, 4096
  buffer_load_dwordx4 a[208:211], v1, s[4:7], s34 offen offset:0
  buffer_load_dwordx4 a[212:215], v1, s[4:7], s34 offen offset:1024
  buffer_load_dwordx4 a[216:219], v1, s[4:7], s34 offen offset:2048
  buffer_load_dwordx4 a[220:223], v1, s[4:7], s34 offen offset:3072
  s_add_u32 s34, s34, 4096
  buffer_load_dwordx4 a[224:227], v1, s[4:7], s34 offen offset:0
  buffer_load_dwordx4 a[228:231], v1, s[4:7], s34 offen offset:1024
  buffer_load_dwordx4 a[232:235], v1, s[4:7], s34 offen offset:2048
  buffer_load_dwordx4 a[236:239], v1, s[4:7], s34 offen offset:3072
  s_waitcnt vmcnt(20)
  s_mul_i32 s34, s15, 12
  s_mul_i32 s35, s16, 6
  s_add_u32 s34, s34, s35
  s_add_u32 s34, s34, 3
  s_mul_i32 s34, s34, 20480
  s_add_u32 s34, s34, 14155776
  buffer_load_dwordx4 v[96:99], v1, s[4:7], s34 offen offset:0
  buffer_load_dwordx4 v[100:103], v1, s[4:7], s34 offen offset:1024
  buffer_load_dwordx4 v[104:107], v1, s[4:7], s34 offen offset:2048
  buffer_load_dwordx4 v[108:111], v1, s[4:7], s34 offen offset:3072
  s_add_u32 s34, s34, 4096
  buffer_load_dwordx4 v[112:115], v1, s[4:7], s34 offen offset:0
  buffer_load_dwordx4 v[116:119], v1, s[4:7], s34 offen offset:1024
  buffer_load_dwordx4 v[120:123], v1, s[4:7], s34 offen offset:2048
  buffer_load_dwordx4 v[124:127], v1, s[4:7], s34 offen offset:3072
  s_add_u32 s34, s34, 4096
  buffer_load_dwordx4 v[128:131], v1, s[4:7], s34 offen offset:0
  buffer_load_dwordx4 v[132:135], v1, s[4:7], s34 offen offset:1024
  buffer_load_dwordx4 v[136:139], v1, s[4:7], s34 offen offset:2048
  buffer_load_dwordx4 v[140:143], v1, s[4:7], s34 offen offset:3072
  s_add_u32 s34, s34, 4096
  buffer_load_dwordx4 v[144:147], v1, s[4:7], s34 offen offset:0
  buffer_load_dwordx4 v[148:151], v1, s[4:7], s34 offen offset:1024
  buffer_load_dwordx4 v[152:155], v1, s[4:7], s34 offen offset:2048
  buffer_load_dwordx4 v[156:159], v1, s[4:7], s34 offen offset:3072
  s_add_u32 s34, s34, 4096
  buffer_load_dwordx4 v[160:163], v1, s[4:7], s34 offen offset:0
  buffer_load_dwordx4 v[164:167], v1, s[4:7], s34 offen offset:1024
  buffer_load_dwordx4 v[168:171], v1, s[4:7], s34 offen offset:2048
  buffer_load_dwordx4 v[172:175], v1, s[4:7], s34 offen offset:3072
  s_waitcnt vmcnt(20)
  s_mul_i32 s34, s15, 12
  s_mul_i32 s35, s16, 6
  s_add_u32 s34, s34, s35
  s_add_u32 s34, s34, 0
  s_mul_i32 s34, s34, 20480
  s_add_u32 s34, s34, 22020096
  buffer_load_dwordx4 v[176:179], v1, s[4:7], s34 offen offset:0
  buffer_load_dwordx4 v[180:183], v1, s[4:7], s34 offen offset:1024
  buffer_load_dwordx4 v[184:187], v1, s[4:7], s34 offen offset:2048
  buffer_load_dwordx4 v[188:191], v1, s[4:7], s34 offen offset:3072
  s_add_u32 s34, s34, 4096
  buffer_load_dwordx4 v[192:195], v1, s[4:7], s34 offen offset:0
  buffer_load_dwordx4 v[196:199], v1, s[4:7], s34 offen offset:1024
  buffer_load_dwordx4 v[200:203], v1, s[4:7], s34 offen offset:2048
  buffer_load_dwordx4 v[204:207], v1, s[4:7], s34 offen offset:3072
  s_add_u32 s34, s34, 4096
  buffer_load_dwordx4 v[208:211], v1, s[4:7], s34 offen offset:0
  buffer_load_dwordx4 v[212:215], v1, s[4:7], s34 offen offset:1024
  buffer_load_dwordx4 v[216:219], v1, s[4:7], s34 offen offset:2048
  buffer_load_dwordx4 v[220:223], v1, s[4:7], s34 offen offset:3072
  s_add_u32 s34, s34, 4096
  buffer_load_dwordx4 v[224:227], v1, s[4:7], s34 offen offset:0
  buffer_load_dwordx4 v[228:231], v1, s[4:7], s34 offen offset:1024
  buffer_load_dwordx4 v[232:235], v1, s[4:7], s34 offen offset:2048
  buffer_load_dwordx4 v[236:239], v1, s[4:7], s34 offen offset:3072
  s_add_u32 s34, s34, 4096
  buffer_load_dwordx4 v[240:243], v1, s[4:7], s34 offen offset:0
  buffer_load_dwordx4 v[244:247], v1, s[4:7], s34 offen offset:1024
  buffer_load_dwordx4 v[248:251], v1, s[4:7], s34 offen offset:2048
  buffer_load_dwordx4 v[252:255], v1, s[4:7], s34 offen offset:3072
  s_waitcnt vmcnt(20)
  v_and_b32 v30, 7, v0
  v_lshlrev_b32 v30, 3, v30
reca_cens230:
  buffer_load_dwordx2 v[28:29], v30, s[8:11], 0 offen sc1
  s_waitcnt vmcnt(0)
  v_sad_u8 v31, v28, 0, 0
  v_sad_u8 v31, v29, 0, v31
  v_cmp_gt_u32 vcc, 32, v31
  s_cbranch_vccz reca_censok231
  s_sleep 8
  s_sub_u32 s18, s18, 1
  s_cbranch_scc0 reca_cens230
  s_mov_b32 s18, 0
reca_censok231:
  v_and_b32 v28, 0x20202020, v28
  v_and_b32 v29, 0x20202020, v29
  v_cmp_ne_u32 s[34:35], 0, v28
  v_cmp_ne_u32 s[36:37], 0, v29
  s_nop 3
  s_and_b32 s34, s34, 0xff
  s_and_b32 s36, s36, 0xff
  s_or_b32 s35, s34, s36
  s_lshr_b32 s37, s35, s13
  s_and_b32 s37, s37, 1
  s_xor_b32 s43, s37, 1
  s_cmp_eq_u32 s57, 0
  s_cselect_b32 s58, s36, s34
  v_mov_b32 v31, 0x80000000
  s_cmp_lg_u32 s43, 0
  s_cbranch_scc1 reca_pslow232
reca_ptop233:
  s_cmp_lt_u32 s17, 3
  s_cbranch_scc1 reca_pgo234
  s_sub_u32 s36, s17, 3
reca_ppoll235:
  buffer_load_dword v28, v4, s[4:7], s25 offen sc1
  s_waitcnt vmcnt(0)
  v_readfirstlane_b32 s34, v28
  s_nop 3
  s_cmp_ge_i32 s34, s36
  s_cbranch_scc1 reca_pgo234
  s_sleep 8
  s_sub_u32 s18, s18, 1
  s_cbranch_scc0 reca_ppoll235
  s_mov_b32 s18, 0
reca_pgo234:
  s_waitcnt vmcnt(0)
  s_barrier
  v_add_u32 v7, s26, v1
  s_xor_b32 s26, s26, 40960
  s_add_u32 s37, s17, 1
  s_cmp_ge_u32 s37, 64
  s_cbranch_scc1 reca_pnodma236
  s_mul_i32 s20, s37, 40960
  s_add_u32 s20, s20, 84934656
  s_add_u32 m0, s26, 0
  s_nop 0
  buffer_load_dwordx4 v1, s[4:7], s20 offen offset:0 lds
  buffer_load_dwordx4 v1, s[4:7], s20 offen offset:1024 lds
  buffer_load_dwordx4 v1, s[4:7], s20 offen offset:2048 lds
  buffer_load_dwordx4 v1, s[4:7], s20 offen offset:3072 lds
  s_add_u32 s20, s20, 4096
  s_add_u32 m0, s26, 4096
  s_nop 0
  buffer_load_dwordx4 v1, s[4:7], s20 offen offset:0 lds
  buffer_load_dwordx4 v1, s[4:7], s20 offen offset:1024 lds
  buffer_load_dwordx4 v1, s[4:7], s20 offen offset:2048 lds
  buffer_load_dwordx4 v1, s[4:7], s20 offen offset:3072 lds
  s_add_u32 s20, s20, 4096
  s_add_u32 m0, s26, 8192
  s_nop 0
  buffer_load_dwordx4 v1, s[4:7], s20 offen offset:0 lds
  buffer_load_dwordx4 v1, s[4:7], s20 offen offset:1024 lds
reca_pnodma236:
  s_lshl_b32 s34, s15, 3
  s_and_b32 s35, s17, 7
  s_add_u32 s34, s34, s35
  s_mul_i32 s34, s34, 12288
  s_mul_i32 s35, s16, 3072
  s_add_u32 s35, s35, s34
  s_add_u32 s21, s35, 37748736
  s_add_u32 s22, s35, 44040192
  s_mul_i32 s35, s16, 6144
  s_add_u32 s35, s35, s34
  s_add_u32 s23, s35, 40894464
  ds_read_b128 v[72:75], v7 offset:0
  ds_read_b128 v[76:79], v7 offset:20480
  ds_read_b128 v[80:83], v7 offset:1024
  ds_read_b128 v[84:87], v7 offset:21504
  ds_read_b128 v[88:91], v7 offset:2048
  ds_read_b128 v[92:95], v7 offset:22528
  s_waitcnt lgkmcnt(4)
  v_mfma_f32_16x16x32_bf16 v[32:35], a[0:3], v[72:75], 0
  v_mfma_f32_16x16x32_bf16 v[36:39], a[0:3], v[76:79], 0
  v_mfma_f32_16x16x32_bf16 v[40:43], a[80:83], v[72:75], 0
  v_mfma_f32_16x16x32_bf16 v[44:47], a[80:83], v[76:79], 0
  v_mfma_f32_16x16x32_bf16 v[48:51], a[160:163], v[72:75], 0
  v_mfma_f32_16x16x32_bf16 v[52:55], a[160:163], v[76:79], 0
  v_mfma_f32_16x16x32_bf16 v[56:59], v[96:99], v[72:75], 0
  v_mfma_f32_16x16x32_bf16 v[60:63], v[96:99], v[76:79], 0
  v_mfma_f32_16x16x32_bf16 v[64:67], v[72:75], v[176:179], 0
  v_mfma_f32_16x16x32_bf16 v[68:71], v[76:79], v[176:179], 0
  ds_read_b128 v[72:75], v7 offset:3072
  ds_read_b128 v[76:79], v7 offset:23552
  s_waitcnt lgkmcnt(4)
  v_mfma_f32_16x16x32_bf16 v[32:35], a[4:7], v[80:83], v[32:35]
  v_mfma_f32_16x16x32_bf16 v[36:39], a[4:7], v[84:87], v[36:39]
  v_mfma_f32_16x16x32_bf16 v[40:43], a[84:87], v[80:83], v[40:43]
  v_mfma_f32_16x16x32_bf16 v[44:47], a[84:87], v[84:87], v[44:47]
  v_mfma_f32_16x16x32_bf16 v[48:51], a[164:167], v[80:83], v[48:51]
  v_mfma_f32_16x16x32_bf16 v[52:55], a[164:167], v[84:87], v[52:55]
  v_mfma_f32_16x16x32_bf16 v[56:59], v[100:103], v[80:83], v[56:59]
  v_mfma_f32_16x16x32_bf16 v[60:63], v[100:103], v[84:87], v[60:63]
  v_mfma_f32_16x16x32_bf16 v[64:67], v[80:83], v[180:183], v[64:67]
  v_mfma_f32_16x16x32_bf16 v[68:71], v[84:87], v[180:183], v[68:71]
  ds_read_b128 v[80:83], v7 offset:4096
  ds_read_b128 v[84:87], v7 offset:24576
  s_waitcnt lgkmcnt(4)
  v_mfma_f32_16x16x32_bf16 v[32:35], a[8:11], v[88:91], v[32:35]
  v_mfma_f32_16x16x32_bf16 v[36:39], a[8:11], v[92:95], v[36:39]
  v_mfma_f32_16x16x32_bf16 v[40:43], a[88:91], v[88:91], v[40:43]
  v_mfma_f32_16x16x32_bf16 v[44:47], a[88:91], v[92:95], v[44:47]
  v_mfma_f32_16x16x32_bf16 v[48:51], a[168:171], v[88:91], v[48:51]
  v_mfma_f32_16x16x32_bf16 v[52:55], a[168:171], v[92:95], v[52:55]
  v_mfma_f32_16x16x32_bf16 v[56:59], v[104:107], v[88:91], v[56:59]
  v_mfma_f32_16x16x32_bf16 v[60:63], v[104:107], v[92:95], v[60:63]
  v_mfma_f32_16x16x32_bf16 v[64:67], v[88:91], v[184:187], v[64:67]
  v_mfma_f32_16x16x32_bf16 v[68:71], v[92:95], v[184:187], v[68:71]
  ds_read_b128 v[88:91], v7 offset:5120
  ds_read_b128 v[92:95], v7 offset:25600
  s_waitcnt lgkmcnt(4)
  v_mfma_f32_16x16x32_bf16 v[32:35], a[12:15], v[72:75], v[32:35]
  v_mfma_f32_16x16x32_bf16 v[36:39], a[12:15], v[76:79], v[36:39]
  v_mfma_f32_16x16x32_bf16 v[40:43], a[92:95], v[72:75], v[40:43]
  v_mfma_f32_16x16x32_bf16 v[44:47], a[92:95], v[76:79], v[44:47]
  v_mfma_f32_16x16x32_bf16 v[48:51], a[172:175], v[72:75], v[48:51]
  v_mfma_f32_16x16x32_bf16 v[52:55], a[172:175], v[76:79], v[52:55]
  v_mfma_f32_16x16x32_bf16 v[56:59], v[108:111], v[72:75], v[56:59]
  v_mfma_f32_16x16x32_bf16 v[60:63], v[108:111], v[76:79], v[60:63]
  v_mfma_f32_16x16x32_bf16 v[64:67], v[72:75], v[188:191], v[64:67]
  v_mfma_f32_16x16x32_bf16 v[68:71], v[76:79], v[188:191], v[68:71]
  ds_read_b128 v[72:75], v7 offset:6144
  ds_read_b128 v[76:79], v7 offset:26624
  s_waitcnt lgkmcnt(4)
  v_mfma_f32_16x16x32_bf16 v[32:35], a[16:19], v[80:83], v[32:35]
  v_mfma_f32_16x16x32_bf16 v[36:39], a[16:19], v[84:87], v[36:39]
  v_mfma_f32_16x16x32_bf16 v[40:43], a[96:99], v[80:83], v[40:43]
  v_mfma_f32_16x16x32_bf16 v[44:47], a[96:99], v[84:87], v[44:47]
  v_mfma_f32_16x16x32_bf16 v[48:51], a[176:179], v[80:83], v[48:51]
  v_mfma_f32_16x16x32_bf16 v[52:55], a[176:179], v[84:87], v[52:55]
  v_mfma_f32_16x16x32_bf16 v[56:59], v[112:115], v[80:83], v[56:59]
  v_mfma_f32_16x16x32_bf16 v[60:63], v[112:115], v[84:87], v[60:63]
  v_mfma_f32_16x16x32_bf16 v[64:67], v[80:83], v[192:195], v[64:67]
  v_mfma_f32_16x16x32_bf16 v[68:71], v[84:87], v[192:195], v[68:71]
  ds_read_b128 v[80:83], v7 offset:7168
  ds_read_b128 v[84:87], v7 offset:27648
  s_waitcnt lgkmcnt(4)
  v_mfma_f32_16x16x32_bf16 v[32:35], a[20:23], v[88:91], v[32:35]
  v_mfma_f32_16x16x32_bf16 v[36:39], a[20:23], v[92:95], v[36:39]
  v_mfma_f32_16x16x32_bf16 v[40:43], a[100:103], v[88:91], v[40:43]
  v_mfma_f32_16x16x32_bf16 v[44:47], a[100:103], v[92:95], v[44:47]
  v_mfma_f32_16x16x32_bf16 v[48:51], a[180:183], v[88:91], v[48:51]
  v_mfma_f32_16x16x32_bf16 v[52:55], a[180:183], v[92:95], v[52:55]
  v_mfma_f32_16x16x32_bf16 v[56:59], v[116:119], v[88:91], v[56:59]
  v_mfma_f32_16x16x32_bf16 v[60:63], v[116:119], v[92:95], v[60:63]
  v_mfma_f32_16x16x32_bf16 v[64:67], v[88:91], v[196:199], v[64:67]
  v_mfma_f32_16x16x32_bf16 v[68:71], v[92:95], v[196:199], v[68:71]
  ds_read_b128 v[88:91], v7 offset:8192
  ds_read_b128 v[92:95], v7 offset:28672
  s_waitcnt lgkmcnt(4)
  v_mfma_f32_16x16x32_bf16 v[32:35], a[24:27], v[72:75], v[32:35]
  v_mfma_f32_16x16x32_bf16 v[36:39], a[24:27], v[76:79], v[36:39]
  v_mfma_f32_16x16x32_bf16 v[40:43], a[104:107], v[72:75], v[40:43]
  v_mfma_f32_16x16x32_bf16 v[44:47], a[104:107], v[76:79], v[44:47]
  v_mfma_f32_16x16x32_bf16 v[48:51], a[184:187], v[72:75], v[48:51]
  v_mfma_f32_16x16x32_bf16 v[52:55], a[184:187], v[76:79], v[52:55]
  v_mfma_f32_16x16x32_bf16 v[56:59], v[120:123], v[72:75], v[56:59]
  v_mfma_f32_16x16x32_bf16 v[60:63], v[120:123], v[76:79], v[60:63]
  v_mfma_f32_16x16x32_bf16 v[64:67], v[72:75], v[200:203], v[64:67]
  v_mfma_f32_16x16x32_bf16 v[68:71], v[76:79], v[200:203], v[68:71]
  ds_read_b128 v[72:75], v7 offset:9216
  ds_read_b128 v[76:79], v7 offset:29696
  s_waitcnt lgkmcnt(4)
  v_mfma_f32_16x16x32_bf16 v[32:35], a[28:31], v[80:83], v[32:35]
  v_mfma_f32_16x16x32_bf16 v[36:39], a[28:31], v[84:87], v[36:39]
  v_mfma_f32_16x16x32_bf16 v[40:43], a[108:111], v[80:83], v[40:43]
  v_mfma_f32_16x16x32_bf16 v[44:47], a[108:111], v[84:87], v[44:47]
  v_mfma_f32_16x16x32_bf16 v[48:51], a[188:191], v[80:83], v[48:51]
  v_mfma_f32_16x16x32_bf16 v[52:55], a[188:191], v[84:87], v[52:55]
  v_mfma_f32_16x16x32_bf16 v[56:59], v[124:127], v[80:83], v[56:59]
  v_mfma_f32_16x16x32_bf16 v[60:63], v[124:127], v[84:87], v[60:63]
  v_mfma_f32_16x16x32_bf16 v[64:67], v[80:83], v[204:207], v[64:67]
  v_mfma_f32_16x16x32_bf16 v[68:71], v[84:87], v[204:207], v[68:71]
  ds_read_b128 v[80:83], v7 offset:10240
  ds_read_b128 v[84:87], v7 offset:30720
  s_waitcnt lgkmcnt(4)
  v_mfma_f32_16x16x32_bf16 v[32:35], a[32:35], v[88:91], v[32:35]
  v_mfma_f32_16x16x32_bf16 v[36:39], a[32:35], v[92:95], v[36:39]
  v_mfma_f32_16x16x32_bf16 v[40:43], a[112:115], v[88:91], v[40:43]
  v_mfma_f32_16x16x32_bf16 v[44:47], a[112:115], v[92:95], v[44:47]
  v_mfma_f32_16x16x32_bf16 v[48:51], a[192:195], v[88:91], v[48:51]
  v_mfma_f32_16x16x32_bf16 v[52:55], a[192:195], v[92:95], v[52:55]
  v_mfma_f32_16x16x32_bf16 v[56:59], v[128:131], v[88:91], v[56:59]
  v_mfma_f32_16x16x32_bf16 v[60:63], v[128:131], v[92:95], v[60:63]
  v_mfma_f32_16x16x32_bf16 v[64:67], v[88:91], v[208:211], v[64:67]
  v_mfma_f32_16x16x32_bf16 v[68:71], v[92:95], v[208:211], v[68:71]
  ds_read_b128 v[88:91], v7 offset:11264
  ds_read_b128 v[92:95], v7 offset:31744
  s_waitcnt lgkmcnt(4)
  v_mfma_f32_16x16x32_bf16 v[32:35], a[36:39], v[72:75], v[32:35]
  v_mfma_f32_16x16x32_bf16 v[36:39], a[36:39], v[76:79], v[36:39]
  v_mfma_f32_16x16x32_bf16 v[40:43], a[116:119], v[72:75], v[40:43]
  v_mfma_f32_16x16x32_bf16 v[44:47], a[116:119], v[76:79], v[44:47]
  v_mfma_f32_16x16x32_bf16 v[48:51], a[196:199], v[72:75], v[48:51]
  v_mfma_f32_16x16x32_bf16 v[52:55], a[196:199], v[76:79], v[52:55]
  v_mfma_f32_16x16x32_bf16 v[56:59], v[132:135], v[72:75], v[56:59]
  v_mfma_f32_16x16x32_bf16 v[60:63], v[132:135], v[76:79], v[60:63]
  v_mfma_f32_16x16x32_bf16 v[64:67], v[72:75], v[212:215], v[64:67]
  v_mfma_f32_16x16x32_bf16 v[68:71], v[76:79], v[212:215], v[68:71]
  ds_read_b128 v[72:75], v7 offset:12288
  ds_read_b128 v[76:79], v7 offset:32768
  s_waitcnt lgkmcnt(4)
  v_mfma_f32_16x16x32_bf16 v[32:35], a[40:43], v[80:83], v[32:35]
  v_mfma_f32_16x16x32_bf16 v[36:39], a[40:43], v[84:87], v[36:39]
  v_mfma_f32_16x16x32_bf16 v[40:43], a[120:123], v[80:83], v[40:43]
  v_mfma_f32_16x16x32_bf16 v[44:47], a[120:123], v[84:87], v[44:47]
  v_mfma_f32_16x16x32_bf16 v[48:51], a[200:203], v[80:83], v[48:51]
  v_mfma_f32_16x16x32_bf16 v[52:55], a[200:203], v[84:87], v[52:55]
  v_mfma_f32_16x16x32_bf16 v[56:59], v[136:139], v[80:83], v[56:59]
  v_mfma_f32_16x16x32_bf16 v[60:63], v[136:139], v[84:87], v[60:63]
  v_mfma_f32_16x16x32_bf16 v[64:67], v[80:83], v[216:219], v[64:67]
  v_mfma_f32_16x16x32_bf16 v[68:71], v[84:87], v[216:219], v[68:71]
  ds_read_b128 v[80:83], v7 offset:13312
  ds_read_b128 v[84:87], v7 offset:33792
  s_waitcnt lgkmcnt(4)
  v_mfma_f32_16x16x32_bf16 v[32:35], a[44:47], v[88:91], v[32:35]
  v_mfma_f32_16x16x32_bf16 v[36:39], a[44:47], v[92:95], v[36:39]
  v_mfma_f32_16x16x32_bf16 v[40:43], a[124:127], v[88:91], v[40:43]
  v_mfma_f32_16x16x32_bf16 v[44:47], a[124:127], v[92:95], v[44:47]
  v_mfma_f32_16x16x32_bf16 v[48:51], a[204:207], v[88:91], v[48:51]
  v_mfma_f32_16x16x32_bf16 v[52:55], a[204:207], v[92:95], v[52:55]
  v_mfma_f32_16x16x32_bf16 v[56:59], v[140:143], v[88:91], v[56:59]
  v_mfma_f32_16x16x32_bf16 v[60:63], v[140:143], v[92:95], v[60:63]
  v_mfma_f32_16x16x32_bf16 v[64:67], v[88:91], v[220:223], v[64:67]
  v_mfma_f32_16x16x32_bf16 v[68:71], v[92:95], v[220:223], v[68:71]
  ds_read_b128 v[88:91], v7 offset:14336
  ds_read_b128 v[92:95], v7 offset:34816
  s_waitcnt lgkmcnt(4)
  v_mfma_f32_16x16x32_bf16 v[32:35], a[48:51], v[72:75], v[32:35]
  v_mfma_f32_16x16x32_bf16 v[36:39], a[48:51], v[76:79], v[36:39]
  v_mfma_f32_16x16x32_bf16 v[40:43], a[128:131], v[72:75], v[40:43]
  v_mfma_f32_16x16x32_bf16 v[44:47], a[128:131], v[76:79], v[44:47]
  v_mfma_f32_16x16x32_bf16 v[48:51], a[208:211], v[72:75], v[48:51]
  v_mfma_f32_16x16x32_bf16 v[52:55], a[208:211], v[76:79], v[52:55]
  v_mfma_f32_16x16x32_bf16 v[56:59], v[144:147], v[72:75], v[56:59]
  v_mfma_f32_16x16x32_bf16 v[60:63], v[144:147], v[76:79], v[60:63]
  v_mfma_f32_16x16x32_bf16 v[64:67], v[72:75], v[224:227], v[64:67]
  v_mfma_f32_16x16x32_bf16 v[68:71], v[76:79], v[224:227], v[68:71]
  ds_read_b128 v[72:75], v7 offset:15360
  ds_read_b128 v[76:79], v7 offset:35840
  s_waitcnt lgkmcnt(4)
  v_mfma_f32_16x16x32_bf16 v[32:35], a[52:55], v[80:83], v[32:35]
  v_mfma_f32_16x16x32_bf16 v[36:39], a[52:55], v[84:87], v[36:39]
  v_mfma_f32_16x16x32_bf16 v[40:43], a[132:135], v[80:83], v[40:43]
  v_mfma_f32_16x16x32_bf16 v[44:47], a[132:135], v[84:87], v[44:47]
  v_mfma_f32_16x16x32_bf16 v[48:51], a[212:215], v[80:83], v[48:51]
  v_mfma_f32_16x16x32_bf16 v[52:55], a[212:215], v[84:87], v[52:55]
  v_mfma_f32_16x16x32_bf16 v[56:59], v[148:151], v[80:83], v[56:59]
  v_mfma_f32_16x16x32_bf16 v[60:63], v[148:151], v[84:87], v[60:63]
  v_mfma_f32_16x16x32_bf16 v[64:67], v[80:83], v[228:231], v[64:67]
  v_mfma_f32_16x16x32_bf16 v[68:71], v[84:87], v[228:231], v[68:71]
  ds_read_b128 v[80:83], v7 offset:16384
  ds_read_b128 v[84:87], v7 offset:36864
  s_waitcnt lgkmcnt(4)
  v_mfma_f32_16x16x32_bf16 v[32:35], a[56:59], v[88:91], v[32:35]
  v_mfma_f32_16x16x32_bf16 v[36:39], a[56:59], v[92:95], v[36:39]
  v_mfma_f32_16x16x32_bf16 v[40:43], a[136:139], v[88:91], v[40:43]
  v_mfma_f32_16x16x32_bf16 v[44:47], a[136:139], v[92:95], v[44:47]
  v_mfma_f32_16x16x32_bf16 v[48:51], a[216:219], v[88:91], v[48:51]
  v_mfma_f32_16x16x32_bf16 v[52:55], a[216:219], v[92:95], v[52:55]
  v_mfma_f32_16x16x32_bf16 v[56:59], v[152:155], v[88:91], v[56:59]
  v_mfma_f32_16x16x32_bf16 v[60:63], v[152:155], v[92:95], v[60:63]
  v_mfma_f32_16x16x32_bf16 v[64:67], v[88:91], v[232:235], v[64:67]
  v_mfma_f32_16x16x32_bf16 v[68:71], v[92:95], v[232:235], v[68:71]
  ds_read_b128 v[88:91], v7 offset:17408
  ds_read_b128 v[92:95], v7 offset:37888
  s_waitcnt lgkmcnt(4)
  v_mfma_f32_16x16x32_bf16 v[32:35], a[60:63], v[72:75], v[32:35]
  v_mfma_f32_16x16x32_bf16 v[36:39], a[60:63], v[76:79], v[36:39]
  v_mfma_f32_16x16x32_bf16 v[40:43], a[140:143], v[72:75], v[40:43]
  v_mfma_f32_16x16x32_bf16 v[44:47], a[140:143], v[76:79], v[44:47]
  v_mfma_f32_16x16x32_bf16 v[48:51], a[220:223], v[72:75], v[48:51]
  v_mfma_f32_16x16x32_bf16 v[52:55], a[220:223], v[76:79], v[52:55]
  v_mfma_f32_16x16x32_bf16 v[56:59], v[156:159], v[72:75], v[56:59]
  v_mfma_f32_16x16x32_bf16 v[60:63], v[156:159], v[76:79], v[60:63]
  v_mfma_f32_16x16x32_bf16 v[64:67], v[72:75], v[236:239], v[64:67]
  v_mfma_f32_16x16x32_bf16 v[68:71], v[76:79], v[236:239], v[68:71]
  ds_read_b128 v[72:75], v7 offset:18432
  ds_read_b128 v[76:79], v7 offset:38912
  s_waitcnt lgkmcnt(4)
  v_mfma_f32_16x16x32_bf16 v[32:35], a[64:67], v[80:83], v[32:35]
  v_mfma_f32_16x16x32_bf16 v[36:39], a[64:67], v[84:87], v[36:39]
  v_mfma_f32_16x16x32_bf16 v[40:43], a[144:147], v[80:83], v[40:43]
  v_mfma_f32_16x16x32_bf16 v[44:47], a[144:147], v[84:87], v[44:47]
  v_mfma_f32_16x16x32_bf16 v[48:51], a[224:227], v[80:83], v[48:51]
  v_mfma_f32_16x16x32_bf16 v[52:55], a[224:227], v[84:87], v[52:55]
  v_mfma_f32_16x16x32_bf16 v[56:59], v[160:163], v[80:83], v[56:59]
  v_mfma_f32_16x16x32_bf16 v[60:63], v[160:163], v[84:87], v[60:63]
  v_mfma_f32_16x16x32_bf16 v[64:67], v[80:83], v[240:243], v[64:67]
  v_mfma_f32_16x16x32_bf16 v[68:71], v[84:87], v[240:243], v[68:71]
  ds_read_b128 v[80:83], v7 offset:19456
  ds_read_b128 v[84:87], v7 offset:39936
  s_waitcnt lgkmcnt(4)
  v_mfma_f32_16x16x32_bf16 v[32:35], a[68:71], v[88:91], v[32:35]
  v_mfma_f32_16x16x32_bf16 v[36:39], a[68:71], v[92:95], v[36:39]
  v_mfma_f32_16x16x32_bf16 v[40:43], a[148:151], v[88:91], v[40:43]
  v_mfma_f32_16x16x32_bf16 v[44:47], a[148:151], v[92:95], v[44:47]
  v_mfma_f32_16x16x32_bf16 v[48:51], a[228:231], v[88:91], v[48:51]
  v_mfma_f32_16x16x32_bf16 v[52:55], a[228:231], v[92:95], v[52:55]
  v_mfma_f32_16x16x32_bf16 v[56:59], v[164:167], v[88:91], v[56:59]
  v_mfma_f32_16x16x32_bf16 v[60:63], v[164:167], v[92:95], v[60:63]
  v_mfma_f32_16x16x32_bf16 v[64:67], v[88:91], v[244:247], v[64:67]
  v_mfma_f32_16x16x32_bf16 v[68:71], v[92:95], v[244:247], v[68:71]
  s_waitcnt lgkmcnt(2)
  v_mfma_f32_16x16x32_bf16 v[32:35], a[72:75], v[72:75], v[32:35]
  v_mfma_f32_16x16x32_bf16 v[36:39], a[72:75], v[76:79], v[36:39]
  v_mfma_f32_16x16x32_bf16 v[40:43], a[152:155], v[72:75], v[40:43]
  v_mfma_f32_16x16x32_bf16 v[44:47], a[152:155], v[76:79], v[44:47]
  v_mfma_f32_16x16x32_bf16 v[48:51], a[232:235], v[72:75], v[48:51]
  v_mfma_f32_16x16x32_bf16 v[52:55], a[232:235], v[76:79], v[52:55]
  v_mfma_f32_16x16x32_bf16 v[56:59], v[168:171], v[72:75], v[56:59]
  v_mfma_f32_16x16x32_bf16 v[60:63], v[168:171], v[76:79], v[60:63]
  v_mfma_f32_16x16x32_bf16 v[64:67], v[72:75], v[248:251], v[64:67]
  v_mfma_f32_16x16x32_bf16 v[68:71], v[76:79], v[248:251], v[68:71]
  s_waitcnt lgkmcnt(0)
  v_mfma_f32_16x16x32_bf16 v[32:35], a[76:79], v[80:83], v[32:35]
  v_mfma_f32_16x16x32_bf16 v[36:39], a[76:79], v[84:87], v[36:39]
  v_mfma_f32_16x16x32_bf16 v[40:43], a[156:159], v[80:83], v[40:43]
  v_mfma_f32_16x16x32_bf16 v[44:47], a[156:159], v[84:87], v[44:47]
  v_mfma_f32_16x16x32_bf16 v[48:51], a[236:239], v[80:83], v[48:51]
  v_mfma_f32_16x16x32_bf16 v[52:55], a[236:239], v[84:87], v[52:55]
  v_mfma_f32_16x16x32_bf16 v[56:59], v[172:175], v[80:83], v[56:59]
  v_mfma_f32_16x16x32_bf16 v[60:63], v[172:175], v[84:87], v[60:63]
  v_mfma_f32_16x16x32_bf16 v[64:67], v[80:83], v[252:255], v[64:67]
  v_mfma_f32_16x16x32_bf16 v[68:71], v[84:87], v[252:255], v[68:71]
  v_cvt_pk_bf16_f32 v8, v32, v33
  v_cvt_pk_bf16_f32 v9, v34, v35
  v_cvt_pk_bf16_f32 v10, v40, v41
  v_cvt_pk_bf16_f32 v11, v42, v43
  s_add_u32 s34, s21, 0
  buffer_store_dwordx4 v[8:11], v1, s[4:7], s34 offen
  v_cvt_pk_bf16_f32 v12, v36, v37
  v_cvt_pk_bf16_f32 v13, v38, v39
  v_cvt_pk_bf16_f32 v14, v44, v45
  v_cvt_pk_bf16_f32 v15, v46, v47
  s_add_u32 s34, s21, 6144
  buffer_store_dwordx4 v[12:15], v1, s[4:7], s34 offen
  v_cvt_pk_bf16_f32 v8, v48, v49
  v_cvt_pk_bf16_f32 v9, v50, v51
  v_cvt_pk_bf16_f32 v10, v56, v57
  v_cvt_pk_bf16_f32 v11, v58, v59
  s_add_u32 s34, s21, 1024
  buffer_store_dwordx4 v[8:11], v1, s[4:7], s34 offen
  v_cvt_pk_bf16_f32 v12, v52, v53
  v_cvt_pk_bf16_f32 v13, v54, v55
  v_cvt_pk_bf16_f32 v14, v60, v61
  v_cvt_pk_bf16_f32 v15, v62, v63
  s_add_u32 s34, s21, 7168
  buffer_store_dwordx4 v[12:15], v1, s[4:7], s34 offen
  v_cvt_pk_bf16_f32 v8, v64, v65
  v_cvt_pk_bf16_f32 v9, v66, v67
  v_cvt_pk_bf16_f32 v10, v68, v69
  v_cvt_pk_bf16_f32 v11, v70, v71
  s_add_u32 s34, s23, 0
  buffer_store_dwordx4 v[8:11], v1, s[4:7], s34 offen
  s_waitcnt vmcnt(0)
  s_barrier
  s_add_u32 s17, s17, 1
  v_mov_b32 v28, s17
  buffer_store_dword v28, v4, s[4:7], s24 offen
  s_cmp_lt_u32 s17, 64
  s_cbranch_scc1 reca_ptop233
  s_branch reca_exit1
reca_pslow232:
reca_ptop238:
  s_cmp_lt_u32 s17, 3
  s_cbranch_scc1 reca_pgo239
  s_sub_u32 s36, s17, 3
reca_ppoll240:
  buffer_load_dword v28, v4, s[4:7], s25 offen sc1
  s_waitcnt vmcnt(0)
  v_readfirstlane_b32 s34, v28
  s_nop 3
  s_cmp_ge_i32 s34, s36
  s_cbranch_scc1 reca_pgo239
  s_sleep 8
  s_sub_u32 s18, s18, 1
  s_cbranch_scc0 reca_ppoll240
  s_mov_b32 s18, 0
reca_pgo239:
  s_waitcnt vmcnt(0)
  s_barrier
  v_add_u32 v7, s26, v1
  s_xor_b32 s26, s26, 40960
  s_add_u32 s37, s17, 1
  s_cmp_ge_u32 s37, 64
  s_cbranch_scc1 reca_pnodma241
  s_mul_i32 s20, s37, 40960
  s_add_u32 s20, s20, 84934656
  s_add_u32 m0, s26, 0
  s_nop 0
  buffer_load_dwordx4 v1, s[4:7], s20 offen offset:0 lds
  buffer_load_dwordx4 v1, s[4:7], s20 offen offset:1024 lds
  buffer_load_dwordx4 v1, s[4:7], s20 offen offset:2048 lds
  buffer_load_dwordx4 v1, s[4:7], s20 offen offset:3072 lds
  s_add_u32 s20, s20, 4096
  s_add_u32 m0, s26, 4096
  s_nop 0
  buffer_load_dwordx4 v1, s[4:7], s20 offen offset:0 lds
  buffer_load_dwordx4 v1, s[4:7], s20 offen offset:1024 lds
  buffer_load_dwordx4 v1, s[4:7], s20 offen offset:2048 lds
  buffer_load_dwordx4 v1, s[4:7], s20 offen offset:3072 lds
  s_add_u32 s20, s20, 4096
  s_add_u32 m0, s26, 8192
  s_nop 0
  buffer_load_dwordx4 v1, s[4:7], s20 offen offset:0 lds
  buffer_load_dwordx4 v1, s[4:7], s20 offen offset:1024 lds
reca_pnodma241:
  s_lshl_b32 s34, s15, 3
  s_and_b32 s35, s17, 7
  s_add_u32 s34, s34, s35
  s_mul_i32 s34, s34, 12288
  s_mul_i32 s35, s16, 3072
  s_add_u32 s35, s35, s34
  s_add_u32 s21, s35, 37748736
  s_add_u32 s22, s35, 44040192
  s_mul_i32 s35, s16, 6144
  s_add_u32 s35, s35, s34
  s_add_u32 s23, s35, 40894464
  ds_read_b128 v[72:75], v7 offset:0
  ds_read_b128 v[76:79], v7 offset:20480
  ds_read_b128 v[80:83], v7 offset:1024
  ds_read_b128 v[84:87], v7 offset:21504
  ds_read_b128 v[88:91], v7 offset:2048
  ds_read_b128 v[92:95], v7 offset:22528
  s_waitcnt lgkmcnt(4)
  v_mfma_f32_16x16x32_bf16 v[32:35], a[0:3], v[72:75], 0
  v_mfma_f32_16x16x32_bf16 v[36:39], a[0:3], v[76:79], 0
  v_mfma_f32_16x16x32_bf16 v[40:43], a[80:83], v[72:75], 0
  v_mfma_f32_16x16x32_bf16 v[44:47], a[80:83], v[76:79], 0
  v_mfma_f32_16x16x32_bf16 v[48:51], a[160:163], v[72:75], 0
  v_mfma_f32_16x16x32_bf16 v[52:55], a[160:163], v[76:79], 0
  v_mfma_f32_16x16x32_bf16 v[56:59], v[96:99], v[72:75], 0
  v_mfma_f32_16x16x32_bf16 v[60:63], v[96:99], v[76:79], 0
  v_mfma_f32_16x16x32_bf16 v[64:67], v[72:75], v[176:179], 0
  v_mfma_f32_16x16x32_bf16 v[68:71], v[76:79], v[176:179], 0
  ds_read_b128 v[72:75], v7 offset:3072
  ds_read_b128 v[76:79], v7 offset:23552
  s_waitcnt lgkmcnt(4)
  v_mfma_f32_16x16x32_bf16 v[32:35], a[4:7], v[80:83], v[32:35]
  v_mfma_f32_16x16x32_bf16 v[36:39], a[4:7], v[84:87], v[36:39]
  v_mfma_f32_16x16x32_bf16 v[40:43], a[84:87], v[80:83], v[40:43]
  v_mfma_f32_16x16x32_bf16 v[44:47], a[84:87], v[84:87], v[44:47]
  v_mfma_f32_16x16x32_bf16 v[48:51], a[164:167], v[80:83], v[48:51]
  v_mfma_f32_16x16x32_bf16 v[52:55], a[164:167], v[84:87], v[52:55]
  v_mfma_f32_16x16x32_bf16 v[56:59], v[100:103], v[80:83], v[56:59]
  v_mfma_f32_16x16x32_bf16 v[60:63], v[100:103], v[84:87], v[60:63]
  v_mfma_f32_16x16x32_bf16 v[64:67], v[80:83], v[180:183], v[64:67]
  v_mfma_f32_16x16x32_bf16 v[68:71], v[84:87], v[180:183], v[68:71]
  ds_read_b128 v[80:83], v7 offset:4096
  ds_read_b128 v[84:87], v7 offset:24576
  s_waitcnt lgkmcnt(4)
  v_mfma_f32_16x16x32_bf16 v[32:35], a[8:11], v[88:91], v[32:35]
  v_mfma_f32_16x16x32_bf16 v[36:39], a[8:11], v[92:95], v[36:39]
  v_mfma_f32_16x16x32_bf16 v[40:43], a[88:91], v[88:91], v[40:43]
  v_mfma_f32_16x16x32_bf16 v[44:47], a[88:91], v[92:95], v[44:47]
  v_mfma_f32_16x16x32_bf16 v[48:51], a[168:171], v[88:91], v[48:51]
  v_mfma_f32_16x16x32_bf16 v[52:55], a[168:171], v[92:95], v[52:55]
  v_mfma_f32_16x16x32_bf16 v[56:59], v[104:107], v[88:91], v[56:59]
  v_mfma_f32_16x16x32_bf16 v[60:63], v[104:107], v[92:95], v[60:63]
  v_mfma_f32_16x16x32_bf16 v[64:67], v[88:91], v[184:187], v[64:67]
  v_mfma_f32_16x16x32_bf16 v[68:71], v[92:95], v[184:187], v[68:71]
  ds_read_b128 v[88:91], v7 offset:5120
  ds_read_b128 v[92:95], v7 offset:25600
  s_waitcnt lgkmcnt(4)
  v_mfma_f32_16x16x32_bf16 v[32:35], a[12:15], v[72:75], v[32:35]
  v_mfma_f32_16x16x32_bf16 v[36:39], a[12:15], v[76:79], v[36:39]
  v_mfma_f32_16x16x32_bf16 v[40:43], a[92:95], v[72:75], v[40:43]
  v_mfma_f32_16x16x32_bf16 v[44:47], a[92:95], v[76:79], v[44:47]
  v_mfma_f32_16x16x32_bf16 v[48:51], a[172:175], v[72:75], v[48:51]
  v_mfma_f32_16x16x32_bf16 v[52:55], a[172:175], v[76:79], v[52:55]
  v_mfma_f32_16x16x32_bf16 v[56:59], v[108:111], v[72:75], v[56:59]
  v_mfma_f32_16x16x32_bf16 v[60:63], v[108:111], v[76:79], v[60:63]
  v_mfma_f32_16x16x32_bf16 v[64:67], v[72:75], v[188:191], v[64:67]
  v_mfma_f32_16x16x32_bf16 v[68:71], v[76:79], v[188:191], v[68:71]
  ds_read_b128 v[72:75], v7 offset:6144
  ds_read_b128 v[76:79], v7 offset:26624
  s_waitcnt lgkmcnt(4)
  v_mfma_f32_16x16x32_bf16 v[32:35], a[16:19], v[80:83], v[32:35]
  v_mfma_f32_16x16x32_bf16 v[36:39], a[16:19], v[84:87], v[36:39]
  v_mfma_f32_16x16x32_bf16 v[40:43], a[96:99], v[80:83], v[40:43]
  v_mfma_f32_16x16x32_bf16 v[44:47], a[96:99], v[84:87], v[44:47]
  v_mfma_f32_16x16x32_bf16 v[48:51], a[176:179], v[80:83], v[48:51]
  v_mfma_f32_16x16x32_bf16 v[52:55], a[176:179], v[84:87], v[52:55]
  v_mfma_f32_16x16x32_bf16 v[56:59], v[112:115], v[80:83], v[56:59]
  v_mfma_f32_16x16x32_bf16 v[60:63], v[112:115], v[84:87], v[60:63]
  v_mfma_f32_16x16x32_bf16 v[64:67], v[80:83], v[192:195], v[64:67]
  v_mfma_f32_16x16x32_bf16 v[68:71], v[84:87], v[192:195], v[68:71]
  ds_read_b128 v[80:83], v7 offset:7168
  ds_read_b128 v[84:87], v7 offset:27648
  s_waitcnt lgkmcnt(4)
  v_mfma_f32_16x16x32_bf16 v[32:35], a[20:23], v[88:91], v[32:35]
  v_mfma_f32_16x16x32_bf16 v[36:39], a[20:23], v[92:95], v[36:39]
  v_mfma_f32_16x16x32_bf16 v[40:43], a[100:103], v[88:91], v[40:43]
  v_mfma_f32_16x16x32_bf16 v[44:47], a[100:103], v[92:95], v[44:47]
  v_mfma_f32_16x16x32_bf16 v[48:51], a[180:183], v[88:91], v[48:51]
  v_mfma_f32_16x16x32_bf16 v[52:55], a[180:183], v[92:95], v[52:55]
  v_mfma_f32_16x16x32_bf16 v[56:59], v[116:119], v[88:91], v[56:59]
  v_mfma_f32_16x16x32_bf16 v[60:63], v[116:119], v[92:95], v[60:63]
  v_mfma_f32_16x16x32_bf16 v[64:67], v[88:91], v[196:199], v[64:67]
  v_mfma_f32_16x16x32_bf16 v[68:71], v[92:95], v[196:199], v[68:71]
  ds_read_b128 v[88:91], v7 offset:8192
  ds_read_b128 v[92:95], v7 offset:28672
  s_waitcnt lgkmcnt(4)
  v_mfma_f32_16x16x32_bf16 v[32:35], a[24:27], v[72:75], v[32:35]
  v_mfma_f32_16x16x32_bf16 v[36:39], a[24:27], v[76:79], v[36:39]
  v_mfma_f32_16x16x32_bf16 v[40:43], a[104:107], v[72:75], v[40:43]
  v_mfma_f32_16x16x32_bf16 v[44:47], a[104:107], v[76:79], v[44:47]
  v_mfma_f32_16x16x32_bf16 v[48:51], a[184:187], v[72:75], v[48:51]
  v_mfma_f32_16x16x32_bf16 v[52:55], a[184:187], v[76:79], v[52:55]
  v_mfma_f32_16x16x32_bf16 v[56:59], v[120:123], v[72:75], v[56:59]
  v_mfma_f32_16x16x32_bf16 v[60:63], v[120:123], v[76:79], v[60:63]
  v_mfma_f32_16x16x32_bf16 v[64:67], v[72:75], v[200:203], v[64:67]
  v_mfma_f32_16x16x32_bf16 v[68:71], v[76:79], v[200:203], v[68:71]
  ds_read_b128 v[72:75], v7 offset:9216
  ds_read_b128 v[76:79], v7 offset:29696
  s_waitcnt lgkmcnt(4)
  v_mfma_f32_16x16x32_bf16 v[32:35], a[28:31], v[80:83], v[32:35]
  v_mfma_f32_16x16x32_bf16 v[36:39], a[28:31], v[84:87], v[36:39]
  v_mfma_f32_16x16x32_bf16 v[40:43], a[108:111], v[80:83], v[40:43]
  v_mfma_f32_16x16x32_bf16 v[44:47], a[108:111], v[84:87], v[44:47]
  v_mfma_f32_16x16x32_bf16 v[48:51], a[188:191], v[80:83], v[48:51]
  v_mfma_f32_16x16x32_bf16 v[52:55], a[188:191], v[84:87], v[52:55]
  v_mfma_f32_16x16x32_bf16 v[56:59], v[124:127], v[80:83], v[56:59]
  v_mfma_f32_16x16x32_bf16 v[60:63], v[124:127], v[84:87], v[60:63]
  v_mfma_f32_16x16x32_bf16 v[64:67], v[80:83], v[204:207], v[64:67]
  v_mfma_f32_16x16x32_bf16 v[68:71], v[84:87], v[204:207], v[68:71]
  ds_read_b128 v[80:83], v7 offset:10240
  ds_read_b128 v[84:87], v7 offset:30720
  s_waitcnt lgkmcnt(4)
  v_mfma_f32_16x16x32_bf16 v[32:35], a[32:35], v[88:91], v[32:35]
  v_mfma_f32_16x16x32_bf16 v[36:39], a[32:35], v[92:95], v[36:39]
  v_mfma_f32_16x16x32_bf16 v[40:43], a[112:115], v[88:91], v[40:43]
  v_mfma_f32_16x16x32_bf16 v[44:47], a[112:115], v[92:95], v[44:47]
  v_mfma_f32_16x16x32_bf16 v[48:51], a[192:195], v[88:91], v[48:51]
  v_mfma_f32_16x16x32_bf16 v[52:55], a[192:195], v[92:95], v[52:55]
  v_mfma_f32_16x16x32_bf16 v[56:59], v[128:131], v[88:91], v[56:59]
  v_mfma_f32_16x16x32_bf16 v[60:63], v[128:131], v[92:95], v[60:63]
  v_mfma_f32_16x16x32_bf16 v[64:67], v[88:91], v[208:211], v[64:67]
  v_mfma_f32_16x16x32_bf16 v[68:71], v[92:95], v[208:211], v[68:71]
  ds_read_b128 v[88:91], v7 offset:11264
  ds_read_b128 v[92:95], v7 offset:31744
  s_waitcnt lgkmcnt(4)
  v_mfma_f32_16x16x32_bf16 v[32:35], a[36:39], v[72:75], v[32:35]
  v_mfma_f32_16x16x32_bf16 v[36:39], a[36:39], v[76:79], v[36:39]
  v_mfma_f32_16x16x32_bf16 v[40:43], a[116:119], v[72:75], v[40:43]
  v_mfma_f32_16x16x32_bf16 v[44:47], a[116:119], v[76:79], v[44:47]
  v_mfma_f32_16x16x32_bf16 v[48:51], a[196:199], v[72:75], v[48:51]
  v_mfma_f32_16x16x32_bf16 v[52:55], a[196:199], v[76:79], v[52:55]
  v_mfma_f32_16x16x32_bf16 v[56:59], v[132:135], v[72:75], v[56:59]
  v_mfma_f32_16x16x32_bf16 v[60:63], v[132:135], v[76:79], v[60:63]
  v_mfma_f32_16x16x32_bf16 v[64:67], v[72:75], v[212:215], v[64:67]
  v_mfma_f32_16x16x32_bf16 v[68:71], v[76:79], v[212:215], v[68:71]
  ds_read_b128 v[72:75], v7 offset:12288
  ds_read_b128 v[76:79], v7 offset:32768
  s_waitcnt lgkmcnt(4)
  v_mfma_f32_16x16x32_bf16 v[32:35], a[40:43], v[80:83], v[32:35]
  v_mfma_f32_16x16x32_bf16 v[36:39], a[40:43], v[84:87], v[36:39]
  v_mfma_f32_16x16x32_bf16 v[40:43], a[120:123], v[80:83], v[40:43]
  v_mfma_f32_16x16x32_bf16 v[44:47], a[120:123], v[84:87], v[44:47]
  v_mfma_f32_16x16x32_bf16 v[48:51], a[200:203], v[80:83], v[48:51]
  v_mfma_f32_16x16x32_bf16 v[52:55], a[200:203], v[84:87], v[52:55]
  v_mfma_f32_16x16x32_bf16 v[56:59], v[136:139], v[80:83], v[56:59]
  v_mfma_f32_16x16x32_bf16 v[60:63], v[136:139], v[84:87], v[60:63]
  v_mfma_f32_16x16x32_bf16 v[64:67], v[80:83], v[216:219], v[64:67]
  v_mfma_f32_16x16x32_bf16 v[68:71], v[84:87], v[216:219], v[68:71]
  ds_read_b128 v[80:83], v7 offset:13312
  ds_read_b128 v[84:87], v7 offset:33792
  s_waitcnt lgkmcnt(4)
  v_mfma_f32_16x16x32_bf16 v[32:35], a[44:47], v[88:91], v[32:35]
  v_mfma_f32_16x16x32_bf16 v[36:39], a[44:47], v[92:95], v[36:39]
  v_mfma_f32_16x16x32_bf16 v[40:43], a[124:127], v[88:91], v[40:43]
  v_mfma_f32_16x16x32_bf16 v[44:47], a[124:127], v[92:95], v[44:47]
  v_mfma_f32_16x16x32_bf16 v[48:51], a[204:207], v[88:91], v[48:51]
  v_mfma_f32_16x16x32_bf16 v[52:55], a[204:207], v[92:95], v[52:55]
  v_mfma_f32_16x16x32_bf16 v[56:59], v[140:143], v[88:91], v[56:59]
  v_mfma_f32_16x16x32_bf16 v[60:63], v[140:143], v[92:95], v[60:63]
  v_mfma_f32_16x16x32_bf16 v[64:67], v[88:91], v[220:223], v[64:67]
  v_mfma_f32_16x16x32_bf16 v[68:71], v[92:95], v[220:223], v[68:71]
  ds_read_b128 v[88:91], v7 offset:14336
  ds_read_b128 v[92:95], v7 offset:34816
  s_waitcnt lgkmcnt(4)
  v_mfma_f32_16x16x32_bf16 v[32:35], a[48:51], v[72:75], v[32:35]
  v_mfma_f32_16x16x32_bf16 v[36:39], a[48:51], v[76:79], v[36:39]
  v_mfma_f32_16x16x32_bf16 v[40:43], a[128:131], v[72:75], v[40:43]
  v_mfma_f32_16x16x32_bf16 v[44:47], a[128:131], v[76:79], v[44:47]
  v_mfma_f32_16x16x32_bf16 v[48:51], a[208:211], v[72:75], v[48:51]
  v_mfma_f32_16x16x32_bf16 v[52:55], a[208:211], v[76:79], v[52:55]
  v_mfma_f32_16x16x32_bf16 v[56:59], v[144:147], v[72:75], v[56:59]
  v_mfma_f32_16x16x32_bf16 v[60:63], v[144:147], v[76:79], v[60:63]
  v_mfma_f32_16x16x32_bf16 v[64:67], v[72:75], v[224:227], v[64:67]
  v_mfma_f32_16x16x32_bf16 v[68:71], v[76:79], v[224:227], v[68:71]
  ds_read_b128 v[72:75], v7 offset:15360
  ds_read_b128 v[76:79], v7 offset:35840
  s_waitcnt lgkmcnt(4)
  v_mfma_f32_16x16x32_bf16 v[32:35], a[52:55], v[80:83], v[32:35]
  v_mfma_f32_16x16x32_bf16 v[36:39], a[52:55], v[84:87], v[36:39]
  v_mfma_f32_16x16x32_bf16 v[40:43], a[132:135], v[80:83], v[40:43]
  v_mfma_f32_16x16x32_bf16 v[44:47], a[132:135], v[84:87], v[44:47]
  v_mfma_f32_16x16x32_bf16 v[48:51], a[212:215], v[80:83], v[48:51]
  v_mfma_f32_16x16x32_bf16 v[52:55], a[212:215], v[84:87], v[52:55]
  v_mfma_f32_16x16x32_bf16 v[56:59], v[148:151], v[80:83], v[56:59]
  v_mfma_f32_16x16x32_bf16 v[60:63], v[148:151], v[84:87], v[60:63]
  v_mfma_f32_16x16x32_bf16 v[64:67], v[80:83], v[228:231], v[64:67]
  v_mfma_f32_16x16x32_bf16 v[68:71], v[84:87], v[228:231], v[68:71]
  ds_read_b128 v[80:83], v7 offset:16384
  ds_read_b128 v[84:87], v7 offset:36864
  s_waitcnt lgkmcnt(4)
  v_mfma_f32_16x16x32_bf16 v[32:35], a[56:59], v[88:91], v[32:35]
  v_mfma_f32_16x16x32_bf16 v[36:39], a[56:59], v[92:95], v[36:39]
  v_mfma_f32_16x16x32_bf16 v[40:43], a[136:139], v[88:91], v[40:43]
  v_mfma_f32_16x16x32_bf16 v[44:47], a[136:139], v[92:95], v[44:47]
  v_mfma_f32_16x16x32_bf16 v[48:51], a[216:219], v[88:91], v[48:51]
  v_mfma_f32_16x16x32_bf16 v[52:55], a[216:219], v[92:95], v[52:55]
  v_mfma_f32_16x16x32_bf16 v[56:59], v[152:155], v[88:91], v[56:59]
  v_mfma_f32_16x16x32_bf16 v[60:63], v[152:155], v[92:95], v[60:63]
  v_mfma_f32_16x16x32_bf16 v[64:67], v[88:91], v[232:235], v[64:67]
  v_mfma_f32_16x16x32_bf16 v[68:71], v[92:95], v[232:235], v[68:71]
  ds_read_b128 v[88:91], v7 offset:17408
  ds_read_b128 v[92:95], v7 offset:37888
  s_waitcnt lgkmcnt(4)
  v_mfma_f32_16x16x32_bf16 v[32:35], a[60:63], v[72:75], v[32:35]
  v_mfma_f32_16x16x32_bf16 v[36:39], a[60:63], v[76:79], v[36:39]
  v_mfma_f32_16x16x32_bf16 v[40:43], a[140:143], v[72:75], v[40:43]
  v_mfma_f32_16x16x32_bf16 v[44:47], a[140:143], v[76:79], v[44:47]
  v_mfma_f32_16x16x32_bf16 v[48:51], a[220:223], v[72:75], v[48:51]
  v_mfma_f32_16x16x32_bf16 v[52:55], a[220:223], v[76:79], v[52:55]
  v_mfma_f32_16x16x32_bf16 v[56:59], v[156:159], v[72:75], v[56:59]
  v_mfma_f32_16x16x32_bf16 v[60:63], v[156:159], v[76:79], v[60:63]
  v_mfma_f32_16x16x32_bf16 v[64:67], v[72:75], v[236:239], v[64:67]
  v_mfma_f32_16x16x32_bf16 v[68:71], v[76:79], v[236:239], v[68:71]
  ds_read_b128 v[72:75], v7 offset:18432
  ds_read_b128 v[76:79], v7 offset:38912
  s_waitcnt lgkmcnt(4)
  v_mfma_f32_16x16x32_bf16 v[32:35], a[64:67], v[80:83], v[32:35]
  v_mfma_f32_16x16x32_bf16 v[36:39], a[64:67], v[84:87], v[36:39]
  v_mfma_f32_16x16x32_bf16 v[40:43], a[144:147], v[80:83], v[40:43]
  v_mfma_f32_16x16x32_bf16 v[44:47], a[144:147], v[84:87], v[44:47]
  v_mfma_f32_16x16x32_bf16 v[48:51], a[224:227], v[80:83], v[48:51]
  v_mfma_f32_16x16x32_bf16 v[52:55], a[224:227], v[84:87], v[52:55]
  v_mfma_f32_16x16x32_bf16 v[56:59], v[160:163], v[80:83], v[56:59]
  v_mfma_f32_16x16x32_bf16 v[60:63], v[160:163], v[84:87], v[60:63]
  v_mfma_f32_16x16x32_bf16 v[64:67], v[80:83], v[240:243], v[64:67]
  v_mfma_f32_16x16x32_bf16 v[68:71], v[84:87], v[240:243], v[68:71]
  ds_read_b128 v[80:83], v7 offset:19456
  ds_read_b128 v[84:87], v7 offset:39936
  s_waitcnt lgkmcnt(4)
  v_mfma_f32_16x16x32_bf16 v[32:35], a[68:71], v[88:91], v[32:35]
  v_mfma_f32_16x16x32_bf16 v[36:39], a[68:71], v[92:95], v[36:39]
  v_mfma_f32_16x16x32_bf16 v[40:43], a[148:151], v[88:91], v[40:43]
  v_mfma_f32_16x16x32_bf16 v[44:47], a[148:151], v[92:95], v[44:47]
  v_mfma_f32_16x16x32_bf16 v[48:51], a[228:231], v[88:91], v[48:51]
  v_mfma_f32_16x16x32_bf16 v[52:55], a[228:231], v[92:95], v[52:55]
  v_mfma_f32_16x16x32_bf16 v[56:59], v[164:167], v[88:91], v[56:59]
  v_mfma_f32_16x16x32_bf16 v[60:63], v[164:167], v[92:95], v[60:63]
  v_mfma_f32_16x16x32_bf16 v[64:67], v[88:91], v[244:247], v[64:67]
  v_mfma_f32_16x16x32_bf16 v[68:71], v[92:95], v[244:247], v[68:71]
  s_waitcnt lgkmcnt(2)
  v_mfma_f32_16x16x32_bf16 v[32:35], a[72:75], v[72:75], v[32:35]
  v_mfma_f32_16x16x32_bf16 v[36:39], a[72:75], v[76:79], v[36:39]
  v_mfma_f32_16x16x32_bf16 v[40:43], a[152:155], v[72:75], v[40:43]
  v_mfma_f32_16x16x32_bf16 v[44:47], a[152:155], v[76:79], v[44:47]
  v_mfma_f32_16x16x32_bf16 v[48:51], a[232:235], v[72:75], v[48:51]
  v_mfma_f32_16x16x32_bf16 v[52:55], a[232:235], v[76:79], v[52:55]
  v_mfma_f32_16x16x32_bf16 v[56:59], v[168:171], v[72:75], v[56:59]
  v_mfma_f32_16x16x32_bf16 v[60:63], v[168:171], v[76:79], v[60:63]
  v_mfma_f32_16x16x32_bf16 v[64:67], v[72:75], v[248:251], v[64:67]
  v_mfma_f32_16x16x32_bf16 v[68:71], v[76:79], v[248:251], v[68:71]
  s_waitcnt lgkmcnt(0)
  v_mfma_f32_16x16x32_bf16 v[32:35], a[76:79], v[80:83], v[32:35]
  v_mfma_f32_16x16x32_bf16 v[36:39], a[76:79], v[84:87], v[36:39]
  v_mfma_f32_16x16x32_bf16 v[40:43], a[156:159], v[80:83], v[40:43]
  v_mfma_f32_16x16x32_bf16 v[44:47], a[156:159], v[84:87], v[44:47]
  v_mfma_f32_16x16x32_bf16 v[48:51], a[236:239], v[80:83], v[48:51]
  v_mfma_f32_16x16x32_bf16 v[52:55], a[236:239], v[84:87], v[52:55]
  v_mfma_f32_16x16x32_bf16 v[56:59], v[172:175], v[80:83], v[56:59]
  v_mfma_f32_16x16x32_bf16 v[60:63], v[172:175], v[84:87], v[60:63]
  v_mfma_f32_16x16x32_bf16 v[64:67], v[80:83], v[252:255], v[64:67]
  v_mfma_f32_16x16x32_bf16 v[68:71], v[84:87], v[252:255], v[68:71]
  v_cvt_pk_bf16_f32 v8, v32, v33
  v_cvt_pk_bf16_f32 v9, v34, v35
  v_cvt_pk_bf16_f32 v10, v40, v41
  v_cvt_pk_bf16_f32 v11, v42, v43
  s_add_u32 s34, s21, 0
  buffer_store_dwordx4 v[8:11], v1, s[4:7], s34 offen sc1
  v_cvt_pk_bf16_f32 v12, v36, v37
  v_cvt_pk_bf16_f32 v13, v38, v39
  v_cvt_pk_bf16_f32 v14, v44, v45
  v_cvt_pk_bf16_f32 v15, v46, v47
  s_add_u32 s34, s21, 6144
  buffer_store_dwordx4 v[12:15], v1, s[4:7], s34 offen sc1
  v_cvt_pk_bf16_f32 v8, v48, v49
  v_cvt_pk_bf16_f32 v9, v50, v51
  v_cvt_pk_bf16_f32 v10, v56, v57
  v_cvt_pk_bf16_f32 v11, v58, v59
  s_add_u32 s34, s21, 1024
  buffer_store_dwordx4 v[8:11], v1, s[4:7], s34 offen sc1
  v_cvt_pk_bf16_f32 v12, v52, v53
  v_cvt_pk_bf16_f32 v13, v54, v55
  v_cvt_pk_bf16_f32 v14, v60, v61
  v_cvt_pk_bf16_f32 v15, v62, v63
  s_add_u32 s34, s21, 7168
  buffer_store_dwordx4 v[12:15], v1, s[4:7], s34 offen sc1
  v_cvt_pk_bf16_f32 v8, v64, v65
  v_cvt_pk_bf16_f32 v9, v66, v67
  v_cvt_pk_bf16_f32 v10, v68, v69
  v_cvt_pk_bf16_f32 v11, v70, v71
  s_add_u32 s34, s23, 0
  buffer_store_dwordx4 v[8:11], v1, s[4:7], s34 offen sc1
  s_waitcnt vmcnt(0)
  s_barrier
  s_add_u32 s17, s17, 1
  v_mov_b32 v28, s17
  buffer_store_dword v28, v4, s[4:7], s24 offen sc1
  s_cmp_lt_u32 s17, 64
  s_cbranch_scc1 reca_ptop238
  s_branch reca_exit1
reca_pw1_227:
  s_mov_b32 s17, 0
  s_mov_b32 s26, 0
  s_mul_i32 s20, s17, 40960
  s_add_u32 s20, s20, 84944896
  s_add_u32 m0, s26, 10240
  s_nop 0
  buffer_load_dwordx4 v1, s[4:7], s20 offen offset:0 lds
  buffer_load_dwordx4 v1, s[4:7], s20 offen offset:1024 lds
  buffer_load_dwordx4 v1, s[4:7], s20 offen offset:2048 lds
  buffer_load_dwordx4 v1, s[4:7], s20 offen offset:3072 lds
  s_add_u32 s20, s20, 4096
  s_add_u32 m0, s26, 14336
  s_nop 0
  buffer_load_dwordx4 v1, s[4:7], s20 offen offset:0 lds
  buffer_load_dwordx4 v1, s[4:7], s20 offen offset:1024 lds
  buffer_load_dwordx4 v1, s[4:7], s20 offen offset:2048 lds
  buffer_load_dwordx4 v1, s[4:7], s20 offen offset:3072 lds
  s_add_u32 s20, s20, 4096
  s_add_u32 m0, s26, 18432
  s_nop 0
  buffer_load_dwordx4 v1, s[4:7], s20 offen offset:0 lds
  buffer_load_dwordx4 v1, s[4:7], s20 offen offset:1024 lds
  s_mul_i32 s34, s15, 12
  s_mul_i32 s35, s16, 6
  s_add_u32 s34, s34, s35
  s_add_u32 s34, s34, 4
  s_mul_i32 s34, s34, 20480
  s_add_u32 s34, s34, 14155776
  buffer_load_dwordx4 a[0:3], v1, s[4:7], s34 offen offset:0
  buffer_load_dwordx4 a[4:7], v1, s[4:7], s34 offen offset:1024
  buffer_load_dwordx4 a[8:11], v1, s[4:7], s34 offen offset:2048
  buffer_load_dwordx4 a[12:15], v1, s[4:7], s34 offen offset:3072
  s_add_u32 s34, s34, 4096
  buffer_load_dwordx4 a[16:19], v1, s[4:7], s34 offen offset:0
  buffer_load_dwordx4 a[20:23], v1, s[4:7], s34 offen offset:1024
  buffer_load_dwordx4 a[24:27], v1, s[4:7], s34 offen offset:2048
  buffer_load_dwordx4 a[28:31], v1, s[4:7], s34 offen offset:3072
  s_add_u32 s34, s34, 4096
  buffer_load_dwordx4 a[32:35], v1, s[4:7], s34 offen offset:0
  buffer_load_dwordx4 a[36:39], v1, s[4:7], s34 offen offset:1024
  buffer_load_dwordx4 a[40:43], v1, s[4:7], s34 offen offset:2048
  buffer_load_dwordx4 a[44:47], v1, s[4:7], s34 offen offset:3072
  s_add_u32 s34, s34, 4096
  buffer_load_dwordx4 a[48:51], v1, s[4:7], s34 offen offset:0
  buffer_load_dwordx4 a[52:55], v1, s[4:7], s34 offen offset:1024
  buffer_load_dwordx4 a[56:59], v1, s[4:7], s34 offen offset:2048
  buffer_load_dwordx4 a[60:63], v1, s[4:7], s34 offen offset:3072
  s_add_u32 s34, s34, 4096
  buffer_load_dwordx4 a[64:67], v1, s[4:7], s34 offen offset:0
  buffer_load_dwordx4 a[68:71], v1, s[4:7], s34 offen offset:1024
  buffer_load_dwordx4 a[72:75], v1, s[4:7], s34 offen offset:2048
  buffer_load_dwordx4 a[76:79], v1, s[4:7], s34 offen offset:3072
  s_mul_i32 s34, s15, 12
  s_mul_i32 s35, s16, 6
  s_add_u32 s34, s34, s35
  s_add_u32 s34, s34, 5
  s_mul_i32 s34, s34, 20480
  s_add_u32 s34, s34, 14155776
  buffer_load_dwordx4 a[80:83], v1, s[4:7], s34 offen offset:0
  buffer_load_dwordx4 a[84:87], v1, s[4:7], s34 offen offset:1024
  buffer_load_dwordx4 a[88:91], v1, s[4:7], s34 offen offset:2048
  buffer_load_dwordx4 a[92:95], v1, s[4:7], s34 offen offset:3072
  s_add_u32 s34, s34, 4096
  buffer_load_dwordx4 a[96:99], v1, s[4:7], s34 offen offset:0
  buffer_load_dwordx4 a[100:103], v1, s[4:7], s34 offen offset:1024
  buffer_load_dwordx4 a[104:107], v1, s[4:7], s34 offen offset:2048
  buffer_load_dwordx4 a[108:111], v1, s[4:7], s34 offen offset:3072
  s_add_u32 s34, s34, 4096
  buffer_load_dwordx4 a[112:115], v1, s[4:7], s34 offen offset:0
  buffer_load_dwordx4 a[116:119], v1, s[4:7], s34 offen offset:1024
  buffer_load_dwordx4 a[120:123], v1, s[4:7], s34 offen offset:2048
  buffer_load_dwordx4 a[124:127], v1, s[4:7], s34 offen offset:3072
  s_add_u32 s34, s34, 4096
  buffer_load_dwordx4 a[128:131], v1, s[4:7], s34 offen offset:0
  buffer_load_dwordx4 a[132:135], v1, s[4:7], s34 offen offset:1024
  buffer_load_dwordx4 a[136:139], v1, s[4:7], s34 offen offset:2048
  buffer_load_dwordx4 a[140:143], v1, s[4:7], s34 offen offset:3072
  s_add_u32 s34, s34, 4096
  buffer_load_dwordx4 a[144:147], v1, s[4:7], s34 offen offset:0
  buffer_load_dwordx4 a[148:151], v1, s[4:7], s34 offen offset:1024
  buffer_load_dwordx4 a[152:155], v1, s[4:7], s34 offen offset:2048
  buffer_load_dwordx4 a[156:159], v1, s[4:7], s34 offen offset:3072
  s_waitcnt vmcnt(20)
  s_mul_i32 s34, s15, 12
  s_mul_i32 s35, s16, 6
  s_add_u32 s34, s34, s35
  s_add_u32 s34, s34, 1
  s_mul_i32 s34, s34, 20480
  s_add_u32 s34, s34, 22020096
  buffer_load_dwordx4 a[160:163], v1, s[4:7], s34 offen offset:0
  buffer_load_dwordx4 a[164:167], v1, s[4:7], s34 offen offset:1024
  buffer_load_dwordx4 a[168:171], v1, s[4:7], s34 offen offset:2048
  buffer_load_dwordx4 a[172:175], v1, s[4:7], s34 offen offset:3072
  s_add_u32 s34, s34, 4096
  buffer_load_dwordx4 a[176:179], v1, s[4:7], s34 offen offset:0
  buffer_load_dwordx4 a[180:183], v1, s[4:7], s34 offen offset:1024
  buffer_load_dwordx4 a[184:187], v1, s[4:7], s34 offen offset:2048
  buffer_load_dwordx4 a[188:191], v1, s[4:7], s34 offen offset:3072
  s_add_u32 s34, s34, 4096
  buffer_load_dwordx4 a[192:195], v1, s[4:7], s34 offen offset:0
  buffer_load_dwordx4 a[196:199], v1, s[4:7], s34 offen offset:1024
  buffer_load_dwordx4 a[200:203], v1, s[4:7], s34 offen offset:2048
  buffer_load_dwordx4 a[204:207], v1, s[4:7], s34 offen offset:3072
  s_add_u32 s34, s34, 4096
  buffer_load_dwordx4 a[208:211], v1, s[4:7], s34 offen offset:0
  buffer_load_dwordx4 a[212:215], v1, s[4:7], s34 offen offset:1024
  buffer_load_dwordx4 a[216:219], v1, s[4:7], s34 offen offset:2048
  buffer_load_dwordx4 a[220:223], v1, s[4:7], s34 offen offset:3072
  s_add_u32 s34, s34, 4096
  buffer_load_dwordx4 a[224:227], v1, s[4:7], s34 offen offset:0
  buffer_load_dwordx4 a[228:231], v1, s[4:7], s34 offen offset:1024
  buffer_load_dwordx4 a[232:235], v1, s[4:7], s34 offen offset:2048
  buffer_load_dwordx4 a[236:239], v1, s[4:7], s34 offen offset:3072
  s_waitcnt vmcnt(20)
  s_mul_i32 s34, s15, 12
  s_mul_i32 s35, s16, 6
  s_add_u32 s34, s34, s35
  s_add_u32 s34, s34, 2
  s_mul_i32 s34, s34, 20480
  s_add_u32 s34, s34, 22020096
  buffer_load_dwordx4 v[96:99], v1, s[4:7], s34 offen offset:0
  buffer_load_dwordx4 v[100:103], v1, s[4:7], s34 offen offset:1024
  buffer_load_dwordx4 v[104:107], v1, s[4:7], s34 offen offset:2048
  buffer_load_dwordx4 v[108:111], v1, s[4:7], s34 offen offset:3072
  s_add_u32 s34, s34, 4096
  buffer_load_dwordx4 v[112:115], v1, s[4:7], s34 offen offset:0
  buffer_load_dwordx4 v[116:119], v1, s[4:7], s34 offen offset:1024
  buffer_load_dwordx4 v[120:123], v1, s[4:7], s34 offen offset:2048
  buffer_load_dwordx4 v[124:127], v1, s[4:7], s34 offen offset:3072
  s_add_u32 s34, s34, 4096
  buffer_load_dwordx4 v[128:131], v1, s[4:7], s34 offen offset:0
  buffer_load_dwordx4 v[132:135], v1, s[4:7], s34 offen offset:1024
  buffer_load_dwordx4 v[136:139], v1, s[4:7], s34 offen offset:2048
  buffer_load_dwordx4 v[140:143], v1, s[4:7], s34 offen offset:3072
  s_add_u32 s34, s34, 4096
  buffer_load_dwordx4 v[144:147], v1, s[4:7], s34 offen offset:0
  buffer_load_dwordx4 v[148:151], v1, s[4:7], s34 offen offset:1024
  buffer_load_dwordx4 v[152:155], v1, s[4:7], s34 offen offset:2048
  buffer_load_dwordx4 v[156:159], v1, s[4:7], s34 offen offset:3072
  s_add_u32 s34, s34, 4096
  buffer_load_dwordx4 v[160:163], v1, s[4:7], s34 offen offset:0
  buffer_load_dwordx4 v[164:167], v1, s[4:7], s34 offen offset:1024
  buffer_load_dwordx4 v[168:171], v1, s[4:7], s34 offen offset:2048
  buffer_load_dwordx4 v[172:175], v1, s[4:7], s34 offen offset:3072
  s_waitcnt vmcnt(20)
  s_mul_i32 s34, s15, 12
  s_mul_i32 s35, s16, 6
  s_add_u32 s34, s34, s35
  s_add_u32 s34, s34, 3
  s_mul_i32 s34, s34, 20480
  s_add_u32 s34, s34, 22020096
  buffer_load_dwordx4 v[176:179], v1, s[4:7], s34 offen offset:0
  buffer_load_dwordx4 v[180:183], v1, s[4:7], s34 offen offset:1024
  buffer_load_dwordx4 v[184:187], v1, s[4:7], s34 offen offset:2048
  buffer_load_dwordx4 v[188:191], v1, s[4:7], s34 offen offset:3072
  s_add_u32 s34, s34, 4096
  buffer_load_dwordx4 v[192:195], v1, s[4:7], s34 offen offset:0
  buffer_load_dwordx4 v[196:199], v1, s[4:7], s34 offen offset:1024
  buffer_load_dwordx4 v[200:203], v1, s[4:7], s34 offen offset:2048
  buffer_load_dwordx4 v[204:207], v1, s[4:7], s34 offen offset:3072
  s_add_u32 s34, s34, 4096
  buffer_load_dwordx4 v[208:211], v1, s[4:7], s34 offen offset:0
  buffer_load_dwordx4 v[212:215], v1, s[4:7], s34 offen offset:1024
  buffer_load_dwordx4 v[216:219], v1, s[4:7], s34 offen offset:2048
  buffer_load_dwordx4 v[220:223], v1, s[4:7], s34 offen offset:3072
  s_add_u32 s34, s34, 4096
  buffer_load_dwordx4 v[224:227], v1, s[4:7], s34 offen offset:0
  buffer_load_dwordx4 v[228:231], v1, s[4:7], s34 offen offset:1024
  buffer_load_dwordx4 v[232:235], v1, s[4:7], s34 offen offset:2048
  buffer_load_dwordx4 v[236:239], v1, s[4:7], s34 offen offset:3072
  s_add_u32 s34, s34, 4096
  buffer_load_dwordx4 v[240:243], v1, s[4:7], s34 offen offset:0
  buffer_load_dwordx4 v[244:247], v1, s[4:7], s34 offen offset:1024
  buffer_load_dwordx4 v[248:251], v1, s[4:7], s34 offen offset:2048
  buffer_load_dwordx4 v[252:255], v1, s[4:7], s34 offen offset:3072
  s_waitcnt vmcnt(20)
  v_and_b32 v30, 7, v0
  v_lshlrev_b32 v30, 3, v30
reca_cens243:
  buffer_load_dwordx2 v[28:29], v30, s[8:11], 0 offen sc1
  s_waitcnt vmcnt(0)
  v_sad_u8 v31, v28, 0, 0
  v_sad_u8 v31, v29, 0, v31
  v_cmp_gt_u32 vcc, 32, v31
  s_cbranch_vccz reca_censok244
  s_sleep 8
  s_sub_u32 s18, s18, 1
  s_cbranch_scc0 reca_cens243
  s_mov_b32 s18, 0
reca_censok244:
  v_and_b32 v28, 0x20202020, v28
  v_and_b32 v29, 0x20202020, v29
  v_cmp_ne_u32 s[34:35], 0, v28
  v_cmp_ne_u32 s[36:37], 0, v29
  s_nop 3
  s_and_b32 s34, s34, 0xff
  s_and_b32 s36, s36, 0xff
  s_or_b32 s35, s34, s36
  s_lshr_b32 s37, s35, s13
  s_and_b32 s37, s37, 1
  s_xor_b32 s43, s37, 1
  s_cmp_eq_u32 s57, 0
  s_cselect_b32 s58, s36, s34
  v_mov_b32 v31, 0x80000000
  s_cmp_lg_u32 s43, 0
  s_cbranch_scc1 reca_pslow245
reca_ptop246:
  s_cmp_lt_u32 s17, 3
  s_cbranch_scc1 reca_pgo247
  s_sub_u32 s36, s17, 3
reca_ppoll248:
  buffer_load_dword v28, v4, s[4:7], s25 offen sc1
  s_waitcnt vmcnt(0)
  v_readfirstlane_b32 s34, v28
  s_nop 3
  s_cmp_ge_i32 s34, s36
  s_cbranch_scc1 reca_pgo247
  s_sleep 8
  s_sub_u32 s18, s18, 1
  s_cbranch_scc0 reca_ppoll248
  s_mov_b32 s18, 0
reca_pgo247:
  s_waitcnt vmcnt(0)
  s_barrier
  v_add_u32 v7, s26, v1
  s_xor_b32 s26, s26, 40960
  s_add_u32 s37, s17, 1
  s_cmp_ge_u32 s37, 64
  s_cbranch_scc1 reca_pnodma249
  s_mul_i32 s20, s37, 40960
  s_add_u32 s20, s20, 84944896
  s_add_u32 m0, s26, 10240
  s_nop 0
  buffer_load_dwordx4 v1, s[4:7], s20 offen offset:0 lds
  buffer_load_dwordx4 v1, s[4:7], s20 offen offset:1024 lds
  buffer_load_dwordx4 v1, s[4:7], s20 offen offset:2048 lds
  buffer_load_dwordx4 v1, s[4:7], s20 offen offset:3072 lds
  s_add_u32 s20, s20, 4096
  s_add_u32 m0, s26, 14336
  s_nop 0
  buffer_load_dwordx4 v1, s[4:7], s20 offen offset:0 lds
  buffer_load_dwordx4 v1, s[4:7], s20 offen offset:1024 lds
  buffer_load_dwordx4 v1, s[4:7], s20 offen offset:2048 lds
  buffer_load_dwordx4 v1, s[4:7], s20 offen offset:3072 lds
  s_add_u32 s20, s20, 4096
  s_add_u32 m0, s26, 18432
  s_nop 0
  buffer_load_dwordx4 v1, s[4:7], s20 offen offset:0 lds
  buffer_load_dwordx4 v1, s[4:7], s20 offen offset:1024 lds
reca_pnodma249:
  s_lshl_b32 s34, s15, 3
  s_and_b32 s35, s17, 7
  s_add_u32 s34, s34, s35
  s_mul_i32 s34, s34, 12288
  s_mul_i32 s35, s16, 3072
  s_add_u32 s35, s35, s34
  s_add_u32 s21, s35, 37748736
  s_add_u32 s22, s35, 44040192
  s_mul_i32 s35, s16, 6144
  s_add_u32 s35, s35, s34
  s_add_u32 s23, s35, 40894464
  ds_read_b128 v[72:75], v7 offset:0
  ds_read_b128 v[76:79], v7 offset:20480
  ds_read_b128 v[80:83], v7 offset:1024
  ds_read_b128 v[84:87], v7 offset:21504
  ds_read_b128 v[88:91], v7 offset:2048
  ds_read_b128 v[92:95], v7 offset:22528
  s_waitcnt lgkmcnt(4)
  v_mfma_f32_16x16x32_bf16 v[32:35], a[0:3], v[72:75], 0
  v_mfma_f32_16x16x32_bf16 v[36:39], a[0:3], v[76:79], 0
  v_mfma_f32_16x16x32_bf16 v[40:43], a[80:83], v[72:75], 0
  v_mfma_f32_16x16x32_bf16 v[44:47], a[80:83], v[76:79], 0
  v_mfma_f32_16x16x32_bf16 v[48:51], v[72:75], a[160:163], 0
  v_mfma_f32_16x16x32_bf16 v[52:55], v[76:79], a[160:163], 0
  v_mfma_f32_16x16x32_bf16 v[56:59], v[72:75], v[96:99], 0
  v_mfma_f32_16x16x32_bf16 v[60:63], v[76:79], v[96:99], 0
  v_mfma_f32_16x16x32_bf16 v[64:67], v[72:75], v[176:179], 0
  v_mfma_f32_16x16x32_bf16 v[68:71], v[76:79], v[176:179], 0
  ds_read_b128 v[72:75], v7 offset:3072
  ds_read_b128 v[76:79], v7 offset:23552
  s_waitcnt lgkmcnt(4)
  v_mfma_f32_16x16x32_bf16 v[32:35], a[4:7], v[80:83], v[32:35]
  v_mfma_f32_16x16x32_bf16 v[36:39], a[4:7], v[84:87], v[36:39]
  v_mfma_f32_16x16x32_bf16 v[40:43], a[84:87], v[80:83], v[40:43]
  v_mfma_f32_16x16x32_bf16 v[44:47], a[84:87], v[84:87], v[44:47]
  v_mfma_f32_16x16x32_bf16 v[48:51], v[80:83], a[164:167], v[48:51]
  v_mfma_f32_16x16x32_bf16 v[52:55], v[84:87], a[164:167], v[52:55]
  v_mfma_f32_16x16x32_bf16 v[56:59], v[80:83], v[100:103], v[56:59]
  v_mfma_f32_16x16x32_bf16 v[60:63], v[84:87], v[100:103], v[60:63]
  v_mfma_f32_16x16x32_bf16 v[64:67], v[80:83], v[180:183], v[64:67]
  v_mfma_f32_16x16x32_bf16 v[68:71], v[84:87], v[180:183], v[68:71]
  ds_read_b128 v[80:83], v7 offset:4096
  ds_read_b128 v[84:87], v7 offset:24576
  s_waitcnt lgkmcnt(4)
  v_mfma_f32_16x16x32_bf16 v[32:35], a[8:11], v[88:91], v[32:35]
  v_mfma_f32_16x16x32_bf16 v[36:39], a[8:11], v[92:95], v[36:39]
  v_mfma_f32_16x16x32_bf16 v[40:43], a[88:91], v[88:91], v[40:43]
  v_mfma_f32_16x16x32_bf16 v[44:47], a[88:91], v[92:95], v[44:47]
  v_mfma_f32_16x16x32_bf16 v[48:51], v[88:91], a[168:171], v[48:51]
  v_mfma_f32_16x16x32_bf16 v[52:55], v[92:95], a[168:171], v[52:55]
  v_mfma_f32_16x16x32_bf16 v[56:59], v[88:91], v[104:107], v[56:59]
  v_mfma_f32_16x16x32_bf16 v[60:63], v[92:95], v[104:107], v[60:63]
  v_mfma_f32_16x16x32_bf16 v[64:67], v[88:91], v[184:187], v[64:67]
  v_mfma_f32_16x16x32_bf16 v[68:71], v[92:95], v[184:187], v[68:71]
  ds_read_b128 v[88:91], v7 offset:5120
  ds_read_b128 v[92:95], v7 offset:25600
  s_waitcnt lgkmcnt(4)
  v_mfma_f32_16x16x32_bf16 v[32:35], a[12:15], v[72:75], v[32:35]
  v_mfma_f32_16x16x32_bf16 v[36:39], a[12:15], v[76:79], v[36:39]
  v_mfma_f32_16x16x32_bf16 v[40:43], a[92:95], v[72:75], v[40:43]
  v_mfma_f32_16x16x32_bf16 v[44:47], a[92:95], v[76:79], v[44:47]
  v_mfma_f32_16x16x32_bf16 v[48:51], v[72:75], a[172:175], v[48:51]
  v_mfma_f32_16x16x32_bf16 v[52:55], v[76:79], a[172:175], v[52:55]
  v_mfma_f32_16x16x32_bf16 v[56:59], v[72:75], v[108:111], v[56:59]
  v_mfma_f32_16x16x32_bf16 v[60:63], v[76:79], v[108:111], v[60:63]
  v_mfma_f32_16x16x32_bf16 v[64:67], v[72:75], v[188:191], v[64:67]
  v_mfma_f32_16x16x32_bf16 v[68:71], v[76:79], v[188:191], v[68:71]
  ds_read_b128 v[72:75], v7 offset:6144
  ds_read_b128 v[76:79], v7 offset:26624
  s_waitcnt lgkmcnt(4)
  v_mfma_f32_16x16x32_bf16 v[32:35], a[16:19], v[80:83], v[32:35]
  v_mfma_f32_16x16x32_bf16 v[36:39], a[16:19], v[84:87], v[36:39]
  v_mfma_f32_16x16x32_bf16 v[40:43], a[96:99], v[80:83], v[40:43]
  v_mfma_f32_16x16x32_bf16 v[44:47], a[96:99], v[84:87], v[44:47]
  v_mfma_f32_16x16x32_bf16 v[48:51], v[80:83], a[176:179], v[48:51]
  v_mfma_f32_16x16x32_bf16 v[52:55], v[84:87], a[176:179], v[52:55]
  v_mfma_f32_16x16x32_bf16 v[56:59], v[80:83], v[112:115], v[56:59]
  v_mfma_f32_16x16x32_bf16 v[60:63], v[84:87], v[112:115], v[60:63]
  v_mfma_f32_16x16x32_bf16 v[64:67], v[80:83], v[192:195], v[64:67]
  v_mfma_f32_16x16x32_bf16 v[68:71], v[84:87], v[192:195], v[68:71]
  ds_read_b128 v[80:83], v7 offset:7168
  ds_read_b128 v[84:87], v7 offset:27648
  s_waitcnt lgkmcnt(4)
  v_mfma_f32_16x16x32_bf16 v[32:35], a[20:23], v[88:91], v[32:35]
  v_mfma_f32_16x16x32_bf16 v[36:39], a[20:23], v[92:95], v[36:39]
  v_mfma_f32_16x16x32_bf16 v[40:43], a[100:103], v[88:91], v[40:43]
  v_mfma_f32_16x16x32_bf16 v[44:47], a[100:103], v[92:95], v[44:47]
  v_mfma_f32_16x16x32_bf16 v[48:51], v[88:91], a[180:183], v[48:51]
  v_mfma_f32_16x16x32_bf16 v[52:55], v[92:95], a[180:183], v[52:55]
  v_mfma_f32_16x16x32_bf16 v[56:59], v[88:91], v[116:119], v[56:59]
  v_mfma_f32_16x16x32_bf16 v[60:63], v[92:95], v[116:119], v[60:63]
  v_mfma_f32_16x16x32_bf16 v[64:67], v[88:91], v[196:199], v[64:67]
  v_mfma_f32_16x16x32_bf16 v[68:71], v[92:95], v[196:199], v[68:71]
  ds_read_b128 v[88:91], v7 offset:8192
  ds_read_b128 v[92:95], v7 offset:28672
  s_waitcnt lgkmcnt(4)
  v_mfma_f32_16x16x32_bf16 v[32:35], a[24:27], v[72:75], v[32:35]
  v_mfma_f32_16x16x32_bf16 v[36:39], a[24:27], v[76:79], v[36:39]
  v_mfma_f32_16x16x32_bf16 v[40:43], a[104:107], v[72:75], v[40:43]
  v_mfma_f32_16x16x32_bf16 v[44:47], a[104:107], v[76:79], v[44:47]
  v_mfma_f32_16x16x32_bf16 v[48:51], v[72:75], a[184:187], v[48:51]
  v_mfma_f32_16x16x32_bf16 v[52:55], v[76:79], a[184:187], v[52:55]
  v_mfma_f32_16x16x32_bf16 v[56:59], v[72:75], v[120:123], v[56:59]
  v_mfma_f32_16x16x32_bf16 v[60:63], v[76:79], v[120:123], v[60:63]
  v_mfma_f32_16x16x32_bf16 v[64:67], v[72:75], v[200:203], v[64:67]
  v_mfma_f32_16x16x32_bf16 v[68:71], v[76:79], v[200:203], v[68:71]
  ds_read_b128 v[72:75], v7 offset:9216
  ds_read_b128 v[76:79], v7 offset:29696
  s_waitcnt lgkmcnt(4)
  v_mfma_f32_16x16x32_bf16 v[32:35], a[28:31], v[80:83], v[32:35]
  v_mfma_f32_16x16x32_bf16 v[36:39], a[28:31], v[84:87], v[36:39]
  v_mfma_f32_16x16x32_bf16 v[40:43], a[108:111], v[80:83], v[40:43]
  v_mfma_f32_16x16x32_bf16 v[44:47], a[108:111], v[84:87], v[44:47]
  v_mfma_f32_16x16x32_bf16 v[48:51], v[80:83], a[188:191], v[48:51]
  v_mfma_f32_16x16x32_bf16 v[52:55], v[84:87], a[188:191], v[52:55]
  v_mfma_f32_16x16x32_bf16 v[56:59], v[80:83], v[124:127], v[56:59]
  v_mfma_f32_16x16x32_bf16 v[60:63], v[84:87], v[124:127], v[60:63]
  v_mfma_f32_16x16x32_bf16 v[64:67], v[80:83], v[204:207], v[64:67]
  v_mfma_f32_16x16x32_bf16 v[68:71], v[84:87], v[204:207], v[68:71]
  ds_read_b128 v[80:83], v7 offset:10240
  ds_read_b128 v[84:87], v7 offset:30720
  s_waitcnt lgkmcnt(4)
  v_mfma_f32_16x16x32_bf16 v[32:35], a[32:35], v[88:91], v[32:35]
  v_mfma_f32_16x16x32_bf16 v[36:39], a[32:35], v[92:95], v[36:39]
  v_mfma_f32_16x16x32_bf16 v[40:43], a[112:115], v[88:91], v[40:43]
  v_mfma_f32_16x16x32_bf16 v[44:47], a[112:115], v[92:95], v[44:47]
  v_mfma_f32_16x16x32_bf16 v[48:51], v[88:91], a[192:195], v[48:51]
  v_mfma_f32_16x16x32_bf16 v[52:55], v[92:95], a[192:195], v[52:55]
  v_mfma_f32_16x16x32_bf16 v[56:59], v[88:91], v[128:131], v[56:59]
  v_mfma_f32_16x16x32_bf16 v[60:63], v[92:95], v[128:131], v[60:63]
  v_mfma_f32_16x16x32_bf16 v[64:67], v[88:91], v[208:211], v[64:67]
  v_mfma_f32_16x16x32_bf16 v[68:71], v[92:95], v[208:211], v[68:71]
  ds_read_b128 v[88:91], v7 offset:11264
  ds_read_b128 v[92:95], v7 offset:31744
  s_waitcnt lgkmcnt(4)
  v_mfma_f32_16x16x32_bf16 v[32:35], a[36:39], v[72:75], v[32:35]
  v_mfma_f32_16x16x32_bf16 v[36:39], a[36:39], v[76:79], v[36:39]
  v_mfma_f32_16x16x32_bf16 v[40:43], a[116:119], v[72:75], v[40:43]
  v_mfma_f32_16x16x32_bf16 v[44:47], a[116:119], v[76:79], v[44:47]
  v_mfma_f32_16x16x32_bf16 v[48:51], v[72:75], a[196:199], v[48:51]
  v_mfma_f32_16x16x32_bf16 v[52:55], v[76:79], a[196:199], v[52:55]
  v_mfma_f32_16x16x32_bf16 v[56:59], v[72:75], v[132:135], v[56:59]
  v_mfma_f32_16x16x32_bf16 v[60:63], v[76:79], v[132:135], v[60:63]
  v_mfma_f32_16x16x32_bf16 v[64:67], v[72:75], v[212:215], v[64:67]
  v_mfma_f32_16x16x32_bf16 v[68:71], v[76:79], v[212:215], v[68:71]
  ds_read_b128 v[72:75], v7 offset:12288
  ds_read_b128 v[76:79], v7 offset:32768
  s_waitcnt lgkmcnt(4)
  v_mfma_f32_16x16x32_bf16 v[32:35], a[40:43], v[80:83], v[32:35]
  v_mfma_f32_16x16x32_bf16 v[36:39], a[40:43], v[84:87], v[36:39]
  v_mfma_f32_16x16x32_bf16 v[40:43], a[120:123], v[80:83], v[40:43]
  v_mfma_f32_16x16x32_bf16 v[44:47], a[120:123], v[84:87], v[44:47]
  v_mfma_f32_16x16x32_bf16 v[48:51], v[80:83], a[200:203], v[48:51]
  v_mfma_f32_16x16x32_bf16 v[52:55], v[84:87], a[200:203], v[52:55]
  v_mfma_f32_16x16x32_bf16 v[56:59], v[80:83], v[136:139], v[56:59]
  v_mfma_f32_16x16x32_bf16 v[60:63], v[84:87], v[136:139], v[60:63]
  v_mfma_f32_16x16x32_bf16 v[64:67], v[80:83], v[216:219], v[64:67]
  v_mfma_f32_16x16x32_bf16 v[68:71], v[84:87], v[216:219], v[68:71]
  ds_read_b128 v[80:83], v7 offset:13312
  ds_read_b128 v[84:87], v7 offset:33792
  s_waitcnt lgkmcnt(4)
  v_mfma_f32_16x16x32_bf16 v[32:35], a[44:47], v[88:91], v[32:35]
  v_mfma_f32_16x16x32_bf16 v[36:39], a[44:47], v[92:95], v[36:39]
  v_mfma_f32_16x16x32_bf16 v[40:43], a[124:127], v[88:91], v[40:43]
  v_mfma_f32_16x16x32_bf16 v[44:47], a[124:127], v[92:95], v[44:47]
  v_mfma_f32_16x16x32_bf16 v[48:51], v[88:91], a[204:207], v[48:51]
  v_mfma_f32_16x16x32_bf16 v[52:55], v[92:95], a[204:207], v[52:55]
  v_mfma_f32_16x16x32_bf16 v[56:59], v[88:91], v[140:143], v[56:59]
  v_mfma_f32_16x16x32_bf16 v[60:63], v[92:95], v[140:143], v[60:63]
  v_mfma_f32_16x16x32_bf16 v[64:67], v[88:91], v[220:223], v[64:67]
  v_mfma_f32_16x16x32_bf16 v[68:71], v[92:95], v[220:223], v[68:71]
  ds_read_b128 v[88:91], v7 offset:14336
  ds_read_b128 v[92:95], v7 offset:34816
  s_waitcnt lgkmcnt(4)
  v_mfma_f32_16x16x32_bf16 v[32:35], a[48:51], v[72:75], v[32:35]
  v_mfma_f32_16x16x32_bf16 v[36:39], a[48:51], v[76:79], v[36:39]
  v_mfma_f32_16x16x32_bf16 v[40:43], a[128:131], v[72:75], v[40:43]
  v_mfma_f32_16x16x32_bf16 v[44:47], a[128:131], v[76:79], v[44:47]
  v_mfma_f32_16x16x32_bf16 v[48:51], v[72:75], a[208:211], v[48:51]
  v_mfma_f32_16x16x32_bf16 v[52:55], v[76:79], a[208:211], v[52:55]
  v_mfma_f32_16x16x32_bf16 v[56:59], v[72:75], v[144:147], v[56:59]
  v_mfma_f32_16x16x32_bf16 v[60:63], v[76:79], v[144:147], v[60:63]
  v_mfma_f32_16x16x32_bf16 v[64:67], v[72:75], v[224:227], v[64:67]
  v_mfma_f32_16x16x32_bf16 v[68:71], v[76:79], v[224:227], v[68:71]
  ds_read_b128 v[72:75], v7 offset:15360
  ds_read_b128 v[76:79], v7 offset:35840
  s_waitcnt lgkmcnt(4)
  v_mfma_f32_16x16x32_bf16 v[32:35], a[52:55], v[80:83], v[32:35]
  v_mfma_f32_16x16x32_bf16 v[36:39], a[52:55], v[84:87], v[36:39]
  v_mfma_f32_16x16x32_bf16 v[40:43], a[132:135], v[80:83], v[40:43]
  v_mfma_f32_16x16x32_bf16 v[44:47], a[132:135], v[84:87], v[44:47]
  v_mfma_f32_16x16x32_bf16 v[48:51], v[80:83], a[212:215], v[48:51]
  v_mfma_f32_16x16x32_bf16 v[52:55], v[84:87], a[212:215], v[52:55]
  v_mfma_f32_16x16x32_bf16 v[56:59], v[80:83], v[148:151], v[56:59]
  v_mfma_f32_16x16x32_bf16 v[60:63], v[84:87], v[148:151], v[60:63]
  v_mfma_f32_16x16x32_bf16 v[64:67], v[80:83], v[228:231], v[64:67]
  v_mfma_f32_16x16x32_bf16 v[68:71], v[84:87], v[228:231], v[68:71]
  ds_read_b128 v[80:83], v7 offset:16384
  ds_read_b128 v[84:87], v7 offset:36864
  s_waitcnt lgkmcnt(4)
  v_mfma_f32_16x16x32_bf16 v[32:35], a[56:59], v[88:91], v[32:35]
  v_mfma_f32_16x16x32_bf16 v[36:39], a[56:59], v[92:95], v[36:39]
  v_mfma_f32_16x16x32_bf16 v[40:43], a[136:139], v[88:91], v[40:43]
  v_mfma_f32_16x16x32_bf16 v[44:47], a[136:139], v[92:95], v[44:47]
  v_mfma_f32_16x16x32_bf16 v[48:51], v[88:91], a[216:219], v[48:51]
  v_mfma_f32_16x16x32_bf16 v[52:55], v[92:95], a[216:219], v[52:55]
  v_mfma_f32_16x16x32_bf16 v[56:59], v[88:91], v[152:155], v[56:59]
  v_mfma_f32_16x16x32_bf16 v[60:63], v[92:95], v[152:155], v[60:63]
  v_mfma_f32_16x16x32_bf16 v[64:67], v[88:91], v[232:235], v[64:67]
  v_mfma_f32_16x16x32_bf16 v[68:71], v[92:95], v[232:235], v[68:71]
  ds_read_b128 v[88:91], v7 offset:17408
  ds_read_b128 v[92:95], v7 offset:37888
  s_waitcnt lgkmcnt(4)
  v_mfma_f32_16x16x32_bf16 v[32:35], a[60:63], v[72:75], v[32:35]
  v_mfma_f32_16x16x32_bf16 v[36:39], a[60:63], v[76:79], v[36:39]
  v_mfma_f32_16x16x32_bf16 v[40:43], a[140:143], v[72:75], v[40:43]
  v_mfma_f32_16x16x32_bf16 v[44:47], a[140:143], v[76:79], v[44:47]
  v_mfma_f32_16x16x32_bf16 v[48:51], v[72:75], a[220:223], v[48:51]
  v_mfma_f32_16x16x32_bf16 v[52:55], v[76:79], a[220:223], v[52:55]
  v_mfma_f32_16x16x32_bf16 v[56:59], v[72:75], v[156:159], v[56:59]
  v_mfma_f32_16x16x32_bf16 v[60:63], v[76:79], v[156:159], v[60:63]
  v_mfma_f32_16x16x32_bf16 v[64:67], v[72:75], v[236:239], v[64:67]
  v_mfma_f32_16x16x32_bf16 v[68:71], v[76:79], v[236:239], v[68:71]
  ds_read_b128 v[72:75], v7 offset:18432
  ds_read_b128 v[76:79], v7 offset:38912
  s_waitcnt lgkmcnt(4)
  v_mfma_f32_16x16x32_bf16 v[32:35], a[64:67], v[80:83], v[32:35]
  v_mfma_f32_16x16x32_bf16 v[36:39], a[64:67], v[84:87], v[36:39]
  v_mfma_f32_16x16x32_bf16 v[40:43], a[144:147], v[80:83], v[40:43]
  v_mfma_f32_16x16x32_bf16 v[44:47], a[144:147], v[84:87], v[44:47]
  v_mfma_f32_16x16x32_bf16 v[48:51], v[80:83], a[224:227], v[48:51]
  v_mfma_f32_16x16x32_bf16 v[52:55], v[84:87], a[224:227], v[52:55]
  v_mfma_f32_16x16x32_bf16 v[56:59], v[80:83], v[160:163], v[56:59]
  v_mfma_f32_16x16x32_bf16 v[60:63], v[84:87], v[160:163], v[60:63]
  v_mfma_f32_16x16x32_bf16 v[64:67], v[80:83], v[240:243], v[64:67]
  v_mfma_f32_16x16x32_bf16 v[68:71], v[84:87], v[240:243], v[68:71]
  ds_read_b128 v[80:83], v7 offset:19456
  ds_read_b128 v[84:87], v7 offset:39936
  s_waitcnt lgkmcnt(4)
  v_mfma_f32_16x16x32_bf16 v[32:35], a[68:71], v[88:91], v[32:35]
  v_mfma_f32_16x16x32_bf16 v[36:39], a[68:71], v[92:95], v[36:39]
  v_mfma_f32_16x16x32_bf16 v[40:43], a[148:151], v[88:91], v[40:43]
  v_mfma_f32_16x16x32_bf16 v[44:47], a[148:151], v[92:95], v[44:47]
  v_mfma_f32_16x16x32_bf16 v[48:51], v[88:91], a[228:231], v[48:51]
  v_mfma_f32_16x16x32_bf16 v[52:55], v[92:95], a[228:231], v[52:55]
  v_mfma_f32_16x16x32_bf16 v[56:59], v[88:91], v[164:167], v[56:59]
  v_mfma_f32_16x16x32_bf16 v[60:63], v[92:95], v[164:167], v[60:63]
  v_mfma_f32_16x16x32_bf16 v[64:67], v[88:91], v[244:247], v[64:67]
  v_mfma_f32_16x16x32_bf16 v[68:71], v[92:95], v[244:247], v[68:71]
  s_waitcnt lgkmcnt(2)
  v_mfma_f32_16x16x32_bf16 v[32:35], a[72:75], v[72:75], v[32:35]
  v_mfma_f32_16x16x32_bf16 v[36:39], a[72:75], v[76:79], v[36:39]
  v_mfma_f32_16x16x32_bf16 v[40:43], a[152:155], v[72:75], v[40:43]
  v_mfma_f32_16x16x32_bf16 v[44:47], a[152:155], v[76:79], v[44:47]
  v_mfma_f32_16x16x32_bf16 v[48:51], v[72:75], a[232:235], v[48:51]
  v_mfma_f32_16x16x32_bf16 v[52:55], v[76:79], a[232:235], v[52:55]
  v_mfma_f32_16x16x32_bf16 v[56:59], v[72:75], v[168:171], v[56:59]
  v_mfma_f32_16x16x32_bf16 v[60:63], v[76:79], v[168:171], v[60:63]
  v_mfma_f32_16x16x32_bf16 v[64:67], v[72:75], v[248:251], v[64:67]
  v_mfma_f32_16x16x32_bf16 v[68:71], v[76:79], v[248:251], v[68:71]
  s_waitcnt lgkmcnt(0)
  v_mfma_f32_16x16x32_bf16 v[32:35], a[76:79], v[80:83], v[32:35]
  v_mfma_f32_16x16x32_bf16 v[36:39], a[76:79], v[84:87], v[36:39]
  v_mfma_f32_16x16x32_bf16 v[40:43], a[156:159], v[80:83], v[40:43]
  v_mfma_f32_16x16x32_bf16 v[44:47], a[156:159], v[84:87], v[44:47]
  v_mfma_f32_16x16x32_bf16 v[48:51], v[80:83], a[236:239], v[48:51]
  v_mfma_f32_16x16x32_bf16 v[52:55], v[84:87], a[236:239], v[52:55]
  v_mfma_f32_16x16x32_bf16 v[56:59], v[80:83], v[172:175], v[56:59]
  v_mfma_f32_16x16x32_bf16 v[60:63], v[84:87], v[172:175], v[60:63]
  v_mfma_f32_16x16x32_bf16 v[64:67], v[80:83], v[252:255], v[64:67]
  v_mfma_f32_16x16x32_bf16 v[68:71], v[84:87], v[252:255], v[68:71]
  v_cvt_pk_bf16_f32 v8, v32, v33
  v_cvt_pk_bf16_f32 v9, v34, v35
  v_cvt_pk_bf16_f32 v10, v40, v41
  v_cvt_pk_bf16_f32 v11, v42, v43
  s_add_u32 s34, s21, 2048
  buffer_store_dwordx4 v[8:11], v1, s[4:7], s34 offen
  v_cvt_pk_bf16_f32 v12, v36, v37
  v_cvt_pk_bf16_f32 v13, v38, v39
  v_cvt_pk_bf16_f32 v14, v44, v45
  v_cvt_pk_bf16_f32 v15, v46, v47
  s_add_u32 s34, s21, 8192
  buffer_store_dwordx4 v[12:15], v1, s[4:7], s34 offen
  v_cvt_pk_bf16_f32 v8, v48, v49
  v_cvt_pk_bf16_f32 v9, v50, v51
  v_cvt_pk_bf16_f32 v10, v52, v53
  v_cvt_pk_bf16_f32 v11, v54, v55
  s_add_u32 s34, s23, 1024
  buffer_store_dwordx4 v[8:11], v1, s[4:7], s34 offen
  v_cvt_pk_bf16_f32 v12, v56, v57
  v_cvt_pk_bf16_f32 v13, v58, v59
  v_cvt_pk_bf16_f32 v14, v60, v61
  v_cvt_pk_bf16_f32 v15, v62, v63
  s_add_u32 s34, s23, 2048
  buffer_store_dwordx4 v[12:15], v1, s[4:7], s34 offen
  v_cvt_pk_bf16_f32 v8, v64, v65
  v_cvt_pk_bf16_f32 v9, v66, v67
  v_cvt_pk_bf16_f32 v10, v68, v69
  v_cvt_pk_bf16_f32 v11, v70, v71
  s_add_u32 s34, s23, 3072
  buffer_store_dwordx4 v[8:11], v1, s[4:7], s34 offen
  s_waitcnt vmcnt(0)
  s_barrier
  s_add_u32 s17, s17, 1
  s_cmp_lt_u32 s17, 64
  s_cbranch_scc1 reca_ptop246
  s_branch reca_exit1
reca_pslow245:
reca_ptop251:
  s_cmp_lt_u32 s17, 3
  s_cbranch_scc1 reca_pgo252
  s_sub_u32 s36, s17, 3
reca_ppoll253:
  buffer_load_dword v28, v4, s[4:7], s25 offen sc1
  s_waitcnt vmcnt(0)
  v_readfirstlane_b32 s34, v28
  s_nop 3
  s_cmp_ge_i32 s34, s36
  s_cbranch_scc1 reca_pgo252
  s_sleep 8
  s_sub_u32 s18, s18, 1
  s_cbranch_scc0 reca_ppoll253
  s_mov_b32 s18, 0
reca_pgo252:
  s_waitcnt vmcnt(0)
  s_barrier
  v_add_u32 v7, s26, v1
  s_xor_b32 s26, s26, 40960
  s_add_u32 s37, s17, 1
  s_cmp_ge_u32 s37, 64
  s_cbranch_scc1 reca_pnodma254
  s_mul_i32 s20, s37, 40960
  s_add_u32 s20, s20, 84944896
  s_add_u32 m0, s26, 10240
  s_nop 0
  buffer_load_dwordx4 v1, s[4:7], s20 offen offset:0 lds
  buffer_load_dwordx4 v1, s[4:7], s20 offen offset:1024 lds
  buffer_load_dwordx4 v1, s[4:7], s20 offen offset:2048 lds
  buffer_load_dwordx4 v1, s[4:7], s20 offen offset:3072 lds
  s_add_u32 s20, s20, 4096
  s_add_u32 m0, s26, 14336
  s_nop 0
  buffer_load_dwordx4 v1, s[4:7], s20 offen offset:0 lds
  buffer_load_dwordx4 v1, s[4:7], s20 offen offset:1024 lds
  buffer_load_dwordx4 v1, s[4:7], s20 offen offset:2048 lds
  buffer_load_dwordx4 v1, s[4:7], s20 offen offset:3072 lds
  s_add_u32 s20, s20, 4096
  s_add_u32 m0, s26, 18432
  s_nop 0
  buffer_load_dwordx4 v1, s[4:7], s20 offen offset:0 lds
  buffer_load_dwordx4 v1, s[4:7], s20 offen offset:1024 lds
reca_pnodma254:
  s_lshl_b32 s34, s15, 3
  s_and_b32 s35, s17, 7
  s_add_u32 s34, s34, s35
  s_mul_i32 s34, s34, 12288
  s_mul_i32 s35, s16, 3072
  s_add_u32 s35, s35, s34
  s_add_u32 s21, s35, 37748736
  s_add_u32 s22, s35, 44040192
  s_mul_i32 s35, s16, 6144
  s_add_u32 s35, s35, s34
  s_add_u32 s23, s35, 40894464
  ds_read_b128 v[72:75], v7 offset:0
  ds_read_b128 v[76:79], v7 offset:20480
  ds_read_b128 v[80:83], v7 offset:1024
  ds_read_b128 v[84:87], v7 offset:21504
  ds_read_b128 v[88:91], v7 offset:2048
  ds_read_b128 v[92:95], v7 offset:22528
  s_waitcnt lgkmcnt(4)
  v_mfma_f32_16x16x32_bf16 v[32:35], a[0:3], v[72:75], 0
  v_mfma_f32_16x16x32_bf16 v[36:39], a[0:3], v[76:79], 0
  v_mfma_f32_16x16x32_bf16 v[40:43], a[80:83], v[72:75], 0
  v_mfma_f32_16x16x32_bf16 v[44:47], a[80:83], v[76:79], 0
  v_mfma_f32_16x16x32_bf16 v[48:51], v[72:75], a[160:163], 0
  v_mfma_f32_16x16x32_bf16 v[52:55], v[76:79], a[160:163], 0
  v_mfma_f32_16x16x32_bf16 v[56:59], v[72:75], v[96:99], 0
  v_mfma_f32_16x16x32_bf16 v[60:63], v[76:79], v[96:99], 0
  v_mfma_f32_16x16x32_bf16 v[64:67], v[72:75], v[176:179], 0
  v_mfma_f32_16x16x32_bf16 v[68:71], v[76:79], v[176:179], 0
  ds_read_b128 v[72:75], v7 offset:3072
  ds_read_b128 v[76:79], v7 offset:23552
  s_waitcnt lgkmcnt(4)
  v_mfma_f32_16x16x32_bf16 v[32:35], a[4:7], v[80:83], v[32:35]
  v_mfma_f32_16x16x32_bf16 v[36:39], a[4:7], v[84:87], v[36:39]
  v_mfma_f32_16x16x32_bf16 v[40:43], a[84:87], v[80:83], v[40:43]
  v_mfma_f32_16x16x32_bf16 v[44:47], a[84:87], v[84:87], v[44:47]
  v_mfma_f32_16x16x32_bf16 v[48:51], v[80:83], a[164:167], v[48:51]
  v_mfma_f32_16x16x32_bf16 v[52:55], v[84:87], a[164:167], v[52:55]
  v_mfma_f32_16x16x32_bf16 v[56:59], v[80:83], v[100:103], v[56:59]
  v_mfma_f32_16x16x32_bf16 v[60:63], v[84:87], v[100:103], v[60:63]
  v_mfma_f32_16x16x32_bf16 v[64:67], v[80:83], v[180:183], v[64:67]
  v_mfma_f32_16x16x32_bf16 v[68:71], v[84:87], v[180:183], v[68:71]
  ds_read_b128 v[80:83], v7 offset:4096
  ds_read_b128 v[84:87], v7 offset:24576
  s_waitcnt lgkmcnt(4)
  v_mfma_f32_16x16x32_bf16 v[32:35], a[8:11], v[88:91], v[32:35]
  v_mfma_f32_16x16x32_bf16 v[36:39], a[8:11], v[92:95], v[36:39]
  v_mfma_f32_16x16x32_bf16 v[40:43], a[88:91], v[88:91], v[40:43]
  v_mfma_f32_16x16x32_bf16 v[44:47], a[88:91], v[92:95], v[44:47]
  v_mfma_f32_16x16x32_bf16 v[48:51], v[88:91], a[168:171], v[48:51]
  v_mfma_f32_16x16x32_bf16 v[52:55], v[92:95], a[168:171], v[52:55]
  v_mfma_f32_16x16x32_bf16 v[56:59], v[88:91], v[104:107], v[56:59]
  v_mfma_f32_16x16x32_bf16 v[60:63], v[92:95], v[104:107], v[60:63]
  v_mfma_f32_16x16x32_bf16 v[64:67], v[88:91], v[184:187], v[64:67]
  v_mfma_f32_16x16x32_bf16 v[68:71], v[92:95], v[184:187], v[68:71]
  ds_read_b128 v[88:91], v7 offset:5120
  ds_read_b128 v[92:95], v7 offset:25600
  s_waitcnt lgkmcnt(4)
  v_mfma_f32_16x16x32_bf16 v[32:35], a[12:15], v[72:75], v[32:35]
  v_mfma_f32_16x16x32_bf16 v[36:39], a[12:15], v[76:79], v[36:39]
  v_mfma_f32_16x16x32_bf16 v[40:43], a[92:95], v[72:75], v[40:43]
  v_mfma_f32_16x16x32_bf16 v[44:47], a[92:95], v[76:79], v[44:47]
  v_mfma_f32_16x16x32_bf16 v[48:51], v[72:75], a[172:175], v[48:51]
  v_mfma_f32_16x16x32_bf16 v[52:55], v[76:79], a[172:175], v[52:55]
  v_mfma_f32_16x16x32_bf16 v[56:59], v[72:75], v[108:111], v[56:59]
  v_mfma_f32_16x16x32_bf16 v[60:63], v[76:79], v[108:111], v[60:63]
  v_mfma_f32_16x16x32_bf16 v[64:67], v[72:75], v[188:191], v[64:67]
  v_mfma_f32_16x16x32_bf16 v[68:71], v[76:79], v[188:191], v[68:71]
  ds_read_b128 v[72:75], v7 offset:6144
  ds_read_b128 v[76:79], v7 offset:26624
  s_waitcnt lgkmcnt(4)
  v_mfma_f32_16x16x32_bf16 v[32:35], a[16:19], v[80:83], v[32:35]
  v_mfma_f32_16x16x32_bf16 v[36:39], a[16:19], v[84:87], v[36:39]
  v_mfma_f32_16x16x32_bf16 v[40:43], a[96:99], v[80:83], v[40:43]
  v_mfma_f32_16x16x32_bf16 v[44:47], a[96:99], v[84:87], v[44:47]
  v_mfma_f32_16x16x32_bf16 v[48:51], v[80:83], a[176:179], v[48:51]
  v_mfma_f32_16x16x32_bf16 v[52:55], v[84:87], a[176:179], v[52:55]
  v_mfma_f32_16x16x32_bf16 v[56:59], v[80:83], v[112:115], v[56:59]
  v_mfma_f32_16x16x32_bf16 v[60:63], v[84:87], v[112:115], v[60:63]
  v_mfma_f32_16x16x32_bf16 v[64:67], v[80:83], v[192:195], v[64:67]
  v_mfma_f32_16x16x32_bf16 v[68:71], v[84:87], v[192:195], v[68:71]
  ds_read_b128 v[80:83], v7 offset:7168
  ds_read_b128 v[84:87], v7 offset:27648
  s_waitcnt lgkmcnt(4)
  v_mfma_f32_16x16x32_bf16 v[32:35], a[20:23], v[88:91], v[32:35]
  v_mfma_f32_16x16x32_bf16 v[36:39], a[20:23], v[92:95], v[36:39]
  v_mfma_f32_16x16x32_bf16 v[40:43], a[100:103], v[88:91], v[40:43]
  v_mfma_f32_16x16x32_bf16 v[44:47], a[100:103], v[92:95], v[44:47]
  v_mfma_f32_16x16x32_bf16 v[48:51], v[88:91], a[180:183], v[48:51]
  v_mfma_f32_16x16x32_bf16 v[52:55], v[92:95], a[180:183], v[52:55]
  v_mfma_f32_16x16x32_bf16 v[56:59], v[88:91], v[116:119], v[56:59]
  v_mfma_f32_16x16x32_bf16 v[60:63], v[92:95], v[116:119], v[60:63]
  v_mfma_f32_16x16x32_bf16 v[64:67], v[88:91], v[196:199], v[64:67]
  v_mfma_f32_16x16x32_bf16 v[68:71], v[92:95], v[196:199], v[68:71]
  ds_read_b128 v[88:91], v7 offset:8192
  ds_read_b128 v[92:95], v7 offset:28672
  s_waitcnt lgkmcnt(4)
  v_mfma_f32_16x16x32_bf16 v[32:35], a[24:27], v[72:75], v[32:35]
  v_mfma_f32_16x16x32_bf16 v[36:39], a[24:27], v[76:79], v[36:39]
  v_mfma_f32_16x16x32_bf16 v[40:43], a[104:107], v[72:75], v[40:43]
  v_mfma_f32_16x16x32_bf16 v[44:47], a[104:107], v[76:79], v[44:47]
  v_mfma_f32_16x16x32_bf16 v[48:51], v[72:75], a[184:187], v[48:51]
  v_mfma_f32_16x16x32_bf16 v[52:55], v[76:79], a[184:187], v[52:55]
  v_mfma_f32_16x16x32_bf16 v[56:59], v[72:75], v[120:123], v[56:59]
  v_mfma_f32_16x16x32_bf16 v[60:63], v[76:79], v[120:123], v[60:63]
  v_mfma_f32_16x16x32_bf16 v[64:67], v[72:75], v[200:203], v[64:67]
  v_mfma_f32_16x16x32_bf16 v[68:71], v[76:79], v[200:203], v[68:71]
  ds_read_b128 v[72:75], v7 offset:9216
  ds_read_b128 v[76:79], v7 offset:29696
  s_waitcnt lgkmcnt(4)
  v_mfma_f32_16x16x32_bf16 v[32:35], a[28:31], v[80:83], v[32:35]
  v_mfma_f32_16x16x32_bf16 v[36:39], a[28:31], v[84:87], v[36:39]
  v_mfma_f32_16x16x32_bf16 v[40:43], a[108:111], v[80:83], v[40:43]
  v_mfma_f32_16x16x32_bf16 v[44:47], a[108:111], v[84:87], v[44:47]
  v_mfma_f32_16x16x32_bf16 v[48:51], v[80:83], a[188:191], v[48:51]
  v_mfma_f32_16x16x32_bf16 v[52:55], v[84:87], a[188:191], v[52:55]
  v_mfma_f32_16x16x32_bf16 v[56:59], v[80:83], v[124:127], v[56:59]
  v_mfma_f32_16x16x32_bf16 v[60:63], v[84:87], v[124:127], v[60:63]
  v_mfma_f32_16x16x32_bf16 v[64:67], v[80:83], v[204:207], v[64:67]
  v_mfma_f32_16x16x32_bf16 v[68:71], v[84:87], v[204:207], v[68:71]
  ds_read_b128 v[80:83], v7 offset:10240
  ds_read_b128 v[84:87], v7 offset:30720
  s_waitcnt lgkmcnt(4)
  v_mfma_f32_16x16x32_bf16 v[32:35], a[32:35], v[88:91], v[32:35]
  v_mfma_f32_16x16x32_bf16 v[36:39], a[32:35], v[92:95], v[36:39]
  v_mfma_f32_16x16x32_bf16 v[40:43], a[112:115], v[88:91], v[40:43]
  v_mfma_f32_16x16x32_bf16 v[44:47], a[112:115], v[92:95], v[44:47]
  v_mfma_f32_16x16x32_bf16 v[48:51], v[88:91], a[192:195], v[48:51]
  v_mfma_f32_16x16x32_bf16 v[52:55], v[92:95], a[192:195], v[52:55]
  v_mfma_f32_16x16x32_bf16 v[56:59], v[88:91], v[128:131], v[56:59]
  v_mfma_f32_16x16x32_bf16 v[60:63], v[92:95], v[128:131], v[60:63]
  v_mfma_f32_16x16x32_bf16 v[64:67], v[88:91], v[208:211], v[64:67]
  v_mfma_f32_16x16x32_bf16 v[68:71], v[92:95], v[208:211], v[68:71]
  ds_read_b128 v[88:91], v7 offset:11264
  ds_read_b128 v[92:95], v7 offset:31744
  s_waitcnt lgkmcnt(4)
  v_mfma_f32_16x16x32_bf16 v[32:35], a[36:39], v[72:75], v[32:35]
  v_mfma_f32_16x16x32_bf16 v[36:39], a[36:39], v[76:79], v[36:39]
  v_mfma_f32_16x16x32_bf16 v[40:43], a[116:119], v[72:75], v[40:43]
  v_mfma_f32_16x16x32_bf16 v[44:47], a[116:119], v[76:79], v[44:47]
  v_mfma_f32_16x16x32_bf16 v[48:51], v[72:75], a[196:199], v[48:51]
  v_mfma_f32_16x16x32_bf16 v[52:55], v[76:79], a[196:199], v[52:55]
  v_mfma_f32_16x16x32_bf16 v[56:59], v[72:75], v[132:135], v[56:59]
  v_mfma_f32_16x16x32_bf16 v[60:63], v[76:79], v[132:135], v[60:63]
  v_mfma_f32_16x16x32_bf16 v[64:67], v[72:75], v[212:215], v[64:67]
  v_mfma_f32_16x16x32_bf16 v[68:71], v[76:79], v[212:215], v[68:71]
  ds_read_b128 v[72:75], v7 offset:12288
  ds_read_b128 v[76:79], v7 offset:32768
  s_waitcnt lgkmcnt(4)
  v_mfma_f32_16x16x32_bf16 v[32:35], a[40:43], v[80:83], v[32:35]
  v_mfma_f32_16x16x32_bf16 v[36:39], a[40:43], v[84:87], v[36:39]
  v_mfma_f32_16x16x32_bf16 v[40:43], a[120:123], v[80:83], v[40:43]
  v_mfma_f32_16x16x32_bf16 v[44:47], a[120:123], v[84:87], v[44:47]
  v_mfma_f32_16x16x32_bf16 v[48:51], v[80:83], a[200:203], v[48:51]
  v_mfma_f32_16x16x32_bf16 v[52:55], v[84:87], a[200:203], v[52:55]
  v_mfma_f32_16x16x32_bf16 v[56:59], v[80:83], v[136:139], v[56:59]
  v_mfma_f32_16x16x32_bf16 v[60:63], v[84:87], v[136:139], v[60:63]
  v_mfma_f32_16x16x32_bf16 v[64:67], v[80:83], v[216:219], v[64:67]
  v_mfma_f32_16x16x32_bf16 v[68:71], v[84:87], v[216:219], v[68:71]
  ds_read_b128 v[80:83], v7 offset:13312
  ds_read_b128 v[84:87], v7 offset:33792
  s_waitcnt lgkmcnt(4)
  v_mfma_f32_16x16x32_bf16 v[32:35], a[44:47], v[88:91], v[32:35]
  v_mfma_f32_16x16x32_bf16 v[36:39], a[44:47], v[92:95], v[36:39]
  v_mfma_f32_16x16x32_bf16 v[40:43], a[124:127], v[88:91], v[40:43]
  v_mfma_f32_16x16x32_bf16 v[44:47], a[124:127], v[92:95], v[44:47]
  v_mfma_f32_16x16x32_bf16 v[48:51], v[88:91], a[204:207], v[48:51]
  v_mfma_f32_16x16x32_bf16 v[52:55], v[92:95], a[204:207], v[52:55]
  v_mfma_f32_16x16x32_bf16 v[56:59], v[88:91], v[140:143], v[56:59]
  v_mfma_f32_16x16x32_bf16 v[60:63], v[92:95], v[140:143], v[60:63]
  v_mfma_f32_16x16x32_bf16 v[64:67], v[88:91], v[220:223], v[64:67]
  v_mfma_f32_16x16x32_bf16 v[68:71], v[92:95], v[220:223], v[68:71]
  ds_read_b128 v[88:91], v7 offset:14336
  ds_read_b128 v[92:95], v7 offset:34816
  s_waitcnt lgkmcnt(4)
  v_mfma_f32_16x16x32_bf16 v[32:35], a[48:51], v[72:75], v[32:35]
  v_mfma_f32_16x16x32_bf16 v[36:39], a[48:51], v[76:79], v[36:39]
  v_mfma_f32_16x16x32_bf16 v[40:43], a[128:131], v[72:75], v[40:43]
  v_mfma_f32_16x16x32_bf16 v[44:47], a[128:131], v[76:79], v[44:47]
  v_mfma_f32_16x16x32_bf16 v[48:51], v[72:75], a[208:211], v[48:51]
  v_mfma_f32_16x16x32_bf16 v[52:55], v[76:79], a[208:211], v[52:55]
  v_mfma_f32_16x16x32_bf16 v[56:59], v[72:75], v[144:147], v[56:59]
  v_mfma_f32_16x16x32_bf16 v[60:63], v[76:79], v[144:147], v[60:63]
  v_mfma_f32_16x16x32_bf16 v[64:67], v[72:75], v[224:227], v[64:67]
  v_mfma_f32_16x16x32_bf16 v[68:71], v[76:79], v[224:227], v[68:71]
  ds_read_b128 v[72:75], v7 offset:15360
  ds_read_b128 v[76:79], v7 offset:35840
  s_waitcnt lgkmcnt(4)
  v_mfma_f32_16x16x32_bf16 v[32:35], a[52:55], v[80:83], v[32:35]
  v_mfma_f32_16x16x32_bf16 v[36:39], a[52:55], v[84:87], v[36:39]
  v_mfma_f32_16x16x32_bf16 v[40:43], a[132:135], v[80:83], v[40:43]
  v_mfma_f32_16x16x32_bf16 v[44:47], a[132:135], v[84:87], v[44:47]
  v_mfma_f32_16x16x32_bf16 v[48:51], v[80:83], a[212:215], v[48:51]
  v_mfma_f32_16x16x32_bf16 v[52:55], v[84:87], a[212:215], v[52:55]
  v_mfma_f32_16x16x32_bf16 v[56:59], v[80:83], v[148:151], v[56:59]
  v_mfma_f32_16x16x32_bf16 v[60:63], v[84:87], v[148:151], v[60:63]
  v_mfma_f32_16x16x32_bf16 v[64:67], v[80:83], v[228:231], v[64:67]
  v_mfma_f32_16x16x32_bf16 v[68:71], v[84:87], v[228:231], v[68:71]
  ds_read_b128 v[80:83], v7 offset:16384
  ds_read_b128 v[84:87], v7 offset:36864
  s_waitcnt lgkmcnt(4)
  v_mfma_f32_16x16x32_bf16 v[32:35], a[56:59], v[88:91], v[32:35]
  v_mfma_f32_16x16x32_bf16 v[36:39], a[56:59], v[92:95], v[36:39]
  v_mfma_f32_16x16x32_bf16 v[40:43], a[136:139], v[88:91], v[40:43]
  v_mfma_f32_16x16x32_bf16 v[44:47], a[136:139], v[92:95], v[44:47]
  v_mfma_f32_16x16x32_bf16 v[48:51], v[88:91], a[216:219], v[48:51]
  v_mfma_f32_16x16x32_bf16 v[52:55], v[92:95], a[216:219], v[52:55]
  v_mfma_f32_16x16x32_bf16 v[56:59], v[88:91], v[152:155], v[56:59]
  v_mfma_f32_16x16x32_bf16 v[60:63], v[92:95], v[152:155], v[60:63]
  v_mfma_f32_16x16x32_bf16 v[64:67], v[88:91], v[232:235], v[64:67]
  v_mfma_f32_16x16x32_bf16 v[68:71], v[92:95], v[232:235], v[68:71]
  ds_read_b128 v[88:91], v7 offset:17408
  ds_read_b128 v[92:95], v7 offset:37888
  s_waitcnt lgkmcnt(4)
  v_mfma_f32_16x16x32_bf16 v[32:35], a[60:63], v[72:75], v[32:35]
  v_mfma_f32_16x16x32_bf16 v[36:39], a[60:63], v[76:79], v[36:39]
  v_mfma_f32_16x16x32_bf16 v[40:43], a[140:143], v[72:75], v[40:43]
  v_mfma_f32_16x16x32_bf16 v[44:47], a[140:143], v[76:79], v[44:47]
  v_mfma_f32_16x16x32_bf16 v[48:51], v[72:75], a[220:223], v[48:51]
  v_mfma_f32_16x16x32_bf16 v[52:55], v[76:79], a[220:223], v[52:55]
  v_mfma_f32_16x16x32_bf16 v[56:59], v[72:75], v[156:159], v[56:59]
  v_mfma_f32_16x16x32_bf16 v[60:63], v[76:79], v[156:159], v[60:63]
  v_mfma_f32_16x16x32_bf16 v[64:67], v[72:75], v[236:239], v[64:67]
  v_mfma_f32_16x16x32_bf16 v[68:71], v[76:79], v[236:239], v[68:71]
  ds_read_b128 v[72:75], v7 offset:18432
  ds_read_b128 v[76:79], v7 offset:38912
  s_waitcnt lgkmcnt(4)
  v_mfma_f32_16x16x32_bf16 v[32:35], a[64:67], v[80:83], v[32:35]
  v_mfma_f32_16x16x32_bf16 v[36:39], a[64:67], v[84:87], v[36:39]
  v_mfma_f32_16x16x32_bf16 v[40:43], a[144:147], v[80:83], v[40:43]
  v_mfma_f32_16x16x32_bf16 v[44:47], a[144:147], v[84:87], v[44:47]
  v_mfma_f32_16x16x32_bf16 v[48:51], v[80:83], a[224:227], v[48:51]
  v_mfma_f32_16x16x32_bf16 v[52:55], v[84:87], a[224:227], v[52:55]
  v_mfma_f32_16x16x32_bf16 v[56:59], v[80:83], v[160:163], v[56:59]
  v_mfma_f32_16x16x32_bf16 v[60:63], v[84:87], v[160:163], v[60:63]
  v_mfma_f32_16x16x32_bf16 v[64:67], v[80:83], v[240:243], v[64:67]
  v_mfma_f32_16x16x32_bf16 v[68:71], v[84:87], v[240:243], v[68:71]
  ds_read_b128 v[80:83], v7 offset:19456
  ds_read_b128 v[84:87], v7 offset:39936
  s_waitcnt lgkmcnt(4)
  v_mfma_f32_16x16x32_bf16 v[32:35], a[68:71], v[88:91], v[32:35]
  v_mfma_f32_16x16x32_bf16 v[36:39], a[68:71], v[92:95], v[36:39]
  v_mfma_f32_16x16x32_bf16 v[40:43], a[148:151], v[88:91], v[40:43]
  v_mfma_f32_16x16x32_bf16 v[44:47], a[148:151], v[92:95], v[44:47]
  v_mfma_f32_16x16x32_bf16 v[48:51], v[88:91], a[228:231], v[48:51]
  v_mfma_f32_16x16x32_bf16 v[52:55], v[92:95], a[228:231], v[52:55]
  v_mfma_f32_16x16x32_bf16 v[56:59], v[88:91], v[164:167], v[56:59]
  v_mfma_f32_16x16x32_bf16 v[60:63], v[92:95], v[164:167], v[60:63]
  v_mfma_f32_16x16x32_bf16 v[64:67], v[88:91], v[244:247], v[64:67]
  v_mfma_f32_16x16x32_bf16 v[68:71], v[92:95], v[244:247], v[68:71]
  s_waitcnt lgkmcnt(2)
  v_mfma_f32_16x16x32_bf16 v[32:35], a[72:75], v[72:75], v[32:35]
  v_mfma_f32_16x16x32_bf16 v[36:39], a[72:75], v[76:79], v[36:39]
  v_mfma_f32_16x16x32_bf16 v[40:43], a[152:155], v[72:75], v[40:43]
  v_mfma_f32_16x16x32_bf16 v[44:47], a[152:155], v[76:79], v[44:47]
  v_mfma_f32_16x16x32_bf16 v[48:51], v[72:75], a[232:235], v[48:51]
  v_mfma_f32_16x16x32_bf16 v[52:55], v[76:79], a[232:235], v[52:55]
  v_mfma_f32_16x16x32_bf16 v[56:59], v[72:75], v[168:171], v[56:59]
  v_mfma_f32_16x16x32_bf16 v[60:63], v[76:79], v[168:171], v[60:63]
  v_mfma_f32_16x16x32_bf16 v[64:67], v[72:75], v[248:251], v[64:67]
  v_mfma_f32_16x16x32_bf16 v[68:71], v[76:79], v[248:251], v[68:71]
  s_waitcnt lgkmcnt(0)
  v_mfma_f32_16x16x32_bf16 v[32:35], a[76:79], v[80:83], v[32:35]
  v_mfma_f32_16x16x32_bf16 v[36:39], a[76:79], v[84:87], v[36:39]
  v_mfma_f32_16x16x32_bf16 v[40:43], a[156:159], v[80:83], v[40:43]
  v_mfma_f32_16x16x32_bf16 v[44:47], a[156:159], v[84:87], v[44:47]
  v_mfma_f32_16x16x32_bf16 v[48:51], v[80:83], a[236:239], v[48:51]
  v_mfma_f32_16x16x32_bf16 v[52:55], v[84:87], a[236:239], v[52:55]
  v_mfma_f32_16x16x32_bf16 v[56:59], v[80:83], v[172:175], v[56:59]
  v_mfma_f32_16x16x32_bf16 v[60:63], v[84:87], v[172:175], v[60:63]
  v_mfma_f32_16x16x32_bf16 v[64:67], v[80:83], v[252:255], v[64:67]
  v_mfma_f32_16x16x32_bf16 v[68:71], v[84:87], v[252:255], v[68:71]
  v_cvt_pk_bf16_f32 v8, v32, v33
  v_cvt_pk_bf16_f32 v9, v34, v35
  v_cvt_pk_bf16_f32 v10, v40, v41
  v_cvt_pk_bf16_f32 v11, v42, v43
  s_add_u32 s34, s21, 2048
  buffer_store_dwordx4 v[8:11], v1, s[4:7], s34 offen sc1
  v_cvt_pk_bf16_f32 v12, v36, v37
  v_cvt_pk_bf16_f32 v13, v38, v39
  v_cvt_pk_bf16_f32 v14, v44, v45
  v_cvt_pk_bf16_f32 v15, v46, v47
  s_add_u32 s34, s21, 8192
  buffer_store_dwordx4 v[12:15], v1, s[4:7], s34 offen sc1
  v_cvt_pk_bf16_f32 v8, v48, v49
  v_cvt_pk_bf16_f32 v9, v50, v51
  v_cvt_pk_bf16_f32 v10, v52, v53
  v_cvt_pk_bf16_f32 v11, v54, v55
  s_add_u32 s34, s23, 1024
  buffer_store_dwordx4 v[8:11], v1, s[4:7], s34 offen sc1
  v_cvt_pk_bf16_f32 v12, v56, v57
  v_cvt_pk_bf16_f32 v13, v58, v59
  v_cvt_pk_bf16_f32 v14, v60, v61
  v_cvt_pk_bf16_f32 v15, v62, v63
  s_add_u32 s34, s23, 2048
  buffer_store_dwordx4 v[12:15], v1, s[4:7], s34 offen sc1
  v_cvt_pk_bf16_f32 v8, v64, v65
  v_cvt_pk_bf16_f32 v9, v66, v67
  v_cvt_pk_bf16_f32 v10, v68, v69
  v_cvt_pk_bf16_f32 v11, v70, v71
  s_add_u32 s34, s23, 3072
  buffer_store_dwordx4 v[8:11], v1, s[4:7], s34 offen sc1
  s_waitcnt vmcnt(0)
  s_barrier
  s_add_u32 s17, s17, 1
  s_cmp_lt_u32 s17, 64
  s_cbranch_scc1 reca_ptop251
  s_branch reca_exit1
reca_pw2_228:
  s_mov_b32 s17, 0
  s_mov_b32 s26, 0
  s_mul_i32 s20, s17, 40960
  s_add_u32 s20, s20, 84955136
  s_add_u32 m0, s26, 20480
  s_nop 0
  buffer_load_dwordx4 v1, s[4:7], s20 offen offset:0 lds
  buffer_load_dwordx4 v1, s[4:7], s20 offen offset:1024 lds
  buffer_load_dwordx4 v1, s[4:7], s20 offen offset:2048 lds
  buffer_load_dwordx4 v1, s[4:7], s20 offen offset:3072 lds
  s_add_u32 s20, s20, 4096
  s_add_u32 m0, s26, 24576
  s_nop 0
  buffer_load_dwordx4 v1, s[4:7], s20 offen offset:0 lds
  buffer_load_dwordx4 v1, s[4:7], s20 offen offset:1024 lds
  buffer_load_dwordx4 v1, s[4:7], s20 offen offset:2048 lds
  buffer_load_dwordx4 v1, s[4:7], s20 offen offset:3072 lds
  s_add_u32 s20, s20, 4096
  s_add_u32 m0, s26, 28672
  s_nop 0
  buffer_load_dwordx4 v1, s[4:7], s20 offen offset:0 lds
  buffer_load_dwordx4 v1, s[4:7], s20 offen offset:1024 lds
  s_mul_i32 s34, s15, 12
  s_mul_i32 s35, s16, 6
  s_add_u32 s34, s34, s35
  s_add_u32 s34, s34, 0
  s_mul_i32 s34, s34, 20480
  s_add_u32 s34, s34, 6291456
  buffer_load_dwordx4 a[0:3], v1, s[4:7], s34 offen offset:0
  buffer_load_dwordx4 a[4:7], v1, s[4:7], s34 offen offset:1024
  buffer_load_dwordx4 a[8:11], v1, s[4:7], s34 offen offset:2048
  buffer_load_dwordx4 a[12:15], v1, s[4:7], s34 offen offset:3072
  s_add_u32 s34, s34, 4096
  buffer_load_dwordx4 a[16:19], v1, s[4:7], s34 offen offset:0
  buffer_load_dwordx4 a[20:23], v1, s[4:7], s34 offen offset:1024
  buffer_load_dwordx4 a[24:27], v1, s[4:7], s34 offen offset:2048
  buffer_load_dwordx4 a[28:31], v1, s[4:7], s34 offen offset:3072
  s_add_u32 s34, s34, 4096
  buffer_load_dwordx4 a[32:35], v1, s[4:7], s34 offen offset:0
  buffer_load_dwordx4 a[36:39], v1, s[4:7], s34 offen offset:1024
  buffer_load_dwordx4 a[40:43], v1, s[4:7], s34 offen offset:2048
  buffer_load_dwordx4 a[44:47], v1, s[4:7], s34 offen offset:3072
  s_add_u32 s34, s34, 4096
  buffer_load_dwordx4 a[48:51], v1, s[4:7], s34 offen offset:0
  buffer_load_dwordx4 a[52:55], v1, s[4:7], s34 offen offset:1024
  buffer_load_dwordx4 a[56:59], v1, s[4:7], s34 offen offset:2048
  buffer_load_dwordx4 a[60:63], v1, s[4:7], s34 offen offset:3072
  s_add_u32 s34, s34, 4096
  buffer_load_dwordx4 a[64:67], v1, s[4:7], s34 offen offset:0
  buffer_load_dwordx4 a[68:71], v1, s[4:7], s34 offen offset:1024
  buffer_load_dwordx4 a[72:75], v1, s[4:7], s34 offen offset:2048
  buffer_load_dwordx4 a[76:79], v1, s[4:7], s34 offen offset:3072
  s_mul_i32 s34, s15, 12
  s_mul_i32 s35, s16, 6
  s_add_u32 s34, s34, s35
  s_add_u32 s34, s34, 1
  s_mul_i32 s34, s34, 20480
  s_add_u32 s34, s34, 6291456
  buffer_load_dwordx4 a[80:83], v1, s[4:7], s34 offen offset:0
  buffer_load_dwordx4 a[84:87], v1, s[4:7], s34 offen offset:1024
  buffer_load_dwordx4 a[88:91], v1, s[4:7], s34 offen offset:2048
  buffer_load_dwordx4 a[92:95], v1, s[4:7], s34 offen offset:3072
  s_add_u32 s34, s34, 4096
  buffer_load_dwordx4 a[96:99], v1, s[4:7], s34 offen offset:0
  buffer_load_dwordx4 a[100:103], v1, s[4:7], s34 offen offset:1024
  buffer_load_dwordx4 a[104:107], v1, s[4:7], s34 offen offset:2048
  buffer_load_dwordx4 a[108:111], v1, s[4:7], s34 offen offset:3072
  s_add_u32 s34, s34, 4096
  buffer_load_dwordx4 a[112:115], v1, s[4:7], s34 offen offset:0
  buffer_load_dwordx4 a[116:119], v1, s[4:7], s34 offen offset:1024
  buffer_load_dwordx4 a[120:123], v1, s[4:7], s34 offen offset:2048
  buffer_load_dwordx4 a[124:127], v1, s[4:7], s34 offen offset:3072
  s_add_u32 s34, s34, 4096
  buffer_load_dwordx4 a[128:131], v1, s[4:7], s34 offen offset:0
  buffer_load_dwordx4 a[132:135], v1, s[4:7], s34 offen offset:1024
  buffer_load_dwordx4 a[136:139], v1, s[4:7], s34 offen offset:2048
  buffer_load_dwordx4 a[140:143], v1, s[4:7], s34 offen offset:3072
  s_add_u32 s34, s34, 4096
  buffer_load_dwordx4 a[144:147], v1, s[4:7], s34 offen offset:0
  buffer_load_dwordx4 a[148:151], v1, s[4:7], s34 offen offset:1024
  buffer_load_dwordx4 a[152:155], v1, s[4:7], s34 offen offset:2048
  buffer_load_dwordx4 a[156:159], v1, s[4:7], s34 offen offset:3072
  s_waitcnt vmcnt(20)
  s_mul_i32 s34, s15, 12
  s_mul_i32 s35, s16, 6
  s_add_u32 s34, s34, s35
  s_add_u32 s34, s34, 4
  s_mul_i32 s34, s34, 20480
  s_add_u32 s34, s34, 22020096
  buffer_load_dwordx4 a[160:163], v1, s[4:7], s34 offen offset:0
  buffer_load_dwordx4 a[164:167], v1, s[4:7], s34 offen offset:1024
  buffer_load_dwordx4 a[168:171], v1, s[4:7], s34 offen offset:2048
  buffer_load_dwordx4 a[172:175], v1, s[4:7], s34 offen offset:3072
  s_add_u32 s34, s34, 4096
  buffer_load_dwordx4 a[176:179], v1, s[4:7], s34 offen offset:0
  buffer_load_dwordx4 a[180:183], v1, s[4:7], s34 offen offset:1024
  buffer_load_dwordx4 a[184:187], v1, s[4:7], s34 offen offset:2048
  buffer_load_dwordx4 a[188:191], v1, s[4:7], s34 offen offset:3072
  s_add_u32 s34, s34, 4096
  buffer_load_dwordx4 a[192:195], v1, s[4:7], s34 offen offset:0
  buffer_load_dwordx4 a[196:199], v1, s[4:7], s34 offen offset:1024
  buffer_load_dwordx4 a[200:203], v1, s[4:7], s34 offen offset:2048
  buffer_load_dwordx4 a[204:207], v1, s[4:7], s34 offen offset:3072
  s_add_u32 s34, s34, 4096
  buffer_load_dwordx4 a[208:211], v1, s[4:7], s34 offen offset:0
  buffer_load_dwordx4 a[212:215], v1, s[4:7], s34 offen offset:1024
  buffer_load_dwordx4 a[216:219], v1, s[4:7], s34 offen offset:2048
  buffer_load_dwordx4 a[220:223], v1, s[4:7], s34 offen offset:3072
  s_add_u32 s34, s34, 4096
  buffer_load_dwordx4 a[224:227], v1, s[4:7], s34 offen offset:0
  buffer_load_dwordx4 a[228:231], v1, s[4:7], s34 offen offset:1024
  buffer_load_dwordx4 a[232:235], v1, s[4:7], s34 offen offset:2048
  buffer_load_dwordx4 a[236:239], v1, s[4:7], s34 offen offset:3072
  s_waitcnt vmcnt(20)
  s_mul_i32 s34, s15, 12
  s_mul_i32 s35, s16, 6
  s_add_u32 s34, s34, s35
  s_add_u32 s34, s34, 5
  s_mul_i32 s34, s34, 20480
  s_add_u32 s34, s34, 22020096
  buffer_load_dwordx4 v[96:99], v1, s[4:7], s34 offen offset:0
  buffer_load_dwordx4 v[100:103], v1, s[4:7], s34 offen offset:1024
  buffer_load_dwordx4 v[104:107], v1, s[4:7], s34 offen offset:2048
  buffer_load_dwordx4 v[108:111], v1, s[4:7], s34 offen offset:3072
  s_add_u32 s34, s34, 4096
  buffer_load_dwordx4 v[112:115], v1, s[4:7], s34 offen offset:0
  buffer_load_dwordx4 v[116:119], v1, s[4:7], s34 offen offset:1024
  buffer_load_dwordx4 v[120:123], v1, s[4:7], s34 offen offset:2048
  buffer_load_dwordx4 v[124:127], v1, s[4:7], s34 offen offset:3072
  s_add_u32 s34, s34, 4096
  buffer_load_dwordx4 v[128:131], v1, s[4:7], s34 offen offset:0
  buffer_load_dwordx4 v[132:135], v1, s[4:7], s34 offen offset:1024
  buffer_load_dwordx4 v[136:139], v1, s[4:7], s34 offen offset:2048
  buffer_load_dwordx4 v[140:143], v1, s[4:7], s34 offen offset:3072
  s_add_u32 s34, s34, 4096
  buffer_load_dwordx4 v[144:147], v1, s[4:7], s34 offen offset:0
  buffer_load_dwordx4 v[148:151], v1, s[4:7], s34 offen offset:1024
  buffer_load_dwordx4 v[152:155], v1, s[4:7], s34 offen offset:2048
  buffer_load_dwordx4 v[156:159], v1, s[4:7], s34 offen offset:3072
  s_add_u32 s34, s34, 4096
  buffer_load_dwordx4 v[160:163], v1, s[4:7], s34 offen offset:0
  buffer_load_dwordx4 v[164:167], v1, s[4:7], s34 offen offset:1024
  buffer_load_dwordx4 v[168:171], v1, s[4:7], s34 offen offset:2048
  buffer_load_dwordx4 v[172:175], v1, s[4:7], s34 offen offset:3072
  s_waitcnt vmcnt(20)
  v_and_b32 v30, 7, v0
  v_lshlrev_b32 v30, 3, v30
reca_cens256:
  buffer_load_dwordx2 v[28:29], v30, s[8:11], 0 offen sc1
  s_waitcnt vmcnt(0)
  v_sad_u8 v31, v28, 0, 0
  v_sad_u8 v31, v29, 0, v31
  v_cmp_gt_u32 vcc, 32, v31
  s_cbranch_vccz reca_censok257
  s_sleep 8
  s_sub_u32 s18, s18, 1
  s_cbranch_scc0 reca_cens256
  s_mov_b32 s18, 0
reca_censok257:
  v_and_b32 v28, 0x20202020, v28
  v_and_b32 v29, 0x20202020, v29
  v_cmp_ne_u32 s[34:35], 0, v28
  v_cmp_ne_u32 s[36:37], 0, v29
  s_nop 3
  s_and_b32 s34, s34, 0xff
  s_and_b32 s36, s36, 0xff
  s_or_b32 s35, s34, s36
  s_lshr_b32 s37, s35, s13
  s_and_b32 s37, s37, 1
  s_xor_b32 s43, s37, 1
  s_cmp_eq_u32 s57, 0
  s_cselect_b32 s58, s36, s34
  v_mov_b32 v31, 0x80000000
  s_cmp_lg_u32 s43, 0
  s_cbranch_scc1 reca_pslow258
reca_ptop259:
  s_cmp_lt_u32 s17, 3
  s_cbranch_scc1 reca_pgo260
  s_sub_u32 s36, s17, 3
reca_ppoll261:
  buffer_load_dword v28, v4, s[4:7], s25 offen sc1
  s_waitcnt vmcnt(0)
  v_readfirstlane_b32 s34, v28
  s_nop 3
  s_cmp_ge_i32 s34, s36
  s_cbranch_scc1 reca_pgo260
  s_sleep 8
  s_sub_u32 s18, s18, 1
  s_cbranch_scc0 reca_ppoll261
  s_mov_b32 s18, 0
reca_pgo260:
  s_waitcnt vmcnt(0)
  s_barrier
  v_add_u32 v7, s26, v1
  s_xor_b32 s26, s26, 40960
  s_add_u32 s37, s17, 1
  s_cmp_ge_u32 s37, 64
  s_cbranch_scc1 reca_pnodma262
  s_mul_i32 s20, s37, 40960
  s_add_u32 s20, s20, 84955136
  s_add_u32 m0, s26, 20480
  s_nop 0
  buffer_load_dwordx4 v1, s[4:7], s20 offen offset:0 lds
  buffer_load_dwordx4 v1, s[4:7], s20 offen offset:1024 lds
  buffer_load_dwordx4 v1, s[4:7], s20 offen offset:2048 lds
  buffer_load_dwordx4 v1, s[4:7], s20 offen offset:3072 lds
  s_add_u32 s20, s20, 4096
  s_add_u32 m0, s26, 24576
  s_nop 0
  buffer_load_dwordx4 v1, s[4:7], s20 offen offset:0 lds
  buffer_load_dwordx4 v1, s[4:7], s20 offen offset:1024 lds
  buffer_load_dwordx4 v1, s[4:7], s20 offen offset:2048 lds
  buffer_load_dwordx4 v1, s[4:7], s20 offen offset:3072 lds
  s_add_u32 s20, s20, 4096
  s_add_u32 m0, s26, 28672
  s_nop 0
  buffer_load_dwordx4 v1, s[4:7], s20 offen offset:0 lds
  buffer_load_dwordx4 v1, s[4:7], s20 offen offset:1024 lds
reca_pnodma262:
  s_lshl_b32 s34, s15, 3
  s_and_b32 s35, s17, 7
  s_add_u32 s34, s34, s35
  s_mul_i32 s34, s34, 12288
  s_mul_i32 s35, s16, 3072
  s_add_u32 s35, s35, s34
  s_add_u32 s21, s35, 37748736
  s_add_u32 s22, s35, 44040192
  s_mul_i32 s35, s16, 6144
  s_add_u32 s35, s35, s34
  s_add_u32 s23, s35, 40894464
  ds_read_b128 v[72:75], v7 offset:0
  ds_read_b128 v[76:79], v7 offset:20480
  ds_read_b128 v[80:83], v7 offset:1024
  ds_read_b128 v[84:87], v7 offset:21504
  ds_read_b128 v[88:91], v7 offset:2048
  ds_read_b128 v[92:95], v7 offset:22528
  s_waitcnt lgkmcnt(4)
  v_mfma_f32_16x16x32_bf16 v[32:35], a[0:3], v[72:75], 0
  v_mfma_f32_16x16x32_bf16 v[36:39], a[0:3], v[76:79], 0
  v_mfma_f32_16x16x32_bf16 v[40:43], a[80:83], v[72:75], 0
  v_mfma_f32_16x16x32_bf16 v[44:47], a[80:83], v[76:79], 0
  v_mfma_f32_16x16x32_bf16 v[48:51], v[72:75], a[160:163], 0
  v_mfma_f32_16x16x32_bf16 v[52:55], v[76:79], a[160:163], 0
  v_mfma_f32_16x16x32_bf16 v[56:59], v[72:75], v[96:99], 0
  v_mfma_f32_16x16x32_bf16 v[60:63], v[76:79], v[96:99], 0
  ds_read_b128 v[72:75], v7 offset:3072
  ds_read_b128 v[76:79], v7 offset:23552
  s_waitcnt lgkmcnt(4)
  v_mfma_f32_16x16x32_bf16 v[32:35], a[4:7], v[80:83], v[32:35]
  v_mfma_f32_16x16x32_bf16 v[36:39], a[4:7], v[84:87], v[36:39]
  v_mfma_f32_16x16x32_bf16 v[40:43], a[84:87], v[80:83], v[40:43]
  v_mfma_f32_16x16x32_bf16 v[44:47], a[84:87], v[84:87], v[44:47]
  v_mfma_f32_16x16x32_bf16 v[48:51], v[80:83], a[164:167], v[48:51]
  v_mfma_f32_16x16x32_bf16 v[52:55], v[84:87], a[164:167], v[52:55]
  v_mfma_f32_16x16x32_bf16 v[56:59], v[80:83], v[100:103], v[56:59]
  v_mfma_f32_16x16x32_bf16 v[60:63], v[84:87], v[100:103], v[60:63]
  ds_read_b128 v[80:83], v7 offset:4096
  ds_read_b128 v[84:87], v7 offset:24576
  s_waitcnt lgkmcnt(4)
  v_mfma_f32_16x16x32_bf16 v[32:35], a[8:11], v[88:91], v[32:35]
  v_mfma_f32_16x16x32_bf16 v[36:39], a[8:11], v[92:95], v[36:39]
  v_mfma_f32_16x16x32_bf16 v[40:43], a[88:91], v[88:91], v[40:43]
  v_mfma_f32_16x16x32_bf16 v[44:47], a[88:91], v[92:95], v[44:47]
  v_mfma_f32_16x16x32_bf16 v[48:51], v[88:91], a[168:171], v[48:51]
  v_mfma_f32_16x16x32_bf16 v[52:55], v[92:95], a[168:171], v[52:55]
  v_mfma_f32_16x16x32_bf16 v[56:59], v[88:91], v[104:107], v[56:59]
  v_mfma_f32_16x16x32_bf16 v[60:63], v[92:95], v[104:107], v[60:63]
  ds_read_b128 v[88:91], v7 offset:5120
  ds_read_b128 v[92:95], v7 offset:25600
  s_waitcnt lgkmcnt(4)
  v_mfma_f32_16x16x32_bf16 v[32:35], a[12:15], v[72:75], v[32:35]
  v_mfma_f32_16x16x32_bf16 v[36:39], a[12:15], v[76:79], v[36:39]
  v_mfma_f32_16x16x32_bf16 v[40:43], a[92:95], v[72:75], v[40:43]
  v_mfma_f32_16x16x32_bf16 v[44:47], a[92:95], v[76:79], v[44:47]
  v_mfma_f32_16x16x32_bf16 v[48:51], v[72:75], a[172:175], v[48:51]
  v_mfma_f32_16x16x32_bf16 v[52:55], v[76:79], a[172:175], v[52:55]
  v_mfma_f32_16x16x32_bf16 v[56:59], v[72:75], v[108:111], v[56:59]
  v_mfma_f32_16x16x32_bf16 v[60:63], v[76:79], v[108:111], v[60:63]
  ds_read_b128 v[72:75], v7 offset:6144
  ds_read_b128 v[76:79], v7 offset:26624
  s_waitcnt lgkmcnt(4)
  v_mfma_f32_16x16x32_bf16 v[32:35], a[16:19], v[80:83], v[32:35]
  v_mfma_f32_16x16x32_bf16 v[36:39], a[16:19], v[84:87], v[36:39]
  v_mfma_f32_16x16x32_bf16 v[40:43], a[96:99], v[80:83], v[40:43]
  v_mfma_f32_16x16x32_bf16 v[44:47], a[96:99], v[84:87], v[44:47]
  v_mfma_f32_16x16x32_bf16 v[48:51], v[80:83], a[176:179], v[48:51]
  v_mfma_f32_16x16x32_bf16 v[52:55], v[84:87], a[176:179], v[52:55]
  v_mfma_f32_16x16x32_bf16 v[56:59], v[80:83], v[112:115], v[56:59]
  v_mfma_f32_16x16x32_bf16 v[60:63], v[84:87], v[112:115], v[60:63]
  ds_read_b128 v[80:83], v7 offset:7168
  ds_read_b128 v[84:87], v7 offset:27648
  s_waitcnt lgkmcnt(4)
  v_mfma_f32_16x16x32_bf16 v[32:35], a[20:23], v[88:91], v[32:35]
  v_mfma_f32_16x16x32_bf16 v[36:39], a[20:23], v[92:95], v[36:39]
  v_mfma_f32_16x16x32_bf16 v[40:43], a[100:103], v[88:91], v[40:43]
  v_mfma_f32_16x16x32_bf16 v[44:47], a[100:103], v[92:95], v[44:47]
  v_mfma_f32_16x16x32_bf16 v[48:51], v[88:91], a[180:183], v[48:51]
  v_mfma_f32_16x16x32_bf16 v[52:55], v[92:95], a[180:183], v[52:55]
  v_mfma_f32_16x16x32_bf16 v[56:59], v[88:91], v[116:119], v[56:59]
  v_mfma_f32_16x16x32_bf16 v[60:63], v[92:95], v[116:119], v[60:63]
  ds_read_b128 v[88:91], v7 offset:8192
  ds_read_b128 v[92:95], v7 offset:28672
  s_waitcnt lgkmcnt(4)
  v_mfma_f32_16x16x32_bf16 v[32:35], a[24:27], v[72:75], v[32:35]
  v_mfma_f32_16x16x32_bf16 v[36:39], a[24:27], v[76:79], v[36:39]
  v_mfma_f32_16x16x32_bf16 v[40:43], a[104:107], v[72:75], v[40:43]
  v_mfma_f32_16x16x32_bf16 v[44:47], a[104:107], v[76:79], v[44:47]
  v_mfma_f32_16x16x32_bf16 v[48:51], v[72:75], a[184:187], v[48:51]
  v_mfma_f32_16x16x32_bf16 v[52:55], v[76:79], a[184:187], v[52:55]
  v_mfma_f32_16x16x32_bf16 v[56:59], v[72:75], v[120:123], v[56:59]
  v_mfma_f32_16x16x32_bf16 v[60:63], v[76:79], v[120:123], v[60:63]
  ds_read_b128 v[72:75], v7 offset:9216
  ds_read_b128 v[76:79], v7 offset:29696
  s_waitcnt lgkmcnt(4)
  v_mfma_f32_16x16x32_bf16 v[32:35], a[28:31], v[80:83], v[32:35]
  v_mfma_f32_16x16x32_bf16 v[36:39], a[28:31], v[84:87], v[36:39]
  v_mfma_f32_16x16x32_bf16 v[40:43], a[108:111], v[80:83], v[40:43]
  v_mfma_f32_16x16x32_bf16 v[44:47], a[108:111], v[84:87], v[44:47]
  v_mfma_f32_16x16x32_bf16 v[48:51], v[80:83], a[188:191], v[48:51]
  v_mfma_f32_16x16x32_bf16 v[52:55], v[84:87], a[188:191], v[52:55]
  v_mfma_f32_16x16x32_bf16 v[56:59], v[80:83], v[124:127], v[56:59]
  v_mfma_f32_16x16x32_bf16 v[60:63], v[84:87], v[124:127], v[60:63]
  ds_read_b128 v[80:83], v7 offset:10240
  ds_read_b128 v[84:87], v7 offset:30720
  s_waitcnt lgkmcnt(4)
  v_mfma_f32_16x16x32_bf16 v[32:35], a[32:35], v[88:91], v[32:35]
  v_mfma_f32_16x16x32_bf16 v[36:39], a[32:35], v[92:95], v[36:39]
  v_mfma_f32_16x16x32_bf16 v[40:43], a[112:115], v[88:91], v[40:43]
  v_mfma_f32_16x16x32_bf16 v[44:47], a[112:115], v[92:95], v[44:47]
  v_mfma_f32_16x16x32_bf16 v[48:51], v[88:91], a[192:195], v[48:51]
  v_mfma_f32_16x16x32_bf16 v[52:55], v[92:95], a[192:195], v[52:55]
  v_mfma_f32_16x16x32_bf16 v[56:59], v[88:91], v[128:131], v[56:59]
  v_mfma_f32_16x16x32_bf16 v[60:63], v[92:95], v[128:131], v[60:63]
  ds_read_b128 v[88:91], v7 offset:11264
  ds_read_b128 v[92:95], v7 offset:31744
  s_waitcnt lgkmcnt(4)
  v_mfma_f32_16x16x32_bf16 v[32:35], a[36:39], v[72:75], v[32:35]
  v_mfma_f32_16x16x32_bf16 v[36:39], a[36:39], v[76:79], v[36:39]
  v_mfma_f32_16x16x32_bf16 v[40:43], a[116:119], v[72:75], v[40:43]
  v_mfma_f32_16x16x32_bf16 v[44:47], a[116:119], v[76:79], v[44:47]
  v_mfma_f32_16x16x32_bf16 v[48:51], v[72:75], a[196:199], v[48:51]
  v_mfma_f32_16x16x32_bf16 v[52:55], v[76:79], a[196:199], v[52:55]
  v_mfma_f32_16x16x32_bf16 v[56:59], v[72:75], v[132:135], v[56:59]
  v_mfma_f32_16x16x32_bf16 v[60:63], v[76:79], v[132:135], v[60:63]
  ds_read_b128 v[72:75], v7 offset:12288
  ds_read_b128 v[76:79], v7 offset:32768
  s_waitcnt lgkmcnt(4)
  v_mfma_f32_16x16x32_bf16 v[32:35], a[40:43], v[80:83], v[32:35]
  v_mfma_f32_16x16x32_bf16 v[36:39], a[40:43], v[84:87], v[36:39]
  v_mfma_f32_16x16x32_bf16 v[40:43], a[120:123], v[80:83], v[40:43]
  v_mfma_f32_16x16x32_bf16 v[44:47], a[120:123], v[84:87], v[44:47]
  v_mfma_f32_16x16x32_bf16 v[48:51], v[80:83], a[200:203], v[48:51]
  v_mfma_f32_16x16x32_bf16 v[52:55], v[84:87], a[200:203], v[52:55]
  v_mfma_f32_16x16x32_bf16 v[56:59], v[80:83], v[136:139], v[56:59]
  v_mfma_f32_16x16x32_bf16 v[60:63], v[84:87], v[136:139], v[60:63]
  ds_read_b128 v[80:83], v7 offset:13312
  ds_read_b128 v[84:87], v7 offset:33792
  s_waitcnt lgkmcnt(4)
  v_mfma_f32_16x16x32_bf16 v[32:35], a[44:47], v[88:91], v[32:35]
  v_mfma_f32_16x16x32_bf16 v[36:39], a[44:47], v[92:95], v[36:39]
  v_mfma_f32_16x16x32_bf16 v[40:43], a[124:127], v[88:91], v[40:43]
  v_mfma_f32_16x16x32_bf16 v[44:47], a[124:127], v[92:95], v[44:47]
  v_mfma_f32_16x16x32_bf16 v[48:51], v[88:91], a[204:207], v[48:51]
  v_mfma_f32_16x16x32_bf16 v[52:55], v[92:95], a[204:207], v[52:55]
  v_mfma_f32_16x16x32_bf16 v[56:59], v[88:91], v[140:143], v[56:59]
  v_mfma_f32_16x16x32_bf16 v[60:63], v[92:95], v[140:143], v[60:63]
  ds_read_b128 v[88:91], v7 offset:14336
  ds_read_b128 v[92:95], v7 offset:34816
  s_waitcnt lgkmcnt(4)
  v_mfma_f32_16x16x32_bf16 v[32:35], a[48:51], v[72:75], v[32:35]
  v_mfma_f32_16x16x32_bf16 v[36:39], a[48:51], v[76:79], v[36:39]
  v_mfma_f32_16x16x32_bf16 v[40:43], a[128:131], v[72:75], v[40:43]
  v_mfma_f32_16x16x32_bf16 v[44:47], a[128:131], v[76:79], v[44:47]
  v_mfma_f32_16x16x32_bf16 v[48:51], v[72:75], a[208:211], v[48:51]
  v_mfma_f32_16x16x32_bf16 v[52:55], v[76:79], a[208:211], v[52:55]
  v_mfma_f32_16x16x32_bf16 v[56:59], v[72:75], v[144:147], v[56:59]
  v_mfma_f32_16x16x32_bf16 v[60:63], v[76:79], v[144:147], v[60:63]
  ds_read_b128 v[72:75], v7 offset:15360
  ds_read_b128 v[76:79], v7 offset:35840
  s_waitcnt lgkmcnt(4)
  v_mfma_f32_16x16x32_bf16 v[32:35], a[52:55], v[80:83], v[32:35]
  v_mfma_f32_16x16x32_bf16 v[36:39], a[52:55], v[84:87], v[36:39]
  v_mfma_f32_16x16x32_bf16 v[40:43], a[132:135], v[80:83], v[40:43]
  v_mfma_f32_16x16x32_bf16 v[44:47], a[132:135], v[84:87], v[44:47]
  v_mfma_f32_16x16x32_bf16 v[48:51], v[80:83], a[212:215], v[48:51]
  v_mfma_f32_16x16x32_bf16 v[52:55], v[84:87], a[212:215], v[52:55]
  v_mfma_f32_16x16x32_bf16 v[56:59], v[80:83], v[148:151], v[56:59]
  v_mfma_f32_16x16x32_bf16 v[60:63], v[84:87], v[148:151], v[60:63]
  ds_read_b128 v[80:83], v7 offset:16384
  ds_read_b128 v[84:87], v7 offset:36864
  s_waitcnt lgkmcnt(4)
  v_mfma_f32_16x16x32_bf16 v[32:35], a[56:59], v[88:91], v[32:35]
  v_mfma_f32_16x16x32_bf16 v[36:39], a[56:59], v[92:95], v[36:39]
  v_mfma_f32_16x16x32_bf16 v[40:43], a[136:139], v[88:91], v[40:43]
  v_mfma_f32_16x16x32_bf16 v[44:47], a[136:139], v[92:95], v[44:47]
  v_mfma_f32_16x16x32_bf16 v[48:51], v[88:91], a[216:219], v[48:51]
  v_mfma_f32_16x16x32_bf16 v[52:55], v[92:95], a[216:219], v[52:55]
  v_mfma_f32_16x16x32_bf16 v[56:59], v[88:91], v[152:155], v[56:59]
  v_mfma_f32_16x16x32_bf16 v[60:63], v[92:95], v[152:155], v[60:63]
  ds_read_b128 v[88:91], v7 offset:17408
  ds_read_b128 v[92:95], v7 offset:37888
  s_waitcnt lgkmcnt(4)
  v_mfma_f32_16x16x32_bf16 v[32:35], a[60:63], v[72:75], v[32:35]
  v_mfma_f32_16x16x32_bf16 v[36:39], a[60:63], v[76:79], v[36:39]
  v_mfma_f32_16x16x32_bf16 v[40:43], a[140:143], v[72:75], v[40:43]
  v_mfma_f32_16x16x32_bf16 v[44:47], a[140:143], v[76:79], v[44:47]
  v_mfma_f32_16x16x32_bf16 v[48:51], v[72:75], a[220:223], v[48:51]
  v_mfma_f32_16x16x32_bf16 v[52:55], v[76:79], a[220:223], v[52:55]
  v_mfma_f32_16x16x32_bf16 v[56:59], v[72:75], v[156:159], v[56:59]
  v_mfma_f32_16x16x32_bf16 v[60:63], v[76:79], v[156:159], v[60:63]
  ds_read_b128 v[72:75], v7 offset:18432
  ds_read_b128 v[76:79], v7 offset:38912
  s_waitcnt lgkmcnt(4)
  v_mfma_f32_16x16x32_bf16 v[32:35], a[64:67], v[80:83], v[32:35]
  v_mfma_f32_16x16x32_bf16 v[36:39], a[64:67], v[84:87], v[36:39]
  v_mfma_f32_16x16x32_bf16 v[40:43], a[144:147], v[80:83], v[40:43]
  v_mfma_f32_16x16x32_bf16 v[44:47], a[144:147], v[84:87], v[44:47]
  v_mfma_f32_16x16x32_bf16 v[48:51], v[80:83], a[224:227], v[48:51]
  v_mfma_f32_16x16x32_bf16 v[52:55], v[84:87], a[224:227], v[52:55]
  v_mfma_f32_16x16x32_bf16 v[56:59], v[80:83], v[160:163], v[56:59]
  v_mfma_f32_16x16x32_bf16 v[60:63], v[84:87], v[160:163], v[60:63]
  ds_read_b128 v[80:83], v7 offset:19456
  ds_read_b128 v[84:87], v7 offset:39936
  s_waitcnt lgkmcnt(4)
  v_mfma_f32_16x16x32_bf16 v[32:35], a[68:71], v[88:91], v[32:35]
  v_mfma_f32_16x16x32_bf16 v[36:39], a[68:71], v[92:95], v[36:39]
  v_mfma_f32_16x16x32_bf16 v[40:43], a[148:151], v[88:91], v[40:43]
  v_mfma_f32_16x16x32_bf16 v[44:47], a[148:151], v[92:95], v[44:47]
  v_mfma_f32_16x16x32_bf16 v[48:51], v[88:91], a[228:231], v[48:51]
  v_mfma_f32_16x16x32_bf16 v[52:55], v[92:95], a[228:231], v[52:55]
  v_mfma_f32_16x16x32_bf16 v[56:59], v[88:91], v[164:167], v[56:59]
  v_mfma_f32_16x16x32_bf16 v[60:63], v[92:95], v[164:167], v[60:63]
  s_waitcnt lgkmcnt(2)
  v_mfma_f32_16x16x32_bf16 v[32:35], a[72:75], v[72:75], v[32:35]
  v_mfma_f32_16x16x32_bf16 v[36:39], a[72:75], v[76:79], v[36:39]
  v_mfma_f32_16x16x32_bf16 v[40:43], a[152:155], v[72:75], v[40:43]
  v_mfma_f32_16x16x32_bf16 v[44:47], a[152:155], v[76:79], v[44:47]
  v_mfma_f32_16x16x32_bf16 v[48:51], v[72:75], a[232:235], v[48:51]
  v_mfma_f32_16x16x32_bf16 v[52:55], v[76:79], a[232:235], v[52:55]
  v_mfma_f32_16x16x32_bf16 v[56:59], v[72:75], v[168:171], v[56:59]
  v_mfma_f32_16x16x32_bf16 v[60:63], v[76:79], v[168:171], v[60:63]
  s_waitcnt lgkmcnt(0)
  v_mfma_f32_16x16x32_bf16 v[32:35], a[76:79], v[80:83], v[32:35]
  v_mfma_f32_16x16x32_bf16 v[36:39], a[76:79], v[84:87], v[36:39]
  v_mfma_f32_16x16x32_bf16 v[40:43], a[156:159], v[80:83], v[40:43]
  v_mfma_f32_16x16x32_bf16 v[44:47], a[156:159], v[84:87], v[44:47]
  v_mfma_f32_16x16x32_bf16 v[48:51], v[80:83], a[236:239], v[48:51]
  v_mfma_f32_16x16x32_bf16 v[52:55], v[84:87], a[236:239], v[52:55]
  v_mfma_f32_16x16x32_bf16 v[56:59], v[80:83], v[172:175], v[56:59]
  v_mfma_f32_16x16x32_bf16 v[60:63], v[84:87], v[172:175], v[60:63]
  s_nop 0
  v_cvt_pk_bf16_f32 v8, v32, v33
  v_cvt_pk_bf16_f32 v9, v34, v35
  v_cvt_pk_bf16_f32 v10, v40, v41
  v_cvt_pk_bf16_f32 v11, v42, v43
  s_add_u32 s34, s22, 0
  buffer_store_dwordx4 v[8:11], v1, s[4:7], s34 offen
  v_cvt_pk_bf16_f32 v12, v36, v37
  v_cvt_pk_bf16_f32 v13, v38, v39
  v_cvt_pk_bf16_f32 v14, v44, v45
  v_cvt_pk_bf16_f32 v15, v46, v47
  s_add_u32 s34, s22, 6144
  buffer_store_dwordx4 v[12:15], v1, s[4:7], s34 offen
  v_cvt_pk_bf16_f32 v8, v48, v49
  v_cvt_pk_bf16_f32 v9, v50, v51
  v_cvt_pk_bf16_f32 v10, v52, v53
  v_cvt_pk_bf16_f32 v11, v54, v55
  s_add_u32 s34, s23, 4096
  buffer_store_dwordx4 v[8:11], v1, s[4:7], s34 offen
  v_cvt_pk_bf16_f32 v12, v56, v57
  v_cvt_pk_bf16_f32 v13, v58, v59
  v_cvt_pk_bf16_f32 v14, v60, v61
  v_cvt_pk_bf16_f32 v15, v62, v63
  s_add_u32 s34, s23, 5120
  buffer_store_dwordx4 v[12:15], v1, s[4:7], s34 offen
  s_waitcnt vmcnt(0)
  s_barrier
  s_add_u32 s17, s17, 1
  s_cmp_lt_u32 s17, 64
  s_cbranch_scc1 reca_ptop259
  s_branch reca_exit1
reca_pslow258:
reca_ptop264:
  s_cmp_lt_u32 s17, 3
  s_cbranch_scc1 reca_pgo265
  s_sub_u32 s36, s17, 3
reca_ppoll266:
  buffer_load_dword v28, v4, s[4:7], s25 offen sc1
  s_waitcnt vmcnt(0)
  v_readfirstlane_b32 s34, v28
  s_nop 3
  s_cmp_ge_i32 s34, s36
  s_cbranch_scc1 reca_pgo265
  s_sleep 8
  s_sub_u32 s18, s18, 1
  s_cbranch_scc0 reca_ppoll266
  s_mov_b32 s18, 0
reca_pgo265:
  s_waitcnt vmcnt(0)
  s_barrier
  v_add_u32 v7, s26, v1
  s_xor_b32 s26, s26, 40960
  s_add_u32 s37, s17, 1
  s_cmp_ge_u32 s37, 64
  s_cbranch_scc1 reca_pnodma267
  s_mul_i32 s20, s37, 40960
  s_add_u32 s20, s20, 84955136
  s_add_u32 m0, s26, 20480
  s_nop 0
  buffer_load_dwordx4 v1, s[4:7], s20 offen offset:0 lds
  buffer_load_dwordx4 v1, s[4:7], s20 offen offset:1024 lds
  buffer_load_dwordx4 v1, s[4:7], s20 offen offset:2048 lds
  buffer_load_dwordx4 v1, s[4:7], s20 offen offset:3072 lds
  s_add_u32 s20, s20, 4096
  s_add_u32 m0, s26, 24576
  s_nop 0
  buffer_load_dwordx4 v1, s[4:7], s20 offen offset:0 lds
  buffer_load_dwordx4 v1, s[4:7], s20 offen offset:1024 lds
  buffer_load_dwordx4 v1, s[4:7], s20 offen offset:2048 lds
  buffer_load_dwordx4 v1, s[4:7], s20 offen offset:3072 lds
  s_add_u32 s20, s20, 4096
  s_add_u32 m0, s26, 28672
  s_nop 0
  buffer_load_dwordx4 v1, s[4:7], s20 offen offset:0 lds
  buffer_load_dwordx4 v1, s[4:7], s20 offen offset:1024 lds
reca_pnodma267:
  s_lshl_b32 s34, s15, 3
  s_and_b32 s35, s17, 7
  s_add_u32 s34, s34, s35
  s_mul_i32 s34, s34, 12288
  s_mul_i32 s35, s16, 3072
  s_add_u32 s35, s35, s34
  s_add_u32 s21, s35, 37748736
  s_add_u32 s22, s35, 44040192
  s_mul_i32 s35, s16, 6144
  s_add_u32 s35, s35, s34
  s_add_u32 s23, s35, 40894464
  ds_read_b128 v[72:75], v7 offset:0
  ds_read_b128 v[76:79], v7 offset:20480
  ds_read_b128 v[80:83], v7 offset:1024
  ds_read_b128 v[84:87], v7 offset:21504
  ds_read_b128 v[88:91], v7 offset:2048
  ds_read_b128 v[92:95], v7 offset:22528
  s_waitcnt lgkmcnt(4)
  v_mfma_f32_16x16x32_bf16 v[32:35], a[0:3], v[72:75], 0
  v_mfma_f32_16x16x32_bf16 v[36:39], a[0:3], v[76:79], 0
  v_mfma_f32_16x16x32_bf16 v[40:43], a[80:83], v[72:75], 0
  v_mfma_f32_16x16x32_bf16 v[44:47], a[80:83], v[76:79], 0
  v_mfma_f32_16x16x32_bf16 v[48:51], v[72:75], a[160:163], 0
  v_mfma_f32_16x16x32_bf16 v[52:55], v[76:79], a[160:163], 0
  v_mfma_f32_16x16x32_bf16 v[56:59], v[72:75], v[96:99], 0
  v_mfma_f32_16x16x32_bf16 v[60:63], v[76:79], v[96:99], 0
  ds_read_b128 v[72:75], v7 offset:3072
  ds_read_b128 v[76:79], v7 offset:23552
  s_waitcnt lgkmcnt(4)
  v_mfma_f32_16x16x32_bf16 v[32:35], a[4:7], v[80:83], v[32:35]
  v_mfma_f32_16x16x32_bf16 v[36:39], a[4:7], v[84:87], v[36:39]
  v_mfma_f32_16x16x32_bf16 v[40:43], a[84:87], v[80:83], v[40:43]
  v_mfma_f32_16x16x32_bf16 v[44:47], a[84:87], v[84:87], v[44:47]
  v_mfma_f32_16x16x32_bf16 v[48:51], v[80:83], a[164:167], v[48:51]
  v_mfma_f32_16x16x32_bf16 v[52:55], v[84:87], a[164:167], v[52:55]
  v_mfma_f32_16x16x32_bf16 v[56:59], v[80:83], v[100:103], v[56:59]
  v_mfma_f32_16x16x32_bf16 v[60:63], v[84:87], v[100:103], v[60:63]
  ds_read_b128 v[80:83], v7 offset:4096
  ds_read_b128 v[84:87], v7 offset:24576
  s_waitcnt lgkmcnt(4)
  v_mfma_f32_16x16x32_bf16 v[32:35], a[8:11], v[88:91], v[32:35]
  v_mfma_f32_16x16x32_bf16 v[36:39], a[8:11], v[92:95], v[36:39]
  v_mfma_f32_16x16x32_bf16 v[40:43], a[88:91], v[88:91], v[40:43]
  v_mfma_f32_16x16x32_bf16 v[44:47], a[88:91], v[92:95], v[44:47]
  v_mfma_f32_16x16x32_bf16 v[48:51], v[88:91], a[168:171], v[48:51]
  v_mfma_f32_16x16x32_bf16 v[52:55], v[92:95], a[168:171], v[52:55]
  v_mfma_f32_16x16x32_bf16 v[56:59], v[88:91], v[104:107], v[56:59]
  v_mfma_f32_16x16x32_bf16 v[60:63], v[92:95], v[104:107], v[60:63]
  ds_read_b128 v[88:91], v7 offset:5120
  ds_read_b128 v[92:95], v7 offset:25600
  s_waitcnt lgkmcnt(4)
  v_mfma_f32_16x16x32_bf16 v[32:35], a[12:15], v[72:75], v[32:35]
  v_mfma_f32_16x16x32_bf16 v[36:39], a[12:15], v[76:79], v[36:39]
  v_mfma_f32_16x16x32_bf16 v[40:43], a[92:95], v[72:75], v[40:43]
  v_mfma_f32_16x16x32_bf16 v[44:47], a[92:95], v[76:79], v[44:47]
  v_mfma_f32_16x16x32_bf16 v[48:51], v[72:75], a[172:175], v[48:51]
  v_mfma_f32_16x16x32_bf16 v[52:55], v[76:79], a[172:175], v[52:55]
  v_mfma_f32_16x16x32_bf16 v[56:59], v[72:75], v[108:111], v[56:59]
  v_mfma_f32_16x16x32_bf16 v[60:63], v[76:79], v[108:111], v[60:63]
  ds_read_b128 v[72:75], v7 offset:6144
  ds_read_b128 v[76:79], v7 offset:26624
  s_waitcnt lgkmcnt(4)
  v_mfma_f32_16x16x32_bf16 v[32:35], a[16:19], v[80:83], v[32:35]
  v_mfma_f32_16x16x32_bf16 v[36:39], a[16:19], v[84:87], v[36:39]
  v_mfma_f32_16x16x32_bf16 v[40:43], a[96:99], v[80:83], v[40:43]
  v_mfma_f32_16x16x32_bf16 v[44:47], a[96:99], v[84:87], v[44:47]
  v_mfma_f32_16x16x32_bf16 v[48:51], v[80:83], a[176:179], v[48:51]
  v_mfma_f32_16x16x32_bf16 v[52:55], v[84:87], a[176:179], v[52:55]
  v_mfma_f32_16x16x32_bf16 v[56:59], v[80:83], v[112:115], v[56:59]
  v_mfma_f32_16x16x32_bf16 v[60:63], v[84:87], v[112:115], v[60:63]
  ds_read_b128 v[80:83], v7 offset:7168
  ds_read_b128 v[84:87], v7 offset:27648
  s_waitcnt lgkmcnt(4)
  v_mfma_f32_16x16x32_bf16 v[32:35], a[20:23], v[88:91], v[32:35]
  v_mfma_f32_16x16x32_bf16 v[36:39], a[20:23], v[92:95], v[36:39]
  v_mfma_f32_16x16x32_bf16 v[40:43], a[100:103], v[88:91], v[40:43]
  v_mfma_f32_16x16x32_bf16 v[44:47], a[100:103], v[92:95], v[44:47]
  v_mfma_f32_16x16x32_bf16 v[48:51], v[88:91], a[180:183], v[48:51]
  v_mfma_f32_16x16x32_bf16 v[52:55], v[92:95], a[180:183], v[52:55]
  v_mfma_f32_16x16x32_bf16 v[56:59], v[88:91], v[116:119], v[56:59]
  v_mfma_f32_16x16x32_bf16 v[60:63], v[92:95], v[116:119], v[60:63]
  ds_read_b128 v[88:91], v7 offset:8192
  ds_read_b128 v[92:95], v7 offset:28672
  s_waitcnt lgkmcnt(4)
  v_mfma_f32_16x16x32_bf16 v[32:35], a[24:27], v[72:75], v[32:35]
  v_mfma_f32_16x16x32_bf16 v[36:39], a[24:27], v[76:79], v[36:39]
  v_mfma_f32_16x16x32_bf16 v[40:43], a[104:107], v[72:75], v[40:43]
  v_mfma_f32_16x16x32_bf16 v[44:47], a[104:107], v[76:79], v[44:47]
  v_mfma_f32_16x16x32_bf16 v[48:51], v[72:75], a[184:187], v[48:51]
  v_mfma_f32_16x16x32_bf16 v[52:55], v[76:79], a[184:187], v[52:55]
  v_mfma_f32_16x16x32_bf16 v[56:59], v[72:75], v[120:123], v[56:59]
  v_mfma_f32_16x16x32_bf16 v[60:63], v[76:79], v[120:123], v[60:63]
  ds_read_b128 v[72:75], v7 offset:9216
  ds_read_b128 v[76:79], v7 offset:29696
  s_waitcnt lgkmcnt(4)
  v_mfma_f32_16x16x32_bf16 v[32:35], a[28:31], v[80:83], v[32:35]
  v_mfma_f32_16x16x32_bf16 v[36:39], a[28:31], v[84:87], v[36:39]
  v_mfma_f32_16x16x32_bf16 v[40:43], a[108:111], v[80:83], v[40:43]
  v_mfma_f32_16x16x32_bf16 v[44:47], a[108:111], v[84:87], v[44:47]
  v_mfma_f32_16x16x32_bf16 v[48:51], v[80:83], a[188:191], v[48:51]
  v_mfma_f32_16x16x32_bf16 v[52:55], v[84:87], a[188:191], v[52:55]
  v_mfma_f32_16x16x32_bf16 v[56:59], v[80:83], v[124:127], v[56:59]
  v_mfma_f32_16x16x32_bf16 v[60:63], v[84:87], v[124:127], v[60:63]
  ds_read_b128 v[80:83], v7 offset:10240
  ds_read_b128 v[84:87], v7 offset:30720
  s_waitcnt lgkmcnt(4)
  v_mfma_f32_16x16x32_bf16 v[32:35], a[32:35], v[88:91], v[32:35]
  v_mfma_f32_16x16x32_bf16 v[36:39], a[32:35], v[92:95], v[36:39]
  v_mfma_f32_16x16x32_bf16 v[40:43], a[112:115], v[88:91], v[40:43]
  v_mfma_f32_16x16x32_bf16 v[44:47], a[112:115], v[92:95], v[44:47]
  v_mfma_f32_16x16x32_bf16 v[48:51], v[88:91], a[192:195], v[48:51]
  v_mfma_f32_16x16x32_bf16 v[52:55], v[92:95], a[192:195], v[52:55]
  v_mfma_f32_16x16x32_bf16 v[56:59], v[88:91], v[128:131], v[56:59]
  v_mfma_f32_16x16x32_bf16 v[60:63], v[92:95], v[128:131], v[60:63]
  ds_read_b128 v[88:91], v7 offset:11264
  ds_read_b128 v[92:95], v7 offset:31744
  s_waitcnt lgkmcnt(4)
  v_mfma_f32_16x16x32_bf16 v[32:35], a[36:39], v[72:75], v[32:35]
  v_mfma_f32_16x16x32_bf16 v[36:39], a[36:39], v[76:79], v[36:39]
  v_mfma_f32_16x16x32_bf16 v[40:43], a[116:119], v[72:75], v[40:43]
  v_mfma_f32_16x16x32_bf16 v[44:47], a[116:119], v[76:79], v[44:47]
  v_mfma_f32_16x16x32_bf16 v[48:51], v[72:75], a[196:199], v[48:51]
  v_mfma_f32_16x16x32_bf16 v[52:55], v[76:79], a[196:199], v[52:55]
  v_mfma_f32_16x16x32_bf16 v[56:59], v[72:75], v[132:135], v[56:59]
  v_mfma_f32_16x16x32_bf16 v[60:63], v[76:79], v[132:135], v[60:63]
  ds_read_b128 v[72:75], v7 offset:12288
  ds_read_b128 v[76:79], v7 offset:32768
  s_waitcnt lgkmcnt(4)
  v_mfma_f32_16x16x32_bf16 v[32:35], a[40:43], v[80:83], v[32:35]
  v_mfma_f32_16x16x32_bf16 v[36:39], a[40:43], v[84:87], v[36:39]
  v_mfma_f32_16x16x32_bf16 v[40:43], a[120:123], v[80:83], v[40:43]
  v_mfma_f32_16x16x32_bf16 v[44:47], a[120:123], v[84:87], v[44:47]
  v_mfma_f32_16x16x32_bf16 v[48:51], v[80:83], a[200:203], v[48:51]
  v_mfma_f32_16x16x32_bf16 v[52:55], v[84:87], a[200:203], v[52:55]
  v_mfma_f32_16x16x32_bf16 v[56:59], v[80:83], v[136:139], v[56:59]
  v_mfma_f32_16x16x32_bf16 v[60:63], v[84:87], v[136:139], v[60:63]
  ds_read_b128 v[80:83], v7 offset:13312
  ds_read_b128 v[84:87], v7 offset:33792
  s_waitcnt lgkmcnt(4)
  v_mfma_f32_16x16x32_bf16 v[32:35], a[44:47], v[88:91], v[32:35]
  v_mfma_f32_16x16x32_bf16 v[36:39], a[44:47], v[92:95], v[36:39]
  v_mfma_f32_16x16x32_bf16 v[40:43], a[124:127], v[88:91], v[40:43]
  v_mfma_f32_16x16x32_bf16 v[44:47], a[124:127], v[92:95], v[44:47]
  v_mfma_f32_16x16x32_bf16 v[48:51], v[88:91], a[204:207], v[48:51]
  v_mfma_f32_16x16x32_bf16 v[52:55], v[92:95], a[204:207], v[52:55]
  v_mfma_f32_16x16x32_bf16 v[56:59], v[88:91], v[140:143], v[56:59]
  v_mfma_f32_16x16x32_bf16 v[60:63], v[92:95], v[140:143], v[60:63]
  ds_read_b128 v[88:91], v7 offset:14336
  ds_read_b128 v[92:95], v7 offset:34816
  s_waitcnt lgkmcnt(4)
  v_mfma_f32_16x16x32_bf16 v[32:35], a[48:51], v[72:75], v[32:35]
  v_mfma_f32_16x16x32_bf16 v[36:39], a[48:51], v[76:79], v[36:39]
  v_mfma_f32_16x16x32_bf16 v[40:43], a[128:131], v[72:75], v[40:43]
  v_mfma_f32_16x16x32_bf16 v[44:47], a[128:131], v[76:79], v[44:47]
  v_mfma_f32_16x16x32_bf16 v[48:51], v[72:75], a[208:211], v[48:51]
  v_mfma_f32_16x16x32_bf16 v[52:55], v[76:79], a[208:211], v[52:55]
  v_mfma_f32_16x16x32_bf16 v[56:59], v[72:75], v[144:147], v[56:59]
  v_mfma_f32_16x16x32_bf16 v[60:63], v[76:79], v[144:147], v[60:63]
  ds_read_b128 v[72:75], v7 offset:15360
  ds_read_b128 v[76:79], v7 offset:35840
  s_waitcnt lgkmcnt(4)
  v_mfma_f32_16x16x32_bf16 v[32:35], a[52:55], v[80:83], v[32:35]
  v_mfma_f32_16x16x32_bf16 v[36:39], a[52:55], v[84:87], v[36:39]
  v_mfma_f32_16x16x32_bf16 v[40:43], a[132:135], v[80:83], v[40:43]
  v_mfma_f32_16x16x32_bf16 v[44:47], a[132:135], v[84:87], v[44:47]
  v_mfma_f32_16x16x32_bf16 v[48:51], v[80:83], a[212:215], v[48:51]
  v_mfma_f32_16x16x32_bf16 v[52:55], v[84:87], a[212:215], v[52:55]
  v_mfma_f32_16x16x32_bf16 v[56:59], v[80:83], v[148:151], v[56:59]
  v_mfma_f32_16x16x32_bf16 v[60:63], v[84:87], v[148:151], v[60:63]
  ds_read_b128 v[80:83], v7 offset:16384
  ds_read_b128 v[84:87], v7 offset:36864
  s_waitcnt lgkmcnt(4)
  v_mfma_f32_16x16x32_bf16 v[32:35], a[56:59], v[88:91], v[32:35]
  v_mfma_f32_16x16x32_bf16 v[36:39], a[56:59], v[92:95], v[36:39]
  v_mfma_f32_16x16x32_bf16 v[40:43], a[136:139], v[88:91], v[40:43]
  v_mfma_f32_16x16x32_bf16 v[44:47], a[136:139], v[92:95], v[44:47]
  v_mfma_f32_16x16x32_bf16 v[48:51], v[88:91], a[216:219], v[48:51]
  v_mfma_f32_16x16x32_bf16 v[52:55], v[92:95], a[216:219], v[52:55]
  v_mfma_f32_16x16x32_bf16 v[56:59], v[88:91], v[152:155], v[56:59]
  v_mfma_f32_16x16x32_bf16 v[60:63], v[92:95], v[152:155], v[60:63]
  ds_read_b128 v[88:91], v7 offset:17408
  ds_read_b128 v[92:95], v7 offset:37888
  s_waitcnt lgkmcnt(4)
  v_mfma_f32_16x16x32_bf16 v[32:35], a[60:63], v[72:75], v[32:35]
  v_mfma_f32_16x16x32_bf16 v[36:39], a[60:63], v[76:79], v[36:39]
  v_mfma_f32_16x16x32_bf16 v[40:43], a[140:143], v[72:75], v[40:43]
  v_mfma_f32_16x16x32_bf16 v[44:47], a[140:143], v[76:79], v[44:47]
  v_mfma_f32_16x16x32_bf16 v[48:51], v[72:75], a[220:223], v[48:51]
  v_mfma_f32_16x16x32_bf16 v[52:55], v[76:79], a[220:223], v[52:55]
  v_mfma_f32_16x16x32_bf16 v[56:59], v[72:75], v[156:159], v[56:59]
  v_mfma_f32_16x16x32_bf16 v[60:63], v[76:79], v[156:159], v[60:63]
  ds_read_b128 v[72:75], v7 offset:18432
  ds_read_b128 v[76:79], v7 offset:38912
  s_waitcnt lgkmcnt(4)
  v_mfma_f32_16x16x32_bf16 v[32:35], a[64:67], v[80:83], v[32:35]
  v_mfma_f32_16x16x32_bf16 v[36:39], a[64:67], v[84:87], v[36:39]
  v_mfma_f32_16x16x32_bf16 v[40:43], a[144:147], v[80:83], v[40:43]
  v_mfma_f32_16x16x32_bf16 v[44:47], a[144:147], v[84:87], v[44:47]
  v_mfma_f32_16x16x32_bf16 v[48:51], v[80:83], a[224:227], v[48:51]
  v_mfma_f32_16x16x32_bf16 v[52:55], v[84:87], a[224:227], v[52:55]
  v_mfma_f32_16x16x32_bf16 v[56:59], v[80:83], v[160:163], v[56:59]
  v_mfma_f32_16x16x32_bf16 v[60:63], v[84:87], v[160:163], v[60:63]
  ds_read_b128 v[80:83], v7 offset:19456
  ds_read_b128 v[84:87], v7 offset:39936
  s_waitcnt lgkmcnt(4)
  v_mfma_f32_16x16x32_bf16 v[32:35], a[68:71], v[88:91], v[32:35]
  v_mfma_f32_16x16x32_bf16 v[36:39], a[68:71], v[92:95], v[36:39]
  v_mfma_f32_16x16x32_bf16 v[40:43], a[148:151], v[88:91], v[40:43]
  v_mfma_f32_16x16x32_bf16 v[44:47], a[148:151], v[92:95], v[44:47]
  v_mfma_f32_16x16x32_bf16 v[48:51], v[88:91], a[228:231], v[48:51]
  v_mfma_f32_16x16x32_bf16 v[52:55], v[92:95], a[228:231], v[52:55]
  v_mfma_f32_16x16x32_bf16 v[56:59], v[88:91], v[164:167], v[56:59]
  v_mfma_f32_16x16x32_bf16 v[60:63], v[92:95], v[164:167], v[60:63]
  s_waitcnt lgkmcnt(2)
  v_mfma_f32_16x16x32_bf16 v[32:35], a[72:75], v[72:75], v[32:35]
  v_mfma_f32_16x16x32_bf16 v[36:39], a[72:75], v[76:79], v[36:39]
  v_mfma_f32_16x16x32_bf16 v[40:43], a[152:155], v[72:75], v[40:43]
  v_mfma_f32_16x16x32_bf16 v[44:47], a[152:155], v[76:79], v[44:47]
  v_mfma_f32_16x16x32_bf16 v[48:51], v[72:75], a[232:235], v[48:51]
  v_mfma_f32_16x16x32_bf16 v[52:55], v[76:79], a[232:235], v[52:55]
  v_mfma_f32_16x16x32_bf16 v[56:59], v[72:75], v[168:171], v[56:59]
  v_mfma_f32_16x16x32_bf16 v[60:63], v[76:79], v[168:171], v[60:63]
  s_waitcnt lgkmcnt(0)
  v_mfma_f32_16x16x32_bf16 v[32:35], a[76:79], v[80:83], v[32:35]
  v_mfma_f32_16x16x32_bf16 v[36:39], a[76:79], v[84:87], v[36:39]
  v_mfma_f32_16x16x32_bf16 v[40:43], a[156:159], v[80:83], v[40:43]
  v_mfma_f32_16x16x32_bf16 v[44:47], a[156:159], v[84:87], v[44:47]
  v_mfma_f32_16x16x32_bf16 v[48:51], v[80:83], a[236:239], v[48:51]
  v_mfma_f32_16x16x32_bf16 v[52:55], v[84:87], a[236:239], v[52:55]
  v_mfma_f32_16x16x32_bf16 v[56:59], v[80:83], v[172:175], v[56:59]
  v_mfma_f32_16x16x32_bf16 v[60:63], v[84:87], v[172:175], v[60:63]
  s_nop 0
  v_cvt_pk_bf16_f32 v8, v32, v33
  v_cvt_pk_bf16_f32 v9, v34, v35
  v_cvt_pk_bf16_f32 v10, v40, v41
  v_cvt_pk_bf16_f32 v11, v42, v43
  s_add_u32 s34, s22, 0
  buffer_store_dwordx4 v[8:11], v1, s[4:7], s34 offen sc1
  v_cvt_pk_bf16_f32 v12, v36, v37
  v_cvt_pk_bf16_f32 v13, v38, v39
  v_cvt_pk_bf16_f32 v14, v44, v45
  v_cvt_pk_bf16_f32 v15, v46, v47
  s_add_u32 s34, s22, 6144
  buffer_store_dwordx4 v[12:15], v1, s[4:7], s34 offen sc1
  v_cvt_pk_bf16_f32 v8, v48, v49
  v_cvt_pk_bf16_f32 v9, v50, v51
  v_cvt_pk_bf16_f32 v10, v52, v53
  v_cvt_pk_bf16_f32 v11, v54, v55
  s_add_u32 s34, s23, 4096
  buffer_store_dwordx4 v[8:11], v1, s[4:7], s34 offen sc1
  v_cvt_pk_bf16_f32 v12, v56, v57
  v_cvt_pk_bf16_f32 v13, v58, v59
  v_cvt_pk_bf16_f32 v14, v60, v61
  v_cvt_pk_bf16_f32 v15, v62, v63
  s_add_u32 s34, s23, 5120
  buffer_store_dwordx4 v[12:15], v1, s[4:7], s34 offen sc1
  s_waitcnt vmcnt(0)
  s_barrier
  s_add_u32 s17, s17, 1
  s_cmp_lt_u32 s17, 64
  s_cbranch_scc1 reca_ptop264
  s_branch reca_exit1
reca_pw3_229:
  s_mov_b32 s17, 0
  s_mov_b32 s26, 0
  s_mul_i32 s20, s17, 40960
  s_add_u32 s20, s20, 84965376
  s_add_u32 m0, s26, 30720
  s_nop 0
  buffer_load_dwordx4 v1, s[4:7], s20 offen offset:0 lds
  buffer_load_dwordx4 v1, s[4:7], s20 offen offset:1024 lds
  buffer_load_dwordx4 v1, s[4:7], s20 offen offset:2048 lds
  buffer_load_dwordx4 v1, s[4:7], s20 offen offset:3072 lds
  s_add_u32 s20, s20, 4096
  s_add_u32 m0, s26, 34816
  s_nop 0
  buffer_load_dwordx4 v1, s[4:7], s20 offen offset:0 lds
  buffer_load_dwordx4 v1, s[4:7], s20 offen offset:1024 lds
  buffer_load_dwordx4 v1, s[4:7], s20 offen offset:2048 lds
  buffer_load_dwordx4 v1, s[4:7], s20 offen offset:3072 lds
  s_add_u32 s20, s20, 4096
  s_add_u32 m0, s26, 38912
  s_nop 0
  buffer_load_dwordx4 v1, s[4:7], s20 offen offset:0 lds
  buffer_load_dwordx4 v1, s[4:7], s20 offen offset:1024 lds
  s_mul_i32 s34, s15, 12
  s_mul_i32 s35, s16, 6
  s_add_u32 s34, s34, s35
  s_add_u32 s34, s34, 2
  s_mul_i32 s34, s34, 20480
  s_add_u32 s34, s34, 6291456
  buffer_load_dwordx4 a[0:3], v1, s[4:7], s34 offen offset:0
  buffer_load_dwordx4 a[4:7], v1, s[4:7], s34 offen offset:1024
  buffer_load_dwordx4 a[8:11], v1, s[4:7], s34 offen offset:2048
  buffer_load_dwordx4 a[12:15], v1, s[4:7], s34 offen offset:3072
  s_add_u32 s34, s34, 4096
  buffer_load_dwordx4 a[16:19], v1, s[4:7], s34 offen offset:0
  buffer_load_dwordx4 a[20:23], v1, s[4:7], s34 offen offset:1024
  buffer_load_dwordx4 a[24:27], v1, s[4:7], s34 offen offset:2048
  buffer_load_dwordx4 a[28:31], v1, s[4:7], s34 offen offset:3072
  s_add_u32 s34, s34, 4096
  buffer_load_dwordx4 a[32:35], v1, s[4:7], s34 offen offset:0
  buffer_load_dwordx4 a[36:39], v1, s[4:7], s34 offen offset:1024
  buffer_load_dwordx4 a[40:43], v1, s[4:7], s34 offen offset:2048
  buffer_load_dwordx4 a[44:47], v1, s[4:7], s34 offen offset:3072
  s_add_u32 s34, s34, 4096
  buffer_load_dwordx4 a[48:51], v1, s[4:7], s34 offen offset:0
  buffer_load_dwordx4 a[52:55], v1, s[4:7], s34 offen offset:1024
  buffer_load_dwordx4 a[56:59], v1, s[4:7], s34 offen offset:2048
  buffer_load_dwordx4 a[60:63], v1, s[4:7], s34 offen offset:3072
  s_add_u32 s34, s34, 4096
  buffer_load_dwordx4 a[64:67], v1, s[4:7], s34 offen offset:0
  buffer_load_dwordx4 a[68:71], v1, s[4:7], s34 offen offset:1024
  buffer_load_dwordx4 a[72:75], v1, s[4:7], s34 offen offset:2048
  buffer_load_dwordx4 a[76:79], v1, s[4:7], s34 offen offset:3072
  s_mul_i32 s34, s15, 12
  s_mul_i32 s35, s16, 6
  s_add_u32 s34, s34, s35
  s_add_u32 s34, s34, 3
  s_mul_i32 s34, s34, 20480
  s_add_u32 s34, s34, 6291456
  buffer_load_dwordx4 a[80:83], v1, s[4:7], s34 offen offset:0
  buffer_load_dwordx4 a[84:87], v1, s[4:7], s34 offen offset:1024
  buffer_load_dwordx4 a[88:91], v1, s[4:7], s34 offen offset:2048
  buffer_load_dwordx4 a[92:95], v1, s[4:7], s34 offen offset:3072
  s_add_u32 s34, s34, 4096
  buffer_load_dwordx4 a[96:99], v1, s[4:7], s34 offen offset:0
  buffer_load_dwordx4 a[100:103], v1, s[4:7], s34 offen offset:1024
  buffer_load_dwordx4 a[104:107], v1, s[4:7], s34 offen offset:2048
  buffer_load_dwordx4 a[108:111], v1, s[4:7], s34 offen offset:3072
  s_add_u32 s34, s34, 4096
  buffer_load_dwordx4 a[112:115], v1, s[4:7], s34 offen offset:0
  buffer_load_dwordx4 a[116:119], v1, s[4:7], s34 offen offset:1024
  buffer_load_dwordx4 a[120:123], v1, s[4:7], s34 offen offset:2048
  buffer_load_dwordx4 a[124:127], v1, s[4:7], s34 offen offset:3072
  s_add_u32 s34, s34, 4096
  buffer_load_dwordx4 a[128:131], v1, s[4:7], s34 offen offset:0
  buffer_load_dwordx4 a[132:135], v1, s[4:7], s34 offen offset:1024
  buffer_load_dwordx4 a[136:139], v1, s[4:7], s34 offen offset:2048
  buffer_load_dwordx4 a[140:143], v1, s[4:7], s34 offen offset:3072
  s_add_u32 s34, s34, 4096
  buffer_load_dwordx4 a[144:147], v1, s[4:7], s34 offen offset:0
  buffer_load_dwordx4 a[148:151], v1, s[4:7], s34 offen offset:1024
  buffer_load_dwordx4 a[152:155], v1, s[4:7], s34 offen offset:2048
  buffer_load_dwordx4 a[156:159], v1, s[4:7], s34 offen offset:3072
  s_waitcnt vmcnt(20)
  s_mul_i32 s34, s15, 12
  s_mul_i32 s35, s16, 6
  s_add_u32 s34, s34, s35
  s_add_u32 s34, s34, 4
  s_mul_i32 s34, s34, 20480
  s_add_u32 s34, s34, 6291456
  buffer_load_dwordx4 a[160:163], v1, s[4:7], s34 offen offset:0
  buffer_load_dwordx4 a[164:167], v1, s[4:7], s34 offen offset:1024
  buffer_load_dwordx4 a[168:171], v1, s[4:7], s34 offen offset:2048
  buffer_load_dwordx4 a[172:175], v1, s[4:7], s34 offen offset:3072
  s_add_u32 s34, s34, 4096
  buffer_load_dwordx4 a[176:179], v1, s[4:7], s34 offen offset:0
  buffer_load_dwordx4 a[180:183], v1, s[4:7], s34 offen offset:1024
  buffer_load_dwordx4 a[184:187], v1, s[4:7], s34 offen offset:2048
  buffer_load_dwordx4 a[188:191], v1, s[4:7], s34 offen offset:3072
  s_add_u32 s34, s34, 4096
  buffer_load_dwordx4 a[192:195], v1, s[4:7], s34 offen offset:0
  buffer_load_dwordx4 a[196:199], v1, s[4:7], s34 offen offset:1024
  buffer_load_dwordx4 a[200:203], v1, s[4:7], s34 offen offset:2048
  buffer_load_dwordx4 a[204:207], v1, s[4:7], s34 offen offset:3072
  s_add_u32 s34, s34, 4096
  buffer_load_dwordx4 a[208:211], v1, s[4:7], s34 offen offset:0
  buffer_load_dwordx4 a[212:215], v1, s[4:7], s34 offen offset:1024
  buffer_load_dwordx4 a[216:219], v1, s[4:7], s34 offen offset:2048
  buffer_load_dwordx4 a[220:223], v1, s[4:7], s34 offen offset:3072
  s_add_u32 s34, s34, 4096
  buffer_load_dwordx4 a[224:227], v1, s[4:7], s34 offen offset:0
  buffer_load_dwordx4 a[228:231], v1, s[4:7], s34 offen offset:1024
  buffer_load_dwordx4 a[232:235], v1, s[4:7], s34 offen offset:2048
  buffer_load_dwordx4 a[236:239], v1, s[4:7], s34 offen offset:3072
  s_waitcnt vmcnt(20)
  s_mul_i32 s34, s15, 12
  s_mul_i32 s35, s16, 6
  s_add_u32 s34, s34, s35
  s_add_u32 s34, s34, 5
  s_mul_i32 s34, s34, 20480
  s_add_u32 s34, s34, 6291456
  buffer_load_dwordx4 v[96:99], v1, s[4:7], s34 offen offset:0
  buffer_load_dwordx4 v[100:103], v1, s[4:7], s34 offen offset:1024
  buffer_load_dwordx4 v[104:107], v1, s[4:7], s34 offen offset:2048
  buffer_load_dwordx4 v[108:111], v1, s[4:7], s34 offen offset:3072
  s_add_u32 s34, s34, 4096
  buffer_load_dwordx4 v[112:115], v1, s[4:7], s34 offen offset:0
  buffer_load_dwordx4 v[116:119], v1, s[4:7], s34 offen offset:1024
  buffer_load_dwordx4 v[120:123], v1, s[4:7], s34 offen offset:2048
  buffer_load_dwordx4 v[124:127], v1, s[4:7], s34 offen offset:3072
  s_add_u32 s34, s34, 4096
  buffer_load_dwordx4 v[128:131], v1, s[4:7], s34 offen offset:0
  buffer_load_dwordx4 v[132:135], v1, s[4:7], s34 offen offset:1024
  buffer_load_dwordx4 v[136:139], v1, s[4:7], s34 offen offset:2048
  buffer_load_dwordx4 v[140:143], v1, s[4:7], s34 offen offset:3072
  s_add_u32 s34, s34, 4096
  buffer_load_dwordx4 v[144:147], v1, s[4:7], s34 offen offset:0
  buffer_load_dwordx4 v[148:151], v1, s[4:7], s34 offen offset:1024
  buffer_load_dwordx4 v[152:155], v1, s[4:7], s34 offen offset:2048
  buffer_load_dwordx4 v[156:159], v1, s[4:7], s34 offen offset:3072
  s_add_u32 s34, s34, 4096
  buffer_load_dwordx4 v[160:163], v1, s[4:7], s34 offen offset:0
  buffer_load_dwordx4 v[164:167], v1, s[4:7], s34 offen offset:1024
  buffer_load_dwordx4 v[168:171], v1, s[4:7], s34 offen offset:2048
  buffer_load_dwordx4 v[172:175], v1, s[4:7], s34 offen offset:3072
  s_waitcnt vmcnt(20)
  v_and_b32 v30, 7, v0
  v_lshlrev_b32 v30, 3, v30
reca_cens269:
  buffer_load_dwordx2 v[28:29], v30, s[8:11], 0 offen sc1
  s_waitcnt vmcnt(0)
  v_sad_u8 v31, v28, 0, 0
  v_sad_u8 v31, v29, 0, v31
  v_cmp_gt_u32 vcc, 32, v31
  s_cbranch_vccz reca_censok270
  s_sleep 8
  s_sub_u32 s18, s18, 1
  s_cbranch_scc0 reca_cens269
  s_mov_b32 s18, 0
reca_censok270:
  v_and_b32 v28, 0x20202020, v28
  v_and_b32 v29, 0x20202020, v29
  v_cmp_ne_u32 s[34:35], 0, v28
  v_cmp_ne_u32 s[36:37], 0, v29
  s_nop 3
  s_and_b32 s34, s34, 0xff
  s_and_b32 s36, s36, 0xff
  s_or_b32 s35, s34, s36
  s_lshr_b32 s37, s35, s13
  s_and_b32 s37, s37, 1
  s_xor_b32 s43, s37, 1
  s_cmp_eq_u32 s57, 0
  s_cselect_b32 s58, s36, s34
  v_mov_b32 v31, 0x80000000
  s_cmp_lg_u32 s43, 0
  s_cbranch_scc1 reca_pslow271
reca_ptop272:
  s_cmp_lt_u32 s17, 3
  s_cbranch_scc1 reca_pgo273
  s_sub_u32 s36, s17, 3
reca_ppoll274:
  buffer_load_dword v28, v4, s[4:7], s25 offen sc1
  s_waitcnt vmcnt(0)
  v_readfirstlane_b32 s34, v28
  s_nop 3
  s_cmp_ge_i32 s34, s36
  s_cbranch_scc1 reca_pgo273
  s_sleep 8
  s_sub_u32 s18, s18, 1
  s_cbranch_scc0 reca_ppoll274
  s_mov_b32 s18, 0
reca_pgo273:
  s_waitcnt vmcnt(0)
  s_barrier
  v_add_u32 v7, s26, v1
  s_xor_b32 s26, s26, 40960
  s_add_u32 s37, s17, 1
  s_cmp_ge_u32 s37, 64
  s_cbranch_scc1 reca_pnodma275
  s_mul_i32 s20, s37, 40960
  s_add_u32 s20, s20, 84965376
  s_add_u32 m0, s26, 30720
  s_nop 0
  buffer_load_dwordx4 v1, s[4:7], s20 offen offset:0 lds
  buffer_load_dwordx4 v1, s[4:7], s20 offen offset:1024 lds
  buffer_load_dwordx4 v1, s[4:7], s20 offen offset:2048 lds
  buffer_load_dwordx4 v1, s[4:7], s20 offen offset:3072 lds
  s_add_u32 s20, s20, 4096
  s_add_u32 m0, s26, 34816
  s_nop 0
  buffer_load_dwordx4 v1, s[4:7], s20 offen offset:0 lds
  buffer_load_dwordx4 v1, s[4:7], s20 offen offset:1024 lds
  buffer_load_dwordx4 v1, s[4:7], s20 offen offset:2048 lds
  buffer_load_dwordx4 v1, s[4:7], s20 offen offset:3072 lds
  s_add_u32 s20, s20, 4096
  s_add_u32 m0, s26, 38912
  s_nop 0
  buffer_load_dwordx4 v1, s[4:7], s20 offen offset:0 lds
  buffer_load_dwordx4 v1, s[4:7], s20 offen offset:1024 lds
reca_pnodma275:
  s_lshl_b32 s34, s15, 3
  s_and_b32 s35, s17, 7
  s_add_u32 s34, s34, s35
  s_mul_i32 s34, s34, 12288
  s_mul_i32 s35, s16, 3072
  s_add_u32 s35, s35, s34
  s_add_u32 s21, s35, 37748736
  s_add_u32 s22, s35, 44040192
  s_mul_i32 s35, s16, 6144
  s_add_u32 s35, s35, s34
  s_add_u32 s23, s35, 40894464
  ds_read_b128 v[72:75], v7 offset:0
  ds_read_b128 v[76:79], v7 offset:20480
  ds_read_b128 v[80:83], v7 offset:1024
  ds_read_b128 v[84:87], v7 offset:21504
  ds_read_b128 v[88:91], v7 offset:2048
  ds_read_b128 v[92:95], v7 offset:22528
  s_waitcnt lgkmcnt(4)
  v_mfma_f32_16x16x32_bf16 v[32:35], a[0:3], v[72:75], 0
  v_mfma_f32_16x16x32_bf16 v[36:39], a[0:3], v[76:79], 0
  v_mfma_f32_16x16x32_bf16 v[40:43], a[80:83], v[72:75], 0
  v_mfma_f32_16x16x32_bf16 v[44:47], a[80:83], v[76:79], 0
  v_mfma_f32_16x16x32_bf16 v[48:51], a[160:163], v[72:75], 0
  v_mfma_f32_16x16x32_bf16 v[52:55], a[160:163], v[76:79], 0
  v_mfma_f32_16x16x32_bf16 v[56:59], v[96:99], v[72:75], 0
  v_mfma_f32_16x16x32_bf16 v[60:63], v[96:99], v[76:79], 0
  ds_read_b128 v[72:75], v7 offset:3072
  ds_read_b128 v[76:79], v7 offset:23552
  s_waitcnt lgkmcnt(4)
  v_mfma_f32_16x16x32_bf16 v[32:35], a[4:7], v[80:83], v[32:35]
  v_mfma_f32_16x16x32_bf16 v[36:39], a[4:7], v[84:87], v[36:39]
  v_mfma_f32_16x16x32_bf16 v[40:43], a[84:87], v[80:83], v[40:43]
  v_mfma_f32_16x16x32_bf16 v[44:47], a[84:87], v[84:87], v[44:47]
  v_mfma_f32_16x16x32_bf16 v[48:51], a[164:167], v[80:83], v[48:51]
  v_mfma_f32_16x16x32_bf16 v[52:55], a[164:167], v[84:87], v[52:55]
  v_mfma_f32_16x16x32_bf16 v[56:59], v[100:103], v[80:83], v[56:59]
  v_mfma_f32_16x16x32_bf16 v[60:63], v[100:103], v[84:87], v[60:63]
  ds_read_b128 v[80:83], v7 offset:4096
  ds_read_b128 v[84:87], v7 offset:24576
  s_waitcnt lgkmcnt(4)
  v_mfma_f32_16x16x32_bf16 v[32:35], a[8:11], v[88:91], v[32:35]
  v_mfma_f32_16x16x32_bf16 v[36:39], a[8:11], v[92:95], v[36:39]
  v_mfma_f32_16x16x32_bf16 v[40:43], a[88:91], v[88:91], v[40:43]
  v_mfma_f32_16x16x32_bf16 v[44:47], a[88:91], v[92:95], v[44:47]
  v_mfma_f32_16x16x32_bf16 v[48:51], a[168:171], v[88:91], v[48:51]
  v_mfma_f32_16x16x32_bf16 v[52:55], a[168:171], v[92:95], v[52:55]
  v_mfma_f32_16x16x32_bf16 v[56:59], v[104:107], v[88:91], v[56:59]
  v_mfma_f32_16x16x32_bf16 v[60:63], v[104:107], v[92:95], v[60:63]
  ds_read_b128 v[88:91], v7 offset:5120
  ds_read_b128 v[92:95], v7 offset:25600
  s_waitcnt lgkmcnt(4)
  v_mfma_f32_16x16x32_bf16 v[32:35], a[12:15], v[72:75], v[32:35]
  v_mfma_f32_16x16x32_bf16 v[36:39], a[12:15], v[76:79], v[36:39]
  v_mfma_f32_16x16x32_bf16 v[40:43], a[92:95], v[72:75], v[40:43]
  v_mfma_f32_16x16x32_bf16 v[44:47], a[92:95], v[76:79], v[44:47]
  v_mfma_f32_16x16x32_bf16 v[48:51], a[172:175], v[72:75], v[48:51]
  v_mfma_f32_16x16x32_bf16 v[52:55], a[172:175], v[76:79], v[52:55]
  v_mfma_f32_16x16x32_bf16 v[56:59], v[108:111], v[72:75], v[56:59]
  v_mfma_f32_16x16x32_bf16 v[60:63], v[108:111], v[76:79], v[60:63]
  ds_read_b128 v[72:75], v7 offset:6144
  ds_read_b128 v[76:79], v7 offset:26624
  s_waitcnt lgkmcnt(4)
  v_mfma_f32_16x16x32_bf16 v[32:35], a[16:19], v[80:83], v[32:35]
  v_mfma_f32_16x16x32_bf16 v[36:39], a[16:19], v[84:87], v[36:39]
  v_mfma_f32_16x16x32_bf16 v[40:43], a[96:99], v[80:83], v[40:43]
  v_mfma_f32_16x16x32_bf16 v[44:47], a[96:99], v[84:87], v[44:47]
  v_mfma_f32_16x16x32_bf16 v[48:51], a[176:179], v[80:83], v[48:51]
  v_mfma_f32_16x16x32_bf16 v[52:55], a[176:179], v[84:87], v[52:55]
  v_mfma_f32_16x16x32_bf16 v[56:59], v[112:115], v[80:83], v[56:59]
  v_mfma_f32_16x16x32_bf16 v[60:63], v[112:115], v[84:87], v[60:63]
  ds_read_b128 v[80:83], v7 offset:7168
  ds_read_b128 v[84:87], v7 offset:27648
  s_waitcnt lgkmcnt(4)
  v_mfma_f32_16x16x32_bf16 v[32:35], a[20:23], v[88:91], v[32:35]
  v_mfma_f32_16x16x32_bf16 v[36:39], a[20:23], v[92:95], v[36:39]
  v_mfma_f32_16x16x32_bf16 v[40:43], a[100:103], v[88:91], v[40:43]
  v_mfma_f32_16x16x32_bf16 v[44:47], a[100:103], v[92:95], v[44:47]
  v_mfma_f32_16x16x32_bf16 v[48:51], a[180:183], v[88:91], v[48:51]
  v_mfma_f32_16x16x32_bf16 v[52:55], a[180:183], v[92:95], v[52:55]
  v_mfma_f32_16x16x32_bf16 v[56:59], v[116:119], v[88:91], v[56:59]
  v_mfma_f32_16x16x32_bf16 v[60:63], v[116:119], v[92:95], v[60:63]
  ds_read_b128 v[88:91], v7 offset:8192
  ds_read_b128 v[92:95], v7 offset:28672
  s_waitcnt lgkmcnt(4)
  v_mfma_f32_16x16x32_bf16 v[32:35], a[24:27], v[72:75], v[32:35]
  v_mfma_f32_16x16x32_bf16 v[36:39], a[24:27], v[76:79], v[36:39]
  v_mfma_f32_16x16x32_bf16 v[40:43], a[104:107], v[72:75], v[40:43]
  v_mfma_f32_16x16x32_bf16 v[44:47], a[104:107], v[76:79], v[44:47]
  v_mfma_f32_16x16x32_bf16 v[48:51], a[184:187], v[72:75], v[48:51]
  v_mfma_f32_16x16x32_bf16 v[52:55], a[184:187], v[76:79], v[52:55]
  v_mfma_f32_16x16x32_bf16 v[56:59], v[120:123], v[72:75], v[56:59]
  v_mfma_f32_16x16x32_bf16 v[60:63], v[120:123], v[76:79], v[60:63]
  ds_read_b128 v[72:75], v7 offset:9216
  ds_read_b128 v[76:79], v7 offset:29696
  s_waitcnt lgkmcnt(4)
  v_mfma_f32_16x16x32_bf16 v[32:35], a[28:31], v[80:83], v[32:35]
  v_mfma_f32_16x16x32_bf16 v[36:39], a[28:31], v[84:87], v[36:39]
  v_mfma_f32_16x16x32_bf16 v[40:43], a[108:111], v[80:83], v[40:43]
  v_mfma_f32_16x16x32_bf16 v[44:47], a[108:111], v[84:87], v[44:47]
  v_mfma_f32_16x16x32_bf16 v[48:51], a[188:191], v[80:83], v[48:51]
  v_mfma_f32_16x16x32_bf16 v[52:55], a[188:191], v[84:87], v[52:55]
  v_mfma_f32_16x16x32_bf16 v[56:59], v[124:127], v[80:83], v[56:59]
  v_mfma_f32_16x16x32_bf16 v[60:63], v[124:127], v[84:87], v[60:63]
  ds_read_b128 v[80:83], v7 offset:10240
  ds_read_b128 v[84:87], v7 offset:30720
  s_waitcnt lgkmcnt(4)
  v_mfma_f32_16x16x32_bf16 v[32:35], a[32:35], v[88:91], v[32:35]
  v_mfma_f32_16x16x32_bf16 v[36:39], a[32:35], v[92:95], v[36:39]
  v_mfma_f32_16x16x32_bf16 v[40:43], a[112:115], v[88:91], v[40:43]
  v_mfma_f32_16x16x32_bf16 v[44:47], a[112:115], v[92:95], v[44:47]
  v_mfma_f32_16x16x32_bf16 v[48:51], a[192:195], v[88:91], v[48:51]
  v_mfma_f32_16x16x32_bf16 v[52:55], a[192:195], v[92:95], v[52:55]
  v_mfma_f32_16x16x32_bf16 v[56:59], v[128:131], v[88:91], v[56:59]
  v_mfma_f32_16x16x32_bf16 v[60:63], v[128:131], v[92:95], v[60:63]
  ds_read_b128 v[88:91], v7 offset:11264
  ds_read_b128 v[92:95], v7 offset:31744
  s_waitcnt lgkmcnt(4)
  v_mfma_f32_16x16x32_bf16 v[32:35], a[36:39], v[72:75], v[32:35]
  v_mfma_f32_16x16x32_bf16 v[36:39], a[36:39], v[76:79], v[36:39]
  v_mfma_f32_16x16x32_bf16 v[40:43], a[116:119], v[72:75], v[40:43]
  v_mfma_f32_16x16x32_bf16 v[44:47], a[116:119], v[76:79], v[44:47]
  v_mfma_f32_16x16x32_bf16 v[48:51], a[196:199], v[72:75], v[48:51]
  v_mfma_f32_16x16x32_bf16 v[52:55], a[196:199], v[76:79], v[52:55]
  v_mfma_f32_16x16x32_bf16 v[56:59], v[132:135], v[72:75], v[56:59]
  v_mfma_f32_16x16x32_bf16 v[60:63], v[132:135], v[76:79], v[60:63]
  ds_read_b128 v[72:75], v7 offset:12288
  ds_read_b128 v[76:79], v7 offset:32768
  s_waitcnt lgkmcnt(4)
  v_mfma_f32_16x16x32_bf16 v[32:35], a[40:43], v[80:83], v[32:35]
  v_mfma_f32_16x16x32_bf16 v[36:39], a[40:43], v[84:87], v[36:39]
  v_mfma_f32_16x16x32_bf16 v[40:43], a[120:123], v[80:83], v[40:43]
  v_mfma_f32_16x16x32_bf16 v[44:47], a[120:123], v[84:87], v[44:47]
  v_mfma_f32_16x16x32_bf16 v[48:51], a[200:203], v[80:83], v[48:51]
  v_mfma_f32_16x16x32_bf16 v[52:55], a[200:203], v[84:87], v[52:55]
  v_mfma_f32_16x16x32_bf16 v[56:59], v[136:139], v[80:83], v[56:59]
  v_mfma_f32_16x16x32_bf16 v[60:63], v[136:139], v[84:87], v[60:63]
  ds_read_b128 v[80:83], v7 offset:13312
  ds_read_b128 v[84:87], v7 offset:33792
  s_waitcnt lgkmcnt(4)
  v_mfma_f32_16x16x32_bf16 v[32:35], a[44:47], v[88:91], v[32:35]
  v_mfma_f32_16x16x32_bf16 v[36:39], a[44:47], v[92:95], v[36:39]
  v_mfma_f32_16x16x32_bf16 v[40:43], a[124:127], v[88:91], v[40:43]
  v_mfma_f32_16x16x32_bf16 v[44:47], a[124:127], v[92:95], v[44:47]
  v_mfma_f32_16x16x32_bf16 v[48:51], a[204:207], v[88:91], v[48:51]
  v_mfma_f32_16x16x32_bf16 v[52:55], a[204:207], v[92:95], v[52:55]
  v_mfma_f32_16x16x32_bf16 v[56:59], v[140:143], v[88:91], v[56:59]
  v_mfma_f32_16x16x32_bf16 v[60:63], v[140:143], v[92:95], v[60:63]
  ds_read_b128 v[88:91], v7 offset:14336
  ds_read_b128 v[92:95], v7 offset:34816
  s_waitcnt lgkmcnt(4)
  v_mfma_f32_16x16x32_bf16 v[32:35], a[48:51], v[72:75], v[32:35]
  v_mfma_f32_16x16x32_bf16 v[36:39], a[48:51], v[76:79], v[36:39]
  v_mfma_f32_16x16x32_bf16 v[40:43], a[128:131], v[72:75], v[40:43]
  v_mfma_f32_16x16x32_bf16 v[44:47], a[128:131], v[76:79], v[44:47]
  v_mfma_f32_16x16x32_bf16 v[48:51], a[208:211], v[72:75], v[48:51]
  v_mfma_f32_16x16x32_bf16 v[52:55], a[208:211], v[76:79], v[52:55]
  v_mfma_f32_16x16x32_bf16 v[56:59], v[144:147], v[72:75], v[56:59]
  v_mfma_f32_16x16x32_bf16 v[60:63], v[144:147], v[76:79], v[60:63]
  ds_read_b128 v[72:75], v7 offset:15360
  ds_read_b128 v[76:79], v7 offset:35840
  s_waitcnt lgkmcnt(4)
  v_mfma_f32_16x16x32_bf16 v[32:35], a[52:55], v[80:83], v[32:35]
  v_mfma_f32_16x16x32_bf16 v[36:39], a[52:55], v[84:87], v[36:39]
  v_mfma_f32_16x16x32_bf16 v[40:43], a[132:135], v[80:83], v[40:43]
  v_mfma_f32_16x16x32_bf16 v[44:47], a[132:135], v[84:87], v[44:47]
  v_mfma_f32_16x16x32_bf16 v[48:51], a[212:215], v[80:83], v[48:51]
  v_mfma_f32_16x16x32_bf16 v[52:55], a[212:215], v[84:87], v[52:55]
  v_mfma_f32_16x16x32_bf16 v[56:59], v[148:151], v[80:83], v[56:59]
  v_mfma_f32_16x16x32_bf16 v[60:63], v[148:151], v[84:87], v[60:63]
  ds_read_b128 v[80:83], v7 offset:16384
  ds_read_b128 v[84:87], v7 offset:36864
  s_waitcnt lgkmcnt(4)
  v_mfma_f32_16x16x32_bf16 v[32:35], a[56:59], v[88:91], v[32:35]
  v_mfma_f32_16x16x32_bf16 v[36:39], a[56:59], v[92:95], v[36:39]
  v_mfma_f32_16x16x32_bf16 v[40:43], a[136:139], v[88:91], v[40:43]
  v_mfma_f32_16x16x32_bf16 v[44:47], a[136:139], v[92:95], v[44:47]
  v_mfma_f32_16x16x32_bf16 v[48:51], a[216:219], v[88:91], v[48:51]
  v_mfma_f32_16x16x32_bf16 v[52:55], a[216:219], v[92:95], v[52:55]
  v_mfma_f32_16x16x32_bf16 v[56:59], v[152:155], v[88:91], v[56:59]
  v_mfma_f32_16x16x32_bf16 v[60:63], v[152:155], v[92:95], v[60:63]
  ds_read_b128 v[88:91], v7 offset:17408
  ds_read_b128 v[92:95], v7 offset:37888
  s_waitcnt lgkmcnt(4)
  v_mfma_f32_16x16x32_bf16 v[32:35], a[60:63], v[72:75], v[32:35]
  v_mfma_f32_16x16x32_bf16 v[36:39], a[60:63], v[76:79], v[36:39]
  v_mfma_f32_16x16x32_bf16 v[40:43], a[140:143], v[72:75], v[40:43]
  v_mfma_f32_16x16x32_bf16 v[44:47], a[140:143], v[76:79], v[44:47]
  v_mfma_f32_16x16x32_bf16 v[48:51], a[220:223], v[72:75], v[48:51]
  v_mfma_f32_16x16x32_bf16 v[52:55], a[220:223], v[76:79], v[52:55]
  v_mfma_f32_16x16x32_bf16 v[56:59], v[156:159], v[72:75], v[56:59]
  v_mfma_f32_16x16x32_bf16 v[60:63], v[156:159], v[76:79], v[60:63]
  ds_read_b128 v[72:75], v7 offset:18432
  ds_read_b128 v[76:79], v7 offset:38912
  s_waitcnt lgkmcnt(4)
  v_mfma_f32_16x16x32_bf16 v[32:35], a[64:67], v[80:83], v[32:35]
  v_mfma_f32_16x16x32_bf16 v[36:39], a[64:67], v[84:87], v[36:39]
  v_mfma_f32_16x16x32_bf16 v[40:43], a[144:147], v[80:83], v[40:43]
  v_mfma_f32_16x16x32_bf16 v[44:47], a[144:147], v[84:87], v[44:47]
  v_mfma_f32_16x16x32_bf16 v[48:51], a[224:227], v[80:83], v[48:51]
  v_mfma_f32_16x16x32_bf16 v[52:55], a[224:227], v[84:87], v[52:55]
  v_mfma_f32_16x16x32_bf16 v[56:59], v[160:163], v[80:83], v[56:59]
  v_mfma_f32_16x16x32_bf16 v[60:63], v[160:163], v[84:87], v[60:63]
  ds_read_b128 v[80:83], v7 offset:19456
  ds_read_b128 v[84:87], v7 offset:39936
  s_waitcnt lgkmcnt(4)
  v_mfma_f32_16x16x32_bf16 v[32:35], a[68:71], v[88:91], v[32:35]
  v_mfma_f32_16x16x32_bf16 v[36:39], a[68:71], v[92:95], v[36:39]
  v_mfma_f32_16x16x32_bf16 v[40:43], a[148:151], v[88:91], v[40:43]
  v_mfma_f32_16x16x32_bf16 v[44:47], a[148:151], v[92:95], v[44:47]
  v_mfma_f32_16x16x32_bf16 v[48:51], a[228:231], v[88:91], v[48:51]
  v_mfma_f32_16x16x32_bf16 v[52:55], a[228:231], v[92:95], v[52:55]
  v_mfma_f32_16x16x32_bf16 v[56:59], v[164:167], v[88:91], v[56:59]
  v_mfma_f32_16x16x32_bf16 v[60:63], v[164:167], v[92:95], v[60:63]
  s_waitcnt lgkmcnt(2)
  v_mfma_f32_16x16x32_bf16 v[32:35], a[72:75], v[72:75], v[32:35]
  v_mfma_f32_16x16x32_bf16 v[36:39], a[72:75], v[76:79], v[36:39]
  v_mfma_f32_16x16x32_bf16 v[40:43], a[152:155], v[72:75], v[40:43]
  v_mfma_f32_16x16x32_bf16 v[44:47], a[152:155], v[76:79], v[44:47]
  v_mfma_f32_16x16x32_bf16 v[48:51], a[232:235], v[72:75], v[48:51]
  v_mfma_f32_16x16x32_bf16 v[52:55], a[232:235], v[76:79], v[52:55]
  v_mfma_f32_16x16x32_bf16 v[56:59], v[168:171], v[72:75], v[56:59]
  v_mfma_f32_16x16x32_bf16 v[60:63], v[168:171], v[76:79], v[60:63]
  s_waitcnt lgkmcnt(0)
  v_mfma_f32_16x16x32_bf16 v[32:35], a[76:79], v[80:83], v[32:35]
  v_mfma_f32_16x16x32_bf16 v[36:39], a[76:79], v[84:87], v[36:39]
  v_mfma_f32_16x16x32_bf16 v[40:43], a[156:159], v[80:83], v[40:43]
  v_mfma_f32_16x16x32_bf16 v[44:47], a[156:159], v[84:87], v[44:47]
  v_mfma_f32_16x16x32_bf16 v[48:51], a[236:239], v[80:83], v[48:51]
  v_mfma_f32_16x16x32_bf16 v[52:55], a[236:239], v[84:87], v[52:55]
  v_mfma_f32_16x16x32_bf16 v[56:59], v[172:175], v[80:83], v[56:59]
  v_mfma_f32_16x16x32_bf16 v[60:63], v[172:175], v[84:87], v[60:63]
  s_nop 0
  v_cvt_pk_bf16_f32 v8, v32, v33
  v_cvt_pk_bf16_f32 v9, v34, v35
  v_cvt_pk_bf16_f32 v10, v40, v41
  v_cvt_pk_bf16_f32 v11, v42, v43
  s_add_u32 s34, s22, 1024
  buffer_store_dwordx4 v[8:11], v1, s[4:7], s34 offen
  v_cvt_pk_bf16_f32 v12, v36, v37
  v_cvt_pk_bf16_f32 v13, v38, v39
  v_cvt_pk_bf16_f32 v14, v44, v45
  v_cvt_pk_bf16_f32 v15, v46, v47
  s_add_u32 s34, s22, 7168
  buffer_store_dwordx4 v[12:15], v1, s[4:7], s34 offen
  v_cvt_pk_bf16_f32 v8, v48, v49
  v_cvt_pk_bf16_f32 v9, v50, v51
  v_cvt_pk_bf16_f32 v10, v56, v57
  v_cvt_pk_bf16_f32 v11, v58, v59
  s_add_u32 s34, s22, 2048
  buffer_store_dwordx4 v[8:11], v1, s[4:7], s34 offen
  v_cvt_pk_bf16_f32 v12, v52, v53
  v_cvt_pk_bf16_f32 v13, v54, v55
  v_cvt_pk_bf16_f32 v14, v60, v61
  v_cvt_pk_bf16_f32 v15, v62, v63
  s_add_u32 s34, s22, 8192
  buffer_store_dwordx4 v[12:15], v1, s[4:7], s34 offen
  s_waitcnt vmcnt(0)
  s_barrier
  s_add_u32 s17, s17, 1
  s_cmp_lt_u32 s17, 64
  s_cbranch_scc1 reca_ptop272
  s_branch reca_exit1
reca_pslow271:
reca_ptop277:
  s_cmp_lt_u32 s17, 3
  s_cbranch_scc1 reca_pgo278
  s_sub_u32 s36, s17, 3
reca_ppoll279:
  buffer_load_dword v28, v4, s[4:7], s25 offen sc1
  s_waitcnt vmcnt(0)
  v_readfirstlane_b32 s34, v28
  s_nop 3
  s_cmp_ge_i32 s34, s36
  s_cbranch_scc1 reca_pgo278
  s_sleep 8
  s_sub_u32 s18, s18, 1
  s_cbranch_scc0 reca_ppoll279
  s_mov_b32 s18, 0
reca_pgo278:
  s_waitcnt vmcnt(0)
  s_barrier
  v_add_u32 v7, s26, v1
  s_xor_b32 s26, s26, 40960
  s_add_u32 s37, s17, 1
  s_cmp_ge_u32 s37, 64
  s_cbranch_scc1 reca_pnodma280
  s_mul_i32 s20, s37, 40960
  s_add_u32 s20, s20, 84965376
  s_add_u32 m0, s26, 30720
  s_nop 0
  buffer_load_dwordx4 v1, s[4:7], s20 offen offset:0 lds
  buffer_load_dwordx4 v1, s[4:7], s20 offen offset:1024 lds
  buffer_load_dwordx4 v1, s[4:7], s20 offen offset:2048 lds
  buffer_load_dwordx4 v1, s[4:7], s20 offen offset:3072 lds
  s_add_u32 s20, s20, 4096
  s_add_u32 m0, s26, 34816
  s_nop 0
  buffer_load_dwordx4 v1, s[4:7], s20 offen offset:0 lds
  buffer_load_dwordx4 v1, s[4:7], s20 offen offset:1024 lds
  buffer_load_dwordx4 v1, s[4:7], s20 offen offset:2048 lds
  buffer_load_dwordx4 v1, s[4:7], s20 offen offset:3072 lds
  s_add_u32 s20, s20, 4096
  s_add_u32 m0, s26, 38912
  s_nop 0
  buffer_load_dwordx4 v1, s[4:7], s20 offen offset:0 lds
  buffer_load_dwordx4 v1, s[4:7], s20 offen offset:1024 lds
reca_pnodma280:
  s_lshl_b32 s34, s15, 3
  s_and_b32 s35, s17, 7
  s_add_u32 s34, s34, s35
  s_mul_i32 s34, s34, 12288
  s_mul_i32 s35, s16, 3072
  s_add_u32 s35, s35, s34
  s_add_u32 s21, s35, 37748736
  s_add_u32 s22, s35, 44040192
  s_mul_i32 s35, s16, 6144
  s_add_u32 s35, s35, s34
  s_add_u32 s23, s35, 40894464
  ds_read_b128 v[72:75], v7 offset:0
  ds_read_b128 v[76:79], v7 offset:20480
  ds_read_b128 v[80:83], v7 offset:1024
  ds_read_b128 v[84:87], v7 offset:21504
  ds_read_b128 v[88:91], v7 offset:2048
  ds_read_b128 v[92:95], v7 offset:22528
  s_waitcnt lgkmcnt(4)
  v_mfma_f32_16x16x32_bf16 v[32:35], a[0:3], v[72:75], 0
  v_mfma_f32_16x16x32_bf16 v[36:39], a[0:3], v[76:79], 0
  v_mfma_f32_16x16x32_bf16 v[40:43], a[80:83], v[72:75], 0
  v_mfma_f32_16x16x32_bf16 v[44:47], a[80:83], v[76:79], 0
  v_mfma_f32_16x16x32_bf16 v[48:51], a[160:163], v[72:75], 0
  v_mfma_f32_16x16x32_bf16 v[52:55], a[160:163], v[76:79], 0
  v_mfma_f32_16x16x32_bf16 v[56:59], v[96:99], v[72:75], 0
  v_mfma_f32_16x16x32_bf16 v[60:63], v[96:99], v[76:79], 0
  ds_read_b128 v[72:75], v7 offset:3072
  ds_read_b128 v[76:79], v7 offset:23552
  s_waitcnt lgkmcnt(4)
  v_mfma_f32_16x16x32_bf16 v[32:35], a[4:7], v[80:83], v[32:35]
  v_mfma_f32_16x16x32_bf16 v[36:39], a[4:7], v[84:87], v[36:39]
  v_mfma_f32_16x16x32_bf16 v[40:43], a[84:87], v[80:83], v[40:43]
  v_mfma_f32_16x16x32_bf16 v[44:47], a[84:87], v[84:87], v[44:47]
  v_mfma_f32_16x16x32_bf16 v[48:51], a[164:167], v[80:83], v[48:51]
  v_mfma_f32_16x16x32_bf16 v[52:55], a[164:167], v[84:87], v[52:55]
  v_mfma_f32_16x16x32_bf16 v[56:59], v[100:103], v[80:83], v[56:59]
  v_mfma_f32_16x16x32_bf16 v[60:63], v[100:103], v[84:87], v[60:63]
  ds_read_b128 v[80:83], v7 offset:4096
  ds_read_b128 v[84:87], v7 offset:24576
  s_waitcnt lgkmcnt(4)
  v_mfma_f32_16x16x32_bf16 v[32:35], a[8:11], v[88:91], v[32:35]
  v_mfma_f32_16x16x32_bf16 v[36:39], a[8:11], v[92:95], v[36:39]
  v_mfma_f32_16x16x32_bf16 v[40:43], a[88:91], v[88:91], v[40:43]
  v_mfma_f32_16x16x32_bf16 v[44:47], a[88:91], v[92:95], v[44:47]
  v_mfma_f32_16x16x32_bf16 v[48:51], a[168:171], v[88:91], v[48:51]
  v_mfma_f32_16x16x32_bf16 v[52:55], a[168:171], v[92:95], v[52:55]
  v_mfma_f32_16x16x32_bf16 v[56:59], v[104:107], v[88:91], v[56:59]
  v_mfma_f32_16x16x32_bf16 v[60:63], v[104:107], v[92:95], v[60:63]
  ds_read_b128 v[88:91], v7 offset:5120
  ds_read_b128 v[92:95], v7 offset:25600
  s_waitcnt lgkmcnt(4)
  v_mfma_f32_16x16x32_bf16 v[32:35], a[12:15], v[72:75], v[32:35]
  v_mfma_f32_16x16x32_bf16 v[36:39], a[12:15], v[76:79], v[36:39]
  v_mfma_f32_16x16x32_bf16 v[40:43], a[92:95], v[72:75], v[40:43]
  v_mfma_f32_16x16x32_bf16 v[44:47], a[92:95], v[76:79], v[44:47]
  v_mfma_f32_16x16x32_bf16 v[48:51], a[172:175], v[72:75], v[48:51]
  v_mfma_f32_16x16x32_bf16 v[52:55], a[172:175], v[76:79], v[52:55]
  v_mfma_f32_16x16x32_bf16 v[56:59], v[108:111], v[72:75], v[56:59]
  v_mfma_f32_16x16x32_bf16 v[60:63], v[108:111], v[76:79], v[60:63]
  ds_read_b128 v[72:75], v7 offset:6144
  ds_read_b128 v[76:79], v7 offset:26624
  s_waitcnt lgkmcnt(4)
  v_mfma_f32_16x16x32_bf16 v[32:35], a[16:19], v[80:83], v[32:35]
  v_mfma_f32_16x16x32_bf16 v[36:39], a[16:19], v[84:87], v[36:39]
  v_mfma_f32_16x16x32_bf16 v[40:43], a[96:99], v[80:83], v[40:43]
  v_mfma_f32_16x16x32_bf16 v[44:47], a[96:99], v[84:87], v[44:47]
  v_mfma_f32_16x16x32_bf16 v[48:51], a[176:179], v[80:83], v[48:51]
  v_mfma_f32_16x16x32_bf16 v[52:55], a[176:179], v[84:87], v[52:55]
  v_mfma_f32_16x16x32_bf16 v[56:59], v[112:115], v[80:83], v[56:59]
  v_mfma_f32_16x16x32_bf16 v[60:63], v[112:115], v[84:87], v[60:63]
  ds_read_b128 v[80:83], v7 offset:7168
  ds_read_b128 v[84:87], v7 offset:27648
  s_waitcnt lgkmcnt(4)
  v_mfma_f32_16x16x32_bf16 v[32:35], a[20:23], v[88:91], v[32:35]
  v_mfma_f32_16x16x32_bf16 v[36:39], a[20:23], v[92:95], v[36:39]
  v_mfma_f32_16x16x32_bf16 v[40:43], a[100:103], v[88:91], v[40:43]
  v_mfma_f32_16x16x32_bf16 v[44:47], a[100:103], v[92:95], v[44:47]
  v_mfma_f32_16x16x32_bf16 v[48:51], a[180:183], v[88:91], v[48:51]
  v_mfma_f32_16x16x32_bf16 v[52:55], a[180:183], v[92:95], v[52:55]
  v_mfma_f32_16x16x32_bf16 v[56:59], v[116:119], v[88:91], v[56:59]
  v_mfma_f32_16x16x32_bf16 v[60:63], v[116:119], v[92:95], v[60:63]
  ds_read_b128 v[88:91], v7 offset:8192
  ds_read_b128 v[92:95], v7 offset:28672
  s_waitcnt lgkmcnt(4)
  v_mfma_f32_16x16x32_bf16 v[32:35], a[24:27], v[72:75], v[32:35]
  v_mfma_f32_16x16x32_bf16 v[36:39], a[24:27], v[76:79], v[36:39]
  v_mfma_f32_16x16x32_bf16 v[40:43], a[104:107], v[72:75], v[40:43]
  v_mfma_f32_16x16x32_bf16 v[44:47], a[104:107], v[76:79], v[44:47]
  v_mfma_f32_16x16x32_bf16 v[48:51], a[184:187], v[72:75], v[48:51]
  v_mfma_f32_16x16x32_bf16 v[52:55], a[184:187], v[76:79], v[52:55]
  v_mfma_f32_16x16x32_bf16 v[56:59], v[120:123], v[72:75], v[56:59]
  v_mfma_f32_16x16x32_bf16 v[60:63], v[120:123], v[76:79], v[60:63]
  ds_read_b128 v[72:75], v7 offset:9216
  ds_read_b128 v[76:79], v7 offset:29696
  s_waitcnt lgkmcnt(4)
  v_mfma_f32_16x16x32_bf16 v[32:35], a[28:31], v[80:83], v[32:35]
  v_mfma_f32_16x16x32_bf16 v[36:39], a[28:31], v[84:87], v[36:39]
  v_mfma_f32_16x16x32_bf16 v[40:43], a[108:111], v[80:83], v[40:43]
  v_mfma_f32_16x16x32_bf16 v[44:47], a[108:111], v[84:87], v[44:47]
  v_mfma_f32_16x16x32_bf16 v[48:51], a[188:191], v[80:83], v[48:51]
  v_mfma_f32_16x16x32_bf16 v[52:55], a[188:191], v[84:87], v[52:55]
  v_mfma_f32_16x16x32_bf16 v[56:59], v[124:127], v[80:83], v[56:59]
  v_mfma_f32_16x16x32_bf16 v[60:63], v[124:127], v[84:87], v[60:63]
  ds_read_b128 v[80:83], v7 offset:10240
  ds_read_b128 v[84:87], v7 offset:30720
  s_waitcnt lgkmcnt(4)
  v_mfma_f32_16x16x32_bf16 v[32:35], a[32:35], v[88:91], v[32:35]
  v_mfma_f32_16x16x32_bf16 v[36:39], a[32:35], v[92:95], v[36:39]
  v_mfma_f32_16x16x32_bf16 v[40:43], a[112:115], v[88:91], v[40:43]
  v_mfma_f32_16x16x32_bf16 v[44:47], a[112:115], v[92:95], v[44:47]
  v_mfma_f32_16x16x32_bf16 v[48:51], a[192:195], v[88:91], v[48:51]
  v_mfma_f32_16x16x32_bf16 v[52:55], a[192:195], v[92:95], v[52:55]
  v_mfma_f32_16x16x32_bf16 v[56:59], v[128:131], v[88:91], v[56:59]
  v_mfma_f32_16x16x32_bf16 v[60:63], v[128:131], v[92:95], v[60:63]
  ds_read_b128 v[88:91], v7 offset:11264
  ds_read_b128 v[92:95], v7 offset:31744
  s_waitcnt lgkmcnt(4)
  v_mfma_f32_16x16x32_bf16 v[32:35], a[36:39], v[72:75], v[32:35]
  v_mfma_f32_16x16x32_bf16 v[36:39], a[36:39], v[76:79], v[36:39]
  v_mfma_f32_16x16x32_bf16 v[40:43], a[116:119], v[72:75], v[40:43]
  v_mfma_f32_16x16x32_bf16 v[44:47], a[116:119], v[76:79], v[44:47]
  v_mfma_f32_16x16x32_bf16 v[48:51], a[196:199], v[72:75], v[48:51]
  v_mfma_f32_16x16x32_bf16 v[52:55], a[196:199], v[76:79], v[52:55]
  v_mfma_f32_16x16x32_bf16 v[56:59], v[132:135], v[72:75], v[56:59]
  v_mfma_f32_16x16x32_bf16 v[60:63], v[132:135], v[76:79], v[60:63]
  ds_read_b128 v[72:75], v7 offset:12288
  ds_read_b128 v[76:79], v7 offset:32768
  s_waitcnt lgkmcnt(4)
  v_mfma_f32_16x16x32_bf16 v[32:35], a[40:43], v[80:83], v[32:35]
  v_mfma_f32_16x16x32_bf16 v[36:39], a[40:43], v[84:87], v[36:39]
  v_mfma_f32_16x16x32_bf16 v[40:43], a[120:123], v[80:83], v[40:43]
  v_mfma_f32_16x16x32_bf16 v[44:47], a[120:123], v[84:87], v[44:47]
  v_mfma_f32_16x16x32_bf16 v[48:51], a[200:203], v[80:83], v[48:51]
  v_mfma_f32_16x16x32_bf16 v[52:55], a[200:203], v[84:87], v[52:55]
  v_mfma_f32_16x16x32_bf16 v[56:59], v[136:139], v[80:83], v[56:59]
  v_mfma_f32_16x16x32_bf16 v[60:63], v[136:139], v[84:87], v[60:63]
  ds_read_b128 v[80:83], v7 offset:13312
  ds_read_b128 v[84:87], v7 offset:33792
  s_waitcnt lgkmcnt(4)
  v_mfma_f32_16x16x32_bf16 v[32:35], a[44:47], v[88:91], v[32:35]
  v_mfma_f32_16x16x32_bf16 v[36:39], a[44:47], v[92:95], v[36:39]
  v_mfma_f32_16x16x32_bf16 v[40:43], a[124:127], v[88:91], v[40:43]
  v_mfma_f32_16x16x32_bf16 v[44:47], a[124:127], v[92:95], v[44:47]
  v_mfma_f32_16x16x32_bf16 v[48:51], a[204:207], v[88:91], v[48:51]
  v_mfma_f32_16x16x32_bf16 v[52:55], a[204:207], v[92:95], v[52:55]
  v_mfma_f32_16x16x32_bf16 v[56:59], v[140:143], v[88:91], v[56:59]
  v_mfma_f32_16x16x32_bf16 v[60:63], v[140:143], v[92:95], v[60:63]
  ds_read_b128 v[88:91], v7 offset:14336
  ds_read_b128 v[92:95], v7 offset:34816
  s_waitcnt lgkmcnt(4)
  v_mfma_f32_16x16x32_bf16 v[32:35], a[48:51], v[72:75], v[32:35]
  v_mfma_f32_16x16x32_bf16 v[36:39], a[48:51], v[76:79], v[36:39]
  v_mfma_f32_16x16x32_bf16 v[40:43], a[128:131], v[72:75], v[40:43]
  v_mfma_f32_16x16x32_bf16 v[44:47], a[128:131], v[76:79], v[44:47]
  v_mfma_f32_16x16x32_bf16 v[48:51], a[208:211], v[72:75], v[48:51]
  v_mfma_f32_16x16x32_bf16 v[52:55], a[208:211], v[76:79], v[52:55]
  v_mfma_f32_16x16x32_bf16 v[56:59], v[144:147], v[72:75], v[56:59]
  v_mfma_f32_16x16x32_bf16 v[60:63], v[144:147], v[76:79], v[60:63]
  ds_read_b128 v[72:75], v7 offset:15360
  ds_read_b128 v[76:79], v7 offset:35840
  s_waitcnt lgkmcnt(4)
  v_mfma_f32_16x16x32_bf16 v[32:35], a[52:55], v[80:83], v[32:35]
  v_mfma_f32_16x16x32_bf16 v[36:39], a[52:55], v[84:87], v[36:39]
  v_mfma_f32_16x16x32_bf16 v[40:43], a[132:135], v[80:83], v[40:43]
  v_mfma_f32_16x16x32_bf16 v[44:47], a[132:135], v[84:87], v[44:47]
  v_mfma_f32_16x16x32_bf16 v[48:51], a[212:215], v[80:83], v[48:51]
  v_mfma_f32_16x16x32_bf16 v[52:55], a[212:215], v[84:87], v[52:55]
  v_mfma_f32_16x16x32_bf16 v[56:59], v[148:151], v[80:83], v[56:59]
  v_mfma_f32_16x16x32_bf16 v[60:63], v[148:151], v[84:87], v[60:63]
  ds_read_b128 v[80:83], v7 offset:16384
  ds_read_b128 v[84:87], v7 offset:36864
  s_waitcnt lgkmcnt(4)
  v_mfma_f32_16x16x32_bf16 v[32:35], a[56:59], v[88:91], v[32:35]
  v_mfma_f32_16x16x32_bf16 v[36:39], a[56:59], v[92:95], v[36:39]
  v_mfma_f32_16x16x32_bf16 v[40:43], a[136:139], v[88:91], v[40:43]
  v_mfma_f32_16x16x32_bf16 v[44:47], a[136:139], v[92:95], v[44:47]
  v_mfma_f32_16x16x32_bf16 v[48:51], a[216:219], v[88:91], v[48:51]
  v_mfma_f32_16x16x32_bf16 v[52:55], a[216:219], v[92:95], v[52:55]
  v_mfma_f32_16x16x32_bf16 v[56:59], v[152:155], v[88:91], v[56:59]
  v_mfma_f32_16x16x32_bf16 v[60:63], v[152:155], v[92:95], v[60:63]
  ds_read_b128 v[88:91], v7 offset:17408
  ds_read_b128 v[92:95], v7 offset:37888
  s_waitcnt lgkmcnt(4)
  v_mfma_f32_16x16x32_bf16 v[32:35], a[60:63], v[72:75], v[32:35]
  v_mfma_f32_16x16x32_bf16 v[36:39], a[60:63], v[76:79], v[36:39]
  v_mfma_f32_16x16x32_bf16 v[40:43], a[140:143], v[72:75], v[40:43]
  v_mfma_f32_16x16x32_bf16 v[44:47], a[140:143], v[76:79], v[44:47]
  v_mfma_f32_16x16x32_bf16 v[48:51], a[220:223], v[72:75], v[48:51]
  v_mfma_f32_16x16x32_bf16 v[52:55], a[220:223], v[76:79], v[52:55]
  v_mfma_f32_16x16x32_bf16 v[56:59], v[156:159], v[72:75], v[56:59]
  v_mfma_f32_16x16x32_bf16 v[60:63], v[156:159], v[76:79], v[60:63]
  ds_read_b128 v[72:75], v7 offset:18432
  ds_read_b128 v[76:79], v7 offset:38912
  s_waitcnt lgkmcnt(4)
  v_mfma_f32_16x16x32_bf16 v[32:35], a[64:67], v[80:83], v[32:35]
  v_mfma_f32_16x16x32_bf16 v[36:39], a[64:67], v[84:87], v[36:39]
  v_mfma_f32_16x16x32_bf16 v[40:43], a[144:147], v[80:83], v[40:43]
  v_mfma_f32_16x16x32_bf16 v[44:47], a[144:147], v[84:87], v[44:47]
  v_mfma_f32_16x16x32_bf16 v[48:51], a[224:227], v[80:83], v[48:51]
  v_mfma_f32_16x16x32_bf16 v[52:55], a[224:227], v[84:87], v[52:55]
  v_mfma_f32_16x16x32_bf16 v[56:59], v[160:163], v[80:83], v[56:59]
  v_mfma_f32_16x16x32_bf16 v[60:63], v[160:163], v[84:87], v[60:63]
  ds_read_b128 v[80:83], v7 offset:19456
  ds_read_b128 v[84:87], v7 offset:39936
  s_waitcnt lgkmcnt(4)
  v_mfma_f32_16x16x32_bf16 v[32:35], a[68:71], v[88:91], v[32:35]
  v_mfma_f32_16x16x32_bf16 v[36:39], a[68:71], v[92:95], v[36:39]
  v_mfma_f32_16x16x32_bf16 v[40:43], a[148:151], v[88:91], v[40:43]
  v_mfma_f32_16x16x32_bf16 v[44:47], a[148:151], v[92:95], v[44:47]
  v_mfma_f32_16x16x32_bf16 v[48:51], a[228:231], v[88:91], v[48:51]
  v_mfma_f32_16x16x32_bf16 v[52:55], a[228:231], v[92:95], v[52:55]
  v_mfma_f32_16x16x32_bf16 v[56:59], v[164:167], v[88:91], v[56:59]
  v_mfma_f32_16x16x32_bf16 v[60:63], v[164:167], v[92:95], v[60:63]
  s_waitcnt lgkmcnt(2)
  v_mfma_f32_16x16x32_bf16 v[32:35], a[72:75], v[72:75], v[32:35]
  v_mfma_f32_16x16x32_bf16 v[36:39], a[72:75], v[76:79], v[36:39]
  v_mfma_f32_16x16x32_bf16 v[40:43], a[152:155], v[72:75], v[40:43]
  v_mfma_f32_16x16x32_bf16 v[44:47], a[152:155], v[76:79], v[44:47]
  v_mfma_f32_16x16x32_bf16 v[48:51], a[232:235], v[72:75], v[48:51]
  v_mfma_f32_16x16x32_bf16 v[52:55], a[232:235], v[76:79], v[52:55]
  v_mfma_f32_16x16x32_bf16 v[56:59], v[168:171], v[72:75], v[56:59]
  v_mfma_f32_16x16x32_bf16 v[60:63], v[168:171], v[76:79], v[60:63]
  s_waitcnt lgkmcnt(0)
  v_mfma_f32_16x16x32_bf16 v[32:35], a[76:79], v[80:83], v[32:35]
  v_mfma_f32_16x16x32_bf16 v[36:39], a[76:79], v[84:87], v[36:39]
  v_mfma_f32_16x16x32_bf16 v[40:43], a[156:159], v[80:83], v[40:43]
  v_mfma_f32_16x16x32_bf16 v[44:47], a[156:159], v[84:87], v[44:47]
  v_mfma_f32_16x16x32_bf16 v[48:51], a[236:239], v[80:83], v[48:51]
  v_mfma_f32_16x16x32_bf16 v[52:55], a[236:239], v[84:87], v[52:55]
  v_mfma_f32_16x16x32_bf16 v[56:59], v[172:175], v[80:83], v[56:59]
  v_mfma_f32_16x16x32_bf16 v[60:63], v[172:175], v[84:87], v[60:63]
  s_nop 0
  v_cvt_pk_bf16_f32 v8, v32, v33
  v_cvt_pk_bf16_f32 v9, v34, v35
  v_cvt_pk_bf16_f32 v10, v40, v41
  v_cvt_pk_bf16_f32 v11, v42, v43
  s_add_u32 s34, s22, 1024
  buffer_store_dwordx4 v[8:11], v1, s[4:7], s34 offen sc1
  v_cvt_pk_bf16_f32 v12, v36, v37
  v_cvt_pk_bf16_f32 v13, v38, v39
  v_cvt_pk_bf16_f32 v14, v44, v45
  v_cvt_pk_bf16_f32 v15, v46, v47
  s_add_u32 s34, s22, 7168
  buffer_store_dwordx4 v[12:15], v1, s[4:7], s34 offen sc1
  v_cvt_pk_bf16_f32 v8, v48, v49
  v_cvt_pk_bf16_f32 v9, v50, v51
  v_cvt_pk_bf16_f32 v10, v56, v57
  v_cvt_pk_bf16_f32 v11, v58, v59
  s_add_u32 s34, s22, 2048
  buffer_store_dwordx4 v[8:11], v1, s[4:7], s34 offen sc1
  v_cvt_pk_bf16_f32 v12, v52, v53
  v_cvt_pk_bf16_f32 v13, v54, v55
  v_cvt_pk_bf16_f32 v14, v60, v61
  v_cvt_pk_bf16_f32 v15, v62, v63
  s_add_u32 s34, s22, 8192
  buffer_store_dwordx4 v[12:15], v1, s[4:7], s34 offen sc1
  s_waitcnt vmcnt(0)
  s_barrier
  s_add_u32 s17, s17, 1
  s_cmp_lt_u32 s17, 64
  s_cbranch_scc1 reca_ptop277
  s_branch reca_exit1
reca_exit1:
reca_exitb3:
  s_endpgm
.globl fin_kernel
.p2align 8
.type fin_kernel,@function
fin_kernel:
  s_cmp_ge_u32 s2, 256
  s_cbranch_scc1 fin_exit1
  s_load_dwordx2 s[8:9], s[0:1], 96
  v_lshrrev_b32 v6, 6, v0
  v_and_b32 v7, 63, v0
  s_and_b32 s13, s2, 7
  v_readfirstlane_b32 s12, v6
  v_lshlrev_b32 v1, 4, v7
  v_add_u32 v2, 0x1000, v1
  v_add_u32 v3, 0x2000, v1
  s_lshr_b32 s14, s2, 3
  s_lshl_b32 s15, s13, 2
  s_add_u32 s15, s15, s12
  s_waitcnt lgkmcnt(0)
  s_mov_b32 s4, s8
  s_mov_b32 s5, s9
  s_mov_b32 s6, 0x10000000
  s_mov_b32 s7, 0x20000
  s_mov_b32 s27, 0x3dd53b95
  v_and_b32 v6, 15, v7
  v_lshrrev_b32 v8, 4, v7
  v_mov_b32 v9, 0x80000000
  v_lshlrev_b32 v10, 4, v6
  v_lshl_add_u32 v10, v8, 7, v10
  v_cmp_gt_u32 vcc, 8, v6
  s_nop 1
  v_cndmask_b32 v4, v9, v10, vcc
  v_lshlrev_b32 v10, 3, v7
  v_cmp_gt_u32 vcc, 32, v7
  s_nop 1
  v_cndmask_b32 v5, v9, v10, vcc
  v_mov_b32 v10, 0xf149f2ca
  v_cmp_le_u32 vcc, 2, v8
  s_nop 1
  v_cndmask_b32 v12, 0, v10, vcc
  v_mov_b32 v13, v12
  v_mov_b32 v14, v12
  v_mov_b32 v15, v12
  v_lshlrev_b32 v11, 2, v8
  v_add_u32 v7, 0, v11
  v_cmp_gt_u32 vcc, v7, v6
  s_nop 1
  v_cndmask_b32 v16, 0, v10, vcc
  v_add_u32 v7, 1, v11
  v_cmp_gt_u32 vcc, v7, v6
  s_nop 1
  v_cndmask_b32 v17, 0, v10, vcc
  v_add_u32 v7, 2, v11
  v_cmp_gt_u32 vcc, v7, v6
  s_nop 1
  v_cndmask_b32 v18, 0, v10, vcc
  v_add_u32 v7, 3, v11
  v_cmp_gt_u32 vcc, v7, v6
  s_nop 1
  v_cndmask_b32 v19, 0, v10, vcc
  v_mov_b32 v20, 0x3f803f80
  v_mov_b32 v21, 0x3f803f80
  v_mov_b32 v22, 0x3f803f80
  v_mov_b32 v23, 0x3f803f80
  s_mul_i32 s16, s12, 6144
  v_add_u32 v240, s16, v1
  v_add_u32 v241, 49152, v240
  s_mul_i32 s16, s12, 10
  s_mul_i32 s16, s16, 192
  s_mul_i32 s17, s13, 24
  s_add_u32 s16, s16, s17
  s_lshl_b32 s16, s16, 10
  s_add_u32 s16, s16, 29884416
  s_add_u32 s30, s16, 0
  s_add_u32 s31, s16, 196608
  s_add_u32 s32, s16, 393216
  s_add_u32 s33, s16, 589824
  s_add_u32 s34, s16, 786432
  s_add_u32 s35, s16, 983040
  s_add_u32 s36, s16, 1179648
  s_add_u32 s37, s16, 1376256
  s_add_u32 s38, s16, 1572864
  s_add_u32 s39, s16, 1769472
  s_cmp_lt_u32 s14, 30
  s_cbranch_scc1 fin_odma3
  s_lshl_b32 s17, s14, 1
  s_add_u32 s17, s17, 0
  s_and_b32 s17, s17, 7
  s_lshl_b32 s16, s15, 3
  s_add_u32 s16, s16, s17
  s_mul_i32 s16, s16, 12288
  s_add_u32 s20, s16, 44040192
  s_add_u32 s21, s16, 37748736
  s_add_u32 s22, s16, 40894464
  s_lshl_b32 s17, s17, 5
  s_add_u32 s17, s17, s15
  s_mul_i32 s17, s17, 3072
  s_add_u32 s23, s17, 47185920
  s_add_u32 s24, s17, 47972352
  s_lshl_b32 s17, s14, 1
  s_add_u32 s17, s17, 1
  s_and_b32 s17, s17, 7
  s_lshl_b32 s16, s15, 3
  s_add_u32 s16, s16, s17
  s_mul_i32 s16, s16, 12288
  s_add_u32 s40, s16, 44040192
  s_add_u32 s41, s16, 37748736
  s_add_u32 s42, s16, 40894464
  s_lshl_b32 s17, s17, 5
  s_add_u32 s17, s17, s15
  s_mul_i32 s17, s17, 3072
  s_add_u32 s43, s17, 47185920
  s_add_u32 s44, s17, 47972352
  buffer_load_dwordx4 v[136:139], v1, s[4:7], s21 offen offset:0
  buffer_load_dwordx4 v[140:143], v1, s[4:7], s21 offen offset:1024
  buffer_load_dwordx4 v[144:147], v1, s[4:7], s21 offen offset:2048
  buffer_load_dwordx4 v[148:151], v1, s[4:7], s21 offen offset:3072
  buffer_load_dwordx4 v[152:155], v2, s[4:7], s21 offen offset:0
  buffer_load_dwordx4 v[156:159], v2, s[4:7], s21 offen offset:1024
  buffer_load_dwordx4 v[160:163], v2, s[4:7], s21 offen offset:2048
  buffer_load_dwordx4 v[164:167], v2, s[4:7], s21 offen offset:3072
  buffer_load_dwordx4 v[168:171], v3, s[4:7], s21 offen offset:0
  buffer_load_dwordx4 v[172:175], v3, s[4:7], s21 offen offset:1024
  buffer_load_dwordx4 v[176:179], v3, s[4:7], s21 offen offset:2048
  buffer_load_dwordx4 v[180:183], v3, s[4:7], s21 offen offset:3072
  buffer_load_dwordx4 v[184:187], v4, s[4:7], s23 offen offset:0
  buffer_load_dwordx4 v[188:191], v4, s[4:7], s23 offen offset:512
  buffer_load_dwordx4 v[192:195], v4, s[4:7], s23 offen offset:1024
  buffer_load_dwordx4 v[196:199], v4, s[4:7], s23 offen offset:1536
  buffer_load_dwordx4 v[200:203], v4, s[4:7], s23 offen offset:2048
  buffer_load_dwordx4 v[204:207], v4, s[4:7], s23 offen offset:2560
  buffer_load_dwordx4 v[88:91], v1, s[4:7], s20 offen offset:0
  buffer_load_dwordx4 v[92:95], v1, s[4:7], s20 offen offset:1024
  buffer_load_dwordx4 v[96:99], v1, s[4:7], s20 offen offset:2048
  buffer_load_dwordx4 v[100:103], v1, s[4:7], s20 offen offset:3072
  buffer_load_dwordx4 v[104:107], v2, s[4:7], s20 offen offset:0
  buffer_load_dwordx4 v[108:111], v2, s[4:7], s20 offen offset:1024
  buffer_load_dwordx4 v[112:115], v2, s[4:7], s20 offen offset:2048
  buffer_load_dwordx4 v[116:119], v2, s[4:7], s20 offen offset:3072
  buffer_load_dwordx4 v[120:123], v3, s[4:7], s20 offen offset:0
  buffer_load_dwordx4 v[124:127], v3, s[4:7], s20 offen offset:1024
  buffer_load_dwordx4 v[128:131], v3, s[4:7], s20 offen offset:2048
  buffer_load_dwordx4 v[132:135], v3, s[4:7], s20 offen offset:3072
  buffer_load_dwordx4 a[0:3], v1, s[4:7], s41 offen offset:0
  buffer_load_dwordx4 a[4:7], v1, s[4:7], s41 offen offset:1024
  buffer_load_dwordx4 a[8:11], v1, s[4:7], s41 offen offset:2048
  buffer_load_dwordx4 a[12:15], v1, s[4:7], s41 offen offset:3072
  buffer_load_dwordx4 a[16:19], v2, s[4:7], s41 offen offset:0
  buffer_load_dwordx4 a[20:23], v2, s[4:7], s41 offen offset:1024
  buffer_load_dwordx4 a[24:27], v2, s[4:7], s41 offen offset:2048
  buffer_load_dwordx4 a[28:31], v2, s[4:7], s41 offen offset:3072
  buffer_load_dwordx4 a[32:35], v3, s[4:7], s41 offen offset:0
  buffer_load_dwordx4 a[36:39], v3, s[4:7], s41 offen offset:1024
  buffer_load_dwordx4 a[40:43], v3, s[4:7], s41 offen offset:2048
  buffer_load_dwordx4 a[44:47], v3, s[4:7], s41 offen offset:3072
  buffer_load_dwordx4 a[48:51], v4, s[4:7], s43 offen offset:0
  buffer_load_dwordx4 a[52:55], v4, s[4:7], s43 offen offset:512
  buffer_load_dwordx4 a[56:59], v4, s[4:7], s43 offen offset:1024
  buffer_load_dwordx4 a[60:63], v4, s[4:7], s43 offen offset:1536
  buffer_load_dwordx4 a[64:67], v4, s[4:7], s43 offen offset:2048
  buffer_load_dwordx4 a[68:71], v4, s[4:7], s43 offen offset:2560
  buffer_load_dwordx4 a[72:75], v1, s[4:7], s40 offen offset:0
  buffer_load_dwordx4 a[76:79], v1, s[4:7], s40 offen offset:1024
  buffer_load_dwordx4 a[80:83], v1, s[4:7], s40 offen offset:2048
  buffer_load_dwordx4 a[84:87], v1, s[4:7], s40 offen offset:3072
  buffer_load_dwordx4 a[88:91], v2, s[4:7], s40 offen offset:0
  buffer_load_dwordx4 a[92:95], v2, s[4:7], s40 offen offset:1024
  buffer_load_dwordx4 a[96:99], v2, s[4:7], s40 offen offset:2048
  buffer_load_dwordx4 a[100:103], v2, s[4:7], s40 offen offset:3072
  buffer_load_dwordx4 a[104:107], v3, s[4:7], s40 offen offset:0
  buffer_load_dwordx4 a[108:111], v3, s[4:7], s40 offen offset:1024
  buffer_load_dwordx4 a[112:115], v3, s[4:7], s40 offen offset:2048
  buffer_load_dwordx4 a[116:119], v3, s[4:7], s40 offen offset:3072
  s_waitcnt vmcnt(35)
  v_mfma_f32_16x16x32_bf16 v[24:27], v[184:187], v[88:91], v[12:15]
  v_mfma_f32_16x16x32_bf16 v[28:31], v[136:139], v[88:91], v[16:19]
  v_mfma_f32_16x16x32_bf16 v[32:35], v[184:187], v[112:115], v[12:15]
  v_mfma_f32_16x16x32_bf16 v[36:39], v[136:139], v[112:115], 0
  v_mfma_f32_16x16x32_bf16 v[40:43], v[160:163], v[112:115], v[16:19]
  s_waitcnt vmcnt(34)
  v_mfma_f32_16x16x32_bf16 v[24:27], v[188:191], v[92:95], v[24:27]
  v_mfma_f32_16x16x32_bf16 v[28:31], v[140:143], v[92:95], v[28:31]
  v_mfma_f32_16x16x32_bf16 v[32:35], v[188:191], v[116:119], v[32:35]
  v_mfma_f32_16x16x32_bf16 v[36:39], v[140:143], v[116:119], v[36:39]
  v_mfma_f32_16x16x32_bf16 v[40:43], v[164:167], v[116:119], v[40:43]
  s_waitcnt vmcnt(33)
  v_mfma_f32_16x16x32_bf16 v[24:27], v[192:195], v[96:99], v[24:27]
  v_mfma_f32_16x16x32_bf16 v[28:31], v[144:147], v[96:99], v[28:31]
  v_mfma_f32_16x16x32_bf16 v[32:35], v[192:195], v[120:123], v[32:35]
  v_mfma_f32_16x16x32_bf16 v[36:39], v[144:147], v[120:123], v[36:39]
  v_mfma_f32_16x16x32_bf16 v[40:43], v[168:171], v[120:123], v[40:43]
  s_waitcnt vmcnt(32)
  v_mfma_f32_16x16x32_bf16 v[24:27], v[196:199], v[100:103], v[24:27]
  v_mfma_f32_16x16x32_bf16 v[28:31], v[148:151], v[100:103], v[28:31]
  v_mfma_f32_16x16x32_bf16 v[32:35], v[196:199], v[124:127], v[32:35]
  v_mfma_f32_16x16x32_bf16 v[36:39], v[148:151], v[124:127], v[36:39]
  v_mfma_f32_16x16x32_bf16 v[40:43], v[172:175], v[124:127], v[40:43]
  s_waitcnt vmcnt(31)
  v_mfma_f32_16x16x32_bf16 v[24:27], v[200:203], v[104:107], v[24:27]
  v_mfma_f32_16x16x32_bf16 v[28:31], v[152:155], v[104:107], v[28:31]
  v_mfma_f32_16x16x32_bf16 v[32:35], v[200:203], v[128:131], v[32:35]
  v_mfma_f32_16x16x32_bf16 v[36:39], v[152:155], v[128:131], v[36:39]
  v_mfma_f32_16x16x32_bf16 v[40:43], v[176:179], v[128:131], v[40:43]
  s_waitcnt vmcnt(30)
  v_mfma_f32_16x16x32_bf16 v[24:27], v[204:207], v[108:111], v[24:27]
  v_mfma_f32_16x16x32_bf16 v[28:31], v[156:159], v[108:111], v[28:31]
  v_mfma_f32_16x16x32_bf16 v[32:35], v[204:207], v[132:135], v[32:35]
  v_mfma_f32_16x16x32_bf16 v[36:39], v[156:159], v[132:135], v[36:39]
  v_mfma_f32_16x16x32_bf16 v[40:43], v[180:183], v[132:135], v[40:43]
  buffer_load_dwordx4 v[88:91], v1, s[4:7], s22 offen offset:0
  buffer_load_dwordx4 v[92:95], v1, s[4:7], s22 offen offset:1024
  buffer_load_dwordx4 v[96:99], v1, s[4:7], s22 offen offset:2048
  buffer_load_dwordx4 v[100:103], v1, s[4:7], s22 offen offset:3072
  buffer_load_dwordx4 v[104:107], v2, s[4:7], s22 offen offset:0
  buffer_load_dwordx4 v[108:111], v2, s[4:7], s22 offen offset:1024
  buffer_load_dwordx4 v[112:115], v2, s[4:7], s22 offen offset:2048
  buffer_load_dwordx4 v[116:119], v2, s[4:7], s22 offen offset:3072
  buffer_load_dwordx4 v[120:123], v3, s[4:7], s22 offen offset:0
  buffer_load_dwordx4 v[124:127], v3, s[4:7], s22 offen offset:1024
  buffer_load_dwordx4 v[128:131], v3, s[4:7], s22 offen offset:2048
  buffer_load_dwordx4 v[132:135], v3, s[4:7], s22 offen offset:3072
  buffer_load_dwordx2 v[136:137], v5, s[4:7], s24 offen offset:0
  buffer_load_dwordx2 v[138:139], v5, s[4:7], s24 offen offset:256
  buffer_load_dwordx2 v[140:141], v5, s[4:7], s24 offen offset:512
  buffer_load_dwordx2 v[142:143], v5, s[4:7], s24 offen offset:768
  buffer_load_dwordx2 v[144:145], v5, s[4:7], s24 offen offset:1024
  buffer_load_dwordx2 v[146:147], v5, s[4:7], s24 offen offset:1280
  buffer_load_dwordx2 v[148:149], v5, s[4:7], s24 offen offset:1536
  buffer_load_dwordx2 v[150:151], v5, s[4:7], s24 offen offset:1792
  buffer_load_dwordx2 v[152:153], v5, s[4:7], s24 offen offset:2048
  buffer_load_dwordx2 v[154:155], v5, s[4:7], s24 offen offset:2304
  buffer_load_dwordx2 v[156:157], v5, s[4:7], s24 offen offset:2560
  buffer_load_dwordx2 v[158:159], v5, s[4:7], s24 offen offset:2816
  v_max3_f32 v6, v24, v25, v26
  v_max3_f32 v6, v6, v27, v28
  v_max3_f32 v6, v6, v29, v30
  v_max_f32 v6, v6, v31
  v_mov_b32 v7, v6
  s_nop 1
  v_permlane32_swap_b32 v6, v7
  v_max_f32 v6, v6, v7
  v_mov_b32 v7, v6
  s_nop 1
  v_permlane16_swap_b32 v6, v7
  v_max_f32 v6, v6, v7
  v_mul_f32 v6, s27, v6
  v_fma_f32 v24, v24, s27, -v6
  v_fma_f32 v25, v25, s27, -v6
  v_fma_f32 v26, v26, s27, -v6
  v_fma_f32 v27, v27, s27, -v6
  v_fma_f32 v28, v28, s27, -v6
  v_fma_f32 v29, v29, s27, -v6
  v_fma_f32 v30, v30, s27, -v6
  v_fma_f32 v31, v31, s27, -v6
  v_exp_f32 v24, v24
  v_exp_f32 v25, v25
  v_exp_f32 v26, v26
  v_exp_f32 v27, v27
  v_exp_f32 v28, v28
  v_exp_f32 v29, v29
  v_exp_f32 v30, v30
  v_exp_f32 v31, v31
  v_max3_f32 v8, v32, v33, v34
  v_max3_f32 v8, v8, v35, v36
  v_max3_f32 v8, v8, v37, v38
  v_max3_f32 v8, v8, v39, v40
  v_max3_f32 v8, v8, v41, v42
  v_max_f32 v8, v8, v43
  v_mov_b32 v10, v8
  s_nop 1
  v_permlane32_swap_b32 v8, v10
  v_max_f32 v8, v8, v10
  v_mov_b32 v10, v8
  s_nop 1
  v_permlane16_swap_b32 v8, v10
  v_max_f32 v8, v8, v10
  v_mul_f32 v8, s27, v8
  v_fma_f32 v32, v32, s27, -v8
  v_fma_f32 v33, v33, s27, -v8
  v_fma_f32 v34, v34, s27, -v8
  v_fma_f32 v35, v35, s27, -v8
  v_fma_f32 v36, v36, s27, -v8
  v_fma_f32 v37, v37, s27, -v8
  v_fma_f32 v38, v38, s27, -v8
  v_fma_f32 v39, v39, s27, -v8
  v_fma_f32 v40, v40, s27, -v8
  v_fma_f32 v41, v41, s27, -v8
  v_fma_f32 v42, v42, s27, -v8
  v_fma_f32 v43, v43, s27, -v8
  v_exp_f32 v32, v32
  v_exp_f32 v33, v33
  v_exp_f32 v34, v34
  v_exp_f32 v35, v35
  v_exp_f32 v36, v36
  v_exp_f32 v37, v37
  v_exp_f32 v38, v38
  v_exp_f32 v39, v39
  v_exp_f32 v40, v40
  v_exp_f32 v41, v41
  v_exp_f32 v42, v42
  v_exp_f32 v43, v43
  v_cvt_pk_bf16_f32 v44, v24, v25
  v_cvt_pk_bf16_f32 v45, v26, v27
  v_cvt_pk_bf16_f32 v46, v28, v29
  v_cvt_pk_bf16_f32 v47, v30, v31
  v_cvt_pk_bf16_f32 v48, v32, v33
  v_cvt_pk_bf16_f32 v49, v34, v35
  v_cvt_pk_bf16_f32 v50, v36, v37
  v_cvt_pk_bf16_f32 v51, v38, v39
  v_cvt_pk_bf16_f32 v52, v40, v41
  v_cvt_pk_bf16_f32 v53, v42, v43
  v_mfma_f32_16x16x16_bf16 v[56:59], v[20:21], v[44:45], 0
  v_mfma_f32_16x16x16_bf16 v[60:63], v[20:21], v[48:49], 0
  v_mfma_f32_16x16x16_bf16 v[56:59], v[20:21], v[46:47], v[56:59]
  v_mfma_f32_16x16x32_bf16 v[60:63], v[20:23], v[50:53], v[60:63]
  s_nop 6
  v_rcp_f32 v10, v56
  v_rcp_f32 v11, v60
  s_waitcnt vmcnt(0)
  v_mfma_f32_16x16x16_bf16 v[64:67], v[136:137], v[44:45], 0
  v_mfma_f32_16x16x16_bf16 v[68:71], v[136:137], v[48:49], 0
  v_mfma_f32_16x16x16_bf16 v[64:67], v[88:89], v[46:47], v[64:67]
  v_mfma_f32_16x16x32_bf16 v[68:71], v[88:91], v[50:53], v[68:71]
  v_mfma_f32_16x16x16_bf16 v[72:75], v[138:139], v[44:45], 0
  v_mfma_f32_16x16x16_bf16 v[76:79], v[138:139], v[48:49], 0
  v_mfma_f32_16x16x16_bf16 v[72:75], v[92:93], v[46:47], v[72:75]
  v_mfma_f32_16x16x32_bf16 v[76:79], v[92:95], v[50:53], v[76:79]
  s_nop 2
  v_mul_f32 v64, v64, v10
  v_mul_f32 v65, v65, v10
  v_mul_f32 v66, v66, v10
  v_mul_f32 v67, v67, v10
  v_cvt_pk_bf16_f32 v80, v64, v65
  v_cvt_pk_bf16_f32 v81, v66, v67
  v_mul_f32 v72, v72, v10
  v_mul_f32 v73, v73, v10
  v_mul_f32 v74, v74, v10
  v_mul_f32 v75, v75, v10
  v_cvt_pk_bf16_f32 v82, v72, v73
  v_cvt_pk_bf16_f32 v83, v74, v75
  ds_write_b128 v240, v[80:83] offset:0
  v_mul_f32 v68, v68, v11
  v_mul_f32 v69, v69, v11
  v_mul_f32 v70, v70, v11
  v_mul_f32 v71, v71, v11
  v_cvt_pk_bf16_f32 v84, v68, v69
  v_cvt_pk_bf16_f32 v85, v70, v71
  v_mul_f32 v76, v76, v11
  v_mul_f32 v77, v77, v11
  v_mul_f32 v78, v78, v11
  v_mul_f32 v79, v79, v11
  v_cvt_pk_bf16_f32 v86, v76, v77
  v_cvt_pk_bf16_f32 v87, v78, v79
  ds_write_b128 v240, v[84:87] offset:24576
  v_mfma_f32_16x16x16_bf16 v[64:67], v[140:141], v[44:45], 0
  v_mfma_f32_16x16x16_bf16 v[68:71], v[140:141], v[48:49], 0
  v_mfma_f32_16x16x16_bf16 v[64:67], v[96:97], v[46:47], v[64:67]
  v_mfma_f32_16x16x32_bf16 v[68:71], v[96:99], v[50:53], v[68:71]
  v_mfma_f32_16x16x16_bf16 v[72:75], v[142:143], v[44:45], 0
  v_mfma_f32_16x16x16_bf16 v[76:79], v[142:143], v[48:49], 0
  v_mfma_f32_16x16x16_bf16 v[72:75], v[100:101], v[46:47], v[72:75]
  v_mfma_f32_16x16x32_bf16 v[76:79], v[100:103], v[50:53], v[76:79]
  s_nop 2
  v_mul_f32 v64, v64, v10
  v_mul_f32 v65, v65, v10
  v_mul_f32 v66, v66, v10
  v_mul_f32 v67, v67, v10
  v_cvt_pk_bf16_f32 v80, v64, v65
  v_cvt_pk_bf16_f32 v81, v66, v67
  v_mul_f32 v72, v72, v10
  v_mul_f32 v73, v73, v10
  v_mul_f32 v74, v74, v10
  v_mul_f32 v75, v75, v10
  v_cvt_pk_bf16_f32 v82, v72, v73
  v_cvt_pk_bf16_f32 v83, v74, v75
  ds_write_b128 v240, v[80:83] offset:1024
  v_mul_f32 v68, v68, v11
  v_mul_f32 v69, v69, v11
  v_mul_f32 v70, v70, v11
  v_mul_f32 v71, v71, v11
  v_cvt_pk_bf16_f32 v84, v68, v69
  v_cvt_pk_bf16_f32 v85, v70, v71
  v_mul_f32 v76, v76, v11
  v_mul_f32 v77, v77, v11
  v_mul_f32 v78, v78, v11
  v_mul_f32 v79, v79, v11
  v_cvt_pk_bf16_f32 v86, v76, v77
  v_cvt_pk_bf16_f32 v87, v78, v79
  ds_write_b128 v240, v[84:87] offset:25600
  v_mfma_f32_16x16x16_bf16 v[64:67], v[144:145], v[44:45], 0
  v_mfma_f32_16x16x16_bf16 v[68:71], v[144:145], v[48:49], 0
  v_mfma_f32_16x16x16_bf16 v[64:67], v[104:105], v[46:47], v[64:67]
  v_mfma_f32_16x16x32_bf16 v[68:71], v[104:107], v[50:53], v[68:71]
  v_mfma_f32_16x16x16_bf16 v[72:75], v[146:147], v[44:45], 0
  v_mfma_f32_16x16x16_bf16 v[76:79], v[146:147], v[48:49], 0
  v_mfma_f32_16x16x16_bf16 v[72:75], v[108:109], v[46:47], v[72:75]
  v_mfma_f32_16x16x32_bf16 v[76:79], v[108:111], v[50:53], v[76:79]
  s_nop 2
  v_mul_f32 v64, v64, v10
  v_mul_f32 v65, v65, v10
  v_mul_f32 v66, v66, v10
  v_mul_f32 v67, v67, v10
  v_cvt_pk_bf16_f32 v80, v64, v65
  v_cvt_pk_bf16_f32 v81, v66, v67
  v_mul_f32 v72, v72, v10
  v_mul_f32 v73, v73, v10
  v_mul_f32 v74, v74, v10
  v_mul_f32 v75, v75, v10
  v_cvt_pk_bf16_f32 v82, v72, v73
  v_cvt_pk_bf16_f32 v83, v74, v75
  ds_write_b128 v240, v[80:83] offset:2048
  v_mul_f32 v68, v68, v11
  v_mul_f32 v69, v69, v11
  v_mul_f32 v70, v70, v11
  v_mul_f32 v71, v71, v11
  v_cvt_pk_bf16_f32 v84, v68, v69
  v_cvt_pk_bf16_f32 v85, v70, v71
  v_mul_f32 v76, v76, v11
  v_mul_f32 v77, v77, v11
  v_mul_f32 v78, v78, v11
  v_mul_f32 v79, v79, v11
  v_cvt_pk_bf16_f32 v86, v76, v77
  v_cvt_pk_bf16_f32 v87, v78, v79
  ds_write_b128 v240, v[84:87] offset:26624
  v_mfma_f32_16x16x16_bf16 v[64:67], v[148:149], v[44:45], 0
  v_mfma_f32_16x16x16_bf16 v[68:71], v[148:149], v[48:49], 0
  v_mfma_f32_16x16x16_bf16 v[64:67], v[112:113], v[46:47], v[64:67]
  v_mfma_f32_16x16x32_bf16 v[68:71], v[112:115], v[50:53], v[68:71]
  v_mfma_f32_16x16x16_bf16 v[72:75], v[150:151], v[44:45], 0
  v_mfma_f32_16x16x16_bf16 v[76:79], v[150:151], v[48:49], 0
  v_mfma_f32_16x16x16_bf16 v[72:75], v[116:117], v[46:47], v[72:75]
  v_mfma_f32_16x16x32_bf16 v[76:79], v[116:119], v[50:53], v[76:79]
  s_nop 2
  v_mul_f32 v64, v64, v10
  v_mul_f32 v65, v65, v10
  v_mul_f32 v66, v66, v10
  v_mul_f32 v67, v67, v10
  v_cvt_pk_bf16_f32 v80, v64, v65
  v_cvt_pk_bf16_f32 v81, v66, v67
  v_mul_f32 v72, v72, v10
  v_mul_f32 v73, v73, v10
  v_mul_f32 v74, v74, v10
  v_mul_f32 v75, v75, v10
  v_cvt_pk_bf16_f32 v82, v72, v73
  v_cvt_pk_bf16_f32 v83, v74, v75
  ds_write_b128 v240, v[80:83] offset:3072
  v_mul_f32 v68, v68, v11
  v_mul_f32 v69, v69, v11
  v_mul_f32 v70, v70, v11
  v_mul_f32 v71, v71, v11
  v_cvt_pk_bf16_f32 v84, v68, v69
  v_cvt_pk_bf16_f32 v85, v70, v71
  v_mul_f32 v76, v76, v11
  v_mul_f32 v77, v77, v11
  v_mul_f32 v78, v78, v11
  v_mul_f32 v79, v79, v11
  v_cvt_pk_bf16_f32 v86, v76, v77
  v_cvt_pk_bf16_f32 v87, v78, v79
  ds_write_b128 v240, v[84:87] offset:27648
  v_mfma_f32_16x16x16_bf16 v[64:67], v[152:153], v[44:45], 0
  v_mfma_f32_16x16x16_bf16 v[68:71], v[152:153], v[48:49], 0
  v_mfma_f32_16x16x16_bf16 v[64:67], v[120:121], v[46:47], v[64:67]
  v_mfma_f32_16x16x32_bf16 v[68:71], v[120:123], v[50:53], v[68:71]
  v_mfma_f32_16x16x16_bf16 v[72:75], v[154:155], v[44:45], 0
  v_mfma_f32_16x16x16_bf16 v[76:79], v[154:155], v[48:49], 0
  v_mfma_f32_16x16x16_bf16 v[72:75], v[124:125], v[46:47], v[72:75]
  v_mfma_f32_16x16x32_bf16 v[76:79], v[124:127], v[50:53], v[76:79]
  s_nop 2
  v_mul_f32 v64, v64, v10
  v_mul_f32 v65, v65, v10
  v_mul_f32 v66, v66, v10
  v_mul_f32 v67, v67, v10
  v_cvt_pk_bf16_f32 v80, v64, v65
  v_cvt_pk_bf16_f32 v81, v66, v67
  v_mul_f32 v72, v72, v10
  v_mul_f32 v73, v73, v10
  v_mul_f32 v74, v74, v10
  v_mul_f32 v75, v75, v10
  v_cvt_pk_bf16_f32 v82, v72, v73
  v_cvt_pk_bf16_f32 v83, v74, v75
  ds_write_b128 v240, v[80:83] offset:4096
  v_mul_f32 v68, v68, v11
  v_mul_f32 v69, v69, v11
  v_mul_f32 v70, v70, v11
  v_mul_f32 v71, v71, v11
  v_cvt_pk_bf16_f32 v84, v68, v69
  v_cvt_pk_bf16_f32 v85, v70, v71
  v_mul_f32 v76, v76, v11
  v_mul_f32 v77, v77, v11
  v_mul_f32 v78, v78, v11
  v_mul_f32 v79, v79, v11
  v_cvt_pk_bf16_f32 v86, v76, v77
  v_cvt_pk_bf16_f32 v87, v78, v79
  ds_write_b128 v240, v[84:87] offset:28672
  v_mfma_f32_16x16x16_bf16 v[64:67], v[156:157], v[44:45], 0
  v_mfma_f32_16x16x16_bf16 v[68:71], v[156:157], v[48:49], 0
  v_mfma_f32_16x16x16_bf16 v[64:67], v[128:129], v[46:47], v[64:67]
  v_mfma_f32_16x16x32_bf16 v[68:71], v[128:131], v[50:53], v[68:71]
  v_mfma_f32_16x16x16_bf16 v[72:75], v[158:159], v[44:45], 0
  v_mfma_f32_16x16x16_bf16 v[76:79], v[158:159], v[48:49], 0
  v_mfma_f32_16x16x16_bf16 v[72:75], v[132:133], v[46:47], v[72:75]
  v_mfma_f32_16x16x32_bf16 v[76:79], v[132:135], v[50:53], v[76:79]
  s_nop 2
  v_mul_f32 v64, v64, v10
  v_mul_f32 v65, v65, v10
  v_mul_f32 v66, v66, v10
  v_mul_f32 v67, v67, v10
  v_cvt_pk_bf16_f32 v80, v64, v65
  v_cvt_pk_bf16_f32 v81, v66, v67
  v_mul_f32 v72, v72, v10
  v_mul_f32 v73, v73, v10
  v_mul_f32 v74, v74, v10
  v_mul_f32 v75, v75, v10
  v_cvt_pk_bf16_f32 v82, v72, v73
  v_cvt_pk_bf16_f32 v83, v74, v75
  ds_write_b128 v240, v[80:83] offset:5120
  v_mul_f32 v68, v68, v11
  v_mul_f32 v69, v69, v11
  v_mul_f32 v70, v70, v11
  v_mul_f32 v71, v71, v11
  v_cvt_pk_bf16_f32 v84, v68, v69
  v_cvt_pk_bf16_f32 v85, v70, v71
  v_mul_f32 v76, v76, v11
  v_mul_f32 v77, v77, v11
  v_mul_f32 v78, v78, v11
  v_mul_f32 v79, v79, v11
  v_cvt_pk_bf16_f32 v86, v76, v77
  v_cvt_pk_bf16_f32 v87, v78, v79
  ds_write_b128 v240, v[84:87] offset:29696
  v_mfma_f32_16x16x32_bf16 v[24:27], a[48:51], a[72:75], v[12:15]
  v_mfma_f32_16x16x32_bf16 v[28:31], a[0:3], a[72:75], v[16:19]
  v_mfma_f32_16x16x32_bf16 v[32:35], a[48:51], a[96:99], v[12:15]
  v_mfma_f32_16x16x32_bf16 v[36:39], a[0:3], a[96:99], 0
  v_mfma_f32_16x16x32_bf16 v[40:43], a[24:27], a[96:99], v[16:19]
  v_mfma_f32_16x16x32_bf16 v[24:27], a[52:55], a[76:79], v[24:27]
  v_mfma_f32_16x16x32_bf16 v[28:31], a[4:7], a[76:79], v[28:31]
  v_mfma_f32_16x16x32_bf16 v[32:35], a[52:55], a[100:103], v[32:35]
  v_mfma_f32_16x16x32_bf16 v[36:39], a[4:7], a[100:103], v[36:39]
  v_mfma_f32_16x16x32_bf16 v[40:43], a[28:31], a[100:103], v[40:43]
  v_mfma_f32_16x16x32_bf16 v[24:27], a[56:59], a[80:83], v[24:27]
  v_mfma_f32_16x16x32_bf16 v[28:31], a[8:11], a[80:83], v[28:31]
  v_mfma_f32_16x16x32_bf16 v[32:35], a[56:59], a[104:107], v[32:35]
  v_mfma_f32_16x16x32_bf16 v[36:39], a[8:11], a[104:107], v[36:39]
  v_mfma_f32_16x16x32_bf16 v[40:43], a[32:35], a[104:107], v[40:43]
  v_mfma_f32_16x16x32_bf16 v[24:27], a[60:63], a[84:87], v[24:27]
  v_mfma_f32_16x16x32_bf16 v[28:31], a[12:15], a[84:87], v[28:31]
  v_mfma_f32_16x16x32_bf16 v[32:35], a[60:63], a[108:111], v[32:35]
  v_mfma_f32_16x16x32_bf16 v[36:39], a[12:15], a[108:111], v[36:39]
  v_mfma_f32_16x16x32_bf16 v[40:43], a[36:39], a[108:111], v[40:43]
  v_mfma_f32_16x16x32_bf16 v[24:27], a[64:67], a[88:91], v[24:27]
  v_mfma_f32_16x16x32_bf16 v[28:31], a[16:19], a[88:91], v[28:31]
  v_mfma_f32_16x16x32_bf16 v[32:35], a[64:67], a[112:115], v[32:35]
  v_mfma_f32_16x16x32_bf16 v[36:39], a[16:19], a[112:115], v[36:39]
  v_mfma_f32_16x16x32_bf16 v[40:43], a[40:43], a[112:115], v[40:43]
  v_mfma_f32_16x16x32_bf16 v[24:27], a[68:71], a[92:95], v[24:27]
  v_mfma_f32_16x16x32_bf16 v[28:31], a[20:23], a[92:95], v[28:31]
  v_mfma_f32_16x16x32_bf16 v[32:35], a[68:71], a[116:119], v[32:35]
  v_mfma_f32_16x16x32_bf16 v[36:39], a[20:23], a[116:119], v[36:39]
  v_mfma_f32_16x16x32_bf16 v[40:43], a[44:47], a[116:119], v[40:43]
  buffer_load_dwordx4 v[88:91], v1, s[4:7], s42 offen offset:0
  buffer_load_dwordx4 v[92:95], v1, s[4:7], s42 offen offset:1024
  buffer_load_dwordx4 v[96:99], v1, s[4:7], s42 offen offset:2048
  buffer_load_dwordx4 v[100:103], v1, s[4:7], s42 offen offset:3072
  buffer_load_dwordx4 v[104:107], v2, s[4:7], s42 offen offset:0
  buffer_load_dwordx4 v[108:111], v2, s[4:7], s42 offen offset:1024
  buffer_load_dwordx4 v[112:115], v2, s[4:7], s42 offen offset:2048
  buffer_load_dwordx4 v[116:119], v2, s[4:7], s42 offen offset:3072
  buffer_load_dwordx4 v[120:123], v3, s[4:7], s42 offen offset:0
  buffer_load_dwordx4 v[124:127], v3, s[4:7], s42 offen offset:1024
  buffer_load_dwordx4 v[128:131], v3, s[4:7], s42 offen offset:2048
  buffer_load_dwordx4 v[132:135], v3, s[4:7], s42 offen offset:3072
  buffer_load_dwordx2 v[136:137], v5, s[4:7], s44 offen offset:0
  buffer_load_dwordx2 v[138:139], v5, s[4:7], s44 offen offset:256
  buffer_load_dwordx2 v[140:141], v5, s[4:7], s44 offen offset:512
  buffer_load_dwordx2 v[142:143], v5, s[4:7], s44 offen offset:768
  buffer_load_dwordx2 v[144:145], v5, s[4:7], s44 offen offset:1024
  buffer_load_dwordx2 v[146:147], v5, s[4:7], s44 offen offset:1280
  buffer_load_dwordx2 v[148:149], v5, s[4:7], s44 offen offset:1536
  buffer_load_dwordx2 v[150:151], v5, s[4:7], s44 offen offset:1792
  buffer_load_dwordx2 v[152:153], v5, s[4:7], s44 offen offset:2048
  buffer_load_dwordx2 v[154:155], v5, s[4:7], s44 offen offset:2304
  buffer_load_dwordx2 v[156:157], v5, s[4:7], s44 offen offset:2560
  buffer_load_dwordx2 v[158:159], v5, s[4:7], s44 offen offset:2816
  v_max3_f32 v6, v24, v25, v26
  v_max3_f32 v6, v6, v27, v28
  v_max3_f32 v6, v6, v29, v30
  v_max_f32 v6, v6, v31
  v_mov_b32 v7, v6
  s_nop 1
  v_permlane32_swap_b32 v6, v7
  v_max_f32 v6, v6, v7
  v_mov_b32 v7, v6
  s_nop 1
  v_permlane16_swap_b32 v6, v7
  v_max_f32 v6, v6, v7
  v_mul_f32 v6, s27, v6
  v_fma_f32 v24, v24, s27, -v6
  v_fma_f32 v25, v25, s27, -v6
  v_fma_f32 v26, v26, s27, -v6
  v_fma_f32 v27, v27, s27, -v6
  v_fma_f32 v28, v28, s27, -v6
  v_fma_f32 v29, v29, s27, -v6
  v_fma_f32 v30, v30, s27, -v6
  v_fma_f32 v31, v31, s27, -v6
  v_exp_f32 v24, v24
  v_exp_f32 v25, v25
  v_exp_f32 v26, v26
  v_exp_f32 v27, v27
  v_exp_f32 v28, v28
  v_exp_f32 v29, v29
  v_exp_f32 v30, v30
  v_exp_f32 v31, v31
  v_max3_f32 v8, v32, v33, v34
  v_max3_f32 v8, v8, v35, v36
  v_max3_f32 v8, v8, v37, v38
  v_max3_f32 v8, v8, v39, v40
  v_max3_f32 v8, v8, v41, v42
  v_max_f32 v8, v8, v43
  v_mov_b32 v10, v8
  s_nop 1
  v_permlane32_swap_b32 v8, v10
  v_max_f32 v8, v8, v10
  v_mov_b32 v10, v8
  s_nop 1
  v_permlane16_swap_b32 v8, v10
  v_max_f32 v8, v8, v10
  v_mul_f32 v8, s27, v8
  v_fma_f32 v32, v32, s27, -v8
  v_fma_f32 v33, v33, s27, -v8
  v_fma_f32 v34, v34, s27, -v8
  v_fma_f32 v35, v35, s27, -v8
  v_fma_f32 v36, v36, s27, -v8
  v_fma_f32 v37, v37, s27, -v8
  v_fma_f32 v38, v38, s27, -v8
  v_fma_f32 v39, v39, s27, -v8
  v_fma_f32 v40, v40, s27, -v8
  v_fma_f32 v41, v41, s27, -v8
  v_fma_f32 v42, v42, s27, -v8
  v_fma_f32 v43, v43, s27, -v8
  v_exp_f32 v32, v32
  v_exp_f32 v33, v33
  v_exp_f32 v34, v34
  v_exp_f32 v35, v35
  v_exp_f32 v36, v36
  v_exp_f32 v37, v37
  v_exp_f32 v38, v38
  v_exp_f32 v39, v39
  v_exp_f32 v40, v40
  v_exp_f32 v41, v41
  v_exp_f32 v42, v42
  v_exp_f32 v43, v43
  v_cvt_pk_bf16_f32 v44, v24, v25
  v_cvt_pk_bf16_f32 v45, v26, v27
  v_cvt_pk_bf16_f32 v46, v28, v29
  v_cvt_pk_bf16_f32 v47, v30, v31
  v_cvt_pk_bf16_f32 v48, v32, v33
  v_cvt_pk_bf16_f32 v49, v34, v35
  v_cvt_pk_bf16_f32 v50, v36, v37
  v_cvt_pk_bf16_f32 v51, v38, v39
  v_cvt_pk_bf16_f32 v52, v40, v41
  v_cvt_pk_bf16_f32 v53, v42, v43
  v_mfma_f32_16x16x16_bf16 v[56:59], v[20:21], v[44:45], 0
  v_mfma_f32_16x16x16_bf16 v[60:63], v[20:21], v[48:49], 0
  v_mfma_f32_16x16x16_bf16 v[56:59], v[20:21], v[46:47], v[56:59]
  v_mfma_f32_16x16x32_bf16 v[60:63], v[20:23], v[50:53], v[60:63]
  s_nop 6
  v_rcp_f32 v10, v56
  v_rcp_f32 v11, v60
  s_waitcnt vmcnt(0)
  buffer_load_dwordx4 a[160:163], v1, s[4:7], s30 offen offset:0
  buffer_load_dwordx4 a[164:167], v1, s[4:7], s31 offen offset:0
  buffer_load_dwordx4 a[168:171], v1, s[4:7], s32 offen offset:0
  buffer_load_dwordx4 a[172:175], v1, s[4:7], s33 offen offset:0
  buffer_load_dwordx4 a[176:179], v1, s[4:7], s34 offen offset:0
  buffer_load_dwordx4 a[180:183], v1, s[4:7], s35 offen offset:0
  buffer_load_dwordx4 a[184:187], v1, s[4:7], s36 offen offset:0
  buffer_load_dwordx4 a[188:191], v1, s[4:7], s37 offen offset:0
  buffer_load_dwordx4 a[192:195], v1, s[4:7], s38 offen offset:0
  buffer_load_dwordx4 a[196:199], v1, s[4:7], s39 offen offset:0
  buffer_load_dwordx4 a[200:203], v1, s[4:7], s30 offen offset:1024
  buffer_load_dwordx4 a[204:207], v1, s[4:7], s31 offen offset:1024
  buffer_load_dwordx4 a[208:211], v1, s[4:7], s32 offen offset:1024
  buffer_load_dwordx4 a[212:215], v1, s[4:7], s33 offen offset:1024
  buffer_load_dwordx4 a[216:219], v1, s[4:7], s34 offen offset:1024
  buffer_load_dwordx4 a[220:223], v1, s[4:7], s35 offen offset:1024
  buffer_load_dwordx4 a[224:227], v1, s[4:7], s36 offen offset:1024
  buffer_load_dwordx4 a[228:231], v1, s[4:7], s37 offen offset:1024
  buffer_load_dwordx4 a[232:235], v1, s[4:7], s38 offen offset:1024
  buffer_load_dwordx4 a[236:239], v1, s[4:7], s39 offen offset:1024
  v_mfma_f32_16x16x16_bf16 v[64:67], v[136:137], v[44:45], 0
  v_mfma_f32_16x16x16_bf16 v[68:71], v[136:137], v[48:49], 0
  v_mfma_f32_16x16x16_bf16 v[64:67], v[88:89], v[46:47], v[64:67]
  v_mfma_f32_16x16x32_bf16 v[68:71], v[88:91], v[50:53], v[68:71]
  v_mfma_f32_16x16x16_bf16 v[72:75], v[138:139], v[44:45], 0
  v_mfma_f32_16x16x16_bf16 v[76:79], v[138:139], v[48:49], 0
  v_mfma_f32_16x16x16_bf16 v[72:75], v[92:93], v[46:47], v[72:75]
  v_mfma_f32_16x16x32_bf16 v[76:79], v[92:95], v[50:53], v[76:79]
  s_nop 2
  v_mul_f32 v64, v64, v10
  v_mul_f32 v65, v65, v10
  v_mul_f32 v66, v66, v10
  v_mul_f32 v67, v67, v10
  v_cvt_pk_bf16_f32 v80, v64, v65
  v_cvt_pk_bf16_f32 v81, v66, v67
  v_mul_f32 v72, v72, v10
  v_mul_f32 v73, v73, v10
  v_mul_f32 v74, v74, v10
  v_mul_f32 v75, v75, v10
  v_cvt_pk_bf16_f32 v82, v72, v73
  v_cvt_pk_bf16_f32 v83, v74, v75
  ds_write_b128 v241, v[80:83] offset:0
  v_mul_f32 v68, v68, v11
  v_mul_f32 v69, v69, v11
  v_mul_f32 v70, v70, v11
  v_mul_f32 v71, v71, v11
  v_cvt_pk_bf16_f32 v84, v68, v69
  v_cvt_pk_bf16_f32 v85, v70, v71
  v_mul_f32 v76, v76, v11
  v_mul_f32 v77, v77, v11
  v_mul_f32 v78, v78, v11
  v_mul_f32 v79, v79, v11
  v_cvt_pk_bf16_f32 v86, v76, v77
  v_cvt_pk_bf16_f32 v87, v78, v79
  ds_write_b128 v241, v[84:87] offset:24576
  v_mfma_f32_16x16x16_bf16 v[64:67], v[140:141], v[44:45], 0
  v_mfma_f32_16x16x16_bf16 v[68:71], v[140:141], v[48:49], 0
  v_mfma_f32_16x16x16_bf16 v[64:67], v[96:97], v[46:47], v[64:67]
  v_mfma_f32_16x16x32_bf16 v[68:71], v[96:99], v[50:53], v[68:71]
  v_mfma_f32_16x16x16_bf16 v[72:75], v[142:143], v[44:45], 0
  v_mfma_f32_16x16x16_bf16 v[76:79], v[142:143], v[48:49], 0
  v_mfma_f32_16x16x16_bf16 v[72:75], v[100:101], v[46:47], v[72:75]
  v_mfma_f32_16x16x32_bf16 v[76:79], v[100:103], v[50:53], v[76:79]
  s_nop 2
  v_mul_f32 v64, v64, v10
  v_mul_f32 v65, v65, v10
  v_mul_f32 v66, v66, v10
  v_mul_f32 v67, v67, v10
  v_cvt_pk_bf16_f32 v80, v64, v65
  v_cvt_pk_bf16_f32 v81, v66, v67
  v_mul_f32 v72, v72, v10
  v_mul_f32 v73, v73, v10
  v_mul_f32 v74, v74, v10
  v_mul_f32 v75, v75, v10
  v_cvt_pk_bf16_f32 v82, v72, v73
  v_cvt_pk_bf16_f32 v83, v74, v75
  ds_write_b128 v241, v[80:83] offset:1024
  v_mul_f32 v68, v68, v11
  v_mul_f32 v69, v69, v11
  v_mul_f32 v70, v70, v11
  v_mul_f32 v71, v71, v11
  v_cvt_pk_bf16_f32 v84, v68, v69
  v_cvt_pk_bf16_f32 v85, v70, v71
  v_mul_f32 v76, v76, v11
  v_mul_f32 v77, v77, v11
  v_mul_f32 v78, v78, v11
  v_mul_f32 v79, v79, v11
  v_cvt_pk_bf16_f32 v86, v76, v77
  v_cvt_pk_bf16_f32 v87, v78, v79
  ds_write_b128 v241, v[84:87] offset:25600
  v_mfma_f32_16x16x16_bf16 v[64:67], v[144:145], v[44:45], 0
  v_mfma_f32_16x16x16_bf16 v[68:71], v[144:145], v[48:49], 0
  v_mfma_f32_16x16x16_bf16 v[64:67], v[104:105], v[46:47], v[64:67]
  v_mfma_f32_16x16x32_bf16 v[68:71], v[104:107], v[50:53], v[68:71]
  v_mfma_f32_16x16x16_bf16 v[72:75], v[146:147], v[44:45], 0
  v_mfma_f32_16x16x16_bf16 v[76:79], v[146:147], v[48:49], 0
  v_mfma_f32_16x16x16_bf16 v[72:75], v[108:109], v[46:47], v[72:75]
  v_mfma_f32_16x16x32_bf16 v[76:79], v[108:111], v[50:53], v[76:79]
  s_nop 2
  v_mul_f32 v64, v64, v10
  v_mul_f32 v65, v65, v10
  v_mul_f32 v66, v66, v10
  v_mul_f32 v67, v67, v10
  v_cvt_pk_bf16_f32 v80, v64, v65
  v_cvt_pk_bf16_f32 v81, v66, v67
  v_mul_f32 v72, v72, v10
  v_mul_f32 v73, v73, v10
  v_mul_f32 v74, v74, v10
  v_mul_f32 v75, v75, v10
  v_cvt_pk_bf16_f32 v82, v72, v73
  v_cvt_pk_bf16_f32 v83, v74, v75
  ds_write_b128 v241, v[80:83] offset:2048
  v_mul_f32 v68, v68, v11
  v_mul_f32 v69, v69, v11
  v_mul_f32 v70, v70, v11
  v_mul_f32 v71, v71, v11
  v_cvt_pk_bf16_f32 v84, v68, v69
  v_cvt_pk_bf16_f32 v85, v70, v71
  v_mul_f32 v76, v76, v11
  v_mul_f32 v77, v77, v11
  v_mul_f32 v78, v78, v11
  v_mul_f32 v79, v79, v11
  v_cvt_pk_bf16_f32 v86, v76, v77
  v_cvt_pk_bf16_f32 v87, v78, v79
  ds_write_b128 v241, v[84:87] offset:26624
  v_mfma_f32_16x16x16_bf16 v[64:67], v[148:149], v[44:45], 0
  v_mfma_f32_16x16x16_bf16 v[68:71], v[148:149], v[48:49], 0
  v_mfma_f32_16x16x16_bf16 v[64:67], v[112:113], v[46:47], v[64:67]
  v_mfma_f32_16x16x32_bf16 v[68:71], v[112:115], v[50:53], v[68:71]
  v_mfma_f32_16x16x16_bf16 v[72:75], v[150:151], v[44:45], 0
  v_mfma_f32_16x16x16_bf16 v[76:79], v[150:151], v[48:49], 0
  v_mfma_f32_16x16x16_bf16 v[72:75], v[116:117], v[46:47], v[72:75]
  v_mfma_f32_16x16x32_bf16 v[76:79], v[116:119], v[50:53], v[76:79]
  s_nop 2
  v_mul_f32 v64, v64, v10
  v_mul_f32 v65, v65, v10
  v_mul_f32 v66, v66, v10
  v_mul_f32 v67, v67, v10
  v_cvt_pk_bf16_f32 v80, v64, v65
  v_cvt_pk_bf16_f32 v81, v66, v67
  v_mul_f32 v72, v72, v10
  v_mul_f32 v73, v73, v10
  v_mul_f32 v74, v74, v10
  v_mul_f32 v75, v75, v10
  v_cvt_pk_bf16_f32 v82, v72, v73
  v_cvt_pk_bf16_f32 v83, v74, v75
  ds_write_b128 v241, v[80:83] offset:3072
  v_mul_f32 v68, v68, v11
  v_mul_f32 v69, v69, v11
  v_mul_f32 v70, v70, v11
  v_mul_f32 v71, v71, v11
  v_cvt_pk_bf16_f32 v84, v68, v69
  v_cvt_pk_bf16_f32 v85, v70, v71
  v_mul_f32 v76, v76, v11
  v_mul_f32 v77, v77, v11
  v_mul_f32 v78, v78, v11
  v_mul_f32 v79, v79, v11
  v_cvt_pk_bf16_f32 v86, v76, v77
  v_cvt_pk_bf16_f32 v87, v78, v79
  ds_write_b128 v241, v[84:87] offset:27648
  v_mfma_f32_16x16x16_bf16 v[64:67], v[152:153], v[44:45], 0
  v_mfma_f32_16x16x16_bf16 v[68:71], v[152:153], v[48:49], 0
  v_mfma_f32_16x16x16_bf16 v[64:67], v[120:121], v[46:47], v[64:67]
  v_mfma_f32_16x16x32_bf16 v[68:71], v[120:123], v[50:53], v[68:71]
  v_mfma_f32_16x16x16_bf16 v[72:75], v[154:155], v[44:45], 0
  v_mfma_f32_16x16x16_bf16 v[76:79], v[154:155], v[48:49], 0
  v_mfma_f32_16x16x16_bf16 v[72:75], v[124:125], v[46:47], v[72:75]
  v_mfma_f32_16x16x32_bf16 v[76:79], v[124:127], v[50:53], v[76:79]
  s_nop 2
  v_mul_f32 v64, v64, v10
  v_mul_f32 v65, v65, v10
  v_mul_f32 v66, v66, v10
  v_mul_f32 v67, v67, v10
  v_cvt_pk_bf16_f32 v80, v64, v65
  v_cvt_pk_bf16_f32 v81, v66, v67
  v_mul_f32 v72, v72, v10
  v_mul_f32 v73, v73, v10
  v_mul_f32 v74, v74, v10
  v_mul_f32 v75, v75, v10
  v_cvt_pk_bf16_f32 v82, v72, v73
  v_cvt_pk_bf16_f32 v83, v74, v75
  ds_write_b128 v241, v[80:83] offset:4096
  v_mul_f32 v68, v68, v11
  v_mul_f32 v69, v69, v11
  v_mul_f32 v70, v70, v11
  v_mul_f32 v71, v71, v11
  v_cvt_pk_bf16_f32 v84, v68, v69
  v_cvt_pk_bf16_f32 v85, v70, v71
  v_mul_f32 v76, v76, v11
  v_mul_f32 v77, v77, v11
  v_mul_f32 v78, v78, v11
  v_mul_f32 v79, v79, v11
  v_cvt_pk_bf16_f32 v86, v76, v77
  v_cvt_pk_bf16_f32 v87, v78, v79
  ds_write_b128 v241, v[84:87] offset:28672
  v_mfma_f32_16x16x16_bf16 v[64:67], v[156:157], v[44:45], 0
  v_mfma_f32_16x16x16_bf16 v[68:71], v[156:157], v[48:49], 0
  v_mfma_f32_16x16x16_bf16 v[64:67], v[128:129], v[46:47], v[64:67]
  v_mfma_f32_16x16x32_bf16 v[68:71], v[128:131], v[50:53], v[68:71]
  v_mfma_f32_16x16x16_bf16 v[72:75], v[158:159], v[44:45], 0
  v_mfma_f32_16x16x16_bf16 v[76:79], v[158:159], v[48:49], 0
  v_mfma_f32_16x16x16_bf16 v[72:75], v[132:133], v[46:47], v[72:75]
  v_mfma_f32_16x16x32_bf16 v[76:79], v[132:135], v[50:53], v[76:79]
  s_nop 2
  v_mul_f32 v64, v64, v10
  v_mul_f32 v65, v65, v10
  v_mul_f32 v66, v66, v10
  v_mul_f32 v67, v67, v10
  v_cvt_pk_bf16_f32 v80, v64, v65
  v_cvt_pk_bf16_f32 v81, v66, v67
  v_mul_f32 v72, v72, v10
  v_mul_f32 v73, v73, v10
  v_mul_f32 v74, v74, v10
  v_mul_f32 v75, v75, v10
  v_cvt_pk_bf16_f32 v82, v72, v73
  v_cvt_pk_bf16_f32 v83, v74, v75
  ds_write_b128 v241, v[80:83] offset:5120
  v_mul_f32 v68, v68, v11
  v_mul_f32 v69, v69, v11
  v_mul_f32 v70, v70, v11
  v_mul_f32 v71, v71, v11
  v_cvt_pk_bf16_f32 v84, v68, v69
  v_cvt_pk_bf16_f32 v85, v70, v71
  v_mul_f32 v76, v76, v11
  v_mul_f32 v77, v77, v11
  v_mul_f32 v78, v78, v11
  v_mul_f32 v79, v79, v11
  v_cvt_pk_bf16_f32 v86, v76, v77
  v_cvt_pk_bf16_f32 v87, v78, v79
  ds_write_b128 v241, v[84:87] offset:29696
  s_branch fin_phase22
fin_odma3:
  s_lshl_b32 s16, s14, 2
  s_add_u32 s16, s16, s12
  s_mul_i32 s16, s16, 192
  s_mul_i32 s17, s13, 24
  s_add_u32 s16, s16, s17
  s_lshl_b32 s16, s16, 10
  s_add_u32 s16, s16, 57147392
  s_mul_i32 s17, s12, 24576
  s_add_u32 m0, s17, 0
  s_nop 0
  buffer_load_dwordx4 v1, s[4:7], s16 offen offset:0 lds
  buffer_load_dwordx4 v1, s[4:7], s16 offen offset:1024 lds
  buffer_load_dwordx4 v1, s[4:7], s16 offen offset:2048 lds
  buffer_load_dwordx4 v1, s[4:7], s16 offen offset:3072 lds
  s_add_u32 s16, s16, 4096
  s_add_u32 m0, s17, 4096
  s_nop 0
  buffer_load_dwordx4 v1, s[4:7], s16 offen offset:0 lds
  buffer_load_dwordx4 v1, s[4:7], s16 offen offset:1024 lds
  buffer_load_dwordx4 v1, s[4:7], s16 offen offset:2048 lds
  buffer_load_dwordx4 v1, s[4:7], s16 offen offset:3072 lds
  s_add_u32 s16, s16, 4096
  s_add_u32 m0, s17, 8192
  s_nop 0
  buffer_load_dwordx4 v1, s[4:7], s16 offen offset:0 lds
  buffer_load_dwordx4 v1, s[4:7], s16 offen offset:1024 lds
  buffer_load_dwordx4 v1, s[4:7], s16 offen offset:2048 lds
  buffer_load_dwordx4 v1, s[4:7], s16 offen offset:3072 lds
  s_add_u32 s16, s16, 4096
  s_add_u32 m0, s17, 12288
  s_nop 0
  buffer_load_dwordx4 v1, s[4:7], s16 offen offset:0 lds
  buffer_load_dwordx4 v1, s[4:7], s16 offen offset:1024 lds
  buffer_load_dwordx4 v1, s[4:7], s16 offen offset:2048 lds
  buffer_load_dwordx4 v1, s[4:7], s16 offen offset:3072 lds
  s_add_u32 s16, s16, 4096
  s_add_u32 m0, s17, 16384
  s_nop 0
  buffer_load_dwordx4 v1, s[4:7], s16 offen offset:0 lds
  buffer_load_dwordx4 v1, s[4:7], s16 offen offset:1024 lds
  buffer_load_dwordx4 v1, s[4:7], s16 offen offset:2048 lds
  buffer_load_dwordx4 v1, s[4:7], s16 offen offset:3072 lds
  s_add_u32 s16, s16, 4096
  s_add_u32 m0, s17, 20480
  s_nop 0
  buffer_load_dwordx4 v1, s[4:7], s16 offen offset:0 lds
  buffer_load_dwordx4 v1, s[4:7], s16 offen offset:1024 lds
  buffer_load_dwordx4 v1, s[4:7], s16 offen offset:2048 lds
  buffer_load_dwordx4 v1, s[4:7], s16 offen offset:3072 lds
  s_add_u32 s16, s16, 4096
  buffer_load_dwordx4 a[160:163], v1, s[4:7], s30 offen offset:0
  buffer_load_dwordx4 a[164:167], v1, s[4:7], s31 offen offset:0
  buffer_load_dwordx4 a[168:171], v1, s[4:7], s32 offen offset:0
  buffer_load_dwordx4 a[172:175], v1, s[4:7], s33 offen offset:0
  buffer_load_dwordx4 a[176:179], v1, s[4:7], s34 offen offset:0
  buffer_load_dwordx4 a[180:183], v1, s[4:7], s35 offen offset:0
  buffer_load_dwordx4 a[184:187], v1, s[4:7], s36 offen offset:0
  buffer_load_dwordx4 a[188:191], v1, s[4:7], s37 offen offset:0
  buffer_load_dwordx4 a[192:195], v1, s[4:7], s38 offen offset:0
  buffer_load_dwordx4 a[196:199], v1, s[4:7], s39 offen offset:0
  buffer_load_dwordx4 a[200:203], v1, s[4:7], s30 offen offset:1024
  buffer_load_dwordx4 a[204:207], v1, s[4:7], s31 offen offset:1024
  buffer_load_dwordx4 a[208:211], v1, s[4:7], s32 offen offset:1024
  buffer_load_dwordx4 a[212:215], v1, s[4:7], s33 offen offset:1024
  buffer_load_dwordx4 a[216:219], v1, s[4:7], s34 offen offset:1024
  buffer_load_dwordx4 a[220:223], v1, s[4:7], s35 offen offset:1024
  buffer_load_dwordx4 a[224:227], v1, s[4:7], s36 offen offset:1024
  buffer_load_dwordx4 a[228:231], v1, s[4:7], s37 offen offset:1024
  buffer_load_dwordx4 a[232:235], v1, s[4:7], s38 offen offset:1024
  buffer_load_dwordx4 a[236:239], v1, s[4:7], s39 offen offset:1024
  s_waitcnt vmcnt(20)
fin_phase22:
  s_waitcnt lgkmcnt(0)
  buffer_load_dwordx4 v[104:107], v1, s[4:7], s30 offen offset:2048
  buffer_load_dwordx4 v[108:111], v1, s[4:7], s31 offen offset:2048
  buffer_load_dwordx4 v[112:115], v1, s[4:7], s32 offen offset:2048
  buffer_load_dwordx4 v[116:119], v1, s[4:7], s33 offen offset:2048
  buffer_load_dwordx4 v[120:123], v1, s[4:7], s34 offen offset:2048
  buffer_load_dwordx4 v[124:127], v1, s[4:7], s35 offen offset:2048
  buffer_load_dwordx4 v[128:131], v1, s[4:7], s36 offen offset:2048
  buffer_load_dwordx4 v[132:135], v1, s[4:7], s37 offen offset:2048
  buffer_load_dwordx4 v[136:139], v1, s[4:7], s38 offen offset:2048
  buffer_load_dwordx4 v[140:143], v1, s[4:7], s39 offen offset:2048
  buffer_load_dwordx4 v[144:147], v1, s[4:7], s30 offen offset:3072
  buffer_load_dwordx4 v[148:151], v1, s[4:7], s31 offen offset:3072
  buffer_load_dwordx4 v[152:155], v1, s[4:7], s32 offen offset:3072
  buffer_load_dwordx4 v[156:159], v1, s[4:7], s33 offen offset:3072
  buffer_load_dwordx4 v[160:163], v1, s[4:7], s34 offen offset:3072
  buffer_load_dwordx4 v[164:167], v1, s[4:7], s35 offen offset:3072
  buffer_load_dwordx4 v[168:171], v1, s[4:7], s36 offen offset:3072
  buffer_load_dwordx4 v[172:175], v1, s[4:7], s37 offen offset:3072
  buffer_load_dwordx4 v[176:179], v1, s[4:7], s38 offen offset:3072
  buffer_load_dwordx4 v[180:183], v1, s[4:7], s39 offen offset:3072
  s_add_u32 s30, s30, 4096
  s_add_u32 s31, s31, 4096
  s_add_u32 s32, s32, 4096
  s_add_u32 s33, s33, 4096
  s_add_u32 s34, s34, 4096
  s_add_u32 s35, s35, 4096
  s_add_u32 s36, s36, 4096
  s_add_u32 s37, s37, 4096
  s_add_u32 s38, s38, 4096
  s_add_u32 s39, s39, 4096
  v_add_u32 v6, 49152, v1
  s_barrier
  ds_read_b128 v[184:187], v1 offset:0
  ds_read_b128 v[188:191], v1 offset:24576
  ds_read_b128 v[192:195], v6 offset:0
  ds_read_b128 v[196:199], v6 offset:24576
  s_waitcnt vmcnt(30)
  ds_read_b128 v[200:203], v1 offset:1024
  ds_read_b128 v[204:207], v1 offset:25600
  ds_read_b128 v[208:211], v6 offset:1024
  ds_read_b128 v[212:215], v6 offset:25600
  s_waitcnt lgkmcnt(4)
  v_mfma_f32_16x16x32_bf16 a[0:3], a[160:163], v[184:187], 0
  v_mfma_f32_16x16x32_bf16 a[4:7], a[160:163], v[188:191], 0
  v_mfma_f32_16x16x32_bf16 a[8:11], a[160:163], v[192:195], 0
  v_mfma_f32_16x16x32_bf16 a[12:15], a[160:163], v[196:199], 0
  v_mfma_f32_16x16x32_bf16 a[16:19], a[164:167], v[184:187], 0
  v_mfma_f32_16x16x32_bf16 a[20:23], a[164:167], v[188:191], 0
  v_mfma_f32_16x16x32_bf16 a[24:27], a[164:167], v[192:195], 0
  v_mfma_f32_16x16x32_bf16 a[28:31], a[164:167], v[196:199], 0
  v_mfma_f32_16x16x32_bf16 a[32:35], a[168:171], v[184:187], 0
  v_mfma_f32_16x16x32_bf16 a[36:39], a[168:171], v[188:191], 0
  v_mfma_f32_16x16x32_bf16 a[40:43], a[168:171], v[192:195], 0
  v_mfma_f32_16x16x32_bf16 a[44:47], a[168:171], v[196:199], 0
  v_mfma_f32_16x16x32_bf16 a[48:51], a[172:175], v[184:187], 0
  v_mfma_f32_16x16x32_bf16 a[52:55], a[172:175], v[188:191], 0
  v_mfma_f32_16x16x32_bf16 a[56:59], a[172:175], v[192:195], 0
  v_mfma_f32_16x16x32_bf16 a[60:63], a[172:175], v[196:199], 0
  v_mfma_f32_16x16x32_bf16 a[64:67], a[176:179], v[184:187], 0
  v_mfma_f32_16x16x32_bf16 a[68:71], a[176:179], v[188:191], 0
  v_mfma_f32_16x16x32_bf16 a[72:75], a[176:179], v[192:195], 0
  v_mfma_f32_16x16x32_bf16 a[76:79], a[176:179], v[196:199], 0
  v_mfma_f32_16x16x32_bf16 a[80:83], a[180:183], v[184:187], 0
  v_mfma_f32_16x16x32_bf16 a[84:87], a[180:183], v[188:191], 0
  v_mfma_f32_16x16x32_bf16 a[88:91], a[180:183], v[192:195], 0
  v_mfma_f32_16x16x32_bf16 a[92:95], a[180:183], v[196:199], 0
  v_mfma_f32_16x16x32_bf16 a[96:99], a[184:187], v[184:187], 0
  v_mfma_f32_16x16x32_bf16 a[100:103], a[184:187], v[188:191], 0
  v_mfma_f32_16x16x32_bf16 a[104:107], a[184:187], v[192:195], 0
  v_mfma_f32_16x16x32_bf16 a[108:111], a[184:187], v[196:199], 0
  v_mfma_f32_16x16x32_bf16 a[112:115], a[188:191], v[184:187], 0
  v_mfma_f32_16x16x32_bf16 a[116:119], a[188:191], v[188:191], 0
  v_mfma_f32_16x16x32_bf16 a[120:123], a[188:191], v[192:195], 0
  v_mfma_f32_16x16x32_bf16 a[124:127], a[188:191], v[196:199], 0
  v_mfma_f32_16x16x32_bf16 a[128:131], a[192:195], v[184:187], 0
  v_mfma_f32_16x16x32_bf16 a[132:135], a[192:195], v[188:191], 0
  v_mfma_f32_16x16x32_bf16 a[136:139], a[192:195], v[192:195], 0
  v_mfma_f32_16x16x32_bf16 a[140:143], a[192:195], v[196:199], 0
  v_mfma_f32_16x16x32_bf16 a[144:147], a[196:199], v[184:187], 0
  v_mfma_f32_16x16x32_bf16 a[148:151], a[196:199], v[188:191], 0
  v_mfma_f32_16x16x32_bf16 a[152:155], a[196:199], v[192:195], 0
  v_mfma_f32_16x16x32_bf16 a[156:159], a[196:199], v[196:199], 0
  buffer_load_dwordx4 v[24:27], v1, s[4:7], s30 offen offset:0
  buffer_load_dwordx4 v[28:31], v1, s[4:7], s31 offen offset:0
  buffer_load_dwordx4 v[32:35], v1, s[4:7], s32 offen offset:0
  buffer_load_dwordx4 v[36:39], v1, s[4:7], s33 offen offset:0
  buffer_load_dwordx4 v[40:43], v1, s[4:7], s34 offen offset:0
  buffer_load_dwordx4 v[44:47], v1, s[4:7], s35 offen offset:0
  buffer_load_dwordx4 v[48:51], v1, s[4:7], s36 offen offset:0
  buffer_load_dwordx4 v[52:55], v1, s[4:7], s37 offen offset:0
  buffer_load_dwordx4 v[56:59], v1, s[4:7], s38 offen offset:0
  buffer_load_dwordx4 v[60:63], v1, s[4:7], s39 offen offset:0
  s_waitcnt vmcnt(30)
  ds_read_b128 v[184:187], v1 offset:2048
  ds_read_b128 v[188:191], v1 offset:26624
  ds_read_b128 v[192:195], v6 offset:2048
  ds_read_b128 v[196:199], v6 offset:26624
  s_waitcnt lgkmcnt(4)
  v_mfma_f32_16x16x32_bf16 a[0:3], a[200:203], v[200:203], a[0:3]
  v_mfma_f32_16x16x32_bf16 a[4:7], a[200:203], v[204:207], a[4:7]
  v_mfma_f32_16x16x32_bf16 a[8:11], a[200:203], v[208:211], a[8:11]
  v_mfma_f32_16x16x32_bf16 a[12:15], a[200:203], v[212:215], a[12:15]
  v_mfma_f32_16x16x32_bf16 a[16:19], a[204:207], v[200:203], a[16:19]
  v_mfma_f32_16x16x32_bf16 a[20:23], a[204:207], v[204:207], a[20:23]
  v_mfma_f32_16x16x32_bf16 a[24:27], a[204:207], v[208:211], a[24:27]
  v_mfma_f32_16x16x32_bf16 a[28:31], a[204:207], v[212:215], a[28:31]
  v_mfma_f32_16x16x32_bf16 a[32:35], a[208:211], v[200:203], a[32:35]
  v_mfma_f32_16x16x32_bf16 a[36:39], a[208:211], v[204:207], a[36:39]
  v_mfma_f32_16x16x32_bf16 a[40:43], a[208:211], v[208:211], a[40:43]
  v_mfma_f32_16x16x32_bf16 a[44:47], a[208:211], v[212:215], a[44:47]
  v_mfma_f32_16x16x32_bf16 a[48:51], a[212:215], v[200:203], a[48:51]
  v_mfma_f32_16x16x32_bf16 a[52:55], a[212:215], v[204:207], a[52:55]
  v_mfma_f32_16x16x32_bf16 a[56:59], a[212:215], v[208:211], a[56:59]
  v_mfma_f32_16x16x32_bf16 a[60:63], a[212:215], v[212:215], a[60:63]
  v_mfma_f32_16x16x32_bf16 a[64:67], a[216:219], v[200:203], a[64:67]
  v_mfma_f32_16x16x32_bf16 a[68:71], a[216:219], v[204:207], a[68:71]
  v_mfma_f32_16x16x32_bf16 a[72:75], a[216:219], v[208:211], a[72:75]
  v_mfma_f32_16x16x32_bf16 a[76:79], a[216:219], v[212:215], a[76:79]
  v_mfma_f32_16x16x32_bf16 a[80:83], a[220:223], v[200:203], a[80:83]
  v_mfma_f32_16x16x32_bf16 a[84:87], a[220:223], v[204:207], a[84:87]
  v_mfma_f32_16x16x32_bf16 a[88:91], a[220:223], v[208:211], a[88:91]
  v_mfma_f32_16x16x32_bf16 a[92:95], a[220:223], v[212:215], a[92:95]
  v_mfma_f32_16x16x32_bf16 a[96:99], a[224:227], v[200:203], a[96:99]
  v_mfma_f32_16x16x32_bf16 a[100:103], a[224:227], v[204:207], a[100:103]
  v_mfma_f32_16x16x32_bf16 a[104:107], a[224:227], v[208:211], a[104:107]
  v_mfma_f32_16x16x32_bf16 a[108:111], a[224:227], v[212:215], a[108:111]
  v_mfma_f32_16x16x32_bf16 a[112:115], a[228:231], v[200:203], a[112:115]
  v_mfma_f32_16x16x32_bf16 a[116:119], a[228:231], v[204:207], a[116:119]
  v_mfma_f32_16x16x32_bf16 a[120:123], a[228:231], v[208:211], a[120:123]
  v_mfma_f32_16x16x32_bf16 a[124:127], a[228:231], v[212:215], a[124:127]
  v_mfma_f32_16x16x32_bf16 a[128:131], a[232:235], v[200:203], a[128:131]
  v_mfma_f32_16x16x32_bf16 a[132:135], a[232:235], v[204:207], a[132:135]
  v_mfma_f32_16x16x32_bf16 a[136:139], a[232:235], v[208:211], a[136:139]
  v_mfma_f32_16x16x32_bf16 a[140:143], a[232:235], v[212:215], a[140:143]
  v_mfma_f32_16x16x32_bf16 a[144:147], a[236:239], v[200:203], a[144:147]
  v_mfma_f32_16x16x32_bf16 a[148:151], a[236:239], v[204:207], a[148:151]
  v_mfma_f32_16x16x32_bf16 a[152:155], a[236:239], v[208:211], a[152:155]
  v_mfma_f32_16x16x32_bf16 a[156:159], a[236:239], v[212:215], a[156:159]
  buffer_load_dwordx4 v[64:67], v1, s[4:7], s30 offen offset:1024
  buffer_load_dwordx4 v[68:71], v1, s[4:7], s31 offen offset:1024
  buffer_load_dwordx4 v[72:75], v1, s[4:7], s32 offen offset:1024
  buffer_load_dwordx4 v[76:79], v1, s[4:7], s33 offen offset:1024
  buffer_load_dwordx4 v[80:83], v1, s[4:7], s34 offen offset:1024
  buffer_load_dwordx4 v[84:87], v1, s[4:7], s35 offen offset:1024
  buffer_load_dwordx4 v[88:91], v1, s[4:7], s36 offen offset:1024
  buffer_load_dwordx4 v[92:95], v1, s[4:7], s37 offen offset:1024
  buffer_load_dwordx4 v[96:99], v1, s[4:7], s38 offen offset:1024
  buffer_load_dwordx4 v[100:103], v1, s[4:7], s39 offen offset:1024
  s_waitcnt vmcnt(30)
  ds_read_b128 v[200:203], v1 offset:3072
  ds_read_b128 v[204:207], v1 offset:27648
  ds_read_b128 v[208:211], v6 offset:3072
  ds_read_b128 v[212:215], v6 offset:27648
  s_waitcnt lgkmcnt(4)
  v_mfma_f32_16x16x32_bf16 a[0:3], v[104:107], v[184:187], a[0:3]
  v_mfma_f32_16x16x32_bf16 a[4:7], v[104:107], v[188:191], a[4:7]
  v_mfma_f32_16x16x32_bf16 a[8:11], v[104:107], v[192:195], a[8:11]
  v_mfma_f32_16x16x32_bf16 a[12:15], v[104:107], v[196:199], a[12:15]
  v_mfma_f32_16x16x32_bf16 a[16:19], v[108:111], v[184:187], a[16:19]
  v_mfma_f32_16x16x32_bf16 a[20:23], v[108:111], v[188:191], a[20:23]
  v_mfma_f32_16x16x32_bf16 a[24:27], v[108:111], v[192:195], a[24:27]
  v_mfma_f32_16x16x32_bf16 a[28:31], v[108:111], v[196:199], a[28:31]
  v_mfma_f32_16x16x32_bf16 a[32:35], v[112:115], v[184:187], a[32:35]
  v_mfma_f32_16x16x32_bf16 a[36:39], v[112:115], v[188:191], a[36:39]
  v_mfma_f32_16x16x32_bf16 a[40:43], v[112:115], v[192:195], a[40:43]
  v_mfma_f32_16x16x32_bf16 a[44:47], v[112:115], v[196:199], a[44:47]
  v_mfma_f32_16x16x32_bf16 a[48:51], v[116:119], v[184:187], a[48:51]
  v_mfma_f32_16x16x32_bf16 a[52:55], v[116:119], v[188:191], a[52:55]
  v_mfma_f32_16x16x32_bf16 a[56:59], v[116:119], v[192:195], a[56:59]
  v_mfma_f32_16x16x32_bf16 a[60:63], v[116:119], v[196:199], a[60:63]
  v_mfma_f32_16x16x32_bf16 a[64:67], v[120:123], v[184:187], a[64:67]
  v_mfma_f32_16x16x32_bf16 a[68:71], v[120:123], v[188:191], a[68:71]
  v_mfma_f32_16x16x32_bf16 a[72:75], v[120:123], v[192:195], a[72:75]
  v_mfma_f32_16x16x32_bf16 a[76:79], v[120:123], v[196:199], a[76:79]
  v_mfma_f32_16x16x32_bf16 a[80:83], v[124:127], v[184:187], a[80:83]
  v_mfma_f32_16x16x32_bf16 a[84:87], v[124:127], v[188:191], a[84:87]
  v_mfma_f32_16x16x32_bf16 a[88:91], v[124:127], v[192:195], a[88:91]
  v_mfma_f32_16x16x32_bf16 a[92:95], v[124:127], v[196:199], a[92:95]
  v_mfma_f32_16x16x32_bf16 a[96:99], v[128:131], v[184:187], a[96:99]
  v_mfma_f32_16x16x32_bf16 a[100:103], v[128:131], v[188:191], a[100:103]
  v_mfma_f32_16x16x32_bf16 a[104:107], v[128:131], v[192:195], a[104:107]
  v_mfma_f32_16x16x32_bf16 a[108:111], v[128:131], v[196:199], a[108:111]
  v_mfma_f32_16x16x32_bf16 a[112:115], v[132:135], v[184:187], a[112:115]
  v_mfma_f32_16x16x32_bf16 a[116:119], v[132:135], v[188:191], a[116:119]
  v_mfma_f32_16x16x32_bf16 a[120:123], v[132:135], v[192:195], a[120:123]
  v_mfma_f32_16x16x32_bf16 a[124:127], v[132:135], v[196:199], a[124:127]
  v_mfma_f32_16x16x32_bf16 a[128:131], v[136:139], v[184:187], a[128:131]
  v_mfma_f32_16x16x32_bf16 a[132:135], v[136:139], v[188:191], a[132:135]
  v_mfma_f32_16x16x32_bf16 a[136:139], v[136:139], v[192:195], a[136:139]
  v_mfma_f32_16x16x32_bf16 a[140:143], v[136:139], v[196:199], a[140:143]
  v_mfma_f32_16x16x32_bf16 a[144:147], v[140:143], v[184:187], a[144:147]
  v_mfma_f32_16x16x32_bf16 a[148:151], v[140:143], v[188:191], a[148:151]
  v_mfma_f32_16x16x32_bf16 a[152:155], v[140:143], v[192:195], a[152:155]
  v_mfma_f32_16x16x32_bf16 a[156:159], v[140:143], v[196:199], a[156:159]
  buffer_load_dwordx4 v[104:107], v1, s[4:7], s30 offen offset:2048
  buffer_load_dwordx4 v[108:111], v1, s[4:7], s31 offen offset:2048
  buffer_load_dwordx4 v[112:115], v1, s[4:7], s32 offen offset:2048
  buffer_load_dwordx4 v[116:119], v1, s[4:7], s33 offen offset:2048
  buffer_load_dwordx4 v[120:123], v1, s[4:7], s34 offen offset:2048
  buffer_load_dwordx4 v[124:127], v1, s[4:7], s35 offen offset:2048
  buffer_load_dwordx4 v[128:131], v1, s[4:7], s36 offen offset:2048
  buffer_load_dwordx4 v[132:135], v1, s[4:7], s37 offen offset:2048
  buffer_load_dwordx4 v[136:139], v1, s[4:7], s38 offen offset:2048
  buffer_load_dwordx4 v[140:143], v1, s[4:7], s39 offen offset:2048
  s_waitcnt vmcnt(30)
  ds_read_b128 v[184:187], v1 offset:4096
  ds_read_b128 v[188:191], v1 offset:28672
  ds_read_b128 v[192:195], v6 offset:4096
  ds_read_b128 v[196:199], v6 offset:28672
  s_waitcnt lgkmcnt(4)
  v_mfma_f32_16x16x32_bf16 a[0:3], v[144:147], v[200:203], a[0:3]
  v_mfma_f32_16x16x32_bf16 a[4:7], v[144:147], v[204:207], a[4:7]
  v_mfma_f32_16x16x32_bf16 a[8:11], v[144:147], v[208:211], a[8:11]
  v_mfma_f32_16x16x32_bf16 a[12:15], v[144:147], v[212:215], a[12:15]
  v_mfma_f32_16x16x32_bf16 a[16:19], v[148:151], v[200:203], a[16:19]
  v_mfma_f32_16x16x32_bf16 a[20:23], v[148:151], v[204:207], a[20:23]
  v_mfma_f32_16x16x32_bf16 a[24:27], v[148:151], v[208:211], a[24:27]
  v_mfma_f32_16x16x32_bf16 a[28:31], v[148:151], v[212:215], a[28:31]
  v_mfma_f32_16x16x32_bf16 a[32:35], v[152:155], v[200:203], a[32:35]
  v_mfma_f32_16x16x32_bf16 a[36:39], v[152:155], v[204:207], a[36:39]
  v_mfma_f32_16x16x32_bf16 a[40:43], v[152:155], v[208:211], a[40:43]
  v_mfma_f32_16x16x32_bf16 a[44:47], v[152:155], v[212:215], a[44:47]
  v_mfma_f32_16x16x32_bf16 a[48:51], v[156:159], v[200:203], a[48:51]
  v_mfma_f32_16x16x32_bf16 a[52:55], v[156:159], v[204:207], a[52:55]
  v_mfma_f32_16x16x32_bf16 a[56:59], v[156:159], v[208:211], a[56:59]
  v_mfma_f32_16x16x32_bf16 a[60:63], v[156:159], v[212:215], a[60:63]
  v_mfma_f32_16x16x32_bf16 a[64:67], v[160:163], v[200:203], a[64:67]
  v_mfma_f32_16x16x32_bf16 a[68:71], v[160:163], v[204:207], a[68:71]
  v_mfma_f32_16x16x32_bf16 a[72:75], v[160:163], v[208:211], a[72:75]
  v_mfma_f32_16x16x32_bf16 a[76:79], v[160:163], v[212:215], a[76:79]
  v_mfma_f32_16x16x32_bf16 a[80:83], v[164:167], v[200:203], a[80:83]
  v_mfma_f32_16x16x32_bf16 a[84:87], v[164:167], v[204:207], a[84:87]
  v_mfma_f32_16x16x32_bf16 a[88:91], v[164:167], v[208:211], a[88:91]
  v_mfma_f32_16x16x32_bf16 a[92:95], v[164:167], v[212:215], a[92:95]
  v_mfma_f32_16x16x32_bf16 a[96:99], v[168:171], v[200:203], a[96:99]
  v_mfma_f32_16x16x32_bf16 a[100:103], v[168:171], v[204:207], a[100:103]
  v_mfma_f32_16x16x32_bf16 a[104:107], v[168:171], v[208:211], a[104:107]
  v_mfma_f32_16x16x32_bf16 a[108:111], v[168:171], v[212:215], a[108:111]
  v_mfma_f32_16x16x32_bf16 a[112:115], v[172:175], v[200:203], a[112:115]
  v_mfma_f32_16x16x32_bf16 a[116:119], v[172:175], v[204:207], a[116:119]
  v_mfma_f32_16x16x32_bf16 a[120:123], v[172:175], v[208:211], a[120:123]
  v_mfma_f32_16x16x32_bf16 a[124:127], v[172:175], v[212:215], a[124:127]
  v_mfma_f32_16x16x32_bf16 a[128:131], v[176:179], v[200:203], a[128:131]
  v_mfma_f32_16x16x32_bf16 a[132:135], v[176:179], v[204:207], a[132:135]
  v_mfma_f32_16x16x32_bf16 a[136:139], v[176:179], v[208:211], a[136:139]
  v_mfma_f32_16x16x32_bf16 a[140:143], v[176:179], v[212:215], a[140:143]
  v_mfma_f32_16x16x32_bf16 a[144:147], v[180:183], v[200:203], a[144:147]
  v_mfma_f32_16x16x32_bf16 a[148:151], v[180:183], v[204:207], a[148:151]
  v_mfma_f32_16x16x32_bf16 a[152:155], v[180:183], v[208:211], a[152:155]
  v_mfma_f32_16x16x32_bf16 a[156:159], v[180:183], v[212:215], a[156:159]
  buffer_load_dwordx4 v[144:147], v1, s[4:7], s30 offen offset:3072
  buffer_load_dwordx4 v[148:151], v1, s[4:7], s31 offen offset:3072
  buffer_load_dwordx4 v[152:155], v1, s[4:7], s32 offen offset:3072
  buffer_load_dwordx4 v[156:159], v1, s[4:7], s33 offen offset:3072
  buffer_load_dwordx4 v[160:163], v1, s[4:7], s34 offen offset:3072
  buffer_load_dwordx4 v[164:167], v1, s[4:7], s35 offen offset:3072
  buffer_load_dwordx4 v[168:171], v1, s[4:7], s36 offen offset:3072
  buffer_load_dwordx4 v[172:175], v1, s[4:7], s37 offen offset:3072
  buffer_load_dwordx4 v[176:179], v1, s[4:7], s38 offen offset:3072
  buffer_load_dwordx4 v[180:183], v1, s[4:7], s39 offen offset:3072
  s_add_u32 s30, s30, 4096
  s_add_u32 s31, s31, 4096
  s_add_u32 s32, s32, 4096
  s_add_u32 s33, s33, 4096
  s_add_u32 s34, s34, 4096
  s_add_u32 s35, s35, 4096
  s_add_u32 s36, s36, 4096
  s_add_u32 s37, s37, 4096
  s_add_u32 s38, s38, 4096
  s_add_u32 s39, s39, 4096
  s_waitcnt vmcnt(30)
  ds_read_b128 v[200:203], v1 offset:5120
  ds_read_b128 v[204:207], v1 offset:29696
  ds_read_b128 v[208:211], v6 offset:5120
  ds_read_b128 v[212:215], v6 offset:29696
  s_waitcnt lgkmcnt(4)
  v_mfma_f32_16x16x32_bf16 a[0:3], v[24:27], v[184:187], a[0:3]
  v_mfma_f32_16x16x32_bf16 a[4:7], v[24:27], v[188:191], a[4:7]
  v_mfma_f32_16x16x32_bf16 a[8:11], v[24:27], v[192:195], a[8:11]
  v_mfma_f32_16x16x32_bf16 a[12:15], v[24:27], v[196:199], a[12:15]
  v_mfma_f32_16x16x32_bf16 a[16:19], v[28:31], v[184:187], a[16:19]
  v_mfma_f32_16x16x32_bf16 a[20:23], v[28:31], v[188:191], a[20:23]
  v_mfma_f32_16x16x32_bf16 a[24:27], v[28:31], v[192:195], a[24:27]
  v_mfma_f32_16x16x32_bf16 a[28:31], v[28:31], v[196:199], a[28:31]
  v_mfma_f32_16x16x32_bf16 a[32:35], v[32:35], v[184:187], a[32:35]
  v_mfma_f32_16x16x32_bf16 a[36:39], v[32:35], v[188:191], a[36:39]
  v_mfma_f32_16x16x32_bf16 a[40:43], v[32:35], v[192:195], a[40:43]
  v_mfma_f32_16x16x32_bf16 a[44:47], v[32:35], v[196:199], a[44:47]
  v_mfma_f32_16x16x32_bf16 a[48:51], v[36:39], v[184:187], a[48:51]
  v_mfma_f32_16x16x32_bf16 a[52:55], v[36:39], v[188:191], a[52:55]
  v_mfma_f32_16x16x32_bf16 a[56:59], v[36:39], v[192:195], a[56:59]
  v_mfma_f32_16x16x32_bf16 a[60:63], v[36:39], v[196:199], a[60:63]
  v_mfma_f32_16x16x32_bf16 a[64:67], v[40:43], v[184:187], a[64:67]
  v_mfma_f32_16x16x32_bf16 a[68:71], v[40:43], v[188:191], a[68:71]
  v_mfma_f32_16x16x32_bf16 a[72:75], v[40:43], v[192:195], a[72:75]
  v_mfma_f32_16x16x32_bf16 a[76:79], v[40:43], v[196:199], a[76:79]
  v_mfma_f32_16x16x32_bf16 a[80:83], v[44:47], v[184:187], a[80:83]
  v_mfma_f32_16x16x32_bf16 a[84:87], v[44:47], v[188:191], a[84:87]
  v_mfma_f32_16x16x32_bf16 a[88:91], v[44:47], v[192:195], a[88:91]
  v_mfma_f32_16x16x32_bf16 a[92:95], v[44:47], v[196:199], a[92:95]
  v_mfma_f32_16x16x32_bf16 a[96:99], v[48:51], v[184:187], a[96:99]
  v_mfma_f32_16x16x32_bf16 a[100:103], v[48:51], v[188:191], a[100:103]
  v_mfma_f32_16x16x32_bf16 a[104:107], v[48:51], v[192:195], a[104:107]
  v_mfma_f32_16x16x32_bf16 a[108:111], v[48:51], v[196:199], a[108:111]
  v_mfma_f32_16x16x32_bf16 a[112:115], v[52:55], v[184:187], a[112:115]
  v_mfma_f32_16x16x32_bf16 a[116:119], v[52:55], v[188:191], a[116:119]
  v_mfma_f32_16x16x32_bf16 a[120:123], v[52:55], v[192:195], a[120:123]
  v_mfma_f32_16x16x32_bf16 a[124:127], v[52:55], v[196:199], a[124:127]
  v_mfma_f32_16x16x32_bf16 a[128:131], v[56:59], v[184:187], a[128:131]
  v_mfma_f32_16x16x32_bf16 a[132:135], v[56:59], v[188:191], a[132:135]
  v_mfma_f32_16x16x32_bf16 a[136:139], v[56:59], v[192:195], a[136:139]
  v_mfma_f32_16x16x32_bf16 a[140:143], v[56:59], v[196:199], a[140:143]
  v_mfma_f32_16x16x32_bf16 a[144:147], v[60:63], v[184:187], a[144:147]
  v_mfma_f32_16x16x32_bf16 a[148:151], v[60:63], v[188:191], a[148:151]
  v_mfma_f32_16x16x32_bf16 a[152:155], v[60:63], v[192:195], a[152:155]
  v_mfma_f32_16x16x32_bf16 a[156:159], v[60:63], v[196:199], a[156:159]
  buffer_load_dwordx4 v[24:27], v1, s[4:7], s30 offen offset:0
  buffer_load_dwordx4 v[28:31], v1, s[4:7], s31 offen offset:0
  buffer_load_dwordx4 v[32:35], v1, s[4:7], s32 offen offset:0
  buffer_load_dwordx4 v[36:39], v1, s[4:7], s33 offen offset:0
  buffer_load_dwordx4 v[40:43], v1, s[4:7], s34 offen offset:0
  buffer_load_dwordx4 v[44:47], v1, s[4:7], s35 offen offset:0
  buffer_load_dwordx4 v[48:51], v1, s[4:7], s36 offen offset:0
  buffer_load_dwordx4 v[52:55], v1, s[4:7], s37 offen offset:0
  buffer_load_dwordx4 v[56:59], v1, s[4:7], s38 offen offset:0
  buffer_load_dwordx4 v[60:63], v1, s[4:7], s39 offen offset:0
  s_waitcnt vmcnt(30)
  ds_read_b128 v[184:187], v1 offset:6144
  ds_read_b128 v[188:191], v1 offset:30720
  ds_read_b128 v[192:195], v6 offset:6144
  ds_read_b128 v[196:199], v6 offset:30720
  s_waitcnt lgkmcnt(4)
  v_mfma_f32_16x16x32_bf16 a[0:3], v[64:67], v[200:203], a[0:3]
  v_mfma_f32_16x16x32_bf16 a[4:7], v[64:67], v[204:207], a[4:7]
  v_mfma_f32_16x16x32_bf16 a[8:11], v[64:67], v[208:211], a[8:11]
  v_mfma_f32_16x16x32_bf16 a[12:15], v[64:67], v[212:215], a[12:15]
  v_mfma_f32_16x16x32_bf16 a[16:19], v[68:71], v[200:203], a[16:19]
  v_mfma_f32_16x16x32_bf16 a[20:23], v[68:71], v[204:207], a[20:23]
  v_mfma_f32_16x16x32_bf16 a[24:27], v[68:71], v[208:211], a[24:27]
  v_mfma_f32_16x16x32_bf16 a[28:31], v[68:71], v[212:215], a[28:31]
  v_mfma_f32_16x16x32_bf16 a[32:35], v[72:75], v[200:203], a[32:35]
  v_mfma_f32_16x16x32_bf16 a[36:39], v[72:75], v[204:207], a[36:39]
  v_mfma_f32_16x16x32_bf16 a[40:43], v[72:75], v[208:211], a[40:43]
  v_mfma_f32_16x16x32_bf16 a[44:47], v[72:75], v[212:215], a[44:47]
  v_mfma_f32_16x16x32_bf16 a[48:51], v[76:79], v[200:203], a[48:51]
  v_mfma_f32_16x16x32_bf16 a[52:55], v[76:79], v[204:207], a[52:55]
  v_mfma_f32_16x16x32_bf16 a[56:59], v[76:79], v[208:211], a[56:59]
  v_mfma_f32_16x16x32_bf16 a[60:63], v[76:79], v[212:215], a[60:63]
  v_mfma_f32_16x16x32_bf16 a[64:67], v[80:83], v[200:203], a[64:67]
  v_mfma_f32_16x16x32_bf16 a[68:71], v[80:83], v[204:207], a[68:71]
  v_mfma_f32_16x16x32_bf16 a[72:75], v[80:83], v[208:211], a[72:75]
  v_mfma_f32_16x16x32_bf16 a[76:79], v[80:83], v[212:215], a[76:79]
  v_mfma_f32_16x16x32_bf16 a[80:83], v[84:87], v[200:203], a[80:83]
  v_mfma_f32_16x16x32_bf16 a[84:87], v[84:87], v[204:207], a[84:87]
  v_mfma_f32_16x16x32_bf16 a[88:91], v[84:87], v[208:211], a[88:91]
  v_mfma_f32_16x16x32_bf16 a[92:95], v[84:87], v[212:215], a[92:95]
  v_mfma_f32_16x16x32_bf16 a[96:99], v[88:91], v[200:203], a[96:99]
  v_mfma_f32_16x16x32_bf16 a[100:103], v[88:91], v[204:207], a[100:103]
  v_mfma_f32_16x16x32_bf16 a[104:107], v[88:91], v[208:211], a[104:107]
  v_mfma_f32_16x16x32_bf16 a[108:111], v[88:91], v[212:215], a[108:111]
  v_mfma_f32_16x16x32_bf16 a[112:115], v[92:95], v[200:203], a[112:115]
  v_mfma_f32_16x16x32_bf16 a[116:119], v[92:95], v[204:207], a[116:119]
  v_mfma_f32_16x16x32_bf16 a[120:123], v[92:95], v[208:211], a[120:123]
  v_mfma_f32_16x16x32_bf16 a[124:127], v[92:95], v[212:215], a[124:127]
  v_mfma_f32_16x16x32_bf16 a[128:131], v[96:99], v[200:203], a[128:131]
  v_mfma_f32_16x16x32_bf16 a[132:135], v[96:99], v[204:207], a[132:135]
  v_mfma_f32_16x16x32_bf16 a[136:139], v[96:99], v[208:211], a[136:139]
  v_mfma_f32_16x16x32_bf16 a[140:143], v[96:99], v[212:215], a[140:143]
  v_mfma_f32_16x16x32_bf16 a[144:147], v[100:103], v[200:203], a[144:147]
  v_mfma_f32_16x16x32_bf16 a[148:151], v[100:103], v[204:207], a[148:151]
  v_mfma_f32_16x16x32_bf16 a[152:155], v[100:103], v[208:211], a[152:155]
  v_mfma_f32_16x16x32_bf16 a[156:159], v[100:103], v[212:215], a[156:159]
  buffer_load_dwordx4 v[64:67], v1, s[4:7], s30 offen offset:1024
  buffer_load_dwordx4 v[68:71], v1, s[4:7], s31 offen offset:1024
  buffer_load_dwordx4 v[72:75], v1, s[4:7], s32 offen offset:1024
  buffer_load_dwordx4 v[76:79], v1, s[4:7], s33 offen offset:1024
  buffer_load_dwordx4 v[80:83], v1, s[4:7], s34 offen offset:1024
  buffer_load_dwordx4 v[84:87], v1, s[4:7], s35 offen offset:1024
  buffer_load_dwordx4 v[88:91], v1, s[4:7], s36 offen offset:1024
  buffer_load_dwordx4 v[92:95], v1, s[4:7], s37 offen offset:1024
  buffer_load_dwordx4 v[96:99], v1, s[4:7], s38 offen offset:1024
  buffer_load_dwordx4 v[100:103], v1, s[4:7], s39 offen offset:1024
  s_waitcnt vmcnt(30)
  ds_read_b128 v[200:203], v1 offset:7168
  ds_read_b128 v[204:207], v1 offset:31744
  ds_read_b128 v[208:211], v6 offset:7168
  ds_read_b128 v[212:215], v6 offset:31744
  s_waitcnt lgkmcnt(4)
  v_mfma_f32_16x16x32_bf16 a[0:3], v[104:107], v[184:187], a[0:3]
  v_mfma_f32_16x16x32_bf16 a[4:7], v[104:107], v[188:191], a[4:7]
  v_mfma_f32_16x16x32_bf16 a[8:11], v[104:107], v[192:195], a[8:11]
  v_mfma_f32_16x16x32_bf16 a[12:15], v[104:107], v[196:199], a[12:15]
  v_mfma_f32_16x16x32_bf16 a[16:19], v[108:111], v[184:187], a[16:19]
  v_mfma_f32_16x16x32_bf16 a[20:23], v[108:111], v[188:191], a[20:23]
  v_mfma_f32_16x16x32_bf16 a[24:27], v[108:111], v[192:195], a[24:27]
  v_mfma_f32_16x16x32_bf16 a[28:31], v[108:111], v[196:199], a[28:31]
  v_mfma_f32_16x16x32_bf16 a[32:35], v[112:115], v[184:187], a[32:35]
  v_mfma_f32_16x16x32_bf16 a[36:39], v[112:115], v[188:191], a[36:39]
  v_mfma_f32_16x16x32_bf16 a[40:43], v[112:115], v[192:195], a[40:43]
  v_mfma_f32_16x16x32_bf16 a[44:47], v[112:115], v[196:199], a[44:47]
  v_mfma_f32_16x16x32_bf16 a[48:51], v[116:119], v[184:187], a[48:51]
  v_mfma_f32_16x16x32_bf16 a[52:55], v[116:119], v[188:191], a[52:55]
  v_mfma_f32_16x16x32_bf16 a[56:59], v[116:119], v[192:195], a[56:59]
  v_mfma_f32_16x16x32_bf16 a[60:63], v[116:119], v[196:199], a[60:63]
  v_mfma_f32_16x16x32_bf16 a[64:67], v[120:123], v[184:187], a[64:67]
  v_mfma_f32_16x16x32_bf16 a[68:71], v[120:123], v[188:191], a[68:71]
  v_mfma_f32_16x16x32_bf16 a[72:75], v[120:123], v[192:195], a[72:75]
  v_mfma_f32_16x16x32_bf16 a[76:79], v[120:123], v[196:199], a[76:79]
  v_mfma_f32_16x16x32_bf16 a[80:83], v[124:127], v[184:187], a[80:83]
  v_mfma_f32_16x16x32_bf16 a[84:87], v[124:127], v[188:191], a[84:87]
  v_mfma_f32_16x16x32_bf16 a[88:91], v[124:127], v[192:195], a[88:91]
  v_mfma_f32_16x16x32_bf16 a[92:95], v[124:127], v[196:199], a[92:95]
  v_mfma_f32_16x16x32_bf16 a[96:99], v[128:131], v[184:187], a[96:99]
  v_mfma_f32_16x16x32_bf16 a[100:103], v[128:131], v[188:191], a[100:103]
  v_mfma_f32_16x16x32_bf16 a[104:107], v[128:131], v[192:195], a[104:107]
  v_mfma_f32_16x16x32_bf16 a[108:111], v[128:131], v[196:199], a[108:111]
  v_mfma_f32_16x16x32_bf16 a[112:115], v[132:135], v[184:187], a[112:115]
  v_mfma_f32_16x16x32_bf16 a[116:119], v[132:135], v[188:191], a[116:119]
  v_mfma_f32_16x16x32_bf16 a[120:123], v[132:135], v[192:195], a[120:123]
  v_mfma_f32_16x16x32_bf16 a[124:127], v[132:135], v[196:199], a[124:127]
  v_mfma_f32_16x16x32_bf16 a[128:131], v[136:139], v[184:187], a[128:131]
  v_mfma_f32_16x16x32_bf16 a[132:135], v[136:139], v[188:191], a[132:135]
  v_mfma_f32_16x16x32_bf16 a[136:139], v[136:139], v[192:195], a[136:139]
  v_mfma_f32_16x16x32_bf16 a[140:143], v[136:139], v[196:199], a[140:143]
  v_mfma_f32_16x16x32_bf16 a[144:147], v[140:143], v[184:187], a[144:147]
  v_mfma_f32_16x16x32_bf16 a[148:151], v[140:143], v[188:191], a[148:151]
  v_mfma_f32_16x16x32_bf16 a[152:155], v[140:143], v[192:195], a[152:155]
  v_mfma_f32_16x16x32_bf16 a[156:159], v[140:143], v[196:199], a[156:159]
  buffer_load_dwordx4 v[104:107], v1, s[4:7], s30 offen offset:2048
  buffer_load_dwordx4 v[108:111], v1, s[4:7], s31 offen offset:2048
  buffer_load_dwordx4 v[112:115], v1, s[4:7], s32 offen offset:2048
  buffer_load_dwordx4 v[116:119], v1, s[4:7], s33 offen offset:2048
  buffer_load_dwordx4 v[120:123], v1, s[4:7], s34 offen offset:2048
  buffer_load_dwordx4 v[124:127], v1, s[4:7], s35 offen offset:2048
  buffer_load_dwordx4 v[128:131], v1, s[4:7], s36 offen offset:2048
  buffer_load_dwordx4 v[132:135], v1, s[4:7], s37 offen offset:2048
  buffer_load_dwordx4 v[136:139], v1, s[4:7], s38 offen offset:2048
  buffer_load_dwordx4 v[140:143], v1, s[4:7], s39 offen offset:2048
  s_waitcnt vmcnt(30)
  ds_read_b128 v[184:187], v1 offset:8192
  ds_read_b128 v[188:191], v1 offset:32768
  ds_read_b128 v[192:195], v6 offset:8192
  ds_read_b128 v[196:199], v6 offset:32768
  s_waitcnt lgkmcnt(4)
  v_mfma_f32_16x16x32_bf16 a[0:3], v[144:147], v[200:203], a[0:3]
  v_mfma_f32_16x16x32_bf16 a[4:7], v[144:147], v[204:207], a[4:7]
  v_mfma_f32_16x16x32_bf16 a[8:11], v[144:147], v[208:211], a[8:11]
  v_mfma_f32_16x16x32_bf16 a[12:15], v[144:147], v[212:215], a[12:15]
  v_mfma_f32_16x16x32_bf16 a[16:19], v[148:151], v[200:203], a[16:19]
  v_mfma_f32_16x16x32_bf16 a[20:23], v[148:151], v[204:207], a[20:23]
  v_mfma_f32_16x16x32_bf16 a[24:27], v[148:151], v[208:211], a[24:27]
  v_mfma_f32_16x16x32_bf16 a[28:31], v[148:151], v[212:215], a[28:31]
  v_mfma_f32_16x16x32_bf16 a[32:35], v[152:155], v[200:203], a[32:35]
  v_mfma_f32_16x16x32_bf16 a[36:39], v[152:155], v[204:207], a[36:39]
  v_mfma_f32_16x16x32_bf16 a[40:43], v[152:155], v[208:211], a[40:43]
  v_mfma_f32_16x16x32_bf16 a[44:47], v[152:155], v[212:215], a[44:47]
  v_mfma_f32_16x16x32_bf16 a[48:51], v[156:159], v[200:203], a[48:51]
  v_mfma_f32_16x16x32_bf16 a[52:55], v[156:159], v[204:207], a[52:55]
  v_mfma_f32_16x16x32_bf16 a[56:59], v[156:159], v[208:211], a[56:59]
  v_mfma_f32_16x16x32_bf16 a[60:63], v[156:159], v[212:215], a[60:63]
  v_mfma_f32_16x16x32_bf16 a[64:67], v[160:163], v[200:203], a[64:67]
  v_mfma_f32_16x16x32_bf16 a[68:71], v[160:163], v[204:207], a[68:71]
  v_mfma_f32_16x16x32_bf16 a[72:75], v[160:163], v[208:211], a[72:75]
  v_mfma_f32_16x16x32_bf16 a[76:79], v[160:163], v[212:215], a[76:79]
  v_mfma_f32_16x16x32_bf16 a[80:83], v[164:167], v[200:203], a[80:83]
  v_mfma_f32_16x16x32_bf16 a[84:87], v[164:167], v[204:207], a[84:87]
  v_mfma_f32_16x16x32_bf16 a[88:91], v[164:167], v[208:211], a[88:91]
  v_mfma_f32_16x16x32_bf16 a[92:95], v[164:167], v[212:215], a[92:95]
  v_mfma_f32_16x16x32_bf16 a[96:99], v[168:171], v[200:203], a[96:99]
  v_mfma_f32_16x16x32_bf16 a[100:103], v[168:171], v[204:207], a[100:103]
  v_mfma_f32_16x16x32_bf16 a[104:107], v[168:171], v[208:211], a[104:107]
  v_mfma_f32_16x16x32_bf16 a[108:111], v[168:171], v[212:215], a[108:111]
  v_mfma_f32_16x16x32_bf16 a[112:115], v[172:175], v[200:203], a[112:115]
  v_mfma_f32_16x16x32_bf16 a[116:119], v[172:175], v[204:207], a[116:119]
  v_mfma_f32_16x16x32_bf16 a[120:123], v[172:175], v[208:211], a[120:123]
  v_mfma_f32_16x16x32_bf16 a[124:127], v[172:175], v[212:215], a[124:127]
  v_mfma_f32_16x16x32_bf16 a[128:131], v[176:179], v[200:203], a[128:131]
  v_mfma_f32_16x16x32_bf16 a[132:135], v[176:179], v[204:207], a[132:135]
  v_mfma_f32_16x16x32_bf16 a[136:139], v[176:179], v[208:211], a[136:139]
  v_mfma_f32_16x16x32_bf16 a[140:143], v[176:179], v[212:215], a[140:143]
  v_mfma_f32_16x16x32_bf16 a[144:147], v[180:183], v[200:203], a[144:147]
  v_mfma_f32_16x16x32_bf16 a[148:151], v[180:183], v[204:207], a[148:151]
  v_mfma_f32_16x16x32_bf16 a[152:155], v[180:183], v[208:211], a[152:155]
  v_mfma_f32_16x16x32_bf16 a[156:159], v[180:183], v[212:215], a[156:159]
  buffer_load_dwordx4 v[144:147], v1, s[4:7], s30 offen offset:3072
  buffer_load_dwordx4 v[148:151], v1, s[4:7], s31 offen offset:3072
  buffer_load_dwordx4 v[152:155], v1, s[4:7], s32 offen offset:3072
  buffer_load_dwordx4 v[156:159], v1, s[4:7], s33 offen offset:3072
  buffer_load_dwordx4 v[160:163], v1, s[4:7], s34 offen offset:3072
  buffer_load_dwordx4 v[164:167], v1, s[4:7], s35 offen offset:3072
  buffer_load_dwordx4 v[168:171], v1, s[4:7], s36 offen offset:3072
  buffer_load_dwordx4 v[172:175], v1, s[4:7], s37 offen offset:3072
  buffer_load_dwordx4 v[176:179], v1, s[4:7], s38 offen offset:3072
  buffer_load_dwordx4 v[180:183], v1, s[4:7], s39 offen offset:3072
  s_add_u32 s30, s30, 4096
  s_add_u32 s31, s31, 4096
  s_add_u32 s32, s32, 4096
  s_add_u32 s33, s33, 4096
  s_add_u32 s34, s34, 4096
  s_add_u32 s35, s35, 4096
  s_add_u32 s36, s36, 4096
  s_add_u32 s37, s37, 4096
  s_add_u32 s38, s38, 4096
  s_add_u32 s39, s39, 4096
  s_waitcnt vmcnt(30)
  ds_read_b128 v[200:203], v1 offset:9216
  ds_read_b128 v[204:207], v1 offset:33792
  ds_read_b128 v[208:211], v6 offset:9216
  ds_read_b128 v[212:215], v6 offset:33792
  s_waitcnt lgkmcnt(4)
  v_mfma_f32_16x16x32_bf16 a[0:3], v[24:27], v[184:187], a[0:3]
  v_mfma_f32_16x16x32_bf16 a[4:7], v[24:27], v[188:191], a[4:7]
  v_mfma_f32_16x16x32_bf16 a[8:11], v[24:27], v[192:195], a[8:11]
  v_mfma_f32_16x16x32_bf16 a[12:15], v[24:27], v[196:199], a[12:15]
  v_mfma_f32_16x16x32_bf16 a[16:19], v[28:31], v[184:187], a[16:19]
  v_mfma_f32_16x16x32_bf16 a[20:23], v[28:31], v[188:191], a[20:23]
  v_mfma_f32_16x16x32_bf16 a[24:27], v[28:31], v[192:195], a[24:27]
  v_mfma_f32_16x16x32_bf16 a[28:31], v[28:31], v[196:199], a[28:31]
  v_mfma_f32_16x16x32_bf16 a[32:35], v[32:35], v[184:187], a[32:35]
  v_mfma_f32_16x16x32_bf16 a[36:39], v[32:35], v[188:191], a[36:39]
  v_mfma_f32_16x16x32_bf16 a[40:43], v[32:35], v[192:195], a[40:43]
  v_mfma_f32_16x16x32_bf16 a[44:47], v[32:35], v[196:199], a[44:47]
  v_mfma_f32_16x16x32_bf16 a[48:51], v[36:39], v[184:187], a[48:51]
  v_mfma_f32_16x16x32_bf16 a[52:55], v[36:39], v[188:191], a[52:55]
  v_mfma_f32_16x16x32_bf16 a[56:59], v[36:39], v[192:195], a[56:59]
  v_mfma_f32_16x16x32_bf16 a[60:63], v[36:39], v[196:199], a[60:63]
  v_mfma_f32_16x16x32_bf16 a[64:67], v[40:43], v[184:187], a[64:67]
  v_mfma_f32_16x16x32_bf16 a[68:71], v[40:43], v[188:191], a[68:71]
  v_mfma_f32_16x16x32_bf16 a[72:75], v[40:43], v[192:195], a[72:75]
  v_mfma_f32_16x16x32_bf16 a[76:79], v[40:43], v[196:199], a[76:79]
  v_mfma_f32_16x16x32_bf16 a[80:83], v[44:47], v[184:187], a[80:83]
  v_mfma_f32_16x16x32_bf16 a[84:87], v[44:47], v[188:191], a[84:87]
  v_mfma_f32_16x16x32_bf16 a[88:91], v[44:47], v[192:195], a[88:91]
  v_mfma_f32_16x16x32_bf16 a[92:95], v[44:47], v[196:199], a[92:95]
  v_mfma_f32_16x16x32_bf16 a[96:99], v[48:51], v[184:187], a[96:99]
  v_mfma_f32_16x16x32_bf16 a[100:103], v[48:51], v[188:191], a[100:103]
  v_mfma_f32_16x16x32_bf16 a[104:107], v[48:51], v[192:195], a[104:107]
  v_mfma_f32_16x16x32_bf16 a[108:111], v[48:51], v[196:199], a[108:111]
  v_mfma_f32_16x16x32_bf16 a[112:115], v[52:55], v[184:187], a[112:115]
  v_mfma_f32_16x16x32_bf16 a[116:119], v[52:55], v[188:191], a[116:119]
  v_mfma_f32_16x16x32_bf16 a[120:123], v[52:55], v[192:195], a[120:123]
  v_mfma_f32_16x16x32_bf16 a[124:127], v[52:55], v[196:199], a[124:127]
  v_mfma_f32_16x16x32_bf16 a[128:131], v[56:59], v[184:187], a[128:131]
  v_mfma_f32_16x16x32_bf16 a[132:135], v[56:59], v[188:191], a[132:135]
  v_mfma_f32_16x16x32_bf16 a[136:139], v[56:59], v[192:195], a[136:139]
  v_mfma_f32_16x16x32_bf16 a[140:143], v[56:59], v[196:199], a[140:143]
  v_mfma_f32_16x16x32_bf16 a[144:147], v[60:63], v[184:187], a[144:147]
  v_mfma_f32_16x16x32_bf16 a[148:151], v[60:63], v[188:191], a[148:151]
  v_mfma_f32_16x16x32_bf16 a[152:155], v[60:63], v[192:195], a[152:155]
  v_mfma_f32_16x16x32_bf16 a[156:159], v[60:63], v[196:199], a[156:159]
  buffer_load_dwordx4 v[24:27], v1, s[4:7], s30 offen offset:0
  buffer_load_dwordx4 v[28:31], v1, s[4:7], s31 offen offset:0
  buffer_load_dwordx4 v[32:35], v1, s[4:7], s32 offen offset:0
  buffer_load_dwordx4 v[36:39], v1, s[4:7], s33 offen offset:0
  buffer_load_dwordx4 v[40:43], v1, s[4:7], s34 offen offset:0
  buffer_load_dwordx4 v[44:47], v1, s[4:7], s35 offen offset:0
  buffer_load_dwordx4 v[48:51], v1, s[4:7], s36 offen offset:0
  buffer_load_dwordx4 v[52:55], v1, s[4:7], s37 offen offset:0
  buffer_load_dwordx4 v[56:59], v1, s[4:7], s38 offen offset:0
  buffer_load_dwordx4 v[60:63], v1, s[4:7], s39 offen offset:0
  s_waitcnt vmcnt(30)
  ds_read_b128 v[184:187], v1 offset:10240
  ds_read_b128 v[188:191], v1 offset:34816
  ds_read_b128 v[192:195], v6 offset:10240
  ds_read_b128 v[196:199], v6 offset:34816
  s_waitcnt lgkmcnt(4)
  v_mfma_f32_16x16x32_bf16 a[0:3], v[64:67], v[200:203], a[0:3]
  v_mfma_f32_16x16x32_bf16 a[4:7], v[64:67], v[204:207], a[4:7]
  v_mfma_f32_16x16x32_bf16 a[8:11], v[64:67], v[208:211], a[8:11]
  v_mfma_f32_16x16x32_bf16 a[12:15], v[64:67], v[212:215], a[12:15]
  v_mfma_f32_16x16x32_bf16 a[16:19], v[68:71], v[200:203], a[16:19]
  v_mfma_f32_16x16x32_bf16 a[20:23], v[68:71], v[204:207], a[20:23]
  v_mfma_f32_16x16x32_bf16 a[24:27], v[68:71], v[208:211], a[24:27]
  v_mfma_f32_16x16x32_bf16 a[28:31], v[68:71], v[212:215], a[28:31]
  v_mfma_f32_16x16x32_bf16 a[32:35], v[72:75], v[200:203], a[32:35]
  v_mfma_f32_16x16x32_bf16 a[36:39], v[72:75], v[204:207], a[36:39]
  v_mfma_f32_16x16x32_bf16 a[40:43], v[72:75], v[208:211], a[40:43]
  v_mfma_f32_16x16x32_bf16 a[44:47], v[72:75], v[212:215], a[44:47]
  v_mfma_f32_16x16x32_bf16 a[48:51], v[76:79], v[200:203], a[48:51]
  v_mfma_f32_16x16x32_bf16 a[52:55], v[76:79], v[204:207], a[52:55]
  v_mfma_f32_16x16x32_bf16 a[56:59], v[76:79], v[208:211], a[56:59]
  v_mfma_f32_16x16x32_bf16 a[60:63], v[76:79], v[212:215], a[60:63]
  v_mfma_f32_16x16x32_bf16 a[64:67], v[80:83], v[200:203], a[64:67]
  v_mfma_f32_16x16x32_bf16 a[68:71], v[80:83], v[204:207], a[68:71]
  v_mfma_f32_16x16x32_bf16 a[72:75], v[80:83], v[208:211], a[72:75]
  v_mfma_f32_16x16x32_bf16 a[76:79], v[80:83], v[212:215], a[76:79]
  v_mfma_f32_16x16x32_bf16 a[80:83], v[84:87], v[200:203], a[80:83]
  v_mfma_f32_16x16x32_bf16 a[84:87], v[84:87], v[204:207], a[84:87]
  v_mfma_f32_16x16x32_bf16 a[88:91], v[84:87], v[208:211], a[88:91]
  v_mfma_f32_16x16x32_bf16 a[92:95], v[84:87], v[212:215], a[92:95]
  v_mfma_f32_16x16x32_bf16 a[96:99], v[88:91], v[200:203], a[96:99]
  v_mfma_f32_16x16x32_bf16 a[100:103], v[88:91], v[204:207], a[100:103]
  v_mfma_f32_16x16x32_bf16 a[104:107], v[88:91], v[208:211], a[104:107]
  v_mfma_f32_16x16x32_bf16 a[108:111], v[88:91], v[212:215], a[108:111]
  v_mfma_f32_16x16x32_bf16 a[112:115], v[92:95], v[200:203], a[112:115]
  v_mfma_f32_16x16x32_bf16 a[116:119], v[92:95], v[204:207], a[116:119]
  v_mfma_f32_16x16x32_bf16 a[120:123], v[92:95], v[208:211], a[120:123]
  v_mfma_f32_16x16x32_bf16 a[124:127], v[92:95], v[212:215], a[124:127]
  v_mfma_f32_16x16x32_bf16 a[128:131], v[96:99], v[200:203], a[128:131]
  v_mfma_f32_16x16x32_bf16 a[132:135], v[96:99], v[204:207], a[132:135]
  v_mfma_f32_16x16x32_bf16 a[136:139], v[96:99], v[208:211], a[136:139]
  v_mfma_f32_16x16x32_bf16 a[140:143], v[96:99], v[212:215], a[140:143]
  v_mfma_f32_16x16x32_bf16 a[144:147], v[100:103], v[200:203], a[144:147]
  v_mfma_f32_16x16x32_bf16 a[148:151], v[100:103], v[204:207], a[148:151]
  v_mfma_f32_16x16x32_bf16 a[152:155], v[100:103], v[208:211], a[152:155]
  v_mfma_f32_16x16x32_bf16 a[156:159], v[100:103], v[212:215], a[156:159]
  buffer_load_dwordx4 v[64:67], v1, s[4:7], s30 offen offset:1024
  buffer_load_dwordx4 v[68:71], v1, s[4:7], s31 offen offset:1024
  buffer_load_dwordx4 v[72:75], v1, s[4:7], s32 offen offset:1024
  buffer_load_dwordx4 v[76:79], v1, s[4:7], s33 offen offset:1024
  buffer_load_dwordx4 v[80:83], v1, s[4:7], s34 offen offset:1024
  buffer_load_dwordx4 v[84:87], v1, s[4:7], s35 offen offset:1024
  buffer_load_dwordx4 v[88:91], v1, s[4:7], s36 offen offset:1024
  buffer_load_dwordx4 v[92:95], v1, s[4:7], s37 offen offset:1024
  buffer_load_dwordx4 v[96:99], v1, s[4:7], s38 offen offset:1024
  buffer_load_dwordx4 v[100:103], v1, s[4:7], s39 offen offset:1024
  s_waitcnt vmcnt(30)
  ds_read_b128 v[200:203], v1 offset:11264
  ds_read_b128 v[204:207], v1 offset:35840
  ds_read_b128 v[208:211], v6 offset:11264
  ds_read_b128 v[212:215], v6 offset:35840
  s_waitcnt lgkmcnt(4)
  v_mfma_f32_16x16x32_bf16 a[0:3], v[104:107], v[184:187], a[0:3]
  v_mfma_f32_16x16x32_bf16 a[4:7], v[104:107], v[188:191], a[4:7]
  v_mfma_f32_16x16x32_bf16 a[8:11], v[104:107], v[192:195], a[8:11]
  v_mfma_f32_16x16x32_bf16 a[12:15], v[104:107], v[196:199], a[12:15]
  v_mfma_f32_16x16x32_bf16 a[16:19], v[108:111], v[184:187], a[16:19]
  v_mfma_f32_16x16x32_bf16 a[20:23], v[108:111], v[188:191], a[20:23]
  v_mfma_f32_16x16x32_bf16 a[24:27], v[108:111], v[192:195], a[24:27]
  v_mfma_f32_16x16x32_bf16 a[28:31], v[108:111], v[196:199], a[28:31]
  v_mfma_f32_16x16x32_bf16 a[32:35], v[112:115], v[184:187], a[32:35]
  v_mfma_f32_16x16x32_bf16 a[36:39], v[112:115], v[188:191], a[36:39]
  v_mfma_f32_16x16x32_bf16 a[40:43], v[112:115], v[192:195], a[40:43]
  v_mfma_f32_16x16x32_bf16 a[44:47], v[112:115], v[196:199], a[44:47]
  v_mfma_f32_16x16x32_bf16 a[48:51], v[116:119], v[184:187], a[48:51]
  v_mfma_f32_16x16x32_bf16 a[52:55], v[116:119], v[188:191], a[52:55]
  v_mfma_f32_16x16x32_bf16 a[56:59], v[116:119], v[192:195], a[56:59]
  v_mfma_f32_16x16x32_bf16 a[60:63], v[116:119], v[196:199], a[60:63]
  v_mfma_f32_16x16x32_bf16 a[64:67], v[120:123], v[184:187], a[64:67]
  v_mfma_f32_16x16x32_bf16 a[68:71], v[120:123], v[188:191], a[68:71]
  v_mfma_f32_16x16x32_bf16 a[72:75], v[120:123], v[192:195], a[72:75]
  v_mfma_f32_16x16x32_bf16 a[76:79], v[120:123], v[196:199], a[76:79]
  v_mfma_f32_16x16x32_bf16 a[80:83], v[124:127], v[184:187], a[80:83]
  v_mfma_f32_16x16x32_bf16 a[84:87], v[124:127], v[188:191], a[84:87]
  v_mfma_f32_16x16x32_bf16 a[88:91], v[124:127], v[192:195], a[88:91]
  v_mfma_f32_16x16x32_bf16 a[92:95], v[124:127], v[196:199], a[92:95]
  v_mfma_f32_16x16x32_bf16 a[96:99], v[128:131], v[184:187], a[96:99]
  v_mfma_f32_16x16x32_bf16 a[100:103], v[128:131], v[188:191], a[100:103]
  v_mfma_f32_16x16x32_bf16 a[104:107], v[128:131], v[192:195], a[104:107]
  v_mfma_f32_16x16x32_bf16 a[108:111], v[128:131], v[196:199], a[108:111]
  v_mfma_f32_16x16x32_bf16 a[112:115], v[132:135], v[184:187], a[112:115]
  v_mfma_f32_16x16x32_bf16 a[116:119], v[132:135], v[188:191], a[116:119]
  v_mfma_f32_16x16x32_bf16 a[120:123], v[132:135], v[192:195], a[120:123]
  v_mfma_f32_16x16x32_bf16 a[124:127], v[132:135], v[196:199], a[124:127]
  v_mfma_f32_16x16x32_bf16 a[128:131], v[136:139], v[184:187], a[128:131]
  v_mfma_f32_16x16x32_bf16 a[132:135], v[136:139], v[188:191], a[132:135]
  v_mfma_f32_16x16x32_bf16 a[136:139], v[136:139], v[192:195], a[136:139]
  v_mfma_f32_16x16x32_bf16 a[140:143], v[136:139], v[196:199], a[140:143]
  v_mfma_f32_16x16x32_bf16 a[144:147], v[140:143], v[184:187], a[144:147]
  v_mfma_f32_16x16x32_bf16 a[148:151], v[140:143], v[188:191], a[148:151]
  v_mfma_f32_16x16x32_bf16 a[152:155], v[140:143], v[192:195], a[152:155]
  v_mfma_f32_16x16x32_bf16 a[156:159], v[140:143], v[196:199], a[156:159]
  buffer_load_dwordx4 v[104:107], v1, s[4:7], s30 offen offset:2048
  buffer_load_dwordx4 v[108:111], v1, s[4:7], s31 offen offset:2048
  buffer_load_dwordx4 v[112:115], v1, s[4:7], s32 offen offset:2048
  buffer_load_dwordx4 v[116:119], v1, s[4:7], s33 offen offset:2048
  buffer_load_dwordx4 v[120:123], v1, s[4:7], s34 offen offset:2048
  buffer_load_dwordx4 v[124:127], v1, s[4:7], s35 offen offset:2048
  buffer_load_dwordx4 v[128:131], v1, s[4:7], s36 offen offset:2048
  buffer_load_dwordx4 v[132:135], v1, s[4:7], s37 offen offset:2048
  buffer_load_dwordx4 v[136:139], v1, s[4:7], s38 offen offset:2048
  buffer_load_dwordx4 v[140:143], v1, s[4:7], s39 offen offset:2048
  s_waitcnt vmcnt(30)
  ds_read_b128 v[184:187], v1 offset:12288
  ds_read_b128 v[188:191], v1 offset:36864
  ds_read_b128 v[192:195], v6 offset:12288
  ds_read_b128 v[196:199], v6 offset:36864
  s_waitcnt lgkmcnt(4)
  v_mfma_f32_16x16x32_bf16 a[0:3], v[144:147], v[200:203], a[0:3]
  v_mfma_f32_16x16x32_bf16 a[4:7], v[144:147], v[204:207], a[4:7]
  v_mfma_f32_16x16x32_bf16 a[8:11], v[144:147], v[208:211], a[8:11]
  v_mfma_f32_16x16x32_bf16 a[12:15], v[144:147], v[212:215], a[12:15]
  v_mfma_f32_16x16x32_bf16 a[16:19], v[148:151], v[200:203], a[16:19]
  v_mfma_f32_16x16x32_bf16 a[20:23], v[148:151], v[204:207], a[20:23]
  v_mfma_f32_16x16x32_bf16 a[24:27], v[148:151], v[208:211], a[24:27]
  v_mfma_f32_16x16x32_bf16 a[28:31], v[148:151], v[212:215], a[28:31]
  v_mfma_f32_16x16x32_bf16 a[32:35], v[152:155], v[200:203], a[32:35]
  v_mfma_f32_16x16x32_bf16 a[36:39], v[152:155], v[204:207], a[36:39]
  v_mfma_f32_16x16x32_bf16 a[40:43], v[152:155], v[208:211], a[40:43]
  v_mfma_f32_16x16x32_bf16 a[44:47], v[152:155], v[212:215], a[44:47]
  v_mfma_f32_16x16x32_bf16 a[48:51], v[156:159], v[200:203], a[48:51]
  v_mfma_f32_16x16x32_bf16 a[52:55], v[156:159], v[204:207], a[52:55]
  v_mfma_f32_16x16x32_bf16 a[56:59], v[156:159], v[208:211], a[56:59]
  v_mfma_f32_16x16x32_bf16 a[60:63], v[156:159], v[212:215], a[60:63]
  v_mfma_f32_16x16x32_bf16 a[64:67], v[160:163], v[200:203], a[64:67]
  v_mfma_f32_16x16x32_bf16 a[68:71], v[160:163], v[204:207], a[68:71]
  v_mfma_f32_16x16x32_bf16 a[72:75], v[160:163], v[208:211], a[72:75]
  v_mfma_f32_16x16x32_bf16 a[76:79], v[160:163], v[212:215], a[76:79]
  v_mfma_f32_16x16x32_bf16 a[80:83], v[164:167], v[200:203], a[80:83]
  v_mfma_f32_16x16x32_bf16 a[84:87], v[164:167], v[204:207], a[84:87]
  v_mfma_f32_16x16x32_bf16 a[88:91], v[164:167], v[208:211], a[88:91]
  v_mfma_f32_16x16x32_bf16 a[92:95], v[164:167], v[212:215], a[92:95]
  v_mfma_f32_16x16x32_bf16 a[96:99], v[168:171], v[200:203], a[96:99]
  v_mfma_f32_16x16x32_bf16 a[100:103], v[168:171], v[204:207], a[100:103]
  v_mfma_f32_16x16x32_bf16 a[104:107], v[168:171], v[208:211], a[104:107]
  v_mfma_f32_16x16x32_bf16 a[108:111], v[168:171], v[212:215], a[108:111]
  v_mfma_f32_16x16x32_bf16 a[112:115], v[172:175], v[200:203], a[112:115]
  v_mfma_f32_16x16x32_bf16 a[116:119], v[172:175], v[204:207], a[116:119]
  v_mfma_f32_16x16x32_bf16 a[120:123], v[172:175], v[208:211], a[120:123]
  v_mfma_f32_16x16x32_bf16 a[124:127], v[172:175], v[212:215], a[124:127]
  v_mfma_f32_16x16x32_bf16 a[128:131], v[176:179], v[200:203], a[128:131]
  v_mfma_f32_16x16x32_bf16 a[132:135], v[176:179], v[204:207], a[132:135]
  v_mfma_f32_16x16x32_bf16 a[136:139], v[176:179], v[208:211], a[136:139]
  v_mfma_f32_16x16x32_bf16 a[140:143], v[176:179], v[212:215], a[140:143]
  v_mfma_f32_16x16x32_bf16 a[144:147], v[180:183], v[200:203], a[144:147]
  v_mfma_f32_16x16x32_bf16 a[148:151], v[180:183], v[204:207], a[148:151]
  v_mfma_f32_16x16x32_bf16 a[152:155], v[180:183], v[208:211], a[152:155]
  v_mfma_f32_16x16x32_bf16 a[156:159], v[180:183], v[212:215], a[156:159]
  buffer_load_dwordx4 v[144:147], v1, s[4:7], s30 offen offset:3072
  buffer_load_dwordx4 v[148:151], v1, s[4:7], s31 offen offset:3072
  buffer_load_dwordx4 v[152:155], v1, s[4:7], s32 offen offset:3072
  buffer_load_dwordx4 v[156:159], v1, s[4:7], s33 offen offset:3072
  buffer_load_dwordx4 v[160:163], v1, s[4:7], s34 offen offset:3072
  buffer_load_dwordx4 v[164:167], v1, s[4:7], s35 offen offset:3072
  buffer_load_dwordx4 v[168:171], v1, s[4:7], s36 offen offset:3072
  buffer_load_dwordx4 v[172:175], v1, s[4:7], s37 offen offset:3072
  buffer_load_dwordx4 v[176:179], v1, s[4:7], s38 offen offset:3072
  buffer_load_dwordx4 v[180:183], v1, s[4:7], s39 offen offset:3072
  s_add_u32 s30, s30, 4096
  s_add_u32 s31, s31, 4096
  s_add_u32 s32, s32, 4096
  s_add_u32 s33, s33, 4096
  s_add_u32 s34, s34, 4096
  s_add_u32 s35, s35, 4096
  s_add_u32 s36, s36, 4096
  s_add_u32 s37, s37, 4096
  s_add_u32 s38, s38, 4096
  s_add_u32 s39, s39, 4096
  s_waitcnt vmcnt(30)
  ds_read_b128 v[200:203], v1 offset:13312
  ds_read_b128 v[204:207], v1 offset:37888
  ds_read_b128 v[208:211], v6 offset:13312
  ds_read_b128 v[212:215], v6 offset:37888
  s_waitcnt lgkmcnt(4)
  v_mfma_f32_16x16x32_bf16 a[0:3], v[24:27], v[184:187], a[0:3]
  v_mfma_f32_16x16x32_bf16 a[4:7], v[24:27], v[188:191], a[4:7]
  v_mfma_f32_16x16x32_bf16 a[8:11], v[24:27], v[192:195], a[8:11]
  v_mfma_f32_16x16x32_bf16 a[12:15], v[24:27], v[196:199], a[12:15]
  v_mfma_f32_16x16x32_bf16 a[16:19], v[28:31], v[184:187], a[16:19]
  v_mfma_f32_16x16x32_bf16 a[20:23], v[28:31], v[188:191], a[20:23]
  v_mfma_f32_16x16x32_bf16 a[24:27], v[28:31], v[192:195], a[24:27]
  v_mfma_f32_16x16x32_bf16 a[28:31], v[28:31], v[196:199], a[28:31]
  v_mfma_f32_16x16x32_bf16 a[32:35], v[32:35], v[184:187], a[32:35]
  v_mfma_f32_16x16x32_bf16 a[36:39], v[32:35], v[188:191], a[36:39]
  v_mfma_f32_16x16x32_bf16 a[40:43], v[32:35], v[192:195], a[40:43]
  v_mfma_f32_16x16x32_bf16 a[44:47], v[32:35], v[196:199], a[44:47]
  v_mfma_f32_16x16x32_bf16 a[48:51], v[36:39], v[184:187], a[48:51]
  v_mfma_f32_16x16x32_bf16 a[52:55], v[36:39], v[188:191], a[52:55]
  v_mfma_f32_16x16x32_bf16 a[56:59], v[36:39], v[192:195], a[56:59]
  v_mfma_f32_16x16x32_bf16 a[60:63], v[36:39], v[196:199], a[60:63]
  v_mfma_f32_16x16x32_bf16 a[64:67], v[40:43], v[184:187], a[64:67]
  v_mfma_f32_16x16x32_bf16 a[68:71], v[40:43], v[188:191], a[68:71]
  v_mfma_f32_16x16x32_bf16 a[72:75], v[40:43], v[192:195], a[72:75]
  v_mfma_f32_16x16x32_bf16 a[76:79], v[40:43], v[196:199], a[76:79]
  v_mfma_f32_16x16x32_bf16 a[80:83], v[44:47], v[184:187], a[80:83]
  v_mfma_f32_16x16x32_bf16 a[84:87], v[44:47], v[188:191], a[84:87]
  v_mfma_f32_16x16x32_bf16 a[88:91], v[44:47], v[192:195], a[88:91]
  v_mfma_f32_16x16x32_bf16 a[92:95], v[44:47], v[196:199], a[92:95]
  v_mfma_f32_16x16x32_bf16 a[96:99], v[48:51], v[184:187], a[96:99]
  v_mfma_f32_16x16x32_bf16 a[100:103], v[48:51], v[188:191], a[100:103]
  v_mfma_f32_16x16x32_bf16 a[104:107], v[48:51], v[192:195], a[104:107]
  v_mfma_f32_16x16x32_bf16 a[108:111], v[48:51], v[196:199], a[108:111]
  v_mfma_f32_16x16x32_bf16 a[112:115], v[52:55], v[184:187], a[112:115]
  v_mfma_f32_16x16x32_bf16 a[116:119], v[52:55], v[188:191], a[116:119]
  v_mfma_f32_16x16x32_bf16 a[120:123], v[52:55], v[192:195], a[120:123]
  v_mfma_f32_16x16x32_bf16 a[124:127], v[52:55], v[196:199], a[124:127]
  v_mfma_f32_16x16x32_bf16 a[128:131], v[56:59], v[184:187], a[128:131]
  v_mfma_f32_16x16x32_bf16 a[132:135], v[56:59], v[188:191], a[132:135]
  v_mfma_f32_16x16x32_bf16 a[136:139], v[56:59], v[192:195], a[136:139]
  v_mfma_f32_16x16x32_bf16 a[140:143], v[56:59], v[196:199], a[140:143]
  v_mfma_f32_16x16x32_bf16 a[144:147], v[60:63], v[184:187], a[144:147]
  v_mfma_f32_16x16x32_bf16 a[148:151], v[60:63], v[188:191], a[148:151]
  v_mfma_f32_16x16x32_bf16 a[152:155], v[60:63], v[192:195], a[152:155]
  v_mfma_f32_16x16x32_bf16 a[156:159], v[60:63], v[196:199], a[156:159]
  buffer_load_dwordx4 v[24:27], v1, s[4:7], s30 offen offset:0
  buffer_load_dwordx4 v[28:31], v1, s[4:7], s31 offen offset:0
  buffer_load_dwordx4 v[32:35], v1, s[4:7], s32 offen offset:0
  buffer_load_dwordx4 v[36:39], v1, s[4:7], s33 offen offset:0
  buffer_load_dwordx4 v[40:43], v1, s[4:7], s34 offen offset:0
  buffer_load_dwordx4 v[44:47], v1, s[4:7], s35 offen offset:0
  buffer_load_dwordx4 v[48:51], v1, s[4:7], s36 offen offset:0
  buffer_load_dwordx4 v[52:55], v1, s[4:7], s37 offen offset:0
  buffer_load_dwordx4 v[56:59], v1, s[4:7], s38 offen offset:0
  buffer_load_dwordx4 v[60:63], v1, s[4:7], s39 offen offset:0
  s_waitcnt vmcnt(30)
  ds_read_b128 v[184:187], v1 offset:14336
  ds_read_b128 v[188:191], v1 offset:38912
  ds_read_b128 v[192:195], v6 offset:14336
  ds_read_b128 v[196:199], v6 offset:38912
  s_waitcnt lgkmcnt(4)
  v_mfma_f32_16x16x32_bf16 a[0:3], v[64:67], v[200:203], a[0:3]
  v_mfma_f32_16x16x32_bf16 a[4:7], v[64:67], v[204:207], a[4:7]
  v_mfma_f32_16x16x32_bf16 a[8:11], v[64:67], v[208:211], a[8:11]
  v_mfma_f32_16x16x32_bf16 a[12:15], v[64:67], v[212:215], a[12:15]
  v_mfma_f32_16x16x32_bf16 a[16:19], v[68:71], v[200:203], a[16:19]
  v_mfma_f32_16x16x32_bf16 a[20:23], v[68:71], v[204:207], a[20:23]
  v_mfma_f32_16x16x32_bf16 a[24:27], v[68:71], v[208:211], a[24:27]
  v_mfma_f32_16x16x32_bf16 a[28:31], v[68:71], v[212:215], a[28:31]
  v_mfma_f32_16x16x32_bf16 a[32:35], v[72:75], v[200:203], a[32:35]
  v_mfma_f32_16x16x32_bf16 a[36:39], v[72:75], v[204:207], a[36:39]
  v_mfma_f32_16x16x32_bf16 a[40:43], v[72:75], v[208:211], a[40:43]
  v_mfma_f32_16x16x32_bf16 a[44:47], v[72:75], v[212:215], a[44:47]
  v_mfma_f32_16x16x32_bf16 a[48:51], v[76:79], v[200:203], a[48:51]
  v_mfma_f32_16x16x32_bf16 a[52:55], v[76:79], v[204:207], a[52:55]
  v_mfma_f32_16x16x32_bf16 a[56:59], v[76:79], v[208:211], a[56:59]
  v_mfma_f32_16x16x32_bf16 a[60:63], v[76:79], v[212:215], a[60:63]
  v_mfma_f32_16x16x32_bf16 a[64:67], v[80:83], v[200:203], a[64:67]
  v_mfma_f32_16x16x32_bf16 a[68:71], v[80:83], v[204:207], a[68:71]
  v_mfma_f32_16x16x32_bf16 a[72:75], v[80:83], v[208:211], a[72:75]
  v_mfma_f32_16x16x32_bf16 a[76:79], v[80:83], v[212:215], a[76:79]
  v_mfma_f32_16x16x32_bf16 a[80:83], v[84:87], v[200:203], a[80:83]
  v_mfma_f32_16x16x32_bf16 a[84:87], v[84:87], v[204:207], a[84:87]
  v_mfma_f32_16x16x32_bf16 a[88:91], v[84:87], v[208:211], a[88:91]
  v_mfma_f32_16x16x32_bf16 a[92:95], v[84:87], v[212:215], a[92:95]
  v_mfma_f32_16x16x32_bf16 a[96:99], v[88:91], v[200:203], a[96:99]
  v_mfma_f32_16x16x32_bf16 a[100:103], v[88:91], v[204:207], a[100:103]
  v_mfma_f32_16x16x32_bf16 a[104:107], v[88:91], v[208:211], a[104:107]
  v_mfma_f32_16x16x32_bf16 a[108:111], v[88:91], v[212:215], a[108:111]
  v_mfma_f32_16x16x32_bf16 a[112:115], v[92:95], v[200:203], a[112:115]
  v_mfma_f32_16x16x32_bf16 a[116:119], v[92:95], v[204:207], a[116:119]
  v_mfma_f32_16x16x32_bf16 a[120:123], v[92:95], v[208:211], a[120:123]
  v_mfma_f32_16x16x32_bf16 a[124:127], v[92:95], v[212:215], a[124:127]
  v_mfma_f32_16x16x32_bf16 a[128:131], v[96:99], v[200:203], a[128:131]
  v_mfma_f32_16x16x32_bf16 a[132:135], v[96:99], v[204:207], a[132:135]
  v_mfma_f32_16x16x32_bf16 a[136:139], v[96:99], v[208:211], a[136:139]
  v_mfma_f32_16x16x32_bf16 a[140:143], v[96:99], v[212:215], a[140:143]
  v_mfma_f32_16x16x32_bf16 a[144:147], v[100:103], v[200:203], a[144:147]
  v_mfma_f32_16x16x32_bf16 a[148:151], v[100:103], v[204:207], a[148:151]
  v_mfma_f32_16x16x32_bf16 a[152:155], v[100:103], v[208:211], a[152:155]
  v_mfma_f32_16x16x32_bf16 a[156:159], v[100:103], v[212:215], a[156:159]
  buffer_load_dwordx4 v[64:67], v1, s[4:7], s30 offen offset:1024
  buffer_load_dwordx4 v[68:71], v1, s[4:7], s31 offen offset:1024
  buffer_load_dwordx4 v[72:75], v1, s[4:7], s32 offen offset:1024
  buffer_load_dwordx4 v[76:79], v1, s[4:7], s33 offen offset:1024
  buffer_load_dwordx4 v[80:83], v1, s[4:7], s34 offen offset:1024
  buffer_load_dwordx4 v[84:87], v1, s[4:7], s35 offen offset:1024
  buffer_load_dwordx4 v[88:91], v1, s[4:7], s36 offen offset:1024
  buffer_load_dwordx4 v[92:95], v1, s[4:7], s37 offen offset:1024
  buffer_load_dwordx4 v[96:99], v1, s[4:7], s38 offen offset:1024
  buffer_load_dwordx4 v[100:103], v1, s[4:7], s39 offen offset:1024
  s_waitcnt vmcnt(30)
  ds_read_b128 v[200:203], v1 offset:15360
  ds_read_b128 v[204:207], v1 offset:39936
  ds_read_b128 v[208:211], v6 offset:15360
  ds_read_b128 v[212:215], v6 offset:39936
  s_waitcnt lgkmcnt(4)
  v_mfma_f32_16x16x32_bf16 a[0:3], v[104:107], v[184:187], a[0:3]
  v_mfma_f32_16x16x32_bf16 a[4:7], v[104:107], v[188:191], a[4:7]
  v_mfma_f32_16x16x32_bf16 a[8:11], v[104:107], v[192:195], a[8:11]
  v_mfma_f32_16x16x32_bf16 a[12:15], v[104:107], v[196:199], a[12:15]
  v_mfma_f32_16x16x32_bf16 a[16:19], v[108:111], v[184:187], a[16:19]
  v_mfma_f32_16x16x32_bf16 a[20:23], v[108:111], v[188:191], a[20:23]
  v_mfma_f32_16x16x32_bf16 a[24:27], v[108:111], v[192:195], a[24:27]
  v_mfma_f32_16x16x32_bf16 a[28:31], v[108:111], v[196:199], a[28:31]
  v_mfma_f32_16x16x32_bf16 a[32:35], v[112:115], v[184:187], a[32:35]
  v_mfma_f32_16x16x32_bf16 a[36:39], v[112:115], v[188:191], a[36:39]
  v_mfma_f32_16x16x32_bf16 a[40:43], v[112:115], v[192:195], a[40:43]
  v_mfma_f32_16x16x32_bf16 a[44:47], v[112:115], v[196:199], a[44:47]
  v_mfma_f32_16x16x32_bf16 a[48:51], v[116:119], v[184:187], a[48:51]
  v_mfma_f32_16x16x32_bf16 a[52:55], v[116:119], v[188:191], a[52:55]
  v_mfma_f32_16x16x32_bf16 a[56:59], v[116:119], v[192:195], a[56:59]
  v_mfma_f32_16x16x32_bf16 a[60:63], v[116:119], v[196:199], a[60:63]
  v_mfma_f32_16x16x32_bf16 a[64:67], v[120:123], v[184:187], a[64:67]
  v_mfma_f32_16x16x32_bf16 a[68:71], v[120:123], v[188:191], a[68:71]
  v_mfma_f32_16x16x32_bf16 a[72:75], v[120:123], v[192:195], a[72:75]
  v_mfma_f32_16x16x32_bf16 a[76:79], v[120:123], v[196:199], a[76:79]
  v_mfma_f32_16x16x32_bf16 a[80:83], v[124:127], v[184:187], a[80:83]
  v_mfma_f32_16x16x32_bf16 a[84:87], v[124:127], v[188:191], a[84:87]
  v_mfma_f32_16x16x32_bf16 a[88:91], v[124:127], v[192:195], a[88:91]
  v_mfma_f32_16x16x32_bf16 a[92:95], v[124:127], v[196:199], a[92:95]
  v_mfma_f32_16x16x32_bf16 a[96:99], v[128:131], v[184:187], a[96:99]
  v_mfma_f32_16x16x32_bf16 a[100:103], v[128:131], v[188:191], a[100:103]
  v_mfma_f32_16x16x32_bf16 a[104:107], v[128:131], v[192:195], a[104:107]
  v_mfma_f32_16x16x32_bf16 a[108:111], v[128:131], v[196:199], a[108:111]
  v_mfma_f32_16x16x32_bf16 a[112:115], v[132:135], v[184:187], a[112:115]
  v_mfma_f32_16x16x32_bf16 a[116:119], v[132:135], v[188:191], a[116:119]
  v_mfma_f32_16x16x32_bf16 a[120:123], v[132:135], v[192:195], a[120:123]
  v_mfma_f32_16x16x32_bf16 a[124:127], v[132:135], v[196:199], a[124:127]
  v_mfma_f32_16x16x32_bf16 a[128:131], v[136:139], v[184:187], a[128:131]
  v_mfma_f32_16x16x32_bf16 a[132:135], v[136:139], v[188:191], a[132:135]
  v_mfma_f32_16x16x32_bf16 a[136:139], v[136:139], v[192:195], a[136:139]
  v_mfma_f32_16x16x32_bf16 a[140:143], v[136:139], v[196:199], a[140:143]
  v_mfma_f32_16x16x32_bf16 a[144:147], v[140:143], v[184:187], a[144:147]
  v_mfma_f32_16x16x32_bf16 a[148:151], v[140:143], v[188:191], a[148:151]
  v_mfma_f32_16x16x32_bf16 a[152:155], v[140:143], v[192:195], a[152:155]
  v_mfma_f32_16x16x32_bf16 a[156:159], v[140:143], v[196:199], a[156:159]
  buffer_load_dwordx4 v[104:107], v1, s[4:7], s30 offen offset:2048
  buffer_load_dwordx4 v[108:111], v1, s[4:7], s31 offen offset:2048
  buffer_load_dwordx4 v[112:115], v1, s[4:7], s32 offen offset:2048
  buffer_load_dwordx4 v[116:119], v1, s[4:7], s33 offen offset:2048
  buffer_load_dwordx4 v[120:123], v1, s[4:7], s34 offen offset:2048
  buffer_load_dwordx4 v[124:127], v1, s[4:7], s35 offen offset:2048
  buffer_load_dwordx4 v[128:131], v1, s[4:7], s36 offen offset:2048
  buffer_load_dwordx4 v[132:135], v1, s[4:7], s37 offen offset:2048
  buffer_load_dwordx4 v[136:139], v1, s[4:7], s38 offen offset:2048
  buffer_load_dwordx4 v[140:143], v1, s[4:7], s39 offen offset:2048
  s_waitcnt vmcnt(30)
  ds_read_b128 v[184:187], v1 offset:16384
  ds_read_b128 v[188:191], v1 offset:40960
  ds_read_b128 v[192:195], v6 offset:16384
  ds_read_b128 v[196:199], v6 offset:40960
  s_waitcnt lgkmcnt(4)
  v_mfma_f32_16x16x32_bf16 a[0:3], v[144:147], v[200:203], a[0:3]
  v_mfma_f32_16x16x32_bf16 a[4:7], v[144:147], v[204:207], a[4:7]
  v_mfma_f32_16x16x32_bf16 a[8:11], v[144:147], v[208:211], a[8:11]
  v_mfma_f32_16x16x32_bf16 a[12:15], v[144:147], v[212:215], a[12:15]
  v_mfma_f32_16x16x32_bf16 a[16:19], v[148:151], v[200:203], a[16:19]
  v_mfma_f32_16x16x32_bf16 a[20:23], v[148:151], v[204:207], a[20:23]
  v_mfma_f32_16x16x32_bf16 a[24:27], v[148:151], v[208:211], a[24:27]
  v_mfma_f32_16x16x32_bf16 a[28:31], v[148:151], v[212:215], a[28:31]
  v_mfma_f32_16x16x32_bf16 a[32:35], v[152:155], v[200:203], a[32:35]
  v_mfma_f32_16x16x32_bf16 a[36:39], v[152:155], v[204:207], a[36:39]
  v_mfma_f32_16x16x32_bf16 a[40:43], v[152:155], v[208:211], a[40:43]
  v_mfma_f32_16x16x32_bf16 a[44:47], v[152:155], v[212:215], a[44:47]
  v_mfma_f32_16x16x32_bf16 a[48:51], v[156:159], v[200:203], a[48:51]
  v_mfma_f32_16x16x32_bf16 a[52:55], v[156:159], v[204:207], a[52:55]
  v_mfma_f32_16x16x32_bf16 a[56:59], v[156:159], v[208:211], a[56:59]
  v_mfma_f32_16x16x32_bf16 a[60:63], v[156:159], v[212:215], a[60:63]
  v_mfma_f32_16x16x32_bf16 a[64:67], v[160:163], v[200:203], a[64:67]
  v_mfma_f32_16x16x32_bf16 a[68:71], v[160:163], v[204:207], a[68:71]
  v_mfma_f32_16x16x32_bf16 a[72:75], v[160:163], v[208:211], a[72:75]
  v_mfma_f32_16x16x32_bf16 a[76:79], v[160:163], v[212:215], a[76:79]
  v_mfma_f32_16x16x32_bf16 a[80:83], v[164:167], v[200:203], a[80:83]
  v_mfma_f32_16x16x32_bf16 a[84:87], v[164:167], v[204:207], a[84:87]
  v_mfma_f32_16x16x32_bf16 a[88:91], v[164:167], v[208:211], a[88:91]
  v_mfma_f32_16x16x32_bf16 a[92:95], v[164:167], v[212:215], a[92:95]
  v_mfma_f32_16x16x32_bf16 a[96:99], v[168:171], v[200:203], a[96:99]
  v_mfma_f32_16x16x32_bf16 a[100:103], v[168:171], v[204:207], a[100:103]
  v_mfma_f32_16x16x32_bf16 a[104:107], v[168:171], v[208:211], a[104:107]
  v_mfma_f32_16x16x32_bf16 a[108:111], v[168:171], v[212:215], a[108:111]
  v_mfma_f32_16x16x32_bf16 a[112:115], v[172:175], v[200:203], a[112:115]
  v_mfma_f32_16x16x32_bf16 a[116:119], v[172:175], v[204:207], a[116:119]
  v_mfma_f32_16x16x32_bf16 a[120:123], v[172:175], v[208:211], a[120:123]
  v_mfma_f32_16x16x32_bf16 a[124:127], v[172:175], v[212:215], a[124:127]
  v_mfma_f32_16x16x32_bf16 a[128:131], v[176:179], v[200:203], a[128:131]
  v_mfma_f32_16x16x32_bf16 a[132:135], v[176:179], v[204:207], a[132:135]
  v_mfma_f32_16x16x32_bf16 a[136:139], v[176:179], v[208:211], a[136:139]
  v_mfma_f32_16x16x32_bf16 a[140:143], v[176:179], v[212:215], a[140:143]
  v_mfma_f32_16x16x32_bf16 a[144:147], v[180:183], v[200:203], a[144:147]
  v_mfma_f32_16x16x32_bf16 a[148:151], v[180:183], v[204:207], a[148:151]
  v_mfma_f32_16x16x32_bf16 a[152:155], v[180:183], v[208:211], a[152:155]
  v_mfma_f32_16x16x32_bf16 a[156:159], v[180:183], v[212:215], a[156:159]
  buffer_load_dwordx4 v[144:147], v1, s[4:7], s30 offen offset:3072
  buffer_load_dwordx4 v[148:151], v1, s[4:7], s31 offen offset:3072
  buffer_load_dwordx4 v[152:155], v1, s[4:7], s32 offen offset:3072
  buffer_load_dwordx4 v[156:159], v1, s[4:7], s33 offen offset:3072
  buffer_load_dwordx4 v[160:163], v1, s[4:7], s34 offen offset:3072
  buffer_load_dwordx4 v[164:167], v1, s[4:7], s35 offen offset:3072
  buffer_load_dwordx4 v[168:171], v1, s[4:7], s36 offen offset:3072
  buffer_load_dwordx4 v[172:175], v1, s[4:7], s37 offen offset:3072
  buffer_load_dwordx4 v[176:179], v1, s[4:7], s38 offen offset:3072
  buffer_load_dwordx4 v[180:183], v1, s[4:7], s39 offen offset:3072
  s_add_u32 s30, s30, 4096
  s_add_u32 s31, s31, 4096
  s_add_u32 s32, s32, 4096
  s_add_u32 s33, s33, 4096
  s_add_u32 s34, s34, 4096
  s_add_u32 s35, s35, 4096
  s_add_u32 s36, s36, 4096
  s_add_u32 s37, s37, 4096
  s_add_u32 s38, s38, 4096
  s_add_u32 s39, s39, 4096
  s_waitcnt vmcnt(30)
  ds_read_b128 v[200:203], v1 offset:17408
  ds_read_b128 v[204:207], v1 offset:41984
  ds_read_b128 v[208:211], v6 offset:17408
  ds_read_b128 v[212:215], v6 offset:41984
  s_waitcnt lgkmcnt(4)
  v_mfma_f32_16x16x32_bf16 a[0:3], v[24:27], v[184:187], a[0:3]
  v_mfma_f32_16x16x32_bf16 a[4:7], v[24:27], v[188:191], a[4:7]
  v_mfma_f32_16x16x32_bf16 a[8:11], v[24:27], v[192:195], a[8:11]
  v_mfma_f32_16x16x32_bf16 a[12:15], v[24:27], v[196:199], a[12:15]
  v_mfma_f32_16x16x32_bf16 a[16:19], v[28:31], v[184:187], a[16:19]
  v_mfma_f32_16x16x32_bf16 a[20:23], v[28:31], v[188:191], a[20:23]
  v_mfma_f32_16x16x32_bf16 a[24:27], v[28:31], v[192:195], a[24:27]
  v_mfma_f32_16x16x32_bf16 a[28:31], v[28:31], v[196:199], a[28:31]
  v_mfma_f32_16x16x32_bf16 a[32:35], v[32:35], v[184:187], a[32:35]
  v_mfma_f32_16x16x32_bf16 a[36:39], v[32:35], v[188:191], a[36:39]
  v_mfma_f32_16x16x32_bf16 a[40:43], v[32:35], v[192:195], a[40:43]
  v_mfma_f32_16x16x32_bf16 a[44:47], v[32:35], v[196:199], a[44:47]
  v_mfma_f32_16x16x32_bf16 a[48:51], v[36:39], v[184:187], a[48:51]
  v_mfma_f32_16x16x32_bf16 a[52:55], v[36:39], v[188:191], a[52:55]
  v_mfma_f32_16x16x32_bf16 a[56:59], v[36:39], v[192:195], a[56:59]
  v_mfma_f32_16x16x32_bf16 a[60:63], v[36:39], v[196:199], a[60:63]
  v_mfma_f32_16x16x32_bf16 a[64:67], v[40:43], v[184:187], a[64:67]
  v_mfma_f32_16x16x32_bf16 a[68:71], v[40:43], v[188:191], a[68:71]
  v_mfma_f32_16x16x32_bf16 a[72:75], v[40:43], v[192:195], a[72:75]
  v_mfma_f32_16x16x32_bf16 a[76:79], v[40:43], v[196:199], a[76:79]
  v_mfma_f32_16x16x32_bf16 a[80:83], v[44:47], v[184:187], a[80:83]
  v_mfma_f32_16x16x32_bf16 a[84:87], v[44:47], v[188:191], a[84:87]
  v_mfma_f32_16x16x32_bf16 a[88:91], v[44:47], v[192:195], a[88:91]
  v_mfma_f32_16x16x32_bf16 a[92:95], v[44:47], v[196:199], a[92:95]
  v_mfma_f32_16x16x32_bf16 a[96:99], v[48:51], v[184:187], a[96:99]
  v_mfma_f32_16x16x32_bf16 a[100:103], v[48:51], v[188:191], a[100:103]
  v_mfma_f32_16x16x32_bf16 a[104:107], v[48:51], v[192:195], a[104:107]
  v_mfma_f32_16x16x32_bf16 a[108:111], v[48:51], v[196:199], a[108:111]
  v_mfma_f32_16x16x32_bf16 a[112:115], v[52:55], v[184:187], a[112:115]
  v_mfma_f32_16x16x32_bf16 a[116:119], v[52:55], v[188:191], a[116:119]
  v_mfma_f32_16x16x32_bf16 a[120:123], v[52:55], v[192:195], a[120:123]
  v_mfma_f32_16x16x32_bf16 a[124:127], v[52:55], v[196:199], a[124:127]
  v_mfma_f32_16x16x32_bf16 a[128:131], v[56:59], v[184:187], a[128:131]
  v_mfma_f32_16x16x32_bf16 a[132:135], v[56:59], v[188:191], a[132:135]
  v_mfma_f32_16x16x32_bf16 a[136:139], v[56:59], v[192:195], a[136:139]
  v_mfma_f32_16x16x32_bf16 a[140:143], v[56:59], v[196:199], a[140:143]
  v_mfma_f32_16x16x32_bf16 a[144:147], v[60:63], v[184:187], a[144:147]
  v_mfma_f32_16x16x32_bf16 a[148:151], v[60:63], v[188:191], a[148:151]
  v_mfma_f32_16x16x32_bf16 a[152:155], v[60:63], v[192:195], a[152:155]
  v_mfma_f32_16x16x32_bf16 a[156:159], v[60:63], v[196:199], a[156:159]
  buffer_load_dwordx4 v[24:27], v1, s[4:7], s30 offen offset:0
  buffer_load_dwordx4 v[28:31], v1, s[4:7], s31 offen offset:0
  buffer_load_dwordx4 v[32:35], v1, s[4:7], s32 offen offset:0
  buffer_load_dwordx4 v[36:39], v1, s[4:7], s33 offen offset:0
  buffer_load_dwordx4 v[40:43], v1, s[4:7], s34 offen offset:0
  buffer_load_dwordx4 v[44:47], v1, s[4:7], s35 offen offset:0
  buffer_load_dwordx4 v[48:51], v1, s[4:7], s36 offen offset:0
  buffer_load_dwordx4 v[52:55], v1, s[4:7], s37 offen offset:0
  buffer_load_dwordx4 v[56:59], v1, s[4:7], s38 offen offset:0
  buffer_load_dwordx4 v[60:63], v1, s[4:7], s39 offen offset:0
  s_waitcnt vmcnt(30)
  ds_read_b128 v[184:187], v1 offset:18432
  ds_read_b128 v[188:191], v1 offset:43008
  ds_read_b128 v[192:195], v6 offset:18432
  ds_read_b128 v[196:199], v6 offset:43008
  s_waitcnt lgkmcnt(4)
  v_mfma_f32_16x16x32_bf16 a[0:3], v[64:67], v[200:203], a[0:3]
  v_mfma_f32_16x16x32_bf16 a[4:7], v[64:67], v[204:207], a[4:7]
  v_mfma_f32_16x16x32_bf16 a[8:11], v[64:67], v[208:211], a[8:11]
  v_mfma_f32_16x16x32_bf16 a[12:15], v[64:67], v[212:215], a[12:15]
  v_mfma_f32_16x16x32_bf16 a[16:19], v[68:71], v[200:203], a[16:19]
  v_mfma_f32_16x16x32_bf16 a[20:23], v[68:71], v[204:207], a[20:23]
  v_mfma_f32_16x16x32_bf16 a[24:27], v[68:71], v[208:211], a[24:27]
  v_mfma_f32_16x16x32_bf16 a[28:31], v[68:71], v[212:215], a[28:31]
  v_mfma_f32_16x16x32_bf16 a[32:35], v[72:75], v[200:203], a[32:35]
  v_mfma_f32_16x16x32_bf16 a[36:39], v[72:75], v[204:207], a[36:39]
  v_mfma_f32_16x16x32_bf16 a[40:43], v[72:75], v[208:211], a[40:43]
  v_mfma_f32_16x16x32_bf16 a[44:47], v[72:75], v[212:215], a[44:47]
  v_mfma_f32_16x16x32_bf16 a[48:51], v[76:79], v[200:203], a[48:51]
  v_mfma_f32_16x16x32_bf16 a[52:55], v[76:79], v[204:207], a[52:55]
  v_mfma_f32_16x16x32_bf16 a[56:59], v[76:79], v[208:211], a[56:59]
  v_mfma_f32_16x16x32_bf16 a[60:63], v[76:79], v[212:215], a[60:63]
  v_mfma_f32_16x16x32_bf16 a[64:67], v[80:83], v[200:203], a[64:67]
  v_mfma_f32_16x16x32_bf16 a[68:71], v[80:83], v[204:207], a[68:71]
  v_mfma_f32_16x16x32_bf16 a[72:75], v[80:83], v[208:211], a[72:75]
  v_mfma_f32_16x16x32_bf16 a[76:79], v[80:83], v[212:215], a[76:79]
  v_mfma_f32_16x16x32_bf16 a[80:83], v[84:87], v[200:203], a[80:83]
  v_mfma_f32_16x16x32_bf16 a[84:87], v[84:87], v[204:207], a[84:87]
  v_mfma_f32_16x16x32_bf16 a[88:91], v[84:87], v[208:211], a[88:91]
  v_mfma_f32_16x16x32_bf16 a[92:95], v[84:87], v[212:215], a[92:95]
  v_mfma_f32_16x16x32_bf16 a[96:99], v[88:91], v[200:203], a[96:99]
  v_mfma_f32_16x16x32_bf16 a[100:103], v[88:91], v[204:207], a[100:103]
  v_mfma_f32_16x16x32_bf16 a[104:107], v[88:91], v[208:211], a[104:107]
  v_mfma_f32_16x16x32_bf16 a[108:111], v[88:91], v[212:215], a[108:111]
  v_mfma_f32_16x16x32_bf16 a[112:115], v[92:95], v[200:203], a[112:115]
  v_mfma_f32_16x16x32_bf16 a[116:119], v[92:95], v[204:207], a[116:119]
  v_mfma_f32_16x16x32_bf16 a[120:123], v[92:95], v[208:211], a[120:123]
  v_mfma_f32_16x16x32_bf16 a[124:127], v[92:95], v[212:215], a[124:127]
  v_mfma_f32_16x16x32_bf16 a[128:131], v[96:99], v[200:203], a[128:131]
  v_mfma_f32_16x16x32_bf16 a[132:135], v[96:99], v[204:207], a[132:135]
  v_mfma_f32_16x16x32_bf16 a[136:139], v[96:99], v[208:211], a[136:139]
  v_mfma_f32_16x16x32_bf16 a[140:143], v[96:99], v[212:215], a[140:143]
  v_mfma_f32_16x16x32_bf16 a[144:147], v[100:103], v[200:203], a[144:147]
  v_mfma_f32_16x16x32_bf16 a[148:151], v[100:103], v[204:207], a[148:151]
  v_mfma_f32_16x16x32_bf16 a[152:155], v[100:103], v[208:211], a[152:155]
  v_mfma_f32_16x16x32_bf16 a[156:159], v[100:103], v[212:215], a[156:159]
  buffer_load_dwordx4 v[64:67], v1, s[4:7], s30 offen offset:1024
  buffer_load_dwordx4 v[68:71], v1, s[4:7], s31 offen offset:1024
  buffer_load_dwordx4 v[72:75], v1, s[4:7], s32 offen offset:1024
  buffer_load_dwordx4 v[76:79], v1, s[4:7], s33 offen offset:1024
  buffer_load_dwordx4 v[80:83], v1, s[4:7], s34 offen offset:1024
  buffer_load_dwordx4 v[84:87], v1, s[4:7], s35 offen offset:1024
  buffer_load_dwordx4 v[88:91], v1, s[4:7], s36 offen offset:1024
  buffer_load_dwordx4 v[92:95], v1, s[4:7], s37 offen offset:1024
  buffer_load_dwordx4 v[96:99], v1, s[4:7], s38 offen offset:1024
  buffer_load_dwordx4 v[100:103], v1, s[4:7], s39 offen offset:1024
  s_waitcnt vmcnt(30)
  ds_read_b128 v[200:203], v1 offset:19456
  ds_read_b128 v[204:207], v1 offset:44032
  ds_read_b128 v[208:211], v6 offset:19456
  ds_read_b128 v[212:215], v6 offset:44032
  s_waitcnt lgkmcnt(4)
  v_mfma_f32_16x16x32_bf16 a[0:3], v[104:107], v[184:187], a[0:3]
  v_mfma_f32_16x16x32_bf16 a[4:7], v[104:107], v[188:191], a[4:7]
  v_mfma_f32_16x16x32_bf16 a[8:11], v[104:107], v[192:195], a[8:11]
  v_mfma_f32_16x16x32_bf16 a[12:15], v[104:107], v[196:199], a[12:15]
  v_mfma_f32_16x16x32_bf16 a[16:19], v[108:111], v[184:187], a[16:19]
  v_mfma_f32_16x16x32_bf16 a[20:23], v[108:111], v[188:191], a[20:23]
  v_mfma_f32_16x16x32_bf16 a[24:27], v[108:111], v[192:195], a[24:27]
  v_mfma_f32_16x16x32_bf16 a[28:31], v[108:111], v[196:199], a[28:31]
  v_mfma_f32_16x16x32_bf16 a[32:35], v[112:115], v[184:187], a[32:35]
  v_mfma_f32_16x16x32_bf16 a[36:39], v[112:115], v[188:191], a[36:39]
  v_mfma_f32_16x16x32_bf16 a[40:43], v[112:115], v[192:195], a[40:43]
  v_mfma_f32_16x16x32_bf16 a[44:47], v[112:115], v[196:199], a[44:47]
  v_mfma_f32_16x16x32_bf16 a[48:51], v[116:119], v[184:187], a[48:51]
  v_mfma_f32_16x16x32_bf16 a[52:55], v[116:119], v[188:191], a[52:55]
  v_mfma_f32_16x16x32_bf16 a[56:59], v[116:119], v[192:195], a[56:59]
  v_mfma_f32_16x16x32_bf16 a[60:63], v[116:119], v[196:199], a[60:63]
  v_mfma_f32_16x16x32_bf16 a[64:67], v[120:123], v[184:187], a[64:67]
  v_mfma_f32_16x16x32_bf16 a[68:71], v[120:123], v[188:191], a[68:71]
  v_mfma_f32_16x16x32_bf16 a[72:75], v[120:123], v[192:195], a[72:75]
  v_mfma_f32_16x16x32_bf16 a[76:79], v[120:123], v[196:199], a[76:79]
  v_mfma_f32_16x16x32_bf16 a[80:83], v[124:127], v[184:187], a[80:83]
  v_mfma_f32_16x16x32_bf16 a[84:87], v[124:127], v[188:191], a[84:87]
  v_mfma_f32_16x16x32_bf16 a[88:91], v[124:127], v[192:195], a[88:91]
  v_mfma_f32_16x16x32_bf16 a[92:95], v[124:127], v[196:199], a[92:95]
  v_mfma_f32_16x16x32_bf16 a[96:99], v[128:131], v[184:187], a[96:99]
  v_mfma_f32_16x16x32_bf16 a[100:103], v[128:131], v[188:191], a[100:103]
  v_mfma_f32_16x16x32_bf16 a[104:107], v[128:131], v[192:195], a[104:107]
  v_mfma_f32_16x16x32_bf16 a[108:111], v[128:131], v[196:199], a[108:111]
  v_mfma_f32_16x16x32_bf16 a[112:115], v[132:135], v[184:187], a[112:115]
  v_mfma_f32_16x16x32_bf16 a[116:119], v[132:135], v[188:191], a[116:119]
  v_mfma_f32_16x16x32_bf16 a[120:123], v[132:135], v[192:195], a[120:123]
  v_mfma_f32_16x16x32_bf16 a[124:127], v[132:135], v[196:199], a[124:127]
  v_mfma_f32_16x16x32_bf16 a[128:131], v[136:139], v[184:187], a[128:131]
  v_mfma_f32_16x16x32_bf16 a[132:135], v[136:139], v[188:191], a[132:135]
  v_mfma_f32_16x16x32_bf16 a[136:139], v[136:139], v[192:195], a[136:139]
  v_mfma_f32_16x16x32_bf16 a[140:143], v[136:139], v[196:199], a[140:143]
  v_mfma_f32_16x16x32_bf16 a[144:147], v[140:143], v[184:187], a[144:147]
  v_mfma_f32_16x16x32_bf16 a[148:151], v[140:143], v[188:191], a[148:151]
  v_mfma_f32_16x16x32_bf16 a[152:155], v[140:143], v[192:195], a[152:155]
  v_mfma_f32_16x16x32_bf16 a[156:159], v[140:143], v[196:199], a[156:159]
  buffer_load_dwordx4 v[104:107], v1, s[4:7], s30 offen offset:2048
  buffer_load_dwordx4 v[108:111], v1, s[4:7], s31 offen offset:2048
  buffer_load_dwordx4 v[112:115], v1, s[4:7], s32 offen offset:2048
  buffer_load_dwordx4 v[116:119], v1, s[4:7], s33 offen offset:2048
  buffer_load_dwordx4 v[120:123], v1, s[4:7], s34 offen offset:2048
  buffer_load_dwordx4 v[124:127], v1, s[4:7], s35 offen offset:2048
  buffer_load_dwordx4 v[128:131], v1, s[4:7], s36 offen offset:2048
  buffer_load_dwordx4 v[132:135], v1, s[4:7], s37 offen offset:2048
  buffer_load_dwordx4 v[136:139], v1, s[4:7], s38 offen offset:2048
  buffer_load_dwordx4 v[140:143], v1, s[4:7], s39 offen offset:2048
  s_waitcnt vmcnt(30)
  ds_read_b128 v[184:187], v1 offset:20480
  ds_read_b128 v[188:191], v1 offset:45056
  ds_read_b128 v[192:195], v6 offset:20480
  ds_read_b128 v[196:199], v6 offset:45056
  s_waitcnt lgkmcnt(4)
  v_mfma_f32_16x16x32_bf16 a[0:3], v[144:147], v[200:203], a[0:3]
  v_mfma_f32_16x16x32_bf16 a[4:7], v[144:147], v[204:207], a[4:7]
  v_mfma_f32_16x16x32_bf16 a[8:11], v[144:147], v[208:211], a[8:11]
  v_mfma_f32_16x16x32_bf16 a[12:15], v[144:147], v[212:215], a[12:15]
  v_mfma_f32_16x16x32_bf16 a[16:19], v[148:151], v[200:203], a[16:19]
  v_mfma_f32_16x16x32_bf16 a[20:23], v[148:151], v[204:207], a[20:23]
  v_mfma_f32_16x16x32_bf16 a[24:27], v[148:151], v[208:211], a[24:27]
  v_mfma_f32_16x16x32_bf16 a[28:31], v[148:151], v[212:215], a[28:31]
  v_mfma_f32_16x16x32_bf16 a[32:35], v[152:155], v[200:203], a[32:35]
  v_mfma_f32_16x16x32_bf16 a[36:39], v[152:155], v[204:207], a[36:39]
  v_mfma_f32_16x16x32_bf16 a[40:43], v[152:155], v[208:211], a[40:43]
  v_mfma_f32_16x16x32_bf16 a[44:47], v[152:155], v[212:215], a[44:47]
  v_mfma_f32_16x16x32_bf16 a[48:51], v[156:159], v[200:203], a[48:51]
  v_mfma_f32_16x16x32_bf16 a[52:55], v[156:159], v[204:207], a[52:55]
  v_mfma_f32_16x16x32_bf16 a[56:59], v[156:159], v[208:211], a[56:59]
  v_mfma_f32_16x16x32_bf16 a[60:63], v[156:159], v[212:215], a[60:63]
  v_mfma_f32_16x16x32_bf16 a[64:67], v[160:163], v[200:203], a[64:67]
  v_mfma_f32_16x16x32_bf16 a[68:71], v[160:163], v[204:207], a[68:71]
  v_mfma_f32_16x16x32_bf16 a[72:75], v[160:163], v[208:211], a[72:75]
  v_mfma_f32_16x16x32_bf16 a[76:79], v[160:163], v[212:215], a[76:79]
  v_mfma_f32_16x16x32_bf16 a[80:83], v[164:167], v[200:203], a[80:83]
  v_mfma_f32_16x16x32_bf16 a[84:87], v[164:167], v[204:207], a[84:87]
  v_mfma_f32_16x16x32_bf16 a[88:91], v[164:167], v[208:211], a[88:91]
  v_mfma_f32_16x16x32_bf16 a[92:95], v[164:167], v[212:215], a[92:95]
  v_mfma_f32_16x16x32_bf16 a[96:99], v[168:171], v[200:203], a[96:99]
  v_mfma_f32_16x16x32_bf16 a[100:103], v[168:171], v[204:207], a[100:103]
  v_mfma_f32_16x16x32_bf16 a[104:107], v[168:171], v[208:211], a[104:107]
  v_mfma_f32_16x16x32_bf16 a[108:111], v[168:171], v[212:215], a[108:111]
  v_mfma_f32_16x16x32_bf16 a[112:115], v[172:175], v[200:203], a[112:115]
  v_mfma_f32_16x16x32_bf16 a[116:119], v[172:175], v[204:207], a[116:119]
  v_mfma_f32_16x16x32_bf16 a[120:123], v[172:175], v[208:211], a[120:123]
  v_mfma_f32_16x16x32_bf16 a[124:127], v[172:175], v[212:215], a[124:127]
  v_mfma_f32_16x16x32_bf16 a[128:131], v[176:179], v[200:203], a[128:131]
  v_mfma_f32_16x16x32_bf16 a[132:135], v[176:179], v[204:207], a[132:135]
  v_mfma_f32_16x16x32_bf16 a[136:139], v[176:179], v[208:211], a[136:139]
  v_mfma_f32_16x16x32_bf16 a[140:143], v[176:179], v[212:215], a[140:143]
  v_mfma_f32_16x16x32_bf16 a[144:147], v[180:183], v[200:203], a[144:147]
  v_mfma_f32_16x16x32_bf16 a[148:151], v[180:183], v[204:207], a[148:151]
  v_mfma_f32_16x16x32_bf16 a[152:155], v[180:183], v[208:211], a[152:155]
  v_mfma_f32_16x16x32_bf16 a[156:159], v[180:183], v[212:215], a[156:159]
  buffer_load_dwordx4 v[144:147], v1, s[4:7], s30 offen offset:3072
  buffer_load_dwordx4 v[148:151], v1, s[4:7], s31 offen offset:3072
  buffer_load_dwordx4 v[152:155], v1, s[4:7], s32 offen offset:3072
  buffer_load_dwordx4 v[156:159], v1, s[4:7], s33 offen offset:3072
  buffer_load_dwordx4 v[160:163], v1, s[4:7], s34 offen offset:3072
  buffer_load_dwordx4 v[164:167], v1, s[4:7], s35 offen offset:3072
  buffer_load_dwordx4 v[168:171], v1, s[4:7], s36 offen offset:3072
  buffer_load_dwordx4 v[172:175], v1, s[4:7], s37 offen offset:3072
  buffer_load_dwordx4 v[176:179], v1, s[4:7], s38 offen offset:3072
  buffer_load_dwordx4 v[180:183], v1, s[4:7], s39 offen offset:3072
  s_add_u32 s30, s30, 4096
  s_add_u32 s31, s31, 4096
  s_add_u32 s32, s32, 4096
  s_add_u32 s33, s33, 4096
  s_add_u32 s34, s34, 4096
  s_add_u32 s35, s35, 4096
  s_add_u32 s36, s36, 4096
  s_add_u32 s37, s37, 4096
  s_add_u32 s38, s38, 4096
  s_add_u32 s39, s39, 4096
  s_waitcnt vmcnt(30)
  ds_read_b128 v[200:203], v1 offset:21504
  ds_read_b128 v[204:207], v1 offset:46080
  ds_read_b128 v[208:211], v6 offset:21504
  ds_read_b128 v[212:215], v6 offset:46080
  s_waitcnt lgkmcnt(4)
  v_mfma_f32_16x16x32_bf16 a[0:3], v[24:27], v[184:187], a[0:3]
  v_mfma_f32_16x16x32_bf16 a[4:7], v[24:27], v[188:191], a[4:7]
  v_mfma_f32_16x16x32_bf16 a[8:11], v[24:27], v[192:195], a[8:11]
  v_mfma_f32_16x16x32_bf16 a[12:15], v[24:27], v[196:199], a[12:15]
  v_mfma_f32_16x16x32_bf16 a[16:19], v[28:31], v[184:187], a[16:19]
  v_mfma_f32_16x16x32_bf16 a[20:23], v[28:31], v[188:191], a[20:23]
  v_mfma_f32_16x16x32_bf16 a[24:27], v[28:31], v[192:195], a[24:27]
  v_mfma_f32_16x16x32_bf16 a[28:31], v[28:31], v[196:199], a[28:31]
  v_mfma_f32_16x16x32_bf16 a[32:35], v[32:35], v[184:187], a[32:35]
  v_mfma_f32_16x16x32_bf16 a[36:39], v[32:35], v[188:191], a[36:39]
  v_mfma_f32_16x16x32_bf16 a[40:43], v[32:35], v[192:195], a[40:43]
  v_mfma_f32_16x16x32_bf16 a[44:47], v[32:35], v[196:199], a[44:47]
  v_mfma_f32_16x16x32_bf16 a[48:51], v[36:39], v[184:187], a[48:51]
  v_mfma_f32_16x16x32_bf16 a[52:55], v[36:39], v[188:191], a[52:55]
  v_mfma_f32_16x16x32_bf16 a[56:59], v[36:39], v[192:195], a[56:59]
  v_mfma_f32_16x16x32_bf16 a[60:63], v[36:39], v[196:199], a[60:63]
  v_mfma_f32_16x16x32_bf16 a[64:67], v[40:43], v[184:187], a[64:67]
  v_mfma_f32_16x16x32_bf16 a[68:71], v[40:43], v[188:191], a[68:71]
  v_mfma_f32_16x16x32_bf16 a[72:75], v[40:43], v[192:195], a[72:75]
  v_mfma_f32_16x16x32_bf16 a[76:79], v[40:43], v[196:199], a[76:79]
  v_mfma_f32_16x16x32_bf16 a[80:83], v[44:47], v[184:187], a[80:83]
  v_mfma_f32_16x16x32_bf16 a[84:87], v[44:47], v[188:191], a[84:87]
  v_mfma_f32_16x16x32_bf16 a[88:91], v[44:47], v[192:195], a[88:91]
  v_mfma_f32_16x16x32_bf16 a[92:95], v[44:47], v[196:199], a[92:95]
  v_mfma_f32_16x16x32_bf16 a[96:99], v[48:51], v[184:187], a[96:99]
  v_mfma_f32_16x16x32_bf16 a[100:103], v[48:51], v[188:191], a[100:103]
  v_mfma_f32_16x16x32_bf16 a[104:107], v[48:51], v[192:195], a[104:107]
  v_mfma_f32_16x16x32_bf16 a[108:111], v[48:51], v[196:199], a[108:111]
  v_mfma_f32_16x16x32_bf16 a[112:115], v[52:55], v[184:187], a[112:115]
  v_mfma_f32_16x16x32_bf16 a[116:119], v[52:55], v[188:191], a[116:119]
  v_mfma_f32_16x16x32_bf16 a[120:123], v[52:55], v[192:195], a[120:123]
  v_mfma_f32_16x16x32_bf16 a[124:127], v[52:55], v[196:199], a[124:127]
  v_mfma_f32_16x16x32_bf16 a[128:131], v[56:59], v[184:187], a[128:131]
  v_mfma_f32_16x16x32_bf16 a[132:135], v[56:59], v[188:191], a[132:135]
  v_mfma_f32_16x16x32_bf16 a[136:139], v[56:59], v[192:195], a[136:139]
  v_mfma_f32_16x16x32_bf16 a[140:143], v[56:59], v[196:199], a[140:143]
  v_mfma_f32_16x16x32_bf16 a[144:147], v[60:63], v[184:187], a[144:147]
  v_mfma_f32_16x16x32_bf16 a[148:151], v[60:63], v[188:191], a[148:151]
  v_mfma_f32_16x16x32_bf16 a[152:155], v[60:63], v[192:195], a[152:155]
  v_mfma_f32_16x16x32_bf16 a[156:159], v[60:63], v[196:199], a[156:159]
  s_waitcnt vmcnt(20)
  ds_read_b128 v[184:187], v1 offset:22528
  ds_read_b128 v[188:191], v1 offset:47104
  ds_read_b128 v[192:195], v6 offset:22528
  ds_read_b128 v[196:199], v6 offset:47104
  s_waitcnt lgkmcnt(4)
  v_mfma_f32_16x16x32_bf16 a[0:3], v[64:67], v[200:203], a[0:3]
  v_mfma_f32_16x16x32_bf16 a[4:7], v[64:67], v[204:207], a[4:7]
  v_mfma_f32_16x16x32_bf16 a[8:11], v[64:67], v[208:211], a[8:11]
  v_mfma_f32_16x16x32_bf16 a[12:15], v[64:67], v[212:215], a[12:15]
  v_mfma_f32_16x16x32_bf16 a[16:19], v[68:71], v[200:203], a[16:19]
  v_mfma_f32_16x16x32_bf16 a[20:23], v[68:71], v[204:207], a[20:23]
  v_mfma_f32_16x16x32_bf16 a[24:27], v[68:71], v[208:211], a[24:27]
  v_mfma_f32_16x16x32_bf16 a[28:31], v[68:71], v[212:215], a[28:31]
  v_mfma_f32_16x16x32_bf16 a[32:35], v[72:75], v[200:203], a[32:35]
  v_mfma_f32_16x16x32_bf16 a[36:39], v[72:75], v[204:207], a[36:39]
  v_mfma_f32_16x16x32_bf16 a[40:43], v[72:75], v[208:211], a[40:43]
  v_mfma_f32_16x16x32_bf16 a[44:47], v[72:75], v[212:215], a[44:47]
  v_mfma_f32_16x16x32_bf16 a[48:51], v[76:79], v[200:203], a[48:51]
  v_mfma_f32_16x16x32_bf16 a[52:55], v[76:79], v[204:207], a[52:55]
  v_mfma_f32_16x16x32_bf16 a[56:59], v[76:79], v[208:211], a[56:59]
  v_mfma_f32_16x16x32_bf16 a[60:63], v[76:79], v[212:215], a[60:63]
  v_mfma_f32_16x16x32_bf16 a[64:67], v[80:83], v[200:203], a[64:67]
  v_mfma_f32_16x16x32_bf16 a[68:71], v[80:83], v[204:207], a[68:71]
  v_mfma_f32_16x16x32_bf16 a[72:75], v[80:83], v[208:211], a[72:75]
  v_mfma_f32_16x16x32_bf16 a[76:79], v[80:83], v[212:215], a[76:79]
  v_mfma_f32_16x16x32_bf16 a[80:83], v[84:87], v[200:203], a[80:83]
  v_mfma_f32_16x16x32_bf16 a[84:87], v[84:87], v[204:207], a[84:87]
  v_mfma_f32_16x16x32_bf16 a[88:91], v[84:87], v[208:211], a[88:91]
  v_mfma_f32_16x16x32_bf16 a[92:95], v[84:87], v[212:215], a[92:95]
  v_mfma_f32_16x16x32_bf16 a[96:99], v[88:91], v[200:203], a[96:99]
  v_mfma_f32_16x16x32_bf16 a[100:103], v[88:91], v[204:207], a[100:103]
  v_mfma_f32_16x16x32_bf16 a[104:107], v[88:91], v[208:211], a[104:107]
  v_mfma_f32_16x16x32_bf16 a[108:111], v[88:91], v[212:215], a[108:111]
  v_mfma_f32_16x16x32_bf16 a[112:115], v[92:95], v[200:203], a[112:115]
  v_mfma_f32_16x16x32_bf16 a[116:119], v[92:95], v[204:207], a[116:119]
  v_mfma_f32_16x16x32_bf16 a[120:123], v[92:95], v[208:211], a[120:123]
  v_mfma_f32_16x16x32_bf16 a[124:127], v[92:95], v[212:215], a[124:127]
  v_mfma_f32_16x16x32_bf16 a[128:131], v[96:99], v[200:203], a[128:131]
  v_mfma_f32_16x16x32_bf16 a[132:135], v[96:99], v[204:207], a[132:135]
  v_mfma_f32_16x16x32_bf16 a[136:139], v[96:99], v[208:211], a[136:139]
  v_mfma_f32_16x16x32_bf16 a[140:143], v[96:99], v[212:215], a[140:143]
  v_mfma_f32_16x16x32_bf16 a[144:147], v[100:103], v[200:203], a[144:147]
  v_mfma_f32_16x16x32_bf16 a[148:151], v[100:103], v[204:207], a[148:151]
  v_mfma_f32_16x16x32_bf16 a[152:155], v[100:103], v[208:211], a[152:155]
  v_mfma_f32_16x16x32_bf16 a[156:159], v[100:103], v[212:215], a[156:159]
  s_waitcnt vmcnt(10)
  ds_read_b128 v[200:203], v1 offset:23552
  ds_read_b128 v[204:207], v1 offset:48128
  ds_read_b128 v[208:211], v6 offset:23552
  ds_read_b128 v[212:215], v6 offset:48128
  s_waitcnt lgkmcnt(4)
  v_mfma_f32_16x16x32_bf16 a[0:3], v[104:107], v[184:187], a[0:3]
  v_mfma_f32_16x16x32_bf16 a[4:7], v[104:107], v[188:191], a[4:7]
  v_mfma_f32_16x16x32_bf16 a[8:11], v[104:107], v[192:195], a[8:11]
  v_mfma_f32_16x16x32_bf16 a[12:15], v[104:107], v[196:199], a[12:15]
  v_mfma_f32_16x16x32_bf16 a[16:19], v[108:111], v[184:187], a[16:19]
  v_mfma_f32_16x16x32_bf16 a[20:23], v[108:111], v[188:191], a[20:23]
  v_mfma_f32_16x16x32_bf16 a[24:27], v[108:111], v[192:195], a[24:27]
  v_mfma_f32_16x16x32_bf16 a[28:31], v[108:111], v[196:199], a[28:31]
  v_mfma_f32_16x16x32_bf16 a[32:35], v[112:115], v[184:187], a[32:35]
  v_mfma_f32_16x16x32_bf16 a[36:39], v[112:115], v[188:191], a[36:39]
  v_mfma_f32_16x16x32_bf16 a[40:43], v[112:115], v[192:195], a[40:43]
  v_mfma_f32_16x16x32_bf16 a[44:47], v[112:115], v[196:199], a[44:47]
  v_mfma_f32_16x16x32_bf16 a[48:51], v[116:119], v[184:187], a[48:51]
  v_mfma_f32_16x16x32_bf16 a[52:55], v[116:119], v[188:191], a[52:55]
  v_mfma_f32_16x16x32_bf16 a[56:59], v[116:119], v[192:195], a[56:59]
  v_mfma_f32_16x16x32_bf16 a[60:63], v[116:119], v[196:199], a[60:63]
  v_mfma_f32_16x16x32_bf16 a[64:67], v[120:123], v[184:187], a[64:67]
  v_mfma_f32_16x16x32_bf16 a[68:71], v[120:123], v[188:191], a[68:71]
  v_mfma_f32_16x16x32_bf16 a[72:75], v[120:123], v[192:195], a[72:75]
  v_mfma_f32_16x16x32_bf16 a[76:79], v[120:123], v[196:199], a[76:79]
  v_mfma_f32_16x16x32_bf16 a[80:83], v[124:127], v[184:187], a[80:83]
  v_mfma_f32_16x16x32_bf16 a[84:87], v[124:127], v[188:191], a[84:87]
  v_mfma_f32_16x16x32_bf16 a[88:91], v[124:127], v[192:195], a[88:91]
  v_mfma_f32_16x16x32_bf16 a[92:95], v[124:127], v[196:199], a[92:95]
  v_mfma_f32_16x16x32_bf16 a[96:99], v[128:131], v[184:187], a[96:99]
  v_mfma_f32_16x16x32_bf16 a[100:103], v[128:131], v[188:191], a[100:103]
  v_mfma_f32_16x16x32_bf16 a[104:107], v[128:131], v[192:195], a[104:107]
  v_mfma_f32_16x16x32_bf16 a[108:111], v[128:131], v[196:199], a[108:111]
  v_mfma_f32_16x16x32_bf16 a[112:115], v[132:135], v[184:187], a[112:115]
  v_mfma_f32_16x16x32_bf16 a[116:119], v[132:135], v[188:191], a[116:119]
  v_mfma_f32_16x16x32_bf16 a[120:123], v[132:135], v[192:195], a[120:123]
  v_mfma_f32_16x16x32_bf16 a[124:127], v[132:135], v[196:199], a[124:127]
  v_mfma_f32_16x16x32_bf16 a[128:131], v[136:139], v[184:187], a[128:131]
  v_mfma_f32_16x16x32_bf16 a[132:135], v[136:139], v[188:191], a[132:135]
  v_mfma_f32_16x16x32_bf16 a[136:139], v[136:139], v[192:195], a[136:139]
  v_mfma_f32_16x16x32_bf16 a[140:143], v[136:139], v[196:199], a[140:143]
  v_mfma_f32_16x16x32_bf16 a[144:147], v[140:143], v[184:187], a[144:147]
  v_mfma_f32_16x16x32_bf16 a[148:151], v[140:143], v[188:191], a[148:151]
  v_mfma_f32_16x16x32_bf16 a[152:155], v[140:143], v[192:195], a[152:155]
  v_mfma_f32_16x16x32_bf16 a[156:159], v[140:143], v[196:199], a[156:159]
  s_waitcnt vmcnt(0)
  s_waitcnt lgkmcnt(0)
  v_mfma_f32_16x16x32_bf16 a[0:3], v[144:147], v[200:203], a[0:3]
  v_mfma_f32_16x16x32_bf16 a[4:7], v[144:147], v[204:207], a[4:7]
  v_mfma_f32_16x16x32_bf16 a[8:11], v[144:147], v[208:211], a[8:11]
  v_mfma_f32_16x16x32_bf16 a[12:15], v[144:147], v[212:215], a[12:15]
  v_mfma_f32_16x16x32_bf16 a[16:19], v[148:151], v[200:203], a[16:19]
  v_mfma_f32_16x16x32_bf16 a[20:23], v[148:151], v[204:207], a[20:23]
  v_mfma_f32_16x16x32_bf16 a[24:27], v[148:151], v[208:211], a[24:27]
  v_mfma_f32_16x16x32_bf16 a[28:31], v[148:151], v[212:215], a[28:31]
  v_mfma_f32_16x16x32_bf16 a[32:35], v[152:155], v[200:203], a[32:35]
  v_mfma_f32_16x16x32_bf16 a[36:39], v[152:155], v[204:207], a[36:39]
  v_mfma_f32_16x16x32_bf16 a[40:43], v[152:155], v[208:211], a[40:43]
  v_mfma_f32_16x16x32_bf16 a[44:47], v[152:155], v[212:215], a[44:47]
  v_mfma_f32_16x16x32_bf16 a[48:51], v[156:159], v[200:203], a[48:51]
  v_mfma_f32_16x16x32_bf16 a[52:55], v[156:159], v[204:207], a[52:55]
  v_mfma_f32_16x16x32_bf16 a[56:59], v[156:159], v[208:211], a[56:59]
  v_mfma_f32_16x16x32_bf16 a[60:63], v[156:159], v[212:215], a[60:63]
  v_mfma_f32_16x16x32_bf16 a[64:67], v[160:163], v[200:203], a[64:67]
  v_mfma_f32_16x16x32_bf16 a[68:71], v[160:163], v[204:207], a[68:71]
  v_mfma_f32_16x16x32_bf16 a[72:75], v[160:163], v[208:211], a[72:75]
  v_mfma_f32_16x16x32_bf16 a[76:79], v[160:163], v[212:215], a[76:79]
  v_mfma_f32_16x16x32_bf16 a[80:83], v[164:167], v[200:203], a[80:83]
  v_mfma_f32_16x16x32_bf16 a[84:87], v[164:167], v[204:207], a[84:87]
  v_mfma_f32_16x16x32_bf16 a[88:91], v[164:167], v[208:211], a[88:91]
  v_mfma_f32_16x16x32_bf16 a[92:95], v[164:167], v[212:215], a[92:95]
  v_mfma_f32_16x16x32_bf16 a[96:99], v[168:171], v[200:203], a[96:99]
  v_mfma_f32_16x16x32_bf16 a[100:103], v[168:171], v[204:207], a[100:103]
  v_mfma_f32_16x16x32_bf16 a[104:107], v[168:171], v[208:211], a[104:107]
  v_mfma_f32_16x16x32_bf16 a[108:111], v[168:171], v[212:215], a[108:111]
  v_mfma_f32_16x16x32_bf16 a[112:115], v[172:175], v[200:203], a[112:115]
  v_mfma_f32_16x16x32_bf16 a[116:119], v[172:175], v[204:207], a[116:119]
  v_mfma_f32_16x16x32_bf16 a[120:123], v[172:175], v[208:211], a[120:123]
  v_mfma_f32_16x16x32_bf16 a[124:127], v[172:175], v[212:215], a[124:127]
  v_mfma_f32_16x16x32_bf16 a[128:131], v[176:179], v[200:203], a[128:131]
  v_mfma_f32_16x16x32_bf16 a[132:135], v[176:179], v[204:207], a[132:135]
  v_mfma_f32_16x16x32_bf16 a[136:139], v[176:179], v[208:211], a[136:139]
  v_mfma_f32_16x16x32_bf16 a[140:143], v[176:179], v[212:215], a[140:143]
  v_mfma_f32_16x16x32_bf16 a[144:147], v[180:183], v[200:203], a[144:147]
  v_mfma_f32_16x16x32_bf16 a[148:151], v[180:183], v[204:207], a[148:151]
  v_mfma_f32_16x16x32_bf16 a[152:155], v[180:183], v[208:211], a[152:155]
  v_mfma_f32_16x16x32_bf16 a[156:159], v[180:183], v[212:215], a[156:159]
  s_lshl_b32 s16, s13, 7
  s_lshl_b32 s17, s14, 2
  s_add_u32 s16, s16, s17
  s_mul_i32 s16, s16, 20
  s_mul_i32 s17, s12, 5
  s_add_u32 s16, s16, s17
  s_lshl_b32 s16, s16, 10
  s_add_u32 s16, s16, 90832896
  s_nop 7
  s_add_u32 s17, s16, 0
  v_accvgpr_read_b32 v24, a0
  v_accvgpr_read_b32 v25, a1
  v_accvgpr_read_b32 v26, a2
  v_accvgpr_read_b32 v27, a3
  v_accvgpr_read_b32 v28, a16
  v_accvgpr_read_b32 v29, a17
  v_accvgpr_read_b32 v30, a18
  v_accvgpr_read_b32 v31, a19
  v_cvt_pk_bf16_f32 v32, v24, v25
  v_cvt_pk_bf16_f32 v33, v26, v27
  v_cvt_pk_bf16_f32 v34, v28, v29
  v_cvt_pk_bf16_f32 v35, v30, v31
  buffer_store_dwordx4 v[32:35], v1, s[4:7], s17 offen offset:0 sc1
  v_accvgpr_read_b32 v36, a32
  v_accvgpr_read_b32 v37, a33
  v_accvgpr_read_b32 v38, a34
  v_accvgpr_read_b32 v39, a35
  v_accvgpr_read_b32 v40, a48
  v_accvgpr_read_b32 v41, a49
  v_accvgpr_read_b32 v42, a50
  v_accvgpr_read_b32 v43, a51
  v_cvt_pk_bf16_f32 v44, v36, v37
  v_cvt_pk_bf16_f32 v45, v38, v39
  v_cvt_pk_bf16_f32 v46, v40, v41
  v_cvt_pk_bf16_f32 v47, v42, v43
  buffer_store_dwordx4 v[44:47], v1, s[4:7], s17 offen offset:1024 sc1
  v_accvgpr_read_b32 v48, a64
  v_accvgpr_read_b32 v49, a65
  v_accvgpr_read_b32 v50, a66
  v_accvgpr_read_b32 v51, a67
  v_accvgpr_read_b32 v52, a80
  v_accvgpr_read_b32 v53, a81
  v_accvgpr_read_b32 v54, a82
  v_accvgpr_read_b32 v55, a83
  v_cvt_pk_bf16_f32 v56, v48, v49
  v_cvt_pk_bf16_f32 v57, v50, v51
  v_cvt_pk_bf16_f32 v58, v52, v53
  v_cvt_pk_bf16_f32 v59, v54, v55
  buffer_store_dwordx4 v[56:59], v1, s[4:7], s17 offen offset:2048 sc1
  v_accvgpr_read_b32 v60, a96
  v_accvgpr_read_b32 v61, a97
  v_accvgpr_read_b32 v62, a98
  v_accvgpr_read_b32 v63, a99
  v_accvgpr_read_b32 v64, a112
  v_accvgpr_read_b32 v65, a113
  v_accvgpr_read_b32 v66, a114
  v_accvgpr_read_b32 v67, a115
  v_cvt_pk_bf16_f32 v68, v60, v61
  v_cvt_pk_bf16_f32 v69, v62, v63
  v_cvt_pk_bf16_f32 v70, v64, v65
  v_cvt_pk_bf16_f32 v71, v66, v67
  buffer_store_dwordx4 v[68:71], v1, s[4:7], s17 offen offset:3072 sc1
  v_accvgpr_read_b32 v24, a128
  v_accvgpr_read_b32 v25, a129
  v_accvgpr_read_b32 v26, a130
  v_accvgpr_read_b32 v27, a131
  v_accvgpr_read_b32 v28, a144
  v_accvgpr_read_b32 v29, a145
  v_accvgpr_read_b32 v30, a146
  v_accvgpr_read_b32 v31, a147
  v_cvt_pk_bf16_f32 v32, v24, v25
  v_cvt_pk_bf16_f32 v33, v26, v27
  v_cvt_pk_bf16_f32 v34, v28, v29
  v_cvt_pk_bf16_f32 v35, v30, v31
  s_add_u32 s17, s17, 4096
  buffer_store_dwordx4 v[32:35], v1, s[4:7], s17 offen offset:0 sc1
  s_add_u32 s17, s16, 20480
  v_accvgpr_read_b32 v36, a4
  v_accvgpr_read_b32 v37, a5
  v_accvgpr_read_b32 v38, a6
  v_accvgpr_read_b32 v39, a7
  v_accvgpr_read_b32 v40, a20
  v_accvgpr_read_b32 v41, a21
  v_accvgpr_read_b32 v42, a22
  v_accvgpr_read_b32 v43, a23
  v_cvt_pk_bf16_f32 v44, v36, v37
  v_cvt_pk_bf16_f32 v45, v38, v39
  v_cvt_pk_bf16_f32 v46, v40, v41
  v_cvt_pk_bf16_f32 v47, v42, v43
  buffer_store_dwordx4 v[44:47], v1, s[4:7], s17 offen offset:0 sc1
  v_accvgpr_read_b32 v48, a36
  v_accvgpr_read_b32 v49, a37
  v_accvgpr_read_b32 v50, a38
  v_accvgpr_read_b32 v51, a39
  v_accvgpr_read_b32 v52, a52
  v_accvgpr_read_b32 v53, a53
  v_accvgpr_read_b32 v54, a54
  v_accvgpr_read_b32 v55, a55
  v_cvt_pk_bf16_f32 v56, v48, v49
  v_cvt_pk_bf16_f32 v57, v50, v51
  v_cvt_pk_bf16_f32 v58, v52, v53
  v_cvt_pk_bf16_f32 v59, v54, v55
  buffer_store_dwordx4 v[56:59], v1, s[4:7], s17 offen offset:1024 sc1
  v_accvgpr_read_b32 v60, a68
  v_accvgpr_read_b32 v61, a69
  v_accvgpr_read_b32 v62, a70
  v_accvgpr_read_b32 v63, a71
  v_accvgpr_read_b32 v64, a84
  v_accvgpr_read_b32 v65, a85
  v_accvgpr_read_b32 v66, a86
  v_accvgpr_read_b32 v67, a87
  v_cvt_pk_bf16_f32 v68, v60, v61
  v_cvt_pk_bf16_f32 v69, v62, v63
  v_cvt_pk_bf16_f32 v70, v64, v65
  v_cvt_pk_bf16_f32 v71, v66, v67
  buffer_store_dwordx4 v[68:71], v1, s[4:7], s17 offen offset:2048 sc1
  v_accvgpr_read_b32 v24, a100
  v_accvgpr_read_b32 v25, a101
  v_accvgpr_read_b32 v26, a102
  v_accvgpr_read_b32 v27, a103
  v_accvgpr_read_b32 v28, a116
  v_accvgpr_read_b32 v29, a117
  v_accvgpr_read_b32 v30, a118
  v_accvgpr_read_b32 v31, a119
  v_cvt_pk_bf16_f32 v32, v24, v25
  v_cvt_pk_bf16_f32 v33, v26, v27
  v_cvt_pk_bf16_f32 v34, v28, v29
  v_cvt_pk_bf16_f32 v35, v30, v31
  buffer_store_dwordx4 v[32:35], v1, s[4:7], s17 offen offset:3072 sc1
  v_accvgpr_read_b32 v36, a132
  v_accvgpr_read_b32 v37, a133
  v_accvgpr_read_b32 v38, a134
  v_accvgpr_read_b32 v39, a135
  v_accvgpr_read_b32 v40, a148
  v_accvgpr_read_b32 v41, a149
  v_accvgpr_read_b32 v42, a150
  v_accvgpr_read_b32 v43, a151
  v_cvt_pk_bf16_f32 v44, v36, v37
  v_cvt_pk_bf16_f32 v45, v38, v39
  v_cvt_pk_bf16_f32 v46, v40, v41
  v_cvt_pk_bf16_f32 v47, v42, v43
  s_add_u32 s17, s17, 4096
  buffer_store_dwordx4 v[44:47], v1, s[4:7], s17 offen offset:0 sc1
  s_add_u32 s17, s16, 40960
  v_accvgpr_read_b32 v48, a8
  v_accvgpr_read_b32 v49, a9
  v_accvgpr_read_b32 v50, a10
  v_accvgpr_read_b32 v51, a11
  v_accvgpr_read_b32 v52, a24
  v_accvgpr_read_b32 v53, a25
  v_accvgpr_read_b32 v54, a26
  v_accvgpr_read_b32 v55, a27
  v_cvt_pk_bf16_f32 v56, v48, v49
  v_cvt_pk_bf16_f32 v57, v50, v51
  v_cvt_pk_bf16_f32 v58, v52, v53
  v_cvt_pk_bf16_f32 v59, v54, v55
  buffer_store_dwordx4 v[56:59], v1, s[4:7], s17 offen offset:0 sc1
  v_accvgpr_read_b32 v60, a40
  v_accvgpr_read_b32 v61, a41
  v_accvgpr_read_b32 v62, a42
  v_accvgpr_read_b32 v63, a43
  v_accvgpr_read_b32 v64, a56
  v_accvgpr_read_b32 v65, a57
  v_accvgpr_read_b32 v66, a58
  v_accvgpr_read_b32 v67, a59
  v_cvt_pk_bf16_f32 v68, v60, v61
  v_cvt_pk_bf16_f32 v69, v62, v63
  v_cvt_pk_bf16_f32 v70, v64, v65
  v_cvt_pk_bf16_f32 v71, v66, v67
  buffer_store_dwordx4 v[68:71], v1, s[4:7], s17 offen offset:1024 sc1
  v_accvgpr_read_b32 v24, a72
  v_accvgpr_read_b32 v25, a73
  v_accvgpr_read_b32 v26, a74
  v_accvgpr_read_b32 v27, a75
  v_accvgpr_read_b32 v28, a88
  v_accvgpr_read_b32 v29, a89
  v_accvgpr_read_b32 v30, a90
  v_accvgpr_read_b32 v31, a91
  v_cvt_pk_bf16_f32 v32, v24, v25
  v_cvt_pk_bf16_f32 v33, v26, v27
  v_cvt_pk_bf16_f32 v34, v28, v29
  v_cvt_pk_bf16_f32 v35, v30, v31
  buffer_store_dwordx4 v[32:35], v1, s[4:7], s17 offen offset:2048 sc1
  v_accvgpr_read_b32 v36, a104
  v_accvgpr_read_b32 v37, a105
  v_accvgpr_read_b32 v38, a106
  v_accvgpr_read_b32 v39, a107
  v_accvgpr_read_b32 v40, a120
  v_accvgpr_read_b32 v41, a121
  v_accvgpr_read_b32 v42, a122
  v_accvgpr_read_b32 v43, a123
  v_cvt_pk_bf16_f32 v44, v36, v37
  v_cvt_pk_bf16_f32 v45, v38, v39
  v_cvt_pk_bf16_f32 v46, v40, v41
  v_cvt_pk_bf16_f32 v47, v42, v43
  buffer_store_dwordx4 v[44:47], v1, s[4:7], s17 offen offset:3072 sc1
  v_accvgpr_read_b32 v48, a136
  v_accvgpr_read_b32 v49, a137
  v_accvgpr_read_b32 v50, a138
  v_accvgpr_read_b32 v51, a139
  v_accvgpr_read_b32 v52, a152
  v_accvgpr_read_b32 v53, a153
  v_accvgpr_read_b32 v54, a154
  v_accvgpr_read_b32 v55, a155
  v_cvt_pk_bf16_f32 v56, v48, v49
  v_cvt_pk_bf16_f32 v57, v50, v51
  v_cvt_pk_bf16_f32 v58, v52, v53
  v_cvt_pk_bf16_f32 v59, v54, v55
  s_add_u32 s17, s17, 4096
  buffer_store_dwordx4 v[56:59], v1, s[4:7], s17 offen offset:0 sc1
  s_add_u32 s17, s16, 61440
  v_accvgpr_read_b32 v60, a12
  v_accvgpr_read_b32 v61, a13
  v_accvgpr_read_b32 v62, a14
  v_accvgpr_read_b32 v63, a15
  v_accvgpr_read_b32 v64, a28
  v_accvgpr_read_b32 v65, a29
  v_accvgpr_read_b32 v66, a30
  v_accvgpr_read_b32 v67, a31
  v_cvt_pk_bf16_f32 v68, v60, v61
  v_cvt_pk_bf16_f32 v69, v62, v63
  v_cvt_pk_bf16_f32 v70, v64, v65
  v_cvt_pk_bf16_f32 v71, v66, v67
  buffer_store_dwordx4 v[68:71], v1, s[4:7], s17 offen offset:0 sc1
  v_accvgpr_read_b32 v24, a44
  v_accvgpr_read_b32 v25, a45
  v_accvgpr_read_b32 v26, a46
  v_accvgpr_read_b32 v27, a47
  v_accvgpr_read_b32 v28, a60
  v_accvgpr_read_b32 v29, a61
  v_accvgpr_read_b32 v30, a62
  v_accvgpr_read_b32 v31, a63
  v_cvt_pk_bf16_f32 v32, v24, v25
  v_cvt_pk_bf16_f32 v33, v26, v27
  v_cvt_pk_bf16_f32 v34, v28, v29
  v_cvt_pk_bf16_f32 v35, v30, v31
  buffer_store_dwordx4 v[32:35], v1, s[4:7], s17 offen offset:1024 sc1
  v_accvgpr_read_b32 v36, a76
  v_accvgpr_read_b32 v37, a77
  v_accvgpr_read_b32 v38, a78
  v_accvgpr_read_b32 v39, a79
  v_accvgpr_read_b32 v40, a92
  v_accvgpr_read_b32 v41, a93
  v_accvgpr_read_b32 v42, a94
  v_accvgpr_read_b32 v43, a95
  v_cvt_pk_bf16_f32 v44, v36, v37
  v_cvt_pk_bf16_f32 v45, v38, v39
  v_cvt_pk_bf16_f32 v46, v40, v41
  v_cvt_pk_bf16_f32 v47, v42, v43
  buffer_store_dwordx4 v[44:47], v1, s[4:7], s17 offen offset:2048 sc1
  v_accvgpr_read_b32 v48, a108
  v_accvgpr_read_b32 v49, a109
  v_accvgpr_read_b32 v50, a110
  v_accvgpr_read_b32 v51, a111
  v_accvgpr_read_b32 v52, a124
  v_accvgpr_read_b32 v53, a125
  v_accvgpr_read_b32 v54, a126
  v_accvgpr_read_b32 v55, a127
  v_cvt_pk_bf16_f32 v56, v48, v49
  v_cvt_pk_bf16_f32 v57, v50, v51
  v_cvt_pk_bf16_f32 v58, v52, v53
  v_cvt_pk_bf16_f32 v59, v54, v55
  buffer_store_dwordx4 v[56:59], v1, s[4:7], s17 offen offset:3072 sc1
  v_accvgpr_read_b32 v60, a140
  v_accvgpr_read_b32 v61, a141
  v_accvgpr_read_b32 v62, a142
  v_accvgpr_read_b32 v63, a143
  v_accvgpr_read_b32 v64, a156
  v_accvgpr_read_b32 v65, a157
  v_accvgpr_read_b32 v66, a158
  v_accvgpr_read_b32 v67, a159
  v_cvt_pk_bf16_f32 v68, v60, v61
  v_cvt_pk_bf16_f32 v69, v62, v63
  v_cvt_pk_bf16_f32 v70, v64, v65
  v_cvt_pk_bf16_f32 v71, v66, v67
  s_add_u32 s17, s17, 4096
  buffer_store_dwordx4 v[68:71], v1, s[4:7], s17 offen offset:0 sc1
fin_exit1:
  s_endpgm
.globl redln1_kernel
.p2align 8
.type redln1_kernel,@function
redln1_kernel:
  s_cmp_ge_u32 s2, 128
  s_cbranch_scc1 redln1_exit1
  s_load_dwordx2 s[12:13], s[0:1], 96
  s_load_dwordx2 s[14:15], s[0:1], 0
  v_lshrrev_b32 v2, 6, v0
  s_nop 0
  v_readfirstlane_b32 s16, v2
  s_waitcnt lgkmcnt(0)
  s_mov_b32 s4, s12
  s_mov_b32 s5, s13
  s_mov_b32 s6, 0x10000000
  s_mov_b32 s7, 0x20000
  s_mov_b32 s8, s14
  s_mov_b32 s9, s15
  s_mov_b32 s10, 2621440
  s_mov_b32 s11, 0x20000
  s_mov_b32 s20, 0
  s_mov_b32 s19, s2
  v_and_b32 v3, 63, v0
  v_lshlrev_b32 v14, 4, v3
  v_and_b32 v2, 15, v3
  v_lshrrev_b32 v4, 4, v3
  s_lshl_b32 s17, s19, 4
  v_add_u32 v15, s17, v2
  v_mul_u32_u24 v15, 1280, v15
  v_lshl_add_u32 v15, v4, 4, v15
  s_mul_i32 s17, s16, 320
  s_add_u32 s20, s20, s17
  s_add_u32 s21, s17, 82313216
  s_mul_i32 s22, s19, 20
  s_mul_i32 s23, s16, 5
  s_add_u32 s22, s22, s23
  s_lshl_b32 s22, s22, 10
  s_add_u32 s22, s22, 90832896
  s_add_u32 s24, s22, 0
  s_add_u32 s25, s22, 2621440
  s_add_u32 s26, s22, 5242880
  s_add_u32 s27, s22, 7864320
  s_add_u32 s28, s22, 10485760
  s_add_u32 s29, s22, 13107200
  s_add_u32 s30, s22, 15728640
  s_add_u32 s31, s22, 18350080
  v_add_u32 v6, 0x1000, v14
  buffer_load_dwordx4 v[16:19], v15, s[8:11], s20 offen offset:0
  buffer_load_dwordx4 v[20:23], v15, s[8:11], s20 offen offset:64
  buffer_load_dwordx4 v[24:27], v15, s[8:11], s20 offen offset:128
  buffer_load_dwordx4 v[28:31], v15, s[8:11], s20 offen offset:192
  buffer_load_dwordx4 v[32:35], v15, s[8:11], s20 offen offset:256
  buffer_load_dwordx4 v[80:83], v14, s[4:7], s24 offen offset:0
  buffer_load_dwordx4 v[84:87], v14, s[4:7], s25 offen offset:0
  buffer_load_dwordx4 v[88:91], v14, s[4:7], s26 offen offset:0
  buffer_load_dwordx4 v[92:95], v14, s[4:7], s27 offen offset:0
  buffer_load_dwordx4 v[96:99], v14, s[4:7], s28 offen offset:0
  buffer_load_dwordx4 v[100:103], v14, s[4:7], s29 offen offset:0
  buffer_load_dwordx4 v[104:107], v14, s[4:7], s30 offen offset:0
  buffer_load_dwordx4 v[108:111], v14, s[4:7], s31 offen offset:0
  buffer_load_dwordx4 v[112:115], v14, s[4:7], s24 offen offset:1024
  buffer_load_dwordx4 v[116:119], v14, s[4:7], s25 offen offset:1024
  buffer_load_dwordx4 v[120:123], v14, s[4:7], s26 offen offset:1024
  buffer_load_dwordx4 v[124:127], v14, s[4:7], s27 offen offset:1024
  buffer_load_dwordx4 v[128:131], v14, s[4:7], s28 offen offset:1024
  buffer_load_dwordx4 v[132:135], v14, s[4:7], s29 offen offset:1024
  buffer_load_dwordx4 v[136:139], v14, s[4:7], s30 offen offset:1024
  buffer_load_dwordx4 v[140:143], v14, s[4:7], s31 offen offset:1024
  buffer_load_dwordx4 v[144:147], v14, s[4:7], s24 offen offset:2048
  buffer_load_dwordx4 v[148:151], v14, s[4:7], s25 offen offset:2048
  buffer_load_dwordx4 v[152:155], v14, s[4:7], s26 offen offset:2048
  buffer_load_dwordx4 v[156:159], v14, s[4:7], s27 offen offset:2048
  buffer_load_dwordx4 v[160:163], v14, s[4:7], s28 offen offset:2048
  buffer_load_dwordx4 v[164:167], v14, s[4:7], s29 offen offset:2048
  buffer_load_dwordx4 v[168:171], v14, s[4:7], s30 offen offset:2048
  buffer_load_dwordx4 v[172:175], v14, s[4:7], s31 offen offset:2048
  buffer_load_dwordx4 v[176:179], v14, s[4:7], s24 offen offset:3072
  buffer_load_dwordx4 v[180:183], v14, s[4:7], s25 offen offset:3072
  buffer_load_dwordx4 v[184:187], v14, s[4:7], s26 offen offset:3072
  buffer_load_dwordx4 v[188:191], v14, s[4:7], s27 offen offset:3072
  buffer_load_dwordx4 v[192:195], v14, s[4:7], s28 offen offset:3072
  buffer_load_dwordx4 v[196:199], v14, s[4:7], s29 offen offset:3072
  buffer_load_dwordx4 v[200:203], v14, s[4:7], s30 offen offset:3072
  buffer_load_dwordx4 v[204:207], v14, s[4:7], s31 offen offset:3072
  buffer_load_dwordx4 v[208:211], v6, s[4:7], s24 offen offset:0
  buffer_load_dwordx4 v[212:215], v6, s[4:7], s25 offen offset:0
  buffer_load_dwordx4 v[216:219], v6, s[4:7], s26 offen offset:0
  buffer_load_dwordx4 v[220:223], v6, s[4:7], s27 offen offset:0
  buffer_load_dwordx4 v[224:227], v6, s[4:7], s28 offen offset:0
  buffer_load_dwordx4 v[228:231], v6, s[4:7], s29 offen offset:0
  buffer_load_dwordx4 v[232:235], v6, s[4:7], s30 offen offset:0
  buffer_load_dwordx4 v[236:239], v6, s[4:7], s31 offen offset:0
  s_waitcnt vmcnt(32)
  v_lshlrev_b32 v36, 16, v80
  v_and_b32 v37, 0xffff0000, v80
  v_lshlrev_b32 v38, 16, v81
  v_and_b32 v39, 0xffff0000, v81
  v_lshlrev_b32 v40, 16, v82
  v_and_b32 v41, 0xffff0000, v82
  v_lshlrev_b32 v42, 16, v83
  v_and_b32 v43, 0xffff0000, v83
  v_lshlrev_b32 v8, 16, v84
  v_and_b32 v9, 0xffff0000, v84
  v_pk_add_f32 v[36:37], v[36:37], v[8:9]
  v_lshlrev_b32 v8, 16, v85
  v_and_b32 v9, 0xffff0000, v85
  v_pk_add_f32 v[38:39], v[38:39], v[8:9]
  v_lshlrev_b32 v8, 16, v86
  v_and_b32 v9, 0xffff0000, v86
  v_pk_add_f32 v[40:41], v[40:41], v[8:9]
  v_lshlrev_b32 v8, 16, v87
  v_and_b32 v9, 0xffff0000, v87
  v_pk_add_f32 v[42:43], v[42:43], v[8:9]
  v_lshlrev_b32 v8, 16, v88
  v_and_b32 v9, 0xffff0000, v88
  v_pk_add_f32 v[36:37], v[36:37], v[8:9]
  v_lshlrev_b32 v8, 16, v89
  v_and_b32 v9, 0xffff0000, v89
  v_pk_add_f32 v[38:39], v[38:39], v[8:9]
  v_lshlrev_b32 v8, 16, v90
  v_and_b32 v9, 0xffff0000, v90
  v_pk_add_f32 v[40:41], v[40:41], v[8:9]
  v_lshlrev_b32 v8, 16, v91
  v_and_b32 v9, 0xffff0000, v91
  v_pk_add_f32 v[42:43], v[42:43], v[8:9]
  v_lshlrev_b32 v8, 16, v92
  v_and_b32 v9, 0xffff0000, v92
  v_pk_add_f32 v[36:37], v[36:37], v[8:9]
  v_lshlrev_b32 v8, 16, v93
  v_and_b32 v9, 0xffff0000, v93
  v_pk_add_f32 v[38:39], v[38:39], v[8:9]
  v_lshlrev_b32 v8, 16, v94
  v_and_b32 v9, 0xffff0000, v94
  v_pk_add_f32 v[40:41], v[40:41], v[8:9]
  v_lshlrev_b32 v8, 16, v95
  v_and_b32 v9, 0xffff0000, v95
  v_pk_add_f32 v[42:43], v[42:43], v[8:9]
  v_lshlrev_b32 v8, 16, v96
  v_and_b32 v9, 0xffff0000, v96
  v_pk_add_f32 v[36:37], v[36:37], v[8:9]
  v_lshlrev_b32 v8, 16, v97
  v_and_b32 v9, 0xffff0000, v97
  v_pk_add_f32 v[38:39], v[38:39], v[8:9]
  v_lshlrev_b32 v8, 16, v98
  v_and_b32 v9, 0xffff0000, v98
  v_pk_add_f32 v[40:41], v[40:41], v[8:9]
  v_lshlrev_b32 v8, 16, v99
  v_and_b32 v9, 0xffff0000, v99
  v_pk_add_f32 v[42:43], v[42:43], v[8:9]
  v_lshlrev_b32 v8, 16, v100
  v_and_b32 v9, 0xffff0000, v100
  v_pk_add_f32 v[36:37], v[36:37], v[8:9]
  v_lshlrev_b32 v8, 16, v101
  v_and_b32 v9, 0xffff0000, v101
  v_pk_add_f32 v[38:39], v[38:39], v[8:9]
  v_lshlrev_b32 v8, 16, v102
  v_and_b32 v9, 0xffff0000, v102
  v_pk_add_f32 v[40:41], v[40:41], v[8:9]
  v_lshlrev_b32 v8, 16, v103
  v_and_b32 v9, 0xffff0000, v103
  v_pk_add_f32 v[42:43], v[42:43], v[8:9]
  v_lshlrev_b32 v8, 16, v104
  v_and_b32 v9, 0xffff0000, v104
  v_pk_add_f32 v[36:37], v[36:37], v[8:9]
  v_lshlrev_b32 v8, 16, v105
  v_and_b32 v9, 0xffff0000, v105
  v_pk_add_f32 v[38:39], v[38:39], v[8:9]
  v_lshlrev_b32 v8, 16, v106
  v_and_b32 v9, 0xffff0000, v106
  v_pk_add_f32 v[40:41], v[40:41], v[8:9]
  v_lshlrev_b32 v8, 16, v107
  v_and_b32 v9, 0xffff0000, v107
  v_pk_add_f32 v[42:43], v[42:43], v[8:9]
  v_lshlrev_b32 v8, 16, v108
  v_and_b32 v9, 0xffff0000, v108
  v_pk_add_f32 v[36:37], v[36:37], v[8:9]
  v_lshlrev_b32 v8, 16, v109
  v_and_b32 v9, 0xffff0000, v109
  v_pk_add_f32 v[38:39], v[38:39], v[8:9]
  v_lshlrev_b32 v8, 16, v110
  v_and_b32 v9, 0xffff0000, v110
  v_pk_add_f32 v[40:41], v[40:41], v[8:9]
  v_lshlrev_b32 v8, 16, v111
  v_and_b32 v9, 0xffff0000, v111
  v_pk_add_f32 v[42:43], v[42:43], v[8:9]
  v_cvt_pk_bf16_f32 v8, v36, v37
  v_lshlrev_b32 v36, 16, v8
  v_and_b32 v37, 0xffff0000, v8
  v_lshlrev_b32 v10, 16, v16
  v_and_b32 v11, 0xffff0000, v16
  v_pk_add_f32 v[36:37], v[36:37], v[10:11]
  v_cvt_pk_bf16_f32 v16, v36, v37
  v_lshlrev_b32 v36, 16, v16
  v_and_b32 v37, 0xffff0000, v16
  v_cvt_pk_bf16_f32 v8, v38, v39
  v_lshlrev_b32 v38, 16, v8
  v_and_b32 v39, 0xffff0000, v8
  v_lshlrev_b32 v10, 16, v17
  v_and_b32 v11, 0xffff0000, v17
  v_pk_add_f32 v[38:39], v[38:39], v[10:11]
  v_cvt_pk_bf16_f32 v17, v38, v39
  v_lshlrev_b32 v38, 16, v17
  v_and_b32 v39, 0xffff0000, v17
  v_cvt_pk_bf16_f32 v8, v40, v41
  v_lshlrev_b32 v40, 16, v8
  v_and_b32 v41, 0xffff0000, v8
  v_lshlrev_b32 v10, 16, v18
  v_and_b32 v11, 0xffff0000, v18
  v_pk_add_f32 v[40:41], v[40:41], v[10:11]
  v_cvt_pk_bf16_f32 v18, v40, v41
  v_lshlrev_b32 v40, 16, v18
  v_and_b32 v41, 0xffff0000, v18
  v_cvt_pk_bf16_f32 v8, v42, v43
  v_lshlrev_b32 v42, 16, v8
  v_and_b32 v43, 0xffff0000, v8
  v_lshlrev_b32 v10, 16, v19
  v_and_b32 v11, 0xffff0000, v19
  v_pk_add_f32 v[42:43], v[42:43], v[10:11]
  v_cvt_pk_bf16_f32 v19, v42, v43
  v_lshlrev_b32 v42, 16, v19
  v_and_b32 v43, 0xffff0000, v19
  buffer_store_dwordx4 v[16:19], v15, s[4:7], s21 offen offset:0 sc1
  s_waitcnt vmcnt(25)
  v_lshlrev_b32 v44, 16, v112
  v_and_b32 v45, 0xffff0000, v112
  v_lshlrev_b32 v46, 16, v113
  v_and_b32 v47, 0xffff0000, v113
  v_lshlrev_b32 v48, 16, v114
  v_and_b32 v49, 0xffff0000, v114
  v_lshlrev_b32 v50, 16, v115
  v_and_b32 v51, 0xffff0000, v115
  v_lshlrev_b32 v8, 16, v116
  v_and_b32 v9, 0xffff0000, v116
  v_pk_add_f32 v[44:45], v[44:45], v[8:9]
  v_lshlrev_b32 v8, 16, v117
  v_and_b32 v9, 0xffff0000, v117
  v_pk_add_f32 v[46:47], v[46:47], v[8:9]
  v_lshlrev_b32 v8, 16, v118
  v_and_b32 v9, 0xffff0000, v118
  v_pk_add_f32 v[48:49], v[48:49], v[8:9]
  v_lshlrev_b32 v8, 16, v119
  v_and_b32 v9, 0xffff0000, v119
  v_pk_add_f32 v[50:51], v[50:51], v[8:9]
  v_lshlrev_b32 v8, 16, v120
  v_and_b32 v9, 0xffff0000, v120
  v_pk_add_f32 v[44:45], v[44:45], v[8:9]
  v_lshlrev_b32 v8, 16, v121
  v_and_b32 v9, 0xffff0000, v121
  v_pk_add_f32 v[46:47], v[46:47], v[8:9]
  v_lshlrev_b32 v8, 16, v122
  v_and_b32 v9, 0xffff0000, v122
  v_pk_add_f32 v[48:49], v[48:49], v[8:9]
  v_lshlrev_b32 v8, 16, v123
  v_and_b32 v9, 0xffff0000, v123
  v_pk_add_f32 v[50:51], v[50:51], v[8:9]
  v_lshlrev_b32 v8, 16, v124
  v_and_b32 v9, 0xffff0000, v124
  v_pk_add_f32 v[44:45], v[44:45], v[8:9]
  v_lshlrev_b32 v8, 16, v125
  v_and_b32 v9, 0xffff0000, v125
  v_pk_add_f32 v[46:47], v[46:47], v[8:9]
  v_lshlrev_b32 v8, 16, v126
  v_and_b32 v9, 0xffff0000, v126
  v_pk_add_f32 v[48:49], v[48:49], v[8:9]
  v_lshlrev_b32 v8, 16, v127
  v_and_b32 v9, 0xffff0000, v127
  v_pk_add_f32 v[50:51], v[50:51], v[8:9]
  v_lshlrev_b32 v8, 16, v128
  v_and_b32 v9, 0xffff0000, v128
  v_pk_add_f32 v[44:45], v[44:45], v[8:9]
  v_lshlrev_b32 v8, 16, v129
  v_and_b32 v9, 0xffff0000, v129
  v_pk_add_f32 v[46:47], v[46:47], v[8:9]
  v_lshlrev_b32 v8, 16, v130
  v_and_b32 v9, 0xffff0000, v130
  v_pk_add_f32 v[48:49], v[48:49], v[8:9]
  v_lshlrev_b32 v8, 16, v131
  v_and_b32 v9, 0xffff0000, v131
  v_pk_add_f32 v[50:51], v[50:51], v[8:9]
  v_lshlrev_b32 v8, 16, v132
  v_and_b32 v9, 0xffff0000, v132
  v_pk_add_f32 v[44:45], v[44:45], v[8:9]
  v_lshlrev_b32 v8, 16, v133
  v_and_b32 v9, 0xffff0000, v133
  v_pk_add_f32 v[46:47], v[46:47], v[8:9]
  v_lshlrev_b32 v8, 16, v134
  v_and_b32 v9, 0xffff0000, v134
  v_pk_add_f32 v[48:49], v[48:49], v[8:9]
  v_lshlrev_b32 v8, 16, v135
  v_and_b32 v9, 0xffff0000, v135
  v_pk_add_f32 v[50:51], v[50:51], v[8:9]
  v_lshlrev_b32 v8, 16, v136
  v_and_b32 v9, 0xffff0000, v136
  v_pk_add_f32 v[44:45], v[44:45], v[8:9]
  v_lshlrev_b32 v8, 16, v137
  v_and_b32 v9, 0xffff0000, v137
  v_pk_add_f32 v[46:47], v[46:47], v[8:9]
  v_lshlrev_b32 v8, 16, v138
  v_and_b32 v9, 0xffff0000, v138
  v_pk_add_f32 v[48:49], v[48:49], v[8:9]
  v_lshlrev_b32 v8, 16, v139
  v_and_b32 v9, 0xffff0000, v139
  v_pk_add_f32 v[50:51], v[50:51], v[8:9]
  v_lshlrev_b32 v8, 16, v140
  v_and_b32 v9, 0xffff0000, v140
  v_pk_add_f32 v[44:45], v[44:45], v[8:9]
  v_lshlrev_b32 v8, 16, v141
  v_and_b32 v9, 0xffff0000, v141
  v_pk_add_f32 v[46:47], v[46:47], v[8:9]
  v_lshlrev_b32 v8, 16, v142
  v_and_b32 v9, 0xffff0000, v142
  v_pk_add_f32 v[48:49], v[48:49], v[8:9]
  v_lshlrev_b32 v8, 16, v143
  v_and_b32 v9, 0xffff0000, v143
  v_pk_add_f32 v[50:51], v[50:51], v[8:9]
  v_cvt_pk_bf16_f32 v8, v44, v45
  v_lshlrev_b32 v44, 16, v8
  v_and_b32 v45, 0xffff0000, v8
  v_lshlrev_b32 v10, 16, v20
  v_and_b32 v11, 0xffff0000, v20
  v_pk_add_f32 v[44:45], v[44:45], v[10:11]
  v_cvt_pk_bf16_f32 v20, v44, v45
  v_lshlrev_b32 v44, 16, v20
  v_and_b32 v45, 0xffff0000, v20
  v_cvt_pk_bf16_f32 v8, v46, v47
  v_lshlrev_b32 v46, 16, v8
  v_and_b32 v47, 0xffff0000, v8
  v_lshlrev_b32 v10, 16, v21
  v_and_b32 v11, 0xffff0000, v21
  v_pk_add_f32 v[46:47], v[46:47], v[10:11]
  v_cvt_pk_bf16_f32 v21, v46, v47
  v_lshlrev_b32 v46, 16, v21
  v_and_b32 v47, 0xffff0000, v21
  v_cvt_pk_bf16_f32 v8, v48, v49
  v_lshlrev_b32 v48, 16, v8
  v_and_b32 v49, 0xffff0000, v8
  v_lshlrev_b32 v10, 16, v22
  v_and_b32 v11, 0xffff0000, v22
  v_pk_add_f32 v[48:49], v[48:49], v[10:11]
  v_cvt_pk_bf16_f32 v22, v48, v49
  v_lshlrev_b32 v48, 16, v22
  v_and_b32 v49, 0xffff0000, v22
  v_cvt_pk_bf16_f32 v8, v50, v51
  v_lshlrev_b32 v50, 16, v8
  v_and_b32 v51, 0xffff0000, v8
  v_lshlrev_b32 v10, 16, v23
  v_and_b32 v11, 0xffff0000, v23
  v_pk_add_f32 v[50:51], v[50:51], v[10:11]
  v_cvt_pk_bf16_f32 v23, v50, v51
  v_lshlrev_b32 v50, 16, v23
  v_and_b32 v51, 0xffff0000, v23
  buffer_store_dwordx4 v[20:23], v15, s[4:7], s21 offen offset:64 sc1
  s_waitcnt vmcnt(18)
  v_lshlrev_b32 v52, 16, v144
  v_and_b32 v53, 0xffff0000, v144
  v_lshlrev_b32 v54, 16, v145
  v_and_b32 v55, 0xffff0000, v145
  v_lshlrev_b32 v56, 16, v146
  v_and_b32 v57, 0xffff0000, v146
  v_lshlrev_b32 v58, 16, v147
  v_and_b32 v59, 0xffff0000, v147
  v_lshlrev_b32 v8, 16, v148
  v_and_b32 v9, 0xffff0000, v148
  v_pk_add_f32 v[52:53], v[52:53], v[8:9]
  v_lshlrev_b32 v8, 16, v149
  v_and_b32 v9, 0xffff0000, v149
  v_pk_add_f32 v[54:55], v[54:55], v[8:9]
  v_lshlrev_b32 v8, 16, v150
  v_and_b32 v9, 0xffff0000, v150
  v_pk_add_f32 v[56:57], v[56:57], v[8:9]
  v_lshlrev_b32 v8, 16, v151
  v_and_b32 v9, 0xffff0000, v151
  v_pk_add_f32 v[58:59], v[58:59], v[8:9]
  v_lshlrev_b32 v8, 16, v152
  v_and_b32 v9, 0xffff0000, v152
  v_pk_add_f32 v[52:53], v[52:53], v[8:9]
  v_lshlrev_b32 v8, 16, v153
  v_and_b32 v9, 0xffff0000, v153
  v_pk_add_f32 v[54:55], v[54:55], v[8:9]
  v_lshlrev_b32 v8, 16, v154
  v_and_b32 v9, 0xffff0000, v154
  v_pk_add_f32 v[56:57], v[56:57], v[8:9]
  v_lshlrev_b32 v8, 16, v155
  v_and_b32 v9, 0xffff0000, v155
  v_pk_add_f32 v[58:59], v[58:59], v[8:9]
  v_lshlrev_b32 v8, 16, v156
  v_and_b32 v9, 0xffff0000, v156
  v_pk_add_f32 v[52:53], v[52:53], v[8:9]
  v_lshlrev_b32 v8, 16, v157
  v_and_b32 v9, 0xffff0000, v157
  v_pk_add_f32 v[54:55], v[54:55], v[8:9]
  v_lshlrev_b32 v8, 16, v158
  v_and_b32 v9, 0xffff0000, v158
  v_pk_add_f32 v[56:57], v[56:57], v[8:9]
  v_lshlrev_b32 v8, 16, v159
  v_and_b32 v9, 0xffff0000, v159
  v_pk_add_f32 v[58:59], v[58:59], v[8:9]
  v_lshlrev_b32 v8, 16, v160
  v_and_b32 v9, 0xffff0000, v160
  v_pk_add_f32 v[52:53], v[52:53], v[8:9]
  v_lshlrev_b32 v8, 16, v161
  v_and_b32 v9, 0xffff0000, v161
  v_pk_add_f32 v[54:55], v[54:55], v[8:9]
  v_lshlrev_b32 v8, 16, v162
  v_and_b32 v9, 0xffff0000, v162
  v_pk_add_f32 v[56:57], v[56:57], v[8:9]
  v_lshlrev_b32 v8, 16, v163
  v_and_b32 v9, 0xffff0000, v163
  v_pk_add_f32 v[58:59], v[58:59], v[8:9]
  v_lshlrev_b32 v8, 16, v164
  v_and_b32 v9, 0xffff0000, v164
  v_pk_add_f32 v[52:53], v[52:53], v[8:9]
  v_lshlrev_b32 v8, 16, v165
  v_and_b32 v9, 0xffff0000, v165
  v_pk_add_f32 v[54:55], v[54:55], v[8:9]
  v_lshlrev_b32 v8, 16, v166
  v_and_b32 v9, 0xffff0000, v166
  v_pk_add_f32 v[56:57], v[56:57], v[8:9]
  v_lshlrev_b32 v8, 16, v167
  v_and_b32 v9, 0xffff0000, v167
  v_pk_add_f32 v[58:59], v[58:59], v[8:9]
  v_lshlrev_b32 v8, 16, v168
  v_and_b32 v9, 0xffff0000, v168
  v_pk_add_f32 v[52:53], v[52:53], v[8:9]
  v_lshlrev_b32 v8, 16, v169
  v_and_b32 v9, 0xffff0000, v169
  v_pk_add_f32 v[54:55], v[54:55], v[8:9]
  v_lshlrev_b32 v8, 16, v170
  v_and_b32 v9, 0xffff0000, v170
  v_pk_add_f32 v[56:57], v[56:57], v[8:9]
  v_lshlrev_b32 v8, 16, v171
  v_and_b32 v9, 0xffff0000, v171
  v_pk_add_f32 v[58:59], v[58:59], v[8:9]
  v_lshlrev_b32 v8, 16, v172
  v_and_b32 v9, 0xffff0000, v172
  v_pk_add_f32 v[52:53], v[52:53], v[8:9]
  v_lshlrev_b32 v8, 16, v173
  v_and_b32 v9, 0xffff0000, v173
  v_pk_add_f32 v[54:55], v[54:55], v[8:9]
  v_lshlrev_b32 v8, 16, v174
  v_and_b32 v9, 0xffff0000, v174
  v_pk_add_f32 v[56:57], v[56:57], v[8:9]
  v_lshlrev_b32 v8, 16, v175
  v_and_b32 v9, 0xffff0000, v175
  v_pk_add_f32 v[58:59], v[58:59], v[8:9]
  v_cvt_pk_bf16_f32 v8, v52, v53
  v_lshlrev_b32 v52, 16, v8
  v_and_b32 v53, 0xffff0000, v8
  v_lshlrev_b32 v10, 16, v24
  v_and_b32 v11, 0xffff0000, v24
  v_pk_add_f32 v[52:53], v[52:53], v[10:11]
  v_cvt_pk_bf16_f32 v24, v52, v53
  v_lshlrev_b32 v52, 16, v24
  v_and_b32 v53, 0xffff0000, v24
  v_cvt_pk_bf16_f32 v8, v54, v55
  v_lshlrev_b32 v54, 16, v8
  v_and_b32 v55, 0xffff0000, v8
  v_lshlrev_b32 v10, 16, v25
  v_and_b32 v11, 0xffff0000, v25
  v_pk_add_f32 v[54:55], v[54:55], v[10:11]
  v_cvt_pk_bf16_f32 v25, v54, v55
  v_lshlrev_b32 v54, 16, v25
  v_and_b32 v55, 0xffff0000, v25
  v_cvt_pk_bf16_f32 v8, v56, v57
  v_lshlrev_b32 v56, 16, v8
  v_and_b32 v57, 0xffff0000, v8
  v_lshlrev_b32 v10, 16, v26
  v_and_b32 v11, 0xffff0000, v26
  v_pk_add_f32 v[56:57], v[56:57], v[10:11]
  v_cvt_pk_bf16_f32 v26, v56, v57
  v_lshlrev_b32 v56, 16, v26
  v_and_b32 v57, 0xffff0000, v26
  v_cvt_pk_bf16_f32 v8, v58, v59
  v_lshlrev_b32 v58, 16, v8
  v_and_b32 v59, 0xffff0000, v8
  v_lshlrev_b32 v10, 16, v27
  v_and_b32 v11, 0xffff0000, v27
  v_pk_add_f32 v[58:59], v[58:59], v[10:11]
  v_cvt_pk_bf16_f32 v27, v58, v59
  v_lshlrev_b32 v58, 16, v27
  v_and_b32 v59, 0xffff0000, v27
  buffer_store_dwordx4 v[24:27], v15, s[4:7], s21 offen offset:128 sc1
  s_waitcnt vmcnt(11)
  v_lshlrev_b32 v60, 16, v176
  v_and_b32 v61, 0xffff0000, v176
  v_lshlrev_b32 v62, 16, v177
  v_and_b32 v63, 0xffff0000, v177
  v_lshlrev_b32 v64, 16, v178
  v_and_b32 v65, 0xffff0000, v178
  v_lshlrev_b32 v66, 16, v179
  v_and_b32 v67, 0xffff0000, v179
  v_lshlrev_b32 v8, 16, v180
  v_and_b32 v9, 0xffff0000, v180
  v_pk_add_f32 v[60:61], v[60:61], v[8:9]
  v_lshlrev_b32 v8, 16, v181
  v_and_b32 v9, 0xffff0000, v181
  v_pk_add_f32 v[62:63], v[62:63], v[8:9]
  v_lshlrev_b32 v8, 16, v182
  v_and_b32 v9, 0xffff0000, v182
  v_pk_add_f32 v[64:65], v[64:65], v[8:9]
  v_lshlrev_b32 v8, 16, v183
  v_and_b32 v9, 0xffff0000, v183
  v_pk_add_f32 v[66:67], v[66:67], v[8:9]
  v_lshlrev_b32 v8, 16, v184
  v_and_b32 v9, 0xffff0000, v184
  v_pk_add_f32 v[60:61], v[60:61], v[8:9]
  v_lshlrev_b32 v8, 16, v185
  v_and_b32 v9, 0xffff0000, v185
  v_pk_add_f32 v[62:63], v[62:63], v[8:9]
  v_lshlrev_b32 v8, 16, v186
  v_and_b32 v9, 0xffff0000, v186
  v_pk_add_f32 v[64:65], v[64:65], v[8:9]
  v_lshlrev_b32 v8, 16, v187
  v_and_b32 v9, 0xffff0000, v187
  v_pk_add_f32 v[66:67], v[66:67], v[8:9]
  v_lshlrev_b32 v8, 16, v188
  v_and_b32 v9, 0xffff0000, v188
  v_pk_add_f32 v[60:61], v[60:61], v[8:9]
  v_lshlrev_b32 v8, 16, v189
  v_and_b32 v9, 0xffff0000, v189
  v_pk_add_f32 v[62:63], v[62:63], v[8:9]
  v_lshlrev_b32 v8, 16, v190
  v_and_b32 v9, 0xffff0000, v190
  v_pk_add_f32 v[64:65], v[64:65], v[8:9]
  v_lshlrev_b32 v8, 16, v191
  v_and_b32 v9, 0xffff0000, v191
  v_pk_add_f32 v[66:67], v[66:67], v[8:9]
  v_lshlrev_b32 v8, 16, v192
  v_and_b32 v9, 0xffff0000, v192
  v_pk_add_f32 v[60:61], v[60:61], v[8:9]
  v_lshlrev_b32 v8, 16, v193
  v_and_b32 v9, 0xffff0000, v193
  v_pk_add_f32 v[62:63], v[62:63], v[8:9]
  v_lshlrev_b32 v8, 16, v194
  v_and_b32 v9, 0xffff0000, v194
  v_pk_add_f32 v[64:65], v[64:65], v[8:9]
  v_lshlrev_b32 v8, 16, v195
  v_and_b32 v9, 0xffff0000, v195
  v_pk_add_f32 v[66:67], v[66:67], v[8:9]
  v_lshlrev_b32 v8, 16, v196
  v_and_b32 v9, 0xffff0000, v196
  v_pk_add_f32 v[60:61], v[60:61], v[8:9]
  v_lshlrev_b32 v8, 16, v197
  v_and_b32 v9, 0xffff0000, v197
  v_pk_add_f32 v[62:63], v[62:63], v[8:9]
  v_lshlrev_b32 v8, 16, v198
  v_and_b32 v9, 0xffff0000, v198
  v_pk_add_f32 v[64:65], v[64:65], v[8:9]
  v_lshlrev_b32 v8, 16, v199
  v_and_b32 v9, 0xffff0000, v199
  v_pk_add_f32 v[66:67], v[66:67], v[8:9]
  v_lshlrev_b32 v8, 16, v200
  v_and_b32 v9, 0xffff0000, v200
  v_pk_add_f32 v[60:61], v[60:61], v[8:9]
  v_lshlrev_b32 v8, 16, v201
  v_and_b32 v9, 0xffff0000, v201
  v_pk_add_f32 v[62:63], v[62:63], v[8:9]
  v_lshlrev_b32 v8, 16, v202
  v_and_b32 v9, 0xffff0000, v202
  v_pk_add_f32 v[64:65], v[64:65], v[8:9]
  v_lshlrev_b32 v8, 16, v203
  v_and_b32 v9, 0xffff0000, v203
  v_pk_add_f32 v[66:67], v[66:67], v[8:9]
  v_lshlrev_b32 v8, 16, v204
  v_and_b32 v9, 0xffff0000, v204
  v_pk_add_f32 v[60:61], v[60:61], v[8:9]
  v_lshlrev_b32 v8, 16, v205
  v_and_b32 v9, 0xffff0000, v205
  v_pk_add_f32 v[62:63], v[62:63], v[8:9]
  v_lshlrev_b32 v8, 16, v206
  v_and_b32 v9, 0xffff0000, v206
  v_pk_add_f32 v[64:65], v[64:65], v[8:9]
  v_lshlrev_b32 v8, 16, v207
  v_and_b32 v9, 0xffff0000, v207
  v_pk_add_f32 v[66:67], v[66:67], v[8:9]
  v_cvt_pk_bf16_f32 v8, v60, v61
  v_lshlrev_b32 v60, 16, v8
  v_and_b32 v61, 0xffff0000, v8
  v_lshlrev_b32 v10, 16, v28
  v_and_b32 v11, 0xffff0000, v28
  v_pk_add_f32 v[60:61], v[60:61], v[10:11]
  v_cvt_pk_bf16_f32 v28, v60, v61
  v_lshlrev_b32 v60, 16, v28
  v_and_b32 v61, 0xffff0000, v28
  v_cvt_pk_bf16_f32 v8, v62, v63
  v_lshlrev_b32 v62, 16, v8
  v_and_b32 v63, 0xffff0000, v8
  v_lshlrev_b32 v10, 16, v29
  v_and_b32 v11, 0xffff0000, v29
  v_pk_add_f32 v[62:63], v[62:63], v[10:11]
  v_cvt_pk_bf16_f32 v29, v62, v63
  v_lshlrev_b32 v62, 16, v29
  v_and_b32 v63, 0xffff0000, v29
  v_cvt_pk_bf16_f32 v8, v64, v65
  v_lshlrev_b32 v64, 16, v8
  v_and_b32 v65, 0xffff0000, v8
  v_lshlrev_b32 v10, 16, v30
  v_and_b32 v11, 0xffff0000, v30
  v_pk_add_f32 v[64:65], v[64:65], v[10:11]
  v_cvt_pk_bf16_f32 v30, v64, v65
  v_lshlrev_b32 v64, 16, v30
  v_and_b32 v65, 0xffff0000, v30
  v_cvt_pk_bf16_f32 v8, v66, v67
  v_lshlrev_b32 v66, 16, v8
  v_and_b32 v67, 0xffff0000, v8
  v_lshlrev_b32 v10, 16, v31
  v_and_b32 v11, 0xffff0000, v31
  v_pk_add_f32 v[66:67], v[66:67], v[10:11]
  v_cvt_pk_bf16_f32 v31, v66, v67
  v_lshlrev_b32 v66, 16, v31
  v_and_b32 v67, 0xffff0000, v31
  buffer_store_dwordx4 v[28:31], v15, s[4:7], s21 offen offset:192 sc1
  s_waitcnt vmcnt(4)
  v_lshlrev_b32 v68, 16, v208
  v_and_b32 v69, 0xffff0000, v208
  v_lshlrev_b32 v70, 16, v209
  v_and_b32 v71, 0xffff0000, v209
  v_lshlrev_b32 v72, 16, v210
  v_and_b32 v73, 0xffff0000, v210
  v_lshlrev_b32 v74, 16, v211
  v_and_b32 v75, 0xffff0000, v211
  v_lshlrev_b32 v8, 16, v212
  v_and_b32 v9, 0xffff0000, v212
  v_pk_add_f32 v[68:69], v[68:69], v[8:9]
  v_lshlrev_b32 v8, 16, v213
  v_and_b32 v9, 0xffff0000, v213
  v_pk_add_f32 v[70:71], v[70:71], v[8:9]
  v_lshlrev_b32 v8, 16, v214
  v_and_b32 v9, 0xffff0000, v214
  v_pk_add_f32 v[72:73], v[72:73], v[8:9]
  v_lshlrev_b32 v8, 16, v215
  v_and_b32 v9, 0xffff0000, v215
  v_pk_add_f32 v[74:75], v[74:75], v[8:9]
  v_lshlrev_b32 v8, 16, v216
  v_and_b32 v9, 0xffff0000, v216
  v_pk_add_f32 v[68:69], v[68:69], v[8:9]
  v_lshlrev_b32 v8, 16, v217
  v_and_b32 v9, 0xffff0000, v217
  v_pk_add_f32 v[70:71], v[70:71], v[8:9]
  v_lshlrev_b32 v8, 16, v218
  v_and_b32 v9, 0xffff0000, v218
  v_pk_add_f32 v[72:73], v[72:73], v[8:9]
  v_lshlrev_b32 v8, 16, v219
  v_and_b32 v9, 0xffff0000, v219
  v_pk_add_f32 v[74:75], v[74:75], v[8:9]
  v_lshlrev_b32 v8, 16, v220
  v_and_b32 v9, 0xffff0000, v220
  v_pk_add_f32 v[68:69], v[68:69], v[8:9]
  v_lshlrev_b32 v8, 16, v221
  v_and_b32 v9, 0xffff0000, v221
  v_pk_add_f32 v[70:71], v[70:71], v[8:9]
  v_lshlrev_b32 v8, 16, v222
  v_and_b32 v9, 0xffff0000, v222
  v_pk_add_f32 v[72:73], v[72:73], v[8:9]
  v_lshlrev_b32 v8, 16, v223
  v_and_b32 v9, 0xffff0000, v223
  v_pk_add_f32 v[74:75], v[74:75], v[8:9]
  v_lshlrev_b32 v8, 16, v224
  v_and_b32 v9, 0xffff0000, v224
  v_pk_add_f32 v[68:69], v[68:69], v[8:9]
  v_lshlrev_b32 v8, 16, v225
  v_and_b32 v9, 0xffff0000, v225
  v_pk_add_f32 v[70:71], v[70:71], v[8:9]
  v_lshlrev_b32 v8, 16, v226
  v_and_b32 v9, 0xffff0000, v226
  v_pk_add_f32 v[72:73], v[72:73], v[8:9]
  v_lshlrev_b32 v8, 16, v227
  v_and_b32 v9, 0xffff0000, v227
  v_pk_add_f32 v[74:75], v[74:75], v[8:9]
  v_lshlrev_b32 v8, 16, v228
  v_and_b32 v9, 0xffff0000, v228
  v_pk_add_f32 v[68:69], v[68:69], v[8:9]
  v_lshlrev_b32 v8, 16, v229
  v_and_b32 v9, 0xffff0000, v229
  v_pk_add_f32 v[70:71], v[70:71], v[8:9]
  v_lshlrev_b32 v8, 16, v230
  v_and_b32 v9, 0xffff0000, v230
  v_pk_add_f32 v[72:73], v[72:73], v[8:9]
  v_lshlrev_b32 v8, 16, v231
  v_and_b32 v9, 0xffff0000, v231
  v_pk_add_f32 v[74:75], v[74:75], v[8:9]
  v_lshlrev_b32 v8, 16, v232
  v_and_b32 v9, 0xffff0000, v232
  v_pk_add_f32 v[68:69], v[68:69], v[8:9]
  v_lshlrev_b32 v8, 16, v233
  v_and_b32 v9, 0xffff0000, v233
  v_pk_add_f32 v[70:71], v[70:71], v[8:9]
  v_lshlrev_b32 v8, 16, v234
  v_and_b32 v9, 0xffff0000, v234
  v_pk_add_f32 v[72:73], v[72:73], v[8:9]
  v_lshlrev_b32 v8, 16, v235
  v_and_b32 v9, 0xffff0000, v235
  v_pk_add_f32 v[74:75], v[74:75], v[8:9]
  v_lshlrev_b32 v8, 16, v236
  v_and_b32 v9, 0xffff0000, v236
  v_pk_add_f32 v[68:69], v[68:69], v[8:9]
  v_lshlrev_b32 v8, 16, v237
  v_and_b32 v9, 0xffff0000, v237
  v_pk_add_f32 v[70:71], v[70:71], v[8:9]
  v_lshlrev_b32 v8, 16, v238
  v_and_b32 v9, 0xffff0000, v238
  v_pk_add_f32 v[72:73], v[72:73], v[8:9]
  v_lshlrev_b32 v8, 16, v239
  v_and_b32 v9, 0xffff0000, v239
  v_pk_add_f32 v[74:75], v[74:75], v[8:9]
  v_cvt_pk_bf16_f32 v8, v68, v69
  v_lshlrev_b32 v68, 16, v8
  v_and_b32 v69, 0xffff0000, v8
  v_lshlrev_b32 v10, 16, v32
  v_and_b32 v11, 0xffff0000, v32
  v_pk_add_f32 v[68:69], v[68:69], v[10:11]
  v_cvt_pk_bf16_f32 v32, v68, v69
  v_lshlrev_b32 v68, 16, v32
  v_and_b32 v69, 0xffff0000, v32
  v_cvt_pk_bf16_f32 v8, v70, v71
  v_lshlrev_b32 v70, 16, v8
  v_and_b32 v71, 0xffff0000, v8
  v_lshlrev_b32 v10, 16, v33
  v_and_b32 v11, 0xffff0000, v33
  v_pk_add_f32 v[70:71], v[70:71], v[10:11]
  v_cvt_pk_bf16_f32 v33, v70, v71
  v_lshlrev_b32 v70, 16, v33
  v_and_b32 v71, 0xffff0000, v33
  v_cvt_pk_bf16_f32 v8, v72, v73
  v_lshlrev_b32 v72, 16, v8
  v_and_b32 v73, 0xffff0000, v8
  v_lshlrev_b32 v10, 16, v34
  v_and_b32 v11, 0xffff0000, v34
  v_pk_add_f32 v[72:73], v[72:73], v[10:11]
  v_cvt_pk_bf16_f32 v34, v72, v73
  v_lshlrev_b32 v72, 16, v34
  v_and_b32 v73, 0xffff0000, v34
  v_cvt_pk_bf16_f32 v8, v74, v75
  v_lshlrev_b32 v74, 16, v8
  v_and_b32 v75, 0xffff0000, v8
  v_lshlrev_b32 v10, 16, v35
  v_and_b32 v11, 0xffff0000, v35
  v_pk_add_f32 v[74:75], v[74:75], v[10:11]
  v_cvt_pk_bf16_f32 v35, v74, v75
  v_lshlrev_b32 v74, 16, v35
  v_and_b32 v75, 0xffff0000, v35
  buffer_store_dwordx4 v[32:35], v15, s[4:7], s21 offen offset:256 sc1
  v_and_b32 v3, 63, v0
  v_and_b32 v2, 15, v3
  v_lshlrev_b32 v5, 2, v2
  s_lshl_b32 s17, s16, 6
  v_add_u32 v1, s17, v5
  v_pk_add_f32 v[6:7], v[36:37], v[38:39]
  v_pk_add_f32 v[6:7], v[6:7], v[40:41]
  v_pk_add_f32 v[6:7], v[6:7], v[42:43]
  v_pk_add_f32 v[6:7], v[6:7], v[44:45]
  v_pk_add_f32 v[6:7], v[6:7], v[46:47]
  v_pk_add_f32 v[6:7], v[6:7], v[48:49]
  v_pk_add_f32 v[6:7], v[6:7], v[50:51]
  v_pk_add_f32 v[6:7], v[6:7], v[52:53]
  v_pk_add_f32 v[6:7], v[6:7], v[54:55]
  v_pk_add_f32 v[6:7], v[6:7], v[56:57]
  v_pk_add_f32 v[6:7], v[6:7], v[58:59]
  v_pk_add_f32 v[6:7], v[6:7], v[60:61]
  v_pk_add_f32 v[6:7], v[6:7], v[62:63]
  v_pk_add_f32 v[6:7], v[6:7], v[64:65]
  v_pk_add_f32 v[6:7], v[6:7], v[66:67]
  v_pk_add_f32 v[6:7], v[6:7], v[68:69]
  v_pk_add_f32 v[6:7], v[6:7], v[70:71]
  v_pk_add_f32 v[6:7], v[6:7], v[72:73]
  v_pk_add_f32 v[6:7], v[6:7], v[74:75]
  v_add_f32 v4, v6, v7
  v_mov_b32 v2, v4
  s_nop 1
  v_permlane32_swap_b32 v4, v2
  v_add_f32 v4, v4, v2
  v_mov_b32 v2, v4
  s_nop 1
  v_permlane16_swap_b32 v4, v2
  v_add_f32 v4, v4, v2
  ds_write_b32 v1, v4 offset:0
  s_waitcnt lgkmcnt(0)
  s_barrier
  ds_read_b32 v4, v5 offset:0
  ds_read_b32 v2, v5 offset:64
  ds_read_b32 v3, v5 offset:128
  ds_read_b32 v6, v5 offset:192
  s_waitcnt lgkmcnt(0)
  v_add_f32 v4, v4, v2
  v_add_f32 v3, v3, v6
  v_add_f32 v4, v4, v3
  v_mul_f32 v6, 0xbacccccd, v4
  v_mov_b32 v7, v6
  v_pk_add_f32 v[36:37], v[36:37], v[6:7]
  v_pk_add_f32 v[38:39], v[38:39], v[6:7]
  v_pk_add_f32 v[40:41], v[40:41], v[6:7]
  v_pk_add_f32 v[42:43], v[42:43], v[6:7]
  v_pk_add_f32 v[44:45], v[44:45], v[6:7]
  v_pk_add_f32 v[46:47], v[46:47], v[6:7]
  v_pk_add_f32 v[48:49], v[48:49], v[6:7]
  v_pk_add_f32 v[50:51], v[50:51], v[6:7]
  v_pk_add_f32 v[52:53], v[52:53], v[6:7]
  v_pk_add_f32 v[54:55], v[54:55], v[6:7]
  v_pk_add_f32 v[56:57], v[56:57], v[6:7]
  v_pk_add_f32 v[58:59], v[58:59], v[6:7]
  v_pk_add_f32 v[60:61], v[60:61], v[6:7]
  v_pk_add_f32 v[62:63], v[62:63], v[6:7]
  v_pk_add_f32 v[64:65], v[64:65], v[6:7]
  v_pk_add_f32 v[66:67], v[66:67], v[6:7]
  v_pk_add_f32 v[68:69], v[68:69], v[6:7]
  v_pk_add_f32 v[70:71], v[70:71], v[6:7]
  v_pk_add_f32 v[72:73], v[72:73], v[6:7]
  v_pk_add_f32 v[74:75], v[74:75], v[6:7]
  v_pk_mul_f32 v[6:7], v[36:37], v[36:37]
  v_pk_fma_f32 v[6:7], v[38:39], v[38:39], v[6:7]
  v_pk_fma_f32 v[6:7], v[40:41], v[40:41], v[6:7]
  v_pk_fma_f32 v[6:7], v[42:43], v[42:43], v[6:7]
  v_pk_fma_f32 v[6:7], v[44:45], v[44:45], v[6:7]
  v_pk_fma_f32 v[6:7], v[46:47], v[46:47], v[6:7]
  v_pk_fma_f32 v[6:7], v[48:49], v[48:49], v[6:7]
  v_pk_fma_f32 v[6:7], v[50:51], v[50:51], v[6:7]
  v_pk_fma_f32 v[6:7], v[52:53], v[52:53], v[6:7]
  v_pk_fma_f32 v[6:7], v[54:55], v[54:55], v[6:7]
  v_pk_fma_f32 v[6:7], v[56:57], v[56:57], v[6:7]
  v_pk_fma_f32 v[6:7], v[58:59], v[58:59], v[6:7]
  v_pk_fma_f32 v[6:7], v[60:61], v[60:61], v[6:7]
  v_pk_fma_f32 v[6:7], v[62:63], v[62:63], v[6:7]
  v_pk_fma_f32 v[6:7], v[64:65], v[64:65], v[6:7]
  v_pk_fma_f32 v[6:7], v[66:67], v[66:67], v[6:7]
  v_pk_fma_f32 v[6:7], v[68:69], v[68:69], v[6:7]
  v_pk_fma_f32 v[6:7], v[70:71], v[70:71], v[6:7]
  v_pk_fma_f32 v[6:7], v[72:73], v[72:73], v[6:7]
  v_pk_fma_f32 v[6:7], v[74:75], v[74:75], v[6:7]
  v_add_f32 v4, v6, v7
  v_mov_b32 v2, v4
  s_nop 1
  v_permlane32_swap_b32 v4, v2
  v_add_f32 v4, v4, v2
  v_mov_b32 v2, v4
  s_nop 1
  v_permlane16_swap_b32 v4, v2
  v_add_f32 v4, v4, v2
  ds_write_b32 v1, v4 offset:256
  s_waitcnt lgkmcnt(0)
  s_barrier
  ds_read_b32 v4, v5 offset:256
  ds_read_b32 v2, v5 offset:320
  ds_read_b32 v3, v5 offset:384
  ds_read_b32 v6, v5 offset:448
  s_waitcnt lgkmcnt(0)
  v_add_f32 v4, v4, v2
  v_add_f32 v3, v3, v6
  v_add_f32 v4, v4, v3
  v_mov_b32 v2, 0x3727c5ac
  v_fmac_f32 v2, 0x3acccccd, v4
  v_rsq_f32 v6, v2
  s_nop 0
  v_mov_b32 v7, v6
  v_pk_mul_f32 v[36:37], v[36:37], v[6:7]
  v_pk_mul_f32 v[38:39], v[38:39], v[6:7]
  v_pk_mul_f32 v[40:41], v[40:41], v[6:7]
  v_pk_mul_f32 v[42:43], v[42:43], v[6:7]
  v_pk_mul_f32 v[44:45], v[44:45], v[6:7]
  v_pk_mul_f32 v[46:47], v[46:47], v[6:7]
  v_pk_mul_f32 v[48:49], v[48:49], v[6:7]
  v_pk_mul_f32 v[50:51], v[50:51], v[6:7]
  v_pk_mul_f32 v[52:53], v[52:53], v[6:7]
  v_pk_mul_f32 v[54:55], v[54:55], v[6:7]
  v_pk_mul_f32 v[56:57], v[56:57], v[6:7]
  v_pk_mul_f32 v[58:59], v[58:59], v[6:7]
  v_pk_mul_f32 v[60:61], v[60:61], v[6:7]
  v_pk_mul_f32 v[62:63], v[62:63], v[6:7]
  v_pk_mul_f32 v[64:65], v[64:65], v[6:7]
  v_pk_mul_f32 v[66:67], v[66:67], v[6:7]
  v_pk_mul_f32 v[68:69], v[68:69], v[6:7]
  v_pk_mul_f32 v[70:71], v[70:71], v[6:7]
  v_pk_mul_f32 v[72:73], v[72:73], v[6:7]
  v_pk_mul_f32 v[74:75], v[74:75], v[6:7]
  v_cvt_pk_bf16_f32 v16, v36, v37
  v_cvt_pk_bf16_f32 v17, v38, v39
  v_cvt_pk_bf16_f32 v18, v40, v41
  v_cvt_pk_bf16_f32 v19, v42, v43
  v_cvt_pk_bf16_f32 v20, v44, v45
  v_cvt_pk_bf16_f32 v21, v46, v47
  v_cvt_pk_bf16_f32 v22, v48, v49
  v_cvt_pk_bf16_f32 v23, v50, v51
  v_cvt_pk_bf16_f32 v24, v52, v53
  v_cvt_pk_bf16_f32 v25, v54, v55
  v_cvt_pk_bf16_f32 v26, v56, v57
  v_cvt_pk_bf16_f32 v27, v58, v59
  v_cvt_pk_bf16_f32 v28, v60, v61
  v_cvt_pk_bf16_f32 v29, v62, v63
  v_cvt_pk_bf16_f32 v30, v64, v65
  v_cvt_pk_bf16_f32 v31, v66, v67
  v_cvt_pk_bf16_f32 v32, v68, v69
  v_cvt_pk_bf16_f32 v33, v70, v71
  v_cvt_pk_bf16_f32 v34, v72, v73
  v_cvt_pk_bf16_f32 v35, v74, v75
  s_mul_i32 s17, s19, 20480
  s_mul_i32 s18, s16, 5120
  s_add_u32 s17, s17, s18
  s_add_u32 s17, s17, 54525952
  buffer_store_dwordx4 v[16:19], v14, s[4:7], s17 offen offset:0 sc1
  buffer_store_dwordx4 v[20:23], v14, s[4:7], s17 offen offset:1024 sc1
  buffer_store_dwordx4 v[24:27], v14, s[4:7], s17 offen offset:2048 sc1
  buffer_store_dwordx4 v[28:31], v14, s[4:7], s17 offen offset:3072 sc1
  s_add_u32 s17, s17, 4096
  buffer_store_dwordx4 v[32:35], v14, s[4:7], s17 offen offset:0 sc1
redln1_exit1:
  s_endpgm
.globl redln2_kernel
.p2align 8
.type redln2_kernel,@function
redln2_kernel:
  s_cmp_ge_u32 s2, 128
  s_cbranch_scc1 redln2_exit1
  s_load_dwordx2 s[12:13], s[0:1], 96
  s_load_dwordx2 s[14:15], s[0:1], 0
  v_lshrrev_b32 v2, 6, v0
  s_nop 0
  v_readfirstlane_b32 s16, v2
  s_waitcnt lgkmcnt(0)
  s_mov_b32 s4, s12
  s_mov_b32 s5, s13
  s_mov_b32 s6, 0x10000000
  s_mov_b32 s7, 0x20000
  s_mov_b32 s8, s12
  s_mov_b32 s9, s13
  s_mov_b32 s10, 0x10000000
  s_mov_b32 s11, 0x20000
  s_mov_b32 s20, 82313216
  s_mov_b32 s19, s2
  v_and_b32 v3, 63, v0
  v_lshlrev_b32 v14, 4, v3
  v_and_b32 v2, 15, v3
  v_lshrrev_b32 v4, 4, v3
  s_lshl_b32 s17, s19, 4
  v_add_u32 v15, s17, v2
  v_mul_u32_u24 v15, 1280, v15
  v_lshl_add_u32 v15, v4, 4, v15
  s_mul_i32 s17, s16, 320
  s_add_u32 s20, s20, s17
  s_add_u32 s21, s17, 82313216
  s_mul_i32 s22, s19, 20
  s_mul_i32 s23, s16, 5
  s_add_u32 s22, s22, s23
  s_lshl_b32 s22, s22, 10
  s_add_u32 s22, s22, 90832896
  s_add_u32 s24, s22, 0
  s_add_u32 s25, s22, 2621440
  s_add_u32 s26, s22, 5242880
  s_add_u32 s27, s22, 7864320
  s_add_u32 s28, s22, 10485760
  s_add_u32 s29, s22, 13107200
  s_add_u32 s30, s22, 15728640
  s_add_u32 s31, s22, 18350080
  v_add_u32 v6, 0x1000, v14
  buffer_load_dwordx4 v[16:19], v15, s[8:11], s20 offen offset:0
  buffer_load_dwordx4 v[20:23], v15, s[8:11], s20 offen offset:64
  buffer_load_dwordx4 v[24:27], v15, s[8:11], s20 offen offset:128
  buffer_load_dwordx4 v[28:31], v15, s[8:11], s20 offen offset:192
  buffer_load_dwordx4 v[32:35], v15, s[8:11], s20 offen offset:256
  buffer_load_dwordx4 v[80:83], v14, s[4:7], s24 offen offset:0
  buffer_load_dwordx4 v[84:87], v14, s[4:7], s25 offen offset:0
  buffer_load_dwordx4 v[88:91], v14, s[4:7], s26 offen offset:0
  buffer_load_dwordx4 v[92:95], v14, s[4:7], s27 offen offset:0
  buffer_load_dwordx4 v[96:99], v14, s[4:7], s28 offen offset:0
  buffer_load_dwordx4 v[100:103], v14, s[4:7], s29 offen offset:0
  buffer_load_dwordx4 v[104:107], v14, s[4:7], s30 offen offset:0
  buffer_load_dwordx4 v[108:111], v14, s[4:7], s31 offen offset:0
  buffer_load_dwordx4 v[112:115], v14, s[4:7], s24 offen offset:1024
  buffer_load_dwordx4 v[116:119], v14, s[4:7], s25 offen offset:1024
  buffer_load_dwordx4 v[120:123], v14, s[4:7], s26 offen offset:1024
  buffer_load_dwordx4 v[124:127], v14, s[4:7], s27 offen offset:1024
  buffer_load_dwordx4 v[128:131], v14, s[4:7], s28 offen offset:1024
  buffer_load_dwordx4 v[132:135], v14, s[4:7], s29 offen offset:1024
  buffer_load_dwordx4 v[136:139], v14, s[4:7], s30 offen offset:1024
  buffer_load_dwordx4 v[140:143], v14, s[4:7], s31 offen offset:1024
  buffer_load_dwordx4 v[144:147], v14, s[4:7], s24 offen offset:2048
  buffer_load_dwordx4 v[148:151], v14, s[4:7], s25 offen offset:2048
  buffer_load_dwordx4 v[152:155], v14, s[4:7], s26 offen offset:2048
  buffer_load_dwordx4 v[156:159], v14, s[4:7], s27 offen offset:2048
  buffer_load_dwordx4 v[160:163], v14, s[4:7], s28 offen offset:2048
  buffer_load_dwordx4 v[164:167], v14, s[4:7], s29 offen offset:2048
  buffer_load_dwordx4 v[168:171], v14, s[4:7], s30 offen offset:2048
  buffer_load_dwordx4 v[172:175], v14, s[4:7], s31 offen offset:2048
  buffer_load_dwordx4 v[176:179], v14, s[4:7], s24 offen offset:3072
  buffer_load_dwordx4 v[180:183], v14, s[4:7], s25 offen offset:3072
  buffer_load_dwordx4 v[184:187], v14, s[4:7], s26 offen offset:3072
  buffer_load_dwordx4 v[188:191], v14, s[4:7], s27 offen offset:3072
  buffer_load_dwordx4 v[192:195], v14, s[4:7], s28 offen offset:3072
  buffer_load_dwordx4 v[196:199], v14, s[4:7], s29 offen offset:3072
  buffer_load_dwordx4 v[200:203], v14, s[4:7], s30 offen offset:3072
  buffer_load_dwordx4 v[204:207], v14, s[4:7], s31 offen offset:3072
  buffer_load_dwordx4 v[208:211], v6, s[4:7], s24 offen offset:0
  buffer_load_dwordx4 v[212:215], v6, s[4:7], s25 offen offset:0
  buffer_load_dwordx4 v[216:219], v6, s[4:7], s26 offen offset:0
  buffer_load_dwordx4 v[220:223], v6, s[4:7], s27 offen offset:0
  buffer_load_dwordx4 v[224:227], v6, s[4:7], s28 offen offset:0
  buffer_load_dwordx4 v[228:231], v6, s[4:7], s29 offen offset:0
  buffer_load_dwordx4 v[232:235], v6, s[4:7], s30 offen offset:0
  buffer_load_dwordx4 v[236:239], v6, s[4:7], s31 offen offset:0
  s_waitcnt vmcnt(32)
  v_lshlrev_b32 v36, 16, v80
  v_and_b32 v37, 0xffff0000, v80
  v_lshlrev_b32 v38, 16, v81
  v_and_b32 v39, 0xffff0000, v81
  v_lshlrev_b32 v40, 16, v82
  v_and_b32 v41, 0xffff0000, v82
  v_lshlrev_b32 v42, 16, v83
  v_and_b32 v43, 0xffff0000, v83
  v_lshlrev_b32 v8, 16, v84
  v_and_b32 v9, 0xffff0000, v84
  v_pk_add_f32 v[36:37], v[36:37], v[8:9]
  v_lshlrev_b32 v8, 16, v85
  v_and_b32 v9, 0xffff0000, v85
  v_pk_add_f32 v[38:39], v[38:39], v[8:9]
  v_lshlrev_b32 v8, 16, v86
  v_and_b32 v9, 0xffff0000, v86
  v_pk_add_f32 v[40:41], v[40:41], v[8:9]
  v_lshlrev_b32 v8, 16, v87
  v_and_b32 v9, 0xffff0000, v87
  v_pk_add_f32 v[42:43], v[42:43], v[8:9]
  v_lshlrev_b32 v8, 16, v88
  v_and_b32 v9, 0xffff0000, v88
  v_pk_add_f32 v[36:37], v[36:37], v[8:9]
  v_lshlrev_b32 v8, 16, v89
  v_and_b32 v9, 0xffff0000, v89
  v_pk_add_f32 v[38:39], v[38:39], v[8:9]
  v_lshlrev_b32 v8, 16, v90
  v_and_b32 v9, 0xffff0000, v90
  v_pk_add_f32 v[40:41], v[40:41], v[8:9]
  v_lshlrev_b32 v8, 16, v91
  v_and_b32 v9, 0xffff0000, v91
  v_pk_add_f32 v[42:43], v[42:43], v[8:9]
  v_lshlrev_b32 v8, 16, v92
  v_and_b32 v9, 0xffff0000, v92
  v_pk_add_f32 v[36:37], v[36:37], v[8:9]
  v_lshlrev_b32 v8, 16, v93
  v_and_b32 v9, 0xffff0000, v93
  v_pk_add_f32 v[38:39], v[38:39], v[8:9]
  v_lshlrev_b32 v8, 16, v94
  v_and_b32 v9, 0xffff0000, v94
  v_pk_add_f32 v[40:41], v[40:41], v[8:9]
  v_lshlrev_b32 v8, 16, v95
  v_and_b32 v9, 0xffff0000, v95
  v_pk_add_f32 v[42:43], v[42:43], v[8:9]
  v_lshlrev_b32 v8, 16, v96
  v_and_b32 v9, 0xffff0000, v96
  v_pk_add_f32 v[36:37], v[36:37], v[8:9]
  v_lshlrev_b32 v8, 16, v97
  v_and_b32 v9, 0xffff0000, v97
  v_pk_add_f32 v[38:39], v[38:39], v[8:9]
  v_lshlrev_b32 v8, 16, v98
  v_and_b32 v9, 0xffff0000, v98
  v_pk_add_f32 v[40:41], v[40:41], v[8:9]
  v_lshlrev_b32 v8, 16, v99
  v_and_b32 v9, 0xffff0000, v99
  v_pk_add_f32 v[42:43], v[42:43], v[8:9]
  v_lshlrev_b32 v8, 16, v100
  v_and_b32 v9, 0xffff0000, v100
  v_pk_add_f32 v[36:37], v[36:37], v[8:9]
  v_lshlrev_b32 v8, 16, v101
  v_and_b32 v9, 0xffff0000, v101
  v_pk_add_f32 v[38:39], v[38:39], v[8:9]
  v_lshlrev_b32 v8, 16, v102
  v_and_b32 v9, 0xffff0000, v102
  v_pk_add_f32 v[40:41], v[40:41], v[8:9]
  v_lshlrev_b32 v8, 16, v103
  v_and_b32 v9, 0xffff0000, v103
  v_pk_add_f32 v[42:43], v[42:43], v[8:9]
  v_lshlrev_b32 v8, 16, v104
  v_and_b32 v9, 0xffff0000, v104
  v_pk_add_f32 v[36:37], v[36:37], v[8:9]
  v_lshlrev_b32 v8, 16, v105
  v_and_b32 v9, 0xffff0000, v105
  v_pk_add_f32 v[38:39], v[38:39], v[8:9]
  v_lshlrev_b32 v8, 16, v106
  v_and_b32 v9, 0xffff0000, v106
  v_pk_add_f32 v[40:41], v[40:41], v[8:9]
  v_lshlrev_b32 v8, 16, v107
  v_and_b32 v9, 0xffff0000, v107
  v_pk_add_f32 v[42:43], v[42:43], v[8:9]
  v_lshlrev_b32 v8, 16, v108
  v_and_b32 v9, 0xffff0000, v108
  v_pk_add_f32 v[36:37], v[36:37], v[8:9]
  v_lshlrev_b32 v8, 16, v109
  v_and_b32 v9, 0xffff0000, v109
  v_pk_add_f32 v[38:39], v[38:39], v[8:9]
  v_lshlrev_b32 v8, 16, v110
  v_and_b32 v9, 0xffff0000, v110
  v_pk_add_f32 v[40:41], v[40:41], v[8:9]
  v_lshlrev_b32 v8, 16, v111
  v_and_b32 v9, 0xffff0000, v111
  v_pk_add_f32 v[42:43], v[42:43], v[8:9]
  v_cvt_pk_bf16_f32 v8, v36, v37
  v_lshlrev_b32 v36, 16, v8
  v_and_b32 v37, 0xffff0000, v8
  v_lshlrev_b32 v10, 16, v16
  v_and_b32 v11, 0xffff0000, v16
  v_pk_add_f32 v[36:37], v[36:37], v[10:11]
  v_cvt_pk_bf16_f32 v16, v36, v37
  v_lshlrev_b32 v36, 16, v16
  v_and_b32 v37, 0xffff0000, v16
  v_cvt_pk_bf16_f32 v8, v38, v39
  v_lshlrev_b32 v38, 16, v8
  v_and_b32 v39, 0xffff0000, v8
  v_lshlrev_b32 v10, 16, v17
  v_and_b32 v11, 0xffff0000, v17
  v_pk_add_f32 v[38:39], v[38:39], v[10:11]
  v_cvt_pk_bf16_f32 v17, v38, v39
  v_lshlrev_b32 v38, 16, v17
  v_and_b32 v39, 0xffff0000, v17
  v_cvt_pk_bf16_f32 v8, v40, v41
  v_lshlrev_b32 v40, 16, v8
  v_and_b32 v41, 0xffff0000, v8
  v_lshlrev_b32 v10, 16, v18
  v_and_b32 v11, 0xffff0000, v18
  v_pk_add_f32 v[40:41], v[40:41], v[10:11]
  v_cvt_pk_bf16_f32 v18, v40, v41
  v_lshlrev_b32 v40, 16, v18
  v_and_b32 v41, 0xffff0000, v18
  v_cvt_pk_bf16_f32 v8, v42, v43
  v_lshlrev_b32 v42, 16, v8
  v_and_b32 v43, 0xffff0000, v8
  v_lshlrev_b32 v10, 16, v19
  v_and_b32 v11, 0xffff0000, v19
  v_pk_add_f32 v[42:43], v[42:43], v[10:11]
  v_cvt_pk_bf16_f32 v19, v42, v43
  v_lshlrev_b32 v42, 16, v19
  v_and_b32 v43, 0xffff0000, v19
  buffer_store_dwordx4 v[16:19], v15, s[4:7], s21 offen offset:0 sc1
  s_waitcnt vmcnt(25)
  v_lshlrev_b32 v44, 16, v112
  v_and_b32 v45, 0xffff0000, v112
  v_lshlrev_b32 v46, 16, v113
  v_and_b32 v47, 0xffff0000, v113
  v_lshlrev_b32 v48, 16, v114
  v_and_b32 v49, 0xffff0000, v114
  v_lshlrev_b32 v50, 16, v115
  v_and_b32 v51, 0xffff0000, v115
  v_lshlrev_b32 v8, 16, v116
  v_and_b32 v9, 0xffff0000, v116
  v_pk_add_f32 v[44:45], v[44:45], v[8:9]
  v_lshlrev_b32 v8, 16, v117
  v_and_b32 v9, 0xffff0000, v117
  v_pk_add_f32 v[46:47], v[46:47], v[8:9]
  v_lshlrev_b32 v8, 16, v118
  v_and_b32 v9, 0xffff0000, v118
  v_pk_add_f32 v[48:49], v[48:49], v[8:9]
  v_lshlrev_b32 v8, 16, v119
  v_and_b32 v9, 0xffff0000, v119
  v_pk_add_f32 v[50:51], v[50:51], v[8:9]
  v_lshlrev_b32 v8, 16, v120
  v_and_b32 v9, 0xffff0000, v120
  v_pk_add_f32 v[44:45], v[44:45], v[8:9]
  v_lshlrev_b32 v8, 16, v121
  v_and_b32 v9, 0xffff0000, v121
  v_pk_add_f32 v[46:47], v[46:47], v[8:9]
  v_lshlrev_b32 v8, 16, v122
  v_and_b32 v9, 0xffff0000, v122
  v_pk_add_f32 v[48:49], v[48:49], v[8:9]
  v_lshlrev_b32 v8, 16, v123
  v_and_b32 v9, 0xffff0000, v123
  v_pk_add_f32 v[50:51], v[50:51], v[8:9]
  v_lshlrev_b32 v8, 16, v124
  v_and_b32 v9, 0xffff0000, v124
  v_pk_add_f32 v[44:45], v[44:45], v[8:9]
  v_lshlrev_b32 v8, 16, v125
  v_and_b32 v9, 0xffff0000, v125
  v_pk_add_f32 v[46:47], v[46:47], v[8:9]
  v_lshlrev_b32 v8, 16, v126
  v_and_b32 v9, 0xffff0000, v126
  v_pk_add_f32 v[48:49], v[48:49], v[8:9]
  v_lshlrev_b32 v8, 16, v127
  v_and_b32 v9, 0xffff0000, v127
  v_pk_add_f32 v[50:51], v[50:51], v[8:9]
  v_lshlrev_b32 v8, 16, v128
  v_and_b32 v9, 0xffff0000, v128
  v_pk_add_f32 v[44:45], v[44:45], v[8:9]
  v_lshlrev_b32 v8, 16, v129
  v_and_b32 v9, 0xffff0000, v129
  v_pk_add_f32 v[46:47], v[46:47], v[8:9]
  v_lshlrev_b32 v8, 16, v130
  v_and_b32 v9, 0xffff0000, v130
  v_pk_add_f32 v[48:49], v[48:49], v[8:9]
  v_lshlrev_b32 v8, 16, v131
  v_and_b32 v9, 0xffff0000, v131
  v_pk_add_f32 v[50:51], v[50:51], v[8:9]
  v_lshlrev_b32 v8, 16, v132
  v_and_b32 v9, 0xffff0000, v132
  v_pk_add_f32 v[44:45], v[44:45], v[8:9]
  v_lshlrev_b32 v8, 16, v133
  v_and_b32 v9, 0xffff0000, v133
  v_pk_add_f32 v[46:47], v[46:47], v[8:9]
  v_lshlrev_b32 v8, 16, v134
  v_and_b32 v9, 0xffff0000, v134
  v_pk_add_f32 v[48:49], v[48:49], v[8:9]
  v_lshlrev_b32 v8, 16, v135
  v_and_b32 v9, 0xffff0000, v135
  v_pk_add_f32 v[50:51], v[50:51], v[8:9]
  v_lshlrev_b32 v8, 16, v136
  v_and_b32 v9, 0xffff0000, v136
  v_pk_add_f32 v[44:45], v[44:45], v[8:9]
  v_lshlrev_b32 v8, 16, v137
  v_and_b32 v9, 0xffff0000, v137
  v_pk_add_f32 v[46:47], v[46:47], v[8:9]
  v_lshlrev_b32 v8, 16, v138
  v_and_b32 v9, 0xffff0000, v138
  v_pk_add_f32 v[48:49], v[48:49], v[8:9]
  v_lshlrev_b32 v8, 16, v139
  v_and_b32 v9, 0xffff0000, v139
  v_pk_add_f32 v[50:51], v[50:51], v[8:9]
  v_lshlrev_b32 v8, 16, v140
  v_and_b32 v9, 0xffff0000, v140
  v_pk_add_f32 v[44:45], v[44:45], v[8:9]
  v_lshlrev_b32 v8, 16, v141
  v_and_b32 v9, 0xffff0000, v141
  v_pk_add_f32 v[46:47], v[46:47], v[8:9]
  v_lshlrev_b32 v8, 16, v142
  v_and_b32 v9, 0xffff0000, v142
  v_pk_add_f32 v[48:49], v[48:49], v[8:9]
  v_lshlrev_b32 v8, 16, v143
  v_and_b32 v9, 0xffff0000, v143
  v_pk_add_f32 v[50:51], v[50:51], v[8:9]
  v_cvt_pk_bf16_f32 v8, v44, v45
  v_lshlrev_b32 v44, 16, v8
  v_and_b32 v45, 0xffff0000, v8
  v_lshlrev_b32 v10, 16, v20
  v_and_b32 v11, 0xffff0000, v20
  v_pk_add_f32 v[44:45], v[44:45], v[10:11]
  v_cvt_pk_bf16_f32 v20, v44, v45
  v_lshlrev_b32 v44, 16, v20
  v_and_b32 v45, 0xffff0000, v20
  v_cvt_pk_bf16_f32 v8, v46, v47
  v_lshlrev_b32 v46, 16, v8
  v_and_b32 v47, 0xffff0000, v8
  v_lshlrev_b32 v10, 16, v21
  v_and_b32 v11, 0xffff0000, v21
  v_pk_add_f32 v[46:47], v[46:47], v[10:11]
  v_cvt_pk_bf16_f32 v21, v46, v47
  v_lshlrev_b32 v46, 16, v21
  v_and_b32 v47, 0xffff0000, v21
  v_cvt_pk_bf16_f32 v8, v48, v49
  v_lshlrev_b32 v48, 16, v8
  v_and_b32 v49, 0xffff0000, v8
  v_lshlrev_b32 v10, 16, v22
  v_and_b32 v11, 0xffff0000, v22
  v_pk_add_f32 v[48:49], v[48:49], v[10:11]
  v_cvt_pk_bf16_f32 v22, v48, v49
  v_lshlrev_b32 v48, 16, v22
  v_and_b32 v49, 0xffff0000, v22
  v_cvt_pk_bf16_f32 v8, v50, v51
  v_lshlrev_b32 v50, 16, v8
  v_and_b32 v51, 0xffff0000, v8
  v_lshlrev_b32 v10, 16, v23
  v_and_b32 v11, 0xffff0000, v23
  v_pk_add_f32 v[50:51], v[50:51], v[10:11]
  v_cvt_pk_bf16_f32 v23, v50, v51
  v_lshlrev_b32 v50, 16, v23
  v_and_b32 v51, 0xffff0000, v23
  buffer_store_dwordx4 v[20:23], v15, s[4:7], s21 offen offset:64 sc1
  s_waitcnt vmcnt(18)
  v_lshlrev_b32 v52, 16, v144
  v_and_b32 v53, 0xffff0000, v144
  v_lshlrev_b32 v54, 16, v145
  v_and_b32 v55, 0xffff0000, v145
  v_lshlrev_b32 v56, 16, v146
  v_and_b32 v57, 0xffff0000, v146
  v_lshlrev_b32 v58, 16, v147
  v_and_b32 v59, 0xffff0000, v147
  v_lshlrev_b32 v8, 16, v148
  v_and_b32 v9, 0xffff0000, v148
  v_pk_add_f32 v[52:53], v[52:53], v[8:9]
  v_lshlrev_b32 v8, 16, v149
  v_and_b32 v9, 0xffff0000, v149
  v_pk_add_f32 v[54:55], v[54:55], v[8:9]
  v_lshlrev_b32 v8, 16, v150
  v_and_b32 v9, 0xffff0000, v150
  v_pk_add_f32 v[56:57], v[56:57], v[8:9]
  v_lshlrev_b32 v8, 16, v151
  v_and_b32 v9, 0xffff0000, v151
  v_pk_add_f32 v[58:59], v[58:59], v[8:9]
  v_lshlrev_b32 v8, 16, v152
  v_and_b32 v9, 0xffff0000, v152
  v_pk_add_f32 v[52:53], v[52:53], v[8:9]
  v_lshlrev_b32 v8, 16, v153
  v_and_b32 v9, 0xffff0000, v153
  v_pk_add_f32 v[54:55], v[54:55], v[8:9]
  v_lshlrev_b32 v8, 16, v154
  v_and_b32 v9, 0xffff0000, v154
  v_pk_add_f32 v[56:57], v[56:57], v[8:9]
  v_lshlrev_b32 v8, 16, v155
  v_and_b32 v9, 0xffff0000, v155
  v_pk_add_f32 v[58:59], v[58:59], v[8:9]
  v_lshlrev_b32 v8, 16, v156
  v_and_b32 v9, 0xffff0000, v156
  v_pk_add_f32 v[52:53], v[52:53], v[8:9]
  v_lshlrev_b32 v8, 16, v157
  v_and_b32 v9, 0xffff0000, v157
  v_pk_add_f32 v[54:55], v[54:55], v[8:9]
  v_lshlrev_b32 v8, 16, v158
  v_and_b32 v9, 0xffff0000, v158
  v_pk_add_f32 v[56:57], v[56:57], v[8:9]
  v_lshlrev_b32 v8, 16, v159
  v_and_b32 v9, 0xffff0000, v159
  v_pk_add_f32 v[58:59], v[58:59], v[8:9]
  v_lshlrev_b32 v8, 16, v160
  v_and_b32 v9, 0xffff0000, v160
  v_pk_add_f32 v[52:53], v[52:53], v[8:9]
  v_lshlrev_b32 v8, 16, v161
  v_and_b32 v9, 0xffff0000, v161
  v_pk_add_f32 v[54:55], v[54:55], v[8:9]
  v_lshlrev_b32 v8, 16, v162
  v_and_b32 v9, 0xffff0000, v162
  v_pk_add_f32 v[56:57], v[56:57], v[8:9]
  v_lshlrev_b32 v8, 16, v163
  v_and_b32 v9, 0xffff0000, v163
  v_pk_add_f32 v[58:59], v[58:59], v[8:9]
  v_lshlrev_b32 v8, 16, v164
  v_and_b32 v9, 0xffff0000, v164
  v_pk_add_f32 v[52:53], v[52:53], v[8:9]
  v_lshlrev_b32 v8, 16, v165
  v_and_b32 v9, 0xffff0000, v165
  v_pk_add_f32 v[54:55], v[54:55], v[8:9]
  v_lshlrev_b32 v8, 16, v166
  v_and_b32 v9, 0xffff0000, v166
  v_pk_add_f32 v[56:57], v[56:57], v[8:9]
  v_lshlrev_b32 v8, 16, v167
  v_and_b32 v9, 0xffff0000, v167
  v_pk_add_f32 v[58:59], v[58:59], v[8:9]
  v_lshlrev_b32 v8, 16, v168
  v_and_b32 v9, 0xffff0000, v168
  v_pk_add_f32 v[52:53], v[52:53], v[8:9]
  v_lshlrev_b32 v8, 16, v169
  v_and_b32 v9, 0xffff0000, v169
  v_pk_add_f32 v[54:55], v[54:55], v[8:9]
  v_lshlrev_b32 v8, 16, v170
  v_and_b32 v9, 0xffff0000, v170
  v_pk_add_f32 v[56:57], v[56:57], v[8:9]
  v_lshlrev_b32 v8, 16, v171
  v_and_b32 v9, 0xffff0000, v171
  v_pk_add_f32 v[58:59], v[58:59], v[8:9]
  v_lshlrev_b32 v8, 16, v172
  v_and_b32 v9, 0xffff0000, v172
  v_pk_add_f32 v[52:53], v[52:53], v[8:9]
  v_lshlrev_b32 v8, 16, v173
  v_and_b32 v9, 0xffff0000, v173
  v_pk_add_f32 v[54:55], v[54:55], v[8:9]
  v_lshlrev_b32 v8, 16, v174
  v_and_b32 v9, 0xffff0000, v174
  v_pk_add_f32 v[56:57], v[56:57], v[8:9]
  v_lshlrev_b32 v8, 16, v175
  v_and_b32 v9, 0xffff0000, v175
  v_pk_add_f32 v[58:59], v[58:59], v[8:9]
  v_cvt_pk_bf16_f32 v8, v52, v53
  v_lshlrev_b32 v52, 16, v8
  v_and_b32 v53, 0xffff0000, v8
  v_lshlrev_b32 v10, 16, v24
  v_and_b32 v11, 0xffff0000, v24
  v_pk_add_f32 v[52:53], v[52:53], v[10:11]
  v_cvt_pk_bf16_f32 v24, v52, v53
  v_lshlrev_b32 v52, 16, v24
  v_and_b32 v53, 0xffff0000, v24
  v_cvt_pk_bf16_f32 v8, v54, v55
  v_lshlrev_b32 v54, 16, v8
  v_and_b32 v55, 0xffff0000, v8
  v_lshlrev_b32 v10, 16, v25
  v_and_b32 v11, 0xffff0000, v25
  v_pk_add_f32 v[54:55], v[54:55], v[10:11]
  v_cvt_pk_bf16_f32 v25, v54, v55
  v_lshlrev_b32 v54, 16, v25
  v_and_b32 v55, 0xffff0000, v25
  v_cvt_pk_bf16_f32 v8, v56, v57
  v_lshlrev_b32 v56, 16, v8
  v_and_b32 v57, 0xffff0000, v8
  v_lshlrev_b32 v10, 16, v26
  v_and_b32 v11, 0xffff0000, v26
  v_pk_add_f32 v[56:57], v[56:57], v[10:11]
  v_cvt_pk_bf16_f32 v26, v56, v57
  v_lshlrev_b32 v56, 16, v26
  v_and_b32 v57, 0xffff0000, v26
  v_cvt_pk_bf16_f32 v8, v58, v59
  v_lshlrev_b32 v58, 16, v8
  v_and_b32 v59, 0xffff0000, v8
  v_lshlrev_b32 v10, 16, v27
  v_and_b32 v11, 0xffff0000, v27
  v_pk_add_f32 v[58:59], v[58:59], v[10:11]
  v_cvt_pk_bf16_f32 v27, v58, v59
  v_lshlrev_b32 v58, 16, v27
  v_and_b32 v59, 0xffff0000, v27
  buffer_store_dwordx4 v[24:27], v15, s[4:7], s21 offen offset:128 sc1
  s_waitcnt vmcnt(11)
  v_lshlrev_b32 v60, 16, v176
  v_and_b32 v61, 0xffff0000, v176
  v_lshlrev_b32 v62, 16, v177
  v_and_b32 v63, 0xffff0000, v177
  v_lshlrev_b32 v64, 16, v178
  v_and_b32 v65, 0xffff0000, v178
  v_lshlrev_b32 v66, 16, v179
  v_and_b32 v67, 0xffff0000, v179
  v_lshlrev_b32 v8, 16, v180
  v_and_b32 v9, 0xffff0000, v180
  v_pk_add_f32 v[60:61], v[60:61], v[8:9]
  v_lshlrev_b32 v8, 16, v181
  v_and_b32 v9, 0xffff0000, v181
  v_pk_add_f32 v[62:63], v[62:63], v[8:9]
  v_lshlrev_b32 v8, 16, v182
  v_and_b32 v9, 0xffff0000, v182
  v_pk_add_f32 v[64:65], v[64:65], v[8:9]
  v_lshlrev_b32 v8, 16, v183
  v_and_b32 v9, 0xffff0000, v183
  v_pk_add_f32 v[66:67], v[66:67], v[8:9]
  v_lshlrev_b32 v8, 16, v184
  v_and_b32 v9, 0xffff0000, v184
  v_pk_add_f32 v[60:61], v[60:61], v[8:9]
  v_lshlrev_b32 v8, 16, v185
  v_and_b32 v9, 0xffff0000, v185
  v_pk_add_f32 v[62:63], v[62:63], v[8:9]
  v_lshlrev_b32 v8, 16, v186
  v_and_b32 v9, 0xffff0000, v186
  v_pk_add_f32 v[64:65], v[64:65], v[8:9]
  v_lshlrev_b32 v8, 16, v187
  v_and_b32 v9, 0xffff0000, v187
  v_pk_add_f32 v[66:67], v[66:67], v[8:9]
  v_lshlrev_b32 v8, 16, v188
  v_and_b32 v9, 0xffff0000, v188
  v_pk_add_f32 v[60:61], v[60:61], v[8:9]
  v_lshlrev_b32 v8, 16, v189
  v_and_b32 v9, 0xffff0000, v189
  v_pk_add_f32 v[62:63], v[62:63], v[8:9]
  v_lshlrev_b32 v8, 16, v190
  v_and_b32 v9, 0xffff0000, v190
  v_pk_add_f32 v[64:65], v[64:65], v[8:9]
  v_lshlrev_b32 v8, 16, v191
  v_and_b32 v9, 0xffff0000, v191
  v_pk_add_f32 v[66:67], v[66:67], v[8:9]
  v_lshlrev_b32 v8, 16, v192
  v_and_b32 v9, 0xffff0000, v192
  v_pk_add_f32 v[60:61], v[60:61], v[8:9]
  v_lshlrev_b32 v8, 16, v193
  v_and_b32 v9, 0xffff0000, v193
  v_pk_add_f32 v[62:63], v[62:63], v[8:9]
  v_lshlrev_b32 v8, 16, v194
  v_and_b32 v9, 0xffff0000, v194
  v_pk_add_f32 v[64:65], v[64:65], v[8:9]
  v_lshlrev_b32 v8, 16, v195
  v_and_b32 v9, 0xffff0000, v195
  v_pk_add_f32 v[66:67], v[66:67], v[8:9]
  v_lshlrev_b32 v8, 16, v196
  v_and_b32 v9, 0xffff0000, v196
  v_pk_add_f32 v[60:61], v[60:61], v[8:9]
  v_lshlrev_b32 v8, 16, v197
  v_and_b32 v9, 0xffff0000, v197
  v_pk_add_f32 v[62:63], v[62:63], v[8:9]
  v_lshlrev_b32 v8, 16, v198
  v_and_b32 v9, 0xffff0000, v198
  v_pk_add_f32 v[64:65], v[64:65], v[8:9]
  v_lshlrev_b32 v8, 16, v199
  v_and_b32 v9, 0xffff0000, v199
  v_pk_add_f32 v[66:67], v[66:67], v[8:9]
  v_lshlrev_b32 v8, 16, v200
  v_and_b32 v9, 0xffff0000, v200
  v_pk_add_f32 v[60:61], v[60:61], v[8:9]
  v_lshlrev_b32 v8, 16, v201
  v_and_b32 v9, 0xffff0000, v201
  v_pk_add_f32 v[62:63], v[62:63], v[8:9]
  v_lshlrev_b32 v8, 16, v202
  v_and_b32 v9, 0xffff0000, v202
  v_pk_add_f32 v[64:65], v[64:65], v[8:9]
  v_lshlrev_b32 v8, 16, v203
  v_and_b32 v9, 0xffff0000, v203
  v_pk_add_f32 v[66:67], v[66:67], v[8:9]
  v_lshlrev_b32 v8, 16, v204
  v_and_b32 v9, 0xffff0000, v204
  v_pk_add_f32 v[60:61], v[60:61], v[8:9]
  v_lshlrev_b32 v8, 16, v205
  v_and_b32 v9, 0xffff0000, v205
  v_pk_add_f32 v[62:63], v[62:63], v[8:9]
  v_lshlrev_b32 v8, 16, v206
  v_and_b32 v9, 0xffff0000, v206
  v_pk_add_f32 v[64:65], v[64:65], v[8:9]
  v_lshlrev_b32 v8, 16, v207
  v_and_b32 v9, 0xffff0000, v207
  v_pk_add_f32 v[66:67], v[66:67], v[8:9]
  v_cvt_pk_bf16_f32 v8, v60, v61
  v_lshlrev_b32 v60, 16, v8
  v_and_b32 v61, 0xffff0000, v8
  v_lshlrev_b32 v10, 16, v28
  v_and_b32 v11, 0xffff0000, v28
  v_pk_add_f32 v[60:61], v[60:61], v[10:11]
  v_cvt_pk_bf16_f32 v28, v60, v61
  v_lshlrev_b32 v60, 16, v28
  v_and_b32 v61, 0xffff0000, v28
  v_cvt_pk_bf16_f32 v8, v62, v63
  v_lshlrev_b32 v62, 16, v8
  v_and_b32 v63, 0xffff0000, v8
  v_lshlrev_b32 v10, 16, v29
  v_and_b32 v11, 0xffff0000, v29
  v_pk_add_f32 v[62:63], v[62:63], v[10:11]
  v_cvt_pk_bf16_f32 v29, v62, v63
  v_lshlrev_b32 v62, 16, v29
  v_and_b32 v63, 0xffff0000, v29
  v_cvt_pk_bf16_f32 v8, v64, v65
  v_lshlrev_b32 v64, 16, v8
  v_and_b32 v65, 0xffff0000, v8
  v_lshlrev_b32 v10, 16, v30
  v_and_b32 v11, 0xffff0000, v30
  v_pk_add_f32 v[64:65], v[64:65], v[10:11]
  v_cvt_pk_bf16_f32 v30, v64, v65
  v_lshlrev_b32 v64, 16, v30
  v_and_b32 v65, 0xffff0000, v30
  v_cvt_pk_bf16_f32 v8, v66, v67
  v_lshlrev_b32 v66, 16, v8
  v_and_b32 v67, 0xffff0000, v8
  v_lshlrev_b32 v10, 16, v31
  v_and_b32 v11, 0xffff0000, v31
  v_pk_add_f32 v[66:67], v[66:67], v[10:11]
  v_cvt_pk_bf16_f32 v31, v66, v67
  v_lshlrev_b32 v66, 16, v31
  v_and_b32 v67, 0xffff0000, v31
  buffer_store_dwordx4 v[28:31], v15, s[4:7], s21 offen offset:192 sc1
  s_waitcnt vmcnt(4)
  v_lshlrev_b32 v68, 16, v208
  v_and_b32 v69, 0xffff0000, v208
  v_lshlrev_b32 v70, 16, v209
  v_and_b32 v71, 0xffff0000, v209
  v_lshlrev_b32 v72, 16, v210
  v_and_b32 v73, 0xffff0000, v210
  v_lshlrev_b32 v74, 16, v211
  v_and_b32 v75, 0xffff0000, v211
  v_lshlrev_b32 v8, 16, v212
  v_and_b32 v9, 0xffff0000, v212
  v_pk_add_f32 v[68:69], v[68:69], v[8:9]
  v_lshlrev_b32 v8, 16, v213
  v_and_b32 v9, 0xffff0000, v213
  v_pk_add_f32 v[70:71], v[70:71], v[8:9]
  v_lshlrev_b32 v8, 16, v214
  v_and_b32 v9, 0xffff0000, v214
  v_pk_add_f32 v[72:73], v[72:73], v[8:9]
  v_lshlrev_b32 v8, 16, v215
  v_and_b32 v9, 0xffff0000, v215
  v_pk_add_f32 v[74:75], v[74:75], v[8:9]
  v_lshlrev_b32 v8, 16, v216
  v_and_b32 v9, 0xffff0000, v216
  v_pk_add_f32 v[68:69], v[68:69], v[8:9]
  v_lshlrev_b32 v8, 16, v217
  v_and_b32 v9, 0xffff0000, v217
  v_pk_add_f32 v[70:71], v[70:71], v[8:9]
  v_lshlrev_b32 v8, 16, v218
  v_and_b32 v9, 0xffff0000, v218
  v_pk_add_f32 v[72:73], v[72:73], v[8:9]
  v_lshlrev_b32 v8, 16, v219
  v_and_b32 v9, 0xffff0000, v219
  v_pk_add_f32 v[74:75], v[74:75], v[8:9]
  v_lshlrev_b32 v8, 16, v220
  v_and_b32 v9, 0xffff0000, v220
  v_pk_add_f32 v[68:69], v[68:69], v[8:9]
  v_lshlrev_b32 v8, 16, v221
  v_and_b32 v9, 0xffff0000, v221
  v_pk_add_f32 v[70:71], v[70:71], v[8:9]
  v_lshlrev_b32 v8, 16, v222
  v_and_b32 v9, 0xffff0000, v222
  v_pk_add_f32 v[72:73], v[72:73], v[8:9]
  v_lshlrev_b32 v8, 16, v223
  v_and_b32 v9, 0xffff0000, v223
  v_pk_add_f32 v[74:75], v[74:75], v[8:9]
  v_lshlrev_b32 v8, 16, v224
  v_and_b32 v9, 0xffff0000, v224
  v_pk_add_f32 v[68:69], v[68:69], v[8:9]
  v_lshlrev_b32 v8, 16, v225
  v_and_b32 v9, 0xffff0000, v225
  v_pk_add_f32 v[70:71], v[70:71], v[8:9]
  v_lshlrev_b32 v8, 16, v226
  v_and_b32 v9, 0xffff0000, v226
  v_pk_add_f32 v[72:73], v[72:73], v[8:9]
  v_lshlrev_b32 v8, 16, v227
  v_and_b32 v9, 0xffff0000, v227
  v_pk_add_f32 v[74:75], v[74:75], v[8:9]
  v_lshlrev_b32 v8, 16, v228
  v_and_b32 v9, 0xffff0000, v228
  v_pk_add_f32 v[68:69], v[68:69], v[8:9]
  v_lshlrev_b32 v8, 16, v229
  v_and_b32 v9, 0xffff0000, v229
  v_pk_add_f32 v[70:71], v[70:71], v[8:9]
  v_lshlrev_b32 v8, 16, v230
  v_and_b32 v9, 0xffff0000, v230
  v_pk_add_f32 v[72:73], v[72:73], v[8:9]
  v_lshlrev_b32 v8, 16, v231
  v_and_b32 v9, 0xffff0000, v231
  v_pk_add_f32 v[74:75], v[74:75], v[8:9]
  v_lshlrev_b32 v8, 16, v232
  v_and_b32 v9, 0xffff0000, v232
  v_pk_add_f32 v[68:69], v[68:69], v[8:9]
  v_lshlrev_b32 v8, 16, v233
  v_and_b32 v9, 0xffff0000, v233
  v_pk_add_f32 v[70:71], v[70:71], v[8:9]
  v_lshlrev_b32 v8, 16, v234
  v_and_b32 v9, 0xffff0000, v234
  v_pk_add_f32 v[72:73], v[72:73], v[8:9]
  v_lshlrev_b32 v8, 16, v235
  v_and_b32 v9, 0xffff0000, v235
  v_pk_add_f32 v[74:75], v[74:75], v[8:9]
  v_lshlrev_b32 v8, 16, v236
  v_and_b32 v9, 0xffff0000, v236
  v_pk_add_f32 v[68:69], v[68:69], v[8:9]
  v_lshlrev_b32 v8, 16, v237
  v_and_b32 v9, 0xffff0000, v237
  v_pk_add_f32 v[70:71], v[70:71], v[8:9]
  v_lshlrev_b32 v8, 16, v238
  v_and_b32 v9, 0xffff0000, v238
  v_pk_add_f32 v[72:73], v[72:73], v[8:9]
  v_lshlrev_b32 v8, 16, v239
  v_and_b32 v9, 0xffff0000, v239
  v_pk_add_f32 v[74:75], v[74:75], v[8:9]
  v_cvt_pk_bf16_f32 v8, v68, v69
  v_lshlrev_b32 v68, 16, v8
  v_and_b32 v69, 0xffff0000, v8
  v_lshlrev_b32 v10, 16, v32
  v_and_b32 v11, 0xffff0000, v32
  v_pk_add_f32 v[68:69], v[68:69], v[10:11]
  v_cvt_pk_bf16_f32 v32, v68, v69
  v_lshlrev_b32 v68, 16, v32
  v_and_b32 v69, 0xffff0000, v32
  v_cvt_pk_bf16_f32 v8, v70, v71
  v_lshlrev_b32 v70, 16, v8
  v_and_b32 v71, 0xffff0000, v8
  v_lshlrev_b32 v10, 16, v33
  v_and_b32 v11, 0xffff0000, v33
  v_pk_add_f32 v[70:71], v[70:71], v[10:11]
  v_cvt_pk_bf16_f32 v33, v70, v71
  v_lshlrev_b32 v70, 16, v33
  v_and_b32 v71, 0xffff0000, v33
  v_cvt_pk_bf16_f32 v8, v72, v73
  v_lshlrev_b32 v72, 16, v8
  v_and_b32 v73, 0xffff0000, v8
  v_lshlrev_b32 v10, 16, v34
  v_and_b32 v11, 0xffff0000, v34
  v_pk_add_f32 v[72:73], v[72:73], v[10:11]
  v_cvt_pk_bf16_f32 v34, v72, v73
  v_lshlrev_b32 v72, 16, v34
  v_and_b32 v73, 0xffff0000, v34
  v_cvt_pk_bf16_f32 v8, v74, v75
  v_lshlrev_b32 v74, 16, v8
  v_and_b32 v75, 0xffff0000, v8
  v_lshlrev_b32 v10, 16, v35
  v_and_b32 v11, 0xffff0000, v35
  v_pk_add_f32 v[74:75], v[74:75], v[10:11]
  v_cvt_pk_bf16_f32 v35, v74, v75
  v_lshlrev_b32 v74, 16, v35
  v_and_b32 v75, 0xffff0000, v35
  buffer_store_dwordx4 v[32:35], v15, s[4:7], s21 offen offset:256 sc1
  v_and_b32 v3, 63, v0
  v_and_b32 v2, 15, v3
  v_lshlrev_b32 v5, 2, v2
  s_lshl_b32 s17, s16, 6
  v_add_u32 v1, s17, v5
  v_pk_add_f32 v[6:7], v[36:37], v[38:39]
  v_pk_add_f32 v[6:7], v[6:7], v[40:41]
  v_pk_add_f32 v[6:7], v[6:7], v[42:43]
  v_pk_add_f32 v[6:7], v[6:7], v[44:45]
  v_pk_add_f32 v[6:7], v[6:7], v[46:47]
  v_pk_add_f32 v[6:7], v[6:7], v[48:49]
  v_pk_add_f32 v[6:7], v[6:7], v[50:51]
  v_pk_add_f32 v[6:7], v[6:7], v[52:53]
  v_pk_add_f32 v[6:7], v[6:7], v[54:55]
  v_pk_add_f32 v[6:7], v[6:7], v[56:57]
  v_pk_add_f32 v[6:7], v[6:7], v[58:59]
  v_pk_add_f32 v[6:7], v[6:7], v[60:61]
  v_pk_add_f32 v[6:7], v[6:7], v[62:63]
  v_pk_add_f32 v[6:7], v[6:7], v[64:65]
  v_pk_add_f32 v[6:7], v[6:7], v[66:67]
  v_pk_add_f32 v[6:7], v[6:7], v[68:69]
  v_pk_add_f32 v[6:7], v[6:7], v[70:71]
  v_pk_add_f32 v[6:7], v[6:7], v[72:73]
  v_pk_add_f32 v[6:7], v[6:7], v[74:75]
  v_add_f32 v4, v6, v7
  v_mov_b32 v2, v4
  s_nop 1
  v_permlane32_swap_b32 v4, v2
  v_add_f32 v4, v4, v2
  v_mov_b32 v2, v4
  s_nop 1
  v_permlane16_swap_b32 v4, v2
  v_add_f32 v4, v4, v2
  ds_write_b32 v1, v4 offset:0
  s_waitcnt lgkmcnt(0)
  s_barrier
  ds_read_b32 v4, v5 offset:0
  ds_read_b32 v2, v5 offset:64
  ds_read_b32 v3, v5 offset:128
  ds_read_b32 v6, v5 offset:192
  s_waitcnt lgkmcnt(0)
  v_add_f32 v4, v4, v2
  v_add_f32 v3, v3, v6
  v_add_f32 v4, v4, v3
  v_mul_f32 v6, 0xbacccccd, v4
  v_mov_b32 v7, v6
  v_pk_add_f32 v[36:37], v[36:37], v[6:7]
  v_pk_add_f32 v[38:39], v[38:39], v[6:7]
  v_pk_add_f32 v[40:41], v[40:41], v[6:7]
  v_pk_add_f32 v[42:43], v[42:43], v[6:7]
  v_pk_add_f32 v[44:45], v[44:45], v[6:7]
  v_pk_add_f32 v[46:47], v[46:47], v[6:7]
  v_pk_add_f32 v[48:49], v[48:49], v[6:7]
  v_pk_add_f32 v[50:51], v[50:51], v[6:7]
  v_pk_add_f32 v[52:53], v[52:53], v[6:7]
  v_pk_add_f32 v[54:55], v[54:55], v[6:7]
  v_pk_add_f32 v[56:57], v[56:57], v[6:7]
  v_pk_add_f32 v[58:59], v[58:59], v[6:7]
  v_pk_add_f32 v[60:61], v[60:61], v[6:7]
  v_pk_add_f32 v[62:63], v[62:63], v[6:7]
  v_pk_add_f32 v[64:65], v[64:65], v[6:7]
  v_pk_add_f32 v[66:67], v[66:67], v[6:7]
  v_pk_add_f32 v[68:69], v[68:69], v[6:7]
  v_pk_add_f32 v[70:71], v[70:71], v[6:7]
  v_pk_add_f32 v[72:73], v[72:73], v[6:7]
  v_pk_add_f32 v[74:75], v[74:75], v[6:7]
  v_pk_mul_f32 v[6:7], v[36:37], v[36:37]
  v_pk_fma_f32 v[6:7], v[38:39], v[38:39], v[6:7]
  v_pk_fma_f32 v[6:7], v[40:41], v[40:41], v[6:7]
  v_pk_fma_f32 v[6:7], v[42:43], v[42:43], v[6:7]
  v_pk_fma_f32 v[6:7], v[44:45], v[44:45], v[6:7]
  v_pk_fma_f32 v[6:7], v[46:47], v[46:47], v[6:7]
  v_pk_fma_f32 v[6:7], v[48:49], v[48:49], v[6:7]
  v_pk_fma_f32 v[6:7], v[50:51], v[50:51], v[6:7]
  v_pk_fma_f32 v[6:7], v[52:53], v[52:53], v[6:7]
  v_pk_fma_f32 v[6:7], v[54:55], v[54:55], v[6:7]
  v_pk_fma_f32 v[6:7], v[56:57], v[56:57], v[6:7]
  v_pk_fma_f32 v[6:7], v[58:59], v[58:59], v[6:7]
  v_pk_fma_f32 v[6:7], v[60:61], v[60:61], v[6:7]
  v_pk_fma_f32 v[6:7], v[62:63], v[62:63], v[6:7]
  v_pk_fma_f32 v[6:7], v[64:65], v[64:65], v[6:7]
  v_pk_fma_f32 v[6:7], v[66:67], v[66:67], v[6:7]
  v_pk_fma_f32 v[6:7], v[68:69], v[68:69], v[6:7]
  v_pk_fma_f32 v[6:7], v[70:71], v[70:71], v[6:7]
  v_pk_fma_f32 v[6:7], v[72:73], v[72:73], v[6:7]
  v_pk_fma_f32 v[6:7], v[74:75], v[74:75], v[6:7]
  v_add_f32 v4, v6, v7
  v_mov_b32 v2, v4
  s_nop 1
  v_permlane32_swap_b32 v4, v2
  v_add_f32 v4, v4, v2
  v_mov_b32 v2, v4
  s_nop 1
  v_permlane16_swap_b32 v4, v2
  v_add_f32 v4, v4, v2
  ds_write_b32 v1, v4 offset:256
  s_waitcnt lgkmcnt(0)
  s_barrier
  ds_read_b32 v4, v5 offset:256
  ds_read_b32 v2, v5 offset:320
  ds_read_b32 v3, v5 offset:384
  ds_read_b32 v6, v5 offset:448
  s_waitcnt lgkmcnt(0)
  v_add_f32 v4, v4, v2
  v_add_f32 v3, v3, v6
  v_add_f32 v4, v4, v3
  v_mov_b32 v2, 0x3727c5ac
  v_fmac_f32 v2, 0x3acccccd, v4
  v_rsq_f32 v6, v2
  s_nop 0
  v_mov_b32 v7, v6
  v_pk_mul_f32 v[36:37], v[36:37], v[6:7]
  v_pk_mul_f32 v[38:39], v[38:39], v[6:7]
  v_pk_mul_f32 v[40:41], v[40:41], v[6:7]
  v_pk_mul_f32 v[42:43], v[42:43], v[6:7]
  v_pk_mul_f32 v[44:45], v[44:45], v[6:7]
  v_pk_mul_f32 v[46:47], v[46:47], v[6:7]
  v_pk_mul_f32 v[48:49], v[48:49], v[6:7]
  v_pk_mul_f32 v[50:51], v[50:51], v[6:7]
  v_pk_mul_f32 v[52:53], v[52:53], v[6:7]
  v_pk_mul_f32 v[54:55], v[54:55], v[6:7]
  v_pk_mul_f32 v[56:57], v[56:57], v[6:7]
  v_pk_mul_f32 v[58:59], v[58:59], v[6:7]
  v_pk_mul_f32 v[60:61], v[60:61], v[6:7]
  v_pk_mul_f32 v[62:63], v[62:63], v[6:7]
  v_pk_mul_f32 v[64:65], v[64:65], v[6:7]
  v_pk_mul_f32 v[66:67], v[66:67], v[6:7]
  v_pk_mul_f32 v[68:69], v[68:69], v[6:7]
  v_pk_mul_f32 v[70:71], v[70:71], v[6:7]
  v_pk_mul_f32 v[72:73], v[72:73], v[6:7]
  v_pk_mul_f32 v[74:75], v[74:75], v[6:7]
  v_cvt_pk_bf16_f32 v16, v36, v37
  v_cvt_pk_bf16_f32 v17, v38, v39
  v_cvt_pk_bf16_f32 v18, v40, v41
  v_cvt_pk_bf16_f32 v19, v42, v43
  v_cvt_pk_bf16_f32 v20, v44, v45
  v_cvt_pk_bf16_f32 v21, v46, v47
  v_cvt_pk_bf16_f32 v22, v48, v49
  v_cvt_pk_bf16_f32 v23, v50, v51
  v_cvt_pk_bf16_f32 v24, v52, v53
  v_cvt_pk_bf16_f32 v25, v54, v55
  v_cvt_pk_bf16_f32 v26, v56, v57
  v_cvt_pk_bf16_f32 v27, v58, v59
  v_cvt_pk_bf16_f32 v28, v60, v61
  v_cvt_pk_bf16_f32 v29, v62, v63
  v_cvt_pk_bf16_f32 v30, v64, v65
  v_cvt_pk_bf16_f32 v31, v66, v67
  v_cvt_pk_bf16_f32 v32, v68, v69
  v_cvt_pk_bf16_f32 v33, v70, v71
  v_cvt_pk_bf16_f32 v34, v72, v73
  v_cvt_pk_bf16_f32 v35, v74, v75
  s_mul_i32 s17, s19, 20480
  s_mul_i32 s18, s16, 5120
  s_add_u32 s17, s17, s18
  s_add_u32 s17, s17, 54525952
  buffer_store_dwordx4 v[16:19], v14, s[4:7], s17 offen offset:0 sc1
  buffer_store_dwordx4 v[20:23], v14, s[4:7], s17 offen offset:1024 sc1
  buffer_store_dwordx4 v[24:27], v14, s[4:7], s17 offen offset:2048 sc1
  buffer_store_dwordx4 v[28:31], v14, s[4:7], s17 offen offset:3072 sc1
  s_add_u32 s17, s17, 4096
  buffer_store_dwordx4 v[32:35], v14, s[4:7], s17 offen offset:0 sc1
redln2_exit1:
  s_endpgm
.globl qkvb_kernel
.p2align 8
.type qkvb_kernel,@function
qkvb_kernel:
  s_cmp_ge_u32 s2, 256
  s_cbranch_scc1 qkvb_exit1
  s_load_dwordx2 s[12:13], s[0:1], 96
  v_lshrrev_b32 v2, 6, v0
  v_and_b32 v3, 63, v0
  s_and_b32 s17, s2, 7
  v_readfirstlane_b32 s16, v2
  v_lshlrev_b32 v1, 4, v3
  s_lshr_b32 s18, s2, 3
  s_waitcnt lgkmcnt(0)
  s_mov_b32 s4, s12
  s_mov_b32 s5, s13
  s_mov_b32 s6, 0x10000000
  s_mov_b32 s7, 0x20000
  s_lshl_b32 s21, s18, 2
  s_add_u32 s21, s21, s16
  s_mul_i32 s21, s21, 20480
  s_add_u32 s21, s21, 54525952
  s_mul_i32 s22, s16, 20480
  v_add_u32 v7, 40960, v1
  v_mov_b32 v6, v1
  s_add_u32 m0, s22, 0
  s_add_u32 s23, s21, 0
  buffer_load_dwordx4 v1, s[4:7], s23 offen offset:0 lds
  buffer_load_dwordx4 v1, s[4:7], s23 offen offset:1024 lds
  buffer_load_dwordx4 v1, s[4:7], s23 offen offset:2048 lds
  buffer_load_dwordx4 v1, s[4:7], s23 offen offset:3072 lds
  s_cmp_eq_u32 s16, 0
  s_cbranch_scc1 qkvb_w0_2
  s_cmp_eq_u32 s16, 1
  s_cbranch_scc1 qkvb_w1_3
  s_cmp_eq_u32 s16, 2
  s_cbranch_scc1 qkvb_w2_4
  s_branch qkvb_w3_5
qkvb_w0_2:
  s_mul_i32 s30, s17, 5
  s_add_u32 s30, s30, 0
  s_mul_i32 s30, s30, 20480
  s_add_u32 s30, s30, 87556096
  s_mul_i32 s31, s17, 5
  s_add_u32 s31, s31, 1
  s_mul_i32 s31, s31, 20480
  s_add_u32 s31, s31, 87556096
  s_mul_i32 s32, s17, 5
  s_add_u32 s32, s32, 2
  s_mul_i32 s32, s32, 20480
  s_add_u32 s32, s32, 87556096
  s_mul_i32 s33, s17, 5
  s_add_u32 s33, s33, 3
  s_mul_i32 s33, s33, 20480
  s_add_u32 s33, s33, 87556096
  buffer_load_dwordx4 v[72:75], v1, s[4:7], s30 offen offset:0
  buffer_load_dwordx4 v[76:79], v1, s[4:7], s31 offen offset:0
  buffer_load_dwordx4 v[80:83], v1, s[4:7], s32 offen offset:0
  buffer_load_dwordx4 v[84:87], v1, s[4:7], s33 offen offset:0
  buffer_load_dwordx4 v[88:91], v1, s[4:7], s30 offen offset:1024
  buffer_load_dwordx4 v[92:95], v1, s[4:7], s31 offen offset:1024
  buffer_load_dwordx4 v[96:99], v1, s[4:7], s32 offen offset:1024
  buffer_load_dwordx4 v[100:103], v1, s[4:7], s33 offen offset:1024
  buffer_load_dwordx4 v[104:107], v1, s[4:7], s30 offen offset:2048
  buffer_load_dwordx4 v[108:111], v1, s[4:7], s31 offen offset:2048
  buffer_load_dwordx4 v[112:115], v1, s[4:7], s32 offen offset:2048
  buffer_load_dwordx4 v[116:119], v1, s[4:7], s33 offen offset:2048
  s_add_u32 m0, s22, 4096
  s_add_u32 s23, s21, 4096
  buffer_load_dwordx4 v1, s[4:7], s23 offen offset:0 lds
  buffer_load_dwordx4 v1, s[4:7], s23 offen offset:1024 lds
  buffer_load_dwordx4 v1, s[4:7], s23 offen offset:2048 lds
  buffer_load_dwordx4 v1, s[4:7], s23 offen offset:3072 lds
  s_add_u32 m0, s22, 8192
  s_add_u32 s23, s21, 8192
  buffer_load_dwordx4 v1, s[4:7], s23 offen offset:0 lds
  buffer_load_dwordx4 v1, s[4:7], s23 offen offset:1024 lds
  buffer_load_dwordx4 v1, s[4:7], s23 offen offset:2048 lds
  buffer_load_dwordx4 v1, s[4:7], s23 offen offset:3072 lds
  s_add_u32 m0, s22, 12288
  s_add_u32 s23, s21, 12288
  buffer_load_dwordx4 v1, s[4:7], s23 offen offset:0 lds
  buffer_load_dwordx4 v1, s[4:7], s23 offen offset:1024 lds
  buffer_load_dwordx4 v1, s[4:7], s23 offen offset:2048 lds
  buffer_load_dwordx4 v1, s[4:7], s23 offen offset:3072 lds
  s_add_u32 m0, s22, 16384
  s_add_u32 s23, s21, 16384
  buffer_load_dwordx4 v1, s[4:7], s23 offen offset:0 lds
  buffer_load_dwordx4 v1, s[4:7], s23 offen offset:1024 lds
  buffer_load_dwordx4 v1, s[4:7], s23 offen offset:2048 lds
  buffer_load_dwordx4 v1, s[4:7], s23 offen offset:3072 lds
  s_waitcnt vmcnt(28)
  s_barrier
  ds_read_b128 v[136:139], v6 offset:0
  ds_read_b128 v[140:143], v6 offset:20480
  ds_read_b128 v[144:147], v7 offset:0
  ds_read_b128 v[148:151], v7 offset:20480
  buffer_load_dwordx4 v[120:123], v1, s[4:7], s30 offen offset:3072
  buffer_load_dwordx4 v[124:127], v1, s[4:7], s31 offen offset:3072
  buffer_load_dwordx4 v[128:131], v1, s[4:7], s32 offen offset:3072
  buffer_load_dwordx4 v[132:135], v1, s[4:7], s33 offen offset:3072
  s_waitcnt vmcnt(28)
  ds_read_b128 v[152:155], v6 offset:1024
  ds_read_b128 v[156:159], v6 offset:21504
  ds_read_b128 v[160:163], v7 offset:1024
  ds_read_b128 v[164:167], v7 offset:21504
  s_waitcnt lgkmcnt(4)
  v_mfma_f32_16x16x32_bf16 v[8:11], v[72:75], v[136:139], 0
  v_mfma_f32_16x16x32_bf16 v[12:15], v[72:75], v[140:143], 0
  v_mfma_f32_16x16x32_bf16 v[16:19], v[72:75], v[144:147], 0
  v_mfma_f32_16x16x32_bf16 v[20:23], v[72:75], v[148:151], 0
  v_mfma_f32_16x16x32_bf16 v[24:27], v[76:79], v[136:139], 0
  v_mfma_f32_16x16x32_bf16 v[28:31], v[76:79], v[140:143], 0
  v_mfma_f32_16x16x32_bf16 v[32:35], v[76:79], v[144:147], 0
  v_mfma_f32_16x16x32_bf16 v[36:39], v[76:79], v[148:151], 0
  v_mfma_f32_16x16x32_bf16 v[40:43], v[80:83], v[136:139], 0
  v_mfma_f32_16x16x32_bf16 v[44:47], v[80:83], v[140:143], 0
  v_mfma_f32_16x16x32_bf16 v[48:51], v[80:83], v[144:147], 0
  v_mfma_f32_16x16x32_bf16 v[52:55], v[80:83], v[148:151], 0
  v_mfma_f32_16x16x32_bf16 v[56:59], v[84:87], v[136:139], 0
  v_mfma_f32_16x16x32_bf16 v[60:63], v[84:87], v[140:143], 0
  v_mfma_f32_16x16x32_bf16 v[64:67], v[84:87], v[144:147], 0
  v_mfma_f32_16x16x32_bf16 v[68:71], v[84:87], v[148:151], 0
  s_add_u32 s30, s30, 4096
  s_add_u32 s31, s31, 4096
  s_add_u32 s32, s32, 4096
  s_add_u32 s33, s33, 4096
  buffer_load_dwordx4 v[72:75], v1, s[4:7], s30 offen offset:0
  buffer_load_dwordx4 v[76:79], v1, s[4:7], s31 offen offset:0
  buffer_load_dwordx4 v[80:83], v1, s[4:7], s32 offen offset:0
  buffer_load_dwordx4 v[84:87], v1, s[4:7], s33 offen offset:0
  s_waitcnt vmcnt(28)
  ds_read_b128 v[136:139], v6 offset:2048
  ds_read_b128 v[140:143], v6 offset:22528
  ds_read_b128 v[144:147], v7 offset:2048
  ds_read_b128 v[148:151], v7 offset:22528
  s_waitcnt lgkmcnt(4)
  v_mfma_f32_16x16x32_bf16 v[8:11], v[88:91], v[152:155], v[8:11]
  v_mfma_f32_16x16x32_bf16 v[12:15], v[88:91], v[156:159], v[12:15]
  v_mfma_f32_16x16x32_bf16 v[16:19], v[88:91], v[160:163], v[16:19]
  v_mfma_f32_16x16x32_bf16 v[20:23], v[88:91], v[164:167], v[20:23]
  v_mfma_f32_16x16x32_bf16 v[24:27], v[92:95], v[152:155], v[24:27]
  v_mfma_f32_16x16x32_bf16 v[28:31], v[92:95], v[156:159], v[28:31]
  v_mfma_f32_16x16x32_bf16 v[32:35], v[92:95], v[160:163], v[32:35]
  v_mfma_f32_16x16x32_bf16 v[36:39], v[92:95], v[164:167], v[36:39]
  v_mfma_f32_16x16x32_bf16 v[40:43], v[96:99], v[152:155], v[40:43]
  v_mfma_f32_16x16x32_bf16 v[44:47], v[96:99], v[156:159], v[44:47]
  v_mfma_f32_16x16x32_bf16 v[48:51], v[96:99], v[160:163], v[48:51]
  v_mfma_f32_16x16x32_bf16 v[52:55], v[96:99], v[164:167], v[52:55]
  v_mfma_f32_16x16x32_bf16 v[56:59], v[100:103], v[152:155], v[56:59]
  v_mfma_f32_16x16x32_bf16 v[60:63], v[100:103], v[156:159], v[60:63]
  v_mfma_f32_16x16x32_bf16 v[64:67], v[100:103], v[160:163], v[64:67]
  v_mfma_f32_16x16x32_bf16 v[68:71], v[100:103], v[164:167], v[68:71]
  buffer_load_dwordx4 v[88:91], v1, s[4:7], s30 offen offset:1024
  buffer_load_dwordx4 v[92:95], v1, s[4:7], s31 offen offset:1024
  buffer_load_dwordx4 v[96:99], v1, s[4:7], s32 offen offset:1024
  buffer_load_dwordx4 v[100:103], v1, s[4:7], s33 offen offset:1024
  s_waitcnt vmcnt(28)
  ds_read_b128 v[152:155], v6 offset:3072
  ds_read_b128 v[156:159], v6 offset:23552
  ds_read_b128 v[160:163], v7 offset:3072
  ds_read_b128 v[164:167], v7 offset:23552
  s_waitcnt lgkmcnt(4)
  v_mfma_f32_16x16x32_bf16 v[8:11], v[104:107], v[136:139], v[8:11]
  v_mfma_f32_16x16x32_bf16 v[12:15], v[104:107], v[140:143], v[12:15]
  v_mfma_f32_16x16x32_bf16 v[16:19], v[104:107], v[144:147], v[16:19]
  v_mfma_f32_16x16x32_bf16 v[20:23], v[104:107], v[148:151], v[20:23]
  v_mfma_f32_16x16x32_bf16 v[24:27], v[108:111], v[136:139], v[24:27]
  v_mfma_f32_16x16x32_bf16 v[28:31], v[108:111], v[140:143], v[28:31]
  v_mfma_f32_16x16x32_bf16 v[32:35], v[108:111], v[144:147], v[32:35]
  v_mfma_f32_16x16x32_bf16 v[36:39], v[108:111], v[148:151], v[36:39]
  v_mfma_f32_16x16x32_bf16 v[40:43], v[112:115], v[136:139], v[40:43]
  v_mfma_f32_16x16x32_bf16 v[44:47], v[112:115], v[140:143], v[44:47]
  v_mfma_f32_16x16x32_bf16 v[48:51], v[112:115], v[144:147], v[48:51]
  v_mfma_f32_16x16x32_bf16 v[52:55], v[112:115], v[148:151], v[52:55]
  v_mfma_f32_16x16x32_bf16 v[56:59], v[116:119], v[136:139], v[56:59]
  v_mfma_f32_16x16x32_bf16 v[60:63], v[116:119], v[140:143], v[60:63]
  v_mfma_f32_16x16x32_bf16 v[64:67], v[116:119], v[144:147], v[64:67]
  v_mfma_f32_16x16x32_bf16 v[68:71], v[116:119], v[148:151], v[68:71]
  buffer_load_dwordx4 v[104:107], v1, s[4:7], s30 offen offset:2048
  buffer_load_dwordx4 v[108:111], v1, s[4:7], s31 offen offset:2048
  buffer_load_dwordx4 v[112:115], v1, s[4:7], s32 offen offset:2048
  buffer_load_dwordx4 v[116:119], v1, s[4:7], s33 offen offset:2048
  s_waitcnt vmcnt(12)
  s_barrier
  ds_read_b128 v[136:139], v6 offset:4096
  ds_read_b128 v[140:143], v6 offset:24576
  ds_read_b128 v[144:147], v7 offset:4096
  ds_read_b128 v[148:151], v7 offset:24576
  s_waitcnt lgkmcnt(4)
  v_mfma_f32_16x16x32_bf16 v[8:11], v[120:123], v[152:155], v[8:11]
  v_mfma_f32_16x16x32_bf16 v[12:15], v[120:123], v[156:159], v[12:15]
  v_mfma_f32_16x16x32_bf16 v[16:19], v[120:123], v[160:163], v[16:19]
  v_mfma_f32_16x16x32_bf16 v[20:23], v[120:123], v[164:167], v[20:23]
  v_mfma_f32_16x16x32_bf16 v[24:27], v[124:127], v[152:155], v[24:27]
  v_mfma_f32_16x16x32_bf16 v[28:31], v[124:127], v[156:159], v[28:31]
  v_mfma_f32_16x16x32_bf16 v[32:35], v[124:127], v[160:163], v[32:35]
  v_mfma_f32_16x16x32_bf16 v[36:39], v[124:127], v[164:167], v[36:39]
  v_mfma_f32_16x16x32_bf16 v[40:43], v[128:131], v[152:155], v[40:43]
  v_mfma_f32_16x16x32_bf16 v[44:47], v[128:131], v[156:159], v[44:47]
  v_mfma_f32_16x16x32_bf16 v[48:51], v[128:131], v[160:163], v[48:51]
  v_mfma_f32_16x16x32_bf16 v[52:55], v[128:131], v[164:167], v[52:55]
  v_mfma_f32_16x16x32_bf16 v[56:59], v[132:135], v[152:155], v[56:59]
  v_mfma_f32_16x16x32_bf16 v[60:63], v[132:135], v[156:159], v[60:63]
  v_mfma_f32_16x16x32_bf16 v[64:67], v[132:135], v[160:163], v[64:67]
  v_mfma_f32_16x16x32_bf16 v[68:71], v[132:135], v[164:167], v[68:71]
  s_mov_b32 s40, 0
  v_add_u32 v6, 4096, v6
  v_add_u32 v7, 4096, v7
qkvb_loop6:
  buffer_load_dwordx4 v[120:123], v1, s[4:7], s30 offen offset:3072
  buffer_load_dwordx4 v[124:127], v1, s[4:7], s31 offen offset:3072
  buffer_load_dwordx4 v[128:131], v1, s[4:7], s32 offen offset:3072
  buffer_load_dwordx4 v[132:135], v1, s[4:7], s33 offen offset:3072
  s_waitcnt vmcnt(12)
  ds_read_b128 v[152:155], v6 offset:1024
  ds_read_b128 v[156:159], v6 offset:21504
  ds_read_b128 v[160:163], v7 offset:1024
  ds_read_b128 v[164:167], v7 offset:21504
  s_waitcnt lgkmcnt(4)
  v_mfma_f32_16x16x32_bf16 v[8:11], v[72:75], v[136:139], v[8:11]
  v_mfma_f32_16x16x32_bf16 v[12:15], v[72:75], v[140:143], v[12:15]
  v_mfma_f32_16x16x32_bf16 v[16:19], v[72:75], v[144:147], v[16:19]
  v_mfma_f32_16x16x32_bf16 v[20:23], v[72:75], v[148:151], v[20:23]
  v_mfma_f32_16x16x32_bf16 v[24:27], v[76:79], v[136:139], v[24:27]
  v_mfma_f32_16x16x32_bf16 v[28:31], v[76:79], v[140:143], v[28:31]
  v_mfma_f32_16x16x32_bf16 v[32:35], v[76:79], v[144:147], v[32:35]
  v_mfma_f32_16x16x32_bf16 v[36:39], v[76:79], v[148:151], v[36:39]
  v_mfma_f32_16x16x32_bf16 v[40:43], v[80:83], v[136:139], v[40:43]
  v_mfma_f32_16x16x32_bf16 v[44:47], v[80:83], v[140:143], v[44:47]
  v_mfma_f32_16x16x32_bf16 v[48:51], v[80:83], v[144:147], v[48:51]
  v_mfma_f32_16x16x32_bf16 v[52:55], v[80:83], v[148:151], v[52:55]
  v_mfma_f32_16x16x32_bf16 v[56:59], v[84:87], v[136:139], v[56:59]
  v_mfma_f32_16x16x32_bf16 v[60:63], v[84:87], v[140:143], v[60:63]
  v_mfma_f32_16x16x32_bf16 v[64:67], v[84:87], v[144:147], v[64:67]
  v_mfma_f32_16x16x32_bf16 v[68:71], v[84:87], v[148:151], v[68:71]
  s_add_u32 s30, s30, 4096
  s_add_u32 s31, s31, 4096
  s_add_u32 s32, s32, 4096
  s_add_u32 s33, s33, 4096
  buffer_load_dwordx4 v[72:75], v1, s[4:7], s30 offen offset:0
  buffer_load_dwordx4 v[76:79], v1, s[4:7], s31 offen offset:0
  buffer_load_dwordx4 v[80:83], v1, s[4:7], s32 offen offset:0
  buffer_load_dwordx4 v[84:87], v1, s[4:7], s33 offen offset:0
  s_waitcnt vmcnt(12)
  ds_read_b128 v[136:139], v6 offset:2048
  ds_read_b128 v[140:143], v6 offset:22528
  ds_read_b128 v[144:147], v7 offset:2048
  ds_read_b128 v[148:151], v7 offset:22528
  s_waitcnt lgkmcnt(4)
  v_mfma_f32_16x16x32_bf16 v[8:11], v[88:91], v[152:155], v[8:11]
  v_mfma_f32_16x16x32_bf16 v[12:15], v[88:91], v[156:159], v[12:15]
  v_mfma_f32_16x16x32_bf16 v[16:19], v[88:91], v[160:163], v[16:19]
  v_mfma_f32_16x16x32_bf16 v[20:23], v[88:91], v[164:167], v[20:23]
  v_mfma_f32_16x16x32_bf16 v[24:27], v[92:95], v[152:155], v[24:27]
  v_mfma_f32_16x16x32_bf16 v[28:31], v[92:95], v[156:159], v[28:31]
  v_mfma_f32_16x16x32_bf16 v[32:35], v[92:95], v[160:163], v[32:35]
  v_mfma_f32_16x16x32_bf16 v[36:39], v[92:95], v[164:167], v[36:39]
  v_mfma_f32_16x16x32_bf16 v[40:43], v[96:99], v[152:155], v[40:43]
  v_mfma_f32_16x16x32_bf16 v[44:47], v[96:99], v[156:159], v[44:47]
  v_mfma_f32_16x16x32_bf16 v[48:51], v[96:99], v[160:163], v[48:51]
  v_mfma_f32_16x16x32_bf16 v[52:55], v[96:99], v[164:167], v[52:55]
  v_mfma_f32_16x16x32_bf16 v[56:59], v[100:103], v[152:155], v[56:59]
  v_mfma_f32_16x16x32_bf16 v[60:63], v[100:103], v[156:159], v[60:63]
  v_mfma_f32_16x16x32_bf16 v[64:67], v[100:103], v[160:163], v[64:67]
  v_mfma_f32_16x16x32_bf16 v[68:71], v[100:103], v[164:167], v[68:71]
  buffer_load_dwordx4 v[88:91], v1, s[4:7], s30 offen offset:1024
  buffer_load_dwordx4 v[92:95], v1, s[4:7], s31 offen offset:1024
  buffer_load_dwordx4 v[96:99], v1, s[4:7], s32 offen offset:1024
  buffer_load_dwordx4 v[100:103], v1, s[4:7], s33 offen offset:1024
  s_waitcnt vmcnt(12)
  ds_read_b128 v[152:155], v6 offset:3072
  ds_read_b128 v[156:159], v6 offset:23552
  ds_read_b128 v[160:163], v7 offset:3072
  ds_read_b128 v[164:167], v7 offset:23552
  s_waitcnt lgkmcnt(4)
  v_mfma_f32_16x16x32_bf16 v[8:11], v[104:107], v[136:139], v[8:11]
  v_mfma_f32_16x16x32_bf16 v[12:15], v[104:107], v[140:143], v[12:15]
  v_mfma_f32_16x16x32_bf16 v[16:19], v[104:107], v[144:147], v[16:19]
  v_mfma_f32_16x16x32_bf16 v[20:23], v[104:107], v[148:151], v[20:23]
  v_mfma_f32_16x16x32_bf16 v[24:27], v[108:111], v[136:139], v[24:27]
  v_mfma_f32_16x16x32_bf16 v[28:31], v[108:111], v[140:143], v[28:31]
  v_mfma_f32_16x16x32_bf16 v[32:35], v[108:111], v[144:147], v[32:35]
  v_mfma_f32_16x16x32_bf16 v[36:39], v[108:111], v[148:151], v[36:39]
  v_mfma_f32_16x16x32_bf16 v[40:43], v[112:115], v[136:139], v[40:43]
  v_mfma_f32_16x16x32_bf16 v[44:47], v[112:115], v[140:143], v[44:47]
  v_mfma_f32_16x16x32_bf16 v[48:51], v[112:115], v[144:147], v[48:51]
  v_mfma_f32_16x16x32_bf16 v[52:55], v[112:115], v[148:151], v[52:55]
  v_mfma_f32_16x16x32_bf16 v[56:59], v[116:119], v[136:139], v[56:59]
  v_mfma_f32_16x16x32_bf16 v[60:63], v[116:119], v[140:143], v[60:63]
  v_mfma_f32_16x16x32_bf16 v[64:67], v[116:119], v[144:147], v[64:67]
  v_mfma_f32_16x16x32_bf16 v[68:71], v[116:119], v[148:151], v[68:71]
  buffer_load_dwordx4 v[104:107], v1, s[4:7], s30 offen offset:2048
  buffer_load_dwordx4 v[108:111], v1, s[4:7], s31 offen offset:2048
  buffer_load_dwordx4 v[112:115], v1, s[4:7], s32 offen offset:2048
  buffer_load_dwordx4 v[116:119], v1, s[4:7], s33 offen offset:2048
  s_waitcnt vmcnt(12)
  ds_read_b128 v[136:139], v6 offset:4096
  ds_read_b128 v[140:143], v6 offset:24576
  ds_read_b128 v[144:147], v7 offset:4096
  ds_read_b128 v[148:151], v7 offset:24576
  s_waitcnt lgkmcnt(4)
  v_mfma_f32_16x16x32_bf16 v[8:11], v[120:123], v[152:155], v[8:11]
  v_mfma_f32_16x16x32_bf16 v[12:15], v[120:123], v[156:159], v[12:15]
  v_mfma_f32_16x16x32_bf16 v[16:19], v[120:123], v[160:163], v[16:19]
  v_mfma_f32_16x16x32_bf16 v[20:23], v[120:123], v[164:167], v[20:23]
  v_mfma_f32_16x16x32_bf16 v[24:27], v[124:127], v[152:155], v[24:27]
  v_mfma_f32_16x16x32_bf16 v[28:31], v[124:127], v[156:159], v[28:31]
  v_mfma_f32_16x16x32_bf16 v[32:35], v[124:127], v[160:163], v[32:35]
  v_mfma_f32_16x16x32_bf16 v[36:39], v[124:127], v[164:167], v[36:39]
  v_mfma_f32_16x16x32_bf16 v[40:43], v[128:131], v[152:155], v[40:43]
  v_mfma_f32_16x16x32_bf16 v[44:47], v[128:131], v[156:159], v[44:47]
  v_mfma_f32_16x16x32_bf16 v[48:51], v[128:131], v[160:163], v[48:51]
  v_mfma_f32_16x16x32_bf16 v[52:55], v[128:131], v[164:167], v[52:55]
  v_mfma_f32_16x16x32_bf16 v[56:59], v[132:135], v[152:155], v[56:59]
  v_mfma_f32_16x16x32_bf16 v[60:63], v[132:135], v[156:159], v[60:63]
  v_mfma_f32_16x16x32_bf16 v[64:67], v[132:135], v[160:163], v[64:67]
  v_mfma_f32_16x16x32_bf16 v[68:71], v[132:135], v[164:167], v[68:71]
  v_add_u32 v6, 4096, v6
  v_add_u32 v7, 4096, v7
  s_add_u32 s40, s40, 1
  s_cmp_lt_u32 s40, 4
  s_cbranch_scc1 qkvb_loop6
  s_waitcnt vmcnt(0) lgkmcnt(0)
  v_and_b32 v2, 63, v0
  v_and_b32 v3, 15, v2
  v_lshrrev_b32 v4, 4, v2
  s_lshl_b32 s41, s17, 19
  s_lshl_b32 s42, s18, 12
  s_add_u32 s41, s41, s42
  s_mov_b32 s46, 0x3ea52b5c
  s_mov_b32 s47, 0x3ea52b5c
  v_lshlrev_b32 v5, 2, v4
  v_add_u32 v5, 0, v5
  v_mul_u32_u24 v168, 205, v5
  v_lshrrev_b32 v168, 12, v168
  v_mul_u32_u24 v6, 20, v168
  v_sub_u32 v5, v5, v6
  v_lshlrev_b32 v168, 17, v168
  v_lshrrev_b32 v6, 4, v5
  v_lshl_add_u32 v168, v6, 10, v168
  v_bfe_u32 v6, v5, 2, 1
  v_lshl_add_u32 v168, v6, 9, v168
  v_bfe_u32 v6, v5, 3, 1
  v_lshl_add_u32 v168, v6, 3, v168
  v_lshl_add_u32 v168, v3, 4, v168
  v_lshlrev_b32 v5, 2, v4
  v_add_u32 v5, 16, v5
  v_mul_u32_u24 v169, 205, v5
  v_lshrrev_b32 v169, 12, v169
  v_mul_u32_u24 v6, 20, v169
  v_sub_u32 v5, v5, v6
  v_lshlrev_b32 v169, 17, v169
  v_lshrrev_b32 v6, 4, v5
  v_lshl_add_u32 v169, v6, 10, v169
  v_bfe_u32 v6, v5, 2, 1
  v_lshl_add_u32 v169, v6, 9, v169
  v_bfe_u32 v6, v5, 3, 1
  v_lshl_add_u32 v169, v6, 3, v169
  v_lshl_add_u32 v169, v3, 4, v169
  v_lshlrev_b32 v5, 2, v4
  v_add_u32 v5, 32, v5
  v_mul_u32_u24 v170, 205, v5
  v_lshrrev_b32 v170, 12, v170
  v_mul_u32_u24 v6, 20, v170
  v_sub_u32 v5, v5, v6
  v_lshlrev_b32 v170, 17, v170
  v_lshrrev_b32 v6, 4, v5
  v_lshl_add_u32 v170, v6, 10, v170
  v_bfe_u32 v6, v5, 2, 1
  v_lshl_add_u32 v170, v6, 9, v170
  v_bfe_u32 v6, v5, 3, 1
  v_lshl_add_u32 v170, v6, 3, v170
  v_lshl_add_u32 v170, v3, 4, v170
  v_lshlrev_b32 v5, 2, v4
  v_add_u32 v5, 48, v5
  v_mul_u32_u24 v171, 205, v5
  v_lshrrev_b32 v171, 12, v171
  v_mul_u32_u24 v6, 20, v171
  v_sub_u32 v5, v5, v6
  v_lshlrev_b32 v171, 17, v171
  v_lshrrev_b32 v6, 4, v5
  v_lshl_add_u32 v171, v6, 10, v171
  v_bfe_u32 v6, v5, 2, 1
  v_lshl_add_u32 v171, v6, 9, v171
  v_bfe_u32 v6, v5, 3, 1
  v_lshl_add_u32 v171, v6, 3, v171
  v_lshl_add_u32 v171, v3, 4, v171
  v_pk_mul_f32 v[8:9], v[8:9], s[46:47]
  v_pk_mul_f32 v[10:11], v[10:11], s[46:47]
  v_cvt_pk_bf16_f32 v136, v8, v9
  v_cvt_pk_bf16_f32 v137, v10, v11
  s_add_u32 s43, s41, 37748736
  buffer_store_dwordx2 v[136:137], v168, s[4:7], s43 offen sc1
  v_pk_mul_f32 v[12:13], v[12:13], s[46:47]
  v_pk_mul_f32 v[14:15], v[14:15], s[46:47]
  v_cvt_pk_bf16_f32 v138, v12, v13
  v_cvt_pk_bf16_f32 v139, v14, v15
  s_add_u32 s43, s41, 37748992
  buffer_store_dwordx2 v[138:139], v168, s[4:7], s43 offen sc1
  v_pk_mul_f32 v[16:17], v[16:17], s[46:47]
  v_pk_mul_f32 v[18:19], v[18:19], s[46:47]
  v_cvt_pk_bf16_f32 v140, v16, v17
  v_cvt_pk_bf16_f32 v141, v18, v19
  s_add_u32 s43, s41, 37750784
  buffer_store_dwordx2 v[140:141], v168, s[4:7], s43 offen sc1
  v_pk_mul_f32 v[20:21], v[20:21], s[46:47]
  v_pk_mul_f32 v[22:23], v[22:23], s[46:47]
  v_cvt_pk_bf16_f32 v142, v20, v21
  v_cvt_pk_bf16_f32 v143, v22, v23
  s_add_u32 s43, s41, 37751040
  buffer_store_dwordx2 v[142:143], v168, s[4:7], s43 offen sc1
  v_pk_mul_f32 v[24:25], v[24:25], s[46:47]
  v_pk_mul_f32 v[26:27], v[26:27], s[46:47]
  v_cvt_pk_bf16_f32 v144, v24, v25
  v_cvt_pk_bf16_f32 v145, v26, v27
  s_add_u32 s43, s41, 37748736
  buffer_store_dwordx2 v[144:145], v169, s[4:7], s43 offen sc1
  v_pk_mul_f32 v[28:29], v[28:29], s[46:47]
  v_pk_mul_f32 v[30:31], v[30:31], s[46:47]
  v_cvt_pk_bf16_f32 v146, v28, v29
  v_cvt_pk_bf16_f32 v147, v30, v31
  s_add_u32 s43, s41, 37748992
  buffer_store_dwordx2 v[146:147], v169, s[4:7], s43 offen sc1
  v_pk_mul_f32 v[32:33], v[32:33], s[46:47]
  v_pk_mul_f32 v[34:35], v[34:35], s[46:47]
  v_cvt_pk_bf16_f32 v148, v32, v33
  v_cvt_pk_bf16_f32 v149, v34, v35
  s_add_u32 s43, s41, 37750784
  buffer_store_dwordx2 v[148:149], v169, s[4:7], s43 offen sc1
  v_pk_mul_f32 v[36:37], v[36:37], s[46:47]
  v_pk_mul_f32 v[38:39], v[38:39], s[46:47]
  v_cvt_pk_bf16_f32 v150, v36, v37
  v_cvt_pk_bf16_f32 v151, v38, v39
  s_add_u32 s43, s41, 37751040
  buffer_store_dwordx2 v[150:151], v169, s[4:7], s43 offen sc1
  v_pk_mul_f32 v[40:41], v[40:41], s[46:47]
  v_pk_mul_f32 v[42:43], v[42:43], s[46:47]
  v_cvt_pk_bf16_f32 v136, v40, v41
  v_cvt_pk_bf16_f32 v137, v42, v43
  s_add_u32 s43, s41, 37748736
  buffer_store_dwordx2 v[136:137], v170, s[4:7], s43 offen sc1
  v_pk_mul_f32 v[44:45], v[44:45], s[46:47]
  v_pk_mul_f32 v[46:47], v[46:47], s[46:47]
  v_cvt_pk_bf16_f32 v138, v44, v45
  v_cvt_pk_bf16_f32 v139, v46, v47
  s_add_u32 s43, s41, 37748992
  buffer_store_dwordx2 v[138:139], v170, s[4:7], s43 offen sc1
  v_pk_mul_f32 v[48:49], v[48:49], s[46:47]
  v_pk_mul_f32 v[50:51], v[50:51], s[46:47]
  v_cvt_pk_bf16_f32 v140, v48, v49
  v_cvt_pk_bf16_f32 v141, v50, v51
  s_add_u32 s43, s41, 37750784
  buffer_store_dwordx2 v[140:141], v170, s[4:7], s43 offen sc1
  v_pk_mul_f32 v[52:53], v[52:53], s[46:47]
  v_pk_mul_f32 v[54:55], v[54:55], s[46:47]
  v_cvt_pk_bf16_f32 v142, v52, v53
  v_cvt_pk_bf16_f32 v143, v54, v55
  s_add_u32 s43, s41, 37751040
  buffer_store_dwordx2 v[142:143], v170, s[4:7], s43 offen sc1
  v_pk_mul_f32 v[56:57], v[56:57], s[46:47]
  v_pk_mul_f32 v[58:59], v[58:59], s[46:47]
  v_cvt_pk_bf16_f32 v144, v56, v57
  v_cvt_pk_bf16_f32 v145, v58, v59
  s_add_u32 s43, s41, 37748736
  buffer_store_dwordx2 v[144:145], v171, s[4:7], s43 offen sc1
  v_pk_mul_f32 v[60:61], v[60:61], s[46:47]
  v_pk_mul_f32 v[62:63], v[62:63], s[46:47]
  v_cvt_pk_bf16_f32 v146, v60, v61
  v_cvt_pk_bf16_f32 v147, v62, v63
  s_add_u32 s43, s41, 37748992
  buffer_store_dwordx2 v[146:147], v171, s[4:7], s43 offen sc1
  v_pk_mul_f32 v[64:65], v[64:65], s[46:47]
  v_pk_mul_f32 v[66:67], v[66:67], s[46:47]
  v_cvt_pk_bf16_f32 v148, v64, v65
  v_cvt_pk_bf16_f32 v149, v66, v67
  s_add_u32 s43, s41, 37750784
  buffer_store_dwordx2 v[148:149], v171, s[4:7], s43 offen sc1
  v_pk_mul_f32 v[68:69], v[68:69], s[46:47]
  v_pk_mul_f32 v[70:71], v[70:71], s[46:47]
  v_cvt_pk_bf16_f32 v150, v68, v69
  v_cvt_pk_bf16_f32 v151, v70, v71
  s_add_u32 s43, s41, 37751040
  buffer_store_dwordx2 v[150:151], v171, s[4:7], s43 offen sc1
  s_branch qkvb_exit1
qkvb_w1_3:
  s_mul_i32 s30, s17, 5
  s_add_u32 s30, s30, 4
  s_mul_i32 s30, s30, 20480
  s_add_u32 s30, s30, 87556096
  s_mul_i32 s31, s17, 5
  s_add_u32 s31, s31, 40
  s_mul_i32 s31, s31, 20480
  s_add_u32 s31, s31, 87556096
  s_mul_i32 s32, s17, 5
  s_add_u32 s32, s32, 41
  s_mul_i32 s32, s32, 20480
  s_add_u32 s32, s32, 87556096
  s_mul_i32 s33, s17, 5
  s_add_u32 s33, s33, 42
  s_mul_i32 s33, s33, 20480
  s_add_u32 s33, s33, 87556096
  buffer_load_dwordx4 v[72:75], v1, s[4:7], s30 offen offset:0
  buffer_load_dwordx4 v[76:79], v1, s[4:7], s31 offen offset:0
  buffer_load_dwordx4 v[80:83], v1, s[4:7], s32 offen offset:0
  buffer_load_dwordx4 v[84:87], v1, s[4:7], s33 offen offset:0
  buffer_load_dwordx4 v[88:91], v1, s[4:7], s30 offen offset:1024
  buffer_load_dwordx4 v[92:95], v1, s[4:7], s31 offen offset:1024
  buffer_load_dwordx4 v[96:99], v1, s[4:7], s32 offen offset:1024
  buffer_load_dwordx4 v[100:103], v1, s[4:7], s33 offen offset:1024
  buffer_load_dwordx4 v[104:107], v1, s[4:7], s30 offen offset:2048
  buffer_load_dwordx4 v[108:111], v1, s[4:7], s31 offen offset:2048
  buffer_load_dwordx4 v[112:115], v1, s[4:7], s32 offen offset:2048
  buffer_load_dwordx4 v[116:119], v1, s[4:7], s33 offen offset:2048
  s_add_u32 m0, s22, 4096
  s_add_u32 s23, s21, 4096
  buffer_load_dwordx4 v1, s[4:7], s23 offen offset:0 lds
  buffer_load_dwordx4 v1, s[4:7], s23 offen offset:1024 lds
  buffer_load_dwordx4 v1, s[4:7], s23 offen offset:2048 lds
  buffer_load_dwordx4 v1, s[4:7], s23 offen offset:3072 lds
  s_add_u32 m0, s22, 8192
  s_add_u32 s23, s21, 8192
  buffer_load_dwordx4 v1, s[4:7], s23 offen offset:0 lds
  buffer_load_dwordx4 v1, s[4:7], s23 offen offset:1024 lds
  buffer_load_dwordx4 v1, s[4:7], s23 offen offset:2048 lds
  buffer_load_dwordx4 v1, s[4:7], s23 offen offset:3072 lds
  s_add_u32 m0, s22, 12288
  s_add_u32 s23, s21, 12288
  buffer_load_dwordx4 v1, s[4:7], s23 offen offset:0 lds
  buffer_load_dwordx4 v1, s[4:7], s23 offen offset:1024 lds
  buffer_load_dwordx4 v1, s[4:7], s23 offen offset:2048 lds
  buffer_load_dwordx4 v1, s[4:7], s23 offen offset:3072 lds
  s_add_u32 m0, s22, 16384
  s_add_u32 s23, s21, 16384
  buffer_load_dwordx4 v1, s[4:7], s23 offen offset:0 lds
  buffer_load_dwordx4 v1, s[4:7], s23 offen offset:1024 lds
  buffer_load_dwordx4 v1, s[4:7], s23 offen offset:2048 lds
  buffer_load_dwordx4 v1, s[4:7], s23 offen offset:3072 lds
  s_waitcnt vmcnt(28)
  s_barrier
  ds_read_b128 v[136:139], v6 offset:0
  ds_read_b128 v[140:143], v6 offset:20480
  ds_read_b128 v[144:147], v7 offset:0
  ds_read_b128 v[148:151], v7 offset:20480
  buffer_load_dwordx4 v[120:123], v1, s[4:7], s30 offen offset:3072
  buffer_load_dwordx4 v[124:127], v1, s[4:7], s31 offen offset:3072
  buffer_load_dwordx4 v[128:131], v1, s[4:7], s32 offen offset:3072
  buffer_load_dwordx4 v[132:135], v1, s[4:7], s33 offen offset:3072
  s_waitcnt vmcnt(28)
  ds_read_b128 v[152:155], v6 offset:1024
  ds_read_b128 v[156:159], v6 offset:21504
  ds_read_b128 v[160:163], v7 offset:1024
  ds_read_b128 v[164:167], v7 offset:21504
  s_waitcnt lgkmcnt(4)
  v_mfma_f32_16x16x32_bf16 v[8:11], v[72:75], v[136:139], 0
  v_mfma_f32_16x16x32_bf16 v[12:15], v[72:75], v[140:143], 0
  v_mfma_f32_16x16x32_bf16 v[16:19], v[72:75], v[144:147], 0
  v_mfma_f32_16x16x32_bf16 v[20:23], v[72:75], v[148:151], 0
  v_mfma_f32_16x16x32_bf16 v[24:27], v[76:79], v[136:139], 0
  v_mfma_f32_16x16x32_bf16 v[28:31], v[76:79], v[140:143], 0
  v_mfma_f32_16x16x32_bf16 v[32:35], v[76:79], v[144:147], 0
  v_mfma_f32_16x16x32_bf16 v[36:39], v[76:79], v[148:151], 0
  v_mfma_f32_16x16x32_bf16 v[40:43], v[80:83], v[136:139], 0
  v_mfma_f32_16x16x32_bf16 v[44:47], v[80:83], v[140:143], 0
  v_mfma_f32_16x16x32_bf16 v[48:51], v[80:83], v[144:147], 0
  v_mfma_f32_16x16x32_bf16 v[52:55], v[80:83], v[148:151], 0
  v_mfma_f32_16x16x32_bf16 v[56:59], v[84:87], v[136:139], 0
  v_mfma_f32_16x16x32_bf16 v[60:63], v[84:87], v[140:143], 0
  v_mfma_f32_16x16x32_bf16 v[64:67], v[84:87], v[144:147], 0
  v_mfma_f32_16x16x32_bf16 v[68:71], v[84:87], v[148:151], 0
  s_add_u32 s30, s30, 4096
  s_add_u32 s31, s31, 4096
  s_add_u32 s32, s32, 4096
  s_add_u32 s33, s33, 4096
  buffer_load_dwordx4 v[72:75], v1, s[4:7], s30 offen offset:0
  buffer_load_dwordx4 v[76:79], v1, s[4:7], s31 offen offset:0
  buffer_load_dwordx4 v[80:83], v1, s[4:7], s32 offen offset:0
  buffer_load_dwordx4 v[84:87], v1, s[4:7], s33 offen offset:0
  s_waitcnt vmcnt(28)
  ds_read_b128 v[136:139], v6 offset:2048
  ds_read_b128 v[140:143], v6 offset:22528
  ds_read_b128 v[144:147], v7 offset:2048
  ds_read_b128 v[148:151], v7 offset:22528
  s_waitcnt lgkmcnt(4)
  v_mfma_f32_16x16x32_bf16 v[8:11], v[88:91], v[152:155], v[8:11]
  v_mfma_f32_16x16x32_bf16 v[12:15], v[88:91], v[156:159], v[12:15]
  v_mfma_f32_16x16x32_bf16 v[16:19], v[88:91], v[160:163], v[16:19]
  v_mfma_f32_16x16x32_bf16 v[20:23], v[88:91], v[164:167], v[20:23]
  v_mfma_f32_16x16x32_bf16 v[24:27], v[92:95], v[152:155], v[24:27]
  v_mfma_f32_16x16x32_bf16 v[28:31], v[92:95], v[156:159], v[28:31]
  v_mfma_f32_16x16x32_bf16 v[32:35], v[92:95], v[160:163], v[32:35]
  v_mfma_f32_16x16x32_bf16 v[36:39], v[92:95], v[164:167], v[36:39]
  v_mfma_f32_16x16x32_bf16 v[40:43], v[96:99], v[152:155], v[40:43]
  v_mfma_f32_16x16x32_bf16 v[44:47], v[96:99], v[156:159], v[44:47]
  v_mfma_f32_16x16x32_bf16 v[48:51], v[96:99], v[160:163], v[48:51]
  v_mfma_f32_16x16x32_bf16 v[52:55], v[96:99], v[164:167], v[52:55]
  v_mfma_f32_16x16x32_bf16 v[56:59], v[100:103], v[152:155], v[56:59]
  v_mfma_f32_16x16x32_bf16 v[60:63], v[100:103], v[156:159], v[60:63]
  v_mfma_f32_16x16x32_bf16 v[64:67], v[100:103], v[160:163], v[64:67]
  v_mfma_f32_16x16x32_bf16 v[68:71], v[100:103], v[164:167], v[68:71]
  buffer_load_dwordx4 v[88:91], v1, s[4:7], s30 offen offset:1024
  buffer_load_dwordx4 v[92:95], v1, s[4:7], s31 offen offset:1024
  buffer_load_dwordx4 v[96:99], v1, s[4:7], s32 offen offset:1024
  buffer_load_dwordx4 v[100:103], v1, s[4:7], s33 offen offset:1024
  s_waitcnt vmcnt(28)
  ds_read_b128 v[152:155], v6 offset:3072
  ds_read_b128 v[156:159], v6 offset:23552
  ds_read_b128 v[160:163], v7 offset:3072
  ds_read_b128 v[164:167], v7 offset:23552
  s_waitcnt lgkmcnt(4)
  v_mfma_f32_16x16x32_bf16 v[8:11], v[104:107], v[136:139], v[8:11]
  v_mfma_f32_16x16x32_bf16 v[12:15], v[104:107], v[140:143], v[12:15]
  v_mfma_f32_16x16x32_bf16 v[16:19], v[104:107], v[144:147], v[16:19]
  v_mfma_f32_16x16x32_bf16 v[20:23], v[104:107], v[148:151], v[20:23]
  v_mfma_f32_16x16x32_bf16 v[24:27], v[108:111], v[136:139], v[24:27]
  v_mfma_f32_16x16x32_bf16 v[28:31], v[108:111], v[140:143], v[28:31]
  v_mfma_f32_16x16x32_bf16 v[32:35], v[108:111], v[144:147], v[32:35]
  v_mfma_f32_16x16x32_bf16 v[36:39], v[108:111], v[148:151], v[36:39]
  v_mfma_f32_16x16x32_bf16 v[40:43], v[112:115], v[136:139], v[40:43]
  v_mfma_f32_16x16x32_bf16 v[44:47], v[112:115], v[140:143], v[44:47]
  v_mfma_f32_16x16x32_bf16 v[48:51], v[112:115], v[144:147], v[48:51]
  v_mfma_f32_16x16x32_bf16 v[52:55], v[112:115], v[148:151], v[52:55]
  v_mfma_f32_16x16x32_bf16 v[56:59], v[116:119], v[136:139], v[56:59]
  v_mfma_f32_16x16x32_bf16 v[60:63], v[116:119], v[140:143], v[60:63]
  v_mfma_f32_16x16x32_bf16 v[64:67], v[116:119], v[144:147], v[64:67]
  v_mfma_f32_16x16x32_bf16 v[68:71], v[116:119], v[148:151], v[68:71]
  buffer_load_dwordx4 v[104:107], v1, s[4:7], s30 offen offset:2048
  buffer_load_dwordx4 v[108:111], v1, s[4:7], s31 offen offset:2048
  buffer_load_dwordx4 v[112:115], v1, s[4:7], s32 offen offset:2048
  buffer_load_dwordx4 v[116:119], v1, s[4:7], s33 offen offset:2048
  s_waitcnt vmcnt(12)
  s_barrier
  ds_read_b128 v[136:139], v6 offset:4096
  ds_read_b128 v[140:143], v6 offset:24576
  ds_read_b128 v[144:147], v7 offset:4096
  ds_read_b128 v[148:151], v7 offset:24576
  s_waitcnt lgkmcnt(4)
  v_mfma_f32_16x16x32_bf16 v[8:11], v[120:123], v[152:155], v[8:11]
  v_mfma_f32_16x16x32_bf16 v[12:15], v[120:123], v[156:159], v[12:15]
  v_mfma_f32_16x16x32_bf16 v[16:19], v[120:123], v[160:163], v[16:19]
  v_mfma_f32_16x16x32_bf16 v[20:23], v[120:123], v[164:167], v[20:23]
  v_mfma_f32_16x16x32_bf16 v[24:27], v[124:127], v[152:155], v[24:27]
  v_mfma_f32_16x16x32_bf16 v[28:31], v[124:127], v[156:159], v[28:31]
  v_mfma_f32_16x16x32_bf16 v[32:35], v[124:127], v[160:163], v[32:35]
  v_mfma_f32_16x16x32_bf16 v[36:39], v[124:127], v[164:167], v[36:39]
  v_mfma_f32_16x16x32_bf16 v[40:43], v[128:131], v[152:155], v[40:43]
  v_mfma_f32_16x16x32_bf16 v[44:47], v[128:131], v[156:159], v[44:47]
  v_mfma_f32_16x16x32_bf16 v[48:51], v[128:131], v[160:163], v[48:51]
  v_mfma_f32_16x16x32_bf16 v[52:55], v[128:131], v[164:167], v[52:55]
  v_mfma_f32_16x16x32_bf16 v[56:59], v[132:135], v[152:155], v[56:59]
  v_mfma_f32_16x16x32_bf16 v[60:63], v[132:135], v[156:159], v[60:63]
  v_mfma_f32_16x16x32_bf16 v[64:67], v[132:135], v[160:163], v[64:67]
  v_mfma_f32_16x16x32_bf16 v[68:71], v[132:135], v[164:167], v[68:71]
  s_mov_b32 s40, 0
  v_add_u32 v6, 4096, v6
  v_add_u32 v7, 4096, v7
qkvb_loop7:
  buffer_load_dwordx4 v[120:123], v1, s[4:7], s30 offen offset:3072
  buffer_load_dwordx4 v[124:127], v1, s[4:7], s31 offen offset:3072
  buffer_load_dwordx4 v[128:131], v1, s[4:7], s32 offen offset:3072
  buffer_load_dwordx4 v[132:135], v1, s[4:7], s33 offen offset:3072
  s_waitcnt vmcnt(12)
  ds_read_b128 v[152:155], v6 offset:1024
  ds_read_b128 v[156:159], v6 offset:21504
  ds_read_b128 v[160:163], v7 offset:1024
  ds_read_b128 v[164:167], v7 offset:21504
  s_waitcnt lgkmcnt(4)
  v_mfma_f32_16x16x32_bf16 v[8:11], v[72:75], v[136:139], v[8:11]
  v_mfma_f32_16x16x32_bf16 v[12:15], v[72:75], v[140:143], v[12:15]
  v_mfma_f32_16x16x32_bf16 v[16:19], v[72:75], v[144:147], v[16:19]
  v_mfma_f32_16x16x32_bf16 v[20:23], v[72:75], v[148:151], v[20:23]
  v_mfma_f32_16x16x32_bf16 v[24:27], v[76:79], v[136:139], v[24:27]
  v_mfma_f32_16x16x32_bf16 v[28:31], v[76:79], v[140:143], v[28:31]
  v_mfma_f32_16x16x32_bf16 v[32:35], v[76:79], v[144:147], v[32:35]
  v_mfma_f32_16x16x32_bf16 v[36:39], v[76:79], v[148:151], v[36:39]
  v_mfma_f32_16x16x32_bf16 v[40:43], v[80:83], v[136:139], v[40:43]
  v_mfma_f32_16x16x32_bf16 v[44:47], v[80:83], v[140:143], v[44:47]
  v_mfma_f32_16x16x32_bf16 v[48:51], v[80:83], v[144:147], v[48:51]
  v_mfma_f32_16x16x32_bf16 v[52:55], v[80:83], v[148:151], v[52:55]
  v_mfma_f32_16x16x32_bf16 v[56:59], v[84:87], v[136:139], v[56:59]
  v_mfma_f32_16x16x32_bf16 v[60:63], v[84:87], v[140:143], v[60:63]
  v_mfma_f32_16x16x32_bf16 v[64:67], v[84:87], v[144:147], v[64:67]
  v_mfma_f32_16x16x32_bf16 v[68:71], v[84:87], v[148:151], v[68:71]
  s_add_u32 s30, s30, 4096
  s_add_u32 s31, s31, 4096
  s_add_u32 s32, s32, 4096
  s_add_u32 s33, s33, 4096
  buffer_load_dwordx4 v[72:75], v1, s[4:7], s30 offen offset:0
  buffer_load_dwordx4 v[76:79], v1, s[4:7], s31 offen offset:0
  buffer_load_dwordx4 v[80:83], v1, s[4:7], s32 offen offset:0
  buffer_load_dwordx4 v[84:87], v1, s[4:7], s33 offen offset:0
  s_waitcnt vmcnt(12)
  ds_read_b128 v[136:139], v6 offset:2048
  ds_read_b128 v[140:143], v6 offset:22528
  ds_read_b128 v[144:147], v7 offset:2048
  ds_read_b128 v[148:151], v7 offset:22528
  s_waitcnt lgkmcnt(4)
  v_mfma_f32_16x16x32_bf16 v[8:11], v[88:91], v[152:155], v[8:11]
  v_mfma_f32_16x16x32_bf16 v[12:15], v[88:91], v[156:159], v[12:15]
  v_mfma_f32_16x16x32_bf16 v[16:19], v[88:91], v[160:163], v[16:19]
  v_mfma_f32_16x16x32_bf16 v[20:23], v[88:91], v[164:167], v[20:23]
  v_mfma_f32_16x16x32_bf16 v[24:27], v[92:95], v[152:155], v[24:27]
  v_mfma_f32_16x16x32_bf16 v[28:31], v[92:95], v[156:159], v[28:31]
  v_mfma_f32_16x16x32_bf16 v[32:35], v[92:95], v[160:163], v[32:35]
  v_mfma_f32_16x16x32_bf16 v[36:39], v[92:95], v[164:167], v[36:39]
  v_mfma_f32_16x16x32_bf16 v[40:43], v[96:99], v[152:155], v[40:43]
  v_mfma_f32_16x16x32_bf16 v[44:47], v[96:99], v[156:159], v[44:47]
  v_mfma_f32_16x16x32_bf16 v[48:51], v[96:99], v[160:163], v[48:51]
  v_mfma_f32_16x16x32_bf16 v[52:55], v[96:99], v[164:167], v[52:55]
  v_mfma_f32_16x16x32_bf16 v[56:59], v[100:103], v[152:155], v[56:59]
  v_mfma_f32_16x16x32_bf16 v[60:63], v[100:103], v[156:159], v[60:63]
  v_mfma_f32_16x16x32_bf16 v[64:67], v[100:103], v[160:163], v[64:67]
  v_mfma_f32_16x16x32_bf16 v[68:71], v[100:103], v[164:167], v[68:71]
  buffer_load_dwordx4 v[88:91], v1, s[4:7], s30 offen offset:1024
  buffer_load_dwordx4 v[92:95], v1, s[4:7], s31 offen offset:1024
  buffer_load_dwordx4 v[96:99], v1, s[4:7], s32 offen offset:1024
  buffer_load_dwordx4 v[100:103], v1, s[4:7], s33 offen offset:1024
  s_waitcnt vmcnt(12)
  ds_read_b128 v[152:155], v6 offset:3072
  ds_read_b128 v[156:159], v6 offset:23552
  ds_read_b128 v[160:163], v7 offset:3072
  ds_read_b128 v[164:167], v7 offset:23552
  s_waitcnt lgkmcnt(4)
  v_mfma_f32_16x16x32_bf16 v[8:11], v[104:107], v[136:139], v[8:11]
  v_mfma_f32_16x16x32_bf16 v[12:15], v[104:107], v[140:143], v[12:15]
  v_mfma_f32_16x16x32_bf16 v[16:19], v[104:107], v[144:147], v[16:19]
  v_mfma_f32_16x16x32_bf16 v[20:23], v[104:107], v[148:151], v[20:23]
  v_mfma_f32_16x16x32_bf16 v[24:27], v[108:111], v[136:139], v[24:27]
  v_mfma_f32_16x16x32_bf16 v[28:31], v[108:111], v[140:143], v[28:31]
  v_mfma_f32_16x16x32_bf16 v[32:35], v[108:111], v[144:147], v[32:35]
  v_mfma_f32_16x16x32_bf16 v[36:39], v[108:111], v[148:151], v[36:39]
  v_mfma_f32_16x16x32_bf16 v[40:43], v[112:115], v[136:139], v[40:43]
  v_mfma_f32_16x16x32_bf16 v[44:47], v[112:115], v[140:143], v[44:47]
  v_mfma_f32_16x16x32_bf16 v[48:51], v[112:115], v[144:147], v[48:51]
  v_mfma_f32_16x16x32_bf16 v[52:55], v[112:115], v[148:151], v[52:55]
  v_mfma_f32_16x16x32_bf16 v[56:59], v[116:119], v[136:139], v[56:59]
  v_mfma_f32_16x16x32_bf16 v[60:63], v[116:119], v[140:143], v[60:63]
  v_mfma_f32_16x16x32_bf16 v[64:67], v[116:119], v[144:147], v[64:67]
  v_mfma_f32_16x16x32_bf16 v[68:71], v[116:119], v[148:151], v[68:71]
  buffer_load_dwordx4 v[104:107], v1, s[4:7], s30 offen offset:2048
  buffer_load_dwordx4 v[108:111], v1, s[4:7], s31 offen offset:2048
  buffer_load_dwordx4 v[112:115], v1, s[4:7], s32 offen offset:2048
  buffer_load_dwordx4 v[116:119], v1, s[4:7], s33 offen offset:2048
  s_waitcnt vmcnt(12)
  ds_read_b128 v[136:139], v6 offset:4096
  ds_read_b128 v[140:143], v6 offset:24576
  ds_read_b128 v[144:147], v7 offset:4096
  ds_read_b128 v[148:151], v7 offset:24576
  s_waitcnt lgkmcnt(4)
  v_mfma_f32_16x16x32_bf16 v[8:11], v[120:123], v[152:155], v[8:11]
  v_mfma_f32_16x16x32_bf16 v[12:15], v[120:123], v[156:159], v[12:15]
  v_mfma_f32_16x16x32_bf16 v[16:19], v[120:123], v[160:163], v[16:19]
  v_mfma_f32_16x16x32_bf16 v[20:23], v[120:123], v[164:167], v[20:23]
  v_mfma_f32_16x16x32_bf16 v[24:27], v[124:127], v[152:155], v[24:27]
  v_mfma_f32_16x16x32_bf16 v[28:31], v[124:127], v[156:159], v[28:31]
  v_mfma_f32_16x16x32_bf16 v[32:35], v[124:127], v[160:163], v[32:35]
  v_mfma_f32_16x16x32_bf16 v[36:39], v[124:127], v[164:167], v[36:39]
  v_mfma_f32_16x16x32_bf16 v[40:43], v[128:131], v[152:155], v[40:43]
  v_mfma_f32_16x16x32_bf16 v[44:47], v[128:131], v[156:159], v[44:47]
  v_mfma_f32_16x16x32_bf16 v[48:51], v[128:131], v[160:163], v[48:51]
  v_mfma_f32_16x16x32_bf16 v[52:55], v[128:131], v[164:167], v[52:55]
  v_mfma_f32_16x16x32_bf16 v[56:59], v[132:135], v[152:155], v[56:59]
  v_mfma_f32_16x16x32_bf16 v[60:63], v[132:135], v[156:159], v[60:63]
  v_mfma_f32_16x16x32_bf16 v[64:67], v[132:135], v[160:163], v[64:67]
  v_mfma_f32_16x16x32_bf16 v[68:71], v[132:135], v[164:167], v[68:71]
  v_add_u32 v6, 4096, v6
  v_add_u32 v7, 4096, v7
  s_add_u32 s40, s40, 1
  s_cmp_lt_u32 s40, 4
  s_cbranch_scc1 qkvb_loop7
  s_waitcnt vmcnt(0) lgkmcnt(0)
  v_and_b32 v2, 63, v0
  v_and_b32 v3, 15, v2
  v_lshrrev_b32 v4, 4, v2
  s_lshl_b32 s41, s17, 19
  s_lshl_b32 s42, s18, 12
  s_add_u32 s41, s41, s42
  s_mov_b32 s46, 0x3ea52b5c
  s_mov_b32 s47, 0x3ea52b5c
  v_lshlrev_b32 v5, 2, v4
  v_add_u32 v5, 64, v5
  v_mul_u32_u24 v168, 205, v5
  v_lshrrev_b32 v168, 12, v168
  v_mul_u32_u24 v6, 20, v168
  v_sub_u32 v5, v5, v6
  v_lshlrev_b32 v168, 17, v168
  v_lshrrev_b32 v6, 4, v5
  v_lshl_add_u32 v168, v6, 10, v168
  v_bfe_u32 v6, v5, 2, 1
  v_lshl_add_u32 v168, v6, 9, v168
  v_bfe_u32 v6, v5, 3, 1
  v_lshl_add_u32 v168, v6, 3, v168
  v_lshl_add_u32 v168, v3, 4, v168
  v_lshlrev_b32 v5, 2, v4
  v_add_u32 v5, 0, v5
  v_mul_u32_u24 v169, 205, v5
  v_lshrrev_b32 v169, 12, v169
  v_mul_u32_u24 v6, 20, v169
  v_sub_u32 v5, v5, v6
  v_lshlrev_b32 v169, 17, v169
  v_lshrrev_b32 v6, 4, v5
  v_lshl_add_u32 v169, v6, 10, v169
  v_bfe_u32 v6, v5, 2, 1
  v_lshl_add_u32 v169, v6, 9, v169
  v_bfe_u32 v6, v5, 3, 1
  v_lshl_add_u32 v169, v6, 3, v169
  v_lshl_add_u32 v169, v3, 4, v169
  v_lshlrev_b32 v5, 2, v4
  v_add_u32 v5, 16, v5
  v_mul_u32_u24 v170, 205, v5
  v_lshrrev_b32 v170, 12, v170
  v_mul_u32_u24 v6, 20, v170
  v_sub_u32 v5, v5, v6
  v_lshlrev_b32 v170, 17, v170
  v_lshrrev_b32 v6, 4, v5
  v_lshl_add_u32 v170, v6, 10, v170
  v_bfe_u32 v6, v5, 2, 1
  v_lshl_add_u32 v170, v6, 9, v170
  v_bfe_u32 v6, v5, 3, 1
  v_lshl_add_u32 v170, v6, 3, v170
  v_lshl_add_u32 v170, v3, 4, v170
  v_lshlrev_b32 v5, 2, v4
  v_add_u32 v5, 32, v5
  v_mul_u32_u24 v171, 205, v5
  v_lshrrev_b32 v171, 12, v171
  v_mul_u32_u24 v6, 20, v171
  v_sub_u32 v5, v5, v6
  v_lshlrev_b32 v171, 17, v171
  v_lshrrev_b32 v6, 4, v5
  v_lshl_add_u32 v171, v6, 10, v171
  v_bfe_u32 v6, v5, 2, 1
  v_lshl_add_u32 v171, v6, 9, v171
  v_bfe_u32 v6, v5, 3, 1
  v_lshl_add_u32 v171, v6, 3, v171
  v_lshl_add_u32 v171, v3, 4, v171
  v_pk_mul_f32 v[8:9], v[8:9], s[46:47]
  v_pk_mul_f32 v[10:11], v[10:11], s[46:47]
  v_cvt_pk_bf16_f32 v136, v8, v9
  v_cvt_pk_bf16_f32 v137, v10, v11
  s_add_u32 s43, s41, 37748736
  buffer_store_dwordx2 v[136:137], v168, s[4:7], s43 offen sc1
  v_pk_mul_f32 v[12:13], v[12:13], s[46:47]
  v_pk_mul_f32 v[14:15], v[14:15], s[46:47]
  v_cvt_pk_bf16_f32 v138, v12, v13
  v_cvt_pk_bf16_f32 v139, v14, v15
  s_add_u32 s43, s41, 37748992
  buffer_store_dwordx2 v[138:139], v168, s[4:7], s43 offen sc1
  v_pk_mul_f32 v[16:17], v[16:17], s[46:47]
  v_pk_mul_f32 v[18:19], v[18:19], s[46:47]
  v_cvt_pk_bf16_f32 v140, v16, v17
  v_cvt_pk_bf16_f32 v141, v18, v19
  s_add_u32 s43, s41, 37750784
  buffer_store_dwordx2 v[140:141], v168, s[4:7], s43 offen sc1
  v_pk_mul_f32 v[20:21], v[20:21], s[46:47]
  v_pk_mul_f32 v[22:23], v[22:23], s[46:47]
  v_cvt_pk_bf16_f32 v142, v20, v21
  v_cvt_pk_bf16_f32 v143, v22, v23
  s_add_u32 s43, s41, 37751040
  buffer_store_dwordx2 v[142:143], v168, s[4:7], s43 offen sc1
  v_cvt_pk_bf16_f32 v144, v24, v25
  v_cvt_pk_bf16_f32 v145, v26, v27
  s_add_u32 s43, s41, 41943040
  buffer_store_dwordx2 v[144:145], v169, s[4:7], s43 offen sc1
  v_cvt_pk_bf16_f32 v146, v28, v29
  v_cvt_pk_bf16_f32 v147, v30, v31
  s_add_u32 s43, s41, 41943296
  buffer_store_dwordx2 v[146:147], v169, s[4:7], s43 offen sc1
  v_cvt_pk_bf16_f32 v148, v32, v33
  v_cvt_pk_bf16_f32 v149, v34, v35
  s_add_u32 s43, s41, 41945088
  buffer_store_dwordx2 v[148:149], v169, s[4:7], s43 offen sc1
  v_cvt_pk_bf16_f32 v150, v36, v37
  v_cvt_pk_bf16_f32 v151, v38, v39
  s_add_u32 s43, s41, 41945344
  buffer_store_dwordx2 v[150:151], v169, s[4:7], s43 offen sc1
  v_cvt_pk_bf16_f32 v136, v40, v41
  v_cvt_pk_bf16_f32 v137, v42, v43
  s_add_u32 s43, s41, 41943040
  buffer_store_dwordx2 v[136:137], v170, s[4:7], s43 offen sc1
  v_cvt_pk_bf16_f32 v138, v44, v45
  v_cvt_pk_bf16_f32 v139, v46, v47
  s_add_u32 s43, s41, 41943296
  buffer_store_dwordx2 v[138:139], v170, s[4:7], s43 offen sc1
  v_cvt_pk_bf16_f32 v140, v48, v49
  v_cvt_pk_bf16_f32 v141, v50, v51
  s_add_u32 s43, s41, 41945088
  buffer_store_dwordx2 v[140:141], v170, s[4:7], s43 offen sc1
  v_cvt_pk_bf16_f32 v142, v52, v53
  v_cvt_pk_bf16_f32 v143, v54, v55
  s_add_u32 s43, s41, 41945344
  buffer_store_dwordx2 v[142:143], v170, s[4:7], s43 offen sc1
  v_cvt_pk_bf16_f32 v144, v56, v57
  v_cvt_pk_bf16_f32 v145, v58, v59
  s_add_u32 s43, s41, 41943040
  buffer_store_dwordx2 v[144:145], v171, s[4:7], s43 offen sc1
  v_cvt_pk_bf16_f32 v146, v60, v61
  v_cvt_pk_bf16_f32 v147, v62, v63
  s_add_u32 s43, s41, 41943296
  buffer_store_dwordx2 v[146:147], v171, s[4:7], s43 offen sc1
  v_cvt_pk_bf16_f32 v148, v64, v65
  v_cvt_pk_bf16_f32 v149, v66, v67
  s_add_u32 s43, s41, 41945088
  buffer_store_dwordx2 v[148:149], v171, s[4:7], s43 offen sc1
  v_cvt_pk_bf16_f32 v150, v68, v69
  v_cvt_pk_bf16_f32 v151, v70, v71
  s_add_u32 s43, s41, 41945344
  buffer_store_dwordx2 v[150:151], v171, s[4:7], s43 offen sc1
  s_branch qkvb_exit1
qkvb_w2_4:
  s_mul_i32 s30, s17, 5
  s_add_u32 s30, s30, 43
  s_mul_i32 s30, s30, 20480
  s_add_u32 s30, s30, 87556096
  s_mul_i32 s31, s17, 5
  s_add_u32 s31, s31, 44
  s_mul_i32 s31, s31, 20480
  s_add_u32 s31, s31, 87556096
  s_mul_i32 s32, s17, 5
  s_add_u32 s32, s32, 80
  s_mul_i32 s32, s32, 20480
  s_add_u32 s32, s32, 87556096
  s_mul_i32 s33, s17, 5
  s_add_u32 s33, s33, 81
  s_mul_i32 s33, s33, 20480
  s_add_u32 s33, s33, 87556096
  buffer_load_dwordx4 v[72:75], v1, s[4:7], s30 offen offset:0
  buffer_load_dwordx4 v[76:79], v1, s[4:7], s31 offen offset:0
  buffer_load_dwordx4 v[80:83], v1, s[4:7], s32 offen offset:0
  buffer_load_dwordx4 v[84:87], v1, s[4:7], s33 offen offset:0
  buffer_load_dwordx4 v[88:91], v1, s[4:7], s30 offen offset:1024
  buffer_load_dwordx4 v[92:95], v1, s[4:7], s31 offen offset:1024
  buffer_load_dwordx4 v[96:99], v1, s[4:7], s32 offen offset:1024
  buffer_load_dwordx4 v[100:103], v1, s[4:7], s33 offen offset:1024
  buffer_load_dwordx4 v[104:107], v1, s[4:7], s30 offen offset:2048
  buffer_load_dwordx4 v[108:111], v1, s[4:7], s31 offen offset:2048
  buffer_load_dwordx4 v[112:115], v1, s[4:7], s32 offen offset:2048
  buffer_load_dwordx4 v[116:119], v1, s[4:7], s33 offen offset:2048
  s_add_u32 m0, s22, 4096
  s_add_u32 s23, s21, 4096
  buffer_load_dwordx4 v1, s[4:7], s23 offen offset:0 lds
  buffer_load_dwordx4 v1, s[4:7], s23 offen offset:1024 lds
  buffer_load_dwordx4 v1, s[4:7], s23 offen offset:2048 lds
  buffer_load_dwordx4 v1, s[4:7], s23 offen offset:3072 lds
  s_add_u32 m0, s22, 8192
  s_add_u32 s23, s21, 8192
  buffer_load_dwordx4 v1, s[4:7], s23 offen offset:0 lds
  buffer_load_dwordx4 v1, s[4:7], s23 offen offset:1024 lds
  buffer_load_dwordx4 v1, s[4:7], s23 offen offset:2048 lds
  buffer_load_dwordx4 v1, s[4:7], s23 offen offset:3072 lds
  s_add_u32 m0, s22, 12288
  s_add_u32 s23, s21, 12288
  buffer_load_dwordx4 v1, s[4:7], s23 offen offset:0 lds
  buffer_load_dwordx4 v1, s[4:7], s23 offen offset:1024 lds
  buffer_load_dwordx4 v1, s[4:7], s23 offen offset:2048 lds
  buffer_load_dwordx4 v1, s[4:7], s23 offen offset:3072 lds
  s_add_u32 m0, s22, 16384
  s_add_u32 s23, s21, 16384
  buffer_load_dwordx4 v1, s[4:7], s23 offen offset:0 lds
  buffer_load_dwordx4 v1, s[4:7], s23 offen offset:1024 lds
  buffer_load_dwordx4 v1, s[4:7], s23 offen offset:2048 lds
  buffer_load_dwordx4 v1, s[4:7], s23 offen offset:3072 lds
  s_waitcnt vmcnt(28)
  s_barrier
  ds_read_b128 v[136:139], v6 offset:0
  ds_read_b128 v[140:143], v6 offset:20480
  ds_read_b128 v[144:147], v7 offset:0
  ds_read_b128 v[148:151], v7 offset:20480
  buffer_load_dwordx4 v[120:123], v1, s[4:7], s30 offen offset:3072
  buffer_load_dwordx4 v[124:127], v1, s[4:7], s31 offen offset:3072
  buffer_load_dwordx4 v[128:131], v1, s[4:7], s32 offen offset:3072
  buffer_load_dwordx4 v[132:135], v1, s[4:7], s33 offen offset:3072
  s_waitcnt vmcnt(28)
  ds_read_b128 v[152:155], v6 offset:1024
  ds_read_b128 v[156:159], v6 offset:21504
  ds_read_b128 v[160:163], v7 offset:1024
  ds_read_b128 v[164:167], v7 offset:21504
  s_waitcnt lgkmcnt(4)
  v_mfma_f32_16x16x32_bf16 v[8:11], v[72:75], v[136:139], 0
  v_mfma_f32_16x16x32_bf16 v[12:15], v[72:75], v[140:143], 0
  v_mfma_f32_16x16x32_bf16 v[16:19], v[72:75], v[144:147], 0
  v_mfma_f32_16x16x32_bf16 v[20:23], v[72:75], v[148:151], 0
  v_mfma_f32_16x16x32_bf16 v[24:27], v[76:79], v[136:139], 0
  v_mfma_f32_16x16x32_bf16 v[28:31], v[76:79], v[140:143], 0
  v_mfma_f32_16x16x32_bf16 v[32:35], v[76:79], v[144:147], 0
  v_mfma_f32_16x16x32_bf16 v[36:39], v[76:79], v[148:151], 0
  v_mfma_f32_16x16x32_bf16 v[40:43], v[136:139], v[80:83], 0
  v_mfma_f32_16x16x32_bf16 v[44:47], v[140:143], v[80:83], 0
  v_mfma_f32_16x16x32_bf16 v[48:51], v[144:147], v[80:83], 0
  v_mfma_f32_16x16x32_bf16 v[52:55], v[148:151], v[80:83], 0
  v_mfma_f32_16x16x32_bf16 v[56:59], v[136:139], v[84:87], 0
  v_mfma_f32_16x16x32_bf16 v[60:63], v[140:143], v[84:87], 0
  v_mfma_f32_16x16x32_bf16 v[64:67], v[144:147], v[84:87], 0
  v_mfma_f32_16x16x32_bf16 v[68:71], v[148:151], v[84:87], 0
  s_add_u32 s30, s30, 4096
  s_add_u32 s31, s31, 4096
  s_add_u32 s32, s32, 4096
  s_add_u32 s33, s33, 4096
  buffer_load_dwordx4 v[72:75], v1, s[4:7], s30 offen offset:0
  buffer_load_dwordx4 v[76:79], v1, s[4:7], s31 offen offset:0
  buffer_load_dwordx4 v[80:83], v1, s[4:7], s32 offen offset:0
  buffer_load_dwordx4 v[84:87], v1, s[4:7], s33 offen offset:0
  s_waitcnt vmcnt(28)
  ds_read_b128 v[136:139], v6 offset:2048
  ds_read_b128 v[140:143], v6 offset:22528
  ds_read_b128 v[144:147], v7 offset:2048
  ds_read_b128 v[148:151], v7 offset:22528
  s_waitcnt lgkmcnt(4)
  v_mfma_f32_16x16x32_bf16 v[8:11], v[88:91], v[152:155], v[8:11]
  v_mfma_f32_16x16x32_bf16 v[12:15], v[88:91], v[156:159], v[12:15]
  v_mfma_f32_16x16x32_bf16 v[16:19], v[88:91], v[160:163], v[16:19]
  v_mfma_f32_16x16x32_bf16 v[20:23], v[88:91], v[164:167], v[20:23]
  v_mfma_f32_16x16x32_bf16 v[24:27], v[92:95], v[152:155], v[24:27]
  v_mfma_f32_16x16x32_bf16 v[28:31], v[92:95], v[156:159], v[28:31]
  v_mfma_f32_16x16x32_bf16 v[32:35], v[92:95], v[160:163], v[32:35]
  v_mfma_f32_16x16x32_bf16 v[36:39], v[92:95], v[164:167], v[36:39]
  v_mfma_f32_16x16x32_bf16 v[40:43], v[152:155], v[96:99], v[40:43]
  v_mfma_f32_16x16x32_bf16 v[44:47], v[156:159], v[96:99], v[44:47]
  v_mfma_f32_16x16x32_bf16 v[48:51], v[160:163], v[96:99], v[48:51]
  v_mfma_f32_16x16x32_bf16 v[52:55], v[164:167], v[96:99], v[52:55]
  v_mfma_f32_16x16x32_bf16 v[56:59], v[152:155], v[100:103], v[56:59]
  v_mfma_f32_16x16x32_bf16 v[60:63], v[156:159], v[100:103], v[60:63]
  v_mfma_f32_16x16x32_bf16 v[64:67], v[160:163], v[100:103], v[64:67]
  v_mfma_f32_16x16x32_bf16 v[68:71], v[164:167], v[100:103], v[68:71]
  buffer_load_dwordx4 v[88:91], v1, s[4:7], s30 offen offset:1024
  buffer_load_dwordx4 v[92:95], v1, s[4:7], s31 offen offset:1024
  buffer_load_dwordx4 v[96:99], v1, s[4:7], s32 offen offset:1024
  buffer_load_dwordx4 v[100:103], v1, s[4:7], s33 offen offset:1024
  s_waitcnt vmcnt(28)
  ds_read_b128 v[152:155], v6 offset:3072
  ds_read_b128 v[156:159], v6 offset:23552
  ds_read_b128 v[160:163], v7 offset:3072
  ds_read_b128 v[164:167], v7 offset:23552
  s_waitcnt lgkmcnt(4)
  v_mfma_f32_16x16x32_bf16 v[8:11], v[104:107], v[136:139], v[8:11]
  v_mfma_f32_16x16x32_bf16 v[12:15], v[104:107], v[140:143], v[12:15]
  v_mfma_f32_16x16x32_bf16 v[16:19], v[104:107], v[144:147], v[16:19]
  v_mfma_f32_16x16x32_bf16 v[20:23], v[104:107], v[148:151], v[20:23]
  v_mfma_f32_16x16x32_bf16 v[24:27], v[108:111], v[136:139], v[24:27]
  v_mfma_f32_16x16x32_bf16 v[28:31], v[108:111], v[140:143], v[28:31]
  v_mfma_f32_16x16x32_bf16 v[32:35], v[108:111], v[144:147], v[32:35]
  v_mfma_f32_16x16x32_bf16 v[36:39], v[108:111], v[148:151], v[36:39]
  v_mfma_f32_16x16x32_bf16 v[40:43], v[136:139], v[112:115], v[40:43]
  v_mfma_f32_16x16x32_bf16 v[44:47], v[140:143], v[112:115], v[44:47]
  v_mfma_f32_16x16x32_bf16 v[48:51], v[144:147], v[112:115], v[48:51]
  v_mfma_f32_16x16x32_bf16 v[52:55], v[148:151], v[112:115], v[52:55]
  v_mfma_f32_16x16x32_bf16 v[56:59], v[136:139], v[116:119], v[56:59]
  v_mfma_f32_16x16x32_bf16 v[60:63], v[140:143], v[116:119], v[60:63]
  v_mfma_f32_16x16x32_bf16 v[64:67], v[144:147], v[116:119], v[64:67]
  v_mfma_f32_16x16x32_bf16 v[68:71], v[148:151], v[116:119], v[68:71]
  buffer_load_dwordx4 v[104:107], v1, s[4:7], s30 offen offset:2048
  buffer_load_dwordx4 v[108:111], v1, s[4:7], s31 offen offset:2048
  buffer_load_dwordx4 v[112:115], v1, s[4:7], s32 offen offset:2048
  buffer_load_dwordx4 v[116:119], v1, s[4:7], s33 offen offset:2048
  s_waitcnt vmcnt(12)
  s_barrier
  ds_read_b128 v[136:139], v6 offset:4096
  ds_read_b128 v[140:143], v6 offset:24576
  ds_read_b128 v[144:147], v7 offset:4096
  ds_read_b128 v[148:151], v7 offset:24576
  s_waitcnt lgkmcnt(4)
  v_mfma_f32_16x16x32_bf16 v[8:11], v[120:123], v[152:155], v[8:11]
  v_mfma_f32_16x16x32_bf16 v[12:15], v[120:123], v[156:159], v[12:15]
  v_mfma_f32_16x16x32_bf16 v[16:19], v[120:123], v[160:163], v[16:19]
  v_mfma_f32_16x16x32_bf16 v[20:23], v[120:123], v[164:167], v[20:23]
  v_mfma_f32_16x16x32_bf16 v[24:27], v[124:127], v[152:155], v[24:27]
  v_mfma_f32_16x16x32_bf16 v[28:31], v[124:127], v[156:159], v[28:31]
  v_mfma_f32_16x16x32_bf16 v[32:35], v[124:127], v[160:163], v[32:35]
  v_mfma_f32_16x16x32_bf16 v[36:39], v[124:127], v[164:167], v[36:39]
  v_mfma_f32_16x16x32_bf16 v[40:43], v[152:155], v[128:131], v[40:43]
  v_mfma_f32_16x16x32_bf16 v[44:47], v[156:159], v[128:131], v[44:47]
  v_mfma_f32_16x16x32_bf16 v[48:51], v[160:163], v[128:131], v[48:51]
  v_mfma_f32_16x16x32_bf16 v[52:55], v[164:167], v[128:131], v[52:55]
  v_mfma_f32_16x16x32_bf16 v[56:59], v[152:155], v[132:135], v[56:59]
  v_mfma_f32_16x16x32_bf16 v[60:63], v[156:159], v[132:135], v[60:63]
  v_mfma_f32_16x16x32_bf16 v[64:67], v[160:163], v[132:135], v[64:67]
  v_mfma_f32_16x16x32_bf16 v[68:71], v[164:167], v[132:135], v[68:71]
  s_mov_b32 s40, 0
  v_add_u32 v6, 4096, v6
  v_add_u32 v7, 4096, v7
qkvb_loop8:
  buffer_load_dwordx4 v[120:123], v1, s[4:7], s30 offen offset:3072
  buffer_load_dwordx4 v[124:127], v1, s[4:7], s31 offen offset:3072
  buffer_load_dwordx4 v[128:131], v1, s[4:7], s32 offen offset:3072
  buffer_load_dwordx4 v[132:135], v1, s[4:7], s33 offen offset:3072
  s_waitcnt vmcnt(12)
  ds_read_b128 v[152:155], v6 offset:1024
  ds_read_b128 v[156:159], v6 offset:21504
  ds_read_b128 v[160:163], v7 offset:1024
  ds_read_b128 v[164:167], v7 offset:21504
  s_waitcnt lgkmcnt(4)
  v_mfma_f32_16x16x32_bf16 v[8:11], v[72:75], v[136:139], v[8:11]
  v_mfma_f32_16x16x32_bf16 v[12:15], v[72:75], v[140:143], v[12:15]
  v_mfma_f32_16x16x32_bf16 v[16:19], v[72:75], v[144:147], v[16:19]
  v_mfma_f32_16x16x32_bf16 v[20:23], v[72:75], v[148:151], v[20:23]
  v_mfma_f32_16x16x32_bf16 v[24:27], v[76:79], v[136:139], v[24:27]
  v_mfma_f32_16x16x32_bf16 v[28:31], v[76:79], v[140:143], v[28:31]
  v_mfma_f32_16x16x32_bf16 v[32:35], v[76:79], v[144:147], v[32:35]
  v_mfma_f32_16x16x32_bf16 v[36:39], v[76:79], v[148:151], v[36:39]
  v_mfma_f32_16x16x32_bf16 v[40:43], v[136:139], v[80:83], v[40:43]
  v_mfma_f32_16x16x32_bf16 v[44:47], v[140:143], v[80:83], v[44:47]
  v_mfma_f32_16x16x32_bf16 v[48:51], v[144:147], v[80:83], v[48:51]
  v_mfma_f32_16x16x32_bf16 v[52:55], v[148:151], v[80:83], v[52:55]
  v_mfma_f32_16x16x32_bf16 v[56:59], v[136:139], v[84:87], v[56:59]
  v_mfma_f32_16x16x32_bf16 v[60:63], v[140:143], v[84:87], v[60:63]
  v_mfma_f32_16x16x32_bf16 v[64:67], v[144:147], v[84:87], v[64:67]
  v_mfma_f32_16x16x32_bf16 v[68:71], v[148:151], v[84:87], v[68:71]
  s_add_u32 s30, s30, 4096
  s_add_u32 s31, s31, 4096
  s_add_u32 s32, s32, 4096
  s_add_u32 s33, s33, 4096
  buffer_load_dwordx4 v[72:75], v1, s[4:7], s30 offen offset:0
  buffer_load_dwordx4 v[76:79], v1, s[4:7], s31 offen offset:0
  buffer_load_dwordx4 v[80:83], v1, s[4:7], s32 offen offset:0
  buffer_load_dwordx4 v[84:87], v1, s[4:7], s33 offen offset:0
  s_waitcnt vmcnt(12)
  ds_read_b128 v[136:139], v6 offset:2048
  ds_read_b128 v[140:143], v6 offset:22528
  ds_read_b128 v[144:147], v7 offset:2048
  ds_read_b128 v[148:151], v7 offset:22528
  s_waitcnt lgkmcnt(4)
  v_mfma_f32_16x16x32_bf16 v[8:11], v[88:91], v[152:155], v[8:11]
  v_mfma_f32_16x16x32_bf16 v[12:15], v[88:91], v[156:159], v[12:15]
  v_mfma_f32_16x16x32_bf16 v[16:19], v[88:91], v[160:163], v[16:19]
  v_mfma_f32_16x16x32_bf16 v[20:23], v[88:91], v[164:167], v[20:23]
  v_mfma_f32_16x16x32_bf16 v[24:27], v[92:95], v[152:155], v[24:27]
  v_mfma_f32_16x16x32_bf16 v[28:31], v[92:95], v[156:159], v[28:31]
  v_mfma_f32_16x16x32_bf16 v[32:35], v[92:95], v[160:163], v[32:35]
  v_mfma_f32_16x16x32_bf16 v[36:39], v[92:95], v[164:167], v[36:39]
  v_mfma_f32_16x16x32_bf16 v[40:43], v[152:155], v[96:99], v[40:43]
  v_mfma_f32_16x16x32_bf16 v[44:47], v[156:159], v[96:99], v[44:47]
  v_mfma_f32_16x16x32_bf16 v[48:51], v[160:163], v[96:99], v[48:51]
  v_mfma_f32_16x16x32_bf16 v[52:55], v[164:167], v[96:99], v[52:55]
  v_mfma_f32_16x16x32_bf16 v[56:59], v[152:155], v[100:103], v[56:59]
  v_mfma_f32_16x16x32_bf16 v[60:63], v[156:159], v[100:103], v[60:63]
  v_mfma_f32_16x16x32_bf16 v[64:67], v[160:163], v[100:103], v[64:67]
  v_mfma_f32_16x16x32_bf16 v[68:71], v[164:167], v[100:103], v[68:71]
  buffer_load_dwordx4 v[88:91], v1, s[4:7], s30 offen offset:1024
  buffer_load_dwordx4 v[92:95], v1, s[4:7], s31 offen offset:1024
  buffer_load_dwordx4 v[96:99], v1, s[4:7], s32 offen offset:1024
  buffer_load_dwordx4 v[100:103], v1, s[4:7], s33 offen offset:1024
  s_waitcnt vmcnt(12)
  ds_read_b128 v[152:155], v6 offset:3072
  ds_read_b128 v[156:159], v6 offset:23552
  ds_read_b128 v[160:163], v7 offset:3072
  ds_read_b128 v[164:167], v7 offset:23552
  s_waitcnt lgkmcnt(4)
  v_mfma_f32_16x16x32_bf16 v[8:11], v[104:107], v[136:139], v[8:11]
  v_mfma_f32_16x16x32_bf16 v[12:15], v[104:107], v[140:143], v[12:15]
  v_mfma_f32_16x16x32_bf16 v[16:19], v[104:107], v[144:147], v[16:19]
  v_mfma_f32_16x16x32_bf16 v[20:23], v[104:107], v[148:151], v[20:23]
  v_mfma_f32_16x16x32_bf16 v[24:27], v[108:111], v[136:139], v[24:27]
  v_mfma_f32_16x16x32_bf16 v[28:31], v[108:111], v[140:143], v[28:31]
  v_mfma_f32_16x16x32_bf16 v[32:35], v[108:111], v[144:147], v[32:35]
  v_mfma_f32_16x16x32_bf16 v[36:39], v[108:111], v[148:151], v[36:39]
  v_mfma_f32_16x16x32_bf16 v[40:43], v[136:139], v[112:115], v[40:43]
  v_mfma_f32_16x16x32_bf16 v[44:47], v[140:143], v[112:115], v[44:47]
  v_mfma_f32_16x16x32_bf16 v[48:51], v[144:147], v[112:115], v[48:51]
  v_mfma_f32_16x16x32_bf16 v[52:55], v[148:151], v[112:115], v[52:55]
  v_mfma_f32_16x16x32_bf16 v[56:59], v[136:139], v[116:119], v[56:59]
  v_mfma_f32_16x16x32_bf16 v[60:63], v[140:143], v[116:119], v[60:63]
  v_mfma_f32_16x16x32_bf16 v[64:67], v[144:147], v[116:119], v[64:67]
  v_mfma_f32_16x16x32_bf16 v[68:71], v[148:151], v[116:119], v[68:71]
  buffer_load_dwordx4 v[104:107], v1, s[4:7], s30 offen offset:2048
  buffer_load_dwordx4 v[108:111], v1, s[4:7], s31 offen offset:2048
  buffer_load_dwordx4 v[112:115], v1, s[4:7], s32 offen offset:2048
  buffer_load_dwordx4 v[116:119], v1, s[4:7], s33 offen offset:2048
  s_waitcnt vmcnt(12)
  ds_read_b128 v[136:139], v6 offset:4096
  ds_read_b128 v[140:143], v6 offset:24576
  ds_read_b128 v[144:147], v7 offset:4096
  ds_read_b128 v[148:151], v7 offset:24576
  s_waitcnt lgkmcnt(4)
  v_mfma_f32_16x16x32_bf16 v[8:11], v[120:123], v[152:155], v[8:11]
  v_mfma_f32_16x16x32_bf16 v[12:15], v[120:123], v[156:159], v[12:15]
  v_mfma_f32_16x16x32_bf16 v[16:19], v[120:123], v[160:163], v[16:19]
  v_mfma_f32_16x16x32_bf16 v[20:23], v[120:123], v[164:167], v[20:23]
  v_mfma_f32_16x16x32_bf16 v[24:27], v[124:127], v[152:155], v[24:27]
  v_mfma_f32_16x16x32_bf16 v[28:31], v[124:127], v[156:159], v[28:31]
  v_mfma_f32_16x16x32_bf16 v[32:35], v[124:127], v[160:163], v[32:35]
  v_mfma_f32_16x16x32_bf16 v[36:39], v[124:127], v[164:167], v[36:39]
  v_mfma_f32_16x16x32_bf16 v[40:43], v[152:155], v[128:131], v[40:43]
  v_mfma_f32_16x16x32_bf16 v[44:47], v[156:159], v[128:131], v[44:47]
  v_mfma_f32_16x16x32_bf16 v[48:51], v[160:163], v[128:131], v[48:51]
  v_mfma_f32_16x16x32_bf16 v[52:55], v[164:167], v[128:131], v[52:55]
  v_mfma_f32_16x16x32_bf16 v[56:59], v[152:155], v[132:135], v[56:59]
  v_mfma_f32_16x16x32_bf16 v[60:63], v[156:159], v[132:135], v[60:63]
  v_mfma_f32_16x16x32_bf16 v[64:67], v[160:163], v[132:135], v[64:67]
  v_mfma_f32_16x16x32_bf16 v[68:71], v[164:167], v[132:135], v[68:71]
  v_add_u32 v6, 4096, v6
  v_add_u32 v7, 4096, v7
  s_add_u32 s40, s40, 1
  s_cmp_lt_u32 s40, 4
  s_cbranch_scc1 qkvb_loop8
  s_waitcnt vmcnt(0) lgkmcnt(0)
  v_and_b32 v2, 63, v0
  v_and_b32 v3, 15, v2
  v_lshrrev_b32 v4, 4, v2
  s_lshl_b32 s41, s17, 19
  s_lshl_b32 s42, s18, 12
  s_add_u32 s41, s41, s42
  s_mov_b32 s46, 0x3ea52b5c
  s_mov_b32 s47, 0x3ea52b5c
  v_lshlrev_b32 v5, 2, v4
  v_add_u32 v5, 48, v5
  v_mul_u32_u24 v168, 205, v5
  v_lshrrev_b32 v168, 12, v168
  v_mul_u32_u24 v6, 20, v168
  v_sub_u32 v5, v5, v6
  v_lshlrev_b32 v168, 17, v168
  v_lshrrev_b32 v6, 4, v5
  v_lshl_add_u32 v168, v6, 10, v168
  v_bfe_u32 v6, v5, 2, 1
  v_lshl_add_u32 v168, v6, 9, v168
  v_bfe_u32 v6, v5, 3, 1
  v_lshl_add_u32 v168, v6, 3, v168
  v_lshl_add_u32 v168, v3, 4, v168
  v_lshlrev_b32 v5, 2, v4
  v_add_u32 v5, 64, v5
  v_mul_u32_u24 v169, 205, v5
  v_lshrrev_b32 v169, 12, v169
  v_mul_u32_u24 v6, 20, v169
  v_sub_u32 v5, v5, v6
  v_lshlrev_b32 v169, 17, v169
  v_lshrrev_b32 v6, 4, v5
  v_lshl_add_u32 v169, v6, 10, v169
  v_bfe_u32 v6, v5, 2, 1
  v_lshl_add_u32 v169, v6, 9, v169
  v_bfe_u32 v6, v5, 3, 1
  v_lshl_add_u32 v169, v6, 3, v169
  v_lshl_add_u32 v169, v3, 4, v169
  v_add_u32 v5, 0, v3
  v_mul_u32_u24 v170, 205, v5
  v_lshrrev_b32 v170, 12, v170
  v_mul_u32_u24 v6, 20, v170
  v_sub_u32 v5, v5, v6
  v_lshlrev_b32 v170, 17, v170
  v_lshl_add_u32 v170, v5, 4, v170
  v_and_b32 v6, 1, v4
  v_lshl_add_u32 v170, v6, 9, v170
  v_lshrrev_b32 v6, 1, v4
  v_lshl_add_u32 v170, v6, 3, v170
  v_add_u32 v5, 16, v3
  v_mul_u32_u24 v171, 205, v5
  v_lshrrev_b32 v171, 12, v171
  v_mul_u32_u24 v6, 20, v171
  v_sub_u32 v5, v5, v6
  v_lshlrev_b32 v171, 17, v171
  v_lshl_add_u32 v171, v5, 4, v171
  v_and_b32 v6, 1, v4
  v_lshl_add_u32 v171, v6, 9, v171
  v_lshrrev_b32 v6, 1, v4
  v_lshl_add_u32 v171, v6, 3, v171
  v_cvt_pk_bf16_f32 v136, v8, v9
  v_cvt_pk_bf16_f32 v137, v10, v11
  s_add_u32 s43, s41, 41943040
  buffer_store_dwordx2 v[136:137], v168, s[4:7], s43 offen sc1
  v_cvt_pk_bf16_f32 v138, v12, v13
  v_cvt_pk_bf16_f32 v139, v14, v15
  s_add_u32 s43, s41, 41943296
  buffer_store_dwordx2 v[138:139], v168, s[4:7], s43 offen sc1
  v_cvt_pk_bf16_f32 v140, v16, v17
  v_cvt_pk_bf16_f32 v141, v18, v19
  s_add_u32 s43, s41, 41945088
  buffer_store_dwordx2 v[140:141], v168, s[4:7], s43 offen sc1
  v_cvt_pk_bf16_f32 v142, v20, v21
  v_cvt_pk_bf16_f32 v143, v22, v23
  s_add_u32 s43, s41, 41945344
  buffer_store_dwordx2 v[142:143], v168, s[4:7], s43 offen sc1
  v_cvt_pk_bf16_f32 v144, v24, v25
  v_cvt_pk_bf16_f32 v145, v26, v27
  s_add_u32 s43, s41, 41943040
  buffer_store_dwordx2 v[144:145], v169, s[4:7], s43 offen sc1
  v_cvt_pk_bf16_f32 v146, v28, v29
  v_cvt_pk_bf16_f32 v147, v30, v31
  s_add_u32 s43, s41, 41943296
  buffer_store_dwordx2 v[146:147], v169, s[4:7], s43 offen sc1
  v_cvt_pk_bf16_f32 v148, v32, v33
  v_cvt_pk_bf16_f32 v149, v34, v35
  s_add_u32 s43, s41, 41945088
  buffer_store_dwordx2 v[148:149], v169, s[4:7], s43 offen sc1
  v_cvt_pk_bf16_f32 v150, v36, v37
  v_cvt_pk_bf16_f32 v151, v38, v39
  s_add_u32 s43, s41, 41945344
  buffer_store_dwordx2 v[150:151], v169, s[4:7], s43 offen sc1
  v_cvt_pk_bf16_f32 v136, v40, v41
  v_cvt_pk_bf16_f32 v137, v42, v43
  s_add_u32 s43, s41, 46137344
  buffer_store_dwordx2 v[136:137], v170, s[4:7], s43 offen sc1
  v_cvt_pk_bf16_f32 v138, v44, v45
  v_cvt_pk_bf16_f32 v139, v46, v47
  s_add_u32 s43, s41, 46138368
  buffer_store_dwordx2 v[138:139], v170, s[4:7], s43 offen sc1
  v_cvt_pk_bf16_f32 v140, v48, v49
  v_cvt_pk_bf16_f32 v141, v50, v51
  s_add_u32 s43, s41, 46139392
  buffer_store_dwordx2 v[140:141], v170, s[4:7], s43 offen sc1
  v_cvt_pk_bf16_f32 v142, v52, v53
  v_cvt_pk_bf16_f32 v143, v54, v55
  s_add_u32 s43, s41, 46140416
  buffer_store_dwordx2 v[142:143], v170, s[4:7], s43 offen sc1
  v_cvt_pk_bf16_f32 v144, v56, v57
  v_cvt_pk_bf16_f32 v145, v58, v59
  s_add_u32 s43, s41, 46137344
  buffer_store_dwordx2 v[144:145], v171, s[4:7], s43 offen sc1
  v_cvt_pk_bf16_f32 v146, v60, v61
  v_cvt_pk_bf16_f32 v147, v62, v63
  s_add_u32 s43, s41, 46138368
  buffer_store_dwordx2 v[146:147], v171, s[4:7], s43 offen sc1
  v_cvt_pk_bf16_f32 v148, v64, v65
  v_cvt_pk_bf16_f32 v149, v66, v67
  s_add_u32 s43, s41, 46139392
  buffer_store_dwordx2 v[148:149], v171, s[4:7], s43 offen sc1
  v_cvt_pk_bf16_f32 v150, v68, v69
  v_cvt_pk_bf16_f32 v151, v70, v71
  s_add_u32 s43, s41, 46140416
  buffer_store_dwordx2 v[150:151], v171, s[4:7], s43 offen sc1
  s_branch qkvb_exit1
qkvb_w3_5:
  s_mul_i32 s30, s17, 5
  s_add_u32 s30, s30, 82
  s_mul_i32 s30, s30, 20480
  s_add_u32 s30, s30, 87556096
  s_mul_i32 s31, s17, 5
  s_add_u32 s31, s31, 83
  s_mul_i32 s31, s31, 20480
  s_add_u32 s31, s31, 87556096
  s_mul_i32 s32, s17, 5
  s_add_u32 s32, s32, 84
  s_mul_i32 s32, s32, 20480
  s_add_u32 s32, s32, 87556096
  buffer_load_dwordx4 v[72:75], v1, s[4:7], s30 offen offset:0
  buffer_load_dwordx4 v[76:79], v1, s[4:7], s31 offen offset:0
  buffer_load_dwordx4 v[80:83], v1, s[4:7], s32 offen offset:0
  buffer_load_dwordx4 v[88:91], v1, s[4:7], s30 offen offset:1024
  buffer_load_dwordx4 v[92:95], v1, s[4:7], s31 offen offset:1024
  buffer_load_dwordx4 v[96:99], v1, s[4:7], s32 offen offset:1024
  buffer_load_dwordx4 v[104:107], v1, s[4:7], s30 offen offset:2048
  buffer_load_dwordx4 v[108:111], v1, s[4:7], s31 offen offset:2048
  buffer_load_dwordx4 v[112:115], v1, s[4:7], s32 offen offset:2048
  s_add_u32 m0, s22, 4096
  s_add_u32 s23, s21, 4096
  buffer_load_dwordx4 v1, s[4:7], s23 offen offset:0 lds
  buffer_load_dwordx4 v1, s[4:7], s23 offen offset:1024 lds
  buffer_load_dwordx4 v1, s[4:7], s23 offen offset:2048 lds
  buffer_load_dwordx4 v1, s[4:7], s23 offen offset:3072 lds
  s_add_u32 m0, s22, 8192
  s_add_u32 s23, s21, 8192
  buffer_load_dwordx4 v1, s[4:7], s23 offen offset:0 lds
  buffer_load_dwordx4 v1, s[4:7], s23 offen offset:1024 lds
  buffer_load_dwordx4 v1, s[4:7], s23 offen offset:2048 lds
  buffer_load_dwordx4 v1, s[4:7], s23 offen offset:3072 lds
  s_add_u32 m0, s22, 12288
  s_add_u32 s23, s21, 12288
  buffer_load_dwordx4 v1, s[4:7], s23 offen offset:0 lds
  buffer_load_dwordx4 v1, s[4:7], s23 offen offset:1024 lds
  buffer_load_dwordx4 v1, s[4:7], s23 offen offset:2048 lds
  buffer_load_dwordx4 v1, s[4:7], s23 offen offset:3072 lds
  s_add_u32 m0, s22, 16384
  s_add_u32 s23, s21, 16384
  buffer_load_dwordx4 v1, s[4:7], s23 offen offset:0 lds
  buffer_load_dwordx4 v1, s[4:7], s23 offen offset:1024 lds
  buffer_load_dwordx4 v1, s[4:7], s23 offen offset:2048 lds
  buffer_load_dwordx4 v1, s[4:7], s23 offen offset:3072 lds
  s_waitcnt vmcnt(25)
  s_barrier
  ds_read_b128 v[136:139], v6 offset:0
  ds_read_b128 v[140:143], v6 offset:20480
  ds_read_b128 v[144:147], v7 offset:0
  ds_read_b128 v[148:151], v7 offset:20480
  buffer_load_dwordx4 v[120:123], v1, s[4:7], s30 offen offset:3072
  buffer_load_dwordx4 v[124:127], v1, s[4:7], s31 offen offset:3072
  buffer_load_dwordx4 v[128:131], v1, s[4:7], s32 offen offset:3072
  s_waitcnt vmcnt(25)
  ds_read_b128 v[152:155], v6 offset:1024
  ds_read_b128 v[156:159], v6 offset:21504
  ds_read_b128 v[160:163], v7 offset:1024
  ds_read_b128 v[164:167], v7 offset:21504
  s_waitcnt lgkmcnt(4)
  v_mfma_f32_16x16x32_bf16 v[8:11], v[136:139], v[72:75], 0
  v_mfma_f32_16x16x32_bf16 v[12:15], v[140:143], v[72:75], 0
  v_mfma_f32_16x16x32_bf16 v[16:19], v[144:147], v[72:75], 0
  v_mfma_f32_16x16x32_bf16 v[20:23], v[148:151], v[72:75], 0
  v_mfma_f32_16x16x32_bf16 v[24:27], v[136:139], v[76:79], 0
  v_mfma_f32_16x16x32_bf16 v[28:31], v[140:143], v[76:79], 0
  v_mfma_f32_16x16x32_bf16 v[32:35], v[144:147], v[76:79], 0
  v_mfma_f32_16x16x32_bf16 v[36:39], v[148:151], v[76:79], 0
  v_mfma_f32_16x16x32_bf16 v[40:43], v[136:139], v[80:83], 0
  v_mfma_f32_16x16x32_bf16 v[44:47], v[140:143], v[80:83], 0
  v_mfma_f32_16x16x32_bf16 v[48:51], v[144:147], v[80:83], 0
  v_mfma_f32_16x16x32_bf16 v[52:55], v[148:151], v[80:83], 0
  s_add_u32 s30, s30, 4096
  s_add_u32 s31, s31, 4096
  s_add_u32 s32, s32, 4096
  buffer_load_dwordx4 v[72:75], v1, s[4:7], s30 offen offset:0
  buffer_load_dwordx4 v[76:79], v1, s[4:7], s31 offen offset:0
  buffer_load_dwordx4 v[80:83], v1, s[4:7], s32 offen offset:0
  s_waitcnt vmcnt(25)
  ds_read_b128 v[136:139], v6 offset:2048
  ds_read_b128 v[140:143], v6 offset:22528
  ds_read_b128 v[144:147], v7 offset:2048
  ds_read_b128 v[148:151], v7 offset:22528
  s_waitcnt lgkmcnt(4)
  v_mfma_f32_16x16x32_bf16 v[8:11], v[152:155], v[88:91], v[8:11]
  v_mfma_f32_16x16x32_bf16 v[12:15], v[156:159], v[88:91], v[12:15]
  v_mfma_f32_16x16x32_bf16 v[16:19], v[160:163], v[88:91], v[16:19]
  v_mfma_f32_16x16x32_bf16 v[20:23], v[164:167], v[88:91], v[20:23]
  v_mfma_f32_16x16x32_bf16 v[24:27], v[152:155], v[92:95], v[24:27]
  v_mfma_f32_16x16x32_bf16 v[28:31], v[156:159], v[92:95], v[28:31]
  v_mfma_f32_16x16x32_bf16 v[32:35], v[160:163], v[92:95], v[32:35]
  v_mfma_f32_16x16x32_bf16 v[36:39], v[164:167], v[92:95], v[36:39]
  v_mfma_f32_16x16x32_bf16 v[40:43], v[152:155], v[96:99], v[40:43]
  v_mfma_f32_16x16x32_bf16 v[44:47], v[156:159], v[96:99], v[44:47]
  v_mfma_f32_16x16x32_bf16 v[48:51], v[160:163], v[96:99], v[48:51]
  v_mfma_f32_16x16x32_bf16 v[52:55], v[164:167], v[96:99], v[52:55]
  buffer_load_dwordx4 v[88:91], v1, s[4:7], s30 offen offset:1024
  buffer_load_dwordx4 v[92:95], v1, s[4:7], s31 offen offset:1024
  buffer_load_dwordx4 v[96:99], v1, s[4:7], s32 offen offset:1024
  s_waitcnt vmcnt(25)
  ds_read_b128 v[152:155], v6 offset:3072
  ds_read_b128 v[156:159], v6 offset:23552
  ds_read_b128 v[160:163], v7 offset:3072
  ds_read_b128 v[164:167], v7 offset:23552
  s_waitcnt lgkmcnt(4)
  v_mfma_f32_16x16x32_bf16 v[8:11], v[136:139], v[104:107], v[8:11]
  v_mfma_f32_16x16x32_bf16 v[12:15], v[140:143], v[104:107], v[12:15]
  v_mfma_f32_16x16x32_bf16 v[16:19], v[144:147], v[104:107], v[16:19]
  v_mfma_f32_16x16x32_bf16 v[20:23], v[148:151], v[104:107], v[20:23]
  v_mfma_f32_16x16x32_bf16 v[24:27], v[136:139], v[108:111], v[24:27]
  v_mfma_f32_16x16x32_bf16 v[28:31], v[140:143], v[108:111], v[28:31]
  v_mfma_f32_16x16x32_bf16 v[32:35], v[144:147], v[108:111], v[32:35]
  v_mfma_f32_16x16x32_bf16 v[36:39], v[148:151], v[108:111], v[36:39]
  v_mfma_f32_16x16x32_bf16 v[40:43], v[136:139], v[112:115], v[40:43]
  v_mfma_f32_16x16x32_bf16 v[44:47], v[140:143], v[112:115], v[44:47]
  v_mfma_f32_16x16x32_bf16 v[48:51], v[144:147], v[112:115], v[48:51]
  v_mfma_f32_16x16x32_bf16 v[52:55], v[148:151], v[112:115], v[52:55]
  buffer_load_dwordx4 v[104:107], v1, s[4:7], s30 offen offset:2048
  buffer_load_dwordx4 v[108:111], v1, s[4:7], s31 offen offset:2048
  buffer_load_dwordx4 v[112:115], v1, s[4:7], s32 offen offset:2048
  s_waitcnt vmcnt(9)
  s_barrier
  ds_read_b128 v[136:139], v6 offset:4096
  ds_read_b128 v[140:143], v6 offset:24576
  ds_read_b128 v[144:147], v7 offset:4096
  ds_read_b128 v[148:151], v7 offset:24576
  s_waitcnt lgkmcnt(4)
  v_mfma_f32_16x16x32_bf16 v[8:11], v[152:155], v[120:123], v[8:11]
  v_mfma_f32_16x16x32_bf16 v[12:15], v[156:159], v[120:123], v[12:15]
  v_mfma_f32_16x16x32_bf16 v[16:19], v[160:163], v[120:123], v[16:19]
  v_mfma_f32_16x16x32_bf16 v[20:23], v[164:167], v[120:123], v[20:23]
  v_mfma_f32_16x16x32_bf16 v[24:27], v[152:155], v[124:127], v[24:27]
  v_mfma_f32_16x16x32_bf16 v[28:31], v[156:159], v[124:127], v[28:31]
  v_mfma_f32_16x16x32_bf16 v[32:35], v[160:163], v[124:127], v[32:35]
  v_mfma_f32_16x16x32_bf16 v[36:39], v[164:167], v[124:127], v[36:39]
  v_mfma_f32_16x16x32_bf16 v[40:43], v[152:155], v[128:131], v[40:43]
  v_mfma_f32_16x16x32_bf16 v[44:47], v[156:159], v[128:131], v[44:47]
  v_mfma_f32_16x16x32_bf16 v[48:51], v[160:163], v[128:131], v[48:51]
  v_mfma_f32_16x16x32_bf16 v[52:55], v[164:167], v[128:131], v[52:55]
  s_mov_b32 s40, 0
  v_add_u32 v6, 4096, v6
  v_add_u32 v7, 4096, v7
qkvb_loop9:
  buffer_load_dwordx4 v[120:123], v1, s[4:7], s30 offen offset:3072
  buffer_load_dwordx4 v[124:127], v1, s[4:7], s31 offen offset:3072
  buffer_load_dwordx4 v[128:131], v1, s[4:7], s32 offen offset:3072
  s_waitcnt vmcnt(9)
  ds_read_b128 v[152:155], v6 offset:1024
  ds_read_b128 v[156:159], v6 offset:21504
  ds_read_b128 v[160:163], v7 offset:1024
  ds_read_b128 v[164:167], v7 offset:21504
  s_waitcnt lgkmcnt(4)
  v_mfma_f32_16x16x32_bf16 v[8:11], v[136:139], v[72:75], v[8:11]
  v_mfma_f32_16x16x32_bf16 v[12:15], v[140:143], v[72:75], v[12:15]
  v_mfma_f32_16x16x32_bf16 v[16:19], v[144:147], v[72:75], v[16:19]
  v_mfma_f32_16x16x32_bf16 v[20:23], v[148:151], v[72:75], v[20:23]
  v_mfma_f32_16x16x32_bf16 v[24:27], v[136:139], v[76:79], v[24:27]
  v_mfma_f32_16x16x32_bf16 v[28:31], v[140:143], v[76:79], v[28:31]
  v_mfma_f32_16x16x32_bf16 v[32:35], v[144:147], v[76:79], v[32:35]
  v_mfma_f32_16x16x32_bf16 v[36:39], v[148:151], v[76:79], v[36:39]
  v_mfma_f32_16x16x32_bf16 v[40:43], v[136:139], v[80:83], v[40:43]
  v_mfma_f32_16x16x32_bf16 v[44:47], v[140:143], v[80:83], v[44:47]
  v_mfma_f32_16x16x32_bf16 v[48:51], v[144:147], v[80:83], v[48:51]
  v_mfma_f32_16x16x32_bf16 v[52:55], v[148:151], v[80:83], v[52:55]
  s_add_u32 s30, s30, 4096
  s_add_u32 s31, s31, 4096
  s_add_u32 s32, s32, 4096
  buffer_load_dwordx4 v[72:75], v1, s[4:7], s30 offen offset:0
  buffer_load_dwordx4 v[76:79], v1, s[4:7], s31 offen offset:0
  buffer_load_dwordx4 v[80:83], v1, s[4:7], s32 offen offset:0
  s_waitcnt vmcnt(9)
  ds_read_b128 v[136:139], v6 offset:2048
  ds_read_b128 v[140:143], v6 offset:22528
  ds_read_b128 v[144:147], v7 offset:2048
  ds_read_b128 v[148:151], v7 offset:22528
  s_waitcnt lgkmcnt(4)
  v_mfma_f32_16x16x32_bf16 v[8:11], v[152:155], v[88:91], v[8:11]
  v_mfma_f32_16x16x32_bf16 v[12:15], v[156:159], v[88:91], v[12:15]
  v_mfma_f32_16x16x32_bf16 v[16:19], v[160:163], v[88:91], v[16:19]
  v_mfma_f32_16x16x32_bf16 v[20:23], v[164:167], v[88:91], v[20:23]
  v_mfma_f32_16x16x32_bf16 v[24:27], v[152:155], v[92:95], v[24:27]
  v_mfma_f32_16x16x32_bf16 v[28:31], v[156:159], v[92:95], v[28:31]
  v_mfma_f32_16x16x32_bf16 v[32:35], v[160:163], v[92:95], v[32:35]
  v_mfma_f32_16x16x32_bf16 v[36:39], v[164:167], v[92:95], v[36:39]
  v_mfma_f32_16x16x32_bf16 v[40:43], v[152:155], v[96:99], v[40:43]
  v_mfma_f32_16x16x32_bf16 v[44:47], v[156:159], v[96:99], v[44:47]
  v_mfma_f32_16x16x32_bf16 v[48:51], v[160:163], v[96:99], v[48:51]
  v_mfma_f32_16x16x32_bf16 v[52:55], v[164:167], v[96:99], v[52:55]
  buffer_load_dwordx4 v[88:91], v1, s[4:7], s30 offen offset:1024
  buffer_load_dwordx4 v[92:95], v1, s[4:7], s31 offen offset:1024
  buffer_load_dwordx4 v[96:99], v1, s[4:7], s32 offen offset:1024
  s_waitcnt vmcnt(9)
  ds_read_b128 v[152:155], v6 offset:3072
  ds_read_b128 v[156:159], v6 offset:23552
  ds_read_b128 v[160:163], v7 offset:3072
  ds_read_b128 v[164:167], v7 offset:23552
  s_waitcnt lgkmcnt(4)
  v_mfma_f32_16x16x32_bf16 v[8:11], v[136:139], v[104:107], v[8:11]
  v_mfma_f32_16x16x32_bf16 v[12:15], v[140:143], v[104:107], v[12:15]
  v_mfma_f32_16x16x32_bf16 v[16:19], v[144:147], v[104:107], v[16:19]
  v_mfma_f32_16x16x32_bf16 v[20:23], v[148:151], v[104:107], v[20:23]
  v_mfma_f32_16x16x32_bf16 v[24:27], v[136:139], v[108:111], v[24:27]
  v_mfma_f32_16x16x32_bf16 v[28:31], v[140:143], v[108:111], v[28:31]
  v_mfma_f32_16x16x32_bf16 v[32:35], v[144:147], v[108:111], v[32:35]
  v_mfma_f32_16x16x32_bf16 v[36:39], v[148:151], v[108:111], v[36:39]
  v_mfma_f32_16x16x32_bf16 v[40:43], v[136:139], v[112:115], v[40:43]
  v_mfma_f32_16x16x32_bf16 v[44:47], v[140:143], v[112:115], v[44:47]
  v_mfma_f32_16x16x32_bf16 v[48:51], v[144:147], v[112:115], v[48:51]
  v_mfma_f32_16x16x32_bf16 v[52:55], v[148:151], v[112:115], v[52:55]
  buffer_load_dwordx4 v[104:107], v1, s[4:7], s30 offen offset:2048
  buffer_load_dwordx4 v[108:111], v1, s[4:7], s31 offen offset:2048
  buffer_load_dwordx4 v[112:115], v1, s[4:7], s32 offen offset:2048
  s_waitcnt vmcnt(9)
  ds_read_b128 v[136:139], v6 offset:4096
  ds_read_b128 v[140:143], v6 offset:24576
  ds_read_b128 v[144:147], v7 offset:4096
  ds_read_b128 v[148:151], v7 offset:24576
  s_waitcnt lgkmcnt(4)
  v_mfma_f32_16x16x32_bf16 v[8:11], v[152:155], v[120:123], v[8:11]
  v_mfma_f32_16x16x32_bf16 v[12:15], v[156:159], v[120:123], v[12:15]
  v_mfma_f32_16x16x32_bf16 v[16:19], v[160:163], v[120:123], v[16:19]
  v_mfma_f32_16x16x32_bf16 v[20:23], v[164:167], v[120:123], v[20:23]
  v_mfma_f32_16x16x32_bf16 v[24:27], v[152:155], v[124:127], v[24:27]
  v_mfma_f32_16x16x32_bf16 v[28:31], v[156:159], v[124:127], v[28:31]
  v_mfma_f32_16x16x32_bf16 v[32:35], v[160:163], v[124:127], v[32:35]
  v_mfma_f32_16x16x32_bf16 v[36:39], v[164:167], v[124:127], v[36:39]
  v_mfma_f32_16x16x32_bf16 v[40:43], v[152:155], v[128:131], v[40:43]
  v_mfma_f32_16x16x32_bf16 v[44:47], v[156:159], v[128:131], v[44:47]
  v_mfma_f32_16x16x32_bf16 v[48:51], v[160:163], v[128:131], v[48:51]
  v_mfma_f32_16x16x32_bf16 v[52:55], v[164:167], v[128:131], v[52:55]
  v_add_u32 v6, 4096, v6
  v_add_u32 v7, 4096, v7
  s_add_u32 s40, s40, 1
  s_cmp_lt_u32 s40, 4
  s_cbranch_scc1 qkvb_loop9
  s_waitcnt vmcnt(0) lgkmcnt(0)
  v_and_b32 v2, 63, v0
  v_and_b32 v3, 15, v2
  v_lshrrev_b32 v4, 4, v2
  s_lshl_b32 s41, s17, 19
  s_lshl_b32 s42, s18, 12
  s_add_u32 s41, s41, s42
  s_mov_b32 s46, 0x3ea52b5c
  s_mov_b32 s47, 0x3ea52b5c
  v_add_u32 v5, 32, v3
  v_mul_u32_u24 v168, 205, v5
  v_lshrrev_b32 v168, 12, v168
  v_mul_u32_u24 v6, 20, v168
  v_sub_u32 v5, v5, v6
  v_lshlrev_b32 v168, 17, v168
  v_lshl_add_u32 v168, v5, 4, v168
  v_and_b32 v6, 1, v4
  v_lshl_add_u32 v168, v6, 9, v168
  v_lshrrev_b32 v6, 1, v4
  v_lshl_add_u32 v168, v6, 3, v168
  v_add_u32 v5, 48, v3
  v_mul_u32_u24 v169, 205, v5
  v_lshrrev_b32 v169, 12, v169
  v_mul_u32_u24 v6, 20, v169
  v_sub_u32 v5, v5, v6
  v_lshlrev_b32 v169, 17, v169
  v_lshl_add_u32 v169, v5, 4, v169
  v_and_b32 v6, 1, v4
  v_lshl_add_u32 v169, v6, 9, v169
  v_lshrrev_b32 v6, 1, v4
  v_lshl_add_u32 v169, v6, 3, v169
  v_add_u32 v5, 64, v3
  v_mul_u32_u24 v170, 205, v5
  v_lshrrev_b32 v170, 12, v170
  v_mul_u32_u24 v6, 20, v170
  v_sub_u32 v5, v5, v6
  v_lshlrev_b32 v170, 17, v170
  v_lshl_add_u32 v170, v5, 4, v170
  v_and_b32 v6, 1, v4
  v_lshl_add_u32 v170, v6, 9, v170
  v_lshrrev_b32 v6, 1, v4
  v_lshl_add_u32 v170, v6, 3, v170
  v_cvt_pk_bf16_f32 v136, v8, v9
  v_cvt_pk_bf16_f32 v137, v10, v11
  s_add_u32 s43, s41, 46137344
  buffer_store_dwordx2 v[136:137], v168, s[4:7], s43 offen sc1
  v_cvt_pk_bf16_f32 v138, v12, v13
  v_cvt_pk_bf16_f32 v139, v14, v15
  s_add_u32 s43, s41, 46138368
  buffer_store_dwordx2 v[138:139], v168, s[4:7], s43 offen sc1
  v_cvt_pk_bf16_f32 v140, v16, v17
  v_cvt_pk_bf16_f32 v141, v18, v19
  s_add_u32 s43, s41, 46139392
  buffer_store_dwordx2 v[140:141], v168, s[4:7], s43 offen sc1
  v_cvt_pk_bf16_f32 v142, v20, v21
  v_cvt_pk_bf16_f32 v143, v22, v23
  s_add_u32 s43, s41, 46140416
  buffer_store_dwordx2 v[142:143], v168, s[4:7], s43 offen sc1
  v_cvt_pk_bf16_f32 v144, v24, v25
  v_cvt_pk_bf16_f32 v145, v26, v27
  s_add_u32 s43, s41, 46137344
  buffer_store_dwordx2 v[144:145], v169, s[4:7], s43 offen sc1
  v_cvt_pk_bf16_f32 v146, v28, v29
  v_cvt_pk_bf16_f32 v147, v30, v31
  s_add_u32 s43, s41, 46138368
  buffer_store_dwordx2 v[146:147], v169, s[4:7], s43 offen sc1
  v_cvt_pk_bf16_f32 v148, v32, v33
  v_cvt_pk_bf16_f32 v149, v34, v35
  s_add_u32 s43, s41, 46139392
  buffer_store_dwordx2 v[148:149], v169, s[4:7], s43 offen sc1
  v_cvt_pk_bf16_f32 v150, v36, v37
  v_cvt_pk_bf16_f32 v151, v38, v39
  s_add_u32 s43, s41, 46140416
  buffer_store_dwordx2 v[150:151], v169, s[4:7], s43 offen sc1
  v_cvt_pk_bf16_f32 v136, v40, v41
  v_cvt_pk_bf16_f32 v137, v42, v43
  s_add_u32 s43, s41, 46137344
  buffer_store_dwordx2 v[136:137], v170, s[4:7], s43 offen sc1
  v_cvt_pk_bf16_f32 v138, v44, v45
  v_cvt_pk_bf16_f32 v139, v46, v47
  s_add_u32 s43, s41, 46138368
  buffer_store_dwordx2 v[138:139], v170, s[4:7], s43 offen sc1
  v_cvt_pk_bf16_f32 v140, v48, v49
  v_cvt_pk_bf16_f32 v141, v50, v51
  s_add_u32 s43, s41, 46139392
  buffer_store_dwordx2 v[140:141], v170, s[4:7], s43 offen sc1
  v_cvt_pk_bf16_f32 v142, v52, v53
  v_cvt_pk_bf16_f32 v143, v54, v55
  s_add_u32 s43, s41, 46140416
  buffer_store_dwordx2 v[142:143], v170, s[4:7], s43 offen sc1
  v_mov_b32 v72, 0
  v_mov_b32 v73, 0
  v_mov_b32 v74, 0
  v_mov_b32 v75, 0
  v_lshlrev_b32 v5, 17, v4
  v_lshl_add_u32 v5, v3, 4, v5
  v_add_u32 v6, 1032, v5
  v_add_u32 v7, 1536, v5
  s_add_u32 s43, s41, 37748736
  buffer_store_dwordx2 v[72:73], v6, s[4:7], s43 offen sc1
  buffer_store_dwordx4 v[72:75], v7, s[4:7], s43 offen sc1
  s_add_u32 s43, s41, 37748992
  buffer_store_dwordx2 v[72:73], v6, s[4:7], s43 offen sc1
  buffer_store_dwordx4 v[72:75], v7, s[4:7], s43 offen sc1
  s_add_u32 s43, s41, 37750784
  buffer_store_dwordx2 v[72:73], v6, s[4:7], s43 offen sc1
  buffer_store_dwordx4 v[72:75], v7, s[4:7], s43 offen sc1
  s_add_u32 s43, s41, 37751040
  buffer_store_dwordx2 v[72:73], v6, s[4:7], s43 offen sc1
  buffer_store_dwordx4 v[72:75], v7, s[4:7], s43 offen sc1
  s_add_u32 s43, s41, 41943040
  buffer_store_dwordx2 v[72:73], v6, s[4:7], s43 offen sc1
  buffer_store_dwordx4 v[72:75], v7, s[4:7], s43 offen sc1
  s_add_u32 s43, s41, 41943296
  buffer_store_dwordx2 v[72:73], v6, s[4:7], s43 offen sc1
  buffer_store_dwordx4 v[72:75], v7, s[4:7], s43 offen sc1
  s_add_u32 s43, s41, 41945088
  buffer_store_dwordx2 v[72:73], v6, s[4:7], s43 offen sc1
  buffer_store_dwordx4 v[72:75], v7, s[4:7], s43 offen sc1
  s_add_u32 s43, s41, 41945344
  buffer_store_dwordx2 v[72:73], v6, s[4:7], s43 offen sc1
  buffer_store_dwordx4 v[72:75], v7, s[4:7], s43 offen sc1
  v_and_b32 v6, 1, v4
  v_lshlrev_b32 v6, 9, v6
  v_add_u32 v5, 20, v3
  v_lshl_add_u32 v6, v5, 4, v6
  v_lshrrev_b32 v5, 1, v4
  v_lshl_add_u32 v6, v5, 17, v6
  v_mov_b32 v5, 0x80000000
  v_cmp_gt_u32 vcc, 12, v3
  s_nop 1
  v_cndmask_b32 v6, v5, v6, vcc
  v_cmp_eq_u32 vcc, 0, v3
  v_mov_b32 v5, 0x3f803f80
  s_nop 0
  v_cndmask_b32 v76, 0, v5, vcc
  v_mov_b32 v77, v76
  v_mov_b32 v78, v76
  v_mov_b32 v79, v76
  s_add_u32 s43, s41, 46137344
  buffer_store_dwordx4 v[76:79], v6, s[4:7], s43 offen sc1
  s_add_u32 s43, s41, 46138368
  buffer_store_dwordx4 v[76:79], v6, s[4:7], s43 offen sc1
  s_add_u32 s43, s41, 46139392
  buffer_store_dwordx4 v[76:79], v6, s[4:7], s43 offen sc1
  s_add_u32 s43, s41, 46140416
  buffer_store_dwordx4 v[76:79], v6, s[4:7], s43 offen sc1
  s_add_u32 s43, s41, 46399488
  buffer_store_dwordx4 v[76:79], v6, s[4:7], s43 offen sc1
  s_add_u32 s43, s41, 46400512
  buffer_store_dwordx4 v[76:79], v6, s[4:7], s43 offen sc1
  s_add_u32 s43, s41, 46401536
  buffer_store_dwordx4 v[76:79], v6, s[4:7], s43 offen sc1
  s_add_u32 s43, s41, 46402560
  buffer_store_dwordx4 v[76:79], v6, s[4:7], s43 offen sc1
  s_branch qkvb_exit1
qkvb_exit1:
  s_endpgm
.globl attnb_kernel
.p2align 8
.type attnb_kernel,@function
attnb_kernel:
  s_cmp_ge_u32 s2, 256
  s_cbranch_scc1 attnb_exit1
  s_load_dwordx2 s[12:13], s[0:1], 96
  v_lshrrev_b32 v2, 6, v0
  v_and_b32 v3, 63, v0
  s_nop 0
  v_readfirstlane_b32 s16, v2
  v_lshlrev_b32 v1, 4, v3
  s_and_b32 s17, s2, 7
  s_lshl_b32 s17, s17, 2
  s_lshr_b32 s18, s2, 3
  s_and_b32 s19, s18, 3
  s_add_u32 s17, s17, s19
  s_lshr_b32 s18, s18, 2
  s_waitcnt lgkmcnt(0)
  s_mov_b32 s4, s12
  s_mov_b32 s5, s13
  s_mov_b32 s6, 0x10000000
  s_mov_b32 s7, 0x20000
  s_lshl_b32 s20, s17, 17
  s_add_u32 s21, s20, 41943040
  s_add_u32 s22, s20, 46137344
  s_lshl_b32 s23, s18, 3
  s_lshl_b32 s24, s16, 1
  s_add_u32 s23, s23, s24
  s_lshl_b32 s24, s23, 11
  s_add_u32 s24, s24, s20
  s_add_u32 s24, s24, 37748736
  buffer_load_dwordx4 v[8:11], v1, s[4:7], s24 offen offset:0
  buffer_load_dwordx4 v[12:15], v1, s[4:7], s24 offen offset:1024
  buffer_load_dwordx4 v[16:19], v1, s[4:7], s24 offen offset:2048
  buffer_load_dwordx4 v[20:23], v1, s[4:7], s24 offen offset:3072
  s_mov_b32 s25, s21
  s_mov_b32 s26, s22
  buffer_load_dwordx4 v[136:139], v1, s[4:7], s25 offen
  buffer_load_dwordx4 v[140:143], v1, s[4:7], s25 offen offset:1024
  buffer_load_dwordx4 v[144:147], v1, s[4:7], s26 offen
  buffer_load_dwordx4 v[148:151], v1, s[4:7], s26 offen offset:1024
  s_add_u32 s25, s25, 2048
  s_add_u32 s26, s26, 2048
  s_waitcnt vmcnt(0)
  v_mfma_f32_32x32x16_bf16 v[88:103], v[136:139], v[8:11], 0
  v_mfma_f32_32x32x16_bf16 v[88:103], v[140:143], v[12:15], v[88:103]
  v_mfma_f32_32x32x16_bf16 v[104:119], v[136:139], v[16:19], 0
  v_mfma_f32_32x32x16_bf16 v[104:119], v[140:143], v[20:23], v[104:119]
  s_nop 9
  v_max3_f32 v2, v88, v89, v90
  v_max3_f32 v2, v2, v91, v92
  v_max3_f32 v2, v2, v93, v94
  v_max3_f32 v2, v2, v95, v96
  v_max3_f32 v2, v2, v97, v98
  v_max3_f32 v2, v2, v99, v100
  v_max3_f32 v2, v2, v101, v102
  v_max_f32 v2, v2, v103
  v_mov_b32 v4, v2
  s_nop 1
  v_permlane32_swap_b32 v2, v4
  v_max_f32 v2, v2, v4
  v_sub_f32 v24, 0, v2
  v_sub_f32 v25, 0, v2
  v_sub_f32 v26, 0, v2
  v_sub_f32 v27, 0, v2
  v_sub_f32 v28, 0, v2
  v_sub_f32 v29, 0, v2
  v_sub_f32 v30, 0, v2
  v_sub_f32 v31, 0, v2
  v_sub_f32 v32, 0, v2
  v_sub_f32 v33, 0, v2
  v_sub_f32 v34, 0, v2
  v_sub_f32 v35, 0, v2
  v_sub_f32 v36, 0, v2
  v_sub_f32 v37, 0, v2
  v_sub_f32 v38, 0, v2
  v_sub_f32 v39, 0, v2
  v_max3_f32 v3, v104, v105, v106
  v_max3_f32 v3, v3, v107, v108
  v_max3_f32 v3, v3, v109, v110
  v_max3_f32 v3, v3, v111, v112
  v_max3_f32 v3, v3, v113, v114
  v_max3_f32 v3, v3, v115, v116
  v_max3_f32 v3, v3, v117, v118
  v_max_f32 v3, v3, v119
  v_mov_b32 v4, v3
  s_nop 1
  v_permlane32_swap_b32 v3, v4
  v_max_f32 v3, v3, v4
  v_sub_f32 v40, 0, v3
  v_sub_f32 v41, 0, v3
  v_sub_f32 v42, 0, v3
  v_sub_f32 v43, 0, v3
  v_sub_f32 v44, 0, v3
  v_sub_f32 v45, 0, v3
  v_sub_f32 v46, 0, v3
  v_sub_f32 v47, 0, v3
  v_sub_f32 v48, 0, v3
  v_sub_f32 v49, 0, v3
  v_sub_f32 v50, 0, v3
  v_sub_f32 v51, 0, v3
  v_sub_f32 v52, 0, v3
  v_sub_f32 v53, 0, v3
  v_sub_f32 v54, 0, v3
  v_sub_f32 v55, 0, v3
  s_mov_b32 s28, 0
attnb_main2:
  s_mov_b32 s25, s21
  s_mov_b32 s26, s22
  buffer_load_dwordx4 v[136:139], v1, s[4:7], s25 offen
  buffer_load_dwordx4 v[140:143], v1, s[4:7], s25 offen offset:1024
  buffer_load_dwordx4 v[144:147], v1, s[4:7], s26 offen
  buffer_load_dwordx4 v[148:151], v1, s[4:7], s26 offen offset:1024
  s_add_u32 s25, s25, 2048
  s_add_u32 s26, s26, 2048
  buffer_load_dwordx4 v[152:155], v1, s[4:7], s25 offen
  buffer_load_dwordx4 v[156:159], v1, s[4:7], s25 offen offset:1024
  buffer_load_dwordx4 v[160:163], v1, s[4:7], s26 offen
  buffer_load_dwordx4 v[164:167], v1, s[4:7], s26 offen offset:1024
  s_add_u32 s25, s25, 2048
  s_add_u32 s26, s26, 2048
  v_mov_b32 v56, 0
  v_mov_b32 v57, 0
  v_mov_b32 v58, 0
  v_mov_b32 v59, 0
  v_mov_b32 v60, 0
  v_mov_b32 v61, 0
  v_mov_b32 v62, 0
  v_mov_b32 v63, 0
  v_mov_b32 v64, 0
  v_mov_b32 v65, 0
  v_mov_b32 v66, 0
  v_mov_b32 v67, 0
  v_mov_b32 v68, 0
  v_mov_b32 v69, 0
  v_mov_b32 v70, 0
  v_mov_b32 v71, 0
  v_mov_b32 v72, 0
  v_mov_b32 v73, 0
  v_mov_b32 v74, 0
  v_mov_b32 v75, 0
  v_mov_b32 v76, 0
  v_mov_b32 v77, 0
  v_mov_b32 v78, 0
  v_mov_b32 v79, 0
  v_mov_b32 v80, 0
  v_mov_b32 v81, 0
  v_mov_b32 v82, 0
  v_mov_b32 v83, 0
  v_mov_b32 v84, 0
  v_mov_b32 v85, 0
  v_mov_b32 v86, 0
  v_mov_b32 v87, 0
  s_waitcnt vmcnt(4)
  v_mfma_f32_32x32x16_bf16 v[88:103], v[136:139], v[8:11], v[24:39]
  v_mfma_f32_32x32x16_bf16 v[88:103], v[140:143], v[12:15], v[88:103]
  s_nop 11
  v_exp_f32 v88, v88
  v_exp_f32 v89, v89
  v_exp_f32 v90, v90
  v_exp_f32 v91, v91
  v_exp_f32 v92, v92
  v_exp_f32 v93, v93
  v_exp_f32 v94, v94
  v_exp_f32 v95, v95
  v_mfma_f32_32x32x16_bf16 v[104:119], v[136:139], v[16:19], v[40:55]
  v_cvt_pk_bf16_f32 v120, v88, v89
  v_cvt_pk_bf16_f32 v121, v90, v91
  v_cvt_pk_bf16_f32 v122, v92, v93
  v_cvt_pk_bf16_f32 v123, v94, v95
  v_exp_f32 v96, v96
  v_exp_f32 v97, v97
  v_mfma_f32_32x32x16_bf16 v[104:119], v[140:143], v[20:23], v[104:119]
  v_exp_f32 v98, v98
  v_exp_f32 v99, v99
  v_exp_f32 v100, v100
  v_exp_f32 v101, v101
  v_mfma_f32_32x32x16_bf16 v[56:71], v[144:147], v[120:123], v[56:71]
  v_exp_f32 v102, v102
  v_exp_f32 v103, v103
  v_cvt_pk_bf16_f32 v124, v96, v97
  v_cvt_pk_bf16_f32 v125, v98, v99
  v_cvt_pk_bf16_f32 v126, v100, v101
  v_cvt_pk_bf16_f32 v127, v102, v103
  buffer_load_dwordx4 v[168:171], v1, s[4:7], s25 offen
  buffer_load_dwordx4 v[172:175], v1, s[4:7], s25 offen offset:1024
  buffer_load_dwordx4 v[176:179], v1, s[4:7], s26 offen
  buffer_load_dwordx4 v[180:183], v1, s[4:7], s26 offen offset:1024
  s_add_u32 s25, s25, 2048
  s_add_u32 s26, s26, 2048
  s_waitcnt vmcnt(4)
  v_exp_f32 v104, v104
  v_exp_f32 v105, v105
  v_exp_f32 v106, v106
  v_exp_f32 v107, v107
  v_mfma_f32_32x32x16_bf16 v[56:71], v[148:151], v[124:127], v[56:71]
  v_exp_f32 v108, v108
  v_exp_f32 v109, v109
  v_exp_f32 v110, v110
  v_exp_f32 v111, v111
  v_mfma_f32_32x32x16_bf16 v[88:103], v[152:155], v[8:11], v[24:39]
  v_cvt_pk_bf16_f32 v128, v104, v105
  v_cvt_pk_bf16_f32 v129, v106, v107
  v_cvt_pk_bf16_f32 v130, v108, v109
  v_cvt_pk_bf16_f32 v131, v110, v111
  v_exp_f32 v112, v112
  v_exp_f32 v113, v113
  v_mfma_f32_32x32x16_bf16 v[88:103], v[156:159], v[12:15], v[88:103]
  v_exp_f32 v114, v114
  v_exp_f32 v115, v115
  v_exp_f32 v116, v116
  v_exp_f32 v117, v117
  v_mfma_f32_32x32x16_bf16 v[72:87], v[144:147], v[128:131], v[72:87]
  v_exp_f32 v118, v118
  v_exp_f32 v119, v119
  v_cvt_pk_bf16_f32 v132, v112, v113
  v_cvt_pk_bf16_f32 v133, v114, v115
  v_cvt_pk_bf16_f32 v134, v116, v117
  v_cvt_pk_bf16_f32 v135, v118, v119
  s_mov_b32 s27, 0
attnb_loop3:
  v_exp_f32 v88, v88
  v_exp_f32 v89, v89
  v_exp_f32 v90, v90
  v_exp_f32 v91, v91
  v_mfma_f32_32x32x16_bf16 v[72:87], v[148:151], v[132:135], v[72:87]
  v_exp_f32 v92, v92
  v_exp_f32 v93, v93
  v_exp_f32 v94, v94
  v_exp_f32 v95, v95
  v_mfma_f32_32x32x16_bf16 v[104:119], v[152:155], v[16:19], v[40:55]
  v_cvt_pk_bf16_f32 v120, v88, v89
  v_cvt_pk_bf16_f32 v121, v90, v91
  v_cvt_pk_bf16_f32 v122, v92, v93
  v_cvt_pk_bf16_f32 v123, v94, v95
  v_exp_f32 v96, v96
  v_exp_f32 v97, v97
  v_mfma_f32_32x32x16_bf16 v[104:119], v[156:159], v[20:23], v[104:119]
  v_exp_f32 v98, v98
  v_exp_f32 v99, v99
  v_exp_f32 v100, v100
  v_exp_f32 v101, v101
  v_mfma_f32_32x32x16_bf16 v[56:71], v[160:163], v[120:123], v[56:71]
  v_exp_f32 v102, v102
  v_exp_f32 v103, v103
  v_cvt_pk_bf16_f32 v124, v96, v97
  v_cvt_pk_bf16_f32 v125, v98, v99
  v_cvt_pk_bf16_f32 v126, v100, v101
  v_cvt_pk_bf16_f32 v127, v102, v103
  buffer_load_dwordx4 v[136:139], v1, s[4:7], s25 offen
  buffer_load_dwordx4 v[140:143], v1, s[4:7], s25 offen offset:1024
  buffer_load_dwordx4 v[144:147], v1, s[4:7], s26 offen
  buffer_load_dwordx4 v[148:151], v1, s[4:7], s26 offen offset:1024
  s_add_u32 s25, s25, 2048
  s_add_u32 s26, s26, 2048
  s_waitcnt vmcnt(4)
  v_exp_f32 v104, v104
  v_exp_f32 v105, v105
  v_exp_f32 v106, v106
  v_exp_f32 v107, v107
  v_mfma_f32_32x32x16_bf16 v[56:71], v[164:167], v[124:127], v[56:71]
  v_exp_f32 v108, v108
  v_exp_f32 v109, v109
  v_exp_f32 v110, v110
  v_exp_f32 v111, v111
  v_mfma_f32_32x32x16_bf16 v[88:103], v[168:171], v[8:11], v[24:39]
  v_cvt_pk_bf16_f32 v128, v104, v105
  v_cvt_pk_bf16_f32 v129, v106, v107
  v_cvt_pk_bf16_f32 v130, v108, v109
  v_cvt_pk_bf16_f32 v131, v110, v111
  v_exp_f32 v112, v112
  v_exp_f32 v113, v113
  v_mfma_f32_32x32x16_bf16 v[88:103], v[172:175], v[12:15], v[88:103]
  v_exp_f32 v114, v114
  v_exp_f32 v115, v115
  v_exp_f32 v116, v116
  v_exp_f32 v117, v117
  v_mfma_f32_32x32x16_bf16 v[72:87], v[160:163], v[128:131], v[72:87]
  v_exp_f32 v118, v118
  v_exp_f32 v119, v119
  v_cvt_pk_bf16_f32 v132, v112, v113
  v_cvt_pk_bf16_f32 v133, v114, v115
  v_cvt_pk_bf16_f32 v134, v116, v117
  v_cvt_pk_bf16_f32 v135, v118, v119
  s_nop 0
  v_exp_f32 v88, v88
  v_exp_f32 v89, v89
  v_exp_f32 v90, v90
  v_exp_f32 v91, v91
  v_mfma_f32_32x32x16_bf16 v[72:87], v[164:167], v[132:135], v[72:87]
  v_exp_f32 v92, v92
  v_exp_f32 v93, v93
  v_exp_f32 v94, v94
  v_exp_f32 v95, v95
  v_mfma_f32_32x32x16_bf16 v[104:119], v[168:171], v[16:19], v[40:55]
  v_cvt_pk_bf16_f32 v120, v88, v89
  v_cvt_pk_bf16_f32 v121, v90, v91
  v_cvt_pk_bf16_f32 v122, v92, v93
  v_cvt_pk_bf16_f32 v123, v94, v95
  v_exp_f32 v96, v96
  v_exp_f32 v97, v97
  v_mfma_f32_32x32x16_bf16 v[104:119], v[172:175], v[20:23], v[104:119]
  v_exp_f32 v98, v98
  v_exp_f32 v99, v99
  v_exp_f32 v100, v100
  v_exp_f32 v101, v101
  v_mfma_f32_32x32x16_bf16 v[56:71], v[176:179], v[120:123], v[56:71]
  v_exp_f32 v102, v102
  v_exp_f32 v103, v103
  v_cvt_pk_bf16_f32 v124, v96, v97
  v_cvt_pk_bf16_f32 v125, v98, v99
  v_cvt_pk_bf16_f32 v126, v100, v101
  v_cvt_pk_bf16_f32 v127, v102, v103
  buffer_load_dwordx4 v[152:155], v1, s[4:7], s25 offen
  buffer_load_dwordx4 v[156:159], v1, s[4:7], s25 offen offset:1024
  buffer_load_dwordx4 v[160:163], v1, s[4:7], s26 offen
  buffer_load_dwordx4 v[164:167], v1, s[4:7], s26 offen offset:1024
  s_add_u32 s25, s25, 2048
  s_add_u32 s26, s26, 2048
  s_waitcnt vmcnt(4)
  v_exp_f32 v104, v104
  v_exp_f32 v105, v105
  v_exp_f32 v106, v106
  v_exp_f32 v107, v107
  v_mfma_f32_32x32x16_bf16 v[56:71], v[180:183], v[124:127], v[56:71]
  v_exp_f32 v108, v108
  v_exp_f32 v109, v109
  v_exp_f32 v110, v110
  v_exp_f32 v111, v111
  v_mfma_f32_32x32x16_bf16 v[88:103], v[136:139], v[8:11], v[24:39]
  v_cvt_pk_bf16_f32 v128, v104, v105
  v_cvt_pk_bf16_f32 v129, v106, v107
  v_cvt_pk_bf16_f32 v130, v108, v109
  v_cvt_pk_bf16_f32 v131, v110, v111
  v_exp_f32 v112, v112
  v_exp_f32 v113, v113
  v_mfma_f32_32x32x16_bf16 v[88:103], v[140:143], v[12:15], v[88:103]
  v_exp_f32 v114, v114
  v_exp_f32 v115, v115
  v_exp_f32 v116, v116
  v_exp_f32 v117, v117
  v_mfma_f32_32x32x16_bf16 v[72:87], v[176:179], v[128:131], v[72:87]
  v_exp_f32 v118, v118
  v_exp_f32 v119, v119
  v_cvt_pk_bf16_f32 v132, v112, v113
  v_cvt_pk_bf16_f32 v133, v114, v115
  v_cvt_pk_bf16_f32 v134, v116, v117
  v_cvt_pk_bf16_f32 v135, v118, v119
  s_nop 0
  v_exp_f32 v88, v88
  v_exp_f32 v89, v89
  v_exp_f32 v90, v90
  v_exp_f32 v91, v91
  v_mfma_f32_32x32x16_bf16 v[72:87], v[180:183], v[132:135], v[72:87]
  v_exp_f32 v92, v92
  v_exp_f32 v93, v93
  v_exp_f32 v94, v94
  v_exp_f32 v95, v95
  v_mfma_f32_32x32x16_bf16 v[104:119], v[136:139], v[16:19], v[40:55]
  v_cvt_pk_bf16_f32 v120, v88, v89
  v_cvt_pk_bf16_f32 v121, v90, v91
  v_cvt_pk_bf16_f32 v122, v92, v93
  v_cvt_pk_bf16_f32 v123, v94, v95
  v_exp_f32 v96, v96
  v_exp_f32 v97, v97
  v_mfma_f32_32x32x16_bf16 v[104:119], v[140:143], v[20:23], v[104:119]
  v_exp_f32 v98, v98
  v_exp_f32 v99, v99
  v_exp_f32 v100, v100
  v_exp_f32 v101, v101
  v_mfma_f32_32x32x16_bf16 v[56:71], v[144:147], v[120:123], v[56:71]
  v_exp_f32 v102, v102
  v_exp_f32 v103, v103
  v_cvt_pk_bf16_f32 v124, v96, v97
  v_cvt_pk_bf16_f32 v125, v98, v99
  v_cvt_pk_bf16_f32 v126, v100, v101
  v_cvt_pk_bf16_f32 v127, v102, v103
  buffer_load_dwordx4 v[168:171], v1, s[4:7], s25 offen
  buffer_load_dwordx4 v[172:175], v1, s[4:7], s25 offen offset:1024
  buffer_load_dwordx4 v[176:179], v1, s[4:7], s26 offen
  buffer_load_dwordx4 v[180:183], v1, s[4:7], s26 offen offset:1024
  s_add_u32 s25, s25, 2048
  s_add_u32 s26, s26, 2048
  s_waitcnt vmcnt(4)
  v_exp_f32 v104, v104
  v_exp_f32 v105, v105
  v_exp_f32 v106, v106
  v_exp_f32 v107, v107
  v_mfma_f32_32x32x16_bf16 v[56:71], v[148:151], v[124:127], v[56:71]
  v_exp_f32 v108, v108
  v_exp_f32 v109, v109
  v_exp_f32 v110, v110
  v_exp_f32 v111, v111
  v_mfma_f32_32x32x16_bf16 v[88:103], v[152:155], v[8:11], v[24:39]
  v_cvt_pk_bf16_f32 v128, v104, v105
  v_cvt_pk_bf16_f32 v129, v106, v107
  v_cvt_pk_bf16_f32 v130, v108, v109
  v_cvt_pk_bf16_f32 v131, v110, v111
  v_exp_f32 v112, v112
  v_exp_f32 v113, v113
  v_mfma_f32_32x32x16_bf16 v[88:103], v[156:159], v[12:15], v[88:103]
  v_exp_f32 v114, v114
  v_exp_f32 v115, v115
  v_exp_f32 v116, v116
  v_exp_f32 v117, v117
  v_mfma_f32_32x32x16_bf16 v[72:87], v[144:147], v[128:131], v[72:87]
  v_exp_f32 v118, v118
  v_exp_f32 v119, v119
  v_cvt_pk_bf16_f32 v132, v112, v113
  v_cvt_pk_bf16_f32 v133, v114, v115
  v_cvt_pk_bf16_f32 v134, v116, v117
  v_cvt_pk_bf16_f32 v135, v118, v119
  s_add_u32 s27, s27, 1
  s_cmp_lt_u32 s27, 20
  s_cbranch_scc1 attnb_loop3
  v_exp_f32 v88, v88
  v_exp_f32 v89, v89
  v_exp_f32 v90, v90
  v_exp_f32 v91, v91
  v_mfma_f32_32x32x16_bf16 v[72:87], v[148:151], v[132:135], v[72:87]
  v_exp_f32 v92, v92
  v_exp_f32 v93, v93
  v_exp_f32 v94, v94
  v_exp_f32 v95, v95
  v_mfma_f32_32x32x16_bf16 v[104:119], v[152:155], v[16:19], v[40:55]
  v_cvt_pk_bf16_f32 v120, v88, v89
  v_cvt_pk_bf16_f32 v121, v90, v91
  v_cvt_pk_bf16_f32 v122, v92, v93
  v_cvt_pk_bf16_f32 v123, v94, v95
  v_exp_f32 v96, v96
  v_exp_f32 v97, v97
  v_mfma_f32_32x32x16_bf16 v[104:119], v[156:159], v[20:23], v[104:119]
  v_exp_f32 v98, v98
  v_exp_f32 v99, v99
  v_exp_f32 v100, v100
  v_exp_f32 v101, v101
  v_mfma_f32_32x32x16_bf16 v[56:71], v[160:163], v[120:123], v[56:71]
  v_exp_f32 v102, v102
  v_exp_f32 v103, v103
  v_cvt_pk_bf16_f32 v124, v96, v97
  v_cvt_pk_bf16_f32 v125, v98, v99
  v_cvt_pk_bf16_f32 v126, v100, v101
  v_cvt_pk_bf16_f32 v127, v102, v103
  buffer_load_dwordx4 v[136:139], v1, s[4:7], s25 offen
  buffer_load_dwordx4 v[140:143], v1, s[4:7], s25 offen offset:1024
  buffer_load_dwordx4 v[144:147], v1, s[4:7], s26 offen
  buffer_load_dwordx4 v[148:151], v1, s[4:7], s26 offen offset:1024
  s_add_u32 s25, s25, 2048
  s_add_u32 s26, s26, 2048
  s_waitcnt vmcnt(4)
  v_exp_f32 v104, v104
  v_exp_f32 v105, v105
  v_exp_f32 v106, v106
  v_exp_f32 v107, v107
  v_mfma_f32_32x32x16_bf16 v[56:71], v[164:167], v[124:127], v[56:71]
  v_exp_f32 v108, v108
  v_exp_f32 v109, v109
  v_exp_f32 v110, v110
  v_exp_f32 v111, v111
  v_mfma_f32_32x32x16_bf16 v[88:103], v[168:171], v[8:11], v[24:39]
  v_cvt_pk_bf16_f32 v128, v104, v105
  v_cvt_pk_bf16_f32 v129, v106, v107
  v_cvt_pk_bf16_f32 v130, v108, v109
  v_cvt_pk_bf16_f32 v131, v110, v111
  v_exp_f32 v112, v112
  v_exp_f32 v113, v113
  v_mfma_f32_32x32x16_bf16 v[88:103], v[172:175], v[12:15], v[88:103]
  v_exp_f32 v114, v114
  v_exp_f32 v115, v115
  v_exp_f32 v116, v116
  v_exp_f32 v117, v117
  v_mfma_f32_32x32x16_bf16 v[72:87], v[160:163], v[128:131], v[72:87]
  v_exp_f32 v118, v118
  v_exp_f32 v119, v119
  v_cvt_pk_bf16_f32 v132, v112, v113
  v_cvt_pk_bf16_f32 v133, v114, v115
  v_cvt_pk_bf16_f32 v134, v116, v117
  v_cvt_pk_bf16_f32 v135, v118, v119
  s_nop 0
  v_exp_f32 v88, v88
  v_exp_f32 v89, v89
  v_exp_f32 v90, v90
  v_exp_f32 v91, v91
  v_mfma_f32_32x32x16_bf16 v[72:87], v[164:167], v[132:135], v[72:87]
  v_exp_f32 v92, v92
  v_exp_f32 v93, v93
  v_exp_f32 v94, v94
  v_exp_f32 v95, v95
  v_mfma_f32_32x32x16_bf16 v[104:119], v[168:171], v[16:19], v[40:55]
  v_cvt_pk_bf16_f32 v120, v88, v89
  v_cvt_pk_bf16_f32 v121, v90, v91
  v_cvt_pk_bf16_f32 v122, v92, v93
  v_cvt_pk_bf16_f32 v123, v94, v95
  v_exp_f32 v96, v96
  v_exp_f32 v97, v97
  v_mfma_f32_32x32x16_bf16 v[104:119], v[172:175], v[20:23], v[104:119]
  v_exp_f32 v98, v98
  v_exp_f32 v99, v99
  v_exp_f32 v100, v100
  v_exp_f32 v101, v101
  v_mfma_f32_32x32x16_bf16 v[56:71], v[176:179], v[120:123], v[56:71]
  v_exp_f32 v102, v102
  v_exp_f32 v103, v103
  v_cvt_pk_bf16_f32 v124, v96, v97
  v_cvt_pk_bf16_f32 v125, v98, v99
  v_cvt_pk_bf16_f32 v126, v100, v101
  v_cvt_pk_bf16_f32 v127, v102, v103
  s_waitcnt vmcnt(0)
  v_exp_f32 v104, v104
  v_exp_f32 v105, v105
  v_exp_f32 v106, v106
  v_exp_f32 v107, v107
  v_mfma_f32_32x32x16_bf16 v[56:71], v[180:183], v[124:127], v[56:71]
  v_exp_f32 v108, v108
  v_exp_f32 v109, v109
  v_exp_f32 v110, v110
  v_exp_f32 v111, v111
  v_mfma_f32_32x32x16_bf16 v[88:103], v[136:139], v[8:11], v[24:39]
  v_cvt_pk_bf16_f32 v128, v104, v105
  v_cvt_pk_bf16_f32 v129, v106, v107
  v_cvt_pk_bf16_f32 v130, v108, v109
  v_cvt_pk_bf16_f32 v131, v110, v111
  v_exp_f32 v112, v112
  v_exp_f32 v113, v113
  v_mfma_f32_32x32x16_bf16 v[88:103], v[140:143], v[12:15], v[88:103]
  v_exp_f32 v114, v114
  v_exp_f32 v115, v115
  v_exp_f32 v116, v116
  v_exp_f32 v117, v117
  v_mfma_f32_32x32x16_bf16 v[72:87], v[176:179], v[128:131], v[72:87]
  v_exp_f32 v118, v118
  v_exp_f32 v119, v119
  v_cvt_pk_bf16_f32 v132, v112, v113
  v_cvt_pk_bf16_f32 v133, v114, v115
  v_cvt_pk_bf16_f32 v134, v116, v117
  v_cvt_pk_bf16_f32 v135, v118, v119
  s_nop 0
  v_exp_f32 v88, v88
  v_exp_f32 v89, v89
  v_exp_f32 v90, v90
  v_exp_f32 v91, v91
  v_mfma_f32_32x32x16_bf16 v[72:87], v[180:183], v[132:135], v[72:87]
  v_exp_f32 v92, v92
  v_exp_f32 v93, v93
  v_exp_f32 v94, v94
  v_exp_f32 v95, v95
  v_mfma_f32_32x32x16_bf16 v[104:119], v[136:139], v[16:19], v[40:55]
  v_cvt_pk_bf16_f32 v120, v88, v89
  v_cvt_pk_bf16_f32 v121, v90, v91
  v_cvt_pk_bf16_f32 v122, v92, v93
  v_cvt_pk_bf16_f32 v123, v94, v95
  v_exp_f32 v96, v96
  v_exp_f32 v97, v97
  v_mfma_f32_32x32x16_bf16 v[104:119], v[140:143], v[20:23], v[104:119]
  v_exp_f32 v98, v98
  v_exp_f32 v99, v99
  v_exp_f32 v100, v100
  v_exp_f32 v101, v101
  v_mfma_f32_32x32x16_bf16 v[56:71], v[144:147], v[120:123], v[56:71]
  v_exp_f32 v102, v102
  v_exp_f32 v103, v103
  v_cvt_pk_bf16_f32 v124, v96, v97
  v_cvt_pk_bf16_f32 v125, v98, v99
  v_cvt_pk_bf16_f32 v126, v100, v101
  v_cvt_pk_bf16_f32 v127, v102, v103
  s_nop 0
  v_exp_f32 v104, v104
  v_exp_f32 v105, v105
  v_exp_f32 v106, v106
  v_exp_f32 v107, v107
  v_mfma_f32_32x32x16_bf16 v[56:71], v[148:151], v[124:127], v[56:71]
  v_exp_f32 v108, v108
  v_exp_f32 v109, v109
  v_exp_f32 v110, v110
  v_exp_f32 v111, v111
  v_cvt_pk_bf16_f32 v128, v104, v105
  v_cvt_pk_bf16_f32 v129, v106, v107
  v_cvt_pk_bf16_f32 v130, v108, v109
  v_cvt_pk_bf16_f32 v131, v110, v111
  v_exp_f32 v112, v112
  v_exp_f32 v113, v113
  v_exp_f32 v114, v114
  v_exp_f32 v115, v115
  v_exp_f32 v116, v116
  v_exp_f32 v117, v117
  v_mfma_f32_32x32x16_bf16 v[72:87], v[144:147], v[128:131], v[72:87]
  v_exp_f32 v118, v118
  v_exp_f32 v119, v119
  v_cvt_pk_bf16_f32 v132, v112, v113
  v_cvt_pk_bf16_f32 v133, v114, v115
  v_cvt_pk_bf16_f32 v134, v116, v117
  v_cvt_pk_bf16_f32 v135, v118, v119
  s_nop 1
  v_mfma_f32_32x32x16_bf16 v[72:87], v[148:151], v[132:135], v[72:87]
  v_mov_b32 v2, v64
  v_mov_b32 v4, v2
  s_nop 1
  v_permlane32_swap_b32 v4, v2
  s_nop 6
  v_mov_b32 v3, v80
  v_mov_b32 v4, v3
  s_nop 1
  v_permlane32_swap_b32 v4, v3
  s_cmp_eq_u32 s28, 1
  s_cbranch_scc1 attnb_done5
  v_max_f32 v4, v2, v3
  v_cmp_nge_f32 vcc, 0x4e800000, v4
  v_cmp_u_f32 s[30:31], v2, v3
  s_nop 3
  s_or_b64 s[32:33], vcc, s[30:31]
  s_movk_i32 s34, 0x207
  v_cmp_class_f32 vcc, v56, s34
  s_nop 3
  s_or_b64 s[32:33], s[32:33], vcc
  v_cmp_class_f32 vcc, v57, s34
  s_nop 3
  s_or_b64 s[32:33], s[32:33], vcc
  v_cmp_class_f32 vcc, v58, s34
  s_nop 3
  s_or_b64 s[32:33], s[32:33], vcc
  v_cmp_class_f32 vcc, v59, s34
  s_nop 3
  s_or_b64 s[32:33], s[32:33], vcc
  v_cmp_class_f32 vcc, v60, s34
  s_nop 3
  s_or_b64 s[32:33], s[32:33], vcc
  v_cmp_class_f32 vcc, v61, s34
  s_nop 3
  s_or_b64 s[32:33], s[32:33], vcc
  v_cmp_class_f32 vcc, v62, s34
  s_nop 3
  s_or_b64 s[32:33], s[32:33], vcc
  v_cmp_class_f32 vcc, v63, s34
  s_nop 3
  s_or_b64 s[32:33], s[32:33], vcc
  v_cmp_class_f32 vcc, v64, s34
  s_nop 3
  s_or_b64 s[32:33], s[32:33], vcc
  v_cmp_class_f32 vcc, v65, s34
  s_nop 3
  s_or_b64 s[32:33], s[32:33], vcc
  v_cmp_class_f32 vcc, v66, s34
  s_nop 3
  s_or_b64 s[32:33], s[32:33], vcc
  v_cmp_class_f32 vcc, v67, s34
  s_nop 3
  s_or_b64 s[32:33], s[32:33], vcc
  v_cmp_class_f32 vcc, v68, s34
  s_nop 3
  s_or_b64 s[32:33], s[32:33], vcc
  v_cmp_class_f32 vcc, v69, s34
  s_nop 3
  s_or_b64 s[32:33], s[32:33], vcc
  v_cmp_class_f32 vcc, v70, s34
  s_nop 3
  s_or_b64 s[32:33], s[32:33], vcc
  v_cmp_class_f32 vcc, v71, s34
  s_nop 3
  s_or_b64 s[32:33], s[32:33], vcc
  v_cmp_class_f32 vcc, v72, s34
  s_nop 3
  s_or_b64 s[32:33], s[32:33], vcc
  v_cmp_class_f32 vcc, v73, s34
  s_nop 3
  s_or_b64 s[32:33], s[32:33], vcc
  v_cmp_class_f32 vcc, v74, s34
  s_nop 3
  s_or_b64 s[32:33], s[32:33], vcc
  v_cmp_class_f32 vcc, v75, s34
  s_nop 3
  s_or_b64 s[32:33], s[32:33], vcc
  v_cmp_class_f32 vcc, v76, s34
  s_nop 3
  s_or_b64 s[32:33], s[32:33], vcc
  v_cmp_class_f32 vcc, v77, s34
  s_nop 3
  s_or_b64 s[32:33], s[32:33], vcc
  v_cmp_class_f32 vcc, v78, s34
  s_nop 3
  s_or_b64 s[32:33], s[32:33], vcc
  v_cmp_class_f32 vcc, v79, s34
  s_nop 3
  s_or_b64 s[32:33], s[32:33], vcc
  v_cmp_class_f32 vcc, v80, s34
  s_nop 3
  s_or_b64 s[32:33], s[32:33], vcc
  v_cmp_class_f32 vcc, v81, s34
  s_nop 3
  s_or_b64 s[32:33], s[32:33], vcc
  v_cmp_class_f32 vcc, v82, s34
  s_nop 3
  s_or_b64 s[32:33], s[32:33], vcc
  v_cmp_class_f32 vcc, v83, s34
  s_nop 3
  s_or_b64 s[32:33], s[32:33], vcc
  v_cmp_class_f32 vcc, v84, s34
  s_nop 3
  s_or_b64 s[32:33], s[32:33], vcc
  v_cmp_class_f32 vcc, v85, s34
  s_nop 3
  s_or_b64 s[32:33], s[32:33], vcc
  v_cmp_class_f32 vcc, v86, s34
  s_nop 3
  s_or_b64 s[32:33], s[32:33], vcc
  v_cmp_class_f32 vcc, v87, s34
  s_nop 3
  s_or_b64 s[32:33], s[32:33], vcc
  s_mov_b64 vcc, s[32:33]
  s_cbranch_vccz attnb_done5
  s_mov_b32 s25, s21
  s_mov_b32 s27, 0
  v_mov_b32 v120, 0xff800000
  v_mov_b32 v121, 0xff800000
attnb_fb4:
  buffer_load_dwordx4 v[136:139], v1, s[4:7], s25 offen
  buffer_load_dwordx4 v[140:143], v1, s[4:7], s25 offen offset:1024
  s_add_u32 s25, s25, 2048
  s_waitcnt vmcnt(0)
  v_mfma_f32_32x32x16_bf16 v[88:103], v[136:139], v[8:11], 0
  v_mfma_f32_32x32x16_bf16 v[88:103], v[140:143], v[12:15], v[88:103]
  v_mfma_f32_32x32x16_bf16 v[104:119], v[136:139], v[16:19], 0
  v_mfma_f32_32x32x16_bf16 v[104:119], v[140:143], v[20:23], v[104:119]
  s_nop 9
  v_max3_f32 v2, v88, v89, v90
  v_max3_f32 v2, v2, v91, v92
  v_max3_f32 v2, v2, v93, v94
  v_max3_f32 v2, v2, v95, v96
  v_max3_f32 v2, v2, v97, v98
  v_max3_f32 v2, v2, v99, v100
  v_max3_f32 v2, v2, v101, v102
  v_max_f32 v2, v2, v103
  v_max_f32 v120, v120, v2
  s_nop 2
  v_max3_f32 v3, v104, v105, v106
  v_max3_f32 v3, v3, v107, v108
  v_max3_f32 v3, v3, v109, v110
  v_max3_f32 v3, v3, v111, v112
  v_max3_f32 v3, v3, v113, v114
  v_max3_f32 v3, v3, v115, v116
  v_max3_f32 v3, v3, v117, v118
  v_max_f32 v3, v3, v119
  v_max_f32 v121, v121, v3
  s_add_u32 s27, s27, 1
  s_cmp_lt_u32 s27, 64
  s_cbranch_scc1 attnb_fb4
  v_mov_b32 v4, v120
  s_nop 1
  v_permlane32_swap_b32 v120, v4
  v_max_f32 v120, v120, v4
  v_sub_f32 v24, 0, v120
  v_sub_f32 v25, 0, v120
  v_sub_f32 v26, 0, v120
  v_sub_f32 v27, 0, v120
  v_sub_f32 v28, 0, v120
  v_sub_f32 v29, 0, v120
  v_sub_f32 v30, 0, v120
  v_sub_f32 v31, 0, v120
  v_sub_f32 v32, 0, v120
  v_sub_f32 v33, 0, v120
  v_sub_f32 v34, 0, v120
  v_sub_f32 v35, 0, v120
  v_sub_f32 v36, 0, v120
  v_sub_f32 v37, 0, v120
  v_sub_f32 v38, 0, v120
  v_sub_f32 v39, 0, v120
  v_mov_b32 v4, v121
  s_nop 1
  v_permlane32_swap_b32 v121, v4
  v_max_f32 v121, v121, v4
  v_sub_f32 v40, 0, v121
  v_sub_f32 v41, 0, v121
  v_sub_f32 v42, 0, v121
  v_sub_f32 v43, 0, v121
  v_sub_f32 v44, 0, v121
  v_sub_f32 v45, 0, v121
  v_sub_f32 v46, 0, v121
  v_sub_f32 v47, 0, v121
  v_sub_f32 v48, 0, v121
  v_sub_f32 v49, 0, v121
  v_sub_f32 v50, 0, v121
  v_sub_f32 v51, 0, v121
  v_sub_f32 v52, 0, v121
  v_sub_f32 v53, 0, v121
  v_sub_f32 v54, 0, v121
  v_sub_f32 v55, 0, v121
  s_mov_b32 s28, 1
  s_branch attnb_main2
attnb_done5:
  v_and_b32 v139, 63, v0
  v_lshrrev_b32 v140, 5, v139
  v_and_b32 v142, 15, v139
  v_lshlrev_b32 v142, 4, v142
  v_bfe_u32 v141, v139, 4, 1
  v_mul_u32_u24 v141, 20480, v141
  v_add_u32 v142, v142, v141
  s_mul_i32 s25, s17, 20
  v_lshlrev_b32 v140, 2, v140
  v_add_u32 v141, s25, v140
  v_add_u32 v141, 0, v141
  v_lshrrev_b32 v136, 5, v141
  v_lshlrev_b32 v136, 10, v136
  v_bfe_u32 v139, v141, 3, 2
  v_lshl_add_u32 v136, v139, 8, v136
  v_bfe_u32 v139, v141, 2, 1
  v_lshl_add_u32 v136, v139, 3, v136
  v_add_u32 v136, v136, v142
  v_add_u32 v141, s25, v140
  v_add_u32 v141, 8, v141
  v_lshrrev_b32 v137, 5, v141
  v_lshlrev_b32 v137, 10, v137
  v_bfe_u32 v139, v141, 3, 2
  v_lshl_add_u32 v137, v139, 8, v137
  v_bfe_u32 v139, v141, 2, 1
  v_lshl_add_u32 v137, v139, 3, v137
  v_add_u32 v137, v137, v142
  v_add_u32 v141, s25, v140
  v_add_u32 v141, 16, v141
  v_lshrrev_b32 v138, 5, v141
  v_lshlrev_b32 v138, 10, v138
  v_bfe_u32 v139, v141, 3, 2
  v_lshl_add_u32 v138, v139, 8, v138
  v_bfe_u32 v139, v141, 2, 1
  v_lshl_add_u32 v138, v139, 3, v138
  v_add_u32 v138, v138, v142
  v_cmp_eq_u32 vcc, 0, v140
  v_mov_b32 v139, 0x80000000
  s_nop 0
  v_cndmask_b32 v138, v139, v138, vcc
  s_mul_i32 s24, s23, 40960
  s_add_u32 s24, s24, 50331648
  v_rcp_f32 v4, v2
  s_nop 0
  v_mul_f32 v56, v56, v4
  v_mul_f32 v57, v57, v4
  v_mul_f32 v58, v58, v4
  v_mul_f32 v59, v59, v4
  v_mul_f32 v60, v60, v4
  v_mul_f32 v61, v61, v4
  v_mul_f32 v62, v62, v4
  v_mul_f32 v63, v63, v4
  v_mul_f32 v64, v64, v4
  v_mul_f32 v65, v65, v4
  v_mul_f32 v66, v66, v4
  v_mul_f32 v67, v67, v4
  v_cvt_pk_bf16_f32 v120, v56, v57
  v_cvt_pk_bf16_f32 v121, v58, v59
  v_cvt_pk_bf16_f32 v122, v60, v61
  v_cvt_pk_bf16_f32 v123, v62, v63
  v_cvt_pk_bf16_f32 v124, v64, v65
  v_cvt_pk_bf16_f32 v125, v66, v67
  buffer_store_dwordx2 v[120:121], v136, s[4:7], s24 offen sc1
  buffer_store_dwordx2 v[122:123], v137, s[4:7], s24 offen sc1
  buffer_store_dwordx2 v[124:125], v138, s[4:7], s24 offen sc1
  v_rcp_f32 v4, v3
  s_nop 0
  v_mul_f32 v72, v72, v4
  v_mul_f32 v73, v73, v4
  v_mul_f32 v74, v74, v4
  v_mul_f32 v75, v75, v4
  v_mul_f32 v76, v76, v4
  v_mul_f32 v77, v77, v4
  v_mul_f32 v78, v78, v4
  v_mul_f32 v79, v79, v4
  v_mul_f32 v80, v80, v4
  v_mul_f32 v81, v81, v4
  v_mul_f32 v82, v82, v4
  v_mul_f32 v83, v83, v4
  v_cvt_pk_bf16_f32 v128, v72, v73
  v_cvt_pk_bf16_f32 v129, v74, v75
  v_cvt_pk_bf16_f32 v130, v76, v77
  v_cvt_pk_bf16_f32 v131, v78, v79
  v_cvt_pk_bf16_f32 v132, v80, v81
  v_cvt_pk_bf16_f32 v133, v82, v83
  s_add_u32 s24, s24, 40960
  buffer_store_dwordx2 v[128:129], v136, s[4:7], s24 offen sc1
  buffer_store_dwordx2 v[130:131], v137, s[4:7], s24 offen sc1
  buffer_store_dwordx2 v[132:133], v138, s[4:7], s24 offen sc1
attnb_exit1:
  s_endpgm
.globl outb1_kernel
.p2align 8
.type outb1_kernel,@function
outb1_kernel:
  s_cmp_ge_u32 s2, 256
  s_cbranch_scc1 outb1_exit1
  s_load_dwordx2 s[12:13], s[0:1], 96
  s_load_dwordx2 s[14:15], s[0:1], 0
  s_load_dwordx2 s[48:49], s[0:1], 80
  v_lshrrev_b32 v3, 6, v0
  v_and_b32 v4, 63, v0
  s_nop 0
  v_readfirstlane_b32 s16, v3
  v_lshlrev_b32 v1, 4, v4
  s_and_b32 s17, s2, 7
  s_lshl_b32 s17, s17, 2
  s_lshr_b32 s18, s2, 3
  s_and_b32 s19, s18, 3
  s_add_u32 s17, s17, s19
  s_lshr_b32 s18, s18, 2
  s_waitcnt lgkmcnt(0)
  s_mov_b32 s4, s12
  s_mov_b32 s5, s13
  s_mov_b32 s6, 0x10000000
  s_mov_b32 s7, 0x20000
  s_mov_b32 s8, s12
  s_mov_b32 s9, s13
  s_mov_b32 s10, 0x10000000
  s_mov_b32 s11, 0x20000
  s_mov_b32 s20, 82313216
  s_mov_b32 s52, s48
  s_mov_b32 s53, s49
  s_mov_b32 s54, 2621440
  s_mov_b32 s55, 0x20000
  s_mul_i32 s21, s18, 5
  s_mul_i32 s21, s21, 20480
  s_add_u32 s24, s21, 90013696
  s_add_u32 s25, s24, 20480
  s_add_u32 s26, s25, 20480
  s_add_u32 s27, s26, 20480
  s_add_u32 s28, s27, 20480
  s_lshl_b32 s21, s17, 2
  s_add_u32 s21, s21, s16
  s_mul_i32 s22, s21, 20480
  s_add_u32 s22, s22, 50331648
  s_lshl_b32 s23, s16, 10
  v_add_u32 v2, s23, v1
  s_mul_i32 s29, s16, 5120
  s_add_u32 m0, s29, 0
  s_nop 0
  buffer_load_dwordx4 v2, s[4:7], s24 offen lds
  s_add_u32 m0, s29, 1024
  s_nop 0
  buffer_load_dwordx4 v2, s[4:7], s25 offen lds
  s_add_u32 m0, s29, 2048
  s_nop 0
  buffer_load_dwordx4 v2, s[4:7], s26 offen lds
  s_add_u32 m0, s29, 3072
  s_nop 0
  buffer_load_dwordx4 v2, s[4:7], s27 offen lds
  s_add_u32 m0, s29, 4096
  s_nop 0
  buffer_load_dwordx4 v2, s[4:7], s28 offen lds
  buffer_load_dwordx4 v[32:35], v1, s[4:7], s22 offen offset:0
  buffer_load_dwordx4 v[36:39], v1, s[4:7], s22 offen offset:1024
  buffer_load_dwordx4 v[40:43], v1, s[4:7], s22 offen offset:2048
  buffer_load_dwordx4 v[44:47], v1, s[4:7], s22 offen offset:3072
  v_add_u32 v2, 0x1000, v2
  s_add_u32 s22, s22, 4096
  s_add_u32 m0, s29, 20480
  s_nop 0
  buffer_load_dwordx4 v2, s[4:7], s24 offen lds
  s_add_u32 m0, s29, 21504
  s_nop 0
  buffer_load_dwordx4 v2, s[4:7], s25 offen lds
  s_add_u32 m0, s29, 22528
  s_nop 0
  buffer_load_dwordx4 v2, s[4:7], s26 offen lds
  s_add_u32 m0, s29, 23552
  s_nop 0
  buffer_load_dwordx4 v2, s[4:7], s27 offen lds
  s_add_u32 m0, s29, 24576
  s_nop 0
  buffer_load_dwordx4 v2, s[4:7], s28 offen lds
  buffer_load_dwordx4 v[48:51], v1, s[4:7], s22 offen offset:0
  buffer_load_dwordx4 v[52:55], v1, s[4:7], s22 offen offset:1024
  buffer_load_dwordx4 v[56:59], v1, s[4:7], s22 offen offset:2048
  buffer_load_dwordx4 v[60:63], v1, s[4:7], s22 offen offset:3072
  v_add_u32 v2, 0x1000, v2
  s_add_u32 s22, s22, 4096
  s_waitcnt vmcnt(9)
  s_barrier
  s_add_u32 m0, s29, 40960
  s_nop 0
  buffer_load_dwordx4 v2, s[4:7], s24 offen lds
  s_add_u32 m0, s29, 41984
  s_nop 0
  buffer_load_dwordx4 v2, s[4:7], s25 offen lds
  s_add_u32 m0, s29, 43008
  s_nop 0
  buffer_load_dwordx4 v2, s[4:7], s26 offen lds
  s_add_u32 m0, s29, 44032
  s_nop 0
  buffer_load_dwordx4 v2, s[4:7], s27 offen lds
  s_add_u32 m0, s29, 45056
  s_nop 0
  buffer_load_dwordx4 v2, s[4:7], s28 offen lds
  buffer_load_dwordx4 v[64:67], v1, s[4:7], s22 offen offset:0
  buffer_load_dwordx4 v[68:71], v1, s[4:7], s22 offen offset:1024
  buffer_load_dwordx4 v[72:75], v1, s[4:7], s22 offen offset:2048
  buffer_load_dwordx4 v[76:79], v1, s[4:7], s22 offen offset:3072
  v_add_u32 v2, 0x1000, v2
  s_add_u32 s22, s22, 4096
  ds_read_b128 v[80:83], v1 offset:0
  ds_read_b128 v[84:87], v1 offset:1024
  ds_read_b128 v[88:91], v1 offset:2048
  ds_read_b128 v[92:95], v1 offset:3072
  ds_read_b128 v[96:99], v1 offset:4096
  ds_read_b128 v[100:103], v1 offset:5120
  ds_read_b128 v[104:107], v1 offset:6144
  ds_read_b128 v[108:111], v1 offset:7168
  ds_read_b128 v[112:115], v1 offset:8192
  ds_read_b128 v[116:119], v1 offset:9216
  s_waitcnt lgkmcnt(5)
  v_mfma_f32_16x16x32_bf16 v[8:11], v[80:83], v[32:35], 0
  v_mfma_f32_16x16x32_bf16 v[12:15], v[84:87], v[32:35], 0
  v_mfma_f32_16x16x32_bf16 v[16:19], v[88:91], v[32:35], 0
  v_mfma_f32_16x16x32_bf16 v[20:23], v[92:95], v[32:35], 0
  v_mfma_f32_16x16x32_bf16 v[24:27], v[96:99], v[32:35], 0
  ds_read_b128 v[80:83], v1 offset:10240
  ds_read_b128 v[84:87], v1 offset:11264
  ds_read_b128 v[88:91], v1 offset:12288
  ds_read_b128 v[92:95], v1 offset:13312
  ds_read_b128 v[96:99], v1 offset:14336
  s_waitcnt lgkmcnt(5)
  v_mfma_f32_16x16x32_bf16 v[8:11], v[100:103], v[36:39], v[8:11]
  v_mfma_f32_16x16x32_bf16 v[12:15], v[104:107], v[36:39], v[12:15]
  v_mfma_f32_16x16x32_bf16 v[16:19], v[108:111], v[36:39], v[16:19]
  v_mfma_f32_16x16x32_bf16 v[20:23], v[112:115], v[36:39], v[20:23]
  v_mfma_f32_16x16x32_bf16 v[24:27], v[116:119], v[36:39], v[24:27]
  ds_read_b128 v[100:103], v1 offset:15360
  ds_read_b128 v[104:107], v1 offset:16384
  ds_read_b128 v[108:111], v1 offset:17408
  ds_read_b128 v[112:115], v1 offset:18432
  ds_read_b128 v[116:119], v1 offset:19456
  s_waitcnt lgkmcnt(5)
  v_mfma_f32_16x16x32_bf16 v[8:11], v[80:83], v[40:43], v[8:11]
  v_mfma_f32_16x16x32_bf16 v[12:15], v[84:87], v[40:43], v[12:15]
  v_mfma_f32_16x16x32_bf16 v[16:19], v[88:91], v[40:43], v[16:19]
  v_mfma_f32_16x16x32_bf16 v[20:23], v[92:95], v[40:43], v[20:23]
  v_mfma_f32_16x16x32_bf16 v[24:27], v[96:99], v[40:43], v[24:27]
  s_waitcnt lgkmcnt(0)
  v_mfma_f32_16x16x32_bf16 v[8:11], v[100:103], v[44:47], v[8:11]
  v_mfma_f32_16x16x32_bf16 v[12:15], v[104:107], v[44:47], v[12:15]
  v_mfma_f32_16x16x32_bf16 v[16:19], v[108:111], v[44:47], v[16:19]
  v_mfma_f32_16x16x32_bf16 v[20:23], v[112:115], v[44:47], v[20:23]
  v_mfma_f32_16x16x32_bf16 v[24:27], v[116:119], v[44:47], v[24:27]
  s_waitcnt vmcnt(9)
  s_barrier
  s_add_u32 m0, s29, 0
  s_nop 0
  buffer_load_dwordx4 v2, s[4:7], s24 offen lds
  s_add_u32 m0, s29, 1024
  s_nop 0
  buffer_load_dwordx4 v2, s[4:7], s25 offen lds
  s_add_u32 m0, s29, 2048
  s_nop 0
  buffer_load_dwordx4 v2, s[4:7], s26 offen lds
  s_add_u32 m0, s29, 3072
  s_nop 0
  buffer_load_dwordx4 v2, s[4:7], s27 offen lds
  s_add_u32 m0, s29, 4096
  s_nop 0
  buffer_load_dwordx4 v2, s[4:7], s28 offen lds
  buffer_load_dwordx4 v[32:35], v1, s[4:7], s22 offen offset:0
  buffer_load_dwordx4 v[36:39], v1, s[4:7], s22 offen offset:1024
  buffer_load_dwordx4 v[40:43], v1, s[4:7], s22 offen offset:2048
  buffer_load_dwordx4 v[44:47], v1, s[4:7], s22 offen offset:3072
  v_add_u32 v2, 0x1000, v2
  s_add_u32 s22, s22, 4096
  ds_read_b128 v[80:83], v1 offset:20480
  ds_read_b128 v[84:87], v1 offset:21504
  ds_read_b128 v[88:91], v1 offset:22528
  ds_read_b128 v[92:95], v1 offset:23552
  ds_read_b128 v[96:99], v1 offset:24576
  ds_read_b128 v[100:103], v1 offset:25600
  ds_read_b128 v[104:107], v1 offset:26624
  ds_read_b128 v[108:111], v1 offset:27648
  ds_read_b128 v[112:115], v1 offset:28672
  ds_read_b128 v[116:119], v1 offset:29696
  s_waitcnt lgkmcnt(5)
  v_mfma_f32_16x16x32_bf16 v[8:11], v[80:83], v[48:51], v[8:11]
  v_mfma_f32_16x16x32_bf16 v[12:15], v[84:87], v[48:51], v[12:15]
  v_mfma_f32_16x16x32_bf16 v[16:19], v[88:91], v[48:51], v[16:19]
  v_mfma_f32_16x16x32_bf16 v[20:23], v[92:95], v[48:51], v[20:23]
  v_mfma_f32_16x16x32_bf16 v[24:27], v[96:99], v[48:51], v[24:27]
  ds_read_b128 v[80:83], v1 offset:30720
  ds_read_b128 v[84:87], v1 offset:31744
  ds_read_b128 v[88:91], v1 offset:32768
  ds_read_b128 v[92:95], v1 offset:33792
  ds_read_b128 v[96:99], v1 offset:34816
  s_waitcnt lgkmcnt(5)
  v_mfma_f32_16x16x32_bf16 v[8:11], v[100:103], v[52:55], v[8:11]
  v_mfma_f32_16x16x32_bf16 v[12:15], v[104:107], v[52:55], v[12:15]
  v_mfma_f32_16x16x32_bf16 v[16:19], v[108:111], v[52:55], v[16:19]
  v_mfma_f32_16x16x32_bf16 v[20:23], v[112:115], v[52:55], v[20:23]
  v_mfma_f32_16x16x32_bf16 v[24:27], v[116:119], v[52:55], v[24:27]
  ds_read_b128 v[100:103], v1 offset:35840
  ds_read_b128 v[104:107], v1 offset:36864
  ds_read_b128 v[108:111], v1 offset:37888
  ds_read_b128 v[112:115], v1 offset:38912
  ds_read_b128 v[116:119], v1 offset:39936
  s_waitcnt lgkmcnt(5)
  v_mfma_f32_16x16x32_bf16 v[8:11], v[80:83], v[56:59], v[8:11]
  v_mfma_f32_16x16x32_bf16 v[12:15], v[84:87], v[56:59], v[12:15]
  v_mfma_f32_16x16x32_bf16 v[16:19], v[88:91], v[56:59], v[16:19]
  v_mfma_f32_16x16x32_bf16 v[20:23], v[92:95], v[56:59], v[20:23]
  v_mfma_f32_16x16x32_bf16 v[24:27], v[96:99], v[56:59], v[24:27]
  s_waitcnt lgkmcnt(0)
  v_mfma_f32_16x16x32_bf16 v[8:11], v[100:103], v[60:63], v[8:11]
  v_mfma_f32_16x16x32_bf16 v[12:15], v[104:107], v[60:63], v[12:15]
  v_mfma_f32_16x16x32_bf16 v[16:19], v[108:111], v[60:63], v[16:19]
  v_mfma_f32_16x16x32_bf16 v[20:23], v[112:115], v[60:63], v[20:23]
  v_mfma_f32_16x16x32_bf16 v[24:27], v[116:119], v[60:63], v[24:27]
  s_waitcnt vmcnt(9)
  s_barrier
  s_add_u32 m0, s29, 20480
  s_nop 0
  buffer_load_dwordx4 v2, s[4:7], s24 offen lds
  s_add_u32 m0, s29, 21504
  s_nop 0
  buffer_load_dwordx4 v2, s[4:7], s25 offen lds
  s_add_u32 m0, s29, 22528
  s_nop 0
  buffer_load_dwordx4 v2, s[4:7], s26 offen lds
  s_add_u32 m0, s29, 23552
  s_nop 0
  buffer_load_dwordx4 v2, s[4:7], s27 offen lds
  s_add_u32 m0, s29, 24576
  s_nop 0
  buffer_load_dwordx4 v2, s[4:7], s28 offen lds
  buffer_load_dwordx4 v[48:51], v1, s[4:7], s22 offen offset:0
  buffer_load_dwordx4 v[52:55], v1, s[4:7], s22 offen offset:1024
  buffer_load_dwordx4 v[56:59], v1, s[4:7], s22 offen offset:2048
  buffer_load_dwordx4 v[60:63], v1, s[4:7], s22 offen offset:3072
  v_add_u32 v2, 0x1000, v2
  s_add_u32 s22, s22, 4096
  ds_read_b128 v[80:83], v1 offset:40960
  ds_read_b128 v[84:87], v1 offset:41984
  ds_read_b128 v[88:91], v1 offset:43008
  ds_read_b128 v[92:95], v1 offset:44032
  ds_read_b128 v[96:99], v1 offset:45056
  ds_read_b128 v[100:103], v1 offset:46080
  ds_read_b128 v[104:107], v1 offset:47104
  ds_read_b128 v[108:111], v1 offset:48128
  ds_read_b128 v[112:115], v1 offset:49152
  ds_read_b128 v[116:119], v1 offset:50176
  s_waitcnt lgkmcnt(5)
  v_mfma_f32_16x16x32_bf16 v[8:11], v[80:83], v[64:67], v[8:11]
  v_mfma_f32_16x16x32_bf16 v[12:15], v[84:87], v[64:67], v[12:15]
  v_mfma_f32_16x16x32_bf16 v[16:19], v[88:91], v[64:67], v[16:19]
  v_mfma_f32_16x16x32_bf16 v[20:23], v[92:95], v[64:67], v[20:23]
  v_mfma_f32_16x16x32_bf16 v[24:27], v[96:99], v[64:67], v[24:27]
  ds_read_b128 v[80:83], v1 offset:51200
  ds_read_b128 v[84:87], v1 offset:52224
  ds_read_b128 v[88:91], v1 offset:53248
  ds_read_b128 v[92:95], v1 offset:54272
  ds_read_b128 v[96:99], v1 offset:55296
  s_waitcnt lgkmcnt(5)
  v_mfma_f32_16x16x32_bf16 v[8:11], v[100:103], v[68:71], v[8:11]
  v_mfma_f32_16x16x32_bf16 v[12:15], v[104:107], v[68:71], v[12:15]
  v_mfma_f32_16x16x32_bf16 v[16:19], v[108:111], v[68:71], v[16:19]
  v_mfma_f32_16x16x32_bf16 v[20:23], v[112:115], v[68:71], v[20:23]
  v_mfma_f32_16x16x32_bf16 v[24:27], v[116:119], v[68:71], v[24:27]
  ds_read_b128 v[100:103], v1 offset:56320
  ds_read_b128 v[104:107], v1 offset:57344
  ds_read_b128 v[108:111], v1 offset:58368
  ds_read_b128 v[112:115], v1 offset:59392
  ds_read_b128 v[116:119], v1 offset:60416
  s_waitcnt lgkmcnt(5)
  v_mfma_f32_16x16x32_bf16 v[8:11], v[80:83], v[72:75], v[8:11]
  v_mfma_f32_16x16x32_bf16 v[12:15], v[84:87], v[72:75], v[12:15]
  v_mfma_f32_16x16x32_bf16 v[16:19], v[88:91], v[72:75], v[16:19]
  v_mfma_f32_16x16x32_bf16 v[20:23], v[92:95], v[72:75], v[20:23]
  v_mfma_f32_16x16x32_bf16 v[24:27], v[96:99], v[72:75], v[24:27]
  s_waitcnt lgkmcnt(0)
  v_mfma_f32_16x16x32_bf16 v[8:11], v[100:103], v[76:79], v[8:11]
  v_mfma_f32_16x16x32_bf16 v[12:15], v[104:107], v[76:79], v[12:15]
  v_mfma_f32_16x16x32_bf16 v[16:19], v[108:111], v[76:79], v[16:19]
  v_mfma_f32_16x16x32_bf16 v[20:23], v[112:115], v[76:79], v[20:23]
  v_mfma_f32_16x16x32_bf16 v[24:27], v[116:119], v[76:79], v[24:27]
  s_waitcnt vmcnt(9)
  s_barrier
  ds_read_b128 v[80:83], v1 offset:0
  ds_read_b128 v[84:87], v1 offset:1024
  ds_read_b128 v[88:91], v1 offset:2048
  ds_read_b128 v[92:95], v1 offset:3072
  ds_read_b128 v[96:99], v1 offset:4096
  ds_read_b128 v[100:103], v1 offset:5120
  ds_read_b128 v[104:107], v1 offset:6144
  ds_read_b128 v[108:111], v1 offset:7168
  ds_read_b128 v[112:115], v1 offset:8192
  ds_read_b128 v[116:119], v1 offset:9216
  s_waitcnt lgkmcnt(5)
  v_mfma_f32_16x16x32_bf16 v[8:11], v[80:83], v[32:35], v[8:11]
  v_mfma_f32_16x16x32_bf16 v[12:15], v[84:87], v[32:35], v[12:15]
  v_mfma_f32_16x16x32_bf16 v[16:19], v[88:91], v[32:35], v[16:19]
  v_mfma_f32_16x16x32_bf16 v[20:23], v[92:95], v[32:35], v[20:23]
  v_mfma_f32_16x16x32_bf16 v[24:27], v[96:99], v[32:35], v[24:27]
  ds_read_b128 v[80:83], v1 offset:10240
  ds_read_b128 v[84:87], v1 offset:11264
  ds_read_b128 v[88:91], v1 offset:12288
  ds_read_b128 v[92:95], v1 offset:13312
  ds_read_b128 v[96:99], v1 offset:14336
  s_waitcnt lgkmcnt(5)
  v_mfma_f32_16x16x32_bf16 v[8:11], v[100:103], v[36:39], v[8:11]
  v_mfma_f32_16x16x32_bf16 v[12:15], v[104:107], v[36:39], v[12:15]
  v_mfma_f32_16x16x32_bf16 v[16:19], v[108:111], v[36:39], v[16:19]
  v_mfma_f32_16x16x32_bf16 v[20:23], v[112:115], v[36:39], v[20:23]
  v_mfma_f32_16x16x32_bf16 v[24:27], v[116:119], v[36:39], v[24:27]
  ds_read_b128 v[100:103], v1 offset:15360
  ds_read_b128 v[104:107], v1 offset:16384
  ds_read_b128 v[108:111], v1 offset:17408
  ds_read_b128 v[112:115], v1 offset:18432
  ds_read_b128 v[116:119], v1 offset:19456
  s_waitcnt lgkmcnt(5)
  v_mfma_f32_16x16x32_bf16 v[8:11], v[80:83], v[40:43], v[8:11]
  v_mfma_f32_16x16x32_bf16 v[12:15], v[84:87], v[40:43], v[12:15]
  v_mfma_f32_16x16x32_bf16 v[16:19], v[88:91], v[40:43], v[16:19]
  v_mfma_f32_16x16x32_bf16 v[20:23], v[92:95], v[40:43], v[20:23]
  v_mfma_f32_16x16x32_bf16 v[24:27], v[96:99], v[40:43], v[24:27]
  s_waitcnt lgkmcnt(0)
  v_mfma_f32_16x16x32_bf16 v[8:11], v[100:103], v[44:47], v[8:11]
  v_mfma_f32_16x16x32_bf16 v[12:15], v[104:107], v[44:47], v[12:15]
  v_mfma_f32_16x16x32_bf16 v[16:19], v[108:111], v[44:47], v[16:19]
  v_mfma_f32_16x16x32_bf16 v[20:23], v[112:115], v[44:47], v[20:23]
  v_mfma_f32_16x16x32_bf16 v[24:27], v[116:119], v[44:47], v[24:27]
  s_waitcnt vmcnt(0)
  s_barrier
  ds_read_b128 v[80:83], v1 offset:20480
  ds_read_b128 v[84:87], v1 offset:21504
  ds_read_b128 v[88:91], v1 offset:22528
  ds_read_b128 v[92:95], v1 offset:23552
  ds_read_b128 v[96:99], v1 offset:24576
  ds_read_b128 v[100:103], v1 offset:25600
  ds_read_b128 v[104:107], v1 offset:26624
  ds_read_b128 v[108:111], v1 offset:27648
  ds_read_b128 v[112:115], v1 offset:28672
  ds_read_b128 v[116:119], v1 offset:29696
  s_waitcnt lgkmcnt(5)
  v_mfma_f32_16x16x32_bf16 v[8:11], v[80:83], v[48:51], v[8:11]
  v_mfma_f32_16x16x32_bf16 v[12:15], v[84:87], v[48:51], v[12:15]
  v_mfma_f32_16x16x32_bf16 v[16:19], v[88:91], v[48:51], v[16:19]
  v_mfma_f32_16x16x32_bf16 v[20:23], v[92:95], v[48:51], v[20:23]
  v_mfma_f32_16x16x32_bf16 v[24:27], v[96:99], v[48:51], v[24:27]
  ds_read_b128 v[80:83], v1 offset:30720
  ds_read_b128 v[84:87], v1 offset:31744
  ds_read_b128 v[88:91], v1 offset:32768
  ds_read_b128 v[92:95], v1 offset:33792
  ds_read_b128 v[96:99], v1 offset:34816
  s_waitcnt lgkmcnt(5)
  v_mfma_f32_16x16x32_bf16 v[8:11], v[100:103], v[52:55], v[8:11]
  v_mfma_f32_16x16x32_bf16 v[12:15], v[104:107], v[52:55], v[12:15]
  v_mfma_f32_16x16x32_bf16 v[16:19], v[108:111], v[52:55], v[16:19]
  v_mfma_f32_16x16x32_bf16 v[20:23], v[112:115], v[52:55], v[20:23]
  v_mfma_f32_16x16x32_bf16 v[24:27], v[116:119], v[52:55], v[24:27]
  ds_read_b128 v[100:103], v1 offset:35840
  ds_read_b128 v[104:107], v1 offset:36864
  ds_read_b128 v[108:111], v1 offset:37888
  ds_read_b128 v[112:115], v1 offset:38912
  ds_read_b128 v[116:119], v1 offset:39936
  s_waitcnt lgkmcnt(5)
  v_mfma_f32_16x16x32_bf16 v[8:11], v[80:83], v[56:59], v[8:11]
  v_mfma_f32_16x16x32_bf16 v[12:15], v[84:87], v[56:59], v[12:15]
  v_mfma_f32_16x16x32_bf16 v[16:19], v[88:91], v[56:59], v[16:19]
  v_mfma_f32_16x16x32_bf16 v[20:23], v[92:95], v[56:59], v[20:23]
  v_mfma_f32_16x16x32_bf16 v[24:27], v[96:99], v[56:59], v[24:27]
  s_waitcnt lgkmcnt(0)
  v_mfma_f32_16x16x32_bf16 v[8:11], v[100:103], v[60:63], v[8:11]
  v_mfma_f32_16x16x32_bf16 v[12:15], v[104:107], v[60:63], v[12:15]
  v_mfma_f32_16x16x32_bf16 v[16:19], v[108:111], v[60:63], v[16:19]
  v_mfma_f32_16x16x32_bf16 v[20:23], v[112:115], v[60:63], v[20:23]
  v_mfma_f32_16x16x32_bf16 v[24:27], v[116:119], v[60:63], v[24:27]
  v_and_b32 v3, 63, v0
  v_and_b32 v4, 15, v3
  v_lshrrev_b32 v3, 4, v3
  s_lshl_b32 s21, s17, 6
  s_lshl_b32 s23, s16, 4
  s_add_u32 s21, s21, s23
  v_add_u32 v4, s21, v4
  v_mul_u32_u24 v6, 1280, v4
  v_lshl_add_u32 v6, v3, 4, v6
  s_mul_i32 s21, s18, 5
  s_add_u32 s23, s21, 0
  s_lshr_b32 s31, s23, 1
  s_lshl_b32 s31, s31, 6
  s_and_b32 s23, s23, 1
  s_lshl_b32 s23, s23, 3
  s_add_u32 s32, s31, s23
  s_add_u32 s40, s32, s20
  buffer_load_dwordx2 v[32:33], v6, s[8:11], s40 offen
  s_add_u32 s23, s21, 1
  s_lshr_b32 s31, s23, 1
  s_lshl_b32 s31, s31, 6
  s_and_b32 s23, s23, 1
  s_lshl_b32 s23, s23, 3
  s_add_u32 s33, s31, s23
  s_add_u32 s41, s33, s20
  buffer_load_dwordx2 v[34:35], v6, s[8:11], s41 offen
  s_add_u32 s23, s21, 2
  s_lshr_b32 s31, s23, 1
  s_lshl_b32 s31, s31, 6
  s_and_b32 s23, s23, 1
  s_lshl_b32 s23, s23, 3
  s_add_u32 s34, s31, s23
  s_add_u32 s42, s34, s20
  buffer_load_dwordx2 v[36:37], v6, s[8:11], s42 offen
  s_add_u32 s23, s21, 3
  s_lshr_b32 s31, s23, 1
  s_lshl_b32 s31, s31, 6
  s_and_b32 s23, s23, 1
  s_lshl_b32 s23, s23, 3
  s_add_u32 s35, s31, s23
  s_add_u32 s43, s35, s20
  buffer_load_dwordx2 v[38:39], v6, s[8:11], s43 offen
  s_add_u32 s23, s21, 4
  s_lshr_b32 s31, s23, 1
  s_lshl_b32 s31, s31, 6
  s_and_b32 s23, s23, 1
  s_lshl_b32 s23, s23, 3
  s_add_u32 s36, s31, s23
  s_add_u32 s44, s36, s20
  buffer_load_dwordx2 v[40:41], v6, s[8:11], s44 offen
  s_waitcnt vmcnt(0)
  v_cvt_pk_bf16_f32 v80, v8, v9
  v_cvt_pk_bf16_f32 v81, v10, v11
  v_lshlrev_b32 v8, 16, v80
  v_and_b32 v9, 0xffff0000, v80
  v_lshlrev_b32 v10, 16, v81
  v_and_b32 v11, 0xffff0000, v81
  v_lshlrev_b32 v82, 16, v32
  v_and_b32 v83, 0xffff0000, v32
  v_lshlrev_b32 v84, 16, v33
  v_and_b32 v85, 0xffff0000, v33
  v_add_f32 v8, v8, v82
  v_add_f32 v9, v9, v83
  v_add_f32 v10, v10, v84
  v_add_f32 v11, v11, v85
  v_cvt_pk_bf16_f32 v32, v8, v9
  v_cvt_pk_bf16_f32 v33, v10, v11
  s_add_u32 s23, s32, 82313216
  buffer_store_dwordx2 v[32:33], v6, s[4:7], s23 offen sc1
  v_cvt_pk_bf16_f32 v80, v12, v13
  v_cvt_pk_bf16_f32 v81, v14, v15
  v_lshlrev_b32 v12, 16, v80
  v_and_b32 v13, 0xffff0000, v80
  v_lshlrev_b32 v14, 16, v81
  v_and_b32 v15, 0xffff0000, v81
  v_lshlrev_b32 v82, 16, v34
  v_and_b32 v83, 0xffff0000, v34
  v_lshlrev_b32 v84, 16, v35
  v_and_b32 v85, 0xffff0000, v35
  v_add_f32 v12, v12, v82
  v_add_f32 v13, v13, v83
  v_add_f32 v14, v14, v84
  v_add_f32 v15, v15, v85
  v_cvt_pk_bf16_f32 v34, v12, v13
  v_cvt_pk_bf16_f32 v35, v14, v15
  s_add_u32 s23, s33, 82313216
  buffer_store_dwordx2 v[34:35], v6, s[4:7], s23 offen sc1
  v_cvt_pk_bf16_f32 v80, v16, v17
  v_cvt_pk_bf16_f32 v81, v18, v19
  v_lshlrev_b32 v16, 16, v80
  v_and_b32 v17, 0xffff0000, v80
  v_lshlrev_b32 v18, 16, v81
  v_and_b32 v19, 0xffff0000, v81
  v_lshlrev_b32 v82, 16, v36
  v_and_b32 v83, 0xffff0000, v36
  v_lshlrev_b32 v84, 16, v37
  v_and_b32 v85, 0xffff0000, v37
  v_add_f32 v16, v16, v82
  v_add_f32 v17, v17, v83
  v_add_f32 v18, v18, v84
  v_add_f32 v19, v19, v85
  v_cvt_pk_bf16_f32 v36, v16, v17
  v_cvt_pk_bf16_f32 v37, v18, v19
  s_add_u32 s23, s34, 82313216
  buffer_store_dwordx2 v[36:37], v6, s[4:7], s23 offen sc1
  v_cvt_pk_bf16_f32 v80, v20, v21
  v_cvt_pk_bf16_f32 v81, v22, v23
  v_lshlrev_b32 v20, 16, v80
  v_and_b32 v21, 0xffff0000, v80
  v_lshlrev_b32 v22, 16, v81
  v_and_b32 v23, 0xffff0000, v81
  v_lshlrev_b32 v82, 16, v38
  v_and_b32 v83, 0xffff0000, v38
  v_lshlrev_b32 v84, 16, v39
  v_and_b32 v85, 0xffff0000, v39
  v_add_f32 v20, v20, v82
  v_add_f32 v21, v21, v83
  v_add_f32 v22, v22, v84
  v_add_f32 v23, v23, v85
  v_cvt_pk_bf16_f32 v38, v20, v21
  v_cvt_pk_bf16_f32 v39, v22, v23
  s_add_u32 s23, s35, 82313216
  buffer_store_dwordx2 v[38:39], v6, s[4:7], s23 offen sc1
  v_cvt_pk_bf16_f32 v80, v24, v25
  v_cvt_pk_bf16_f32 v81, v26, v27
  v_lshlrev_b32 v24, 16, v80
  v_and_b32 v25, 0xffff0000, v80
  v_lshlrev_b32 v26, 16, v81
  v_and_b32 v27, 0xffff0000, v81
  v_lshlrev_b32 v82, 16, v40
  v_and_b32 v83, 0xffff0000, v40
  v_lshlrev_b32 v84, 16, v41
  v_and_b32 v85, 0xffff0000, v41
  v_add_f32 v24, v24, v82
  v_add_f32 v25, v25, v83
  v_add_f32 v26, v26, v84
  v_add_f32 v27, v27, v85
  v_cvt_pk_bf16_f32 v40, v24, v25
  v_cvt_pk_bf16_f32 v41, v26, v27
  s_add_u32 s23, s36, 82313216
  buffer_store_dwordx2 v[40:41], v6, s[4:7], s23 offen sc1
outb1_exit1:
  s_endpgm
.globl outb2_kernel
.p2align 8
.type outb2_kernel,@function
outb2_kernel:
  s_cmp_ge_u32 s2, 256
  s_cbranch_scc1 outb2_exit1
  s_load_dwordx2 s[12:13], s[0:1], 96
  s_load_dwordx2 s[14:15], s[0:1], 0
  s_load_dwordx2 s[48:49], s[0:1], 80
  v_lshrrev_b32 v3, 6, v0
  v_and_b32 v4, 63, v0
  s_nop 0
  v_readfirstlane_b32 s16, v3
  v_lshlrev_b32 v1, 4, v4
  s_and_b32 s17, s2, 7
  s_lshl_b32 s17, s17, 2
  s_lshr_b32 s18, s2, 3
  s_and_b32 s19, s18, 3
  s_add_u32 s17, s17, s19
  s_lshr_b32 s18, s18, 2
  s_waitcnt lgkmcnt(0)
  s_mov_b32 s4, s12
  s_mov_b32 s5, s13
  s_mov_b32 s6, 0x10000000
  s_mov_b32 s7, 0x20000
  s_mov_b32 s8, s12
  s_mov_b32 s9, s13
  s_mov_b32 s10, 0x10000000
  s_mov_b32 s11, 0x20000
  s_mov_b32 s20, 82313216
  s_mov_b32 s52, s48
  s_mov_b32 s53, s49
  s_mov_b32 s54, 2621440
  s_mov_b32 s55, 0x20000
  s_mul_i32 s21, s18, 5
  s_mul_i32 s21, s21, 20480
  s_add_u32 s24, s21, 90013696
  s_add_u32 s25, s24, 20480
  s_add_u32 s26, s25, 20480
  s_add_u32 s27, s26, 20480
  s_add_u32 s28, s27, 20480
  s_lshl_b32 s21, s17, 2
  s_add_u32 s21, s21, s16
  s_mul_i32 s22, s21, 20480
  s_add_u32 s22, s22, 50331648
  s_lshl_b32 s23, s16, 10
  v_add_u32 v2, s23, v1
  s_mul_i32 s29, s16, 5120
  s_add_u32 m0, s29, 0
  s_nop 0
  buffer_load_dwordx4 v2, s[4:7], s24 offen lds
  s_add_u32 m0, s29, 1024
  s_nop 0
  buffer_load_dwordx4 v2, s[4:7], s25 offen lds
  s_add_u32 m0, s29, 2048
  s_nop 0
  buffer_load_dwordx4 v2, s[4:7], s26 offen lds
  s_add_u32 m0, s29, 3072
  s_nop 0
  buffer_load_dwordx4 v2, s[4:7], s27 offen lds
  s_add_u32 m0, s29, 4096
  s_nop 0
  buffer_load_dwordx4 v2, s[4:7], s28 offen lds
  buffer_load_dwordx4 v[32:35], v1, s[4:7], s22 offen offset:0
  buffer_load_dwordx4 v[36:39], v1, s[4:7], s22 offen offset:1024
  buffer_load_dwordx4 v[40:43], v1, s[4:7], s22 offen offset:2048
  buffer_load_dwordx4 v[44:47], v1, s[4:7], s22 offen offset:3072
  v_add_u32 v2, 0x1000, v2
  s_add_u32 s22, s22, 4096
  s_add_u32 m0, s29, 20480
  s_nop 0
  buffer_load_dwordx4 v2, s[4:7], s24 offen lds
  s_add_u32 m0, s29, 21504
  s_nop 0
  buffer_load_dwordx4 v2, s[4:7], s25 offen lds
  s_add_u32 m0, s29, 22528
  s_nop 0
  buffer_load_dwordx4 v2, s[4:7], s26 offen lds
  s_add_u32 m0, s29, 23552
  s_nop 0
  buffer_load_dwordx4 v2, s[4:7], s27 offen lds
  s_add_u32 m0, s29, 24576
  s_nop 0
  buffer_load_dwordx4 v2, s[4:7], s28 offen lds
  buffer_load_dwordx4 v[48:51], v1, s[4:7], s22 offen offset:0
  buffer_load_dwordx4 v[52:55], v1, s[4:7], s22 offen offset:1024
  buffer_load_dwordx4 v[56:59], v1, s[4:7], s22 offen offset:2048
  buffer_load_dwordx4 v[60:63], v1, s[4:7], s22 offen offset:3072
  v_add_u32 v2, 0x1000, v2
  s_add_u32 s22, s22, 4096
  s_waitcnt vmcnt(9)
  s_barrier
  s_add_u32 m0, s29, 40960
  s_nop 0
  buffer_load_dwordx4 v2, s[4:7], s24 offen lds
  s_add_u32 m0, s29, 41984
  s_nop 0
  buffer_load_dwordx4 v2, s[4:7], s25 offen lds
  s_add_u32 m0, s29, 43008
  s_nop 0
  buffer_load_dwordx4 v2, s[4:7], s26 offen lds
  s_add_u32 m0, s29, 44032
  s_nop 0
  buffer_load_dwordx4 v2, s[4:7], s27 offen lds
  s_add_u32 m0, s29, 45056
  s_nop 0
  buffer_load_dwordx4 v2, s[4:7], s28 offen lds
  buffer_load_dwordx4 v[64:67], v1, s[4:7], s22 offen offset:0
  buffer_load_dwordx4 v[68:71], v1, s[4:7], s22 offen offset:1024
  buffer_load_dwordx4 v[72:75], v1, s[4:7], s22 offen offset:2048
  buffer_load_dwordx4 v[76:79], v1, s[4:7], s22 offen offset:3072
  v_add_u32 v2, 0x1000, v2
  s_add_u32 s22, s22, 4096
  ds_read_b128 v[80:83], v1 offset:0
  ds_read_b128 v[84:87], v1 offset:1024
  ds_read_b128 v[88:91], v1 offset:2048
  ds_read_b128 v[92:95], v1 offset:3072
  ds_read_b128 v[96:99], v1 offset:4096
  ds_read_b128 v[100:103], v1 offset:5120
  ds_read_b128 v[104:107], v1 offset:6144
  ds_read_b128 v[108:111], v1 offset:7168
  ds_read_b128 v[112:115], v1 offset:8192
  ds_read_b128 v[116:119], v1 offset:9216
  s_waitcnt lgkmcnt(5)
  v_mfma_f32_16x16x32_bf16 v[8:11], v[80:83], v[32:35], 0
  v_mfma_f32_16x16x32_bf16 v[12:15], v[84:87], v[32:35], 0
  v_mfma_f32_16x16x32_bf16 v[16:19], v[88:91], v[32:35], 0
  v_mfma_f32_16x16x32_bf16 v[20:23], v[92:95], v[32:35], 0
  v_mfma_f32_16x16x32_bf16 v[24:27], v[96:99], v[32:35], 0
  ds_read_b128 v[80:83], v1 offset:10240
  ds_read_b128 v[84:87], v1 offset:11264
  ds_read_b128 v[88:91], v1 offset:12288
  ds_read_b128 v[92:95], v1 offset:13312
  ds_read_b128 v[96:99], v1 offset:14336
  s_waitcnt lgkmcnt(5)
  v_mfma_f32_16x16x32_bf16 v[8:11], v[100:103], v[36:39], v[8:11]
  v_mfma_f32_16x16x32_bf16 v[12:15], v[104:107], v[36:39], v[12:15]
  v_mfma_f32_16x16x32_bf16 v[16:19], v[108:111], v[36:39], v[16:19]
  v_mfma_f32_16x16x32_bf16 v[20:23], v[112:115], v[36:39], v[20:23]
  v_mfma_f32_16x16x32_bf16 v[24:27], v[116:119], v[36:39], v[24:27]
  ds_read_b128 v[100:103], v1 offset:15360
  ds_read_b128 v[104:107], v1 offset:16384
  ds_read_b128 v[108:111], v1 offset:17408
  ds_read_b128 v[112:115], v1 offset:18432
  ds_read_b128 v[116:119], v1 offset:19456
  s_waitcnt lgkmcnt(5)
  v_mfma_f32_16x16x32_bf16 v[8:11], v[80:83], v[40:43], v[8:11]
  v_mfma_f32_16x16x32_bf16 v[12:15], v[84:87], v[40:43], v[12:15]
  v_mfma_f32_16x16x32_bf16 v[16:19], v[88:91], v[40:43], v[16:19]
  v_mfma_f32_16x16x32_bf16 v[20:23], v[92:95], v[40:43], v[20:23]
  v_mfma_f32_16x16x32_bf16 v[24:27], v[96:99], v[40:43], v[24:27]
  s_waitcnt lgkmcnt(0)
  v_mfma_f32_16x16x32_bf16 v[8:11], v[100:103], v[44:47], v[8:11]
  v_mfma_f32_16x16x32_bf16 v[12:15], v[104:107], v[44:47], v[12:15]
  v_mfma_f32_16x16x32_bf16 v[16:19], v[108:111], v[44:47], v[16:19]
  v_mfma_f32_16x16x32_bf16 v[20:23], v[112:115], v[44:47], v[20:23]
  v_mfma_f32_16x16x32_bf16 v[24:27], v[116:119], v[44:47], v[24:27]
  s_waitcnt vmcnt(9)
  s_barrier
  s_add_u32 m0, s29, 0
  s_nop 0
  buffer_load_dwordx4 v2, s[4:7], s24 offen lds
  s_add_u32 m0, s29, 1024
  s_nop 0
  buffer_load_dwordx4 v2, s[4:7], s25 offen lds
  s_add_u32 m0, s29, 2048
  s_nop 0
  buffer_load_dwordx4 v2, s[4:7], s26 offen lds
  s_add_u32 m0, s29, 3072
  s_nop 0
  buffer_load_dwordx4 v2, s[4:7], s27 offen lds
  s_add_u32 m0, s29, 4096
  s_nop 0
  buffer_load_dwordx4 v2, s[4:7], s28 offen lds
  buffer_load_dwordx4 v[32:35], v1, s[4:7], s22 offen offset:0
  buffer_load_dwordx4 v[36:39], v1, s[4:7], s22 offen offset:1024
  buffer_load_dwordx4 v[40:43], v1, s[4:7], s22 offen offset:2048
  buffer_load_dwordx4 v[44:47], v1, s[4:7], s22 offen offset:3072
  v_add_u32 v2, 0x1000, v2
  s_add_u32 s22, s22, 4096
  ds_read_b128 v[80:83], v1 offset:20480
  ds_read_b128 v[84:87], v1 offset:21504
  ds_read_b128 v[88:91], v1 offset:22528
  ds_read_b128 v[92:95], v1 offset:23552
  ds_read_b128 v[96:99], v1 offset:24576
  ds_read_b128 v[100:103], v1 offset:25600
  ds_read_b128 v[104:107], v1 offset:26624
  ds_read_b128 v[108:111], v1 offset:27648
  ds_read_b128 v[112:115], v1 offset:28672
  ds_read_b128 v[116:119], v1 offset:29696
  s_waitcnt lgkmcnt(5)
  v_mfma_f32_16x16x32_bf16 v[8:11], v[80:83], v[48:51], v[8:11]
  v_mfma_f32_16x16x32_bf16 v[12:15], v[84:87], v[48:51], v[12:15]
  v_mfma_f32_16x16x32_bf16 v[16:19], v[88:91], v[48:51], v[16:19]
  v_mfma_f32_16x16x32_bf16 v[20:23], v[92:95], v[48:51], v[20:23]
  v_mfma_f32_16x16x32_bf16 v[24:27], v[96:99], v[48:51], v[24:27]
  ds_read_b128 v[80:83], v1 offset:30720
  ds_read_b128 v[84:87], v1 offset:31744
  ds_read_b128 v[88:91], v1 offset:32768
  ds_read_b128 v[92:95], v1 offset:33792
  ds_read_b128 v[96:99], v1 offset:34816
  s_waitcnt lgkmcnt(5)
  v_mfma_f32_16x16x32_bf16 v[8:11], v[100:103], v[52:55], v[8:11]
  v_mfma_f32_16x16x32_bf16 v[12:15], v[104:107], v[52:55], v[12:15]
  v_mfma_f32_16x16x32_bf16 v[16:19], v[108:111], v[52:55], v[16:19]
  v_mfma_f32_16x16x32_bf16 v[20:23], v[112:115], v[52:55], v[20:23]
  v_mfma_f32_16x16x32_bf16 v[24:27], v[116:119], v[52:55], v[24:27]
  ds_read_b128 v[100:103], v1 offset:35840
  ds_read_b128 v[104:107], v1 offset:36864
  ds_read_b128 v[108:111], v1 offset:37888
  ds_read_b128 v[112:115], v1 offset:38912
  ds_read_b128 v[116:119], v1 offset:39936
  s_waitcnt lgkmcnt(5)
  v_mfma_f32_16x16x32_bf16 v[8:11], v[80:83], v[56:59], v[8:11]
  v_mfma_f32_16x16x32_bf16 v[12:15], v[84:87], v[56:59], v[12:15]
  v_mfma_f32_16x16x32_bf16 v[16:19], v[88:91], v[56:59], v[16:19]
  v_mfma_f32_16x16x32_bf16 v[20:23], v[92:95], v[56:59], v[20:23]
  v_mfma_f32_16x16x32_bf16 v[24:27], v[96:99], v[56:59], v[24:27]
  s_waitcnt lgkmcnt(0)
  v_mfma_f32_16x16x32_bf16 v[8:11], v[100:103], v[60:63], v[8:11]
  v_mfma_f32_16x16x32_bf16 v[12:15], v[104:107], v[60:63], v[12:15]
  v_mfma_f32_16x16x32_bf16 v[16:19], v[108:111], v[60:63], v[16:19]
  v_mfma_f32_16x16x32_bf16 v[20:23], v[112:115], v[60:63], v[20:23]
  v_mfma_f32_16x16x32_bf16 v[24:27], v[116:119], v[60:63], v[24:27]
  s_waitcnt vmcnt(9)
  s_barrier
  s_add_u32 m0, s29, 20480
  s_nop 0
  buffer_load_dwordx4 v2, s[4:7], s24 offen lds
  s_add_u32 m0, s29, 21504
  s_nop 0
  buffer_load_dwordx4 v2, s[4:7], s25 offen lds
  s_add_u32 m0, s29, 22528
  s_nop 0
  buffer_load_dwordx4 v2, s[4:7], s26 offen lds
  s_add_u32 m0, s29, 23552
  s_nop 0
  buffer_load_dwordx4 v2, s[4:7], s27 offen lds
  s_add_u32 m0, s29, 24576
  s_nop 0
  buffer_load_dwordx4 v2, s[4:7], s28 offen lds
  buffer_load_dwordx4 v[48:51], v1, s[4:7], s22 offen offset:0
  buffer_load_dwordx4 v[52:55], v1, s[4:7], s22 offen offset:1024
  buffer_load_dwordx4 v[56:59], v1, s[4:7], s22 offen offset:2048
  buffer_load_dwordx4 v[60:63], v1, s[4:7], s22 offen offset:3072
  v_add_u32 v2, 0x1000, v2
  s_add_u32 s22, s22, 4096
  ds_read_b128 v[80:83], v1 offset:40960
  ds_read_b128 v[84:87], v1 offset:41984
  ds_read_b128 v[88:91], v1 offset:43008
  ds_read_b128 v[92:95], v1 offset:44032
  ds_read_b128 v[96:99], v1 offset:45056
  ds_read_b128 v[100:103], v1 offset:46080
  ds_read_b128 v[104:107], v1 offset:47104
  ds_read_b128 v[108:111], v1 offset:48128
  ds_read_b128 v[112:115], v1 offset:49152
  ds_read_b128 v[116:119], v1 offset:50176
  s_waitcnt lgkmcnt(5)
  v_mfma_f32_16x16x32_bf16 v[8:11], v[80:83], v[64:67], v[8:11]
  v_mfma_f32_16x16x32_bf16 v[12:15], v[84:87], v[64:67], v[12:15]
  v_mfma_f32_16x16x32_bf16 v[16:19], v[88:91], v[64:67], v[16:19]
  v_mfma_f32_16x16x32_bf16 v[20:23], v[92:95], v[64:67], v[20:23]
  v_mfma_f32_16x16x32_bf16 v[24:27], v[96:99], v[64:67], v[24:27]
  ds_read_b128 v[80:83], v1 offset:51200
  ds_read_b128 v[84:87], v1 offset:52224
  ds_read_b128 v[88:91], v1 offset:53248
  ds_read_b128 v[92:95], v1 offset:54272
  ds_read_b128 v[96:99], v1 offset:55296
  s_waitcnt lgkmcnt(5)
  v_mfma_f32_16x16x32_bf16 v[8:11], v[100:103], v[68:71], v[8:11]
  v_mfma_f32_16x16x32_bf16 v[12:15], v[104:107], v[68:71], v[12:15]
  v_mfma_f32_16x16x32_bf16 v[16:19], v[108:111], v[68:71], v[16:19]
  v_mfma_f32_16x16x32_bf16 v[20:23], v[112:115], v[68:71], v[20:23]
  v_mfma_f32_16x16x32_bf16 v[24:27], v[116:119], v[68:71], v[24:27]
  ds_read_b128 v[100:103], v1 offset:56320
  ds_read_b128 v[104:107], v1 offset:57344
  ds_read_b128 v[108:111], v1 offset:58368
  ds_read_b128 v[112:115], v1 offset:59392
  ds_read_b128 v[116:119], v1 offset:60416
  s_waitcnt lgkmcnt(5)
  v_mfma_f32_16x16x32_bf16 v[8:11], v[80:83], v[72:75], v[8:11]
  v_mfma_f32_16x16x32_bf16 v[12:15], v[84:87], v[72:75], v[12:15]
  v_mfma_f32_16x16x32_bf16 v[16:19], v[88:91], v[72:75], v[16:19]
  v_mfma_f32_16x16x32_bf16 v[20:23], v[92:95], v[72:75], v[20:23]
  v_mfma_f32_16x16x32_bf16 v[24:27], v[96:99], v[72:75], v[24:27]
  s_waitcnt lgkmcnt(0)
  v_mfma_f32_16x16x32_bf16 v[8:11], v[100:103], v[76:79], v[8:11]
  v_mfma_f32_16x16x32_bf16 v[12:15], v[104:107], v[76:79], v[12:15]
  v_mfma_f32_16x16x32_bf16 v[16:19], v[108:111], v[76:79], v[16:19]
  v_mfma_f32_16x16x32_bf16 v[20:23], v[112:115], v[76:79], v[20:23]
  v_mfma_f32_16x16x32_bf16 v[24:27], v[116:119], v[76:79], v[24:27]
  s_waitcnt vmcnt(9)
  s_barrier
  ds_read_b128 v[80:83], v1 offset:0
  ds_read_b128 v[84:87], v1 offset:1024
  ds_read_b128 v[88:91], v1 offset:2048
  ds_read_b128 v[92:95], v1 offset:3072
  ds_read_b128 v[96:99], v1 offset:4096
  ds_read_b128 v[100:103], v1 offset:5120
  ds_read_b128 v[104:107], v1 offset:6144
  ds_read_b128 v[108:111], v1 offset:7168
  ds_read_b128 v[112:115], v1 offset:8192
  ds_read_b128 v[116:119], v1 offset:9216
  s_waitcnt lgkmcnt(5)
  v_mfma_f32_16x16x32_bf16 v[8:11], v[80:83], v[32:35], v[8:11]
  v_mfma_f32_16x16x32_bf16 v[12:15], v[84:87], v[32:35], v[12:15]
  v_mfma_f32_16x16x32_bf16 v[16:19], v[88:91], v[32:35], v[16:19]
  v_mfma_f32_16x16x32_bf16 v[20:23], v[92:95], v[32:35], v[20:23]
  v_mfma_f32_16x16x32_bf16 v[24:27], v[96:99], v[32:35], v[24:27]
  ds_read_b128 v[80:83], v1 offset:10240
  ds_read_b128 v[84:87], v1 offset:11264
  ds_read_b128 v[88:91], v1 offset:12288
  ds_read_b128 v[92:95], v1 offset:13312
  ds_read_b128 v[96:99], v1 offset:14336
  s_waitcnt lgkmcnt(5)
  v_mfma_f32_16x16x32_bf16 v[8:11], v[100:103], v[36:39], v[8:11]
  v_mfma_f32_16x16x32_bf16 v[12:15], v[104:107], v[36:39], v[12:15]
  v_mfma_f32_16x16x32_bf16 v[16:19], v[108:111], v[36:39], v[16:19]
  v_mfma_f32_16x16x32_bf16 v[20:23], v[112:115], v[36:39], v[20:23]
  v_mfma_f32_16x16x32_bf16 v[24:27], v[116:119], v[36:39], v[24:27]
  ds_read_b128 v[100:103], v1 offset:15360
  ds_read_b128 v[104:107], v1 offset:16384
  ds_read_b128 v[108:111], v1 offset:17408
  ds_read_b128 v[112:115], v1 offset:18432
  ds_read_b128 v[116:119], v1 offset:19456
  s_waitcnt lgkmcnt(5)
  v_mfma_f32_16x16x32_bf16 v[8:11], v[80:83], v[40:43], v[8:11]
  v_mfma_f32_16x16x32_bf16 v[12:15], v[84:87], v[40:43], v[12:15]
  v_mfma_f32_16x16x32_bf16 v[16:19], v[88:91], v[40:43], v[16:19]
  v_mfma_f32_16x16x32_bf16 v[20:23], v[92:95], v[40:43], v[20:23]
  v_mfma_f32_16x16x32_bf16 v[24:27], v[96:99], v[40:43], v[24:27]
  s_waitcnt lgkmcnt(0)
  v_mfma_f32_16x16x32_bf16 v[8:11], v[100:103], v[44:47], v[8:11]
  v_mfma_f32_16x16x32_bf16 v[12:15], v[104:107], v[44:47], v[12:15]
  v_mfma_f32_16x16x32_bf16 v[16:19], v[108:111], v[44:47], v[16:19]
  v_mfma_f32_16x16x32_bf16 v[20:23], v[112:115], v[44:47], v[20:23]
  v_mfma_f32_16x16x32_bf16 v[24:27], v[116:119], v[44:47], v[24:27]
  s_waitcnt vmcnt(0)
  s_barrier
  ds_read_b128 v[80:83], v1 offset:20480
  ds_read_b128 v[84:87], v1 offset:21504
  ds_read_b128 v[88:91], v1 offset:22528
  ds_read_b128 v[92:95], v1 offset:23552
  ds_read_b128 v[96:99], v1 offset:24576
  ds_read_b128 v[100:103], v1 offset:25600
  ds_read_b128 v[104:107], v1 offset:26624
  ds_read_b128 v[108:111], v1 offset:27648
  ds_read_b128 v[112:115], v1 offset:28672
  ds_read_b128 v[116:119], v1 offset:29696
  s_waitcnt lgkmcnt(5)
  v_mfma_f32_16x16x32_bf16 v[8:11], v[80:83], v[48:51], v[8:11]
  v_mfma_f32_16x16x32_bf16 v[12:15], v[84:87], v[48:51], v[12:15]
  v_mfma_f32_16x16x32_bf16 v[16:19], v[88:91], v[48:51], v[16:19]
  v_mfma_f32_16x16x32_bf16 v[20:23], v[92:95], v[48:51], v[20:23]
  v_mfma_f32_16x16x32_bf16 v[24:27], v[96:99], v[48:51], v[24:27]
  ds_read_b128 v[80:83], v1 offset:30720
  ds_read_b128 v[84:87], v1 offset:31744
  ds_read_b128 v[88:91], v1 offset:32768
  ds_read_b128 v[92:95], v1 offset:33792
  ds_read_b128 v[96:99], v1 offset:34816
  s_waitcnt lgkmcnt(5)
  v_mfma_f32_16x16x32_bf16 v[8:11], v[100:103], v[52:55], v[8:11]
  v_mfma_f32_16x16x32_bf16 v[12:15], v[104:107], v[52:55], v[12:15]
  v_mfma_f32_16x16x32_bf16 v[16:19], v[108:111], v[52:55], v[16:19]
  v_mfma_f32_16x16x32_bf16 v[20:23], v[112:115], v[52:55], v[20:23]
  v_mfma_f32_16x16x32_bf16 v[24:27], v[116:119], v[52:55], v[24:27]
  ds_read_b128 v[100:103], v1 offset:35840
  ds_read_b128 v[104:107], v1 offset:36864
  ds_read_b128 v[108:111], v1 offset:37888
  ds_read_b128 v[112:115], v1 offset:38912
  ds_read_b128 v[116:119], v1 offset:39936
  s_waitcnt lgkmcnt(5)
  v_mfma_f32_16x16x32_bf16 v[8:11], v[80:83], v[56:59], v[8:11]
  v_mfma_f32_16x16x32_bf16 v[12:15], v[84:87], v[56:59], v[12:15]
  v_mfma_f32_16x16x32_bf16 v[16:19], v[88:91], v[56:59], v[16:19]
  v_mfma_f32_16x16x32_bf16 v[20:23], v[92:95], v[56:59], v[20:23]
  v_mfma_f32_16x16x32_bf16 v[24:27], v[96:99], v[56:59], v[24:27]
  s_waitcnt lgkmcnt(0)
  v_mfma_f32_16x16x32_bf16 v[8:11], v[100:103], v[60:63], v[8:11]
  v_mfma_f32_16x16x32_bf16 v[12:15], v[104:107], v[60:63], v[12:15]
  v_mfma_f32_16x16x32_bf16 v[16:19], v[108:111], v[60:63], v[16:19]
  v_mfma_f32_16x16x32_bf16 v[20:23], v[112:115], v[60:63], v[20:23]
  v_mfma_f32_16x16x32_bf16 v[24:27], v[116:119], v[60:63], v[24:27]
  v_and_b32 v3, 63, v0
  v_and_b32 v4, 15, v3
  v_lshrrev_b32 v3, 4, v3
  s_lshl_b32 s21, s17, 6
  s_lshl_b32 s23, s16, 4
  s_add_u32 s21, s21, s23
  v_add_u32 v4, s21, v4
  v_mul_u32_u24 v6, 1280, v4
  v_lshl_add_u32 v6, v3, 4, v6
  s_mul_i32 s21, s18, 5
  s_add_u32 s23, s21, 0
  s_lshr_b32 s31, s23, 1
  s_lshl_b32 s31, s31, 6
  s_and_b32 s23, s23, 1
  s_lshl_b32 s23, s23, 3
  s_add_u32 s32, s31, s23
  s_add_u32 s40, s32, s20
  buffer_load_dwordx2 v[32:33], v6, s[8:11], s40 offen
  s_add_u32 s23, s21, 1
  s_lshr_b32 s31, s23, 1
  s_lshl_b32 s31, s31, 6
  s_and_b32 s23, s23, 1
  s_lshl_b32 s23, s23, 3
  s_add_u32 s33, s31, s23
  s_add_u32 s41, s33, s20
  buffer_load_dwordx2 v[34:35], v6, s[8:11], s41 offen
  s_add_u32 s23, s21, 2
  s_lshr_b32 s31, s23, 1
  s_lshl_b32 s31, s31, 6
  s_and_b32 s23, s23, 1
  s_lshl_b32 s23, s23, 3
  s_add_u32 s34, s31, s23
  s_add_u32 s42, s34, s20
  buffer_load_dwordx2 v[36:37], v6, s[8:11], s42 offen
  s_add_u32 s23, s21, 3
  s_lshr_b32 s31, s23, 1
  s_lshl_b32 s31, s31, 6
  s_and_b32 s23, s23, 1
  s_lshl_b32 s23, s23, 3
  s_add_u32 s35, s31, s23
  s_add_u32 s43, s35, s20
  buffer_load_dwordx2 v[38:39], v6, s[8:11], s43 offen
  s_add_u32 s23, s21, 4
  s_lshr_b32 s31, s23, 1
  s_lshl_b32 s31, s31, 6
  s_and_b32 s23, s23, 1
  s_lshl_b32 s23, s23, 3
  s_add_u32 s36, s31, s23
  s_add_u32 s44, s36, s20
  buffer_load_dwordx2 v[40:41], v6, s[8:11], s44 offen
  s_waitcnt vmcnt(0)
  v_cvt_pk_bf16_f32 v80, v8, v9
  v_cvt_pk_bf16_f32 v81, v10, v11
  v_lshlrev_b32 v8, 16, v80
  v_and_b32 v9, 0xffff0000, v80
  v_lshlrev_b32 v10, 16, v81
  v_and_b32 v11, 0xffff0000, v81
  v_lshlrev_b32 v82, 16, v32
  v_and_b32 v83, 0xffff0000, v32
  v_lshlrev_b32 v84, 16, v33
  v_and_b32 v85, 0xffff0000, v33
  v_add_f32 v8, v8, v82
  v_add_f32 v9, v9, v83
  v_add_f32 v10, v10, v84
  v_add_f32 v11, v11, v85
  v_cvt_pk_bf16_f32 v32, v8, v9
  v_cvt_pk_bf16_f32 v33, v10, v11
  buffer_store_dwordx2 v[32:33], v6, s[52:55], s32 offen sc1
  v_cvt_pk_bf16_f32 v80, v12, v13
  v_cvt_pk_bf16_f32 v81, v14, v15
  v_lshlrev_b32 v12, 16, v80
  v_and_b32 v13, 0xffff0000, v80
  v_lshlrev_b32 v14, 16, v81
  v_and_b32 v15, 0xffff0000, v81
  v_lshlrev_b32 v82, 16, v34
  v_and_b32 v83, 0xffff0000, v34
  v_lshlrev_b32 v84, 16, v35
  v_and_b32 v85, 0xffff0000, v35
  v_add_f32 v12, v12, v82
  v_add_f32 v13, v13, v83
  v_add_f32 v14, v14, v84
  v_add_f32 v15, v15, v85
  v_cvt_pk_bf16_f32 v34, v12, v13
  v_cvt_pk_bf16_f32 v35, v14, v15
  buffer_store_dwordx2 v[34:35], v6, s[52:55], s33 offen sc1
  v_cvt_pk_bf16_f32 v80, v16, v17
  v_cvt_pk_bf16_f32 v81, v18, v19
  v_lshlrev_b32 v16, 16, v80
  v_and_b32 v17, 0xffff0000, v80
  v_lshlrev_b32 v18, 16, v81
  v_and_b32 v19, 0xffff0000, v81
  v_lshlrev_b32 v82, 16, v36
  v_and_b32 v83, 0xffff0000, v36
  v_lshlrev_b32 v84, 16, v37
  v_and_b32 v85, 0xffff0000, v37
  v_add_f32 v16, v16, v82
  v_add_f32 v17, v17, v83
  v_add_f32 v18, v18, v84
  v_add_f32 v19, v19, v85
  v_cvt_pk_bf16_f32 v36, v16, v17
  v_cvt_pk_bf16_f32 v37, v18, v19
  buffer_store_dwordx2 v[36:37], v6, s[52:55], s34 offen sc1
  v_cvt_pk_bf16_f32 v80, v20, v21
  v_cvt_pk_bf16_f32 v81, v22, v23
  v_lshlrev_b32 v20, 16, v80
  v_and_b32 v21, 0xffff0000, v80
  v_lshlrev_b32 v22, 16, v81
  v_and_b32 v23, 0xffff0000, v81
  v_lshlrev_b32 v82, 16, v38
  v_and_b32 v83, 0xffff0000, v38
  v_lshlrev_b32 v84, 16, v39
  v_and_b32 v85, 0xffff0000, v39
  v_add_f32 v20, v20, v82
  v_add_f32 v21, v21, v83
  v_add_f32 v22, v22, v84
  v_add_f32 v23, v23, v85
  v_cvt_pk_bf16_f32 v38, v20, v21
  v_cvt_pk_bf16_f32 v39, v22, v23
  buffer_store_dwordx2 v[38:39], v6, s[52:55], s35 offen sc1
  v_cvt_pk_bf16_f32 v80, v24, v25
  v_cvt_pk_bf16_f32 v81, v26, v27
  v_lshlrev_b32 v24, 16, v80
  v_and_b32 v25, 0xffff0000, v80
  v_lshlrev_b32 v26, 16, v81
  v_and_b32 v27, 0xffff0000, v81
  v_lshlrev_b32 v82, 16, v40
  v_and_b32 v83, 0xffff0000, v40
  v_lshlrev_b32 v84, 16, v41
  v_and_b32 v85, 0xffff0000, v41
  v_add_f32 v24, v24, v82
  v_add_f32 v25, v25, v83
  v_add_f32 v26, v26, v84
  v_add_f32 v27, v27, v85
  v_cvt_pk_bf16_f32 v40, v24, v25
  v_cvt_pk_bf16_f32 v41, v26, v27
  buffer_store_dwordx2 v[40:41], v6, s[52:55], s36 offen sc1
outb2_exit1:
  s_endpgm
.section .rodata,"a"
.p2align 6
.amdhsa_kernel prep_kernel
  .amdhsa_next_free_vgpr 80
  .amdhsa_next_free_sgpr 64
  .amdhsa_accum_offset 80
  .amdhsa_group_segment_fixed_size 0
  .amdhsa_kernarg_size 104
  .amdhsa_user_sgpr_count 2
  .amdhsa_user_sgpr_kernarg_segment_ptr 1
  .amdhsa_system_sgpr_workgroup_id_x 1
  .amdhsa_float_denorm_mode_32 3
.end_amdhsa_kernel
.p2align 6
.amdhsa_kernel ln2_kernel
  .amdhsa_next_free_vgpr 80
  .amdhsa_next_free_sgpr 40
  .amdhsa_accum_offset 80
  .amdhsa_group_segment_fixed_size 0
  .amdhsa_kernarg_size 104
  .amdhsa_user_sgpr_count 2
  .amdhsa_user_sgpr_kernarg_segment_ptr 1
  .amdhsa_system_sgpr_workgroup_id_x 1
  .amdhsa_float_denorm_mode_32 3
.end_amdhsa_kernel
.p2align 6
.amdhsa_kernel reca_kernel
  .amdhsa_next_free_vgpr 512
  .amdhsa_next_free_sgpr 102
  .amdhsa_accum_offset 256
  .amdhsa_group_segment_fixed_size 0
  .amdhsa_kernarg_size 104
  .amdhsa_user_sgpr_count 2
  .amdhsa_user_sgpr_kernarg_segment_ptr 1
  .amdhsa_system_sgpr_workgroup_id_x 1
  .amdhsa_float_denorm_mode_32 3
.end_amdhsa_kernel
.p2align 6
.amdhsa_kernel fin_kernel
  .amdhsa_next_free_vgpr 496
  .amdhsa_next_free_sgpr 64
  .amdhsa_accum_offset 256
  .amdhsa_group_segment_fixed_size 0
  .amdhsa_kernarg_size 104
  .amdhsa_user_sgpr_count 2
  .amdhsa_user_sgpr_kernarg_segment_ptr 1
  .amdhsa_system_sgpr_workgroup_id_x 1
  .amdhsa_float_denorm_mode_32 3
.end_amdhsa_kernel
.p2align 6
.amdhsa_kernel redln1_kernel
  .amdhsa_next_free_vgpr 248
  .amdhsa_next_free_sgpr 48
  .amdhsa_accum_offset 248
  .amdhsa_group_segment_fixed_size 0
  .amdhsa_kernarg_size 104
  .amdhsa_user_sgpr_count 2
  .amdhsa_user_sgpr_kernarg_segment_ptr 1
  .amdhsa_system_sgpr_workgroup_id_x 1
  .amdhsa_float_denorm_mode_32 3
.end_amdhsa_kernel
.p2align 6
.amdhsa_kernel redln2_kernel
  .amdhsa_next_free_vgpr 248
  .amdhsa_next_free_sgpr 48
  .amdhsa_accum_offset 248
  .amdhsa_group_segment_fixed_size 0
  .amdhsa_kernarg_size 104
  .amdhsa_user_sgpr_count 2
  .amdhsa_user_sgpr_kernarg_segment_ptr 1
  .amdhsa_system_sgpr_workgroup_id_x 1
  .amdhsa_float_denorm_mode_32 3
.end_amdhsa_kernel
.p2align 6
.amdhsa_kernel qkvb_kernel
  .amdhsa_next_free_vgpr 176
  .amdhsa_next_free_sgpr 64
  .amdhsa_accum_offset 176
  .amdhsa_group_segment_fixed_size 0
  .amdhsa_kernarg_size 104
  .amdhsa_user_sgpr_count 2
  .amdhsa_user_sgpr_kernarg_segment_ptr 1
  .amdhsa_system_sgpr_workgroup_id_x 1
  .amdhsa_float_denorm_mode_32 3
.end_amdhsa_kernel
.p2align 6
.amdhsa_kernel attnb_kernel
  .amdhsa_next_free_vgpr 200
  .amdhsa_next_free_sgpr 48
  .amdhsa_accum_offset 200
  .amdhsa_group_segment_fixed_size 0
  .amdhsa_kernarg_size 104
  .amdhsa_user_sgpr_count 2
  .amdhsa_user_sgpr_kernarg_segment_ptr 1
  .amdhsa_system_sgpr_workgroup_id_x 1
  .amdhsa_float_denorm_mode_32 3
.end_amdhsa_kernel
.p2align 6
.amdhsa_kernel outb1_kernel
  .amdhsa_next_free_vgpr 128
  .amdhsa_next_free_sgpr 64
  .amdhsa_accum_offset 128
  .amdhsa_group_segment_fixed_size 0
  .amdhsa_kernarg_size 104
  .amdhsa_user_sgpr_count 2
  .amdhsa_user_sgpr_kernarg_segment_ptr 1
  .amdhsa_system_sgpr_workgroup_id_x 1
  .amdhsa_float_denorm_mode_32 3
.end_amdhsa_kernel
.p2align 6
.amdhsa_kernel outb2_kernel
  .amdhsa_next_free_vgpr 128
  .amdhsa_next_free_sgpr 64
  .amdhsa_accum_offset 128
  .amdhsa_group_segment_fixed_size 0
  .amdhsa_kernarg_size 104
  .amdhsa_user_sgpr_count 2
  .amdhsa_user_sgpr_kernarg_segment_ptr 1
  .amdhsa_system_sgpr_workgroup_id_x 1
  .amdhsa_float_denorm_mode_32 3
.end_amdhsa_kernel
```

```asm
; @launch kernel=prep_kernel grid=(2248,1,1) block=(256,1,1) lds=18944
; @launch kernel=reca_kernel grid=(256,1,1) block=(256,1,1) lds=81920
; @launch kernel=fin_kernel grid=(256,1,1) block=(256,1,1) lds=98304
; @launch kernel=redln1_kernel grid=(256,1,1) block=(128,1,1) lds=128
; @launch kernel=qkvb_kernel grid=(256,1,1) block=(256,1,1) lds=81920
; @launch kernel=attnb_kernel grid=(256,1,1) block=(256,1,1) lds=0
; @launch kernel=outb1_kernel grid=(256,1,1) block=(256,1,1) lds=61440
; @launch kernel=ln2_kernel grid=(128,1,1) block=(256,1,1) lds=512
; @launch kernel=reca_kernel grid=(256,1,1) block=(256,1,1) lds=81920
; @launch kernel=fin_kernel grid=(256,1,1) block=(256,1,1) lds=98304
; @launch kernel=redln2_kernel grid=(256,1,1) block=(128,1,1) lds=128
; @launch kernel=qkvb_kernel grid=(256,1,1) block=(256,1,1) lds=81920
; @launch kernel=attnb_kernel grid=(256,1,1) block=(256,1,1) lds=0
; @launch kernel=outb2_kernel grid=(256,1,1) block=(256,1,1) lds=61440
.amdgcn_target "amdgcn-amd-amdhsa--gfx950"
.text
.globl prep_kernel
.p2align 8
.type prep_kernel,@function
prep_kernel:
  s_cmp_ge_u32 s2, 128
  s_cbranch_scc1 prep_notln5
  s_load_dwordx2 s[12:13], s[0:1], 96
  s_load_dwordx2 s[14:15], s[0:1], 0
  v_lshrrev_b32 v2, 6, v0
  v_and_b32 v3, 63, v0
  s_nop 0
  v_readfirstlane_b32 s16, v2
  s_waitcnt lgkmcnt(0)
  s_mov_b32 s4, s12
  s_mov_b32 s5, s13
  s_mov_b32 s6, 0x10000000
  s_mov_b32 s7, 0x20000
  s_mov_b32 s8, s14
  s_mov_b32 s9, s15
  s_mov_b32 s10, 2621440
  s_mov_b32 s11, 0x20000
  s_mov_b32 s20, 0
  v_and_b32 v2, 15, v3
  v_lshrrev_b32 v4, 4, v3
  s_lshl_b32 s17, s2, 4
  v_add_u32 v1, s17, v2
  v_mul_u32_u24 v1, 1280, v1
  v_lshl_add_u32 v1, v4, 4, v1
  s_mul_i32 s17, s16, 320
  s_add_u32 s20, s20, s17
  buffer_load_dwordx4 v[8:11], v1, s[8:11], s20 offen offset:0
  buffer_load_dwordx4 v[12:15], v1, s[8:11], s20 offen offset:64
  buffer_load_dwordx4 v[16:19], v1, s[8:11], s20 offen offset:128
  buffer_load_dwordx4 v[20:23], v1, s[8:11], s20 offen offset:192
  buffer_load_dwordx4 v[24:27], v1, s[8:11], s20 offen offset:256
  s_sub_u32 s21, 0, s12
  s_and_b32 s21, s21, 0x1fffff
  s_add_u32 s21, s21, 2097152
  v_mov_b32 v68, -1
  v_mov_b32 v69, -1
  v_mov_b32 v70, -1
  v_mov_b32 v71, -1
  v_lshlrev_b32 v72, 4, v0
  s_mul_i32 s22, s2, 12096
  s_add_u32 s22, s22, 0
  s_mul_i32 s23, s2, 12288
  s_add_u32 s23, s23, s21
  buffer_store_dwordx4 v[68:71], v72, s[4:7], s22 offen sc1
  s_add_u32 s22, s22, 4096
  buffer_store_dwordx4 v[68:71], v72, s[4:7], s22 offen sc1
  s_add_u32 s22, s22, 4096
  v_mov_b32 v73, 0x80000000
  v_cmp_gt_u32 vcc, 244, v0
  s_nop 1
  v_cndmask_b32 v73, v73, v72, vcc
  buffer_store_dwordx4 v[68:71], v73, s[4:7], s22 offen
  buffer_store_dwordx4 v[68:71], v72, s[4:7], s23 offen sc1
  s_add_u32 s23, s23, 4096
  buffer_store_dwordx4 v[68:71], v72, s[4:7], s23 offen sc1
  s_add_u32 s23, s23, 4096
  buffer_store_dwordx4 v[68:71], v72, s[4:7], s23 offen sc1
  s_add_u32 s23, s23, 4096
  s_mul_i32 s23, s2, 2048
  s_add_u32 s23, s23, s21
  s_add_u32 s23, s23, 1572864
  v_mov_b32 v73, 0x80000000
  v_cmp_gt_u32 vcc, 128, v0
  s_nop 1
  v_cndmask_b32 v73, v73, v72, vcc
  buffer_store_dwordx4 v[68:71], v73, s[4:7], s23 offen sc1
  s_waitcnt vmcnt(7)
  s_mul_i32 s17, s16, 320
  s_add_u32 s17, s17, 82313216
  buffer_store_dwordx4 v[8:11], v1, s[4:7], s17 offen offset:0
  buffer_store_dwordx4 v[12:15], v1, s[4:7], s17 offen offset:64
  buffer_store_dwordx4 v[16:19], v1, s[4:7], s17 offen offset:128
  buffer_store_dwordx4 v[20:23], v1, s[4:7], s17 offen offset:192
  buffer_store_dwordx4 v[24:27], v1, s[4:7], s17 offen offset:256
  v_lshlrev_b32 v5, 2, v2
  s_lshl_b32 s17, s16, 6
  v_add_u32 v1, s17, v5
  s_waitcnt vmcnt(5)
  v_lshlrev_b32 v28, 16, v8
  v_and_b32 v29, 0xffff0000, v8
  v_lshlrev_b32 v30, 16, v9
  v_and_b32 v31, 0xffff0000, v9
  v_lshlrev_b32 v32, 16, v10
  v_and_b32 v33, 0xffff0000, v10
  v_lshlrev_b32 v34, 16, v11
  v_and_b32 v35, 0xffff0000, v11
  v_lshlrev_b32 v36, 16, v12
  v_and_b32 v37, 0xffff0000, v12
  v_lshlrev_b32 v38, 16, v13
  v_and_b32 v39, 0xffff0000, v13
  v_lshlrev_b32 v40, 16, v14
  v_and_b32 v41, 0xffff0000, v14
  v_lshlrev_b32 v42, 16, v15
  v_and_b32 v43, 0xffff0000, v15
  v_lshlrev_b32 v44, 16, v16
  v_and_b32 v45, 0xffff0000, v16
  v_lshlrev_b32 v46, 16, v17
  v_and_b32 v47, 0xffff0000, v17
  v_lshlrev_b32 v48, 16, v18
  v_and_b32 v49, 0xffff0000, v18
  v_lshlrev_b32 v50, 16, v19
  v_and_b32 v51, 0xffff0000, v19
  v_lshlrev_b32 v52, 16, v20
  v_and_b32 v53, 0xffff0000, v20
  v_lshlrev_b32 v54, 16, v21
  v_and_b32 v55, 0xffff0000, v21
  v_lshlrev_b32 v56, 16, v22
  v_and_b32 v57, 0xffff0000, v22
  v_lshlrev_b32 v58, 16, v23
  v_and_b32 v59, 0xffff0000, v23
  v_lshlrev_b32 v60, 16, v24
  v_and_b32 v61, 0xffff0000, v24
  v_lshlrev_b32 v62, 16, v25
  v_and_b32 v63, 0xffff0000, v25
  v_lshlrev_b32 v64, 16, v26
  v_and_b32 v65, 0xffff0000, v26
  v_lshlrev_b32 v66, 16, v27
  v_and_b32 v67, 0xffff0000, v27
  v_pk_add_f32 v[6:7], v[28:29], v[30:31]
  v_pk_add_f32 v[6:7], v[6:7], v[32:33]
  v_pk_add_f32 v[6:7], v[6:7], v[34:35]
  v_pk_add_f32 v[6:7], v[6:7], v[36:37]
  v_pk_add_f32 v[6:7], v[6:7], v[38:39]
  v_pk_add_f32 v[6:7], v[6:7], v[40:41]
  v_pk_add_f32 v[6:7], v[6:7], v[42:43]
  v_pk_add_f32 v[6:7], v[6:7], v[44:45]
  v_pk_add_f32 v[6:7], v[6:7], v[46:47]
  v_pk_add_f32 v[6:7], v[6:7], v[48:49]
  v_pk_add_f32 v[6:7], v[6:7], v[50:51]
  v_pk_add_f32 v[6:7], v[6:7], v[52:53]
  v_pk_add_f32 v[6:7], v[6:7], v[54:55]
  v_pk_add_f32 v[6:7], v[6:7], v[56:57]
  v_pk_add_f32 v[6:7], v[6:7], v[58:59]
  v_pk_add_f32 v[6:7], v[6:7], v[60:61]
  v_pk_add_f32 v[6:7], v[6:7], v[62:63]
  v_pk_add_f32 v[6:7], v[6:7], v[64:65]
  v_pk_add_f32 v[6:7], v[6:7], v[66:67]
  v_add_f32 v4, v6, v7
  v_mov_b32 v2, v4
  s_nop 1
  v_permlane32_swap_b32 v4, v2
  v_add_f32 v4, v4, v2
  v_mov_b32 v2, v4
  s_nop 1
  v_permlane16_swap_b32 v4, v2
  v_add_f32 v4, v4, v2
  ds_write_b32 v1, v4 offset:0
  s_waitcnt lgkmcnt(0)
  s_barrier
  ds_read_b32 v4, v5 offset:0
  ds_read_b32 v2, v5 offset:64
  ds_read_b32 v3, v5 offset:128
  ds_read_b32 v6, v5 offset:192
  s_waitcnt lgkmcnt(0)
  v_add_f32 v4, v4, v2
  v_add_f32 v3, v3, v6
  v_add_f32 v4, v4, v3
  v_mul_f32 v4, 0x3acccccd, v4
  v_sub_f32 v28, v28, v4
  v_sub_f32 v29, v29, v4
  v_sub_f32 v30, v30, v4
  v_sub_f32 v31, v31, v4
  v_sub_f32 v32, v32, v4
  v_sub_f32 v33, v33, v4
  v_sub_f32 v34, v34, v4
  v_sub_f32 v35, v35, v4
  v_sub_f32 v36, v36, v4
  v_sub_f32 v37, v37, v4
  v_sub_f32 v38, v38, v4
  v_sub_f32 v39, v39, v4
  v_sub_f32 v40, v40, v4
  v_sub_f32 v41, v41, v4
  v_sub_f32 v42, v42, v4
  v_sub_f32 v43, v43, v4
  v_sub_f32 v44, v44, v4
  v_sub_f32 v45, v45, v4
  v_sub_f32 v46, v46, v4
  v_sub_f32 v47, v47, v4
  v_sub_f32 v48, v48, v4
  v_sub_f32 v49, v49, v4
  v_sub_f32 v50, v50, v4
  v_sub_f32 v51, v51, v4
  v_sub_f32 v52, v52, v4
  v_sub_f32 v53, v53, v4
  v_sub_f32 v54, v54, v4
  v_sub_f32 v55, v55, v4
  v_sub_f32 v56, v56, v4
  v_sub_f32 v57, v57, v4
  v_sub_f32 v58, v58, v4
  v_sub_f32 v59, v59, v4
  v_sub_f32 v60, v60, v4
  v_sub_f32 v61, v61, v4
  v_sub_f32 v62, v62, v4
  v_sub_f32 v63, v63, v4
  v_sub_f32 v64, v64, v4
  v_sub_f32 v65, v65, v4
  v_sub_f32 v66, v66, v4
  v_sub_f32 v67, v67, v4
  v_mul_f32 v6, v28, v28
  v_mul_f32 v7, v29, v29
  v_fmac_f32 v6, v30, v30
  v_fmac_f32 v7, v31, v31
  v_fmac_f32 v6, v32, v32
  v_fmac_f32 v7, v33, v33
  v_fmac_f32 v6, v34, v34
  v_fmac_f32 v7, v35, v35
  v_fmac_f32 v6, v36, v36
  v_fmac_f32 v7, v37, v37
  v_fmac_f32 v6, v38, v38
  v_fmac_f32 v7, v39, v39
  v_fmac_f32 v6, v40, v40
  v_fmac_f32 v7, v41, v41
  v_fmac_f32 v6, v42, v42
  v_fmac_f32 v7, v43, v43
  v_fmac_f32 v6, v44, v44
  v_fmac_f32 v7, v45, v45
  v_fmac_f32 v6, v46, v46
  v_fmac_f32 v7, v47, v47
  v_fmac_f32 v6, v48, v48
  v_fmac_f32 v7, v49, v49
  v_fmac_f32 v6, v50, v50
  v_fmac_f32 v7, v51, v51
  v_fmac_f32 v6, v52, v52
  v_fmac_f32 v7, v53, v53
  v_fmac_f32 v6, v54, v54
  v_fmac_f32 v7, v55, v55
  v_fmac_f32 v6, v56, v56
  v_fmac_f32 v7, v57, v57
  v_fmac_f32 v6, v58, v58
  v_fmac_f32 v7, v59, v59
  v_fmac_f32 v6, v60, v60
  v_fmac_f32 v7, v61, v61
  v_fmac_f32 v6, v62, v62
  v_fmac_f32 v7, v63, v63
  v_fmac_f32 v6, v64, v64
  v_fmac_f32 v7, v65, v65
  v_fmac_f32 v6, v66, v66
  v_fmac_f32 v7, v67, v67
  v_add_f32 v4, v6, v7
  v_mov_b32 v2, v4
  s_nop 1
  v_permlane32_swap_b32 v4, v2
  v_add_f32 v4, v4, v2
  v_mov_b32 v2, v4
  s_nop 1
  v_permlane16_swap_b32 v4, v2
  v_add_f32 v4, v4, v2
  ds_write_b32 v1, v4 offset:256
  s_waitcnt lgkmcnt(0)
  s_barrier
  ds_read_b32 v4, v5 offset:256
  ds_read_b32 v2, v5 offset:320
  ds_read_b32 v3, v5 offset:384
  ds_read_b32 v6, v5 offset:448
  s_waitcnt lgkmcnt(0)
  v_add_f32 v4, v4, v2
  v_add_f32 v3, v3, v6
  v_add_f32 v4, v4, v3
  v_mov_b32 v2, 0x3727c5ac
  v_fmac_f32 v2, 0x3acccccd, v4
  v_rsq_f32 v4, v2
  s_nop 0
  v_mul_f32 v28, v28, v4
  v_mul_f32 v29, v29, v4
  v_mul_f32 v30, v30, v4
  v_mul_f32 v31, v31, v4
  v_mul_f32 v32, v32, v4
  v_mul_f32 v33, v33, v4
  v_mul_f32 v34, v34, v4
  v_mul_f32 v35, v35, v4
  v_mul_f32 v36, v36, v4
  v_mul_f32 v37, v37, v4
  v_mul_f32 v38, v38, v4
  v_mul_f32 v39, v39, v4
  v_mul_f32 v40, v40, v4
  v_mul_f32 v41, v41, v4
  v_mul_f32 v42, v42, v4
  v_mul_f32 v43, v43, v4
  v_mul_f32 v44, v44, v4
  v_mul_f32 v45, v45, v4
  v_mul_f32 v46, v46, v4
  v_mul_f32 v47, v47, v4
  v_mul_f32 v48, v48, v4
  v_mul_f32 v49, v49, v4
  v_mul_f32 v50, v50, v4
  v_mul_f32 v51, v51, v4
  v_mul_f32 v52, v52, v4
  v_mul_f32 v53, v53, v4
  v_mul_f32 v54, v54, v4
  v_mul_f32 v55, v55, v4
  v_mul_f32 v56, v56, v4
  v_mul_f32 v57, v57, v4
  v_mul_f32 v58, v58, v4
  v_mul_f32 v59, v59, v4
  v_mul_f32 v60, v60, v4
  v_mul_f32 v61, v61, v4
  v_mul_f32 v62, v62, v4
  v_mul_f32 v63, v63, v4
  v_mul_f32 v64, v64, v4
  v_mul_f32 v65, v65, v4
  v_mul_f32 v66, v66, v4
  v_mul_f32 v67, v67, v4
  v_cvt_pk_bf16_f32 v8, v28, v29
  v_cvt_pk_bf16_f32 v9, v30, v31
  v_cvt_pk_bf16_f32 v10, v32, v33
  v_cvt_pk_bf16_f32 v11, v34, v35
  v_cvt_pk_bf16_f32 v12, v36, v37
  v_cvt_pk_bf16_f32 v13, v38, v39
  v_cvt_pk_bf16_f32 v14, v40, v41
  v_cvt_pk_bf16_f32 v15, v42, v43
  v_cvt_pk_bf16_f32 v16, v44, v45
  v_cvt_pk_bf16_f32 v17, v46, v47
  v_cvt_pk_bf16_f32 v18, v48, v49
  v_cvt_pk_bf16_f32 v19, v50, v51
  v_cvt_pk_bf16_f32 v20, v52, v53
  v_cvt_pk_bf16_f32 v21, v54, v55
  v_cvt_pk_bf16_f32 v22, v56, v57
  v_cvt_pk_bf16_f32 v23, v58, v59
  v_cvt_pk_bf16_f32 v24, v60, v61
  v_cvt_pk_bf16_f32 v25, v62, v63
  v_cvt_pk_bf16_f32 v26, v64, v65
  v_cvt_pk_bf16_f32 v27, v66, v67
  v_and_b32 v3, 63, v0
  v_lshlrev_b32 v1, 4, v3
  s_mul_i32 s17, s2, 20480
  s_mul_i32 s18, s16, 5120
  s_add_u32 s17, s17, s18
  s_add_u32 s17, s17, 84934656
  buffer_store_dwordx4 v[8:11], v1, s[4:7], s17 offen offset:0 sc1
  buffer_store_dwordx4 v[12:15], v1, s[4:7], s17 offen offset:1024 sc1
  buffer_store_dwordx4 v[16:19], v1, s[4:7], s17 offen offset:2048 sc1
  buffer_store_dwordx4 v[20:23], v1, s[4:7], s17 offen offset:3072 sc1
  s_add_u32 s17, s17, 4096
  buffer_store_dwordx4 v[24:27], v1, s[4:7], s17 offen offset:0 sc1
  s_endpgm
prep_notln5:
  s_sub_u32 s2, s2, 128
  s_cmp_ge_u32 s2, 2120
  s_cbranch_scc1 prep_exit1
  s_load_dwordx2 s[12:13], s[0:1], 96
  s_load_dwordx4 s[16:19], s[0:1], 16
  s_load_dwordx4 s[20:23], s[0:1], 32
  s_load_dwordx4 s[24:27], s[0:1], 64
  v_lshrrev_b32 v6, 6, v0
  v_and_b32 v1, 63, v0
  s_nop 0
  v_readfirstlane_b32 s14, v6
  v_lshlrev_b32 v5, 4, v1
  s_lshl_b32 s15, s2, 2
  s_nop 1
  s_add_u32 s15, s15, s14
  s_add_u32 s28, s15, 7680
  s_sub_u32 s29, s15, 800
  s_cmp_lt_u32 s15, 800
  s_cselect_b32 s15, s28, s29
  s_waitcnt lgkmcnt(0)
  s_mov_b32 s4, s12
  s_mov_b32 s5, s13
  s_mov_b32 s6, 0x10000000
  s_mov_b32 s7, 0x20000
  s_mov_b32 s11, 0x20000
  v_and_b32 v2, 15, v1
  v_lshrrev_b32 v3, 4, v1
  s_cmp_ge_u32 s15, 5760
  s_cbranch_scc1 prep_s22
  s_mul_hi_u32 s31, s15, 2236963
  s_mul_i32 s32, s31, 1920
  s_sub_u32 s32, s15, s32
  s_mul_hi_u32 s33, s32, 214748365
  s_mul_i32 s34, s33, 20
  s_sub_u32 s34, s32, s34
  s_cmp_eq_u32 s31, 0
  s_cselect_b32 s8, s16, s18
  s_cselect_b32 s9, s17, s19
  s_cmp_eq_u32 s31, 2
  s_cselect_b32 s8, s20, s8
  s_cselect_b32 s9, s21, s9
  s_mov_b32 s10, 7864320
  s_mul_i32 s35, s31, 7864320
  s_add_u32 s35, s35, 6291456
  v_lshrrev_b32 v6, 3, v1
  s_lshl_b32 s36, s34, 5
  v_add_u32 v6, s36, v6
  s_mov_b32 s37, 12288
  v_mul_lo_u32 v4, v6, s37
  s_lshl_b32 s36, s33, 7
  v_and_b32 v6, 7, v1
  v_lshl_add_u32 v4, v6, 4, v4
  v_add_u32 v4, s36, v4
  v_lshrrev_b32 v6, 3, v1
  v_mul_u32_u24 v12, 144, v6
  v_and_b32 v6, 7, v1
  v_lshl_add_u32 v12, v6, 4, v12
  s_mul_i32 s36, s14, 4608
  s_add_u32 s36, s36, 512
  v_add_u32 v12, s36, v12
  s_mov_b32 s29, 0
  buffer_load_dwordx4 v[16:19], v4, s[8:11], s29 offen
  s_mov_b32 s29, 98304
  buffer_load_dwordx4 v[20:23], v4, s[8:11], s29 offen
  s_mov_b32 s29, 196608
  buffer_load_dwordx4 v[24:27], v4, s[8:11], s29 offen
  s_mov_b32 s29, 294912
  buffer_load_dwordx4 v[28:31], v4, s[8:11], s29 offen
  v_bfe_u32 v6, v1, 2, 2
  v_lshlrev_b32 v13, 3, v3
  v_add_u32 v13, v13, v6
  v_mul_u32_u24 v13, 144, v13
  v_and_b32 v6, 3, v1
  v_lshl_add_u32 v13, v6, 3, v13
  v_add_u32 v13, s36, v13
  s_waitcnt vmcnt(3)
  ds_write_b128 v12, v[16:19] offset:0
  s_waitcnt vmcnt(2)
  ds_write_b128 v12, v[20:23] offset:1152
  s_waitcnt vmcnt(1)
  ds_write_b128 v12, v[24:27] offset:2304
  s_waitcnt vmcnt(0)
  ds_write_b128 v12, v[28:31] offset:3456
  s_waitcnt lgkmcnt(0)
  ds_read_b64_tr_b16 v[48:49], v13 offset:0
  ds_read_b64_tr_b16 v[50:51], v13 offset:576
  ds_read_b64_tr_b16 v[52:53], v13 offset:32
  ds_read_b64_tr_b16 v[54:55], v13 offset:608
  ds_read_b64_tr_b16 v[56:57], v13 offset:64
  ds_read_b64_tr_b16 v[58:59], v13 offset:640
  ds_read_b64_tr_b16 v[60:61], v13 offset:96
  ds_read_b64_tr_b16 v[62:63], v13 offset:672
  s_waitcnt lgkmcnt(6)
  s_lshl_b32 s30, s33, 2
  s_add_u32 s30, s30, 0
  s_mul_i32 s30, s30, 20
  s_add_u32 s30, s30, s34
  s_lshl_b32 s30, s30, 10
  s_add_u32 s30, s30, s35
  buffer_store_dwordx4 v[48:51], v5, s[4:7], s30 offen sc1
  s_waitcnt lgkmcnt(4)
  s_lshl_b32 s30, s33, 2
  s_add_u32 s30, s30, 1
  s_mul_i32 s30, s30, 20
  s_add_u32 s30, s30, s34
  s_lshl_b32 s30, s30, 10
  s_add_u32 s30, s30, s35
  buffer_store_dwordx4 v[52:55], v5, s[4:7], s30 offen sc1
  s_waitcnt lgkmcnt(2)
  s_lshl_b32 s30, s33, 2
  s_add_u32 s30, s30, 2
  s_mul_i32 s30, s30, 20
  s_add_u32 s30, s30, s34
  s_lshl_b32 s30, s30, 10
  s_add_u32 s30, s30, s35
  buffer_store_dwordx4 v[56:59], v5, s[4:7], s30 offen sc1
  s_waitcnt lgkmcnt(0)
  s_lshl_b32 s30, s33, 2
  s_add_u32 s30, s30, 3
  s_mul_i32 s30, s30, 20
  s_add_u32 s30, s30, s34
  s_lshl_b32 s30, s30, 10
  s_add_u32 s30, s30, s35
  buffer_store_dwordx4 v[60:63], v5, s[4:7], s30 offen sc1
  s_branch prep_exit1
prep_s22:
  s_sub_u32 s15, s15, 5760
  s_cmp_ge_u32 s15, 1920
  s_cbranch_scc1 prep_s33
  s_mul_hi_u32 s33, s15, 22369622
  s_mul_i32 s34, s33, 192
  s_sub_u32 s34, s15, s34
  s_mov_b32 s8, s22
  s_mov_b32 s9, s23
  s_mov_b32 s10, 7864320
  v_lshrrev_b32 v6, 3, v1
  s_lshl_b32 s36, s34, 5
  v_add_u32 v6, s36, v6
  v_mul_u32_u24 v4, 1280, v6
  s_lshl_b32 s36, s33, 7
  v_and_b32 v6, 7, v1
  v_lshl_add_u32 v4, v6, 4, v4
  v_add_u32 v4, s36, v4
  v_lshrrev_b32 v6, 3, v1
  v_mul_u32_u24 v12, 144, v6
  v_and_b32 v6, 7, v1
  v_lshl_add_u32 v12, v6, 4, v12
  s_mul_i32 s36, s14, 4608
  s_add_u32 s36, s36, 512
  v_add_u32 v12, s36, v12
  s_mov_b32 s29, 0
  buffer_load_dwordx4 v[16:19], v4, s[8:11], s29 offen
  s_mov_b32 s29, 10240
  buffer_load_dwordx4 v[20:23], v4, s[8:11], s29 offen
  s_mov_b32 s29, 20480
  buffer_load_dwordx4 v[24:27], v4, s[8:11], s29 offen
  s_mov_b32 s29, 30720
  buffer_load_dwordx4 v[28:31], v4, s[8:11], s29 offen
  v_bfe_u32 v6, v1, 2, 2
  v_lshlrev_b32 v13, 2, v3
  v_add_u32 v13, v13, v6
  v_mul_u32_u24 v13, 144, v13
  v_and_b32 v6, 3, v1
  v_lshl_add_u32 v13, v6, 4, v13
  v_add_u32 v13, s36, v13
  s_waitcnt vmcnt(3)
  ds_write_b128 v12, v[16:19] offset:0
  s_waitcnt vmcnt(2)
  ds_write_b128 v12, v[20:23] offset:1152
  s_waitcnt vmcnt(1)
  ds_write_b128 v12, v[24:27] offset:2304
  s_waitcnt vmcnt(0)
  ds_write_b128 v12, v[28:31] offset:3456
  s_waitcnt lgkmcnt(0)
  ds_read_b64_tr_b16 v[48:49], v13 offset:0
  ds_read_b64_tr_b16 v[50:51], v13 offset:2304
  ds_read_b64_tr_b16 v[52:53], v13 offset:8
  ds_read_b64_tr_b16 v[54:55], v13 offset:2312
  ds_read_b64_tr_b16 v[56:57], v13 offset:64
  ds_read_b64_tr_b16 v[58:59], v13 offset:2368
  ds_read_b64_tr_b16 v[60:61], v13 offset:72
  ds_read_b64_tr_b16 v[62:63], v13 offset:2376
  s_waitcnt lgkmcnt(6)
  s_lshl_b32 s30, s33, 2
  s_add_u32 s30, s30, 0
  s_mul_i32 s30, s30, 192
  s_add_u32 s30, s30, s34
  s_lshl_b32 s30, s30, 10
  s_add_u32 s30, s30, 29884416
  buffer_store_dwordx4 v[48:51], v5, s[4:7], s30 offen sc1
  s_waitcnt lgkmcnt(4)
  s_lshl_b32 s30, s33, 2
  s_add_u32 s30, s30, 1
  s_mul_i32 s30, s30, 192
  s_add_u32 s30, s30, s34
  s_lshl_b32 s30, s30, 10
  s_add_u32 s30, s30, 29884416
  buffer_store_dwordx4 v[52:55], v5, s[4:7], s30 offen sc1
  s_waitcnt lgkmcnt(2)
  s_lshl_b32 s30, s33, 2
  s_add_u32 s30, s30, 2
  s_mul_i32 s30, s30, 192
  s_add_u32 s30, s30, s34
  s_lshl_b32 s30, s30, 10
  s_add_u32 s30, s30, 29884416
  buffer_store_dwordx4 v[56:59], v5, s[4:7], s30 offen sc1
  s_waitcnt lgkmcnt(0)
  s_lshl_b32 s30, s33, 2
  s_add_u32 s30, s30, 3
  s_mul_i32 s30, s30, 192
  s_add_u32 s30, s30, s34
  s_lshl_b32 s30, s30, 10
  s_add_u32 s30, s30, 29884416
  buffer_store_dwordx4 v[60:63], v5, s[4:7], s30 offen sc1
  s_branch prep_exit1
prep_s33:
  s_sub_u32 s15, s15, 1920
  s_cmp_ge_u32 s15, 600
  s_cbranch_scc1 prep_s44
  s_mul_hi_u32 s33, s15, 214748365
  s_mul_i32 s34, s33, 20
  s_sub_u32 s34, s15, s34
  s_mov_b32 s8, s24
  s_mov_b32 s9, s25
  s_mov_b32 s10, 2457600
  v_lshrrev_b32 v6, 3, v1
  s_lshl_b32 s36, s34, 5
  v_add_u32 v6, s36, v6
  v_mul_u32_u24 v4, 3840, v6
  s_lshl_b32 s36, s33, 7
  v_and_b32 v6, 7, v1
  v_lshl_add_u32 v4, v6, 4, v4
  v_add_u32 v4, s36, v4
  v_lshrrev_b32 v6, 3, v1
  v_mul_u32_u24 v12, 144, v6
  v_and_b32 v6, 7, v1
  v_lshl_add_u32 v12, v6, 4, v12
  s_mul_i32 s36, s14, 4608
  s_add_u32 s36, s36, 512
  v_add_u32 v12, s36, v12
  s_mov_b32 s29, 0
  buffer_load_dwordx4 v[16:19], v4, s[8:11], s29 offen
  s_mov_b32 s29, 30720
  buffer_load_dwordx4 v[20:23], v4, s[8:11], s29 offen
  s_mov_b32 s29, 61440
  buffer_load_dwordx4 v[24:27], v4, s[8:11], s29 offen
  s_mov_b32 s29, 92160
  buffer_load_dwordx4 v[28:31], v4, s[8:11], s29 offen
  v_bfe_u32 v6, v1, 2, 2
  v_lshlrev_b32 v13, 3, v3
  v_add_u32 v13, v13, v6
  v_mul_u32_u24 v13, 144, v13
  v_and_b32 v6, 3, v1
  v_lshl_add_u32 v13, v6, 3, v13
  v_add_u32 v13, s36, v13
  s_waitcnt vmcnt(3)
  ds_write_b128 v12, v[16:19] offset:0
  s_waitcnt vmcnt(2)
  ds_write_b128 v12, v[20:23] offset:1152
  s_waitcnt vmcnt(1)
  ds_write_b128 v12, v[24:27] offset:2304
  s_waitcnt vmcnt(0)
  ds_write_b128 v12, v[28:31] offset:3456
  s_waitcnt lgkmcnt(0)
  ds_read_b64_tr_b16 v[48:49], v13 offset:0
  ds_read_b64_tr_b16 v[50:51], v13 offset:576
  ds_read_b64_tr_b16 v[52:53], v13 offset:32
  ds_read_b64_tr_b16 v[54:55], v13 offset:608
  ds_read_b64_tr_b16 v[56:57], v13 offset:64
  ds_read_b64_tr_b16 v[58:59], v13 offset:640
  ds_read_b64_tr_b16 v[60:61], v13 offset:96
  ds_read_b64_tr_b16 v[62:63], v13 offset:672
  s_waitcnt lgkmcnt(6)
  s_lshl_b32 s30, s33, 2
  s_add_u32 s30, s30, 0
  s_mul_i32 s30, s30, 20
  s_add_u32 s30, s30, s34
  s_lshl_b32 s30, s30, 10
  s_add_u32 s30, s30, 87556096
  buffer_store_dwordx4 v[48:51], v5, s[4:7], s30 offen sc1
  s_waitcnt lgkmcnt(4)
  s_lshl_b32 s30, s33, 2
  s_add_u32 s30, s30, 1
  s_mul_i32 s30, s30, 20
  s_add_u32 s30, s30, s34
  s_lshl_b32 s30, s30, 10
  s_add_u32 s30, s30, 87556096
  buffer_store_dwordx4 v[52:55], v5, s[4:7], s30 offen sc1
  s_waitcnt lgkmcnt(2)
  s_lshl_b32 s30, s33, 2
  s_add_u32 s30, s30, 2
  s_mul_i32 s30, s30, 20
  s_add_u32 s30, s30, s34
  s_lshl_b32 s30, s30, 10
  s_add_u32 s30, s30, 87556096
  buffer_store_dwordx4 v[56:59], v5, s[4:7], s30 offen sc1
  s_waitcnt lgkmcnt(0)
  s_lshl_b32 s30, s33, 2
  s_add_u32 s30, s30, 3
  s_mul_i32 s30, s30, 20
  s_add_u32 s30, s30, s34
  s_lshl_b32 s30, s30, 10
  s_add_u32 s30, s30, 87556096
  buffer_store_dwordx4 v[60:63], v5, s[4:7], s30 offen sc1
  s_branch prep_exit1
prep_s44:
  s_sub_u32 s15, s15, 600
  s_mul_hi_u32 s33, s15, 214748365
  s_mul_i32 s34, s33, 20
  s_sub_u32 s34, s15, s34
  s_mov_b32 s8, s26
  s_mov_b32 s9, s27
  s_mov_b32 s10, 819200
  v_lshrrev_b32 v6, 3, v1
  s_lshl_b32 s36, s34, 5
  v_add_u32 v6, s36, v6
  v_mul_u32_u24 v4, 1280, v6
  s_lshl_b32 s36, s33, 7
  v_and_b32 v6, 7, v1
  v_lshl_add_u32 v4, v6, 4, v4
  v_add_u32 v4, s36, v4
  v_lshrrev_b32 v6, 3, v1
  v_mul_u32_u24 v12, 144, v6
  v_and_b32 v6, 7, v1
  v_lshl_add_u32 v12, v6, 4, v12
  s_mul_i32 s36, s14, 4608
  s_add_u32 s36, s36, 512
  v_add_u32 v12, s36, v12
  s_mov_b32 s29, 0
  buffer_load_dwordx4 v[16:19], v4, s[8:11], s29 offen
  s_mov_b32 s29, 10240
  buffer_load_dwordx4 v[20:23], v4, s[8:11], s29 offen
  s_mov_b32 s29, 20480
  buffer_load_dwordx4 v[24:27], v4, s[8:11], s29 offen
  s_mov_b32 s29, 30720
  buffer_load_dwordx4 v[28:31], v4, s[8:11], s29 offen
  v_bfe_u32 v6, v1, 2, 2
  v_lshlrev_b32 v13, 3, v3
  v_add_u32 v13, v13, v6
  v_mul_u32_u24 v13, 144, v13
  v_and_b32 v6, 3, v1
  v_lshl_add_u32 v13, v6, 4, v13
  v_add_u32 v13, s36, v13
  s_waitcnt vmcnt(3)
  ds_write_b128 v12, v[16:19] offset:0
  s_waitcnt vmcnt(2)
  ds_write_b128 v12, v[20:23] offset:1152
  s_waitcnt vmcnt(1)
  ds_write_b128 v12, v[24:27] offset:2304
  s_waitcnt vmcnt(0)
  ds_write_b128 v12, v[28:31] offset:3456
  s_waitcnt lgkmcnt(0)
  ds_read_b64_tr_b16 v[48:49], v13 offset:0
  ds_read_b64_tr_b16 v[50:51], v13 offset:576
  ds_read_b64_tr_b16 v[52:53], v13 offset:8
  ds_read_b64_tr_b16 v[54:55], v13 offset:584
  ds_read_b64_tr_b16 v[56:57], v13 offset:64
  ds_read_b64_tr_b16 v[58:59], v13 offset:640
  ds_read_b64_tr_b16 v[60:61], v13 offset:72
  ds_read_b64_tr_b16 v[62:63], v13 offset:648
  s_waitcnt lgkmcnt(6)
  s_lshl_b32 s30, s33, 2
  s_add_u32 s30, s30, 0
  s_mul_i32 s30, s30, 20
  s_add_u32 s30, s30, s34
  s_lshl_b32 s30, s30, 10
  s_add_u32 s30, s30, 90013696
  buffer_store_dwordx4 v[48:51], v5, s[4:7], s30 offen sc1
  s_waitcnt lgkmcnt(4)
  s_lshl_b32 s30, s33, 2
  s_add_u32 s30, s30, 1
  s_mul_i32 s30, s30, 20
  s_add_u32 s30, s30, s34
  s_lshl_b32 s30, s30, 10
  s_add_u32 s30, s30, 90013696
  buffer_store_dwordx4 v[52:55], v5, s[4:7], s30 offen sc1
  s_waitcnt lgkmcnt(2)
  s_lshl_b32 s30, s33, 2
  s_add_u32 s30, s30, 2
  s_mul_i32 s30, s30, 20
  s_add_u32 s30, s30, s34
  s_lshl_b32 s30, s30, 10
  s_add_u32 s30, s30, 90013696
  buffer_store_dwordx4 v[56:59], v5, s[4:7], s30 offen sc1
  s_waitcnt lgkmcnt(0)
  s_lshl_b32 s30, s33, 2
  s_add_u32 s30, s30, 3
  s_mul_i32 s30, s30, 20
  s_add_u32 s30, s30, s34
  s_lshl_b32 s30, s30, 10
  s_add_u32 s30, s30, 90013696
  buffer_store_dwordx4 v[60:63], v5, s[4:7], s30 offen sc1
prep_exit1:
  s_endpgm
.globl ln2_kernel
.p2align 8
.type ln2_kernel,@function
ln2_kernel:
  s_cmp_ge_u32 s2, 128
  s_cbranch_scc1 ln2_exit1
  s_load_dwordx2 s[12:13], s[0:1], 96
  s_load_dwordx2 s[14:15], s[0:1], 0
  v_lshrrev_b32 v2, 6, v0
  v_and_b32 v3, 63, v0
  s_nop 0
  v_readfirstlane_b32 s16, v2
  s_waitcnt lgkmcnt(0)
  s_mov_b32 s4, s12
  s_mov_b32 s5, s13
  s_mov_b32 s6, 0x10000000
  s_mov_b32 s7, 0x20000
  s_mov_b32 s8, s12
  s_mov_b32 s9, s13
  s_mov_b32 s10, 0x10000000
  s_mov_b32 s11, 0x20000
  s_mov_b32 s20, 82313216
  v_and_b32 v2, 15, v3
  v_lshrrev_b32 v4, 4, v3
  s_lshl_b32 s17, s2, 4
  v_add_u32 v1, s17, v2
  v_mul_u32_u24 v1, 1280, v1
  v_lshl_add_u32 v1, v4, 4, v1
  s_mul_i32 s17, s16, 320
  s_add_u32 s20, s20, s17
  buffer_load_dwordx4 v[8:11], v1, s[8:11], s20 offen offset:0
  buffer_load_dwordx4 v[12:15], v1, s[8:11], s20 offen offset:64
  buffer_load_dwordx4 v[16:19], v1, s[8:11], s20 offen offset:128
  buffer_load_dwordx4 v[20:23], v1, s[8:11], s20 offen offset:192
  buffer_load_dwordx4 v[24:27], v1, s[8:11], s20 offen offset:256
  s_sub_u32 s21, 0, s12
  s_and_b32 s21, s21, 0x1fffff
  s_add_u32 s21, s21, 2097152
  v_mov_b32 v68, -1
  v_mov_b32 v69, -1
  v_mov_b32 v70, -1
  v_mov_b32 v71, -1
  v_lshlrev_b32 v72, 4, v0
  s_mul_i32 s22, s2, 12096
  s_add_u32 s22, s22, 0
  s_mul_i32 s23, s2, 12288
  s_add_u32 s23, s23, s21
  buffer_store_dwordx4 v[68:71], v72, s[4:7], s22 offen sc1
  s_add_u32 s22, s22, 4096
  buffer_store_dwordx4 v[68:71], v72, s[4:7], s22 offen sc1
  s_add_u32 s22, s22, 4096
  v_mov_b32 v73, 0x80000000
  v_cmp_gt_u32 vcc, 244, v0
  s_nop 1
  v_cndmask_b32 v73, v73, v72, vcc
  buffer_store_dwordx4 v[68:71], v73, s[4:7], s22 offen
  buffer_store_dwordx4 v[68:71], v72, s[4:7], s23 offen sc1
  s_add_u32 s23, s23, 4096
  buffer_store_dwordx4 v[68:71], v72, s[4:7], s23 offen sc1
  s_add_u32 s23, s23, 4096
  buffer_store_dwordx4 v[68:71], v72, s[4:7], s23 offen sc1
  s_add_u32 s23, s23, 4096
  s_mul_i32 s23, s2, 2048
  s_add_u32 s23, s23, s21
  s_add_u32 s23, s23, 1572864
  v_mov_b32 v73, 0x80000000
  v_cmp_gt_u32 vcc, 128, v0
  s_nop 1
  v_cndmask_b32 v73, v73, v72, vcc
  buffer_store_dwordx4 v[68:71], v73, s[4:7], s23 offen sc1
  v_lshlrev_b32 v5, 2, v2
  s_lshl_b32 s17, s16, 6
  v_add_u32 v1, s17, v5
  s_waitcnt vmcnt(7)
  v_lshlrev_b32 v28, 16, v8
  v_and_b32 v29, 0xffff0000, v8
  v_lshlrev_b32 v30, 16, v9
  v_and_b32 v31, 0xffff0000, v9
  v_lshlrev_b32 v32, 16, v10
  v_and_b32 v33, 0xffff0000, v10
  v_lshlrev_b32 v34, 16, v11
  v_and_b32 v35, 0xffff0000, v11
  v_lshlrev_b32 v36, 16, v12
  v_and_b32 v37, 0xffff0000, v12
  v_lshlrev_b32 v38, 16, v13
  v_and_b32 v39, 0xffff0000, v13
  v_lshlrev_b32 v40, 16, v14
  v_and_b32 v41, 0xffff0000, v14
  v_lshlrev_b32 v42, 16, v15
  v_and_b32 v43, 0xffff0000, v15
  v_lshlrev_b32 v44, 16, v16
  v_and_b32 v45, 0xffff0000, v16
  v_lshlrev_b32 v46, 16, v17
  v_and_b32 v47, 0xffff0000, v17
  v_lshlrev_b32 v48, 16, v18
  v_and_b32 v49, 0xffff0000, v18
  v_lshlrev_b32 v50, 16, v19
  v_and_b32 v51, 0xffff0000, v19
  v_lshlrev_b32 v52, 16, v20
  v_and_b32 v53, 0xffff0000, v20
  v_lshlrev_b32 v54, 16, v21
  v_and_b32 v55, 0xffff0000, v21
  v_lshlrev_b32 v56, 16, v22
  v_and_b32 v57, 0xffff0000, v22
  v_lshlrev_b32 v58, 16, v23
  v_and_b32 v59, 0xffff0000, v23
  v_lshlrev_b32 v60, 16, v24
  v_and_b32 v61, 0xffff0000, v24
  v_lshlrev_b32 v62, 16, v25
  v_and_b32 v63, 0xffff0000, v25
  v_lshlrev_b32 v64, 16, v26
  v_and_b32 v65, 0xffff0000, v26
  v_lshlrev_b32 v66, 16, v27
  v_and_b32 v67, 0xffff0000, v27
  v_pk_add_f32 v[6:7], v[28:29], v[30:31]
  v_pk_add_f32 v[6:7], v[6:7], v[32:33]
  v_pk_add_f32 v[6:7], v[6:7], v[34:35]
  v_pk_add_f32 v[6:7], v[6:7], v[36:37]
  v_pk_add_f32 v[6:7], v[6:7], v[38:39]
  v_pk_add_f32 v[6:7], v[6:7], v[40:41]
  v_pk_add_f32 v[6:7], v[6:7], v[42:43]
  v_pk_add_f32 v[6:7], v[6:7], v[44:45]
  v_pk_add_f32 v[6:7], v[6:7], v[46:47]
  v_pk_add_f32 v[6:7], v[6:7], v[48:49]
  v_pk_add_f32 v[6:7], v[6:7], v[50:51]
  v_pk_add_f32 v[6:7], v[6:7], v[52:53]
  v_pk_add_f32 v[6:7], v[6:7], v[54:55]
  v_pk_add_f32 v[6:7], v[6:7], v[56:57]
  v_pk_add_f32 v[6:7], v[6:7], v[58:59]
  v_pk_add_f32 v[6:7], v[6:7], v[60:61]
  v_pk_add_f32 v[6:7], v[6:7], v[62:63]
  v_pk_add_f32 v[6:7], v[6:7], v[64:65]
  v_pk_add_f32 v[6:7], v[6:7], v[66:67]
  v_add_f32 v4, v6, v7
  v_mov_b32 v2, v4
  s_nop 1
  v_permlane32_swap_b32 v4, v2
  v_add_f32 v4, v4, v2
  v_mov_b32 v2, v4
  s_nop 1
  v_permlane16_swap_b32 v4, v2
  v_add_f32 v4, v4, v2
  ds_write_b32 v1, v4 offset:0
  s_waitcnt lgkmcnt(0)
  s_barrier
  ds_read_b32 v4, v5 offset:0
  ds_read_b32 v2, v5 offset:64
  ds_read_b32 v3, v5 offset:128
  ds_read_b32 v6, v5 offset:192
  s_waitcnt lgkmcnt(0)
  v_add_f32 v4, v4, v2
  v_add_f32 v3, v3, v6
  v_add_f32 v4, v4, v3
  v_mul_f32 v4, 0x3acccccd, v4
  v_sub_f32 v28, v28, v4
  v_sub_f32 v29, v29, v4
  v_sub_f32 v30, v30, v4
  v_sub_f32 v31, v31, v4
  v_sub_f32 v32, v32, v4
  v_sub_f32 v33, v33, v4
  v_sub_f32 v34, v34, v4
  v_sub_f32 v35, v35, v4
  v_sub_f32 v36, v36, v4
  v_sub_f32 v37, v37, v4
  v_sub_f32 v38, v38, v4
  v_sub_f32 v39, v39, v4
  v_sub_f32 v40, v40, v4
  v_sub_f32 v41, v41, v4
  v_sub_f32 v42, v42, v4
  v_sub_f32 v43, v43, v4
  v_sub_f32 v44, v44, v4
  v_sub_f32 v45, v45, v4
  v_sub_f32 v46, v46, v4
  v_sub_f32 v47, v47, v4
  v_sub_f32 v48, v48, v4
  v_sub_f32 v49, v49, v4
  v_sub_f32 v50, v50, v4
  v_sub_f32 v51, v51, v4
  v_sub_f32 v52, v52, v4
  v_sub_f32 v53, v53, v4
  v_sub_f32 v54, v54, v4
  v_sub_f32 v55, v55, v4
  v_sub_f32 v56, v56, v4
  v_sub_f32 v57, v57, v4
  v_sub_f32 v58, v58, v4
  v_sub_f32 v59, v59, v4
  v_sub_f32 v60, v60, v4
  v_sub_f32 v61, v61, v4
  v_sub_f32 v62, v62, v4
  v_sub_f32 v63, v63, v4
  v_sub_f32 v64, v64, v4
  v_sub_f32 v65, v65, v4
  v_sub_f32 v66, v66, v4
  v_sub_f32 v67, v67, v4
  v_mul_f32 v6, v28, v28
  v_mul_f32 v7, v29, v29
  v_fmac_f32 v6, v30, v30
  v_fmac_f32 v7, v31, v31
  v_fmac_f32 v6, v32, v32
  v_fmac_f32 v7, v33, v33
  v_fmac_f32 v6, v34, v34
  v_fmac_f32 v7, v35, v35
  v_fmac_f32 v6, v36, v36
  v_fmac_f32 v7, v37, v37
  v_fmac_f32 v6, v38, v38
  v_fmac_f32 v7, v39, v39
  v_fmac_f32 v6, v40, v40
  v_fmac_f32 v7, v41, v41
  v_fmac_f32 v6, v42, v42
  v_fmac_f32 v7, v43, v43
  v_fmac_f32 v6, v44, v44
  v_fmac_f32 v7, v45, v45
  v_fmac_f32 v6, v46, v46
  v_fmac_f32 v7, v47, v47
  v_fmac_f32 v6, v48, v48
  v_fmac_f32 v7, v49, v49
  v_fmac_f32 v6, v50, v50
  v_fmac_f32 v7, v51, v51
  v_fmac_f32 v6, v52, v52
  v_fmac_f32 v7, v53, v53
  v_fmac_f32 v6, v54, v54
  v_fmac_f32 v7, v55, v55
  v_fmac_f32 v6, v56, v56
  v_fmac_f32 v7, v57, v57
  v_fmac_f32 v6, v58, v58
  v_fmac_f32 v7, v59, v59
  v_fmac_f32 v6, v60, v60
  v_fmac_f32 v7, v61, v61
  v_fmac_f32 v6, v62, v62
  v_fmac_f32 v7, v63, v63
  v_fmac_f32 v6, v64, v64
  v_fmac_f32 v7, v65, v65
  v_fmac_f32 v6, v66, v66
  v_fmac_f32 v7, v67, v67
  v_add_f32 v4, v6, v7
  v_mov_b32 v2, v4
  s_nop 1
  v_permlane32_swap_b32 v4, v2
  v_add_f32 v4, v4, v2
  v_mov_b32 v2, v4
  s_nop 1
  v_permlane16_swap_b32 v4, v2
  v_add_f32 v4, v4, v2
  ds_write_b32 v1, v4 offset:256
  s_waitcnt lgkmcnt(0)
  s_barrier
  ds_read_b32 v4, v5 offset:256
  ds_read_b32 v2, v5 offset:320
  ds_read_b32 v3, v5 offset:384
  ds_read_b32 v6, v5 offset:448
  s_waitcnt lgkmcnt(0)
  v_add_f32 v4, v4, v2
  v_add_f32 v3, v3, v6
  v_add_f32 v4, v4, v3
  v_mov_b32 v2, 0x3727c5ac
  v_fmac_f32 v2, 0x3acccccd, v4
  v_rsq_f32 v4, v2
  s_nop 0
  v_mul_f32 v28, v28, v4
  v_mul_f32 v29, v29, v4
  v_mul_f32 v30, v30, v4
  v_mul_f32 v31, v31, v4
  v_mul_f32 v32, v32, v4
  v_mul_f32 v33, v33, v4
  v_mul_f32 v34, v34, v4
  v_mul_f32 v35, v35, v4
  v_mul_f32 v36, v36, v4
  v_mul_f32 v37, v37, v4
  v_mul_f32 v38, v38, v4
  v_mul_f32 v39, v39, v4
  v_mul_f32 v40, v40, v4
  v_mul_f32 v41, v41, v4
  v_mul_f32 v42, v42, v4
  v_mul_f32 v43, v43, v4
  v_mul_f32 v44, v44, v4
  v_mul_f32 v45, v45, v4
  v_mul_f32 v46, v46, v4
  v_mul_f32 v47, v47, v4
  v_mul_f32 v48, v48, v4
  v_mul_f32 v49, v49, v4
  v_mul_f32 v50, v50, v4
  v_mul_f32 v51, v51, v4
  v_mul_f32 v52, v52, v4
  v_mul_f32 v53, v53, v4
  v_mul_f32 v54, v54, v4
  v_mul_f32 v55, v55, v4
  v_mul_f32 v56, v56, v4
  v_mul_f32 v57, v57, v4
  v_mul_f32 v58, v58, v4
  v_mul_f32 v59, v59, v4
  v_mul_f32 v60, v60, v4
  v_mul_f32 v61, v61, v4
  v_mul_f32 v62, v62, v4
  v_mul_f32 v63, v63, v4
  v_mul_f32 v64, v64, v4
  v_mul_f32 v65, v65, v4
  v_mul_f32 v66, v66, v4
  v_mul_f32 v67, v67, v4
  v_cvt_pk_bf16_f32 v8, v28, v29
  v_cvt_pk_bf16_f32 v9, v30, v31
  v_cvt_pk_bf16_f32 v10, v32, v33
  v_cvt_pk_bf16_f32 v11, v34, v35
  v_cvt_pk_bf16_f32 v12, v36, v37
  v_cvt_pk_bf16_f32 v13, v38, v39
  v_cvt_pk_bf16_f32 v14, v40, v41
  v_cvt_pk_bf16_f32 v15, v42, v43
  v_cvt_pk_bf16_f32 v16, v44, v45
  v_cvt_pk_bf16_f32 v17, v46, v47
  v_cvt_pk_bf16_f32 v18, v48, v49
  v_cvt_pk_bf16_f32 v19, v50, v51
  v_cvt_pk_bf16_f32 v20, v52, v53
  v_cvt_pk_bf16_f32 v21, v54, v55
  v_cvt_pk_bf16_f32 v22, v56, v57
  v_cvt_pk_bf16_f32 v23, v58, v59
  v_cvt_pk_bf16_f32 v24, v60, v61
  v_cvt_pk_bf16_f32 v25, v62, v63
  v_cvt_pk_bf16_f32 v26, v64, v65
  v_cvt_pk_bf16_f32 v27, v66, v67
  v_and_b32 v3, 63, v0
  v_lshlrev_b32 v1, 4, v3
  s_mul_i32 s17, s2, 20480
  s_mul_i32 s18, s16, 5120
  s_add_u32 s17, s17, s18
  s_add_u32 s17, s17, 84934656
  buffer_store_dwordx4 v[8:11], v1, s[4:7], s17 offen offset:0 sc1
  buffer_store_dwordx4 v[12:15], v1, s[4:7], s17 offen offset:1024 sc1
  buffer_store_dwordx4 v[16:19], v1, s[4:7], s17 offen offset:2048 sc1
  buffer_store_dwordx4 v[20:23], v1, s[4:7], s17 offen offset:3072 sc1
  s_add_u32 s17, s17, 4096
  buffer_store_dwordx4 v[24:27], v1, s[4:7], s17 offen offset:0 sc1
ln2_exit1:
  s_endpgm
.globl reca_kernel
.p2align 8
.type reca_kernel,@function
reca_kernel:
  s_cmp_ge_u32 s2, 256
  s_cbranch_scc1 reca_exitb3
  s_load_dwordx2 s[48:49], s[0:1], 96
  s_load_dwordx2 s[50:51], s[0:1], 88
  s_load_dwordx2 s[52:53], s[0:1], 8
  s_getreg_b32 s42, hwreg(HW_REG_XCC_ID, 0, 3)
  v_lshrrev_b32 v28, 6, v0
  v_and_b32 v29, 63, v0
  s_and_b32 s13, s2, 7
  v_readfirstlane_b32 s12, v28
  v_lshlrev_b32 v1, 4, v29
  s_lshr_b32 s14, s2, 3
  s_mov_b32 s18, 0x100000
  s_waitcnt lgkmcnt(0)
  s_mov_b32 s57, 0
  s_mov_b32 s4, s48
  s_mov_b32 s5, s49
  s_mov_b32 s6, 0x10000000
  s_mov_b32 s7, 0x20000
  s_mov_b32 s8, s50
  s_mov_b32 s9, s51
  s_mov_b32 s10, 256
  s_mov_b32 s11, 0x20000
  v_add_u32 v2, 0x1000, v1
  v_add_u32 v3, 0x2000, v1
  v_mov_b32 v31, 0x80000000
  s_lshl_b32 s34, s42, 3
  s_lshl_b64 s[36:37], 1, s34
  s_lshl_b32 s34, s13, 3
  v_cmp_eq_u32 vcc, 0, v0
  v_mov_b32 v30, s34
  s_nop 0
  v_cndmask_b32 v30, v31, v30, vcc
  v_mov_b32 v44, s36
  v_mov_b32 v45, s37
  buffer_atomic_add_x2 v[44:45], v30, s[8:11], 0 offen
  s_sub_u32 s56, 0, s48
  s_and_b32 s56, s56, 0x1fffff
  s_add_u32 s56, s56, 2097152
  s_nop 0
  s_cmp_ge_u32 s14, 24
  s_cbranch_scc1 reca_proj2
  s_mul_i32 s34, s14, 43
  s_lshr_b32 s34, s34, 8
  s_mul_i32 s35, s34, 6
  s_sub_u32 s16, s14, s35
  s_lshl_b32 s15, s13, 2
  s_add_u32 s15, s15, s34
  s_lshr_b32 s19, s12, 1
  s_and_b32 s37, s12, 1
  s_mul_i32 s34, s15, 12
  s_lshl_b32 s35, s16, 1
  s_add_u32 s34, s34, s35
  s_add_u32 s34, s34, s37
  s_mul_i32 s34, s34, 20480
  s_mov_b32 s35, 14155776
  s_cmp_eq_u32 s19, 0
  s_cselect_b32 s35, 6291456, s35
  s_add_u32 s35, s35, s34
  s_mul_i32 s36, s19, 10240
  s_add_u32 s20, s35, s36
  s_sub_u32 s36, 10240, s36
  s_add_u32 s21, s35, s36
  s_add_u32 s22, s34, 22020096
  s_mul_i32 s36, s19, 10240
  s_add_u32 s22, s22, s36
  buffer_load_dwordx4 a[0:3], v1, s[4:7], s20 offen offset:0
  buffer_load_dwordx4 a[4:7], v1, s[4:7], s20 offen offset:1024
  buffer_load_dwordx4 a[8:11], v1, s[4:7], s20 offen offset:2048
  buffer_load_dwordx4 a[12:15], v1, s[4:7], s20 offen offset:3072
  buffer_load_dwordx4 a[16:19], v2, s[4:7], s20 offen offset:0
  buffer_load_dwordx4 a[20:23], v2, s[4:7], s20 offen offset:1024
  buffer_load_dwordx4 a[24:27], v2, s[4:7], s20 offen offset:2048
  buffer_load_dwordx4 a[28:31], v2, s[4:7], s20 offen offset:3072
  buffer_load_dwordx4 a[32:35], v3, s[4:7], s20 offen offset:0
  buffer_load_dwordx4 a[36:39], v3, s[4:7], s20 offen offset:1024
  buffer_load_dwordx4 a[40:43], v1, s[4:7], s21 offen offset:0
  buffer_load_dwordx4 a[44:47], v1, s[4:7], s21 offen offset:1024
  buffer_load_dwordx4 a[48:51], v1, s[4:7], s21 offen offset:2048
  buffer_load_dwordx4 a[52:55], v1, s[4:7], s21 offen offset:3072
  buffer_load_dwordx4 a[56:59], v2, s[4:7], s21 offen offset:0
  buffer_load_dwordx4 a[60:63], v2, s[4:7], s21 offen offset:1024
  buffer_load_dwordx4 a[64:67], v2, s[4:7], s21 offen offset:2048
  buffer_load_dwordx4 a[68:71], v2, s[4:7], s21 offen offset:3072
  buffer_load_dwordx4 a[72:75], v3, s[4:7], s21 offen offset:0
  buffer_load_dwordx4 a[76:79], v3, s[4:7], s21 offen offset:1024
  buffer_load_dwordx4 a[80:83], v1, s[4:7], s22 offen offset:0
  buffer_load_dwordx4 a[84:87], v1, s[4:7], s22 offen offset:1024
  buffer_load_dwordx4 a[88:91], v1, s[4:7], s22 offen offset:2048
  buffer_load_dwordx4 a[92:95], v1, s[4:7], s22 offen offset:3072
  buffer_load_dwordx4 a[96:99], v2, s[4:7], s22 offen offset:0
  buffer_load_dwordx4 a[100:103], v2, s[4:7], s22 offen offset:1024
  buffer_load_dwordx4 a[104:107], v2, s[4:7], s22 offen offset:2048
  buffer_load_dwordx4 a[108:111], v2, s[4:7], s22 offen offset:3072
  buffer_load_dwordx4 a[112:115], v3, s[4:7], s22 offen offset:0
  buffer_load_dwordx4 a[116:119], v3, s[4:7], s22 offen offset:1024
  s_cmp_ge_u32 s14, 20
  s_cbranch_scc1 reca_now24
  s_cmp_ge_u32 s12, 2
  s_cbranch_scc1 reca_now24
  s_lshl_b32 s34, s14, 1
  s_add_u32 s34, s34, s12
  s_mul_i32 s34, s34, 192
  s_mul_i32 s35, s13, 24
  s_add_u32 s34, s34, s35
  s_lshl_b32 s34, s34, 10
  s_add_u32 s34, s34, 29884416
  buffer_load_dwordx4 a[120:123], v1, s[4:7], s34 offen offset:0
  buffer_load_dwordx4 a[124:127], v1, s[4:7], s34 offen offset:1024
  buffer_load_dwordx4 a[128:131], v1, s[4:7], s34 offen offset:2048
  buffer_load_dwordx4 a[132:135], v1, s[4:7], s34 offen offset:3072
  buffer_load_dwordx4 a[136:139], v2, s[4:7], s34 offen offset:0
  buffer_load_dwordx4 a[140:143], v2, s[4:7], s34 offen offset:1024
  buffer_load_dwordx4 a[144:147], v2, s[4:7], s34 offen offset:2048
  buffer_load_dwordx4 a[148:151], v2, s[4:7], s34 offen offset:3072
  buffer_load_dwordx4 a[152:155], v3, s[4:7], s34 offen offset:0
  buffer_load_dwordx4 a[156:159], v3, s[4:7], s34 offen offset:1024
  buffer_load_dwordx4 a[160:163], v3, s[4:7], s34 offen offset:2048
  buffer_load_dwordx4 a[164:167], v3, s[4:7], s34 offen offset:3072
  s_add_u32 s34, s34, 12288
  buffer_load_dwordx4 a[168:171], v1, s[4:7], s34 offen offset:0
  buffer_load_dwordx4 a[172:175], v1, s[4:7], s34 offen offset:1024
  buffer_load_dwordx4 a[176:179], v1, s[4:7], s34 offen offset:2048
  buffer_load_dwordx4 a[180:183], v1, s[4:7], s34 offen offset:3072
  buffer_load_dwordx4 a[184:187], v2, s[4:7], s34 offen offset:0
  buffer_load_dwordx4 a[188:191], v2, s[4:7], s34 offen offset:1024
  buffer_load_dwordx4 a[192:195], v2, s[4:7], s34 offen offset:2048
  buffer_load_dwordx4 a[196:199], v2, s[4:7], s34 offen offset:3072
  buffer_load_dwordx4 a[200:203], v3, s[4:7], s34 offen offset:0
  buffer_load_dwordx4 a[204:207], v3, s[4:7], s34 offen offset:1024
  buffer_load_dwordx4 a[208:211], v3, s[4:7], s34 offen offset:2048
  buffer_load_dwordx4 a[212:215], v3, s[4:7], s34 offen offset:3072
reca_now24:
  v_and_b32 v29, 63, v0
  v_and_b32 v28, 15, v29
  v_lshrrev_b32 v30, 4, v29
  v_mov_b32 v32, -1
  v_mov_b32 v33, -1
  v_mov_b32 v34, -1
  v_mov_b32 v35, -1
  s_mul_i32 s34, s12, 2560
  v_add_u32 v4, s34, v1
  v_and_b32 v44, 31, v29
  v_lshlrev_b32 v44, 4, v44
  s_add_u32 s34, s34, 2048
  v_add_u32 v5, s34, v44
  v_and_b32 v44, 7, v29
  v_lshlrev_b32 v44, 4, v44
  v_lshl_add_u32 v44, v30, 7, v44
  s_mul_i32 s34, s19, 5120
  v_add_u32 v6, s34, v44
  s_sub_u32 s34, 5120, s34
  v_add_u32 v7, s34, v44
  v_lshrrev_b32 v45, 3, v28
  v_lshl_add_u32 v12, v45, 9, v44
  s_mul_i32 s34, s19, 5120
  v_add_u32 v236, s34, v12
  s_sub_u32 s34, 5120, s34
  v_add_u32 v237, s34, v12
  v_add_u32 v13, 0x1000, v12
  v_add_u32 v14, 0x2000, v12
  v_cmp_gt_u32 s[54:55], 8, v28
  s_lshl_b32 s34, s16, 10
  s_lshl_b32 s35, s19, 7
  s_add_u32 s34, s34, s35
  s_and_b32 s35, s12, 1
  s_lshl_b32 s36, s35, 3
  s_add_u32 s34, s34, s36
  v_lshlrev_b32 v44, 4, v28
  v_lshl_add_u32 v45, v30, 8, v44
  v_add_u32 v45, s34, v45
  v_cndmask_b32 v8, v31, v45, s[54:55]
  v_lshl_add_u32 v44, v30, 7, v44
  v_add_u32 v45, s36, v44
  v_cndmask_b32 v9, v31, v45, s[54:55]
  s_lshl_b32 s34, s14, 9
  v_add_u32 v45, s34, v44
  v_cndmask_b32 v11, v31, v45, s[54:55]
  s_mul_i32 s34, s13, 49152
  s_lshr_b32 s35, s14, 3
  s_lshl_b32 s35, s35, 14
  s_add_u32 s34, s34, s35
  s_and_b32 s35, s14, 7
  s_lshl_b32 s35, s35, 10
  s_add_u32 s34, s34, s35
  s_lshl_b32 s35, s12, 9
  s_add_u32 s34, s34, s35
  v_add_u32 v45, s34, v44
  v_cndmask_b32 v15, v31, v45, s[54:55]
  s_cmp_lt_u32 s14, 20
  s_cselect_b32 s34, 0, 0x80000000
  v_or_b32 v15, s34, v15
  v_lshlrev_b32 v45, 3, v29
  v_cmp_gt_u32 vcc, 32, v29
  s_nop 1
  v_cndmask_b32 v10, v31, v45, vcc
  s_sub_u32 s35, s14, 4
  s_cmp_lt_u32 s14, 20
  s_cselect_b32 s34, s14, s35
  s_lshr_b32 s35, s34, 3
  s_lshl_b32 s35, s35, 14
  s_and_b32 s34, s34, 7
  s_lshl_b32 s34, s34, 10
  s_add_u32 s34, s34, s35
  v_add_u32 v20, s34, v1
  v_add_u32 v21, 49152, v20
  v_add_u32 v22, 98304, v20
  v_add_u32 v23, 147456, v20
  v_add_u32 v24, 196608, v20
  v_add_u32 v25, 245760, v20
  v_add_u32 v26, 294912, v20
  v_add_u32 v27, 344064, v20
  v_lshrrev_b32 v44, 3, v29
  v_and_b32 v44, 3, v44
  v_lshlrev_b32 v44, 7, v44
  v_and_b32 v45, 7, v29
  v_lshl_add_u32 v44, v45, 4, v44
  v_lshrrev_b32 v45, 5, v29
  v_lshl_add_u32 v44, v45, 3, v44
  s_lshl_b32 s34, s14, 9
  s_cmp_lt_u32 s14, 20
  s_cselect_b32 s34, s34, 0x80000000
  v_add_u32 v16, s34, v44
  v_cmp_eq_u32 vcc, 0, v29
  v_mov_b32 v45, 0
  s_nop 0
  v_cndmask_b32 v19, v31, v45, vcc
  s_lshl_b32 s34, s15, 8
  s_add_u32 s34, s34, 1540096
  v_and_b32 v45, 1, v29
  v_lshlrev_b32 v45, 7, v45
  v_add_u32 v233, s34, v45
  s_lshl_b32 s34, s12, 10
  s_add_u32 s34, s34, 10240
  v_add_u32 v17, s34, v1
  v_mov_b32 v36, 0x3f803f80
  v_mov_b32 v37, 0x3f803f80
  v_mov_b32 v38, 0x3f803f80
  v_mov_b32 v39, 0x3f803f80
  v_mov_b32 v44, 0xf149f2ca
  v_cmp_gt_u32 vcc, 2, v30
  s_nop 1
  v_cndmask_b32 v40, 0, v44, vcc
  v_mov_b32 v41, v40
  v_mov_b32 v42, v40
  v_mov_b32 v43, v40
  v_and_b32 v44, 31, v29
  v_lshlrev_b32 v44, 4, v44
  v_add_u32 v45, 47972352, v44
  v_add_u32 v44, 47185920, v44
  v_cmp_gt_u32 vcc, 32, v29
  s_nop 1
  v_cndmask_b32 v238, v45, v44, vcc
  s_mov_b32 s41, 0x3dd53b95
  s_mul_i32 s38, s13, 40960
  s_add_u32 s38, s38, 0
  s_mul_i32 s39, s15, 24576
  s_add_u32 s39, s39, 327680
  s_mul_i32 s40, s13, 49152
  s_add_u32 s40, s40, 1114112
  s_mov_b32 s60, s52
  s_mov_b32 s61, s53
  s_mov_b32 s62, 10240
  s_mov_b32 s63, 0x20000
  v_and_b32 v29, 63, v0
  v_and_b32 v44, 7, v29
  v_mul_u32_u24 v44, 1280, v44
  v_lshrrev_b32 v45, 3, v29
  v_and_b32 v45, 3, v45
  v_lshl_add_u32 v44, v45, 4, v44
  s_mul_i32 s34, s12, 320
  v_add_u32 v44, s34, v44
  v_add_u32 v46, 256, v44
  v_lshrrev_b32 v45, 5, v29
  v_lshl_add_u32 v44, v45, 6, v44
  buffer_load_dwordx4 v[128:131], v44, s[60:63], 0 offen
  buffer_load_dwordx4 v[132:135], v44, s[60:63], 0 offen offset:128
  buffer_load_dwordx4 v[136:139], v46, s[60:63], 0 offen
  v_and_b32 v44, 63, v0
  v_and_b32 v45, 3, v44
  v_lshlrev_b32 v45, 21, v45
  v_min_u32 v45, 786368, v45
  v_add_u32 v46, 47185920, v45
  v_add_u32 v45, 47972352, v45
  v_cmp_gt_u32 vcc, 4, v44
  s_nop 1
  v_cndmask_b32 v46, v45, v46, vcc
  s_mul_i32 s34, s15, 98304
  v_and_b32 v45, 1, v44
  v_mul_u32_u24 v45, 98240, v45
  v_add_u32 v45, s34, v45
  v_add_u32 v28, 37748736, v45
  v_add_u32 v45, 40894464, v45
  v_cmp_gt_u32 vcc, 10, v44
  s_nop 1
  v_cndmask_b32 v45, v45, v28, vcc
  v_cmp_gt_u32 vcc, 8, v44
  s_nop 1
  v_cndmask_b32 v46, v45, v46, vcc
  v_cmp_gt_u32 vcc, 12, v44
  s_nop 1
  v_cndmask_b32 v46, v31, v46, vcc
  buffer_load_dword v234, v46, s[4:7], 0 offen
  v_and_b32 v44, 63, v0
  v_lshlrev_b32 v45, 21, v44
  v_min_u32 v45, 25165760, v45
  v_add_u32 v45, 57147392, v45
  s_lshl_b32 s34, s13, 2
  s_add_u32 s34, s34, s14
  s_sub_u32 s34, s34, 20
  s_and_b32 s34, s34, 31
  s_mul_i32 s34, s34, 98304
  s_add_u32 s34, s34, 44040192
  v_and_b32 v46, 1, v44
  v_mul_u32_u24 v46, 98240, v46
  v_add_u32 v46, s34, v46
  v_cmp_gt_u32 vcc, 13, v44
  s_nop 1
  v_cndmask_b32 v46, v46, v45, vcc
  v_cmp_gt_u32 vcc, 15, v44
  s_nop 1
  v_cndmask_b32 v46, v31, v46, vcc
  buffer_load_dword v235, v46, s[4:7], 0 offen
  v_and_b32 v30, 7, v0
  v_lshlrev_b32 v30, 3, v30
reca_cens5:
  buffer_load_dwordx2 v[28:29], v30, s[8:11], 0 offen sc1
  s_waitcnt vmcnt(0)
  v_sad_u8 v31, v28, 0, 0
  v_sad_u8 v31, v29, 0, v31
  v_cmp_gt_u32 vcc, 32, v31
  s_cbranch_vccz reca_censok6
  s_sleep 8
  s_sub_u32 s18, s18, 1
  s_cbranch_scc0 reca_cens5
  s_mov_b32 s18, 0
reca_censok6:
  v_and_b32 v28, 0x20202020, v28
  v_and_b32 v29, 0x20202020, v29
  v_cmp_ne_u32 s[34:35], 0, v28
  v_cmp_ne_u32 s[36:37], 0, v29
  s_nop 3
  s_and_b32 s34, s34, 0xff
  s_and_b32 s36, s36, 0xff
  s_or_b32 s35, s34, s36
  s_lshr_b32 s37, s35, s13
  s_and_b32 s37, s37, 1
  s_xor_b32 s43, s37, 1
  s_cmp_eq_u32 s57, 0
  s_cselect_b32 s58, s36, s34
  v_mov_b32 v31, 0x80000000
  v_add_u32 v232, 0x2000, v15
  s_lshr_b32 s44, s2, 4
  s_lshl_b32 s44, s44, 14
  s_and_b32 s34, s2, 15
  s_lshl_b32 s34, s34, 9
  s_add_u32 s44, s44, s34
  s_add_u32 s44, s44, 1572864
  s_add_u32 s44, s44, s56
  s_mov_b32 s45, -1
  s_mov_b32 s47, -1
  s_cmp_lg_u32 s12, 2
  s_cbranch_scc1 reca_noprobe7
  s_add_u32 s35, s44, 0
  s_memtime s[60:61]
  s_waitcnt lgkmcnt(0)
  buffer_load_dword v28, v19, s[4:7], s35 offen sc1
  s_waitcnt vmcnt(0)
  s_memtime s[62:63]
  s_waitcnt lgkmcnt(0)
  s_sub_u32 s36, s62, s60
  s_min_u32 s45, s45, s36
  s_add_u32 s35, s44, 8192
  s_memtime s[60:61]
  s_waitcnt lgkmcnt(0)
  buffer_load_dword v28, v19, s[4:7], s35 offen sc1
  s_waitcnt vmcnt(0)
  s_memtime s[62:63]
  s_waitcnt lgkmcnt(0)
  s_sub_u32 s36, s62, s60
  s_min_u32 s47, s47, s36
  s_add_u32 s35, s44, 128
  s_memtime s[60:61]
  s_waitcnt lgkmcnt(0)
  buffer_load_dword v28, v19, s[4:7], s35 offen sc1
  s_waitcnt vmcnt(0)
  s_memtime s[62:63]
  s_waitcnt lgkmcnt(0)
  s_sub_u32 s36, s62, s60
  s_min_u32 s45, s45, s36
  s_add_u32 s35, s44, 8320
  s_memtime s[60:61]
  s_waitcnt lgkmcnt(0)
  buffer_load_dword v28, v19, s[4:7], s35 offen sc1
  s_waitcnt vmcnt(0)
  s_memtime s[62:63]
  s_waitcnt lgkmcnt(0)
  s_sub_u32 s36, s62, s60
  s_min_u32 s47, s47, s36
  s_add_u32 s35, s44, 256
  s_memtime s[60:61]
  s_waitcnt lgkmcnt(0)
  buffer_load_dword v28, v19, s[4:7], s35 offen sc1
  s_waitcnt vmcnt(0)
  s_memtime s[62:63]
  s_waitcnt lgkmcnt(0)
  s_sub_u32 s36, s62, s60
  s_min_u32 s45, s45, s36
  s_add_u32 s35, s44, 8448
  s_memtime s[60:61]
  s_waitcnt lgkmcnt(0)
  buffer_load_dword v28, v19, s[4:7], s35 offen sc1
  s_waitcnt vmcnt(0)
  s_memtime s[62:63]
  s_waitcnt lgkmcnt(0)
  s_sub_u32 s36, s62, s60
  s_min_u32 s47, s47, s36
  s_cmp_lt_u32 s47, s45
  s_cbranch_scc0 reca_noprobe7
  v_add_u32 v20, 0x2000, v20
  v_add_u32 v21, 0x2000, v21
  v_add_u32 v22, 0x2000, v22
  v_add_u32 v23, 0x2000, v23
  v_add_u32 v24, 0x2000, v24
  v_add_u32 v25, 0x2000, v25
  v_add_u32 v26, 0x2000, v26
  v_add_u32 v27, 0x2000, v27
reca_noprobe7:
  s_lshl_b32 s59, s13, 2
  s_add_u32 s59, s59, s14
  s_sub_u32 s59, s59, 20
  v_and_b32 v29, 63, v0
  v_and_b32 v28, 15, v29
  v_lshrrev_b32 v30, 4, v29
  v_lshlrev_b32 v92, 4, v28
  v_lshl_add_u32 v92, v30, 7, v92
  v_cmp_gt_u32 vcc, 8, v28
  s_nop 1
  v_cndmask_b32 v92, v31, v92, vcc
  v_lshlrev_b32 v93, 3, v29
  v_cmp_gt_u32 vcc, 32, v29
  s_nop 1
  v_cndmask_b32 v93, v31, v93, vcc
  v_mov_b32 v82, 0xf149f2ca
  v_cmp_le_u32 vcc, 2, v30
  s_nop 1
  v_cndmask_b32 v84, 0, v82, vcc
  v_mov_b32 v85, v84
  v_mov_b32 v86, v84
  v_mov_b32 v87, v84
  v_lshlrev_b32 v30, 2, v30
  v_add_u32 v29, 0, v30
  v_cmp_gt_u32 vcc, v29, v28
  s_nop 1
  v_cndmask_b32 v88, 0, v82, vcc
  v_add_u32 v29, 1, v30
  v_cmp_gt_u32 vcc, v29, v28
  s_nop 1
  v_cndmask_b32 v89, 0, v82, vcc
  v_add_u32 v29, 2, v30
  v_cmp_gt_u32 vcc, v29, v28
  s_nop 1
  v_cndmask_b32 v90, 0, v82, vcc
  v_add_u32 v29, 3, v30
  v_cmp_gt_u32 vcc, v29, v28
  s_nop 1
  v_cndmask_b32 v91, 0, v82, vcc
  s_mov_b32 s17, 0
  s_cmp_lg_u32 s12, 3
  s_cbranch_scc1 reca_nopf08
  s_add_u32 s37, s17, 1
reca_pf9:
  buffer_load_dword v28, v233, s[4:7], 0 offen sc1
  s_waitcnt vmcnt(0)
  v_cmp_gt_i32 vcc, s37, v28
  s_cbranch_vccz reca_pfok10
  s_sleep 1
  s_sub_u32 s18, s18, 1
  s_cbranch_scc0 reca_pf9
  s_mov_b32 s18, 0
reca_pfok10:
  s_lshl_b32 s34, s15, 3
  s_and_b32 s35, s17, 7
  s_add_u32 s34, s34, s35
  s_mul_i32 s34, s34, 12288
  s_add_u32 s32, s34, 37748736
  s_lshl_b32 s35, s16, 11
  s_add_u32 s34, s34, s35
  s_add_u32 s33, s34, 40894464
  buffer_load_dwordx4 a[120:123], v1, s[4:7], s32 offen offset:0 sc1
  buffer_load_dwordx4 a[124:127], v1, s[4:7], s32 offen offset:1024 sc1
  buffer_load_dwordx4 a[128:131], v1, s[4:7], s32 offen offset:2048 sc1
  buffer_load_dwordx4 a[132:135], v1, s[4:7], s32 offen offset:3072 sc1
  buffer_load_dwordx4 a[136:139], v2, s[4:7], s32 offen offset:0 sc1
  buffer_load_dwordx4 a[140:143], v2, s[4:7], s32 offen offset:1024 sc1
  buffer_load_dwordx4 a[144:147], v2, s[4:7], s32 offen offset:2048 sc1
  buffer_load_dwordx4 a[148:151], v2, s[4:7], s32 offen offset:3072 sc1
  buffer_load_dwordx4 a[152:155], v3, s[4:7], s32 offen offset:0 sc1
  buffer_load_dwordx4 a[156:159], v3, s[4:7], s32 offen offset:1024 sc1
  buffer_load_dwordx4 a[160:163], v3, s[4:7], s32 offen offset:2048 sc1
  buffer_load_dwordx4 a[164:167], v3, s[4:7], s32 offen offset:3072 sc1
  buffer_load_dwordx4 a[168:171], v1, s[4:7], s33 offen offset:0 sc1
  buffer_load_dwordx4 a[172:175], v1, s[4:7], s33 offen offset:1024 sc1
  s_waitcnt vmcnt(0)
reca_nopf08:
  s_cmp_lg_u32 s43, 0
  s_cbranch_scc1 reca_slow11
  s_cmp_ge_u32 s14, 20
  s_cbranch_scc1 reca_twinf12
  s_branch reca_gotmem15
reca_step14:
  s_and_b32 s34, s17, 3
  s_mul_i32 s20, s34, 10240
  s_add_u32 s20, s20, s38
  s_sleep 2
  buffer_load_dwordx4 v[128:131], v4, s[4:7], s20 offen sc1
  buffer_load_dwordx4 v[132:135], v4, s[4:7], s20 offen offset:1024 sc1
  buffer_load_dwordx4 v[136:139], v5, s[4:7], s20 offen sc1
  s_waitcnt vmcnt(2)
  v_max_u32 v29, v128, v130
  v_cmp_eq_u32 vcc, -1, v29
  s_cbranch_vccnz reca_retry17
reca_resume18:
  s_waitcnt vmcnt(1)
  v_max_u32 v29, v132, v134
  v_cmp_eq_u32 vcc, -1, v29
  ds_write_b128 v4, v[128:131]
  s_cbranch_vccnz reca_retry19
reca_resume20:
  s_waitcnt vmcnt(0)
  v_max_u32 v29, v136, v138
  v_cmp_eq_u32 vcc, -1, v29
  ds_write_b128 v4, v[132:135] offset:1024
  s_cbranch_vccnz reca_retry21
reca_resume22:
  ds_write_b128 v5, v[136:139]
  s_branch reca_gotmem216
reca_gotmem15:
  ds_write_b128 v4, v[128:131]
  ds_write_b128 v4, v[132:135] offset:1024
  ds_write_b128 v5, v[136:139]
reca_gotmem216:
  s_and_b32 s34, s17, 3
  s_mul_i32 s21, s34, 6144
  s_add_u32 s21, s21, s39
  s_mul_i32 s22, s34, 12288
  s_add_u32 s22, s22, s40
  s_mul_i32 s25, s34, 393216
  s_add_u32 s25, s25, s56
  s_add_u32 s35, s17, 1
  s_and_b32 s35, s35, 3
  s_mul_i32 s24, s35, 10240
  s_add_u32 s24, s24, s38
  s_waitcnt lgkmcnt(0)
  s_barrier
  ds_read_b128 v[128:131], v236 offset:0
  ds_read_b128 v[132:135], v236 offset:1024
  ds_read_b128 v[136:139], v236 offset:2048
  ds_read_b128 v[140:143], v236 offset:3072
  ds_read_b128 v[144:147], v236 offset:4096
  ds_read_b128 v[148:151], v237 offset:0
  ds_read_b128 v[152:155], v237 offset:1024
  ds_read_b128 v[156:159], v237 offset:2048
  ds_read_b128 v[160:163], v237 offset:3072
  ds_read_b128 v[164:167], v237 offset:4096
  s_waitcnt lgkmcnt(9)
  v_mfma_f32_16x16x32_bf16 v[44:47], a[0:3], v[128:131], 0
  ds_read_b128 v[168:171], v6 offset:0
  v_mfma_f32_16x16x32_bf16 v[240:243], a[4:7], v[128:131], 0
  s_waitcnt lgkmcnt(9)
  v_mfma_f32_16x16x32_bf16 v[44:47], a[8:11], v[132:135], v[44:47]
  ds_read_b128 v[172:175], v6 offset:512
  v_mfma_f32_16x16x32_bf16 v[240:243], a[12:15], v[132:135], v[240:243]
  s_waitcnt lgkmcnt(9)
  v_mfma_f32_16x16x32_bf16 v[44:47], a[16:19], v[136:139], v[44:47]
  ds_read_b128 v[176:179], v6 offset:1024
  v_mfma_f32_16x16x32_bf16 v[240:243], a[20:23], v[136:139], v[240:243]
  s_waitcnt lgkmcnt(9)
  v_mfma_f32_16x16x32_bf16 v[44:47], a[24:27], v[140:143], v[44:47]
  ds_read_b128 v[180:183], v6 offset:1536
  v_mfma_f32_16x16x32_bf16 v[240:243], a[28:31], v[140:143], v[240:243]
  s_waitcnt lgkmcnt(9)
  v_mfma_f32_16x16x32_bf16 v[44:47], a[32:35], v[144:147], v[44:47]
  ds_read_b128 v[184:187], v6 offset:2048
  v_mfma_f32_16x16x32_bf16 v[240:243], a[36:39], v[144:147], v[240:243]
  s_waitcnt lgkmcnt(9)
  v_mfma_f32_16x16x32_bf16 v[44:47], a[40:43], v[148:151], v[44:47]
  ds_read_b128 v[188:191], v6 offset:2560
  v_mfma_f32_16x16x32_bf16 v[240:243], a[44:47], v[148:151], v[240:243]
  s_waitcnt lgkmcnt(9)
  v_mfma_f32_16x16x32_bf16 v[44:47], a[48:51], v[152:155], v[44:47]
  ds_read_b128 v[192:195], v6 offset:3072
  v_mfma_f32_16x16x32_bf16 v[240:243], a[52:55], v[152:155], v[240:243]
  s_waitcnt lgkmcnt(9)
  v_mfma_f32_16x16x32_bf16 v[44:47], a[56:59], v[156:159], v[44:47]
  ds_read_b128 v[196:199], v6 offset:3584
  v_mfma_f32_16x16x32_bf16 v[240:243], a[60:63], v[156:159], v[240:243]
  s_waitcnt lgkmcnt(9)
  v_mfma_f32_16x16x32_bf16 v[44:47], a[64:67], v[160:163], v[44:47]
  ds_read_b128 v[200:203], v6 offset:4096
  v_mfma_f32_16x16x32_bf16 v[240:243], a[68:71], v[160:163], v[240:243]
  s_waitcnt lgkmcnt(9)
  v_mfma_f32_16x16x32_bf16 v[44:47], a[72:75], v[164:167], v[44:47]
  ds_read_b128 v[204:207], v6 offset:4608
  v_mfma_f32_16x16x32_bf16 v[240:243], a[76:79], v[164:167], v[240:243]
  s_waitcnt lgkmcnt(9)
  v_mfma_f32_16x16x32_bf16 v[48:51], v[168:171], a[80:83], 0
  s_and_b32 s34, s17, 7
  s_lshl_b32 s34, s34, 5
  s_add_u32 s34, s34, s15
  s_mul_i32 s34, s34, 3072
  s_lshl_b32 s35, s16, 9
  s_add_u32 s34, s34, s35
  s_add_u32 s30, s34, 47185920
  s_add_u32 s31, s34, 47972352
  v_add_f32_dpp v44, v240, v44 row_ror:8 row_mask:0xf bank_mask:0xf
  v_add_f32_dpp v45, v241, v45 row_ror:8 row_mask:0xf bank_mask:0xf
  v_add_f32_dpp v46, v242, v46 row_ror:8 row_mask:0xf bank_mask:0xf
  v_add_f32_dpp v47, v243, v47 row_ror:8 row_mask:0xf bank_mask:0xf
  v_cvt_pk_bf16_f32 v52, v44, v45
  v_cvt_pk_bf16_f32 v53, v46, v47
  buffer_store_dwordx2 v[52:53], v8, s[4:7], s21 offen
  s_waitcnt lgkmcnt(8)
  v_mfma_f32_16x16x32_bf16 v[48:51], v[172:175], a[84:87], v[48:51]
  s_waitcnt lgkmcnt(7)
  v_mfma_f32_16x16x32_bf16 v[48:51], v[176:179], a[88:91], v[48:51]
  s_waitcnt lgkmcnt(6)
  v_mfma_f32_16x16x32_bf16 v[48:51], v[180:183], a[92:95], v[48:51]
  s_waitcnt lgkmcnt(5)
  v_mfma_f32_16x16x32_bf16 v[48:51], v[184:187], a[96:99], v[48:51]
  s_waitcnt lgkmcnt(4)
  v_mfma_f32_16x16x32_bf16 v[48:51], v[188:191], a[100:103], v[48:51]
  s_waitcnt lgkmcnt(3)
  v_mfma_f32_16x16x32_bf16 v[48:51], v[192:195], a[104:107], v[48:51]
  s_waitcnt lgkmcnt(2)
  v_mfma_f32_16x16x32_bf16 v[48:51], v[196:199], a[108:111], v[48:51]
  s_waitcnt lgkmcnt(1)
  v_mfma_f32_16x16x32_bf16 v[48:51], v[200:203], a[112:115], v[48:51]
  s_waitcnt lgkmcnt(0)
  v_mfma_f32_16x16x32_bf16 v[48:51], v[204:207], a[116:119], v[48:51]
  s_cmp_eq_u32 s12, 3
  s_cbranch_scc1 reca_swave23
  s_nop 5
  ds_write_b128 v17, v[48:51]
  s_add_u32 s34, s17, 2
  s_and_b32 s34, s34, 3
  s_mul_i32 s26, s34, 10240
  s_add_u32 s26, s26, s38
  s_mul_i32 s27, s34, 6144
  s_add_u32 s27, s27, s39
  s_mul_i32 s28, s34, 12288
  s_add_u32 s28, s28, s40
  s_mul_i32 s29, s34, 393216
  s_add_u32 s29, s29, s56
  s_waitcnt lgkmcnt(0)
  s_barrier
  s_cmp_eq_u32 s17, 63
  s_cbranch_scc1 reca_last25
  buffer_store_dwordx2 v[32:33], v8, s[4:7], s27 offen
  s_cmp_lg_u32 s12, 2
  s_cbranch_scc1 reca_b326
  buffer_store_dwordx2 v[52:53], v9, s[4:7], s30 offen
  buffer_store_dwordx2 v[32:33], v16, s[4:7], s26 offen
  s_cmp_lg_u32 s14, 0
  s_cbranch_scc1 reca_b326
  v_mov_b32 v28, s17
  s_lshl_b32 s34, s13, 7
  s_add_u32 s34, s34, 1507328
  buffer_store_dword v28, v19, s[4:7], s34 offen
  s_branch reca_b326
reca_last25:
  s_cmp_lg_u32 s12, 2
  s_cbranch_scc1 reca_exit1
  buffer_store_dwordx2 v[52:53], v9, s[4:7], s30 offen
  s_branch reca_exit1
reca_swave23:
  s_cmp_lg_u32 s17, 63
  s_cbranch_scc1 reca_vmst29
  s_barrier
  ds_read_b128 v[56:59], v1 offset:10240
  ds_read_b128 v[60:63], v1 offset:11264
  ds_read_b128 v[64:67], v1 offset:12288
  s_waitcnt lgkmcnt(0)
  v_add_f32 v56, v56, v64
  v_add_f32 v60, v60, v48
  v_add_f32 v57, v57, v65
  v_add_f32 v61, v61, v49
  v_add_f32 v58, v58, v66
  v_add_f32 v62, v62, v50
  v_add_f32 v59, v59, v67
  v_add_f32 v63, v63, v51
  v_cvt_pk_bf16_f32 v68, v56, v57
  v_cvt_pk_bf16_f32 v69, v58, v59
  v_cvt_pk_bf16_f32 v70, v60, v61
  v_cvt_pk_bf16_f32 v71, v62, v63
  buffer_store_dwordx2 v[52:53], v9, s[4:7], s30 offen
  buffer_store_dwordx2 v[68:69], v10, s[4:7], s31 offen
  buffer_store_dwordx2 v[70:71], v10, s[4:7], s31 offen offset:256
  s_branch reca_exit1
reca_vmst29:
  s_sleep 1
  buffer_load_dwordx4 v[208:211], v1, s[4:7], s21 offen offset:0 sc1
  buffer_load_dwordx4 v[212:215], v1, s[4:7], s21 offen offset:1024 sc1
  buffer_load_dwordx4 v[216:219], v1, s[4:7], s21 offen offset:2048 sc1
  buffer_load_dwordx4 v[220:223], v1, s[4:7], s21 offen offset:3072 sc1
  buffer_load_dwordx4 v[224:227], v2, s[4:7], s21 offen offset:0 sc1
  buffer_load_dwordx4 v[228:231], v2, s[4:7], s21 offen offset:1024 sc1
  s_waitcnt vmcnt(5)
  v_max_u32 v29, v208, v210
  v_cmp_eq_u32 vcc, -1, v29
  s_cbranch_vccnz reca_retry30
reca_resume31:
  s_waitcnt vmcnt(4)
  v_max_u32 v29, v212, v214
  v_cmp_eq_u32 vcc, -1, v29
  v_mfma_f32_16x16x32_bf16 v[76:79], a[120:123], v[208:211], 0
  v_mfma_f32_16x16x32_bf16 v[80:83], a[144:147], v[208:211], 0
  v_mfma_f32_16x16x32_bf16 v[72:75], v[208:211], v[208:211], v[40:43]
  s_cbranch_vccnz reca_retry32
reca_resume33:
  s_waitcnt vmcnt(3)
  v_max_u32 v29, v216, v218
  v_cmp_eq_u32 vcc, -1, v29
  v_mfma_f32_16x16x32_bf16 v[76:79], a[124:127], v[212:215], v[76:79]
  v_mfma_f32_16x16x32_bf16 v[80:83], a[148:151], v[212:215], v[80:83]
  v_mfma_f32_16x16x32_bf16 v[72:75], v[212:215], v[212:215], v[72:75]
  s_cbranch_vccnz reca_retry34
reca_resume35:
  s_waitcnt vmcnt(2)
  v_max_u32 v29, v220, v222
  v_cmp_eq_u32 vcc, -1, v29
  v_mfma_f32_16x16x32_bf16 v[76:79], a[128:131], v[216:219], v[76:79]
  v_mfma_f32_16x16x32_bf16 v[80:83], a[152:155], v[216:219], v[80:83]
  v_mfma_f32_16x16x32_bf16 v[72:75], v[216:219], v[216:219], v[72:75]
  s_cbranch_vccnz reca_retry36
reca_resume37:
  s_waitcnt vmcnt(1)
  v_max_u32 v29, v224, v226
  v_cmp_eq_u32 vcc, -1, v29
  v_mfma_f32_16x16x32_bf16 v[76:79], a[132:135], v[220:223], v[76:79]
  v_mfma_f32_16x16x32_bf16 v[80:83], a[156:159], v[220:223], v[80:83]
  v_mfma_f32_16x16x32_bf16 v[72:75], v[220:223], v[220:223], v[72:75]
  s_cbranch_vccnz reca_retry38
reca_resume39:
  s_waitcnt vmcnt(0)
  v_max_u32 v29, v228, v230
  v_cmp_eq_u32 vcc, -1, v29
  v_mfma_f32_16x16x32_bf16 v[76:79], a[136:139], v[224:227], v[76:79]
  v_mfma_f32_16x16x32_bf16 v[80:83], a[160:163], v[224:227], v[80:83]
  v_mfma_f32_16x16x32_bf16 v[72:75], v[224:227], v[224:227], v[72:75]
  s_cbranch_vccnz reca_retry40
reca_resume41:
  v_mfma_f32_16x16x32_bf16 v[76:79], a[140:143], v[228:231], v[76:79]
  v_mfma_f32_16x16x32_bf16 v[80:83], a[164:167], v[228:231], v[80:83]
  v_mfma_f32_16x16x32_bf16 v[72:75], v[228:231], v[228:231], v[72:75]
  s_barrier
  ds_read_b128 v[56:59], v1 offset:10240
  ds_read_b128 v[60:63], v1 offset:11264
  ds_read_b128 v[64:67], v1 offset:12288
  s_nop 1
  v_max3_f32 v28, v76, v77, v78
  v_max3_f32 v29, v80, v81, v82
  v_max3_f32 v28, v28, v79, v83
  v_max3_f32 v29, v29, v72, v73
  v_max3_f32 v28, v28, v74, v75
  v_max_f32 v28, v28, v29
  v_mov_b32 v29, v28
  s_nop 1
  v_permlane32_swap_b32 v28, v29
  v_max_f32 v28, v28, v29
  v_mov_b32 v29, v28
  s_nop 1
  v_permlane16_swap_b32 v28, v29
  v_max_f32 v28, v28, v29
  v_mul_f32 v28, s41, v28
  v_fma_f32 v76, v76, s41, -v28
  v_fma_f32 v77, v77, s41, -v28
  v_fma_f32 v78, v78, s41, -v28
  v_fma_f32 v79, v79, s41, -v28
  v_fma_f32 v80, v80, s41, -v28
  v_fma_f32 v81, v81, s41, -v28
  v_fma_f32 v82, v82, s41, -v28
  v_fma_f32 v83, v83, s41, -v28
  v_fma_f32 v72, v72, s41, -v28
  v_fma_f32 v73, v73, s41, -v28
  v_fma_f32 v74, v74, s41, -v28
  v_fma_f32 v75, v75, s41, -v28
  v_exp_f32 v76, v76
  v_exp_f32 v77, v77
  v_exp_f32 v78, v78
  v_exp_f32 v79, v79
  v_exp_f32 v80, v80
  v_exp_f32 v81, v81
  v_exp_f32 v82, v82
  v_exp_f32 v83, v83
  v_cvt_pk_bf16_f32 v84, v76, v77
  v_cvt_pk_bf16_f32 v85, v78, v79
  v_cvt_pk_bf16_f32 v86, v80, v81
  v_cvt_pk_bf16_f32 v87, v82, v83
  v_exp_f32 v72, v72
  v_exp_f32 v73, v73
  v_mfma_f32_16x16x32_bf16 v[100:103], v[36:39], v[84:87], 0
  v_exp_f32 v74, v74
  v_exp_f32 v75, v75
  v_mfma_f32_16x16x32_bf16 v[92:95], a[168:171], v[84:87], 0
  v_cvt_pk_bf16_f32 v88, v72, v73
  v_cvt_pk_bf16_f32 v89, v74, v75
  v_mfma_f32_16x16x32_bf16 v[96:99], a[172:175], v[84:87], 0
  s_waitcnt lgkmcnt(0)
  v_mfma_f32_16x16x16_bf16 v[100:103], v[36:37], v[88:89], v[100:103]
  v_add_f32 v56, v56, v64
  v_add_f32 v60, v60, v48
  v_add_f32 v57, v57, v65
  v_add_f32 v61, v61, v49
  v_add_f32 v58, v58, v66
  v_add_f32 v62, v62, v50
  v_add_f32 v59, v59, v67
  v_add_f32 v63, v63, v51
  v_cvt_pk_bf16_f32 v68, v56, v57
  v_cvt_pk_bf16_f32 v69, v58, v59
  v_cvt_pk_bf16_f32 v70, v60, v61
  v_cvt_pk_bf16_f32 v71, v62, v63
  v_mfma_f32_16x16x16_bf16 v[92:95], v[68:69], v[88:89], v[92:95]
  v_rcp_f32 v28, v100
  v_mfma_f32_16x16x16_bf16 v[96:99], v[70:71], v[88:89], v[96:99]
  v_mov_b32 v29, v28
  s_nop 4
  v_pk_mul_f32 v[92:93], v[92:93], v[28:29]
  v_pk_mul_f32 v[94:95], v[94:95], v[28:29]
  v_pk_mul_f32 v[96:97], v[96:97], v[28:29]
  v_pk_mul_f32 v[98:99], v[98:99], v[28:29]
  v_cvt_pk_bf16_f32 v104, v92, v93
  v_cvt_pk_bf16_f32 v105, v94, v95
  v_cvt_pk_bf16_f32 v106, v96, v97
  v_cvt_pk_bf16_f32 v107, v98, v99
  buffer_store_dwordx4 v[104:107], v11, s[4:7], s22 offen
reca_b326:
  s_barrier
  s_cmp_ge_u32 s12, 2
  s_cbranch_scc1 reca_notg242
  s_sleep 3
  buffer_load_dwordx4 v[128:131], v12, s[4:7], s22 offen offset:0 sc1
  buffer_load_dwordx4 v[132:135], v12, s[4:7], s22 offen offset:1024 sc1
  buffer_load_dwordx4 v[136:139], v12, s[4:7], s22 offen offset:2048 sc1
  buffer_load_dwordx4 v[140:143], v12, s[4:7], s22 offen offset:3072 sc1
  buffer_load_dwordx4 v[144:147], v13, s[4:7], s22 offen offset:0 sc1
  buffer_load_dwordx4 v[148:151], v13, s[4:7], s22 offen offset:1024 sc1
  buffer_load_dwordx4 v[152:155], v13, s[4:7], s22 offen offset:2048 sc1
  buffer_load_dwordx4 v[156:159], v13, s[4:7], s22 offen offset:3072 sc1
  buffer_load_dwordx4 v[160:163], v14, s[4:7], s22 offen offset:0 sc1
  buffer_load_dwordx4 v[164:167], v14, s[4:7], s22 offen offset:1024 sc1
  buffer_load_dwordx4 v[168:171], v14, s[4:7], s22 offen offset:2048 sc1
  buffer_load_dwordx4 v[172:175], v14, s[4:7], s22 offen offset:3072 sc1
  s_waitcnt vmcnt(11)
  v_cmp_eq_u32 vcc, -1, v128
  s_cbranch_vccnz reca_retry43
reca_resume44:
  s_waitcnt vmcnt(10)
  v_cmp_eq_u32 vcc, -1, v132
  v_mfma_f32_16x16x32_bf16 v[108:111], a[120:123], v[128:131], 0
  v_mfma_f32_16x16x32_bf16 v[112:115], a[124:127], v[128:131], 0
  s_cbranch_vccnz reca_retry45
reca_resume46:
  s_waitcnt vmcnt(9)
  v_cmp_eq_u32 vcc, -1, v136
  v_mfma_f32_16x16x32_bf16 v[108:111], a[128:131], v[132:135], v[108:111]
  v_mfma_f32_16x16x32_bf16 v[112:115], a[132:135], v[132:135], v[112:115]
  s_cbranch_vccnz reca_retry47
reca_resume48:
  s_waitcnt vmcnt(8)
  v_cmp_eq_u32 vcc, -1, v140
  v_mfma_f32_16x16x32_bf16 v[108:111], a[136:139], v[136:139], v[108:111]
  v_mfma_f32_16x16x32_bf16 v[112:115], a[140:143], v[136:139], v[112:115]
  s_cbranch_vccnz reca_retry49
reca_resume50:
  s_waitcnt vmcnt(7)
  v_cmp_eq_u32 vcc, -1, v144
  v_mfma_f32_16x16x32_bf16 v[108:111], a[144:147], v[140:143], v[108:111]
  v_mfma_f32_16x16x32_bf16 v[112:115], a[148:151], v[140:143], v[112:115]
  s_cbranch_vccnz reca_retry51
reca_resume52:
  s_waitcnt vmcnt(6)
  v_cmp_eq_u32 vcc, -1, v148
  v_mfma_f32_16x16x32_bf16 v[108:111], a[152:155], v[144:147], v[108:111]
  v_mfma_f32_16x16x32_bf16 v[112:115], a[156:159], v[144:147], v[112:115]
  s_cbranch_vccnz reca_retry53
reca_resume54:
  s_waitcnt vmcnt(5)
  v_cmp_eq_u32 vcc, -1, v152
  v_mfma_f32_16x16x32_bf16 v[108:111], a[160:163], v[148:151], v[108:111]
  v_mfma_f32_16x16x32_bf16 v[112:115], a[164:167], v[148:151], v[112:115]
  s_cbranch_vccnz reca_retry55
reca_resume56:
  s_waitcnt vmcnt(4)
  v_cmp_eq_u32 vcc, -1, v156
  v_mfma_f32_16x16x32_bf16 v[108:111], a[168:171], v[152:155], v[108:111]
  v_mfma_f32_16x16x32_bf16 v[112:115], a[172:175], v[152:155], v[112:115]
  s_cbranch_vccnz reca_retry57
reca_resume58:
  s_waitcnt vmcnt(3)
  v_cmp_eq_u32 vcc, -1, v160
  v_mfma_f32_16x16x32_bf16 v[108:111], a[176:179], v[156:159], v[108:111]
  v_mfma_f32_16x16x32_bf16 v[112:115], a[180:183], v[156:159], v[112:115]
  s_cbranch_vccnz reca_retry59
reca_resume60:
  s_waitcnt vmcnt(2)
  v_cmp_eq_u32 vcc, -1, v164
  v_mfma_f32_16x16x32_bf16 v[108:111], a[184:187], v[160:163], v[108:111]
  v_mfma_f32_16x16x32_bf16 v[112:115], a[188:191], v[160:163], v[112:115]
  s_cbranch_vccnz reca_retry61
reca_resume62:
  s_waitcnt vmcnt(1)
  v_cmp_eq_u32 vcc, -1, v168
  v_mfma_f32_16x16x32_bf16 v[108:111], a[192:195], v[164:167], v[108:111]
  v_mfma_f32_16x16x32_bf16 v[112:115], a[196:199], v[164:167], v[112:115]
  s_cbranch_vccnz reca_retry63
reca_resume64:
  s_waitcnt vmcnt(0)
  v_cmp_eq_u32 vcc, -1, v172
  v_mfma_f32_16x16x32_bf16 v[108:111], a[200:203], v[168:171], v[108:111]
  v_mfma_f32_16x16x32_bf16 v[112:115], a[204:207], v[168:171], v[112:115]
  s_cbranch_vccnz reca_retry65
reca_resume66:
  v_mfma_f32_16x16x32_bf16 v[108:111], a[208:211], v[172:175], v[108:111]
  v_mfma_f32_16x16x32_bf16 v[112:115], a[212:215], v[172:175], v[112:115]
  s_nop 7
  v_add_f32_dpp v116, v112, v108 row_ror:8 row_mask:0xf bank_mask:0xf
  v_add_f32_dpp v117, v113, v109 row_ror:8 row_mask:0xf bank_mask:0xf
  v_add_f32_dpp v118, v114, v110 row_ror:8 row_mask:0xf bank_mask:0xf
  v_add_f32_dpp v119, v115, v111 row_ror:8 row_mask:0xf bank_mask:0xf
  buffer_store_dwordx4 v[116:119], v15, s[4:7], s25 offen sc1
  buffer_store_dwordx4 v[116:119], v232, s[4:7], s25 offen sc1
  buffer_store_dwordx4 v[32:35], v15, s[4:7], s29 offen sc1
  buffer_store_dwordx4 v[32:35], v232, s[4:7], s29 offen sc1
  s_branch reca_b427
reca_notg242:
  s_cmp_lg_u32 s12, 3
  s_cbranch_scc1 reca_b427
  s_add_u32 s34, s17, 2
  s_and_b32 s34, s34, 3
  s_mul_i32 s26, s34, 10240
  s_add_u32 s26, s26, s38
  s_mul_i32 s27, s34, 6144
  s_add_u32 s27, s27, s39
  s_mul_i32 s28, s34, 12288
  s_add_u32 s28, s28, s40
  s_mul_i32 s29, s34, 393216
  s_add_u32 s29, s29, s56
  buffer_store_dwordx2 v[32:33], v8, s[4:7], s27 offen
  buffer_store_dwordx4 v[32:35], v11, s[4:7], s28 offen
reca_b427:
  s_barrier
  s_cmp_lg_u32 s12, 2
  s_cbranch_scc1 reca_not267
  s_sleep 8
  buffer_load_dwordx4 v[128:131], v20, s[4:7], s25 offen sc1
  buffer_load_dwordx4 v[132:135], v21, s[4:7], s25 offen sc1
  buffer_load_dwordx4 v[136:139], v22, s[4:7], s25 offen sc1
  buffer_load_dwordx4 v[140:143], v23, s[4:7], s25 offen sc1
  buffer_load_dwordx4 v[144:147], v24, s[4:7], s25 offen sc1
  buffer_load_dwordx4 v[148:151], v25, s[4:7], s25 offen sc1
  buffer_load_dwordx4 v[152:155], v26, s[4:7], s25 offen sc1
  buffer_load_dwordx4 v[156:159], v27, s[4:7], s25 offen sc1
  s_waitcnt vmcnt(7)
  v_cmp_eq_u32 vcc, -1, v128
  s_cbranch_vccnz reca_retry68
reca_resume69:
  s_waitcnt vmcnt(6)
  v_cmp_eq_u32 vcc, -1, v132
  s_cbranch_vccnz reca_retry70
reca_resume71:
  s_waitcnt vmcnt(5)
  v_cmp_eq_u32 vcc, -1, v136
  v_pk_add_f32 v[116:117], v[128:129], v[132:133]
  v_pk_add_f32 v[118:119], v[130:131], v[134:135]
  s_cbranch_vccnz reca_retry72
reca_resume73:
  s_waitcnt vmcnt(4)
  v_cmp_eq_u32 vcc, -1, v140
  v_pk_add_f32 v[116:117], v[116:117], v[136:137]
  v_pk_add_f32 v[118:119], v[118:119], v[138:139]
  s_cbranch_vccnz reca_retry74
reca_resume75:
  s_waitcnt vmcnt(3)
  v_cmp_eq_u32 vcc, -1, v144
  v_pk_add_f32 v[116:117], v[116:117], v[140:141]
  v_pk_add_f32 v[118:119], v[118:119], v[142:143]
  s_cbranch_vccnz reca_retry76
reca_resume77:
  s_waitcnt vmcnt(2)
  v_cmp_eq_u32 vcc, -1, v148
  v_pk_add_f32 v[116:117], v[116:117], v[144:145]
  v_pk_add_f32 v[118:119], v[118:119], v[146:147]
  s_cbranch_vccnz reca_retry78
reca_resume79:
  s_waitcnt vmcnt(1)
  v_cmp_eq_u32 vcc, -1, v152
  v_pk_add_f32 v[116:117], v[116:117], v[148:149]
  v_pk_add_f32 v[118:119], v[118:119], v[150:151]
  s_cbranch_vccnz reca_retry80
reca_resume81:
  s_waitcnt vmcnt(0)
  v_cmp_eq_u32 vcc, -1, v156
  v_pk_add_f32 v[116:117], v[116:117], v[152:153]
  v_pk_add_f32 v[118:119], v[118:119], v[154:155]
  s_cbranch_vccnz reca_retry82
reca_resume83:
  v_pk_add_f32 v[116:117], v[116:117], v[156:157]
  v_pk_add_f32 v[118:119], v[118:119], v[158:159]
  v_cvt_pk_bf16_f32 v132, v116, v117
  v_cvt_pk_bf16_f32 v133, v118, v119
  buffer_store_dwordx2 v[132:133], v16, s[4:7], s24 offen
  s_branch reca_b528
reca_not267:
  s_cmp_lg_u32 s12, 3
  s_cbranch_scc1 reca_b528
  s_add_u32 s36, s17, 1
  s_cmp_ge_u32 s36, 63
  s_cbranch_scc1 reca_nopf84
  s_add_u32 s37, s36, 1
reca_pf85:
  buffer_load_dword v28, v233, s[4:7], 0 offen sc1
  s_waitcnt vmcnt(0)
  v_cmp_gt_i32 vcc, s37, v28
  s_cbranch_vccz reca_pfok86
  s_sleep 1
  s_sub_u32 s18, s18, 1
  s_cbranch_scc0 reca_pf85
  s_mov_b32 s18, 0
reca_pfok86:
  s_lshl_b32 s34, s15, 3
  s_and_b32 s35, s36, 7
  s_add_u32 s34, s34, s35
  s_mul_i32 s34, s34, 12288
  s_add_u32 s32, s34, 37748736
  s_lshl_b32 s35, s16, 11
  s_add_u32 s34, s34, s35
  s_add_u32 s33, s34, 40894464
  buffer_load_dwordx4 a[120:123], v1, s[4:7], s32 offen offset:0 sc1
  buffer_load_dwordx4 a[124:127], v1, s[4:7], s32 offen offset:1024 sc1
  buffer_load_dwordx4 a[128:131], v1, s[4:7], s32 offen offset:2048 sc1
  buffer_load_dwordx4 a[132:135], v1, s[4:7], s32 offen offset:3072 sc1
  buffer_load_dwordx4 a[136:139], v2, s[4:7], s32 offen offset:0 sc1
  buffer_load_dwordx4 a[140:143], v2, s[4:7], s32 offen offset:1024 sc1
  buffer_load_dwordx4 a[144:147], v2, s[4:7], s32 offen offset:2048 sc1
  buffer_load_dwordx4 a[148:151], v2, s[4:7], s32 offen offset:3072 sc1
  buffer_load_dwordx4 a[152:155], v3, s[4:7], s32 offen offset:0 sc1
  buffer_load_dwordx4 a[156:159], v3, s[4:7], s32 offen offset:1024 sc1
  buffer_load_dwordx4 a[160:163], v3, s[4:7], s32 offen offset:2048 sc1
  buffer_load_dwordx4 a[164:167], v3, s[4:7], s32 offen offset:3072 sc1
  buffer_load_dwordx4 a[168:171], v1, s[4:7], s33 offen offset:0 sc1
  buffer_load_dwordx4 a[172:175], v1, s[4:7], s33 offen offset:1024 sc1
reca_nopf84:
  buffer_store_dwordx2 v[52:53], v9, s[4:7], s30 offen
  buffer_store_dwordx2 v[68:69], v10, s[4:7], s31 offen
  buffer_store_dwordx2 v[70:71], v10, s[4:7], s31 offen offset:256
reca_b528:
  s_barrier
  s_add_u32 s17, s17, 1
  s_branch reca_step14
reca_retry17:
  s_sub_u32 s18, s18, 1
  s_cbranch_scc1 reca_retry17_to
  buffer_load_dwordx4 v[128:131], v4, s[4:7], s20 offen sc1
  buffer_load_dwordx4 v[132:135], v4, s[4:7], s20 offen offset:1024 sc1
  buffer_load_dwordx4 v[136:139], v5, s[4:7], s20 offen sc1
  s_waitcnt vmcnt(2)
  v_max_u32 v29, v128, v130
  v_cmp_eq_u32 vcc, -1, v29
  s_cbranch_vccnz reca_retry17
  s_branch reca_resume18
reca_retry17_to:
  s_mov_b32 s18, 0
  s_waitcnt vmcnt(0)
  s_branch reca_resume18
reca_retry19:
  s_sub_u32 s18, s18, 1
  s_cbranch_scc1 reca_retry19_to
  buffer_load_dwordx4 v[132:135], v4, s[4:7], s20 offen offset:1024 sc1
  buffer_load_dwordx4 v[136:139], v5, s[4:7], s20 offen sc1
  s_waitcnt vmcnt(1)
  v_max_u32 v29, v132, v134
  v_cmp_eq_u32 vcc, -1, v29
  s_cbranch_vccnz reca_retry19
  s_branch reca_resume20
reca_retry19_to:
  s_mov_b32 s18, 0
  s_waitcnt vmcnt(0)
  s_branch reca_resume20
reca_retry21:
  s_sub_u32 s18, s18, 1
  s_cbranch_scc1 reca_retry21_to
  buffer_load_dwordx4 v[136:139], v5, s[4:7], s20 offen sc1
  s_waitcnt vmcnt(0)
  v_max_u32 v29, v136, v138
  v_cmp_eq_u32 vcc, -1, v29
  s_cbranch_vccnz reca_retry21
  s_branch reca_resume22
reca_retry21_to:
  s_mov_b32 s18, 0
  s_waitcnt vmcnt(0)
  s_branch reca_resume22
reca_retry30:
  s_sub_u32 s18, s18, 1
  s_cbranch_scc1 reca_retry30_to
  buffer_load_dwordx4 v[208:211], v1, s[4:7], s21 offen offset:0 sc1
  buffer_load_dwordx4 v[212:215], v1, s[4:7], s21 offen offset:1024 sc1
  buffer_load_dwordx4 v[216:219], v1, s[4:7], s21 offen offset:2048 sc1
  buffer_load_dwordx4 v[220:223], v1, s[4:7], s21 offen offset:3072 sc1
  buffer_load_dwordx4 v[224:227], v2, s[4:7], s21 offen offset:0 sc1
  buffer_load_dwordx4 v[228:231], v2, s[4:7], s21 offen offset:1024 sc1
  s_waitcnt vmcnt(5)
  v_max_u32 v29, v208, v210
  v_cmp_eq_u32 vcc, -1, v29
  s_cbranch_vccnz reca_retry30
  s_branch reca_resume31
reca_retry30_to:
  s_mov_b32 s18, 0
  s_waitcnt vmcnt(0)
  s_branch reca_resume31
reca_retry32:
  s_sub_u32 s18, s18, 1
  s_cbranch_scc1 reca_retry32_to
  buffer_load_dwordx4 v[212:215], v1, s[4:7], s21 offen offset:1024 sc1
  buffer_load_dwordx4 v[216:219], v1, s[4:7], s21 offen offset:2048 sc1
  buffer_load_dwordx4 v[220:223], v1, s[4:7], s21 offen offset:3072 sc1
  buffer_load_dwordx4 v[224:227], v2, s[4:7], s21 offen offset:0 sc1
  buffer_load_dwordx4 v[228:231], v2, s[4:7], s21 offen offset:1024 sc1
  s_waitcnt vmcnt(4)
  v_max_u32 v29, v212, v214
  v_cmp_eq_u32 vcc, -1, v29
  s_cbranch_vccnz reca_retry32
  s_branch reca_resume33
reca_retry32_to:
  s_mov_b32 s18, 0
  s_waitcnt vmcnt(0)
  s_branch reca_resume33
reca_retry34:
  s_sub_u32 s18, s18, 1
  s_cbranch_scc1 reca_retry34_to
  buffer_load_dwordx4 v[216:219], v1, s[4:7], s21 offen offset:2048 sc1
  buffer_load_dwordx4 v[220:223], v1, s[4:7], s21 offen offset:3072 sc1
  buffer_load_dwordx4 v[224:227], v2, s[4:7], s21 offen offset:0 sc1
  buffer_load_dwordx4 v[228:231], v2, s[4:7], s21 offen offset:1024 sc1
  s_waitcnt vmcnt(3)
  v_max_u32 v29, v216, v218
  v_cmp_eq_u32 vcc, -1, v29
  s_cbranch_vccnz reca_retry34
  s_branch reca_resume35
reca_retry34_to:
  s_mov_b32 s18, 0
  s_waitcnt vmcnt(0)
  s_branch reca_resume35
reca_retry36:
  s_sub_u32 s18, s18, 1
  s_cbranch_scc1 reca_retry36_to
  buffer_load_dwordx4 v[220:223], v1, s[4:7], s21 offen offset:3072 sc1
  buffer_load_dwordx4 v[224:227], v2, s[4:7], s21 offen offset:0 sc1
  buffer_load_dwordx4 v[228:231], v2, s[4:7], s21 offen offset:1024 sc1
  s_waitcnt vmcnt(2)
  v_max_u32 v29, v220, v222
  v_cmp_eq_u32 vcc, -1, v29
  s_cbranch_vccnz reca_retry36
  s_branch reca_resume37
reca_retry36_to:
  s_mov_b32 s18, 0
  s_waitcnt vmcnt(0)
  s_branch reca_resume37
reca_retry38:
  s_sub_u32 s18, s18, 1
  s_cbranch_scc1 reca_retry38_to
  buffer_load_dwordx4 v[224:227], v2, s[4:7], s21 offen offset:0 sc1
  buffer_load_dwordx4 v[228:231], v2, s[4:7], s21 offen offset:1024 sc1
  s_waitcnt vmcnt(1)
  v_max_u32 v29, v224, v226
  v_cmp_eq_u32 vcc, -1, v29
  s_cbranch_vccnz reca_retry38
  s_branch reca_resume39
reca_retry38_to:
  s_mov_b32 s18, 0
  s_waitcnt vmcnt(0)
  s_branch reca_resume39
reca_retry40:
  s_sub_u32 s18, s18, 1
  s_cbranch_scc1 reca_retry40_to
  buffer_load_dwordx4 v[228:231], v2, s[4:7], s21 offen offset:1024 sc1
  s_waitcnt vmcnt(0)
  v_max_u32 v29, v228, v230
  v_cmp_eq_u32 vcc, -1, v29
  s_cbranch_vccnz reca_retry40
  s_branch reca_resume41
reca_retry40_to:
  s_mov_b32 s18, 0
  s_waitcnt vmcnt(0)
  s_branch reca_resume41
reca_retry43:
  s_sub_u32 s18, s18, 1
  s_cbranch_scc1 reca_retry43_to
  buffer_load_dwordx4 v[128:131], v12, s[4:7], s22 offen offset:0 sc1
  buffer_load_dwordx4 v[132:135], v12, s[4:7], s22 offen offset:1024 sc1
  buffer_load_dwordx4 v[136:139], v12, s[4:7], s22 offen offset:2048 sc1
  buffer_load_dwordx4 v[140:143], v12, s[4:7], s22 offen offset:3072 sc1
  buffer_load_dwordx4 v[144:147], v13, s[4:7], s22 offen offset:0 sc1
  buffer_load_dwordx4 v[148:151], v13, s[4:7], s22 offen offset:1024 sc1
  buffer_load_dwordx4 v[152:155], v13, s[4:7], s22 offen offset:2048 sc1
  buffer_load_dwordx4 v[156:159], v13, s[4:7], s22 offen offset:3072 sc1
  buffer_load_dwordx4 v[160:163], v14, s[4:7], s22 offen offset:0 sc1
  buffer_load_dwordx4 v[164:167], v14, s[4:7], s22 offen offset:1024 sc1
  buffer_load_dwordx4 v[168:171], v14, s[4:7], s22 offen offset:2048 sc1
  buffer_load_dwordx4 v[172:175], v14, s[4:7], s22 offen offset:3072 sc1
  s_waitcnt vmcnt(11)
  v_cmp_eq_u32 vcc, -1, v128
  s_cbranch_vccnz reca_retry43
  s_branch reca_resume44
reca_retry43_to:
  s_mov_b32 s18, 0
  s_waitcnt vmcnt(0)
  s_branch reca_resume44
reca_retry45:
  s_sub_u32 s18, s18, 1
  s_cbranch_scc1 reca_retry45_to
  buffer_load_dwordx4 v[132:135], v12, s[4:7], s22 offen offset:1024 sc1
  buffer_load_dwordx4 v[136:139], v12, s[4:7], s22 offen offset:2048 sc1
  buffer_load_dwordx4 v[140:143], v12, s[4:7], s22 offen offset:3072 sc1
  buffer_load_dwordx4 v[144:147], v13, s[4:7], s22 offen offset:0 sc1
  buffer_load_dwordx4 v[148:151], v13, s[4:7], s22 offen offset:1024 sc1
  buffer_load_dwordx4 v[152:155], v13, s[4:7], s22 offen offset:2048 sc1
  buffer_load_dwordx4 v[156:159], v13, s[4:7], s22 offen offset:3072 sc1
  buffer_load_dwordx4 v[160:163], v14, s[4:7], s22 offen offset:0 sc1
  buffer_load_dwordx4 v[164:167], v14, s[4:7], s22 offen offset:1024 sc1
  buffer_load_dwordx4 v[168:171], v14, s[4:7], s22 offen offset:2048 sc1
  buffer_load_dwordx4 v[172:175], v14, s[4:7], s22 offen offset:3072 sc1
  s_waitcnt vmcnt(10)
  v_cmp_eq_u32 vcc, -1, v132
  s_cbranch_vccnz reca_retry45
  s_branch reca_resume46
reca_retry45_to:
  s_mov_b32 s18, 0
  s_waitcnt vmcnt(0)
  s_branch reca_resume46
reca_retry47:
  s_sub_u32 s18, s18, 1
  s_cbranch_scc1 reca_retry47_to
  buffer_load_dwordx4 v[136:139], v12, s[4:7], s22 offen offset:2048 sc1
  buffer_load_dwordx4 v[140:143], v12, s[4:7], s22 offen offset:3072 sc1
  buffer_load_dwordx4 v[144:147], v13, s[4:7], s22 offen offset:0 sc1
  buffer_load_dwordx4 v[148:151], v13, s[4:7], s22 offen offset:1024 sc1
  buffer_load_dwordx4 v[152:155], v13, s[4:7], s22 offen offset:2048 sc1
  buffer_load_dwordx4 v[156:159], v13, s[4:7], s22 offen offset:3072 sc1
  buffer_load_dwordx4 v[160:163], v14, s[4:7], s22 offen offset:0 sc1
  buffer_load_dwordx4 v[164:167], v14, s[4:7], s22 offen offset:1024 sc1
  buffer_load_dwordx4 v[168:171], v14, s[4:7], s22 offen offset:2048 sc1
  buffer_load_dwordx4 v[172:175], v14, s[4:7], s22 offen offset:3072 sc1
  s_waitcnt vmcnt(9)
  v_cmp_eq_u32 vcc, -1, v136
  s_cbranch_vccnz reca_retry47
  s_branch reca_resume48
reca_retry47_to:
  s_mov_b32 s18, 0
  s_waitcnt vmcnt(0)
  s_branch reca_resume48
reca_retry49:
  s_sub_u32 s18, s18, 1
  s_cbranch_scc1 reca_retry49_to
  buffer_load_dwordx4 v[140:143], v12, s[4:7], s22 offen offset:3072 sc1
  buffer_load_dwordx4 v[144:147], v13, s[4:7], s22 offen offset:0 sc1
  buffer_load_dwordx4 v[148:151], v13, s[4:7], s22 offen offset:1024 sc1
  buffer_load_dwordx4 v[152:155], v13, s[4:7], s22 offen offset:2048 sc1
  buffer_load_dwordx4 v[156:159], v13, s[4:7], s22 offen offset:3072 sc1
  buffer_load_dwordx4 v[160:163], v14, s[4:7], s22 offen offset:0 sc1
  buffer_load_dwordx4 v[164:167], v14, s[4:7], s22 offen offset:1024 sc1
  buffer_load_dwordx4 v[168:171], v14, s[4:7], s22 offen offset:2048 sc1
  buffer_load_dwordx4 v[172:175], v14, s[4:7], s22 offen offset:3072 sc1
  s_waitcnt vmcnt(8)
  v_cmp_eq_u32 vcc, -1, v140
  s_cbranch_vccnz reca_retry49
  s_branch reca_resume50
reca_retry49_to:
  s_mov_b32 s18, 0
  s_waitcnt vmcnt(0)
  s_branch reca_resume50
reca_retry51:
  s_sub_u32 s18, s18, 1
  s_cbranch_scc1 reca_retry51_to
  buffer_load_dwordx4 v[144:147], v13, s[4:7], s22 offen offset:0 sc1
  buffer_load_dwordx4 v[148:151], v13, s[4:7], s22 offen offset:1024 sc1
  buffer_load_dwordx4 v[152:155], v13, s[4:7], s22 offen offset:2048 sc1
  buffer_load_dwordx4 v[156:159], v13, s[4:7], s22 offen offset:3072 sc1
  buffer_load_dwordx4 v[160:163], v14, s[4:7], s22 offen offset:0 sc1
  buffer_load_dwordx4 v[164:167], v14, s[4:7], s22 offen offset:1024 sc1
  buffer_load_dwordx4 v[168:171], v14, s[4:7], s22 offen offset:2048 sc1
  buffer_load_dwordx4 v[172:175], v14, s[4:7], s22 offen offset:3072 sc1
  s_waitcnt vmcnt(7)
  v_cmp_eq_u32 vcc, -1, v144
  s_cbranch_vccnz reca_retry51
  s_branch reca_resume52
reca_retry51_to:
  s_mov_b32 s18, 0
  s_waitcnt vmcnt(0)
  s_branch reca_resume52
reca_retry53:
  s_sub_u32 s18, s18, 1
  s_cbranch_scc1 reca_retry53_to
  buffer_load_dwordx4 v[148:151], v13, s[4:7], s22 offen offset:1024 sc1
  buffer_load_dwordx4 v[152:155], v13, s[4:7], s22 offen offset:2048 sc1
  buffer_load_dwordx4 v[156:159], v13, s[4:7], s22 offen offset:3072 sc1
  buffer_load_dwordx4 v[160:163], v14, s[4:7], s22 offen offset:0 sc1
  buffer_load_dwordx4 v[164:167], v14, s[4:7], s22 offen offset:1024 sc1
  buffer_load_dwordx4 v[168:171], v14, s[4:7], s22 offen offset:2048 sc1
  buffer_load_dwordx4 v[172:175], v14, s[4:7], s22 offen offset:3072 sc1
  s_waitcnt vmcnt(6)
  v_cmp_eq_u32 vcc, -1, v148
  s_cbranch_vccnz reca_retry53
  s_branch reca_resume54
reca_retry53_to:
  s_mov_b32 s18, 0
  s_waitcnt vmcnt(0)
  s_branch reca_resume54
reca_retry55:
  s_sub_u32 s18, s18, 1
  s_cbranch_scc1 reca_retry55_to
  buffer_load_dwordx4 v[152:155], v13, s[4:7], s22 offen offset:2048 sc1
  buffer_load_dwordx4 v[156:159], v13, s[4:7], s22 offen offset:3072 sc1
  buffer_load_dwordx4 v[160:163], v14, s[4:7], s22 offen offset:0 sc1
  buffer_load_dwordx4 v[164:167], v14, s[4:7], s22 offen offset:1024 sc1
  buffer_load_dwordx4 v[168:171], v14, s[4:7], s22 offen offset:2048 sc1
  buffer_load_dwordx4 v[172:175], v14, s[4:7], s22 offen offset:3072 sc1
  s_waitcnt vmcnt(5)
  v_cmp_eq_u32 vcc, -1, v152
  s_cbranch_vccnz reca_retry55
  s_branch reca_resume56
reca_retry55_to:
  s_mov_b32 s18, 0
  s_waitcnt vmcnt(0)
  s_branch reca_resume56
reca_retry57:
  s_sub_u32 s18, s18, 1
  s_cbranch_scc1 reca_retry57_to
  buffer_load_dwordx4 v[156:159], v13, s[4:7], s22 offen offset:3072 sc1
  buffer_load_dwordx4 v[160:163], v14, s[4:7], s22 offen offset:0 sc1
  buffer_load_dwordx4 v[164:167], v14, s[4:7], s22 offen offset:1024 sc1
  buffer_load_dwordx4 v[168:171], v14, s[4:7], s22 offen offset:2048 sc1
  buffer_load_dwordx4 v[172:175], v14, s[4:7], s22 offen offset:3072 sc1
  s_waitcnt vmcnt(4)
  v_cmp_eq_u32 vcc, -1, v156
  s_cbranch_vccnz reca_retry57
  s_branch reca_resume58
reca_retry57_to:
  s_mov_b32 s18, 0
  s_waitcnt vmcnt(0)
  s_branch reca_resume58
reca_retry59:
  s_sub_u32 s18, s18, 1
  s_cbranch_scc1 reca_retry59_to
  buffer_load_dwordx4 v[160:163], v14, s[4:7], s22 offen offset:0 sc1
  buffer_load_dwordx4 v[164:167], v14, s[4:7], s22 offen offset:1024 sc1
  buffer_load_dwordx4 v[168:171], v14, s[4:7], s22 offen offset:2048 sc1
  buffer_load_dwordx4 v[172:175], v14, s[4:7], s22 offen offset:3072 sc1
  s_waitcnt vmcnt(3)
  v_cmp_eq_u32 vcc, -1, v160
  s_cbranch_vccnz reca_retry59
  s_branch reca_resume60
reca_retry59_to:
  s_mov_b32 s18, 0
  s_waitcnt vmcnt(0)
  s_branch reca_resume60
reca_retry61:
  s_sub_u32 s18, s18, 1
  s_cbranch_scc1 reca_retry61_to
  buffer_load_dwordx4 v[164:167], v14, s[4:7], s22 offen offset:1024 sc1
  buffer_load_dwordx4 v[168:171], v14, s[4:7], s22 offen offset:2048 sc1
  buffer_load_dwordx4 v[172:175], v14, s[4:7], s22 offen offset:3072 sc1
  s_waitcnt vmcnt(2)
  v_cmp_eq_u32 vcc, -1, v164
  s_cbranch_vccnz reca_retry61
  s_branch reca_resume62
reca_retry61_to:
  s_mov_b32 s18, 0
  s_waitcnt vmcnt(0)
  s_branch reca_resume62
reca_retry63:
  s_sub_u32 s18, s18, 1
  s_cbranch_scc1 reca_retry63_to
  buffer_load_dwordx4 v[168:171], v14, s[4:7], s22 offen offset:2048 sc1
  buffer_load_dwordx4 v[172:175], v14, s[4:7], s22 offen offset:3072 sc1
  s_waitcnt vmcnt(1)
  v_cmp_eq_u32 vcc, -1, v168
  s_cbranch_vccnz reca_retry63
  s_branch reca_resume64
reca_retry63_to:
  s_mov_b32 s18, 0
  s_waitcnt vmcnt(0)
  s_branch reca_resume64
reca_retry65:
  s_sub_u32 s18, s18, 1
  s_cbranch_scc1 reca_retry65_to
  buffer_load_dwordx4 v[172:175], v14, s[4:7], s22 offen offset:3072 sc1
  s_waitcnt vmcnt(0)
  v_cmp_eq_u32 vcc, -1, v172
  s_cbranch_vccnz reca_retry65
  s_branch reca_resume66
reca_retry65_to:
  s_mov_b32 s18, 0
  s_waitcnt vmcnt(0)
  s_branch reca_resume66
reca_retry68:
  s_sub_u32 s18, s18, 1
  s_cbranch_scc1 reca_retry68_to
  buffer_load_dwordx4 v[128:131], v20, s[4:7], s25 offen sc1
  buffer_load_dwordx4 v[132:135], v21, s[4:7], s25 offen sc1
  buffer_load_dwordx4 v[136:139], v22, s[4:7], s25 offen sc1
  buffer_load_dwordx4 v[140:143], v23, s[4:7], s25 offen sc1
  buffer_load_dwordx4 v[144:147], v24, s[4:7], s25 offen sc1
  buffer_load_dwordx4 v[148:151], v25, s[4:7], s25 offen sc1
  buffer_load_dwordx4 v[152:155], v26, s[4:7], s25 offen sc1
  buffer_load_dwordx4 v[156:159], v27, s[4:7], s25 offen sc1
  s_waitcnt vmcnt(7)
  v_cmp_eq_u32 vcc, -1, v128
  s_cbranch_vccnz reca_retry68
  s_branch reca_resume69
reca_retry68_to:
  s_mov_b32 s18, 0
  s_waitcnt vmcnt(0)
  s_branch reca_resume69
reca_retry70:
  s_sub_u32 s18, s18, 1
  s_cbranch_scc1 reca_retry70_to
  buffer_load_dwordx4 v[132:135], v21, s[4:7], s25 offen sc1
  buffer_load_dwordx4 v[136:139], v22, s[4:7], s25 offen sc1
  buffer_load_dwordx4 v[140:143], v23, s[4:7], s25 offen sc1
  buffer_load_dwordx4 v[144:147], v24, s[4:7], s25 offen sc1
  buffer_load_dwordx4 v[148:151], v25, s[4:7], s25 offen sc1
  buffer_load_dwordx4 v[152:155], v26, s[4:7], s25 offen sc1
  buffer_load_dwordx4 v[156:159], v27, s[4:7], s25 offen sc1
  s_waitcnt vmcnt(6)
  v_cmp_eq_u32 vcc, -1, v132
  s_cbranch_vccnz reca_retry70
  s_branch reca_resume71
reca_retry70_to:
  s_mov_b32 s18, 0
  s_waitcnt vmcnt(0)
  s_branch reca_resume71
reca_retry72:
  s_sub_u32 s18, s18, 1
  s_cbranch_scc1 reca_retry72_to
  buffer_load_dwordx4 v[136:139], v22, s[4:7], s25 offen sc1
  buffer_load_dwordx4 v[140:143], v23, s[4:7], s25 offen sc1
  buffer_load_dwordx4 v[144:147], v24, s[4:7], s25 offen sc1
  buffer_load_dwordx4 v[148:151], v25, s[4:7], s25 offen sc1
  buffer_load_dwordx4 v[152:155], v26, s[4:7], s25 offen sc1
  buffer_load_dwordx4 v[156:159], v27, s[4:7], s25 offen sc1
  s_waitcnt vmcnt(5)
  v_cmp_eq_u32 vcc, -1, v136
  s_cbranch_vccnz reca_retry72
  s_branch reca_resume73
reca_retry72_to:
  s_mov_b32 s18, 0
  s_waitcnt vmcnt(0)
  s_branch reca_resume73
reca_retry74:
  s_sub_u32 s18, s18, 1
  s_cbranch_scc1 reca_retry74_to
  buffer_load_dwordx4 v[140:143], v23, s[4:7], s25 offen sc1
  buffer_load_dwordx4 v[144:147], v24, s[4:7], s25 offen sc1
  buffer_load_dwordx4 v[148:151], v25, s[4:7], s25 offen sc1
  buffer_load_dwordx4 v[152:155], v26, s[4:7], s25 offen sc1
  buffer_load_dwordx4 v[156:159], v27, s[4:7], s25 offen sc1
  s_waitcnt vmcnt(4)
  v_cmp_eq_u32 vcc, -1, v140
  s_cbranch_vccnz reca_retry74
  s_branch reca_resume75
reca_retry74_to:
  s_mov_b32 s18, 0
  s_waitcnt vmcnt(0)
  s_branch reca_resume75
reca_retry76:
  s_sub_u32 s18, s18, 1
  s_cbranch_scc1 reca_retry76_to
  buffer_load_dwordx4 v[144:147], v24, s[4:7], s25 offen sc1
  buffer_load_dwordx4 v[148:151], v25, s[4:7], s25 offen sc1
  buffer_load_dwordx4 v[152:155], v26, s[4:7], s25 offen sc1
  buffer_load_dwordx4 v[156:159], v27, s[4:7], s25 offen sc1
  s_waitcnt vmcnt(3)
  v_cmp_eq_u32 vcc, -1, v144
  s_cbranch_vccnz reca_retry76
  s_branch reca_resume77
reca_retry76_to:
  s_mov_b32 s18, 0
  s_waitcnt vmcnt(0)
  s_branch reca_resume77
reca_retry78:
  s_sub_u32 s18, s18, 1
  s_cbranch_scc1 reca_retry78_to
  buffer_load_dwordx4 v[148:151], v25, s[4:7], s25 offen sc1
  buffer_load_dwordx4 v[152:155], v26, s[4:7], s25 offen sc1
  buffer_load_dwordx4 v[156:159], v27, s[4:7], s25 offen sc1
  s_waitcnt vmcnt(2)
  v_cmp_eq_u32 vcc, -1, v148
  s_cbranch_vccnz reca_retry78
  s_branch reca_resume79
reca_retry78_to:
  s_mov_b32 s18, 0
  s_waitcnt vmcnt(0)
  s_branch reca_resume79
reca_retry80:
  s_sub_u32 s18, s18, 1
  s_cbranch_scc1 reca_retry80_to
  buffer_load_dwordx4 v[152:155], v26, s[4:7], s25 offen sc1
  buffer_load_dwordx4 v[156:159], v27, s[4:7], s25 offen sc1
  s_waitcnt vmcnt(1)
  v_cmp_eq_u32 vcc, -1, v152
  s_cbranch_vccnz reca_retry80
  s_branch reca_resume81
reca_retry80_to:
  s_mov_b32 s18, 0
  s_waitcnt vmcnt(0)
  s_branch reca_resume81
reca_retry82:
  s_sub_u32 s18, s18, 1
  s_cbranch_scc1 reca_retry82_to
  buffer_load_dwordx4 v[156:159], v27, s[4:7], s25 offen sc1
  s_waitcnt vmcnt(0)
  v_cmp_eq_u32 vcc, -1, v156
  s_cbranch_vccnz reca_retry82
  s_branch reca_resume83
reca_retry82_to:
  s_mov_b32 s18, 0
  s_waitcnt vmcnt(0)
  s_branch reca_resume83
reca_twinf12:
  s_branch reca_gotmem88
reca_step87:
  s_and_b32 s34, s17, 3
  s_mul_i32 s20, s34, 10240
  s_add_u32 s20, s20, s38
  s_sleep 5
  buffer_load_dwordx4 v[128:131], v4, s[4:7], s20 offen sc1
  buffer_load_dwordx4 v[132:135], v4, s[4:7], s20 offen offset:1024 sc1
  buffer_load_dwordx4 v[136:139], v5, s[4:7], s20 offen sc1
  s_waitcnt vmcnt(2)
  v_max_u32 v29, v128, v130
  v_cmp_eq_u32 vcc, -1, v29
  s_cbranch_vccnz reca_retry90
reca_resume91:
  s_waitcnt vmcnt(1)
  v_max_u32 v29, v132, v134
  v_cmp_eq_u32 vcc, -1, v29
  ds_write_b128 v4, v[128:131]
  s_cbranch_vccnz reca_retry92
reca_resume93:
  s_waitcnt vmcnt(0)
  v_max_u32 v29, v136, v138
  v_cmp_eq_u32 vcc, -1, v29
  ds_write_b128 v4, v[132:135] offset:1024
  s_cbranch_vccnz reca_retry94
reca_resume95:
  ds_write_b128 v5, v[136:139]
  s_branch reca_gotmem289
reca_gotmem88:
  ds_write_b128 v4, v[128:131]
  ds_write_b128 v4, v[132:135] offset:1024
  ds_write_b128 v5, v[136:139]
reca_gotmem289:
  s_and_b32 s34, s17, 3
  s_mul_i32 s21, s34, 6144
  s_add_u32 s21, s21, s39
  s_mul_i32 s22, s34, 12288
  s_add_u32 s22, s22, s40
  s_mul_i32 s25, s34, 393216
  s_add_u32 s25, s25, s56
  s_add_u32 s35, s17, 1
  s_and_b32 s35, s35, 3
  s_mul_i32 s24, s35, 10240
  s_add_u32 s24, s24, s38
  s_waitcnt lgkmcnt(0)
  s_barrier
  ds_read_b128 v[128:131], v236 offset:0
  ds_read_b128 v[132:135], v236 offset:1024
  ds_read_b128 v[136:139], v236 offset:2048
  ds_read_b128 v[140:143], v236 offset:3072
  ds_read_b128 v[144:147], v236 offset:4096
  ds_read_b128 v[148:151], v237 offset:0
  ds_read_b128 v[152:155], v237 offset:1024
  ds_read_b128 v[156:159], v237 offset:2048
  ds_read_b128 v[160:163], v237 offset:3072
  ds_read_b128 v[164:167], v237 offset:4096
  s_waitcnt lgkmcnt(9)
  v_mfma_f32_16x16x32_bf16 v[44:47], a[0:3], v[128:131], 0
  ds_read_b128 v[168:171], v6 offset:0
  v_mfma_f32_16x16x32_bf16 v[240:243], a[4:7], v[128:131], 0
  s_waitcnt lgkmcnt(9)
  v_mfma_f32_16x16x32_bf16 v[44:47], a[8:11], v[132:135], v[44:47]
  ds_read_b128 v[172:175], v6 offset:512
  v_mfma_f32_16x16x32_bf16 v[240:243], a[12:15], v[132:135], v[240:243]
  s_waitcnt lgkmcnt(9)
  v_mfma_f32_16x16x32_bf16 v[44:47], a[16:19], v[136:139], v[44:47]
  ds_read_b128 v[176:179], v6 offset:1024
  v_mfma_f32_16x16x32_bf16 v[240:243], a[20:23], v[136:139], v[240:243]
  s_waitcnt lgkmcnt(9)
  v_mfma_f32_16x16x32_bf16 v[44:47], a[24:27], v[140:143], v[44:47]
  ds_read_b128 v[180:183], v6 offset:1536
  v_mfma_f32_16x16x32_bf16 v[240:243], a[28:31], v[140:143], v[240:243]
  s_waitcnt lgkmcnt(9)
  v_mfma_f32_16x16x32_bf16 v[44:47], a[32:35], v[144:147], v[44:47]
  ds_read_b128 v[184:187], v6 offset:2048
  v_mfma_f32_16x16x32_bf16 v[240:243], a[36:39], v[144:147], v[240:243]
  s_waitcnt lgkmcnt(9)
  v_mfma_f32_16x16x32_bf16 v[44:47], a[40:43], v[148:151], v[44:47]
  ds_read_b128 v[188:191], v6 offset:2560
  v_mfma_f32_16x16x32_bf16 v[240:243], a[44:47], v[148:151], v[240:243]
  s_waitcnt lgkmcnt(9)
  v_mfma_f32_16x16x32_bf16 v[44:47], a[48:51], v[152:155], v[44:47]
  ds_read_b128 v[192:195], v6 offset:3072
  v_mfma_f32_16x16x32_bf16 v[240:243], a[52:55], v[152:155], v[240:243]
  s_waitcnt lgkmcnt(9)
  v_mfma_f32_16x16x32_bf16 v[44:47], a[56:59], v[156:159], v[44:47]
  ds_read_b128 v[196:199], v6 offset:3584
  v_mfma_f32_16x16x32_bf16 v[240:243], a[60:63], v[156:159], v[240:243]
  s_waitcnt lgkmcnt(9)
  v_mfma_f32_16x16x32_bf16 v[44:47], a[64:67], v[160:163], v[44:47]
  ds_read_b128 v[200:203], v6 offset:4096
  v_mfma_f32_16x16x32_bf16 v[240:243], a[68:71], v[160:163], v[240:243]
  s_waitcnt lgkmcnt(9)
  v_mfma_f32_16x16x32_bf16 v[44:47], a[72:75], v[164:167], v[44:47]
  ds_read_b128 v[204:207], v6 offset:4608
  v_mfma_f32_16x16x32_bf16 v[240:243], a[76:79], v[164:167], v[240:243]
  s_waitcnt lgkmcnt(9)
  v_mfma_f32_16x16x32_bf16 v[48:51], v[168:171], a[80:83], 0
  s_and_b32 s34, s17, 7
  s_lshl_b32 s34, s34, 5
  s_add_u32 s34, s34, s15
  s_mul_i32 s34, s34, 3072
  s_lshl_b32 s35, s16, 9
  s_add_u32 s34, s34, s35
  s_add_u32 s30, s34, 47185920
  s_add_u32 s31, s34, 47972352
  v_add_f32_dpp v44, v240, v44 row_ror:8 row_mask:0xf bank_mask:0xf
  v_add_f32_dpp v45, v241, v45 row_ror:8 row_mask:0xf bank_mask:0xf
  v_add_f32_dpp v46, v242, v46 row_ror:8 row_mask:0xf bank_mask:0xf
  v_add_f32_dpp v47, v243, v47 row_ror:8 row_mask:0xf bank_mask:0xf
  v_cvt_pk_bf16_f32 v52, v44, v45
  v_cvt_pk_bf16_f32 v53, v46, v47
  buffer_store_dwordx2 v[52:53], v8, s[4:7], s21 offen
  s_waitcnt lgkmcnt(8)
  v_mfma_f32_16x16x32_bf16 v[48:51], v[172:175], a[84:87], v[48:51]
  s_waitcnt lgkmcnt(7)
  v_mfma_f32_16x16x32_bf16 v[48:51], v[176:179], a[88:91], v[48:51]
  s_waitcnt lgkmcnt(6)
  v_mfma_f32_16x16x32_bf16 v[48:51], v[180:183], a[92:95], v[48:51]
  s_waitcnt lgkmcnt(5)
  v_mfma_f32_16x16x32_bf16 v[48:51], v[184:187], a[96:99], v[48:51]
  s_waitcnt lgkmcnt(4)
  v_mfma_f32_16x16x32_bf16 v[48:51], v[188:191], a[100:103], v[48:51]
  s_waitcnt lgkmcnt(3)
  v_mfma_f32_16x16x32_bf16 v[48:51], v[192:195], a[104:107], v[48:51]
  s_waitcnt lgkmcnt(2)
  v_mfma_f32_16x16x32_bf16 v[48:51], v[196:199], a[108:111], v[48:51]
  s_waitcnt lgkmcnt(1)
  v_mfma_f32_16x16x32_bf16 v[48:51], v[200:203], a[112:115], v[48:51]
  s_waitcnt lgkmcnt(0)
  v_mfma_f32_16x16x32_bf16 v[48:51], v[204:207], a[116:119], v[48:51]
  s_cmp_eq_u32 s12, 3
  s_cbranch_scc1 reca_swave96
  s_nop 5
  ds_write_b128 v17, v[48:51]
  s_add_u32 s34, s17, 2
  s_and_b32 s34, s34, 3
  s_mul_i32 s26, s34, 10240
  s_add_u32 s26, s26, s38
  s_mul_i32 s27, s34, 6144
  s_add_u32 s27, s27, s39
  s_mul_i32 s28, s34, 12288
  s_add_u32 s28, s28, s40
  s_mul_i32 s29, s34, 393216
  s_add_u32 s29, s29, s56
  s_waitcnt lgkmcnt(0)
  s_barrier
  s_cmp_eq_u32 s17, 63
  s_cbranch_scc1 reca_last98
  buffer_store_dwordx2 v[32:33], v8, s[4:7], s27 offen
  s_cmp_lg_u32 s12, 2
  s_cbranch_scc1 reca_tw1102_n
  buffer_store_dwordx2 v[52:53], v9, s[4:7], s30 offen
reca_tw1102_n:
  s_barrier
  s_cmp_eq_u32 s12, 1
  s_cbranch_scc1 reca_tw1102
  s_cmp_eq_u32 s12, 2
  s_cbranch_scc1 reca_tw2103
  s_cmp_lt_u32 s17, 2
  s_cbranch_scc1 reca_b5101
  s_cmp_gt_u32 s17, 61
  s_cbranch_scc1 reca_b5101
  s_sub_u32 s36, s17, 2
  s_and_b32 s36, s36, 7
  s_lshl_b32 s34, s59, 3
  s_add_u32 s34, s34, s36
  s_mul_i32 s34, s34, 12288
  s_add_u32 s23, s34, 37748736
  s_add_u32 s60, s34, 44040192
  s_lshl_b32 s35, s36, 5
  s_add_u32 s35, s35, s59
  s_mul_i32 s35, s35, 3072
  s_add_u32 s61, s35, 47185920
  buffer_load_dwordx4 a[120:123], v1, s[4:7], s23 offen offset:0 sc1
  buffer_load_dwordx4 a[124:127], v1, s[4:7], s23 offen offset:1024 sc1
  buffer_load_dwordx4 a[128:131], v1, s[4:7], s23 offen offset:2048 sc1
  buffer_load_dwordx4 a[132:135], v1, s[4:7], s23 offen offset:3072 sc1
  buffer_load_dwordx4 a[136:139], v2, s[4:7], s23 offen offset:0 sc1
  buffer_load_dwordx4 a[140:143], v2, s[4:7], s23 offen offset:1024 sc1
  buffer_load_dwordx4 a[144:147], v2, s[4:7], s23 offen offset:2048 sc1
  buffer_load_dwordx4 a[148:151], v2, s[4:7], s23 offen offset:3072 sc1
  buffer_load_dwordx4 a[152:155], v3, s[4:7], s23 offen offset:0 sc1
  buffer_load_dwordx4 a[156:159], v3, s[4:7], s23 offen offset:1024 sc1
  buffer_load_dwordx4 a[160:163], v3, s[4:7], s23 offen offset:2048 sc1
  buffer_load_dwordx4 a[164:167], v3, s[4:7], s23 offen offset:3072 sc1
  buffer_load_dwordx4 a[216:219], v92, s[4:7], s61 offen offset:0 sc1
  buffer_load_dwordx4 a[220:223], v92, s[4:7], s61 offen offset:512 sc1
  buffer_load_dwordx4 a[224:227], v92, s[4:7], s61 offen offset:1024 sc1
  buffer_load_dwordx4 a[228:231], v92, s[4:7], s61 offen offset:1536 sc1
  buffer_load_dwordx4 a[232:235], v92, s[4:7], s61 offen offset:2048 sc1
  buffer_load_dwordx4 a[236:239], v92, s[4:7], s61 offen offset:2560 sc1
  buffer_load_dwordx4 a[168:171], v1, s[4:7], s60 offen offset:0 sc1
  buffer_load_dwordx4 a[172:175], v1, s[4:7], s60 offen offset:1024 sc1
  buffer_load_dwordx4 a[176:179], v1, s[4:7], s60 offen offset:2048 sc1
  buffer_load_dwordx4 a[180:183], v1, s[4:7], s60 offen offset:3072 sc1
  buffer_load_dwordx4 a[184:187], v2, s[4:7], s60 offen offset:0 sc1
  buffer_load_dwordx4 a[188:191], v2, s[4:7], s60 offen offset:1024 sc1
  buffer_load_dwordx4 a[192:195], v2, s[4:7], s60 offen offset:2048 sc1
  buffer_load_dwordx4 a[196:199], v2, s[4:7], s60 offen offset:3072 sc1
  buffer_load_dwordx4 a[200:203], v3, s[4:7], s60 offen offset:0 sc1
  buffer_load_dwordx4 a[204:207], v3, s[4:7], s60 offen offset:1024 sc1
  buffer_load_dwordx4 a[208:211], v3, s[4:7], s60 offen offset:2048 sc1
  buffer_load_dwordx4 a[212:215], v3, s[4:7], s60 offen offset:3072 sc1
  s_waitcnt vmcnt(5)
  v_mfma_f32_16x16x32_bf16 v[128:131], a[216:219], a[168:171], v[84:87]
  v_mfma_f32_16x16x32_bf16 v[132:135], a[120:123], a[168:171], v[88:91]
  v_mfma_f32_16x16x32_bf16 v[136:139], a[216:219], a[192:195], v[84:87]
  v_mfma_f32_16x16x32_bf16 v[140:143], a[120:123], a[192:195], 0
  v_mfma_f32_16x16x32_bf16 v[144:147], a[144:147], a[192:195], v[88:91]
  s_waitcnt vmcnt(4)
  v_mfma_f32_16x16x32_bf16 v[128:131], a[220:223], a[172:175], v[128:131]
  v_mfma_f32_16x16x32_bf16 v[132:135], a[124:127], a[172:175], v[132:135]
  v_mfma_f32_16x16x32_bf16 v[136:139], a[220:223], a[196:199], v[136:139]
  v_mfma_f32_16x16x32_bf16 v[140:143], a[124:127], a[196:199], v[140:143]
  v_mfma_f32_16x16x32_bf16 v[144:147], a[148:151], a[196:199], v[144:147]
  s_waitcnt vmcnt(3)
  v_mfma_f32_16x16x32_bf16 v[128:131], a[224:227], a[176:179], v[128:131]
  v_mfma_f32_16x16x32_bf16 v[132:135], a[128:131], a[176:179], v[132:135]
  v_mfma_f32_16x16x32_bf16 v[136:139], a[224:227], a[200:203], v[136:139]
  v_mfma_f32_16x16x32_bf16 v[140:143], a[128:131], a[200:203], v[140:143]
  v_mfma_f32_16x16x32_bf16 v[144:147], a[152:155], a[200:203], v[144:147]
  s_waitcnt vmcnt(2)
  v_mfma_f32_16x16x32_bf16 v[128:131], a[228:231], a[180:183], v[128:131]
  v_mfma_f32_16x16x32_bf16 v[132:135], a[132:135], a[180:183], v[132:135]
  v_mfma_f32_16x16x32_bf16 v[136:139], a[228:231], a[204:207], v[136:139]
  v_mfma_f32_16x16x32_bf16 v[140:143], a[132:135], a[204:207], v[140:143]
  v_mfma_f32_16x16x32_bf16 v[144:147], a[156:159], a[204:207], v[144:147]
  s_waitcnt vmcnt(1)
  v_mfma_f32_16x16x32_bf16 v[128:131], a[232:235], a[184:187], v[128:131]
  v_mfma_f32_16x16x32_bf16 v[132:135], a[136:139], a[184:187], v[132:135]
  v_mfma_f32_16x16x32_bf16 v[136:139], a[232:235], a[208:211], v[136:139]
  v_mfma_f32_16x16x32_bf16 v[140:143], a[136:139], a[208:211], v[140:143]
  v_mfma_f32_16x16x32_bf16 v[144:147], a[160:163], a[208:211], v[144:147]
  s_waitcnt vmcnt(0)
  v_mfma_f32_16x16x32_bf16 v[128:131], a[236:239], a[188:191], v[128:131]
  v_mfma_f32_16x16x32_bf16 v[132:135], a[140:143], a[188:191], v[132:135]
  v_mfma_f32_16x16x32_bf16 v[136:139], a[236:239], a[212:215], v[136:139]
  v_mfma_f32_16x16x32_bf16 v[140:143], a[140:143], a[212:215], v[140:143]
  v_mfma_f32_16x16x32_bf16 v[144:147], a[164:167], a[212:215], v[144:147]
  s_nop 3
  v_max3_f32 v28, v128, v129, v130
  v_max3_f32 v28, v28, v131, v132
  v_max3_f32 v28, v28, v133, v134
  v_max_f32 v28, v28, v135
  v_mov_b32 v29, v28
  s_nop 1
  v_permlane32_swap_b32 v28, v29
  v_max_f32 v28, v28, v29
  v_mov_b32 v29, v28
  s_nop 1
  v_permlane16_swap_b32 v28, v29
  v_max_f32 v28, v28, v29
  v_mul_f32 v28, s41, v28
  v_fma_f32 v128, v128, s41, -v28
  v_fma_f32 v129, v129, s41, -v28
  v_fma_f32 v130, v130, s41, -v28
  v_fma_f32 v131, v131, s41, -v28
  v_fma_f32 v132, v132, s41, -v28
  v_fma_f32 v133, v133, s41, -v28
  v_fma_f32 v134, v134, s41, -v28
  v_fma_f32 v135, v135, s41, -v28
  v_exp_f32 v128, v128
  v_exp_f32 v129, v129
  v_exp_f32 v130, v130
  v_exp_f32 v131, v131
  v_exp_f32 v132, v132
  v_exp_f32 v133, v133
  v_exp_f32 v134, v134
  v_exp_f32 v135, v135
  v_max3_f32 v30, v136, v137, v138
  v_max3_f32 v30, v30, v139, v140
  v_max3_f32 v30, v30, v141, v142
  v_max3_f32 v30, v30, v143, v144
  v_max3_f32 v30, v30, v145, v146
  v_max_f32 v30, v30, v147
  v_mov_b32 v29, v30
  s_nop 1
  v_permlane32_swap_b32 v30, v29
  v_max_f32 v30, v30, v29
  v_mov_b32 v29, v30
  s_nop 1
  v_permlane16_swap_b32 v30, v29
  v_max_f32 v30, v30, v29
  v_mul_f32 v30, s41, v30
  v_fma_f32 v136, v136, s41, -v30
  v_fma_f32 v137, v137, s41, -v30
  v_fma_f32 v138, v138, s41, -v30
  v_fma_f32 v139, v139, s41, -v30
  v_fma_f32 v140, v140, s41, -v30
  v_fma_f32 v141, v141, s41, -v30
  v_fma_f32 v142, v142, s41, -v30
  v_fma_f32 v143, v143, s41, -v30
  v_fma_f32 v144, v144, s41, -v30
  v_fma_f32 v145, v145, s41, -v30
  v_fma_f32 v146, v146, s41, -v30
  v_fma_f32 v147, v147, s41, -v30
  v_exp_f32 v136, v136
  v_exp_f32 v137, v137
  v_exp_f32 v138, v138
  v_exp_f32 v139, v139
  v_exp_f32 v140, v140
  v_exp_f32 v141, v141
  v_exp_f32 v142, v142
  v_exp_f32 v143, v143
  v_exp_f32 v144, v144
  v_exp_f32 v145, v145
  v_exp_f32 v146, v146
  v_exp_f32 v147, v147
  v_cvt_pk_bf16_f32 v72, v128, v129
  v_cvt_pk_bf16_f32 v73, v130, v131
  v_cvt_pk_bf16_f32 v74, v132, v133
  v_cvt_pk_bf16_f32 v75, v134, v135
  v_cvt_pk_bf16_f32 v76, v136, v137
  v_cvt_pk_bf16_f32 v77, v138, v139
  v_cvt_pk_bf16_f32 v78, v140, v141
  v_cvt_pk_bf16_f32 v79, v142, v143
  v_cvt_pk_bf16_f32 v80, v144, v145
  v_cvt_pk_bf16_f32 v81, v146, v147
  v_mfma_f32_16x16x16_bf16 v[148:151], v[36:37], v[72:73], 0
  v_mfma_f32_16x16x16_bf16 v[152:155], v[36:37], v[76:77], 0
  v_mfma_f32_16x16x16_bf16 v[148:151], v[36:37], v[74:75], v[148:151]
  v_mfma_f32_16x16x32_bf16 v[152:155], v[36:39], v[78:81], v[152:155]
  s_nop 6
  v_rcp_f32 v82, v148
  v_rcp_f32 v83, v152
  s_and_b32 s34, s17, 1
  s_mul_i32 s34, s34, 3072
  v_add_u32 v28, s34, v1
  ds_write_b128 v28, v[72:75] offset:16384
  ds_write_b128 v28, v[76:79] offset:17408
  ds_write_b128 v28, v[80:83] offset:18432
  s_waitcnt lgkmcnt(0)
  s_branch reca_b5101
reca_tw1102:
  s_cmp_lt_u32 s17, 3
  s_cbranch_scc1 reca_b5101
  s_sub_u32 s36, s17, 3
  s_and_b32 s37, s36, 7
  s_lshl_b32 s34, s59, 3
  s_add_u32 s34, s34, s37
  s_mul_i32 s34, s34, 12288
  s_add_u32 s23, s34, 40894464
  s_lshl_b32 s35, s37, 5
  s_add_u32 s35, s35, s59
  s_mul_i32 s35, s35, 3072
  s_add_u32 s61, s35, 47972352
  s_mul_i32 s34, s36, 393216
  s_mul_i32 s35, s59, 6144
  s_add_u32 s34, s34, s35
  s_add_u32 s60, s34, 57147392
  s_add_u32 s34, s17, 1
  s_and_b32 s34, s34, 1
  s_mul_i32 s34, s34, 3072
  v_add_u32 v28, s34, v1
  ds_read_b128 v[72:75], v28 offset:16384
  ds_read_b128 v[76:79], v28 offset:17408
  ds_read_b128 v[80:83], v28 offset:18432
  buffer_load_dwordx2 a[168:169], v93, s[4:7], s61 offen offset:0 sc1
  buffer_load_dwordx4 a[120:123], v1, s[4:7], s23 offen offset:0 sc1
  buffer_load_dwordx2 a[170:171], v93, s[4:7], s61 offen offset:256 sc1
  buffer_load_dwordx4 a[124:127], v1, s[4:7], s23 offen offset:1024 sc1
  buffer_load_dwordx2 a[172:173], v93, s[4:7], s61 offen offset:512 sc1
  buffer_load_dwordx4 a[128:131], v1, s[4:7], s23 offen offset:2048 sc1
  buffer_load_dwordx2 a[174:175], v93, s[4:7], s61 offen offset:768 sc1
  buffer_load_dwordx4 a[132:135], v1, s[4:7], s23 offen offset:3072 sc1
  buffer_load_dwordx2 a[176:177], v93, s[4:7], s61 offen offset:1024 sc1
  buffer_load_dwordx4 a[136:139], v2, s[4:7], s23 offen offset:0 sc1
  buffer_load_dwordx2 a[178:179], v93, s[4:7], s61 offen offset:1280 sc1
  buffer_load_dwordx4 a[140:143], v2, s[4:7], s23 offen offset:1024 sc1
  s_waitcnt lgkmcnt(0)
  s_waitcnt vmcnt(8)
  v_mfma_f32_16x16x16_bf16 v[156:159], a[168:169], v[72:73], 0
  v_mfma_f32_16x16x16_bf16 v[160:163], a[168:169], v[76:77], 0
  v_mfma_f32_16x16x16_bf16 v[156:159], a[120:121], v[74:75], v[156:159]
  v_mfma_f32_16x16x32_bf16 v[160:163], a[120:123], v[78:81], v[160:163]
  v_mfma_f32_16x16x16_bf16 v[164:167], a[170:171], v[72:73], 0
  v_mfma_f32_16x16x16_bf16 v[168:171], a[170:171], v[76:77], 0
  v_mfma_f32_16x16x16_bf16 v[164:167], a[124:125], v[74:75], v[164:167]
  v_mfma_f32_16x16x32_bf16 v[168:171], a[124:127], v[78:81], v[168:171]
  s_nop 2
  v_mul_f32 v156, v156, v82
  v_mul_f32 v157, v157, v82
  v_mul_f32 v158, v158, v82
  v_mul_f32 v159, v159, v82
  v_cvt_pk_bf16_f32 v172, v156, v157
  v_cvt_pk_bf16_f32 v173, v158, v159
  v_mul_f32 v164, v164, v82
  v_mul_f32 v165, v165, v82
  v_mul_f32 v166, v166, v82
  v_mul_f32 v167, v167, v82
  v_cvt_pk_bf16_f32 v174, v164, v165
  v_cvt_pk_bf16_f32 v175, v166, v167
  buffer_store_dwordx4 v[172:175], v1, s[4:7], s60 offen offset:0 sc1
  v_mul_f32 v160, v160, v83
  v_mul_f32 v161, v161, v83
  v_mul_f32 v162, v162, v83
  v_mul_f32 v163, v163, v83
  v_cvt_pk_bf16_f32 v176, v160, v161
  v_cvt_pk_bf16_f32 v177, v162, v163
  v_mul_f32 v168, v168, v83
  v_mul_f32 v169, v169, v83
  v_mul_f32 v170, v170, v83
  v_mul_f32 v171, v171, v83
  v_cvt_pk_bf16_f32 v178, v168, v169
  v_cvt_pk_bf16_f32 v179, v170, v171
  s_add_u32 s34, s60, 196608
  buffer_store_dwordx4 v[176:179], v1, s[4:7], s34 offen offset:0 sc1
  s_waitcnt vmcnt(6)
  v_mfma_f32_16x16x16_bf16 v[156:159], a[172:173], v[72:73], 0
  v_mfma_f32_16x16x16_bf16 v[160:163], a[172:173], v[76:77], 0
  v_mfma_f32_16x16x16_bf16 v[156:159], a[128:129], v[74:75], v[156:159]
  v_mfma_f32_16x16x32_bf16 v[160:163], a[128:131], v[78:81], v[160:163]
  v_mfma_f32_16x16x16_bf16 v[164:167], a[174:175], v[72:73], 0
  v_mfma_f32_16x16x16_bf16 v[168:171], a[174:175], v[76:77], 0
  v_mfma_f32_16x16x16_bf16 v[164:167], a[132:133], v[74:75], v[164:167]
  v_mfma_f32_16x16x32_bf16 v[168:171], a[132:135], v[78:81], v[168:171]
  s_nop 2
  v_mul_f32 v156, v156, v82
  v_mul_f32 v157, v157, v82
  v_mul_f32 v158, v158, v82
  v_mul_f32 v159, v159, v82
  v_cvt_pk_bf16_f32 v172, v156, v157
  v_cvt_pk_bf16_f32 v173, v158, v159
  v_mul_f32 v164, v164, v82
  v_mul_f32 v165, v165, v82
  v_mul_f32 v166, v166, v82
  v_mul_f32 v167, v167, v82
  v_cvt_pk_bf16_f32 v174, v164, v165
  v_cvt_pk_bf16_f32 v175, v166, v167
  buffer_store_dwordx4 v[172:175], v1, s[4:7], s60 offen offset:1024 sc1
  v_mul_f32 v160, v160, v83
  v_mul_f32 v161, v161, v83
  v_mul_f32 v162, v162, v83
  v_mul_f32 v163, v163, v83
  v_cvt_pk_bf16_f32 v176, v160, v161
  v_cvt_pk_bf16_f32 v177, v162, v163
  v_mul_f32 v168, v168, v83
  v_mul_f32 v169, v169, v83
  v_mul_f32 v170, v170, v83
  v_mul_f32 v171, v171, v83
  v_cvt_pk_bf16_f32 v178, v168, v169
  v_cvt_pk_bf16_f32 v179, v170, v171
  s_add_u32 s34, s60, 196608
  buffer_store_dwordx4 v[176:179], v1, s[4:7], s34 offen offset:1024 sc1
  s_waitcnt vmcnt(4)
  v_mfma_f32_16x16x16_bf16 v[156:159], a[176:177], v[72:73], 0
  v_mfma_f32_16x16x16_bf16 v[160:163], a[176:177], v[76:77], 0
  v_mfma_f32_16x16x16_bf16 v[156:159], a[136:137], v[74:75], v[156:159]
  v_mfma_f32_16x16x32_bf16 v[160:163], a[136:139], v[78:81], v[160:163]
  v_mfma_f32_16x16x16_bf16 v[164:167], a[178:179], v[72:73], 0
  v_mfma_f32_16x16x16_bf16 v[168:171], a[178:179], v[76:77], 0
  v_mfma_f32_16x16x16_bf16 v[164:167], a[140:141], v[74:75], v[164:167]
  v_mfma_f32_16x16x32_bf16 v[168:171], a[140:143], v[78:81], v[168:171]
  s_nop 2
  v_mul_f32 v156, v156, v82
  v_mul_f32 v157, v157, v82
  v_mul_f32 v158, v158, v82
  v_mul_f32 v159, v159, v82
  v_cvt_pk_bf16_f32 v172, v156, v157
  v_cvt_pk_bf16_f32 v173, v158, v159
  v_mul_f32 v164, v164, v82
  v_mul_f32 v165, v165, v82
  v_mul_f32 v166, v166, v82
  v_mul_f32 v167, v167, v82
  v_cvt_pk_bf16_f32 v174, v164, v165
  v_cvt_pk_bf16_f32 v175, v166, v167
  buffer_store_dwordx4 v[172:175], v1, s[4:7], s60 offen offset:2048 sc1
  v_mul_f32 v160, v160, v83
  v_mul_f32 v161, v161, v83
  v_mul_f32 v162, v162, v83
  v_mul_f32 v163, v163, v83
  v_cvt_pk_bf16_f32 v176, v160, v161
  v_cvt_pk_bf16_f32 v177, v162, v163
  v_mul_f32 v168, v168, v83
  v_mul_f32 v169, v169, v83
  v_mul_f32 v170, v170, v83
  v_mul_f32 v171, v171, v83
  v_cvt_pk_bf16_f32 v178, v168, v169
  v_cvt_pk_bf16_f32 v179, v170, v171
  s_add_u32 s34, s60, 196608
  buffer_store_dwordx4 v[176:179], v1, s[4:7], s34 offen offset:2048 sc1
  s_branch reca_b5101
reca_tw2103:
  s_cmp_lt_u32 s17, 3
  s_cbranch_scc1 reca_b5101
  s_sub_u32 s36, s17, 3
  s_and_b32 s37, s36, 7
  s_lshl_b32 s34, s59, 3
  s_add_u32 s34, s34, s37
  s_mul_i32 s34, s34, 12288
  s_add_u32 s23, s34, 40894464
  s_lshl_b32 s35, s37, 5
  s_add_u32 s35, s35, s59
  s_mul_i32 s35, s35, 3072
  s_add_u32 s61, s35, 47972352
  s_mul_i32 s34, s36, 393216
  s_mul_i32 s35, s59, 6144
  s_add_u32 s34, s34, s35
  s_add_u32 s60, s34, 57147392
  s_add_u32 s34, s17, 1
  s_and_b32 s34, s34, 1
  s_mul_i32 s34, s34, 3072
  v_add_u32 v28, s34, v1
  ds_read_b128 v[72:75], v28 offset:16384
  ds_read_b128 v[76:79], v28 offset:17408
  ds_read_b128 v[80:83], v28 offset:18432
  buffer_load_dwordx2 a[180:181], v93, s[4:7], s61 offen offset:1536 sc1
  buffer_load_dwordx4 a[144:147], v2, s[4:7], s23 offen offset:2048 sc1
  buffer_load_dwordx2 a[182:183], v93, s[4:7], s61 offen offset:1792 sc1
  buffer_load_dwordx4 a[148:151], v2, s[4:7], s23 offen offset:3072 sc1
  buffer_load_dwordx2 a[184:185], v93, s[4:7], s61 offen offset:2048 sc1
  buffer_load_dwordx4 a[152:155], v3, s[4:7], s23 offen offset:0 sc1
  buffer_load_dwordx2 a[186:187], v93, s[4:7], s61 offen offset:2304 sc1
  buffer_load_dwordx4 a[156:159], v3, s[4:7], s23 offen offset:1024 sc1
  buffer_load_dwordx2 a[188:189], v93, s[4:7], s61 offen offset:2560 sc1
  buffer_load_dwordx4 a[160:163], v3, s[4:7], s23 offen offset:2048 sc1
  buffer_load_dwordx2 a[190:191], v93, s[4:7], s61 offen offset:2816 sc1
  buffer_load_dwordx4 a[164:167], v3, s[4:7], s23 offen offset:3072 sc1
  s_waitcnt lgkmcnt(0)
  s_waitcnt vmcnt(8)
  v_mfma_f32_16x16x16_bf16 v[156:159], a[180:181], v[72:73], 0
  v_mfma_f32_16x16x16_bf16 v[160:163], a[180:181], v[76:77], 0
  v_mfma_f32_16x16x16_bf16 v[156:159], a[144:145], v[74:75], v[156:159]
  v_mfma_f32_16x16x32_bf16 v[160:163], a[144:147], v[78:81], v[160:163]
  v_mfma_f32_16x16x16_bf16 v[164:167], a[182:183], v[72:73], 0
  v_mfma_f32_16x16x16_bf16 v[168:171], a[182:183], v[76:77], 0
  v_mfma_f32_16x16x16_bf16 v[164:167], a[148:149], v[74:75], v[164:167]
  v_mfma_f32_16x16x32_bf16 v[168:171], a[148:151], v[78:81], v[168:171]
  s_nop 2
  v_mul_f32 v156, v156, v82
  v_mul_f32 v157, v157, v82
  v_mul_f32 v158, v158, v82
  v_mul_f32 v159, v159, v82
  v_cvt_pk_bf16_f32 v172, v156, v157
  v_cvt_pk_bf16_f32 v173, v158, v159
  v_mul_f32 v164, v164, v82
  v_mul_f32 v165, v165, v82
  v_mul_f32 v166, v166, v82
  v_mul_f32 v167, v167, v82
  v_cvt_pk_bf16_f32 v174, v164, v165
  v_cvt_pk_bf16_f32 v175, v166, v167
  buffer_store_dwordx4 v[172:175], v1, s[4:7], s60 offen offset:3072 sc1
  v_mul_f32 v160, v160, v83
  v_mul_f32 v161, v161, v83
  v_mul_f32 v162, v162, v83
  v_mul_f32 v163, v163, v83
  v_cvt_pk_bf16_f32 v176, v160, v161
  v_cvt_pk_bf16_f32 v177, v162, v163
  v_mul_f32 v168, v168, v83
  v_mul_f32 v169, v169, v83
  v_mul_f32 v170, v170, v83
  v_mul_f32 v171, v171, v83
  v_cvt_pk_bf16_f32 v178, v168, v169
  v_cvt_pk_bf16_f32 v179, v170, v171
  s_add_u32 s34, s60, 196608
  buffer_store_dwordx4 v[176:179], v1, s[4:7], s34 offen offset:3072 sc1
  s_waitcnt vmcnt(6)
  v_mfma_f32_16x16x16_bf16 v[156:159], a[184:185], v[72:73], 0
  v_mfma_f32_16x16x16_bf16 v[160:163], a[184:185], v[76:77], 0
  v_mfma_f32_16x16x16_bf16 v[156:159], a[152:153], v[74:75], v[156:159]
  v_mfma_f32_16x16x32_bf16 v[160:163], a[152:155], v[78:81], v[160:163]
  v_mfma_f32_16x16x16_bf16 v[164:167], a[186:187], v[72:73], 0
  v_mfma_f32_16x16x16_bf16 v[168:171], a[186:187], v[76:77], 0
  v_mfma_f32_16x16x16_bf16 v[164:167], a[156:157], v[74:75], v[164:167]
  v_mfma_f32_16x16x32_bf16 v[168:171], a[156:159], v[78:81], v[168:171]
  s_nop 2
  v_mul_f32 v156, v156, v82
  v_mul_f32 v157, v157, v82
  v_mul_f32 v158, v158, v82
  v_mul_f32 v159, v159, v82
  v_cvt_pk_bf16_f32 v172, v156, v157
  v_cvt_pk_bf16_f32 v173, v158, v159
  v_mul_f32 v164, v164, v82
  v_mul_f32 v165, v165, v82
  v_mul_f32 v166, v166, v82
  v_mul_f32 v167, v167, v82
  v_cvt_pk_bf16_f32 v174, v164, v165
  v_cvt_pk_bf16_f32 v175, v166, v167
  buffer_store_dwordx4 v[172:175], v2, s[4:7], s60 offen offset:0 sc1
  v_mul_f32 v160, v160, v83
  v_mul_f32 v161, v161, v83
  v_mul_f32 v162, v162, v83
  v_mul_f32 v163, v163, v83
  v_cvt_pk_bf16_f32 v176, v160, v161
  v_cvt_pk_bf16_f32 v177, v162, v163
  v_mul_f32 v168, v168, v83
  v_mul_f32 v169, v169, v83
  v_mul_f32 v170, v170, v83
  v_mul_f32 v171, v171, v83
  v_cvt_pk_bf16_f32 v178, v168, v169
  v_cvt_pk_bf16_f32 v179, v170, v171
  s_add_u32 s34, s60, 196608
  buffer_store_dwordx4 v[176:179], v2, s[4:7], s34 offen offset:0 sc1
  s_waitcnt vmcnt(4)
  v_mfma_f32_16x16x16_bf16 v[156:159], a[188:189], v[72:73], 0
  v_mfma_f32_16x16x16_bf16 v[160:163], a[188:189], v[76:77], 0
  v_mfma_f32_16x16x16_bf16 v[156:159], a[160:161], v[74:75], v[156:159]
  v_mfma_f32_16x16x32_bf16 v[160:163], a[160:163], v[78:81], v[160:163]
  v_mfma_f32_16x16x16_bf16 v[164:167], a[190:191], v[72:73], 0
  v_mfma_f32_16x16x16_bf16 v[168:171], a[190:191], v[76:77], 0
  v_mfma_f32_16x16x16_bf16 v[164:167], a[164:165], v[74:75], v[164:167]
  v_mfma_f32_16x16x32_bf16 v[168:171], a[164:167], v[78:81], v[168:171]
  s_nop 2
  v_mul_f32 v156, v156, v82
  v_mul_f32 v157, v157, v82
  v_mul_f32 v158, v158, v82
  v_mul_f32 v159, v159, v82
  v_cvt_pk_bf16_f32 v172, v156, v157
  v_cvt_pk_bf16_f32 v173, v158, v159
  v_mul_f32 v164, v164, v82
  v_mul_f32 v165, v165, v82
  v_mul_f32 v166, v166, v82
  v_mul_f32 v167, v167, v82
  v_cvt_pk_bf16_f32 v174, v164, v165
  v_cvt_pk_bf16_f32 v175, v166, v167
  buffer_store_dwordx4 v[172:175], v2, s[4:7], s60 offen offset:1024 sc1
  v_mul_f32 v160, v160, v83
  v_mul_f32 v161, v161, v83
  v_mul_f32 v162, v162, v83
  v_mul_f32 v163, v163, v83
  v_cvt_pk_bf16_f32 v176, v160, v161
  v_cvt_pk_bf16_f32 v177, v162, v163
  v_mul_f32 v168, v168, v83
  v_mul_f32 v169, v169, v83
  v_mul_f32 v170, v170, v83
  v_mul_f32 v171, v171, v83
  v_cvt_pk_bf16_f32 v178, v168, v169
  v_cvt_pk_bf16_f32 v179, v170, v171
  s_add_u32 s34, s60, 196608
  buffer_store_dwordx4 v[176:179], v2, s[4:7], s34 offen offset:1024 sc1
  s_branch reca_b5101
  s_cmp_lg_u32 s12, 2
  s_cbranch_scc1 reca_b399
  buffer_store_dwordx2 v[52:53], v9, s[4:7], s30 offen
  buffer_store_dwordx2 v[32:33], v16, s[4:7], s26 offen
  s_cmp_lg_u32 s14, 0
  s_cbranch_scc1 reca_b399
  v_mov_b32 v28, s17
  s_lshl_b32 s34, s13, 7
  s_add_u32 s34, s34, 1507328
  buffer_store_dword v28, v19, s[4:7], s34 offen
  s_branch reca_b399
reca_last98:
  s_cmp_lg_u32 s12, 2
  s_cbranch_scc1 reca_exit1
  buffer_store_dwordx2 v[52:53], v9, s[4:7], s30 offen
  s_branch reca_exit1
reca_swave96:
  s_cmp_lg_u32 s17, 63
  s_cbranch_scc1 reca_vmst104
  s_barrier
  ds_read_b128 v[56:59], v1 offset:10240
  ds_read_b128 v[60:63], v1 offset:11264
  ds_read_b128 v[64:67], v1 offset:12288
  s_waitcnt lgkmcnt(0)
  v_add_f32 v56, v56, v64
  v_add_f32 v60, v60, v48
  v_add_f32 v57, v57, v65
  v_add_f32 v61, v61, v49
  v_add_f32 v58, v58, v66
  v_add_f32 v62, v62, v50
  v_add_f32 v59, v59, v67
  v_add_f32 v63, v63, v51
  v_cvt_pk_bf16_f32 v68, v56, v57
  v_cvt_pk_bf16_f32 v69, v58, v59
  v_cvt_pk_bf16_f32 v70, v60, v61
  v_cvt_pk_bf16_f32 v71, v62, v63
  buffer_store_dwordx2 v[52:53], v9, s[4:7], s30 offen
  buffer_store_dwordx2 v[68:69], v10, s[4:7], s31 offen
  buffer_store_dwordx2 v[70:71], v10, s[4:7], s31 offen offset:256
  s_branch reca_exit1
reca_vmst104:
  s_sleep 1
  buffer_load_dwordx4 v[208:211], v1, s[4:7], s21 offen offset:0 sc1
  buffer_load_dwordx4 v[212:215], v1, s[4:7], s21 offen offset:1024 sc1
  buffer_load_dwordx4 v[216:219], v1, s[4:7], s21 offen offset:2048 sc1
  buffer_load_dwordx4 v[220:223], v1, s[4:7], s21 offen offset:3072 sc1
  buffer_load_dwordx4 v[224:227], v2, s[4:7], s21 offen offset:0 sc1
  buffer_load_dwordx4 v[228:231], v2, s[4:7], s21 offen offset:1024 sc1
  s_waitcnt vmcnt(5)
  v_max_u32 v29, v208, v210
  v_cmp_eq_u32 vcc, -1, v29
  s_cbranch_vccnz reca_retry105
reca_resume106:
  s_waitcnt vmcnt(4)
  v_max_u32 v29, v212, v214
  v_cmp_eq_u32 vcc, -1, v29
  v_mfma_f32_16x16x32_bf16 v[76:79], a[120:123], v[208:211], 0
  v_mfma_f32_16x16x32_bf16 v[80:83], a[144:147], v[208:211], 0
  v_mfma_f32_16x16x32_bf16 v[72:75], v[208:211], v[208:211], v[40:43]
  s_cbranch_vccnz reca_retry107
reca_resume108:
  s_waitcnt vmcnt(3)
  v_max_u32 v29, v216, v218
  v_cmp_eq_u32 vcc, -1, v29
  v_mfma_f32_16x16x32_bf16 v[76:79], a[124:127], v[212:215], v[76:79]
  v_mfma_f32_16x16x32_bf16 v[80:83], a[148:151], v[212:215], v[80:83]
  v_mfma_f32_16x16x32_bf16 v[72:75], v[212:215], v[212:215], v[72:75]
  s_cbranch_vccnz reca_retry109
reca_resume110:
  s_waitcnt vmcnt(2)
  v_max_u32 v29, v220, v222
  v_cmp_eq_u32 vcc, -1, v29
  v_mfma_f32_16x16x32_bf16 v[76:79], a[128:131], v[216:219], v[76:79]
  v_mfma_f32_16x16x32_bf16 v[80:83], a[152:155], v[216:219], v[80:83]
  v_mfma_f32_16x16x32_bf16 v[72:75], v[216:219], v[216:219], v[72:75]
  s_cbranch_vccnz reca_retry111
reca_resume112:
  s_waitcnt vmcnt(1)
  v_max_u32 v29, v224, v226
  v_cmp_eq_u32 vcc, -1, v29
  v_mfma_f32_16x16x32_bf16 v[76:79], a[132:135], v[220:223], v[76:79]
  v_mfma_f32_16x16x32_bf16 v[80:83], a[156:159], v[220:223], v[80:83]
  v_mfma_f32_16x16x32_bf16 v[72:75], v[220:223], v[220:223], v[72:75]
  s_cbranch_vccnz reca_retry113
reca_resume114:
  s_waitcnt vmcnt(0)
  v_max_u32 v29, v228, v230
  v_cmp_eq_u32 vcc, -1, v29
  v_mfma_f32_16x16x32_bf16 v[76:79], a[136:139], v[224:227], v[76:79]
  v_mfma_f32_16x16x32_bf16 v[80:83], a[160:163], v[224:227], v[80:83]
  v_mfma_f32_16x16x32_bf16 v[72:75], v[224:227], v[224:227], v[72:75]
  s_cbranch_vccnz reca_retry115
reca_resume116:
  v_mfma_f32_16x16x32_bf16 v[76:79], a[140:143], v[228:231], v[76:79]
  v_mfma_f32_16x16x32_bf16 v[80:83], a[164:167], v[228:231], v[80:83]
  v_mfma_f32_16x16x32_bf16 v[72:75], v[228:231], v[228:231], v[72:75]
  s_barrier
  ds_read_b128 v[56:59], v1 offset:10240
  ds_read_b128 v[60:63], v1 offset:11264
  ds_read_b128 v[64:67], v1 offset:12288
  s_nop 1
  v_max3_f32 v28, v76, v77, v78
  v_max3_f32 v29, v80, v81, v82
  v_max3_f32 v28, v28, v79, v83
  v_max3_f32 v29, v29, v72, v73
  v_max3_f32 v28, v28, v74, v75
  v_max_f32 v28, v28, v29
  v_mov_b32 v29, v28
  s_nop 1
  v_permlane32_swap_b32 v28, v29
  v_max_f32 v28, v28, v29
  v_mov_b32 v29, v28
  s_nop 1
  v_permlane16_swap_b32 v28, v29
  v_max_f32 v28, v28, v29
  v_mul_f32 v28, s41, v28
  v_fma_f32 v76, v76, s41, -v28
  v_fma_f32 v77, v77, s41, -v28
  v_fma_f32 v78, v78, s41, -v28
  v_fma_f32 v79, v79, s41, -v28
  v_fma_f32 v80, v80, s41, -v28
  v_fma_f32 v81, v81, s41, -v28
  v_fma_f32 v82, v82, s41, -v28
  v_fma_f32 v83, v83, s41, -v28
  v_fma_f32 v72, v72, s41, -v28
  v_fma_f32 v73, v73, s41, -v28
  v_fma_f32 v74, v74, s41, -v28
  v_fma_f32 v75, v75, s41, -v28
  v_exp_f32 v76, v76
  v_exp_f32 v77, v77
  v_exp_f32 v78, v78
  v_exp_f32 v79, v79
  v_exp_f32 v80, v80
  v_exp_f32 v81, v81
  v_exp_f32 v82, v82
  v_exp_f32 v83, v83
  v_cvt_pk_bf16_f32 v84, v76, v77
  v_cvt_pk_bf16_f32 v85, v78, v79
  v_cvt_pk_bf16_f32 v86, v80, v81
  v_cvt_pk_bf16_f32 v87, v82, v83
  v_exp_f32 v72, v72
  v_exp_f32 v73, v73
  v_mfma_f32_16x16x32_bf16 v[100:103], v[36:39], v[84:87], 0
  v_exp_f32 v74, v74
  v_exp_f32 v75, v75
  v_mfma_f32_16x16x32_bf16 v[92:95], a[168:171], v[84:87], 0
  v_cvt_pk_bf16_f32 v88, v72, v73
  v_cvt_pk_bf16_f32 v89, v74, v75
  v_mfma_f32_16x16x32_bf16 v[96:99], a[172:175], v[84:87], 0
  s_waitcnt lgkmcnt(0)
  v_mfma_f32_16x16x16_bf16 v[100:103], v[36:37], v[88:89], v[100:103]
  v_add_f32 v56, v56, v64
  v_add_f32 v60, v60, v48
  v_add_f32 v57, v57, v65
  v_add_f32 v61, v61, v49
  v_add_f32 v58, v58, v66
  v_add_f32 v62, v62, v50
  v_add_f32 v59, v59, v67
  v_add_f32 v63, v63, v51
  v_cvt_pk_bf16_f32 v68, v56, v57
  v_cvt_pk_bf16_f32 v69, v58, v59
  v_cvt_pk_bf16_f32 v70, v60, v61
  v_cvt_pk_bf16_f32 v71, v62, v63
  v_mfma_f32_16x16x16_bf16 v[92:95], v[68:69], v[88:89], v[92:95]
  v_rcp_f32 v28, v100
  v_mfma_f32_16x16x16_bf16 v[96:99], v[70:71], v[88:89], v[96:99]
  v_mov_b32 v29, v28
  s_nop 4
  v_pk_mul_f32 v[92:93], v[92:93], v[28:29]
  v_pk_mul_f32 v[94:95], v[94:95], v[28:29]
  v_pk_mul_f32 v[96:97], v[96:97], v[28:29]
  v_pk_mul_f32 v[98:99], v[98:99], v[28:29]
  v_cvt_pk_bf16_f32 v104, v92, v93
  v_cvt_pk_bf16_f32 v105, v94, v95
  v_cvt_pk_bf16_f32 v106, v96, v97
  v_cvt_pk_bf16_f32 v107, v98, v99
  buffer_store_dwordx4 v[104:107], v11, s[4:7], s22 offen
  s_barrier
  s_add_u32 s34, s17, 2
  s_and_b32 s34, s34, 3
  s_mul_i32 s26, s34, 10240
  s_add_u32 s26, s26, s38
  s_mul_i32 s27, s34, 6144
  s_add_u32 s27, s27, s39
  s_mul_i32 s28, s34, 12288
  s_add_u32 s28, s28, s40
  s_mul_i32 s29, s34, 393216
  s_add_u32 s29, s29, s56
  buffer_store_dwordx2 v[32:33], v8, s[4:7], s27 offen
  buffer_store_dwordx4 v[32:35], v11, s[4:7], s28 offen
  s_add_u32 s36, s17, 1
  s_cmp_ge_u32 s36, 63
  s_cbranch_scc1 reca_nopf117
  s_add_u32 s37, s36, 1
reca_pf118:
  buffer_load_dword v28, v233, s[4:7], 0 offen sc1
  s_waitcnt vmcnt(0)
  v_cmp_gt_i32 vcc, s37, v28
  s_cbranch_vccz reca_pfok119
  s_sleep 1
  s_sub_u32 s18, s18, 1
  s_cbranch_scc0 reca_pf118
  s_mov_b32 s18, 0
reca_pfok119:
  s_lshl_b32 s34, s15, 3
  s_and_b32 s35, s36, 7
  s_add_u32 s34, s34, s35
  s_mul_i32 s34, s34, 12288
  s_add_u32 s32, s34, 37748736
  s_lshl_b32 s35, s16, 11
  s_add_u32 s34, s34, s35
  s_add_u32 s33, s34, 40894464
  buffer_load_dwordx4 a[120:123], v1, s[4:7], s32 offen offset:0 sc1
  buffer_load_dwordx4 a[124:127], v1, s[4:7], s32 offen offset:1024 sc1
  buffer_load_dwordx4 a[128:131], v1, s[4:7], s32 offen offset:2048 sc1
  buffer_load_dwordx4 a[132:135], v1, s[4:7], s32 offen offset:3072 sc1
  buffer_load_dwordx4 a[136:139], v2, s[4:7], s32 offen offset:0 sc1
  buffer_load_dwordx4 a[140:143], v2, s[4:7], s32 offen offset:1024 sc1
  buffer_load_dwordx4 a[144:147], v2, s[4:7], s32 offen offset:2048 sc1
  buffer_load_dwordx4 a[148:151], v2, s[4:7], s32 offen offset:3072 sc1
  buffer_load_dwordx4 a[152:155], v3, s[4:7], s32 offen offset:0 sc1
  buffer_load_dwordx4 a[156:159], v3, s[4:7], s32 offen offset:1024 sc1
  buffer_load_dwordx4 a[160:163], v3, s[4:7], s32 offen offset:2048 sc1
  buffer_load_dwordx4 a[164:167], v3, s[4:7], s32 offen offset:3072 sc1
  buffer_load_dwordx4 a[168:171], v1, s[4:7], s33 offen offset:0 sc1
  buffer_load_dwordx4 a[172:175], v1, s[4:7], s33 offen offset:1024 sc1
reca_nopf117:
  buffer_store_dwordx2 v[52:53], v9, s[4:7], s30 offen
  buffer_store_dwordx2 v[68:69], v10, s[4:7], s31 offen
  buffer_store_dwordx2 v[70:71], v10, s[4:7], s31 offen offset:256
reca_b5101:
  s_barrier
  s_add_u32 s17, s17, 1
  s_branch reca_step87
reca_b399:
  s_endpgm
reca_retry90:
  s_sub_u32 s18, s18, 1
  s_cbranch_scc1 reca_retry90_to
  buffer_load_dwordx4 v[128:131], v4, s[4:7], s20 offen sc1
  buffer_load_dwordx4 v[132:135], v4, s[4:7], s20 offen offset:1024 sc1
  buffer_load_dwordx4 v[136:139], v5, s[4:7], s20 offen sc1
  s_waitcnt vmcnt(2)
  v_max_u32 v29, v128, v130
  v_cmp_eq_u32 vcc, -1, v29
  s_cbranch_vccnz reca_retry90
  s_branch reca_resume91
reca_retry90_to:
  s_mov_b32 s18, 0
  s_waitcnt vmcnt(0)
  s_branch reca_resume91
reca_retry92:
  s_sub_u32 s18, s18, 1
  s_cbranch_scc1 reca_retry92_to
  buffer_load_dwordx4 v[132:135], v4, s[4:7], s20 offen offset:1024 sc1
  buffer_load_dwordx4 v[136:139], v5, s[4:7], s20 offen sc1
  s_waitcnt vmcnt(1)
  v_max_u32 v29, v132, v134
  v_cmp_eq_u32 vcc, -1, v29
  s_cbranch_vccnz reca_retry92
  s_branch reca_resume93
reca_retry92_to:
  s_mov_b32 s18, 0
  s_waitcnt vmcnt(0)
  s_branch reca_resume93
reca_retry94:
  s_sub_u32 s18, s18, 1
  s_cbranch_scc1 reca_retry94_to
  buffer_load_dwordx4 v[136:139], v5, s[4:7], s20 offen sc1
  s_waitcnt vmcnt(0)
  v_max_u32 v29, v136, v138
  v_cmp_eq_u32 vcc, -1, v29
  s_cbranch_vccnz reca_retry94
  s_branch reca_resume95
reca_retry94_to:
  s_mov_b32 s18, 0
  s_waitcnt vmcnt(0)
  s_branch reca_resume95
reca_retry105:
  s_sub_u32 s18, s18, 1
  s_cbranch_scc1 reca_retry105_to
  buffer_load_dwordx4 v[208:211], v1, s[4:7], s21 offen offset:0 sc1
  buffer_load_dwordx4 v[212:215], v1, s[4:7], s21 offen offset:1024 sc1
  buffer_load_dwordx4 v[216:219], v1, s[4:7], s21 offen offset:2048 sc1
  buffer_load_dwordx4 v[220:223], v1, s[4:7], s21 offen offset:3072 sc1
  buffer_load_dwordx4 v[224:227], v2, s[4:7], s21 offen offset:0 sc1
  buffer_load_dwordx4 v[228:231], v2, s[4:7], s21 offen offset:1024 sc1
  s_waitcnt vmcnt(5)
  v_max_u32 v29, v208, v210
  v_cmp_eq_u32 vcc, -1, v29
  s_cbranch_vccnz reca_retry105
  s_branch reca_resume106
reca_retry105_to:
  s_mov_b32 s18, 0
  s_waitcnt vmcnt(0)
  s_branch reca_resume106
reca_retry107:
  s_sub_u32 s18, s18, 1
  s_cbranch_scc1 reca_retry107_to
  buffer_load_dwordx4 v[212:215], v1, s[4:7], s21 offen offset:1024 sc1
  buffer_load_dwordx4 v[216:219], v1, s[4:7], s21 offen offset:2048 sc1
  buffer_load_dwordx4 v[220:223], v1, s[4:7], s21 offen offset:3072 sc1
  buffer_load_dwordx4 v[224:227], v2, s[4:7], s21 offen offset:0 sc1
  buffer_load_dwordx4 v[228:231], v2, s[4:7], s21 offen offset:1024 sc1
  s_waitcnt vmcnt(4)
  v_max_u32 v29, v212, v214
  v_cmp_eq_u32 vcc, -1, v29
  s_cbranch_vccnz reca_retry107
  s_branch reca_resume108
reca_retry107_to:
  s_mov_b32 s18, 0
  s_waitcnt vmcnt(0)
  s_branch reca_resume108
reca_retry109:
  s_sub_u32 s18, s18, 1
  s_cbranch_scc1 reca_retry109_to
  buffer_load_dwordx4 v[216:219], v1, s[4:7], s21 offen offset:2048 sc1
  buffer_load_dwordx4 v[220:223], v1, s[4:7], s21 offen offset:3072 sc1
  buffer_load_dwordx4 v[224:227], v2, s[4:7], s21 offen offset:0 sc1
  buffer_load_dwordx4 v[228:231], v2, s[4:7], s21 offen offset:1024 sc1
  s_waitcnt vmcnt(3)
  v_max_u32 v29, v216, v218
  v_cmp_eq_u32 vcc, -1, v29
  s_cbranch_vccnz reca_retry109
  s_branch reca_resume110
reca_retry109_to:
  s_mov_b32 s18, 0
  s_waitcnt vmcnt(0)
  s_branch reca_resume110
reca_retry111:
  s_sub_u32 s18, s18, 1
  s_cbranch_scc1 reca_retry111_to
  buffer_load_dwordx4 v[220:223], v1, s[4:7], s21 offen offset:3072 sc1
  buffer_load_dwordx4 v[224:227], v2, s[4:7], s21 offen offset:0 sc1
  buffer_load_dwordx4 v[228:231], v2, s[4:7], s21 offen offset:1024 sc1
  s_waitcnt vmcnt(2)
  v_max_u32 v29, v220, v222
  v_cmp_eq_u32 vcc, -1, v29
  s_cbranch_vccnz reca_retry111
  s_branch reca_resume112
reca_retry111_to:
  s_mov_b32 s18, 0
  s_waitcnt vmcnt(0)
  s_branch reca_resume112
reca_retry113:
  s_sub_u32 s18, s18, 1
  s_cbranch_scc1 reca_retry113_to
  buffer_load_dwordx4 v[224:227], v2, s[4:7], s21 offen offset:0 sc1
  buffer_load_dwordx4 v[228:231], v2, s[4:7], s21 offen offset:1024 sc1
  s_waitcnt vmcnt(1)
  v_max_u32 v29, v224, v226
  v_cmp_eq_u32 vcc, -1, v29
  s_cbranch_vccnz reca_retry113
  s_branch reca_resume114
reca_retry113_to:
  s_mov_b32 s18, 0
  s_waitcnt vmcnt(0)
  s_branch reca_resume114
reca_retry115:
  s_sub_u32 s18, s18, 1
  s_cbranch_scc1 reca_retry115_to
  buffer_load_dwordx4 v[228:231], v2, s[4:7], s21 offen offset:1024 sc1
  s_waitcnt vmcnt(0)
  v_max_u32 v29, v228, v230
  v_cmp_eq_u32 vcc, -1, v29
  s_cbranch_vccnz reca_retry115
  s_branch reca_resume116
reca_retry115_to:
  s_mov_b32 s18, 0
  s_waitcnt vmcnt(0)
  s_branch reca_resume116
reca_slow11:
  s_cmp_ge_u32 s14, 20
  s_cbranch_scc1 reca_twins13
  s_branch reca_gotmem121
reca_step120:
  s_and_b32 s34, s17, 3
  s_mul_i32 s20, s34, 10240
  s_add_u32 s20, s20, s38
  s_sleep 2
  buffer_load_dwordx4 v[128:131], v4, s[4:7], s20 offen sc1
  buffer_load_dwordx4 v[132:135], v4, s[4:7], s20 offen offset:1024 sc1
  buffer_load_dwordx4 v[136:139], v5, s[4:7], s20 offen sc1
  s_waitcnt vmcnt(2)
  v_max_u32 v29, v128, v130
  v_cmp_eq_u32 vcc, -1, v29
  s_cbranch_vccnz reca_retry123
reca_resume124:
  s_waitcnt vmcnt(1)
  v_max_u32 v29, v132, v134
  v_cmp_eq_u32 vcc, -1, v29
  ds_write_b128 v4, v[128:131]
  s_cbranch_vccnz reca_retry125
reca_resume126:
  s_waitcnt vmcnt(0)
  v_max_u32 v29, v136, v138
  v_cmp_eq_u32 vcc, -1, v29
  ds_write_b128 v4, v[132:135] offset:1024
  s_cbranch_vccnz reca_retry127
reca_resume128:
  ds_write_b128 v5, v[136:139]
  s_branch reca_gotmem2122
reca_gotmem121:
  ds_write_b128 v4, v[128:131]
  ds_write_b128 v4, v[132:135] offset:1024
  ds_write_b128 v5, v[136:139]
reca_gotmem2122:
  s_and_b32 s34, s17, 3
  s_mul_i32 s21, s34, 6144
  s_add_u32 s21, s21, s39
  s_mul_i32 s22, s34, 12288
  s_add_u32 s22, s22, s40
  s_mul_i32 s25, s34, 393216
  s_add_u32 s25, s25, s56
  s_add_u32 s35, s17, 1
  s_and_b32 s35, s35, 3
  s_mul_i32 s24, s35, 10240
  s_add_u32 s24, s24, s38
  s_waitcnt lgkmcnt(0)
  s_barrier
  ds_read_b128 v[128:131], v236 offset:0
  ds_read_b128 v[132:135], v236 offset:1024
  ds_read_b128 v[136:139], v236 offset:2048
  ds_read_b128 v[140:143], v236 offset:3072
  ds_read_b128 v[144:147], v236 offset:4096
  ds_read_b128 v[148:151], v237 offset:0
  ds_read_b128 v[152:155], v237 offset:1024
  ds_read_b128 v[156:159], v237 offset:2048
  ds_read_b128 v[160:163], v237 offset:3072
  ds_read_b128 v[164:167], v237 offset:4096
  s_waitcnt lgkmcnt(9)
  v_mfma_f32_16x16x32_bf16 v[44:47], a[0:3], v[128:131], 0
  ds_read_b128 v[168:171], v6 offset:0
  v_mfma_f32_16x16x32_bf16 v[240:243], a[4:7], v[128:131], 0
  s_waitcnt lgkmcnt(9)
  v_mfma_f32_16x16x32_bf16 v[44:47], a[8:11], v[132:135], v[44:47]
  ds_read_b128 v[172:175], v6 offset:512
  v_mfma_f32_16x16x32_bf16 v[240:243], a[12:15], v[132:135], v[240:243]
  s_waitcnt lgkmcnt(9)
  v_mfma_f32_16x16x32_bf16 v[44:47], a[16:19], v[136:139], v[44:47]
  ds_read_b128 v[176:179], v6 offset:1024
  v_mfma_f32_16x16x32_bf16 v[240:243], a[20:23], v[136:139], v[240:243]
  s_waitcnt lgkmcnt(9)
  v_mfma_f32_16x16x32_bf16 v[44:47], a[24:27], v[140:143], v[44:47]
  ds_read_b128 v[180:183], v6 offset:1536
  v_mfma_f32_16x16x32_bf16 v[240:243], a[28:31], v[140:143], v[240:243]
  s_waitcnt lgkmcnt(9)
  v_mfma_f32_16x16x32_bf16 v[44:47], a[32:35], v[144:147], v[44:47]
  ds_read_b128 v[184:187], v6 offset:2048
  v_mfma_f32_16x16x32_bf16 v[240:243], a[36:39], v[144:147], v[240:243]
  s_waitcnt lgkmcnt(9)
  v_mfma_f32_16x16x32_bf16 v[44:47], a[40:43], v[148:151], v[44:47]
  ds_read_b128 v[188:191], v6 offset:2560
  v_mfma_f32_16x16x32_bf16 v[240:243], a[44:47], v[148:151], v[240:243]
  s_waitcnt lgkmcnt(9)
  v_mfma_f32_16x16x32_bf16 v[44:47], a[48:51], v[152:155], v[44:47]
  ds_read_b128 v[192:195], v6 offset:3072
  v_mfma_f32_16x16x32_bf16 v[240:243], a[52:55], v[152:155], v[240:243]
  s_waitcnt lgkmcnt(9)
  v_mfma_f32_16x16x32_bf16 v[44:47], a[56:59], v[156:159], v[44:47]
  ds_read_b128 v[196:199], v6 offset:3584
  v_mfma_f32_16x16x32_bf16 v[240:243], a[60:63], v[156:159], v[240:243]
  s_waitcnt lgkmcnt(9)
  v_mfma_f32_16x16x32_bf16 v[44:47], a[64:67], v[160:163], v[44:47]
  ds_read_b128 v[200:203], v6 offset:4096
  v_mfma_f32_16x16x32_bf16 v[240:243], a[68:71], v[160:163], v[240:243]
  s_waitcnt lgkmcnt(9)
  v_mfma_f32_16x16x32_bf16 v[44:47], a[72:75], v[164:167], v[44:47]
  ds_read_b128 v[204:207], v6 offset:4608
  v_mfma_f32_16x16x32_bf16 v[240:243], a[76:79], v[164:167], v[240:243]
  s_waitcnt lgkmcnt(9)
  v_mfma_f32_16x16x32_bf16 v[48:51], v[168:171], a[80:83], 0
  s_and_b32 s34, s17, 7
  s_lshl_b32 s34, s34, 5
  s_add_u32 s34, s34, s15
  s_mul_i32 s34, s34, 3072
  s_lshl_b32 s35, s16, 9
  s_add_u32 s34, s34, s35
  s_add_u32 s30, s34, 47185920
  s_add_u32 s31, s34, 47972352
  v_add_f32_dpp v44, v240, v44 row_ror:8 row_mask:0xf bank_mask:0xf
  v_add_f32_dpp v45, v241, v45 row_ror:8 row_mask:0xf bank_mask:0xf
  v_add_f32_dpp v46, v242, v46 row_ror:8 row_mask:0xf bank_mask:0xf
  v_add_f32_dpp v47, v243, v47 row_ror:8 row_mask:0xf bank_mask:0xf
  v_cvt_pk_bf16_f32 v52, v44, v45
  v_cvt_pk_bf16_f32 v53, v46, v47
  buffer_store_dwordx2 v[52:53], v8, s[4:7], s21 offen sc1
  s_waitcnt lgkmcnt(8)
  v_mfma_f32_16x16x32_bf16 v[48:51], v[172:175], a[84:87], v[48:51]
  s_waitcnt lgkmcnt(7)
  v_mfma_f32_16x16x32_bf16 v[48:51], v[176:179], a[88:91], v[48:51]
  s_waitcnt lgkmcnt(6)
  v_mfma_f32_16x16x32_bf16 v[48:51], v[180:183], a[92:95], v[48:51]
  s_waitcnt lgkmcnt(5)
  v_mfma_f32_16x16x32_bf16 v[48:51], v[184:187], a[96:99], v[48:51]
  s_waitcnt lgkmcnt(4)
  v_mfma_f32_16x16x32_bf16 v[48:51], v[188:191], a[100:103], v[48:51]
  s_waitcnt lgkmcnt(3)
  v_mfma_f32_16x16x32_bf16 v[48:51], v[192:195], a[104:107], v[48:51]
  s_waitcnt lgkmcnt(2)
  v_mfma_f32_16x16x32_bf16 v[48:51], v[196:199], a[108:111], v[48:51]
  s_waitcnt lgkmcnt(1)
  v_mfma_f32_16x16x32_bf16 v[48:51], v[200:203], a[112:115], v[48:51]
  s_waitcnt lgkmcnt(0)
  v_mfma_f32_16x16x32_bf16 v[48:51], v[204:207], a[116:119], v[48:51]
  s_cmp_eq_u32 s12, 3
  s_cbranch_scc1 reca_swave129
  s_nop 5
  ds_write_b128 v17, v[48:51]
  s_add_u32 s34, s17, 2
  s_and_b32 s34, s34, 3
  s_mul_i32 s26, s34, 10240
  s_add_u32 s26, s26, s38
  s_mul_i32 s27, s34, 6144
  s_add_u32 s27, s27, s39
  s_mul_i32 s28, s34, 12288
  s_add_u32 s28, s28, s40
  s_mul_i32 s29, s34, 393216
  s_add_u32 s29, s29, s56
  s_waitcnt lgkmcnt(0)
  s_barrier
  s_cmp_eq_u32 s17, 63
  s_cbranch_scc1 reca_last131
  buffer_store_dwordx2 v[32:33], v8, s[4:7], s27 offen sc1
  s_cmp_lg_u32 s12, 2
  s_cbranch_scc1 reca_b3132
  buffer_store_dwordx2 v[52:53], v9, s[4:7], s30 offen sc1
  buffer_store_dwordx2 v[32:33], v16, s[4:7], s26 offen sc1
  s_cmp_lg_u32 s14, 0
  s_cbranch_scc1 reca_b3132
  v_mov_b32 v28, s17
  s_lshl_b32 s34, s13, 7
  s_add_u32 s34, s34, 1507328
  buffer_store_dword v28, v19, s[4:7], s34 offen sc1
  s_branch reca_b3132
reca_last131:
  s_cmp_lg_u32 s12, 2
  s_cbranch_scc1 reca_exit1
  buffer_store_dwordx2 v[52:53], v9, s[4:7], s30 offen
  s_branch reca_exit1
reca_swave129:
  s_cmp_lg_u32 s17, 63
  s_cbranch_scc1 reca_vmst135
  s_barrier
  ds_read_b128 v[56:59], v1 offset:10240
  ds_read_b128 v[60:63], v1 offset:11264
  ds_read_b128 v[64:67], v1 offset:12288
  s_waitcnt lgkmcnt(0)
  v_add_f32 v56, v56, v64
  v_add_f32 v60, v60, v48
  v_add_f32 v57, v57, v65
  v_add_f32 v61, v61, v49
  v_add_f32 v58, v58, v66
  v_add_f32 v62, v62, v50
  v_add_f32 v59, v59, v67
  v_add_f32 v63, v63, v51
  v_cvt_pk_bf16_f32 v68, v56, v57
  v_cvt_pk_bf16_f32 v69, v58, v59
  v_cvt_pk_bf16_f32 v70, v60, v61
  v_cvt_pk_bf16_f32 v71, v62, v63
  buffer_store_dwordx2 v[52:53], v9, s[4:7], s30 offen
  buffer_store_dwordx2 v[68:69], v10, s[4:7], s31 offen
  buffer_store_dwordx2 v[70:71], v10, s[4:7], s31 offen offset:256
  s_branch reca_exit1
reca_vmst135:
  s_sleep 1
  buffer_load_dwordx4 v[208:211], v1, s[4:7], s21 offen offset:0 sc1
  buffer_load_dwordx4 v[212:215], v1, s[4:7], s21 offen offset:1024 sc1
  buffer_load_dwordx4 v[216:219], v1, s[4:7], s21 offen offset:2048 sc1
  buffer_load_dwordx4 v[220:223], v1, s[4:7], s21 offen offset:3072 sc1
  buffer_load_dwordx4 v[224:227], v2, s[4:7], s21 offen offset:0 sc1
  buffer_load_dwordx4 v[228:231], v2, s[4:7], s21 offen offset:1024 sc1
  s_waitcnt vmcnt(5)
  v_max_u32 v29, v208, v210
  v_cmp_eq_u32 vcc, -1, v29
  s_cbranch_vccnz reca_retry136
reca_resume137:
  s_waitcnt vmcnt(4)
  v_max_u32 v29, v212, v214
  v_cmp_eq_u32 vcc, -1, v29
  v_mfma_f32_16x16x32_bf16 v[76:79], a[120:123], v[208:211], 0
  v_mfma_f32_16x16x32_bf16 v[80:83], a[144:147], v[208:211], 0
  v_mfma_f32_16x16x32_bf16 v[72:75], v[208:211], v[208:211], v[40:43]
  s_cbranch_vccnz reca_retry138
reca_resume139:
  s_waitcnt vmcnt(3)
  v_max_u32 v29, v216, v218
  v_cmp_eq_u32 vcc, -1, v29
  v_mfma_f32_16x16x32_bf16 v[76:79], a[124:127], v[212:215], v[76:79]
  v_mfma_f32_16x16x32_bf16 v[80:83], a[148:151], v[212:215], v[80:83]
  v_mfma_f32_16x16x32_bf16 v[72:75], v[212:215], v[212:215], v[72:75]
  s_cbranch_vccnz reca_retry140
reca_resume141:
  s_waitcnt vmcnt(2)
  v_max_u32 v29, v220, v222
  v_cmp_eq_u32 vcc, -1, v29
  v_mfma_f32_16x16x32_bf16 v[76:79], a[128:131], v[216:219], v[76:79]
  v_mfma_f32_16x16x32_bf16 v[80:83], a[152:155], v[216:219], v[80:83]
  v_mfma_f32_16x16x32_bf16 v[72:75], v[216:219], v[216:219], v[72:75]
  s_cbranch_vccnz reca_retry142
reca_resume143:
  s_waitcnt vmcnt(1)
  v_max_u32 v29, v224, v226
  v_cmp_eq_u32 vcc, -1, v29
  v_mfma_f32_16x16x32_bf16 v[76:79], a[132:135], v[220:223], v[76:79]
  v_mfma_f32_16x16x32_bf16 v[80:83], a[156:159], v[220:223], v[80:83]
  v_mfma_f32_16x16x32_bf16 v[72:75], v[220:223], v[220:223], v[72:75]
  s_cbranch_vccnz reca_retry144
reca_resume145:
  s_waitcnt vmcnt(0)
  v_max_u32 v29, v228, v230
  v_cmp_eq_u32 vcc, -1, v29
  v_mfma_f32_16x16x32_bf16 v[76:79], a[136:139], v[224:227], v[76:79]
  v_mfma_f32_16x16x32_bf16 v[80:83], a[160:163], v[224:227], v[80:83]
  v_mfma_f32_16x16x32_bf16 v[72:75], v[224:227], v[224:227], v[72:75]
  s_cbranch_vccnz reca_retry146
reca_resume147:
  v_mfma_f32_16x16x32_bf16 v[76:79], a[140:143], v[228:231], v[76:79]
  v_mfma_f32_16x16x32_bf16 v[80:83], a[164:167], v[228:231], v[80:83]
  v_mfma_f32_16x16x32_bf16 v[72:75], v[228:231], v[228:231], v[72:75]
  s_barrier
  ds_read_b128 v[56:59], v1 offset:10240
  ds_read_b128 v[60:63], v1 offset:11264
  ds_read_b128 v[64:67], v1 offset:12288
  s_nop 1
  v_max3_f32 v28, v76, v77, v78
  v_max3_f32 v29, v80, v81, v82
  v_max3_f32 v28, v28, v79, v83
  v_max3_f32 v29, v29, v72, v73
  v_max3_f32 v28, v28, v74, v75
  v_max_f32 v28, v28, v29
  v_mov_b32 v29, v28
  s_nop 1
  v_permlane32_swap_b32 v28, v29
  v_max_f32 v28, v28, v29
  v_mov_b32 v29, v28
  s_nop 1
  v_permlane16_swap_b32 v28, v29
  v_max_f32 v28, v28, v29
  v_mul_f32 v28, s41, v28
  v_fma_f32 v76, v76, s41, -v28
  v_fma_f32 v77, v77, s41, -v28
  v_fma_f32 v78, v78, s41, -v28
  v_fma_f32 v79, v79, s41, -v28
  v_fma_f32 v80, v80, s41, -v28
  v_fma_f32 v81, v81, s41, -v28
  v_fma_f32 v82, v82, s41, -v28
  v_fma_f32 v83, v83, s41, -v28
  v_fma_f32 v72, v72, s41, -v28
  v_fma_f32 v73, v73, s41, -v28
  v_fma_f32 v74, v74, s41, -v28
  v_fma_f32 v75, v75, s41, -v28
  v_exp_f32 v76, v76
  v_exp_f32 v77, v77
  v_exp_f32 v78, v78
  v_exp_f32 v79, v79
  v_exp_f32 v80, v80
  v_exp_f32 v81, v81
  v_exp_f32 v82, v82
  v_exp_f32 v83, v83
  v_cvt_pk_bf16_f32 v84, v76, v77
  v_cvt_pk_bf16_f32 v85, v78, v79
  v_cvt_pk_bf16_f32 v86, v80, v81
  v_cvt_pk_bf16_f32 v87, v82, v83
  v_exp_f32 v72, v72
  v_exp_f32 v73, v73
  v_mfma_f32_16x16x32_bf16 v[100:103], v[36:39], v[84:87], 0
  v_exp_f32 v74, v74
  v_exp_f32 v75, v75
  v_mfma_f32_16x16x32_bf16 v[92:95], a[168:171], v[84:87], 0
  v_cvt_pk_bf16_f32 v88, v72, v73
  v_cvt_pk_bf16_f32 v89, v74, v75
  v_mfma_f32_16x16x32_bf16 v[96:99], a[172:175], v[84:87], 0
  s_waitcnt lgkmcnt(0)
  v_mfma_f32_16x16x16_bf16 v[100:103], v[36:37], v[88:89], v[100:103]
  v_add_f32 v56, v56, v64
  v_add_f32 v60, v60, v48
  v_add_f32 v57, v57, v65
  v_add_f32 v61, v61, v49
  v_add_f32 v58, v58, v66
  v_add_f32 v62, v62, v50
  v_add_f32 v59, v59, v67
  v_add_f32 v63, v63, v51
  v_cvt_pk_bf16_f32 v68, v56, v57
  v_cvt_pk_bf16_f32 v69, v58, v59
  v_cvt_pk_bf16_f32 v70, v60, v61
  v_cvt_pk_bf16_f32 v71, v62, v63
  v_mfma_f32_16x16x16_bf16 v[92:95], v[68:69], v[88:89], v[92:95]
  v_rcp_f32 v28, v100
  v_mfma_f32_16x16x16_bf16 v[96:99], v[70:71], v[88:89], v[96:99]
  v_mov_b32 v29, v28
  s_nop 4
  v_pk_mul_f32 v[92:93], v[92:93], v[28:29]
  v_pk_mul_f32 v[94:95], v[94:95], v[28:29]
  v_pk_mul_f32 v[96:97], v[96:97], v[28:29]
  v_pk_mul_f32 v[98:99], v[98:99], v[28:29]
  v_cvt_pk_bf16_f32 v104, v92, v93
  v_cvt_pk_bf16_f32 v105, v94, v95
  v_cvt_pk_bf16_f32 v106, v96, v97
  v_cvt_pk_bf16_f32 v107, v98, v99
  buffer_store_dwordx4 v[104:107], v11, s[4:7], s22 offen sc1
reca_b3132:
  s_barrier
  s_cmp_ge_u32 s12, 2
  s_cbranch_scc1 reca_notg2148
  s_sleep 3
  buffer_load_dwordx4 v[128:131], v12, s[4:7], s22 offen offset:0 sc1
  buffer_load_dwordx4 v[132:135], v12, s[4:7], s22 offen offset:1024 sc1
  buffer_load_dwordx4 v[136:139], v12, s[4:7], s22 offen offset:2048 sc1
  buffer_load_dwordx4 v[140:143], v12, s[4:7], s22 offen offset:3072 sc1
  buffer_load_dwordx4 v[144:147], v13, s[4:7], s22 offen offset:0 sc1
  buffer_load_dwordx4 v[148:151], v13, s[4:7], s22 offen offset:1024 sc1
  buffer_load_dwordx4 v[152:155], v13, s[4:7], s22 offen offset:2048 sc1
  buffer_load_dwordx4 v[156:159], v13, s[4:7], s22 offen offset:3072 sc1
  buffer_load_dwordx4 v[160:163], v14, s[4:7], s22 offen offset:0 sc1
  buffer_load_dwordx4 v[164:167], v14, s[4:7], s22 offen offset:1024 sc1
  buffer_load_dwordx4 v[168:171], v14, s[4:7], s22 offen offset:2048 sc1
  buffer_load_dwordx4 v[172:175], v14, s[4:7], s22 offen offset:3072 sc1
  s_waitcnt vmcnt(11)
  v_cmp_eq_u32 vcc, -1, v128
  s_cbranch_vccnz reca_retry149
reca_resume150:
  s_waitcnt vmcnt(10)
  v_cmp_eq_u32 vcc, -1, v132
  v_mfma_f32_16x16x32_bf16 v[108:111], a[120:123], v[128:131], 0
  v_mfma_f32_16x16x32_bf16 v[112:115], a[124:127], v[128:131], 0
  s_cbranch_vccnz reca_retry151
reca_resume152:
  s_waitcnt vmcnt(9)
  v_cmp_eq_u32 vcc, -1, v136
  v_mfma_f32_16x16x32_bf16 v[108:111], a[128:131], v[132:135], v[108:111]
  v_mfma_f32_16x16x32_bf16 v[112:115], a[132:135], v[132:135], v[112:115]
  s_cbranch_vccnz reca_retry153
reca_resume154:
  s_waitcnt vmcnt(8)
  v_cmp_eq_u32 vcc, -1, v140
  v_mfma_f32_16x16x32_bf16 v[108:111], a[136:139], v[136:139], v[108:111]
  v_mfma_f32_16x16x32_bf16 v[112:115], a[140:143], v[136:139], v[112:115]
  s_cbranch_vccnz reca_retry155
reca_resume156:
  s_waitcnt vmcnt(7)
  v_cmp_eq_u32 vcc, -1, v144
  v_mfma_f32_16x16x32_bf16 v[108:111], a[144:147], v[140:143], v[108:111]
  v_mfma_f32_16x16x32_bf16 v[112:115], a[148:151], v[140:143], v[112:115]
  s_cbranch_vccnz reca_retry157
reca_resume158:
  s_waitcnt vmcnt(6)
  v_cmp_eq_u32 vcc, -1, v148
  v_mfma_f32_16x16x32_bf16 v[108:111], a[152:155], v[144:147], v[108:111]
  v_mfma_f32_16x16x32_bf16 v[112:115], a[156:159], v[144:147], v[112:115]
  s_cbranch_vccnz reca_retry159
reca_resume160:
  s_waitcnt vmcnt(5)
  v_cmp_eq_u32 vcc, -1, v152
  v_mfma_f32_16x16x32_bf16 v[108:111], a[160:163], v[148:151], v[108:111]
  v_mfma_f32_16x16x32_bf16 v[112:115], a[164:167], v[148:151], v[112:115]
  s_cbranch_vccnz reca_retry161
reca_resume162:
  s_waitcnt vmcnt(4)
  v_cmp_eq_u32 vcc, -1, v156
  v_mfma_f32_16x16x32_bf16 v[108:111], a[168:171], v[152:155], v[108:111]
  v_mfma_f32_16x16x32_bf16 v[112:115], a[172:175], v[152:155], v[112:115]
  s_cbranch_vccnz reca_retry163
reca_resume164:
  s_waitcnt vmcnt(3)
  v_cmp_eq_u32 vcc, -1, v160
  v_mfma_f32_16x16x32_bf16 v[108:111], a[176:179], v[156:159], v[108:111]
  v_mfma_f32_16x16x32_bf16 v[112:115], a[180:183], v[156:159], v[112:115]
  s_cbranch_vccnz reca_retry165
reca_resume166:
  s_waitcnt vmcnt(2)
  v_cmp_eq_u32 vcc, -1, v164
  v_mfma_f32_16x16x32_bf16 v[108:111], a[184:187], v[160:163], v[108:111]
  v_mfma_f32_16x16x32_bf16 v[112:115], a[188:191], v[160:163], v[112:115]
  s_cbranch_vccnz reca_retry167
reca_resume168:
  s_waitcnt vmcnt(1)
  v_cmp_eq_u32 vcc, -1, v168
  v_mfma_f32_16x16x32_bf16 v[108:111], a[192:195], v[164:167], v[108:111]
  v_mfma_f32_16x16x32_bf16 v[112:115], a[196:199], v[164:167], v[112:115]
  s_cbranch_vccnz reca_retry169
reca_resume170:
  s_waitcnt vmcnt(0)
  v_cmp_eq_u32 vcc, -1, v172
  v_mfma_f32_16x16x32_bf16 v[108:111], a[200:203], v[168:171], v[108:111]
  v_mfma_f32_16x16x32_bf16 v[112:115], a[204:207], v[168:171], v[112:115]
  s_cbranch_vccnz reca_retry171
reca_resume172:
  v_mfma_f32_16x16x32_bf16 v[108:111], a[208:211], v[172:175], v[108:111]
  v_mfma_f32_16x16x32_bf16 v[112:115], a[212:215], v[172:175], v[112:115]
  s_nop 7
  v_add_f32_dpp v116, v112, v108 row_ror:8 row_mask:0xf bank_mask:0xf
  v_add_f32_dpp v117, v113, v109 row_ror:8 row_mask:0xf bank_mask:0xf
  v_add_f32_dpp v118, v114, v110 row_ror:8 row_mask:0xf bank_mask:0xf
  v_add_f32_dpp v119, v115, v111 row_ror:8 row_mask:0xf bank_mask:0xf
  buffer_store_dwordx4 v[116:119], v15, s[4:7], s25 offen sc1
  buffer_store_dwordx4 v[116:119], v232, s[4:7], s25 offen sc1
  buffer_store_dwordx4 v[32:35], v15, s[4:7], s29 offen sc1
  buffer_store_dwordx4 v[32:35], v232, s[4:7], s29 offen sc1
  s_branch reca_b4133
reca_notg2148:
  s_cmp_lg_u32 s12, 3
  s_cbranch_scc1 reca_b4133
  s_add_u32 s34, s17, 2
  s_and_b32 s34, s34, 3
  s_mul_i32 s26, s34, 10240
  s_add_u32 s26, s26, s38
  s_mul_i32 s27, s34, 6144
  s_add_u32 s27, s27, s39
  s_mul_i32 s28, s34, 12288
  s_add_u32 s28, s28, s40
  s_mul_i32 s29, s34, 393216
  s_add_u32 s29, s29, s56
  buffer_store_dwordx2 v[32:33], v8, s[4:7], s27 offen sc1
  buffer_store_dwordx4 v[32:35], v11, s[4:7], s28 offen sc1
reca_b4133:
  s_barrier
  s_cmp_lg_u32 s12, 2
  s_cbranch_scc1 reca_not2173
  s_sleep 8
  buffer_load_dwordx4 v[128:131], v20, s[4:7], s25 offen sc1
  buffer_load_dwordx4 v[132:135], v21, s[4:7], s25 offen sc1
  buffer_load_dwordx4 v[136:139], v22, s[4:7], s25 offen sc1
  buffer_load_dwordx4 v[140:143], v23, s[4:7], s25 offen sc1
  buffer_load_dwordx4 v[144:147], v24, s[4:7], s25 offen sc1
  buffer_load_dwordx4 v[148:151], v25, s[4:7], s25 offen sc1
  buffer_load_dwordx4 v[152:155], v26, s[4:7], s25 offen sc1
  buffer_load_dwordx4 v[156:159], v27, s[4:7], s25 offen sc1
  s_waitcnt vmcnt(7)
  v_cmp_eq_u32 vcc, -1, v128
  s_cbranch_vccnz reca_retry174
reca_resume175:
  s_waitcnt vmcnt(6)
  v_cmp_eq_u32 vcc, -1, v132
  s_cbranch_vccnz reca_retry176
reca_resume177:
  s_waitcnt vmcnt(5)
  v_cmp_eq_u32 vcc, -1, v136
  v_pk_add_f32 v[116:117], v[128:129], v[132:133]
  v_pk_add_f32 v[118:119], v[130:131], v[134:135]
  s_cbranch_vccnz reca_retry178
reca_resume179:
  s_waitcnt vmcnt(4)
  v_cmp_eq_u32 vcc, -1, v140
  v_pk_add_f32 v[116:117], v[116:117], v[136:137]
  v_pk_add_f32 v[118:119], v[118:119], v[138:139]
  s_cbranch_vccnz reca_retry180
reca_resume181:
  s_waitcnt vmcnt(3)
  v_cmp_eq_u32 vcc, -1, v144
  v_pk_add_f32 v[116:117], v[116:117], v[140:141]
  v_pk_add_f32 v[118:119], v[118:119], v[142:143]
  s_cbranch_vccnz reca_retry182
reca_resume183:
  s_waitcnt vmcnt(2)
  v_cmp_eq_u32 vcc, -1, v148
  v_pk_add_f32 v[116:117], v[116:117], v[144:145]
  v_pk_add_f32 v[118:119], v[118:119], v[146:147]
  s_cbranch_vccnz reca_retry184
reca_resume185:
  s_waitcnt vmcnt(1)
  v_cmp_eq_u32 vcc, -1, v152
  v_pk_add_f32 v[116:117], v[116:117], v[148:149]
  v_pk_add_f32 v[118:119], v[118:119], v[150:151]
  s_cbranch_vccnz reca_retry186
reca_resume187:
  s_waitcnt vmcnt(0)
  v_cmp_eq_u32 vcc, -1, v156
  v_pk_add_f32 v[116:117], v[116:117], v[152:153]
  v_pk_add_f32 v[118:119], v[118:119], v[154:155]
  s_cbranch_vccnz reca_retry188
reca_resume189:
  v_pk_add_f32 v[116:117], v[116:117], v[156:157]
  v_pk_add_f32 v[118:119], v[118:119], v[158:159]
  v_cvt_pk_bf16_f32 v132, v116, v117
  v_cvt_pk_bf16_f32 v133, v118, v119
  buffer_store_dwordx2 v[132:133], v16, s[4:7], s24 offen sc1
  s_branch reca_b5134
reca_not2173:
  s_cmp_lg_u32 s12, 3
  s_cbranch_scc1 reca_b5134
  s_add_u32 s36, s17, 1
  s_cmp_ge_u32 s36, 63
  s_cbranch_scc1 reca_nopf190
  s_add_u32 s37, s36, 1
reca_pf191:
  buffer_load_dword v28, v233, s[4:7], 0 offen sc1
  s_waitcnt vmcnt(0)
  v_cmp_gt_i32 vcc, s37, v28
  s_cbranch_vccz reca_pfok192
  s_sleep 1
  s_sub_u32 s18, s18, 1
  s_cbranch_scc0 reca_pf191
  s_mov_b32 s18, 0
reca_pfok192:
  s_lshl_b32 s34, s15, 3
  s_and_b32 s35, s36, 7
  s_add_u32 s34, s34, s35
  s_mul_i32 s34, s34, 12288
  s_add_u32 s32, s34, 37748736
  s_lshl_b32 s35, s16, 11
  s_add_u32 s34, s34, s35
  s_add_u32 s33, s34, 40894464
  buffer_load_dwordx4 a[120:123], v1, s[4:7], s32 offen offset:0 sc1
  buffer_load_dwordx4 a[124:127], v1, s[4:7], s32 offen offset:1024 sc1
  buffer_load_dwordx4 a[128:131], v1, s[4:7], s32 offen offset:2048 sc1
  buffer_load_dwordx4 a[132:135], v1, s[4:7], s32 offen offset:3072 sc1
  buffer_load_dwordx4 a[136:139], v2, s[4:7], s32 offen offset:0 sc1
  buffer_load_dwordx4 a[140:143], v2, s[4:7], s32 offen offset:1024 sc1
  buffer_load_dwordx4 a[144:147], v2, s[4:7], s32 offen offset:2048 sc1
  buffer_load_dwordx4 a[148:151], v2, s[4:7], s32 offen offset:3072 sc1
  buffer_load_dwordx4 a[152:155], v3, s[4:7], s32 offen offset:0 sc1
  buffer_load_dwordx4 a[156:159], v3, s[4:7], s32 offen offset:1024 sc1
  buffer_load_dwordx4 a[160:163], v3, s[4:7], s32 offen offset:2048 sc1
  buffer_load_dwordx4 a[164:167], v3, s[4:7], s32 offen offset:3072 sc1
  buffer_load_dwordx4 a[168:171], v1, s[4:7], s33 offen offset:0 sc1
  buffer_load_dwordx4 a[172:175], v1, s[4:7], s33 offen offset:1024 sc1
reca_nopf190:
  buffer_store_dwordx2 v[52:53], v9, s[4:7], s30 offen sc1
  buffer_store_dwordx2 v[68:69], v10, s[4:7], s31 offen sc1
  buffer_store_dwordx2 v[70:71], v10, s[4:7], s31 offen offset:256 sc1
reca_b5134:
  s_barrier
  s_add_u32 s17, s17, 1
  s_branch reca_step120
reca_retry123:
  s_sub_u32 s18, s18, 1
  s_cbranch_scc1 reca_retry123_to
  buffer_load_dwordx4 v[128:131], v4, s[4:7], s20 offen sc1
  buffer_load_dwordx4 v[132:135], v4, s[4:7], s20 offen offset:1024 sc1
  buffer_load_dwordx4 v[136:139], v5, s[4:7], s20 offen sc1
  s_waitcnt vmcnt(2)
  v_max_u32 v29, v128, v130
  v_cmp_eq_u32 vcc, -1, v29
  s_cbranch_vccnz reca_retry123
  s_branch reca_resume124
reca_retry123_to:
  s_mov_b32 s18, 0
  s_waitcnt vmcnt(0)
  s_branch reca_resume124
reca_retry125:
  s_sub_u32 s18, s18, 1
  s_cbranch_scc1 reca_retry125_to
  buffer_load_dwordx4 v[132:135], v4, s[4:7], s20 offen offset:1024 sc1
  buffer_load_dwordx4 v[136:139], v5, s[4:7], s20 offen sc1
  s_waitcnt vmcnt(1)
  v_max_u32 v29, v132, v134
  v_cmp_eq_u32 vcc, -1, v29
  s_cbranch_vccnz reca_retry125
  s_branch reca_resume126
reca_retry125_to:
  s_mov_b32 s18, 0
  s_waitcnt vmcnt(0)
  s_branch reca_resume126
reca_retry127:
  s_sub_u32 s18, s18, 1
  s_cbranch_scc1 reca_retry127_to
  buffer_load_dwordx4 v[136:139], v5, s[4:7], s20 offen sc1
  s_waitcnt vmcnt(0)
  v_max_u32 v29, v136, v138
  v_cmp_eq_u32 vcc, -1, v29
  s_cbranch_vccnz reca_retry127
  s_branch reca_resume128
reca_retry127_to:
  s_mov_b32 s18, 0
  s_waitcnt vmcnt(0)
  s_branch reca_resume128
reca_retry136:
  s_sub_u32 s18, s18, 1
  s_cbranch_scc1 reca_retry136_to
  buffer_load_dwordx4 v[208:211], v1, s[4:7], s21 offen offset:0 sc1
  buffer_load_dwordx4 v[212:215], v1, s[4:7], s21 offen offset:1024 sc1
  buffer_load_dwordx4 v[216:219], v1, s[4:7], s21 offen offset:2048 sc1
  buffer_load_dwordx4 v[220:223], v1, s[4:7], s21 offen offset:3072 sc1
  buffer_load_dwordx4 v[224:227], v2, s[4:7], s21 offen offset:0 sc1
  buffer_load_dwordx4 v[228:231], v2, s[4:7], s21 offen offset:1024 sc1
  s_waitcnt vmcnt(5)
  v_max_u32 v29, v208, v210
  v_cmp_eq_u32 vcc, -1, v29
  s_cbranch_vccnz reca_retry136
  s_branch reca_resume137
reca_retry136_to:
  s_mov_b32 s18, 0
  s_waitcnt vmcnt(0)
  s_branch reca_resume137
reca_retry138:
  s_sub_u32 s18, s18, 1
  s_cbranch_scc1 reca_retry138_to
  buffer_load_dwordx4 v[212:215], v1, s[4:7], s21 offen offset:1024 sc1
  buffer_load_dwordx4 v[216:219], v1, s[4:7], s21 offen offset:2048 sc1
  buffer_load_dwordx4 v[220:223], v1, s[4:7], s21 offen offset:3072 sc1
  buffer_load_dwordx4 v[224:227], v2, s[4:7], s21 offen offset:0 sc1
  buffer_load_dwordx4 v[228:231], v2, s[4:7], s21 offen offset:1024 sc1
  s_waitcnt vmcnt(4)
  v_max_u32 v29, v212, v214
  v_cmp_eq_u32 vcc, -1, v29
  s_cbranch_vccnz reca_retry138
  s_branch reca_resume139
reca_retry138_to:
  s_mov_b32 s18, 0
  s_waitcnt vmcnt(0)
  s_branch reca_resume139
reca_retry140:
  s_sub_u32 s18, s18, 1
  s_cbranch_scc1 reca_retry140_to
  buffer_load_dwordx4 v[216:219], v1, s[4:7], s21 offen offset:2048 sc1
  buffer_load_dwordx4 v[220:223], v1, s[4:7], s21 offen offset:3072 sc1
  buffer_load_dwordx4 v[224:227], v2, s[4:7], s21 offen offset:0 sc1
  buffer_load_dwordx4 v[228:231], v2, s[4:7], s21 offen offset:1024 sc1
  s_waitcnt vmcnt(3)
  v_max_u32 v29, v216, v218
  v_cmp_eq_u32 vcc, -1, v29
  s_cbranch_vccnz reca_retry140
  s_branch reca_resume141
reca_retry140_to:
  s_mov_b32 s18, 0
  s_waitcnt vmcnt(0)
  s_branch reca_resume141
reca_retry142:
  s_sub_u32 s18, s18, 1
  s_cbranch_scc1 reca_retry142_to
  buffer_load_dwordx4 v[220:223], v1, s[4:7], s21 offen offset:3072 sc1
  buffer_load_dwordx4 v[224:227], v2, s[4:7], s21 offen offset:0 sc1
  buffer_load_dwordx4 v[228:231], v2, s[4:7], s21 offen offset:1024 sc1
  s_waitcnt vmcnt(2)
  v_max_u32 v29, v220, v222
  v_cmp_eq_u32 vcc, -1, v29
  s_cbranch_vccnz reca_retry142
  s_branch reca_resume143
reca_retry142_to:
  s_mov_b32 s18, 0
  s_waitcnt vmcnt(0)
  s_branch reca_resume143
reca_retry144:
  s_sub_u32 s18, s18, 1
  s_cbranch_scc1 reca_retry144_to
  buffer_load_dwordx4 v[224:227], v2, s[4:7], s21 offen offset:0 sc1
  buffer_load_dwordx4 v[228:231], v2, s[4:7], s21 offen offset:1024 sc1
  s_waitcnt vmcnt(1)
  v_max_u32 v29, v224, v226
  v_cmp_eq_u32 vcc, -1, v29
  s_cbranch_vccnz reca_retry144
  s_branch reca_resume145
reca_retry144_to:
  s_mov_b32 s18, 0
  s_waitcnt vmcnt(0)
  s_branch reca_resume145
reca_retry146:
  s_sub_u32 s18, s18, 1
  s_cbranch_scc1 reca_retry146_to
  buffer_load_dwordx4 v[228:231], v2, s[4:7], s21 offen offset:1024 sc1
  s_waitcnt vmcnt(0)
  v_max_u32 v29, v228, v230
  v_cmp_eq_u32 vcc, -1, v29
  s_cbranch_vccnz reca_retry146
  s_branch reca_resume147
reca_retry146_to:
  s_mov_b32 s18, 0
  s_waitcnt vmcnt(0)
  s_branch reca_resume147
reca_retry149:
  s_sub_u32 s18, s18, 1
  s_cbranch_scc1 reca_retry149_to
  buffer_load_dwordx4 v[128:131], v12, s[4:7], s22 offen offset:0 sc1
  buffer_load_dwordx4 v[132:135], v12, s[4:7], s22 offen offset:1024 sc1
  buffer_load_dwordx4 v[136:139], v12, s[4:7], s22 offen offset:2048 sc1
  buffer_load_dwordx4 v[140:143], v12, s[4:7], s22 offen offset:3072 sc1
  buffer_load_dwordx4 v[144:147], v13, s[4:7], s22 offen offset:0 sc1
  buffer_load_dwordx4 v[148:151], v13, s[4:7], s22 offen offset:1024 sc1
  buffer_load_dwordx4 v[152:155], v13, s[4:7], s22 offen offset:2048 sc1
  buffer_load_dwordx4 v[156:159], v13, s[4:7], s22 offen offset:3072 sc1
  buffer_load_dwordx4 v[160:163], v14, s[4:7], s22 offen offset:0 sc1
  buffer_load_dwordx4 v[164:167], v14, s[4:7], s22 offen offset:1024 sc1
  buffer_load_dwordx4 v[168:171], v14, s[4:7], s22 offen offset:2048 sc1
  buffer_load_dwordx4 v[172:175], v14, s[4:7], s22 offen offset:3072 sc1
  s_waitcnt vmcnt(11)
  v_cmp_eq_u32 vcc, -1, v128
  s_cbranch_vccnz reca_retry149
  s_branch reca_resume150
reca_retry149_to:
  s_mov_b32 s18, 0
  s_waitcnt vmcnt(0)
  s_branch reca_resume150
reca_retry151:
  s_sub_u32 s18, s18, 1
  s_cbranch_scc1 reca_retry151_to
  buffer_load_dwordx4 v[132:135], v12, s[4:7], s22 offen offset:1024 sc1
  buffer_load_dwordx4 v[136:139], v12, s[4:7], s22 offen offset:2048 sc1
  buffer_load_dwordx4 v[140:143], v12, s[4:7], s22 offen offset:3072 sc1
  buffer_load_dwordx4 v[144:147], v13, s[4:7], s22 offen offset:0 sc1
  buffer_load_dwordx4 v[148:151], v13, s[4:7], s22 offen offset:1024 sc1
  buffer_load_dwordx4 v[152:155], v13, s[4:7], s22 offen offset:2048 sc1
  buffer_load_dwordx4 v[156:159], v13, s[4:7], s22 offen offset:3072 sc1
  buffer_load_dwordx4 v[160:163], v14, s[4:7], s22 offen offset:0 sc1
  buffer_load_dwordx4 v[164:167], v14, s[4:7], s22 offen offset:1024 sc1
  buffer_load_dwordx4 v[168:171], v14, s[4:7], s22 offen offset:2048 sc1
  buffer_load_dwordx4 v[172:175], v14, s[4:7], s22 offen offset:3072 sc1
  s_waitcnt vmcnt(10)
  v_cmp_eq_u32 vcc, -1, v132
  s_cbranch_vccnz reca_retry151
  s_branch reca_resume152
reca_retry151_to:
  s_mov_b32 s18, 0
  s_waitcnt vmcnt(0)
  s_branch reca_resume152
reca_retry153:
  s_sub_u32 s18, s18, 1
  s_cbranch_scc1 reca_retry153_to
  buffer_load_dwordx4 v[136:139], v12, s[4:7], s22 offen offset:2048 sc1
  buffer_load_dwordx4 v[140:143], v12, s[4:7], s22 offen offset:3072 sc1
  buffer_load_dwordx4 v[144:147], v13, s[4:7], s22 offen offset:0 sc1
  buffer_load_dwordx4 v[148:151], v13, s[4:7], s22 offen offset:1024 sc1
  buffer_load_dwordx4 v[152:155], v13, s[4:7], s22 offen offset:2048 sc1
  buffer_load_dwordx4 v[156:159], v13, s[4:7], s22 offen offset:3072 sc1
  buffer_load_dwordx4 v[160:163], v14, s[4:7], s22 offen offset:0 sc1
  buffer_load_dwordx4 v[164:167], v14, s[4:7], s22 offen offset:1024 sc1
  buffer_load_dwordx4 v[168:171], v14, s[4:7], s22 offen offset:2048 sc1
  buffer_load_dwordx4 v[172:175], v14, s[4:7], s22 offen offset:3072 sc1
  s_waitcnt vmcnt(9)
  v_cmp_eq_u32 vcc, -1, v136
  s_cbranch_vccnz reca_retry153
  s_branch reca_resume154
reca_retry153_to:
  s_mov_b32 s18, 0
  s_waitcnt vmcnt(0)
  s_branch reca_resume154
reca_retry155:
  s_sub_u32 s18, s18, 1
  s_cbranch_scc1 reca_retry155_to
  buffer_load_dwordx4 v[140:143], v12, s[4:7], s22 offen offset:3072 sc1
  buffer_load_dwordx4 v[144:147], v13, s[4:7], s22 offen offset:0 sc1
  buffer_load_dwordx4 v[148:151], v13, s[4:7], s22 offen offset:1024 sc1
  buffer_load_dwordx4 v[152:155], v13, s[4:7], s22 offen offset:2048 sc1
  buffer_load_dwordx4 v[156:159], v13, s[4:7], s22 offen offset:3072 sc1
  buffer_load_dwordx4 v[160:163], v14, s[4:7], s22 offen offset:0 sc1
  buffer_load_dwordx4 v[164:167], v14, s[4:7], s22 offen offset:1024 sc1
  buffer_load_dwordx4 v[168:171], v14, s[4:7], s22 offen offset:2048 sc1
  buffer_load_dwordx4 v[172:175], v14, s[4:7], s22 offen offset:3072 sc1
  s_waitcnt vmcnt(8)
  v_cmp_eq_u32 vcc, -1, v140
  s_cbranch_vccnz reca_retry155
  s_branch reca_resume156
reca_retry155_to:
  s_mov_b32 s18, 0
  s_waitcnt vmcnt(0)
  s_branch reca_resume156
reca_retry157:
  s_sub_u32 s18, s18, 1
  s_cbranch_scc1 reca_retry157_to
  buffer_load_dwordx4 v[144:147], v13, s[4:7], s22 offen offset:0 sc1
  buffer_load_dwordx4 v[148:151], v13, s[4:7], s22 offen offset:1024 sc1
  buffer_load_dwordx4 v[152:155], v13, s[4:7], s22 offen offset:2048 sc1
  buffer_load_dwordx4 v[156:159], v13, s[4:7], s22 offen offset:3072 sc1
  buffer_load_dwordx4 v[160:163], v14, s[4:7], s22 offen offset:0 sc1
  buffer_load_dwordx4 v[164:167], v14, s[4:7], s22 offen offset:1024 sc1
  buffer_load_dwordx4 v[168:171], v14, s[4:7], s22 offen offset:2048 sc1
  buffer_load_dwordx4 v[172:175], v14, s[4:7], s22 offen offset:3072 sc1
  s_waitcnt vmcnt(7)
  v_cmp_eq_u32 vcc, -1, v144
  s_cbranch_vccnz reca_retry157
  s_branch reca_resume158
reca_retry157_to:
  s_mov_b32 s18, 0
  s_waitcnt vmcnt(0)
  s_branch reca_resume158
reca_retry159:
  s_sub_u32 s18, s18, 1
  s_cbranch_scc1 reca_retry159_to
  buffer_load_dwordx4 v[148:151], v13, s[4:7], s22 offen offset:1024 sc1
  buffer_load_dwordx4 v[152:155], v13, s[4:7], s22 offen offset:2048 sc1
  buffer_load_dwordx4 v[156:159], v13, s[4:7], s22 offen offset:3072 sc1
  buffer_load_dwordx4 v[160:163], v14, s[4:7], s22 offen offset:0 sc1
  buffer_load_dwordx4 v[164:167], v14, s[4:7], s22 offen offset:1024 sc1
  buffer_load_dwordx4 v[168:171], v14, s[4:7], s22 offen offset:2048 sc1
  buffer_load_dwordx4 v[172:175], v14, s[4:7], s22 offen offset:3072 sc1
  s_waitcnt vmcnt(6)
  v_cmp_eq_u32 vcc, -1, v148
  s_cbranch_vccnz reca_retry159
  s_branch reca_resume160
reca_retry159_to:
  s_mov_b32 s18, 0
  s_waitcnt vmcnt(0)
  s_branch reca_resume160
reca_retry161:
  s_sub_u32 s18, s18, 1
  s_cbranch_scc1 reca_retry161_to
  buffer_load_dwordx4 v[152:155], v13, s[4:7], s22 offen offset:2048 sc1
  buffer_load_dwordx4 v[156:159], v13, s[4:7], s22 offen offset:3072 sc1
  buffer_load_dwordx4 v[160:163], v14, s[4:7], s22 offen offset:0 sc1
  buffer_load_dwordx4 v[164:167], v14, s[4:7], s22 offen offset:1024 sc1
  buffer_load_dwordx4 v[168:171], v14, s[4:7], s22 offen offset:2048 sc1
  buffer_load_dwordx4 v[172:175], v14, s[4:7], s22 offen offset:3072 sc1
  s_waitcnt vmcnt(5)
  v_cmp_eq_u32 vcc, -1, v152
  s_cbranch_vccnz reca_retry161
  s_branch reca_resume162
reca_retry161_to:
  s_mov_b32 s18, 0
  s_waitcnt vmcnt(0)
  s_branch reca_resume162
reca_retry163:
  s_sub_u32 s18, s18, 1
  s_cbranch_scc1 reca_retry163_to
  buffer_load_dwordx4 v[156:159], v13, s[4:7], s22 offen offset:3072 sc1
  buffer_load_dwordx4 v[160:163], v14, s[4:7], s22 offen offset:0 sc1
  buffer_load_dwordx4 v[164:167], v14, s[4:7], s22 offen offset:1024 sc1
  buffer_load_dwordx4 v[168:171], v14, s[4:7], s22 offen offset:2048 sc1
  buffer_load_dwordx4 v[172:175], v14, s[4:7], s22 offen offset:3072 sc1
  s_waitcnt vmcnt(4)
  v_cmp_eq_u32 vcc, -1, v156
  s_cbranch_vccnz reca_retry163
  s_branch reca_resume164
reca_retry163_to:
  s_mov_b32 s18, 0
  s_waitcnt vmcnt(0)
  s_branch reca_resume164
reca_retry165:
  s_sub_u32 s18, s18, 1
  s_cbranch_scc1 reca_retry165_to
  buffer_load_dwordx4 v[160:163], v14, s[4:7], s22 offen offset:0 sc1
  buffer_load_dwordx4 v[164:167], v14, s[4:7], s22 offen offset:1024 sc1
  buffer_load_dwordx4 v[168:171], v14, s[4:7], s22 offen offset:2048 sc1
  buffer_load_dwordx4 v[172:175], v14, s[4:7], s22 offen offset:3072 sc1
  s_waitcnt vmcnt(3)
  v_cmp_eq_u32 vcc, -1, v160
  s_cbranch_vccnz reca_retry165
  s_branch reca_resume166
reca_retry165_to:
  s_mov_b32 s18, 0
  s_waitcnt vmcnt(0)
  s_branch reca_resume166
reca_retry167:
  s_sub_u32 s18, s18, 1
  s_cbranch_scc1 reca_retry167_to
  buffer_load_dwordx4 v[164:167], v14, s[4:7], s22 offen offset:1024 sc1
  buffer_load_dwordx4 v[168:171], v14, s[4:7], s22 offen offset:2048 sc1
  buffer_load_dwordx4 v[172:175], v14, s[4:7], s22 offen offset:3072 sc1
  s_waitcnt vmcnt(2)
  v_cmp_eq_u32 vcc, -1, v164
  s_cbranch_vccnz reca_retry167
  s_branch reca_resume168
reca_retry167_to:
  s_mov_b32 s18, 0
  s_waitcnt vmcnt(0)
  s_branch reca_resume168
reca_retry169:
  s_sub_u32 s18, s18, 1
  s_cbranch_scc1 reca_retry169_to
  buffer_load_dwordx4 v[168:171], v14, s[4:7], s22 offen offset:2048 sc1
  buffer_load_dwordx4 v[172:175], v14, s[4:7], s22 offen offset:3072 sc1
  s_waitcnt vmcnt(1)
  v_cmp_eq_u32 vcc, -1, v168
  s_cbranch_vccnz reca_retry169
  s_branch reca_resume170
reca_retry169_to:
  s_mov_b32 s18, 0
  s_waitcnt vmcnt(0)
  s_branch reca_resume170
reca_retry171:
  s_sub_u32 s18, s18, 1
  s_cbranch_scc1 reca_retry171_to
  buffer_load_dwordx4 v[172:175], v14, s[4:7], s22 offen offset:3072 sc1
  s_waitcnt vmcnt(0)
  v_cmp_eq_u32 vcc, -1, v172
  s_cbranch_vccnz reca_retry171
  s_branch reca_resume172
reca_retry171_to:
  s_mov_b32 s18, 0
  s_waitcnt vmcnt(0)
  s_branch reca_resume172
reca_retry174:
  s_sub_u32 s18, s18, 1
  s_cbranch_scc1 reca_retry174_to
  buffer_load_dwordx4 v[128:131], v20, s[4:7], s25 offen sc1
  buffer_load_dwordx4 v[132:135], v21, s[4:7], s25 offen sc1
  buffer_load_dwordx4 v[136:139], v22, s[4:7], s25 offen sc1
  buffer_load_dwordx4 v[140:143], v23, s[4:7], s25 offen sc1
  buffer_load_dwordx4 v[144:147], v24, s[4:7], s25 offen sc1
  buffer_load_dwordx4 v[148:151], v25, s[4:7], s25 offen sc1
  buffer_load_dwordx4 v[152:155], v26, s[4:7], s25 offen sc1
  buffer_load_dwordx4 v[156:159], v27, s[4:7], s25 offen sc1
  s_waitcnt vmcnt(7)
  v_cmp_eq_u32 vcc, -1, v128
  s_cbranch_vccnz reca_retry174
  s_branch reca_resume175
reca_retry174_to:
  s_mov_b32 s18, 0
  s_waitcnt vmcnt(0)
  s_branch reca_resume175
reca_retry176:
  s_sub_u32 s18, s18, 1
  s_cbranch_scc1 reca_retry176_to
  buffer_load_dwordx4 v[132:135], v21, s[4:7], s25 offen sc1
  buffer_load_dwordx4 v[136:139], v22, s[4:7], s25 offen sc1
  buffer_load_dwordx4 v[140:143], v23, s[4:7], s25 offen sc1
  buffer_load_dwordx4 v[144:147], v24, s[4:7], s25 offen sc1
  buffer_load_dwordx4 v[148:151], v25, s[4:7], s25 offen sc1
  buffer_load_dwordx4 v[152:155], v26, s[4:7], s25 offen sc1
  buffer_load_dwordx4 v[156:159], v27, s[4:7], s25 offen sc1
  s_waitcnt vmcnt(6)
  v_cmp_eq_u32 vcc, -1, v132
  s_cbranch_vccnz reca_retry176
  s_branch reca_resume177
reca_retry176_to:
  s_mov_b32 s18, 0
  s_waitcnt vmcnt(0)
  s_branch reca_resume177
reca_retry178:
  s_sub_u32 s18, s18, 1
  s_cbranch_scc1 reca_retry178_to
  buffer_load_dwordx4 v[136:139], v22, s[4:7], s25 offen sc1
  buffer_load_dwordx4 v[140:143], v23, s[4:7], s25 offen sc1
  buffer_load_dwordx4 v[144:147], v24, s[4:7], s25 offen sc1
  buffer_load_dwordx4 v[148:151], v25, s[4:7], s25 offen sc1
  buffer_load_dwordx4 v[152:155], v26, s[4:7], s25 offen sc1
  buffer_load_dwordx4 v[156:159], v27, s[4:7], s25 offen sc1
  s_waitcnt vmcnt(5)
  v_cmp_eq_u32 vcc, -1, v136
  s_cbranch_vccnz reca_retry178
  s_branch reca_resume179
reca_retry178_to:
  s_mov_b32 s18, 0
  s_waitcnt vmcnt(0)
  s_branch reca_resume179
reca_retry180:
  s_sub_u32 s18, s18, 1
  s_cbranch_scc1 reca_retry180_to
  buffer_load_dwordx4 v[140:143], v23, s[4:7], s25 offen sc1
  buffer_load_dwordx4 v[144:147], v24, s[4:7], s25 offen sc1
  buffer_load_dwordx4 v[148:151], v25, s[4:7], s25 offen sc1
  buffer_load_dwordx4 v[152:155], v26, s[4:7], s25 offen sc1
  buffer_load_dwordx4 v[156:159], v27, s[4:7], s25 offen sc1
  s_waitcnt vmcnt(4)
  v_cmp_eq_u32 vcc, -1, v140
  s_cbranch_vccnz reca_retry180
  s_branch reca_resume181
reca_retry180_to:
  s_mov_b32 s18, 0
  s_waitcnt vmcnt(0)
  s_branch reca_resume181
reca_retry182:
  s_sub_u32 s18, s18, 1
  s_cbranch_scc1 reca_retry182_to
  buffer_load_dwordx4 v[144:147], v24, s[4:7], s25 offen sc1
  buffer_load_dwordx4 v[148:151], v25, s[4:7], s25 offen sc1
  buffer_load_dwordx4 v[152:155], v26, s[4:7], s25 offen sc1
  buffer_load_dwordx4 v[156:159], v27, s[4:7], s25 offen sc1
  s_waitcnt vmcnt(3)
  v_cmp_eq_u32 vcc, -1, v144
  s_cbranch_vccnz reca_retry182
  s_branch reca_resume183
reca_retry182_to:
  s_mov_b32 s18, 0
  s_waitcnt vmcnt(0)
  s_branch reca_resume183
reca_retry184:
  s_sub_u32 s18, s18, 1
  s_cbranch_scc1 reca_retry184_to
  buffer_load_dwordx4 v[148:151], v25, s[4:7], s25 offen sc1
  buffer_load_dwordx4 v[152:155], v26, s[4:7], s25 offen sc1
  buffer_load_dwordx4 v[156:159], v27, s[4:7], s25 offen sc1
  s_waitcnt vmcnt(2)
  v_cmp_eq_u32 vcc, -1, v148
  s_cbranch_vccnz reca_retry184
  s_branch reca_resume185
reca_retry184_to:
  s_mov_b32 s18, 0
  s_waitcnt vmcnt(0)
  s_branch reca_resume185
reca_retry186:
  s_sub_u32 s18, s18, 1
  s_cbranch_scc1 reca_retry186_to
  buffer_load_dwordx4 v[152:155], v26, s[4:7], s25 offen sc1
  buffer_load_dwordx4 v[156:159], v27, s[4:7], s25 offen sc1
  s_waitcnt vmcnt(1)
  v_cmp_eq_u32 vcc, -1, v152
  s_cbranch_vccnz reca_retry186
  s_branch reca_resume187
reca_retry186_to:
  s_mov_b32 s18, 0
  s_waitcnt vmcnt(0)
  s_branch reca_resume187
reca_retry188:
  s_sub_u32 s18, s18, 1
  s_cbranch_scc1 reca_retry188_to
  buffer_load_dwordx4 v[156:159], v27, s[4:7], s25 offen sc1
  s_waitcnt vmcnt(0)
  v_cmp_eq_u32 vcc, -1, v156
  s_cbranch_vccnz reca_retry188
  s_branch reca_resume189
reca_retry188_to:
  s_mov_b32 s18, 0
  s_waitcnt vmcnt(0)
  s_branch reca_resume189
reca_twins13:
  s_branch reca_gotmem194
reca_step193:
  s_and_b32 s34, s17, 3
  s_mul_i32 s20, s34, 10240
  s_add_u32 s20, s20, s38
  s_sleep 5
  buffer_load_dwordx4 v[128:131], v4, s[4:7], s20 offen sc1
  buffer_load_dwordx4 v[132:135], v4, s[4:7], s20 offen offset:1024 sc1
  buffer_load_dwordx4 v[136:139], v5, s[4:7], s20 offen sc1
  s_waitcnt vmcnt(2)
  v_max_u32 v29, v128, v130
  v_cmp_eq_u32 vcc, -1, v29
  s_cbranch_vccnz reca_retry196
reca_resume197:
  s_waitcnt vmcnt(1)
  v_max_u32 v29, v132, v134
  v_cmp_eq_u32 vcc, -1, v29
  ds_write_b128 v4, v[128:131]
  s_cbranch_vccnz reca_retry198
reca_resume199:
  s_waitcnt vmcnt(0)
  v_max_u32 v29, v136, v138
  v_cmp_eq_u32 vcc, -1, v29
  ds_write_b128 v4, v[132:135] offset:1024
  s_cbranch_vccnz reca_retry200
reca_resume201:
  ds_write_b128 v5, v[136:139]
  s_branch reca_gotmem2195
reca_gotmem194:
  ds_write_b128 v4, v[128:131]
  ds_write_b128 v4, v[132:135] offset:1024
  ds_write_b128 v5, v[136:139]
reca_gotmem2195:
  s_and_b32 s34, s17, 3
  s_mul_i32 s21, s34, 6144
  s_add_u32 s21, s21, s39
  s_mul_i32 s22, s34, 12288
  s_add_u32 s22, s22, s40
  s_mul_i32 s25, s34, 393216
  s_add_u32 s25, s25, s56
  s_add_u32 s35, s17, 1
  s_and_b32 s35, s35, 3
  s_mul_i32 s24, s35, 10240
  s_add_u32 s24, s24, s38
  s_waitcnt lgkmcnt(0)
  s_barrier
  ds_read_b128 v[128:131], v236 offset:0
  ds_read_b128 v[132:135], v236 offset:1024
  ds_read_b128 v[136:139], v236 offset:2048
  ds_read_b128 v[140:143], v236 offset:3072
  ds_read_b128 v[144:147], v236 offset:4096
  ds_read_b128 v[148:151], v237 offset:0
  ds_read_b128 v[152:155], v237 offset:1024
  ds_read_b128 v[156:159], v237 offset:2048
  ds_read_b128 v[160:163], v237 offset:3072
  ds_read_b128 v[164:167], v237 offset:4096
  s_waitcnt lgkmcnt(9)
  v_mfma_f32_16x16x32_bf16 v[44:47], a[0:3], v[128:131], 0
  ds_read_b128 v[168:171], v6 offset:0
  v_mfma_f32_16x16x32_bf16 v[240:243], a[4:7], v[128:131], 0
  s_waitcnt lgkmcnt(9)
  v_mfma_f32_16x16x32_bf16 v[44:47], a[8:11], v[132:135], v[44:47]
  ds_read_b128 v[172:175], v6 offset:512
  v_mfma_f32_16x16x32_bf16 v[240:243], a[12:15], v[132:135], v[240:243]
  s_waitcnt lgkmcnt(9)
  v_mfma_f32_16x16x32_bf16 v[44:47], a[16:19], v[136:139], v[44:47]
  ds_read_b128 v[176:179], v6 offset:1024
  v_mfma_f32_16x16x32_bf16 v[240:243], a[20:23], v[136:139], v[240:243]
  s_waitcnt lgkmcnt(9)
  v_mfma_f32_16x16x32_bf16 v[44:47], a[24:27], v[140:143], v[44:47]
  ds_read_b128 v[180:183], v6 offset:1536
  v_mfma_f32_16x16x32_bf16 v[240:243], a[28:31], v[140:143], v[240:243]
  s_waitcnt lgkmcnt(9)
  v_mfma_f32_16x16x32_bf16 v[44:47], a[32:35], v[144:147], v[44:47]
  ds_read_b128 v[184:187], v6 offset:2048
  v_mfma_f32_16x16x32_bf16 v[240:243], a[36:39], v[144:147], v[240:243]
  s_waitcnt lgkmcnt(9)
  v_mfma_f32_16x16x32_bf16 v[44:47], a[40:43], v[148:151], v[44:47]
  ds_read_b128 v[188:191], v6 offset:2560
  v_mfma_f32_16x16x32_bf16 v[240:243], a[44:47], v[148:151], v[240:243]
  s_waitcnt lgkmcnt(9)
  v_mfma_f32_16x16x32_bf16 v[44:47], a[48:51], v[152:155], v[44:47]
  ds_read_b128 v[192:195], v6 offset:3072
  v_mfma_f32_16x16x32_bf16 v[240:243], a[52:55], v[152:155], v[240:243]
  s_waitcnt lgkmcnt(9)
  v_mfma_f32_16x16x32_bf16 v[44:47], a[56:59], v[156:159], v[44:47]
  ds_read_b128 v[196:199], v6 offset:3584
  v_mfma_f32_16x16x32_bf16 v[240:243], a[60:63], v[156:159], v[240:243]
  s_waitcnt lgkmcnt(9)
  v_mfma_f32_16x16x32_bf16 v[44:47], a[64:67], v[160:163], v[44:47]
  ds_read_b128 v[200:203], v6 offset:4096
  v_mfma_f32_16x16x32_bf16 v[240:243], a[68:71], v[160:163], v[240:243]
  s_waitcnt lgkmcnt(9)
  v_mfma_f32_16x16x32_bf16 v[44:47], a[72:75], v[164:167], v[44:47]
  ds_read_b128 v[204:207], v6 offset:4608
  v_mfma_f32_16x16x32_bf16 v[240:243], a[76:79], v[164:167], v[240:243]
  s_waitcnt lgkmcnt(9)
  v_mfma_f32_16x16x32_bf16 v[48:51], v[168:171], a[80:83], 0
  s_and_b32 s34, s17, 7
  s_lshl_b32 s34, s34, 5
  s_add_u32 s34, s34, s15
  s_mul_i32 s34, s34, 3072
  s_lshl_b32 s35, s16, 9
  s_add_u32 s34, s34, s35
  s_add_u32 s30, s34, 47185920
  s_add_u32 s31, s34, 47972352
  v_add_f32_dpp v44, v240, v44 row_ror:8 row_mask:0xf bank_mask:0xf
  v_add_f32_dpp v45, v241, v45 row_ror:8 row_mask:0xf bank_mask:0xf
  v_add_f32_dpp v46, v242, v46 row_ror:8 row_mask:0xf bank_mask:0xf
  v_add_f32_dpp v47, v243, v47 row_ror:8 row_mask:0xf bank_mask:0xf
  v_cvt_pk_bf16_f32 v52, v44, v45
  v_cvt_pk_bf16_f32 v53, v46, v47
  buffer_store_dwordx2 v[52:53], v8, s[4:7], s21 offen sc1
  s_waitcnt lgkmcnt(8)
  v_mfma_f32_16x16x32_bf16 v[48:51], v[172:175], a[84:87], v[48:51]
  s_waitcnt lgkmcnt(7)
  v_mfma_f32_16x16x32_bf16 v[48:51], v[176:179], a[88:91], v[48:51]
  s_waitcnt lgkmcnt(6)
  v_mfma_f32_16x16x32_bf16 v[48:51], v[180:183], a[92:95], v[48:51]
  s_waitcnt lgkmcnt(5)
  v_mfma_f32_16x16x32_bf16 v[48:51], v[184:187], a[96:99], v[48:51]
  s_waitcnt lgkmcnt(4)
  v_mfma_f32_16x16x32_bf16 v[48:51], v[188:191], a[100:103], v[48:51]
  s_waitcnt lgkmcnt(3)
  v_mfma_f32_16x16x32_bf16 v[48:51], v[192:195], a[104:107], v[48:51]
  s_waitcnt lgkmcnt(2)
  v_mfma_f32_16x16x32_bf16 v[48:51], v[196:199], a[108:111], v[48:51]
  s_waitcnt lgkmcnt(1)
  v_mfma_f32_16x16x32_bf16 v[48:51], v[200:203], a[112:115], v[48:51]
  s_waitcnt lgkmcnt(0)
  v_mfma_f32_16x16x32_bf16 v[48:51], v[204:207], a[116:119], v[48:51]
  s_cmp_eq_u32 s12, 3
  s_cbranch_scc1 reca_swave202
  s_nop 5
  ds_write_b128 v17, v[48:51]
  s_add_u32 s34, s17, 2
  s_and_b32 s34, s34, 3
  s_mul_i32 s26, s34, 10240
  s_add_u32 s26, s26, s38
  s_mul_i32 s27, s34, 6144
  s_add_u32 s27, s27, s39
  s_mul_i32 s28, s34, 12288
  s_add_u32 s28, s28, s40
  s_mul_i32 s29, s34, 393216
  s_add_u32 s29, s29, s56
  s_waitcnt lgkmcnt(0)
  s_barrier
  s_cmp_eq_u32 s17, 63
  s_cbranch_scc1 reca_last204
  buffer_store_dwordx2 v[32:33], v8, s[4:7], s27 offen sc1
  s_cmp_lg_u32 s12, 2
  s_cbranch_scc1 reca_tw1208_n
  buffer_store_dwordx2 v[52:53], v9, s[4:7], s30 offen sc1
reca_tw1208_n:
  s_barrier
  s_cmp_eq_u32 s12, 1
  s_cbranch_scc1 reca_tw1208
  s_cmp_eq_u32 s12, 2
  s_cbranch_scc1 reca_tw2209
  s_cmp_lt_u32 s17, 2
  s_cbranch_scc1 reca_b5207
  s_cmp_gt_u32 s17, 61
  s_cbranch_scc1 reca_b5207
  s_sub_u32 s36, s17, 2
  s_and_b32 s36, s36, 7
  s_lshl_b32 s34, s59, 3
  s_add_u32 s34, s34, s36
  s_mul_i32 s34, s34, 12288
  s_add_u32 s23, s34, 37748736
  s_add_u32 s60, s34, 44040192
  s_lshl_b32 s35, s36, 5
  s_add_u32 s35, s35, s59
  s_mul_i32 s35, s35, 3072
  s_add_u32 s61, s35, 47185920
  buffer_load_dwordx4 a[120:123], v1, s[4:7], s23 offen offset:0 sc1
  buffer_load_dwordx4 a[124:127], v1, s[4:7], s23 offen offset:1024 sc1
  buffer_load_dwordx4 a[128:131], v1, s[4:7], s23 offen offset:2048 sc1
  buffer_load_dwordx4 a[132:135], v1, s[4:7], s23 offen offset:3072 sc1
  buffer_load_dwordx4 a[136:139], v2, s[4:7], s23 offen offset:0 sc1
  buffer_load_dwordx4 a[140:143], v2, s[4:7], s23 offen offset:1024 sc1
  buffer_load_dwordx4 a[144:147], v2, s[4:7], s23 offen offset:2048 sc1
  buffer_load_dwordx4 a[148:151], v2, s[4:7], s23 offen offset:3072 sc1
  buffer_load_dwordx4 a[152:155], v3, s[4:7], s23 offen offset:0 sc1
  buffer_load_dwordx4 a[156:159], v3, s[4:7], s23 offen offset:1024 sc1
  buffer_load_dwordx4 a[160:163], v3, s[4:7], s23 offen offset:2048 sc1
  buffer_load_dwordx4 a[164:167], v3, s[4:7], s23 offen offset:3072 sc1
  buffer_load_dwordx4 a[216:219], v92, s[4:7], s61 offen offset:0 sc1
  buffer_load_dwordx4 a[220:223], v92, s[4:7], s61 offen offset:512 sc1
  buffer_load_dwordx4 a[224:227], v92, s[4:7], s61 offen offset:1024 sc1
  buffer_load_dwordx4 a[228:231], v92, s[4:7], s61 offen offset:1536 sc1
  buffer_load_dwordx4 a[232:235], v92, s[4:7], s61 offen offset:2048 sc1
  buffer_load_dwordx4 a[236:239], v92, s[4:7], s61 offen offset:2560 sc1
  buffer_load_dwordx4 a[168:171], v1, s[4:7], s60 offen offset:0 sc1
  buffer_load_dwordx4 a[172:175], v1, s[4:7], s60 offen offset:1024 sc1
  buffer_load_dwordx4 a[176:179], v1, s[4:7], s60 offen offset:2048 sc1
  buffer_load_dwordx4 a[180:183], v1, s[4:7], s60 offen offset:3072 sc1
  buffer_load_dwordx4 a[184:187], v2, s[4:7], s60 offen offset:0 sc1
  buffer_load_dwordx4 a[188:191], v2, s[4:7], s60 offen offset:1024 sc1
  buffer_load_dwordx4 a[192:195], v2, s[4:7], s60 offen offset:2048 sc1
  buffer_load_dwordx4 a[196:199], v2, s[4:7], s60 offen offset:3072 sc1
  buffer_load_dwordx4 a[200:203], v3, s[4:7], s60 offen offset:0 sc1
  buffer_load_dwordx4 a[204:207], v3, s[4:7], s60 offen offset:1024 sc1
  buffer_load_dwordx4 a[208:211], v3, s[4:7], s60 offen offset:2048 sc1
  buffer_load_dwordx4 a[212:215], v3, s[4:7], s60 offen offset:3072 sc1
  s_waitcnt vmcnt(5)
  v_mfma_f32_16x16x32_bf16 v[128:131], a[216:219], a[168:171], v[84:87]
  v_mfma_f32_16x16x32_bf16 v[132:135], a[120:123], a[168:171], v[88:91]
  v_mfma_f32_16x16x32_bf16 v[136:139], a[216:219], a[192:195], v[84:87]
  v_mfma_f32_16x16x32_bf16 v[140:143], a[120:123], a[192:195], 0
  v_mfma_f32_16x16x32_bf16 v[144:147], a[144:147], a[192:195], v[88:91]
  s_waitcnt vmcnt(4)
  v_mfma_f32_16x16x32_bf16 v[128:131], a[220:223], a[172:175], v[128:131]
  v_mfma_f32_16x16x32_bf16 v[132:135], a[124:127], a[172:175], v[132:135]
  v_mfma_f32_16x16x32_bf16 v[136:139], a[220:223], a[196:199], v[136:139]
  v_mfma_f32_16x16x32_bf16 v[140:143], a[124:127], a[196:199], v[140:143]
  v_mfma_f32_16x16x32_bf16 v[144:147], a[148:151], a[196:199], v[144:147]
  s_waitcnt vmcnt(3)
  v_mfma_f32_16x16x32_bf16 v[128:131], a[224:227], a[176:179], v[128:131]
  v_mfma_f32_16x16x32_bf16 v[132:135], a[128:131], a[176:179], v[132:135]
  v_mfma_f32_16x16x32_bf16 v[136:139], a[224:227], a[200:203], v[136:139]
  v_mfma_f32_16x16x32_bf16 v[140:143], a[128:131], a[200:203], v[140:143]
  v_mfma_f32_16x16x32_bf16 v[144:147], a[152:155], a[200:203], v[144:147]
  s_waitcnt vmcnt(2)
  v_mfma_f32_16x16x32_bf16 v[128:131], a[228:231], a[180:183], v[128:131]
  v_mfma_f32_16x16x32_bf16 v[132:135], a[132:135], a[180:183], v[132:135]
  v_mfma_f32_16x16x32_bf16 v[136:139], a[228:231], a[204:207], v[136:139]
  v_mfma_f32_16x16x32_bf16 v[140:143], a[132:135], a[204:207], v[140:143]
  v_mfma_f32_16x16x32_bf16 v[144:147], a[156:159], a[204:207], v[144:147]
  s_waitcnt vmcnt(1)
  v_mfma_f32_16x16x32_bf16 v[128:131], a[232:235], a[184:187], v[128:131]
  v_mfma_f32_16x16x32_bf16 v[132:135], a[136:139], a[184:187], v[132:135]
  v_mfma_f32_16x16x32_bf16 v[136:139], a[232:235], a[208:211], v[136:139]
  v_mfma_f32_16x16x32_bf16 v[140:143], a[136:139], a[208:211], v[140:143]
  v_mfma_f32_16x16x32_bf16 v[144:147], a[160:163], a[208:211], v[144:147]
  s_waitcnt vmcnt(0)
  v_mfma_f32_16x16x32_bf16 v[128:131], a[236:239], a[188:191], v[128:131]
  v_mfma_f32_16x16x32_bf16 v[132:135], a[140:143], a[188:191], v[132:135]
  v_mfma_f32_16x16x32_bf16 v[136:139], a[236:239], a[212:215], v[136:139]
  v_mfma_f32_16x16x32_bf16 v[140:143], a[140:143], a[212:215], v[140:143]
  v_mfma_f32_16x16x32_bf16 v[144:147], a[164:167], a[212:215], v[144:147]
  s_nop 3
  v_max3_f32 v28, v128, v129, v130
  v_max3_f32 v28, v28, v131, v132
  v_max3_f32 v28, v28, v133, v134
  v_max_f32 v28, v28, v135
  v_mov_b32 v29, v28
  s_nop 1
  v_permlane32_swap_b32 v28, v29
  v_max_f32 v28, v28, v29
  v_mov_b32 v29, v28
  s_nop 1
  v_permlane16_swap_b32 v28, v29
  v_max_f32 v28, v28, v29
  v_mul_f32 v28, s41, v28
  v_fma_f32 v128, v128, s41, -v28
  v_fma_f32 v129, v129, s41, -v28
  v_fma_f32 v130, v130, s41, -v28
  v_fma_f32 v131, v131, s41, -v28
  v_fma_f32 v132, v132, s41, -v28
  v_fma_f32 v133, v133, s41, -v28
  v_fma_f32 v134, v134, s41, -v28
  v_fma_f32 v135, v135, s41, -v28
  v_exp_f32 v128, v128
  v_exp_f32 v129, v129
  v_exp_f32 v130, v130
  v_exp_f32 v131, v131
  v_exp_f32 v132, v132
  v_exp_f32 v133, v133
  v_exp_f32 v134, v134
  v_exp_f32 v135, v135
  v_max3_f32 v30, v136, v137, v138
  v_max3_f32 v30, v30, v139, v140
  v_max3_f32 v30, v30, v141, v142
  v_max3_f32 v30, v30, v143, v144
  v_max3_f32 v30, v30, v145, v146
  v_max_f32 v30, v30, v147
  v_mov_b32 v29, v30
  s_nop 1
  v_permlane32_swap_b32 v30, v29
  v_max_f32 v30, v30, v29
  v_mov_b32 v29, v30
  s_nop 1
  v_permlane16_swap_b32 v30, v29
  v_max_f32 v30, v30, v29
  v_mul_f32 v30, s41, v30
  v_fma_f32 v136, v136, s41, -v30
  v_fma_f32 v137, v137, s41, -v30
  v_fma_f32 v138, v138, s41, -v30
  v_fma_f32 v139, v139, s41, -v30
  v_fma_f32 v140, v140, s41, -v30
  v_fma_f32 v141, v141, s41, -v30
  v_fma_f32 v142, v142, s41, -v30
  v_fma_f32 v143, v143, s41, -v30
  v_fma_f32 v144, v144, s41, -v30
  v_fma_f32 v145, v145, s41, -v30
  v_fma_f32 v146, v146, s41, -v30
  v_fma_f32 v147, v147, s41, -v30
  v_exp_f32 v136, v136
  v_exp_f32 v137, v137
  v_exp_f32 v138, v138
  v_exp_f32 v139, v139
  v_exp_f32 v140, v140
  v_exp_f32 v141, v141
  v_exp_f32 v142, v142
  v_exp_f32 v143, v143
  v_exp_f32 v144, v144
  v_exp_f32 v145, v145
  v_exp_f32 v146, v146
  v_exp_f32 v147, v147
  v_cvt_pk_bf16_f32 v72, v128, v129
  v_cvt_pk_bf16_f32 v73, v130, v131
  v_cvt_pk_bf16_f32 v74, v132, v133
  v_cvt_pk_bf16_f32 v75, v134, v135
  v_cvt_pk_bf16_f32 v76, v136, v137
  v_cvt_pk_bf16_f32 v77, v138, v139
  v_cvt_pk_bf16_f32 v78, v140, v141
  v_cvt_pk_bf16_f32 v79, v142, v143
  v_cvt_pk_bf16_f32 v80, v144, v145
  v_cvt_pk_bf16_f32 v81, v146, v147
  v_mfma_f32_16x16x16_bf16 v[148:151], v[36:37], v[72:73], 0
  v_mfma_f32_16x16x16_bf16 v[152:155], v[36:37], v[76:77], 0
  v_mfma_f32_16x16x16_bf16 v[148:151], v[36:37], v[74:75], v[148:151]
  v_mfma_f32_16x16x32_bf16 v[152:155], v[36:39], v[78:81], v[152:155]
  s_nop 6
  v_rcp_f32 v82, v148
  v_rcp_f32 v83, v152
  s_and_b32 s34, s17, 1
  s_mul_i32 s34, s34, 3072
  v_add_u32 v28, s34, v1
  ds_write_b128 v28, v[72:75] offset:16384
  ds_write_b128 v28, v[76:79] offset:17408
  ds_write_b128 v28, v[80:83] offset:18432
  s_waitcnt lgkmcnt(0)
  s_branch reca_b5207
reca_tw1208:
  s_cmp_lt_u32 s17, 3
  s_cbranch_scc1 reca_b5207
  s_sub_u32 s36, s17, 3
  s_and_b32 s37, s36, 7
  s_lshl_b32 s34, s59, 3
  s_add_u32 s34, s34, s37
  s_mul_i32 s34, s34, 12288
  s_add_u32 s23, s34, 40894464
  s_lshl_b32 s35, s37, 5
  s_add_u32 s35, s35, s59
  s_mul_i32 s35, s35, 3072
  s_add_u32 s61, s35, 47972352
  s_mul_i32 s34, s36, 393216
  s_mul_i32 s35, s59, 6144
  s_add_u32 s34, s34, s35
  s_add_u32 s60, s34, 57147392
  s_add_u32 s34, s17, 1
  s_and_b32 s34, s34, 1
  s_mul_i32 s34, s34, 3072
  v_add_u32 v28, s34, v1
  ds_read_b128 v[72:75], v28 offset:16384
  ds_read_b128 v[76:79], v28 offset:17408
  ds_read_b128 v[80:83], v28 offset:18432
  buffer_load_dwordx2 a[168:169], v93, s[4:7], s61 offen offset:0 sc1
  buffer_load_dwordx4 a[120:123], v1, s[4:7], s23 offen offset:0 sc1
  buffer_load_dwordx2 a[170:171], v93, s[4:7], s61 offen offset:256 sc1
  buffer_load_dwordx4 a[124:127], v1, s[4:7], s23 offen offset:1024 sc1
  buffer_load_dwordx2 a[172:173], v93, s[4:7], s61 offen offset:512 sc1
  buffer_load_dwordx4 a[128:131], v1, s[4:7], s23 offen offset:2048 sc1
  buffer_load_dwordx2 a[174:175], v93, s[4:7], s61 offen offset:768 sc1
  buffer_load_dwordx4 a[132:135], v1, s[4:7], s23 offen offset:3072 sc1
  buffer_load_dwordx2 a[176:177], v93, s[4:7], s61 offen offset:1024 sc1
  buffer_load_dwordx4 a[136:139], v2, s[4:7], s23 offen offset:0 sc1
  buffer_load_dwordx2 a[178:179], v93, s[4:7], s61 offen offset:1280 sc1
  buffer_load_dwordx4 a[140:143], v2, s[4:7], s23 offen offset:1024 sc1
  s_waitcnt lgkmcnt(0)
  s_waitcnt vmcnt(8)
  v_mfma_f32_16x16x16_bf16 v[156:159], a[168:169], v[72:73], 0
  v_mfma_f32_16x16x16_bf16 v[160:163], a[168:169], v[76:77], 0
  v_mfma_f32_16x16x16_bf16 v[156:159], a[120:121], v[74:75], v[156:159]
  v_mfma_f32_16x16x32_bf16 v[160:163], a[120:123], v[78:81], v[160:163]
  v_mfma_f32_16x16x16_bf16 v[164:167], a[170:171], v[72:73], 0
  v_mfma_f32_16x16x16_bf16 v[168:171], a[170:171], v[76:77], 0
  v_mfma_f32_16x16x16_bf16 v[164:167], a[124:125], v[74:75], v[164:167]
  v_mfma_f32_16x16x32_bf16 v[168:171], a[124:127], v[78:81], v[168:171]
  s_nop 2
  v_mul_f32 v156, v156, v82
  v_mul_f32 v157, v157, v82
  v_mul_f32 v158, v158, v82
  v_mul_f32 v159, v159, v82
  v_cvt_pk_bf16_f32 v172, v156, v157
  v_cvt_pk_bf16_f32 v173, v158, v159
  v_mul_f32 v164, v164, v82
  v_mul_f32 v165, v165, v82
  v_mul_f32 v166, v166, v82
  v_mul_f32 v167, v167, v82
  v_cvt_pk_bf16_f32 v174, v164, v165
  v_cvt_pk_bf16_f32 v175, v166, v167
  buffer_store_dwordx4 v[172:175], v1, s[4:7], s60 offen offset:0 sc1
  v_mul_f32 v160, v160, v83
  v_mul_f32 v161, v161, v83
  v_mul_f32 v162, v162, v83
  v_mul_f32 v163, v163, v83
  v_cvt_pk_bf16_f32 v176, v160, v161
  v_cvt_pk_bf16_f32 v177, v162, v163
  v_mul_f32 v168, v168, v83
  v_mul_f32 v169, v169, v83
  v_mul_f32 v170, v170, v83
  v_mul_f32 v171, v171, v83
  v_cvt_pk_bf16_f32 v178, v168, v169
  v_cvt_pk_bf16_f32 v179, v170, v171
  s_add_u32 s34, s60, 196608
  buffer_store_dwordx4 v[176:179], v1, s[4:7], s34 offen offset:0 sc1
  s_waitcnt vmcnt(6)
  v_mfma_f32_16x16x16_bf16 v[156:159], a[172:173], v[72:73], 0
  v_mfma_f32_16x16x16_bf16 v[160:163], a[172:173], v[76:77], 0
  v_mfma_f32_16x16x16_bf16 v[156:159], a[128:129], v[74:75], v[156:159]
  v_mfma_f32_16x16x32_bf16 v[160:163], a[128:131], v[78:81], v[160:163]
  v_mfma_f32_16x16x16_bf16 v[164:167], a[174:175], v[72:73], 0
  v_mfma_f32_16x16x16_bf16 v[168:171], a[174:175], v[76:77], 0
  v_mfma_f32_16x16x16_bf16 v[164:167], a[132:133], v[74:75], v[164:167]
  v_mfma_f32_16x16x32_bf16 v[168:171], a[132:135], v[78:81], v[168:171]
  s_nop 2
  v_mul_f32 v156, v156, v82
  v_mul_f32 v157, v157, v82
  v_mul_f32 v158, v158, v82
  v_mul_f32 v159, v159, v82
  v_cvt_pk_bf16_f32 v172, v156, v157
  v_cvt_pk_bf16_f32 v173, v158, v159
  v_mul_f32 v164, v164, v82
  v_mul_f32 v165, v165, v82
  v_mul_f32 v166, v166, v82
  v_mul_f32 v167, v167, v82
  v_cvt_pk_bf16_f32 v174, v164, v165
  v_cvt_pk_bf16_f32 v175, v166, v167
  buffer_store_dwordx4 v[172:175], v1, s[4:7], s60 offen offset:1024 sc1
  v_mul_f32 v160, v160, v83
  v_mul_f32 v161, v161, v83
  v_mul_f32 v162, v162, v83
  v_mul_f32 v163, v163, v83
  v_cvt_pk_bf16_f32 v176, v160, v161
  v_cvt_pk_bf16_f32 v177, v162, v163
  v_mul_f32 v168, v168, v83
  v_mul_f32 v169, v169, v83
  v_mul_f32 v170, v170, v83
  v_mul_f32 v171, v171, v83
  v_cvt_pk_bf16_f32 v178, v168, v169
  v_cvt_pk_bf16_f32 v179, v170, v171
  s_add_u32 s34, s60, 196608
  buffer_store_dwordx4 v[176:179], v1, s[4:7], s34 offen offset:1024 sc1
  s_waitcnt vmcnt(4)
  v_mfma_f32_16x16x16_bf16 v[156:159], a[176:177], v[72:73], 0
  v_mfma_f32_16x16x16_bf16 v[160:163], a[176:177], v[76:77], 0
  v_mfma_f32_16x16x16_bf16 v[156:159], a[136:137], v[74:75], v[156:159]
  v_mfma_f32_16x16x32_bf16 v[160:163], a[136:139], v[78:81], v[160:163]
  v_mfma_f32_16x16x16_bf16 v[164:167], a[178:179], v[72:73], 0
  v_mfma_f32_16x16x16_bf16 v[168:171], a[178:179], v[76:77], 0
  v_mfma_f32_16x16x16_bf16 v[164:167], a[140:141], v[74:75], v[164:167]
  v_mfma_f32_16x16x32_bf16 v[168:171], a[140:143], v[78:81], v[168:171]
  s_nop 2
  v_mul_f32 v156, v156, v82
  v_mul_f32 v157, v157, v82
  v_mul_f32 v158, v158, v82
  v_mul_f32 v159, v159, v82
  v_cvt_pk_bf16_f32 v172, v156, v157
  v_cvt_pk_bf16_f32 v173, v158, v159
  v_mul_f32 v164, v164, v82
  v_mul_f32 v165, v165, v82
  v_mul_f32 v166, v166, v82
  v_mul_f32 v167, v167, v82
  v_cvt_pk_bf16_f32 v174, v164, v165
  v_cvt_pk_bf16_f32 v175, v166, v167
  buffer_store_dwordx4 v[172:175], v1, s[4:7], s60 offen offset:2048 sc1
  v_mul_f32 v160, v160, v83
  v_mul_f32 v161, v161, v83
  v_mul_f32 v162, v162, v83
  v_mul_f32 v163, v163, v83
  v_cvt_pk_bf16_f32 v176, v160, v161
  v_cvt_pk_bf16_f32 v177, v162, v163
  v_mul_f32 v168, v168, v83
  v_mul_f32 v169, v169, v83
  v_mul_f32 v170, v170, v83
  v_mul_f32 v171, v171, v83
  v_cvt_pk_bf16_f32 v178, v168, v169
  v_cvt_pk_bf16_f32 v179, v170, v171
  s_add_u32 s34, s60, 196608
  buffer_store_dwordx4 v[176:179], v1, s[4:7], s34 offen offset:2048 sc1
  s_branch reca_b5207
reca_tw2209:
  s_cmp_lt_u32 s17, 3
  s_cbranch_scc1 reca_b5207
  s_sub_u32 s36, s17, 3
  s_and_b32 s37, s36, 7
  s_lshl_b32 s34, s59, 3
  s_add_u32 s34, s34, s37
  s_mul_i32 s34, s34, 12288
  s_add_u32 s23, s34, 40894464
  s_lshl_b32 s35, s37, 5
  s_add_u32 s35, s35, s59
  s_mul_i32 s35, s35, 3072
  s_add_u32 s61, s35, 47972352
  s_mul_i32 s34, s36, 393216
  s_mul_i32 s35, s59, 6144
  s_add_u32 s34, s34, s35
  s_add_u32 s60, s34, 57147392
  s_add_u32 s34, s17, 1
  s_and_b32 s34, s34, 1
  s_mul_i32 s34, s34, 3072
  v_add_u32 v28, s34, v1
  ds_read_b128 v[72:75], v28 offset:16384
  ds_read_b128 v[76:79], v28 offset:17408
  ds_read_b128 v[80:83], v28 offset:18432
  buffer_load_dwordx2 a[180:181], v93, s[4:7], s61 offen offset:1536 sc1
  buffer_load_dwordx4 a[144:147], v2, s[4:7], s23 offen offset:2048 sc1
  buffer_load_dwordx2 a[182:183], v93, s[4:7], s61 offen offset:1792 sc1
  buffer_load_dwordx4 a[148:151], v2, s[4:7], s23 offen offset:3072 sc1
  buffer_load_dwordx2 a[184:185], v93, s[4:7], s61 offen offset:2048 sc1
  buffer_load_dwordx4 a[152:155], v3, s[4:7], s23 offen offset:0 sc1
  buffer_load_dwordx2 a[186:187], v93, s[4:7], s61 offen offset:2304 sc1
  buffer_load_dwordx4 a[156:159], v3, s[4:7], s23 offen offset:1024 sc1
  buffer_load_dwordx2 a[188:189], v93, s[4:7], s61 offen offset:2560 sc1
  buffer_load_dwordx4 a[160:163], v3, s[4:7], s23 offen offset:2048 sc1
  buffer_load_dwordx2 a[190:191], v93, s[4:7], s61 offen offset:2816 sc1
  buffer_load_dwordx4 a[164:167], v3, s[4:7], s23 offen offset:3072 sc1
  s_waitcnt lgkmcnt(0)
  s_waitcnt vmcnt(8)
  v_mfma_f32_16x16x16_bf16 v[156:159], a[180:181], v[72:73], 0
  v_mfma_f32_16x16x16_bf16 v[160:163], a[180:181], v[76:77], 0
  v_mfma_f32_16x16x16_bf16 v[156:159], a[144:145], v[74:75], v[156:159]
  v_mfma_f32_16x16x32_bf16 v[160:163], a[144:147], v[78:81], v[160:163]
  v_mfma_f32_16x16x16_bf16 v[164:167], a[182:183], v[72:73], 0
  v_mfma_f32_16x16x16_bf16 v[168:171], a[182:183], v[76:77], 0
  v_mfma_f32_16x16x16_bf16 v[164:167], a[148:149], v[74:75], v[164:167]
  v_mfma_f32_16x16x32_bf16 v[168:171], a[148:151], v[78:81], v[168:171]
  s_nop 2
  v_mul_f32 v156, v156, v82
  v_mul_f32 v157, v157, v82
  v_mul_f32 v158, v158, v82
  v_mul_f32 v159, v159, v82
  v_cvt_pk_bf16_f32 v172, v156, v157
  v_cvt_pk_bf16_f32 v173, v158, v159
  v_mul_f32 v164, v164, v82
  v_mul_f32 v165, v165, v82
  v_mul_f32 v166, v166, v82
  v_mul_f32 v167, v167, v82
  v_cvt_pk_bf16_f32 v174, v164, v165
  v_cvt_pk_bf16_f32 v175, v166, v167
  buffer_store_dwordx4 v[172:175], v1, s[4:7], s60 offen offset:3072 sc1
  v_mul_f32 v160, v160, v83
  v_mul_f32 v161, v161, v83
  v_mul_f32 v162, v162, v83
  v_mul_f32 v163, v163, v83
  v_cvt_pk_bf16_f32 v176, v160, v161
  v_cvt_pk_bf16_f32 v177, v162, v163
  v_mul_f32 v168, v168, v83
  v_mul_f32 v169, v169, v83
  v_mul_f32 v170, v170, v83
  v_mul_f32 v171, v171, v83
  v_cvt_pk_bf16_f32 v178, v168, v169
  v_cvt_pk_bf16_f32 v179, v170, v171
  s_add_u32 s34, s60, 196608
  buffer_store_dwordx4 v[176:179], v1, s[4:7], s34 offen offset:3072 sc1
  s_waitcnt vmcnt(6)
  v_mfma_f32_16x16x16_bf16 v[156:159], a[184:185], v[72:73], 0
  v_mfma_f32_16x16x16_bf16 v[160:163], a[184:185], v[76:77], 0
  v_mfma_f32_16x16x16_bf16 v[156:159], a[152:153], v[74:75], v[156:159]
  v_mfma_f32_16x16x32_bf16 v[160:163], a[152:155], v[78:81], v[160:163]
  v_mfma_f32_16x16x16_bf16 v[164:167], a[186:187], v[72:73], 0
  v_mfma_f32_16x16x16_bf16 v[168:171], a[186:187], v[76:77], 0
  v_mfma_f32_16x16x16_bf16 v[164:167], a[156:157], v[74:75], v[164:167]
  v_mfma_f32_16x16x32_bf16 v[168:171], a[156:159], v[78:81], v[168:171]
  s_nop 2
  v_mul_f32 v156, v156, v82
  v_mul_f32 v157, v157, v82
  v_mul_f32 v158, v158, v82
  v_mul_f32 v159, v159, v82
  v_cvt_pk_bf16_f32 v172, v156, v157
  v_cvt_pk_bf16_f32 v173, v158, v159
  v_mul_f32 v164, v164, v82
  v_mul_f32 v165, v165, v82
  v_mul_f32 v166, v166, v82
  v_mul_f32 v167, v167, v82
  v_cvt_pk_bf16_f32 v174, v164, v165
  v_cvt_pk_bf16_f32 v175, v166, v167
  buffer_store_dwordx4 v[172:175], v2, s[4:7], s60 offen offset:0 sc1
  v_mul_f32 v160, v160, v83
  v_mul_f32 v161, v161, v83
  v_mul_f32 v162, v162, v83
  v_mul_f32 v163, v163, v83
  v_cvt_pk_bf16_f32 v176, v160, v161
  v_cvt_pk_bf16_f32 v177, v162, v163
  v_mul_f32 v168, v168, v83
  v_mul_f32 v169, v169, v83
  v_mul_f32 v170, v170, v83
  v_mul_f32 v171, v171, v83
  v_cvt_pk_bf16_f32 v178, v168, v169
  v_cvt_pk_bf16_f32 v179, v170, v171
  s_add_u32 s34, s60, 196608
  buffer_store_dwordx4 v[176:179], v2, s[4:7], s34 offen offset:0 sc1
  s_waitcnt vmcnt(4)
  v_mfma_f32_16x16x16_bf16 v[156:159], a[188:189], v[72:73], 0
  v_mfma_f32_16x16x16_bf16 v[160:163], a[188:189], v[76:77], 0
  v_mfma_f32_16x16x16_bf16 v[156:159], a[160:161], v[74:75], v[156:159]
  v_mfma_f32_16x16x32_bf16 v[160:163], a[160:163], v[78:81], v[160:163]
  v_mfma_f32_16x16x16_bf16 v[164:167], a[190:191], v[72:73], 0
  v_mfma_f32_16x16x16_bf16 v[168:171], a[190:191], v[76:77], 0
  v_mfma_f32_16x16x16_bf16 v[164:167], a[164:165], v[74:75], v[164:167]
  v_mfma_f32_16x16x32_bf16 v[168:171], a[164:167], v[78:81], v[168:171]
  s_nop 2
  v_mul_f32 v156, v156, v82
  v_mul_f32 v157, v157, v82
  v_mul_f32 v158, v158, v82
  v_mul_f32 v159, v159, v82
  v_cvt_pk_bf16_f32 v172, v156, v157
  v_cvt_pk_bf16_f32 v173, v158, v159
  v_mul_f32 v164, v164, v82
  v_mul_f32 v165, v165, v82
  v_mul_f32 v166, v166, v82
  v_mul_f32 v167, v167, v82
  v_cvt_pk_bf16_f32 v174, v164, v165
  v_cvt_pk_bf16_f32 v175, v166, v167
  buffer_store_dwordx4 v[172:175], v2, s[4:7], s60 offen offset:1024 sc1
  v_mul_f32 v160, v160, v83
  v_mul_f32 v161, v161, v83
  v_mul_f32 v162, v162, v83
  v_mul_f32 v163, v163, v83
  v_cvt_pk_bf16_f32 v176, v160, v161
  v_cvt_pk_bf16_f32 v177, v162, v163
  v_mul_f32 v168, v168, v83
  v_mul_f32 v169, v169, v83
  v_mul_f32 v170, v170, v83
  v_mul_f32 v171, v171, v83
  v_cvt_pk_bf16_f32 v178, v168, v169
  v_cvt_pk_bf16_f32 v179, v170, v171
  s_add_u32 s34, s60, 196608
  buffer_store_dwordx4 v[176:179], v2, s[4:7], s34 offen offset:1024 sc1
  s_branch reca_b5207
  s_cmp_lg_u32 s12, 2
  s_cbranch_scc1 reca_b3205
  buffer_store_dwordx2 v[52:53], v9, s[4:7], s30 offen sc1
  buffer_store_dwordx2 v[32:33], v16, s[4:7], s26 offen sc1
  s_cmp_lg_u32 s14, 0
  s_cbranch_scc1 reca_b3205
  v_mov_b32 v28, s17
  s_lshl_b32 s34, s13, 7
  s_add_u32 s34, s34, 1507328
  buffer_store_dword v28, v19, s[4:7], s34 offen sc1
  s_branch reca_b3205
reca_last204:
  s_cmp_lg_u32 s12, 2
  s_cbranch_scc1 reca_exit1
  buffer_store_dwordx2 v[52:53], v9, s[4:7], s30 offen
  s_branch reca_exit1
reca_swave202:
  s_cmp_lg_u32 s17, 63
  s_cbranch_scc1 reca_vmst210
  s_barrier
  ds_read_b128 v[56:59], v1 offset:10240
  ds_read_b128 v[60:63], v1 offset:11264
  ds_read_b128 v[64:67], v1 offset:12288
  s_waitcnt lgkmcnt(0)
  v_add_f32 v56, v56, v64
  v_add_f32 v60, v60, v48
  v_add_f32 v57, v57, v65
  v_add_f32 v61, v61, v49
  v_add_f32 v58, v58, v66
  v_add_f32 v62, v62, v50
  v_add_f32 v59, v59, v67
  v_add_f32 v63, v63, v51
  v_cvt_pk_bf16_f32 v68, v56, v57
  v_cvt_pk_bf16_f32 v69, v58, v59
  v_cvt_pk_bf16_f32 v70, v60, v61
  v_cvt_pk_bf16_f32 v71, v62, v63
  buffer_store_dwordx2 v[52:53], v9, s[4:7], s30 offen
  buffer_store_dwordx2 v[68:69], v10, s[4:7], s31 offen
  buffer_store_dwordx2 v[70:71], v10, s[4:7], s31 offen offset:256
  s_branch reca_exit1
reca_vmst210:
  s_sleep 1
  buffer_load_dwordx4 v[208:211], v1, s[4:7], s21 offen offset:0 sc1
  buffer_load_dwordx4 v[212:215], v1, s[4:7], s21 offen offset:1024 sc1
  buffer_load_dwordx4 v[216:219], v1, s[4:7], s21 offen offset:2048 sc1
  buffer_load_dwordx4 v[220:223], v1, s[4:7], s21 offen offset:3072 sc1
  buffer_load_dwordx4 v[224:227], v2, s[4:7], s21 offen offset:0 sc1
  buffer_load_dwordx4 v[228:231], v2, s[4:7], s21 offen offset:1024 sc1
  s_waitcnt vmcnt(5)
  v_max_u32 v29, v208, v210
  v_cmp_eq_u32 vcc, -1, v29
  s_cbranch_vccnz reca_retry211
reca_resume212:
  s_waitcnt vmcnt(4)
  v_max_u32 v29, v212, v214
  v_cmp_eq_u32 vcc, -1, v29
  v_mfma_f32_16x16x32_bf16 v[76:79], a[120:123], v[208:211], 0
  v_mfma_f32_16x16x32_bf16 v[80:83], a[144:147], v[208:211], 0
  v_mfma_f32_16x16x32_bf16 v[72:75], v[208:211], v[208:211], v[40:43]
  s_cbranch_vccnz reca_retry213
reca_resume214:
  s_waitcnt vmcnt(3)
  v_max_u32 v29, v216, v218
  v_cmp_eq_u32 vcc, -1, v29
  v_mfma_f32_16x16x32_bf16 v[76:79], a[124:127], v[212:215], v[76:79]
  v_mfma_f32_16x16x32_bf16 v[80:83], a[148:151], v[212:215], v[80:83]
  v_mfma_f32_16x16x32_bf16 v[72:75], v[212:215], v[212:215], v[72:75]
  s_cbranch_vccnz reca_retry215
reca_resume216:
  s_waitcnt vmcnt(2)
  v_max_u32 v29, v220, v222
  v_cmp_eq_u32 vcc, -1, v29
  v_mfma_f32_16x16x32_bf16 v[76:79], a[128:131], v[216:219], v[76:79]
  v_mfma_f32_16x16x32_bf16 v[80:83], a[152:155], v[216:219], v[80:83]
  v_mfma_f32_16x16x32_bf16 v[72:75], v[216:219], v[216:219], v[72:75]
  s_cbranch_vccnz reca_retry217
reca_resume218:
  s_waitcnt vmcnt(1)
  v_max_u32 v29, v224, v226
  v_cmp_eq_u32 vcc, -1, v29
  v_mfma_f32_16x16x32_bf16 v[76:79], a[132:135], v[220:223], v[76:79]
  v_mfma_f32_16x16x32_bf16 v[80:83], a[156:159], v[220:223], v[80:83]
  v_mfma_f32_16x16x32_bf16 v[72:75], v[220:223], v[220:223], v[72:75]
  s_cbranch_vccnz reca_retry219
reca_resume220:
  s_waitcnt vmcnt(0)
  v_max_u32 v29, v228, v230
  v_cmp_eq_u32 vcc, -1, v29
  v_mfma_f32_16x16x32_bf16 v[76:79], a[136:139], v[224:227], v[76:79]
  v_mfma_f32_16x16x32_bf16 v[80:83], a[160:163], v[224:227], v[80:83]
  v_mfma_f32_16x16x32_bf16 v[72:75], v[224:227], v[224:227], v[72:75]
  s_cbranch_vccnz reca_retry221
reca_resume222:
  v_mfma_f32_16x16x32_bf16 v[76:79], a[140:143], v[228:231], v[76:79]
  v_mfma_f32_16x16x32_bf16 v[80:83], a[164:167], v[228:231], v[80:83]
  v_mfma_f32_16x16x32_bf16 v[72:75], v[228:231], v[228:231], v[72:75]
  s_barrier
  ds_read_b128 v[56:59], v1 offset:10240
  ds_read_b128 v[60:63], v1 offset:11264
  ds_read_b128 v[64:67], v1 offset:12288
  s_nop 1
  v_max3_f32 v28, v76, v77, v78
  v_max3_f32 v29, v80, v81, v82
  v_max3_f32 v28, v28, v79, v83
  v_max3_f32 v29, v29, v72, v73
  v_max3_f32 v28, v28, v74, v75
  v_max_f32 v28, v28, v29
  v_mov_b32 v29, v28
  s_nop 1
  v_permlane32_swap_b32 v28, v29
  v_max_f32 v28, v28, v29
  v_mov_b32 v29, v28
  s_nop 1
  v_permlane16_swap_b32 v28, v29
  v_max_f32 v28, v28, v29
  v_mul_f32 v28, s41, v28
  v_fma_f32 v76, v76, s41, -v28
  v_fma_f32 v77, v77, s41, -v28
  v_fma_f32 v78, v78, s41, -v28
  v_fma_f32 v79, v79, s41, -v28
  v_fma_f32 v80, v80, s41, -v28
  v_fma_f32 v81, v81, s41, -v28
  v_fma_f32 v82, v82, s41, -v28
  v_fma_f32 v83, v83, s41, -v28
  v_fma_f32 v72, v72, s41, -v28
  v_fma_f32 v73, v73, s41, -v28
  v_fma_f32 v74, v74, s41, -v28
  v_fma_f32 v75, v75, s41, -v28
  v_exp_f32 v76, v76
  v_exp_f32 v77, v77
  v_exp_f32 v78, v78
  v_exp_f32 v79, v79
  v_exp_f32 v80, v80
  v_exp_f32 v81, v81
  v_exp_f32 v82, v82
  v_exp_f32 v83, v83
  v_cvt_pk_bf16_f32 v84, v76, v77
  v_cvt_pk_bf16_f32 v85, v78, v79
  v_cvt_pk_bf16_f32 v86, v80, v81
  v_cvt_pk_bf16_f32 v87, v82, v83
  v_exp_f32 v72, v72
  v_exp_f32 v73, v73
  v_mfma_f32_16x16x32_bf16 v[100:103], v[36:39], v[84:87], 0
  v_exp_f32 v74, v74
  v_exp_f32 v75, v75
  v_mfma_f32_16x16x32_bf16 v[92:95], a[168:171], v[84:87], 0
  v_cvt_pk_bf16_f32 v88, v72, v73
  v_cvt_pk_bf16_f32 v89, v74, v75
  v_mfma_f32_16x16x32_bf16 v[96:99], a[172:175], v[84:87], 0
  s_waitcnt lgkmcnt(0)
  v_mfma_f32_16x16x16_bf16 v[100:103], v[36:37], v[88:89], v[100:103]
  v_add_f32 v56, v56, v64
  v_add_f32 v60, v60, v48
  v_add_f32 v57, v57, v65
  v_add_f32 v61, v61, v49
  v_add_f32 v58, v58, v66
  v_add_f32 v62, v62, v50
  v_add_f32 v59, v59, v67
  v_add_f32 v63, v63, v51
  v_cvt_pk_bf16_f32 v68, v56, v57
  v_cvt_pk_bf16_f32 v69, v58, v59
  v_cvt_pk_bf16_f32 v70, v60, v61
  v_cvt_pk_bf16_f32 v71, v62, v63
  v_mfma_f32_16x16x16_bf16 v[92:95], v[68:69], v[88:89], v[92:95]
  v_rcp_f32 v28, v100
  v_mfma_f32_16x16x16_bf16 v[96:99], v[70:71], v[88:89], v[96:99]
  v_mov_b32 v29, v28
  s_nop 4
  v_pk_mul_f32 v[92:93], v[92:93], v[28:29]
  v_pk_mul_f32 v[94:95], v[94:95], v[28:29]
  v_pk_mul_f32 v[96:97], v[96:97], v[28:29]
  v_pk_mul_f32 v[98:99], v[98:99], v[28:29]
  v_cvt_pk_bf16_f32 v104, v92, v93
  v_cvt_pk_bf16_f32 v105, v94, v95
  v_cvt_pk_bf16_f32 v106, v96, v97
  v_cvt_pk_bf16_f32 v107, v98, v99
  buffer_store_dwordx4 v[104:107], v11, s[4:7], s22 offen sc1
  s_barrier
  s_add_u32 s34, s17, 2
  s_and_b32 s34, s34, 3
  s_mul_i32 s26, s34, 10240
  s_add_u32 s26, s26, s38
  s_mul_i32 s27, s34, 6144
  s_add_u32 s27, s27, s39
  s_mul_i32 s28, s34, 12288
  s_add_u32 s28, s28, s40
  s_mul_i32 s29, s34, 393216
  s_add_u32 s29, s29, s56
  buffer_store_dwordx2 v[32:33], v8, s[4:7], s27 offen sc1
  buffer_store_dwordx4 v[32:35], v11, s[4:7], s28 offen sc1
  s_add_u32 s36, s17, 1
  s_cmp_ge_u32 s36, 63
  s_cbranch_scc1 reca_nopf223
  s_add_u32 s37, s36, 1
reca_pf224:
  buffer_load_dword v28, v233, s[4:7], 0 offen sc1
  s_waitcnt vmcnt(0)
  v_cmp_gt_i32 vcc, s37, v28
  s_cbranch_vccz reca_pfok225
  s_sleep 1
  s_sub_u32 s18, s18, 1
  s_cbranch_scc0 reca_pf224
  s_mov_b32 s18, 0
reca_pfok225:
  s_lshl_b32 s34, s15, 3
  s_and_b32 s35, s36, 7
  s_add_u32 s34, s34, s35
  s_mul_i32 s34, s34, 12288
  s_add_u32 s32, s34, 37748736
  s_lshl_b32 s35, s16, 11
  s_add_u32 s34, s34, s35
  s_add_u32 s33, s34, 40894464
  buffer_load_dwordx4 a[120:123], v1, s[4:7], s32 offen offset:0 sc1
  buffer_load_dwordx4 a[124:127], v1, s[4:7], s32 offen offset:1024 sc1
  buffer_load_dwordx4 a[128:131], v1, s[4:7], s32 offen offset:2048 sc1
  buffer_load_dwordx4 a[132:135], v1, s[4:7], s32 offen offset:3072 sc1
  buffer_load_dwordx4 a[136:139], v2, s[4:7], s32 offen offset:0 sc1
  buffer_load_dwordx4 a[140:143], v2, s[4:7], s32 offen offset:1024 sc1
  buffer_load_dwordx4 a[144:147], v2, s[4:7], s32 offen offset:2048 sc1
  buffer_load_dwordx4 a[148:151], v2, s[4:7], s32 offen offset:3072 sc1
  buffer_load_dwordx4 a[152:155], v3, s[4:7], s32 offen offset:0 sc1
  buffer_load_dwordx4 a[156:159], v3, s[4:7], s32 offen offset:1024 sc1
  buffer_load_dwordx4 a[160:163], v3, s[4:7], s32 offen offset:2048 sc1
  buffer_load_dwordx4 a[164:167], v3, s[4:7], s32 offen offset:3072 sc1
  buffer_load_dwordx4 a[168:171], v1, s[4:7], s33 offen offset:0 sc1
  buffer_load_dwordx4 a[172:175], v1, s[4:7], s33 offen offset:1024 sc1
reca_nopf223:
  buffer_store_dwordx2 v[52:53], v9, s[4:7], s30 offen sc1
  buffer_store_dwordx2 v[68:69], v10, s[4:7], s31 offen sc1
  buffer_store_dwordx2 v[70:71], v10, s[4:7], s31 offen offset:256 sc1
reca_b5207:
  s_barrier
  s_add_u32 s17, s17, 1
  s_branch reca_step193
reca_b3205:
  s_endpgm
reca_retry196:
  s_sub_u32 s18, s18, 1
  s_cbranch_scc1 reca_retry196_to
  buffer_load_dwordx4 v[128:131], v4, s[4:7], s20 offen sc1
  buffer_load_dwordx4 v[132:135], v4, s[4:7], s20 offen offset:1024 sc1
  buffer_load_dwordx4 v[136:139], v5, s[4:7], s20 offen sc1
  s_waitcnt vmcnt(2)
  v_max_u32 v29, v128, v130
  v_cmp_eq_u32 vcc, -1, v29
  s_cbranch_vccnz reca_retry196
  s_branch reca_resume197
reca_retry196_to:
  s_mov_b32 s18, 0
  s_waitcnt vmcnt(0)
  s_branch reca_resume197
reca_retry198:
  s_sub_u32 s18, s18, 1
  s_cbranch_scc1 reca_retry198_to
  buffer_load_dwordx4 v[132:135], v4, s[4:7], s20 offen offset:1024 sc1
  buffer_load_dwordx4 v[136:139], v5, s[4:7], s20 offen sc1
  s_waitcnt vmcnt(1)
  v_max_u32 v29, v132, v134
  v_cmp_eq_u32 vcc, -1, v29
  s_cbranch_vccnz reca_retry198
  s_branch reca_resume199
reca_retry198_to:
  s_mov_b32 s18, 0
  s_waitcnt vmcnt(0)
  s_branch reca_resume199
reca_retry200:
  s_sub_u32 s18, s18, 1
  s_cbranch_scc1 reca_retry200_to
  buffer_load_dwordx4 v[136:139], v5, s[4:7], s20 offen sc1
  s_waitcnt vmcnt(0)
  v_max_u32 v29, v136, v138
  v_cmp_eq_u32 vcc, -1, v29
  s_cbranch_vccnz reca_retry200
  s_branch reca_resume201
reca_retry200_to:
  s_mov_b32 s18, 0
  s_waitcnt vmcnt(0)
  s_branch reca_resume201
reca_retry211:
  s_sub_u32 s18, s18, 1
  s_cbranch_scc1 reca_retry211_to
  buffer_load_dwordx4 v[208:211], v1, s[4:7], s21 offen offset:0 sc1
  buffer_load_dwordx4 v[212:215], v1, s[4:7], s21 offen offset:1024 sc1
  buffer_load_dwordx4 v[216:219], v1, s[4:7], s21 offen offset:2048 sc1
  buffer_load_dwordx4 v[220:223], v1, s[4:7], s21 offen offset:3072 sc1
  buffer_load_dwordx4 v[224:227], v2, s[4:7], s21 offen offset:0 sc1
  buffer_load_dwordx4 v[228:231], v2, s[4:7], s21 offen offset:1024 sc1
  s_waitcnt vmcnt(5)
  v_max_u32 v29, v208, v210
  v_cmp_eq_u32 vcc, -1, v29
  s_cbranch_vccnz reca_retry211
  s_branch reca_resume212
reca_retry211_to:
  s_mov_b32 s18, 0
  s_waitcnt vmcnt(0)
  s_branch reca_resume212
reca_retry213:
  s_sub_u32 s18, s18, 1
  s_cbranch_scc1 reca_retry213_to
  buffer_load_dwordx4 v[212:215], v1, s[4:7], s21 offen offset:1024 sc1
  buffer_load_dwordx4 v[216:219], v1, s[4:7], s21 offen offset:2048 sc1
  buffer_load_dwordx4 v[220:223], v1, s[4:7], s21 offen offset:3072 sc1
  buffer_load_dwordx4 v[224:227], v2, s[4:7], s21 offen offset:0 sc1
  buffer_load_dwordx4 v[228:231], v2, s[4:7], s21 offen offset:1024 sc1
  s_waitcnt vmcnt(4)
  v_max_u32 v29, v212, v214
  v_cmp_eq_u32 vcc, -1, v29
  s_cbranch_vccnz reca_retry213
  s_branch reca_resume214
reca_retry213_to:
  s_mov_b32 s18, 0
  s_waitcnt vmcnt(0)
  s_branch reca_resume214
reca_retry215:
  s_sub_u32 s18, s18, 1
  s_cbranch_scc1 reca_retry215_to
  buffer_load_dwordx4 v[216:219], v1, s[4:7], s21 offen offset:2048 sc1
  buffer_load_dwordx4 v[220:223], v1, s[4:7], s21 offen offset:3072 sc1
  buffer_load_dwordx4 v[224:227], v2, s[4:7], s21 offen offset:0 sc1
  buffer_load_dwordx4 v[228:231], v2, s[4:7], s21 offen offset:1024 sc1
  s_waitcnt vmcnt(3)
  v_max_u32 v29, v216, v218
  v_cmp_eq_u32 vcc, -1, v29
  s_cbranch_vccnz reca_retry215
  s_branch reca_resume216
reca_retry215_to:
  s_mov_b32 s18, 0
  s_waitcnt vmcnt(0)
  s_branch reca_resume216
reca_retry217:
  s_sub_u32 s18, s18, 1
  s_cbranch_scc1 reca_retry217_to
  buffer_load_dwordx4 v[220:223], v1, s[4:7], s21 offen offset:3072 sc1
  buffer_load_dwordx4 v[224:227], v2, s[4:7], s21 offen offset:0 sc1
  buffer_load_dwordx4 v[228:231], v2, s[4:7], s21 offen offset:1024 sc1
  s_waitcnt vmcnt(2)
  v_max_u32 v29, v220, v222
  v_cmp_eq_u32 vcc, -1, v29
  s_cbranch_vccnz reca_retry217
  s_branch reca_resume218
reca_retry217_to:
  s_mov_b32 s18, 0
  s_waitcnt vmcnt(0)
  s_branch reca_resume218
reca_retry219:
  s_sub_u32 s18, s18, 1
  s_cbranch_scc1 reca_retry219_to
  buffer_load_dwordx4 v[224:227], v2, s[4:7], s21 offen offset:0 sc1
  buffer_load_dwordx4 v[228:231], v2, s[4:7], s21 offen offset:1024 sc1
  s_waitcnt vmcnt(1)
  v_max_u32 v29, v224, v226
  v_cmp_eq_u32 vcc, -1, v29
  s_cbranch_vccnz reca_retry219
  s_branch reca_resume220
reca_retry219_to:
  s_mov_b32 s18, 0
  s_waitcnt vmcnt(0)
  s_branch reca_resume220
reca_retry221:
  s_sub_u32 s18, s18, 1
  s_cbranch_scc1 reca_retry221_to
  buffer_load_dwordx4 v[228:231], v2, s[4:7], s21 offen offset:1024 sc1
  s_waitcnt vmcnt(0)
  v_max_u32 v29, v228, v230
  v_cmp_eq_u32 vcc, -1, v29
  s_cbranch_vccnz reca_retry221
  s_branch reca_resume222
reca_retry221_to:
  s_mov_b32 s18, 0
  s_waitcnt vmcnt(0)
  s_branch reca_resume222
reca_proj2:
  s_sub_u32 s34, s14, 24
  s_lshr_b32 s35, s34, 1
  s_and_b32 s16, s34, 1
  s_lshl_b32 s15, s13, 2
  s_add_u32 s15, s15, s35
  s_lshl_b32 s24, s13, 3
  s_add_u32 s24, s24, s34
  s_lshl_b32 s24, s24, 7
  s_add_u32 s24, s24, 1540096
  s_lshl_b32 s25, s13, 7
  s_add_u32 s25, s25, 1507328
  v_and_b32 v28, 63, v0
  v_lshlrev_b32 v1, 4, v28
  v_mov_b32 v29, 0x80000000
  v_cmp_eq_u32 vcc, 0, v28
  v_mov_b32 v4, 0
  s_nop 0
  v_cndmask_b32 v4, v29, v4, vcc
  v_cmp_gt_u32 vcc, 32, v28
  s_nop 1
  v_cndmask_b32 v5, v29, v1, vcc
  s_cmp_eq_u32 s12, 0
  s_cbranch_scc1 reca_pw0_226
  s_cmp_eq_u32 s12, 1
  s_cbranch_scc1 reca_pw1_227
  s_cmp_eq_u32 s12, 2
  s_cbranch_scc1 reca_pw2_228
  s_branch reca_pw3_229
reca_pw0_226:
  s_mov_b32 s17, 0
  s_mov_b32 s26, 0
  s_mul_i32 s20, s17, 40960
  s_add_u32 s20, s20, 84934656
  s_add_u32 m0, s26, 0
  s_nop 0
  buffer_load_dwordx4 v1, s[4:7], s20 offen offset:0 lds
  buffer_load_dwordx4 v1, s[4:7], s20 offen offset:1024 lds
  buffer_load_dwordx4 v1, s[4:7], s20 offen offset:2048 lds
  buffer_load_dwordx4 v1, s[4:7], s20 offen offset:3072 lds
  s_add_u32 s20, s20, 4096
  s_add_u32 m0, s26, 4096
  s_nop 0
  buffer_load_dwordx4 v1, s[4:7], s20 offen offset:0 lds
  buffer_load_dwordx4 v1, s[4:7], s20 offen offset:1024 lds
  buffer_load_dwordx4 v1, s[4:7], s20 offen offset:2048 lds
  buffer_load_dwordx4 v1, s[4:7], s20 offen offset:3072 lds
  s_add_u32 s20, s20, 4096
  s_add_u32 m0, s26, 8192
  s_nop 0
  buffer_load_dwordx4 v1, s[4:7], s20 offen offset:0 lds
  buffer_load_dwordx4 v1, s[4:7], s20 offen offset:1024 lds
  s_mul_i32 s34, s15, 12
  s_mul_i32 s35, s16, 6
  s_add_u32 s34, s34, s35
  s_add_u32 s34, s34, 0
  s_mul_i32 s34, s34, 20480
  s_add_u32 s34, s34, 14155776
  buffer_load_dwordx4 a[0:3], v1, s[4:7], s34 offen offset:0
  buffer_load_dwordx4 a[4:7], v1, s[4:7], s34 offen offset:1024
  buffer_load_dwordx4 a[8:11], v1, s[4:7], s34 offen offset:2048
  buffer_load_dwordx4 a[12:15], v1, s[4:7], s34 offen offset:3072
  s_add_u32 s34, s34, 4096
  buffer_load_dwordx4 a[16:19], v1, s[4:7], s34 offen offset:0
  buffer_load_dwordx4 a[20:23], v1, s[4:7], s34 offen offset:1024
  buffer_load_dwordx4 a[24:27], v1, s[4:7], s34 offen offset:2048
  buffer_load_dwordx4 a[28:31], v1, s[4:7], s34 offen offset:3072
  s_add_u32 s34, s34, 4096
  buffer_load_dwordx4 a[32:35], v1, s[4:7], s34 offen offset:0
  buffer_load_dwordx4 a[36:39], v1, s[4:7], s34 offen offset:1024
  buffer_load_dwordx4 a[40:43], v1, s[4:7], s34 offen offset:2048
  buffer_load_dwordx4 a[44:47], v1, s[4:7], s34 offen offset:3072
  s_add_u32 s34, s34, 4096
  buffer_load_dwordx4 a[48:51], v1, s[4:7], s34 offen offset:0
  buffer_load_dwordx4 a[52:55], v1, s[4:7], s34 offen offset:1024
  buffer_load_dwordx4 a[56:59], v1, s[4:7], s34 offen offset:2048
  buffer_load_dwordx4 a[60:63], v1, s[4:7], s34 offen offset:3072
  s_add_u32 s34, s34, 4096
  buffer_load_dwordx4 a[64:67], v1, s[4:7], s34 offen offset:0
  buffer_load_dwordx4 a[68:71], v1, s[4:7], s34 offen offset:1024
  buffer_load_dwordx4 a[72:75], v1, s[4:7], s34 offen offset:2048
  buffer_load_dwordx4 a[76:79], v1, s[4:7], s34 offen offset:3072
  s_mul_i32 s34, s15, 12
  s_mul_i32 s35, s16, 6
  s_add_u32 s34, s34, s35
  s_add_u32 s34, s34, 1
  s_mul_i32 s34, s34, 20480
  s_add_u32 s34, s34, 14155776
  buffer_load_dwordx4 a[80:83], v1, s[4:7], s34 offen offset:0
  buffer_load_dwordx4 a[84:87], v1, s[4:7], s34 offen offset:1024
  buffer_load_dwordx4 a[88:91], v1, s[4:7], s34 offen offset:2048
  buffer_load_dwordx4 a[92:95], v1, s[4:7], s34 offen offset:3072
  s_add_u32 s34, s34, 4096
  buffer_load_dwordx4 a[96:99], v1, s[4:7], s34 offen offset:0
  buffer_load_dwordx4 a[100:103], v1, s[4:7], s34 offen offset:1024
  buffer_load_dwordx4 a[104:107], v1, s[4:7], s34 offen offset:2048
  buffer_load_dwordx4 a[108:111], v1, s[4:7], s34 offen offset:3072
  s_add_u32 s34, s34, 4096
  buffer_load_dwordx4 a[112:115], v1, s[4:7], s34 offen offset:0
  buffer_load_dwordx4 a[116:119], v1, s[4:7], s34 offen offset:1024
  buffer_load_dwordx4 a[120:123], v1, s[4:7], s34 offen offset:2048
  buffer_load_dwordx4 a[124:127], v1, s[4:7], s34 offen offset:3072
  s_add_u32 s34, s34, 4096
  buffer_load_dwordx4 a[128:131], v1, s[4:7], s34 offen offset:0
  buffer_load_dwordx4 a[132:135], v1, s[4:7], s34 offen offset:1024
  buffer_load_dwordx4 a[136:139], v1, s[4:7], s34 offen offset:2048
  buffer_load_dwordx4 a[140:143], v1, s[4:7], s34 offen offset:3072
  s_add_u32 s34, s34, 4096
  buffer_load_dwordx4 a[144:147], v1, s[4:7], s34 offen offset:0
  buffer_load_dwordx4 a[148:151], v1, s[4:7], s34 offen offset:1024
  buffer_load_dwordx4 a[152:155], v1, s[4:7], s34 offen offset:2048
  buffer_load_dwordx4 a[156:159], v1, s[4:7], s34 offen offset:3072
  s_waitcnt vmcnt(20)
  s_mul_i32 s34, s15, 12
  s_mul_i32 s35, s16, 6
  s_add_u32 s34, s34, s35
  s_add_u32 s34, s34, 2
  s_mul_i32 s34, s34, 20480
  s_add_u32 s34, s34, 14155776
  buffer_load_dwordx4 a[160:163], v1, s[4:7], s34 offen offset:0
  buffer_load_dwordx4 a[164:167], v1, s[4:7], s34 offen offset:1024
  buffer_load_dwordx4 a[168:171], v1, s[4:7], s34 offen offset:2048
  buffer_load_dwordx4 a[172:175], v1, s[4:7], s34 offen offset:3072
  s_add_u32 s34, s34, 4096
  buffer_load_dwordx4 a[176:179], v1, s[4:7], s34 offen offset:0
  buffer_load_dwordx4 a[180:183], v1, s[4:7], s34 offen offset:1024
  buffer_load_dwordx4 a[184:187], v1, s[4:7], s34 offen offset:2048
  buffer_load_dwordx4 a[188:191], v1, s[4:7], s34 offen offset:3072
  s_add_u32 s34, s34, 4096
  buffer_load_dwordx4 a[192:195], v1, s[4:7], s34 offen offset:0
  buffer_load_dwordx4 a[196:199], v1, s[4:7], s34 offen offset:1024
  buffer_load_dwordx4 a[200:203], v1, s[4:7], s34 offen offset:2048
  buffer_load_dwordx4 a[204:207], v1, s[4:7], s34 offen offset:3072
  s_add_u32 s34, s34, 4096
  buffer_load_dwordx4 a[208:211], v1, s[4:7], s34 offen offset:0
  buffer_load_dwordx4 a[212:215], v1, s[4:7], s34 offen offset:1024
  buffer_load_dwordx4 a[216:219], v1, s[4:7], s34 offen offset:2048
  buffer_load_dwordx4 a[220:223], v1, s[4:7], s34 offen offset:3072
  s_add_u32 s34, s34, 4096
  buffer_load_dwordx4 a[224:227], v1, s[4:7], s34 offen offset:0
  buffer_load_dwordx4 a[228:231], v1, s[4:7], s34 offen offset:1024
  buffer_load_dwordx4 a[232:235], v1, s[4:7], s34 offen offset:2048
  buffer_load_dwordx4 a[236:239], v1, s[4:7], s34 offen offset:3072
  s_waitcnt vmcnt(20)
  s_mul_i32 s34, s15, 12
  s_mul_i32 s35, s16, 6
  s_add_u32 s34, s34, s35
  s_add_u32 s34, s34, 3
  s_mul_i32 s34, s34, 20480
  s_add_u32 s34, s34, 14155776
  buffer_load_dwordx4 v[96:99], v1, s[4:7], s34 offen offset:0
  buffer_load_dwordx4 v[100:103], v1, s[4:7], s34 offen offset:1024
  buffer_load_dwordx4 v[104:107], v1, s[4:7], s34 offen offset:2048
  buffer_load_dwordx4 v[108:111], v1, s[4:7], s34 offen offset:3072
  s_add_u32 s34, s34, 4096
  buffer_load_dwordx4 v[112:115], v1, s[4:7], s34 offen offset:0
  buffer_load_dwordx4 v[116:119], v1, s[4:7], s34 offen offset:1024
  buffer_load_dwordx4 v[120:123], v1, s[4:7], s34 offen offset:2048
  buffer_load_dwordx4 v[124:127], v1, s[4:7], s34 offen offset:3072
  s_add_u32 s34, s34, 4096
  buffer_load_dwordx4 v[128:131], v1, s[4:7], s34 offen offset:0
  buffer_load_dwordx4 v[132:135], v1, s[4:7], s34 offen offset:1024
  buffer_load_dwordx4 v[136:139], v1, s[4:7], s34 offen offset:2048
  buffer_load_dwordx4 v[140:143], v1, s[4:7], s34 offen offset:3072
  s_add_u32 s34, s34, 4096
  buffer_load_dwordx4 v[144:147], v1, s[4:7], s34 offen offset:0
  buffer_load_dwordx4 v[148:151], v1, s[4:7], s34 offen offset:1024
  buffer_load_dwordx4 v[152:155], v1, s[4:7], s34 offen offset:2048
  buffer_load_dwordx4 v[156:159], v1, s[4:7], s34 offen offset:3072
  s_add_u32 s34, s34, 4096
  buffer_load_dwordx4 v[160:163], v1, s[4:7], s34 offen offset:0
  buffer_load_dwordx4 v[164:167], v1, s[4:7], s34 offen offset:1024
  buffer_load_dwordx4 v[168:171], v1, s[4:7], s34 offen offset:2048
  buffer_load_dwordx4 v[172:175], v1, s[4:7], s34 offen offset:3072
  s_waitcnt vmcnt(20)
  s_mul_i32 s34, s15, 12
  s_mul_i32 s35, s16, 6
  s_add_u32 s34, s34, s35
  s_add_u32 s34, s34, 0
  s_mul_i32 s34, s34, 20480
  s_add_u32 s34, s34, 22020096
  buffer_load_dwordx4 v[176:179], v1, s[4:7], s34 offen offset:0
  buffer_load_dwordx4 v[180:183], v1, s[4:7], s34 offen offset:1024
  buffer_load_dwordx4 v[184:187], v1, s[4:7], s34 offen offset:2048
  buffer_load_dwordx4 v[188:191], v1, s[4:7], s34 offen offset:3072
  s_add_u32 s34, s34, 4096
  buffer_load_dwordx4 v[192:195], v1, s[4:7], s34 offen offset:0
  buffer_load_dwordx4 v[196:199], v1, s[4:7], s34 offen offset:1024
  buffer_load_dwordx4 v[200:203], v1, s[4:7], s34 offen offset:2048
  buffer_load_dwordx4 v[204:207], v1, s[4:7], s34 offen offset:3072
  s_add_u32 s34, s34, 4096
  buffer_load_dwordx4 v[208:211], v1, s[4:7], s34 offen offset:0
  buffer_load_dwordx4 v[212:215], v1, s[4:7], s34 offen offset:1024
  buffer_load_dwordx4 v[216:219], v1, s[4:7], s34 offen offset:2048
  buffer_load_dwordx4 v[220:223], v1, s[4:7], s34 offen offset:3072
  s_add_u32 s34, s34, 4096
  buffer_load_dwordx4 v[224:227], v1, s[4:7], s34 offen offset:0
  buffer_load_dwordx4 v[228:231], v1, s[4:7], s34 offen offset:1024
  buffer_load_dwordx4 v[232:235], v1, s[4:7], s34 offen offset:2048
  buffer_load_dwordx4 v[236:239], v1, s[4:7], s34 offen offset:3072
  s_add_u32 s34, s34, 4096
  buffer_load_dwordx4 v[240:243], v1, s[4:7], s34 offen offset:0
  buffer_load_dwordx4 v[244:247], v1, s[4:7], s34 offen offset:1024
  buffer_load_dwordx4 v[248:251], v1, s[4:7], s34 offen offset:2048
  buffer_load_dwordx4 v[252:255], v1, s[4:7], s34 offen offset:3072
  s_waitcnt vmcnt(20)
  v_and_b32 v30, 7, v0
  v_lshlrev_b32 v30, 3, v30
reca_cens230:
  buffer_load_dwordx2 v[28:29], v30, s[8:11], 0 offen sc1
  s_waitcnt vmcnt(0)
  v_sad_u8 v31, v28, 0, 0
  v_sad_u8 v31, v29, 0, v31
  v_cmp_gt_u32 vcc, 32, v31
  s_cbranch_vccz reca_censok231
  s_sleep 8
  s_sub_u32 s18, s18, 1
  s_cbranch_scc0 reca_cens230
  s_mov_b32 s18, 0
reca_censok231:
  v_and_b32 v28, 0x20202020, v28
  v_and_b32 v29, 0x20202020, v29
  v_cmp_ne_u32 s[34:35], 0, v28
  v_cmp_ne_u32 s[36:37], 0, v29
  s_nop 3
  s_and_b32 s34, s34, 0xff
  s_and_b32 s36, s36, 0xff
  s_or_b32 s35, s34, s36
  s_lshr_b32 s37, s35, s13
  s_and_b32 s37, s37, 1
  s_xor_b32 s43, s37, 1
  s_cmp_eq_u32 s57, 0
  s_cselect_b32 s58, s36, s34
  v_mov_b32 v31, 0x80000000
  s_cmp_lg_u32 s43, 0
  s_cbranch_scc1 reca_pslow232
reca_ptop233:
  s_cmp_lt_u32 s17, 3
  s_cbranch_scc1 reca_pgo234
  s_sub_u32 s36, s17, 3
reca_ppoll235:
  buffer_load_dword v28, v4, s[4:7], s25 offen sc1
  s_waitcnt vmcnt(0)
  v_readfirstlane_b32 s34, v28
  s_nop 3
  s_cmp_ge_i32 s34, s36
  s_cbranch_scc1 reca_pgo234
  s_sleep 8
  s_sub_u32 s18, s18, 1
  s_cbranch_scc0 reca_ppoll235
  s_mov_b32 s18, 0
reca_pgo234:
  s_waitcnt vmcnt(0)
  s_barrier
  v_add_u32 v7, s26, v1
  s_xor_b32 s26, s26, 40960
  s_add_u32 s37, s17, 1
  s_cmp_ge_u32 s37, 64
  s_cbranch_scc1 reca_pnodma236
  s_mul_i32 s20, s37, 40960
  s_add_u32 s20, s20, 84934656
  s_add_u32 m0, s26, 0
  s_nop 0
  buffer_load_dwordx4 v1, s[4:7], s20 offen offset:0 lds
  buffer_load_dwordx4 v1, s[4:7], s20 offen offset:1024 lds
  buffer_load_dwordx4 v1, s[4:7], s20 offen offset:2048 lds
  buffer_load_dwordx4 v1, s[4:7], s20 offen offset:3072 lds
  s_add_u32 s20, s20, 4096
  s_add_u32 m0, s26, 4096
  s_nop 0
  buffer_load_dwordx4 v1, s[4:7], s20 offen offset:0 lds
  buffer_load_dwordx4 v1, s[4:7], s20 offen offset:1024 lds
  buffer_load_dwordx4 v1, s[4:7], s20 offen offset:2048 lds
  buffer_load_dwordx4 v1, s[4:7], s20 offen offset:3072 lds
  s_add_u32 s20, s20, 4096
  s_add_u32 m0, s26, 8192
  s_nop 0
  buffer_load_dwordx4 v1, s[4:7], s20 offen offset:0 lds
  buffer_load_dwordx4 v1, s[4:7], s20 offen offset:1024 lds
reca_pnodma236:
  s_lshl_b32 s34, s15, 3
  s_and_b32 s35, s17, 7
  s_add_u32 s34, s34, s35
  s_mul_i32 s34, s34, 12288
  s_mul_i32 s35, s16, 3072
  s_add_u32 s35, s35, s34
  s_add_u32 s21, s35, 37748736
  s_add_u32 s22, s35, 44040192
  s_mul_i32 s35, s16, 6144
  s_add_u32 s35, s35, s34
  s_add_u32 s23, s35, 40894464
  ds_read_b128 v[72:75], v7 offset:0
  ds_read_b128 v[76:79], v7 offset:20480
  ds_read_b128 v[80:83], v7 offset:1024
  ds_read_b128 v[84:87], v7 offset:21504
  ds_read_b128 v[88:91], v7 offset:2048
  ds_read_b128 v[92:95], v7 offset:22528
  s_waitcnt lgkmcnt(4)
  v_mfma_f32_16x16x32_bf16 v[32:35], a[0:3], v[72:75], 0
  v_mfma_f32_16x16x32_bf16 v[36:39], a[0:3], v[76:79], 0
  v_mfma_f32_16x16x32_bf16 v[40:43], a[80:83], v[72:75], 0
  v_mfma_f32_16x16x32_bf16 v[44:47], a[80:83], v[76:79], 0
  v_mfma_f32_16x16x32_bf16 v[48:51], a[160:163], v[72:75], 0
  v_mfma_f32_16x16x32_bf16 v[52:55], a[160:163], v[76:79], 0
  v_mfma_f32_16x16x32_bf16 v[56:59], v[96:99], v[72:75], 0
  v_mfma_f32_16x16x32_bf16 v[60:63], v[96:99], v[76:79], 0
  v_mfma_f32_16x16x32_bf16 v[64:67], v[72:75], v[176:179], 0
  v_mfma_f32_16x16x32_bf16 v[68:71], v[76:79], v[176:179], 0
  ds_read_b128 v[72:75], v7 offset:3072
  ds_read_b128 v[76:79], v7 offset:23552
  s_waitcnt lgkmcnt(4)
  v_mfma_f32_16x16x32_bf16 v[32:35], a[4:7], v[80:83], v[32:35]
  v_mfma_f32_16x16x32_bf16 v[36:39], a[4:7], v[84:87], v[36:39]
  v_mfma_f32_16x16x32_bf16 v[40:43], a[84:87], v[80:83], v[40:43]
  v_mfma_f32_16x16x32_bf16 v[44:47], a[84:87], v[84:87], v[44:47]
  v_mfma_f32_16x16x32_bf16 v[48:51], a[164:167], v[80:83], v[48:51]
  v_mfma_f32_16x16x32_bf16 v[52:55], a[164:167], v[84:87], v[52:55]
  v_mfma_f32_16x16x32_bf16 v[56:59], v[100:103], v[80:83], v[56:59]
  v_mfma_f32_16x16x32_bf16 v[60:63], v[100:103], v[84:87], v[60:63]
  v_mfma_f32_16x16x32_bf16 v[64:67], v[80:83], v[180:183], v[64:67]
  v_mfma_f32_16x16x32_bf16 v[68:71], v[84:87], v[180:183], v[68:71]
  ds_read_b128 v[80:83], v7 offset:4096
  ds_read_b128 v[84:87], v7 offset:24576
  s_waitcnt lgkmcnt(4)
  v_mfma_f32_16x16x32_bf16 v[32:35], a[8:11], v[88:91], v[32:35]
  v_mfma_f32_16x16x32_bf16 v[36:39], a[8:11], v[92:95], v[36:39]
  v_mfma_f32_16x16x32_bf16 v[40:43], a[88:91], v[88:91], v[40:43]
  v_mfma_f32_16x16x32_bf16 v[44:47], a[88:91], v[92:95], v[44:47]
  v_mfma_f32_16x16x32_bf16 v[48:51], a[168:171], v[88:91], v[48:51]
  v_mfma_f32_16x16x32_bf16 v[52:55], a[168:171], v[92:95], v[52:55]
  v_mfma_f32_16x16x32_bf16 v[56:59], v[104:107], v[88:91], v[56:59]
  v_mfma_f32_16x16x32_bf16 v[60:63], v[104:107], v[92:95], v[60:63]
  v_mfma_f32_16x16x32_bf16 v[64:67], v[88:91], v[184:187], v[64:67]
  v_mfma_f32_16x16x32_bf16 v[68:71], v[92:95], v[184:187], v[68:71]
  ds_read_b128 v[88:91], v7 offset:5120
  ds_read_b128 v[92:95], v7 offset:25600
  s_waitcnt lgkmcnt(4)
  v_mfma_f32_16x16x32_bf16 v[32:35], a[12:15], v[72:75], v[32:35]
  v_mfma_f32_16x16x32_bf16 v[36:39], a[12:15], v[76:79], v[36:39]
  v_mfma_f32_16x16x32_bf16 v[40:43], a[92:95], v[72:75], v[40:43]
  v_mfma_f32_16x16x32_bf16 v[44:47], a[92:95], v[76:79], v[44:47]
  v_mfma_f32_16x16x32_bf16 v[48:51], a[172:175], v[72:75], v[48:51]
  v_mfma_f32_16x16x32_bf16 v[52:55], a[172:175], v[76:79], v[52:55]
  v_mfma_f32_16x16x32_bf16 v[56:59], v[108:111], v[72:75], v[56:59]
  v_mfma_f32_16x16x32_bf16 v[60:63], v[108:111], v[76:79], v[60:63]
  v_mfma_f32_16x16x32_bf16 v[64:67], v[72:75], v[188:191], v[64:67]
  v_mfma_f32_16x16x32_bf16 v[68:71], v[76:79], v[188:191], v[68:71]
  ds_read_b128 v[72:75], v7 offset:6144
  ds_read_b128 v[76:79], v7 offset:26624
  s_waitcnt lgkmcnt(4)
  v_mfma_f32_16x16x32_bf16 v[32:35], a[16:19], v[80:83], v[32:35]
  v_mfma_f32_16x16x32_bf16 v[36:39], a[16:19], v[84:87], v[36:39]
  v_mfma_f32_16x16x32_bf16 v[40:43], a[96:99], v[80:83], v[40:43]
  v_mfma_f32_16x16x32_bf16 v[44:47], a[96:99], v[84:87], v[44:47]
  v_mfma_f32_16x16x32_bf16 v[48:51], a[176:179], v[80:83], v[48:51]
  v_mfma_f32_16x16x32_bf16 v[52:55], a[176:179], v[84:87], v[52:55]
  v_mfma_f32_16x16x32_bf16 v[56:59], v[112:115], v[80:83], v[56:59]
  v_mfma_f32_16x16x32_bf16 v[60:63], v[112:115], v[84:87], v[60:63]
  v_mfma_f32_16x16x32_bf16 v[64:67], v[80:83], v[192:195], v[64:67]
  v_mfma_f32_16x16x32_bf16 v[68:71], v[84:87], v[192:195], v[68:71]
  ds_read_b128 v[80:83], v7 offset:7168
  ds_read_b128 v[84:87], v7 offset:27648
  s_waitcnt lgkmcnt(4)
  v_mfma_f32_16x16x32_bf16 v[32:35], a[20:23], v[88:91], v[32:35]
  v_mfma_f32_16x16x32_bf16 v[36:39], a[20:23], v[92:95], v[36:39]
  v_mfma_f32_16x16x32_bf16 v[40:43], a[100:103], v[88:91], v[40:43]
  v_mfma_f32_16x16x32_bf16 v[44:47], a[100:103], v[92:95], v[44:47]
  v_mfma_f32_16x16x32_bf16 v[48:51], a[180:183], v[88:91], v[48:51]
  v_mfma_f32_16x16x32_bf16 v[52:55], a[180:183], v[92:95], v[52:55]
  v_mfma_f32_16x16x32_bf16 v[56:59], v[116:119], v[88:91], v[56:59]
  v_mfma_f32_16x16x32_bf16 v[60:63], v[116:119], v[92:95], v[60:63]
  v_mfma_f32_16x16x32_bf16 v[64:67], v[88:91], v[196:199], v[64:67]
  v_mfma_f32_16x16x32_bf16 v[68:71], v[92:95], v[196:199], v[68:71]
  ds_read_b128 v[88:91], v7 offset:8192
  ds_read_b128 v[92:95], v7 offset:28672
  s_waitcnt lgkmcnt(4)
  v_mfma_f32_16x16x32_bf16 v[32:35], a[24:27], v[72:75], v[32:35]
  v_mfma_f32_16x16x32_bf16 v[36:39], a[24:27], v[76:79], v[36:39]
  v_mfma_f32_16x16x32_bf16 v[40:43], a[104:107], v[72:75], v[40:43]
  v_mfma_f32_16x16x32_bf16 v[44:47], a[104:107], v[76:79], v[44:47]
  v_mfma_f32_16x16x32_bf16 v[48:51], a[184:187], v[72:75], v[48:51]
  v_mfma_f32_16x16x32_bf16 v[52:55], a[184:187], v[76:79], v[52:55]
  v_mfma_f32_16x16x32_bf16 v[56:59], v[120:123], v[72:75], v[56:59]
  v_mfma_f32_16x16x32_bf16 v[60:63], v[120:123], v[76:79], v[60:63]
  v_mfma_f32_16x16x32_bf16 v[64:67], v[72:75], v[200:203], v[64:67]
  v_mfma_f32_16x16x32_bf16 v[68:71], v[76:79], v[200:203], v[68:71]
  ds_read_b128 v[72:75], v7 offset:9216
  ds_read_b128 v[76:79], v7 offset:29696
  s_waitcnt lgkmcnt(4)
  v_mfma_f32_16x16x32_bf16 v[32:35], a[28:31], v[80:83], v[32:35]
  v_mfma_f32_16x16x32_bf16 v[36:39], a[28:31], v[84:87], v[36:39]
  v_mfma_f32_16x16x32_bf16 v[40:43], a[108:111], v[80:83], v[40:43]
  v_mfma_f32_16x16x32_bf16 v[44:47], a[108:111], v[84:87], v[44:47]
  v_mfma_f32_16x16x32_bf16 v[48:51], a[188:191], v[80:83], v[48:51]
  v_mfma_f32_16x16x32_bf16 v[52:55], a[188:191], v[84:87], v[52:55]
  v_mfma_f32_16x16x32_bf16 v[56:59], v[124:127], v[80:83], v[56:59]
  v_mfma_f32_16x16x32_bf16 v[60:63], v[124:127], v[84:87], v[60:63]
  v_mfma_f32_16x16x32_bf16 v[64:67], v[80:83], v[204:207], v[64:67]
  v_mfma_f32_16x16x32_bf16 v[68:71], v[84:87], v[204:207], v[68:71]
  ds_read_b128 v[80:83], v7 offset:10240
  ds_read_b128 v[84:87], v7 offset:30720
  s_waitcnt lgkmcnt(4)
  v_mfma_f32_16x16x32_bf16 v[32:35], a[32:35], v[88:91], v[32:35]
  v_mfma_f32_16x16x32_bf16 v[36:39], a[32:35], v[92:95], v[36:39]
  v_mfma_f32_16x16x32_bf16 v[40:43], a[112:115], v[88:91], v[40:43]
  v_mfma_f32_16x16x32_bf16 v[44:47], a[112:115], v[92:95], v[44:47]
  v_mfma_f32_16x16x32_bf16 v[48:51], a[192:195], v[88:91], v[48:51]
  v_mfma_f32_16x16x32_bf16 v[52:55], a[192:195], v[92:95], v[52:55]
  v_mfma_f32_16x16x32_bf16 v[56:59], v[128:131], v[88:91], v[56:59]
  v_mfma_f32_16x16x32_bf16 v[60:63], v[128:131], v[92:95], v[60:63]
  v_mfma_f32_16x16x32_bf16 v[64:67], v[88:91], v[208:211], v[64:67]
  v_mfma_f32_16x16x32_bf16 v[68:71], v[92:95], v[208:211], v[68:71]
  ds_read_b128 v[88:91], v7 offset:11264
  ds_read_b128 v[92:95], v7 offset:31744
  s_waitcnt lgkmcnt(4)
  v_mfma_f32_16x16x32_bf16 v[32:35], a[36:39], v[72:75], v[32:35]
  v_mfma_f32_16x16x32_bf16 v[36:39], a[36:39], v[76:79], v[36:39]
  v_mfma_f32_16x16x32_bf16 v[40:43], a[116:119], v[72:75], v[40:43]
  v_mfma_f32_16x16x32_bf16 v[44:47], a[116:119], v[76:79], v[44:47]
  v_mfma_f32_16x16x32_bf16 v[48:51], a[196:199], v[72:75], v[48:51]
  v_mfma_f32_16x16x32_bf16 v[52:55], a[196:199], v[76:79], v[52:55]
  v_mfma_f32_16x16x32_bf16 v[56:59], v[132:135], v[72:75], v[56:59]
  v_mfma_f32_16x16x32_bf16 v[60:63], v[132:135], v[76:79], v[60:63]
  v_mfma_f32_16x16x32_bf16 v[64:67], v[72:75], v[212:215], v[64:67]
  v_mfma_f32_16x16x32_bf16 v[68:71], v[76:79], v[212:215], v[68:71]
  ds_read_b128 v[72:75], v7 offset:12288
  ds_read_b128 v[76:79], v7 offset:32768
  s_waitcnt lgkmcnt(4)
  v_mfma_f32_16x16x32_bf16 v[32:35], a[40:43], v[80:83], v[32:35]
  v_mfma_f32_16x16x32_bf16 v[36:39], a[40:43], v[84:87], v[36:39]
  v_mfma_f32_16x16x32_bf16 v[40:43], a[120:123], v[80:83], v[40:43]
  v_mfma_f32_16x16x32_bf16 v[44:47], a[120:123], v[84:87], v[44:47]
  v_mfma_f32_16x16x32_bf16 v[48:51], a[200:203], v[80:83], v[48:51]
  v_mfma_f32_16x16x32_bf16 v[52:55], a[200:203], v[84:87], v[52:55]
  v_mfma_f32_16x16x32_bf16 v[56:59], v[136:139], v[80:83], v[56:59]
  v_mfma_f32_16x16x32_bf16 v[60:63], v[136:139], v[84:87], v[60:63]
  v_mfma_f32_16x16x32_bf16 v[64:67], v[80:83], v[216:219], v[64:67]
  v_mfma_f32_16x16x32_bf16 v[68:71], v[84:87], v[216:219], v[68:71]
  ds_read_b128 v[80:83], v7 offset:13312
  ds_read_b128 v[84:87], v7 offset:33792
  s_waitcnt lgkmcnt(4)
  v_mfma_f32_16x16x32_bf16 v[32:35], a[44:47], v[88:91], v[32:35]
  v_mfma_f32_16x16x32_bf16 v[36:39], a[44:47], v[92:95], v[36:39]
  v_mfma_f32_16x16x32_bf16 v[40:43], a[124:127], v[88:91], v[40:43]
  v_mfma_f32_16x16x32_bf16 v[44:47], a[124:127], v[92:95], v[44:47]
  v_mfma_f32_16x16x32_bf16 v[48:51], a[204:207], v[88:91], v[48:51]
  v_mfma_f32_16x16x32_bf16 v[52:55], a[204:207], v[92:95], v[52:55]
  v_mfma_f32_16x16x32_bf16 v[56:59], v[140:143], v[88:91], v[56:59]
  v_mfma_f32_16x16x32_bf16 v[60:63], v[140:143], v[92:95], v[60:63]
  v_mfma_f32_16x16x32_bf16 v[64:67], v[88:91], v[220:223], v[64:67]
  v_mfma_f32_16x16x32_bf16 v[68:71], v[92:95], v[220:223], v[68:71]
  ds_read_b128 v[88:91], v7 offset:14336
  ds_read_b128 v[92:95], v7 offset:34816
  s_waitcnt lgkmcnt(4)
  v_mfma_f32_16x16x32_bf16 v[32:35], a[48:51], v[72:75], v[32:35]
  v_mfma_f32_16x16x32_bf16 v[36:39], a[48:51], v[76:79], v[36:39]
  v_mfma_f32_16x16x32_bf16 v[40:43], a[128:131], v[72:75], v[40:43]
  v_mfma_f32_16x16x32_bf16 v[44:47], a[128:131], v[76:79], v[44:47]
  v_mfma_f32_16x16x32_bf16 v[48:51], a[208:211], v[72:75], v[48:51]
  v_mfma_f32_16x16x32_bf16 v[52:55], a[208:211], v[76:79], v[52:55]
  v_mfma_f32_16x16x32_bf16 v[56:59], v[144:147], v[72:75], v[56:59]
  v_mfma_f32_16x16x32_bf16 v[60:63], v[144:147], v[76:79], v[60:63]
  v_mfma_f32_16x16x32_bf16 v[64:67], v[72:75], v[224:227], v[64:67]
  v_mfma_f32_16x16x32_bf16 v[68:71], v[76:79], v[224:227], v[68:71]
  ds_read_b128 v[72:75], v7 offset:15360
  ds_read_b128 v[76:79], v7 offset:35840
  s_waitcnt lgkmcnt(4)
  v_mfma_f32_16x16x32_bf16 v[32:35], a[52:55], v[80:83], v[32:35]
  v_mfma_f32_16x16x32_bf16 v[36:39], a[52:55], v[84:87], v[36:39]
  v_mfma_f32_16x16x32_bf16 v[40:43], a[132:135], v[80:83], v[40:43]
  v_mfma_f32_16x16x32_bf16 v[44:47], a[132:135], v[84:87], v[44:47]
  v_mfma_f32_16x16x32_bf16 v[48:51], a[212:215], v[80:83], v[48:51]
  v_mfma_f32_16x16x32_bf16 v[52:55], a[212:215], v[84:87], v[52:55]
  v_mfma_f32_16x16x32_bf16 v[56:59], v[148:151], v[80:83], v[56:59]
  v_mfma_f32_16x16x32_bf16 v[60:63], v[148:151], v[84:87], v[60:63]
  v_mfma_f32_16x16x32_bf16 v[64:67], v[80:83], v[228:231], v[64:67]
  v_mfma_f32_16x16x32_bf16 v[68:71], v[84:87], v[228:231], v[68:71]
  ds_read_b128 v[80:83], v7 offset:16384
  ds_read_b128 v[84:87], v7 offset:36864
  s_waitcnt lgkmcnt(4)
  v_mfma_f32_16x16x32_bf16 v[32:35], a[56:59], v[88:91], v[32:35]
  v_mfma_f32_16x16x32_bf16 v[36:39], a[56:59], v[92:95], v[36:39]
  v_mfma_f32_16x16x32_bf16 v[40:43], a[136:139], v[88:91], v[40:43]
  v_mfma_f32_16x16x32_bf16 v[44:47], a[136:139], v[92:95], v[44:47]
  v_mfma_f32_16x16x32_bf16 v[48:51], a[216:219], v[88:91], v[48:51]
  v_mfma_f32_16x16x32_bf16 v[52:55], a[216:219], v[92:95], v[52:55]
  v_mfma_f32_16x16x32_bf16 v[56:59], v[152:155], v[88:91], v[56:59]
  v_mfma_f32_16x16x32_bf16 v[60:63], v[152:155], v[92:95], v[60:63]
  v_mfma_f32_16x16x32_bf16 v[64:67], v[88:91], v[232:235], v[64:67]
  v_mfma_f32_16x16x32_bf16 v[68:71], v[92:95], v[232:235], v[68:71]
  ds_read_b128 v[88:91], v7 offset:17408
  ds_read_b128 v[92:95], v7 offset:37888
  s_waitcnt lgkmcnt(4)
  v_mfma_f32_16x16x32_bf16 v[32:35], a[60:63], v[72:75], v[32:35]
  v_mfma_f32_16x16x32_bf16 v[36:39], a[60:63], v[76:79], v[36:39]
  v_mfma_f32_16x16x32_bf16 v[40:43], a[140:143], v[72:75], v[40:43]
  v_mfma_f32_16x16x32_bf16 v[44:47], a[140:143], v[76:79], v[44:47]
  v_mfma_f32_16x16x32_bf16 v[48:51], a[220:223], v[72:75], v[48:51]
  v_mfma_f32_16x16x32_bf16 v[52:55], a[220:223], v[76:79], v[52:55]
  v_mfma_f32_16x16x32_bf16 v[56:59], v[156:159], v[72:75], v[56:59]
  v_mfma_f32_16x16x32_bf16 v[60:63], v[156:159], v[76:79], v[60:63]
  v_mfma_f32_16x16x32_bf16 v[64:67], v[72:75], v[236:239], v[64:67]
  v_mfma_f32_16x16x32_bf16 v[68:71], v[76:79], v[236:239], v[68:71]
  ds_read_b128 v[72:75], v7 offset:18432
  ds_read_b128 v[76:79], v7 offset:38912
  s_waitcnt lgkmcnt(4)
  v_mfma_f32_16x16x32_bf16 v[32:35], a[64:67], v[80:83], v[32:35]
  v_mfma_f32_16x16x32_bf16 v[36:39], a[64:67], v[84:87], v[36:39]
  v_mfma_f32_16x16x32_bf16 v[40:43], a[144:147], v[80:83], v[40:43]
  v_mfma_f32_16x16x32_bf16 v[44:47], a[144:147], v[84:87], v[44:47]
  v_mfma_f32_16x16x32_bf16 v[48:51], a[224:227], v[80:83], v[48:51]
  v_mfma_f32_16x16x32_bf16 v[52:55], a[224:227], v[84:87], v[52:55]
  v_mfma_f32_16x16x32_bf16 v[56:59], v[160:163], v[80:83], v[56:59]
  v_mfma_f32_16x16x32_bf16 v[60:63], v[160:163], v[84:87], v[60:63]
  v_mfma_f32_16x16x32_bf16 v[64:67], v[80:83], v[240:243], v[64:67]
  v_mfma_f32_16x16x32_bf16 v[68:71], v[84:87], v[240:243], v[68:71]
  ds_read_b128 v[80:83], v7 offset:19456
  ds_read_b128 v[84:87], v7 offset:39936
  s_waitcnt lgkmcnt(4)
  v_mfma_f32_16x16x32_bf16 v[32:35], a[68:71], v[88:91], v[32:35]
  v_mfma_f32_16x16x32_bf16 v[36:39], a[68:71], v[92:95], v[36:39]
  v_mfma_f32_16x16x32_bf16 v[40:43], a[148:151], v[88:91], v[40:43]
  v_mfma_f32_16x16x32_bf16 v[44:47], a[148:151], v[92:95], v[44:47]
  v_mfma_f32_16x16x32_bf16 v[48:51], a[228:231], v[88:91], v[48:51]
  v_mfma_f32_16x16x32_bf16 v[52:55], a[228:231], v[92:95], v[52:55]
  v_mfma_f32_16x16x32_bf16 v[56:59], v[164:167], v[88:91], v[56:59]
  v_mfma_f32_16x16x32_bf16 v[60:63], v[164:167], v[92:95], v[60:63]
  v_mfma_f32_16x16x32_bf16 v[64:67], v[88:91], v[244:247], v[64:67]
  v_mfma_f32_16x16x32_bf16 v[68:71], v[92:95], v[244:247], v[68:71]
  s_waitcnt lgkmcnt(2)
  v_mfma_f32_16x16x32_bf16 v[32:35], a[72:75], v[72:75], v[32:35]
  v_mfma_f32_16x16x32_bf16 v[36:39], a[72:75], v[76:79], v[36:39]
  v_mfma_f32_16x16x32_bf16 v[40:43], a[152:155], v[72:75], v[40:43]
  v_mfma_f32_16x16x32_bf16 v[44:47], a[152:155], v[76:79], v[44:47]
  v_mfma_f32_16x16x32_bf16 v[48:51], a[232:235], v[72:75], v[48:51]
  v_mfma_f32_16x16x32_bf16 v[52:55], a[232:235], v[76:79], v[52:55]
  v_mfma_f32_16x16x32_bf16 v[56:59], v[168:171], v[72:75], v[56:59]
  v_mfma_f32_16x16x32_bf16 v[60:63], v[168:171], v[76:79], v[60:63]
  v_mfma_f32_16x16x32_bf16 v[64:67], v[72:75], v[248:251], v[64:67]
  v_mfma_f32_16x16x32_bf16 v[68:71], v[76:79], v[248:251], v[68:71]
  s_waitcnt lgkmcnt(0)
  v_mfma_f32_16x16x32_bf16 v[32:35], a[76:79], v[80:83], v[32:35]
  v_mfma_f32_16x16x32_bf16 v[36:39], a[76:79], v[84:87], v[36:39]
  v_mfma_f32_16x16x32_bf16 v[40:43], a[156:159], v[80:83], v[40:43]
  v_mfma_f32_16x16x32_bf16 v[44:47], a[156:159], v[84:87], v[44:47]
  v_mfma_f32_16x16x32_bf16 v[48:51], a[236:239], v[80:83], v[48:51]
  v_mfma_f32_16x16x32_bf16 v[52:55], a[236:239], v[84:87], v[52:55]
  v_mfma_f32_16x16x32_bf16 v[56:59], v[172:175], v[80:83], v[56:59]
  v_mfma_f32_16x16x32_bf16 v[60:63], v[172:175], v[84:87], v[60:63]
  v_mfma_f32_16x16x32_bf16 v[64:67], v[80:83], v[252:255], v[64:67]
  v_mfma_f32_16x16x32_bf16 v[68:71], v[84:87], v[252:255], v[68:71]
  v_cvt_pk_bf16_f32 v8, v32, v33
  v_cvt_pk_bf16_f32 v9, v34, v35
  v_cvt_pk_bf16_f32 v10, v40, v41
  v_cvt_pk_bf16_f32 v11, v42, v43
  s_add_u32 s34, s21, 0
  buffer_store_dwordx4 v[8:11], v1, s[4:7], s34 offen
  v_cvt_pk_bf16_f32 v12, v36, v37
  v_cvt_pk_bf16_f32 v13, v38, v39
  v_cvt_pk_bf16_f32 v14, v44, v45
  v_cvt_pk_bf16_f32 v15, v46, v47
  s_add_u32 s34, s21, 6144
  buffer_store_dwordx4 v[12:15], v1, s[4:7], s34 offen
  v_cvt_pk_bf16_f32 v8, v48, v49
  v_cvt_pk_bf16_f32 v9, v50, v51
  v_cvt_pk_bf16_f32 v10, v56, v57
  v_cvt_pk_bf16_f32 v11, v58, v59
  s_add_u32 s34, s21, 1024
  buffer_store_dwordx4 v[8:11], v1, s[4:7], s34 offen
  v_cvt_pk_bf16_f32 v12, v52, v53
  v_cvt_pk_bf16_f32 v13, v54, v55
  v_cvt_pk_bf16_f32 v14, v60, v61
  v_cvt_pk_bf16_f32 v15, v62, v63
  s_add_u32 s34, s21, 7168
  buffer_store_dwordx4 v[12:15], v1, s[4:7], s34 offen
  v_cvt_pk_bf16_f32 v8, v64, v65
  v_cvt_pk_bf16_f32 v9, v66, v67
  v_cvt_pk_bf16_f32 v10, v68, v69
  v_cvt_pk_bf16_f32 v11, v70, v71
  s_add_u32 s34, s23, 0
  buffer_store_dwordx4 v[8:11], v1, s[4:7], s34 offen
  s_waitcnt vmcnt(0)
  s_barrier
  s_add_u32 s17, s17, 1
  v_mov_b32 v28, s17
  buffer_store_dword v28, v4, s[4:7], s24 offen
  s_cmp_lt_u32 s17, 64
  s_cbranch_scc1 reca_ptop233
  s_branch reca_exit1
reca_pslow232:
reca_ptop238:
  s_cmp_lt_u32 s17, 3
  s_cbranch_scc1 reca_pgo239
  s_sub_u32 s36, s17, 3
reca_ppoll240:
  buffer_load_dword v28, v4, s[4:7], s25 offen sc1
  s_waitcnt vmcnt(0)
  v_readfirstlane_b32 s34, v28
  s_nop 3
  s_cmp_ge_i32 s34, s36
  s_cbranch_scc1 reca_pgo239
  s_sleep 8
  s_sub_u32 s18, s18, 1
  s_cbranch_scc0 reca_ppoll240
  s_mov_b32 s18, 0
reca_pgo239:
  s_waitcnt vmcnt(0)
  s_barrier
  v_add_u32 v7, s26, v1
  s_xor_b32 s26, s26, 40960
  s_add_u32 s37, s17, 1
  s_cmp_ge_u32 s37, 64
  s_cbranch_scc1 reca_pnodma241
  s_mul_i32 s20, s37, 40960
  s_add_u32 s20, s20, 84934656
  s_add_u32 m0, s26, 0
  s_nop 0
  buffer_load_dwordx4 v1, s[4:7], s20 offen offset:0 lds
  buffer_load_dwordx4 v1, s[4:7], s20 offen offset:1024 lds
  buffer_load_dwordx4 v1, s[4:7], s20 offen offset:2048 lds
  buffer_load_dwordx4 v1, s[4:7], s20 offen offset:3072 lds
  s_add_u32 s20, s20, 4096
  s_add_u32 m0, s26, 4096
  s_nop 0
  buffer_load_dwordx4 v1, s[4:7], s20 offen offset:0 lds
  buffer_load_dwordx4 v1, s[4:7], s20 offen offset:1024 lds
  buffer_load_dwordx4 v1, s[4:7], s20 offen offset:2048 lds
  buffer_load_dwordx4 v1, s[4:7], s20 offen offset:3072 lds
  s_add_u32 s20, s20, 4096
  s_add_u32 m0, s26, 8192
  s_nop 0
  buffer_load_dwordx4 v1, s[4:7], s20 offen offset:0 lds
  buffer_load_dwordx4 v1, s[4:7], s20 offen offset:1024 lds
reca_pnodma241:
  s_lshl_b32 s34, s15, 3
  s_and_b32 s35, s17, 7
  s_add_u32 s34, s34, s35
  s_mul_i32 s34, s34, 12288
  s_mul_i32 s35, s16, 3072
  s_add_u32 s35, s35, s34
  s_add_u32 s21, s35, 37748736
  s_add_u32 s22, s35, 44040192
  s_mul_i32 s35, s16, 6144
  s_add_u32 s35, s35, s34
  s_add_u32 s23, s35, 40894464
  ds_read_b128 v[72:75], v7 offset:0
  ds_read_b128 v[76:79], v7 offset:20480
  ds_read_b128 v[80:83], v7 offset:1024
  ds_read_b128 v[84:87], v7 offset:21504
  ds_read_b128 v[88:91], v7 offset:2048
  ds_read_b128 v[92:95], v7 offset:22528
  s_waitcnt lgkmcnt(4)
  v_mfma_f32_16x16x32_bf16 v[32:35], a[0:3], v[72:75], 0
  v_mfma_f32_16x16x32_bf16 v[36:39], a[0:3], v[76:79], 0
  v_mfma_f32_16x16x32_bf16 v[40:43], a[80:83], v[72:75], 0
  v_mfma_f32_16x16x32_bf16 v[44:47], a[80:83], v[76:79], 0
  v_mfma_f32_16x16x32_bf16 v[48:51], a[160:163], v[72:75], 0
  v_mfma_f32_16x16x32_bf16 v[52:55], a[160:163], v[76:79], 0
  v_mfma_f32_16x16x32_bf16 v[56:59], v[96:99], v[72:75], 0
  v_mfma_f32_16x16x32_bf16 v[60:63], v[96:99], v[76:79], 0
  v_mfma_f32_16x16x32_bf16 v[64:67], v[72:75], v[176:179], 0
  v_mfma_f32_16x16x32_bf16 v[68:71], v[76:79], v[176:179], 0
  ds_read_b128 v[72:75], v7 offset:3072
  ds_read_b128 v[76:79], v7 offset:23552
  s_waitcnt lgkmcnt(4)
  v_mfma_f32_16x16x32_bf16 v[32:35], a[4:7], v[80:83], v[32:35]
  v_mfma_f32_16x16x32_bf16 v[36:39], a[4:7], v[84:87], v[36:39]
  v_mfma_f32_16x16x32_bf16 v[40:43], a[84:87], v[80:83], v[40:43]
  v_mfma_f32_16x16x32_bf16 v[44:47], a[84:87], v[84:87], v[44:47]
  v_mfma_f32_16x16x32_bf16 v[48:51], a[164:167], v[80:83], v[48:51]
  v_mfma_f32_16x16x32_bf16 v[52:55], a[164:167], v[84:87], v[52:55]
  v_mfma_f32_16x16x32_bf16 v[56:59], v[100:103], v[80:83], v[56:59]
  v_mfma_f32_16x16x32_bf16 v[60:63], v[100:103], v[84:87], v[60:63]
  v_mfma_f32_16x16x32_bf16 v[64:67], v[80:83], v[180:183], v[64:67]
  v_mfma_f32_16x16x32_bf16 v[68:71], v[84:87], v[180:183], v[68:71]
  ds_read_b128 v[80:83], v7 offset:4096
  ds_read_b128 v[84:87], v7 offset:24576
  s_waitcnt lgkmcnt(4)
  v_mfma_f32_16x16x32_bf16 v[32:35], a[8:11], v[88:91], v[32:35]
  v_mfma_f32_16x16x32_bf16 v[36:39], a[8:11], v[92:95], v[36:39]
  v_mfma_f32_16x16x32_bf16 v[40:43], a[88:91], v[88:91], v[40:43]
  v_mfma_f32_16x16x32_bf16 v[44:47], a[88:91], v[92:95], v[44:47]
  v_mfma_f32_16x16x32_bf16 v[48:51], a[168:171], v[88:91], v[48:51]
  v_mfma_f32_16x16x32_bf16 v[52:55], a[168:171], v[92:95], v[52:55]
  v_mfma_f32_16x16x32_bf16 v[56:59], v[104:107], v[88:91], v[56:59]
  v_mfma_f32_16x16x32_bf16 v[60:63], v[104:107], v[92:95], v[60:63]
  v_mfma_f32_16x16x32_bf16 v[64:67], v[88:91], v[184:187], v[64:67]
  v_mfma_f32_16x16x32_bf16 v[68:71], v[92:95], v[184:187], v[68:71]
  ds_read_b128 v[88:91], v7 offset:5120
  ds_read_b128 v[92:95], v7 offset:25600
  s_waitcnt lgkmcnt(4)
  v_mfma_f32_16x16x32_bf16 v[32:35], a[12:15], v[72:75], v[32:35]
  v_mfma_f32_16x16x32_bf16 v[36:39], a[12:15], v[76:79], v[36:39]
  v_mfma_f32_16x16x32_bf16 v[40:43], a[92:95], v[72:75], v[40:43]
  v_mfma_f32_16x16x32_bf16 v[44:47], a[92:95], v[76:79], v[44:47]
  v_mfma_f32_16x16x32_bf16 v[48:51], a[172:175], v[72:75], v[48:51]
  v_mfma_f32_16x16x32_bf16 v[52:55], a[172:175], v[76:79], v[52:55]
  v_mfma_f32_16x16x32_bf16 v[56:59], v[108:111], v[72:75], v[56:59]
  v_mfma_f32_16x16x32_bf16 v[60:63], v[108:111], v[76:79], v[60:63]
  v_mfma_f32_16x16x32_bf16 v[64:67], v[72:75], v[188:191], v[64:67]
  v_mfma_f32_16x16x32_bf16 v[68:71], v[76:79], v[188:191], v[68:71]
  ds_read_b128 v[72:75], v7 offset:6144
  ds_read_b128 v[76:79], v7 offset:26624
  s_waitcnt lgkmcnt(4)
  v_mfma_f32_16x16x32_bf16 v[32:35], a[16:19], v[80:83], v[32:35]
  v_mfma_f32_16x16x32_bf16 v[36:39], a[16:19], v[84:87], v[36:39]
  v_mfma_f32_16x16x32_bf16 v[40:43], a[96:99], v[80:83], v[40:43]
  v_mfma_f32_16x16x32_bf16 v[44:47], a[96:99], v[84:87], v[44:47]
  v_mfma_f32_16x16x32_bf16 v[48:51], a[176:179], v[80:83], v[48:51]
  v_mfma_f32_16x16x32_bf16 v[52:55], a[176:179], v[84:87], v[52:55]
  v_mfma_f32_16x16x32_bf16 v[56:59], v[112:115], v[80:83], v[56:59]
  v_mfma_f32_16x16x32_bf16 v[60:63], v[112:115], v[84:87], v[60:63]
  v_mfma_f32_16x16x32_bf16 v[64:67], v[80:83], v[192:195], v[64:67]
  v_mfma_f32_16x16x32_bf16 v[68:71], v[84:87], v[192:195], v[68:71]
  ds_read_b128 v[80:83], v7 offset:7168
  ds_read_b128 v[84:87], v7 offset:27648
  s_waitcnt lgkmcnt(4)
  v_mfma_f32_16x16x32_bf16 v[32:35], a[20:23], v[88:91], v[32:35]
  v_mfma_f32_16x16x32_bf16 v[36:39], a[20:23], v[92:95], v[36:39]
  v_mfma_f32_16x16x32_bf16 v[40:43], a[100:103], v[88:91], v[40:43]
  v_mfma_f32_16x16x32_bf16 v[44:47], a[100:103], v[92:95], v[44:47]
  v_mfma_f32_16x16x32_bf16 v[48:51], a[180:183], v[88:91], v[48:51]
  v_mfma_f32_16x16x32_bf16 v[52:55], a[180:183], v[92:95], v[52:55]
  v_mfma_f32_16x16x32_bf16 v[56:59], v[116:119], v[88:91], v[56:59]
  v_mfma_f32_16x16x32_bf16 v[60:63], v[116:119], v[92:95], v[60:63]
  v_mfma_f32_16x16x32_bf16 v[64:67], v[88:91], v[196:199], v[64:67]
  v_mfma_f32_16x16x32_bf16 v[68:71], v[92:95], v[196:199], v[68:71]
  ds_read_b128 v[88:91], v7 offset:8192
  ds_read_b128 v[92:95], v7 offset:28672
  s_waitcnt lgkmcnt(4)
  v_mfma_f32_16x16x32_bf16 v[32:35], a[24:27], v[72:75], v[32:35]
  v_mfma_f32_16x16x32_bf16 v[36:39], a[24:27], v[76:79], v[36:39]
  v_mfma_f32_16x16x32_bf16 v[40:43], a[104:107], v[72:75], v[40:43]
  v_mfma_f32_16x16x32_bf16 v[44:47], a[104:107], v[76:79], v[44:47]
  v_mfma_f32_16x16x32_bf16 v[48:51], a[184:187], v[72:75], v[48:51]
  v_mfma_f32_16x16x32_bf16 v[52:55], a[184:187], v[76:79], v[52:55]
  v_mfma_f32_16x16x32_bf16 v[56:59], v[120:123], v[72:75], v[56:59]
  v_mfma_f32_16x16x32_bf16 v[60:63], v[120:123], v[76:79], v[60:63]
  v_mfma_f32_16x16x32_bf16 v[64:67], v[72:75], v[200:203], v[64:67]
  v_mfma_f32_16x16x32_bf16 v[68:71], v[76:79], v[200:203], v[68:71]
  ds_read_b128 v[72:75], v7 offset:9216
  ds_read_b128 v[76:79], v7 offset:29696
  s_waitcnt lgkmcnt(4)
  v_mfma_f32_16x16x32_bf16 v[32:35], a[28:31], v[80:83], v[32:35]
  v_mfma_f32_16x16x32_bf16 v[36:39], a[28:31], v[84:87], v[36:39]
  v_mfma_f32_16x16x32_bf16 v[40:43], a[108:111], v[80:83], v[40:43]
  v_mfma_f32_16x16x32_bf16 v[44:47], a[108:111], v[84:87], v[44:47]
  v_mfma_f32_16x16x32_bf16 v[48:51], a[188:191], v[80:83], v[48:51]
  v_mfma_f32_16x16x32_bf16 v[52:55], a[188:191], v[84:87], v[52:55]
  v_mfma_f32_16x16x32_bf16 v[56:59], v[124:127], v[80:83], v[56:59]
  v_mfma_f32_16x16x32_bf16 v[60:63], v[124:127], v[84:87], v[60:63]
  v_mfma_f32_16x16x32_bf16 v[64:67], v[80:83], v[204:207], v[64:67]
  v_mfma_f32_16x16x32_bf16 v[68:71], v[84:87], v[204:207], v[68:71]
  ds_read_b128 v[80:83], v7 offset:10240
  ds_read_b128 v[84:87], v7 offset:30720
  s_waitcnt lgkmcnt(4)
  v_mfma_f32_16x16x32_bf16 v[32:35], a[32:35], v[88:91], v[32:35]
  v_mfma_f32_16x16x32_bf16 v[36:39], a[32:35], v[92:95], v[36:39]
  v_mfma_f32_16x16x32_bf16 v[40:43], a[112:115], v[88:91], v[40:43]
  v_mfma_f32_16x16x32_bf16 v[44:47], a[112:115], v[92:95], v[44:47]
  v_mfma_f32_16x16x32_bf16 v[48:51], a[192:195], v[88:91], v[48:51]
  v_mfma_f32_16x16x32_bf16 v[52:55], a[192:195], v[92:95], v[52:55]
  v_mfma_f32_16x16x32_bf16 v[56:59], v[128:131], v[88:91], v[56:59]
  v_mfma_f32_16x16x32_bf16 v[60:63], v[128:131], v[92:95], v[60:63]
  v_mfma_f32_16x16x32_bf16 v[64:67], v[88:91], v[208:211], v[64:67]
  v_mfma_f32_16x16x32_bf16 v[68:71], v[92:95], v[208:211], v[68:71]
  ds_read_b128 v[88:91], v7 offset:11264
  ds_read_b128 v[92:95], v7 offset:31744
  s_waitcnt lgkmcnt(4)
  v_mfma_f32_16x16x32_bf16 v[32:35], a[36:39], v[72:75], v[32:35]
  v_mfma_f32_16x16x32_bf16 v[36:39], a[36:39], v[76:79], v[36:39]
  v_mfma_f32_16x16x32_bf16 v[40:43], a[116:119], v[72:75], v[40:43]
  v_mfma_f32_16x16x32_bf16 v[44:47], a[116:119], v[76:79], v[44:47]
  v_mfma_f32_16x16x32_bf16 v[48:51], a[196:199], v[72:75], v[48:51]
  v_mfma_f32_16x16x32_bf16 v[52:55], a[196:199], v[76:79], v[52:55]
  v_mfma_f32_16x16x32_bf16 v[56:59], v[132:135], v[72:75], v[56:59]
  v_mfma_f32_16x16x32_bf16 v[60:63], v[132:135], v[76:79], v[60:63]
  v_mfma_f32_16x16x32_bf16 v[64:67], v[72:75], v[212:215], v[64:67]
  v_mfma_f32_16x16x32_bf16 v[68:71], v[76:79], v[212:215], v[68:71]
  ds_read_b128 v[72:75], v7 offset:12288
  ds_read_b128 v[76:79], v7 offset:32768
  s_waitcnt lgkmcnt(4)
  v_mfma_f32_16x16x32_bf16 v[32:35], a[40:43], v[80:83], v[32:35]
  v_mfma_f32_16x16x32_bf16 v[36:39], a[40:43], v[84:87], v[36:39]
  v_mfma_f32_16x16x32_bf16 v[40:43], a[120:123], v[80:83], v[40:43]
  v_mfma_f32_16x16x32_bf16 v[44:47], a[120:123], v[84:87], v[44:47]
  v_mfma_f32_16x16x32_bf16 v[48:51], a[200:203], v[80:83], v[48:51]
  v_mfma_f32_16x16x32_bf16 v[52:55], a[200:203], v[84:87], v[52:55]
  v_mfma_f32_16x16x32_bf16 v[56:59], v[136:139], v[80:83], v[56:59]
  v_mfma_f32_16x16x32_bf16 v[60:63], v[136:139], v[84:87], v[60:63]
  v_mfma_f32_16x16x32_bf16 v[64:67], v[80:83], v[216:219], v[64:67]
  v_mfma_f32_16x16x32_bf16 v[68:71], v[84:87], v[216:219], v[68:71]
  ds_read_b128 v[80:83], v7 offset:13312
  ds_read_b128 v[84:87], v7 offset:33792
  s_waitcnt lgkmcnt(4)
  v_mfma_f32_16x16x32_bf16 v[32:35], a[44:47], v[88:91], v[32:35]
  v_mfma_f32_16x16x32_bf16 v[36:39], a[44:47], v[92:95], v[36:39]
  v_mfma_f32_16x16x32_bf16 v[40:43], a[124:127], v[88:91], v[40:43]
  v_mfma_f32_16x16x32_bf16 v[44:47], a[124:127], v[92:95], v[44:47]
  v_mfma_f32_16x16x32_bf16 v[48:51], a[204:207], v[88:91], v[48:51]
  v_mfma_f32_16x16x32_bf16 v[52:55], a[204:207], v[92:95], v[52:55]
  v_mfma_f32_16x16x32_bf16 v[56:59], v[140:143], v[88:91], v[56:59]
  v_mfma_f32_16x16x32_bf16 v[60:63], v[140:143], v[92:95], v[60:63]
  v_mfma_f32_16x16x32_bf16 v[64:67], v[88:91], v[220:223], v[64:67]
  v_mfma_f32_16x16x32_bf16 v[68:71], v[92:95], v[220:223], v[68:71]
  ds_read_b128 v[88:91], v7 offset:14336
  ds_read_b128 v[92:95], v7 offset:34816
  s_waitcnt lgkmcnt(4)
  v_mfma_f32_16x16x32_bf16 v[32:35], a[48:51], v[72:75], v[32:35]
  v_mfma_f32_16x16x32_bf16 v[36:39], a[48:51], v[76:79], v[36:39]
  v_mfma_f32_16x16x32_bf16 v[40:43], a[128:131], v[72:75], v[40:43]
  v_mfma_f32_16x16x32_bf16 v[44:47], a[128:131], v[76:79], v[44:47]
  v_mfma_f32_16x16x32_bf16 v[48:51], a[208:211], v[72:75], v[48:51]
  v_mfma_f32_16x16x32_bf16 v[52:55], a[208:211], v[76:79], v[52:55]
  v_mfma_f32_16x16x32_bf16 v[56:59], v[144:147], v[72:75], v[56:59]
  v_mfma_f32_16x16x32_bf16 v[60:63], v[144:147], v[76:79], v[60:63]
  v_mfma_f32_16x16x32_bf16 v[64:67], v[72:75], v[224:227], v[64:67]
  v_mfma_f32_16x16x32_bf16 v[68:71], v[76:79], v[224:227], v[68:71]
  ds_read_b128 v[72:75], v7 offset:15360
  ds_read_b128 v[76:79], v7 offset:35840
  s_waitcnt lgkmcnt(4)
  v_mfma_f32_16x16x32_bf16 v[32:35], a[52:55], v[80:83], v[32:35]
  v_mfma_f32_16x16x32_bf16 v[36:39], a[52:55], v[84:87], v[36:39]
  v_mfma_f32_16x16x32_bf16 v[40:43], a[132:135], v[80:83], v[40:43]
  v_mfma_f32_16x16x32_bf16 v[44:47], a[132:135], v[84:87], v[44:47]
  v_mfma_f32_16x16x32_bf16 v[48:51], a[212:215], v[80:83], v[48:51]
  v_mfma_f32_16x16x32_bf16 v[52:55], a[212:215], v[84:87], v[52:55]
  v_mfma_f32_16x16x32_bf16 v[56:59], v[148:151], v[80:83], v[56:59]
  v_mfma_f32_16x16x32_bf16 v[60:63], v[148:151], v[84:87], v[60:63]
  v_mfma_f32_16x16x32_bf16 v[64:67], v[80:83], v[228:231], v[64:67]
  v_mfma_f32_16x16x32_bf16 v[68:71], v[84:87], v[228:231], v[68:71]
  ds_read_b128 v[80:83], v7 offset:16384
  ds_read_b128 v[84:87], v7 offset:36864
  s_waitcnt lgkmcnt(4)
  v_mfma_f32_16x16x32_bf16 v[32:35], a[56:59], v[88:91], v[32:35]
  v_mfma_f32_16x16x32_bf16 v[36:39], a[56:59], v[92:95], v[36:39]
  v_mfma_f32_16x16x32_bf16 v[40:43], a[136:139], v[88:91], v[40:43]
  v_mfma_f32_16x16x32_bf16 v[44:47], a[136:139], v[92:95], v[44:47]
  v_mfma_f32_16x16x32_bf16 v[48:51], a[216:219], v[88:91], v[48:51]
  v_mfma_f32_16x16x32_bf16 v[52:55], a[216:219], v[92:95], v[52:55]
  v_mfma_f32_16x16x32_bf16 v[56:59], v[152:155], v[88:91], v[56:59]
  v_mfma_f32_16x16x32_bf16 v[60:63], v[152:155], v[92:95], v[60:63]
  v_mfma_f32_16x16x32_bf16 v[64:67], v[88:91], v[232:235], v[64:67]
  v_mfma_f32_16x16x32_bf16 v[68:71], v[92:95], v[232:235], v[68:71]
  ds_read_b128 v[88:91], v7 offset:17408
  ds_read_b128 v[92:95], v7 offset:37888
  s_waitcnt lgkmcnt(4)
  v_mfma_f32_16x16x32_bf16 v[32:35], a[60:63], v[72:75], v[32:35]
  v_mfma_f32_16x16x32_bf16 v[36:39], a[60:63], v[76:79], v[36:39]
  v_mfma_f32_16x16x32_bf16 v[40:43], a[140:143], v[72:75], v[40:43]
  v_mfma_f32_16x16x32_bf16 v[44:47], a[140:143], v[76:79], v[44:47]
  v_mfma_f32_16x16x32_bf16 v[48:51], a[220:223], v[72:75], v[48:51]
  v_mfma_f32_16x16x32_bf16 v[52:55], a[220:223], v[76:79], v[52:55]
  v_mfma_f32_16x16x32_bf16 v[56:59], v[156:159], v[72:75], v[56:59]
  v_mfma_f32_16x16x32_bf16 v[60:63], v[156:159], v[76:79], v[60:63]
  v_mfma_f32_16x16x32_bf16 v[64:67], v[72:75], v[236:239], v[64:67]
  v_mfma_f32_16x16x32_bf16 v[68:71], v[76:79], v[236:239], v[68:71]
  ds_read_b128 v[72:75], v7 offset:18432
  ds_read_b128 v[76:79], v7 offset:38912
  s_waitcnt lgkmcnt(4)
  v_mfma_f32_16x16x32_bf16 v[32:35], a[64:67], v[80:83], v[32:35]
  v_mfma_f32_16x16x32_bf16 v[36:39], a[64:67], v[84:87], v[36:39]
  v_mfma_f32_16x16x32_bf16 v[40:43], a[144:147], v[80:83], v[40:43]
  v_mfma_f32_16x16x32_bf16 v[44:47], a[144:147], v[84:87], v[44:47]
  v_mfma_f32_16x16x32_bf16 v[48:51], a[224:227], v[80:83], v[48:51]
  v_mfma_f32_16x16x32_bf16 v[52:55], a[224:227], v[84:87], v[52:55]
  v_mfma_f32_16x16x32_bf16 v[56:59], v[160:163], v[80:83], v[56:59]
  v_mfma_f32_16x16x32_bf16 v[60:63], v[160:163], v[84:87], v[60:63]
  v_mfma_f32_16x16x32_bf16 v[64:67], v[80:83], v[240:243], v[64:67]
  v_mfma_f32_16x16x32_bf16 v[68:71], v[84:87], v[240:243], v[68:71]
  ds_read_b128 v[80:83], v7 offset:19456
  ds_read_b128 v[84:87], v7 offset:39936
  s_waitcnt lgkmcnt(4)
  v_mfma_f32_16x16x32_bf16 v[32:35], a[68:71], v[88:91], v[32:35]
  v_mfma_f32_16x16x32_bf16 v[36:39], a[68:71], v[92:95], v[36:39]
  v_mfma_f32_16x16x32_bf16 v[40:43], a[148:151], v[88:91], v[40:43]
  v_mfma_f32_16x16x32_bf16 v[44:47], a[148:151], v[92:95], v[44:47]
  v_mfma_f32_16x16x32_bf16 v[48:51], a[228:231], v[88:91], v[48:51]
  v_mfma_f32_16x16x32_bf16 v[52:55], a[228:231], v[92:95], v[52:55]
  v_mfma_f32_16x16x32_bf16 v[56:59], v[164:167], v[88:91], v[56:59]
  v_mfma_f32_16x16x32_bf16 v[60:63], v[164:167], v[92:95], v[60:63]
  v_mfma_f32_16x16x32_bf16 v[64:67], v[88:91], v[244:247], v[64:67]
  v_mfma_f32_16x16x32_bf16 v[68:71], v[92:95], v[244:247], v[68:71]
  s_waitcnt lgkmcnt(2)
  v_mfma_f32_16x16x32_bf16 v[32:35], a[72:75], v[72:75], v[32:35]
  v_mfma_f32_16x16x32_bf16 v[36:39], a[72:75], v[76:79], v[36:39]
  v_mfma_f32_16x16x32_bf16 v[40:43], a[152:155], v[72:75], v[40:43]
  v_mfma_f32_16x16x32_bf16 v[44:47], a[152:155], v[76:79], v[44:47]
  v_mfma_f32_16x16x32_bf16 v[48:51], a[232:235], v[72:75], v[48:51]
  v_mfma_f32_16x16x32_bf16 v[52:55], a[232:235], v[76:79], v[52:55]
  v_mfma_f32_16x16x32_bf16 v[56:59], v[168:171], v[72:75], v[56:59]
  v_mfma_f32_16x16x32_bf16 v[60:63], v[168:171], v[76:79], v[60:63]
  v_mfma_f32_16x16x32_bf16 v[64:67], v[72:75], v[248:251], v[64:67]
  v_mfma_f32_16x16x32_bf16 v[68:71], v[76:79], v[248:251], v[68:71]
  s_waitcnt lgkmcnt(0)
  v_mfma_f32_16x16x32_bf16 v[32:35], a[76:79], v[80:83], v[32:35]
  v_mfma_f32_16x16x32_bf16 v[36:39], a[76:79], v[84:87], v[36:39]
  v_mfma_f32_16x16x32_bf16 v[40:43], a[156:159], v[80:83], v[40:43]
  v_mfma_f32_16x16x32_bf16 v[44:47], a[156:159], v[84:87], v[44:47]
  v_mfma_f32_16x16x32_bf16 v[48:51], a[236:239], v[80:83], v[48:51]
  v_mfma_f32_16x16x32_bf16 v[52:55], a[236:239], v[84:87], v[52:55]
  v_mfma_f32_16x16x32_bf16 v[56:59], v[172:175], v[80:83], v[56:59]
  v_mfma_f32_16x16x32_bf16 v[60:63], v[172:175], v[84:87], v[60:63]
  v_mfma_f32_16x16x32_bf16 v[64:67], v[80:83], v[252:255], v[64:67]
  v_mfma_f32_16x16x32_bf16 v[68:71], v[84:87], v[252:255], v[68:71]
  v_cvt_pk_bf16_f32 v8, v32, v33
  v_cvt_pk_bf16_f32 v9, v34, v35
  v_cvt_pk_bf16_f32 v10, v40, v41
  v_cvt_pk_bf16_f32 v11, v42, v43
  s_add_u32 s34, s21, 0
  buffer_store_dwordx4 v[8:11], v1, s[4:7], s34 offen sc1
  v_cvt_pk_bf16_f32 v12, v36, v37
  v_cvt_pk_bf16_f32 v13, v38, v39
  v_cvt_pk_bf16_f32 v14, v44, v45
  v_cvt_pk_bf16_f32 v15, v46, v47
  s_add_u32 s34, s21, 6144
  buffer_store_dwordx4 v[12:15], v1, s[4:7], s34 offen sc1
  v_cvt_pk_bf16_f32 v8, v48, v49
  v_cvt_pk_bf16_f32 v9, v50, v51
  v_cvt_pk_bf16_f32 v10, v56, v57
  v_cvt_pk_bf16_f32 v11, v58, v59
  s_add_u32 s34, s21, 1024
  buffer_store_dwordx4 v[8:11], v1, s[4:7], s34 offen sc1
  v_cvt_pk_bf16_f32 v12, v52, v53
  v_cvt_pk_bf16_f32 v13, v54, v55
  v_cvt_pk_bf16_f32 v14, v60, v61
  v_cvt_pk_bf16_f32 v15, v62, v63
  s_add_u32 s34, s21, 7168
  buffer_store_dwordx4 v[12:15], v1, s[4:7], s34 offen sc1
  v_cvt_pk_bf16_f32 v8, v64, v65
  v_cvt_pk_bf16_f32 v9, v66, v67
  v_cvt_pk_bf16_f32 v10, v68, v69
  v_cvt_pk_bf16_f32 v11, v70, v71
  s_add_u32 s34, s23, 0
  buffer_store_dwordx4 v[8:11], v1, s[4:7], s34 offen sc1
  s_waitcnt vmcnt(0)
  s_barrier
  s_add_u32 s17, s17, 1
  v_mov_b32 v28, s17
  buffer_store_dword v28, v4, s[4:7], s24 offen sc1
  s_cmp_lt_u32 s17, 64
  s_cbranch_scc1 reca_ptop238
  s_branch reca_exit1
reca_pw1_227:
  s_mov_b32 s17, 0
  s_mov_b32 s26, 0
  s_mul_i32 s20, s17, 40960
  s_add_u32 s20, s20, 84944896
  s_add_u32 m0, s26, 10240
  s_nop 0
  buffer_load_dwordx4 v1, s[4:7], s20 offen offset:0 lds
  buffer_load_dwordx4 v1, s[4:7], s20 offen offset:1024 lds
  buffer_load_dwordx4 v1, s[4:7], s20 offen offset:2048 lds
  buffer_load_dwordx4 v1, s[4:7], s20 offen offset:3072 lds
  s_add_u32 s20, s20, 4096
  s_add_u32 m0, s26, 14336
  s_nop 0
  buffer_load_dwordx4 v1, s[4:7], s20 offen offset:0 lds
  buffer_load_dwordx4 v1, s[4:7], s20 offen offset:1024 lds
  buffer_load_dwordx4 v1, s[4:7], s20 offen offset:2048 lds
  buffer_load_dwordx4 v1, s[4:7], s20 offen offset:3072 lds
  s_add_u32 s20, s20, 4096
  s_add_u32 m0, s26, 18432
  s_nop 0
  buffer_load_dwordx4 v1, s[4:7], s20 offen offset:0 lds
  buffer_load_dwordx4 v1, s[4:7], s20 offen offset:1024 lds
  s_mul_i32 s34, s15, 12
  s_mul_i32 s35, s16, 6
  s_add_u32 s34, s34, s35
  s_add_u32 s34, s34, 4
  s_mul_i32 s34, s34, 20480
  s_add_u32 s34, s34, 14155776
  buffer_load_dwordx4 a[0:3], v1, s[4:7], s34 offen offset:0
  buffer_load_dwordx4 a[4:7], v1, s[4:7], s34 offen offset:1024
  buffer_load_dwordx4 a[8:11], v1, s[4:7], s34 offen offset:2048
  buffer_load_dwordx4 a[12:15], v1, s[4:7], s34 offen offset:3072
  s_add_u32 s34, s34, 4096
  buffer_load_dwordx4 a[16:19], v1, s[4:7], s34 offen offset:0
  buffer_load_dwordx4 a[20:23], v1, s[4:7], s34 offen offset:1024
  buffer_load_dwordx4 a[24:27], v1, s[4:7], s34 offen offset:2048
  buffer_load_dwordx4 a[28:31], v1, s[4:7], s34 offen offset:3072
  s_add_u32 s34, s34, 4096
  buffer_load_dwordx4 a[32:35], v1, s[4:7], s34 offen offset:0
  buffer_load_dwordx4 a[36:39], v1, s[4:7], s34 offen offset:1024
  buffer_load_dwordx4 a[40:43], v1, s[4:7], s34 offen offset:2048
  buffer_load_dwordx4 a[44:47], v1, s[4:7], s34 offen offset:3072
  s_add_u32 s34, s34, 4096
  buffer_load_dwordx4 a[48:51], v1, s[4:7], s34 offen offset:0
  buffer_load_dwordx4 a[52:55], v1, s[4:7], s34 offen offset:1024
  buffer_load_dwordx4 a[56:59], v1, s[4:7], s34 offen offset:2048
  buffer_load_dwordx4 a[60:63], v1, s[4:7], s34 offen offset:3072
  s_add_u32 s34, s34, 4096
  buffer_load_dwordx4 a[64:67], v1, s[4:7], s34 offen offset:0
  buffer_load_dwordx4 a[68:71], v1, s[4:7], s34 offen offset:1024
  buffer_load_dwordx4 a[72:75], v1, s[4:7], s34 offen offset:2048
  buffer_load_dwordx4 a[76:79], v1, s[4:7], s34 offen offset:3072
  s_mul_i32 s34, s15, 12
  s_mul_i32 s35, s16, 6
  s_add_u32 s34, s34, s35
  s_add_u32 s34, s34, 5
  s_mul_i32 s34, s34, 20480
  s_add_u32 s34, s34, 14155776
  buffer_load_dwordx4 a[80:83], v1, s[4:7], s34 offen offset:0
  buffer_load_dwordx4 a[84:87], v1, s[4:7], s34 offen offset:1024
  buffer_load_dwordx4 a[88:91], v1, s[4:7], s34 offen offset:2048
  buffer_load_dwordx4 a[92:95], v1, s[4:7], s34 offen offset:3072
  s_add_u32 s34, s34, 4096
  buffer_load_dwordx4 a[96:99], v1, s[4:7], s34 offen offset:0
  buffer_load_dwordx4 a[100:103], v1, s[4:7], s34 offen offset:1024
  buffer_load_dwordx4 a[104:107], v1, s[4:7], s34 offen offset:2048
  buffer_load_dwordx4 a[108:111], v1, s[4:7], s34 offen offset:3072
  s_add_u32 s34, s34, 4096
  buffer_load_dwordx4 a[112:115], v1, s[4:7], s34 offen offset:0
  buffer_load_dwordx4 a[116:119], v1, s[4:7], s34 offen offset:1024
  buffer_load_dwordx4 a[120:123], v1, s[4:7], s34 offen offset:2048
  buffer_load_dwordx4 a[124:127], v1, s[4:7], s34 offen offset:3072
  s_add_u32 s34, s34, 4096
  buffer_load_dwordx4 a[128:131], v1, s[4:7], s34 offen offset:0
  buffer_load_dwordx4 a[132:135], v1, s[4:7], s34 offen offset:1024
  buffer_load_dwordx4 a[136:139], v1, s[4:7], s34 offen offset:2048
  buffer_load_dwordx4 a[140:143], v1, s[4:7], s34 offen offset:3072
  s_add_u32 s34, s34, 4096
  buffer_load_dwordx4 a[144:147], v1, s[4:7], s34 offen offset:0
  buffer_load_dwordx4 a[148:151], v1, s[4:7], s34 offen offset:1024
  buffer_load_dwordx4 a[152:155], v1, s[4:7], s34 offen offset:2048
  buffer_load_dwordx4 a[156:159], v1, s[4:7], s34 offen offset:3072
  s_waitcnt vmcnt(20)
  s_mul_i32 s34, s15, 12
  s_mul_i32 s35, s16, 6
  s_add_u32 s34, s34, s35
  s_add_u32 s34, s34, 1
  s_mul_i32 s34, s34, 20480
  s_add_u32 s34, s34, 22020096
  buffer_load_dwordx4 a[160:163], v1, s[4:7], s34 offen offset:0
  buffer_load_dwordx4 a[164:167], v1, s[4:7], s34 offen offset:1024
  buffer_load_dwordx4 a[168:171], v1, s[4:7], s34 offen offset:2048
  buffer_load_dwordx4 a[172:175], v1, s[4:7], s34 offen offset:3072
  s_add_u32 s34, s34, 4096
  buffer_load_dwordx4 a[176:179], v1, s[4:7], s34 offen offset:0
  buffer_load_dwordx4 a[180:183], v1, s[4:7], s34 offen offset:1024
  buffer_load_dwordx4 a[184:187], v1, s[4:7], s34 offen offset:2048
  buffer_load_dwordx4 a[188:191], v1, s[4:7], s34 offen offset:3072
  s_add_u32 s34, s34, 4096
  buffer_load_dwordx4 a[192:195], v1, s[4:7], s34 offen offset:0
  buffer_load_dwordx4 a[196:199], v1, s[4:7], s34 offen offset:1024
  buffer_load_dwordx4 a[200:203], v1, s[4:7], s34 offen offset:2048
  buffer_load_dwordx4 a[204:207], v1, s[4:7], s34 offen offset:3072
  s_add_u32 s34, s34, 4096
  buffer_load_dwordx4 a[208:211], v1, s[4:7], s34 offen offset:0
  buffer_load_dwordx4 a[212:215], v1, s[4:7], s34 offen offset:1024
  buffer_load_dwordx4 a[216:219], v1, s[4:7], s34 offen offset:2048
  buffer_load_dwordx4 a[220:223], v1, s[4:7], s34 offen offset:3072
  s_add_u32 s34, s34, 4096
  buffer_load_dwordx4 a[224:227], v1, s[4:7], s34 offen offset:0
  buffer_load_dwordx4 a[228:231], v1, s[4:7], s34 offen offset:1024
  buffer_load_dwordx4 a[232:235], v1, s[4:7], s34 offen offset:2048
  buffer_load_dwordx4 a[236:239], v1, s[4:7], s34 offen offset:3072
  s_waitcnt vmcnt(20)
  s_mul_i32 s34, s15, 12
  s_mul_i32 s35, s16, 6
  s_add_u32 s34, s34, s35
  s_add_u32 s34, s34, 2
  s_mul_i32 s34, s34, 20480
  s_add_u32 s34, s34, 22020096
  buffer_load_dwordx4 v[96:99], v1, s[4:7], s34 offen offset:0
  buffer_load_dwordx4 v[100:103], v1, s[4:7], s34 offen offset:1024
  buffer_load_dwordx4 v[104:107], v1, s[4:7], s34 offen offset:2048
  buffer_load_dwordx4 v[108:111], v1, s[4:7], s34 offen offset:3072
  s_add_u32 s34, s34, 4096
  buffer_load_dwordx4 v[112:115], v1, s[4:7], s34 offen offset:0
  buffer_load_dwordx4 v[116:119], v1, s[4:7], s34 offen offset:1024
  buffer_load_dwordx4 v[120:123], v1, s[4:7], s34 offen offset:2048
  buffer_load_dwordx4 v[124:127], v1, s[4:7], s34 offen offset:3072
  s_add_u32 s34, s34, 4096
  buffer_load_dwordx4 v[128:131], v1, s[4:7], s34 offen offset:0
  buffer_load_dwordx4 v[132:135], v1, s[4:7], s34 offen offset:1024
  buffer_load_dwordx4 v[136:139], v1, s[4:7], s34 offen offset:2048
  buffer_load_dwordx4 v[140:143], v1, s[4:7], s34 offen offset:3072
  s_add_u32 s34, s34, 4096
  buffer_load_dwordx4 v[144:147], v1, s[4:7], s34 offen offset:0
  buffer_load_dwordx4 v[148:151], v1, s[4:7], s34 offen offset:1024
  buffer_load_dwordx4 v[152:155], v1, s[4:7], s34 offen offset:2048
  buffer_load_dwordx4 v[156:159], v1, s[4:7], s34 offen offset:3072
  s_add_u32 s34, s34, 4096
  buffer_load_dwordx4 v[160:163], v1, s[4:7], s34 offen offset:0
  buffer_load_dwordx4 v[164:167], v1, s[4:7], s34 offen offset:1024
  buffer_load_dwordx4 v[168:171], v1, s[4:7], s34 offen offset:2048
  buffer_load_dwordx4 v[172:175], v1, s[4:7], s34 offen offset:3072
  s_waitcnt vmcnt(20)
  s_mul_i32 s34, s15, 12
  s_mul_i32 s35, s16, 6
  s_add_u32 s34, s34, s35
  s_add_u32 s34, s34, 3
  s_mul_i32 s34, s34, 20480
  s_add_u32 s34, s34, 22020096
  buffer_load_dwordx4 v[176:179], v1, s[4:7], s34 offen offset:0
  buffer_load_dwordx4 v[180:183], v1, s[4:7], s34 offen offset:1024
  buffer_load_dwordx4 v[184:187], v1, s[4:7], s34 offen offset:2048
  buffer_load_dwordx4 v[188:191], v1, s[4:7], s34 offen offset:3072
  s_add_u32 s34, s34, 4096
  buffer_load_dwordx4 v[192:195], v1, s[4:7], s34 offen offset:0
  buffer_load_dwordx4 v[196:199], v1, s[4:7], s34 offen offset:1024
  buffer_load_dwordx4 v[200:203], v1, s[4:7], s34 offen offset:2048
  buffer_load_dwordx4 v[204:207], v1, s[4:7], s34 offen offset:3072
  s_add_u32 s34, s34, 4096
  buffer_load_dwordx4 v[208:211], v1, s[4:7], s34 offen offset:0
  buffer_load_dwordx4 v[212:215], v1, s[4:7], s34 offen offset:1024
  buffer_load_dwordx4 v[216:219], v1, s[4:7], s34 offen offset:2048
  buffer_load_dwordx4 v[220:223], v1, s[4:7], s34 offen offset:3072
  s_add_u32 s34, s34, 4096
  buffer_load_dwordx4 v[224:227], v1, s[4:7], s34 offen offset:0
  buffer_load_dwordx4 v[228:231], v1, s[4:7], s34 offen offset:1024
  buffer_load_dwordx4 v[232:235], v1, s[4:7], s34 offen offset:2048
  buffer_load_dwordx4 v[236:239], v1, s[4:7], s34 offen offset:3072
  s_add_u32 s34, s34, 4096
  buffer_load_dwordx4 v[240:243], v1, s[4:7], s34 offen offset:0
  buffer_load_dwordx4 v[244:247], v1, s[4:7], s34 offen offset:1024
  buffer_load_dwordx4 v[248:251], v1, s[4:7], s34 offen offset:2048
  buffer_load_dwordx4 v[252:255], v1, s[4:7], s34 offen offset:3072
  s_waitcnt vmcnt(20)
  v_and_b32 v30, 7, v0
  v_lshlrev_b32 v30, 3, v30
reca_cens243:
  buffer_load_dwordx2 v[28:29], v30, s[8:11], 0 offen sc1
  s_waitcnt vmcnt(0)
  v_sad_u8 v31, v28, 0, 0
  v_sad_u8 v31, v29, 0, v31
  v_cmp_gt_u32 vcc, 32, v31
  s_cbranch_vccz reca_censok244
  s_sleep 8
  s_sub_u32 s18, s18, 1
  s_cbranch_scc0 reca_cens243
  s_mov_b32 s18, 0
reca_censok244:
  v_and_b32 v28, 0x20202020, v28
  v_and_b32 v29, 0x20202020, v29
  v_cmp_ne_u32 s[34:35], 0, v28
  v_cmp_ne_u32 s[36:37], 0, v29
  s_nop 3
  s_and_b32 s34, s34, 0xff
  s_and_b32 s36, s36, 0xff
  s_or_b32 s35, s34, s36
  s_lshr_b32 s37, s35, s13
  s_and_b32 s37, s37, 1
  s_xor_b32 s43, s37, 1
  s_cmp_eq_u32 s57, 0
  s_cselect_b32 s58, s36, s34
  v_mov_b32 v31, 0x80000000
  s_cmp_lg_u32 s43, 0
  s_cbranch_scc1 reca_pslow245
reca_ptop246:
  s_cmp_lt_u32 s17, 3
  s_cbranch_scc1 reca_pgo247
  s_sub_u32 s36, s17, 3
reca_ppoll248:
  buffer_load_dword v28, v4, s[4:7], s25 offen sc1
  s_waitcnt vmcnt(0)
  v_readfirstlane_b32 s34, v28
  s_nop 3
  s_cmp_ge_i32 s34, s36
  s_cbranch_scc1 reca_pgo247
  s_sleep 8
  s_sub_u32 s18, s18, 1
  s_cbranch_scc0 reca_ppoll248
  s_mov_b32 s18, 0
reca_pgo247:
  s_waitcnt vmcnt(0)
  s_barrier
  v_add_u32 v7, s26, v1
  s_xor_b32 s26, s26, 40960
  s_add_u32 s37, s17, 1
  s_cmp_ge_u32 s37, 64
  s_cbranch_scc1 reca_pnodma249
  s_mul_i32 s20, s37, 40960
  s_add_u32 s20, s20, 84944896
  s_add_u32 m0, s26, 10240
  s_nop 0
  buffer_load_dwordx4 v1, s[4:7], s20 offen offset:0 lds
  buffer_load_dwordx4 v1, s[4:7], s20 offen offset:1024 lds
  buffer_load_dwordx4 v1, s[4:7], s20 offen offset:2048 lds
  buffer_load_dwordx4 v1, s[4:7], s20 offen offset:3072 lds
  s_add_u32 s20, s20, 4096
  s_add_u32 m0, s26, 14336
  s_nop 0
  buffer_load_dwordx4 v1, s[4:7], s20 offen offset:0 lds
  buffer_load_dwordx4 v1, s[4:7], s20 offen offset:1024 lds
  buffer_load_dwordx4 v1, s[4:7], s20 offen offset:2048 lds
  buffer_load_dwordx4 v1, s[4:7], s20 offen offset:3072 lds
  s_add_u32 s20, s20, 4096
  s_add_u32 m0, s26, 18432
  s_nop 0
  buffer_load_dwordx4 v1, s[4:7], s20 offen offset:0 lds
  buffer_load_dwordx4 v1, s[4:7], s20 offen offset:1024 lds
reca_pnodma249:
  s_lshl_b32 s34, s15, 3
  s_and_b32 s35, s17, 7
  s_add_u32 s34, s34, s35
  s_mul_i32 s34, s34, 12288
  s_mul_i32 s35, s16, 3072
  s_add_u32 s35, s35, s34
  s_add_u32 s21, s35, 37748736
  s_add_u32 s22, s35, 44040192
  s_mul_i32 s35, s16, 6144
  s_add_u32 s35, s35, s34
  s_add_u32 s23, s35, 40894464
  ds_read_b128 v[72:75], v7 offset:0
  ds_read_b128 v[76:79], v7 offset:20480
  ds_read_b128 v[80:83], v7 offset:1024
  ds_read_b128 v[84:87], v7 offset:21504
  ds_read_b128 v[88:91], v7 offset:2048
  ds_read_b128 v[92:95], v7 offset:22528
  s_waitcnt lgkmcnt(4)
  v_mfma_f32_16x16x32_bf16 v[32:35], a[0:3], v[72:75], 0
  v_mfma_f32_16x16x32_bf16 v[36:39], a[0:3], v[76:79], 0
  v_mfma_f32_16x16x32_bf16 v[40:43], a[80:83], v[72:75], 0
  v_mfma_f32_16x16x32_bf16 v[44:47], a[80:83], v[76:79], 0
  v_mfma_f32_16x16x32_bf16 v[48:51], v[72:75], a[160:163], 0
  v_mfma_f32_16x16x32_bf16 v[52:55], v[76:79], a[160:163], 0
  v_mfma_f32_16x16x32_bf16 v[56:59], v[72:75], v[96:99], 0
  v_mfma_f32_16x16x32_bf16 v[60:63], v[76:79], v[96:99], 0
  v_mfma_f32_16x16x32_bf16 v[64:67], v[72:75], v[176:179], 0
  v_mfma_f32_16x16x32_bf16 v[68:71], v[76:79], v[176:179], 0
  ds_read_b128 v[72:75], v7 offset:3072
  ds_read_b128 v[76:79], v7 offset:23552
  s_waitcnt lgkmcnt(4)
  v_mfma_f32_16x16x32_bf16 v[32:35], a[4:7], v[80:83], v[32:35]
  v_mfma_f32_16x16x32_bf16 v[36:39], a[4:7], v[84:87], v[36:39]
  v_mfma_f32_16x16x32_bf16 v[40:43], a[84:87], v[80:83], v[40:43]
  v_mfma_f32_16x16x32_bf16 v[44:47], a[84:87], v[84:87], v[44:47]
  v_mfma_f32_16x16x32_bf16 v[48:51], v[80:83], a[164:167], v[48:51]
  v_mfma_f32_16x16x32_bf16 v[52:55], v[84:87], a[164:167], v[52:55]
  v_mfma_f32_16x16x32_bf16 v[56:59], v[80:83], v[100:103], v[56:59]
  v_mfma_f32_16x16x32_bf16 v[60:63], v[84:87], v[100:103], v[60:63]
  v_mfma_f32_16x16x32_bf16 v[64:67], v[80:83], v[180:183], v[64:67]
  v_mfma_f32_16x16x32_bf16 v[68:71], v[84:87], v[180:183], v[68:71]
  ds_read_b128 v[80:83], v7 offset:4096
  ds_read_b128 v[84:87], v7 offset:24576
  s_waitcnt lgkmcnt(4)
  v_mfma_f32_16x16x32_bf16 v[32:35], a[8:11], v[88:91], v[32:35]
  v_mfma_f32_16x16x32_bf16 v[36:39], a[8:11], v[92:95], v[36:39]
  v_mfma_f32_16x16x32_bf16 v[40:43], a[88:91], v[88:91], v[40:43]
  v_mfma_f32_16x16x32_bf16 v[44:47], a[88:91], v[92:95], v[44:47]
  v_mfma_f32_16x16x32_bf16 v[48:51], v[88:91], a[168:171], v[48:51]
  v_mfma_f32_16x16x32_bf16 v[52:55], v[92:95], a[168:171], v[52:55]
  v_mfma_f32_16x16x32_bf16 v[56:59], v[88:91], v[104:107], v[56:59]
  v_mfma_f32_16x16x32_bf16 v[60:63], v[92:95], v[104:107], v[60:63]
  v_mfma_f32_16x16x32_bf16 v[64:67], v[88:91], v[184:187], v[64:67]
  v_mfma_f32_16x16x32_bf16 v[68:71], v[92:95], v[184:187], v[68:71]
  ds_read_b128 v[88:91], v7 offset:5120
  ds_read_b128 v[92:95], v7 offset:25600
  s_waitcnt lgkmcnt(4)
  v_mfma_f32_16x16x32_bf16 v[32:35], a[12:15], v[72:75], v[32:35]
  v_mfma_f32_16x16x32_bf16 v[36:39], a[12:15], v[76:79], v[36:39]
  v_mfma_f32_16x16x32_bf16 v[40:43], a[92:95], v[72:75], v[40:43]
  v_mfma_f32_16x16x32_bf16 v[44:47], a[92:95], v[76:79], v[44:47]
  v_mfma_f32_16x16x32_bf16 v[48:51], v[72:75], a[172:175], v[48:51]
  v_mfma_f32_16x16x32_bf16 v[52:55], v[76:79], a[172:175], v[52:55]
  v_mfma_f32_16x16x32_bf16 v[56:59], v[72:75], v[108:111], v[56:59]
  v_mfma_f32_16x16x32_bf16 v[60:63], v[76:79], v[108:111], v[60:63]
  v_mfma_f32_16x16x32_bf16 v[64:67], v[72:75], v[188:191], v[64:67]
  v_mfma_f32_16x16x32_bf16 v[68:71], v[76:79], v[188:191], v[68:71]
  ds_read_b128 v[72:75], v7 offset:6144
  ds_read_b128 v[76:79], v7 offset:26624
  s_waitcnt lgkmcnt(4)
  v_mfma_f32_16x16x32_bf16 v[32:35], a[16:19], v[80:83], v[32:35]
  v_mfma_f32_16x16x32_bf16 v[36:39], a[16:19], v[84:87], v[36:39]
  v_mfma_f32_16x16x32_bf16 v[40:43], a[96:99], v[80:83], v[40:43]
  v_mfma_f32_16x16x32_bf16 v[44:47], a[96:99], v[84:87], v[44:47]
  v_mfma_f32_16x16x32_bf16 v[48:51], v[80:83], a[176:179], v[48:51]
  v_mfma_f32_16x16x32_bf16 v[52:55], v[84:87], a[176:179], v[52:55]
  v_mfma_f32_16x16x32_bf16 v[56:59], v[80:83], v[112:115], v[56:59]
  v_mfma_f32_16x16x32_bf16 v[60:63], v[84:87], v[112:115], v[60:63]
  v_mfma_f32_16x16x32_bf16 v[64:67], v[80:83], v[192:195], v[64:67]
  v_mfma_f32_16x16x32_bf16 v[68:71], v[84:87], v[192:195], v[68:71]
  ds_read_b128 v[80:83], v7 offset:7168
  ds_read_b128 v[84:87], v7 offset:27648
  s_waitcnt lgkmcnt(4)
  v_mfma_f32_16x16x32_bf16 v[32:35], a[20:23], v[88:91], v[32:35]
  v_mfma_f32_16x16x32_bf16 v[36:39], a[20:23], v[92:95], v[36:39]
  v_mfma_f32_16x16x32_bf16 v[40:43], a[100:103], v[88:91], v[40:43]
  v_mfma_f32_16x16x32_bf16 v[44:47], a[100:103], v[92:95], v[44:47]
  v_mfma_f32_16x16x32_bf16 v[48:51], v[88:91], a[180:183], v[48:51]
  v_mfma_f32_16x16x32_bf16 v[52:55], v[92:95], a[180:183], v[52:55]
  v_mfma_f32_16x16x32_bf16 v[56:59], v[88:91], v[116:119], v[56:59]
  v_mfma_f32_16x16x32_bf16 v[60:63], v[92:95], v[116:119], v[60:63]
  v_mfma_f32_16x16x32_bf16 v[64:67], v[88:91], v[196:199], v[64:67]
  v_mfma_f32_16x16x32_bf16 v[68:71], v[92:95], v[196:199], v[68:71]
  ds_read_b128 v[88:91], v7 offset:8192
  ds_read_b128 v[92:95], v7 offset:28672
  s_waitcnt lgkmcnt(4)
  v_mfma_f32_16x16x32_bf16 v[32:35], a[24:27], v[72:75], v[32:35]
  v_mfma_f32_16x16x32_bf16 v[36:39], a[24:27], v[76:79], v[36:39]
  v_mfma_f32_16x16x32_bf16 v[40:43], a[104:107], v[72:75], v[40:43]
  v_mfma_f32_16x16x32_bf16 v[44:47], a[104:107], v[76:79], v[44:47]
  v_mfma_f32_16x16x32_bf16 v[48:51], v[72:75], a[184:187], v[48:51]
  v_mfma_f32_16x16x32_bf16 v[52:55], v[76:79], a[184:187], v[52:55]
  v_mfma_f32_16x16x32_bf16 v[56:59], v[72:75], v[120:123], v[56:59]
  v_mfma_f32_16x16x32_bf16 v[60:63], v[76:79], v[120:123], v[60:63]
  v_mfma_f32_16x16x32_bf16 v[64:67], v[72:75], v[200:203], v[64:67]
  v_mfma_f32_16x16x32_bf16 v[68:71], v[76:79], v[200:203], v[68:71]
  ds_read_b128 v[72:75], v7 offset:9216
  ds_read_b128 v[76:79], v7 offset:29696
  s_waitcnt lgkmcnt(4)
  v_mfma_f32_16x16x32_bf16 v[32:35], a[28:31], v[80:83], v[32:35]
  v_mfma_f32_16x16x32_bf16 v[36:39], a[28:31], v[84:87], v[36:39]
  v_mfma_f32_16x16x32_bf16 v[40:43], a[108:111], v[80:83], v[40:43]
  v_mfma_f32_16x16x32_bf16 v[44:47], a[108:111], v[84:87], v[44:47]
  v_mfma_f32_16x16x32_bf16 v[48:51], v[80:83], a[188:191], v[48:51]
  v_mfma_f32_16x16x32_bf16 v[52:55], v[84:87], a[188:191], v[52:55]
  v_mfma_f32_16x16x32_bf16 v[56:59], v[80:83], v[124:127], v[56:59]
  v_mfma_f32_16x16x32_bf16 v[60:63], v[84:87], v[124:127], v[60:63]
  v_mfma_f32_16x16x32_bf16 v[64:67], v[80:83], v[204:207], v[64:67]
  v_mfma_f32_16x16x32_bf16 v[68:71], v[84:87], v[204:207], v[68:71]
  ds_read_b128 v[80:83], v7 offset:10240
  ds_read_b128 v[84:87], v7 offset:30720
  s_waitcnt lgkmcnt(4)
  v_mfma_f32_16x16x32_bf16 v[32:35], a[32:35], v[88:91], v[32:35]
  v_mfma_f32_16x16x32_bf16 v[36:39], a[32:35], v[92:95], v[36:39]
  v_mfma_f32_16x16x32_bf16 v[40:43], a[112:115], v[88:91], v[40:43]
  v_mfma_f32_16x16x32_bf16 v[44:47], a[112:115], v[92:95], v[44:47]
  v_mfma_f32_16x16x32_bf16 v[48:51], v[88:91], a[192:195], v[48:51]
  v_mfma_f32_16x16x32_bf16 v[52:55], v[92:95], a[192:195], v[52:55]
  v_mfma_f32_16x16x32_bf16 v[56:59], v[88:91], v[128:131], v[56:59]
  v_mfma_f32_16x16x32_bf16 v[60:63], v[92:95], v[128:131], v[60:63]
  v_mfma_f32_16x16x32_bf16 v[64:67], v[88:91], v[208:211], v[64:67]
  v_mfma_f32_16x16x32_bf16 v[68:71], v[92:95], v[208:211], v[68:71]
  ds_read_b128 v[88:91], v7 offset:11264
  ds_read_b128 v[92:95], v7 offset:31744
  s_waitcnt lgkmcnt(4)
  v_mfma_f32_16x16x32_bf16 v[32:35], a[36:39], v[72:75], v[32:35]
  v_mfma_f32_16x16x32_bf16 v[36:39], a[36:39], v[76:79], v[36:39]
  v_mfma_f32_16x16x32_bf16 v[40:43], a[116:119], v[72:75], v[40:43]
  v_mfma_f32_16x16x32_bf16 v[44:47], a[116:119], v[76:79], v[44:47]
  v_mfma_f32_16x16x32_bf16 v[48:51], v[72:75], a[196:199], v[48:51]
  v_mfma_f32_16x16x32_bf16 v[52:55], v[76:79], a[196:199], v[52:55]
  v_mfma_f32_16x16x32_bf16 v[56:59], v[72:75], v[132:135], v[56:59]
  v_mfma_f32_16x16x32_bf16 v[60:63], v[76:79], v[132:135], v[60:63]
  v_mfma_f32_16x16x32_bf16 v[64:67], v[72:75], v[212:215], v[64:67]
  v_mfma_f32_16x16x32_bf16 v[68:71], v[76:79], v[212:215], v[68:71]
  ds_read_b128 v[72:75], v7 offset:12288
  ds_read_b128 v[76:79], v7 offset:32768
  s_waitcnt lgkmcnt(4)
  v_mfma_f32_16x16x32_bf16 v[32:35], a[40:43], v[80:83], v[32:35]
  v_mfma_f32_16x16x32_bf16 v[36:39], a[40:43], v[84:87], v[36:39]
  v_mfma_f32_16x16x32_bf16 v[40:43], a[120:123], v[80:83], v[40:43]
  v_mfma_f32_16x16x32_bf16 v[44:47], a[120:123], v[84:87], v[44:47]
  v_mfma_f32_16x16x32_bf16 v[48:51], v[80:83], a[200:203], v[48:51]
  v_mfma_f32_16x16x32_bf16 v[52:55], v[84:87], a[200:203], v[52:55]
  v_mfma_f32_16x16x32_bf16 v[56:59], v[80:83], v[136:139], v[56:59]
  v_mfma_f32_16x16x32_bf16 v[60:63], v[84:87], v[136:139], v[60:63]
  v_mfma_f32_16x16x32_bf16 v[64:67], v[80:83], v[216:219], v[64:67]
  v_mfma_f32_16x16x32_bf16 v[68:71], v[84:87], v[216:219], v[68:71]
  ds_read_b128 v[80:83], v7 offset:13312
  ds_read_b128 v[84:87], v7 offset:33792
  s_waitcnt lgkmcnt(4)
  v_mfma_f32_16x16x32_bf16 v[32:35], a[44:47], v[88:91], v[32:35]
  v_mfma_f32_16x16x32_bf16 v[36:39], a[44:47], v[92:95], v[36:39]
  v_mfma_f32_16x16x32_bf16 v[40:43], a[124:127], v[88:91], v[40:43]
  v_mfma_f32_16x16x32_bf16 v[44:47], a[124:127], v[92:95], v[44:47]
  v_mfma_f32_16x16x32_bf16 v[48:51], v[88:91], a[204:207], v[48:51]
  v_mfma_f32_16x16x32_bf16 v[52:55], v[92:95], a[204:207], v[52:55]
  v_mfma_f32_16x16x32_bf16 v[56:59], v[88:91], v[140:143], v[56:59]
  v_mfma_f32_16x16x32_bf16 v[60:63], v[92:95], v[140:143], v[60:63]
  v_mfma_f32_16x16x32_bf16 v[64:67], v[88:91], v[220:223], v[64:67]
  v_mfma_f32_16x16x32_bf16 v[68:71], v[92:95], v[220:223], v[68:71]
  ds_read_b128 v[88:91], v7 offset:14336
  ds_read_b128 v[92:95], v7 offset:34816
  s_waitcnt lgkmcnt(4)
  v_mfma_f32_16x16x32_bf16 v[32:35], a[48:51], v[72:75], v[32:35]
  v_mfma_f32_16x16x32_bf16 v[36:39], a[48:51], v[76:79], v[36:39]
  v_mfma_f32_16x16x32_bf16 v[40:43], a[128:131], v[72:75], v[40:43]
  v_mfma_f32_16x16x32_bf16 v[44:47], a[128:131], v[76:79], v[44:47]
  v_mfma_f32_16x16x32_bf16 v[48:51], v[72:75], a[208:211], v[48:51]
  v_mfma_f32_16x16x32_bf16 v[52:55], v[76:79], a[208:211], v[52:55]
  v_mfma_f32_16x16x32_bf16 v[56:59], v[72:75], v[144:147], v[56:59]
  v_mfma_f32_16x16x32_bf16 v[60:63], v[76:79], v[144:147], v[60:63]
  v_mfma_f32_16x16x32_bf16 v[64:67], v[72:75], v[224:227], v[64:67]
  v_mfma_f32_16x16x32_bf16 v[68:71], v[76:79], v[224:227], v[68:71]
  ds_read_b128 v[72:75], v7 offset:15360
  ds_read_b128 v[76:79], v7 offset:35840
  s_waitcnt lgkmcnt(4)
  v_mfma_f32_16x16x32_bf16 v[32:35], a[52:55], v[80:83], v[32:35]
  v_mfma_f32_16x16x32_bf16 v[36:39], a[52:55], v[84:87], v[36:39]
  v_mfma_f32_16x16x32_bf16 v[40:43], a[132:135], v[80:83], v[40:43]
  v_mfma_f32_16x16x32_bf16 v[44:47], a[132:135], v[84:87], v[44:47]
  v_mfma_f32_16x16x32_bf16 v[48:51], v[80:83], a[212:215], v[48:51]
  v_mfma_f32_16x16x32_bf16 v[52:55], v[84:87], a[212:215], v[52:55]
  v_mfma_f32_16x16x32_bf16 v[56:59], v[80:83], v[148:151], v[56:59]
  v_mfma_f32_16x16x32_bf16 v[60:63], v[84:87], v[148:151], v[60:63]
  v_mfma_f32_16x16x32_bf16 v[64:67], v[80:83], v[228:231], v[64:67]
  v_mfma_f32_16x16x32_bf16 v[68:71], v[84:87], v[228:231], v[68:71]
  ds_read_b128 v[80:83], v7 offset:16384
  ds_read_b128 v[84:87], v7 offset:36864
  s_waitcnt lgkmcnt(4)
  v_mfma_f32_16x16x32_bf16 v[32:35], a[56:59], v[88:91], v[32:35]
  v_mfma_f32_16x16x32_bf16 v[36:39], a[56:59], v[92:95], v[36:39]
  v_mfma_f32_16x16x32_bf16 v[40:43], a[136:139], v[88:91], v[40:43]
  v_mfma_f32_16x16x32_bf16 v[44:47], a[136:139], v[92:95], v[44:47]
  v_mfma_f32_16x16x32_bf16 v[48:51], v[88:91], a[216:219], v[48:51]
  v_mfma_f32_16x16x32_bf16 v[52:55], v[92:95], a[216:219], v[52:55]
  v_mfma_f32_16x16x32_bf16 v[56:59], v[88:91], v[152:155], v[56:59]
  v_mfma_f32_16x16x32_bf16 v[60:63], v[92:95], v[152:155], v[60:63]
  v_mfma_f32_16x16x32_bf16 v[64:67], v[88:91], v[232:235], v[64:67]
  v_mfma_f32_16x16x32_bf16 v[68:71], v[92:95], v[232:235], v[68:71]
  ds_read_b128 v[88:91], v7 offset:17408
  ds_read_b128 v[92:95], v7 offset:37888
  s_waitcnt lgkmcnt(4)
  v_mfma_f32_16x16x32_bf16 v[32:35], a[60:63], v[72:75], v[32:35]
  v_mfma_f32_16x16x32_bf16 v[36:39], a[60:63], v[76:79], v[36:39]
  v_mfma_f32_16x16x32_bf16 v[40:43], a[140:143], v[72:75], v[40:43]
  v_mfma_f32_16x16x32_bf16 v[44:47], a[140:143], v[76:79], v[44:47]
  v_mfma_f32_16x16x32_bf16 v[48:51], v[72:75], a[220:223], v[48:51]
  v_mfma_f32_16x16x32_bf16 v[52:55], v[76:79], a[220:223], v[52:55]
  v_mfma_f32_16x16x32_bf16 v[56:59], v[72:75], v[156:159], v[56:59]
  v_mfma_f32_16x16x32_bf16 v[60:63], v[76:79], v[156:159], v[60:63]
  v_mfma_f32_16x16x32_bf16 v[64:67], v[72:75], v[236:239], v[64:67]
  v_mfma_f32_16x16x32_bf16 v[68:71], v[76:79], v[236:239], v[68:71]
  ds_read_b128 v[72:75], v7 offset:18432
  ds_read_b128 v[76:79], v7 offset:38912
  s_waitcnt lgkmcnt(4)
  v_mfma_f32_16x16x32_bf16 v[32:35], a[64:67], v[80:83], v[32:35]
  v_mfma_f32_16x16x32_bf16 v[36:39], a[64:67], v[84:87], v[36:39]
  v_mfma_f32_16x16x32_bf16 v[40:43], a[144:147], v[80:83], v[40:43]
  v_mfma_f32_16x16x32_bf16 v[44:47], a[144:147], v[84:87], v[44:47]
  v_mfma_f32_16x16x32_bf16 v[48:51], v[80:83], a[224:227], v[48:51]
  v_mfma_f32_16x16x32_bf16 v[52:55], v[84:87], a[224:227], v[52:55]
  v_mfma_f32_16x16x32_bf16 v[56:59], v[80:83], v[160:163], v[56:59]
  v_mfma_f32_16x16x32_bf16 v[60:63], v[84:87], v[160:163], v[60:63]
  v_mfma_f32_16x16x32_bf16 v[64:67], v[80:83], v[240:243], v[64:67]
  v_mfma_f32_16x16x32_bf16 v[68:71], v[84:87], v[240:243], v[68:71]
  ds_read_b128 v[80:83], v7 offset:19456
  ds_read_b128 v[84:87], v7 offset:39936
  s_waitcnt lgkmcnt(4)
  v_mfma_f32_16x16x32_bf16 v[32:35], a[68:71], v[88:91], v[32:35]
  v_mfma_f32_16x16x32_bf16 v[36:39], a[68:71], v[92:95], v[36:39]
  v_mfma_f32_16x16x32_bf16 v[40:43], a[148:151], v[88:91], v[40:43]
  v_mfma_f32_16x16x32_bf16 v[44:47], a[148:151], v[92:95], v[44:47]
  v_mfma_f32_16x16x32_bf16 v[48:51], v[88:91], a[228:231], v[48:51]
  v_mfma_f32_16x16x32_bf16 v[52:55], v[92:95], a[228:231], v[52:55]
  v_mfma_f32_16x16x32_bf16 v[56:59], v[88:91], v[164:167], v[56:59]
  v_mfma_f32_16x16x32_bf16 v[60:63], v[92:95], v[164:167], v[60:63]
  v_mfma_f32_16x16x32_bf16 v[64:67], v[88:91], v[244:247], v[64:67]
  v_mfma_f32_16x16x32_bf16 v[68:71], v[92:95], v[244:247], v[68:71]
  s_waitcnt lgkmcnt(2)
  v_mfma_f32_16x16x32_bf16 v[32:35], a[72:75], v[72:75], v[32:35]
  v_mfma_f32_16x16x32_bf16 v[36:39], a[72:75], v[76:79], v[36:39]
  v_mfma_f32_16x16x32_bf16 v[40:43], a[152:155], v[72:75], v[40:43]
  v_mfma_f32_16x16x32_bf16 v[44:47], a[152:155], v[76:79], v[44:47]
  v_mfma_f32_16x16x32_bf16 v[48:51], v[72:75], a[232:235], v[48:51]
  v_mfma_f32_16x16x32_bf16 v[52:55], v[76:79], a[232:235], v[52:55]
  v_mfma_f32_16x16x32_bf16 v[56:59], v[72:75], v[168:171], v[56:59]
  v_mfma_f32_16x16x32_bf16 v[60:63], v[76:79], v[168:171], v[60:63]
  v_mfma_f32_16x16x32_bf16 v[64:67], v[72:75], v[248:251], v[64:67]
  v_mfma_f32_16x16x32_bf16 v[68:71], v[76:79], v[248:251], v[68:71]
  s_waitcnt lgkmcnt(0)
  v_mfma_f32_16x16x32_bf16 v[32:35], a[76:79], v[80:83], v[32:35]
  v_mfma_f32_16x16x32_bf16 v[36:39], a[76:79], v[84:87], v[36:39]
  v_mfma_f32_16x16x32_bf16 v[40:43], a[156:159], v[80:83], v[40:43]
  v_mfma_f32_16x16x32_bf16 v[44:47], a[156:159], v[84:87], v[44:47]
  v_mfma_f32_16x16x32_bf16 v[48:51], v[80:83], a[236:239], v[48:51]
  v_mfma_f32_16x16x32_bf16 v[52:55], v[84:87], a[236:239], v[52:55]
  v_mfma_f32_16x16x32_bf16 v[56:59], v[80:83], v[172:175], v[56:59]
  v_mfma_f32_16x16x32_bf16 v[60:63], v[84:87], v[172:175], v[60:63]
  v_mfma_f32_16x16x32_bf16 v[64:67], v[80:83], v[252:255], v[64:67]
  v_mfma_f32_16x16x32_bf16 v[68:71], v[84:87], v[252:255], v[68:71]
  v_cvt_pk_bf16_f32 v8, v32, v33
  v_cvt_pk_bf16_f32 v9, v34, v35
  v_cvt_pk_bf16_f32 v10, v40, v41
  v_cvt_pk_bf16_f32 v11, v42, v43
  s_add_u32 s34, s21, 2048
  buffer_store_dwordx4 v[8:11], v1, s[4:7], s34 offen
  v_cvt_pk_bf16_f32 v12, v36, v37
  v_cvt_pk_bf16_f32 v13, v38, v39
  v_cvt_pk_bf16_f32 v14, v44, v45
  v_cvt_pk_bf16_f32 v15, v46, v47
  s_add_u32 s34, s21, 8192
  buffer_store_dwordx4 v[12:15], v1, s[4:7], s34 offen
  v_cvt_pk_bf16_f32 v8, v48, v49
  v_cvt_pk_bf16_f32 v9, v50, v51
  v_cvt_pk_bf16_f32 v10, v52, v53
  v_cvt_pk_bf16_f32 v11, v54, v55
  s_add_u32 s34, s23, 1024
  buffer_store_dwordx4 v[8:11], v1, s[4:7], s34 offen
  v_cvt_pk_bf16_f32 v12, v56, v57
  v_cvt_pk_bf16_f32 v13, v58, v59
  v_cvt_pk_bf16_f32 v14, v60, v61
  v_cvt_pk_bf16_f32 v15, v62, v63
  s_add_u32 s34, s23, 2048
  buffer_store_dwordx4 v[12:15], v1, s[4:7], s34 offen
  v_cvt_pk_bf16_f32 v8, v64, v65
  v_cvt_pk_bf16_f32 v9, v66, v67
  v_cvt_pk_bf16_f32 v10, v68, v69
  v_cvt_pk_bf16_f32 v11, v70, v71
  s_add_u32 s34, s23, 3072
  buffer_store_dwordx4 v[8:11], v1, s[4:7], s34 offen
  s_waitcnt vmcnt(0)
  s_barrier
  s_add_u32 s17, s17, 1
  s_cmp_lt_u32 s17, 64
  s_cbranch_scc1 reca_ptop246
  s_branch reca_exit1
reca_pslow245:
reca_ptop251:
  s_cmp_lt_u32 s17, 3
  s_cbranch_scc1 reca_pgo252
  s_sub_u32 s36, s17, 3
reca_ppoll253:
  buffer_load_dword v28, v4, s[4:7], s25 offen sc1
  s_waitcnt vmcnt(0)
  v_readfirstlane_b32 s34, v28
  s_nop 3
  s_cmp_ge_i32 s34, s36
  s_cbranch_scc1 reca_pgo252
  s_sleep 8
  s_sub_u32 s18, s18, 1
  s_cbranch_scc0 reca_ppoll253
  s_mov_b32 s18, 0
reca_pgo252:
  s_waitcnt vmcnt(0)
  s_barrier
  v_add_u32 v7, s26, v1
  s_xor_b32 s26, s26, 40960
  s_add_u32 s37, s17, 1
  s_cmp_ge_u32 s37, 64
  s_cbranch_scc1 reca_pnodma254
  s_mul_i32 s20, s37, 40960
  s_add_u32 s20, s20, 84944896
  s_add_u32 m0, s26, 10240
  s_nop 0
  buffer_load_dwordx4 v1, s[4:7], s20 offen offset:0 lds
  buffer_load_dwordx4 v1, s[4:7], s20 offen offset:1024 lds
  buffer_load_dwordx4 v1, s[4:7], s20 offen offset:2048 lds
  buffer_load_dwordx4 v1, s[4:7], s20 offen offset:3072 lds
  s_add_u32 s20, s20, 4096
  s_add_u32 m0, s26, 14336
  s_nop 0
  buffer_load_dwordx4 v1, s[4:7], s20 offen offset:0 lds
  buffer_load_dwordx4 v1, s[4:7], s20 offen offset:1024 lds
  buffer_load_dwordx4 v1, s[4:7], s20 offen offset:2048 lds
  buffer_load_dwordx4 v1, s[4:7], s20 offen offset:3072 lds
  s_add_u32 s20, s20, 4096
  s_add_u32 m0, s26, 18432
  s_nop 0
  buffer_load_dwordx4 v1, s[4:7], s20 offen offset:0 lds
  buffer_load_dwordx4 v1, s[4:7], s20 offen offset:1024 lds
reca_pnodma254:
  s_lshl_b32 s34, s15, 3
  s_and_b32 s35, s17, 7
  s_add_u32 s34, s34, s35
  s_mul_i32 s34, s34, 12288
  s_mul_i32 s35, s16, 3072
  s_add_u32 s35, s35, s34
  s_add_u32 s21, s35, 37748736
  s_add_u32 s22, s35, 44040192
  s_mul_i32 s35, s16, 6144
  s_add_u32 s35, s35, s34
  s_add_u32 s23, s35, 40894464
  ds_read_b128 v[72:75], v7 offset:0
  ds_read_b128 v[76:79], v7 offset:20480
  ds_read_b128 v[80:83], v7 offset:1024
  ds_read_b128 v[84:87], v7 offset:21504
  ds_read_b128 v[88:91], v7 offset:2048
  ds_read_b128 v[92:95], v7 offset:22528
  s_waitcnt lgkmcnt(4)
  v_mfma_f32_16x16x32_bf16 v[32:35], a[0:3], v[72:75], 0
  v_mfma_f32_16x16x32_bf16 v[36:39], a[0:3], v[76:79], 0
  v_mfma_f32_16x16x32_bf16 v[40:43], a[80:83], v[72:75], 0
  v_mfma_f32_16x16x32_bf16 v[44:47], a[80:83], v[76:79], 0
  v_mfma_f32_16x16x32_bf16 v[48:51], v[72:75], a[160:163], 0
  v_mfma_f32_16x16x32_bf16 v[52:55], v[76:79], a[160:163], 0
  v_mfma_f32_16x16x32_bf16 v[56:59], v[72:75], v[96:99], 0
  v_mfma_f32_16x16x32_bf16 v[60:63], v[76:79], v[96:99], 0
  v_mfma_f32_16x16x32_bf16 v[64:67], v[72:75], v[176:179], 0
  v_mfma_f32_16x16x32_bf16 v[68:71], v[76:79], v[176:179], 0
  ds_read_b128 v[72:75], v7 offset:3072
  ds_read_b128 v[76:79], v7 offset:23552
  s_waitcnt lgkmcnt(4)
  v_mfma_f32_16x16x32_bf16 v[32:35], a[4:7], v[80:83], v[32:35]
  v_mfma_f32_16x16x32_bf16 v[36:39], a[4:7], v[84:87], v[36:39]
  v_mfma_f32_16x16x32_bf16 v[40:43], a[84:87], v[80:83], v[40:43]
  v_mfma_f32_16x16x32_bf16 v[44:47], a[84:87], v[84:87], v[44:47]
  v_mfma_f32_16x16x32_bf16 v[48:51], v[80:83], a[164:167], v[48:51]
  v_mfma_f32_16x16x32_bf16 v[52:55], v[84:87], a[164:167], v[52:55]
  v_mfma_f32_16x16x32_bf16 v[56:59], v[80:83], v[100:103], v[56:59]
  v_mfma_f32_16x16x32_bf16 v[60:63], v[84:87], v[100:103], v[60:63]
  v_mfma_f32_16x16x32_bf16 v[64:67], v[80:83], v[180:183], v[64:67]
  v_mfma_f32_16x16x32_bf16 v[68:71], v[84:87], v[180:183], v[68:71]
  ds_read_b128 v[80:83], v7 offset:4096
  ds_read_b128 v[84:87], v7 offset:24576
  s_waitcnt lgkmcnt(4)
  v_mfma_f32_16x16x32_bf16 v[32:35], a[8:11], v[88:91], v[32:35]
  v_mfma_f32_16x16x32_bf16 v[36:39], a[8:11], v[92:95], v[36:39]
  v_mfma_f32_16x16x32_bf16 v[40:43], a[88:91], v[88:91], v[40:43]
  v_mfma_f32_16x16x32_bf16 v[44:47], a[88:91], v[92:95], v[44:47]
  v_mfma_f32_16x16x32_bf16 v[48:51], v[88:91], a[168:171], v[48:51]
  v_mfma_f32_16x16x32_bf16 v[52:55], v[92:95], a[168:171], v[52:55]
  v_mfma_f32_16x16x32_bf16 v[56:59], v[88:91], v[104:107], v[56:59]
  v_mfma_f32_16x16x32_bf16 v[60:63], v[92:95], v[104:107], v[60:63]
  v_mfma_f32_16x16x32_bf16 v[64:67], v[88:91], v[184:187], v[64:67]
  v_mfma_f32_16x16x32_bf16 v[68:71], v[92:95], v[184:187], v[68:71]
  ds_read_b128 v[88:91], v7 offset:5120
  ds_read_b128 v[92:95], v7 offset:25600
  s_waitcnt lgkmcnt(4)
  v_mfma_f32_16x16x32_bf16 v[32:35], a[12:15], v[72:75], v[32:35]
  v_mfma_f32_16x16x32_bf16 v[36:39], a[12:15], v[76:79], v[36:39]
  v_mfma_f32_16x16x32_bf16 v[40:43], a[92:95], v[72:75], v[40:43]
  v_mfma_f32_16x16x32_bf16 v[44:47], a[92:95], v[76:79], v[44:47]
  v_mfma_f32_16x16x32_bf16 v[48:51], v[72:75], a[172:175], v[48:51]
  v_mfma_f32_16x16x32_bf16 v[52:55], v[76:79], a[172:175], v[52:55]
  v_mfma_f32_16x16x32_bf16 v[56:59], v[72:75], v[108:111], v[56:59]
  v_mfma_f32_16x16x32_bf16 v[60:63], v[76:79], v[108:111], v[60:63]
  v_mfma_f32_16x16x32_bf16 v[64:67], v[72:75], v[188:191], v[64:67]
  v_mfma_f32_16x16x32_bf16 v[68:71], v[76:79], v[188:191], v[68:71]
  ds_read_b128 v[72:75], v7 offset:6144
  ds_read_b128 v[76:79], v7 offset:26624
  s_waitcnt lgkmcnt(4)
  v_mfma_f32_16x16x32_bf16 v[32:35], a[16:19], v[80:83], v[32:35]
  v_mfma_f32_16x16x32_bf16 v[36:39], a[16:19], v[84:87], v[36:39]
  v_mfma_f32_16x16x32_bf16 v[40:43], a[96:99], v[80:83], v[40:43]
  v_mfma_f32_16x16x32_bf16 v[44:47], a[96:99], v[84:87], v[44:47]
  v_mfma_f32_16x16x32_bf16 v[48:51], v[80:83], a[176:179], v[48:51]
  v_mfma_f32_16x16x32_bf16 v[52:55], v[84:87], a[176:179], v[52:55]
  v_mfma_f32_16x16x32_bf16 v[56:59], v[80:83], v[112:115], v[56:59]
  v_mfma_f32_16x16x32_bf16 v[60:63], v[84:87], v[112:115], v[60:63]
  v_mfma_f32_16x16x32_bf16 v[64:67], v[80:83], v[192:195], v[64:67]
  v_mfma_f32_16x16x32_bf16 v[68:71], v[84:87], v[192:195], v[68:71]
  ds_read_b128 v[80:83], v7 offset:7168
  ds_read_b128 v[84:87], v7 offset:27648
  s_waitcnt lgkmcnt(4)
  v_mfma_f32_16x16x32_bf16 v[32:35], a[20:23], v[88:91], v[32:35]
  v_mfma_f32_16x16x32_bf16 v[36:39], a[20:23], v[92:95], v[36:39]
  v_mfma_f32_16x16x32_bf16 v[40:43], a[100:103], v[88:91], v[40:43]
  v_mfma_f32_16x16x32_bf16 v[44:47], a[100:103], v[92:95], v[44:47]
  v_mfma_f32_16x16x32_bf16 v[48:51], v[88:91], a[180:183], v[48:51]
  v_mfma_f32_16x16x32_bf16 v[52:55], v[92:95], a[180:183], v[52:55]
  v_mfma_f32_16x16x32_bf16 v[56:59], v[88:91], v[116:119], v[56:59]
  v_mfma_f32_16x16x32_bf16 v[60:63], v[92:95], v[116:119], v[60:63]
  v_mfma_f32_16x16x32_bf16 v[64:67], v[88:91], v[196:199], v[64:67]
  v_mfma_f32_16x16x32_bf16 v[68:71], v[92:95], v[196:199], v[68:71]
  ds_read_b128 v[88:91], v7 offset:8192
  ds_read_b128 v[92:95], v7 offset:28672
  s_waitcnt lgkmcnt(4)
  v_mfma_f32_16x16x32_bf16 v[32:35], a[24:27], v[72:75], v[32:35]
  v_mfma_f32_16x16x32_bf16 v[36:39], a[24:27], v[76:79], v[36:39]
  v_mfma_f32_16x16x32_bf16 v[40:43], a[104:107], v[72:75], v[40:43]
  v_mfma_f32_16x16x32_bf16 v[44:47], a[104:107], v[76:79], v[44:47]
  v_mfma_f32_16x16x32_bf16 v[48:51], v[72:75], a[184:187], v[48:51]
  v_mfma_f32_16x16x32_bf16 v[52:55], v[76:79], a[184:187], v[52:55]
  v_mfma_f32_16x16x32_bf16 v[56:59], v[72:75], v[120:123], v[56:59]
  v_mfma_f32_16x16x32_bf16 v[60:63], v[76:79], v[120:123], v[60:63]
  v_mfma_f32_16x16x32_bf16 v[64:67], v[72:75], v[200:203], v[64:67]
  v_mfma_f32_16x16x32_bf16 v[68:71], v[76:79], v[200:203], v[68:71]
  ds_read_b128 v[72:75], v7 offset:9216
  ds_read_b128 v[76:79], v7 offset:29696
  s_waitcnt lgkmcnt(4)
  v_mfma_f32_16x16x32_bf16 v[32:35], a[28:31], v[80:83], v[32:35]
  v_mfma_f32_16x16x32_bf16 v[36:39], a[28:31], v[84:87], v[36:39]
  v_mfma_f32_16x16x32_bf16 v[40:43], a[108:111], v[80:83], v[40:43]
  v_mfma_f32_16x16x32_bf16 v[44:47], a[108:111], v[84:87], v[44:47]
  v_mfma_f32_16x16x32_bf16 v[48:51], v[80:83], a[188:191], v[48:51]
  v_mfma_f32_16x16x32_bf16 v[52:55], v[84:87], a[188:191], v[52:55]
  v_mfma_f32_16x16x32_bf16 v[56:59], v[80:83], v[124:127], v[56:59]
  v_mfma_f32_16x16x32_bf16 v[60:63], v[84:87], v[124:127], v[60:63]
  v_mfma_f32_16x16x32_bf16 v[64:67], v[80:83], v[204:207], v[64:67]
  v_mfma_f32_16x16x32_bf16 v[68:71], v[84:87], v[204:207], v[68:71]
  ds_read_b128 v[80:83], v7 offset:10240
  ds_read_b128 v[84:87], v7 offset:30720
  s_waitcnt lgkmcnt(4)
  v_mfma_f32_16x16x32_bf16 v[32:35], a[32:35], v[88:91], v[32:35]
  v_mfma_f32_16x16x32_bf16 v[36:39], a[32:35], v[92:95], v[36:39]
  v_mfma_f32_16x16x32_bf16 v[40:43], a[112:115], v[88:91], v[40:43]
  v_mfma_f32_16x16x32_bf16 v[44:47], a[112:115], v[92:95], v[44:47]
  v_mfma_f32_16x16x32_bf16 v[48:51], v[88:91], a[192:195], v[48:51]
  v_mfma_f32_16x16x32_bf16 v[52:55], v[92:95], a[192:195], v[52:55]
  v_mfma_f32_16x16x32_bf16 v[56:59], v[88:91], v[128:131], v[56:59]
  v_mfma_f32_16x16x32_bf16 v[60:63], v[92:95], v[128:131], v[60:63]
  v_mfma_f32_16x16x32_bf16 v[64:67], v[88:91], v[208:211], v[64:67]
  v_mfma_f32_16x16x32_bf16 v[68:71], v[92:95], v[208:211], v[68:71]
  ds_read_b128 v[88:91], v7 offset:11264
  ds_read_b128 v[92:95], v7 offset:31744
  s_waitcnt lgkmcnt(4)
  v_mfma_f32_16x16x32_bf16 v[32:35], a[36:39], v[72:75], v[32:35]
  v_mfma_f32_16x16x32_bf16 v[36:39], a[36:39], v[76:79], v[36:39]
  v_mfma_f32_16x16x32_bf16 v[40:43], a[116:119], v[72:75], v[40:43]
  v_mfma_f32_16x16x32_bf16 v[44:47], a[116:119], v[76:79], v[44:47]
  v_mfma_f32_16x16x32_bf16 v[48:51], v[72:75], a[196:199], v[48:51]
  v_mfma_f32_16x16x32_bf16 v[52:55], v[76:79], a[196:199], v[52:55]
  v_mfma_f32_16x16x32_bf16 v[56:59], v[72:75], v[132:135], v[56:59]
  v_mfma_f32_16x16x32_bf16 v[60:63], v[76:79], v[132:135], v[60:63]
  v_mfma_f32_16x16x32_bf16 v[64:67], v[72:75], v[212:215], v[64:67]
  v_mfma_f32_16x16x32_bf16 v[68:71], v[76:79], v[212:215], v[68:71]
  ds_read_b128 v[72:75], v7 offset:12288
  ds_read_b128 v[76:79], v7 offset:32768
  s_waitcnt lgkmcnt(4)
  v_mfma_f32_16x16x32_bf16 v[32:35], a[40:43], v[80:83], v[32:35]
  v_mfma_f32_16x16x32_bf16 v[36:39], a[40:43], v[84:87], v[36:39]
  v_mfma_f32_16x16x32_bf16 v[40:43], a[120:123], v[80:83], v[40:43]
  v_mfma_f32_16x16x32_bf16 v[44:47], a[120:123], v[84:87], v[44:47]
  v_mfma_f32_16x16x32_bf16 v[48:51], v[80:83], a[200:203], v[48:51]
  v_mfma_f32_16x16x32_bf16 v[52:55], v[84:87], a[200:203], v[52:55]
  v_mfma_f32_16x16x32_bf16 v[56:59], v[80:83], v[136:139], v[56:59]
  v_mfma_f32_16x16x32_bf16 v[60:63], v[84:87], v[136:139], v[60:63]
  v_mfma_f32_16x16x32_bf16 v[64:67], v[80:83], v[216:219], v[64:67]
  v_mfma_f32_16x16x32_bf16 v[68:71], v[84:87], v[216:219], v[68:71]
  ds_read_b128 v[80:83], v7 offset:13312
  ds_read_b128 v[84:87], v7 offset:33792
  s_waitcnt lgkmcnt(4)
  v_mfma_f32_16x16x32_bf16 v[32:35], a[44:47], v[88:91], v[32:35]
  v_mfma_f32_16x16x32_bf16 v[36:39], a[44:47], v[92:95], v[36:39]
  v_mfma_f32_16x16x32_bf16 v[40:43], a[124:127], v[88:91], v[40:43]
  v_mfma_f32_16x16x32_bf16 v[44:47], a[124:127], v[92:95], v[44:47]
  v_mfma_f32_16x16x32_bf16 v[48:51], v[88:91], a[204:207], v[48:51]
  v_mfma_f32_16x16x32_bf16 v[52:55], v[92:95], a[204:207], v[52:55]
  v_mfma_f32_16x16x32_bf16 v[56:59], v[88:91], v[140:143], v[56:59]
  v_mfma_f32_16x16x32_bf16 v[60:63], v[92:95], v[140:143], v[60:63]
  v_mfma_f32_16x16x32_bf16 v[64:67], v[88:91], v[220:223], v[64:67]
  v_mfma_f32_16x16x32_bf16 v[68:71], v[92:95], v[220:223], v[68:71]
  ds_read_b128 v[88:91], v7 offset:14336
  ds_read_b128 v[92:95], v7 offset:34816
  s_waitcnt lgkmcnt(4)
  v_mfma_f32_16x16x32_bf16 v[32:35], a[48:51], v[72:75], v[32:35]
  v_mfma_f32_16x16x32_bf16 v[36:39], a[48:51], v[76:79], v[36:39]
  v_mfma_f32_16x16x32_bf16 v[40:43], a[128:131], v[72:75], v[40:43]
  v_mfma_f32_16x16x32_bf16 v[44:47], a[128:131], v[76:79], v[44:47]
  v_mfma_f32_16x16x32_bf16 v[48:51], v[72:75], a[208:211], v[48:51]
  v_mfma_f32_16x16x32_bf16 v[52:55], v[76:79], a[208:211], v[52:55]
  v_mfma_f32_16x16x32_bf16 v[56:59], v[72:75], v[144:147], v[56:59]
  v_mfma_f32_16x16x32_bf16 v[60:63], v[76:79], v[144:147], v[60:63]
  v_mfma_f32_16x16x32_bf16 v[64:67], v[72:75], v[224:227], v[64:67]
  v_mfma_f32_16x16x32_bf16 v[68:71], v[76:79], v[224:227], v[68:71]
  ds_read_b128 v[72:75], v7 offset:15360
  ds_read_b128 v[76:79], v7 offset:35840
  s_waitcnt lgkmcnt(4)
  v_mfma_f32_16x16x32_bf16 v[32:35], a[52:55], v[80:83], v[32:35]
  v_mfma_f32_16x16x32_bf16 v[36:39], a[52:55], v[84:87], v[36:39]
  v_mfma_f32_16x16x32_bf16 v[40:43], a[132:135], v[80:83], v[40:43]
  v_mfma_f32_16x16x32_bf16 v[44:47], a[132:135], v[84:87], v[44:47]
  v_mfma_f32_16x16x32_bf16 v[48:51], v[80:83], a[212:215], v[48:51]
  v_mfma_f32_16x16x32_bf16 v[52:55], v[84:87], a[212:215], v[52:55]
  v_mfma_f32_16x16x32_bf16 v[56:59], v[80:83], v[148:151], v[56:59]
  v_mfma_f32_16x16x32_bf16 v[60:63], v[84:87], v[148:151], v[60:63]
  v_mfma_f32_16x16x32_bf16 v[64:67], v[80:83], v[228:231], v[64:67]
  v_mfma_f32_16x16x32_bf16 v[68:71], v[84:87], v[228:231], v[68:71]
  ds_read_b128 v[80:83], v7 offset:16384
  ds_read_b128 v[84:87], v7 offset:36864
  s_waitcnt lgkmcnt(4)
  v_mfma_f32_16x16x32_bf16 v[32:35], a[56:59], v[88:91], v[32:35]
  v_mfma_f32_16x16x32_bf16 v[36:39], a[56:59], v[92:95], v[36:39]
  v_mfma_f32_16x16x32_bf16 v[40:43], a[136:139], v[88:91], v[40:43]
  v_mfma_f32_16x16x32_bf16 v[44:47], a[136:139], v[92:95], v[44:47]
  v_mfma_f32_16x16x32_bf16 v[48:51], v[88:91], a[216:219], v[48:51]
  v_mfma_f32_16x16x32_bf16 v[52:55], v[92:95], a[216:219], v[52:55]
  v_mfma_f32_16x16x32_bf16 v[56:59], v[88:91], v[152:155], v[56:59]
  v_mfma_f32_16x16x32_bf16 v[60:63], v[92:95], v[152:155], v[60:63]
  v_mfma_f32_16x16x32_bf16 v[64:67], v[88:91], v[232:235], v[64:67]
  v_mfma_f32_16x16x32_bf16 v[68:71], v[92:95], v[232:235], v[68:71]
  ds_read_b128 v[88:91], v7 offset:17408
  ds_read_b128 v[92:95], v7 offset:37888
  s_waitcnt lgkmcnt(4)
  v_mfma_f32_16x16x32_bf16 v[32:35], a[60:63], v[72:75], v[32:35]
  v_mfma_f32_16x16x32_bf16 v[36:39], a[60:63], v[76:79], v[36:39]
  v_mfma_f32_16x16x32_bf16 v[40:43], a[140:143], v[72:75], v[40:43]
  v_mfma_f32_16x16x32_bf16 v[44:47], a[140:143], v[76:79], v[44:47]
  v_mfma_f32_16x16x32_bf16 v[48:51], v[72:75], a[220:223], v[48:51]
  v_mfma_f32_16x16x32_bf16 v[52:55], v[76:79], a[220:223], v[52:55]
  v_mfma_f32_16x16x32_bf16 v[56:59], v[72:75], v[156:159], v[56:59]
  v_mfma_f32_16x16x32_bf16 v[60:63], v[76:79], v[156:159], v[60:63]
  v_mfma_f32_16x16x32_bf16 v[64:67], v[72:75], v[236:239], v[64:67]
  v_mfma_f32_16x16x32_bf16 v[68:71], v[76:79], v[236:239], v[68:71]
  ds_read_b128 v[72:75], v7 offset:18432
  ds_read_b128 v[76:79], v7 offset:38912
  s_waitcnt lgkmcnt(4)
  v_mfma_f32_16x16x32_bf16 v[32:35], a[64:67], v[80:83], v[32:35]
  v_mfma_f32_16x16x32_bf16 v[36:39], a[64:67], v[84:87], v[36:39]
  v_mfma_f32_16x16x32_bf16 v[40:43], a[144:147], v[80:83], v[40:43]
  v_mfma_f32_16x16x32_bf16 v[44:47], a[144:147], v[84:87], v[44:47]
  v_mfma_f32_16x16x32_bf16 v[48:51], v[80:83], a[224:227], v[48:51]
  v_mfma_f32_16x16x32_bf16 v[52:55], v[84:87], a[224:227], v[52:55]
  v_mfma_f32_16x16x32_bf16 v[56:59], v[80:83], v[160:163], v[56:59]
  v_mfma_f32_16x16x32_bf16 v[60:63], v[84:87], v[160:163], v[60:63]
  v_mfma_f32_16x16x32_bf16 v[64:67], v[80:83], v[240:243], v[64:67]
  v_mfma_f32_16x16x32_bf16 v[68:71], v[84:87], v[240:243], v[68:71]
  ds_read_b128 v[80:83], v7 offset:19456
  ds_read_b128 v[84:87], v7 offset:39936
  s_waitcnt lgkmcnt(4)
  v_mfma_f32_16x16x32_bf16 v[32:35], a[68:71], v[88:91], v[32:35]
  v_mfma_f32_16x16x32_bf16 v[36:39], a[68:71], v[92:95], v[36:39]
  v_mfma_f32_16x16x32_bf16 v[40:43], a[148:151], v[88:91], v[40:43]
  v_mfma_f32_16x16x32_bf16 v[44:47], a[148:151], v[92:95], v[44:47]
  v_mfma_f32_16x16x32_bf16 v[48:51], v[88:91], a[228:231], v[48:51]
  v_mfma_f32_16x16x32_bf16 v[52:55], v[92:95], a[228:231], v[52:55]
  v_mfma_f32_16x16x32_bf16 v[56:59], v[88:91], v[164:167], v[56:59]
  v_mfma_f32_16x16x32_bf16 v[60:63], v[92:95], v[164:167], v[60:63]
  v_mfma_f32_16x16x32_bf16 v[64:67], v[88:91], v[244:247], v[64:67]
  v_mfma_f32_16x16x32_bf16 v[68:71], v[92:95], v[244:247], v[68:71]
  s_waitcnt lgkmcnt(2)
  v_mfma_f32_16x16x32_bf16 v[32:35], a[72:75], v[72:75], v[32:35]
  v_mfma_f32_16x16x32_bf16 v[36:39], a[72:75], v[76:79], v[36:39]
  v_mfma_f32_16x16x32_bf16 v[40:43], a[152:155], v[72:75], v[40:43]
  v_mfma_f32_16x16x32_bf16 v[44:47], a[152:155], v[76:79], v[44:47]
  v_mfma_f32_16x16x32_bf16 v[48:51], v[72:75], a[232:235], v[48:51]
  v_mfma_f32_16x16x32_bf16 v[52:55], v[76:79], a[232:235], v[52:55]
  v_mfma_f32_16x16x32_bf16 v[56:59], v[72:75], v[168:171], v[56:59]
  v_mfma_f32_16x16x32_bf16 v[60:63], v[76:79], v[168:171], v[60:63]
  v_mfma_f32_16x16x32_bf16 v[64:67], v[72:75], v[248:251], v[64:67]
  v_mfma_f32_16x16x32_bf16 v[68:71], v[76:79], v[248:251], v[68:71]
  s_waitcnt lgkmcnt(0)
  v_mfma_f32_16x16x32_bf16 v[32:35], a[76:79], v[80:83], v[32:35]
  v_mfma_f32_16x16x32_bf16 v[36:39], a[76:79], v[84:87], v[36:39]
  v_mfma_f32_16x16x32_bf16 v[40:43], a[156:159], v[80:83], v[40:43]
  v_mfma_f32_16x16x32_bf16 v[44:47], a[156:159], v[84:87], v[44:47]
  v_mfma_f32_16x16x32_bf16 v[48:51], v[80:83], a[236:239], v[48:51]
  v_mfma_f32_16x16x32_bf16 v[52:55], v[84:87], a[236:239], v[52:55]
  v_mfma_f32_16x16x32_bf16 v[56:59], v[80:83], v[172:175], v[56:59]
  v_mfma_f32_16x16x32_bf16 v[60:63], v[84:87], v[172:175], v[60:63]
  v_mfma_f32_16x16x32_bf16 v[64:67], v[80:83], v[252:255], v[64:67]
  v_mfma_f32_16x16x32_bf16 v[68:71], v[84:87], v[252:255], v[68:71]
  v_cvt_pk_bf16_f32 v8, v32, v33
  v_cvt_pk_bf16_f32 v9, v34, v35
  v_cvt_pk_bf16_f32 v10, v40, v41
  v_cvt_pk_bf16_f32 v11, v42, v43
  s_add_u32 s34, s21, 2048
  buffer_store_dwordx4 v[8:11], v1, s[4:7], s34 offen sc1
  v_cvt_pk_bf16_f32 v12, v36, v37
  v_cvt_pk_bf16_f32 v13, v38, v39
  v_cvt_pk_bf16_f32 v14, v44, v45
  v_cvt_pk_bf16_f32 v15, v46, v47
  s_add_u32 s34, s21, 8192
  buffer_store_dwordx4 v[12:15], v1, s[4:7], s34 offen sc1
  v_cvt_pk_bf16_f32 v8, v48, v49
  v_cvt_pk_bf16_f32 v9, v50, v51
  v_cvt_pk_bf16_f32 v10, v52, v53
  v_cvt_pk_bf16_f32 v11, v54, v55
  s_add_u32 s34, s23, 1024
  buffer_store_dwordx4 v[8:11], v1, s[4:7], s34 offen sc1
  v_cvt_pk_bf16_f32 v12, v56, v57
  v_cvt_pk_bf16_f32 v13, v58, v59
  v_cvt_pk_bf16_f32 v14, v60, v61
  v_cvt_pk_bf16_f32 v15, v62, v63
  s_add_u32 s34, s23, 2048
  buffer_store_dwordx4 v[12:15], v1, s[4:7], s34 offen sc1
  v_cvt_pk_bf16_f32 v8, v64, v65
  v_cvt_pk_bf16_f32 v9, v66, v67
  v_cvt_pk_bf16_f32 v10, v68, v69
  v_cvt_pk_bf16_f32 v11, v70, v71
  s_add_u32 s34, s23, 3072
  buffer_store_dwordx4 v[8:11], v1, s[4:7], s34 offen sc1
  s_waitcnt vmcnt(0)
  s_barrier
  s_add_u32 s17, s17, 1
  s_cmp_lt_u32 s17, 64
  s_cbranch_scc1 reca_ptop251
  s_branch reca_exit1
reca_pw2_228:
  s_mov_b32 s17, 0
  s_mov_b32 s26, 0
  s_mul_i32 s20, s17, 40960
  s_add_u32 s20, s20, 84955136
  s_add_u32 m0, s26, 20480
  s_nop 0
  buffer_load_dwordx4 v1, s[4:7], s20 offen offset:0 lds
  buffer_load_dwordx4 v1, s[4:7], s20 offen offset:1024 lds
  buffer_load_dwordx4 v1, s[4:7], s20 offen offset:2048 lds
  buffer_load_dwordx4 v1, s[4:7], s20 offen offset:3072 lds
  s_add_u32 s20, s20, 4096
  s_add_u32 m0, s26, 24576
  s_nop 0
  buffer_load_dwordx4 v1, s[4:7], s20 offen offset:0 lds
  buffer_load_dwordx4 v1, s[4:7], s20 offen offset:1024 lds
  buffer_load_dwordx4 v1, s[4:7], s20 offen offset:2048 lds
  buffer_load_dwordx4 v1, s[4:7], s20 offen offset:3072 lds
  s_add_u32 s20, s20, 4096
  s_add_u32 m0, s26, 28672
  s_nop 0
  buffer_load_dwordx4 v1, s[4:7], s20 offen offset:0 lds
  buffer_load_dwordx4 v1, s[4:7], s20 offen offset:1024 lds
  s_mul_i32 s34, s15, 12
  s_mul_i32 s35, s16, 6
  s_add_u32 s34, s34, s35
  s_add_u32 s34, s34, 0
  s_mul_i32 s34, s34, 20480
  s_add_u32 s34, s34, 6291456
  buffer_load_dwordx4 a[0:3], v1, s[4:7], s34 offen offset:0
  buffer_load_dwordx4 a[4:7], v1, s[4:7], s34 offen offset:1024
  buffer_load_dwordx4 a[8:11], v1, s[4:7], s34 offen offset:2048
  buffer_load_dwordx4 a[12:15], v1, s[4:7], s34 offen offset:3072
  s_add_u32 s34, s34, 4096
  buffer_load_dwordx4 a[16:19], v1, s[4:7], s34 offen offset:0
  buffer_load_dwordx4 a[20:23], v1, s[4:7], s34 offen offset:1024
  buffer_load_dwordx4 a[24:27], v1, s[4:7], s34 offen offset:2048
  buffer_load_dwordx4 a[28:31], v1, s[4:7], s34 offen offset:3072
  s_add_u32 s34, s34, 4096
  buffer_load_dwordx4 a[32:35], v1, s[4:7], s34 offen offset:0
  buffer_load_dwordx4 a[36:39], v1, s[4:7], s34 offen offset:1024
  buffer_load_dwordx4 a[40:43], v1, s[4:7], s34 offen offset:2048
  buffer_load_dwordx4 a[44:47], v1, s[4:7], s34 offen offset:3072
  s_add_u32 s34, s34, 4096
  buffer_load_dwordx4 a[48:51], v1, s[4:7], s34 offen offset:0
  buffer_load_dwordx4 a[52:55], v1, s[4:7], s34 offen offset:1024
  buffer_load_dwordx4 a[56:59], v1, s[4:7], s34 offen offset:2048
  buffer_load_dwordx4 a[60:63], v1, s[4:7], s34 offen offset:3072
  s_add_u32 s34, s34, 4096
  buffer_load_dwordx4 a[64:67], v1, s[4:7], s34 offen offset:0
  buffer_load_dwordx4 a[68:71], v1, s[4:7], s34 offen offset:1024
  buffer_load_dwordx4 a[72:75], v1, s[4:7], s34 offen offset:2048
  buffer_load_dwordx4 a[76:79], v1, s[4:7], s34 offen offset:3072
  s_mul_i32 s34, s15, 12
  s_mul_i32 s35, s16, 6
  s_add_u32 s34, s34, s35
  s_add_u32 s34, s34, 1
  s_mul_i32 s34, s34, 20480
  s_add_u32 s34, s34, 6291456
  buffer_load_dwordx4 a[80:83], v1, s[4:7], s34 offen offset:0
  buffer_load_dwordx4 a[84:87], v1, s[4:7], s34 offen offset:1024
  buffer_load_dwordx4 a[88:91], v1, s[4:7], s34 offen offset:2048
  buffer_load_dwordx4 a[92:95], v1, s[4:7], s34 offen offset:3072
  s_add_u32 s34, s34, 4096
  buffer_load_dwordx4 a[96:99], v1, s[4:7], s34 offen offset:0
  buffer_load_dwordx4 a[100:103], v1, s[4:7], s34 offen offset:1024
  buffer_load_dwordx4 a[104:107], v1, s[4:7], s34 offen offset:2048
  buffer_load_dwordx4 a[108:111], v1, s[4:7], s34 offen offset:3072
  s_add_u32 s34, s34, 4096
  buffer_load_dwordx4 a[112:115], v1, s[4:7], s34 offen offset:0
  buffer_load_dwordx4 a[116:119], v1, s[4:7], s34 offen offset:1024
  buffer_load_dwordx4 a[120:123], v1, s[4:7], s34 offen offset:2048
  buffer_load_dwordx4 a[124:127], v1, s[4:7], s34 offen offset:3072
  s_add_u32 s34, s34, 4096
  buffer_load_dwordx4 a[128:131], v1, s[4:7], s34 offen offset:0
  buffer_load_dwordx4 a[132:135], v1, s[4:7], s34 offen offset:1024
  buffer_load_dwordx4 a[136:139], v1, s[4:7], s34 offen offset:2048
  buffer_load_dwordx4 a[140:143], v1, s[4:7], s34 offen offset:3072
  s_add_u32 s34, s34, 4096
  buffer_load_dwordx4 a[144:147], v1, s[4:7], s34 offen offset:0
  buffer_load_dwordx4 a[148:151], v1, s[4:7], s34 offen offset:1024
  buffer_load_dwordx4 a[152:155], v1, s[4:7], s34 offen offset:2048
  buffer_load_dwordx4 a[156:159], v1, s[4:7], s34 offen offset:3072
  s_waitcnt vmcnt(20)
  s_mul_i32 s34, s15, 12
  s_mul_i32 s35, s16, 6
  s_add_u32 s34, s34, s35
  s_add_u32 s34, s34, 4
  s_mul_i32 s34, s34, 20480
  s_add_u32 s34, s34, 22020096
  buffer_load_dwordx4 a[160:163], v1, s[4:7], s34 offen offset:0
  buffer_load_dwordx4 a[164:167], v1, s[4:7], s34 offen offset:1024
  buffer_load_dwordx4 a[168:171], v1, s[4:7], s34 offen offset:2048
  buffer_load_dwordx4 a[172:175], v1, s[4:7], s34 offen offset:3072
  s_add_u32 s34, s34, 4096
  buffer_load_dwordx4 a[176:179], v1, s[4:7], s34 offen offset:0
  buffer_load_dwordx4 a[180:183], v1, s[4:7], s34 offen offset:1024
  buffer_load_dwordx4 a[184:187], v1, s[4:7], s34 offen offset:2048
  buffer_load_dwordx4 a[188:191], v1, s[4:7], s34 offen offset:3072
  s_add_u32 s34, s34, 4096
  buffer_load_dwordx4 a[192:195], v1, s[4:7], s34 offen offset:0
  buffer_load_dwordx4 a[196:199], v1, s[4:7], s34 offen offset:1024
  buffer_load_dwordx4 a[200:203], v1, s[4:7], s34 offen offset:2048
  buffer_load_dwordx4 a[204:207], v1, s[4:7], s34 offen offset:3072
  s_add_u32 s34, s34, 4096
  buffer_load_dwordx4 a[208:211], v1, s[4:7], s34 offen offset:0
  buffer_load_dwordx4 a[212:215], v1, s[4:7], s34 offen offset:1024
  buffer_load_dwordx4 a[216:219], v1, s[4:7], s34 offen offset:2048
  buffer_load_dwordx4 a[220:223], v1, s[4:7], s34 offen offset:3072
  s_add_u32 s34, s34, 4096
  buffer_load_dwordx4 a[224:227], v1, s[4:7], s34 offen offset:0
  buffer_load_dwordx4 a[228:231], v1, s[4:7], s34 offen offset:1024
  buffer_load_dwordx4 a[232:235], v1, s[4:7], s34 offen offset:2048
  buffer_load_dwordx4 a[236:239], v1, s[4:7], s34 offen offset:3072
  s_waitcnt vmcnt(20)
  s_mul_i32 s34, s15, 12
  s_mul_i32 s35, s16, 6
  s_add_u32 s34, s34, s35
  s_add_u32 s34, s34, 5
  s_mul_i32 s34, s34, 20480
  s_add_u32 s34, s34, 22020096
  buffer_load_dwordx4 v[96:99], v1, s[4:7], s34 offen offset:0
  buffer_load_dwordx4 v[100:103], v1, s[4:7], s34 offen offset:1024
  buffer_load_dwordx4 v[104:107], v1, s[4:7], s34 offen offset:2048
  buffer_load_dwordx4 v[108:111], v1, s[4:7], s34 offen offset:3072
  s_add_u32 s34, s34, 4096
  buffer_load_dwordx4 v[112:115], v1, s[4:7], s34 offen offset:0
  buffer_load_dwordx4 v[116:119], v1, s[4:7], s34 offen offset:1024
  buffer_load_dwordx4 v[120:123], v1, s[4:7], s34 offen offset:2048
  buffer_load_dwordx4 v[124:127], v1, s[4:7], s34 offen offset:3072
  s_add_u32 s34, s34, 4096
  buffer_load_dwordx4 v[128:131], v1, s[4:7], s34 offen offset:0
  buffer_load_dwordx4 v[132:135], v1, s[4:7], s34 offen offset:1024
  buffer_load_dwordx4 v[136:139], v1, s[4:7], s34 offen offset:2048
  buffer_load_dwordx4 v[140:143], v1, s[4:7], s34 offen offset:3072
  s_add_u32 s34, s34, 4096
  buffer_load_dwordx4 v[144:147], v1, s[4:7], s34 offen offset:0
  buffer_load_dwordx4 v[148:151], v1, s[4:7], s34 offen offset:1024
  buffer_load_dwordx4 v[152:155], v1, s[4:7], s34 offen offset:2048
  buffer_load_dwordx4 v[156:159], v1, s[4:7], s34 offen offset:3072
  s_add_u32 s34, s34, 4096
  buffer_load_dwordx4 v[160:163], v1, s[4:7], s34 offen offset:0
  buffer_load_dwordx4 v[164:167], v1, s[4:7], s34 offen offset:1024
  buffer_load_dwordx4 v[168:171], v1, s[4:7], s34 offen offset:2048
  buffer_load_dwordx4 v[172:175], v1, s[4:7], s34 offen offset:3072
  s_waitcnt vmcnt(20)
  v_and_b32 v30, 7, v0
  v_lshlrev_b32 v30, 3, v30
reca_cens256:
  buffer_load_dwordx2 v[28:29], v30, s[8:11], 0 offen sc1
  s_waitcnt vmcnt(0)
  v_sad_u8 v31, v28, 0, 0
  v_sad_u8 v31, v29, 0, v31
  v_cmp_gt_u32 vcc, 32, v31
  s_cbranch_vccz reca_censok257
  s_sleep 8
  s_sub_u32 s18, s18, 1
  s_cbranch_scc0 reca_cens256
  s_mov_b32 s18, 0
reca_censok257:
  v_and_b32 v28, 0x20202020, v28
  v_and_b32 v29, 0x20202020, v29
  v_cmp_ne_u32 s[34:35], 0, v28
  v_cmp_ne_u32 s[36:37], 0, v29
  s_nop 3
  s_and_b32 s34, s34, 0xff
  s_and_b32 s36, s36, 0xff
  s_or_b32 s35, s34, s36
  s_lshr_b32 s37, s35, s13
  s_and_b32 s37, s37, 1
  s_xor_b32 s43, s37, 1
  s_cmp_eq_u32 s57, 0
  s_cselect_b32 s58, s36, s34
  v_mov_b32 v31, 0x80000000
  s_cmp_lg_u32 s43, 0
  s_cbranch_scc1 reca_pslow258
reca_ptop259:
  s_cmp_lt_u32 s17, 3
  s_cbranch_scc1 reca_pgo260
  s_sub_u32 s36, s17, 3
reca_ppoll261:
  buffer_load_dword v28, v4, s[4:7], s25 offen sc1
  s_waitcnt vmcnt(0)
  v_readfirstlane_b32 s34, v28
  s_nop 3
  s_cmp_ge_i32 s34, s36
  s_cbranch_scc1 reca_pgo260
  s_sleep 8
  s_sub_u32 s18, s18, 1
  s_cbranch_scc0 reca_ppoll261
  s_mov_b32 s18, 0
reca_pgo260:
  s_waitcnt vmcnt(0)
  s_barrier
  v_add_u32 v7, s26, v1
  s_xor_b32 s26, s26, 40960
  s_add_u32 s37, s17, 1
  s_cmp_ge_u32 s37, 64
  s_cbranch_scc1 reca_pnodma262
  s_mul_i32 s20, s37, 40960
  s_add_u32 s20, s20, 84955136
  s_add_u32 m0, s26, 20480
  s_nop 0
  buffer_load_dwordx4 v1, s[4:7], s20 offen offset:0 lds
  buffer_load_dwordx4 v1, s[4:7], s20 offen offset:1024 lds
  buffer_load_dwordx4 v1, s[4:7], s20 offen offset:2048 lds
  buffer_load_dwordx4 v1, s[4:7], s20 offen offset:3072 lds
  s_add_u32 s20, s20, 4096
  s_add_u32 m0, s26, 24576
  s_nop 0
  buffer_load_dwordx4 v1, s[4:7], s20 offen offset:0 lds
  buffer_load_dwordx4 v1, s[4:7], s20 offen offset:1024 lds
  buffer_load_dwordx4 v1, s[4:7], s20 offen offset:2048 lds
  buffer_load_dwordx4 v1, s[4:7], s20 offen offset:3072 lds
  s_add_u32 s20, s20, 4096
  s_add_u32 m0, s26, 28672
  s_nop 0
  buffer_load_dwordx4 v1, s[4:7], s20 offen offset:0 lds
  buffer_load_dwordx4 v1, s[4:7], s20 offen offset:1024 lds
reca_pnodma262:
  s_lshl_b32 s34, s15, 3
  s_and_b32 s35, s17, 7
  s_add_u32 s34, s34, s35
  s_mul_i32 s34, s34, 12288
  s_mul_i32 s35, s16, 3072
  s_add_u32 s35, s35, s34
  s_add_u32 s21, s35, 37748736
  s_add_u32 s22, s35, 44040192
  s_mul_i32 s35, s16, 6144
  s_add_u32 s35, s35, s34
  s_add_u32 s23, s35, 40894464
  ds_read_b128 v[72:75], v7 offset:0
  ds_read_b128 v[76:79], v7 offset:20480
  ds_read_b128 v[80:83], v7 offset:1024
  ds_read_b128 v[84:87], v7 offset:21504
  ds_read_b128 v[88:91], v7 offset:2048
  ds_read_b128 v[92:95], v7 offset:22528
  s_waitcnt lgkmcnt(4)
  v_mfma_f32_16x16x32_bf16 v[32:35], a[0:3], v[72:75], 0
  v_mfma_f32_16x16x32_bf16 v[36:39], a[0:3], v[76:79], 0
  v_mfma_f32_16x16x32_bf16 v[40:43], a[80:83], v[72:75], 0
  v_mfma_f32_16x16x32_bf16 v[44:47], a[80:83], v[76:79], 0
  v_mfma_f32_16x16x32_bf16 v[48:51], v[72:75], a[160:163], 0
  v_mfma_f32_16x16x32_bf16 v[52:55], v[76:79], a[160:163], 0
  v_mfma_f32_16x16x32_bf16 v[56:59], v[72:75], v[96:99], 0
  v_mfma_f32_16x16x32_bf16 v[60:63], v[76:79], v[96:99], 0
  ds_read_b128 v[72:75], v7 offset:3072
  ds_read_b128 v[76:79], v7 offset:23552
  s_waitcnt lgkmcnt(4)
  v_mfma_f32_16x16x32_bf16 v[32:35], a[4:7], v[80:83], v[32:35]
  v_mfma_f32_16x16x32_bf16 v[36:39], a[4:7], v[84:87], v[36:39]
  v_mfma_f32_16x16x32_bf16 v[40:43], a[84:87], v[80:83], v[40:43]
  v_mfma_f32_16x16x32_bf16 v[44:47], a[84:87], v[84:87], v[44:47]
  v_mfma_f32_16x16x32_bf16 v[48:51], v[80:83], a[164:167], v[48:51]
  v_mfma_f32_16x16x32_bf16 v[52:55], v[84:87], a[164:167], v[52:55]
  v_mfma_f32_16x16x32_bf16 v[56:59], v[80:83], v[100:103], v[56:59]
  v_mfma_f32_16x16x32_bf16 v[60:63], v[84:87], v[100:103], v[60:63]
  ds_read_b128 v[80:83], v7 offset:4096
  ds_read_b128 v[84:87], v7 offset:24576
  s_waitcnt lgkmcnt(4)
  v_mfma_f32_16x16x32_bf16 v[32:35], a[8:11], v[88:91], v[32:35]
  v_mfma_f32_16x16x32_bf16 v[36:39], a[8:11], v[92:95], v[36:39]
  v_mfma_f32_16x16x32_bf16 v[40:43], a[88:91], v[88:91], v[40:43]
  v_mfma_f32_16x16x32_bf16 v[44:47], a[88:91], v[92:95], v[44:47]
  v_mfma_f32_16x16x32_bf16 v[48:51], v[88:91], a[168:171], v[48:51]
  v_mfma_f32_16x16x32_bf16 v[52:55], v[92:95], a[168:171], v[52:55]
  v_mfma_f32_16x16x32_bf16 v[56:59], v[88:91], v[104:107], v[56:59]
  v_mfma_f32_16x16x32_bf16 v[60:63], v[92:95], v[104:107], v[60:63]
  ds_read_b128 v[88:91], v7 offset:5120
  ds_read_b128 v[92:95], v7 offset:25600
  s_waitcnt lgkmcnt(4)
  v_mfma_f32_16x16x32_bf16 v[32:35], a[12:15], v[72:75], v[32:35]
  v_mfma_f32_16x16x32_bf16 v[36:39], a[12:15], v[76:79], v[36:39]
  v_mfma_f32_16x16x32_bf16 v[40:43], a[92:95], v[72:75], v[40:43]
  v_mfma_f32_16x16x32_bf16 v[44:47], a[92:95], v[76:79], v[44:47]
  v_mfma_f32_16x16x32_bf16 v[48:51], v[72:75], a[172:175], v[48:51]
  v_mfma_f32_16x16x32_bf16 v[52:55], v[76:79], a[172:175], v[52:55]
  v_mfma_f32_16x16x32_bf16 v[56:59], v[72:75], v[108:111], v[56:59]
  v_mfma_f32_16x16x32_bf16 v[60:63], v[76:79], v[108:111], v[60:63]
  ds_read_b128 v[72:75], v7 offset:6144
  ds_read_b128 v[76:79], v7 offset:26624
  s_waitcnt lgkmcnt(4)
  v_mfma_f32_16x16x32_bf16 v[32:35], a[16:19], v[80:83], v[32:35]
  v_mfma_f32_16x16x32_bf16 v[36:39], a[16:19], v[84:87], v[36:39]
  v_mfma_f32_16x16x32_bf16 v[40:43], a[96:99], v[80:83], v[40:43]
  v_mfma_f32_16x16x32_bf16 v[44:47], a[96:99], v[84:87], v[44:47]
  v_mfma_f32_16x16x32_bf16 v[48:51], v[80:83], a[176:179], v[48:51]
  v_mfma_f32_16x16x32_bf16 v[52:55], v[84:87], a[176:179], v[52:55]
  v_mfma_f32_16x16x32_bf16 v[56:59], v[80:83], v[112:115], v[56:59]
  v_mfma_f32_16x16x32_bf16 v[60:63], v[84:87], v[112:115], v[60:63]
  ds_read_b128 v[80:83], v7 offset:7168
  ds_read_b128 v[84:87], v7 offset:27648
  s_waitcnt lgkmcnt(4)
  v_mfma_f32_16x16x32_bf16 v[32:35], a[20:23], v[88:91], v[32:35]
  v_mfma_f32_16x16x32_bf16 v[36:39], a[20:23], v[92:95], v[36:39]
  v_mfma_f32_16x16x32_bf16 v[40:43], a[100:103], v[88:91], v[40:43]
  v_mfma_f32_16x16x32_bf16 v[44:47], a[100:103], v[92:95], v[44:47]
  v_mfma_f32_16x16x32_bf16 v[48:51], v[88:91], a[180:183], v[48:51]
  v_mfma_f32_16x16x32_bf16 v[52:55], v[92:95], a[180:183], v[52:55]
  v_mfma_f32_16x16x32_bf16 v[56:59], v[88:91], v[116:119], v[56:59]
  v_mfma_f32_16x16x32_bf16 v[60:63], v[92:95], v[116:119], v[60:63]
  ds_read_b128 v[88:91], v7 offset:8192
  ds_read_b128 v[92:95], v7 offset:28672
  s_waitcnt lgkmcnt(4)
  v_mfma_f32_16x16x32_bf16 v[32:35], a[24:27], v[72:75], v[32:35]
  v_mfma_f32_16x16x32_bf16 v[36:39], a[24:27], v[76:79], v[36:39]
  v_mfma_f32_16x16x32_bf16 v[40:43], a[104:107], v[72:75], v[40:43]
  v_mfma_f32_16x16x32_bf16 v[44:47], a[104:107], v[76:79], v[44:47]
  v_mfma_f32_16x16x32_bf16 v[48:51], v[72:75], a[184:187], v[48:51]
  v_mfma_f32_16x16x32_bf16 v[52:55], v[76:79], a[184:187], v[52:55]
  v_mfma_f32_16x16x32_bf16 v[56:59], v[72:75], v[120:123], v[56:59]
  v_mfma_f32_16x16x32_bf16 v[60:63], v[76:79], v[120:123], v[60:63]
  ds_read_b128 v[72:75], v7 offset:9216
  ds_read_b128 v[76:79], v7 offset:29696
  s_waitcnt lgkmcnt(4)
  v_mfma_f32_16x16x32_bf16 v[32:35], a[28:31], v[80:83], v[32:35]
  v_mfma_f32_16x16x32_bf16 v[36:39], a[28:31], v[84:87], v[36:39]
  v_mfma_f32_16x16x32_bf16 v[40:43], a[108:111], v[80:83], v[40:43]
  v_mfma_f32_16x16x32_bf16 v[44:47], a[108:111], v[84:87], v[44:47]
  v_mfma_f32_16x16x32_bf16 v[48:51], v[80:83], a[188:191], v[48:51]
  v_mfma_f32_16x16x32_bf16 v[52:55], v[84:87], a[188:191], v[52:55]
  v_mfma_f32_16x16x32_bf16 v[56:59], v[80:83], v[124:127], v[56:59]
  v_mfma_f32_16x16x32_bf16 v[60:63], v[84:87], v[124:127], v[60:63]
  ds_read_b128 v[80:83], v7 offset:10240
  ds_read_b128 v[84:87], v7 offset:30720
  s_waitcnt lgkmcnt(4)
  v_mfma_f32_16x16x32_bf16 v[32:35], a[32:35], v[88:91], v[32:35]
  v_mfma_f32_16x16x32_bf16 v[36:39], a[32:35], v[92:95], v[36:39]
  v_mfma_f32_16x16x32_bf16 v[40:43], a[112:115], v[88:91], v[40:43]
  v_mfma_f32_16x16x32_bf16 v[44:47], a[112:115], v[92:95], v[44:47]
  v_mfma_f32_16x16x32_bf16 v[48:51], v[88:91], a[192:195], v[48:51]
  v_mfma_f32_16x16x32_bf16 v[52:55], v[92:95], a[192:195], v[52:55]
  v_mfma_f32_16x16x32_bf16 v[56:59], v[88:91], v[128:131], v[56:59]
  v_mfma_f32_16x16x32_bf16 v[60:63], v[92:95], v[128:131], v[60:63]
  ds_read_b128 v[88:91], v7 offset:11264
  ds_read_b128 v[92:95], v7 offset:31744
  s_waitcnt lgkmcnt(4)
  v_mfma_f32_16x16x32_bf16 v[32:35], a[36:39], v[72:75], v[32:35]
  v_mfma_f32_16x16x32_bf16 v[36:39], a[36:39], v[76:79], v[36:39]
  v_mfma_f32_16x16x32_bf16 v[40:43], a[116:119], v[72:75], v[40:43]
  v_mfma_f32_16x16x32_bf16 v[44:47], a[116:119], v[76:79], v[44:47]
  v_mfma_f32_16x16x32_bf16 v[48:51], v[72:75], a[196:199], v[48:51]
  v_mfma_f32_16x16x32_bf16 v[52:55], v[76:79], a[196:199], v[52:55]
  v_mfma_f32_16x16x32_bf16 v[56:59], v[72:75], v[132:135], v[56:59]
  v_mfma_f32_16x16x32_bf16 v[60:63], v[76:79], v[132:135], v[60:63]
  ds_read_b128 v[72:75], v7 offset:12288
  ds_read_b128 v[76:79], v7 offset:32768
  s_waitcnt lgkmcnt(4)
  v_mfma_f32_16x16x32_bf16 v[32:35], a[40:43], v[80:83], v[32:35]
  v_mfma_f32_16x16x32_bf16 v[36:39], a[40:43], v[84:87], v[36:39]
  v_mfma_f32_16x16x32_bf16 v[40:43], a[120:123], v[80:83], v[40:43]
  v_mfma_f32_16x16x32_bf16 v[44:47], a[120:123], v[84:87], v[44:47]
  v_mfma_f32_16x16x32_bf16 v[48:51], v[80:83], a[200:203], v[48:51]
  v_mfma_f32_16x16x32_bf16 v[52:55], v[84:87], a[200:203], v[52:55]
  v_mfma_f32_16x16x32_bf16 v[56:59], v[80:83], v[136:139], v[56:59]
  v_mfma_f32_16x16x32_bf16 v[60:63], v[84:87], v[136:139], v[60:63]
  ds_read_b128 v[80:83], v7 offset:13312
  ds_read_b128 v[84:87], v7 offset:33792
  s_waitcnt lgkmcnt(4)
  v_mfma_f32_16x16x32_bf16 v[32:35], a[44:47], v[88:91], v[32:35]
  v_mfma_f32_16x16x32_bf16 v[36:39], a[44:47], v[92:95], v[36:39]
  v_mfma_f32_16x16x32_bf16 v[40:43], a[124:127], v[88:91], v[40:43]
  v_mfma_f32_16x16x32_bf16 v[44:47], a[124:127], v[92:95], v[44:47]
  v_mfma_f32_16x16x32_bf16 v[48:51], v[88:91], a[204:207], v[48:51]
  v_mfma_f32_16x16x32_bf16 v[52:55], v[92:95], a[204:207], v[52:55]
  v_mfma_f32_16x16x32_bf16 v[56:59], v[88:91], v[140:143], v[56:59]
  v_mfma_f32_16x16x32_bf16 v[60:63], v[92:95], v[140:143], v[60:63]
  ds_read_b128 v[88:91], v7 offset:14336
  ds_read_b128 v[92:95], v7 offset:34816
  s_waitcnt lgkmcnt(4)
  v_mfma_f32_16x16x32_bf16 v[32:35], a[48:51], v[72:75], v[32:35]
  v_mfma_f32_16x16x32_bf16 v[36:39], a[48:51], v[76:79], v[36:39]
  v_mfma_f32_16x16x32_bf16 v[40:43], a[128:131], v[72:75], v[40:43]
  v_mfma_f32_16x16x32_bf16 v[44:47], a[128:131], v[76:79], v[44:47]
  v_mfma_f32_16x16x32_bf16 v[48:51], v[72:75], a[208:211], v[48:51]
  v_mfma_f32_16x16x32_bf16 v[52:55], v[76:79], a[208:211], v[52:55]
  v_mfma_f32_16x16x32_bf16 v[56:59], v[72:75], v[144:147], v[56:59]
  v_mfma_f32_16x16x32_bf16 v[60:63], v[76:79], v[144:147], v[60:63]
  ds_read_b128 v[72:75], v7 offset:15360
  ds_read_b128 v[76:79], v7 offset:35840
  s_waitcnt lgkmcnt(4)
  v_mfma_f32_16x16x32_bf16 v[32:35], a[52:55], v[80:83], v[32:35]
  v_mfma_f32_16x16x32_bf16 v[36:39], a[52:55], v[84:87], v[36:39]
  v_mfma_f32_16x16x32_bf16 v[40:43], a[132:135], v[80:83], v[40:43]
  v_mfma_f32_16x16x32_bf16 v[44:47], a[132:135], v[84:87], v[44:47]
  v_mfma_f32_16x16x32_bf16 v[48:51], v[80:83], a[212:215], v[48:51]
  v_mfma_f32_16x16x32_bf16 v[52:55], v[84:87], a[212:215], v[52:55]
  v_mfma_f32_16x16x32_bf16 v[56:59], v[80:83], v[148:151], v[56:59]
  v_mfma_f32_16x16x32_bf16 v[60:63], v[84:87], v[148:151], v[60:63]
  ds_read_b128 v[80:83], v7 offset:16384
  ds_read_b128 v[84:87], v7 offset:36864
  s_waitcnt lgkmcnt(4)
  v_mfma_f32_16x16x32_bf16 v[32:35], a[56:59], v[88:91], v[32:35]
  v_mfma_f32_16x16x32_bf16 v[36:39], a[56:59], v[92:95], v[36:39]
  v_mfma_f32_16x16x32_bf16 v[40:43], a[136:139], v[88:91], v[40:43]
  v_mfma_f32_16x16x32_bf16 v[44:47], a[136:139], v[92:95], v[44:47]
  v_mfma_f32_16x16x32_bf16 v[48:51], v[88:91], a[216:219], v[48:51]
  v_mfma_f32_16x16x32_bf16 v[52:55], v[92:95], a[216:219], v[52:55]
  v_mfma_f32_16x16x32_bf16 v[56:59], v[88:91], v[152:155], v[56:59]
  v_mfma_f32_16x16x32_bf16 v[60:63], v[92:95], v[152:155], v[60:63]
  ds_read_b128 v[88:91], v7 offset:17408
  ds_read_b128 v[92:95], v7 offset:37888
  s_waitcnt lgkmcnt(4)
  v_mfma_f32_16x16x32_bf16 v[32:35], a[60:63], v[72:75], v[32:35]
  v_mfma_f32_16x16x32_bf16 v[36:39], a[60:63], v[76:79], v[36:39]
  v_mfma_f32_16x16x32_bf16 v[40:43], a[140:143], v[72:75], v[40:43]
  v_mfma_f32_16x16x32_bf16 v[44:47], a[140:143], v[76:79], v[44:47]
  v_mfma_f32_16x16x32_bf16 v[48:51], v[72:75], a[220:223], v[48:51]
  v_mfma_f32_16x16x32_bf16 v[52:55], v[76:79], a[220:223], v[52:55]
  v_mfma_f32_16x16x32_bf16 v[56:59], v[72:75], v[156:159], v[56:59]
  v_mfma_f32_16x16x32_bf16 v[60:63], v[76:79], v[156:159], v[60:63]
  ds_read_b128 v[72:75], v7 offset:18432
  ds_read_b128 v[76:79], v7 offset:38912
  s_waitcnt lgkmcnt(4)
  v_mfma_f32_16x16x32_bf16 v[32:35], a[64:67], v[80:83], v[32:35]
  v_mfma_f32_16x16x32_bf16 v[36:39], a[64:67], v[84:87], v[36:39]
  v_mfma_f32_16x16x32_bf16 v[40:43], a[144:147], v[80:83], v[40:43]
  v_mfma_f32_16x16x32_bf16 v[44:47], a[144:147], v[84:87], v[44:47]
  v_mfma_f32_16x16x32_bf16 v[48:51], v[80:83], a[224:227], v[48:51]
  v_mfma_f32_16x16x32_bf16 v[52:55], v[84:87], a[224:227], v[52:55]
  v_mfma_f32_16x16x32_bf16 v[56:59], v[80:83], v[160:163], v[56:59]
  v_mfma_f32_16x16x32_bf16 v[60:63], v[84:87], v[160:163], v[60:63]
  ds_read_b128 v[80:83], v7 offset:19456
  ds_read_b128 v[84:87], v7 offset:39936
  s_waitcnt lgkmcnt(4)
  v_mfma_f32_16x16x32_bf16 v[32:35], a[68:71], v[88:91], v[32:35]
  v_mfma_f32_16x16x32_bf16 v[36:39], a[68:71], v[92:95], v[36:39]
  v_mfma_f32_16x16x32_bf16 v[40:43], a[148:151], v[88:91], v[40:43]
  v_mfma_f32_16x16x32_bf16 v[44:47], a[148:151], v[92:95], v[44:47]
  v_mfma_f32_16x16x32_bf16 v[48:51], v[88:91], a[228:231], v[48:51]
  v_mfma_f32_16x16x32_bf16 v[52:55], v[92:95], a[228:231], v[52:55]
  v_mfma_f32_16x16x32_bf16 v[56:59], v[88:91], v[164:167], v[56:59]
  v_mfma_f32_16x16x32_bf16 v[60:63], v[92:95], v[164:167], v[60:63]
  s_waitcnt lgkmcnt(2)
  v_mfma_f32_16x16x32_bf16 v[32:35], a[72:75], v[72:75], v[32:35]
  v_mfma_f32_16x16x32_bf16 v[36:39], a[72:75], v[76:79], v[36:39]
  v_mfma_f32_16x16x32_bf16 v[40:43], a[152:155], v[72:75], v[40:43]
  v_mfma_f32_16x16x32_bf16 v[44:47], a[152:155], v[76:79], v[44:47]
  v_mfma_f32_16x16x32_bf16 v[48:51], v[72:75], a[232:235], v[48:51]
  v_mfma_f32_16x16x32_bf16 v[52:55], v[76:79], a[232:235], v[52:55]
  v_mfma_f32_16x16x32_bf16 v[56:59], v[72:75], v[168:171], v[56:59]
  v_mfma_f32_16x16x32_bf16 v[60:63], v[76:79], v[168:171], v[60:63]
  s_waitcnt lgkmcnt(0)
  v_mfma_f32_16x16x32_bf16 v[32:35], a[76:79], v[80:83], v[32:35]
  v_mfma_f32_16x16x32_bf16 v[36:39], a[76:79], v[84:87], v[36:39]
  v_mfma_f32_16x16x32_bf16 v[40:43], a[156:159], v[80:83], v[40:43]
  v_mfma_f32_16x16x32_bf16 v[44:47], a[156:159], v[84:87], v[44:47]
  v_mfma_f32_16x16x32_bf16 v[48:51], v[80:83], a[236:239], v[48:51]
  v_mfma_f32_16x16x32_bf16 v[52:55], v[84:87], a[236:239], v[52:55]
  v_mfma_f32_16x16x32_bf16 v[56:59], v[80:83], v[172:175], v[56:59]
  v_mfma_f32_16x16x32_bf16 v[60:63], v[84:87], v[172:175], v[60:63]
  s_nop 0
  v_cvt_pk_bf16_f32 v8, v32, v33
  v_cvt_pk_bf16_f32 v9, v34, v35
  v_cvt_pk_bf16_f32 v10, v40, v41
  v_cvt_pk_bf16_f32 v11, v42, v43
  s_add_u32 s34, s22, 0
  buffer_store_dwordx4 v[8:11], v1, s[4:7], s34 offen
  v_cvt_pk_bf16_f32 v12, v36, v37
  v_cvt_pk_bf16_f32 v13, v38, v39
  v_cvt_pk_bf16_f32 v14, v44, v45
  v_cvt_pk_bf16_f32 v15, v46, v47
  s_add_u32 s34, s22, 6144
  buffer_store_dwordx4 v[12:15], v1, s[4:7], s34 offen
  v_cvt_pk_bf16_f32 v8, v48, v49
  v_cvt_pk_bf16_f32 v9, v50, v51
  v_cvt_pk_bf16_f32 v10, v52, v53
  v_cvt_pk_bf16_f32 v11, v54, v55
  s_add_u32 s34, s23, 4096
  buffer_store_dwordx4 v[8:11], v1, s[4:7], s34 offen
  v_cvt_pk_bf16_f32 v12, v56, v57
  v_cvt_pk_bf16_f32 v13, v58, v59
  v_cvt_pk_bf16_f32 v14, v60, v61
  v_cvt_pk_bf16_f32 v15, v62, v63
  s_add_u32 s34, s23, 5120
  buffer_store_dwordx4 v[12:15], v1, s[4:7], s34 offen
  s_waitcnt vmcnt(0)
  s_barrier
  s_add_u32 s17, s17, 1
  s_cmp_lt_u32 s17, 64
  s_cbranch_scc1 reca_ptop259
  s_branch reca_exit1
reca_pslow258:
reca_ptop264:
  s_cmp_lt_u32 s17, 3
  s_cbranch_scc1 reca_pgo265
  s_sub_u32 s36, s17, 3
reca_ppoll266:
  buffer_load_dword v28, v4, s[4:7], s25 offen sc1
  s_waitcnt vmcnt(0)
  v_readfirstlane_b32 s34, v28
  s_nop 3
  s_cmp_ge_i32 s34, s36
  s_cbranch_scc1 reca_pgo265
  s_sleep 8
  s_sub_u32 s18, s18, 1
  s_cbranch_scc0 reca_ppoll266
  s_mov_b32 s18, 0
reca_pgo265:
  s_waitcnt vmcnt(0)
  s_barrier
  v_add_u32 v7, s26, v1
  s_xor_b32 s26, s26, 40960
  s_add_u32 s37, s17, 1
  s_cmp_ge_u32 s37, 64
  s_cbranch_scc1 reca_pnodma267
  s_mul_i32 s20, s37, 40960
  s_add_u32 s20, s20, 84955136
  s_add_u32 m0, s26, 20480
  s_nop 0
  buffer_load_dwordx4 v1, s[4:7], s20 offen offset:0 lds
  buffer_load_dwordx4 v1, s[4:7], s20 offen offset:1024 lds
  buffer_load_dwordx4 v1, s[4:7], s20 offen offset:2048 lds
  buffer_load_dwordx4 v1, s[4:7], s20 offen offset:3072 lds
  s_add_u32 s20, s20, 4096
  s_add_u32 m0, s26, 24576
  s_nop 0
  buffer_load_dwordx4 v1, s[4:7], s20 offen offset:0 lds
  buffer_load_dwordx4 v1, s[4:7], s20 offen offset:1024 lds
  buffer_load_dwordx4 v1, s[4:7], s20 offen offset:2048 lds
  buffer_load_dwordx4 v1, s[4:7], s20 offen offset:3072 lds
  s_add_u32 s20, s20, 4096
  s_add_u32 m0, s26, 28672
  s_nop 0
  buffer_load_dwordx4 v1, s[4:7], s20 offen offset:0 lds
  buffer_load_dwordx4 v1, s[4:7], s20 offen offset:1024 lds
reca_pnodma267:
  s_lshl_b32 s34, s15, 3
  s_and_b32 s35, s17, 7
  s_add_u32 s34, s34, s35
  s_mul_i32 s34, s34, 12288
  s_mul_i32 s35, s16, 3072
  s_add_u32 s35, s35, s34
  s_add_u32 s21, s35, 37748736
  s_add_u32 s22, s35, 44040192
  s_mul_i32 s35, s16, 6144
  s_add_u32 s35, s35, s34
  s_add_u32 s23, s35, 40894464
  ds_read_b128 v[72:75], v7 offset:0
  ds_read_b128 v[76:79], v7 offset:20480
  ds_read_b128 v[80:83], v7 offset:1024
  ds_read_b128 v[84:87], v7 offset:21504
  ds_read_b128 v[88:91], v7 offset:2048
  ds_read_b128 v[92:95], v7 offset:22528
  s_waitcnt lgkmcnt(4)
  v_mfma_f32_16x16x32_bf16 v[32:35], a[0:3], v[72:75], 0
  v_mfma_f32_16x16x32_bf16 v[36:39], a[0:3], v[76:79], 0
  v_mfma_f32_16x16x32_bf16 v[40:43], a[80:83], v[72:75], 0
  v_mfma_f32_16x16x32_bf16 v[44:47], a[80:83], v[76:79], 0
  v_mfma_f32_16x16x32_bf16 v[48:51], v[72:75], a[160:163], 0
  v_mfma_f32_16x16x32_bf16 v[52:55], v[76:79], a[160:163], 0
  v_mfma_f32_16x16x32_bf16 v[56:59], v[72:75], v[96:99], 0
  v_mfma_f32_16x16x32_bf16 v[60:63], v[76:79], v[96:99], 0
  ds_read_b128 v[72:75], v7 offset:3072
  ds_read_b128 v[76:79], v7 offset:23552
  s_waitcnt lgkmcnt(4)
  v_mfma_f32_16x16x32_bf16 v[32:35], a[4:7], v[80:83], v[32:35]
  v_mfma_f32_16x16x32_bf16 v[36:39], a[4:7], v[84:87], v[36:39]
  v_mfma_f32_16x16x32_bf16 v[40:43], a[84:87], v[80:83], v[40:43]
  v_mfma_f32_16x16x32_bf16 v[44:47], a[84:87], v[84:87], v[44:47]
  v_mfma_f32_16x16x32_bf16 v[48:51], v[80:83], a[164:167], v[48:51]
  v_mfma_f32_16x16x32_bf16 v[52:55], v[84:87], a[164:167], v[52:55]
  v_mfma_f32_16x16x32_bf16 v[56:59], v[80:83], v[100:103], v[56:59]
  v_mfma_f32_16x16x32_bf16 v[60:63], v[84:87], v[100:103], v[60:63]
  ds_read_b128 v[80:83], v7 offset:4096
  ds_read_b128 v[84:87], v7 offset:24576
  s_waitcnt lgkmcnt(4)
  v_mfma_f32_16x16x32_bf16 v[32:35], a[8:11], v[88:91], v[32:35]
  v_mfma_f32_16x16x32_bf16 v[36:39], a[8:11], v[92:95], v[36:39]
  v_mfma_f32_16x16x32_bf16 v[40:43], a[88:91], v[88:91], v[40:43]
  v_mfma_f32_16x16x32_bf16 v[44:47], a[88:91], v[92:95], v[44:47]
  v_mfma_f32_16x16x32_bf16 v[48:51], v[88:91], a[168:171], v[48:51]
  v_mfma_f32_16x16x32_bf16 v[52:55], v[92:95], a[168:171], v[52:55]
  v_mfma_f32_16x16x32_bf16 v[56:59], v[88:91], v[104:107], v[56:59]
  v_mfma_f32_16x16x32_bf16 v[60:63], v[92:95], v[104:107], v[60:63]
  ds_read_b128 v[88:91], v7 offset:5120
  ds_read_b128 v[92:95], v7 offset:25600
  s_waitcnt lgkmcnt(4)
  v_mfma_f32_16x16x32_bf16 v[32:35], a[12:15], v[72:75], v[32:35]
  v_mfma_f32_16x16x32_bf16 v[36:39], a[12:15], v[76:79], v[36:39]
  v_mfma_f32_16x16x32_bf16 v[40:43], a[92:95], v[72:75], v[40:43]
  v_mfma_f32_16x16x32_bf16 v[44:47], a[92:95], v[76:79], v[44:47]
  v_mfma_f32_16x16x32_bf16 v[48:51], v[72:75], a[172:175], v[48:51]
  v_mfma_f32_16x16x32_bf16 v[52:55], v[76:79], a[172:175], v[52:55]
  v_mfma_f32_16x16x32_bf16 v[56:59], v[72:75], v[108:111], v[56:59]
  v_mfma_f32_16x16x32_bf16 v[60:63], v[76:79], v[108:111], v[60:63]
  ds_read_b128 v[72:75], v7 offset:6144
  ds_read_b128 v[76:79], v7 offset:26624
  s_waitcnt lgkmcnt(4)
  v_mfma_f32_16x16x32_bf16 v[32:35], a[16:19], v[80:83], v[32:35]
  v_mfma_f32_16x16x32_bf16 v[36:39], a[16:19], v[84:87], v[36:39]
  v_mfma_f32_16x16x32_bf16 v[40:43], a[96:99], v[80:83], v[40:43]
  v_mfma_f32_16x16x32_bf16 v[44:47], a[96:99], v[84:87], v[44:47]
  v_mfma_f32_16x16x32_bf16 v[48:51], v[80:83], a[176:179], v[48:51]
  v_mfma_f32_16x16x32_bf16 v[52:55], v[84:87], a[176:179], v[52:55]
  v_mfma_f32_16x16x32_bf16 v[56:59], v[80:83], v[112:115], v[56:59]
  v_mfma_f32_16x16x32_bf16 v[60:63], v[84:87], v[112:115], v[60:63]
  ds_read_b128 v[80:83], v7 offset:7168
  ds_read_b128 v[84:87], v7 offset:27648
  s_waitcnt lgkmcnt(4)
  v_mfma_f32_16x16x32_bf16 v[32:35], a[20:23], v[88:91], v[32:35]
  v_mfma_f32_16x16x32_bf16 v[36:39], a[20:23], v[92:95], v[36:39]
  v_mfma_f32_16x16x32_bf16 v[40:43], a[100:103], v[88:91], v[40:43]
  v_mfma_f32_16x16x32_bf16 v[44:47], a[100:103], v[92:95], v[44:47]
  v_mfma_f32_16x16x32_bf16 v[48:51], v[88:91], a[180:183], v[48:51]
  v_mfma_f32_16x16x32_bf16 v[52:55], v[92:95], a[180:183], v[52:55]
  v_mfma_f32_16x16x32_bf16 v[56:59], v[88:91], v[116:119], v[56:59]
  v_mfma_f32_16x16x32_bf16 v[60:63], v[92:95], v[116:119], v[60:63]
  ds_read_b128 v[88:91], v7 offset:8192
  ds_read_b128 v[92:95], v7 offset:28672
  s_waitcnt lgkmcnt(4)
  v_mfma_f32_16x16x32_bf16 v[32:35], a[24:27], v[72:75], v[32:35]
  v_mfma_f32_16x16x32_bf16 v[36:39], a[24:27], v[76:79], v[36:39]
  v_mfma_f32_16x16x32_bf16 v[40:43], a[104:107], v[72:75], v[40:43]
  v_mfma_f32_16x16x32_bf16 v[44:47], a[104:107], v[76:79], v[44:47]
  v_mfma_f32_16x16x32_bf16 v[48:51], v[72:75], a[184:187], v[48:51]
  v_mfma_f32_16x16x32_bf16 v[52:55], v[76:79], a[184:187], v[52:55]
  v_mfma_f32_16x16x32_bf16 v[56:59], v[72:75], v[120:123], v[56:59]
  v_mfma_f32_16x16x32_bf16 v[60:63], v[76:79], v[120:123], v[60:63]
  ds_read_b128 v[72:75], v7 offset:9216
  ds_read_b128 v[76:79], v7 offset:29696
  s_waitcnt lgkmcnt(4)
  v_mfma_f32_16x16x32_bf16 v[32:35], a[28:31], v[80:83], v[32:35]
  v_mfma_f32_16x16x32_bf16 v[36:39], a[28:31], v[84:87], v[36:39]
  v_mfma_f32_16x16x32_bf16 v[40:43], a[108:111], v[80:83], v[40:43]
  v_mfma_f32_16x16x32_bf16 v[44:47], a[108:111], v[84:87], v[44:47]
  v_mfma_f32_16x16x32_bf16 v[48:51], v[80:83], a[188:191], v[48:51]
  v_mfma_f32_16x16x32_bf16 v[52:55], v[84:87], a[188:191], v[52:55]
  v_mfma_f32_16x16x32_bf16 v[56:59], v[80:83], v[124:127], v[56:59]
  v_mfma_f32_16x16x32_bf16 v[60:63], v[84:87], v[124:127], v[60:63]
  ds_read_b128 v[80:83], v7 offset:10240
  ds_read_b128 v[84:87], v7 offset:30720
  s_waitcnt lgkmcnt(4)
  v_mfma_f32_16x16x32_bf16 v[32:35], a[32:35], v[88:91], v[32:35]
  v_mfma_f32_16x16x32_bf16 v[36:39], a[32:35], v[92:95], v[36:39]
  v_mfma_f32_16x16x32_bf16 v[40:43], a[112:115], v[88:91], v[40:43]
  v_mfma_f32_16x16x32_bf16 v[44:47], a[112:115], v[92:95], v[44:47]
  v_mfma_f32_16x16x32_bf16 v[48:51], v[88:91], a[192:195], v[48:51]
  v_mfma_f32_16x16x32_bf16 v[52:55], v[92:95], a[192:195], v[52:55]
  v_mfma_f32_16x16x32_bf16 v[56:59], v[88:91], v[128:131], v[56:59]
  v_mfma_f32_16x16x32_bf16 v[60:63], v[92:95], v[128:131], v[60:63]
  ds_read_b128 v[88:91], v7 offset:11264
  ds_read_b128 v[92:95], v7 offset:31744
  s_waitcnt lgkmcnt(4)
  v_mfma_f32_16x16x32_bf16 v[32:35], a[36:39], v[72:75], v[32:35]
  v_mfma_f32_16x16x32_bf16 v[36:39], a[36:39], v[76:79], v[36:39]
  v_mfma_f32_16x16x32_bf16 v[40:43], a[116:119], v[72:75], v[40:43]
  v_mfma_f32_16x16x32_bf16 v[44:47], a[116:119], v[76:79], v[44:47]
  v_mfma_f32_16x16x32_bf16 v[48:51], v[72:75], a[196:199], v[48:51]
  v_mfma_f32_16x16x32_bf16 v[52:55], v[76:79], a[196:199], v[52:55]
  v_mfma_f32_16x16x32_bf16 v[56:59], v[72:75], v[132:135], v[56:59]
  v_mfma_f32_16x16x32_bf16 v[60:63], v[76:79], v[132:135], v[60:63]
  ds_read_b128 v[72:75], v7 offset:12288
  ds_read_b128 v[76:79], v7 offset:32768
  s_waitcnt lgkmcnt(4)
  v_mfma_f32_16x16x32_bf16 v[32:35], a[40:43], v[80:83], v[32:35]
  v_mfma_f32_16x16x32_bf16 v[36:39], a[40:43], v[84:87], v[36:39]
  v_mfma_f32_16x16x32_bf16 v[40:43], a[120:123], v[80:83], v[40:43]
  v_mfma_f32_16x16x32_bf16 v[44:47], a[120:123], v[84:87], v[44:47]
  v_mfma_f32_16x16x32_bf16 v[48:51], v[80:83], a[200:203], v[48:51]
  v_mfma_f32_16x16x32_bf16 v[52:55], v[84:87], a[200:203], v[52:55]
  v_mfma_f32_16x16x32_bf16 v[56:59], v[80:83], v[136:139], v[56:59]
  v_mfma_f32_16x16x32_bf16 v[60:63], v[84:87], v[136:139], v[60:63]
  ds_read_b128 v[80:83], v7 offset:13312
  ds_read_b128 v[84:87], v7 offset:33792
  s_waitcnt lgkmcnt(4)
  v_mfma_f32_16x16x32_bf16 v[32:35], a[44:47], v[88:91], v[32:35]
  v_mfma_f32_16x16x32_bf16 v[36:39], a[44:47], v[92:95], v[36:39]
  v_mfma_f32_16x16x32_bf16 v[40:43], a[124:127], v[88:91], v[40:43]
  v_mfma_f32_16x16x32_bf16 v[44:47], a[124:127], v[92:95], v[44:47]
  v_mfma_f32_16x16x32_bf16 v[48:51], v[88:91], a[204:207], v[48:51]
  v_mfma_f32_16x16x32_bf16 v[52:55], v[92:95], a[204:207], v[52:55]
  v_mfma_f32_16x16x32_bf16 v[56:59], v[88:91], v[140:143], v[56:59]
  v_mfma_f32_16x16x32_bf16 v[60:63], v[92:95], v[140:143], v[60:63]
  ds_read_b128 v[88:91], v7 offset:14336
  ds_read_b128 v[92:95], v7 offset:34816
  s_waitcnt lgkmcnt(4)
  v_mfma_f32_16x16x32_bf16 v[32:35], a[48:51], v[72:75], v[32:35]
  v_mfma_f32_16x16x32_bf16 v[36:39], a[48:51], v[76:79], v[36:39]
  v_mfma_f32_16x16x32_bf16 v[40:43], a[128:131], v[72:75], v[40:43]
  v_mfma_f32_16x16x32_bf16 v[44:47], a[128:131], v[76:79], v[44:47]
  v_mfma_f32_16x16x32_bf16 v[48:51], v[72:75], a[208:211], v[48:51]
  v_mfma_f32_16x16x32_bf16 v[52:55], v[76:79], a[208:211], v[52:55]
  v_mfma_f32_16x16x32_bf16 v[56:59], v[72:75], v[144:147], v[56:59]
  v_mfma_f32_16x16x32_bf16 v[60:63], v[76:79], v[144:147], v[60:63]
  ds_read_b128 v[72:75], v7 offset:15360
  ds_read_b128 v[76:79], v7 offset:35840
  s_waitcnt lgkmcnt(4)
  v_mfma_f32_16x16x32_bf16 v[32:35], a[52:55], v[80:83], v[32:35]
  v_mfma_f32_16x16x32_bf16 v[36:39], a[52:55], v[84:87], v[36:39]
  v_mfma_f32_16x16x32_bf16 v[40:43], a[132:135], v[80:83], v[40:43]
  v_mfma_f32_16x16x32_bf16 v[44:47], a[132:135], v[84:87], v[44:47]
  v_mfma_f32_16x16x32_bf16 v[48:51], v[80:83], a[212:215], v[48:51]
  v_mfma_f32_16x16x32_bf16 v[52:55], v[84:87], a[212:215], v[52:55]
  v_mfma_f32_16x16x32_bf16 v[56:59], v[80:83], v[148:151], v[56:59]
  v_mfma_f32_16x16x32_bf16 v[60:63], v[84:87], v[148:151], v[60:63]
  ds_read_b128 v[80:83], v7 offset:16384
  ds_read_b128 v[84:87], v7 offset:36864
  s_waitcnt lgkmcnt(4)
  v_mfma_f32_16x16x32_bf16 v[32:35], a[56:59], v[88:91], v[32:35]
  v_mfma_f32_16x16x32_bf16 v[36:39], a[56:59], v[92:95], v[36:39]
  v_mfma_f32_16x16x32_bf16 v[40:43], a[136:139], v[88:91], v[40:43]
  v_mfma_f32_16x16x32_bf16 v[44:47], a[136:139], v[92:95], v[44:47]
  v_mfma_f32_16x16x32_bf16 v[48:51], v[88:91], a[216:219], v[48:51]
  v_mfma_f32_16x16x32_bf16 v[52:55], v[92:95], a[216:219], v[52:55]
  v_mfma_f32_16x16x32_bf16 v[56:59], v[88:91], v[152:155], v[56:59]
  v_mfma_f32_16x16x32_bf16 v[60:63], v[92:95], v[152:155], v[60:63]
  ds_read_b128 v[88:91], v7 offset:17408
  ds_read_b128 v[92:95], v7 offset:37888
  s_waitcnt lgkmcnt(4)
  v_mfma_f32_16x16x32_bf16 v[32:35], a[60:63], v[72:75], v[32:35]
  v_mfma_f32_16x16x32_bf16 v[36:39], a[60:63], v[76:79], v[36:39]
  v_mfma_f32_16x16x32_bf16 v[40:43], a[140:143], v[72:75], v[40:43]
  v_mfma_f32_16x16x32_bf16 v[44:47], a[140:143], v[76:79], v[44:47]
  v_mfma_f32_16x16x32_bf16 v[48:51], v[72:75], a[220:223], v[48:51]
  v_mfma_f32_16x16x32_bf16 v[52:55], v[76:79], a[220:223], v[52:55]
  v_mfma_f32_16x16x32_bf16 v[56:59], v[72:75], v[156:159], v[56:59]
  v_mfma_f32_16x16x32_bf16 v[60:63], v[76:79], v[156:159], v[60:63]
  ds_read_b128 v[72:75], v7 offset:18432
  ds_read_b128 v[76:79], v7 offset:38912
  s_waitcnt lgkmcnt(4)
  v_mfma_f32_16x16x32_bf16 v[32:35], a[64:67], v[80:83], v[32:35]
  v_mfma_f32_16x16x32_bf16 v[36:39], a[64:67], v[84:87], v[36:39]
  v_mfma_f32_16x16x32_bf16 v[40:43], a[144:147], v[80:83], v[40:43]
  v_mfma_f32_16x16x32_bf16 v[44:47], a[144:147], v[84:87], v[44:47]
  v_mfma_f32_16x16x32_bf16 v[48:51], v[80:83], a[224:227], v[48:51]
  v_mfma_f32_16x16x32_bf16 v[52:55], v[84:87], a[224:227], v[52:55]
  v_mfma_f32_16x16x32_bf16 v[56:59], v[80:83], v[160:163], v[56:59]
  v_mfma_f32_16x16x32_bf16 v[60:63], v[84:87], v[160:163], v[60:63]
  ds_read_b128 v[80:83], v7 offset:19456
  ds_read_b128 v[84:87], v7 offset:39936
  s_waitcnt lgkmcnt(4)
  v_mfma_f32_16x16x32_bf16 v[32:35], a[68:71], v[88:91], v[32:35]
  v_mfma_f32_16x16x32_bf16 v[36:39], a[68:71], v[92:95], v[36:39]
  v_mfma_f32_16x16x32_bf16 v[40:43], a[148:151], v[88:91], v[40:43]
  v_mfma_f32_16x16x32_bf16 v[44:47], a[148:151], v[92:95], v[44:47]
  v_mfma_f32_16x16x32_bf16 v[48:51], v[88:91], a[228:231], v[48:51]
  v_mfma_f32_16x16x32_bf16 v[52:55], v[92:95], a[228:231], v[52:55]
  v_mfma_f32_16x16x32_bf16 v[56:59], v[88:91], v[164:167], v[56:59]
  v_mfma_f32_16x16x32_bf16 v[60:63], v[92:95], v[164:167], v[60:63]
  s_waitcnt lgkmcnt(2)
  v_mfma_f32_16x16x32_bf16 v[32:35], a[72:75], v[72:75], v[32:35]
  v_mfma_f32_16x16x32_bf16 v[36:39], a[72:75], v[76:79], v[36:39]
  v_mfma_f32_16x16x32_bf16 v[40:43], a[152:155], v[72:75], v[40:43]
  v_mfma_f32_16x16x32_bf16 v[44:47], a[152:155], v[76:79], v[44:47]
  v_mfma_f32_16x16x32_bf16 v[48:51], v[72:75], a[232:235], v[48:51]
  v_mfma_f32_16x16x32_bf16 v[52:55], v[76:79], a[232:235], v[52:55]
  v_mfma_f32_16x16x32_bf16 v[56:59], v[72:75], v[168:171], v[56:59]
  v_mfma_f32_16x16x32_bf16 v[60:63], v[76:79], v[168:171], v[60:63]
  s_waitcnt lgkmcnt(0)
  v_mfma_f32_16x16x32_bf16 v[32:35], a[76:79], v[80:83], v[32:35]
  v_mfma_f32_16x16x32_bf16 v[36:39], a[76:79], v[84:87], v[36:39]
  v_mfma_f32_16x16x32_bf16 v[40:43], a[156:159], v[80:83], v[40:43]
  v_mfma_f32_16x16x32_bf16 v[44:47], a[156:159], v[84:87], v[44:47]
  v_mfma_f32_16x16x32_bf16 v[48:51], v[80:83], a[236:239], v[48:51]
  v_mfma_f32_16x16x32_bf16 v[52:55], v[84:87], a[236:239], v[52:55]
  v_mfma_f32_16x16x32_bf16 v[56:59], v[80:83], v[172:175], v[56:59]
  v_mfma_f32_16x16x32_bf16 v[60:63], v[84:87], v[172:175], v[60:63]
  s_nop 0
  v_cvt_pk_bf16_f32 v8, v32, v33
  v_cvt_pk_bf16_f32 v9, v34, v35
  v_cvt_pk_bf16_f32 v10, v40, v41
  v_cvt_pk_bf16_f32 v11, v42, v43
  s_add_u32 s34, s22, 0
  buffer_store_dwordx4 v[8:11], v1, s[4:7], s34 offen sc1
  v_cvt_pk_bf16_f32 v12, v36, v37
  v_cvt_pk_bf16_f32 v13, v38, v39
  v_cvt_pk_bf16_f32 v14, v44, v45
  v_cvt_pk_bf16_f32 v15, v46, v47
  s_add_u32 s34, s22, 6144
  buffer_store_dwordx4 v[12:15], v1, s[4:7], s34 offen sc1
  v_cvt_pk_bf16_f32 v8, v48, v49
  v_cvt_pk_bf16_f32 v9, v50, v51
  v_cvt_pk_bf16_f32 v10, v52, v53
  v_cvt_pk_bf16_f32 v11, v54, v55
  s_add_u32 s34, s23, 4096
  buffer_store_dwordx4 v[8:11], v1, s[4:7], s34 offen sc1
  v_cvt_pk_bf16_f32 v12, v56, v57
  v_cvt_pk_bf16_f32 v13, v58, v59
  v_cvt_pk_bf16_f32 v14, v60, v61
  v_cvt_pk_bf16_f32 v15, v62, v63
  s_add_u32 s34, s23, 5120
  buffer_store_dwordx4 v[12:15], v1, s[4:7], s34 offen sc1
  s_waitcnt vmcnt(0)
  s_barrier
  s_add_u32 s17, s17, 1
  s_cmp_lt_u32 s17, 64
  s_cbranch_scc1 reca_ptop264
  s_branch reca_exit1
reca_pw3_229:
  s_mov_b32 s17, 0
  s_mov_b32 s26, 0
  s_mul_i32 s20, s17, 40960
  s_add_u32 s20, s20, 84965376
  s_add_u32 m0, s26, 30720
  s_nop 0
  buffer_load_dwordx4 v1, s[4:7], s20 offen offset:0 lds
  buffer_load_dwordx4 v1, s[4:7], s20 offen offset:1024 lds
  buffer_load_dwordx4 v1, s[4:7], s20 offen offset:2048 lds
  buffer_load_dwordx4 v1, s[4:7], s20 offen offset:3072 lds
  s_add_u32 s20, s20, 4096
  s_add_u32 m0, s26, 34816
  s_nop 0
  buffer_load_dwordx4 v1, s[4:7], s20 offen offset:0 lds
  buffer_load_dwordx4 v1, s[4:7], s20 offen offset:1024 lds
  buffer_load_dwordx4 v1, s[4:7], s20 offen offset:2048 lds
  buffer_load_dwordx4 v1, s[4:7], s20 offen offset:3072 lds
  s_add_u32 s20, s20, 4096
  s_add_u32 m0, s26, 38912
  s_nop 0
  buffer_load_dwordx4 v1, s[4:7], s20 offen offset:0 lds
  buffer_load_dwordx4 v1, s[4:7], s20 offen offset:1024 lds
  s_mul_i32 s34, s15, 12
  s_mul_i32 s35, s16, 6
  s_add_u32 s34, s34, s35
  s_add_u32 s34, s34, 2
  s_mul_i32 s34, s34, 20480
  s_add_u32 s34, s34, 6291456
  buffer_load_dwordx4 a[0:3], v1, s[4:7], s34 offen offset:0
  buffer_load_dwordx4 a[4:7], v1, s[4:7], s34 offen offset:1024
  buffer_load_dwordx4 a[8:11], v1, s[4:7], s34 offen offset:2048
  buffer_load_dwordx4 a[12:15], v1, s[4:7], s34 offen offset:3072
  s_add_u32 s34, s34, 4096
  buffer_load_dwordx4 a[16:19], v1, s[4:7], s34 offen offset:0
  buffer_load_dwordx4 a[20:23], v1, s[4:7], s34 offen offset:1024
  buffer_load_dwordx4 a[24:27], v1, s[4:7], s34 offen offset:2048
  buffer_load_dwordx4 a[28:31], v1, s[4:7], s34 offen offset:3072
  s_add_u32 s34, s34, 4096
  buffer_load_dwordx4 a[32:35], v1, s[4:7], s34 offen offset:0
  buffer_load_dwordx4 a[36:39], v1, s[4:7], s34 offen offset:1024
  buffer_load_dwordx4 a[40:43], v1, s[4:7], s34 offen offset:2048
  buffer_load_dwordx4 a[44:47], v1, s[4:7], s34 offen offset:3072
  s_add_u32 s34, s34, 4096
  buffer_load_dwordx4 a[48:51], v1, s[4:7], s34 offen offset:0
  buffer_load_dwordx4 a[52:55], v1, s[4:7], s34 offen offset:1024
  buffer_load_dwordx4 a[56:59], v1, s[4:7], s34 offen offset:2048
  buffer_load_dwordx4 a[60:63], v1, s[4:7], s34 offen offset:3072
  s_add_u32 s34, s34, 4096
  buffer_load_dwordx4 a[64:67], v1, s[4:7], s34 offen offset:0
  buffer_load_dwordx4 a[68:71], v1, s[4:7], s34 offen offset:1024
  buffer_load_dwordx4 a[72:75], v1, s[4:7], s34 offen offset:2048
  buffer_load_dwordx4 a[76:79], v1, s[4:7], s34 offen offset:3072
  s_mul_i32 s34, s15, 12
  s_mul_i32 s35, s16, 6
  s_add_u32 s34, s34, s35
  s_add_u32 s34, s34, 3
  s_mul_i32 s34, s34, 20480
  s_add_u32 s34, s34, 6291456
  buffer_load_dwordx4 a[80:83], v1, s[4:7], s34 offen offset:0
  buffer_load_dwordx4 a[84:87], v1, s[4:7], s34 offen offset:1024
  buffer_load_dwordx4 a[88:91], v1, s[4:7], s34 offen offset:2048
  buffer_load_dwordx4 a[92:95], v1, s[4:7], s34 offen offset:3072
  s_add_u32 s34, s34, 4096
  buffer_load_dwordx4 a[96:99], v1, s[4:7], s34 offen offset:0
  buffer_load_dwordx4 a[100:103], v1, s[4:7], s34 offen offset:1024
  buffer_load_dwordx4 a[104:107], v1, s[4:7], s34 offen offset:2048
  buffer_load_dwordx4 a[108:111], v1, s[4:7], s34 offen offset:3072
  s_add_u32 s34, s34, 4096
  buffer_load_dwordx4 a[112:115], v1, s[4:7], s34 offen offset:0
  buffer_load_dwordx4 a[116:119], v1, s[4:7], s34 offen offset:1024
  buffer_load_dwordx4 a[120:123], v1, s[4:7], s34 offen offset:2048
  buffer_load_dwordx4 a[124:127], v1, s[4:7], s34 offen offset:3072
  s_add_u32 s34, s34, 4096
  buffer_load_dwordx4 a[128:131], v1, s[4:7], s34 offen offset:0
  buffer_load_dwordx4 a[132:135], v1, s[4:7], s34 offen offset:1024
  buffer_load_dwordx4 a[136:139], v1, s[4:7], s34 offen offset:2048
  buffer_load_dwordx4 a[140:143], v1, s[4:7], s34 offen offset:3072
  s_add_u32 s34, s34, 4096
  buffer_load_dwordx4 a[144:147], v1, s[4:7], s34 offen offset:0
  buffer_load_dwordx4 a[148:151], v1, s[4:7], s34 offen offset:1024
  buffer_load_dwordx4 a[152:155], v1, s[4:7], s34 offen offset:2048
  buffer_load_dwordx4 a[156:159], v1, s[4:7], s34 offen offset:3072
  s_waitcnt vmcnt(20)
  s_mul_i32 s34, s15, 12
  s_mul_i32 s35, s16, 6
  s_add_u32 s34, s34, s35
  s_add_u32 s34, s34, 4
  s_mul_i32 s34, s34, 20480
  s_add_u32 s34, s34, 6291456
  buffer_load_dwordx4 a[160:163], v1, s[4:7], s34 offen offset:0
  buffer_load_dwordx4 a[164:167], v1, s[4:7], s34 offen offset:1024
  buffer_load_dwordx4 a[168:171], v1, s[4:7], s34 offen offset:2048
  buffer_load_dwordx4 a[172:175], v1, s[4:7], s34 offen offset:3072
  s_add_u32 s34, s34, 4096
  buffer_load_dwordx4 a[176:179], v1, s[4:7], s34 offen offset:0
  buffer_load_dwordx4 a[180:183], v1, s[4:7], s34 offen offset:1024
  buffer_load_dwordx4 a[184:187], v1, s[4:7], s34 offen offset:2048
  buffer_load_dwordx4 a[188:191], v1, s[4:7], s34 offen offset:3072
  s_add_u32 s34, s34, 4096
  buffer_load_dwordx4 a[192:195], v1, s[4:7], s34 offen offset:0
  buffer_load_dwordx4 a[196:199], v1, s[4:7], s34 offen offset:1024
  buffer_load_dwordx4 a[200:203], v1, s[4:7], s34 offen offset:2048
  buffer_load_dwordx4 a[204:207], v1, s[4:7], s34 offen offset:3072
  s_add_u32 s34, s34, 4096
  buffer_load_dwordx4 a[208:211], v1, s[4:7], s34 offen offset:0
  buffer_load_dwordx4 a[212:215], v1, s[4:7], s34 offen offset:1024
  buffer_load_dwordx4 a[216:219], v1, s[4:7], s34 offen offset:2048
  buffer_load_dwordx4 a[220:223], v1, s[4:7], s34 offen offset:3072
  s_add_u32 s34, s34, 4096
  buffer_load_dwordx4 a[224:227], v1, s[4:7], s34 offen offset:0
  buffer_load_dwordx4 a[228:231], v1, s[4:7], s34 offen offset:1024
  buffer_load_dwordx4 a[232:235], v1, s[4:7], s34 offen offset:2048
  buffer_load_dwordx4 a[236:239], v1, s[4:7], s34 offen offset:3072
  s_waitcnt vmcnt(20)
  s_mul_i32 s34, s15, 12
  s_mul_i32 s35, s16, 6
  s_add_u32 s34, s34, s35
  s_add_u32 s34, s34, 5
  s_mul_i32 s34, s34, 20480
  s_add_u32 s34, s34, 6291456
  buffer_load_dwordx4 v[96:99], v1, s[4:7], s34 offen offset:0
  buffer_load_dwordx4 v[100:103], v1, s[4:7], s34 offen offset:1024
  buffer_load_dwordx4 v[104:107], v1, s[4:7], s34 offen offset:2048
  buffer_load_dwordx4 v[108:111], v1, s[4:7], s34 offen offset:3072
  s_add_u32 s34, s34, 4096
  buffer_load_dwordx4 v[112:115], v1, s[4:7], s34 offen offset:0
  buffer_load_dwordx4 v[116:119], v1, s[4:7], s34 offen offset:1024
  buffer_load_dwordx4 v[120:123], v1, s[4:7], s34 offen offset:2048
  buffer_load_dwordx4 v[124:127], v1, s[4:7], s34 offen offset:3072
  s_add_u32 s34, s34, 4096
  buffer_load_dwordx4 v[128:131], v1, s[4:7], s34 offen offset:0
  buffer_load_dwordx4 v[132:135], v1, s[4:7], s34 offen offset:1024
  buffer_load_dwordx4 v[136:139], v1, s[4:7], s34 offen offset:2048
  buffer_load_dwordx4 v[140:143], v1, s[4:7], s34 offen offset:3072
  s_add_u32 s34, s34, 4096
  buffer_load_dwordx4 v[144:147], v1, s[4:7], s34 offen offset:0
  buffer_load_dwordx4 v[148:151], v1, s[4:7], s34 offen offset:1024
  buffer_load_dwordx4 v[152:155], v1, s[4:7], s34 offen offset:2048
  buffer_load_dwordx4 v[156:159], v1, s[4:7], s34 offen offset:3072
  s_add_u32 s34, s34, 4096
  buffer_load_dwordx4 v[160:163], v1, s[4:7], s34 offen offset:0
  buffer_load_dwordx4 v[164:167], v1, s[4:7], s34 offen offset:1024
  buffer_load_dwordx4 v[168:171], v1, s[4:7], s34 offen offset:2048
  buffer_load_dwordx4 v[172:175], v1, s[4:7], s34 offen offset:3072
  s_waitcnt vmcnt(20)
  v_and_b32 v30, 7, v0
  v_lshlrev_b32 v30, 3, v30
reca_cens269:
  buffer_load_dwordx2 v[28:29], v30, s[8:11], 0 offen sc1
  s_waitcnt vmcnt(0)
  v_sad_u8 v31, v28, 0, 0
  v_sad_u8 v31, v29, 0, v31
  v_cmp_gt_u32 vcc, 32, v31
  s_cbranch_vccz reca_censok270
  s_sleep 8
  s_sub_u32 s18, s18, 1
  s_cbranch_scc0 reca_cens269
  s_mov_b32 s18, 0
reca_censok270:
  v_and_b32 v28, 0x20202020, v28
  v_and_b32 v29, 0x20202020, v29
  v_cmp_ne_u32 s[34:35], 0, v28
  v_cmp_ne_u32 s[36:37], 0, v29
  s_nop 3
  s_and_b32 s34, s34, 0xff
  s_and_b32 s36, s36, 0xff
  s_or_b32 s35, s34, s36
  s_lshr_b32 s37, s35, s13
  s_and_b32 s37, s37, 1
  s_xor_b32 s43, s37, 1
  s_cmp_eq_u32 s57, 0
  s_cselect_b32 s58, s36, s34
  v_mov_b32 v31, 0x80000000
  s_cmp_lg_u32 s43, 0
  s_cbranch_scc1 reca_pslow271
reca_ptop272:
  s_cmp_lt_u32 s17, 3
  s_cbranch_scc1 reca_pgo273
  s_sub_u32 s36, s17, 3
reca_ppoll274:
  buffer_load_dword v28, v4, s[4:7], s25 offen sc1
  s_waitcnt vmcnt(0)
  v_readfirstlane_b32 s34, v28
  s_nop 3
  s_cmp_ge_i32 s34, s36
  s_cbranch_scc1 reca_pgo273
  s_sleep 8
  s_sub_u32 s18, s18, 1
  s_cbranch_scc0 reca_ppoll274
  s_mov_b32 s18, 0
reca_pgo273:
  s_waitcnt vmcnt(0)
  s_barrier
  v_add_u32 v7, s26, v1
  s_xor_b32 s26, s26, 40960
  s_add_u32 s37, s17, 1
  s_cmp_ge_u32 s37, 64
  s_cbranch_scc1 reca_pnodma275
  s_mul_i32 s20, s37, 40960
  s_add_u32 s20, s20, 84965376
  s_add_u32 m0, s26, 30720
  s_nop 0
  buffer_load_dwordx4 v1, s[4:7], s20 offen offset:0 lds
  buffer_load_dwordx4 v1, s[4:7], s20 offen offset:1024 lds
  buffer_load_dwordx4 v1, s[4:7], s20 offen offset:2048 lds
  buffer_load_dwordx4 v1, s[4:7], s20 offen offset:3072 lds
  s_add_u32 s20, s20, 4096
  s_add_u32 m0, s26, 34816
  s_nop 0
  buffer_load_dwordx4 v1, s[4:7], s20 offen offset:0 lds
  buffer_load_dwordx4 v1, s[4:7], s20 offen offset:1024 lds
  buffer_load_dwordx4 v1, s[4:7], s20 offen offset:2048 lds
  buffer_load_dwordx4 v1, s[4:7], s20 offen offset:3072 lds
  s_add_u32 s20, s20, 4096
  s_add_u32 m0, s26, 38912
  s_nop 0
  buffer_load_dwordx4 v1, s[4:7], s20 offen offset:0 lds
  buffer_load_dwordx4 v1, s[4:7], s20 offen offset:1024 lds
reca_pnodma275:
  s_lshl_b32 s34, s15, 3
  s_and_b32 s35, s17, 7
  s_add_u32 s34, s34, s35
  s_mul_i32 s34, s34, 12288
  s_mul_i32 s35, s16, 3072
  s_add_u32 s35, s35, s34
  s_add_u32 s21, s35, 37748736
  s_add_u32 s22, s35, 44040192
  s_mul_i32 s35, s16, 6144
  s_add_u32 s35, s35, s34
  s_add_u32 s23, s35, 40894464
  ds_read_b128 v[72:75], v7 offset:0
  ds_read_b128 v[76:79], v7 offset:20480
  ds_read_b128 v[80:83], v7 offset:1024
  ds_read_b128 v[84:87], v7 offset:21504
  ds_read_b128 v[88:91], v7 offset:2048
  ds_read_b128 v[92:95], v7 offset:22528
  s_waitcnt lgkmcnt(4)
  v_mfma_f32_16x16x32_bf16 v[32:35], a[0:3], v[72:75], 0
  v_mfma_f32_16x16x32_bf16 v[36:39], a[0:3], v[76:79], 0
  v_mfma_f32_16x16x32_bf16 v[40:43], a[80:83], v[72:75], 0
  v_mfma_f32_16x16x32_bf16 v[44:47], a[80:83], v[76:79], 0
  v_mfma_f32_16x16x32_bf16 v[48:51], a[160:163], v[72:75], 0
  v_mfma_f32_16x16x32_bf16 v[52:55], a[160:163], v[76:79], 0
  v_mfma_f32_16x16x32_bf16 v[56:59], v[96:99], v[72:75], 0
  v_mfma_f32_16x16x32_bf16 v[60:63], v[96:99], v[76:79], 0
  ds_read_b128 v[72:75], v7 offset:3072
  ds_read_b128 v[76:79], v7 offset:23552
  s_waitcnt lgkmcnt(4)
  v_mfma_f32_16x16x32_bf16 v[32:35], a[4:7], v[80:83], v[32:35]
  v_mfma_f32_16x16x32_bf16 v[36:39], a[4:7], v[84:87], v[36:39]
  v_mfma_f32_16x16x32_bf16 v[40:43], a[84:87], v[80:83], v[40:43]
  v_mfma_f32_16x16x32_bf16 v[44:47], a[84:87], v[84:87], v[44:47]
  v_mfma_f32_16x16x32_bf16 v[48:51], a[164:167], v[80:83], v[48:51]
  v_mfma_f32_16x16x32_bf16 v[52:55], a[164:167], v[84:87], v[52:55]
  v_mfma_f32_16x16x32_bf16 v[56:59], v[100:103], v[80:83], v[56:59]
  v_mfma_f32_16x16x32_bf16 v[60:63], v[100:103], v[84:87], v[60:63]
  ds_read_b128 v[80:83], v7 offset:4096
  ds_read_b128 v[84:87], v7 offset:24576
  s_waitcnt lgkmcnt(4)
  v_mfma_f32_16x16x32_bf16 v[32:35], a[8:11], v[88:91], v[32:35]
  v_mfma_f32_16x16x32_bf16 v[36:39], a[8:11], v[92:95], v[36:39]
  v_mfma_f32_16x16x32_bf16 v[40:43], a[88:91], v[88:91], v[40:43]
  v_mfma_f32_16x16x32_bf16 v[44:47], a[88:91], v[92:95], v[44:47]
  v_mfma_f32_16x16x32_bf16 v[48:51], a[168:171], v[88:91], v[48:51]
  v_mfma_f32_16x16x32_bf16 v[52:55], a[168:171], v[92:95], v[52:55]
  v_mfma_f32_16x16x32_bf16 v[56:59], v[104:107], v[88:91], v[56:59]
  v_mfma_f32_16x16x32_bf16 v[60:63], v[104:107], v[92:95], v[60:63]
  ds_read_b128 v[88:91], v7 offset:5120
  ds_read_b128 v[92:95], v7 offset:25600
  s_waitcnt lgkmcnt(4)
  v_mfma_f32_16x16x32_bf16 v[32:35], a[12:15], v[72:75], v[32:35]
  v_mfma_f32_16x16x32_bf16 v[36:39], a[12:15], v[76:79], v[36:39]
  v_mfma_f32_16x16x32_bf16 v[40:43], a[92:95], v[72:75], v[40:43]
  v_mfma_f32_16x16x32_bf16 v[44:47], a[92:95], v[76:79], v[44:47]
  v_mfma_f32_16x16x32_bf16 v[48:51], a[172:175], v[72:75], v[48:51]
  v_mfma_f32_16x16x32_bf16 v[52:55], a[172:175], v[76:79], v[52:55]
  v_mfma_f32_16x16x32_bf16 v[56:59], v[108:111], v[72:75], v[56:59]
  v_mfma_f32_16x16x32_bf16 v[60:63], v[108:111], v[76:79], v[60:63]
  ds_read_b128 v[72:75], v7 offset:6144
  ds_read_b128 v[76:79], v7 offset:26624
  s_waitcnt lgkmcnt(4)
  v_mfma_f32_16x16x32_bf16 v[32:35], a[16:19], v[80:83], v[32:35]
  v_mfma_f32_16x16x32_bf16 v[36:39], a[16:19], v[84:87], v[36:39]
  v_mfma_f32_16x16x32_bf16 v[40:43], a[96:99], v[80:83], v[40:43]
  v_mfma_f32_16x16x32_bf16 v[44:47], a[96:99], v[84:87], v[44:47]
  v_mfma_f32_16x16x32_bf16 v[48:51], a[176:179], v[80:83], v[48:51]
  v_mfma_f32_16x16x32_bf16 v[52:55], a[176:179], v[84:87], v[52:55]
  v_mfma_f32_16x16x32_bf16 v[56:59], v[112:115], v[80:83], v[56:59]
  v_mfma_f32_16x16x32_bf16 v[60:63], v[112:115], v[84:87], v[60:63]
  ds_read_b128 v[80:83], v7 offset:7168
  ds_read_b128 v[84:87], v7 offset:27648
  s_waitcnt lgkmcnt(4)
  v_mfma_f32_16x16x32_bf16 v[32:35], a[20:23], v[88:91], v[32:35]
  v_mfma_f32_16x16x32_bf16 v[36:39], a[20:23], v[92:95], v[36:39]
  v_mfma_f32_16x16x32_bf16 v[40:43], a[100:103], v[88:91], v[40:43]
  v_mfma_f32_16x16x32_bf16 v[44:47], a[100:103], v[92:95], v[44:47]
  v_mfma_f32_16x16x32_bf16 v[48:51], a[180:183], v[88:91], v[48:51]
  v_mfma_f32_16x16x32_bf16 v[52:55], a[180:183], v[92:95], v[52:55]
  v_mfma_f32_16x16x32_bf16 v[56:59], v[116:119], v[88:91], v[56:59]
  v_mfma_f32_16x16x32_bf16 v[60:63], v[116:119], v[92:95], v[60:63]
  ds_read_b128 v[88:91], v7 offset:8192
  ds_read_b128 v[92:95], v7 offset:28672
  s_waitcnt lgkmcnt(4)
  v_mfma_f32_16x16x32_bf16 v[32:35], a[24:27], v[72:75], v[32:35]
  v_mfma_f32_16x16x32_bf16 v[36:39], a[24:27], v[76:79], v[36:39]
  v_mfma_f32_16x16x32_bf16 v[40:43], a[104:107], v[72:75], v[40:43]
  v_mfma_f32_16x16x32_bf16 v[44:47], a[104:107], v[76:79], v[44:47]
  v_mfma_f32_16x16x32_bf16 v[48:51], a[184:187], v[72:75], v[48:51]
  v_mfma_f32_16x16x32_bf16 v[52:55], a[184:187], v[76:79], v[52:55]
  v_mfma_f32_16x16x32_bf16 v[56:59], v[120:123], v[72:75], v[56:59]
  v_mfma_f32_16x16x32_bf16 v[60:63], v[120:123], v[76:79], v[60:63]
  ds_read_b128 v[72:75], v7 offset:9216
  ds_read_b128 v[76:79], v7 offset:29696
  s_waitcnt lgkmcnt(4)
  v_mfma_f32_16x16x32_bf16 v[32:35], a[28:31], v[80:83], v[32:35]
  v_mfma_f32_16x16x32_bf16 v[36:39], a[28:31], v[84:87], v[36:39]
  v_mfma_f32_16x16x32_bf16 v[40:43], a[108:111], v[80:83], v[40:43]
  v_mfma_f32_16x16x32_bf16 v[44:47], a[108:111], v[84:87], v[44:47]
  v_mfma_f32_16x16x32_bf16 v[48:51], a[188:191], v[80:83], v[48:51]
  v_mfma_f32_16x16x32_bf16 v[52:55], a[188:191], v[84:87], v[52:55]
  v_mfma_f32_16x16x32_bf16 v[56:59], v[124:127], v[80:83], v[56:59]
  v_mfma_f32_16x16x32_bf16 v[60:63], v[124:127], v[84:87], v[60:63]
  ds_read_b128 v[80:83], v7 offset:10240
  ds_read_b128 v[84:87], v7 offset:30720
  s_waitcnt lgkmcnt(4)
  v_mfma_f32_16x16x32_bf16 v[32:35], a[32:35], v[88:91], v[32:35]
  v_mfma_f32_16x16x32_bf16 v[36:39], a[32:35], v[92:95], v[36:39]
  v_mfma_f32_16x16x32_bf16 v[40:43], a[112:115], v[88:91], v[40:43]
  v_mfma_f32_16x16x32_bf16 v[44:47], a[112:115], v[92:95], v[44:47]
  v_mfma_f32_16x16x32_bf16 v[48:51], a[192:195], v[88:91], v[48:51]
  v_mfma_f32_16x16x32_bf16 v[52:55], a[192:195], v[92:95], v[52:55]
  v_mfma_f32_16x16x32_bf16 v[56:59], v[128:131], v[88:91], v[56:59]
  v_mfma_f32_16x16x32_bf16 v[60:63], v[128:131], v[92:95], v[60:63]
  ds_read_b128 v[88:91], v7 offset:11264
  ds_read_b128 v[92:95], v7 offset:31744
  s_waitcnt lgkmcnt(4)
  v_mfma_f32_16x16x32_bf16 v[32:35], a[36:39], v[72:75], v[32:35]
  v_mfma_f32_16x16x32_bf16 v[36:39], a[36:39], v[76:79], v[36:39]
  v_mfma_f32_16x16x32_bf16 v[40:43], a[116:119], v[72:75], v[40:43]
  v_mfma_f32_16x16x32_bf16 v[44:47], a[116:119], v[76:79], v[44:47]
  v_mfma_f32_16x16x32_bf16 v[48:51], a[196:199], v[72:75], v[48:51]
  v_mfma_f32_16x16x32_bf16 v[52:55], a[196:199], v[76:79], v[52:55]
  v_mfma_f32_16x16x32_bf16 v[56:59], v[132:135], v[72:75], v[56:59]
  v_mfma_f32_16x16x32_bf16 v[60:63], v[132:135], v[76:79], v[60:63]
  ds_read_b128 v[72:75], v7 offset:12288
  ds_read_b128 v[76:79], v7 offset:32768
  s_waitcnt lgkmcnt(4)
  v_mfma_f32_16x16x32_bf16 v[32:35], a[40:43], v[80:83], v[32:35]
  v_mfma_f32_16x16x32_bf16 v[36:39], a[40:43], v[84:87], v[36:39]
  v_mfma_f32_16x16x32_bf16 v[40:43], a[120:123], v[80:83], v[40:43]
  v_mfma_f32_16x16x32_bf16 v[44:47], a[120:123], v[84:87], v[44:47]
  v_mfma_f32_16x16x32_bf16 v[48:51], a[200:203], v[80:83], v[48:51]
  v_mfma_f32_16x16x32_bf16 v[52:55], a[200:203], v[84:87], v[52:55]
  v_mfma_f32_16x16x32_bf16 v[56:59], v[136:139], v[80:83], v[56:59]
  v_mfma_f32_16x16x32_bf16 v[60:63], v[136:139], v[84:87], v[60:63]
  ds_read_b128 v[80:83], v7 offset:13312
  ds_read_b128 v[84:87], v7 offset:33792
  s_waitcnt lgkmcnt(4)
  v_mfma_f32_16x16x32_bf16 v[32:35], a[44:47], v[88:91], v[32:35]
  v_mfma_f32_16x16x32_bf16 v[36:39], a[44:47], v[92:95], v[36:39]
  v_mfma_f32_16x16x32_bf16 v[40:43], a[124:127], v[88:91], v[40:43]
  v_mfma_f32_16x16x32_bf16 v[44:47], a[124:127], v[92:95], v[44:47]
  v_mfma_f32_16x16x32_bf16 v[48:51], a[204:207], v[88:91], v[48:51]
  v_mfma_f32_16x16x32_bf16 v[52:55], a[204:207], v[92:95], v[52:55]
  v_mfma_f32_16x16x32_bf16 v[56:59], v[140:143], v[88:91], v[56:59]
  v_mfma_f32_16x16x32_bf16 v[60:63], v[140:143], v[92:95], v[60:63]
  ds_read_b128 v[88:91], v7 offset:14336
  ds_read_b128 v[92:95], v7 offset:34816
  s_waitcnt lgkmcnt(4)
  v_mfma_f32_16x16x32_bf16 v[32:35], a[48:51], v[72:75], v[32:35]
  v_mfma_f32_16x16x32_bf16 v[36:39], a[48:51], v[76:79], v[36:39]
  v_mfma_f32_16x16x32_bf16 v[40:43], a[128:131], v[72:75], v[40:43]
  v_mfma_f32_16x16x32_bf16 v[44:47], a[128:131], v[76:79], v[44:47]
  v_mfma_f32_16x16x32_bf16 v[48:51], a[208:211], v[72:75], v[48:51]
  v_mfma_f32_16x16x32_bf16 v[52:55], a[208:211], v[76:79], v[52:55]
  v_mfma_f32_16x16x32_bf16 v[56:59], v[144:147], v[72:75], v[56:59]
  v_mfma_f32_16x16x32_bf16 v[60:63], v[144:147], v[76:79], v[60:63]
  ds_read_b128 v[72:75], v7 offset:15360
  ds_read_b128 v[76:79], v7 offset:35840
  s_waitcnt lgkmcnt(4)
  v_mfma_f32_16x16x32_bf16 v[32:35], a[52:55], v[80:83], v[32:35]
  v_mfma_f32_16x16x32_bf16 v[36:39], a[52:55], v[84:87], v[36:39]
  v_mfma_f32_16x16x32_bf16 v[40:43], a[132:135], v[80:83], v[40:43]
  v_mfma_f32_16x16x32_bf16 v[44:47], a[132:135], v[84:87], v[44:47]
  v_mfma_f32_16x16x32_bf16 v[48:51], a[212:215], v[80:83], v[48:51]
  v_mfma_f32_16x16x32_bf16 v[52:55], a[212:215], v[84:87], v[52:55]
  v_mfma_f32_16x16x32_bf16 v[56:59], v[148:151], v[80:83], v[56:59]
  v_mfma_f32_16x16x32_bf16 v[60:63], v[148:151], v[84:87], v[60:63]
  ds_read_b128 v[80:83], v7 offset:16384
  ds_read_b128 v[84:87], v7 offset:36864
  s_waitcnt lgkmcnt(4)
  v_mfma_f32_16x16x32_bf16 v[32:35], a[56:59], v[88:91], v[32:35]
  v_mfma_f32_16x16x32_bf16 v[36:39], a[56:59], v[92:95], v[36:39]
  v_mfma_f32_16x16x32_bf16 v[40:43], a[136:139], v[88:91], v[40:43]
  v_mfma_f32_16x16x32_bf16 v[44:47], a[136:139], v[92:95], v[44:47]
  v_mfma_f32_16x16x32_bf16 v[48:51], a[216:219], v[88:91], v[48:51]
  v_mfma_f32_16x16x32_bf16 v[52:55], a[216:219], v[92:95], v[52:55]
  v_mfma_f32_16x16x32_bf16 v[56:59], v[152:155], v[88:91], v[56:59]
  v_mfma_f32_16x16x32_bf16 v[60:63], v[152:155], v[92:95], v[60:63]
  ds_read_b128 v[88:91], v7 offset:17408
  ds_read_b128 v[92:95], v7 offset:37888
  s_waitcnt lgkmcnt(4)
  v_mfma_f32_16x16x32_bf16 v[32:35], a[60:63], v[72:75], v[32:35]
  v_mfma_f32_16x16x32_bf16 v[36:39], a[60:63], v[76:79], v[36:39]
  v_mfma_f32_16x16x32_bf16 v[40:43], a[140:143], v[72:75], v[40:43]
  v_mfma_f32_16x16x32_bf16 v[44:47], a[140:143], v[76:79], v[44:47]
  v_mfma_f32_16x16x32_bf16 v[48:51], a[220:223], v[72:75], v[48:51]
  v_mfma_f32_16x16x32_bf16 v[52:55], a[220:223], v[76:79], v[52:55]
  v_mfma_f32_16x16x32_bf16 v[56:59], v[156:159], v[72:75], v[56:59]
  v_mfma_f32_16x16x32_bf16 v[60:63], v[156:159], v[76:79], v[60:63]
  ds_read_b128 v[72:75], v7 offset:18432
  ds_read_b128 v[76:79], v7 offset:38912
  s_waitcnt lgkmcnt(4)
  v_mfma_f32_16x16x32_bf16 v[32:35], a[64:67], v[80:83], v[32:35]
  v_mfma_f32_16x16x32_bf16 v[36:39], a[64:67], v[84:87], v[36:39]
  v_mfma_f32_16x16x32_bf16 v[40:43], a[144:147], v[80:83], v[40:43]
  v_mfma_f32_16x16x32_bf16 v[44:47], a[144:147], v[84:87], v[44:47]
  v_mfma_f32_16x16x32_bf16 v[48:51], a[224:227], v[80:83], v[48:51]
  v_mfma_f32_16x16x32_bf16 v[52:55], a[224:227], v[84:87], v[52:55]
  v_mfma_f32_16x16x32_bf16 v[56:59], v[160:163], v[80:83], v[56:59]
  v_mfma_f32_16x16x32_bf16 v[60:63], v[160:163], v[84:87], v[60:63]
  ds_read_b128 v[80:83], v7 offset:19456
  ds_read_b128 v[84:87], v7 offset:39936
  s_waitcnt lgkmcnt(4)
  v_mfma_f32_16x16x32_bf16 v[32:35], a[68:71], v[88:91], v[32:35]
  v_mfma_f32_16x16x32_bf16 v[36:39], a[68:71], v[92:95], v[36:39]
  v_mfma_f32_16x16x32_bf16 v[40:43], a[148:151], v[88:91], v[40:43]
  v_mfma_f32_16x16x32_bf16 v[44:47], a[148:151], v[92:95], v[44:47]
  v_mfma_f32_16x16x32_bf16 v[48:51], a[228:231], v[88:91], v[48:51]
  v_mfma_f32_16x16x32_bf16 v[52:55], a[228:231], v[92:95], v[52:55]
  v_mfma_f32_16x16x32_bf16 v[56:59], v[164:167], v[88:91], v[56:59]
  v_mfma_f32_16x16x32_bf16 v[60:63], v[164:167], v[92:95], v[60:63]
  s_waitcnt lgkmcnt(2)
  v_mfma_f32_16x16x32_bf16 v[32:35], a[72:75], v[72:75], v[32:35]
  v_mfma_f32_16x16x32_bf16 v[36:39], a[72:75], v[76:79], v[36:39]
  v_mfma_f32_16x16x32_bf16 v[40:43], a[152:155], v[72:75], v[40:43]
  v_mfma_f32_16x16x32_bf16 v[44:47], a[152:155], v[76:79], v[44:47]
  v_mfma_f32_16x16x32_bf16 v[48:51], a[232:235], v[72:75], v[48:51]
  v_mfma_f32_16x16x32_bf16 v[52:55], a[232:235], v[76:79], v[52:55]
  v_mfma_f32_16x16x32_bf16 v[56:59], v[168:171], v[72:75], v[56:59]
  v_mfma_f32_16x16x32_bf16 v[60:63], v[168:171], v[76:79], v[60:63]
  s_waitcnt lgkmcnt(0)
  v_mfma_f32_16x16x32_bf16 v[32:35], a[76:79], v[80:83], v[32:35]
  v_mfma_f32_16x16x32_bf16 v[36:39], a[76:79], v[84:87], v[36:39]
  v_mfma_f32_16x16x32_bf16 v[40:43], a[156:159], v[80:83], v[40:43]
  v_mfma_f32_16x16x32_bf16 v[44:47], a[156:159], v[84:87], v[44:47]
  v_mfma_f32_16x16x32_bf16 v[48:51], a[236:239], v[80:83], v[48:51]
  v_mfma_f32_16x16x32_bf16 v[52:55], a[236:239], v[84:87], v[52:55]
  v_mfma_f32_16x16x32_bf16 v[56:59], v[172:175], v[80:83], v[56:59]
  v_mfma_f32_16x16x32_bf16 v[60:63], v[172:175], v[84:87], v[60:63]
  s_nop 0
  v_cvt_pk_bf16_f32 v8, v32, v33
  v_cvt_pk_bf16_f32 v9, v34, v35
  v_cvt_pk_bf16_f32 v10, v40, v41
  v_cvt_pk_bf16_f32 v11, v42, v43
  s_add_u32 s34, s22, 1024
  buffer_store_dwordx4 v[8:11], v1, s[4:7], s34 offen
  v_cvt_pk_bf16_f32 v12, v36, v37
  v_cvt_pk_bf16_f32 v13, v38, v39
  v_cvt_pk_bf16_f32 v14, v44, v45
  v_cvt_pk_bf16_f32 v15, v46, v47
  s_add_u32 s34, s22, 7168
  buffer_store_dwordx4 v[12:15], v1, s[4:7], s34 offen
  v_cvt_pk_bf16_f32 v8, v48, v49
  v_cvt_pk_bf16_f32 v9, v50, v51
  v_cvt_pk_bf16_f32 v10, v56, v57
  v_cvt_pk_bf16_f32 v11, v58, v59
  s_add_u32 s34, s22, 2048
  buffer_store_dwordx4 v[8:11], v1, s[4:7], s34 offen
  v_cvt_pk_bf16_f32 v12, v52, v53
  v_cvt_pk_bf16_f32 v13, v54, v55
  v_cvt_pk_bf16_f32 v14, v60, v61
  v_cvt_pk_bf16_f32 v15, v62, v63
  s_add_u32 s34, s22, 8192
  buffer_store_dwordx4 v[12:15], v1, s[4:7], s34 offen
  s_waitcnt vmcnt(0)
  s_barrier
  s_add_u32 s17, s17, 1
  s_cmp_lt_u32 s17, 64
  s_cbranch_scc1 reca_ptop272
  s_branch reca_exit1
reca_pslow271:
reca_ptop277:
  s_cmp_lt_u32 s17, 3
  s_cbranch_scc1 reca_pgo278
  s_sub_u32 s36, s17, 3
reca_ppoll279:
  buffer_load_dword v28, v4, s[4:7], s25 offen sc1
  s_waitcnt vmcnt(0)
  v_readfirstlane_b32 s34, v28
  s_nop 3
  s_cmp_ge_i32 s34, s36
  s_cbranch_scc1 reca_pgo278
  s_sleep 8
  s_sub_u32 s18, s18, 1
  s_cbranch_scc0 reca_ppoll279
  s_mov_b32 s18, 0
reca_pgo278:
  s_waitcnt vmcnt(0)
  s_barrier
  v_add_u32 v7, s26, v1
  s_xor_b32 s26, s26, 40960
  s_add_u32 s37, s17, 1
  s_cmp_ge_u32 s37, 64
  s_cbranch_scc1 reca_pnodma280
  s_mul_i32 s20, s37, 40960
  s_add_u32 s20, s20, 84965376
  s_add_u32 m0, s26, 30720
  s_nop 0
  buffer_load_dwordx4 v1, s[4:7], s20 offen offset:0 lds
  buffer_load_dwordx4 v1, s[4:7], s20 offen offset:1024 lds
  buffer_load_dwordx4 v1, s[4:7], s20 offen offset:2048 lds
  buffer_load_dwordx4 v1, s[4:7], s20 offen offset:3072 lds
  s_add_u32 s20, s20, 4096
  s_add_u32 m0, s26, 34816
  s_nop 0
  buffer_load_dwordx4 v1, s[4:7], s20 offen offset:0 lds
  buffer_load_dwordx4 v1, s[4:7], s20 offen offset:1024 lds
  buffer_load_dwordx4 v1, s[4:7], s20 offen offset:2048 lds
  buffer_load_dwordx4 v1, s[4:7], s20 offen offset:3072 lds
  s_add_u32 s20, s20, 4096
  s_add_u32 m0, s26, 38912
  s_nop 0
  buffer_load_dwordx4 v1, s[4:7], s20 offen offset:0 lds
  buffer_load_dwordx4 v1, s[4:7], s20 offen offset:1024 lds
reca_pnodma280:
  s_lshl_b32 s34, s15, 3
  s_and_b32 s35, s17, 7
  s_add_u32 s34, s34, s35
  s_mul_i32 s34, s34, 12288
  s_mul_i32 s35, s16, 3072
  s_add_u32 s35, s35, s34
  s_add_u32 s21, s35, 37748736
  s_add_u32 s22, s35, 44040192
  s_mul_i32 s35, s16, 6144
  s_add_u32 s35, s35, s34
  s_add_u32 s23, s35, 40894464
  ds_read_b128 v[72:75], v7 offset:0
  ds_read_b128 v[76:79], v7 offset:20480
  ds_read_b128 v[80:83], v7 offset:1024
  ds_read_b128 v[84:87], v7 offset:21504
  ds_read_b128 v[88:91], v7 offset:2048
  ds_read_b128 v[92:95], v7 offset:22528
  s_waitcnt lgkmcnt(4)
  v_mfma_f32_16x16x32_bf16 v[32:35], a[0:3], v[72:75], 0
  v_mfma_f32_16x16x32_bf16 v[36:39], a[0:3], v[76:79], 0
  v_mfma_f32_16x16x32_bf16 v[40:43], a[80:83], v[72:75], 0
  v_mfma_f32_16x16x32_bf16 v[44:47], a[80:83], v[76:79], 0
  v_mfma_f32_16x16x32_bf16 v[48:51], a[160:163], v[72:75], 0
  v_mfma_f32_16x16x32_bf16 v[52:55], a[160:163], v[76:79], 0
  v_mfma_f32_16x16x32_bf16 v[56:59], v[96:99], v[72:75], 0
  v_mfma_f32_16x16x32_bf16 v[60:63], v[96:99], v[76:79], 0
  ds_read_b128 v[72:75], v7 offset:3072
  ds_read_b128 v[76:79], v7 offset:23552
  s_waitcnt lgkmcnt(4)
  v_mfma_f32_16x16x32_bf16 v[32:35], a[4:7], v[80:83], v[32:35]
  v_mfma_f32_16x16x32_bf16 v[36:39], a[4:7], v[84:87], v[36:39]
  v_mfma_f32_16x16x32_bf16 v[40:43], a[84:87], v[80:83], v[40:43]
  v_mfma_f32_16x16x32_bf16 v[44:47], a[84:87], v[84:87], v[44:47]
  v_mfma_f32_16x16x32_bf16 v[48:51], a[164:167], v[80:83], v[48:51]
  v_mfma_f32_16x16x32_bf16 v[52:55], a[164:167], v[84:87], v[52:55]
  v_mfma_f32_16x16x32_bf16 v[56:59], v[100:103], v[80:83], v[56:59]
  v_mfma_f32_16x16x32_bf16 v[60:63], v[100:103], v[84:87], v[60:63]
  ds_read_b128 v[80:83], v7 offset:4096
  ds_read_b128 v[84:87], v7 offset:24576
  s_waitcnt lgkmcnt(4)
  v_mfma_f32_16x16x32_bf16 v[32:35], a[8:11], v[88:91], v[32:35]
  v_mfma_f32_16x16x32_bf16 v[36:39], a[8:11], v[92:95], v[36:39]
  v_mfma_f32_16x16x32_bf16 v[40:43], a[88:91], v[88:91], v[40:43]
  v_mfma_f32_16x16x32_bf16 v[44:47], a[88:91], v[92:95], v[44:47]
  v_mfma_f32_16x16x32_bf16 v[48:51], a[168:171], v[88:91], v[48:51]
  v_mfma_f32_16x16x32_bf16 v[52:55], a[168:171], v[92:95], v[52:55]
  v_mfma_f32_16x16x32_bf16 v[56:59], v[104:107], v[88:91], v[56:59]
  v_mfma_f32_16x16x32_bf16 v[60:63], v[104:107], v[92:95], v[60:63]
  ds_read_b128 v[88:91], v7 offset:5120
  ds_read_b128 v[92:95], v7 offset:25600
  s_waitcnt lgkmcnt(4)
  v_mfma_f32_16x16x32_bf16 v[32:35], a[12:15], v[72:75], v[32:35]
  v_mfma_f32_16x16x32_bf16 v[36:39], a[12:15], v[76:79], v[36:39]
  v_mfma_f32_16x16x32_bf16 v[40:43], a[92:95], v[72:75], v[40:43]
  v_mfma_f32_16x16x32_bf16 v[44:47], a[92:95], v[76:79], v[44:47]
  v_mfma_f32_16x16x32_bf16 v[48:51], a[172:175], v[72:75], v[48:51]
  v_mfma_f32_16x16x32_bf16 v[52:55], a[172:175], v[76:79], v[52:55]
  v_mfma_f32_16x16x32_bf16 v[56:59], v[108:111], v[72:75], v[56:59]
  v_mfma_f32_16x16x32_bf16 v[60:63], v[108:111], v[76:79], v[60:63]
  ds_read_b128 v[72:75], v7 offset:6144
  ds_read_b128 v[76:79], v7 offset:26624
  s_waitcnt lgkmcnt(4)
  v_mfma_f32_16x16x32_bf16 v[32:35], a[16:19], v[80:83], v[32:35]
  v_mfma_f32_16x16x32_bf16 v[36:39], a[16:19], v[84:87], v[36:39]
  v_mfma_f32_16x16x32_bf16 v[40:43], a[96:99], v[80:83], v[40:43]
  v_mfma_f32_16x16x32_bf16 v[44:47], a[96:99], v[84:87], v[44:47]
  v_mfma_f32_16x16x32_bf16 v[48:51], a[176:179], v[80:83], v[48:51]
  v_mfma_f32_16x16x32_bf16 v[52:55], a[176:179], v[84:87], v[52:55]
  v_mfma_f32_16x16x32_bf16 v[56:59], v[112:115], v[80:83], v[56:59]
  v_mfma_f32_16x16x32_bf16 v[60:63], v[112:115], v[84:87], v[60:63]
  ds_read_b128 v[80:83], v7 offset:7168
  ds_read_b128 v[84:87], v7 offset:27648
  s_waitcnt lgkmcnt(4)
  v_mfma_f32_16x16x32_bf16 v[32:35], a[20:23], v[88:91], v[32:35]
  v_mfma_f32_16x16x32_bf16 v[36:39], a[20:23], v[92:95], v[36:39]
  v_mfma_f32_16x16x32_bf16 v[40:43], a[100:103], v[88:91], v[40:43]
  v_mfma_f32_16x16x32_bf16 v[44:47], a[100:103], v[92:95], v[44:47]
  v_mfma_f32_16x16x32_bf16 v[48:51], a[180:183], v[88:91], v[48:51]
  v_mfma_f32_16x16x32_bf16 v[52:55], a[180:183], v[92:95], v[52:55]
  v_mfma_f32_16x16x32_bf16 v[56:59], v[116:119], v[88:91], v[56:59]
  v_mfma_f32_16x16x32_bf16 v[60:63], v[116:119], v[92:95], v[60:63]
  ds_read_b128 v[88:91], v7 offset:8192
  ds_read_b128 v[92:95], v7 offset:28672
  s_waitcnt lgkmcnt(4)
  v_mfma_f32_16x16x32_bf16 v[32:35], a[24:27], v[72:75], v[32:35]
  v_mfma_f32_16x16x32_bf16 v[36:39], a[24:27], v[76:79], v[36:39]
  v_mfma_f32_16x16x32_bf16 v[40:43], a[104:107], v[72:75], v[40:43]
  v_mfma_f32_16x16x32_bf16 v[44:47], a[104:107], v[76:79], v[44:47]
  v_mfma_f32_16x16x32_bf16 v[48:51], a[184:187], v[72:75], v[48:51]
  v_mfma_f32_16x16x32_bf16 v[52:55], a[184:187], v[76:79], v[52:55]
  v_mfma_f32_16x16x32_bf16 v[56:59], v[120:123], v[72:75], v[56:59]
  v_mfma_f32_16x16x32_bf16 v[60:63], v[120:123], v[76:79], v[60:63]
  ds_read_b128 v[72:75], v7 offset:9216
  ds_read_b128 v[76:79], v7 offset:29696
  s_waitcnt lgkmcnt(4)
  v_mfma_f32_16x16x32_bf16 v[32:35], a[28:31], v[80:83], v[32:35]
  v_mfma_f32_16x16x32_bf16 v[36:39], a[28:31], v[84:87], v[36:39]
  v_mfma_f32_16x16x32_bf16 v[40:43], a[108:111], v[80:83], v[40:43]
  v_mfma_f32_16x16x32_bf16 v[44:47], a[108:111], v[84:87], v[44:47]
  v_mfma_f32_16x16x32_bf16 v[48:51], a[188:191], v[80:83], v[48:51]
  v_mfma_f32_16x16x32_bf16 v[52:55], a[188:191], v[84:87], v[52:55]
  v_mfma_f32_16x16x32_bf16 v[56:59], v[124:127], v[80:83], v[56:59]
  v_mfma_f32_16x16x32_bf16 v[60:63], v[124:127], v[84:87], v[60:63]
  ds_read_b128 v[80:83], v7 offset:10240
  ds_read_b128 v[84:87], v7 offset:30720
  s_waitcnt lgkmcnt(4)
  v_mfma_f32_16x16x32_bf16 v[32:35], a[32:35], v[88:91], v[32:35]
  v_mfma_f32_16x16x32_bf16 v[36:39], a[32:35], v[92:95], v[36:39]
  v_mfma_f32_16x16x32_bf16 v[40:43], a[112:115], v[88:91], v[40:43]
  v_mfma_f32_16x16x32_bf16 v[44:47], a[112:115], v[92:95], v[44:47]
  v_mfma_f32_16x16x32_bf16 v[48:51], a[192:195], v[88:91], v[48:51]
  v_mfma_f32_16x16x32_bf16 v[52:55], a[192:195], v[92:95], v[52:55]
  v_mfma_f32_16x16x32_bf16 v[56:59], v[128:131], v[88:91], v[56:59]
  v_mfma_f32_16x16x32_bf16 v[60:63], v[128:131], v[92:95], v[60:63]
  ds_read_b128 v[88:91], v7 offset:11264
  ds_read_b128 v[92:95], v7 offset:31744
  s_waitcnt lgkmcnt(4)
  v_mfma_f32_16x16x32_bf16 v[32:35], a[36:39], v[72:75], v[32:35]
  v_mfma_f32_16x16x32_bf16 v[36:39], a[36:39], v[76:79], v[36:39]
  v_mfma_f32_16x16x32_bf16 v[40:43], a[116:119], v[72:75], v[40:43]
  v_mfma_f32_16x16x32_bf16 v[44:47], a[116:119], v[76:79], v[44:47]
  v_mfma_f32_16x16x32_bf16 v[48:51], a[196:199], v[72:75], v[48:51]
  v_mfma_f32_16x16x32_bf16 v[52:55], a[196:199], v[76:79], v[52:55]
  v_mfma_f32_16x16x32_bf16 v[56:59], v[132:135], v[72:75], v[56:59]
  v_mfma_f32_16x16x32_bf16 v[60:63], v[132:135], v[76:79], v[60:63]
  ds_read_b128 v[72:75], v7 offset:12288
  ds_read_b128 v[76:79], v7 offset:32768
  s_waitcnt lgkmcnt(4)
  v_mfma_f32_16x16x32_bf16 v[32:35], a[40:43], v[80:83], v[32:35]
  v_mfma_f32_16x16x32_bf16 v[36:39], a[40:43], v[84:87], v[36:39]
  v_mfma_f32_16x16x32_bf16 v[40:43], a[120:123], v[80:83], v[40:43]
  v_mfma_f32_16x16x32_bf16 v[44:47], a[120:123], v[84:87], v[44:47]
  v_mfma_f32_16x16x32_bf16 v[48:51], a[200:203], v[80:83], v[48:51]
  v_mfma_f32_16x16x32_bf16 v[52:55], a[200:203], v[84:87], v[52:55]
  v_mfma_f32_16x16x32_bf16 v[56:59], v[136:139], v[80:83], v[56:59]
  v_mfma_f32_16x16x32_bf16 v[60:63], v[136:139], v[84:87], v[60:63]
  ds_read_b128 v[80:83], v7 offset:13312
  ds_read_b128 v[84:87], v7 offset:33792
  s_waitcnt lgkmcnt(4)
  v_mfma_f32_16x16x32_bf16 v[32:35], a[44:47], v[88:91], v[32:35]
  v_mfma_f32_16x16x32_bf16 v[36:39], a[44:47], v[92:95], v[36:39]
  v_mfma_f32_16x16x32_bf16 v[40:43], a[124:127], v[88:91], v[40:43]
  v_mfma_f32_16x16x32_bf16 v[44:47], a[124:127], v[92:95], v[44:47]
  v_mfma_f32_16x16x32_bf16 v[48:51], a[204:207], v[88:91], v[48:51]
  v_mfma_f32_16x16x32_bf16 v[52:55], a[204:207], v[92:95], v[52:55]
  v_mfma_f32_16x16x32_bf16 v[56:59], v[140:143], v[88:91], v[56:59]
  v_mfma_f32_16x16x32_bf16 v[60:63], v[140:143], v[92:95], v[60:63]
  ds_read_b128 v[88:91], v7 offset:14336
  ds_read_b128 v[92:95], v7 offset:34816
  s_waitcnt lgkmcnt(4)
  v_mfma_f32_16x16x32_bf16 v[32:35], a[48:51], v[72:75], v[32:35]
  v_mfma_f32_16x16x32_bf16 v[36:39], a[48:51], v[76:79], v[36:39]
  v_mfma_f32_16x16x32_bf16 v[40:43], a[128:131], v[72:75], v[40:43]
  v_mfma_f32_16x16x32_bf16 v[44:47], a[128:131], v[76:79], v[44:47]
  v_mfma_f32_16x16x32_bf16 v[48:51], a[208:211], v[72:75], v[48:51]
  v_mfma_f32_16x16x32_bf16 v[52:55], a[208:211], v[76:79], v[52:55]
  v_mfma_f32_16x16x32_bf16 v[56:59], v[144:147], v[72:75], v[56:59]
  v_mfma_f32_16x16x32_bf16 v[60:63], v[144:147], v[76:79], v[60:63]
  ds_read_b128 v[72:75], v7 offset:15360
  ds_read_b128 v[76:79], v7 offset:35840
  s_waitcnt lgkmcnt(4)
  v_mfma_f32_16x16x32_bf16 v[32:35], a[52:55], v[80:83], v[32:35]
  v_mfma_f32_16x16x32_bf16 v[36:39], a[52:55], v[84:87], v[36:39]
  v_mfma_f32_16x16x32_bf16 v[40:43], a[132:135], v[80:83], v[40:43]
  v_mfma_f32_16x16x32_bf16 v[44:47], a[132:135], v[84:87], v[44:47]
  v_mfma_f32_16x16x32_bf16 v[48:51], a[212:215], v[80:83], v[48:51]
  v_mfma_f32_16x16x32_bf16 v[52:55], a[212:215], v[84:87], v[52:55]
  v_mfma_f32_16x16x32_bf16 v[56:59], v[148:151], v[80:83], v[56:59]
  v_mfma_f32_16x16x32_bf16 v[60:63], v[148:151], v[84:87], v[60:63]
  ds_read_b128 v[80:83], v7 offset:16384
  ds_read_b128 v[84:87], v7 offset:36864
  s_waitcnt lgkmcnt(4)
  v_mfma_f32_16x16x32_bf16 v[32:35], a[56:59], v[88:91], v[32:35]
  v_mfma_f32_16x16x32_bf16 v[36:39], a[56:59], v[92:95], v[36:39]
  v_mfma_f32_16x16x32_bf16 v[40:43], a[136:139], v[88:91], v[40:43]
  v_mfma_f32_16x16x32_bf16 v[44:47], a[136:139], v[92:95], v[44:47]
  v_mfma_f32_16x16x32_bf16 v[48:51], a[216:219], v[88:91], v[48:51]
  v_mfma_f32_16x16x32_bf16 v[52:55], a[216:219], v[92:95], v[52:55]
  v_mfma_f32_16x16x32_bf16 v[56:59], v[152:155], v[88:91], v[56:59]
  v_mfma_f32_16x16x32_bf16 v[60:63], v[152:155], v[92:95], v[60:63]
  ds_read_b128 v[88:91], v7 offset:17408
  ds_read_b128 v[92:95], v7 offset:37888
  s_waitcnt lgkmcnt(4)
  v_mfma_f32_16x16x32_bf16 v[32:35], a[60:63], v[72:75], v[32:35]
  v_mfma_f32_16x16x32_bf16 v[36:39], a[60:63], v[76:79], v[36:39]
  v_mfma_f32_16x16x32_bf16 v[40:43], a[140:143], v[72:75], v[40:43]
  v_mfma_f32_16x16x32_bf16 v[44:47], a[140:143], v[76:79], v[44:47]
  v_mfma_f32_16x16x32_bf16 v[48:51], a[220:223], v[72:75], v[48:51]
  v_mfma_f32_16x16x32_bf16 v[52:55], a[220:223], v[76:79], v[52:55]
  v_mfma_f32_16x16x32_bf16 v[56:59], v[156:159], v[72:75], v[56:59]
  v_mfma_f32_16x16x32_bf16 v[60:63], v[156:159], v[76:79], v[60:63]
  ds_read_b128 v[72:75], v7 offset:18432
  ds_read_b128 v[76:79], v7 offset:38912
  s_waitcnt lgkmcnt(4)
  v_mfma_f32_16x16x32_bf16 v[32:35], a[64:67], v[80:83], v[32:35]
  v_mfma_f32_16x16x32_bf16 v[36:39], a[64:67], v[84:87], v[36:39]
  v_mfma_f32_16x16x32_bf16 v[40:43], a[144:147], v[80:83], v[40:43]
  v_mfma_f32_16x16x32_bf16 v[44:47], a[144:147], v[84:87], v[44:47]
  v_mfma_f32_16x16x32_bf16 v[48:51], a[224:227], v[80:83], v[48:51]
  v_mfma_f32_16x16x32_bf16 v[52:55], a[224:227], v[84:87], v[52:55]
  v_mfma_f32_16x16x32_bf16 v[56:59], v[160:163], v[80:83], v[56:59]
  v_mfma_f32_16x16x32_bf16 v[60:63], v[160:163], v[84:87], v[60:63]
  ds_read_b128 v[80:83], v7 offset:19456
  ds_read_b128 v[84:87], v7 offset:39936
  s_waitcnt lgkmcnt(4)
  v_mfma_f32_16x16x32_bf16 v[32:35], a[68:71], v[88:91], v[32:35]
  v_mfma_f32_16x16x32_bf16 v[36:39], a[68:71], v[92:95], v[36:39]
  v_mfma_f32_16x16x32_bf16 v[40:43], a[148:151], v[88:91], v[40:43]
  v_mfma_f32_16x16x32_bf16 v[44:47], a[148:151], v[92:95], v[44:47]
  v_mfma_f32_16x16x32_bf16 v[48:51], a[228:231], v[88:91], v[48:51]
  v_mfma_f32_16x16x32_bf16 v[52:55], a[228:231], v[92:95], v[52:55]
  v_mfma_f32_16x16x32_bf16 v[56:59], v[164:167], v[88:91], v[56:59]
  v_mfma_f32_16x16x32_bf16 v[60:63], v[164:167], v[92:95], v[60:63]
  s_waitcnt lgkmcnt(2)
  v_mfma_f32_16x16x32_bf16 v[32:35], a[72:75], v[72:75], v[32:35]
  v_mfma_f32_16x16x32_bf16 v[36:39], a[72:75], v[76:79], v[36:39]
  v_mfma_f32_16x16x32_bf16 v[40:43], a[152:155], v[72:75], v[40:43]
  v_mfma_f32_16x16x32_bf16 v[44:47], a[152:155], v[76:79], v[44:47]
  v_mfma_f32_16x16x32_bf16 v[48:51], a[232:235], v[72:75], v[48:51]
  v_mfma_f32_16x16x32_bf16 v[52:55], a[232:235], v[76:79], v[52:55]
  v_mfma_f32_16x16x32_bf16 v[56:59], v[168:171], v[72:75], v[56:59]
  v_mfma_f32_16x16x32_bf16 v[60:63], v[168:171], v[76:79], v[60:63]
  s_waitcnt lgkmcnt(0)
  v_mfma_f32_16x16x32_bf16 v[32:35], a[76:79], v[80:83], v[32:35]
  v_mfma_f32_16x16x32_bf16 v[36:39], a[76:79], v[84:87], v[36:39]
  v_mfma_f32_16x16x32_bf16 v[40:43], a[156:159], v[80:83], v[40:43]
  v_mfma_f32_16x16x32_bf16 v[44:47], a[156:159], v[84:87], v[44:47]
  v_mfma_f32_16x16x32_bf16 v[48:51], a[236:239], v[80:83], v[48:51]
  v_mfma_f32_16x16x32_bf16 v[52:55], a[236:239], v[84:87], v[52:55]
  v_mfma_f32_16x16x32_bf16 v[56:59], v[172:175], v[80:83], v[56:59]
  v_mfma_f32_16x16x32_bf16 v[60:63], v[172:175], v[84:87], v[60:63]
  s_nop 0
  v_cvt_pk_bf16_f32 v8, v32, v33
  v_cvt_pk_bf16_f32 v9, v34, v35
  v_cvt_pk_bf16_f32 v10, v40, v41
  v_cvt_pk_bf16_f32 v11, v42, v43
  s_add_u32 s34, s22, 1024
  buffer_store_dwordx4 v[8:11], v1, s[4:7], s34 offen sc1
  v_cvt_pk_bf16_f32 v12, v36, v37
  v_cvt_pk_bf16_f32 v13, v38, v39
  v_cvt_pk_bf16_f32 v14, v44, v45
  v_cvt_pk_bf16_f32 v15, v46, v47
  s_add_u32 s34, s22, 7168
  buffer_store_dwordx4 v[12:15], v1, s[4:7], s34 offen sc1
  v_cvt_pk_bf16_f32 v8, v48, v49
  v_cvt_pk_bf16_f32 v9, v50, v51
  v_cvt_pk_bf16_f32 v10, v56, v57
  v_cvt_pk_bf16_f32 v11, v58, v59
  s_add_u32 s34, s22, 2048
  buffer_store_dwordx4 v[8:11], v1, s[4:7], s34 offen sc1
  v_cvt_pk_bf16_f32 v12, v52, v53
  v_cvt_pk_bf16_f32 v13, v54, v55
  v_cvt_pk_bf16_f32 v14, v60, v61
  v_cvt_pk_bf16_f32 v15, v62, v63
  s_add_u32 s34, s22, 8192
  buffer_store_dwordx4 v[12:15], v1, s[4:7], s34 offen sc1
  s_waitcnt vmcnt(0)
  s_barrier
  s_add_u32 s17, s17, 1
  s_cmp_lt_u32 s17, 64
  s_cbranch_scc1 reca_ptop277
  s_branch reca_exit1
reca_exit1:
reca_exitb3:
  s_endpgm
.globl fin_kernel
.p2align 8
.type fin_kernel,@function
fin_kernel:
  s_cmp_ge_u32 s2, 256
  s_cbranch_scc1 fin_exit1
  s_load_dwordx2 s[8:9], s[0:1], 96
  v_lshrrev_b32 v6, 6, v0
  v_and_b32 v7, 63, v0
  s_and_b32 s13, s2, 7
  v_readfirstlane_b32 s12, v6
  v_lshlrev_b32 v1, 4, v7
  v_add_u32 v2, 0x1000, v1
  v_add_u32 v3, 0x2000, v1
  s_lshr_b32 s14, s2, 3
  s_lshl_b32 s15, s13, 2
  s_add_u32 s15, s15, s12
  s_waitcnt lgkmcnt(0)
  s_mov_b32 s4, s8
  s_mov_b32 s5, s9
  s_mov_b32 s6, 0x10000000
  s_mov_b32 s7, 0x20000
  s_mov_b32 s27, 0x3dd53b95
  v_and_b32 v6, 15, v7
  v_lshrrev_b32 v8, 4, v7
  v_mov_b32 v9, 0x80000000
  v_lshlrev_b32 v10, 4, v6
  v_lshl_add_u32 v10, v8, 7, v10
  v_cmp_gt_u32 vcc, 8, v6
  s_nop 1
  v_cndmask_b32 v4, v9, v10, vcc
  v_lshlrev_b32 v10, 3, v7
  v_cmp_gt_u32 vcc, 32, v7
  s_nop 1
  v_cndmask_b32 v5, v9, v10, vcc
  v_mov_b32 v10, 0xf149f2ca
  v_cmp_le_u32 vcc, 2, v8
  s_nop 1
  v_cndmask_b32 v12, 0, v10, vcc
  v_mov_b32 v13, v12
  v_mov_b32 v14, v12
  v_mov_b32 v15, v12
  v_lshlrev_b32 v11, 2, v8
  v_add_u32 v7, 0, v11
  v_cmp_gt_u32 vcc, v7, v6
  s_nop 1
  v_cndmask_b32 v16, 0, v10, vcc
  v_add_u32 v7, 1, v11
  v_cmp_gt_u32 vcc, v7, v6
  s_nop 1
  v_cndmask_b32 v17, 0, v10, vcc
  v_add_u32 v7, 2, v11
  v_cmp_gt_u32 vcc, v7, v6
  s_nop 1
  v_cndmask_b32 v18, 0, v10, vcc
  v_add_u32 v7, 3, v11
  v_cmp_gt_u32 vcc, v7, v6
  s_nop 1
  v_cndmask_b32 v19, 0, v10, vcc
  v_mov_b32 v20, 0x3f803f80
  v_mov_b32 v21, 0x3f803f80
  v_mov_b32 v22, 0x3f803f80
  v_mov_b32 v23, 0x3f803f80
  s_mul_i32 s16, s12, 6144
  v_add_u32 v240, s16, v1
  v_add_u32 v241, 49152, v240
  s_mul_i32 s16, s12, 10
  s_mul_i32 s16, s16, 192
  s_mul_i32 s17, s13, 24
  s_add_u32 s16, s16, s17
  s_lshl_b32 s16, s16, 10
  s_add_u32 s16, s16, 29884416
  s_add_u32 s30, s16, 0
  s_add_u32 s31, s16, 196608
  s_add_u32 s32, s16, 393216
  s_add_u32 s33, s16, 589824
  s_add_u32 s34, s16, 786432
  s_add_u32 s35, s16, 983040
  s_add_u32 s36, s16, 1179648
  s_add_u32 s37, s16, 1376256
  s_add_u32 s38, s16, 1572864
  s_add_u32 s39, s16, 1769472
  s_cmp_lt_u32 s14, 30
  s_cbranch_scc1 fin_odma3
  s_lshl_b32 s17, s14, 1
  s_add_u32 s17, s17, 0
  s_and_b32 s17, s17, 7
  s_lshl_b32 s16, s15, 3
  s_add_u32 s16, s16, s17
  s_mul_i32 s16, s16, 12288
  s_add_u32 s20, s16, 44040192
  s_add_u32 s21, s16, 37748736
  s_add_u32 s22, s16, 40894464
  s_lshl_b32 s17, s17, 5
  s_add_u32 s17, s17, s15
  s_mul_i32 s17, s17, 3072
  s_add_u32 s23, s17, 47185920
  s_add_u32 s24, s17, 47972352
  s_lshl_b32 s17, s14, 1
  s_add_u32 s17, s17, 1
  s_and_b32 s17, s17, 7
  s_lshl_b32 s16, s15, 3
  s_add_u32 s16, s16, s17
  s_mul_i32 s16, s16, 12288
  s_add_u32 s40, s16, 44040192
  s_add_u32 s41, s16, 37748736
  s_add_u32 s42, s16, 40894464
  s_lshl_b32 s17, s17, 5
  s_add_u32 s17, s17, s15
  s_mul_i32 s17, s17, 3072
  s_add_u32 s43, s17, 47185920
  s_add_u32 s44, s17, 47972352
  buffer_load_dwordx4 v[136:139], v1, s[4:7], s21 offen offset:0
  buffer_load_dwordx4 v[140:143], v1, s[4:7], s21 offen offset:1024
  buffer_load_dwordx4 v[144:147], v1, s[4:7], s21 offen offset:2048
  buffer_load_dwordx4 v[148:151], v1, s[4:7], s21 offen offset:3072
  buffer_load_dwordx4 v[152:155], v2, s[4:7], s21 offen offset:0
  buffer_load_dwordx4 v[156:159], v2, s[4:7], s21 offen offset:1024
  buffer_load_dwordx4 v[160:163], v2, s[4:7], s21 offen offset:2048
  buffer_load_dwordx4 v[164:167], v2, s[4:7], s21 offen offset:3072
  buffer_load_dwordx4 v[168:171], v3, s[4:7], s21 offen offset:0
  buffer_load_dwordx4 v[172:175], v3, s[4:7], s21 offen offset:1024
  buffer_load_dwordx4 v[176:179], v3, s[4:7], s21 offen offset:2048
  buffer_load_dwordx4 v[180:183], v3, s[4:7], s21 offen offset:3072
  buffer_load_dwordx4 v[184:187], v4, s[4:7], s23 offen offset:0
  buffer_load_dwordx4 v[188:191], v4, s[4:7], s23 offen offset:512
  buffer_load_dwordx4 v[192:195], v4, s[4:7], s23 offen offset:1024
  buffer_load_dwordx4 v[196:199], v4, s[4:7], s23 offen offset:1536
  buffer_load_dwordx4 v[200:203], v4, s[4:7], s23 offen offset:2048
  buffer_load_dwordx4 v[204:207], v4, s[4:7], s23 offen offset:2560
  buffer_load_dwordx4 v[88:91], v1, s[4:7], s20 offen offset:0
  buffer_load_dwordx4 v[92:95], v1, s[4:7], s20 offen offset:1024
  buffer_load_dwordx4 v[96:99], v1, s[4:7], s20 offen offset:2048
  buffer_load_dwordx4 v[100:103], v1, s[4:7], s20 offen offset:3072
  buffer_load_dwordx4 v[104:107], v2, s[4:7], s20 offen offset:0
  buffer_load_dwordx4 v[108:111], v2, s[4:7], s20 offen offset:1024
  buffer_load_dwordx4 v[112:115], v2, s[4:7], s20 offen offset:2048
  buffer_load_dwordx4 v[116:119], v2, s[4:7], s20 offen offset:3072
  buffer_load_dwordx4 v[120:123], v3, s[4:7], s20 offen offset:0
  buffer_load_dwordx4 v[124:127], v3, s[4:7], s20 offen offset:1024
  buffer_load_dwordx4 v[128:131], v3, s[4:7], s20 offen offset:2048
  buffer_load_dwordx4 v[132:135], v3, s[4:7], s20 offen offset:3072
  buffer_load_dwordx4 a[0:3], v1, s[4:7], s41 offen offset:0
  buffer_load_dwordx4 a[4:7], v1, s[4:7], s41 offen offset:1024
  buffer_load_dwordx4 a[8:11], v1, s[4:7], s41 offen offset:2048
  buffer_load_dwordx4 a[12:15], v1, s[4:7], s41 offen offset:3072
  buffer_load_dwordx4 a[16:19], v2, s[4:7], s41 offen offset:0
  buffer_load_dwordx4 a[20:23], v2, s[4:7], s41 offen offset:1024
  buffer_load_dwordx4 a[24:27], v2, s[4:7], s41 offen offset:2048
  buffer_load_dwordx4 a[28:31], v2, s[4:7], s41 offen offset:3072
  buffer_load_dwordx4 a[32:35], v3, s[4:7], s41 offen offset:0
  buffer_load_dwordx4 a[36:39], v3, s[4:7], s41 offen offset:1024
  buffer_load_dwordx4 a[40:43], v3, s[4:7], s41 offen offset:2048
  buffer_load_dwordx4 a[44:47], v3, s[4:7], s41 offen offset:3072
  buffer_load_dwordx4 a[48:51], v4, s[4:7], s43 offen offset:0
  buffer_load_dwordx4 a[52:55], v4, s[4:7], s43 offen offset:512
  buffer_load_dwordx4 a[56:59], v4, s[4:7], s43 offen offset:1024
  buffer_load_dwordx4 a[60:63], v4, s[4:7], s43 offen offset:1536
  buffer_load_dwordx4 a[64:67], v4, s[4:7], s43 offen offset:2048
  buffer_load_dwordx4 a[68:71], v4, s[4:7], s43 offen offset:2560
  buffer_load_dwordx4 a[72:75], v1, s[4:7], s40 offen offset:0
  buffer_load_dwordx4 a[76:79], v1, s[4:7], s40 offen offset:1024
  buffer_load_dwordx4 a[80:83], v1, s[4:7], s40 offen offset:2048
  buffer_load_dwordx4 a[84:87], v1, s[4:7], s40 offen offset:3072
  buffer_load_dwordx4 a[88:91], v2, s[4:7], s40 offen offset:0
  buffer_load_dwordx4 a[92:95], v2, s[4:7], s40 offen offset:1024
  buffer_load_dwordx4 a[96:99], v2, s[4:7], s40 offen offset:2048
  buffer_load_dwordx4 a[100:103], v2, s[4:7], s40 offen offset:3072
  buffer_load_dwordx4 a[104:107], v3, s[4:7], s40 offen offset:0
  buffer_load_dwordx4 a[108:111], v3, s[4:7], s40 offen offset:1024
  buffer_load_dwordx4 a[112:115], v3, s[4:7], s40 offen offset:2048
  buffer_load_dwordx4 a[116:119], v3, s[4:7], s40 offen offset:3072
  s_waitcnt vmcnt(35)
  v_mfma_f32_16x16x32_bf16 v[24:27], v[184:187], v[88:91], v[12:15]
  v_mfma_f32_16x16x32_bf16 v[28:31], v[136:139], v[88:91], v[16:19]
  v_mfma_f32_16x16x32_bf16 v[32:35], v[184:187], v[112:115], v[12:15]
  v_mfma_f32_16x16x32_bf16 v[36:39], v[136:139], v[112:115], 0
  v_mfma_f32_16x16x32_bf16 v[40:43], v[160:163], v[112:115], v[16:19]
  s_waitcnt vmcnt(34)
  v_mfma_f32_16x16x32_bf16 v[24:27], v[188:191], v[92:95], v[24:27]
  v_mfma_f32_16x16x32_bf16 v[28:31], v[140:143], v[92:95], v[28:31]
  v_mfma_f32_16x16x32_bf16 v[32:35], v[188:191], v[116:119], v[32:35]
  v_mfma_f32_16x16x32_bf16 v[36:39], v[140:143], v[116:119], v[36:39]
  v_mfma_f32_16x16x32_bf16 v[40:43], v[164:167], v[116:119], v[40:43]
  s_waitcnt vmcnt(33)
  v_mfma_f32_16x16x32_bf16 v[24:27], v[192:195], v[96:99], v[24:27]
  v_mfma_f32_16x16x32_bf16 v[28:31], v[144:147], v[96:99], v[28:31]
  v_mfma_f32_16x16x32_bf16 v[32:35], v[192:195], v[120:123], v[32:35]
  v_mfma_f32_16x16x32_bf16 v[36:39], v[144:147], v[120:123], v[36:39]
  v_mfma_f32_16x16x32_bf16 v[40:43], v[168:171], v[120:123], v[40:43]
  s_waitcnt vmcnt(32)
  v_mfma_f32_16x16x32_bf16 v[24:27], v[196:199], v[100:103], v[24:27]
  v_mfma_f32_16x16x32_bf16 v[28:31], v[148:151], v[100:103], v[28:31]
  v_mfma_f32_16x16x32_bf16 v[32:35], v[196:199], v[124:127], v[32:35]
  v_mfma_f32_16x16x32_bf16 v[36:39], v[148:151], v[124:127], v[36:39]
  v_mfma_f32_16x16x32_bf16 v[40:43], v[172:175], v[124:127], v[40:43]
  s_waitcnt vmcnt(31)
  v_mfma_f32_16x16x32_bf16 v[24:27], v[200:203], v[104:107], v[24:27]
  v_mfma_f32_16x16x32_bf16 v[28:31], v[152:155], v[104:107], v[28:31]
  v_mfma_f32_16x16x32_bf16 v[32:35], v[200:203], v[128:131], v[32:35]
  v_mfma_f32_16x16x32_bf16 v[36:39], v[152:155], v[128:131], v[36:39]
  v_mfma_f32_16x16x32_bf16 v[40:43], v[176:179], v[128:131], v[40:43]
  s_waitcnt vmcnt(30)
  v_mfma_f32_16x16x32_bf16 v[24:27], v[204:207], v[108:111], v[24:27]
  v_mfma_f32_16x16x32_bf16 v[28:31], v[156:159], v[108:111], v[28:31]
  v_mfma_f32_16x16x32_bf16 v[32:35], v[204:207], v[132:135], v[32:35]
  v_mfma_f32_16x16x32_bf16 v[36:39], v[156:159], v[132:135], v[36:39]
  v_mfma_f32_16x16x32_bf16 v[40:43], v[180:183], v[132:135], v[40:43]
  buffer_load_dwordx4 v[88:91], v1, s[4:7], s22 offen offset:0
  buffer_load_dwordx4 v[92:95], v1, s[4:7], s22 offen offset:1024
  buffer_load_dwordx4 v[96:99], v1, s[4:7], s22 offen offset:2048
  buffer_load_dwordx4 v[100:103], v1, s[4:7], s22 offen offset:3072
  buffer_load_dwordx4 v[104:107], v2, s[4:7], s22 offen offset:0
  buffer_load_dwordx4 v[108:111], v2, s[4:7], s22 offen offset:1024
  buffer_load_dwordx4 v[112:115], v2, s[4:7], s22 offen offset:2048
  buffer_load_dwordx4 v[116:119], v2, s[4:7], s22 offen offset:3072
  buffer_load_dwordx4 v[120:123], v3, s[4:7], s22 offen offset:0
  buffer_load_dwordx4 v[124:127], v3, s[4:7], s22 offen offset:1024
  buffer_load_dwordx4 v[128:131], v3, s[4:7], s22 offen offset:2048
  buffer_load_dwordx4 v[132:135], v3, s[4:7], s22 offen offset:3072
  buffer_load_dwordx2 v[136:137], v5, s[4:7], s24 offen offset:0
  buffer_load_dwordx2 v[138:139], v5, s[4:7], s24 offen offset:256
  buffer_load_dwordx2 v[140:141], v5, s[4:7], s24 offen offset:512
  buffer_load_dwordx2 v[142:143], v5, s[4:7], s24 offen offset:768
  buffer_load_dwordx2 v[144:145], v5, s[4:7], s24 offen offset:1024
  buffer_load_dwordx2 v[146:147], v5, s[4:7], s24 offen offset:1280
  buffer_load_dwordx2 v[148:149], v5, s[4:7], s24 offen offset:1536
  buffer_load_dwordx2 v[150:151], v5, s[4:7], s24 offen offset:1792
  buffer_load_dwordx2 v[152:153], v5, s[4:7], s24 offen offset:2048
  buffer_load_dwordx2 v[154:155], v5, s[4:7], s24 offen offset:2304
  buffer_load_dwordx2 v[156:157], v5, s[4:7], s24 offen offset:2560
  buffer_load_dwordx2 v[158:159], v5, s[4:7], s24 offen offset:2816
  v_max3_f32 v6, v24, v25, v26
  v_max3_f32 v6, v6, v27, v28
  v_max3_f32 v6, v6, v29, v30
  v_max_f32 v6, v6, v31
  v_mov_b32 v7, v6
  s_nop 1
  v_permlane32_swap_b32 v6, v7
  v_max_f32 v6, v6, v7
  v_mov_b32 v7, v6
  s_nop 1
  v_permlane16_swap_b32 v6, v7
  v_max_f32 v6, v6, v7
  v_mul_f32 v6, s27, v6
  v_fma_f32 v24, v24, s27, -v6
  v_fma_f32 v25, v25, s27, -v6
  v_fma_f32 v26, v26, s27, -v6
  v_fma_f32 v27, v27, s27, -v6
  v_fma_f32 v28, v28, s27, -v6
  v_fma_f32 v29, v29, s27, -v6
  v_fma_f32 v30, v30, s27, -v6
  v_fma_f32 v31, v31, s27, -v6
  v_exp_f32 v24, v24
  v_exp_f32 v25, v25
  v_exp_f32 v26, v26
  v_exp_f32 v27, v27
  v_exp_f32 v28, v28
  v_exp_f32 v29, v29
  v_exp_f32 v30, v30
  v_exp_f32 v31, v31
  v_max3_f32 v8, v32, v33, v34
  v_max3_f32 v8, v8, v35, v36
  v_max3_f32 v8, v8, v37, v38
  v_max3_f32 v8, v8, v39, v40
  v_max3_f32 v8, v8, v41, v42
  v_max_f32 v8, v8, v43
  v_mov_b32 v10, v8
  s_nop 1
  v_permlane32_swap_b32 v8, v10
  v_max_f32 v8, v8, v10
  v_mov_b32 v10, v8
  s_nop 1
  v_permlane16_swap_b32 v8, v10
  v_max_f32 v8, v8, v10
  v_mul_f32 v8, s27, v8
  v_fma_f32 v32, v32, s27, -v8
  v_fma_f32 v33, v33, s27, -v8
  v_fma_f32 v34, v34, s27, -v8
  v_fma_f32 v35, v35, s27, -v8
  v_fma_f32 v36, v36, s27, -v8
  v_fma_f32 v37, v37, s27, -v8
  v_fma_f32 v38, v38, s27, -v8
  v_fma_f32 v39, v39, s27, -v8
  v_fma_f32 v40, v40, s27, -v8
  v_fma_f32 v41, v41, s27, -v8
  v_fma_f32 v42, v42, s27, -v8
  v_fma_f32 v43, v43, s27, -v8
  v_exp_f32 v32, v32
  v_exp_f32 v33, v33
  v_exp_f32 v34, v34
  v_exp_f32 v35, v35
  v_exp_f32 v36, v36
  v_exp_f32 v37, v37
  v_exp_f32 v38, v38
  v_exp_f32 v39, v39
  v_exp_f32 v40, v40
  v_exp_f32 v41, v41
  v_exp_f32 v42, v42
  v_exp_f32 v43, v43
  v_cvt_pk_bf16_f32 v44, v24, v25
  v_cvt_pk_bf16_f32 v45, v26, v27
  v_cvt_pk_bf16_f32 v46, v28, v29
  v_cvt_pk_bf16_f32 v47, v30, v31
  v_cvt_pk_bf16_f32 v48, v32, v33
  v_cvt_pk_bf16_f32 v49, v34, v35
  v_cvt_pk_bf16_f32 v50, v36, v37
  v_cvt_pk_bf16_f32 v51, v38, v39
  v_cvt_pk_bf16_f32 v52, v40, v41
  v_cvt_pk_bf16_f32 v53, v42, v43
  v_mfma_f32_16x16x16_bf16 v[56:59], v[20:21], v[44:45], 0
  v_mfma_f32_16x16x16_bf16 v[60:63], v[20:21], v[48:49], 0
  v_mfma_f32_16x16x16_bf16 v[56:59], v[20:21], v[46:47], v[56:59]
  v_mfma_f32_16x16x32_bf16 v[60:63], v[20:23], v[50:53], v[60:63]
  s_nop 6
  v_rcp_f32 v10, v56
  v_rcp_f32 v11, v60
  s_waitcnt vmcnt(0)
  v_mfma_f32_16x16x16_bf16 v[64:67], v[136:137], v[44:45], 0
  v_mfma_f32_16x16x16_bf16 v[68:71], v[136:137], v[48:49], 0
  v_mfma_f32_16x16x16_bf16 v[64:67], v[88:89], v[46:47], v[64:67]
  v_mfma_f32_16x16x32_bf16 v[68:71], v[88:91], v[50:53], v[68:71]
  v_mfma_f32_16x16x16_bf16 v[72:75], v[138:139], v[44:45], 0
  v_mfma_f32_16x16x16_bf16 v[76:79], v[138:139], v[48:49], 0
  v_mfma_f32_16x16x16_bf16 v[72:75], v[92:93], v[46:47], v[72:75]
  v_mfma_f32_16x16x32_bf16 v[76:79], v[92:95], v[50:53], v[76:79]
  s_nop 2
  v_mul_f32 v64, v64, v10
  v_mul_f32 v65, v65, v10
  v_mul_f32 v66, v66, v10
  v_mul_f32 v67, v67, v10
  v_cvt_pk_bf16_f32 v80, v64, v65
  v_cvt_pk_bf16_f32 v81, v66, v67
  v_mul_f32 v72, v72, v10
  v_mul_f32 v73, v73, v10
  v_mul_f32 v74, v74, v10
  v_mul_f32 v75, v75, v10
  v_cvt_pk_bf16_f32 v82, v72, v73
  v_cvt_pk_bf16_f32 v83, v74, v75
  ds_write_b128 v240, v[80:83] offset:0
  v_mul_f32 v68, v68, v11
  v_mul_f32 v69, v69, v11
  v_mul_f32 v70, v70, v11
  v_mul_f32 v71, v71, v11
  v_cvt_pk_bf16_f32 v84, v68, v69
  v_cvt_pk_bf16_f32 v85, v70, v71
  v_mul_f32 v76, v76, v11
  v_mul_f32 v77, v77, v11
  v_mul_f32 v78, v78, v11
  v_mul_f32 v79, v79, v11
  v_cvt_pk_bf16_f32 v86, v76, v77
  v_cvt_pk_bf16_f32 v87, v78, v79
  ds_write_b128 v240, v[84:87] offset:24576
  v_mfma_f32_16x16x16_bf16 v[64:67], v[140:141], v[44:45], 0
  v_mfma_f32_16x16x16_bf16 v[68:71], v[140:141], v[48:49], 0
  v_mfma_f32_16x16x16_bf16 v[64:67], v[96:97], v[46:47], v[64:67]
  v_mfma_f32_16x16x32_bf16 v[68:71], v[96:99], v[50:53], v[68:71]
  v_mfma_f32_16x16x16_bf16 v[72:75], v[142:143], v[44:45], 0
  v_mfma_f32_16x16x16_bf16 v[76:79], v[142:143], v[48:49], 0
  v_mfma_f32_16x16x16_bf16 v[72:75], v[100:101], v[46:47], v[72:75]
  v_mfma_f32_16x16x32_bf16 v[76:79], v[100:103], v[50:53], v[76:79]
  s_nop 2
  v_mul_f32 v64, v64, v10
  v_mul_f32 v65, v65, v10
  v_mul_f32 v66, v66, v10
  v_mul_f32 v67, v67, v10
  v_cvt_pk_bf16_f32 v80, v64, v65
  v_cvt_pk_bf16_f32 v81, v66, v67
  v_mul_f32 v72, v72, v10
  v_mul_f32 v73, v73, v10
  v_mul_f32 v74, v74, v10
  v_mul_f32 v75, v75, v10
  v_cvt_pk_bf16_f32 v82, v72, v73
  v_cvt_pk_bf16_f32 v83, v74, v75
  ds_write_b128 v240, v[80:83] offset:1024
  v_mul_f32 v68, v68, v11
  v_mul_f32 v69, v69, v11
  v_mul_f32 v70, v70, v11
  v_mul_f32 v71, v71, v11
  v_cvt_pk_bf16_f32 v84, v68, v69
  v_cvt_pk_bf16_f32 v85, v70, v71
  v_mul_f32 v76, v76, v11
  v_mul_f32 v77, v77, v11
  v_mul_f32 v78, v78, v11
  v_mul_f32 v79, v79, v11
  v_cvt_pk_bf16_f32 v86, v76, v77
  v_cvt_pk_bf16_f32 v87, v78, v79
  ds_write_b128 v240, v[84:87] offset:25600
  v_mfma_f32_16x16x16_bf16 v[64:67], v[144:145], v[44:45], 0
  v_mfma_f32_16x16x16_bf16 v[68:71], v[144:145], v[48:49], 0
  v_mfma_f32_16x16x16_bf16 v[64:67], v[104:105], v[46:47], v[64:67]
  v_mfma_f32_16x16x32_bf16 v[68:71], v[104:107], v[50:53], v[68:71]
  v_mfma_f32_16x16x16_bf16 v[72:75], v[146:147], v[44:45], 0
  v_mfma_f32_16x16x16_bf16 v[76:79], v[146:147], v[48:49], 0
  v_mfma_f32_16x16x16_bf16 v[72:75], v[108:109], v[46:47], v[72:75]
  v_mfma_f32_16x16x32_bf16 v[76:79], v[108:111], v[50:53], v[76:79]
  s_nop 2
  v_mul_f32 v64, v64, v10
  v_mul_f32 v65, v65, v10
  v_mul_f32 v66, v66, v10
  v_mul_f32 v67, v67, v10
  v_cvt_pk_bf16_f32 v80, v64, v65
  v_cvt_pk_bf16_f32 v81, v66, v67
  v_mul_f32 v72, v72, v10
  v_mul_f32 v73, v73, v10
  v_mul_f32 v74, v74, v10
  v_mul_f32 v75, v75, v10
  v_cvt_pk_bf16_f32 v82, v72, v73
  v_cvt_pk_bf16_f32 v83, v74, v75
  ds_write_b128 v240, v[80:83] offset:2048
  v_mul_f32 v68, v68, v11
  v_mul_f32 v69, v69, v11
  v_mul_f32 v70, v70, v11
  v_mul_f32 v71, v71, v11
  v_cvt_pk_bf16_f32 v84, v68, v69
  v_cvt_pk_bf16_f32 v85, v70, v71
  v_mul_f32 v76, v76, v11
  v_mul_f32 v77, v77, v11
  v_mul_f32 v78, v78, v11
  v_mul_f32 v79, v79, v11
  v_cvt_pk_bf16_f32 v86, v76, v77
  v_cvt_pk_bf16_f32 v87, v78, v79
  ds_write_b128 v240, v[84:87] offset:26624
  v_mfma_f32_16x16x16_bf16 v[64:67], v[148:149], v[44:45], 0
  v_mfma_f32_16x16x16_bf16 v[68:71], v[148:149], v[48:49], 0
  v_mfma_f32_16x16x16_bf16 v[64:67], v[112:113], v[46:47], v[64:67]
  v_mfma_f32_16x16x32_bf16 v[68:71], v[112:115], v[50:53], v[68:71]
  v_mfma_f32_16x16x16_bf16 v[72:75], v[150:151], v[44:45], 0
  v_mfma_f32_16x16x16_bf16 v[76:79], v[150:151], v[48:49], 0
  v_mfma_f32_16x16x16_bf16 v[72:75], v[116:117], v[46:47], v[72:75]
  v_mfma_f32_16x16x32_bf16 v[76:79], v[116:119], v[50:53], v[76:79]
  s_nop 2
  v_mul_f32 v64, v64, v10
  v_mul_f32 v65, v65, v10
  v_mul_f32 v66, v66, v10
  v_mul_f32 v67, v67, v10
  v_cvt_pk_bf16_f32 v80, v64, v65
  v_cvt_pk_bf16_f32 v81, v66, v67
  v_mul_f32 v72, v72, v10
  v_mul_f32 v73, v73, v10
  v_mul_f32 v74, v74, v10
  v_mul_f32 v75, v75, v10
  v_cvt_pk_bf16_f32 v82, v72, v73
  v_cvt_pk_bf16_f32 v83, v74, v75
  ds_write_b128 v240, v[80:83] offset:3072
  v_mul_f32 v68, v68, v11
  v_mul_f32 v69, v69, v11
  v_mul_f32 v70, v70, v11
  v_mul_f32 v71, v71, v11
  v_cvt_pk_bf16_f32 v84, v68, v69
  v_cvt_pk_bf16_f32 v85, v70, v71
  v_mul_f32 v76, v76, v11
  v_mul_f32 v77, v77, v11
  v_mul_f32 v78, v78, v11
  v_mul_f32 v79, v79, v11
  v_cvt_pk_bf16_f32 v86, v76, v77
  v_cvt_pk_bf16_f32 v87, v78, v79
  ds_write_b128 v240, v[84:87] offset:27648
  v_mfma_f32_16x16x16_bf16 v[64:67], v[152:153], v[44:45], 0
  v_mfma_f32_16x16x16_bf16 v[68:71], v[152:153], v[48:49], 0
  v_mfma_f32_16x16x16_bf16 v[64:67], v[120:121], v[46:47], v[64:67]
  v_mfma_f32_16x16x32_bf16 v[68:71], v[120:123], v[50:53], v[68:71]
  v_mfma_f32_16x16x16_bf16 v[72:75], v[154:155], v[44:45], 0
  v_mfma_f32_16x16x16_bf16 v[76:79], v[154:155], v[48:49], 0
  v_mfma_f32_16x16x16_bf16 v[72:75], v[124:125], v[46:47], v[72:75]
  v_mfma_f32_16x16x32_bf16 v[76:79], v[124:127], v[50:53], v[76:79]
  s_nop 2
  v_mul_f32 v64, v64, v10
  v_mul_f32 v65, v65, v10
  v_mul_f32 v66, v66, v10
  v_mul_f32 v67, v67, v10
  v_cvt_pk_bf16_f32 v80, v64, v65
  v_cvt_pk_bf16_f32 v81, v66, v67
  v_mul_f32 v72, v72, v10
  v_mul_f32 v73, v73, v10
  v_mul_f32 v74, v74, v10
  v_mul_f32 v75, v75, v10
  v_cvt_pk_bf16_f32 v82, v72, v73
  v_cvt_pk_bf16_f32 v83, v74, v75
  ds_write_b128 v240, v[80:83] offset:4096
  v_mul_f32 v68, v68, v11
  v_mul_f32 v69, v69, v11
  v_mul_f32 v70, v70, v11
  v_mul_f32 v71, v71, v11
  v_cvt_pk_bf16_f32 v84, v68, v69
  v_cvt_pk_bf16_f32 v85, v70, v71
  v_mul_f32 v76, v76, v11
  v_mul_f32 v77, v77, v11
  v_mul_f32 v78, v78, v11
  v_mul_f32 v79, v79, v11
  v_cvt_pk_bf16_f32 v86, v76, v77
  v_cvt_pk_bf16_f32 v87, v78, v79
  ds_write_b128 v240, v[84:87] offset:28672
  v_mfma_f32_16x16x16_bf16 v[64:67], v[156:157], v[44:45], 0
  v_mfma_f32_16x16x16_bf16 v[68:71], v[156:157], v[48:49], 0
  v_mfma_f32_16x16x16_bf16 v[64:67], v[128:129], v[46:47], v[64:67]
  v_mfma_f32_16x16x32_bf16 v[68:71], v[128:131], v[50:53], v[68:71]
  v_mfma_f32_16x16x16_bf16 v[72:75], v[158:159], v[44:45], 0
  v_mfma_f32_16x16x16_bf16 v[76:79], v[158:159], v[48:49], 0
  v_mfma_f32_16x16x16_bf16 v[72:75], v[132:133], v[46:47], v[72:75]
  v_mfma_f32_16x16x32_bf16 v[76:79], v[132:135], v[50:53], v[76:79]
  s_nop 2
  v_mul_f32 v64, v64, v10
  v_mul_f32 v65, v65, v10
  v_mul_f32 v66, v66, v10
  v_mul_f32 v67, v67, v10
  v_cvt_pk_bf16_f32 v80, v64, v65
  v_cvt_pk_bf16_f32 v81, v66, v67
  v_mul_f32 v72, v72, v10
  v_mul_f32 v73, v73, v10
  v_mul_f32 v74, v74, v10
  v_mul_f32 v75, v75, v10
  v_cvt_pk_bf16_f32 v82, v72, v73
  v_cvt_pk_bf16_f32 v83, v74, v75
  ds_write_b128 v240, v[80:83] offset:5120
  v_mul_f32 v68, v68, v11
  v_mul_f32 v69, v69, v11
  v_mul_f32 v70, v70, v11
  v_mul_f32 v71, v71, v11
  v_cvt_pk_bf16_f32 v84, v68, v69
  v_cvt_pk_bf16_f32 v85, v70, v71
  v_mul_f32 v76, v76, v11
  v_mul_f32 v77, v77, v11
  v_mul_f32 v78, v78, v11
  v_mul_f32 v79, v79, v11
  v_cvt_pk_bf16_f32 v86, v76, v77
  v_cvt_pk_bf16_f32 v87, v78, v79
  ds_write_b128 v240, v[84:87] offset:29696
  v_mfma_f32_16x16x32_bf16 v[24:27], a[48:51], a[72:75], v[12:15]
  v_mfma_f32_16x16x32_bf16 v[28:31], a[0:3], a[72:75], v[16:19]
  v_mfma_f32_16x16x32_bf16 v[32:35], a[48:51], a[96:99], v[12:15]
  v_mfma_f32_16x16x32_bf16 v[36:39], a[0:3], a[96:99], 0
  v_mfma_f32_16x16x32_bf16 v[40:43], a[24:27], a[96:99], v[16:19]
  v_mfma_f32_16x16x32_bf16 v[24:27], a[52:55], a[76:79], v[24:27]
  v_mfma_f32_16x16x32_bf16 v[28:31], a[4:7], a[76:79], v[28:31]
  v_mfma_f32_16x16x32_bf16 v[32:35], a[52:55], a[100:103], v[32:35]
  v_mfma_f32_16x16x32_bf16 v[36:39], a[4:7], a[100:103], v[36:39]
  v_mfma_f32_16x16x32_bf16 v[40:43], a[28:31], a[100:103], v[40:43]
  v_mfma_f32_16x16x32_bf16 v[24:27], a[56:59], a[80:83], v[24:27]
  v_mfma_f32_16x16x32_bf16 v[28:31], a[8:11], a[80:83], v[28:31]
  v_mfma_f32_16x16x32_bf16 v[32:35], a[56:59], a[104:107], v[32:35]
  v_mfma_f32_16x16x32_bf16 v[36:39], a[8:11], a[104:107], v[36:39]
  v_mfma_f32_16x16x32_bf16 v[40:43], a[32:35], a[104:107], v[40:43]
  v_mfma_f32_16x16x32_bf16 v[24:27], a[60:63], a[84:87], v[24:27]
  v_mfma_f32_16x16x32_bf16 v[28:31], a[12:15], a[84:87], v[28:31]
  v_mfma_f32_16x16x32_bf16 v[32:35], a[60:63], a[108:111], v[32:35]
  v_mfma_f32_16x16x32_bf16 v[36:39], a[12:15], a[108:111], v[36:39]
  v_mfma_f32_16x16x32_bf16 v[40:43], a[36:39], a[108:111], v[40:43]
  v_mfma_f32_16x16x32_bf16 v[24:27], a[64:67], a[88:91], v[24:27]
  v_mfma_f32_16x16x32_bf16 v[28:31], a[16:19], a[88:91], v[28:31]
  v_mfma_f32_16x16x32_bf16 v[32:35], a[64:67], a[112:115], v[32:35]
  v_mfma_f32_16x16x32_bf16 v[36:39], a[16:19], a[112:115], v[36:39]
  v_mfma_f32_16x16x32_bf16 v[40:43], a[40:43], a[112:115], v[40:43]
  v_mfma_f32_16x16x32_bf16 v[24:27], a[68:71], a[92:95], v[24:27]
  v_mfma_f32_16x16x32_bf16 v[28:31], a[20:23], a[92:95], v[28:31]
  v_mfma_f32_16x16x32_bf16 v[32:35], a[68:71], a[116:119], v[32:35]
  v_mfma_f32_16x16x32_bf16 v[36:39], a[20:23], a[116:119], v[36:39]
  v_mfma_f32_16x16x32_bf16 v[40:43], a[44:47], a[116:119], v[40:43]
  buffer_load_dwordx4 v[88:91], v1, s[4:7], s42 offen offset:0
  buffer_load_dwordx4 v[92:95], v1, s[4:7], s42 offen offset:1024
  buffer_load_dwordx4 v[96:99], v1, s[4:7], s42 offen offset:2048
  buffer_load_dwordx4 v[100:103], v1, s[4:7], s42 offen offset:3072
  buffer_load_dwordx4 v[104:107], v2, s[4:7], s42 offen offset:0
  buffer_load_dwordx4 v[108:111], v2, s[4:7], s42 offen offset:1024
  buffer_load_dwordx4 v[112:115], v2, s[4:7], s42 offen offset:2048
  buffer_load_dwordx4 v[116:119], v2, s[4:7], s42 offen offset:3072
  buffer_load_dwordx4 v[120:123], v3, s[4:7], s42 offen offset:0
  buffer_load_dwordx4 v[124:127], v3, s[4:7], s42 offen offset:1024
  buffer_load_dwordx4 v[128:131], v3, s[4:7], s42 offen offset:2048
  buffer_load_dwordx4 v[132:135], v3, s[4:7], s42 offen offset:3072
  buffer_load_dwordx2 v[136:137], v5, s[4:7], s44 offen offset:0
  buffer_load_dwordx2 v[138:139], v5, s[4:7], s44 offen offset:256
  buffer_load_dwordx2 v[140:141], v5, s[4:7], s44 offen offset:512
  buffer_load_dwordx2 v[142:143], v5, s[4:7], s44 offen offset:768
  buffer_load_dwordx2 v[144:145], v5, s[4:7], s44 offen offset:1024
  buffer_load_dwordx2 v[146:147], v5, s[4:7], s44 offen offset:1280
  buffer_load_dwordx2 v[148:149], v5, s[4:7], s44 offen offset:1536
  buffer_load_dwordx2 v[150:151], v5, s[4:7], s44 offen offset:1792
  buffer_load_dwordx2 v[152:153], v5, s[4:7], s44 offen offset:2048
  buffer_load_dwordx2 v[154:155], v5, s[4:7], s44 offen offset:2304
  buffer_load_dwordx2 v[156:157], v5, s[4:7], s44 offen offset:2560
  buffer_load_dwordx2 v[158:159], v5, s[4:7], s44 offen offset:2816
  v_max3_f32 v6, v24, v25, v26
  v_max3_f32 v6, v6, v27, v28
  v_max3_f32 v6, v6, v29, v30
  v_max_f32 v6, v6, v31
  v_mov_b32 v7, v6
  s_nop 1
  v_permlane32_swap_b32 v6, v7
  v_max_f32 v6, v6, v7
  v_mov_b32 v7, v6
  s_nop 1
  v_permlane16_swap_b32 v6, v7
  v_max_f32 v6, v6, v7
  v_mul_f32 v6, s27, v6
  v_fma_f32 v24, v24, s27, -v6
  v_fma_f32 v25, v25, s27, -v6
  v_fma_f32 v26, v26, s27, -v6
  v_fma_f32 v27, v27, s27, -v6
  v_fma_f32 v28, v28, s27, -v6
  v_fma_f32 v29, v29, s27, -v6
  v_fma_f32 v30, v30, s27, -v6
  v_fma_f32 v31, v31, s27, -v6
  v_exp_f32 v24, v24
  v_exp_f32 v25, v25
  v_exp_f32 v26, v26
  v_exp_f32 v27, v27
  v_exp_f32 v28, v28
  v_exp_f32 v29, v29
  v_exp_f32 v30, v30
  v_exp_f32 v31, v31
  v_max3_f32 v8, v32, v33, v34
  v_max3_f32 v8, v8, v35, v36
  v_max3_f32 v8, v8, v37, v38
  v_max3_f32 v8, v8, v39, v40
  v_max3_f32 v8, v8, v41, v42
  v_max_f32 v8, v8, v43
  v_mov_b32 v10, v8
  s_nop 1
  v_permlane32_swap_b32 v8, v10
  v_max_f32 v8, v8, v10
  v_mov_b32 v10, v8
  s_nop 1
  v_permlane16_swap_b32 v8, v10
  v_max_f32 v8, v8, v10
  v_mul_f32 v8, s27, v8
  v_fma_f32 v32, v32, s27, -v8
  v_fma_f32 v33, v33, s27, -v8
  v_fma_f32 v34, v34, s27, -v8
  v_fma_f32 v35, v35, s27, -v8
  v_fma_f32 v36, v36, s27, -v8
  v_fma_f32 v37, v37, s27, -v8
  v_fma_f32 v38, v38, s27, -v8
  v_fma_f32 v39, v39, s27, -v8
  v_fma_f32 v40, v40, s27, -v8
  v_fma_f32 v41, v41, s27, -v8
  v_fma_f32 v42, v42, s27, -v8
  v_fma_f32 v43, v43, s27, -v8
  v_exp_f32 v32, v32
  v_exp_f32 v33, v33
  v_exp_f32 v34, v34
  v_exp_f32 v35, v35
  v_exp_f32 v36, v36
  v_exp_f32 v37, v37
  v_exp_f32 v38, v38
  v_exp_f32 v39, v39
  v_exp_f32 v40, v40
  v_exp_f32 v41, v41
  v_exp_f32 v42, v42
  v_exp_f32 v43, v43
  v_cvt_pk_bf16_f32 v44, v24, v25
  v_cvt_pk_bf16_f32 v45, v26, v27
  v_cvt_pk_bf16_f32 v46, v28, v29
  v_cvt_pk_bf16_f32 v47, v30, v31
  v_cvt_pk_bf16_f32 v48, v32, v33
  v_cvt_pk_bf16_f32 v49, v34, v35
  v_cvt_pk_bf16_f32 v50, v36, v37
  v_cvt_pk_bf16_f32 v51, v38, v39
  v_cvt_pk_bf16_f32 v52, v40, v41
  v_cvt_pk_bf16_f32 v53, v42, v43
  v_mfma_f32_16x16x16_bf16 v[56:59], v[20:21], v[44:45], 0
  v_mfma_f32_16x16x16_bf16 v[60:63], v[20:21], v[48:49], 0
  v_mfma_f32_16x16x16_bf16 v[56:59], v[20:21], v[46:47], v[56:59]
  v_mfma_f32_16x16x32_bf16 v[60:63], v[20:23], v[50:53], v[60:63]
  s_nop 6
  v_rcp_f32 v10, v56
  v_rcp_f32 v11, v60
  s_waitcnt vmcnt(0)
  buffer_load_dwordx4 a[160:163], v1, s[4:7], s30 offen offset:0
  buffer_load_dwordx4 a[164:167], v1, s[4:7], s31 offen offset:0
  buffer_load_dwordx4 a[168:171], v1, s[4:7], s32 offen offset:0
  buffer_load_dwordx4 a[172:175], v1, s[4:7], s33 offen offset:0
  buffer_load_dwordx4 a[176:179], v1, s[4:7], s34 offen offset:0
  buffer_load_dwordx4 a[180:183], v1, s[4:7], s35 offen offset:0
  buffer_load_dwordx4 a[184:187], v1, s[4:7], s36 offen offset:0
  buffer_load_dwordx4 a[188:191], v1, s[4:7], s37 offen offset:0
  buffer_load_dwordx4 a[192:195], v1, s[4:7], s38 offen offset:0
  buffer_load_dwordx4 a[196:199], v1, s[4:7], s39 offen offset:0
  buffer_load_dwordx4 a[200:203], v1, s[4:7], s30 offen offset:1024
  buffer_load_dwordx4 a[204:207], v1, s[4:7], s31 offen offset:1024
  buffer_load_dwordx4 a[208:211], v1, s[4:7], s32 offen offset:1024
  buffer_load_dwordx4 a[212:215], v1, s[4:7], s33 offen offset:1024
  buffer_load_dwordx4 a[216:219], v1, s[4:7], s34 offen offset:1024
  buffer_load_dwordx4 a[220:223], v1, s[4:7], s35 offen offset:1024
  buffer_load_dwordx4 a[224:227], v1, s[4:7], s36 offen offset:1024
  buffer_load_dwordx4 a[228:231], v1, s[4:7], s37 offen offset:1024
  buffer_load_dwordx4 a[232:235], v1, s[4:7], s38 offen offset:1024
  buffer_load_dwordx4 a[236:239], v1, s[4:7], s39 offen offset:1024
  v_mfma_f32_16x16x16_bf16 v[64:67], v[136:137], v[44:45], 0
  v_mfma_f32_16x16x16_bf16 v[68:71], v[136:137], v[48:49], 0
  v_mfma_f32_16x16x16_bf16 v[64:67], v[88:89], v[46:47], v[64:67]
  v_mfma_f32_16x16x32_bf16 v[68:71], v[88:91], v[50:53], v[68:71]
  v_mfma_f32_16x16x16_bf16 v[72:75], v[138:139], v[44:45], 0
  v_mfma_f32_16x16x16_bf16 v[76:79], v[138:139], v[48:49], 0
  v_mfma_f32_16x16x16_bf16 v[72:75], v[92:93], v[46:47], v[72:75]
  v_mfma_f32_16x16x32_bf16 v[76:79], v[92:95], v[50:53], v[76:79]
  s_nop 2
  v_mul_f32 v64, v64, v10
  v_mul_f32 v65, v65, v10
  v_mul_f32 v66, v66, v10
  v_mul_f32 v67, v67, v10
  v_cvt_pk_bf16_f32 v80, v64, v65
  v_cvt_pk_bf16_f32 v81, v66, v67
  v_mul_f32 v72, v72, v10
  v_mul_f32 v73, v73, v10
  v_mul_f32 v74, v74, v10
  v_mul_f32 v75, v75, v10
  v_cvt_pk_bf16_f32 v82, v72, v73
  v_cvt_pk_bf16_f32 v83, v74, v75
  ds_write_b128 v241, v[80:83] offset:0
  v_mul_f32 v68, v68, v11
  v_mul_f32 v69, v69, v11
  v_mul_f32 v70, v70, v11
  v_mul_f32 v71, v71, v11
  v_cvt_pk_bf16_f32 v84, v68, v69
  v_cvt_pk_bf16_f32 v85, v70, v71
  v_mul_f32 v76, v76, v11
  v_mul_f32 v77, v77, v11
  v_mul_f32 v78, v78, v11
  v_mul_f32 v79, v79, v11
  v_cvt_pk_bf16_f32 v86, v76, v77
  v_cvt_pk_bf16_f32 v87, v78, v79
  ds_write_b128 v241, v[84:87] offset:24576
  v_mfma_f32_16x16x16_bf16 v[64:67], v[140:141], v[44:45], 0
  v_mfma_f32_16x16x16_bf16 v[68:71], v[140:141], v[48:49], 0
  v_mfma_f32_16x16x16_bf16 v[64:67], v[96:97], v[46:47], v[64:67]
  v_mfma_f32_16x16x32_bf16 v[68:71], v[96:99], v[50:53], v[68:71]
  v_mfma_f32_16x16x16_bf16 v[72:75], v[142:143], v[44:45], 0
  v_mfma_f32_16x16x16_bf16 v[76:79], v[142:143], v[48:49], 0
  v_mfma_f32_16x16x16_bf16 v[72:75], v[100:101], v[46:47], v[72:75]
  v_mfma_f32_16x16x32_bf16 v[76:79], v[100:103], v[50:53], v[76:79]
  s_nop 2
  v_mul_f32 v64, v64, v10
  v_mul_f32 v65, v65, v10
  v_mul_f32 v66, v66, v10
  v_mul_f32 v67, v67, v10
  v_cvt_pk_bf16_f32 v80, v64, v65
  v_cvt_pk_bf16_f32 v81, v66, v67
  v_mul_f32 v72, v72, v10
  v_mul_f32 v73, v73, v10
  v_mul_f32 v74, v74, v10
  v_mul_f32 v75, v75, v10
  v_cvt_pk_bf16_f32 v82, v72, v73
  v_cvt_pk_bf16_f32 v83, v74, v75
  ds_write_b128 v241, v[80:83] offset:1024
  v_mul_f32 v68, v68, v11
  v_mul_f32 v69, v69, v11
  v_mul_f32 v70, v70, v11
  v_mul_f32 v71, v71, v11
  v_cvt_pk_bf16_f32 v84, v68, v69
  v_cvt_pk_bf16_f32 v85, v70, v71
  v_mul_f32 v76, v76, v11
  v_mul_f32 v77, v77, v11
  v_mul_f32 v78, v78, v11
  v_mul_f32 v79, v79, v11
  v_cvt_pk_bf16_f32 v86, v76, v77
  v_cvt_pk_bf16_f32 v87, v78, v79
  ds_write_b128 v241, v[84:87] offset:25600
  v_mfma_f32_16x16x16_bf16 v[64:67], v[144:145], v[44:45], 0
  v_mfma_f32_16x16x16_bf16 v[68:71], v[144:145], v[48:49], 0
  v_mfma_f32_16x16x16_bf16 v[64:67], v[104:105], v[46:47], v[64:67]
  v_mfma_f32_16x16x32_bf16 v[68:71], v[104:107], v[50:53], v[68:71]
  v_mfma_f32_16x16x16_bf16 v[72:75], v[146:147], v[44:45], 0
  v_mfma_f32_16x16x16_bf16 v[76:79], v[146:147], v[48:49], 0
  v_mfma_f32_16x16x16_bf16 v[72:75], v[108:109], v[46:47], v[72:75]
  v_mfma_f32_16x16x32_bf16 v[76:79], v[108:111], v[50:53], v[76:79]
  s_nop 2
  v_mul_f32 v64, v64, v10
  v_mul_f32 v65, v65, v10
  v_mul_f32 v66, v66, v10
  v_mul_f32 v67, v67, v10
  v_cvt_pk_bf16_f32 v80, v64, v65
  v_cvt_pk_bf16_f32 v81, v66, v67
  v_mul_f32 v72, v72, v10
  v_mul_f32 v73, v73, v10
  v_mul_f32 v74, v74, v10
  v_mul_f32 v75, v75, v10
  v_cvt_pk_bf16_f32 v82, v72, v73
  v_cvt_pk_bf16_f32 v83, v74, v75
  ds_write_b128 v241, v[80:83] offset:2048
  v_mul_f32 v68, v68, v11
  v_mul_f32 v69, v69, v11
  v_mul_f32 v70, v70, v11
  v_mul_f32 v71, v71, v11
  v_cvt_pk_bf16_f32 v84, v68, v69
  v_cvt_pk_bf16_f32 v85, v70, v71
  v_mul_f32 v76, v76, v11
  v_mul_f32 v77, v77, v11
  v_mul_f32 v78, v78, v11
  v_mul_f32 v79, v79, v11
  v_cvt_pk_bf16_f32 v86, v76, v77
  v_cvt_pk_bf16_f32 v87, v78, v79
  ds_write_b128 v241, v[84:87] offset:26624
  v_mfma_f32_16x16x16_bf16 v[64:67], v[148:149], v[44:45], 0
  v_mfma_f32_16x16x16_bf16 v[68:71], v[148:149], v[48:49], 0
  v_mfma_f32_16x16x16_bf16 v[64:67], v[112:113], v[46:47], v[64:67]
  v_mfma_f32_16x16x32_bf16 v[68:71], v[112:115], v[50:53], v[68:71]
  v_mfma_f32_16x16x16_bf16 v[72:75], v[150:151], v[44:45], 0
  v_mfma_f32_16x16x16_bf16 v[76:79], v[150:151], v[48:49], 0
  v_mfma_f32_16x16x16_bf16 v[72:75], v[116:117], v[46:47], v[72:75]
  v_mfma_f32_16x16x32_bf16 v[76:79], v[116:119], v[50:53], v[76:79]
  s_nop 2
  v_mul_f32 v64, v64, v10
  v_mul_f32 v65, v65, v10
  v_mul_f32 v66, v66, v10
  v_mul_f32 v67, v67, v10
  v_cvt_pk_bf16_f32 v80, v64, v65
  v_cvt_pk_bf16_f32 v81, v66, v67
  v_mul_f32 v72, v72, v10
  v_mul_f32 v73, v73, v10
  v_mul_f32 v74, v74, v10
  v_mul_f32 v75, v75, v10
  v_cvt_pk_bf16_f32 v82, v72, v73
  v_cvt_pk_bf16_f32 v83, v74, v75
  ds_write_b128 v241, v[80:83] offset:3072
  v_mul_f32 v68, v68, v11
  v_mul_f32 v69, v69, v11
  v_mul_f32 v70, v70, v11
  v_mul_f32 v71, v71, v11
  v_cvt_pk_bf16_f32 v84, v68, v69
  v_cvt_pk_bf16_f32 v85, v70, v71
  v_mul_f32 v76, v76, v11
  v_mul_f32 v77, v77, v11
  v_mul_f32 v78, v78, v11
  v_mul_f32 v79, v79, v11
  v_cvt_pk_bf16_f32 v86, v76, v77
  v_cvt_pk_bf16_f32 v87, v78, v79
  ds_write_b128 v241, v[84:87] offset:27648
  v_mfma_f32_16x16x16_bf16 v[64:67], v[152:153], v[44:45], 0
  v_mfma_f32_16x16x16_bf16 v[68:71], v[152:153], v[48:49], 0
  v_mfma_f32_16x16x16_bf16 v[64:67], v[120:121], v[46:47], v[64:67]
  v_mfma_f32_16x16x32_bf16 v[68:71], v[120:123], v[50:53], v[68:71]
  v_mfma_f32_16x16x16_bf16 v[72:75], v[154:155], v[44:45], 0
  v_mfma_f32_16x16x16_bf16 v[76:79], v[154:155], v[48:49], 0
  v_mfma_f32_16x16x16_bf16 v[72:75], v[124:125], v[46:47], v[72:75]
  v_mfma_f32_16x16x32_bf16 v[76:79], v[124:127], v[50:53], v[76:79]
  s_nop 2
  v_mul_f32 v64, v64, v10
  v_mul_f32 v65, v65, v10
  v_mul_f32 v66, v66, v10
  v_mul_f32 v67, v67, v10
  v_cvt_pk_bf16_f32 v80, v64, v65
  v_cvt_pk_bf16_f32 v81, v66, v67
  v_mul_f32 v72, v72, v10
  v_mul_f32 v73, v73, v10
  v_mul_f32 v74, v74, v10
  v_mul_f32 v75, v75, v10
  v_cvt_pk_bf16_f32 v82, v72, v73
  v_cvt_pk_bf16_f32 v83, v74, v75
  ds_write_b128 v241, v[80:83] offset:4096
  v_mul_f32 v68, v68, v11
  v_mul_f32 v69, v69, v11
  v_mul_f32 v70, v70, v11
  v_mul_f32 v71, v71, v11
  v_cvt_pk_bf16_f32 v84, v68, v69
  v_cvt_pk_bf16_f32 v85, v70, v71
  v_mul_f32 v76, v76, v11
  v_mul_f32 v77, v77, v11
  v_mul_f32 v78, v78, v11
  v_mul_f32 v79, v79, v11
  v_cvt_pk_bf16_f32 v86, v76, v77
  v_cvt_pk_bf16_f32 v87, v78, v79
  ds_write_b128 v241, v[84:87] offset:28672
  v_mfma_f32_16x16x16_bf16 v[64:67], v[156:157], v[44:45], 0
  v_mfma_f32_16x16x16_bf16 v[68:71], v[156:157], v[48:49], 0
  v_mfma_f32_16x16x16_bf16 v[64:67], v[128:129], v[46:47], v[64:67]
  v_mfma_f32_16x16x32_bf16 v[68:71], v[128:131], v[50:53], v[68:71]
  v_mfma_f32_16x16x16_bf16 v[72:75], v[158:159], v[44:45], 0
  v_mfma_f32_16x16x16_bf16 v[76:79], v[158:159], v[48:49], 0
  v_mfma_f32_16x16x16_bf16 v[72:75], v[132:133], v[46:47], v[72:75]
  v_mfma_f32_16x16x32_bf16 v[76:79], v[132:135], v[50:53], v[76:79]
  s_nop 2
  v_mul_f32 v64, v64, v10
  v_mul_f32 v65, v65, v10
  v_mul_f32 v66, v66, v10
  v_mul_f32 v67, v67, v10
  v_cvt_pk_bf16_f32 v80, v64, v65
  v_cvt_pk_bf16_f32 v81, v66, v67
  v_mul_f32 v72, v72, v10
  v_mul_f32 v73, v73, v10
  v_mul_f32 v74, v74, v10
  v_mul_f32 v75, v75, v10
  v_cvt_pk_bf16_f32 v82, v72, v73
  v_cvt_pk_bf16_f32 v83, v74, v75
  ds_write_b128 v241, v[80:83] offset:5120
  v_mul_f32 v68, v68, v11
  v_mul_f32 v69, v69, v11
  v_mul_f32 v70, v70, v11
  v_mul_f32 v71, v71, v11
  v_cvt_pk_bf16_f32 v84, v68, v69
  v_cvt_pk_bf16_f32 v85, v70, v71
  v_mul_f32 v76, v76, v11
  v_mul_f32 v77, v77, v11
  v_mul_f32 v78, v78, v11
  v_mul_f32 v79, v79, v11
  v_cvt_pk_bf16_f32 v86, v76, v77
  v_cvt_pk_bf16_f32 v87, v78, v79
  ds_write_b128 v241, v[84:87] offset:29696
  s_branch fin_phase22
fin_odma3:
  s_lshl_b32 s16, s14, 2
  s_add_u32 s16, s16, s12
  s_mul_i32 s16, s16, 192
  s_mul_i32 s17, s13, 24
  s_add_u32 s16, s16, s17
  s_lshl_b32 s16, s16, 10
  s_add_u32 s16, s16, 57147392
  s_mul_i32 s17, s12, 24576
  s_add_u32 m0, s17, 0
  s_nop 0
  buffer_load_dwordx4 v1, s[4:7], s16 offen offset:0 lds
  buffer_load_dwordx4 v1, s[4:7], s16 offen offset:1024 lds
  buffer_load_dwordx4 v1, s[4:7], s16 offen offset:2048 lds
  buffer_load_dwordx4 v1, s[4:7], s16 offen offset:3072 lds
  s_add_u32 s16, s16, 4096
  s_add_u32 m0, s17, 4096
  s_nop 0
  buffer_load_dwordx4 v1, s[4:7], s16 offen offset:0 lds
  buffer_load_dwordx4 v1, s[4:7], s16 offen offset:1024 lds
  buffer_load_dwordx4 v1, s[4:7], s16 offen offset:2048 lds
  buffer_load_dwordx4 v1, s[4:7], s16 offen offset:3072 lds
  s_add_u32 s16, s16, 4096
  s_add_u32 m0, s17, 8192
  s_nop 0
  buffer_load_dwordx4 v1, s[4:7], s16 offen offset:0 lds
  buffer_load_dwordx4 v1, s[4:7], s16 offen offset:1024 lds
  buffer_load_dwordx4 v1, s[4:7], s16 offen offset:2048 lds
  buffer_load_dwordx4 v1, s[4:7], s16 offen offset:3072 lds
  s_add_u32 s16, s16, 4096
  s_add_u32 m0, s17, 12288
  s_nop 0
  buffer_load_dwordx4 v1, s[4:7], s16 offen offset:0 lds
  buffer_load_dwordx4 v1, s[4:7], s16 offen offset:1024 lds
  buffer_load_dwordx4 v1, s[4:7], s16 offen offset:2048 lds
  buffer_load_dwordx4 v1, s[4:7], s16 offen offset:3072 lds
  s_add_u32 s16, s16, 4096
  s_add_u32 m0, s17, 16384
  s_nop 0
  buffer_load_dwordx4 v1, s[4:7], s16 offen offset:0 lds
  buffer_load_dwordx4 v1, s[4:7], s16 offen offset:1024 lds
  buffer_load_dwordx4 v1, s[4:7], s16 offen offset:2048 lds
  buffer_load_dwordx4 v1, s[4:7], s16 offen offset:3072 lds
  s_add_u32 s16, s16, 4096
  s_add_u32 m0, s17, 20480
  s_nop 0
  buffer_load_dwordx4 v1, s[4:7], s16 offen offset:0 lds
  buffer_load_dwordx4 v1, s[4:7], s16 offen offset:1024 lds
  buffer_load_dwordx4 v1, s[4:7], s16 offen offset:2048 lds
  buffer_load_dwordx4 v1, s[4:7], s16 offen offset:3072 lds
  s_add_u32 s16, s16, 4096
  buffer_load_dwordx4 a[160:163], v1, s[4:7], s30 offen offset:0
  buffer_load_dwordx4 a[164:167], v1, s[4:7], s31 offen offset:0
  buffer_load_dwordx4 a[168:171], v1, s[4:7], s32 offen offset:0
  buffer_load_dwordx4 a[172:175], v1, s[4:7], s33 offen offset:0
  buffer_load_dwordx4 a[176:179], v1, s[4:7], s34 offen offset:0
  buffer_load_dwordx4 a[180:183], v1, s[4:7], s35 offen offset:0
  buffer_load_dwordx4 a[184:187], v1, s[4:7], s36 offen offset:0
  buffer_load_dwordx4 a[188:191], v1, s[4:7], s37 offen offset:0
  buffer_load_dwordx4 a[192:195], v1, s[4:7], s38 offen offset:0
  buffer_load_dwordx4 a[196:199], v1, s[4:7], s39 offen offset:0
  buffer_load_dwordx4 a[200:203], v1, s[4:7], s30 offen offset:1024
  buffer_load_dwordx4 a[204:207], v1, s[4:7], s31 offen offset:1024
  buffer_load_dwordx4 a[208:211], v1, s[4:7], s32 offen offset:1024
  buffer_load_dwordx4 a[212:215], v1, s[4:7], s33 offen offset:1024
  buffer_load_dwordx4 a[216:219], v1, s[4:7], s34 offen offset:1024
  buffer_load_dwordx4 a[220:223], v1, s[4:7], s35 offen offset:1024
  buffer_load_dwordx4 a[224:227], v1, s[4:7], s36 offen offset:1024
  buffer_load_dwordx4 a[228:231], v1, s[4:7], s37 offen offset:1024
  buffer_load_dwordx4 a[232:235], v1, s[4:7], s38 offen offset:1024
  buffer_load_dwordx4 a[236:239], v1, s[4:7], s39 offen offset:1024
  s_waitcnt vmcnt(20)
fin_phase22:
  s_waitcnt lgkmcnt(0)
  buffer_load_dwordx4 v[104:107], v1, s[4:7], s30 offen offset:2048
  buffer_load_dwordx4 v[108:111], v1, s[4:7], s31 offen offset:2048
  buffer_load_dwordx4 v[112:115], v1, s[4:7], s32 offen offset:2048
  buffer_load_dwordx4 v[116:119], v1, s[4:7], s33 offen offset:2048
  buffer_load_dwordx4 v[120:123], v1, s[4:7], s34 offen offset:2048
  buffer_load_dwordx4 v[124:127], v1, s[4:7], s35 offen offset:2048
  buffer_load_dwordx4 v[128:131], v1, s[4:7], s36 offen offset:2048
  buffer_load_dwordx4 v[132:135], v1, s[4:7], s37 offen offset:2048
  buffer_load_dwordx4 v[136:139], v1, s[4:7], s38 offen offset:2048
  buffer_load_dwordx4 v[140:143], v1, s[4:7], s39 offen offset:2048
  buffer_load_dwordx4 v[144:147], v1, s[4:7], s30 offen offset:3072
  buffer_load_dwordx4 v[148:151], v1, s[4:7], s31 offen offset:3072
  buffer_load_dwordx4 v[152:155], v1, s[4:7], s32 offen offset:3072
  buffer_load_dwordx4 v[156:159], v1, s[4:7], s33 offen offset:3072
  buffer_load_dwordx4 v[160:163], v1, s[4:7], s34 offen offset:3072
  buffer_load_dwordx4 v[164:167], v1, s[4:7], s35 offen offset:3072
  buffer_load_dwordx4 v[168:171], v1, s[4:7], s36 offen offset:3072
  buffer_load_dwordx4 v[172:175], v1, s[4:7], s37 offen offset:3072
  buffer_load_dwordx4 v[176:179], v1, s[4:7], s38 offen offset:3072
  buffer_load_dwordx4 v[180:183], v1, s[4:7], s39 offen offset:3072
  s_add_u32 s30, s30, 4096
  s_add_u32 s31, s31, 4096
  s_add_u32 s32, s32, 4096
  s_add_u32 s33, s33, 4096
  s_add_u32 s34, s34, 4096
  s_add_u32 s35, s35, 4096
  s_add_u32 s36, s36, 4096
  s_add_u32 s37, s37, 4096
  s_add_u32 s38, s38, 4096
  s_add_u32 s39, s39, 4096
  v_add_u32 v6, 49152, v1
  s_barrier
  ds_read_b128 v[184:187], v1 offset:0
  ds_read_b128 v[188:191], v1 offset:24576
  ds_read_b128 v[192:195], v6 offset:0
  ds_read_b128 v[196:199], v6 offset:24576
  s_waitcnt vmcnt(30)
  ds_read_b128 v[200:203], v1 offset:1024
  ds_read_b128 v[204:207], v1 offset:25600
  ds_read_b128 v[208:211], v6 offset:1024
  ds_read_b128 v[212:215], v6 offset:25600
  s_waitcnt lgkmcnt(4)
  v_mfma_f32_16x16x32_bf16 a[0:3], a[160:163], v[184:187], 0
  v_mfma_f32_16x16x32_bf16 a[4:7], a[160:163], v[188:191], 0
  v_mfma_f32_16x16x32_bf16 a[8:11], a[160:163], v[192:195], 0
  v_mfma_f32_16x16x32_bf16 a[12:15], a[160:163], v[196:199], 0
  v_mfma_f32_16x16x32_bf16 a[16:19], a[164:167], v[184:187], 0
  v_mfma_f32_16x16x32_bf16 a[20:23], a[164:167], v[188:191], 0
  v_mfma_f32_16x16x32_bf16 a[24:27], a[164:167], v[192:195], 0
  v_mfma_f32_16x16x32_bf16 a[28:31], a[164:167], v[196:199], 0
  v_mfma_f32_16x16x32_bf16 a[32:35], a[168:171], v[184:187], 0
  v_mfma_f32_16x16x32_bf16 a[36:39], a[168:171], v[188:191], 0
  v_mfma_f32_16x16x32_bf16 a[40:43], a[168:171], v[192:195], 0
  v_mfma_f32_16x16x32_bf16 a[44:47], a[168:171], v[196:199], 0
  v_mfma_f32_16x16x32_bf16 a[48:51], a[172:175], v[184:187], 0
  v_mfma_f32_16x16x32_bf16 a[52:55], a[172:175], v[188:191], 0
  v_mfma_f32_16x16x32_bf16 a[56:59], a[172:175], v[192:195], 0
  v_mfma_f32_16x16x32_bf16 a[60:63], a[172:175], v[196:199], 0
  v_mfma_f32_16x16x32_bf16 a[64:67], a[176:179], v[184:187], 0
  v_mfma_f32_16x16x32_bf16 a[68:71], a[176:179], v[188:191], 0
  v_mfma_f32_16x16x32_bf16 a[72:75], a[176:179], v[192:195], 0
  v_mfma_f32_16x16x32_bf16 a[76:79], a[176:179], v[196:199], 0
  v_mfma_f32_16x16x32_bf16 a[80:83], a[180:183], v[184:187], 0
  v_mfma_f32_16x16x32_bf16 a[84:87], a[180:183], v[188:191], 0
  v_mfma_f32_16x16x32_bf16 a[88:91], a[180:183], v[192:195], 0
  v_mfma_f32_16x16x32_bf16 a[92:95], a[180:183], v[196:199], 0
  v_mfma_f32_16x16x32_bf16 a[96:99], a[184:187], v[184:187], 0
  v_mfma_f32_16x16x32_bf16 a[100:103], a[184:187], v[188:191], 0
  v_mfma_f32_16x16x32_bf16 a[104:107], a[184:187], v[192:195], 0
  v_mfma_f32_16x16x32_bf16 a[108:111], a[184:187], v[196:199], 0
  v_mfma_f32_16x16x32_bf16 a[112:115], a[188:191], v[184:187], 0
  v_mfma_f32_16x16x32_bf16 a[116:119], a[188:191], v[188:191], 0
  v_mfma_f32_16x16x32_bf16 a[120:123], a[188:191], v[192:195], 0
  v_mfma_f32_16x16x32_bf16 a[124:127], a[188:191], v[196:199], 0
  v_mfma_f32_16x16x32_bf16 a[128:131], a[192:195], v[184:187], 0
  v_mfma_f32_16x16x32_bf16 a[132:135], a[192:195], v[188:191], 0
  v_mfma_f32_16x16x32_bf16 a[136:139], a[192:195], v[192:195], 0
  v_mfma_f32_16x16x32_bf16 a[140:143], a[192:195], v[196:199], 0
  v_mfma_f32_16x16x32_bf16 a[144:147], a[196:199], v[184:187], 0
  v_mfma_f32_16x16x32_bf16 a[148:151], a[196:199], v[188:191], 0
  v_mfma_f32_16x16x32_bf16 a[152:155], a[196:199], v[192:195], 0
  v_mfma_f32_16x16x32_bf16 a[156:159], a[196:199], v[196:199], 0
  buffer_load_dwordx4 v[24:27], v1, s[4:7], s30 offen offset:0
  buffer_load_dwordx4 v[28:31], v1, s[4:7], s31 offen offset:0
  buffer_load_dwordx4 v[32:35], v1, s[4:7], s32 offen offset:0
  buffer_load_dwordx4 v[36:39], v1, s[4:7], s33 offen offset:0
  buffer_load_dwordx4 v[40:43], v1, s[4:7], s34 offen offset:0
  buffer_load_dwordx4 v[44:47], v1, s[4:7], s35 offen offset:0
  buffer_load_dwordx4 v[48:51], v1, s[4:7], s36 offen offset:0
  buffer_load_dwordx4 v[52:55], v1, s[4:7], s37 offen offset:0
  buffer_load_dwordx4 v[56:59], v1, s[4:7], s38 offen offset:0
  buffer_load_dwordx4 v[60:63], v1, s[4:7], s39 offen offset:0
  s_waitcnt vmcnt(30)
  ds_read_b128 v[184:187], v1 offset:2048
  ds_read_b128 v[188:191], v1 offset:26624
  ds_read_b128 v[192:195], v6 offset:2048
  ds_read_b128 v[196:199], v6 offset:26624
  s_waitcnt lgkmcnt(4)
  v_mfma_f32_16x16x32_bf16 a[0:3], a[200:203], v[200:203], a[0:3]
  v_mfma_f32_16x16x32_bf16 a[4:7], a[200:203], v[204:207], a[4:7]
  v_mfma_f32_16x16x32_bf16 a[8:11], a[200:203], v[208:211], a[8:11]
  v_mfma_f32_16x16x32_bf16 a[12:15], a[200:203], v[212:215], a[12:15]
  v_mfma_f32_16x16x32_bf16 a[16:19], a[204:207], v[200:203], a[16:19]
  v_mfma_f32_16x16x32_bf16 a[20:23], a[204:207], v[204:207], a[20:23]
  v_mfma_f32_16x16x32_bf16 a[24:27], a[204:207], v[208:211], a[24:27]
  v_mfma_f32_16x16x32_bf16 a[28:31], a[204:207], v[212:215], a[28:31]
  v_mfma_f32_16x16x32_bf16 a[32:35], a[208:211], v[200:203], a[32:35]
  v_mfma_f32_16x16x32_bf16 a[36:39], a[208:211], v[204:207], a[36:39]
  v_mfma_f32_16x16x32_bf16 a[40:43], a[208:211], v[208:211], a[40:43]
  v_mfma_f32_16x16x32_bf16 a[44:47], a[208:211], v[212:215], a[44:47]
  v_mfma_f32_16x16x32_bf16 a[48:51], a[212:215], v[200:203], a[48:51]
  v_mfma_f32_16x16x32_bf16 a[52:55], a[212:215], v[204:207], a[52:55]
  v_mfma_f32_16x16x32_bf16 a[56:59], a[212:215], v[208:211], a[56:59]
  v_mfma_f32_16x16x32_bf16 a[60:63], a[212:215], v[212:215], a[60:63]
  v_mfma_f32_16x16x32_bf16 a[64:67], a[216:219], v[200:203], a[64:67]
  v_mfma_f32_16x16x32_bf16 a[68:71], a[216:219], v[204:207], a[68:71]
  v_mfma_f32_16x16x32_bf16 a[72:75], a[216:219], v[208:211], a[72:75]
  v_mfma_f32_16x16x32_bf16 a[76:79], a[216:219], v[212:215], a[76:79]
  v_mfma_f32_16x16x32_bf16 a[80:83], a[220:223], v[200:203], a[80:83]
  v_mfma_f32_16x16x32_bf16 a[84:87], a[220:223], v[204:207], a[84:87]
  v_mfma_f32_16x16x32_bf16 a[88:91], a[220:223], v[208:211], a[88:91]
  v_mfma_f32_16x16x32_bf16 a[92:95], a[220:223], v[212:215], a[92:95]
  v_mfma_f32_16x16x32_bf16 a[96:99], a[224:227], v[200:203], a[96:99]
  v_mfma_f32_16x16x32_bf16 a[100:103], a[224:227], v[204:207], a[100:103]
  v_mfma_f32_16x16x32_bf16 a[104:107], a[224:227], v[208:211], a[104:107]
  v_mfma_f32_16x16x32_bf16 a[108:111], a[224:227], v[212:215], a[108:111]
  v_mfma_f32_16x16x32_bf16 a[112:115], a[228:231], v[200:203], a[112:115]
  v_mfma_f32_16x16x32_bf16 a[116:119], a[228:231], v[204:207], a[116:119]
  v_mfma_f32_16x16x32_bf16 a[120:123], a[228:231], v[208:211], a[120:123]
  v_mfma_f32_16x16x32_bf16 a[124:127], a[228:231], v[212:215], a[124:127]
  v_mfma_f32_16x16x32_bf16 a[128:131], a[232:235], v[200:203], a[128:131]
  v_mfma_f32_16x16x32_bf16 a[132:135], a[232:235], v[204:207], a[132:135]
  v_mfma_f32_16x16x32_bf16 a[136:139], a[232:235], v[208:211], a[136:139]
  v_mfma_f32_16x16x32_bf16 a[140:143], a[232:235], v[212:215], a[140:143]
  v_mfma_f32_16x16x32_bf16 a[144:147], a[236:239], v[200:203], a[144:147]
  v_mfma_f32_16x16x32_bf16 a[148:151], a[236:239], v[204:207], a[148:151]
  v_mfma_f32_16x16x32_bf16 a[152:155], a[236:239], v[208:211], a[152:155]
  v_mfma_f32_16x16x32_bf16 a[156:159], a[236:239], v[212:215], a[156:159]
  buffer_load_dwordx4 v[64:67], v1, s[4:7], s30 offen offset:1024
  buffer_load_dwordx4 v[68:71], v1, s[4:7], s31 offen offset:1024
  buffer_load_dwordx4 v[72:75], v1, s[4:7], s32 offen offset:1024
  buffer_load_dwordx4 v[76:79], v1, s[4:7], s33 offen offset:1024
  buffer_load_dwordx4 v[80:83], v1, s[4:7], s34 offen offset:1024
  buffer_load_dwordx4 v[84:87], v1, s[4:7], s35 offen offset:1024
  buffer_load_dwordx4 v[88:91], v1, s[4:7], s36 offen offset:1024
  buffer_load_dwordx4 v[92:95], v1, s[4:7], s37 offen offset:1024
  buffer_load_dwordx4 v[96:99], v1, s[4:7], s38 offen offset:1024
  buffer_load_dwordx4 v[100:103], v1, s[4:7], s39 offen offset:1024
  s_waitcnt vmcnt(30)
  ds_read_b128 v[200:203], v1 offset:3072
  ds_read_b128 v[204:207], v1 offset:27648
  ds_read_b128 v[208:211], v6 offset:3072
  ds_read_b128 v[212:215], v6 offset:27648
  s_waitcnt lgkmcnt(4)
  v_mfma_f32_16x16x32_bf16 a[0:3], v[104:107], v[184:187], a[0:3]
  v_mfma_f32_16x16x32_bf16 a[4:7], v[104:107], v[188:191], a[4:7]
  v_mfma_f32_16x16x32_bf16 a[8:11], v[104:107], v[192:195], a[8:11]
  v_mfma_f32_16x16x32_bf16 a[12:15], v[104:107], v[196:199], a[12:15]
  v_mfma_f32_16x16x32_bf16 a[16:19], v[108:111], v[184:187], a[16:19]
  v_mfma_f32_16x16x32_bf16 a[20:23], v[108:111], v[188:191], a[20:23]
  v_mfma_f32_16x16x32_bf16 a[24:27], v[108:111], v[192:195], a[24:27]
  v_mfma_f32_16x16x32_bf16 a[28:31], v[108:111], v[196:199], a[28:31]
  v_mfma_f32_16x16x32_bf16 a[32:35], v[112:115], v[184:187], a[32:35]
  v_mfma_f32_16x16x32_bf16 a[36:39], v[112:115], v[188:191], a[36:39]
  v_mfma_f32_16x16x32_bf16 a[40:43], v[112:115], v[192:195], a[40:43]
  v_mfma_f32_16x16x32_bf16 a[44:47], v[112:115], v[196:199], a[44:47]
  v_mfma_f32_16x16x32_bf16 a[48:51], v[116:119], v[184:187], a[48:51]
  v_mfma_f32_16x16x32_bf16 a[52:55], v[116:119], v[188:191], a[52:55]
  v_mfma_f32_16x16x32_bf16 a[56:59], v[116:119], v[192:195], a[56:59]
  v_mfma_f32_16x16x32_bf16 a[60:63], v[116:119], v[196:199], a[60:63]
  v_mfma_f32_16x16x32_bf16 a[64:67], v[120:123], v[184:187], a[64:67]
  v_mfma_f32_16x16x32_bf16 a[68:71], v[120:123], v[188:191], a[68:71]
  v_mfma_f32_16x16x32_bf16 a[72:75], v[120:123], v[192:195], a[72:75]
  v_mfma_f32_16x16x32_bf16 a[76:79], v[120:123], v[196:199], a[76:79]
  v_mfma_f32_16x16x32_bf16 a[80:83], v[124:127], v[184:187], a[80:83]
  v_mfma_f32_16x16x32_bf16 a[84:87], v[124:127], v[188:191], a[84:87]
  v_mfma_f32_16x16x32_bf16 a[88:91], v[124:127], v[192:195], a[88:91]
  v_mfma_f32_16x16x32_bf16 a[92:95], v[124:127], v[196:199], a[92:95]
  v_mfma_f32_16x16x32_bf16 a[96:99], v[128:131], v[184:187], a[96:99]
  v_mfma_f32_16x16x32_bf16 a[100:103], v[128:131], v[188:191], a[100:103]
  v_mfma_f32_16x16x32_bf16 a[104:107], v[128:131], v[192:195], a[104:107]
  v_mfma_f32_16x16x32_bf16 a[108:111], v[128:131], v[196:199], a[108:111]
  v_mfma_f32_16x16x32_bf16 a[112:115], v[132:135], v[184:187], a[112:115]
  v_mfma_f32_16x16x32_bf16 a[116:119], v[132:135], v[188:191], a[116:119]
  v_mfma_f32_16x16x32_bf16 a[120:123], v[132:135], v[192:195], a[120:123]
  v_mfma_f32_16x16x32_bf16 a[124:127], v[132:135], v[196:199], a[124:127]
  v_mfma_f32_16x16x32_bf16 a[128:131], v[136:139], v[184:187], a[128:131]
  v_mfma_f32_16x16x32_bf16 a[132:135], v[136:139], v[188:191], a[132:135]
  v_mfma_f32_16x16x32_bf16 a[136:139], v[136:139], v[192:195], a[136:139]
  v_mfma_f32_16x16x32_bf16 a[140:143], v[136:139], v[196:199], a[140:143]
  v_mfma_f32_16x16x32_bf16 a[144:147], v[140:143], v[184:187], a[144:147]
  v_mfma_f32_16x16x32_bf16 a[148:151], v[140:143], v[188:191], a[148:151]
  v_mfma_f32_16x16x32_bf16 a[152:155], v[140:143], v[192:195], a[152:155]
  v_mfma_f32_16x16x32_bf16 a[156:159], v[140:143], v[196:199], a[156:159]
  buffer_load_dwordx4 v[104:107], v1, s[4:7], s30 offen offset:2048
  buffer_load_dwordx4 v[108:111], v1, s[4:7], s31 offen offset:2048
  buffer_load_dwordx4 v[112:115], v1, s[4:7], s32 offen offset:2048
  buffer_load_dwordx4 v[116:119], v1, s[4:7], s33 offen offset:2048
  buffer_load_dwordx4 v[120:123], v1, s[4:7], s34 offen offset:2048
  buffer_load_dwordx4 v[124:127], v1, s[4:7], s35 offen offset:2048
  buffer_load_dwordx4 v[128:131], v1, s[4:7], s36 offen offset:2048
  buffer_load_dwordx4 v[132:135], v1, s[4:7], s37 offen offset:2048
  buffer_load_dwordx4 v[136:139], v1, s[4:7], s38 offen offset:2048
  buffer_load_dwordx4 v[140:143], v1, s[4:7], s39 offen offset:2048
  s_waitcnt vmcnt(30)
  ds_read_b128 v[184:187], v1 offset:4096
  ds_read_b128 v[188:191], v1 offset:28672
  ds_read_b128 v[192:195], v6 offset:4096
  ds_read_b128 v[196:199], v6 offset:28672
  s_waitcnt lgkmcnt(4)
  v_mfma_f32_16x16x32_bf16 a[0:3], v[144:147], v[200:203], a[0:3]
  v_mfma_f32_16x16x32_bf16 a[4:7], v[144:147], v[204:207], a[4:7]
  v_mfma_f32_16x16x32_bf16 a[8:11], v[144:147], v[208:211], a[8:11]
  v_mfma_f32_16x16x32_bf16 a[12:15], v[144:147], v[212:215], a[12:15]
  v_mfma_f32_16x16x32_bf16 a[16:19], v[148:151], v[200:203], a[16:19]
  v_mfma_f32_16x16x32_bf16 a[20:23], v[148:151], v[204:207], a[20:23]
  v_mfma_f32_16x16x32_bf16 a[24:27], v[148:151], v[208:211], a[24:27]
  v_mfma_f32_16x16x32_bf16 a[28:31], v[148:151], v[212:215], a[28:31]
  v_mfma_f32_16x16x32_bf16 a[32:35], v[152:155], v[200:203], a[32:35]
  v_mfma_f32_16x16x32_bf16 a[36:39], v[152:155], v[204:207], a[36:39]
  v_mfma_f32_16x16x32_bf16 a[40:43], v[152:155], v[208:211], a[40:43]
  v_mfma_f32_16x16x32_bf16 a[44:47], v[152:155], v[212:215], a[44:47]
  v_mfma_f32_16x16x32_bf16 a[48:51], v[156:159], v[200:203], a[48:51]
  v_mfma_f32_16x16x32_bf16 a[52:55], v[156:159], v[204:207], a[52:55]
  v_mfma_f32_16x16x32_bf16 a[56:59], v[156:159], v[208:211], a[56:59]
  v_mfma_f32_16x16x32_bf16 a[60:63], v[156:159], v[212:215], a[60:63]
  v_mfma_f32_16x16x32_bf16 a[64:67], v[160:163], v[200:203], a[64:67]
  v_mfma_f32_16x16x32_bf16 a[68:71], v[160:163], v[204:207], a[68:71]
  v_mfma_f32_16x16x32_bf16 a[72:75], v[160:163], v[208:211], a[72:75]
  v_mfma_f32_16x16x32_bf16 a[76:79], v[160:163], v[212:215], a[76:79]
  v_mfma_f32_16x16x32_bf16 a[80:83], v[164:167], v[200:203], a[80:83]
  v_mfma_f32_16x16x32_bf16 a[84:87], v[164:167], v[204:207], a[84:87]
  v_mfma_f32_16x16x32_bf16 a[88:91], v[164:167], v[208:211], a[88:91]
  v_mfma_f32_16x16x32_bf16 a[92:95], v[164:167], v[212:215], a[92:95]
  v_mfma_f32_16x16x32_bf16 a[96:99], v[168:171], v[200:203], a[96:99]
  v_mfma_f32_16x16x32_bf16 a[100:103], v[168:171], v[204:207], a[100:103]
  v_mfma_f32_16x16x32_bf16 a[104:107], v[168:171], v[208:211], a[104:107]
  v_mfma_f32_16x16x32_bf16 a[108:111], v[168:171], v[212:215], a[108:111]
  v_mfma_f32_16x16x32_bf16 a[112:115], v[172:175], v[200:203], a[112:115]
  v_mfma_f32_16x16x32_bf16 a[116:119], v[172:175], v[204:207], a[116:119]
  v_mfma_f32_16x16x32_bf16 a[120:123], v[172:175], v[208:211], a[120:123]
  v_mfma_f32_16x16x32_bf16 a[124:127], v[172:175], v[212:215], a[124:127]
  v_mfma_f32_16x16x32_bf16 a[128:131], v[176:179], v[200:203], a[128:131]
  v_mfma_f32_16x16x32_bf16 a[132:135], v[176:179], v[204:207], a[132:135]
  v_mfma_f32_16x16x32_bf16 a[136:139], v[176:179], v[208:211], a[136:139]
  v_mfma_f32_16x16x32_bf16 a[140:143], v[176:179], v[212:215], a[140:143]
  v_mfma_f32_16x16x32_bf16 a[144:147], v[180:183], v[200:203], a[144:147]
  v_mfma_f32_16x16x32_bf16 a[148:151], v[180:183], v[204:207], a[148:151]
  v_mfma_f32_16x16x32_bf16 a[152:155], v[180:183], v[208:211], a[152:155]
  v_mfma_f32_16x16x32_bf16 a[156:159], v[180:183], v[212:215], a[156:159]
  buffer_load_dwordx4 v[144:147], v1, s[4:7], s30 offen offset:3072
  buffer_load_dwordx4 v[148:151], v1, s[4:7], s31 offen offset:3072
  buffer_load_dwordx4 v[152:155], v1, s[4:7], s32 offen offset:3072
  buffer_load_dwordx4 v[156:159], v1, s[4:7], s33 offen offset:3072
  buffer_load_dwordx4 v[160:163], v1, s[4:7], s34 offen offset:3072
  buffer_load_dwordx4 v[164:167], v1, s[4:7], s35 offen offset:3072
  buffer_load_dwordx4 v[168:171], v1, s[4:7], s36 offen offset:3072
  buffer_load_dwordx4 v[172:175], v1, s[4:7], s37 offen offset:3072
  buffer_load_dwordx4 v[176:179], v1, s[4:7], s38 offen offset:3072
  buffer_load_dwordx4 v[180:183], v1, s[4:7], s39 offen offset:3072
  s_add_u32 s30, s30, 4096
  s_add_u32 s31, s31, 4096
  s_add_u32 s32, s32, 4096
  s_add_u32 s33, s33, 4096
  s_add_u32 s34, s34, 4096
  s_add_u32 s35, s35, 4096
  s_add_u32 s36, s36, 4096
  s_add_u32 s37, s37, 4096
  s_add_u32 s38, s38, 4096
  s_add_u32 s39, s39, 4096
  s_waitcnt vmcnt(30)
  ds_read_b128 v[200:203], v1 offset:5120
  ds_read_b128 v[204:207], v1 offset:29696
  ds_read_b128 v[208:211], v6 offset:5120
  ds_read_b128 v[212:215], v6 offset:29696
  s_waitcnt lgkmcnt(4)
  v_mfma_f32_16x16x32_bf16 a[0:3], v[24:27], v[184:187], a[0:3]
  v_mfma_f32_16x16x32_bf16 a[4:7], v[24:27], v[188:191], a[4:7]
  v_mfma_f32_16x16x32_bf16 a[8:11], v[24:27], v[192:195], a[8:11]
  v_mfma_f32_16x16x32_bf16 a[12:15], v[24:27], v[196:199], a[12:15]
  v_mfma_f32_16x16x32_bf16 a[16:19], v[28:31], v[184:187], a[16:19]
  v_mfma_f32_16x16x32_bf16 a[20:23], v[28:31], v[188:191], a[20:23]
  v_mfma_f32_16x16x32_bf16 a[24:27], v[28:31], v[192:195], a[24:27]
  v_mfma_f32_16x16x32_bf16 a[28:31], v[28:31], v[196:199], a[28:31]
  v_mfma_f32_16x16x32_bf16 a[32:35], v[32:35], v[184:187], a[32:35]
  v_mfma_f32_16x16x32_bf16 a[36:39], v[32:35], v[188:191], a[36:39]
  v_mfma_f32_16x16x32_bf16 a[40:43], v[32:35], v[192:195], a[40:43]
  v_mfma_f32_16x16x32_bf16 a[44:47], v[32:35], v[196:199], a[44:47]
  v_mfma_f32_16x16x32_bf16 a[48:51], v[36:39], v[184:187], a[48:51]
  v_mfma_f32_16x16x32_bf16 a[52:55], v[36:39], v[188:191], a[52:55]
  v_mfma_f32_16x16x32_bf16 a[56:59], v[36:39], v[192:195], a[56:59]
  v_mfma_f32_16x16x32_bf16 a[60:63], v[36:39], v[196:199], a[60:63]
  v_mfma_f32_16x16x32_bf16 a[64:67], v[40:43], v[184:187], a[64:67]
  v_mfma_f32_16x16x32_bf16 a[68:71], v[40:43], v[188:191], a[68:71]
  v_mfma_f32_16x16x32_bf16 a[72:75], v[40:43], v[192:195], a[72:75]
  v_mfma_f32_16x16x32_bf16 a[76:79], v[40:43], v[196:199], a[76:79]
  v_mfma_f32_16x16x32_bf16 a[80:83], v[44:47], v[184:187], a[80:83]
  v_mfma_f32_16x16x32_bf16 a[84:87], v[44:47], v[188:191], a[84:87]
  v_mfma_f32_16x16x32_bf16 a[88:91], v[44:47], v[192:195], a[88:91]
  v_mfma_f32_16x16x32_bf16 a[92:95], v[44:47], v[196:199], a[92:95]
  v_mfma_f32_16x16x32_bf16 a[96:99], v[48:51], v[184:187], a[96:99]
  v_mfma_f32_16x16x32_bf16 a[100:103], v[48:51], v[188:191], a[100:103]
  v_mfma_f32_16x16x32_bf16 a[104:107], v[48:51], v[192:195], a[104:107]
  v_mfma_f32_16x16x32_bf16 a[108:111], v[48:51], v[196:199], a[108:111]
  v_mfma_f32_16x16x32_bf16 a[112:115], v[52:55], v[184:187], a[112:115]
  v_mfma_f32_16x16x32_bf16 a[116:119], v[52:55], v[188:191], a[116:119]
  v_mfma_f32_16x16x32_bf16 a[120:123], v[52:55], v[192:195], a[120:123]
  v_mfma_f32_16x16x32_bf16 a[124:127], v[52:55], v[196:199], a[124:127]
  v_mfma_f32_16x16x32_bf16 a[128:131], v[56:59], v[184:187], a[128:131]
  v_mfma_f32_16x16x32_bf16 a[132:135], v[56:59], v[188:191], a[132:135]
  v_mfma_f32_16x16x32_bf16 a[136:139], v[56:59], v[192:195], a[136:139]
  v_mfma_f32_16x16x32_bf16 a[140:143], v[56:59], v[196:199], a[140:143]
  v_mfma_f32_16x16x32_bf16 a[144:147], v[60:63], v[184:187], a[144:147]
  v_mfma_f32_16x16x32_bf16 a[148:151], v[60:63], v[188:191], a[148:151]
  v_mfma_f32_16x16x32_bf16 a[152:155], v[60:63], v[192:195], a[152:155]
  v_mfma_f32_16x16x32_bf16 a[156:159], v[60:63], v[196:199], a[156:159]
  buffer_load_dwordx4 v[24:27], v1, s[4:7], s30 offen offset:0
  buffer_load_dwordx4 v[28:31], v1, s[4:7], s31 offen offset:0
  buffer_load_dwordx4 v[32:35], v1, s[4:7], s32 offen offset:0
  buffer_load_dwordx4 v[36:39], v1, s[4:7], s33 offen offset:0
  buffer_load_dwordx4 v[40:43], v1, s[4:7], s34 offen offset:0
  buffer_load_dwordx4 v[44:47], v1, s[4:7], s35 offen offset:0
  buffer_load_dwordx4 v[48:51], v1, s[4:7], s36 offen offset:0
  buffer_load_dwordx4 v[52:55], v1, s[4:7], s37 offen offset:0
  buffer_load_dwordx4 v[56:59], v1, s[4:7], s38 offen offset:0
  buffer_load_dwordx4 v[60:63], v1, s[4:7], s39 offen offset:0
  s_waitcnt vmcnt(30)
  ds_read_b128 v[184:187], v1 offset:6144
  ds_read_b128 v[188:191], v1 offset:30720
  ds_read_b128 v[192:195], v6 offset:6144
  ds_read_b128 v[196:199], v6 offset:30720
  s_waitcnt lgkmcnt(4)
  v_mfma_f32_16x16x32_bf16 a[0:3], v[64:67], v[200:203], a[0:3]
  v_mfma_f32_16x16x32_bf16 a[4:7], v[64:67], v[204:207], a[4:7]
  v_mfma_f32_16x16x32_bf16 a[8:11], v[64:67], v[208:211], a[8:11]
  v_mfma_f32_16x16x32_bf16 a[12:15], v[64:67], v[212:215], a[12:15]
  v_mfma_f32_16x16x32_bf16 a[16:19], v[68:71], v[200:203], a[16:19]
  v_mfma_f32_16x16x32_bf16 a[20:23], v[68:71], v[204:207], a[20:23]
  v_mfma_f32_16x16x32_bf16 a[24:27], v[68:71], v[208:211], a[24:27]
  v_mfma_f32_16x16x32_bf16 a[28:31], v[68:71], v[212:215], a[28:31]
  v_mfma_f32_16x16x32_bf16 a[32:35], v[72:75], v[200:203], a[32:35]
  v_mfma_f32_16x16x32_bf16 a[36:39], v[72:75], v[204:207], a[36:39]
  v_mfma_f32_16x16x32_bf16 a[40:43], v[72:75], v[208:211], a[40:43]
  v_mfma_f32_16x16x32_bf16 a[44:47], v[72:75], v[212:215], a[44:47]
  v_mfma_f32_16x16x32_bf16 a[48:51], v[76:79], v[200:203], a[48:51]
  v_mfma_f32_16x16x32_bf16 a[52:55], v[76:79], v[204:207], a[52:55]
  v_mfma_f32_16x16x32_bf16 a[56:59], v[76:79], v[208:211], a[56:59]
  v_mfma_f32_16x16x32_bf16 a[60:63], v[76:79], v[212:215], a[60:63]
  v_mfma_f32_16x16x32_bf16 a[64:67], v[80:83], v[200:203], a[64:67]
  v_mfma_f32_16x16x32_bf16 a[68:71], v[80:83], v[204:207], a[68:71]
  v_mfma_f32_16x16x32_bf16 a[72:75], v[80:83], v[208:211], a[72:75]
  v_mfma_f32_16x16x32_bf16 a[76:79], v[80:83], v[212:215], a[76:79]
  v_mfma_f32_16x16x32_bf16 a[80:83], v[84:87], v[200:203], a[80:83]
  v_mfma_f32_16x16x32_bf16 a[84:87], v[84:87], v[204:207], a[84:87]
  v_mfma_f32_16x16x32_bf16 a[88:91], v[84:87], v[208:211], a[88:91]
  v_mfma_f32_16x16x32_bf16 a[92:95], v[84:87], v[212:215], a[92:95]
  v_mfma_f32_16x16x32_bf16 a[96:99], v[88:91], v[200:203], a[96:99]
  v_mfma_f32_16x16x32_bf16 a[100:103], v[88:91], v[204:207], a[100:103]
  v_mfma_f32_16x16x32_bf16 a[104:107], v[88:91], v[208:211], a[104:107]
  v_mfma_f32_16x16x32_bf16 a[108:111], v[88:91], v[212:215], a[108:111]
  v_mfma_f32_16x16x32_bf16 a[112:115], v[92:95], v[200:203], a[112:115]
  v_mfma_f32_16x16x32_bf16 a[116:119], v[92:95], v[204:207], a[116:119]
  v_mfma_f32_16x16x32_bf16 a[120:123], v[92:95], v[208:211], a[120:123]
  v_mfma_f32_16x16x32_bf16 a[124:127], v[92:95], v[212:215], a[124:127]
  v_mfma_f32_16x16x32_bf16 a[128:131], v[96:99], v[200:203], a[128:131]
  v_mfma_f32_16x16x32_bf16 a[132:135], v[96:99], v[204:207], a[132:135]
  v_mfma_f32_16x16x32_bf16 a[136:139], v[96:99], v[208:211], a[136:139]
  v_mfma_f32_16x16x32_bf16 a[140:143], v[96:99], v[212:215], a[140:143]
  v_mfma_f32_16x16x32_bf16 a[144:147], v[100:103], v[200:203], a[144:147]
  v_mfma_f32_16x16x32_bf16 a[148:151], v[100:103], v[204:207], a[148:151]
  v_mfma_f32_16x16x32_bf16 a[152:155], v[100:103], v[208:211], a[152:155]
  v_mfma_f32_16x16x32_bf16 a[156:159], v[100:103], v[212:215], a[156:159]
  buffer_load_dwordx4 v[64:67], v1, s[4:7], s30 offen offset:1024
  buffer_load_dwordx4 v[68:71], v1, s[4:7], s31 offen offset:1024
  buffer_load_dwordx4 v[72:75], v1, s[4:7], s32 offen offset:1024
  buffer_load_dwordx4 v[76:79], v1, s[4:7], s33 offen offset:1024
  buffer_load_dwordx4 v[80:83], v1, s[4:7], s34 offen offset:1024
  buffer_load_dwordx4 v[84:87], v1, s[4:7], s35 offen offset:1024
  buffer_load_dwordx4 v[88:91], v1, s[4:7], s36 offen offset:1024
  buffer_load_dwordx4 v[92:95], v1, s[4:7], s37 offen offset:1024
  buffer_load_dwordx4 v[96:99], v1, s[4:7], s38 offen offset:1024
  buffer_load_dwordx4 v[100:103], v1, s[4:7], s39 offen offset:1024
  s_waitcnt vmcnt(30)
  ds_read_b128 v[200:203], v1 offset:7168
  ds_read_b128 v[204:207], v1 offset:31744
  ds_read_b128 v[208:211], v6 offset:7168
  ds_read_b128 v[212:215], v6 offset:31744
  s_waitcnt lgkmcnt(4)
  v_mfma_f32_16x16x32_bf16 a[0:3], v[104:107], v[184:187], a[0:3]
  v_mfma_f32_16x16x32_bf16 a[4:7], v[104:107], v[188:191], a[4:7]
  v_mfma_f32_16x16x32_bf16 a[8:11], v[104:107], v[192:195], a[8:11]
  v_mfma_f32_16x16x32_bf16 a[12:15], v[104:107], v[196:199], a[12:15]
  v_mfma_f32_16x16x32_bf16 a[16:19], v[108:111], v[184:187], a[16:19]
  v_mfma_f32_16x16x32_bf16 a[20:23], v[108:111], v[188:191], a[20:23]
  v_mfma_f32_16x16x32_bf16 a[24:27], v[108:111], v[192:195], a[24:27]
  v_mfma_f32_16x16x32_bf16 a[28:31], v[108:111], v[196:199], a[28:31]
  v_mfma_f32_16x16x32_bf16 a[32:35], v[112:115], v[184:187], a[32:35]
  v_mfma_f32_16x16x32_bf16 a[36:39], v[112:115], v[188:191], a[36:39]
  v_mfma_f32_16x16x32_bf16 a[40:43], v[112:115], v[192:195], a[40:43]
  v_mfma_f32_16x16x32_bf16 a[44:47], v[112:115], v[196:199], a[44:47]
  v_mfma_f32_16x16x32_bf16 a[48:51], v[116:119], v[184:187], a[48:51]
  v_mfma_f32_16x16x32_bf16 a[52:55], v[116:119], v[188:191], a[52:55]
  v_mfma_f32_16x16x32_bf16 a[56:59], v[116:119], v[192:195], a[56:59]
  v_mfma_f32_16x16x32_bf16 a[60:63], v[116:119], v[196:199], a[60:63]
  v_mfma_f32_16x16x32_bf16 a[64:67], v[120:123], v[184:187], a[64:67]
  v_mfma_f32_16x16x32_bf16 a[68:71], v[120:123], v[188:191], a[68:71]
  v_mfma_f32_16x16x32_bf16 a[72:75], v[120:123], v[192:195], a[72:75]
  v_mfma_f32_16x16x32_bf16 a[76:79], v[120:123], v[196:199], a[76:79]
  v_mfma_f32_16x16x32_bf16 a[80:83], v[124:127], v[184:187], a[80:83]
  v_mfma_f32_16x16x32_bf16 a[84:87], v[124:127], v[188:191], a[84:87]
  v_mfma_f32_16x16x32_bf16 a[88:91], v[124:127], v[192:195], a[88:91]
  v_mfma_f32_16x16x32_bf16 a[92:95], v[124:127], v[196:199], a[92:95]
  v_mfma_f32_16x16x32_bf16 a[96:99], v[128:131], v[184:187], a[96:99]
  v_mfma_f32_16x16x32_bf16 a[100:103], v[128:131], v[188:191], a[100:103]
  v_mfma_f32_16x16x32_bf16 a[104:107], v[128:131], v[192:195], a[104:107]
  v_mfma_f32_16x16x32_bf16 a[108:111], v[128:131], v[196:199], a[108:111]
  v_mfma_f32_16x16x32_bf16 a[112:115], v[132:135], v[184:187], a[112:115]
  v_mfma_f32_16x16x32_bf16 a[116:119], v[132:135], v[188:191], a[116:119]
  v_mfma_f32_16x16x32_bf16 a[120:123], v[132:135], v[192:195], a[120:123]
  v_mfma_f32_16x16x32_bf16 a[124:127], v[132:135], v[196:199], a[124:127]
  v_mfma_f32_16x16x32_bf16 a[128:131], v[136:139], v[184:187], a[128:131]
  v_mfma_f32_16x16x32_bf16 a[132:135], v[136:139], v[188:191], a[132:135]
  v_mfma_f32_16x16x32_bf16 a[136:139], v[136:139], v[192:195], a[136:139]
  v_mfma_f32_16x16x32_bf16 a[140:143], v[136:139], v[196:199], a[140:143]
  v_mfma_f32_16x16x32_bf16 a[144:147], v[140:143], v[184:187], a[144:147]
  v_mfma_f32_16x16x32_bf16 a[148:151], v[140:143], v[188:191], a[148:151]
  v_mfma_f32_16x16x32_bf16 a[152:155], v[140:143], v[192:195], a[152:155]
  v_mfma_f32_16x16x32_bf16 a[156:159], v[140:143], v[196:199], a[156:159]
  buffer_load_dwordx4 v[104:107], v1, s[4:7], s30 offen offset:2048
  buffer_load_dwordx4 v[108:111], v1, s[4:7], s31 offen offset:2048
  buffer_load_dwordx4 v[112:115], v1, s[4:7], s32 offen offset:2048
  buffer_load_dwordx4 v[116:119], v1, s[4:7], s33 offen offset:2048
  buffer_load_dwordx4 v[120:123], v1, s[4:7], s34 offen offset:2048
  buffer_load_dwordx4 v[124:127], v1, s[4:7], s35 offen offset:2048
  buffer_load_dwordx4 v[128:131], v1, s[4:7], s36 offen offset:2048
  buffer_load_dwordx4 v[132:135], v1, s[4:7], s37 offen offset:2048
  buffer_load_dwordx4 v[136:139], v1, s[4:7], s38 offen offset:2048
  buffer_load_dwordx4 v[140:143], v1, s[4:7], s39 offen offset:2048
  s_waitcnt vmcnt(30)
  ds_read_b128 v[184:187], v1 offset:8192
  ds_read_b128 v[188:191], v1 offset:32768
  ds_read_b128 v[192:195], v6 offset:8192
  ds_read_b128 v[196:199], v6 offset:32768
  s_waitcnt lgkmcnt(4)
  v_mfma_f32_16x16x32_bf16 a[0:3], v[144:147], v[200:203], a[0:3]
  v_mfma_f32_16x16x32_bf16 a[4:7], v[144:147], v[204:207], a[4:7]
  v_mfma_f32_16x16x32_bf16 a[8:11], v[144:147], v[208:211], a[8:11]
  v_mfma_f32_16x16x32_bf16 a[12:15], v[144:147], v[212:215], a[12:15]
  v_mfma_f32_16x16x32_bf16 a[16:19], v[148:151], v[200:203], a[16:19]
  v_mfma_f32_16x16x32_bf16 a[20:23], v[148:151], v[204:207], a[20:23]
  v_mfma_f32_16x16x32_bf16 a[24:27], v[148:151], v[208:211], a[24:27]
  v_mfma_f32_16x16x32_bf16 a[28:31], v[148:151], v[212:215], a[28:31]
  v_mfma_f32_16x16x32_bf16 a[32:35], v[152:155], v[200:203], a[32:35]
  v_mfma_f32_16x16x32_bf16 a[36:39], v[152:155], v[204:207], a[36:39]
  v_mfma_f32_16x16x32_bf16 a[40:43], v[152:155], v[208:211], a[40:43]
  v_mfma_f32_16x16x32_bf16 a[44:47], v[152:155], v[212:215], a[44:47]
  v_mfma_f32_16x16x32_bf16 a[48:51], v[156:159], v[200:203], a[48:51]
  v_mfma_f32_16x16x32_bf16 a[52:55], v[156:159], v[204:207], a[52:55]
  v_mfma_f32_16x16x32_bf16 a[56:59], v[156:159], v[208:211], a[56:59]
  v_mfma_f32_16x16x32_bf16 a[60:63], v[156:159], v[212:215], a[60:63]
  v_mfma_f32_16x16x32_bf16 a[64:67], v[160:163], v[200:203], a[64:67]
  v_mfma_f32_16x16x32_bf16 a[68:71], v[160:163], v[204:207], a[68:71]
  v_mfma_f32_16x16x32_bf16 a[72:75], v[160:163], v[208:211], a[72:75]
  v_mfma_f32_16x16x32_bf16 a[76:79], v[160:163], v[212:215], a[76:79]
  v_mfma_f32_16x16x32_bf16 a[80:83], v[164:167], v[200:203], a[80:83]
  v_mfma_f32_16x16x32_bf16 a[84:87], v[164:167], v[204:207], a[84:87]
  v_mfma_f32_16x16x32_bf16 a[88:91], v[164:167], v[208:211], a[88:91]
  v_mfma_f32_16x16x32_bf16 a[92:95], v[164:167], v[212:215], a[92:95]
  v_mfma_f32_16x16x32_bf16 a[96:99], v[168:171], v[200:203], a[96:99]
  v_mfma_f32_16x16x32_bf16 a[100:103], v[168:171], v[204:207], a[100:103]
  v_mfma_f32_16x16x32_bf16 a[104:107], v[168:171], v[208:211], a[104:107]
  v_mfma_f32_16x16x32_bf16 a[108:111], v[168:171], v[212:215], a[108:111]
  v_mfma_f32_16x16x32_bf16 a[112:115], v[172:175], v[200:203], a[112:115]
  v_mfma_f32_16x16x32_bf16 a[116:119], v[172:175], v[204:207], a[116:119]
  v_mfma_f32_16x16x32_bf16 a[120:123], v[172:175], v[208:211], a[120:123]
  v_mfma_f32_16x16x32_bf16 a[124:127], v[172:175], v[212:215], a[124:127]
  v_mfma_f32_16x16x32_bf16 a[128:131], v[176:179], v[200:203], a[128:131]
  v_mfma_f32_16x16x32_bf16 a[132:135], v[176:179], v[204:207], a[132:135]
  v_mfma_f32_16x16x32_bf16 a[136:139], v[176:179], v[208:211], a[136:139]
  v_mfma_f32_16x16x32_bf16 a[140:143], v[176:179], v[212:215], a[140:143]
  v_mfma_f32_16x16x32_bf16 a[144:147], v[180:183], v[200:203], a[144:147]
  v_mfma_f32_16x16x32_bf16 a[148:151], v[180:183], v[204:207], a[148:151]
  v_mfma_f32_16x16x32_bf16 a[152:155], v[180:183], v[208:211], a[152:155]
  v_mfma_f32_16x16x32_bf16 a[156:159], v[180:183], v[212:215], a[156:159]
  buffer_load_dwordx4 v[144:147], v1, s[4:7], s30 offen offset:3072
  buffer_load_dwordx4 v[148:151], v1, s[4:7], s31 offen offset:3072
  buffer_load_dwordx4 v[152:155], v1, s[4:7], s32 offen offset:3072
  buffer_load_dwordx4 v[156:159], v1, s[4:7], s33 offen offset:3072
  buffer_load_dwordx4 v[160:163], v1, s[4:7], s34 offen offset:3072
  buffer_load_dwordx4 v[164:167], v1, s[4:7], s35 offen offset:3072
  buffer_load_dwordx4 v[168:171], v1, s[4:7], s36 offen offset:3072
  buffer_load_dwordx4 v[172:175], v1, s[4:7], s37 offen offset:3072
  buffer_load_dwordx4 v[176:179], v1, s[4:7], s38 offen offset:3072
  buffer_load_dwordx4 v[180:183], v1, s[4:7], s39 offen offset:3072
  s_add_u32 s30, s30, 4096
  s_add_u32 s31, s31, 4096
  s_add_u32 s32, s32, 4096
  s_add_u32 s33, s33, 4096
  s_add_u32 s34, s34, 4096
  s_add_u32 s35, s35, 4096
  s_add_u32 s36, s36, 4096
  s_add_u32 s37, s37, 4096
  s_add_u32 s38, s38, 4096
  s_add_u32 s39, s39, 4096
  s_waitcnt vmcnt(30)
  ds_read_b128 v[200:203], v1 offset:9216
  ds_read_b128 v[204:207], v1 offset:33792
  ds_read_b128 v[208:211], v6 offset:9216
  ds_read_b128 v[212:215], v6 offset:33792
  s_waitcnt lgkmcnt(4)
  v_mfma_f32_16x16x32_bf16 a[0:3], v[24:27], v[184:187], a[0:3]
  v_mfma_f32_16x16x32_bf16 a[4:7], v[24:27], v[188:191], a[4:7]
  v_mfma_f32_16x16x32_bf16 a[8:11], v[24:27], v[192:195], a[8:11]
  v_mfma_f32_16x16x32_bf16 a[12:15], v[24:27], v[196:199], a[12:15]
  v_mfma_f32_16x16x32_bf16 a[16:19], v[28:31], v[184:187], a[16:19]
  v_mfma_f32_16x16x32_bf16 a[20:23], v[28:31], v[188:191], a[20:23]
  v_mfma_f32_16x16x32_bf16 a[24:27], v[28:31], v[192:195], a[24:27]
  v_mfma_f32_16x16x32_bf16 a[28:31], v[28:31], v[196:199], a[28:31]
  v_mfma_f32_16x16x32_bf16 a[32:35], v[32:35], v[184:187], a[32:35]
  v_mfma_f32_16x16x32_bf16 a[36:39], v[32:35], v[188:191], a[36:39]
  v_mfma_f32_16x16x32_bf16 a[40:43], v[32:35], v[192:195], a[40:43]
  v_mfma_f32_16x16x32_bf16 a[44:47], v[32:35], v[196:199], a[44:47]
  v_mfma_f32_16x16x32_bf16 a[48:51], v[36:39], v[184:187], a[48:51]
  v_mfma_f32_16x16x32_bf16 a[52:55], v[36:39], v[188:191], a[52:55]
  v_mfma_f32_16x16x32_bf16 a[56:59], v[36:39], v[192:195], a[56:59]
  v_mfma_f32_16x16x32_bf16 a[60:63], v[36:39], v[196:199], a[60:63]
  v_mfma_f32_16x16x32_bf16 a[64:67], v[40:43], v[184:187], a[64:67]
  v_mfma_f32_16x16x32_bf16 a[68:71], v[40:43], v[188:191], a[68:71]
  v_mfma_f32_16x16x32_bf16 a[72:75], v[40:43], v[192:195], a[72:75]
  v_mfma_f32_16x16x32_bf16 a[76:79], v[40:43], v[196:199], a[76:79]
  v_mfma_f32_16x16x32_bf16 a[80:83], v[44:47], v[184:187], a[80:83]
  v_mfma_f32_16x16x32_bf16 a[84:87], v[44:47], v[188:191], a[84:87]
  v_mfma_f32_16x16x32_bf16 a[88:91], v[44:47], v[192:195], a[88:91]
  v_mfma_f32_16x16x32_bf16 a[92:95], v[44:47], v[196:199], a[92:95]
  v_mfma_f32_16x16x32_bf16 a[96:99], v[48:51], v[184:187], a[96:99]
  v_mfma_f32_16x16x32_bf16 a[100:103], v[48:51], v[188:191], a[100:103]
  v_mfma_f32_16x16x32_bf16 a[104:107], v[48:51], v[192:195], a[104:107]
  v_mfma_f32_16x16x32_bf16 a[108:111], v[48:51], v[196:199], a[108:111]
  v_mfma_f32_16x16x32_bf16 a[112:115], v[52:55], v[184:187], a[112:115]
  v_mfma_f32_16x16x32_bf16 a[116:119], v[52:55], v[188:191], a[116:119]
  v_mfma_f32_16x16x32_bf16 a[120:123], v[52:55], v[192:195], a[120:123]
  v_mfma_f32_16x16x32_bf16 a[124:127], v[52:55], v[196:199], a[124:127]
  v_mfma_f32_16x16x32_bf16 a[128:131], v[56:59], v[184:187], a[128:131]
  v_mfma_f32_16x16x32_bf16 a[132:135], v[56:59], v[188:191], a[132:135]
  v_mfma_f32_16x16x32_bf16 a[136:139], v[56:59], v[192:195], a[136:139]
  v_mfma_f32_16x16x32_bf16 a[140:143], v[56:59], v[196:199], a[140:143]
  v_mfma_f32_16x16x32_bf16 a[144:147], v[60:63], v[184:187], a[144:147]
  v_mfma_f32_16x16x32_bf16 a[148:151], v[60:63], v[188:191], a[148:151]
  v_mfma_f32_16x16x32_bf16 a[152:155], v[60:63], v[192:195], a[152:155]
  v_mfma_f32_16x16x32_bf16 a[156:159], v[60:63], v[196:199], a[156:159]
  buffer_load_dwordx4 v[24:27], v1, s[4:7], s30 offen offset:0
  buffer_load_dwordx4 v[28:31], v1, s[4:7], s31 offen offset:0
  buffer_load_dwordx4 v[32:35], v1, s[4:7], s32 offen offset:0
  buffer_load_dwordx4 v[36:39], v1, s[4:7], s33 offen offset:0
  buffer_load_dwordx4 v[40:43], v1, s[4:7], s34 offen offset:0
  buffer_load_dwordx4 v[44:47], v1, s[4:7], s35 offen offset:0
  buffer_load_dwordx4 v[48:51], v1, s[4:7], s36 offen offset:0
  buffer_load_dwordx4 v[52:55], v1, s[4:7], s37 offen offset:0
  buffer_load_dwordx4 v[56:59], v1, s[4:7], s38 offen offset:0
  buffer_load_dwordx4 v[60:63], v1, s[4:7], s39 offen offset:0
  s_waitcnt vmcnt(30)
  ds_read_b128 v[184:187], v1 offset:10240
  ds_read_b128 v[188:191], v1 offset:34816
  ds_read_b128 v[192:195], v6 offset:10240
  ds_read_b128 v[196:199], v6 offset:34816
  s_waitcnt lgkmcnt(4)
  v_mfma_f32_16x16x32_bf16 a[0:3], v[64:67], v[200:203], a[0:3]
  v_mfma_f32_16x16x32_bf16 a[4:7], v[64:67], v[204:207], a[4:7]
  v_mfma_f32_16x16x32_bf16 a[8:11], v[64:67], v[208:211], a[8:11]
  v_mfma_f32_16x16x32_bf16 a[12:15], v[64:67], v[212:215], a[12:15]
  v_mfma_f32_16x16x32_bf16 a[16:19], v[68:71], v[200:203], a[16:19]
  v_mfma_f32_16x16x32_bf16 a[20:23], v[68:71], v[204:207], a[20:23]
  v_mfma_f32_16x16x32_bf16 a[24:27], v[68:71], v[208:211], a[24:27]
  v_mfma_f32_16x16x32_bf16 a[28:31], v[68:71], v[212:215], a[28:31]
  v_mfma_f32_16x16x32_bf16 a[32:35], v[72:75], v[200:203], a[32:35]
  v_mfma_f32_16x16x32_bf16 a[36:39], v[72:75], v[204:207], a[36:39]
  v_mfma_f32_16x16x32_bf16 a[40:43], v[72:75], v[208:211], a[40:43]
  v_mfma_f32_16x16x32_bf16 a[44:47], v[72:75], v[212:215], a[44:47]
  v_mfma_f32_16x16x32_bf16 a[48:51], v[76:79], v[200:203], a[48:51]
  v_mfma_f32_16x16x32_bf16 a[52:55], v[76:79], v[204:207], a[52:55]
  v_mfma_f32_16x16x32_bf16 a[56:59], v[76:79], v[208:211], a[56:59]
  v_mfma_f32_16x16x32_bf16 a[60:63], v[76:79], v[212:215], a[60:63]
  v_mfma_f32_16x16x32_bf16 a[64:67], v[80:83], v[200:203], a[64:67]
  v_mfma_f32_16x16x32_bf16 a[68:71], v[80:83], v[204:207], a[68:71]
  v_mfma_f32_16x16x32_bf16 a[72:75], v[80:83], v[208:211], a[72:75]
  v_mfma_f32_16x16x32_bf16 a[76:79], v[80:83], v[212:215], a[76:79]
  v_mfma_f32_16x16x32_bf16 a[80:83], v[84:87], v[200:203], a[80:83]
  v_mfma_f32_16x16x32_bf16 a[84:87], v[84:87], v[204:207], a[84:87]
  v_mfma_f32_16x16x32_bf16 a[88:91], v[84:87], v[208:211], a[88:91]
  v_mfma_f32_16x16x32_bf16 a[92:95], v[84:87], v[212:215], a[92:95]
  v_mfma_f32_16x16x32_bf16 a[96:99], v[88:91], v[200:203], a[96:99]
  v_mfma_f32_16x16x32_bf16 a[100:103], v[88:91], v[204:207], a[100:103]
  v_mfma_f32_16x16x32_bf16 a[104:107], v[88:91], v[208:211], a[104:107]
  v_mfma_f32_16x16x32_bf16 a[108:111], v[88:91], v[212:215], a[108:111]
  v_mfma_f32_16x16x32_bf16 a[112:115], v[92:95], v[200:203], a[112:115]
  v_mfma_f32_16x16x32_bf16 a[116:119], v[92:95], v[204:207], a[116:119]
  v_mfma_f32_16x16x32_bf16 a[120:123], v[92:95], v[208:211], a[120:123]
  v_mfma_f32_16x16x32_bf16 a[124:127], v[92:95], v[212:215], a[124:127]
  v_mfma_f32_16x16x32_bf16 a[128:131], v[96:99], v[200:203], a[128:131]
  v_mfma_f32_16x16x32_bf16 a[132:135], v[96:99], v[204:207], a[132:135]
  v_mfma_f32_16x16x32_bf16 a[136:139], v[96:99], v[208:211], a[136:139]
  v_mfma_f32_16x16x32_bf16 a[140:143], v[96:99], v[212:215], a[140:143]
  v_mfma_f32_16x16x32_bf16 a[144:147], v[100:103], v[200:203], a[144:147]
  v_mfma_f32_16x16x32_bf16 a[148:151], v[100:103], v[204:207], a[148:151]
  v_mfma_f32_16x16x32_bf16 a[152:155], v[100:103], v[208:211], a[152:155]
  v_mfma_f32_16x16x32_bf16 a[156:159], v[100:103], v[212:215], a[156:159]
  buffer_load_dwordx4 v[64:67], v1, s[4:7], s30 offen offset:1024
  buffer_load_dwordx4 v[68:71], v1, s[4:7], s31 offen offset:1024
  buffer_load_dwordx4 v[72:75], v1, s[4:7], s32 offen offset:1024
  buffer_load_dwordx4 v[76:79], v1, s[4:7], s33 offen offset:1024
  buffer_load_dwordx4 v[80:83], v1, s[4:7], s34 offen offset:1024
  buffer_load_dwordx4 v[84:87], v1, s[4:7], s35 offen offset:1024
  buffer_load_dwordx4 v[88:91], v1, s[4:7], s36 offen offset:1024
  buffer_load_dwordx4 v[92:95], v1, s[4:7], s37 offen offset:1024
  buffer_load_dwordx4 v[96:99], v1, s[4:7], s38 offen offset:1024
  buffer_load_dwordx4 v[100:103], v1, s[4:7], s39 offen offset:1024
  s_waitcnt vmcnt(30)
  ds_read_b128 v[200:203], v1 offset:11264
  ds_read_b128 v[204:207], v1 offset:35840
  ds_read_b128 v[208:211], v6 offset:11264
  ds_read_b128 v[212:215], v6 offset:35840
  s_waitcnt lgkmcnt(4)
  v_mfma_f32_16x16x32_bf16 a[0:3], v[104:107], v[184:187], a[0:3]
  v_mfma_f32_16x16x32_bf16 a[4:7], v[104:107], v[188:191], a[4:7]
  v_mfma_f32_16x16x32_bf16 a[8:11], v[104:107], v[192:195], a[8:11]
  v_mfma_f32_16x16x32_bf16 a[12:15], v[104:107], v[196:199], a[12:15]
  v_mfma_f32_16x16x32_bf16 a[16:19], v[108:111], v[184:187], a[16:19]
  v_mfma_f32_16x16x32_bf16 a[20:23], v[108:111], v[188:191], a[20:23]
  v_mfma_f32_16x16x32_bf16 a[24:27], v[108:111], v[192:195], a[24:27]
  v_mfma_f32_16x16x32_bf16 a[28:31], v[108:111], v[196:199], a[28:31]
  v_mfma_f32_16x16x32_bf16 a[32:35], v[112:115], v[184:187], a[32:35]
  v_mfma_f32_16x16x32_bf16 a[36:39], v[112:115], v[188:191], a[36:39]
  v_mfma_f32_16x16x32_bf16 a[40:43], v[112:115], v[192:195], a[40:43]
  v_mfma_f32_16x16x32_bf16 a[44:47], v[112:115], v[196:199], a[44:47]
  v_mfma_f32_16x16x32_bf16 a[48:51], v[116:119], v[184:187], a[48:51]
  v_mfma_f32_16x16x32_bf16 a[52:55], v[116:119], v[188:191], a[52:55]
  v_mfma_f32_16x16x32_bf16 a[56:59], v[116:119], v[192:195], a[56:59]
  v_mfma_f32_16x16x32_bf16 a[60:63], v[116:119], v[196:199], a[60:63]
  v_mfma_f32_16x16x32_bf16 a[64:67], v[120:123], v[184:187], a[64:67]
  v_mfma_f32_16x16x32_bf16 a[68:71], v[120:123], v[188:191], a[68:71]
  v_mfma_f32_16x16x32_bf16 a[72:75], v[120:123], v[192:195], a[72:75]
  v_mfma_f32_16x16x32_bf16 a[76:79], v[120:123], v[196:199], a[76:79]
  v_mfma_f32_16x16x32_bf16 a[80:83], v[124:127], v[184:187], a[80:83]
  v_mfma_f32_16x16x32_bf16 a[84:87], v[124:127], v[188:191], a[84:87]
  v_mfma_f32_16x16x32_bf16 a[88:91], v[124:127], v[192:195], a[88:91]
  v_mfma_f32_16x16x32_bf16 a[92:95], v[124:127], v[196:199], a[92:95]
  v_mfma_f32_16x16x32_bf16 a[96:99], v[128:131], v[184:187], a[96:99]
  v_mfma_f32_16x16x32_bf16 a[100:103], v[128:131], v[188:191], a[100:103]
  v_mfma_f32_16x16x32_bf16 a[104:107], v[128:131], v[192:195], a[104:107]
  v_mfma_f32_16x16x32_bf16 a[108:111], v[128:131], v[196:199], a[108:111]
  v_mfma_f32_16x16x32_bf16 a[112:115], v[132:135], v[184:187], a[112:115]
  v_mfma_f32_16x16x32_bf16 a[116:119], v[132:135], v[188:191], a[116:119]
  v_mfma_f32_16x16x32_bf16 a[120:123], v[132:135], v[192:195], a[120:123]
  v_mfma_f32_16x16x32_bf16 a[124:127], v[132:135], v[196:199], a[124:127]
  v_mfma_f32_16x16x32_bf16 a[128:131], v[136:139], v[184:187], a[128:131]
  v_mfma_f32_16x16x32_bf16 a[132:135], v[136:139], v[188:191], a[132:135]
  v_mfma_f32_16x16x32_bf16 a[136:139], v[136:139], v[192:195], a[136:139]
  v_mfma_f32_16x16x32_bf16 a[140:143], v[136:139], v[196:199], a[140:143]
  v_mfma_f32_16x16x32_bf16 a[144:147], v[140:143], v[184:187], a[144:147]
  v_mfma_f32_16x16x32_bf16 a[148:151], v[140:143], v[188:191], a[148:151]
  v_mfma_f32_16x16x32_bf16 a[152:155], v[140:143], v[192:195], a[152:155]
  v_mfma_f32_16x16x32_bf16 a[156:159], v[140:143], v[196:199], a[156:159]
  buffer_load_dwordx4 v[104:107], v1, s[4:7], s30 offen offset:2048
  buffer_load_dwordx4 v[108:111], v1, s[4:7], s31 offen offset:2048
  buffer_load_dwordx4 v[112:115], v1, s[4:7], s32 offen offset:2048
  buffer_load_dwordx4 v[116:119], v1, s[4:7], s33 offen offset:2048
  buffer_load_dwordx4 v[120:123], v1, s[4:7], s34 offen offset:2048
  buffer_load_dwordx4 v[124:127], v1, s[4:7], s35 offen offset:2048
  buffer_load_dwordx4 v[128:131], v1, s[4:7], s36 offen offset:2048
  buffer_load_dwordx4 v[132:135], v1, s[4:7], s37 offen offset:2048
  buffer_load_dwordx4 v[136:139], v1, s[4:7], s38 offen offset:2048
  buffer_load_dwordx4 v[140:143], v1, s[4:7], s39 offen offset:2048
  s_waitcnt vmcnt(30)
  ds_read_b128 v[184:187], v1 offset:12288
  ds_read_b128 v[188:191], v1 offset:36864
  ds_read_b128 v[192:195], v6 offset:12288
  ds_read_b128 v[196:199], v6 offset:36864
  s_waitcnt lgkmcnt(4)
  v_mfma_f32_16x16x32_bf16 a[0:3], v[144:147], v[200:203], a[0:3]
  v_mfma_f32_16x16x32_bf16 a[4:7], v[144:147], v[204:207], a[4:7]
  v_mfma_f32_16x16x32_bf16 a[8:11], v[144:147], v[208:211], a[8:11]
  v_mfma_f32_16x16x32_bf16 a[12:15], v[144:147], v[212:215], a[12:15]
  v_mfma_f32_16x16x32_bf16 a[16:19], v[148:151], v[200:203], a[16:19]
  v_mfma_f32_16x16x32_bf16 a[20:23], v[148:151], v[204:207], a[20:23]
  v_mfma_f32_16x16x32_bf16 a[24:27], v[148:151], v[208:211], a[24:27]
  v_mfma_f32_16x16x32_bf16 a[28:31], v[148:151], v[212:215], a[28:31]
  v_mfma_f32_16x16x32_bf16 a[32:35], v[152:155], v[200:203], a[32:35]
  v_mfma_f32_16x16x32_bf16 a[36:39], v[152:155], v[204:207], a[36:39]
  v_mfma_f32_16x16x32_bf16 a[40:43], v[152:155], v[208:211], a[40:43]
  v_mfma_f32_16x16x32_bf16 a[44:47], v[152:155], v[212:215], a[44:47]
  v_mfma_f32_16x16x32_bf16 a[48:51], v[156:159], v[200:203], a[48:51]
  v_mfma_f32_16x16x32_bf16 a[52:55], v[156:159], v[204:207], a[52:55]
  v_mfma_f32_16x16x32_bf16 a[56:59], v[156:159], v[208:211], a[56:59]
  v_mfma_f32_16x16x32_bf16 a[60:63], v[156:159], v[212:215], a[60:63]
  v_mfma_f32_16x16x32_bf16 a[64:67], v[160:163], v[200:203], a[64:67]
  v_mfma_f32_16x16x32_bf16 a[68:71], v[160:163], v[204:207], a[68:71]
  v_mfma_f32_16x16x32_bf16 a[72:75], v[160:163], v[208:211], a[72:75]
  v_mfma_f32_16x16x32_bf16 a[76:79], v[160:163], v[212:215], a[76:79]
  v_mfma_f32_16x16x32_bf16 a[80:83], v[164:167], v[200:203], a[80:83]
  v_mfma_f32_16x16x32_bf16 a[84:87], v[164:167], v[204:207], a[84:87]
  v_mfma_f32_16x16x32_bf16 a[88:91], v[164:167], v[208:211], a[88:91]
  v_mfma_f32_16x16x32_bf16 a[92:95], v[164:167], v[212:215], a[92:95]
  v_mfma_f32_16x16x32_bf16 a[96:99], v[168:171], v[200:203], a[96:99]
  v_mfma_f32_16x16x32_bf16 a[100:103], v[168:171], v[204:207], a[100:103]
  v_mfma_f32_16x16x32_bf16 a[104:107], v[168:171], v[208:211], a[104:107]
  v_mfma_f32_16x16x32_bf16 a[108:111], v[168:171], v[212:215], a[108:111]
  v_mfma_f32_16x16x32_bf16 a[112:115], v[172:175], v[200:203], a[112:115]
  v_mfma_f32_16x16x32_bf16 a[116:119], v[172:175], v[204:207], a[116:119]
  v_mfma_f32_16x16x32_bf16 a[120:123], v[172:175], v[208:211], a[120:123]
  v_mfma_f32_16x16x32_bf16 a[124:127], v[172:175], v[212:215], a[124:127]
  v_mfma_f32_16x16x32_bf16 a[128:131], v[176:179], v[200:203], a[128:131]
  v_mfma_f32_16x16x32_bf16 a[132:135], v[176:179], v[204:207], a[132:135]
  v_mfma_f32_16x16x32_bf16 a[136:139], v[176:179], v[208:211], a[136:139]
  v_mfma_f32_16x16x32_bf16 a[140:143], v[176:179], v[212:215], a[140:143]
  v_mfma_f32_16x16x32_bf16 a[144:147], v[180:183], v[200:203], a[144:147]
  v_mfma_f32_16x16x32_bf16 a[148:151], v[180:183], v[204:207], a[148:151]
  v_mfma_f32_16x16x32_bf16 a[152:155], v[180:183], v[208:211], a[152:155]
  v_mfma_f32_16x16x32_bf16 a[156:159], v[180:183], v[212:215], a[156:159]
  buffer_load_dwordx4 v[144:147], v1, s[4:7], s30 offen offset:3072
  buffer_load_dwordx4 v[148:151], v1, s[4:7], s31 offen offset:3072
  buffer_load_dwordx4 v[152:155], v1, s[4:7], s32 offen offset:3072
  buffer_load_dwordx4 v[156:159], v1, s[4:7], s33 offen offset:3072
  buffer_load_dwordx4 v[160:163], v1, s[4:7], s34 offen offset:3072
  buffer_load_dwordx4 v[164:167], v1, s[4:7], s35 offen offset:3072
  buffer_load_dwordx4 v[168:171], v1, s[4:7], s36 offen offset:3072
  buffer_load_dwordx4 v[172:175], v1, s[4:7], s37 offen offset:3072
  buffer_load_dwordx4 v[176:179], v1, s[4:7], s38 offen offset:3072
  buffer_load_dwordx4 v[180:183], v1, s[4:7], s39 offen offset:3072
  s_add_u32 s30, s30, 4096
  s_add_u32 s31, s31, 4096
  s_add_u32 s32, s32, 4096
  s_add_u32 s33, s33, 4096
  s_add_u32 s34, s34, 4096
  s_add_u32 s35, s35, 4096
  s_add_u32 s36, s36, 4096
  s_add_u32 s37, s37, 4096
  s_add_u32 s38, s38, 4096
  s_add_u32 s39, s39, 4096
  s_waitcnt vmcnt(30)
  ds_read_b128 v[200:203], v1 offset:13312
  ds_read_b128 v[204:207], v1 offset:37888
  ds_read_b128 v[208:211], v6 offset:13312
  ds_read_b128 v[212:215], v6 offset:37888
  s_waitcnt lgkmcnt(4)
  v_mfma_f32_16x16x32_bf16 a[0:3], v[24:27], v[184:187], a[0:3]
  v_mfma_f32_16x16x32_bf16 a[4:7], v[24:27], v[188:191], a[4:7]
  v_mfma_f32_16x16x32_bf16 a[8:11], v[24:27], v[192:195], a[8:11]
  v_mfma_f32_16x16x32_bf16 a[12:15], v[24:27], v[196:199], a[12:15]
  v_mfma_f32_16x16x32_bf16 a[16:19], v[28:31], v[184:187], a[16:19]
  v_mfma_f32_16x16x32_bf16 a[20:23], v[28:31], v[188:191], a[20:23]
  v_mfma_f32_16x16x32_bf16 a[24:27], v[28:31], v[192:195], a[24:27]
  v_mfma_f32_16x16x32_bf16 a[28:31], v[28:31], v[196:199], a[28:31]
  v_mfma_f32_16x16x32_bf16 a[32:35], v[32:35], v[184:187], a[32:35]
  v_mfma_f32_16x16x32_bf16 a[36:39], v[32:35], v[188:191], a[36:39]
  v_mfma_f32_16x16x32_bf16 a[40:43], v[32:35], v[192:195], a[40:43]
  v_mfma_f32_16x16x32_bf16 a[44:47], v[32:35], v[196:199], a[44:47]
  v_mfma_f32_16x16x32_bf16 a[48:51], v[36:39], v[184:187], a[48:51]
  v_mfma_f32_16x16x32_bf16 a[52:55], v[36:39], v[188:191], a[52:55]
  v_mfma_f32_16x16x32_bf16 a[56:59], v[36:39], v[192:195], a[56:59]
  v_mfma_f32_16x16x32_bf16 a[60:63], v[36:39], v[196:199], a[60:63]
  v_mfma_f32_16x16x32_bf16 a[64:67], v[40:43], v[184:187], a[64:67]
  v_mfma_f32_16x16x32_bf16 a[68:71], v[40:43], v[188:191], a[68:71]
  v_mfma_f32_16x16x32_bf16 a[72:75], v[40:43], v[192:195], a[72:75]
  v_mfma_f32_16x16x32_bf16 a[76:79], v[40:43], v[196:199], a[76:79]
  v_mfma_f32_16x16x32_bf16 a[80:83], v[44:47], v[184:187], a[80:83]
  v_mfma_f32_16x16x32_bf16 a[84:87], v[44:47], v[188:191], a[84:87]
  v_mfma_f32_16x16x32_bf16 a[88:91], v[44:47], v[192:195], a[88:91]
  v_mfma_f32_16x16x32_bf16 a[92:95], v[44:47], v[196:199], a[92:95]
  v_mfma_f32_16x16x32_bf16 a[96:99], v[48:51], v[184:187], a[96:99]
  v_mfma_f32_16x16x32_bf16 a[100:103], v[48:51], v[188:191], a[100:103]
  v_mfma_f32_16x16x32_bf16 a[104:107], v[48:51], v[192:195], a[104:107]
  v_mfma_f32_16x16x32_bf16 a[108:111], v[48:51], v[196:199], a[108:111]
  v_mfma_f32_16x16x32_bf16 a[112:115], v[52:55], v[184:187], a[112:115]
  v_mfma_f32_16x16x32_bf16 a[116:119], v[52:55], v[188:191], a[116:119]
  v_mfma_f32_16x16x32_bf16 a[120:123], v[52:55], v[192:195], a[120:123]
  v_mfma_f32_16x16x32_bf16 a[124:127], v[52:55], v[196:199], a[124:127]
  v_mfma_f32_16x16x32_bf16 a[128:131], v[56:59], v[184:187], a[128:131]
  v_mfma_f32_16x16x32_bf16 a[132:135], v[56:59], v[188:191], a[132:135]
  v_mfma_f32_16x16x32_bf16 a[136:139], v[56:59], v[192:195], a[136:139]
  v_mfma_f32_16x16x32_bf16 a[140:143], v[56:59], v[196:199], a[140:143]
  v_mfma_f32_16x16x32_bf16 a[144:147], v[60:63], v[184:187], a[144:147]
  v_mfma_f32_16x16x32_bf16 a[148:151], v[60:63], v[188:191], a[148:151]
  v_mfma_f32_16x16x32_bf16 a[152:155], v[60:63], v[192:195], a[152:155]
  v_mfma_f32_16x16x32_bf16 a[156:159], v[60:63], v[196:199], a[156:159]
  buffer_load_dwordx4 v[24:27], v1, s[4:7], s30 offen offset:0
  buffer_load_dwordx4 v[28:31], v1, s[4:7], s31 offen offset:0
  buffer_load_dwordx4 v[32:35], v1, s[4:7], s32 offen offset:0
  buffer_load_dwordx4 v[36:39], v1, s[4:7], s33 offen offset:0
  buffer_load_dwordx4 v[40:43], v1, s[4:7], s34 offen offset:0
  buffer_load_dwordx4 v[44:47], v1, s[4:7], s35 offen offset:0
  buffer_load_dwordx4 v[48:51], v1, s[4:7], s36 offen offset:0
  buffer_load_dwordx4 v[52:55], v1, s[4:7], s37 offen offset:0
  buffer_load_dwordx4 v[56:59], v1, s[4:7], s38 offen offset:0
  buffer_load_dwordx4 v[60:63], v1, s[4:7], s39 offen offset:0
  s_waitcnt vmcnt(30)
  ds_read_b128 v[184:187], v1 offset:14336
  ds_read_b128 v[188:191], v1 offset:38912
  ds_read_b128 v[192:195], v6 offset:14336
  ds_read_b128 v[196:199], v6 offset:38912
  s_waitcnt lgkmcnt(4)
  v_mfma_f32_16x16x32_bf16 a[0:3], v[64:67], v[200:203], a[0:3]
  v_mfma_f32_16x16x32_bf16 a[4:7], v[64:67], v[204:207], a[4:7]
  v_mfma_f32_16x16x32_bf16 a[8:11], v[64:67], v[208:211], a[8:11]
  v_mfma_f32_16x16x32_bf16 a[12:15], v[64:67], v[212:215], a[12:15]
  v_mfma_f32_16x16x32_bf16 a[16:19], v[68:71], v[200:203], a[16:19]
  v_mfma_f32_16x16x32_bf16 a[20:23], v[68:71], v[204:207], a[20:23]
  v_mfma_f32_16x16x32_bf16 a[24:27], v[68:71], v[208:211], a[24:27]
  v_mfma_f32_16x16x32_bf16 a[28:31], v[68:71], v[212:215], a[28:31]
  v_mfma_f32_16x16x32_bf16 a[32:35], v[72:75], v[200:203], a[32:35]
  v_mfma_f32_16x16x32_bf16 a[36:39], v[72:75], v[204:207], a[36:39]
  v_mfma_f32_16x16x32_bf16 a[40:43], v[72:75], v[208:211], a[40:43]
  v_mfma_f32_16x16x32_bf16 a[44:47], v[72:75], v[212:215], a[44:47]
  v_mfma_f32_16x16x32_bf16 a[48:51], v[76:79], v[200:203], a[48:51]
  v_mfma_f32_16x16x32_bf16 a[52:55], v[76:79], v[204:207], a[52:55]
  v_mfma_f32_16x16x32_bf16 a[56:59], v[76:79], v[208:211], a[56:59]
  v_mfma_f32_16x16x32_bf16 a[60:63], v[76:79], v[212:215], a[60:63]
  v_mfma_f32_16x16x32_bf16 a[64:67], v[80:83], v[200:203], a[64:67]
  v_mfma_f32_16x16x32_bf16 a[68:71], v[80:83], v[204:207], a[68:71]
  v_mfma_f32_16x16x32_bf16 a[72:75], v[80:83], v[208:211], a[72:75]
  v_mfma_f32_16x16x32_bf16 a[76:79], v[80:83], v[212:215], a[76:79]
  v_mfma_f32_16x16x32_bf16 a[80:83], v[84:87], v[200:203], a[80:83]
  v_mfma_f32_16x16x32_bf16 a[84:87], v[84:87], v[204:207], a[84:87]
  v_mfma_f32_16x16x32_bf16 a[88:91], v[84:87], v[208:211], a[88:91]
  v_mfma_f32_16x16x32_bf16 a[92:95], v[84:87], v[212:215], a[92:95]
  v_mfma_f32_16x16x32_bf16 a[96:99], v[88:91], v[200:203], a[96:99]
  v_mfma_f32_16x16x32_bf16 a[100:103], v[88:91], v[204:207], a[100:103]
  v_mfma_f32_16x16x32_bf16 a[104:107], v[88:91], v[208:211], a[104:107]
  v_mfma_f32_16x16x32_bf16 a[108:111], v[88:91], v[212:215], a[108:111]
  v_mfma_f32_16x16x32_bf16 a[112:115], v[92:95], v[200:203], a[112:115]
  v_mfma_f32_16x16x32_bf16 a[116:119], v[92:95], v[204:207], a[116:119]
  v_mfma_f32_16x16x32_bf16 a[120:123], v[92:95], v[208:211], a[120:123]
  v_mfma_f32_16x16x32_bf16 a[124:127], v[92:95], v[212:215], a[124:127]
  v_mfma_f32_16x16x32_bf16 a[128:131], v[96:99], v[200:203], a[128:131]
  v_mfma_f32_16x16x32_bf16 a[132:135], v[96:99], v[204:207], a[132:135]
  v_mfma_f32_16x16x32_bf16 a[136:139], v[96:99], v[208:211], a[136:139]
  v_mfma_f32_16x16x32_bf16 a[140:143], v[96:99], v[212:215], a[140:143]
  v_mfma_f32_16x16x32_bf16 a[144:147], v[100:103], v[200:203], a[144:147]
  v_mfma_f32_16x16x32_bf16 a[148:151], v[100:103], v[204:207], a[148:151]
  v_mfma_f32_16x16x32_bf16 a[152:155], v[100:103], v[208:211], a[152:155]
  v_mfma_f32_16x16x32_bf16 a[156:159], v[100:103], v[212:215], a[156:159]
  buffer_load_dwordx4 v[64:67], v1, s[4:7], s30 offen offset:1024
  buffer_load_dwordx4 v[68:71], v1, s[4:7], s31 offen offset:1024
  buffer_load_dwordx4 v[72:75], v1, s[4:7], s32 offen offset:1024
  buffer_load_dwordx4 v[76:79], v1, s[4:7], s33 offen offset:1024
  buffer_load_dwordx4 v[80:83], v1, s[4:7], s34 offen offset:1024
  buffer_load_dwordx4 v[84:87], v1, s[4:7], s35 offen offset:1024
  buffer_load_dwordx4 v[88:91], v1, s[4:7], s36 offen offset:1024
  buffer_load_dwordx4 v[92:95], v1, s[4:7], s37 offen offset:1024
  buffer_load_dwordx4 v[96:99], v1, s[4:7], s38 offen offset:1024
  buffer_load_dwordx4 v[100:103], v1, s[4:7], s39 offen offset:1024
  s_waitcnt vmcnt(30)
  ds_read_b128 v[200:203], v1 offset:15360
  ds_read_b128 v[204:207], v1 offset:39936
  ds_read_b128 v[208:211], v6 offset:15360
  ds_read_b128 v[212:215], v6 offset:39936
  s_waitcnt lgkmcnt(4)
  v_mfma_f32_16x16x32_bf16 a[0:3], v[104:107], v[184:187], a[0:3]
  v_mfma_f32_16x16x32_bf16 a[4:7], v[104:107], v[188:191], a[4:7]
  v_mfma_f32_16x16x32_bf16 a[8:11], v[104:107], v[192:195], a[8:11]
  v_mfma_f32_16x16x32_bf16 a[12:15], v[104:107], v[196:199], a[12:15]
  v_mfma_f32_16x16x32_bf16 a[16:19], v[108:111], v[184:187], a[16:19]
  v_mfma_f32_16x16x32_bf16 a[20:23], v[108:111], v[188:191], a[20:23]
  v_mfma_f32_16x16x32_bf16 a[24:27], v[108:111], v[192:195], a[24:27]
  v_mfma_f32_16x16x32_bf16 a[28:31], v[108:111], v[196:199], a[28:31]
  v_mfma_f32_16x16x32_bf16 a[32:35], v[112:115], v[184:187], a[32:35]
  v_mfma_f32_16x16x32_bf16 a[36:39], v[112:115], v[188:191], a[36:39]
  v_mfma_f32_16x16x32_bf16 a[40:43], v[112:115], v[192:195], a[40:43]
  v_mfma_f32_16x16x32_bf16 a[44:47], v[112:115], v[196:199], a[44:47]
  v_mfma_f32_16x16x32_bf16 a[48:51], v[116:119], v[184:187], a[48:51]
  v_mfma_f32_16x16x32_bf16 a[52:55], v[116:119], v[188:191], a[52:55]
  v_mfma_f32_16x16x32_bf16 a[56:59], v[116:119], v[192:195], a[56:59]
  v_mfma_f32_16x16x32_bf16 a[60:63], v[116:119], v[196:199], a[60:63]
  v_mfma_f32_16x16x32_bf16 a[64:67], v[120:123], v[184:187], a[64:67]
  v_mfma_f32_16x16x32_bf16 a[68:71], v[120:123], v[188:191], a[68:71]
  v_mfma_f32_16x16x32_bf16 a[72:75], v[120:123], v[192:195], a[72:75]
  v_mfma_f32_16x16x32_bf16 a[76:79], v[120:123], v[196:199], a[76:79]
  v_mfma_f32_16x16x32_bf16 a[80:83], v[124:127], v[184:187], a[80:83]
  v_mfma_f32_16x16x32_bf16 a[84:87], v[124:127], v[188:191], a[84:87]
  v_mfma_f32_16x16x32_bf16 a[88:91], v[124:127], v[192:195], a[88:91]
  v_mfma_f32_16x16x32_bf16 a[92:95], v[124:127], v[196:199], a[92:95]
  v_mfma_f32_16x16x32_bf16 a[96:99], v[128:131], v[184:187], a[96:99]
  v_mfma_f32_16x16x32_bf16 a[100:103], v[128:131], v[188:191], a[100:103]
  v_mfma_f32_16x16x32_bf16 a[104:107], v[128:131], v[192:195], a[104:107]
  v_mfma_f32_16x16x32_bf16 a[108:111], v[128:131], v[196:199], a[108:111]
  v_mfma_f32_16x16x32_bf16 a[112:115], v[132:135], v[184:187], a[112:115]
  v_mfma_f32_16x16x32_bf16 a[116:119], v[132:135], v[188:191], a[116:119]
  v_mfma_f32_16x16x32_bf16 a[120:123], v[132:135], v[192:195], a[120:123]
  v_mfma_f32_16x16x32_bf16 a[124:127], v[132:135], v[196:199], a[124:127]
  v_mfma_f32_16x16x32_bf16 a[128:131], v[136:139], v[184:187], a[128:131]
  v_mfma_f32_16x16x32_bf16 a[132:135], v[136:139], v[188:191], a[132:135]
  v_mfma_f32_16x16x32_bf16 a[136:139], v[136:139], v[192:195], a[136:139]
  v_mfma_f32_16x16x32_bf16 a[140:143], v[136:139], v[196:199], a[140:143]
  v_mfma_f32_16x16x32_bf16 a[144:147], v[140:143], v[184:187], a[144:147]
  v_mfma_f32_16x16x32_bf16 a[148:151], v[140:143], v[188:191], a[148:151]
  v_mfma_f32_16x16x32_bf16 a[152:155], v[140:143], v[192:195], a[152:155]
  v_mfma_f32_16x16x32_bf16 a[156:159], v[140:143], v[196:199], a[156:159]
  buffer_load_dwordx4 v[104:107], v1, s[4:7], s30 offen offset:2048
  buffer_load_dwordx4 v[108:111], v1, s[4:7], s31 offen offset:2048
  buffer_load_dwordx4 v[112:115], v1, s[4:7], s32 offen offset:2048
  buffer_load_dwordx4 v[116:119], v1, s[4:7], s33 offen offset:2048
  buffer_load_dwordx4 v[120:123], v1, s[4:7], s34 offen offset:2048
  buffer_load_dwordx4 v[124:127], v1, s[4:7], s35 offen offset:2048
  buffer_load_dwordx4 v[128:131], v1, s[4:7], s36 offen offset:2048
  buffer_load_dwordx4 v[132:135], v1, s[4:7], s37 offen offset:2048
  buffer_load_dwordx4 v[136:139], v1, s[4:7], s38 offen offset:2048
  buffer_load_dwordx4 v[140:143], v1, s[4:7], s39 offen offset:2048
  s_waitcnt vmcnt(30)
  ds_read_b128 v[184:187], v1 offset:16384
  ds_read_b128 v[188:191], v1 offset:40960
  ds_read_b128 v[192:195], v6 offset:16384
  ds_read_b128 v[196:199], v6 offset:40960
  s_waitcnt lgkmcnt(4)
  v_mfma_f32_16x16x32_bf16 a[0:3], v[144:147], v[200:203], a[0:3]
  v_mfma_f32_16x16x32_bf16 a[4:7], v[144:147], v[204:207], a[4:7]
  v_mfma_f32_16x16x32_bf16 a[8:11], v[144:147], v[208:211], a[8:11]
  v_mfma_f32_16x16x32_bf16 a[12:15], v[144:147], v[212:215], a[12:15]
  v_mfma_f32_16x16x32_bf16 a[16:19], v[148:151], v[200:203], a[16:19]
  v_mfma_f32_16x16x32_bf16 a[20:23], v[148:151], v[204:207], a[20:23]
  v_mfma_f32_16x16x32_bf16 a[24:27], v[148:151], v[208:211], a[24:27]
  v_mfma_f32_16x16x32_bf16 a[28:31], v[148:151], v[212:215], a[28:31]
  v_mfma_f32_16x16x32_bf16 a[32:35], v[152:155], v[200:203], a[32:35]
  v_mfma_f32_16x16x32_bf16 a[36:39], v[152:155], v[204:207], a[36:39]
  v_mfma_f32_16x16x32_bf16 a[40:43], v[152:155], v[208:211], a[40:43]
  v_mfma_f32_16x16x32_bf16 a[44:47], v[152:155], v[212:215], a[44:47]
  v_mfma_f32_16x16x32_bf16 a[48:51], v[156:159], v[200:203], a[48:51]
  v_mfma_f32_16x16x32_bf16 a[52:55], v[156:159], v[204:207], a[52:55]
  v_mfma_f32_16x16x32_bf16 a[56:59], v[156:159], v[208:211], a[56:59]
  v_mfma_f32_16x16x32_bf16 a[60:63], v[156:159], v[212:215], a[60:63]
  v_mfma_f32_16x16x32_bf16 a[64:67], v[160:163], v[200:203], a[64:67]
  v_mfma_f32_16x16x32_bf16 a[68:71], v[160:163], v[204:207], a[68:71]
  v_mfma_f32_16x16x32_bf16 a[72:75], v[160:163], v[208:211], a[72:75]
  v_mfma_f32_16x16x32_bf16 a[76:79], v[160:163], v[212:215], a[76:79]
  v_mfma_f32_16x16x32_bf16 a[80:83], v[164:167], v[200:203], a[80:83]
  v_mfma_f32_16x16x32_bf16 a[84:87], v[164:167], v[204:207], a[84:87]
  v_mfma_f32_16x16x32_bf16 a[88:91], v[164:167], v[208:211], a[88:91]
  v_mfma_f32_16x16x32_bf16 a[92:95], v[164:167], v[212:215], a[92:95]
  v_mfma_f32_16x16x32_bf16 a[96:99], v[168:171], v[200:203], a[96:99]
  v_mfma_f32_16x16x32_bf16 a[100:103], v[168:171], v[204:207], a[100:103]
  v_mfma_f32_16x16x32_bf16 a[104:107], v[168:171], v[208:211], a[104:107]
  v_mfma_f32_16x16x32_bf16 a[108:111], v[168:171], v[212:215], a[108:111]
  v_mfma_f32_16x16x32_bf16 a[112:115], v[172:175], v[200:203], a[112:115]
  v_mfma_f32_16x16x32_bf16 a[116:119], v[172:175], v[204:207], a[116:119]
  v_mfma_f32_16x16x32_bf16 a[120:123], v[172:175], v[208:211], a[120:123]
  v_mfma_f32_16x16x32_bf16 a[124:127], v[172:175], v[212:215], a[124:127]
  v_mfma_f32_16x16x32_bf16 a[128:131], v[176:179], v[200:203], a[128:131]
  v_mfma_f32_16x16x32_bf16 a[132:135], v[176:179], v[204:207], a[132:135]
  v_mfma_f32_16x16x32_bf16 a[136:139], v[176:179], v[208:211], a[136:139]
  v_mfma_f32_16x16x32_bf16 a[140:143], v[176:179], v[212:215], a[140:143]
  v_mfma_f32_16x16x32_bf16 a[144:147], v[180:183], v[200:203], a[144:147]
  v_mfma_f32_16x16x32_bf16 a[148:151], v[180:183], v[204:207], a[148:151]
  v_mfma_f32_16x16x32_bf16 a[152:155], v[180:183], v[208:211], a[152:155]
  v_mfma_f32_16x16x32_bf16 a[156:159], v[180:183], v[212:215], a[156:159]
  buffer_load_dwordx4 v[144:147], v1, s[4:7], s30 offen offset:3072
  buffer_load_dwordx4 v[148:151], v1, s[4:7], s31 offen offset:3072
  buffer_load_dwordx4 v[152:155], v1, s[4:7], s32 offen offset:3072
  buffer_load_dwordx4 v[156:159], v1, s[4:7], s33 offen offset:3072
  buffer_load_dwordx4 v[160:163], v1, s[4:7], s34 offen offset:3072
  buffer_load_dwordx4 v[164:167], v1, s[4:7], s35 offen offset:3072
  buffer_load_dwordx4 v[168:171], v1, s[4:7], s36 offen offset:3072
  buffer_load_dwordx4 v[172:175], v1, s[4:7], s37 offen offset:3072
  buffer_load_dwordx4 v[176:179], v1, s[4:7], s38 offen offset:3072
  buffer_load_dwordx4 v[180:183], v1, s[4:7], s39 offen offset:3072
  s_add_u32 s30, s30, 4096
  s_add_u32 s31, s31, 4096
  s_add_u32 s32, s32, 4096
  s_add_u32 s33, s33, 4096
  s_add_u32 s34, s34, 4096
  s_add_u32 s35, s35, 4096
  s_add_u32 s36, s36, 4096
  s_add_u32 s37, s37, 4096
  s_add_u32 s38, s38, 4096
  s_add_u32 s39, s39, 4096
  s_waitcnt vmcnt(30)
  ds_read_b128 v[200:203], v1 offset:17408
  ds_read_b128 v[204:207], v1 offset:41984
  ds_read_b128 v[208:211], v6 offset:17408
  ds_read_b128 v[212:215], v6 offset:41984
  s_waitcnt lgkmcnt(4)
  v_mfma_f32_16x16x32_bf16 a[0:3], v[24:27], v[184:187], a[0:3]
  v_mfma_f32_16x16x32_bf16 a[4:7], v[24:27], v[188:191], a[4:7]
  v_mfma_f32_16x16x32_bf16 a[8:11], v[24:27], v[192:195], a[8:11]
  v_mfma_f32_16x16x32_bf16 a[12:15], v[24:27], v[196:199], a[12:15]
  v_mfma_f32_16x16x32_bf16 a[16:19], v[28:31], v[184:187], a[16:19]
  v_mfma_f32_16x16x32_bf16 a[20:23], v[28:31], v[188:191], a[20:23]
  v_mfma_f32_16x16x32_bf16 a[24:27], v[28:31], v[192:195], a[24:27]
  v_mfma_f32_16x16x32_bf16 a[28:31], v[28:31], v[196:199], a[28:31]
  v_mfma_f32_16x16x32_bf16 a[32:35], v[32:35], v[184:187], a[32:35]
  v_mfma_f32_16x16x32_bf16 a[36:39], v[32:35], v[188:191], a[36:39]
  v_mfma_f32_16x16x32_bf16 a[40:43], v[32:35], v[192:195], a[40:43]
  v_mfma_f32_16x16x32_bf16 a[44:47], v[32:35], v[196:199], a[44:47]
  v_mfma_f32_16x16x32_bf16 a[48:51], v[36:39], v[184:187], a[48:51]
  v_mfma_f32_16x16x32_bf16 a[52:55], v[36:39], v[188:191], a[52:55]
  v_mfma_f32_16x16x32_bf16 a[56:59], v[36:39], v[192:195], a[56:59]
  v_mfma_f32_16x16x32_bf16 a[60:63], v[36:39], v[196:199], a[60:63]
  v_mfma_f32_16x16x32_bf16 a[64:67], v[40:43], v[184:187], a[64:67]
  v_mfma_f32_16x16x32_bf16 a[68:71], v[40:43], v[188:191], a[68:71]
  v_mfma_f32_16x16x32_bf16 a[72:75], v[40:43], v[192:195], a[72:75]
  v_mfma_f32_16x16x32_bf16 a[76:79], v[40:43], v[196:199], a[76:79]
  v_mfma_f32_16x16x32_bf16 a[80:83], v[44:47], v[184:187], a[80:83]
  v_mfma_f32_16x16x32_bf16 a[84:87], v[44:47], v[188:191], a[84:87]
  v_mfma_f32_16x16x32_bf16 a[88:91], v[44:47], v[192:195], a[88:91]
  v_mfma_f32_16x16x32_bf16 a[92:95], v[44:47], v[196:199], a[92:95]
  v_mfma_f32_16x16x32_bf16 a[96:99], v[48:51], v[184:187], a[96:99]
  v_mfma_f32_16x16x32_bf16 a[100:103], v[48:51], v[188:191], a[100:103]
  v_mfma_f32_16x16x32_bf16 a[104:107], v[48:51], v[192:195], a[104:107]
  v_mfma_f32_16x16x32_bf16 a[108:111], v[48:51], v[196:199], a[108:111]
  v_mfma_f32_16x16x32_bf16 a[112:115], v[52:55], v[184:187], a[112:115]
  v_mfma_f32_16x16x32_bf16 a[116:119], v[52:55], v[188:191], a[116:119]
  v_mfma_f32_16x16x32_bf16 a[120:123], v[52:55], v[192:195], a[120:123]
  v_mfma_f32_16x16x32_bf16 a[124:127], v[52:55], v[196:199], a[124:127]
  v_mfma_f32_16x16x32_bf16 a[128:131], v[56:59], v[184:187], a[128:131]
  v_mfma_f32_16x16x32_bf16 a[132:135], v[56:59], v[188:191], a[132:135]
  v_mfma_f32_16x16x32_bf16 a[136:139], v[56:59], v[192:195], a[136:139]
  v_mfma_f32_16x16x32_bf16 a[140:143], v[56:59], v[196:199], a[140:143]
  v_mfma_f32_16x16x32_bf16 a[144:147], v[60:63], v[184:187], a[144:147]
  v_mfma_f32_16x16x32_bf16 a[148:151], v[60:63], v[188:191], a[148:151]
  v_mfma_f32_16x16x32_bf16 a[152:155], v[60:63], v[192:195], a[152:155]
  v_mfma_f32_16x16x32_bf16 a[156:159], v[60:63], v[196:199], a[156:159]
  buffer_load_dwordx4 v[24:27], v1, s[4:7], s30 offen offset:0
  buffer_load_dwordx4 v[28:31], v1, s[4:7], s31 offen offset:0
  buffer_load_dwordx4 v[32:35], v1, s[4:7], s32 offen offset:0
  buffer_load_dwordx4 v[36:39], v1, s[4:7], s33 offen offset:0
  buffer_load_dwordx4 v[40:43], v1, s[4:7], s34 offen offset:0
  buffer_load_dwordx4 v[44:47], v1, s[4:7], s35 offen offset:0
  buffer_load_dwordx4 v[48:51], v1, s[4:7], s36 offen offset:0
  buffer_load_dwordx4 v[52:55], v1, s[4:7], s37 offen offset:0
  buffer_load_dwordx4 v[56:59], v1, s[4:7], s38 offen offset:0
  buffer_load_dwordx4 v[60:63], v1, s[4:7], s39 offen offset:0
  s_waitcnt vmcnt(30)
  ds_read_b128 v[184:187], v1 offset:18432
  ds_read_b128 v[188:191], v1 offset:43008
  ds_read_b128 v[192:195], v6 offset:18432
  ds_read_b128 v[196:199], v6 offset:43008
  s_waitcnt lgkmcnt(4)
  v_mfma_f32_16x16x32_bf16 a[0:3], v[64:67], v[200:203], a[0:3]
  v_mfma_f32_16x16x32_bf16 a[4:7], v[64:67], v[204:207], a[4:7]
  v_mfma_f32_16x16x32_bf16 a[8:11], v[64:67], v[208:211], a[8:11]
  v_mfma_f32_16x16x32_bf16 a[12:15], v[64:67], v[212:215], a[12:15]
  v_mfma_f32_16x16x32_bf16 a[16:19], v[68:71], v[200:203], a[16:19]
  v_mfma_f32_16x16x32_bf16 a[20:23], v[68:71], v[204:207], a[20:23]
  v_mfma_f32_16x16x32_bf16 a[24:27], v[68:71], v[208:211], a[24:27]
  v_mfma_f32_16x16x32_bf16 a[28:31], v[68:71], v[212:215], a[28:31]
  v_mfma_f32_16x16x32_bf16 a[32:35], v[72:75], v[200:203], a[32:35]
  v_mfma_f32_16x16x32_bf16 a[36:39], v[72:75], v[204:207], a[36:39]
  v_mfma_f32_16x16x32_bf16 a[40:43], v[72:75], v[208:211], a[40:43]
  v_mfma_f32_16x16x32_bf16 a[44:47], v[72:75], v[212:215], a[44:47]
  v_mfma_f32_16x16x32_bf16 a[48:51], v[76:79], v[200:203], a[48:51]
  v_mfma_f32_16x16x32_bf16 a[52:55], v[76:79], v[204:207], a[52:55]
  v_mfma_f32_16x16x32_bf16 a[56:59], v[76:79], v[208:211], a[56:59]
  v_mfma_f32_16x16x32_bf16 a[60:63], v[76:79], v[212:215], a[60:63]
  v_mfma_f32_16x16x32_bf16 a[64:67], v[80:83], v[200:203], a[64:67]
  v_mfma_f32_16x16x32_bf16 a[68:71], v[80:83], v[204:207], a[68:71]
  v_mfma_f32_16x16x32_bf16 a[72:75], v[80:83], v[208:211], a[72:75]
  v_mfma_f32_16x16x32_bf16 a[76:79], v[80:83], v[212:215], a[76:79]
  v_mfma_f32_16x16x32_bf16 a[80:83], v[84:87], v[200:203], a[80:83]
  v_mfma_f32_16x16x32_bf16 a[84:87], v[84:87], v[204:207], a[84:87]
  v_mfma_f32_16x16x32_bf16 a[88:91], v[84:87], v[208:211], a[88:91]
  v_mfma_f32_16x16x32_bf16 a[92:95], v[84:87], v[212:215], a[92:95]
  v_mfma_f32_16x16x32_bf16 a[96:99], v[88:91], v[200:203], a[96:99]
  v_mfma_f32_16x16x32_bf16 a[100:103], v[88:91], v[204:207], a[100:103]
  v_mfma_f32_16x16x32_bf16 a[104:107], v[88:91], v[208:211], a[104:107]
  v_mfma_f32_16x16x32_bf16 a[108:111], v[88:91], v[212:215], a[108:111]
  v_mfma_f32_16x16x32_bf16 a[112:115], v[92:95], v[200:203], a[112:115]
  v_mfma_f32_16x16x32_bf16 a[116:119], v[92:95], v[204:207], a[116:119]
  v_mfma_f32_16x16x32_bf16 a[120:123], v[92:95], v[208:211], a[120:123]
  v_mfma_f32_16x16x32_bf16 a[124:127], v[92:95], v[212:215], a[124:127]
  v_mfma_f32_16x16x32_bf16 a[128:131], v[96:99], v[200:203], a[128:131]
  v_mfma_f32_16x16x32_bf16 a[132:135], v[96:99], v[204:207], a[132:135]
  v_mfma_f32_16x16x32_bf16 a[136:139], v[96:99], v[208:211], a[136:139]
  v_mfma_f32_16x16x32_bf16 a[140:143], v[96:99], v[212:215], a[140:143]
  v_mfma_f32_16x16x32_bf16 a[144:147], v[100:103], v[200:203], a[144:147]
  v_mfma_f32_16x16x32_bf16 a[148:151], v[100:103], v[204:207], a[148:151]
  v_mfma_f32_16x16x32_bf16 a[152:155], v[100:103], v[208:211], a[152:155]
  v_mfma_f32_16x16x32_bf16 a[156:159], v[100:103], v[212:215], a[156:159]
  buffer_load_dwordx4 v[64:67], v1, s[4:7], s30 offen offset:1024
  buffer_load_dwordx4 v[68:71], v1, s[4:7], s31 offen offset:1024
  buffer_load_dwordx4 v[72:75], v1, s[4:7], s32 offen offset:1024
  buffer_load_dwordx4 v[76:79], v1, s[4:7], s33 offen offset:1024
  buffer_load_dwordx4 v[80:83], v1, s[4:7], s34 offen offset:1024
  buffer_load_dwordx4 v[84:87], v1, s[4:7], s35 offen offset:1024
  buffer_load_dwordx4 v[88:91], v1, s[4:7], s36 offen offset:1024
  buffer_load_dwordx4 v[92:95], v1, s[4:7], s37 offen offset:1024
  buffer_load_dwordx4 v[96:99], v1, s[4:7], s38 offen offset:1024
  buffer_load_dwordx4 v[100:103], v1, s[4:7], s39 offen offset:1024
  s_waitcnt vmcnt(30)
  ds_read_b128 v[200:203], v1 offset:19456
  ds_read_b128 v[204:207], v1 offset:44032
  ds_read_b128 v[208:211], v6 offset:19456
  ds_read_b128 v[212:215], v6 offset:44032
  s_waitcnt lgkmcnt(4)
  v_mfma_f32_16x16x32_bf16 a[0:3], v[104:107], v[184:187], a[0:3]
  v_mfma_f32_16x16x32_bf16 a[4:7], v[104:107], v[188:191], a[4:7]
  v_mfma_f32_16x16x32_bf16 a[8:11], v[104:107], v[192:195], a[8:11]
  v_mfma_f32_16x16x32_bf16 a[12:15], v[104:107], v[196:199], a[12:15]
  v_mfma_f32_16x16x32_bf16 a[16:19], v[108:111], v[184:187], a[16:19]
  v_mfma_f32_16x16x32_bf16 a[20:23], v[108:111], v[188:191], a[20:23]
  v_mfma_f32_16x16x32_bf16 a[24:27], v[108:111], v[192:195], a[24:27]
  v_mfma_f32_16x16x32_bf16 a[28:31], v[108:111], v[196:199], a[28:31]
  v_mfma_f32_16x16x32_bf16 a[32:35], v[112:115], v[184:187], a[32:35]
  v_mfma_f32_16x16x32_bf16 a[36:39], v[112:115], v[188:191], a[36:39]
  v_mfma_f32_16x16x32_bf16 a[40:43], v[112:115], v[192:195], a[40:43]
  v_mfma_f32_16x16x32_bf16 a[44:47], v[112:115], v[196:199], a[44:47]
  v_mfma_f32_16x16x32_bf16 a[48:51], v[116:119], v[184:187], a[48:51]
  v_mfma_f32_16x16x32_bf16 a[52:55], v[116:119], v[188:191], a[52:55]
  v_mfma_f32_16x16x32_bf16 a[56:59], v[116:119], v[192:195], a[56:59]
  v_mfma_f32_16x16x32_bf16 a[60:63], v[116:119], v[196:199], a[60:63]
  v_mfma_f32_16x16x32_bf16 a[64:67], v[120:123], v[184:187], a[64:67]
  v_mfma_f32_16x16x32_bf16 a[68:71], v[120:123], v[188:191], a[68:71]
  v_mfma_f32_16x16x32_bf16 a[72:75], v[120:123], v[192:195], a[72:75]
  v_mfma_f32_16x16x32_bf16 a[76:79], v[120:123], v[196:199], a[76:79]
  v_mfma_f32_16x16x32_bf16 a[80:83], v[124:127], v[184:187], a[80:83]
  v_mfma_f32_16x16x32_bf16 a[84:87], v[124:127], v[188:191], a[84:87]
  v_mfma_f32_16x16x32_bf16 a[88:91], v[124:127], v[192:195], a[88:91]
  v_mfma_f32_16x16x32_bf16 a[92:95], v[124:127], v[196:199], a[92:95]
  v_mfma_f32_16x16x32_bf16 a[96:99], v[128:131], v[184:187], a[96:99]
  v_mfma_f32_16x16x32_bf16 a[100:103], v[128:131], v[188:191], a[100:103]
  v_mfma_f32_16x16x32_bf16 a[104:107], v[128:131], v[192:195], a[104:107]
  v_mfma_f32_16x16x32_bf16 a[108:111], v[128:131], v[196:199], a[108:111]
  v_mfma_f32_16x16x32_bf16 a[112:115], v[132:135], v[184:187], a[112:115]
  v_mfma_f32_16x16x32_bf16 a[116:119], v[132:135], v[188:191], a[116:119]
  v_mfma_f32_16x16x32_bf16 a[120:123], v[132:135], v[192:195], a[120:123]
  v_mfma_f32_16x16x32_bf16 a[124:127], v[132:135], v[196:199], a[124:127]
  v_mfma_f32_16x16x32_bf16 a[128:131], v[136:139], v[184:187], a[128:131]
  v_mfma_f32_16x16x32_bf16 a[132:135], v[136:139], v[188:191], a[132:135]
  v_mfma_f32_16x16x32_bf16 a[136:139], v[136:139], v[192:195], a[136:139]
  v_mfma_f32_16x16x32_bf16 a[140:143], v[136:139], v[196:199], a[140:143]
  v_mfma_f32_16x16x32_bf16 a[144:147], v[140:143], v[184:187], a[144:147]
  v_mfma_f32_16x16x32_bf16 a[148:151], v[140:143], v[188:191], a[148:151]
  v_mfma_f32_16x16x32_bf16 a[152:155], v[140:143], v[192:195], a[152:155]
  v_mfma_f32_16x16x32_bf16 a[156:159], v[140:143], v[196:199], a[156:159]
  buffer_load_dwordx4 v[104:107], v1, s[4:7], s30 offen offset:2048
  buffer_load_dwordx4 v[108:111], v1, s[4:7], s31 offen offset:2048
  buffer_load_dwordx4 v[112:115], v1, s[4:7], s32 offen offset:2048
  buffer_load_dwordx4 v[116:119], v1, s[4:7], s33 offen offset:2048
  buffer_load_dwordx4 v[120:123], v1, s[4:7], s34 offen offset:2048
  buffer_load_dwordx4 v[124:127], v1, s[4:7], s35 offen offset:2048
  buffer_load_dwordx4 v[128:131], v1, s[4:7], s36 offen offset:2048
  buffer_load_dwordx4 v[132:135], v1, s[4:7], s37 offen offset:2048
  buffer_load_dwordx4 v[136:139], v1, s[4:7], s38 offen offset:2048
  buffer_load_dwordx4 v[140:143], v1, s[4:7], s39 offen offset:2048
  s_waitcnt vmcnt(30)
  ds_read_b128 v[184:187], v1 offset:20480
  ds_read_b128 v[188:191], v1 offset:45056
  ds_read_b128 v[192:195], v6 offset:20480
  ds_read_b128 v[196:199], v6 offset:45056
  s_waitcnt lgkmcnt(4)
  v_mfma_f32_16x16x32_bf16 a[0:3], v[144:147], v[200:203], a[0:3]
  v_mfma_f32_16x16x32_bf16 a[4:7], v[144:147], v[204:207], a[4:7]
  v_mfma_f32_16x16x32_bf16 a[8:11], v[144:147], v[208:211], a[8:11]
  v_mfma_f32_16x16x32_bf16 a[12:15], v[144:147], v[212:215], a[12:15]
  v_mfma_f32_16x16x32_bf16 a[16:19], v[148:151], v[200:203], a[16:19]
  v_mfma_f32_16x16x32_bf16 a[20:23], v[148:151], v[204:207], a[20:23]
  v_mfma_f32_16x16x32_bf16 a[24:27], v[148:151], v[208:211], a[24:27]
  v_mfma_f32_16x16x32_bf16 a[28:31], v[148:151], v[212:215], a[28:31]
  v_mfma_f32_16x16x32_bf16 a[32:35], v[152:155], v[200:203], a[32:35]
  v_mfma_f32_16x16x32_bf16 a[36:39], v[152:155], v[204:207], a[36:39]
  v_mfma_f32_16x16x32_bf16 a[40:43], v[152:155], v[208:211], a[40:43]
  v_mfma_f32_16x16x32_bf16 a[44:47], v[152:155], v[212:215], a[44:47]
  v_mfma_f32_16x16x32_bf16 a[48:51], v[156:159], v[200:203], a[48:51]
  v_mfma_f32_16x16x32_bf16 a[52:55], v[156:159], v[204:207], a[52:55]
  v_mfma_f32_16x16x32_bf16 a[56:59], v[156:159], v[208:211], a[56:59]
  v_mfma_f32_16x16x32_bf16 a[60:63], v[156:159], v[212:215], a[60:63]
  v_mfma_f32_16x16x32_bf16 a[64:67], v[160:163], v[200:203], a[64:67]
  v_mfma_f32_16x16x32_bf16 a[68:71], v[160:163], v[204:207], a[68:71]
  v_mfma_f32_16x16x32_bf16 a[72:75], v[160:163], v[208:211], a[72:75]
  v_mfma_f32_16x16x32_bf16 a[76:79], v[160:163], v[212:215], a[76:79]
  v_mfma_f32_16x16x32_bf16 a[80:83], v[164:167], v[200:203], a[80:83]
  v_mfma_f32_16x16x32_bf16 a[84:87], v[164:167], v[204:207], a[84:87]
  v_mfma_f32_16x16x32_bf16 a[88:91], v[164:167], v[208:211], a[88:91]
  v_mfma_f32_16x16x32_bf16 a[92:95], v[164:167], v[212:215], a[92:95]
  v_mfma_f32_16x16x32_bf16 a[96:99], v[168:171], v[200:203], a[96:99]
  v_mfma_f32_16x16x32_bf16 a[100:103], v[168:171], v[204:207], a[100:103]
  v_mfma_f32_16x16x32_bf16 a[104:107], v[168:171], v[208:211], a[104:107]
  v_mfma_f32_16x16x32_bf16 a[108:111], v[168:171], v[212:215], a[108:111]
  v_mfma_f32_16x16x32_bf16 a[112:115], v[172:175], v[200:203], a[112:115]
  v_mfma_f32_16x16x32_bf16 a[116:119], v[172:175], v[204:207], a[116:119]
  v_mfma_f32_16x16x32_bf16 a[120:123], v[172:175], v[208:211], a[120:123]
  v_mfma_f32_16x16x32_bf16 a[124:127], v[172:175], v[212:215], a[124:127]
  v_mfma_f32_16x16x32_bf16 a[128:131], v[176:179], v[200:203], a[128:131]
  v_mfma_f32_16x16x32_bf16 a[132:135], v[176:179], v[204:207], a[132:135]
  v_mfma_f32_16x16x32_bf16 a[136:139], v[176:179], v[208:211], a[136:139]
  v_mfma_f32_16x16x32_bf16 a[140:143], v[176:179], v[212:215], a[140:143]
  v_mfma_f32_16x16x32_bf16 a[144:147], v[180:183], v[200:203], a[144:147]
  v_mfma_f32_16x16x32_bf16 a[148:151], v[180:183], v[204:207], a[148:151]
  v_mfma_f32_16x16x32_bf16 a[152:155], v[180:183], v[208:211], a[152:155]
  v_mfma_f32_16x16x32_bf16 a[156:159], v[180:183], v[212:215], a[156:159]
  buffer_load_dwordx4 v[144:147], v1, s[4:7], s30 offen offset:3072
  buffer_load_dwordx4 v[148:151], v1, s[4:7], s31 offen offset:3072
  buffer_load_dwordx4 v[152:155], v1, s[4:7], s32 offen offset:3072
  buffer_load_dwordx4 v[156:159], v1, s[4:7], s33 offen offset:3072
  buffer_load_dwordx4 v[160:163], v1, s[4:7], s34 offen offset:3072
  buffer_load_dwordx4 v[164:167], v1, s[4:7], s35 offen offset:3072
  buffer_load_dwordx4 v[168:171], v1, s[4:7], s36 offen offset:3072
  buffer_load_dwordx4 v[172:175], v1, s[4:7], s37 offen offset:3072
  buffer_load_dwordx4 v[176:179], v1, s[4:7], s38 offen offset:3072
  buffer_load_dwordx4 v[180:183], v1, s[4:7], s39 offen offset:3072
  s_add_u32 s30, s30, 4096
  s_add_u32 s31, s31, 4096
  s_add_u32 s32, s32, 4096
  s_add_u32 s33, s33, 4096
  s_add_u32 s34, s34, 4096
  s_add_u32 s35, s35, 4096
  s_add_u32 s36, s36, 4096
  s_add_u32 s37, s37, 4096
  s_add_u32 s38, s38, 4096
  s_add_u32 s39, s39, 4096
  s_waitcnt vmcnt(30)
  ds_read_b128 v[200:203], v1 offset:21504
  ds_read_b128 v[204:207], v1 offset:46080
  ds_read_b128 v[208:211], v6 offset:21504
  ds_read_b128 v[212:215], v6 offset:46080
  s_waitcnt lgkmcnt(4)
  v_mfma_f32_16x16x32_bf16 a[0:3], v[24:27], v[184:187], a[0:3]
  v_mfma_f32_16x16x32_bf16 a[4:7], v[24:27], v[188:191], a[4:7]
  v_mfma_f32_16x16x32_bf16 a[8:11], v[24:27], v[192:195], a[8:11]
  v_mfma_f32_16x16x32_bf16 a[12:15], v[24:27], v[196:199], a[12:15]
  v_mfma_f32_16x16x32_bf16 a[16:19], v[28:31], v[184:187], a[16:19]
  v_mfma_f32_16x16x32_bf16 a[20:23], v[28:31], v[188:191], a[20:23]
  v_mfma_f32_16x16x32_bf16 a[24:27], v[28:31], v[192:195], a[24:27]
  v_mfma_f32_16x16x32_bf16 a[28:31], v[28:31], v[196:199], a[28:31]
  v_mfma_f32_16x16x32_bf16 a[32:35], v[32:35], v[184:187], a[32:35]
  v_mfma_f32_16x16x32_bf16 a[36:39], v[32:35], v[188:191], a[36:39]
  v_mfma_f32_16x16x32_bf16 a[40:43], v[32:35], v[192:195], a[40:43]
  v_mfma_f32_16x16x32_bf16 a[44:47], v[32:35], v[196:199], a[44:47]
  v_mfma_f32_16x16x32_bf16 a[48:51], v[36:39], v[184:187], a[48:51]
  v_mfma_f32_16x16x32_bf16 a[52:55], v[36:39], v[188:191], a[52:55]
  v_mfma_f32_16x16x32_bf16 a[56:59], v[36:39], v[192:195], a[56:59]
  v_mfma_f32_16x16x32_bf16 a[60:63], v[36:39], v[196:199], a[60:63]
  v_mfma_f32_16x16x32_bf16 a[64:67], v[40:43], v[184:187], a[64:67]
  v_mfma_f32_16x16x32_bf16 a[68:71], v[40:43], v[188:191], a[68:71]
  v_mfma_f32_16x16x32_bf16 a[72:75], v[40:43], v[192:195], a[72:75]
  v_mfma_f32_16x16x32_bf16 a[76:79], v[40:43], v[196:199], a[76:79]
  v_mfma_f32_16x16x32_bf16 a[80:83], v[44:47], v[184:187], a[80:83]
  v_mfma_f32_16x16x32_bf16 a[84:87], v[44:47], v[188:191], a[84:87]
  v_mfma_f32_16x16x32_bf16 a[88:91], v[44:47], v[192:195], a[88:91]
  v_mfma_f32_16x16x32_bf16 a[92:95], v[44:47], v[196:199], a[92:95]
  v_mfma_f32_16x16x32_bf16 a[96:99], v[48:51], v[184:187], a[96:99]
  v_mfma_f32_16x16x32_bf16 a[100:103], v[48:51], v[188:191], a[100:103]
  v_mfma_f32_16x16x32_bf16 a[104:107], v[48:51], v[192:195], a[104:107]
  v_mfma_f32_16x16x32_bf16 a[108:111], v[48:51], v[196:199], a[108:111]
  v_mfma_f32_16x16x32_bf16 a[112:115], v[52:55], v[184:187], a[112:115]
  v_mfma_f32_16x16x32_bf16 a[116:119], v[52:55], v[188:191], a[116:119]
  v_mfma_f32_16x16x32_bf16 a[120:123], v[52:55], v[192:195], a[120:123]
  v_mfma_f32_16x16x32_bf16 a[124:127], v[52:55], v[196:199], a[124:127]
  v_mfma_f32_16x16x32_bf16 a[128:131], v[56:59], v[184:187], a[128:131]
  v_mfma_f32_16x16x32_bf16 a[132:135], v[56:59], v[188:191], a[132:135]
  v_mfma_f32_16x16x32_bf16 a[136:139], v[56:59], v[192:195], a[136:139]
  v_mfma_f32_16x16x32_bf16 a[140:143], v[56:59], v[196:199], a[140:143]
  v_mfma_f32_16x16x32_bf16 a[144:147], v[60:63], v[184:187], a[144:147]
  v_mfma_f32_16x16x32_bf16 a[148:151], v[60:63], v[188:191], a[148:151]
  v_mfma_f32_16x16x32_bf16 a[152:155], v[60:63], v[192:195], a[152:155]
  v_mfma_f32_16x16x32_bf16 a[156:159], v[60:63], v[196:199], a[156:159]
  s_waitcnt vmcnt(20)
  ds_read_b128 v[184:187], v1 offset:22528
  ds_read_b128 v[188:191], v1 offset:47104
  ds_read_b128 v[192:195], v6 offset:22528
  ds_read_b128 v[196:199], v6 offset:47104
  s_waitcnt lgkmcnt(4)
  v_mfma_f32_16x16x32_bf16 a[0:3], v[64:67], v[200:203], a[0:3]
  v_mfma_f32_16x16x32_bf16 a[4:7], v[64:67], v[204:207], a[4:7]
  v_mfma_f32_16x16x32_bf16 a[8:11], v[64:67], v[208:211], a[8:11]
  v_mfma_f32_16x16x32_bf16 a[12:15], v[64:67], v[212:215], a[12:15]
  v_mfma_f32_16x16x32_bf16 a[16:19], v[68:71], v[200:203], a[16:19]
  v_mfma_f32_16x16x32_bf16 a[20:23], v[68:71], v[204:207], a[20:23]
  v_mfma_f32_16x16x32_bf16 a[24:27], v[68:71], v[208:211], a[24:27]
  v_mfma_f32_16x16x32_bf16 a[28:31], v[68:71], v[212:215], a[28:31]
  v_mfma_f32_16x16x32_bf16 a[32:35], v[72:75], v[200:203], a[32:35]
  v_mfma_f32_16x16x32_bf16 a[36:39], v[72:75], v[204:207], a[36:39]
  v_mfma_f32_16x16x32_bf16 a[40:43], v[72:75], v[208:211], a[40:43]
  v_mfma_f32_16x16x32_bf16 a[44:47], v[72:75], v[212:215], a[44:47]
  v_mfma_f32_16x16x32_bf16 a[48:51], v[76:79], v[200:203], a[48:51]
  v_mfma_f32_16x16x32_bf16 a[52:55], v[76:79], v[204:207], a[52:55]
  v_mfma_f32_16x16x32_bf16 a[56:59], v[76:79], v[208:211], a[56:59]
  v_mfma_f32_16x16x32_bf16 a[60:63], v[76:79], v[212:215], a[60:63]
  v_mfma_f32_16x16x32_bf16 a[64:67], v[80:83], v[200:203], a[64:67]
  v_mfma_f32_16x16x32_bf16 a[68:71], v[80:83], v[204:207], a[68:71]
  v_mfma_f32_16x16x32_bf16 a[72:75], v[80:83], v[208:211], a[72:75]
  v_mfma_f32_16x16x32_bf16 a[76:79], v[80:83], v[212:215], a[76:79]
  v_mfma_f32_16x16x32_bf16 a[80:83], v[84:87], v[200:203], a[80:83]
  v_mfma_f32_16x16x32_bf16 a[84:87], v[84:87], v[204:207], a[84:87]
  v_mfma_f32_16x16x32_bf16 a[88:91], v[84:87], v[208:211], a[88:91]
  v_mfma_f32_16x16x32_bf16 a[92:95], v[84:87], v[212:215], a[92:95]
  v_mfma_f32_16x16x32_bf16 a[96:99], v[88:91], v[200:203], a[96:99]
  v_mfma_f32_16x16x32_bf16 a[100:103], v[88:91], v[204:207], a[100:103]
  v_mfma_f32_16x16x32_bf16 a[104:107], v[88:91], v[208:211], a[104:107]
  v_mfma_f32_16x16x32_bf16 a[108:111], v[88:91], v[212:215], a[108:111]
  v_mfma_f32_16x16x32_bf16 a[112:115], v[92:95], v[200:203], a[112:115]
  v_mfma_f32_16x16x32_bf16 a[116:119], v[92:95], v[204:207], a[116:119]
  v_mfma_f32_16x16x32_bf16 a[120:123], v[92:95], v[208:211], a[120:123]
  v_mfma_f32_16x16x32_bf16 a[124:127], v[92:95], v[212:215], a[124:127]
  v_mfma_f32_16x16x32_bf16 a[128:131], v[96:99], v[200:203], a[128:131]
  v_mfma_f32_16x16x32_bf16 a[132:135], v[96:99], v[204:207], a[132:135]
  v_mfma_f32_16x16x32_bf16 a[136:139], v[96:99], v[208:211], a[136:139]
  v_mfma_f32_16x16x32_bf16 a[140:143], v[96:99], v[212:215], a[140:143]
  v_mfma_f32_16x16x32_bf16 a[144:147], v[100:103], v[200:203], a[144:147]
  v_mfma_f32_16x16x32_bf16 a[148:151], v[100:103], v[204:207], a[148:151]
  v_mfma_f32_16x16x32_bf16 a[152:155], v[100:103], v[208:211], a[152:155]
  v_mfma_f32_16x16x32_bf16 a[156:159], v[100:103], v[212:215], a[156:159]
  s_waitcnt vmcnt(10)
  ds_read_b128 v[200:203], v1 offset:23552
  ds_read_b128 v[204:207], v1 offset:48128
  ds_read_b128 v[208:211], v6 offset:23552
  ds_read_b128 v[212:215], v6 offset:48128
  s_waitcnt lgkmcnt(4)
  v_mfma_f32_16x16x32_bf16 a[0:3], v[104:107], v[184:187], a[0:3]
  v_mfma_f32_16x16x32_bf16 a[4:7], v[104:107], v[188:191], a[4:7]
  v_mfma_f32_16x16x32_bf16 a[8:11], v[104:107], v[192:195], a[8:11]
  v_mfma_f32_16x16x32_bf16 a[12:15], v[104:107], v[196:199], a[12:15]
  v_mfma_f32_16x16x32_bf16 a[16:19], v[108:111], v[184:187], a[16:19]
  v_mfma_f32_16x16x32_bf16 a[20:23], v[108:111], v[188:191], a[20:23]
  v_mfma_f32_16x16x32_bf16 a[24:27], v[108:111], v[192:195], a[24:27]
  v_mfma_f32_16x16x32_bf16 a[28:31], v[108:111], v[196:199], a[28:31]
  v_mfma_f32_16x16x32_bf16 a[32:35], v[112:115], v[184:187], a[32:35]
  v_mfma_f32_16x16x32_bf16 a[36:39], v[112:115], v[188:191], a[36:39]
  v_mfma_f32_16x16x32_bf16 a[40:43], v[112:115], v[192:195], a[40:43]
  v_mfma_f32_16x16x32_bf16 a[44:47], v[112:115], v[196:199], a[44:47]
  v_mfma_f32_16x16x32_bf16 a[48:51], v[116:119], v[184:187], a[48:51]
  v_mfma_f32_16x16x32_bf16 a[52:55], v[116:119], v[188:191], a[52:55]
  v_mfma_f32_16x16x32_bf16 a[56:59], v[116:119], v[192:195], a[56:59]
  v_mfma_f32_16x16x32_bf16 a[60:63], v[116:119], v[196:199], a[60:63]
  v_mfma_f32_16x16x32_bf16 a[64:67], v[120:123], v[184:187], a[64:67]
  v_mfma_f32_16x16x32_bf16 a[68:71], v[120:123], v[188:191], a[68:71]
  v_mfma_f32_16x16x32_bf16 a[72:75], v[120:123], v[192:195], a[72:75]
  v_mfma_f32_16x16x32_bf16 a[76:79], v[120:123], v[196:199], a[76:79]
  v_mfma_f32_16x16x32_bf16 a[80:83], v[124:127], v[184:187], a[80:83]
  v_mfma_f32_16x16x32_bf16 a[84:87], v[124:127], v[188:191], a[84:87]
  v_mfma_f32_16x16x32_bf16 a[88:91], v[124:127], v[192:195], a[88:91]
  v_mfma_f32_16x16x32_bf16 a[92:95], v[124:127], v[196:199], a[92:95]
  v_mfma_f32_16x16x32_bf16 a[96:99], v[128:131], v[184:187], a[96:99]
  v_mfma_f32_16x16x32_bf16 a[100:103], v[128:131], v[188:191], a[100:103]
  v_mfma_f32_16x16x32_bf16 a[104:107], v[128:131], v[192:195], a[104:107]
  v_mfma_f32_16x16x32_bf16 a[108:111], v[128:131], v[196:199], a[108:111]
  v_mfma_f32_16x16x32_bf16 a[112:115], v[132:135], v[184:187], a[112:115]
  v_mfma_f32_16x16x32_bf16 a[116:119], v[132:135], v[188:191], a[116:119]
  v_mfma_f32_16x16x32_bf16 a[120:123], v[132:135], v[192:195], a[120:123]
  v_mfma_f32_16x16x32_bf16 a[124:127], v[132:135], v[196:199], a[124:127]
  v_mfma_f32_16x16x32_bf16 a[128:131], v[136:139], v[184:187], a[128:131]
  v_mfma_f32_16x16x32_bf16 a[132:135], v[136:139], v[188:191], a[132:135]
  v_mfma_f32_16x16x32_bf16 a[136:139], v[136:139], v[192:195], a[136:139]
  v_mfma_f32_16x16x32_bf16 a[140:143], v[136:139], v[196:199], a[140:143]
  v_mfma_f32_16x16x32_bf16 a[144:147], v[140:143], v[184:187], a[144:147]
  v_mfma_f32_16x16x32_bf16 a[148:151], v[140:143], v[188:191], a[148:151]
  v_mfma_f32_16x16x32_bf16 a[152:155], v[140:143], v[192:195], a[152:155]
  v_mfma_f32_16x16x32_bf16 a[156:159], v[140:143], v[196:199], a[156:159]
  s_waitcnt vmcnt(0)
  s_waitcnt lgkmcnt(0)
  v_mfma_f32_16x16x32_bf16 a[0:3], v[144:147], v[200:203], a[0:3]
  v_mfma_f32_16x16x32_bf16 a[4:7], v[144:147], v[204:207], a[4:7]
  v_mfma_f32_16x16x32_bf16 a[8:11], v[144:147], v[208:211], a[8:11]
  v_mfma_f32_16x16x32_bf16 a[12:15], v[144:147], v[212:215], a[12:15]
  v_mfma_f32_16x16x32_bf16 a[16:19], v[148:151], v[200:203], a[16:19]
  v_mfma_f32_16x16x32_bf16 a[20:23], v[148:151], v[204:207], a[20:23]
  v_mfma_f32_16x16x32_bf16 a[24:27], v[148:151], v[208:211], a[24:27]
  v_mfma_f32_16x16x32_bf16 a[28:31], v[148:151], v[212:215], a[28:31]
  v_mfma_f32_16x16x32_bf16 a[32:35], v[152:155], v[200:203], a[32:35]
  v_mfma_f32_16x16x32_bf16 a[36:39], v[152:155], v[204:207], a[36:39]
  v_mfma_f32_16x16x32_bf16 a[40:43], v[152:155], v[208:211], a[40:43]
  v_mfma_f32_16x16x32_bf16 a[44:47], v[152:155], v[212:215], a[44:47]
  v_mfma_f32_16x16x32_bf16 a[48:51], v[156:159], v[200:203], a[48:51]
  v_mfma_f32_16x16x32_bf16 a[52:55], v[156:159], v[204:207], a[52:55]
  v_mfma_f32_16x16x32_bf16 a[56:59], v[156:159], v[208:211], a[56:59]
  v_mfma_f32_16x16x32_bf16 a[60:63], v[156:159], v[212:215], a[60:63]
  v_mfma_f32_16x16x32_bf16 a[64:67], v[160:163], v[200:203], a[64:67]
  v_mfma_f32_16x16x32_bf16 a[68:71], v[160:163], v[204:207], a[68:71]
  v_mfma_f32_16x16x32_bf16 a[72:75], v[160:163], v[208:211], a[72:75]
  v_mfma_f32_16x16x32_bf16 a[76:79], v[160:163], v[212:215], a[76:79]
  v_mfma_f32_16x16x32_bf16 a[80:83], v[164:167], v[200:203], a[80:83]
  v_mfma_f32_16x16x32_bf16 a[84:87], v[164:167], v[204:207], a[84:87]
  v_mfma_f32_16x16x32_bf16 a[88:91], v[164:167], v[208:211], a[88:91]
  v_mfma_f32_16x16x32_bf16 a[92:95], v[164:167], v[212:215], a[92:95]
  v_mfma_f32_16x16x32_bf16 a[96:99], v[168:171], v[200:203], a[96:99]
  v_mfma_f32_16x16x32_bf16 a[100:103], v[168:171], v[204:207], a[100:103]
  v_mfma_f32_16x16x32_bf16 a[104:107], v[168:171], v[208:211], a[104:107]
  v_mfma_f32_16x16x32_bf16 a[108:111], v[168:171], v[212:215], a[108:111]
  v_mfma_f32_16x16x32_bf16 a[112:115], v[172:175], v[200:203], a[112:115]
  v_mfma_f32_16x16x32_bf16 a[116:119], v[172:175], v[204:207], a[116:119]
  v_mfma_f32_16x16x32_bf16 a[120:123], v[172:175], v[208:211], a[120:123]
  v_mfma_f32_16x16x32_bf16 a[124:127], v[172:175], v[212:215], a[124:127]
  v_mfma_f32_16x16x32_bf16 a[128:131], v[176:179], v[200:203], a[128:131]
  v_mfma_f32_16x16x32_bf16 a[132:135], v[176:179], v[204:207], a[132:135]
  v_mfma_f32_16x16x32_bf16 a[136:139], v[176:179], v[208:211], a[136:139]
  v_mfma_f32_16x16x32_bf16 a[140:143], v[176:179], v[212:215], a[140:143]
  v_mfma_f32_16x16x32_bf16 a[144:147], v[180:183], v[200:203], a[144:147]
  v_mfma_f32_16x16x32_bf16 a[148:151], v[180:183], v[204:207], a[148:151]
  v_mfma_f32_16x16x32_bf16 a[152:155], v[180:183], v[208:211], a[152:155]
  v_mfma_f32_16x16x32_bf16 a[156:159], v[180:183], v[212:215], a[156:159]
  s_lshl_b32 s16, s13, 7
  s_lshl_b32 s17, s14, 2
  s_add_u32 s16, s16, s17
  s_mul_i32 s16, s16, 20
  s_mul_i32 s17, s12, 5
  s_add_u32 s16, s16, s17
  s_lshl_b32 s16, s16, 10
  s_add_u32 s16, s16, 90832896
  s_nop 7
  s_add_u32 s17, s16, 0
  v_accvgpr_read_b32 v24, a0
  v_accvgpr_read_b32 v25, a1
  v_accvgpr_read_b32 v26, a2
  v_accvgpr_read_b32 v27, a3
  v_accvgpr_read_b32 v28, a16
  v_accvgpr_read_b32 v29, a17
  v_accvgpr_read_b32 v30, a18
  v_accvgpr_read_b32 v31, a19
  v_cvt_pk_bf16_f32 v32, v24, v25
  v_cvt_pk_bf16_f32 v33, v26, v27
  v_cvt_pk_bf16_f32 v34, v28, v29
  v_cvt_pk_bf16_f32 v35, v30, v31
  buffer_store_dwordx4 v[32:35], v1, s[4:7], s17 offen offset:0 sc1
  v_accvgpr_read_b32 v36, a32
  v_accvgpr_read_b32 v37, a33
  v_accvgpr_read_b32 v38, a34
  v_accvgpr_read_b32 v39, a35
  v_accvgpr_read_b32 v40, a48
  v_accvgpr_read_b32 v41, a49
  v_accvgpr_read_b32 v42, a50
  v_accvgpr_read_b32 v43, a51
  v_cvt_pk_bf16_f32 v44, v36, v37
  v_cvt_pk_bf16_f32 v45, v38, v39
  v_cvt_pk_bf16_f32 v46, v40, v41
  v_cvt_pk_bf16_f32 v47, v42, v43
  buffer_store_dwordx4 v[44:47], v1, s[4:7], s17 offen offset:1024 sc1
  v_accvgpr_read_b32 v48, a64
  v_accvgpr_read_b32 v49, a65
  v_accvgpr_read_b32 v50, a66
  v_accvgpr_read_b32 v51, a67
  v_accvgpr_read_b32 v52, a80
  v_accvgpr_read_b32 v53, a81
  v_accvgpr_read_b32 v54, a82
  v_accvgpr_read_b32 v55, a83
  v_cvt_pk_bf16_f32 v56, v48, v49
  v_cvt_pk_bf16_f32 v57, v50, v51
  v_cvt_pk_bf16_f32 v58, v52, v53
  v_cvt_pk_bf16_f32 v59, v54, v55
  buffer_store_dwordx4 v[56:59], v1, s[4:7], s17 offen offset:2048 sc1
  v_accvgpr_read_b32 v60, a96
  v_accvgpr_read_b32 v61, a97
  v_accvgpr_read_b32 v62, a98
  v_accvgpr_read_b32 v63, a99
  v_accvgpr_read_b32 v64, a112
  v_accvgpr_read_b32 v65, a113
  v_accvgpr_read_b32 v66, a114
  v_accvgpr_read_b32 v67, a115
  v_cvt_pk_bf16_f32 v68, v60, v61
  v_cvt_pk_bf16_f32 v69, v62, v63
  v_cvt_pk_bf16_f32 v70, v64, v65
  v_cvt_pk_bf16_f32 v71, v66, v67
  buffer_store_dwordx4 v[68:71], v1, s[4:7], s17 offen offset:3072 sc1
  v_accvgpr_read_b32 v24, a128
  v_accvgpr_read_b32 v25, a129
  v_accvgpr_read_b32 v26, a130
  v_accvgpr_read_b32 v27, a131
  v_accvgpr_read_b32 v28, a144
  v_accvgpr_read_b32 v29, a145
  v_accvgpr_read_b32 v30, a146
  v_accvgpr_read_b32 v31, a147
  v_cvt_pk_bf16_f32 v32, v24, v25
  v_cvt_pk_bf16_f32 v33, v26, v27
  v_cvt_pk_bf16_f32 v34, v28, v29
  v_cvt_pk_bf16_f32 v35, v30, v31
  s_add_u32 s17, s17, 4096
  buffer_store_dwordx4 v[32:35], v1, s[4:7], s17 offen offset:0 sc1
  s_add_u32 s17, s16, 20480
  v_accvgpr_read_b32 v36, a4
  v_accvgpr_read_b32 v37, a5
  v_accvgpr_read_b32 v38, a6
  v_accvgpr_read_b32 v39, a7
  v_accvgpr_read_b32 v40, a20
  v_accvgpr_read_b32 v41, a21
  v_accvgpr_read_b32 v42, a22
  v_accvgpr_read_b32 v43, a23
  v_cvt_pk_bf16_f32 v44, v36, v37
  v_cvt_pk_bf16_f32 v45, v38, v39
  v_cvt_pk_bf16_f32 v46, v40, v41
  v_cvt_pk_bf16_f32 v47, v42, v43
  buffer_store_dwordx4 v[44:47], v1, s[4:7], s17 offen offset:0 sc1
  v_accvgpr_read_b32 v48, a36
  v_accvgpr_read_b32 v49, a37
  v_accvgpr_read_b32 v50, a38
  v_accvgpr_read_b32 v51, a39
  v_accvgpr_read_b32 v52, a52
  v_accvgpr_read_b32 v53, a53
  v_accvgpr_read_b32 v54, a54
  v_accvgpr_read_b32 v55, a55
  v_cvt_pk_bf16_f32 v56, v48, v49
  v_cvt_pk_bf16_f32 v57, v50, v51
  v_cvt_pk_bf16_f32 v58, v52, v53
  v_cvt_pk_bf16_f32 v59, v54, v55
  buffer_store_dwordx4 v[56:59], v1, s[4:7], s17 offen offset:1024 sc1
  v_accvgpr_read_b32 v60, a68
  v_accvgpr_read_b32 v61, a69
  v_accvgpr_read_b32 v62, a70
  v_accvgpr_read_b32 v63, a71
  v_accvgpr_read_b32 v64, a84
  v_accvgpr_read_b32 v65, a85
  v_accvgpr_read_b32 v66, a86
  v_accvgpr_read_b32 v67, a87
  v_cvt_pk_bf16_f32 v68, v60, v61
  v_cvt_pk_bf16_f32 v69, v62, v63
  v_cvt_pk_bf16_f32 v70, v64, v65
  v_cvt_pk_bf16_f32 v71, v66, v67
  buffer_store_dwordx4 v[68:71], v1, s[4:7], s17 offen offset:2048 sc1
  v_accvgpr_read_b32 v24, a100
  v_accvgpr_read_b32 v25, a101
  v_accvgpr_read_b32 v26, a102
  v_accvgpr_read_b32 v27, a103
  v_accvgpr_read_b32 v28, a116
  v_accvgpr_read_b32 v29, a117
  v_accvgpr_read_b32 v30, a118
  v_accvgpr_read_b32 v31, a119
  v_cvt_pk_bf16_f32 v32, v24, v25
  v_cvt_pk_bf16_f32 v33, v26, v27
  v_cvt_pk_bf16_f32 v34, v28, v29
  v_cvt_pk_bf16_f32 v35, v30, v31
  buffer_store_dwordx4 v[32:35], v1, s[4:7], s17 offen offset:3072 sc1
  v_accvgpr_read_b32 v36, a132
  v_accvgpr_read_b32 v37, a133
  v_accvgpr_read_b32 v38, a134
  v_accvgpr_read_b32 v39, a135
  v_accvgpr_read_b32 v40, a148
  v_accvgpr_read_b32 v41, a149
  v_accvgpr_read_b32 v42, a150
  v_accvgpr_read_b32 v43, a151
  v_cvt_pk_bf16_f32 v44, v36, v37
  v_cvt_pk_bf16_f32 v45, v38, v39
  v_cvt_pk_bf16_f32 v46, v40, v41
  v_cvt_pk_bf16_f32 v47, v42, v43
  s_add_u32 s17, s17, 4096
  buffer_store_dwordx4 v[44:47], v1, s[4:7], s17 offen offset:0 sc1
  s_add_u32 s17, s16, 40960
  v_accvgpr_read_b32 v48, a8
  v_accvgpr_read_b32 v49, a9
  v_accvgpr_read_b32 v50, a10
  v_accvgpr_read_b32 v51, a11
  v_accvgpr_read_b32 v52, a24
  v_accvgpr_read_b32 v53, a25
  v_accvgpr_read_b32 v54, a26
  v_accvgpr_read_b32 v55, a27
  v_cvt_pk_bf16_f32 v56, v48, v49
  v_cvt_pk_bf16_f32 v57, v50, v51
  v_cvt_pk_bf16_f32 v58, v52, v53
  v_cvt_pk_bf16_f32 v59, v54, v55
  buffer_store_dwordx4 v[56:59], v1, s[4:7], s17 offen offset:0 sc1
  v_accvgpr_read_b32 v60, a40
  v_accvgpr_read_b32 v61, a41
  v_accvgpr_read_b32 v62, a42
  v_accvgpr_read_b32 v63, a43
  v_accvgpr_read_b32 v64, a56
  v_accvgpr_read_b32 v65, a57
  v_accvgpr_read_b32 v66, a58
  v_accvgpr_read_b32 v67, a59
  v_cvt_pk_bf16_f32 v68, v60, v61
  v_cvt_pk_bf16_f32 v69, v62, v63
  v_cvt_pk_bf16_f32 v70, v64, v65
  v_cvt_pk_bf16_f32 v71, v66, v67
  buffer_store_dwordx4 v[68:71], v1, s[4:7], s17 offen offset:1024 sc1
  v_accvgpr_read_b32 v24, a72
  v_accvgpr_read_b32 v25, a73
  v_accvgpr_read_b32 v26, a74
  v_accvgpr_read_b32 v27, a75
  v_accvgpr_read_b32 v28, a88
  v_accvgpr_read_b32 v29, a89
  v_accvgpr_read_b32 v30, a90
  v_accvgpr_read_b32 v31, a91
  v_cvt_pk_bf16_f32 v32, v24, v25
  v_cvt_pk_bf16_f32 v33, v26, v27
  v_cvt_pk_bf16_f32 v34, v28, v29
  v_cvt_pk_bf16_f32 v35, v30, v31
  buffer_store_dwordx4 v[32:35], v1, s[4:7], s17 offen offset:2048 sc1
  v_accvgpr_read_b32 v36, a104
  v_accvgpr_read_b32 v37, a105
  v_accvgpr_read_b32 v38, a106
  v_accvgpr_read_b32 v39, a107
  v_accvgpr_read_b32 v40, a120
  v_accvgpr_read_b32 v41, a121
  v_accvgpr_read_b32 v42, a122
  v_accvgpr_read_b32 v43, a123
  v_cvt_pk_bf16_f32 v44, v36, v37
  v_cvt_pk_bf16_f32 v45, v38, v39
  v_cvt_pk_bf16_f32 v46, v40, v41
  v_cvt_pk_bf16_f32 v47, v42, v43
  buffer_store_dwordx4 v[44:47], v1, s[4:7], s17 offen offset:3072 sc1
  v_accvgpr_read_b32 v48, a136
  v_accvgpr_read_b32 v49, a137
  v_accvgpr_read_b32 v50, a138
  v_accvgpr_read_b32 v51, a139
  v_accvgpr_read_b32 v52, a152
  v_accvgpr_read_b32 v53, a153
  v_accvgpr_read_b32 v54, a154
  v_accvgpr_read_b32 v55, a155
  v_cvt_pk_bf16_f32 v56, v48, v49
  v_cvt_pk_bf16_f32 v57, v50, v51
  v_cvt_pk_bf16_f32 v58, v52, v53
  v_cvt_pk_bf16_f32 v59, v54, v55
  s_add_u32 s17, s17, 4096
  buffer_store_dwordx4 v[56:59], v1, s[4:7], s17 offen offset:0 sc1
  s_add_u32 s17, s16, 61440
  v_accvgpr_read_b32 v60, a12
  v_accvgpr_read_b32 v61, a13
  v_accvgpr_read_b32 v62, a14
  v_accvgpr_read_b32 v63, a15
  v_accvgpr_read_b32 v64, a28
  v_accvgpr_read_b32 v65, a29
  v_accvgpr_read_b32 v66, a30
  v_accvgpr_read_b32 v67, a31
  v_cvt_pk_bf16_f32 v68, v60, v61
  v_cvt_pk_bf16_f32 v69, v62, v63
  v_cvt_pk_bf16_f32 v70, v64, v65
  v_cvt_pk_bf16_f32 v71, v66, v67
  buffer_store_dwordx4 v[68:71], v1, s[4:7], s17 offen offset:0 sc1
  v_accvgpr_read_b32 v24, a44
  v_accvgpr_read_b32 v25, a45
  v_accvgpr_read_b32 v26, a46
  v_accvgpr_read_b32 v27, a47
  v_accvgpr_read_b32 v28, a60
  v_accvgpr_read_b32 v29, a61
  v_accvgpr_read_b32 v30, a62
  v_accvgpr_read_b32 v31, a63
  v_cvt_pk_bf16_f32 v32, v24, v25
  v_cvt_pk_bf16_f32 v33, v26, v27
  v_cvt_pk_bf16_f32 v34, v28, v29
  v_cvt_pk_bf16_f32 v35, v30, v31
  buffer_store_dwordx4 v[32:35], v1, s[4:7], s17 offen offset:1024 sc1
  v_accvgpr_read_b32 v36, a76
  v_accvgpr_read_b32 v37, a77
  v_accvgpr_read_b32 v38, a78
  v_accvgpr_read_b32 v39, a79
  v_accvgpr_read_b32 v40, a92
  v_accvgpr_read_b32 v41, a93
  v_accvgpr_read_b32 v42, a94
  v_accvgpr_read_b32 v43, a95
  v_cvt_pk_bf16_f32 v44, v36, v37
  v_cvt_pk_bf16_f32 v45, v38, v39
  v_cvt_pk_bf16_f32 v46, v40, v41
  v_cvt_pk_bf16_f32 v47, v42, v43
  buffer_store_dwordx4 v[44:47], v1, s[4:7], s17 offen offset:2048 sc1
  v_accvgpr_read_b32 v48, a108
  v_accvgpr_read_b32 v49, a109
  v_accvgpr_read_b32 v50, a110
  v_accvgpr_read_b32 v51, a111
  v_accvgpr_read_b32 v52, a124
  v_accvgpr_read_b32 v53, a125
  v_accvgpr_read_b32 v54, a126
  v_accvgpr_read_b32 v55, a127
  v_cvt_pk_bf16_f32 v56, v48, v49
  v_cvt_pk_bf16_f32 v57, v50, v51
  v_cvt_pk_bf16_f32 v58, v52, v53
  v_cvt_pk_bf16_f32 v59, v54, v55
  buffer_store_dwordx4 v[56:59], v1, s[4:7], s17 offen offset:3072 sc1
  v_accvgpr_read_b32 v60, a140
  v_accvgpr_read_b32 v61, a141
  v_accvgpr_read_b32 v62, a142
  v_accvgpr_read_b32 v63, a143
  v_accvgpr_read_b32 v64, a156
  v_accvgpr_read_b32 v65, a157
  v_accvgpr_read_b32 v66, a158
  v_accvgpr_read_b32 v67, a159
  v_cvt_pk_bf16_f32 v68, v60, v61
  v_cvt_pk_bf16_f32 v69, v62, v63
  v_cvt_pk_bf16_f32 v70, v64, v65
  v_cvt_pk_bf16_f32 v71, v66, v67
  s_add_u32 s17, s17, 4096
  buffer_store_dwordx4 v[68:71], v1, s[4:7], s17 offen offset:0 sc1
fin_exit1:
  s_endpgm
.globl redln1_kernel
.p2align 8
.type redln1_kernel,@function
redln1_kernel:
  s_cmp_ge_u32 s2, 256
  s_cbranch_scc1 redln1_exit1
  s_load_dwordx2 s[12:13], s[0:1], 96
  s_load_dwordx2 s[14:15], s[0:1], 0
  v_lshrrev_b32 v2, 6, v0
  v_and_b32 v3, 63, v0
  s_lshr_b32 s19, s2, 1
  v_readfirstlane_b32 s16, v2
  s_and_b32 s18, s2, 1
  s_waitcnt lgkmcnt(0)
  s_mov_b32 s4, s12
  s_mov_b32 s5, s13
  s_mov_b32 s6, 0x10000000
  s_mov_b32 s7, 0x20000
  s_mov_b32 s8, s14
  s_mov_b32 s9, s15
  s_mov_b32 s10, 2621440
  s_mov_b32 s11, 0x20000
  s_mov_b32 s20, 0
  v_and_b32 v2, 7, v3
  v_bfe_u32 v4, v3, 3, 2
  v_lshrrev_b32 v5, 5, v3
  s_lshl_b32 s17, s18, 7
  v_lshlrev_b32 v14, 4, v2
  v_lshl_add_u32 v14, v4, 8, v14
  v_lshl_add_u32 v14, v5, 10, v14
  v_add_u32 v14, s17, v14
  s_lshl_b32 s17, s2, 3
  v_add_u32 v15, s17, v2
  v_mul_u32_u24 v15, 1280, v15
  v_lshl_add_u32 v15, v4, 4, v15
  v_lshl_add_u32 v15, v5, 6, v15
  s_mul_i32 s17, s16, 640
  s_add_u32 s20, s20, s17
  s_add_u32 s21, s17, 82313216
  s_mul_i32 s22, s19, 20
  s_mul_i32 s23, s16, 10
  s_add_u32 s22, s22, s23
  s_lshl_b32 s22, s22, 10
  s_add_u32 s34, s22, 54525952
  s_add_u32 s22, s22, 90832896
  s_add_u32 s24, s22, 0
  s_add_u32 s25, s22, 2621440
  s_add_u32 s26, s22, 5242880
  s_add_u32 s27, s22, 7864320
  s_add_u32 s28, s22, 10485760
  s_add_u32 s29, s22, 13107200
  s_add_u32 s30, s22, 15728640
  s_add_u32 s31, s22, 18350080
  v_add_u32 v6, 0x1000, v14
  v_add_u32 v7, 0x2000, v14
  buffer_load_dwordx4 v[16:19], v15, s[8:11], s20 offen offset:0
  buffer_load_dwordx4 v[20:23], v15, s[8:11], s20 offen offset:128
  buffer_load_dwordx4 v[24:27], v15, s[8:11], s20 offen offset:256
  buffer_load_dwordx4 v[28:31], v15, s[8:11], s20 offen offset:384
  buffer_load_dwordx4 v[32:35], v15, s[8:11], s20 offen offset:512
  buffer_load_dwordx4 v[80:83], v14, s[4:7], s24 offen offset:0
  buffer_load_dwordx4 v[84:87], v14, s[4:7], s25 offen offset:0
  buffer_load_dwordx4 v[88:91], v14, s[4:7], s26 offen offset:0
  buffer_load_dwordx4 v[92:95], v14, s[4:7], s27 offen offset:0
  buffer_load_dwordx4 v[96:99], v14, s[4:7], s28 offen offset:0
  buffer_load_dwordx4 v[100:103], v14, s[4:7], s29 offen offset:0
  buffer_load_dwordx4 v[104:107], v14, s[4:7], s30 offen offset:0
  buffer_load_dwordx4 v[108:111], v14, s[4:7], s31 offen offset:0
  buffer_load_dwordx4 v[112:115], v14, s[4:7], s24 offen offset:2048
  buffer_load_dwordx4 v[116:119], v14, s[4:7], s25 offen offset:2048
  buffer_load_dwordx4 v[120:123], v14, s[4:7], s26 offen offset:2048
  buffer_load_dwordx4 v[124:127], v14, s[4:7], s27 offen offset:2048
  buffer_load_dwordx4 v[128:131], v14, s[4:7], s28 offen offset:2048
  buffer_load_dwordx4 v[132:135], v14, s[4:7], s29 offen offset:2048
  buffer_load_dwordx4 v[136:139], v14, s[4:7], s30 offen offset:2048
  buffer_load_dwordx4 v[140:143], v14, s[4:7], s31 offen offset:2048
  buffer_load_dwordx4 v[144:147], v6, s[4:7], s24 offen offset:0
  buffer_load_dwordx4 v[148:151], v6, s[4:7], s25 offen offset:0
  buffer_load_dwordx4 v[152:155], v6, s[4:7], s26 offen offset:0
  buffer_load_dwordx4 v[156:159], v6, s[4:7], s27 offen offset:0
  buffer_load_dwordx4 v[160:163], v6, s[4:7], s28 offen offset:0
  buffer_load_dwordx4 v[164:167], v6, s[4:7], s29 offen offset:0
  buffer_load_dwordx4 v[168:171], v6, s[4:7], s30 offen offset:0
  buffer_load_dwordx4 v[172:175], v6, s[4:7], s31 offen offset:0
  buffer_load_dwordx4 v[176:179], v6, s[4:7], s24 offen offset:2048
  buffer_load_dwordx4 v[180:183], v6, s[4:7], s25 offen offset:2048
  buffer_load_dwordx4 v[184:187], v6, s[4:7], s26 offen offset:2048
  buffer_load_dwordx4 v[188:191], v6, s[4:7], s27 offen offset:2048
  buffer_load_dwordx4 v[192:195], v6, s[4:7], s28 offen offset:2048
  buffer_load_dwordx4 v[196:199], v6, s[4:7], s29 offen offset:2048
  buffer_load_dwordx4 v[200:203], v6, s[4:7], s30 offen offset:2048
  buffer_load_dwordx4 v[204:207], v6, s[4:7], s31 offen offset:2048
  buffer_load_dwordx4 v[208:211], v7, s[4:7], s24 offen offset:0
  buffer_load_dwordx4 v[212:215], v7, s[4:7], s25 offen offset:0
  buffer_load_dwordx4 v[216:219], v7, s[4:7], s26 offen offset:0
  buffer_load_dwordx4 v[220:223], v7, s[4:7], s27 offen offset:0
  buffer_load_dwordx4 v[224:227], v7, s[4:7], s28 offen offset:0
  buffer_load_dwordx4 v[228:231], v7, s[4:7], s29 offen offset:0
  buffer_load_dwordx4 v[232:235], v7, s[4:7], s30 offen offset:0
  buffer_load_dwordx4 v[236:239], v7, s[4:7], s31 offen offset:0
  s_waitcnt vmcnt(32)
  v_lshlrev_b32 v36, 16, v80
  v_and_b32 v37, 0xffff0000, v80
  v_lshlrev_b32 v38, 16, v81
  v_and_b32 v39, 0xffff0000, v81
  v_lshlrev_b32 v40, 16, v82
  v_and_b32 v41, 0xffff0000, v82
  v_lshlrev_b32 v42, 16, v83
  v_and_b32 v43, 0xffff0000, v83
  v_lshlrev_b32 v8, 16, v84
  v_and_b32 v9, 0xffff0000, v84
  v_pk_add_f32 v[36:37], v[36:37], v[8:9]
  v_lshlrev_b32 v10, 16, v85
  v_and_b32 v11, 0xffff0000, v85
  v_pk_add_f32 v[38:39], v[38:39], v[10:11]
  v_lshlrev_b32 v8, 16, v86
  v_and_b32 v9, 0xffff0000, v86
  v_pk_add_f32 v[40:41], v[40:41], v[8:9]
  v_lshlrev_b32 v10, 16, v87
  v_and_b32 v11, 0xffff0000, v87
  v_pk_add_f32 v[42:43], v[42:43], v[10:11]
  v_lshlrev_b32 v8, 16, v88
  v_and_b32 v9, 0xffff0000, v88
  v_pk_add_f32 v[36:37], v[36:37], v[8:9]
  v_lshlrev_b32 v10, 16, v89
  v_and_b32 v11, 0xffff0000, v89
  v_pk_add_f32 v[38:39], v[38:39], v[10:11]
  v_lshlrev_b32 v8, 16, v90
  v_and_b32 v9, 0xffff0000, v90
  v_pk_add_f32 v[40:41], v[40:41], v[8:9]
  v_lshlrev_b32 v10, 16, v91
  v_and_b32 v11, 0xffff0000, v91
  v_pk_add_f32 v[42:43], v[42:43], v[10:11]
  v_lshlrev_b32 v8, 16, v92
  v_and_b32 v9, 0xffff0000, v92
  v_pk_add_f32 v[36:37], v[36:37], v[8:9]
  v_lshlrev_b32 v10, 16, v93
  v_and_b32 v11, 0xffff0000, v93
  v_pk_add_f32 v[38:39], v[38:39], v[10:11]
  v_lshlrev_b32 v8, 16, v94
  v_and_b32 v9, 0xffff0000, v94
  v_pk_add_f32 v[40:41], v[40:41], v[8:9]
  v_lshlrev_b32 v10, 16, v95
  v_and_b32 v11, 0xffff0000, v95
  v_pk_add_f32 v[42:43], v[42:43], v[10:11]
  v_lshlrev_b32 v8, 16, v96
  v_and_b32 v9, 0xffff0000, v96
  v_pk_add_f32 v[36:37], v[36:37], v[8:9]
  v_lshlrev_b32 v10, 16, v97
  v_and_b32 v11, 0xffff0000, v97
  v_pk_add_f32 v[38:39], v[38:39], v[10:11]
  v_lshlrev_b32 v8, 16, v98
  v_and_b32 v9, 0xffff0000, v98
  v_pk_add_f32 v[40:41], v[40:41], v[8:9]
  v_lshlrev_b32 v10, 16, v99
  v_and_b32 v11, 0xffff0000, v99
  v_pk_add_f32 v[42:43], v[42:43], v[10:11]
  v_lshlrev_b32 v8, 16, v100
  v_and_b32 v9, 0xffff0000, v100
  v_pk_add_f32 v[36:37], v[36:37], v[8:9]
  v_lshlrev_b32 v10, 16, v101
  v_and_b32 v11, 0xffff0000, v101
  v_pk_add_f32 v[38:39], v[38:39], v[10:11]
  v_lshlrev_b32 v8, 16, v102
  v_and_b32 v9, 0xffff0000, v102
  v_pk_add_f32 v[40:41], v[40:41], v[8:9]
  v_lshlrev_b32 v10, 16, v103
  v_and_b32 v11, 0xffff0000, v103
  v_pk_add_f32 v[42:43], v[42:43], v[10:11]
  v_lshlrev_b32 v8, 16, v104
  v_and_b32 v9, 0xffff0000, v104
  v_pk_add_f32 v[36:37], v[36:37], v[8:9]
  v_lshlrev_b32 v10, 16, v105
  v_and_b32 v11, 0xffff0000, v105
  v_pk_add_f32 v[38:39], v[38:39], v[10:11]
  v_lshlrev_b32 v8, 16, v106
  v_and_b32 v9, 0xffff0000, v106
  v_pk_add_f32 v[40:41], v[40:41], v[8:9]
  v_lshlrev_b32 v10, 16, v107
  v_and_b32 v11, 0xffff0000, v107
  v_pk_add_f32 v[42:43], v[42:43], v[10:11]
  v_lshlrev_b32 v8, 16, v108
  v_and_b32 v9, 0xffff0000, v108
  v_pk_add_f32 v[36:37], v[36:37], v[8:9]
  v_lshlrev_b32 v10, 16, v109
  v_and_b32 v11, 0xffff0000, v109
  v_pk_add_f32 v[38:39], v[38:39], v[10:11]
  v_lshlrev_b32 v8, 16, v110
  v_and_b32 v9, 0xffff0000, v110
  v_pk_add_f32 v[40:41], v[40:41], v[8:9]
  v_lshlrev_b32 v10, 16, v111
  v_and_b32 v11, 0xffff0000, v111
  v_pk_add_f32 v[42:43], v[42:43], v[10:11]
  v_cvt_pk_bf16_f32 v8, v36, v37
  v_lshlrev_b32 v36, 16, v8
  v_and_b32 v37, 0xffff0000, v8
  v_lshlrev_b32 v10, 16, v16
  v_and_b32 v11, 0xffff0000, v16
  v_pk_add_f32 v[36:37], v[36:37], v[10:11]
  v_cvt_pk_bf16_f32 v16, v36, v37
  v_lshlrev_b32 v36, 16, v16
  v_and_b32 v37, 0xffff0000, v16
  v_cvt_pk_bf16_f32 v8, v38, v39
  v_lshlrev_b32 v38, 16, v8
  v_and_b32 v39, 0xffff0000, v8
  v_lshlrev_b32 v10, 16, v17
  v_and_b32 v11, 0xffff0000, v17
  v_pk_add_f32 v[38:39], v[38:39], v[10:11]
  v_cvt_pk_bf16_f32 v17, v38, v39
  v_lshlrev_b32 v38, 16, v17
  v_and_b32 v39, 0xffff0000, v17
  v_cvt_pk_bf16_f32 v8, v40, v41
  v_lshlrev_b32 v40, 16, v8
  v_and_b32 v41, 0xffff0000, v8
  v_lshlrev_b32 v10, 16, v18
  v_and_b32 v11, 0xffff0000, v18
  v_pk_add_f32 v[40:41], v[40:41], v[10:11]
  v_cvt_pk_bf16_f32 v18, v40, v41
  v_lshlrev_b32 v40, 16, v18
  v_and_b32 v41, 0xffff0000, v18
  v_cvt_pk_bf16_f32 v8, v42, v43
  v_lshlrev_b32 v42, 16, v8
  v_and_b32 v43, 0xffff0000, v8
  v_lshlrev_b32 v10, 16, v19
  v_and_b32 v11, 0xffff0000, v19
  v_pk_add_f32 v[42:43], v[42:43], v[10:11]
  v_cvt_pk_bf16_f32 v19, v42, v43
  v_lshlrev_b32 v42, 16, v19
  v_and_b32 v43, 0xffff0000, v19
  buffer_store_dwordx4 v[16:19], v15, s[4:7], s21 offen offset:0 sc1
  s_waitcnt vmcnt(25)
  v_lshlrev_b32 v44, 16, v112
  v_and_b32 v45, 0xffff0000, v112
  v_lshlrev_b32 v46, 16, v113
  v_and_b32 v47, 0xffff0000, v113
  v_lshlrev_b32 v48, 16, v114
  v_and_b32 v49, 0xffff0000, v114
  v_lshlrev_b32 v50, 16, v115
  v_and_b32 v51, 0xffff0000, v115
  v_lshlrev_b32 v8, 16, v116
  v_and_b32 v9, 0xffff0000, v116
  v_pk_add_f32 v[44:45], v[44:45], v[8:9]
  v_lshlrev_b32 v10, 16, v117
  v_and_b32 v11, 0xffff0000, v117
  v_pk_add_f32 v[46:47], v[46:47], v[10:11]
  v_lshlrev_b32 v8, 16, v118
  v_and_b32 v9, 0xffff0000, v118
  v_pk_add_f32 v[48:49], v[48:49], v[8:9]
  v_lshlrev_b32 v10, 16, v119
  v_and_b32 v11, 0xffff0000, v119
  v_pk_add_f32 v[50:51], v[50:51], v[10:11]
  v_lshlrev_b32 v8, 16, v120
  v_and_b32 v9, 0xffff0000, v120
  v_pk_add_f32 v[44:45], v[44:45], v[8:9]
  v_lshlrev_b32 v10, 16, v121
  v_and_b32 v11, 0xffff0000, v121
  v_pk_add_f32 v[46:47], v[46:47], v[10:11]
  v_lshlrev_b32 v8, 16, v122
  v_and_b32 v9, 0xffff0000, v122
  v_pk_add_f32 v[48:49], v[48:49], v[8:9]
  v_lshlrev_b32 v10, 16, v123
  v_and_b32 v11, 0xffff0000, v123
  v_pk_add_f32 v[50:51], v[50:51], v[10:11]
  v_lshlrev_b32 v8, 16, v124
  v_and_b32 v9, 0xffff0000, v124
  v_pk_add_f32 v[44:45], v[44:45], v[8:9]
  v_lshlrev_b32 v10, 16, v125
  v_and_b32 v11, 0xffff0000, v125
  v_pk_add_f32 v[46:47], v[46:47], v[10:11]
  v_lshlrev_b32 v8, 16, v126
  v_and_b32 v9, 0xffff0000, v126
  v_pk_add_f32 v[48:49], v[48:49], v[8:9]
  v_lshlrev_b32 v10, 16, v127
  v_and_b32 v11, 0xffff0000, v127
  v_pk_add_f32 v[50:51], v[50:51], v[10:11]
  v_lshlrev_b32 v8, 16, v128
  v_and_b32 v9, 0xffff0000, v128
  v_pk_add_f32 v[44:45], v[44:45], v[8:9]
  v_lshlrev_b32 v10, 16, v129
  v_and_b32 v11, 0xffff0000, v129
  v_pk_add_f32 v[46:47], v[46:47], v[10:11]
  v_lshlrev_b32 v8, 16, v130
  v_and_b32 v9, 0xffff0000, v130
  v_pk_add_f32 v[48:49], v[48:49], v[8:9]
  v_lshlrev_b32 v10, 16, v131
  v_and_b32 v11, 0xffff0000, v131
  v_pk_add_f32 v[50:51], v[50:51], v[10:11]
  v_lshlrev_b32 v8, 16, v132
  v_and_b32 v9, 0xffff0000, v132
  v_pk_add_f32 v[44:45], v[44:45], v[8:9]
  v_lshlrev_b32 v10, 16, v133
  v_and_b32 v11, 0xffff0000, v133
  v_pk_add_f32 v[46:47], v[46:47], v[10:11]
  v_lshlrev_b32 v8, 16, v134
  v_and_b32 v9, 0xffff0000, v134
  v_pk_add_f32 v[48:49], v[48:49], v[8:9]
  v_lshlrev_b32 v10, 16, v135
  v_and_b32 v11, 0xffff0000, v135
  v_pk_add_f32 v[50:51], v[50:51], v[10:11]
  v_lshlrev_b32 v8, 16, v136
  v_and_b32 v9, 0xffff0000, v136
  v_pk_add_f32 v[44:45], v[44:45], v[8:9]
  v_lshlrev_b32 v10, 16, v137
  v_and_b32 v11, 0xffff0000, v137
  v_pk_add_f32 v[46:47], v[46:47], v[10:11]
  v_lshlrev_b32 v8, 16, v138
  v_and_b32 v9, 0xffff0000, v138
  v_pk_add_f32 v[48:49], v[48:49], v[8:9]
  v_lshlrev_b32 v10, 16, v139
  v_and_b32 v11, 0xffff0000, v139
  v_pk_add_f32 v[50:51], v[50:51], v[10:11]
  v_lshlrev_b32 v8, 16, v140
  v_and_b32 v9, 0xffff0000, v140
  v_pk_add_f32 v[44:45], v[44:45], v[8:9]
  v_lshlrev_b32 v10, 16, v141
  v_and_b32 v11, 0xffff0000, v141
  v_pk_add_f32 v[46:47], v[46:47], v[10:11]
  v_lshlrev_b32 v8, 16, v142
  v_and_b32 v9, 0xffff0000, v142
  v_pk_add_f32 v[48:49], v[48:49], v[8:9]
  v_lshlrev_b32 v10, 16, v143
  v_and_b32 v11, 0xffff0000, v143
  v_pk_add_f32 v[50:51], v[50:51], v[10:11]
  v_cvt_pk_bf16_f32 v8, v44, v45
  v_lshlrev_b32 v44, 16, v8
  v_and_b32 v45, 0xffff0000, v8
  v_lshlrev_b32 v10, 16, v20
  v_and_b32 v11, 0xffff0000, v20
  v_pk_add_f32 v[44:45], v[44:45], v[10:11]
  v_cvt_pk_bf16_f32 v20, v44, v45
  v_lshlrev_b32 v44, 16, v20
  v_and_b32 v45, 0xffff0000, v20
  v_cvt_pk_bf16_f32 v8, v46, v47
  v_lshlrev_b32 v46, 16, v8
  v_and_b32 v47, 0xffff0000, v8
  v_lshlrev_b32 v10, 16, v21
  v_and_b32 v11, 0xffff0000, v21
  v_pk_add_f32 v[46:47], v[46:47], v[10:11]
  v_cvt_pk_bf16_f32 v21, v46, v47
  v_lshlrev_b32 v46, 16, v21
  v_and_b32 v47, 0xffff0000, v21
  v_cvt_pk_bf16_f32 v8, v48, v49
  v_lshlrev_b32 v48, 16, v8
  v_and_b32 v49, 0xffff0000, v8
  v_lshlrev_b32 v10, 16, v22
  v_and_b32 v11, 0xffff0000, v22
  v_pk_add_f32 v[48:49], v[48:49], v[10:11]
  v_cvt_pk_bf16_f32 v22, v48, v49
  v_lshlrev_b32 v48, 16, v22
  v_and_b32 v49, 0xffff0000, v22
  v_cvt_pk_bf16_f32 v8, v50, v51
  v_lshlrev_b32 v50, 16, v8
  v_and_b32 v51, 0xffff0000, v8
  v_lshlrev_b32 v10, 16, v23
  v_and_b32 v11, 0xffff0000, v23
  v_pk_add_f32 v[50:51], v[50:51], v[10:11]
  v_cvt_pk_bf16_f32 v23, v50, v51
  v_lshlrev_b32 v50, 16, v23
  v_and_b32 v51, 0xffff0000, v23
  buffer_store_dwordx4 v[20:23], v15, s[4:7], s21 offen offset:128 sc1
  s_waitcnt vmcnt(18)
  v_lshlrev_b32 v52, 16, v144
  v_and_b32 v53, 0xffff0000, v144
  v_lshlrev_b32 v54, 16, v145
  v_and_b32 v55, 0xffff0000, v145
  v_lshlrev_b32 v56, 16, v146
  v_and_b32 v57, 0xffff0000, v146
  v_lshlrev_b32 v58, 16, v147
  v_and_b32 v59, 0xffff0000, v147
  v_lshlrev_b32 v8, 16, v148
  v_and_b32 v9, 0xffff0000, v148
  v_pk_add_f32 v[52:53], v[52:53], v[8:9]
  v_lshlrev_b32 v10, 16, v149
  v_and_b32 v11, 0xffff0000, v149
  v_pk_add_f32 v[54:55], v[54:55], v[10:11]
  v_lshlrev_b32 v8, 16, v150
  v_and_b32 v9, 0xffff0000, v150
  v_pk_add_f32 v[56:57], v[56:57], v[8:9]
  v_lshlrev_b32 v10, 16, v151
  v_and_b32 v11, 0xffff0000, v151
  v_pk_add_f32 v[58:59], v[58:59], v[10:11]
  v_lshlrev_b32 v8, 16, v152
  v_and_b32 v9, 0xffff0000, v152
  v_pk_add_f32 v[52:53], v[52:53], v[8:9]
  v_lshlrev_b32 v10, 16, v153
  v_and_b32 v11, 0xffff0000, v153
  v_pk_add_f32 v[54:55], v[54:55], v[10:11]
  v_lshlrev_b32 v8, 16, v154
  v_and_b32 v9, 0xffff0000, v154
  v_pk_add_f32 v[56:57], v[56:57], v[8:9]
  v_lshlrev_b32 v10, 16, v155
  v_and_b32 v11, 0xffff0000, v155
  v_pk_add_f32 v[58:59], v[58:59], v[10:11]
  v_lshlrev_b32 v8, 16, v156
  v_and_b32 v9, 0xffff0000, v156
  v_pk_add_f32 v[52:53], v[52:53], v[8:9]
  v_lshlrev_b32 v10, 16, v157
  v_and_b32 v11, 0xffff0000, v157
  v_pk_add_f32 v[54:55], v[54:55], v[10:11]
  v_lshlrev_b32 v8, 16, v158
  v_and_b32 v9, 0xffff0000, v158
  v_pk_add_f32 v[56:57], v[56:57], v[8:9]
  v_lshlrev_b32 v10, 16, v159
  v_and_b32 v11, 0xffff0000, v159
  v_pk_add_f32 v[58:59], v[58:59], v[10:11]
  v_lshlrev_b32 v8, 16, v160
  v_and_b32 v9, 0xffff0000, v160
  v_pk_add_f32 v[52:53], v[52:53], v[8:9]
  v_lshlrev_b32 v10, 16, v161
  v_and_b32 v11, 0xffff0000, v161
  v_pk_add_f32 v[54:55], v[54:55], v[10:11]
  v_lshlrev_b32 v8, 16, v162
  v_and_b32 v9, 0xffff0000, v162
  v_pk_add_f32 v[56:57], v[56:57], v[8:9]
  v_lshlrev_b32 v10, 16, v163
  v_and_b32 v11, 0xffff0000, v163
  v_pk_add_f32 v[58:59], v[58:59], v[10:11]
  v_lshlrev_b32 v8, 16, v164
  v_and_b32 v9, 0xffff0000, v164
  v_pk_add_f32 v[52:53], v[52:53], v[8:9]
  v_lshlrev_b32 v10, 16, v165
  v_and_b32 v11, 0xffff0000, v165
  v_pk_add_f32 v[54:55], v[54:55], v[10:11]
  v_lshlrev_b32 v8, 16, v166
  v_and_b32 v9, 0xffff0000, v166
  v_pk_add_f32 v[56:57], v[56:57], v[8:9]
  v_lshlrev_b32 v10, 16, v167
  v_and_b32 v11, 0xffff0000, v167
  v_pk_add_f32 v[58:59], v[58:59], v[10:11]
  v_lshlrev_b32 v8, 16, v168
  v_and_b32 v9, 0xffff0000, v168
  v_pk_add_f32 v[52:53], v[52:53], v[8:9]
  v_lshlrev_b32 v10, 16, v169
  v_and_b32 v11, 0xffff0000, v169
  v_pk_add_f32 v[54:55], v[54:55], v[10:11]
  v_lshlrev_b32 v8, 16, v170
  v_and_b32 v9, 0xffff0000, v170
  v_pk_add_f32 v[56:57], v[56:57], v[8:9]
  v_lshlrev_b32 v10, 16, v171
  v_and_b32 v11, 0xffff0000, v171
  v_pk_add_f32 v[58:59], v[58:59], v[10:11]
  v_lshlrev_b32 v8, 16, v172
  v_and_b32 v9, 0xffff0000, v172
  v_pk_add_f32 v[52:53], v[52:53], v[8:9]
  v_lshlrev_b32 v10, 16, v173
  v_and_b32 v11, 0xffff0000, v173
  v_pk_add_f32 v[54:55], v[54:55], v[10:11]
  v_lshlrev_b32 v8, 16, v174
  v_and_b32 v9, 0xffff0000, v174
  v_pk_add_f32 v[56:57], v[56:57], v[8:9]
  v_lshlrev_b32 v10, 16, v175
  v_and_b32 v11, 0xffff0000, v175
  v_pk_add_f32 v[58:59], v[58:59], v[10:11]
  v_cvt_pk_bf16_f32 v8, v52, v53
  v_lshlrev_b32 v52, 16, v8
  v_and_b32 v53, 0xffff0000, v8
  v_lshlrev_b32 v10, 16, v24
  v_and_b32 v11, 0xffff0000, v24
  v_pk_add_f32 v[52:53], v[52:53], v[10:11]
  v_cvt_pk_bf16_f32 v24, v52, v53
  v_lshlrev_b32 v52, 16, v24
  v_and_b32 v53, 0xffff0000, v24
  v_cvt_pk_bf16_f32 v8, v54, v55
  v_lshlrev_b32 v54, 16, v8
  v_and_b32 v55, 0xffff0000, v8
  v_lshlrev_b32 v10, 16, v25
  v_and_b32 v11, 0xffff0000, v25
  v_pk_add_f32 v[54:55], v[54:55], v[10:11]
  v_cvt_pk_bf16_f32 v25, v54, v55
  v_lshlrev_b32 v54, 16, v25
  v_and_b32 v55, 0xffff0000, v25
  v_cvt_pk_bf16_f32 v8, v56, v57
  v_lshlrev_b32 v56, 16, v8
  v_and_b32 v57, 0xffff0000, v8
  v_lshlrev_b32 v10, 16, v26
  v_and_b32 v11, 0xffff0000, v26
  v_pk_add_f32 v[56:57], v[56:57], v[10:11]
  v_cvt_pk_bf16_f32 v26, v56, v57
  v_lshlrev_b32 v56, 16, v26
  v_and_b32 v57, 0xffff0000, v26
  v_cvt_pk_bf16_f32 v8, v58, v59
  v_lshlrev_b32 v58, 16, v8
  v_and_b32 v59, 0xffff0000, v8
  v_lshlrev_b32 v10, 16, v27
  v_and_b32 v11, 0xffff0000, v27
  v_pk_add_f32 v[58:59], v[58:59], v[10:11]
  v_cvt_pk_bf16_f32 v27, v58, v59
  v_lshlrev_b32 v58, 16, v27
  v_and_b32 v59, 0xffff0000, v27
  buffer_store_dwordx4 v[24:27], v15, s[4:7], s21 offen offset:256 sc1
  s_waitcnt vmcnt(11)
  v_lshlrev_b32 v60, 16, v176
  v_and_b32 v61, 0xffff0000, v176
  v_lshlrev_b32 v62, 16, v177
  v_and_b32 v63, 0xffff0000, v177
  v_lshlrev_b32 v64, 16, v178
  v_and_b32 v65, 0xffff0000, v178
  v_lshlrev_b32 v66, 16, v179
  v_and_b32 v67, 0xffff0000, v179
  v_lshlrev_b32 v8, 16, v180
  v_and_b32 v9, 0xffff0000, v180
  v_pk_add_f32 v[60:61], v[60:61], v[8:9]
  v_lshlrev_b32 v10, 16, v181
  v_and_b32 v11, 0xffff0000, v181
  v_pk_add_f32 v[62:63], v[62:63], v[10:11]
  v_lshlrev_b32 v8, 16, v182
  v_and_b32 v9, 0xffff0000, v182
  v_pk_add_f32 v[64:65], v[64:65], v[8:9]
  v_lshlrev_b32 v10, 16, v183
  v_and_b32 v11, 0xffff0000, v183
  v_pk_add_f32 v[66:67], v[66:67], v[10:11]
  v_lshlrev_b32 v8, 16, v184
  v_and_b32 v9, 0xffff0000, v184
  v_pk_add_f32 v[60:61], v[60:61], v[8:9]
  v_lshlrev_b32 v10, 16, v185
  v_and_b32 v11, 0xffff0000, v185
  v_pk_add_f32 v[62:63], v[62:63], v[10:11]
  v_lshlrev_b32 v8, 16, v186
  v_and_b32 v9, 0xffff0000, v186
  v_pk_add_f32 v[64:65], v[64:65], v[8:9]
  v_lshlrev_b32 v10, 16, v187
  v_and_b32 v11, 0xffff0000, v187
  v_pk_add_f32 v[66:67], v[66:67], v[10:11]
  v_lshlrev_b32 v8, 16, v188
  v_and_b32 v9, 0xffff0000, v188
  v_pk_add_f32 v[60:61], v[60:61], v[8:9]
  v_lshlrev_b32 v10, 16, v189
  v_and_b32 v11, 0xffff0000, v189
  v_pk_add_f32 v[62:63], v[62:63], v[10:11]
  v_lshlrev_b32 v8, 16, v190
  v_and_b32 v9, 0xffff0000, v190
  v_pk_add_f32 v[64:65], v[64:65], v[8:9]
  v_lshlrev_b32 v10, 16, v191
  v_and_b32 v11, 0xffff0000, v191
  v_pk_add_f32 v[66:67], v[66:67], v[10:11]
  v_lshlrev_b32 v8, 16, v192
  v_and_b32 v9, 0xffff0000, v192
  v_pk_add_f32 v[60:61], v[60:61], v[8:9]
  v_lshlrev_b32 v10, 16, v193
  v_and_b32 v11, 0xffff0000, v193
  v_pk_add_f32 v[62:63], v[62:63], v[10:11]
  v_lshlrev_b32 v8, 16, v194
  v_and_b32 v9, 0xffff0000, v194
  v_pk_add_f32 v[64:65], v[64:65], v[8:9]
  v_lshlrev_b32 v10, 16, v195
  v_and_b32 v11, 0xffff0000, v195
  v_pk_add_f32 v[66:67], v[66:67], v[10:11]
  v_lshlrev_b32 v8, 16, v196
  v_and_b32 v9, 0xffff0000, v196
  v_pk_add_f32 v[60:61], v[60:61], v[8:9]
  v_lshlrev_b32 v10, 16, v197
  v_and_b32 v11, 0xffff0000, v197
  v_pk_add_f32 v[62:63], v[62:63], v[10:11]
  v_lshlrev_b32 v8, 16, v198
  v_and_b32 v9, 0xffff0000, v198
  v_pk_add_f32 v[64:65], v[64:65], v[8:9]
  v_lshlrev_b32 v10, 16, v199
  v_and_b32 v11, 0xffff0000, v199
  v_pk_add_f32 v[66:67], v[66:67], v[10:11]
  v_lshlrev_b32 v8, 16, v200
  v_and_b32 v9, 0xffff0000, v200
  v_pk_add_f32 v[60:61], v[60:61], v[8:9]
  v_lshlrev_b32 v10, 16, v201
  v_and_b32 v11, 0xffff0000, v201
  v_pk_add_f32 v[62:63], v[62:63], v[10:11]
  v_lshlrev_b32 v8, 16, v202
  v_and_b32 v9, 0xffff0000, v202
  v_pk_add_f32 v[64:65], v[64:65], v[8:9]
  v_lshlrev_b32 v10, 16, v203
  v_and_b32 v11, 0xffff0000, v203
  v_pk_add_f32 v[66:67], v[66:67], v[10:11]
  v_lshlrev_b32 v8, 16, v204
  v_and_b32 v9, 0xffff0000, v204
  v_pk_add_f32 v[60:61], v[60:61], v[8:9]
  v_lshlrev_b32 v10, 16, v205
  v_and_b32 v11, 0xffff0000, v205
  v_pk_add_f32 v[62:63], v[62:63], v[10:11]
  v_lshlrev_b32 v8, 16, v206
  v_and_b32 v9, 0xffff0000, v206
  v_pk_add_f32 v[64:65], v[64:65], v[8:9]
  v_lshlrev_b32 v10, 16, v207
  v_and_b32 v11, 0xffff0000, v207
  v_pk_add_f32 v[66:67], v[66:67], v[10:11]
  v_cvt_pk_bf16_f32 v8, v60, v61
  v_lshlrev_b32 v60, 16, v8
  v_and_b32 v61, 0xffff0000, v8
  v_lshlrev_b32 v10, 16, v28
  v_and_b32 v11, 0xffff0000, v28
  v_pk_add_f32 v[60:61], v[60:61], v[10:11]
  v_cvt_pk_bf16_f32 v28, v60, v61
  v_lshlrev_b32 v60, 16, v28
  v_and_b32 v61, 0xffff0000, v28
  v_cvt_pk_bf16_f32 v8, v62, v63
  v_lshlrev_b32 v62, 16, v8
  v_and_b32 v63, 0xffff0000, v8
  v_lshlrev_b32 v10, 16, v29
  v_and_b32 v11, 0xffff0000, v29
  v_pk_add_f32 v[62:63], v[62:63], v[10:11]
  v_cvt_pk_bf16_f32 v29, v62, v63
  v_lshlrev_b32 v62, 16, v29
  v_and_b32 v63, 0xffff0000, v29
  v_cvt_pk_bf16_f32 v8, v64, v65
  v_lshlrev_b32 v64, 16, v8
  v_and_b32 v65, 0xffff0000, v8
  v_lshlrev_b32 v10, 16, v30
  v_and_b32 v11, 0xffff0000, v30
  v_pk_add_f32 v[64:65], v[64:65], v[10:11]
  v_cvt_pk_bf16_f32 v30, v64, v65
  v_lshlrev_b32 v64, 16, v30
  v_and_b32 v65, 0xffff0000, v30
  v_cvt_pk_bf16_f32 v8, v66, v67
  v_lshlrev_b32 v66, 16, v8
  v_and_b32 v67, 0xffff0000, v8
  v_lshlrev_b32 v10, 16, v31
  v_and_b32 v11, 0xffff0000, v31
  v_pk_add_f32 v[66:67], v[66:67], v[10:11]
  v_cvt_pk_bf16_f32 v31, v66, v67
  v_lshlrev_b32 v66, 16, v31
  v_and_b32 v67, 0xffff0000, v31
  buffer_store_dwordx4 v[28:31], v15, s[4:7], s21 offen offset:384 sc1
  s_waitcnt vmcnt(4)
  v_lshlrev_b32 v68, 16, v208
  v_and_b32 v69, 0xffff0000, v208
  v_lshlrev_b32 v70, 16, v209
  v_and_b32 v71, 0xffff0000, v209
  v_lshlrev_b32 v72, 16, v210
  v_and_b32 v73, 0xffff0000, v210
  v_lshlrev_b32 v74, 16, v211
  v_and_b32 v75, 0xffff0000, v211
  v_lshlrev_b32 v8, 16, v212
  v_and_b32 v9, 0xffff0000, v212
  v_pk_add_f32 v[68:69], v[68:69], v[8:9]
  v_lshlrev_b32 v10, 16, v213
  v_and_b32 v11, 0xffff0000, v213
  v_pk_add_f32 v[70:71], v[70:71], v[10:11]
  v_lshlrev_b32 v8, 16, v214
  v_and_b32 v9, 0xffff0000, v214
  v_pk_add_f32 v[72:73], v[72:73], v[8:9]
  v_lshlrev_b32 v10, 16, v215
  v_and_b32 v11, 0xffff0000, v215
  v_pk_add_f32 v[74:75], v[74:75], v[10:11]
  v_lshlrev_b32 v8, 16, v216
  v_and_b32 v9, 0xffff0000, v216
  v_pk_add_f32 v[68:69], v[68:69], v[8:9]
  v_lshlrev_b32 v10, 16, v217
  v_and_b32 v11, 0xffff0000, v217
  v_pk_add_f32 v[70:71], v[70:71], v[10:11]
  v_lshlrev_b32 v8, 16, v218
  v_and_b32 v9, 0xffff0000, v218
  v_pk_add_f32 v[72:73], v[72:73], v[8:9]
  v_lshlrev_b32 v10, 16, v219
  v_and_b32 v11, 0xffff0000, v219
  v_pk_add_f32 v[74:75], v[74:75], v[10:11]
  v_lshlrev_b32 v8, 16, v220
  v_and_b32 v9, 0xffff0000, v220
  v_pk_add_f32 v[68:69], v[68:69], v[8:9]
  v_lshlrev_b32 v10, 16, v221
  v_and_b32 v11, 0xffff0000, v221
  v_pk_add_f32 v[70:71], v[70:71], v[10:11]
  v_lshlrev_b32 v8, 16, v222
  v_and_b32 v9, 0xffff0000, v222
  v_pk_add_f32 v[72:73], v[72:73], v[8:9]
  v_lshlrev_b32 v10, 16, v223
  v_and_b32 v11, 0xffff0000, v223
  v_pk_add_f32 v[74:75], v[74:75], v[10:11]
  v_lshlrev_b32 v8, 16, v224
  v_and_b32 v9, 0xffff0000, v224
  v_pk_add_f32 v[68:69], v[68:69], v[8:9]
  v_lshlrev_b32 v10, 16, v225
  v_and_b32 v11, 0xffff0000, v225
  v_pk_add_f32 v[70:71], v[70:71], v[10:11]
  v_lshlrev_b32 v8, 16, v226
  v_and_b32 v9, 0xffff0000, v226
  v_pk_add_f32 v[72:73], v[72:73], v[8:9]
  v_lshlrev_b32 v10, 16, v227
  v_and_b32 v11, 0xffff0000, v227
  v_pk_add_f32 v[74:75], v[74:75], v[10:11]
  v_lshlrev_b32 v8, 16, v228
  v_and_b32 v9, 0xffff0000, v228
  v_pk_add_f32 v[68:69], v[68:69], v[8:9]
  v_lshlrev_b32 v10, 16, v229
  v_and_b32 v11, 0xffff0000, v229
  v_pk_add_f32 v[70:71], v[70:71], v[10:11]
  v_lshlrev_b32 v8, 16, v230
  v_and_b32 v9, 0xffff0000, v230
  v_pk_add_f32 v[72:73], v[72:73], v[8:9]
  v_lshlrev_b32 v10, 16, v231
  v_and_b32 v11, 0xffff0000, v231
  v_pk_add_f32 v[74:75], v[74:75], v[10:11]
  v_lshlrev_b32 v8, 16, v232
  v_and_b32 v9, 0xffff0000, v232
  v_pk_add_f32 v[68:69], v[68:69], v[8:9]
  v_lshlrev_b32 v10, 16, v233
  v_and_b32 v11, 0xffff0000, v233
  v_pk_add_f32 v[70:71], v[70:71], v[10:11]
  v_lshlrev_b32 v8, 16, v234
  v_and_b32 v9, 0xffff0000, v234
  v_pk_add_f32 v[72:73], v[72:73], v[8:9]
  v_lshlrev_b32 v10, 16, v235
  v_and_b32 v11, 0xffff0000, v235
  v_pk_add_f32 v[74:75], v[74:75], v[10:11]
  v_lshlrev_b32 v8, 16, v236
  v_and_b32 v9, 0xffff0000, v236
  v_pk_add_f32 v[68:69], v[68:69], v[8:9]
  v_lshlrev_b32 v10, 16, v237
  v_and_b32 v11, 0xffff0000, v237
  v_pk_add_f32 v[70:71], v[70:71], v[10:11]
  v_lshlrev_b32 v8, 16, v238
  v_and_b32 v9, 0xffff0000, v238
  v_pk_add_f32 v[72:73], v[72:73], v[8:9]
  v_lshlrev_b32 v10, 16, v239
  v_and_b32 v11, 0xffff0000, v239
  v_pk_add_f32 v[74:75], v[74:75], v[10:11]
  v_cvt_pk_bf16_f32 v8, v68, v69
  v_lshlrev_b32 v68, 16, v8
  v_and_b32 v69, 0xffff0000, v8
  v_lshlrev_b32 v10, 16, v32
  v_and_b32 v11, 0xffff0000, v32
  v_pk_add_f32 v[68:69], v[68:69], v[10:11]
  v_cvt_pk_bf16_f32 v32, v68, v69
  v_lshlrev_b32 v68, 16, v32
  v_and_b32 v69, 0xffff0000, v32
  v_cvt_pk_bf16_f32 v8, v70, v71
  v_lshlrev_b32 v70, 16, v8
  v_and_b32 v71, 0xffff0000, v8
  v_lshlrev_b32 v10, 16, v33
  v_and_b32 v11, 0xffff0000, v33
  v_pk_add_f32 v[70:71], v[70:71], v[10:11]
  v_cvt_pk_bf16_f32 v33, v70, v71
  v_lshlrev_b32 v70, 16, v33
  v_and_b32 v71, 0xffff0000, v33
  v_cvt_pk_bf16_f32 v8, v72, v73
  v_lshlrev_b32 v72, 16, v8
  v_and_b32 v73, 0xffff0000, v8
  v_lshlrev_b32 v10, 16, v34
  v_and_b32 v11, 0xffff0000, v34
  v_pk_add_f32 v[72:73], v[72:73], v[10:11]
  v_cvt_pk_bf16_f32 v34, v72, v73
  v_lshlrev_b32 v72, 16, v34
  v_and_b32 v73, 0xffff0000, v34
  v_cvt_pk_bf16_f32 v8, v74, v75
  v_lshlrev_b32 v74, 16, v8
  v_and_b32 v75, 0xffff0000, v8
  v_lshlrev_b32 v10, 16, v35
  v_and_b32 v11, 0xffff0000, v35
  v_pk_add_f32 v[74:75], v[74:75], v[10:11]
  v_cvt_pk_bf16_f32 v35, v74, v75
  v_lshlrev_b32 v74, 16, v35
  v_and_b32 v75, 0xffff0000, v35
  buffer_store_dwordx4 v[32:35], v15, s[4:7], s21 offen offset:512 sc1
  v_and_b32 v3, 63, v0
  v_and_b32 v2, 7, v3
  v_lshlrev_b32 v5, 2, v2
  s_lshl_b32 s17, s16, 5
  v_add_u32 v1, s17, v5
  v_pk_add_f32 v[6:7], v[36:37], v[38:39]
  v_pk_add_f32 v[6:7], v[6:7], v[40:41]
  v_pk_add_f32 v[6:7], v[6:7], v[42:43]
  v_pk_add_f32 v[6:7], v[6:7], v[44:45]
  v_pk_add_f32 v[6:7], v[6:7], v[46:47]
  v_pk_add_f32 v[6:7], v[6:7], v[48:49]
  v_pk_add_f32 v[6:7], v[6:7], v[50:51]
  v_pk_add_f32 v[6:7], v[6:7], v[52:53]
  v_pk_add_f32 v[6:7], v[6:7], v[54:55]
  v_pk_add_f32 v[6:7], v[6:7], v[56:57]
  v_pk_add_f32 v[6:7], v[6:7], v[58:59]
  v_pk_add_f32 v[6:7], v[6:7], v[60:61]
  v_pk_add_f32 v[6:7], v[6:7], v[62:63]
  v_pk_add_f32 v[6:7], v[6:7], v[64:65]
  v_pk_add_f32 v[6:7], v[6:7], v[66:67]
  v_pk_add_f32 v[6:7], v[6:7], v[68:69]
  v_pk_add_f32 v[6:7], v[6:7], v[70:71]
  v_pk_add_f32 v[6:7], v[6:7], v[72:73]
  v_pk_add_f32 v[6:7], v[6:7], v[74:75]
  v_add_f32 v4, v6, v7
  s_nop 1
  v_add_f32_dpp v4, v4, v4 row_ror:8 row_mask:0xf bank_mask:0xf
  v_mov_b32 v2, v4
  s_nop 1
  v_permlane16_swap_b32 v4, v2
  v_add_f32 v4, v4, v2
  v_mov_b32 v2, v4
  s_nop 1
  v_permlane32_swap_b32 v4, v2
  v_add_f32 v4, v4, v2
  ds_write_b32 v1, v4 offset:0
  s_waitcnt lgkmcnt(0)
  s_barrier
  ds_read_b32 v4, v5 offset:0
  ds_read_b32 v2, v5 offset:32
  s_waitcnt lgkmcnt(0)
  v_add_f32 v4, v4, v2
  v_mul_f32 v6, 0xbacccccd, v4
  v_mov_b32 v7, v6
  v_pk_add_f32 v[36:37], v[36:37], v[6:7]
  v_pk_add_f32 v[38:39], v[38:39], v[6:7]
  v_pk_add_f32 v[40:41], v[40:41], v[6:7]
  v_pk_add_f32 v[42:43], v[42:43], v[6:7]
  v_pk_add_f32 v[44:45], v[44:45], v[6:7]
  v_pk_add_f32 v[46:47], v[46:47], v[6:7]
  v_pk_add_f32 v[48:49], v[48:49], v[6:7]
  v_pk_add_f32 v[50:51], v[50:51], v[6:7]
  v_pk_add_f32 v[52:53], v[52:53], v[6:7]
  v_pk_add_f32 v[54:55], v[54:55], v[6:7]
  v_pk_add_f32 v[56:57], v[56:57], v[6:7]
  v_pk_add_f32 v[58:59], v[58:59], v[6:7]
  v_pk_add_f32 v[60:61], v[60:61], v[6:7]
  v_pk_add_f32 v[62:63], v[62:63], v[6:7]
  v_pk_add_f32 v[64:65], v[64:65], v[6:7]
  v_pk_add_f32 v[66:67], v[66:67], v[6:7]
  v_pk_add_f32 v[68:69], v[68:69], v[6:7]
  v_pk_add_f32 v[70:71], v[70:71], v[6:7]
  v_pk_add_f32 v[72:73], v[72:73], v[6:7]
  v_pk_add_f32 v[74:75], v[74:75], v[6:7]
  v_pk_mul_f32 v[6:7], v[36:37], v[36:37]
  v_pk_fma_f32 v[6:7], v[38:39], v[38:39], v[6:7]
  v_pk_fma_f32 v[6:7], v[40:41], v[40:41], v[6:7]
  v_pk_fma_f32 v[6:7], v[42:43], v[42:43], v[6:7]
  v_pk_fma_f32 v[6:7], v[44:45], v[44:45], v[6:7]
  v_pk_fma_f32 v[6:7], v[46:47], v[46:47], v[6:7]
  v_pk_fma_f32 v[6:7], v[48:49], v[48:49], v[6:7]
  v_pk_fma_f32 v[6:7], v[50:51], v[50:51], v[6:7]
  v_pk_fma_f32 v[6:7], v[52:53], v[52:53], v[6:7]
  v_pk_fma_f32 v[6:7], v[54:55], v[54:55], v[6:7]
  v_pk_fma_f32 v[6:7], v[56:57], v[56:57], v[6:7]
  v_pk_fma_f32 v[6:7], v[58:59], v[58:59], v[6:7]
  v_pk_fma_f32 v[6:7], v[60:61], v[60:61], v[6:7]
  v_pk_fma_f32 v[6:7], v[62:63], v[62:63], v[6:7]
  v_pk_fma_f32 v[6:7], v[64:65], v[64:65], v[6:7]
  v_pk_fma_f32 v[6:7], v[66:67], v[66:67], v[6:7]
  v_pk_fma_f32 v[6:7], v[68:69], v[68:69], v[6:7]
  v_pk_fma_f32 v[6:7], v[70:71], v[70:71], v[6:7]
  v_pk_fma_f32 v[6:7], v[72:73], v[72:73], v[6:7]
  v_pk_fma_f32 v[6:7], v[74:75], v[74:75], v[6:7]
  v_add_f32 v4, v6, v7
  s_nop 1
  v_add_f32_dpp v4, v4, v4 row_ror:8 row_mask:0xf bank_mask:0xf
  v_mov_b32 v2, v4
  s_nop 1
  v_permlane16_swap_b32 v4, v2
  v_add_f32 v4, v4, v2
  v_mov_b32 v2, v4
  s_nop 1
  v_permlane32_swap_b32 v4, v2
  v_add_f32 v4, v4, v2
  ds_write_b32 v1, v4 offset:64
  s_waitcnt lgkmcnt(0)
  s_barrier
  ds_read_b32 v4, v5 offset:64
  ds_read_b32 v2, v5 offset:96
  s_waitcnt lgkmcnt(0)
  v_add_f32 v4, v4, v2
  v_mov_b32 v2, 0x3727c5ac
  v_fmac_f32 v2, 0x3acccccd, v4
  v_rsq_f32 v6, v2
  s_nop 0
  v_mov_b32 v7, v6
  v_pk_mul_f32 v[36:37], v[36:37], v[6:7]
  v_pk_mul_f32 v[38:39], v[38:39], v[6:7]
  v_pk_mul_f32 v[40:41], v[40:41], v[6:7]
  v_pk_mul_f32 v[42:43], v[42:43], v[6:7]
  v_pk_mul_f32 v[44:45], v[44:45], v[6:7]
  v_pk_mul_f32 v[46:47], v[46:47], v[6:7]
  v_pk_mul_f32 v[48:49], v[48:49], v[6:7]
  v_pk_mul_f32 v[50:51], v[50:51], v[6:7]
  v_pk_mul_f32 v[52:53], v[52:53], v[6:7]
  v_pk_mul_f32 v[54:55], v[54:55], v[6:7]
  v_pk_mul_f32 v[56:57], v[56:57], v[6:7]
  v_pk_mul_f32 v[58:59], v[58:59], v[6:7]
  v_pk_mul_f32 v[60:61], v[60:61], v[6:7]
  v_pk_mul_f32 v[62:63], v[62:63], v[6:7]
  v_pk_mul_f32 v[64:65], v[64:65], v[6:7]
  v_pk_mul_f32 v[66:67], v[66:67], v[6:7]
  v_pk_mul_f32 v[68:69], v[68:69], v[6:7]
  v_pk_mul_f32 v[70:71], v[70:71], v[6:7]
  v_pk_mul_f32 v[72:73], v[72:73], v[6:7]
  v_pk_mul_f32 v[74:75], v[74:75], v[6:7]
  v_cvt_pk_bf16_f32 v16, v36, v37
  v_cvt_pk_bf16_f32 v17, v38, v39
  v_cvt_pk_bf16_f32 v18, v40, v41
  v_cvt_pk_bf16_f32 v19, v42, v43
  v_cvt_pk_bf16_f32 v20, v44, v45
  v_cvt_pk_bf16_f32 v21, v46, v47
  v_cvt_pk_bf16_f32 v22, v48, v49
  v_cvt_pk_bf16_f32 v23, v50, v51
  v_cvt_pk_bf16_f32 v24, v52, v53
  v_cvt_pk_bf16_f32 v25, v54, v55
  v_cvt_pk_bf16_f32 v26, v56, v57
  v_cvt_pk_bf16_f32 v27, v58, v59
  v_cvt_pk_bf16_f32 v28, v60, v61
  v_cvt_pk_bf16_f32 v29, v62, v63
  v_cvt_pk_bf16_f32 v30, v64, v65
  v_cvt_pk_bf16_f32 v31, v66, v67
  v_cvt_pk_bf16_f32 v32, v68, v69
  v_cvt_pk_bf16_f32 v33, v70, v71
  v_cvt_pk_bf16_f32 v34, v72, v73
  v_cvt_pk_bf16_f32 v35, v74, v75
  v_add_u32 v6, 0x1000, v14
  v_add_u32 v7, 0x2000, v14
  buffer_store_dwordx4 v[16:19], v14, s[4:7], s34 offen offset:0 sc1
  buffer_store_dwordx4 v[20:23], v14, s[4:7], s34 offen offset:2048 sc1
  buffer_store_dwordx4 v[24:27], v6, s[4:7], s34 offen offset:0 sc1
  buffer_store_dwordx4 v[28:31], v6, s[4:7], s34 offen offset:2048 sc1
  buffer_store_dwordx4 v[32:35], v7, s[4:7], s34 offen offset:0 sc1
redln1_exit1:
  s_endpgm
.globl redln2_kernel
.p2align 8
.type redln2_kernel,@function
redln2_kernel:
  s_cmp_ge_u32 s2, 256
  s_cbranch_scc1 redln2_exit1
  s_load_dwordx2 s[12:13], s[0:1], 96
  s_load_dwordx2 s[14:15], s[0:1], 0
  v_lshrrev_b32 v2, 6, v0
  v_and_b32 v3, 63, v0
  s_lshr_b32 s19, s2, 1
  v_readfirstlane_b32 s16, v2
  s_and_b32 s18, s2, 1
  s_waitcnt lgkmcnt(0)
  s_mov_b32 s4, s12
  s_mov_b32 s5, s13
  s_mov_b32 s6, 0x10000000
  s_mov_b32 s7, 0x20000
  s_mov_b32 s8, s12
  s_mov_b32 s9, s13
  s_mov_b32 s10, 0x10000000
  s_mov_b32 s11, 0x20000
  s_mov_b32 s20, 82313216
  v_and_b32 v2, 7, v3
  v_bfe_u32 v4, v3, 3, 2
  v_lshrrev_b32 v5, 5, v3
  s_lshl_b32 s17, s18, 7
  v_lshlrev_b32 v14, 4, v2
  v_lshl_add_u32 v14, v4, 8, v14
  v_lshl_add_u32 v14, v5, 10, v14
  v_add_u32 v14, s17, v14
  s_lshl_b32 s17, s2, 3
  v_add_u32 v15, s17, v2
  v_mul_u32_u24 v15, 1280, v15
  v_lshl_add_u32 v15, v4, 4, v15
  v_lshl_add_u32 v15, v5, 6, v15
  s_mul_i32 s17, s16, 640
  s_add_u32 s20, s20, s17
  s_add_u32 s21, s17, 82313216
  s_mul_i32 s22, s19, 20
  s_mul_i32 s23, s16, 10
  s_add_u32 s22, s22, s23
  s_lshl_b32 s22, s22, 10
  s_add_u32 s34, s22, 54525952
  s_add_u32 s22, s22, 90832896
  s_add_u32 s24, s22, 0
  s_add_u32 s25, s22, 2621440
  s_add_u32 s26, s22, 5242880
  s_add_u32 s27, s22, 7864320
  s_add_u32 s28, s22, 10485760
  s_add_u32 s29, s22, 13107200
  s_add_u32 s30, s22, 15728640
  s_add_u32 s31, s22, 18350080
  v_add_u32 v6, 0x1000, v14
  v_add_u32 v7, 0x2000, v14
  buffer_load_dwordx4 v[16:19], v15, s[8:11], s20 offen offset:0
  buffer_load_dwordx4 v[20:23], v15, s[8:11], s20 offen offset:128
  buffer_load_dwordx4 v[24:27], v15, s[8:11], s20 offen offset:256
  buffer_load_dwordx4 v[28:31], v15, s[8:11], s20 offen offset:384
  buffer_load_dwordx4 v[32:35], v15, s[8:11], s20 offen offset:512
  buffer_load_dwordx4 v[80:83], v14, s[4:7], s24 offen offset:0
  buffer_load_dwordx4 v[84:87], v14, s[4:7], s25 offen offset:0
  buffer_load_dwordx4 v[88:91], v14, s[4:7], s26 offen offset:0
  buffer_load_dwordx4 v[92:95], v14, s[4:7], s27 offen offset:0
  buffer_load_dwordx4 v[96:99], v14, s[4:7], s28 offen offset:0
  buffer_load_dwordx4 v[100:103], v14, s[4:7], s29 offen offset:0
  buffer_load_dwordx4 v[104:107], v14, s[4:7], s30 offen offset:0
  buffer_load_dwordx4 v[108:111], v14, s[4:7], s31 offen offset:0
  buffer_load_dwordx4 v[112:115], v14, s[4:7], s24 offen offset:2048
  buffer_load_dwordx4 v[116:119], v14, s[4:7], s25 offen offset:2048
  buffer_load_dwordx4 v[120:123], v14, s[4:7], s26 offen offset:2048
  buffer_load_dwordx4 v[124:127], v14, s[4:7], s27 offen offset:2048
  buffer_load_dwordx4 v[128:131], v14, s[4:7], s28 offen offset:2048
  buffer_load_dwordx4 v[132:135], v14, s[4:7], s29 offen offset:2048
  buffer_load_dwordx4 v[136:139], v14, s[4:7], s30 offen offset:2048
  buffer_load_dwordx4 v[140:143], v14, s[4:7], s31 offen offset:2048
  buffer_load_dwordx4 v[144:147], v6, s[4:7], s24 offen offset:0
  buffer_load_dwordx4 v[148:151], v6, s[4:7], s25 offen offset:0
  buffer_load_dwordx4 v[152:155], v6, s[4:7], s26 offen offset:0
  buffer_load_dwordx4 v[156:159], v6, s[4:7], s27 offen offset:0
  buffer_load_dwordx4 v[160:163], v6, s[4:7], s28 offen offset:0
  buffer_load_dwordx4 v[164:167], v6, s[4:7], s29 offen offset:0
  buffer_load_dwordx4 v[168:171], v6, s[4:7], s30 offen offset:0
  buffer_load_dwordx4 v[172:175], v6, s[4:7], s31 offen offset:0
  buffer_load_dwordx4 v[176:179], v6, s[4:7], s24 offen offset:2048
  buffer_load_dwordx4 v[180:183], v6, s[4:7], s25 offen offset:2048
  buffer_load_dwordx4 v[184:187], v6, s[4:7], s26 offen offset:2048
  buffer_load_dwordx4 v[188:191], v6, s[4:7], s27 offen offset:2048
  buffer_load_dwordx4 v[192:195], v6, s[4:7], s28 offen offset:2048
  buffer_load_dwordx4 v[196:199], v6, s[4:7], s29 offen offset:2048
  buffer_load_dwordx4 v[200:203], v6, s[4:7], s30 offen offset:2048
  buffer_load_dwordx4 v[204:207], v6, s[4:7], s31 offen offset:2048
  buffer_load_dwordx4 v[208:211], v7, s[4:7], s24 offen offset:0
  buffer_load_dwordx4 v[212:215], v7, s[4:7], s25 offen offset:0
  buffer_load_dwordx4 v[216:219], v7, s[4:7], s26 offen offset:0
  buffer_load_dwordx4 v[220:223], v7, s[4:7], s27 offen offset:0
  buffer_load_dwordx4 v[224:227], v7, s[4:7], s28 offen offset:0
  buffer_load_dwordx4 v[228:231], v7, s[4:7], s29 offen offset:0
  buffer_load_dwordx4 v[232:235], v7, s[4:7], s30 offen offset:0
  buffer_load_dwordx4 v[236:239], v7, s[4:7], s31 offen offset:0
  s_waitcnt vmcnt(32)
  v_lshlrev_b32 v36, 16, v80
  v_and_b32 v37, 0xffff0000, v80
  v_lshlrev_b32 v38, 16, v81
  v_and_b32 v39, 0xffff0000, v81
  v_lshlrev_b32 v40, 16, v82
  v_and_b32 v41, 0xffff0000, v82
  v_lshlrev_b32 v42, 16, v83
  v_and_b32 v43, 0xffff0000, v83
  v_lshlrev_b32 v8, 16, v84
  v_and_b32 v9, 0xffff0000, v84
  v_pk_add_f32 v[36:37], v[36:37], v[8:9]
  v_lshlrev_b32 v10, 16, v85
  v_and_b32 v11, 0xffff0000, v85
  v_pk_add_f32 v[38:39], v[38:39], v[10:11]
  v_lshlrev_b32 v8, 16, v86
  v_and_b32 v9, 0xffff0000, v86
  v_pk_add_f32 v[40:41], v[40:41], v[8:9]
  v_lshlrev_b32 v10, 16, v87
  v_and_b32 v11, 0xffff0000, v87
  v_pk_add_f32 v[42:43], v[42:43], v[10:11]
  v_lshlrev_b32 v8, 16, v88
  v_and_b32 v9, 0xffff0000, v88
  v_pk_add_f32 v[36:37], v[36:37], v[8:9]
  v_lshlrev_b32 v10, 16, v89
  v_and_b32 v11, 0xffff0000, v89
  v_pk_add_f32 v[38:39], v[38:39], v[10:11]
  v_lshlrev_b32 v8, 16, v90
  v_and_b32 v9, 0xffff0000, v90
  v_pk_add_f32 v[40:41], v[40:41], v[8:9]
  v_lshlrev_b32 v10, 16, v91
  v_and_b32 v11, 0xffff0000, v91
  v_pk_add_f32 v[42:43], v[42:43], v[10:11]
  v_lshlrev_b32 v8, 16, v92
  v_and_b32 v9, 0xffff0000, v92
  v_pk_add_f32 v[36:37], v[36:37], v[8:9]
  v_lshlrev_b32 v10, 16, v93
  v_and_b32 v11, 0xffff0000, v93
  v_pk_add_f32 v[38:39], v[38:39], v[10:11]
  v_lshlrev_b32 v8, 16, v94
  v_and_b32 v9, 0xffff0000, v94
  v_pk_add_f32 v[40:41], v[40:41], v[8:9]
  v_lshlrev_b32 v10, 16, v95
  v_and_b32 v11, 0xffff0000, v95
  v_pk_add_f32 v[42:43], v[42:43], v[10:11]
  v_lshlrev_b32 v8, 16, v96
  v_and_b32 v9, 0xffff0000, v96
  v_pk_add_f32 v[36:37], v[36:37], v[8:9]
  v_lshlrev_b32 v10, 16, v97
  v_and_b32 v11, 0xffff0000, v97
  v_pk_add_f32 v[38:39], v[38:39], v[10:11]
  v_lshlrev_b32 v8, 16, v98
  v_and_b32 v9, 0xffff0000, v98
  v_pk_add_f32 v[40:41], v[40:41], v[8:9]
  v_lshlrev_b32 v10, 16, v99
  v_and_b32 v11, 0xffff0000, v99
  v_pk_add_f32 v[42:43], v[42:43], v[10:11]
  v_lshlrev_b32 v8, 16, v100
  v_and_b32 v9, 0xffff0000, v100
  v_pk_add_f32 v[36:37], v[36:37], v[8:9]
  v_lshlrev_b32 v10, 16, v101
  v_and_b32 v11, 0xffff0000, v101
  v_pk_add_f32 v[38:39], v[38:39], v[10:11]
  v_lshlrev_b32 v8, 16, v102
  v_and_b32 v9, 0xffff0000, v102
  v_pk_add_f32 v[40:41], v[40:41], v[8:9]
  v_lshlrev_b32 v10, 16, v103
  v_and_b32 v11, 0xffff0000, v103
  v_pk_add_f32 v[42:43], v[42:43], v[10:11]
  v_lshlrev_b32 v8, 16, v104
  v_and_b32 v9, 0xffff0000, v104
  v_pk_add_f32 v[36:37], v[36:37], v[8:9]
  v_lshlrev_b32 v10, 16, v105
  v_and_b32 v11, 0xffff0000, v105
  v_pk_add_f32 v[38:39], v[38:39], v[10:11]
  v_lshlrev_b32 v8, 16, v106
  v_and_b32 v9, 0xffff0000, v106
  v_pk_add_f32 v[40:41], v[40:41], v[8:9]
  v_lshlrev_b32 v10, 16, v107
  v_and_b32 v11, 0xffff0000, v107
  v_pk_add_f32 v[42:43], v[42:43], v[10:11]
  v_lshlrev_b32 v8, 16, v108
  v_and_b32 v9, 0xffff0000, v108
  v_pk_add_f32 v[36:37], v[36:37], v[8:9]
  v_lshlrev_b32 v10, 16, v109
  v_and_b32 v11, 0xffff0000, v109
  v_pk_add_f32 v[38:39], v[38:39], v[10:11]
  v_lshlrev_b32 v8, 16, v110
  v_and_b32 v9, 0xffff0000, v110
  v_pk_add_f32 v[40:41], v[40:41], v[8:9]
  v_lshlrev_b32 v10, 16, v111
  v_and_b32 v11, 0xffff0000, v111
  v_pk_add_f32 v[42:43], v[42:43], v[10:11]
  v_cvt_pk_bf16_f32 v8, v36, v37
  v_lshlrev_b32 v36, 16, v8
  v_and_b32 v37, 0xffff0000, v8
  v_lshlrev_b32 v10, 16, v16
  v_and_b32 v11, 0xffff0000, v16
  v_pk_add_f32 v[36:37], v[36:37], v[10:11]
  v_cvt_pk_bf16_f32 v16, v36, v37
  v_lshlrev_b32 v36, 16, v16
  v_and_b32 v37, 0xffff0000, v16
  v_cvt_pk_bf16_f32 v8, v38, v39
  v_lshlrev_b32 v38, 16, v8
  v_and_b32 v39, 0xffff0000, v8
  v_lshlrev_b32 v10, 16, v17
  v_and_b32 v11, 0xffff0000, v17
  v_pk_add_f32 v[38:39], v[38:39], v[10:11]
  v_cvt_pk_bf16_f32 v17, v38, v39
  v_lshlrev_b32 v38, 16, v17
  v_and_b32 v39, 0xffff0000, v17
  v_cvt_pk_bf16_f32 v8, v40, v41
  v_lshlrev_b32 v40, 16, v8
  v_and_b32 v41, 0xffff0000, v8
  v_lshlrev_b32 v10, 16, v18
  v_and_b32 v11, 0xffff0000, v18
  v_pk_add_f32 v[40:41], v[40:41], v[10:11]
  v_cvt_pk_bf16_f32 v18, v40, v41
  v_lshlrev_b32 v40, 16, v18
  v_and_b32 v41, 0xffff0000, v18
  v_cvt_pk_bf16_f32 v8, v42, v43
  v_lshlrev_b32 v42, 16, v8
  v_and_b32 v43, 0xffff0000, v8
  v_lshlrev_b32 v10, 16, v19
  v_and_b32 v11, 0xffff0000, v19
  v_pk_add_f32 v[42:43], v[42:43], v[10:11]
  v_cvt_pk_bf16_f32 v19, v42, v43
  v_lshlrev_b32 v42, 16, v19
  v_and_b32 v43, 0xffff0000, v19
  buffer_store_dwordx4 v[16:19], v15, s[4:7], s21 offen offset:0 sc1
  s_waitcnt vmcnt(25)
  v_lshlrev_b32 v44, 16, v112
  v_and_b32 v45, 0xffff0000, v112
  v_lshlrev_b32 v46, 16, v113
  v_and_b32 v47, 0xffff0000, v113
  v_lshlrev_b32 v48, 16, v114
  v_and_b32 v49, 0xffff0000, v114
  v_lshlrev_b32 v50, 16, v115
  v_and_b32 v51, 0xffff0000, v115
  v_lshlrev_b32 v8, 16, v116
  v_and_b32 v9, 0xffff0000, v116
  v_pk_add_f32 v[44:45], v[44:45], v[8:9]
  v_lshlrev_b32 v10, 16, v117
  v_and_b32 v11, 0xffff0000, v117
  v_pk_add_f32 v[46:47], v[46:47], v[10:11]
  v_lshlrev_b32 v8, 16, v118
  v_and_b32 v9, 0xffff0000, v118
  v_pk_add_f32 v[48:49], v[48:49], v[8:9]
  v_lshlrev_b32 v10, 16, v119
  v_and_b32 v11, 0xffff0000, v119
  v_pk_add_f32 v[50:51], v[50:51], v[10:11]
  v_lshlrev_b32 v8, 16, v120
  v_and_b32 v9, 0xffff0000, v120
  v_pk_add_f32 v[44:45], v[44:45], v[8:9]
  v_lshlrev_b32 v10, 16, v121
  v_and_b32 v11, 0xffff0000, v121
  v_pk_add_f32 v[46:47], v[46:47], v[10:11]
  v_lshlrev_b32 v8, 16, v122
  v_and_b32 v9, 0xffff0000, v122
  v_pk_add_f32 v[48:49], v[48:49], v[8:9]
  v_lshlrev_b32 v10, 16, v123
  v_and_b32 v11, 0xffff0000, v123
  v_pk_add_f32 v[50:51], v[50:51], v[10:11]
  v_lshlrev_b32 v8, 16, v124
  v_and_b32 v9, 0xffff0000, v124
  v_pk_add_f32 v[44:45], v[44:45], v[8:9]
  v_lshlrev_b32 v10, 16, v125
  v_and_b32 v11, 0xffff0000, v125
  v_pk_add_f32 v[46:47], v[46:47], v[10:11]
  v_lshlrev_b32 v8, 16, v126
  v_and_b32 v9, 0xffff0000, v126
  v_pk_add_f32 v[48:49], v[48:49], v[8:9]
  v_lshlrev_b32 v10, 16, v127
  v_and_b32 v11, 0xffff0000, v127
  v_pk_add_f32 v[50:51], v[50:51], v[10:11]
  v_lshlrev_b32 v8, 16, v128
  v_and_b32 v9, 0xffff0000, v128
  v_pk_add_f32 v[44:45], v[44:45], v[8:9]
  v_lshlrev_b32 v10, 16, v129
  v_and_b32 v11, 0xffff0000, v129
  v_pk_add_f32 v[46:47], v[46:47], v[10:11]
  v_lshlrev_b32 v8, 16, v130
  v_and_b32 v9, 0xffff0000, v130
  v_pk_add_f32 v[48:49], v[48:49], v[8:9]
  v_lshlrev_b32 v10, 16, v131
  v_and_b32 v11, 0xffff0000, v131
  v_pk_add_f32 v[50:51], v[50:51], v[10:11]
  v_lshlrev_b32 v8, 16, v132
  v_and_b32 v9, 0xffff0000, v132
  v_pk_add_f32 v[44:45], v[44:45], v[8:9]
  v_lshlrev_b32 v10, 16, v133
  v_and_b32 v11, 0xffff0000, v133
  v_pk_add_f32 v[46:47], v[46:47], v[10:11]
  v_lshlrev_b32 v8, 16, v134
  v_and_b32 v9, 0xffff0000, v134
  v_pk_add_f32 v[48:49], v[48:49], v[8:9]
  v_lshlrev_b32 v10, 16, v135
  v_and_b32 v11, 0xffff0000, v135
  v_pk_add_f32 v[50:51], v[50:51], v[10:11]
  v_lshlrev_b32 v8, 16, v136
  v_and_b32 v9, 0xffff0000, v136
  v_pk_add_f32 v[44:45], v[44:45], v[8:9]
  v_lshlrev_b32 v10, 16, v137
  v_and_b32 v11, 0xffff0000, v137
  v_pk_add_f32 v[46:47], v[46:47], v[10:11]
  v_lshlrev_b32 v8, 16, v138
  v_and_b32 v9, 0xffff0000, v138
  v_pk_add_f32 v[48:49], v[48:49], v[8:9]
  v_lshlrev_b32 v10, 16, v139
  v_and_b32 v11, 0xffff0000, v139
  v_pk_add_f32 v[50:51], v[50:51], v[10:11]
  v_lshlrev_b32 v8, 16, v140
  v_and_b32 v9, 0xffff0000, v140
  v_pk_add_f32 v[44:45], v[44:45], v[8:9]
  v_lshlrev_b32 v10, 16, v141
  v_and_b32 v11, 0xffff0000, v141
  v_pk_add_f32 v[46:47], v[46:47], v[10:11]
  v_lshlrev_b32 v8, 16, v142
  v_and_b32 v9, 0xffff0000, v142
  v_pk_add_f32 v[48:49], v[48:49], v[8:9]
  v_lshlrev_b32 v10, 16, v143
  v_and_b32 v11, 0xffff0000, v143
  v_pk_add_f32 v[50:51], v[50:51], v[10:11]
  v_cvt_pk_bf16_f32 v8, v44, v45
  v_lshlrev_b32 v44, 16, v8
  v_and_b32 v45, 0xffff0000, v8
  v_lshlrev_b32 v10, 16, v20
  v_and_b32 v11, 0xffff0000, v20
  v_pk_add_f32 v[44:45], v[44:45], v[10:11]
  v_cvt_pk_bf16_f32 v20, v44, v45
  v_lshlrev_b32 v44, 16, v20
  v_and_b32 v45, 0xffff0000, v20
  v_cvt_pk_bf16_f32 v8, v46, v47
  v_lshlrev_b32 v46, 16, v8
  v_and_b32 v47, 0xffff0000, v8
  v_lshlrev_b32 v10, 16, v21
  v_and_b32 v11, 0xffff0000, v21
  v_pk_add_f32 v[46:47], v[46:47], v[10:11]
  v_cvt_pk_bf16_f32 v21, v46, v47
  v_lshlrev_b32 v46, 16, v21
  v_and_b32 v47, 0xffff0000, v21
  v_cvt_pk_bf16_f32 v8, v48, v49
  v_lshlrev_b32 v48, 16, v8
  v_and_b32 v49, 0xffff0000, v8
  v_lshlrev_b32 v10, 16, v22
  v_and_b32 v11, 0xffff0000, v22
  v_pk_add_f32 v[48:49], v[48:49], v[10:11]
  v_cvt_pk_bf16_f32 v22, v48, v49
  v_lshlrev_b32 v48, 16, v22
  v_and_b32 v49, 0xffff0000, v22
  v_cvt_pk_bf16_f32 v8, v50, v51
  v_lshlrev_b32 v50, 16, v8
  v_and_b32 v51, 0xffff0000, v8
  v_lshlrev_b32 v10, 16, v23
  v_and_b32 v11, 0xffff0000, v23
  v_pk_add_f32 v[50:51], v[50:51], v[10:11]
  v_cvt_pk_bf16_f32 v23, v50, v51
  v_lshlrev_b32 v50, 16, v23
  v_and_b32 v51, 0xffff0000, v23
  buffer_store_dwordx4 v[20:23], v15, s[4:7], s21 offen offset:128 sc1
  s_waitcnt vmcnt(18)
  v_lshlrev_b32 v52, 16, v144
  v_and_b32 v53, 0xffff0000, v144
  v_lshlrev_b32 v54, 16, v145
  v_and_b32 v55, 0xffff0000, v145
  v_lshlrev_b32 v56, 16, v146
  v_and_b32 v57, 0xffff0000, v146
  v_lshlrev_b32 v58, 16, v147
  v_and_b32 v59, 0xffff0000, v147
  v_lshlrev_b32 v8, 16, v148
  v_and_b32 v9, 0xffff0000, v148
  v_pk_add_f32 v[52:53], v[52:53], v[8:9]
  v_lshlrev_b32 v10, 16, v149
  v_and_b32 v11, 0xffff0000, v149
  v_pk_add_f32 v[54:55], v[54:55], v[10:11]
  v_lshlrev_b32 v8, 16, v150
  v_and_b32 v9, 0xffff0000, v150
  v_pk_add_f32 v[56:57], v[56:57], v[8:9]
  v_lshlrev_b32 v10, 16, v151
  v_and_b32 v11, 0xffff0000, v151
  v_pk_add_f32 v[58:59], v[58:59], v[10:11]
  v_lshlrev_b32 v8, 16, v152
  v_and_b32 v9, 0xffff0000, v152
  v_pk_add_f32 v[52:53], v[52:53], v[8:9]
  v_lshlrev_b32 v10, 16, v153
  v_and_b32 v11, 0xffff0000, v153
  v_pk_add_f32 v[54:55], v[54:55], v[10:11]
  v_lshlrev_b32 v8, 16, v154
  v_and_b32 v9, 0xffff0000, v154
  v_pk_add_f32 v[56:57], v[56:57], v[8:9]
  v_lshlrev_b32 v10, 16, v155
  v_and_b32 v11, 0xffff0000, v155
  v_pk_add_f32 v[58:59], v[58:59], v[10:11]
  v_lshlrev_b32 v8, 16, v156
  v_and_b32 v9, 0xffff0000, v156
  v_pk_add_f32 v[52:53], v[52:53], v[8:9]
  v_lshlrev_b32 v10, 16, v157
  v_and_b32 v11, 0xffff0000, v157
  v_pk_add_f32 v[54:55], v[54:55], v[10:11]
  v_lshlrev_b32 v8, 16, v158
  v_and_b32 v9, 0xffff0000, v158
  v_pk_add_f32 v[56:57], v[56:57], v[8:9]
  v_lshlrev_b32 v10, 16, v159
  v_and_b32 v11, 0xffff0000, v159
  v_pk_add_f32 v[58:59], v[58:59], v[10:11]
  v_lshlrev_b32 v8, 16, v160
  v_and_b32 v9, 0xffff0000, v160
  v_pk_add_f32 v[52:53], v[52:53], v[8:9]
  v_lshlrev_b32 v10, 16, v161
  v_and_b32 v11, 0xffff0000, v161
  v_pk_add_f32 v[54:55], v[54:55], v[10:11]
  v_lshlrev_b32 v8, 16, v162
  v_and_b32 v9, 0xffff0000, v162
  v_pk_add_f32 v[56:57], v[56:57], v[8:9]
  v_lshlrev_b32 v10, 16, v163
  v_and_b32 v11, 0xffff0000, v163
  v_pk_add_f32 v[58:59], v[58:59], v[10:11]
  v_lshlrev_b32 v8, 16, v164
  v_and_b32 v9, 0xffff0000, v164
  v_pk_add_f32 v[52:53], v[52:53], v[8:9]
  v_lshlrev_b32 v10, 16, v165
  v_and_b32 v11, 0xffff0000, v165
  v_pk_add_f32 v[54:55], v[54:55], v[10:11]
  v_lshlrev_b32 v8, 16, v166
  v_and_b32 v9, 0xffff0000, v166
  v_pk_add_f32 v[56:57], v[56:57], v[8:9]
  v_lshlrev_b32 v10, 16, v167
  v_and_b32 v11, 0xffff0000, v167
  v_pk_add_f32 v[58:59], v[58:59], v[10:11]
  v_lshlrev_b32 v8, 16, v168
  v_and_b32 v9, 0xffff0000, v168
  v_pk_add_f32 v[52:53], v[52:53], v[8:9]
  v_lshlrev_b32 v10, 16, v169
  v_and_b32 v11, 0xffff0000, v169
  v_pk_add_f32 v[54:55], v[54:55], v[10:11]
  v_lshlrev_b32 v8, 16, v170
  v_and_b32 v9, 0xffff0000, v170
  v_pk_add_f32 v[56:57], v[56:57], v[8:9]
  v_lshlrev_b32 v10, 16, v171
  v_and_b32 v11, 0xffff0000, v171
  v_pk_add_f32 v[58:59], v[58:59], v[10:11]
  v_lshlrev_b32 v8, 16, v172
  v_and_b32 v9, 0xffff0000, v172
  v_pk_add_f32 v[52:53], v[52:53], v[8:9]
  v_lshlrev_b32 v10, 16, v173
  v_and_b32 v11, 0xffff0000, v173
  v_pk_add_f32 v[54:55], v[54:55], v[10:11]
  v_lshlrev_b32 v8, 16, v174
  v_and_b32 v9, 0xffff0000, v174
  v_pk_add_f32 v[56:57], v[56:57], v[8:9]
  v_lshlrev_b32 v10, 16, v175
  v_and_b32 v11, 0xffff0000, v175
  v_pk_add_f32 v[58:59], v[58:59], v[10:11]
  v_cvt_pk_bf16_f32 v8, v52, v53
  v_lshlrev_b32 v52, 16, v8
  v_and_b32 v53, 0xffff0000, v8
  v_lshlrev_b32 v10, 16, v24
  v_and_b32 v11, 0xffff0000, v24
  v_pk_add_f32 v[52:53], v[52:53], v[10:11]
  v_cvt_pk_bf16_f32 v24, v52, v53
  v_lshlrev_b32 v52, 16, v24
  v_and_b32 v53, 0xffff0000, v24
  v_cvt_pk_bf16_f32 v8, v54, v55
  v_lshlrev_b32 v54, 16, v8
  v_and_b32 v55, 0xffff0000, v8
  v_lshlrev_b32 v10, 16, v25
  v_and_b32 v11, 0xffff0000, v25
  v_pk_add_f32 v[54:55], v[54:55], v[10:11]
  v_cvt_pk_bf16_f32 v25, v54, v55
  v_lshlrev_b32 v54, 16, v25
  v_and_b32 v55, 0xffff0000, v25
  v_cvt_pk_bf16_f32 v8, v56, v57
  v_lshlrev_b32 v56, 16, v8
  v_and_b32 v57, 0xffff0000, v8
  v_lshlrev_b32 v10, 16, v26
  v_and_b32 v11, 0xffff0000, v26
  v_pk_add_f32 v[56:57], v[56:57], v[10:11]
  v_cvt_pk_bf16_f32 v26, v56, v57
  v_lshlrev_b32 v56, 16, v26
  v_and_b32 v57, 0xffff0000, v26
  v_cvt_pk_bf16_f32 v8, v58, v59
  v_lshlrev_b32 v58, 16, v8
  v_and_b32 v59, 0xffff0000, v8
  v_lshlrev_b32 v10, 16, v27
  v_and_b32 v11, 0xffff0000, v27
  v_pk_add_f32 v[58:59], v[58:59], v[10:11]
  v_cvt_pk_bf16_f32 v27, v58, v59
  v_lshlrev_b32 v58, 16, v27
  v_and_b32 v59, 0xffff0000, v27
  buffer_store_dwordx4 v[24:27], v15, s[4:7], s21 offen offset:256 sc1
  s_waitcnt vmcnt(11)
  v_lshlrev_b32 v60, 16, v176
  v_and_b32 v61, 0xffff0000, v176
  v_lshlrev_b32 v62, 16, v177
  v_and_b32 v63, 0xffff0000, v177
  v_lshlrev_b32 v64, 16, v178
  v_and_b32 v65, 0xffff0000, v178
  v_lshlrev_b32 v66, 16, v179
  v_and_b32 v67, 0xffff0000, v179
  v_lshlrev_b32 v8, 16, v180
  v_and_b32 v9, 0xffff0000, v180
  v_pk_add_f32 v[60:61], v[60:61], v[8:9]
  v_lshlrev_b32 v10, 16, v181
  v_and_b32 v11, 0xffff0000, v181
  v_pk_add_f32 v[62:63], v[62:63], v[10:11]
  v_lshlrev_b32 v8, 16, v182
  v_and_b32 v9, 0xffff0000, v182
  v_pk_add_f32 v[64:65], v[64:65], v[8:9]
  v_lshlrev_b32 v10, 16, v183
  v_and_b32 v11, 0xffff0000, v183
  v_pk_add_f32 v[66:67], v[66:67], v[10:11]
  v_lshlrev_b32 v8, 16, v184
  v_and_b32 v9, 0xffff0000, v184
  v_pk_add_f32 v[60:61], v[60:61], v[8:9]
  v_lshlrev_b32 v10, 16, v185
  v_and_b32 v11, 0xffff0000, v185
  v_pk_add_f32 v[62:63], v[62:63], v[10:11]
  v_lshlrev_b32 v8, 16, v186
  v_and_b32 v9, 0xffff0000, v186
  v_pk_add_f32 v[64:65], v[64:65], v[8:9]
  v_lshlrev_b32 v10, 16, v187
  v_and_b32 v11, 0xffff0000, v187
  v_pk_add_f32 v[66:67], v[66:67], v[10:11]
  v_lshlrev_b32 v8, 16, v188
  v_and_b32 v9, 0xffff0000, v188
  v_pk_add_f32 v[60:61], v[60:61], v[8:9]
  v_lshlrev_b32 v10, 16, v189
  v_and_b32 v11, 0xffff0000, v189
  v_pk_add_f32 v[62:63], v[62:63], v[10:11]
  v_lshlrev_b32 v8, 16, v190
  v_and_b32 v9, 0xffff0000, v190
  v_pk_add_f32 v[64:65], v[64:65], v[8:9]
  v_lshlrev_b32 v10, 16, v191
  v_and_b32 v11, 0xffff0000, v191
  v_pk_add_f32 v[66:67], v[66:67], v[10:11]
  v_lshlrev_b32 v8, 16, v192
  v_and_b32 v9, 0xffff0000, v192
  v_pk_add_f32 v[60:61], v[60:61], v[8:9]
  v_lshlrev_b32 v10, 16, v193
  v_and_b32 v11, 0xffff0000, v193
  v_pk_add_f32 v[62:63], v[62:63], v[10:11]
  v_lshlrev_b32 v8, 16, v194
  v_and_b32 v9, 0xffff0000, v194
  v_pk_add_f32 v[64:65], v[64:65], v[8:9]
  v_lshlrev_b32 v10, 16, v195
  v_and_b32 v11, 0xffff0000, v195
  v_pk_add_f32 v[66:67], v[66:67], v[10:11]
  v_lshlrev_b32 v8, 16, v196
  v_and_b32 v9, 0xffff0000, v196
  v_pk_add_f32 v[60:61], v[60:61], v[8:9]
  v_lshlrev_b32 v10, 16, v197
  v_and_b32 v11, 0xffff0000, v197
  v_pk_add_f32 v[62:63], v[62:63], v[10:11]
  v_lshlrev_b32 v8, 16, v198
  v_and_b32 v9, 0xffff0000, v198
  v_pk_add_f32 v[64:65], v[64:65], v[8:9]
  v_lshlrev_b32 v10, 16, v199
  v_and_b32 v11, 0xffff0000, v199
  v_pk_add_f32 v[66:67], v[66:67], v[10:11]
  v_lshlrev_b32 v8, 16, v200
  v_and_b32 v9, 0xffff0000, v200
  v_pk_add_f32 v[60:61], v[60:61], v[8:9]
  v_lshlrev_b32 v10, 16, v201
  v_and_b32 v11, 0xffff0000, v201
  v_pk_add_f32 v[62:63], v[62:63], v[10:11]
  v_lshlrev_b32 v8, 16, v202
  v_and_b32 v9, 0xffff0000, v202
  v_pk_add_f32 v[64:65], v[64:65], v[8:9]
  v_lshlrev_b32 v10, 16, v203
  v_and_b32 v11, 0xffff0000, v203
  v_pk_add_f32 v[66:67], v[66:67], v[10:11]
  v_lshlrev_b32 v8, 16, v204
  v_and_b32 v9, 0xffff0000, v204
  v_pk_add_f32 v[60:61], v[60:61], v[8:9]
  v_lshlrev_b32 v10, 16, v205
  v_and_b32 v11, 0xffff0000, v205
  v_pk_add_f32 v[62:63], v[62:63], v[10:11]
  v_lshlrev_b32 v8, 16, v206
  v_and_b32 v9, 0xffff0000, v206
  v_pk_add_f32 v[64:65], v[64:65], v[8:9]
  v_lshlrev_b32 v10, 16, v207
  v_and_b32 v11, 0xffff0000, v207
  v_pk_add_f32 v[66:67], v[66:67], v[10:11]
  v_cvt_pk_bf16_f32 v8, v60, v61
  v_lshlrev_b32 v60, 16, v8
  v_and_b32 v61, 0xffff0000, v8
  v_lshlrev_b32 v10, 16, v28
  v_and_b32 v11, 0xffff0000, v28
  v_pk_add_f32 v[60:61], v[60:61], v[10:11]
  v_cvt_pk_bf16_f32 v28, v60, v61
  v_lshlrev_b32 v60, 16, v28
  v_and_b32 v61, 0xffff0000, v28
  v_cvt_pk_bf16_f32 v8, v62, v63
  v_lshlrev_b32 v62, 16, v8
  v_and_b32 v63, 0xffff0000, v8
  v_lshlrev_b32 v10, 16, v29
  v_and_b32 v11, 0xffff0000, v29
  v_pk_add_f32 v[62:63], v[62:63], v[10:11]
  v_cvt_pk_bf16_f32 v29, v62, v63
  v_lshlrev_b32 v62, 16, v29
  v_and_b32 v63, 0xffff0000, v29
  v_cvt_pk_bf16_f32 v8, v64, v65
  v_lshlrev_b32 v64, 16, v8
  v_and_b32 v65, 0xffff0000, v8
  v_lshlrev_b32 v10, 16, v30
  v_and_b32 v11, 0xffff0000, v30
  v_pk_add_f32 v[64:65], v[64:65], v[10:11]
  v_cvt_pk_bf16_f32 v30, v64, v65
  v_lshlrev_b32 v64, 16, v30
  v_and_b32 v65, 0xffff0000, v30
  v_cvt_pk_bf16_f32 v8, v66, v67
  v_lshlrev_b32 v66, 16, v8
  v_and_b32 v67, 0xffff0000, v8
  v_lshlrev_b32 v10, 16, v31
  v_and_b32 v11, 0xffff0000, v31
  v_pk_add_f32 v[66:67], v[66:67], v[10:11]
  v_cvt_pk_bf16_f32 v31, v66, v67
  v_lshlrev_b32 v66, 16, v31
  v_and_b32 v67, 0xffff0000, v31
  buffer_store_dwordx4 v[28:31], v15, s[4:7], s21 offen offset:384 sc1
  s_waitcnt vmcnt(4)
  v_lshlrev_b32 v68, 16, v208
  v_and_b32 v69, 0xffff0000, v208
  v_lshlrev_b32 v70, 16, v209
  v_and_b32 v71, 0xffff0000, v209
  v_lshlrev_b32 v72, 16, v210
  v_and_b32 v73, 0xffff0000, v210
  v_lshlrev_b32 v74, 16, v211
  v_and_b32 v75, 0xffff0000, v211
  v_lshlrev_b32 v8, 16, v212
  v_and_b32 v9, 0xffff0000, v212
  v_pk_add_f32 v[68:69], v[68:69], v[8:9]
  v_lshlrev_b32 v10, 16, v213
  v_and_b32 v11, 0xffff0000, v213
  v_pk_add_f32 v[70:71], v[70:71], v[10:11]
  v_lshlrev_b32 v8, 16, v214
  v_and_b32 v9, 0xffff0000, v214
  v_pk_add_f32 v[72:73], v[72:73], v[8:9]
  v_lshlrev_b32 v10, 16, v215
  v_and_b32 v11, 0xffff0000, v215
  v_pk_add_f32 v[74:75], v[74:75], v[10:11]
  v_lshlrev_b32 v8, 16, v216
  v_and_b32 v9, 0xffff0000, v216
  v_pk_add_f32 v[68:69], v[68:69], v[8:9]
  v_lshlrev_b32 v10, 16, v217
  v_and_b32 v11, 0xffff0000, v217
  v_pk_add_f32 v[70:71], v[70:71], v[10:11]
  v_lshlrev_b32 v8, 16, v218
  v_and_b32 v9, 0xffff0000, v218
  v_pk_add_f32 v[72:73], v[72:73], v[8:9]
  v_lshlrev_b32 v10, 16, v219
  v_and_b32 v11, 0xffff0000, v219
  v_pk_add_f32 v[74:75], v[74:75], v[10:11]
  v_lshlrev_b32 v8, 16, v220
  v_and_b32 v9, 0xffff0000, v220
  v_pk_add_f32 v[68:69], v[68:69], v[8:9]
  v_lshlrev_b32 v10, 16, v221
  v_and_b32 v11, 0xffff0000, v221
  v_pk_add_f32 v[70:71], v[70:71], v[10:11]
  v_lshlrev_b32 v8, 16, v222
  v_and_b32 v9, 0xffff0000, v222
  v_pk_add_f32 v[72:73], v[72:73], v[8:9]
  v_lshlrev_b32 v10, 16, v223
  v_and_b32 v11, 0xffff0000, v223
  v_pk_add_f32 v[74:75], v[74:75], v[10:11]
  v_lshlrev_b32 v8, 16, v224
  v_and_b32 v9, 0xffff0000, v224
  v_pk_add_f32 v[68:69], v[68:69], v[8:9]
  v_lshlrev_b32 v10, 16, v225
  v_and_b32 v11, 0xffff0000, v225
  v_pk_add_f32 v[70:71], v[70:71], v[10:11]
  v_lshlrev_b32 v8, 16, v226
  v_and_b32 v9, 0xffff0000, v226
  v_pk_add_f32 v[72:73], v[72:73], v[8:9]
  v_lshlrev_b32 v10, 16, v227
  v_and_b32 v11, 0xffff0000, v227
  v_pk_add_f32 v[74:75], v[74:75], v[10:11]
  v_lshlrev_b32 v8, 16, v228
  v_and_b32 v9, 0xffff0000, v228
  v_pk_add_f32 v[68:69], v[68:69], v[8:9]
  v_lshlrev_b32 v10, 16, v229
  v_and_b32 v11, 0xffff0000, v229
  v_pk_add_f32 v[70:71], v[70:71], v[10:11]
  v_lshlrev_b32 v8, 16, v230
  v_and_b32 v9, 0xffff0000, v230
  v_pk_add_f32 v[72:73], v[72:73], v[8:9]
  v_lshlrev_b32 v10, 16, v231
  v_and_b32 v11, 0xffff0000, v231
  v_pk_add_f32 v[74:75], v[74:75], v[10:11]
  v_lshlrev_b32 v8, 16, v232
  v_and_b32 v9, 0xffff0000, v232
  v_pk_add_f32 v[68:69], v[68:69], v[8:9]
  v_lshlrev_b32 v10, 16, v233
  v_and_b32 v11, 0xffff0000, v233
  v_pk_add_f32 v[70:71], v[70:71], v[10:11]
  v_lshlrev_b32 v8, 16, v234
  v_and_b32 v9, 0xffff0000, v234
  v_pk_add_f32 v[72:73], v[72:73], v[8:9]
  v_lshlrev_b32 v10, 16, v235
  v_and_b32 v11, 0xffff0000, v235
  v_pk_add_f32 v[74:75], v[74:75], v[10:11]
  v_lshlrev_b32 v8, 16, v236
  v_and_b32 v9, 0xffff0000, v236
  v_pk_add_f32 v[68:69], v[68:69], v[8:9]
  v_lshlrev_b32 v10, 16, v237
  v_and_b32 v11, 0xffff0000, v237
  v_pk_add_f32 v[70:71], v[70:71], v[10:11]
  v_lshlrev_b32 v8, 16, v238
  v_and_b32 v9, 0xffff0000, v238
  v_pk_add_f32 v[72:73], v[72:73], v[8:9]
  v_lshlrev_b32 v10, 16, v239
  v_and_b32 v11, 0xffff0000, v239
  v_pk_add_f32 v[74:75], v[74:75], v[10:11]
  v_cvt_pk_bf16_f32 v8, v68, v69
  v_lshlrev_b32 v68, 16, v8
  v_and_b32 v69, 0xffff0000, v8
  v_lshlrev_b32 v10, 16, v32
  v_and_b32 v11, 0xffff0000, v32
  v_pk_add_f32 v[68:69], v[68:69], v[10:11]
  v_cvt_pk_bf16_f32 v32, v68, v69
  v_lshlrev_b32 v68, 16, v32
  v_and_b32 v69, 0xffff0000, v32
  v_cvt_pk_bf16_f32 v8, v70, v71
  v_lshlrev_b32 v70, 16, v8
  v_and_b32 v71, 0xffff0000, v8
  v_lshlrev_b32 v10, 16, v33
  v_and_b32 v11, 0xffff0000, v33
  v_pk_add_f32 v[70:71], v[70:71], v[10:11]
  v_cvt_pk_bf16_f32 v33, v70, v71
  v_lshlrev_b32 v70, 16, v33
  v_and_b32 v71, 0xffff0000, v33
  v_cvt_pk_bf16_f32 v8, v72, v73
  v_lshlrev_b32 v72, 16, v8
  v_and_b32 v73, 0xffff0000, v8
  v_lshlrev_b32 v10, 16, v34
  v_and_b32 v11, 0xffff0000, v34
  v_pk_add_f32 v[72:73], v[72:73], v[10:11]
  v_cvt_pk_bf16_f32 v34, v72, v73
  v_lshlrev_b32 v72, 16, v34
  v_and_b32 v73, 0xffff0000, v34
  v_cvt_pk_bf16_f32 v8, v74, v75
  v_lshlrev_b32 v74, 16, v8
  v_and_b32 v75, 0xffff0000, v8
  v_lshlrev_b32 v10, 16, v35
  v_and_b32 v11, 0xffff0000, v35
  v_pk_add_f32 v[74:75], v[74:75], v[10:11]
  v_cvt_pk_bf16_f32 v35, v74, v75
  v_lshlrev_b32 v74, 16, v35
  v_and_b32 v75, 0xffff0000, v35
  buffer_store_dwordx4 v[32:35], v15, s[4:7], s21 offen offset:512 sc1
  v_and_b32 v3, 63, v0
  v_and_b32 v2, 7, v3
  v_lshlrev_b32 v5, 2, v2
  s_lshl_b32 s17, s16, 5
  v_add_u32 v1, s17, v5
  v_pk_add_f32 v[6:7], v[36:37], v[38:39]
  v_pk_add_f32 v[6:7], v[6:7], v[40:41]
  v_pk_add_f32 v[6:7], v[6:7], v[42:43]
  v_pk_add_f32 v[6:7], v[6:7], v[44:45]
  v_pk_add_f32 v[6:7], v[6:7], v[46:47]
  v_pk_add_f32 v[6:7], v[6:7], v[48:49]
  v_pk_add_f32 v[6:7], v[6:7], v[50:51]
  v_pk_add_f32 v[6:7], v[6:7], v[52:53]
  v_pk_add_f32 v[6:7], v[6:7], v[54:55]
  v_pk_add_f32 v[6:7], v[6:7], v[56:57]
  v_pk_add_f32 v[6:7], v[6:7], v[58:59]
  v_pk_add_f32 v[6:7], v[6:7], v[60:61]
  v_pk_add_f32 v[6:7], v[6:7], v[62:63]
  v_pk_add_f32 v[6:7], v[6:7], v[64:65]
  v_pk_add_f32 v[6:7], v[6:7], v[66:67]
  v_pk_add_f32 v[6:7], v[6:7], v[68:69]
  v_pk_add_f32 v[6:7], v[6:7], v[70:71]
  v_pk_add_f32 v[6:7], v[6:7], v[72:73]
  v_pk_add_f32 v[6:7], v[6:7], v[74:75]
  v_add_f32 v4, v6, v7
  s_nop 1
  v_add_f32_dpp v4, v4, v4 row_ror:8 row_mask:0xf bank_mask:0xf
  v_mov_b32 v2, v4
  s_nop 1
  v_permlane16_swap_b32 v4, v2
  v_add_f32 v4, v4, v2
  v_mov_b32 v2, v4
  s_nop 1
  v_permlane32_swap_b32 v4, v2
  v_add_f32 v4, v4, v2
  ds_write_b32 v1, v4 offset:0
  s_waitcnt lgkmcnt(0)
  s_barrier
  ds_read_b32 v4, v5 offset:0
  ds_read_b32 v2, v5 offset:32
  s_waitcnt lgkmcnt(0)
  v_add_f32 v4, v4, v2
  v_mul_f32 v6, 0xbacccccd, v4
  v_mov_b32 v7, v6
  v_pk_add_f32 v[36:37], v[36:37], v[6:7]
  v_pk_add_f32 v[38:39], v[38:39], v[6:7]
  v_pk_add_f32 v[40:41], v[40:41], v[6:7]
  v_pk_add_f32 v[42:43], v[42:43], v[6:7]
  v_pk_add_f32 v[44:45], v[44:45], v[6:7]
  v_pk_add_f32 v[46:47], v[46:47], v[6:7]
  v_pk_add_f32 v[48:49], v[48:49], v[6:7]
  v_pk_add_f32 v[50:51], v[50:51], v[6:7]
  v_pk_add_f32 v[52:53], v[52:53], v[6:7]
  v_pk_add_f32 v[54:55], v[54:55], v[6:7]
  v_pk_add_f32 v[56:57], v[56:57], v[6:7]
  v_pk_add_f32 v[58:59], v[58:59], v[6:7]
  v_pk_add_f32 v[60:61], v[60:61], v[6:7]
  v_pk_add_f32 v[62:63], v[62:63], v[6:7]
  v_pk_add_f32 v[64:65], v[64:65], v[6:7]
  v_pk_add_f32 v[66:67], v[66:67], v[6:7]
  v_pk_add_f32 v[68:69], v[68:69], v[6:7]
  v_pk_add_f32 v[70:71], v[70:71], v[6:7]
  v_pk_add_f32 v[72:73], v[72:73], v[6:7]
  v_pk_add_f32 v[74:75], v[74:75], v[6:7]
  v_pk_mul_f32 v[6:7], v[36:37], v[36:37]
  v_pk_fma_f32 v[6:7], v[38:39], v[38:39], v[6:7]
  v_pk_fma_f32 v[6:7], v[40:41], v[40:41], v[6:7]
  v_pk_fma_f32 v[6:7], v[42:43], v[42:43], v[6:7]
  v_pk_fma_f32 v[6:7], v[44:45], v[44:45], v[6:7]
  v_pk_fma_f32 v[6:7], v[46:47], v[46:47], v[6:7]
  v_pk_fma_f32 v[6:7], v[48:49], v[48:49], v[6:7]
  v_pk_fma_f32 v[6:7], v[50:51], v[50:51], v[6:7]
  v_pk_fma_f32 v[6:7], v[52:53], v[52:53], v[6:7]
  v_pk_fma_f32 v[6:7], v[54:55], v[54:55], v[6:7]
  v_pk_fma_f32 v[6:7], v[56:57], v[56:57], v[6:7]
  v_pk_fma_f32 v[6:7], v[58:59], v[58:59], v[6:7]
  v_pk_fma_f32 v[6:7], v[60:61], v[60:61], v[6:7]
  v_pk_fma_f32 v[6:7], v[62:63], v[62:63], v[6:7]
  v_pk_fma_f32 v[6:7], v[64:65], v[64:65], v[6:7]
  v_pk_fma_f32 v[6:7], v[66:67], v[66:67], v[6:7]
  v_pk_fma_f32 v[6:7], v[68:69], v[68:69], v[6:7]
  v_pk_fma_f32 v[6:7], v[70:71], v[70:71], v[6:7]
  v_pk_fma_f32 v[6:7], v[72:73], v[72:73], v[6:7]
  v_pk_fma_f32 v[6:7], v[74:75], v[74:75], v[6:7]
  v_add_f32 v4, v6, v7
  s_nop 1
  v_add_f32_dpp v4, v4, v4 row_ror:8 row_mask:0xf bank_mask:0xf
  v_mov_b32 v2, v4
  s_nop 1
  v_permlane16_swap_b32 v4, v2
  v_add_f32 v4, v4, v2
  v_mov_b32 v2, v4
  s_nop 1
  v_permlane32_swap_b32 v4, v2
  v_add_f32 v4, v4, v2
  ds_write_b32 v1, v4 offset:64
  s_waitcnt lgkmcnt(0)
  s_barrier
  ds_read_b32 v4, v5 offset:64
  ds_read_b32 v2, v5 offset:96
  s_waitcnt lgkmcnt(0)
  v_add_f32 v4, v4, v2
  v_mov_b32 v2, 0x3727c5ac
  v_fmac_f32 v2, 0x3acccccd, v4
  v_rsq_f32 v6, v2
  s_nop 0
  v_mov_b32 v7, v6
  v_pk_mul_f32 v[36:37], v[36:37], v[6:7]
  v_pk_mul_f32 v[38:39], v[38:39], v[6:7]
  v_pk_mul_f32 v[40:41], v[40:41], v[6:7]
  v_pk_mul_f32 v[42:43], v[42:43], v[6:7]
  v_pk_mul_f32 v[44:45], v[44:45], v[6:7]
  v_pk_mul_f32 v[46:47], v[46:47], v[6:7]
  v_pk_mul_f32 v[48:49], v[48:49], v[6:7]
  v_pk_mul_f32 v[50:51], v[50:51], v[6:7]
  v_pk_mul_f32 v[52:53], v[52:53], v[6:7]
  v_pk_mul_f32 v[54:55], v[54:55], v[6:7]
  v_pk_mul_f32 v[56:57], v[56:57], v[6:7]
  v_pk_mul_f32 v[58:59], v[58:59], v[6:7]
  v_pk_mul_f32 v[60:61], v[60:61], v[6:7]
  v_pk_mul_f32 v[62:63], v[62:63], v[6:7]
  v_pk_mul_f32 v[64:65], v[64:65], v[6:7]
  v_pk_mul_f32 v[66:67], v[66:67], v[6:7]
  v_pk_mul_f32 v[68:69], v[68:69], v[6:7]
  v_pk_mul_f32 v[70:71], v[70:71], v[6:7]
  v_pk_mul_f32 v[72:73], v[72:73], v[6:7]
  v_pk_mul_f32 v[74:75], v[74:75], v[6:7]
  v_cvt_pk_bf16_f32 v16, v36, v37
  v_cvt_pk_bf16_f32 v17, v38, v39
  v_cvt_pk_bf16_f32 v18, v40, v41
  v_cvt_pk_bf16_f32 v19, v42, v43
  v_cvt_pk_bf16_f32 v20, v44, v45
  v_cvt_pk_bf16_f32 v21, v46, v47
  v_cvt_pk_bf16_f32 v22, v48, v49
  v_cvt_pk_bf16_f32 v23, v50, v51
  v_cvt_pk_bf16_f32 v24, v52, v53
  v_cvt_pk_bf16_f32 v25, v54, v55
  v_cvt_pk_bf16_f32 v26, v56, v57
  v_cvt_pk_bf16_f32 v27, v58, v59
  v_cvt_pk_bf16_f32 v28, v60, v61
  v_cvt_pk_bf16_f32 v29, v62, v63
  v_cvt_pk_bf16_f32 v30, v64, v65
  v_cvt_pk_bf16_f32 v31, v66, v67
  v_cvt_pk_bf16_f32 v32, v68, v69
  v_cvt_pk_bf16_f32 v33, v70, v71
  v_cvt_pk_bf16_f32 v34, v72, v73
  v_cvt_pk_bf16_f32 v35, v74, v75
  v_add_u32 v6, 0x1000, v14
  v_add_u32 v7, 0x2000, v14
  buffer_store_dwordx4 v[16:19], v14, s[4:7], s34 offen offset:0 sc1
  buffer_store_dwordx4 v[20:23], v14, s[4:7], s34 offen offset:2048 sc1
  buffer_store_dwordx4 v[24:27], v6, s[4:7], s34 offen offset:0 sc1
  buffer_store_dwordx4 v[28:31], v6, s[4:7], s34 offen offset:2048 sc1
  buffer_store_dwordx4 v[32:35], v7, s[4:7], s34 offen offset:0 sc1
redln2_exit1:
  s_endpgm
.globl qkvb_kernel
.p2align 8
.type qkvb_kernel,@function
qkvb_kernel:
  s_cmp_ge_u32 s2, 256
  s_cbranch_scc1 qkvb_exit1
  s_load_dwordx2 s[12:13], s[0:1], 96
  v_lshrrev_b32 v2, 6, v0
  v_and_b32 v3, 63, v0
  s_and_b32 s17, s2, 7
  v_readfirstlane_b32 s16, v2
  v_lshlrev_b32 v1, 4, v3
  s_lshr_b32 s18, s2, 3
  s_waitcnt lgkmcnt(0)
  s_mov_b32 s4, s12
  s_mov_b32 s5, s13
  s_mov_b32 s6, 0x10000000
  s_mov_b32 s7, 0x20000
  s_lshl_b32 s21, s18, 2
  s_add_u32 s21, s21, s16
  s_mul_i32 s21, s21, 20480
  s_add_u32 s21, s21, 54525952
  s_mul_i32 s22, s16, 20480
  v_add_u32 v7, 40960, v1
  v_mov_b32 v6, v1
  s_add_u32 m0, s22, 0
  s_add_u32 s23, s21, 0
  buffer_load_dwordx4 v1, s[4:7], s23 offen offset:0 lds
  buffer_load_dwordx4 v1, s[4:7], s23 offen offset:1024 lds
  buffer_load_dwordx4 v1, s[4:7], s23 offen offset:2048 lds
  buffer_load_dwordx4 v1, s[4:7], s23 offen offset:3072 lds
  s_cmp_eq_u32 s16, 0
  s_cbranch_scc1 qkvb_w0_2
  s_cmp_eq_u32 s16, 1
  s_cbranch_scc1 qkvb_w1_3
  s_cmp_eq_u32 s16, 2
  s_cbranch_scc1 qkvb_w2_4
  s_branch qkvb_w3_5
qkvb_w0_2:
  s_mul_i32 s30, s17, 5
  s_add_u32 s30, s30, 0
  s_mul_i32 s30, s30, 20480
  s_add_u32 s30, s30, 87556096
  s_mul_i32 s31, s17, 5
  s_add_u32 s31, s31, 1
  s_mul_i32 s31, s31, 20480
  s_add_u32 s31, s31, 87556096
  s_mul_i32 s32, s17, 5
  s_add_u32 s32, s32, 2
  s_mul_i32 s32, s32, 20480
  s_add_u32 s32, s32, 87556096
  s_mul_i32 s33, s17, 5
  s_add_u32 s33, s33, 3
  s_mul_i32 s33, s33, 20480
  s_add_u32 s33, s33, 87556096
  buffer_load_dwordx4 v[72:75], v1, s[4:7], s30 offen offset:0
  buffer_load_dwordx4 v[76:79], v1, s[4:7], s31 offen offset:0
  buffer_load_dwordx4 v[80:83], v1, s[4:7], s32 offen offset:0
  buffer_load_dwordx4 v[84:87], v1, s[4:7], s33 offen offset:0
  buffer_load_dwordx4 v[88:91], v1, s[4:7], s30 offen offset:1024
  buffer_load_dwordx4 v[92:95], v1, s[4:7], s31 offen offset:1024
  buffer_load_dwordx4 v[96:99], v1, s[4:7], s32 offen offset:1024
  buffer_load_dwordx4 v[100:103], v1, s[4:7], s33 offen offset:1024
  buffer_load_dwordx4 v[104:107], v1, s[4:7], s30 offen offset:2048
  buffer_load_dwordx4 v[108:111], v1, s[4:7], s31 offen offset:2048
  buffer_load_dwordx4 v[112:115], v1, s[4:7], s32 offen offset:2048
  buffer_load_dwordx4 v[116:119], v1, s[4:7], s33 offen offset:2048
  s_add_u32 m0, s22, 4096
  s_add_u32 s23, s21, 4096
  buffer_load_dwordx4 v1, s[4:7], s23 offen offset:0 lds
  buffer_load_dwordx4 v1, s[4:7], s23 offen offset:1024 lds
  buffer_load_dwordx4 v1, s[4:7], s23 offen offset:2048 lds
  buffer_load_dwordx4 v1, s[4:7], s23 offen offset:3072 lds
  s_add_u32 m0, s22, 8192
  s_add_u32 s23, s21, 8192
  buffer_load_dwordx4 v1, s[4:7], s23 offen offset:0 lds
  buffer_load_dwordx4 v1, s[4:7], s23 offen offset:1024 lds
  buffer_load_dwordx4 v1, s[4:7], s23 offen offset:2048 lds
  buffer_load_dwordx4 v1, s[4:7], s23 offen offset:3072 lds
  s_add_u32 m0, s22, 12288
  s_add_u32 s23, s21, 12288
  buffer_load_dwordx4 v1, s[4:7], s23 offen offset:0 lds
  buffer_load_dwordx4 v1, s[4:7], s23 offen offset:1024 lds
  buffer_load_dwordx4 v1, s[4:7], s23 offen offset:2048 lds
  buffer_load_dwordx4 v1, s[4:7], s23 offen offset:3072 lds
  s_add_u32 m0, s22, 16384
  s_add_u32 s23, s21, 16384
  buffer_load_dwordx4 v1, s[4:7], s23 offen offset:0 lds
  buffer_load_dwordx4 v1, s[4:7], s23 offen offset:1024 lds
  buffer_load_dwordx4 v1, s[4:7], s23 offen offset:2048 lds
  buffer_load_dwordx4 v1, s[4:7], s23 offen offset:3072 lds
  s_waitcnt vmcnt(28)
  s_barrier
  ds_read_b128 v[136:139], v6 offset:0
  ds_read_b128 v[140:143], v6 offset:20480
  ds_read_b128 v[144:147], v7 offset:0
  ds_read_b128 v[148:151], v7 offset:20480
  buffer_load_dwordx4 v[120:123], v1, s[4:7], s30 offen offset:3072
  buffer_load_dwordx4 v[124:127], v1, s[4:7], s31 offen offset:3072
  buffer_load_dwordx4 v[128:131], v1, s[4:7], s32 offen offset:3072
  buffer_load_dwordx4 v[132:135], v1, s[4:7], s33 offen offset:3072
  s_waitcnt vmcnt(28)
  ds_read_b128 v[152:155], v6 offset:1024
  ds_read_b128 v[156:159], v6 offset:21504
  ds_read_b128 v[160:163], v7 offset:1024
  ds_read_b128 v[164:167], v7 offset:21504
  s_waitcnt lgkmcnt(4)
  v_mfma_f32_16x16x32_bf16 v[8:11], v[72:75], v[136:139], 0
  v_mfma_f32_16x16x32_bf16 v[12:15], v[72:75], v[140:143], 0
  v_mfma_f32_16x16x32_bf16 v[16:19], v[72:75], v[144:147], 0
  v_mfma_f32_16x16x32_bf16 v[20:23], v[72:75], v[148:151], 0
  v_mfma_f32_16x16x32_bf16 v[24:27], v[76:79], v[136:139], 0
  v_mfma_f32_16x16x32_bf16 v[28:31], v[76:79], v[140:143], 0
  v_mfma_f32_16x16x32_bf16 v[32:35], v[76:79], v[144:147], 0
  v_mfma_f32_16x16x32_bf16 v[36:39], v[76:79], v[148:151], 0
  v_mfma_f32_16x16x32_bf16 v[40:43], v[80:83], v[136:139], 0
  v_mfma_f32_16x16x32_bf16 v[44:47], v[80:83], v[140:143], 0
  v_mfma_f32_16x16x32_bf16 v[48:51], v[80:83], v[144:147], 0
  v_mfma_f32_16x16x32_bf16 v[52:55], v[80:83], v[148:151], 0
  v_mfma_f32_16x16x32_bf16 v[56:59], v[84:87], v[136:139], 0
  v_mfma_f32_16x16x32_bf16 v[60:63], v[84:87], v[140:143], 0
  v_mfma_f32_16x16x32_bf16 v[64:67], v[84:87], v[144:147], 0
  v_mfma_f32_16x16x32_bf16 v[68:71], v[84:87], v[148:151], 0
  s_add_u32 s30, s30, 4096
  s_add_u32 s31, s31, 4096
  s_add_u32 s32, s32, 4096
  s_add_u32 s33, s33, 4096
  buffer_load_dwordx4 v[72:75], v1, s[4:7], s30 offen offset:0
  buffer_load_dwordx4 v[76:79], v1, s[4:7], s31 offen offset:0
  buffer_load_dwordx4 v[80:83], v1, s[4:7], s32 offen offset:0
  buffer_load_dwordx4 v[84:87], v1, s[4:7], s33 offen offset:0
  s_waitcnt vmcnt(28)
  ds_read_b128 v[136:139], v6 offset:2048
  ds_read_b128 v[140:143], v6 offset:22528
  ds_read_b128 v[144:147], v7 offset:2048
  ds_read_b128 v[148:151], v7 offset:22528
  s_waitcnt lgkmcnt(4)
  v_mfma_f32_16x16x32_bf16 v[8:11], v[88:91], v[152:155], v[8:11]
  v_mfma_f32_16x16x32_bf16 v[12:15], v[88:91], v[156:159], v[12:15]
  v_mfma_f32_16x16x32_bf16 v[16:19], v[88:91], v[160:163], v[16:19]
  v_mfma_f32_16x16x32_bf16 v[20:23], v[88:91], v[164:167], v[20:23]
  v_mfma_f32_16x16x32_bf16 v[24:27], v[92:95], v[152:155], v[24:27]
  v_mfma_f32_16x16x32_bf16 v[28:31], v[92:95], v[156:159], v[28:31]
  v_mfma_f32_16x16x32_bf16 v[32:35], v[92:95], v[160:163], v[32:35]
  v_mfma_f32_16x16x32_bf16 v[36:39], v[92:95], v[164:167], v[36:39]
  v_mfma_f32_16x16x32_bf16 v[40:43], v[96:99], v[152:155], v[40:43]
  v_mfma_f32_16x16x32_bf16 v[44:47], v[96:99], v[156:159], v[44:47]
  v_mfma_f32_16x16x32_bf16 v[48:51], v[96:99], v[160:163], v[48:51]
  v_mfma_f32_16x16x32_bf16 v[52:55], v[96:99], v[164:167], v[52:55]
  v_mfma_f32_16x16x32_bf16 v[56:59], v[100:103], v[152:155], v[56:59]
  v_mfma_f32_16x16x32_bf16 v[60:63], v[100:103], v[156:159], v[60:63]
  v_mfma_f32_16x16x32_bf16 v[64:67], v[100:103], v[160:163], v[64:67]
  v_mfma_f32_16x16x32_bf16 v[68:71], v[100:103], v[164:167], v[68:71]
  buffer_load_dwordx4 v[88:91], v1, s[4:7], s30 offen offset:1024
  buffer_load_dwordx4 v[92:95], v1, s[4:7], s31 offen offset:1024
  buffer_load_dwordx4 v[96:99], v1, s[4:7], s32 offen offset:1024
  buffer_load_dwordx4 v[100:103], v1, s[4:7], s33 offen offset:1024
  s_waitcnt vmcnt(28)
  ds_read_b128 v[152:155], v6 offset:3072
  ds_read_b128 v[156:159], v6 offset:23552
  ds_read_b128 v[160:163], v7 offset:3072
  ds_read_b128 v[164:167], v7 offset:23552
  s_waitcnt lgkmcnt(4)
  v_mfma_f32_16x16x32_bf16 v[8:11], v[104:107], v[136:139], v[8:11]
  v_mfma_f32_16x16x32_bf16 v[12:15], v[104:107], v[140:143], v[12:15]
  v_mfma_f32_16x16x32_bf16 v[16:19], v[104:107], v[144:147], v[16:19]
  v_mfma_f32_16x16x32_bf16 v[20:23], v[104:107], v[148:151], v[20:23]
  v_mfma_f32_16x16x32_bf16 v[24:27], v[108:111], v[136:139], v[24:27]
  v_mfma_f32_16x16x32_bf16 v[28:31], v[108:111], v[140:143], v[28:31]
  v_mfma_f32_16x16x32_bf16 v[32:35], v[108:111], v[144:147], v[32:35]
  v_mfma_f32_16x16x32_bf16 v[36:39], v[108:111], v[148:151], v[36:39]
  v_mfma_f32_16x16x32_bf16 v[40:43], v[112:115], v[136:139], v[40:43]
  v_mfma_f32_16x16x32_bf16 v[44:47], v[112:115], v[140:143], v[44:47]
  v_mfma_f32_16x16x32_bf16 v[48:51], v[112:115], v[144:147], v[48:51]
  v_mfma_f32_16x16x32_bf16 v[52:55], v[112:115], v[148:151], v[52:55]
  v_mfma_f32_16x16x32_bf16 v[56:59], v[116:119], v[136:139], v[56:59]
  v_mfma_f32_16x16x32_bf16 v[60:63], v[116:119], v[140:143], v[60:63]
  v_mfma_f32_16x16x32_bf16 v[64:67], v[116:119], v[144:147], v[64:67]
  v_mfma_f32_16x16x32_bf16 v[68:71], v[116:119], v[148:151], v[68:71]
  buffer_load_dwordx4 v[104:107], v1, s[4:7], s30 offen offset:2048
  buffer_load_dwordx4 v[108:111], v1, s[4:7], s31 offen offset:2048
  buffer_load_dwordx4 v[112:115], v1, s[4:7], s32 offen offset:2048
  buffer_load_dwordx4 v[116:119], v1, s[4:7], s33 offen offset:2048
  s_waitcnt vmcnt(12)
  s_barrier
  ds_read_b128 v[136:139], v6 offset:4096
  ds_read_b128 v[140:143], v6 offset:24576
  ds_read_b128 v[144:147], v7 offset:4096
  ds_read_b128 v[148:151], v7 offset:24576
  s_waitcnt lgkmcnt(4)
  v_mfma_f32_16x16x32_bf16 v[8:11], v[120:123], v[152:155], v[8:11]
  v_mfma_f32_16x16x32_bf16 v[12:15], v[120:123], v[156:159], v[12:15]
  v_mfma_f32_16x16x32_bf16 v[16:19], v[120:123], v[160:163], v[16:19]
  v_mfma_f32_16x16x32_bf16 v[20:23], v[120:123], v[164:167], v[20:23]
  v_mfma_f32_16x16x32_bf16 v[24:27], v[124:127], v[152:155], v[24:27]
  v_mfma_f32_16x16x32_bf16 v[28:31], v[124:127], v[156:159], v[28:31]
  v_mfma_f32_16x16x32_bf16 v[32:35], v[124:127], v[160:163], v[32:35]
  v_mfma_f32_16x16x32_bf16 v[36:39], v[124:127], v[164:167], v[36:39]
  v_mfma_f32_16x16x32_bf16 v[40:43], v[128:131], v[152:155], v[40:43]
  v_mfma_f32_16x16x32_bf16 v[44:47], v[128:131], v[156:159], v[44:47]
  v_mfma_f32_16x16x32_bf16 v[48:51], v[128:131], v[160:163], v[48:51]
  v_mfma_f32_16x16x32_bf16 v[52:55], v[128:131], v[164:167], v[52:55]
  v_mfma_f32_16x16x32_bf16 v[56:59], v[132:135], v[152:155], v[56:59]
  v_mfma_f32_16x16x32_bf16 v[60:63], v[132:135], v[156:159], v[60:63]
  v_mfma_f32_16x16x32_bf16 v[64:67], v[132:135], v[160:163], v[64:67]
  v_mfma_f32_16x16x32_bf16 v[68:71], v[132:135], v[164:167], v[68:71]
  s_mov_b32 s40, 0
  v_add_u32 v6, 4096, v6
  v_add_u32 v7, 4096, v7
qkvb_loop6:
  buffer_load_dwordx4 v[120:123], v1, s[4:7], s30 offen offset:3072
  buffer_load_dwordx4 v[124:127], v1, s[4:7], s31 offen offset:3072
  buffer_load_dwordx4 v[128:131], v1, s[4:7], s32 offen offset:3072
  buffer_load_dwordx4 v[132:135], v1, s[4:7], s33 offen offset:3072
  s_waitcnt vmcnt(12)
  ds_read_b128 v[152:155], v6 offset:1024
  ds_read_b128 v[156:159], v6 offset:21504
  ds_read_b128 v[160:163], v7 offset:1024
  ds_read_b128 v[164:167], v7 offset:21504
  s_waitcnt lgkmcnt(4)
  v_mfma_f32_16x16x32_bf16 v[8:11], v[72:75], v[136:139], v[8:11]
  v_mfma_f32_16x16x32_bf16 v[12:15], v[72:75], v[140:143], v[12:15]
  v_mfma_f32_16x16x32_bf16 v[16:19], v[72:75], v[144:147], v[16:19]
  v_mfma_f32_16x16x32_bf16 v[20:23], v[72:75], v[148:151], v[20:23]
  v_mfma_f32_16x16x32_bf16 v[24:27], v[76:79], v[136:139], v[24:27]
  v_mfma_f32_16x16x32_bf16 v[28:31], v[76:79], v[140:143], v[28:31]
  v_mfma_f32_16x16x32_bf16 v[32:35], v[76:79], v[144:147], v[32:35]
  v_mfma_f32_16x16x32_bf16 v[36:39], v[76:79], v[148:151], v[36:39]
  v_mfma_f32_16x16x32_bf16 v[40:43], v[80:83], v[136:139], v[40:43]
  v_mfma_f32_16x16x32_bf16 v[44:47], v[80:83], v[140:143], v[44:47]
  v_mfma_f32_16x16x32_bf16 v[48:51], v[80:83], v[144:147], v[48:51]
  v_mfma_f32_16x16x32_bf16 v[52:55], v[80:83], v[148:151], v[52:55]
  v_mfma_f32_16x16x32_bf16 v[56:59], v[84:87], v[136:139], v[56:59]
  v_mfma_f32_16x16x32_bf16 v[60:63], v[84:87], v[140:143], v[60:63]
  v_mfma_f32_16x16x32_bf16 v[64:67], v[84:87], v[144:147], v[64:67]
  v_mfma_f32_16x16x32_bf16 v[68:71], v[84:87], v[148:151], v[68:71]
  s_add_u32 s30, s30, 4096
  s_add_u32 s31, s31, 4096
  s_add_u32 s32, s32, 4096
  s_add_u32 s33, s33, 4096
  buffer_load_dwordx4 v[72:75], v1, s[4:7], s30 offen offset:0
  buffer_load_dwordx4 v[76:79], v1, s[4:7], s31 offen offset:0
  buffer_load_dwordx4 v[80:83], v1, s[4:7], s32 offen offset:0
  buffer_load_dwordx4 v[84:87], v1, s[4:7], s33 offen offset:0
  s_waitcnt vmcnt(12)
  ds_read_b128 v[136:139], v6 offset:2048
  ds_read_b128 v[140:143], v6 offset:22528
  ds_read_b128 v[144:147], v7 offset:2048
  ds_read_b128 v[148:151], v7 offset:22528
  s_waitcnt lgkmcnt(4)
  v_mfma_f32_16x16x32_bf16 v[8:11], v[88:91], v[152:155], v[8:11]
  v_mfma_f32_16x16x32_bf16 v[12:15], v[88:91], v[156:159], v[12:15]
  v_mfma_f32_16x16x32_bf16 v[16:19], v[88:91], v[160:163], v[16:19]
  v_mfma_f32_16x16x32_bf16 v[20:23], v[88:91], v[164:167], v[20:23]
  v_mfma_f32_16x16x32_bf16 v[24:27], v[92:95], v[152:155], v[24:27]
  v_mfma_f32_16x16x32_bf16 v[28:31], v[92:95], v[156:159], v[28:31]
  v_mfma_f32_16x16x32_bf16 v[32:35], v[92:95], v[160:163], v[32:35]
  v_mfma_f32_16x16x32_bf16 v[36:39], v[92:95], v[164:167], v[36:39]
  v_mfma_f32_16x16x32_bf16 v[40:43], v[96:99], v[152:155], v[40:43]
  v_mfma_f32_16x16x32_bf16 v[44:47], v[96:99], v[156:159], v[44:47]
  v_mfma_f32_16x16x32_bf16 v[48:51], v[96:99], v[160:163], v[48:51]
  v_mfma_f32_16x16x32_bf16 v[52:55], v[96:99], v[164:167], v[52:55]
  v_mfma_f32_16x16x32_bf16 v[56:59], v[100:103], v[152:155], v[56:59]
  v_mfma_f32_16x16x32_bf16 v[60:63], v[100:103], v[156:159], v[60:63]
  v_mfma_f32_16x16x32_bf16 v[64:67], v[100:103], v[160:163], v[64:67]
  v_mfma_f32_16x16x32_bf16 v[68:71], v[100:103], v[164:167], v[68:71]
  buffer_load_dwordx4 v[88:91], v1, s[4:7], s30 offen offset:1024
  buffer_load_dwordx4 v[92:95], v1, s[4:7], s31 offen offset:1024
  buffer_load_dwordx4 v[96:99], v1, s[4:7], s32 offen offset:1024
  buffer_load_dwordx4 v[100:103], v1, s[4:7], s33 offen offset:1024
  s_waitcnt vmcnt(12)
  ds_read_b128 v[152:155], v6 offset:3072
  ds_read_b128 v[156:159], v6 offset:23552
  ds_read_b128 v[160:163], v7 offset:3072
  ds_read_b128 v[164:167], v7 offset:23552
  s_waitcnt lgkmcnt(4)
  v_mfma_f32_16x16x32_bf16 v[8:11], v[104:107], v[136:139], v[8:11]
  v_mfma_f32_16x16x32_bf16 v[12:15], v[104:107], v[140:143], v[12:15]
  v_mfma_f32_16x16x32_bf16 v[16:19], v[104:107], v[144:147], v[16:19]
  v_mfma_f32_16x16x32_bf16 v[20:23], v[104:107], v[148:151], v[20:23]
  v_mfma_f32_16x16x32_bf16 v[24:27], v[108:111], v[136:139], v[24:27]
  v_mfma_f32_16x16x32_bf16 v[28:31], v[108:111], v[140:143], v[28:31]
  v_mfma_f32_16x16x32_bf16 v[32:35], v[108:111], v[144:147], v[32:35]
  v_mfma_f32_16x16x32_bf16 v[36:39], v[108:111], v[148:151], v[36:39]
  v_mfma_f32_16x16x32_bf16 v[40:43], v[112:115], v[136:139], v[40:43]
  v_mfma_f32_16x16x32_bf16 v[44:47], v[112:115], v[140:143], v[44:47]
  v_mfma_f32_16x16x32_bf16 v[48:51], v[112:115], v[144:147], v[48:51]
  v_mfma_f32_16x16x32_bf16 v[52:55], v[112:115], v[148:151], v[52:55]
  v_mfma_f32_16x16x32_bf16 v[56:59], v[116:119], v[136:139], v[56:59]
  v_mfma_f32_16x16x32_bf16 v[60:63], v[116:119], v[140:143], v[60:63]
  v_mfma_f32_16x16x32_bf16 v[64:67], v[116:119], v[144:147], v[64:67]
  v_mfma_f32_16x16x32_bf16 v[68:71], v[116:119], v[148:151], v[68:71]
  buffer_load_dwordx4 v[104:107], v1, s[4:7], s30 offen offset:2048
  buffer_load_dwordx4 v[108:111], v1, s[4:7], s31 offen offset:2048
  buffer_load_dwordx4 v[112:115], v1, s[4:7], s32 offen offset:2048
  buffer_load_dwordx4 v[116:119], v1, s[4:7], s33 offen offset:2048
  s_waitcnt vmcnt(12)
  ds_read_b128 v[136:139], v6 offset:4096
  ds_read_b128 v[140:143], v6 offset:24576
  ds_read_b128 v[144:147], v7 offset:4096
  ds_read_b128 v[148:151], v7 offset:24576
  s_waitcnt lgkmcnt(4)
  v_mfma_f32_16x16x32_bf16 v[8:11], v[120:123], v[152:155], v[8:11]
  v_mfma_f32_16x16x32_bf16 v[12:15], v[120:123], v[156:159], v[12:15]
  v_mfma_f32_16x16x32_bf16 v[16:19], v[120:123], v[160:163], v[16:19]
  v_mfma_f32_16x16x32_bf16 v[20:23], v[120:123], v[164:167], v[20:23]
  v_mfma_f32_16x16x32_bf16 v[24:27], v[124:127], v[152:155], v[24:27]
  v_mfma_f32_16x16x32_bf16 v[28:31], v[124:127], v[156:159], v[28:31]
  v_mfma_f32_16x16x32_bf16 v[32:35], v[124:127], v[160:163], v[32:35]
  v_mfma_f32_16x16x32_bf16 v[36:39], v[124:127], v[164:167], v[36:39]
  v_mfma_f32_16x16x32_bf16 v[40:43], v[128:131], v[152:155], v[40:43]
  v_mfma_f32_16x16x32_bf16 v[44:47], v[128:131], v[156:159], v[44:47]
  v_mfma_f32_16x16x32_bf16 v[48:51], v[128:131], v[160:163], v[48:51]
  v_mfma_f32_16x16x32_bf16 v[52:55], v[128:131], v[164:167], v[52:55]
  v_mfma_f32_16x16x32_bf16 v[56:59], v[132:135], v[152:155], v[56:59]
  v_mfma_f32_16x16x32_bf16 v[60:63], v[132:135], v[156:159], v[60:63]
  v_mfma_f32_16x16x32_bf16 v[64:67], v[132:135], v[160:163], v[64:67]
  v_mfma_f32_16x16x32_bf16 v[68:71], v[132:135], v[164:167], v[68:71]
  v_add_u32 v6, 4096, v6
  v_add_u32 v7, 4096, v7
  s_add_u32 s40, s40, 1
  s_cmp_lt_u32 s40, 4
  s_cbranch_scc1 qkvb_loop6
  s_waitcnt vmcnt(0) lgkmcnt(0)
  v_and_b32 v2, 63, v0
  v_and_b32 v3, 15, v2
  v_lshrrev_b32 v4, 4, v2
  s_lshl_b32 s41, s17, 19
  s_lshl_b32 s42, s18, 12
  s_add_u32 s41, s41, s42
  s_mov_b32 s46, 0x3ea52b5c
  s_mov_b32 s47, 0x3ea52b5c
  v_lshlrev_b32 v5, 2, v4
  v_add_u32 v5, 0, v5
  v_mul_u32_u24 v168, 205, v5
  v_lshrrev_b32 v168, 12, v168
  v_mul_u32_u24 v6, 20, v168
  v_sub_u32 v5, v5, v6
  v_lshlrev_b32 v168, 17, v168
  v_lshrrev_b32 v6, 4, v5
  v_lshl_add_u32 v168, v6, 10, v168
  v_bfe_u32 v6, v5, 2, 1
  v_lshl_add_u32 v168, v6, 9, v168
  v_bfe_u32 v6, v5, 3, 1
  v_lshl_add_u32 v168, v6, 3, v168
  v_lshl_add_u32 v168, v3, 4, v168
  v_lshlrev_b32 v5, 2, v4
  v_add_u32 v5, 16, v5
  v_mul_u32_u24 v169, 205, v5
  v_lshrrev_b32 v169, 12, v169
  v_mul_u32_u24 v6, 20, v169
  v_sub_u32 v5, v5, v6
  v_lshlrev_b32 v169, 17, v169
  v_lshrrev_b32 v6, 4, v5
  v_lshl_add_u32 v169, v6, 10, v169
  v_bfe_u32 v6, v5, 2, 1
  v_lshl_add_u32 v169, v6, 9, v169
  v_bfe_u32 v6, v5, 3, 1
  v_lshl_add_u32 v169, v6, 3, v169
  v_lshl_add_u32 v169, v3, 4, v169
  v_lshlrev_b32 v5, 2, v4
  v_add_u32 v5, 32, v5
  v_mul_u32_u24 v170, 205, v5
  v_lshrrev_b32 v170, 12, v170
  v_mul_u32_u24 v6, 20, v170
  v_sub_u32 v5, v5, v6
  v_lshlrev_b32 v170, 17, v170
  v_lshrrev_b32 v6, 4, v5
  v_lshl_add_u32 v170, v6, 10, v170
  v_bfe_u32 v6, v5, 2, 1
  v_lshl_add_u32 v170, v6, 9, v170
  v_bfe_u32 v6, v5, 3, 1
  v_lshl_add_u32 v170, v6, 3, v170
  v_lshl_add_u32 v170, v3, 4, v170
  v_lshlrev_b32 v5, 2, v4
  v_add_u32 v5, 48, v5
  v_mul_u32_u24 v171, 205, v5
  v_lshrrev_b32 v171, 12, v171
  v_mul_u32_u24 v6, 20, v171
  v_sub_u32 v5, v5, v6
  v_lshlrev_b32 v171, 17, v171
  v_lshrrev_b32 v6, 4, v5
  v_lshl_add_u32 v171, v6, 10, v171
  v_bfe_u32 v6, v5, 2, 1
  v_lshl_add_u32 v171, v6, 9, v171
  v_bfe_u32 v6, v5, 3, 1
  v_lshl_add_u32 v171, v6, 3, v171
  v_lshl_add_u32 v171, v3, 4, v171
  v_pk_mul_f32 v[8:9], v[8:9], s[46:47]
  v_pk_mul_f32 v[10:11], v[10:11], s[46:47]
  v_cvt_pk_bf16_f32 v136, v8, v9
  v_cvt_pk_bf16_f32 v137, v10, v11
  s_add_u32 s43, s41, 37748736
  buffer_store_dwordx2 v[136:137], v168, s[4:7], s43 offen sc1
  v_pk_mul_f32 v[12:13], v[12:13], s[46:47]
  v_pk_mul_f32 v[14:15], v[14:15], s[46:47]
  v_cvt_pk_bf16_f32 v138, v12, v13
  v_cvt_pk_bf16_f32 v139, v14, v15
  s_add_u32 s43, s41, 37748992
  buffer_store_dwordx2 v[138:139], v168, s[4:7], s43 offen sc1
  v_pk_mul_f32 v[16:17], v[16:17], s[46:47]
  v_pk_mul_f32 v[18:19], v[18:19], s[46:47]
  v_cvt_pk_bf16_f32 v140, v16, v17
  v_cvt_pk_bf16_f32 v141, v18, v19
  s_add_u32 s43, s41, 37750784
  buffer_store_dwordx2 v[140:141], v168, s[4:7], s43 offen sc1
  v_pk_mul_f32 v[20:21], v[20:21], s[46:47]
  v_pk_mul_f32 v[22:23], v[22:23], s[46:47]
  v_cvt_pk_bf16_f32 v142, v20, v21
  v_cvt_pk_bf16_f32 v143, v22, v23
  s_add_u32 s43, s41, 37751040
  buffer_store_dwordx2 v[142:143], v168, s[4:7], s43 offen sc1
  v_pk_mul_f32 v[24:25], v[24:25], s[46:47]
  v_pk_mul_f32 v[26:27], v[26:27], s[46:47]
  v_cvt_pk_bf16_f32 v144, v24, v25
  v_cvt_pk_bf16_f32 v145, v26, v27
  s_add_u32 s43, s41, 37748736
  buffer_store_dwordx2 v[144:145], v169, s[4:7], s43 offen sc1
  v_pk_mul_f32 v[28:29], v[28:29], s[46:47]
  v_pk_mul_f32 v[30:31], v[30:31], s[46:47]
  v_cvt_pk_bf16_f32 v146, v28, v29
  v_cvt_pk_bf16_f32 v147, v30, v31
  s_add_u32 s43, s41, 37748992
  buffer_store_dwordx2 v[146:147], v169, s[4:7], s43 offen sc1
  v_pk_mul_f32 v[32:33], v[32:33], s[46:47]
  v_pk_mul_f32 v[34:35], v[34:35], s[46:47]
  v_cvt_pk_bf16_f32 v148, v32, v33
  v_cvt_pk_bf16_f32 v149, v34, v35
  s_add_u32 s43, s41, 37750784
  buffer_store_dwordx2 v[148:149], v169, s[4:7], s43 offen sc1
  v_pk_mul_f32 v[36:37], v[36:37], s[46:47]
  v_pk_mul_f32 v[38:39], v[38:39], s[46:47]
  v_cvt_pk_bf16_f32 v150, v36, v37
  v_cvt_pk_bf16_f32 v151, v38, v39
  s_add_u32 s43, s41, 37751040
  buffer_store_dwordx2 v[150:151], v169, s[4:7], s43 offen sc1
  v_pk_mul_f32 v[40:41], v[40:41], s[46:47]
  v_pk_mul_f32 v[42:43], v[42:43], s[46:47]
  v_cvt_pk_bf16_f32 v136, v40, v41
  v_cvt_pk_bf16_f32 v137, v42, v43
  s_add_u32 s43, s41, 37748736
  buffer_store_dwordx2 v[136:137], v170, s[4:7], s43 offen sc1
  v_pk_mul_f32 v[44:45], v[44:45], s[46:47]
  v_pk_mul_f32 v[46:47], v[46:47], s[46:47]
  v_cvt_pk_bf16_f32 v138, v44, v45
  v_cvt_pk_bf16_f32 v139, v46, v47
  s_add_u32 s43, s41, 37748992
  buffer_store_dwordx2 v[138:139], v170, s[4:7], s43 offen sc1
  v_pk_mul_f32 v[48:49], v[48:49], s[46:47]
  v_pk_mul_f32 v[50:51], v[50:51], s[46:47]
  v_cvt_pk_bf16_f32 v140, v48, v49
  v_cvt_pk_bf16_f32 v141, v50, v51
  s_add_u32 s43, s41, 37750784
  buffer_store_dwordx2 v[140:141], v170, s[4:7], s43 offen sc1
  v_pk_mul_f32 v[52:53], v[52:53], s[46:47]
  v_pk_mul_f32 v[54:55], v[54:55], s[46:47]
  v_cvt_pk_bf16_f32 v142, v52, v53
  v_cvt_pk_bf16_f32 v143, v54, v55
  s_add_u32 s43, s41, 37751040
  buffer_store_dwordx2 v[142:143], v170, s[4:7], s43 offen sc1
  v_pk_mul_f32 v[56:57], v[56:57], s[46:47]
  v_pk_mul_f32 v[58:59], v[58:59], s[46:47]
  v_cvt_pk_bf16_f32 v144, v56, v57
  v_cvt_pk_bf16_f32 v145, v58, v59
  s_add_u32 s43, s41, 37748736
  buffer_store_dwordx2 v[144:145], v171, s[4:7], s43 offen sc1
  v_pk_mul_f32 v[60:61], v[60:61], s[46:47]
  v_pk_mul_f32 v[62:63], v[62:63], s[46:47]
  v_cvt_pk_bf16_f32 v146, v60, v61
  v_cvt_pk_bf16_f32 v147, v62, v63
  s_add_u32 s43, s41, 37748992
  buffer_store_dwordx2 v[146:147], v171, s[4:7], s43 offen sc1
  v_pk_mul_f32 v[64:65], v[64:65], s[46:47]
  v_pk_mul_f32 v[66:67], v[66:67], s[46:47]
  v_cvt_pk_bf16_f32 v148, v64, v65
  v_cvt_pk_bf16_f32 v149, v66, v67
  s_add_u32 s43, s41, 37750784
  buffer_store_dwordx2 v[148:149], v171, s[4:7], s43 offen sc1
  v_pk_mul_f32 v[68:69], v[68:69], s[46:47]
  v_pk_mul_f32 v[70:71], v[70:71], s[46:47]
  v_cvt_pk_bf16_f32 v150, v68, v69
  v_cvt_pk_bf16_f32 v151, v70, v71
  s_add_u32 s43, s41, 37751040
  buffer_store_dwordx2 v[150:151], v171, s[4:7], s43 offen sc1
  s_branch qkvb_exit1
qkvb_w1_3:
  s_mul_i32 s30, s17, 5
  s_add_u32 s30, s30, 4
  s_mul_i32 s30, s30, 20480
  s_add_u32 s30, s30, 87556096
  s_mul_i32 s31, s17, 5
  s_add_u32 s31, s31, 40
  s_mul_i32 s31, s31, 20480
  s_add_u32 s31, s31, 87556096
  s_mul_i32 s32, s17, 5
  s_add_u32 s32, s32, 41
  s_mul_i32 s32, s32, 20480
  s_add_u32 s32, s32, 87556096
  s_mul_i32 s33, s17, 5
  s_add_u32 s33, s33, 42
  s_mul_i32 s33, s33, 20480
  s_add_u32 s33, s33, 87556096
  buffer_load_dwordx4 v[72:75], v1, s[4:7], s30 offen offset:0
  buffer_load_dwordx4 v[76:79], v1, s[4:7], s31 offen offset:0
  buffer_load_dwordx4 v[80:83], v1, s[4:7], s32 offen offset:0
  buffer_load_dwordx4 v[84:87], v1, s[4:7], s33 offen offset:0
  buffer_load_dwordx4 v[88:91], v1, s[4:7], s30 offen offset:1024
  buffer_load_dwordx4 v[92:95], v1, s[4:7], s31 offen offset:1024
  buffer_load_dwordx4 v[96:99], v1, s[4:7], s32 offen offset:1024
  buffer_load_dwordx4 v[100:103], v1, s[4:7], s33 offen offset:1024
  buffer_load_dwordx4 v[104:107], v1, s[4:7], s30 offen offset:2048
  buffer_load_dwordx4 v[108:111], v1, s[4:7], s31 offen offset:2048
  buffer_load_dwordx4 v[112:115], v1, s[4:7], s32 offen offset:2048
  buffer_load_dwordx4 v[116:119], v1, s[4:7], s33 offen offset:2048
  s_add_u32 m0, s22, 4096
  s_add_u32 s23, s21, 4096
  buffer_load_dwordx4 v1, s[4:7], s23 offen offset:0 lds
  buffer_load_dwordx4 v1, s[4:7], s23 offen offset:1024 lds
  buffer_load_dwordx4 v1, s[4:7], s23 offen offset:2048 lds
  buffer_load_dwordx4 v1, s[4:7], s23 offen offset:3072 lds
  s_add_u32 m0, s22, 8192
  s_add_u32 s23, s21, 8192
  buffer_load_dwordx4 v1, s[4:7], s23 offen offset:0 lds
  buffer_load_dwordx4 v1, s[4:7], s23 offen offset:1024 lds
  buffer_load_dwordx4 v1, s[4:7], s23 offen offset:2048 lds
  buffer_load_dwordx4 v1, s[4:7], s23 offen offset:3072 lds
  s_add_u32 m0, s22, 12288
  s_add_u32 s23, s21, 12288
  buffer_load_dwordx4 v1, s[4:7], s23 offen offset:0 lds
  buffer_load_dwordx4 v1, s[4:7], s23 offen offset:1024 lds
  buffer_load_dwordx4 v1, s[4:7], s23 offen offset:2048 lds
  buffer_load_dwordx4 v1, s[4:7], s23 offen offset:3072 lds
  s_add_u32 m0, s22, 16384
  s_add_u32 s23, s21, 16384
  buffer_load_dwordx4 v1, s[4:7], s23 offen offset:0 lds
  buffer_load_dwordx4 v1, s[4:7], s23 offen offset:1024 lds
  buffer_load_dwordx4 v1, s[4:7], s23 offen offset:2048 lds
  buffer_load_dwordx4 v1, s[4:7], s23 offen offset:3072 lds
  s_waitcnt vmcnt(28)
  s_barrier
  ds_read_b128 v[136:139], v6 offset:0
  ds_read_b128 v[140:143], v6 offset:20480
  ds_read_b128 v[144:147], v7 offset:0
  ds_read_b128 v[148:151], v7 offset:20480
  buffer_load_dwordx4 v[120:123], v1, s[4:7], s30 offen offset:3072
  buffer_load_dwordx4 v[124:127], v1, s[4:7], s31 offen offset:3072
  buffer_load_dwordx4 v[128:131], v1, s[4:7], s32 offen offset:3072
  buffer_load_dwordx4 v[132:135], v1, s[4:7], s33 offen offset:3072
  s_waitcnt vmcnt(28)
  ds_read_b128 v[152:155], v6 offset:1024
  ds_read_b128 v[156:159], v6 offset:21504
  ds_read_b128 v[160:163], v7 offset:1024
  ds_read_b128 v[164:167], v7 offset:21504
  s_waitcnt lgkmcnt(4)
  v_mfma_f32_16x16x32_bf16 v[8:11], v[72:75], v[136:139], 0
  v_mfma_f32_16x16x32_bf16 v[12:15], v[72:75], v[140:143], 0
  v_mfma_f32_16x16x32_bf16 v[16:19], v[72:75], v[144:147], 0
  v_mfma_f32_16x16x32_bf16 v[20:23], v[72:75], v[148:151], 0
  v_mfma_f32_16x16x32_bf16 v[24:27], v[76:79], v[136:139], 0
  v_mfma_f32_16x16x32_bf16 v[28:31], v[76:79], v[140:143], 0
  v_mfma_f32_16x16x32_bf16 v[32:35], v[76:79], v[144:147], 0
  v_mfma_f32_16x16x32_bf16 v[36:39], v[76:79], v[148:151], 0
  v_mfma_f32_16x16x32_bf16 v[40:43], v[80:83], v[136:139], 0
  v_mfma_f32_16x16x32_bf16 v[44:47], v[80:83], v[140:143], 0
  v_mfma_f32_16x16x32_bf16 v[48:51], v[80:83], v[144:147], 0
  v_mfma_f32_16x16x32_bf16 v[52:55], v[80:83], v[148:151], 0
  v_mfma_f32_16x16x32_bf16 v[56:59], v[84:87], v[136:139], 0
  v_mfma_f32_16x16x32_bf16 v[60:63], v[84:87], v[140:143], 0
  v_mfma_f32_16x16x32_bf16 v[64:67], v[84:87], v[144:147], 0
  v_mfma_f32_16x16x32_bf16 v[68:71], v[84:87], v[148:151], 0
  s_add_u32 s30, s30, 4096
  s_add_u32 s31, s31, 4096
  s_add_u32 s32, s32, 4096
  s_add_u32 s33, s33, 4096
  buffer_load_dwordx4 v[72:75], v1, s[4:7], s30 offen offset:0
  buffer_load_dwordx4 v[76:79], v1, s[4:7], s31 offen offset:0
  buffer_load_dwordx4 v[80:83], v1, s[4:7], s32 offen offset:0
  buffer_load_dwordx4 v[84:87], v1, s[4:7], s33 offen offset:0
  s_waitcnt vmcnt(28)
  ds_read_b128 v[136:139], v6 offset:2048
  ds_read_b128 v[140:143], v6 offset:22528
  ds_read_b128 v[144:147], v7 offset:2048
  ds_read_b128 v[148:151], v7 offset:22528
  s_waitcnt lgkmcnt(4)
  v_mfma_f32_16x16x32_bf16 v[8:11], v[88:91], v[152:155], v[8:11]
  v_mfma_f32_16x16x32_bf16 v[12:15], v[88:91], v[156:159], v[12:15]
  v_mfma_f32_16x16x32_bf16 v[16:19], v[88:91], v[160:163], v[16:19]
  v_mfma_f32_16x16x32_bf16 v[20:23], v[88:91], v[164:167], v[20:23]
  v_mfma_f32_16x16x32_bf16 v[24:27], v[92:95], v[152:155], v[24:27]
  v_mfma_f32_16x16x32_bf16 v[28:31], v[92:95], v[156:159], v[28:31]
  v_mfma_f32_16x16x32_bf16 v[32:35], v[92:95], v[160:163], v[32:35]
  v_mfma_f32_16x16x32_bf16 v[36:39], v[92:95], v[164:167], v[36:39]
  v_mfma_f32_16x16x32_bf16 v[40:43], v[96:99], v[152:155], v[40:43]
  v_mfma_f32_16x16x32_bf16 v[44:47], v[96:99], v[156:159], v[44:47]
  v_mfma_f32_16x16x32_bf16 v[48:51], v[96:99], v[160:163], v[48:51]
  v_mfma_f32_16x16x32_bf16 v[52:55], v[96:99], v[164:167], v[52:55]
  v_mfma_f32_16x16x32_bf16 v[56:59], v[100:103], v[152:155], v[56:59]
  v_mfma_f32_16x16x32_bf16 v[60:63], v[100:103], v[156:159], v[60:63]
  v_mfma_f32_16x16x32_bf16 v[64:67], v[100:103], v[160:163], v[64:67]
  v_mfma_f32_16x16x32_bf16 v[68:71], v[100:103], v[164:167], v[68:71]
  buffer_load_dwordx4 v[88:91], v1, s[4:7], s30 offen offset:1024
  buffer_load_dwordx4 v[92:95], v1, s[4:7], s31 offen offset:1024
  buffer_load_dwordx4 v[96:99], v1, s[4:7], s32 offen offset:1024
  buffer_load_dwordx4 v[100:103], v1, s[4:7], s33 offen offset:1024
  s_waitcnt vmcnt(28)
  ds_read_b128 v[152:155], v6 offset:3072
  ds_read_b128 v[156:159], v6 offset:23552
  ds_read_b128 v[160:163], v7 offset:3072
  ds_read_b128 v[164:167], v7 offset:23552
  s_waitcnt lgkmcnt(4)
  v_mfma_f32_16x16x32_bf16 v[8:11], v[104:107], v[136:139], v[8:11]
  v_mfma_f32_16x16x32_bf16 v[12:15], v[104:107], v[140:143], v[12:15]
  v_mfma_f32_16x16x32_bf16 v[16:19], v[104:107], v[144:147], v[16:19]
  v_mfma_f32_16x16x32_bf16 v[20:23], v[104:107], v[148:151], v[20:23]
  v_mfma_f32_16x16x32_bf16 v[24:27], v[108:111], v[136:139], v[24:27]
  v_mfma_f32_16x16x32_bf16 v[28:31], v[108:111], v[140:143], v[28:31]
  v_mfma_f32_16x16x32_bf16 v[32:35], v[108:111], v[144:147], v[32:35]
  v_mfma_f32_16x16x32_bf16 v[36:39], v[108:111], v[148:151], v[36:39]
  v_mfma_f32_16x16x32_bf16 v[40:43], v[112:115], v[136:139], v[40:43]
  v_mfma_f32_16x16x32_bf16 v[44:47], v[112:115], v[140:143], v[44:47]
  v_mfma_f32_16x16x32_bf16 v[48:51], v[112:115], v[144:147], v[48:51]
  v_mfma_f32_16x16x32_bf16 v[52:55], v[112:115], v[148:151], v[52:55]
  v_mfma_f32_16x16x32_bf16 v[56:59], v[116:119], v[136:139], v[56:59]
  v_mfma_f32_16x16x32_bf16 v[60:63], v[116:119], v[140:143], v[60:63]
  v_mfma_f32_16x16x32_bf16 v[64:67], v[116:119], v[144:147], v[64:67]
  v_mfma_f32_16x16x32_bf16 v[68:71], v[116:119], v[148:151], v[68:71]
  buffer_load_dwordx4 v[104:107], v1, s[4:7], s30 offen offset:2048
  buffer_load_dwordx4 v[108:111], v1, s[4:7], s31 offen offset:2048
  buffer_load_dwordx4 v[112:115], v1, s[4:7], s32 offen offset:2048
  buffer_load_dwordx4 v[116:119], v1, s[4:7], s33 offen offset:2048
  s_waitcnt vmcnt(12)
  s_barrier
  ds_read_b128 v[136:139], v6 offset:4096
  ds_read_b128 v[140:143], v6 offset:24576
  ds_read_b128 v[144:147], v7 offset:4096
  ds_read_b128 v[148:151], v7 offset:24576
  s_waitcnt lgkmcnt(4)
  v_mfma_f32_16x16x32_bf16 v[8:11], v[120:123], v[152:155], v[8:11]
  v_mfma_f32_16x16x32_bf16 v[12:15], v[120:123], v[156:159], v[12:15]
  v_mfma_f32_16x16x32_bf16 v[16:19], v[120:123], v[160:163], v[16:19]
  v_mfma_f32_16x16x32_bf16 v[20:23], v[120:123], v[164:167], v[20:23]
  v_mfma_f32_16x16x32_bf16 v[24:27], v[124:127], v[152:155], v[24:27]
  v_mfma_f32_16x16x32_bf16 v[28:31], v[124:127], v[156:159], v[28:31]
  v_mfma_f32_16x16x32_bf16 v[32:35], v[124:127], v[160:163], v[32:35]
  v_mfma_f32_16x16x32_bf16 v[36:39], v[124:127], v[164:167], v[36:39]
  v_mfma_f32_16x16x32_bf16 v[40:43], v[128:131], v[152:155], v[40:43]
  v_mfma_f32_16x16x32_bf16 v[44:47], v[128:131], v[156:159], v[44:47]
  v_mfma_f32_16x16x32_bf16 v[48:51], v[128:131], v[160:163], v[48:51]
  v_mfma_f32_16x16x32_bf16 v[52:55], v[128:131], v[164:167], v[52:55]
  v_mfma_f32_16x16x32_bf16 v[56:59], v[132:135], v[152:155], v[56:59]
  v_mfma_f32_16x16x32_bf16 v[60:63], v[132:135], v[156:159], v[60:63]
  v_mfma_f32_16x16x32_bf16 v[64:67], v[132:135], v[160:163], v[64:67]
  v_mfma_f32_16x16x32_bf16 v[68:71], v[132:135], v[164:167], v[68:71]
  s_mov_b32 s40, 0
  v_add_u32 v6, 4096, v6
  v_add_u32 v7, 4096, v7
qkvb_loop7:
  buffer_load_dwordx4 v[120:123], v1, s[4:7], s30 offen offset:3072
  buffer_load_dwordx4 v[124:127], v1, s[4:7], s31 offen offset:3072
  buffer_load_dwordx4 v[128:131], v1, s[4:7], s32 offen offset:3072
  buffer_load_dwordx4 v[132:135], v1, s[4:7], s33 offen offset:3072
  s_waitcnt vmcnt(12)
  ds_read_b128 v[152:155], v6 offset:1024
  ds_read_b128 v[156:159], v6 offset:21504
  ds_read_b128 v[160:163], v7 offset:1024
  ds_read_b128 v[164:167], v7 offset:21504
  s_waitcnt lgkmcnt(4)
  v_mfma_f32_16x16x32_bf16 v[8:11], v[72:75], v[136:139], v[8:11]
  v_mfma_f32_16x16x32_bf16 v[12:15], v[72:75], v[140:143], v[12:15]
  v_mfma_f32_16x16x32_bf16 v[16:19], v[72:75], v[144:147], v[16:19]
  v_mfma_f32_16x16x32_bf16 v[20:23], v[72:75], v[148:151], v[20:23]
  v_mfma_f32_16x16x32_bf16 v[24:27], v[76:79], v[136:139], v[24:27]
  v_mfma_f32_16x16x32_bf16 v[28:31], v[76:79], v[140:143], v[28:31]
  v_mfma_f32_16x16x32_bf16 v[32:35], v[76:79], v[144:147], v[32:35]
  v_mfma_f32_16x16x32_bf16 v[36:39], v[76:79], v[148:151], v[36:39]
  v_mfma_f32_16x16x32_bf16 v[40:43], v[80:83], v[136:139], v[40:43]
  v_mfma_f32_16x16x32_bf16 v[44:47], v[80:83], v[140:143], v[44:47]
  v_mfma_f32_16x16x32_bf16 v[48:51], v[80:83], v[144:147], v[48:51]
  v_mfma_f32_16x16x32_bf16 v[52:55], v[80:83], v[148:151], v[52:55]
  v_mfma_f32_16x16x32_bf16 v[56:59], v[84:87], v[136:139], v[56:59]
  v_mfma_f32_16x16x32_bf16 v[60:63], v[84:87], v[140:143], v[60:63]
  v_mfma_f32_16x16x32_bf16 v[64:67], v[84:87], v[144:147], v[64:67]
  v_mfma_f32_16x16x32_bf16 v[68:71], v[84:87], v[148:151], v[68:71]
  s_add_u32 s30, s30, 4096
  s_add_u32 s31, s31, 4096
  s_add_u32 s32, s32, 4096
  s_add_u32 s33, s33, 4096
  buffer_load_dwordx4 v[72:75], v1, s[4:7], s30 offen offset:0
  buffer_load_dwordx4 v[76:79], v1, s[4:7], s31 offen offset:0
  buffer_load_dwordx4 v[80:83], v1, s[4:7], s32 offen offset:0
  buffer_load_dwordx4 v[84:87], v1, s[4:7], s33 offen offset:0
  s_waitcnt vmcnt(12)
  ds_read_b128 v[136:139], v6 offset:2048
  ds_read_b128 v[140:143], v6 offset:22528
  ds_read_b128 v[144:147], v7 offset:2048
  ds_read_b128 v[148:151], v7 offset:22528
  s_waitcnt lgkmcnt(4)
  v_mfma_f32_16x16x32_bf16 v[8:11], v[88:91], v[152:155], v[8:11]
  v_mfma_f32_16x16x32_bf16 v[12:15], v[88:91], v[156:159], v[12:15]
  v_mfma_f32_16x16x32_bf16 v[16:19], v[88:91], v[160:163], v[16:19]
  v_mfma_f32_16x16x32_bf16 v[20:23], v[88:91], v[164:167], v[20:23]
  v_mfma_f32_16x16x32_bf16 v[24:27], v[92:95], v[152:155], v[24:27]
  v_mfma_f32_16x16x32_bf16 v[28:31], v[92:95], v[156:159], v[28:31]
  v_mfma_f32_16x16x32_bf16 v[32:35], v[92:95], v[160:163], v[32:35]
  v_mfma_f32_16x16x32_bf16 v[36:39], v[92:95], v[164:167], v[36:39]
  v_mfma_f32_16x16x32_bf16 v[40:43], v[96:99], v[152:155], v[40:43]
  v_mfma_f32_16x16x32_bf16 v[44:47], v[96:99], v[156:159], v[44:47]
  v_mfma_f32_16x16x32_bf16 v[48:51], v[96:99], v[160:163], v[48:51]
  v_mfma_f32_16x16x32_bf16 v[52:55], v[96:99], v[164:167], v[52:55]
  v_mfma_f32_16x16x32_bf16 v[56:59], v[100:103], v[152:155], v[56:59]
  v_mfma_f32_16x16x32_bf16 v[60:63], v[100:103], v[156:159], v[60:63]
  v_mfma_f32_16x16x32_bf16 v[64:67], v[100:103], v[160:163], v[64:67]
  v_mfma_f32_16x16x32_bf16 v[68:71], v[100:103], v[164:167], v[68:71]
  buffer_load_dwordx4 v[88:91], v1, s[4:7], s30 offen offset:1024
  buffer_load_dwordx4 v[92:95], v1, s[4:7], s31 offen offset:1024
  buffer_load_dwordx4 v[96:99], v1, s[4:7], s32 offen offset:1024
  buffer_load_dwordx4 v[100:103], v1, s[4:7], s33 offen offset:1024
  s_waitcnt vmcnt(12)
  ds_read_b128 v[152:155], v6 offset:3072
  ds_read_b128 v[156:159], v6 offset:23552
  ds_read_b128 v[160:163], v7 offset:3072
  ds_read_b128 v[164:167], v7 offset:23552
  s_waitcnt lgkmcnt(4)
  v_mfma_f32_16x16x32_bf16 v[8:11], v[104:107], v[136:139], v[8:11]
  v_mfma_f32_16x16x32_bf16 v[12:15], v[104:107], v[140:143], v[12:15]
  v_mfma_f32_16x16x32_bf16 v[16:19], v[104:107], v[144:147], v[16:19]
  v_mfma_f32_16x16x32_bf16 v[20:23], v[104:107], v[148:151], v[20:23]
  v_mfma_f32_16x16x32_bf16 v[24:27], v[108:111], v[136:139], v[24:27]
  v_mfma_f32_16x16x32_bf16 v[28:31], v[108:111], v[140:143], v[28:31]
  v_mfma_f32_16x16x32_bf16 v[32:35], v[108:111], v[144:147], v[32:35]
  v_mfma_f32_16x16x32_bf16 v[36:39], v[108:111], v[148:151], v[36:39]
  v_mfma_f32_16x16x32_bf16 v[40:43], v[112:115], v[136:139], v[40:43]
  v_mfma_f32_16x16x32_bf16 v[44:47], v[112:115], v[140:143], v[44:47]
  v_mfma_f32_16x16x32_bf16 v[48:51], v[112:115], v[144:147], v[48:51]
  v_mfma_f32_16x16x32_bf16 v[52:55], v[112:115], v[148:151], v[52:55]
  v_mfma_f32_16x16x32_bf16 v[56:59], v[116:119], v[136:139], v[56:59]
  v_mfma_f32_16x16x32_bf16 v[60:63], v[116:119], v[140:143], v[60:63]
  v_mfma_f32_16x16x32_bf16 v[64:67], v[116:119], v[144:147], v[64:67]
  v_mfma_f32_16x16x32_bf16 v[68:71], v[116:119], v[148:151], v[68:71]
  buffer_load_dwordx4 v[104:107], v1, s[4:7], s30 offen offset:2048
  buffer_load_dwordx4 v[108:111], v1, s[4:7], s31 offen offset:2048
  buffer_load_dwordx4 v[112:115], v1, s[4:7], s32 offen offset:2048
  buffer_load_dwordx4 v[116:119], v1, s[4:7], s33 offen offset:2048
  s_waitcnt vmcnt(12)
  ds_read_b128 v[136:139], v6 offset:4096
  ds_read_b128 v[140:143], v6 offset:24576
  ds_read_b128 v[144:147], v7 offset:4096
  ds_read_b128 v[148:151], v7 offset:24576
  s_waitcnt lgkmcnt(4)
  v_mfma_f32_16x16x32_bf16 v[8:11], v[120:123], v[152:155], v[8:11]
  v_mfma_f32_16x16x32_bf16 v[12:15], v[120:123], v[156:159], v[12:15]
  v_mfma_f32_16x16x32_bf16 v[16:19], v[120:123], v[160:163], v[16:19]
  v_mfma_f32_16x16x32_bf16 v[20:23], v[120:123], v[164:167], v[20:23]
  v_mfma_f32_16x16x32_bf16 v[24:27], v[124:127], v[152:155], v[24:27]
  v_mfma_f32_16x16x32_bf16 v[28:31], v[124:127], v[156:159], v[28:31]
  v_mfma_f32_16x16x32_bf16 v[32:35], v[124:127], v[160:163], v[32:35]
  v_mfma_f32_16x16x32_bf16 v[36:39], v[124:127], v[164:167], v[36:39]
  v_mfma_f32_16x16x32_bf16 v[40:43], v[128:131], v[152:155], v[40:43]
  v_mfma_f32_16x16x32_bf16 v[44:47], v[128:131], v[156:159], v[44:47]
  v_mfma_f32_16x16x32_bf16 v[48:51], v[128:131], v[160:163], v[48:51]
  v_mfma_f32_16x16x32_bf16 v[52:55], v[128:131], v[164:167], v[52:55]
  v_mfma_f32_16x16x32_bf16 v[56:59], v[132:135], v[152:155], v[56:59]
  v_mfma_f32_16x16x32_bf16 v[60:63], v[132:135], v[156:159], v[60:63]
  v_mfma_f32_16x16x32_bf16 v[64:67], v[132:135], v[160:163], v[64:67]
  v_mfma_f32_16x16x32_bf16 v[68:71], v[132:135], v[164:167], v[68:71]
  v_add_u32 v6, 4096, v6
  v_add_u32 v7, 4096, v7
  s_add_u32 s40, s40, 1
  s_cmp_lt_u32 s40, 4
  s_cbranch_scc1 qkvb_loop7
  s_waitcnt vmcnt(0) lgkmcnt(0)
  v_and_b32 v2, 63, v0
  v_and_b32 v3, 15, v2
  v_lshrrev_b32 v4, 4, v2
  s_lshl_b32 s41, s17, 19
  s_lshl_b32 s42, s18, 12
  s_add_u32 s41, s41, s42
  s_mov_b32 s46, 0x3ea52b5c
  s_mov_b32 s47, 0x3ea52b5c
  v_lshlrev_b32 v5, 2, v4
  v_add_u32 v5, 64, v5
  v_mul_u32_u24 v168, 205, v5
  v_lshrrev_b32 v168, 12, v168
  v_mul_u32_u24 v6, 20, v168
  v_sub_u32 v5, v5, v6
  v_lshlrev_b32 v168, 17, v168
  v_lshrrev_b32 v6, 4, v5
  v_lshl_add_u32 v168, v6, 10, v168
  v_bfe_u32 v6, v5, 2, 1
  v_lshl_add_u32 v168, v6, 9, v168
  v_bfe_u32 v6, v5, 3, 1
  v_lshl_add_u32 v168, v6, 3, v168
  v_lshl_add_u32 v168, v3, 4, v168
  v_lshlrev_b32 v5, 2, v4
  v_add_u32 v5, 0, v5
  v_mul_u32_u24 v169, 205, v5
  v_lshrrev_b32 v169, 12, v169
  v_mul_u32_u24 v6, 20, v169
  v_sub_u32 v5, v5, v6
  v_lshlrev_b32 v169, 17, v169
  v_lshrrev_b32 v6, 4, v5
  v_lshl_add_u32 v169, v6, 10, v169
  v_bfe_u32 v6, v5, 2, 1
  v_lshl_add_u32 v169, v6, 9, v169
  v_bfe_u32 v6, v5, 3, 1
  v_lshl_add_u32 v169, v6, 3, v169
  v_lshl_add_u32 v169, v3, 4, v169
  v_lshlrev_b32 v5, 2, v4
  v_add_u32 v5, 16, v5
  v_mul_u32_u24 v170, 205, v5
  v_lshrrev_b32 v170, 12, v170
  v_mul_u32_u24 v6, 20, v170
  v_sub_u32 v5, v5, v6
  v_lshlrev_b32 v170, 17, v170
  v_lshrrev_b32 v6, 4, v5
  v_lshl_add_u32 v170, v6, 10, v170
  v_bfe_u32 v6, v5, 2, 1
  v_lshl_add_u32 v170, v6, 9, v170
  v_bfe_u32 v6, v5, 3, 1
  v_lshl_add_u32 v170, v6, 3, v170
  v_lshl_add_u32 v170, v3, 4, v170
  v_lshlrev_b32 v5, 2, v4
  v_add_u32 v5, 32, v5
  v_mul_u32_u24 v171, 205, v5
  v_lshrrev_b32 v171, 12, v171
  v_mul_u32_u24 v6, 20, v171
  v_sub_u32 v5, v5, v6
  v_lshlrev_b32 v171, 17, v171
  v_lshrrev_b32 v6, 4, v5
  v_lshl_add_u32 v171, v6, 10, v171
  v_bfe_u32 v6, v5, 2, 1
  v_lshl_add_u32 v171, v6, 9, v171
  v_bfe_u32 v6, v5, 3, 1
  v_lshl_add_u32 v171, v6, 3, v171
  v_lshl_add_u32 v171, v3, 4, v171
  v_pk_mul_f32 v[8:9], v[8:9], s[46:47]
  v_pk_mul_f32 v[10:11], v[10:11], s[46:47]
  v_cvt_pk_bf16_f32 v136, v8, v9
  v_cvt_pk_bf16_f32 v137, v10, v11
  s_add_u32 s43, s41, 37748736
  buffer_store_dwordx2 v[136:137], v168, s[4:7], s43 offen sc1
  v_pk_mul_f32 v[12:13], v[12:13], s[46:47]
  v_pk_mul_f32 v[14:15], v[14:15], s[46:47]
  v_cvt_pk_bf16_f32 v138, v12, v13
  v_cvt_pk_bf16_f32 v139, v14, v15
  s_add_u32 s43, s41, 37748992
  buffer_store_dwordx2 v[138:139], v168, s[4:7], s43 offen sc1
  v_pk_mul_f32 v[16:17], v[16:17], s[46:47]
  v_pk_mul_f32 v[18:19], v[18:19], s[46:47]
  v_cvt_pk_bf16_f32 v140, v16, v17
  v_cvt_pk_bf16_f32 v141, v18, v19
  s_add_u32 s43, s41, 37750784
  buffer_store_dwordx2 v[140:141], v168, s[4:7], s43 offen sc1
  v_pk_mul_f32 v[20:21], v[20:21], s[46:47]
  v_pk_mul_f32 v[22:23], v[22:23], s[46:47]
  v_cvt_pk_bf16_f32 v142, v20, v21
  v_cvt_pk_bf16_f32 v143, v22, v23
  s_add_u32 s43, s41, 37751040
  buffer_store_dwordx2 v[142:143], v168, s[4:7], s43 offen sc1
  v_cvt_pk_bf16_f32 v144, v24, v25
  v_cvt_pk_bf16_f32 v145, v26, v27
  s_add_u32 s43, s41, 41943040
  buffer_store_dwordx2 v[144:145], v169, s[4:7], s43 offen sc1
  v_cvt_pk_bf16_f32 v146, v28, v29
  v_cvt_pk_bf16_f32 v147, v30, v31
  s_add_u32 s43, s41, 41943296
  buffer_store_dwordx2 v[146:147], v169, s[4:7], s43 offen sc1
  v_cvt_pk_bf16_f32 v148, v32, v33
  v_cvt_pk_bf16_f32 v149, v34, v35
  s_add_u32 s43, s41, 41945088
  buffer_store_dwordx2 v[148:149], v169, s[4:7], s43 offen sc1
  v_cvt_pk_bf16_f32 v150, v36, v37
  v_cvt_pk_bf16_f32 v151, v38, v39
  s_add_u32 s43, s41, 41945344
  buffer_store_dwordx2 v[150:151], v169, s[4:7], s43 offen sc1
  v_cvt_pk_bf16_f32 v136, v40, v41
  v_cvt_pk_bf16_f32 v137, v42, v43
  s_add_u32 s43, s41, 41943040
  buffer_store_dwordx2 v[136:137], v170, s[4:7], s43 offen sc1
  v_cvt_pk_bf16_f32 v138, v44, v45
  v_cvt_pk_bf16_f32 v139, v46, v47
  s_add_u32 s43, s41, 41943296
  buffer_store_dwordx2 v[138:139], v170, s[4:7], s43 offen sc1
  v_cvt_pk_bf16_f32 v140, v48, v49
  v_cvt_pk_bf16_f32 v141, v50, v51
  s_add_u32 s43, s41, 41945088
  buffer_store_dwordx2 v[140:141], v170, s[4:7], s43 offen sc1
  v_cvt_pk_bf16_f32 v142, v52, v53
  v_cvt_pk_bf16_f32 v143, v54, v55
  s_add_u32 s43, s41, 41945344
  buffer_store_dwordx2 v[142:143], v170, s[4:7], s43 offen sc1
  v_cvt_pk_bf16_f32 v144, v56, v57
  v_cvt_pk_bf16_f32 v145, v58, v59
  s_add_u32 s43, s41, 41943040
  buffer_store_dwordx2 v[144:145], v171, s[4:7], s43 offen sc1
  v_cvt_pk_bf16_f32 v146, v60, v61
  v_cvt_pk_bf16_f32 v147, v62, v63
  s_add_u32 s43, s41, 41943296
  buffer_store_dwordx2 v[146:147], v171, s[4:7], s43 offen sc1
  v_cvt_pk_bf16_f32 v148, v64, v65
  v_cvt_pk_bf16_f32 v149, v66, v67
  s_add_u32 s43, s41, 41945088
  buffer_store_dwordx2 v[148:149], v171, s[4:7], s43 offen sc1
  v_cvt_pk_bf16_f32 v150, v68, v69
  v_cvt_pk_bf16_f32 v151, v70, v71
  s_add_u32 s43, s41, 41945344
  buffer_store_dwordx2 v[150:151], v171, s[4:7], s43 offen sc1
  s_branch qkvb_exit1
qkvb_w2_4:
  s_mul_i32 s30, s17, 5
  s_add_u32 s30, s30, 43
  s_mul_i32 s30, s30, 20480
  s_add_u32 s30, s30, 87556096
  s_mul_i32 s31, s17, 5
  s_add_u32 s31, s31, 44
  s_mul_i32 s31, s31, 20480
  s_add_u32 s31, s31, 87556096
  s_mul_i32 s32, s17, 5
  s_add_u32 s32, s32, 80
  s_mul_i32 s32, s32, 20480
  s_add_u32 s32, s32, 87556096
  s_mul_i32 s33, s17, 5
  s_add_u32 s33, s33, 81
  s_mul_i32 s33, s33, 20480
  s_add_u32 s33, s33, 87556096
  buffer_load_dwordx4 v[72:75], v1, s[4:7], s30 offen offset:0
  buffer_load_dwordx4 v[76:79], v1, s[4:7], s31 offen offset:0
  buffer_load_dwordx4 v[80:83], v1, s[4:7], s32 offen offset:0
  buffer_load_dwordx4 v[84:87], v1, s[4:7], s33 offen offset:0
  buffer_load_dwordx4 v[88:91], v1, s[4:7], s30 offen offset:1024
  buffer_load_dwordx4 v[92:95], v1, s[4:7], s31 offen offset:1024
  buffer_load_dwordx4 v[96:99], v1, s[4:7], s32 offen offset:1024
  buffer_load_dwordx4 v[100:103], v1, s[4:7], s33 offen offset:1024
  buffer_load_dwordx4 v[104:107], v1, s[4:7], s30 offen offset:2048
  buffer_load_dwordx4 v[108:111], v1, s[4:7], s31 offen offset:2048
  buffer_load_dwordx4 v[112:115], v1, s[4:7], s32 offen offset:2048
  buffer_load_dwordx4 v[116:119], v1, s[4:7], s33 offen offset:2048
  s_add_u32 m0, s22, 4096
  s_add_u32 s23, s21, 4096
  buffer_load_dwordx4 v1, s[4:7], s23 offen offset:0 lds
  buffer_load_dwordx4 v1, s[4:7], s23 offen offset:1024 lds
  buffer_load_dwordx4 v1, s[4:7], s23 offen offset:2048 lds
  buffer_load_dwordx4 v1, s[4:7], s23 offen offset:3072 lds
  s_add_u32 m0, s22, 8192
  s_add_u32 s23, s21, 8192
  buffer_load_dwordx4 v1, s[4:7], s23 offen offset:0 lds
  buffer_load_dwordx4 v1, s[4:7], s23 offen offset:1024 lds
  buffer_load_dwordx4 v1, s[4:7], s23 offen offset:2048 lds
  buffer_load_dwordx4 v1, s[4:7], s23 offen offset:3072 lds
  s_add_u32 m0, s22, 12288
  s_add_u32 s23, s21, 12288
  buffer_load_dwordx4 v1, s[4:7], s23 offen offset:0 lds
  buffer_load_dwordx4 v1, s[4:7], s23 offen offset:1024 lds
  buffer_load_dwordx4 v1, s[4:7], s23 offen offset:2048 lds
  buffer_load_dwordx4 v1, s[4:7], s23 offen offset:3072 lds
  s_add_u32 m0, s22, 16384
  s_add_u32 s23, s21, 16384
  buffer_load_dwordx4 v1, s[4:7], s23 offen offset:0 lds
  buffer_load_dwordx4 v1, s[4:7], s23 offen offset:1024 lds
  buffer_load_dwordx4 v1, s[4:7], s23 offen offset:2048 lds
  buffer_load_dwordx4 v1, s[4:7], s23 offen offset:3072 lds
  s_waitcnt vmcnt(28)
  s_barrier
  ds_read_b128 v[136:139], v6 offset:0
  ds_read_b128 v[140:143], v6 offset:20480
  ds_read_b128 v[144:147], v7 offset:0
  ds_read_b128 v[148:151], v7 offset:20480
  buffer_load_dwordx4 v[120:123], v1, s[4:7], s30 offen offset:3072
  buffer_load_dwordx4 v[124:127], v1, s[4:7], s31 offen offset:3072
  buffer_load_dwordx4 v[128:131], v1, s[4:7], s32 offen offset:3072
  buffer_load_dwordx4 v[132:135], v1, s[4:7], s33 offen offset:3072
  s_waitcnt vmcnt(28)
  ds_read_b128 v[152:155], v6 offset:1024
  ds_read_b128 v[156:159], v6 offset:21504
  ds_read_b128 v[160:163], v7 offset:1024
  ds_read_b128 v[164:167], v7 offset:21504
  s_waitcnt lgkmcnt(4)
  v_mfma_f32_16x16x32_bf16 v[8:11], v[72:75], v[136:139], 0
  v_mfma_f32_16x16x32_bf16 v[12:15], v[72:75], v[140:143], 0
  v_mfma_f32_16x16x32_bf16 v[16:19], v[72:75], v[144:147], 0
  v_mfma_f32_16x16x32_bf16 v[20:23], v[72:75], v[148:151], 0
  v_mfma_f32_16x16x32_bf16 v[24:27], v[76:79], v[136:139], 0
  v_mfma_f32_16x16x32_bf16 v[28:31], v[76:79], v[140:143], 0
  v_mfma_f32_16x16x32_bf16 v[32:35], v[76:79], v[144:147], 0
  v_mfma_f32_16x16x32_bf16 v[36:39], v[76:79], v[148:151], 0
  v_mfma_f32_16x16x32_bf16 v[40:43], v[136:139], v[80:83], 0
  v_mfma_f32_16x16x32_bf16 v[44:47], v[140:143], v[80:83], 0
  v_mfma_f32_16x16x32_bf16 v[48:51], v[144:147], v[80:83], 0
  v_mfma_f32_16x16x32_bf16 v[52:55], v[148:151], v[80:83], 0
  v_mfma_f32_16x16x32_bf16 v[56:59], v[136:139], v[84:87], 0
  v_mfma_f32_16x16x32_bf16 v[60:63], v[140:143], v[84:87], 0
  v_mfma_f32_16x16x32_bf16 v[64:67], v[144:147], v[84:87], 0
  v_mfma_f32_16x16x32_bf16 v[68:71], v[148:151], v[84:87], 0
  s_add_u32 s30, s30, 4096
  s_add_u32 s31, s31, 4096
  s_add_u32 s32, s32, 4096
  s_add_u32 s33, s33, 4096
  buffer_load_dwordx4 v[72:75], v1, s[4:7], s30 offen offset:0
  buffer_load_dwordx4 v[76:79], v1, s[4:7], s31 offen offset:0
  buffer_load_dwordx4 v[80:83], v1, s[4:7], s32 offen offset:0
  buffer_load_dwordx4 v[84:87], v1, s[4:7], s33 offen offset:0
  s_waitcnt vmcnt(28)
  ds_read_b128 v[136:139], v6 offset:2048
  ds_read_b128 v[140:143], v6 offset:22528
  ds_read_b128 v[144:147], v7 offset:2048
  ds_read_b128 v[148:151], v7 offset:22528
  s_waitcnt lgkmcnt(4)
  v_mfma_f32_16x16x32_bf16 v[8:11], v[88:91], v[152:155], v[8:11]
  v_mfma_f32_16x16x32_bf16 v[12:15], v[88:91], v[156:159], v[12:15]
  v_mfma_f32_16x16x32_bf16 v[16:19], v[88:91], v[160:163], v[16:19]
  v_mfma_f32_16x16x32_bf16 v[20:23], v[88:91], v[164:167], v[20:23]
  v_mfma_f32_16x16x32_bf16 v[24:27], v[92:95], v[152:155], v[24:27]
  v_mfma_f32_16x16x32_bf16 v[28:31], v[92:95], v[156:159], v[28:31]
  v_mfma_f32_16x16x32_bf16 v[32:35], v[92:95], v[160:163], v[32:35]
  v_mfma_f32_16x16x32_bf16 v[36:39], v[92:95], v[164:167], v[36:39]
  v_mfma_f32_16x16x32_bf16 v[40:43], v[152:155], v[96:99], v[40:43]
  v_mfma_f32_16x16x32_bf16 v[44:47], v[156:159], v[96:99], v[44:47]
  v_mfma_f32_16x16x32_bf16 v[48:51], v[160:163], v[96:99], v[48:51]
  v_mfma_f32_16x16x32_bf16 v[52:55], v[164:167], v[96:99], v[52:55]
  v_mfma_f32_16x16x32_bf16 v[56:59], v[152:155], v[100:103], v[56:59]
  v_mfma_f32_16x16x32_bf16 v[60:63], v[156:159], v[100:103], v[60:63]
  v_mfma_f32_16x16x32_bf16 v[64:67], v[160:163], v[100:103], v[64:67]
  v_mfma_f32_16x16x32_bf16 v[68:71], v[164:167], v[100:103], v[68:71]
  buffer_load_dwordx4 v[88:91], v1, s[4:7], s30 offen offset:1024
  buffer_load_dwordx4 v[92:95], v1, s[4:7], s31 offen offset:1024
  buffer_load_dwordx4 v[96:99], v1, s[4:7], s32 offen offset:1024
  buffer_load_dwordx4 v[100:103], v1, s[4:7], s33 offen offset:1024
  s_waitcnt vmcnt(28)
  ds_read_b128 v[152:155], v6 offset:3072
  ds_read_b128 v[156:159], v6 offset:23552
  ds_read_b128 v[160:163], v7 offset:3072
  ds_read_b128 v[164:167], v7 offset:23552
  s_waitcnt lgkmcnt(4)
  v_mfma_f32_16x16x32_bf16 v[8:11], v[104:107], v[136:139], v[8:11]
  v_mfma_f32_16x16x32_bf16 v[12:15], v[104:107], v[140:143], v[12:15]
  v_mfma_f32_16x16x32_bf16 v[16:19], v[104:107], v[144:147], v[16:19]
  v_mfma_f32_16x16x32_bf16 v[20:23], v[104:107], v[148:151], v[20:23]
  v_mfma_f32_16x16x32_bf16 v[24:27], v[108:111], v[136:139], v[24:27]
  v_mfma_f32_16x16x32_bf16 v[28:31], v[108:111], v[140:143], v[28:31]
  v_mfma_f32_16x16x32_bf16 v[32:35], v[108:111], v[144:147], v[32:35]
  v_mfma_f32_16x16x32_bf16 v[36:39], v[108:111], v[148:151], v[36:39]
  v_mfma_f32_16x16x32_bf16 v[40:43], v[136:139], v[112:115], v[40:43]
  v_mfma_f32_16x16x32_bf16 v[44:47], v[140:143], v[112:115], v[44:47]
  v_mfma_f32_16x16x32_bf16 v[48:51], v[144:147], v[112:115], v[48:51]
  v_mfma_f32_16x16x32_bf16 v[52:55], v[148:151], v[112:115], v[52:55]
  v_mfma_f32_16x16x32_bf16 v[56:59], v[136:139], v[116:119], v[56:59]
  v_mfma_f32_16x16x32_bf16 v[60:63], v[140:143], v[116:119], v[60:63]
  v_mfma_f32_16x16x32_bf16 v[64:67], v[144:147], v[116:119], v[64:67]
  v_mfma_f32_16x16x32_bf16 v[68:71], v[148:151], v[116:119], v[68:71]
  buffer_load_dwordx4 v[104:107], v1, s[4:7], s30 offen offset:2048
  buffer_load_dwordx4 v[108:111], v1, s[4:7], s31 offen offset:2048
  buffer_load_dwordx4 v[112:115], v1, s[4:7], s32 offen offset:2048
  buffer_load_dwordx4 v[116:119], v1, s[4:7], s33 offen offset:2048
  s_waitcnt vmcnt(12)
  s_barrier
  ds_read_b128 v[136:139], v6 offset:4096
  ds_read_b128 v[140:143], v6 offset:24576
  ds_read_b128 v[144:147], v7 offset:4096
  ds_read_b128 v[148:151], v7 offset:24576
  s_waitcnt lgkmcnt(4)
  v_mfma_f32_16x16x32_bf16 v[8:11], v[120:123], v[152:155], v[8:11]
  v_mfma_f32_16x16x32_bf16 v[12:15], v[120:123], v[156:159], v[12:15]
  v_mfma_f32_16x16x32_bf16 v[16:19], v[120:123], v[160:163], v[16:19]
  v_mfma_f32_16x16x32_bf16 v[20:23], v[120:123], v[164:167], v[20:23]
  v_mfma_f32_16x16x32_bf16 v[24:27], v[124:127], v[152:155], v[24:27]
  v_mfma_f32_16x16x32_bf16 v[28:31], v[124:127], v[156:159], v[28:31]
  v_mfma_f32_16x16x32_bf16 v[32:35], v[124:127], v[160:163], v[32:35]
  v_mfma_f32_16x16x32_bf16 v[36:39], v[124:127], v[164:167], v[36:39]
  v_mfma_f32_16x16x32_bf16 v[40:43], v[152:155], v[128:131], v[40:43]
  v_mfma_f32_16x16x32_bf16 v[44:47], v[156:159], v[128:131], v[44:47]
  v_mfma_f32_16x16x32_bf16 v[48:51], v[160:163], v[128:131], v[48:51]
  v_mfma_f32_16x16x32_bf16 v[52:55], v[164:167], v[128:131], v[52:55]
  v_mfma_f32_16x16x32_bf16 v[56:59], v[152:155], v[132:135], v[56:59]
  v_mfma_f32_16x16x32_bf16 v[60:63], v[156:159], v[132:135], v[60:63]
  v_mfma_f32_16x16x32_bf16 v[64:67], v[160:163], v[132:135], v[64:67]
  v_mfma_f32_16x16x32_bf16 v[68:71], v[164:167], v[132:135], v[68:71]
  s_mov_b32 s40, 0
  v_add_u32 v6, 4096, v6
  v_add_u32 v7, 4096, v7
qkvb_loop8:
  buffer_load_dwordx4 v[120:123], v1, s[4:7], s30 offen offset:3072
  buffer_load_dwordx4 v[124:127], v1, s[4:7], s31 offen offset:3072
  buffer_load_dwordx4 v[128:131], v1, s[4:7], s32 offen offset:3072
  buffer_load_dwordx4 v[132:135], v1, s[4:7], s33 offen offset:3072
  s_waitcnt vmcnt(12)
  ds_read_b128 v[152:155], v6 offset:1024
  ds_read_b128 v[156:159], v6 offset:21504
  ds_read_b128 v[160:163], v7 offset:1024
  ds_read_b128 v[164:167], v7 offset:21504
  s_waitcnt lgkmcnt(4)
  v_mfma_f32_16x16x32_bf16 v[8:11], v[72:75], v[136:139], v[8:11]
  v_mfma_f32_16x16x32_bf16 v[12:15], v[72:75], v[140:143], v[12:15]
  v_mfma_f32_16x16x32_bf16 v[16:19], v[72:75], v[144:147], v[16:19]
  v_mfma_f32_16x16x32_bf16 v[20:23], v[72:75], v[148:151], v[20:23]
  v_mfma_f32_16x16x32_bf16 v[24:27], v[76:79], v[136:139], v[24:27]
  v_mfma_f32_16x16x32_bf16 v[28:31], v[76:79], v[140:143], v[28:31]
  v_mfma_f32_16x16x32_bf16 v[32:35], v[76:79], v[144:147], v[32:35]
  v_mfma_f32_16x16x32_bf16 v[36:39], v[76:79], v[148:151], v[36:39]
  v_mfma_f32_16x16x32_bf16 v[40:43], v[136:139], v[80:83], v[40:43]
  v_mfma_f32_16x16x32_bf16 v[44:47], v[140:143], v[80:83], v[44:47]
  v_mfma_f32_16x16x32_bf16 v[48:51], v[144:147], v[80:83], v[48:51]
  v_mfma_f32_16x16x32_bf16 v[52:55], v[148:151], v[80:83], v[52:55]
  v_mfma_f32_16x16x32_bf16 v[56:59], v[136:139], v[84:87], v[56:59]
  v_mfma_f32_16x16x32_bf16 v[60:63], v[140:143], v[84:87], v[60:63]
  v_mfma_f32_16x16x32_bf16 v[64:67], v[144:147], v[84:87], v[64:67]
  v_mfma_f32_16x16x32_bf16 v[68:71], v[148:151], v[84:87], v[68:71]
  s_add_u32 s30, s30, 4096
  s_add_u32 s31, s31, 4096
  s_add_u32 s32, s32, 4096
  s_add_u32 s33, s33, 4096
  buffer_load_dwordx4 v[72:75], v1, s[4:7], s30 offen offset:0
  buffer_load_dwordx4 v[76:79], v1, s[4:7], s31 offen offset:0
  buffer_load_dwordx4 v[80:83], v1, s[4:7], s32 offen offset:0
  buffer_load_dwordx4 v[84:87], v1, s[4:7], s33 offen offset:0
  s_waitcnt vmcnt(12)
  ds_read_b128 v[136:139], v6 offset:2048
  ds_read_b128 v[140:143], v6 offset:22528
  ds_read_b128 v[144:147], v7 offset:2048
  ds_read_b128 v[148:151], v7 offset:22528
  s_waitcnt lgkmcnt(4)
  v_mfma_f32_16x16x32_bf16 v[8:11], v[88:91], v[152:155], v[8:11]
  v_mfma_f32_16x16x32_bf16 v[12:15], v[88:91], v[156:159], v[12:15]
  v_mfma_f32_16x16x32_bf16 v[16:19], v[88:91], v[160:163], v[16:19]
  v_mfma_f32_16x16x32_bf16 v[20:23], v[88:91], v[164:167], v[20:23]
  v_mfma_f32_16x16x32_bf16 v[24:27], v[92:95], v[152:155], v[24:27]
  v_mfma_f32_16x16x32_bf16 v[28:31], v[92:95], v[156:159], v[28:31]
  v_mfma_f32_16x16x32_bf16 v[32:35], v[92:95], v[160:163], v[32:35]
  v_mfma_f32_16x16x32_bf16 v[36:39], v[92:95], v[164:167], v[36:39]
  v_mfma_f32_16x16x32_bf16 v[40:43], v[152:155], v[96:99], v[40:43]
  v_mfma_f32_16x16x32_bf16 v[44:47], v[156:159], v[96:99], v[44:47]
  v_mfma_f32_16x16x32_bf16 v[48:51], v[160:163], v[96:99], v[48:51]
  v_mfma_f32_16x16x32_bf16 v[52:55], v[164:167], v[96:99], v[52:55]
  v_mfma_f32_16x16x32_bf16 v[56:59], v[152:155], v[100:103], v[56:59]
  v_mfma_f32_16x16x32_bf16 v[60:63], v[156:159], v[100:103], v[60:63]
  v_mfma_f32_16x16x32_bf16 v[64:67], v[160:163], v[100:103], v[64:67]
  v_mfma_f32_16x16x32_bf16 v[68:71], v[164:167], v[100:103], v[68:71]
  buffer_load_dwordx4 v[88:91], v1, s[4:7], s30 offen offset:1024
  buffer_load_dwordx4 v[92:95], v1, s[4:7], s31 offen offset:1024
  buffer_load_dwordx4 v[96:99], v1, s[4:7], s32 offen offset:1024
  buffer_load_dwordx4 v[100:103], v1, s[4:7], s33 offen offset:1024
  s_waitcnt vmcnt(12)
  ds_read_b128 v[152:155], v6 offset:3072
  ds_read_b128 v[156:159], v6 offset:23552
  ds_read_b128 v[160:163], v7 offset:3072
  ds_read_b128 v[164:167], v7 offset:23552
  s_waitcnt lgkmcnt(4)
  v_mfma_f32_16x16x32_bf16 v[8:11], v[104:107], v[136:139], v[8:11]
  v_mfma_f32_16x16x32_bf16 v[12:15], v[104:107], v[140:143], v[12:15]
  v_mfma_f32_16x16x32_bf16 v[16:19], v[104:107], v[144:147], v[16:19]
  v_mfma_f32_16x16x32_bf16 v[20:23], v[104:107], v[148:151], v[20:23]
  v_mfma_f32_16x16x32_bf16 v[24:27], v[108:111], v[136:139], v[24:27]
  v_mfma_f32_16x16x32_bf16 v[28:31], v[108:111], v[140:143], v[28:31]
  v_mfma_f32_16x16x32_bf16 v[32:35], v[108:111], v[144:147], v[32:35]
  v_mfma_f32_16x16x32_bf16 v[36:39], v[108:111], v[148:151], v[36:39]
  v_mfma_f32_16x16x32_bf16 v[40:43], v[136:139], v[112:115], v[40:43]
  v_mfma_f32_16x16x32_bf16 v[44:47], v[140:143], v[112:115], v[44:47]
  v_mfma_f32_16x16x32_bf16 v[48:51], v[144:147], v[112:115], v[48:51]
  v_mfma_f32_16x16x32_bf16 v[52:55], v[148:151], v[112:115], v[52:55]
  v_mfma_f32_16x16x32_bf16 v[56:59], v[136:139], v[116:119], v[56:59]
  v_mfma_f32_16x16x32_bf16 v[60:63], v[140:143], v[116:119], v[60:63]
  v_mfma_f32_16x16x32_bf16 v[64:67], v[144:147], v[116:119], v[64:67]
  v_mfma_f32_16x16x32_bf16 v[68:71], v[148:151], v[116:119], v[68:71]
  buffer_load_dwordx4 v[104:107], v1, s[4:7], s30 offen offset:2048
  buffer_load_dwordx4 v[108:111], v1, s[4:7], s31 offen offset:2048
  buffer_load_dwordx4 v[112:115], v1, s[4:7], s32 offen offset:2048
  buffer_load_dwordx4 v[116:119], v1, s[4:7], s33 offen offset:2048
  s_waitcnt vmcnt(12)
  ds_read_b128 v[136:139], v6 offset:4096
  ds_read_b128 v[140:143], v6 offset:24576
  ds_read_b128 v[144:147], v7 offset:4096
  ds_read_b128 v[148:151], v7 offset:24576
  s_waitcnt lgkmcnt(4)
  v_mfma_f32_16x16x32_bf16 v[8:11], v[120:123], v[152:155], v[8:11]
  v_mfma_f32_16x16x32_bf16 v[12:15], v[120:123], v[156:159], v[12:15]
  v_mfma_f32_16x16x32_bf16 v[16:19], v[120:123], v[160:163], v[16:19]
  v_mfma_f32_16x16x32_bf16 v[20:23], v[120:123], v[164:167], v[20:23]
  v_mfma_f32_16x16x32_bf16 v[24:27], v[124:127], v[152:155], v[24:27]
  v_mfma_f32_16x16x32_bf16 v[28:31], v[124:127], v[156:159], v[28:31]
  v_mfma_f32_16x16x32_bf16 v[32:35], v[124:127], v[160:163], v[32:35]
  v_mfma_f32_16x16x32_bf16 v[36:39], v[124:127], v[164:167], v[36:39]
  v_mfma_f32_16x16x32_bf16 v[40:43], v[152:155], v[128:131], v[40:43]
  v_mfma_f32_16x16x32_bf16 v[44:47], v[156:159], v[128:131], v[44:47]
  v_mfma_f32_16x16x32_bf16 v[48:51], v[160:163], v[128:131], v[48:51]
  v_mfma_f32_16x16x32_bf16 v[52:55], v[164:167], v[128:131], v[52:55]
  v_mfma_f32_16x16x32_bf16 v[56:59], v[152:155], v[132:135], v[56:59]
  v_mfma_f32_16x16x32_bf16 v[60:63], v[156:159], v[132:135], v[60:63]
  v_mfma_f32_16x16x32_bf16 v[64:67], v[160:163], v[132:135], v[64:67]
  v_mfma_f32_16x16x32_bf16 v[68:71], v[164:167], v[132:135], v[68:71]
  v_add_u32 v6, 4096, v6
  v_add_u32 v7, 4096, v7
  s_add_u32 s40, s40, 1
  s_cmp_lt_u32 s40, 4
  s_cbranch_scc1 qkvb_loop8
  s_waitcnt vmcnt(0) lgkmcnt(0)
  v_and_b32 v2, 63, v0
  v_and_b32 v3, 15, v2
  v_lshrrev_b32 v4, 4, v2
  s_lshl_b32 s41, s17, 19
  s_lshl_b32 s42, s18, 12
  s_add_u32 s41, s41, s42
  s_mov_b32 s46, 0x3ea52b5c
  s_mov_b32 s47, 0x3ea52b5c
  v_lshlrev_b32 v5, 2, v4
  v_add_u32 v5, 48, v5
  v_mul_u32_u24 v168, 205, v5
  v_lshrrev_b32 v168, 12, v168
  v_mul_u32_u24 v6, 20, v168
  v_sub_u32 v5, v5, v6
  v_lshlrev_b32 v168, 17, v168
  v_lshrrev_b32 v6, 4, v5
  v_lshl_add_u32 v168, v6, 10, v168
  v_bfe_u32 v6, v5, 2, 1
  v_lshl_add_u32 v168, v6, 9, v168
  v_bfe_u32 v6, v5, 3, 1
  v_lshl_add_u32 v168, v6, 3, v168
  v_lshl_add_u32 v168, v3, 4, v168
  v_lshlrev_b32 v5, 2, v4
  v_add_u32 v5, 64, v5
  v_mul_u32_u24 v169, 205, v5
  v_lshrrev_b32 v169, 12, v169
  v_mul_u32_u24 v6, 20, v169
  v_sub_u32 v5, v5, v6
  v_lshlrev_b32 v169, 17, v169
  v_lshrrev_b32 v6, 4, v5
  v_lshl_add_u32 v169, v6, 10, v169
  v_bfe_u32 v6, v5, 2, 1
  v_lshl_add_u32 v169, v6, 9, v169
  v_bfe_u32 v6, v5, 3, 1
  v_lshl_add_u32 v169, v6, 3, v169
  v_lshl_add_u32 v169, v3, 4, v169
  v_add_u32 v5, 0, v3
  v_mul_u32_u24 v170, 205, v5
  v_lshrrev_b32 v170, 12, v170
  v_mul_u32_u24 v6, 20, v170
  v_sub_u32 v5, v5, v6
  v_lshlrev_b32 v170, 17, v170
  v_lshl_add_u32 v170, v5, 4, v170
  v_and_b32 v6, 1, v4
  v_lshl_add_u32 v170, v6, 9, v170
  v_lshrrev_b32 v6, 1, v4
  v_lshl_add_u32 v170, v6, 3, v170
  v_add_u32 v5, 16, v3
  v_mul_u32_u24 v171, 205, v5
  v_lshrrev_b32 v171, 12, v171
  v_mul_u32_u24 v6, 20, v171
  v_sub_u32 v5, v5, v6
  v_lshlrev_b32 v171, 17, v171
  v_lshl_add_u32 v171, v5, 4, v171
  v_and_b32 v6, 1, v4
  v_lshl_add_u32 v171, v6, 9, v171
  v_lshrrev_b32 v6, 1, v4
  v_lshl_add_u32 v171, v6, 3, v171
  v_cvt_pk_bf16_f32 v136, v8, v9
  v_cvt_pk_bf16_f32 v137, v10, v11
  s_add_u32 s43, s41, 41943040
  buffer_store_dwordx2 v[136:137], v168, s[4:7], s43 offen sc1
  v_cvt_pk_bf16_f32 v138, v12, v13
  v_cvt_pk_bf16_f32 v139, v14, v15
  s_add_u32 s43, s41, 41943296
  buffer_store_dwordx2 v[138:139], v168, s[4:7], s43 offen sc1
  v_cvt_pk_bf16_f32 v140, v16, v17
  v_cvt_pk_bf16_f32 v141, v18, v19
  s_add_u32 s43, s41, 41945088
  buffer_store_dwordx2 v[140:141], v168, s[4:7], s43 offen sc1
  v_cvt_pk_bf16_f32 v142, v20, v21
  v_cvt_pk_bf16_f32 v143, v22, v23
  s_add_u32 s43, s41, 41945344
  buffer_store_dwordx2 v[142:143], v168, s[4:7], s43 offen sc1
  v_cvt_pk_bf16_f32 v144, v24, v25
  v_cvt_pk_bf16_f32 v145, v26, v27
  s_add_u32 s43, s41, 41943040
  buffer_store_dwordx2 v[144:145], v169, s[4:7], s43 offen sc1
  v_cvt_pk_bf16_f32 v146, v28, v29
  v_cvt_pk_bf16_f32 v147, v30, v31
  s_add_u32 s43, s41, 41943296
  buffer_store_dwordx2 v[146:147], v169, s[4:7], s43 offen sc1
  v_cvt_pk_bf16_f32 v148, v32, v33
  v_cvt_pk_bf16_f32 v149, v34, v35
  s_add_u32 s43, s41, 41945088
  buffer_store_dwordx2 v[148:149], v169, s[4:7], s43 offen sc1
  v_cvt_pk_bf16_f32 v150, v36, v37
  v_cvt_pk_bf16_f32 v151, v38, v39
  s_add_u32 s43, s41, 41945344
  buffer_store_dwordx2 v[150:151], v169, s[4:7], s43 offen sc1
  v_cvt_pk_bf16_f32 v136, v40, v41
  v_cvt_pk_bf16_f32 v137, v42, v43
  s_add_u32 s43, s41, 46137344
  buffer_store_dwordx2 v[136:137], v170, s[4:7], s43 offen sc1
  v_cvt_pk_bf16_f32 v138, v44, v45
  v_cvt_pk_bf16_f32 v139, v46, v47
  s_add_u32 s43, s41, 46138368
  buffer_store_dwordx2 v[138:139], v170, s[4:7], s43 offen sc1
  v_cvt_pk_bf16_f32 v140, v48, v49
  v_cvt_pk_bf16_f32 v141, v50, v51
  s_add_u32 s43, s41, 46139392
  buffer_store_dwordx2 v[140:141], v170, s[4:7], s43 offen sc1
  v_cvt_pk_bf16_f32 v142, v52, v53
  v_cvt_pk_bf16_f32 v143, v54, v55
  s_add_u32 s43, s41, 46140416
  buffer_store_dwordx2 v[142:143], v170, s[4:7], s43 offen sc1
  v_cvt_pk_bf16_f32 v144, v56, v57
  v_cvt_pk_bf16_f32 v145, v58, v59
  s_add_u32 s43, s41, 46137344
  buffer_store_dwordx2 v[144:145], v171, s[4:7], s43 offen sc1
  v_cvt_pk_bf16_f32 v146, v60, v61
  v_cvt_pk_bf16_f32 v147, v62, v63
  s_add_u32 s43, s41, 46138368
  buffer_store_dwordx2 v[146:147], v171, s[4:7], s43 offen sc1
  v_cvt_pk_bf16_f32 v148, v64, v65
  v_cvt_pk_bf16_f32 v149, v66, v67
  s_add_u32 s43, s41, 46139392
  buffer_store_dwordx2 v[148:149], v171, s[4:7], s43 offen sc1
  v_cvt_pk_bf16_f32 v150, v68, v69
  v_cvt_pk_bf16_f32 v151, v70, v71
  s_add_u32 s43, s41, 46140416
  buffer_store_dwordx2 v[150:151], v171, s[4:7], s43 offen sc1
  s_branch qkvb_exit1
qkvb_w3_5:
  s_mul_i32 s30, s17, 5
  s_add_u32 s30, s30, 82
  s_mul_i32 s30, s30, 20480
  s_add_u32 s30, s30, 87556096
  s_mul_i32 s31, s17, 5
  s_add_u32 s31, s31, 83
  s_mul_i32 s31, s31, 20480
  s_add_u32 s31, s31, 87556096
  s_mul_i32 s32, s17, 5
  s_add_u32 s32, s32, 84
  s_mul_i32 s32, s32, 20480
  s_add_u32 s32, s32, 87556096
  buffer_load_dwordx4 v[72:75], v1, s[4:7], s30 offen offset:0
  buffer_load_dwordx4 v[76:79], v1, s[4:7], s31 offen offset:0
  buffer_load_dwordx4 v[80:83], v1, s[4:7], s32 offen offset:0
  buffer_load_dwordx4 v[88:91], v1, s[4:7], s30 offen offset:1024
  buffer_load_dwordx4 v[92:95], v1, s[4:7], s31 offen offset:1024
  buffer_load_dwordx4 v[96:99], v1, s[4:7], s32 offen offset:1024
  buffer_load_dwordx4 v[104:107], v1, s[4:7], s30 offen offset:2048
  buffer_load_dwordx4 v[108:111], v1, s[4:7], s31 offen offset:2048
  buffer_load_dwordx4 v[112:115], v1, s[4:7], s32 offen offset:2048
  s_add_u32 m0, s22, 4096
  s_add_u32 s23, s21, 4096
  buffer_load_dwordx4 v1, s[4:7], s23 offen offset:0 lds
  buffer_load_dwordx4 v1, s[4:7], s23 offen offset:1024 lds
  buffer_load_dwordx4 v1, s[4:7], s23 offen offset:2048 lds
  buffer_load_dwordx4 v1, s[4:7], s23 offen offset:3072 lds
  s_add_u32 m0, s22, 8192
  s_add_u32 s23, s21, 8192
  buffer_load_dwordx4 v1, s[4:7], s23 offen offset:0 lds
  buffer_load_dwordx4 v1, s[4:7], s23 offen offset:1024 lds
  buffer_load_dwordx4 v1, s[4:7], s23 offen offset:2048 lds
  buffer_load_dwordx4 v1, s[4:7], s23 offen offset:3072 lds
  s_add_u32 m0, s22, 12288
  s_add_u32 s23, s21, 12288
  buffer_load_dwordx4 v1, s[4:7], s23 offen offset:0 lds
  buffer_load_dwordx4 v1, s[4:7], s23 offen offset:1024 lds
  buffer_load_dwordx4 v1, s[4:7], s23 offen offset:2048 lds
  buffer_load_dwordx4 v1, s[4:7], s23 offen offset:3072 lds
  s_add_u32 m0, s22, 16384
  s_add_u32 s23, s21, 16384
  buffer_load_dwordx4 v1, s[4:7], s23 offen offset:0 lds
  buffer_load_dwordx4 v1, s[4:7], s23 offen offset:1024 lds
  buffer_load_dwordx4 v1, s[4:7], s23 offen offset:2048 lds
  buffer_load_dwordx4 v1, s[4:7], s23 offen offset:3072 lds
  s_waitcnt vmcnt(25)
  s_barrier
  ds_read_b128 v[136:139], v6 offset:0
  ds_read_b128 v[140:143], v6 offset:20480
  ds_read_b128 v[144:147], v7 offset:0
  ds_read_b128 v[148:151], v7 offset:20480
  buffer_load_dwordx4 v[120:123], v1, s[4:7], s30 offen offset:3072
  buffer_load_dwordx4 v[124:127], v1, s[4:7], s31 offen offset:3072
  buffer_load_dwordx4 v[128:131], v1, s[4:7], s32 offen offset:3072
  s_waitcnt vmcnt(25)
  ds_read_b128 v[152:155], v6 offset:1024
  ds_read_b128 v[156:159], v6 offset:21504
  ds_read_b128 v[160:163], v7 offset:1024
  ds_read_b128 v[164:167], v7 offset:21504
  s_waitcnt lgkmcnt(4)
  v_mfma_f32_16x16x32_bf16 v[8:11], v[136:139], v[72:75], 0
  v_mfma_f32_16x16x32_bf16 v[12:15], v[140:143], v[72:75], 0
  v_mfma_f32_16x16x32_bf16 v[16:19], v[144:147], v[72:75], 0
  v_mfma_f32_16x16x32_bf16 v[20:23], v[148:151], v[72:75], 0
  v_mfma_f32_16x16x32_bf16 v[24:27], v[136:139], v[76:79], 0
  v_mfma_f32_16x16x32_bf16 v[28:31], v[140:143], v[76:79], 0
  v_mfma_f32_16x16x32_bf16 v[32:35], v[144:147], v[76:79], 0
  v_mfma_f32_16x16x32_bf16 v[36:39], v[148:151], v[76:79], 0
  v_mfma_f32_16x16x32_bf16 v[40:43], v[136:139], v[80:83], 0
  v_mfma_f32_16x16x32_bf16 v[44:47], v[140:143], v[80:83], 0
  v_mfma_f32_16x16x32_bf16 v[48:51], v[144:147], v[80:83], 0
  v_mfma_f32_16x16x32_bf16 v[52:55], v[148:151], v[80:83], 0
  s_add_u32 s30, s30, 4096
  s_add_u32 s31, s31, 4096
  s_add_u32 s32, s32, 4096
  buffer_load_dwordx4 v[72:75], v1, s[4:7], s30 offen offset:0
  buffer_load_dwordx4 v[76:79], v1, s[4:7], s31 offen offset:0
  buffer_load_dwordx4 v[80:83], v1, s[4:7], s32 offen offset:0
  s_waitcnt vmcnt(25)
  ds_read_b128 v[136:139], v6 offset:2048
  ds_read_b128 v[140:143], v6 offset:22528
  ds_read_b128 v[144:147], v7 offset:2048
  ds_read_b128 v[148:151], v7 offset:22528
  s_waitcnt lgkmcnt(4)
  v_mfma_f32_16x16x32_bf16 v[8:11], v[152:155], v[88:91], v[8:11]
  v_mfma_f32_16x16x32_bf16 v[12:15], v[156:159], v[88:91], v[12:15]
  v_mfma_f32_16x16x32_bf16 v[16:19], v[160:163], v[88:91], v[16:19]
  v_mfma_f32_16x16x32_bf16 v[20:23], v[164:167], v[88:91], v[20:23]
  v_mfma_f32_16x16x32_bf16 v[24:27], v[152:155], v[92:95], v[24:27]
  v_mfma_f32_16x16x32_bf16 v[28:31], v[156:159], v[92:95], v[28:31]
  v_mfma_f32_16x16x32_bf16 v[32:35], v[160:163], v[92:95], v[32:35]
  v_mfma_f32_16x16x32_bf16 v[36:39], v[164:167], v[92:95], v[36:39]
  v_mfma_f32_16x16x32_bf16 v[40:43], v[152:155], v[96:99], v[40:43]
  v_mfma_f32_16x16x32_bf16 v[44:47], v[156:159], v[96:99], v[44:47]
  v_mfma_f32_16x16x32_bf16 v[48:51], v[160:163], v[96:99], v[48:51]
  v_mfma_f32_16x16x32_bf16 v[52:55], v[164:167], v[96:99], v[52:55]
  buffer_load_dwordx4 v[88:91], v1, s[4:7], s30 offen offset:1024
  buffer_load_dwordx4 v[92:95], v1, s[4:7], s31 offen offset:1024
  buffer_load_dwordx4 v[96:99], v1, s[4:7], s32 offen offset:1024
  s_waitcnt vmcnt(25)
  ds_read_b128 v[152:155], v6 offset:3072
  ds_read_b128 v[156:159], v6 offset:23552
  ds_read_b128 v[160:163], v7 offset:3072
  ds_read_b128 v[164:167], v7 offset:23552
  s_waitcnt lgkmcnt(4)
  v_mfma_f32_16x16x32_bf16 v[8:11], v[136:139], v[104:107], v[8:11]
  v_mfma_f32_16x16x32_bf16 v[12:15], v[140:143], v[104:107], v[12:15]
  v_mfma_f32_16x16x32_bf16 v[16:19], v[144:147], v[104:107], v[16:19]
  v_mfma_f32_16x16x32_bf16 v[20:23], v[148:151], v[104:107], v[20:23]
  v_mfma_f32_16x16x32_bf16 v[24:27], v[136:139], v[108:111], v[24:27]
  v_mfma_f32_16x16x32_bf16 v[28:31], v[140:143], v[108:111], v[28:31]
  v_mfma_f32_16x16x32_bf16 v[32:35], v[144:147], v[108:111], v[32:35]
  v_mfma_f32_16x16x32_bf16 v[36:39], v[148:151], v[108:111], v[36:39]
  v_mfma_f32_16x16x32_bf16 v[40:43], v[136:139], v[112:115], v[40:43]
  v_mfma_f32_16x16x32_bf16 v[44:47], v[140:143], v[112:115], v[44:47]
  v_mfma_f32_16x16x32_bf16 v[48:51], v[144:147], v[112:115], v[48:51]
  v_mfma_f32_16x16x32_bf16 v[52:55], v[148:151], v[112:115], v[52:55]
  buffer_load_dwordx4 v[104:107], v1, s[4:7], s30 offen offset:2048
  buffer_load_dwordx4 v[108:111], v1, s[4:7], s31 offen offset:2048
  buffer_load_dwordx4 v[112:115], v1, s[4:7], s32 offen offset:2048
  s_waitcnt vmcnt(9)
  s_barrier
  ds_read_b128 v[136:139], v6 offset:4096
  ds_read_b128 v[140:143], v6 offset:24576
  ds_read_b128 v[144:147], v7 offset:4096
  ds_read_b128 v[148:151], v7 offset:24576
  s_waitcnt lgkmcnt(4)
  v_mfma_f32_16x16x32_bf16 v[8:11], v[152:155], v[120:123], v[8:11]
  v_mfma_f32_16x16x32_bf16 v[12:15], v[156:159], v[120:123], v[12:15]
  v_mfma_f32_16x16x32_bf16 v[16:19], v[160:163], v[120:123], v[16:19]
  v_mfma_f32_16x16x32_bf16 v[20:23], v[164:167], v[120:123], v[20:23]
  v_mfma_f32_16x16x32_bf16 v[24:27], v[152:155], v[124:127], v[24:27]
  v_mfma_f32_16x16x32_bf16 v[28:31], v[156:159], v[124:127], v[28:31]
  v_mfma_f32_16x16x32_bf16 v[32:35], v[160:163], v[124:127], v[32:35]
  v_mfma_f32_16x16x32_bf16 v[36:39], v[164:167], v[124:127], v[36:39]
  v_mfma_f32_16x16x32_bf16 v[40:43], v[152:155], v[128:131], v[40:43]
  v_mfma_f32_16x16x32_bf16 v[44:47], v[156:159], v[128:131], v[44:47]
  v_mfma_f32_16x16x32_bf16 v[48:51], v[160:163], v[128:131], v[48:51]
  v_mfma_f32_16x16x32_bf16 v[52:55], v[164:167], v[128:131], v[52:55]
  s_mov_b32 s40, 0
  v_add_u32 v6, 4096, v6
  v_add_u32 v7, 4096, v7
qkvb_loop9:
  buffer_load_dwordx4 v[120:123], v1, s[4:7], s30 offen offset:3072
  buffer_load_dwordx4 v[124:127], v1, s[4:7], s31 offen offset:3072
  buffer_load_dwordx4 v[128:131], v1, s[4:7], s32 offen offset:3072
  s_waitcnt vmcnt(9)
  ds_read_b128 v[152:155], v6 offset:1024
  ds_read_b128 v[156:159], v6 offset:21504
  ds_read_b128 v[160:163], v7 offset:1024
  ds_read_b128 v[164:167], v7 offset:21504
  s_waitcnt lgkmcnt(4)
  v_mfma_f32_16x16x32_bf16 v[8:11], v[136:139], v[72:75], v[8:11]
  v_mfma_f32_16x16x32_bf16 v[12:15], v[140:143], v[72:75], v[12:15]
  v_mfma_f32_16x16x32_bf16 v[16:19], v[144:147], v[72:75], v[16:19]
  v_mfma_f32_16x16x32_bf16 v[20:23], v[148:151], v[72:75], v[20:23]
  v_mfma_f32_16x16x32_bf16 v[24:27], v[136:139], v[76:79], v[24:27]
  v_mfma_f32_16x16x32_bf16 v[28:31], v[140:143], v[76:79], v[28:31]
  v_mfma_f32_16x16x32_bf16 v[32:35], v[144:147], v[76:79], v[32:35]
  v_mfma_f32_16x16x32_bf16 v[36:39], v[148:151], v[76:79], v[36:39]
  v_mfma_f32_16x16x32_bf16 v[40:43], v[136:139], v[80:83], v[40:43]
  v_mfma_f32_16x16x32_bf16 v[44:47], v[140:143], v[80:83], v[44:47]
  v_mfma_f32_16x16x32_bf16 v[48:51], v[144:147], v[80:83], v[48:51]
  v_mfma_f32_16x16x32_bf16 v[52:55], v[148:151], v[80:83], v[52:55]
  s_add_u32 s30, s30, 4096
  s_add_u32 s31, s31, 4096
  s_add_u32 s32, s32, 4096
  buffer_load_dwordx4 v[72:75], v1, s[4:7], s30 offen offset:0
  buffer_load_dwordx4 v[76:79], v1, s[4:7], s31 offen offset:0
  buffer_load_dwordx4 v[80:83], v1, s[4:7], s32 offen offset:0
  s_waitcnt vmcnt(9)
  ds_read_b128 v[136:139], v6 offset:2048
  ds_read_b128 v[140:143], v6 offset:22528
  ds_read_b128 v[144:147], v7 offset:2048
  ds_read_b128 v[148:151], v7 offset:22528
  s_waitcnt lgkmcnt(4)
  v_mfma_f32_16x16x32_bf16 v[8:11], v[152:155], v[88:91], v[8:11]
  v_mfma_f32_16x16x32_bf16 v[12:15], v[156:159], v[88:91], v[12:15]
  v_mfma_f32_16x16x32_bf16 v[16:19], v[160:163], v[88:91], v[16:19]
  v_mfma_f32_16x16x32_bf16 v[20:23], v[164:167], v[88:91], v[20:23]
  v_mfma_f32_16x16x32_bf16 v[24:27], v[152:155], v[92:95], v[24:27]
  v_mfma_f32_16x16x32_bf16 v[28:31], v[156:159], v[92:95], v[28:31]
  v_mfma_f32_16x16x32_bf16 v[32:35], v[160:163], v[92:95], v[32:35]
  v_mfma_f32_16x16x32_bf16 v[36:39], v[164:167], v[92:95], v[36:39]
  v_mfma_f32_16x16x32_bf16 v[40:43], v[152:155], v[96:99], v[40:43]
  v_mfma_f32_16x16x32_bf16 v[44:47], v[156:159], v[96:99], v[44:47]
  v_mfma_f32_16x16x32_bf16 v[48:51], v[160:163], v[96:99], v[48:51]
  v_mfma_f32_16x16x32_bf16 v[52:55], v[164:167], v[96:99], v[52:55]
  buffer_load_dwordx4 v[88:91], v1, s[4:7], s30 offen offset:1024
  buffer_load_dwordx4 v[92:95], v1, s[4:7], s31 offen offset:1024
  buffer_load_dwordx4 v[96:99], v1, s[4:7], s32 offen offset:1024
  s_waitcnt vmcnt(9)
  ds_read_b128 v[152:155], v6 offset:3072
  ds_read_b128 v[156:159], v6 offset:23552
  ds_read_b128 v[160:163], v7 offset:3072
  ds_read_b128 v[164:167], v7 offset:23552
  s_waitcnt lgkmcnt(4)
  v_mfma_f32_16x16x32_bf16 v[8:11], v[136:139], v[104:107], v[8:11]
  v_mfma_f32_16x16x32_bf16 v[12:15], v[140:143], v[104:107], v[12:15]
  v_mfma_f32_16x16x32_bf16 v[16:19], v[144:147], v[104:107], v[16:19]
  v_mfma_f32_16x16x32_bf16 v[20:23], v[148:151], v[104:107], v[20:23]
  v_mfma_f32_16x16x32_bf16 v[24:27], v[136:139], v[108:111], v[24:27]
  v_mfma_f32_16x16x32_bf16 v[28:31], v[140:143], v[108:111], v[28:31]
  v_mfma_f32_16x16x32_bf16 v[32:35], v[144:147], v[108:111], v[32:35]
  v_mfma_f32_16x16x32_bf16 v[36:39], v[148:151], v[108:111], v[36:39]
  v_mfma_f32_16x16x32_bf16 v[40:43], v[136:139], v[112:115], v[40:43]
  v_mfma_f32_16x16x32_bf16 v[44:47], v[140:143], v[112:115], v[44:47]
  v_mfma_f32_16x16x32_bf16 v[48:51], v[144:147], v[112:115], v[48:51]
  v_mfma_f32_16x16x32_bf16 v[52:55], v[148:151], v[112:115], v[52:55]
  buffer_load_dwordx4 v[104:107], v1, s[4:7], s30 offen offset:2048
  buffer_load_dwordx4 v[108:111], v1, s[4:7], s31 offen offset:2048
  buffer_load_dwordx4 v[112:115], v1, s[4:7], s32 offen offset:2048
  s_waitcnt vmcnt(9)
  ds_read_b128 v[136:139], v6 offset:4096
  ds_read_b128 v[140:143], v6 offset:24576
  ds_read_b128 v[144:147], v7 offset:4096
  ds_read_b128 v[148:151], v7 offset:24576
  s_waitcnt lgkmcnt(4)
  v_mfma_f32_16x16x32_bf16 v[8:11], v[152:155], v[120:123], v[8:11]
  v_mfma_f32_16x16x32_bf16 v[12:15], v[156:159], v[120:123], v[12:15]
  v_mfma_f32_16x16x32_bf16 v[16:19], v[160:163], v[120:123], v[16:19]
  v_mfma_f32_16x16x32_bf16 v[20:23], v[164:167], v[120:123], v[20:23]
  v_mfma_f32_16x16x32_bf16 v[24:27], v[152:155], v[124:127], v[24:27]
  v_mfma_f32_16x16x32_bf16 v[28:31], v[156:159], v[124:127], v[28:31]
  v_mfma_f32_16x16x32_bf16 v[32:35], v[160:163], v[124:127], v[32:35]
  v_mfma_f32_16x16x32_bf16 v[36:39], v[164:167], v[124:127], v[36:39]
  v_mfma_f32_16x16x32_bf16 v[40:43], v[152:155], v[128:131], v[40:43]
  v_mfma_f32_16x16x32_bf16 v[44:47], v[156:159], v[128:131], v[44:47]
  v_mfma_f32_16x16x32_bf16 v[48:51], v[160:163], v[128:131], v[48:51]
  v_mfma_f32_16x16x32_bf16 v[52:55], v[164:167], v[128:131], v[52:55]
  v_add_u32 v6, 4096, v6
  v_add_u32 v7, 4096, v7
  s_add_u32 s40, s40, 1
  s_cmp_lt_u32 s40, 4
  s_cbranch_scc1 qkvb_loop9
  s_waitcnt vmcnt(0) lgkmcnt(0)
  v_and_b32 v2, 63, v0
  v_and_b32 v3, 15, v2
  v_lshrrev_b32 v4, 4, v2
  s_lshl_b32 s41, s17, 19
  s_lshl_b32 s42, s18, 12
  s_add_u32 s41, s41, s42
  s_mov_b32 s46, 0x3ea52b5c
  s_mov_b32 s47, 0x3ea52b5c
  v_add_u32 v5, 32, v3
  v_mul_u32_u24 v168, 205, v5
  v_lshrrev_b32 v168, 12, v168
  v_mul_u32_u24 v6, 20, v168
  v_sub_u32 v5, v5, v6
  v_lshlrev_b32 v168, 17, v168
  v_lshl_add_u32 v168, v5, 4, v168
  v_and_b32 v6, 1, v4
  v_lshl_add_u32 v168, v6, 9, v168
  v_lshrrev_b32 v6, 1, v4
  v_lshl_add_u32 v168, v6, 3, v168
  v_add_u32 v5, 48, v3
  v_mul_u32_u24 v169, 205, v5
  v_lshrrev_b32 v169, 12, v169
  v_mul_u32_u24 v6, 20, v169
  v_sub_u32 v5, v5, v6
  v_lshlrev_b32 v169, 17, v169
  v_lshl_add_u32 v169, v5, 4, v169
  v_and_b32 v6, 1, v4
  v_lshl_add_u32 v169, v6, 9, v169
  v_lshrrev_b32 v6, 1, v4
  v_lshl_add_u32 v169, v6, 3, v169
  v_add_u32 v5, 64, v3
  v_mul_u32_u24 v170, 205, v5
  v_lshrrev_b32 v170, 12, v170
  v_mul_u32_u24 v6, 20, v170
  v_sub_u32 v5, v5, v6
  v_lshlrev_b32 v170, 17, v170
  v_lshl_add_u32 v170, v5, 4, v170
  v_and_b32 v6, 1, v4
  v_lshl_add_u32 v170, v6, 9, v170
  v_lshrrev_b32 v6, 1, v4
  v_lshl_add_u32 v170, v6, 3, v170
  v_cvt_pk_bf16_f32 v136, v8, v9
  v_cvt_pk_bf16_f32 v137, v10, v11
  s_add_u32 s43, s41, 46137344
  buffer_store_dwordx2 v[136:137], v168, s[4:7], s43 offen sc1
  v_cvt_pk_bf16_f32 v138, v12, v13
  v_cvt_pk_bf16_f32 v139, v14, v15
  s_add_u32 s43, s41, 46138368
  buffer_store_dwordx2 v[138:139], v168, s[4:7], s43 offen sc1
  v_cvt_pk_bf16_f32 v140, v16, v17
  v_cvt_pk_bf16_f32 v141, v18, v19
  s_add_u32 s43, s41, 46139392
  buffer_store_dwordx2 v[140:141], v168, s[4:7], s43 offen sc1
  v_cvt_pk_bf16_f32 v142, v20, v21
  v_cvt_pk_bf16_f32 v143, v22, v23
  s_add_u32 s43, s41, 46140416
  buffer_store_dwordx2 v[142:143], v168, s[4:7], s43 offen sc1
  v_cvt_pk_bf16_f32 v144, v24, v25
  v_cvt_pk_bf16_f32 v145, v26, v27
  s_add_u32 s43, s41, 46137344
  buffer_store_dwordx2 v[144:145], v169, s[4:7], s43 offen sc1
  v_cvt_pk_bf16_f32 v146, v28, v29
  v_cvt_pk_bf16_f32 v147, v30, v31
  s_add_u32 s43, s41, 46138368
  buffer_store_dwordx2 v[146:147], v169, s[4:7], s43 offen sc1
  v_cvt_pk_bf16_f32 v148, v32, v33
  v_cvt_pk_bf16_f32 v149, v34, v35
  s_add_u32 s43, s41, 46139392
  buffer_store_dwordx2 v[148:149], v169, s[4:7], s43 offen sc1
  v_cvt_pk_bf16_f32 v150, v36, v37
  v_cvt_pk_bf16_f32 v151, v38, v39
  s_add_u32 s43, s41, 46140416
  buffer_store_dwordx2 v[150:151], v169, s[4:7], s43 offen sc1
  v_cvt_pk_bf16_f32 v136, v40, v41
  v_cvt_pk_bf16_f32 v137, v42, v43
  s_add_u32 s43, s41, 46137344
  buffer_store_dwordx2 v[136:137], v170, s[4:7], s43 offen sc1
  v_cvt_pk_bf16_f32 v138, v44, v45
  v_cvt_pk_bf16_f32 v139, v46, v47
  s_add_u32 s43, s41, 46138368
  buffer_store_dwordx2 v[138:139], v170, s[4:7], s43 offen sc1
  v_cvt_pk_bf16_f32 v140, v48, v49
  v_cvt_pk_bf16_f32 v141, v50, v51
  s_add_u32 s43, s41, 46139392
  buffer_store_dwordx2 v[140:141], v170, s[4:7], s43 offen sc1
  v_cvt_pk_bf16_f32 v142, v52, v53
  v_cvt_pk_bf16_f32 v143, v54, v55
  s_add_u32 s43, s41, 46140416
  buffer_store_dwordx2 v[142:143], v170, s[4:7], s43 offen sc1
  v_mov_b32 v72, 0
  v_mov_b32 v73, 0
  v_mov_b32 v74, 0
  v_mov_b32 v75, 0
  v_lshlrev_b32 v5, 17, v4
  v_lshl_add_u32 v5, v3, 4, v5
  v_add_u32 v6, 1032, v5
  v_add_u32 v7, 1536, v5
  s_add_u32 s43, s41, 37748736
  buffer_store_dwordx2 v[72:73], v6, s[4:7], s43 offen sc1
  buffer_store_dwordx4 v[72:75], v7, s[4:7], s43 offen sc1
  s_add_u32 s43, s41, 37748992
  buffer_store_dwordx2 v[72:73], v6, s[4:7], s43 offen sc1
  buffer_store_dwordx4 v[72:75], v7, s[4:7], s43 offen sc1
  s_add_u32 s43, s41, 37750784
  buffer_store_dwordx2 v[72:73], v6, s[4:7], s43 offen sc1
  buffer_store_dwordx4 v[72:75], v7, s[4:7], s43 offen sc1
  s_add_u32 s43, s41, 37751040
  buffer_store_dwordx2 v[72:73], v6, s[4:7], s43 offen sc1
  buffer_store_dwordx4 v[72:75], v7, s[4:7], s43 offen sc1
  s_add_u32 s43, s41, 41943040
  buffer_store_dwordx2 v[72:73], v6, s[4:7], s43 offen sc1
  buffer_store_dwordx4 v[72:75], v7, s[4:7], s43 offen sc1
  s_add_u32 s43, s41, 41943296
  buffer_store_dwordx2 v[72:73], v6, s[4:7], s43 offen sc1
  buffer_store_dwordx4 v[72:75], v7, s[4:7], s43 offen sc1
  s_add_u32 s43, s41, 41945088
  buffer_store_dwordx2 v[72:73], v6, s[4:7], s43 offen sc1
  buffer_store_dwordx4 v[72:75], v7, s[4:7], s43 offen sc1
  s_add_u32 s43, s41, 41945344
  buffer_store_dwordx2 v[72:73], v6, s[4:7], s43 offen sc1
  buffer_store_dwordx4 v[72:75], v7, s[4:7], s43 offen sc1
  v_and_b32 v6, 1, v4
  v_lshlrev_b32 v6, 9, v6
  v_add_u32 v5, 20, v3
  v_lshl_add_u32 v6, v5, 4, v6
  v_lshrrev_b32 v5, 1, v4
  v_lshl_add_u32 v6, v5, 17, v6
  v_mov_b32 v5, 0x80000000
  v_cmp_gt_u32 vcc, 12, v3
  s_nop 1
  v_cndmask_b32 v6, v5, v6, vcc
  v_cmp_eq_u32 vcc, 0, v3
  v_mov_b32 v5, 0x3f803f80
  s_nop 0
  v_cndmask_b32 v76, 0, v5, vcc
  v_mov_b32 v77, v76
  v_mov_b32 v78, v76
  v_mov_b32 v79, v76
  s_add_u32 s43, s41, 46137344
  buffer_store_dwordx4 v[76:79], v6, s[4:7], s43 offen sc1
  s_add_u32 s43, s41, 46138368
  buffer_store_dwordx4 v[76:79], v6, s[4:7], s43 offen sc1
  s_add_u32 s43, s41, 46139392
  buffer_store_dwordx4 v[76:79], v6, s[4:7], s43 offen sc1
  s_add_u32 s43, s41, 46140416
  buffer_store_dwordx4 v[76:79], v6, s[4:7], s43 offen sc1
  s_add_u32 s43, s41, 46399488
  buffer_store_dwordx4 v[76:79], v6, s[4:7], s43 offen sc1
  s_add_u32 s43, s41, 46400512
  buffer_store_dwordx4 v[76:79], v6, s[4:7], s43 offen sc1
  s_add_u32 s43, s41, 46401536
  buffer_store_dwordx4 v[76:79], v6, s[4:7], s43 offen sc1
  s_add_u32 s43, s41, 46402560
  buffer_store_dwordx4 v[76:79], v6, s[4:7], s43 offen sc1
  s_branch qkvb_exit1
qkvb_exit1:
  s_endpgm
.globl attnb_kernel
.p2align 8
.type attnb_kernel,@function
attnb_kernel:
  s_cmp_ge_u32 s2, 256
  s_cbranch_scc1 attnb_exit1
  s_load_dwordx2 s[12:13], s[0:1], 96
  v_lshrrev_b32 v2, 6, v0
  v_and_b32 v3, 63, v0
  s_nop 0
  v_readfirstlane_b32 s16, v2
  v_lshlrev_b32 v1, 4, v3
  s_and_b32 s17, s2, 7
  s_lshl_b32 s17, s17, 2
  s_lshr_b32 s18, s2, 3
  s_and_b32 s19, s18, 3
  s_add_u32 s17, s17, s19
  s_lshr_b32 s18, s18, 2
  s_waitcnt lgkmcnt(0)
  s_mov_b32 s4, s12
  s_mov_b32 s5, s13
  s_mov_b32 s6, 0x10000000
  s_mov_b32 s7, 0x20000
  s_lshl_b32 s20, s17, 17
  s_add_u32 s21, s20, 41943040
  s_add_u32 s22, s20, 46137344
  s_lshl_b32 s23, s18, 3
  s_lshl_b32 s24, s16, 1
  s_add_u32 s23, s23, s24
  s_lshl_b32 s24, s23, 11
  s_add_u32 s24, s24, s20
  s_add_u32 s24, s24, 37748736
  buffer_load_dwordx4 v[8:11], v1, s[4:7], s24 offen offset:0
  buffer_load_dwordx4 v[12:15], v1, s[4:7], s24 offen offset:1024
  buffer_load_dwordx4 v[16:19], v1, s[4:7], s24 offen offset:2048
  buffer_load_dwordx4 v[20:23], v1, s[4:7], s24 offen offset:3072
  s_mov_b32 s25, s21
  s_mov_b32 s26, s22
  buffer_load_dwordx4 v[136:139], v1, s[4:7], s25 offen
  buffer_load_dwordx4 v[140:143], v1, s[4:7], s25 offen offset:1024
  buffer_load_dwordx4 v[144:147], v1, s[4:7], s26 offen
  buffer_load_dwordx4 v[148:151], v1, s[4:7], s26 offen offset:1024
  s_add_u32 s25, s25, 2048
  s_add_u32 s26, s26, 2048
  s_waitcnt vmcnt(0)
  v_mfma_f32_32x32x16_bf16 v[88:103], v[136:139], v[8:11], 0
  v_mfma_f32_32x32x16_bf16 v[88:103], v[140:143], v[12:15], v[88:103]
  v_mfma_f32_32x32x16_bf16 v[104:119], v[136:139], v[16:19], 0
  v_mfma_f32_32x32x16_bf16 v[104:119], v[140:143], v[20:23], v[104:119]
  s_nop 9
  v_max3_f32 v2, v88, v89, v90
  v_max3_f32 v2, v2, v91, v92
  v_max3_f32 v2, v2, v93, v94
  v_max3_f32 v2, v2, v95, v96
  v_max3_f32 v2, v2, v97, v98
  v_max3_f32 v2, v2, v99, v100
  v_max3_f32 v2, v2, v101, v102
  v_max_f32 v2, v2, v103
  v_mov_b32 v4, v2
  s_nop 1
  v_permlane32_swap_b32 v2, v4
  v_max_f32 v2, v2, v4
  v_sub_f32 v24, 0, v2
  v_sub_f32 v25, 0, v2
  v_sub_f32 v26, 0, v2
  v_sub_f32 v27, 0, v2
  v_sub_f32 v28, 0, v2
  v_sub_f32 v29, 0, v2
  v_sub_f32 v30, 0, v2
  v_sub_f32 v31, 0, v2
  v_sub_f32 v32, 0, v2
  v_sub_f32 v33, 0, v2
  v_sub_f32 v34, 0, v2
  v_sub_f32 v35, 0, v2
  v_sub_f32 v36, 0, v2
  v_sub_f32 v37, 0, v2
  v_sub_f32 v38, 0, v2
  v_sub_f32 v39, 0, v2
  v_max3_f32 v3, v104, v105, v106
  v_max3_f32 v3, v3, v107, v108
  v_max3_f32 v3, v3, v109, v110
  v_max3_f32 v3, v3, v111, v112
  v_max3_f32 v3, v3, v113, v114
  v_max3_f32 v3, v3, v115, v116
  v_max3_f32 v3, v3, v117, v118
  v_max_f32 v3, v3, v119
  v_mov_b32 v4, v3
  s_nop 1
  v_permlane32_swap_b32 v3, v4
  v_max_f32 v3, v3, v4
  v_sub_f32 v40, 0, v3
  v_sub_f32 v41, 0, v3
  v_sub_f32 v42, 0, v3
  v_sub_f32 v43, 0, v3
  v_sub_f32 v44, 0, v3
  v_sub_f32 v45, 0, v3
  v_sub_f32 v46, 0, v3
  v_sub_f32 v47, 0, v3
  v_sub_f32 v48, 0, v3
  v_sub_f32 v49, 0, v3
  v_sub_f32 v50, 0, v3
  v_sub_f32 v51, 0, v3
  v_sub_f32 v52, 0, v3
  v_sub_f32 v53, 0, v3
  v_sub_f32 v54, 0, v3
  v_sub_f32 v55, 0, v3
  s_mov_b32 s28, 0
attnb_main2:
  s_mov_b32 s25, s21
  s_mov_b32 s26, s22
  buffer_load_dwordx4 v[136:139], v1, s[4:7], s25 offen
  buffer_load_dwordx4 v[140:143], v1, s[4:7], s25 offen offset:1024
  buffer_load_dwordx4 v[144:147], v1, s[4:7], s26 offen
  buffer_load_dwordx4 v[148:151], v1, s[4:7], s26 offen offset:1024
  s_add_u32 s25, s25, 2048
  s_add_u32 s26, s26, 2048
  buffer_load_dwordx4 v[152:155], v1, s[4:7], s25 offen
  buffer_load_dwordx4 v[156:159], v1, s[4:7], s25 offen offset:1024
  buffer_load_dwordx4 v[160:163], v1, s[4:7], s26 offen
  buffer_load_dwordx4 v[164:167], v1, s[4:7], s26 offen offset:1024
  s_add_u32 s25, s25, 2048
  s_add_u32 s26, s26, 2048
  v_mov_b32 v56, 0
  v_mov_b32 v57, 0
  v_mov_b32 v58, 0
  v_mov_b32 v59, 0
  v_mov_b32 v60, 0
  v_mov_b32 v61, 0
  v_mov_b32 v62, 0
  v_mov_b32 v63, 0
  v_mov_b32 v64, 0
  v_mov_b32 v65, 0
  v_mov_b32 v66, 0
  v_mov_b32 v67, 0
  v_mov_b32 v68, 0
  v_mov_b32 v69, 0
  v_mov_b32 v70, 0
  v_mov_b32 v71, 0
  v_mov_b32 v72, 0
  v_mov_b32 v73, 0
  v_mov_b32 v74, 0
  v_mov_b32 v75, 0
  v_mov_b32 v76, 0
  v_mov_b32 v77, 0
  v_mov_b32 v78, 0
  v_mov_b32 v79, 0
  v_mov_b32 v80, 0
  v_mov_b32 v81, 0
  v_mov_b32 v82, 0
  v_mov_b32 v83, 0
  v_mov_b32 v84, 0
  v_mov_b32 v85, 0
  v_mov_b32 v86, 0
  v_mov_b32 v87, 0
  s_waitcnt vmcnt(4)
  v_mfma_f32_32x32x16_bf16 v[88:103], v[136:139], v[8:11], v[24:39]
  v_mfma_f32_32x32x16_bf16 v[88:103], v[140:143], v[12:15], v[88:103]
  s_nop 11
  v_exp_f32 v88, v88
  v_exp_f32 v89, v89
  v_exp_f32 v90, v90
  v_exp_f32 v91, v91
  v_exp_f32 v92, v92
  v_exp_f32 v93, v93
  v_exp_f32 v94, v94
  v_exp_f32 v95, v95
  v_mfma_f32_32x32x16_bf16 v[104:119], v[136:139], v[16:19], v[40:55]
  v_cvt_pk_bf16_f32 v120, v88, v89
  v_cvt_pk_bf16_f32 v121, v90, v91
  v_cvt_pk_bf16_f32 v122, v92, v93
  v_cvt_pk_bf16_f32 v123, v94, v95
  v_exp_f32 v96, v96
  v_exp_f32 v97, v97
  v_mfma_f32_32x32x16_bf16 v[104:119], v[140:143], v[20:23], v[104:119]
  v_exp_f32 v98, v98
  v_exp_f32 v99, v99
  v_exp_f32 v100, v100
  v_exp_f32 v101, v101
  v_mfma_f32_32x32x16_bf16 v[56:71], v[144:147], v[120:123], v[56:71]
  v_exp_f32 v102, v102
  v_exp_f32 v103, v103
  v_cvt_pk_bf16_f32 v124, v96, v97
  v_cvt_pk_bf16_f32 v125, v98, v99
  v_cvt_pk_bf16_f32 v126, v100, v101
  v_cvt_pk_bf16_f32 v127, v102, v103
  buffer_load_dwordx4 v[168:171], v1, s[4:7], s25 offen
  buffer_load_dwordx4 v[172:175], v1, s[4:7], s25 offen offset:1024
  buffer_load_dwordx4 v[176:179], v1, s[4:7], s26 offen
  buffer_load_dwordx4 v[180:183], v1, s[4:7], s26 offen offset:1024
  s_add_u32 s25, s25, 2048
  s_add_u32 s26, s26, 2048
  s_waitcnt vmcnt(4)
  v_exp_f32 v104, v104
  v_exp_f32 v105, v105
  v_exp_f32 v106, v106
  v_exp_f32 v107, v107
  v_mfma_f32_32x32x16_bf16 v[56:71], v[148:151], v[124:127], v[56:71]
  v_exp_f32 v108, v108
  v_exp_f32 v109, v109
  v_exp_f32 v110, v110
  v_exp_f32 v111, v111
  v_mfma_f32_32x32x16_bf16 v[88:103], v[152:155], v[8:11], v[24:39]
  v_cvt_pk_bf16_f32 v128, v104, v105
  v_cvt_pk_bf16_f32 v129, v106, v107
  v_cvt_pk_bf16_f32 v130, v108, v109
  v_cvt_pk_bf16_f32 v131, v110, v111
  v_exp_f32 v112, v112
  v_exp_f32 v113, v113
  v_mfma_f32_32x32x16_bf16 v[88:103], v[156:159], v[12:15], v[88:103]
  v_exp_f32 v114, v114
  v_exp_f32 v115, v115
  v_exp_f32 v116, v116
  v_exp_f32 v117, v117
  v_mfma_f32_32x32x16_bf16 v[72:87], v[144:147], v[128:131], v[72:87]
  v_exp_f32 v118, v118
  v_exp_f32 v119, v119
  v_cvt_pk_bf16_f32 v132, v112, v113
  v_cvt_pk_bf16_f32 v133, v114, v115
  v_cvt_pk_bf16_f32 v134, v116, v117
  v_cvt_pk_bf16_f32 v135, v118, v119
  s_mov_b32 s27, 0
attnb_loop3:
  v_exp_f32 v88, v88
  v_exp_f32 v89, v89
  v_exp_f32 v90, v90
  v_exp_f32 v91, v91
  v_mfma_f32_32x32x16_bf16 v[72:87], v[148:151], v[132:135], v[72:87]
  v_exp_f32 v92, v92
  v_exp_f32 v93, v93
  v_exp_f32 v94, v94
  v_exp_f32 v95, v95
  v_mfma_f32_32x32x16_bf16 v[104:119], v[152:155], v[16:19], v[40:55]
  v_cvt_pk_bf16_f32 v120, v88, v89
  v_cvt_pk_bf16_f32 v121, v90, v91
  v_cvt_pk_bf16_f32 v122, v92, v93
  v_cvt_pk_bf16_f32 v123, v94, v95
  v_exp_f32 v96, v96
  v_exp_f32 v97, v97
  v_mfma_f32_32x32x16_bf16 v[104:119], v[156:159], v[20:23], v[104:119]
  v_exp_f32 v98, v98
  v_exp_f32 v99, v99
  v_exp_f32 v100, v100
  v_exp_f32 v101, v101
  v_mfma_f32_32x32x16_bf16 v[56:71], v[160:163], v[120:123], v[56:71]
  v_exp_f32 v102, v102
  v_exp_f32 v103, v103
  v_cvt_pk_bf16_f32 v124, v96, v97
  v_cvt_pk_bf16_f32 v125, v98, v99
  v_cvt_pk_bf16_f32 v126, v100, v101
  v_cvt_pk_bf16_f32 v127, v102, v103
  buffer_load_dwordx4 v[136:139], v1, s[4:7], s25 offen
  buffer_load_dwordx4 v[140:143], v1, s[4:7], s25 offen offset:1024
  buffer_load_dwordx4 v[144:147], v1, s[4:7], s26 offen
  buffer_load_dwordx4 v[148:151], v1, s[4:7], s26 offen offset:1024
  s_add_u32 s25, s25, 2048
  s_add_u32 s26, s26, 2048
  s_waitcnt vmcnt(4)
  v_exp_f32 v104, v104
  v_exp_f32 v105, v105
  v_exp_f32 v106, v106
  v_exp_f32 v107, v107
  v_mfma_f32_32x32x16_bf16 v[56:71], v[164:167], v[124:127], v[56:71]
  v_exp_f32 v108, v108
  v_exp_f32 v109, v109
  v_exp_f32 v110, v110
  v_exp_f32 v111, v111
  v_mfma_f32_32x32x16_bf16 v[88:103], v[168:171], v[8:11], v[24:39]
  v_cvt_pk_bf16_f32 v128, v104, v105
  v_cvt_pk_bf16_f32 v129, v106, v107
  v_cvt_pk_bf16_f32 v130, v108, v109
  v_cvt_pk_bf16_f32 v131, v110, v111
  v_exp_f32 v112, v112
  v_exp_f32 v113, v113
  v_mfma_f32_32x32x16_bf16 v[88:103], v[172:175], v[12:15], v[88:103]
  v_exp_f32 v114, v114
  v_exp_f32 v115, v115
  v_exp_f32 v116, v116
  v_exp_f32 v117, v117
  v_mfma_f32_32x32x16_bf16 v[72:87], v[160:163], v[128:131], v[72:87]
  v_exp_f32 v118, v118
  v_exp_f32 v119, v119
  v_cvt_pk_bf16_f32 v132, v112, v113
  v_cvt_pk_bf16_f32 v133, v114, v115
  v_cvt_pk_bf16_f32 v134, v116, v117
  v_cvt_pk_bf16_f32 v135, v118, v119
  s_nop 0
  v_exp_f32 v88, v88
  v_exp_f32 v89, v89
  v_exp_f32 v90, v90
  v_exp_f32 v91, v91
  v_mfma_f32_32x32x16_bf16 v[72:87], v[164:167], v[132:135], v[72:87]
  v_exp_f32 v92, v92
  v_exp_f32 v93, v93
  v_exp_f32 v94, v94
  v_exp_f32 v95, v95
  v_mfma_f32_32x32x16_bf16 v[104:119], v[168:171], v[16:19], v[40:55]
  v_cvt_pk_bf16_f32 v120, v88, v89
  v_cvt_pk_bf16_f32 v121, v90, v91
  v_cvt_pk_bf16_f32 v122, v92, v93
  v_cvt_pk_bf16_f32 v123, v94, v95
  v_exp_f32 v96, v96
  v_exp_f32 v97, v97
  v_mfma_f32_32x32x16_bf16 v[104:119], v[172:175], v[20:23], v[104:119]
  v_exp_f32 v98, v98
  v_exp_f32 v99, v99
  v_exp_f32 v100, v100
  v_exp_f32 v101, v101
  v_mfma_f32_32x32x16_bf16 v[56:71], v[176:179], v[120:123], v[56:71]
  v_exp_f32 v102, v102
  v_exp_f32 v103, v103
  v_cvt_pk_bf16_f32 v124, v96, v97
  v_cvt_pk_bf16_f32 v125, v98, v99
  v_cvt_pk_bf16_f32 v126, v100, v101
  v_cvt_pk_bf16_f32 v127, v102, v103
  buffer_load_dwordx4 v[152:155], v1, s[4:7], s25 offen
  buffer_load_dwordx4 v[156:159], v1, s[4:7], s25 offen offset:1024
  buffer_load_dwordx4 v[160:163], v1, s[4:7], s26 offen
  buffer_load_dwordx4 v[164:167], v1, s[4:7], s26 offen offset:1024
  s_add_u32 s25, s25, 2048
  s_add_u32 s26, s26, 2048
  s_waitcnt vmcnt(4)
  v_exp_f32 v104, v104
  v_exp_f32 v105, v105
  v_exp_f32 v106, v106
  v_exp_f32 v107, v107
  v_mfma_f32_32x32x16_bf16 v[56:71], v[180:183], v[124:127], v[56:71]
  v_exp_f32 v108, v108
  v_exp_f32 v109, v109
  v_exp_f32 v110, v110
  v_exp_f32 v111, v111
  v_mfma_f32_32x32x16_bf16 v[88:103], v[136:139], v[8:11], v[24:39]
  v_cvt_pk_bf16_f32 v128, v104, v105
  v_cvt_pk_bf16_f32 v129, v106, v107
  v_cvt_pk_bf16_f32 v130, v108, v109
  v_cvt_pk_bf16_f32 v131, v110, v111
  v_exp_f32 v112, v112
  v_exp_f32 v113, v113
  v_mfma_f32_32x32x16_bf16 v[88:103], v[140:143], v[12:15], v[88:103]
  v_exp_f32 v114, v114
  v_exp_f32 v115, v115
  v_exp_f32 v116, v116
  v_exp_f32 v117, v117
  v_mfma_f32_32x32x16_bf16 v[72:87], v[176:179], v[128:131], v[72:87]
  v_exp_f32 v118, v118
  v_exp_f32 v119, v119
  v_cvt_pk_bf16_f32 v132, v112, v113
  v_cvt_pk_bf16_f32 v133, v114, v115
  v_cvt_pk_bf16_f32 v134, v116, v117
  v_cvt_pk_bf16_f32 v135, v118, v119
  s_nop 0
  v_exp_f32 v88, v88
  v_exp_f32 v89, v89
  v_exp_f32 v90, v90
  v_exp_f32 v91, v91
  v_mfma_f32_32x32x16_bf16 v[72:87], v[180:183], v[132:135], v[72:87]
  v_exp_f32 v92, v92
  v_exp_f32 v93, v93
  v_exp_f32 v94, v94
  v_exp_f32 v95, v95
  v_mfma_f32_32x32x16_bf16 v[104:119], v[136:139], v[16:19], v[40:55]
  v_cvt_pk_bf16_f32 v120, v88, v89
  v_cvt_pk_bf16_f32 v121, v90, v91
  v_cvt_pk_bf16_f32 v122, v92, v93
  v_cvt_pk_bf16_f32 v123, v94, v95
  v_exp_f32 v96, v96
  v_exp_f32 v97, v97
  v_mfma_f32_32x32x16_bf16 v[104:119], v[140:143], v[20:23], v[104:119]
  v_exp_f32 v98, v98
  v_exp_f32 v99, v99
  v_exp_f32 v100, v100
  v_exp_f32 v101, v101
  v_mfma_f32_32x32x16_bf16 v[56:71], v[144:147], v[120:123], v[56:71]
  v_exp_f32 v102, v102
  v_exp_f32 v103, v103
  v_cvt_pk_bf16_f32 v124, v96, v97
  v_cvt_pk_bf16_f32 v125, v98, v99
  v_cvt_pk_bf16_f32 v126, v100, v101
  v_cvt_pk_bf16_f32 v127, v102, v103
  buffer_load_dwordx4 v[168:171], v1, s[4:7], s25 offen
  buffer_load_dwordx4 v[172:175], v1, s[4:7], s25 offen offset:1024
  buffer_load_dwordx4 v[176:179], v1, s[4:7], s26 offen
  buffer_load_dwordx4 v[180:183], v1, s[4:7], s26 offen offset:1024
  s_add_u32 s25, s25, 2048
  s_add_u32 s26, s26, 2048
  s_waitcnt vmcnt(4)
  v_exp_f32 v104, v104
  v_exp_f32 v105, v105
  v_exp_f32 v106, v106
  v_exp_f32 v107, v107
  v_mfma_f32_32x32x16_bf16 v[56:71], v[148:151], v[124:127], v[56:71]
  v_exp_f32 v108, v108
  v_exp_f32 v109, v109
  v_exp_f32 v110, v110
  v_exp_f32 v111, v111
  v_mfma_f32_32x32x16_bf16 v[88:103], v[152:155], v[8:11], v[24:39]
  v_cvt_pk_bf16_f32 v128, v104, v105
  v_cvt_pk_bf16_f32 v129, v106, v107
  v_cvt_pk_bf16_f32 v130, v108, v109
  v_cvt_pk_bf16_f32 v131, v110, v111
  v_exp_f32 v112, v112
  v_exp_f32 v113, v113
  v_mfma_f32_32x32x16_bf16 v[88:103], v[156:159], v[12:15], v[88:103]
  v_exp_f32 v114, v114
  v_exp_f32 v115, v115
  v_exp_f32 v116, v116
  v_exp_f32 v117, v117
  v_mfma_f32_32x32x16_bf16 v[72:87], v[144:147], v[128:131], v[72:87]
  v_exp_f32 v118, v118
  v_exp_f32 v119, v119
  v_cvt_pk_bf16_f32 v132, v112, v113
  v_cvt_pk_bf16_f32 v133, v114, v115
  v_cvt_pk_bf16_f32 v134, v116, v117
  v_cvt_pk_bf16_f32 v135, v118, v119
  s_add_u32 s27, s27, 1
  s_cmp_lt_u32 s27, 20
  s_cbranch_scc1 attnb_loop3
  v_exp_f32 v88, v88
  v_exp_f32 v89, v89
  v_exp_f32 v90, v90
  v_exp_f32 v91, v91
  v_mfma_f32_32x32x16_bf16 v[72:87], v[148:151], v[132:135], v[72:87]
  v_exp_f32 v92, v92
  v_exp_f32 v93, v93
  v_exp_f32 v94, v94
  v_exp_f32 v95, v95
  v_mfma_f32_32x32x16_bf16 v[104:119], v[152:155], v[16:19], v[40:55]
  v_cvt_pk_bf16_f32 v120, v88, v89
  v_cvt_pk_bf16_f32 v121, v90, v91
  v_cvt_pk_bf16_f32 v122, v92, v93
  v_cvt_pk_bf16_f32 v123, v94, v95
  v_exp_f32 v96, v96
  v_exp_f32 v97, v97
  v_mfma_f32_32x32x16_bf16 v[104:119], v[156:159], v[20:23], v[104:119]
  v_exp_f32 v98, v98
  v_exp_f32 v99, v99
  v_exp_f32 v100, v100
  v_exp_f32 v101, v101
  v_mfma_f32_32x32x16_bf16 v[56:71], v[160:163], v[120:123], v[56:71]
  v_exp_f32 v102, v102
  v_exp_f32 v103, v103
  v_cvt_pk_bf16_f32 v124, v96, v97
  v_cvt_pk_bf16_f32 v125, v98, v99
  v_cvt_pk_bf16_f32 v126, v100, v101
  v_cvt_pk_bf16_f32 v127, v102, v103
  buffer_load_dwordx4 v[136:139], v1, s[4:7], s25 offen
  buffer_load_dwordx4 v[140:143], v1, s[4:7], s25 offen offset:1024
  buffer_load_dwordx4 v[144:147], v1, s[4:7], s26 offen
  buffer_load_dwordx4 v[148:151], v1, s[4:7], s26 offen offset:1024
  s_add_u32 s25, s25, 2048
  s_add_u32 s26, s26, 2048
  s_waitcnt vmcnt(4)
  v_exp_f32 v104, v104
  v_exp_f32 v105, v105
  v_exp_f32 v106, v106
  v_exp_f32 v107, v107
  v_mfma_f32_32x32x16_bf16 v[56:71], v[164:167], v[124:127], v[56:71]
  v_exp_f32 v108, v108
  v_exp_f32 v109, v109
  v_exp_f32 v110, v110
  v_exp_f32 v111, v111
  v_mfma_f32_32x32x16_bf16 v[88:103], v[168:171], v[8:11], v[24:39]
  v_cvt_pk_bf16_f32 v128, v104, v105
  v_cvt_pk_bf16_f32 v129, v106, v107
  v_cvt_pk_bf16_f32 v130, v108, v109
  v_cvt_pk_bf16_f32 v131, v110, v111
  v_exp_f32 v112, v112
  v_exp_f32 v113, v113
  v_mfma_f32_32x32x16_bf16 v[88:103], v[172:175], v[12:15], v[88:103]
  v_exp_f32 v114, v114
  v_exp_f32 v115, v115
  v_exp_f32 v116, v116
  v_exp_f32 v117, v117
  v_mfma_f32_32x32x16_bf16 v[72:87], v[160:163], v[128:131], v[72:87]
  v_exp_f32 v118, v118
  v_exp_f32 v119, v119
  v_cvt_pk_bf16_f32 v132, v112, v113
  v_cvt_pk_bf16_f32 v133, v114, v115
  v_cvt_pk_bf16_f32 v134, v116, v117
  v_cvt_pk_bf16_f32 v135, v118, v119
  s_nop 0
  v_exp_f32 v88, v88
  v_exp_f32 v89, v89
  v_exp_f32 v90, v90
  v_exp_f32 v91, v91
  v_mfma_f32_32x32x16_bf16 v[72:87], v[164:167], v[132:135], v[72:87]
  v_exp_f32 v92, v92
  v_exp_f32 v93, v93
  v_exp_f32 v94, v94
  v_exp_f32 v95, v95
  v_mfma_f32_32x32x16_bf16 v[104:119], v[168:171], v[16:19], v[40:55]
  v_cvt_pk_bf16_f32 v120, v88, v89
  v_cvt_pk_bf16_f32 v121, v90, v91
  v_cvt_pk_bf16_f32 v122, v92, v93
  v_cvt_pk_bf16_f32 v123, v94, v95
  v_exp_f32 v96, v96
  v_exp_f32 v97, v97
  v_mfma_f32_32x32x16_bf16 v[104:119], v[172:175], v[20:23], v[104:119]
  v_exp_f32 v98, v98
  v_exp_f32 v99, v99
  v_exp_f32 v100, v100
  v_exp_f32 v101, v101
  v_mfma_f32_32x32x16_bf16 v[56:71], v[176:179], v[120:123], v[56:71]
  v_exp_f32 v102, v102
  v_exp_f32 v103, v103
  v_cvt_pk_bf16_f32 v124, v96, v97
  v_cvt_pk_bf16_f32 v125, v98, v99
  v_cvt_pk_bf16_f32 v126, v100, v101
  v_cvt_pk_bf16_f32 v127, v102, v103
  s_waitcnt vmcnt(0)
  v_exp_f32 v104, v104
  v_exp_f32 v105, v105
  v_exp_f32 v106, v106
  v_exp_f32 v107, v107
  v_mfma_f32_32x32x16_bf16 v[56:71], v[180:183], v[124:127], v[56:71]
  v_exp_f32 v108, v108
  v_exp_f32 v109, v109
  v_exp_f32 v110, v110
  v_exp_f32 v111, v111
  v_mfma_f32_32x32x16_bf16 v[88:103], v[136:139], v[8:11], v[24:39]
  v_cvt_pk_bf16_f32 v128, v104, v105
  v_cvt_pk_bf16_f32 v129, v106, v107
  v_cvt_pk_bf16_f32 v130, v108, v109
  v_cvt_pk_bf16_f32 v131, v110, v111
  v_exp_f32 v112, v112
  v_exp_f32 v113, v113
  v_mfma_f32_32x32x16_bf16 v[88:103], v[140:143], v[12:15], v[88:103]
  v_exp_f32 v114, v114
  v_exp_f32 v115, v115
  v_exp_f32 v116, v116
  v_exp_f32 v117, v117
  v_mfma_f32_32x32x16_bf16 v[72:87], v[176:179], v[128:131], v[72:87]
  v_exp_f32 v118, v118
  v_exp_f32 v119, v119
  v_cvt_pk_bf16_f32 v132, v112, v113
  v_cvt_pk_bf16_f32 v133, v114, v115
  v_cvt_pk_bf16_f32 v134, v116, v117
  v_cvt_pk_bf16_f32 v135, v118, v119
  s_nop 0
  v_exp_f32 v88, v88
  v_exp_f32 v89, v89
  v_exp_f32 v90, v90
  v_exp_f32 v91, v91
  v_mfma_f32_32x32x16_bf16 v[72:87], v[180:183], v[132:135], v[72:87]
  v_exp_f32 v92, v92
  v_exp_f32 v93, v93
  v_exp_f32 v94, v94
  v_exp_f32 v95, v95
  v_mfma_f32_32x32x16_bf16 v[104:119], v[136:139], v[16:19], v[40:55]
  v_cvt_pk_bf16_f32 v120, v88, v89
  v_cvt_pk_bf16_f32 v121, v90, v91
  v_cvt_pk_bf16_f32 v122, v92, v93
  v_cvt_pk_bf16_f32 v123, v94, v95
  v_exp_f32 v96, v96
  v_exp_f32 v97, v97
  v_mfma_f32_32x32x16_bf16 v[104:119], v[140:143], v[20:23], v[104:119]
  v_exp_f32 v98, v98
  v_exp_f32 v99, v99
  v_exp_f32 v100, v100
  v_exp_f32 v101, v101
  v_mfma_f32_32x32x16_bf16 v[56:71], v[144:147], v[120:123], v[56:71]
  v_exp_f32 v102, v102
  v_exp_f32 v103, v103
  v_cvt_pk_bf16_f32 v124, v96, v97
  v_cvt_pk_bf16_f32 v125, v98, v99
  v_cvt_pk_bf16_f32 v126, v100, v101
  v_cvt_pk_bf16_f32 v127, v102, v103
  s_nop 0
  v_exp_f32 v104, v104
  v_exp_f32 v105, v105
  v_exp_f32 v106, v106
  v_exp_f32 v107, v107
  v_mfma_f32_32x32x16_bf16 v[56:71], v[148:151], v[124:127], v[56:71]
  v_exp_f32 v108, v108
  v_exp_f32 v109, v109
  v_exp_f32 v110, v110
  v_exp_f32 v111, v111
  v_cvt_pk_bf16_f32 v128, v104, v105
  v_cvt_pk_bf16_f32 v129, v106, v107
  v_cvt_pk_bf16_f32 v130, v108, v109
  v_cvt_pk_bf16_f32 v131, v110, v111
  v_exp_f32 v112, v112
  v_exp_f32 v113, v113
  v_exp_f32 v114, v114
  v_exp_f32 v115, v115
  v_exp_f32 v116, v116
  v_exp_f32 v117, v117
  v_mfma_f32_32x32x16_bf16 v[72:87], v[144:147], v[128:131], v[72:87]
  v_exp_f32 v118, v118
  v_exp_f32 v119, v119
  v_cvt_pk_bf16_f32 v132, v112, v113
  v_cvt_pk_bf16_f32 v133, v114, v115
  v_cvt_pk_bf16_f32 v134, v116, v117
  v_cvt_pk_bf16_f32 v135, v118, v119
  s_nop 1
  v_mfma_f32_32x32x16_bf16 v[72:87], v[148:151], v[132:135], v[72:87]
  v_mov_b32 v2, v64
  v_mov_b32 v4, v2
  s_nop 1
  v_permlane32_swap_b32 v4, v2
  s_nop 6
  v_mov_b32 v3, v80
  v_mov_b32 v4, v3
  s_nop 1
  v_permlane32_swap_b32 v4, v3
  s_cmp_eq_u32 s28, 1
  s_cbranch_scc1 attnb_done5
  v_max_f32 v4, v2, v3
  v_cmp_nge_f32 vcc, 0x4e800000, v4
  v_cmp_u_f32 s[30:31], v2, v3
  s_nop 3
  s_or_b64 s[32:33], vcc, s[30:31]
  s_movk_i32 s34, 0x207
  v_cmp_class_f32 vcc, v56, s34
  s_nop 3
  s_or_b64 s[32:33], s[32:33], vcc
  v_cmp_class_f32 vcc, v57, s34
  s_nop 3
  s_or_b64 s[32:33], s[32:33], vcc
  v_cmp_class_f32 vcc, v58, s34
  s_nop 3
  s_or_b64 s[32:33], s[32:33], vcc
  v_cmp_class_f32 vcc, v59, s34
  s_nop 3
  s_or_b64 s[32:33], s[32:33], vcc
  v_cmp_class_f32 vcc, v60, s34
  s_nop 3
  s_or_b64 s[32:33], s[32:33], vcc
  v_cmp_class_f32 vcc, v61, s34
  s_nop 3
  s_or_b64 s[32:33], s[32:33], vcc
  v_cmp_class_f32 vcc, v62, s34
  s_nop 3
  s_or_b64 s[32:33], s[32:33], vcc
  v_cmp_class_f32 vcc, v63, s34
  s_nop 3
  s_or_b64 s[32:33], s[32:33], vcc
  v_cmp_class_f32 vcc, v64, s34
  s_nop 3
  s_or_b64 s[32:33], s[32:33], vcc
  v_cmp_class_f32 vcc, v65, s34
  s_nop 3
  s_or_b64 s[32:33], s[32:33], vcc
  v_cmp_class_f32 vcc, v66, s34
  s_nop 3
  s_or_b64 s[32:33], s[32:33], vcc
  v_cmp_class_f32 vcc, v67, s34
  s_nop 3
  s_or_b64 s[32:33], s[32:33], vcc
  v_cmp_class_f32 vcc, v68, s34
  s_nop 3
  s_or_b64 s[32:33], s[32:33], vcc
  v_cmp_class_f32 vcc, v69, s34
  s_nop 3
  s_or_b64 s[32:33], s[32:33], vcc
  v_cmp_class_f32 vcc, v70, s34
  s_nop 3
  s_or_b64 s[32:33], s[32:33], vcc
  v_cmp_class_f32 vcc, v71, s34
  s_nop 3
  s_or_b64 s[32:33], s[32:33], vcc
  v_cmp_class_f32 vcc, v72, s34
  s_nop 3
  s_or_b64 s[32:33], s[32:33], vcc
  v_cmp_class_f32 vcc, v73, s34
  s_nop 3
  s_or_b64 s[32:33], s[32:33], vcc
  v_cmp_class_f32 vcc, v74, s34
  s_nop 3
  s_or_b64 s[32:33], s[32:33], vcc
  v_cmp_class_f32 vcc, v75, s34
  s_nop 3
  s_or_b64 s[32:33], s[32:33], vcc
  v_cmp_class_f32 vcc, v76, s34
  s_nop 3
  s_or_b64 s[32:33], s[32:33], vcc
  v_cmp_class_f32 vcc, v77, s34
  s_nop 3
  s_or_b64 s[32:33], s[32:33], vcc
  v_cmp_class_f32 vcc, v78, s34
  s_nop 3
  s_or_b64 s[32:33], s[32:33], vcc
  v_cmp_class_f32 vcc, v79, s34
  s_nop 3
  s_or_b64 s[32:33], s[32:33], vcc
  v_cmp_class_f32 vcc, v80, s34
  s_nop 3
  s_or_b64 s[32:33], s[32:33], vcc
  v_cmp_class_f32 vcc, v81, s34
  s_nop 3
  s_or_b64 s[32:33], s[32:33], vcc
  v_cmp_class_f32 vcc, v82, s34
  s_nop 3
  s_or_b64 s[32:33], s[32:33], vcc
  v_cmp_class_f32 vcc, v83, s34
  s_nop 3
  s_or_b64 s[32:33], s[32:33], vcc
  v_cmp_class_f32 vcc, v84, s34
  s_nop 3
  s_or_b64 s[32:33], s[32:33], vcc
  v_cmp_class_f32 vcc, v85, s34
  s_nop 3
  s_or_b64 s[32:33], s[32:33], vcc
  v_cmp_class_f32 vcc, v86, s34
  s_nop 3
  s_or_b64 s[32:33], s[32:33], vcc
  v_cmp_class_f32 vcc, v87, s34
  s_nop 3
  s_or_b64 s[32:33], s[32:33], vcc
  s_mov_b64 vcc, s[32:33]
  s_cbranch_vccz attnb_done5
  s_mov_b32 s25, s21
  s_mov_b32 s27, 0
  v_mov_b32 v120, 0xff800000
  v_mov_b32 v121, 0xff800000
attnb_fb4:
  buffer_load_dwordx4 v[136:139], v1, s[4:7], s25 offen
  buffer_load_dwordx4 v[140:143], v1, s[4:7], s25 offen offset:1024
  s_add_u32 s25, s25, 2048
  s_waitcnt vmcnt(0)
  v_mfma_f32_32x32x16_bf16 v[88:103], v[136:139], v[8:11], 0
  v_mfma_f32_32x32x16_bf16 v[88:103], v[140:143], v[12:15], v[88:103]
  v_mfma_f32_32x32x16_bf16 v[104:119], v[136:139], v[16:19], 0
  v_mfma_f32_32x32x16_bf16 v[104:119], v[140:143], v[20:23], v[104:119]
  s_nop 9
  v_max3_f32 v2, v88, v89, v90
  v_max3_f32 v2, v2, v91, v92
  v_max3_f32 v2, v2, v93, v94
  v_max3_f32 v2, v2, v95, v96
  v_max3_f32 v2, v2, v97, v98
  v_max3_f32 v2, v2, v99, v100
  v_max3_f32 v2, v2, v101, v102
  v_max_f32 v2, v2, v103
  v_max_f32 v120, v120, v2
  s_nop 2
  v_max3_f32 v3, v104, v105, v106
  v_max3_f32 v3, v3, v107, v108
  v_max3_f32 v3, v3, v109, v110
  v_max3_f32 v3, v3, v111, v112
  v_max3_f32 v3, v3, v113, v114
  v_max3_f32 v3, v3, v115, v116
  v_max3_f32 v3, v3, v117, v118
  v_max_f32 v3, v3, v119
  v_max_f32 v121, v121, v3
  s_add_u32 s27, s27, 1
  s_cmp_lt_u32 s27, 64
  s_cbranch_scc1 attnb_fb4
  v_mov_b32 v4, v120
  s_nop 1
  v_permlane32_swap_b32 v120, v4
  v_max_f32 v120, v120, v4
  v_sub_f32 v24, 0, v120
  v_sub_f32 v25, 0, v120
  v_sub_f32 v26, 0, v120
  v_sub_f32 v27, 0, v120
  v_sub_f32 v28, 0, v120
  v_sub_f32 v29, 0, v120
  v_sub_f32 v30, 0, v120
  v_sub_f32 v31, 0, v120
  v_sub_f32 v32, 0, v120
  v_sub_f32 v33, 0, v120
  v_sub_f32 v34, 0, v120
  v_sub_f32 v35, 0, v120
  v_sub_f32 v36, 0, v120
  v_sub_f32 v37, 0, v120
  v_sub_f32 v38, 0, v120
  v_sub_f32 v39, 0, v120
  v_mov_b32 v4, v121
  s_nop 1
  v_permlane32_swap_b32 v121, v4
  v_max_f32 v121, v121, v4
  v_sub_f32 v40, 0, v121
  v_sub_f32 v41, 0, v121
  v_sub_f32 v42, 0, v121
  v_sub_f32 v43, 0, v121
  v_sub_f32 v44, 0, v121
  v_sub_f32 v45, 0, v121
  v_sub_f32 v46, 0, v121
  v_sub_f32 v47, 0, v121
  v_sub_f32 v48, 0, v121
  v_sub_f32 v49, 0, v121
  v_sub_f32 v50, 0, v121
  v_sub_f32 v51, 0, v121
  v_sub_f32 v52, 0, v121
  v_sub_f32 v53, 0, v121
  v_sub_f32 v54, 0, v121
  v_sub_f32 v55, 0, v121
  s_mov_b32 s28, 1
  s_branch attnb_main2
attnb_done5:
  v_and_b32 v139, 63, v0
  v_lshrrev_b32 v140, 5, v139
  v_and_b32 v142, 15, v139
  v_lshlrev_b32 v142, 4, v142
  v_bfe_u32 v141, v139, 4, 1
  v_mul_u32_u24 v141, 20480, v141
  v_add_u32 v142, v142, v141
  s_mul_i32 s25, s17, 20
  v_lshlrev_b32 v140, 2, v140
  v_add_u32 v141, s25, v140
  v_add_u32 v141, 0, v141
  v_lshrrev_b32 v136, 5, v141
  v_lshlrev_b32 v136, 10, v136
  v_bfe_u32 v139, v141, 3, 2
  v_lshl_add_u32 v136, v139, 8, v136
  v_bfe_u32 v139, v141, 2, 1
  v_lshl_add_u32 v136, v139, 3, v136
  v_add_u32 v136, v136, v142
  v_add_u32 v141, s25, v140
  v_add_u32 v141, 8, v141
  v_lshrrev_b32 v137, 5, v141
  v_lshlrev_b32 v137, 10, v137
  v_bfe_u32 v139, v141, 3, 2
  v_lshl_add_u32 v137, v139, 8, v137
  v_bfe_u32 v139, v141, 2, 1
  v_lshl_add_u32 v137, v139, 3, v137
  v_add_u32 v137, v137, v142
  v_add_u32 v141, s25, v140
  v_add_u32 v141, 16, v141
  v_lshrrev_b32 v138, 5, v141
  v_lshlrev_b32 v138, 10, v138
  v_bfe_u32 v139, v141, 3, 2
  v_lshl_add_u32 v138, v139, 8, v138
  v_bfe_u32 v139, v141, 2, 1
  v_lshl_add_u32 v138, v139, 3, v138
  v_add_u32 v138, v138, v142
  v_cmp_eq_u32 vcc, 0, v140
  v_mov_b32 v139, 0x80000000
  s_nop 0
  v_cndmask_b32 v138, v139, v138, vcc
  s_mul_i32 s24, s23, 40960
  s_add_u32 s24, s24, 50331648
  v_rcp_f32 v4, v2
  s_nop 0
  v_mul_f32 v56, v56, v4
  v_mul_f32 v57, v57, v4
  v_mul_f32 v58, v58, v4
  v_mul_f32 v59, v59, v4
  v_mul_f32 v60, v60, v4
  v_mul_f32 v61, v61, v4
  v_mul_f32 v62, v62, v4
  v_mul_f32 v63, v63, v4
  v_mul_f32 v64, v64, v4
  v_mul_f32 v65, v65, v4
  v_mul_f32 v66, v66, v4
  v_mul_f32 v67, v67, v4
  v_cvt_pk_bf16_f32 v120, v56, v57
  v_cvt_pk_bf16_f32 v121, v58, v59
  v_cvt_pk_bf16_f32 v122, v60, v61
  v_cvt_pk_bf16_f32 v123, v62, v63
  v_cvt_pk_bf16_f32 v124, v64, v65
  v_cvt_pk_bf16_f32 v125, v66, v67
  buffer_store_dwordx2 v[120:121], v136, s[4:7], s24 offen sc1
  buffer_store_dwordx2 v[122:123], v137, s[4:7], s24 offen sc1
  buffer_store_dwordx2 v[124:125], v138, s[4:7], s24 offen sc1
  v_rcp_f32 v4, v3
  s_nop 0
  v_mul_f32 v72, v72, v4
  v_mul_f32 v73, v73, v4
  v_mul_f32 v74, v74, v4
  v_mul_f32 v75, v75, v4
  v_mul_f32 v76, v76, v4
  v_mul_f32 v77, v77, v4
  v_mul_f32 v78, v78, v4
  v_mul_f32 v79, v79, v4
  v_mul_f32 v80, v80, v4
  v_mul_f32 v81, v81, v4
  v_mul_f32 v82, v82, v4
  v_mul_f32 v83, v83, v4
  v_cvt_pk_bf16_f32 v128, v72, v73
  v_cvt_pk_bf16_f32 v129, v74, v75
  v_cvt_pk_bf16_f32 v130, v76, v77
  v_cvt_pk_bf16_f32 v131, v78, v79
  v_cvt_pk_bf16_f32 v132, v80, v81
  v_cvt_pk_bf16_f32 v133, v82, v83
  s_add_u32 s24, s24, 40960
  buffer_store_dwordx2 v[128:129], v136, s[4:7], s24 offen sc1
  buffer_store_dwordx2 v[130:131], v137, s[4:7], s24 offen sc1
  buffer_store_dwordx2 v[132:133], v138, s[4:7], s24 offen sc1
attnb_exit1:
  s_endpgm
.globl outb1_kernel
.p2align 8
.type outb1_kernel,@function
outb1_kernel:
  s_cmp_ge_u32 s2, 256
  s_cbranch_scc1 outb1_exit1
  s_load_dwordx2 s[12:13], s[0:1], 96
  s_load_dwordx2 s[14:15], s[0:1], 0
  s_load_dwordx2 s[48:49], s[0:1], 80
  v_lshrrev_b32 v3, 6, v0
  v_and_b32 v4, 63, v0
  s_nop 0
  v_readfirstlane_b32 s16, v3
  v_lshlrev_b32 v1, 4, v4
  s_and_b32 s17, s2, 7
  s_lshl_b32 s17, s17, 2
  s_lshr_b32 s18, s2, 3
  s_and_b32 s19, s18, 3
  s_add_u32 s17, s17, s19
  s_lshr_b32 s18, s18, 2
  s_waitcnt lgkmcnt(0)
  s_mov_b32 s4, s12
  s_mov_b32 s5, s13
  s_mov_b32 s6, 0x10000000
  s_mov_b32 s7, 0x20000
  s_mov_b32 s8, s12
  s_mov_b32 s9, s13
  s_mov_b32 s10, 0x10000000
  s_mov_b32 s11, 0x20000
  s_mov_b32 s20, 82313216
  s_mov_b32 s52, s48
  s_mov_b32 s53, s49
  s_mov_b32 s54, 2621440
  s_mov_b32 s55, 0x20000
  s_mul_i32 s21, s18, 5
  s_mul_i32 s21, s21, 20480
  s_add_u32 s24, s21, 90013696
  s_add_u32 s25, s24, 20480
  s_add_u32 s26, s25, 20480
  s_add_u32 s27, s26, 20480
  s_add_u32 s28, s27, 20480
  s_lshl_b32 s21, s17, 2
  s_add_u32 s21, s21, s16
  s_mul_i32 s22, s21, 20480
  s_add_u32 s22, s22, 50331648
  s_lshl_b32 s23, s16, 10
  v_add_u32 v2, s23, v1
  s_mul_i32 s29, s16, 5120
  s_add_u32 m0, s29, 0
  s_nop 0
  buffer_load_dwordx4 v2, s[4:7], s24 offen lds
  s_add_u32 m0, s29, 1024
  s_nop 0
  buffer_load_dwordx4 v2, s[4:7], s25 offen lds
  s_add_u32 m0, s29, 2048
  s_nop 0
  buffer_load_dwordx4 v2, s[4:7], s26 offen lds
  s_add_u32 m0, s29, 3072
  s_nop 0
  buffer_load_dwordx4 v2, s[4:7], s27 offen lds
  s_add_u32 m0, s29, 4096
  s_nop 0
  buffer_load_dwordx4 v2, s[4:7], s28 offen lds
  buffer_load_dwordx4 v[32:35], v1, s[4:7], s22 offen offset:0
  buffer_load_dwordx4 v[36:39], v1, s[4:7], s22 offen offset:1024
  buffer_load_dwordx4 v[40:43], v1, s[4:7], s22 offen offset:2048
  buffer_load_dwordx4 v[44:47], v1, s[4:7], s22 offen offset:3072
  v_add_u32 v2, 0x1000, v2
  s_add_u32 s22, s22, 4096
  s_add_u32 m0, s29, 20480
  s_nop 0
  buffer_load_dwordx4 v2, s[4:7], s24 offen lds
  s_add_u32 m0, s29, 21504
  s_nop 0
  buffer_load_dwordx4 v2, s[4:7], s25 offen lds
  s_add_u32 m0, s29, 22528
  s_nop 0
  buffer_load_dwordx4 v2, s[4:7], s26 offen lds
  s_add_u32 m0, s29, 23552
  s_nop 0
  buffer_load_dwordx4 v2, s[4:7], s27 offen lds
  s_add_u32 m0, s29, 24576
  s_nop 0
  buffer_load_dwordx4 v2, s[4:7], s28 offen lds
  buffer_load_dwordx4 v[48:51], v1, s[4:7], s22 offen offset:0
  buffer_load_dwordx4 v[52:55], v1, s[4:7], s22 offen offset:1024
  buffer_load_dwordx4 v[56:59], v1, s[4:7], s22 offen offset:2048
  buffer_load_dwordx4 v[60:63], v1, s[4:7], s22 offen offset:3072
  v_add_u32 v2, 0x1000, v2
  s_add_u32 s22, s22, 4096
  s_waitcnt vmcnt(9)
  s_barrier
  s_add_u32 m0, s29, 40960
  s_nop 0
  buffer_load_dwordx4 v2, s[4:7], s24 offen lds
  s_add_u32 m0, s29, 41984
  s_nop 0
  buffer_load_dwordx4 v2, s[4:7], s25 offen lds
  s_add_u32 m0, s29, 43008
  s_nop 0
  buffer_load_dwordx4 v2, s[4:7], s26 offen lds
  s_add_u32 m0, s29, 44032
  s_nop 0
  buffer_load_dwordx4 v2, s[4:7], s27 offen lds
  s_add_u32 m0, s29, 45056
  s_nop 0
  buffer_load_dwordx4 v2, s[4:7], s28 offen lds
  buffer_load_dwordx4 v[64:67], v1, s[4:7], s22 offen offset:0
  buffer_load_dwordx4 v[68:71], v1, s[4:7], s22 offen offset:1024
  buffer_load_dwordx4 v[72:75], v1, s[4:7], s22 offen offset:2048
  buffer_load_dwordx4 v[76:79], v1, s[4:7], s22 offen offset:3072
  v_add_u32 v2, 0x1000, v2
  s_add_u32 s22, s22, 4096
  ds_read_b128 v[80:83], v1 offset:0
  ds_read_b128 v[84:87], v1 offset:1024
  ds_read_b128 v[88:91], v1 offset:2048
  ds_read_b128 v[92:95], v1 offset:3072
  ds_read_b128 v[96:99], v1 offset:4096
  ds_read_b128 v[100:103], v1 offset:5120
  ds_read_b128 v[104:107], v1 offset:6144
  ds_read_b128 v[108:111], v1 offset:7168
  ds_read_b128 v[112:115], v1 offset:8192
  ds_read_b128 v[116:119], v1 offset:9216
  s_waitcnt lgkmcnt(5)
  v_mfma_f32_16x16x32_bf16 v[8:11], v[80:83], v[32:35], 0
  v_mfma_f32_16x16x32_bf16 v[12:15], v[84:87], v[32:35], 0
  v_mfma_f32_16x16x32_bf16 v[16:19], v[88:91], v[32:35], 0
  v_mfma_f32_16x16x32_bf16 v[20:23], v[92:95], v[32:35], 0
  v_mfma_f32_16x16x32_bf16 v[24:27], v[96:99], v[32:35], 0
  ds_read_b128 v[80:83], v1 offset:10240
  ds_read_b128 v[84:87], v1 offset:11264
  ds_read_b128 v[88:91], v1 offset:12288
  ds_read_b128 v[92:95], v1 offset:13312
  ds_read_b128 v[96:99], v1 offset:14336
  s_waitcnt lgkmcnt(5)
  v_mfma_f32_16x16x32_bf16 v[8:11], v[100:103], v[36:39], v[8:11]
  v_mfma_f32_16x16x32_bf16 v[12:15], v[104:107], v[36:39], v[12:15]
  v_mfma_f32_16x16x32_bf16 v[16:19], v[108:111], v[36:39], v[16:19]
  v_mfma_f32_16x16x32_bf16 v[20:23], v[112:115], v[36:39], v[20:23]
  v_mfma_f32_16x16x32_bf16 v[24:27], v[116:119], v[36:39], v[24:27]
  ds_read_b128 v[100:103], v1 offset:15360
  ds_read_b128 v[104:107], v1 offset:16384
  ds_read_b128 v[108:111], v1 offset:17408
  ds_read_b128 v[112:115], v1 offset:18432
  ds_read_b128 v[116:119], v1 offset:19456
  s_waitcnt lgkmcnt(5)
  v_mfma_f32_16x16x32_bf16 v[8:11], v[80:83], v[40:43], v[8:11]
  v_mfma_f32_16x16x32_bf16 v[12:15], v[84:87], v[40:43], v[12:15]
  v_mfma_f32_16x16x32_bf16 v[16:19], v[88:91], v[40:43], v[16:19]
  v_mfma_f32_16x16x32_bf16 v[20:23], v[92:95], v[40:43], v[20:23]
  v_mfma_f32_16x16x32_bf16 v[24:27], v[96:99], v[40:43], v[24:27]
  s_waitcnt lgkmcnt(0)
  v_mfma_f32_16x16x32_bf16 v[8:11], v[100:103], v[44:47], v[8:11]
  v_mfma_f32_16x16x32_bf16 v[12:15], v[104:107], v[44:47], v[12:15]
  v_mfma_f32_16x16x32_bf16 v[16:19], v[108:111], v[44:47], v[16:19]
  v_mfma_f32_16x16x32_bf16 v[20:23], v[112:115], v[44:47], v[20:23]
  v_mfma_f32_16x16x32_bf16 v[24:27], v[116:119], v[44:47], v[24:27]
  s_waitcnt vmcnt(9)
  s_barrier
  s_add_u32 m0, s29, 0
  s_nop 0
  buffer_load_dwordx4 v2, s[4:7], s24 offen lds
  s_add_u32 m0, s29, 1024
  s_nop 0
  buffer_load_dwordx4 v2, s[4:7], s25 offen lds
  s_add_u32 m0, s29, 2048
  s_nop 0
  buffer_load_dwordx4 v2, s[4:7], s26 offen lds
  s_add_u32 m0, s29, 3072
  s_nop 0
  buffer_load_dwordx4 v2, s[4:7], s27 offen lds
  s_add_u32 m0, s29, 4096
  s_nop 0
  buffer_load_dwordx4 v2, s[4:7], s28 offen lds
  buffer_load_dwordx4 v[32:35], v1, s[4:7], s22 offen offset:0
  buffer_load_dwordx4 v[36:39], v1, s[4:7], s22 offen offset:1024
  buffer_load_dwordx4 v[40:43], v1, s[4:7], s22 offen offset:2048
  buffer_load_dwordx4 v[44:47], v1, s[4:7], s22 offen offset:3072
  v_add_u32 v2, 0x1000, v2
  s_add_u32 s22, s22, 4096
  ds_read_b128 v[80:83], v1 offset:20480
  ds_read_b128 v[84:87], v1 offset:21504
  ds_read_b128 v[88:91], v1 offset:22528
  ds_read_b128 v[92:95], v1 offset:23552
  ds_read_b128 v[96:99], v1 offset:24576
  ds_read_b128 v[100:103], v1 offset:25600
  ds_read_b128 v[104:107], v1 offset:26624
  ds_read_b128 v[108:111], v1 offset:27648
  ds_read_b128 v[112:115], v1 offset:28672
  ds_read_b128 v[116:119], v1 offset:29696
  s_waitcnt lgkmcnt(5)
  v_mfma_f32_16x16x32_bf16 v[8:11], v[80:83], v[48:51], v[8:11]
  v_mfma_f32_16x16x32_bf16 v[12:15], v[84:87], v[48:51], v[12:15]
  v_mfma_f32_16x16x32_bf16 v[16:19], v[88:91], v[48:51], v[16:19]
  v_mfma_f32_16x16x32_bf16 v[20:23], v[92:95], v[48:51], v[20:23]
  v_mfma_f32_16x16x32_bf16 v[24:27], v[96:99], v[48:51], v[24:27]
  ds_read_b128 v[80:83], v1 offset:30720
  ds_read_b128 v[84:87], v1 offset:31744
  ds_read_b128 v[88:91], v1 offset:32768
  ds_read_b128 v[92:95], v1 offset:33792
  ds_read_b128 v[96:99], v1 offset:34816
  s_waitcnt lgkmcnt(5)
  v_mfma_f32_16x16x32_bf16 v[8:11], v[100:103], v[52:55], v[8:11]
  v_mfma_f32_16x16x32_bf16 v[12:15], v[104:107], v[52:55], v[12:15]
  v_mfma_f32_16x16x32_bf16 v[16:19], v[108:111], v[52:55], v[16:19]
  v_mfma_f32_16x16x32_bf16 v[20:23], v[112:115], v[52:55], v[20:23]
  v_mfma_f32_16x16x32_bf16 v[24:27], v[116:119], v[52:55], v[24:27]
  ds_read_b128 v[100:103], v1 offset:35840
  ds_read_b128 v[104:107], v1 offset:36864
  ds_read_b128 v[108:111], v1 offset:37888
  ds_read_b128 v[112:115], v1 offset:38912
  ds_read_b128 v[116:119], v1 offset:39936
  s_waitcnt lgkmcnt(5)
  v_mfma_f32_16x16x32_bf16 v[8:11], v[80:83], v[56:59], v[8:11]
  v_mfma_f32_16x16x32_bf16 v[12:15], v[84:87], v[56:59], v[12:15]
  v_mfma_f32_16x16x32_bf16 v[16:19], v[88:91], v[56:59], v[16:19]
  v_mfma_f32_16x16x32_bf16 v[20:23], v[92:95], v[56:59], v[20:23]
  v_mfma_f32_16x16x32_bf16 v[24:27], v[96:99], v[56:59], v[24:27]
  s_waitcnt lgkmcnt(0)
  v_mfma_f32_16x16x32_bf16 v[8:11], v[100:103], v[60:63], v[8:11]
  v_mfma_f32_16x16x32_bf16 v[12:15], v[104:107], v[60:63], v[12:15]
  v_mfma_f32_16x16x32_bf16 v[16:19], v[108:111], v[60:63], v[16:19]
  v_mfma_f32_16x16x32_bf16 v[20:23], v[112:115], v[60:63], v[20:23]
  v_mfma_f32_16x16x32_bf16 v[24:27], v[116:119], v[60:63], v[24:27]
  s_waitcnt vmcnt(9)
  s_barrier
  s_add_u32 m0, s29, 20480
  s_nop 0
  buffer_load_dwordx4 v2, s[4:7], s24 offen lds
  s_add_u32 m0, s29, 21504
  s_nop 0
  buffer_load_dwordx4 v2, s[4:7], s25 offen lds
  s_add_u32 m0, s29, 22528
  s_nop 0
  buffer_load_dwordx4 v2, s[4:7], s26 offen lds
  s_add_u32 m0, s29, 23552
  s_nop 0
  buffer_load_dwordx4 v2, s[4:7], s27 offen lds
  s_add_u32 m0, s29, 24576
  s_nop 0
  buffer_load_dwordx4 v2, s[4:7], s28 offen lds
  buffer_load_dwordx4 v[48:51], v1, s[4:7], s22 offen offset:0
  buffer_load_dwordx4 v[52:55], v1, s[4:7], s22 offen offset:1024
  buffer_load_dwordx4 v[56:59], v1, s[4:7], s22 offen offset:2048
  buffer_load_dwordx4 v[60:63], v1, s[4:7], s22 offen offset:3072
  v_add_u32 v2, 0x1000, v2
  s_add_u32 s22, s22, 4096
  ds_read_b128 v[80:83], v1 offset:40960
  ds_read_b128 v[84:87], v1 offset:41984
  ds_read_b128 v[88:91], v1 offset:43008
  ds_read_b128 v[92:95], v1 offset:44032
  ds_read_b128 v[96:99], v1 offset:45056
  ds_read_b128 v[100:103], v1 offset:46080
  ds_read_b128 v[104:107], v1 offset:47104
  ds_read_b128 v[108:111], v1 offset:48128
  ds_read_b128 v[112:115], v1 offset:49152
  ds_read_b128 v[116:119], v1 offset:50176
  s_waitcnt lgkmcnt(5)
  v_mfma_f32_16x16x32_bf16 v[8:11], v[80:83], v[64:67], v[8:11]
  v_mfma_f32_16x16x32_bf16 v[12:15], v[84:87], v[64:67], v[12:15]
  v_mfma_f32_16x16x32_bf16 v[16:19], v[88:91], v[64:67], v[16:19]
  v_mfma_f32_16x16x32_bf16 v[20:23], v[92:95], v[64:67], v[20:23]
  v_mfma_f32_16x16x32_bf16 v[24:27], v[96:99], v[64:67], v[24:27]
  ds_read_b128 v[80:83], v1 offset:51200
  ds_read_b128 v[84:87], v1 offset:52224
  ds_read_b128 v[88:91], v1 offset:53248
  ds_read_b128 v[92:95], v1 offset:54272
  ds_read_b128 v[96:99], v1 offset:55296
  s_waitcnt lgkmcnt(5)
  v_mfma_f32_16x16x32_bf16 v[8:11], v[100:103], v[68:71], v[8:11]
  v_mfma_f32_16x16x32_bf16 v[12:15], v[104:107], v[68:71], v[12:15]
  v_mfma_f32_16x16x32_bf16 v[16:19], v[108:111], v[68:71], v[16:19]
  v_mfma_f32_16x16x32_bf16 v[20:23], v[112:115], v[68:71], v[20:23]
  v_mfma_f32_16x16x32_bf16 v[24:27], v[116:119], v[68:71], v[24:27]
  ds_read_b128 v[100:103], v1 offset:56320
  ds_read_b128 v[104:107], v1 offset:57344
  ds_read_b128 v[108:111], v1 offset:58368
  ds_read_b128 v[112:115], v1 offset:59392
  ds_read_b128 v[116:119], v1 offset:60416
  s_waitcnt lgkmcnt(5)
  v_mfma_f32_16x16x32_bf16 v[8:11], v[80:83], v[72:75], v[8:11]
  v_mfma_f32_16x16x32_bf16 v[12:15], v[84:87], v[72:75], v[12:15]
  v_mfma_f32_16x16x32_bf16 v[16:19], v[88:91], v[72:75], v[16:19]
  v_mfma_f32_16x16x32_bf16 v[20:23], v[92:95], v[72:75], v[20:23]
  v_mfma_f32_16x16x32_bf16 v[24:27], v[96:99], v[72:75], v[24:27]
  s_waitcnt lgkmcnt(0)
  v_mfma_f32_16x16x32_bf16 v[8:11], v[100:103], v[76:79], v[8:11]
  v_mfma_f32_16x16x32_bf16 v[12:15], v[104:107], v[76:79], v[12:15]
  v_mfma_f32_16x16x32_bf16 v[16:19], v[108:111], v[76:79], v[16:19]
  v_mfma_f32_16x16x32_bf16 v[20:23], v[112:115], v[76:79], v[20:23]
  v_mfma_f32_16x16x32_bf16 v[24:27], v[116:119], v[76:79], v[24:27]
  s_waitcnt vmcnt(9)
  s_barrier
  ds_read_b128 v[80:83], v1 offset:0
  ds_read_b128 v[84:87], v1 offset:1024
  ds_read_b128 v[88:91], v1 offset:2048
  ds_read_b128 v[92:95], v1 offset:3072
  ds_read_b128 v[96:99], v1 offset:4096
  ds_read_b128 v[100:103], v1 offset:5120
  ds_read_b128 v[104:107], v1 offset:6144
  ds_read_b128 v[108:111], v1 offset:7168
  ds_read_b128 v[112:115], v1 offset:8192
  ds_read_b128 v[116:119], v1 offset:9216
  s_waitcnt lgkmcnt(5)
  v_mfma_f32_16x16x32_bf16 v[8:11], v[80:83], v[32:35], v[8:11]
  v_mfma_f32_16x16x32_bf16 v[12:15], v[84:87], v[32:35], v[12:15]
  v_mfma_f32_16x16x32_bf16 v[16:19], v[88:91], v[32:35], v[16:19]
  v_mfma_f32_16x16x32_bf16 v[20:23], v[92:95], v[32:35], v[20:23]
  v_mfma_f32_16x16x32_bf16 v[24:27], v[96:99], v[32:35], v[24:27]
  ds_read_b128 v[80:83], v1 offset:10240
  ds_read_b128 v[84:87], v1 offset:11264
  ds_read_b128 v[88:91], v1 offset:12288
  ds_read_b128 v[92:95], v1 offset:13312
  ds_read_b128 v[96:99], v1 offset:14336
  s_waitcnt lgkmcnt(5)
  v_mfma_f32_16x16x32_bf16 v[8:11], v[100:103], v[36:39], v[8:11]
  v_mfma_f32_16x16x32_bf16 v[12:15], v[104:107], v[36:39], v[12:15]
  v_mfma_f32_16x16x32_bf16 v[16:19], v[108:111], v[36:39], v[16:19]
  v_mfma_f32_16x16x32_bf16 v[20:23], v[112:115], v[36:39], v[20:23]
  v_mfma_f32_16x16x32_bf16 v[24:27], v[116:119], v[36:39], v[24:27]
  ds_read_b128 v[100:103], v1 offset:15360
  ds_read_b128 v[104:107], v1 offset:16384
  ds_read_b128 v[108:111], v1 offset:17408
  ds_read_b128 v[112:115], v1 offset:18432
  ds_read_b128 v[116:119], v1 offset:19456
  s_waitcnt lgkmcnt(5)
  v_mfma_f32_16x16x32_bf16 v[8:11], v[80:83], v[40:43], v[8:11]
  v_mfma_f32_16x16x32_bf16 v[12:15], v[84:87], v[40:43], v[12:15]
  v_mfma_f32_16x16x32_bf16 v[16:19], v[88:91], v[40:43], v[16:19]
  v_mfma_f32_16x16x32_bf16 v[20:23], v[92:95], v[40:43], v[20:23]
  v_mfma_f32_16x16x32_bf16 v[24:27], v[96:99], v[40:43], v[24:27]
  s_waitcnt lgkmcnt(0)
  v_mfma_f32_16x16x32_bf16 v[8:11], v[100:103], v[44:47], v[8:11]
  v_mfma_f32_16x16x32_bf16 v[12:15], v[104:107], v[44:47], v[12:15]
  v_mfma_f32_16x16x32_bf16 v[16:19], v[108:111], v[44:47], v[16:19]
  v_mfma_f32_16x16x32_bf16 v[20:23], v[112:115], v[44:47], v[20:23]
  v_mfma_f32_16x16x32_bf16 v[24:27], v[116:119], v[44:47], v[24:27]
  s_waitcnt vmcnt(0)
  s_barrier
  ds_read_b128 v[80:83], v1 offset:20480
  ds_read_b128 v[84:87], v1 offset:21504
  ds_read_b128 v[88:91], v1 offset:22528
  ds_read_b128 v[92:95], v1 offset:23552
  ds_read_b128 v[96:99], v1 offset:24576
  ds_read_b128 v[100:103], v1 offset:25600
  ds_read_b128 v[104:107], v1 offset:26624
  ds_read_b128 v[108:111], v1 offset:27648
  ds_read_b128 v[112:115], v1 offset:28672
  ds_read_b128 v[116:119], v1 offset:29696
  s_waitcnt lgkmcnt(5)
  v_mfma_f32_16x16x32_bf16 v[8:11], v[80:83], v[48:51], v[8:11]
  v_mfma_f32_16x16x32_bf16 v[12:15], v[84:87], v[48:51], v[12:15]
  v_mfma_f32_16x16x32_bf16 v[16:19], v[88:91], v[48:51], v[16:19]
  v_mfma_f32_16x16x32_bf16 v[20:23], v[92:95], v[48:51], v[20:23]
  v_mfma_f32_16x16x32_bf16 v[24:27], v[96:99], v[48:51], v[24:27]
  ds_read_b128 v[80:83], v1 offset:30720
  ds_read_b128 v[84:87], v1 offset:31744
  ds_read_b128 v[88:91], v1 offset:32768
  ds_read_b128 v[92:95], v1 offset:33792
  ds_read_b128 v[96:99], v1 offset:34816
  s_waitcnt lgkmcnt(5)
  v_mfma_f32_16x16x32_bf16 v[8:11], v[100:103], v[52:55], v[8:11]
  v_mfma_f32_16x16x32_bf16 v[12:15], v[104:107], v[52:55], v[12:15]
  v_mfma_f32_16x16x32_bf16 v[16:19], v[108:111], v[52:55], v[16:19]
  v_mfma_f32_16x16x32_bf16 v[20:23], v[112:115], v[52:55], v[20:23]
  v_mfma_f32_16x16x32_bf16 v[24:27], v[116:119], v[52:55], v[24:27]
  ds_read_b128 v[100:103], v1 offset:35840
  ds_read_b128 v[104:107], v1 offset:36864
  ds_read_b128 v[108:111], v1 offset:37888
  ds_read_b128 v[112:115], v1 offset:38912
  ds_read_b128 v[116:119], v1 offset:39936
  s_waitcnt lgkmcnt(5)
  v_mfma_f32_16x16x32_bf16 v[8:11], v[80:83], v[56:59], v[8:11]
  v_mfma_f32_16x16x32_bf16 v[12:15], v[84:87], v[56:59], v[12:15]
  v_mfma_f32_16x16x32_bf16 v[16:19], v[88:91], v[56:59], v[16:19]
  v_mfma_f32_16x16x32_bf16 v[20:23], v[92:95], v[56:59], v[20:23]
  v_mfma_f32_16x16x32_bf16 v[24:27], v[96:99], v[56:59], v[24:27]
  s_waitcnt lgkmcnt(0)
  v_mfma_f32_16x16x32_bf16 v[8:11], v[100:103], v[60:63], v[8:11]
  v_mfma_f32_16x16x32_bf16 v[12:15], v[104:107], v[60:63], v[12:15]
  v_mfma_f32_16x16x32_bf16 v[16:19], v[108:111], v[60:63], v[16:19]
  v_mfma_f32_16x16x32_bf16 v[20:23], v[112:115], v[60:63], v[20:23]
  v_mfma_f32_16x16x32_bf16 v[24:27], v[116:119], v[60:63], v[24:27]
  v_and_b32 v3, 63, v0
  v_and_b32 v4, 15, v3
  v_lshrrev_b32 v3, 4, v3
  s_lshl_b32 s21, s17, 6
  s_lshl_b32 s23, s16, 4
  s_add_u32 s21, s21, s23
  v_add_u32 v4, s21, v4
  v_mul_u32_u24 v6, 1280, v4
  v_lshl_add_u32 v6, v3, 4, v6
  s_mul_i32 s21, s18, 5
  s_add_u32 s23, s21, 0
  s_lshr_b32 s31, s23, 1
  s_lshl_b32 s31, s31, 6
  s_and_b32 s23, s23, 1
  s_lshl_b32 s23, s23, 3
  s_add_u32 s32, s31, s23
  s_add_u32 s40, s32, s20
  buffer_load_dwordx2 v[32:33], v6, s[8:11], s40 offen
  s_add_u32 s23, s21, 1
  s_lshr_b32 s31, s23, 1
  s_lshl_b32 s31, s31, 6
  s_and_b32 s23, s23, 1
  s_lshl_b32 s23, s23, 3
  s_add_u32 s33, s31, s23
  s_add_u32 s41, s33, s20
  buffer_load_dwordx2 v[34:35], v6, s[8:11], s41 offen
  s_add_u32 s23, s21, 2
  s_lshr_b32 s31, s23, 1
  s_lshl_b32 s31, s31, 6
  s_and_b32 s23, s23, 1
  s_lshl_b32 s23, s23, 3
  s_add_u32 s34, s31, s23
  s_add_u32 s42, s34, s20
  buffer_load_dwordx2 v[36:37], v6, s[8:11], s42 offen
  s_add_u32 s23, s21, 3
  s_lshr_b32 s31, s23, 1
  s_lshl_b32 s31, s31, 6
  s_and_b32 s23, s23, 1
  s_lshl_b32 s23, s23, 3
  s_add_u32 s35, s31, s23
  s_add_u32 s43, s35, s20
  buffer_load_dwordx2 v[38:39], v6, s[8:11], s43 offen
  s_add_u32 s23, s21, 4
  s_lshr_b32 s31, s23, 1
  s_lshl_b32 s31, s31, 6
  s_and_b32 s23, s23, 1
  s_lshl_b32 s23, s23, 3
  s_add_u32 s36, s31, s23
  s_add_u32 s44, s36, s20
  buffer_load_dwordx2 v[40:41], v6, s[8:11], s44 offen
  s_waitcnt vmcnt(0)
  v_cvt_pk_bf16_f32 v80, v8, v9
  v_cvt_pk_bf16_f32 v81, v10, v11
  v_lshlrev_b32 v8, 16, v80
  v_and_b32 v9, 0xffff0000, v80
  v_lshlrev_b32 v10, 16, v81
  v_and_b32 v11, 0xffff0000, v81
  v_lshlrev_b32 v82, 16, v32
  v_and_b32 v83, 0xffff0000, v32
  v_lshlrev_b32 v84, 16, v33
  v_and_b32 v85, 0xffff0000, v33
  v_add_f32 v8, v8, v82
  v_add_f32 v9, v9, v83
  v_add_f32 v10, v10, v84
  v_add_f32 v11, v11, v85
  v_cvt_pk_bf16_f32 v32, v8, v9
  v_cvt_pk_bf16_f32 v33, v10, v11
  s_add_u32 s23, s32, 82313216
  buffer_store_dwordx2 v[32:33], v6, s[4:7], s23 offen sc1
  v_cvt_pk_bf16_f32 v80, v12, v13
  v_cvt_pk_bf16_f32 v81, v14, v15
  v_lshlrev_b32 v12, 16, v80
  v_and_b32 v13, 0xffff0000, v80
  v_lshlrev_b32 v14, 16, v81
  v_and_b32 v15, 0xffff0000, v81
  v_lshlrev_b32 v82, 16, v34
  v_and_b32 v83, 0xffff0000, v34
  v_lshlrev_b32 v84, 16, v35
  v_and_b32 v85, 0xffff0000, v35
  v_add_f32 v12, v12, v82
  v_add_f32 v13, v13, v83
  v_add_f32 v14, v14, v84
  v_add_f32 v15, v15, v85
  v_cvt_pk_bf16_f32 v34, v12, v13
  v_cvt_pk_bf16_f32 v35, v14, v15
  s_add_u32 s23, s33, 82313216
  buffer_store_dwordx2 v[34:35], v6, s[4:7], s23 offen sc1
  v_cvt_pk_bf16_f32 v80, v16, v17
  v_cvt_pk_bf16_f32 v81, v18, v19
  v_lshlrev_b32 v16, 16, v80
  v_and_b32 v17, 0xffff0000, v80
  v_lshlrev_b32 v18, 16, v81
  v_and_b32 v19, 0xffff0000, v81
  v_lshlrev_b32 v82, 16, v36
  v_and_b32 v83, 0xffff0000, v36
  v_lshlrev_b32 v84, 16, v37
  v_and_b32 v85, 0xffff0000, v37
  v_add_f32 v16, v16, v82
  v_add_f32 v17, v17, v83
  v_add_f32 v18, v18, v84
  v_add_f32 v19, v19, v85
  v_cvt_pk_bf16_f32 v36, v16, v17
  v_cvt_pk_bf16_f32 v37, v18, v19
  s_add_u32 s23, s34, 82313216
  buffer_store_dwordx2 v[36:37], v6, s[4:7], s23 offen sc1
  v_cvt_pk_bf16_f32 v80, v20, v21
  v_cvt_pk_bf16_f32 v81, v22, v23
  v_lshlrev_b32 v20, 16, v80
  v_and_b32 v21, 0xffff0000, v80
  v_lshlrev_b32 v22, 16, v81
  v_and_b32 v23, 0xffff0000, v81
  v_lshlrev_b32 v82, 16, v38
  v_and_b32 v83, 0xffff0000, v38
  v_lshlrev_b32 v84, 16, v39
  v_and_b32 v85, 0xffff0000, v39
  v_add_f32 v20, v20, v82
  v_add_f32 v21, v21, v83
  v_add_f32 v22, v22, v84
  v_add_f32 v23, v23, v85
  v_cvt_pk_bf16_f32 v38, v20, v21
  v_cvt_pk_bf16_f32 v39, v22, v23
  s_add_u32 s23, s35, 82313216
  buffer_store_dwordx2 v[38:39], v6, s[4:7], s23 offen sc1
  v_cvt_pk_bf16_f32 v80, v24, v25
  v_cvt_pk_bf16_f32 v81, v26, v27
  v_lshlrev_b32 v24, 16, v80
  v_and_b32 v25, 0xffff0000, v80
  v_lshlrev_b32 v26, 16, v81
  v_and_b32 v27, 0xffff0000, v81
  v_lshlrev_b32 v82, 16, v40
  v_and_b32 v83, 0xffff0000, v40
  v_lshlrev_b32 v84, 16, v41
  v_and_b32 v85, 0xffff0000, v41
  v_add_f32 v24, v24, v82
  v_add_f32 v25, v25, v83
  v_add_f32 v26, v26, v84
  v_add_f32 v27, v27, v85
  v_cvt_pk_bf16_f32 v40, v24, v25
  v_cvt_pk_bf16_f32 v41, v26, v27
  s_add_u32 s23, s36, 82313216
  buffer_store_dwordx2 v[40:41], v6, s[4:7], s23 offen sc1
outb1_exit1:
  s_endpgm
.globl outb2_kernel
.p2align 8
.type outb2_kernel,@function
outb2_kernel:
  s_cmp_ge_u32 s2, 256
  s_cbranch_scc1 outb2_exit1
  s_load_dwordx2 s[12:13], s[0:1], 96
  s_load_dwordx2 s[14:15], s[0:1], 0
  s_load_dwordx2 s[48:49], s[0:1], 80
  v_lshrrev_b32 v3, 6, v0
  v_and_b32 v4, 63, v0
  s_nop 0
  v_readfirstlane_b32 s16, v3
  v_lshlrev_b32 v1, 4, v4
  s_and_b32 s17, s2, 7
  s_lshl_b32 s17, s17, 2
  s_lshr_b32 s18, s2, 3
  s_and_b32 s19, s18, 3
  s_add_u32 s17, s17, s19
  s_lshr_b32 s18, s18, 2
  s_waitcnt lgkmcnt(0)
  s_mov_b32 s4, s12
  s_mov_b32 s5, s13
  s_mov_b32 s6, 0x10000000
  s_mov_b32 s7, 0x20000
  s_mov_b32 s8, s12
  s_mov_b32 s9, s13
  s_mov_b32 s10, 0x10000000
  s_mov_b32 s11, 0x20000
  s_mov_b32 s20, 82313216
  s_mov_b32 s52, s48
  s_mov_b32 s53, s49
  s_mov_b32 s54, 2621440
  s_mov_b32 s55, 0x20000
  s_mul_i32 s21, s18, 5
  s_mul_i32 s21, s21, 20480
  s_add_u32 s24, s21, 90013696
  s_add_u32 s25, s24, 20480
  s_add_u32 s26, s25, 20480
  s_add_u32 s27, s26, 20480
  s_add_u32 s28, s27, 20480
  s_lshl_b32 s21, s17, 2
  s_add_u32 s21, s21, s16
  s_mul_i32 s22, s21, 20480
  s_add_u32 s22, s22, 50331648
  s_lshl_b32 s23, s16, 10
  v_add_u32 v2, s23, v1
  s_mul_i32 s29, s16, 5120
  s_add_u32 m0, s29, 0
  s_nop 0
  buffer_load_dwordx4 v2, s[4:7], s24 offen lds
  s_add_u32 m0, s29, 1024
  s_nop 0
  buffer_load_dwordx4 v2, s[4:7], s25 offen lds
  s_add_u32 m0, s29, 2048
  s_nop 0
  buffer_load_dwordx4 v2, s[4:7], s26 offen lds
  s_add_u32 m0, s29, 3072
  s_nop 0
  buffer_load_dwordx4 v2, s[4:7], s27 offen lds
  s_add_u32 m0, s29, 4096
  s_nop 0
  buffer_load_dwordx4 v2, s[4:7], s28 offen lds
  buffer_load_dwordx4 v[32:35], v1, s[4:7], s22 offen offset:0
  buffer_load_dwordx4 v[36:39], v1, s[4:7], s22 offen offset:1024
  buffer_load_dwordx4 v[40:43], v1, s[4:7], s22 offen offset:2048
  buffer_load_dwordx4 v[44:47], v1, s[4:7], s22 offen offset:3072
  v_add_u32 v2, 0x1000, v2
  s_add_u32 s22, s22, 4096
  s_add_u32 m0, s29, 20480
  s_nop 0
  buffer_load_dwordx4 v2, s[4:7], s24 offen lds
  s_add_u32 m0, s29, 21504
  s_nop 0
  buffer_load_dwordx4 v2, s[4:7], s25 offen lds
  s_add_u32 m0, s29, 22528
  s_nop 0
  buffer_load_dwordx4 v2, s[4:7], s26 offen lds
  s_add_u32 m0, s29, 23552
  s_nop 0
  buffer_load_dwordx4 v2, s[4:7], s27 offen lds
  s_add_u32 m0, s29, 24576
  s_nop 0
  buffer_load_dwordx4 v2, s[4:7], s28 offen lds
  buffer_load_dwordx4 v[48:51], v1, s[4:7], s22 offen offset:0
  buffer_load_dwordx4 v[52:55], v1, s[4:7], s22 offen offset:1024
  buffer_load_dwordx4 v[56:59], v1, s[4:7], s22 offen offset:2048
  buffer_load_dwordx4 v[60:63], v1, s[4:7], s22 offen offset:3072
  v_add_u32 v2, 0x1000, v2
  s_add_u32 s22, s22, 4096
  s_waitcnt vmcnt(9)
  s_barrier
  s_add_u32 m0, s29, 40960
  s_nop 0
  buffer_load_dwordx4 v2, s[4:7], s24 offen lds
  s_add_u32 m0, s29, 41984
  s_nop 0
  buffer_load_dwordx4 v2, s[4:7], s25 offen lds
  s_add_u32 m0, s29, 43008
  s_nop 0
  buffer_load_dwordx4 v2, s[4:7], s26 offen lds
  s_add_u32 m0, s29, 44032
  s_nop 0
  buffer_load_dwordx4 v2, s[4:7], s27 offen lds
  s_add_u32 m0, s29, 45056
  s_nop 0
  buffer_load_dwordx4 v2, s[4:7], s28 offen lds
  buffer_load_dwordx4 v[64:67], v1, s[4:7], s22 offen offset:0
  buffer_load_dwordx4 v[68:71], v1, s[4:7], s22 offen offset:1024
  buffer_load_dwordx4 v[72:75], v1, s[4:7], s22 offen offset:2048
  buffer_load_dwordx4 v[76:79], v1, s[4:7], s22 offen offset:3072
  v_add_u32 v2, 0x1000, v2
  s_add_u32 s22, s22, 4096
  ds_read_b128 v[80:83], v1 offset:0
  ds_read_b128 v[84:87], v1 offset:1024
  ds_read_b128 v[88:91], v1 offset:2048
  ds_read_b128 v[92:95], v1 offset:3072
  ds_read_b128 v[96:99], v1 offset:4096
  ds_read_b128 v[100:103], v1 offset:5120
  ds_read_b128 v[104:107], v1 offset:6144
  ds_read_b128 v[108:111], v1 offset:7168
  ds_read_b128 v[112:115], v1 offset:8192
  ds_read_b128 v[116:119], v1 offset:9216
  s_waitcnt lgkmcnt(5)
  v_mfma_f32_16x16x32_bf16 v[8:11], v[80:83], v[32:35], 0
  v_mfma_f32_16x16x32_bf16 v[12:15], v[84:87], v[32:35], 0
  v_mfma_f32_16x16x32_bf16 v[16:19], v[88:91], v[32:35], 0
  v_mfma_f32_16x16x32_bf16 v[20:23], v[92:95], v[32:35], 0
  v_mfma_f32_16x16x32_bf16 v[24:27], v[96:99], v[32:35], 0
  ds_read_b128 v[80:83], v1 offset:10240
  ds_read_b128 v[84:87], v1 offset:11264
  ds_read_b128 v[88:91], v1 offset:12288
  ds_read_b128 v[92:95], v1 offset:13312
  ds_read_b128 v[96:99], v1 offset:14336
  s_waitcnt lgkmcnt(5)
  v_mfma_f32_16x16x32_bf16 v[8:11], v[100:103], v[36:39], v[8:11]
  v_mfma_f32_16x16x32_bf16 v[12:15], v[104:107], v[36:39], v[12:15]
  v_mfma_f32_16x16x32_bf16 v[16:19], v[108:111], v[36:39], v[16:19]
  v_mfma_f32_16x16x32_bf16 v[20:23], v[112:115], v[36:39], v[20:23]
  v_mfma_f32_16x16x32_bf16 v[24:27], v[116:119], v[36:39], v[24:27]
  ds_read_b128 v[100:103], v1 offset:15360
  ds_read_b128 v[104:107], v1 offset:16384
  ds_read_b128 v[108:111], v1 offset:17408
  ds_read_b128 v[112:115], v1 offset:18432
  ds_read_b128 v[116:119], v1 offset:19456
  s_waitcnt lgkmcnt(5)
  v_mfma_f32_16x16x32_bf16 v[8:11], v[80:83], v[40:43], v[8:11]
  v_mfma_f32_16x16x32_bf16 v[12:15], v[84:87], v[40:43], v[12:15]
  v_mfma_f32_16x16x32_bf16 v[16:19], v[88:91], v[40:43], v[16:19]
  v_mfma_f32_16x16x32_bf16 v[20:23], v[92:95], v[40:43], v[20:23]
  v_mfma_f32_16x16x32_bf16 v[24:27], v[96:99], v[40:43], v[24:27]
  s_waitcnt lgkmcnt(0)
  v_mfma_f32_16x16x32_bf16 v[8:11], v[100:103], v[44:47], v[8:11]
  v_mfma_f32_16x16x32_bf16 v[12:15], v[104:107], v[44:47], v[12:15]
  v_mfma_f32_16x16x32_bf16 v[16:19], v[108:111], v[44:47], v[16:19]
  v_mfma_f32_16x16x32_bf16 v[20:23], v[112:115], v[44:47], v[20:23]
  v_mfma_f32_16x16x32_bf16 v[24:27], v[116:119], v[44:47], v[24:27]
  s_waitcnt vmcnt(9)
  s_barrier
  s_add_u32 m0, s29, 0
  s_nop 0
  buffer_load_dwordx4 v2, s[4:7], s24 offen lds
  s_add_u32 m0, s29, 1024
  s_nop 0
  buffer_load_dwordx4 v2, s[4:7], s25 offen lds
  s_add_u32 m0, s29, 2048
  s_nop 0
  buffer_load_dwordx4 v2, s[4:7], s26 offen lds
  s_add_u32 m0, s29, 3072
  s_nop 0
  buffer_load_dwordx4 v2, s[4:7], s27 offen lds
  s_add_u32 m0, s29, 4096
  s_nop 0
  buffer_load_dwordx4 v2, s[4:7], s28 offen lds
  buffer_load_dwordx4 v[32:35], v1, s[4:7], s22 offen offset:0
  buffer_load_dwordx4 v[36:39], v1, s[4:7], s22 offen offset:1024
  buffer_load_dwordx4 v[40:43], v1, s[4:7], s22 offen offset:2048
  buffer_load_dwordx4 v[44:47], v1, s[4:7], s22 offen offset:3072
  v_add_u32 v2, 0x1000, v2
  s_add_u32 s22, s22, 4096
  ds_read_b128 v[80:83], v1 offset:20480
  ds_read_b128 v[84:87], v1 offset:21504
  ds_read_b128 v[88:91], v1 offset:22528
  ds_read_b128 v[92:95], v1 offset:23552
  ds_read_b128 v[96:99], v1 offset:24576
  ds_read_b128 v[100:103], v1 offset:25600
  ds_read_b128 v[104:107], v1 offset:26624
  ds_read_b128 v[108:111], v1 offset:27648
  ds_read_b128 v[112:115], v1 offset:28672
  ds_read_b128 v[116:119], v1 offset:29696
  s_waitcnt lgkmcnt(5)
  v_mfma_f32_16x16x32_bf16 v[8:11], v[80:83], v[48:51], v[8:11]
  v_mfma_f32_16x16x32_bf16 v[12:15], v[84:87], v[48:51], v[12:15]
  v_mfma_f32_16x16x32_bf16 v[16:19], v[88:91], v[48:51], v[16:19]
  v_mfma_f32_16x16x32_bf16 v[20:23], v[92:95], v[48:51], v[20:23]
  v_mfma_f32_16x16x32_bf16 v[24:27], v[96:99], v[48:51], v[24:27]
  ds_read_b128 v[80:83], v1 offset:30720
  ds_read_b128 v[84:87], v1 offset:31744
  ds_read_b128 v[88:91], v1 offset:32768
  ds_read_b128 v[92:95], v1 offset:33792
  ds_read_b128 v[96:99], v1 offset:34816
  s_waitcnt lgkmcnt(5)
  v_mfma_f32_16x16x32_bf16 v[8:11], v[100:103], v[52:55], v[8:11]
  v_mfma_f32_16x16x32_bf16 v[12:15], v[104:107], v[52:55], v[12:15]
  v_mfma_f32_16x16x32_bf16 v[16:19], v[108:111], v[52:55], v[16:19]
  v_mfma_f32_16x16x32_bf16 v[20:23], v[112:115], v[52:55], v[20:23]
  v_mfma_f32_16x16x32_bf16 v[24:27], v[116:119], v[52:55], v[24:27]
  ds_read_b128 v[100:103], v1 offset:35840
  ds_read_b128 v[104:107], v1 offset:36864
  ds_read_b128 v[108:111], v1 offset:37888
  ds_read_b128 v[112:115], v1 offset:38912
  ds_read_b128 v[116:119], v1 offset:39936
  s_waitcnt lgkmcnt(5)
  v_mfma_f32_16x16x32_bf16 v[8:11], v[80:83], v[56:59], v[8:11]
  v_mfma_f32_16x16x32_bf16 v[12:15], v[84:87], v[56:59], v[12:15]
  v_mfma_f32_16x16x32_bf16 v[16:19], v[88:91], v[56:59], v[16:19]
  v_mfma_f32_16x16x32_bf16 v[20:23], v[92:95], v[56:59], v[20:23]
  v_mfma_f32_16x16x32_bf16 v[24:27], v[96:99], v[56:59], v[24:27]
  s_waitcnt lgkmcnt(0)
  v_mfma_f32_16x16x32_bf16 v[8:11], v[100:103], v[60:63], v[8:11]
  v_mfma_f32_16x16x32_bf16 v[12:15], v[104:107], v[60:63], v[12:15]
  v_mfma_f32_16x16x32_bf16 v[16:19], v[108:111], v[60:63], v[16:19]
  v_mfma_f32_16x16x32_bf16 v[20:23], v[112:115], v[60:63], v[20:23]
  v_mfma_f32_16x16x32_bf16 v[24:27], v[116:119], v[60:63], v[24:27]
  s_waitcnt vmcnt(9)
  s_barrier
  s_add_u32 m0, s29, 20480
  s_nop 0
  buffer_load_dwordx4 v2, s[4:7], s24 offen lds
  s_add_u32 m0, s29, 21504
  s_nop 0
  buffer_load_dwordx4 v2, s[4:7], s25 offen lds
  s_add_u32 m0, s29, 22528
  s_nop 0
  buffer_load_dwordx4 v2, s[4:7], s26 offen lds
  s_add_u32 m0, s29, 23552
  s_nop 0
  buffer_load_dwordx4 v2, s[4:7], s27 offen lds
  s_add_u32 m0, s29, 24576
  s_nop 0
  buffer_load_dwordx4 v2, s[4:7], s28 offen lds
  buffer_load_dwordx4 v[48:51], v1, s[4:7], s22 offen offset:0
  buffer_load_dwordx4 v[52:55], v1, s[4:7], s22 offen offset:1024
  buffer_load_dwordx4 v[56:59], v1, s[4:7], s22 offen offset:2048
  buffer_load_dwordx4 v[60:63], v1, s[4:7], s22 offen offset:3072
  v_add_u32 v2, 0x1000, v2
  s_add_u32 s22, s22, 4096
  ds_read_b128 v[80:83], v1 offset:40960
  ds_read_b128 v[84:87], v1 offset:41984
  ds_read_b128 v[88:91], v1 offset:43008
  ds_read_b128 v[92:95], v1 offset:44032
  ds_read_b128 v[96:99], v1 offset:45056
  ds_read_b128 v[100:103], v1 offset:46080
  ds_read_b128 v[104:107], v1 offset:47104
  ds_read_b128 v[108:111], v1 offset:48128
  ds_read_b128 v[112:115], v1 offset:49152
  ds_read_b128 v[116:119], v1 offset:50176
  s_waitcnt lgkmcnt(5)
  v_mfma_f32_16x16x32_bf16 v[8:11], v[80:83], v[64:67], v[8:11]
  v_mfma_f32_16x16x32_bf16 v[12:15], v[84:87], v[64:67], v[12:15]
  v_mfma_f32_16x16x32_bf16 v[16:19], v[88:91], v[64:67], v[16:19]
  v_mfma_f32_16x16x32_bf16 v[20:23], v[92:95], v[64:67], v[20:23]
  v_mfma_f32_16x16x32_bf16 v[24:27], v[96:99], v[64:67], v[24:27]
  ds_read_b128 v[80:83], v1 offset:51200
  ds_read_b128 v[84:87], v1 offset:52224
  ds_read_b128 v[88:91], v1 offset:53248
  ds_read_b128 v[92:95], v1 offset:54272
  ds_read_b128 v[96:99], v1 offset:55296
  s_waitcnt lgkmcnt(5)
  v_mfma_f32_16x16x32_bf16 v[8:11], v[100:103], v[68:71], v[8:11]
  v_mfma_f32_16x16x32_bf16 v[12:15], v[104:107], v[68:71], v[12:15]
  v_mfma_f32_16x16x32_bf16 v[16:19], v[108:111], v[68:71], v[16:19]
  v_mfma_f32_16x16x32_bf16 v[20:23], v[112:115], v[68:71], v[20:23]
  v_mfma_f32_16x16x32_bf16 v[24:27], v[116:119], v[68:71], v[24:27]
  ds_read_b128 v[100:103], v1 offset:56320
  ds_read_b128 v[104:107], v1 offset:57344
  ds_read_b128 v[108:111], v1 offset:58368
  ds_read_b128 v[112:115], v1 offset:59392
  ds_read_b128 v[116:119], v1 offset:60416
  s_waitcnt lgkmcnt(5)
  v_mfma_f32_16x16x32_bf16 v[8:11], v[80:83], v[72:75], v[8:11]
  v_mfma_f32_16x16x32_bf16 v[12:15], v[84:87], v[72:75], v[12:15]
  v_mfma_f32_16x16x32_bf16 v[16:19], v[88:91], v[72:75], v[16:19]
  v_mfma_f32_16x16x32_bf16 v[20:23], v[92:95], v[72:75], v[20:23]
  v_mfma_f32_16x16x32_bf16 v[24:27], v[96:99], v[72:75], v[24:27]
  s_waitcnt lgkmcnt(0)
  v_mfma_f32_16x16x32_bf16 v[8:11], v[100:103], v[76:79], v[8:11]
  v_mfma_f32_16x16x32_bf16 v[12:15], v[104:107], v[76:79], v[12:15]
  v_mfma_f32_16x16x32_bf16 v[16:19], v[108:111], v[76:79], v[16:19]
  v_mfma_f32_16x16x32_bf16 v[20:23], v[112:115], v[76:79], v[20:23]
  v_mfma_f32_16x16x32_bf16 v[24:27], v[116:119], v[76:79], v[24:27]
  s_waitcnt vmcnt(9)
  s_barrier
  ds_read_b128 v[80:83], v1 offset:0
  ds_read_b128 v[84:87], v1 offset:1024
  ds_read_b128 v[88:91], v1 offset:2048
  ds_read_b128 v[92:95], v1 offset:3072
  ds_read_b128 v[96:99], v1 offset:4096
  ds_read_b128 v[100:103], v1 offset:5120
  ds_read_b128 v[104:107], v1 offset:6144
  ds_read_b128 v[108:111], v1 offset:7168
  ds_read_b128 v[112:115], v1 offset:8192
  ds_read_b128 v[116:119], v1 offset:9216
  s_waitcnt lgkmcnt(5)
  v_mfma_f32_16x16x32_bf16 v[8:11], v[80:83], v[32:35], v[8:11]
  v_mfma_f32_16x16x32_bf16 v[12:15], v[84:87], v[32:35], v[12:15]
  v_mfma_f32_16x16x32_bf16 v[16:19], v[88:91], v[32:35], v[16:19]
  v_mfma_f32_16x16x32_bf16 v[20:23], v[92:95], v[32:35], v[20:23]
  v_mfma_f32_16x16x32_bf16 v[24:27], v[96:99], v[32:35], v[24:27]
  ds_read_b128 v[80:83], v1 offset:10240
  ds_read_b128 v[84:87], v1 offset:11264
  ds_read_b128 v[88:91], v1 offset:12288
  ds_read_b128 v[92:95], v1 offset:13312
  ds_read_b128 v[96:99], v1 offset:14336
  s_waitcnt lgkmcnt(5)
  v_mfma_f32_16x16x32_bf16 v[8:11], v[100:103], v[36:39], v[8:11]
  v_mfma_f32_16x16x32_bf16 v[12:15], v[104:107], v[36:39], v[12:15]
  v_mfma_f32_16x16x32_bf16 v[16:19], v[108:111], v[36:39], v[16:19]
  v_mfma_f32_16x16x32_bf16 v[20:23], v[112:115], v[36:39], v[20:23]
  v_mfma_f32_16x16x32_bf16 v[24:27], v[116:119], v[36:39], v[24:27]
  ds_read_b128 v[100:103], v1 offset:15360
  ds_read_b128 v[104:107], v1 offset:16384
  ds_read_b128 v[108:111], v1 offset:17408
  ds_read_b128 v[112:115], v1 offset:18432
  ds_read_b128 v[116:119], v1 offset:19456
  s_waitcnt lgkmcnt(5)
  v_mfma_f32_16x16x32_bf16 v[8:11], v[80:83], v[40:43], v[8:11]
  v_mfma_f32_16x16x32_bf16 v[12:15], v[84:87], v[40:43], v[12:15]
  v_mfma_f32_16x16x32_bf16 v[16:19], v[88:91], v[40:43], v[16:19]
  v_mfma_f32_16x16x32_bf16 v[20:23], v[92:95], v[40:43], v[20:23]
  v_mfma_f32_16x16x32_bf16 v[24:27], v[96:99], v[40:43], v[24:27]
  s_waitcnt lgkmcnt(0)
  v_mfma_f32_16x16x32_bf16 v[8:11], v[100:103], v[44:47], v[8:11]
  v_mfma_f32_16x16x32_bf16 v[12:15], v[104:107], v[44:47], v[12:15]
  v_mfma_f32_16x16x32_bf16 v[16:19], v[108:111], v[44:47], v[16:19]
  v_mfma_f32_16x16x32_bf16 v[20:23], v[112:115], v[44:47], v[20:23]
  v_mfma_f32_16x16x32_bf16 v[24:27], v[116:119], v[44:47], v[24:27]
  s_waitcnt vmcnt(0)
  s_barrier
  ds_read_b128 v[80:83], v1 offset:20480
  ds_read_b128 v[84:87], v1 offset:21504
  ds_read_b128 v[88:91], v1 offset:22528
  ds_read_b128 v[92:95], v1 offset:23552
  ds_read_b128 v[96:99], v1 offset:24576
  ds_read_b128 v[100:103], v1 offset:25600
  ds_read_b128 v[104:107], v1 offset:26624
  ds_read_b128 v[108:111], v1 offset:27648
  ds_read_b128 v[112:115], v1 offset:28672
  ds_read_b128 v[116:119], v1 offset:29696
  s_waitcnt lgkmcnt(5)
  v_mfma_f32_16x16x32_bf16 v[8:11], v[80:83], v[48:51], v[8:11]
  v_mfma_f32_16x16x32_bf16 v[12:15], v[84:87], v[48:51], v[12:15]
  v_mfma_f32_16x16x32_bf16 v[16:19], v[88:91], v[48:51], v[16:19]
  v_mfma_f32_16x16x32_bf16 v[20:23], v[92:95], v[48:51], v[20:23]
  v_mfma_f32_16x16x32_bf16 v[24:27], v[96:99], v[48:51], v[24:27]
  ds_read_b128 v[80:83], v1 offset:30720
  ds_read_b128 v[84:87], v1 offset:31744
  ds_read_b128 v[88:91], v1 offset:32768
  ds_read_b128 v[92:95], v1 offset:33792
  ds_read_b128 v[96:99], v1 offset:34816
  s_waitcnt lgkmcnt(5)
  v_mfma_f32_16x16x32_bf16 v[8:11], v[100:103], v[52:55], v[8:11]
  v_mfma_f32_16x16x32_bf16 v[12:15], v[104:107], v[52:55], v[12:15]
  v_mfma_f32_16x16x32_bf16 v[16:19], v[108:111], v[52:55], v[16:19]
  v_mfma_f32_16x16x32_bf16 v[20:23], v[112:115], v[52:55], v[20:23]
  v_mfma_f32_16x16x32_bf16 v[24:27], v[116:119], v[52:55], v[24:27]
  ds_read_b128 v[100:103], v1 offset:35840
  ds_read_b128 v[104:107], v1 offset:36864
  ds_read_b128 v[108:111], v1 offset:37888
  ds_read_b128 v[112:115], v1 offset:38912
  ds_read_b128 v[116:119], v1 offset:39936
  s_waitcnt lgkmcnt(5)
  v_mfma_f32_16x16x32_bf16 v[8:11], v[80:83], v[56:59], v[8:11]
  v_mfma_f32_16x16x32_bf16 v[12:15], v[84:87], v[56:59], v[12:15]
  v_mfma_f32_16x16x32_bf16 v[16:19], v[88:91], v[56:59], v[16:19]
  v_mfma_f32_16x16x32_bf16 v[20:23], v[92:95], v[56:59], v[20:23]
  v_mfma_f32_16x16x32_bf16 v[24:27], v[96:99], v[56:59], v[24:27]
  s_waitcnt lgkmcnt(0)
  v_mfma_f32_16x16x32_bf16 v[8:11], v[100:103], v[60:63], v[8:11]
  v_mfma_f32_16x16x32_bf16 v[12:15], v[104:107], v[60:63], v[12:15]
  v_mfma_f32_16x16x32_bf16 v[16:19], v[108:111], v[60:63], v[16:19]
  v_mfma_f32_16x16x32_bf16 v[20:23], v[112:115], v[60:63], v[20:23]
  v_mfma_f32_16x16x32_bf16 v[24:27], v[116:119], v[60:63], v[24:27]
  v_and_b32 v3, 63, v0
  v_and_b32 v4, 15, v3
  v_lshrrev_b32 v3, 4, v3
  s_lshl_b32 s21, s17, 6
  s_lshl_b32 s23, s16, 4
  s_add_u32 s21, s21, s23
  v_add_u32 v4, s21, v4
  v_mul_u32_u24 v6, 1280, v4
  v_lshl_add_u32 v6, v3, 4, v6
  s_mul_i32 s21, s18, 5
  s_add_u32 s23, s21, 0
  s_lshr_b32 s31, s23, 1
  s_lshl_b32 s31, s31, 6
  s_and_b32 s23, s23, 1
  s_lshl_b32 s23, s23, 3
  s_add_u32 s32, s31, s23
  s_add_u32 s40, s32, s20
  buffer_load_dwordx2 v[32:33], v6, s[8:11], s40 offen
  s_add_u32 s23, s21, 1
  s_lshr_b32 s31, s23, 1
  s_lshl_b32 s31, s31, 6
  s_and_b32 s23, s23, 1
  s_lshl_b32 s23, s23, 3
  s_add_u32 s33, s31, s23
  s_add_u32 s41, s33, s20
  buffer_load_dwordx2 v[34:35], v6, s[8:11], s41 offen
  s_add_u32 s23, s21, 2
  s_lshr_b32 s31, s23, 1
  s_lshl_b32 s31, s31, 6
  s_and_b32 s23, s23, 1
  s_lshl_b32 s23, s23, 3
  s_add_u32 s34, s31, s23
  s_add_u32 s42, s34, s20
  buffer_load_dwordx2 v[36:37], v6, s[8:11], s42 offen
  s_add_u32 s23, s21, 3
  s_lshr_b32 s31, s23, 1
  s_lshl_b32 s31, s31, 6
  s_and_b32 s23, s23, 1
  s_lshl_b32 s23, s23, 3
  s_add_u32 s35, s31, s23
  s_add_u32 s43, s35, s20
  buffer_load_dwordx2 v[38:39], v6, s[8:11], s43 offen
  s_add_u32 s23, s21, 4
  s_lshr_b32 s31, s23, 1
  s_lshl_b32 s31, s31, 6
  s_and_b32 s23, s23, 1
  s_lshl_b32 s23, s23, 3
  s_add_u32 s36, s31, s23
  s_add_u32 s44, s36, s20
  buffer_load_dwordx2 v[40:41], v6, s[8:11], s44 offen
  s_waitcnt vmcnt(0)
  v_cvt_pk_bf16_f32 v80, v8, v9
  v_cvt_pk_bf16_f32 v81, v10, v11
  v_lshlrev_b32 v8, 16, v80
  v_and_b32 v9, 0xffff0000, v80
  v_lshlrev_b32 v10, 16, v81
  v_and_b32 v11, 0xffff0000, v81
  v_lshlrev_b32 v82, 16, v32
  v_and_b32 v83, 0xffff0000, v32
  v_lshlrev_b32 v84, 16, v33
  v_and_b32 v85, 0xffff0000, v33
  v_add_f32 v8, v8, v82
  v_add_f32 v9, v9, v83
  v_add_f32 v10, v10, v84
  v_add_f32 v11, v11, v85
  v_cvt_pk_bf16_f32 v32, v8, v9
  v_cvt_pk_bf16_f32 v33, v10, v11
  buffer_store_dwordx2 v[32:33], v6, s[52:55], s32 offen sc1
  v_cvt_pk_bf16_f32 v80, v12, v13
  v_cvt_pk_bf16_f32 v81, v14, v15
  v_lshlrev_b32 v12, 16, v80
  v_and_b32 v13, 0xffff0000, v80
  v_lshlrev_b32 v14, 16, v81
  v_and_b32 v15, 0xffff0000, v81
  v_lshlrev_b32 v82, 16, v34
  v_and_b32 v83, 0xffff0000, v34
  v_lshlrev_b32 v84, 16, v35
  v_and_b32 v85, 0xffff0000, v35
  v_add_f32 v12, v12, v82
  v_add_f32 v13, v13, v83
  v_add_f32 v14, v14, v84
  v_add_f32 v15, v15, v85
  v_cvt_pk_bf16_f32 v34, v12, v13
  v_cvt_pk_bf16_f32 v35, v14, v15
  buffer_store_dwordx2 v[34:35], v6, s[52:55], s33 offen sc1
  v_cvt_pk_bf16_f32 v80, v16, v17
  v_cvt_pk_bf16_f32 v81, v18, v19
  v_lshlrev_b32 v16, 16, v80
  v_and_b32 v17, 0xffff0000, v80
  v_lshlrev_b32 v18, 16, v81
  v_and_b32 v19, 0xffff0000, v81
  v_lshlrev_b32 v82, 16, v36
  v_and_b32 v83, 0xffff0000, v36
  v_lshlrev_b32 v84, 16, v37
  v_and_b32 v85, 0xffff0000, v37
  v_add_f32 v16, v16, v82
  v_add_f32 v17, v17, v83
  v_add_f32 v18, v18, v84
  v_add_f32 v19, v19, v85
  v_cvt_pk_bf16_f32 v36, v16, v17
  v_cvt_pk_bf16_f32 v37, v18, v19
  buffer_store_dwordx2 v[36:37], v6, s[52:55], s34 offen sc1
  v_cvt_pk_bf16_f32 v80, v20, v21
  v_cvt_pk_bf16_f32 v81, v22, v23
  v_lshlrev_b32 v20, 16, v80
  v_and_b32 v21, 0xffff0000, v80
  v_lshlrev_b32 v22, 16, v81
  v_and_b32 v23, 0xffff0000, v81
  v_lshlrev_b32 v82, 16, v38
  v_and_b32 v83, 0xffff0000, v38
  v_lshlrev_b32 v84, 16, v39
  v_and_b32 v85, 0xffff0000, v39
  v_add_f32 v20, v20, v82
  v_add_f32 v21, v21, v83
  v_add_f32 v22, v22, v84
  v_add_f32 v23, v23, v85
  v_cvt_pk_bf16_f32 v38, v20, v21
  v_cvt_pk_bf16_f32 v39, v22, v23
  buffer_store_dwordx2 v[38:39], v6, s[52:55], s35 offen sc1
  v_cvt_pk_bf16_f32 v80, v24, v25
  v_cvt_pk_bf16_f32 v81, v26, v27
  v_lshlrev_b32 v24, 16, v80
  v_and_b32 v25, 0xffff0000, v80
  v_lshlrev_b32 v26, 16, v81
  v_and_b32 v27, 0xffff0000, v81
  v_lshlrev_b32 v82, 16, v40
  v_and_b32 v83, 0xffff0000, v40
  v_lshlrev_b32 v84, 16, v41
  v_and_b32 v85, 0xffff0000, v41
  v_add_f32 v24, v24, v82
  v_add_f32 v25, v25, v83
  v_add_f32 v26, v26, v84
  v_add_f32 v27, v27, v85
  v_cvt_pk_bf16_f32 v40, v24, v25
  v_cvt_pk_bf16_f32 v41, v26, v27
  buffer_store_dwordx2 v[40:41], v6, s[52:55], s36 offen sc1
outb2_exit1:
  s_endpgm
.section .rodata,"a"
.p2align 6
.amdhsa_kernel prep_kernel
  .amdhsa_next_free_vgpr 80
  .amdhsa_next_free_sgpr 64
  .amdhsa_accum_offset 80
  .amdhsa_group_segment_fixed_size 0
  .amdhsa_kernarg_size 104
  .amdhsa_user_sgpr_count 2
  .amdhsa_user_sgpr_kernarg_segment_ptr 1
  .amdhsa_system_sgpr_workgroup_id_x 1
  .amdhsa_float_denorm_mode_32 3
.end_amdhsa_kernel
.p2align 6
.amdhsa_kernel ln2_kernel
  .amdhsa_next_free_vgpr 80
  .amdhsa_next_free_sgpr 40
  .amdhsa_accum_offset 80
  .amdhsa_group_segment_fixed_size 0
  .amdhsa_kernarg_size 104
  .amdhsa_user_sgpr_count 2
  .amdhsa_user_sgpr_kernarg_segment_ptr 1
  .amdhsa_system_sgpr_workgroup_id_x 1
  .amdhsa_float_denorm_mode_32 3
.end_amdhsa_kernel
.p2align 6
.amdhsa_kernel reca_kernel
  .amdhsa_next_free_vgpr 512
  .amdhsa_next_free_sgpr 102
  .amdhsa_accum_offset 256
  .amdhsa_group_segment_fixed_size 0
  .amdhsa_kernarg_size 104
  .amdhsa_user_sgpr_count 2
  .amdhsa_user_sgpr_kernarg_segment_ptr 1
  .amdhsa_system_sgpr_workgroup_id_x 1
  .amdhsa_float_denorm_mode_32 3
.end_amdhsa_kernel
.p2align 6
.amdhsa_kernel fin_kernel
  .amdhsa_next_free_vgpr 496
  .amdhsa_next_free_sgpr 64
  .amdhsa_accum_offset 256
  .amdhsa_group_segment_fixed_size 0
  .amdhsa_kernarg_size 104
  .amdhsa_user_sgpr_count 2
  .amdhsa_user_sgpr_kernarg_segment_ptr 1
  .amdhsa_system_sgpr_workgroup_id_x 1
  .amdhsa_float_denorm_mode_32 3
.end_amdhsa_kernel
.p2align 6
.amdhsa_kernel redln1_kernel
  .amdhsa_next_free_vgpr 248
  .amdhsa_next_free_sgpr 48
  .amdhsa_accum_offset 248
  .amdhsa_group_segment_fixed_size 0
  .amdhsa_kernarg_size 104
  .amdhsa_user_sgpr_count 2
  .amdhsa_user_sgpr_kernarg_segment_ptr 1
  .amdhsa_system_sgpr_workgroup_id_x 1
  .amdhsa_float_denorm_mode_32 3
.end_amdhsa_kernel
.p2align 6
.amdhsa_kernel redln2_kernel
  .amdhsa_next_free_vgpr 248
  .amdhsa_next_free_sgpr 48
  .amdhsa_accum_offset 248
  .amdhsa_group_segment_fixed_size 0
  .amdhsa_kernarg_size 104
  .amdhsa_user_sgpr_count 2
  .amdhsa_user_sgpr_kernarg_segment_ptr 1
  .amdhsa_system_sgpr_workgroup_id_x 1
  .amdhsa_float_denorm_mode_32 3
.end_amdhsa_kernel
.p2align 6
.amdhsa_kernel qkvb_kernel
  .amdhsa_next_free_vgpr 176
  .amdhsa_next_free_sgpr 64
  .amdhsa_accum_offset 176
  .amdhsa_group_segment_fixed_size 0
  .amdhsa_kernarg_size 104
  .amdhsa_user_sgpr_count 2
  .amdhsa_user_sgpr_kernarg_segment_ptr 1
  .amdhsa_system_sgpr_workgroup_id_x 1
  .amdhsa_float_denorm_mode_32 3
.end_amdhsa_kernel
.p2align 6
.amdhsa_kernel attnb_kernel
  .amdhsa_next_free_vgpr 200
  .amdhsa_next_free_sgpr 48
  .amdhsa_accum_offset 200
  .amdhsa_group_segment_fixed_size 0
  .amdhsa_kernarg_size 104
  .amdhsa_user_sgpr_count 2
  .amdhsa_user_sgpr_kernarg_segment_ptr 1
  .amdhsa_system_sgpr_workgroup_id_x 1
  .amdhsa_float_denorm_mode_32 3
.end_amdhsa_kernel
.p2align 6
.amdhsa_kernel outb1_kernel
  .amdhsa_next_free_vgpr 128
  .amdhsa_next_free_sgpr 64
  .amdhsa_accum_offset 128
  .amdhsa_group_segment_fixed_size 0
  .amdhsa_kernarg_size 104
  .amdhsa_user_sgpr_count 2
  .amdhsa_user_sgpr_kernarg_segment_ptr 1
  .amdhsa_system_sgpr_workgroup_id_x 1
  .amdhsa_float_denorm_mode_32 3
.end_amdhsa_kernel
.p2align 6
.amdhsa_kernel outb2_kernel
  .amdhsa_next_free_vgpr 128
  .amdhsa_next_free_sgpr 64
  .amdhsa_accum_offset 128
  .amdhsa_group_segment_fixed_size 0
  .amdhsa_kernarg_size 104
  .amdhsa_user_sgpr_count 2
  .amdhsa_user_sgpr_kernarg_segment_ptr 1
  .amdhsa_system_sgpr_workgroup_id_x 1
  .amdhsa_float_denorm_mode_32 3
.end_amdhsa_kernel
```

```asm
; @launch kernel=prep_kernel grid=(2248,1,1) block=(256,1,1) lds=18944
; @launch kernel=reca_kernel grid=(256,1,1) block=(256,1,1) lds=81920
; @launch kernel=fin_kernel grid=(256,1,1) block=(256,1,1) lds=98304
; @launch kernel=redln1_kernel grid=(256,1,1) block=(128,1,1) lds=128
; @launch kernel=qkvb_kernel grid=(256,1,1) block=(256,1,1) lds=81920
; @launch kernel=attnb_kernel grid=(256,1,1) block=(256,1,1) lds=0
; @launch kernel=outb1_kernel grid=(256,1,1) block=(256,1,1) lds=61440
; @launch kernel=ln2_kernel grid=(128,1,1) block=(256,1,1) lds=512
; @launch kernel=reca_kernel grid=(256,1,1) block=(256,1,1) lds=81920
; @launch kernel=fin_kernel grid=(256,1,1) block=(256,1,1) lds=98304
; @launch kernel=redln2_kernel grid=(256,1,1) block=(128,1,1) lds=128
; @launch kernel=qkvb_kernel grid=(256,1,1) block=(256,1,1) lds=81920
; @launch kernel=attnb_kernel grid=(256,1,1) block=(256,1,1) lds=0
; @launch kernel=outb2_kernel grid=(256,1,1) block=(256,1,1) lds=61440
.amdgcn_target "amdgcn-amd-amdhsa--gfx950"
.text
.globl prep_kernel
.p2align 8
.type prep_kernel,@function
prep_kernel:
s_cmp_ge_u32 s2, 128
s_cbranch_scc1 prep_notln5
s_load_dwordx2 s[12:13], s[0:1], 96
s_load_dwordx2 s[14:15], s[0:1], 0
v_lshrrev_b32 v2, 6, v0
v_and_b32 v3, 63, v0
s_nop 0
v_readfirstlane_b32 s16, v2
s_waitcnt lgkmcnt(0)
s_mov_b32 s4, s12
s_mov_b32 s5, s13
s_mov_b32 s6, 0x10000000
s_mov_b32 s7, 0x20000
s_mov_b32 s8, s14
s_mov_b32 s9, s15
s_mov_b32 s10, 2621440
s_mov_b32 s11, 0x20000
s_mov_b32 s20, 0
v_and_b32 v2, 15, v3
v_lshrrev_b32 v4, 4, v3
s_lshl_b32 s17, s2, 4
v_add_u32 v1, s17, v2
v_mul_u32_u24 v1, 1280, v1
v_lshl_add_u32 v1, v4, 4, v1
s_mul_i32 s17, s16, 320
s_add_u32 s20, s20, s17
buffer_load_dwordx4 v[8:11], v1, s[8:11], s20 offen offset:0
buffer_load_dwordx4 v[12:15], v1, s[8:11], s20 offen offset:64
buffer_load_dwordx4 v[16:19], v1, s[8:11], s20 offen offset:128
buffer_load_dwordx4 v[20:23], v1, s[8:11], s20 offen offset:192
buffer_load_dwordx4 v[24:27], v1, s[8:11], s20 offen offset:256
s_sub_u32 s21, 0, s12
s_and_b32 s21, s21, 0x1fffff
s_add_u32 s21, s21, 2097152
v_mov_b32 v68, -1
v_mov_b32 v69, -1
v_mov_b32 v70, -1
v_mov_b32 v71, -1
v_lshlrev_b32 v72, 4, v0
s_mul_i32 s22, s2, 12096
s_add_u32 s22, s22, 0
s_mul_i32 s23, s2, 12288
s_add_u32 s23, s23, s21
buffer_store_dwordx4 v[68:71], v72, s[4:7], s22 offen sc1
s_add_u32 s22, s22, 4096
buffer_store_dwordx4 v[68:71], v72, s[4:7], s22 offen sc1
s_add_u32 s22, s22, 4096
v_mov_b32 v73, 0x80000000
v_cmp_gt_u32 vcc, 244, v0
s_nop 1
v_cndmask_b32 v73, v73, v72, vcc
buffer_store_dwordx4 v[68:71], v73, s[4:7], s22 offen
buffer_store_dwordx4 v[68:71], v72, s[4:7], s23 offen sc1
s_add_u32 s23, s23, 4096
buffer_store_dwordx4 v[68:71], v72, s[4:7], s23 offen sc1
s_add_u32 s23, s23, 4096
buffer_store_dwordx4 v[68:71], v72, s[4:7], s23 offen sc1
s_add_u32 s23, s23, 4096
s_mul_i32 s23, s2, 2048
s_add_u32 s23, s23, s21
s_add_u32 s23, s23, 1572864
v_mov_b32 v73, 0x80000000
v_cmp_gt_u32 vcc, 128, v0
s_nop 1
v_cndmask_b32 v73, v73, v72, vcc
buffer_store_dwordx4 v[68:71], v73, s[4:7], s23 offen sc1
s_waitcnt vmcnt(7)
s_mul_i32 s17, s16, 320
s_add_u32 s17, s17, 82313216
buffer_store_dwordx4 v[8:11], v1, s[4:7], s17 offen offset:0
buffer_store_dwordx4 v[12:15], v1, s[4:7], s17 offen offset:64
buffer_store_dwordx4 v[16:19], v1, s[4:7], s17 offen offset:128
buffer_store_dwordx4 v[20:23], v1, s[4:7], s17 offen offset:192
buffer_store_dwordx4 v[24:27], v1, s[4:7], s17 offen offset:256
v_lshlrev_b32 v5, 2, v2
s_lshl_b32 s17, s16, 6
v_add_u32 v1, s17, v5
s_waitcnt vmcnt(5)
v_lshlrev_b32 v28, 16, v8
v_and_b32 v29, 0xffff0000, v8
v_lshlrev_b32 v30, 16, v9
v_and_b32 v31, 0xffff0000, v9
v_lshlrev_b32 v32, 16, v10
v_and_b32 v33, 0xffff0000, v10
v_lshlrev_b32 v34, 16, v11
v_and_b32 v35, 0xffff0000, v11
v_lshlrev_b32 v36, 16, v12
v_and_b32 v37, 0xffff0000, v12
v_lshlrev_b32 v38, 16, v13
v_and_b32 v39, 0xffff0000, v13
v_lshlrev_b32 v40, 16, v14
v_and_b32 v41, 0xffff0000, v14
v_lshlrev_b32 v42, 16, v15
v_and_b32 v43, 0xffff0000, v15
v_lshlrev_b32 v44, 16, v16
v_and_b32 v45, 0xffff0000, v16
v_lshlrev_b32 v46, 16, v17
v_and_b32 v47, 0xffff0000, v17
v_lshlrev_b32 v48, 16, v18
v_and_b32 v49, 0xffff0000, v18
v_lshlrev_b32 v50, 16, v19
v_and_b32 v51, 0xffff0000, v19
v_lshlrev_b32 v52, 16, v20
v_and_b32 v53, 0xffff0000, v20
v_lshlrev_b32 v54, 16, v21
v_and_b32 v55, 0xffff0000, v21
v_lshlrev_b32 v56, 16, v22
v_and_b32 v57, 0xffff0000, v22
v_lshlrev_b32 v58, 16, v23
v_and_b32 v59, 0xffff0000, v23
v_lshlrev_b32 v60, 16, v24
v_and_b32 v61, 0xffff0000, v24
v_lshlrev_b32 v62, 16, v25
v_and_b32 v63, 0xffff0000, v25
v_lshlrev_b32 v64, 16, v26
v_and_b32 v65, 0xffff0000, v26
v_lshlrev_b32 v66, 16, v27
v_and_b32 v67, 0xffff0000, v27
v_pk_add_f32 v[6:7], v[28:29], v[30:31]
v_pk_add_f32 v[6:7], v[6:7], v[32:33]
v_pk_add_f32 v[6:7], v[6:7], v[34:35]
v_pk_add_f32 v[6:7], v[6:7], v[36:37]
v_pk_add_f32 v[6:7], v[6:7], v[38:39]
v_pk_add_f32 v[6:7], v[6:7], v[40:41]
v_pk_add_f32 v[6:7], v[6:7], v[42:43]
v_pk_add_f32 v[6:7], v[6:7], v[44:45]
v_pk_add_f32 v[6:7], v[6:7], v[46:47]
v_pk_add_f32 v[6:7], v[6:7], v[48:49]
v_pk_add_f32 v[6:7], v[6:7], v[50:51]
v_pk_add_f32 v[6:7], v[6:7], v[52:53]
v_pk_add_f32 v[6:7], v[6:7], v[54:55]
v_pk_add_f32 v[6:7], v[6:7], v[56:57]
v_pk_add_f32 v[6:7], v[6:7], v[58:59]
v_pk_add_f32 v[6:7], v[6:7], v[60:61]
v_pk_add_f32 v[6:7], v[6:7], v[62:63]
v_pk_add_f32 v[6:7], v[6:7], v[64:65]
v_pk_add_f32 v[6:7], v[6:7], v[66:67]
v_add_f32 v4, v6, v7
v_mov_b32 v2, v4
s_nop 1
v_permlane32_swap_b32 v4, v2
v_add_f32 v4, v4, v2
v_mov_b32 v2, v4
s_nop 1
v_permlane16_swap_b32 v4, v2
v_add_f32 v4, v4, v2
ds_write_b32 v1, v4 offset:0
s_waitcnt lgkmcnt(0)
s_barrier
ds_read_b32 v4, v5 offset:0
ds_read_b32 v2, v5 offset:64
ds_read_b32 v3, v5 offset:128
ds_read_b32 v6, v5 offset:192
s_waitcnt lgkmcnt(0)
v_add_f32 v4, v4, v2
v_add_f32 v3, v3, v6
v_add_f32 v4, v4, v3
v_mul_f32 v4, 0x3acccccd, v4
v_sub_f32 v28, v28, v4
v_sub_f32 v29, v29, v4
v_sub_f32 v30, v30, v4
v_sub_f32 v31, v31, v4
v_sub_f32 v32, v32, v4
v_sub_f32 v33, v33, v4
v_sub_f32 v34, v34, v4
v_sub_f32 v35, v35, v4
v_sub_f32 v36, v36, v4
v_sub_f32 v37, v37, v4
v_sub_f32 v38, v38, v4
v_sub_f32 v39, v39, v4
v_sub_f32 v40, v40, v4
v_sub_f32 v41, v41, v4
v_sub_f32 v42, v42, v4
v_sub_f32 v43, v43, v4
v_sub_f32 v44, v44, v4
v_sub_f32 v45, v45, v4
v_sub_f32 v46, v46, v4
v_sub_f32 v47, v47, v4
v_sub_f32 v48, v48, v4
v_sub_f32 v49, v49, v4
v_sub_f32 v50, v50, v4
v_sub_f32 v51, v51, v4
v_sub_f32 v52, v52, v4
v_sub_f32 v53, v53, v4
v_sub_f32 v54, v54, v4
v_sub_f32 v55, v55, v4
v_sub_f32 v56, v56, v4
v_sub_f32 v57, v57, v4
v_sub_f32 v58, v58, v4
v_sub_f32 v59, v59, v4
v_sub_f32 v60, v60, v4
v_sub_f32 v61, v61, v4
v_sub_f32 v62, v62, v4
v_sub_f32 v63, v63, v4
v_sub_f32 v64, v64, v4
v_sub_f32 v65, v65, v4
v_sub_f32 v66, v66, v4
v_sub_f32 v67, v67, v4
v_mul_f32 v6, v28, v28
v_mul_f32 v7, v29, v29
v_fmac_f32 v6, v30, v30
v_fmac_f32 v7, v31, v31
v_fmac_f32 v6, v32, v32
v_fmac_f32 v7, v33, v33
v_fmac_f32 v6, v34, v34
v_fmac_f32 v7, v35, v35
v_fmac_f32 v6, v36, v36
v_fmac_f32 v7, v37, v37
v_fmac_f32 v6, v38, v38
v_fmac_f32 v7, v39, v39
v_fmac_f32 v6, v40, v40
v_fmac_f32 v7, v41, v41
v_fmac_f32 v6, v42, v42
v_fmac_f32 v7, v43, v43
v_fmac_f32 v6, v44, v44
v_fmac_f32 v7, v45, v45
v_fmac_f32 v6, v46, v46
v_fmac_f32 v7, v47, v47
v_fmac_f32 v6, v48, v48
v_fmac_f32 v7, v49, v49
v_fmac_f32 v6, v50, v50
v_fmac_f32 v7, v51, v51
v_fmac_f32 v6, v52, v52
v_fmac_f32 v7, v53, v53
v_fmac_f32 v6, v54, v54
v_fmac_f32 v7, v55, v55
v_fmac_f32 v6, v56, v56
v_fmac_f32 v7, v57, v57
v_fmac_f32 v6, v58, v58
v_fmac_f32 v7, v59, v59
v_fmac_f32 v6, v60, v60
v_fmac_f32 v7, v61, v61
v_fmac_f32 v6, v62, v62
v_fmac_f32 v7, v63, v63
v_fmac_f32 v6, v64, v64
v_fmac_f32 v7, v65, v65
v_fmac_f32 v6, v66, v66
v_fmac_f32 v7, v67, v67
v_add_f32 v4, v6, v7
v_mov_b32 v2, v4
s_nop 1
v_permlane32_swap_b32 v4, v2
v_add_f32 v4, v4, v2
v_mov_b32 v2, v4
s_nop 1
v_permlane16_swap_b32 v4, v2
v_add_f32 v4, v4, v2
ds_write_b32 v1, v4 offset:256
s_waitcnt lgkmcnt(0)
s_barrier
ds_read_b32 v4, v5 offset:256
ds_read_b32 v2, v5 offset:320
ds_read_b32 v3, v5 offset:384
ds_read_b32 v6, v5 offset:448
s_waitcnt lgkmcnt(0)
v_add_f32 v4, v4, v2
v_add_f32 v3, v3, v6
v_add_f32 v4, v4, v3
v_mov_b32 v2, 0x3727c5ac
v_fmac_f32 v2, 0x3acccccd, v4
v_rsq_f32 v4, v2
s_nop 0
v_mul_f32 v28, v28, v4
v_mul_f32 v29, v29, v4
v_mul_f32 v30, v30, v4
v_mul_f32 v31, v31, v4
v_mul_f32 v32, v32, v4
v_mul_f32 v33, v33, v4
v_mul_f32 v34, v34, v4
v_mul_f32 v35, v35, v4
v_mul_f32 v36, v36, v4
v_mul_f32 v37, v37, v4
v_mul_f32 v38, v38, v4
v_mul_f32 v39, v39, v4
v_mul_f32 v40, v40, v4
v_mul_f32 v41, v41, v4
v_mul_f32 v42, v42, v4
v_mul_f32 v43, v43, v4
v_mul_f32 v44, v44, v4
v_mul_f32 v45, v45, v4
v_mul_f32 v46, v46, v4
v_mul_f32 v47, v47, v4
v_mul_f32 v48, v48, v4
v_mul_f32 v49, v49, v4
v_mul_f32 v50, v50, v4
v_mul_f32 v51, v51, v4
v_mul_f32 v52, v52, v4
v_mul_f32 v53, v53, v4
v_mul_f32 v54, v54, v4
v_mul_f32 v55, v55, v4
v_mul_f32 v56, v56, v4
v_mul_f32 v57, v57, v4
v_mul_f32 v58, v58, v4
v_mul_f32 v59, v59, v4
v_mul_f32 v60, v60, v4
v_mul_f32 v61, v61, v4
v_mul_f32 v62, v62, v4
v_mul_f32 v63, v63, v4
v_mul_f32 v64, v64, v4
v_mul_f32 v65, v65, v4
v_mul_f32 v66, v66, v4
v_mul_f32 v67, v67, v4
v_cvt_pk_bf16_f32 v8, v28, v29
v_cvt_pk_bf16_f32 v9, v30, v31
v_cvt_pk_bf16_f32 v10, v32, v33
v_cvt_pk_bf16_f32 v11, v34, v35
v_cvt_pk_bf16_f32 v12, v36, v37
v_cvt_pk_bf16_f32 v13, v38, v39
v_cvt_pk_bf16_f32 v14, v40, v41
v_cvt_pk_bf16_f32 v15, v42, v43
v_cvt_pk_bf16_f32 v16, v44, v45
v_cvt_pk_bf16_f32 v17, v46, v47
v_cvt_pk_bf16_f32 v18, v48, v49
v_cvt_pk_bf16_f32 v19, v50, v51
v_cvt_pk_bf16_f32 v20, v52, v53
v_cvt_pk_bf16_f32 v21, v54, v55
v_cvt_pk_bf16_f32 v22, v56, v57
v_cvt_pk_bf16_f32 v23, v58, v59
v_cvt_pk_bf16_f32 v24, v60, v61
v_cvt_pk_bf16_f32 v25, v62, v63
v_cvt_pk_bf16_f32 v26, v64, v65
v_cvt_pk_bf16_f32 v27, v66, v67
v_and_b32 v3, 63, v0
v_lshlrev_b32 v1, 4, v3
s_mul_i32 s17, s2, 20480
s_mul_i32 s18, s16, 5120
s_add_u32 s17, s17, s18
s_add_u32 s17, s17, 84934656
buffer_store_dwordx4 v[8:11], v1, s[4:7], s17 offen offset:0 sc1
buffer_store_dwordx4 v[12:15], v1, s[4:7], s17 offen offset:1024 sc1
buffer_store_dwordx4 v[16:19], v1, s[4:7], s17 offen offset:2048 sc1
buffer_store_dwordx4 v[20:23], v1, s[4:7], s17 offen offset:3072 sc1
s_add_u32 s17, s17, 4096
buffer_store_dwordx4 v[24:27], v1, s[4:7], s17 offen offset:0 sc1
s_endpgm
prep_notln5:
s_sub_u32 s2, s2, 128
s_cmp_ge_u32 s2, 2120
s_cbranch_scc1 prep_exit1
s_load_dwordx2 s[12:13], s[0:1], 96
s_load_dwordx4 s[16:19], s[0:1], 16
s_load_dwordx4 s[20:23], s[0:1], 32
s_load_dwordx4 s[24:27], s[0:1], 64
v_lshrrev_b32 v6, 6, v0
v_and_b32 v1, 63, v0
s_nop 0
v_readfirstlane_b32 s14, v6
v_lshlrev_b32 v5, 4, v1
s_lshl_b32 s15, s2, 2
s_nop 1
s_add_u32 s15, s15, s14
s_add_u32 s28, s15, 7680
s_sub_u32 s29, s15, 800
s_cmp_lt_u32 s15, 800
s_cselect_b32 s15, s28, s29
s_waitcnt lgkmcnt(0)
s_mov_b32 s4, s12
s_mov_b32 s5, s13
s_mov_b32 s6, 0x10000000
s_mov_b32 s7, 0x20000
s_mov_b32 s11, 0x20000
v_and_b32 v2, 15, v1
v_lshrrev_b32 v3, 4, v1
s_cmp_ge_u32 s15, 5760
s_cbranch_scc1 prep_s22
s_mul_hi_u32 s31, s15, 2236963
s_mul_i32 s32, s31, 1920
s_sub_u32 s32, s15, s32
s_mul_hi_u32 s34, s32, 44739243
s_mul_i32 s33, s34, 96
s_sub_u32 s33, s32, s33
s_cmp_eq_u32 s31, 0
s_cselect_b32 s8, s16, s18
s_cselect_b32 s9, s17, s19
s_cmp_eq_u32 s31, 2
s_cselect_b32 s8, s20, s8
s_cselect_b32 s9, s21, s9
s_mov_b32 s10, 7864320
s_mul_i32 s35, s31, 7864320
s_add_u32 s35, s35, 6291456
v_lshrrev_b32 v6, 3, v1
s_lshl_b32 s36, s34, 5
v_add_u32 v6, s36, v6
s_mov_b32 s37, 12288
v_mul_lo_u32 v4, v6, s37
s_lshl_b32 s36, s33, 7
v_and_b32 v6, 7, v1
v_lshl_add_u32 v4, v6, 4, v4
v_add_u32 v4, s36, v4
v_lshrrev_b32 v6, 3, v1
v_mul_u32_u24 v12, 144, v6
v_and_b32 v6, 7, v1
v_lshl_add_u32 v12, v6, 4, v12
s_mul_i32 s36, s14, 4608
s_add_u32 s36, s36, 512
v_add_u32 v12, s36, v12
s_mov_b32 s29, 0
buffer_load_dwordx4 v[16:19], v4, s[8:11], s29 offen
s_mov_b32 s29, 98304
buffer_load_dwordx4 v[20:23], v4, s[8:11], s29 offen
s_mov_b32 s29, 196608
buffer_load_dwordx4 v[24:27], v4, s[8:11], s29 offen
s_mov_b32 s29, 294912
buffer_load_dwordx4 v[28:31], v4, s[8:11], s29 offen
v_bfe_u32 v6, v1, 2, 2
v_lshlrev_b32 v13, 3, v3
v_add_u32 v13, v13, v6
v_mul_u32_u24 v13, 144, v13
v_and_b32 v6, 3, v1
v_lshl_add_u32 v13, v6, 3, v13
v_add_u32 v13, s36, v13
s_waitcnt vmcnt(3)
ds_write_b128 v12, v[16:19] offset:0
s_waitcnt vmcnt(2)
ds_write_b128 v12, v[20:23] offset:1152
s_waitcnt vmcnt(1)
ds_write_b128 v12, v[24:27] offset:2304
s_waitcnt vmcnt(0)
ds_write_b128 v12, v[28:31] offset:3456
s_waitcnt lgkmcnt(0)
ds_read_b64_tr_b16 v[48:49], v13 offset:0
ds_read_b64_tr_b16 v[50:51], v13 offset:576
ds_read_b64_tr_b16 v[52:53], v13 offset:32
ds_read_b64_tr_b16 v[54:55], v13 offset:608
ds_read_b64_tr_b16 v[56:57], v13 offset:64
ds_read_b64_tr_b16 v[58:59], v13 offset:640
ds_read_b64_tr_b16 v[60:61], v13 offset:96
ds_read_b64_tr_b16 v[62:63], v13 offset:672
s_waitcnt lgkmcnt(6)
s_lshl_b32 s30, s33, 2
s_add_u32 s30, s30, 0
s_mul_i32 s30, s30, 20
s_add_u32 s30, s30, s34
s_lshl_b32 s30, s30, 10
s_add_u32 s30, s30, s35
buffer_store_dwordx4 v[48:51], v5, s[4:7], s30 offen sc1
s_waitcnt lgkmcnt(4)
s_lshl_b32 s30, s33, 2
s_add_u32 s30, s30, 1
s_mul_i32 s30, s30, 20
s_add_u32 s30, s30, s34
s_lshl_b32 s30, s30, 10
s_add_u32 s30, s30, s35
buffer_store_dwordx4 v[52:55], v5, s[4:7], s30 offen sc1
s_waitcnt lgkmcnt(2)
s_lshl_b32 s30, s33, 2
s_add_u32 s30, s30, 2
s_mul_i32 s30, s30, 20
s_add_u32 s30, s30, s34
s_lshl_b32 s30, s30, 10
s_add_u32 s30, s30, s35
buffer_store_dwordx4 v[56:59], v5, s[4:7], s30 offen sc1
s_waitcnt lgkmcnt(0)
s_lshl_b32 s30, s33, 2
s_add_u32 s30, s30, 3
s_mul_i32 s30, s30, 20
s_add_u32 s30, s30, s34
s_lshl_b32 s30, s30, 10
s_add_u32 s30, s30, s35
buffer_store_dwordx4 v[60:63], v5, s[4:7], s30 offen sc1
s_branch prep_exit1
prep_s22:
s_sub_u32 s15, s15, 5760
s_cmp_ge_u32 s15, 1920
s_cbranch_scc1 prep_s33
s_mul_hi_u32 s34, s15, 429496730
s_mul_i32 s33, s34, 10
s_sub_u32 s33, s15, s33
s_mov_b32 s8, s22
s_mov_b32 s9, s23
s_mov_b32 s10, 7864320
v_lshrrev_b32 v6, 3, v1
s_lshl_b32 s36, s34, 5
v_add_u32 v6, s36, v6
v_mul_u32_u24 v4, 1280, v6
s_lshl_b32 s36, s33, 7
v_and_b32 v6, 7, v1
v_lshl_add_u32 v4, v6, 4, v4
v_add_u32 v4, s36, v4
v_lshrrev_b32 v6, 3, v1
v_mul_u32_u24 v12, 144, v6
v_and_b32 v6, 7, v1
v_lshl_add_u32 v12, v6, 4, v12
s_mul_i32 s36, s14, 4608
s_add_u32 s36, s36, 512
v_add_u32 v12, s36, v12
s_mov_b32 s29, 0
buffer_load_dwordx4 v[16:19], v4, s[8:11], s29 offen
s_mov_b32 s29, 10240
buffer_load_dwordx4 v[20:23], v4, s[8:11], s29 offen
s_mov_b32 s29, 20480
buffer_load_dwordx4 v[24:27], v4, s[8:11], s29 offen
s_mov_b32 s29, 30720
buffer_load_dwordx4 v[28:31], v4, s[8:11], s29 offen
v_bfe_u32 v6, v1, 2, 2
v_lshlrev_b32 v13, 2, v3
v_add_u32 v13, v13, v6
v_mul_u32_u24 v13, 144, v13
v_and_b32 v6, 3, v1
v_lshl_add_u32 v13, v6, 4, v13
v_add_u32 v13, s36, v13
s_waitcnt vmcnt(3)
ds_write_b128 v12, v[16:19] offset:0
s_waitcnt vmcnt(2)
ds_write_b128 v12, v[20:23] offset:1152
s_waitcnt vmcnt(1)
ds_write_b128 v12, v[24:27] offset:2304
s_waitcnt vmcnt(0)
ds_write_b128 v12, v[28:31] offset:3456
s_waitcnt lgkmcnt(0)
ds_read_b64_tr_b16 v[48:49], v13 offset:0
ds_read_b64_tr_b16 v[50:51], v13 offset:2304
ds_read_b64_tr_b16 v[52:53], v13 offset:8
ds_read_b64_tr_b16 v[54:55], v13 offset:2312
ds_read_b64_tr_b16 v[56:57], v13 offset:64
ds_read_b64_tr_b16 v[58:59], v13 offset:2368
ds_read_b64_tr_b16 v[60:61], v13 offset:72
ds_read_b64_tr_b16 v[62:63], v13 offset:2376
s_waitcnt lgkmcnt(6)
s_lshl_b32 s30, s33, 2
s_add_u32 s30, s30, 0
s_mul_i32 s30, s30, 192
s_add_u32 s30, s30, s34
s_lshl_b32 s30, s30, 10
s_add_u32 s30, s30, 29884416
buffer_store_dwordx4 v[48:51], v5, s[4:7], s30 offen sc1
s_waitcnt lgkmcnt(4)
s_lshl_b32 s30, s33, 2
s_add_u32 s30, s30, 1
s_mul_i32 s30, s30, 192
s_add_u32 s30, s30, s34
s_lshl_b32 s30, s30, 10
s_add_u32 s30, s30, 29884416
buffer_store_dwordx4 v[52:55], v5, s[4:7], s30 offen sc1
s_waitcnt lgkmcnt(2)
s_lshl_b32 s30, s33, 2
s_add_u32 s30, s30, 2
s_mul_i32 s30, s30, 192
s_add_u32 s30, s30, s34
s_lshl_b32 s30, s30, 10
s_add_u32 s30, s30, 29884416
buffer_store_dwordx4 v[56:59], v5, s[4:7], s30 offen sc1
s_waitcnt lgkmcnt(0)
s_lshl_b32 s30, s33, 2
s_add_u32 s30, s30, 3
s_mul_i32 s30, s30, 192
s_add_u32 s30, s30, s34
s_lshl_b32 s30, s30, 10
s_add_u32 s30, s30, 29884416
buffer_store_dwordx4 v[60:63], v5, s[4:7], s30 offen sc1
s_branch prep_exit1
prep_s33:
s_sub_u32 s15, s15, 1920
s_cmp_ge_u32 s15, 600
s_cbranch_scc1 prep_s44
s_mul_hi_u32 s34, s15, 143165577
s_mul_i32 s33, s34, 30
s_sub_u32 s33, s15, s33
s_mov_b32 s8, s24
s_mov_b32 s9, s25
s_mov_b32 s10, 2457600
v_lshrrev_b32 v6, 3, v1
s_lshl_b32 s36, s34, 5
v_add_u32 v6, s36, v6
v_mul_u32_u24 v4, 3840, v6
s_lshl_b32 s36, s33, 7
v_and_b32 v6, 7, v1
v_lshl_add_u32 v4, v6, 4, v4
v_add_u32 v4, s36, v4
v_lshrrev_b32 v6, 3, v1
v_mul_u32_u24 v12, 144, v6
v_and_b32 v6, 7, v1
v_lshl_add_u32 v12, v6, 4, v12
s_mul_i32 s36, s14, 4608
s_add_u32 s36, s36, 512
v_add_u32 v12, s36, v12
s_mov_b32 s29, 0
buffer_load_dwordx4 v[16:19], v4, s[8:11], s29 offen
s_mov_b32 s29, 30720
buffer_load_dwordx4 v[20:23], v4, s[8:11], s29 offen
s_mov_b32 s29, 61440
buffer_load_dwordx4 v[24:27], v4, s[8:11], s29 offen
s_mov_b32 s29, 92160
buffer_load_dwordx4 v[28:31], v4, s[8:11], s29 offen
v_bfe_u32 v6, v1, 2, 2
v_lshlrev_b32 v13, 3, v3
v_add_u32 v13, v13, v6
v_mul_u32_u24 v13, 144, v13
v_and_b32 v6, 3, v1
v_lshl_add_u32 v13, v6, 3, v13
v_add_u32 v13, s36, v13
s_waitcnt vmcnt(3)
ds_write_b128 v12, v[16:19] offset:0
s_waitcnt vmcnt(2)
ds_write_b128 v12, v[20:23] offset:1152
s_waitcnt vmcnt(1)
ds_write_b128 v12, v[24:27] offset:2304
s_waitcnt vmcnt(0)
ds_write_b128 v12, v[28:31] offset:3456
s_waitcnt lgkmcnt(0)
ds_read_b64_tr_b16 v[48:49], v13 offset:0
ds_read_b64_tr_b16 v[50:51], v13 offset:576
ds_read_b64_tr_b16 v[52:53], v13 offset:32
ds_read_b64_tr_b16 v[54:55], v13 offset:608
ds_read_b64_tr_b16 v[56:57], v13 offset:64
ds_read_b64_tr_b16 v[58:59], v13 offset:640
ds_read_b64_tr_b16 v[60:61], v13 offset:96
ds_read_b64_tr_b16 v[62:63], v13 offset:672
s_waitcnt lgkmcnt(6)
s_lshl_b32 s30, s33, 2
s_add_u32 s30, s30, 0
s_mul_i32 s30, s30, 20
s_add_u32 s30, s30, s34
s_lshl_b32 s30, s30, 10
s_add_u32 s30, s30, 87556096
buffer_store_dwordx4 v[48:51], v5, s[4:7], s30 offen sc1
s_waitcnt lgkmcnt(4)
s_lshl_b32 s30, s33, 2
s_add_u32 s30, s30, 1
s_mul_i32 s30, s30, 20
s_add_u32 s30, s30, s34
s_lshl_b32 s30, s30, 10
s_add_u32 s30, s30, 87556096
buffer_store_dwordx4 v[52:55], v5, s[4:7], s30 offen sc1
s_waitcnt lgkmcnt(2)
s_lshl_b32 s30, s33, 2
s_add_u32 s30, s30, 2
s_mul_i32 s30, s30, 20
s_add_u32 s30, s30, s34
s_lshl_b32 s30, s30, 10
s_add_u32 s30, s30, 87556096
buffer_store_dwordx4 v[56:59], v5, s[4:7], s30 offen sc1
s_waitcnt lgkmcnt(0)
s_lshl_b32 s30, s33, 2
s_add_u32 s30, s30, 3
s_mul_i32 s30, s30, 20
s_add_u32 s30, s30, s34
s_lshl_b32 s30, s30, 10
s_add_u32 s30, s30, 87556096
buffer_store_dwordx4 v[60:63], v5, s[4:7], s30 offen sc1
s_branch prep_exit1
prep_s44:
s_sub_u32 s15, s15, 600
s_mul_hi_u32 s34, s15, 429496730
s_mul_i32 s33, s34, 10
s_sub_u32 s33, s15, s33
s_mov_b32 s8, s26
s_mov_b32 s9, s27
s_mov_b32 s10, 819200
v_lshrrev_b32 v6, 3, v1
s_lshl_b32 s36, s34, 5
v_add_u32 v6, s36, v6
v_mul_u32_u24 v4, 1280, v6
s_lshl_b32 s36, s33, 7
v_and_b32 v6, 7, v1
v_lshl_add_u32 v4, v6, 4, v4
v_add_u32 v4, s36, v4
v_lshrrev_b32 v6, 3, v1
v_mul_u32_u24 v12, 144, v6
v_and_b32 v6, 7, v1
v_lshl_add_u32 v12, v6, 4, v12
s_mul_i32 s36, s14, 4608
s_add_u32 s36, s36, 512
v_add_u32 v12, s36, v12
s_mov_b32 s29, 0
buffer_load_dwordx4 v[16:19], v4, s[8:11], s29 offen
s_mov_b32 s29, 10240
buffer_load_dwordx4 v[20:23], v4, s[8:11], s29 offen
s_mov_b32 s29, 20480
buffer_load_dwordx4 v[24:27], v4, s[8:11], s29 offen
s_mov_b32 s29, 30720
buffer_load_dwordx4 v[28:31], v4, s[8:11], s29 offen
v_bfe_u32 v6, v1, 2, 2
v_lshlrev_b32 v13, 3, v3
v_add_u32 v13, v13, v6
v_mul_u32_u24 v13, 144, v13
v_and_b32 v6, 3, v1
v_lshl_add_u32 v13, v6, 4, v13
v_add_u32 v13, s36, v13
s_waitcnt vmcnt(3)
ds_write_b128 v12, v[16:19] offset:0
s_waitcnt vmcnt(2)
ds_write_b128 v12, v[20:23] offset:1152
s_waitcnt vmcnt(1)
ds_write_b128 v12, v[24:27] offset:2304
s_waitcnt vmcnt(0)
ds_write_b128 v12, v[28:31] offset:3456
s_waitcnt lgkmcnt(0)
ds_read_b64_tr_b16 v[48:49], v13 offset:0
ds_read_b64_tr_b16 v[50:51], v13 offset:576
ds_read_b64_tr_b16 v[52:53], v13 offset:8
ds_read_b64_tr_b16 v[54:55], v13 offset:584
ds_read_b64_tr_b16 v[56:57], v13 offset:64
ds_read_b64_tr_b16 v[58:59], v13 offset:640
ds_read_b64_tr_b16 v[60:61], v13 offset:72
ds_read_b64_tr_b16 v[62:63], v13 offset:648
s_waitcnt lgkmcnt(6)
s_lshl_b32 s30, s33, 2
s_add_u32 s30, s30, 0
s_mul_i32 s30, s30, 20
s_add_u32 s30, s30, s34
s_lshl_b32 s30, s30, 10
s_add_u32 s30, s30, 90013696
buffer_store_dwordx4 v[48:51], v5, s[4:7], s30 offen sc1
s_waitcnt lgkmcnt(4)
s_lshl_b32 s30, s33, 2
s_add_u32 s30, s30, 1
s_mul_i32 s30, s30, 20
s_add_u32 s30, s30, s34
s_lshl_b32 s30, s30, 10
s_add_u32 s30, s30, 90013696
buffer_store_dwordx4 v[52:55], v5, s[4:7], s30 offen sc1
s_waitcnt lgkmcnt(2)
s_lshl_b32 s30, s33, 2
s_add_u32 s30, s30, 2
s_mul_i32 s30, s30, 20
s_add_u32 s30, s30, s34
s_lshl_b32 s30, s30, 10
s_add_u32 s30, s30, 90013696
buffer_store_dwordx4 v[56:59], v5, s[4:7], s30 offen sc1
s_waitcnt lgkmcnt(0)
s_lshl_b32 s30, s33, 2
s_add_u32 s30, s30, 3
s_mul_i32 s30, s30, 20
s_add_u32 s30, s30, s34
s_lshl_b32 s30, s30, 10
s_add_u32 s30, s30, 90013696
buffer_store_dwordx4 v[60:63], v5, s[4:7], s30 offen sc1
prep_exit1:
s_endpgm
.globl ln2_kernel
.p2align 8
.type ln2_kernel,@function
ln2_kernel:
s_cmp_ge_u32 s2, 128
s_cbranch_scc1 ln2_exit1
s_load_dwordx2 s[12:13], s[0:1], 96
s_load_dwordx2 s[14:15], s[0:1], 0
v_lshrrev_b32 v2, 6, v0
v_and_b32 v3, 63, v0
s_nop 0
v_readfirstlane_b32 s16, v2
s_waitcnt lgkmcnt(0)
s_mov_b32 s4, s12
s_mov_b32 s5, s13
s_mov_b32 s6, 0x10000000
s_mov_b32 s7, 0x20000
s_mov_b32 s8, s12
s_mov_b32 s9, s13
s_mov_b32 s10, 0x10000000
s_mov_b32 s11, 0x20000
s_mov_b32 s20, 82313216
v_and_b32 v2, 15, v3
v_lshrrev_b32 v4, 4, v3
s_lshl_b32 s17, s2, 4
v_add_u32 v1, s17, v2
v_mul_u32_u24 v1, 1280, v1
v_lshl_add_u32 v1, v4, 4, v1
s_mul_i32 s17, s16, 320
s_add_u32 s20, s20, s17
buffer_load_dwordx4 v[8:11], v1, s[8:11], s20 offen offset:0
buffer_load_dwordx4 v[12:15], v1, s[8:11], s20 offen offset:64
buffer_load_dwordx4 v[16:19], v1, s[8:11], s20 offen offset:128
buffer_load_dwordx4 v[20:23], v1, s[8:11], s20 offen offset:192
buffer_load_dwordx4 v[24:27], v1, s[8:11], s20 offen offset:256
s_sub_u32 s21, 0, s12
s_and_b32 s21, s21, 0x1fffff
s_add_u32 s21, s21, 2097152
v_mov_b32 v68, -1
v_mov_b32 v69, -1
v_mov_b32 v70, -1
v_mov_b32 v71, -1
v_lshlrev_b32 v72, 4, v0
s_mul_i32 s22, s2, 12096
s_add_u32 s22, s22, 0
s_mul_i32 s23, s2, 12288
s_add_u32 s23, s23, s21
buffer_store_dwordx4 v[68:71], v72, s[4:7], s22 offen sc1
s_add_u32 s22, s22, 4096
buffer_store_dwordx4 v[68:71], v72, s[4:7], s22 offen sc1
s_add_u32 s22, s22, 4096
v_mov_b32 v73, 0x80000000
v_cmp_gt_u32 vcc, 244, v0
s_nop 1
v_cndmask_b32 v73, v73, v72, vcc
buffer_store_dwordx4 v[68:71], v73, s[4:7], s22 offen
buffer_store_dwordx4 v[68:71], v72, s[4:7], s23 offen sc1
s_add_u32 s23, s23, 4096
buffer_store_dwordx4 v[68:71], v72, s[4:7], s23 offen sc1
s_add_u32 s23, s23, 4096
buffer_store_dwordx4 v[68:71], v72, s[4:7], s23 offen sc1
s_add_u32 s23, s23, 4096
s_mul_i32 s23, s2, 2048
s_add_u32 s23, s23, s21
s_add_u32 s23, s23, 1572864
v_mov_b32 v73, 0x80000000
v_cmp_gt_u32 vcc, 128, v0
s_nop 1
v_cndmask_b32 v73, v73, v72, vcc
buffer_store_dwordx4 v[68:71], v73, s[4:7], s23 offen sc1
v_lshlrev_b32 v5, 2, v2
s_lshl_b32 s17, s16, 6
v_add_u32 v1, s17, v5
s_waitcnt vmcnt(7)
v_lshlrev_b32 v28, 16, v8
v_and_b32 v29, 0xffff0000, v8
v_lshlrev_b32 v30, 16, v9
v_and_b32 v31, 0xffff0000, v9
v_lshlrev_b32 v32, 16, v10
v_and_b32 v33, 0xffff0000, v10
v_lshlrev_b32 v34, 16, v11
v_and_b32 v35, 0xffff0000, v11
v_lshlrev_b32 v36, 16, v12
v_and_b32 v37, 0xffff0000, v12
v_lshlrev_b32 v38, 16, v13
v_and_b32 v39, 0xffff0000, v13
v_lshlrev_b32 v40, 16, v14
v_and_b32 v41, 0xffff0000, v14
v_lshlrev_b32 v42, 16, v15
v_and_b32 v43, 0xffff0000, v15
v_lshlrev_b32 v44, 16, v16
v_and_b32 v45, 0xffff0000, v16
v_lshlrev_b32 v46, 16, v17
v_and_b32 v47, 0xffff0000, v17
v_lshlrev_b32 v48, 16, v18
v_and_b32 v49, 0xffff0000, v18
v_lshlrev_b32 v50, 16, v19
v_and_b32 v51, 0xffff0000, v19
v_lshlrev_b32 v52, 16, v20
v_and_b32 v53, 0xffff0000, v20
v_lshlrev_b32 v54, 16, v21
v_and_b32 v55, 0xffff0000, v21
v_lshlrev_b32 v56, 16, v22
v_and_b32 v57, 0xffff0000, v22
v_lshlrev_b32 v58, 16, v23
v_and_b32 v59, 0xffff0000, v23
v_lshlrev_b32 v60, 16, v24
v_and_b32 v61, 0xffff0000, v24
v_lshlrev_b32 v62, 16, v25
v_and_b32 v63, 0xffff0000, v25
v_lshlrev_b32 v64, 16, v26
v_and_b32 v65, 0xffff0000, v26
v_lshlrev_b32 v66, 16, v27
v_and_b32 v67, 0xffff0000, v27
v_pk_add_f32 v[6:7], v[28:29], v[30:31]
v_pk_add_f32 v[6:7], v[6:7], v[32:33]
v_pk_add_f32 v[6:7], v[6:7], v[34:35]
v_pk_add_f32 v[6:7], v[6:7], v[36:37]
v_pk_add_f32 v[6:7], v[6:7], v[38:39]
v_pk_add_f32 v[6:7], v[6:7], v[40:41]
v_pk_add_f32 v[6:7], v[6:7], v[42:43]
v_pk_add_f32 v[6:7], v[6:7], v[44:45]
v_pk_add_f32 v[6:7], v[6:7], v[46:47]
v_pk_add_f32 v[6:7], v[6:7], v[48:49]
v_pk_add_f32 v[6:7], v[6:7], v[50:51]
v_pk_add_f32 v[6:7], v[6:7], v[52:53]
v_pk_add_f32 v[6:7], v[6:7], v[54:55]
v_pk_add_f32 v[6:7], v[6:7], v[56:57]
v_pk_add_f32 v[6:7], v[6:7], v[58:59]
v_pk_add_f32 v[6:7], v[6:7], v[60:61]
v_pk_add_f32 v[6:7], v[6:7], v[62:63]
v_pk_add_f32 v[6:7], v[6:7], v[64:65]
v_pk_add_f32 v[6:7], v[6:7], v[66:67]
v_add_f32 v4, v6, v7
v_mov_b32 v2, v4
s_nop 1
v_permlane32_swap_b32 v4, v2
v_add_f32 v4, v4, v2
v_mov_b32 v2, v4
s_nop 1
v_permlane16_swap_b32 v4, v2
v_add_f32 v4, v4, v2
ds_write_b32 v1, v4 offset:0
s_waitcnt lgkmcnt(0)
s_barrier
ds_read_b32 v4, v5 offset:0
ds_read_b32 v2, v5 offset:64
ds_read_b32 v3, v5 offset:128
ds_read_b32 v6, v5 offset:192
s_waitcnt lgkmcnt(0)
v_add_f32 v4, v4, v2
v_add_f32 v3, v3, v6
v_add_f32 v4, v4, v3
v_mul_f32 v4, 0x3acccccd, v4
v_sub_f32 v28, v28, v4
v_sub_f32 v29, v29, v4
v_sub_f32 v30, v30, v4
v_sub_f32 v31, v31, v4
v_sub_f32 v32, v32, v4
v_sub_f32 v33, v33, v4
v_sub_f32 v34, v34, v4
v_sub_f32 v35, v35, v4
v_sub_f32 v36, v36, v4
v_sub_f32 v37, v37, v4
v_sub_f32 v38, v38, v4
v_sub_f32 v39, v39, v4
v_sub_f32 v40, v40, v4
v_sub_f32 v41, v41, v4
v_sub_f32 v42, v42, v4
v_sub_f32 v43, v43, v4
v_sub_f32 v44, v44, v4
v_sub_f32 v45, v45, v4
v_sub_f32 v46, v46, v4
v_sub_f32 v47, v47, v4
v_sub_f32 v48, v48, v4
v_sub_f32 v49, v49, v4
v_sub_f32 v50, v50, v4
v_sub_f32 v51, v51, v4
v_sub_f32 v52, v52, v4
v_sub_f32 v53, v53, v4
v_sub_f32 v54, v54, v4
v_sub_f32 v55, v55, v4
v_sub_f32 v56, v56, v4
v_sub_f32 v57, v57, v4
v_sub_f32 v58, v58, v4
v_sub_f32 v59, v59, v4
v_sub_f32 v60, v60, v4
v_sub_f32 v61, v61, v4
v_sub_f32 v62, v62, v4
v_sub_f32 v63, v63, v4
v_sub_f32 v64, v64, v4
v_sub_f32 v65, v65, v4
v_sub_f32 v66, v66, v4
v_sub_f32 v67, v67, v4
v_mul_f32 v6, v28, v28
v_mul_f32 v7, v29, v29
v_fmac_f32 v6, v30, v30
v_fmac_f32 v7, v31, v31
v_fmac_f32 v6, v32, v32
v_fmac_f32 v7, v33, v33
v_fmac_f32 v6, v34, v34
v_fmac_f32 v7, v35, v35
v_fmac_f32 v6, v36, v36
v_fmac_f32 v7, v37, v37
v_fmac_f32 v6, v38, v38
v_fmac_f32 v7, v39, v39
v_fmac_f32 v6, v40, v40
v_fmac_f32 v7, v41, v41
v_fmac_f32 v6, v42, v42
v_fmac_f32 v7, v43, v43
v_fmac_f32 v6, v44, v44
v_fmac_f32 v7, v45, v45
v_fmac_f32 v6, v46, v46
v_fmac_f32 v7, v47, v47
v_fmac_f32 v6, v48, v48
v_fmac_f32 v7, v49, v49
v_fmac_f32 v6, v50, v50
v_fmac_f32 v7, v51, v51
v_fmac_f32 v6, v52, v52
v_fmac_f32 v7, v53, v53
v_fmac_f32 v6, v54, v54
v_fmac_f32 v7, v55, v55
v_fmac_f32 v6, v56, v56
v_fmac_f32 v7, v57, v57
v_fmac_f32 v6, v58, v58
v_fmac_f32 v7, v59, v59
v_fmac_f32 v6, v60, v60
v_fmac_f32 v7, v61, v61
v_fmac_f32 v6, v62, v62
v_fmac_f32 v7, v63, v63
v_fmac_f32 v6, v64, v64
v_fmac_f32 v7, v65, v65
v_fmac_f32 v6, v66, v66
v_fmac_f32 v7, v67, v67
v_add_f32 v4, v6, v7
v_mov_b32 v2, v4
s_nop 1
v_permlane32_swap_b32 v4, v2
v_add_f32 v4, v4, v2
v_mov_b32 v2, v4
s_nop 1
v_permlane16_swap_b32 v4, v2
v_add_f32 v4, v4, v2
ds_write_b32 v1, v4 offset:256
s_waitcnt lgkmcnt(0)
s_barrier
ds_read_b32 v4, v5 offset:256
ds_read_b32 v2, v5 offset:320
ds_read_b32 v3, v5 offset:384
ds_read_b32 v6, v5 offset:448
s_waitcnt lgkmcnt(0)
v_add_f32 v4, v4, v2
v_add_f32 v3, v3, v6
v_add_f32 v4, v4, v3
v_mov_b32 v2, 0x3727c5ac
v_fmac_f32 v2, 0x3acccccd, v4
v_rsq_f32 v4, v2
s_nop 0
v_mul_f32 v28, v28, v4
v_mul_f32 v29, v29, v4
v_mul_f32 v30, v30, v4
v_mul_f32 v31, v31, v4
v_mul_f32 v32, v32, v4
v_mul_f32 v33, v33, v4
v_mul_f32 v34, v34, v4
v_mul_f32 v35, v35, v4
v_mul_f32 v36, v36, v4
v_mul_f32 v37, v37, v4
v_mul_f32 v38, v38, v4
v_mul_f32 v39, v39, v4
v_mul_f32 v40, v40, v4
v_mul_f32 v41, v41, v4
v_mul_f32 v42, v42, v4
v_mul_f32 v43, v43, v4
v_mul_f32 v44, v44, v4
v_mul_f32 v45, v45, v4
v_mul_f32 v46, v46, v4
v_mul_f32 v47, v47, v4
v_mul_f32 v48, v48, v4
v_mul_f32 v49, v49, v4
v_mul_f32 v50, v50, v4
v_mul_f32 v51, v51, v4
v_mul_f32 v52, v52, v4
v_mul_f32 v53, v53, v4
v_mul_f32 v54, v54, v4
v_mul_f32 v55, v55, v4
v_mul_f32 v56, v56, v4
v_mul_f32 v57, v57, v4
v_mul_f32 v58, v58, v4
v_mul_f32 v59, v59, v4
v_mul_f32 v60, v60, v4
v_mul_f32 v61, v61, v4
v_mul_f32 v62, v62, v4
v_mul_f32 v63, v63, v4
v_mul_f32 v64, v64, v4
v_mul_f32 v65, v65, v4
v_mul_f32 v66, v66, v4
v_mul_f32 v67, v67, v4
v_cvt_pk_bf16_f32 v8, v28, v29
v_cvt_pk_bf16_f32 v9, v30, v31
v_cvt_pk_bf16_f32 v10, v32, v33
v_cvt_pk_bf16_f32 v11, v34, v35
v_cvt_pk_bf16_f32 v12, v36, v37
v_cvt_pk_bf16_f32 v13, v38, v39
v_cvt_pk_bf16_f32 v14, v40, v41
v_cvt_pk_bf16_f32 v15, v42, v43
v_cvt_pk_bf16_f32 v16, v44, v45
v_cvt_pk_bf16_f32 v17, v46, v47
v_cvt_pk_bf16_f32 v18, v48, v49
v_cvt_pk_bf16_f32 v19, v50, v51
v_cvt_pk_bf16_f32 v20, v52, v53
v_cvt_pk_bf16_f32 v21, v54, v55
v_cvt_pk_bf16_f32 v22, v56, v57
v_cvt_pk_bf16_f32 v23, v58, v59
v_cvt_pk_bf16_f32 v24, v60, v61
v_cvt_pk_bf16_f32 v25, v62, v63
v_cvt_pk_bf16_f32 v26, v64, v65
v_cvt_pk_bf16_f32 v27, v66, v67
v_and_b32 v3, 63, v0
v_lshlrev_b32 v1, 4, v3
s_mul_i32 s17, s2, 20480
s_mul_i32 s18, s16, 5120
s_add_u32 s17, s17, s18
s_add_u32 s17, s17, 84934656
buffer_store_dwordx4 v[8:11], v1, s[4:7], s17 offen offset:0 sc1
buffer_store_dwordx4 v[12:15], v1, s[4:7], s17 offen offset:1024 sc1
buffer_store_dwordx4 v[16:19], v1, s[4:7], s17 offen offset:2048 sc1
buffer_store_dwordx4 v[20:23], v1, s[4:7], s17 offen offset:3072 sc1
s_add_u32 s17, s17, 4096
buffer_store_dwordx4 v[24:27], v1, s[4:7], s17 offen offset:0 sc1
ln2_exit1:
s_endpgm
.globl reca_kernel
.p2align 8
.type reca_kernel,@function
reca_kernel:
s_cmp_ge_u32 s2, 256
s_cbranch_scc1 reca_exitb3
s_load_dwordx2 s[48:49], s[0:1], 96
s_load_dwordx2 s[50:51], s[0:1], 88
s_load_dwordx2 s[52:53], s[0:1], 8
s_getreg_b32 s42, hwreg(HW_REG_XCC_ID, 0, 3)
v_lshrrev_b32 v28, 6, v0
v_and_b32 v29, 63, v0
s_and_b32 s13, s2, 7
v_readfirstlane_b32 s12, v28
v_lshlrev_b32 v1, 4, v29
s_lshr_b32 s14, s2, 3
s_mov_b32 s18, 0x100000
s_waitcnt lgkmcnt(0)
s_mov_b32 s57, 0
s_mov_b32 s4, s48
s_mov_b32 s5, s49
s_mov_b32 s6, 0x10000000
s_mov_b32 s7, 0x20000
s_mov_b32 s8, s50
s_mov_b32 s9, s51
s_mov_b32 s10, 256
s_mov_b32 s11, 0x20000
v_add_u32 v2, 0x1000, v1
v_add_u32 v3, 0x2000, v1
v_mov_b32 v31, 0x80000000
s_lshl_b32 s34, s42, 3
s_lshl_b64 s[36:37], 1, s34
s_lshl_b32 s34, s13, 3
v_cmp_eq_u32 vcc, 0, v0
v_mov_b32 v30, s34
s_nop 0
v_cndmask_b32 v30, v31, v30, vcc
v_mov_b32 v44, s36
v_mov_b32 v45, s37
buffer_atomic_add_x2 v[44:45], v30, s[8:11], 0 offen
s_sub_u32 s56, 0, s48
s_and_b32 s56, s56, 0x1fffff
s_add_u32 s56, s56, 2097152
s_nop 0
s_cmp_ge_u32 s14, 24
s_cbranch_scc1 reca_proj2
s_mul_i32 s34, s14, 43
s_lshr_b32 s34, s34, 8
s_mul_i32 s35, s34, 6
s_sub_u32 s16, s14, s35
s_lshl_b32 s15, s13, 2
s_add_u32 s15, s15, s34
s_lshr_b32 s19, s12, 1
s_and_b32 s37, s12, 1
s_mul_i32 s34, s15, 12
s_lshl_b32 s35, s16, 1
s_add_u32 s34, s34, s35
s_add_u32 s34, s34, s37
s_mul_i32 s34, s34, 20480
s_mov_b32 s35, 14155776
s_cmp_eq_u32 s19, 0
s_cselect_b32 s35, 6291456, s35
s_add_u32 s35, s35, s34
s_mul_i32 s36, s19, 10240
s_add_u32 s20, s35, s36
s_sub_u32 s36, 10240, s36
s_add_u32 s21, s35, s36
s_add_u32 s22, s34, 22020096
s_mul_i32 s36, s19, 10240
s_add_u32 s22, s22, s36
buffer_load_dwordx4 a[0:3], v1, s[4:7], s20 offen offset:0
buffer_load_dwordx4 a[4:7], v1, s[4:7], s20 offen offset:1024
buffer_load_dwordx4 a[8:11], v1, s[4:7], s20 offen offset:2048
buffer_load_dwordx4 a[12:15], v1, s[4:7], s20 offen offset:3072
buffer_load_dwordx4 a[16:19], v2, s[4:7], s20 offen offset:0
buffer_load_dwordx4 a[20:23], v2, s[4:7], s20 offen offset:1024
buffer_load_dwordx4 a[24:27], v2, s[4:7], s20 offen offset:2048
buffer_load_dwordx4 a[28:31], v2, s[4:7], s20 offen offset:3072
buffer_load_dwordx4 a[32:35], v3, s[4:7], s20 offen offset:0
buffer_load_dwordx4 a[36:39], v3, s[4:7], s20 offen offset:1024
buffer_load_dwordx4 a[40:43], v1, s[4:7], s21 offen offset:0
buffer_load_dwordx4 a[44:47], v1, s[4:7], s21 offen offset:1024
buffer_load_dwordx4 a[48:51], v1, s[4:7], s21 offen offset:2048
buffer_load_dwordx4 a[52:55], v1, s[4:7], s21 offen offset:3072
buffer_load_dwordx4 a[56:59], v2, s[4:7], s21 offen offset:0
buffer_load_dwordx4 a[60:63], v2, s[4:7], s21 offen offset:1024
buffer_load_dwordx4 a[64:67], v2, s[4:7], s21 offen offset:2048
buffer_load_dwordx4 a[68:71], v2, s[4:7], s21 offen offset:3072
buffer_load_dwordx4 a[72:75], v3, s[4:7], s21 offen offset:0
buffer_load_dwordx4 a[76:79], v3, s[4:7], s21 offen offset:1024
buffer_load_dwordx4 a[80:83], v1, s[4:7], s22 offen offset:0
buffer_load_dwordx4 a[84:87], v1, s[4:7], s22 offen offset:1024
buffer_load_dwordx4 a[88:91], v1, s[4:7], s22 offen offset:2048
buffer_load_dwordx4 a[92:95], v1, s[4:7], s22 offen offset:3072
buffer_load_dwordx4 a[96:99], v2, s[4:7], s22 offen offset:0
buffer_load_dwordx4 a[100:103], v2, s[4:7], s22 offen offset:1024
buffer_load_dwordx4 a[104:107], v2, s[4:7], s22 offen offset:2048
buffer_load_dwordx4 a[108:111], v2, s[4:7], s22 offen offset:3072
buffer_load_dwordx4 a[112:115], v3, s[4:7], s22 offen offset:0
buffer_load_dwordx4 a[116:119], v3, s[4:7], s22 offen offset:1024
s_cmp_ge_u32 s14, 20
s_cbranch_scc1 reca_now24
s_cmp_ge_u32 s12, 2
s_cbranch_scc1 reca_now24
s_lshl_b32 s34, s14, 1
s_add_u32 s34, s34, s12
s_mul_i32 s34, s34, 192
s_mul_i32 s35, s13, 24
s_add_u32 s34, s34, s35
s_lshl_b32 s34, s34, 10
s_add_u32 s34, s34, 29884416
buffer_load_dwordx4 a[120:123], v1, s[4:7], s34 offen offset:0
buffer_load_dwordx4 a[124:127], v1, s[4:7], s34 offen offset:1024
buffer_load_dwordx4 a[128:131], v1, s[4:7], s34 offen offset:2048
buffer_load_dwordx4 a[132:135], v1, s[4:7], s34 offen offset:3072
buffer_load_dwordx4 a[136:139], v2, s[4:7], s34 offen offset:0
buffer_load_dwordx4 a[140:143], v2, s[4:7], s34 offen offset:1024
buffer_load_dwordx4 a[144:147], v2, s[4:7], s34 offen offset:2048
buffer_load_dwordx4 a[148:151], v2, s[4:7], s34 offen offset:3072
buffer_load_dwordx4 a[152:155], v3, s[4:7], s34 offen offset:0
buffer_load_dwordx4 a[156:159], v3, s[4:7], s34 offen offset:1024
buffer_load_dwordx4 a[160:163], v3, s[4:7], s34 offen offset:2048
buffer_load_dwordx4 a[164:167], v3, s[4:7], s34 offen offset:3072
s_add_u32 s34, s34, 12288
buffer_load_dwordx4 a[168:171], v1, s[4:7], s34 offen offset:0
buffer_load_dwordx4 a[172:175], v1, s[4:7], s34 offen offset:1024
buffer_load_dwordx4 a[176:179], v1, s[4:7], s34 offen offset:2048
buffer_load_dwordx4 a[180:183], v1, s[4:7], s34 offen offset:3072
buffer_load_dwordx4 a[184:187], v2, s[4:7], s34 offen offset:0
buffer_load_dwordx4 a[188:191], v2, s[4:7], s34 offen offset:1024
buffer_load_dwordx4 a[192:195], v2, s[4:7], s34 offen offset:2048
buffer_load_dwordx4 a[196:199], v2, s[4:7], s34 offen offset:3072
buffer_load_dwordx4 a[200:203], v3, s[4:7], s34 offen offset:0
buffer_load_dwordx4 a[204:207], v3, s[4:7], s34 offen offset:1024
buffer_load_dwordx4 a[208:211], v3, s[4:7], s34 offen offset:2048
buffer_load_dwordx4 a[212:215], v3, s[4:7], s34 offen offset:3072
reca_now24:
v_and_b32 v29, 63, v0
v_and_b32 v28, 15, v29
v_lshrrev_b32 v30, 4, v29
v_mov_b32 v32, -1
v_mov_b32 v33, -1
v_mov_b32 v34, -1
v_mov_b32 v35, -1
s_mul_i32 s34, s12, 2560
v_add_u32 v4, s34, v1
v_and_b32 v44, 31, v29
v_lshlrev_b32 v44, 4, v44
s_add_u32 s34, s34, 2048
v_add_u32 v5, s34, v44
v_and_b32 v44, 7, v29
v_lshlrev_b32 v44, 4, v44
v_lshl_add_u32 v44, v30, 7, v44
s_mul_i32 s34, s19, 5120
v_add_u32 v6, s34, v44
s_sub_u32 s34, 5120, s34
v_add_u32 v7, s34, v44
v_lshrrev_b32 v45, 3, v28
v_lshl_add_u32 v12, v45, 9, v44
s_mul_i32 s34, s19, 5120
v_add_u32 v236, s34, v12
s_sub_u32 s34, 5120, s34
v_add_u32 v237, s34, v12
v_add_u32 v13, 0x1000, v12
v_add_u32 v14, 0x2000, v12
v_cmp_gt_u32 s[54:55], 8, v28
s_lshl_b32 s34, s16, 10
s_lshl_b32 s35, s19, 7
s_add_u32 s34, s34, s35
s_and_b32 s35, s12, 1
s_lshl_b32 s36, s35, 3
s_add_u32 s34, s34, s36
v_lshlrev_b32 v44, 4, v28
v_lshl_add_u32 v45, v30, 8, v44
v_add_u32 v45, s34, v45
v_cndmask_b32 v8, v31, v45, s[54:55]
v_lshl_add_u32 v44, v30, 7, v44
v_add_u32 v45, s36, v44
v_cndmask_b32 v9, v31, v45, s[54:55]
s_lshl_b32 s34, s14, 9
v_add_u32 v45, s34, v44
v_cndmask_b32 v11, v31, v45, s[54:55]
s_mul_i32 s34, s13, 49152
s_lshr_b32 s35, s14, 3
s_lshl_b32 s35, s35, 14
s_add_u32 s34, s34, s35
s_and_b32 s35, s14, 7
s_lshl_b32 s35, s35, 10
s_add_u32 s34, s34, s35
s_lshl_b32 s35, s12, 9
s_add_u32 s34, s34, s35
v_add_u32 v45, s34, v44
v_cndmask_b32 v15, v31, v45, s[54:55]
s_cmp_lt_u32 s14, 20
s_cselect_b32 s34, 0, 0x80000000
v_or_b32 v15, s34, v15
v_lshlrev_b32 v45, 3, v29
v_cmp_gt_u32 vcc, 32, v29
s_nop 1
v_cndmask_b32 v10, v31, v45, vcc
s_sub_u32 s35, s14, 4
s_cmp_lt_u32 s14, 20
s_cselect_b32 s34, s14, s35
s_lshr_b32 s35, s34, 3
s_lshl_b32 s35, s35, 14
s_and_b32 s34, s34, 7
s_lshl_b32 s34, s34, 10
s_add_u32 s34, s34, s35
v_add_u32 v20, s34, v1
v_add_u32 v21, 49152, v20
v_add_u32 v22, 98304, v20
v_add_u32 v23, 147456, v20
v_add_u32 v24, 196608, v20
v_add_u32 v25, 245760, v20
v_add_u32 v26, 294912, v20
v_add_u32 v27, 344064, v20
v_lshrrev_b32 v44, 3, v29
v_and_b32 v44, 3, v44
v_lshlrev_b32 v44, 7, v44
v_and_b32 v45, 7, v29
v_lshl_add_u32 v44, v45, 4, v44
v_lshrrev_b32 v45, 5, v29
v_lshl_add_u32 v44, v45, 3, v44
s_lshl_b32 s34, s14, 9
s_cmp_lt_u32 s14, 20
s_cselect_b32 s34, s34, 0x80000000
v_add_u32 v16, s34, v44
v_cmp_eq_u32 vcc, 0, v29
v_mov_b32 v45, 0
s_nop 0
v_cndmask_b32 v19, v31, v45, vcc
s_lshl_b32 s34, s15, 8
s_add_u32 s34, s34, 1540096
v_and_b32 v45, 1, v29
v_lshlrev_b32 v45, 7, v45
v_add_u32 v233, s34, v45
s_lshl_b32 s34, s12, 10
s_add_u32 s34, s34, 10240
v_add_u32 v17, s34, v1
v_mov_b32 v36, 0x3f803f80
v_mov_b32 v37, 0x3f803f80
v_mov_b32 v38, 0x3f803f80
v_mov_b32 v39, 0x3f803f80
v_mov_b32 v44, 0xf149f2ca
v_cmp_gt_u32 vcc, 2, v30
s_nop 1
v_cndmask_b32 v40, 0, v44, vcc
v_mov_b32 v41, v40
v_mov_b32 v42, v40
v_mov_b32 v43, v40
v_and_b32 v44, 31, v29
v_lshlrev_b32 v44, 4, v44
v_add_u32 v45, 47972352, v44
v_add_u32 v44, 47185920, v44
v_cmp_gt_u32 vcc, 32, v29
s_nop 1
v_cndmask_b32 v238, v45, v44, vcc
s_mov_b32 s41, 0x3dd53b95
s_mul_i32 s38, s13, 40960
s_add_u32 s38, s38, 0
s_mul_i32 s39, s15, 24576
s_add_u32 s39, s39, 327680
s_mul_i32 s40, s13, 49152
s_add_u32 s40, s40, 1114112
s_mov_b32 s60, s52
s_mov_b32 s61, s53
s_mov_b32 s62, 10240
s_mov_b32 s63, 0x20000
v_and_b32 v29, 63, v0
v_and_b32 v44, 7, v29
v_mul_u32_u24 v44, 1280, v44
v_lshrrev_b32 v45, 3, v29
v_and_b32 v45, 3, v45
v_lshl_add_u32 v44, v45, 4, v44
s_mul_i32 s34, s12, 320
v_add_u32 v44, s34, v44
v_add_u32 v46, 256, v44
v_lshrrev_b32 v45, 5, v29
v_lshl_add_u32 v44, v45, 6, v44
buffer_load_dwordx4 v[128:131], v44, s[60:63], 0 offen
buffer_load_dwordx4 v[132:135], v44, s[60:63], 0 offen offset:128
buffer_load_dwordx4 v[136:139], v46, s[60:63], 0 offen
v_and_b32 v44, 63, v0
v_and_b32 v45, 3, v44
v_lshlrev_b32 v45, 21, v45
v_min_u32 v45, 786368, v45
v_add_u32 v46, 47185920, v45
v_add_u32 v45, 47972352, v45
v_cmp_gt_u32 vcc, 4, v44
s_nop 1
v_cndmask_b32 v46, v45, v46, vcc
s_mul_i32 s34, s15, 98304
v_and_b32 v45, 1, v44
v_mul_u32_u24 v45, 98240, v45
v_add_u32 v45, s34, v45
v_add_u32 v28, 37748736, v45
v_add_u32 v45, 40894464, v45
v_cmp_gt_u32 vcc, 10, v44
s_nop 1
v_cndmask_b32 v45, v45, v28, vcc
v_cmp_gt_u32 vcc, 8, v44
s_nop 1
v_cndmask_b32 v46, v45, v46, vcc
v_cmp_gt_u32 vcc, 12, v44
s_nop 1
v_cndmask_b32 v46, v31, v46, vcc
buffer_load_dword v234, v46, s[4:7], 0 offen
v_and_b32 v44, 63, v0
v_lshlrev_b32 v45, 21, v44
v_min_u32 v45, 25165760, v45
v_add_u32 v45, 57147392, v45
s_lshl_b32 s34, s13, 2
s_add_u32 s34, s34, s14
s_sub_u32 s34, s34, 20
s_and_b32 s34, s34, 31
s_mul_i32 s34, s34, 98304
s_add_u32 s34, s34, 44040192
v_and_b32 v46, 1, v44
v_mul_u32_u24 v46, 98240, v46
v_add_u32 v46, s34, v46
v_cmp_gt_u32 vcc, 13, v44
s_nop 1
v_cndmask_b32 v46, v46, v45, vcc
v_cmp_gt_u32 vcc, 15, v44
s_nop 1
v_cndmask_b32 v46, v31, v46, vcc
buffer_load_dword v235, v46, s[4:7], 0 offen
v_and_b32 v30, 7, v0
v_lshlrev_b32 v30, 3, v30
reca_cens5:
buffer_load_dwordx2 v[28:29], v30, s[8:11], 0 offen sc1
s_waitcnt vmcnt(0)
v_sad_u8 v31, v28, 0, 0
v_sad_u8 v31, v29, 0, v31
v_cmp_gt_u32 vcc, 32, v31
s_cbranch_vccz reca_censok6
s_sleep 8
s_sub_u32 s18, s18, 1
s_cbranch_scc0 reca_cens5
s_mov_b32 s18, 0
reca_censok6:
v_and_b32 v28, 0x20202020, v28
v_and_b32 v29, 0x20202020, v29
v_cmp_ne_u32 s[34:35], 0, v28
v_cmp_ne_u32 s[36:37], 0, v29
s_nop 3
s_and_b32 s34, s34, 0xff
s_and_b32 s36, s36, 0xff
s_or_b32 s35, s34, s36
s_lshr_b32 s37, s35, s13
s_and_b32 s37, s37, 1
s_xor_b32 s43, s37, 1
s_cmp_eq_u32 s57, 0
s_cselect_b32 s58, s36, s34
v_mov_b32 v31, 0x80000000
v_add_u32 v232, 0x2000, v15
s_lshr_b32 s44, s2, 4
s_lshl_b32 s44, s44, 14
s_and_b32 s34, s2, 15
s_lshl_b32 s34, s34, 9
s_add_u32 s44, s44, s34
s_add_u32 s44, s44, 1572864
s_add_u32 s44, s44, s56
s_mov_b32 s45, -1
s_mov_b32 s47, -1
s_cmp_lg_u32 s12, 2
s_cbranch_scc1 reca_noprobe7
s_add_u32 s35, s44, 0
s_memtime s[60:61]
s_waitcnt lgkmcnt(0)
buffer_load_dword v28, v19, s[4:7], s35 offen sc1
s_waitcnt vmcnt(0)
s_memtime s[62:63]
s_waitcnt lgkmcnt(0)
s_sub_u32 s36, s62, s60
s_min_u32 s45, s45, s36
s_add_u32 s35, s44, 8192
s_memtime s[60:61]
s_waitcnt lgkmcnt(0)
buffer_load_dword v28, v19, s[4:7], s35 offen sc1
s_waitcnt vmcnt(0)
s_memtime s[62:63]
s_waitcnt lgkmcnt(0)
s_sub_u32 s36, s62, s60
s_min_u32 s47, s47, s36
s_add_u32 s35, s44, 128
s_memtime s[60:61]
s_waitcnt lgkmcnt(0)
buffer_load_dword v28, v19, s[4:7], s35 offen sc1
s_waitcnt vmcnt(0)
s_memtime s[62:63]
s_waitcnt lgkmcnt(0)
s_sub_u32 s36, s62, s60
s_min_u32 s45, s45, s36
s_add_u32 s35, s44, 8320
s_memtime s[60:61]
s_waitcnt lgkmcnt(0)
buffer_load_dword v28, v19, s[4:7], s35 offen sc1
s_waitcnt vmcnt(0)
s_memtime s[62:63]
s_waitcnt lgkmcnt(0)
s_sub_u32 s36, s62, s60
s_min_u32 s47, s47, s36
s_add_u32 s35, s44, 256
s_memtime s[60:61]
s_waitcnt lgkmcnt(0)
buffer_load_dword v28, v19, s[4:7], s35 offen sc1
s_waitcnt vmcnt(0)
s_memtime s[62:63]
s_waitcnt lgkmcnt(0)
s_sub_u32 s36, s62, s60
s_min_u32 s45, s45, s36
s_add_u32 s35, s44, 8448
s_memtime s[60:61]
s_waitcnt lgkmcnt(0)
buffer_load_dword v28, v19, s[4:7], s35 offen sc1
s_waitcnt vmcnt(0)
s_memtime s[62:63]
s_waitcnt lgkmcnt(0)
s_sub_u32 s36, s62, s60
s_min_u32 s47, s47, s36
s_cmp_lt_u32 s47, s45
s_cbranch_scc0 reca_noprobe7
v_add_u32 v20, 0x2000, v20
v_add_u32 v21, 0x2000, v21
v_add_u32 v22, 0x2000, v22
v_add_u32 v23, 0x2000, v23
v_add_u32 v24, 0x2000, v24
v_add_u32 v25, 0x2000, v25
v_add_u32 v26, 0x2000, v26
v_add_u32 v27, 0x2000, v27
reca_noprobe7:
s_lshl_b32 s59, s13, 2
s_add_u32 s59, s59, s14
s_sub_u32 s59, s59, 20
v_and_b32 v29, 63, v0
v_and_b32 v28, 15, v29
v_lshrrev_b32 v30, 4, v29
v_lshlrev_b32 v92, 4, v28
v_lshl_add_u32 v92, v30, 7, v92
v_cmp_gt_u32 vcc, 8, v28
s_nop 1
v_cndmask_b32 v92, v31, v92, vcc
v_lshlrev_b32 v93, 3, v29
v_cmp_gt_u32 vcc, 32, v29
s_nop 1
v_cndmask_b32 v93, v31, v93, vcc
v_mov_b32 v82, 0xf149f2ca
v_cmp_le_u32 vcc, 2, v30
s_nop 1
v_cndmask_b32 v84, 0, v82, vcc
v_mov_b32 v85, v84
v_mov_b32 v86, v84
v_mov_b32 v87, v84
v_lshlrev_b32 v30, 2, v30
v_add_u32 v29, 0, v30
v_cmp_gt_u32 vcc, v29, v28
s_nop 1
v_cndmask_b32 v88, 0, v82, vcc
v_add_u32 v29, 1, v30
v_cmp_gt_u32 vcc, v29, v28
s_nop 1
v_cndmask_b32 v89, 0, v82, vcc
v_add_u32 v29, 2, v30
v_cmp_gt_u32 vcc, v29, v28
s_nop 1
v_cndmask_b32 v90, 0, v82, vcc
v_add_u32 v29, 3, v30
v_cmp_gt_u32 vcc, v29, v28
s_nop 1
v_cndmask_b32 v91, 0, v82, vcc
s_mov_b32 s17, 0
s_cmp_lg_u32 s12, 3
s_cbranch_scc1 reca_nopf08
s_add_u32 s37, s17, 1
reca_pf9:
buffer_load_dword v28, v233, s[4:7], 0 offen sc1
s_waitcnt vmcnt(0)
v_cmp_gt_i32 vcc, s37, v28
s_cbranch_vccz reca_pfok10
s_sleep 1
s_sub_u32 s18, s18, 1
s_cbranch_scc0 reca_pf9
s_mov_b32 s18, 0
reca_pfok10:
s_lshl_b32 s34, s15, 3
s_and_b32 s35, s17, 7
s_add_u32 s34, s34, s35
s_mul_i32 s34, s34, 12288
s_add_u32 s32, s34, 37748736
s_lshl_b32 s35, s16, 11
s_add_u32 s34, s34, s35
s_add_u32 s33, s34, 40894464
buffer_load_dwordx4 a[120:123], v1, s[4:7], s32 offen offset:0 sc1
buffer_load_dwordx4 a[124:127], v1, s[4:7], s32 offen offset:1024 sc1
buffer_load_dwordx4 a[128:131], v1, s[4:7], s32 offen offset:2048 sc1
buffer_load_dwordx4 a[132:135], v1, s[4:7], s32 offen offset:3072 sc1
buffer_load_dwordx4 a[136:139], v2, s[4:7], s32 offen offset:0 sc1
buffer_load_dwordx4 a[140:143], v2, s[4:7], s32 offen offset:1024 sc1
buffer_load_dwordx4 a[144:147], v2, s[4:7], s32 offen offset:2048 sc1
buffer_load_dwordx4 a[148:151], v2, s[4:7], s32 offen offset:3072 sc1
buffer_load_dwordx4 a[152:155], v3, s[4:7], s32 offen offset:0 sc1
buffer_load_dwordx4 a[156:159], v3, s[4:7], s32 offen offset:1024 sc1
buffer_load_dwordx4 a[160:163], v3, s[4:7], s32 offen offset:2048 sc1
buffer_load_dwordx4 a[164:167], v3, s[4:7], s32 offen offset:3072 sc1
buffer_load_dwordx4 a[168:171], v1, s[4:7], s33 offen offset:0 sc1
buffer_load_dwordx4 a[172:175], v1, s[4:7], s33 offen offset:1024 sc1
s_waitcnt vmcnt(0)
reca_nopf08:
s_cmp_lg_u32 s43, 0
s_cbranch_scc1 reca_slow11
s_cmp_ge_u32 s14, 20
s_cbranch_scc1 reca_twinf12
s_branch reca_gotmem15
reca_step14:
s_and_b32 s34, s17, 3
s_mul_i32 s20, s34, 10240
s_add_u32 s20, s20, s38
s_sleep 2
buffer_load_dwordx4 v[128:131], v4, s[4:7], s20 offen sc1
buffer_load_dwordx4 v[132:135], v4, s[4:7], s20 offen offset:1024 sc1
buffer_load_dwordx4 v[136:139], v5, s[4:7], s20 offen sc1
s_waitcnt vmcnt(2)
v_max_u32 v29, v128, v130
v_cmp_eq_u32 vcc, -1, v29
s_cbranch_vccnz reca_retry17
reca_resume18:
s_waitcnt vmcnt(1)
v_max_u32 v29, v132, v134
v_cmp_eq_u32 vcc, -1, v29
ds_write_b128 v4, v[128:131]
s_cbranch_vccnz reca_retry19
reca_resume20:
s_waitcnt vmcnt(0)
v_max_u32 v29, v136, v138
v_cmp_eq_u32 vcc, -1, v29
ds_write_b128 v4, v[132:135] offset:1024
s_cbranch_vccnz reca_retry21
reca_resume22:
ds_write_b128 v5, v[136:139]
s_branch reca_gotmem216
reca_gotmem15:
ds_write_b128 v4, v[128:131]
ds_write_b128 v4, v[132:135] offset:1024
ds_write_b128 v5, v[136:139]
reca_gotmem216:
s_and_b32 s34, s17, 3
s_mul_i32 s21, s34, 6144
s_add_u32 s21, s21, s39
s_mul_i32 s22, s34, 12288
s_add_u32 s22, s22, s40
s_mul_i32 s25, s34, 393216
s_add_u32 s25, s25, s56
s_add_u32 s35, s17, 1
s_and_b32 s35, s35, 3
s_mul_i32 s24, s35, 10240
s_add_u32 s24, s24, s38
s_waitcnt lgkmcnt(0)
s_barrier
ds_read_b128 v[128:131], v236 offset:0
ds_read_b128 v[132:135], v236 offset:1024
ds_read_b128 v[136:139], v236 offset:2048
ds_read_b128 v[140:143], v236 offset:3072
ds_read_b128 v[144:147], v236 offset:4096
ds_read_b128 v[148:151], v237 offset:0
ds_read_b128 v[152:155], v237 offset:1024
ds_read_b128 v[156:159], v237 offset:2048
ds_read_b128 v[160:163], v237 offset:3072
ds_read_b128 v[164:167], v237 offset:4096
s_waitcnt lgkmcnt(9)
v_mfma_f32_16x16x32_bf16 v[44:47], a[0:3], v[128:131], 0
ds_read_b128 v[168:171], v6 offset:0
v_mfma_f32_16x16x32_bf16 v[240:243], a[4:7], v[128:131], 0
s_waitcnt lgkmcnt(9)
v_mfma_f32_16x16x32_bf16 v[44:47], a[8:11], v[132:135], v[44:47]
ds_read_b128 v[172:175], v6 offset:512
v_mfma_f32_16x16x32_bf16 v[240:243], a[12:15], v[132:135], v[240:243]
s_waitcnt lgkmcnt(9)
v_mfma_f32_16x16x32_bf16 v[44:47], a[16:19], v[136:139], v[44:47]
ds_read_b128 v[176:179], v6 offset:1024
v_mfma_f32_16x16x32_bf16 v[240:243], a[20:23], v[136:139], v[240:243]
s_waitcnt lgkmcnt(9)
v_mfma_f32_16x16x32_bf16 v[44:47], a[24:27], v[140:143], v[44:47]
ds_read_b128 v[180:183], v6 offset:1536
v_mfma_f32_16x16x32_bf16 v[240:243], a[28:31], v[140:143], v[240:243]
s_waitcnt lgkmcnt(9)
v_mfma_f32_16x16x32_bf16 v[44:47], a[32:35], v[144:147], v[44:47]
ds_read_b128 v[184:187], v6 offset:2048
v_mfma_f32_16x16x32_bf16 v[240:243], a[36:39], v[144:147], v[240:243]
s_waitcnt lgkmcnt(9)
v_mfma_f32_16x16x32_bf16 v[44:47], a[40:43], v[148:151], v[44:47]
ds_read_b128 v[188:191], v6 offset:2560
v_mfma_f32_16x16x32_bf16 v[240:243], a[44:47], v[148:151], v[240:243]
s_waitcnt lgkmcnt(9)
v_mfma_f32_16x16x32_bf16 v[44:47], a[48:51], v[152:155], v[44:47]
ds_read_b128 v[192:195], v6 offset:3072
v_mfma_f32_16x16x32_bf16 v[240:243], a[52:55], v[152:155], v[240:243]
s_waitcnt lgkmcnt(9)
v_mfma_f32_16x16x32_bf16 v[44:47], a[56:59], v[156:159], v[44:47]
ds_read_b128 v[196:199], v6 offset:3584
v_mfma_f32_16x16x32_bf16 v[240:243], a[60:63], v[156:159], v[240:243]
s_waitcnt lgkmcnt(9)
v_mfma_f32_16x16x32_bf16 v[44:47], a[64:67], v[160:163], v[44:47]
ds_read_b128 v[200:203], v6 offset:4096
v_mfma_f32_16x16x32_bf16 v[240:243], a[68:71], v[160:163], v[240:243]
s_waitcnt lgkmcnt(9)
v_mfma_f32_16x16x32_bf16 v[44:47], a[72:75], v[164:167], v[44:47]
ds_read_b128 v[204:207], v6 offset:4608
v_mfma_f32_16x16x32_bf16 v[240:243], a[76:79], v[164:167], v[240:243]
s_waitcnt lgkmcnt(9)
v_mfma_f32_16x16x32_bf16 v[48:51], v[168:171], a[80:83], 0
s_and_b32 s34, s17, 7
s_lshl_b32 s34, s34, 5
s_add_u32 s34, s34, s15
s_mul_i32 s34, s34, 3072
s_lshl_b32 s35, s16, 9
s_add_u32 s34, s34, s35
s_add_u32 s30, s34, 47185920
s_add_u32 s31, s34, 47972352
v_add_f32_dpp v44, v240, v44 row_ror:8 row_mask:0xf bank_mask:0xf
v_add_f32_dpp v45, v241, v45 row_ror:8 row_mask:0xf bank_mask:0xf
v_add_f32_dpp v46, v242, v46 row_ror:8 row_mask:0xf bank_mask:0xf
v_add_f32_dpp v47, v243, v47 row_ror:8 row_mask:0xf bank_mask:0xf
v_cvt_pk_bf16_f32 v52, v44, v45
v_cvt_pk_bf16_f32 v53, v46, v47
buffer_store_dwordx2 v[52:53], v8, s[4:7], s21 offen
s_waitcnt lgkmcnt(8)
v_mfma_f32_16x16x32_bf16 v[48:51], v[172:175], a[84:87], v[48:51]
s_waitcnt lgkmcnt(7)
v_mfma_f32_16x16x32_bf16 v[48:51], v[176:179], a[88:91], v[48:51]
s_waitcnt lgkmcnt(6)
v_mfma_f32_16x16x32_bf16 v[48:51], v[180:183], a[92:95], v[48:51]
s_waitcnt lgkmcnt(5)
v_mfma_f32_16x16x32_bf16 v[48:51], v[184:187], a[96:99], v[48:51]
s_waitcnt lgkmcnt(4)
v_mfma_f32_16x16x32_bf16 v[48:51], v[188:191], a[100:103], v[48:51]
s_waitcnt lgkmcnt(3)
v_mfma_f32_16x16x32_bf16 v[48:51], v[192:195], a[104:107], v[48:51]
s_waitcnt lgkmcnt(2)
v_mfma_f32_16x16x32_bf16 v[48:51], v[196:199], a[108:111], v[48:51]
s_waitcnt lgkmcnt(1)
v_mfma_f32_16x16x32_bf16 v[48:51], v[200:203], a[112:115], v[48:51]
s_waitcnt lgkmcnt(0)
v_mfma_f32_16x16x32_bf16 v[48:51], v[204:207], a[116:119], v[48:51]
s_cmp_eq_u32 s12, 3
s_cbranch_scc1 reca_swave23
s_nop 5
ds_write_b128 v17, v[48:51]
s_add_u32 s34, s17, 2
s_and_b32 s34, s34, 3
s_mul_i32 s26, s34, 10240
s_add_u32 s26, s26, s38
s_mul_i32 s27, s34, 6144
s_add_u32 s27, s27, s39
s_mul_i32 s28, s34, 12288
s_add_u32 s28, s28, s40
s_mul_i32 s29, s34, 393216
s_add_u32 s29, s29, s56
s_waitcnt lgkmcnt(0)
s_barrier
s_cmp_eq_u32 s17, 63
s_cbranch_scc1 reca_last25
buffer_store_dwordx2 v[32:33], v8, s[4:7], s27 offen
s_cmp_lg_u32 s12, 2
s_cbranch_scc1 reca_b326
buffer_store_dwordx2 v[52:53], v9, s[4:7], s30 offen
buffer_store_dwordx2 v[32:33], v16, s[4:7], s26 offen
s_cmp_lg_u32 s14, 0
s_cbranch_scc1 reca_b326
v_mov_b32 v28, s17
s_lshl_b32 s34, s13, 7
s_add_u32 s34, s34, 1507328
buffer_store_dword v28, v19, s[4:7], s34 offen
s_branch reca_b326
reca_last25:
s_cmp_lg_u32 s12, 2
s_cbranch_scc1 reca_exit1
buffer_store_dwordx2 v[52:53], v9, s[4:7], s30 offen
s_branch reca_exit1
reca_swave23:
s_cmp_lg_u32 s17, 63
s_cbranch_scc1 reca_vmst29
s_barrier
ds_read_b128 v[56:59], v1 offset:10240
ds_read_b128 v[60:63], v1 offset:11264
ds_read_b128 v[64:67], v1 offset:12288
s_waitcnt lgkmcnt(0)
v_add_f32 v56, v56, v64
v_add_f32 v60, v60, v48
v_add_f32 v57, v57, v65
v_add_f32 v61, v61, v49
v_add_f32 v58, v58, v66
v_add_f32 v62, v62, v50
v_add_f32 v59, v59, v67
v_add_f32 v63, v63, v51
v_cvt_pk_bf16_f32 v68, v56, v57
v_cvt_pk_bf16_f32 v69, v58, v59
v_cvt_pk_bf16_f32 v70, v60, v61
v_cvt_pk_bf16_f32 v71, v62, v63
buffer_store_dwordx2 v[52:53], v9, s[4:7], s30 offen
buffer_store_dwordx2 v[68:69], v10, s[4:7], s31 offen
buffer_store_dwordx2 v[70:71], v10, s[4:7], s31 offen offset:256
s_branch reca_exit1
reca_vmst29:
s_sleep 1
buffer_load_dwordx4 v[208:211], v1, s[4:7], s21 offen offset:0 sc1
buffer_load_dwordx4 v[212:215], v1, s[4:7], s21 offen offset:1024 sc1
buffer_load_dwordx4 v[216:219], v1, s[4:7], s21 offen offset:2048 sc1
buffer_load_dwordx4 v[220:223], v1, s[4:7], s21 offen offset:3072 sc1
buffer_load_dwordx4 v[224:227], v2, s[4:7], s21 offen offset:0 sc1
buffer_load_dwordx4 v[228:231], v2, s[4:7], s21 offen offset:1024 sc1
s_waitcnt vmcnt(5)
v_max_u32 v29, v208, v210
v_cmp_eq_u32 vcc, -1, v29
s_cbranch_vccnz reca_retry30
reca_resume31:
s_waitcnt vmcnt(4)
v_max_u32 v29, v212, v214
v_cmp_eq_u32 vcc, -1, v29
v_mfma_f32_16x16x32_bf16 v[76:79], a[120:123], v[208:211], 0
v_mfma_f32_16x16x32_bf16 v[80:83], a[144:147], v[208:211], 0
v_mfma_f32_16x16x32_bf16 v[72:75], v[208:211], v[208:211], v[40:43]
s_cbranch_vccnz reca_retry32
reca_resume33:
s_waitcnt vmcnt(3)
v_max_u32 v29, v216, v218
v_cmp_eq_u32 vcc, -1, v29
v_mfma_f32_16x16x32_bf16 v[76:79], a[124:127], v[212:215], v[76:79]
v_mfma_f32_16x16x32_bf16 v[80:83], a[148:151], v[212:215], v[80:83]
v_mfma_f32_16x16x32_bf16 v[72:75], v[212:215], v[212:215], v[72:75]
s_cbranch_vccnz reca_retry34
reca_resume35:
s_waitcnt vmcnt(2)
v_max_u32 v29, v220, v222
v_cmp_eq_u32 vcc, -1, v29
v_mfma_f32_16x16x32_bf16 v[76:79], a[128:131], v[216:219], v[76:79]
v_mfma_f32_16x16x32_bf16 v[80:83], a[152:155], v[216:219], v[80:83]
v_mfma_f32_16x16x32_bf16 v[72:75], v[216:219], v[216:219], v[72:75]
s_cbranch_vccnz reca_retry36
reca_resume37:
s_waitcnt vmcnt(1)
v_max_u32 v29, v224, v226
v_cmp_eq_u32 vcc, -1, v29
v_mfma_f32_16x16x32_bf16 v[76:79], a[132:135], v[220:223], v[76:79]
v_mfma_f32_16x16x32_bf16 v[80:83], a[156:159], v[220:223], v[80:83]
v_mfma_f32_16x16x32_bf16 v[72:75], v[220:223], v[220:223], v[72:75]
s_cbranch_vccnz reca_retry38
reca_resume39:
s_waitcnt vmcnt(0)
v_max_u32 v29, v228, v230
v_cmp_eq_u32 vcc, -1, v29
v_mfma_f32_16x16x32_bf16 v[76:79], a[136:139], v[224:227], v[76:79]
v_mfma_f32_16x16x32_bf16 v[80:83], a[160:163], v[224:227], v[80:83]
v_mfma_f32_16x16x32_bf16 v[72:75], v[224:227], v[224:227], v[72:75]
s_cbranch_vccnz reca_retry40
reca_resume41:
v_mfma_f32_16x16x32_bf16 v[76:79], a[140:143], v[228:231], v[76:79]
v_mfma_f32_16x16x32_bf16 v[80:83], a[164:167], v[228:231], v[80:83]
v_mfma_f32_16x16x32_bf16 v[72:75], v[228:231], v[228:231], v[72:75]
s_barrier
ds_read_b128 v[56:59], v1 offset:10240
ds_read_b128 v[60:63], v1 offset:11264
ds_read_b128 v[64:67], v1 offset:12288
s_nop 1
v_max3_f32 v28, v76, v77, v78
v_max3_f32 v29, v80, v81, v82
v_max3_f32 v28, v28, v79, v83
v_max3_f32 v29, v29, v72, v73
v_max3_f32 v28, v28, v74, v75
v_max_f32 v28, v28, v29
v_mov_b32 v29, v28
s_nop 1
v_permlane32_swap_b32 v28, v29
v_max_f32 v28, v28, v29
v_mov_b32 v29, v28
s_nop 1
v_permlane16_swap_b32 v28, v29
v_max_f32 v28, v28, v29
v_mul_f32 v28, s41, v28
v_fma_f32 v76, v76, s41, -v28
v_fma_f32 v77, v77, s41, -v28
v_fma_f32 v78, v78, s41, -v28
v_fma_f32 v79, v79, s41, -v28
v_fma_f32 v80, v80, s41, -v28
v_fma_f32 v81, v81, s41, -v28
v_fma_f32 v82, v82, s41, -v28
v_fma_f32 v83, v83, s41, -v28
v_fma_f32 v72, v72, s41, -v28
v_fma_f32 v73, v73, s41, -v28
v_fma_f32 v74, v74, s41, -v28
v_fma_f32 v75, v75, s41, -v28
v_exp_f32 v76, v76
v_exp_f32 v77, v77
v_exp_f32 v78, v78
v_exp_f32 v79, v79
v_exp_f32 v80, v80
v_exp_f32 v81, v81
v_exp_f32 v82, v82
v_exp_f32 v83, v83
v_cvt_pk_bf16_f32 v84, v76, v77
v_cvt_pk_bf16_f32 v85, v78, v79
v_cvt_pk_bf16_f32 v86, v80, v81
v_cvt_pk_bf16_f32 v87, v82, v83
v_exp_f32 v72, v72
v_exp_f32 v73, v73
v_mfma_f32_16x16x32_bf16 v[100:103], v[36:39], v[84:87], 0
v_exp_f32 v74, v74
v_exp_f32 v75, v75
v_mfma_f32_16x16x32_bf16 v[92:95], a[168:171], v[84:87], 0
v_cvt_pk_bf16_f32 v88, v72, v73
v_cvt_pk_bf16_f32 v89, v74, v75
v_mfma_f32_16x16x32_bf16 v[96:99], a[172:175], v[84:87], 0
s_waitcnt lgkmcnt(0)
v_mfma_f32_16x16x16_bf16 v[100:103], v[36:37], v[88:89], v[100:103]
v_add_f32 v56, v56, v64
v_add_f32 v60, v60, v48
v_add_f32 v57, v57, v65
v_add_f32 v61, v61, v49
v_add_f32 v58, v58, v66
v_add_f32 v62, v62, v50
v_add_f32 v59, v59, v67
v_add_f32 v63, v63, v51
v_cvt_pk_bf16_f32 v68, v56, v57
v_cvt_pk_bf16_f32 v69, v58, v59
v_cvt_pk_bf16_f32 v70, v60, v61
v_cvt_pk_bf16_f32 v71, v62, v63
v_mfma_f32_16x16x16_bf16 v[92:95], v[68:69], v[88:89], v[92:95]
v_rcp_f32 v28, v100
v_mfma_f32_16x16x16_bf16 v[96:99], v[70:71], v[88:89], v[96:99]
v_mov_b32 v29, v28
s_nop 4
v_pk_mul_f32 v[92:93], v[92:93], v[28:29]
v_pk_mul_f32 v[94:95], v[94:95], v[28:29]
v_pk_mul_f32 v[96:97], v[96:97], v[28:29]
v_pk_mul_f32 v[98:99], v[98:99], v[28:29]
v_cvt_pk_bf16_f32 v104, v92, v93
v_cvt_pk_bf16_f32 v105, v94, v95
v_cvt_pk_bf16_f32 v106, v96, v97
v_cvt_pk_bf16_f32 v107, v98, v99
buffer_store_dwordx4 v[104:107], v11, s[4:7], s22 offen
reca_b326:
s_barrier
s_cmp_ge_u32 s12, 2
s_cbranch_scc1 reca_notg242
s_sleep 3
buffer_load_dwordx4 v[128:131], v12, s[4:7], s22 offen offset:0 sc1
buffer_load_dwordx4 v[132:135], v12, s[4:7], s22 offen offset:1024 sc1
buffer_load_dwordx4 v[136:139], v12, s[4:7], s22 offen offset:2048 sc1
buffer_load_dwordx4 v[140:143], v12, s[4:7], s22 offen offset:3072 sc1
buffer_load_dwordx4 v[144:147], v13, s[4:7], s22 offen offset:0 sc1
buffer_load_dwordx4 v[148:151], v13, s[4:7], s22 offen offset:1024 sc1
buffer_load_dwordx4 v[152:155], v13, s[4:7], s22 offen offset:2048 sc1
buffer_load_dwordx4 v[156:159], v13, s[4:7], s22 offen offset:3072 sc1
buffer_load_dwordx4 v[160:163], v14, s[4:7], s22 offen offset:0 sc1
buffer_load_dwordx4 v[164:167], v14, s[4:7], s22 offen offset:1024 sc1
buffer_load_dwordx4 v[168:171], v14, s[4:7], s22 offen offset:2048 sc1
buffer_load_dwordx4 v[172:175], v14, s[4:7], s22 offen offset:3072 sc1
s_waitcnt vmcnt(11)
v_cmp_eq_u32 vcc, -1, v128
s_cbranch_vccnz reca_retry43
reca_resume44:
s_waitcnt vmcnt(10)
v_cmp_eq_u32 vcc, -1, v132
v_mfma_f32_16x16x32_bf16 v[108:111], a[120:123], v[128:131], 0
v_mfma_f32_16x16x32_bf16 v[112:115], a[124:127], v[128:131], 0
s_cbranch_vccnz reca_retry45
reca_resume46:
s_waitcnt vmcnt(9)
v_cmp_eq_u32 vcc, -1, v136
v_mfma_f32_16x16x32_bf16 v[108:111], a[128:131], v[132:135], v[108:111]
v_mfma_f32_16x16x32_bf16 v[112:115], a[132:135], v[132:135], v[112:115]
s_cbranch_vccnz reca_retry47
reca_resume48:
s_waitcnt vmcnt(8)
v_cmp_eq_u32 vcc, -1, v140
v_mfma_f32_16x16x32_bf16 v[108:111], a[136:139], v[136:139], v[108:111]
v_mfma_f32_16x16x32_bf16 v[112:115], a[140:143], v[136:139], v[112:115]
s_cbranch_vccnz reca_retry49
reca_resume50:
s_waitcnt vmcnt(7)
v_cmp_eq_u32 vcc, -1, v144
v_mfma_f32_16x16x32_bf16 v[108:111], a[144:147], v[140:143], v[108:111]
v_mfma_f32_16x16x32_bf16 v[112:115], a[148:151], v[140:143], v[112:115]
s_cbranch_vccnz reca_retry51
reca_resume52:
s_waitcnt vmcnt(6)
v_cmp_eq_u32 vcc, -1, v148
v_mfma_f32_16x16x32_bf16 v[108:111], a[152:155], v[144:147], v[108:111]
v_mfma_f32_16x16x32_bf16 v[112:115], a[156:159], v[144:147], v[112:115]
s_cbranch_vccnz reca_retry53
reca_resume54:
s_waitcnt vmcnt(5)
v_cmp_eq_u32 vcc, -1, v152
v_mfma_f32_16x16x32_bf16 v[108:111], a[160:163], v[148:151], v[108:111]
v_mfma_f32_16x16x32_bf16 v[112:115], a[164:167], v[148:151], v[112:115]
s_cbranch_vccnz reca_retry55
reca_resume56:
s_waitcnt vmcnt(4)
v_cmp_eq_u32 vcc, -1, v156
v_mfma_f32_16x16x32_bf16 v[108:111], a[168:171], v[152:155], v[108:111]
v_mfma_f32_16x16x32_bf16 v[112:115], a[172:175], v[152:155], v[112:115]
s_cbranch_vccnz reca_retry57
reca_resume58:
s_waitcnt vmcnt(3)
v_cmp_eq_u32 vcc, -1, v160
v_mfma_f32_16x16x32_bf16 v[108:111], a[176:179], v[156:159], v[108:111]
v_mfma_f32_16x16x32_bf16 v[112:115], a[180:183], v[156:159], v[112:115]
s_cbranch_vccnz reca_retry59
reca_resume60:
s_waitcnt vmcnt(2)
v_cmp_eq_u32 vcc, -1, v164
v_mfma_f32_16x16x32_bf16 v[108:111], a[184:187], v[160:163], v[108:111]
v_mfma_f32_16x16x32_bf16 v[112:115], a[188:191], v[160:163], v[112:115]
s_cbranch_vccnz reca_retry61
reca_resume62:
s_waitcnt vmcnt(1)
v_cmp_eq_u32 vcc, -1, v168
v_mfma_f32_16x16x32_bf16 v[108:111], a[192:195], v[164:167], v[108:111]
v_mfma_f32_16x16x32_bf16 v[112:115], a[196:199], v[164:167], v[112:115]
s_cbranch_vccnz reca_retry63
reca_resume64:
s_waitcnt vmcnt(0)
v_cmp_eq_u32 vcc, -1, v172
v_mfma_f32_16x16x32_bf16 v[108:111], a[200:203], v[168:171], v[108:111]
v_mfma_f32_16x16x32_bf16 v[112:115], a[204:207], v[168:171], v[112:115]
s_cbranch_vccnz reca_retry65
reca_resume66:
v_mfma_f32_16x16x32_bf16 v[108:111], a[208:211], v[172:175], v[108:111]
v_mfma_f32_16x16x32_bf16 v[112:115], a[212:215], v[172:175], v[112:115]
s_nop 7
v_add_f32_dpp v116, v112, v108 row_ror:8 row_mask:0xf bank_mask:0xf
v_add_f32_dpp v117, v113, v109 row_ror:8 row_mask:0xf bank_mask:0xf
v_add_f32_dpp v118, v114, v110 row_ror:8 row_mask:0xf bank_mask:0xf
v_add_f32_dpp v119, v115, v111 row_ror:8 row_mask:0xf bank_mask:0xf
buffer_store_dwordx4 v[116:119], v15, s[4:7], s25 offen sc1
buffer_store_dwordx4 v[116:119], v232, s[4:7], s25 offen sc1
buffer_store_dwordx4 v[32:35], v15, s[4:7], s29 offen sc1
buffer_store_dwordx4 v[32:35], v232, s[4:7], s29 offen sc1
s_branch reca_b427
reca_notg242:
s_cmp_lg_u32 s12, 3
s_cbranch_scc1 reca_b427
s_add_u32 s34, s17, 2
s_and_b32 s34, s34, 3
s_mul_i32 s26, s34, 10240
s_add_u32 s26, s26, s38
s_mul_i32 s27, s34, 6144
s_add_u32 s27, s27, s39
s_mul_i32 s28, s34, 12288
s_add_u32 s28, s28, s40
s_mul_i32 s29, s34, 393216
s_add_u32 s29, s29, s56
buffer_store_dwordx2 v[32:33], v8, s[4:7], s27 offen
buffer_store_dwordx4 v[32:35], v11, s[4:7], s28 offen
reca_b427:
s_barrier
s_cmp_lg_u32 s12, 2
s_cbranch_scc1 reca_not267
s_sleep 8
buffer_load_dwordx4 v[128:131], v20, s[4:7], s25 offen sc1
buffer_load_dwordx4 v[132:135], v21, s[4:7], s25 offen sc1
buffer_load_dwordx4 v[136:139], v22, s[4:7], s25 offen sc1
buffer_load_dwordx4 v[140:143], v23, s[4:7], s25 offen sc1
buffer_load_dwordx4 v[144:147], v24, s[4:7], s25 offen sc1
buffer_load_dwordx4 v[148:151], v25, s[4:7], s25 offen sc1
buffer_load_dwordx4 v[152:155], v26, s[4:7], s25 offen sc1
buffer_load_dwordx4 v[156:159], v27, s[4:7], s25 offen sc1
s_waitcnt vmcnt(7)
v_cmp_eq_u32 vcc, -1, v128
s_cbranch_vccnz reca_retry68
reca_resume69:
s_waitcnt vmcnt(6)
v_cmp_eq_u32 vcc, -1, v132
s_cbranch_vccnz reca_retry70
reca_resume71:
s_waitcnt vmcnt(5)
v_cmp_eq_u32 vcc, -1, v136
v_pk_add_f32 v[116:117], v[128:129], v[132:133]
v_pk_add_f32 v[118:119], v[130:131], v[134:135]
s_cbranch_vccnz reca_retry72
reca_resume73:
s_waitcnt vmcnt(4)
v_cmp_eq_u32 vcc, -1, v140
v_pk_add_f32 v[116:117], v[116:117], v[136:137]
v_pk_add_f32 v[118:119], v[118:119], v[138:139]
s_cbranch_vccnz reca_retry74
reca_resume75:
s_waitcnt vmcnt(3)
v_cmp_eq_u32 vcc, -1, v144
v_pk_add_f32 v[116:117], v[116:117], v[140:141]
v_pk_add_f32 v[118:119], v[118:119], v[142:143]
s_cbranch_vccnz reca_retry76
reca_resume77:
s_waitcnt vmcnt(2)
v_cmp_eq_u32 vcc, -1, v148
v_pk_add_f32 v[116:117], v[116:117], v[144:145]
v_pk_add_f32 v[118:119], v[118:119], v[146:147]
s_cbranch_vccnz reca_retry78
reca_resume79:
s_waitcnt vmcnt(1)
v_cmp_eq_u32 vcc, -1, v152
v_pk_add_f32 v[116:117], v[116:117], v[148:149]
v_pk_add_f32 v[118:119], v[118:119], v[150:151]
s_cbranch_vccnz reca_retry80
reca_resume81:
s_waitcnt vmcnt(0)
v_cmp_eq_u32 vcc, -1, v156
v_pk_add_f32 v[116:117], v[116:117], v[152:153]
v_pk_add_f32 v[118:119], v[118:119], v[154:155]
s_cbranch_vccnz reca_retry82
reca_resume83:
v_pk_add_f32 v[116:117], v[116:117], v[156:157]
v_pk_add_f32 v[118:119], v[118:119], v[158:159]
v_cvt_pk_bf16_f32 v132, v116, v117
v_cvt_pk_bf16_f32 v133, v118, v119
buffer_store_dwordx2 v[132:133], v16, s[4:7], s24 offen
s_branch reca_b528
reca_not267:
s_cmp_lg_u32 s12, 3
s_cbranch_scc1 reca_b528
s_add_u32 s36, s17, 1
s_cmp_ge_u32 s36, 63
s_cbranch_scc1 reca_nopf84
s_add_u32 s37, s36, 1
reca_pf85:
buffer_load_dword v28, v233, s[4:7], 0 offen sc1
s_waitcnt vmcnt(0)
v_cmp_gt_i32 vcc, s37, v28
s_cbranch_vccz reca_pfok86
s_sleep 1
s_sub_u32 s18, s18, 1
s_cbranch_scc0 reca_pf85
s_mov_b32 s18, 0
reca_pfok86:
s_lshl_b32 s34, s15, 3
s_and_b32 s35, s36, 7
s_add_u32 s34, s34, s35
s_mul_i32 s34, s34, 12288
s_add_u32 s32, s34, 37748736
s_lshl_b32 s35, s16, 11
s_add_u32 s34, s34, s35
s_add_u32 s33, s34, 40894464
buffer_load_dwordx4 a[120:123], v1, s[4:7], s32 offen offset:0 sc1
buffer_load_dwordx4 a[124:127], v1, s[4:7], s32 offen offset:1024 sc1
buffer_load_dwordx4 a[128:131], v1, s[4:7], s32 offen offset:2048 sc1
buffer_load_dwordx4 a[132:135], v1, s[4:7], s32 offen offset:3072 sc1
buffer_load_dwordx4 a[136:139], v2, s[4:7], s32 offen offset:0 sc1
buffer_load_dwordx4 a[140:143], v2, s[4:7], s32 offen offset:1024 sc1
buffer_load_dwordx4 a[144:147], v2, s[4:7], s32 offen offset:2048 sc1
buffer_load_dwordx4 a[148:151], v2, s[4:7], s32 offen offset:3072 sc1
buffer_load_dwordx4 a[152:155], v3, s[4:7], s32 offen offset:0 sc1
buffer_load_dwordx4 a[156:159], v3, s[4:7], s32 offen offset:1024 sc1
buffer_load_dwordx4 a[160:163], v3, s[4:7], s32 offen offset:2048 sc1
buffer_load_dwordx4 a[164:167], v3, s[4:7], s32 offen offset:3072 sc1
buffer_load_dwordx4 a[168:171], v1, s[4:7], s33 offen offset:0 sc1
buffer_load_dwordx4 a[172:175], v1, s[4:7], s33 offen offset:1024 sc1
reca_nopf84:
buffer_store_dwordx2 v[52:53], v9, s[4:7], s30 offen
buffer_store_dwordx2 v[68:69], v10, s[4:7], s31 offen
buffer_store_dwordx2 v[70:71], v10, s[4:7], s31 offen offset:256
reca_b528:
s_barrier
s_add_u32 s17, s17, 1
s_branch reca_step14
reca_retry17:
s_sub_u32 s18, s18, 1
s_cbranch_scc1 reca_retry17_to
buffer_load_dwordx4 v[128:131], v4, s[4:7], s20 offen sc1
buffer_load_dwordx4 v[132:135], v4, s[4:7], s20 offen offset:1024 sc1
buffer_load_dwordx4 v[136:139], v5, s[4:7], s20 offen sc1
s_waitcnt vmcnt(2)
v_max_u32 v29, v128, v130
v_cmp_eq_u32 vcc, -1, v29
s_cbranch_vccnz reca_retry17
s_branch reca_resume18
reca_retry17_to:
s_mov_b32 s18, 0
s_waitcnt vmcnt(0)
s_branch reca_resume18
reca_retry19:
s_sub_u32 s18, s18, 1
s_cbranch_scc1 reca_retry19_to
buffer_load_dwordx4 v[132:135], v4, s[4:7], s20 offen offset:1024 sc1
buffer_load_dwordx4 v[136:139], v5, s[4:7], s20 offen sc1
s_waitcnt vmcnt(1)
v_max_u32 v29, v132, v134
v_cmp_eq_u32 vcc, -1, v29
s_cbranch_vccnz reca_retry19
s_branch reca_resume20
reca_retry19_to:
s_mov_b32 s18, 0
s_waitcnt vmcnt(0)
s_branch reca_resume20
reca_retry21:
s_sub_u32 s18, s18, 1
s_cbranch_scc1 reca_retry21_to
buffer_load_dwordx4 v[136:139], v5, s[4:7], s20 offen sc1
s_waitcnt vmcnt(0)
v_max_u32 v29, v136, v138
v_cmp_eq_u32 vcc, -1, v29
s_cbranch_vccnz reca_retry21
s_branch reca_resume22
reca_retry21_to:
s_mov_b32 s18, 0
s_waitcnt vmcnt(0)
s_branch reca_resume22
reca_retry30:
s_sub_u32 s18, s18, 1
s_cbranch_scc1 reca_retry30_to
buffer_load_dwordx4 v[208:211], v1, s[4:7], s21 offen offset:0 sc1
buffer_load_dwordx4 v[212:215], v1, s[4:7], s21 offen offset:1024 sc1
buffer_load_dwordx4 v[216:219], v1, s[4:7], s21 offen offset:2048 sc1
buffer_load_dwordx4 v[220:223], v1, s[4:7], s21 offen offset:3072 sc1
buffer_load_dwordx4 v[224:227], v2, s[4:7], s21 offen offset:0 sc1
buffer_load_dwordx4 v[228:231], v2, s[4:7], s21 offen offset:1024 sc1
s_waitcnt vmcnt(5)
v_max_u32 v29, v208, v210
v_cmp_eq_u32 vcc, -1, v29
s_cbranch_vccnz reca_retry30
s_branch reca_resume31
reca_retry30_to:
s_mov_b32 s18, 0
s_waitcnt vmcnt(0)
s_branch reca_resume31
reca_retry32:
s_sub_u32 s18, s18, 1
s_cbranch_scc1 reca_retry32_to
buffer_load_dwordx4 v[212:215], v1, s[4:7], s21 offen offset:1024 sc1
buffer_load_dwordx4 v[216:219], v1, s[4:7], s21 offen offset:2048 sc1
buffer_load_dwordx4 v[220:223], v1, s[4:7], s21 offen offset:3072 sc1
buffer_load_dwordx4 v[224:227], v2, s[4:7], s21 offen offset:0 sc1
buffer_load_dwordx4 v[228:231], v2, s[4:7], s21 offen offset:1024 sc1
s_waitcnt vmcnt(4)
v_max_u32 v29, v212, v214
v_cmp_eq_u32 vcc, -1, v29
s_cbranch_vccnz reca_retry32
s_branch reca_resume33
reca_retry32_to:
s_mov_b32 s18, 0
s_waitcnt vmcnt(0)
s_branch reca_resume33
reca_retry34:
s_sub_u32 s18, s18, 1
s_cbranch_scc1 reca_retry34_to
buffer_load_dwordx4 v[216:219], v1, s[4:7], s21 offen offset:2048 sc1
buffer_load_dwordx4 v[220:223], v1, s[4:7], s21 offen offset:3072 sc1
buffer_load_dwordx4 v[224:227], v2, s[4:7], s21 offen offset:0 sc1
buffer_load_dwordx4 v[228:231], v2, s[4:7], s21 offen offset:1024 sc1
s_waitcnt vmcnt(3)
v_max_u32 v29, v216, v218
v_cmp_eq_u32 vcc, -1, v29
s_cbranch_vccnz reca_retry34
s_branch reca_resume35
reca_retry34_to:
s_mov_b32 s18, 0
s_waitcnt vmcnt(0)
s_branch reca_resume35
reca_retry36:
s_sub_u32 s18, s18, 1
s_cbranch_scc1 reca_retry36_to
buffer_load_dwordx4 v[220:223], v1, s[4:7], s21 offen offset:3072 sc1
buffer_load_dwordx4 v[224:227], v2, s[4:7], s21 offen offset:0 sc1
buffer_load_dwordx4 v[228:231], v2, s[4:7], s21 offen offset:1024 sc1
s_waitcnt vmcnt(2)
v_max_u32 v29, v220, v222
v_cmp_eq_u32 vcc, -1, v29
s_cbranch_vccnz reca_retry36
s_branch reca_resume37
reca_retry36_to:
s_mov_b32 s18, 0
s_waitcnt vmcnt(0)
s_branch reca_resume37
reca_retry38:
s_sub_u32 s18, s18, 1
s_cbranch_scc1 reca_retry38_to
buffer_load_dwordx4 v[224:227], v2, s[4:7], s21 offen offset:0 sc1
buffer_load_dwordx4 v[228:231], v2, s[4:7], s21 offen offset:1024 sc1
s_waitcnt vmcnt(1)
v_max_u32 v29, v224, v226
v_cmp_eq_u32 vcc, -1, v29
s_cbranch_vccnz reca_retry38
s_branch reca_resume39
reca_retry38_to:
s_mov_b32 s18, 0
s_waitcnt vmcnt(0)
s_branch reca_resume39
reca_retry40:
s_sub_u32 s18, s18, 1
s_cbranch_scc1 reca_retry40_to
buffer_load_dwordx4 v[228:231], v2, s[4:7], s21 offen offset:1024 sc1
s_waitcnt vmcnt(0)
v_max_u32 v29, v228, v230
v_cmp_eq_u32 vcc, -1, v29
s_cbranch_vccnz reca_retry40
s_branch reca_resume41
reca_retry40_to:
s_mov_b32 s18, 0
s_waitcnt vmcnt(0)
s_branch reca_resume41
reca_retry43:
s_sub_u32 s18, s18, 1
s_cbranch_scc1 reca_retry43_to
buffer_load_dwordx4 v[128:131], v12, s[4:7], s22 offen offset:0 sc1
buffer_load_dwordx4 v[132:135], v12, s[4:7], s22 offen offset:1024 sc1
buffer_load_dwordx4 v[136:139], v12, s[4:7], s22 offen offset:2048 sc1
buffer_load_dwordx4 v[140:143], v12, s[4:7], s22 offen offset:3072 sc1
buffer_load_dwordx4 v[144:147], v13, s[4:7], s22 offen offset:0 sc1
buffer_load_dwordx4 v[148:151], v13, s[4:7], s22 offen offset:1024 sc1
buffer_load_dwordx4 v[152:155], v13, s[4:7], s22 offen offset:2048 sc1
buffer_load_dwordx4 v[156:159], v13, s[4:7], s22 offen offset:3072 sc1
buffer_load_dwordx4 v[160:163], v14, s[4:7], s22 offen offset:0 sc1
buffer_load_dwordx4 v[164:167], v14, s[4:7], s22 offen offset:1024 sc1
buffer_load_dwordx4 v[168:171], v14, s[4:7], s22 offen offset:2048 sc1
buffer_load_dwordx4 v[172:175], v14, s[4:7], s22 offen offset:3072 sc1
s_waitcnt vmcnt(11)
v_cmp_eq_u32 vcc, -1, v128
s_cbranch_vccnz reca_retry43
s_branch reca_resume44
reca_retry43_to:
s_mov_b32 s18, 0
s_waitcnt vmcnt(0)
s_branch reca_resume44
reca_retry45:
s_sub_u32 s18, s18, 1
s_cbranch_scc1 reca_retry45_to
buffer_load_dwordx4 v[132:135], v12, s[4:7], s22 offen offset:1024 sc1
buffer_load_dwordx4 v[136:139], v12, s[4:7], s22 offen offset:2048 sc1
buffer_load_dwordx4 v[140:143], v12, s[4:7], s22 offen offset:3072 sc1
buffer_load_dwordx4 v[144:147], v13, s[4:7], s22 offen offset:0 sc1
buffer_load_dwordx4 v[148:151], v13, s[4:7], s22 offen offset:1024 sc1
buffer_load_dwordx4 v[152:155], v13, s[4:7], s22 offen offset:2048 sc1
buffer_load_dwordx4 v[156:159], v13, s[4:7], s22 offen offset:3072 sc1
buffer_load_dwordx4 v[160:163], v14, s[4:7], s22 offen offset:0 sc1
buffer_load_dwordx4 v[164:167], v14, s[4:7], s22 offen offset:1024 sc1
buffer_load_dwordx4 v[168:171], v14, s[4:7], s22 offen offset:2048 sc1
buffer_load_dwordx4 v[172:175], v14, s[4:7], s22 offen offset:3072 sc1
s_waitcnt vmcnt(10)
v_cmp_eq_u32 vcc, -1, v132
s_cbranch_vccnz reca_retry45
s_branch reca_resume46
reca_retry45_to:
s_mov_b32 s18, 0
s_waitcnt vmcnt(0)
s_branch reca_resume46
reca_retry47:
s_sub_u32 s18, s18, 1
s_cbranch_scc1 reca_retry47_to
buffer_load_dwordx4 v[136:139], v12, s[4:7], s22 offen offset:2048 sc1
buffer_load_dwordx4 v[140:143], v12, s[4:7], s22 offen offset:3072 sc1
buffer_load_dwordx4 v[144:147], v13, s[4:7], s22 offen offset:0 sc1
buffer_load_dwordx4 v[148:151], v13, s[4:7], s22 offen offset:1024 sc1
buffer_load_dwordx4 v[152:155], v13, s[4:7], s22 offen offset:2048 sc1
buffer_load_dwordx4 v[156:159], v13, s[4:7], s22 offen offset:3072 sc1
buffer_load_dwordx4 v[160:163], v14, s[4:7], s22 offen offset:0 sc1
buffer_load_dwordx4 v[164:167], v14, s[4:7], s22 offen offset:1024 sc1
buffer_load_dwordx4 v[168:171], v14, s[4:7], s22 offen offset:2048 sc1
buffer_load_dwordx4 v[172:175], v14, s[4:7], s22 offen offset:3072 sc1
s_waitcnt vmcnt(9)
v_cmp_eq_u32 vcc, -1, v136
s_cbranch_vccnz reca_retry47
s_branch reca_resume48
reca_retry47_to:
s_mov_b32 s18, 0
s_waitcnt vmcnt(0)
s_branch reca_resume48
reca_retry49:
s_sub_u32 s18, s18, 1
s_cbranch_scc1 reca_retry49_to
buffer_load_dwordx4 v[140:143], v12, s[4:7], s22 offen offset:3072 sc1
buffer_load_dwordx4 v[144:147], v13, s[4:7], s22 offen offset:0 sc1
buffer_load_dwordx4 v[148:151], v13, s[4:7], s22 offen offset:1024 sc1
buffer_load_dwordx4 v[152:155], v13, s[4:7], s22 offen offset:2048 sc1
buffer_load_dwordx4 v[156:159], v13, s[4:7], s22 offen offset:3072 sc1
buffer_load_dwordx4 v[160:163], v14, s[4:7], s22 offen offset:0 sc1
buffer_load_dwordx4 v[164:167], v14, s[4:7], s22 offen offset:1024 sc1
buffer_load_dwordx4 v[168:171], v14, s[4:7], s22 offen offset:2048 sc1
buffer_load_dwordx4 v[172:175], v14, s[4:7], s22 offen offset:3072 sc1
s_waitcnt vmcnt(8)
v_cmp_eq_u32 vcc, -1, v140
s_cbranch_vccnz reca_retry49
s_branch reca_resume50
reca_retry49_to:
s_mov_b32 s18, 0
s_waitcnt vmcnt(0)
s_branch reca_resume50
reca_retry51:
s_sub_u32 s18, s18, 1
s_cbranch_scc1 reca_retry51_to
buffer_load_dwordx4 v[144:147], v13, s[4:7], s22 offen offset:0 sc1
buffer_load_dwordx4 v[148:151], v13, s[4:7], s22 offen offset:1024 sc1
buffer_load_dwordx4 v[152:155], v13, s[4:7], s22 offen offset:2048 sc1
buffer_load_dwordx4 v[156:159], v13, s[4:7], s22 offen offset:3072 sc1
buffer_load_dwordx4 v[160:163], v14, s[4:7], s22 offen offset:0 sc1
buffer_load_dwordx4 v[164:167], v14, s[4:7], s22 offen offset:1024 sc1
buffer_load_dwordx4 v[168:171], v14, s[4:7], s22 offen offset:2048 sc1
buffer_load_dwordx4 v[172:175], v14, s[4:7], s22 offen offset:3072 sc1
s_waitcnt vmcnt(7)
v_cmp_eq_u32 vcc, -1, v144
s_cbranch_vccnz reca_retry51
s_branch reca_resume52
reca_retry51_to:
s_mov_b32 s18, 0
s_waitcnt vmcnt(0)
s_branch reca_resume52
reca_retry53:
s_sub_u32 s18, s18, 1
s_cbranch_scc1 reca_retry53_to
buffer_load_dwordx4 v[148:151], v13, s[4:7], s22 offen offset:1024 sc1
buffer_load_dwordx4 v[152:155], v13, s[4:7], s22 offen offset:2048 sc1
buffer_load_dwordx4 v[156:159], v13, s[4:7], s22 offen offset:3072 sc1
buffer_load_dwordx4 v[160:163], v14, s[4:7], s22 offen offset:0 sc1
buffer_load_dwordx4 v[164:167], v14, s[4:7], s22 offen offset:1024 sc1
buffer_load_dwordx4 v[168:171], v14, s[4:7], s22 offen offset:2048 sc1
buffer_load_dwordx4 v[172:175], v14, s[4:7], s22 offen offset:3072 sc1
s_waitcnt vmcnt(6)
v_cmp_eq_u32 vcc, -1, v148
s_cbranch_vccnz reca_retry53
s_branch reca_resume54
reca_retry53_to:
s_mov_b32 s18, 0
s_waitcnt vmcnt(0)
s_branch reca_resume54
reca_retry55:
s_sub_u32 s18, s18, 1
s_cbranch_scc1 reca_retry55_to
buffer_load_dwordx4 v[152:155], v13, s[4:7], s22 offen offset:2048 sc1
buffer_load_dwordx4 v[156:159], v13, s[4:7], s22 offen offset:3072 sc1
buffer_load_dwordx4 v[160:163], v14, s[4:7], s22 offen offset:0 sc1
buffer_load_dwordx4 v[164:167], v14, s[4:7], s22 offen offset:1024 sc1
buffer_load_dwordx4 v[168:171], v14, s[4:7], s22 offen offset:2048 sc1
buffer_load_dwordx4 v[172:175], v14, s[4:7], s22 offen offset:3072 sc1
s_waitcnt vmcnt(5)
v_cmp_eq_u32 vcc, -1, v152
s_cbranch_vccnz reca_retry55
s_branch reca_resume56
reca_retry55_to:
s_mov_b32 s18, 0
s_waitcnt vmcnt(0)
s_branch reca_resume56
reca_retry57:
s_sub_u32 s18, s18, 1
s_cbranch_scc1 reca_retry57_to
buffer_load_dwordx4 v[156:159], v13, s[4:7], s22 offen offset:3072 sc1
buffer_load_dwordx4 v[160:163], v14, s[4:7], s22 offen offset:0 sc1
buffer_load_dwordx4 v[164:167], v14, s[4:7], s22 offen offset:1024 sc1
buffer_load_dwordx4 v[168:171], v14, s[4:7], s22 offen offset:2048 sc1
buffer_load_dwordx4 v[172:175], v14, s[4:7], s22 offen offset:3072 sc1
s_waitcnt vmcnt(4)
v_cmp_eq_u32 vcc, -1, v156
s_cbranch_vccnz reca_retry57
s_branch reca_resume58
reca_retry57_to:
s_mov_b32 s18, 0
s_waitcnt vmcnt(0)
s_branch reca_resume58
reca_retry59:
s_sub_u32 s18, s18, 1
s_cbranch_scc1 reca_retry59_to
buffer_load_dwordx4 v[160:163], v14, s[4:7], s22 offen offset:0 sc1
buffer_load_dwordx4 v[164:167], v14, s[4:7], s22 offen offset:1024 sc1
buffer_load_dwordx4 v[168:171], v14, s[4:7], s22 offen offset:2048 sc1
buffer_load_dwordx4 v[172:175], v14, s[4:7], s22 offen offset:3072 sc1
s_waitcnt vmcnt(3)
v_cmp_eq_u32 vcc, -1, v160
s_cbranch_vccnz reca_retry59
s_branch reca_resume60
reca_retry59_to:
s_mov_b32 s18, 0
s_waitcnt vmcnt(0)
s_branch reca_resume60
reca_retry61:
s_sub_u32 s18, s18, 1
s_cbranch_scc1 reca_retry61_to
buffer_load_dwordx4 v[164:167], v14, s[4:7], s22 offen offset:1024 sc1
buffer_load_dwordx4 v[168:171], v14, s[4:7], s22 offen offset:2048 sc1
buffer_load_dwordx4 v[172:175], v14, s[4:7], s22 offen offset:3072 sc1
s_waitcnt vmcnt(2)
v_cmp_eq_u32 vcc, -1, v164
s_cbranch_vccnz reca_retry61
s_branch reca_resume62
reca_retry61_to:
s_mov_b32 s18, 0
s_waitcnt vmcnt(0)
s_branch reca_resume62
reca_retry63:
s_sub_u32 s18, s18, 1
s_cbranch_scc1 reca_retry63_to
buffer_load_dwordx4 v[168:171], v14, s[4:7], s22 offen offset:2048 sc1
buffer_load_dwordx4 v[172:175], v14, s[4:7], s22 offen offset:3072 sc1
s_waitcnt vmcnt(1)
v_cmp_eq_u32 vcc, -1, v168
s_cbranch_vccnz reca_retry63
s_branch reca_resume64
reca_retry63_to:
s_mov_b32 s18, 0
s_waitcnt vmcnt(0)
s_branch reca_resume64
reca_retry65:
s_sub_u32 s18, s18, 1
s_cbranch_scc1 reca_retry65_to
buffer_load_dwordx4 v[172:175], v14, s[4:7], s22 offen offset:3072 sc1
s_waitcnt vmcnt(0)
v_cmp_eq_u32 vcc, -1, v172
s_cbranch_vccnz reca_retry65
s_branch reca_resume66
reca_retry65_to:
s_mov_b32 s18, 0
s_waitcnt vmcnt(0)
s_branch reca_resume66
reca_retry68:
s_sub_u32 s18, s18, 1
s_cbranch_scc1 reca_retry68_to
buffer_load_dwordx4 v[128:131], v20, s[4:7], s25 offen sc1
buffer_load_dwordx4 v[132:135], v21, s[4:7], s25 offen sc1
buffer_load_dwordx4 v[136:139], v22, s[4:7], s25 offen sc1
buffer_load_dwordx4 v[140:143], v23, s[4:7], s25 offen sc1
buffer_load_dwordx4 v[144:147], v24, s[4:7], s25 offen sc1
buffer_load_dwordx4 v[148:151], v25, s[4:7], s25 offen sc1
buffer_load_dwordx4 v[152:155], v26, s[4:7], s25 offen sc1
buffer_load_dwordx4 v[156:159], v27, s[4:7], s25 offen sc1
s_waitcnt vmcnt(7)
v_cmp_eq_u32 vcc, -1, v128
s_cbranch_vccnz reca_retry68
s_branch reca_resume69
reca_retry68_to:
s_mov_b32 s18, 0
s_waitcnt vmcnt(0)
s_branch reca_resume69
reca_retry70:
s_sub_u32 s18, s18, 1
s_cbranch_scc1 reca_retry70_to
buffer_load_dwordx4 v[132:135], v21, s[4:7], s25 offen sc1
buffer_load_dwordx4 v[136:139], v22, s[4:7], s25 offen sc1
buffer_load_dwordx4 v[140:143], v23, s[4:7], s25 offen sc1
buffer_load_dwordx4 v[144:147], v24, s[4:7], s25 offen sc1
buffer_load_dwordx4 v[148:151], v25, s[4:7], s25 offen sc1
buffer_load_dwordx4 v[152:155], v26, s[4:7], s25 offen sc1
buffer_load_dwordx4 v[156:159], v27, s[4:7], s25 offen sc1
s_waitcnt vmcnt(6)
v_cmp_eq_u32 vcc, -1, v132
s_cbranch_vccnz reca_retry70
s_branch reca_resume71
reca_retry70_to:
s_mov_b32 s18, 0
s_waitcnt vmcnt(0)
s_branch reca_resume71
reca_retry72:
s_sub_u32 s18, s18, 1
s_cbranch_scc1 reca_retry72_to
buffer_load_dwordx4 v[136:139], v22, s[4:7], s25 offen sc1
buffer_load_dwordx4 v[140:143], v23, s[4:7], s25 offen sc1
buffer_load_dwordx4 v[144:147], v24, s[4:7], s25 offen sc1
buffer_load_dwordx4 v[148:151], v25, s[4:7], s25 offen sc1
buffer_load_dwordx4 v[152:155], v26, s[4:7], s25 offen sc1
buffer_load_dwordx4 v[156:159], v27, s[4:7], s25 offen sc1
s_waitcnt vmcnt(5)
v_cmp_eq_u32 vcc, -1, v136
s_cbranch_vccnz reca_retry72
s_branch reca_resume73
reca_retry72_to:
s_mov_b32 s18, 0
s_waitcnt vmcnt(0)
s_branch reca_resume73
reca_retry74:
s_sub_u32 s18, s18, 1
s_cbranch_scc1 reca_retry74_to
buffer_load_dwordx4 v[140:143], v23, s[4:7], s25 offen sc1
buffer_load_dwordx4 v[144:147], v24, s[4:7], s25 offen sc1
buffer_load_dwordx4 v[148:151], v25, s[4:7], s25 offen sc1
buffer_load_dwordx4 v[152:155], v26, s[4:7], s25 offen sc1
buffer_load_dwordx4 v[156:159], v27, s[4:7], s25 offen sc1
s_waitcnt vmcnt(4)
v_cmp_eq_u32 vcc, -1, v140
s_cbranch_vccnz reca_retry74
s_branch reca_resume75
reca_retry74_to:
s_mov_b32 s18, 0
s_waitcnt vmcnt(0)
s_branch reca_resume75
reca_retry76:
s_sub_u32 s18, s18, 1
s_cbranch_scc1 reca_retry76_to
buffer_load_dwordx4 v[144:147], v24, s[4:7], s25 offen sc1
buffer_load_dwordx4 v[148:151], v25, s[4:7], s25 offen sc1
buffer_load_dwordx4 v[152:155], v26, s[4:7], s25 offen sc1
buffer_load_dwordx4 v[156:159], v27, s[4:7], s25 offen sc1
s_waitcnt vmcnt(3)
v_cmp_eq_u32 vcc, -1, v144
s_cbranch_vccnz reca_retry76
s_branch reca_resume77
reca_retry76_to:
s_mov_b32 s18, 0
s_waitcnt vmcnt(0)
s_branch reca_resume77
reca_retry78:
s_sub_u32 s18, s18, 1
s_cbranch_scc1 reca_retry78_to
buffer_load_dwordx4 v[148:151], v25, s[4:7], s25 offen sc1
buffer_load_dwordx4 v[152:155], v26, s[4:7], s25 offen sc1
buffer_load_dwordx4 v[156:159], v27, s[4:7], s25 offen sc1
s_waitcnt vmcnt(2)
v_cmp_eq_u32 vcc, -1, v148
s_cbranch_vccnz reca_retry78
s_branch reca_resume79
reca_retry78_to:
s_mov_b32 s18, 0
s_waitcnt vmcnt(0)
s_branch reca_resume79
reca_retry80:
s_sub_u32 s18, s18, 1
s_cbranch_scc1 reca_retry80_to
buffer_load_dwordx4 v[152:155], v26, s[4:7], s25 offen sc1
buffer_load_dwordx4 v[156:159], v27, s[4:7], s25 offen sc1
s_waitcnt vmcnt(1)
v_cmp_eq_u32 vcc, -1, v152
s_cbranch_vccnz reca_retry80
s_branch reca_resume81
reca_retry80_to:
s_mov_b32 s18, 0
s_waitcnt vmcnt(0)
s_branch reca_resume81
reca_retry82:
s_sub_u32 s18, s18, 1
s_cbranch_scc1 reca_retry82_to
buffer_load_dwordx4 v[156:159], v27, s[4:7], s25 offen sc1
s_waitcnt vmcnt(0)
v_cmp_eq_u32 vcc, -1, v156
s_cbranch_vccnz reca_retry82
s_branch reca_resume83
reca_retry82_to:
s_mov_b32 s18, 0
s_waitcnt vmcnt(0)
s_branch reca_resume83
reca_twinf12:
s_branch reca_gotmem88
reca_step87:
s_and_b32 s34, s17, 3
s_mul_i32 s20, s34, 10240
s_add_u32 s20, s20, s38
s_sleep 5
buffer_load_dwordx4 v[128:131], v4, s[4:7], s20 offen sc1
buffer_load_dwordx4 v[132:135], v4, s[4:7], s20 offen offset:1024 sc1
buffer_load_dwordx4 v[136:139], v5, s[4:7], s20 offen sc1
s_waitcnt vmcnt(2)
v_max_u32 v29, v128, v130
v_cmp_eq_u32 vcc, -1, v29
s_cbranch_vccnz reca_retry90
reca_resume91:
s_waitcnt vmcnt(1)
v_max_u32 v29, v132, v134
v_cmp_eq_u32 vcc, -1, v29
ds_write_b128 v4, v[128:131]
s_cbranch_vccnz reca_retry92
reca_resume93:
s_waitcnt vmcnt(0)
v_max_u32 v29, v136, v138
v_cmp_eq_u32 vcc, -1, v29
ds_write_b128 v4, v[132:135] offset:1024
s_cbranch_vccnz reca_retry94
reca_resume95:
ds_write_b128 v5, v[136:139]
s_branch reca_gotmem289
reca_gotmem88:
ds_write_b128 v4, v[128:131]
ds_write_b128 v4, v[132:135] offset:1024
ds_write_b128 v5, v[136:139]
reca_gotmem289:
s_and_b32 s34, s17, 3
s_mul_i32 s21, s34, 6144
s_add_u32 s21, s21, s39
s_mul_i32 s22, s34, 12288
s_add_u32 s22, s22, s40
s_mul_i32 s25, s34, 393216
s_add_u32 s25, s25, s56
s_add_u32 s35, s17, 1
s_and_b32 s35, s35, 3
s_mul_i32 s24, s35, 10240
s_add_u32 s24, s24, s38
s_waitcnt lgkmcnt(0)
s_barrier
ds_read_b128 v[128:131], v236 offset:0
ds_read_b128 v[132:135], v236 offset:1024
ds_read_b128 v[136:139], v236 offset:2048
ds_read_b128 v[140:143], v236 offset:3072
ds_read_b128 v[144:147], v236 offset:4096
ds_read_b128 v[148:151], v237 offset:0
ds_read_b128 v[152:155], v237 offset:1024
ds_read_b128 v[156:159], v237 offset:2048
ds_read_b128 v[160:163], v237 offset:3072
ds_read_b128 v[164:167], v237 offset:4096
s_waitcnt lgkmcnt(9)
v_mfma_f32_16x16x32_bf16 v[44:47], a[0:3], v[128:131], 0
ds_read_b128 v[168:171], v6 offset:0
v_mfma_f32_16x16x32_bf16 v[240:243], a[4:7], v[128:131], 0
s_waitcnt lgkmcnt(9)
v_mfma_f32_16x16x32_bf16 v[44:47], a[8:11], v[132:135], v[44:47]
ds_read_b128 v[172:175], v6 offset:512
v_mfma_f32_16x16x32_bf16 v[240:243], a[12:15], v[132:135], v[240:243]
s_waitcnt lgkmcnt(9)
v_mfma_f32_16x16x32_bf16 v[44:47], a[16:19], v[136:139], v[44:47]
ds_read_b128 v[176:179], v6 offset:1024
v_mfma_f32_16x16x32_bf16 v[240:243], a[20:23], v[136:139], v[240:243]
s_waitcnt lgkmcnt(9)
v_mfma_f32_16x16x32_bf16 v[44:47], a[24:27], v[140:143], v[44:47]
ds_read_b128 v[180:183], v6 offset:1536
v_mfma_f32_16x16x32_bf16 v[240:243], a[28:31], v[140:143], v[240:243]
s_waitcnt lgkmcnt(9)
v_mfma_f32_16x16x32_bf16 v[44:47], a[32:35], v[144:147], v[44:47]
ds_read_b128 v[184:187], v6 offset:2048
v_mfma_f32_16x16x32_bf16 v[240:243], a[36:39], v[144:147], v[240:243]
s_waitcnt lgkmcnt(9)
v_mfma_f32_16x16x32_bf16 v[44:47], a[40:43], v[148:151], v[44:47]
ds_read_b128 v[188:191], v6 offset:2560
v_mfma_f32_16x16x32_bf16 v[240:243], a[44:47], v[148:151], v[240:243]
s_waitcnt lgkmcnt(9)
v_mfma_f32_16x16x32_bf16 v[44:47], a[48:51], v[152:155], v[44:47]
ds_read_b128 v[192:195], v6 offset:3072
v_mfma_f32_16x16x32_bf16 v[240:243], a[52:55], v[152:155], v[240:243]
s_waitcnt lgkmcnt(9)
v_mfma_f32_16x16x32_bf16 v[44:47], a[56:59], v[156:159], v[44:47]
ds_read_b128 v[196:199], v6 offset:3584
v_mfma_f32_16x16x32_bf16 v[240:243], a[60:63], v[156:159], v[240:243]
s_waitcnt lgkmcnt(9)
v_mfma_f32_16x16x32_bf16 v[44:47], a[64:67], v[160:163], v[44:47]
ds_read_b128 v[200:203], v6 offset:4096
v_mfma_f32_16x16x32_bf16 v[240:243], a[68:71], v[160:163], v[240:243]
s_waitcnt lgkmcnt(9)
v_mfma_f32_16x16x32_bf16 v[44:47], a[72:75], v[164:167], v[44:47]
ds_read_b128 v[204:207], v6 offset:4608
v_mfma_f32_16x16x32_bf16 v[240:243], a[76:79], v[164:167], v[240:243]
s_waitcnt lgkmcnt(9)
v_mfma_f32_16x16x32_bf16 v[48:51], v[168:171], a[80:83], 0
s_and_b32 s34, s17, 7
s_lshl_b32 s34, s34, 5
s_add_u32 s34, s34, s15
s_mul_i32 s34, s34, 3072
s_lshl_b32 s35, s16, 9
s_add_u32 s34, s34, s35
s_add_u32 s30, s34, 47185920
s_add_u32 s31, s34, 47972352
v_add_f32_dpp v44, v240, v44 row_ror:8 row_mask:0xf bank_mask:0xf
v_add_f32_dpp v45, v241, v45 row_ror:8 row_mask:0xf bank_mask:0xf
v_add_f32_dpp v46, v242, v46 row_ror:8 row_mask:0xf bank_mask:0xf
v_add_f32_dpp v47, v243, v47 row_ror:8 row_mask:0xf bank_mask:0xf
v_cvt_pk_bf16_f32 v52, v44, v45
v_cvt_pk_bf16_f32 v53, v46, v47
buffer_store_dwordx2 v[52:53], v8, s[4:7], s21 offen
s_waitcnt lgkmcnt(8)
v_mfma_f32_16x16x32_bf16 v[48:51], v[172:175], a[84:87], v[48:51]
s_waitcnt lgkmcnt(7)
v_mfma_f32_16x16x32_bf16 v[48:51], v[176:179], a[88:91], v[48:51]
s_waitcnt lgkmcnt(6)
v_mfma_f32_16x16x32_bf16 v[48:51], v[180:183], a[92:95], v[48:51]
s_waitcnt lgkmcnt(5)
v_mfma_f32_16x16x32_bf16 v[48:51], v[184:187], a[96:99], v[48:51]
s_waitcnt lgkmcnt(4)
v_mfma_f32_16x16x32_bf16 v[48:51], v[188:191], a[100:103], v[48:51]
s_waitcnt lgkmcnt(3)
v_mfma_f32_16x16x32_bf16 v[48:51], v[192:195], a[104:107], v[48:51]
s_waitcnt lgkmcnt(2)
v_mfma_f32_16x16x32_bf16 v[48:51], v[196:199], a[108:111], v[48:51]
s_waitcnt lgkmcnt(1)
v_mfma_f32_16x16x32_bf16 v[48:51], v[200:203], a[112:115], v[48:51]
s_waitcnt lgkmcnt(0)
v_mfma_f32_16x16x32_bf16 v[48:51], v[204:207], a[116:119], v[48:51]
s_cmp_eq_u32 s12, 3
s_cbranch_scc1 reca_swave96
s_nop 5
ds_write_b128 v17, v[48:51]
s_add_u32 s34, s17, 2
s_and_b32 s34, s34, 3
s_mul_i32 s26, s34, 10240
s_add_u32 s26, s26, s38
s_mul_i32 s27, s34, 6144
s_add_u32 s27, s27, s39
s_mul_i32 s28, s34, 12288
s_add_u32 s28, s28, s40
s_mul_i32 s29, s34, 393216
s_add_u32 s29, s29, s56
s_waitcnt lgkmcnt(0)
s_barrier
s_cmp_eq_u32 s17, 63
s_cbranch_scc1 reca_last98
buffer_store_dwordx2 v[32:33], v8, s[4:7], s27 offen
s_cmp_lg_u32 s12, 2
s_cbranch_scc1 reca_tw1102_n
buffer_store_dwordx2 v[52:53], v9, s[4:7], s30 offen
reca_tw1102_n:
s_barrier
s_cmp_eq_u32 s12, 1
s_cbranch_scc1 reca_tw1102
s_cmp_eq_u32 s12, 2
s_cbranch_scc1 reca_tw2103
s_cmp_lt_u32 s17, 2
s_cbranch_scc1 reca_b5101
s_cmp_gt_u32 s17, 61
s_cbranch_scc1 reca_b5101
s_sub_u32 s36, s17, 2
s_and_b32 s36, s36, 7
s_lshl_b32 s34, s59, 3
s_add_u32 s34, s34, s36
s_mul_i32 s34, s34, 12288
s_add_u32 s23, s34, 37748736
s_add_u32 s60, s34, 44040192
s_lshl_b32 s35, s36, 5
s_add_u32 s35, s35, s59
s_mul_i32 s35, s35, 3072
s_add_u32 s61, s35, 47185920
buffer_load_dwordx4 a[120:123], v1, s[4:7], s23 offen offset:0 sc1
buffer_load_dwordx4 a[124:127], v1, s[4:7], s23 offen offset:1024 sc1
buffer_load_dwordx4 a[128:131], v1, s[4:7], s23 offen offset:2048 sc1
buffer_load_dwordx4 a[132:135], v1, s[4:7], s23 offen offset:3072 sc1
buffer_load_dwordx4 a[136:139], v2, s[4:7], s23 offen offset:0 sc1
buffer_load_dwordx4 a[140:143], v2, s[4:7], s23 offen offset:1024 sc1
buffer_load_dwordx4 a[144:147], v2, s[4:7], s23 offen offset:2048 sc1
buffer_load_dwordx4 a[148:151], v2, s[4:7], s23 offen offset:3072 sc1
buffer_load_dwordx4 a[152:155], v3, s[4:7], s23 offen offset:0 sc1
buffer_load_dwordx4 a[156:159], v3, s[4:7], s23 offen offset:1024 sc1
buffer_load_dwordx4 a[160:163], v3, s[4:7], s23 offen offset:2048 sc1
buffer_load_dwordx4 a[164:167], v3, s[4:7], s23 offen offset:3072 sc1
buffer_load_dwordx4 a[216:219], v92, s[4:7], s61 offen offset:0 sc1
buffer_load_dwordx4 a[220:223], v92, s[4:7], s61 offen offset:512 sc1
buffer_load_dwordx4 a[224:227], v92, s[4:7], s61 offen offset:1024 sc1
buffer_load_dwordx4 a[228:231], v92, s[4:7], s61 offen offset:1536 sc1
buffer_load_dwordx4 a[232:235], v92, s[4:7], s61 offen offset:2048 sc1
buffer_load_dwordx4 a[236:239], v92, s[4:7], s61 offen offset:2560 sc1
buffer_load_dwordx4 a[168:171], v1, s[4:7], s60 offen offset:0 sc1
buffer_load_dwordx4 a[172:175], v1, s[4:7], s60 offen offset:1024 sc1
buffer_load_dwordx4 a[176:179], v1, s[4:7], s60 offen offset:2048 sc1
buffer_load_dwordx4 a[180:183], v1, s[4:7], s60 offen offset:3072 sc1
buffer_load_dwordx4 a[184:187], v2, s[4:7], s60 offen offset:0 sc1
buffer_load_dwordx4 a[188:191], v2, s[4:7], s60 offen offset:1024 sc1
buffer_load_dwordx4 a[192:195], v2, s[4:7], s60 offen offset:2048 sc1
buffer_load_dwordx4 a[196:199], v2, s[4:7], s60 offen offset:3072 sc1
buffer_load_dwordx4 a[200:203], v3, s[4:7], s60 offen offset:0 sc1
buffer_load_dwordx4 a[204:207], v3, s[4:7], s60 offen offset:1024 sc1
buffer_load_dwordx4 a[208:211], v3, s[4:7], s60 offen offset:2048 sc1
buffer_load_dwordx4 a[212:215], v3, s[4:7], s60 offen offset:3072 sc1
s_waitcnt vmcnt(5)
v_mfma_f32_16x16x32_bf16 v[128:131], a[216:219], a[168:171], v[84:87]
v_mfma_f32_16x16x32_bf16 v[132:135], a[120:123], a[168:171], v[88:91]
v_mfma_f32_16x16x32_bf16 v[136:139], a[216:219], a[192:195], v[84:87]
v_mfma_f32_16x16x32_bf16 v[140:143], a[120:123], a[192:195], 0
v_mfma_f32_16x16x32_bf16 v[144:147], a[144:147], a[192:195], v[88:91]
s_waitcnt vmcnt(4)
v_mfma_f32_16x16x32_bf16 v[128:131], a[220:223], a[172:175], v[128:131]
v_mfma_f32_16x16x32_bf16 v[132:135], a[124:127], a[172:175], v[132:135]
v_mfma_f32_16x16x32_bf16 v[136:139], a[220:223], a[196:199], v[136:139]
v_mfma_f32_16x16x32_bf16 v[140:143], a[124:127], a[196:199], v[140:143]
v_mfma_f32_16x16x32_bf16 v[144:147], a[148:151], a[196:199], v[144:147]
s_waitcnt vmcnt(3)
v_mfma_f32_16x16x32_bf16 v[128:131], a[224:227], a[176:179], v[128:131]
v_mfma_f32_16x16x32_bf16 v[132:135], a[128:131], a[176:179], v[132:135]
v_mfma_f32_16x16x32_bf16 v[136:139], a[224:227], a[200:203], v[136:139]
v_mfma_f32_16x16x32_bf16 v[140:143], a[128:131], a[200:203], v[140:143]
v_mfma_f32_16x16x32_bf16 v[144:147], a[152:155], a[200:203], v[144:147]
s_waitcnt vmcnt(2)
v_mfma_f32_16x16x32_bf16 v[128:131], a[228:231], a[180:183], v[128:131]
v_mfma_f32_16x16x32_bf16 v[132:135], a[132:135], a[180:183], v[132:135]
v_mfma_f32_16x16x32_bf16 v[136:139], a[228:231], a[204:207], v[136:139]
v_mfma_f32_16x16x32_bf16 v[140:143], a[132:135], a[204:207], v[140:143]
v_mfma_f32_16x16x32_bf16 v[144:147], a[156:159], a[204:207], v[144:147]
s_waitcnt vmcnt(1)
v_mfma_f32_16x16x32_bf16 v[128:131], a[232:235], a[184:187], v[128:131]
v_mfma_f32_16x16x32_bf16 v[132:135], a[136:139], a[184:187], v[132:135]
v_mfma_f32_16x16x32_bf16 v[136:139], a[232:235], a[208:211], v[136:139]
v_mfma_f32_16x16x32_bf16 v[140:143], a[136:139], a[208:211], v[140:143]
v_mfma_f32_16x16x32_bf16 v[144:147], a[160:163], a[208:211], v[144:147]
s_waitcnt vmcnt(0)
v_mfma_f32_16x16x32_bf16 v[128:131], a[236:239], a[188:191], v[128:131]
v_mfma_f32_16x16x32_bf16 v[132:135], a[140:143], a[188:191], v[132:135]
v_mfma_f32_16x16x32_bf16 v[136:139], a[236:239], a[212:215], v[136:139]
v_mfma_f32_16x16x32_bf16 v[140:143], a[140:143], a[212:215], v[140:143]
v_mfma_f32_16x16x32_bf16 v[144:147], a[164:167], a[212:215], v[144:147]
s_nop 3
v_max3_f32 v28, v128, v129, v130
v_max3_f32 v28, v28, v131, v132
v_max3_f32 v28, v28, v133, v134
v_max_f32 v28, v28, v135
v_mov_b32 v29, v28
s_nop 1
v_permlane32_swap_b32 v28, v29
v_max_f32 v28, v28, v29
v_mov_b32 v29, v28
s_nop 1
v_permlane16_swap_b32 v28, v29
v_max_f32 v28, v28, v29
v_mul_f32 v28, s41, v28
v_fma_f32 v128, v128, s41, -v28
v_fma_f32 v129, v129, s41, -v28
v_fma_f32 v130, v130, s41, -v28
v_fma_f32 v131, v131, s41, -v28
v_fma_f32 v132, v132, s41, -v28
v_fma_f32 v133, v133, s41, -v28
v_fma_f32 v134, v134, s41, -v28
v_fma_f32 v135, v135, s41, -v28
v_exp_f32 v128, v128
v_exp_f32 v129, v129
v_exp_f32 v130, v130
v_exp_f32 v131, v131
v_exp_f32 v132, v132
v_exp_f32 v133, v133
v_exp_f32 v134, v134
v_exp_f32 v135, v135
v_max3_f32 v30, v136, v137, v138
v_max3_f32 v30, v30, v139, v140
v_max3_f32 v30, v30, v141, v142
v_max3_f32 v30, v30, v143, v144
v_max3_f32 v30, v30, v145, v146
v_max_f32 v30, v30, v147
v_mov_b32 v29, v30
s_nop 1
v_permlane32_swap_b32 v30, v29
v_max_f32 v30, v30, v29
v_mov_b32 v29, v30
s_nop 1
v_permlane16_swap_b32 v30, v29
v_max_f32 v30, v30, v29
v_mul_f32 v30, s41, v30
v_fma_f32 v136, v136, s41, -v30
v_fma_f32 v137, v137, s41, -v30
v_fma_f32 v138, v138, s41, -v30
v_fma_f32 v139, v139, s41, -v30
v_fma_f32 v140, v140, s41, -v30
v_fma_f32 v141, v141, s41, -v30
v_fma_f32 v142, v142, s41, -v30
v_fma_f32 v143, v143, s41, -v30
v_fma_f32 v144, v144, s41, -v30
v_fma_f32 v145, v145, s41, -v30
v_fma_f32 v146, v146, s41, -v30
v_fma_f32 v147, v147, s41, -v30
v_exp_f32 v136, v136
v_exp_f32 v137, v137
v_exp_f32 v138, v138
v_exp_f32 v139, v139
v_exp_f32 v140, v140
v_exp_f32 v141, v141
v_exp_f32 v142, v142
v_exp_f32 v143, v143
v_exp_f32 v144, v144
v_exp_f32 v145, v145
v_exp_f32 v146, v146
v_exp_f32 v147, v147
v_cvt_pk_bf16_f32 v72, v128, v129
v_cvt_pk_bf16_f32 v73, v130, v131
v_cvt_pk_bf16_f32 v74, v132, v133
v_cvt_pk_bf16_f32 v75, v134, v135
v_cvt_pk_bf16_f32 v76, v136, v137
v_cvt_pk_bf16_f32 v77, v138, v139
v_cvt_pk_bf16_f32 v78, v140, v141
v_cvt_pk_bf16_f32 v79, v142, v143
v_cvt_pk_bf16_f32 v80, v144, v145
v_cvt_pk_bf16_f32 v81, v146, v147
v_mfma_f32_16x16x16_bf16 v[148:151], v[36:37], v[72:73], 0
v_mfma_f32_16x16x16_bf16 v[152:155], v[36:37], v[76:77], 0
v_mfma_f32_16x16x16_bf16 v[148:151], v[36:37], v[74:75], v[148:151]
v_mfma_f32_16x16x32_bf16 v[152:155], v[36:39], v[78:81], v[152:155]
s_nop 6
v_rcp_f32 v82, v148
v_rcp_f32 v83, v152
s_and_b32 s34, s17, 1
s_mul_i32 s34, s34, 3072
v_add_u32 v28, s34, v1
ds_write_b128 v28, v[72:75] offset:16384
ds_write_b128 v28, v[76:79] offset:17408
ds_write_b128 v28, v[80:83] offset:18432
s_waitcnt lgkmcnt(0)
s_branch reca_b5101
reca_tw1102:
s_cmp_lt_u32 s17, 3
s_cbranch_scc1 reca_b5101
s_sub_u32 s36, s17, 3
s_and_b32 s37, s36, 7
s_lshl_b32 s34, s59, 3
s_add_u32 s34, s34, s37
s_mul_i32 s34, s34, 12288
s_add_u32 s23, s34, 40894464
s_lshl_b32 s35, s37, 5
s_add_u32 s35, s35, s59
s_mul_i32 s35, s35, 3072
s_add_u32 s61, s35, 47972352
s_mul_i32 s34, s36, 393216
s_mul_i32 s35, s59, 6144
s_add_u32 s34, s34, s35
s_add_u32 s60, s34, 57147392
s_add_u32 s34, s17, 1
s_and_b32 s34, s34, 1
s_mul_i32 s34, s34, 3072
v_add_u32 v28, s34, v1
ds_read_b128 v[72:75], v28 offset:16384
ds_read_b128 v[76:79], v28 offset:17408
ds_read_b128 v[80:83], v28 offset:18432
buffer_load_dwordx2 a[168:169], v93, s[4:7], s61 offen offset:0 sc1
buffer_load_dwordx4 a[120:123], v1, s[4:7], s23 offen offset:0 sc1
buffer_load_dwordx2 a[170:171], v93, s[4:7], s61 offen offset:256 sc1
buffer_load_dwordx4 a[124:127], v1, s[4:7], s23 offen offset:1024 sc1
buffer_load_dwordx2 a[172:173], v93, s[4:7], s61 offen offset:512 sc1
buffer_load_dwordx4 a[128:131], v1, s[4:7], s23 offen offset:2048 sc1
buffer_load_dwordx2 a[174:175], v93, s[4:7], s61 offen offset:768 sc1
buffer_load_dwordx4 a[132:135], v1, s[4:7], s23 offen offset:3072 sc1
buffer_load_dwordx2 a[176:177], v93, s[4:7], s61 offen offset:1024 sc1
buffer_load_dwordx4 a[136:139], v2, s[4:7], s23 offen offset:0 sc1
buffer_load_dwordx2 a[178:179], v93, s[4:7], s61 offen offset:1280 sc1
buffer_load_dwordx4 a[140:143], v2, s[4:7], s23 offen offset:1024 sc1
s_waitcnt lgkmcnt(0)
s_waitcnt vmcnt(8)
v_mfma_f32_16x16x16_bf16 v[156:159], a[168:169], v[72:73], 0
v_mfma_f32_16x16x16_bf16 v[160:163], a[168:169], v[76:77], 0
v_mfma_f32_16x16x16_bf16 v[156:159], a[120:121], v[74:75], v[156:159]
v_mfma_f32_16x16x32_bf16 v[160:163], a[120:123], v[78:81], v[160:163]
v_mfma_f32_16x16x16_bf16 v[164:167], a[170:171], v[72:73], 0
v_mfma_f32_16x16x16_bf16 v[168:171], a[170:171], v[76:77], 0
v_mfma_f32_16x16x16_bf16 v[164:167], a[124:125], v[74:75], v[164:167]
v_mfma_f32_16x16x32_bf16 v[168:171], a[124:127], v[78:81], v[168:171]
s_nop 2
v_mul_f32 v156, v156, v82
v_mul_f32 v157, v157, v82
v_mul_f32 v158, v158, v82
v_mul_f32 v159, v159, v82
v_cvt_pk_bf16_f32 v172, v156, v157
v_cvt_pk_bf16_f32 v173, v158, v159
v_mul_f32 v164, v164, v82
v_mul_f32 v165, v165, v82
v_mul_f32 v166, v166, v82
v_mul_f32 v167, v167, v82
v_cvt_pk_bf16_f32 v174, v164, v165
v_cvt_pk_bf16_f32 v175, v166, v167
buffer_store_dwordx4 v[172:175], v1, s[4:7], s60 offen offset:0 sc1
v_mul_f32 v160, v160, v83
v_mul_f32 v161, v161, v83
v_mul_f32 v162, v162, v83
v_mul_f32 v163, v163, v83
v_cvt_pk_bf16_f32 v176, v160, v161
v_cvt_pk_bf16_f32 v177, v162, v163
v_mul_f32 v168, v168, v83
v_mul_f32 v169, v169, v83
v_mul_f32 v170, v170, v83
v_mul_f32 v171, v171, v83
v_cvt_pk_bf16_f32 v178, v168, v169
v_cvt_pk_bf16_f32 v179, v170, v171
s_add_u32 s34, s60, 196608
buffer_store_dwordx4 v[176:179], v1, s[4:7], s34 offen offset:0 sc1
s_waitcnt vmcnt(6)
v_mfma_f32_16x16x16_bf16 v[156:159], a[172:173], v[72:73], 0
v_mfma_f32_16x16x16_bf16 v[160:163], a[172:173], v[76:77], 0
v_mfma_f32_16x16x16_bf16 v[156:159], a[128:129], v[74:75], v[156:159]
v_mfma_f32_16x16x32_bf16 v[160:163], a[128:131], v[78:81], v[160:163]
v_mfma_f32_16x16x16_bf16 v[164:167], a[174:175], v[72:73], 0
v_mfma_f32_16x16x16_bf16 v[168:171], a[174:175], v[76:77], 0
v_mfma_f32_16x16x16_bf16 v[164:167], a[132:133], v[74:75], v[164:167]
v_mfma_f32_16x16x32_bf16 v[168:171], a[132:135], v[78:81], v[168:171]
s_nop 2
v_mul_f32 v156, v156, v82
v_mul_f32 v157, v157, v82
v_mul_f32 v158, v158, v82
v_mul_f32 v159, v159, v82
v_cvt_pk_bf16_f32 v172, v156, v157
v_cvt_pk_bf16_f32 v173, v158, v159
v_mul_f32 v164, v164, v82
v_mul_f32 v165, v165, v82
v_mul_f32 v166, v166, v82
v_mul_f32 v167, v167, v82
v_cvt_pk_bf16_f32 v174, v164, v165
v_cvt_pk_bf16_f32 v175, v166, v167
buffer_store_dwordx4 v[172:175], v1, s[4:7], s60 offen offset:1024 sc1
v_mul_f32 v160, v160, v83
v_mul_f32 v161, v161, v83
v_mul_f32 v162, v162, v83
v_mul_f32 v163, v163, v83
v_cvt_pk_bf16_f32 v176, v160, v161
v_cvt_pk_bf16_f32 v177, v162, v163
v_mul_f32 v168, v168, v83
v_mul_f32 v169, v169, v83
v_mul_f32 v170, v170, v83
v_mul_f32 v171, v171, v83
v_cvt_pk_bf16_f32 v178, v168, v169
v_cvt_pk_bf16_f32 v179, v170, v171
s_add_u32 s34, s60, 196608
buffer_store_dwordx4 v[176:179], v1, s[4:7], s34 offen offset:1024 sc1
s_waitcnt vmcnt(4)
v_mfma_f32_16x16x16_bf16 v[156:159], a[176:177], v[72:73], 0
v_mfma_f32_16x16x16_bf16 v[160:163], a[176:177], v[76:77], 0
v_mfma_f32_16x16x16_bf16 v[156:159], a[136:137], v[74:75], v[156:159]
v_mfma_f32_16x16x32_bf16 v[160:163], a[136:139], v[78:81], v[160:163]
v_mfma_f32_16x16x16_bf16 v[164:167], a[178:179], v[72:73], 0
v_mfma_f32_16x16x16_bf16 v[168:171], a[178:179], v[76:77], 0
v_mfma_f32_16x16x16_bf16 v[164:167], a[140:141], v[74:75], v[164:167]
v_mfma_f32_16x16x32_bf16 v[168:171], a[140:143], v[78:81], v[168:171]
s_nop 2
v_mul_f32 v156, v156, v82
v_mul_f32 v157, v157, v82
v_mul_f32 v158, v158, v82
v_mul_f32 v159, v159, v82
v_cvt_pk_bf16_f32 v172, v156, v157
v_cvt_pk_bf16_f32 v173, v158, v159
v_mul_f32 v164, v164, v82
v_mul_f32 v165, v165, v82
v_mul_f32 v166, v166, v82
v_mul_f32 v167, v167, v82
v_cvt_pk_bf16_f32 v174, v164, v165
v_cvt_pk_bf16_f32 v175, v166, v167
buffer_store_dwordx4 v[172:175], v1, s[4:7], s60 offen offset:2048 sc1
v_mul_f32 v160, v160, v83
v_mul_f32 v161, v161, v83
v_mul_f32 v162, v162, v83
v_mul_f32 v163, v163, v83
v_cvt_pk_bf16_f32 v176, v160, v161
v_cvt_pk_bf16_f32 v177, v162, v163
v_mul_f32 v168, v168, v83
v_mul_f32 v169, v169, v83
v_mul_f32 v170, v170, v83
v_mul_f32 v171, v171, v83
v_cvt_pk_bf16_f32 v178, v168, v169
v_cvt_pk_bf16_f32 v179, v170, v171
s_add_u32 s34, s60, 196608
buffer_store_dwordx4 v[176:179], v1, s[4:7], s34 offen offset:2048 sc1
s_branch reca_b5101
reca_tw2103:
s_cmp_lt_u32 s17, 3
s_cbranch_scc1 reca_b5101
s_sub_u32 s36, s17, 3
s_and_b32 s37, s36, 7
s_lshl_b32 s34, s59, 3
s_add_u32 s34, s34, s37
s_mul_i32 s34, s34, 12288
s_add_u32 s23, s34, 40894464
s_lshl_b32 s35, s37, 5
s_add_u32 s35, s35, s59
s_mul_i32 s35, s35, 3072
s_add_u32 s61, s35, 47972352
s_mul_i32 s34, s36, 393216
s_mul_i32 s35, s59, 6144
s_add_u32 s34, s34, s35
s_add_u32 s60, s34, 57147392
s_add_u32 s34, s17, 1
s_and_b32 s34, s34, 1
s_mul_i32 s34, s34, 3072
v_add_u32 v28, s34, v1
ds_read_b128 v[72:75], v28 offset:16384
ds_read_b128 v[76:79], v28 offset:17408
ds_read_b128 v[80:83], v28 offset:18432
buffer_load_dwordx2 a[180:181], v93, s[4:7], s61 offen offset:1536 sc1
buffer_load_dwordx4 a[144:147], v2, s[4:7], s23 offen offset:2048 sc1
buffer_load_dwordx2 a[182:183], v93, s[4:7], s61 offen offset:1792 sc1
buffer_load_dwordx4 a[148:151], v2, s[4:7], s23 offen offset:3072 sc1
buffer_load_dwordx2 a[184:185], v93, s[4:7], s61 offen offset:2048 sc1
buffer_load_dwordx4 a[152:155], v3, s[4:7], s23 offen offset:0 sc1
buffer_load_dwordx2 a[186:187], v93, s[4:7], s61 offen offset:2304 sc1
buffer_load_dwordx4 a[156:159], v3, s[4:7], s23 offen offset:1024 sc1
buffer_load_dwordx2 a[188:189], v93, s[4:7], s61 offen offset:2560 sc1
buffer_load_dwordx4 a[160:163], v3, s[4:7], s23 offen offset:2048 sc1
buffer_load_dwordx2 a[190:191], v93, s[4:7], s61 offen offset:2816 sc1
buffer_load_dwordx4 a[164:167], v3, s[4:7], s23 offen offset:3072 sc1
s_waitcnt lgkmcnt(0)
s_waitcnt vmcnt(8)
v_mfma_f32_16x16x16_bf16 v[156:159], a[180:181], v[72:73], 0
v_mfma_f32_16x16x16_bf16 v[160:163], a[180:181], v[76:77], 0
v_mfma_f32_16x16x16_bf16 v[156:159], a[144:145], v[74:75], v[156:159]
v_mfma_f32_16x16x32_bf16 v[160:163], a[144:147], v[78:81], v[160:163]
v_mfma_f32_16x16x16_bf16 v[164:167], a[182:183], v[72:73], 0
v_mfma_f32_16x16x16_bf16 v[168:171], a[182:183], v[76:77], 0
v_mfma_f32_16x16x16_bf16 v[164:167], a[148:149], v[74:75], v[164:167]
v_mfma_f32_16x16x32_bf16 v[168:171], a[148:151], v[78:81], v[168:171]
s_nop 2
v_mul_f32 v156, v156, v82
v_mul_f32 v157, v157, v82
v_mul_f32 v158, v158, v82
v_mul_f32 v159, v159, v82
v_cvt_pk_bf16_f32 v172, v156, v157
v_cvt_pk_bf16_f32 v173, v158, v159
v_mul_f32 v164, v164, v82
v_mul_f32 v165, v165, v82
v_mul_f32 v166, v166, v82
v_mul_f32 v167, v167, v82
v_cvt_pk_bf16_f32 v174, v164, v165
v_cvt_pk_bf16_f32 v175, v166, v167
buffer_store_dwordx4 v[172:175], v1, s[4:7], s60 offen offset:3072 sc1
v_mul_f32 v160, v160, v83
v_mul_f32 v161, v161, v83
v_mul_f32 v162, v162, v83
v_mul_f32 v163, v163, v83
v_cvt_pk_bf16_f32 v176, v160, v161
v_cvt_pk_bf16_f32 v177, v162, v163
v_mul_f32 v168, v168, v83
v_mul_f32 v169, v169, v83
v_mul_f32 v170, v170, v83
v_mul_f32 v171, v171, v83
v_cvt_pk_bf16_f32 v178, v168, v169
v_cvt_pk_bf16_f32 v179, v170, v171
s_add_u32 s34, s60, 196608
buffer_store_dwordx4 v[176:179], v1, s[4:7], s34 offen offset:3072 sc1
s_waitcnt vmcnt(6)
v_mfma_f32_16x16x16_bf16 v[156:159], a[184:185], v[72:73], 0
v_mfma_f32_16x16x16_bf16 v[160:163], a[184:185], v[76:77], 0
v_mfma_f32_16x16x16_bf16 v[156:159], a[152:153], v[74:75], v[156:159]
v_mfma_f32_16x16x32_bf16 v[160:163], a[152:155], v[78:81], v[160:163]
v_mfma_f32_16x16x16_bf16 v[164:167], a[186:187], v[72:73], 0
v_mfma_f32_16x16x16_bf16 v[168:171], a[186:187], v[76:77], 0
v_mfma_f32_16x16x16_bf16 v[164:167], a[156:157], v[74:75], v[164:167]
v_mfma_f32_16x16x32_bf16 v[168:171], a[156:159], v[78:81], v[168:171]
s_nop 2
v_mul_f32 v156, v156, v82
v_mul_f32 v157, v157, v82
v_mul_f32 v158, v158, v82
v_mul_f32 v159, v159, v82
v_cvt_pk_bf16_f32 v172, v156, v157
v_cvt_pk_bf16_f32 v173, v158, v159
v_mul_f32 v164, v164, v82
v_mul_f32 v165, v165, v82
v_mul_f32 v166, v166, v82
v_mul_f32 v167, v167, v82
v_cvt_pk_bf16_f32 v174, v164, v165
v_cvt_pk_bf16_f32 v175, v166, v167
buffer_store_dwordx4 v[172:175], v2, s[4:7], s60 offen offset:0 sc1
v_mul_f32 v160, v160, v83
v_mul_f32 v161, v161, v83
v_mul_f32 v162, v162, v83
v_mul_f32 v163, v163, v83
v_cvt_pk_bf16_f32 v176, v160, v161
v_cvt_pk_bf16_f32 v177, v162, v163
v_mul_f32 v168, v168, v83
v_mul_f32 v169, v169, v83
v_mul_f32 v170, v170, v83
v_mul_f32 v171, v171, v83
v_cvt_pk_bf16_f32 v178, v168, v169
v_cvt_pk_bf16_f32 v179, v170, v171
s_add_u32 s34, s60, 196608
buffer_store_dwordx4 v[176:179], v2, s[4:7], s34 offen offset:0 sc1
s_waitcnt vmcnt(4)
v_mfma_f32_16x16x16_bf16 v[156:159], a[188:189], v[72:73], 0
v_mfma_f32_16x16x16_bf16 v[160:163], a[188:189], v[76:77], 0
v_mfma_f32_16x16x16_bf16 v[156:159], a[160:161], v[74:75], v[156:159]
v_mfma_f32_16x16x32_bf16 v[160:163], a[160:163], v[78:81], v[160:163]
v_mfma_f32_16x16x16_bf16 v[164:167], a[190:191], v[72:73], 0
v_mfma_f32_16x16x16_bf16 v[168:171], a[190:191], v[76:77], 0
v_mfma_f32_16x16x16_bf16 v[164:167], a[164:165], v[74:75], v[164:167]
v_mfma_f32_16x16x32_bf16 v[168:171], a[164:167], v[78:81], v[168:171]
s_nop 2
v_mul_f32 v156, v156, v82
v_mul_f32 v157, v157, v82
v_mul_f32 v158, v158, v82
v_mul_f32 v159, v159, v82
v_cvt_pk_bf16_f32 v172, v156, v157
v_cvt_pk_bf16_f32 v173, v158, v159
v_mul_f32 v164, v164, v82
v_mul_f32 v165, v165, v82
v_mul_f32 v166, v166, v82
v_mul_f32 v167, v167, v82
v_cvt_pk_bf16_f32 v174, v164, v165
v_cvt_pk_bf16_f32 v175, v166, v167
buffer_store_dwordx4 v[172:175], v2, s[4:7], s60 offen offset:1024 sc1
v_mul_f32 v160, v160, v83
v_mul_f32 v161, v161, v83
v_mul_f32 v162, v162, v83
v_mul_f32 v163, v163, v83
v_cvt_pk_bf16_f32 v176, v160, v161
v_cvt_pk_bf16_f32 v177, v162, v163
v_mul_f32 v168, v168, v83
v_mul_f32 v169, v169, v83
v_mul_f32 v170, v170, v83
v_mul_f32 v171, v171, v83
v_cvt_pk_bf16_f32 v178, v168, v169
v_cvt_pk_bf16_f32 v179, v170, v171
s_add_u32 s34, s60, 196608
buffer_store_dwordx4 v[176:179], v2, s[4:7], s34 offen offset:1024 sc1
s_branch reca_b5101
s_cmp_lg_u32 s12, 2
s_cbranch_scc1 reca_b399
buffer_store_dwordx2 v[52:53], v9, s[4:7], s30 offen
buffer_store_dwordx2 v[32:33], v16, s[4:7], s26 offen
s_cmp_lg_u32 s14, 0
s_cbranch_scc1 reca_b399
v_mov_b32 v28, s17
s_lshl_b32 s34, s13, 7
s_add_u32 s34, s34, 1507328
buffer_store_dword v28, v19, s[4:7], s34 offen
s_branch reca_b399
reca_last98:
s_cmp_lg_u32 s12, 2
s_cbranch_scc1 reca_exit1
buffer_store_dwordx2 v[52:53], v9, s[4:7], s30 offen
s_branch reca_exit1
reca_swave96:
s_cmp_lg_u32 s17, 63
s_cbranch_scc1 reca_vmst104
s_barrier
ds_read_b128 v[56:59], v1 offset:10240
ds_read_b128 v[60:63], v1 offset:11264
ds_read_b128 v[64:67], v1 offset:12288
s_waitcnt lgkmcnt(0)
v_add_f32 v56, v56, v64
v_add_f32 v60, v60, v48
v_add_f32 v57, v57, v65
v_add_f32 v61, v61, v49
v_add_f32 v58, v58, v66
v_add_f32 v62, v62, v50
v_add_f32 v59, v59, v67
v_add_f32 v63, v63, v51
v_cvt_pk_bf16_f32 v68, v56, v57
v_cvt_pk_bf16_f32 v69, v58, v59
v_cvt_pk_bf16_f32 v70, v60, v61
v_cvt_pk_bf16_f32 v71, v62, v63
buffer_store_dwordx2 v[52:53], v9, s[4:7], s30 offen
buffer_store_dwordx2 v[68:69], v10, s[4:7], s31 offen
buffer_store_dwordx2 v[70:71], v10, s[4:7], s31 offen offset:256
s_branch reca_exit1
reca_vmst104:
s_sleep 1
buffer_load_dwordx4 v[208:211], v1, s[4:7], s21 offen offset:0 sc1
buffer_load_dwordx4 v[212:215], v1, s[4:7], s21 offen offset:1024 sc1
buffer_load_dwordx4 v[216:219], v1, s[4:7], s21 offen offset:2048 sc1
buffer_load_dwordx4 v[220:223], v1, s[4:7], s21 offen offset:3072 sc1
buffer_load_dwordx4 v[224:227], v2, s[4:7], s21 offen offset:0 sc1
buffer_load_dwordx4 v[228:231], v2, s[4:7], s21 offen offset:1024 sc1
s_waitcnt vmcnt(5)
v_max_u32 v29, v208, v210
v_cmp_eq_u32 vcc, -1, v29
s_cbranch_vccnz reca_retry105
reca_resume106:
s_waitcnt vmcnt(4)
v_max_u32 v29, v212, v214
v_cmp_eq_u32 vcc, -1, v29
v_mfma_f32_16x16x32_bf16 v[76:79], a[120:123], v[208:211], 0
v_mfma_f32_16x16x32_bf16 v[80:83], a[144:147], v[208:211], 0
v_mfma_f32_16x16x32_bf16 v[72:75], v[208:211], v[208:211], v[40:43]
s_cbranch_vccnz reca_retry107
reca_resume108:
s_waitcnt vmcnt(3)
v_max_u32 v29, v216, v218
v_cmp_eq_u32 vcc, -1, v29
v_mfma_f32_16x16x32_bf16 v[76:79], a[124:127], v[212:215], v[76:79]
v_mfma_f32_16x16x32_bf16 v[80:83], a[148:151], v[212:215], v[80:83]
v_mfma_f32_16x16x32_bf16 v[72:75], v[212:215], v[212:215], v[72:75]
s_cbranch_vccnz reca_retry109
reca_resume110:
s_waitcnt vmcnt(2)
v_max_u32 v29, v220, v222
v_cmp_eq_u32 vcc, -1, v29
v_mfma_f32_16x16x32_bf16 v[76:79], a[128:131], v[216:219], v[76:79]
v_mfma_f32_16x16x32_bf16 v[80:83], a[152:155], v[216:219], v[80:83]
v_mfma_f32_16x16x32_bf16 v[72:75], v[216:219], v[216:219], v[72:75]
s_cbranch_vccnz reca_retry111
reca_resume112:
s_waitcnt vmcnt(1)
v_max_u32 v29, v224, v226
v_cmp_eq_u32 vcc, -1, v29
v_mfma_f32_16x16x32_bf16 v[76:79], a[132:135], v[220:223], v[76:79]
v_mfma_f32_16x16x32_bf16 v[80:83], a[156:159], v[220:223], v[80:83]
v_mfma_f32_16x16x32_bf16 v[72:75], v[220:223], v[220:223], v[72:75]
s_cbranch_vccnz reca_retry113
reca_resume114:
s_waitcnt vmcnt(0)
v_max_u32 v29, v228, v230
v_cmp_eq_u32 vcc, -1, v29
v_mfma_f32_16x16x32_bf16 v[76:79], a[136:139], v[224:227], v[76:79]
v_mfma_f32_16x16x32_bf16 v[80:83], a[160:163], v[224:227], v[80:83]
v_mfma_f32_16x16x32_bf16 v[72:75], v[224:227], v[224:227], v[72:75]
s_cbranch_vccnz reca_retry115
reca_resume116:
v_mfma_f32_16x16x32_bf16 v[76:79], a[140:143], v[228:231], v[76:79]
v_mfma_f32_16x16x32_bf16 v[80:83], a[164:167], v[228:231], v[80:83]
v_mfma_f32_16x16x32_bf16 v[72:75], v[228:231], v[228:231], v[72:75]
s_barrier
ds_read_b128 v[56:59], v1 offset:10240
ds_read_b128 v[60:63], v1 offset:11264
ds_read_b128 v[64:67], v1 offset:12288
s_nop 1
v_max3_f32 v28, v76, v77, v78
v_max3_f32 v29, v80, v81, v82
v_max3_f32 v28, v28, v79, v83
v_max3_f32 v29, v29, v72, v73
v_max3_f32 v28, v28, v74, v75
v_max_f32 v28, v28, v29
v_mov_b32 v29, v28
s_nop 1
v_permlane32_swap_b32 v28, v29
v_max_f32 v28, v28, v29
v_mov_b32 v29, v28
s_nop 1
v_permlane16_swap_b32 v28, v29
v_max_f32 v28, v28, v29
v_mul_f32 v28, s41, v28
v_fma_f32 v76, v76, s41, -v28
v_fma_f32 v77, v77, s41, -v28
v_fma_f32 v78, v78, s41, -v28
v_fma_f32 v79, v79, s41, -v28
v_fma_f32 v80, v80, s41, -v28
v_fma_f32 v81, v81, s41, -v28
v_fma_f32 v82, v82, s41, -v28
v_fma_f32 v83, v83, s41, -v28
v_fma_f32 v72, v72, s41, -v28
v_fma_f32 v73, v73, s41, -v28
v_fma_f32 v74, v74, s41, -v28
v_fma_f32 v75, v75, s41, -v28
v_exp_f32 v76, v76
v_exp_f32 v77, v77
v_exp_f32 v78, v78
v_exp_f32 v79, v79
v_exp_f32 v80, v80
v_exp_f32 v81, v81
v_exp_f32 v82, v82
v_exp_f32 v83, v83
v_cvt_pk_bf16_f32 v84, v76, v77
v_cvt_pk_bf16_f32 v85, v78, v79
v_cvt_pk_bf16_f32 v86, v80, v81
v_cvt_pk_bf16_f32 v87, v82, v83
v_exp_f32 v72, v72
v_exp_f32 v73, v73
v_mfma_f32_16x16x32_bf16 v[100:103], v[36:39], v[84:87], 0
v_exp_f32 v74, v74
v_exp_f32 v75, v75
v_mfma_f32_16x16x32_bf16 v[92:95], a[168:171], v[84:87], 0
v_cvt_pk_bf16_f32 v88, v72, v73
v_cvt_pk_bf16_f32 v89, v74, v75
v_mfma_f32_16x16x32_bf16 v[96:99], a[172:175], v[84:87], 0
s_waitcnt lgkmcnt(0)
v_mfma_f32_16x16x16_bf16 v[100:103], v[36:37], v[88:89], v[100:103]
v_add_f32 v56, v56, v64
v_add_f32 v60, v60, v48
v_add_f32 v57, v57, v65
v_add_f32 v61, v61, v49
v_add_f32 v58, v58, v66
v_add_f32 v62, v62, v50
v_add_f32 v59, v59, v67
v_add_f32 v63, v63, v51
v_cvt_pk_bf16_f32 v68, v56, v57
v_cvt_pk_bf16_f32 v69, v58, v59
v_cvt_pk_bf16_f32 v70, v60, v61
v_cvt_pk_bf16_f32 v71, v62, v63
v_mfma_f32_16x16x16_bf16 v[92:95], v[68:69], v[88:89], v[92:95]
v_rcp_f32 v28, v100
v_mfma_f32_16x16x16_bf16 v[96:99], v[70:71], v[88:89], v[96:99]
v_mov_b32 v29, v28
s_nop 4
v_pk_mul_f32 v[92:93], v[92:93], v[28:29]
v_pk_mul_f32 v[94:95], v[94:95], v[28:29]
v_pk_mul_f32 v[96:97], v[96:97], v[28:29]
v_pk_mul_f32 v[98:99], v[98:99], v[28:29]
v_cvt_pk_bf16_f32 v104, v92, v93
v_cvt_pk_bf16_f32 v105, v94, v95
v_cvt_pk_bf16_f32 v106, v96, v97
v_cvt_pk_bf16_f32 v107, v98, v99
buffer_store_dwordx4 v[104:107], v11, s[4:7], s22 offen
s_barrier
s_add_u32 s34, s17, 2
s_and_b32 s34, s34, 3
s_mul_i32 s26, s34, 10240
s_add_u32 s26, s26, s38
s_mul_i32 s27, s34, 6144
s_add_u32 s27, s27, s39
s_mul_i32 s28, s34, 12288
s_add_u32 s28, s28, s40
s_mul_i32 s29, s34, 393216
s_add_u32 s29, s29, s56
buffer_store_dwordx2 v[32:33], v8, s[4:7], s27 offen
buffer_store_dwordx4 v[32:35], v11, s[4:7], s28 offen
s_add_u32 s36, s17, 1
s_cmp_ge_u32 s36, 63
s_cbranch_scc1 reca_nopf117
s_add_u32 s37, s36, 1
reca_pf118:
buffer_load_dword v28, v233, s[4:7], 0 offen sc1
s_waitcnt vmcnt(0)
v_cmp_gt_i32 vcc, s37, v28
s_cbranch_vccz reca_pfok119
s_sleep 1
s_sub_u32 s18, s18, 1
s_cbranch_scc0 reca_pf118
s_mov_b32 s18, 0
reca_pfok119:
s_lshl_b32 s34, s15, 3
s_and_b32 s35, s36, 7
s_add_u32 s34, s34, s35
s_mul_i32 s34, s34, 12288
s_add_u32 s32, s34, 37748736
s_lshl_b32 s35, s16, 11
s_add_u32 s34, s34, s35
s_add_u32 s33, s34, 40894464
buffer_load_dwordx4 a[120:123], v1, s[4:7], s32 offen offset:0 sc1
buffer_load_dwordx4 a[124:127], v1, s[4:7], s32 offen offset:1024 sc1
buffer_load_dwordx4 a[128:131], v1, s[4:7], s32 offen offset:2048 sc1
buffer_load_dwordx4 a[132:135], v1, s[4:7], s32 offen offset:3072 sc1
buffer_load_dwordx4 a[136:139], v2, s[4:7], s32 offen offset:0 sc1
buffer_load_dwordx4 a[140:143], v2, s[4:7], s32 offen offset:1024 sc1
buffer_load_dwordx4 a[144:147], v2, s[4:7], s32 offen offset:2048 sc1
buffer_load_dwordx4 a[148:151], v2, s[4:7], s32 offen offset:3072 sc1
buffer_load_dwordx4 a[152:155], v3, s[4:7], s32 offen offset:0 sc1
buffer_load_dwordx4 a[156:159], v3, s[4:7], s32 offen offset:1024 sc1
buffer_load_dwordx4 a[160:163], v3, s[4:7], s32 offen offset:2048 sc1
buffer_load_dwordx4 a[164:167], v3, s[4:7], s32 offen offset:3072 sc1
buffer_load_dwordx4 a[168:171], v1, s[4:7], s33 offen offset:0 sc1
buffer_load_dwordx4 a[172:175], v1, s[4:7], s33 offen offset:1024 sc1
reca_nopf117:
buffer_store_dwordx2 v[52:53], v9, s[4:7], s30 offen
buffer_store_dwordx2 v[68:69], v10, s[4:7], s31 offen
buffer_store_dwordx2 v[70:71], v10, s[4:7], s31 offen offset:256
reca_b5101:
s_barrier
s_add_u32 s17, s17, 1
s_branch reca_step87
reca_b399:
s_endpgm
reca_retry90:
s_sub_u32 s18, s18, 1
s_cbranch_scc1 reca_retry90_to
buffer_load_dwordx4 v[128:131], v4, s[4:7], s20 offen sc1
buffer_load_dwordx4 v[132:135], v4, s[4:7], s20 offen offset:1024 sc1
buffer_load_dwordx4 v[136:139], v5, s[4:7], s20 offen sc1
s_waitcnt vmcnt(2)
v_max_u32 v29, v128, v130
v_cmp_eq_u32 vcc, -1, v29
s_cbranch_vccnz reca_retry90
s_branch reca_resume91
reca_retry90_to:
s_mov_b32 s18, 0
s_waitcnt vmcnt(0)
s_branch reca_resume91
reca_retry92:
s_sub_u32 s18, s18, 1
s_cbranch_scc1 reca_retry92_to
buffer_load_dwordx4 v[132:135], v4, s[4:7], s20 offen offset:1024 sc1
buffer_load_dwordx4 v[136:139], v5, s[4:7], s20 offen sc1
s_waitcnt vmcnt(1)
v_max_u32 v29, v132, v134
v_cmp_eq_u32 vcc, -1, v29
s_cbranch_vccnz reca_retry92
s_branch reca_resume93
reca_retry92_to:
s_mov_b32 s18, 0
s_waitcnt vmcnt(0)
s_branch reca_resume93
reca_retry94:
s_sub_u32 s18, s18, 1
s_cbranch_scc1 reca_retry94_to
buffer_load_dwordx4 v[136:139], v5, s[4:7], s20 offen sc1
s_waitcnt vmcnt(0)
v_max_u32 v29, v136, v138
v_cmp_eq_u32 vcc, -1, v29
s_cbranch_vccnz reca_retry94
s_branch reca_resume95
reca_retry94_to:
s_mov_b32 s18, 0
s_waitcnt vmcnt(0)
s_branch reca_resume95
reca_retry105:
s_sub_u32 s18, s18, 1
s_cbranch_scc1 reca_retry105_to
buffer_load_dwordx4 v[208:211], v1, s[4:7], s21 offen offset:0 sc1
buffer_load_dwordx4 v[212:215], v1, s[4:7], s21 offen offset:1024 sc1
buffer_load_dwordx4 v[216:219], v1, s[4:7], s21 offen offset:2048 sc1
buffer_load_dwordx4 v[220:223], v1, s[4:7], s21 offen offset:3072 sc1
buffer_load_dwordx4 v[224:227], v2, s[4:7], s21 offen offset:0 sc1
buffer_load_dwordx4 v[228:231], v2, s[4:7], s21 offen offset:1024 sc1
s_waitcnt vmcnt(5)
v_max_u32 v29, v208, v210
v_cmp_eq_u32 vcc, -1, v29
s_cbranch_vccnz reca_retry105
s_branch reca_resume106
reca_retry105_to:
s_mov_b32 s18, 0
s_waitcnt vmcnt(0)
s_branch reca_resume106
reca_retry107:
s_sub_u32 s18, s18, 1
s_cbranch_scc1 reca_retry107_to
buffer_load_dwordx4 v[212:215], v1, s[4:7], s21 offen offset:1024 sc1
buffer_load_dwordx4 v[216:219], v1, s[4:7], s21 offen offset:2048 sc1
buffer_load_dwordx4 v[220:223], v1, s[4:7], s21 offen offset:3072 sc1
buffer_load_dwordx4 v[224:227], v2, s[4:7], s21 offen offset:0 sc1
buffer_load_dwordx4 v[228:231], v2, s[4:7], s21 offen offset:1024 sc1
s_waitcnt vmcnt(4)
v_max_u32 v29, v212, v214
v_cmp_eq_u32 vcc, -1, v29
s_cbranch_vccnz reca_retry107
s_branch reca_resume108
reca_retry107_to:
s_mov_b32 s18, 0
s_waitcnt vmcnt(0)
s_branch reca_resume108
reca_retry109:
s_sub_u32 s18, s18, 1
s_cbranch_scc1 reca_retry109_to
buffer_load_dwordx4 v[216:219], v1, s[4:7], s21 offen offset:2048 sc1
buffer_load_dwordx4 v[220:223], v1, s[4:7], s21 offen offset:3072 sc1
buffer_load_dwordx4 v[224:227], v2, s[4:7], s21 offen offset:0 sc1
buffer_load_dwordx4 v[228:231], v2, s[4:7], s21 offen offset:1024 sc1
s_waitcnt vmcnt(3)
v_max_u32 v29, v216, v218
v_cmp_eq_u32 vcc, -1, v29
s_cbranch_vccnz reca_retry109
s_branch reca_resume110
reca_retry109_to:
s_mov_b32 s18, 0
s_waitcnt vmcnt(0)
s_branch reca_resume110
reca_retry111:
s_sub_u32 s18, s18, 1
s_cbranch_scc1 reca_retry111_to
buffer_load_dwordx4 v[220:223], v1, s[4:7], s21 offen offset:3072 sc1
buffer_load_dwordx4 v[224:227], v2, s[4:7], s21 offen offset:0 sc1
buffer_load_dwordx4 v[228:231], v2, s[4:7], s21 offen offset:1024 sc1
s_waitcnt vmcnt(2)
v_max_u32 v29, v220, v222
v_cmp_eq_u32 vcc, -1, v29
s_cbranch_vccnz reca_retry111
s_branch reca_resume112
reca_retry111_to:
s_mov_b32 s18, 0
s_waitcnt vmcnt(0)
s_branch reca_resume112
reca_retry113:
s_sub_u32 s18, s18, 1
s_cbranch_scc1 reca_retry113_to
buffer_load_dwordx4 v[224:227], v2, s[4:7], s21 offen offset:0 sc1
buffer_load_dwordx4 v[228:231], v2, s[4:7], s21 offen offset:1024 sc1
s_waitcnt vmcnt(1)
v_max_u32 v29, v224, v226
v_cmp_eq_u32 vcc, -1, v29
s_cbranch_vccnz reca_retry113
s_branch reca_resume114
reca_retry113_to:
s_mov_b32 s18, 0
s_waitcnt vmcnt(0)
s_branch reca_resume114
reca_retry115:
s_sub_u32 s18, s18, 1
s_cbranch_scc1 reca_retry115_to
buffer_load_dwordx4 v[228:231], v2, s[4:7], s21 offen offset:1024 sc1
s_waitcnt vmcnt(0)
v_max_u32 v29, v228, v230
v_cmp_eq_u32 vcc, -1, v29
s_cbranch_vccnz reca_retry115
s_branch reca_resume116
reca_retry115_to:
s_mov_b32 s18, 0
s_waitcnt vmcnt(0)
s_branch reca_resume116
reca_slow11:
s_cmp_ge_u32 s14, 20
s_cbranch_scc1 reca_twins13
s_branch reca_gotmem121
reca_step120:
s_and_b32 s34, s17, 3
s_mul_i32 s20, s34, 10240
s_add_u32 s20, s20, s38
s_sleep 2
buffer_load_dwordx4 v[128:131], v4, s[4:7], s20 offen sc1
buffer_load_dwordx4 v[132:135], v4, s[4:7], s20 offen offset:1024 sc1
buffer_load_dwordx4 v[136:139], v5, s[4:7], s20 offen sc1
s_waitcnt vmcnt(2)
v_max_u32 v29, v128, v130
v_cmp_eq_u32 vcc, -1, v29
s_cbranch_vccnz reca_retry123
reca_resume124:
s_waitcnt vmcnt(1)
v_max_u32 v29, v132, v134
v_cmp_eq_u32 vcc, -1, v29
ds_write_b128 v4, v[128:131]
s_cbranch_vccnz reca_retry125
reca_resume126:
s_waitcnt vmcnt(0)
v_max_u32 v29, v136, v138
v_cmp_eq_u32 vcc, -1, v29
ds_write_b128 v4, v[132:135] offset:1024
s_cbranch_vccnz reca_retry127
reca_resume128:
ds_write_b128 v5, v[136:139]
s_branch reca_gotmem2122
reca_gotmem121:
ds_write_b128 v4, v[128:131]
ds_write_b128 v4, v[132:135] offset:1024
ds_write_b128 v5, v[136:139]
reca_gotmem2122:
s_and_b32 s34, s17, 3
s_mul_i32 s21, s34, 6144
s_add_u32 s21, s21, s39
s_mul_i32 s22, s34, 12288
s_add_u32 s22, s22, s40
s_mul_i32 s25, s34, 393216
s_add_u32 s25, s25, s56
s_add_u32 s35, s17, 1
s_and_b32 s35, s35, 3
s_mul_i32 s24, s35, 10240
s_add_u32 s24, s24, s38
s_waitcnt lgkmcnt(0)
s_barrier
ds_read_b128 v[128:131], v236 offset:0
ds_read_b128 v[132:135], v236 offset:1024
ds_read_b128 v[136:139], v236 offset:2048
ds_read_b128 v[140:143], v236 offset:3072
ds_read_b128 v[144:147], v236 offset:4096
ds_read_b128 v[148:151], v237 offset:0
ds_read_b128 v[152:155], v237 offset:1024
ds_read_b128 v[156:159], v237 offset:2048
ds_read_b128 v[160:163], v237 offset:3072
ds_read_b128 v[164:167], v237 offset:4096
s_waitcnt lgkmcnt(9)
v_mfma_f32_16x16x32_bf16 v[44:47], a[0:3], v[128:131], 0
ds_read_b128 v[168:171], v6 offset:0
v_mfma_f32_16x16x32_bf16 v[240:243], a[4:7], v[128:131], 0
s_waitcnt lgkmcnt(9)
v_mfma_f32_16x16x32_bf16 v[44:47], a[8:11], v[132:135], v[44:47]
ds_read_b128 v[172:175], v6 offset:512
v_mfma_f32_16x16x32_bf16 v[240:243], a[12:15], v[132:135], v[240:243]
s_waitcnt lgkmcnt(9)
v_mfma_f32_16x16x32_bf16 v[44:47], a[16:19], v[136:139], v[44:47]
ds_read_b128 v[176:179], v6 offset:1024
v_mfma_f32_16x16x32_bf16 v[240:243], a[20:23], v[136:139], v[240:243]
s_waitcnt lgkmcnt(9)
v_mfma_f32_16x16x32_bf16 v[44:47], a[24:27], v[140:143], v[44:47]
ds_read_b128 v[180:183], v6 offset:1536
v_mfma_f32_16x16x32_bf16 v[240:243], a[28:31], v[140:143], v[240:243]
s_waitcnt lgkmcnt(9)
v_mfma_f32_16x16x32_bf16 v[44:47], a[32:35], v[144:147], v[44:47]
ds_read_b128 v[184:187], v6 offset:2048
v_mfma_f32_16x16x32_bf16 v[240:243], a[36:39], v[144:147], v[240:243]
s_waitcnt lgkmcnt(9)
v_mfma_f32_16x16x32_bf16 v[44:47], a[40:43], v[148:151], v[44:47]
ds_read_b128 v[188:191], v6 offset:2560
v_mfma_f32_16x16x32_bf16 v[240:243], a[44:47], v[148:151], v[240:243]
s_waitcnt lgkmcnt(9)
v_mfma_f32_16x16x32_bf16 v[44:47], a[48:51], v[152:155], v[44:47]
ds_read_b128 v[192:195], v6 offset:3072
v_mfma_f32_16x16x32_bf16 v[240:243], a[52:55], v[152:155], v[240:243]
s_waitcnt lgkmcnt(9)
v_mfma_f32_16x16x32_bf16 v[44:47], a[56:59], v[156:159], v[44:47]
ds_read_b128 v[196:199], v6 offset:3584
v_mfma_f32_16x16x32_bf16 v[240:243], a[60:63], v[156:159], v[240:243]
s_waitcnt lgkmcnt(9)
v_mfma_f32_16x16x32_bf16 v[44:47], a[64:67], v[160:163], v[44:47]
ds_read_b128 v[200:203], v6 offset:4096
v_mfma_f32_16x16x32_bf16 v[240:243], a[68:71], v[160:163], v[240:243]
s_waitcnt lgkmcnt(9)
v_mfma_f32_16x16x32_bf16 v[44:47], a[72:75], v[164:167], v[44:47]
ds_read_b128 v[204:207], v6 offset:4608
v_mfma_f32_16x16x32_bf16 v[240:243], a[76:79], v[164:167], v[240:243]
s_waitcnt lgkmcnt(9)
v_mfma_f32_16x16x32_bf16 v[48:51], v[168:171], a[80:83], 0
s_and_b32 s34, s17, 7
s_lshl_b32 s34, s34, 5
s_add_u32 s34, s34, s15
s_mul_i32 s34, s34, 3072
s_lshl_b32 s35, s16, 9
s_add_u32 s34, s34, s35
s_add_u32 s30, s34, 47185920
s_add_u32 s31, s34, 47972352
v_add_f32_dpp v44, v240, v44 row_ror:8 row_mask:0xf bank_mask:0xf
v_add_f32_dpp v45, v241, v45 row_ror:8 row_mask:0xf bank_mask:0xf
v_add_f32_dpp v46, v242, v46 row_ror:8 row_mask:0xf bank_mask:0xf
v_add_f32_dpp v47, v243, v47 row_ror:8 row_mask:0xf bank_mask:0xf
v_cvt_pk_bf16_f32 v52, v44, v45
v_cvt_pk_bf16_f32 v53, v46, v47
buffer_store_dwordx2 v[52:53], v8, s[4:7], s21 offen sc1
s_waitcnt lgkmcnt(8)
v_mfma_f32_16x16x32_bf16 v[48:51], v[172:175], a[84:87], v[48:51]
s_waitcnt lgkmcnt(7)
v_mfma_f32_16x16x32_bf16 v[48:51], v[176:179], a[88:91], v[48:51]
s_waitcnt lgkmcnt(6)
v_mfma_f32_16x16x32_bf16 v[48:51], v[180:183], a[92:95], v[48:51]
s_waitcnt lgkmcnt(5)
v_mfma_f32_16x16x32_bf16 v[48:51], v[184:187], a[96:99], v[48:51]
s_waitcnt lgkmcnt(4)
v_mfma_f32_16x16x32_bf16 v[48:51], v[188:191], a[100:103], v[48:51]
s_waitcnt lgkmcnt(3)
v_mfma_f32_16x16x32_bf16 v[48:51], v[192:195], a[104:107], v[48:51]
s_waitcnt lgkmcnt(2)
v_mfma_f32_16x16x32_bf16 v[48:51], v[196:199], a[108:111], v[48:51]
s_waitcnt lgkmcnt(1)
v_mfma_f32_16x16x32_bf16 v[48:51], v[200:203], a[112:115], v[48:51]
s_waitcnt lgkmcnt(0)
v_mfma_f32_16x16x32_bf16 v[48:51], v[204:207], a[116:119], v[48:51]
s_cmp_eq_u32 s12, 3
s_cbranch_scc1 reca_swave129
s_nop 5
ds_write_b128 v17, v[48:51]
s_add_u32 s34, s17, 2
s_and_b32 s34, s34, 3
s_mul_i32 s26, s34, 10240
s_add_u32 s26, s26, s38
s_mul_i32 s27, s34, 6144
s_add_u32 s27, s27, s39
s_mul_i32 s28, s34, 12288
s_add_u32 s28, s28, s40
s_mul_i32 s29, s34, 393216
s_add_u32 s29, s29, s56
s_waitcnt lgkmcnt(0)
s_barrier
s_cmp_eq_u32 s17, 63
s_cbranch_scc1 reca_last131
buffer_store_dwordx2 v[32:33], v8, s[4:7], s27 offen sc1
s_cmp_lg_u32 s12, 2
s_cbranch_scc1 reca_b3132
buffer_store_dwordx2 v[52:53], v9, s[4:7], s30 offen sc1
buffer_store_dwordx2 v[32:33], v16, s[4:7], s26 offen sc1
s_cmp_lg_u32 s14, 0
s_cbranch_scc1 reca_b3132
v_mov_b32 v28, s17
s_lshl_b32 s34, s13, 7
s_add_u32 s34, s34, 1507328
buffer_store_dword v28, v19, s[4:7], s34 offen sc1
s_branch reca_b3132
reca_last131:
s_cmp_lg_u32 s12, 2
s_cbranch_scc1 reca_exit1
buffer_store_dwordx2 v[52:53], v9, s[4:7], s30 offen
s_branch reca_exit1
reca_swave129:
s_cmp_lg_u32 s17, 63
s_cbranch_scc1 reca_vmst135
s_barrier
ds_read_b128 v[56:59], v1 offset:10240
ds_read_b128 v[60:63], v1 offset:11264
ds_read_b128 v[64:67], v1 offset:12288
s_waitcnt lgkmcnt(0)
v_add_f32 v56, v56, v64
v_add_f32 v60, v60, v48
v_add_f32 v57, v57, v65
v_add_f32 v61, v61, v49
v_add_f32 v58, v58, v66
v_add_f32 v62, v62, v50
v_add_f32 v59, v59, v67
v_add_f32 v63, v63, v51
v_cvt_pk_bf16_f32 v68, v56, v57
v_cvt_pk_bf16_f32 v69, v58, v59
v_cvt_pk_bf16_f32 v70, v60, v61
v_cvt_pk_bf16_f32 v71, v62, v63
buffer_store_dwordx2 v[52:53], v9, s[4:7], s30 offen
buffer_store_dwordx2 v[68:69], v10, s[4:7], s31 offen
buffer_store_dwordx2 v[70:71], v10, s[4:7], s31 offen offset:256
s_branch reca_exit1
reca_vmst135:
s_sleep 1
buffer_load_dwordx4 v[208:211], v1, s[4:7], s21 offen offset:0 sc1
buffer_load_dwordx4 v[212:215], v1, s[4:7], s21 offen offset:1024 sc1
buffer_load_dwordx4 v[216:219], v1, s[4:7], s21 offen offset:2048 sc1
buffer_load_dwordx4 v[220:223], v1, s[4:7], s21 offen offset:3072 sc1
buffer_load_dwordx4 v[224:227], v2, s[4:7], s21 offen offset:0 sc1
buffer_load_dwordx4 v[228:231], v2, s[4:7], s21 offen offset:1024 sc1
s_waitcnt vmcnt(5)
v_max_u32 v29, v208, v210
v_cmp_eq_u32 vcc, -1, v29
s_cbranch_vccnz reca_retry136
reca_resume137:
s_waitcnt vmcnt(4)
v_max_u32 v29, v212, v214
v_cmp_eq_u32 vcc, -1, v29
v_mfma_f32_16x16x32_bf16 v[76:79], a[120:123], v[208:211], 0
v_mfma_f32_16x16x32_bf16 v[80:83], a[144:147], v[208:211], 0
v_mfma_f32_16x16x32_bf16 v[72:75], v[208:211], v[208:211], v[40:43]
s_cbranch_vccnz reca_retry138
reca_resume139:
s_waitcnt vmcnt(3)
v_max_u32 v29, v216, v218
v_cmp_eq_u32 vcc, -1, v29
v_mfma_f32_16x16x32_bf16 v[76:79], a[124:127], v[212:215], v[76:79]
v_mfma_f32_16x16x32_bf16 v[80:83], a[148:151], v[212:215], v[80:83]
v_mfma_f32_16x16x32_bf16 v[72:75], v[212:215], v[212:215], v[72:75]
s_cbranch_vccnz reca_retry140
reca_resume141:
s_waitcnt vmcnt(2)
v_max_u32 v29, v220, v222
v_cmp_eq_u32 vcc, -1, v29
v_mfma_f32_16x16x32_bf16 v[76:79], a[128:131], v[216:219], v[76:79]
v_mfma_f32_16x16x32_bf16 v[80:83], a[152:155], v[216:219], v[80:83]
v_mfma_f32_16x16x32_bf16 v[72:75], v[216:219], v[216:219], v[72:75]
s_cbranch_vccnz reca_retry142
reca_resume143:
s_waitcnt vmcnt(1)
v_max_u32 v29, v224, v226
v_cmp_eq_u32 vcc, -1, v29
v_mfma_f32_16x16x32_bf16 v[76:79], a[132:135], v[220:223], v[76:79]
v_mfma_f32_16x16x32_bf16 v[80:83], a[156:159], v[220:223], v[80:83]
v_mfma_f32_16x16x32_bf16 v[72:75], v[220:223], v[220:223], v[72:75]
s_cbranch_vccnz reca_retry144
reca_resume145:
s_waitcnt vmcnt(0)
v_max_u32 v29, v228, v230
v_cmp_eq_u32 vcc, -1, v29
v_mfma_f32_16x16x32_bf16 v[76:79], a[136:139], v[224:227], v[76:79]
v_mfma_f32_16x16x32_bf16 v[80:83], a[160:163], v[224:227], v[80:83]
v_mfma_f32_16x16x32_bf16 v[72:75], v[224:227], v[224:227], v[72:75]
s_cbranch_vccnz reca_retry146
reca_resume147:
v_mfma_f32_16x16x32_bf16 v[76:79], a[140:143], v[228:231], v[76:79]
v_mfma_f32_16x16x32_bf16 v[80:83], a[164:167], v[228:231], v[80:83]
v_mfma_f32_16x16x32_bf16 v[72:75], v[228:231], v[228:231], v[72:75]
s_barrier
ds_read_b128 v[56:59], v1 offset:10240
ds_read_b128 v[60:63], v1 offset:11264
ds_read_b128 v[64:67], v1 offset:12288
s_nop 1
v_max3_f32 v28, v76, v77, v78
v_max3_f32 v29, v80, v81, v82
v_max3_f32 v28, v28, v79, v83
v_max3_f32 v29, v29, v72, v73
v_max3_f32 v28, v28, v74, v75
v_max_f32 v28, v28, v29
v_mov_b32 v29, v28
s_nop 1
v_permlane32_swap_b32 v28, v29
v_max_f32 v28, v28, v29
v_mov_b32 v29, v28
s_nop 1
v_permlane16_swap_b32 v28, v29
v_max_f32 v28, v28, v29
v_mul_f32 v28, s41, v28
v_fma_f32 v76, v76, s41, -v28
v_fma_f32 v77, v77, s41, -v28
v_fma_f32 v78, v78, s41, -v28
v_fma_f32 v79, v79, s41, -v28
v_fma_f32 v80, v80, s41, -v28
v_fma_f32 v81, v81, s41, -v28
v_fma_f32 v82, v82, s41, -v28
v_fma_f32 v83, v83, s41, -v28
v_fma_f32 v72, v72, s41, -v28
v_fma_f32 v73, v73, s41, -v28
v_fma_f32 v74, v74, s41, -v28
v_fma_f32 v75, v75, s41, -v28
v_exp_f32 v76, v76
v_exp_f32 v77, v77
v_exp_f32 v78, v78
v_exp_f32 v79, v79
v_exp_f32 v80, v80
v_exp_f32 v81, v81
v_exp_f32 v82, v82
v_exp_f32 v83, v83
v_cvt_pk_bf16_f32 v84, v76, v77
v_cvt_pk_bf16_f32 v85, v78, v79
v_cvt_pk_bf16_f32 v86, v80, v81
v_cvt_pk_bf16_f32 v87, v82, v83
v_exp_f32 v72, v72
v_exp_f32 v73, v73
v_mfma_f32_16x16x32_bf16 v[100:103], v[36:39], v[84:87], 0
v_exp_f32 v74, v74
v_exp_f32 v75, v75
v_mfma_f32_16x16x32_bf16 v[92:95], a[168:171], v[84:87], 0
v_cvt_pk_bf16_f32 v88, v72, v73
v_cvt_pk_bf16_f32 v89, v74, v75
v_mfma_f32_16x16x32_bf16 v[96:99], a[172:175], v[84:87], 0
s_waitcnt lgkmcnt(0)
v_mfma_f32_16x16x16_bf16 v[100:103], v[36:37], v[88:89], v[100:103]
v_add_f32 v56, v56, v64
v_add_f32 v60, v60, v48
v_add_f32 v57, v57, v65
v_add_f32 v61, v61, v49
v_add_f32 v58, v58, v66
v_add_f32 v62, v62, v50
v_add_f32 v59, v59, v67
v_add_f32 v63, v63, v51
v_cvt_pk_bf16_f32 v68, v56, v57
v_cvt_pk_bf16_f32 v69, v58, v59
v_cvt_pk_bf16_f32 v70, v60, v61
v_cvt_pk_bf16_f32 v71, v62, v63
v_mfma_f32_16x16x16_bf16 v[92:95], v[68:69], v[88:89], v[92:95]
v_rcp_f32 v28, v100
v_mfma_f32_16x16x16_bf16 v[96:99], v[70:71], v[88:89], v[96:99]
v_mov_b32 v29, v28
s_nop 4
v_pk_mul_f32 v[92:93], v[92:93], v[28:29]
v_pk_mul_f32 v[94:95], v[94:95], v[28:29]
v_pk_mul_f32 v[96:97], v[96:97], v[28:29]
v_pk_mul_f32 v[98:99], v[98:99], v[28:29]
v_cvt_pk_bf16_f32 v104, v92, v93
v_cvt_pk_bf16_f32 v105, v94, v95
v_cvt_pk_bf16_f32 v106, v96, v97
v_cvt_pk_bf16_f32 v107, v98, v99
buffer_store_dwordx4 v[104:107], v11, s[4:7], s22 offen sc1
reca_b3132:
s_barrier
s_cmp_ge_u32 s12, 2
s_cbranch_scc1 reca_notg2148
s_sleep 3
buffer_load_dwordx4 v[128:131], v12, s[4:7], s22 offen offset:0 sc1
buffer_load_dwordx4 v[132:135], v12, s[4:7], s22 offen offset:1024 sc1
buffer_load_dwordx4 v[136:139], v12, s[4:7], s22 offen offset:2048 sc1
buffer_load_dwordx4 v[140:143], v12, s[4:7], s22 offen offset:3072 sc1
buffer_load_dwordx4 v[144:147], v13, s[4:7], s22 offen offset:0 sc1
buffer_load_dwordx4 v[148:151], v13, s[4:7], s22 offen offset:1024 sc1
buffer_load_dwordx4 v[152:155], v13, s[4:7], s22 offen offset:2048 sc1
buffer_load_dwordx4 v[156:159], v13, s[4:7], s22 offen offset:3072 sc1
buffer_load_dwordx4 v[160:163], v14, s[4:7], s22 offen offset:0 sc1
buffer_load_dwordx4 v[164:167], v14, s[4:7], s22 offen offset:1024 sc1
buffer_load_dwordx4 v[168:171], v14, s[4:7], s22 offen offset:2048 sc1
buffer_load_dwordx4 v[172:175], v14, s[4:7], s22 offen offset:3072 sc1
s_waitcnt vmcnt(11)
v_cmp_eq_u32 vcc, -1, v128
s_cbranch_vccnz reca_retry149
reca_resume150:
s_waitcnt vmcnt(10)
v_cmp_eq_u32 vcc, -1, v132
v_mfma_f32_16x16x32_bf16 v[108:111], a[120:123], v[128:131], 0
v_mfma_f32_16x16x32_bf16 v[112:115], a[124:127], v[128:131], 0
s_cbranch_vccnz reca_retry151
reca_resume152:
s_waitcnt vmcnt(9)
v_cmp_eq_u32 vcc, -1, v136
v_mfma_f32_16x16x32_bf16 v[108:111], a[128:131], v[132:135], v[108:111]
v_mfma_f32_16x16x32_bf16 v[112:115], a[132:135], v[132:135], v[112:115]
s_cbranch_vccnz reca_retry153
reca_resume154:
s_waitcnt vmcnt(8)
v_cmp_eq_u32 vcc, -1, v140
v_mfma_f32_16x16x32_bf16 v[108:111], a[136:139], v[136:139], v[108:111]
v_mfma_f32_16x16x32_bf16 v[112:115], a[140:143], v[136:139], v[112:115]
s_cbranch_vccnz reca_retry155
reca_resume156:
s_waitcnt vmcnt(7)
v_cmp_eq_u32 vcc, -1, v144
v_mfma_f32_16x16x32_bf16 v[108:111], a[144:147], v[140:143], v[108:111]
v_mfma_f32_16x16x32_bf16 v[112:115], a[148:151], v[140:143], v[112:115]
s_cbranch_vccnz reca_retry157
reca_resume158:
s_waitcnt vmcnt(6)
v_cmp_eq_u32 vcc, -1, v148
v_mfma_f32_16x16x32_bf16 v[108:111], a[152:155], v[144:147], v[108:111]
v_mfma_f32_16x16x32_bf16 v[112:115], a[156:159], v[144:147], v[112:115]
s_cbranch_vccnz reca_retry159
reca_resume160:
s_waitcnt vmcnt(5)
v_cmp_eq_u32 vcc, -1, v152
v_mfma_f32_16x16x32_bf16 v[108:111], a[160:163], v[148:151], v[108:111]
v_mfma_f32_16x16x32_bf16 v[112:115], a[164:167], v[148:151], v[112:115]
s_cbranch_vccnz reca_retry161
reca_resume162:
s_waitcnt vmcnt(4)
v_cmp_eq_u32 vcc, -1, v156
v_mfma_f32_16x16x32_bf16 v[108:111], a[168:171], v[152:155], v[108:111]
v_mfma_f32_16x16x32_bf16 v[112:115], a[172:175], v[152:155], v[112:115]
s_cbranch_vccnz reca_retry163
reca_resume164:
s_waitcnt vmcnt(3)
v_cmp_eq_u32 vcc, -1, v160
v_mfma_f32_16x16x32_bf16 v[108:111], a[176:179], v[156:159], v[108:111]
v_mfma_f32_16x16x32_bf16 v[112:115], a[180:183], v[156:159], v[112:115]
s_cbranch_vccnz reca_retry165
reca_resume166:
s_waitcnt vmcnt(2)
v_cmp_eq_u32 vcc, -1, v164
v_mfma_f32_16x16x32_bf16 v[108:111], a[184:187], v[160:163], v[108:111]
v_mfma_f32_16x16x32_bf16 v[112:115], a[188:191], v[160:163], v[112:115]
s_cbranch_vccnz reca_retry167
reca_resume168:
s_waitcnt vmcnt(1)
v_cmp_eq_u32 vcc, -1, v168
v_mfma_f32_16x16x32_bf16 v[108:111], a[192:195], v[164:167], v[108:111]
v_mfma_f32_16x16x32_bf16 v[112:115], a[196:199], v[164:167], v[112:115]
s_cbranch_vccnz reca_retry169
reca_resume170:
s_waitcnt vmcnt(0)
v_cmp_eq_u32 vcc, -1, v172
v_mfma_f32_16x16x32_bf16 v[108:111], a[200:203], v[168:171], v[108:111]
v_mfma_f32_16x16x32_bf16 v[112:115], a[204:207], v[168:171], v[112:115]
s_cbranch_vccnz reca_retry171
reca_resume172:
v_mfma_f32_16x16x32_bf16 v[108:111], a[208:211], v[172:175], v[108:111]
v_mfma_f32_16x16x32_bf16 v[112:115], a[212:215], v[172:175], v[112:115]
s_nop 7
v_add_f32_dpp v116, v112, v108 row_ror:8 row_mask:0xf bank_mask:0xf
v_add_f32_dpp v117, v113, v109 row_ror:8 row_mask:0xf bank_mask:0xf
v_add_f32_dpp v118, v114, v110 row_ror:8 row_mask:0xf bank_mask:0xf
v_add_f32_dpp v119, v115, v111 row_ror:8 row_mask:0xf bank_mask:0xf
buffer_store_dwordx4 v[116:119], v15, s[4:7], s25 offen sc1
buffer_store_dwordx4 v[116:119], v232, s[4:7], s25 offen sc1
buffer_store_dwordx4 v[32:35], v15, s[4:7], s29 offen sc1
buffer_store_dwordx4 v[32:35], v232, s[4:7], s29 offen sc1
s_branch reca_b4133
reca_notg2148:
s_cmp_lg_u32 s12, 3
s_cbranch_scc1 reca_b4133
s_add_u32 s34, s17, 2
s_and_b32 s34, s34, 3
s_mul_i32 s26, s34, 10240
s_add_u32 s26, s26, s38
s_mul_i32 s27, s34, 6144
s_add_u32 s27, s27, s39
s_mul_i32 s28, s34, 12288
s_add_u32 s28, s28, s40
s_mul_i32 s29, s34, 393216
s_add_u32 s29, s29, s56
buffer_store_dwordx2 v[32:33], v8, s[4:7], s27 offen sc1
buffer_store_dwordx4 v[32:35], v11, s[4:7], s28 offen sc1
reca_b4133:
s_barrier
s_cmp_lg_u32 s12, 2
s_cbranch_scc1 reca_not2173
s_sleep 8
buffer_load_dwordx4 v[128:131], v20, s[4:7], s25 offen sc1
buffer_load_dwordx4 v[132:135], v21, s[4:7], s25 offen sc1
buffer_load_dwordx4 v[136:139], v22, s[4:7], s25 offen sc1
buffer_load_dwordx4 v[140:143], v23, s[4:7], s25 offen sc1
buffer_load_dwordx4 v[144:147], v24, s[4:7], s25 offen sc1
buffer_load_dwordx4 v[148:151], v25, s[4:7], s25 offen sc1
buffer_load_dwordx4 v[152:155], v26, s[4:7], s25 offen sc1
buffer_load_dwordx4 v[156:159], v27, s[4:7], s25 offen sc1
s_waitcnt vmcnt(7)
v_cmp_eq_u32 vcc, -1, v128
s_cbranch_vccnz reca_retry174
reca_resume175:
s_waitcnt vmcnt(6)
v_cmp_eq_u32 vcc, -1, v132
s_cbranch_vccnz reca_retry176
reca_resume177:
s_waitcnt vmcnt(5)
v_cmp_eq_u32 vcc, -1, v136
v_pk_add_f32 v[116:117], v[128:129], v[132:133]
v_pk_add_f32 v[118:119], v[130:131], v[134:135]
s_cbranch_vccnz reca_retry178
reca_resume179:
s_waitcnt vmcnt(4)
v_cmp_eq_u32 vcc, -1, v140
v_pk_add_f32 v[116:117], v[116:117], v[136:137]
v_pk_add_f32 v[118:119], v[118:119], v[138:139]
s_cbranch_vccnz reca_retry180
reca_resume181:
s_waitcnt vmcnt(3)
v_cmp_eq_u32 vcc, -1, v144
v_pk_add_f32 v[116:117], v[116:117], v[140:141]
v_pk_add_f32 v[118:119], v[118:119], v[142:143]
s_cbranch_vccnz reca_retry182
reca_resume183:
s_waitcnt vmcnt(2)
v_cmp_eq_u32 vcc, -1, v148
v_pk_add_f32 v[116:117], v[116:117], v[144:145]
v_pk_add_f32 v[118:119], v[118:119], v[146:147]
s_cbranch_vccnz reca_retry184
reca_resume185:
s_waitcnt vmcnt(1)
v_cmp_eq_u32 vcc, -1, v152
v_pk_add_f32 v[116:117], v[116:117], v[148:149]
v_pk_add_f32 v[118:119], v[118:119], v[150:151]
s_cbranch_vccnz reca_retry186
reca_resume187:
s_waitcnt vmcnt(0)
v_cmp_eq_u32 vcc, -1, v156
v_pk_add_f32 v[116:117], v[116:117], v[152:153]
v_pk_add_f32 v[118:119], v[118:119], v[154:155]
s_cbranch_vccnz reca_retry188
reca_resume189:
v_pk_add_f32 v[116:117], v[116:117], v[156:157]
v_pk_add_f32 v[118:119], v[118:119], v[158:159]
v_cvt_pk_bf16_f32 v132, v116, v117
v_cvt_pk_bf16_f32 v133, v118, v119
buffer_store_dwordx2 v[132:133], v16, s[4:7], s24 offen sc1
s_branch reca_b5134
reca_not2173:
s_cmp_lg_u32 s12, 3
s_cbranch_scc1 reca_b5134
s_add_u32 s36, s17, 1
s_cmp_ge_u32 s36, 63
s_cbranch_scc1 reca_nopf190
s_add_u32 s37, s36, 1
reca_pf191:
buffer_load_dword v28, v233, s[4:7], 0 offen sc1
s_waitcnt vmcnt(0)
v_cmp_gt_i32 vcc, s37, v28
s_cbranch_vccz reca_pfok192
s_sleep 1
s_sub_u32 s18, s18, 1
s_cbranch_scc0 reca_pf191
s_mov_b32 s18, 0
reca_pfok192:
s_lshl_b32 s34, s15, 3
s_and_b32 s35, s36, 7
s_add_u32 s34, s34, s35
s_mul_i32 s34, s34, 12288
s_add_u32 s32, s34, 37748736
s_lshl_b32 s35, s16, 11
s_add_u32 s34, s34, s35
s_add_u32 s33, s34, 40894464
buffer_load_dwordx4 a[120:123], v1, s[4:7], s32 offen offset:0 sc1
buffer_load_dwordx4 a[124:127], v1, s[4:7], s32 offen offset:1024 sc1
buffer_load_dwordx4 a[128:131], v1, s[4:7], s32 offen offset:2048 sc1
buffer_load_dwordx4 a[132:135], v1, s[4:7], s32 offen offset:3072 sc1
buffer_load_dwordx4 a[136:139], v2, s[4:7], s32 offen offset:0 sc1
buffer_load_dwordx4 a[140:143], v2, s[4:7], s32 offen offset:1024 sc1
buffer_load_dwordx4 a[144:147], v2, s[4:7], s32 offen offset:2048 sc1
buffer_load_dwordx4 a[148:151], v2, s[4:7], s32 offen offset:3072 sc1
buffer_load_dwordx4 a[152:155], v3, s[4:7], s32 offen offset:0 sc1
buffer_load_dwordx4 a[156:159], v3, s[4:7], s32 offen offset:1024 sc1
buffer_load_dwordx4 a[160:163], v3, s[4:7], s32 offen offset:2048 sc1
buffer_load_dwordx4 a[164:167], v3, s[4:7], s32 offen offset:3072 sc1
buffer_load_dwordx4 a[168:171], v1, s[4:7], s33 offen offset:0 sc1
buffer_load_dwordx4 a[172:175], v1, s[4:7], s33 offen offset:1024 sc1
reca_nopf190:
buffer_store_dwordx2 v[52:53], v9, s[4:7], s30 offen sc1
buffer_store_dwordx2 v[68:69], v10, s[4:7], s31 offen sc1
buffer_store_dwordx2 v[70:71], v10, s[4:7], s31 offen offset:256 sc1
reca_b5134:
s_barrier
s_add_u32 s17, s17, 1
s_branch reca_step120
reca_retry123:
s_sub_u32 s18, s18, 1
s_cbranch_scc1 reca_retry123_to
buffer_load_dwordx4 v[128:131], v4, s[4:7], s20 offen sc1
buffer_load_dwordx4 v[132:135], v4, s[4:7], s20 offen offset:1024 sc1
buffer_load_dwordx4 v[136:139], v5, s[4:7], s20 offen sc1
s_waitcnt vmcnt(2)
v_max_u32 v29, v128, v130
v_cmp_eq_u32 vcc, -1, v29
s_cbranch_vccnz reca_retry123
s_branch reca_resume124
reca_retry123_to:
s_mov_b32 s18, 0
s_waitcnt vmcnt(0)
s_branch reca_resume124
reca_retry125:
s_sub_u32 s18, s18, 1
s_cbranch_scc1 reca_retry125_to
buffer_load_dwordx4 v[132:135], v4, s[4:7], s20 offen offset:1024 sc1
buffer_load_dwordx4 v[136:139], v5, s[4:7], s20 offen sc1
s_waitcnt vmcnt(1)
v_max_u32 v29, v132, v134
v_cmp_eq_u32 vcc, -1, v29
s_cbranch_vccnz reca_retry125
s_branch reca_resume126
reca_retry125_to:
s_mov_b32 s18, 0
s_waitcnt vmcnt(0)
s_branch reca_resume126
reca_retry127:
s_sub_u32 s18, s18, 1
s_cbranch_scc1 reca_retry127_to
buffer_load_dwordx4 v[136:139], v5, s[4:7], s20 offen sc1
s_waitcnt vmcnt(0)
v_max_u32 v29, v136, v138
v_cmp_eq_u32 vcc, -1, v29
s_cbranch_vccnz reca_retry127
s_branch reca_resume128
reca_retry127_to:
s_mov_b32 s18, 0
s_waitcnt vmcnt(0)
s_branch reca_resume128
reca_retry136:
s_sub_u32 s18, s18, 1
s_cbranch_scc1 reca_retry136_to
buffer_load_dwordx4 v[208:211], v1, s[4:7], s21 offen offset:0 sc1
buffer_load_dwordx4 v[212:215], v1, s[4:7], s21 offen offset:1024 sc1
buffer_load_dwordx4 v[216:219], v1, s[4:7], s21 offen offset:2048 sc1
buffer_load_dwordx4 v[220:223], v1, s[4:7], s21 offen offset:3072 sc1
buffer_load_dwordx4 v[224:227], v2, s[4:7], s21 offen offset:0 sc1
buffer_load_dwordx4 v[228:231], v2, s[4:7], s21 offen offset:1024 sc1
s_waitcnt vmcnt(5)
v_max_u32 v29, v208, v210
v_cmp_eq_u32 vcc, -1, v29
s_cbranch_vccnz reca_retry136
s_branch reca_resume137
reca_retry136_to:
s_mov_b32 s18, 0
s_waitcnt vmcnt(0)
s_branch reca_resume137
reca_retry138:
s_sub_u32 s18, s18, 1
s_cbranch_scc1 reca_retry138_to
buffer_load_dwordx4 v[212:215], v1, s[4:7], s21 offen offset:1024 sc1
buffer_load_dwordx4 v[216:219], v1, s[4:7], s21 offen offset:2048 sc1
buffer_load_dwordx4 v[220:223], v1, s[4:7], s21 offen offset:3072 sc1
buffer_load_dwordx4 v[224:227], v2, s[4:7], s21 offen offset:0 sc1
buffer_load_dwordx4 v[228:231], v2, s[4:7], s21 offen offset:1024 sc1
s_waitcnt vmcnt(4)
v_max_u32 v29, v212, v214
v_cmp_eq_u32 vcc, -1, v29
s_cbranch_vccnz reca_retry138
s_branch reca_resume139
reca_retry138_to:
s_mov_b32 s18, 0
s_waitcnt vmcnt(0)
s_branch reca_resume139
reca_retry140:
s_sub_u32 s18, s18, 1
s_cbranch_scc1 reca_retry140_to
buffer_load_dwordx4 v[216:219], v1, s[4:7], s21 offen offset:2048 sc1
buffer_load_dwordx4 v[220:223], v1, s[4:7], s21 offen offset:3072 sc1
buffer_load_dwordx4 v[224:227], v2, s[4:7], s21 offen offset:0 sc1
buffer_load_dwordx4 v[228:231], v2, s[4:7], s21 offen offset:1024 sc1
s_waitcnt vmcnt(3)
v_max_u32 v29, v216, v218
v_cmp_eq_u32 vcc, -1, v29
s_cbranch_vccnz reca_retry140
s_branch reca_resume141
reca_retry140_to:
s_mov_b32 s18, 0
s_waitcnt vmcnt(0)
s_branch reca_resume141
reca_retry142:
s_sub_u32 s18, s18, 1
s_cbranch_scc1 reca_retry142_to
buffer_load_dwordx4 v[220:223], v1, s[4:7], s21 offen offset:3072 sc1
buffer_load_dwordx4 v[224:227], v2, s[4:7], s21 offen offset:0 sc1
buffer_load_dwordx4 v[228:231], v2, s[4:7], s21 offen offset:1024 sc1
s_waitcnt vmcnt(2)
v_max_u32 v29, v220, v222
v_cmp_eq_u32 vcc, -1, v29
s_cbranch_vccnz reca_retry142
s_branch reca_resume143
reca_retry142_to:
s_mov_b32 s18, 0
s_waitcnt vmcnt(0)
s_branch reca_resume143
reca_retry144:
s_sub_u32 s18, s18, 1
s_cbranch_scc1 reca_retry144_to
buffer_load_dwordx4 v[224:227], v2, s[4:7], s21 offen offset:0 sc1
buffer_load_dwordx4 v[228:231], v2, s[4:7], s21 offen offset:1024 sc1
s_waitcnt vmcnt(1)
v_max_u32 v29, v224, v226
v_cmp_eq_u32 vcc, -1, v29
s_cbranch_vccnz reca_retry144
s_branch reca_resume145
reca_retry144_to:
s_mov_b32 s18, 0
s_waitcnt vmcnt(0)
s_branch reca_resume145
reca_retry146:
s_sub_u32 s18, s18, 1
s_cbranch_scc1 reca_retry146_to
buffer_load_dwordx4 v[228:231], v2, s[4:7], s21 offen offset:1024 sc1
s_waitcnt vmcnt(0)
v_max_u32 v29, v228, v230
v_cmp_eq_u32 vcc, -1, v29
s_cbranch_vccnz reca_retry146
s_branch reca_resume147
reca_retry146_to:
s_mov_b32 s18, 0
s_waitcnt vmcnt(0)
s_branch reca_resume147
reca_retry149:
s_sub_u32 s18, s18, 1
s_cbranch_scc1 reca_retry149_to
buffer_load_dwordx4 v[128:131], v12, s[4:7], s22 offen offset:0 sc1
buffer_load_dwordx4 v[132:135], v12, s[4:7], s22 offen offset:1024 sc1
buffer_load_dwordx4 v[136:139], v12, s[4:7], s22 offen offset:2048 sc1
buffer_load_dwordx4 v[140:143], v12, s[4:7], s22 offen offset:3072 sc1
buffer_load_dwordx4 v[144:147], v13, s[4:7], s22 offen offset:0 sc1
buffer_load_dwordx4 v[148:151], v13, s[4:7], s22 offen offset:1024 sc1
buffer_load_dwordx4 v[152:155], v13, s[4:7], s22 offen offset:2048 sc1
buffer_load_dwordx4 v[156:159], v13, s[4:7], s22 offen offset:3072 sc1
buffer_load_dwordx4 v[160:163], v14, s[4:7], s22 offen offset:0 sc1
buffer_load_dwordx4 v[164:167], v14, s[4:7], s22 offen offset:1024 sc1
buffer_load_dwordx4 v[168:171], v14, s[4:7], s22 offen offset:2048 sc1
buffer_load_dwordx4 v[172:175], v14, s[4:7], s22 offen offset:3072 sc1
s_waitcnt vmcnt(11)
v_cmp_eq_u32 vcc, -1, v128
s_cbranch_vccnz reca_retry149
s_branch reca_resume150
reca_retry149_to:
s_mov_b32 s18, 0
s_waitcnt vmcnt(0)
s_branch reca_resume150
reca_retry151:
s_sub_u32 s18, s18, 1
s_cbranch_scc1 reca_retry151_to
buffer_load_dwordx4 v[132:135], v12, s[4:7], s22 offen offset:1024 sc1
buffer_load_dwordx4 v[136:139], v12, s[4:7], s22 offen offset:2048 sc1
buffer_load_dwordx4 v[140:143], v12, s[4:7], s22 offen offset:3072 sc1
buffer_load_dwordx4 v[144:147], v13, s[4:7], s22 offen offset:0 sc1
buffer_load_dwordx4 v[148:151], v13, s[4:7], s22 offen offset:1024 sc1
buffer_load_dwordx4 v[152:155], v13, s[4:7], s22 offen offset:2048 sc1
buffer_load_dwordx4 v[156:159], v13, s[4:7], s22 offen offset:3072 sc1
buffer_load_dwordx4 v[160:163], v14, s[4:7], s22 offen offset:0 sc1
buffer_load_dwordx4 v[164:167], v14, s[4:7], s22 offen offset:1024 sc1
buffer_load_dwordx4 v[168:171], v14, s[4:7], s22 offen offset:2048 sc1
buffer_load_dwordx4 v[172:175], v14, s[4:7], s22 offen offset:3072 sc1
s_waitcnt vmcnt(10)
v_cmp_eq_u32 vcc, -1, v132
s_cbranch_vccnz reca_retry151
s_branch reca_resume152
reca_retry151_to:
s_mov_b32 s18, 0
s_waitcnt vmcnt(0)
s_branch reca_resume152
reca_retry153:
s_sub_u32 s18, s18, 1
s_cbranch_scc1 reca_retry153_to
buffer_load_dwordx4 v[136:139], v12, s[4:7], s22 offen offset:2048 sc1
buffer_load_dwordx4 v[140:143], v12, s[4:7], s22 offen offset:3072 sc1
buffer_load_dwordx4 v[144:147], v13, s[4:7], s22 offen offset:0 sc1
buffer_load_dwordx4 v[148:151], v13, s[4:7], s22 offen offset:1024 sc1
buffer_load_dwordx4 v[152:155], v13, s[4:7], s22 offen offset:2048 sc1
buffer_load_dwordx4 v[156:159], v13, s[4:7], s22 offen offset:3072 sc1
buffer_load_dwordx4 v[160:163], v14, s[4:7], s22 offen offset:0 sc1
buffer_load_dwordx4 v[164:167], v14, s[4:7], s22 offen offset:1024 sc1
buffer_load_dwordx4 v[168:171], v14, s[4:7], s22 offen offset:2048 sc1
buffer_load_dwordx4 v[172:175], v14, s[4:7], s22 offen offset:3072 sc1
s_waitcnt vmcnt(9)
v_cmp_eq_u32 vcc, -1, v136
s_cbranch_vccnz reca_retry153
s_branch reca_resume154
reca_retry153_to:
s_mov_b32 s18, 0
s_waitcnt vmcnt(0)
s_branch reca_resume154
reca_retry155:
s_sub_u32 s18, s18, 1
s_cbranch_scc1 reca_retry155_to
buffer_load_dwordx4 v[140:143], v12, s[4:7], s22 offen offset:3072 sc1
buffer_load_dwordx4 v[144:147], v13, s[4:7], s22 offen offset:0 sc1
buffer_load_dwordx4 v[148:151], v13, s[4:7], s22 offen offset:1024 sc1
buffer_load_dwordx4 v[152:155], v13, s[4:7], s22 offen offset:2048 sc1
buffer_load_dwordx4 v[156:159], v13, s[4:7], s22 offen offset:3072 sc1
buffer_load_dwordx4 v[160:163], v14, s[4:7], s22 offen offset:0 sc1
buffer_load_dwordx4 v[164:167], v14, s[4:7], s22 offen offset:1024 sc1
buffer_load_dwordx4 v[168:171], v14, s[4:7], s22 offen offset:2048 sc1
buffer_load_dwordx4 v[172:175], v14, s[4:7], s22 offen offset:3072 sc1
s_waitcnt vmcnt(8)
v_cmp_eq_u32 vcc, -1, v140
s_cbranch_vccnz reca_retry155
s_branch reca_resume156
reca_retry155_to:
s_mov_b32 s18, 0
s_waitcnt vmcnt(0)
s_branch reca_resume156
reca_retry157:
s_sub_u32 s18, s18, 1
s_cbranch_scc1 reca_retry157_to
buffer_load_dwordx4 v[144:147], v13, s[4:7], s22 offen offset:0 sc1
buffer_load_dwordx4 v[148:151], v13, s[4:7], s22 offen offset:1024 sc1
buffer_load_dwordx4 v[152:155], v13, s[4:7], s22 offen offset:2048 sc1
buffer_load_dwordx4 v[156:159], v13, s[4:7], s22 offen offset:3072 sc1
buffer_load_dwordx4 v[160:163], v14, s[4:7], s22 offen offset:0 sc1
buffer_load_dwordx4 v[164:167], v14, s[4:7], s22 offen offset:1024 sc1
buffer_load_dwordx4 v[168:171], v14, s[4:7], s22 offen offset:2048 sc1
buffer_load_dwordx4 v[172:175], v14, s[4:7], s22 offen offset:3072 sc1
s_waitcnt vmcnt(7)
v_cmp_eq_u32 vcc, -1, v144
s_cbranch_vccnz reca_retry157
s_branch reca_resume158
reca_retry157_to:
s_mov_b32 s18, 0
s_waitcnt vmcnt(0)
s_branch reca_resume158
reca_retry159:
s_sub_u32 s18, s18, 1
s_cbranch_scc1 reca_retry159_to
buffer_load_dwordx4 v[148:151], v13, s[4:7], s22 offen offset:1024 sc1
buffer_load_dwordx4 v[152:155], v13, s[4:7], s22 offen offset:2048 sc1
buffer_load_dwordx4 v[156:159], v13, s[4:7], s22 offen offset:3072 sc1
buffer_load_dwordx4 v[160:163], v14, s[4:7], s22 offen offset:0 sc1
buffer_load_dwordx4 v[164:167], v14, s[4:7], s22 offen offset:1024 sc1
buffer_load_dwordx4 v[168:171], v14, s[4:7], s22 offen offset:2048 sc1
buffer_load_dwordx4 v[172:175], v14, s[4:7], s22 offen offset:3072 sc1
s_waitcnt vmcnt(6)
v_cmp_eq_u32 vcc, -1, v148
s_cbranch_vccnz reca_retry159
s_branch reca_resume160
reca_retry159_to:
s_mov_b32 s18, 0
s_waitcnt vmcnt(0)
s_branch reca_resume160
reca_retry161:
s_sub_u32 s18, s18, 1
s_cbranch_scc1 reca_retry161_to
buffer_load_dwordx4 v[152:155], v13, s[4:7], s22 offen offset:2048 sc1
buffer_load_dwordx4 v[156:159], v13, s[4:7], s22 offen offset:3072 sc1
buffer_load_dwordx4 v[160:163], v14, s[4:7], s22 offen offset:0 sc1
buffer_load_dwordx4 v[164:167], v14, s[4:7], s22 offen offset:1024 sc1
buffer_load_dwordx4 v[168:171], v14, s[4:7], s22 offen offset:2048 sc1
buffer_load_dwordx4 v[172:175], v14, s[4:7], s22 offen offset:3072 sc1
s_waitcnt vmcnt(5)
v_cmp_eq_u32 vcc, -1, v152
s_cbranch_vccnz reca_retry161
s_branch reca_resume162
reca_retry161_to:
s_mov_b32 s18, 0
s_waitcnt vmcnt(0)
s_branch reca_resume162
reca_retry163:
s_sub_u32 s18, s18, 1
s_cbranch_scc1 reca_retry163_to
buffer_load_dwordx4 v[156:159], v13, s[4:7], s22 offen offset:3072 sc1
buffer_load_dwordx4 v[160:163], v14, s[4:7], s22 offen offset:0 sc1
buffer_load_dwordx4 v[164:167], v14, s[4:7], s22 offen offset:1024 sc1
buffer_load_dwordx4 v[168:171], v14, s[4:7], s22 offen offset:2048 sc1
buffer_load_dwordx4 v[172:175], v14, s[4:7], s22 offen offset:3072 sc1
s_waitcnt vmcnt(4)
v_cmp_eq_u32 vcc, -1, v156
s_cbranch_vccnz reca_retry163
s_branch reca_resume164
reca_retry163_to:
s_mov_b32 s18, 0
s_waitcnt vmcnt(0)
s_branch reca_resume164
reca_retry165:
s_sub_u32 s18, s18, 1
s_cbranch_scc1 reca_retry165_to
buffer_load_dwordx4 v[160:163], v14, s[4:7], s22 offen offset:0 sc1
buffer_load_dwordx4 v[164:167], v14, s[4:7], s22 offen offset:1024 sc1
buffer_load_dwordx4 v[168:171], v14, s[4:7], s22 offen offset:2048 sc1
buffer_load_dwordx4 v[172:175], v14, s[4:7], s22 offen offset:3072 sc1
s_waitcnt vmcnt(3)
v_cmp_eq_u32 vcc, -1, v160
s_cbranch_vccnz reca_retry165
s_branch reca_resume166
reca_retry165_to:
s_mov_b32 s18, 0
s_waitcnt vmcnt(0)
s_branch reca_resume166
reca_retry167:
s_sub_u32 s18, s18, 1
s_cbranch_scc1 reca_retry167_to
buffer_load_dwordx4 v[164:167], v14, s[4:7], s22 offen offset:1024 sc1
buffer_load_dwordx4 v[168:171], v14, s[4:7], s22 offen offset:2048 sc1
buffer_load_dwordx4 v[172:175], v14, s[4:7], s22 offen offset:3072 sc1
s_waitcnt vmcnt(2)
v_cmp_eq_u32 vcc, -1, v164
s_cbranch_vccnz reca_retry167
s_branch reca_resume168
reca_retry167_to:
s_mov_b32 s18, 0
s_waitcnt vmcnt(0)
s_branch reca_resume168
reca_retry169:
s_sub_u32 s18, s18, 1
s_cbranch_scc1 reca_retry169_to
buffer_load_dwordx4 v[168:171], v14, s[4:7], s22 offen offset:2048 sc1
buffer_load_dwordx4 v[172:175], v14, s[4:7], s22 offen offset:3072 sc1
s_waitcnt vmcnt(1)
v_cmp_eq_u32 vcc, -1, v168
s_cbranch_vccnz reca_retry169
s_branch reca_resume170
reca_retry169_to:
s_mov_b32 s18, 0
s_waitcnt vmcnt(0)
s_branch reca_resume170
reca_retry171:
s_sub_u32 s18, s18, 1
s_cbranch_scc1 reca_retry171_to
buffer_load_dwordx4 v[172:175], v14, s[4:7], s22 offen offset:3072 sc1
s_waitcnt vmcnt(0)
v_cmp_eq_u32 vcc, -1, v172
s_cbranch_vccnz reca_retry171
s_branch reca_resume172
reca_retry171_to:
s_mov_b32 s18, 0
s_waitcnt vmcnt(0)
s_branch reca_resume172
reca_retry174:
s_sub_u32 s18, s18, 1
s_cbranch_scc1 reca_retry174_to
buffer_load_dwordx4 v[128:131], v20, s[4:7], s25 offen sc1
buffer_load_dwordx4 v[132:135], v21, s[4:7], s25 offen sc1
buffer_load_dwordx4 v[136:139], v22, s[4:7], s25 offen sc1
buffer_load_dwordx4 v[140:143], v23, s[4:7], s25 offen sc1
buffer_load_dwordx4 v[144:147], v24, s[4:7], s25 offen sc1
buffer_load_dwordx4 v[148:151], v25, s[4:7], s25 offen sc1
buffer_load_dwordx4 v[152:155], v26, s[4:7], s25 offen sc1
buffer_load_dwordx4 v[156:159], v27, s[4:7], s25 offen sc1
s_waitcnt vmcnt(7)
v_cmp_eq_u32 vcc, -1, v128
s_cbranch_vccnz reca_retry174
s_branch reca_resume175
reca_retry174_to:
s_mov_b32 s18, 0
s_waitcnt vmcnt(0)
s_branch reca_resume175
reca_retry176:
s_sub_u32 s18, s18, 1
s_cbranch_scc1 reca_retry176_to
buffer_load_dwordx4 v[132:135], v21, s[4:7], s25 offen sc1
buffer_load_dwordx4 v[136:139], v22, s[4:7], s25 offen sc1
buffer_load_dwordx4 v[140:143], v23, s[4:7], s25 offen sc1
buffer_load_dwordx4 v[144:147], v24, s[4:7], s25 offen sc1
buffer_load_dwordx4 v[148:151], v25, s[4:7], s25 offen sc1
buffer_load_dwordx4 v[152:155], v26, s[4:7], s25 offen sc1
buffer_load_dwordx4 v[156:159], v27, s[4:7], s25 offen sc1
s_waitcnt vmcnt(6)
v_cmp_eq_u32 vcc, -1, v132
s_cbranch_vccnz reca_retry176
s_branch reca_resume177
reca_retry176_to:
s_mov_b32 s18, 0
s_waitcnt vmcnt(0)
s_branch reca_resume177
reca_retry178:
s_sub_u32 s18, s18, 1
s_cbranch_scc1 reca_retry178_to
buffer_load_dwordx4 v[136:139], v22, s[4:7], s25 offen sc1
buffer_load_dwordx4 v[140:143], v23, s[4:7], s25 offen sc1
buffer_load_dwordx4 v[144:147], v24, s[4:7], s25 offen sc1
buffer_load_dwordx4 v[148:151], v25, s[4:7], s25 offen sc1
buffer_load_dwordx4 v[152:155], v26, s[4:7], s25 offen sc1
buffer_load_dwordx4 v[156:159], v27, s[4:7], s25 offen sc1
s_waitcnt vmcnt(5)
v_cmp_eq_u32 vcc, -1, v136
s_cbranch_vccnz reca_retry178
s_branch reca_resume179
reca_retry178_to:
s_mov_b32 s18, 0
s_waitcnt vmcnt(0)
s_branch reca_resume179
reca_retry180:
s_sub_u32 s18, s18, 1
s_cbranch_scc1 reca_retry180_to
buffer_load_dwordx4 v[140:143], v23, s[4:7], s25 offen sc1
buffer_load_dwordx4 v[144:147], v24, s[4:7], s25 offen sc1
buffer_load_dwordx4 v[148:151], v25, s[4:7], s25 offen sc1
buffer_load_dwordx4 v[152:155], v26, s[4:7], s25 offen sc1
buffer_load_dwordx4 v[156:159], v27, s[4:7], s25 offen sc1
s_waitcnt vmcnt(4)
v_cmp_eq_u32 vcc, -1, v140
s_cbranch_vccnz reca_retry180
s_branch reca_resume181
reca_retry180_to:
s_mov_b32 s18, 0
s_waitcnt vmcnt(0)
s_branch reca_resume181
reca_retry182:
s_sub_u32 s18, s18, 1
s_cbranch_scc1 reca_retry182_to
buffer_load_dwordx4 v[144:147], v24, s[4:7], s25 offen sc1
buffer_load_dwordx4 v[148:151], v25, s[4:7], s25 offen sc1
buffer_load_dwordx4 v[152:155], v26, s[4:7], s25 offen sc1
buffer_load_dwordx4 v[156:159], v27, s[4:7], s25 offen sc1
s_waitcnt vmcnt(3)
v_cmp_eq_u32 vcc, -1, v144
s_cbranch_vccnz reca_retry182
s_branch reca_resume183
reca_retry182_to:
s_mov_b32 s18, 0
s_waitcnt vmcnt(0)
s_branch reca_resume183
reca_retry184:
s_sub_u32 s18, s18, 1
s_cbranch_scc1 reca_retry184_to
buffer_load_dwordx4 v[148:151], v25, s[4:7], s25 offen sc1
buffer_load_dwordx4 v[152:155], v26, s[4:7], s25 offen sc1
buffer_load_dwordx4 v[156:159], v27, s[4:7], s25 offen sc1
s_waitcnt vmcnt(2)
v_cmp_eq_u32 vcc, -1, v148
s_cbranch_vccnz reca_retry184
s_branch reca_resume185
reca_retry184_to:
s_mov_b32 s18, 0
s_waitcnt vmcnt(0)
s_branch reca_resume185
reca_retry186:
s_sub_u32 s18, s18, 1
s_cbranch_scc1 reca_retry186_to
buffer_load_dwordx4 v[152:155], v26, s[4:7], s25 offen sc1
buffer_load_dwordx4 v[156:159], v27, s[4:7], s25 offen sc1
s_waitcnt vmcnt(1)
v_cmp_eq_u32 vcc, -1, v152
s_cbranch_vccnz reca_retry186
s_branch reca_resume187
reca_retry186_to:
s_mov_b32 s18, 0
s_waitcnt vmcnt(0)
s_branch reca_resume187
reca_retry188:
s_sub_u32 s18, s18, 1
s_cbranch_scc1 reca_retry188_to
buffer_load_dwordx4 v[156:159], v27, s[4:7], s25 offen sc1
s_waitcnt vmcnt(0)
v_cmp_eq_u32 vcc, -1, v156
s_cbranch_vccnz reca_retry188
s_branch reca_resume189
reca_retry188_to:
s_mov_b32 s18, 0
s_waitcnt vmcnt(0)
s_branch reca_resume189
reca_twins13:
s_branch reca_gotmem194
reca_step193:
s_and_b32 s34, s17, 3
s_mul_i32 s20, s34, 10240
s_add_u32 s20, s20, s38
s_sleep 5
buffer_load_dwordx4 v[128:131], v4, s[4:7], s20 offen sc1
buffer_load_dwordx4 v[132:135], v4, s[4:7], s20 offen offset:1024 sc1
buffer_load_dwordx4 v[136:139], v5, s[4:7], s20 offen sc1
s_waitcnt vmcnt(2)
v_max_u32 v29, v128, v130
v_cmp_eq_u32 vcc, -1, v29
s_cbranch_vccnz reca_retry196
reca_resume197:
s_waitcnt vmcnt(1)
v_max_u32 v29, v132, v134
v_cmp_eq_u32 vcc, -1, v29
ds_write_b128 v4, v[128:131]
s_cbranch_vccnz reca_retry198
reca_resume199:
s_waitcnt vmcnt(0)
v_max_u32 v29, v136, v138
v_cmp_eq_u32 vcc, -1, v29
ds_write_b128 v4, v[132:135] offset:1024
s_cbranch_vccnz reca_retry200
reca_resume201:
ds_write_b128 v5, v[136:139]
s_branch reca_gotmem2195
reca_gotmem194:
ds_write_b128 v4, v[128:131]
ds_write_b128 v4, v[132:135] offset:1024
ds_write_b128 v5, v[136:139]
reca_gotmem2195:
s_and_b32 s34, s17, 3
s_mul_i32 s21, s34, 6144
s_add_u32 s21, s21, s39
s_mul_i32 s22, s34, 12288
s_add_u32 s22, s22, s40
s_mul_i32 s25, s34, 393216
s_add_u32 s25, s25, s56
s_add_u32 s35, s17, 1
s_and_b32 s35, s35, 3
s_mul_i32 s24, s35, 10240
s_add_u32 s24, s24, s38
s_waitcnt lgkmcnt(0)
s_barrier
ds_read_b128 v[128:131], v236 offset:0
ds_read_b128 v[132:135], v236 offset:1024
ds_read_b128 v[136:139], v236 offset:2048
ds_read_b128 v[140:143], v236 offset:3072
ds_read_b128 v[144:147], v236 offset:4096
ds_read_b128 v[148:151], v237 offset:0
ds_read_b128 v[152:155], v237 offset:1024
ds_read_b128 v[156:159], v237 offset:2048
ds_read_b128 v[160:163], v237 offset:3072
ds_read_b128 v[164:167], v237 offset:4096
s_waitcnt lgkmcnt(9)
v_mfma_f32_16x16x32_bf16 v[44:47], a[0:3], v[128:131], 0
ds_read_b128 v[168:171], v6 offset:0
v_mfma_f32_16x16x32_bf16 v[240:243], a[4:7], v[128:131], 0
s_waitcnt lgkmcnt(9)
v_mfma_f32_16x16x32_bf16 v[44:47], a[8:11], v[132:135], v[44:47]
ds_read_b128 v[172:175], v6 offset:512
v_mfma_f32_16x16x32_bf16 v[240:243], a[12:15], v[132:135], v[240:243]
s_waitcnt lgkmcnt(9)
v_mfma_f32_16x16x32_bf16 v[44:47], a[16:19], v[136:139], v[44:47]
ds_read_b128 v[176:179], v6 offset:1024
v_mfma_f32_16x16x32_bf16 v[240:243], a[20:23], v[136:139], v[240:243]
s_waitcnt lgkmcnt(9)
v_mfma_f32_16x16x32_bf16 v[44:47], a[24:27], v[140:143], v[44:47]
ds_read_b128 v[180:183], v6 offset:1536
v_mfma_f32_16x16x32_bf16 v[240:243], a[28:31], v[140:143], v[240:243]
s_waitcnt lgkmcnt(9)
v_mfma_f32_16x16x32_bf16 v[44:47], a[32:35], v[144:147], v[44:47]
ds_read_b128 v[184:187], v6 offset:2048
v_mfma_f32_16x16x32_bf16 v[240:243], a[36:39], v[144:147], v[240:243]
s_waitcnt lgkmcnt(9)
v_mfma_f32_16x16x32_bf16 v[44:47], a[40:43], v[148:151], v[44:47]
ds_read_b128 v[188:191], v6 offset:2560
v_mfma_f32_16x16x32_bf16 v[240:243], a[44:47], v[148:151], v[240:243]
s_waitcnt lgkmcnt(9)
v_mfma_f32_16x16x32_bf16 v[44:47], a[48:51], v[152:155], v[44:47]
ds_read_b128 v[192:195], v6 offset:3072
v_mfma_f32_16x16x32_bf16 v[240:243], a[52:55], v[152:155], v[240:243]
s_waitcnt lgkmcnt(9)
v_mfma_f32_16x16x32_bf16 v[44:47], a[56:59], v[156:159], v[44:47]
ds_read_b128 v[196:199], v6 offset:3584
v_mfma_f32_16x16x32_bf16 v[240:243], a[60:63], v[156:159], v[240:243]
s_waitcnt lgkmcnt(9)
v_mfma_f32_16x16x32_bf16 v[44:47], a[64:67], v[160:163], v[44:47]
ds_read_b128 v[200:203], v6 offset:4096
v_mfma_f32_16x16x32_bf16 v[240:243], a[68:71], v[160:163], v[240:243]
s_waitcnt lgkmcnt(9)
v_mfma_f32_16x16x32_bf16 v[44:47], a[72:75], v[164:167], v[44:47]
ds_read_b128 v[204:207], v6 offset:4608
v_mfma_f32_16x16x32_bf16 v[240:243], a[76:79], v[164:167], v[240:243]
s_waitcnt lgkmcnt(9)
v_mfma_f32_16x16x32_bf16 v[48:51], v[168:171], a[80:83], 0
s_and_b32 s34, s17, 7
s_lshl_b32 s34, s34, 5
s_add_u32 s34, s34, s15
s_mul_i32 s34, s34, 3072
s_lshl_b32 s35, s16, 9
s_add_u32 s34, s34, s35
s_add_u32 s30, s34, 47185920
s_add_u32 s31, s34, 47972352
v_add_f32_dpp v44, v240, v44 row_ror:8 row_mask:0xf bank_mask:0xf
v_add_f32_dpp v45, v241, v45 row_ror:8 row_mask:0xf bank_mask:0xf
v_add_f32_dpp v46, v242, v46 row_ror:8 row_mask:0xf bank_mask:0xf
v_add_f32_dpp v47, v243, v47 row_ror:8 row_mask:0xf bank_mask:0xf
v_cvt_pk_bf16_f32 v52, v44, v45
v_cvt_pk_bf16_f32 v53, v46, v47
buffer_store_dwordx2 v[52:53], v8, s[4:7], s21 offen sc1
s_waitcnt lgkmcnt(8)
v_mfma_f32_16x16x32_bf16 v[48:51], v[172:175], a[84:87], v[48:51]
s_waitcnt lgkmcnt(7)
v_mfma_f32_16x16x32_bf16 v[48:51], v[176:179], a[88:91], v[48:51]
s_waitcnt lgkmcnt(6)
v_mfma_f32_16x16x32_bf16 v[48:51], v[180:183], a[92:95], v[48:51]
s_waitcnt lgkmcnt(5)
v_mfma_f32_16x16x32_bf16 v[48:51], v[184:187], a[96:99], v[48:51]
s_waitcnt lgkmcnt(4)
v_mfma_f32_16x16x32_bf16 v[48:51], v[188:191], a[100:103], v[48:51]
s_waitcnt lgkmcnt(3)
v_mfma_f32_16x16x32_bf16 v[48:51], v[192:195], a[104:107], v[48:51]
s_waitcnt lgkmcnt(2)
v_mfma_f32_16x16x32_bf16 v[48:51], v[196:199], a[108:111], v[48:51]
s_waitcnt lgkmcnt(1)
v_mfma_f32_16x16x32_bf16 v[48:51], v[200:203], a[112:115], v[48:51]
s_waitcnt lgkmcnt(0)
v_mfma_f32_16x16x32_bf16 v[48:51], v[204:207], a[116:119], v[48:51]
s_cmp_eq_u32 s12, 3
s_cbranch_scc1 reca_swave202
s_nop 5
ds_write_b128 v17, v[48:51]
s_add_u32 s34, s17, 2
s_and_b32 s34, s34, 3
s_mul_i32 s26, s34, 10240
s_add_u32 s26, s26, s38
s_mul_i32 s27, s34, 6144
s_add_u32 s27, s27, s39
s_mul_i32 s28, s34, 12288
s_add_u32 s28, s28, s40
s_mul_i32 s29, s34, 393216
s_add_u32 s29, s29, s56
s_waitcnt lgkmcnt(0)
s_barrier
s_cmp_eq_u32 s17, 63
s_cbranch_scc1 reca_last204
buffer_store_dwordx2 v[32:33], v8, s[4:7], s27 offen sc1
s_cmp_lg_u32 s12, 2
s_cbranch_scc1 reca_tw1208_n
buffer_store_dwordx2 v[52:53], v9, s[4:7], s30 offen sc1
reca_tw1208_n:
s_barrier
s_cmp_eq_u32 s12, 1
s_cbranch_scc1 reca_tw1208
s_cmp_eq_u32 s12, 2
s_cbranch_scc1 reca_tw2209
s_cmp_lt_u32 s17, 2
s_cbranch_scc1 reca_b5207
s_cmp_gt_u32 s17, 61
s_cbranch_scc1 reca_b5207
s_sub_u32 s36, s17, 2
s_and_b32 s36, s36, 7
s_lshl_b32 s34, s59, 3
s_add_u32 s34, s34, s36
s_mul_i32 s34, s34, 12288
s_add_u32 s23, s34, 37748736
s_add_u32 s60, s34, 44040192
s_lshl_b32 s35, s36, 5
s_add_u32 s35, s35, s59
s_mul_i32 s35, s35, 3072
s_add_u32 s61, s35, 47185920
buffer_load_dwordx4 a[120:123], v1, s[4:7], s23 offen offset:0 sc1
buffer_load_dwordx4 a[124:127], v1, s[4:7], s23 offen offset:1024 sc1
buffer_load_dwordx4 a[128:131], v1, s[4:7], s23 offen offset:2048 sc1
buffer_load_dwordx4 a[132:135], v1, s[4:7], s23 offen offset:3072 sc1
buffer_load_dwordx4 a[136:139], v2, s[4:7], s23 offen offset:0 sc1
buffer_load_dwordx4 a[140:143], v2, s[4:7], s23 offen offset:1024 sc1
buffer_load_dwordx4 a[144:147], v2, s[4:7], s23 offen offset:2048 sc1
buffer_load_dwordx4 a[148:151], v2, s[4:7], s23 offen offset:3072 sc1
buffer_load_dwordx4 a[152:155], v3, s[4:7], s23 offen offset:0 sc1
buffer_load_dwordx4 a[156:159], v3, s[4:7], s23 offen offset:1024 sc1
buffer_load_dwordx4 a[160:163], v3, s[4:7], s23 offen offset:2048 sc1
buffer_load_dwordx4 a[164:167], v3, s[4:7], s23 offen offset:3072 sc1
buffer_load_dwordx4 a[216:219], v92, s[4:7], s61 offen offset:0 sc1
buffer_load_dwordx4 a[220:223], v92, s[4:7], s61 offen offset:512 sc1
buffer_load_dwordx4 a[224:227], v92, s[4:7], s61 offen offset:1024 sc1
buffer_load_dwordx4 a[228:231], v92, s[4:7], s61 offen offset:1536 sc1
buffer_load_dwordx4 a[232:235], v92, s[4:7], s61 offen offset:2048 sc1
buffer_load_dwordx4 a[236:239], v92, s[4:7], s61 offen offset:2560 sc1
buffer_load_dwordx4 a[168:171], v1, s[4:7], s60 offen offset:0 sc1
buffer_load_dwordx4 a[172:175], v1, s[4:7], s60 offen offset:1024 sc1
buffer_load_dwordx4 a[176:179], v1, s[4:7], s60 offen offset:2048 sc1
buffer_load_dwordx4 a[180:183], v1, s[4:7], s60 offen offset:3072 sc1
buffer_load_dwordx4 a[184:187], v2, s[4:7], s60 offen offset:0 sc1
buffer_load_dwordx4 a[188:191], v2, s[4:7], s60 offen offset:1024 sc1
buffer_load_dwordx4 a[192:195], v2, s[4:7], s60 offen offset:2048 sc1
buffer_load_dwordx4 a[196:199], v2, s[4:7], s60 offen offset:3072 sc1
buffer_load_dwordx4 a[200:203], v3, s[4:7], s60 offen offset:0 sc1
buffer_load_dwordx4 a[204:207], v3, s[4:7], s60 offen offset:1024 sc1
buffer_load_dwordx4 a[208:211], v3, s[4:7], s60 offen offset:2048 sc1
buffer_load_dwordx4 a[212:215], v3, s[4:7], s60 offen offset:3072 sc1
s_waitcnt vmcnt(5)
v_mfma_f32_16x16x32_bf16 v[128:131], a[216:219], a[168:171], v[84:87]
v_mfma_f32_16x16x32_bf16 v[132:135], a[120:123], a[168:171], v[88:91]
v_mfma_f32_16x16x32_bf16 v[136:139], a[216:219], a[192:195], v[84:87]
v_mfma_f32_16x16x32_bf16 v[140:143], a[120:123], a[192:195], 0
v_mfma_f32_16x16x32_bf16 v[144:147], a[144:147], a[192:195], v[88:91]
s_waitcnt vmcnt(4)
v_mfma_f32_16x16x32_bf16 v[128:131], a[220:223], a[172:175], v[128:131]
v_mfma_f32_16x16x32_bf16 v[132:135], a[124:127], a[172:175], v[132:135]
v_mfma_f32_16x16x32_bf16 v[136:139], a[220:223], a[196:199], v[136:139]
v_mfma_f32_16x16x32_bf16 v[140:143], a[124:127], a[196:199], v[140:143]
v_mfma_f32_16x16x32_bf16 v[144:147], a[148:151], a[196:199], v[144:147]
s_waitcnt vmcnt(3)
v_mfma_f32_16x16x32_bf16 v[128:131], a[224:227], a[176:179], v[128:131]
v_mfma_f32_16x16x32_bf16 v[132:135], a[128:131], a[176:179], v[132:135]
v_mfma_f32_16x16x32_bf16 v[136:139], a[224:227], a[200:203], v[136:139]
v_mfma_f32_16x16x32_bf16 v[140:143], a[128:131], a[200:203], v[140:143]
v_mfma_f32_16x16x32_bf16 v[144:147], a[152:155], a[200:203], v[144:147]
s_waitcnt vmcnt(2)
v_mfma_f32_16x16x32_bf16 v[128:131], a[228:231], a[180:183], v[128:131]
v_mfma_f32_16x16x32_bf16 v[132:135], a[132:135], a[180:183], v[132:135]
v_mfma_f32_16x16x32_bf16 v[136:139], a[228:231], a[204:207], v[136:139]
v_mfma_f32_16x16x32_bf16 v[140:143], a[132:135], a[204:207], v[140:143]
v_mfma_f32_16x16x32_bf16 v[144:147], a[156:159], a[204:207], v[144:147]
s_waitcnt vmcnt(1)
v_mfma_f32_16x16x32_bf16 v[128:131], a[232:235], a[184:187], v[128:131]
v_mfma_f32_16x16x32_bf16 v[132:135], a[136:139], a[184:187], v[132:135]
v_mfma_f32_16x16x32_bf16 v[136:139], a[232:235], a[208:211], v[136:139]
v_mfma_f32_16x16x32_bf16 v[140:143], a[136:139], a[208:211], v[140:143]
v_mfma_f32_16x16x32_bf16 v[144:147], a[160:163], a[208:211], v[144:147]
s_waitcnt vmcnt(0)
v_mfma_f32_16x16x32_bf16 v[128:131], a[236:239], a[188:191], v[128:131]
v_mfma_f32_16x16x32_bf16 v[132:135], a[140:143], a[188:191], v[132:135]
v_mfma_f32_16x16x32_bf16 v[136:139], a[236:239], a[212:215], v[136:139]
v_mfma_f32_16x16x32_bf16 v[140:143], a[140:143], a[212:215], v[140:143]
v_mfma_f32_16x16x32_bf16 v[144:147], a[164:167], a[212:215], v[144:147]
s_nop 3
v_max3_f32 v28, v128, v129, v130
v_max3_f32 v28, v28, v131, v132
v_max3_f32 v28, v28, v133, v134
v_max_f32 v28, v28, v135
v_mov_b32 v29, v28
s_nop 1
v_permlane32_swap_b32 v28, v29
v_max_f32 v28, v28, v29
v_mov_b32 v29, v28
s_nop 1
v_permlane16_swap_b32 v28, v29
v_max_f32 v28, v28, v29
v_mul_f32 v28, s41, v28
v_fma_f32 v128, v128, s41, -v28
v_fma_f32 v129, v129, s41, -v28
v_fma_f32 v130, v130, s41, -v28
v_fma_f32 v131, v131, s41, -v28
v_fma_f32 v132, v132, s41, -v28
v_fma_f32 v133, v133, s41, -v28
v_fma_f32 v134, v134, s41, -v28
v_fma_f32 v135, v135, s41, -v28
v_exp_f32 v128, v128
v_exp_f32 v129, v129
v_exp_f32 v130, v130
v_exp_f32 v131, v131
v_exp_f32 v132, v132
v_exp_f32 v133, v133
v_exp_f32 v134, v134
v_exp_f32 v135, v135
v_max3_f32 v30, v136, v137, v138
v_max3_f32 v30, v30, v139, v140
v_max3_f32 v30, v30, v141, v142
v_max3_f32 v30, v30, v143, v144
v_max3_f32 v30, v30, v145, v146
v_max_f32 v30, v30, v147
v_mov_b32 v29, v30
s_nop 1
v_permlane32_swap_b32 v30, v29
v_max_f32 v30, v30, v29
v_mov_b32 v29, v30
s_nop 1
v_permlane16_swap_b32 v30, v29
v_max_f32 v30, v30, v29
v_mul_f32 v30, s41, v30
v_fma_f32 v136, v136, s41, -v30
v_fma_f32 v137, v137, s41, -v30
v_fma_f32 v138, v138, s41, -v30
v_fma_f32 v139, v139, s41, -v30
v_fma_f32 v140, v140, s41, -v30
v_fma_f32 v141, v141, s41, -v30
v_fma_f32 v142, v142, s41, -v30
v_fma_f32 v143, v143, s41, -v30
v_fma_f32 v144, v144, s41, -v30
v_fma_f32 v145, v145, s41, -v30
v_fma_f32 v146, v146, s41, -v30
v_fma_f32 v147, v147, s41, -v30
v_exp_f32 v136, v136
v_exp_f32 v137, v137
v_exp_f32 v138, v138
v_exp_f32 v139, v139
v_exp_f32 v140, v140
v_exp_f32 v141, v141
v_exp_f32 v142, v142
v_exp_f32 v143, v143
v_exp_f32 v144, v144
v_exp_f32 v145, v145
v_exp_f32 v146, v146
v_exp_f32 v147, v147
v_cvt_pk_bf16_f32 v72, v128, v129
v_cvt_pk_bf16_f32 v73, v130, v131
v_cvt_pk_bf16_f32 v74, v132, v133
v_cvt_pk_bf16_f32 v75, v134, v135
v_cvt_pk_bf16_f32 v76, v136, v137
v_cvt_pk_bf16_f32 v77, v138, v139
v_cvt_pk_bf16_f32 v78, v140, v141
v_cvt_pk_bf16_f32 v79, v142, v143
v_cvt_pk_bf16_f32 v80, v144, v145
v_cvt_pk_bf16_f32 v81, v146, v147
v_mfma_f32_16x16x16_bf16 v[148:151], v[36:37], v[72:73], 0
v_mfma_f32_16x16x16_bf16 v[152:155], v[36:37], v[76:77], 0
v_mfma_f32_16x16x16_bf16 v[148:151], v[36:37], v[74:75], v[148:151]
v_mfma_f32_16x16x32_bf16 v[152:155], v[36:39], v[78:81], v[152:155]
s_nop 6
v_rcp_f32 v82, v148
v_rcp_f32 v83, v152
s_and_b32 s34, s17, 1
s_mul_i32 s34, s34, 3072
v_add_u32 v28, s34, v1
ds_write_b128 v28, v[72:75] offset:16384
ds_write_b128 v28, v[76:79] offset:17408
ds_write_b128 v28, v[80:83] offset:18432
s_waitcnt lgkmcnt(0)
s_branch reca_b5207
reca_tw1208:
s_cmp_lt_u32 s17, 3
s_cbranch_scc1 reca_b5207
s_sub_u32 s36, s17, 3
s_and_b32 s37, s36, 7
s_lshl_b32 s34, s59, 3
s_add_u32 s34, s34, s37
s_mul_i32 s34, s34, 12288
s_add_u32 s23, s34, 40894464
s_lshl_b32 s35, s37, 5
s_add_u32 s35, s35, s59
s_mul_i32 s35, s35, 3072
s_add_u32 s61, s35, 47972352
s_mul_i32 s34, s36, 393216
s_mul_i32 s35, s59, 6144
s_add_u32 s34, s34, s35
s_add_u32 s60, s34, 57147392
s_add_u32 s34, s17, 1
s_and_b32 s34, s34, 1
s_mul_i32 s34, s34, 3072
v_add_u32 v28, s34, v1
ds_read_b128 v[72:75], v28 offset:16384
ds_read_b128 v[76:79], v28 offset:17408
ds_read_b128 v[80:83], v28 offset:18432
buffer_load_dwordx2 a[168:169], v93, s[4:7], s61 offen offset:0 sc1
buffer_load_dwordx4 a[120:123], v1, s[4:7], s23 offen offset:0 sc1
buffer_load_dwordx2 a[170:171], v93, s[4:7], s61 offen offset:256 sc1
buffer_load_dwordx4 a[124:127], v1, s[4:7], s23 offen offset:1024 sc1
buffer_load_dwordx2 a[172:173], v93, s[4:7], s61 offen offset:512 sc1
buffer_load_dwordx4 a[128:131], v1, s[4:7], s23 offen offset:2048 sc1
buffer_load_dwordx2 a[174:175], v93, s[4:7], s61 offen offset:768 sc1
buffer_load_dwordx4 a[132:135], v1, s[4:7], s23 offen offset:3072 sc1
buffer_load_dwordx2 a[176:177], v93, s[4:7], s61 offen offset:1024 sc1
buffer_load_dwordx4 a[136:139], v2, s[4:7], s23 offen offset:0 sc1
buffer_load_dwordx2 a[178:179], v93, s[4:7], s61 offen offset:1280 sc1
buffer_load_dwordx4 a[140:143], v2, s[4:7], s23 offen offset:1024 sc1
s_waitcnt lgkmcnt(0)
s_waitcnt vmcnt(8)
v_mfma_f32_16x16x16_bf16 v[156:159], a[168:169], v[72:73], 0
v_mfma_f32_16x16x16_bf16 v[160:163], a[168:169], v[76:77], 0
v_mfma_f32_16x16x16_bf16 v[156:159], a[120:121], v[74:75], v[156:159]
v_mfma_f32_16x16x32_bf16 v[160:163], a[120:123], v[78:81], v[160:163]
v_mfma_f32_16x16x16_bf16 v[164:167], a[170:171], v[72:73], 0
v_mfma_f32_16x16x16_bf16 v[168:171], a[170:171], v[76:77], 0
v_mfma_f32_16x16x16_bf16 v[164:167], a[124:125], v[74:75], v[164:167]
v_mfma_f32_16x16x32_bf16 v[168:171], a[124:127], v[78:81], v[168:171]
s_nop 2
v_mul_f32 v156, v156, v82
v_mul_f32 v157, v157, v82
v_mul_f32 v158, v158, v82
v_mul_f32 v159, v159, v82
v_cvt_pk_bf16_f32 v172, v156, v157
v_cvt_pk_bf16_f32 v173, v158, v159
v_mul_f32 v164, v164, v82
v_mul_f32 v165, v165, v82
v_mul_f32 v166, v166, v82
v_mul_f32 v167, v167, v82
v_cvt_pk_bf16_f32 v174, v164, v165
v_cvt_pk_bf16_f32 v175, v166, v167
buffer_store_dwordx4 v[172:175], v1, s[4:7], s60 offen offset:0 sc1
v_mul_f32 v160, v160, v83
v_mul_f32 v161, v161, v83
v_mul_f32 v162, v162, v83
v_mul_f32 v163, v163, v83
v_cvt_pk_bf16_f32 v176, v160, v161
v_cvt_pk_bf16_f32 v177, v162, v163
v_mul_f32 v168, v168, v83
v_mul_f32 v169, v169, v83
v_mul_f32 v170, v170, v83
v_mul_f32 v171, v171, v83
v_cvt_pk_bf16_f32 v178, v168, v169
v_cvt_pk_bf16_f32 v179, v170, v171
s_add_u32 s34, s60, 196608
buffer_store_dwordx4 v[176:179], v1, s[4:7], s34 offen offset:0 sc1
s_waitcnt vmcnt(6)
v_mfma_f32_16x16x16_bf16 v[156:159], a[172:173], v[72:73], 0
v_mfma_f32_16x16x16_bf16 v[160:163], a[172:173], v[76:77], 0
v_mfma_f32_16x16x16_bf16 v[156:159], a[128:129], v[74:75], v[156:159]
v_mfma_f32_16x16x32_bf16 v[160:163], a[128:131], v[78:81], v[160:163]
v_mfma_f32_16x16x16_bf16 v[164:167], a[174:175], v[72:73], 0
v_mfma_f32_16x16x16_bf16 v[168:171], a[174:175], v[76:77], 0
v_mfma_f32_16x16x16_bf16 v[164:167], a[132:133], v[74:75], v[164:167]
v_mfma_f32_16x16x32_bf16 v[168:171], a[132:135], v[78:81], v[168:171]
s_nop 2
v_mul_f32 v156, v156, v82
v_mul_f32 v157, v157, v82
v_mul_f32 v158, v158, v82
v_mul_f32 v159, v159, v82
v_cvt_pk_bf16_f32 v172, v156, v157
v_cvt_pk_bf16_f32 v173, v158, v159
v_mul_f32 v164, v164, v82
v_mul_f32 v165, v165, v82
v_mul_f32 v166, v166, v82
v_mul_f32 v167, v167, v82
v_cvt_pk_bf16_f32 v174, v164, v165
v_cvt_pk_bf16_f32 v175, v166, v167
buffer_store_dwordx4 v[172:175], v1, s[4:7], s60 offen offset:1024 sc1
v_mul_f32 v160, v160, v83
v_mul_f32 v161, v161, v83
v_mul_f32 v162, v162, v83
v_mul_f32 v163, v163, v83
v_cvt_pk_bf16_f32 v176, v160, v161
v_cvt_pk_bf16_f32 v177, v162, v163
v_mul_f32 v168, v168, v83
v_mul_f32 v169, v169, v83
v_mul_f32 v170, v170, v83
v_mul_f32 v171, v171, v83
v_cvt_pk_bf16_f32 v178, v168, v169
v_cvt_pk_bf16_f32 v179, v170, v171
s_add_u32 s34, s60, 196608
buffer_store_dwordx4 v[176:179], v1, s[4:7], s34 offen offset:1024 sc1
s_waitcnt vmcnt(4)
v_mfma_f32_16x16x16_bf16 v[156:159], a[176:177], v[72:73], 0
v_mfma_f32_16x16x16_bf16 v[160:163], a[176:177], v[76:77], 0
v_mfma_f32_16x16x16_bf16 v[156:159], a[136:137], v[74:75], v[156:159]
v_mfma_f32_16x16x32_bf16 v[160:163], a[136:139], v[78:81], v[160:163]
v_mfma_f32_16x16x16_bf16 v[164:167], a[178:179], v[72:73], 0
v_mfma_f32_16x16x16_bf16 v[168:171], a[178:179], v[76:77], 0
v_mfma_f32_16x16x16_bf16 v[164:167], a[140:141], v[74:75], v[164:167]
v_mfma_f32_16x16x32_bf16 v[168:171], a[140:143], v[78:81], v[168:171]
s_nop 2
v_mul_f32 v156, v156, v82
v_mul_f32 v157, v157, v82
v_mul_f32 v158, v158, v82
v_mul_f32 v159, v159, v82
v_cvt_pk_bf16_f32 v172, v156, v157
v_cvt_pk_bf16_f32 v173, v158, v159
v_mul_f32 v164, v164, v82
v_mul_f32 v165, v165, v82
v_mul_f32 v166, v166, v82
v_mul_f32 v167, v167, v82
v_cvt_pk_bf16_f32 v174, v164, v165
v_cvt_pk_bf16_f32 v175, v166, v167
buffer_store_dwordx4 v[172:175], v1, s[4:7], s60 offen offset:2048 sc1
v_mul_f32 v160, v160, v83
v_mul_f32 v161, v161, v83
v_mul_f32 v162, v162, v83
v_mul_f32 v163, v163, v83
v_cvt_pk_bf16_f32 v176, v160, v161
v_cvt_pk_bf16_f32 v177, v162, v163
v_mul_f32 v168, v168, v83
v_mul_f32 v169, v169, v83
v_mul_f32 v170, v170, v83
v_mul_f32 v171, v171, v83
v_cvt_pk_bf16_f32 v178, v168, v169
v_cvt_pk_bf16_f32 v179, v170, v171
s_add_u32 s34, s60, 196608
buffer_store_dwordx4 v[176:179], v1, s[4:7], s34 offen offset:2048 sc1
s_branch reca_b5207
reca_tw2209:
s_cmp_lt_u32 s17, 3
s_cbranch_scc1 reca_b5207
s_sub_u32 s36, s17, 3
s_and_b32 s37, s36, 7
s_lshl_b32 s34, s59, 3
s_add_u32 s34, s34, s37
s_mul_i32 s34, s34, 12288
s_add_u32 s23, s34, 40894464
s_lshl_b32 s35, s37, 5
s_add_u32 s35, s35, s59
s_mul_i32 s35, s35, 3072
s_add_u32 s61, s35, 47972352
s_mul_i32 s34, s36, 393216
s_mul_i32 s35, s59, 6144
s_add_u32 s34, s34, s35
s_add_u32 s60, s34, 57147392
s_add_u32 s34, s17, 1
s_and_b32 s34, s34, 1
s_mul_i32 s34, s34, 3072
v_add_u32 v28, s34, v1
ds_read_b128 v[72:75], v28 offset:16384
ds_read_b128 v[76:79], v28 offset:17408
ds_read_b128 v[80:83], v28 offset:18432
buffer_load_dwordx2 a[180:181], v93, s[4:7], s61 offen offset:1536 sc1
buffer_load_dwordx4 a[144:147], v2, s[4:7], s23 offen offset:2048 sc1
buffer_load_dwordx2 a[182:183], v93, s[4:7], s61 offen offset:1792 sc1
buffer_load_dwordx4 a[148:151], v2, s[4:7], s23 offen offset:3072 sc1
buffer_load_dwordx2 a[184:185], v93, s[4:7], s61 offen offset:2048 sc1
buffer_load_dwordx4 a[152:155], v3, s[4:7], s23 offen offset:0 sc1
buffer_load_dwordx2 a[186:187], v93, s[4:7], s61 offen offset:2304 sc1
buffer_load_dwordx4 a[156:159], v3, s[4:7], s23 offen offset:1024 sc1
buffer_load_dwordx2 a[188:189], v93, s[4:7], s61 offen offset:2560 sc1
buffer_load_dwordx4 a[160:163], v3, s[4:7], s23 offen offset:2048 sc1
buffer_load_dwordx2 a[190:191], v93, s[4:7], s61 offen offset:2816 sc1
buffer_load_dwordx4 a[164:167], v3, s[4:7], s23 offen offset:3072 sc1
s_waitcnt lgkmcnt(0)
s_waitcnt vmcnt(8)
v_mfma_f32_16x16x16_bf16 v[156:159], a[180:181], v[72:73], 0
v_mfma_f32_16x16x16_bf16 v[160:163], a[180:181], v[76:77], 0
v_mfma_f32_16x16x16_bf16 v[156:159], a[144:145], v[74:75], v[156:159]
v_mfma_f32_16x16x32_bf16 v[160:163], a[144:147], v[78:81], v[160:163]
v_mfma_f32_16x16x16_bf16 v[164:167], a[182:183], v[72:73], 0
v_mfma_f32_16x16x16_bf16 v[168:171], a[182:183], v[76:77], 0
v_mfma_f32_16x16x16_bf16 v[164:167], a[148:149], v[74:75], v[164:167]
v_mfma_f32_16x16x32_bf16 v[168:171], a[148:151], v[78:81], v[168:171]
s_nop 2
v_mul_f32 v156, v156, v82
v_mul_f32 v157, v157, v82
v_mul_f32 v158, v158, v82
v_mul_f32 v159, v159, v82
v_cvt_pk_bf16_f32 v172, v156, v157
v_cvt_pk_bf16_f32 v173, v158, v159
v_mul_f32 v164, v164, v82
v_mul_f32 v165, v165, v82
v_mul_f32 v166, v166, v82
v_mul_f32 v167, v167, v82
v_cvt_pk_bf16_f32 v174, v164, v165
v_cvt_pk_bf16_f32 v175, v166, v167
buffer_store_dwordx4 v[172:175], v1, s[4:7], s60 offen offset:3072 sc1
v_mul_f32 v160, v160, v83
v_mul_f32 v161, v161, v83
v_mul_f32 v162, v162, v83
v_mul_f32 v163, v163, v83
v_cvt_pk_bf16_f32 v176, v160, v161
v_cvt_pk_bf16_f32 v177, v162, v163
v_mul_f32 v168, v168, v83
v_mul_f32 v169, v169, v83
v_mul_f32 v170, v170, v83
v_mul_f32 v171, v171, v83
v_cvt_pk_bf16_f32 v178, v168, v169
v_cvt_pk_bf16_f32 v179, v170, v171
s_add_u32 s34, s60, 196608
buffer_store_dwordx4 v[176:179], v1, s[4:7], s34 offen offset:3072 sc1
s_waitcnt vmcnt(6)
v_mfma_f32_16x16x16_bf16 v[156:159], a[184:185], v[72:73], 0
v_mfma_f32_16x16x16_bf16 v[160:163], a[184:185], v[76:77], 0
v_mfma_f32_16x16x16_bf16 v[156:159], a[152:153], v[74:75], v[156:159]
v_mfma_f32_16x16x32_bf16 v[160:163], a[152:155], v[78:81], v[160:163]
v_mfma_f32_16x16x16_bf16 v[164:167], a[186:187], v[72:73], 0
v_mfma_f32_16x16x16_bf16 v[168:171], a[186:187], v[76:77], 0
v_mfma_f32_16x16x16_bf16 v[164:167], a[156:157], v[74:75], v[164:167]
v_mfma_f32_16x16x32_bf16 v[168:171], a[156:159], v[78:81], v[168:171]
s_nop 2
v_mul_f32 v156, v156, v82
v_mul_f32 v157, v157, v82
v_mul_f32 v158, v158, v82
v_mul_f32 v159, v159, v82
v_cvt_pk_bf16_f32 v172, v156, v157
v_cvt_pk_bf16_f32 v173, v158, v159
v_mul_f32 v164, v164, v82
v_mul_f32 v165, v165, v82
v_mul_f32 v166, v166, v82
v_mul_f32 v167, v167, v82
v_cvt_pk_bf16_f32 v174, v164, v165
v_cvt_pk_bf16_f32 v175, v166, v167
buffer_store_dwordx4 v[172:175], v2, s[4:7], s60 offen offset:0 sc1
v_mul_f32 v160, v160, v83
v_mul_f32 v161, v161, v83
v_mul_f32 v162, v162, v83
v_mul_f32 v163, v163, v83
v_cvt_pk_bf16_f32 v176, v160, v161
v_cvt_pk_bf16_f32 v177, v162, v163
v_mul_f32 v168, v168, v83
v_mul_f32 v169, v169, v83
v_mul_f32 v170, v170, v83
v_mul_f32 v171, v171, v83
v_cvt_pk_bf16_f32 v178, v168, v169
v_cvt_pk_bf16_f32 v179, v170, v171
s_add_u32 s34, s60, 196608
buffer_store_dwordx4 v[176:179], v2, s[4:7], s34 offen offset:0 sc1
s_waitcnt vmcnt(4)
v_mfma_f32_16x16x16_bf16 v[156:159], a[188:189], v[72:73], 0
v_mfma_f32_16x16x16_bf16 v[160:163], a[188:189], v[76:77], 0
v_mfma_f32_16x16x16_bf16 v[156:159], a[160:161], v[74:75], v[156:159]
v_mfma_f32_16x16x32_bf16 v[160:163], a[160:163], v[78:81], v[160:163]
v_mfma_f32_16x16x16_bf16 v[164:167], a[190:191], v[72:73], 0
v_mfma_f32_16x16x16_bf16 v[168:171], a[190:191], v[76:77], 0
v_mfma_f32_16x16x16_bf16 v[164:167], a[164:165], v[74:75], v[164:167]
v_mfma_f32_16x16x32_bf16 v[168:171], a[164:167], v[78:81], v[168:171]
s_nop 2
v_mul_f32 v156, v156, v82
v_mul_f32 v157, v157, v82
v_mul_f32 v158, v158, v82
v_mul_f32 v159, v159, v82
v_cvt_pk_bf16_f32 v172, v156, v157
v_cvt_pk_bf16_f32 v173, v158, v159
v_mul_f32 v164, v164, v82
v_mul_f32 v165, v165, v82
v_mul_f32 v166, v166, v82
v_mul_f32 v167, v167, v82
v_cvt_pk_bf16_f32 v174, v164, v165
v_cvt_pk_bf16_f32 v175, v166, v167
buffer_store_dwordx4 v[172:175], v2, s[4:7], s60 offen offset:1024 sc1
v_mul_f32 v160, v160, v83
v_mul_f32 v161, v161, v83
v_mul_f32 v162, v162, v83
v_mul_f32 v163, v163, v83
v_cvt_pk_bf16_f32 v176, v160, v161
v_cvt_pk_bf16_f32 v177, v162, v163
v_mul_f32 v168, v168, v83
v_mul_f32 v169, v169, v83
v_mul_f32 v170, v170, v83
v_mul_f32 v171, v171, v83
v_cvt_pk_bf16_f32 v178, v168, v169
v_cvt_pk_bf16_f32 v179, v170, v171
s_add_u32 s34, s60, 196608
buffer_store_dwordx4 v[176:179], v2, s[4:7], s34 offen offset:1024 sc1
s_branch reca_b5207
s_cmp_lg_u32 s12, 2
s_cbranch_scc1 reca_b3205
buffer_store_dwordx2 v[52:53], v9, s[4:7], s30 offen sc1
buffer_store_dwordx2 v[32:33], v16, s[4:7], s26 offen sc1
s_cmp_lg_u32 s14, 0
s_cbranch_scc1 reca_b3205
v_mov_b32 v28, s17
s_lshl_b32 s34, s13, 7
s_add_u32 s34, s34, 1507328
buffer_store_dword v28, v19, s[4:7], s34 offen sc1
s_branch reca_b3205
reca_last204:
s_cmp_lg_u32 s12, 2
s_cbranch_scc1 reca_exit1
buffer_store_dwordx2 v[52:53], v9, s[4:7], s30 offen
s_branch reca_exit1
reca_swave202:
s_cmp_lg_u32 s17, 63
s_cbranch_scc1 reca_vmst210
s_barrier
ds_read_b128 v[56:59], v1 offset:10240
ds_read_b128 v[60:63], v1 offset:11264
ds_read_b128 v[64:67], v1 offset:12288
s_waitcnt lgkmcnt(0)
v_add_f32 v56, v56, v64
v_add_f32 v60, v60, v48
v_add_f32 v57, v57, v65
v_add_f32 v61, v61, v49
v_add_f32 v58, v58, v66
v_add_f32 v62, v62, v50
v_add_f32 v59, v59, v67
v_add_f32 v63, v63, v51
v_cvt_pk_bf16_f32 v68, v56, v57
v_cvt_pk_bf16_f32 v69, v58, v59
v_cvt_pk_bf16_f32 v70, v60, v61
v_cvt_pk_bf16_f32 v71, v62, v63
buffer_store_dwordx2 v[52:53], v9, s[4:7], s30 offen
buffer_store_dwordx2 v[68:69], v10, s[4:7], s31 offen
buffer_store_dwordx2 v[70:71], v10, s[4:7], s31 offen offset:256
s_branch reca_exit1
reca_vmst210:
s_sleep 1
buffer_load_dwordx4 v[208:211], v1, s[4:7], s21 offen offset:0 sc1
buffer_load_dwordx4 v[212:215], v1, s[4:7], s21 offen offset:1024 sc1
buffer_load_dwordx4 v[216:219], v1, s[4:7], s21 offen offset:2048 sc1
buffer_load_dwordx4 v[220:223], v1, s[4:7], s21 offen offset:3072 sc1
buffer_load_dwordx4 v[224:227], v2, s[4:7], s21 offen offset:0 sc1
buffer_load_dwordx4 v[228:231], v2, s[4:7], s21 offen offset:1024 sc1
s_waitcnt vmcnt(5)
v_max_u32 v29, v208, v210
v_cmp_eq_u32 vcc, -1, v29
s_cbranch_vccnz reca_retry211
reca_resume212:
s_waitcnt vmcnt(4)
v_max_u32 v29, v212, v214
v_cmp_eq_u32 vcc, -1, v29
v_mfma_f32_16x16x32_bf16 v[76:79], a[120:123], v[208:211], 0
v_mfma_f32_16x16x32_bf16 v[80:83], a[144:147], v[208:211], 0
v_mfma_f32_16x16x32_bf16 v[72:75], v[208:211], v[208:211], v[40:43]
s_cbranch_vccnz reca_retry213
reca_resume214:
s_waitcnt vmcnt(3)
v_max_u32 v29, v216, v218
v_cmp_eq_u32 vcc, -1, v29
v_mfma_f32_16x16x32_bf16 v[76:79], a[124:127], v[212:215], v[76:79]
v_mfma_f32_16x16x32_bf16 v[80:83], a[148:151], v[212:215], v[80:83]
v_mfma_f32_16x16x32_bf16 v[72:75], v[212:215], v[212:215], v[72:75]
s_cbranch_vccnz reca_retry215
reca_resume216:
s_waitcnt vmcnt(2)
v_max_u32 v29, v220, v222
v_cmp_eq_u32 vcc, -1, v29
v_mfma_f32_16x16x32_bf16 v[76:79], a[128:131], v[216:219], v[76:79]
v_mfma_f32_16x16x32_bf16 v[80:83], a[152:155], v[216:219], v[80:83]
v_mfma_f32_16x16x32_bf16 v[72:75], v[216:219], v[216:219], v[72:75]
s_cbranch_vccnz reca_retry217
reca_resume218:
s_waitcnt vmcnt(1)
v_max_u32 v29, v224, v226
v_cmp_eq_u32 vcc, -1, v29
v_mfma_f32_16x16x32_bf16 v[76:79], a[132:135], v[220:223], v[76:79]
v_mfma_f32_16x16x32_bf16 v[80:83], a[156:159], v[220:223], v[80:83]
v_mfma_f32_16x16x32_bf16 v[72:75], v[220:223], v[220:223], v[72:75]
s_cbranch_vccnz reca_retry219
reca_resume220:
s_waitcnt vmcnt(0)
v_max_u32 v29, v228, v230
v_cmp_eq_u32 vcc, -1, v29
v_mfma_f32_16x16x32_bf16 v[76:79], a[136:139], v[224:227], v[76:79]
v_mfma_f32_16x16x32_bf16 v[80:83], a[160:163], v[224:227], v[80:83]
v_mfma_f32_16x16x32_bf16 v[72:75], v[224:227], v[224:227], v[72:75]
s_cbranch_vccnz reca_retry221
reca_resume222:
v_mfma_f32_16x16x32_bf16 v[76:79], a[140:143], v[228:231], v[76:79]
v_mfma_f32_16x16x32_bf16 v[80:83], a[164:167], v[228:231], v[80:83]
v_mfma_f32_16x16x32_bf16 v[72:75], v[228:231], v[228:231], v[72:75]
s_barrier
ds_read_b128 v[56:59], v1 offset:10240
ds_read_b128 v[60:63], v1 offset:11264
ds_read_b128 v[64:67], v1 offset:12288
s_nop 1
v_max3_f32 v28, v76, v77, v78
v_max3_f32 v29, v80, v81, v82
v_max3_f32 v28, v28, v79, v83
v_max3_f32 v29, v29, v72, v73
v_max3_f32 v28, v28, v74, v75
v_max_f32 v28, v28, v29
v_mov_b32 v29, v28
s_nop 1
v_permlane32_swap_b32 v28, v29
v_max_f32 v28, v28, v29
v_mov_b32 v29, v28
s_nop 1
v_permlane16_swap_b32 v28, v29
v_max_f32 v28, v28, v29
v_mul_f32 v28, s41, v28
v_fma_f32 v76, v76, s41, -v28
v_fma_f32 v77, v77, s41, -v28
v_fma_f32 v78, v78, s41, -v28
v_fma_f32 v79, v79, s41, -v28
v_fma_f32 v80, v80, s41, -v28
v_fma_f32 v81, v81, s41, -v28
v_fma_f32 v82, v82, s41, -v28
v_fma_f32 v83, v83, s41, -v28
v_fma_f32 v72, v72, s41, -v28
v_fma_f32 v73, v73, s41, -v28
v_fma_f32 v74, v74, s41, -v28
v_fma_f32 v75, v75, s41, -v28
v_exp_f32 v76, v76
v_exp_f32 v77, v77
v_exp_f32 v78, v78
v_exp_f32 v79, v79
v_exp_f32 v80, v80
v_exp_f32 v81, v81
v_exp_f32 v82, v82
v_exp_f32 v83, v83
v_cvt_pk_bf16_f32 v84, v76, v77
v_cvt_pk_bf16_f32 v85, v78, v79
v_cvt_pk_bf16_f32 v86, v80, v81
v_cvt_pk_bf16_f32 v87, v82, v83
v_exp_f32 v72, v72
v_exp_f32 v73, v73
v_mfma_f32_16x16x32_bf16 v[100:103], v[36:39], v[84:87], 0
v_exp_f32 v74, v74
v_exp_f32 v75, v75
v_mfma_f32_16x16x32_bf16 v[92:95], a[168:171], v[84:87], 0
v_cvt_pk_bf16_f32 v88, v72, v73
v_cvt_pk_bf16_f32 v89, v74, v75
v_mfma_f32_16x16x32_bf16 v[96:99], a[172:175], v[84:87], 0
s_waitcnt lgkmcnt(0)
v_mfma_f32_16x16x16_bf16 v[100:103], v[36:37], v[88:89], v[100:103]
v_add_f32 v56, v56, v64
v_add_f32 v60, v60, v48
v_add_f32 v57, v57, v65
v_add_f32 v61, v61, v49
v_add_f32 v58, v58, v66
v_add_f32 v62, v62, v50
v_add_f32 v59, v59, v67
v_add_f32 v63, v63, v51
v_cvt_pk_bf16_f32 v68, v56, v57
v_cvt_pk_bf16_f32 v69, v58, v59
v_cvt_pk_bf16_f32 v70, v60, v61
v_cvt_pk_bf16_f32 v71, v62, v63
v_mfma_f32_16x16x16_bf16 v[92:95], v[68:69], v[88:89], v[92:95]
v_rcp_f32 v28, v100
v_mfma_f32_16x16x16_bf16 v[96:99], v[70:71], v[88:89], v[96:99]
v_mov_b32 v29, v28
s_nop 4
v_pk_mul_f32 v[92:93], v[92:93], v[28:29]
v_pk_mul_f32 v[94:95], v[94:95], v[28:29]
v_pk_mul_f32 v[96:97], v[96:97], v[28:29]
v_pk_mul_f32 v[98:99], v[98:99], v[28:29]
v_cvt_pk_bf16_f32 v104, v92, v93
v_cvt_pk_bf16_f32 v105, v94, v95
v_cvt_pk_bf16_f32 v106, v96, v97
v_cvt_pk_bf16_f32 v107, v98, v99
buffer_store_dwordx4 v[104:107], v11, s[4:7], s22 offen sc1
s_barrier
s_add_u32 s34, s17, 2
s_and_b32 s34, s34, 3
s_mul_i32 s26, s34, 10240
s_add_u32 s26, s26, s38
s_mul_i32 s27, s34, 6144
s_add_u32 s27, s27, s39
s_mul_i32 s28, s34, 12288
s_add_u32 s28, s28, s40
s_mul_i32 s29, s34, 393216
s_add_u32 s29, s29, s56
buffer_store_dwordx2 v[32:33], v8, s[4:7], s27 offen sc1
buffer_store_dwordx4 v[32:35], v11, s[4:7], s28 offen sc1
s_add_u32 s36, s17, 1
s_cmp_ge_u32 s36, 63
s_cbranch_scc1 reca_nopf223
s_add_u32 s37, s36, 1
reca_pf224:
buffer_load_dword v28, v233, s[4:7], 0 offen sc1
s_waitcnt vmcnt(0)
v_cmp_gt_i32 vcc, s37, v28
s_cbranch_vccz reca_pfok225
s_sleep 1
s_sub_u32 s18, s18, 1
s_cbranch_scc0 reca_pf224
s_mov_b32 s18, 0
reca_pfok225:
s_lshl_b32 s34, s15, 3
s_and_b32 s35, s36, 7
s_add_u32 s34, s34, s35
s_mul_i32 s34, s34, 12288
s_add_u32 s32, s34, 37748736
s_lshl_b32 s35, s16, 11
s_add_u32 s34, s34, s35
s_add_u32 s33, s34, 40894464
buffer_load_dwordx4 a[120:123], v1, s[4:7], s32 offen offset:0 sc1
buffer_load_dwordx4 a[124:127], v1, s[4:7], s32 offen offset:1024 sc1
buffer_load_dwordx4 a[128:131], v1, s[4:7], s32 offen offset:2048 sc1
buffer_load_dwordx4 a[132:135], v1, s[4:7], s32 offen offset:3072 sc1
buffer_load_dwordx4 a[136:139], v2, s[4:7], s32 offen offset:0 sc1
buffer_load_dwordx4 a[140:143], v2, s[4:7], s32 offen offset:1024 sc1
buffer_load_dwordx4 a[144:147], v2, s[4:7], s32 offen offset:2048 sc1
buffer_load_dwordx4 a[148:151], v2, s[4:7], s32 offen offset:3072 sc1
buffer_load_dwordx4 a[152:155], v3, s[4:7], s32 offen offset:0 sc1
buffer_load_dwordx4 a[156:159], v3, s[4:7], s32 offen offset:1024 sc1
buffer_load_dwordx4 a[160:163], v3, s[4:7], s32 offen offset:2048 sc1
buffer_load_dwordx4 a[164:167], v3, s[4:7], s32 offen offset:3072 sc1
buffer_load_dwordx4 a[168:171], v1, s[4:7], s33 offen offset:0 sc1
buffer_load_dwordx4 a[172:175], v1, s[4:7], s33 offen offset:1024 sc1
reca_nopf223:
buffer_store_dwordx2 v[52:53], v9, s[4:7], s30 offen sc1
buffer_store_dwordx2 v[68:69], v10, s[4:7], s31 offen sc1
buffer_store_dwordx2 v[70:71], v10, s[4:7], s31 offen offset:256 sc1
reca_b5207:
s_barrier
s_add_u32 s17, s17, 1
s_branch reca_step193
reca_b3205:
s_endpgm
reca_retry196:
s_sub_u32 s18, s18, 1
s_cbranch_scc1 reca_retry196_to
buffer_load_dwordx4 v[128:131], v4, s[4:7], s20 offen sc1
buffer_load_dwordx4 v[132:135], v4, s[4:7], s20 offen offset:1024 sc1
buffer_load_dwordx4 v[136:139], v5, s[4:7], s20 offen sc1
s_waitcnt vmcnt(2)
v_max_u32 v29, v128, v130
v_cmp_eq_u32 vcc, -1, v29
s_cbranch_vccnz reca_retry196
s_branch reca_resume197
reca_retry196_to:
s_mov_b32 s18, 0
s_waitcnt vmcnt(0)
s_branch reca_resume197
reca_retry198:
s_sub_u32 s18, s18, 1
s_cbranch_scc1 reca_retry198_to
buffer_load_dwordx4 v[132:135], v4, s[4:7], s20 offen offset:1024 sc1
buffer_load_dwordx4 v[136:139], v5, s[4:7], s20 offen sc1
s_waitcnt vmcnt(1)
v_max_u32 v29, v132, v134
v_cmp_eq_u32 vcc, -1, v29
s_cbranch_vccnz reca_retry198
s_branch reca_resume199
reca_retry198_to:
s_mov_b32 s18, 0
s_waitcnt vmcnt(0)
s_branch reca_resume199
reca_retry200:
s_sub_u32 s18, s18, 1
s_cbranch_scc1 reca_retry200_to
buffer_load_dwordx4 v[136:139], v5, s[4:7], s20 offen sc1
s_waitcnt vmcnt(0)
v_max_u32 v29, v136, v138
v_cmp_eq_u32 vcc, -1, v29
s_cbranch_vccnz reca_retry200
s_branch reca_resume201
reca_retry200_to:
s_mov_b32 s18, 0
s_waitcnt vmcnt(0)
s_branch reca_resume201
reca_retry211:
s_sub_u32 s18, s18, 1
s_cbranch_scc1 reca_retry211_to
buffer_load_dwordx4 v[208:211], v1, s[4:7], s21 offen offset:0 sc1
buffer_load_dwordx4 v[212:215], v1, s[4:7], s21 offen offset:1024 sc1
buffer_load_dwordx4 v[216:219], v1, s[4:7], s21 offen offset:2048 sc1
buffer_load_dwordx4 v[220:223], v1, s[4:7], s21 offen offset:3072 sc1
buffer_load_dwordx4 v[224:227], v2, s[4:7], s21 offen offset:0 sc1
buffer_load_dwordx4 v[228:231], v2, s[4:7], s21 offen offset:1024 sc1
s_waitcnt vmcnt(5)
v_max_u32 v29, v208, v210
v_cmp_eq_u32 vcc, -1, v29
s_cbranch_vccnz reca_retry211
s_branch reca_resume212
reca_retry211_to:
s_mov_b32 s18, 0
s_waitcnt vmcnt(0)
s_branch reca_resume212
reca_retry213:
s_sub_u32 s18, s18, 1
s_cbranch_scc1 reca_retry213_to
buffer_load_dwordx4 v[212:215], v1, s[4:7], s21 offen offset:1024 sc1
buffer_load_dwordx4 v[216:219], v1, s[4:7], s21 offen offset:2048 sc1
buffer_load_dwordx4 v[220:223], v1, s[4:7], s21 offen offset:3072 sc1
buffer_load_dwordx4 v[224:227], v2, s[4:7], s21 offen offset:0 sc1
buffer_load_dwordx4 v[228:231], v2, s[4:7], s21 offen offset:1024 sc1
s_waitcnt vmcnt(4)
v_max_u32 v29, v212, v214
v_cmp_eq_u32 vcc, -1, v29
s_cbranch_vccnz reca_retry213
s_branch reca_resume214
reca_retry213_to:
s_mov_b32 s18, 0
s_waitcnt vmcnt(0)
s_branch reca_resume214
reca_retry215:
s_sub_u32 s18, s18, 1
s_cbranch_scc1 reca_retry215_to
buffer_load_dwordx4 v[216:219], v1, s[4:7], s21 offen offset:2048 sc1
buffer_load_dwordx4 v[220:223], v1, s[4:7], s21 offen offset:3072 sc1
buffer_load_dwordx4 v[224:227], v2, s[4:7], s21 offen offset:0 sc1
buffer_load_dwordx4 v[228:231], v2, s[4:7], s21 offen offset:1024 sc1
s_waitcnt vmcnt(3)
v_max_u32 v29, v216, v218
v_cmp_eq_u32 vcc, -1, v29
s_cbranch_vccnz reca_retry215
s_branch reca_resume216
reca_retry215_to:
s_mov_b32 s18, 0
s_waitcnt vmcnt(0)
s_branch reca_resume216
reca_retry217:
s_sub_u32 s18, s18, 1
s_cbranch_scc1 reca_retry217_to
buffer_load_dwordx4 v[220:223], v1, s[4:7], s21 offen offset:3072 sc1
buffer_load_dwordx4 v[224:227], v2, s[4:7], s21 offen offset:0 sc1
buffer_load_dwordx4 v[228:231], v2, s[4:7], s21 offen offset:1024 sc1
s_waitcnt vmcnt(2)
v_max_u32 v29, v220, v222
v_cmp_eq_u32 vcc, -1, v29
s_cbranch_vccnz reca_retry217
s_branch reca_resume218
reca_retry217_to:
s_mov_b32 s18, 0
s_waitcnt vmcnt(0)
s_branch reca_resume218
reca_retry219:
s_sub_u32 s18, s18, 1
s_cbranch_scc1 reca_retry219_to
buffer_load_dwordx4 v[224:227], v2, s[4:7], s21 offen offset:0 sc1
buffer_load_dwordx4 v[228:231], v2, s[4:7], s21 offen offset:1024 sc1
s_waitcnt vmcnt(1)
v_max_u32 v29, v224, v226
v_cmp_eq_u32 vcc, -1, v29
s_cbranch_vccnz reca_retry219
s_branch reca_resume220
reca_retry219_to:
s_mov_b32 s18, 0
s_waitcnt vmcnt(0)
s_branch reca_resume220
reca_retry221:
s_sub_u32 s18, s18, 1
s_cbranch_scc1 reca_retry221_to
buffer_load_dwordx4 v[228:231], v2, s[4:7], s21 offen offset:1024 sc1
s_waitcnt vmcnt(0)
v_max_u32 v29, v228, v230
v_cmp_eq_u32 vcc, -1, v29
s_cbranch_vccnz reca_retry221
s_branch reca_resume222
reca_retry221_to:
s_mov_b32 s18, 0
s_waitcnt vmcnt(0)
s_branch reca_resume222
reca_proj2:
s_sub_u32 s34, s14, 24
s_lshr_b32 s35, s34, 1
s_and_b32 s16, s34, 1
s_lshl_b32 s15, s13, 2
s_add_u32 s15, s15, s35
s_lshl_b32 s24, s13, 3
s_add_u32 s24, s24, s34
s_lshl_b32 s24, s24, 7
s_add_u32 s24, s24, 1540096
s_lshl_b32 s25, s13, 7
s_add_u32 s25, s25, 1507328
v_and_b32 v28, 63, v0
v_lshlrev_b32 v1, 4, v28
v_mov_b32 v29, 0x80000000
v_cmp_eq_u32 vcc, 0, v28
v_mov_b32 v4, 0
s_nop 0
v_cndmask_b32 v4, v29, v4, vcc
v_cmp_gt_u32 vcc, 32, v28
s_nop 1
v_cndmask_b32 v5, v29, v1, vcc
s_cmp_eq_u32 s12, 0
s_cbranch_scc1 reca_pw0_226
s_cmp_eq_u32 s12, 1
s_cbranch_scc1 reca_pw1_227
s_cmp_eq_u32 s12, 2
s_cbranch_scc1 reca_pw2_228
s_branch reca_pw3_229
reca_pw0_226:
s_mov_b32 s17, 0
s_mov_b32 s26, 0
s_mul_i32 s20, s17, 40960
s_add_u32 s20, s20, 84934656
s_add_u32 m0, s26, 0
s_nop 0
buffer_load_dwordx4 v1, s[4:7], s20 offen offset:0 lds
buffer_load_dwordx4 v1, s[4:7], s20 offen offset:1024 lds
buffer_load_dwordx4 v1, s[4:7], s20 offen offset:2048 lds
buffer_load_dwordx4 v1, s[4:7], s20 offen offset:3072 lds
s_add_u32 s20, s20, 4096
s_add_u32 m0, s26, 4096
s_nop 0
buffer_load_dwordx4 v1, s[4:7], s20 offen offset:0 lds
buffer_load_dwordx4 v1, s[4:7], s20 offen offset:1024 lds
buffer_load_dwordx4 v1, s[4:7], s20 offen offset:2048 lds
buffer_load_dwordx4 v1, s[4:7], s20 offen offset:3072 lds
s_add_u32 s20, s20, 4096
s_add_u32 m0, s26, 8192
s_nop 0
buffer_load_dwordx4 v1, s[4:7], s20 offen offset:0 lds
buffer_load_dwordx4 v1, s[4:7], s20 offen offset:1024 lds
s_mul_i32 s34, s15, 12
s_mul_i32 s35, s16, 6
s_add_u32 s34, s34, s35
s_add_u32 s34, s34, 0
s_mul_i32 s34, s34, 20480
s_add_u32 s34, s34, 14155776
buffer_load_dwordx4 a[0:3], v1, s[4:7], s34 offen offset:0
buffer_load_dwordx4 a[4:7], v1, s[4:7], s34 offen offset:1024
buffer_load_dwordx4 a[8:11], v1, s[4:7], s34 offen offset:2048
buffer_load_dwordx4 a[12:15], v1, s[4:7], s34 offen offset:3072
s_add_u32 s34, s34, 4096
buffer_load_dwordx4 a[16:19], v1, s[4:7], s34 offen offset:0
buffer_load_dwordx4 a[20:23], v1, s[4:7], s34 offen offset:1024
buffer_load_dwordx4 a[24:27], v1, s[4:7], s34 offen offset:2048
buffer_load_dwordx4 a[28:31], v1, s[4:7], s34 offen offset:3072
s_add_u32 s34, s34, 4096
buffer_load_dwordx4 a[32:35], v1, s[4:7], s34 offen offset:0
buffer_load_dwordx4 a[36:39], v1, s[4:7], s34 offen offset:1024
buffer_load_dwordx4 a[40:43], v1, s[4:7], s34 offen offset:2048
buffer_load_dwordx4 a[44:47], v1, s[4:7], s34 offen offset:3072
s_add_u32 s34, s34, 4096
buffer_load_dwordx4 a[48:51], v1, s[4:7], s34 offen offset:0
buffer_load_dwordx4 a[52:55], v1, s[4:7], s34 offen offset:1024
buffer_load_dwordx4 a[56:59], v1, s[4:7], s34 offen offset:2048
buffer_load_dwordx4 a[60:63], v1, s[4:7], s34 offen offset:3072
s_add_u32 s34, s34, 4096
buffer_load_dwordx4 a[64:67], v1, s[4:7], s34 offen offset:0
buffer_load_dwordx4 a[68:71], v1, s[4:7], s34 offen offset:1024
buffer_load_dwordx4 a[72:75], v1, s[4:7], s34 offen offset:2048
buffer_load_dwordx4 a[76:79], v1, s[4:7], s34 offen offset:3072
s_mul_i32 s34, s15, 12
s_mul_i32 s35, s16, 6
s_add_u32 s34, s34, s35
s_add_u32 s34, s34, 1
s_mul_i32 s34, s34, 20480
s_add_u32 s34, s34, 14155776
buffer_load_dwordx4 a[80:83], v1, s[4:7], s34 offen offset:0
buffer_load_dwordx4 a[84:87], v1, s[4:7], s34 offen offset:1024
buffer_load_dwordx4 a[88:91], v1, s[4:7], s34 offen offset:2048
buffer_load_dwordx4 a[92:95], v1, s[4:7], s34 offen offset:3072
s_add_u32 s34, s34, 4096
buffer_load_dwordx4 a[96:99], v1, s[4:7], s34 offen offset:0
buffer_load_dwordx4 a[100:103], v1, s[4:7], s34 offen offset:1024
buffer_load_dwordx4 a[104:107], v1, s[4:7], s34 offen offset:2048
buffer_load_dwordx4 a[108:111], v1, s[4:7], s34 offen offset:3072
s_add_u32 s34, s34, 4096
buffer_load_dwordx4 a[112:115], v1, s[4:7], s34 offen offset:0
buffer_load_dwordx4 a[116:119], v1, s[4:7], s34 offen offset:1024
buffer_load_dwordx4 a[120:123], v1, s[4:7], s34 offen offset:2048
buffer_load_dwordx4 a[124:127], v1, s[4:7], s34 offen offset:3072
s_add_u32 s34, s34, 4096
buffer_load_dwordx4 a[128:131], v1, s[4:7], s34 offen offset:0
buffer_load_dwordx4 a[132:135], v1, s[4:7], s34 offen offset:1024
buffer_load_dwordx4 a[136:139], v1, s[4:7], s34 offen offset:2048
buffer_load_dwordx4 a[140:143], v1, s[4:7], s34 offen offset:3072
s_add_u32 s34, s34, 4096
buffer_load_dwordx4 a[144:147], v1, s[4:7], s34 offen offset:0
buffer_load_dwordx4 a[148:151], v1, s[4:7], s34 offen offset:1024
buffer_load_dwordx4 a[152:155], v1, s[4:7], s34 offen offset:2048
buffer_load_dwordx4 a[156:159], v1, s[4:7], s34 offen offset:3072
s_waitcnt vmcnt(20)
s_mul_i32 s34, s15, 12
s_mul_i32 s35, s16, 6
s_add_u32 s34, s34, s35
s_add_u32 s34, s34, 2
s_mul_i32 s34, s34, 20480
s_add_u32 s34, s34, 14155776
buffer_load_dwordx4 a[160:163], v1, s[4:7], s34 offen offset:0
buffer_load_dwordx4 a[164:167], v1, s[4:7], s34 offen offset:1024
buffer_load_dwordx4 a[168:171], v1, s[4:7], s34 offen offset:2048
buffer_load_dwordx4 a[172:175], v1, s[4:7], s34 offen offset:3072
s_add_u32 s34, s34, 4096
buffer_load_dwordx4 a[176:179], v1, s[4:7], s34 offen offset:0
buffer_load_dwordx4 a[180:183], v1, s[4:7], s34 offen offset:1024
buffer_load_dwordx4 a[184:187], v1, s[4:7], s34 offen offset:2048
buffer_load_dwordx4 a[188:191], v1, s[4:7], s34 offen offset:3072
s_add_u32 s34, s34, 4096
buffer_load_dwordx4 a[192:195], v1, s[4:7], s34 offen offset:0
buffer_load_dwordx4 a[196:199], v1, s[4:7], s34 offen offset:1024
buffer_load_dwordx4 a[200:203], v1, s[4:7], s34 offen offset:2048
buffer_load_dwordx4 a[204:207], v1, s[4:7], s34 offen offset:3072
s_add_u32 s34, s34, 4096
buffer_load_dwordx4 a[208:211], v1, s[4:7], s34 offen offset:0
buffer_load_dwordx4 a[212:215], v1, s[4:7], s34 offen offset:1024
buffer_load_dwordx4 a[216:219], v1, s[4:7], s34 offen offset:2048
buffer_load_dwordx4 a[220:223], v1, s[4:7], s34 offen offset:3072
s_add_u32 s34, s34, 4096
buffer_load_dwordx4 a[224:227], v1, s[4:7], s34 offen offset:0
buffer_load_dwordx4 a[228:231], v1, s[4:7], s34 offen offset:1024
buffer_load_dwordx4 a[232:235], v1, s[4:7], s34 offen offset:2048
buffer_load_dwordx4 a[236:239], v1, s[4:7], s34 offen offset:3072
s_waitcnt vmcnt(20)
s_mul_i32 s34, s15, 12
s_mul_i32 s35, s16, 6
s_add_u32 s34, s34, s35
s_add_u32 s34, s34, 3
s_mul_i32 s34, s34, 20480
s_add_u32 s34, s34, 14155776
buffer_load_dwordx4 v[96:99], v1, s[4:7], s34 offen offset:0
buffer_load_dwordx4 v[100:103], v1, s[4:7], s34 offen offset:1024
buffer_load_dwordx4 v[104:107], v1, s[4:7], s34 offen offset:2048
buffer_load_dwordx4 v[108:111], v1, s[4:7], s34 offen offset:3072
s_add_u32 s34, s34, 4096
buffer_load_dwordx4 v[112:115], v1, s[4:7], s34 offen offset:0
buffer_load_dwordx4 v[116:119], v1, s[4:7], s34 offen offset:1024
buffer_load_dwordx4 v[120:123], v1, s[4:7], s34 offen offset:2048
buffer_load_dwordx4 v[124:127], v1, s[4:7], s34 offen offset:3072
s_add_u32 s34, s34, 4096
buffer_load_dwordx4 v[128:131], v1, s[4:7], s34 offen offset:0
buffer_load_dwordx4 v[132:135], v1, s[4:7], s34 offen offset:1024
buffer_load_dwordx4 v[136:139], v1, s[4:7], s34 offen offset:2048
buffer_load_dwordx4 v[140:143], v1, s[4:7], s34 offen offset:3072
s_add_u32 s34, s34, 4096
buffer_load_dwordx4 v[144:147], v1, s[4:7], s34 offen offset:0
buffer_load_dwordx4 v[148:151], v1, s[4:7], s34 offen offset:1024
buffer_load_dwordx4 v[152:155], v1, s[4:7], s34 offen offset:2048
buffer_load_dwordx4 v[156:159], v1, s[4:7], s34 offen offset:3072
s_add_u32 s34, s34, 4096
buffer_load_dwordx4 v[160:163], v1, s[4:7], s34 offen offset:0
buffer_load_dwordx4 v[164:167], v1, s[4:7], s34 offen offset:1024
buffer_load_dwordx4 v[168:171], v1, s[4:7], s34 offen offset:2048
buffer_load_dwordx4 v[172:175], v1, s[4:7], s34 offen offset:3072
s_waitcnt vmcnt(20)
s_mul_i32 s34, s15, 12
s_mul_i32 s35, s16, 6
s_add_u32 s34, s34, s35
s_add_u32 s34, s34, 0
s_mul_i32 s34, s34, 20480
s_add_u32 s34, s34, 22020096
buffer_load_dwordx4 v[176:179], v1, s[4:7], s34 offen offset:0
buffer_load_dwordx4 v[180:183], v1, s[4:7], s34 offen offset:1024
buffer_load_dwordx4 v[184:187], v1, s[4:7], s34 offen offset:2048
buffer_load_dwordx4 v[188:191], v1, s[4:7], s34 offen offset:3072
s_add_u32 s34, s34, 4096
buffer_load_dwordx4 v[192:195], v1, s[4:7], s34 offen offset:0
buffer_load_dwordx4 v[196:199], v1, s[4:7], s34 offen offset:1024
buffer_load_dwordx4 v[200:203], v1, s[4:7], s34 offen offset:2048
buffer_load_dwordx4 v[204:207], v1, s[4:7], s34 offen offset:3072
s_add_u32 s34, s34, 4096
buffer_load_dwordx4 v[208:211], v1, s[4:7], s34 offen offset:0
buffer_load_dwordx4 v[212:215], v1, s[4:7], s34 offen offset:1024
buffer_load_dwordx4 v[216:219], v1, s[4:7], s34 offen offset:2048
buffer_load_dwordx4 v[220:223], v1, s[4:7], s34 offen offset:3072
s_add_u32 s34, s34, 4096
buffer_load_dwordx4 v[224:227], v1, s[4:7], s34 offen offset:0
buffer_load_dwordx4 v[228:231], v1, s[4:7], s34 offen offset:1024
buffer_load_dwordx4 v[232:235], v1, s[4:7], s34 offen offset:2048
buffer_load_dwordx4 v[236:239], v1, s[4:7], s34 offen offset:3072
s_add_u32 s34, s34, 4096
buffer_load_dwordx4 v[240:243], v1, s[4:7], s34 offen offset:0
buffer_load_dwordx4 v[244:247], v1, s[4:7], s34 offen offset:1024
buffer_load_dwordx4 v[248:251], v1, s[4:7], s34 offen offset:2048
buffer_load_dwordx4 v[252:255], v1, s[4:7], s34 offen offset:3072
s_waitcnt vmcnt(20)
v_and_b32 v30, 7, v0
v_lshlrev_b32 v30, 3, v30
reca_cens230:
buffer_load_dwordx2 v[28:29], v30, s[8:11], 0 offen sc1
s_waitcnt vmcnt(0)
v_sad_u8 v31, v28, 0, 0
v_sad_u8 v31, v29, 0, v31
v_cmp_gt_u32 vcc, 32, v31
s_cbranch_vccz reca_censok231
s_sleep 8
s_sub_u32 s18, s18, 1
s_cbranch_scc0 reca_cens230
s_mov_b32 s18, 0
reca_censok231:
v_and_b32 v28, 0x20202020, v28
v_and_b32 v29, 0x20202020, v29
v_cmp_ne_u32 s[34:35], 0, v28
v_cmp_ne_u32 s[36:37], 0, v29
s_nop 3
s_and_b32 s34, s34, 0xff
s_and_b32 s36, s36, 0xff
s_or_b32 s35, s34, s36
s_lshr_b32 s37, s35, s13
s_and_b32 s37, s37, 1
s_xor_b32 s43, s37, 1
s_cmp_eq_u32 s57, 0
s_cselect_b32 s58, s36, s34
v_mov_b32 v31, 0x80000000
s_cmp_lg_u32 s43, 0
s_cbranch_scc1 reca_pslow232
reca_ptop233:
s_cmp_lt_u32 s17, 3
s_cbranch_scc1 reca_pgo234
s_sub_u32 s36, s17, 3
reca_ppoll235:
buffer_load_dword v28, v4, s[4:7], s25 offen sc1
s_waitcnt vmcnt(0)
v_readfirstlane_b32 s34, v28
s_nop 3
s_cmp_ge_i32 s34, s36
s_cbranch_scc1 reca_pgo234
s_sleep 8
s_sub_u32 s18, s18, 1
s_cbranch_scc0 reca_ppoll235
s_mov_b32 s18, 0
reca_pgo234:
s_waitcnt vmcnt(0)
s_barrier
v_add_u32 v7, s26, v1
s_xor_b32 s26, s26, 40960
s_add_u32 s37, s17, 1
s_cmp_ge_u32 s37, 64
s_cbranch_scc1 reca_pnodma236
s_mul_i32 s20, s37, 40960
s_add_u32 s20, s20, 84934656
s_add_u32 m0, s26, 0
s_nop 0
buffer_load_dwordx4 v1, s[4:7], s20 offen offset:0 lds
buffer_load_dwordx4 v1, s[4:7], s20 offen offset:1024 lds
buffer_load_dwordx4 v1, s[4:7], s20 offen offset:2048 lds
buffer_load_dwordx4 v1, s[4:7], s20 offen offset:3072 lds
s_add_u32 s20, s20, 4096
s_add_u32 m0, s26, 4096
s_nop 0
buffer_load_dwordx4 v1, s[4:7], s20 offen offset:0 lds
buffer_load_dwordx4 v1, s[4:7], s20 offen offset:1024 lds
buffer_load_dwordx4 v1, s[4:7], s20 offen offset:2048 lds
buffer_load_dwordx4 v1, s[4:7], s20 offen offset:3072 lds
s_add_u32 s20, s20, 4096
s_add_u32 m0, s26, 8192
s_nop 0
buffer_load_dwordx4 v1, s[4:7], s20 offen offset:0 lds
buffer_load_dwordx4 v1, s[4:7], s20 offen offset:1024 lds
reca_pnodma236:
s_lshl_b32 s34, s15, 3
s_and_b32 s35, s17, 7
s_add_u32 s34, s34, s35
s_mul_i32 s34, s34, 12288
s_mul_i32 s35, s16, 3072
s_add_u32 s35, s35, s34
s_add_u32 s21, s35, 37748736
s_add_u32 s22, s35, 44040192
s_mul_i32 s35, s16, 6144
s_add_u32 s35, s35, s34
s_add_u32 s23, s35, 40894464
ds_read_b128 v[72:75], v7 offset:0
ds_read_b128 v[76:79], v7 offset:20480
ds_read_b128 v[80:83], v7 offset:1024
ds_read_b128 v[84:87], v7 offset:21504
ds_read_b128 v[88:91], v7 offset:2048
ds_read_b128 v[92:95], v7 offset:22528
s_waitcnt lgkmcnt(4)
v_mfma_f32_16x16x32_bf16 v[32:35], a[0:3], v[72:75], 0
v_mfma_f32_16x16x32_bf16 v[36:39], a[0:3], v[76:79], 0
v_mfma_f32_16x16x32_bf16 v[40:43], a[80:83], v[72:75], 0
v_mfma_f32_16x16x32_bf16 v[44:47], a[80:83], v[76:79], 0
v_mfma_f32_16x16x32_bf16 v[48:51], a[160:163], v[72:75], 0
v_mfma_f32_16x16x32_bf16 v[52:55], a[160:163], v[76:79], 0
v_mfma_f32_16x16x32_bf16 v[56:59], v[96:99], v[72:75], 0
v_mfma_f32_16x16x32_bf16 v[60:63], v[96:99], v[76:79], 0
v_mfma_f32_16x16x32_bf16 v[64:67], v[72:75], v[176:179], 0
v_mfma_f32_16x16x32_bf16 v[68:71], v[76:79], v[176:179], 0
ds_read_b128 v[72:75], v7 offset:3072
ds_read_b128 v[76:79], v7 offset:23552
s_waitcnt lgkmcnt(4)
v_mfma_f32_16x16x32_bf16 v[32:35], a[4:7], v[80:83], v[32:35]
v_mfma_f32_16x16x32_bf16 v[36:39], a[4:7], v[84:87], v[36:39]
v_mfma_f32_16x16x32_bf16 v[40:43], a[84:87], v[80:83], v[40:43]
v_mfma_f32_16x16x32_bf16 v[44:47], a[84:87], v[84:87], v[44:47]
v_mfma_f32_16x16x32_bf16 v[48:51], a[164:167], v[80:83], v[48:51]
v_mfma_f32_16x16x32_bf16 v[52:55], a[164:167], v[84:87], v[52:55]
v_mfma_f32_16x16x32_bf16 v[56:59], v[100:103], v[80:83], v[56:59]
v_mfma_f32_16x16x32_bf16 v[60:63], v[100:103], v[84:87], v[60:63]
v_mfma_f32_16x16x32_bf16 v[64:67], v[80:83], v[180:183], v[64:67]
v_mfma_f32_16x16x32_bf16 v[68:71], v[84:87], v[180:183], v[68:71]
ds_read_b128 v[80:83], v7 offset:4096
ds_read_b128 v[84:87], v7 offset:24576
s_waitcnt lgkmcnt(4)
v_mfma_f32_16x16x32_bf16 v[32:35], a[8:11], v[88:91], v[32:35]
v_mfma_f32_16x16x32_bf16 v[36:39], a[8:11], v[92:95], v[36:39]
v_mfma_f32_16x16x32_bf16 v[40:43], a[88:91], v[88:91], v[40:43]
v_mfma_f32_16x16x32_bf16 v[44:47], a[88:91], v[92:95], v[44:47]
v_mfma_f32_16x16x32_bf16 v[48:51], a[168:171], v[88:91], v[48:51]
v_mfma_f32_16x16x32_bf16 v[52:55], a[168:171], v[92:95], v[52:55]
v_mfma_f32_16x16x32_bf16 v[56:59], v[104:107], v[88:91], v[56:59]
v_mfma_f32_16x16x32_bf16 v[60:63], v[104:107], v[92:95], v[60:63]
v_mfma_f32_16x16x32_bf16 v[64:67], v[88:91], v[184:187], v[64:67]
v_mfma_f32_16x16x32_bf16 v[68:71], v[92:95], v[184:187], v[68:71]
ds_read_b128 v[88:91], v7 offset:5120
ds_read_b128 v[92:95], v7 offset:25600
s_waitcnt lgkmcnt(4)
v_mfma_f32_16x16x32_bf16 v[32:35], a[12:15], v[72:75], v[32:35]
v_mfma_f32_16x16x32_bf16 v[36:39], a[12:15], v[76:79], v[36:39]
v_mfma_f32_16x16x32_bf16 v[40:43], a[92:95], v[72:75], v[40:43]
v_mfma_f32_16x16x32_bf16 v[44:47], a[92:95], v[76:79], v[44:47]
v_mfma_f32_16x16x32_bf16 v[48:51], a[172:175], v[72:75], v[48:51]
v_mfma_f32_16x16x32_bf16 v[52:55], a[172:175], v[76:79], v[52:55]
v_mfma_f32_16x16x32_bf16 v[56:59], v[108:111], v[72:75], v[56:59]
v_mfma_f32_16x16x32_bf16 v[60:63], v[108:111], v[76:79], v[60:63]
v_mfma_f32_16x16x32_bf16 v[64:67], v[72:75], v[188:191], v[64:67]
v_mfma_f32_16x16x32_bf16 v[68:71], v[76:79], v[188:191], v[68:71]
ds_read_b128 v[72:75], v7 offset:6144
ds_read_b128 v[76:79], v7 offset:26624
s_waitcnt lgkmcnt(4)
v_mfma_f32_16x16x32_bf16 v[32:35], a[16:19], v[80:83], v[32:35]
v_mfma_f32_16x16x32_bf16 v[36:39], a[16:19], v[84:87], v[36:39]
v_mfma_f32_16x16x32_bf16 v[40:43], a[96:99], v[80:83], v[40:43]
v_mfma_f32_16x16x32_bf16 v[44:47], a[96:99], v[84:87], v[44:47]
v_mfma_f32_16x16x32_bf16 v[48:51], a[176:179], v[80:83], v[48:51]
v_mfma_f32_16x16x32_bf16 v[52:55], a[176:179], v[84:87], v[52:55]
v_mfma_f32_16x16x32_bf16 v[56:59], v[112:115], v[80:83], v[56:59]
v_mfma_f32_16x16x32_bf16 v[60:63], v[112:115], v[84:87], v[60:63]
v_mfma_f32_16x16x32_bf16 v[64:67], v[80:83], v[192:195], v[64:67]
v_mfma_f32_16x16x32_bf16 v[68:71], v[84:87], v[192:195], v[68:71]
ds_read_b128 v[80:83], v7 offset:7168
ds_read_b128 v[84:87], v7 offset:27648
s_waitcnt lgkmcnt(4)
v_mfma_f32_16x16x32_bf16 v[32:35], a[20:23], v[88:91], v[32:35]
v_mfma_f32_16x16x32_bf16 v[36:39], a[20:23], v[92:95], v[36:39]
v_mfma_f32_16x16x32_bf16 v[40:43], a[100:103], v[88:91], v[40:43]
v_mfma_f32_16x16x32_bf16 v[44:47], a[100:103], v[92:95], v[44:47]
v_mfma_f32_16x16x32_bf16 v[48:51], a[180:183], v[88:91], v[48:51]
v_mfma_f32_16x16x32_bf16 v[52:55], a[180:183], v[92:95], v[52:55]
v_mfma_f32_16x16x32_bf16 v[56:59], v[116:119], v[88:91], v[56:59]
v_mfma_f32_16x16x32_bf16 v[60:63], v[116:119], v[92:95], v[60:63]
v_mfma_f32_16x16x32_bf16 v[64:67], v[88:91], v[196:199], v[64:67]
v_mfma_f32_16x16x32_bf16 v[68:71], v[92:95], v[196:199], v[68:71]
ds_read_b128 v[88:91], v7 offset:8192
ds_read_b128 v[92:95], v7 offset:28672
s_waitcnt lgkmcnt(4)
v_mfma_f32_16x16x32_bf16 v[32:35], a[24:27], v[72:75], v[32:35]
v_mfma_f32_16x16x32_bf16 v[36:39], a[24:27], v[76:79], v[36:39]
v_mfma_f32_16x16x32_bf16 v[40:43], a[104:107], v[72:75], v[40:43]
v_mfma_f32_16x16x32_bf16 v[44:47], a[104:107], v[76:79], v[44:47]
v_mfma_f32_16x16x32_bf16 v[48:51], a[184:187], v[72:75], v[48:51]
v_mfma_f32_16x16x32_bf16 v[52:55], a[184:187], v[76:79], v[52:55]
v_mfma_f32_16x16x32_bf16 v[56:59], v[120:123], v[72:75], v[56:59]
v_mfma_f32_16x16x32_bf16 v[60:63], v[120:123], v[76:79], v[60:63]
v_mfma_f32_16x16x32_bf16 v[64:67], v[72:75], v[200:203], v[64:67]
v_mfma_f32_16x16x32_bf16 v[68:71], v[76:79], v[200:203], v[68:71]
ds_read_b128 v[72:75], v7 offset:9216
ds_read_b128 v[76:79], v7 offset:29696
s_waitcnt lgkmcnt(4)
v_mfma_f32_16x16x32_bf16 v[32:35], a[28:31], v[80:83], v[32:35]
v_mfma_f32_16x16x32_bf16 v[36:39], a[28:31], v[84:87], v[36:39]
v_mfma_f32_16x16x32_bf16 v[40:43], a[108:111], v[80:83], v[40:43]
v_mfma_f32_16x16x32_bf16 v[44:47], a[108:111], v[84:87], v[44:47]
v_mfma_f32_16x16x32_bf16 v[48:51], a[188:191], v[80:83], v[48:51]
v_mfma_f32_16x16x32_bf16 v[52:55], a[188:191], v[84:87], v[52:55]
v_mfma_f32_16x16x32_bf16 v[56:59], v[124:127], v[80:83], v[56:59]
v_mfma_f32_16x16x32_bf16 v[60:63], v[124:127], v[84:87], v[60:63]
v_mfma_f32_16x16x32_bf16 v[64:67], v[80:83], v[204:207], v[64:67]
v_mfma_f32_16x16x32_bf16 v[68:71], v[84:87], v[204:207], v[68:71]
ds_read_b128 v[80:83], v7 offset:10240
ds_read_b128 v[84:87], v7 offset:30720
s_waitcnt lgkmcnt(4)
v_mfma_f32_16x16x32_bf16 v[32:35], a[32:35], v[88:91], v[32:35]
v_mfma_f32_16x16x32_bf16 v[36:39], a[32:35], v[92:95], v[36:39]
v_mfma_f32_16x16x32_bf16 v[40:43], a[112:115], v[88:91], v[40:43]
v_mfma_f32_16x16x32_bf16 v[44:47], a[112:115], v[92:95], v[44:47]
v_mfma_f32_16x16x32_bf16 v[48:51], a[192:195], v[88:91], v[48:51]
v_mfma_f32_16x16x32_bf16 v[52:55], a[192:195], v[92:95], v[52:55]
v_mfma_f32_16x16x32_bf16 v[56:59], v[128:131], v[88:91], v[56:59]
v_mfma_f32_16x16x32_bf16 v[60:63], v[128:131], v[92:95], v[60:63]
v_mfma_f32_16x16x32_bf16 v[64:67], v[88:91], v[208:211], v[64:67]
v_mfma_f32_16x16x32_bf16 v[68:71], v[92:95], v[208:211], v[68:71]
ds_read_b128 v[88:91], v7 offset:11264
ds_read_b128 v[92:95], v7 offset:31744
s_waitcnt lgkmcnt(4)
v_mfma_f32_16x16x32_bf16 v[32:35], a[36:39], v[72:75], v[32:35]
v_mfma_f32_16x16x32_bf16 v[36:39], a[36:39], v[76:79], v[36:39]
v_mfma_f32_16x16x32_bf16 v[40:43], a[116:119], v[72:75], v[40:43]
v_mfma_f32_16x16x32_bf16 v[44:47], a[116:119], v[76:79], v[44:47]
v_mfma_f32_16x16x32_bf16 v[48:51], a[196:199], v[72:75], v[48:51]
v_mfma_f32_16x16x32_bf16 v[52:55], a[196:199], v[76:79], v[52:55]
v_mfma_f32_16x16x32_bf16 v[56:59], v[132:135], v[72:75], v[56:59]
v_mfma_f32_16x16x32_bf16 v[60:63], v[132:135], v[76:79], v[60:63]
v_mfma_f32_16x16x32_bf16 v[64:67], v[72:75], v[212:215], v[64:67]
v_mfma_f32_16x16x32_bf16 v[68:71], v[76:79], v[212:215], v[68:71]
ds_read_b128 v[72:75], v7 offset:12288
ds_read_b128 v[76:79], v7 offset:32768
s_waitcnt lgkmcnt(4)
v_mfma_f32_16x16x32_bf16 v[32:35], a[40:43], v[80:83], v[32:35]
v_mfma_f32_16x16x32_bf16 v[36:39], a[40:43], v[84:87], v[36:39]
v_mfma_f32_16x16x32_bf16 v[40:43], a[120:123], v[80:83], v[40:43]
v_mfma_f32_16x16x32_bf16 v[44:47], a[120:123], v[84:87], v[44:47]
v_mfma_f32_16x16x32_bf16 v[48:51], a[200:203], v[80:83], v[48:51]
v_mfma_f32_16x16x32_bf16 v[52:55], a[200:203], v[84:87], v[52:55]
v_mfma_f32_16x16x32_bf16 v[56:59], v[136:139], v[80:83], v[56:59]
v_mfma_f32_16x16x32_bf16 v[60:63], v[136:139], v[84:87], v[60:63]
v_mfma_f32_16x16x32_bf16 v[64:67], v[80:83], v[216:219], v[64:67]
v_mfma_f32_16x16x32_bf16 v[68:71], v[84:87], v[216:219], v[68:71]
ds_read_b128 v[80:83], v7 offset:13312
ds_read_b128 v[84:87], v7 offset:33792
s_waitcnt lgkmcnt(4)
v_mfma_f32_16x16x32_bf16 v[32:35], a[44:47], v[88:91], v[32:35]
v_mfma_f32_16x16x32_bf16 v[36:39], a[44:47], v[92:95], v[36:39]
v_mfma_f32_16x16x32_bf16 v[40:43], a[124:127], v[88:91], v[40:43]
v_mfma_f32_16x16x32_bf16 v[44:47], a[124:127], v[92:95], v[44:47]
v_mfma_f32_16x16x32_bf16 v[48:51], a[204:207], v[88:91], v[48:51]
v_mfma_f32_16x16x32_bf16 v[52:55], a[204:207], v[92:95], v[52:55]
v_mfma_f32_16x16x32_bf16 v[56:59], v[140:143], v[88:91], v[56:59]
v_mfma_f32_16x16x32_bf16 v[60:63], v[140:143], v[92:95], v[60:63]
v_mfma_f32_16x16x32_bf16 v[64:67], v[88:91], v[220:223], v[64:67]
v_mfma_f32_16x16x32_bf16 v[68:71], v[92:95], v[220:223], v[68:71]
ds_read_b128 v[88:91], v7 offset:14336
ds_read_b128 v[92:95], v7 offset:34816
s_waitcnt lgkmcnt(4)
v_mfma_f32_16x16x32_bf16 v[32:35], a[48:51], v[72:75], v[32:35]
v_mfma_f32_16x16x32_bf16 v[36:39], a[48:51], v[76:79], v[36:39]
v_mfma_f32_16x16x32_bf16 v[40:43], a[128:131], v[72:75], v[40:43]
v_mfma_f32_16x16x32_bf16 v[44:47], a[128:131], v[76:79], v[44:47]
v_mfma_f32_16x16x32_bf16 v[48:51], a[208:211], v[72:75], v[48:51]
v_mfma_f32_16x16x32_bf16 v[52:55], a[208:211], v[76:79], v[52:55]
v_mfma_f32_16x16x32_bf16 v[56:59], v[144:147], v[72:75], v[56:59]
v_mfma_f32_16x16x32_bf16 v[60:63], v[144:147], v[76:79], v[60:63]
v_mfma_f32_16x16x32_bf16 v[64:67], v[72:75], v[224:227], v[64:67]
v_mfma_f32_16x16x32_bf16 v[68:71], v[76:79], v[224:227], v[68:71]
ds_read_b128 v[72:75], v7 offset:15360
ds_read_b128 v[76:79], v7 offset:35840
s_waitcnt lgkmcnt(4)
v_mfma_f32_16x16x32_bf16 v[32:35], a[52:55], v[80:83], v[32:35]
v_mfma_f32_16x16x32_bf16 v[36:39], a[52:55], v[84:87], v[36:39]
v_mfma_f32_16x16x32_bf16 v[40:43], a[132:135], v[80:83], v[40:43]
v_mfma_f32_16x16x32_bf16 v[44:47], a[132:135], v[84:87], v[44:47]
v_mfma_f32_16x16x32_bf16 v[48:51], a[212:215], v[80:83], v[48:51]
v_mfma_f32_16x16x32_bf16 v[52:55], a[212:215], v[84:87], v[52:55]
v_mfma_f32_16x16x32_bf16 v[56:59], v[148:151], v[80:83], v[56:59]
v_mfma_f32_16x16x32_bf16 v[60:63], v[148:151], v[84:87], v[60:63]
v_mfma_f32_16x16x32_bf16 v[64:67], v[80:83], v[228:231], v[64:67]
v_mfma_f32_16x16x32_bf16 v[68:71], v[84:87], v[228:231], v[68:71]
ds_read_b128 v[80:83], v7 offset:16384
ds_read_b128 v[84:87], v7 offset:36864
s_waitcnt lgkmcnt(4)
v_mfma_f32_16x16x32_bf16 v[32:35], a[56:59], v[88:91], v[32:35]
v_mfma_f32_16x16x32_bf16 v[36:39], a[56:59], v[92:95], v[36:39]
v_mfma_f32_16x16x32_bf16 v[40:43], a[136:139], v[88:91], v[40:43]
v_mfma_f32_16x16x32_bf16 v[44:47], a[136:139], v[92:95], v[44:47]
v_mfma_f32_16x16x32_bf16 v[48:51], a[216:219], v[88:91], v[48:51]
v_mfma_f32_16x16x32_bf16 v[52:55], a[216:219], v[92:95], v[52:55]
v_mfma_f32_16x16x32_bf16 v[56:59], v[152:155], v[88:91], v[56:59]
v_mfma_f32_16x16x32_bf16 v[60:63], v[152:155], v[92:95], v[60:63]
v_mfma_f32_16x16x32_bf16 v[64:67], v[88:91], v[232:235], v[64:67]
v_mfma_f32_16x16x32_bf16 v[68:71], v[92:95], v[232:235], v[68:71]
ds_read_b128 v[88:91], v7 offset:17408
ds_read_b128 v[92:95], v7 offset:37888
s_waitcnt lgkmcnt(4)
v_mfma_f32_16x16x32_bf16 v[32:35], a[60:63], v[72:75], v[32:35]
v_mfma_f32_16x16x32_bf16 v[36:39], a[60:63], v[76:79], v[36:39]
v_mfma_f32_16x16x32_bf16 v[40:43], a[140:143], v[72:75], v[40:43]
v_mfma_f32_16x16x32_bf16 v[44:47], a[140:143], v[76:79], v[44:47]
v_mfma_f32_16x16x32_bf16 v[48:51], a[220:223], v[72:75], v[48:51]
v_mfma_f32_16x16x32_bf16 v[52:55], a[220:223], v[76:79], v[52:55]
v_mfma_f32_16x16x32_bf16 v[56:59], v[156:159], v[72:75], v[56:59]
v_mfma_f32_16x16x32_bf16 v[60:63], v[156:159], v[76:79], v[60:63]
v_mfma_f32_16x16x32_bf16 v[64:67], v[72:75], v[236:239], v[64:67]
v_mfma_f32_16x16x32_bf16 v[68:71], v[76:79], v[236:239], v[68:71]
ds_read_b128 v[72:75], v7 offset:18432
ds_read_b128 v[76:79], v7 offset:38912
s_waitcnt lgkmcnt(4)
v_mfma_f32_16x16x32_bf16 v[32:35], a[64:67], v[80:83], v[32:35]
v_mfma_f32_16x16x32_bf16 v[36:39], a[64:67], v[84:87], v[36:39]
v_mfma_f32_16x16x32_bf16 v[40:43], a[144:147], v[80:83], v[40:43]
v_mfma_f32_16x16x32_bf16 v[44:47], a[144:147], v[84:87], v[44:47]
v_mfma_f32_16x16x32_bf16 v[48:51], a[224:227], v[80:83], v[48:51]
v_mfma_f32_16x16x32_bf16 v[52:55], a[224:227], v[84:87], v[52:55]
v_mfma_f32_16x16x32_bf16 v[56:59], v[160:163], v[80:83], v[56:59]
v_mfma_f32_16x16x32_bf16 v[60:63], v[160:163], v[84:87], v[60:63]
v_mfma_f32_16x16x32_bf16 v[64:67], v[80:83], v[240:243], v[64:67]
v_mfma_f32_16x16x32_bf16 v[68:71], v[84:87], v[240:243], v[68:71]
ds_read_b128 v[80:83], v7 offset:19456
ds_read_b128 v[84:87], v7 offset:39936
s_waitcnt lgkmcnt(4)
v_mfma_f32_16x16x32_bf16 v[32:35], a[68:71], v[88:91], v[32:35]
v_mfma_f32_16x16x32_bf16 v[36:39], a[68:71], v[92:95], v[36:39]
v_mfma_f32_16x16x32_bf16 v[40:43], a[148:151], v[88:91], v[40:43]
v_mfma_f32_16x16x32_bf16 v[44:47], a[148:151], v[92:95], v[44:47]
v_mfma_f32_16x16x32_bf16 v[48:51], a[228:231], v[88:91], v[48:51]
v_mfma_f32_16x16x32_bf16 v[52:55], a[228:231], v[92:95], v[52:55]
v_mfma_f32_16x16x32_bf16 v[56:59], v[164:167], v[88:91], v[56:59]
v_mfma_f32_16x16x32_bf16 v[60:63], v[164:167], v[92:95], v[60:63]
v_mfma_f32_16x16x32_bf16 v[64:67], v[88:91], v[244:247], v[64:67]
v_mfma_f32_16x16x32_bf16 v[68:71], v[92:95], v[244:247], v[68:71]
s_waitcnt lgkmcnt(2)
v_mfma_f32_16x16x32_bf16 v[32:35], a[72:75], v[72:75], v[32:35]
v_mfma_f32_16x16x32_bf16 v[36:39], a[72:75], v[76:79], v[36:39]
v_mfma_f32_16x16x32_bf16 v[40:43], a[152:155], v[72:75], v[40:43]
v_mfma_f32_16x16x32_bf16 v[44:47], a[152:155], v[76:79], v[44:47]
v_mfma_f32_16x16x32_bf16 v[48:51], a[232:235], v[72:75], v[48:51]
v_mfma_f32_16x16x32_bf16 v[52:55], a[232:235], v[76:79], v[52:55]
v_mfma_f32_16x16x32_bf16 v[56:59], v[168:171], v[72:75], v[56:59]
v_mfma_f32_16x16x32_bf16 v[60:63], v[168:171], v[76:79], v[60:63]
v_mfma_f32_16x16x32_bf16 v[64:67], v[72:75], v[248:251], v[64:67]
v_mfma_f32_16x16x32_bf16 v[68:71], v[76:79], v[248:251], v[68:71]
s_waitcnt lgkmcnt(0)
v_mfma_f32_16x16x32_bf16 v[32:35], a[76:79], v[80:83], v[32:35]
v_mfma_f32_16x16x32_bf16 v[36:39], a[76:79], v[84:87], v[36:39]
v_mfma_f32_16x16x32_bf16 v[40:43], a[156:159], v[80:83], v[40:43]
v_mfma_f32_16x16x32_bf16 v[44:47], a[156:159], v[84:87], v[44:47]
v_mfma_f32_16x16x32_bf16 v[48:51], a[236:239], v[80:83], v[48:51]
v_mfma_f32_16x16x32_bf16 v[52:55], a[236:239], v[84:87], v[52:55]
v_mfma_f32_16x16x32_bf16 v[56:59], v[172:175], v[80:83], v[56:59]
v_mfma_f32_16x16x32_bf16 v[60:63], v[172:175], v[84:87], v[60:63]
v_mfma_f32_16x16x32_bf16 v[64:67], v[80:83], v[252:255], v[64:67]
v_mfma_f32_16x16x32_bf16 v[68:71], v[84:87], v[252:255], v[68:71]
v_cvt_pk_bf16_f32 v8, v32, v33
v_cvt_pk_bf16_f32 v9, v34, v35
v_cvt_pk_bf16_f32 v10, v40, v41
v_cvt_pk_bf16_f32 v11, v42, v43
s_add_u32 s34, s21, 0
buffer_store_dwordx4 v[8:11], v1, s[4:7], s34 offen
v_cvt_pk_bf16_f32 v12, v36, v37
v_cvt_pk_bf16_f32 v13, v38, v39
v_cvt_pk_bf16_f32 v14, v44, v45
v_cvt_pk_bf16_f32 v15, v46, v47
s_add_u32 s34, s21, 6144
buffer_store_dwordx4 v[12:15], v1, s[4:7], s34 offen
v_cvt_pk_bf16_f32 v8, v48, v49
v_cvt_pk_bf16_f32 v9, v50, v51
v_cvt_pk_bf16_f32 v10, v56, v57
v_cvt_pk_bf16_f32 v11, v58, v59
s_add_u32 s34, s21, 1024
buffer_store_dwordx4 v[8:11], v1, s[4:7], s34 offen
v_cvt_pk_bf16_f32 v12, v52, v53
v_cvt_pk_bf16_f32 v13, v54, v55
v_cvt_pk_bf16_f32 v14, v60, v61
v_cvt_pk_bf16_f32 v15, v62, v63
s_add_u32 s34, s21, 7168
buffer_store_dwordx4 v[12:15], v1, s[4:7], s34 offen
v_cvt_pk_bf16_f32 v8, v64, v65
v_cvt_pk_bf16_f32 v9, v66, v67
v_cvt_pk_bf16_f32 v10, v68, v69
v_cvt_pk_bf16_f32 v11, v70, v71
s_add_u32 s34, s23, 0
buffer_store_dwordx4 v[8:11], v1, s[4:7], s34 offen
s_waitcnt vmcnt(0)
s_barrier
s_add_u32 s17, s17, 1
v_mov_b32 v28, s17
buffer_store_dword v28, v4, s[4:7], s24 offen
s_cmp_lt_u32 s17, 64
s_cbranch_scc1 reca_ptop233
s_branch reca_exit1
reca_pslow232:
reca_ptop238:
s_cmp_lt_u32 s17, 3
s_cbranch_scc1 reca_pgo239
s_sub_u32 s36, s17, 3
reca_ppoll240:
buffer_load_dword v28, v4, s[4:7], s25 offen sc1
s_waitcnt vmcnt(0)
v_readfirstlane_b32 s34, v28
s_nop 3
s_cmp_ge_i32 s34, s36
s_cbranch_scc1 reca_pgo239
s_sleep 8
s_sub_u32 s18, s18, 1
s_cbranch_scc0 reca_ppoll240
s_mov_b32 s18, 0
reca_pgo239:
s_waitcnt vmcnt(0)
s_barrier
v_add_u32 v7, s26, v1
s_xor_b32 s26, s26, 40960
s_add_u32 s37, s17, 1
s_cmp_ge_u32 s37, 64
s_cbranch_scc1 reca_pnodma241
s_mul_i32 s20, s37, 40960
s_add_u32 s20, s20, 84934656
s_add_u32 m0, s26, 0
s_nop 0
buffer_load_dwordx4 v1, s[4:7], s20 offen offset:0 lds
buffer_load_dwordx4 v1, s[4:7], s20 offen offset:1024 lds
buffer_load_dwordx4 v1, s[4:7], s20 offen offset:2048 lds
buffer_load_dwordx4 v1, s[4:7], s20 offen offset:3072 lds
s_add_u32 s20, s20, 4096
s_add_u32 m0, s26, 4096
s_nop 0
buffer_load_dwordx4 v1, s[4:7], s20 offen offset:0 lds
buffer_load_dwordx4 v1, s[4:7], s20 offen offset:1024 lds
buffer_load_dwordx4 v1, s[4:7], s20 offen offset:2048 lds
buffer_load_dwordx4 v1, s[4:7], s20 offen offset:3072 lds
s_add_u32 s20, s20, 4096
s_add_u32 m0, s26, 8192
s_nop 0
buffer_load_dwordx4 v1, s[4:7], s20 offen offset:0 lds
buffer_load_dwordx4 v1, s[4:7], s20 offen offset:1024 lds
reca_pnodma241:
s_lshl_b32 s34, s15, 3
s_and_b32 s35, s17, 7
s_add_u32 s34, s34, s35
s_mul_i32 s34, s34, 12288
s_mul_i32 s35, s16, 3072
s_add_u32 s35, s35, s34
s_add_u32 s21, s35, 37748736
s_add_u32 s22, s35, 44040192
s_mul_i32 s35, s16, 6144
s_add_u32 s35, s35, s34
s_add_u32 s23, s35, 40894464
ds_read_b128 v[72:75], v7 offset:0
ds_read_b128 v[76:79], v7 offset:20480
ds_read_b128 v[80:83], v7 offset:1024
ds_read_b128 v[84:87], v7 offset:21504
ds_read_b128 v[88:91], v7 offset:2048
ds_read_b128 v[92:95], v7 offset:22528
s_waitcnt lgkmcnt(4)
v_mfma_f32_16x16x32_bf16 v[32:35], a[0:3], v[72:75], 0
v_mfma_f32_16x16x32_bf16 v[36:39], a[0:3], v[76:79], 0
v_mfma_f32_16x16x32_bf16 v[40:43], a[80:83], v[72:75], 0
v_mfma_f32_16x16x32_bf16 v[44:47], a[80:83], v[76:79], 0
v_mfma_f32_16x16x32_bf16 v[48:51], a[160:163], v[72:75], 0
v_mfma_f32_16x16x32_bf16 v[52:55], a[160:163], v[76:79], 0
v_mfma_f32_16x16x32_bf16 v[56:59], v[96:99], v[72:75], 0
v_mfma_f32_16x16x32_bf16 v[60:63], v[96:99], v[76:79], 0
v_mfma_f32_16x16x32_bf16 v[64:67], v[72:75], v[176:179], 0
v_mfma_f32_16x16x32_bf16 v[68:71], v[76:79], v[176:179], 0
ds_read_b128 v[72:75], v7 offset:3072
ds_read_b128 v[76:79], v7 offset:23552
s_waitcnt lgkmcnt(4)
v_mfma_f32_16x16x32_bf16 v[32:35], a[4:7], v[80:83], v[32:35]
v_mfma_f32_16x16x32_bf16 v[36:39], a[4:7], v[84:87], v[36:39]
v_mfma_f32_16x16x32_bf16 v[40:43], a[84:87], v[80:83], v[40:43]
v_mfma_f32_16x16x32_bf16 v[44:47], a[84:87], v[84:87], v[44:47]
v_mfma_f32_16x16x32_bf16 v[48:51], a[164:167], v[80:83], v[48:51]
v_mfma_f32_16x16x32_bf16 v[52:55], a[164:167], v[84:87], v[52:55]
v_mfma_f32_16x16x32_bf16 v[56:59], v[100:103], v[80:83], v[56:59]
v_mfma_f32_16x16x32_bf16 v[60:63], v[100:103], v[84:87], v[60:63]
v_mfma_f32_16x16x32_bf16 v[64:67], v[80:83], v[180:183], v[64:67]
v_mfma_f32_16x16x32_bf16 v[68:71], v[84:87], v[180:183], v[68:71]
ds_read_b128 v[80:83], v7 offset:4096
ds_read_b128 v[84:87], v7 offset:24576
s_waitcnt lgkmcnt(4)
v_mfma_f32_16x16x32_bf16 v[32:35], a[8:11], v[88:91], v[32:35]
v_mfma_f32_16x16x32_bf16 v[36:39], a[8:11], v[92:95], v[36:39]
v_mfma_f32_16x16x32_bf16 v[40:43], a[88:91], v[88:91], v[40:43]
v_mfma_f32_16x16x32_bf16 v[44:47], a[88:91], v[92:95], v[44:47]
v_mfma_f32_16x16x32_bf16 v[48:51], a[168:171], v[88:91], v[48:51]
v_mfma_f32_16x16x32_bf16 v[52:55], a[168:171], v[92:95], v[52:55]
v_mfma_f32_16x16x32_bf16 v[56:59], v[104:107], v[88:91], v[56:59]
v_mfma_f32_16x16x32_bf16 v[60:63], v[104:107], v[92:95], v[60:63]
v_mfma_f32_16x16x32_bf16 v[64:67], v[88:91], v[184:187], v[64:67]
v_mfma_f32_16x16x32_bf16 v[68:71], v[92:95], v[184:187], v[68:71]
ds_read_b128 v[88:91], v7 offset:5120
ds_read_b128 v[92:95], v7 offset:25600
s_waitcnt lgkmcnt(4)
v_mfma_f32_16x16x32_bf16 v[32:35], a[12:15], v[72:75], v[32:35]
v_mfma_f32_16x16x32_bf16 v[36:39], a[12:15], v[76:79], v[36:39]
v_mfma_f32_16x16x32_bf16 v[40:43], a[92:95], v[72:75], v[40:43]
v_mfma_f32_16x16x32_bf16 v[44:47], a[92:95], v[76:79], v[44:47]
v_mfma_f32_16x16x32_bf16 v[48:51], a[172:175], v[72:75], v[48:51]
v_mfma_f32_16x16x32_bf16 v[52:55], a[172:175], v[76:79], v[52:55]
v_mfma_f32_16x16x32_bf16 v[56:59], v[108:111], v[72:75], v[56:59]
v_mfma_f32_16x16x32_bf16 v[60:63], v[108:111], v[76:79], v[60:63]
v_mfma_f32_16x16x32_bf16 v[64:67], v[72:75], v[188:191], v[64:67]
v_mfma_f32_16x16x32_bf16 v[68:71], v[76:79], v[188:191], v[68:71]
ds_read_b128 v[72:75], v7 offset:6144
ds_read_b128 v[76:79], v7 offset:26624
s_waitcnt lgkmcnt(4)
v_mfma_f32_16x16x32_bf16 v[32:35], a[16:19], v[80:83], v[32:35]
v_mfma_f32_16x16x32_bf16 v[36:39], a[16:19], v[84:87], v[36:39]
v_mfma_f32_16x16x32_bf16 v[40:43], a[96:99], v[80:83], v[40:43]
v_mfma_f32_16x16x32_bf16 v[44:47], a[96:99], v[84:87], v[44:47]
v_mfma_f32_16x16x32_bf16 v[48:51], a[176:179], v[80:83], v[48:51]
v_mfma_f32_16x16x32_bf16 v[52:55], a[176:179], v[84:87], v[52:55]
v_mfma_f32_16x16x32_bf16 v[56:59], v[112:115], v[80:83], v[56:59]
v_mfma_f32_16x16x32_bf16 v[60:63], v[112:115], v[84:87], v[60:63]
v_mfma_f32_16x16x32_bf16 v[64:67], v[80:83], v[192:195], v[64:67]
v_mfma_f32_16x16x32_bf16 v[68:71], v[84:87], v[192:195], v[68:71]
ds_read_b128 v[80:83], v7 offset:7168
ds_read_b128 v[84:87], v7 offset:27648
s_waitcnt lgkmcnt(4)
v_mfma_f32_16x16x32_bf16 v[32:35], a[20:23], v[88:91], v[32:35]
v_mfma_f32_16x16x32_bf16 v[36:39], a[20:23], v[92:95], v[36:39]
v_mfma_f32_16x16x32_bf16 v[40:43], a[100:103], v[88:91], v[40:43]
v_mfma_f32_16x16x32_bf16 v[44:47], a[100:103], v[92:95], v[44:47]
v_mfma_f32_16x16x32_bf16 v[48:51], a[180:183], v[88:91], v[48:51]
v_mfma_f32_16x16x32_bf16 v[52:55], a[180:183], v[92:95], v[52:55]
v_mfma_f32_16x16x32_bf16 v[56:59], v[116:119], v[88:91], v[56:59]
v_mfma_f32_16x16x32_bf16 v[60:63], v[116:119], v[92:95], v[60:63]
v_mfma_f32_16x16x32_bf16 v[64:67], v[88:91], v[196:199], v[64:67]
v_mfma_f32_16x16x32_bf16 v[68:71], v[92:95], v[196:199], v[68:71]
ds_read_b128 v[88:91], v7 offset:8192
ds_read_b128 v[92:95], v7 offset:28672
s_waitcnt lgkmcnt(4)
v_mfma_f32_16x16x32_bf16 v[32:35], a[24:27], v[72:75], v[32:35]
v_mfma_f32_16x16x32_bf16 v[36:39], a[24:27], v[76:79], v[36:39]
v_mfma_f32_16x16x32_bf16 v[40:43], a[104:107], v[72:75], v[40:43]
v_mfma_f32_16x16x32_bf16 v[44:47], a[104:107], v[76:79], v[44:47]
v_mfma_f32_16x16x32_bf16 v[48:51], a[184:187], v[72:75], v[48:51]
v_mfma_f32_16x16x32_bf16 v[52:55], a[184:187], v[76:79], v[52:55]
v_mfma_f32_16x16x32_bf16 v[56:59], v[120:123], v[72:75], v[56:59]
v_mfma_f32_16x16x32_bf16 v[60:63], v[120:123], v[76:79], v[60:63]
v_mfma_f32_16x16x32_bf16 v[64:67], v[72:75], v[200:203], v[64:67]
v_mfma_f32_16x16x32_bf16 v[68:71], v[76:79], v[200:203], v[68:71]
ds_read_b128 v[72:75], v7 offset:9216
ds_read_b128 v[76:79], v7 offset:29696
s_waitcnt lgkmcnt(4)
v_mfma_f32_16x16x32_bf16 v[32:35], a[28:31], v[80:83], v[32:35]
v_mfma_f32_16x16x32_bf16 v[36:39], a[28:31], v[84:87], v[36:39]
v_mfma_f32_16x16x32_bf16 v[40:43], a[108:111], v[80:83], v[40:43]
v_mfma_f32_16x16x32_bf16 v[44:47], a[108:111], v[84:87], v[44:47]
v_mfma_f32_16x16x32_bf16 v[48:51], a[188:191], v[80:83], v[48:51]
v_mfma_f32_16x16x32_bf16 v[52:55], a[188:191], v[84:87], v[52:55]
v_mfma_f32_16x16x32_bf16 v[56:59], v[124:127], v[80:83], v[56:59]
v_mfma_f32_16x16x32_bf16 v[60:63], v[124:127], v[84:87], v[60:63]
v_mfma_f32_16x16x32_bf16 v[64:67], v[80:83], v[204:207], v[64:67]
v_mfma_f32_16x16x32_bf16 v[68:71], v[84:87], v[204:207], v[68:71]
ds_read_b128 v[80:83], v7 offset:10240
ds_read_b128 v[84:87], v7 offset:30720
s_waitcnt lgkmcnt(4)
v_mfma_f32_16x16x32_bf16 v[32:35], a[32:35], v[88:91], v[32:35]
v_mfma_f32_16x16x32_bf16 v[36:39], a[32:35], v[92:95], v[36:39]
v_mfma_f32_16x16x32_bf16 v[40:43], a[112:115], v[88:91], v[40:43]
v_mfma_f32_16x16x32_bf16 v[44:47], a[112:115], v[92:95], v[44:47]
v_mfma_f32_16x16x32_bf16 v[48:51], a[192:195], v[88:91], v[48:51]
v_mfma_f32_16x16x32_bf16 v[52:55], a[192:195], v[92:95], v[52:55]
v_mfma_f32_16x16x32_bf16 v[56:59], v[128:131], v[88:91], v[56:59]
v_mfma_f32_16x16x32_bf16 v[60:63], v[128:131], v[92:95], v[60:63]
v_mfma_f32_16x16x32_bf16 v[64:67], v[88:91], v[208:211], v[64:67]
v_mfma_f32_16x16x32_bf16 v[68:71], v[92:95], v[208:211], v[68:71]
ds_read_b128 v[88:91], v7 offset:11264
ds_read_b128 v[92:95], v7 offset:31744
s_waitcnt lgkmcnt(4)
v_mfma_f32_16x16x32_bf16 v[32:35], a[36:39], v[72:75], v[32:35]
v_mfma_f32_16x16x32_bf16 v[36:39], a[36:39], v[76:79], v[36:39]
v_mfma_f32_16x16x32_bf16 v[40:43], a[116:119], v[72:75], v[40:43]
v_mfma_f32_16x16x32_bf16 v[44:47], a[116:119], v[76:79], v[44:47]
v_mfma_f32_16x16x32_bf16 v[48:51], a[196:199], v[72:75], v[48:51]
v_mfma_f32_16x16x32_bf16 v[52:55], a[196:199], v[76:79], v[52:55]
v_mfma_f32_16x16x32_bf16 v[56:59], v[132:135], v[72:75], v[56:59]
v_mfma_f32_16x16x32_bf16 v[60:63], v[132:135], v[76:79], v[60:63]
v_mfma_f32_16x16x32_bf16 v[64:67], v[72:75], v[212:215], v[64:67]
v_mfma_f32_16x16x32_bf16 v[68:71], v[76:79], v[212:215], v[68:71]
ds_read_b128 v[72:75], v7 offset:12288
ds_read_b128 v[76:79], v7 offset:32768
s_waitcnt lgkmcnt(4)
v_mfma_f32_16x16x32_bf16 v[32:35], a[40:43], v[80:83], v[32:35]
v_mfma_f32_16x16x32_bf16 v[36:39], a[40:43], v[84:87], v[36:39]
v_mfma_f32_16x16x32_bf16 v[40:43], a[120:123], v[80:83], v[40:43]
v_mfma_f32_16x16x32_bf16 v[44:47], a[120:123], v[84:87], v[44:47]
v_mfma_f32_16x16x32_bf16 v[48:51], a[200:203], v[80:83], v[48:51]
v_mfma_f32_16x16x32_bf16 v[52:55], a[200:203], v[84:87], v[52:55]
v_mfma_f32_16x16x32_bf16 v[56:59], v[136:139], v[80:83], v[56:59]
v_mfma_f32_16x16x32_bf16 v[60:63], v[136:139], v[84:87], v[60:63]
v_mfma_f32_16x16x32_bf16 v[64:67], v[80:83], v[216:219], v[64:67]
v_mfma_f32_16x16x32_bf16 v[68:71], v[84:87], v[216:219], v[68:71]
ds_read_b128 v[80:83], v7 offset:13312
ds_read_b128 v[84:87], v7 offset:33792
s_waitcnt lgkmcnt(4)
v_mfma_f32_16x16x32_bf16 v[32:35], a[44:47], v[88:91], v[32:35]
v_mfma_f32_16x16x32_bf16 v[36:39], a[44:47], v[92:95], v[36:39]
v_mfma_f32_16x16x32_bf16 v[40:43], a[124:127], v[88:91], v[40:43]
v_mfma_f32_16x16x32_bf16 v[44:47], a[124:127], v[92:95], v[44:47]
v_mfma_f32_16x16x32_bf16 v[48:51], a[204:207], v[88:91], v[48:51]
v_mfma_f32_16x16x32_bf16 v[52:55], a[204:207], v[92:95], v[52:55]
v_mfma_f32_16x16x32_bf16 v[56:59], v[140:143], v[88:91], v[56:59]
v_mfma_f32_16x16x32_bf16 v[60:63], v[140:143], v[92:95], v[60:63]
v_mfma_f32_16x16x32_bf16 v[64:67], v[88:91], v[220:223], v[64:67]
v_mfma_f32_16x16x32_bf16 v[68:71], v[92:95], v[220:223], v[68:71]
ds_read_b128 v[88:91], v7 offset:14336
ds_read_b128 v[92:95], v7 offset:34816
s_waitcnt lgkmcnt(4)
v_mfma_f32_16x16x32_bf16 v[32:35], a[48:51], v[72:75], v[32:35]
v_mfma_f32_16x16x32_bf16 v[36:39], a[48:51], v[76:79], v[36:39]
v_mfma_f32_16x16x32_bf16 v[40:43], a[128:131], v[72:75], v[40:43]
v_mfma_f32_16x16x32_bf16 v[44:47], a[128:131], v[76:79], v[44:47]
v_mfma_f32_16x16x32_bf16 v[48:51], a[208:211], v[72:75], v[48:51]
v_mfma_f32_16x16x32_bf16 v[52:55], a[208:211], v[76:79], v[52:55]
v_mfma_f32_16x16x32_bf16 v[56:59], v[144:147], v[72:75], v[56:59]
v_mfma_f32_16x16x32_bf16 v[60:63], v[144:147], v[76:79], v[60:63]
v_mfma_f32_16x16x32_bf16 v[64:67], v[72:75], v[224:227], v[64:67]
v_mfma_f32_16x16x32_bf16 v[68:71], v[76:79], v[224:227], v[68:71]
ds_read_b128 v[72:75], v7 offset:15360
ds_read_b128 v[76:79], v7 offset:35840
s_waitcnt lgkmcnt(4)
v_mfma_f32_16x16x32_bf16 v[32:35], a[52:55], v[80:83], v[32:35]
v_mfma_f32_16x16x32_bf16 v[36:39], a[52:55], v[84:87], v[36:39]
v_mfma_f32_16x16x32_bf16 v[40:43], a[132:135], v[80:83], v[40:43]
v_mfma_f32_16x16x32_bf16 v[44:47], a[132:135], v[84:87], v[44:47]
v_mfma_f32_16x16x32_bf16 v[48:51], a[212:215], v[80:83], v[48:51]
v_mfma_f32_16x16x32_bf16 v[52:55], a[212:215], v[84:87], v[52:55]
v_mfma_f32_16x16x32_bf16 v[56:59], v[148:151], v[80:83], v[56:59]
v_mfma_f32_16x16x32_bf16 v[60:63], v[148:151], v[84:87], v[60:63]
v_mfma_f32_16x16x32_bf16 v[64:67], v[80:83], v[228:231], v[64:67]
v_mfma_f32_16x16x32_bf16 v[68:71], v[84:87], v[228:231], v[68:71]
ds_read_b128 v[80:83], v7 offset:16384
ds_read_b128 v[84:87], v7 offset:36864
s_waitcnt lgkmcnt(4)
v_mfma_f32_16x16x32_bf16 v[32:35], a[56:59], v[88:91], v[32:35]
v_mfma_f32_16x16x32_bf16 v[36:39], a[56:59], v[92:95], v[36:39]
v_mfma_f32_16x16x32_bf16 v[40:43], a[136:139], v[88:91], v[40:43]
v_mfma_f32_16x16x32_bf16 v[44:47], a[136:139], v[92:95], v[44:47]
v_mfma_f32_16x16x32_bf16 v[48:51], a[216:219], v[88:91], v[48:51]
v_mfma_f32_16x16x32_bf16 v[52:55], a[216:219], v[92:95], v[52:55]
v_mfma_f32_16x16x32_bf16 v[56:59], v[152:155], v[88:91], v[56:59]
v_mfma_f32_16x16x32_bf16 v[60:63], v[152:155], v[92:95], v[60:63]
v_mfma_f32_16x16x32_bf16 v[64:67], v[88:91], v[232:235], v[64:67]
v_mfma_f32_16x16x32_bf16 v[68:71], v[92:95], v[232:235], v[68:71]
ds_read_b128 v[88:91], v7 offset:17408
ds_read_b128 v[92:95], v7 offset:37888
s_waitcnt lgkmcnt(4)
v_mfma_f32_16x16x32_bf16 v[32:35], a[60:63], v[72:75], v[32:35]
v_mfma_f32_16x16x32_bf16 v[36:39], a[60:63], v[76:79], v[36:39]
v_mfma_f32_16x16x32_bf16 v[40:43], a[140:143], v[72:75], v[40:43]
v_mfma_f32_16x16x32_bf16 v[44:47], a[140:143], v[76:79], v[44:47]
v_mfma_f32_16x16x32_bf16 v[48:51], a[220:223], v[72:75], v[48:51]
v_mfma_f32_16x16x32_bf16 v[52:55], a[220:223], v[76:79], v[52:55]
v_mfma_f32_16x16x32_bf16 v[56:59], v[156:159], v[72:75], v[56:59]
v_mfma_f32_16x16x32_bf16 v[60:63], v[156:159], v[76:79], v[60:63]
v_mfma_f32_16x16x32_bf16 v[64:67], v[72:75], v[236:239], v[64:67]
v_mfma_f32_16x16x32_bf16 v[68:71], v[76:79], v[236:239], v[68:71]
ds_read_b128 v[72:75], v7 offset:18432
ds_read_b128 v[76:79], v7 offset:38912
s_waitcnt lgkmcnt(4)
v_mfma_f32_16x16x32_bf16 v[32:35], a[64:67], v[80:83], v[32:35]
v_mfma_f32_16x16x32_bf16 v[36:39], a[64:67], v[84:87], v[36:39]
v_mfma_f32_16x16x32_bf16 v[40:43], a[144:147], v[80:83], v[40:43]
v_mfma_f32_16x16x32_bf16 v[44:47], a[144:147], v[84:87], v[44:47]
v_mfma_f32_16x16x32_bf16 v[48:51], a[224:227], v[80:83], v[48:51]
v_mfma_f32_16x16x32_bf16 v[52:55], a[224:227], v[84:87], v[52:55]
v_mfma_f32_16x16x32_bf16 v[56:59], v[160:163], v[80:83], v[56:59]
v_mfma_f32_16x16x32_bf16 v[60:63], v[160:163], v[84:87], v[60:63]
v_mfma_f32_16x16x32_bf16 v[64:67], v[80:83], v[240:243], v[64:67]
v_mfma_f32_16x16x32_bf16 v[68:71], v[84:87], v[240:243], v[68:71]
ds_read_b128 v[80:83], v7 offset:19456
ds_read_b128 v[84:87], v7 offset:39936
s_waitcnt lgkmcnt(4)
v_mfma_f32_16x16x32_bf16 v[32:35], a[68:71], v[88:91], v[32:35]
v_mfma_f32_16x16x32_bf16 v[36:39], a[68:71], v[92:95], v[36:39]
v_mfma_f32_16x16x32_bf16 v[40:43], a[148:151], v[88:91], v[40:43]
v_mfma_f32_16x16x32_bf16 v[44:47], a[148:151], v[92:95], v[44:47]
v_mfma_f32_16x16x32_bf16 v[48:51], a[228:231], v[88:91], v[48:51]
v_mfma_f32_16x16x32_bf16 v[52:55], a[228:231], v[92:95], v[52:55]
v_mfma_f32_16x16x32_bf16 v[56:59], v[164:167], v[88:91], v[56:59]
v_mfma_f32_16x16x32_bf16 v[60:63], v[164:167], v[92:95], v[60:63]
v_mfma_f32_16x16x32_bf16 v[64:67], v[88:91], v[244:247], v[64:67]
v_mfma_f32_16x16x32_bf16 v[68:71], v[92:95], v[244:247], v[68:71]
s_waitcnt lgkmcnt(2)
v_mfma_f32_16x16x32_bf16 v[32:35], a[72:75], v[72:75], v[32:35]
v_mfma_f32_16x16x32_bf16 v[36:39], a[72:75], v[76:79], v[36:39]
v_mfma_f32_16x16x32_bf16 v[40:43], a[152:155], v[72:75], v[40:43]
v_mfma_f32_16x16x32_bf16 v[44:47], a[152:155], v[76:79], v[44:47]
v_mfma_f32_16x16x32_bf16 v[48:51], a[232:235], v[72:75], v[48:51]
v_mfma_f32_16x16x32_bf16 v[52:55], a[232:235], v[76:79], v[52:55]
v_mfma_f32_16x16x32_bf16 v[56:59], v[168:171], v[72:75], v[56:59]
v_mfma_f32_16x16x32_bf16 v[60:63], v[168:171], v[76:79], v[60:63]
v_mfma_f32_16x16x32_bf16 v[64:67], v[72:75], v[248:251], v[64:67]
v_mfma_f32_16x16x32_bf16 v[68:71], v[76:79], v[248:251], v[68:71]
s_waitcnt lgkmcnt(0)
v_mfma_f32_16x16x32_bf16 v[32:35], a[76:79], v[80:83], v[32:35]
v_mfma_f32_16x16x32_bf16 v[36:39], a[76:79], v[84:87], v[36:39]
v_mfma_f32_16x16x32_bf16 v[40:43], a[156:159], v[80:83], v[40:43]
v_mfma_f32_16x16x32_bf16 v[44:47], a[156:159], v[84:87], v[44:47]
v_mfma_f32_16x16x32_bf16 v[48:51], a[236:239], v[80:83], v[48:51]
v_mfma_f32_16x16x32_bf16 v[52:55], a[236:239], v[84:87], v[52:55]
v_mfma_f32_16x16x32_bf16 v[56:59], v[172:175], v[80:83], v[56:59]
v_mfma_f32_16x16x32_bf16 v[60:63], v[172:175], v[84:87], v[60:63]
v_mfma_f32_16x16x32_bf16 v[64:67], v[80:83], v[252:255], v[64:67]
v_mfma_f32_16x16x32_bf16 v[68:71], v[84:87], v[252:255], v[68:71]
v_cvt_pk_bf16_f32 v8, v32, v33
v_cvt_pk_bf16_f32 v9, v34, v35
v_cvt_pk_bf16_f32 v10, v40, v41
v_cvt_pk_bf16_f32 v11, v42, v43
s_add_u32 s34, s21, 0
buffer_store_dwordx4 v[8:11], v1, s[4:7], s34 offen sc1
v_cvt_pk_bf16_f32 v12, v36, v37
v_cvt_pk_bf16_f32 v13, v38, v39
v_cvt_pk_bf16_f32 v14, v44, v45
v_cvt_pk_bf16_f32 v15, v46, v47
s_add_u32 s34, s21, 6144
buffer_store_dwordx4 v[12:15], v1, s[4:7], s34 offen sc1
v_cvt_pk_bf16_f32 v8, v48, v49
v_cvt_pk_bf16_f32 v9, v50, v51
v_cvt_pk_bf16_f32 v10, v56, v57
v_cvt_pk_bf16_f32 v11, v58, v59
s_add_u32 s34, s21, 1024
buffer_store_dwordx4 v[8:11], v1, s[4:7], s34 offen sc1
v_cvt_pk_bf16_f32 v12, v52, v53
v_cvt_pk_bf16_f32 v13, v54, v55
v_cvt_pk_bf16_f32 v14, v60, v61
v_cvt_pk_bf16_f32 v15, v62, v63
s_add_u32 s34, s21, 7168
buffer_store_dwordx4 v[12:15], v1, s[4:7], s34 offen sc1
v_cvt_pk_bf16_f32 v8, v64, v65
v_cvt_pk_bf16_f32 v9, v66, v67
v_cvt_pk_bf16_f32 v10, v68, v69
v_cvt_pk_bf16_f32 v11, v70, v71
s_add_u32 s34, s23, 0
buffer_store_dwordx4 v[8:11], v1, s[4:7], s34 offen sc1
s_waitcnt vmcnt(0)
s_barrier
s_add_u32 s17, s17, 1
v_mov_b32 v28, s17
buffer_store_dword v28, v4, s[4:7], s24 offen sc1
s_cmp_lt_u32 s17, 64
s_cbranch_scc1 reca_ptop238
s_branch reca_exit1
reca_pw1_227:
s_mov_b32 s17, 0
s_mov_b32 s26, 0
s_mul_i32 s20, s17, 40960
s_add_u32 s20, s20, 84944896
s_add_u32 m0, s26, 10240
s_nop 0
buffer_load_dwordx4 v1, s[4:7], s20 offen offset:0 lds
buffer_load_dwordx4 v1, s[4:7], s20 offen offset:1024 lds
buffer_load_dwordx4 v1, s[4:7], s20 offen offset:2048 lds
buffer_load_dwordx4 v1, s[4:7], s20 offen offset:3072 lds
s_add_u32 s20, s20, 4096
s_add_u32 m0, s26, 14336
s_nop 0
buffer_load_dwordx4 v1, s[4:7], s20 offen offset:0 lds
buffer_load_dwordx4 v1, s[4:7], s20 offen offset:1024 lds
buffer_load_dwordx4 v1, s[4:7], s20 offen offset:2048 lds
buffer_load_dwordx4 v1, s[4:7], s20 offen offset:3072 lds
s_add_u32 s20, s20, 4096
s_add_u32 m0, s26, 18432
s_nop 0
buffer_load_dwordx4 v1, s[4:7], s20 offen offset:0 lds
buffer_load_dwordx4 v1, s[4:7], s20 offen offset:1024 lds
s_mul_i32 s34, s15, 12
s_mul_i32 s35, s16, 6
s_add_u32 s34, s34, s35
s_add_u32 s34, s34, 4
s_mul_i32 s34, s34, 20480
s_add_u32 s34, s34, 14155776
buffer_load_dwordx4 a[0:3], v1, s[4:7], s34 offen offset:0
buffer_load_dwordx4 a[4:7], v1, s[4:7], s34 offen offset:1024
buffer_load_dwordx4 a[8:11], v1, s[4:7], s34 offen offset:2048
buffer_load_dwordx4 a[12:15], v1, s[4:7], s34 offen offset:3072
s_add_u32 s34, s34, 4096
buffer_load_dwordx4 a[16:19], v1, s[4:7], s34 offen offset:0
buffer_load_dwordx4 a[20:23], v1, s[4:7], s34 offen offset:1024
buffer_load_dwordx4 a[24:27], v1, s[4:7], s34 offen offset:2048
buffer_load_dwordx4 a[28:31], v1, s[4:7], s34 offen offset:3072
s_add_u32 s34, s34, 4096
buffer_load_dwordx4 a[32:35], v1, s[4:7], s34 offen offset:0
buffer_load_dwordx4 a[36:39], v1, s[4:7], s34 offen offset:1024
buffer_load_dwordx4 a[40:43], v1, s[4:7], s34 offen offset:2048
buffer_load_dwordx4 a[44:47], v1, s[4:7], s34 offen offset:3072
s_add_u32 s34, s34, 4096
buffer_load_dwordx4 a[48:51], v1, s[4:7], s34 offen offset:0
buffer_load_dwordx4 a[52:55], v1, s[4:7], s34 offen offset:1024
buffer_load_dwordx4 a[56:59], v1, s[4:7], s34 offen offset:2048
buffer_load_dwordx4 a[60:63], v1, s[4:7], s34 offen offset:3072
s_add_u32 s34, s34, 4096
buffer_load_dwordx4 a[64:67], v1, s[4:7], s34 offen offset:0
buffer_load_dwordx4 a[68:71], v1, s[4:7], s34 offen offset:1024
buffer_load_dwordx4 a[72:75], v1, s[4:7], s34 offen offset:2048
buffer_load_dwordx4 a[76:79], v1, s[4:7], s34 offen offset:3072
s_mul_i32 s34, s15, 12
s_mul_i32 s35, s16, 6
s_add_u32 s34, s34, s35
s_add_u32 s34, s34, 5
s_mul_i32 s34, s34, 20480
s_add_u32 s34, s34, 14155776
buffer_load_dwordx4 a[80:83], v1, s[4:7], s34 offen offset:0
buffer_load_dwordx4 a[84:87], v1, s[4:7], s34 offen offset:1024
buffer_load_dwordx4 a[88:91], v1, s[4:7], s34 offen offset:2048
buffer_load_dwordx4 a[92:95], v1, s[4:7], s34 offen offset:3072
s_add_u32 s34, s34, 4096
buffer_load_dwordx4 a[96:99], v1, s[4:7], s34 offen offset:0
buffer_load_dwordx4 a[100:103], v1, s[4:7], s34 offen offset:1024
buffer_load_dwordx4 a[104:107], v1, s[4:7], s34 offen offset:2048
buffer_load_dwordx4 a[108:111], v1, s[4:7], s34 offen offset:3072
s_add_u32 s34, s34, 4096
buffer_load_dwordx4 a[112:115], v1, s[4:7], s34 offen offset:0
buffer_load_dwordx4 a[116:119], v1, s[4:7], s34 offen offset:1024
buffer_load_dwordx4 a[120:123], v1, s[4:7], s34 offen offset:2048
buffer_load_dwordx4 a[124:127], v1, s[4:7], s34 offen offset:3072
s_add_u32 s34, s34, 4096
buffer_load_dwordx4 a[128:131], v1, s[4:7], s34 offen offset:0
buffer_load_dwordx4 a[132:135], v1, s[4:7], s34 offen offset:1024
buffer_load_dwordx4 a[136:139], v1, s[4:7], s34 offen offset:2048
buffer_load_dwordx4 a[140:143], v1, s[4:7], s34 offen offset:3072
s_add_u32 s34, s34, 4096
buffer_load_dwordx4 a[144:147], v1, s[4:7], s34 offen offset:0
buffer_load_dwordx4 a[148:151], v1, s[4:7], s34 offen offset:1024
buffer_load_dwordx4 a[152:155], v1, s[4:7], s34 offen offset:2048
buffer_load_dwordx4 a[156:159], v1, s[4:7], s34 offen offset:3072
s_waitcnt vmcnt(20)
s_mul_i32 s34, s15, 12
s_mul_i32 s35, s16, 6
s_add_u32 s34, s34, s35
s_add_u32 s34, s34, 1
s_mul_i32 s34, s34, 20480
s_add_u32 s34, s34, 22020096
buffer_load_dwordx4 a[160:163], v1, s[4:7], s34 offen offset:0
buffer_load_dwordx4 a[164:167], v1, s[4:7], s34 offen offset:1024
buffer_load_dwordx4 a[168:171], v1, s[4:7], s34 offen offset:2048
buffer_load_dwordx4 a[172:175], v1, s[4:7], s34 offen offset:3072
s_add_u32 s34, s34, 4096
buffer_load_dwordx4 a[176:179], v1, s[4:7], s34 offen offset:0
buffer_load_dwordx4 a[180:183], v1, s[4:7], s34 offen offset:1024
buffer_load_dwordx4 a[184:187], v1, s[4:7], s34 offen offset:2048
buffer_load_dwordx4 a[188:191], v1, s[4:7], s34 offen offset:3072
s_add_u32 s34, s34, 4096
buffer_load_dwordx4 a[192:195], v1, s[4:7], s34 offen offset:0
buffer_load_dwordx4 a[196:199], v1, s[4:7], s34 offen offset:1024
buffer_load_dwordx4 a[200:203], v1, s[4:7], s34 offen offset:2048
buffer_load_dwordx4 a[204:207], v1, s[4:7], s34 offen offset:3072
s_add_u32 s34, s34, 4096
buffer_load_dwordx4 a[208:211], v1, s[4:7], s34 offen offset:0
buffer_load_dwordx4 a[212:215], v1, s[4:7], s34 offen offset:1024
buffer_load_dwordx4 a[216:219], v1, s[4:7], s34 offen offset:2048
buffer_load_dwordx4 a[220:223], v1, s[4:7], s34 offen offset:3072
s_add_u32 s34, s34, 4096
buffer_load_dwordx4 a[224:227], v1, s[4:7], s34 offen offset:0
buffer_load_dwordx4 a[228:231], v1, s[4:7], s34 offen offset:1024
buffer_load_dwordx4 a[232:235], v1, s[4:7], s34 offen offset:2048
buffer_load_dwordx4 a[236:239], v1, s[4:7], s34 offen offset:3072
s_waitcnt vmcnt(20)
s_mul_i32 s34, s15, 12
s_mul_i32 s35, s16, 6
s_add_u32 s34, s34, s35
s_add_u32 s34, s34, 2
s_mul_i32 s34, s34, 20480
s_add_u32 s34, s34, 22020096
buffer_load_dwordx4 v[96:99], v1, s[4:7], s34 offen offset:0
buffer_load_dwordx4 v[100:103], v1, s[4:7], s34 offen offset:1024
buffer_load_dwordx4 v[104:107], v1, s[4:7], s34 offen offset:2048
buffer_load_dwordx4 v[108:111], v1, s[4:7], s34 offen offset:3072
s_add_u32 s34, s34, 4096
buffer_load_dwordx4 v[112:115], v1, s[4:7], s34 offen offset:0
buffer_load_dwordx4 v[116:119], v1, s[4:7], s34 offen offset:1024
buffer_load_dwordx4 v[120:123], v1, s[4:7], s34 offen offset:2048
buffer_load_dwordx4 v[124:127], v1, s[4:7], s34 offen offset:3072
s_add_u32 s34, s34, 4096
buffer_load_dwordx4 v[128:131], v1, s[4:7], s34 offen offset:0
buffer_load_dwordx4 v[132:135], v1, s[4:7], s34 offen offset:1024
buffer_load_dwordx4 v[136:139], v1, s[4:7], s34 offen offset:2048
buffer_load_dwordx4 v[140:143], v1, s[4:7], s34 offen offset:3072
s_add_u32 s34, s34, 4096
buffer_load_dwordx4 v[144:147], v1, s[4:7], s34 offen offset:0
buffer_load_dwordx4 v[148:151], v1, s[4:7], s34 offen offset:1024
buffer_load_dwordx4 v[152:155], v1, s[4:7], s34 offen offset:2048
buffer_load_dwordx4 v[156:159], v1, s[4:7], s34 offen offset:3072
s_add_u32 s34, s34, 4096
buffer_load_dwordx4 v[160:163], v1, s[4:7], s34 offen offset:0
buffer_load_dwordx4 v[164:167], v1, s[4:7], s34 offen offset:1024
buffer_load_dwordx4 v[168:171], v1, s[4:7], s34 offen offset:2048
buffer_load_dwordx4 v[172:175], v1, s[4:7], s34 offen offset:3072
s_waitcnt vmcnt(20)
s_mul_i32 s34, s15, 12
s_mul_i32 s35, s16, 6
s_add_u32 s34, s34, s35
s_add_u32 s34, s34, 3
s_mul_i32 s34, s34, 20480
s_add_u32 s34, s34, 22020096
buffer_load_dwordx4 v[176:179], v1, s[4:7], s34 offen offset:0
buffer_load_dwordx4 v[180:183], v1, s[4:7], s34 offen offset:1024
buffer_load_dwordx4 v[184:187], v1, s[4:7], s34 offen offset:2048
buffer_load_dwordx4 v[188:191], v1, s[4:7], s34 offen offset:3072
s_add_u32 s34, s34, 4096
buffer_load_dwordx4 v[192:195], v1, s[4:7], s34 offen offset:0
buffer_load_dwordx4 v[196:199], v1, s[4:7], s34 offen offset:1024
buffer_load_dwordx4 v[200:203], v1, s[4:7], s34 offen offset:2048
buffer_load_dwordx4 v[204:207], v1, s[4:7], s34 offen offset:3072
s_add_u32 s34, s34, 4096
buffer_load_dwordx4 v[208:211], v1, s[4:7], s34 offen offset:0
buffer_load_dwordx4 v[212:215], v1, s[4:7], s34 offen offset:1024
buffer_load_dwordx4 v[216:219], v1, s[4:7], s34 offen offset:2048
buffer_load_dwordx4 v[220:223], v1, s[4:7], s34 offen offset:3072
s_add_u32 s34, s34, 4096
buffer_load_dwordx4 v[224:227], v1, s[4:7], s34 offen offset:0
buffer_load_dwordx4 v[228:231], v1, s[4:7], s34 offen offset:1024
buffer_load_dwordx4 v[232:235], v1, s[4:7], s34 offen offset:2048
buffer_load_dwordx4 v[236:239], v1, s[4:7], s34 offen offset:3072
s_add_u32 s34, s34, 4096
buffer_load_dwordx4 v[240:243], v1, s[4:7], s34 offen offset:0
buffer_load_dwordx4 v[244:247], v1, s[4:7], s34 offen offset:1024
buffer_load_dwordx4 v[248:251], v1, s[4:7], s34 offen offset:2048
buffer_load_dwordx4 v[252:255], v1, s[4:7], s34 offen offset:3072
s_waitcnt vmcnt(20)
v_and_b32 v30, 7, v0
v_lshlrev_b32 v30, 3, v30
reca_cens243:
buffer_load_dwordx2 v[28:29], v30, s[8:11], 0 offen sc1
s_waitcnt vmcnt(0)
v_sad_u8 v31, v28, 0, 0
v_sad_u8 v31, v29, 0, v31
v_cmp_gt_u32 vcc, 32, v31
s_cbranch_vccz reca_censok244
s_sleep 8
s_sub_u32 s18, s18, 1
s_cbranch_scc0 reca_cens243
s_mov_b32 s18, 0
reca_censok244:
v_and_b32 v28, 0x20202020, v28
v_and_b32 v29, 0x20202020, v29
v_cmp_ne_u32 s[34:35], 0, v28
v_cmp_ne_u32 s[36:37], 0, v29
s_nop 3
s_and_b32 s34, s34, 0xff
s_and_b32 s36, s36, 0xff
s_or_b32 s35, s34, s36
s_lshr_b32 s37, s35, s13
s_and_b32 s37, s37, 1
s_xor_b32 s43, s37, 1
s_cmp_eq_u32 s57, 0
s_cselect_b32 s58, s36, s34
v_mov_b32 v31, 0x80000000
s_cmp_lg_u32 s43, 0
s_cbranch_scc1 reca_pslow245
reca_ptop246:
s_cmp_lt_u32 s17, 3
s_cbranch_scc1 reca_pgo247
s_sub_u32 s36, s17, 3
reca_ppoll248:
buffer_load_dword v28, v4, s[4:7], s25 offen sc1
s_waitcnt vmcnt(0)
v_readfirstlane_b32 s34, v28
s_nop 3
s_cmp_ge_i32 s34, s36
s_cbranch_scc1 reca_pgo247
s_sleep 8
s_sub_u32 s18, s18, 1
s_cbranch_scc0 reca_ppoll248
s_mov_b32 s18, 0
reca_pgo247:
s_waitcnt vmcnt(0)
s_barrier
v_add_u32 v7, s26, v1
s_xor_b32 s26, s26, 40960
s_add_u32 s37, s17, 1
s_cmp_ge_u32 s37, 64
s_cbranch_scc1 reca_pnodma249
s_mul_i32 s20, s37, 40960
s_add_u32 s20, s20, 84944896
s_add_u32 m0, s26, 10240
s_nop 0
buffer_load_dwordx4 v1, s[4:7], s20 offen offset:0 lds
buffer_load_dwordx4 v1, s[4:7], s20 offen offset:1024 lds
buffer_load_dwordx4 v1, s[4:7], s20 offen offset:2048 lds
buffer_load_dwordx4 v1, s[4:7], s20 offen offset:3072 lds
s_add_u32 s20, s20, 4096
s_add_u32 m0, s26, 14336
s_nop 0
buffer_load_dwordx4 v1, s[4:7], s20 offen offset:0 lds
buffer_load_dwordx4 v1, s[4:7], s20 offen offset:1024 lds
buffer_load_dwordx4 v1, s[4:7], s20 offen offset:2048 lds
buffer_load_dwordx4 v1, s[4:7], s20 offen offset:3072 lds
s_add_u32 s20, s20, 4096
s_add_u32 m0, s26, 18432
s_nop 0
buffer_load_dwordx4 v1, s[4:7], s20 offen offset:0 lds
buffer_load_dwordx4 v1, s[4:7], s20 offen offset:1024 lds
reca_pnodma249:
s_lshl_b32 s34, s15, 3
s_and_b32 s35, s17, 7
s_add_u32 s34, s34, s35
s_mul_i32 s34, s34, 12288
s_mul_i32 s35, s16, 3072
s_add_u32 s35, s35, s34
s_add_u32 s21, s35, 37748736
s_add_u32 s22, s35, 44040192
s_mul_i32 s35, s16, 6144
s_add_u32 s35, s35, s34
s_add_u32 s23, s35, 40894464
ds_read_b128 v[72:75], v7 offset:0
ds_read_b128 v[76:79], v7 offset:20480
ds_read_b128 v[80:83], v7 offset:1024
ds_read_b128 v[84:87], v7 offset:21504
ds_read_b128 v[88:91], v7 offset:2048
ds_read_b128 v[92:95], v7 offset:22528
s_waitcnt lgkmcnt(4)
v_mfma_f32_16x16x32_bf16 v[32:35], a[0:3], v[72:75], 0
v_mfma_f32_16x16x32_bf16 v[36:39], a[0:3], v[76:79], 0
v_mfma_f32_16x16x32_bf16 v[40:43], a[80:83], v[72:75], 0
v_mfma_f32_16x16x32_bf16 v[44:47], a[80:83], v[76:79], 0
v_mfma_f32_16x16x32_bf16 v[48:51], v[72:75], a[160:163], 0
v_mfma_f32_16x16x32_bf16 v[52:55], v[76:79], a[160:163], 0
v_mfma_f32_16x16x32_bf16 v[56:59], v[72:75], v[96:99], 0
v_mfma_f32_16x16x32_bf16 v[60:63], v[76:79], v[96:99], 0
v_mfma_f32_16x16x32_bf16 v[64:67], v[72:75], v[176:179], 0
v_mfma_f32_16x16x32_bf16 v[68:71], v[76:79], v[176:179], 0
ds_read_b128 v[72:75], v7 offset:3072
ds_read_b128 v[76:79], v7 offset:23552
s_waitcnt lgkmcnt(4)
v_mfma_f32_16x16x32_bf16 v[32:35], a[4:7], v[80:83], v[32:35]
v_mfma_f32_16x16x32_bf16 v[36:39], a[4:7], v[84:87], v[36:39]
v_mfma_f32_16x16x32_bf16 v[40:43], a[84:87], v[80:83], v[40:43]
v_mfma_f32_16x16x32_bf16 v[44:47], a[84:87], v[84:87], v[44:47]
v_mfma_f32_16x16x32_bf16 v[48:51], v[80:83], a[164:167], v[48:51]
v_mfma_f32_16x16x32_bf16 v[52:55], v[84:87], a[164:167], v[52:55]
v_mfma_f32_16x16x32_bf16 v[56:59], v[80:83], v[100:103], v[56:59]
v_mfma_f32_16x16x32_bf16 v[60:63], v[84:87], v[100:103], v[60:63]
v_mfma_f32_16x16x32_bf16 v[64:67], v[80:83], v[180:183], v[64:67]
v_mfma_f32_16x16x32_bf16 v[68:71], v[84:87], v[180:183], v[68:71]
ds_read_b128 v[80:83], v7 offset:4096
ds_read_b128 v[84:87], v7 offset:24576
s_waitcnt lgkmcnt(4)
v_mfma_f32_16x16x32_bf16 v[32:35], a[8:11], v[88:91], v[32:35]
v_mfma_f32_16x16x32_bf16 v[36:39], a[8:11], v[92:95], v[36:39]
v_mfma_f32_16x16x32_bf16 v[40:43], a[88:91], v[88:91], v[40:43]
v_mfma_f32_16x16x32_bf16 v[44:47], a[88:91], v[92:95], v[44:47]
v_mfma_f32_16x16x32_bf16 v[48:51], v[88:91], a[168:171], v[48:51]
v_mfma_f32_16x16x32_bf16 v[52:55], v[92:95], a[168:171], v[52:55]
v_mfma_f32_16x16x32_bf16 v[56:59], v[88:91], v[104:107], v[56:59]
v_mfma_f32_16x16x32_bf16 v[60:63], v[92:95], v[104:107], v[60:63]
v_mfma_f32_16x16x32_bf16 v[64:67], v[88:91], v[184:187], v[64:67]
v_mfma_f32_16x16x32_bf16 v[68:71], v[92:95], v[184:187], v[68:71]
ds_read_b128 v[88:91], v7 offset:5120
ds_read_b128 v[92:95], v7 offset:25600
s_waitcnt lgkmcnt(4)
v_mfma_f32_16x16x32_bf16 v[32:35], a[12:15], v[72:75], v[32:35]
v_mfma_f32_16x16x32_bf16 v[36:39], a[12:15], v[76:79], v[36:39]
v_mfma_f32_16x16x32_bf16 v[40:43], a[92:95], v[72:75], v[40:43]
v_mfma_f32_16x16x32_bf16 v[44:47], a[92:95], v[76:79], v[44:47]
v_mfma_f32_16x16x32_bf16 v[48:51], v[72:75], a[172:175], v[48:51]
v_mfma_f32_16x16x32_bf16 v[52:55], v[76:79], a[172:175], v[52:55]
v_mfma_f32_16x16x32_bf16 v[56:59], v[72:75], v[108:111], v[56:59]
v_mfma_f32_16x16x32_bf16 v[60:63], v[76:79], v[108:111], v[60:63]
v_mfma_f32_16x16x32_bf16 v[64:67], v[72:75], v[188:191], v[64:67]
v_mfma_f32_16x16x32_bf16 v[68:71], v[76:79], v[188:191], v[68:71]
ds_read_b128 v[72:75], v7 offset:6144
ds_read_b128 v[76:79], v7 offset:26624
s_waitcnt lgkmcnt(4)
v_mfma_f32_16x16x32_bf16 v[32:35], a[16:19], v[80:83], v[32:35]
v_mfma_f32_16x16x32_bf16 v[36:39], a[16:19], v[84:87], v[36:39]
v_mfma_f32_16x16x32_bf16 v[40:43], a[96:99], v[80:83], v[40:43]
v_mfma_f32_16x16x32_bf16 v[44:47], a[96:99], v[84:87], v[44:47]
v_mfma_f32_16x16x32_bf16 v[48:51], v[80:83], a[176:179], v[48:51]
v_mfma_f32_16x16x32_bf16 v[52:55], v[84:87], a[176:179], v[52:55]
v_mfma_f32_16x16x32_bf16 v[56:59], v[80:83], v[112:115], v[56:59]
v_mfma_f32_16x16x32_bf16 v[60:63], v[84:87], v[112:115], v[60:63]
v_mfma_f32_16x16x32_bf16 v[64:67], v[80:83], v[192:195], v[64:67]
v_mfma_f32_16x16x32_bf16 v[68:71], v[84:87], v[192:195], v[68:71]
ds_read_b128 v[80:83], v7 offset:7168
ds_read_b128 v[84:87], v7 offset:27648
s_waitcnt lgkmcnt(4)
v_mfma_f32_16x16x32_bf16 v[32:35], a[20:23], v[88:91], v[32:35]
v_mfma_f32_16x16x32_bf16 v[36:39], a[20:23], v[92:95], v[36:39]
v_mfma_f32_16x16x32_bf16 v[40:43], a[100:103], v[88:91], v[40:43]
v_mfma_f32_16x16x32_bf16 v[44:47], a[100:103], v[92:95], v[44:47]
v_mfma_f32_16x16x32_bf16 v[48:51], v[88:91], a[180:183], v[48:51]
v_mfma_f32_16x16x32_bf16 v[52:55], v[92:95], a[180:183], v[52:55]
v_mfma_f32_16x16x32_bf16 v[56:59], v[88:91], v[116:119], v[56:59]
v_mfma_f32_16x16x32_bf16 v[60:63], v[92:95], v[116:119], v[60:63]
v_mfma_f32_16x16x32_bf16 v[64:67], v[88:91], v[196:199], v[64:67]
v_mfma_f32_16x16x32_bf16 v[68:71], v[92:95], v[196:199], v[68:71]
ds_read_b128 v[88:91], v7 offset:8192
ds_read_b128 v[92:95], v7 offset:28672
s_waitcnt lgkmcnt(4)
v_mfma_f32_16x16x32_bf16 v[32:35], a[24:27], v[72:75], v[32:35]
v_mfma_f32_16x16x32_bf16 v[36:39], a[24:27], v[76:79], v[36:39]
v_mfma_f32_16x16x32_bf16 v[40:43], a[104:107], v[72:75], v[40:43]
v_mfma_f32_16x16x32_bf16 v[44:47], a[104:107], v[76:79], v[44:47]
v_mfma_f32_16x16x32_bf16 v[48:51], v[72:75], a[184:187], v[48:51]
v_mfma_f32_16x16x32_bf16 v[52:55], v[76:79], a[184:187], v[52:55]
v_mfma_f32_16x16x32_bf16 v[56:59], v[72:75], v[120:123], v[56:59]
v_mfma_f32_16x16x32_bf16 v[60:63], v[76:79], v[120:123], v[60:63]
v_mfma_f32_16x16x32_bf16 v[64:67], v[72:75], v[200:203], v[64:67]
v_mfma_f32_16x16x32_bf16 v[68:71], v[76:79], v[200:203], v[68:71]
ds_read_b128 v[72:75], v7 offset:9216
ds_read_b128 v[76:79], v7 offset:29696
s_waitcnt lgkmcnt(4)
v_mfma_f32_16x16x32_bf16 v[32:35], a[28:31], v[80:83], v[32:35]
v_mfma_f32_16x16x32_bf16 v[36:39], a[28:31], v[84:87], v[36:39]
v_mfma_f32_16x16x32_bf16 v[40:43], a[108:111], v[80:83], v[40:43]
v_mfma_f32_16x16x32_bf16 v[44:47], a[108:111], v[84:87], v[44:47]
v_mfma_f32_16x16x32_bf16 v[48:51], v[80:83], a[188:191], v[48:51]
v_mfma_f32_16x16x32_bf16 v[52:55], v[84:87], a[188:191], v[52:55]
v_mfma_f32_16x16x32_bf16 v[56:59], v[80:83], v[124:127], v[56:59]
v_mfma_f32_16x16x32_bf16 v[60:63], v[84:87], v[124:127], v[60:63]
v_mfma_f32_16x16x32_bf16 v[64:67], v[80:83], v[204:207], v[64:67]
v_mfma_f32_16x16x32_bf16 v[68:71], v[84:87], v[204:207], v[68:71]
ds_read_b128 v[80:83], v7 offset:10240
ds_read_b128 v[84:87], v7 offset:30720
s_waitcnt lgkmcnt(4)
v_mfma_f32_16x16x32_bf16 v[32:35], a[32:35], v[88:91], v[32:35]
v_mfma_f32_16x16x32_bf16 v[36:39], a[32:35], v[92:95], v[36:39]
v_mfma_f32_16x16x32_bf16 v[40:43], a[112:115], v[88:91], v[40:43]
v_mfma_f32_16x16x32_bf16 v[44:47], a[112:115], v[92:95], v[44:47]
v_mfma_f32_16x16x32_bf16 v[48:51], v[88:91], a[192:195], v[48:51]
v_mfma_f32_16x16x32_bf16 v[52:55], v[92:95], a[192:195], v[52:55]
v_mfma_f32_16x16x32_bf16 v[56:59], v[88:91], v[128:131], v[56:59]
v_mfma_f32_16x16x32_bf16 v[60:63], v[92:95], v[128:131], v[60:63]
v_mfma_f32_16x16x32_bf16 v[64:67], v[88:91], v[208:211], v[64:67]
v_mfma_f32_16x16x32_bf16 v[68:71], v[92:95], v[208:211], v[68:71]
ds_read_b128 v[88:91], v7 offset:11264
ds_read_b128 v[92:95], v7 offset:31744
s_waitcnt lgkmcnt(4)
v_mfma_f32_16x16x32_bf16 v[32:35], a[36:39], v[72:75], v[32:35]
v_mfma_f32_16x16x32_bf16 v[36:39], a[36:39], v[76:79], v[36:39]
v_mfma_f32_16x16x32_bf16 v[40:43], a[116:119], v[72:75], v[40:43]
v_mfma_f32_16x16x32_bf16 v[44:47], a[116:119], v[76:79], v[44:47]
v_mfma_f32_16x16x32_bf16 v[48:51], v[72:75], a[196:199], v[48:51]
v_mfma_f32_16x16x32_bf16 v[52:55], v[76:79], a[196:199], v[52:55]
v_mfma_f32_16x16x32_bf16 v[56:59], v[72:75], v[132:135], v[56:59]
v_mfma_f32_16x16x32_bf16 v[60:63], v[76:79], v[132:135], v[60:63]
v_mfma_f32_16x16x32_bf16 v[64:67], v[72:75], v[212:215], v[64:67]
v_mfma_f32_16x16x32_bf16 v[68:71], v[76:79], v[212:215], v[68:71]
ds_read_b128 v[72:75], v7 offset:12288
ds_read_b128 v[76:79], v7 offset:32768
s_waitcnt lgkmcnt(4)
v_mfma_f32_16x16x32_bf16 v[32:35], a[40:43], v[80:83], v[32:35]
v_mfma_f32_16x16x32_bf16 v[36:39], a[40:43], v[84:87], v[36:39]
v_mfma_f32_16x16x32_bf16 v[40:43], a[120:123], v[80:83], v[40:43]
v_mfma_f32_16x16x32_bf16 v[44:47], a[120:123], v[84:87], v[44:47]
v_mfma_f32_16x16x32_bf16 v[48:51], v[80:83], a[200:203], v[48:51]
v_mfma_f32_16x16x32_bf16 v[52:55], v[84:87], a[200:203], v[52:55]
v_mfma_f32_16x16x32_bf16 v[56:59], v[80:83], v[136:139], v[56:59]
v_mfma_f32_16x16x32_bf16 v[60:63], v[84:87], v[136:139], v[60:63]
v_mfma_f32_16x16x32_bf16 v[64:67], v[80:83], v[216:219], v[64:67]
v_mfma_f32_16x16x32_bf16 v[68:71], v[84:87], v[216:219], v[68:71]
ds_read_b128 v[80:83], v7 offset:13312
ds_read_b128 v[84:87], v7 offset:33792
s_waitcnt lgkmcnt(4)
v_mfma_f32_16x16x32_bf16 v[32:35], a[44:47], v[88:91], v[32:35]
v_mfma_f32_16x16x32_bf16 v[36:39], a[44:47], v[92:95], v[36:39]
v_mfma_f32_16x16x32_bf16 v[40:43], a[124:127], v[88:91], v[40:43]
v_mfma_f32_16x16x32_bf16 v[44:47], a[124:127], v[92:95], v[44:47]
v_mfma_f32_16x16x32_bf16 v[48:51], v[88:91], a[204:207], v[48:51]
v_mfma_f32_16x16x32_bf16 v[52:55], v[92:95], a[204:207], v[52:55]
v_mfma_f32_16x16x32_bf16 v[56:59], v[88:91], v[140:143], v[56:59]
v_mfma_f32_16x16x32_bf16 v[60:63], v[92:95], v[140:143], v[60:63]
v_mfma_f32_16x16x32_bf16 v[64:67], v[88:91], v[220:223], v[64:67]
v_mfma_f32_16x16x32_bf16 v[68:71], v[92:95], v[220:223], v[68:71]
ds_read_b128 v[88:91], v7 offset:14336
ds_read_b128 v[92:95], v7 offset:34816
s_waitcnt lgkmcnt(4)
v_mfma_f32_16x16x32_bf16 v[32:35], a[48:51], v[72:75], v[32:35]
v_mfma_f32_16x16x32_bf16 v[36:39], a[48:51], v[76:79], v[36:39]
v_mfma_f32_16x16x32_bf16 v[40:43], a[128:131], v[72:75], v[40:43]
v_mfma_f32_16x16x32_bf16 v[44:47], a[128:131], v[76:79], v[44:47]
v_mfma_f32_16x16x32_bf16 v[48:51], v[72:75], a[208:211], v[48:51]
v_mfma_f32_16x16x32_bf16 v[52:55], v[76:79], a[208:211], v[52:55]
v_mfma_f32_16x16x32_bf16 v[56:59], v[72:75], v[144:147], v[56:59]
v_mfma_f32_16x16x32_bf16 v[60:63], v[76:79], v[144:147], v[60:63]
v_mfma_f32_16x16x32_bf16 v[64:67], v[72:75], v[224:227], v[64:67]
v_mfma_f32_16x16x32_bf16 v[68:71], v[76:79], v[224:227], v[68:71]
ds_read_b128 v[72:75], v7 offset:15360
ds_read_b128 v[76:79], v7 offset:35840
s_waitcnt lgkmcnt(4)
v_mfma_f32_16x16x32_bf16 v[32:35], a[52:55], v[80:83], v[32:35]
v_mfma_f32_16x16x32_bf16 v[36:39], a[52:55], v[84:87], v[36:39]
v_mfma_f32_16x16x32_bf16 v[40:43], a[132:135], v[80:83], v[40:43]
v_mfma_f32_16x16x32_bf16 v[44:47], a[132:135], v[84:87], v[44:47]
v_mfma_f32_16x16x32_bf16 v[48:51], v[80:83], a[212:215], v[48:51]
v_mfma_f32_16x16x32_bf16 v[52:55], v[84:87], a[212:215], v[52:55]
v_mfma_f32_16x16x32_bf16 v[56:59], v[80:83], v[148:151], v[56:59]
v_mfma_f32_16x16x32_bf16 v[60:63], v[84:87], v[148:151], v[60:63]
v_mfma_f32_16x16x32_bf16 v[64:67], v[80:83], v[228:231], v[64:67]
v_mfma_f32_16x16x32_bf16 v[68:71], v[84:87], v[228:231], v[68:71]
ds_read_b128 v[80:83], v7 offset:16384
ds_read_b128 v[84:87], v7 offset:36864
s_waitcnt lgkmcnt(4)
v_mfma_f32_16x16x32_bf16 v[32:35], a[56:59], v[88:91], v[32:35]
v_mfma_f32_16x16x32_bf16 v[36:39], a[56:59], v[92:95], v[36:39]
v_mfma_f32_16x16x32_bf16 v[40:43], a[136:139], v[88:91], v[40:43]
v_mfma_f32_16x16x32_bf16 v[44:47], a[136:139], v[92:95], v[44:47]
v_mfma_f32_16x16x32_bf16 v[48:51], v[88:91], a[216:219], v[48:51]
v_mfma_f32_16x16x32_bf16 v[52:55], v[92:95], a[216:219], v[52:55]
v_mfma_f32_16x16x32_bf16 v[56:59], v[88:91], v[152:155], v[56:59]
v_mfma_f32_16x16x32_bf16 v[60:63], v[92:95], v[152:155], v[60:63]
v_mfma_f32_16x16x32_bf16 v[64:67], v[88:91], v[232:235], v[64:67]
v_mfma_f32_16x16x32_bf16 v[68:71], v[92:95], v[232:235], v[68:71]
ds_read_b128 v[88:91], v7 offset:17408
ds_read_b128 v[92:95], v7 offset:37888
s_waitcnt lgkmcnt(4)
v_mfma_f32_16x16x32_bf16 v[32:35], a[60:63], v[72:75], v[32:35]
v_mfma_f32_16x16x32_bf16 v[36:39], a[60:63], v[76:79], v[36:39]
v_mfma_f32_16x16x32_bf16 v[40:43], a[140:143], v[72:75], v[40:43]
v_mfma_f32_16x16x32_bf16 v[44:47], a[140:143], v[76:79], v[44:47]
v_mfma_f32_16x16x32_bf16 v[48:51], v[72:75], a[220:223], v[48:51]
v_mfma_f32_16x16x32_bf16 v[52:55], v[76:79], a[220:223], v[52:55]
v_mfma_f32_16x16x32_bf16 v[56:59], v[72:75], v[156:159], v[56:59]
v_mfma_f32_16x16x32_bf16 v[60:63], v[76:79], v[156:159], v[60:63]
v_mfma_f32_16x16x32_bf16 v[64:67], v[72:75], v[236:239], v[64:67]
v_mfma_f32_16x16x32_bf16 v[68:71], v[76:79], v[236:239], v[68:71]
ds_read_b128 v[72:75], v7 offset:18432
ds_read_b128 v[76:79], v7 offset:38912
s_waitcnt lgkmcnt(4)
v_mfma_f32_16x16x32_bf16 v[32:35], a[64:67], v[80:83], v[32:35]
v_mfma_f32_16x16x32_bf16 v[36:39], a[64:67], v[84:87], v[36:39]
v_mfma_f32_16x16x32_bf16 v[40:43], a[144:147], v[80:83], v[40:43]
v_mfma_f32_16x16x32_bf16 v[44:47], a[144:147], v[84:87], v[44:47]
v_mfma_f32_16x16x32_bf16 v[48:51], v[80:83], a[224:227], v[48:51]
v_mfma_f32_16x16x32_bf16 v[52:55], v[84:87], a[224:227], v[52:55]
v_mfma_f32_16x16x32_bf16 v[56:59], v[80:83], v[160:163], v[56:59]
v_mfma_f32_16x16x32_bf16 v[60:63], v[84:87], v[160:163], v[60:63]
v_mfma_f32_16x16x32_bf16 v[64:67], v[80:83], v[240:243], v[64:67]
v_mfma_f32_16x16x32_bf16 v[68:71], v[84:87], v[240:243], v[68:71]
ds_read_b128 v[80:83], v7 offset:19456
ds_read_b128 v[84:87], v7 offset:39936
s_waitcnt lgkmcnt(4)
v_mfma_f32_16x16x32_bf16 v[32:35], a[68:71], v[88:91], v[32:35]
v_mfma_f32_16x16x32_bf16 v[36:39], a[68:71], v[92:95], v[36:39]
v_mfma_f32_16x16x32_bf16 v[40:43], a[148:151], v[88:91], v[40:43]
v_mfma_f32_16x16x32_bf16 v[44:47], a[148:151], v[92:95], v[44:47]
v_mfma_f32_16x16x32_bf16 v[48:51], v[88:91], a[228:231], v[48:51]
v_mfma_f32_16x16x32_bf16 v[52:55], v[92:95], a[228:231], v[52:55]
v_mfma_f32_16x16x32_bf16 v[56:59], v[88:91], v[164:167], v[56:59]
v_mfma_f32_16x16x32_bf16 v[60:63], v[92:95], v[164:167], v[60:63]
v_mfma_f32_16x16x32_bf16 v[64:67], v[88:91], v[244:247], v[64:67]
v_mfma_f32_16x16x32_bf16 v[68:71], v[92:95], v[244:247], v[68:71]
s_waitcnt lgkmcnt(2)
v_mfma_f32_16x16x32_bf16 v[32:35], a[72:75], v[72:75], v[32:35]
v_mfma_f32_16x16x32_bf16 v[36:39], a[72:75], v[76:79], v[36:39]
v_mfma_f32_16x16x32_bf16 v[40:43], a[152:155], v[72:75], v[40:43]
v_mfma_f32_16x16x32_bf16 v[44:47], a[152:155], v[76:79], v[44:47]
v_mfma_f32_16x16x32_bf16 v[48:51], v[72:75], a[232:235], v[48:51]
v_mfma_f32_16x16x32_bf16 v[52:55], v[76:79], a[232:235], v[52:55]
v_mfma_f32_16x16x32_bf16 v[56:59], v[72:75], v[168:171], v[56:59]
v_mfma_f32_16x16x32_bf16 v[60:63], v[76:79], v[168:171], v[60:63]
v_mfma_f32_16x16x32_bf16 v[64:67], v[72:75], v[248:251], v[64:67]
v_mfma_f32_16x16x32_bf16 v[68:71], v[76:79], v[248:251], v[68:71]
s_waitcnt lgkmcnt(0)
v_mfma_f32_16x16x32_bf16 v[32:35], a[76:79], v[80:83], v[32:35]
v_mfma_f32_16x16x32_bf16 v[36:39], a[76:79], v[84:87], v[36:39]
v_mfma_f32_16x16x32_bf16 v[40:43], a[156:159], v[80:83], v[40:43]
v_mfma_f32_16x16x32_bf16 v[44:47], a[156:159], v[84:87], v[44:47]
v_mfma_f32_16x16x32_bf16 v[48:51], v[80:83], a[236:239], v[48:51]
v_mfma_f32_16x16x32_bf16 v[52:55], v[84:87], a[236:239], v[52:55]
v_mfma_f32_16x16x32_bf16 v[56:59], v[80:83], v[172:175], v[56:59]
v_mfma_f32_16x16x32_bf16 v[60:63], v[84:87], v[172:175], v[60:63]
v_mfma_f32_16x16x32_bf16 v[64:67], v[80:83], v[252:255], v[64:67]
v_mfma_f32_16x16x32_bf16 v[68:71], v[84:87], v[252:255], v[68:71]
v_cvt_pk_bf16_f32 v8, v32, v33
v_cvt_pk_bf16_f32 v9, v34, v35
v_cvt_pk_bf16_f32 v10, v40, v41
v_cvt_pk_bf16_f32 v11, v42, v43
s_add_u32 s34, s21, 2048
buffer_store_dwordx4 v[8:11], v1, s[4:7], s34 offen
v_cvt_pk_bf16_f32 v12, v36, v37
v_cvt_pk_bf16_f32 v13, v38, v39
v_cvt_pk_bf16_f32 v14, v44, v45
v_cvt_pk_bf16_f32 v15, v46, v47
s_add_u32 s34, s21, 8192
buffer_store_dwordx4 v[12:15], v1, s[4:7], s34 offen
v_cvt_pk_bf16_f32 v8, v48, v49
v_cvt_pk_bf16_f32 v9, v50, v51
v_cvt_pk_bf16_f32 v10, v52, v53
v_cvt_pk_bf16_f32 v11, v54, v55
s_add_u32 s34, s23, 1024
buffer_store_dwordx4 v[8:11], v1, s[4:7], s34 offen
v_cvt_pk_bf16_f32 v12, v56, v57
v_cvt_pk_bf16_f32 v13, v58, v59
v_cvt_pk_bf16_f32 v14, v60, v61
v_cvt_pk_bf16_f32 v15, v62, v63
s_add_u32 s34, s23, 2048
buffer_store_dwordx4 v[12:15], v1, s[4:7], s34 offen
v_cvt_pk_bf16_f32 v8, v64, v65
v_cvt_pk_bf16_f32 v9, v66, v67
v_cvt_pk_bf16_f32 v10, v68, v69
v_cvt_pk_bf16_f32 v11, v70, v71
s_add_u32 s34, s23, 3072
buffer_store_dwordx4 v[8:11], v1, s[4:7], s34 offen
s_waitcnt vmcnt(0)
s_barrier
s_add_u32 s17, s17, 1
s_cmp_lt_u32 s17, 64
s_cbranch_scc1 reca_ptop246
s_branch reca_exit1
reca_pslow245:
reca_ptop251:
s_cmp_lt_u32 s17, 3
s_cbranch_scc1 reca_pgo252
s_sub_u32 s36, s17, 3
reca_ppoll253:
buffer_load_dword v28, v4, s[4:7], s25 offen sc1
s_waitcnt vmcnt(0)
v_readfirstlane_b32 s34, v28
s_nop 3
s_cmp_ge_i32 s34, s36
s_cbranch_scc1 reca_pgo252
s_sleep 8
s_sub_u32 s18, s18, 1
s_cbranch_scc0 reca_ppoll253
s_mov_b32 s18, 0
reca_pgo252:
s_waitcnt vmcnt(0)
s_barrier
v_add_u32 v7, s26, v1
s_xor_b32 s26, s26, 40960
s_add_u32 s37, s17, 1
s_cmp_ge_u32 s37, 64
s_cbranch_scc1 reca_pnodma254
s_mul_i32 s20, s37, 40960
s_add_u32 s20, s20, 84944896
s_add_u32 m0, s26, 10240
s_nop 0
buffer_load_dwordx4 v1, s[4:7], s20 offen offset:0 lds
buffer_load_dwordx4 v1, s[4:7], s20 offen offset:1024 lds
buffer_load_dwordx4 v1, s[4:7], s20 offen offset:2048 lds
buffer_load_dwordx4 v1, s[4:7], s20 offen offset:3072 lds
s_add_u32 s20, s20, 4096
s_add_u32 m0, s26, 14336
s_nop 0
buffer_load_dwordx4 v1, s[4:7], s20 offen offset:0 lds
buffer_load_dwordx4 v1, s[4:7], s20 offen offset:1024 lds
buffer_load_dwordx4 v1, s[4:7], s20 offen offset:2048 lds
buffer_load_dwordx4 v1, s[4:7], s20 offen offset:3072 lds
s_add_u32 s20, s20, 4096
s_add_u32 m0, s26, 18432
s_nop 0
buffer_load_dwordx4 v1, s[4:7], s20 offen offset:0 lds
buffer_load_dwordx4 v1, s[4:7], s20 offen offset:1024 lds
reca_pnodma254:
s_lshl_b32 s34, s15, 3
s_and_b32 s35, s17, 7
s_add_u32 s34, s34, s35
s_mul_i32 s34, s34, 12288
s_mul_i32 s35, s16, 3072
s_add_u32 s35, s35, s34
s_add_u32 s21, s35, 37748736
s_add_u32 s22, s35, 44040192
s_mul_i32 s35, s16, 6144
s_add_u32 s35, s35, s34
s_add_u32 s23, s35, 40894464
ds_read_b128 v[72:75], v7 offset:0
ds_read_b128 v[76:79], v7 offset:20480
ds_read_b128 v[80:83], v7 offset:1024
ds_read_b128 v[84:87], v7 offset:21504
ds_read_b128 v[88:91], v7 offset:2048
ds_read_b128 v[92:95], v7 offset:22528
s_waitcnt lgkmcnt(4)
v_mfma_f32_16x16x32_bf16 v[32:35], a[0:3], v[72:75], 0
v_mfma_f32_16x16x32_bf16 v[36:39], a[0:3], v[76:79], 0
v_mfma_f32_16x16x32_bf16 v[40:43], a[80:83], v[72:75], 0
v_mfma_f32_16x16x32_bf16 v[44:47], a[80:83], v[76:79], 0
v_mfma_f32_16x16x32_bf16 v[48:51], v[72:75], a[160:163], 0
v_mfma_f32_16x16x32_bf16 v[52:55], v[76:79], a[160:163], 0
v_mfma_f32_16x16x32_bf16 v[56:59], v[72:75], v[96:99], 0
v_mfma_f32_16x16x32_bf16 v[60:63], v[76:79], v[96:99], 0
v_mfma_f32_16x16x32_bf16 v[64:67], v[72:75], v[176:179], 0
v_mfma_f32_16x16x32_bf16 v[68:71], v[76:79], v[176:179], 0
ds_read_b128 v[72:75], v7 offset:3072
ds_read_b128 v[76:79], v7 offset:23552
s_waitcnt lgkmcnt(4)
v_mfma_f32_16x16x32_bf16 v[32:35], a[4:7], v[80:83], v[32:35]
v_mfma_f32_16x16x32_bf16 v[36:39], a[4:7], v[84:87], v[36:39]
v_mfma_f32_16x16x32_bf16 v[40:43], a[84:87], v[80:83], v[40:43]
v_mfma_f32_16x16x32_bf16 v[44:47], a[84:87], v[84:87], v[44:47]
v_mfma_f32_16x16x32_bf16 v[48:51], v[80:83], a[164:167], v[48:51]
v_mfma_f32_16x16x32_bf16 v[52:55], v[84:87], a[164:167], v[52:55]
v_mfma_f32_16x16x32_bf16 v[56:59], v[80:83], v[100:103], v[56:59]
v_mfma_f32_16x16x32_bf16 v[60:63], v[84:87], v[100:103], v[60:63]
v_mfma_f32_16x16x32_bf16 v[64:67], v[80:83], v[180:183], v[64:67]
v_mfma_f32_16x16x32_bf16 v[68:71], v[84:87], v[180:183], v[68:71]
ds_read_b128 v[80:83], v7 offset:4096
ds_read_b128 v[84:87], v7 offset:24576
s_waitcnt lgkmcnt(4)
v_mfma_f32_16x16x32_bf16 v[32:35], a[8:11], v[88:91], v[32:35]
v_mfma_f32_16x16x32_bf16 v[36:39], a[8:11], v[92:95], v[36:39]
v_mfma_f32_16x16x32_bf16 v[40:43], a[88:91], v[88:91], v[40:43]
v_mfma_f32_16x16x32_bf16 v[44:47], a[88:91], v[92:95], v[44:47]
v_mfma_f32_16x16x32_bf16 v[48:51], v[88:91], a[168:171], v[48:51]
v_mfma_f32_16x16x32_bf16 v[52:55], v[92:95], a[168:171], v[52:55]
v_mfma_f32_16x16x32_bf16 v[56:59], v[88:91], v[104:107], v[56:59]
v_mfma_f32_16x16x32_bf16 v[60:63], v[92:95], v[104:107], v[60:63]
v_mfma_f32_16x16x32_bf16 v[64:67], v[88:91], v[184:187], v[64:67]
v_mfma_f32_16x16x32_bf16 v[68:71], v[92:95], v[184:187], v[68:71]
ds_read_b128 v[88:91], v7 offset:5120
ds_read_b128 v[92:95], v7 offset:25600
s_waitcnt lgkmcnt(4)
v_mfma_f32_16x16x32_bf16 v[32:35], a[12:15], v[72:75], v[32:35]
v_mfma_f32_16x16x32_bf16 v[36:39], a[12:15], v[76:79], v[36:39]
v_mfma_f32_16x16x32_bf16 v[40:43], a[92:95], v[72:75], v[40:43]
v_mfma_f32_16x16x32_bf16 v[44:47], a[92:95], v[76:79], v[44:47]
v_mfma_f32_16x16x32_bf16 v[48:51], v[72:75], a[172:175], v[48:51]
v_mfma_f32_16x16x32_bf16 v[52:55], v[76:79], a[172:175], v[52:55]
v_mfma_f32_16x16x32_bf16 v[56:59], v[72:75], v[108:111], v[56:59]
v_mfma_f32_16x16x32_bf16 v[60:63], v[76:79], v[108:111], v[60:63]
v_mfma_f32_16x16x32_bf16 v[64:67], v[72:75], v[188:191], v[64:67]
v_mfma_f32_16x16x32_bf16 v[68:71], v[76:79], v[188:191], v[68:71]
ds_read_b128 v[72:75], v7 offset:6144
ds_read_b128 v[76:79], v7 offset:26624
s_waitcnt lgkmcnt(4)
v_mfma_f32_16x16x32_bf16 v[32:35], a[16:19], v[80:83], v[32:35]
v_mfma_f32_16x16x32_bf16 v[36:39], a[16:19], v[84:87], v[36:39]
v_mfma_f32_16x16x32_bf16 v[40:43], a[96:99], v[80:83], v[40:43]
v_mfma_f32_16x16x32_bf16 v[44:47], a[96:99], v[84:87], v[44:47]
v_mfma_f32_16x16x32_bf16 v[48:51], v[80:83], a[176:179], v[48:51]
v_mfma_f32_16x16x32_bf16 v[52:55], v[84:87], a[176:179], v[52:55]
v_mfma_f32_16x16x32_bf16 v[56:59], v[80:83], v[112:115], v[56:59]
v_mfma_f32_16x16x32_bf16 v[60:63], v[84:87], v[112:115], v[60:63]
v_mfma_f32_16x16x32_bf16 v[64:67], v[80:83], v[192:195], v[64:67]
v_mfma_f32_16x16x32_bf16 v[68:71], v[84:87], v[192:195], v[68:71]
ds_read_b128 v[80:83], v7 offset:7168
ds_read_b128 v[84:87], v7 offset:27648
s_waitcnt lgkmcnt(4)
v_mfma_f32_16x16x32_bf16 v[32:35], a[20:23], v[88:91], v[32:35]
v_mfma_f32_16x16x32_bf16 v[36:39], a[20:23], v[92:95], v[36:39]
v_mfma_f32_16x16x32_bf16 v[40:43], a[100:103], v[88:91], v[40:43]
v_mfma_f32_16x16x32_bf16 v[44:47], a[100:103], v[92:95], v[44:47]
v_mfma_f32_16x16x32_bf16 v[48:51], v[88:91], a[180:183], v[48:51]
v_mfma_f32_16x16x32_bf16 v[52:55], v[92:95], a[180:183], v[52:55]
v_mfma_f32_16x16x32_bf16 v[56:59], v[88:91], v[116:119], v[56:59]
v_mfma_f32_16x16x32_bf16 v[60:63], v[92:95], v[116:119], v[60:63]
v_mfma_f32_16x16x32_bf16 v[64:67], v[88:91], v[196:199], v[64:67]
v_mfma_f32_16x16x32_bf16 v[68:71], v[92:95], v[196:199], v[68:71]
ds_read_b128 v[88:91], v7 offset:8192
ds_read_b128 v[92:95], v7 offset:28672
s_waitcnt lgkmcnt(4)
v_mfma_f32_16x16x32_bf16 v[32:35], a[24:27], v[72:75], v[32:35]
v_mfma_f32_16x16x32_bf16 v[36:39], a[24:27], v[76:79], v[36:39]
v_mfma_f32_16x16x32_bf16 v[40:43], a[104:107], v[72:75], v[40:43]
v_mfma_f32_16x16x32_bf16 v[44:47], a[104:107], v[76:79], v[44:47]
v_mfma_f32_16x16x32_bf16 v[48:51], v[72:75], a[184:187], v[48:51]
v_mfma_f32_16x16x32_bf16 v[52:55], v[76:79], a[184:187], v[52:55]
v_mfma_f32_16x16x32_bf16 v[56:59], v[72:75], v[120:123], v[56:59]
v_mfma_f32_16x16x32_bf16 v[60:63], v[76:79], v[120:123], v[60:63]
v_mfma_f32_16x16x32_bf16 v[64:67], v[72:75], v[200:203], v[64:67]
v_mfma_f32_16x16x32_bf16 v[68:71], v[76:79], v[200:203], v[68:71]
ds_read_b128 v[72:75], v7 offset:9216
ds_read_b128 v[76:79], v7 offset:29696
s_waitcnt lgkmcnt(4)
v_mfma_f32_16x16x32_bf16 v[32:35], a[28:31], v[80:83], v[32:35]
v_mfma_f32_16x16x32_bf16 v[36:39], a[28:31], v[84:87], v[36:39]
v_mfma_f32_16x16x32_bf16 v[40:43], a[108:111], v[80:83], v[40:43]
v_mfma_f32_16x16x32_bf16 v[44:47], a[108:111], v[84:87], v[44:47]
v_mfma_f32_16x16x32_bf16 v[48:51], v[80:83], a[188:191], v[48:51]
v_mfma_f32_16x16x32_bf16 v[52:55], v[84:87], a[188:191], v[52:55]
v_mfma_f32_16x16x32_bf16 v[56:59], v[80:83], v[124:127], v[56:59]
v_mfma_f32_16x16x32_bf16 v[60:63], v[84:87], v[124:127], v[60:63]
v_mfma_f32_16x16x32_bf16 v[64:67], v[80:83], v[204:207], v[64:67]
v_mfma_f32_16x16x32_bf16 v[68:71], v[84:87], v[204:207], v[68:71]
ds_read_b128 v[80:83], v7 offset:10240
ds_read_b128 v[84:87], v7 offset:30720
s_waitcnt lgkmcnt(4)
v_mfma_f32_16x16x32_bf16 v[32:35], a[32:35], v[88:91], v[32:35]
v_mfma_f32_16x16x32_bf16 v[36:39], a[32:35], v[92:95], v[36:39]
v_mfma_f32_16x16x32_bf16 v[40:43], a[112:115], v[88:91], v[40:43]
v_mfma_f32_16x16x32_bf16 v[44:47], a[112:115], v[92:95], v[44:47]
v_mfma_f32_16x16x32_bf16 v[48:51], v[88:91], a[192:195], v[48:51]
v_mfma_f32_16x16x32_bf16 v[52:55], v[92:95], a[192:195], v[52:55]
v_mfma_f32_16x16x32_bf16 v[56:59], v[88:91], v[128:131], v[56:59]
v_mfma_f32_16x16x32_bf16 v[60:63], v[92:95], v[128:131], v[60:63]
v_mfma_f32_16x16x32_bf16 v[64:67], v[88:91], v[208:211], v[64:67]
v_mfma_f32_16x16x32_bf16 v[68:71], v[92:95], v[208:211], v[68:71]
ds_read_b128 v[88:91], v7 offset:11264
ds_read_b128 v[92:95], v7 offset:31744
s_waitcnt lgkmcnt(4)
v_mfma_f32_16x16x32_bf16 v[32:35], a[36:39], v[72:75], v[32:35]
v_mfma_f32_16x16x32_bf16 v[36:39], a[36:39], v[76:79], v[36:39]
v_mfma_f32_16x16x32_bf16 v[40:43], a[116:119], v[72:75], v[40:43]
v_mfma_f32_16x16x32_bf16 v[44:47], a[116:119], v[76:79], v[44:47]
v_mfma_f32_16x16x32_bf16 v[48:51], v[72:75], a[196:199], v[48:51]
v_mfma_f32_16x16x32_bf16 v[52:55], v[76:79], a[196:199], v[52:55]
v_mfma_f32_16x16x32_bf16 v[56:59], v[72:75], v[132:135], v[56:59]
v_mfma_f32_16x16x32_bf16 v[60:63], v[76:79], v[132:135], v[60:63]
v_mfma_f32_16x16x32_bf16 v[64:67], v[72:75], v[212:215], v[64:67]
v_mfma_f32_16x16x32_bf16 v[68:71], v[76:79], v[212:215], v[68:71]
ds_read_b128 v[72:75], v7 offset:12288
ds_read_b128 v[76:79], v7 offset:32768
s_waitcnt lgkmcnt(4)
v_mfma_f32_16x16x32_bf16 v[32:35], a[40:43], v[80:83], v[32:35]
v_mfma_f32_16x16x32_bf16 v[36:39], a[40:43], v[84:87], v[36:39]
v_mfma_f32_16x16x32_bf16 v[40:43], a[120:123], v[80:83], v[40:43]
v_mfma_f32_16x16x32_bf16 v[44:47], a[120:123], v[84:87], v[44:47]
v_mfma_f32_16x16x32_bf16 v[48:51], v[80:83], a[200:203], v[48:51]
v_mfma_f32_16x16x32_bf16 v[52:55], v[84:87], a[200:203], v[52:55]
v_mfma_f32_16x16x32_bf16 v[56:59], v[80:83], v[136:139], v[56:59]
v_mfma_f32_16x16x32_bf16 v[60:63], v[84:87], v[136:139], v[60:63]
v_mfma_f32_16x16x32_bf16 v[64:67], v[80:83], v[216:219], v[64:67]
v_mfma_f32_16x16x32_bf16 v[68:71], v[84:87], v[216:219], v[68:71]
ds_read_b128 v[80:83], v7 offset:13312
ds_read_b128 v[84:87], v7 offset:33792
s_waitcnt lgkmcnt(4)
v_mfma_f32_16x16x32_bf16 v[32:35], a[44:47], v[88:91], v[32:35]
v_mfma_f32_16x16x32_bf16 v[36:39], a[44:47], v[92:95], v[36:39]
v_mfma_f32_16x16x32_bf16 v[40:43], a[124:127], v[88:91], v[40:43]
v_mfma_f32_16x16x32_bf16 v[44:47], a[124:127], v[92:95], v[44:47]
v_mfma_f32_16x16x32_bf16 v[48:51], v[88:91], a[204:207], v[48:51]
v_mfma_f32_16x16x32_bf16 v[52:55], v[92:95], a[204:207], v[52:55]
v_mfma_f32_16x16x32_bf16 v[56:59], v[88:91], v[140:143], v[56:59]
v_mfma_f32_16x16x32_bf16 v[60:63], v[92:95], v[140:143], v[60:63]
v_mfma_f32_16x16x32_bf16 v[64:67], v[88:91], v[220:223], v[64:67]
v_mfma_f32_16x16x32_bf16 v[68:71], v[92:95], v[220:223], v[68:71]
ds_read_b128 v[88:91], v7 offset:14336
ds_read_b128 v[92:95], v7 offset:34816
s_waitcnt lgkmcnt(4)
v_mfma_f32_16x16x32_bf16 v[32:35], a[48:51], v[72:75], v[32:35]
v_mfma_f32_16x16x32_bf16 v[36:39], a[48:51], v[76:79], v[36:39]
v_mfma_f32_16x16x32_bf16 v[40:43], a[128:131], v[72:75], v[40:43]
v_mfma_f32_16x16x32_bf16 v[44:47], a[128:131], v[76:79], v[44:47]
v_mfma_f32_16x16x32_bf16 v[48:51], v[72:75], a[208:211], v[48:51]
v_mfma_f32_16x16x32_bf16 v[52:55], v[76:79], a[208:211], v[52:55]
v_mfma_f32_16x16x32_bf16 v[56:59], v[72:75], v[144:147], v[56:59]
v_mfma_f32_16x16x32_bf16 v[60:63], v[76:79], v[144:147], v[60:63]
v_mfma_f32_16x16x32_bf16 v[64:67], v[72:75], v[224:227], v[64:67]
v_mfma_f32_16x16x32_bf16 v[68:71], v[76:79], v[224:227], v[68:71]
ds_read_b128 v[72:75], v7 offset:15360
ds_read_b128 v[76:79], v7 offset:35840
s_waitcnt lgkmcnt(4)
v_mfma_f32_16x16x32_bf16 v[32:35], a[52:55], v[80:83], v[32:35]
v_mfma_f32_16x16x32_bf16 v[36:39], a[52:55], v[84:87], v[36:39]
v_mfma_f32_16x16x32_bf16 v[40:43], a[132:135], v[80:83], v[40:43]
v_mfma_f32_16x16x32_bf16 v[44:47], a[132:135], v[84:87], v[44:47]
v_mfma_f32_16x16x32_bf16 v[48:51], v[80:83], a[212:215], v[48:51]
v_mfma_f32_16x16x32_bf16 v[52:55], v[84:87], a[212:215], v[52:55]
v_mfma_f32_16x16x32_bf16 v[56:59], v[80:83], v[148:151], v[56:59]
v_mfma_f32_16x16x32_bf16 v[60:63], v[84:87], v[148:151], v[60:63]
v_mfma_f32_16x16x32_bf16 v[64:67], v[80:83], v[228:231], v[64:67]
v_mfma_f32_16x16x32_bf16 v[68:71], v[84:87], v[228:231], v[68:71]
ds_read_b128 v[80:83], v7 offset:16384
ds_read_b128 v[84:87], v7 offset:36864
s_waitcnt lgkmcnt(4)
v_mfma_f32_16x16x32_bf16 v[32:35], a[56:59], v[88:91], v[32:35]
v_mfma_f32_16x16x32_bf16 v[36:39], a[56:59], v[92:95], v[36:39]
v_mfma_f32_16x16x32_bf16 v[40:43], a[136:139], v[88:91], v[40:43]
v_mfma_f32_16x16x32_bf16 v[44:47], a[136:139], v[92:95], v[44:47]
v_mfma_f32_16x16x32_bf16 v[48:51], v[88:91], a[216:219], v[48:51]
v_mfma_f32_16x16x32_bf16 v[52:55], v[92:95], a[216:219], v[52:55]
v_mfma_f32_16x16x32_bf16 v[56:59], v[88:91], v[152:155], v[56:59]
v_mfma_f32_16x16x32_bf16 v[60:63], v[92:95], v[152:155], v[60:63]
v_mfma_f32_16x16x32_bf16 v[64:67], v[88:91], v[232:235], v[64:67]
v_mfma_f32_16x16x32_bf16 v[68:71], v[92:95], v[232:235], v[68:71]
ds_read_b128 v[88:91], v7 offset:17408
ds_read_b128 v[92:95], v7 offset:37888
s_waitcnt lgkmcnt(4)
v_mfma_f32_16x16x32_bf16 v[32:35], a[60:63], v[72:75], v[32:35]
v_mfma_f32_16x16x32_bf16 v[36:39], a[60:63], v[76:79], v[36:39]
v_mfma_f32_16x16x32_bf16 v[40:43], a[140:143], v[72:75], v[40:43]
v_mfma_f32_16x16x32_bf16 v[44:47], a[140:143], v[76:79], v[44:47]
v_mfma_f32_16x16x32_bf16 v[48:51], v[72:75], a[220:223], v[48:51]
v_mfma_f32_16x16x32_bf16 v[52:55], v[76:79], a[220:223], v[52:55]
v_mfma_f32_16x16x32_bf16 v[56:59], v[72:75], v[156:159], v[56:59]
v_mfma_f32_16x16x32_bf16 v[60:63], v[76:79], v[156:159], v[60:63]
v_mfma_f32_16x16x32_bf16 v[64:67], v[72:75], v[236:239], v[64:67]
v_mfma_f32_16x16x32_bf16 v[68:71], v[76:79], v[236:239], v[68:71]
ds_read_b128 v[72:75], v7 offset:18432
ds_read_b128 v[76:79], v7 offset:38912
s_waitcnt lgkmcnt(4)
v_mfma_f32_16x16x32_bf16 v[32:35], a[64:67], v[80:83], v[32:35]
v_mfma_f32_16x16x32_bf16 v[36:39], a[64:67], v[84:87], v[36:39]
v_mfma_f32_16x16x32_bf16 v[40:43], a[144:147], v[80:83], v[40:43]
v_mfma_f32_16x16x32_bf16 v[44:47], a[144:147], v[84:87], v[44:47]
v_mfma_f32_16x16x32_bf16 v[48:51], v[80:83], a[224:227], v[48:51]
v_mfma_f32_16x16x32_bf16 v[52:55], v[84:87], a[224:227], v[52:55]
v_mfma_f32_16x16x32_bf16 v[56:59], v[80:83], v[160:163], v[56:59]
v_mfma_f32_16x16x32_bf16 v[60:63], v[84:87], v[160:163], v[60:63]
v_mfma_f32_16x16x32_bf16 v[64:67], v[80:83], v[240:243], v[64:67]
v_mfma_f32_16x16x32_bf16 v[68:71], v[84:87], v[240:243], v[68:71]
ds_read_b128 v[80:83], v7 offset:19456
ds_read_b128 v[84:87], v7 offset:39936
s_waitcnt lgkmcnt(4)
v_mfma_f32_16x16x32_bf16 v[32:35], a[68:71], v[88:91], v[32:35]
v_mfma_f32_16x16x32_bf16 v[36:39], a[68:71], v[92:95], v[36:39]
v_mfma_f32_16x16x32_bf16 v[40:43], a[148:151], v[88:91], v[40:43]
v_mfma_f32_16x16x32_bf16 v[44:47], a[148:151], v[92:95], v[44:47]
v_mfma_f32_16x16x32_bf16 v[48:51], v[88:91], a[228:231], v[48:51]
v_mfma_f32_16x16x32_bf16 v[52:55], v[92:95], a[228:231], v[52:55]
v_mfma_f32_16x16x32_bf16 v[56:59], v[88:91], v[164:167], v[56:59]
v_mfma_f32_16x16x32_bf16 v[60:63], v[92:95], v[164:167], v[60:63]
v_mfma_f32_16x16x32_bf16 v[64:67], v[88:91], v[244:247], v[64:67]
v_mfma_f32_16x16x32_bf16 v[68:71], v[92:95], v[244:247], v[68:71]
s_waitcnt lgkmcnt(2)
v_mfma_f32_16x16x32_bf16 v[32:35], a[72:75], v[72:75], v[32:35]
v_mfma_f32_16x16x32_bf16 v[36:39], a[72:75], v[76:79], v[36:39]
v_mfma_f32_16x16x32_bf16 v[40:43], a[152:155], v[72:75], v[40:43]
v_mfma_f32_16x16x32_bf16 v[44:47], a[152:155], v[76:79], v[44:47]
v_mfma_f32_16x16x32_bf16 v[48:51], v[72:75], a[232:235], v[48:51]
v_mfma_f32_16x16x32_bf16 v[52:55], v[76:79], a[232:235], v[52:55]
v_mfma_f32_16x16x32_bf16 v[56:59], v[72:75], v[168:171], v[56:59]
v_mfma_f32_16x16x32_bf16 v[60:63], v[76:79], v[168:171], v[60:63]
v_mfma_f32_16x16x32_bf16 v[64:67], v[72:75], v[248:251], v[64:67]
v_mfma_f32_16x16x32_bf16 v[68:71], v[76:79], v[248:251], v[68:71]
s_waitcnt lgkmcnt(0)
v_mfma_f32_16x16x32_bf16 v[32:35], a[76:79], v[80:83], v[32:35]
v_mfma_f32_16x16x32_bf16 v[36:39], a[76:79], v[84:87], v[36:39]
v_mfma_f32_16x16x32_bf16 v[40:43], a[156:159], v[80:83], v[40:43]
v_mfma_f32_16x16x32_bf16 v[44:47], a[156:159], v[84:87], v[44:47]
v_mfma_f32_16x16x32_bf16 v[48:51], v[80:83], a[236:239], v[48:51]
v_mfma_f32_16x16x32_bf16 v[52:55], v[84:87], a[236:239], v[52:55]
v_mfma_f32_16x16x32_bf16 v[56:59], v[80:83], v[172:175], v[56:59]
v_mfma_f32_16x16x32_bf16 v[60:63], v[84:87], v[172:175], v[60:63]
v_mfma_f32_16x16x32_bf16 v[64:67], v[80:83], v[252:255], v[64:67]
v_mfma_f32_16x16x32_bf16 v[68:71], v[84:87], v[252:255], v[68:71]
v_cvt_pk_bf16_f32 v8, v32, v33
v_cvt_pk_bf16_f32 v9, v34, v35
v_cvt_pk_bf16_f32 v10, v40, v41
v_cvt_pk_bf16_f32 v11, v42, v43
s_add_u32 s34, s21, 2048
buffer_store_dwordx4 v[8:11], v1, s[4:7], s34 offen sc1
v_cvt_pk_bf16_f32 v12, v36, v37
v_cvt_pk_bf16_f32 v13, v38, v39
v_cvt_pk_bf16_f32 v14, v44, v45
v_cvt_pk_bf16_f32 v15, v46, v47
s_add_u32 s34, s21, 8192
buffer_store_dwordx4 v[12:15], v1, s[4:7], s34 offen sc1
v_cvt_pk_bf16_f32 v8, v48, v49
v_cvt_pk_bf16_f32 v9, v50, v51
v_cvt_pk_bf16_f32 v10, v52, v53
v_cvt_pk_bf16_f32 v11, v54, v55
s_add_u32 s34, s23, 1024
buffer_store_dwordx4 v[8:11], v1, s[4:7], s34 offen sc1
v_cvt_pk_bf16_f32 v12, v56, v57
v_cvt_pk_bf16_f32 v13, v58, v59
v_cvt_pk_bf16_f32 v14, v60, v61
v_cvt_pk_bf16_f32 v15, v62, v63
s_add_u32 s34, s23, 2048
buffer_store_dwordx4 v[12:15], v1, s[4:7], s34 offen sc1
v_cvt_pk_bf16_f32 v8, v64, v65
v_cvt_pk_bf16_f32 v9, v66, v67
v_cvt_pk_bf16_f32 v10, v68, v69
v_cvt_pk_bf16_f32 v11, v70, v71
s_add_u32 s34, s23, 3072
buffer_store_dwordx4 v[8:11], v1, s[4:7], s34 offen sc1
s_waitcnt vmcnt(0)
s_barrier
s_add_u32 s17, s17, 1
s_cmp_lt_u32 s17, 64
s_cbranch_scc1 reca_ptop251
s_branch reca_exit1
reca_pw2_228:
s_mov_b32 s17, 0
s_mov_b32 s26, 0
s_mul_i32 s20, s17, 40960
s_add_u32 s20, s20, 84955136
s_add_u32 m0, s26, 20480
s_nop 0
buffer_load_dwordx4 v1, s[4:7], s20 offen offset:0 lds
buffer_load_dwordx4 v1, s[4:7], s20 offen offset:1024 lds
buffer_load_dwordx4 v1, s[4:7], s20 offen offset:2048 lds
buffer_load_dwordx4 v1, s[4:7], s20 offen offset:3072 lds
s_add_u32 s20, s20, 4096
s_add_u32 m0, s26, 24576
s_nop 0
buffer_load_dwordx4 v1, s[4:7], s20 offen offset:0 lds
buffer_load_dwordx4 v1, s[4:7], s20 offen offset:1024 lds
buffer_load_dwordx4 v1, s[4:7], s20 offen offset:2048 lds
buffer_load_dwordx4 v1, s[4:7], s20 offen offset:3072 lds
s_add_u32 s20, s20, 4096
s_add_u32 m0, s26, 28672
s_nop 0
buffer_load_dwordx4 v1, s[4:7], s20 offen offset:0 lds
buffer_load_dwordx4 v1, s[4:7], s20 offen offset:1024 lds
s_mul_i32 s34, s15, 12
s_mul_i32 s35, s16, 6
s_add_u32 s34, s34, s35
s_add_u32 s34, s34, 0
s_mul_i32 s34, s34, 20480
s_add_u32 s34, s34, 6291456
buffer_load_dwordx4 a[0:3], v1, s[4:7], s34 offen offset:0
buffer_load_dwordx4 a[4:7], v1, s[4:7], s34 offen offset:1024
buffer_load_dwordx4 a[8:11], v1, s[4:7], s34 offen offset:2048
buffer_load_dwordx4 a[12:15], v1, s[4:7], s34 offen offset:3072
s_add_u32 s34, s34, 4096
buffer_load_dwordx4 a[16:19], v1, s[4:7], s34 offen offset:0
buffer_load_dwordx4 a[20:23], v1, s[4:7], s34 offen offset:1024
buffer_load_dwordx4 a[24:27], v1, s[4:7], s34 offen offset:2048
buffer_load_dwordx4 a[28:31], v1, s[4:7], s34 offen offset:3072
s_add_u32 s34, s34, 4096
buffer_load_dwordx4 a[32:35], v1, s[4:7], s34 offen offset:0
buffer_load_dwordx4 a[36:39], v1, s[4:7], s34 offen offset:1024
buffer_load_dwordx4 a[40:43], v1, s[4:7], s34 offen offset:2048
buffer_load_dwordx4 a[44:47], v1, s[4:7], s34 offen offset:3072
s_add_u32 s34, s34, 4096
buffer_load_dwordx4 a[48:51], v1, s[4:7], s34 offen offset:0
buffer_load_dwordx4 a[52:55], v1, s[4:7], s34 offen offset:1024
buffer_load_dwordx4 a[56:59], v1, s[4:7], s34 offen offset:2048
buffer_load_dwordx4 a[60:63], v1, s[4:7], s34 offen offset:3072
s_add_u32 s34, s34, 4096
buffer_load_dwordx4 a[64:67], v1, s[4:7], s34 offen offset:0
buffer_load_dwordx4 a[68:71], v1, s[4:7], s34 offen offset:1024
buffer_load_dwordx4 a[72:75], v1, s[4:7], s34 offen offset:2048
buffer_load_dwordx4 a[76:79], v1, s[4:7], s34 offen offset:3072
s_mul_i32 s34, s15, 12
s_mul_i32 s35, s16, 6
s_add_u32 s34, s34, s35
s_add_u32 s34, s34, 1
s_mul_i32 s34, s34, 20480
s_add_u32 s34, s34, 6291456
buffer_load_dwordx4 a[80:83], v1, s[4:7], s34 offen offset:0
buffer_load_dwordx4 a[84:87], v1, s[4:7], s34 offen offset:1024
buffer_load_dwordx4 a[88:91], v1, s[4:7], s34 offen offset:2048
buffer_load_dwordx4 a[92:95], v1, s[4:7], s34 offen offset:3072
s_add_u32 s34, s34, 4096
buffer_load_dwordx4 a[96:99], v1, s[4:7], s34 offen offset:0
buffer_load_dwordx4 a[100:103], v1, s[4:7], s34 offen offset:1024
buffer_load_dwordx4 a[104:107], v1, s[4:7], s34 offen offset:2048
buffer_load_dwordx4 a[108:111], v1, s[4:7], s34 offen offset:3072
s_add_u32 s34, s34, 4096
buffer_load_dwordx4 a[112:115], v1, s[4:7], s34 offen offset:0
buffer_load_dwordx4 a[116:119], v1, s[4:7], s34 offen offset:1024
buffer_load_dwordx4 a[120:123], v1, s[4:7], s34 offen offset:2048
buffer_load_dwordx4 a[124:127], v1, s[4:7], s34 offen offset:3072
s_add_u32 s34, s34, 4096
buffer_load_dwordx4 a[128:131], v1, s[4:7], s34 offen offset:0
buffer_load_dwordx4 a[132:135], v1, s[4:7], s34 offen offset:1024
buffer_load_dwordx4 a[136:139], v1, s[4:7], s34 offen offset:2048
buffer_load_dwordx4 a[140:143], v1, s[4:7], s34 offen offset:3072
s_add_u32 s34, s34, 4096
buffer_load_dwordx4 a[144:147], v1, s[4:7], s34 offen offset:0
buffer_load_dwordx4 a[148:151], v1, s[4:7], s34 offen offset:1024
buffer_load_dwordx4 a[152:155], v1, s[4:7], s34 offen offset:2048
buffer_load_dwordx4 a[156:159], v1, s[4:7], s34 offen offset:3072
s_waitcnt vmcnt(20)
s_mul_i32 s34, s15, 12
s_mul_i32 s35, s16, 6
s_add_u32 s34, s34, s35
s_add_u32 s34, s34, 4
s_mul_i32 s34, s34, 20480
s_add_u32 s34, s34, 22020096
buffer_load_dwordx4 a[160:163], v1, s[4:7], s34 offen offset:0
buffer_load_dwordx4 a[164:167], v1, s[4:7], s34 offen offset:1024
buffer_load_dwordx4 a[168:171], v1, s[4:7], s34 offen offset:2048
buffer_load_dwordx4 a[172:175], v1, s[4:7], s34 offen offset:3072
s_add_u32 s34, s34, 4096
buffer_load_dwordx4 a[176:179], v1, s[4:7], s34 offen offset:0
buffer_load_dwordx4 a[180:183], v1, s[4:7], s34 offen offset:1024
buffer_load_dwordx4 a[184:187], v1, s[4:7], s34 offen offset:2048
buffer_load_dwordx4 a[188:191], v1, s[4:7], s34 offen offset:3072
s_add_u32 s34, s34, 4096
buffer_load_dwordx4 a[192:195], v1, s[4:7], s34 offen offset:0
buffer_load_dwordx4 a[196:199], v1, s[4:7], s34 offen offset:1024
buffer_load_dwordx4 a[200:203], v1, s[4:7], s34 offen offset:2048
buffer_load_dwordx4 a[204:207], v1, s[4:7], s34 offen offset:3072
s_add_u32 s34, s34, 4096
buffer_load_dwordx4 a[208:211], v1, s[4:7], s34 offen offset:0
buffer_load_dwordx4 a[212:215], v1, s[4:7], s34 offen offset:1024
buffer_load_dwordx4 a[216:219], v1, s[4:7], s34 offen offset:2048
buffer_load_dwordx4 a[220:223], v1, s[4:7], s34 offen offset:3072
s_add_u32 s34, s34, 4096
buffer_load_dwordx4 a[224:227], v1, s[4:7], s34 offen offset:0
buffer_load_dwordx4 a[228:231], v1, s[4:7], s34 offen offset:1024
buffer_load_dwordx4 a[232:235], v1, s[4:7], s34 offen offset:2048
buffer_load_dwordx4 a[236:239], v1, s[4:7], s34 offen offset:3072
s_waitcnt vmcnt(20)
s_mul_i32 s34, s15, 12
s_mul_i32 s35, s16, 6
s_add_u32 s34, s34, s35
s_add_u32 s34, s34, 5
s_mul_i32 s34, s34, 20480
s_add_u32 s34, s34, 22020096
buffer_load_dwordx4 v[96:99], v1, s[4:7], s34 offen offset:0
buffer_load_dwordx4 v[100:103], v1, s[4:7], s34 offen offset:1024
buffer_load_dwordx4 v[104:107], v1, s[4:7], s34 offen offset:2048
buffer_load_dwordx4 v[108:111], v1, s[4:7], s34 offen offset:3072
s_add_u32 s34, s34, 4096
buffer_load_dwordx4 v[112:115], v1, s[4:7], s34 offen offset:0
buffer_load_dwordx4 v[116:119], v1, s[4:7], s34 offen offset:1024
buffer_load_dwordx4 v[120:123], v1, s[4:7], s34 offen offset:2048
buffer_load_dwordx4 v[124:127], v1, s[4:7], s34 offen offset:3072
s_add_u32 s34, s34, 4096
buffer_load_dwordx4 v[128:131], v1, s[4:7], s34 offen offset:0
buffer_load_dwordx4 v[132:135], v1, s[4:7], s34 offen offset:1024
buffer_load_dwordx4 v[136:139], v1, s[4:7], s34 offen offset:2048
buffer_load_dwordx4 v[140:143], v1, s[4:7], s34 offen offset:3072
s_add_u32 s34, s34, 4096
buffer_load_dwordx4 v[144:147], v1, s[4:7], s34 offen offset:0
buffer_load_dwordx4 v[148:151], v1, s[4:7], s34 offen offset:1024
buffer_load_dwordx4 v[152:155], v1, s[4:7], s34 offen offset:2048
buffer_load_dwordx4 v[156:159], v1, s[4:7], s34 offen offset:3072
s_add_u32 s34, s34, 4096
buffer_load_dwordx4 v[160:163], v1, s[4:7], s34 offen offset:0
buffer_load_dwordx4 v[164:167], v1, s[4:7], s34 offen offset:1024
buffer_load_dwordx4 v[168:171], v1, s[4:7], s34 offen offset:2048
buffer_load_dwordx4 v[172:175], v1, s[4:7], s34 offen offset:3072
s_waitcnt vmcnt(20)
v_and_b32 v30, 7, v0
v_lshlrev_b32 v30, 3, v30
reca_cens256:
buffer_load_dwordx2 v[28:29], v30, s[8:11], 0 offen sc1
s_waitcnt vmcnt(0)
v_sad_u8 v31, v28, 0, 0
v_sad_u8 v31, v29, 0, v31
v_cmp_gt_u32 vcc, 32, v31
s_cbranch_vccz reca_censok257
s_sleep 8
s_sub_u32 s18, s18, 1
s_cbranch_scc0 reca_cens256
s_mov_b32 s18, 0
reca_censok257:
v_and_b32 v28, 0x20202020, v28
v_and_b32 v29, 0x20202020, v29
v_cmp_ne_u32 s[34:35], 0, v28
v_cmp_ne_u32 s[36:37], 0, v29
s_nop 3
s_and_b32 s34, s34, 0xff
s_and_b32 s36, s36, 0xff
s_or_b32 s35, s34, s36
s_lshr_b32 s37, s35, s13
s_and_b32 s37, s37, 1
s_xor_b32 s43, s37, 1
s_cmp_eq_u32 s57, 0
s_cselect_b32 s58, s36, s34
v_mov_b32 v31, 0x80000000
s_cmp_lg_u32 s43, 0
s_cbranch_scc1 reca_pslow258
reca_ptop259:
s_cmp_lt_u32 s17, 3
s_cbranch_scc1 reca_pgo260
s_sub_u32 s36, s17, 3
reca_ppoll261:
buffer_load_dword v28, v4, s[4:7], s25 offen sc1
s_waitcnt vmcnt(0)
v_readfirstlane_b32 s34, v28
s_nop 3
s_cmp_ge_i32 s34, s36
s_cbranch_scc1 reca_pgo260
s_sleep 8
s_sub_u32 s18, s18, 1
s_cbranch_scc0 reca_ppoll261
s_mov_b32 s18, 0
reca_pgo260:
s_waitcnt vmcnt(0)
s_barrier
v_add_u32 v7, s26, v1
s_xor_b32 s26, s26, 40960
s_add_u32 s37, s17, 1
s_cmp_ge_u32 s37, 64
s_cbranch_scc1 reca_pnodma262
s_mul_i32 s20, s37, 40960
s_add_u32 s20, s20, 84955136
s_add_u32 m0, s26, 20480
s_nop 0
buffer_load_dwordx4 v1, s[4:7], s20 offen offset:0 lds
buffer_load_dwordx4 v1, s[4:7], s20 offen offset:1024 lds
buffer_load_dwordx4 v1, s[4:7], s20 offen offset:2048 lds
buffer_load_dwordx4 v1, s[4:7], s20 offen offset:3072 lds
s_add_u32 s20, s20, 4096
s_add_u32 m0, s26, 24576
s_nop 0
buffer_load_dwordx4 v1, s[4:7], s20 offen offset:0 lds
buffer_load_dwordx4 v1, s[4:7], s20 offen offset:1024 lds
buffer_load_dwordx4 v1, s[4:7], s20 offen offset:2048 lds
buffer_load_dwordx4 v1, s[4:7], s20 offen offset:3072 lds
s_add_u32 s20, s20, 4096
s_add_u32 m0, s26, 28672
s_nop 0
buffer_load_dwordx4 v1, s[4:7], s20 offen offset:0 lds
buffer_load_dwordx4 v1, s[4:7], s20 offen offset:1024 lds
reca_pnodma262:
s_lshl_b32 s34, s15, 3
s_and_b32 s35, s17, 7
s_add_u32 s34, s34, s35
s_mul_i32 s34, s34, 12288
s_mul_i32 s35, s16, 3072
s_add_u32 s35, s35, s34
s_add_u32 s21, s35, 37748736
s_add_u32 s22, s35, 44040192
s_mul_i32 s35, s16, 6144
s_add_u32 s35, s35, s34
s_add_u32 s23, s35, 40894464
ds_read_b128 v[72:75], v7 offset:0
ds_read_b128 v[76:79], v7 offset:20480
ds_read_b128 v[80:83], v7 offset:1024
ds_read_b128 v[84:87], v7 offset:21504
ds_read_b128 v[88:91], v7 offset:2048
ds_read_b128 v[92:95], v7 offset:22528
s_waitcnt lgkmcnt(4)
v_mfma_f32_16x16x32_bf16 v[32:35], a[0:3], v[72:75], 0
v_mfma_f32_16x16x32_bf16 v[36:39], a[0:3], v[76:79], 0
v_mfma_f32_16x16x32_bf16 v[40:43], a[80:83], v[72:75], 0
v_mfma_f32_16x16x32_bf16 v[44:47], a[80:83], v[76:79], 0
v_mfma_f32_16x16x32_bf16 v[48:51], v[72:75], a[160:163], 0
v_mfma_f32_16x16x32_bf16 v[52:55], v[76:79], a[160:163], 0
v_mfma_f32_16x16x32_bf16 v[56:59], v[72:75], v[96:99], 0
v_mfma_f32_16x16x32_bf16 v[60:63], v[76:79], v[96:99], 0
ds_read_b128 v[72:75], v7 offset:3072
ds_read_b128 v[76:79], v7 offset:23552
s_waitcnt lgkmcnt(4)
v_mfma_f32_16x16x32_bf16 v[32:35], a[4:7], v[80:83], v[32:35]
v_mfma_f32_16x16x32_bf16 v[36:39], a[4:7], v[84:87], v[36:39]
v_mfma_f32_16x16x32_bf16 v[40:43], a[84:87], v[80:83], v[40:43]
v_mfma_f32_16x16x32_bf16 v[44:47], a[84:87], v[84:87], v[44:47]
v_mfma_f32_16x16x32_bf16 v[48:51], v[80:83], a[164:167], v[48:51]
v_mfma_f32_16x16x32_bf16 v[52:55], v[84:87], a[164:167], v[52:55]
v_mfma_f32_16x16x32_bf16 v[56:59], v[80:83], v[100:103], v[56:59]
v_mfma_f32_16x16x32_bf16 v[60:63], v[84:87], v[100:103], v[60:63]
ds_read_b128 v[80:83], v7 offset:4096
ds_read_b128 v[84:87], v7 offset:24576
s_waitcnt lgkmcnt(4)
v_mfma_f32_16x16x32_bf16 v[32:35], a[8:11], v[88:91], v[32:35]
v_mfma_f32_16x16x32_bf16 v[36:39], a[8:11], v[92:95], v[36:39]
v_mfma_f32_16x16x32_bf16 v[40:43], a[88:91], v[88:91], v[40:43]
v_mfma_f32_16x16x32_bf16 v[44:47], a[88:91], v[92:95], v[44:47]
v_mfma_f32_16x16x32_bf16 v[48:51], v[88:91], a[168:171], v[48:51]
v_mfma_f32_16x16x32_bf16 v[52:55], v[92:95], a[168:171], v[52:55]
v_mfma_f32_16x16x32_bf16 v[56:59], v[88:91], v[104:107], v[56:59]
v_mfma_f32_16x16x32_bf16 v[60:63], v[92:95], v[104:107], v[60:63]
ds_read_b128 v[88:91], v7 offset:5120
ds_read_b128 v[92:95], v7 offset:25600
s_waitcnt lgkmcnt(4)
v_mfma_f32_16x16x32_bf16 v[32:35], a[12:15], v[72:75], v[32:35]
v_mfma_f32_16x16x32_bf16 v[36:39], a[12:15], v[76:79], v[36:39]
v_mfma_f32_16x16x32_bf16 v[40:43], a[92:95], v[72:75], v[40:43]
v_mfma_f32_16x16x32_bf16 v[44:47], a[92:95], v[76:79], v[44:47]
v_mfma_f32_16x16x32_bf16 v[48:51], v[72:75], a[172:175], v[48:51]
v_mfma_f32_16x16x32_bf16 v[52:55], v[76:79], a[172:175], v[52:55]
v_mfma_f32_16x16x32_bf16 v[56:59], v[72:75], v[108:111], v[56:59]
v_mfma_f32_16x16x32_bf16 v[60:63], v[76:79], v[108:111], v[60:63]
ds_read_b128 v[72:75], v7 offset:6144
ds_read_b128 v[76:79], v7 offset:26624
s_waitcnt lgkmcnt(4)
v_mfma_f32_16x16x32_bf16 v[32:35], a[16:19], v[80:83], v[32:35]
v_mfma_f32_16x16x32_bf16 v[36:39], a[16:19], v[84:87], v[36:39]
v_mfma_f32_16x16x32_bf16 v[40:43], a[96:99], v[80:83], v[40:43]
v_mfma_f32_16x16x32_bf16 v[44:47], a[96:99], v[84:87], v[44:47]
v_mfma_f32_16x16x32_bf16 v[48:51], v[80:83], a[176:179], v[48:51]
v_mfma_f32_16x16x32_bf16 v[52:55], v[84:87], a[176:179], v[52:55]
v_mfma_f32_16x16x32_bf16 v[56:59], v[80:83], v[112:115], v[56:59]
v_mfma_f32_16x16x32_bf16 v[60:63], v[84:87], v[112:115], v[60:63]
ds_read_b128 v[80:83], v7 offset:7168
ds_read_b128 v[84:87], v7 offset:27648
s_waitcnt lgkmcnt(4)
v_mfma_f32_16x16x32_bf16 v[32:35], a[20:23], v[88:91], v[32:35]
v_mfma_f32_16x16x32_bf16 v[36:39], a[20:23], v[92:95], v[36:39]
v_mfma_f32_16x16x32_bf16 v[40:43], a[100:103], v[88:91], v[40:43]
v_mfma_f32_16x16x32_bf16 v[44:47], a[100:103], v[92:95], v[44:47]
v_mfma_f32_16x16x32_bf16 v[48:51], v[88:91], a[180:183], v[48:51]
v_mfma_f32_16x16x32_bf16 v[52:55], v[92:95], a[180:183], v[52:55]
v_mfma_f32_16x16x32_bf16 v[56:59], v[88:91], v[116:119], v[56:59]
v_mfma_f32_16x16x32_bf16 v[60:63], v[92:95], v[116:119], v[60:63]
ds_read_b128 v[88:91], v7 offset:8192
ds_read_b128 v[92:95], v7 offset:28672
s_waitcnt lgkmcnt(4)
v_mfma_f32_16x16x32_bf16 v[32:35], a[24:27], v[72:75], v[32:35]
v_mfma_f32_16x16x32_bf16 v[36:39], a[24:27], v[76:79], v[36:39]
v_mfma_f32_16x16x32_bf16 v[40:43], a[104:107], v[72:75], v[40:43]
v_mfma_f32_16x16x32_bf16 v[44:47], a[104:107], v[76:79], v[44:47]
v_mfma_f32_16x16x32_bf16 v[48:51], v[72:75], a[184:187], v[48:51]
v_mfma_f32_16x16x32_bf16 v[52:55], v[76:79], a[184:187], v[52:55]
v_mfma_f32_16x16x32_bf16 v[56:59], v[72:75], v[120:123], v[56:59]
v_mfma_f32_16x16x32_bf16 v[60:63], v[76:79], v[120:123], v[60:63]
ds_read_b128 v[72:75], v7 offset:9216
ds_read_b128 v[76:79], v7 offset:29696
s_waitcnt lgkmcnt(4)
v_mfma_f32_16x16x32_bf16 v[32:35], a[28:31], v[80:83], v[32:35]
v_mfma_f32_16x16x32_bf16 v[36:39], a[28:31], v[84:87], v[36:39]
v_mfma_f32_16x16x32_bf16 v[40:43], a[108:111], v[80:83], v[40:43]
v_mfma_f32_16x16x32_bf16 v[44:47], a[108:111], v[84:87], v[44:47]
v_mfma_f32_16x16x32_bf16 v[48:51], v[80:83], a[188:191], v[48:51]
v_mfma_f32_16x16x32_bf16 v[52:55], v[84:87], a[188:191], v[52:55]
v_mfma_f32_16x16x32_bf16 v[56:59], v[80:83], v[124:127], v[56:59]
v_mfma_f32_16x16x32_bf16 v[60:63], v[84:87], v[124:127], v[60:63]
ds_read_b128 v[80:83], v7 offset:10240
ds_read_b128 v[84:87], v7 offset:30720
s_waitcnt lgkmcnt(4)
v_mfma_f32_16x16x32_bf16 v[32:35], a[32:35], v[88:91], v[32:35]
v_mfma_f32_16x16x32_bf16 v[36:39], a[32:35], v[92:95], v[36:39]
v_mfma_f32_16x16x32_bf16 v[40:43], a[112:115], v[88:91], v[40:43]
v_mfma_f32_16x16x32_bf16 v[44:47], a[112:115], v[92:95], v[44:47]
v_mfma_f32_16x16x32_bf16 v[48:51], v[88:91], a[192:195], v[48:51]
v_mfma_f32_16x16x32_bf16 v[52:55], v[92:95], a[192:195], v[52:55]
v_mfma_f32_16x16x32_bf16 v[56:59], v[88:91], v[128:131], v[56:59]
v_mfma_f32_16x16x32_bf16 v[60:63], v[92:95], v[128:131], v[60:63]
ds_read_b128 v[88:91], v7 offset:11264
ds_read_b128 v[92:95], v7 offset:31744
s_waitcnt lgkmcnt(4)
v_mfma_f32_16x16x32_bf16 v[32:35], a[36:39], v[72:75], v[32:35]
v_mfma_f32_16x16x32_bf16 v[36:39], a[36:39], v[76:79], v[36:39]
v_mfma_f32_16x16x32_bf16 v[40:43], a[116:119], v[72:75], v[40:43]
v_mfma_f32_16x16x32_bf16 v[44:47], a[116:119], v[76:79], v[44:47]
v_mfma_f32_16x16x32_bf16 v[48:51], v[72:75], a[196:199], v[48:51]
v_mfma_f32_16x16x32_bf16 v[52:55], v[76:79], a[196:199], v[52:55]
v_mfma_f32_16x16x32_bf16 v[56:59], v[72:75], v[132:135], v[56:59]
v_mfma_f32_16x16x32_bf16 v[60:63], v[76:79], v[132:135], v[60:63]
ds_read_b128 v[72:75], v7 offset:12288
ds_read_b128 v[76:79], v7 offset:32768
s_waitcnt lgkmcnt(4)
v_mfma_f32_16x16x32_bf16 v[32:35], a[40:43], v[80:83], v[32:35]
v_mfma_f32_16x16x32_bf16 v[36:39], a[40:43], v[84:87], v[36:39]
v_mfma_f32_16x16x32_bf16 v[40:43], a[120:123], v[80:83], v[40:43]
v_mfma_f32_16x16x32_bf16 v[44:47], a[120:123], v[84:87], v[44:47]
v_mfma_f32_16x16x32_bf16 v[48:51], v[80:83], a[200:203], v[48:51]
v_mfma_f32_16x16x32_bf16 v[52:55], v[84:87], a[200:203], v[52:55]
v_mfma_f32_16x16x32_bf16 v[56:59], v[80:83], v[136:139], v[56:59]
v_mfma_f32_16x16x32_bf16 v[60:63], v[84:87], v[136:139], v[60:63]
ds_read_b128 v[80:83], v7 offset:13312
ds_read_b128 v[84:87], v7 offset:33792
s_waitcnt lgkmcnt(4)
v_mfma_f32_16x16x32_bf16 v[32:35], a[44:47], v[88:91], v[32:35]
v_mfma_f32_16x16x32_bf16 v[36:39], a[44:47], v[92:95], v[36:39]
v_mfma_f32_16x16x32_bf16 v[40:43], a[124:127], v[88:91], v[40:43]
v_mfma_f32_16x16x32_bf16 v[44:47], a[124:127], v[92:95], v[44:47]
v_mfma_f32_16x16x32_bf16 v[48:51], v[88:91], a[204:207], v[48:51]
v_mfma_f32_16x16x32_bf16 v[52:55], v[92:95], a[204:207], v[52:55]
v_mfma_f32_16x16x32_bf16 v[56:59], v[88:91], v[140:143], v[56:59]
v_mfma_f32_16x16x32_bf16 v[60:63], v[92:95], v[140:143], v[60:63]
ds_read_b128 v[88:91], v7 offset:14336
ds_read_b128 v[92:95], v7 offset:34816
s_waitcnt lgkmcnt(4)
v_mfma_f32_16x16x32_bf16 v[32:35], a[48:51], v[72:75], v[32:35]
v_mfma_f32_16x16x32_bf16 v[36:39], a[48:51], v[76:79], v[36:39]
v_mfma_f32_16x16x32_bf16 v[40:43], a[128:131], v[72:75], v[40:43]
v_mfma_f32_16x16x32_bf16 v[44:47], a[128:131], v[76:79], v[44:47]
v_mfma_f32_16x16x32_bf16 v[48:51], v[72:75], a[208:211], v[48:51]
v_mfma_f32_16x16x32_bf16 v[52:55], v[76:79], a[208:211], v[52:55]
v_mfma_f32_16x16x32_bf16 v[56:59], v[72:75], v[144:147], v[56:59]
v_mfma_f32_16x16x32_bf16 v[60:63], v[76:79], v[144:147], v[60:63]
ds_read_b128 v[72:75], v7 offset:15360
ds_read_b128 v[76:79], v7 offset:35840
s_waitcnt lgkmcnt(4)
v_mfma_f32_16x16x32_bf16 v[32:35], a[52:55], v[80:83], v[32:35]
v_mfma_f32_16x16x32_bf16 v[36:39], a[52:55], v[84:87], v[36:39]
v_mfma_f32_16x16x32_bf16 v[40:43], a[132:135], v[80:83], v[40:43]
v_mfma_f32_16x16x32_bf16 v[44:47], a[132:135], v[84:87], v[44:47]
v_mfma_f32_16x16x32_bf16 v[48:51], v[80:83], a[212:215], v[48:51]
v_mfma_f32_16x16x32_bf16 v[52:55], v[84:87], a[212:215], v[52:55]
v_mfma_f32_16x16x32_bf16 v[56:59], v[80:83], v[148:151], v[56:59]
v_mfma_f32_16x16x32_bf16 v[60:63], v[84:87], v[148:151], v[60:63]
ds_read_b128 v[80:83], v7 offset:16384
ds_read_b128 v[84:87], v7 offset:36864
s_waitcnt lgkmcnt(4)
v_mfma_f32_16x16x32_bf16 v[32:35], a[56:59], v[88:91], v[32:35]
v_mfma_f32_16x16x32_bf16 v[36:39], a[56:59], v[92:95], v[36:39]
v_mfma_f32_16x16x32_bf16 v[40:43], a[136:139], v[88:91], v[40:43]
v_mfma_f32_16x16x32_bf16 v[44:47], a[136:139], v[92:95], v[44:47]
v_mfma_f32_16x16x32_bf16 v[48:51], v[88:91], a[216:219], v[48:51]
v_mfma_f32_16x16x32_bf16 v[52:55], v[92:95], a[216:219], v[52:55]
v_mfma_f32_16x16x32_bf16 v[56:59], v[88:91], v[152:155], v[56:59]
v_mfma_f32_16x16x32_bf16 v[60:63], v[92:95], v[152:155], v[60:63]
ds_read_b128 v[88:91], v7 offset:17408
ds_read_b128 v[92:95], v7 offset:37888
s_waitcnt lgkmcnt(4)
v_mfma_f32_16x16x32_bf16 v[32:35], a[60:63], v[72:75], v[32:35]
v_mfma_f32_16x16x32_bf16 v[36:39], a[60:63], v[76:79], v[36:39]
v_mfma_f32_16x16x32_bf16 v[40:43], a[140:143], v[72:75], v[40:43]
v_mfma_f32_16x16x32_bf16 v[44:47], a[140:143], v[76:79], v[44:47]
v_mfma_f32_16x16x32_bf16 v[48:51], v[72:75], a[220:223], v[48:51]
v_mfma_f32_16x16x32_bf16 v[52:55], v[76:79], a[220:223], v[52:55]
v_mfma_f32_16x16x32_bf16 v[56:59], v[72:75], v[156:159], v[56:59]
v_mfma_f32_16x16x32_bf16 v[60:63], v[76:79], v[156:159], v[60:63]
ds_read_b128 v[72:75], v7 offset:18432
ds_read_b128 v[76:79], v7 offset:38912
s_waitcnt lgkmcnt(4)
v_mfma_f32_16x16x32_bf16 v[32:35], a[64:67], v[80:83], v[32:35]
v_mfma_f32_16x16x32_bf16 v[36:39], a[64:67], v[84:87], v[36:39]
v_mfma_f32_16x16x32_bf16 v[40:43], a[144:147], v[80:83], v[40:43]
v_mfma_f32_16x16x32_bf16 v[44:47], a[144:147], v[84:87], v[44:47]
v_mfma_f32_16x16x32_bf16 v[48:51], v[80:83], a[224:227], v[48:51]
v_mfma_f32_16x16x32_bf16 v[52:55], v[84:87], a[224:227], v[52:55]
v_mfma_f32_16x16x32_bf16 v[56:59], v[80:83], v[160:163], v[56:59]
v_mfma_f32_16x16x32_bf16 v[60:63], v[84:87], v[160:163], v[60:63]
ds_read_b128 v[80:83], v7 offset:19456
ds_read_b128 v[84:87], v7 offset:39936
s_waitcnt lgkmcnt(4)
v_mfma_f32_16x16x32_bf16 v[32:35], a[68:71], v[88:91], v[32:35]
v_mfma_f32_16x16x32_bf16 v[36:39], a[68:71], v[92:95], v[36:39]
v_mfma_f32_16x16x32_bf16 v[40:43], a[148:151], v[88:91], v[40:43]
v_mfma_f32_16x16x32_bf16 v[44:47], a[148:151], v[92:95], v[44:47]
v_mfma_f32_16x16x32_bf16 v[48:51], v[88:91], a[228:231], v[48:51]
v_mfma_f32_16x16x32_bf16 v[52:55], v[92:95], a[228:231], v[52:55]
v_mfma_f32_16x16x32_bf16 v[56:59], v[88:91], v[164:167], v[56:59]
v_mfma_f32_16x16x32_bf16 v[60:63], v[92:95], v[164:167], v[60:63]
s_waitcnt lgkmcnt(2)
v_mfma_f32_16x16x32_bf16 v[32:35], a[72:75], v[72:75], v[32:35]
v_mfma_f32_16x16x32_bf16 v[36:39], a[72:75], v[76:79], v[36:39]
v_mfma_f32_16x16x32_bf16 v[40:43], a[152:155], v[72:75], v[40:43]
v_mfma_f32_16x16x32_bf16 v[44:47], a[152:155], v[76:79], v[44:47]
v_mfma_f32_16x16x32_bf16 v[48:51], v[72:75], a[232:235], v[48:51]
v_mfma_f32_16x16x32_bf16 v[52:55], v[76:79], a[232:235], v[52:55]
v_mfma_f32_16x16x32_bf16 v[56:59], v[72:75], v[168:171], v[56:59]
v_mfma_f32_16x16x32_bf16 v[60:63], v[76:79], v[168:171], v[60:63]
s_waitcnt lgkmcnt(0)
v_mfma_f32_16x16x32_bf16 v[32:35], a[76:79], v[80:83], v[32:35]
v_mfma_f32_16x16x32_bf16 v[36:39], a[76:79], v[84:87], v[36:39]
v_mfma_f32_16x16x32_bf16 v[40:43], a[156:159], v[80:83], v[40:43]
v_mfma_f32_16x16x32_bf16 v[44:47], a[156:159], v[84:87], v[44:47]
v_mfma_f32_16x16x32_bf16 v[48:51], v[80:83], a[236:239], v[48:51]
v_mfma_f32_16x16x32_bf16 v[52:55], v[84:87], a[236:239], v[52:55]
v_mfma_f32_16x16x32_bf16 v[56:59], v[80:83], v[172:175], v[56:59]
v_mfma_f32_16x16x32_bf16 v[60:63], v[84:87], v[172:175], v[60:63]
s_nop 0
v_cvt_pk_bf16_f32 v8, v32, v33
v_cvt_pk_bf16_f32 v9, v34, v35
v_cvt_pk_bf16_f32 v10, v40, v41
v_cvt_pk_bf16_f32 v11, v42, v43
s_add_u32 s34, s22, 0
buffer_store_dwordx4 v[8:11], v1, s[4:7], s34 offen
v_cvt_pk_bf16_f32 v12, v36, v37
v_cvt_pk_bf16_f32 v13, v38, v39
v_cvt_pk_bf16_f32 v14, v44, v45
v_cvt_pk_bf16_f32 v15, v46, v47
s_add_u32 s34, s22, 6144
buffer_store_dwordx4 v[12:15], v1, s[4:7], s34 offen
v_cvt_pk_bf16_f32 v8, v48, v49
v_cvt_pk_bf16_f32 v9, v50, v51
v_cvt_pk_bf16_f32 v10, v52, v53
v_cvt_pk_bf16_f32 v11, v54, v55
s_add_u32 s34, s23, 4096
buffer_store_dwordx4 v[8:11], v1, s[4:7], s34 offen
v_cvt_pk_bf16_f32 v12, v56, v57
v_cvt_pk_bf16_f32 v13, v58, v59
v_cvt_pk_bf16_f32 v14, v60, v61
v_cvt_pk_bf16_f32 v15, v62, v63
s_add_u32 s34, s23, 5120
buffer_store_dwordx4 v[12:15], v1, s[4:7], s34 offen
s_waitcnt vmcnt(0)
s_barrier
s_add_u32 s17, s17, 1
s_cmp_lt_u32 s17, 64
s_cbranch_scc1 reca_ptop259
s_branch reca_exit1
reca_pslow258:
reca_ptop264:
s_cmp_lt_u32 s17, 3
s_cbranch_scc1 reca_pgo265
s_sub_u32 s36, s17, 3
reca_ppoll266:
buffer_load_dword v28, v4, s[4:7], s25 offen sc1
s_waitcnt vmcnt(0)
v_readfirstlane_b32 s34, v28
s_nop 3
s_cmp_ge_i32 s34, s36
s_cbranch_scc1 reca_pgo265
s_sleep 8
s_sub_u32 s18, s18, 1
s_cbranch_scc0 reca_ppoll266
s_mov_b32 s18, 0
reca_pgo265:
s_waitcnt vmcnt(0)
s_barrier
v_add_u32 v7, s26, v1
s_xor_b32 s26, s26, 40960
s_add_u32 s37, s17, 1
s_cmp_ge_u32 s37, 64
s_cbranch_scc1 reca_pnodma267
s_mul_i32 s20, s37, 40960
s_add_u32 s20, s20, 84955136
s_add_u32 m0, s26, 20480
s_nop 0
buffer_load_dwordx4 v1, s[4:7], s20 offen offset:0 lds
buffer_load_dwordx4 v1, s[4:7], s20 offen offset:1024 lds
buffer_load_dwordx4 v1, s[4:7], s20 offen offset:2048 lds
buffer_load_dwordx4 v1, s[4:7], s20 offen offset:3072 lds
s_add_u32 s20, s20, 4096
s_add_u32 m0, s26, 24576
s_nop 0
buffer_load_dwordx4 v1, s[4:7], s20 offen offset:0 lds
buffer_load_dwordx4 v1, s[4:7], s20 offen offset:1024 lds
buffer_load_dwordx4 v1, s[4:7], s20 offen offset:2048 lds
buffer_load_dwordx4 v1, s[4:7], s20 offen offset:3072 lds
s_add_u32 s20, s20, 4096
s_add_u32 m0, s26, 28672
s_nop 0
buffer_load_dwordx4 v1, s[4:7], s20 offen offset:0 lds
buffer_load_dwordx4 v1, s[4:7], s20 offen offset:1024 lds
reca_pnodma267:
s_lshl_b32 s34, s15, 3
s_and_b32 s35, s17, 7
s_add_u32 s34, s34, s35
s_mul_i32 s34, s34, 12288
s_mul_i32 s35, s16, 3072
s_add_u32 s35, s35, s34
s_add_u32 s21, s35, 37748736
s_add_u32 s22, s35, 44040192
s_mul_i32 s35, s16, 6144
s_add_u32 s35, s35, s34
s_add_u32 s23, s35, 40894464
ds_read_b128 v[72:75], v7 offset:0
ds_read_b128 v[76:79], v7 offset:20480
ds_read_b128 v[80:83], v7 offset:1024
ds_read_b128 v[84:87], v7 offset:21504
ds_read_b128 v[88:91], v7 offset:2048
ds_read_b128 v[92:95], v7 offset:22528
s_waitcnt lgkmcnt(4)
v_mfma_f32_16x16x32_bf16 v[32:35], a[0:3], v[72:75], 0
v_mfma_f32_16x16x32_bf16 v[36:39], a[0:3], v[76:79], 0
v_mfma_f32_16x16x32_bf16 v[40:43], a[80:83], v[72:75], 0
v_mfma_f32_16x16x32_bf16 v[44:47], a[80:83], v[76:79], 0
v_mfma_f32_16x16x32_bf16 v[48:51], v[72:75], a[160:163], 0
v_mfma_f32_16x16x32_bf16 v[52:55], v[76:79], a[160:163], 0
v_mfma_f32_16x16x32_bf16 v[56:59], v[72:75], v[96:99], 0
v_mfma_f32_16x16x32_bf16 v[60:63], v[76:79], v[96:99], 0
ds_read_b128 v[72:75], v7 offset:3072
ds_read_b128 v[76:79], v7 offset:23552
s_waitcnt lgkmcnt(4)
v_mfma_f32_16x16x32_bf16 v[32:35], a[4:7], v[80:83], v[32:35]
v_mfma_f32_16x16x32_bf16 v[36:39], a[4:7], v[84:87], v[36:39]
v_mfma_f32_16x16x32_bf16 v[40:43], a[84:87], v[80:83], v[40:43]
v_mfma_f32_16x16x32_bf16 v[44:47], a[84:87], v[84:87], v[44:47]
v_mfma_f32_16x16x32_bf16 v[48:51], v[80:83], a[164:167], v[48:51]
v_mfma_f32_16x16x32_bf16 v[52:55], v[84:87], a[164:167], v[52:55]
v_mfma_f32_16x16x32_bf16 v[56:59], v[80:83], v[100:103], v[56:59]
v_mfma_f32_16x16x32_bf16 v[60:63], v[84:87], v[100:103], v[60:63]
ds_read_b128 v[80:83], v7 offset:4096
ds_read_b128 v[84:87], v7 offset:24576
s_waitcnt lgkmcnt(4)
v_mfma_f32_16x16x32_bf16 v[32:35], a[8:11], v[88:91], v[32:35]
v_mfma_f32_16x16x32_bf16 v[36:39], a[8:11], v[92:95], v[36:39]
v_mfma_f32_16x16x32_bf16 v[40:43], a[88:91], v[88:91], v[40:43]
v_mfma_f32_16x16x32_bf16 v[44:47], a[88:91], v[92:95], v[44:47]
v_mfma_f32_16x16x32_bf16 v[48:51], v[88:91], a[168:171], v[48:51]
v_mfma_f32_16x16x32_bf16 v[52:55], v[92:95], a[168:171], v[52:55]
v_mfma_f32_16x16x32_bf16 v[56:59], v[88:91], v[104:107], v[56:59]
v_mfma_f32_16x16x32_bf16 v[60:63], v[92:95], v[104:107], v[60:63]
ds_read_b128 v[88:91], v7 offset:5120
ds_read_b128 v[92:95], v7 offset:25600
s_waitcnt lgkmcnt(4)
v_mfma_f32_16x16x32_bf16 v[32:35], a[12:15], v[72:75], v[32:35]
v_mfma_f32_16x16x32_bf16 v[36:39], a[12:15], v[76:79], v[36:39]
v_mfma_f32_16x16x32_bf16 v[40:43], a[92:95], v[72:75], v[40:43]
v_mfma_f32_16x16x32_bf16 v[44:47], a[92:95], v[76:79], v[44:47]
v_mfma_f32_16x16x32_bf16 v[48:51], v[72:75], a[172:175], v[48:51]
v_mfma_f32_16x16x32_bf16 v[52:55], v[76:79], a[172:175], v[52:55]
v_mfma_f32_16x16x32_bf16 v[56:59], v[72:75], v[108:111], v[56:59]
v_mfma_f32_16x16x32_bf16 v[60:63], v[76:79], v[108:111], v[60:63]
ds_read_b128 v[72:75], v7 offset:6144
ds_read_b128 v[76:79], v7 offset:26624
s_waitcnt lgkmcnt(4)
v_mfma_f32_16x16x32_bf16 v[32:35], a[16:19], v[80:83], v[32:35]
v_mfma_f32_16x16x32_bf16 v[36:39], a[16:19], v[84:87], v[36:39]
v_mfma_f32_16x16x32_bf16 v[40:43], a[96:99], v[80:83], v[40:43]
v_mfma_f32_16x16x32_bf16 v[44:47], a[96:99], v[84:87], v[44:47]
v_mfma_f32_16x16x32_bf16 v[48:51], v[80:83], a[176:179], v[48:51]
v_mfma_f32_16x16x32_bf16 v[52:55], v[84:87], a[176:179], v[52:55]
v_mfma_f32_16x16x32_bf16 v[56:59], v[80:83], v[112:115], v[56:59]
v_mfma_f32_16x16x32_bf16 v[60:63], v[84:87], v[112:115], v[60:63]
ds_read_b128 v[80:83], v7 offset:7168
ds_read_b128 v[84:87], v7 offset:27648
s_waitcnt lgkmcnt(4)
v_mfma_f32_16x16x32_bf16 v[32:35], a[20:23], v[88:91], v[32:35]
v_mfma_f32_16x16x32_bf16 v[36:39], a[20:23], v[92:95], v[36:39]
v_mfma_f32_16x16x32_bf16 v[40:43], a[100:103], v[88:91], v[40:43]
v_mfma_f32_16x16x32_bf16 v[44:47], a[100:103], v[92:95], v[44:47]
v_mfma_f32_16x16x32_bf16 v[48:51], v[88:91], a[180:183], v[48:51]
v_mfma_f32_16x16x32_bf16 v[52:55], v[92:95], a[180:183], v[52:55]
v_mfma_f32_16x16x32_bf16 v[56:59], v[88:91], v[116:119], v[56:59]
v_mfma_f32_16x16x32_bf16 v[60:63], v[92:95], v[116:119], v[60:63]
ds_read_b128 v[88:91], v7 offset:8192
ds_read_b128 v[92:95], v7 offset:28672
s_waitcnt lgkmcnt(4)
v_mfma_f32_16x16x32_bf16 v[32:35], a[24:27], v[72:75], v[32:35]
v_mfma_f32_16x16x32_bf16 v[36:39], a[24:27], v[76:79], v[36:39]
v_mfma_f32_16x16x32_bf16 v[40:43], a[104:107], v[72:75], v[40:43]
v_mfma_f32_16x16x32_bf16 v[44:47], a[104:107], v[76:79], v[44:47]
v_mfma_f32_16x16x32_bf16 v[48:51], v[72:75], a[184:187], v[48:51]
v_mfma_f32_16x16x32_bf16 v[52:55], v[76:79], a[184:187], v[52:55]
v_mfma_f32_16x16x32_bf16 v[56:59], v[72:75], v[120:123], v[56:59]
v_mfma_f32_16x16x32_bf16 v[60:63], v[76:79], v[120:123], v[60:63]
ds_read_b128 v[72:75], v7 offset:9216
ds_read_b128 v[76:79], v7 offset:29696
s_waitcnt lgkmcnt(4)
v_mfma_f32_16x16x32_bf16 v[32:35], a[28:31], v[80:83], v[32:35]
v_mfma_f32_16x16x32_bf16 v[36:39], a[28:31], v[84:87], v[36:39]
v_mfma_f32_16x16x32_bf16 v[40:43], a[108:111], v[80:83], v[40:43]
v_mfma_f32_16x16x32_bf16 v[44:47], a[108:111], v[84:87], v[44:47]
v_mfma_f32_16x16x32_bf16 v[48:51], v[80:83], a[188:191], v[48:51]
v_mfma_f32_16x16x32_bf16 v[52:55], v[84:87], a[188:191], v[52:55]
v_mfma_f32_16x16x32_bf16 v[56:59], v[80:83], v[124:127], v[56:59]
v_mfma_f32_16x16x32_bf16 v[60:63], v[84:87], v[124:127], v[60:63]
ds_read_b128 v[80:83], v7 offset:10240
ds_read_b128 v[84:87], v7 offset:30720
s_waitcnt lgkmcnt(4)
v_mfma_f32_16x16x32_bf16 v[32:35], a[32:35], v[88:91], v[32:35]
v_mfma_f32_16x16x32_bf16 v[36:39], a[32:35], v[92:95], v[36:39]
v_mfma_f32_16x16x32_bf16 v[40:43], a[112:115], v[88:91], v[40:43]
v_mfma_f32_16x16x32_bf16 v[44:47], a[112:115], v[92:95], v[44:47]
v_mfma_f32_16x16x32_bf16 v[48:51], v[88:91], a[192:195], v[48:51]
v_mfma_f32_16x16x32_bf16 v[52:55], v[92:95], a[192:195], v[52:55]
v_mfma_f32_16x16x32_bf16 v[56:59], v[88:91], v[128:131], v[56:59]
v_mfma_f32_16x16x32_bf16 v[60:63], v[92:95], v[128:131], v[60:63]
ds_read_b128 v[88:91], v7 offset:11264
ds_read_b128 v[92:95], v7 offset:31744
s_waitcnt lgkmcnt(4)
v_mfma_f32_16x16x32_bf16 v[32:35], a[36:39], v[72:75], v[32:35]
v_mfma_f32_16x16x32_bf16 v[36:39], a[36:39], v[76:79], v[36:39]
v_mfma_f32_16x16x32_bf16 v[40:43], a[116:119], v[72:75], v[40:43]
v_mfma_f32_16x16x32_bf16 v[44:47], a[116:119], v[76:79], v[44:47]
v_mfma_f32_16x16x32_bf16 v[48:51], v[72:75], a[196:199], v[48:51]
v_mfma_f32_16x16x32_bf16 v[52:55], v[76:79], a[196:199], v[52:55]
v_mfma_f32_16x16x32_bf16 v[56:59], v[72:75], v[132:135], v[56:59]
v_mfma_f32_16x16x32_bf16 v[60:63], v[76:79], v[132:135], v[60:63]
ds_read_b128 v[72:75], v7 offset:12288
ds_read_b128 v[76:79], v7 offset:32768
s_waitcnt lgkmcnt(4)
v_mfma_f32_16x16x32_bf16 v[32:35], a[40:43], v[80:83], v[32:35]
v_mfma_f32_16x16x32_bf16 v[36:39], a[40:43], v[84:87], v[36:39]
v_mfma_f32_16x16x32_bf16 v[40:43], a[120:123], v[80:83], v[40:43]
v_mfma_f32_16x16x32_bf16 v[44:47], a[120:123], v[84:87], v[44:47]
v_mfma_f32_16x16x32_bf16 v[48:51], v[80:83], a[200:203], v[48:51]
v_mfma_f32_16x16x32_bf16 v[52:55], v[84:87], a[200:203], v[52:55]
v_mfma_f32_16x16x32_bf16 v[56:59], v[80:83], v[136:139], v[56:59]
v_mfma_f32_16x16x32_bf16 v[60:63], v[84:87], v[136:139], v[60:63]
ds_read_b128 v[80:83], v7 offset:13312
ds_read_b128 v[84:87], v7 offset:33792
s_waitcnt lgkmcnt(4)
v_mfma_f32_16x16x32_bf16 v[32:35], a[44:47], v[88:91], v[32:35]
v_mfma_f32_16x16x32_bf16 v[36:39], a[44:47], v[92:95], v[36:39]
v_mfma_f32_16x16x32_bf16 v[40:43], a[124:127], v[88:91], v[40:43]
v_mfma_f32_16x16x32_bf16 v[44:47], a[124:127], v[92:95], v[44:47]
v_mfma_f32_16x16x32_bf16 v[48:51], v[88:91], a[204:207], v[48:51]
v_mfma_f32_16x16x32_bf16 v[52:55], v[92:95], a[204:207], v[52:55]
v_mfma_f32_16x16x32_bf16 v[56:59], v[88:91], v[140:143], v[56:59]
v_mfma_f32_16x16x32_bf16 v[60:63], v[92:95], v[140:143], v[60:63]
ds_read_b128 v[88:91], v7 offset:14336
ds_read_b128 v[92:95], v7 offset:34816
s_waitcnt lgkmcnt(4)
v_mfma_f32_16x16x32_bf16 v[32:35], a[48:51], v[72:75], v[32:35]
v_mfma_f32_16x16x32_bf16 v[36:39], a[48:51], v[76:79], v[36:39]
v_mfma_f32_16x16x32_bf16 v[40:43], a[128:131], v[72:75], v[40:43]
v_mfma_f32_16x16x32_bf16 v[44:47], a[128:131], v[76:79], v[44:47]
v_mfma_f32_16x16x32_bf16 v[48:51], v[72:75], a[208:211], v[48:51]
v_mfma_f32_16x16x32_bf16 v[52:55], v[76:79], a[208:211], v[52:55]
v_mfma_f32_16x16x32_bf16 v[56:59], v[72:75], v[144:147], v[56:59]
v_mfma_f32_16x16x32_bf16 v[60:63], v[76:79], v[144:147], v[60:63]
ds_read_b128 v[72:75], v7 offset:15360
ds_read_b128 v[76:79], v7 offset:35840
s_waitcnt lgkmcnt(4)
v_mfma_f32_16x16x32_bf16 v[32:35], a[52:55], v[80:83], v[32:35]
v_mfma_f32_16x16x32_bf16 v[36:39], a[52:55], v[84:87], v[36:39]
v_mfma_f32_16x16x32_bf16 v[40:43], a[132:135], v[80:83], v[40:43]
v_mfma_f32_16x16x32_bf16 v[44:47], a[132:135], v[84:87], v[44:47]
v_mfma_f32_16x16x32_bf16 v[48:51], v[80:83], a[212:215], v[48:51]
v_mfma_f32_16x16x32_bf16 v[52:55], v[84:87], a[212:215], v[52:55]
v_mfma_f32_16x16x32_bf16 v[56:59], v[80:83], v[148:151], v[56:59]
v_mfma_f32_16x16x32_bf16 v[60:63], v[84:87], v[148:151], v[60:63]
ds_read_b128 v[80:83], v7 offset:16384
ds_read_b128 v[84:87], v7 offset:36864
s_waitcnt lgkmcnt(4)
v_mfma_f32_16x16x32_bf16 v[32:35], a[56:59], v[88:91], v[32:35]
v_mfma_f32_16x16x32_bf16 v[36:39], a[56:59], v[92:95], v[36:39]
v_mfma_f32_16x16x32_bf16 v[40:43], a[136:139], v[88:91], v[40:43]
v_mfma_f32_16x16x32_bf16 v[44:47], a[136:139], v[92:95], v[44:47]
v_mfma_f32_16x16x32_bf16 v[48:51], v[88:91], a[216:219], v[48:51]
v_mfma_f32_16x16x32_bf16 v[52:55], v[92:95], a[216:219], v[52:55]
v_mfma_f32_16x16x32_bf16 v[56:59], v[88:91], v[152:155], v[56:59]
v_mfma_f32_16x16x32_bf16 v[60:63], v[92:95], v[152:155], v[60:63]
ds_read_b128 v[88:91], v7 offset:17408
ds_read_b128 v[92:95], v7 offset:37888
s_waitcnt lgkmcnt(4)
v_mfma_f32_16x16x32_bf16 v[32:35], a[60:63], v[72:75], v[32:35]
v_mfma_f32_16x16x32_bf16 v[36:39], a[60:63], v[76:79], v[36:39]
v_mfma_f32_16x16x32_bf16 v[40:43], a[140:143], v[72:75], v[40:43]
v_mfma_f32_16x16x32_bf16 v[44:47], a[140:143], v[76:79], v[44:47]
v_mfma_f32_16x16x32_bf16 v[48:51], v[72:75], a[220:223], v[48:51]
v_mfma_f32_16x16x32_bf16 v[52:55], v[76:79], a[220:223], v[52:55]
v_mfma_f32_16x16x32_bf16 v[56:59], v[72:75], v[156:159], v[56:59]
v_mfma_f32_16x16x32_bf16 v[60:63], v[76:79], v[156:159], v[60:63]
ds_read_b128 v[72:75], v7 offset:18432
ds_read_b128 v[76:79], v7 offset:38912
s_waitcnt lgkmcnt(4)
v_mfma_f32_16x16x32_bf16 v[32:35], a[64:67], v[80:83], v[32:35]
v_mfma_f32_16x16x32_bf16 v[36:39], a[64:67], v[84:87], v[36:39]
v_mfma_f32_16x16x32_bf16 v[40:43], a[144:147], v[80:83], v[40:43]
v_mfma_f32_16x16x32_bf16 v[44:47], a[144:147], v[84:87], v[44:47]
v_mfma_f32_16x16x32_bf16 v[48:51], v[80:83], a[224:227], v[48:51]
v_mfma_f32_16x16x32_bf16 v[52:55], v[84:87], a[224:227], v[52:55]
v_mfma_f32_16x16x32_bf16 v[56:59], v[80:83], v[160:163], v[56:59]
v_mfma_f32_16x16x32_bf16 v[60:63], v[84:87], v[160:163], v[60:63]
ds_read_b128 v[80:83], v7 offset:19456
ds_read_b128 v[84:87], v7 offset:39936
s_waitcnt lgkmcnt(4)
v_mfma_f32_16x16x32_bf16 v[32:35], a[68:71], v[88:91], v[32:35]
v_mfma_f32_16x16x32_bf16 v[36:39], a[68:71], v[92:95], v[36:39]
v_mfma_f32_16x16x32_bf16 v[40:43], a[148:151], v[88:91], v[40:43]
v_mfma_f32_16x16x32_bf16 v[44:47], a[148:151], v[92:95], v[44:47]
v_mfma_f32_16x16x32_bf16 v[48:51], v[88:91], a[228:231], v[48:51]
v_mfma_f32_16x16x32_bf16 v[52:55], v[92:95], a[228:231], v[52:55]
v_mfma_f32_16x16x32_bf16 v[56:59], v[88:91], v[164:167], v[56:59]
v_mfma_f32_16x16x32_bf16 v[60:63], v[92:95], v[164:167], v[60:63]
s_waitcnt lgkmcnt(2)
v_mfma_f32_16x16x32_bf16 v[32:35], a[72:75], v[72:75], v[32:35]
v_mfma_f32_16x16x32_bf16 v[36:39], a[72:75], v[76:79], v[36:39]
v_mfma_f32_16x16x32_bf16 v[40:43], a[152:155], v[72:75], v[40:43]
v_mfma_f32_16x16x32_bf16 v[44:47], a[152:155], v[76:79], v[44:47]
v_mfma_f32_16x16x32_bf16 v[48:51], v[72:75], a[232:235], v[48:51]
v_mfma_f32_16x16x32_bf16 v[52:55], v[76:79], a[232:235], v[52:55]
v_mfma_f32_16x16x32_bf16 v[56:59], v[72:75], v[168:171], v[56:59]
v_mfma_f32_16x16x32_bf16 v[60:63], v[76:79], v[168:171], v[60:63]
s_waitcnt lgkmcnt(0)
v_mfma_f32_16x16x32_bf16 v[32:35], a[76:79], v[80:83], v[32:35]
v_mfma_f32_16x16x32_bf16 v[36:39], a[76:79], v[84:87], v[36:39]
v_mfma_f32_16x16x32_bf16 v[40:43], a[156:159], v[80:83], v[40:43]
v_mfma_f32_16x16x32_bf16 v[44:47], a[156:159], v[84:87], v[44:47]
v_mfma_f32_16x16x32_bf16 v[48:51], v[80:83], a[236:239], v[48:51]
v_mfma_f32_16x16x32_bf16 v[52:55], v[84:87], a[236:239], v[52:55]
v_mfma_f32_16x16x32_bf16 v[56:59], v[80:83], v[172:175], v[56:59]
v_mfma_f32_16x16x32_bf16 v[60:63], v[84:87], v[172:175], v[60:63]
s_nop 0
v_cvt_pk_bf16_f32 v8, v32, v33
v_cvt_pk_bf16_f32 v9, v34, v35
v_cvt_pk_bf16_f32 v10, v40, v41
v_cvt_pk_bf16_f32 v11, v42, v43
s_add_u32 s34, s22, 0
buffer_store_dwordx4 v[8:11], v1, s[4:7], s34 offen sc1
v_cvt_pk_bf16_f32 v12, v36, v37
v_cvt_pk_bf16_f32 v13, v38, v39
v_cvt_pk_bf16_f32 v14, v44, v45
v_cvt_pk_bf16_f32 v15, v46, v47
s_add_u32 s34, s22, 6144
buffer_store_dwordx4 v[12:15], v1, s[4:7], s34 offen sc1
v_cvt_pk_bf16_f32 v8, v48, v49
v_cvt_pk_bf16_f32 v9, v50, v51
v_cvt_pk_bf16_f32 v10, v52, v53
v_cvt_pk_bf16_f32 v11, v54, v55
s_add_u32 s34, s23, 4096
buffer_store_dwordx4 v[8:11], v1, s[4:7], s34 offen sc1
v_cvt_pk_bf16_f32 v12, v56, v57
v_cvt_pk_bf16_f32 v13, v58, v59
v_cvt_pk_bf16_f32 v14, v60, v61
v_cvt_pk_bf16_f32 v15, v62, v63
s_add_u32 s34, s23, 5120
buffer_store_dwordx4 v[12:15], v1, s[4:7], s34 offen sc1
s_waitcnt vmcnt(0)
s_barrier
s_add_u32 s17, s17, 1
s_cmp_lt_u32 s17, 64
s_cbranch_scc1 reca_ptop264
s_branch reca_exit1
reca_pw3_229:
s_mov_b32 s17, 0
s_mov_b32 s26, 0
s_mul_i32 s20, s17, 40960
s_add_u32 s20, s20, 84965376
s_add_u32 m0, s26, 30720
s_nop 0
buffer_load_dwordx4 v1, s[4:7], s20 offen offset:0 lds
buffer_load_dwordx4 v1, s[4:7], s20 offen offset:1024 lds
buffer_load_dwordx4 v1, s[4:7], s20 offen offset:2048 lds
buffer_load_dwordx4 v1, s[4:7], s20 offen offset:3072 lds
s_add_u32 s20, s20, 4096
s_add_u32 m0, s26, 34816
s_nop 0
buffer_load_dwordx4 v1, s[4:7], s20 offen offset:0 lds
buffer_load_dwordx4 v1, s[4:7], s20 offen offset:1024 lds
buffer_load_dwordx4 v1, s[4:7], s20 offen offset:2048 lds
buffer_load_dwordx4 v1, s[4:7], s20 offen offset:3072 lds
s_add_u32 s20, s20, 4096
s_add_u32 m0, s26, 38912
s_nop 0
buffer_load_dwordx4 v1, s[4:7], s20 offen offset:0 lds
buffer_load_dwordx4 v1, s[4:7], s20 offen offset:1024 lds
s_mul_i32 s34, s15, 12
s_mul_i32 s35, s16, 6
s_add_u32 s34, s34, s35
s_add_u32 s34, s34, 2
s_mul_i32 s34, s34, 20480
s_add_u32 s34, s34, 6291456
buffer_load_dwordx4 a[0:3], v1, s[4:7], s34 offen offset:0
buffer_load_dwordx4 a[4:7], v1, s[4:7], s34 offen offset:1024
buffer_load_dwordx4 a[8:11], v1, s[4:7], s34 offen offset:2048
buffer_load_dwordx4 a[12:15], v1, s[4:7], s34 offen offset:3072
s_add_u32 s34, s34, 4096
buffer_load_dwordx4 a[16:19], v1, s[4:7], s34 offen offset:0
buffer_load_dwordx4 a[20:23], v1, s[4:7], s34 offen offset:1024
buffer_load_dwordx4 a[24:27], v1, s[4:7], s34 offen offset:2048
buffer_load_dwordx4 a[28:31], v1, s[4:7], s34 offen offset:3072
s_add_u32 s34, s34, 4096
buffer_load_dwordx4 a[32:35], v1, s[4:7], s34 offen offset:0
buffer_load_dwordx4 a[36:39], v1, s[4:7], s34 offen offset:1024
buffer_load_dwordx4 a[40:43], v1, s[4:7], s34 offen offset:2048
buffer_load_dwordx4 a[44:47], v1, s[4:7], s34 offen offset:3072
s_add_u32 s34, s34, 4096
buffer_load_dwordx4 a[48:51], v1, s[4:7], s34 offen offset:0
buffer_load_dwordx4 a[52:55], v1, s[4:7], s34 offen offset:1024
buffer_load_dwordx4 a[56:59], v1, s[4:7], s34 offen offset:2048
buffer_load_dwordx4 a[60:63], v1, s[4:7], s34 offen offset:3072
s_add_u32 s34, s34, 4096
buffer_load_dwordx4 a[64:67], v1, s[4:7], s34 offen offset:0
buffer_load_dwordx4 a[68:71], v1, s[4:7], s34 offen offset:1024
buffer_load_dwordx4 a[72:75], v1, s[4:7], s34 offen offset:2048
buffer_load_dwordx4 a[76:79], v1, s[4:7], s34 offen offset:3072
s_mul_i32 s34, s15, 12
s_mul_i32 s35, s16, 6
s_add_u32 s34, s34, s35
s_add_u32 s34, s34, 3
s_mul_i32 s34, s34, 20480
s_add_u32 s34, s34, 6291456
buffer_load_dwordx4 a[80:83], v1, s[4:7], s34 offen offset:0
buffer_load_dwordx4 a[84:87], v1, s[4:7], s34 offen offset:1024
buffer_load_dwordx4 a[88:91], v1, s[4:7], s34 offen offset:2048
buffer_load_dwordx4 a[92:95], v1, s[4:7], s34 offen offset:3072
s_add_u32 s34, s34, 4096
buffer_load_dwordx4 a[96:99], v1, s[4:7], s34 offen offset:0
buffer_load_dwordx4 a[100:103], v1, s[4:7], s34 offen offset:1024
buffer_load_dwordx4 a[104:107], v1, s[4:7], s34 offen offset:2048
buffer_load_dwordx4 a[108:111], v1, s[4:7], s34 offen offset:3072
s_add_u32 s34, s34, 4096
buffer_load_dwordx4 a[112:115], v1, s[4:7], s34 offen offset:0
buffer_load_dwordx4 a[116:119], v1, s[4:7], s34 offen offset:1024
buffer_load_dwordx4 a[120:123], v1, s[4:7], s34 offen offset:2048
buffer_load_dwordx4 a[124:127], v1, s[4:7], s34 offen offset:3072
s_add_u32 s34, s34, 4096
buffer_load_dwordx4 a[128:131], v1, s[4:7], s34 offen offset:0
buffer_load_dwordx4 a[132:135], v1, s[4:7], s34 offen offset:1024
buffer_load_dwordx4 a[136:139], v1, s[4:7], s34 offen offset:2048
buffer_load_dwordx4 a[140:143], v1, s[4:7], s34 offen offset:3072
s_add_u32 s34, s34, 4096
buffer_load_dwordx4 a[144:147], v1, s[4:7], s34 offen offset:0
buffer_load_dwordx4 a[148:151], v1, s[4:7], s34 offen offset:1024
buffer_load_dwordx4 a[152:155], v1, s[4:7], s34 offen offset:2048
buffer_load_dwordx4 a[156:159], v1, s[4:7], s34 offen offset:3072
s_waitcnt vmcnt(20)
s_mul_i32 s34, s15, 12
s_mul_i32 s35, s16, 6
s_add_u32 s34, s34, s35
s_add_u32 s34, s34, 4
s_mul_i32 s34, s34, 20480
s_add_u32 s34, s34, 6291456
buffer_load_dwordx4 a[160:163], v1, s[4:7], s34 offen offset:0
buffer_load_dwordx4 a[164:167], v1, s[4:7], s34 offen offset:1024
buffer_load_dwordx4 a[168:171], v1, s[4:7], s34 offen offset:2048
buffer_load_dwordx4 a[172:175], v1, s[4:7], s34 offen offset:3072
s_add_u32 s34, s34, 4096
buffer_load_dwordx4 a[176:179], v1, s[4:7], s34 offen offset:0
buffer_load_dwordx4 a[180:183], v1, s[4:7], s34 offen offset:1024
buffer_load_dwordx4 a[184:187], v1, s[4:7], s34 offen offset:2048
buffer_load_dwordx4 a[188:191], v1, s[4:7], s34 offen offset:3072
s_add_u32 s34, s34, 4096
buffer_load_dwordx4 a[192:195], v1, s[4:7], s34 offen offset:0
buffer_load_dwordx4 a[196:199], v1, s[4:7], s34 offen offset:1024
buffer_load_dwordx4 a[200:203], v1, s[4:7], s34 offen offset:2048
buffer_load_dwordx4 a[204:207], v1, s[4:7], s34 offen offset:3072
s_add_u32 s34, s34, 4096
buffer_load_dwordx4 a[208:211], v1, s[4:7], s34 offen offset:0
buffer_load_dwordx4 a[212:215], v1, s[4:7], s34 offen offset:1024
buffer_load_dwordx4 a[216:219], v1, s[4:7], s34 offen offset:2048
buffer_load_dwordx4 a[220:223], v1, s[4:7], s34 offen offset:3072
s_add_u32 s34, s34, 4096
buffer_load_dwordx4 a[224:227], v1, s[4:7], s34 offen offset:0
buffer_load_dwordx4 a[228:231], v1, s[4:7], s34 offen offset:1024
buffer_load_dwordx4 a[232:235], v1, s[4:7], s34 offen offset:2048
buffer_load_dwordx4 a[236:239], v1, s[4:7], s34 offen offset:3072
s_waitcnt vmcnt(20)
s_mul_i32 s34, s15, 12
s_mul_i32 s35, s16, 6
s_add_u32 s34, s34, s35
s_add_u32 s34, s34, 5
s_mul_i32 s34, s34, 20480
s_add_u32 s34, s34, 6291456
buffer_load_dwordx4 v[96:99], v1, s[4:7], s34 offen offset:0
buffer_load_dwordx4 v[100:103], v1, s[4:7], s34 offen offset:1024
buffer_load_dwordx4 v[104:107], v1, s[4:7], s34 offen offset:2048
buffer_load_dwordx4 v[108:111], v1, s[4:7], s34 offen offset:3072
s_add_u32 s34, s34, 4096
buffer_load_dwordx4 v[112:115], v1, s[4:7], s34 offen offset:0
buffer_load_dwordx4 v[116:119], v1, s[4:7], s34 offen offset:1024
buffer_load_dwordx4 v[120:123], v1, s[4:7], s34 offen offset:2048
buffer_load_dwordx4 v[124:127], v1, s[4:7], s34 offen offset:3072
s_add_u32 s34, s34, 4096
buffer_load_dwordx4 v[128:131], v1, s[4:7], s34 offen offset:0
buffer_load_dwordx4 v[132:135], v1, s[4:7], s34 offen offset:1024
buffer_load_dwordx4 v[136:139], v1, s[4:7], s34 offen offset:2048
buffer_load_dwordx4 v[140:143], v1, s[4:7], s34 offen offset:3072
s_add_u32 s34, s34, 4096
buffer_load_dwordx4 v[144:147], v1, s[4:7], s34 offen offset:0
buffer_load_dwordx4 v[148:151], v1, s[4:7], s34 offen offset:1024
buffer_load_dwordx4 v[152:155], v1, s[4:7], s34 offen offset:2048
buffer_load_dwordx4 v[156:159], v1, s[4:7], s34 offen offset:3072
s_add_u32 s34, s34, 4096
buffer_load_dwordx4 v[160:163], v1, s[4:7], s34 offen offset:0
buffer_load_dwordx4 v[164:167], v1, s[4:7], s34 offen offset:1024
buffer_load_dwordx4 v[168:171], v1, s[4:7], s34 offen offset:2048
buffer_load_dwordx4 v[172:175], v1, s[4:7], s34 offen offset:3072
s_waitcnt vmcnt(20)
v_and_b32 v30, 7, v0
v_lshlrev_b32 v30, 3, v30
reca_cens269:
buffer_load_dwordx2 v[28:29], v30, s[8:11], 0 offen sc1
s_waitcnt vmcnt(0)
v_sad_u8 v31, v28, 0, 0
v_sad_u8 v31, v29, 0, v31
v_cmp_gt_u32 vcc, 32, v31
s_cbranch_vccz reca_censok270
s_sleep 8
s_sub_u32 s18, s18, 1
s_cbranch_scc0 reca_cens269
s_mov_b32 s18, 0
reca_censok270:
v_and_b32 v28, 0x20202020, v28
v_and_b32 v29, 0x20202020, v29
v_cmp_ne_u32 s[34:35], 0, v28
v_cmp_ne_u32 s[36:37], 0, v29
s_nop 3
s_and_b32 s34, s34, 0xff
s_and_b32 s36, s36, 0xff
s_or_b32 s35, s34, s36
s_lshr_b32 s37, s35, s13
s_and_b32 s37, s37, 1
s_xor_b32 s43, s37, 1
s_cmp_eq_u32 s57, 0
s_cselect_b32 s58, s36, s34
v_mov_b32 v31, 0x80000000
s_cmp_lg_u32 s43, 0
s_cbranch_scc1 reca_pslow271
reca_ptop272:
s_cmp_lt_u32 s17, 3
s_cbranch_scc1 reca_pgo273
s_sub_u32 s36, s17, 3
reca_ppoll274:
buffer_load_dword v28, v4, s[4:7], s25 offen sc1
s_waitcnt vmcnt(0)
v_readfirstlane_b32 s34, v28
s_nop 3
s_cmp_ge_i32 s34, s36
s_cbranch_scc1 reca_pgo273
s_sleep 8
s_sub_u32 s18, s18, 1
s_cbranch_scc0 reca_ppoll274
s_mov_b32 s18, 0
reca_pgo273:
s_waitcnt vmcnt(0)
s_barrier
v_add_u32 v7, s26, v1
s_xor_b32 s26, s26, 40960
s_add_u32 s37, s17, 1
s_cmp_ge_u32 s37, 64
s_cbranch_scc1 reca_pnodma275
s_mul_i32 s20, s37, 40960
s_add_u32 s20, s20, 84965376
s_add_u32 m0, s26, 30720
s_nop 0
buffer_load_dwordx4 v1, s[4:7], s20 offen offset:0 lds
buffer_load_dwordx4 v1, s[4:7], s20 offen offset:1024 lds
buffer_load_dwordx4 v1, s[4:7], s20 offen offset:2048 lds
buffer_load_dwordx4 v1, s[4:7], s20 offen offset:3072 lds
s_add_u32 s20, s20, 4096
s_add_u32 m0, s26, 34816
s_nop 0
buffer_load_dwordx4 v1, s[4:7], s20 offen offset:0 lds
buffer_load_dwordx4 v1, s[4:7], s20 offen offset:1024 lds
buffer_load_dwordx4 v1, s[4:7], s20 offen offset:2048 lds
buffer_load_dwordx4 v1, s[4:7], s20 offen offset:3072 lds
s_add_u32 s20, s20, 4096
s_add_u32 m0, s26, 38912
s_nop 0
buffer_load_dwordx4 v1, s[4:7], s20 offen offset:0 lds
buffer_load_dwordx4 v1, s[4:7], s20 offen offset:1024 lds
reca_pnodma275:
s_lshl_b32 s34, s15, 3
s_and_b32 s35, s17, 7
s_add_u32 s34, s34, s35
s_mul_i32 s34, s34, 12288
s_mul_i32 s35, s16, 3072
s_add_u32 s35, s35, s34
s_add_u32 s21, s35, 37748736
s_add_u32 s22, s35, 44040192
s_mul_i32 s35, s16, 6144
s_add_u32 s35, s35, s34
s_add_u32 s23, s35, 40894464
ds_read_b128 v[72:75], v7 offset:0
ds_read_b128 v[76:79], v7 offset:20480
ds_read_b128 v[80:83], v7 offset:1024
ds_read_b128 v[84:87], v7 offset:21504
ds_read_b128 v[88:91], v7 offset:2048
ds_read_b128 v[92:95], v7 offset:22528
s_waitcnt lgkmcnt(4)
v_mfma_f32_16x16x32_bf16 v[32:35], a[0:3], v[72:75], 0
v_mfma_f32_16x16x32_bf16 v[36:39], a[0:3], v[76:79], 0
v_mfma_f32_16x16x32_bf16 v[40:43], a[80:83], v[72:75], 0
v_mfma_f32_16x16x32_bf16 v[44:47], a[80:83], v[76:79], 0
v_mfma_f32_16x16x32_bf16 v[48:51], a[160:163], v[72:75], 0
v_mfma_f32_16x16x32_bf16 v[52:55], a[160:163], v[76:79], 0
v_mfma_f32_16x16x32_bf16 v[56:59], v[96:99], v[72:75], 0
v_mfma_f32_16x16x32_bf16 v[60:63], v[96:99], v[76:79], 0
ds_read_b128 v[72:75], v7 offset:3072
ds_read_b128 v[76:79], v7 offset:23552
s_waitcnt lgkmcnt(4)
v_mfma_f32_16x16x32_bf16 v[32:35], a[4:7], v[80:83], v[32:35]
v_mfma_f32_16x16x32_bf16 v[36:39], a[4:7], v[84:87], v[36:39]
v_mfma_f32_16x16x32_bf16 v[40:43], a[84:87], v[80:83], v[40:43]
v_mfma_f32_16x16x32_bf16 v[44:47], a[84:87], v[84:87], v[44:47]
v_mfma_f32_16x16x32_bf16 v[48:51], a[164:167], v[80:83], v[48:51]
v_mfma_f32_16x16x32_bf16 v[52:55], a[164:167], v[84:87], v[52:55]
v_mfma_f32_16x16x32_bf16 v[56:59], v[100:103], v[80:83], v[56:59]
v_mfma_f32_16x16x32_bf16 v[60:63], v[100:103], v[84:87], v[60:63]
ds_read_b128 v[80:83], v7 offset:4096
ds_read_b128 v[84:87], v7 offset:24576
s_waitcnt lgkmcnt(4)
v_mfma_f32_16x16x32_bf16 v[32:35], a[8:11], v[88:91], v[32:35]
v_mfma_f32_16x16x32_bf16 v[36:39], a[8:11], v[92:95], v[36:39]
v_mfma_f32_16x16x32_bf16 v[40:43], a[88:91], v[88:91], v[40:43]
v_mfma_f32_16x16x32_bf16 v[44:47], a[88:91], v[92:95], v[44:47]
v_mfma_f32_16x16x32_bf16 v[48:51], a[168:171], v[88:91], v[48:51]
v_mfma_f32_16x16x32_bf16 v[52:55], a[168:171], v[92:95], v[52:55]
v_mfma_f32_16x16x32_bf16 v[56:59], v[104:107], v[88:91], v[56:59]
v_mfma_f32_16x16x32_bf16 v[60:63], v[104:107], v[92:95], v[60:63]
ds_read_b128 v[88:91], v7 offset:5120
ds_read_b128 v[92:95], v7 offset:25600
s_waitcnt lgkmcnt(4)
v_mfma_f32_16x16x32_bf16 v[32:35], a[12:15], v[72:75], v[32:35]
v_mfma_f32_16x16x32_bf16 v[36:39], a[12:15], v[76:79], v[36:39]
v_mfma_f32_16x16x32_bf16 v[40:43], a[92:95], v[72:75], v[40:43]
v_mfma_f32_16x16x32_bf16 v[44:47], a[92:95], v[76:79], v[44:47]
v_mfma_f32_16x16x32_bf16 v[48:51], a[172:175], v[72:75], v[48:51]
v_mfma_f32_16x16x32_bf16 v[52:55], a[172:175], v[76:79], v[52:55]
v_mfma_f32_16x16x32_bf16 v[56:59], v[108:111], v[72:75], v[56:59]
v_mfma_f32_16x16x32_bf16 v[60:63], v[108:111], v[76:79], v[60:63]
ds_read_b128 v[72:75], v7 offset:6144
ds_read_b128 v[76:79], v7 offset:26624
s_waitcnt lgkmcnt(4)
v_mfma_f32_16x16x32_bf16 v[32:35], a[16:19], v[80:83], v[32:35]
v_mfma_f32_16x16x32_bf16 v[36:39], a[16:19], v[84:87], v[36:39]
v_mfma_f32_16x16x32_bf16 v[40:43], a[96:99], v[80:83], v[40:43]
v_mfma_f32_16x16x32_bf16 v[44:47], a[96:99], v[84:87], v[44:47]
v_mfma_f32_16x16x32_bf16 v[48:51], a[176:179], v[80:83], v[48:51]
v_mfma_f32_16x16x32_bf16 v[52:55], a[176:179], v[84:87], v[52:55]
v_mfma_f32_16x16x32_bf16 v[56:59], v[112:115], v[80:83], v[56:59]
v_mfma_f32_16x16x32_bf16 v[60:63], v[112:115], v[84:87], v[60:63]
ds_read_b128 v[80:83], v7 offset:7168
ds_read_b128 v[84:87], v7 offset:27648
s_waitcnt lgkmcnt(4)
v_mfma_f32_16x16x32_bf16 v[32:35], a[20:23], v[88:91], v[32:35]
v_mfma_f32_16x16x32_bf16 v[36:39], a[20:23], v[92:95], v[36:39]
v_mfma_f32_16x16x32_bf16 v[40:43], a[100:103], v[88:91], v[40:43]
v_mfma_f32_16x16x32_bf16 v[44:47], a[100:103], v[92:95], v[44:47]
v_mfma_f32_16x16x32_bf16 v[48:51], a[180:183], v[88:91], v[48:51]
v_mfma_f32_16x16x32_bf16 v[52:55], a[180:183], v[92:95], v[52:55]
v_mfma_f32_16x16x32_bf16 v[56:59], v[116:119], v[88:91], v[56:59]
v_mfma_f32_16x16x32_bf16 v[60:63], v[116:119], v[92:95], v[60:63]
ds_read_b128 v[88:91], v7 offset:8192
ds_read_b128 v[92:95], v7 offset:28672
s_waitcnt lgkmcnt(4)
v_mfma_f32_16x16x32_bf16 v[32:35], a[24:27], v[72:75], v[32:35]
v_mfma_f32_16x16x32_bf16 v[36:39], a[24:27], v[76:79], v[36:39]
v_mfma_f32_16x16x32_bf16 v[40:43], a[104:107], v[72:75], v[40:43]
v_mfma_f32_16x16x32_bf16 v[44:47], a[104:107], v[76:79], v[44:47]
v_mfma_f32_16x16x32_bf16 v[48:51], a[184:187], v[72:75], v[48:51]
v_mfma_f32_16x16x32_bf16 v[52:55], a[184:187], v[76:79], v[52:55]
v_mfma_f32_16x16x32_bf16 v[56:59], v[120:123], v[72:75], v[56:59]
v_mfma_f32_16x16x32_bf16 v[60:63], v[120:123], v[76:79], v[60:63]
ds_read_b128 v[72:75], v7 offset:9216
ds_read_b128 v[76:79], v7 offset:29696
s_waitcnt lgkmcnt(4)
v_mfma_f32_16x16x32_bf16 v[32:35], a[28:31], v[80:83], v[32:35]
v_mfma_f32_16x16x32_bf16 v[36:39], a[28:31], v[84:87], v[36:39]
v_mfma_f32_16x16x32_bf16 v[40:43], a[108:111], v[80:83], v[40:43]
v_mfma_f32_16x16x32_bf16 v[44:47], a[108:111], v[84:87], v[44:47]
v_mfma_f32_16x16x32_bf16 v[48:51], a[188:191], v[80:83], v[48:51]
v_mfma_f32_16x16x32_bf16 v[52:55], a[188:191], v[84:87], v[52:55]
v_mfma_f32_16x16x32_bf16 v[56:59], v[124:127], v[80:83], v[56:59]
v_mfma_f32_16x16x32_bf16 v[60:63], v[124:127], v[84:87], v[60:63]
ds_read_b128 v[80:83], v7 offset:10240
ds_read_b128 v[84:87], v7 offset:30720
s_waitcnt lgkmcnt(4)
v_mfma_f32_16x16x32_bf16 v[32:35], a[32:35], v[88:91], v[32:35]
v_mfma_f32_16x16x32_bf16 v[36:39], a[32:35], v[92:95], v[36:39]
v_mfma_f32_16x16x32_bf16 v[40:43], a[112:115], v[88:91], v[40:43]
v_mfma_f32_16x16x32_bf16 v[44:47], a[112:115], v[92:95], v[44:47]
v_mfma_f32_16x16x32_bf16 v[48:51], a[192:195], v[88:91], v[48:51]
v_mfma_f32_16x16x32_bf16 v[52:55], a[192:195], v[92:95], v[52:55]
v_mfma_f32_16x16x32_bf16 v[56:59], v[128:131], v[88:91], v[56:59]
v_mfma_f32_16x16x32_bf16 v[60:63], v[128:131], v[92:95], v[60:63]
ds_read_b128 v[88:91], v7 offset:11264
ds_read_b128 v[92:95], v7 offset:31744
s_waitcnt lgkmcnt(4)
v_mfma_f32_16x16x32_bf16 v[32:35], a[36:39], v[72:75], v[32:35]
v_mfma_f32_16x16x32_bf16 v[36:39], a[36:39], v[76:79], v[36:39]
v_mfma_f32_16x16x32_bf16 v[40:43], a[116:119], v[72:75], v[40:43]
v_mfma_f32_16x16x32_bf16 v[44:47], a[116:119], v[76:79], v[44:47]
v_mfma_f32_16x16x32_bf16 v[48:51], a[196:199], v[72:75], v[48:51]
v_mfma_f32_16x16x32_bf16 v[52:55], a[196:199], v[76:79], v[52:55]
v_mfma_f32_16x16x32_bf16 v[56:59], v[132:135], v[72:75], v[56:59]
v_mfma_f32_16x16x32_bf16 v[60:63], v[132:135], v[76:79], v[60:63]
ds_read_b128 v[72:75], v7 offset:12288
ds_read_b128 v[76:79], v7 offset:32768
s_waitcnt lgkmcnt(4)
v_mfma_f32_16x16x32_bf16 v[32:35], a[40:43], v[80:83], v[32:35]
v_mfma_f32_16x16x32_bf16 v[36:39], a[40:43], v[84:87], v[36:39]
v_mfma_f32_16x16x32_bf16 v[40:43], a[120:123], v[80:83], v[40:43]
v_mfma_f32_16x16x32_bf16 v[44:47], a[120:123], v[84:87], v[44:47]
v_mfma_f32_16x16x32_bf16 v[48:51], a[200:203], v[80:83], v[48:51]
v_mfma_f32_16x16x32_bf16 v[52:55], a[200:203], v[84:87], v[52:55]
v_mfma_f32_16x16x32_bf16 v[56:59], v[136:139], v[80:83], v[56:59]
v_mfma_f32_16x16x32_bf16 v[60:63], v[136:139], v[84:87], v[60:63]
ds_read_b128 v[80:83], v7 offset:13312
ds_read_b128 v[84:87], v7 offset:33792
s_waitcnt lgkmcnt(4)
v_mfma_f32_16x16x32_bf16 v[32:35], a[44:47], v[88:91], v[32:35]
v_mfma_f32_16x16x32_bf16 v[36:39], a[44:47], v[92:95], v[36:39]
v_mfma_f32_16x16x32_bf16 v[40:43], a[124:127], v[88:91], v[40:43]
v_mfma_f32_16x16x32_bf16 v[44:47], a[124:127], v[92:95], v[44:47]
v_mfma_f32_16x16x32_bf16 v[48:51], a[204:207], v[88:91], v[48:51]
v_mfma_f32_16x16x32_bf16 v[52:55], a[204:207], v[92:95], v[52:55]
v_mfma_f32_16x16x32_bf16 v[56:59], v[140:143], v[88:91], v[56:59]
v_mfma_f32_16x16x32_bf16 v[60:63], v[140:143], v[92:95], v[60:63]
ds_read_b128 v[88:91], v7 offset:14336
ds_read_b128 v[92:95], v7 offset:34816
s_waitcnt lgkmcnt(4)
v_mfma_f32_16x16x32_bf16 v[32:35], a[48:51], v[72:75], v[32:35]
v_mfma_f32_16x16x32_bf16 v[36:39], a[48:51], v[76:79], v[36:39]
v_mfma_f32_16x16x32_bf16 v[40:43], a[128:131], v[72:75], v[40:43]
v_mfma_f32_16x16x32_bf16 v[44:47], a[128:131], v[76:79], v[44:47]
v_mfma_f32_16x16x32_bf16 v[48:51], a[208:211], v[72:75], v[48:51]
v_mfma_f32_16x16x32_bf16 v[52:55], a[208:211], v[76:79], v[52:55]
v_mfma_f32_16x16x32_bf16 v[56:59], v[144:147], v[72:75], v[56:59]
v_mfma_f32_16x16x32_bf16 v[60:63], v[144:147], v[76:79], v[60:63]
ds_read_b128 v[72:75], v7 offset:15360
ds_read_b128 v[76:79], v7 offset:35840
s_waitcnt lgkmcnt(4)
v_mfma_f32_16x16x32_bf16 v[32:35], a[52:55], v[80:83], v[32:35]
v_mfma_f32_16x16x32_bf16 v[36:39], a[52:55], v[84:87], v[36:39]
v_mfma_f32_16x16x32_bf16 v[40:43], a[132:135], v[80:83], v[40:43]
v_mfma_f32_16x16x32_bf16 v[44:47], a[132:135], v[84:87], v[44:47]
v_mfma_f32_16x16x32_bf16 v[48:51], a[212:215], v[80:83], v[48:51]
v_mfma_f32_16x16x32_bf16 v[52:55], a[212:215], v[84:87], v[52:55]
v_mfma_f32_16x16x32_bf16 v[56:59], v[148:151], v[80:83], v[56:59]
v_mfma_f32_16x16x32_bf16 v[60:63], v[148:151], v[84:87], v[60:63]
ds_read_b128 v[80:83], v7 offset:16384
ds_read_b128 v[84:87], v7 offset:36864
s_waitcnt lgkmcnt(4)
v_mfma_f32_16x16x32_bf16 v[32:35], a[56:59], v[88:91], v[32:35]
v_mfma_f32_16x16x32_bf16 v[36:39], a[56:59], v[92:95], v[36:39]
v_mfma_f32_16x16x32_bf16 v[40:43], a[136:139], v[88:91], v[40:43]
v_mfma_f32_16x16x32_bf16 v[44:47], a[136:139], v[92:95], v[44:47]
v_mfma_f32_16x16x32_bf16 v[48:51], a[216:219], v[88:91], v[48:51]
v_mfma_f32_16x16x32_bf16 v[52:55], a[216:219], v[92:95], v[52:55]
v_mfma_f32_16x16x32_bf16 v[56:59], v[152:155], v[88:91], v[56:59]
v_mfma_f32_16x16x32_bf16 v[60:63], v[152:155], v[92:95], v[60:63]
ds_read_b128 v[88:91], v7 offset:17408
ds_read_b128 v[92:95], v7 offset:37888
s_waitcnt lgkmcnt(4)
v_mfma_f32_16x16x32_bf16 v[32:35], a[60:63], v[72:75], v[32:35]
v_mfma_f32_16x16x32_bf16 v[36:39], a[60:63], v[76:79], v[36:39]
v_mfma_f32_16x16x32_bf16 v[40:43], a[140:143], v[72:75], v[40:43]
v_mfma_f32_16x16x32_bf16 v[44:47], a[140:143], v[76:79], v[44:47]
v_mfma_f32_16x16x32_bf16 v[48:51], a[220:223], v[72:75], v[48:51]
v_mfma_f32_16x16x32_bf16 v[52:55], a[220:223], v[76:79], v[52:55]
v_mfma_f32_16x16x32_bf16 v[56:59], v[156:159], v[72:75], v[56:59]
v_mfma_f32_16x16x32_bf16 v[60:63], v[156:159], v[76:79], v[60:63]
ds_read_b128 v[72:75], v7 offset:18432
ds_read_b128 v[76:79], v7 offset:38912
s_waitcnt lgkmcnt(4)
v_mfma_f32_16x16x32_bf16 v[32:35], a[64:67], v[80:83], v[32:35]
v_mfma_f32_16x16x32_bf16 v[36:39], a[64:67], v[84:87], v[36:39]
v_mfma_f32_16x16x32_bf16 v[40:43], a[144:147], v[80:83], v[40:43]
v_mfma_f32_16x16x32_bf16 v[44:47], a[144:147], v[84:87], v[44:47]
v_mfma_f32_16x16x32_bf16 v[48:51], a[224:227], v[80:83], v[48:51]
v_mfma_f32_16x16x32_bf16 v[52:55], a[224:227], v[84:87], v[52:55]
v_mfma_f32_16x16x32_bf16 v[56:59], v[160:163], v[80:83], v[56:59]
v_mfma_f32_16x16x32_bf16 v[60:63], v[160:163], v[84:87], v[60:63]
ds_read_b128 v[80:83], v7 offset:19456
ds_read_b128 v[84:87], v7 offset:39936
s_waitcnt lgkmcnt(4)
v_mfma_f32_16x16x32_bf16 v[32:35], a[68:71], v[88:91], v[32:35]
v_mfma_f32_16x16x32_bf16 v[36:39], a[68:71], v[92:95], v[36:39]
v_mfma_f32_16x16x32_bf16 v[40:43], a[148:151], v[88:91], v[40:43]
v_mfma_f32_16x16x32_bf16 v[44:47], a[148:151], v[92:95], v[44:47]
v_mfma_f32_16x16x32_bf16 v[48:51], a[228:231], v[88:91], v[48:51]
v_mfma_f32_16x16x32_bf16 v[52:55], a[228:231], v[92:95], v[52:55]
v_mfma_f32_16x16x32_bf16 v[56:59], v[164:167], v[88:91], v[56:59]
v_mfma_f32_16x16x32_bf16 v[60:63], v[164:167], v[92:95], v[60:63]
s_waitcnt lgkmcnt(2)
v_mfma_f32_16x16x32_bf16 v[32:35], a[72:75], v[72:75], v[32:35]
v_mfma_f32_16x16x32_bf16 v[36:39], a[72:75], v[76:79], v[36:39]
v_mfma_f32_16x16x32_bf16 v[40:43], a[152:155], v[72:75], v[40:43]
v_mfma_f32_16x16x32_bf16 v[44:47], a[152:155], v[76:79], v[44:47]
v_mfma_f32_16x16x32_bf16 v[48:51], a[232:235], v[72:75], v[48:51]
v_mfma_f32_16x16x32_bf16 v[52:55], a[232:235], v[76:79], v[52:55]
v_mfma_f32_16x16x32_bf16 v[56:59], v[168:171], v[72:75], v[56:59]
v_mfma_f32_16x16x32_bf16 v[60:63], v[168:171], v[76:79], v[60:63]
s_waitcnt lgkmcnt(0)
v_mfma_f32_16x16x32_bf16 v[32:35], a[76:79], v[80:83], v[32:35]
v_mfma_f32_16x16x32_bf16 v[36:39], a[76:79], v[84:87], v[36:39]
v_mfma_f32_16x16x32_bf16 v[40:43], a[156:159], v[80:83], v[40:43]
v_mfma_f32_16x16x32_bf16 v[44:47], a[156:159], v[84:87], v[44:47]
v_mfma_f32_16x16x32_bf16 v[48:51], a[236:239], v[80:83], v[48:51]
v_mfma_f32_16x16x32_bf16 v[52:55], a[236:239], v[84:87], v[52:55]
v_mfma_f32_16x16x32_bf16 v[56:59], v[172:175], v[80:83], v[56:59]
v_mfma_f32_16x16x32_bf16 v[60:63], v[172:175], v[84:87], v[60:63]
s_nop 0
v_cvt_pk_bf16_f32 v8, v32, v33
v_cvt_pk_bf16_f32 v9, v34, v35
v_cvt_pk_bf16_f32 v10, v40, v41
v_cvt_pk_bf16_f32 v11, v42, v43
s_add_u32 s34, s22, 1024
buffer_store_dwordx4 v[8:11], v1, s[4:7], s34 offen
v_cvt_pk_bf16_f32 v12, v36, v37
v_cvt_pk_bf16_f32 v13, v38, v39
v_cvt_pk_bf16_f32 v14, v44, v45
v_cvt_pk_bf16_f32 v15, v46, v47
s_add_u32 s34, s22, 7168
buffer_store_dwordx4 v[12:15], v1, s[4:7], s34 offen
v_cvt_pk_bf16_f32 v8, v48, v49
v_cvt_pk_bf16_f32 v9, v50, v51
v_cvt_pk_bf16_f32 v10, v56, v57
v_cvt_pk_bf16_f32 v11, v58, v59
s_add_u32 s34, s22, 2048
buffer_store_dwordx4 v[8:11], v1, s[4:7], s34 offen
v_cvt_pk_bf16_f32 v12, v52, v53
v_cvt_pk_bf16_f32 v13, v54, v55
v_cvt_pk_bf16_f32 v14, v60, v61
v_cvt_pk_bf16_f32 v15, v62, v63
s_add_u32 s34, s22, 8192
buffer_store_dwordx4 v[12:15], v1, s[4:7], s34 offen
s_waitcnt vmcnt(0)
s_barrier
s_add_u32 s17, s17, 1
s_cmp_lt_u32 s17, 64
s_cbranch_scc1 reca_ptop272
s_branch reca_exit1
reca_pslow271:
reca_ptop277:
s_cmp_lt_u32 s17, 3
s_cbranch_scc1 reca_pgo278
s_sub_u32 s36, s17, 3
reca_ppoll279:
buffer_load_dword v28, v4, s[4:7], s25 offen sc1
s_waitcnt vmcnt(0)
v_readfirstlane_b32 s34, v28
s_nop 3
s_cmp_ge_i32 s34, s36
s_cbranch_scc1 reca_pgo278
s_sleep 8
s_sub_u32 s18, s18, 1
s_cbranch_scc0 reca_ppoll279
s_mov_b32 s18, 0
reca_pgo278:
s_waitcnt vmcnt(0)
s_barrier
v_add_u32 v7, s26, v1
s_xor_b32 s26, s26, 40960
s_add_u32 s37, s17, 1
s_cmp_ge_u32 s37, 64
s_cbranch_scc1 reca_pnodma280
s_mul_i32 s20, s37, 40960
s_add_u32 s20, s20, 84965376
s_add_u32 m0, s26, 30720
s_nop 0
buffer_load_dwordx4 v1, s[4:7], s20 offen offset:0 lds
buffer_load_dwordx4 v1, s[4:7], s20 offen offset:1024 lds
buffer_load_dwordx4 v1, s[4:7], s20 offen offset:2048 lds
buffer_load_dwordx4 v1, s[4:7], s20 offen offset:3072 lds
s_add_u32 s20, s20, 4096
s_add_u32 m0, s26, 34816
s_nop 0
buffer_load_dwordx4 v1, s[4:7], s20 offen offset:0 lds
buffer_load_dwordx4 v1, s[4:7], s20 offen offset:1024 lds
buffer_load_dwordx4 v1, s[4:7], s20 offen offset:2048 lds
buffer_load_dwordx4 v1, s[4:7], s20 offen offset:3072 lds
s_add_u32 s20, s20, 4096
s_add_u32 m0, s26, 38912
s_nop 0
buffer_load_dwordx4 v1, s[4:7], s20 offen offset:0 lds
buffer_load_dwordx4 v1, s[4:7], s20 offen offset:1024 lds
reca_pnodma280:
s_lshl_b32 s34, s15, 3
s_and_b32 s35, s17, 7
s_add_u32 s34, s34, s35
s_mul_i32 s34, s34, 12288
s_mul_i32 s35, s16, 3072
s_add_u32 s35, s35, s34
s_add_u32 s21, s35, 37748736
s_add_u32 s22, s35, 44040192
s_mul_i32 s35, s16, 6144
s_add_u32 s35, s35, s34
s_add_u32 s23, s35, 40894464
ds_read_b128 v[72:75], v7 offset:0
ds_read_b128 v[76:79], v7 offset:20480
ds_read_b128 v[80:83], v7 offset:1024
ds_read_b128 v[84:87], v7 offset:21504
ds_read_b128 v[88:91], v7 offset:2048
ds_read_b128 v[92:95], v7 offset:22528
s_waitcnt lgkmcnt(4)
v_mfma_f32_16x16x32_bf16 v[32:35], a[0:3], v[72:75], 0
v_mfma_f32_16x16x32_bf16 v[36:39], a[0:3], v[76:79], 0
v_mfma_f32_16x16x32_bf16 v[40:43], a[80:83], v[72:75], 0
v_mfma_f32_16x16x32_bf16 v[44:47], a[80:83], v[76:79], 0
v_mfma_f32_16x16x32_bf16 v[48:51], a[160:163], v[72:75], 0
v_mfma_f32_16x16x32_bf16 v[52:55], a[160:163], v[76:79], 0
v_mfma_f32_16x16x32_bf16 v[56:59], v[96:99], v[72:75], 0
v_mfma_f32_16x16x32_bf16 v[60:63], v[96:99], v[76:79], 0
ds_read_b128 v[72:75], v7 offset:3072
ds_read_b128 v[76:79], v7 offset:23552
s_waitcnt lgkmcnt(4)
v_mfma_f32_16x16x32_bf16 v[32:35], a[4:7], v[80:83], v[32:35]
v_mfma_f32_16x16x32_bf16 v[36:39], a[4:7], v[84:87], v[36:39]
v_mfma_f32_16x16x32_bf16 v[40:43], a[84:87], v[80:83], v[40:43]
v_mfma_f32_16x16x32_bf16 v[44:47], a[84:87], v[84:87], v[44:47]
v_mfma_f32_16x16x32_bf16 v[48:51], a[164:167], v[80:83], v[48:51]
v_mfma_f32_16x16x32_bf16 v[52:55], a[164:167], v[84:87], v[52:55]
v_mfma_f32_16x16x32_bf16 v[56:59], v[100:103], v[80:83], v[56:59]
v_mfma_f32_16x16x32_bf16 v[60:63], v[100:103], v[84:87], v[60:63]
ds_read_b128 v[80:83], v7 offset:4096
ds_read_b128 v[84:87], v7 offset:24576
s_waitcnt lgkmcnt(4)
v_mfma_f32_16x16x32_bf16 v[32:35], a[8:11], v[88:91], v[32:35]
v_mfma_f32_16x16x32_bf16 v[36:39], a[8:11], v[92:95], v[36:39]
v_mfma_f32_16x16x32_bf16 v[40:43], a[88:91], v[88:91], v[40:43]
v_mfma_f32_16x16x32_bf16 v[44:47], a[88:91], v[92:95], v[44:47]
v_mfma_f32_16x16x32_bf16 v[48:51], a[168:171], v[88:91], v[48:51]
v_mfma_f32_16x16x32_bf16 v[52:55], a[168:171], v[92:95], v[52:55]
v_mfma_f32_16x16x32_bf16 v[56:59], v[104:107], v[88:91], v[56:59]
v_mfma_f32_16x16x32_bf16 v[60:63], v[104:107], v[92:95], v[60:63]
ds_read_b128 v[88:91], v7 offset:5120
ds_read_b128 v[92:95], v7 offset:25600
s_waitcnt lgkmcnt(4)
v_mfma_f32_16x16x32_bf16 v[32:35], a[12:15], v[72:75], v[32:35]
v_mfma_f32_16x16x32_bf16 v[36:39], a[12:15], v[76:79], v[36:39]
v_mfma_f32_16x16x32_bf16 v[40:43], a[92:95], v[72:75], v[40:43]
v_mfma_f32_16x16x32_bf16 v[44:47], a[92:95], v[76:79], v[44:47]
v_mfma_f32_16x16x32_bf16 v[48:51], a[172:175], v[72:75], v[48:51]
v_mfma_f32_16x16x32_bf16 v[52:55], a[172:175], v[76:79], v[52:55]
v_mfma_f32_16x16x32_bf16 v[56:59], v[108:111], v[72:75], v[56:59]
v_mfma_f32_16x16x32_bf16 v[60:63], v[108:111], v[76:79], v[60:63]
ds_read_b128 v[72:75], v7 offset:6144
ds_read_b128 v[76:79], v7 offset:26624
s_waitcnt lgkmcnt(4)
v_mfma_f32_16x16x32_bf16 v[32:35], a[16:19], v[80:83], v[32:35]
v_mfma_f32_16x16x32_bf16 v[36:39], a[16:19], v[84:87], v[36:39]
v_mfma_f32_16x16x32_bf16 v[40:43], a[96:99], v[80:83], v[40:43]
v_mfma_f32_16x16x32_bf16 v[44:47], a[96:99], v[84:87], v[44:47]
v_mfma_f32_16x16x32_bf16 v[48:51], a[176:179], v[80:83], v[48:51]
v_mfma_f32_16x16x32_bf16 v[52:55], a[176:179], v[84:87], v[52:55]
v_mfma_f32_16x16x32_bf16 v[56:59], v[112:115], v[80:83], v[56:59]
v_mfma_f32_16x16x32_bf16 v[60:63], v[112:115], v[84:87], v[60:63]
ds_read_b128 v[80:83], v7 offset:7168
ds_read_b128 v[84:87], v7 offset:27648
s_waitcnt lgkmcnt(4)
v_mfma_f32_16x16x32_bf16 v[32:35], a[20:23], v[88:91], v[32:35]
v_mfma_f32_16x16x32_bf16 v[36:39], a[20:23], v[92:95], v[36:39]
v_mfma_f32_16x16x32_bf16 v[40:43], a[100:103], v[88:91], v[40:43]
v_mfma_f32_16x16x32_bf16 v[44:47], a[100:103], v[92:95], v[44:47]
v_mfma_f32_16x16x32_bf16 v[48:51], a[180:183], v[88:91], v[48:51]
v_mfma_f32_16x16x32_bf16 v[52:55], a[180:183], v[92:95], v[52:55]
v_mfma_f32_16x16x32_bf16 v[56:59], v[116:119], v[88:91], v[56:59]
v_mfma_f32_16x16x32_bf16 v[60:63], v[116:119], v[92:95], v[60:63]
ds_read_b128 v[88:91], v7 offset:8192
ds_read_b128 v[92:95], v7 offset:28672
s_waitcnt lgkmcnt(4)
v_mfma_f32_16x16x32_bf16 v[32:35], a[24:27], v[72:75], v[32:35]
v_mfma_f32_16x16x32_bf16 v[36:39], a[24:27], v[76:79], v[36:39]
v_mfma_f32_16x16x32_bf16 v[40:43], a[104:107], v[72:75], v[40:43]
v_mfma_f32_16x16x32_bf16 v[44:47], a[104:107], v[76:79], v[44:47]
v_mfma_f32_16x16x32_bf16 v[48:51], a[184:187], v[72:75], v[48:51]
v_mfma_f32_16x16x32_bf16 v[52:55], a[184:187], v[76:79], v[52:55]
v_mfma_f32_16x16x32_bf16 v[56:59], v[120:123], v[72:75], v[56:59]
v_mfma_f32_16x16x32_bf16 v[60:63], v[120:123], v[76:79], v[60:63]
ds_read_b128 v[72:75], v7 offset:9216
ds_read_b128 v[76:79], v7 offset:29696
s_waitcnt lgkmcnt(4)
v_mfma_f32_16x16x32_bf16 v[32:35], a[28:31], v[80:83], v[32:35]
v_mfma_f32_16x16x32_bf16 v[36:39], a[28:31], v[84:87], v[36:39]
v_mfma_f32_16x16x32_bf16 v[40:43], a[108:111], v[80:83], v[40:43]
v_mfma_f32_16x16x32_bf16 v[44:47], a[108:111], v[84:87], v[44:47]
v_mfma_f32_16x16x32_bf16 v[48:51], a[188:191], v[80:83], v[48:51]
v_mfma_f32_16x16x32_bf16 v[52:55], a[188:191], v[84:87], v[52:55]
v_mfma_f32_16x16x32_bf16 v[56:59], v[124:127], v[80:83], v[56:59]
v_mfma_f32_16x16x32_bf16 v[60:63], v[124:127], v[84:87], v[60:63]
ds_read_b128 v[80:83], v7 offset:10240
ds_read_b128 v[84:87], v7 offset:30720
s_waitcnt lgkmcnt(4)
v_mfma_f32_16x16x32_bf16 v[32:35], a[32:35], v[88:91], v[32:35]
v_mfma_f32_16x16x32_bf16 v[36:39], a[32:35], v[92:95], v[36:39]
v_mfma_f32_16x16x32_bf16 v[40:43], a[112:115], v[88:91], v[40:43]
v_mfma_f32_16x16x32_bf16 v[44:47], a[112:115], v[92:95], v[44:47]
v_mfma_f32_16x16x32_bf16 v[48:51], a[192:195], v[88:91], v[48:51]
v_mfma_f32_16x16x32_bf16 v[52:55], a[192:195], v[92:95], v[52:55]
v_mfma_f32_16x16x32_bf16 v[56:59], v[128:131], v[88:91], v[56:59]
v_mfma_f32_16x16x32_bf16 v[60:63], v[128:131], v[92:95], v[60:63]
ds_read_b128 v[88:91], v7 offset:11264
ds_read_b128 v[92:95], v7 offset:31744
s_waitcnt lgkmcnt(4)
v_mfma_f32_16x16x32_bf16 v[32:35], a[36:39], v[72:75], v[32:35]
v_mfma_f32_16x16x32_bf16 v[36:39], a[36:39], v[76:79], v[36:39]
v_mfma_f32_16x16x32_bf16 v[40:43], a[116:119], v[72:75], v[40:43]
v_mfma_f32_16x16x32_bf16 v[44:47], a[116:119], v[76:79], v[44:47]
v_mfma_f32_16x16x32_bf16 v[48:51], a[196:199], v[72:75], v[48:51]
v_mfma_f32_16x16x32_bf16 v[52:55], a[196:199], v[76:79], v[52:55]
v_mfma_f32_16x16x32_bf16 v[56:59], v[132:135], v[72:75], v[56:59]
v_mfma_f32_16x16x32_bf16 v[60:63], v[132:135], v[76:79], v[60:63]
ds_read_b128 v[72:75], v7 offset:12288
ds_read_b128 v[76:79], v7 offset:32768
s_waitcnt lgkmcnt(4)
v_mfma_f32_16x16x32_bf16 v[32:35], a[40:43], v[80:83], v[32:35]
v_mfma_f32_16x16x32_bf16 v[36:39], a[40:43], v[84:87], v[36:39]
v_mfma_f32_16x16x32_bf16 v[40:43], a[120:123], v[80:83], v[40:43]
v_mfma_f32_16x16x32_bf16 v[44:47], a[120:123], v[84:87], v[44:47]
v_mfma_f32_16x16x32_bf16 v[48:51], a[200:203], v[80:83], v[48:51]
v_mfma_f32_16x16x32_bf16 v[52:55], a[200:203], v[84:87], v[52:55]
v_mfma_f32_16x16x32_bf16 v[56:59], v[136:139], v[80:83], v[56:59]
v_mfma_f32_16x16x32_bf16 v[60:63], v[136:139], v[84:87], v[60:63]
ds_read_b128 v[80:83], v7 offset:13312
ds_read_b128 v[84:87], v7 offset:33792
s_waitcnt lgkmcnt(4)
v_mfma_f32_16x16x32_bf16 v[32:35], a[44:47], v[88:91], v[32:35]
v_mfma_f32_16x16x32_bf16 v[36:39], a[44:47], v[92:95], v[36:39]
v_mfma_f32_16x16x32_bf16 v[40:43], a[124:127], v[88:91], v[40:43]
v_mfma_f32_16x16x32_bf16 v[44:47], a[124:127], v[92:95], v[44:47]
v_mfma_f32_16x16x32_bf16 v[48:51], a[204:207], v[88:91], v[48:51]
v_mfma_f32_16x16x32_bf16 v[52:55], a[204:207], v[92:95], v[52:55]
v_mfma_f32_16x16x32_bf16 v[56:59], v[140:143], v[88:91], v[56:59]
v_mfma_f32_16x16x32_bf16 v[60:63], v[140:143], v[92:95], v[60:63]
ds_read_b128 v[88:91], v7 offset:14336
ds_read_b128 v[92:95], v7 offset:34816
s_waitcnt lgkmcnt(4)
v_mfma_f32_16x16x32_bf16 v[32:35], a[48:51], v[72:75], v[32:35]
v_mfma_f32_16x16x32_bf16 v[36:39], a[48:51], v[76:79], v[36:39]
v_mfma_f32_16x16x32_bf16 v[40:43], a[128:131], v[72:75], v[40:43]
v_mfma_f32_16x16x32_bf16 v[44:47], a[128:131], v[76:79], v[44:47]
v_mfma_f32_16x16x32_bf16 v[48:51], a[208:211], v[72:75], v[48:51]
v_mfma_f32_16x16x32_bf16 v[52:55], a[208:211], v[76:79], v[52:55]
v_mfma_f32_16x16x32_bf16 v[56:59], v[144:147], v[72:75], v[56:59]
v_mfma_f32_16x16x32_bf16 v[60:63], v[144:147], v[76:79], v[60:63]
ds_read_b128 v[72:75], v7 offset:15360
ds_read_b128 v[76:79], v7 offset:35840
s_waitcnt lgkmcnt(4)
v_mfma_f32_16x16x32_bf16 v[32:35], a[52:55], v[80:83], v[32:35]
v_mfma_f32_16x16x32_bf16 v[36:39], a[52:55], v[84:87], v[36:39]
v_mfma_f32_16x16x32_bf16 v[40:43], a[132:135], v[80:83], v[40:43]
v_mfma_f32_16x16x32_bf16 v[44:47], a[132:135], v[84:87], v[44:47]
v_mfma_f32_16x16x32_bf16 v[48:51], a[212:215], v[80:83], v[48:51]
v_mfma_f32_16x16x32_bf16 v[52:55], a[212:215], v[84:87], v[52:55]
v_mfma_f32_16x16x32_bf16 v[56:59], v[148:151], v[80:83], v[56:59]
v_mfma_f32_16x16x32_bf16 v[60:63], v[148:151], v[84:87], v[60:63]
ds_read_b128 v[80:83], v7 offset:16384
ds_read_b128 v[84:87], v7 offset:36864
s_waitcnt lgkmcnt(4)
v_mfma_f32_16x16x32_bf16 v[32:35], a[56:59], v[88:91], v[32:35]
v_mfma_f32_16x16x32_bf16 v[36:39], a[56:59], v[92:95], v[36:39]
v_mfma_f32_16x16x32_bf16 v[40:43], a[136:139], v[88:91], v[40:43]
v_mfma_f32_16x16x32_bf16 v[44:47], a[136:139], v[92:95], v[44:47]
v_mfma_f32_16x16x32_bf16 v[48:51], a[216:219], v[88:91], v[48:51]
v_mfma_f32_16x16x32_bf16 v[52:55], a[216:219], v[92:95], v[52:55]
v_mfma_f32_16x16x32_bf16 v[56:59], v[152:155], v[88:91], v[56:59]
v_mfma_f32_16x16x32_bf16 v[60:63], v[152:155], v[92:95], v[60:63]
ds_read_b128 v[88:91], v7 offset:17408
ds_read_b128 v[92:95], v7 offset:37888
s_waitcnt lgkmcnt(4)
v_mfma_f32_16x16x32_bf16 v[32:35], a[60:63], v[72:75], v[32:35]
v_mfma_f32_16x16x32_bf16 v[36:39], a[60:63], v[76:79], v[36:39]
v_mfma_f32_16x16x32_bf16 v[40:43], a[140:143], v[72:75], v[40:43]
v_mfma_f32_16x16x32_bf16 v[44:47], a[140:143], v[76:79], v[44:47]
v_mfma_f32_16x16x32_bf16 v[48:51], a[220:223], v[72:75], v[48:51]
v_mfma_f32_16x16x32_bf16 v[52:55], a[220:223], v[76:79], v[52:55]
v_mfma_f32_16x16x32_bf16 v[56:59], v[156:159], v[72:75], v[56:59]
v_mfma_f32_16x16x32_bf16 v[60:63], v[156:159], v[76:79], v[60:63]
ds_read_b128 v[72:75], v7 offset:18432
ds_read_b128 v[76:79], v7 offset:38912
s_waitcnt lgkmcnt(4)
v_mfma_f32_16x16x32_bf16 v[32:35], a[64:67], v[80:83], v[32:35]
v_mfma_f32_16x16x32_bf16 v[36:39], a[64:67], v[84:87], v[36:39]
v_mfma_f32_16x16x32_bf16 v[40:43], a[144:147], v[80:83], v[40:43]
v_mfma_f32_16x16x32_bf16 v[44:47], a[144:147], v[84:87], v[44:47]
v_mfma_f32_16x16x32_bf16 v[48:51], a[224:227], v[80:83], v[48:51]
v_mfma_f32_16x16x32_bf16 v[52:55], a[224:227], v[84:87], v[52:55]
v_mfma_f32_16x16x32_bf16 v[56:59], v[160:163], v[80:83], v[56:59]
v_mfma_f32_16x16x32_bf16 v[60:63], v[160:163], v[84:87], v[60:63]
ds_read_b128 v[80:83], v7 offset:19456
ds_read_b128 v[84:87], v7 offset:39936
s_waitcnt lgkmcnt(4)
v_mfma_f32_16x16x32_bf16 v[32:35], a[68:71], v[88:91], v[32:35]
v_mfma_f32_16x16x32_bf16 v[36:39], a[68:71], v[92:95], v[36:39]
v_mfma_f32_16x16x32_bf16 v[40:43], a[148:151], v[88:91], v[40:43]
v_mfma_f32_16x16x32_bf16 v[44:47], a[148:151], v[92:95], v[44:47]
v_mfma_f32_16x16x32_bf16 v[48:51], a[228:231], v[88:91], v[48:51]
v_mfma_f32_16x16x32_bf16 v[52:55], a[228:231], v[92:95], v[52:55]
v_mfma_f32_16x16x32_bf16 v[56:59], v[164:167], v[88:91], v[56:59]
v_mfma_f32_16x16x32_bf16 v[60:63], v[164:167], v[92:95], v[60:63]
s_waitcnt lgkmcnt(2)
v_mfma_f32_16x16x32_bf16 v[32:35], a[72:75], v[72:75], v[32:35]
v_mfma_f32_16x16x32_bf16 v[36:39], a[72:75], v[76:79], v[36:39]
v_mfma_f32_16x16x32_bf16 v[40:43], a[152:155], v[72:75], v[40:43]
v_mfma_f32_16x16x32_bf16 v[44:47], a[152:155], v[76:79], v[44:47]
v_mfma_f32_16x16x32_bf16 v[48:51], a[232:235], v[72:75], v[48:51]
v_mfma_f32_16x16x32_bf16 v[52:55], a[232:235], v[76:79], v[52:55]
v_mfma_f32_16x16x32_bf16 v[56:59], v[168:171], v[72:75], v[56:59]
v_mfma_f32_16x16x32_bf16 v[60:63], v[168:171], v[76:79], v[60:63]
s_waitcnt lgkmcnt(0)
v_mfma_f32_16x16x32_bf16 v[32:35], a[76:79], v[80:83], v[32:35]
v_mfma_f32_16x16x32_bf16 v[36:39], a[76:79], v[84:87], v[36:39]
v_mfma_f32_16x16x32_bf16 v[40:43], a[156:159], v[80:83], v[40:43]
v_mfma_f32_16x16x32_bf16 v[44:47], a[156:159], v[84:87], v[44:47]
v_mfma_f32_16x16x32_bf16 v[48:51], a[236:239], v[80:83], v[48:51]
v_mfma_f32_16x16x32_bf16 v[52:55], a[236:239], v[84:87], v[52:55]
v_mfma_f32_16x16x32_bf16 v[56:59], v[172:175], v[80:83], v[56:59]
v_mfma_f32_16x16x32_bf16 v[60:63], v[172:175], v[84:87], v[60:63]
s_nop 0
v_cvt_pk_bf16_f32 v8, v32, v33
v_cvt_pk_bf16_f32 v9, v34, v35
v_cvt_pk_bf16_f32 v10, v40, v41
v_cvt_pk_bf16_f32 v11, v42, v43
s_add_u32 s34, s22, 1024
buffer_store_dwordx4 v[8:11], v1, s[4:7], s34 offen sc1
v_cvt_pk_bf16_f32 v12, v36, v37
v_cvt_pk_bf16_f32 v13, v38, v39
v_cvt_pk_bf16_f32 v14, v44, v45
v_cvt_pk_bf16_f32 v15, v46, v47
s_add_u32 s34, s22, 7168
buffer_store_dwordx4 v[12:15], v1, s[4:7], s34 offen sc1
v_cvt_pk_bf16_f32 v8, v48, v49
v_cvt_pk_bf16_f32 v9, v50, v51
v_cvt_pk_bf16_f32 v10, v56, v57
v_cvt_pk_bf16_f32 v11, v58, v59
s_add_u32 s34, s22, 2048
buffer_store_dwordx4 v[8:11], v1, s[4:7], s34 offen sc1
v_cvt_pk_bf16_f32 v12, v52, v53
v_cvt_pk_bf16_f32 v13, v54, v55
v_cvt_pk_bf16_f32 v14, v60, v61
v_cvt_pk_bf16_f32 v15, v62, v63
s_add_u32 s34, s22, 8192
buffer_store_dwordx4 v[12:15], v1, s[4:7], s34 offen sc1
s_waitcnt vmcnt(0)
s_barrier
s_add_u32 s17, s17, 1
s_cmp_lt_u32 s17, 64
s_cbranch_scc1 reca_ptop277
s_branch reca_exit1
reca_exit1:
reca_exitb3:
s_endpgm
.globl fin_kernel
.p2align 8
.type fin_kernel,@function
fin_kernel:
s_cmp_ge_u32 s2, 256
s_cbranch_scc1 fin_exit1
s_load_dwordx2 s[8:9], s[0:1], 96
v_lshrrev_b32 v6, 6, v0
v_and_b32 v7, 63, v0
s_and_b32 s13, s2, 7
v_readfirstlane_b32 s12, v6
v_lshlrev_b32 v1, 4, v7
v_add_u32 v2, 0x1000, v1
v_add_u32 v3, 0x2000, v1
s_lshr_b32 s14, s2, 3
s_lshl_b32 s15, s13, 2
s_add_u32 s15, s15, s12
s_waitcnt lgkmcnt(0)
s_mov_b32 s4, s8
s_mov_b32 s5, s9
s_mov_b32 s6, 0x10000000
s_mov_b32 s7, 0x20000
s_mov_b32 s27, 0x3dd53b95
v_and_b32 v6, 15, v7
v_lshrrev_b32 v8, 4, v7
v_mov_b32 v9, 0x80000000
v_lshlrev_b32 v10, 4, v6
v_lshl_add_u32 v10, v8, 7, v10
v_cmp_gt_u32 vcc, 8, v6
s_nop 1
v_cndmask_b32 v4, v9, v10, vcc
v_lshlrev_b32 v10, 3, v7
v_cmp_gt_u32 vcc, 32, v7
s_nop 1
v_cndmask_b32 v5, v9, v10, vcc
v_mov_b32 v10, 0xf149f2ca
v_cmp_le_u32 vcc, 2, v8
s_nop 1
v_cndmask_b32 v12, 0, v10, vcc
v_mov_b32 v13, v12
v_mov_b32 v14, v12
v_mov_b32 v15, v12
v_lshlrev_b32 v11, 2, v8
v_add_u32 v7, 0, v11
v_cmp_gt_u32 vcc, v7, v6
s_nop 1
v_cndmask_b32 v16, 0, v10, vcc
v_add_u32 v7, 1, v11
v_cmp_gt_u32 vcc, v7, v6
s_nop 1
v_cndmask_b32 v17, 0, v10, vcc
v_add_u32 v7, 2, v11
v_cmp_gt_u32 vcc, v7, v6
s_nop 1
v_cndmask_b32 v18, 0, v10, vcc
v_add_u32 v7, 3, v11
v_cmp_gt_u32 vcc, v7, v6
s_nop 1
v_cndmask_b32 v19, 0, v10, vcc
v_mov_b32 v20, 0x3f803f80
v_mov_b32 v21, 0x3f803f80
v_mov_b32 v22, 0x3f803f80
v_mov_b32 v23, 0x3f803f80
s_mul_i32 s16, s12, 6144
v_add_u32 v240, s16, v1
v_add_u32 v241, 49152, v240
s_mul_i32 s16, s12, 10
s_mul_i32 s16, s16, 192
s_mul_i32 s17, s13, 24
s_add_u32 s16, s16, s17
s_lshl_b32 s16, s16, 10
s_add_u32 s16, s16, 29884416
s_add_u32 s30, s16, 0
s_add_u32 s31, s16, 196608
s_add_u32 s32, s16, 393216
s_add_u32 s33, s16, 589824
s_add_u32 s34, s16, 786432
s_add_u32 s35, s16, 983040
s_add_u32 s36, s16, 1179648
s_add_u32 s37, s16, 1376256
s_add_u32 s38, s16, 1572864
s_add_u32 s39, s16, 1769472
s_cmp_lt_u32 s14, 30
s_cbranch_scc1 fin_odma3
s_lshl_b32 s17, s14, 1
s_add_u32 s17, s17, 0
s_and_b32 s17, s17, 7
s_lshl_b32 s16, s15, 3
s_add_u32 s16, s16, s17
s_mul_i32 s16, s16, 12288
s_add_u32 s20, s16, 44040192
s_add_u32 s21, s16, 37748736
s_add_u32 s22, s16, 40894464
s_lshl_b32 s17, s17, 5
s_add_u32 s17, s17, s15
s_mul_i32 s17, s17, 3072
s_add_u32 s23, s17, 47185920
s_add_u32 s24, s17, 47972352
s_lshl_b32 s17, s14, 1
s_add_u32 s17, s17, 1
s_and_b32 s17, s17, 7
s_lshl_b32 s16, s15, 3
s_add_u32 s16, s16, s17
s_mul_i32 s16, s16, 12288
s_add_u32 s40, s16, 44040192
s_add_u32 s41, s16, 37748736
s_add_u32 s42, s16, 40894464
s_lshl_b32 s17, s17, 5
s_add_u32 s17, s17, s15
s_mul_i32 s17, s17, 3072
s_add_u32 s43, s17, 47185920
s_add_u32 s44, s17, 47972352
buffer_load_dwordx4 v[136:139], v1, s[4:7], s21 offen offset:0
buffer_load_dwordx4 v[140:143], v1, s[4:7], s21 offen offset:1024
buffer_load_dwordx4 v[144:147], v1, s[4:7], s21 offen offset:2048
buffer_load_dwordx4 v[148:151], v1, s[4:7], s21 offen offset:3072
buffer_load_dwordx4 v[152:155], v2, s[4:7], s21 offen offset:0
buffer_load_dwordx4 v[156:159], v2, s[4:7], s21 offen offset:1024
buffer_load_dwordx4 v[160:163], v2, s[4:7], s21 offen offset:2048
buffer_load_dwordx4 v[164:167], v2, s[4:7], s21 offen offset:3072
buffer_load_dwordx4 v[168:171], v3, s[4:7], s21 offen offset:0
buffer_load_dwordx4 v[172:175], v3, s[4:7], s21 offen offset:1024
buffer_load_dwordx4 v[176:179], v3, s[4:7], s21 offen offset:2048
buffer_load_dwordx4 v[180:183], v3, s[4:7], s21 offen offset:3072
buffer_load_dwordx4 v[184:187], v4, s[4:7], s23 offen offset:0
buffer_load_dwordx4 v[188:191], v4, s[4:7], s23 offen offset:512
buffer_load_dwordx4 v[192:195], v4, s[4:7], s23 offen offset:1024
buffer_load_dwordx4 v[196:199], v4, s[4:7], s23 offen offset:1536
buffer_load_dwordx4 v[200:203], v4, s[4:7], s23 offen offset:2048
buffer_load_dwordx4 v[204:207], v4, s[4:7], s23 offen offset:2560
buffer_load_dwordx4 v[88:91], v1, s[4:7], s20 offen offset:0
buffer_load_dwordx4 v[92:95], v1, s[4:7], s20 offen offset:1024
buffer_load_dwordx4 v[96:99], v1, s[4:7], s20 offen offset:2048
buffer_load_dwordx4 v[100:103], v1, s[4:7], s20 offen offset:3072
buffer_load_dwordx4 v[104:107], v2, s[4:7], s20 offen offset:0
buffer_load_dwordx4 v[108:111], v2, s[4:7], s20 offen offset:1024
buffer_load_dwordx4 v[112:115], v2, s[4:7], s20 offen offset:2048
buffer_load_dwordx4 v[116:119], v2, s[4:7], s20 offen offset:3072
buffer_load_dwordx4 v[120:123], v3, s[4:7], s20 offen offset:0
buffer_load_dwordx4 v[124:127], v3, s[4:7], s20 offen offset:1024
buffer_load_dwordx4 v[128:131], v3, s[4:7], s20 offen offset:2048
buffer_load_dwordx4 v[132:135], v3, s[4:7], s20 offen offset:3072
buffer_load_dwordx4 a[0:3], v1, s[4:7], s41 offen offset:0
buffer_load_dwordx4 a[4:7], v1, s[4:7], s41 offen offset:1024
buffer_load_dwordx4 a[8:11], v1, s[4:7], s41 offen offset:2048
buffer_load_dwordx4 a[12:15], v1, s[4:7], s41 offen offset:3072
buffer_load_dwordx4 a[16:19], v2, s[4:7], s41 offen offset:0
buffer_load_dwordx4 a[20:23], v2, s[4:7], s41 offen offset:1024
buffer_load_dwordx4 a[24:27], v2, s[4:7], s41 offen offset:2048
buffer_load_dwordx4 a[28:31], v2, s[4:7], s41 offen offset:3072
buffer_load_dwordx4 a[32:35], v3, s[4:7], s41 offen offset:0
buffer_load_dwordx4 a[36:39], v3, s[4:7], s41 offen offset:1024
buffer_load_dwordx4 a[40:43], v3, s[4:7], s41 offen offset:2048
buffer_load_dwordx4 a[44:47], v3, s[4:7], s41 offen offset:3072
buffer_load_dwordx4 a[48:51], v4, s[4:7], s43 offen offset:0
buffer_load_dwordx4 a[52:55], v4, s[4:7], s43 offen offset:512
buffer_load_dwordx4 a[56:59], v4, s[4:7], s43 offen offset:1024
buffer_load_dwordx4 a[60:63], v4, s[4:7], s43 offen offset:1536
buffer_load_dwordx4 a[64:67], v4, s[4:7], s43 offen offset:2048
buffer_load_dwordx4 a[68:71], v4, s[4:7], s43 offen offset:2560
buffer_load_dwordx4 a[72:75], v1, s[4:7], s40 offen offset:0
buffer_load_dwordx4 a[76:79], v1, s[4:7], s40 offen offset:1024
buffer_load_dwordx4 a[80:83], v1, s[4:7], s40 offen offset:2048
buffer_load_dwordx4 a[84:87], v1, s[4:7], s40 offen offset:3072
buffer_load_dwordx4 a[88:91], v2, s[4:7], s40 offen offset:0
buffer_load_dwordx4 a[92:95], v2, s[4:7], s40 offen offset:1024
buffer_load_dwordx4 a[96:99], v2, s[4:7], s40 offen offset:2048
buffer_load_dwordx4 a[100:103], v2, s[4:7], s40 offen offset:3072
buffer_load_dwordx4 a[104:107], v3, s[4:7], s40 offen offset:0
buffer_load_dwordx4 a[108:111], v3, s[4:7], s40 offen offset:1024
buffer_load_dwordx4 a[112:115], v3, s[4:7], s40 offen offset:2048
buffer_load_dwordx4 a[116:119], v3, s[4:7], s40 offen offset:3072
s_waitcnt vmcnt(35)
v_mfma_f32_16x16x32_bf16 v[24:27], v[184:187], v[88:91], v[12:15]
v_mfma_f32_16x16x32_bf16 v[28:31], v[136:139], v[88:91], v[16:19]
v_mfma_f32_16x16x32_bf16 v[32:35], v[184:187], v[112:115], v[12:15]
v_mfma_f32_16x16x32_bf16 v[36:39], v[136:139], v[112:115], 0
v_mfma_f32_16x16x32_bf16 v[40:43], v[160:163], v[112:115], v[16:19]
s_waitcnt vmcnt(34)
v_mfma_f32_16x16x32_bf16 v[24:27], v[188:191], v[92:95], v[24:27]
v_mfma_f32_16x16x32_bf16 v[28:31], v[140:143], v[92:95], v[28:31]
v_mfma_f32_16x16x32_bf16 v[32:35], v[188:191], v[116:119], v[32:35]
v_mfma_f32_16x16x32_bf16 v[36:39], v[140:143], v[116:119], v[36:39]
v_mfma_f32_16x16x32_bf16 v[40:43], v[164:167], v[116:119], v[40:43]
s_waitcnt vmcnt(33)
v_mfma_f32_16x16x32_bf16 v[24:27], v[192:195], v[96:99], v[24:27]
v_mfma_f32_16x16x32_bf16 v[28:31], v[144:147], v[96:99], v[28:31]
v_mfma_f32_16x16x32_bf16 v[32:35], v[192:195], v[120:123], v[32:35]
v_mfma_f32_16x16x32_bf16 v[36:39], v[144:147], v[120:123], v[36:39]
v_mfma_f32_16x16x32_bf16 v[40:43], v[168:171], v[120:123], v[40:43]
s_waitcnt vmcnt(32)
v_mfma_f32_16x16x32_bf16 v[24:27], v[196:199], v[100:103], v[24:27]
v_mfma_f32_16x16x32_bf16 v[28:31], v[148:151], v[100:103], v[28:31]
v_mfma_f32_16x16x32_bf16 v[32:35], v[196:199], v[124:127], v[32:35]
v_mfma_f32_16x16x32_bf16 v[36:39], v[148:151], v[124:127], v[36:39]
v_mfma_f32_16x16x32_bf16 v[40:43], v[172:175], v[124:127], v[40:43]
s_waitcnt vmcnt(31)
v_mfma_f32_16x16x32_bf16 v[24:27], v[200:203], v[104:107], v[24:27]
v_mfma_f32_16x16x32_bf16 v[28:31], v[152:155], v[104:107], v[28:31]
v_mfma_f32_16x16x32_bf16 v[32:35], v[200:203], v[128:131], v[32:35]
v_mfma_f32_16x16x32_bf16 v[36:39], v[152:155], v[128:131], v[36:39]
v_mfma_f32_16x16x32_bf16 v[40:43], v[176:179], v[128:131], v[40:43]
s_waitcnt vmcnt(30)
v_mfma_f32_16x16x32_bf16 v[24:27], v[204:207], v[108:111], v[24:27]
v_mfma_f32_16x16x32_bf16 v[28:31], v[156:159], v[108:111], v[28:31]
v_mfma_f32_16x16x32_bf16 v[32:35], v[204:207], v[132:135], v[32:35]
v_mfma_f32_16x16x32_bf16 v[36:39], v[156:159], v[132:135], v[36:39]
v_mfma_f32_16x16x32_bf16 v[40:43], v[180:183], v[132:135], v[40:43]
buffer_load_dwordx4 v[88:91], v1, s[4:7], s22 offen offset:0
buffer_load_dwordx4 v[92:95], v1, s[4:7], s22 offen offset:1024
buffer_load_dwordx4 v[96:99], v1, s[4:7], s22 offen offset:2048
buffer_load_dwordx4 v[100:103], v1, s[4:7], s22 offen offset:3072
buffer_load_dwordx4 v[104:107], v2, s[4:7], s22 offen offset:0
buffer_load_dwordx4 v[108:111], v2, s[4:7], s22 offen offset:1024
buffer_load_dwordx4 v[112:115], v2, s[4:7], s22 offen offset:2048
buffer_load_dwordx4 v[116:119], v2, s[4:7], s22 offen offset:3072
buffer_load_dwordx4 v[120:123], v3, s[4:7], s22 offen offset:0
buffer_load_dwordx4 v[124:127], v3, s[4:7], s22 offen offset:1024
buffer_load_dwordx4 v[128:131], v3, s[4:7], s22 offen offset:2048
buffer_load_dwordx4 v[132:135], v3, s[4:7], s22 offen offset:3072
buffer_load_dwordx2 v[136:137], v5, s[4:7], s24 offen offset:0
buffer_load_dwordx2 v[138:139], v5, s[4:7], s24 offen offset:256
buffer_load_dwordx2 v[140:141], v5, s[4:7], s24 offen offset:512
buffer_load_dwordx2 v[142:143], v5, s[4:7], s24 offen offset:768
buffer_load_dwordx2 v[144:145], v5, s[4:7], s24 offen offset:1024
buffer_load_dwordx2 v[146:147], v5, s[4:7], s24 offen offset:1280
buffer_load_dwordx2 v[148:149], v5, s[4:7], s24 offen offset:1536
buffer_load_dwordx2 v[150:151], v5, s[4:7], s24 offen offset:1792
buffer_load_dwordx2 v[152:153], v5, s[4:7], s24 offen offset:2048
buffer_load_dwordx2 v[154:155], v5, s[4:7], s24 offen offset:2304
buffer_load_dwordx2 v[156:157], v5, s[4:7], s24 offen offset:2560
buffer_load_dwordx2 v[158:159], v5, s[4:7], s24 offen offset:2816
v_max3_f32 v6, v24, v25, v26
v_max3_f32 v6, v6, v27, v28
v_max3_f32 v6, v6, v29, v30
v_max_f32 v6, v6, v31
v_mov_b32 v7, v6
s_nop 1
v_permlane32_swap_b32 v6, v7
v_max_f32 v6, v6, v7
v_mov_b32 v7, v6
s_nop 1
v_permlane16_swap_b32 v6, v7
v_max_f32 v6, v6, v7
v_mul_f32 v6, s27, v6
v_fma_f32 v24, v24, s27, -v6
v_fma_f32 v25, v25, s27, -v6
v_fma_f32 v26, v26, s27, -v6
v_fma_f32 v27, v27, s27, -v6
v_fma_f32 v28, v28, s27, -v6
v_fma_f32 v29, v29, s27, -v6
v_fma_f32 v30, v30, s27, -v6
v_fma_f32 v31, v31, s27, -v6
v_exp_f32 v24, v24
v_exp_f32 v25, v25
v_exp_f32 v26, v26
v_exp_f32 v27, v27
v_exp_f32 v28, v28
v_exp_f32 v29, v29
v_exp_f32 v30, v30
v_exp_f32 v31, v31
v_max3_f32 v8, v32, v33, v34
v_max3_f32 v8, v8, v35, v36
v_max3_f32 v8, v8, v37, v38
v_max3_f32 v8, v8, v39, v40
v_max3_f32 v8, v8, v41, v42
v_max_f32 v8, v8, v43
v_mov_b32 v10, v8
s_nop 1
v_permlane32_swap_b32 v8, v10
v_max_f32 v8, v8, v10
v_mov_b32 v10, v8
s_nop 1
v_permlane16_swap_b32 v8, v10
v_max_f32 v8, v8, v10
v_mul_f32 v8, s27, v8
v_fma_f32 v32, v32, s27, -v8
v_fma_f32 v33, v33, s27, -v8
v_fma_f32 v34, v34, s27, -v8
v_fma_f32 v35, v35, s27, -v8
v_fma_f32 v36, v36, s27, -v8
v_fma_f32 v37, v37, s27, -v8
v_fma_f32 v38, v38, s27, -v8
v_fma_f32 v39, v39, s27, -v8
v_fma_f32 v40, v40, s27, -v8
v_fma_f32 v41, v41, s27, -v8
v_fma_f32 v42, v42, s27, -v8
v_fma_f32 v43, v43, s27, -v8
v_exp_f32 v32, v32
v_exp_f32 v33, v33
v_exp_f32 v34, v34
v_exp_f32 v35, v35
v_exp_f32 v36, v36
v_exp_f32 v37, v37
v_exp_f32 v38, v38
v_exp_f32 v39, v39
v_exp_f32 v40, v40
v_exp_f32 v41, v41
v_exp_f32 v42, v42
v_exp_f32 v43, v43
v_cvt_pk_bf16_f32 v44, v24, v25
v_cvt_pk_bf16_f32 v45, v26, v27
v_cvt_pk_bf16_f32 v46, v28, v29
v_cvt_pk_bf16_f32 v47, v30, v31
v_cvt_pk_bf16_f32 v48, v32, v33
v_cvt_pk_bf16_f32 v49, v34, v35
v_cvt_pk_bf16_f32 v50, v36, v37
v_cvt_pk_bf16_f32 v51, v38, v39
v_cvt_pk_bf16_f32 v52, v40, v41
v_cvt_pk_bf16_f32 v53, v42, v43
v_mfma_f32_16x16x16_bf16 v[56:59], v[20:21], v[44:45], 0
v_mfma_f32_16x16x16_bf16 v[60:63], v[20:21], v[48:49], 0
v_mfma_f32_16x16x16_bf16 v[56:59], v[20:21], v[46:47], v[56:59]
v_mfma_f32_16x16x32_bf16 v[60:63], v[20:23], v[50:53], v[60:63]
s_nop 6
v_rcp_f32 v10, v56
v_rcp_f32 v11, v60
s_waitcnt vmcnt(0)
v_mfma_f32_16x16x16_bf16 v[64:67], v[136:137], v[44:45], 0
v_mfma_f32_16x16x16_bf16 v[68:71], v[136:137], v[48:49], 0
v_mfma_f32_16x16x16_bf16 v[64:67], v[88:89], v[46:47], v[64:67]
v_mfma_f32_16x16x32_bf16 v[68:71], v[88:91], v[50:53], v[68:71]
v_mfma_f32_16x16x16_bf16 v[72:75], v[138:139], v[44:45], 0
v_mfma_f32_16x16x16_bf16 v[76:79], v[138:139], v[48:49], 0
v_mfma_f32_16x16x16_bf16 v[72:75], v[92:93], v[46:47], v[72:75]
v_mfma_f32_16x16x32_bf16 v[76:79], v[92:95], v[50:53], v[76:79]
s_nop 2
v_mul_f32 v64, v64, v10
v_mul_f32 v65, v65, v10
v_mul_f32 v66, v66, v10
v_mul_f32 v67, v67, v10
v_cvt_pk_bf16_f32 v80, v64, v65
v_cvt_pk_bf16_f32 v81, v66, v67
v_mul_f32 v72, v72, v10
v_mul_f32 v73, v73, v10
v_mul_f32 v74, v74, v10
v_mul_f32 v75, v75, v10
v_cvt_pk_bf16_f32 v82, v72, v73
v_cvt_pk_bf16_f32 v83, v74, v75
ds_write_b128 v240, v[80:83] offset:0
v_mul_f32 v68, v68, v11
v_mul_f32 v69, v69, v11
v_mul_f32 v70, v70, v11
v_mul_f32 v71, v71, v11
v_cvt_pk_bf16_f32 v84, v68, v69
v_cvt_pk_bf16_f32 v85, v70, v71
v_mul_f32 v76, v76, v11
v_mul_f32 v77, v77, v11
v_mul_f32 v78, v78, v11
v_mul_f32 v79, v79, v11
v_cvt_pk_bf16_f32 v86, v76, v77
v_cvt_pk_bf16_f32 v87, v78, v79
ds_write_b128 v240, v[84:87] offset:24576
v_mfma_f32_16x16x16_bf16 v[64:67], v[140:141], v[44:45], 0
v_mfma_f32_16x16x16_bf16 v[68:71], v[140:141], v[48:49], 0
v_mfma_f32_16x16x16_bf16 v[64:67], v[96:97], v[46:47], v[64:67]
v_mfma_f32_16x16x32_bf16 v[68:71], v[96:99], v[50:53], v[68:71]
v_mfma_f32_16x16x16_bf16 v[72:75], v[142:143], v[44:45], 0
v_mfma_f32_16x16x16_bf16 v[76:79], v[142:143], v[48:49], 0
v_mfma_f32_16x16x16_bf16 v[72:75], v[100:101], v[46:47], v[72:75]
v_mfma_f32_16x16x32_bf16 v[76:79], v[100:103], v[50:53], v[76:79]
s_nop 2
v_mul_f32 v64, v64, v10
v_mul_f32 v65, v65, v10
v_mul_f32 v66, v66, v10
v_mul_f32 v67, v67, v10
v_cvt_pk_bf16_f32 v80, v64, v65
v_cvt_pk_bf16_f32 v81, v66, v67
v_mul_f32 v72, v72, v10
v_mul_f32 v73, v73, v10
v_mul_f32 v74, v74, v10
v_mul_f32 v75, v75, v10
v_cvt_pk_bf16_f32 v82, v72, v73
v_cvt_pk_bf16_f32 v83, v74, v75
ds_write_b128 v240, v[80:83] offset:1024
v_mul_f32 v68, v68, v11
v_mul_f32 v69, v69, v11
v_mul_f32 v70, v70, v11
v_mul_f32 v71, v71, v11
v_cvt_pk_bf16_f32 v84, v68, v69
v_cvt_pk_bf16_f32 v85, v70, v71
v_mul_f32 v76, v76, v11
v_mul_f32 v77, v77, v11
v_mul_f32 v78, v78, v11
v_mul_f32 v79, v79, v11
v_cvt_pk_bf16_f32 v86, v76, v77
v_cvt_pk_bf16_f32 v87, v78, v79
ds_write_b128 v240, v[84:87] offset:25600
v_mfma_f32_16x16x16_bf16 v[64:67], v[144:145], v[44:45], 0
v_mfma_f32_16x16x16_bf16 v[68:71], v[144:145], v[48:49], 0
v_mfma_f32_16x16x16_bf16 v[64:67], v[104:105], v[46:47], v[64:67]
v_mfma_f32_16x16x32_bf16 v[68:71], v[104:107], v[50:53], v[68:71]
v_mfma_f32_16x16x16_bf16 v[72:75], v[146:147], v[44:45], 0
v_mfma_f32_16x16x16_bf16 v[76:79], v[146:147], v[48:49], 0
v_mfma_f32_16x16x16_bf16 v[72:75], v[108:109], v[46:47], v[72:75]
v_mfma_f32_16x16x32_bf16 v[76:79], v[108:111], v[50:53], v[76:79]
s_nop 2
v_mul_f32 v64, v64, v10
v_mul_f32 v65, v65, v10
v_mul_f32 v66, v66, v10
v_mul_f32 v67, v67, v10
v_cvt_pk_bf16_f32 v80, v64, v65
v_cvt_pk_bf16_f32 v81, v66, v67
v_mul_f32 v72, v72, v10
v_mul_f32 v73, v73, v10
v_mul_f32 v74, v74, v10
v_mul_f32 v75, v75, v10
v_cvt_pk_bf16_f32 v82, v72, v73
v_cvt_pk_bf16_f32 v83, v74, v75
ds_write_b128 v240, v[80:83] offset:2048
v_mul_f32 v68, v68, v11
v_mul_f32 v69, v69, v11
v_mul_f32 v70, v70, v11
v_mul_f32 v71, v71, v11
v_cvt_pk_bf16_f32 v84, v68, v69
v_cvt_pk_bf16_f32 v85, v70, v71
v_mul_f32 v76, v76, v11
v_mul_f32 v77, v77, v11
v_mul_f32 v78, v78, v11
v_mul_f32 v79, v79, v11
v_cvt_pk_bf16_f32 v86, v76, v77
v_cvt_pk_bf16_f32 v87, v78, v79
ds_write_b128 v240, v[84:87] offset:26624
v_mfma_f32_16x16x16_bf16 v[64:67], v[148:149], v[44:45], 0
v_mfma_f32_16x16x16_bf16 v[68:71], v[148:149], v[48:49], 0
v_mfma_f32_16x16x16_bf16 v[64:67], v[112:113], v[46:47], v[64:67]
v_mfma_f32_16x16x32_bf16 v[68:71], v[112:115], v[50:53], v[68:71]
v_mfma_f32_16x16x16_bf16 v[72:75], v[150:151], v[44:45], 0
v_mfma_f32_16x16x16_bf16 v[76:79], v[150:151], v[48:49], 0
v_mfma_f32_16x16x16_bf16 v[72:75], v[116:117], v[46:47], v[72:75]
v_mfma_f32_16x16x32_bf16 v[76:79], v[116:119], v[50:53], v[76:79]
s_nop 2
v_mul_f32 v64, v64, v10
v_mul_f32 v65, v65, v10
v_mul_f32 v66, v66, v10
v_mul_f32 v67, v67, v10
v_cvt_pk_bf16_f32 v80, v64, v65
v_cvt_pk_bf16_f32 v81, v66, v67
v_mul_f32 v72, v72, v10
v_mul_f32 v73, v73, v10
v_mul_f32 v74, v74, v10
v_mul_f32 v75, v75, v10
v_cvt_pk_bf16_f32 v82, v72, v73
v_cvt_pk_bf16_f32 v83, v74, v75
ds_write_b128 v240, v[80:83] offset:3072
v_mul_f32 v68, v68, v11
v_mul_f32 v69, v69, v11
v_mul_f32 v70, v70, v11
v_mul_f32 v71, v71, v11
v_cvt_pk_bf16_f32 v84, v68, v69
v_cvt_pk_bf16_f32 v85, v70, v71
v_mul_f32 v76, v76, v11
v_mul_f32 v77, v77, v11
v_mul_f32 v78, v78, v11
v_mul_f32 v79, v79, v11
v_cvt_pk_bf16_f32 v86, v76, v77
v_cvt_pk_bf16_f32 v87, v78, v79
ds_write_b128 v240, v[84:87] offset:27648
v_mfma_f32_16x16x16_bf16 v[64:67], v[152:153], v[44:45], 0
v_mfma_f32_16x16x16_bf16 v[68:71], v[152:153], v[48:49], 0
v_mfma_f32_16x16x16_bf16 v[64:67], v[120:121], v[46:47], v[64:67]
v_mfma_f32_16x16x32_bf16 v[68:71], v[120:123], v[50:53], v[68:71]
v_mfma_f32_16x16x16_bf16 v[72:75], v[154:155], v[44:45], 0
v_mfma_f32_16x16x16_bf16 v[76:79], v[154:155], v[48:49], 0
v_mfma_f32_16x16x16_bf16 v[72:75], v[124:125], v[46:47], v[72:75]
v_mfma_f32_16x16x32_bf16 v[76:79], v[124:127], v[50:53], v[76:79]
s_nop 2
v_mul_f32 v64, v64, v10
v_mul_f32 v65, v65, v10
v_mul_f32 v66, v66, v10
v_mul_f32 v67, v67, v10
v_cvt_pk_bf16_f32 v80, v64, v65
v_cvt_pk_bf16_f32 v81, v66, v67
v_mul_f32 v72, v72, v10
v_mul_f32 v73, v73, v10
v_mul_f32 v74, v74, v10
v_mul_f32 v75, v75, v10
v_cvt_pk_bf16_f32 v82, v72, v73
v_cvt_pk_bf16_f32 v83, v74, v75
ds_write_b128 v240, v[80:83] offset:4096
v_mul_f32 v68, v68, v11
v_mul_f32 v69, v69, v11
v_mul_f32 v70, v70, v11
v_mul_f32 v71, v71, v11
v_cvt_pk_bf16_f32 v84, v68, v69
v_cvt_pk_bf16_f32 v85, v70, v71
v_mul_f32 v76, v76, v11
v_mul_f32 v77, v77, v11
v_mul_f32 v78, v78, v11
v_mul_f32 v79, v79, v11
v_cvt_pk_bf16_f32 v86, v76, v77
v_cvt_pk_bf16_f32 v87, v78, v79
ds_write_b128 v240, v[84:87] offset:28672
v_mfma_f32_16x16x16_bf16 v[64:67], v[156:157], v[44:45], 0
v_mfma_f32_16x16x16_bf16 v[68:71], v[156:157], v[48:49], 0
v_mfma_f32_16x16x16_bf16 v[64:67], v[128:129], v[46:47], v[64:67]
v_mfma_f32_16x16x32_bf16 v[68:71], v[128:131], v[50:53], v[68:71]
v_mfma_f32_16x16x16_bf16 v[72:75], v[158:159], v[44:45], 0
v_mfma_f32_16x16x16_bf16 v[76:79], v[158:159], v[48:49], 0
v_mfma_f32_16x16x16_bf16 v[72:75], v[132:133], v[46:47], v[72:75]
v_mfma_f32_16x16x32_bf16 v[76:79], v[132:135], v[50:53], v[76:79]
s_nop 2
v_mul_f32 v64, v64, v10
v_mul_f32 v65, v65, v10
v_mul_f32 v66, v66, v10
v_mul_f32 v67, v67, v10
v_cvt_pk_bf16_f32 v80, v64, v65
v_cvt_pk_bf16_f32 v81, v66, v67
v_mul_f32 v72, v72, v10
v_mul_f32 v73, v73, v10
v_mul_f32 v74, v74, v10
v_mul_f32 v75, v75, v10
v_cvt_pk_bf16_f32 v82, v72, v73
v_cvt_pk_bf16_f32 v83, v74, v75
ds_write_b128 v240, v[80:83] offset:5120
v_mul_f32 v68, v68, v11
v_mul_f32 v69, v69, v11
v_mul_f32 v70, v70, v11
v_mul_f32 v71, v71, v11
v_cvt_pk_bf16_f32 v84, v68, v69
v_cvt_pk_bf16_f32 v85, v70, v71
v_mul_f32 v76, v76, v11
v_mul_f32 v77, v77, v11
v_mul_f32 v78, v78, v11
v_mul_f32 v79, v79, v11
v_cvt_pk_bf16_f32 v86, v76, v77
v_cvt_pk_bf16_f32 v87, v78, v79
ds_write_b128 v240, v[84:87] offset:29696
v_mfma_f32_16x16x32_bf16 v[24:27], a[48:51], a[72:75], v[12:15]
v_mfma_f32_16x16x32_bf16 v[28:31], a[0:3], a[72:75], v[16:19]
v_mfma_f32_16x16x32_bf16 v[32:35], a[48:51], a[96:99], v[12:15]
v_mfma_f32_16x16x32_bf16 v[36:39], a[0:3], a[96:99], 0
v_mfma_f32_16x16x32_bf16 v[40:43], a[24:27], a[96:99], v[16:19]
v_mfma_f32_16x16x32_bf16 v[24:27], a[52:55], a[76:79], v[24:27]
v_mfma_f32_16x16x32_bf16 v[28:31], a[4:7], a[76:79], v[28:31]
v_mfma_f32_16x16x32_bf16 v[32:35], a[52:55], a[100:103], v[32:35]
v_mfma_f32_16x16x32_bf16 v[36:39], a[4:7], a[100:103], v[36:39]
v_mfma_f32_16x16x32_bf16 v[40:43], a[28:31], a[100:103], v[40:43]
v_mfma_f32_16x16x32_bf16 v[24:27], a[56:59], a[80:83], v[24:27]
v_mfma_f32_16x16x32_bf16 v[28:31], a[8:11], a[80:83], v[28:31]
v_mfma_f32_16x16x32_bf16 v[32:35], a[56:59], a[104:107], v[32:35]
v_mfma_f32_16x16x32_bf16 v[36:39], a[8:11], a[104:107], v[36:39]
v_mfma_f32_16x16x32_bf16 v[40:43], a[32:35], a[104:107], v[40:43]
v_mfma_f32_16x16x32_bf16 v[24:27], a[60:63], a[84:87], v[24:27]
v_mfma_f32_16x16x32_bf16 v[28:31], a[12:15], a[84:87], v[28:31]
v_mfma_f32_16x16x32_bf16 v[32:35], a[60:63], a[108:111], v[32:35]
v_mfma_f32_16x16x32_bf16 v[36:39], a[12:15], a[108:111], v[36:39]
v_mfma_f32_16x16x32_bf16 v[40:43], a[36:39], a[108:111], v[40:43]
v_mfma_f32_16x16x32_bf16 v[24:27], a[64:67], a[88:91], v[24:27]
v_mfma_f32_16x16x32_bf16 v[28:31], a[16:19], a[88:91], v[28:31]
v_mfma_f32_16x16x32_bf16 v[32:35], a[64:67], a[112:115], v[32:35]
v_mfma_f32_16x16x32_bf16 v[36:39], a[16:19], a[112:115], v[36:39]
v_mfma_f32_16x16x32_bf16 v[40:43], a[40:43], a[112:115], v[40:43]
v_mfma_f32_16x16x32_bf16 v[24:27], a[68:71], a[92:95], v[24:27]
v_mfma_f32_16x16x32_bf16 v[28:31], a[20:23], a[92:95], v[28:31]
v_mfma_f32_16x16x32_bf16 v[32:35], a[68:71], a[116:119], v[32:35]
v_mfma_f32_16x16x32_bf16 v[36:39], a[20:23], a[116:119], v[36:39]
v_mfma_f32_16x16x32_bf16 v[40:43], a[44:47], a[116:119], v[40:43]
buffer_load_dwordx4 v[88:91], v1, s[4:7], s42 offen offset:0
buffer_load_dwordx4 v[92:95], v1, s[4:7], s42 offen offset:1024
buffer_load_dwordx4 v[96:99], v1, s[4:7], s42 offen offset:2048
buffer_load_dwordx4 v[100:103], v1, s[4:7], s42 offen offset:3072
buffer_load_dwordx4 v[104:107], v2, s[4:7], s42 offen offset:0
buffer_load_dwordx4 v[108:111], v2, s[4:7], s42 offen offset:1024
buffer_load_dwordx4 v[112:115], v2, s[4:7], s42 offen offset:2048
buffer_load_dwordx4 v[116:119], v2, s[4:7], s42 offen offset:3072
buffer_load_dwordx4 v[120:123], v3, s[4:7], s42 offen offset:0
buffer_load_dwordx4 v[124:127], v3, s[4:7], s42 offen offset:1024
buffer_load_dwordx4 v[128:131], v3, s[4:7], s42 offen offset:2048
buffer_load_dwordx4 v[132:135], v3, s[4:7], s42 offen offset:3072
buffer_load_dwordx2 v[136:137], v5, s[4:7], s44 offen offset:0
buffer_load_dwordx2 v[138:139], v5, s[4:7], s44 offen offset:256
buffer_load_dwordx2 v[140:141], v5, s[4:7], s44 offen offset:512
buffer_load_dwordx2 v[142:143], v5, s[4:7], s44 offen offset:768
buffer_load_dwordx2 v[144:145], v5, s[4:7], s44 offen offset:1024
buffer_load_dwordx2 v[146:147], v5, s[4:7], s44 offen offset:1280
buffer_load_dwordx2 v[148:149], v5, s[4:7], s44 offen offset:1536
buffer_load_dwordx2 v[150:151], v5, s[4:7], s44 offen offset:1792
buffer_load_dwordx2 v[152:153], v5, s[4:7], s44 offen offset:2048
buffer_load_dwordx2 v[154:155], v5, s[4:7], s44 offen offset:2304
buffer_load_dwordx2 v[156:157], v5, s[4:7], s44 offen offset:2560
buffer_load_dwordx2 v[158:159], v5, s[4:7], s44 offen offset:2816
v_max3_f32 v6, v24, v25, v26
v_max3_f32 v6, v6, v27, v28
v_max3_f32 v6, v6, v29, v30
v_max_f32 v6, v6, v31
v_mov_b32 v7, v6
s_nop 1
v_permlane32_swap_b32 v6, v7
v_max_f32 v6, v6, v7
v_mov_b32 v7, v6
s_nop 1
v_permlane16_swap_b32 v6, v7
v_max_f32 v6, v6, v7
v_mul_f32 v6, s27, v6
v_fma_f32 v24, v24, s27, -v6
v_fma_f32 v25, v25, s27, -v6
v_fma_f32 v26, v26, s27, -v6
v_fma_f32 v27, v27, s27, -v6
v_fma_f32 v28, v28, s27, -v6
v_fma_f32 v29, v29, s27, -v6
v_fma_f32 v30, v30, s27, -v6
v_fma_f32 v31, v31, s27, -v6
v_exp_f32 v24, v24
v_exp_f32 v25, v25
v_exp_f32 v26, v26
v_exp_f32 v27, v27
v_exp_f32 v28, v28
v_exp_f32 v29, v29
v_exp_f32 v30, v30
v_exp_f32 v31, v31
v_max3_f32 v8, v32, v33, v34
v_max3_f32 v8, v8, v35, v36
v_max3_f32 v8, v8, v37, v38
v_max3_f32 v8, v8, v39, v40
v_max3_f32 v8, v8, v41, v42
v_max_f32 v8, v8, v43
v_mov_b32 v10, v8
s_nop 1
v_permlane32_swap_b32 v8, v10
v_max_f32 v8, v8, v10
v_mov_b32 v10, v8
s_nop 1
v_permlane16_swap_b32 v8, v10
v_max_f32 v8, v8, v10
v_mul_f32 v8, s27, v8
v_fma_f32 v32, v32, s27, -v8
v_fma_f32 v33, v33, s27, -v8
v_fma_f32 v34, v34, s27, -v8
v_fma_f32 v35, v35, s27, -v8
v_fma_f32 v36, v36, s27, -v8
v_fma_f32 v37, v37, s27, -v8
v_fma_f32 v38, v38, s27, -v8
v_fma_f32 v39, v39, s27, -v8
v_fma_f32 v40, v40, s27, -v8
v_fma_f32 v41, v41, s27, -v8
v_fma_f32 v42, v42, s27, -v8
v_fma_f32 v43, v43, s27, -v8
v_exp_f32 v32, v32
v_exp_f32 v33, v33
v_exp_f32 v34, v34
v_exp_f32 v35, v35
v_exp_f32 v36, v36
v_exp_f32 v37, v37
v_exp_f32 v38, v38
v_exp_f32 v39, v39
v_exp_f32 v40, v40
v_exp_f32 v41, v41
v_exp_f32 v42, v42
v_exp_f32 v43, v43
v_cvt_pk_bf16_f32 v44, v24, v25
v_cvt_pk_bf16_f32 v45, v26, v27
v_cvt_pk_bf16_f32 v46, v28, v29
v_cvt_pk_bf16_f32 v47, v30, v31
v_cvt_pk_bf16_f32 v48, v32, v33
v_cvt_pk_bf16_f32 v49, v34, v35
v_cvt_pk_bf16_f32 v50, v36, v37
v_cvt_pk_bf16_f32 v51, v38, v39
v_cvt_pk_bf16_f32 v52, v40, v41
v_cvt_pk_bf16_f32 v53, v42, v43
v_mfma_f32_16x16x16_bf16 v[56:59], v[20:21], v[44:45], 0
v_mfma_f32_16x16x16_bf16 v[60:63], v[20:21], v[48:49], 0
v_mfma_f32_16x16x16_bf16 v[56:59], v[20:21], v[46:47], v[56:59]
v_mfma_f32_16x16x32_bf16 v[60:63], v[20:23], v[50:53], v[60:63]
s_nop 6
v_rcp_f32 v10, v56
v_rcp_f32 v11, v60
s_waitcnt vmcnt(0)
buffer_load_dwordx4 a[160:163], v1, s[4:7], s30 offen offset:0
buffer_load_dwordx4 a[164:167], v1, s[4:7], s31 offen offset:0
buffer_load_dwordx4 a[168:171], v1, s[4:7], s32 offen offset:0
buffer_load_dwordx4 a[172:175], v1, s[4:7], s33 offen offset:0
buffer_load_dwordx4 a[176:179], v1, s[4:7], s34 offen offset:0
buffer_load_dwordx4 a[180:183], v1, s[4:7], s35 offen offset:0
buffer_load_dwordx4 a[184:187], v1, s[4:7], s36 offen offset:0
buffer_load_dwordx4 a[188:191], v1, s[4:7], s37 offen offset:0
buffer_load_dwordx4 a[192:195], v1, s[4:7], s38 offen offset:0
buffer_load_dwordx4 a[196:199], v1, s[4:7], s39 offen offset:0
buffer_load_dwordx4 a[200:203], v1, s[4:7], s30 offen offset:1024
buffer_load_dwordx4 a[204:207], v1, s[4:7], s31 offen offset:1024
buffer_load_dwordx4 a[208:211], v1, s[4:7], s32 offen offset:1024
buffer_load_dwordx4 a[212:215], v1, s[4:7], s33 offen offset:1024
buffer_load_dwordx4 a[216:219], v1, s[4:7], s34 offen offset:1024
buffer_load_dwordx4 a[220:223], v1, s[4:7], s35 offen offset:1024
buffer_load_dwordx4 a[224:227], v1, s[4:7], s36 offen offset:1024
buffer_load_dwordx4 a[228:231], v1, s[4:7], s37 offen offset:1024
buffer_load_dwordx4 a[232:235], v1, s[4:7], s38 offen offset:1024
buffer_load_dwordx4 a[236:239], v1, s[4:7], s39 offen offset:1024
v_mfma_f32_16x16x16_bf16 v[64:67], v[136:137], v[44:45], 0
v_mfma_f32_16x16x16_bf16 v[68:71], v[136:137], v[48:49], 0
v_mfma_f32_16x16x16_bf16 v[64:67], v[88:89], v[46:47], v[64:67]
v_mfma_f32_16x16x32_bf16 v[68:71], v[88:91], v[50:53], v[68:71]
v_mfma_f32_16x16x16_bf16 v[72:75], v[138:139], v[44:45], 0
v_mfma_f32_16x16x16_bf16 v[76:79], v[138:139], v[48:49], 0
v_mfma_f32_16x16x16_bf16 v[72:75], v[92:93], v[46:47], v[72:75]
v_mfma_f32_16x16x32_bf16 v[76:79], v[92:95], v[50:53], v[76:79]
s_nop 2
v_mul_f32 v64, v64, v10
v_mul_f32 v65, v65, v10
v_mul_f32 v66, v66, v10
v_mul_f32 v67, v67, v10
v_cvt_pk_bf16_f32 v80, v64, v65
v_cvt_pk_bf16_f32 v81, v66, v67
v_mul_f32 v72, v72, v10
v_mul_f32 v73, v73, v10
v_mul_f32 v74, v74, v10
v_mul_f32 v75, v75, v10
v_cvt_pk_bf16_f32 v82, v72, v73
v_cvt_pk_bf16_f32 v83, v74, v75
ds_write_b128 v241, v[80:83] offset:0
v_mul_f32 v68, v68, v11
v_mul_f32 v69, v69, v11
v_mul_f32 v70, v70, v11
v_mul_f32 v71, v71, v11
v_cvt_pk_bf16_f32 v84, v68, v69
v_cvt_pk_bf16_f32 v85, v70, v71
v_mul_f32 v76, v76, v11
v_mul_f32 v77, v77, v11
v_mul_f32 v78, v78, v11
v_mul_f32 v79, v79, v11
v_cvt_pk_bf16_f32 v86, v76, v77
v_cvt_pk_bf16_f32 v87, v78, v79
ds_write_b128 v241, v[84:87] offset:24576
v_mfma_f32_16x16x16_bf16 v[64:67], v[140:141], v[44:45], 0
v_mfma_f32_16x16x16_bf16 v[68:71], v[140:141], v[48:49], 0
v_mfma_f32_16x16x16_bf16 v[64:67], v[96:97], v[46:47], v[64:67]
v_mfma_f32_16x16x32_bf16 v[68:71], v[96:99], v[50:53], v[68:71]
v_mfma_f32_16x16x16_bf16 v[72:75], v[142:143], v[44:45], 0
v_mfma_f32_16x16x16_bf16 v[76:79], v[142:143], v[48:49], 0
v_mfma_f32_16x16x16_bf16 v[72:75], v[100:101], v[46:47], v[72:75]
v_mfma_f32_16x16x32_bf16 v[76:79], v[100:103], v[50:53], v[76:79]
s_nop 2
v_mul_f32 v64, v64, v10
v_mul_f32 v65, v65, v10
v_mul_f32 v66, v66, v10
v_mul_f32 v67, v67, v10
v_cvt_pk_bf16_f32 v80, v64, v65
v_cvt_pk_bf16_f32 v81, v66, v67
v_mul_f32 v72, v72, v10
v_mul_f32 v73, v73, v10
v_mul_f32 v74, v74, v10
v_mul_f32 v75, v75, v10
v_cvt_pk_bf16_f32 v82, v72, v73
v_cvt_pk_bf16_f32 v83, v74, v75
ds_write_b128 v241, v[80:83] offset:1024
v_mul_f32 v68, v68, v11
v_mul_f32 v69, v69, v11
v_mul_f32 v70, v70, v11
v_mul_f32 v71, v71, v11
v_cvt_pk_bf16_f32 v84, v68, v69
v_cvt_pk_bf16_f32 v85, v70, v71
v_mul_f32 v76, v76, v11
v_mul_f32 v77, v77, v11
v_mul_f32 v78, v78, v11
v_mul_f32 v79, v79, v11
v_cvt_pk_bf16_f32 v86, v76, v77
v_cvt_pk_bf16_f32 v87, v78, v79
ds_write_b128 v241, v[84:87] offset:25600
v_mfma_f32_16x16x16_bf16 v[64:67], v[144:145], v[44:45], 0
v_mfma_f32_16x16x16_bf16 v[68:71], v[144:145], v[48:49], 0
v_mfma_f32_16x16x16_bf16 v[64:67], v[104:105], v[46:47], v[64:67]
v_mfma_f32_16x16x32_bf16 v[68:71], v[104:107], v[50:53], v[68:71]
v_mfma_f32_16x16x16_bf16 v[72:75], v[146:147], v[44:45], 0
v_mfma_f32_16x16x16_bf16 v[76:79], v[146:147], v[48:49], 0
v_mfma_f32_16x16x16_bf16 v[72:75], v[108:109], v[46:47], v[72:75]
v_mfma_f32_16x16x32_bf16 v[76:79], v[108:111], v[50:53], v[76:79]
s_nop 2
v_mul_f32 v64, v64, v10
v_mul_f32 v65, v65, v10
v_mul_f32 v66, v66, v10
v_mul_f32 v67, v67, v10
v_cvt_pk_bf16_f32 v80, v64, v65
v_cvt_pk_bf16_f32 v81, v66, v67
v_mul_f32 v72, v72, v10
v_mul_f32 v73, v73, v10
v_mul_f32 v74, v74, v10
v_mul_f32 v75, v75, v10
v_cvt_pk_bf16_f32 v82, v72, v73
v_cvt_pk_bf16_f32 v83, v74, v75
ds_write_b128 v241, v[80:83] offset:2048
v_mul_f32 v68, v68, v11
v_mul_f32 v69, v69, v11
v_mul_f32 v70, v70, v11
v_mul_f32 v71, v71, v11
v_cvt_pk_bf16_f32 v84, v68, v69
v_cvt_pk_bf16_f32 v85, v70, v71
v_mul_f32 v76, v76, v11
v_mul_f32 v77, v77, v11
v_mul_f32 v78, v78, v11
v_mul_f32 v79, v79, v11
v_cvt_pk_bf16_f32 v86, v76, v77
v_cvt_pk_bf16_f32 v87, v78, v79
ds_write_b128 v241, v[84:87] offset:26624
v_mfma_f32_16x16x16_bf16 v[64:67], v[148:149], v[44:45], 0
v_mfma_f32_16x16x16_bf16 v[68:71], v[148:149], v[48:49], 0
v_mfma_f32_16x16x16_bf16 v[64:67], v[112:113], v[46:47], v[64:67]
v_mfma_f32_16x16x32_bf16 v[68:71], v[112:115], v[50:53], v[68:71]
v_mfma_f32_16x16x16_bf16 v[72:75], v[150:151], v[44:45], 0
v_mfma_f32_16x16x16_bf16 v[76:79], v[150:151], v[48:49], 0
v_mfma_f32_16x16x16_bf16 v[72:75], v[116:117], v[46:47], v[72:75]
v_mfma_f32_16x16x32_bf16 v[76:79], v[116:119], v[50:53], v[76:79]
s_nop 2
v_mul_f32 v64, v64, v10
v_mul_f32 v65, v65, v10
v_mul_f32 v66, v66, v10
v_mul_f32 v67, v67, v10
v_cvt_pk_bf16_f32 v80, v64, v65
v_cvt_pk_bf16_f32 v81, v66, v67
v_mul_f32 v72, v72, v10
v_mul_f32 v73, v73, v10
v_mul_f32 v74, v74, v10
v_mul_f32 v75, v75, v10
v_cvt_pk_bf16_f32 v82, v72, v73
v_cvt_pk_bf16_f32 v83, v74, v75
ds_write_b128 v241, v[80:83] offset:3072
v_mul_f32 v68, v68, v11
v_mul_f32 v69, v69, v11
v_mul_f32 v70, v70, v11
v_mul_f32 v71, v71, v11
v_cvt_pk_bf16_f32 v84, v68, v69
v_cvt_pk_bf16_f32 v85, v70, v71
v_mul_f32 v76, v76, v11
v_mul_f32 v77, v77, v11
v_mul_f32 v78, v78, v11
v_mul_f32 v79, v79, v11
v_cvt_pk_bf16_f32 v86, v76, v77
v_cvt_pk_bf16_f32 v87, v78, v79
ds_write_b128 v241, v[84:87] offset:27648
v_mfma_f32_16x16x16_bf16 v[64:67], v[152:153], v[44:45], 0
v_mfma_f32_16x16x16_bf16 v[68:71], v[152:153], v[48:49], 0
v_mfma_f32_16x16x16_bf16 v[64:67], v[120:121], v[46:47], v[64:67]
v_mfma_f32_16x16x32_bf16 v[68:71], v[120:123], v[50:53], v[68:71]
v_mfma_f32_16x16x16_bf16 v[72:75], v[154:155], v[44:45], 0
v_mfma_f32_16x16x16_bf16 v[76:79], v[154:155], v[48:49], 0
v_mfma_f32_16x16x16_bf16 v[72:75], v[124:125], v[46:47], v[72:75]
v_mfma_f32_16x16x32_bf16 v[76:79], v[124:127], v[50:53], v[76:79]
s_nop 2
v_mul_f32 v64, v64, v10
v_mul_f32 v65, v65, v10
v_mul_f32 v66, v66, v10
v_mul_f32 v67, v67, v10
v_cvt_pk_bf16_f32 v80, v64, v65
v_cvt_pk_bf16_f32 v81, v66, v67
v_mul_f32 v72, v72, v10
v_mul_f32 v73, v73, v10
v_mul_f32 v74, v74, v10
v_mul_f32 v75, v75, v10
v_cvt_pk_bf16_f32 v82, v72, v73
v_cvt_pk_bf16_f32 v83, v74, v75
ds_write_b128 v241, v[80:83] offset:4096
v_mul_f32 v68, v68, v11
v_mul_f32 v69, v69, v11
v_mul_f32 v70, v70, v11
v_mul_f32 v71, v71, v11
v_cvt_pk_bf16_f32 v84, v68, v69
v_cvt_pk_bf16_f32 v85, v70, v71
v_mul_f32 v76, v76, v11
v_mul_f32 v77, v77, v11
v_mul_f32 v78, v78, v11
v_mul_f32 v79, v79, v11
v_cvt_pk_bf16_f32 v86, v76, v77
v_cvt_pk_bf16_f32 v87, v78, v79
ds_write_b128 v241, v[84:87] offset:28672
v_mfma_f32_16x16x16_bf16 v[64:67], v[156:157], v[44:45], 0
v_mfma_f32_16x16x16_bf16 v[68:71], v[156:157], v[48:49], 0
v_mfma_f32_16x16x16_bf16 v[64:67], v[128:129], v[46:47], v[64:67]
v_mfma_f32_16x16x32_bf16 v[68:71], v[128:131], v[50:53], v[68:71]
v_mfma_f32_16x16x16_bf16 v[72:75], v[158:159], v[44:45], 0
v_mfma_f32_16x16x16_bf16 v[76:79], v[158:159], v[48:49], 0
v_mfma_f32_16x16x16_bf16 v[72:75], v[132:133], v[46:47], v[72:75]
v_mfma_f32_16x16x32_bf16 v[76:79], v[132:135], v[50:53], v[76:79]
s_nop 2
v_mul_f32 v64, v64, v10
v_mul_f32 v65, v65, v10
v_mul_f32 v66, v66, v10
v_mul_f32 v67, v67, v10
v_cvt_pk_bf16_f32 v80, v64, v65
v_cvt_pk_bf16_f32 v81, v66, v67
v_mul_f32 v72, v72, v10
v_mul_f32 v73, v73, v10
v_mul_f32 v74, v74, v10
v_mul_f32 v75, v75, v10
v_cvt_pk_bf16_f32 v82, v72, v73
v_cvt_pk_bf16_f32 v83, v74, v75
ds_write_b128 v241, v[80:83] offset:5120
v_mul_f32 v68, v68, v11
v_mul_f32 v69, v69, v11
v_mul_f32 v70, v70, v11
v_mul_f32 v71, v71, v11
v_cvt_pk_bf16_f32 v84, v68, v69
v_cvt_pk_bf16_f32 v85, v70, v71
v_mul_f32 v76, v76, v11
v_mul_f32 v77, v77, v11
v_mul_f32 v78, v78, v11
v_mul_f32 v79, v79, v11
v_cvt_pk_bf16_f32 v86, v76, v77
v_cvt_pk_bf16_f32 v87, v78, v79
ds_write_b128 v241, v[84:87] offset:29696
s_waitcnt lgkmcnt(0)
buffer_load_dwordx4 v[104:107], v1, s[4:7], s30 offen offset:2048
buffer_load_dwordx4 v[108:111], v1, s[4:7], s31 offen offset:2048
buffer_load_dwordx4 v[112:115], v1, s[4:7], s32 offen offset:2048
buffer_load_dwordx4 v[116:119], v1, s[4:7], s33 offen offset:2048
buffer_load_dwordx4 v[120:123], v1, s[4:7], s34 offen offset:2048
buffer_load_dwordx4 v[124:127], v1, s[4:7], s35 offen offset:2048
buffer_load_dwordx4 v[128:131], v1, s[4:7], s36 offen offset:2048
buffer_load_dwordx4 v[132:135], v1, s[4:7], s37 offen offset:2048
buffer_load_dwordx4 v[136:139], v1, s[4:7], s38 offen offset:2048
buffer_load_dwordx4 v[140:143], v1, s[4:7], s39 offen offset:2048
buffer_load_dwordx4 v[144:147], v1, s[4:7], s30 offen offset:3072
buffer_load_dwordx4 v[148:151], v1, s[4:7], s31 offen offset:3072
buffer_load_dwordx4 v[152:155], v1, s[4:7], s32 offen offset:3072
buffer_load_dwordx4 v[156:159], v1, s[4:7], s33 offen offset:3072
buffer_load_dwordx4 v[160:163], v1, s[4:7], s34 offen offset:3072
buffer_load_dwordx4 v[164:167], v1, s[4:7], s35 offen offset:3072
buffer_load_dwordx4 v[168:171], v1, s[4:7], s36 offen offset:3072
buffer_load_dwordx4 v[172:175], v1, s[4:7], s37 offen offset:3072
buffer_load_dwordx4 v[176:179], v1, s[4:7], s38 offen offset:3072
buffer_load_dwordx4 v[180:183], v1, s[4:7], s39 offen offset:3072
s_add_u32 s30, s30, 4096
s_add_u32 s31, s31, 4096
s_add_u32 s32, s32, 4096
s_add_u32 s33, s33, 4096
s_add_u32 s34, s34, 4096
s_add_u32 s35, s35, 4096
s_add_u32 s36, s36, 4096
s_add_u32 s37, s37, 4096
s_add_u32 s38, s38, 4096
s_add_u32 s39, s39, 4096
v_add_u32 v6, 49152, v1
s_barrier
ds_read_b128 v[184:187], v1 offset:0
ds_read_b128 v[188:191], v1 offset:24576
ds_read_b128 v[192:195], v6 offset:0
ds_read_b128 v[196:199], v6 offset:24576
s_waitcnt vmcnt(30)
ds_read_b128 v[200:203], v1 offset:1024
ds_read_b128 v[204:207], v1 offset:25600
ds_read_b128 v[208:211], v6 offset:1024
ds_read_b128 v[212:215], v6 offset:25600
s_waitcnt lgkmcnt(4)
v_mfma_f32_16x16x32_bf16 a[0:3], a[160:163], v[184:187], 0
v_mfma_f32_16x16x32_bf16 a[4:7], a[160:163], v[188:191], 0
v_mfma_f32_16x16x32_bf16 a[8:11], a[160:163], v[192:195], 0
v_mfma_f32_16x16x32_bf16 a[12:15], a[160:163], v[196:199], 0
v_mfma_f32_16x16x32_bf16 a[16:19], a[164:167], v[184:187], 0
v_mfma_f32_16x16x32_bf16 a[20:23], a[164:167], v[188:191], 0
v_mfma_f32_16x16x32_bf16 a[24:27], a[164:167], v[192:195], 0
v_mfma_f32_16x16x32_bf16 a[28:31], a[164:167], v[196:199], 0
v_mfma_f32_16x16x32_bf16 a[32:35], a[168:171], v[184:187], 0
v_mfma_f32_16x16x32_bf16 a[36:39], a[168:171], v[188:191], 0
v_mfma_f32_16x16x32_bf16 a[40:43], a[168:171], v[192:195], 0
v_mfma_f32_16x16x32_bf16 a[44:47], a[168:171], v[196:199], 0
v_mfma_f32_16x16x32_bf16 a[48:51], a[172:175], v[184:187], 0
v_mfma_f32_16x16x32_bf16 a[52:55], a[172:175], v[188:191], 0
v_mfma_f32_16x16x32_bf16 a[56:59], a[172:175], v[192:195], 0
v_mfma_f32_16x16x32_bf16 a[60:63], a[172:175], v[196:199], 0
v_mfma_f32_16x16x32_bf16 a[64:67], a[176:179], v[184:187], 0
v_mfma_f32_16x16x32_bf16 a[68:71], a[176:179], v[188:191], 0
v_mfma_f32_16x16x32_bf16 a[72:75], a[176:179], v[192:195], 0
v_mfma_f32_16x16x32_bf16 a[76:79], a[176:179], v[196:199], 0
v_mfma_f32_16x16x32_bf16 a[80:83], a[180:183], v[184:187], 0
v_mfma_f32_16x16x32_bf16 a[84:87], a[180:183], v[188:191], 0
v_mfma_f32_16x16x32_bf16 a[88:91], a[180:183], v[192:195], 0
v_mfma_f32_16x16x32_bf16 a[92:95], a[180:183], v[196:199], 0
v_mfma_f32_16x16x32_bf16 a[96:99], a[184:187], v[184:187], 0
v_mfma_f32_16x16x32_bf16 a[100:103], a[184:187], v[188:191], 0
v_mfma_f32_16x16x32_bf16 a[104:107], a[184:187], v[192:195], 0
v_mfma_f32_16x16x32_bf16 a[108:111], a[184:187], v[196:199], 0
v_mfma_f32_16x16x32_bf16 a[112:115], a[188:191], v[184:187], 0
v_mfma_f32_16x16x32_bf16 a[116:119], a[188:191], v[188:191], 0
v_mfma_f32_16x16x32_bf16 a[120:123], a[188:191], v[192:195], 0
v_mfma_f32_16x16x32_bf16 a[124:127], a[188:191], v[196:199], 0
v_mfma_f32_16x16x32_bf16 a[128:131], a[192:195], v[184:187], 0
v_mfma_f32_16x16x32_bf16 a[132:135], a[192:195], v[188:191], 0
v_mfma_f32_16x16x32_bf16 a[136:139], a[192:195], v[192:195], 0
v_mfma_f32_16x16x32_bf16 a[140:143], a[192:195], v[196:199], 0
v_mfma_f32_16x16x32_bf16 a[144:147], a[196:199], v[184:187], 0
v_mfma_f32_16x16x32_bf16 a[148:151], a[196:199], v[188:191], 0
v_mfma_f32_16x16x32_bf16 a[152:155], a[196:199], v[192:195], 0
v_mfma_f32_16x16x32_bf16 a[156:159], a[196:199], v[196:199], 0
buffer_load_dwordx4 v[24:27], v1, s[4:7], s30 offen offset:0
buffer_load_dwordx4 v[28:31], v1, s[4:7], s31 offen offset:0
buffer_load_dwordx4 v[32:35], v1, s[4:7], s32 offen offset:0
buffer_load_dwordx4 v[36:39], v1, s[4:7], s33 offen offset:0
buffer_load_dwordx4 v[40:43], v1, s[4:7], s34 offen offset:0
buffer_load_dwordx4 v[44:47], v1, s[4:7], s35 offen offset:0
buffer_load_dwordx4 v[48:51], v1, s[4:7], s36 offen offset:0
buffer_load_dwordx4 v[52:55], v1, s[4:7], s37 offen offset:0
buffer_load_dwordx4 v[56:59], v1, s[4:7], s38 offen offset:0
buffer_load_dwordx4 v[60:63], v1, s[4:7], s39 offen offset:0
s_waitcnt vmcnt(30)
ds_read_b128 v[184:187], v1 offset:2048
ds_read_b128 v[188:191], v1 offset:26624
ds_read_b128 v[192:195], v6 offset:2048
ds_read_b128 v[196:199], v6 offset:26624
s_waitcnt lgkmcnt(4)
v_mfma_f32_16x16x32_bf16 a[0:3], a[200:203], v[200:203], a[0:3]
v_mfma_f32_16x16x32_bf16 a[4:7], a[200:203], v[204:207], a[4:7]
v_mfma_f32_16x16x32_bf16 a[8:11], a[200:203], v[208:211], a[8:11]
v_mfma_f32_16x16x32_bf16 a[12:15], a[200:203], v[212:215], a[12:15]
v_mfma_f32_16x16x32_bf16 a[16:19], a[204:207], v[200:203], a[16:19]
v_mfma_f32_16x16x32_bf16 a[20:23], a[204:207], v[204:207], a[20:23]
v_mfma_f32_16x16x32_bf16 a[24:27], a[204:207], v[208:211], a[24:27]
v_mfma_f32_16x16x32_bf16 a[28:31], a[204:207], v[212:215], a[28:31]
v_mfma_f32_16x16x32_bf16 a[32:35], a[208:211], v[200:203], a[32:35]
v_mfma_f32_16x16x32_bf16 a[36:39], a[208:211], v[204:207], a[36:39]
v_mfma_f32_16x16x32_bf16 a[40:43], a[208:211], v[208:211], a[40:43]
v_mfma_f32_16x16x32_bf16 a[44:47], a[208:211], v[212:215], a[44:47]
v_mfma_f32_16x16x32_bf16 a[48:51], a[212:215], v[200:203], a[48:51]
v_mfma_f32_16x16x32_bf16 a[52:55], a[212:215], v[204:207], a[52:55]
v_mfma_f32_16x16x32_bf16 a[56:59], a[212:215], v[208:211], a[56:59]
v_mfma_f32_16x16x32_bf16 a[60:63], a[212:215], v[212:215], a[60:63]
v_mfma_f32_16x16x32_bf16 a[64:67], a[216:219], v[200:203], a[64:67]
v_mfma_f32_16x16x32_bf16 a[68:71], a[216:219], v[204:207], a[68:71]
v_mfma_f32_16x16x32_bf16 a[72:75], a[216:219], v[208:211], a[72:75]
v_mfma_f32_16x16x32_bf16 a[76:79], a[216:219], v[212:215], a[76:79]
v_mfma_f32_16x16x32_bf16 a[80:83], a[220:223], v[200:203], a[80:83]
v_mfma_f32_16x16x32_bf16 a[84:87], a[220:223], v[204:207], a[84:87]
v_mfma_f32_16x16x32_bf16 a[88:91], a[220:223], v[208:211], a[88:91]
v_mfma_f32_16x16x32_bf16 a[92:95], a[220:223], v[212:215], a[92:95]
v_mfma_f32_16x16x32_bf16 a[96:99], a[224:227], v[200:203], a[96:99]
v_mfma_f32_16x16x32_bf16 a[100:103], a[224:227], v[204:207], a[100:103]
v_mfma_f32_16x16x32_bf16 a[104:107], a[224:227], v[208:211], a[104:107]
v_mfma_f32_16x16x32_bf16 a[108:111], a[224:227], v[212:215], a[108:111]
v_mfma_f32_16x16x32_bf16 a[112:115], a[228:231], v[200:203], a[112:115]
v_mfma_f32_16x16x32_bf16 a[116:119], a[228:231], v[204:207], a[116:119]
v_mfma_f32_16x16x32_bf16 a[120:123], a[228:231], v[208:211], a[120:123]
v_mfma_f32_16x16x32_bf16 a[124:127], a[228:231], v[212:215], a[124:127]
v_mfma_f32_16x16x32_bf16 a[128:131], a[232:235], v[200:203], a[128:131]
v_mfma_f32_16x16x32_bf16 a[132:135], a[232:235], v[204:207], a[132:135]
v_mfma_f32_16x16x32_bf16 a[136:139], a[232:235], v[208:211], a[136:139]
v_mfma_f32_16x16x32_bf16 a[140:143], a[232:235], v[212:215], a[140:143]
v_mfma_f32_16x16x32_bf16 a[144:147], a[236:239], v[200:203], a[144:147]
v_mfma_f32_16x16x32_bf16 a[148:151], a[236:239], v[204:207], a[148:151]
v_mfma_f32_16x16x32_bf16 a[152:155], a[236:239], v[208:211], a[152:155]
v_mfma_f32_16x16x32_bf16 a[156:159], a[236:239], v[212:215], a[156:159]
buffer_load_dwordx4 v[64:67], v1, s[4:7], s30 offen offset:1024
buffer_load_dwordx4 v[68:71], v1, s[4:7], s31 offen offset:1024
buffer_load_dwordx4 v[72:75], v1, s[4:7], s32 offen offset:1024
buffer_load_dwordx4 v[76:79], v1, s[4:7], s33 offen offset:1024
buffer_load_dwordx4 v[80:83], v1, s[4:7], s34 offen offset:1024
buffer_load_dwordx4 v[84:87], v1, s[4:7], s35 offen offset:1024
buffer_load_dwordx4 v[88:91], v1, s[4:7], s36 offen offset:1024
buffer_load_dwordx4 v[92:95], v1, s[4:7], s37 offen offset:1024
buffer_load_dwordx4 v[96:99], v1, s[4:7], s38 offen offset:1024
buffer_load_dwordx4 v[100:103], v1, s[4:7], s39 offen offset:1024
s_waitcnt vmcnt(30)
ds_read_b128 v[200:203], v1 offset:3072
ds_read_b128 v[204:207], v1 offset:27648
ds_read_b128 v[208:211], v6 offset:3072
ds_read_b128 v[212:215], v6 offset:27648
s_waitcnt lgkmcnt(4)
v_mfma_f32_16x16x32_bf16 a[0:3], v[104:107], v[184:187], a[0:3]
v_mfma_f32_16x16x32_bf16 a[4:7], v[104:107], v[188:191], a[4:7]
v_mfma_f32_16x16x32_bf16 a[8:11], v[104:107], v[192:195], a[8:11]
v_mfma_f32_16x16x32_bf16 a[12:15], v[104:107], v[196:199], a[12:15]
v_mfma_f32_16x16x32_bf16 a[16:19], v[108:111], v[184:187], a[16:19]
v_mfma_f32_16x16x32_bf16 a[20:23], v[108:111], v[188:191], a[20:23]
v_mfma_f32_16x16x32_bf16 a[24:27], v[108:111], v[192:195], a[24:27]
v_mfma_f32_16x16x32_bf16 a[28:31], v[108:111], v[196:199], a[28:31]
v_mfma_f32_16x16x32_bf16 a[32:35], v[112:115], v[184:187], a[32:35]
v_mfma_f32_16x16x32_bf16 a[36:39], v[112:115], v[188:191], a[36:39]
v_mfma_f32_16x16x32_bf16 a[40:43], v[112:115], v[192:195], a[40:43]
v_mfma_f32_16x16x32_bf16 a[44:47], v[112:115], v[196:199], a[44:47]
v_mfma_f32_16x16x32_bf16 a[48:51], v[116:119], v[184:187], a[48:51]
v_mfma_f32_16x16x32_bf16 a[52:55], v[116:119], v[188:191], a[52:55]
v_mfma_f32_16x16x32_bf16 a[56:59], v[116:119], v[192:195], a[56:59]
v_mfma_f32_16x16x32_bf16 a[60:63], v[116:119], v[196:199], a[60:63]
v_mfma_f32_16x16x32_bf16 a[64:67], v[120:123], v[184:187], a[64:67]
v_mfma_f32_16x16x32_bf16 a[68:71], v[120:123], v[188:191], a[68:71]
v_mfma_f32_16x16x32_bf16 a[72:75], v[120:123], v[192:195], a[72:75]
v_mfma_f32_16x16x32_bf16 a[76:79], v[120:123], v[196:199], a[76:79]
v_mfma_f32_16x16x32_bf16 a[80:83], v[124:127], v[184:187], a[80:83]
v_mfma_f32_16x16x32_bf16 a[84:87], v[124:127], v[188:191], a[84:87]
v_mfma_f32_16x16x32_bf16 a[88:91], v[124:127], v[192:195], a[88:91]
v_mfma_f32_16x16x32_bf16 a[92:95], v[124:127], v[196:199], a[92:95]
v_mfma_f32_16x16x32_bf16 a[96:99], v[128:131], v[184:187], a[96:99]
v_mfma_f32_16x16x32_bf16 a[100:103], v[128:131], v[188:191], a[100:103]
v_mfma_f32_16x16x32_bf16 a[104:107], v[128:131], v[192:195], a[104:107]
v_mfma_f32_16x16x32_bf16 a[108:111], v[128:131], v[196:199], a[108:111]
v_mfma_f32_16x16x32_bf16 a[112:115], v[132:135], v[184:187], a[112:115]
v_mfma_f32_16x16x32_bf16 a[116:119], v[132:135], v[188:191], a[116:119]
v_mfma_f32_16x16x32_bf16 a[120:123], v[132:135], v[192:195], a[120:123]
v_mfma_f32_16x16x32_bf16 a[124:127], v[132:135], v[196:199], a[124:127]
v_mfma_f32_16x16x32_bf16 a[128:131], v[136:139], v[184:187], a[128:131]
v_mfma_f32_16x16x32_bf16 a[132:135], v[136:139], v[188:191], a[132:135]
v_mfma_f32_16x16x32_bf16 a[136:139], v[136:139], v[192:195], a[136:139]
v_mfma_f32_16x16x32_bf16 a[140:143], v[136:139], v[196:199], a[140:143]
v_mfma_f32_16x16x32_bf16 a[144:147], v[140:143], v[184:187], a[144:147]
v_mfma_f32_16x16x32_bf16 a[148:151], v[140:143], v[188:191], a[148:151]
v_mfma_f32_16x16x32_bf16 a[152:155], v[140:143], v[192:195], a[152:155]
v_mfma_f32_16x16x32_bf16 a[156:159], v[140:143], v[196:199], a[156:159]
buffer_load_dwordx4 v[104:107], v1, s[4:7], s30 offen offset:2048
buffer_load_dwordx4 v[108:111], v1, s[4:7], s31 offen offset:2048
buffer_load_dwordx4 v[112:115], v1, s[4:7], s32 offen offset:2048
buffer_load_dwordx4 v[116:119], v1, s[4:7], s33 offen offset:2048
buffer_load_dwordx4 v[120:123], v1, s[4:7], s34 offen offset:2048
buffer_load_dwordx4 v[124:127], v1, s[4:7], s35 offen offset:2048
buffer_load_dwordx4 v[128:131], v1, s[4:7], s36 offen offset:2048
buffer_load_dwordx4 v[132:135], v1, s[4:7], s37 offen offset:2048
buffer_load_dwordx4 v[136:139], v1, s[4:7], s38 offen offset:2048
buffer_load_dwordx4 v[140:143], v1, s[4:7], s39 offen offset:2048
s_waitcnt vmcnt(30)
ds_read_b128 v[184:187], v1 offset:4096
ds_read_b128 v[188:191], v1 offset:28672
ds_read_b128 v[192:195], v6 offset:4096
ds_read_b128 v[196:199], v6 offset:28672
s_waitcnt lgkmcnt(4)
v_mfma_f32_16x16x32_bf16 a[0:3], v[144:147], v[200:203], a[0:3]
v_mfma_f32_16x16x32_bf16 a[4:7], v[144:147], v[204:207], a[4:7]
v_mfma_f32_16x16x32_bf16 a[8:11], v[144:147], v[208:211], a[8:11]
v_mfma_f32_16x16x32_bf16 a[12:15], v[144:147], v[212:215], a[12:15]
v_mfma_f32_16x16x32_bf16 a[16:19], v[148:151], v[200:203], a[16:19]
v_mfma_f32_16x16x32_bf16 a[20:23], v[148:151], v[204:207], a[20:23]
v_mfma_f32_16x16x32_bf16 a[24:27], v[148:151], v[208:211], a[24:27]
v_mfma_f32_16x16x32_bf16 a[28:31], v[148:151], v[212:215], a[28:31]
v_mfma_f32_16x16x32_bf16 a[32:35], v[152:155], v[200:203], a[32:35]
v_mfma_f32_16x16x32_bf16 a[36:39], v[152:155], v[204:207], a[36:39]
v_mfma_f32_16x16x32_bf16 a[40:43], v[152:155], v[208:211], a[40:43]
v_mfma_f32_16x16x32_bf16 a[44:47], v[152:155], v[212:215], a[44:47]
v_mfma_f32_16x16x32_bf16 a[48:51], v[156:159], v[200:203], a[48:51]
v_mfma_f32_16x16x32_bf16 a[52:55], v[156:159], v[204:207], a[52:55]
v_mfma_f32_16x16x32_bf16 a[56:59], v[156:159], v[208:211], a[56:59]
v_mfma_f32_16x16x32_bf16 a[60:63], v[156:159], v[212:215], a[60:63]
v_mfma_f32_16x16x32_bf16 a[64:67], v[160:163], v[200:203], a[64:67]
v_mfma_f32_16x16x32_bf16 a[68:71], v[160:163], v[204:207], a[68:71]
v_mfma_f32_16x16x32_bf16 a[72:75], v[160:163], v[208:211], a[72:75]
v_mfma_f32_16x16x32_bf16 a[76:79], v[160:163], v[212:215], a[76:79]
v_mfma_f32_16x16x32_bf16 a[80:83], v[164:167], v[200:203], a[80:83]
v_mfma_f32_16x16x32_bf16 a[84:87], v[164:167], v[204:207], a[84:87]
v_mfma_f32_16x16x32_bf16 a[88:91], v[164:167], v[208:211], a[88:91]
v_mfma_f32_16x16x32_bf16 a[92:95], v[164:167], v[212:215], a[92:95]
v_mfma_f32_16x16x32_bf16 a[96:99], v[168:171], v[200:203], a[96:99]
v_mfma_f32_16x16x32_bf16 a[100:103], v[168:171], v[204:207], a[100:103]
v_mfma_f32_16x16x32_bf16 a[104:107], v[168:171], v[208:211], a[104:107]
v_mfma_f32_16x16x32_bf16 a[108:111], v[168:171], v[212:215], a[108:111]
v_mfma_f32_16x16x32_bf16 a[112:115], v[172:175], v[200:203], a[112:115]
v_mfma_f32_16x16x32_bf16 a[116:119], v[172:175], v[204:207], a[116:119]
v_mfma_f32_16x16x32_bf16 a[120:123], v[172:175], v[208:211], a[120:123]
v_mfma_f32_16x16x32_bf16 a[124:127], v[172:175], v[212:215], a[124:127]
v_mfma_f32_16x16x32_bf16 a[128:131], v[176:179], v[200:203], a[128:131]
v_mfma_f32_16x16x32_bf16 a[132:135], v[176:179], v[204:207], a[132:135]
v_mfma_f32_16x16x32_bf16 a[136:139], v[176:179], v[208:211], a[136:139]
v_mfma_f32_16x16x32_bf16 a[140:143], v[176:179], v[212:215], a[140:143]
v_mfma_f32_16x16x32_bf16 a[144:147], v[180:183], v[200:203], a[144:147]
v_mfma_f32_16x16x32_bf16 a[148:151], v[180:183], v[204:207], a[148:151]
v_mfma_f32_16x16x32_bf16 a[152:155], v[180:183], v[208:211], a[152:155]
v_mfma_f32_16x16x32_bf16 a[156:159], v[180:183], v[212:215], a[156:159]
buffer_load_dwordx4 v[144:147], v1, s[4:7], s30 offen offset:3072
buffer_load_dwordx4 v[148:151], v1, s[4:7], s31 offen offset:3072
buffer_load_dwordx4 v[152:155], v1, s[4:7], s32 offen offset:3072
buffer_load_dwordx4 v[156:159], v1, s[4:7], s33 offen offset:3072
buffer_load_dwordx4 v[160:163], v1, s[4:7], s34 offen offset:3072
buffer_load_dwordx4 v[164:167], v1, s[4:7], s35 offen offset:3072
buffer_load_dwordx4 v[168:171], v1, s[4:7], s36 offen offset:3072
buffer_load_dwordx4 v[172:175], v1, s[4:7], s37 offen offset:3072
buffer_load_dwordx4 v[176:179], v1, s[4:7], s38 offen offset:3072
buffer_load_dwordx4 v[180:183], v1, s[4:7], s39 offen offset:3072
s_add_u32 s30, s30, 4096
s_add_u32 s31, s31, 4096
s_add_u32 s32, s32, 4096
s_add_u32 s33, s33, 4096
s_add_u32 s34, s34, 4096
s_add_u32 s35, s35, 4096
s_add_u32 s36, s36, 4096
s_add_u32 s37, s37, 4096
s_add_u32 s38, s38, 4096
s_add_u32 s39, s39, 4096
s_waitcnt vmcnt(30)
ds_read_b128 v[200:203], v1 offset:5120
ds_read_b128 v[204:207], v1 offset:29696
ds_read_b128 v[208:211], v6 offset:5120
ds_read_b128 v[212:215], v6 offset:29696
s_waitcnt lgkmcnt(4)
v_mfma_f32_16x16x32_bf16 a[0:3], v[24:27], v[184:187], a[0:3]
v_mfma_f32_16x16x32_bf16 a[4:7], v[24:27], v[188:191], a[4:7]
v_mfma_f32_16x16x32_bf16 a[8:11], v[24:27], v[192:195], a[8:11]
v_mfma_f32_16x16x32_bf16 a[12:15], v[24:27], v[196:199], a[12:15]
v_mfma_f32_16x16x32_bf16 a[16:19], v[28:31], v[184:187], a[16:19]
v_mfma_f32_16x16x32_bf16 a[20:23], v[28:31], v[188:191], a[20:23]
v_mfma_f32_16x16x32_bf16 a[24:27], v[28:31], v[192:195], a[24:27]
v_mfma_f32_16x16x32_bf16 a[28:31], v[28:31], v[196:199], a[28:31]
v_mfma_f32_16x16x32_bf16 a[32:35], v[32:35], v[184:187], a[32:35]
v_mfma_f32_16x16x32_bf16 a[36:39], v[32:35], v[188:191], a[36:39]
v_mfma_f32_16x16x32_bf16 a[40:43], v[32:35], v[192:195], a[40:43]
v_mfma_f32_16x16x32_bf16 a[44:47], v[32:35], v[196:199], a[44:47]
v_mfma_f32_16x16x32_bf16 a[48:51], v[36:39], v[184:187], a[48:51]
v_mfma_f32_16x16x32_bf16 a[52:55], v[36:39], v[188:191], a[52:55]
v_mfma_f32_16x16x32_bf16 a[56:59], v[36:39], v[192:195], a[56:59]
v_mfma_f32_16x16x32_bf16 a[60:63], v[36:39], v[196:199], a[60:63]
v_mfma_f32_16x16x32_bf16 a[64:67], v[40:43], v[184:187], a[64:67]
v_mfma_f32_16x16x32_bf16 a[68:71], v[40:43], v[188:191], a[68:71]
v_mfma_f32_16x16x32_bf16 a[72:75], v[40:43], v[192:195], a[72:75]
v_mfma_f32_16x16x32_bf16 a[76:79], v[40:43], v[196:199], a[76:79]
v_mfma_f32_16x16x32_bf16 a[80:83], v[44:47], v[184:187], a[80:83]
v_mfma_f32_16x16x32_bf16 a[84:87], v[44:47], v[188:191], a[84:87]
v_mfma_f32_16x16x32_bf16 a[88:91], v[44:47], v[192:195], a[88:91]
v_mfma_f32_16x16x32_bf16 a[92:95], v[44:47], v[196:199], a[92:95]
v_mfma_f32_16x16x32_bf16 a[96:99], v[48:51], v[184:187], a[96:99]
v_mfma_f32_16x16x32_bf16 a[100:103], v[48:51], v[188:191], a[100:103]
v_mfma_f32_16x16x32_bf16 a[104:107], v[48:51], v[192:195], a[104:107]
v_mfma_f32_16x16x32_bf16 a[108:111], v[48:51], v[196:199], a[108:111]
v_mfma_f32_16x16x32_bf16 a[112:115], v[52:55], v[184:187], a[112:115]
v_mfma_f32_16x16x32_bf16 a[116:119], v[52:55], v[188:191], a[116:119]
v_mfma_f32_16x16x32_bf16 a[120:123], v[52:55], v[192:195], a[120:123]
v_mfma_f32_16x16x32_bf16 a[124:127], v[52:55], v[196:199], a[124:127]
v_mfma_f32_16x16x32_bf16 a[128:131], v[56:59], v[184:187], a[128:131]
v_mfma_f32_16x16x32_bf16 a[132:135], v[56:59], v[188:191], a[132:135]
v_mfma_f32_16x16x32_bf16 a[136:139], v[56:59], v[192:195], a[136:139]
v_mfma_f32_16x16x32_bf16 a[140:143], v[56:59], v[196:199], a[140:143]
v_mfma_f32_16x16x32_bf16 a[144:147], v[60:63], v[184:187], a[144:147]
v_mfma_f32_16x16x32_bf16 a[148:151], v[60:63], v[188:191], a[148:151]
v_mfma_f32_16x16x32_bf16 a[152:155], v[60:63], v[192:195], a[152:155]
v_mfma_f32_16x16x32_bf16 a[156:159], v[60:63], v[196:199], a[156:159]
buffer_load_dwordx4 v[24:27], v1, s[4:7], s30 offen offset:0
buffer_load_dwordx4 v[28:31], v1, s[4:7], s31 offen offset:0
buffer_load_dwordx4 v[32:35], v1, s[4:7], s32 offen offset:0
buffer_load_dwordx4 v[36:39], v1, s[4:7], s33 offen offset:0
buffer_load_dwordx4 v[40:43], v1, s[4:7], s34 offen offset:0
buffer_load_dwordx4 v[44:47], v1, s[4:7], s35 offen offset:0
buffer_load_dwordx4 v[48:51], v1, s[4:7], s36 offen offset:0
buffer_load_dwordx4 v[52:55], v1, s[4:7], s37 offen offset:0
buffer_load_dwordx4 v[56:59], v1, s[4:7], s38 offen offset:0
buffer_load_dwordx4 v[60:63], v1, s[4:7], s39 offen offset:0
s_waitcnt vmcnt(30)
ds_read_b128 v[184:187], v1 offset:6144
ds_read_b128 v[188:191], v1 offset:30720
ds_read_b128 v[192:195], v6 offset:6144
ds_read_b128 v[196:199], v6 offset:30720
s_waitcnt lgkmcnt(4)
v_mfma_f32_16x16x32_bf16 a[0:3], v[64:67], v[200:203], a[0:3]
v_mfma_f32_16x16x32_bf16 a[4:7], v[64:67], v[204:207], a[4:7]
v_mfma_f32_16x16x32_bf16 a[8:11], v[64:67], v[208:211], a[8:11]
v_mfma_f32_16x16x32_bf16 a[12:15], v[64:67], v[212:215], a[12:15]
v_mfma_f32_16x16x32_bf16 a[16:19], v[68:71], v[200:203], a[16:19]
v_mfma_f32_16x16x32_bf16 a[20:23], v[68:71], v[204:207], a[20:23]
v_mfma_f32_16x16x32_bf16 a[24:27], v[68:71], v[208:211], a[24:27]
v_mfma_f32_16x16x32_bf16 a[28:31], v[68:71], v[212:215], a[28:31]
v_mfma_f32_16x16x32_bf16 a[32:35], v[72:75], v[200:203], a[32:35]
v_mfma_f32_16x16x32_bf16 a[36:39], v[72:75], v[204:207], a[36:39]
v_mfma_f32_16x16x32_bf16 a[40:43], v[72:75], v[208:211], a[40:43]
v_mfma_f32_16x16x32_bf16 a[44:47], v[72:75], v[212:215], a[44:47]
v_mfma_f32_16x16x32_bf16 a[48:51], v[76:79], v[200:203], a[48:51]
v_mfma_f32_16x16x32_bf16 a[52:55], v[76:79], v[204:207], a[52:55]
v_mfma_f32_16x16x32_bf16 a[56:59], v[76:79], v[208:211], a[56:59]
v_mfma_f32_16x16x32_bf16 a[60:63], v[76:79], v[212:215], a[60:63]
v_mfma_f32_16x16x32_bf16 a[64:67], v[80:83], v[200:203], a[64:67]
v_mfma_f32_16x16x32_bf16 a[68:71], v[80:83], v[204:207], a[68:71]
v_mfma_f32_16x16x32_bf16 a[72:75], v[80:83], v[208:211], a[72:75]
v_mfma_f32_16x16x32_bf16 a[76:79], v[80:83], v[212:215], a[76:79]
v_mfma_f32_16x16x32_bf16 a[80:83], v[84:87], v[200:203], a[80:83]
v_mfma_f32_16x16x32_bf16 a[84:87], v[84:87], v[204:207], a[84:87]
v_mfma_f32_16x16x32_bf16 a[88:91], v[84:87], v[208:211], a[88:91]
v_mfma_f32_16x16x32_bf16 a[92:95], v[84:87], v[212:215], a[92:95]
v_mfma_f32_16x16x32_bf16 a[96:99], v[88:91], v[200:203], a[96:99]
v_mfma_f32_16x16x32_bf16 a[100:103], v[88:91], v[204:207], a[100:103]
v_mfma_f32_16x16x32_bf16 a[104:107], v[88:91], v[208:211], a[104:107]
v_mfma_f32_16x16x32_bf16 a[108:111], v[88:91], v[212:215], a[108:111]
v_mfma_f32_16x16x32_bf16 a[112:115], v[92:95], v[200:203], a[112:115]
v_mfma_f32_16x16x32_bf16 a[116:119], v[92:95], v[204:207], a[116:119]
v_mfma_f32_16x16x32_bf16 a[120:123], v[92:95], v[208:211], a[120:123]
v_mfma_f32_16x16x32_bf16 a[124:127], v[92:95], v[212:215], a[124:127]
v_mfma_f32_16x16x32_bf16 a[128:131], v[96:99], v[200:203], a[128:131]
v_mfma_f32_16x16x32_bf16 a[132:135], v[96:99], v[204:207], a[132:135]
v_mfma_f32_16x16x32_bf16 a[136:139], v[96:99], v[208:211], a[136:139]
v_mfma_f32_16x16x32_bf16 a[140:143], v[96:99], v[212:215], a[140:143]
v_mfma_f32_16x16x32_bf16 a[144:147], v[100:103], v[200:203], a[144:147]
v_mfma_f32_16x16x32_bf16 a[148:151], v[100:103], v[204:207], a[148:151]
v_mfma_f32_16x16x32_bf16 a[152:155], v[100:103], v[208:211], a[152:155]
v_mfma_f32_16x16x32_bf16 a[156:159], v[100:103], v[212:215], a[156:159]
buffer_load_dwordx4 v[64:67], v1, s[4:7], s30 offen offset:1024
buffer_load_dwordx4 v[68:71], v1, s[4:7], s31 offen offset:1024
buffer_load_dwordx4 v[72:75], v1, s[4:7], s32 offen offset:1024
buffer_load_dwordx4 v[76:79], v1, s[4:7], s33 offen offset:1024
buffer_load_dwordx4 v[80:83], v1, s[4:7], s34 offen offset:1024
buffer_load_dwordx4 v[84:87], v1, s[4:7], s35 offen offset:1024
buffer_load_dwordx4 v[88:91], v1, s[4:7], s36 offen offset:1024
buffer_load_dwordx4 v[92:95], v1, s[4:7], s37 offen offset:1024
buffer_load_dwordx4 v[96:99], v1, s[4:7], s38 offen offset:1024
buffer_load_dwordx4 v[100:103], v1, s[4:7], s39 offen offset:1024
s_waitcnt vmcnt(30)
ds_read_b128 v[200:203], v1 offset:7168
ds_read_b128 v[204:207], v1 offset:31744
ds_read_b128 v[208:211], v6 offset:7168
ds_read_b128 v[212:215], v6 offset:31744
s_waitcnt lgkmcnt(4)
v_mfma_f32_16x16x32_bf16 a[0:3], v[104:107], v[184:187], a[0:3]
v_mfma_f32_16x16x32_bf16 a[4:7], v[104:107], v[188:191], a[4:7]
v_mfma_f32_16x16x32_bf16 a[8:11], v[104:107], v[192:195], a[8:11]
v_mfma_f32_16x16x32_bf16 a[12:15], v[104:107], v[196:199], a[12:15]
v_mfma_f32_16x16x32_bf16 a[16:19], v[108:111], v[184:187], a[16:19]
v_mfma_f32_16x16x32_bf16 a[20:23], v[108:111], v[188:191], a[20:23]
v_mfma_f32_16x16x32_bf16 a[24:27], v[108:111], v[192:195], a[24:27]
v_mfma_f32_16x16x32_bf16 a[28:31], v[108:111], v[196:199], a[28:31]
v_mfma_f32_16x16x32_bf16 a[32:35], v[112:115], v[184:187], a[32:35]
v_mfma_f32_16x16x32_bf16 a[36:39], v[112:115], v[188:191], a[36:39]
v_mfma_f32_16x16x32_bf16 a[40:43], v[112:115], v[192:195], a[40:43]
v_mfma_f32_16x16x32_bf16 a[44:47], v[112:115], v[196:199], a[44:47]
v_mfma_f32_16x16x32_bf16 a[48:51], v[116:119], v[184:187], a[48:51]
v_mfma_f32_16x16x32_bf16 a[52:55], v[116:119], v[188:191], a[52:55]
v_mfma_f32_16x16x32_bf16 a[56:59], v[116:119], v[192:195], a[56:59]
v_mfma_f32_16x16x32_bf16 a[60:63], v[116:119], v[196:199], a[60:63]
v_mfma_f32_16x16x32_bf16 a[64:67], v[120:123], v[184:187], a[64:67]
v_mfma_f32_16x16x32_bf16 a[68:71], v[120:123], v[188:191], a[68:71]
v_mfma_f32_16x16x32_bf16 a[72:75], v[120:123], v[192:195], a[72:75]
v_mfma_f32_16x16x32_bf16 a[76:79], v[120:123], v[196:199], a[76:79]
v_mfma_f32_16x16x32_bf16 a[80:83], v[124:127], v[184:187], a[80:83]
v_mfma_f32_16x16x32_bf16 a[84:87], v[124:127], v[188:191], a[84:87]
v_mfma_f32_16x16x32_bf16 a[88:91], v[124:127], v[192:195], a[88:91]
v_mfma_f32_16x16x32_bf16 a[92:95], v[124:127], v[196:199], a[92:95]
v_mfma_f32_16x16x32_bf16 a[96:99], v[128:131], v[184:187], a[96:99]
v_mfma_f32_16x16x32_bf16 a[100:103], v[128:131], v[188:191], a[100:103]
v_mfma_f32_16x16x32_bf16 a[104:107], v[128:131], v[192:195], a[104:107]
v_mfma_f32_16x16x32_bf16 a[108:111], v[128:131], v[196:199], a[108:111]
v_mfma_f32_16x16x32_bf16 a[112:115], v[132:135], v[184:187], a[112:115]
v_mfma_f32_16x16x32_bf16 a[116:119], v[132:135], v[188:191], a[116:119]
v_mfma_f32_16x16x32_bf16 a[120:123], v[132:135], v[192:195], a[120:123]
v_mfma_f32_16x16x32_bf16 a[124:127], v[132:135], v[196:199], a[124:127]
v_mfma_f32_16x16x32_bf16 a[128:131], v[136:139], v[184:187], a[128:131]
v_mfma_f32_16x16x32_bf16 a[132:135], v[136:139], v[188:191], a[132:135]
v_mfma_f32_16x16x32_bf16 a[136:139], v[136:139], v[192:195], a[136:139]
v_mfma_f32_16x16x32_bf16 a[140:143], v[136:139], v[196:199], a[140:143]
v_mfma_f32_16x16x32_bf16 a[144:147], v[140:143], v[184:187], a[144:147]
v_mfma_f32_16x16x32_bf16 a[148:151], v[140:143], v[188:191], a[148:151]
v_mfma_f32_16x16x32_bf16 a[152:155], v[140:143], v[192:195], a[152:155]
v_mfma_f32_16x16x32_bf16 a[156:159], v[140:143], v[196:199], a[156:159]
buffer_load_dwordx4 v[104:107], v1, s[4:7], s30 offen offset:2048
buffer_load_dwordx4 v[108:111], v1, s[4:7], s31 offen offset:2048
buffer_load_dwordx4 v[112:115], v1, s[4:7], s32 offen offset:2048
buffer_load_dwordx4 v[116:119], v1, s[4:7], s33 offen offset:2048
buffer_load_dwordx4 v[120:123], v1, s[4:7], s34 offen offset:2048
buffer_load_dwordx4 v[124:127], v1, s[4:7], s35 offen offset:2048
buffer_load_dwordx4 v[128:131], v1, s[4:7], s36 offen offset:2048
buffer_load_dwordx4 v[132:135], v1, s[4:7], s37 offen offset:2048
buffer_load_dwordx4 v[136:139], v1, s[4:7], s38 offen offset:2048
buffer_load_dwordx4 v[140:143], v1, s[4:7], s39 offen offset:2048
s_waitcnt vmcnt(30)
ds_read_b128 v[184:187], v1 offset:8192
ds_read_b128 v[188:191], v1 offset:32768
ds_read_b128 v[192:195], v6 offset:8192
ds_read_b128 v[196:199], v6 offset:32768
s_waitcnt lgkmcnt(4)
v_mfma_f32_16x16x32_bf16 a[0:3], v[144:147], v[200:203], a[0:3]
v_mfma_f32_16x16x32_bf16 a[4:7], v[144:147], v[204:207], a[4:7]
v_mfma_f32_16x16x32_bf16 a[8:11], v[144:147], v[208:211], a[8:11]
v_mfma_f32_16x16x32_bf16 a[12:15], v[144:147], v[212:215], a[12:15]
v_mfma_f32_16x16x32_bf16 a[16:19], v[148:151], v[200:203], a[16:19]
v_mfma_f32_16x16x32_bf16 a[20:23], v[148:151], v[204:207], a[20:23]
v_mfma_f32_16x16x32_bf16 a[24:27], v[148:151], v[208:211], a[24:27]
v_mfma_f32_16x16x32_bf16 a[28:31], v[148:151], v[212:215], a[28:31]
v_mfma_f32_16x16x32_bf16 a[32:35], v[152:155], v[200:203], a[32:35]
v_mfma_f32_16x16x32_bf16 a[36:39], v[152:155], v[204:207], a[36:39]
v_mfma_f32_16x16x32_bf16 a[40:43], v[152:155], v[208:211], a[40:43]
v_mfma_f32_16x16x32_bf16 a[44:47], v[152:155], v[212:215], a[44:47]
v_mfma_f32_16x16x32_bf16 a[48:51], v[156:159], v[200:203], a[48:51]
v_mfma_f32_16x16x32_bf16 a[52:55], v[156:159], v[204:207], a[52:55]
v_mfma_f32_16x16x32_bf16 a[56:59], v[156:159], v[208:211], a[56:59]
v_mfma_f32_16x16x32_bf16 a[60:63], v[156:159], v[212:215], a[60:63]
v_mfma_f32_16x16x32_bf16 a[64:67], v[160:163], v[200:203], a[64:67]
v_mfma_f32_16x16x32_bf16 a[68:71], v[160:163], v[204:207], a[68:71]
v_mfma_f32_16x16x32_bf16 a[72:75], v[160:163], v[208:211], a[72:75]
v_mfma_f32_16x16x32_bf16 a[76:79], v[160:163], v[212:215], a[76:79]
v_mfma_f32_16x16x32_bf16 a[80:83], v[164:167], v[200:203], a[80:83]
v_mfma_f32_16x16x32_bf16 a[84:87], v[164:167], v[204:207], a[84:87]
v_mfma_f32_16x16x32_bf16 a[88:91], v[164:167], v[208:211], a[88:91]
v_mfma_f32_16x16x32_bf16 a[92:95], v[164:167], v[212:215], a[92:95]
v_mfma_f32_16x16x32_bf16 a[96:99], v[168:171], v[200:203], a[96:99]
v_mfma_f32_16x16x32_bf16 a[100:103], v[168:171], v[204:207], a[100:103]
v_mfma_f32_16x16x32_bf16 a[104:107], v[168:171], v[208:211], a[104:107]
v_mfma_f32_16x16x32_bf16 a[108:111], v[168:171], v[212:215], a[108:111]
v_mfma_f32_16x16x32_bf16 a[112:115], v[172:175], v[200:203], a[112:115]
v_mfma_f32_16x16x32_bf16 a[116:119], v[172:175], v[204:207], a[116:119]
v_mfma_f32_16x16x32_bf16 a[120:123], v[172:175], v[208:211], a[120:123]
v_mfma_f32_16x16x32_bf16 a[124:127], v[172:175], v[212:215], a[124:127]
v_mfma_f32_16x16x32_bf16 a[128:131], v[176:179], v[200:203], a[128:131]
v_mfma_f32_16x16x32_bf16 a[132:135], v[176:179], v[204:207], a[132:135]
v_mfma_f32_16x16x32_bf16 a[136:139], v[176:179], v[208:211], a[136:139]
v_mfma_f32_16x16x32_bf16 a[140:143], v[176:179], v[212:215], a[140:143]
v_mfma_f32_16x16x32_bf16 a[144:147], v[180:183], v[200:203], a[144:147]
v_mfma_f32_16x16x32_bf16 a[148:151], v[180:183], v[204:207], a[148:151]
v_mfma_f32_16x16x32_bf16 a[152:155], v[180:183], v[208:211], a[152:155]
v_mfma_f32_16x16x32_bf16 a[156:159], v[180:183], v[212:215], a[156:159]
buffer_load_dwordx4 v[144:147], v1, s[4:7], s30 offen offset:3072
buffer_load_dwordx4 v[148:151], v1, s[4:7], s31 offen offset:3072
buffer_load_dwordx4 v[152:155], v1, s[4:7], s32 offen offset:3072
buffer_load_dwordx4 v[156:159], v1, s[4:7], s33 offen offset:3072
buffer_load_dwordx4 v[160:163], v1, s[4:7], s34 offen offset:3072
buffer_load_dwordx4 v[164:167], v1, s[4:7], s35 offen offset:3072
buffer_load_dwordx4 v[168:171], v1, s[4:7], s36 offen offset:3072
buffer_load_dwordx4 v[172:175], v1, s[4:7], s37 offen offset:3072
buffer_load_dwordx4 v[176:179], v1, s[4:7], s38 offen offset:3072
buffer_load_dwordx4 v[180:183], v1, s[4:7], s39 offen offset:3072
s_add_u32 s30, s30, 4096
s_add_u32 s31, s31, 4096
s_add_u32 s32, s32, 4096
s_add_u32 s33, s33, 4096
s_add_u32 s34, s34, 4096
s_add_u32 s35, s35, 4096
s_add_u32 s36, s36, 4096
s_add_u32 s37, s37, 4096
s_add_u32 s38, s38, 4096
s_add_u32 s39, s39, 4096
s_waitcnt vmcnt(30)
ds_read_b128 v[200:203], v1 offset:9216
ds_read_b128 v[204:207], v1 offset:33792
ds_read_b128 v[208:211], v6 offset:9216
ds_read_b128 v[212:215], v6 offset:33792
s_waitcnt lgkmcnt(4)
v_mfma_f32_16x16x32_bf16 a[0:3], v[24:27], v[184:187], a[0:3]
v_mfma_f32_16x16x32_bf16 a[4:7], v[24:27], v[188:191], a[4:7]
v_mfma_f32_16x16x32_bf16 a[8:11], v[24:27], v[192:195], a[8:11]
v_mfma_f32_16x16x32_bf16 a[12:15], v[24:27], v[196:199], a[12:15]
v_mfma_f32_16x16x32_bf16 a[16:19], v[28:31], v[184:187], a[16:19]
v_mfma_f32_16x16x32_bf16 a[20:23], v[28:31], v[188:191], a[20:23]
v_mfma_f32_16x16x32_bf16 a[24:27], v[28:31], v[192:195], a[24:27]
v_mfma_f32_16x16x32_bf16 a[28:31], v[28:31], v[196:199], a[28:31]
v_mfma_f32_16x16x32_bf16 a[32:35], v[32:35], v[184:187], a[32:35]
v_mfma_f32_16x16x32_bf16 a[36:39], v[32:35], v[188:191], a[36:39]
v_mfma_f32_16x16x32_bf16 a[40:43], v[32:35], v[192:195], a[40:43]
v_mfma_f32_16x16x32_bf16 a[44:47], v[32:35], v[196:199], a[44:47]
v_mfma_f32_16x16x32_bf16 a[48:51], v[36:39], v[184:187], a[48:51]
v_mfma_f32_16x16x32_bf16 a[52:55], v[36:39], v[188:191], a[52:55]
v_mfma_f32_16x16x32_bf16 a[56:59], v[36:39], v[192:195], a[56:59]
v_mfma_f32_16x16x32_bf16 a[60:63], v[36:39], v[196:199], a[60:63]
v_mfma_f32_16x16x32_bf16 a[64:67], v[40:43], v[184:187], a[64:67]
v_mfma_f32_16x16x32_bf16 a[68:71], v[40:43], v[188:191], a[68:71]
v_mfma_f32_16x16x32_bf16 a[72:75], v[40:43], v[192:195], a[72:75]
v_mfma_f32_16x16x32_bf16 a[76:79], v[40:43], v[196:199], a[76:79]
v_mfma_f32_16x16x32_bf16 a[80:83], v[44:47], v[184:187], a[80:83]
v_mfma_f32_16x16x32_bf16 a[84:87], v[44:47], v[188:191], a[84:87]
v_mfma_f32_16x16x32_bf16 a[88:91], v[44:47], v[192:195], a[88:91]
v_mfma_f32_16x16x32_bf16 a[92:95], v[44:47], v[196:199], a[92:95]
v_mfma_f32_16x16x32_bf16 a[96:99], v[48:51], v[184:187], a[96:99]
v_mfma_f32_16x16x32_bf16 a[100:103], v[48:51], v[188:191], a[100:103]
v_mfma_f32_16x16x32_bf16 a[104:107], v[48:51], v[192:195], a[104:107]
v_mfma_f32_16x16x32_bf16 a[108:111], v[48:51], v[196:199], a[108:111]
v_mfma_f32_16x16x32_bf16 a[112:115], v[52:55], v[184:187], a[112:115]
v_mfma_f32_16x16x32_bf16 a[116:119], v[52:55], v[188:191], a[116:119]
v_mfma_f32_16x16x32_bf16 a[120:123], v[52:55], v[192:195], a[120:123]
v_mfma_f32_16x16x32_bf16 a[124:127], v[52:55], v[196:199], a[124:127]
v_mfma_f32_16x16x32_bf16 a[128:131], v[56:59], v[184:187], a[128:131]
v_mfma_f32_16x16x32_bf16 a[132:135], v[56:59], v[188:191], a[132:135]
v_mfma_f32_16x16x32_bf16 a[136:139], v[56:59], v[192:195], a[136:139]
v_mfma_f32_16x16x32_bf16 a[140:143], v[56:59], v[196:199], a[140:143]
v_mfma_f32_16x16x32_bf16 a[144:147], v[60:63], v[184:187], a[144:147]
v_mfma_f32_16x16x32_bf16 a[148:151], v[60:63], v[188:191], a[148:151]
v_mfma_f32_16x16x32_bf16 a[152:155], v[60:63], v[192:195], a[152:155]
v_mfma_f32_16x16x32_bf16 a[156:159], v[60:63], v[196:199], a[156:159]
buffer_load_dwordx4 v[24:27], v1, s[4:7], s30 offen offset:0
buffer_load_dwordx4 v[28:31], v1, s[4:7], s31 offen offset:0
buffer_load_dwordx4 v[32:35], v1, s[4:7], s32 offen offset:0
buffer_load_dwordx4 v[36:39], v1, s[4:7], s33 offen offset:0
buffer_load_dwordx4 v[40:43], v1, s[4:7], s34 offen offset:0
buffer_load_dwordx4 v[44:47], v1, s[4:7], s35 offen offset:0
buffer_load_dwordx4 v[48:51], v1, s[4:7], s36 offen offset:0
buffer_load_dwordx4 v[52:55], v1, s[4:7], s37 offen offset:0
buffer_load_dwordx4 v[56:59], v1, s[4:7], s38 offen offset:0
buffer_load_dwordx4 v[60:63], v1, s[4:7], s39 offen offset:0
s_waitcnt vmcnt(30)
ds_read_b128 v[184:187], v1 offset:10240
ds_read_b128 v[188:191], v1 offset:34816
ds_read_b128 v[192:195], v6 offset:10240
ds_read_b128 v[196:199], v6 offset:34816
s_waitcnt lgkmcnt(4)
v_mfma_f32_16x16x32_bf16 a[0:3], v[64:67], v[200:203], a[0:3]
v_mfma_f32_16x16x32_bf16 a[4:7], v[64:67], v[204:207], a[4:7]
v_mfma_f32_16x16x32_bf16 a[8:11], v[64:67], v[208:211], a[8:11]
v_mfma_f32_16x16x32_bf16 a[12:15], v[64:67], v[212:215], a[12:15]
v_mfma_f32_16x16x32_bf16 a[16:19], v[68:71], v[200:203], a[16:19]
v_mfma_f32_16x16x32_bf16 a[20:23], v[68:71], v[204:207], a[20:23]
v_mfma_f32_16x16x32_bf16 a[24:27], v[68:71], v[208:211], a[24:27]
v_mfma_f32_16x16x32_bf16 a[28:31], v[68:71], v[212:215], a[28:31]
v_mfma_f32_16x16x32_bf16 a[32:35], v[72:75], v[200:203], a[32:35]
v_mfma_f32_16x16x32_bf16 a[36:39], v[72:75], v[204:207], a[36:39]
v_mfma_f32_16x16x32_bf16 a[40:43], v[72:75], v[208:211], a[40:43]
v_mfma_f32_16x16x32_bf16 a[44:47], v[72:75], v[212:215], a[44:47]
v_mfma_f32_16x16x32_bf16 a[48:51], v[76:79], v[200:203], a[48:51]
v_mfma_f32_16x16x32_bf16 a[52:55], v[76:79], v[204:207], a[52:55]
v_mfma_f32_16x16x32_bf16 a[56:59], v[76:79], v[208:211], a[56:59]
v_mfma_f32_16x16x32_bf16 a[60:63], v[76:79], v[212:215], a[60:63]
v_mfma_f32_16x16x32_bf16 a[64:67], v[80:83], v[200:203], a[64:67]
v_mfma_f32_16x16x32_bf16 a[68:71], v[80:83], v[204:207], a[68:71]
v_mfma_f32_16x16x32_bf16 a[72:75], v[80:83], v[208:211], a[72:75]
v_mfma_f32_16x16x32_bf16 a[76:79], v[80:83], v[212:215], a[76:79]
v_mfma_f32_16x16x32_bf16 a[80:83], v[84:87], v[200:203], a[80:83]
v_mfma_f32_16x16x32_bf16 a[84:87], v[84:87], v[204:207], a[84:87]
v_mfma_f32_16x16x32_bf16 a[88:91], v[84:87], v[208:211], a[88:91]
v_mfma_f32_16x16x32_bf16 a[92:95], v[84:87], v[212:215], a[92:95]
v_mfma_f32_16x16x32_bf16 a[96:99], v[88:91], v[200:203], a[96:99]
v_mfma_f32_16x16x32_bf16 a[100:103], v[88:91], v[204:207], a[100:103]
v_mfma_f32_16x16x32_bf16 a[104:107], v[88:91], v[208:211], a[104:107]
v_mfma_f32_16x16x32_bf16 a[108:111], v[88:91], v[212:215], a[108:111]
v_mfma_f32_16x16x32_bf16 a[112:115], v[92:95], v[200:203], a[112:115]
v_mfma_f32_16x16x32_bf16 a[116:119], v[92:95], v[204:207], a[116:119]
v_mfma_f32_16x16x32_bf16 a[120:123], v[92:95], v[208:211], a[120:123]
v_mfma_f32_16x16x32_bf16 a[124:127], v[92:95], v[212:215], a[124:127]
v_mfma_f32_16x16x32_bf16 a[128:131], v[96:99], v[200:203], a[128:131]
v_mfma_f32_16x16x32_bf16 a[132:135], v[96:99], v[204:207], a[132:135]
v_mfma_f32_16x16x32_bf16 a[136:139], v[96:99], v[208:211], a[136:139]
v_mfma_f32_16x16x32_bf16 a[140:143], v[96:99], v[212:215], a[140:143]
v_mfma_f32_16x16x32_bf16 a[144:147], v[100:103], v[200:203], a[144:147]
v_mfma_f32_16x16x32_bf16 a[148:151], v[100:103], v[204:207], a[148:151]
v_mfma_f32_16x16x32_bf16 a[152:155], v[100:103], v[208:211], a[152:155]
v_mfma_f32_16x16x32_bf16 a[156:159], v[100:103], v[212:215], a[156:159]
buffer_load_dwordx4 v[64:67], v1, s[4:7], s30 offen offset:1024
buffer_load_dwordx4 v[68:71], v1, s[4:7], s31 offen offset:1024
buffer_load_dwordx4 v[72:75], v1, s[4:7], s32 offen offset:1024
buffer_load_dwordx4 v[76:79], v1, s[4:7], s33 offen offset:1024
buffer_load_dwordx4 v[80:83], v1, s[4:7], s34 offen offset:1024
buffer_load_dwordx4 v[84:87], v1, s[4:7], s35 offen offset:1024
buffer_load_dwordx4 v[88:91], v1, s[4:7], s36 offen offset:1024
buffer_load_dwordx4 v[92:95], v1, s[4:7], s37 offen offset:1024
buffer_load_dwordx4 v[96:99], v1, s[4:7], s38 offen offset:1024
buffer_load_dwordx4 v[100:103], v1, s[4:7], s39 offen offset:1024
s_waitcnt vmcnt(30)
ds_read_b128 v[200:203], v1 offset:11264
ds_read_b128 v[204:207], v1 offset:35840
ds_read_b128 v[208:211], v6 offset:11264
ds_read_b128 v[212:215], v6 offset:35840
s_waitcnt lgkmcnt(4)
v_mfma_f32_16x16x32_bf16 a[0:3], v[104:107], v[184:187], a[0:3]
v_mfma_f32_16x16x32_bf16 a[4:7], v[104:107], v[188:191], a[4:7]
v_mfma_f32_16x16x32_bf16 a[8:11], v[104:107], v[192:195], a[8:11]
v_mfma_f32_16x16x32_bf16 a[12:15], v[104:107], v[196:199], a[12:15]
v_mfma_f32_16x16x32_bf16 a[16:19], v[108:111], v[184:187], a[16:19]
v_mfma_f32_16x16x32_bf16 a[20:23], v[108:111], v[188:191], a[20:23]
v_mfma_f32_16x16x32_bf16 a[24:27], v[108:111], v[192:195], a[24:27]
v_mfma_f32_16x16x32_bf16 a[28:31], v[108:111], v[196:199], a[28:31]
v_mfma_f32_16x16x32_bf16 a[32:35], v[112:115], v[184:187], a[32:35]
v_mfma_f32_16x16x32_bf16 a[36:39], v[112:115], v[188:191], a[36:39]
v_mfma_f32_16x16x32_bf16 a[40:43], v[112:115], v[192:195], a[40:43]
v_mfma_f32_16x16x32_bf16 a[44:47], v[112:115], v[196:199], a[44:47]
v_mfma_f32_16x16x32_bf16 a[48:51], v[116:119], v[184:187], a[48:51]
v_mfma_f32_16x16x32_bf16 a[52:55], v[116:119], v[188:191], a[52:55]
v_mfma_f32_16x16x32_bf16 a[56:59], v[116:119], v[192:195], a[56:59]
v_mfma_f32_16x16x32_bf16 a[60:63], v[116:119], v[196:199], a[60:63]
v_mfma_f32_16x16x32_bf16 a[64:67], v[120:123], v[184:187], a[64:67]
v_mfma_f32_16x16x32_bf16 a[68:71], v[120:123], v[188:191], a[68:71]
v_mfma_f32_16x16x32_bf16 a[72:75], v[120:123], v[192:195], a[72:75]
v_mfma_f32_16x16x32_bf16 a[76:79], v[120:123], v[196:199], a[76:79]
v_mfma_f32_16x16x32_bf16 a[80:83], v[124:127], v[184:187], a[80:83]
v_mfma_f32_16x16x32_bf16 a[84:87], v[124:127], v[188:191], a[84:87]
v_mfma_f32_16x16x32_bf16 a[88:91], v[124:127], v[192:195], a[88:91]
v_mfma_f32_16x16x32_bf16 a[92:95], v[124:127], v[196:199], a[92:95]
v_mfma_f32_16x16x32_bf16 a[96:99], v[128:131], v[184:187], a[96:99]
v_mfma_f32_16x16x32_bf16 a[100:103], v[128:131], v[188:191], a[100:103]
v_mfma_f32_16x16x32_bf16 a[104:107], v[128:131], v[192:195], a[104:107]
v_mfma_f32_16x16x32_bf16 a[108:111], v[128:131], v[196:199], a[108:111]
v_mfma_f32_16x16x32_bf16 a[112:115], v[132:135], v[184:187], a[112:115]
v_mfma_f32_16x16x32_bf16 a[116:119], v[132:135], v[188:191], a[116:119]
v_mfma_f32_16x16x32_bf16 a[120:123], v[132:135], v[192:195], a[120:123]
v_mfma_f32_16x16x32_bf16 a[124:127], v[132:135], v[196:199], a[124:127]
v_mfma_f32_16x16x32_bf16 a[128:131], v[136:139], v[184:187], a[128:131]
v_mfma_f32_16x16x32_bf16 a[132:135], v[136:139], v[188:191], a[132:135]
v_mfma_f32_16x16x32_bf16 a[136:139], v[136:139], v[192:195], a[136:139]
v_mfma_f32_16x16x32_bf16 a[140:143], v[136:139], v[196:199], a[140:143]
v_mfma_f32_16x16x32_bf16 a[144:147], v[140:143], v[184:187], a[144:147]
v_mfma_f32_16x16x32_bf16 a[148:151], v[140:143], v[188:191], a[148:151]
v_mfma_f32_16x16x32_bf16 a[152:155], v[140:143], v[192:195], a[152:155]
v_mfma_f32_16x16x32_bf16 a[156:159], v[140:143], v[196:199], a[156:159]
buffer_load_dwordx4 v[104:107], v1, s[4:7], s30 offen offset:2048
buffer_load_dwordx4 v[108:111], v1, s[4:7], s31 offen offset:2048
buffer_load_dwordx4 v[112:115], v1, s[4:7], s32 offen offset:2048
buffer_load_dwordx4 v[116:119], v1, s[4:7], s33 offen offset:2048
buffer_load_dwordx4 v[120:123], v1, s[4:7], s34 offen offset:2048
buffer_load_dwordx4 v[124:127], v1, s[4:7], s35 offen offset:2048
buffer_load_dwordx4 v[128:131], v1, s[4:7], s36 offen offset:2048
buffer_load_dwordx4 v[132:135], v1, s[4:7], s37 offen offset:2048
buffer_load_dwordx4 v[136:139], v1, s[4:7], s38 offen offset:2048
buffer_load_dwordx4 v[140:143], v1, s[4:7], s39 offen offset:2048
s_waitcnt vmcnt(30)
ds_read_b128 v[184:187], v1 offset:12288
ds_read_b128 v[188:191], v1 offset:36864
ds_read_b128 v[192:195], v6 offset:12288
ds_read_b128 v[196:199], v6 offset:36864
s_waitcnt lgkmcnt(4)
v_mfma_f32_16x16x32_bf16 a[0:3], v[144:147], v[200:203], a[0:3]
v_mfma_f32_16x16x32_bf16 a[4:7], v[144:147], v[204:207], a[4:7]
v_mfma_f32_16x16x32_bf16 a[8:11], v[144:147], v[208:211], a[8:11]
v_mfma_f32_16x16x32_bf16 a[12:15], v[144:147], v[212:215], a[12:15]
v_mfma_f32_16x16x32_bf16 a[16:19], v[148:151], v[200:203], a[16:19]
v_mfma_f32_16x16x32_bf16 a[20:23], v[148:151], v[204:207], a[20:23]
v_mfma_f32_16x16x32_bf16 a[24:27], v[148:151], v[208:211], a[24:27]
v_mfma_f32_16x16x32_bf16 a[28:31], v[148:151], v[212:215], a[28:31]
v_mfma_f32_16x16x32_bf16 a[32:35], v[152:155], v[200:203], a[32:35]
v_mfma_f32_16x16x32_bf16 a[36:39], v[152:155], v[204:207], a[36:39]
v_mfma_f32_16x16x32_bf16 a[40:43], v[152:155], v[208:211], a[40:43]
v_mfma_f32_16x16x32_bf16 a[44:47], v[152:155], v[212:215], a[44:47]
v_mfma_f32_16x16x32_bf16 a[48:51], v[156:159], v[200:203], a[48:51]
v_mfma_f32_16x16x32_bf16 a[52:55], v[156:159], v[204:207], a[52:55]
v_mfma_f32_16x16x32_bf16 a[56:59], v[156:159], v[208:211], a[56:59]
v_mfma_f32_16x16x32_bf16 a[60:63], v[156:159], v[212:215], a[60:63]
v_mfma_f32_16x16x32_bf16 a[64:67], v[160:163], v[200:203], a[64:67]
v_mfma_f32_16x16x32_bf16 a[68:71], v[160:163], v[204:207], a[68:71]
v_mfma_f32_16x16x32_bf16 a[72:75], v[160:163], v[208:211], a[72:75]
v_mfma_f32_16x16x32_bf16 a[76:79], v[160:163], v[212:215], a[76:79]
v_mfma_f32_16x16x32_bf16 a[80:83], v[164:167], v[200:203], a[80:83]
v_mfma_f32_16x16x32_bf16 a[84:87], v[164:167], v[204:207], a[84:87]
v_mfma_f32_16x16x32_bf16 a[88:91], v[164:167], v[208:211], a[88:91]
v_mfma_f32_16x16x32_bf16 a[92:95], v[164:167], v[212:215], a[92:95]
v_mfma_f32_16x16x32_bf16 a[96:99], v[168:171], v[200:203], a[96:99]
v_mfma_f32_16x16x32_bf16 a[100:103], v[168:171], v[204:207], a[100:103]
v_mfma_f32_16x16x32_bf16 a[104:107], v[168:171], v[208:211], a[104:107]
v_mfma_f32_16x16x32_bf16 a[108:111], v[168:171], v[212:215], a[108:111]
v_mfma_f32_16x16x32_bf16 a[112:115], v[172:175], v[200:203], a[112:115]
v_mfma_f32_16x16x32_bf16 a[116:119], v[172:175], v[204:207], a[116:119]
v_mfma_f32_16x16x32_bf16 a[120:123], v[172:175], v[208:211], a[120:123]
v_mfma_f32_16x16x32_bf16 a[124:127], v[172:175], v[212:215], a[124:127]
v_mfma_f32_16x16x32_bf16 a[128:131], v[176:179], v[200:203], a[128:131]
v_mfma_f32_16x16x32_bf16 a[132:135], v[176:179], v[204:207], a[132:135]
v_mfma_f32_16x16x32_bf16 a[136:139], v[176:179], v[208:211], a[136:139]
v_mfma_f32_16x16x32_bf16 a[140:143], v[176:179], v[212:215], a[140:143]
v_mfma_f32_16x16x32_bf16 a[144:147], v[180:183], v[200:203], a[144:147]
v_mfma_f32_16x16x32_bf16 a[148:151], v[180:183], v[204:207], a[148:151]
v_mfma_f32_16x16x32_bf16 a[152:155], v[180:183], v[208:211], a[152:155]
v_mfma_f32_16x16x32_bf16 a[156:159], v[180:183], v[212:215], a[156:159]
buffer_load_dwordx4 v[144:147], v1, s[4:7], s30 offen offset:3072
buffer_load_dwordx4 v[148:151], v1, s[4:7], s31 offen offset:3072
buffer_load_dwordx4 v[152:155], v1, s[4:7], s32 offen offset:3072
buffer_load_dwordx4 v[156:159], v1, s[4:7], s33 offen offset:3072
buffer_load_dwordx4 v[160:163], v1, s[4:7], s34 offen offset:3072
buffer_load_dwordx4 v[164:167], v1, s[4:7], s35 offen offset:3072
buffer_load_dwordx4 v[168:171], v1, s[4:7], s36 offen offset:3072
buffer_load_dwordx4 v[172:175], v1, s[4:7], s37 offen offset:3072
buffer_load_dwordx4 v[176:179], v1, s[4:7], s38 offen offset:3072
buffer_load_dwordx4 v[180:183], v1, s[4:7], s39 offen offset:3072
s_add_u32 s30, s30, 4096
s_add_u32 s31, s31, 4096
s_add_u32 s32, s32, 4096
s_add_u32 s33, s33, 4096
s_add_u32 s34, s34, 4096
s_add_u32 s35, s35, 4096
s_add_u32 s36, s36, 4096
s_add_u32 s37, s37, 4096
s_add_u32 s38, s38, 4096
s_add_u32 s39, s39, 4096
s_waitcnt vmcnt(30)
ds_read_b128 v[200:203], v1 offset:13312
ds_read_b128 v[204:207], v1 offset:37888
ds_read_b128 v[208:211], v6 offset:13312
ds_read_b128 v[212:215], v6 offset:37888
s_waitcnt lgkmcnt(4)
v_mfma_f32_16x16x32_bf16 a[0:3], v[24:27], v[184:187], a[0:3]
v_mfma_f32_16x16x32_bf16 a[4:7], v[24:27], v[188:191], a[4:7]
v_mfma_f32_16x16x32_bf16 a[8:11], v[24:27], v[192:195], a[8:11]
v_mfma_f32_16x16x32_bf16 a[12:15], v[24:27], v[196:199], a[12:15]
v_mfma_f32_16x16x32_bf16 a[16:19], v[28:31], v[184:187], a[16:19]
v_mfma_f32_16x16x32_bf16 a[20:23], v[28:31], v[188:191], a[20:23]
v_mfma_f32_16x16x32_bf16 a[24:27], v[28:31], v[192:195], a[24:27]
v_mfma_f32_16x16x32_bf16 a[28:31], v[28:31], v[196:199], a[28:31]
v_mfma_f32_16x16x32_bf16 a[32:35], v[32:35], v[184:187], a[32:35]
v_mfma_f32_16x16x32_bf16 a[36:39], v[32:35], v[188:191], a[36:39]
v_mfma_f32_16x16x32_bf16 a[40:43], v[32:35], v[192:195], a[40:43]
v_mfma_f32_16x16x32_bf16 a[44:47], v[32:35], v[196:199], a[44:47]
v_mfma_f32_16x16x32_bf16 a[48:51], v[36:39], v[184:187], a[48:51]
v_mfma_f32_16x16x32_bf16 a[52:55], v[36:39], v[188:191], a[52:55]
v_mfma_f32_16x16x32_bf16 a[56:59], v[36:39], v[192:195], a[56:59]
v_mfma_f32_16x16x32_bf16 a[60:63], v[36:39], v[196:199], a[60:63]
v_mfma_f32_16x16x32_bf16 a[64:67], v[40:43], v[184:187], a[64:67]
v_mfma_f32_16x16x32_bf16 a[68:71], v[40:43], v[188:191], a[68:71]
v_mfma_f32_16x16x32_bf16 a[72:75], v[40:43], v[192:195], a[72:75]
v_mfma_f32_16x16x32_bf16 a[76:79], v[40:43], v[196:199], a[76:79]
v_mfma_f32_16x16x32_bf16 a[80:83], v[44:47], v[184:187], a[80:83]
v_mfma_f32_16x16x32_bf16 a[84:87], v[44:47], v[188:191], a[84:87]
v_mfma_f32_16x16x32_bf16 a[88:91], v[44:47], v[192:195], a[88:91]
v_mfma_f32_16x16x32_bf16 a[92:95], v[44:47], v[196:199], a[92:95]
v_mfma_f32_16x16x32_bf16 a[96:99], v[48:51], v[184:187], a[96:99]
v_mfma_f32_16x16x32_bf16 a[100:103], v[48:51], v[188:191], a[100:103]
v_mfma_f32_16x16x32_bf16 a[104:107], v[48:51], v[192:195], a[104:107]
v_mfma_f32_16x16x32_bf16 a[108:111], v[48:51], v[196:199], a[108:111]
v_mfma_f32_16x16x32_bf16 a[112:115], v[52:55], v[184:187], a[112:115]
v_mfma_f32_16x16x32_bf16 a[116:119], v[52:55], v[188:191], a[116:119]
v_mfma_f32_16x16x32_bf16 a[120:123], v[52:55], v[192:195], a[120:123]
v_mfma_f32_16x16x32_bf16 a[124:127], v[52:55], v[196:199], a[124:127]
v_mfma_f32_16x16x32_bf16 a[128:131], v[56:59], v[184:187], a[128:131]
v_mfma_f32_16x16x32_bf16 a[132:135], v[56:59], v[188:191], a[132:135]
v_mfma_f32_16x16x32_bf16 a[136:139], v[56:59], v[192:195], a[136:139]
v_mfma_f32_16x16x32_bf16 a[140:143], v[56:59], v[196:199], a[140:143]
v_mfma_f32_16x16x32_bf16 a[144:147], v[60:63], v[184:187], a[144:147]
v_mfma_f32_16x16x32_bf16 a[148:151], v[60:63], v[188:191], a[148:151]
v_mfma_f32_16x16x32_bf16 a[152:155], v[60:63], v[192:195], a[152:155]
v_mfma_f32_16x16x32_bf16 a[156:159], v[60:63], v[196:199], a[156:159]
buffer_load_dwordx4 v[24:27], v1, s[4:7], s30 offen offset:0
buffer_load_dwordx4 v[28:31], v1, s[4:7], s31 offen offset:0
buffer_load_dwordx4 v[32:35], v1, s[4:7], s32 offen offset:0
buffer_load_dwordx4 v[36:39], v1, s[4:7], s33 offen offset:0
buffer_load_dwordx4 v[40:43], v1, s[4:7], s34 offen offset:0
buffer_load_dwordx4 v[44:47], v1, s[4:7], s35 offen offset:0
buffer_load_dwordx4 v[48:51], v1, s[4:7], s36 offen offset:0
buffer_load_dwordx4 v[52:55], v1, s[4:7], s37 offen offset:0
buffer_load_dwordx4 v[56:59], v1, s[4:7], s38 offen offset:0
buffer_load_dwordx4 v[60:63], v1, s[4:7], s39 offen offset:0
s_waitcnt vmcnt(30)
ds_read_b128 v[184:187], v1 offset:14336
ds_read_b128 v[188:191], v1 offset:38912
ds_read_b128 v[192:195], v6 offset:14336
ds_read_b128 v[196:199], v6 offset:38912
s_waitcnt lgkmcnt(4)
v_mfma_f32_16x16x32_bf16 a[0:3], v[64:67], v[200:203], a[0:3]
v_mfma_f32_16x16x32_bf16 a[4:7], v[64:67], v[204:207], a[4:7]
v_mfma_f32_16x16x32_bf16 a[8:11], v[64:67], v[208:211], a[8:11]
v_mfma_f32_16x16x32_bf16 a[12:15], v[64:67], v[212:215], a[12:15]
v_mfma_f32_16x16x32_bf16 a[16:19], v[68:71], v[200:203], a[16:19]
v_mfma_f32_16x16x32_bf16 a[20:23], v[68:71], v[204:207], a[20:23]
v_mfma_f32_16x16x32_bf16 a[24:27], v[68:71], v[208:211], a[24:27]
v_mfma_f32_16x16x32_bf16 a[28:31], v[68:71], v[212:215], a[28:31]
v_mfma_f32_16x16x32_bf16 a[32:35], v[72:75], v[200:203], a[32:35]
v_mfma_f32_16x16x32_bf16 a[36:39], v[72:75], v[204:207], a[36:39]
v_mfma_f32_16x16x32_bf16 a[40:43], v[72:75], v[208:211], a[40:43]
v_mfma_f32_16x16x32_bf16 a[44:47], v[72:75], v[212:215], a[44:47]
v_mfma_f32_16x16x32_bf16 a[48:51], v[76:79], v[200:203], a[48:51]
v_mfma_f32_16x16x32_bf16 a[52:55], v[76:79], v[204:207], a[52:55]
v_mfma_f32_16x16x32_bf16 a[56:59], v[76:79], v[208:211], a[56:59]
v_mfma_f32_16x16x32_bf16 a[60:63], v[76:79], v[212:215], a[60:63]
v_mfma_f32_16x16x32_bf16 a[64:67], v[80:83], v[200:203], a[64:67]
v_mfma_f32_16x16x32_bf16 a[68:71], v[80:83], v[204:207], a[68:71]
v_mfma_f32_16x16x32_bf16 a[72:75], v[80:83], v[208:211], a[72:75]
v_mfma_f32_16x16x32_bf16 a[76:79], v[80:83], v[212:215], a[76:79]
v_mfma_f32_16x16x32_bf16 a[80:83], v[84:87], v[200:203], a[80:83]
v_mfma_f32_16x16x32_bf16 a[84:87], v[84:87], v[204:207], a[84:87]
v_mfma_f32_16x16x32_bf16 a[88:91], v[84:87], v[208:211], a[88:91]
v_mfma_f32_16x16x32_bf16 a[92:95], v[84:87], v[212:215], a[92:95]
v_mfma_f32_16x16x32_bf16 a[96:99], v[88:91], v[200:203], a[96:99]
v_mfma_f32_16x16x32_bf16 a[100:103], v[88:91], v[204:207], a[100:103]
v_mfma_f32_16x16x32_bf16 a[104:107], v[88:91], v[208:211], a[104:107]
v_mfma_f32_16x16x32_bf16 a[108:111], v[88:91], v[212:215], a[108:111]
v_mfma_f32_16x16x32_bf16 a[112:115], v[92:95], v[200:203], a[112:115]
v_mfma_f32_16x16x32_bf16 a[116:119], v[92:95], v[204:207], a[116:119]
v_mfma_f32_16x16x32_bf16 a[120:123], v[92:95], v[208:211], a[120:123]
v_mfma_f32_16x16x32_bf16 a[124:127], v[92:95], v[212:215], a[124:127]
v_mfma_f32_16x16x32_bf16 a[128:131], v[96:99], v[200:203], a[128:131]
v_mfma_f32_16x16x32_bf16 a[132:135], v[96:99], v[204:207], a[132:135]
v_mfma_f32_16x16x32_bf16 a[136:139], v[96:99], v[208:211], a[136:139]
v_mfma_f32_16x16x32_bf16 a[140:143], v[96:99], v[212:215], a[140:143]
v_mfma_f32_16x16x32_bf16 a[144:147], v[100:103], v[200:203], a[144:147]
v_mfma_f32_16x16x32_bf16 a[148:151], v[100:103], v[204:207], a[148:151]
v_mfma_f32_16x16x32_bf16 a[152:155], v[100:103], v[208:211], a[152:155]
v_mfma_f32_16x16x32_bf16 a[156:159], v[100:103], v[212:215], a[156:159]
buffer_load_dwordx4 v[64:67], v1, s[4:7], s30 offen offset:1024
buffer_load_dwordx4 v[68:71], v1, s[4:7], s31 offen offset:1024
buffer_load_dwordx4 v[72:75], v1, s[4:7], s32 offen offset:1024
buffer_load_dwordx4 v[76:79], v1, s[4:7], s33 offen offset:1024
buffer_load_dwordx4 v[80:83], v1, s[4:7], s34 offen offset:1024
buffer_load_dwordx4 v[84:87], v1, s[4:7], s35 offen offset:1024
buffer_load_dwordx4 v[88:91], v1, s[4:7], s36 offen offset:1024
buffer_load_dwordx4 v[92:95], v1, s[4:7], s37 offen offset:1024
buffer_load_dwordx4 v[96:99], v1, s[4:7], s38 offen offset:1024
buffer_load_dwordx4 v[100:103], v1, s[4:7], s39 offen offset:1024
s_waitcnt vmcnt(30)
ds_read_b128 v[200:203], v1 offset:15360
ds_read_b128 v[204:207], v1 offset:39936
ds_read_b128 v[208:211], v6 offset:15360
ds_read_b128 v[212:215], v6 offset:39936
s_waitcnt lgkmcnt(4)
v_mfma_f32_16x16x32_bf16 a[0:3], v[104:107], v[184:187], a[0:3]
v_mfma_f32_16x16x32_bf16 a[4:7], v[104:107], v[188:191], a[4:7]
v_mfma_f32_16x16x32_bf16 a[8:11], v[104:107], v[192:195], a[8:11]
v_mfma_f32_16x16x32_bf16 a[12:15], v[104:107], v[196:199], a[12:15]
v_mfma_f32_16x16x32_bf16 a[16:19], v[108:111], v[184:187], a[16:19]
v_mfma_f32_16x16x32_bf16 a[20:23], v[108:111], v[188:191], a[20:23]
v_mfma_f32_16x16x32_bf16 a[24:27], v[108:111], v[192:195], a[24:27]
v_mfma_f32_16x16x32_bf16 a[28:31], v[108:111], v[196:199], a[28:31]
v_mfma_f32_16x16x32_bf16 a[32:35], v[112:115], v[184:187], a[32:35]
v_mfma_f32_16x16x32_bf16 a[36:39], v[112:115], v[188:191], a[36:39]
v_mfma_f32_16x16x32_bf16 a[40:43], v[112:115], v[192:195], a[40:43]
v_mfma_f32_16x16x32_bf16 a[44:47], v[112:115], v[196:199], a[44:47]
v_mfma_f32_16x16x32_bf16 a[48:51], v[116:119], v[184:187], a[48:51]
v_mfma_f32_16x16x32_bf16 a[52:55], v[116:119], v[188:191], a[52:55]
v_mfma_f32_16x16x32_bf16 a[56:59], v[116:119], v[192:195], a[56:59]
v_mfma_f32_16x16x32_bf16 a[60:63], v[116:119], v[196:199], a[60:63]
v_mfma_f32_16x16x32_bf16 a[64:67], v[120:123], v[184:187], a[64:67]
v_mfma_f32_16x16x32_bf16 a[68:71], v[120:123], v[188:191], a[68:71]
v_mfma_f32_16x16x32_bf16 a[72:75], v[120:123], v[192:195], a[72:75]
v_mfma_f32_16x16x32_bf16 a[76:79], v[120:123], v[196:199], a[76:79]
v_mfma_f32_16x16x32_bf16 a[80:83], v[124:127], v[184:187], a[80:83]
v_mfma_f32_16x16x32_bf16 a[84:87], v[124:127], v[188:191], a[84:87]
v_mfma_f32_16x16x32_bf16 a[88:91], v[124:127], v[192:195], a[88:91]
v_mfma_f32_16x16x32_bf16 a[92:95], v[124:127], v[196:199], a[92:95]
v_mfma_f32_16x16x32_bf16 a[96:99], v[128:131], v[184:187], a[96:99]
v_mfma_f32_16x16x32_bf16 a[100:103], v[128:131], v[188:191], a[100:103]
v_mfma_f32_16x16x32_bf16 a[104:107], v[128:131], v[192:195], a[104:107]
v_mfma_f32_16x16x32_bf16 a[108:111], v[128:131], v[196:199], a[108:111]
v_mfma_f32_16x16x32_bf16 a[112:115], v[132:135], v[184:187], a[112:115]
v_mfma_f32_16x16x32_bf16 a[116:119], v[132:135], v[188:191], a[116:119]
v_mfma_f32_16x16x32_bf16 a[120:123], v[132:135], v[192:195], a[120:123]
v_mfma_f32_16x16x32_bf16 a[124:127], v[132:135], v[196:199], a[124:127]
v_mfma_f32_16x16x32_bf16 a[128:131], v[136:139], v[184:187], a[128:131]
v_mfma_f32_16x16x32_bf16 a[132:135], v[136:139], v[188:191], a[132:135]
v_mfma_f32_16x16x32_bf16 a[136:139], v[136:139], v[192:195], a[136:139]
v_mfma_f32_16x16x32_bf16 a[140:143], v[136:139], v[196:199], a[140:143]
v_mfma_f32_16x16x32_bf16 a[144:147], v[140:143], v[184:187], a[144:147]
v_mfma_f32_16x16x32_bf16 a[148:151], v[140:143], v[188:191], a[148:151]
v_mfma_f32_16x16x32_bf16 a[152:155], v[140:143], v[192:195], a[152:155]
v_mfma_f32_16x16x32_bf16 a[156:159], v[140:143], v[196:199], a[156:159]
buffer_load_dwordx4 v[104:107], v1, s[4:7], s30 offen offset:2048
buffer_load_dwordx4 v[108:111], v1, s[4:7], s31 offen offset:2048
buffer_load_dwordx4 v[112:115], v1, s[4:7], s32 offen offset:2048
buffer_load_dwordx4 v[116:119], v1, s[4:7], s33 offen offset:2048
buffer_load_dwordx4 v[120:123], v1, s[4:7], s34 offen offset:2048
buffer_load_dwordx4 v[124:127], v1, s[4:7], s35 offen offset:2048
buffer_load_dwordx4 v[128:131], v1, s[4:7], s36 offen offset:2048
buffer_load_dwordx4 v[132:135], v1, s[4:7], s37 offen offset:2048
buffer_load_dwordx4 v[136:139], v1, s[4:7], s38 offen offset:2048
buffer_load_dwordx4 v[140:143], v1, s[4:7], s39 offen offset:2048
s_waitcnt vmcnt(30)
ds_read_b128 v[184:187], v1 offset:16384
ds_read_b128 v[188:191], v1 offset:40960
ds_read_b128 v[192:195], v6 offset:16384
ds_read_b128 v[196:199], v6 offset:40960
s_waitcnt lgkmcnt(4)
v_mfma_f32_16x16x32_bf16 a[0:3], v[144:147], v[200:203], a[0:3]
v_mfma_f32_16x16x32_bf16 a[4:7], v[144:147], v[204:207], a[4:7]
v_mfma_f32_16x16x32_bf16 a[8:11], v[144:147], v[208:211], a[8:11]
v_mfma_f32_16x16x32_bf16 a[12:15], v[144:147], v[212:215], a[12:15]
v_mfma_f32_16x16x32_bf16 a[16:19], v[148:151], v[200:203], a[16:19]
v_mfma_f32_16x16x32_bf16 a[20:23], v[148:151], v[204:207], a[20:23]
v_mfma_f32_16x16x32_bf16 a[24:27], v[148:151], v[208:211], a[24:27]
v_mfma_f32_16x16x32_bf16 a[28:31], v[148:151], v[212:215], a[28:31]
v_mfma_f32_16x16x32_bf16 a[32:35], v[152:155], v[200:203], a[32:35]
v_mfma_f32_16x16x32_bf16 a[36:39], v[152:155], v[204:207], a[36:39]
v_mfma_f32_16x16x32_bf16 a[40:43], v[152:155], v[208:211], a[40:43]
v_mfma_f32_16x16x32_bf16 a[44:47], v[152:155], v[212:215], a[44:47]
v_mfma_f32_16x16x32_bf16 a[48:51], v[156:159], v[200:203], a[48:51]
v_mfma_f32_16x16x32_bf16 a[52:55], v[156:159], v[204:207], a[52:55]
v_mfma_f32_16x16x32_bf16 a[56:59], v[156:159], v[208:211], a[56:59]
v_mfma_f32_16x16x32_bf16 a[60:63], v[156:159], v[212:215], a[60:63]
v_mfma_f32_16x16x32_bf16 a[64:67], v[160:163], v[200:203], a[64:67]
v_mfma_f32_16x16x32_bf16 a[68:71], v[160:163], v[204:207], a[68:71]
v_mfma_f32_16x16x32_bf16 a[72:75], v[160:163], v[208:211], a[72:75]
v_mfma_f32_16x16x32_bf16 a[76:79], v[160:163], v[212:215], a[76:79]
v_mfma_f32_16x16x32_bf16 a[80:83], v[164:167], v[200:203], a[80:83]
v_mfma_f32_16x16x32_bf16 a[84:87], v[164:167], v[204:207], a[84:87]
v_mfma_f32_16x16x32_bf16 a[88:91], v[164:167], v[208:211], a[88:91]
v_mfma_f32_16x16x32_bf16 a[92:95], v[164:167], v[212:215], a[92:95]
v_mfma_f32_16x16x32_bf16 a[96:99], v[168:171], v[200:203], a[96:99]
v_mfma_f32_16x16x32_bf16 a[100:103], v[168:171], v[204:207], a[100:103]
v_mfma_f32_16x16x32_bf16 a[104:107], v[168:171], v[208:211], a[104:107]
v_mfma_f32_16x16x32_bf16 a[108:111], v[168:171], v[212:215], a[108:111]
v_mfma_f32_16x16x32_bf16 a[112:115], v[172:175], v[200:203], a[112:115]
v_mfma_f32_16x16x32_bf16 a[116:119], v[172:175], v[204:207], a[116:119]
v_mfma_f32_16x16x32_bf16 a[120:123], v[172:175], v[208:211], a[120:123]
v_mfma_f32_16x16x32_bf16 a[124:127], v[172:175], v[212:215], a[124:127]
v_mfma_f32_16x16x32_bf16 a[128:131], v[176:179], v[200:203], a[128:131]
v_mfma_f32_16x16x32_bf16 a[132:135], v[176:179], v[204:207], a[132:135]
v_mfma_f32_16x16x32_bf16 a[136:139], v[176:179], v[208:211], a[136:139]
v_mfma_f32_16x16x32_bf16 a[140:143], v[176:179], v[212:215], a[140:143]
v_mfma_f32_16x16x32_bf16 a[144:147], v[180:183], v[200:203], a[144:147]
v_mfma_f32_16x16x32_bf16 a[148:151], v[180:183], v[204:207], a[148:151]
v_mfma_f32_16x16x32_bf16 a[152:155], v[180:183], v[208:211], a[152:155]
v_mfma_f32_16x16x32_bf16 a[156:159], v[180:183], v[212:215], a[156:159]
buffer_load_dwordx4 v[144:147], v1, s[4:7], s30 offen offset:3072
buffer_load_dwordx4 v[148:151], v1, s[4:7], s31 offen offset:3072
buffer_load_dwordx4 v[152:155], v1, s[4:7], s32 offen offset:3072
buffer_load_dwordx4 v[156:159], v1, s[4:7], s33 offen offset:3072
buffer_load_dwordx4 v[160:163], v1, s[4:7], s34 offen offset:3072
buffer_load_dwordx4 v[164:167], v1, s[4:7], s35 offen offset:3072
buffer_load_dwordx4 v[168:171], v1, s[4:7], s36 offen offset:3072
buffer_load_dwordx4 v[172:175], v1, s[4:7], s37 offen offset:3072
buffer_load_dwordx4 v[176:179], v1, s[4:7], s38 offen offset:3072
buffer_load_dwordx4 v[180:183], v1, s[4:7], s39 offen offset:3072
s_add_u32 s30, s30, 4096
s_add_u32 s31, s31, 4096
s_add_u32 s32, s32, 4096
s_add_u32 s33, s33, 4096
s_add_u32 s34, s34, 4096
s_add_u32 s35, s35, 4096
s_add_u32 s36, s36, 4096
s_add_u32 s37, s37, 4096
s_add_u32 s38, s38, 4096
s_add_u32 s39, s39, 4096
s_waitcnt vmcnt(30)
ds_read_b128 v[200:203], v1 offset:17408
ds_read_b128 v[204:207], v1 offset:41984
ds_read_b128 v[208:211], v6 offset:17408
ds_read_b128 v[212:215], v6 offset:41984
s_waitcnt lgkmcnt(4)
v_mfma_f32_16x16x32_bf16 a[0:3], v[24:27], v[184:187], a[0:3]
v_mfma_f32_16x16x32_bf16 a[4:7], v[24:27], v[188:191], a[4:7]
v_mfma_f32_16x16x32_bf16 a[8:11], v[24:27], v[192:195], a[8:11]
v_mfma_f32_16x16x32_bf16 a[12:15], v[24:27], v[196:199], a[12:15]
v_mfma_f32_16x16x32_bf16 a[16:19], v[28:31], v[184:187], a[16:19]
v_mfma_f32_16x16x32_bf16 a[20:23], v[28:31], v[188:191], a[20:23]
v_mfma_f32_16x16x32_bf16 a[24:27], v[28:31], v[192:195], a[24:27]
v_mfma_f32_16x16x32_bf16 a[28:31], v[28:31], v[196:199], a[28:31]
v_mfma_f32_16x16x32_bf16 a[32:35], v[32:35], v[184:187], a[32:35]
v_mfma_f32_16x16x32_bf16 a[36:39], v[32:35], v[188:191], a[36:39]
v_mfma_f32_16x16x32_bf16 a[40:43], v[32:35], v[192:195], a[40:43]
v_mfma_f32_16x16x32_bf16 a[44:47], v[32:35], v[196:199], a[44:47]
v_mfma_f32_16x16x32_bf16 a[48:51], v[36:39], v[184:187], a[48:51]
v_mfma_f32_16x16x32_bf16 a[52:55], v[36:39], v[188:191], a[52:55]
v_mfma_f32_16x16x32_bf16 a[56:59], v[36:39], v[192:195], a[56:59]
v_mfma_f32_16x16x32_bf16 a[60:63], v[36:39], v[196:199], a[60:63]
v_mfma_f32_16x16x32_bf16 a[64:67], v[40:43], v[184:187], a[64:67]
v_mfma_f32_16x16x32_bf16 a[68:71], v[40:43], v[188:191], a[68:71]
v_mfma_f32_16x16x32_bf16 a[72:75], v[40:43], v[192:195], a[72:75]
v_mfma_f32_16x16x32_bf16 a[76:79], v[40:43], v[196:199], a[76:79]
v_mfma_f32_16x16x32_bf16 a[80:83], v[44:47], v[184:187], a[80:83]
v_mfma_f32_16x16x32_bf16 a[84:87], v[44:47], v[188:191], a[84:87]
v_mfma_f32_16x16x32_bf16 a[88:91], v[44:47], v[192:195], a[88:91]
v_mfma_f32_16x16x32_bf16 a[92:95], v[44:47], v[196:199], a[92:95]
v_mfma_f32_16x16x32_bf16 a[96:99], v[48:51], v[184:187], a[96:99]
v_mfma_f32_16x16x32_bf16 a[100:103], v[48:51], v[188:191], a[100:103]
v_mfma_f32_16x16x32_bf16 a[104:107], v[48:51], v[192:195], a[104:107]
v_mfma_f32_16x16x32_bf16 a[108:111], v[48:51], v[196:199], a[108:111]
v_mfma_f32_16x16x32_bf16 a[112:115], v[52:55], v[184:187], a[112:115]
v_mfma_f32_16x16x32_bf16 a[116:119], v[52:55], v[188:191], a[116:119]
v_mfma_f32_16x16x32_bf16 a[120:123], v[52:55], v[192:195], a[120:123]
v_mfma_f32_16x16x32_bf16 a[124:127], v[52:55], v[196:199], a[124:127]
v_mfma_f32_16x16x32_bf16 a[128:131], v[56:59], v[184:187], a[128:131]
v_mfma_f32_16x16x32_bf16 a[132:135], v[56:59], v[188:191], a[132:135]
v_mfma_f32_16x16x32_bf16 a[136:139], v[56:59], v[192:195], a[136:139]
v_mfma_f32_16x16x32_bf16 a[140:143], v[56:59], v[196:199], a[140:143]
v_mfma_f32_16x16x32_bf16 a[144:147], v[60:63], v[184:187], a[144:147]
v_mfma_f32_16x16x32_bf16 a[148:151], v[60:63], v[188:191], a[148:151]
v_mfma_f32_16x16x32_bf16 a[152:155], v[60:63], v[192:195], a[152:155]
v_mfma_f32_16x16x32_bf16 a[156:159], v[60:63], v[196:199], a[156:159]
buffer_load_dwordx4 v[24:27], v1, s[4:7], s30 offen offset:0
buffer_load_dwordx4 v[28:31], v1, s[4:7], s31 offen offset:0
buffer_load_dwordx4 v[32:35], v1, s[4:7], s32 offen offset:0
buffer_load_dwordx4 v[36:39], v1, s[4:7], s33 offen offset:0
buffer_load_dwordx4 v[40:43], v1, s[4:7], s34 offen offset:0
buffer_load_dwordx4 v[44:47], v1, s[4:7], s35 offen offset:0
buffer_load_dwordx4 v[48:51], v1, s[4:7], s36 offen offset:0
buffer_load_dwordx4 v[52:55], v1, s[4:7], s37 offen offset:0
buffer_load_dwordx4 v[56:59], v1, s[4:7], s38 offen offset:0
buffer_load_dwordx4 v[60:63], v1, s[4:7], s39 offen offset:0
s_waitcnt vmcnt(30)
ds_read_b128 v[184:187], v1 offset:18432
ds_read_b128 v[188:191], v1 offset:43008
ds_read_b128 v[192:195], v6 offset:18432
ds_read_b128 v[196:199], v6 offset:43008
s_waitcnt lgkmcnt(4)
v_mfma_f32_16x16x32_bf16 a[0:3], v[64:67], v[200:203], a[0:3]
v_mfma_f32_16x16x32_bf16 a[4:7], v[64:67], v[204:207], a[4:7]
v_mfma_f32_16x16x32_bf16 a[8:11], v[64:67], v[208:211], a[8:11]
v_mfma_f32_16x16x32_bf16 a[12:15], v[64:67], v[212:215], a[12:15]
v_mfma_f32_16x16x32_bf16 a[16:19], v[68:71], v[200:203], a[16:19]
v_mfma_f32_16x16x32_bf16 a[20:23], v[68:71], v[204:207], a[20:23]
v_mfma_f32_16x16x32_bf16 a[24:27], v[68:71], v[208:211], a[24:27]
v_mfma_f32_16x16x32_bf16 a[28:31], v[68:71], v[212:215], a[28:31]
v_mfma_f32_16x16x32_bf16 a[32:35], v[72:75], v[200:203], a[32:35]
v_mfma_f32_16x16x32_bf16 a[36:39], v[72:75], v[204:207], a[36:39]
v_mfma_f32_16x16x32_bf16 a[40:43], v[72:75], v[208:211], a[40:43]
v_mfma_f32_16x16x32_bf16 a[44:47], v[72:75], v[212:215], a[44:47]
v_mfma_f32_16x16x32_bf16 a[48:51], v[76:79], v[200:203], a[48:51]
v_mfma_f32_16x16x32_bf16 a[52:55], v[76:79], v[204:207], a[52:55]
v_mfma_f32_16x16x32_bf16 a[56:59], v[76:79], v[208:211], a[56:59]
v_mfma_f32_16x16x32_bf16 a[60:63], v[76:79], v[212:215], a[60:63]
v_mfma_f32_16x16x32_bf16 a[64:67], v[80:83], v[200:203], a[64:67]
v_mfma_f32_16x16x32_bf16 a[68:71], v[80:83], v[204:207], a[68:71]
v_mfma_f32_16x16x32_bf16 a[72:75], v[80:83], v[208:211], a[72:75]
v_mfma_f32_16x16x32_bf16 a[76:79], v[80:83], v[212:215], a[76:79]
v_mfma_f32_16x16x32_bf16 a[80:83], v[84:87], v[200:203], a[80:83]
v_mfma_f32_16x16x32_bf16 a[84:87], v[84:87], v[204:207], a[84:87]
v_mfma_f32_16x16x32_bf16 a[88:91], v[84:87], v[208:211], a[88:91]
v_mfma_f32_16x16x32_bf16 a[92:95], v[84:87], v[212:215], a[92:95]
v_mfma_f32_16x16x32_bf16 a[96:99], v[88:91], v[200:203], a[96:99]
v_mfma_f32_16x16x32_bf16 a[100:103], v[88:91], v[204:207], a[100:103]
v_mfma_f32_16x16x32_bf16 a[104:107], v[88:91], v[208:211], a[104:107]
v_mfma_f32_16x16x32_bf16 a[108:111], v[88:91], v[212:215], a[108:111]
v_mfma_f32_16x16x32_bf16 a[112:115], v[92:95], v[200:203], a[112:115]
v_mfma_f32_16x16x32_bf16 a[116:119], v[92:95], v[204:207], a[116:119]
v_mfma_f32_16x16x32_bf16 a[120:123], v[92:95], v[208:211], a[120:123]
v_mfma_f32_16x16x32_bf16 a[124:127], v[92:95], v[212:215], a[124:127]
v_mfma_f32_16x16x32_bf16 a[128:131], v[96:99], v[200:203], a[128:131]
v_mfma_f32_16x16x32_bf16 a[132:135], v[96:99], v[204:207], a[132:135]
v_mfma_f32_16x16x32_bf16 a[136:139], v[96:99], v[208:211], a[136:139]
v_mfma_f32_16x16x32_bf16 a[140:143], v[96:99], v[212:215], a[140:143]
v_mfma_f32_16x16x32_bf16 a[144:147], v[100:103], v[200:203], a[144:147]
v_mfma_f32_16x16x32_bf16 a[148:151], v[100:103], v[204:207], a[148:151]
v_mfma_f32_16x16x32_bf16 a[152:155], v[100:103], v[208:211], a[152:155]
v_mfma_f32_16x16x32_bf16 a[156:159], v[100:103], v[212:215], a[156:159]
buffer_load_dwordx4 v[64:67], v1, s[4:7], s30 offen offset:1024
buffer_load_dwordx4 v[68:71], v1, s[4:7], s31 offen offset:1024
buffer_load_dwordx4 v[72:75], v1, s[4:7], s32 offen offset:1024
buffer_load_dwordx4 v[76:79], v1, s[4:7], s33 offen offset:1024
buffer_load_dwordx4 v[80:83], v1, s[4:7], s34 offen offset:1024
buffer_load_dwordx4 v[84:87], v1, s[4:7], s35 offen offset:1024
buffer_load_dwordx4 v[88:91], v1, s[4:7], s36 offen offset:1024
buffer_load_dwordx4 v[92:95], v1, s[4:7], s37 offen offset:1024
buffer_load_dwordx4 v[96:99], v1, s[4:7], s38 offen offset:1024
buffer_load_dwordx4 v[100:103], v1, s[4:7], s39 offen offset:1024
s_waitcnt vmcnt(30)
ds_read_b128 v[200:203], v1 offset:19456
ds_read_b128 v[204:207], v1 offset:44032
ds_read_b128 v[208:211], v6 offset:19456
ds_read_b128 v[212:215], v6 offset:44032
s_waitcnt lgkmcnt(4)
v_mfma_f32_16x16x32_bf16 a[0:3], v[104:107], v[184:187], a[0:3]
v_mfma_f32_16x16x32_bf16 a[4:7], v[104:107], v[188:191], a[4:7]
v_mfma_f32_16x16x32_bf16 a[8:11], v[104:107], v[192:195], a[8:11]
v_mfma_f32_16x16x32_bf16 a[12:15], v[104:107], v[196:199], a[12:15]
v_mfma_f32_16x16x32_bf16 a[16:19], v[108:111], v[184:187], a[16:19]
v_mfma_f32_16x16x32_bf16 a[20:23], v[108:111], v[188:191], a[20:23]
v_mfma_f32_16x16x32_bf16 a[24:27], v[108:111], v[192:195], a[24:27]
v_mfma_f32_16x16x32_bf16 a[28:31], v[108:111], v[196:199], a[28:31]
v_mfma_f32_16x16x32_bf16 a[32:35], v[112:115], v[184:187], a[32:35]
v_mfma_f32_16x16x32_bf16 a[36:39], v[112:115], v[188:191], a[36:39]
v_mfma_f32_16x16x32_bf16 a[40:43], v[112:115], v[192:195], a[40:43]
v_mfma_f32_16x16x32_bf16 a[44:47], v[112:115], v[196:199], a[44:47]
v_mfma_f32_16x16x32_bf16 a[48:51], v[116:119], v[184:187], a[48:51]
v_mfma_f32_16x16x32_bf16 a[52:55], v[116:119], v[188:191], a[52:55]
v_mfma_f32_16x16x32_bf16 a[56:59], v[116:119], v[192:195], a[56:59]
v_mfma_f32_16x16x32_bf16 a[60:63], v[116:119], v[196:199], a[60:63]
v_mfma_f32_16x16x32_bf16 a[64:67], v[120:123], v[184:187], a[64:67]
v_mfma_f32_16x16x32_bf16 a[68:71], v[120:123], v[188:191], a[68:71]
v_mfma_f32_16x16x32_bf16 a[72:75], v[120:123], v[192:195], a[72:75]
v_mfma_f32_16x16x32_bf16 a[76:79], v[120:123], v[196:199], a[76:79]
v_mfma_f32_16x16x32_bf16 a[80:83], v[124:127], v[184:187], a[80:83]
v_mfma_f32_16x16x32_bf16 a[84:87], v[124:127], v[188:191], a[84:87]
v_mfma_f32_16x16x32_bf16 a[88:91], v[124:127], v[192:195], a[88:91]
v_mfma_f32_16x16x32_bf16 a[92:95], v[124:127], v[196:199], a[92:95]
v_mfma_f32_16x16x32_bf16 a[96:99], v[128:131], v[184:187], a[96:99]
v_mfma_f32_16x16x32_bf16 a[100:103], v[128:131], v[188:191], a[100:103]
v_mfma_f32_16x16x32_bf16 a[104:107], v[128:131], v[192:195], a[104:107]
v_mfma_f32_16x16x32_bf16 a[108:111], v[128:131], v[196:199], a[108:111]
v_mfma_f32_16x16x32_bf16 a[112:115], v[132:135], v[184:187], a[112:115]
v_mfma_f32_16x16x32_bf16 a[116:119], v[132:135], v[188:191], a[116:119]
v_mfma_f32_16x16x32_bf16 a[120:123], v[132:135], v[192:195], a[120:123]
v_mfma_f32_16x16x32_bf16 a[124:127], v[132:135], v[196:199], a[124:127]
v_mfma_f32_16x16x32_bf16 a[128:131], v[136:139], v[184:187], a[128:131]
v_mfma_f32_16x16x32_bf16 a[132:135], v[136:139], v[188:191], a[132:135]
v_mfma_f32_16x16x32_bf16 a[136:139], v[136:139], v[192:195], a[136:139]
v_mfma_f32_16x16x32_bf16 a[140:143], v[136:139], v[196:199], a[140:143]
v_mfma_f32_16x16x32_bf16 a[144:147], v[140:143], v[184:187], a[144:147]
v_mfma_f32_16x16x32_bf16 a[148:151], v[140:143], v[188:191], a[148:151]
v_mfma_f32_16x16x32_bf16 a[152:155], v[140:143], v[192:195], a[152:155]
v_mfma_f32_16x16x32_bf16 a[156:159], v[140:143], v[196:199], a[156:159]
buffer_load_dwordx4 v[104:107], v1, s[4:7], s30 offen offset:2048
buffer_load_dwordx4 v[108:111], v1, s[4:7], s31 offen offset:2048
buffer_load_dwordx4 v[112:115], v1, s[4:7], s32 offen offset:2048
buffer_load_dwordx4 v[116:119], v1, s[4:7], s33 offen offset:2048
buffer_load_dwordx4 v[120:123], v1, s[4:7], s34 offen offset:2048
buffer_load_dwordx4 v[124:127], v1, s[4:7], s35 offen offset:2048
buffer_load_dwordx4 v[128:131], v1, s[4:7], s36 offen offset:2048
buffer_load_dwordx4 v[132:135], v1, s[4:7], s37 offen offset:2048
buffer_load_dwordx4 v[136:139], v1, s[4:7], s38 offen offset:2048
buffer_load_dwordx4 v[140:143], v1, s[4:7], s39 offen offset:2048
s_waitcnt vmcnt(30)
ds_read_b128 v[184:187], v1 offset:20480
ds_read_b128 v[188:191], v1 offset:45056
ds_read_b128 v[192:195], v6 offset:20480
ds_read_b128 v[196:199], v6 offset:45056
s_waitcnt lgkmcnt(4)
v_mfma_f32_16x16x32_bf16 a[0:3], v[144:147], v[200:203], a[0:3]
v_mfma_f32_16x16x32_bf16 a[4:7], v[144:147], v[204:207], a[4:7]
v_mfma_f32_16x16x32_bf16 a[8:11], v[144:147], v[208:211], a[8:11]
v_mfma_f32_16x16x32_bf16 a[12:15], v[144:147], v[212:215], a[12:15]
v_mfma_f32_16x16x32_bf16 a[16:19], v[148:151], v[200:203], a[16:19]
v_mfma_f32_16x16x32_bf16 a[20:23], v[148:151], v[204:207], a[20:23]
v_mfma_f32_16x16x32_bf16 a[24:27], v[148:151], v[208:211], a[24:27]
v_mfma_f32_16x16x32_bf16 a[28:31], v[148:151], v[212:215], a[28:31]
v_mfma_f32_16x16x32_bf16 a[32:35], v[152:155], v[200:203], a[32:35]
v_mfma_f32_16x16x32_bf16 a[36:39], v[152:155], v[204:207], a[36:39]
v_mfma_f32_16x16x32_bf16 a[40:43], v[152:155], v[208:211], a[40:43]
v_mfma_f32_16x16x32_bf16 a[44:47], v[152:155], v[212:215], a[44:47]
v_mfma_f32_16x16x32_bf16 a[48:51], v[156:159], v[200:203], a[48:51]
v_mfma_f32_16x16x32_bf16 a[52:55], v[156:159], v[204:207], a[52:55]
v_mfma_f32_16x16x32_bf16 a[56:59], v[156:159], v[208:211], a[56:59]
v_mfma_f32_16x16x32_bf16 a[60:63], v[156:159], v[212:215], a[60:63]
v_mfma_f32_16x16x32_bf16 a[64:67], v[160:163], v[200:203], a[64:67]
v_mfma_f32_16x16x32_bf16 a[68:71], v[160:163], v[204:207], a[68:71]
v_mfma_f32_16x16x32_bf16 a[72:75], v[160:163], v[208:211], a[72:75]
v_mfma_f32_16x16x32_bf16 a[76:79], v[160:163], v[212:215], a[76:79]
v_mfma_f32_16x16x32_bf16 a[80:83], v[164:167], v[200:203], a[80:83]
v_mfma_f32_16x16x32_bf16 a[84:87], v[164:167], v[204:207], a[84:87]
v_mfma_f32_16x16x32_bf16 a[88:91], v[164:167], v[208:211], a[88:91]
v_mfma_f32_16x16x32_bf16 a[92:95], v[164:167], v[212:215], a[92:95]
v_mfma_f32_16x16x32_bf16 a[96:99], v[168:171], v[200:203], a[96:99]
v_mfma_f32_16x16x32_bf16 a[100:103], v[168:171], v[204:207], a[100:103]
v_mfma_f32_16x16x32_bf16 a[104:107], v[168:171], v[208:211], a[104:107]
v_mfma_f32_16x16x32_bf16 a[108:111], v[168:171], v[212:215], a[108:111]
v_mfma_f32_16x16x32_bf16 a[112:115], v[172:175], v[200:203], a[112:115]
v_mfma_f32_16x16x32_bf16 a[116:119], v[172:175], v[204:207], a[116:119]
v_mfma_f32_16x16x32_bf16 a[120:123], v[172:175], v[208:211], a[120:123]
v_mfma_f32_16x16x32_bf16 a[124:127], v[172:175], v[212:215], a[124:127]
v_mfma_f32_16x16x32_bf16 a[128:131], v[176:179], v[200:203], a[128:131]
v_mfma_f32_16x16x32_bf16 a[132:135], v[176:179], v[204:207], a[132:135]
v_mfma_f32_16x16x32_bf16 a[136:139], v[176:179], v[208:211], a[136:139]
v_mfma_f32_16x16x32_bf16 a[140:143], v[176:179], v[212:215], a[140:143]
v_mfma_f32_16x16x32_bf16 a[144:147], v[180:183], v[200:203], a[144:147]
v_mfma_f32_16x16x32_bf16 a[148:151], v[180:183], v[204:207], a[148:151]
v_mfma_f32_16x16x32_bf16 a[152:155], v[180:183], v[208:211], a[152:155]
v_mfma_f32_16x16x32_bf16 a[156:159], v[180:183], v[212:215], a[156:159]
buffer_load_dwordx4 v[144:147], v1, s[4:7], s30 offen offset:3072
buffer_load_dwordx4 v[148:151], v1, s[4:7], s31 offen offset:3072
buffer_load_dwordx4 v[152:155], v1, s[4:7], s32 offen offset:3072
buffer_load_dwordx4 v[156:159], v1, s[4:7], s33 offen offset:3072
buffer_load_dwordx4 v[160:163], v1, s[4:7], s34 offen offset:3072
buffer_load_dwordx4 v[164:167], v1, s[4:7], s35 offen offset:3072
buffer_load_dwordx4 v[168:171], v1, s[4:7], s36 offen offset:3072
buffer_load_dwordx4 v[172:175], v1, s[4:7], s37 offen offset:3072
buffer_load_dwordx4 v[176:179], v1, s[4:7], s38 offen offset:3072
buffer_load_dwordx4 v[180:183], v1, s[4:7], s39 offen offset:3072
s_add_u32 s30, s30, 4096
s_add_u32 s31, s31, 4096
s_add_u32 s32, s32, 4096
s_add_u32 s33, s33, 4096
s_add_u32 s34, s34, 4096
s_add_u32 s35, s35, 4096
s_add_u32 s36, s36, 4096
s_add_u32 s37, s37, 4096
s_add_u32 s38, s38, 4096
s_add_u32 s39, s39, 4096
s_waitcnt vmcnt(30)
ds_read_b128 v[200:203], v1 offset:21504
ds_read_b128 v[204:207], v1 offset:46080
ds_read_b128 v[208:211], v6 offset:21504
ds_read_b128 v[212:215], v6 offset:46080
s_waitcnt lgkmcnt(4)
v_mfma_f32_16x16x32_bf16 a[0:3], v[24:27], v[184:187], a[0:3]
v_mfma_f32_16x16x32_bf16 a[4:7], v[24:27], v[188:191], a[4:7]
v_mfma_f32_16x16x32_bf16 a[8:11], v[24:27], v[192:195], a[8:11]
v_mfma_f32_16x16x32_bf16 a[12:15], v[24:27], v[196:199], a[12:15]
v_mfma_f32_16x16x32_bf16 a[16:19], v[28:31], v[184:187], a[16:19]
v_mfma_f32_16x16x32_bf16 a[20:23], v[28:31], v[188:191], a[20:23]
v_mfma_f32_16x16x32_bf16 a[24:27], v[28:31], v[192:195], a[24:27]
v_mfma_f32_16x16x32_bf16 a[28:31], v[28:31], v[196:199], a[28:31]
v_mfma_f32_16x16x32_bf16 a[32:35], v[32:35], v[184:187], a[32:35]
v_mfma_f32_16x16x32_bf16 a[36:39], v[32:35], v[188:191], a[36:39]
v_mfma_f32_16x16x32_bf16 a[40:43], v[32:35], v[192:195], a[40:43]
v_mfma_f32_16x16x32_bf16 a[44:47], v[32:35], v[196:199], a[44:47]
v_mfma_f32_16x16x32_bf16 a[48:51], v[36:39], v[184:187], a[48:51]
v_mfma_f32_16x16x32_bf16 a[52:55], v[36:39], v[188:191], a[52:55]
v_mfma_f32_16x16x32_bf16 a[56:59], v[36:39], v[192:195], a[56:59]
v_mfma_f32_16x16x32_bf16 a[60:63], v[36:39], v[196:199], a[60:63]
v_mfma_f32_16x16x32_bf16 a[64:67], v[40:43], v[184:187], a[64:67]
v_mfma_f32_16x16x32_bf16 a[68:71], v[40:43], v[188:191], a[68:71]
v_mfma_f32_16x16x32_bf16 a[72:75], v[40:43], v[192:195], a[72:75]
v_mfma_f32_16x16x32_bf16 a[76:79], v[40:43], v[196:199], a[76:79]
v_mfma_f32_16x16x32_bf16 a[80:83], v[44:47], v[184:187], a[80:83]
v_mfma_f32_16x16x32_bf16 a[84:87], v[44:47], v[188:191], a[84:87]
v_mfma_f32_16x16x32_bf16 a[88:91], v[44:47], v[192:195], a[88:91]
v_mfma_f32_16x16x32_bf16 a[92:95], v[44:47], v[196:199], a[92:95]
v_mfma_f32_16x16x32_bf16 a[96:99], v[48:51], v[184:187], a[96:99]
v_mfma_f32_16x16x32_bf16 a[100:103], v[48:51], v[188:191], a[100:103]
v_mfma_f32_16x16x32_bf16 a[104:107], v[48:51], v[192:195], a[104:107]
v_mfma_f32_16x16x32_bf16 a[108:111], v[48:51], v[196:199], a[108:111]
v_mfma_f32_16x16x32_bf16 a[112:115], v[52:55], v[184:187], a[112:115]
v_mfma_f32_16x16x32_bf16 a[116:119], v[52:55], v[188:191], a[116:119]
v_mfma_f32_16x16x32_bf16 a[120:123], v[52:55], v[192:195], a[120:123]
v_mfma_f32_16x16x32_bf16 a[124:127], v[52:55], v[196:199], a[124:127]
v_mfma_f32_16x16x32_bf16 a[128:131], v[56:59], v[184:187], a[128:131]
v_mfma_f32_16x16x32_bf16 a[132:135], v[56:59], v[188:191], a[132:135]
v_mfma_f32_16x16x32_bf16 a[136:139], v[56:59], v[192:195], a[136:139]
v_mfma_f32_16x16x32_bf16 a[140:143], v[56:59], v[196:199], a[140:143]
v_mfma_f32_16x16x32_bf16 a[144:147], v[60:63], v[184:187], a[144:147]
v_mfma_f32_16x16x32_bf16 a[148:151], v[60:63], v[188:191], a[148:151]
v_mfma_f32_16x16x32_bf16 a[152:155], v[60:63], v[192:195], a[152:155]
v_mfma_f32_16x16x32_bf16 a[156:159], v[60:63], v[196:199], a[156:159]
s_waitcnt vmcnt(20)
ds_read_b128 v[184:187], v1 offset:22528
ds_read_b128 v[188:191], v1 offset:47104
ds_read_b128 v[192:195], v6 offset:22528
ds_read_b128 v[196:199], v6 offset:47104
s_waitcnt lgkmcnt(4)
v_mfma_f32_16x16x32_bf16 a[0:3], v[64:67], v[200:203], a[0:3]
v_mfma_f32_16x16x32_bf16 a[4:7], v[64:67], v[204:207], a[4:7]
v_mfma_f32_16x16x32_bf16 a[8:11], v[64:67], v[208:211], a[8:11]
v_mfma_f32_16x16x32_bf16 a[12:15], v[64:67], v[212:215], a[12:15]
v_mfma_f32_16x16x32_bf16 a[16:19], v[68:71], v[200:203], a[16:19]
v_mfma_f32_16x16x32_bf16 a[20:23], v[68:71], v[204:207], a[20:23]
v_mfma_f32_16x16x32_bf16 a[24:27], v[68:71], v[208:211], a[24:27]
v_mfma_f32_16x16x32_bf16 a[28:31], v[68:71], v[212:215], a[28:31]
v_mfma_f32_16x16x32_bf16 a[32:35], v[72:75], v[200:203], a[32:35]
v_mfma_f32_16x16x32_bf16 a[36:39], v[72:75], v[204:207], a[36:39]
v_mfma_f32_16x16x32_bf16 a[40:43], v[72:75], v[208:211], a[40:43]
v_mfma_f32_16x16x32_bf16 a[44:47], v[72:75], v[212:215], a[44:47]
v_mfma_f32_16x16x32_bf16 a[48:51], v[76:79], v[200:203], a[48:51]
v_mfma_f32_16x16x32_bf16 a[52:55], v[76:79], v[204:207], a[52:55]
v_mfma_f32_16x16x32_bf16 a[56:59], v[76:79], v[208:211], a[56:59]
v_mfma_f32_16x16x32_bf16 a[60:63], v[76:79], v[212:215], a[60:63]
v_mfma_f32_16x16x32_bf16 a[64:67], v[80:83], v[200:203], a[64:67]
v_mfma_f32_16x16x32_bf16 a[68:71], v[80:83], v[204:207], a[68:71]
v_mfma_f32_16x16x32_bf16 a[72:75], v[80:83], v[208:211], a[72:75]
v_mfma_f32_16x16x32_bf16 a[76:79], v[80:83], v[212:215], a[76:79]
v_mfma_f32_16x16x32_bf16 a[80:83], v[84:87], v[200:203], a[80:83]
v_mfma_f32_16x16x32_bf16 a[84:87], v[84:87], v[204:207], a[84:87]
v_mfma_f32_16x16x32_bf16 a[88:91], v[84:87], v[208:211], a[88:91]
v_mfma_f32_16x16x32_bf16 a[92:95], v[84:87], v[212:215], a[92:95]
v_mfma_f32_16x16x32_bf16 a[96:99], v[88:91], v[200:203], a[96:99]
v_mfma_f32_16x16x32_bf16 a[100:103], v[88:91], v[204:207], a[100:103]
v_mfma_f32_16x16x32_bf16 a[104:107], v[88:91], v[208:211], a[104:107]
v_mfma_f32_16x16x32_bf16 a[108:111], v[88:91], v[212:215], a[108:111]
v_mfma_f32_16x16x32_bf16 a[112:115], v[92:95], v[200:203], a[112:115]
v_mfma_f32_16x16x32_bf16 a[116:119], v[92:95], v[204:207], a[116:119]
v_mfma_f32_16x16x32_bf16 a[120:123], v[92:95], v[208:211], a[120:123]
v_mfma_f32_16x16x32_bf16 a[124:127], v[92:95], v[212:215], a[124:127]
v_mfma_f32_16x16x32_bf16 a[128:131], v[96:99], v[200:203], a[128:131]
v_mfma_f32_16x16x32_bf16 a[132:135], v[96:99], v[204:207], a[132:135]
v_mfma_f32_16x16x32_bf16 a[136:139], v[96:99], v[208:211], a[136:139]
v_mfma_f32_16x16x32_bf16 a[140:143], v[96:99], v[212:215], a[140:143]
v_mfma_f32_16x16x32_bf16 a[144:147], v[100:103], v[200:203], a[144:147]
v_mfma_f32_16x16x32_bf16 a[148:151], v[100:103], v[204:207], a[148:151]
v_mfma_f32_16x16x32_bf16 a[152:155], v[100:103], v[208:211], a[152:155]
v_mfma_f32_16x16x32_bf16 a[156:159], v[100:103], v[212:215], a[156:159]
s_waitcnt vmcnt(10)
ds_read_b128 v[200:203], v1 offset:23552
ds_read_b128 v[204:207], v1 offset:48128
ds_read_b128 v[208:211], v6 offset:23552
ds_read_b128 v[212:215], v6 offset:48128
s_waitcnt lgkmcnt(4)
v_mfma_f32_16x16x32_bf16 a[0:3], v[104:107], v[184:187], a[0:3]
v_mfma_f32_16x16x32_bf16 a[4:7], v[104:107], v[188:191], a[4:7]
v_mfma_f32_16x16x32_bf16 a[8:11], v[104:107], v[192:195], a[8:11]
v_mfma_f32_16x16x32_bf16 a[12:15], v[104:107], v[196:199], a[12:15]
v_mfma_f32_16x16x32_bf16 a[16:19], v[108:111], v[184:187], a[16:19]
v_mfma_f32_16x16x32_bf16 a[20:23], v[108:111], v[188:191], a[20:23]
v_mfma_f32_16x16x32_bf16 a[24:27], v[108:111], v[192:195], a[24:27]
v_mfma_f32_16x16x32_bf16 a[28:31], v[108:111], v[196:199], a[28:31]
v_mfma_f32_16x16x32_bf16 a[32:35], v[112:115], v[184:187], a[32:35]
v_mfma_f32_16x16x32_bf16 a[36:39], v[112:115], v[188:191], a[36:39]
v_mfma_f32_16x16x32_bf16 a[40:43], v[112:115], v[192:195], a[40:43]
v_mfma_f32_16x16x32_bf16 a[44:47], v[112:115], v[196:199], a[44:47]
v_mfma_f32_16x16x32_bf16 a[48:51], v[116:119], v[184:187], a[48:51]
v_mfma_f32_16x16x32_bf16 a[52:55], v[116:119], v[188:191], a[52:55]
v_mfma_f32_16x16x32_bf16 a[56:59], v[116:119], v[192:195], a[56:59]
v_mfma_f32_16x16x32_bf16 a[60:63], v[116:119], v[196:199], a[60:63]
v_mfma_f32_16x16x32_bf16 a[64:67], v[120:123], v[184:187], a[64:67]
v_mfma_f32_16x16x32_bf16 a[68:71], v[120:123], v[188:191], a[68:71]
v_mfma_f32_16x16x32_bf16 a[72:75], v[120:123], v[192:195], a[72:75]
v_mfma_f32_16x16x32_bf16 a[76:79], v[120:123], v[196:199], a[76:79]
v_mfma_f32_16x16x32_bf16 a[80:83], v[124:127], v[184:187], a[80:83]
v_mfma_f32_16x16x32_bf16 a[84:87], v[124:127], v[188:191], a[84:87]
v_mfma_f32_16x16x32_bf16 a[88:91], v[124:127], v[192:195], a[88:91]
v_mfma_f32_16x16x32_bf16 a[92:95], v[124:127], v[196:199], a[92:95]
v_mfma_f32_16x16x32_bf16 a[96:99], v[128:131], v[184:187], a[96:99]
v_mfma_f32_16x16x32_bf16 a[100:103], v[128:131], v[188:191], a[100:103]
v_mfma_f32_16x16x32_bf16 a[104:107], v[128:131], v[192:195], a[104:107]
v_mfma_f32_16x16x32_bf16 a[108:111], v[128:131], v[196:199], a[108:111]
v_mfma_f32_16x16x32_bf16 a[112:115], v[132:135], v[184:187], a[112:115]
v_mfma_f32_16x16x32_bf16 a[116:119], v[132:135], v[188:191], a[116:119]
v_mfma_f32_16x16x32_bf16 a[120:123], v[132:135], v[192:195], a[120:123]
v_mfma_f32_16x16x32_bf16 a[124:127], v[132:135], v[196:199], a[124:127]
v_mfma_f32_16x16x32_bf16 a[128:131], v[136:139], v[184:187], a[128:131]
v_mfma_f32_16x16x32_bf16 a[132:135], v[136:139], v[188:191], a[132:135]
v_mfma_f32_16x16x32_bf16 a[136:139], v[136:139], v[192:195], a[136:139]
v_mfma_f32_16x16x32_bf16 a[140:143], v[136:139], v[196:199], a[140:143]
v_mfma_f32_16x16x32_bf16 a[144:147], v[140:143], v[184:187], a[144:147]
v_mfma_f32_16x16x32_bf16 a[148:151], v[140:143], v[188:191], a[148:151]
v_mfma_f32_16x16x32_bf16 a[152:155], v[140:143], v[192:195], a[152:155]
v_mfma_f32_16x16x32_bf16 a[156:159], v[140:143], v[196:199], a[156:159]
s_waitcnt vmcnt(0)
s_waitcnt lgkmcnt(0)
v_mfma_f32_16x16x32_bf16 a[0:3], v[144:147], v[200:203], a[0:3]
v_mfma_f32_16x16x32_bf16 a[4:7], v[144:147], v[204:207], a[4:7]
v_mfma_f32_16x16x32_bf16 a[8:11], v[144:147], v[208:211], a[8:11]
v_mfma_f32_16x16x32_bf16 a[12:15], v[144:147], v[212:215], a[12:15]
v_mfma_f32_16x16x32_bf16 a[16:19], v[148:151], v[200:203], a[16:19]
v_mfma_f32_16x16x32_bf16 a[20:23], v[148:151], v[204:207], a[20:23]
v_mfma_f32_16x16x32_bf16 a[24:27], v[148:151], v[208:211], a[24:27]
v_mfma_f32_16x16x32_bf16 a[28:31], v[148:151], v[212:215], a[28:31]
v_mfma_f32_16x16x32_bf16 a[32:35], v[152:155], v[200:203], a[32:35]
v_mfma_f32_16x16x32_bf16 a[36:39], v[152:155], v[204:207], a[36:39]
v_mfma_f32_16x16x32_bf16 a[40:43], v[152:155], v[208:211], a[40:43]
v_mfma_f32_16x16x32_bf16 a[44:47], v[152:155], v[212:215], a[44:47]
v_mfma_f32_16x16x32_bf16 a[48:51], v[156:159], v[200:203], a[48:51]
v_mfma_f32_16x16x32_bf16 a[52:55], v[156:159], v[204:207], a[52:55]
v_mfma_f32_16x16x32_bf16 a[56:59], v[156:159], v[208:211], a[56:59]
v_mfma_f32_16x16x32_bf16 a[60:63], v[156:159], v[212:215], a[60:63]
v_mfma_f32_16x16x32_bf16 a[64:67], v[160:163], v[200:203], a[64:67]
v_mfma_f32_16x16x32_bf16 a[68:71], v[160:163], v[204:207], a[68:71]
v_mfma_f32_16x16x32_bf16 a[72:75], v[160:163], v[208:211], a[72:75]
v_mfma_f32_16x16x32_bf16 a[76:79], v[160:163], v[212:215], a[76:79]
v_mfma_f32_16x16x32_bf16 a[80:83], v[164:167], v[200:203], a[80:83]
v_mfma_f32_16x16x32_bf16 a[84:87], v[164:167], v[204:207], a[84:87]
v_mfma_f32_16x16x32_bf16 a[88:91], v[164:167], v[208:211], a[88:91]
v_mfma_f32_16x16x32_bf16 a[92:95], v[164:167], v[212:215], a[92:95]
v_mfma_f32_16x16x32_bf16 a[96:99], v[168:171], v[200:203], a[96:99]
v_mfma_f32_16x16x32_bf16 a[100:103], v[168:171], v[204:207], a[100:103]
v_mfma_f32_16x16x32_bf16 a[104:107], v[168:171], v[208:211], a[104:107]
v_mfma_f32_16x16x32_bf16 a[108:111], v[168:171], v[212:215], a[108:111]
v_mfma_f32_16x16x32_bf16 a[112:115], v[172:175], v[200:203], a[112:115]
v_mfma_f32_16x16x32_bf16 a[116:119], v[172:175], v[204:207], a[116:119]
v_mfma_f32_16x16x32_bf16 a[120:123], v[172:175], v[208:211], a[120:123]
v_mfma_f32_16x16x32_bf16 a[124:127], v[172:175], v[212:215], a[124:127]
v_mfma_f32_16x16x32_bf16 a[128:131], v[176:179], v[200:203], a[128:131]
v_mfma_f32_16x16x32_bf16 a[132:135], v[176:179], v[204:207], a[132:135]
v_mfma_f32_16x16x32_bf16 a[136:139], v[176:179], v[208:211], a[136:139]
v_mfma_f32_16x16x32_bf16 a[140:143], v[176:179], v[212:215], a[140:143]
v_mfma_f32_16x16x32_bf16 a[144:147], v[180:183], v[200:203], a[144:147]
v_mfma_f32_16x16x32_bf16 a[148:151], v[180:183], v[204:207], a[148:151]
v_mfma_f32_16x16x32_bf16 a[152:155], v[180:183], v[208:211], a[152:155]
v_mfma_f32_16x16x32_bf16 a[156:159], v[180:183], v[212:215], a[156:159]
s_branch fin_store4
fin_odma3:
s_lshl_b32 s16, s14, 2
s_add_u32 s16, s16, s12
s_mul_i32 s16, s16, 192
s_mul_i32 s17, s13, 24
s_add_u32 s16, s16, s17
s_lshl_b32 s16, s16, 10
s_add_u32 s16, s16, 57147392
s_mul_i32 s17, s12, 24576
v_add_u32 v6, 49152, v1
s_add_u32 m0, s17, 0
s_add_u32 s18, s16, 0
buffer_load_dwordx4 v1, s[4:7], s18 offen offset:0 lds
buffer_load_dwordx4 v1, s[4:7], s18 offen offset:1024 lds
buffer_load_dwordx4 v1, s[4:7], s18 offen offset:2048 lds
buffer_load_dwordx4 v1, s[4:7], s18 offen offset:3072 lds
s_add_u32 m0, s17, 4096
s_add_u32 s18, s16, 4096
buffer_load_dwordx4 v1, s[4:7], s18 offen offset:0 lds
buffer_load_dwordx4 v1, s[4:7], s18 offen offset:1024 lds
buffer_load_dwordx4 a[160:163], v1, s[4:7], s30 offen offset:0
buffer_load_dwordx4 a[164:167], v1, s[4:7], s31 offen offset:0
buffer_load_dwordx4 a[168:171], v1, s[4:7], s32 offen offset:0
buffer_load_dwordx4 a[172:175], v1, s[4:7], s33 offen offset:0
buffer_load_dwordx4 a[176:179], v1, s[4:7], s34 offen offset:0
buffer_load_dwordx4 a[180:183], v1, s[4:7], s35 offen offset:0
buffer_load_dwordx4 a[184:187], v1, s[4:7], s36 offen offset:0
buffer_load_dwordx4 a[188:191], v1, s[4:7], s37 offen offset:0
buffer_load_dwordx4 a[192:195], v1, s[4:7], s38 offen offset:0
buffer_load_dwordx4 a[196:199], v1, s[4:7], s39 offen offset:0
buffer_load_dwordx4 a[200:203], v1, s[4:7], s30 offen offset:1024
buffer_load_dwordx4 a[204:207], v1, s[4:7], s31 offen offset:1024
buffer_load_dwordx4 a[208:211], v1, s[4:7], s32 offen offset:1024
buffer_load_dwordx4 a[212:215], v1, s[4:7], s33 offen offset:1024
buffer_load_dwordx4 a[216:219], v1, s[4:7], s34 offen offset:1024
buffer_load_dwordx4 a[220:223], v1, s[4:7], s35 offen offset:1024
buffer_load_dwordx4 a[224:227], v1, s[4:7], s36 offen offset:1024
buffer_load_dwordx4 a[228:231], v1, s[4:7], s37 offen offset:1024
buffer_load_dwordx4 a[232:235], v1, s[4:7], s38 offen offset:1024
buffer_load_dwordx4 a[236:239], v1, s[4:7], s39 offen offset:1024
s_add_u32 m0, s17, 6144
s_add_u32 s18, s16, 6144
buffer_load_dwordx4 v1, s[4:7], s18 offen offset:0 lds
buffer_load_dwordx4 v1, s[4:7], s18 offen offset:1024 lds
buffer_load_dwordx4 v1, s[4:7], s18 offen offset:2048 lds
buffer_load_dwordx4 v1, s[4:7], s18 offen offset:3072 lds
s_add_u32 m0, s17, 10240
s_add_u32 s18, s16, 10240
buffer_load_dwordx4 v1, s[4:7], s18 offen offset:0 lds
buffer_load_dwordx4 v1, s[4:7], s18 offen offset:1024 lds
buffer_load_dwordx4 v[104:107], v1, s[4:7], s30 offen offset:2048
buffer_load_dwordx4 v[108:111], v1, s[4:7], s31 offen offset:2048
buffer_load_dwordx4 v[112:115], v1, s[4:7], s32 offen offset:2048
buffer_load_dwordx4 v[116:119], v1, s[4:7], s33 offen offset:2048
buffer_load_dwordx4 v[120:123], v1, s[4:7], s34 offen offset:2048
buffer_load_dwordx4 v[124:127], v1, s[4:7], s35 offen offset:2048
buffer_load_dwordx4 v[128:131], v1, s[4:7], s36 offen offset:2048
buffer_load_dwordx4 v[132:135], v1, s[4:7], s37 offen offset:2048
buffer_load_dwordx4 v[136:139], v1, s[4:7], s38 offen offset:2048
buffer_load_dwordx4 v[140:143], v1, s[4:7], s39 offen offset:2048
s_waitcnt vmcnt(36)
s_barrier
s_add_u32 m0, s17, 12288
s_add_u32 s18, s16, 12288
buffer_load_dwordx4 v1, s[4:7], s18 offen offset:0 lds
buffer_load_dwordx4 v1, s[4:7], s18 offen offset:1024 lds
buffer_load_dwordx4 v1, s[4:7], s18 offen offset:2048 lds
buffer_load_dwordx4 v1, s[4:7], s18 offen offset:3072 lds
s_add_u32 m0, s17, 16384
s_add_u32 s18, s16, 16384
buffer_load_dwordx4 v1, s[4:7], s18 offen offset:0 lds
buffer_load_dwordx4 v1, s[4:7], s18 offen offset:1024 lds
buffer_load_dwordx4 v[144:147], v1, s[4:7], s30 offen offset:3072
buffer_load_dwordx4 v[148:151], v1, s[4:7], s31 offen offset:3072
buffer_load_dwordx4 v[152:155], v1, s[4:7], s32 offen offset:3072
buffer_load_dwordx4 v[156:159], v1, s[4:7], s33 offen offset:3072
buffer_load_dwordx4 v[160:163], v1, s[4:7], s34 offen offset:3072
buffer_load_dwordx4 v[164:167], v1, s[4:7], s35 offen offset:3072
buffer_load_dwordx4 v[168:171], v1, s[4:7], s36 offen offset:3072
buffer_load_dwordx4 v[172:175], v1, s[4:7], s37 offen offset:3072
buffer_load_dwordx4 v[176:179], v1, s[4:7], s38 offen offset:3072
buffer_load_dwordx4 v[180:183], v1, s[4:7], s39 offen offset:3072
s_add_u32 s30, s30, 4096
s_add_u32 s31, s31, 4096
s_add_u32 s32, s32, 4096
s_add_u32 s33, s33, 4096
s_add_u32 s34, s34, 4096
s_add_u32 s35, s35, 4096
s_add_u32 s36, s36, 4096
s_add_u32 s37, s37, 4096
s_add_u32 s38, s38, 4096
s_add_u32 s39, s39, 4096
ds_read_b128 v[184:187], v1 offset:0
ds_read_b128 v[188:191], v1 offset:24576
ds_read_b128 v[192:195], v6 offset:0
ds_read_b128 v[196:199], v6 offset:24576
s_waitcnt vmcnt(42)
ds_read_b128 v[200:203], v1 offset:1024
ds_read_b128 v[204:207], v1 offset:25600
ds_read_b128 v[208:211], v6 offset:1024
ds_read_b128 v[212:215], v6 offset:25600
s_waitcnt lgkmcnt(4)
v_mfma_f32_16x16x32_bf16 a[0:3], a[160:163], v[184:187], 0
v_mfma_f32_16x16x32_bf16 a[4:7], a[160:163], v[188:191], 0
v_mfma_f32_16x16x32_bf16 a[8:11], a[160:163], v[192:195], 0
v_mfma_f32_16x16x32_bf16 a[12:15], a[160:163], v[196:199], 0
v_mfma_f32_16x16x32_bf16 a[16:19], a[164:167], v[184:187], 0
v_mfma_f32_16x16x32_bf16 a[20:23], a[164:167], v[188:191], 0
v_mfma_f32_16x16x32_bf16 a[24:27], a[164:167], v[192:195], 0
v_mfma_f32_16x16x32_bf16 a[28:31], a[164:167], v[196:199], 0
v_mfma_f32_16x16x32_bf16 a[32:35], a[168:171], v[184:187], 0
v_mfma_f32_16x16x32_bf16 a[36:39], a[168:171], v[188:191], 0
v_mfma_f32_16x16x32_bf16 a[40:43], a[168:171], v[192:195], 0
v_mfma_f32_16x16x32_bf16 a[44:47], a[168:171], v[196:199], 0
v_mfma_f32_16x16x32_bf16 a[48:51], a[172:175], v[184:187], 0
v_mfma_f32_16x16x32_bf16 a[52:55], a[172:175], v[188:191], 0
v_mfma_f32_16x16x32_bf16 a[56:59], a[172:175], v[192:195], 0
v_mfma_f32_16x16x32_bf16 a[60:63], a[172:175], v[196:199], 0
v_mfma_f32_16x16x32_bf16 a[64:67], a[176:179], v[184:187], 0
v_mfma_f32_16x16x32_bf16 a[68:71], a[176:179], v[188:191], 0
v_mfma_f32_16x16x32_bf16 a[72:75], a[176:179], v[192:195], 0
v_mfma_f32_16x16x32_bf16 a[76:79], a[176:179], v[196:199], 0
v_mfma_f32_16x16x32_bf16 a[80:83], a[180:183], v[184:187], 0
v_mfma_f32_16x16x32_bf16 a[84:87], a[180:183], v[188:191], 0
v_mfma_f32_16x16x32_bf16 a[88:91], a[180:183], v[192:195], 0
v_mfma_f32_16x16x32_bf16 a[92:95], a[180:183], v[196:199], 0
v_mfma_f32_16x16x32_bf16 a[96:99], a[184:187], v[184:187], 0
v_mfma_f32_16x16x32_bf16 a[100:103], a[184:187], v[188:191], 0
v_mfma_f32_16x16x32_bf16 a[104:107], a[184:187], v[192:195], 0
v_mfma_f32_16x16x32_bf16 a[108:111], a[184:187], v[196:199], 0
v_mfma_f32_16x16x32_bf16 a[112:115], a[188:191], v[184:187], 0
v_mfma_f32_16x16x32_bf16 a[116:119], a[188:191], v[188:191], 0
v_mfma_f32_16x16x32_bf16 a[120:123], a[188:191], v[192:195], 0
v_mfma_f32_16x16x32_bf16 a[124:127], a[188:191], v[196:199], 0
v_mfma_f32_16x16x32_bf16 a[128:131], a[192:195], v[184:187], 0
v_mfma_f32_16x16x32_bf16 a[132:135], a[192:195], v[188:191], 0
v_mfma_f32_16x16x32_bf16 a[136:139], a[192:195], v[192:195], 0
v_mfma_f32_16x16x32_bf16 a[140:143], a[192:195], v[196:199], 0
v_mfma_f32_16x16x32_bf16 a[144:147], a[196:199], v[184:187], 0
v_mfma_f32_16x16x32_bf16 a[148:151], a[196:199], v[188:191], 0
v_mfma_f32_16x16x32_bf16 a[152:155], a[196:199], v[192:195], 0
v_mfma_f32_16x16x32_bf16 a[156:159], a[196:199], v[196:199], 0
buffer_load_dwordx4 v[24:27], v1, s[4:7], s30 offen offset:0
buffer_load_dwordx4 v[28:31], v1, s[4:7], s31 offen offset:0
buffer_load_dwordx4 v[32:35], v1, s[4:7], s32 offen offset:0
buffer_load_dwordx4 v[36:39], v1, s[4:7], s33 offen offset:0
buffer_load_dwordx4 v[40:43], v1, s[4:7], s34 offen offset:0
buffer_load_dwordx4 v[44:47], v1, s[4:7], s35 offen offset:0
buffer_load_dwordx4 v[48:51], v1, s[4:7], s36 offen offset:0
buffer_load_dwordx4 v[52:55], v1, s[4:7], s37 offen offset:0
buffer_load_dwordx4 v[56:59], v1, s[4:7], s38 offen offset:0
buffer_load_dwordx4 v[60:63], v1, s[4:7], s39 offen offset:0
s_add_u32 m0, s17, 18432
s_add_u32 s18, s16, 18432
buffer_load_dwordx4 v1, s[4:7], s18 offen offset:0 lds
buffer_load_dwordx4 v1, s[4:7], s18 offen offset:1024 lds
buffer_load_dwordx4 v1, s[4:7], s18 offen offset:2048 lds
buffer_load_dwordx4 v1, s[4:7], s18 offen offset:3072 lds
s_add_u32 m0, s17, 22528
s_add_u32 s18, s16, 22528
buffer_load_dwordx4 v1, s[4:7], s18 offen offset:0 lds
buffer_load_dwordx4 v1, s[4:7], s18 offen offset:1024 lds
s_waitcnt vmcnt(48)
ds_read_b128 v[184:187], v1 offset:2048
ds_read_b128 v[188:191], v1 offset:26624
ds_read_b128 v[192:195], v6 offset:2048
ds_read_b128 v[196:199], v6 offset:26624
s_waitcnt lgkmcnt(4)
v_mfma_f32_16x16x32_bf16 a[0:3], a[200:203], v[200:203], a[0:3]
v_mfma_f32_16x16x32_bf16 a[4:7], a[200:203], v[204:207], a[4:7]
v_mfma_f32_16x16x32_bf16 a[8:11], a[200:203], v[208:211], a[8:11]
v_mfma_f32_16x16x32_bf16 a[12:15], a[200:203], v[212:215], a[12:15]
v_mfma_f32_16x16x32_bf16 a[16:19], a[204:207], v[200:203], a[16:19]
v_mfma_f32_16x16x32_bf16 a[20:23], a[204:207], v[204:207], a[20:23]
v_mfma_f32_16x16x32_bf16 a[24:27], a[204:207], v[208:211], a[24:27]
v_mfma_f32_16x16x32_bf16 a[28:31], a[204:207], v[212:215], a[28:31]
v_mfma_f32_16x16x32_bf16 a[32:35], a[208:211], v[200:203], a[32:35]
v_mfma_f32_16x16x32_bf16 a[36:39], a[208:211], v[204:207], a[36:39]
v_mfma_f32_16x16x32_bf16 a[40:43], a[208:211], v[208:211], a[40:43]
v_mfma_f32_16x16x32_bf16 a[44:47], a[208:211], v[212:215], a[44:47]
v_mfma_f32_16x16x32_bf16 a[48:51], a[212:215], v[200:203], a[48:51]
v_mfma_f32_16x16x32_bf16 a[52:55], a[212:215], v[204:207], a[52:55]
v_mfma_f32_16x16x32_bf16 a[56:59], a[212:215], v[208:211], a[56:59]
v_mfma_f32_16x16x32_bf16 a[60:63], a[212:215], v[212:215], a[60:63]
v_mfma_f32_16x16x32_bf16 a[64:67], a[216:219], v[200:203], a[64:67]
v_mfma_f32_16x16x32_bf16 a[68:71], a[216:219], v[204:207], a[68:71]
v_mfma_f32_16x16x32_bf16 a[72:75], a[216:219], v[208:211], a[72:75]
v_mfma_f32_16x16x32_bf16 a[76:79], a[216:219], v[212:215], a[76:79]
v_mfma_f32_16x16x32_bf16 a[80:83], a[220:223], v[200:203], a[80:83]
v_mfma_f32_16x16x32_bf16 a[84:87], a[220:223], v[204:207], a[84:87]
v_mfma_f32_16x16x32_bf16 a[88:91], a[220:223], v[208:211], a[88:91]
v_mfma_f32_16x16x32_bf16 a[92:95], a[220:223], v[212:215], a[92:95]
v_mfma_f32_16x16x32_bf16 a[96:99], a[224:227], v[200:203], a[96:99]
v_mfma_f32_16x16x32_bf16 a[100:103], a[224:227], v[204:207], a[100:103]
v_mfma_f32_16x16x32_bf16 a[104:107], a[224:227], v[208:211], a[104:107]
v_mfma_f32_16x16x32_bf16 a[108:111], a[224:227], v[212:215], a[108:111]
v_mfma_f32_16x16x32_bf16 a[112:115], a[228:231], v[200:203], a[112:115]
v_mfma_f32_16x16x32_bf16 a[116:119], a[228:231], v[204:207], a[116:119]
v_mfma_f32_16x16x32_bf16 a[120:123], a[228:231], v[208:211], a[120:123]
v_mfma_f32_16x16x32_bf16 a[124:127], a[228:231], v[212:215], a[124:127]
v_mfma_f32_16x16x32_bf16 a[128:131], a[232:235], v[200:203], a[128:131]
v_mfma_f32_16x16x32_bf16 a[132:135], a[232:235], v[204:207], a[132:135]
v_mfma_f32_16x16x32_bf16 a[136:139], a[232:235], v[208:211], a[136:139]
v_mfma_f32_16x16x32_bf16 a[140:143], a[232:235], v[212:215], a[140:143]
v_mfma_f32_16x16x32_bf16 a[144:147], a[236:239], v[200:203], a[144:147]
v_mfma_f32_16x16x32_bf16 a[148:151], a[236:239], v[204:207], a[148:151]
v_mfma_f32_16x16x32_bf16 a[152:155], a[236:239], v[208:211], a[152:155]
v_mfma_f32_16x16x32_bf16 a[156:159], a[236:239], v[212:215], a[156:159]
buffer_load_dwordx4 v[64:67], v1, s[4:7], s30 offen offset:1024
buffer_load_dwordx4 v[68:71], v1, s[4:7], s31 offen offset:1024
buffer_load_dwordx4 v[72:75], v1, s[4:7], s32 offen offset:1024
buffer_load_dwordx4 v[76:79], v1, s[4:7], s33 offen offset:1024
buffer_load_dwordx4 v[80:83], v1, s[4:7], s34 offen offset:1024
buffer_load_dwordx4 v[84:87], v1, s[4:7], s35 offen offset:1024
buffer_load_dwordx4 v[88:91], v1, s[4:7], s36 offen offset:1024
buffer_load_dwordx4 v[92:95], v1, s[4:7], s37 offen offset:1024
buffer_load_dwordx4 v[96:99], v1, s[4:7], s38 offen offset:1024
buffer_load_dwordx4 v[100:103], v1, s[4:7], s39 offen offset:1024
s_waitcnt vmcnt(42)
ds_read_b128 v[200:203], v1 offset:3072
ds_read_b128 v[204:207], v1 offset:27648
ds_read_b128 v[208:211], v6 offset:3072
ds_read_b128 v[212:215], v6 offset:27648
s_waitcnt lgkmcnt(4)
v_mfma_f32_16x16x32_bf16 a[0:3], v[104:107], v[184:187], a[0:3]
v_mfma_f32_16x16x32_bf16 a[4:7], v[104:107], v[188:191], a[4:7]
v_mfma_f32_16x16x32_bf16 a[8:11], v[104:107], v[192:195], a[8:11]
v_mfma_f32_16x16x32_bf16 a[12:15], v[104:107], v[196:199], a[12:15]
v_mfma_f32_16x16x32_bf16 a[16:19], v[108:111], v[184:187], a[16:19]
v_mfma_f32_16x16x32_bf16 a[20:23], v[108:111], v[188:191], a[20:23]
v_mfma_f32_16x16x32_bf16 a[24:27], v[108:111], v[192:195], a[24:27]
v_mfma_f32_16x16x32_bf16 a[28:31], v[108:111], v[196:199], a[28:31]
v_mfma_f32_16x16x32_bf16 a[32:35], v[112:115], v[184:187], a[32:35]
v_mfma_f32_16x16x32_bf16 a[36:39], v[112:115], v[188:191], a[36:39]
v_mfma_f32_16x16x32_bf16 a[40:43], v[112:115], v[192:195], a[40:43]
v_mfma_f32_16x16x32_bf16 a[44:47], v[112:115], v[196:199], a[44:47]
v_mfma_f32_16x16x32_bf16 a[48:51], v[116:119], v[184:187], a[48:51]
v_mfma_f32_16x16x32_bf16 a[52:55], v[116:119], v[188:191], a[52:55]
v_mfma_f32_16x16x32_bf16 a[56:59], v[116:119], v[192:195], a[56:59]
v_mfma_f32_16x16x32_bf16 a[60:63], v[116:119], v[196:199], a[60:63]
v_mfma_f32_16x16x32_bf16 a[64:67], v[120:123], v[184:187], a[64:67]
v_mfma_f32_16x16x32_bf16 a[68:71], v[120:123], v[188:191], a[68:71]
v_mfma_f32_16x16x32_bf16 a[72:75], v[120:123], v[192:195], a[72:75]
v_mfma_f32_16x16x32_bf16 a[76:79], v[120:123], v[196:199], a[76:79]
v_mfma_f32_16x16x32_bf16 a[80:83], v[124:127], v[184:187], a[80:83]
v_mfma_f32_16x16x32_bf16 a[84:87], v[124:127], v[188:191], a[84:87]
v_mfma_f32_16x16x32_bf16 a[88:91], v[124:127], v[192:195], a[88:91]
v_mfma_f32_16x16x32_bf16 a[92:95], v[124:127], v[196:199], a[92:95]
v_mfma_f32_16x16x32_bf16 a[96:99], v[128:131], v[184:187], a[96:99]
v_mfma_f32_16x16x32_bf16 a[100:103], v[128:131], v[188:191], a[100:103]
v_mfma_f32_16x16x32_bf16 a[104:107], v[128:131], v[192:195], a[104:107]
v_mfma_f32_16x16x32_bf16 a[108:111], v[128:131], v[196:199], a[108:111]
v_mfma_f32_16x16x32_bf16 a[112:115], v[132:135], v[184:187], a[112:115]
v_mfma_f32_16x16x32_bf16 a[116:119], v[132:135], v[188:191], a[116:119]
v_mfma_f32_16x16x32_bf16 a[120:123], v[132:135], v[192:195], a[120:123]
v_mfma_f32_16x16x32_bf16 a[124:127], v[132:135], v[196:199], a[124:127]
v_mfma_f32_16x16x32_bf16 a[128:131], v[136:139], v[184:187], a[128:131]
v_mfma_f32_16x16x32_bf16 a[132:135], v[136:139], v[188:191], a[132:135]
v_mfma_f32_16x16x32_bf16 a[136:139], v[136:139], v[192:195], a[136:139]
v_mfma_f32_16x16x32_bf16 a[140:143], v[136:139], v[196:199], a[140:143]
v_mfma_f32_16x16x32_bf16 a[144:147], v[140:143], v[184:187], a[144:147]
v_mfma_f32_16x16x32_bf16 a[148:151], v[140:143], v[188:191], a[148:151]
v_mfma_f32_16x16x32_bf16 a[152:155], v[140:143], v[192:195], a[152:155]
v_mfma_f32_16x16x32_bf16 a[156:159], v[140:143], v[196:199], a[156:159]
buffer_load_dwordx4 v[104:107], v1, s[4:7], s30 offen offset:2048
buffer_load_dwordx4 v[108:111], v1, s[4:7], s31 offen offset:2048
buffer_load_dwordx4 v[112:115], v1, s[4:7], s32 offen offset:2048
buffer_load_dwordx4 v[116:119], v1, s[4:7], s33 offen offset:2048
buffer_load_dwordx4 v[120:123], v1, s[4:7], s34 offen offset:2048
buffer_load_dwordx4 v[124:127], v1, s[4:7], s35 offen offset:2048
buffer_load_dwordx4 v[128:131], v1, s[4:7], s36 offen offset:2048
buffer_load_dwordx4 v[132:135], v1, s[4:7], s37 offen offset:2048
buffer_load_dwordx4 v[136:139], v1, s[4:7], s38 offen offset:2048
buffer_load_dwordx4 v[140:143], v1, s[4:7], s39 offen offset:2048
s_waitcnt vmcnt(36)
ds_read_b128 v[184:187], v1 offset:4096
ds_read_b128 v[188:191], v1 offset:28672
ds_read_b128 v[192:195], v6 offset:4096
ds_read_b128 v[196:199], v6 offset:28672
s_waitcnt lgkmcnt(4)
v_mfma_f32_16x16x32_bf16 a[0:3], v[144:147], v[200:203], a[0:3]
v_mfma_f32_16x16x32_bf16 a[4:7], v[144:147], v[204:207], a[4:7]
v_mfma_f32_16x16x32_bf16 a[8:11], v[144:147], v[208:211], a[8:11]
v_mfma_f32_16x16x32_bf16 a[12:15], v[144:147], v[212:215], a[12:15]
v_mfma_f32_16x16x32_bf16 a[16:19], v[148:151], v[200:203], a[16:19]
v_mfma_f32_16x16x32_bf16 a[20:23], v[148:151], v[204:207], a[20:23]
v_mfma_f32_16x16x32_bf16 a[24:27], v[148:151], v[208:211], a[24:27]
v_mfma_f32_16x16x32_bf16 a[28:31], v[148:151], v[212:215], a[28:31]
v_mfma_f32_16x16x32_bf16 a[32:35], v[152:155], v[200:203], a[32:35]
v_mfma_f32_16x16x32_bf16 a[36:39], v[152:155], v[204:207], a[36:39]
v_mfma_f32_16x16x32_bf16 a[40:43], v[152:155], v[208:211], a[40:43]
v_mfma_f32_16x16x32_bf16 a[44:47], v[152:155], v[212:215], a[44:47]
v_mfma_f32_16x16x32_bf16 a[48:51], v[156:159], v[200:203], a[48:51]
v_mfma_f32_16x16x32_bf16 a[52:55], v[156:159], v[204:207], a[52:55]
v_mfma_f32_16x16x32_bf16 a[56:59], v[156:159], v[208:211], a[56:59]
v_mfma_f32_16x16x32_bf16 a[60:63], v[156:159], v[212:215], a[60:63]
v_mfma_f32_16x16x32_bf16 a[64:67], v[160:163], v[200:203], a[64:67]
v_mfma_f32_16x16x32_bf16 a[68:71], v[160:163], v[204:207], a[68:71]
v_mfma_f32_16x16x32_bf16 a[72:75], v[160:163], v[208:211], a[72:75]
v_mfma_f32_16x16x32_bf16 a[76:79], v[160:163], v[212:215], a[76:79]
v_mfma_f32_16x16x32_bf16 a[80:83], v[164:167], v[200:203], a[80:83]
v_mfma_f32_16x16x32_bf16 a[84:87], v[164:167], v[204:207], a[84:87]
v_mfma_f32_16x16x32_bf16 a[88:91], v[164:167], v[208:211], a[88:91]
v_mfma_f32_16x16x32_bf16 a[92:95], v[164:167], v[212:215], a[92:95]
v_mfma_f32_16x16x32_bf16 a[96:99], v[168:171], v[200:203], a[96:99]
v_mfma_f32_16x16x32_bf16 a[100:103], v[168:171], v[204:207], a[100:103]
v_mfma_f32_16x16x32_bf16 a[104:107], v[168:171], v[208:211], a[104:107]
v_mfma_f32_16x16x32_bf16 a[108:111], v[168:171], v[212:215], a[108:111]
v_mfma_f32_16x16x32_bf16 a[112:115], v[172:175], v[200:203], a[112:115]
v_mfma_f32_16x16x32_bf16 a[116:119], v[172:175], v[204:207], a[116:119]
v_mfma_f32_16x16x32_bf16 a[120:123], v[172:175], v[208:211], a[120:123]
v_mfma_f32_16x16x32_bf16 a[124:127], v[172:175], v[212:215], a[124:127]
v_mfma_f32_16x16x32_bf16 a[128:131], v[176:179], v[200:203], a[128:131]
v_mfma_f32_16x16x32_bf16 a[132:135], v[176:179], v[204:207], a[132:135]
v_mfma_f32_16x16x32_bf16 a[136:139], v[176:179], v[208:211], a[136:139]
v_mfma_f32_16x16x32_bf16 a[140:143], v[176:179], v[212:215], a[140:143]
v_mfma_f32_16x16x32_bf16 a[144:147], v[180:183], v[200:203], a[144:147]
v_mfma_f32_16x16x32_bf16 a[148:151], v[180:183], v[204:207], a[148:151]
v_mfma_f32_16x16x32_bf16 a[152:155], v[180:183], v[208:211], a[152:155]
v_mfma_f32_16x16x32_bf16 a[156:159], v[180:183], v[212:215], a[156:159]
buffer_load_dwordx4 v[144:147], v1, s[4:7], s30 offen offset:3072
buffer_load_dwordx4 v[148:151], v1, s[4:7], s31 offen offset:3072
buffer_load_dwordx4 v[152:155], v1, s[4:7], s32 offen offset:3072
buffer_load_dwordx4 v[156:159], v1, s[4:7], s33 offen offset:3072
buffer_load_dwordx4 v[160:163], v1, s[4:7], s34 offen offset:3072
buffer_load_dwordx4 v[164:167], v1, s[4:7], s35 offen offset:3072
buffer_load_dwordx4 v[168:171], v1, s[4:7], s36 offen offset:3072
buffer_load_dwordx4 v[172:175], v1, s[4:7], s37 offen offset:3072
buffer_load_dwordx4 v[176:179], v1, s[4:7], s38 offen offset:3072
buffer_load_dwordx4 v[180:183], v1, s[4:7], s39 offen offset:3072
s_add_u32 s30, s30, 4096
s_add_u32 s31, s31, 4096
s_add_u32 s32, s32, 4096
s_add_u32 s33, s33, 4096
s_add_u32 s34, s34, 4096
s_add_u32 s35, s35, 4096
s_add_u32 s36, s36, 4096
s_add_u32 s37, s37, 4096
s_add_u32 s38, s38, 4096
s_add_u32 s39, s39, 4096
s_waitcnt vmcnt(36)
ds_read_b128 v[200:203], v1 offset:5120
ds_read_b128 v[204:207], v1 offset:29696
ds_read_b128 v[208:211], v6 offset:5120
ds_read_b128 v[212:215], v6 offset:29696
s_waitcnt lgkmcnt(4)
v_mfma_f32_16x16x32_bf16 a[0:3], v[24:27], v[184:187], a[0:3]
v_mfma_f32_16x16x32_bf16 a[4:7], v[24:27], v[188:191], a[4:7]
v_mfma_f32_16x16x32_bf16 a[8:11], v[24:27], v[192:195], a[8:11]
v_mfma_f32_16x16x32_bf16 a[12:15], v[24:27], v[196:199], a[12:15]
v_mfma_f32_16x16x32_bf16 a[16:19], v[28:31], v[184:187], a[16:19]
v_mfma_f32_16x16x32_bf16 a[20:23], v[28:31], v[188:191], a[20:23]
v_mfma_f32_16x16x32_bf16 a[24:27], v[28:31], v[192:195], a[24:27]
v_mfma_f32_16x16x32_bf16 a[28:31], v[28:31], v[196:199], a[28:31]
v_mfma_f32_16x16x32_bf16 a[32:35], v[32:35], v[184:187], a[32:35]
v_mfma_f32_16x16x32_bf16 a[36:39], v[32:35], v[188:191], a[36:39]
v_mfma_f32_16x16x32_bf16 a[40:43], v[32:35], v[192:195], a[40:43]
v_mfma_f32_16x16x32_bf16 a[44:47], v[32:35], v[196:199], a[44:47]
v_mfma_f32_16x16x32_bf16 a[48:51], v[36:39], v[184:187], a[48:51]
v_mfma_f32_16x16x32_bf16 a[52:55], v[36:39], v[188:191], a[52:55]
v_mfma_f32_16x16x32_bf16 a[56:59], v[36:39], v[192:195], a[56:59]
v_mfma_f32_16x16x32_bf16 a[60:63], v[36:39], v[196:199], a[60:63]
v_mfma_f32_16x16x32_bf16 a[64:67], v[40:43], v[184:187], a[64:67]
v_mfma_f32_16x16x32_bf16 a[68:71], v[40:43], v[188:191], a[68:71]
v_mfma_f32_16x16x32_bf16 a[72:75], v[40:43], v[192:195], a[72:75]
v_mfma_f32_16x16x32_bf16 a[76:79], v[40:43], v[196:199], a[76:79]
v_mfma_f32_16x16x32_bf16 a[80:83], v[44:47], v[184:187], a[80:83]
v_mfma_f32_16x16x32_bf16 a[84:87], v[44:47], v[188:191], a[84:87]
v_mfma_f32_16x16x32_bf16 a[88:91], v[44:47], v[192:195], a[88:91]
v_mfma_f32_16x16x32_bf16 a[92:95], v[44:47], v[196:199], a[92:95]
v_mfma_f32_16x16x32_bf16 a[96:99], v[48:51], v[184:187], a[96:99]
v_mfma_f32_16x16x32_bf16 a[100:103], v[48:51], v[188:191], a[100:103]
v_mfma_f32_16x16x32_bf16 a[104:107], v[48:51], v[192:195], a[104:107]
v_mfma_f32_16x16x32_bf16 a[108:111], v[48:51], v[196:199], a[108:111]
v_mfma_f32_16x16x32_bf16 a[112:115], v[52:55], v[184:187], a[112:115]
v_mfma_f32_16x16x32_bf16 a[116:119], v[52:55], v[188:191], a[116:119]
v_mfma_f32_16x16x32_bf16 a[120:123], v[52:55], v[192:195], a[120:123]
v_mfma_f32_16x16x32_bf16 a[124:127], v[52:55], v[196:199], a[124:127]
v_mfma_f32_16x16x32_bf16 a[128:131], v[56:59], v[184:187], a[128:131]
v_mfma_f32_16x16x32_bf16 a[132:135], v[56:59], v[188:191], a[132:135]
v_mfma_f32_16x16x32_bf16 a[136:139], v[56:59], v[192:195], a[136:139]
v_mfma_f32_16x16x32_bf16 a[140:143], v[56:59], v[196:199], a[140:143]
v_mfma_f32_16x16x32_bf16 a[144:147], v[60:63], v[184:187], a[144:147]
v_mfma_f32_16x16x32_bf16 a[148:151], v[60:63], v[188:191], a[148:151]
v_mfma_f32_16x16x32_bf16 a[152:155], v[60:63], v[192:195], a[152:155]
v_mfma_f32_16x16x32_bf16 a[156:159], v[60:63], v[196:199], a[156:159]
buffer_load_dwordx4 v[24:27], v1, s[4:7], s30 offen offset:0
buffer_load_dwordx4 v[28:31], v1, s[4:7], s31 offen offset:0
buffer_load_dwordx4 v[32:35], v1, s[4:7], s32 offen offset:0
buffer_load_dwordx4 v[36:39], v1, s[4:7], s33 offen offset:0
buffer_load_dwordx4 v[40:43], v1, s[4:7], s34 offen offset:0
buffer_load_dwordx4 v[44:47], v1, s[4:7], s35 offen offset:0
buffer_load_dwordx4 v[48:51], v1, s[4:7], s36 offen offset:0
buffer_load_dwordx4 v[52:55], v1, s[4:7], s37 offen offset:0
buffer_load_dwordx4 v[56:59], v1, s[4:7], s38 offen offset:0
buffer_load_dwordx4 v[60:63], v1, s[4:7], s39 offen offset:0
s_barrier
s_waitcnt vmcnt(30)
ds_read_b128 v[184:187], v1 offset:6144
ds_read_b128 v[188:191], v1 offset:30720
ds_read_b128 v[192:195], v6 offset:6144
ds_read_b128 v[196:199], v6 offset:30720
s_waitcnt lgkmcnt(4)
v_mfma_f32_16x16x32_bf16 a[0:3], v[64:67], v[200:203], a[0:3]
v_mfma_f32_16x16x32_bf16 a[4:7], v[64:67], v[204:207], a[4:7]
v_mfma_f32_16x16x32_bf16 a[8:11], v[64:67], v[208:211], a[8:11]
v_mfma_f32_16x16x32_bf16 a[12:15], v[64:67], v[212:215], a[12:15]
v_mfma_f32_16x16x32_bf16 a[16:19], v[68:71], v[200:203], a[16:19]
v_mfma_f32_16x16x32_bf16 a[20:23], v[68:71], v[204:207], a[20:23]
v_mfma_f32_16x16x32_bf16 a[24:27], v[68:71], v[208:211], a[24:27]
v_mfma_f32_16x16x32_bf16 a[28:31], v[68:71], v[212:215], a[28:31]
v_mfma_f32_16x16x32_bf16 a[32:35], v[72:75], v[200:203], a[32:35]
v_mfma_f32_16x16x32_bf16 a[36:39], v[72:75], v[204:207], a[36:39]
v_mfma_f32_16x16x32_bf16 a[40:43], v[72:75], v[208:211], a[40:43]
v_mfma_f32_16x16x32_bf16 a[44:47], v[72:75], v[212:215], a[44:47]
v_mfma_f32_16x16x32_bf16 a[48:51], v[76:79], v[200:203], a[48:51]
v_mfma_f32_16x16x32_bf16 a[52:55], v[76:79], v[204:207], a[52:55]
v_mfma_f32_16x16x32_bf16 a[56:59], v[76:79], v[208:211], a[56:59]
v_mfma_f32_16x16x32_bf16 a[60:63], v[76:79], v[212:215], a[60:63]
v_mfma_f32_16x16x32_bf16 a[64:67], v[80:83], v[200:203], a[64:67]
v_mfma_f32_16x16x32_bf16 a[68:71], v[80:83], v[204:207], a[68:71]
v_mfma_f32_16x16x32_bf16 a[72:75], v[80:83], v[208:211], a[72:75]
v_mfma_f32_16x16x32_bf16 a[76:79], v[80:83], v[212:215], a[76:79]
v_mfma_f32_16x16x32_bf16 a[80:83], v[84:87], v[200:203], a[80:83]
v_mfma_f32_16x16x32_bf16 a[84:87], v[84:87], v[204:207], a[84:87]
v_mfma_f32_16x16x32_bf16 a[88:91], v[84:87], v[208:211], a[88:91]
v_mfma_f32_16x16x32_bf16 a[92:95], v[84:87], v[212:215], a[92:95]
v_mfma_f32_16x16x32_bf16 a[96:99], v[88:91], v[200:203], a[96:99]
v_mfma_f32_16x16x32_bf16 a[100:103], v[88:91], v[204:207], a[100:103]
v_mfma_f32_16x16x32_bf16 a[104:107], v[88:91], v[208:211], a[104:107]
v_mfma_f32_16x16x32_bf16 a[108:111], v[88:91], v[212:215], a[108:111]
v_mfma_f32_16x16x32_bf16 a[112:115], v[92:95], v[200:203], a[112:115]
v_mfma_f32_16x16x32_bf16 a[116:119], v[92:95], v[204:207], a[116:119]
v_mfma_f32_16x16x32_bf16 a[120:123], v[92:95], v[208:211], a[120:123]
v_mfma_f32_16x16x32_bf16 a[124:127], v[92:95], v[212:215], a[124:127]
v_mfma_f32_16x16x32_bf16 a[128:131], v[96:99], v[200:203], a[128:131]
v_mfma_f32_16x16x32_bf16 a[132:135], v[96:99], v[204:207], a[132:135]
v_mfma_f32_16x16x32_bf16 a[136:139], v[96:99], v[208:211], a[136:139]
v_mfma_f32_16x16x32_bf16 a[140:143], v[96:99], v[212:215], a[140:143]
v_mfma_f32_16x16x32_bf16 a[144:147], v[100:103], v[200:203], a[144:147]
v_mfma_f32_16x16x32_bf16 a[148:151], v[100:103], v[204:207], a[148:151]
v_mfma_f32_16x16x32_bf16 a[152:155], v[100:103], v[208:211], a[152:155]
v_mfma_f32_16x16x32_bf16 a[156:159], v[100:103], v[212:215], a[156:159]
buffer_load_dwordx4 v[64:67], v1, s[4:7], s30 offen offset:1024
buffer_load_dwordx4 v[68:71], v1, s[4:7], s31 offen offset:1024
buffer_load_dwordx4 v[72:75], v1, s[4:7], s32 offen offset:1024
buffer_load_dwordx4 v[76:79], v1, s[4:7], s33 offen offset:1024
buffer_load_dwordx4 v[80:83], v1, s[4:7], s34 offen offset:1024
buffer_load_dwordx4 v[84:87], v1, s[4:7], s35 offen offset:1024
buffer_load_dwordx4 v[88:91], v1, s[4:7], s36 offen offset:1024
buffer_load_dwordx4 v[92:95], v1, s[4:7], s37 offen offset:1024
buffer_load_dwordx4 v[96:99], v1, s[4:7], s38 offen offset:1024
buffer_load_dwordx4 v[100:103], v1, s[4:7], s39 offen offset:1024
s_waitcnt vmcnt(30)
ds_read_b128 v[200:203], v1 offset:7168
ds_read_b128 v[204:207], v1 offset:31744
ds_read_b128 v[208:211], v6 offset:7168
ds_read_b128 v[212:215], v6 offset:31744
s_waitcnt lgkmcnt(4)
v_mfma_f32_16x16x32_bf16 a[0:3], v[104:107], v[184:187], a[0:3]
v_mfma_f32_16x16x32_bf16 a[4:7], v[104:107], v[188:191], a[4:7]
v_mfma_f32_16x16x32_bf16 a[8:11], v[104:107], v[192:195], a[8:11]
v_mfma_f32_16x16x32_bf16 a[12:15], v[104:107], v[196:199], a[12:15]
v_mfma_f32_16x16x32_bf16 a[16:19], v[108:111], v[184:187], a[16:19]
v_mfma_f32_16x16x32_bf16 a[20:23], v[108:111], v[188:191], a[20:23]
v_mfma_f32_16x16x32_bf16 a[24:27], v[108:111], v[192:195], a[24:27]
v_mfma_f32_16x16x32_bf16 a[28:31], v[108:111], v[196:199], a[28:31]
v_mfma_f32_16x16x32_bf16 a[32:35], v[112:115], v[184:187], a[32:35]
v_mfma_f32_16x16x32_bf16 a[36:39], v[112:115], v[188:191], a[36:39]
v_mfma_f32_16x16x32_bf16 a[40:43], v[112:115], v[192:195], a[40:43]
v_mfma_f32_16x16x32_bf16 a[44:47], v[112:115], v[196:199], a[44:47]
v_mfma_f32_16x16x32_bf16 a[48:51], v[116:119], v[184:187], a[48:51]
v_mfma_f32_16x16x32_bf16 a[52:55], v[116:119], v[188:191], a[52:55]
v_mfma_f32_16x16x32_bf16 a[56:59], v[116:119], v[192:195], a[56:59]
v_mfma_f32_16x16x32_bf16 a[60:63], v[116:119], v[196:199], a[60:63]
v_mfma_f32_16x16x32_bf16 a[64:67], v[120:123], v[184:187], a[64:67]
v_mfma_f32_16x16x32_bf16 a[68:71], v[120:123], v[188:191], a[68:71]
v_mfma_f32_16x16x32_bf16 a[72:75], v[120:123], v[192:195], a[72:75]
v_mfma_f32_16x16x32_bf16 a[76:79], v[120:123], v[196:199], a[76:79]
v_mfma_f32_16x16x32_bf16 a[80:83], v[124:127], v[184:187], a[80:83]
v_mfma_f32_16x16x32_bf16 a[84:87], v[124:127], v[188:191], a[84:87]
v_mfma_f32_16x16x32_bf16 a[88:91], v[124:127], v[192:195], a[88:91]
v_mfma_f32_16x16x32_bf16 a[92:95], v[124:127], v[196:199], a[92:95]
v_mfma_f32_16x16x32_bf16 a[96:99], v[128:131], v[184:187], a[96:99]
v_mfma_f32_16x16x32_bf16 a[100:103], v[128:131], v[188:191], a[100:103]
v_mfma_f32_16x16x32_bf16 a[104:107], v[128:131], v[192:195], a[104:107]
v_mfma_f32_16x16x32_bf16 a[108:111], v[128:131], v[196:199], a[108:111]
v_mfma_f32_16x16x32_bf16 a[112:115], v[132:135], v[184:187], a[112:115]
v_mfma_f32_16x16x32_bf16 a[116:119], v[132:135], v[188:191], a[116:119]
v_mfma_f32_16x16x32_bf16 a[120:123], v[132:135], v[192:195], a[120:123]
v_mfma_f32_16x16x32_bf16 a[124:127], v[132:135], v[196:199], a[124:127]
v_mfma_f32_16x16x32_bf16 a[128:131], v[136:139], v[184:187], a[128:131]
v_mfma_f32_16x16x32_bf16 a[132:135], v[136:139], v[188:191], a[132:135]
v_mfma_f32_16x16x32_bf16 a[136:139], v[136:139], v[192:195], a[136:139]
v_mfma_f32_16x16x32_bf16 a[140:143], v[136:139], v[196:199], a[140:143]
v_mfma_f32_16x16x32_bf16 a[144:147], v[140:143], v[184:187], a[144:147]
v_mfma_f32_16x16x32_bf16 a[148:151], v[140:143], v[188:191], a[148:151]
v_mfma_f32_16x16x32_bf16 a[152:155], v[140:143], v[192:195], a[152:155]
v_mfma_f32_16x16x32_bf16 a[156:159], v[140:143], v[196:199], a[156:159]
buffer_load_dwordx4 v[104:107], v1, s[4:7], s30 offen offset:2048
buffer_load_dwordx4 v[108:111], v1, s[4:7], s31 offen offset:2048
buffer_load_dwordx4 v[112:115], v1, s[4:7], s32 offen offset:2048
buffer_load_dwordx4 v[116:119], v1, s[4:7], s33 offen offset:2048
buffer_load_dwordx4 v[120:123], v1, s[4:7], s34 offen offset:2048
buffer_load_dwordx4 v[124:127], v1, s[4:7], s35 offen offset:2048
buffer_load_dwordx4 v[128:131], v1, s[4:7], s36 offen offset:2048
buffer_load_dwordx4 v[132:135], v1, s[4:7], s37 offen offset:2048
buffer_load_dwordx4 v[136:139], v1, s[4:7], s38 offen offset:2048
buffer_load_dwordx4 v[140:143], v1, s[4:7], s39 offen offset:2048
s_waitcnt vmcnt(30)
ds_read_b128 v[184:187], v1 offset:8192
ds_read_b128 v[188:191], v1 offset:32768
ds_read_b128 v[192:195], v6 offset:8192
ds_read_b128 v[196:199], v6 offset:32768
s_waitcnt lgkmcnt(4)
v_mfma_f32_16x16x32_bf16 a[0:3], v[144:147], v[200:203], a[0:3]
v_mfma_f32_16x16x32_bf16 a[4:7], v[144:147], v[204:207], a[4:7]
v_mfma_f32_16x16x32_bf16 a[8:11], v[144:147], v[208:211], a[8:11]
v_mfma_f32_16x16x32_bf16 a[12:15], v[144:147], v[212:215], a[12:15]
v_mfma_f32_16x16x32_bf16 a[16:19], v[148:151], v[200:203], a[16:19]
v_mfma_f32_16x16x32_bf16 a[20:23], v[148:151], v[204:207], a[20:23]
v_mfma_f32_16x16x32_bf16 a[24:27], v[148:151], v[208:211], a[24:27]
v_mfma_f32_16x16x32_bf16 a[28:31], v[148:151], v[212:215], a[28:31]
v_mfma_f32_16x16x32_bf16 a[32:35], v[152:155], v[200:203], a[32:35]
v_mfma_f32_16x16x32_bf16 a[36:39], v[152:155], v[204:207], a[36:39]
v_mfma_f32_16x16x32_bf16 a[40:43], v[152:155], v[208:211], a[40:43]
v_mfma_f32_16x16x32_bf16 a[44:47], v[152:155], v[212:215], a[44:47]
v_mfma_f32_16x16x32_bf16 a[48:51], v[156:159], v[200:203], a[48:51]
v_mfma_f32_16x16x32_bf16 a[52:55], v[156:159], v[204:207], a[52:55]
v_mfma_f32_16x16x32_bf16 a[56:59], v[156:159], v[208:211], a[56:59]
v_mfma_f32_16x16x32_bf16 a[60:63], v[156:159], v[212:215], a[60:63]
v_mfma_f32_16x16x32_bf16 a[64:67], v[160:163], v[200:203], a[64:67]
v_mfma_f32_16x16x32_bf16 a[68:71], v[160:163], v[204:207], a[68:71]
v_mfma_f32_16x16x32_bf16 a[72:75], v[160:163], v[208:211], a[72:75]
v_mfma_f32_16x16x32_bf16 a[76:79], v[160:163], v[212:215], a[76:79]
v_mfma_f32_16x16x32_bf16 a[80:83], v[164:167], v[200:203], a[80:83]
v_mfma_f32_16x16x32_bf16 a[84:87], v[164:167], v[204:207], a[84:87]
v_mfma_f32_16x16x32_bf16 a[88:91], v[164:167], v[208:211], a[88:91]
v_mfma_f32_16x16x32_bf16 a[92:95], v[164:167], v[212:215], a[92:95]
v_mfma_f32_16x16x32_bf16 a[96:99], v[168:171], v[200:203], a[96:99]
v_mfma_f32_16x16x32_bf16 a[100:103], v[168:171], v[204:207], a[100:103]
v_mfma_f32_16x16x32_bf16 a[104:107], v[168:171], v[208:211], a[104:107]
v_mfma_f32_16x16x32_bf16 a[108:111], v[168:171], v[212:215], a[108:111]
v_mfma_f32_16x16x32_bf16 a[112:115], v[172:175], v[200:203], a[112:115]
v_mfma_f32_16x16x32_bf16 a[116:119], v[172:175], v[204:207], a[116:119]
v_mfma_f32_16x16x32_bf16 a[120:123], v[172:175], v[208:211], a[120:123]
v_mfma_f32_16x16x32_bf16 a[124:127], v[172:175], v[212:215], a[124:127]
v_mfma_f32_16x16x32_bf16 a[128:131], v[176:179], v[200:203], a[128:131]
v_mfma_f32_16x16x32_bf16 a[132:135], v[176:179], v[204:207], a[132:135]
v_mfma_f32_16x16x32_bf16 a[136:139], v[176:179], v[208:211], a[136:139]
v_mfma_f32_16x16x32_bf16 a[140:143], v[176:179], v[212:215], a[140:143]
v_mfma_f32_16x16x32_bf16 a[144:147], v[180:183], v[200:203], a[144:147]
v_mfma_f32_16x16x32_bf16 a[148:151], v[180:183], v[204:207], a[148:151]
v_mfma_f32_16x16x32_bf16 a[152:155], v[180:183], v[208:211], a[152:155]
v_mfma_f32_16x16x32_bf16 a[156:159], v[180:183], v[212:215], a[156:159]
buffer_load_dwordx4 v[144:147], v1, s[4:7], s30 offen offset:3072
buffer_load_dwordx4 v[148:151], v1, s[4:7], s31 offen offset:3072
buffer_load_dwordx4 v[152:155], v1, s[4:7], s32 offen offset:3072
buffer_load_dwordx4 v[156:159], v1, s[4:7], s33 offen offset:3072
buffer_load_dwordx4 v[160:163], v1, s[4:7], s34 offen offset:3072
buffer_load_dwordx4 v[164:167], v1, s[4:7], s35 offen offset:3072
buffer_load_dwordx4 v[168:171], v1, s[4:7], s36 offen offset:3072
buffer_load_dwordx4 v[172:175], v1, s[4:7], s37 offen offset:3072
buffer_load_dwordx4 v[176:179], v1, s[4:7], s38 offen offset:3072
buffer_load_dwordx4 v[180:183], v1, s[4:7], s39 offen offset:3072
s_add_u32 s30, s30, 4096
s_add_u32 s31, s31, 4096
s_add_u32 s32, s32, 4096
s_add_u32 s33, s33, 4096
s_add_u32 s34, s34, 4096
s_add_u32 s35, s35, 4096
s_add_u32 s36, s36, 4096
s_add_u32 s37, s37, 4096
s_add_u32 s38, s38, 4096
s_add_u32 s39, s39, 4096
s_waitcnt vmcnt(30)
ds_read_b128 v[200:203], v1 offset:9216
ds_read_b128 v[204:207], v1 offset:33792
ds_read_b128 v[208:211], v6 offset:9216
ds_read_b128 v[212:215], v6 offset:33792
s_waitcnt lgkmcnt(4)
v_mfma_f32_16x16x32_bf16 a[0:3], v[24:27], v[184:187], a[0:3]
v_mfma_f32_16x16x32_bf16 a[4:7], v[24:27], v[188:191], a[4:7]
v_mfma_f32_16x16x32_bf16 a[8:11], v[24:27], v[192:195], a[8:11]
v_mfma_f32_16x16x32_bf16 a[12:15], v[24:27], v[196:199], a[12:15]
v_mfma_f32_16x16x32_bf16 a[16:19], v[28:31], v[184:187], a[16:19]
v_mfma_f32_16x16x32_bf16 a[20:23], v[28:31], v[188:191], a[20:23]
v_mfma_f32_16x16x32_bf16 a[24:27], v[28:31], v[192:195], a[24:27]
v_mfma_f32_16x16x32_bf16 a[28:31], v[28:31], v[196:199], a[28:31]
v_mfma_f32_16x16x32_bf16 a[32:35], v[32:35], v[184:187], a[32:35]
v_mfma_f32_16x16x32_bf16 a[36:39], v[32:35], v[188:191], a[36:39]
v_mfma_f32_16x16x32_bf16 a[40:43], v[32:35], v[192:195], a[40:43]
v_mfma_f32_16x16x32_bf16 a[44:47], v[32:35], v[196:199], a[44:47]
v_mfma_f32_16x16x32_bf16 a[48:51], v[36:39], v[184:187], a[48:51]
v_mfma_f32_16x16x32_bf16 a[52:55], v[36:39], v[188:191], a[52:55]
v_mfma_f32_16x16x32_bf16 a[56:59], v[36:39], v[192:195], a[56:59]
v_mfma_f32_16x16x32_bf16 a[60:63], v[36:39], v[196:199], a[60:63]
v_mfma_f32_16x16x32_bf16 a[64:67], v[40:43], v[184:187], a[64:67]
v_mfma_f32_16x16x32_bf16 a[68:71], v[40:43], v[188:191], a[68:71]
v_mfma_f32_16x16x32_bf16 a[72:75], v[40:43], v[192:195], a[72:75]
v_mfma_f32_16x16x32_bf16 a[76:79], v[40:43], v[196:199], a[76:79]
v_mfma_f32_16x16x32_bf16 a[80:83], v[44:47], v[184:187], a[80:83]
v_mfma_f32_16x16x32_bf16 a[84:87], v[44:47], v[188:191], a[84:87]
v_mfma_f32_16x16x32_bf16 a[88:91], v[44:47], v[192:195], a[88:91]
v_mfma_f32_16x16x32_bf16 a[92:95], v[44:47], v[196:199], a[92:95]
v_mfma_f32_16x16x32_bf16 a[96:99], v[48:51], v[184:187], a[96:99]
v_mfma_f32_16x16x32_bf16 a[100:103], v[48:51], v[188:191], a[100:103]
v_mfma_f32_16x16x32_bf16 a[104:107], v[48:51], v[192:195], a[104:107]
v_mfma_f32_16x16x32_bf16 a[108:111], v[48:51], v[196:199], a[108:111]
v_mfma_f32_16x16x32_bf16 a[112:115], v[52:55], v[184:187], a[112:115]
v_mfma_f32_16x16x32_bf16 a[116:119], v[52:55], v[188:191], a[116:119]
v_mfma_f32_16x16x32_bf16 a[120:123], v[52:55], v[192:195], a[120:123]
v_mfma_f32_16x16x32_bf16 a[124:127], v[52:55], v[196:199], a[124:127]
v_mfma_f32_16x16x32_bf16 a[128:131], v[56:59], v[184:187], a[128:131]
v_mfma_f32_16x16x32_bf16 a[132:135], v[56:59], v[188:191], a[132:135]
v_mfma_f32_16x16x32_bf16 a[136:139], v[56:59], v[192:195], a[136:139]
v_mfma_f32_16x16x32_bf16 a[140:143], v[56:59], v[196:199], a[140:143]
v_mfma_f32_16x16x32_bf16 a[144:147], v[60:63], v[184:187], a[144:147]
v_mfma_f32_16x16x32_bf16 a[148:151], v[60:63], v[188:191], a[148:151]
v_mfma_f32_16x16x32_bf16 a[152:155], v[60:63], v[192:195], a[152:155]
v_mfma_f32_16x16x32_bf16 a[156:159], v[60:63], v[196:199], a[156:159]
buffer_load_dwordx4 v[24:27], v1, s[4:7], s30 offen offset:0
buffer_load_dwordx4 v[28:31], v1, s[4:7], s31 offen offset:0
buffer_load_dwordx4 v[32:35], v1, s[4:7], s32 offen offset:0
buffer_load_dwordx4 v[36:39], v1, s[4:7], s33 offen offset:0
buffer_load_dwordx4 v[40:43], v1, s[4:7], s34 offen offset:0
buffer_load_dwordx4 v[44:47], v1, s[4:7], s35 offen offset:0
buffer_load_dwordx4 v[48:51], v1, s[4:7], s36 offen offset:0
buffer_load_dwordx4 v[52:55], v1, s[4:7], s37 offen offset:0
buffer_load_dwordx4 v[56:59], v1, s[4:7], s38 offen offset:0
buffer_load_dwordx4 v[60:63], v1, s[4:7], s39 offen offset:0
s_waitcnt vmcnt(30)
ds_read_b128 v[184:187], v1 offset:10240
ds_read_b128 v[188:191], v1 offset:34816
ds_read_b128 v[192:195], v6 offset:10240
ds_read_b128 v[196:199], v6 offset:34816
s_waitcnt lgkmcnt(4)
v_mfma_f32_16x16x32_bf16 a[0:3], v[64:67], v[200:203], a[0:3]
v_mfma_f32_16x16x32_bf16 a[4:7], v[64:67], v[204:207], a[4:7]
v_mfma_f32_16x16x32_bf16 a[8:11], v[64:67], v[208:211], a[8:11]
v_mfma_f32_16x16x32_bf16 a[12:15], v[64:67], v[212:215], a[12:15]
v_mfma_f32_16x16x32_bf16 a[16:19], v[68:71], v[200:203], a[16:19]
v_mfma_f32_16x16x32_bf16 a[20:23], v[68:71], v[204:207], a[20:23]
v_mfma_f32_16x16x32_bf16 a[24:27], v[68:71], v[208:211], a[24:27]
v_mfma_f32_16x16x32_bf16 a[28:31], v[68:71], v[212:215], a[28:31]
v_mfma_f32_16x16x32_bf16 a[32:35], v[72:75], v[200:203], a[32:35]
v_mfma_f32_16x16x32_bf16 a[36:39], v[72:75], v[204:207], a[36:39]
v_mfma_f32_16x16x32_bf16 a[40:43], v[72:75], v[208:211], a[40:43]
v_mfma_f32_16x16x32_bf16 a[44:47], v[72:75], v[212:215], a[44:47]
v_mfma_f32_16x16x32_bf16 a[48:51], v[76:79], v[200:203], a[48:51]
v_mfma_f32_16x16x32_bf16 a[52:55], v[76:79], v[204:207], a[52:55]
v_mfma_f32_16x16x32_bf16 a[56:59], v[76:79], v[208:211], a[56:59]
v_mfma_f32_16x16x32_bf16 a[60:63], v[76:79], v[212:215], a[60:63]
v_mfma_f32_16x16x32_bf16 a[64:67], v[80:83], v[200:203], a[64:67]
v_mfma_f32_16x16x32_bf16 a[68:71], v[80:83], v[204:207], a[68:71]
v_mfma_f32_16x16x32_bf16 a[72:75], v[80:83], v[208:211], a[72:75]
v_mfma_f32_16x16x32_bf16 a[76:79], v[80:83], v[212:215], a[76:79]
v_mfma_f32_16x16x32_bf16 a[80:83], v[84:87], v[200:203], a[80:83]
v_mfma_f32_16x16x32_bf16 a[84:87], v[84:87], v[204:207], a[84:87]
v_mfma_f32_16x16x32_bf16 a[88:91], v[84:87], v[208:211], a[88:91]
v_mfma_f32_16x16x32_bf16 a[92:95], v[84:87], v[212:215], a[92:95]
v_mfma_f32_16x16x32_bf16 a[96:99], v[88:91], v[200:203], a[96:99]
v_mfma_f32_16x16x32_bf16 a[100:103], v[88:91], v[204:207], a[100:103]
v_mfma_f32_16x16x32_bf16 a[104:107], v[88:91], v[208:211], a[104:107]
v_mfma_f32_16x16x32_bf16 a[108:111], v[88:91], v[212:215], a[108:111]
v_mfma_f32_16x16x32_bf16 a[112:115], v[92:95], v[200:203], a[112:115]
v_mfma_f32_16x16x32_bf16 a[116:119], v[92:95], v[204:207], a[116:119]
v_mfma_f32_16x16x32_bf16 a[120:123], v[92:95], v[208:211], a[120:123]
v_mfma_f32_16x16x32_bf16 a[124:127], v[92:95], v[212:215], a[124:127]
v_mfma_f32_16x16x32_bf16 a[128:131], v[96:99], v[200:203], a[128:131]
v_mfma_f32_16x16x32_bf16 a[132:135], v[96:99], v[204:207], a[132:135]
v_mfma_f32_16x16x32_bf16 a[136:139], v[96:99], v[208:211], a[136:139]
v_mfma_f32_16x16x32_bf16 a[140:143], v[96:99], v[212:215], a[140:143]
v_mfma_f32_16x16x32_bf16 a[144:147], v[100:103], v[200:203], a[144:147]
v_mfma_f32_16x16x32_bf16 a[148:151], v[100:103], v[204:207], a[148:151]
v_mfma_f32_16x16x32_bf16 a[152:155], v[100:103], v[208:211], a[152:155]
v_mfma_f32_16x16x32_bf16 a[156:159], v[100:103], v[212:215], a[156:159]
buffer_load_dwordx4 v[64:67], v1, s[4:7], s30 offen offset:1024
buffer_load_dwordx4 v[68:71], v1, s[4:7], s31 offen offset:1024
buffer_load_dwordx4 v[72:75], v1, s[4:7], s32 offen offset:1024
buffer_load_dwordx4 v[76:79], v1, s[4:7], s33 offen offset:1024
buffer_load_dwordx4 v[80:83], v1, s[4:7], s34 offen offset:1024
buffer_load_dwordx4 v[84:87], v1, s[4:7], s35 offen offset:1024
buffer_load_dwordx4 v[88:91], v1, s[4:7], s36 offen offset:1024
buffer_load_dwordx4 v[92:95], v1, s[4:7], s37 offen offset:1024
buffer_load_dwordx4 v[96:99], v1, s[4:7], s38 offen offset:1024
buffer_load_dwordx4 v[100:103], v1, s[4:7], s39 offen offset:1024
s_waitcnt vmcnt(30)
ds_read_b128 v[200:203], v1 offset:11264
ds_read_b128 v[204:207], v1 offset:35840
ds_read_b128 v[208:211], v6 offset:11264
ds_read_b128 v[212:215], v6 offset:35840
s_waitcnt lgkmcnt(4)
v_mfma_f32_16x16x32_bf16 a[0:3], v[104:107], v[184:187], a[0:3]
v_mfma_f32_16x16x32_bf16 a[4:7], v[104:107], v[188:191], a[4:7]
v_mfma_f32_16x16x32_bf16 a[8:11], v[104:107], v[192:195], a[8:11]
v_mfma_f32_16x16x32_bf16 a[12:15], v[104:107], v[196:199], a[12:15]
v_mfma_f32_16x16x32_bf16 a[16:19], v[108:111], v[184:187], a[16:19]
v_mfma_f32_16x16x32_bf16 a[20:23], v[108:111], v[188:191], a[20:23]
v_mfma_f32_16x16x32_bf16 a[24:27], v[108:111], v[192:195], a[24:27]
v_mfma_f32_16x16x32_bf16 a[28:31], v[108:111], v[196:199], a[28:31]
v_mfma_f32_16x16x32_bf16 a[32:35], v[112:115], v[184:187], a[32:35]
v_mfma_f32_16x16x32_bf16 a[36:39], v[112:115], v[188:191], a[36:39]
v_mfma_f32_16x16x32_bf16 a[40:43], v[112:115], v[192:195], a[40:43]
v_mfma_f32_16x16x32_bf16 a[44:47], v[112:115], v[196:199], a[44:47]
v_mfma_f32_16x16x32_bf16 a[48:51], v[116:119], v[184:187], a[48:51]
v_mfma_f32_16x16x32_bf16 a[52:55], v[116:119], v[188:191], a[52:55]
v_mfma_f32_16x16x32_bf16 a[56:59], v[116:119], v[192:195], a[56:59]
v_mfma_f32_16x16x32_bf16 a[60:63], v[116:119], v[196:199], a[60:63]
v_mfma_f32_16x16x32_bf16 a[64:67], v[120:123], v[184:187], a[64:67]
v_mfma_f32_16x16x32_bf16 a[68:71], v[120:123], v[188:191], a[68:71]
v_mfma_f32_16x16x32_bf16 a[72:75], v[120:123], v[192:195], a[72:75]
v_mfma_f32_16x16x32_bf16 a[76:79], v[120:123], v[196:199], a[76:79]
v_mfma_f32_16x16x32_bf16 a[80:83], v[124:127], v[184:187], a[80:83]
v_mfma_f32_16x16x32_bf16 a[84:87], v[124:127], v[188:191], a[84:87]
v_mfma_f32_16x16x32_bf16 a[88:91], v[124:127], v[192:195], a[88:91]
v_mfma_f32_16x16x32_bf16 a[92:95], v[124:127], v[196:199], a[92:95]
v_mfma_f32_16x16x32_bf16 a[96:99], v[128:131], v[184:187], a[96:99]
v_mfma_f32_16x16x32_bf16 a[100:103], v[128:131], v[188:191], a[100:103]
v_mfma_f32_16x16x32_bf16 a[104:107], v[128:131], v[192:195], a[104:107]
v_mfma_f32_16x16x32_bf16 a[108:111], v[128:131], v[196:199], a[108:111]
v_mfma_f32_16x16x32_bf16 a[112:115], v[132:135], v[184:187], a[112:115]
v_mfma_f32_16x16x32_bf16 a[116:119], v[132:135], v[188:191], a[116:119]
v_mfma_f32_16x16x32_bf16 a[120:123], v[132:135], v[192:195], a[120:123]
v_mfma_f32_16x16x32_bf16 a[124:127], v[132:135], v[196:199], a[124:127]
v_mfma_f32_16x16x32_bf16 a[128:131], v[136:139], v[184:187], a[128:131]
v_mfma_f32_16x16x32_bf16 a[132:135], v[136:139], v[188:191], a[132:135]
v_mfma_f32_16x16x32_bf16 a[136:139], v[136:139], v[192:195], a[136:139]
v_mfma_f32_16x16x32_bf16 a[140:143], v[136:139], v[196:199], a[140:143]
v_mfma_f32_16x16x32_bf16 a[144:147], v[140:143], v[184:187], a[144:147]
v_mfma_f32_16x16x32_bf16 a[148:151], v[140:143], v[188:191], a[148:151]
v_mfma_f32_16x16x32_bf16 a[152:155], v[140:143], v[192:195], a[152:155]
v_mfma_f32_16x16x32_bf16 a[156:159], v[140:143], v[196:199], a[156:159]
buffer_load_dwordx4 v[104:107], v1, s[4:7], s30 offen offset:2048
buffer_load_dwordx4 v[108:111], v1, s[4:7], s31 offen offset:2048
buffer_load_dwordx4 v[112:115], v1, s[4:7], s32 offen offset:2048
buffer_load_dwordx4 v[116:119], v1, s[4:7], s33 offen offset:2048
buffer_load_dwordx4 v[120:123], v1, s[4:7], s34 offen offset:2048
buffer_load_dwordx4 v[124:127], v1, s[4:7], s35 offen offset:2048
buffer_load_dwordx4 v[128:131], v1, s[4:7], s36 offen offset:2048
buffer_load_dwordx4 v[132:135], v1, s[4:7], s37 offen offset:2048
buffer_load_dwordx4 v[136:139], v1, s[4:7], s38 offen offset:2048
buffer_load_dwordx4 v[140:143], v1, s[4:7], s39 offen offset:2048
s_barrier
s_waitcnt vmcnt(30)
ds_read_b128 v[184:187], v1 offset:12288
ds_read_b128 v[188:191], v1 offset:36864
ds_read_b128 v[192:195], v6 offset:12288
ds_read_b128 v[196:199], v6 offset:36864
s_waitcnt lgkmcnt(4)
v_mfma_f32_16x16x32_bf16 a[0:3], v[144:147], v[200:203], a[0:3]
v_mfma_f32_16x16x32_bf16 a[4:7], v[144:147], v[204:207], a[4:7]
v_mfma_f32_16x16x32_bf16 a[8:11], v[144:147], v[208:211], a[8:11]
v_mfma_f32_16x16x32_bf16 a[12:15], v[144:147], v[212:215], a[12:15]
v_mfma_f32_16x16x32_bf16 a[16:19], v[148:151], v[200:203], a[16:19]
v_mfma_f32_16x16x32_bf16 a[20:23], v[148:151], v[204:207], a[20:23]
v_mfma_f32_16x16x32_bf16 a[24:27], v[148:151], v[208:211], a[24:27]
v_mfma_f32_16x16x32_bf16 a[28:31], v[148:151], v[212:215], a[28:31]
v_mfma_f32_16x16x32_bf16 a[32:35], v[152:155], v[200:203], a[32:35]
v_mfma_f32_16x16x32_bf16 a[36:39], v[152:155], v[204:207], a[36:39]
v_mfma_f32_16x16x32_bf16 a[40:43], v[152:155], v[208:211], a[40:43]
v_mfma_f32_16x16x32_bf16 a[44:47], v[152:155], v[212:215], a[44:47]
v_mfma_f32_16x16x32_bf16 a[48:51], v[156:159], v[200:203], a[48:51]
v_mfma_f32_16x16x32_bf16 a[52:55], v[156:159], v[204:207], a[52:55]
v_mfma_f32_16x16x32_bf16 a[56:59], v[156:159], v[208:211], a[56:59]
v_mfma_f32_16x16x32_bf16 a[60:63], v[156:159], v[212:215], a[60:63]
v_mfma_f32_16x16x32_bf16 a[64:67], v[160:163], v[200:203], a[64:67]
v_mfma_f32_16x16x32_bf16 a[68:71], v[160:163], v[204:207], a[68:71]
v_mfma_f32_16x16x32_bf16 a[72:75], v[160:163], v[208:211], a[72:75]
v_mfma_f32_16x16x32_bf16 a[76:79], v[160:163], v[212:215], a[76:79]
v_mfma_f32_16x16x32_bf16 a[80:83], v[164:167], v[200:203], a[80:83]
v_mfma_f32_16x16x32_bf16 a[84:87], v[164:167], v[204:207], a[84:87]
v_mfma_f32_16x16x32_bf16 a[88:91], v[164:167], v[208:211], a[88:91]
v_mfma_f32_16x16x32_bf16 a[92:95], v[164:167], v[212:215], a[92:95]
v_mfma_f32_16x16x32_bf16 a[96:99], v[168:171], v[200:203], a[96:99]
v_mfma_f32_16x16x32_bf16 a[100:103], v[168:171], v[204:207], a[100:103]
v_mfma_f32_16x16x32_bf16 a[104:107], v[168:171], v[208:211], a[104:107]
v_mfma_f32_16x16x32_bf16 a[108:111], v[168:171], v[212:215], a[108:111]
v_mfma_f32_16x16x32_bf16 a[112:115], v[172:175], v[200:203], a[112:115]
v_mfma_f32_16x16x32_bf16 a[116:119], v[172:175], v[204:207], a[116:119]
v_mfma_f32_16x16x32_bf16 a[120:123], v[172:175], v[208:211], a[120:123]
v_mfma_f32_16x16x32_bf16 a[124:127], v[172:175], v[212:215], a[124:127]
v_mfma_f32_16x16x32_bf16 a[128:131], v[176:179], v[200:203], a[128:131]
v_mfma_f32_16x16x32_bf16 a[132:135], v[176:179], v[204:207], a[132:135]
v_mfma_f32_16x16x32_bf16 a[136:139], v[176:179], v[208:211], a[136:139]
v_mfma_f32_16x16x32_bf16 a[140:143], v[176:179], v[212:215], a[140:143]
v_mfma_f32_16x16x32_bf16 a[144:147], v[180:183], v[200:203], a[144:147]
v_mfma_f32_16x16x32_bf16 a[148:151], v[180:183], v[204:207], a[148:151]
v_mfma_f32_16x16x32_bf16 a[152:155], v[180:183], v[208:211], a[152:155]
v_mfma_f32_16x16x32_bf16 a[156:159], v[180:183], v[212:215], a[156:159]
buffer_load_dwordx4 v[144:147], v1, s[4:7], s30 offen offset:3072
buffer_load_dwordx4 v[148:151], v1, s[4:7], s31 offen offset:3072
buffer_load_dwordx4 v[152:155], v1, s[4:7], s32 offen offset:3072
buffer_load_dwordx4 v[156:159], v1, s[4:7], s33 offen offset:3072
buffer_load_dwordx4 v[160:163], v1, s[4:7], s34 offen offset:3072
buffer_load_dwordx4 v[164:167], v1, s[4:7], s35 offen offset:3072
buffer_load_dwordx4 v[168:171], v1, s[4:7], s36 offen offset:3072
buffer_load_dwordx4 v[172:175], v1, s[4:7], s37 offen offset:3072
buffer_load_dwordx4 v[176:179], v1, s[4:7], s38 offen offset:3072
buffer_load_dwordx4 v[180:183], v1, s[4:7], s39 offen offset:3072
s_add_u32 s30, s30, 4096
s_add_u32 s31, s31, 4096
s_add_u32 s32, s32, 4096
s_add_u32 s33, s33, 4096
s_add_u32 s34, s34, 4096
s_add_u32 s35, s35, 4096
s_add_u32 s36, s36, 4096
s_add_u32 s37, s37, 4096
s_add_u32 s38, s38, 4096
s_add_u32 s39, s39, 4096
s_waitcnt vmcnt(30)
ds_read_b128 v[200:203], v1 offset:13312
ds_read_b128 v[204:207], v1 offset:37888
ds_read_b128 v[208:211], v6 offset:13312
ds_read_b128 v[212:215], v6 offset:37888
s_waitcnt lgkmcnt(4)
v_mfma_f32_16x16x32_bf16 a[0:3], v[24:27], v[184:187], a[0:3]
v_mfma_f32_16x16x32_bf16 a[4:7], v[24:27], v[188:191], a[4:7]
v_mfma_f32_16x16x32_bf16 a[8:11], v[24:27], v[192:195], a[8:11]
v_mfma_f32_16x16x32_bf16 a[12:15], v[24:27], v[196:199], a[12:15]
v_mfma_f32_16x16x32_bf16 a[16:19], v[28:31], v[184:187], a[16:19]
v_mfma_f32_16x16x32_bf16 a[20:23], v[28:31], v[188:191], a[20:23]
v_mfma_f32_16x16x32_bf16 a[24:27], v[28:31], v[192:195], a[24:27]
v_mfma_f32_16x16x32_bf16 a[28:31], v[28:31], v[196:199], a[28:31]
v_mfma_f32_16x16x32_bf16 a[32:35], v[32:35], v[184:187], a[32:35]
v_mfma_f32_16x16x32_bf16 a[36:39], v[32:35], v[188:191], a[36:39]
v_mfma_f32_16x16x32_bf16 a[40:43], v[32:35], v[192:195], a[40:43]
v_mfma_f32_16x16x32_bf16 a[44:47], v[32:35], v[196:199], a[44:47]
v_mfma_f32_16x16x32_bf16 a[48:51], v[36:39], v[184:187], a[48:51]
v_mfma_f32_16x16x32_bf16 a[52:55], v[36:39], v[188:191], a[52:55]
v_mfma_f32_16x16x32_bf16 a[56:59], v[36:39], v[192:195], a[56:59]
v_mfma_f32_16x16x32_bf16 a[60:63], v[36:39], v[196:199], a[60:63]
v_mfma_f32_16x16x32_bf16 a[64:67], v[40:43], v[184:187], a[64:67]
v_mfma_f32_16x16x32_bf16 a[68:71], v[40:43], v[188:191], a[68:71]
v_mfma_f32_16x16x32_bf16 a[72:75], v[40:43], v[192:195], a[72:75]
v_mfma_f32_16x16x32_bf16 a[76:79], v[40:43], v[196:199], a[76:79]
v_mfma_f32_16x16x32_bf16 a[80:83], v[44:47], v[184:187], a[80:83]
v_mfma_f32_16x16x32_bf16 a[84:87], v[44:47], v[188:191], a[84:87]
v_mfma_f32_16x16x32_bf16 a[88:91], v[44:47], v[192:195], a[88:91]
v_mfma_f32_16x16x32_bf16 a[92:95], v[44:47], v[196:199], a[92:95]
v_mfma_f32_16x16x32_bf16 a[96:99], v[48:51], v[184:187], a[96:99]
v_mfma_f32_16x16x32_bf16 a[100:103], v[48:51], v[188:191], a[100:103]
v_mfma_f32_16x16x32_bf16 a[104:107], v[48:51], v[192:195], a[104:107]
v_mfma_f32_16x16x32_bf16 a[108:111], v[48:51], v[196:199], a[108:111]
v_mfma_f32_16x16x32_bf16 a[112:115], v[52:55], v[184:187], a[112:115]
v_mfma_f32_16x16x32_bf16 a[116:119], v[52:55], v[188:191], a[116:119]
v_mfma_f32_16x16x32_bf16 a[120:123], v[52:55], v[192:195], a[120:123]
v_mfma_f32_16x16x32_bf16 a[124:127], v[52:55], v[196:199], a[124:127]
v_mfma_f32_16x16x32_bf16 a[128:131], v[56:59], v[184:187], a[128:131]
v_mfma_f32_16x16x32_bf16 a[132:135], v[56:59], v[188:191], a[132:135]
v_mfma_f32_16x16x32_bf16 a[136:139], v[56:59], v[192:195], a[136:139]
v_mfma_f32_16x16x32_bf16 a[140:143], v[56:59], v[196:199], a[140:143]
v_mfma_f32_16x16x32_bf16 a[144:147], v[60:63], v[184:187], a[144:147]
v_mfma_f32_16x16x32_bf16 a[148:151], v[60:63], v[188:191], a[148:151]
v_mfma_f32_16x16x32_bf16 a[152:155], v[60:63], v[192:195], a[152:155]
v_mfma_f32_16x16x32_bf16 a[156:159], v[60:63], v[196:199], a[156:159]
buffer_load_dwordx4 v[24:27], v1, s[4:7], s30 offen offset:0
buffer_load_dwordx4 v[28:31], v1, s[4:7], s31 offen offset:0
buffer_load_dwordx4 v[32:35], v1, s[4:7], s32 offen offset:0
buffer_load_dwordx4 v[36:39], v1, s[4:7], s33 offen offset:0
buffer_load_dwordx4 v[40:43], v1, s[4:7], s34 offen offset:0
buffer_load_dwordx4 v[44:47], v1, s[4:7], s35 offen offset:0
buffer_load_dwordx4 v[48:51], v1, s[4:7], s36 offen offset:0
buffer_load_dwordx4 v[52:55], v1, s[4:7], s37 offen offset:0
buffer_load_dwordx4 v[56:59], v1, s[4:7], s38 offen offset:0
buffer_load_dwordx4 v[60:63], v1, s[4:7], s39 offen offset:0
s_waitcnt vmcnt(30)
ds_read_b128 v[184:187], v1 offset:14336
ds_read_b128 v[188:191], v1 offset:38912
ds_read_b128 v[192:195], v6 offset:14336
ds_read_b128 v[196:199], v6 offset:38912
s_waitcnt lgkmcnt(4)
v_mfma_f32_16x16x32_bf16 a[0:3], v[64:67], v[200:203], a[0:3]
v_mfma_f32_16x16x32_bf16 a[4:7], v[64:67], v[204:207], a[4:7]
v_mfma_f32_16x16x32_bf16 a[8:11], v[64:67], v[208:211], a[8:11]
v_mfma_f32_16x16x32_bf16 a[12:15], v[64:67], v[212:215], a[12:15]
v_mfma_f32_16x16x32_bf16 a[16:19], v[68:71], v[200:203], a[16:19]
v_mfma_f32_16x16x32_bf16 a[20:23], v[68:71], v[204:207], a[20:23]
v_mfma_f32_16x16x32_bf16 a[24:27], v[68:71], v[208:211], a[24:27]
v_mfma_f32_16x16x32_bf16 a[28:31], v[68:71], v[212:215], a[28:31]
v_mfma_f32_16x16x32_bf16 a[32:35], v[72:75], v[200:203], a[32:35]
v_mfma_f32_16x16x32_bf16 a[36:39], v[72:75], v[204:207], a[36:39]
v_mfma_f32_16x16x32_bf16 a[40:43], v[72:75], v[208:211], a[40:43]
v_mfma_f32_16x16x32_bf16 a[44:47], v[72:75], v[212:215], a[44:47]
v_mfma_f32_16x16x32_bf16 a[48:51], v[76:79], v[200:203], a[48:51]
v_mfma_f32_16x16x32_bf16 a[52:55], v[76:79], v[204:207], a[52:55]
v_mfma_f32_16x16x32_bf16 a[56:59], v[76:79], v[208:211], a[56:59]
v_mfma_f32_16x16x32_bf16 a[60:63], v[76:79], v[212:215], a[60:63]
v_mfma_f32_16x16x32_bf16 a[64:67], v[80:83], v[200:203], a[64:67]
v_mfma_f32_16x16x32_bf16 a[68:71], v[80:83], v[204:207], a[68:71]
v_mfma_f32_16x16x32_bf16 a[72:75], v[80:83], v[208:211], a[72:75]
v_mfma_f32_16x16x32_bf16 a[76:79], v[80:83], v[212:215], a[76:79]
v_mfma_f32_16x16x32_bf16 a[80:83], v[84:87], v[200:203], a[80:83]
v_mfma_f32_16x16x32_bf16 a[84:87], v[84:87], v[204:207], a[84:87]
v_mfma_f32_16x16x32_bf16 a[88:91], v[84:87], v[208:211], a[88:91]
v_mfma_f32_16x16x32_bf16 a[92:95], v[84:87], v[212:215], a[92:95]
v_mfma_f32_16x16x32_bf16 a[96:99], v[88:91], v[200:203], a[96:99]
v_mfma_f32_16x16x32_bf16 a[100:103], v[88:91], v[204:207], a[100:103]
v_mfma_f32_16x16x32_bf16 a[104:107], v[88:91], v[208:211], a[104:107]
v_mfma_f32_16x16x32_bf16 a[108:111], v[88:91], v[212:215], a[108:111]
v_mfma_f32_16x16x32_bf16 a[112:115], v[92:95], v[200:203], a[112:115]
v_mfma_f32_16x16x32_bf16 a[116:119], v[92:95], v[204:207], a[116:119]
v_mfma_f32_16x16x32_bf16 a[120:123], v[92:95], v[208:211], a[120:123]
v_mfma_f32_16x16x32_bf16 a[124:127], v[92:95], v[212:215], a[124:127]
v_mfma_f32_16x16x32_bf16 a[128:131], v[96:99], v[200:203], a[128:131]
v_mfma_f32_16x16x32_bf16 a[132:135], v[96:99], v[204:207], a[132:135]
v_mfma_f32_16x16x32_bf16 a[136:139], v[96:99], v[208:211], a[136:139]
v_mfma_f32_16x16x32_bf16 a[140:143], v[96:99], v[212:215], a[140:143]
v_mfma_f32_16x16x32_bf16 a[144:147], v[100:103], v[200:203], a[144:147]
v_mfma_f32_16x16x32_bf16 a[148:151], v[100:103], v[204:207], a[148:151]
v_mfma_f32_16x16x32_bf16 a[152:155], v[100:103], v[208:211], a[152:155]
v_mfma_f32_16x16x32_bf16 a[156:159], v[100:103], v[212:215], a[156:159]
buffer_load_dwordx4 v[64:67], v1, s[4:7], s30 offen offset:1024
buffer_load_dwordx4 v[68:71], v1, s[4:7], s31 offen offset:1024
buffer_load_dwordx4 v[72:75], v1, s[4:7], s32 offen offset:1024
buffer_load_dwordx4 v[76:79], v1, s[4:7], s33 offen offset:1024
buffer_load_dwordx4 v[80:83], v1, s[4:7], s34 offen offset:1024
buffer_load_dwordx4 v[84:87], v1, s[4:7], s35 offen offset:1024
buffer_load_dwordx4 v[88:91], v1, s[4:7], s36 offen offset:1024
buffer_load_dwordx4 v[92:95], v1, s[4:7], s37 offen offset:1024
buffer_load_dwordx4 v[96:99], v1, s[4:7], s38 offen offset:1024
buffer_load_dwordx4 v[100:103], v1, s[4:7], s39 offen offset:1024
s_waitcnt vmcnt(30)
ds_read_b128 v[200:203], v1 offset:15360
ds_read_b128 v[204:207], v1 offset:39936
ds_read_b128 v[208:211], v6 offset:15360
ds_read_b128 v[212:215], v6 offset:39936
s_waitcnt lgkmcnt(4)
v_mfma_f32_16x16x32_bf16 a[0:3], v[104:107], v[184:187], a[0:3]
v_mfma_f32_16x16x32_bf16 a[4:7], v[104:107], v[188:191], a[4:7]
v_mfma_f32_16x16x32_bf16 a[8:11], v[104:107], v[192:195], a[8:11]
v_mfma_f32_16x16x32_bf16 a[12:15], v[104:107], v[196:199], a[12:15]
v_mfma_f32_16x16x32_bf16 a[16:19], v[108:111], v[184:187], a[16:19]
v_mfma_f32_16x16x32_bf16 a[20:23], v[108:111], v[188:191], a[20:23]
v_mfma_f32_16x16x32_bf16 a[24:27], v[108:111], v[192:195], a[24:27]
v_mfma_f32_16x16x32_bf16 a[28:31], v[108:111], v[196:199], a[28:31]
v_mfma_f32_16x16x32_bf16 a[32:35], v[112:115], v[184:187], a[32:35]
v_mfma_f32_16x16x32_bf16 a[36:39], v[112:115], v[188:191], a[36:39]
v_mfma_f32_16x16x32_bf16 a[40:43], v[112:115], v[192:195], a[40:43]
v_mfma_f32_16x16x32_bf16 a[44:47], v[112:115], v[196:199], a[44:47]
v_mfma_f32_16x16x32_bf16 a[48:51], v[116:119], v[184:187], a[48:51]
v_mfma_f32_16x16x32_bf16 a[52:55], v[116:119], v[188:191], a[52:55]
v_mfma_f32_16x16x32_bf16 a[56:59], v[116:119], v[192:195], a[56:59]
v_mfma_f32_16x16x32_bf16 a[60:63], v[116:119], v[196:199], a[60:63]
v_mfma_f32_16x16x32_bf16 a[64:67], v[120:123], v[184:187], a[64:67]
v_mfma_f32_16x16x32_bf16 a[68:71], v[120:123], v[188:191], a[68:71]
v_mfma_f32_16x16x32_bf16 a[72:75], v[120:123], v[192:195], a[72:75]
v_mfma_f32_16x16x32_bf16 a[76:79], v[120:123], v[196:199], a[76:79]
v_mfma_f32_16x16x32_bf16 a[80:83], v[124:127], v[184:187], a[80:83]
v_mfma_f32_16x16x32_bf16 a[84:87], v[124:127], v[188:191], a[84:87]
v_mfma_f32_16x16x32_bf16 a[88:91], v[124:127], v[192:195], a[88:91]
v_mfma_f32_16x16x32_bf16 a[92:95], v[124:127], v[196:199], a[92:95]
v_mfma_f32_16x16x32_bf16 a[96:99], v[128:131], v[184:187], a[96:99]
v_mfma_f32_16x16x32_bf16 a[100:103], v[128:131], v[188:191], a[100:103]
v_mfma_f32_16x16x32_bf16 a[104:107], v[128:131], v[192:195], a[104:107]
v_mfma_f32_16x16x32_bf16 a[108:111], v[128:131], v[196:199], a[108:111]
v_mfma_f32_16x16x32_bf16 a[112:115], v[132:135], v[184:187], a[112:115]
v_mfma_f32_16x16x32_bf16 a[116:119], v[132:135], v[188:191], a[116:119]
v_mfma_f32_16x16x32_bf16 a[120:123], v[132:135], v[192:195], a[120:123]
v_mfma_f32_16x16x32_bf16 a[124:127], v[132:135], v[196:199], a[124:127]
v_mfma_f32_16x16x32_bf16 a[128:131], v[136:139], v[184:187], a[128:131]
v_mfma_f32_16x16x32_bf16 a[132:135], v[136:139], v[188:191], a[132:135]
v_mfma_f32_16x16x32_bf16 a[136:139], v[136:139], v[192:195], a[136:139]
v_mfma_f32_16x16x32_bf16 a[140:143], v[136:139], v[196:199], a[140:143]
v_mfma_f32_16x16x32_bf16 a[144:147], v[140:143], v[184:187], a[144:147]
v_mfma_f32_16x16x32_bf16 a[148:151], v[140:143], v[188:191], a[148:151]
v_mfma_f32_16x16x32_bf16 a[152:155], v[140:143], v[192:195], a[152:155]
v_mfma_f32_16x16x32_bf16 a[156:159], v[140:143], v[196:199], a[156:159]
buffer_load_dwordx4 v[104:107], v1, s[4:7], s30 offen offset:2048
buffer_load_dwordx4 v[108:111], v1, s[4:7], s31 offen offset:2048
buffer_load_dwordx4 v[112:115], v1, s[4:7], s32 offen offset:2048
buffer_load_dwordx4 v[116:119], v1, s[4:7], s33 offen offset:2048
buffer_load_dwordx4 v[120:123], v1, s[4:7], s34 offen offset:2048
buffer_load_dwordx4 v[124:127], v1, s[4:7], s35 offen offset:2048
buffer_load_dwordx4 v[128:131], v1, s[4:7], s36 offen offset:2048
buffer_load_dwordx4 v[132:135], v1, s[4:7], s37 offen offset:2048
buffer_load_dwordx4 v[136:139], v1, s[4:7], s38 offen offset:2048
buffer_load_dwordx4 v[140:143], v1, s[4:7], s39 offen offset:2048
s_waitcnt vmcnt(30)
ds_read_b128 v[184:187], v1 offset:16384
ds_read_b128 v[188:191], v1 offset:40960
ds_read_b128 v[192:195], v6 offset:16384
ds_read_b128 v[196:199], v6 offset:40960
s_waitcnt lgkmcnt(4)
v_mfma_f32_16x16x32_bf16 a[0:3], v[144:147], v[200:203], a[0:3]
v_mfma_f32_16x16x32_bf16 a[4:7], v[144:147], v[204:207], a[4:7]
v_mfma_f32_16x16x32_bf16 a[8:11], v[144:147], v[208:211], a[8:11]
v_mfma_f32_16x16x32_bf16 a[12:15], v[144:147], v[212:215], a[12:15]
v_mfma_f32_16x16x32_bf16 a[16:19], v[148:151], v[200:203], a[16:19]
v_mfma_f32_16x16x32_bf16 a[20:23], v[148:151], v[204:207], a[20:23]
v_mfma_f32_16x16x32_bf16 a[24:27], v[148:151], v[208:211], a[24:27]
v_mfma_f32_16x16x32_bf16 a[28:31], v[148:151], v[212:215], a[28:31]
v_mfma_f32_16x16x32_bf16 a[32:35], v[152:155], v[200:203], a[32:35]
v_mfma_f32_16x16x32_bf16 a[36:39], v[152:155], v[204:207], a[36:39]
v_mfma_f32_16x16x32_bf16 a[40:43], v[152:155], v[208:211], a[40:43]
v_mfma_f32_16x16x32_bf16 a[44:47], v[152:155], v[212:215], a[44:47]
v_mfma_f32_16x16x32_bf16 a[48:51], v[156:159], v[200:203], a[48:51]
v_mfma_f32_16x16x32_bf16 a[52:55], v[156:159], v[204:207], a[52:55]
v_mfma_f32_16x16x32_bf16 a[56:59], v[156:159], v[208:211], a[56:59]
v_mfma_f32_16x16x32_bf16 a[60:63], v[156:159], v[212:215], a[60:63]
v_mfma_f32_16x16x32_bf16 a[64:67], v[160:163], v[200:203], a[64:67]
v_mfma_f32_16x16x32_bf16 a[68:71], v[160:163], v[204:207], a[68:71]
v_mfma_f32_16x16x32_bf16 a[72:75], v[160:163], v[208:211], a[72:75]
v_mfma_f32_16x16x32_bf16 a[76:79], v[160:163], v[212:215], a[76:79]
v_mfma_f32_16x16x32_bf16 a[80:83], v[164:167], v[200:203], a[80:83]
v_mfma_f32_16x16x32_bf16 a[84:87], v[164:167], v[204:207], a[84:87]
v_mfma_f32_16x16x32_bf16 a[88:91], v[164:167], v[208:211], a[88:91]
v_mfma_f32_16x16x32_bf16 a[92:95], v[164:167], v[212:215], a[92:95]
v_mfma_f32_16x16x32_bf16 a[96:99], v[168:171], v[200:203], a[96:99]
v_mfma_f32_16x16x32_bf16 a[100:103], v[168:171], v[204:207], a[100:103]
v_mfma_f32_16x16x32_bf16 a[104:107], v[168:171], v[208:211], a[104:107]
v_mfma_f32_16x16x32_bf16 a[108:111], v[168:171], v[212:215], a[108:111]
v_mfma_f32_16x16x32_bf16 a[112:115], v[172:175], v[200:203], a[112:115]
v_mfma_f32_16x16x32_bf16 a[116:119], v[172:175], v[204:207], a[116:119]
v_mfma_f32_16x16x32_bf16 a[120:123], v[172:175], v[208:211], a[120:123]
v_mfma_f32_16x16x32_bf16 a[124:127], v[172:175], v[212:215], a[124:127]
v_mfma_f32_16x16x32_bf16 a[128:131], v[176:179], v[200:203], a[128:131]
v_mfma_f32_16x16x32_bf16 a[132:135], v[176:179], v[204:207], a[132:135]
v_mfma_f32_16x16x32_bf16 a[136:139], v[176:179], v[208:211], a[136:139]
v_mfma_f32_16x16x32_bf16 a[140:143], v[176:179], v[212:215], a[140:143]
v_mfma_f32_16x16x32_bf16 a[144:147], v[180:183], v[200:203], a[144:147]
v_mfma_f32_16x16x32_bf16 a[148:151], v[180:183], v[204:207], a[148:151]
v_mfma_f32_16x16x32_bf16 a[152:155], v[180:183], v[208:211], a[152:155]
v_mfma_f32_16x16x32_bf16 a[156:159], v[180:183], v[212:215], a[156:159]
buffer_load_dwordx4 v[144:147], v1, s[4:7], s30 offen offset:3072
buffer_load_dwordx4 v[148:151], v1, s[4:7], s31 offen offset:3072
buffer_load_dwordx4 v[152:155], v1, s[4:7], s32 offen offset:3072
buffer_load_dwordx4 v[156:159], v1, s[4:7], s33 offen offset:3072
buffer_load_dwordx4 v[160:163], v1, s[4:7], s34 offen offset:3072
buffer_load_dwordx4 v[164:167], v1, s[4:7], s35 offen offset:3072
buffer_load_dwordx4 v[168:171], v1, s[4:7], s36 offen offset:3072
buffer_load_dwordx4 v[172:175], v1, s[4:7], s37 offen offset:3072
buffer_load_dwordx4 v[176:179], v1, s[4:7], s38 offen offset:3072
buffer_load_dwordx4 v[180:183], v1, s[4:7], s39 offen offset:3072
s_add_u32 s30, s30, 4096
s_add_u32 s31, s31, 4096
s_add_u32 s32, s32, 4096
s_add_u32 s33, s33, 4096
s_add_u32 s34, s34, 4096
s_add_u32 s35, s35, 4096
s_add_u32 s36, s36, 4096
s_add_u32 s37, s37, 4096
s_add_u32 s38, s38, 4096
s_add_u32 s39, s39, 4096
s_waitcnt vmcnt(30)
ds_read_b128 v[200:203], v1 offset:17408
ds_read_b128 v[204:207], v1 offset:41984
ds_read_b128 v[208:211], v6 offset:17408
ds_read_b128 v[212:215], v6 offset:41984
s_waitcnt lgkmcnt(4)
v_mfma_f32_16x16x32_bf16 a[0:3], v[24:27], v[184:187], a[0:3]
v_mfma_f32_16x16x32_bf16 a[4:7], v[24:27], v[188:191], a[4:7]
v_mfma_f32_16x16x32_bf16 a[8:11], v[24:27], v[192:195], a[8:11]
v_mfma_f32_16x16x32_bf16 a[12:15], v[24:27], v[196:199], a[12:15]
v_mfma_f32_16x16x32_bf16 a[16:19], v[28:31], v[184:187], a[16:19]
v_mfma_f32_16x16x32_bf16 a[20:23], v[28:31], v[188:191], a[20:23]
v_mfma_f32_16x16x32_bf16 a[24:27], v[28:31], v[192:195], a[24:27]
v_mfma_f32_16x16x32_bf16 a[28:31], v[28:31], v[196:199], a[28:31]
v_mfma_f32_16x16x32_bf16 a[32:35], v[32:35], v[184:187], a[32:35]
v_mfma_f32_16x16x32_bf16 a[36:39], v[32:35], v[188:191], a[36:39]
v_mfma_f32_16x16x32_bf16 a[40:43], v[32:35], v[192:195], a[40:43]
v_mfma_f32_16x16x32_bf16 a[44:47], v[32:35], v[196:199], a[44:47]
v_mfma_f32_16x16x32_bf16 a[48:51], v[36:39], v[184:187], a[48:51]
v_mfma_f32_16x16x32_bf16 a[52:55], v[36:39], v[188:191], a[52:55]
v_mfma_f32_16x16x32_bf16 a[56:59], v[36:39], v[192:195], a[56:59]
v_mfma_f32_16x16x32_bf16 a[60:63], v[36:39], v[196:199], a[60:63]
v_mfma_f32_16x16x32_bf16 a[64:67], v[40:43], v[184:187], a[64:67]
v_mfma_f32_16x16x32_bf16 a[68:71], v[40:43], v[188:191], a[68:71]
v_mfma_f32_16x16x32_bf16 a[72:75], v[40:43], v[192:195], a[72:75]
v_mfma_f32_16x16x32_bf16 a[76:79], v[40:43], v[196:199], a[76:79]
v_mfma_f32_16x16x32_bf16 a[80:83], v[44:47], v[184:187], a[80:83]
v_mfma_f32_16x16x32_bf16 a[84:87], v[44:47], v[188:191], a[84:87]
v_mfma_f32_16x16x32_bf16 a[88:91], v[44:47], v[192:195], a[88:91]
v_mfma_f32_16x16x32_bf16 a[92:95], v[44:47], v[196:199], a[92:95]
v_mfma_f32_16x16x32_bf16 a[96:99], v[48:51], v[184:187], a[96:99]
v_mfma_f32_16x16x32_bf16 a[100:103], v[48:51], v[188:191], a[100:103]
v_mfma_f32_16x16x32_bf16 a[104:107], v[48:51], v[192:195], a[104:107]
v_mfma_f32_16x16x32_bf16 a[108:111], v[48:51], v[196:199], a[108:111]
v_mfma_f32_16x16x32_bf16 a[112:115], v[52:55], v[184:187], a[112:115]
v_mfma_f32_16x16x32_bf16 a[116:119], v[52:55], v[188:191], a[116:119]
v_mfma_f32_16x16x32_bf16 a[120:123], v[52:55], v[192:195], a[120:123]
v_mfma_f32_16x16x32_bf16 a[124:127], v[52:55], v[196:199], a[124:127]
v_mfma_f32_16x16x32_bf16 a[128:131], v[56:59], v[184:187], a[128:131]
v_mfma_f32_16x16x32_bf16 a[132:135], v[56:59], v[188:191], a[132:135]
v_mfma_f32_16x16x32_bf16 a[136:139], v[56:59], v[192:195], a[136:139]
v_mfma_f32_16x16x32_bf16 a[140:143], v[56:59], v[196:199], a[140:143]
v_mfma_f32_16x16x32_bf16 a[144:147], v[60:63], v[184:187], a[144:147]
v_mfma_f32_16x16x32_bf16 a[148:151], v[60:63], v[188:191], a[148:151]
v_mfma_f32_16x16x32_bf16 a[152:155], v[60:63], v[192:195], a[152:155]
v_mfma_f32_16x16x32_bf16 a[156:159], v[60:63], v[196:199], a[156:159]
buffer_load_dwordx4 v[24:27], v1, s[4:7], s30 offen offset:0
buffer_load_dwordx4 v[28:31], v1, s[4:7], s31 offen offset:0
buffer_load_dwordx4 v[32:35], v1, s[4:7], s32 offen offset:0
buffer_load_dwordx4 v[36:39], v1, s[4:7], s33 offen offset:0
buffer_load_dwordx4 v[40:43], v1, s[4:7], s34 offen offset:0
buffer_load_dwordx4 v[44:47], v1, s[4:7], s35 offen offset:0
buffer_load_dwordx4 v[48:51], v1, s[4:7], s36 offen offset:0
buffer_load_dwordx4 v[52:55], v1, s[4:7], s37 offen offset:0
buffer_load_dwordx4 v[56:59], v1, s[4:7], s38 offen offset:0
buffer_load_dwordx4 v[60:63], v1, s[4:7], s39 offen offset:0
s_barrier
s_waitcnt vmcnt(30)
ds_read_b128 v[184:187], v1 offset:18432
ds_read_b128 v[188:191], v1 offset:43008
ds_read_b128 v[192:195], v6 offset:18432
ds_read_b128 v[196:199], v6 offset:43008
s_waitcnt lgkmcnt(4)
v_mfma_f32_16x16x32_bf16 a[0:3], v[64:67], v[200:203], a[0:3]
v_mfma_f32_16x16x32_bf16 a[4:7], v[64:67], v[204:207], a[4:7]
v_mfma_f32_16x16x32_bf16 a[8:11], v[64:67], v[208:211], a[8:11]
v_mfma_f32_16x16x32_bf16 a[12:15], v[64:67], v[212:215], a[12:15]
v_mfma_f32_16x16x32_bf16 a[16:19], v[68:71], v[200:203], a[16:19]
v_mfma_f32_16x16x32_bf16 a[20:23], v[68:71], v[204:207], a[20:23]
v_mfma_f32_16x16x32_bf16 a[24:27], v[68:71], v[208:211], a[24:27]
v_mfma_f32_16x16x32_bf16 a[28:31], v[68:71], v[212:215], a[28:31]
v_mfma_f32_16x16x32_bf16 a[32:35], v[72:75], v[200:203], a[32:35]
v_mfma_f32_16x16x32_bf16 a[36:39], v[72:75], v[204:207], a[36:39]
v_mfma_f32_16x16x32_bf16 a[40:43], v[72:75], v[208:211], a[40:43]
v_mfma_f32_16x16x32_bf16 a[44:47], v[72:75], v[212:215], a[44:47]
v_mfma_f32_16x16x32_bf16 a[48:51], v[76:79], v[200:203], a[48:51]
v_mfma_f32_16x16x32_bf16 a[52:55], v[76:79], v[204:207], a[52:55]
v_mfma_f32_16x16x32_bf16 a[56:59], v[76:79], v[208:211], a[56:59]
v_mfma_f32_16x16x32_bf16 a[60:63], v[76:79], v[212:215], a[60:63]
v_mfma_f32_16x16x32_bf16 a[64:67], v[80:83], v[200:203], a[64:67]
v_mfma_f32_16x16x32_bf16 a[68:71], v[80:83], v[204:207], a[68:71]
v_mfma_f32_16x16x32_bf16 a[72:75], v[80:83], v[208:211], a[72:75]
v_mfma_f32_16x16x32_bf16 a[76:79], v[80:83], v[212:215], a[76:79]
v_mfma_f32_16x16x32_bf16 a[80:83], v[84:87], v[200:203], a[80:83]
v_mfma_f32_16x16x32_bf16 a[84:87], v[84:87], v[204:207], a[84:87]
v_mfma_f32_16x16x32_bf16 a[88:91], v[84:87], v[208:211], a[88:91]
v_mfma_f32_16x16x32_bf16 a[92:95], v[84:87], v[212:215], a[92:95]
v_mfma_f32_16x16x32_bf16 a[96:99], v[88:91], v[200:203], a[96:99]
v_mfma_f32_16x16x32_bf16 a[100:103], v[88:91], v[204:207], a[100:103]
v_mfma_f32_16x16x32_bf16 a[104:107], v[88:91], v[208:211], a[104:107]
v_mfma_f32_16x16x32_bf16 a[108:111], v[88:91], v[212:215], a[108:111]
v_mfma_f32_16x16x32_bf16 a[112:115], v[92:95], v[200:203], a[112:115]
v_mfma_f32_16x16x32_bf16 a[116:119], v[92:95], v[204:207], a[116:119]
v_mfma_f32_16x16x32_bf16 a[120:123], v[92:95], v[208:211], a[120:123]
v_mfma_f32_16x16x32_bf16 a[124:127], v[92:95], v[212:215], a[124:127]
v_mfma_f32_16x16x32_bf16 a[128:131], v[96:99], v[200:203], a[128:131]
v_mfma_f32_16x16x32_bf16 a[132:135], v[96:99], v[204:207], a[132:135]
v_mfma_f32_16x16x32_bf16 a[136:139], v[96:99], v[208:211], a[136:139]
v_mfma_f32_16x16x32_bf16 a[140:143], v[96:99], v[212:215], a[140:143]
v_mfma_f32_16x16x32_bf16 a[144:147], v[100:103], v[200:203], a[144:147]
v_mfma_f32_16x16x32_bf16 a[148:151], v[100:103], v[204:207], a[148:151]
v_mfma_f32_16x16x32_bf16 a[152:155], v[100:103], v[208:211], a[152:155]
v_mfma_f32_16x16x32_bf16 a[156:159], v[100:103], v[212:215], a[156:159]
buffer_load_dwordx4 v[64:67], v1, s[4:7], s30 offen offset:1024
buffer_load_dwordx4 v[68:71], v1, s[4:7], s31 offen offset:1024
buffer_load_dwordx4 v[72:75], v1, s[4:7], s32 offen offset:1024
buffer_load_dwordx4 v[76:79], v1, s[4:7], s33 offen offset:1024
buffer_load_dwordx4 v[80:83], v1, s[4:7], s34 offen offset:1024
buffer_load_dwordx4 v[84:87], v1, s[4:7], s35 offen offset:1024
buffer_load_dwordx4 v[88:91], v1, s[4:7], s36 offen offset:1024
buffer_load_dwordx4 v[92:95], v1, s[4:7], s37 offen offset:1024
buffer_load_dwordx4 v[96:99], v1, s[4:7], s38 offen offset:1024
buffer_load_dwordx4 v[100:103], v1, s[4:7], s39 offen offset:1024
s_waitcnt vmcnt(30)
ds_read_b128 v[200:203], v1 offset:19456
ds_read_b128 v[204:207], v1 offset:44032
ds_read_b128 v[208:211], v6 offset:19456
ds_read_b128 v[212:215], v6 offset:44032
s_waitcnt lgkmcnt(4)
v_mfma_f32_16x16x32_bf16 a[0:3], v[104:107], v[184:187], a[0:3]
v_mfma_f32_16x16x32_bf16 a[4:7], v[104:107], v[188:191], a[4:7]
v_mfma_f32_16x16x32_bf16 a[8:11], v[104:107], v[192:195], a[8:11]
v_mfma_f32_16x16x32_bf16 a[12:15], v[104:107], v[196:199], a[12:15]
v_mfma_f32_16x16x32_bf16 a[16:19], v[108:111], v[184:187], a[16:19]
v_mfma_f32_16x16x32_bf16 a[20:23], v[108:111], v[188:191], a[20:23]
v_mfma_f32_16x16x32_bf16 a[24:27], v[108:111], v[192:195], a[24:27]
v_mfma_f32_16x16x32_bf16 a[28:31], v[108:111], v[196:199], a[28:31]
v_mfma_f32_16x16x32_bf16 a[32:35], v[112:115], v[184:187], a[32:35]
v_mfma_f32_16x16x32_bf16 a[36:39], v[112:115], v[188:191], a[36:39]
v_mfma_f32_16x16x32_bf16 a[40:43], v[112:115], v[192:195], a[40:43]
v_mfma_f32_16x16x32_bf16 a[44:47], v[112:115], v[196:199], a[44:47]
v_mfma_f32_16x16x32_bf16 a[48:51], v[116:119], v[184:187], a[48:51]
v_mfma_f32_16x16x32_bf16 a[52:55], v[116:119], v[188:191], a[52:55]
v_mfma_f32_16x16x32_bf16 a[56:59], v[116:119], v[192:195], a[56:59]
v_mfma_f32_16x16x32_bf16 a[60:63], v[116:119], v[196:199], a[60:63]
v_mfma_f32_16x16x32_bf16 a[64:67], v[120:123], v[184:187], a[64:67]
v_mfma_f32_16x16x32_bf16 a[68:71], v[120:123], v[188:191], a[68:71]
v_mfma_f32_16x16x32_bf16 a[72:75], v[120:123], v[192:195], a[72:75]
v_mfma_f32_16x16x32_bf16 a[76:79], v[120:123], v[196:199], a[76:79]
v_mfma_f32_16x16x32_bf16 a[80:83], v[124:127], v[184:187], a[80:83]
v_mfma_f32_16x16x32_bf16 a[84:87], v[124:127], v[188:191], a[84:87]
v_mfma_f32_16x16x32_bf16 a[88:91], v[124:127], v[192:195], a[88:91]
v_mfma_f32_16x16x32_bf16 a[92:95], v[124:127], v[196:199], a[92:95]
v_mfma_f32_16x16x32_bf16 a[96:99], v[128:131], v[184:187], a[96:99]
v_mfma_f32_16x16x32_bf16 a[100:103], v[128:131], v[188:191], a[100:103]
v_mfma_f32_16x16x32_bf16 a[104:107], v[128:131], v[192:195], a[104:107]
v_mfma_f32_16x16x32_bf16 a[108:111], v[128:131], v[196:199], a[108:111]
v_mfma_f32_16x16x32_bf16 a[112:115], v[132:135], v[184:187], a[112:115]
v_mfma_f32_16x16x32_bf16 a[116:119], v[132:135], v[188:191], a[116:119]
v_mfma_f32_16x16x32_bf16 a[120:123], v[132:135], v[192:195], a[120:123]
v_mfma_f32_16x16x32_bf16 a[124:127], v[132:135], v[196:199], a[124:127]
v_mfma_f32_16x16x32_bf16 a[128:131], v[136:139], v[184:187], a[128:131]
v_mfma_f32_16x16x32_bf16 a[132:135], v[136:139], v[188:191], a[132:135]
v_mfma_f32_16x16x32_bf16 a[136:139], v[136:139], v[192:195], a[136:139]
v_mfma_f32_16x16x32_bf16 a[140:143], v[136:139], v[196:199], a[140:143]
v_mfma_f32_16x16x32_bf16 a[144:147], v[140:143], v[184:187], a[144:147]
v_mfma_f32_16x16x32_bf16 a[148:151], v[140:143], v[188:191], a[148:151]
v_mfma_f32_16x16x32_bf16 a[152:155], v[140:143], v[192:195], a[152:155]
v_mfma_f32_16x16x32_bf16 a[156:159], v[140:143], v[196:199], a[156:159]
buffer_load_dwordx4 v[104:107], v1, s[4:7], s30 offen offset:2048
buffer_load_dwordx4 v[108:111], v1, s[4:7], s31 offen offset:2048
buffer_load_dwordx4 v[112:115], v1, s[4:7], s32 offen offset:2048
buffer_load_dwordx4 v[116:119], v1, s[4:7], s33 offen offset:2048
buffer_load_dwordx4 v[120:123], v1, s[4:7], s34 offen offset:2048
buffer_load_dwordx4 v[124:127], v1, s[4:7], s35 offen offset:2048
buffer_load_dwordx4 v[128:131], v1, s[4:7], s36 offen offset:2048
buffer_load_dwordx4 v[132:135], v1, s[4:7], s37 offen offset:2048
buffer_load_dwordx4 v[136:139], v1, s[4:7], s38 offen offset:2048
buffer_load_dwordx4 v[140:143], v1, s[4:7], s39 offen offset:2048
s_waitcnt vmcnt(30)
ds_read_b128 v[184:187], v1 offset:20480
ds_read_b128 v[188:191], v1 offset:45056
ds_read_b128 v[192:195], v6 offset:20480
ds_read_b128 v[196:199], v6 offset:45056
s_waitcnt lgkmcnt(4)
v_mfma_f32_16x16x32_bf16 a[0:3], v[144:147], v[200:203], a[0:3]
v_mfma_f32_16x16x32_bf16 a[4:7], v[144:147], v[204:207], a[4:7]
v_mfma_f32_16x16x32_bf16 a[8:11], v[144:147], v[208:211], a[8:11]
v_mfma_f32_16x16x32_bf16 a[12:15], v[144:147], v[212:215], a[12:15]
v_mfma_f32_16x16x32_bf16 a[16:19], v[148:151], v[200:203], a[16:19]
v_mfma_f32_16x16x32_bf16 a[20:23], v[148:151], v[204:207], a[20:23]
v_mfma_f32_16x16x32_bf16 a[24:27], v[148:151], v[208:211], a[24:27]
v_mfma_f32_16x16x32_bf16 a[28:31], v[148:151], v[212:215], a[28:31]
v_mfma_f32_16x16x32_bf16 a[32:35], v[152:155], v[200:203], a[32:35]
v_mfma_f32_16x16x32_bf16 a[36:39], v[152:155], v[204:207], a[36:39]
v_mfma_f32_16x16x32_bf16 a[40:43], v[152:155], v[208:211], a[40:43]
v_mfma_f32_16x16x32_bf16 a[44:47], v[152:155], v[212:215], a[44:47]
v_mfma_f32_16x16x32_bf16 a[48:51], v[156:159], v[200:203], a[48:51]
v_mfma_f32_16x16x32_bf16 a[52:55], v[156:159], v[204:207], a[52:55]
v_mfma_f32_16x16x32_bf16 a[56:59], v[156:159], v[208:211], a[56:59]
v_mfma_f32_16x16x32_bf16 a[60:63], v[156:159], v[212:215], a[60:63]
v_mfma_f32_16x16x32_bf16 a[64:67], v[160:163], v[200:203], a[64:67]
v_mfma_f32_16x16x32_bf16 a[68:71], v[160:163], v[204:207], a[68:71]
v_mfma_f32_16x16x32_bf16 a[72:75], v[160:163], v[208:211], a[72:75]
v_mfma_f32_16x16x32_bf16 a[76:79], v[160:163], v[212:215], a[76:79]
v_mfma_f32_16x16x32_bf16 a[80:83], v[164:167], v[200:203], a[80:83]
v_mfma_f32_16x16x32_bf16 a[84:87], v[164:167], v[204:207], a[84:87]
v_mfma_f32_16x16x32_bf16 a[88:91], v[164:167], v[208:211], a[88:91]
v_mfma_f32_16x16x32_bf16 a[92:95], v[164:167], v[212:215], a[92:95]
v_mfma_f32_16x16x32_bf16 a[96:99], v[168:171], v[200:203], a[96:99]
v_mfma_f32_16x16x32_bf16 a[100:103], v[168:171], v[204:207], a[100:103]
v_mfma_f32_16x16x32_bf16 a[104:107], v[168:171], v[208:211], a[104:107]
v_mfma_f32_16x16x32_bf16 a[108:111], v[168:171], v[212:215], a[108:111]
v_mfma_f32_16x16x32_bf16 a[112:115], v[172:175], v[200:203], a[112:115]
v_mfma_f32_16x16x32_bf16 a[116:119], v[172:175], v[204:207], a[116:119]
v_mfma_f32_16x16x32_bf16 a[120:123], v[172:175], v[208:211], a[120:123]
v_mfma_f32_16x16x32_bf16 a[124:127], v[172:175], v[212:215], a[124:127]
v_mfma_f32_16x16x32_bf16 a[128:131], v[176:179], v[200:203], a[128:131]
v_mfma_f32_16x16x32_bf16 a[132:135], v[176:179], v[204:207], a[132:135]
v_mfma_f32_16x16x32_bf16 a[136:139], v[176:179], v[208:211], a[136:139]
v_mfma_f32_16x16x32_bf16 a[140:143], v[176:179], v[212:215], a[140:143]
v_mfma_f32_16x16x32_bf16 a[144:147], v[180:183], v[200:203], a[144:147]
v_mfma_f32_16x16x32_bf16 a[148:151], v[180:183], v[204:207], a[148:151]
v_mfma_f32_16x16x32_bf16 a[152:155], v[180:183], v[208:211], a[152:155]
v_mfma_f32_16x16x32_bf16 a[156:159], v[180:183], v[212:215], a[156:159]
buffer_load_dwordx4 v[144:147], v1, s[4:7], s30 offen offset:3072
buffer_load_dwordx4 v[148:151], v1, s[4:7], s31 offen offset:3072
buffer_load_dwordx4 v[152:155], v1, s[4:7], s32 offen offset:3072
buffer_load_dwordx4 v[156:159], v1, s[4:7], s33 offen offset:3072
buffer_load_dwordx4 v[160:163], v1, s[4:7], s34 offen offset:3072
buffer_load_dwordx4 v[164:167], v1, s[4:7], s35 offen offset:3072
buffer_load_dwordx4 v[168:171], v1, s[4:7], s36 offen offset:3072
buffer_load_dwordx4 v[172:175], v1, s[4:7], s37 offen offset:3072
buffer_load_dwordx4 v[176:179], v1, s[4:7], s38 offen offset:3072
buffer_load_dwordx4 v[180:183], v1, s[4:7], s39 offen offset:3072
s_add_u32 s30, s30, 4096
s_add_u32 s31, s31, 4096
s_add_u32 s32, s32, 4096
s_add_u32 s33, s33, 4096
s_add_u32 s34, s34, 4096
s_add_u32 s35, s35, 4096
s_add_u32 s36, s36, 4096
s_add_u32 s37, s37, 4096
s_add_u32 s38, s38, 4096
s_add_u32 s39, s39, 4096
s_waitcnt vmcnt(30)
ds_read_b128 v[200:203], v1 offset:21504
ds_read_b128 v[204:207], v1 offset:46080
ds_read_b128 v[208:211], v6 offset:21504
ds_read_b128 v[212:215], v6 offset:46080
s_waitcnt lgkmcnt(4)
v_mfma_f32_16x16x32_bf16 a[0:3], v[24:27], v[184:187], a[0:3]
v_mfma_f32_16x16x32_bf16 a[4:7], v[24:27], v[188:191], a[4:7]
v_mfma_f32_16x16x32_bf16 a[8:11], v[24:27], v[192:195], a[8:11]
v_mfma_f32_16x16x32_bf16 a[12:15], v[24:27], v[196:199], a[12:15]
v_mfma_f32_16x16x32_bf16 a[16:19], v[28:31], v[184:187], a[16:19]
v_mfma_f32_16x16x32_bf16 a[20:23], v[28:31], v[188:191], a[20:23]
v_mfma_f32_16x16x32_bf16 a[24:27], v[28:31], v[192:195], a[24:27]
v_mfma_f32_16x16x32_bf16 a[28:31], v[28:31], v[196:199], a[28:31]
v_mfma_f32_16x16x32_bf16 a[32:35], v[32:35], v[184:187], a[32:35]
v_mfma_f32_16x16x32_bf16 a[36:39], v[32:35], v[188:191], a[36:39]
v_mfma_f32_16x16x32_bf16 a[40:43], v[32:35], v[192:195], a[40:43]
v_mfma_f32_16x16x32_bf16 a[44:47], v[32:35], v[196:199], a[44:47]
v_mfma_f32_16x16x32_bf16 a[48:51], v[36:39], v[184:187], a[48:51]
v_mfma_f32_16x16x32_bf16 a[52:55], v[36:39], v[188:191], a[52:55]
v_mfma_f32_16x16x32_bf16 a[56:59], v[36:39], v[192:195], a[56:59]
v_mfma_f32_16x16x32_bf16 a[60:63], v[36:39], v[196:199], a[60:63]
v_mfma_f32_16x16x32_bf16 a[64:67], v[40:43], v[184:187], a[64:67]
v_mfma_f32_16x16x32_bf16 a[68:71], v[40:43], v[188:191], a[68:71]
v_mfma_f32_16x16x32_bf16 a[72:75], v[40:43], v[192:195], a[72:75]
v_mfma_f32_16x16x32_bf16 a[76:79], v[40:43], v[196:199], a[76:79]
v_mfma_f32_16x16x32_bf16 a[80:83], v[44:47], v[184:187], a[80:83]
v_mfma_f32_16x16x32_bf16 a[84:87], v[44:47], v[188:191], a[84:87]
v_mfma_f32_16x16x32_bf16 a[88:91], v[44:47], v[192:195], a[88:91]
v_mfma_f32_16x16x32_bf16 a[92:95], v[44:47], v[196:199], a[92:95]
v_mfma_f32_16x16x32_bf16 a[96:99], v[48:51], v[184:187], a[96:99]
v_mfma_f32_16x16x32_bf16 a[100:103], v[48:51], v[188:191], a[100:103]
v_mfma_f32_16x16x32_bf16 a[104:107], v[48:51], v[192:195], a[104:107]
v_mfma_f32_16x16x32_bf16 a[108:111], v[48:51], v[196:199], a[108:111]
v_mfma_f32_16x16x32_bf16 a[112:115], v[52:55], v[184:187], a[112:115]
v_mfma_f32_16x16x32_bf16 a[116:119], v[52:55], v[188:191], a[116:119]
v_mfma_f32_16x16x32_bf16 a[120:123], v[52:55], v[192:195], a[120:123]
v_mfma_f32_16x16x32_bf16 a[124:127], v[52:55], v[196:199], a[124:127]
v_mfma_f32_16x16x32_bf16 a[128:131], v[56:59], v[184:187], a[128:131]
v_mfma_f32_16x16x32_bf16 a[132:135], v[56:59], v[188:191], a[132:135]
v_mfma_f32_16x16x32_bf16 a[136:139], v[56:59], v[192:195], a[136:139]
v_mfma_f32_16x16x32_bf16 a[140:143], v[56:59], v[196:199], a[140:143]
v_mfma_f32_16x16x32_bf16 a[144:147], v[60:63], v[184:187], a[144:147]
v_mfma_f32_16x16x32_bf16 a[148:151], v[60:63], v[188:191], a[148:151]
v_mfma_f32_16x16x32_bf16 a[152:155], v[60:63], v[192:195], a[152:155]
v_mfma_f32_16x16x32_bf16 a[156:159], v[60:63], v[196:199], a[156:159]
s_waitcnt vmcnt(20)
ds_read_b128 v[184:187], v1 offset:22528
ds_read_b128 v[188:191], v1 offset:47104
ds_read_b128 v[192:195], v6 offset:22528
ds_read_b128 v[196:199], v6 offset:47104
s_waitcnt lgkmcnt(4)
v_mfma_f32_16x16x32_bf16 a[0:3], v[64:67], v[200:203], a[0:3]
v_mfma_f32_16x16x32_bf16 a[4:7], v[64:67], v[204:207], a[4:7]
v_mfma_f32_16x16x32_bf16 a[8:11], v[64:67], v[208:211], a[8:11]
v_mfma_f32_16x16x32_bf16 a[12:15], v[64:67], v[212:215], a[12:15]
v_mfma_f32_16x16x32_bf16 a[16:19], v[68:71], v[200:203], a[16:19]
v_mfma_f32_16x16x32_bf16 a[20:23], v[68:71], v[204:207], a[20:23]
v_mfma_f32_16x16x32_bf16 a[24:27], v[68:71], v[208:211], a[24:27]
v_mfma_f32_16x16x32_bf16 a[28:31], v[68:71], v[212:215], a[28:31]
v_mfma_f32_16x16x32_bf16 a[32:35], v[72:75], v[200:203], a[32:35]
v_mfma_f32_16x16x32_bf16 a[36:39], v[72:75], v[204:207], a[36:39]
v_mfma_f32_16x16x32_bf16 a[40:43], v[72:75], v[208:211], a[40:43]
v_mfma_f32_16x16x32_bf16 a[44:47], v[72:75], v[212:215], a[44:47]
v_mfma_f32_16x16x32_bf16 a[48:51], v[76:79], v[200:203], a[48:51]
v_mfma_f32_16x16x32_bf16 a[52:55], v[76:79], v[204:207], a[52:55]
v_mfma_f32_16x16x32_bf16 a[56:59], v[76:79], v[208:211], a[56:59]
v_mfma_f32_16x16x32_bf16 a[60:63], v[76:79], v[212:215], a[60:63]
v_mfma_f32_16x16x32_bf16 a[64:67], v[80:83], v[200:203], a[64:67]
v_mfma_f32_16x16x32_bf16 a[68:71], v[80:83], v[204:207], a[68:71]
v_mfma_f32_16x16x32_bf16 a[72:75], v[80:83], v[208:211], a[72:75]
v_mfma_f32_16x16x32_bf16 a[76:79], v[80:83], v[212:215], a[76:79]
v_mfma_f32_16x16x32_bf16 a[80:83], v[84:87], v[200:203], a[80:83]
v_mfma_f32_16x16x32_bf16 a[84:87], v[84:87], v[204:207], a[84:87]
v_mfma_f32_16x16x32_bf16 a[88:91], v[84:87], v[208:211], a[88:91]
v_mfma_f32_16x16x32_bf16 a[92:95], v[84:87], v[212:215], a[92:95]
v_mfma_f32_16x16x32_bf16 a[96:99], v[88:91], v[200:203], a[96:99]
v_mfma_f32_16x16x32_bf16 a[100:103], v[88:91], v[204:207], a[100:103]
v_mfma_f32_16x16x32_bf16 a[104:107], v[88:91], v[208:211], a[104:107]
v_mfma_f32_16x16x32_bf16 a[108:111], v[88:91], v[212:215], a[108:111]
v_mfma_f32_16x16x32_bf16 a[112:115], v[92:95], v[200:203], a[112:115]
v_mfma_f32_16x16x32_bf16 a[116:119], v[92:95], v[204:207], a[116:119]
v_mfma_f32_16x16x32_bf16 a[120:123], v[92:95], v[208:211], a[120:123]
v_mfma_f32_16x16x32_bf16 a[124:127], v[92:95], v[212:215], a[124:127]
v_mfma_f32_16x16x32_bf16 a[128:131], v[96:99], v[200:203], a[128:131]
v_mfma_f32_16x16x32_bf16 a[132:135], v[96:99], v[204:207], a[132:135]
v_mfma_f32_16x16x32_bf16 a[136:139], v[96:99], v[208:211], a[136:139]
v_mfma_f32_16x16x32_bf16 a[140:143], v[96:99], v[212:215], a[140:143]
v_mfma_f32_16x16x32_bf16 a[144:147], v[100:103], v[200:203], a[144:147]
v_mfma_f32_16x16x32_bf16 a[148:151], v[100:103], v[204:207], a[148:151]
v_mfma_f32_16x16x32_bf16 a[152:155], v[100:103], v[208:211], a[152:155]
v_mfma_f32_16x16x32_bf16 a[156:159], v[100:103], v[212:215], a[156:159]
s_waitcnt vmcnt(10)
ds_read_b128 v[200:203], v1 offset:23552
ds_read_b128 v[204:207], v1 offset:48128
ds_read_b128 v[208:211], v6 offset:23552
ds_read_b128 v[212:215], v6 offset:48128
s_waitcnt lgkmcnt(4)
v_mfma_f32_16x16x32_bf16 a[0:3], v[104:107], v[184:187], a[0:3]
v_mfma_f32_16x16x32_bf16 a[4:7], v[104:107], v[188:191], a[4:7]
v_mfma_f32_16x16x32_bf16 a[8:11], v[104:107], v[192:195], a[8:11]
v_mfma_f32_16x16x32_bf16 a[12:15], v[104:107], v[196:199], a[12:15]
v_mfma_f32_16x16x32_bf16 a[16:19], v[108:111], v[184:187], a[16:19]
v_mfma_f32_16x16x32_bf16 a[20:23], v[108:111], v[188:191], a[20:23]
v_mfma_f32_16x16x32_bf16 a[24:27], v[108:111], v[192:195], a[24:27]
v_mfma_f32_16x16x32_bf16 a[28:31], v[108:111], v[196:199], a[28:31]
v_mfma_f32_16x16x32_bf16 a[32:35], v[112:115], v[184:187], a[32:35]
v_mfma_f32_16x16x32_bf16 a[36:39], v[112:115], v[188:191], a[36:39]
v_mfma_f32_16x16x32_bf16 a[40:43], v[112:115], v[192:195], a[40:43]
v_mfma_f32_16x16x32_bf16 a[44:47], v[112:115], v[196:199], a[44:47]
v_mfma_f32_16x16x32_bf16 a[48:51], v[116:119], v[184:187], a[48:51]
v_mfma_f32_16x16x32_bf16 a[52:55], v[116:119], v[188:191], a[52:55]
v_mfma_f32_16x16x32_bf16 a[56:59], v[116:119], v[192:195], a[56:59]
v_mfma_f32_16x16x32_bf16 a[60:63], v[116:119], v[196:199], a[60:63]
v_mfma_f32_16x16x32_bf16 a[64:67], v[120:123], v[184:187], a[64:67]
v_mfma_f32_16x16x32_bf16 a[68:71], v[120:123], v[188:191], a[68:71]
v_mfma_f32_16x16x32_bf16 a[72:75], v[120:123], v[192:195], a[72:75]
v_mfma_f32_16x16x32_bf16 a[76:79], v[120:123], v[196:199], a[76:79]
v_mfma_f32_16x16x32_bf16 a[80:83], v[124:127], v[184:187], a[80:83]
v_mfma_f32_16x16x32_bf16 a[84:87], v[124:127], v[188:191], a[84:87]
v_mfma_f32_16x16x32_bf16 a[88:91], v[124:127], v[192:195], a[88:91]
v_mfma_f32_16x16x32_bf16 a[92:95], v[124:127], v[196:199], a[92:95]
v_mfma_f32_16x16x32_bf16 a[96:99], v[128:131], v[184:187], a[96:99]
v_mfma_f32_16x16x32_bf16 a[100:103], v[128:131], v[188:191], a[100:103]
v_mfma_f32_16x16x32_bf16 a[104:107], v[128:131], v[192:195], a[104:107]
v_mfma_f32_16x16x32_bf16 a[108:111], v[128:131], v[196:199], a[108:111]
v_mfma_f32_16x16x32_bf16 a[112:115], v[132:135], v[184:187], a[112:115]
v_mfma_f32_16x16x32_bf16 a[116:119], v[132:135], v[188:191], a[116:119]
v_mfma_f32_16x16x32_bf16 a[120:123], v[132:135], v[192:195], a[120:123]
v_mfma_f32_16x16x32_bf16 a[124:127], v[132:135], v[196:199], a[124:127]
v_mfma_f32_16x16x32_bf16 a[128:131], v[136:139], v[184:187], a[128:131]
v_mfma_f32_16x16x32_bf16 a[132:135], v[136:139], v[188:191], a[132:135]
v_mfma_f32_16x16x32_bf16 a[136:139], v[136:139], v[192:195], a[136:139]
v_mfma_f32_16x16x32_bf16 a[140:143], v[136:139], v[196:199], a[140:143]
v_mfma_f32_16x16x32_bf16 a[144:147], v[140:143], v[184:187], a[144:147]
v_mfma_f32_16x16x32_bf16 a[148:151], v[140:143], v[188:191], a[148:151]
v_mfma_f32_16x16x32_bf16 a[152:155], v[140:143], v[192:195], a[152:155]
v_mfma_f32_16x16x32_bf16 a[156:159], v[140:143], v[196:199], a[156:159]
s_waitcnt vmcnt(0)
s_waitcnt lgkmcnt(0)
v_mfma_f32_16x16x32_bf16 a[0:3], v[144:147], v[200:203], a[0:3]
v_mfma_f32_16x16x32_bf16 a[4:7], v[144:147], v[204:207], a[4:7]
v_mfma_f32_16x16x32_bf16 a[8:11], v[144:147], v[208:211], a[8:11]
v_mfma_f32_16x16x32_bf16 a[12:15], v[144:147], v[212:215], a[12:15]
v_mfma_f32_16x16x32_bf16 a[16:19], v[148:151], v[200:203], a[16:19]
v_mfma_f32_16x16x32_bf16 a[20:23], v[148:151], v[204:207], a[20:23]
v_mfma_f32_16x16x32_bf16 a[24:27], v[148:151], v[208:211], a[24:27]
v_mfma_f32_16x16x32_bf16 a[28:31], v[148:151], v[212:215], a[28:31]
v_mfma_f32_16x16x32_bf16 a[32:35], v[152:155], v[200:203], a[32:35]
v_mfma_f32_16x16x32_bf16 a[36:39], v[152:155], v[204:207], a[36:39]
v_mfma_f32_16x16x32_bf16 a[40:43], v[152:155], v[208:211], a[40:43]
v_mfma_f32_16x16x32_bf16 a[44:47], v[152:155], v[212:215], a[44:47]
v_mfma_f32_16x16x32_bf16 a[48:51], v[156:159], v[200:203], a[48:51]
v_mfma_f32_16x16x32_bf16 a[52:55], v[156:159], v[204:207], a[52:55]
v_mfma_f32_16x16x32_bf16 a[56:59], v[156:159], v[208:211], a[56:59]
v_mfma_f32_16x16x32_bf16 a[60:63], v[156:159], v[212:215], a[60:63]
v_mfma_f32_16x16x32_bf16 a[64:67], v[160:163], v[200:203], a[64:67]
v_mfma_f32_16x16x32_bf16 a[68:71], v[160:163], v[204:207], a[68:71]
v_mfma_f32_16x16x32_bf16 a[72:75], v[160:163], v[208:211], a[72:75]
v_mfma_f32_16x16x32_bf16 a[76:79], v[160:163], v[212:215], a[76:79]
v_mfma_f32_16x16x32_bf16 a[80:83], v[164:167], v[200:203], a[80:83]
v_mfma_f32_16x16x32_bf16 a[84:87], v[164:167], v[204:207], a[84:87]
v_mfma_f32_16x16x32_bf16 a[88:91], v[164:167], v[208:211], a[88:91]
v_mfma_f32_16x16x32_bf16 a[92:95], v[164:167], v[212:215], a[92:95]
v_mfma_f32_16x16x32_bf16 a[96:99], v[168:171], v[200:203], a[96:99]
v_mfma_f32_16x16x32_bf16 a[100:103], v[168:171], v[204:207], a[100:103]
v_mfma_f32_16x16x32_bf16 a[104:107], v[168:171], v[208:211], a[104:107]
v_mfma_f32_16x16x32_bf16 a[108:111], v[168:171], v[212:215], a[108:111]
v_mfma_f32_16x16x32_bf16 a[112:115], v[172:175], v[200:203], a[112:115]
v_mfma_f32_16x16x32_bf16 a[116:119], v[172:175], v[204:207], a[116:119]
v_mfma_f32_16x16x32_bf16 a[120:123], v[172:175], v[208:211], a[120:123]
v_mfma_f32_16x16x32_bf16 a[124:127], v[172:175], v[212:215], a[124:127]
v_mfma_f32_16x16x32_bf16 a[128:131], v[176:179], v[200:203], a[128:131]
v_mfma_f32_16x16x32_bf16 a[132:135], v[176:179], v[204:207], a[132:135]
v_mfma_f32_16x16x32_bf16 a[136:139], v[176:179], v[208:211], a[136:139]
v_mfma_f32_16x16x32_bf16 a[140:143], v[176:179], v[212:215], a[140:143]
v_mfma_f32_16x16x32_bf16 a[144:147], v[180:183], v[200:203], a[144:147]
v_mfma_f32_16x16x32_bf16 a[148:151], v[180:183], v[204:207], a[148:151]
v_mfma_f32_16x16x32_bf16 a[152:155], v[180:183], v[208:211], a[152:155]
v_mfma_f32_16x16x32_bf16 a[156:159], v[180:183], v[212:215], a[156:159]
fin_store4:
s_lshl_b32 s16, s13, 7
s_lshl_b32 s17, s14, 2
s_add_u32 s16, s16, s17
s_mul_i32 s16, s16, 20
s_mul_i32 s17, s12, 5
s_add_u32 s16, s16, s17
s_lshl_b32 s16, s16, 10
s_add_u32 s16, s16, 90832896
s_nop 7
s_add_u32 s17, s16, 0
v_accvgpr_read_b32 v24, a0
v_accvgpr_read_b32 v25, a1
v_accvgpr_read_b32 v26, a2
v_accvgpr_read_b32 v27, a3
v_accvgpr_read_b32 v28, a16
v_accvgpr_read_b32 v29, a17
v_accvgpr_read_b32 v30, a18
v_accvgpr_read_b32 v31, a19
v_cvt_pk_bf16_f32 v32, v24, v25
v_cvt_pk_bf16_f32 v33, v26, v27
v_cvt_pk_bf16_f32 v34, v28, v29
v_cvt_pk_bf16_f32 v35, v30, v31
buffer_store_dwordx4 v[32:35], v1, s[4:7], s17 offen offset:0 sc1
v_accvgpr_read_b32 v36, a32
v_accvgpr_read_b32 v37, a33
v_accvgpr_read_b32 v38, a34
v_accvgpr_read_b32 v39, a35
v_accvgpr_read_b32 v40, a48
v_accvgpr_read_b32 v41, a49
v_accvgpr_read_b32 v42, a50
v_accvgpr_read_b32 v43, a51
v_cvt_pk_bf16_f32 v44, v36, v37
v_cvt_pk_bf16_f32 v45, v38, v39
v_cvt_pk_bf16_f32 v46, v40, v41
v_cvt_pk_bf16_f32 v47, v42, v43
buffer_store_dwordx4 v[44:47], v1, s[4:7], s17 offen offset:1024 sc1
v_accvgpr_read_b32 v48, a64
v_accvgpr_read_b32 v49, a65
v_accvgpr_read_b32 v50, a66
v_accvgpr_read_b32 v51, a67
v_accvgpr_read_b32 v52, a80
v_accvgpr_read_b32 v53, a81
v_accvgpr_read_b32 v54, a82
v_accvgpr_read_b32 v55, a83
v_cvt_pk_bf16_f32 v56, v48, v49
v_cvt_pk_bf16_f32 v57, v50, v51
v_cvt_pk_bf16_f32 v58, v52, v53
v_cvt_pk_bf16_f32 v59, v54, v55
buffer_store_dwordx4 v[56:59], v1, s[4:7], s17 offen offset:2048 sc1
v_accvgpr_read_b32 v60, a96
v_accvgpr_read_b32 v61, a97
v_accvgpr_read_b32 v62, a98
v_accvgpr_read_b32 v63, a99
v_accvgpr_read_b32 v64, a112
v_accvgpr_read_b32 v65, a113
v_accvgpr_read_b32 v66, a114
v_accvgpr_read_b32 v67, a115
v_cvt_pk_bf16_f32 v68, v60, v61
v_cvt_pk_bf16_f32 v69, v62, v63
v_cvt_pk_bf16_f32 v70, v64, v65
v_cvt_pk_bf16_f32 v71, v66, v67
buffer_store_dwordx4 v[68:71], v1, s[4:7], s17 offen offset:3072 sc1
v_accvgpr_read_b32 v24, a128
v_accvgpr_read_b32 v25, a129
v_accvgpr_read_b32 v26, a130
v_accvgpr_read_b32 v27, a131
v_accvgpr_read_b32 v28, a144
v_accvgpr_read_b32 v29, a145
v_accvgpr_read_b32 v30, a146
v_accvgpr_read_b32 v31, a147
v_cvt_pk_bf16_f32 v32, v24, v25
v_cvt_pk_bf16_f32 v33, v26, v27
v_cvt_pk_bf16_f32 v34, v28, v29
v_cvt_pk_bf16_f32 v35, v30, v31
s_add_u32 s17, s17, 4096
buffer_store_dwordx4 v[32:35], v1, s[4:7], s17 offen offset:0 sc1
s_add_u32 s17, s16, 20480
v_accvgpr_read_b32 v36, a4
v_accvgpr_read_b32 v37, a5
v_accvgpr_read_b32 v38, a6
v_accvgpr_read_b32 v39, a7
v_accvgpr_read_b32 v40, a20
v_accvgpr_read_b32 v41, a21
v_accvgpr_read_b32 v42, a22
v_accvgpr_read_b32 v43, a23
v_cvt_pk_bf16_f32 v44, v36, v37
v_cvt_pk_bf16_f32 v45, v38, v39
v_cvt_pk_bf16_f32 v46, v40, v41
v_cvt_pk_bf16_f32 v47, v42, v43
buffer_store_dwordx4 v[44:47], v1, s[4:7], s17 offen offset:0 sc1
v_accvgpr_read_b32 v48, a36
v_accvgpr_read_b32 v49, a37
v_accvgpr_read_b32 v50, a38
v_accvgpr_read_b32 v51, a39
v_accvgpr_read_b32 v52, a52
v_accvgpr_read_b32 v53, a53
v_accvgpr_read_b32 v54, a54
v_accvgpr_read_b32 v55, a55
v_cvt_pk_bf16_f32 v56, v48, v49
v_cvt_pk_bf16_f32 v57, v50, v51
v_cvt_pk_bf16_f32 v58, v52, v53
v_cvt_pk_bf16_f32 v59, v54, v55
buffer_store_dwordx4 v[56:59], v1, s[4:7], s17 offen offset:1024 sc1
v_accvgpr_read_b32 v60, a68
v_accvgpr_read_b32 v61, a69
v_accvgpr_read_b32 v62, a70
v_accvgpr_read_b32 v63, a71
v_accvgpr_read_b32 v64, a84
v_accvgpr_read_b32 v65, a85
v_accvgpr_read_b32 v66, a86
v_accvgpr_read_b32 v67, a87
v_cvt_pk_bf16_f32 v68, v60, v61
v_cvt_pk_bf16_f32 v69, v62, v63
v_cvt_pk_bf16_f32 v70, v64, v65
v_cvt_pk_bf16_f32 v71, v66, v67
buffer_store_dwordx4 v[68:71], v1, s[4:7], s17 offen offset:2048 sc1
v_accvgpr_read_b32 v24, a100
v_accvgpr_read_b32 v25, a101
v_accvgpr_read_b32 v26, a102
v_accvgpr_read_b32 v27, a103
v_accvgpr_read_b32 v28, a116
v_accvgpr_read_b32 v29, a117
v_accvgpr_read_b32 v30, a118
v_accvgpr_read_b32 v31, a119
v_cvt_pk_bf16_f32 v32, v24, v25
v_cvt_pk_bf16_f32 v33, v26, v27
v_cvt_pk_bf16_f32 v34, v28, v29
v_cvt_pk_bf16_f32 v35, v30, v31
buffer_store_dwordx4 v[32:35], v1, s[4:7], s17 offen offset:3072 sc1
v_accvgpr_read_b32 v36, a132
v_accvgpr_read_b32 v37, a133
v_accvgpr_read_b32 v38, a134
v_accvgpr_read_b32 v39, a135
v_accvgpr_read_b32 v40, a148
v_accvgpr_read_b32 v41, a149
v_accvgpr_read_b32 v42, a150
v_accvgpr_read_b32 v43, a151
v_cvt_pk_bf16_f32 v44, v36, v37
v_cvt_pk_bf16_f32 v45, v38, v39
v_cvt_pk_bf16_f32 v46, v40, v41
v_cvt_pk_bf16_f32 v47, v42, v43
s_add_u32 s17, s17, 4096
buffer_store_dwordx4 v[44:47], v1, s[4:7], s17 offen offset:0 sc1
s_add_u32 s17, s16, 40960
v_accvgpr_read_b32 v48, a8
v_accvgpr_read_b32 v49, a9
v_accvgpr_read_b32 v50, a10
v_accvgpr_read_b32 v51, a11
v_accvgpr_read_b32 v52, a24
v_accvgpr_read_b32 v53, a25
v_accvgpr_read_b32 v54, a26
v_accvgpr_read_b32 v55, a27
v_cvt_pk_bf16_f32 v56, v48, v49
v_cvt_pk_bf16_f32 v57, v50, v51
v_cvt_pk_bf16_f32 v58, v52, v53
v_cvt_pk_bf16_f32 v59, v54, v55
buffer_store_dwordx4 v[56:59], v1, s[4:7], s17 offen offset:0 sc1
v_accvgpr_read_b32 v60, a40
v_accvgpr_read_b32 v61, a41
v_accvgpr_read_b32 v62, a42
v_accvgpr_read_b32 v63, a43
v_accvgpr_read_b32 v64, a56
v_accvgpr_read_b32 v65, a57
v_accvgpr_read_b32 v66, a58
v_accvgpr_read_b32 v67, a59
v_cvt_pk_bf16_f32 v68, v60, v61
v_cvt_pk_bf16_f32 v69, v62, v63
v_cvt_pk_bf16_f32 v70, v64, v65
v_cvt_pk_bf16_f32 v71, v66, v67
buffer_store_dwordx4 v[68:71], v1, s[4:7], s17 offen offset:1024 sc1
v_accvgpr_read_b32 v24, a72
v_accvgpr_read_b32 v25, a73
v_accvgpr_read_b32 v26, a74
v_accvgpr_read_b32 v27, a75
v_accvgpr_read_b32 v28, a88
v_accvgpr_read_b32 v29, a89
v_accvgpr_read_b32 v30, a90
v_accvgpr_read_b32 v31, a91
v_cvt_pk_bf16_f32 v32, v24, v25
v_cvt_pk_bf16_f32 v33, v26, v27
v_cvt_pk_bf16_f32 v34, v28, v29
v_cvt_pk_bf16_f32 v35, v30, v31
buffer_store_dwordx4 v[32:35], v1, s[4:7], s17 offen offset:2048 sc1
v_accvgpr_read_b32 v36, a104
v_accvgpr_read_b32 v37, a105
v_accvgpr_read_b32 v38, a106
v_accvgpr_read_b32 v39, a107
v_accvgpr_read_b32 v40, a120
v_accvgpr_read_b32 v41, a121
v_accvgpr_read_b32 v42, a122
v_accvgpr_read_b32 v43, a123
v_cvt_pk_bf16_f32 v44, v36, v37
v_cvt_pk_bf16_f32 v45, v38, v39
v_cvt_pk_bf16_f32 v46, v40, v41
v_cvt_pk_bf16_f32 v47, v42, v43
buffer_store_dwordx4 v[44:47], v1, s[4:7], s17 offen offset:3072 sc1
v_accvgpr_read_b32 v48, a136
v_accvgpr_read_b32 v49, a137
v_accvgpr_read_b32 v50, a138
v_accvgpr_read_b32 v51, a139
v_accvgpr_read_b32 v52, a152
v_accvgpr_read_b32 v53, a153
v_accvgpr_read_b32 v54, a154
v_accvgpr_read_b32 v55, a155
v_cvt_pk_bf16_f32 v56, v48, v49
v_cvt_pk_bf16_f32 v57, v50, v51
v_cvt_pk_bf16_f32 v58, v52, v53
v_cvt_pk_bf16_f32 v59, v54, v55
s_add_u32 s17, s17, 4096
buffer_store_dwordx4 v[56:59], v1, s[4:7], s17 offen offset:0 sc1
s_add_u32 s17, s16, 61440
v_accvgpr_read_b32 v60, a12
v_accvgpr_read_b32 v61, a13
v_accvgpr_read_b32 v62, a14
v_accvgpr_read_b32 v63, a15
v_accvgpr_read_b32 v64, a28
v_accvgpr_read_b32 v65, a29
v_accvgpr_read_b32 v66, a30
v_accvgpr_read_b32 v67, a31
v_cvt_pk_bf16_f32 v68, v60, v61
v_cvt_pk_bf16_f32 v69, v62, v63
v_cvt_pk_bf16_f32 v70, v64, v65
v_cvt_pk_bf16_f32 v71, v66, v67
buffer_store_dwordx4 v[68:71], v1, s[4:7], s17 offen offset:0 sc1
v_accvgpr_read_b32 v24, a44
v_accvgpr_read_b32 v25, a45
v_accvgpr_read_b32 v26, a46
v_accvgpr_read_b32 v27, a47
v_accvgpr_read_b32 v28, a60
v_accvgpr_read_b32 v29, a61
v_accvgpr_read_b32 v30, a62
v_accvgpr_read_b32 v31, a63
v_cvt_pk_bf16_f32 v32, v24, v25
v_cvt_pk_bf16_f32 v33, v26, v27
v_cvt_pk_bf16_f32 v34, v28, v29
v_cvt_pk_bf16_f32 v35, v30, v31
buffer_store_dwordx4 v[32:35], v1, s[4:7], s17 offen offset:1024 sc1
v_accvgpr_read_b32 v36, a76
v_accvgpr_read_b32 v37, a77
v_accvgpr_read_b32 v38, a78
v_accvgpr_read_b32 v39, a79
v_accvgpr_read_b32 v40, a92
v_accvgpr_read_b32 v41, a93
v_accvgpr_read_b32 v42, a94
v_accvgpr_read_b32 v43, a95
v_cvt_pk_bf16_f32 v44, v36, v37
v_cvt_pk_bf16_f32 v45, v38, v39
v_cvt_pk_bf16_f32 v46, v40, v41
v_cvt_pk_bf16_f32 v47, v42, v43
buffer_store_dwordx4 v[44:47], v1, s[4:7], s17 offen offset:2048 sc1
v_accvgpr_read_b32 v48, a108
v_accvgpr_read_b32 v49, a109
v_accvgpr_read_b32 v50, a110
v_accvgpr_read_b32 v51, a111
v_accvgpr_read_b32 v52, a124
v_accvgpr_read_b32 v53, a125
v_accvgpr_read_b32 v54, a126
v_accvgpr_read_b32 v55, a127
v_cvt_pk_bf16_f32 v56, v48, v49
v_cvt_pk_bf16_f32 v57, v50, v51
v_cvt_pk_bf16_f32 v58, v52, v53
v_cvt_pk_bf16_f32 v59, v54, v55
buffer_store_dwordx4 v[56:59], v1, s[4:7], s17 offen offset:3072 sc1
v_accvgpr_read_b32 v60, a140
v_accvgpr_read_b32 v61, a141
v_accvgpr_read_b32 v62, a142
v_accvgpr_read_b32 v63, a143
v_accvgpr_read_b32 v64, a156
v_accvgpr_read_b32 v65, a157
v_accvgpr_read_b32 v66, a158
v_accvgpr_read_b32 v67, a159
v_cvt_pk_bf16_f32 v68, v60, v61
v_cvt_pk_bf16_f32 v69, v62, v63
v_cvt_pk_bf16_f32 v70, v64, v65
v_cvt_pk_bf16_f32 v71, v66, v67
s_add_u32 s17, s17, 4096
buffer_store_dwordx4 v[68:71], v1, s[4:7], s17 offen offset:0 sc1
fin_exit1:
s_endpgm
.globl redln1_kernel
.p2align 8
.type redln1_kernel,@function
redln1_kernel:
s_cmp_ge_u32 s2, 256
s_cbranch_scc1 redln1_exit1
s_load_dwordx2 s[12:13], s[0:1], 96
s_load_dwordx2 s[14:15], s[0:1], 0
v_lshrrev_b32 v2, 6, v0
v_and_b32 v3, 63, v0
s_lshr_b32 s19, s2, 1
v_readfirstlane_b32 s16, v2
s_and_b32 s18, s2, 1
s_waitcnt lgkmcnt(0)
s_mov_b32 s4, s12
s_mov_b32 s5, s13
s_mov_b32 s6, 0x10000000
s_mov_b32 s7, 0x20000
s_mov_b32 s8, s14
s_mov_b32 s9, s15
s_mov_b32 s10, 2621440
s_mov_b32 s11, 0x20000
s_mov_b32 s20, 0
v_and_b32 v2, 7, v3
v_bfe_u32 v4, v3, 3, 2
v_lshrrev_b32 v5, 5, v3
s_lshl_b32 s17, s18, 7
v_lshlrev_b32 v14, 4, v2
v_lshl_add_u32 v14, v4, 8, v14
v_lshl_add_u32 v14, v5, 10, v14
v_add_u32 v14, s17, v14
s_lshl_b32 s17, s2, 3
v_add_u32 v15, s17, v2
v_mul_u32_u24 v15, 1280, v15
v_lshl_add_u32 v15, v4, 4, v15
v_lshl_add_u32 v15, v5, 6, v15
s_mul_i32 s17, s16, 640
s_add_u32 s20, s20, s17
s_add_u32 s21, s17, 82313216
s_mul_i32 s22, s19, 20
s_mul_i32 s23, s16, 10
s_add_u32 s22, s22, s23
s_lshl_b32 s22, s22, 10
s_add_u32 s34, s22, 54525952
s_add_u32 s22, s22, 90832896
s_add_u32 s24, s22, 0
s_add_u32 s25, s22, 2621440
s_add_u32 s26, s22, 5242880
s_add_u32 s27, s22, 7864320
s_add_u32 s28, s22, 10485760
s_add_u32 s29, s22, 13107200
s_add_u32 s30, s22, 15728640
s_add_u32 s31, s22, 18350080
v_add_u32 v6, 0x1000, v14
v_add_u32 v7, 0x2000, v14
buffer_load_dwordx4 v[16:19], v15, s[8:11], s20 offen offset:0
buffer_load_dwordx4 v[20:23], v15, s[8:11], s20 offen offset:128
buffer_load_dwordx4 v[24:27], v15, s[8:11], s20 offen offset:256
buffer_load_dwordx4 v[28:31], v15, s[8:11], s20 offen offset:384
buffer_load_dwordx4 v[32:35], v15, s[8:11], s20 offen offset:512
buffer_load_dwordx4 v[80:83], v14, s[4:7], s24 offen offset:0
buffer_load_dwordx4 v[84:87], v14, s[4:7], s25 offen offset:0
buffer_load_dwordx4 v[88:91], v14, s[4:7], s26 offen offset:0
buffer_load_dwordx4 v[92:95], v14, s[4:7], s27 offen offset:0
buffer_load_dwordx4 v[96:99], v14, s[4:7], s28 offen offset:0
buffer_load_dwordx4 v[100:103], v14, s[4:7], s29 offen offset:0
buffer_load_dwordx4 v[104:107], v14, s[4:7], s30 offen offset:0
buffer_load_dwordx4 v[108:111], v14, s[4:7], s31 offen offset:0
buffer_load_dwordx4 v[112:115], v14, s[4:7], s24 offen offset:2048
buffer_load_dwordx4 v[116:119], v14, s[4:7], s25 offen offset:2048
buffer_load_dwordx4 v[120:123], v14, s[4:7], s26 offen offset:2048
buffer_load_dwordx4 v[124:127], v14, s[4:7], s27 offen offset:2048
buffer_load_dwordx4 v[128:131], v14, s[4:7], s28 offen offset:2048
buffer_load_dwordx4 v[132:135], v14, s[4:7], s29 offen offset:2048
buffer_load_dwordx4 v[136:139], v14, s[4:7], s30 offen offset:2048
buffer_load_dwordx4 v[140:143], v14, s[4:7], s31 offen offset:2048
buffer_load_dwordx4 v[144:147], v6, s[4:7], s24 offen offset:0
buffer_load_dwordx4 v[148:151], v6, s[4:7], s25 offen offset:0
buffer_load_dwordx4 v[152:155], v6, s[4:7], s26 offen offset:0
buffer_load_dwordx4 v[156:159], v6, s[4:7], s27 offen offset:0
buffer_load_dwordx4 v[160:163], v6, s[4:7], s28 offen offset:0
buffer_load_dwordx4 v[164:167], v6, s[4:7], s29 offen offset:0
buffer_load_dwordx4 v[168:171], v6, s[4:7], s30 offen offset:0
buffer_load_dwordx4 v[172:175], v6, s[4:7], s31 offen offset:0
buffer_load_dwordx4 v[176:179], v6, s[4:7], s24 offen offset:2048
buffer_load_dwordx4 v[180:183], v6, s[4:7], s25 offen offset:2048
buffer_load_dwordx4 v[184:187], v6, s[4:7], s26 offen offset:2048
buffer_load_dwordx4 v[188:191], v6, s[4:7], s27 offen offset:2048
buffer_load_dwordx4 v[192:195], v6, s[4:7], s28 offen offset:2048
buffer_load_dwordx4 v[196:199], v6, s[4:7], s29 offen offset:2048
buffer_load_dwordx4 v[200:203], v6, s[4:7], s30 offen offset:2048
buffer_load_dwordx4 v[204:207], v6, s[4:7], s31 offen offset:2048
buffer_load_dwordx4 v[208:211], v7, s[4:7], s24 offen offset:0
buffer_load_dwordx4 v[212:215], v7, s[4:7], s25 offen offset:0
buffer_load_dwordx4 v[216:219], v7, s[4:7], s26 offen offset:0
buffer_load_dwordx4 v[220:223], v7, s[4:7], s27 offen offset:0
buffer_load_dwordx4 v[224:227], v7, s[4:7], s28 offen offset:0
buffer_load_dwordx4 v[228:231], v7, s[4:7], s29 offen offset:0
buffer_load_dwordx4 v[232:235], v7, s[4:7], s30 offen offset:0
buffer_load_dwordx4 v[236:239], v7, s[4:7], s31 offen offset:0
s_waitcnt vmcnt(32)
v_lshlrev_b32 v36, 16, v80
v_and_b32 v37, 0xffff0000, v80
v_lshlrev_b32 v38, 16, v81
v_and_b32 v39, 0xffff0000, v81
v_lshlrev_b32 v40, 16, v82
v_and_b32 v41, 0xffff0000, v82
v_lshlrev_b32 v42, 16, v83
v_and_b32 v43, 0xffff0000, v83
v_lshlrev_b32 v8, 16, v84
v_and_b32 v9, 0xffff0000, v84
v_pk_add_f32 v[36:37], v[36:37], v[8:9]
v_lshlrev_b32 v10, 16, v85
v_and_b32 v11, 0xffff0000, v85
v_pk_add_f32 v[38:39], v[38:39], v[10:11]
v_lshlrev_b32 v8, 16, v86
v_and_b32 v9, 0xffff0000, v86
v_pk_add_f32 v[40:41], v[40:41], v[8:9]
v_lshlrev_b32 v10, 16, v87
v_and_b32 v11, 0xffff0000, v87
v_pk_add_f32 v[42:43], v[42:43], v[10:11]
v_lshlrev_b32 v8, 16, v88
v_and_b32 v9, 0xffff0000, v88
v_pk_add_f32 v[36:37], v[36:37], v[8:9]
v_lshlrev_b32 v10, 16, v89
v_and_b32 v11, 0xffff0000, v89
v_pk_add_f32 v[38:39], v[38:39], v[10:11]
v_lshlrev_b32 v8, 16, v90
v_and_b32 v9, 0xffff0000, v90
v_pk_add_f32 v[40:41], v[40:41], v[8:9]
v_lshlrev_b32 v10, 16, v91
v_and_b32 v11, 0xffff0000, v91
v_pk_add_f32 v[42:43], v[42:43], v[10:11]
v_lshlrev_b32 v8, 16, v92
v_and_b32 v9, 0xffff0000, v92
v_pk_add_f32 v[36:37], v[36:37], v[8:9]
v_lshlrev_b32 v10, 16, v93
v_and_b32 v11, 0xffff0000, v93
v_pk_add_f32 v[38:39], v[38:39], v[10:11]
v_lshlrev_b32 v8, 16, v94
v_and_b32 v9, 0xffff0000, v94
v_pk_add_f32 v[40:41], v[40:41], v[8:9]
v_lshlrev_b32 v10, 16, v95
v_and_b32 v11, 0xffff0000, v95
v_pk_add_f32 v[42:43], v[42:43], v[10:11]
v_lshlrev_b32 v8, 16, v96
v_and_b32 v9, 0xffff0000, v96
v_pk_add_f32 v[36:37], v[36:37], v[8:9]
v_lshlrev_b32 v10, 16, v97
v_and_b32 v11, 0xffff0000, v97
v_pk_add_f32 v[38:39], v[38:39], v[10:11]
v_lshlrev_b32 v8, 16, v98
v_and_b32 v9, 0xffff0000, v98
v_pk_add_f32 v[40:41], v[40:41], v[8:9]
v_lshlrev_b32 v10, 16, v99
v_and_b32 v11, 0xffff0000, v99
v_pk_add_f32 v[42:43], v[42:43], v[10:11]
v_lshlrev_b32 v8, 16, v100
v_and_b32 v9, 0xffff0000, v100
v_pk_add_f32 v[36:37], v[36:37], v[8:9]
v_lshlrev_b32 v10, 16, v101
v_and_b32 v11, 0xffff0000, v101
v_pk_add_f32 v[38:39], v[38:39], v[10:11]
v_lshlrev_b32 v8, 16, v102
v_and_b32 v9, 0xffff0000, v102
v_pk_add_f32 v[40:41], v[40:41], v[8:9]
v_lshlrev_b32 v10, 16, v103
v_and_b32 v11, 0xffff0000, v103
v_pk_add_f32 v[42:43], v[42:43], v[10:11]
v_lshlrev_b32 v8, 16, v104
v_and_b32 v9, 0xffff0000, v104
v_pk_add_f32 v[36:37], v[36:37], v[8:9]
v_lshlrev_b32 v10, 16, v105
v_and_b32 v11, 0xffff0000, v105
v_pk_add_f32 v[38:39], v[38:39], v[10:11]
v_lshlrev_b32 v8, 16, v106
v_and_b32 v9, 0xffff0000, v106
v_pk_add_f32 v[40:41], v[40:41], v[8:9]
v_lshlrev_b32 v10, 16, v107
v_and_b32 v11, 0xffff0000, v107
v_pk_add_f32 v[42:43], v[42:43], v[10:11]
v_lshlrev_b32 v8, 16, v108
v_and_b32 v9, 0xffff0000, v108
v_pk_add_f32 v[36:37], v[36:37], v[8:9]
v_lshlrev_b32 v10, 16, v109
v_and_b32 v11, 0xffff0000, v109
v_pk_add_f32 v[38:39], v[38:39], v[10:11]
v_lshlrev_b32 v8, 16, v110
v_and_b32 v9, 0xffff0000, v110
v_pk_add_f32 v[40:41], v[40:41], v[8:9]
v_lshlrev_b32 v10, 16, v111
v_and_b32 v11, 0xffff0000, v111
v_pk_add_f32 v[42:43], v[42:43], v[10:11]
v_cvt_pk_bf16_f32 v8, v36, v37
v_lshlrev_b32 v36, 16, v8
v_and_b32 v37, 0xffff0000, v8
v_lshlrev_b32 v10, 16, v16
v_and_b32 v11, 0xffff0000, v16
v_pk_add_f32 v[36:37], v[36:37], v[10:11]
v_cvt_pk_bf16_f32 v16, v36, v37
v_lshlrev_b32 v36, 16, v16
v_and_b32 v37, 0xffff0000, v16
v_cvt_pk_bf16_f32 v8, v38, v39
v_lshlrev_b32 v38, 16, v8
v_and_b32 v39, 0xffff0000, v8
v_lshlrev_b32 v10, 16, v17
v_and_b32 v11, 0xffff0000, v17
v_pk_add_f32 v[38:39], v[38:39], v[10:11]
v_cvt_pk_bf16_f32 v17, v38, v39
v_lshlrev_b32 v38, 16, v17
v_and_b32 v39, 0xffff0000, v17
v_cvt_pk_bf16_f32 v8, v40, v41
v_lshlrev_b32 v40, 16, v8
v_and_b32 v41, 0xffff0000, v8
v_lshlrev_b32 v10, 16, v18
v_and_b32 v11, 0xffff0000, v18
v_pk_add_f32 v[40:41], v[40:41], v[10:11]
v_cvt_pk_bf16_f32 v18, v40, v41
v_lshlrev_b32 v40, 16, v18
v_and_b32 v41, 0xffff0000, v18
v_cvt_pk_bf16_f32 v8, v42, v43
v_lshlrev_b32 v42, 16, v8
v_and_b32 v43, 0xffff0000, v8
v_lshlrev_b32 v10, 16, v19
v_and_b32 v11, 0xffff0000, v19
v_pk_add_f32 v[42:43], v[42:43], v[10:11]
v_cvt_pk_bf16_f32 v19, v42, v43
v_lshlrev_b32 v42, 16, v19
v_and_b32 v43, 0xffff0000, v19
buffer_store_dwordx4 v[16:19], v15, s[4:7], s21 offen offset:0 sc1
s_waitcnt vmcnt(25)
v_lshlrev_b32 v44, 16, v112
v_and_b32 v45, 0xffff0000, v112
v_lshlrev_b32 v46, 16, v113
v_and_b32 v47, 0xffff0000, v113
v_lshlrev_b32 v48, 16, v114
v_and_b32 v49, 0xffff0000, v114
v_lshlrev_b32 v50, 16, v115
v_and_b32 v51, 0xffff0000, v115
v_lshlrev_b32 v8, 16, v116
v_and_b32 v9, 0xffff0000, v116
v_pk_add_f32 v[44:45], v[44:45], v[8:9]
v_lshlrev_b32 v10, 16, v117
v_and_b32 v11, 0xffff0000, v117
v_pk_add_f32 v[46:47], v[46:47], v[10:11]
v_lshlrev_b32 v8, 16, v118
v_and_b32 v9, 0xffff0000, v118
v_pk_add_f32 v[48:49], v[48:49], v[8:9]
v_lshlrev_b32 v10, 16, v119
v_and_b32 v11, 0xffff0000, v119
v_pk_add_f32 v[50:51], v[50:51], v[10:11]
v_lshlrev_b32 v8, 16, v120
v_and_b32 v9, 0xffff0000, v120
v_pk_add_f32 v[44:45], v[44:45], v[8:9]
v_lshlrev_b32 v10, 16, v121
v_and_b32 v11, 0xffff0000, v121
v_pk_add_f32 v[46:47], v[46:47], v[10:11]
v_lshlrev_b32 v8, 16, v122
v_and_b32 v9, 0xffff0000, v122
v_pk_add_f32 v[48:49], v[48:49], v[8:9]
v_lshlrev_b32 v10, 16, v123
v_and_b32 v11, 0xffff0000, v123
v_pk_add_f32 v[50:51], v[50:51], v[10:11]
v_lshlrev_b32 v8, 16, v124
v_and_b32 v9, 0xffff0000, v124
v_pk_add_f32 v[44:45], v[44:45], v[8:9]
v_lshlrev_b32 v10, 16, v125
v_and_b32 v11, 0xffff0000, v125
v_pk_add_f32 v[46:47], v[46:47], v[10:11]
v_lshlrev_b32 v8, 16, v126
v_and_b32 v9, 0xffff0000, v126
v_pk_add_f32 v[48:49], v[48:49], v[8:9]
v_lshlrev_b32 v10, 16, v127
v_and_b32 v11, 0xffff0000, v127
v_pk_add_f32 v[50:51], v[50:51], v[10:11]
v_lshlrev_b32 v8, 16, v128
v_and_b32 v9, 0xffff0000, v128
v_pk_add_f32 v[44:45], v[44:45], v[8:9]
v_lshlrev_b32 v10, 16, v129
v_and_b32 v11, 0xffff0000, v129
v_pk_add_f32 v[46:47], v[46:47], v[10:11]
v_lshlrev_b32 v8, 16, v130
v_and_b32 v9, 0xffff0000, v130
v_pk_add_f32 v[48:49], v[48:49], v[8:9]
v_lshlrev_b32 v10, 16, v131
v_and_b32 v11, 0xffff0000, v131
v_pk_add_f32 v[50:51], v[50:51], v[10:11]
v_lshlrev_b32 v8, 16, v132
v_and_b32 v9, 0xffff0000, v132
v_pk_add_f32 v[44:45], v[44:45], v[8:9]
v_lshlrev_b32 v10, 16, v133
v_and_b32 v11, 0xffff0000, v133
v_pk_add_f32 v[46:47], v[46:47], v[10:11]
v_lshlrev_b32 v8, 16, v134
v_and_b32 v9, 0xffff0000, v134
v_pk_add_f32 v[48:49], v[48:49], v[8:9]
v_lshlrev_b32 v10, 16, v135
v_and_b32 v11, 0xffff0000, v135
v_pk_add_f32 v[50:51], v[50:51], v[10:11]
v_lshlrev_b32 v8, 16, v136
v_and_b32 v9, 0xffff0000, v136
v_pk_add_f32 v[44:45], v[44:45], v[8:9]
v_lshlrev_b32 v10, 16, v137
v_and_b32 v11, 0xffff0000, v137
v_pk_add_f32 v[46:47], v[46:47], v[10:11]
v_lshlrev_b32 v8, 16, v138
v_and_b32 v9, 0xffff0000, v138
v_pk_add_f32 v[48:49], v[48:49], v[8:9]
v_lshlrev_b32 v10, 16, v139
v_and_b32 v11, 0xffff0000, v139
v_pk_add_f32 v[50:51], v[50:51], v[10:11]
v_lshlrev_b32 v8, 16, v140
v_and_b32 v9, 0xffff0000, v140
v_pk_add_f32 v[44:45], v[44:45], v[8:9]
v_lshlrev_b32 v10, 16, v141
v_and_b32 v11, 0xffff0000, v141
v_pk_add_f32 v[46:47], v[46:47], v[10:11]
v_lshlrev_b32 v8, 16, v142
v_and_b32 v9, 0xffff0000, v142
v_pk_add_f32 v[48:49], v[48:49], v[8:9]
v_lshlrev_b32 v10, 16, v143
v_and_b32 v11, 0xffff0000, v143
v_pk_add_f32 v[50:51], v[50:51], v[10:11]
v_cvt_pk_bf16_f32 v8, v44, v45
v_lshlrev_b32 v44, 16, v8
v_and_b32 v45, 0xffff0000, v8
v_lshlrev_b32 v10, 16, v20
v_and_b32 v11, 0xffff0000, v20
v_pk_add_f32 v[44:45], v[44:45], v[10:11]
v_cvt_pk_bf16_f32 v20, v44, v45
v_lshlrev_b32 v44, 16, v20
v_and_b32 v45, 0xffff0000, v20
v_cvt_pk_bf16_f32 v8, v46, v47
v_lshlrev_b32 v46, 16, v8
v_and_b32 v47, 0xffff0000, v8
v_lshlrev_b32 v10, 16, v21
v_and_b32 v11, 0xffff0000, v21
v_pk_add_f32 v[46:47], v[46:47], v[10:11]
v_cvt_pk_bf16_f32 v21, v46, v47
v_lshlrev_b32 v46, 16, v21
v_and_b32 v47, 0xffff0000, v21
v_cvt_pk_bf16_f32 v8, v48, v49
v_lshlrev_b32 v48, 16, v8
v_and_b32 v49, 0xffff0000, v8
v_lshlrev_b32 v10, 16, v22
v_and_b32 v11, 0xffff0000, v22
v_pk_add_f32 v[48:49], v[48:49], v[10:11]
v_cvt_pk_bf16_f32 v22, v48, v49
v_lshlrev_b32 v48, 16, v22
v_and_b32 v49, 0xffff0000, v22
v_cvt_pk_bf16_f32 v8, v50, v51
v_lshlrev_b32 v50, 16, v8
v_and_b32 v51, 0xffff0000, v8
v_lshlrev_b32 v10, 16, v23
v_and_b32 v11, 0xffff0000, v23
v_pk_add_f32 v[50:51], v[50:51], v[10:11]
v_cvt_pk_bf16_f32 v23, v50, v51
v_lshlrev_b32 v50, 16, v23
v_and_b32 v51, 0xffff0000, v23
buffer_store_dwordx4 v[20:23], v15, s[4:7], s21 offen offset:128 sc1
s_waitcnt vmcnt(18)
v_lshlrev_b32 v52, 16, v144
v_and_b32 v53, 0xffff0000, v144
v_lshlrev_b32 v54, 16, v145
v_and_b32 v55, 0xffff0000, v145
v_lshlrev_b32 v56, 16, v146
v_and_b32 v57, 0xffff0000, v146
v_lshlrev_b32 v58, 16, v147
v_and_b32 v59, 0xffff0000, v147
v_lshlrev_b32 v8, 16, v148
v_and_b32 v9, 0xffff0000, v148
v_pk_add_f32 v[52:53], v[52:53], v[8:9]
v_lshlrev_b32 v10, 16, v149
v_and_b32 v11, 0xffff0000, v149
v_pk_add_f32 v[54:55], v[54:55], v[10:11]
v_lshlrev_b32 v8, 16, v150
v_and_b32 v9, 0xffff0000, v150
v_pk_add_f32 v[56:57], v[56:57], v[8:9]
v_lshlrev_b32 v10, 16, v151
v_and_b32 v11, 0xffff0000, v151
v_pk_add_f32 v[58:59], v[58:59], v[10:11]
v_lshlrev_b32 v8, 16, v152
v_and_b32 v9, 0xffff0000, v152
v_pk_add_f32 v[52:53], v[52:53], v[8:9]
v_lshlrev_b32 v10, 16, v153
v_and_b32 v11, 0xffff0000, v153
v_pk_add_f32 v[54:55], v[54:55], v[10:11]
v_lshlrev_b32 v8, 16, v154
v_and_b32 v9, 0xffff0000, v154
v_pk_add_f32 v[56:57], v[56:57], v[8:9]
v_lshlrev_b32 v10, 16, v155
v_and_b32 v11, 0xffff0000, v155
v_pk_add_f32 v[58:59], v[58:59], v[10:11]
v_lshlrev_b32 v8, 16, v156
v_and_b32 v9, 0xffff0000, v156
v_pk_add_f32 v[52:53], v[52:53], v[8:9]
v_lshlrev_b32 v10, 16, v157
v_and_b32 v11, 0xffff0000, v157
v_pk_add_f32 v[54:55], v[54:55], v[10:11]
v_lshlrev_b32 v8, 16, v158
v_and_b32 v9, 0xffff0000, v158
v_pk_add_f32 v[56:57], v[56:57], v[8:9]
v_lshlrev_b32 v10, 16, v159
v_and_b32 v11, 0xffff0000, v159
v_pk_add_f32 v[58:59], v[58:59], v[10:11]
v_lshlrev_b32 v8, 16, v160
v_and_b32 v9, 0xffff0000, v160
v_pk_add_f32 v[52:53], v[52:53], v[8:9]
v_lshlrev_b32 v10, 16, v161
v_and_b32 v11, 0xffff0000, v161
v_pk_add_f32 v[54:55], v[54:55], v[10:11]
v_lshlrev_b32 v8, 16, v162
v_and_b32 v9, 0xffff0000, v162
v_pk_add_f32 v[56:57], v[56:57], v[8:9]
v_lshlrev_b32 v10, 16, v163
v_and_b32 v11, 0xffff0000, v163
v_pk_add_f32 v[58:59], v[58:59], v[10:11]
v_lshlrev_b32 v8, 16, v164
v_and_b32 v9, 0xffff0000, v164
v_pk_add_f32 v[52:53], v[52:53], v[8:9]
v_lshlrev_b32 v10, 16, v165
v_and_b32 v11, 0xffff0000, v165
v_pk_add_f32 v[54:55], v[54:55], v[10:11]
v_lshlrev_b32 v8, 16, v166
v_and_b32 v9, 0xffff0000, v166
v_pk_add_f32 v[56:57], v[56:57], v[8:9]
v_lshlrev_b32 v10, 16, v167
v_and_b32 v11, 0xffff0000, v167
v_pk_add_f32 v[58:59], v[58:59], v[10:11]
v_lshlrev_b32 v8, 16, v168
v_and_b32 v9, 0xffff0000, v168
v_pk_add_f32 v[52:53], v[52:53], v[8:9]
v_lshlrev_b32 v10, 16, v169
v_and_b32 v11, 0xffff0000, v169
v_pk_add_f32 v[54:55], v[54:55], v[10:11]
v_lshlrev_b32 v8, 16, v170
v_and_b32 v9, 0xffff0000, v170
v_pk_add_f32 v[56:57], v[56:57], v[8:9]
v_lshlrev_b32 v10, 16, v171
v_and_b32 v11, 0xffff0000, v171
v_pk_add_f32 v[58:59], v[58:59], v[10:11]
v_lshlrev_b32 v8, 16, v172
v_and_b32 v9, 0xffff0000, v172
v_pk_add_f32 v[52:53], v[52:53], v[8:9]
v_lshlrev_b32 v10, 16, v173
v_and_b32 v11, 0xffff0000, v173
v_pk_add_f32 v[54:55], v[54:55], v[10:11]
v_lshlrev_b32 v8, 16, v174
v_and_b32 v9, 0xffff0000, v174
v_pk_add_f32 v[56:57], v[56:57], v[8:9]
v_lshlrev_b32 v10, 16, v175
v_and_b32 v11, 0xffff0000, v175
v_pk_add_f32 v[58:59], v[58:59], v[10:11]
v_cvt_pk_bf16_f32 v8, v52, v53
v_lshlrev_b32 v52, 16, v8
v_and_b32 v53, 0xffff0000, v8
v_lshlrev_b32 v10, 16, v24
v_and_b32 v11, 0xffff0000, v24
v_pk_add_f32 v[52:53], v[52:53], v[10:11]
v_cvt_pk_bf16_f32 v24, v52, v53
v_lshlrev_b32 v52, 16, v24
v_and_b32 v53, 0xffff0000, v24
v_cvt_pk_bf16_f32 v8, v54, v55
v_lshlrev_b32 v54, 16, v8
v_and_b32 v55, 0xffff0000, v8
v_lshlrev_b32 v10, 16, v25
v_and_b32 v11, 0xffff0000, v25
v_pk_add_f32 v[54:55], v[54:55], v[10:11]
v_cvt_pk_bf16_f32 v25, v54, v55
v_lshlrev_b32 v54, 16, v25
v_and_b32 v55, 0xffff0000, v25
v_cvt_pk_bf16_f32 v8, v56, v57
v_lshlrev_b32 v56, 16, v8
v_and_b32 v57, 0xffff0000, v8
v_lshlrev_b32 v10, 16, v26
v_and_b32 v11, 0xffff0000, v26
v_pk_add_f32 v[56:57], v[56:57], v[10:11]
v_cvt_pk_bf16_f32 v26, v56, v57
v_lshlrev_b32 v56, 16, v26
v_and_b32 v57, 0xffff0000, v26
v_cvt_pk_bf16_f32 v8, v58, v59
v_lshlrev_b32 v58, 16, v8
v_and_b32 v59, 0xffff0000, v8
v_lshlrev_b32 v10, 16, v27
v_and_b32 v11, 0xffff0000, v27
v_pk_add_f32 v[58:59], v[58:59], v[10:11]
v_cvt_pk_bf16_f32 v27, v58, v59
v_lshlrev_b32 v58, 16, v27
v_and_b32 v59, 0xffff0000, v27
buffer_store_dwordx4 v[24:27], v15, s[4:7], s21 offen offset:256 sc1
s_waitcnt vmcnt(11)
v_lshlrev_b32 v60, 16, v176
v_and_b32 v61, 0xffff0000, v176
v_lshlrev_b32 v62, 16, v177
v_and_b32 v63, 0xffff0000, v177
v_lshlrev_b32 v64, 16, v178
v_and_b32 v65, 0xffff0000, v178
v_lshlrev_b32 v66, 16, v179
v_and_b32 v67, 0xffff0000, v179
v_lshlrev_b32 v8, 16, v180
v_and_b32 v9, 0xffff0000, v180
v_pk_add_f32 v[60:61], v[60:61], v[8:9]
v_lshlrev_b32 v10, 16, v181
v_and_b32 v11, 0xffff0000, v181
v_pk_add_f32 v[62:63], v[62:63], v[10:11]
v_lshlrev_b32 v8, 16, v182
v_and_b32 v9, 0xffff0000, v182
v_pk_add_f32 v[64:65], v[64:65], v[8:9]
v_lshlrev_b32 v10, 16, v183
v_and_b32 v11, 0xffff0000, v183
v_pk_add_f32 v[66:67], v[66:67], v[10:11]
v_lshlrev_b32 v8, 16, v184
v_and_b32 v9, 0xffff0000, v184
v_pk_add_f32 v[60:61], v[60:61], v[8:9]
v_lshlrev_b32 v10, 16, v185
v_and_b32 v11, 0xffff0000, v185
v_pk_add_f32 v[62:63], v[62:63], v[10:11]
v_lshlrev_b32 v8, 16, v186
v_and_b32 v9, 0xffff0000, v186
v_pk_add_f32 v[64:65], v[64:65], v[8:9]
v_lshlrev_b32 v10, 16, v187
v_and_b32 v11, 0xffff0000, v187
v_pk_add_f32 v[66:67], v[66:67], v[10:11]
v_lshlrev_b32 v8, 16, v188
v_and_b32 v9, 0xffff0000, v188
v_pk_add_f32 v[60:61], v[60:61], v[8:9]
v_lshlrev_b32 v10, 16, v189
v_and_b32 v11, 0xffff0000, v189
v_pk_add_f32 v[62:63], v[62:63], v[10:11]
v_lshlrev_b32 v8, 16, v190
v_and_b32 v9, 0xffff0000, v190
v_pk_add_f32 v[64:65], v[64:65], v[8:9]
v_lshlrev_b32 v10, 16, v191
v_and_b32 v11, 0xffff0000, v191
v_pk_add_f32 v[66:67], v[66:67], v[10:11]
v_lshlrev_b32 v8, 16, v192
v_and_b32 v9, 0xffff0000, v192
v_pk_add_f32 v[60:61], v[60:61], v[8:9]
v_lshlrev_b32 v10, 16, v193
v_and_b32 v11, 0xffff0000, v193
v_pk_add_f32 v[62:63], v[62:63], v[10:11]
v_lshlrev_b32 v8, 16, v194
v_and_b32 v9, 0xffff0000, v194
v_pk_add_f32 v[64:65], v[64:65], v[8:9]
v_lshlrev_b32 v10, 16, v195
v_and_b32 v11, 0xffff0000, v195
v_pk_add_f32 v[66:67], v[66:67], v[10:11]
v_lshlrev_b32 v8, 16, v196
v_and_b32 v9, 0xffff0000, v196
v_pk_add_f32 v[60:61], v[60:61], v[8:9]
v_lshlrev_b32 v10, 16, v197
v_and_b32 v11, 0xffff0000, v197
v_pk_add_f32 v[62:63], v[62:63], v[10:11]
v_lshlrev_b32 v8, 16, v198
v_and_b32 v9, 0xffff0000, v198
v_pk_add_f32 v[64:65], v[64:65], v[8:9]
v_lshlrev_b32 v10, 16, v199
v_and_b32 v11, 0xffff0000, v199
v_pk_add_f32 v[66:67], v[66:67], v[10:11]
v_lshlrev_b32 v8, 16, v200
v_and_b32 v9, 0xffff0000, v200
v_pk_add_f32 v[60:61], v[60:61], v[8:9]
v_lshlrev_b32 v10, 16, v201
v_and_b32 v11, 0xffff0000, v201
v_pk_add_f32 v[62:63], v[62:63], v[10:11]
v_lshlrev_b32 v8, 16, v202
v_and_b32 v9, 0xffff0000, v202
v_pk_add_f32 v[64:65], v[64:65], v[8:9]
v_lshlrev_b32 v10, 16, v203
v_and_b32 v11, 0xffff0000, v203
v_pk_add_f32 v[66:67], v[66:67], v[10:11]
v_lshlrev_b32 v8, 16, v204
v_and_b32 v9, 0xffff0000, v204
v_pk_add_f32 v[60:61], v[60:61], v[8:9]
v_lshlrev_b32 v10, 16, v205
v_and_b32 v11, 0xffff0000, v205
v_pk_add_f32 v[62:63], v[62:63], v[10:11]
v_lshlrev_b32 v8, 16, v206
v_and_b32 v9, 0xffff0000, v206
v_pk_add_f32 v[64:65], v[64:65], v[8:9]
v_lshlrev_b32 v10, 16, v207
v_and_b32 v11, 0xffff0000, v207
v_pk_add_f32 v[66:67], v[66:67], v[10:11]
v_cvt_pk_bf16_f32 v8, v60, v61
v_lshlrev_b32 v60, 16, v8
v_and_b32 v61, 0xffff0000, v8
v_lshlrev_b32 v10, 16, v28
v_and_b32 v11, 0xffff0000, v28
v_pk_add_f32 v[60:61], v[60:61], v[10:11]
v_cvt_pk_bf16_f32 v28, v60, v61
v_lshlrev_b32 v60, 16, v28
v_and_b32 v61, 0xffff0000, v28
v_cvt_pk_bf16_f32 v8, v62, v63
v_lshlrev_b32 v62, 16, v8
v_and_b32 v63, 0xffff0000, v8
v_lshlrev_b32 v10, 16, v29
v_and_b32 v11, 0xffff0000, v29
v_pk_add_f32 v[62:63], v[62:63], v[10:11]
v_cvt_pk_bf16_f32 v29, v62, v63
v_lshlrev_b32 v62, 16, v29
v_and_b32 v63, 0xffff0000, v29
v_cvt_pk_bf16_f32 v8, v64, v65
v_lshlrev_b32 v64, 16, v8
v_and_b32 v65, 0xffff0000, v8
v_lshlrev_b32 v10, 16, v30
v_and_b32 v11, 0xffff0000, v30
v_pk_add_f32 v[64:65], v[64:65], v[10:11]
v_cvt_pk_bf16_f32 v30, v64, v65
v_lshlrev_b32 v64, 16, v30
v_and_b32 v65, 0xffff0000, v30
v_cvt_pk_bf16_f32 v8, v66, v67
v_lshlrev_b32 v66, 16, v8
v_and_b32 v67, 0xffff0000, v8
v_lshlrev_b32 v10, 16, v31
v_and_b32 v11, 0xffff0000, v31
v_pk_add_f32 v[66:67], v[66:67], v[10:11]
v_cvt_pk_bf16_f32 v31, v66, v67
v_lshlrev_b32 v66, 16, v31
v_and_b32 v67, 0xffff0000, v31
buffer_store_dwordx4 v[28:31], v15, s[4:7], s21 offen offset:384 sc1
s_waitcnt vmcnt(4)
v_lshlrev_b32 v68, 16, v208
v_and_b32 v69, 0xffff0000, v208
v_lshlrev_b32 v70, 16, v209
v_and_b32 v71, 0xffff0000, v209
v_lshlrev_b32 v72, 16, v210
v_and_b32 v73, 0xffff0000, v210
v_lshlrev_b32 v74, 16, v211
v_and_b32 v75, 0xffff0000, v211
v_lshlrev_b32 v8, 16, v212
v_and_b32 v9, 0xffff0000, v212
v_pk_add_f32 v[68:69], v[68:69], v[8:9]
v_lshlrev_b32 v10, 16, v213
v_and_b32 v11, 0xffff0000, v213
v_pk_add_f32 v[70:71], v[70:71], v[10:11]
v_lshlrev_b32 v8, 16, v214
v_and_b32 v9, 0xffff0000, v214
v_pk_add_f32 v[72:73], v[72:73], v[8:9]
v_lshlrev_b32 v10, 16, v215
v_and_b32 v11, 0xffff0000, v215
v_pk_add_f32 v[74:75], v[74:75], v[10:11]
v_lshlrev_b32 v8, 16, v216
v_and_b32 v9, 0xffff0000, v216
v_pk_add_f32 v[68:69], v[68:69], v[8:9]
v_lshlrev_b32 v10, 16, v217
v_and_b32 v11, 0xffff0000, v217
v_pk_add_f32 v[70:71], v[70:71], v[10:11]
v_lshlrev_b32 v8, 16, v218
v_and_b32 v9, 0xffff0000, v218
v_pk_add_f32 v[72:73], v[72:73], v[8:9]
v_lshlrev_b32 v10, 16, v219
v_and_b32 v11, 0xffff0000, v219
v_pk_add_f32 v[74:75], v[74:75], v[10:11]
v_lshlrev_b32 v8, 16, v220
v_and_b32 v9, 0xffff0000, v220
v_pk_add_f32 v[68:69], v[68:69], v[8:9]
v_lshlrev_b32 v10, 16, v221
v_and_b32 v11, 0xffff0000, v221
v_pk_add_f32 v[70:71], v[70:71], v[10:11]
v_lshlrev_b32 v8, 16, v222
v_and_b32 v9, 0xffff0000, v222
v_pk_add_f32 v[72:73], v[72:73], v[8:9]
v_lshlrev_b32 v10, 16, v223
v_and_b32 v11, 0xffff0000, v223
v_pk_add_f32 v[74:75], v[74:75], v[10:11]
v_lshlrev_b32 v8, 16, v224
v_and_b32 v9, 0xffff0000, v224
v_pk_add_f32 v[68:69], v[68:69], v[8:9]
v_lshlrev_b32 v10, 16, v225
v_and_b32 v11, 0xffff0000, v225
v_pk_add_f32 v[70:71], v[70:71], v[10:11]
v_lshlrev_b32 v8, 16, v226
v_and_b32 v9, 0xffff0000, v226
v_pk_add_f32 v[72:73], v[72:73], v[8:9]
v_lshlrev_b32 v10, 16, v227
v_and_b32 v11, 0xffff0000, v227
v_pk_add_f32 v[74:75], v[74:75], v[10:11]
v_lshlrev_b32 v8, 16, v228
v_and_b32 v9, 0xffff0000, v228
v_pk_add_f32 v[68:69], v[68:69], v[8:9]
v_lshlrev_b32 v10, 16, v229
v_and_b32 v11, 0xffff0000, v229
v_pk_add_f32 v[70:71], v[70:71], v[10:11]
v_lshlrev_b32 v8, 16, v230
v_and_b32 v9, 0xffff0000, v230
v_pk_add_f32 v[72:73], v[72:73], v[8:9]
v_lshlrev_b32 v10, 16, v231
v_and_b32 v11, 0xffff0000, v231
v_pk_add_f32 v[74:75], v[74:75], v[10:11]
v_lshlrev_b32 v8, 16, v232
v_and_b32 v9, 0xffff0000, v232
v_pk_add_f32 v[68:69], v[68:69], v[8:9]
v_lshlrev_b32 v10, 16, v233
v_and_b32 v11, 0xffff0000, v233
v_pk_add_f32 v[70:71], v[70:71], v[10:11]
v_lshlrev_b32 v8, 16, v234
v_and_b32 v9, 0xffff0000, v234
v_pk_add_f32 v[72:73], v[72:73], v[8:9]
v_lshlrev_b32 v10, 16, v235
v_and_b32 v11, 0xffff0000, v235
v_pk_add_f32 v[74:75], v[74:75], v[10:11]
v_lshlrev_b32 v8, 16, v236
v_and_b32 v9, 0xffff0000, v236
v_pk_add_f32 v[68:69], v[68:69], v[8:9]
v_lshlrev_b32 v10, 16, v237
v_and_b32 v11, 0xffff0000, v237
v_pk_add_f32 v[70:71], v[70:71], v[10:11]
v_lshlrev_b32 v8, 16, v238
v_and_b32 v9, 0xffff0000, v238
v_pk_add_f32 v[72:73], v[72:73], v[8:9]
v_lshlrev_b32 v10, 16, v239
v_and_b32 v11, 0xffff0000, v239
v_pk_add_f32 v[74:75], v[74:75], v[10:11]
v_cvt_pk_bf16_f32 v8, v68, v69
v_lshlrev_b32 v68, 16, v8
v_and_b32 v69, 0xffff0000, v8
v_lshlrev_b32 v10, 16, v32
v_and_b32 v11, 0xffff0000, v32
v_pk_add_f32 v[68:69], v[68:69], v[10:11]
v_cvt_pk_bf16_f32 v32, v68, v69
v_lshlrev_b32 v68, 16, v32
v_and_b32 v69, 0xffff0000, v32
v_cvt_pk_bf16_f32 v8, v70, v71
v_lshlrev_b32 v70, 16, v8
v_and_b32 v71, 0xffff0000, v8
v_lshlrev_b32 v10, 16, v33
v_and_b32 v11, 0xffff0000, v33
v_pk_add_f32 v[70:71], v[70:71], v[10:11]
v_cvt_pk_bf16_f32 v33, v70, v71
v_lshlrev_b32 v70, 16, v33
v_and_b32 v71, 0xffff0000, v33
v_cvt_pk_bf16_f32 v8, v72, v73
v_lshlrev_b32 v72, 16, v8
v_and_b32 v73, 0xffff0000, v8
v_lshlrev_b32 v10, 16, v34
v_and_b32 v11, 0xffff0000, v34
v_pk_add_f32 v[72:73], v[72:73], v[10:11]
v_cvt_pk_bf16_f32 v34, v72, v73
v_lshlrev_b32 v72, 16, v34
v_and_b32 v73, 0xffff0000, v34
v_cvt_pk_bf16_f32 v8, v74, v75
v_lshlrev_b32 v74, 16, v8
v_and_b32 v75, 0xffff0000, v8
v_lshlrev_b32 v10, 16, v35
v_and_b32 v11, 0xffff0000, v35
v_pk_add_f32 v[74:75], v[74:75], v[10:11]
v_cvt_pk_bf16_f32 v35, v74, v75
v_lshlrev_b32 v74, 16, v35
v_and_b32 v75, 0xffff0000, v35
buffer_store_dwordx4 v[32:35], v15, s[4:7], s21 offen offset:512 sc1
v_and_b32 v3, 63, v0
v_and_b32 v2, 7, v3
v_lshlrev_b32 v5, 2, v2
s_lshl_b32 s17, s16, 5
v_add_u32 v1, s17, v5
v_pk_add_f32 v[6:7], v[36:37], v[38:39]
v_pk_add_f32 v[6:7], v[6:7], v[40:41]
v_pk_add_f32 v[6:7], v[6:7], v[42:43]
v_pk_add_f32 v[6:7], v[6:7], v[44:45]
v_pk_add_f32 v[6:7], v[6:7], v[46:47]
v_pk_add_f32 v[6:7], v[6:7], v[48:49]
v_pk_add_f32 v[6:7], v[6:7], v[50:51]
v_pk_add_f32 v[6:7], v[6:7], v[52:53]
v_pk_add_f32 v[6:7], v[6:7], v[54:55]
v_pk_add_f32 v[6:7], v[6:7], v[56:57]
v_pk_add_f32 v[6:7], v[6:7], v[58:59]
v_pk_add_f32 v[6:7], v[6:7], v[60:61]
v_pk_add_f32 v[6:7], v[6:7], v[62:63]
v_pk_add_f32 v[6:7], v[6:7], v[64:65]
v_pk_add_f32 v[6:7], v[6:7], v[66:67]
v_pk_add_f32 v[6:7], v[6:7], v[68:69]
v_pk_add_f32 v[6:7], v[6:7], v[70:71]
v_pk_add_f32 v[6:7], v[6:7], v[72:73]
v_pk_add_f32 v[6:7], v[6:7], v[74:75]
v_add_f32 v4, v6, v7
s_nop 1
v_add_f32_dpp v4, v4, v4 row_ror:8 row_mask:0xf bank_mask:0xf
v_mov_b32 v2, v4
s_nop 1
v_permlane16_swap_b32 v4, v2
v_add_f32 v4, v4, v2
v_mov_b32 v2, v4
s_nop 1
v_permlane32_swap_b32 v4, v2
v_add_f32 v4, v4, v2
ds_write_b32 v1, v4 offset:0
s_waitcnt lgkmcnt(0)
s_barrier
ds_read_b32 v4, v5 offset:0
ds_read_b32 v2, v5 offset:32
s_waitcnt lgkmcnt(0)
v_add_f32 v4, v4, v2
v_mul_f32 v6, 0xbacccccd, v4
v_mov_b32 v7, v6
v_pk_add_f32 v[36:37], v[36:37], v[6:7]
v_pk_add_f32 v[38:39], v[38:39], v[6:7]
v_pk_add_f32 v[40:41], v[40:41], v[6:7]
v_pk_add_f32 v[42:43], v[42:43], v[6:7]
v_pk_add_f32 v[44:45], v[44:45], v[6:7]
v_pk_add_f32 v[46:47], v[46:47], v[6:7]
v_pk_add_f32 v[48:49], v[48:49], v[6:7]
v_pk_add_f32 v[50:51], v[50:51], v[6:7]
v_pk_add_f32 v[52:53], v[52:53], v[6:7]
v_pk_add_f32 v[54:55], v[54:55], v[6:7]
v_pk_add_f32 v[56:57], v[56:57], v[6:7]
v_pk_add_f32 v[58:59], v[58:59], v[6:7]
v_pk_add_f32 v[60:61], v[60:61], v[6:7]
v_pk_add_f32 v[62:63], v[62:63], v[6:7]
v_pk_add_f32 v[64:65], v[64:65], v[6:7]
v_pk_add_f32 v[66:67], v[66:67], v[6:7]
v_pk_add_f32 v[68:69], v[68:69], v[6:7]
v_pk_add_f32 v[70:71], v[70:71], v[6:7]
v_pk_add_f32 v[72:73], v[72:73], v[6:7]
v_pk_add_f32 v[74:75], v[74:75], v[6:7]
v_pk_mul_f32 v[6:7], v[36:37], v[36:37]
v_pk_fma_f32 v[6:7], v[38:39], v[38:39], v[6:7]
v_pk_fma_f32 v[6:7], v[40:41], v[40:41], v[6:7]
v_pk_fma_f32 v[6:7], v[42:43], v[42:43], v[6:7]
v_pk_fma_f32 v[6:7], v[44:45], v[44:45], v[6:7]
v_pk_fma_f32 v[6:7], v[46:47], v[46:47], v[6:7]
v_pk_fma_f32 v[6:7], v[48:49], v[48:49], v[6:7]
v_pk_fma_f32 v[6:7], v[50:51], v[50:51], v[6:7]
v_pk_fma_f32 v[6:7], v[52:53], v[52:53], v[6:7]
v_pk_fma_f32 v[6:7], v[54:55], v[54:55], v[6:7]
v_pk_fma_f32 v[6:7], v[56:57], v[56:57], v[6:7]
v_pk_fma_f32 v[6:7], v[58:59], v[58:59], v[6:7]
v_pk_fma_f32 v[6:7], v[60:61], v[60:61], v[6:7]
v_pk_fma_f32 v[6:7], v[62:63], v[62:63], v[6:7]
v_pk_fma_f32 v[6:7], v[64:65], v[64:65], v[6:7]
v_pk_fma_f32 v[6:7], v[66:67], v[66:67], v[6:7]
v_pk_fma_f32 v[6:7], v[68:69], v[68:69], v[6:7]
v_pk_fma_f32 v[6:7], v[70:71], v[70:71], v[6:7]
v_pk_fma_f32 v[6:7], v[72:73], v[72:73], v[6:7]
v_pk_fma_f32 v[6:7], v[74:75], v[74:75], v[6:7]
v_add_f32 v4, v6, v7
s_nop 1
v_add_f32_dpp v4, v4, v4 row_ror:8 row_mask:0xf bank_mask:0xf
v_mov_b32 v2, v4
s_nop 1
v_permlane16_swap_b32 v4, v2
v_add_f32 v4, v4, v2
v_mov_b32 v2, v4
s_nop 1
v_permlane32_swap_b32 v4, v2
v_add_f32 v4, v4, v2
ds_write_b32 v1, v4 offset:64
s_waitcnt lgkmcnt(0)
s_barrier
ds_read_b32 v4, v5 offset:64
ds_read_b32 v2, v5 offset:96
s_waitcnt lgkmcnt(0)
v_add_f32 v4, v4, v2
v_mov_b32 v2, 0x3727c5ac
v_fmac_f32 v2, 0x3acccccd, v4
v_rsq_f32 v6, v2
s_nop 0
v_mov_b32 v7, v6
v_pk_mul_f32 v[36:37], v[36:37], v[6:7]
v_pk_mul_f32 v[38:39], v[38:39], v[6:7]
v_pk_mul_f32 v[40:41], v[40:41], v[6:7]
v_pk_mul_f32 v[42:43], v[42:43], v[6:7]
v_pk_mul_f32 v[44:45], v[44:45], v[6:7]
v_pk_mul_f32 v[46:47], v[46:47], v[6:7]
v_pk_mul_f32 v[48:49], v[48:49], v[6:7]
v_pk_mul_f32 v[50:51], v[50:51], v[6:7]
v_pk_mul_f32 v[52:53], v[52:53], v[6:7]
v_pk_mul_f32 v[54:55], v[54:55], v[6:7]
v_pk_mul_f32 v[56:57], v[56:57], v[6:7]
v_pk_mul_f32 v[58:59], v[58:59], v[6:7]
v_pk_mul_f32 v[60:61], v[60:61], v[6:7]
v_pk_mul_f32 v[62:63], v[62:63], v[6:7]
v_pk_mul_f32 v[64:65], v[64:65], v[6:7]
v_pk_mul_f32 v[66:67], v[66:67], v[6:7]
v_pk_mul_f32 v[68:69], v[68:69], v[6:7]
v_pk_mul_f32 v[70:71], v[70:71], v[6:7]
v_pk_mul_f32 v[72:73], v[72:73], v[6:7]
v_pk_mul_f32 v[74:75], v[74:75], v[6:7]
v_cvt_pk_bf16_f32 v16, v36, v37
v_cvt_pk_bf16_f32 v17, v38, v39
v_cvt_pk_bf16_f32 v18, v40, v41
v_cvt_pk_bf16_f32 v19, v42, v43
v_cvt_pk_bf16_f32 v20, v44, v45
v_cvt_pk_bf16_f32 v21, v46, v47
v_cvt_pk_bf16_f32 v22, v48, v49
v_cvt_pk_bf16_f32 v23, v50, v51
v_cvt_pk_bf16_f32 v24, v52, v53
v_cvt_pk_bf16_f32 v25, v54, v55
v_cvt_pk_bf16_f32 v26, v56, v57
v_cvt_pk_bf16_f32 v27, v58, v59
v_cvt_pk_bf16_f32 v28, v60, v61
v_cvt_pk_bf16_f32 v29, v62, v63
v_cvt_pk_bf16_f32 v30, v64, v65
v_cvt_pk_bf16_f32 v31, v66, v67
v_cvt_pk_bf16_f32 v32, v68, v69
v_cvt_pk_bf16_f32 v33, v70, v71
v_cvt_pk_bf16_f32 v34, v72, v73
v_cvt_pk_bf16_f32 v35, v74, v75
v_add_u32 v6, 0x1000, v14
v_add_u32 v7, 0x2000, v14
buffer_store_dwordx4 v[16:19], v14, s[4:7], s34 offen offset:0 sc1
buffer_store_dwordx4 v[20:23], v14, s[4:7], s34 offen offset:2048 sc1
buffer_store_dwordx4 v[24:27], v6, s[4:7], s34 offen offset:0 sc1
buffer_store_dwordx4 v[28:31], v6, s[4:7], s34 offen offset:2048 sc1
buffer_store_dwordx4 v[32:35], v7, s[4:7], s34 offen offset:0 sc1
redln1_exit1:
s_endpgm
.globl redln2_kernel
.p2align 8
.type redln2_kernel,@function
redln2_kernel:
s_cmp_ge_u32 s2, 256
s_cbranch_scc1 redln2_exit1
s_load_dwordx2 s[12:13], s[0:1], 96
s_load_dwordx2 s[14:15], s[0:1], 0
v_lshrrev_b32 v2, 6, v0
v_and_b32 v3, 63, v0
s_lshr_b32 s19, s2, 1
v_readfirstlane_b32 s16, v2
s_and_b32 s18, s2, 1
s_waitcnt lgkmcnt(0)
s_mov_b32 s4, s12
s_mov_b32 s5, s13
s_mov_b32 s6, 0x10000000
s_mov_b32 s7, 0x20000
s_mov_b32 s8, s12
s_mov_b32 s9, s13
s_mov_b32 s10, 0x10000000
s_mov_b32 s11, 0x20000
s_mov_b32 s20, 82313216
v_and_b32 v2, 7, v3
v_bfe_u32 v4, v3, 3, 2
v_lshrrev_b32 v5, 5, v3
s_lshl_b32 s17, s18, 7
v_lshlrev_b32 v14, 4, v2
v_lshl_add_u32 v14, v4, 8, v14
v_lshl_add_u32 v14, v5, 10, v14
v_add_u32 v14, s17, v14
s_lshl_b32 s17, s2, 3
v_add_u32 v15, s17, v2
v_mul_u32_u24 v15, 1280, v15
v_lshl_add_u32 v15, v4, 4, v15
v_lshl_add_u32 v15, v5, 6, v15
s_mul_i32 s17, s16, 640
s_add_u32 s20, s20, s17
s_add_u32 s21, s17, 82313216
s_mul_i32 s22, s19, 20
s_mul_i32 s23, s16, 10
s_add_u32 s22, s22, s23
s_lshl_b32 s22, s22, 10
s_add_u32 s34, s22, 54525952
s_add_u32 s22, s22, 90832896
s_add_u32 s24, s22, 0
s_add_u32 s25, s22, 2621440
s_add_u32 s26, s22, 5242880
s_add_u32 s27, s22, 7864320
s_add_u32 s28, s22, 10485760
s_add_u32 s29, s22, 13107200
s_add_u32 s30, s22, 15728640
s_add_u32 s31, s22, 18350080
v_add_u32 v6, 0x1000, v14
v_add_u32 v7, 0x2000, v14
buffer_load_dwordx4 v[16:19], v15, s[8:11], s20 offen offset:0
buffer_load_dwordx4 v[20:23], v15, s[8:11], s20 offen offset:128
buffer_load_dwordx4 v[24:27], v15, s[8:11], s20 offen offset:256
buffer_load_dwordx4 v[28:31], v15, s[8:11], s20 offen offset:384
buffer_load_dwordx4 v[32:35], v15, s[8:11], s20 offen offset:512
buffer_load_dwordx4 v[80:83], v14, s[4:7], s24 offen offset:0
buffer_load_dwordx4 v[84:87], v14, s[4:7], s25 offen offset:0
buffer_load_dwordx4 v[88:91], v14, s[4:7], s26 offen offset:0
buffer_load_dwordx4 v[92:95], v14, s[4:7], s27 offen offset:0
buffer_load_dwordx4 v[96:99], v14, s[4:7], s28 offen offset:0
buffer_load_dwordx4 v[100:103], v14, s[4:7], s29 offen offset:0
buffer_load_dwordx4 v[104:107], v14, s[4:7], s30 offen offset:0
buffer_load_dwordx4 v[108:111], v14, s[4:7], s31 offen offset:0
buffer_load_dwordx4 v[112:115], v14, s[4:7], s24 offen offset:2048
buffer_load_dwordx4 v[116:119], v14, s[4:7], s25 offen offset:2048
buffer_load_dwordx4 v[120:123], v14, s[4:7], s26 offen offset:2048
buffer_load_dwordx4 v[124:127], v14, s[4:7], s27 offen offset:2048
buffer_load_dwordx4 v[128:131], v14, s[4:7], s28 offen offset:2048
buffer_load_dwordx4 v[132:135], v14, s[4:7], s29 offen offset:2048
buffer_load_dwordx4 v[136:139], v14, s[4:7], s30 offen offset:2048
buffer_load_dwordx4 v[140:143], v14, s[4:7], s31 offen offset:2048
buffer_load_dwordx4 v[144:147], v6, s[4:7], s24 offen offset:0
buffer_load_dwordx4 v[148:151], v6, s[4:7], s25 offen offset:0
buffer_load_dwordx4 v[152:155], v6, s[4:7], s26 offen offset:0
buffer_load_dwordx4 v[156:159], v6, s[4:7], s27 offen offset:0
buffer_load_dwordx4 v[160:163], v6, s[4:7], s28 offen offset:0
buffer_load_dwordx4 v[164:167], v6, s[4:7], s29 offen offset:0
buffer_load_dwordx4 v[168:171], v6, s[4:7], s30 offen offset:0
buffer_load_dwordx4 v[172:175], v6, s[4:7], s31 offen offset:0
buffer_load_dwordx4 v[176:179], v6, s[4:7], s24 offen offset:2048
buffer_load_dwordx4 v[180:183], v6, s[4:7], s25 offen offset:2048
buffer_load_dwordx4 v[184:187], v6, s[4:7], s26 offen offset:2048
buffer_load_dwordx4 v[188:191], v6, s[4:7], s27 offen offset:2048
buffer_load_dwordx4 v[192:195], v6, s[4:7], s28 offen offset:2048
buffer_load_dwordx4 v[196:199], v6, s[4:7], s29 offen offset:2048
buffer_load_dwordx4 v[200:203], v6, s[4:7], s30 offen offset:2048
buffer_load_dwordx4 v[204:207], v6, s[4:7], s31 offen offset:2048
buffer_load_dwordx4 v[208:211], v7, s[4:7], s24 offen offset:0
buffer_load_dwordx4 v[212:215], v7, s[4:7], s25 offen offset:0
buffer_load_dwordx4 v[216:219], v7, s[4:7], s26 offen offset:0
buffer_load_dwordx4 v[220:223], v7, s[4:7], s27 offen offset:0
buffer_load_dwordx4 v[224:227], v7, s[4:7], s28 offen offset:0
buffer_load_dwordx4 v[228:231], v7, s[4:7], s29 offen offset:0
buffer_load_dwordx4 v[232:235], v7, s[4:7], s30 offen offset:0
buffer_load_dwordx4 v[236:239], v7, s[4:7], s31 offen offset:0
s_waitcnt vmcnt(32)
v_lshlrev_b32 v36, 16, v80
v_and_b32 v37, 0xffff0000, v80
v_lshlrev_b32 v38, 16, v81
v_and_b32 v39, 0xffff0000, v81
v_lshlrev_b32 v40, 16, v82
v_and_b32 v41, 0xffff0000, v82
v_lshlrev_b32 v42, 16, v83
v_and_b32 v43, 0xffff0000, v83
v_lshlrev_b32 v8, 16, v84
v_and_b32 v9, 0xffff0000, v84
v_pk_add_f32 v[36:37], v[36:37], v[8:9]
v_lshlrev_b32 v10, 16, v85
v_and_b32 v11, 0xffff0000, v85
v_pk_add_f32 v[38:39], v[38:39], v[10:11]
v_lshlrev_b32 v8, 16, v86
v_and_b32 v9, 0xffff0000, v86
v_pk_add_f32 v[40:41], v[40:41], v[8:9]
v_lshlrev_b32 v10, 16, v87
v_and_b32 v11, 0xffff0000, v87
v_pk_add_f32 v[42:43], v[42:43], v[10:11]
v_lshlrev_b32 v8, 16, v88
v_and_b32 v9, 0xffff0000, v88
v_pk_add_f32 v[36:37], v[36:37], v[8:9]
v_lshlrev_b32 v10, 16, v89
v_and_b32 v11, 0xffff0000, v89
v_pk_add_f32 v[38:39], v[38:39], v[10:11]
v_lshlrev_b32 v8, 16, v90
v_and_b32 v9, 0xffff0000, v90
v_pk_add_f32 v[40:41], v[40:41], v[8:9]
v_lshlrev_b32 v10, 16, v91
v_and_b32 v11, 0xffff0000, v91
v_pk_add_f32 v[42:43], v[42:43], v[10:11]
v_lshlrev_b32 v8, 16, v92
v_and_b32 v9, 0xffff0000, v92
v_pk_add_f32 v[36:37], v[36:37], v[8:9]
v_lshlrev_b32 v10, 16, v93
v_and_b32 v11, 0xffff0000, v93
v_pk_add_f32 v[38:39], v[38:39], v[10:11]
v_lshlrev_b32 v8, 16, v94
v_and_b32 v9, 0xffff0000, v94
v_pk_add_f32 v[40:41], v[40:41], v[8:9]
v_lshlrev_b32 v10, 16, v95
v_and_b32 v11, 0xffff0000, v95
v_pk_add_f32 v[42:43], v[42:43], v[10:11]
v_lshlrev_b32 v8, 16, v96
v_and_b32 v9, 0xffff0000, v96
v_pk_add_f32 v[36:37], v[36:37], v[8:9]
v_lshlrev_b32 v10, 16, v97
v_and_b32 v11, 0xffff0000, v97
v_pk_add_f32 v[38:39], v[38:39], v[10:11]
v_lshlrev_b32 v8, 16, v98
v_and_b32 v9, 0xffff0000, v98
v_pk_add_f32 v[40:41], v[40:41], v[8:9]
v_lshlrev_b32 v10, 16, v99
v_and_b32 v11, 0xffff0000, v99
v_pk_add_f32 v[42:43], v[42:43], v[10:11]
v_lshlrev_b32 v8, 16, v100
v_and_b32 v9, 0xffff0000, v100
v_pk_add_f32 v[36:37], v[36:37], v[8:9]
v_lshlrev_b32 v10, 16, v101
v_and_b32 v11, 0xffff0000, v101
v_pk_add_f32 v[38:39], v[38:39], v[10:11]
v_lshlrev_b32 v8, 16, v102
v_and_b32 v9, 0xffff0000, v102
v_pk_add_f32 v[40:41], v[40:41], v[8:9]
v_lshlrev_b32 v10, 16, v103
v_and_b32 v11, 0xffff0000, v103
v_pk_add_f32 v[42:43], v[42:43], v[10:11]
v_lshlrev_b32 v8, 16, v104
v_and_b32 v9, 0xffff0000, v104
v_pk_add_f32 v[36:37], v[36:37], v[8:9]
v_lshlrev_b32 v10, 16, v105
v_and_b32 v11, 0xffff0000, v105
v_pk_add_f32 v[38:39], v[38:39], v[10:11]
v_lshlrev_b32 v8, 16, v106
v_and_b32 v9, 0xffff0000, v106
v_pk_add_f32 v[40:41], v[40:41], v[8:9]
v_lshlrev_b32 v10, 16, v107
v_and_b32 v11, 0xffff0000, v107
v_pk_add_f32 v[42:43], v[42:43], v[10:11]
v_lshlrev_b32 v8, 16, v108
v_and_b32 v9, 0xffff0000, v108
v_pk_add_f32 v[36:37], v[36:37], v[8:9]
v_lshlrev_b32 v10, 16, v109
v_and_b32 v11, 0xffff0000, v109
v_pk_add_f32 v[38:39], v[38:39], v[10:11]
v_lshlrev_b32 v8, 16, v110
v_and_b32 v9, 0xffff0000, v110
v_pk_add_f32 v[40:41], v[40:41], v[8:9]
v_lshlrev_b32 v10, 16, v111
v_and_b32 v11, 0xffff0000, v111
v_pk_add_f32 v[42:43], v[42:43], v[10:11]
v_cvt_pk_bf16_f32 v8, v36, v37
v_lshlrev_b32 v36, 16, v8
v_and_b32 v37, 0xffff0000, v8
v_lshlrev_b32 v10, 16, v16
v_and_b32 v11, 0xffff0000, v16
v_pk_add_f32 v[36:37], v[36:37], v[10:11]
v_cvt_pk_bf16_f32 v16, v36, v37
v_lshlrev_b32 v36, 16, v16
v_and_b32 v37, 0xffff0000, v16
v_cvt_pk_bf16_f32 v8, v38, v39
v_lshlrev_b32 v38, 16, v8
v_and_b32 v39, 0xffff0000, v8
v_lshlrev_b32 v10, 16, v17
v_and_b32 v11, 0xffff0000, v17
v_pk_add_f32 v[38:39], v[38:39], v[10:11]
v_cvt_pk_bf16_f32 v17, v38, v39
v_lshlrev_b32 v38, 16, v17
v_and_b32 v39, 0xffff0000, v17
v_cvt_pk_bf16_f32 v8, v40, v41
v_lshlrev_b32 v40, 16, v8
v_and_b32 v41, 0xffff0000, v8
v_lshlrev_b32 v10, 16, v18
v_and_b32 v11, 0xffff0000, v18
v_pk_add_f32 v[40:41], v[40:41], v[10:11]
v_cvt_pk_bf16_f32 v18, v40, v41
v_lshlrev_b32 v40, 16, v18
v_and_b32 v41, 0xffff0000, v18
v_cvt_pk_bf16_f32 v8, v42, v43
v_lshlrev_b32 v42, 16, v8
v_and_b32 v43, 0xffff0000, v8
v_lshlrev_b32 v10, 16, v19
v_and_b32 v11, 0xffff0000, v19
v_pk_add_f32 v[42:43], v[42:43], v[10:11]
v_cvt_pk_bf16_f32 v19, v42, v43
v_lshlrev_b32 v42, 16, v19
v_and_b32 v43, 0xffff0000, v19
buffer_store_dwordx4 v[16:19], v15, s[4:7], s21 offen offset:0 sc1
s_waitcnt vmcnt(25)
v_lshlrev_b32 v44, 16, v112
v_and_b32 v45, 0xffff0000, v112
v_lshlrev_b32 v46, 16, v113
v_and_b32 v47, 0xffff0000, v113
v_lshlrev_b32 v48, 16, v114
v_and_b32 v49, 0xffff0000, v114
v_lshlrev_b32 v50, 16, v115
v_and_b32 v51, 0xffff0000, v115
v_lshlrev_b32 v8, 16, v116
v_and_b32 v9, 0xffff0000, v116
v_pk_add_f32 v[44:45], v[44:45], v[8:9]
v_lshlrev_b32 v10, 16, v117
v_and_b32 v11, 0xffff0000, v117
v_pk_add_f32 v[46:47], v[46:47], v[10:11]
v_lshlrev_b32 v8, 16, v118
v_and_b32 v9, 0xffff0000, v118
v_pk_add_f32 v[48:49], v[48:49], v[8:9]
v_lshlrev_b32 v10, 16, v119
v_and_b32 v11, 0xffff0000, v119
v_pk_add_f32 v[50:51], v[50:51], v[10:11]
v_lshlrev_b32 v8, 16, v120
v_and_b32 v9, 0xffff0000, v120
v_pk_add_f32 v[44:45], v[44:45], v[8:9]
v_lshlrev_b32 v10, 16, v121
v_and_b32 v11, 0xffff0000, v121
v_pk_add_f32 v[46:47], v[46:47], v[10:11]
v_lshlrev_b32 v8, 16, v122
v_and_b32 v9, 0xffff0000, v122
v_pk_add_f32 v[48:49], v[48:49], v[8:9]
v_lshlrev_b32 v10, 16, v123
v_and_b32 v11, 0xffff0000, v123
v_pk_add_f32 v[50:51], v[50:51], v[10:11]
v_lshlrev_b32 v8, 16, v124
v_and_b32 v9, 0xffff0000, v124
v_pk_add_f32 v[44:45], v[44:45], v[8:9]
v_lshlrev_b32 v10, 16, v125
v_and_b32 v11, 0xffff0000, v125
v_pk_add_f32 v[46:47], v[46:47], v[10:11]
v_lshlrev_b32 v8, 16, v126
v_and_b32 v9, 0xffff0000, v126
v_pk_add_f32 v[48:49], v[48:49], v[8:9]
v_lshlrev_b32 v10, 16, v127
v_and_b32 v11, 0xffff0000, v127
v_pk_add_f32 v[50:51], v[50:51], v[10:11]
v_lshlrev_b32 v8, 16, v128
v_and_b32 v9, 0xffff0000, v128
v_pk_add_f32 v[44:45], v[44:45], v[8:9]
v_lshlrev_b32 v10, 16, v129
v_and_b32 v11, 0xffff0000, v129
v_pk_add_f32 v[46:47], v[46:47], v[10:11]
v_lshlrev_b32 v8, 16, v130
v_and_b32 v9, 0xffff0000, v130
v_pk_add_f32 v[48:49], v[48:49], v[8:9]
v_lshlrev_b32 v10, 16, v131
v_and_b32 v11, 0xffff0000, v131
v_pk_add_f32 v[50:51], v[50:51], v[10:11]
v_lshlrev_b32 v8, 16, v132
v_and_b32 v9, 0xffff0000, v132
v_pk_add_f32 v[44:45], v[44:45], v[8:9]
v_lshlrev_b32 v10, 16, v133
v_and_b32 v11, 0xffff0000, v133
v_pk_add_f32 v[46:47], v[46:47], v[10:11]
v_lshlrev_b32 v8, 16, v134
v_and_b32 v9, 0xffff0000, v134
v_pk_add_f32 v[48:49], v[48:49], v[8:9]
v_lshlrev_b32 v10, 16, v135
v_and_b32 v11, 0xffff0000, v135
v_pk_add_f32 v[50:51], v[50:51], v[10:11]
v_lshlrev_b32 v8, 16, v136
v_and_b32 v9, 0xffff0000, v136
v_pk_add_f32 v[44:45], v[44:45], v[8:9]
v_lshlrev_b32 v10, 16, v137
v_and_b32 v11, 0xffff0000, v137
v_pk_add_f32 v[46:47], v[46:47], v[10:11]
v_lshlrev_b32 v8, 16, v138
v_and_b32 v9, 0xffff0000, v138
v_pk_add_f32 v[48:49], v[48:49], v[8:9]
v_lshlrev_b32 v10, 16, v139
v_and_b32 v11, 0xffff0000, v139
v_pk_add_f32 v[50:51], v[50:51], v[10:11]
v_lshlrev_b32 v8, 16, v140
v_and_b32 v9, 0xffff0000, v140
v_pk_add_f32 v[44:45], v[44:45], v[8:9]
v_lshlrev_b32 v10, 16, v141
v_and_b32 v11, 0xffff0000, v141
v_pk_add_f32 v[46:47], v[46:47], v[10:11]
v_lshlrev_b32 v8, 16, v142
v_and_b32 v9, 0xffff0000, v142
v_pk_add_f32 v[48:49], v[48:49], v[8:9]
v_lshlrev_b32 v10, 16, v143
v_and_b32 v11, 0xffff0000, v143
v_pk_add_f32 v[50:51], v[50:51], v[10:11]
v_cvt_pk_bf16_f32 v8, v44, v45
v_lshlrev_b32 v44, 16, v8
v_and_b32 v45, 0xffff0000, v8
v_lshlrev_b32 v10, 16, v20
v_and_b32 v11, 0xffff0000, v20
v_pk_add_f32 v[44:45], v[44:45], v[10:11]
v_cvt_pk_bf16_f32 v20, v44, v45
v_lshlrev_b32 v44, 16, v20
v_and_b32 v45, 0xffff0000, v20
v_cvt_pk_bf16_f32 v8, v46, v47
v_lshlrev_b32 v46, 16, v8
v_and_b32 v47, 0xffff0000, v8
v_lshlrev_b32 v10, 16, v21
v_and_b32 v11, 0xffff0000, v21
v_pk_add_f32 v[46:47], v[46:47], v[10:11]
v_cvt_pk_bf16_f32 v21, v46, v47
v_lshlrev_b32 v46, 16, v21
v_and_b32 v47, 0xffff0000, v21
v_cvt_pk_bf16_f32 v8, v48, v49
v_lshlrev_b32 v48, 16, v8
v_and_b32 v49, 0xffff0000, v8
v_lshlrev_b32 v10, 16, v22
v_and_b32 v11, 0xffff0000, v22
v_pk_add_f32 v[48:49], v[48:49], v[10:11]
v_cvt_pk_bf16_f32 v22, v48, v49
v_lshlrev_b32 v48, 16, v22
v_and_b32 v49, 0xffff0000, v22
v_cvt_pk_bf16_f32 v8, v50, v51
v_lshlrev_b32 v50, 16, v8
v_and_b32 v51, 0xffff0000, v8
v_lshlrev_b32 v10, 16, v23
v_and_b32 v11, 0xffff0000, v23
v_pk_add_f32 v[50:51], v[50:51], v[10:11]
v_cvt_pk_bf16_f32 v23, v50, v51
v_lshlrev_b32 v50, 16, v23
v_and_b32 v51, 0xffff0000, v23
buffer_store_dwordx4 v[20:23], v15, s[4:7], s21 offen offset:128 sc1
s_waitcnt vmcnt(18)
v_lshlrev_b32 v52, 16, v144
v_and_b32 v53, 0xffff0000, v144
v_lshlrev_b32 v54, 16, v145
v_and_b32 v55, 0xffff0000, v145
v_lshlrev_b32 v56, 16, v146
v_and_b32 v57, 0xffff0000, v146
v_lshlrev_b32 v58, 16, v147
v_and_b32 v59, 0xffff0000, v147
v_lshlrev_b32 v8, 16, v148
v_and_b32 v9, 0xffff0000, v148
v_pk_add_f32 v[52:53], v[52:53], v[8:9]
v_lshlrev_b32 v10, 16, v149
v_and_b32 v11, 0xffff0000, v149
v_pk_add_f32 v[54:55], v[54:55], v[10:11]
v_lshlrev_b32 v8, 16, v150
v_and_b32 v9, 0xffff0000, v150
v_pk_add_f32 v[56:57], v[56:57], v[8:9]
v_lshlrev_b32 v10, 16, v151
v_and_b32 v11, 0xffff0000, v151
v_pk_add_f32 v[58:59], v[58:59], v[10:11]
v_lshlrev_b32 v8, 16, v152
v_and_b32 v9, 0xffff0000, v152
v_pk_add_f32 v[52:53], v[52:53], v[8:9]
v_lshlrev_b32 v10, 16, v153
v_and_b32 v11, 0xffff0000, v153
v_pk_add_f32 v[54:55], v[54:55], v[10:11]
v_lshlrev_b32 v8, 16, v154
v_and_b32 v9, 0xffff0000, v154
v_pk_add_f32 v[56:57], v[56:57], v[8:9]
v_lshlrev_b32 v10, 16, v155
v_and_b32 v11, 0xffff0000, v155
v_pk_add_f32 v[58:59], v[58:59], v[10:11]
v_lshlrev_b32 v8, 16, v156
v_and_b32 v9, 0xffff0000, v156
v_pk_add_f32 v[52:53], v[52:53], v[8:9]
v_lshlrev_b32 v10, 16, v157
v_and_b32 v11, 0xffff0000, v157
v_pk_add_f32 v[54:55], v[54:55], v[10:11]
v_lshlrev_b32 v8, 16, v158
v_and_b32 v9, 0xffff0000, v158
v_pk_add_f32 v[56:57], v[56:57], v[8:9]
v_lshlrev_b32 v10, 16, v159
v_and_b32 v11, 0xffff0000, v159
v_pk_add_f32 v[58:59], v[58:59], v[10:11]
v_lshlrev_b32 v8, 16, v160
v_and_b32 v9, 0xffff0000, v160
v_pk_add_f32 v[52:53], v[52:53], v[8:9]
v_lshlrev_b32 v10, 16, v161
v_and_b32 v11, 0xffff0000, v161
v_pk_add_f32 v[54:55], v[54:55], v[10:11]
v_lshlrev_b32 v8, 16, v162
v_and_b32 v9, 0xffff0000, v162
v_pk_add_f32 v[56:57], v[56:57], v[8:9]
v_lshlrev_b32 v10, 16, v163
v_and_b32 v11, 0xffff0000, v163
v_pk_add_f32 v[58:59], v[58:59], v[10:11]
v_lshlrev_b32 v8, 16, v164
v_and_b32 v9, 0xffff0000, v164
v_pk_add_f32 v[52:53], v[52:53], v[8:9]
v_lshlrev_b32 v10, 16, v165
v_and_b32 v11, 0xffff0000, v165
v_pk_add_f32 v[54:55], v[54:55], v[10:11]
v_lshlrev_b32 v8, 16, v166
v_and_b32 v9, 0xffff0000, v166
v_pk_add_f32 v[56:57], v[56:57], v[8:9]
v_lshlrev_b32 v10, 16, v167
v_and_b32 v11, 0xffff0000, v167
v_pk_add_f32 v[58:59], v[58:59], v[10:11]
v_lshlrev_b32 v8, 16, v168
v_and_b32 v9, 0xffff0000, v168
v_pk_add_f32 v[52:53], v[52:53], v[8:9]
v_lshlrev_b32 v10, 16, v169
v_and_b32 v11, 0xffff0000, v169
v_pk_add_f32 v[54:55], v[54:55], v[10:11]
v_lshlrev_b32 v8, 16, v170
v_and_b32 v9, 0xffff0000, v170
v_pk_add_f32 v[56:57], v[56:57], v[8:9]
v_lshlrev_b32 v10, 16, v171
v_and_b32 v11, 0xffff0000, v171
v_pk_add_f32 v[58:59], v[58:59], v[10:11]
v_lshlrev_b32 v8, 16, v172
v_and_b32 v9, 0xffff0000, v172
v_pk_add_f32 v[52:53], v[52:53], v[8:9]
v_lshlrev_b32 v10, 16, v173
v_and_b32 v11, 0xffff0000, v173
v_pk_add_f32 v[54:55], v[54:55], v[10:11]
v_lshlrev_b32 v8, 16, v174
v_and_b32 v9, 0xffff0000, v174
v_pk_add_f32 v[56:57], v[56:57], v[8:9]
v_lshlrev_b32 v10, 16, v175
v_and_b32 v11, 0xffff0000, v175
v_pk_add_f32 v[58:59], v[58:59], v[10:11]
v_cvt_pk_bf16_f32 v8, v52, v53
v_lshlrev_b32 v52, 16, v8
v_and_b32 v53, 0xffff0000, v8
v_lshlrev_b32 v10, 16, v24
v_and_b32 v11, 0xffff0000, v24
v_pk_add_f32 v[52:53], v[52:53], v[10:11]
v_cvt_pk_bf16_f32 v24, v52, v53
v_lshlrev_b32 v52, 16, v24
v_and_b32 v53, 0xffff0000, v24
v_cvt_pk_bf16_f32 v8, v54, v55
v_lshlrev_b32 v54, 16, v8
v_and_b32 v55, 0xffff0000, v8
v_lshlrev_b32 v10, 16, v25
v_and_b32 v11, 0xffff0000, v25
v_pk_add_f32 v[54:55], v[54:55], v[10:11]
v_cvt_pk_bf16_f32 v25, v54, v55
v_lshlrev_b32 v54, 16, v25
v_and_b32 v55, 0xffff0000, v25
v_cvt_pk_bf16_f32 v8, v56, v57
v_lshlrev_b32 v56, 16, v8
v_and_b32 v57, 0xffff0000, v8
v_lshlrev_b32 v10, 16, v26
v_and_b32 v11, 0xffff0000, v26
v_pk_add_f32 v[56:57], v[56:57], v[10:11]
v_cvt_pk_bf16_f32 v26, v56, v57
v_lshlrev_b32 v56, 16, v26
v_and_b32 v57, 0xffff0000, v26
v_cvt_pk_bf16_f32 v8, v58, v59
v_lshlrev_b32 v58, 16, v8
v_and_b32 v59, 0xffff0000, v8
v_lshlrev_b32 v10, 16, v27
v_and_b32 v11, 0xffff0000, v27
v_pk_add_f32 v[58:59], v[58:59], v[10:11]
v_cvt_pk_bf16_f32 v27, v58, v59
v_lshlrev_b32 v58, 16, v27
v_and_b32 v59, 0xffff0000, v27
buffer_store_dwordx4 v[24:27], v15, s[4:7], s21 offen offset:256 sc1
s_waitcnt vmcnt(11)
v_lshlrev_b32 v60, 16, v176
v_and_b32 v61, 0xffff0000, v176
v_lshlrev_b32 v62, 16, v177
v_and_b32 v63, 0xffff0000, v177
v_lshlrev_b32 v64, 16, v178
v_and_b32 v65, 0xffff0000, v178
v_lshlrev_b32 v66, 16, v179
v_and_b32 v67, 0xffff0000, v179
v_lshlrev_b32 v8, 16, v180
v_and_b32 v9, 0xffff0000, v180
v_pk_add_f32 v[60:61], v[60:61], v[8:9]
v_lshlrev_b32 v10, 16, v181
v_and_b32 v11, 0xffff0000, v181
v_pk_add_f32 v[62:63], v[62:63], v[10:11]
v_lshlrev_b32 v8, 16, v182
v_and_b32 v9, 0xffff0000, v182
v_pk_add_f32 v[64:65], v[64:65], v[8:9]
v_lshlrev_b32 v10, 16, v183
v_and_b32 v11, 0xffff0000, v183
v_pk_add_f32 v[66:67], v[66:67], v[10:11]
v_lshlrev_b32 v8, 16, v184
v_and_b32 v9, 0xffff0000, v184
v_pk_add_f32 v[60:61], v[60:61], v[8:9]
v_lshlrev_b32 v10, 16, v185
v_and_b32 v11, 0xffff0000, v185
v_pk_add_f32 v[62:63], v[62:63], v[10:11]
v_lshlrev_b32 v8, 16, v186
v_and_b32 v9, 0xffff0000, v186
v_pk_add_f32 v[64:65], v[64:65], v[8:9]
v_lshlrev_b32 v10, 16, v187
v_and_b32 v11, 0xffff0000, v187
v_pk_add_f32 v[66:67], v[66:67], v[10:11]
v_lshlrev_b32 v8, 16, v188
v_and_b32 v9, 0xffff0000, v188
v_pk_add_f32 v[60:61], v[60:61], v[8:9]
v_lshlrev_b32 v10, 16, v189
v_and_b32 v11, 0xffff0000, v189
v_pk_add_f32 v[62:63], v[62:63], v[10:11]
v_lshlrev_b32 v8, 16, v190
v_and_b32 v9, 0xffff0000, v190
v_pk_add_f32 v[64:65], v[64:65], v[8:9]
v_lshlrev_b32 v10, 16, v191
v_and_b32 v11, 0xffff0000, v191
v_pk_add_f32 v[66:67], v[66:67], v[10:11]
v_lshlrev_b32 v8, 16, v192
v_and_b32 v9, 0xffff0000, v192
v_pk_add_f32 v[60:61], v[60:61], v[8:9]
v_lshlrev_b32 v10, 16, v193
v_and_b32 v11, 0xffff0000, v193
v_pk_add_f32 v[62:63], v[62:63], v[10:11]
v_lshlrev_b32 v8, 16, v194
v_and_b32 v9, 0xffff0000, v194
v_pk_add_f32 v[64:65], v[64:65], v[8:9]
v_lshlrev_b32 v10, 16, v195
v_and_b32 v11, 0xffff0000, v195
v_pk_add_f32 v[66:67], v[66:67], v[10:11]
v_lshlrev_b32 v8, 16, v196
v_and_b32 v9, 0xffff0000, v196
v_pk_add_f32 v[60:61], v[60:61], v[8:9]
v_lshlrev_b32 v10, 16, v197
v_and_b32 v11, 0xffff0000, v197
v_pk_add_f32 v[62:63], v[62:63], v[10:11]
v_lshlrev_b32 v8, 16, v198
v_and_b32 v9, 0xffff0000, v198
v_pk_add_f32 v[64:65], v[64:65], v[8:9]
v_lshlrev_b32 v10, 16, v199
v_and_b32 v11, 0xffff0000, v199
v_pk_add_f32 v[66:67], v[66:67], v[10:11]
v_lshlrev_b32 v8, 16, v200
v_and_b32 v9, 0xffff0000, v200
v_pk_add_f32 v[60:61], v[60:61], v[8:9]
v_lshlrev_b32 v10, 16, v201
v_and_b32 v11, 0xffff0000, v201
v_pk_add_f32 v[62:63], v[62:63], v[10:11]
v_lshlrev_b32 v8, 16, v202
v_and_b32 v9, 0xffff0000, v202
v_pk_add_f32 v[64:65], v[64:65], v[8:9]
v_lshlrev_b32 v10, 16, v203
v_and_b32 v11, 0xffff0000, v203
v_pk_add_f32 v[66:67], v[66:67], v[10:11]
v_lshlrev_b32 v8, 16, v204
v_and_b32 v9, 0xffff0000, v204
v_pk_add_f32 v[60:61], v[60:61], v[8:9]
v_lshlrev_b32 v10, 16, v205
v_and_b32 v11, 0xffff0000, v205
v_pk_add_f32 v[62:63], v[62:63], v[10:11]
v_lshlrev_b32 v8, 16, v206
v_and_b32 v9, 0xffff0000, v206
v_pk_add_f32 v[64:65], v[64:65], v[8:9]
v_lshlrev_b32 v10, 16, v207
v_and_b32 v11, 0xffff0000, v207
v_pk_add_f32 v[66:67], v[66:67], v[10:11]
v_cvt_pk_bf16_f32 v8, v60, v61
v_lshlrev_b32 v60, 16, v8
v_and_b32 v61, 0xffff0000, v8
v_lshlrev_b32 v10, 16, v28
v_and_b32 v11, 0xffff0000, v28
v_pk_add_f32 v[60:61], v[60:61], v[10:11]
v_cvt_pk_bf16_f32 v28, v60, v61
v_lshlrev_b32 v60, 16, v28
v_and_b32 v61, 0xffff0000, v28
v_cvt_pk_bf16_f32 v8, v62, v63
v_lshlrev_b32 v62, 16, v8
v_and_b32 v63, 0xffff0000, v8
v_lshlrev_b32 v10, 16, v29
v_and_b32 v11, 0xffff0000, v29
v_pk_add_f32 v[62:63], v[62:63], v[10:11]
v_cvt_pk_bf16_f32 v29, v62, v63
v_lshlrev_b32 v62, 16, v29
v_and_b32 v63, 0xffff0000, v29
v_cvt_pk_bf16_f32 v8, v64, v65
v_lshlrev_b32 v64, 16, v8
v_and_b32 v65, 0xffff0000, v8
v_lshlrev_b32 v10, 16, v30
v_and_b32 v11, 0xffff0000, v30
v_pk_add_f32 v[64:65], v[64:65], v[10:11]
v_cvt_pk_bf16_f32 v30, v64, v65
v_lshlrev_b32 v64, 16, v30
v_and_b32 v65, 0xffff0000, v30
v_cvt_pk_bf16_f32 v8, v66, v67
v_lshlrev_b32 v66, 16, v8
v_and_b32 v67, 0xffff0000, v8
v_lshlrev_b32 v10, 16, v31
v_and_b32 v11, 0xffff0000, v31
v_pk_add_f32 v[66:67], v[66:67], v[10:11]
v_cvt_pk_bf16_f32 v31, v66, v67
v_lshlrev_b32 v66, 16, v31
v_and_b32 v67, 0xffff0000, v31
buffer_store_dwordx4 v[28:31], v15, s[4:7], s21 offen offset:384 sc1
s_waitcnt vmcnt(4)
v_lshlrev_b32 v68, 16, v208
v_and_b32 v69, 0xffff0000, v208
v_lshlrev_b32 v70, 16, v209
v_and_b32 v71, 0xffff0000, v209
v_lshlrev_b32 v72, 16, v210
v_and_b32 v73, 0xffff0000, v210
v_lshlrev_b32 v74, 16, v211
v_and_b32 v75, 0xffff0000, v211
v_lshlrev_b32 v8, 16, v212
v_and_b32 v9, 0xffff0000, v212
v_pk_add_f32 v[68:69], v[68:69], v[8:9]
v_lshlrev_b32 v10, 16, v213
v_and_b32 v11, 0xffff0000, v213
v_pk_add_f32 v[70:71], v[70:71], v[10:11]
v_lshlrev_b32 v8, 16, v214
v_and_b32 v9, 0xffff0000, v214
v_pk_add_f32 v[72:73], v[72:73], v[8:9]
v_lshlrev_b32 v10, 16, v215
v_and_b32 v11, 0xffff0000, v215
v_pk_add_f32 v[74:75], v[74:75], v[10:11]
v_lshlrev_b32 v8, 16, v216
v_and_b32 v9, 0xffff0000, v216
v_pk_add_f32 v[68:69], v[68:69], v[8:9]
v_lshlrev_b32 v10, 16, v217
v_and_b32 v11, 0xffff0000, v217
v_pk_add_f32 v[70:71], v[70:71], v[10:11]
v_lshlrev_b32 v8, 16, v218
v_and_b32 v9, 0xffff0000, v218
v_pk_add_f32 v[72:73], v[72:73], v[8:9]
v_lshlrev_b32 v10, 16, v219
v_and_b32 v11, 0xffff0000, v219
v_pk_add_f32 v[74:75], v[74:75], v[10:11]
v_lshlrev_b32 v8, 16, v220
v_and_b32 v9, 0xffff0000, v220
v_pk_add_f32 v[68:69], v[68:69], v[8:9]
v_lshlrev_b32 v10, 16, v221
v_and_b32 v11, 0xffff0000, v221
v_pk_add_f32 v[70:71], v[70:71], v[10:11]
v_lshlrev_b32 v8, 16, v222
v_and_b32 v9, 0xffff0000, v222
v_pk_add_f32 v[72:73], v[72:73], v[8:9]
v_lshlrev_b32 v10, 16, v223
v_and_b32 v11, 0xffff0000, v223
v_pk_add_f32 v[74:75], v[74:75], v[10:11]
v_lshlrev_b32 v8, 16, v224
v_and_b32 v9, 0xffff0000, v224
v_pk_add_f32 v[68:69], v[68:69], v[8:9]
v_lshlrev_b32 v10, 16, v225
v_and_b32 v11, 0xffff0000, v225
v_pk_add_f32 v[70:71], v[70:71], v[10:11]
v_lshlrev_b32 v8, 16, v226
v_and_b32 v9, 0xffff0000, v226
v_pk_add_f32 v[72:73], v[72:73], v[8:9]
v_lshlrev_b32 v10, 16, v227
v_and_b32 v11, 0xffff0000, v227
v_pk_add_f32 v[74:75], v[74:75], v[10:11]
v_lshlrev_b32 v8, 16, v228
v_and_b32 v9, 0xffff0000, v228
v_pk_add_f32 v[68:69], v[68:69], v[8:9]
v_lshlrev_b32 v10, 16, v229
v_and_b32 v11, 0xffff0000, v229
v_pk_add_f32 v[70:71], v[70:71], v[10:11]
v_lshlrev_b32 v8, 16, v230
v_and_b32 v9, 0xffff0000, v230
v_pk_add_f32 v[72:73], v[72:73], v[8:9]
v_lshlrev_b32 v10, 16, v231
v_and_b32 v11, 0xffff0000, v231
v_pk_add_f32 v[74:75], v[74:75], v[10:11]
v_lshlrev_b32 v8, 16, v232
v_and_b32 v9, 0xffff0000, v232
v_pk_add_f32 v[68:69], v[68:69], v[8:9]
v_lshlrev_b32 v10, 16, v233
v_and_b32 v11, 0xffff0000, v233
v_pk_add_f32 v[70:71], v[70:71], v[10:11]
v_lshlrev_b32 v8, 16, v234
v_and_b32 v9, 0xffff0000, v234
v_pk_add_f32 v[72:73], v[72:73], v[8:9]
v_lshlrev_b32 v10, 16, v235
v_and_b32 v11, 0xffff0000, v235
v_pk_add_f32 v[74:75], v[74:75], v[10:11]
v_lshlrev_b32 v8, 16, v236
v_and_b32 v9, 0xffff0000, v236
v_pk_add_f32 v[68:69], v[68:69], v[8:9]
v_lshlrev_b32 v10, 16, v237
v_and_b32 v11, 0xffff0000, v237
v_pk_add_f32 v[70:71], v[70:71], v[10:11]
v_lshlrev_b32 v8, 16, v238
v_and_b32 v9, 0xffff0000, v238
v_pk_add_f32 v[72:73], v[72:73], v[8:9]
v_lshlrev_b32 v10, 16, v239
v_and_b32 v11, 0xffff0000, v239
v_pk_add_f32 v[74:75], v[74:75], v[10:11]
v_cvt_pk_bf16_f32 v8, v68, v69
v_lshlrev_b32 v68, 16, v8
v_and_b32 v69, 0xffff0000, v8
v_lshlrev_b32 v10, 16, v32
v_and_b32 v11, 0xffff0000, v32
v_pk_add_f32 v[68:69], v[68:69], v[10:11]
v_cvt_pk_bf16_f32 v32, v68, v69
v_lshlrev_b32 v68, 16, v32
v_and_b32 v69, 0xffff0000, v32
v_cvt_pk_bf16_f32 v8, v70, v71
v_lshlrev_b32 v70, 16, v8
v_and_b32 v71, 0xffff0000, v8
v_lshlrev_b32 v10, 16, v33
v_and_b32 v11, 0xffff0000, v33
v_pk_add_f32 v[70:71], v[70:71], v[10:11]
v_cvt_pk_bf16_f32 v33, v70, v71
v_lshlrev_b32 v70, 16, v33
v_and_b32 v71, 0xffff0000, v33
v_cvt_pk_bf16_f32 v8, v72, v73
v_lshlrev_b32 v72, 16, v8
v_and_b32 v73, 0xffff0000, v8
v_lshlrev_b32 v10, 16, v34
v_and_b32 v11, 0xffff0000, v34
v_pk_add_f32 v[72:73], v[72:73], v[10:11]
v_cvt_pk_bf16_f32 v34, v72, v73
v_lshlrev_b32 v72, 16, v34
v_and_b32 v73, 0xffff0000, v34
v_cvt_pk_bf16_f32 v8, v74, v75
v_lshlrev_b32 v74, 16, v8
v_and_b32 v75, 0xffff0000, v8
v_lshlrev_b32 v10, 16, v35
v_and_b32 v11, 0xffff0000, v35
v_pk_add_f32 v[74:75], v[74:75], v[10:11]
v_cvt_pk_bf16_f32 v35, v74, v75
v_lshlrev_b32 v74, 16, v35
v_and_b32 v75, 0xffff0000, v35
buffer_store_dwordx4 v[32:35], v15, s[4:7], s21 offen offset:512 sc1
v_and_b32 v3, 63, v0
v_and_b32 v2, 7, v3
v_lshlrev_b32 v5, 2, v2
s_lshl_b32 s17, s16, 5
v_add_u32 v1, s17, v5
v_pk_add_f32 v[6:7], v[36:37], v[38:39]
v_pk_add_f32 v[6:7], v[6:7], v[40:41]
v_pk_add_f32 v[6:7], v[6:7], v[42:43]
v_pk_add_f32 v[6:7], v[6:7], v[44:45]
v_pk_add_f32 v[6:7], v[6:7], v[46:47]
v_pk_add_f32 v[6:7], v[6:7], v[48:49]
v_pk_add_f32 v[6:7], v[6:7], v[50:51]
v_pk_add_f32 v[6:7], v[6:7], v[52:53]
v_pk_add_f32 v[6:7], v[6:7], v[54:55]
v_pk_add_f32 v[6:7], v[6:7], v[56:57]
v_pk_add_f32 v[6:7], v[6:7], v[58:59]
v_pk_add_f32 v[6:7], v[6:7], v[60:61]
v_pk_add_f32 v[6:7], v[6:7], v[62:63]
v_pk_add_f32 v[6:7], v[6:7], v[64:65]
v_pk_add_f32 v[6:7], v[6:7], v[66:67]
v_pk_add_f32 v[6:7], v[6:7], v[68:69]
v_pk_add_f32 v[6:7], v[6:7], v[70:71]
v_pk_add_f32 v[6:7], v[6:7], v[72:73]
v_pk_add_f32 v[6:7], v[6:7], v[74:75]
v_add_f32 v4, v6, v7
s_nop 1
v_add_f32_dpp v4, v4, v4 row_ror:8 row_mask:0xf bank_mask:0xf
v_mov_b32 v2, v4
s_nop 1
v_permlane16_swap_b32 v4, v2
v_add_f32 v4, v4, v2
v_mov_b32 v2, v4
s_nop 1
v_permlane32_swap_b32 v4, v2
v_add_f32 v4, v4, v2
ds_write_b32 v1, v4 offset:0
s_waitcnt lgkmcnt(0)
s_barrier
ds_read_b32 v4, v5 offset:0
ds_read_b32 v2, v5 offset:32
s_waitcnt lgkmcnt(0)
v_add_f32 v4, v4, v2
v_mul_f32 v6, 0xbacccccd, v4
v_mov_b32 v7, v6
v_pk_add_f32 v[36:37], v[36:37], v[6:7]
v_pk_add_f32 v[38:39], v[38:39], v[6:7]
v_pk_add_f32 v[40:41], v[40:41], v[6:7]
v_pk_add_f32 v[42:43], v[42:43], v[6:7]
v_pk_add_f32 v[44:45], v[44:45], v[6:7]
v_pk_add_f32 v[46:47], v[46:47], v[6:7]
v_pk_add_f32 v[48:49], v[48:49], v[6:7]
v_pk_add_f32 v[50:51], v[50:51], v[6:7]
v_pk_add_f32 v[52:53], v[52:53], v[6:7]
v_pk_add_f32 v[54:55], v[54:55], v[6:7]
v_pk_add_f32 v[56:57], v[56:57], v[6:7]
v_pk_add_f32 v[58:59], v[58:59], v[6:7]
v_pk_add_f32 v[60:61], v[60:61], v[6:7]
v_pk_add_f32 v[62:63], v[62:63], v[6:7]
v_pk_add_f32 v[64:65], v[64:65], v[6:7]
v_pk_add_f32 v[66:67], v[66:67], v[6:7]
v_pk_add_f32 v[68:69], v[68:69], v[6:7]
v_pk_add_f32 v[70:71], v[70:71], v[6:7]
v_pk_add_f32 v[72:73], v[72:73], v[6:7]
v_pk_add_f32 v[74:75], v[74:75], v[6:7]
v_pk_mul_f32 v[6:7], v[36:37], v[36:37]
v_pk_fma_f32 v[6:7], v[38:39], v[38:39], v[6:7]
v_pk_fma_f32 v[6:7], v[40:41], v[40:41], v[6:7]
v_pk_fma_f32 v[6:7], v[42:43], v[42:43], v[6:7]
v_pk_fma_f32 v[6:7], v[44:45], v[44:45], v[6:7]
v_pk_fma_f32 v[6:7], v[46:47], v[46:47], v[6:7]
v_pk_fma_f32 v[6:7], v[48:49], v[48:49], v[6:7]
v_pk_fma_f32 v[6:7], v[50:51], v[50:51], v[6:7]
v_pk_fma_f32 v[6:7], v[52:53], v[52:53], v[6:7]
v_pk_fma_f32 v[6:7], v[54:55], v[54:55], v[6:7]
v_pk_fma_f32 v[6:7], v[56:57], v[56:57], v[6:7]
v_pk_fma_f32 v[6:7], v[58:59], v[58:59], v[6:7]
v_pk_fma_f32 v[6:7], v[60:61], v[60:61], v[6:7]
v_pk_fma_f32 v[6:7], v[62:63], v[62:63], v[6:7]
v_pk_fma_f32 v[6:7], v[64:65], v[64:65], v[6:7]
v_pk_fma_f32 v[6:7], v[66:67], v[66:67], v[6:7]
v_pk_fma_f32 v[6:7], v[68:69], v[68:69], v[6:7]
v_pk_fma_f32 v[6:7], v[70:71], v[70:71], v[6:7]
v_pk_fma_f32 v[6:7], v[72:73], v[72:73], v[6:7]
v_pk_fma_f32 v[6:7], v[74:75], v[74:75], v[6:7]
v_add_f32 v4, v6, v7
s_nop 1
v_add_f32_dpp v4, v4, v4 row_ror:8 row_mask:0xf bank_mask:0xf
v_mov_b32 v2, v4
s_nop 1
v_permlane16_swap_b32 v4, v2
v_add_f32 v4, v4, v2
v_mov_b32 v2, v4
s_nop 1
v_permlane32_swap_b32 v4, v2
v_add_f32 v4, v4, v2
ds_write_b32 v1, v4 offset:64
s_waitcnt lgkmcnt(0)
s_barrier
ds_read_b32 v4, v5 offset:64
ds_read_b32 v2, v5 offset:96
s_waitcnt lgkmcnt(0)
v_add_f32 v4, v4, v2
v_mov_b32 v2, 0x3727c5ac
v_fmac_f32 v2, 0x3acccccd, v4
v_rsq_f32 v6, v2
s_nop 0
v_mov_b32 v7, v6
v_pk_mul_f32 v[36:37], v[36:37], v[6:7]
v_pk_mul_f32 v[38:39], v[38:39], v[6:7]
v_pk_mul_f32 v[40:41], v[40:41], v[6:7]
v_pk_mul_f32 v[42:43], v[42:43], v[6:7]
v_pk_mul_f32 v[44:45], v[44:45], v[6:7]
v_pk_mul_f32 v[46:47], v[46:47], v[6:7]
v_pk_mul_f32 v[48:49], v[48:49], v[6:7]
v_pk_mul_f32 v[50:51], v[50:51], v[6:7]
v_pk_mul_f32 v[52:53], v[52:53], v[6:7]
v_pk_mul_f32 v[54:55], v[54:55], v[6:7]
v_pk_mul_f32 v[56:57], v[56:57], v[6:7]
v_pk_mul_f32 v[58:59], v[58:59], v[6:7]
v_pk_mul_f32 v[60:61], v[60:61], v[6:7]
v_pk_mul_f32 v[62:63], v[62:63], v[6:7]
v_pk_mul_f32 v[64:65], v[64:65], v[6:7]
v_pk_mul_f32 v[66:67], v[66:67], v[6:7]
v_pk_mul_f32 v[68:69], v[68:69], v[6:7]
v_pk_mul_f32 v[70:71], v[70:71], v[6:7]
v_pk_mul_f32 v[72:73], v[72:73], v[6:7]
v_pk_mul_f32 v[74:75], v[74:75], v[6:7]
v_cvt_pk_bf16_f32 v16, v36, v37
v_cvt_pk_bf16_f32 v17, v38, v39
v_cvt_pk_bf16_f32 v18, v40, v41
v_cvt_pk_bf16_f32 v19, v42, v43
v_cvt_pk_bf16_f32 v20, v44, v45
v_cvt_pk_bf16_f32 v21, v46, v47
v_cvt_pk_bf16_f32 v22, v48, v49
v_cvt_pk_bf16_f32 v23, v50, v51
v_cvt_pk_bf16_f32 v24, v52, v53
v_cvt_pk_bf16_f32 v25, v54, v55
v_cvt_pk_bf16_f32 v26, v56, v57
v_cvt_pk_bf16_f32 v27, v58, v59
v_cvt_pk_bf16_f32 v28, v60, v61
v_cvt_pk_bf16_f32 v29, v62, v63
v_cvt_pk_bf16_f32 v30, v64, v65
v_cvt_pk_bf16_f32 v31, v66, v67
v_cvt_pk_bf16_f32 v32, v68, v69
v_cvt_pk_bf16_f32 v33, v70, v71
v_cvt_pk_bf16_f32 v34, v72, v73
v_cvt_pk_bf16_f32 v35, v74, v75
v_add_u32 v6, 0x1000, v14
v_add_u32 v7, 0x2000, v14
buffer_store_dwordx4 v[16:19], v14, s[4:7], s34 offen offset:0 sc1
buffer_store_dwordx4 v[20:23], v14, s[4:7], s34 offen offset:2048 sc1
buffer_store_dwordx4 v[24:27], v6, s[4:7], s34 offen offset:0 sc1
buffer_store_dwordx4 v[28:31], v6, s[4:7], s34 offen offset:2048 sc1
buffer_store_dwordx4 v[32:35], v7, s[4:7], s34 offen offset:0 sc1
redln2_exit1:
s_endpgm
.globl qkvb_kernel
.p2align 8
.type qkvb_kernel,@function
qkvb_kernel:
s_cmp_ge_u32 s2, 256
s_cbranch_scc1 qkvb_exit1
s_load_dwordx2 s[12:13], s[0:1], 96
v_lshrrev_b32 v2, 6, v0
v_and_b32 v3, 63, v0
s_and_b32 s17, s2, 7
v_readfirstlane_b32 s16, v2
v_lshlrev_b32 v1, 4, v3
s_lshr_b32 s18, s2, 3
s_waitcnt lgkmcnt(0)
s_mov_b32 s4, s12
s_mov_b32 s5, s13
s_mov_b32 s6, 0x10000000
s_mov_b32 s7, 0x20000
s_lshl_b32 s21, s18, 2
s_add_u32 s21, s21, s16
s_mul_i32 s21, s21, 20480
s_add_u32 s21, s21, 54525952
s_mul_i32 s22, s16, 20480
v_add_u32 v7, 40960, v1
v_mov_b32 v6, v1
s_add_u32 m0, s22, 0
s_add_u32 s23, s21, 0
buffer_load_dwordx4 v1, s[4:7], s23 offen offset:0 lds
buffer_load_dwordx4 v1, s[4:7], s23 offen offset:1024 lds
buffer_load_dwordx4 v1, s[4:7], s23 offen offset:2048 lds
buffer_load_dwordx4 v1, s[4:7], s23 offen offset:3072 lds
s_cmp_eq_u32 s16, 0
s_cbranch_scc1 qkvb_w0_2
s_cmp_eq_u32 s16, 1
s_cbranch_scc1 qkvb_w1_3
s_cmp_eq_u32 s16, 2
s_cbranch_scc1 qkvb_w2_4
s_branch qkvb_w3_5
qkvb_w0_2:
s_mul_i32 s30, s17, 5
s_add_u32 s30, s30, 0
s_mul_i32 s30, s30, 20480
s_add_u32 s30, s30, 87556096
s_mul_i32 s31, s17, 5
s_add_u32 s31, s31, 1
s_mul_i32 s31, s31, 20480
s_add_u32 s31, s31, 87556096
s_mul_i32 s32, s17, 5
s_add_u32 s32, s32, 2
s_mul_i32 s32, s32, 20480
s_add_u32 s32, s32, 87556096
s_mul_i32 s33, s17, 5
s_add_u32 s33, s33, 3
s_mul_i32 s33, s33, 20480
s_add_u32 s33, s33, 87556096
buffer_load_dwordx4 v[72:75], v1, s[4:7], s30 offen offset:0
buffer_load_dwordx4 v[76:79], v1, s[4:7], s31 offen offset:0
buffer_load_dwordx4 v[80:83], v1, s[4:7], s32 offen offset:0
buffer_load_dwordx4 v[84:87], v1, s[4:7], s33 offen offset:0
buffer_load_dwordx4 v[88:91], v1, s[4:7], s30 offen offset:1024
buffer_load_dwordx4 v[92:95], v1, s[4:7], s31 offen offset:1024
buffer_load_dwordx4 v[96:99], v1, s[4:7], s32 offen offset:1024
buffer_load_dwordx4 v[100:103], v1, s[4:7], s33 offen offset:1024
buffer_load_dwordx4 v[104:107], v1, s[4:7], s30 offen offset:2048
buffer_load_dwordx4 v[108:111], v1, s[4:7], s31 offen offset:2048
buffer_load_dwordx4 v[112:115], v1, s[4:7], s32 offen offset:2048
buffer_load_dwordx4 v[116:119], v1, s[4:7], s33 offen offset:2048
s_add_u32 m0, s22, 4096
s_add_u32 s23, s21, 4096
buffer_load_dwordx4 v1, s[4:7], s23 offen offset:0 lds
buffer_load_dwordx4 v1, s[4:7], s23 offen offset:1024 lds
buffer_load_dwordx4 v1, s[4:7], s23 offen offset:2048 lds
buffer_load_dwordx4 v1, s[4:7], s23 offen offset:3072 lds
s_add_u32 m0, s22, 8192
s_add_u32 s23, s21, 8192
buffer_load_dwordx4 v1, s[4:7], s23 offen offset:0 lds
buffer_load_dwordx4 v1, s[4:7], s23 offen offset:1024 lds
buffer_load_dwordx4 v1, s[4:7], s23 offen offset:2048 lds
buffer_load_dwordx4 v1, s[4:7], s23 offen offset:3072 lds
s_add_u32 m0, s22, 12288
s_add_u32 s23, s21, 12288
buffer_load_dwordx4 v1, s[4:7], s23 offen offset:0 lds
buffer_load_dwordx4 v1, s[4:7], s23 offen offset:1024 lds
buffer_load_dwordx4 v1, s[4:7], s23 offen offset:2048 lds
buffer_load_dwordx4 v1, s[4:7], s23 offen offset:3072 lds
s_add_u32 m0, s22, 16384
s_add_u32 s23, s21, 16384
buffer_load_dwordx4 v1, s[4:7], s23 offen offset:0 lds
buffer_load_dwordx4 v1, s[4:7], s23 offen offset:1024 lds
buffer_load_dwordx4 v1, s[4:7], s23 offen offset:2048 lds
buffer_load_dwordx4 v1, s[4:7], s23 offen offset:3072 lds
s_waitcnt vmcnt(28)
s_barrier
ds_read_b128 v[136:139], v6 offset:0
ds_read_b128 v[140:143], v6 offset:20480
ds_read_b128 v[144:147], v7 offset:0
ds_read_b128 v[148:151], v7 offset:20480
buffer_load_dwordx4 v[120:123], v1, s[4:7], s30 offen offset:3072
buffer_load_dwordx4 v[124:127], v1, s[4:7], s31 offen offset:3072
buffer_load_dwordx4 v[128:131], v1, s[4:7], s32 offen offset:3072
buffer_load_dwordx4 v[132:135], v1, s[4:7], s33 offen offset:3072
s_waitcnt vmcnt(28)
ds_read_b128 v[152:155], v6 offset:1024
ds_read_b128 v[156:159], v6 offset:21504
ds_read_b128 v[160:163], v7 offset:1024
ds_read_b128 v[164:167], v7 offset:21504
s_waitcnt lgkmcnt(4)
v_mfma_f32_16x16x32_bf16 v[8:11], v[72:75], v[136:139], 0
v_mfma_f32_16x16x32_bf16 v[12:15], v[72:75], v[140:143], 0
v_mfma_f32_16x16x32_bf16 v[16:19], v[72:75], v[144:147], 0
v_mfma_f32_16x16x32_bf16 v[20:23], v[72:75], v[148:151], 0
v_mfma_f32_16x16x32_bf16 v[24:27], v[76:79], v[136:139], 0
v_mfma_f32_16x16x32_bf16 v[28:31], v[76:79], v[140:143], 0
v_mfma_f32_16x16x32_bf16 v[32:35], v[76:79], v[144:147], 0
v_mfma_f32_16x16x32_bf16 v[36:39], v[76:79], v[148:151], 0
v_mfma_f32_16x16x32_bf16 v[40:43], v[80:83], v[136:139], 0
v_mfma_f32_16x16x32_bf16 v[44:47], v[80:83], v[140:143], 0
v_mfma_f32_16x16x32_bf16 v[48:51], v[80:83], v[144:147], 0
v_mfma_f32_16x16x32_bf16 v[52:55], v[80:83], v[148:151], 0
v_mfma_f32_16x16x32_bf16 v[56:59], v[84:87], v[136:139], 0
v_mfma_f32_16x16x32_bf16 v[60:63], v[84:87], v[140:143], 0
v_mfma_f32_16x16x32_bf16 v[64:67], v[84:87], v[144:147], 0
v_mfma_f32_16x16x32_bf16 v[68:71], v[84:87], v[148:151], 0
s_add_u32 s30, s30, 4096
s_add_u32 s31, s31, 4096
s_add_u32 s32, s32, 4096
s_add_u32 s33, s33, 4096
buffer_load_dwordx4 v[72:75], v1, s[4:7], s30 offen offset:0
buffer_load_dwordx4 v[76:79], v1, s[4:7], s31 offen offset:0
buffer_load_dwordx4 v[80:83], v1, s[4:7], s32 offen offset:0
buffer_load_dwordx4 v[84:87], v1, s[4:7], s33 offen offset:0
s_waitcnt vmcnt(28)
ds_read_b128 v[136:139], v6 offset:2048
ds_read_b128 v[140:143], v6 offset:22528
ds_read_b128 v[144:147], v7 offset:2048
ds_read_b128 v[148:151], v7 offset:22528
s_waitcnt lgkmcnt(4)
v_mfma_f32_16x16x32_bf16 v[8:11], v[88:91], v[152:155], v[8:11]
v_mfma_f32_16x16x32_bf16 v[12:15], v[88:91], v[156:159], v[12:15]
v_mfma_f32_16x16x32_bf16 v[16:19], v[88:91], v[160:163], v[16:19]
v_mfma_f32_16x16x32_bf16 v[20:23], v[88:91], v[164:167], v[20:23]
v_mfma_f32_16x16x32_bf16 v[24:27], v[92:95], v[152:155], v[24:27]
v_mfma_f32_16x16x32_bf16 v[28:31], v[92:95], v[156:159], v[28:31]
v_mfma_f32_16x16x32_bf16 v[32:35], v[92:95], v[160:163], v[32:35]
v_mfma_f32_16x16x32_bf16 v[36:39], v[92:95], v[164:167], v[36:39]
v_mfma_f32_16x16x32_bf16 v[40:43], v[96:99], v[152:155], v[40:43]
v_mfma_f32_16x16x32_bf16 v[44:47], v[96:99], v[156:159], v[44:47]
v_mfma_f32_16x16x32_bf16 v[48:51], v[96:99], v[160:163], v[48:51]
v_mfma_f32_16x16x32_bf16 v[52:55], v[96:99], v[164:167], v[52:55]
v_mfma_f32_16x16x32_bf16 v[56:59], v[100:103], v[152:155], v[56:59]
v_mfma_f32_16x16x32_bf16 v[60:63], v[100:103], v[156:159], v[60:63]
v_mfma_f32_16x16x32_bf16 v[64:67], v[100:103], v[160:163], v[64:67]
v_mfma_f32_16x16x32_bf16 v[68:71], v[100:103], v[164:167], v[68:71]
buffer_load_dwordx4 v[88:91], v1, s[4:7], s30 offen offset:1024
buffer_load_dwordx4 v[92:95], v1, s[4:7], s31 offen offset:1024
buffer_load_dwordx4 v[96:99], v1, s[4:7], s32 offen offset:1024
buffer_load_dwordx4 v[100:103], v1, s[4:7], s33 offen offset:1024
s_waitcnt vmcnt(28)
ds_read_b128 v[152:155], v6 offset:3072
ds_read_b128 v[156:159], v6 offset:23552
ds_read_b128 v[160:163], v7 offset:3072
ds_read_b128 v[164:167], v7 offset:23552
s_waitcnt lgkmcnt(4)
v_mfma_f32_16x16x32_bf16 v[8:11], v[104:107], v[136:139], v[8:11]
v_mfma_f32_16x16x32_bf16 v[12:15], v[104:107], v[140:143], v[12:15]
v_mfma_f32_16x16x32_bf16 v[16:19], v[104:107], v[144:147], v[16:19]
v_mfma_f32_16x16x32_bf16 v[20:23], v[104:107], v[148:151], v[20:23]
v_mfma_f32_16x16x32_bf16 v[24:27], v[108:111], v[136:139], v[24:27]
v_mfma_f32_16x16x32_bf16 v[28:31], v[108:111], v[140:143], v[28:31]
v_mfma_f32_16x16x32_bf16 v[32:35], v[108:111], v[144:147], v[32:35]
v_mfma_f32_16x16x32_bf16 v[36:39], v[108:111], v[148:151], v[36:39]
v_mfma_f32_16x16x32_bf16 v[40:43], v[112:115], v[136:139], v[40:43]
v_mfma_f32_16x16x32_bf16 v[44:47], v[112:115], v[140:143], v[44:47]
v_mfma_f32_16x16x32_bf16 v[48:51], v[112:115], v[144:147], v[48:51]
v_mfma_f32_16x16x32_bf16 v[52:55], v[112:115], v[148:151], v[52:55]
v_mfma_f32_16x16x32_bf16 v[56:59], v[116:119], v[136:139], v[56:59]
v_mfma_f32_16x16x32_bf16 v[60:63], v[116:119], v[140:143], v[60:63]
v_mfma_f32_16x16x32_bf16 v[64:67], v[116:119], v[144:147], v[64:67]
v_mfma_f32_16x16x32_bf16 v[68:71], v[116:119], v[148:151], v[68:71]
buffer_load_dwordx4 v[104:107], v1, s[4:7], s30 offen offset:2048
buffer_load_dwordx4 v[108:111], v1, s[4:7], s31 offen offset:2048
buffer_load_dwordx4 v[112:115], v1, s[4:7], s32 offen offset:2048
buffer_load_dwordx4 v[116:119], v1, s[4:7], s33 offen offset:2048
s_waitcnt vmcnt(12)
s_barrier
ds_read_b128 v[136:139], v6 offset:4096
ds_read_b128 v[140:143], v6 offset:24576
ds_read_b128 v[144:147], v7 offset:4096
ds_read_b128 v[148:151], v7 offset:24576
s_waitcnt lgkmcnt(4)
v_mfma_f32_16x16x32_bf16 v[8:11], v[120:123], v[152:155], v[8:11]
v_mfma_f32_16x16x32_bf16 v[12:15], v[120:123], v[156:159], v[12:15]
v_mfma_f32_16x16x32_bf16 v[16:19], v[120:123], v[160:163], v[16:19]
v_mfma_f32_16x16x32_bf16 v[20:23], v[120:123], v[164:167], v[20:23]
v_mfma_f32_16x16x32_bf16 v[24:27], v[124:127], v[152:155], v[24:27]
v_mfma_f32_16x16x32_bf16 v[28:31], v[124:127], v[156:159], v[28:31]
v_mfma_f32_16x16x32_bf16 v[32:35], v[124:127], v[160:163], v[32:35]
v_mfma_f32_16x16x32_bf16 v[36:39], v[124:127], v[164:167], v[36:39]
v_mfma_f32_16x16x32_bf16 v[40:43], v[128:131], v[152:155], v[40:43]
v_mfma_f32_16x16x32_bf16 v[44:47], v[128:131], v[156:159], v[44:47]
v_mfma_f32_16x16x32_bf16 v[48:51], v[128:131], v[160:163], v[48:51]
v_mfma_f32_16x16x32_bf16 v[52:55], v[128:131], v[164:167], v[52:55]
v_mfma_f32_16x16x32_bf16 v[56:59], v[132:135], v[152:155], v[56:59]
v_mfma_f32_16x16x32_bf16 v[60:63], v[132:135], v[156:159], v[60:63]
v_mfma_f32_16x16x32_bf16 v[64:67], v[132:135], v[160:163], v[64:67]
v_mfma_f32_16x16x32_bf16 v[68:71], v[132:135], v[164:167], v[68:71]
s_mov_b32 s40, 0
v_add_u32 v6, 4096, v6
v_add_u32 v7, 4096, v7
qkvb_loop6:
buffer_load_dwordx4 v[120:123], v1, s[4:7], s30 offen offset:3072
buffer_load_dwordx4 v[124:127], v1, s[4:7], s31 offen offset:3072
buffer_load_dwordx4 v[128:131], v1, s[4:7], s32 offen offset:3072
buffer_load_dwordx4 v[132:135], v1, s[4:7], s33 offen offset:3072
s_waitcnt vmcnt(12)
ds_read_b128 v[152:155], v6 offset:1024
ds_read_b128 v[156:159], v6 offset:21504
ds_read_b128 v[160:163], v7 offset:1024
ds_read_b128 v[164:167], v7 offset:21504
s_waitcnt lgkmcnt(4)
v_mfma_f32_16x16x32_bf16 v[8:11], v[72:75], v[136:139], v[8:11]
v_mfma_f32_16x16x32_bf16 v[12:15], v[72:75], v[140:143], v[12:15]
v_mfma_f32_16x16x32_bf16 v[16:19], v[72:75], v[144:147], v[16:19]
v_mfma_f32_16x16x32_bf16 v[20:23], v[72:75], v[148:151], v[20:23]
v_mfma_f32_16x16x32_bf16 v[24:27], v[76:79], v[136:139], v[24:27]
v_mfma_f32_16x16x32_bf16 v[28:31], v[76:79], v[140:143], v[28:31]
v_mfma_f32_16x16x32_bf16 v[32:35], v[76:79], v[144:147], v[32:35]
v_mfma_f32_16x16x32_bf16 v[36:39], v[76:79], v[148:151], v[36:39]
v_mfma_f32_16x16x32_bf16 v[40:43], v[80:83], v[136:139], v[40:43]
v_mfma_f32_16x16x32_bf16 v[44:47], v[80:83], v[140:143], v[44:47]
v_mfma_f32_16x16x32_bf16 v[48:51], v[80:83], v[144:147], v[48:51]
v_mfma_f32_16x16x32_bf16 v[52:55], v[80:83], v[148:151], v[52:55]
v_mfma_f32_16x16x32_bf16 v[56:59], v[84:87], v[136:139], v[56:59]
v_mfma_f32_16x16x32_bf16 v[60:63], v[84:87], v[140:143], v[60:63]
v_mfma_f32_16x16x32_bf16 v[64:67], v[84:87], v[144:147], v[64:67]
v_mfma_f32_16x16x32_bf16 v[68:71], v[84:87], v[148:151], v[68:71]
s_add_u32 s30, s30, 4096
s_add_u32 s31, s31, 4096
s_add_u32 s32, s32, 4096
s_add_u32 s33, s33, 4096
buffer_load_dwordx4 v[72:75], v1, s[4:7], s30 offen offset:0
buffer_load_dwordx4 v[76:79], v1, s[4:7], s31 offen offset:0
buffer_load_dwordx4 v[80:83], v1, s[4:7], s32 offen offset:0
buffer_load_dwordx4 v[84:87], v1, s[4:7], s33 offen offset:0
s_waitcnt vmcnt(12)
ds_read_b128 v[136:139], v6 offset:2048
ds_read_b128 v[140:143], v6 offset:22528
ds_read_b128 v[144:147], v7 offset:2048
ds_read_b128 v[148:151], v7 offset:22528
s_waitcnt lgkmcnt(4)
v_mfma_f32_16x16x32_bf16 v[8:11], v[88:91], v[152:155], v[8:11]
v_mfma_f32_16x16x32_bf16 v[12:15], v[88:91], v[156:159], v[12:15]
v_mfma_f32_16x16x32_bf16 v[16:19], v[88:91], v[160:163], v[16:19]
v_mfma_f32_16x16x32_bf16 v[20:23], v[88:91], v[164:167], v[20:23]
v_mfma_f32_16x16x32_bf16 v[24:27], v[92:95], v[152:155], v[24:27]
v_mfma_f32_16x16x32_bf16 v[28:31], v[92:95], v[156:159], v[28:31]
v_mfma_f32_16x16x32_bf16 v[32:35], v[92:95], v[160:163], v[32:35]
v_mfma_f32_16x16x32_bf16 v[36:39], v[92:95], v[164:167], v[36:39]
v_mfma_f32_16x16x32_bf16 v[40:43], v[96:99], v[152:155], v[40:43]
v_mfma_f32_16x16x32_bf16 v[44:47], v[96:99], v[156:159], v[44:47]
v_mfma_f32_16x16x32_bf16 v[48:51], v[96:99], v[160:163], v[48:51]
v_mfma_f32_16x16x32_bf16 v[52:55], v[96:99], v[164:167], v[52:55]
v_mfma_f32_16x16x32_bf16 v[56:59], v[100:103], v[152:155], v[56:59]
v_mfma_f32_16x16x32_bf16 v[60:63], v[100:103], v[156:159], v[60:63]
v_mfma_f32_16x16x32_bf16 v[64:67], v[100:103], v[160:163], v[64:67]
v_mfma_f32_16x16x32_bf16 v[68:71], v[100:103], v[164:167], v[68:71]
buffer_load_dwordx4 v[88:91], v1, s[4:7], s30 offen offset:1024
buffer_load_dwordx4 v[92:95], v1, s[4:7], s31 offen offset:1024
buffer_load_dwordx4 v[96:99], v1, s[4:7], s32 offen offset:1024
buffer_load_dwordx4 v[100:103], v1, s[4:7], s33 offen offset:1024
s_waitcnt vmcnt(12)
ds_read_b128 v[152:155], v6 offset:3072
ds_read_b128 v[156:159], v6 offset:23552
ds_read_b128 v[160:163], v7 offset:3072
ds_read_b128 v[164:167], v7 offset:23552
s_waitcnt lgkmcnt(4)
v_mfma_f32_16x16x32_bf16 v[8:11], v[104:107], v[136:139], v[8:11]
v_mfma_f32_16x16x32_bf16 v[12:15], v[104:107], v[140:143], v[12:15]
v_mfma_f32_16x16x32_bf16 v[16:19], v[104:107], v[144:147], v[16:19]
v_mfma_f32_16x16x32_bf16 v[20:23], v[104:107], v[148:151], v[20:23]
v_mfma_f32_16x16x32_bf16 v[24:27], v[108:111], v[136:139], v[24:27]
v_mfma_f32_16x16x32_bf16 v[28:31], v[108:111], v[140:143], v[28:31]
v_mfma_f32_16x16x32_bf16 v[32:35], v[108:111], v[144:147], v[32:35]
v_mfma_f32_16x16x32_bf16 v[36:39], v[108:111], v[148:151], v[36:39]
v_mfma_f32_16x16x32_bf16 v[40:43], v[112:115], v[136:139], v[40:43]
v_mfma_f32_16x16x32_bf16 v[44:47], v[112:115], v[140:143], v[44:47]
v_mfma_f32_16x16x32_bf16 v[48:51], v[112:115], v[144:147], v[48:51]
v_mfma_f32_16x16x32_bf16 v[52:55], v[112:115], v[148:151], v[52:55]
v_mfma_f32_16x16x32_bf16 v[56:59], v[116:119], v[136:139], v[56:59]
v_mfma_f32_16x16x32_bf16 v[60:63], v[116:119], v[140:143], v[60:63]
v_mfma_f32_16x16x32_bf16 v[64:67], v[116:119], v[144:147], v[64:67]
v_mfma_f32_16x16x32_bf16 v[68:71], v[116:119], v[148:151], v[68:71]
buffer_load_dwordx4 v[104:107], v1, s[4:7], s30 offen offset:2048
buffer_load_dwordx4 v[108:111], v1, s[4:7], s31 offen offset:2048
buffer_load_dwordx4 v[112:115], v1, s[4:7], s32 offen offset:2048
buffer_load_dwordx4 v[116:119], v1, s[4:7], s33 offen offset:2048
s_waitcnt vmcnt(12)
ds_read_b128 v[136:139], v6 offset:4096
ds_read_b128 v[140:143], v6 offset:24576
ds_read_b128 v[144:147], v7 offset:4096
ds_read_b128 v[148:151], v7 offset:24576
s_waitcnt lgkmcnt(4)
v_mfma_f32_16x16x32_bf16 v[8:11], v[120:123], v[152:155], v[8:11]
v_mfma_f32_16x16x32_bf16 v[12:15], v[120:123], v[156:159], v[12:15]
v_mfma_f32_16x16x32_bf16 v[16:19], v[120:123], v[160:163], v[16:19]
v_mfma_f32_16x16x32_bf16 v[20:23], v[120:123], v[164:167], v[20:23]
v_mfma_f32_16x16x32_bf16 v[24:27], v[124:127], v[152:155], v[24:27]
v_mfma_f32_16x16x32_bf16 v[28:31], v[124:127], v[156:159], v[28:31]
v_mfma_f32_16x16x32_bf16 v[32:35], v[124:127], v[160:163], v[32:35]
v_mfma_f32_16x16x32_bf16 v[36:39], v[124:127], v[164:167], v[36:39]
v_mfma_f32_16x16x32_bf16 v[40:43], v[128:131], v[152:155], v[40:43]
v_mfma_f32_16x16x32_bf16 v[44:47], v[128:131], v[156:159], v[44:47]
v_mfma_f32_16x16x32_bf16 v[48:51], v[128:131], v[160:163], v[48:51]
v_mfma_f32_16x16x32_bf16 v[52:55], v[128:131], v[164:167], v[52:55]
v_mfma_f32_16x16x32_bf16 v[56:59], v[132:135], v[152:155], v[56:59]
v_mfma_f32_16x16x32_bf16 v[60:63], v[132:135], v[156:159], v[60:63]
v_mfma_f32_16x16x32_bf16 v[64:67], v[132:135], v[160:163], v[64:67]
v_mfma_f32_16x16x32_bf16 v[68:71], v[132:135], v[164:167], v[68:71]
v_add_u32 v6, 4096, v6
v_add_u32 v7, 4096, v7
s_add_u32 s40, s40, 1
s_cmp_lt_u32 s40, 4
s_cbranch_scc1 qkvb_loop6
s_waitcnt vmcnt(0) lgkmcnt(0)
v_and_b32 v2, 63, v0
v_and_b32 v3, 15, v2
v_lshrrev_b32 v4, 4, v2
s_lshl_b32 s41, s17, 19
s_lshl_b32 s42, s18, 12
s_add_u32 s41, s41, s42
s_mov_b32 s46, 0x3ea52b5c
s_mov_b32 s47, 0x3ea52b5c
v_lshlrev_b32 v5, 2, v4
v_add_u32 v5, 0, v5
v_mul_u32_u24 v168, 205, v5
v_lshrrev_b32 v168, 12, v168
v_mul_u32_u24 v6, 20, v168
v_sub_u32 v5, v5, v6
v_lshlrev_b32 v168, 17, v168
v_lshrrev_b32 v6, 4, v5
v_lshl_add_u32 v168, v6, 10, v168
v_bfe_u32 v6, v5, 2, 1
v_lshl_add_u32 v168, v6, 9, v168
v_bfe_u32 v6, v5, 3, 1
v_lshl_add_u32 v168, v6, 3, v168
v_lshl_add_u32 v168, v3, 4, v168
v_lshlrev_b32 v5, 2, v4
v_add_u32 v5, 16, v5
v_mul_u32_u24 v169, 205, v5
v_lshrrev_b32 v169, 12, v169
v_mul_u32_u24 v6, 20, v169
v_sub_u32 v5, v5, v6
v_lshlrev_b32 v169, 17, v169
v_lshrrev_b32 v6, 4, v5
v_lshl_add_u32 v169, v6, 10, v169
v_bfe_u32 v6, v5, 2, 1
v_lshl_add_u32 v169, v6, 9, v169
v_bfe_u32 v6, v5, 3, 1
v_lshl_add_u32 v169, v6, 3, v169
v_lshl_add_u32 v169, v3, 4, v169
v_lshlrev_b32 v5, 2, v4
v_add_u32 v5, 32, v5
v_mul_u32_u24 v170, 205, v5
v_lshrrev_b32 v170, 12, v170
v_mul_u32_u24 v6, 20, v170
v_sub_u32 v5, v5, v6
v_lshlrev_b32 v170, 17, v170
v_lshrrev_b32 v6, 4, v5
v_lshl_add_u32 v170, v6, 10, v170
v_bfe_u32 v6, v5, 2, 1
v_lshl_add_u32 v170, v6, 9, v170
v_bfe_u32 v6, v5, 3, 1
v_lshl_add_u32 v170, v6, 3, v170
v_lshl_add_u32 v170, v3, 4, v170
v_lshlrev_b32 v5, 2, v4
v_add_u32 v5, 48, v5
v_mul_u32_u24 v171, 205, v5
v_lshrrev_b32 v171, 12, v171
v_mul_u32_u24 v6, 20, v171
v_sub_u32 v5, v5, v6
v_lshlrev_b32 v171, 17, v171
v_lshrrev_b32 v6, 4, v5
v_lshl_add_u32 v171, v6, 10, v171
v_bfe_u32 v6, v5, 2, 1
v_lshl_add_u32 v171, v6, 9, v171
v_bfe_u32 v6, v5, 3, 1
v_lshl_add_u32 v171, v6, 3, v171
v_lshl_add_u32 v171, v3, 4, v171
v_pk_mul_f32 v[8:9], v[8:9], s[46:47]
v_pk_mul_f32 v[10:11], v[10:11], s[46:47]
v_cvt_pk_bf16_f32 v136, v8, v9
v_cvt_pk_bf16_f32 v137, v10, v11
s_add_u32 s43, s41, 37748736
buffer_store_dwordx2 v[136:137], v168, s[4:7], s43 offen sc1
v_pk_mul_f32 v[12:13], v[12:13], s[46:47]
v_pk_mul_f32 v[14:15], v[14:15], s[46:47]
v_cvt_pk_bf16_f32 v138, v12, v13
v_cvt_pk_bf16_f32 v139, v14, v15
s_add_u32 s43, s41, 37748992
buffer_store_dwordx2 v[138:139], v168, s[4:7], s43 offen sc1
v_pk_mul_f32 v[16:17], v[16:17], s[46:47]
v_pk_mul_f32 v[18:19], v[18:19], s[46:47]
v_cvt_pk_bf16_f32 v140, v16, v17
v_cvt_pk_bf16_f32 v141, v18, v19
s_add_u32 s43, s41, 37750784
buffer_store_dwordx2 v[140:141], v168, s[4:7], s43 offen sc1
v_pk_mul_f32 v[20:21], v[20:21], s[46:47]
v_pk_mul_f32 v[22:23], v[22:23], s[46:47]
v_cvt_pk_bf16_f32 v142, v20, v21
v_cvt_pk_bf16_f32 v143, v22, v23
s_add_u32 s43, s41, 37751040
buffer_store_dwordx2 v[142:143], v168, s[4:7], s43 offen sc1
v_pk_mul_f32 v[24:25], v[24:25], s[46:47]
v_pk_mul_f32 v[26:27], v[26:27], s[46:47]
v_cvt_pk_bf16_f32 v144, v24, v25
v_cvt_pk_bf16_f32 v145, v26, v27
s_add_u32 s43, s41, 37748736
buffer_store_dwordx2 v[144:145], v169, s[4:7], s43 offen sc1
v_pk_mul_f32 v[28:29], v[28:29], s[46:47]
v_pk_mul_f32 v[30:31], v[30:31], s[46:47]
v_cvt_pk_bf16_f32 v146, v28, v29
v_cvt_pk_bf16_f32 v147, v30, v31
s_add_u32 s43, s41, 37748992
buffer_store_dwordx2 v[146:147], v169, s[4:7], s43 offen sc1
v_pk_mul_f32 v[32:33], v[32:33], s[46:47]
v_pk_mul_f32 v[34:35], v[34:35], s[46:47]
v_cvt_pk_bf16_f32 v148, v32, v33
v_cvt_pk_bf16_f32 v149, v34, v35
s_add_u32 s43, s41, 37750784
buffer_store_dwordx2 v[148:149], v169, s[4:7], s43 offen sc1
v_pk_mul_f32 v[36:37], v[36:37], s[46:47]
v_pk_mul_f32 v[38:39], v[38:39], s[46:47]
v_cvt_pk_bf16_f32 v150, v36, v37
v_cvt_pk_bf16_f32 v151, v38, v39
s_add_u32 s43, s41, 37751040
buffer_store_dwordx2 v[150:151], v169, s[4:7], s43 offen sc1
v_pk_mul_f32 v[40:41], v[40:41], s[46:47]
v_pk_mul_f32 v[42:43], v[42:43], s[46:47]
v_cvt_pk_bf16_f32 v136, v40, v41
v_cvt_pk_bf16_f32 v137, v42, v43
s_add_u32 s43, s41, 37748736
buffer_store_dwordx2 v[136:137], v170, s[4:7], s43 offen sc1
v_pk_mul_f32 v[44:45], v[44:45], s[46:47]
v_pk_mul_f32 v[46:47], v[46:47], s[46:47]
v_cvt_pk_bf16_f32 v138, v44, v45
v_cvt_pk_bf16_f32 v139, v46, v47
s_add_u32 s43, s41, 37748992
buffer_store_dwordx2 v[138:139], v170, s[4:7], s43 offen sc1
v_pk_mul_f32 v[48:49], v[48:49], s[46:47]
v_pk_mul_f32 v[50:51], v[50:51], s[46:47]
v_cvt_pk_bf16_f32 v140, v48, v49
v_cvt_pk_bf16_f32 v141, v50, v51
s_add_u32 s43, s41, 37750784
buffer_store_dwordx2 v[140:141], v170, s[4:7], s43 offen sc1
v_pk_mul_f32 v[52:53], v[52:53], s[46:47]
v_pk_mul_f32 v[54:55], v[54:55], s[46:47]
v_cvt_pk_bf16_f32 v142, v52, v53
v_cvt_pk_bf16_f32 v143, v54, v55
s_add_u32 s43, s41, 37751040
buffer_store_dwordx2 v[142:143], v170, s[4:7], s43 offen sc1
v_pk_mul_f32 v[56:57], v[56:57], s[46:47]
v_pk_mul_f32 v[58:59], v[58:59], s[46:47]
v_cvt_pk_bf16_f32 v144, v56, v57
v_cvt_pk_bf16_f32 v145, v58, v59
s_add_u32 s43, s41, 37748736
buffer_store_dwordx2 v[144:145], v171, s[4:7], s43 offen sc1
v_pk_mul_f32 v[60:61], v[60:61], s[46:47]
v_pk_mul_f32 v[62:63], v[62:63], s[46:47]
v_cvt_pk_bf16_f32 v146, v60, v61
v_cvt_pk_bf16_f32 v147, v62, v63
s_add_u32 s43, s41, 37748992
buffer_store_dwordx2 v[146:147], v171, s[4:7], s43 offen sc1
v_pk_mul_f32 v[64:65], v[64:65], s[46:47]
v_pk_mul_f32 v[66:67], v[66:67], s[46:47]
v_cvt_pk_bf16_f32 v148, v64, v65
v_cvt_pk_bf16_f32 v149, v66, v67
s_add_u32 s43, s41, 37750784
buffer_store_dwordx2 v[148:149], v171, s[4:7], s43 offen sc1
v_pk_mul_f32 v[68:69], v[68:69], s[46:47]
v_pk_mul_f32 v[70:71], v[70:71], s[46:47]
v_cvt_pk_bf16_f32 v150, v68, v69
v_cvt_pk_bf16_f32 v151, v70, v71
s_add_u32 s43, s41, 37751040
buffer_store_dwordx2 v[150:151], v171, s[4:7], s43 offen sc1
s_branch qkvb_exit1
qkvb_w1_3:
s_mul_i32 s30, s17, 5
s_add_u32 s30, s30, 4
s_mul_i32 s30, s30, 20480
s_add_u32 s30, s30, 87556096
s_mul_i32 s31, s17, 5
s_add_u32 s31, s31, 40
s_mul_i32 s31, s31, 20480
s_add_u32 s31, s31, 87556096
s_mul_i32 s32, s17, 5
s_add_u32 s32, s32, 41
s_mul_i32 s32, s32, 20480
s_add_u32 s32, s32, 87556096
s_mul_i32 s33, s17, 5
s_add_u32 s33, s33, 42
s_mul_i32 s33, s33, 20480
s_add_u32 s33, s33, 87556096
buffer_load_dwordx4 v[72:75], v1, s[4:7], s30 offen offset:0
buffer_load_dwordx4 v[76:79], v1, s[4:7], s31 offen offset:0
buffer_load_dwordx4 v[80:83], v1, s[4:7], s32 offen offset:0
buffer_load_dwordx4 v[84:87], v1, s[4:7], s33 offen offset:0
buffer_load_dwordx4 v[88:91], v1, s[4:7], s30 offen offset:1024
buffer_load_dwordx4 v[92:95], v1, s[4:7], s31 offen offset:1024
buffer_load_dwordx4 v[96:99], v1, s[4:7], s32 offen offset:1024
buffer_load_dwordx4 v[100:103], v1, s[4:7], s33 offen offset:1024
buffer_load_dwordx4 v[104:107], v1, s[4:7], s30 offen offset:2048
buffer_load_dwordx4 v[108:111], v1, s[4:7], s31 offen offset:2048
buffer_load_dwordx4 v[112:115], v1, s[4:7], s32 offen offset:2048
buffer_load_dwordx4 v[116:119], v1, s[4:7], s33 offen offset:2048
s_add_u32 m0, s22, 4096
s_add_u32 s23, s21, 4096
buffer_load_dwordx4 v1, s[4:7], s23 offen offset:0 lds
buffer_load_dwordx4 v1, s[4:7], s23 offen offset:1024 lds
buffer_load_dwordx4 v1, s[4:7], s23 offen offset:2048 lds
buffer_load_dwordx4 v1, s[4:7], s23 offen offset:3072 lds
s_add_u32 m0, s22, 8192
s_add_u32 s23, s21, 8192
buffer_load_dwordx4 v1, s[4:7], s23 offen offset:0 lds
buffer_load_dwordx4 v1, s[4:7], s23 offen offset:1024 lds
buffer_load_dwordx4 v1, s[4:7], s23 offen offset:2048 lds
buffer_load_dwordx4 v1, s[4:7], s23 offen offset:3072 lds
s_add_u32 m0, s22, 12288
s_add_u32 s23, s21, 12288
buffer_load_dwordx4 v1, s[4:7], s23 offen offset:0 lds
buffer_load_dwordx4 v1, s[4:7], s23 offen offset:1024 lds
buffer_load_dwordx4 v1, s[4:7], s23 offen offset:2048 lds
buffer_load_dwordx4 v1, s[4:7], s23 offen offset:3072 lds
s_add_u32 m0, s22, 16384
s_add_u32 s23, s21, 16384
buffer_load_dwordx4 v1, s[4:7], s23 offen offset:0 lds
buffer_load_dwordx4 v1, s[4:7], s23 offen offset:1024 lds
buffer_load_dwordx4 v1, s[4:7], s23 offen offset:2048 lds
buffer_load_dwordx4 v1, s[4:7], s23 offen offset:3072 lds
s_waitcnt vmcnt(28)
s_barrier
ds_read_b128 v[136:139], v6 offset:0
ds_read_b128 v[140:143], v6 offset:20480
ds_read_b128 v[144:147], v7 offset:0
ds_read_b128 v[148:151], v7 offset:20480
buffer_load_dwordx4 v[120:123], v1, s[4:7], s30 offen offset:3072
buffer_load_dwordx4 v[124:127], v1, s[4:7], s31 offen offset:3072
buffer_load_dwordx4 v[128:131], v1, s[4:7], s32 offen offset:3072
buffer_load_dwordx4 v[132:135], v1, s[4:7], s33 offen offset:3072
s_waitcnt vmcnt(28)
ds_read_b128 v[152:155], v6 offset:1024
ds_read_b128 v[156:159], v6 offset:21504
ds_read_b128 v[160:163], v7 offset:1024
ds_read_b128 v[164:167], v7 offset:21504
s_waitcnt lgkmcnt(4)
v_mfma_f32_16x16x32_bf16 v[8:11], v[72:75], v[136:139], 0
v_mfma_f32_16x16x32_bf16 v[12:15], v[72:75], v[140:143], 0
v_mfma_f32_16x16x32_bf16 v[16:19], v[72:75], v[144:147], 0
v_mfma_f32_16x16x32_bf16 v[20:23], v[72:75], v[148:151], 0
v_mfma_f32_16x16x32_bf16 v[24:27], v[76:79], v[136:139], 0
v_mfma_f32_16x16x32_bf16 v[28:31], v[76:79], v[140:143], 0
v_mfma_f32_16x16x32_bf16 v[32:35], v[76:79], v[144:147], 0
v_mfma_f32_16x16x32_bf16 v[36:39], v[76:79], v[148:151], 0
v_mfma_f32_16x16x32_bf16 v[40:43], v[80:83], v[136:139], 0
v_mfma_f32_16x16x32_bf16 v[44:47], v[80:83], v[140:143], 0
v_mfma_f32_16x16x32_bf16 v[48:51], v[80:83], v[144:147], 0
v_mfma_f32_16x16x32_bf16 v[52:55], v[80:83], v[148:151], 0
v_mfma_f32_16x16x32_bf16 v[56:59], v[84:87], v[136:139], 0
v_mfma_f32_16x16x32_bf16 v[60:63], v[84:87], v[140:143], 0
v_mfma_f32_16x16x32_bf16 v[64:67], v[84:87], v[144:147], 0
v_mfma_f32_16x16x32_bf16 v[68:71], v[84:87], v[148:151], 0
s_add_u32 s30, s30, 4096
s_add_u32 s31, s31, 4096
s_add_u32 s32, s32, 4096
s_add_u32 s33, s33, 4096
buffer_load_dwordx4 v[72:75], v1, s[4:7], s30 offen offset:0
buffer_load_dwordx4 v[76:79], v1, s[4:7], s31 offen offset:0
buffer_load_dwordx4 v[80:83], v1, s[4:7], s32 offen offset:0
buffer_load_dwordx4 v[84:87], v1, s[4:7], s33 offen offset:0
s_waitcnt vmcnt(28)
ds_read_b128 v[136:139], v6 offset:2048
ds_read_b128 v[140:143], v6 offset:22528
ds_read_b128 v[144:147], v7 offset:2048
ds_read_b128 v[148:151], v7 offset:22528
s_waitcnt lgkmcnt(4)
v_mfma_f32_16x16x32_bf16 v[8:11], v[88:91], v[152:155], v[8:11]
v_mfma_f32_16x16x32_bf16 v[12:15], v[88:91], v[156:159], v[12:15]
v_mfma_f32_16x16x32_bf16 v[16:19], v[88:91], v[160:163], v[16:19]
v_mfma_f32_16x16x32_bf16 v[20:23], v[88:91], v[164:167], v[20:23]
v_mfma_f32_16x16x32_bf16 v[24:27], v[92:95], v[152:155], v[24:27]
v_mfma_f32_16x16x32_bf16 v[28:31], v[92:95], v[156:159], v[28:31]
v_mfma_f32_16x16x32_bf16 v[32:35], v[92:95], v[160:163], v[32:35]
v_mfma_f32_16x16x32_bf16 v[36:39], v[92:95], v[164:167], v[36:39]
v_mfma_f32_16x16x32_bf16 v[40:43], v[96:99], v[152:155], v[40:43]
v_mfma_f32_16x16x32_bf16 v[44:47], v[96:99], v[156:159], v[44:47]
v_mfma_f32_16x16x32_bf16 v[48:51], v[96:99], v[160:163], v[48:51]
v_mfma_f32_16x16x32_bf16 v[52:55], v[96:99], v[164:167], v[52:55]
v_mfma_f32_16x16x32_bf16 v[56:59], v[100:103], v[152:155], v[56:59]
v_mfma_f32_16x16x32_bf16 v[60:63], v[100:103], v[156:159], v[60:63]
v_mfma_f32_16x16x32_bf16 v[64:67], v[100:103], v[160:163], v[64:67]
v_mfma_f32_16x16x32_bf16 v[68:71], v[100:103], v[164:167], v[68:71]
buffer_load_dwordx4 v[88:91], v1, s[4:7], s30 offen offset:1024
buffer_load_dwordx4 v[92:95], v1, s[4:7], s31 offen offset:1024
buffer_load_dwordx4 v[96:99], v1, s[4:7], s32 offen offset:1024
buffer_load_dwordx4 v[100:103], v1, s[4:7], s33 offen offset:1024
s_waitcnt vmcnt(28)
ds_read_b128 v[152:155], v6 offset:3072
ds_read_b128 v[156:159], v6 offset:23552
ds_read_b128 v[160:163], v7 offset:3072
ds_read_b128 v[164:167], v7 offset:23552
s_waitcnt lgkmcnt(4)
v_mfma_f32_16x16x32_bf16 v[8:11], v[104:107], v[136:139], v[8:11]
v_mfma_f32_16x16x32_bf16 v[12:15], v[104:107], v[140:143], v[12:15]
v_mfma_f32_16x16x32_bf16 v[16:19], v[104:107], v[144:147], v[16:19]
v_mfma_f32_16x16x32_bf16 v[20:23], v[104:107], v[148:151], v[20:23]
v_mfma_f32_16x16x32_bf16 v[24:27], v[108:111], v[136:139], v[24:27]
v_mfma_f32_16x16x32_bf16 v[28:31], v[108:111], v[140:143], v[28:31]
v_mfma_f32_16x16x32_bf16 v[32:35], v[108:111], v[144:147], v[32:35]
v_mfma_f32_16x16x32_bf16 v[36:39], v[108:111], v[148:151], v[36:39]
v_mfma_f32_16x16x32_bf16 v[40:43], v[112:115], v[136:139], v[40:43]
v_mfma_f32_16x16x32_bf16 v[44:47], v[112:115], v[140:143], v[44:47]
v_mfma_f32_16x16x32_bf16 v[48:51], v[112:115], v[144:147], v[48:51]
v_mfma_f32_16x16x32_bf16 v[52:55], v[112:115], v[148:151], v[52:55]
v_mfma_f32_16x16x32_bf16 v[56:59], v[116:119], v[136:139], v[56:59]
v_mfma_f32_16x16x32_bf16 v[60:63], v[116:119], v[140:143], v[60:63]
v_mfma_f32_16x16x32_bf16 v[64:67], v[116:119], v[144:147], v[64:67]
v_mfma_f32_16x16x32_bf16 v[68:71], v[116:119], v[148:151], v[68:71]
buffer_load_dwordx4 v[104:107], v1, s[4:7], s30 offen offset:2048
buffer_load_dwordx4 v[108:111], v1, s[4:7], s31 offen offset:2048
buffer_load_dwordx4 v[112:115], v1, s[4:7], s32 offen offset:2048
buffer_load_dwordx4 v[116:119], v1, s[4:7], s33 offen offset:2048
s_waitcnt vmcnt(12)
s_barrier
ds_read_b128 v[136:139], v6 offset:4096
ds_read_b128 v[140:143], v6 offset:24576
ds_read_b128 v[144:147], v7 offset:4096
ds_read_b128 v[148:151], v7 offset:24576
s_waitcnt lgkmcnt(4)
v_mfma_f32_16x16x32_bf16 v[8:11], v[120:123], v[152:155], v[8:11]
v_mfma_f32_16x16x32_bf16 v[12:15], v[120:123], v[156:159], v[12:15]
v_mfma_f32_16x16x32_bf16 v[16:19], v[120:123], v[160:163], v[16:19]
v_mfma_f32_16x16x32_bf16 v[20:23], v[120:123], v[164:167], v[20:23]
v_mfma_f32_16x16x32_bf16 v[24:27], v[124:127], v[152:155], v[24:27]
v_mfma_f32_16x16x32_bf16 v[28:31], v[124:127], v[156:159], v[28:31]
v_mfma_f32_16x16x32_bf16 v[32:35], v[124:127], v[160:163], v[32:35]
v_mfma_f32_16x16x32_bf16 v[36:39], v[124:127], v[164:167], v[36:39]
v_mfma_f32_16x16x32_bf16 v[40:43], v[128:131], v[152:155], v[40:43]
v_mfma_f32_16x16x32_bf16 v[44:47], v[128:131], v[156:159], v[44:47]
v_mfma_f32_16x16x32_bf16 v[48:51], v[128:131], v[160:163], v[48:51]
v_mfma_f32_16x16x32_bf16 v[52:55], v[128:131], v[164:167], v[52:55]
v_mfma_f32_16x16x32_bf16 v[56:59], v[132:135], v[152:155], v[56:59]
v_mfma_f32_16x16x32_bf16 v[60:63], v[132:135], v[156:159], v[60:63]
v_mfma_f32_16x16x32_bf16 v[64:67], v[132:135], v[160:163], v[64:67]
v_mfma_f32_16x16x32_bf16 v[68:71], v[132:135], v[164:167], v[68:71]
s_mov_b32 s40, 0
v_add_u32 v6, 4096, v6
v_add_u32 v7, 4096, v7
qkvb_loop7:
buffer_load_dwordx4 v[120:123], v1, s[4:7], s30 offen offset:3072
buffer_load_dwordx4 v[124:127], v1, s[4:7], s31 offen offset:3072
buffer_load_dwordx4 v[128:131], v1, s[4:7], s32 offen offset:3072
buffer_load_dwordx4 v[132:135], v1, s[4:7], s33 offen offset:3072
s_waitcnt vmcnt(12)
ds_read_b128 v[152:155], v6 offset:1024
ds_read_b128 v[156:159], v6 offset:21504
ds_read_b128 v[160:163], v7 offset:1024
ds_read_b128 v[164:167], v7 offset:21504
s_waitcnt lgkmcnt(4)
v_mfma_f32_16x16x32_bf16 v[8:11], v[72:75], v[136:139], v[8:11]
v_mfma_f32_16x16x32_bf16 v[12:15], v[72:75], v[140:143], v[12:15]
v_mfma_f32_16x16x32_bf16 v[16:19], v[72:75], v[144:147], v[16:19]
v_mfma_f32_16x16x32_bf16 v[20:23], v[72:75], v[148:151], v[20:23]
v_mfma_f32_16x16x32_bf16 v[24:27], v[76:79], v[136:139], v[24:27]
v_mfma_f32_16x16x32_bf16 v[28:31], v[76:79], v[140:143], v[28:31]
v_mfma_f32_16x16x32_bf16 v[32:35], v[76:79], v[144:147], v[32:35]
v_mfma_f32_16x16x32_bf16 v[36:39], v[76:79], v[148:151], v[36:39]
v_mfma_f32_16x16x32_bf16 v[40:43], v[80:83], v[136:139], v[40:43]
v_mfma_f32_16x16x32_bf16 v[44:47], v[80:83], v[140:143], v[44:47]
v_mfma_f32_16x16x32_bf16 v[48:51], v[80:83], v[144:147], v[48:51]
v_mfma_f32_16x16x32_bf16 v[52:55], v[80:83], v[148:151], v[52:55]
v_mfma_f32_16x16x32_bf16 v[56:59], v[84:87], v[136:139], v[56:59]
v_mfma_f32_16x16x32_bf16 v[60:63], v[84:87], v[140:143], v[60:63]
v_mfma_f32_16x16x32_bf16 v[64:67], v[84:87], v[144:147], v[64:67]
v_mfma_f32_16x16x32_bf16 v[68:71], v[84:87], v[148:151], v[68:71]
s_add_u32 s30, s30, 4096
s_add_u32 s31, s31, 4096
s_add_u32 s32, s32, 4096
s_add_u32 s33, s33, 4096
buffer_load_dwordx4 v[72:75], v1, s[4:7], s30 offen offset:0
buffer_load_dwordx4 v[76:79], v1, s[4:7], s31 offen offset:0
buffer_load_dwordx4 v[80:83], v1, s[4:7], s32 offen offset:0
buffer_load_dwordx4 v[84:87], v1, s[4:7], s33 offen offset:0
s_waitcnt vmcnt(12)
ds_read_b128 v[136:139], v6 offset:2048
ds_read_b128 v[140:143], v6 offset:22528
ds_read_b128 v[144:147], v7 offset:2048
ds_read_b128 v[148:151], v7 offset:22528
s_waitcnt lgkmcnt(4)
v_mfma_f32_16x16x32_bf16 v[8:11], v[88:91], v[152:155], v[8:11]
v_mfma_f32_16x16x32_bf16 v[12:15], v[88:91], v[156:159], v[12:15]
v_mfma_f32_16x16x32_bf16 v[16:19], v[88:91], v[160:163], v[16:19]
v_mfma_f32_16x16x32_bf16 v[20:23], v[88:91], v[164:167], v[20:23]
v_mfma_f32_16x16x32_bf16 v[24:27], v[92:95], v[152:155], v[24:27]
v_mfma_f32_16x16x32_bf16 v[28:31], v[92:95], v[156:159], v[28:31]
v_mfma_f32_16x16x32_bf16 v[32:35], v[92:95], v[160:163], v[32:35]
v_mfma_f32_16x16x32_bf16 v[36:39], v[92:95], v[164:167], v[36:39]
v_mfma_f32_16x16x32_bf16 v[40:43], v[96:99], v[152:155], v[40:43]
v_mfma_f32_16x16x32_bf16 v[44:47], v[96:99], v[156:159], v[44:47]
v_mfma_f32_16x16x32_bf16 v[48:51], v[96:99], v[160:163], v[48:51]
v_mfma_f32_16x16x32_bf16 v[52:55], v[96:99], v[164:167], v[52:55]
v_mfma_f32_16x16x32_bf16 v[56:59], v[100:103], v[152:155], v[56:59]
v_mfma_f32_16x16x32_bf16 v[60:63], v[100:103], v[156:159], v[60:63]
v_mfma_f32_16x16x32_bf16 v[64:67], v[100:103], v[160:163], v[64:67]
v_mfma_f32_16x16x32_bf16 v[68:71], v[100:103], v[164:167], v[68:71]
buffer_load_dwordx4 v[88:91], v1, s[4:7], s30 offen offset:1024
buffer_load_dwordx4 v[92:95], v1, s[4:7], s31 offen offset:1024
buffer_load_dwordx4 v[96:99], v1, s[4:7], s32 offen offset:1024
buffer_load_dwordx4 v[100:103], v1, s[4:7], s33 offen offset:1024
s_waitcnt vmcnt(12)
ds_read_b128 v[152:155], v6 offset:3072
ds_read_b128 v[156:159], v6 offset:23552
ds_read_b128 v[160:163], v7 offset:3072
ds_read_b128 v[164:167], v7 offset:23552
s_waitcnt lgkmcnt(4)
v_mfma_f32_16x16x32_bf16 v[8:11], v[104:107], v[136:139], v[8:11]
v_mfma_f32_16x16x32_bf16 v[12:15], v[104:107], v[140:143], v[12:15]
v_mfma_f32_16x16x32_bf16 v[16:19], v[104:107], v[144:147], v[16:19]
v_mfma_f32_16x16x32_bf16 v[20:23], v[104:107], v[148:151], v[20:23]
v_mfma_f32_16x16x32_bf16 v[24:27], v[108:111], v[136:139], v[24:27]
v_mfma_f32_16x16x32_bf16 v[28:31], v[108:111], v[140:143], v[28:31]
v_mfma_f32_16x16x32_bf16 v[32:35], v[108:111], v[144:147], v[32:35]
v_mfma_f32_16x16x32_bf16 v[36:39], v[108:111], v[148:151], v[36:39]
v_mfma_f32_16x16x32_bf16 v[40:43], v[112:115], v[136:139], v[40:43]
v_mfma_f32_16x16x32_bf16 v[44:47], v[112:115], v[140:143], v[44:47]
v_mfma_f32_16x16x32_bf16 v[48:51], v[112:115], v[144:147], v[48:51]
v_mfma_f32_16x16x32_bf16 v[52:55], v[112:115], v[148:151], v[52:55]
v_mfma_f32_16x16x32_bf16 v[56:59], v[116:119], v[136:139], v[56:59]
v_mfma_f32_16x16x32_bf16 v[60:63], v[116:119], v[140:143], v[60:63]
v_mfma_f32_16x16x32_bf16 v[64:67], v[116:119], v[144:147], v[64:67]
v_mfma_f32_16x16x32_bf16 v[68:71], v[116:119], v[148:151], v[68:71]
buffer_load_dwordx4 v[104:107], v1, s[4:7], s30 offen offset:2048
buffer_load_dwordx4 v[108:111], v1, s[4:7], s31 offen offset:2048
buffer_load_dwordx4 v[112:115], v1, s[4:7], s32 offen offset:2048
buffer_load_dwordx4 v[116:119], v1, s[4:7], s33 offen offset:2048
s_waitcnt vmcnt(12)
ds_read_b128 v[136:139], v6 offset:4096
ds_read_b128 v[140:143], v6 offset:24576
ds_read_b128 v[144:147], v7 offset:4096
ds_read_b128 v[148:151], v7 offset:24576
s_waitcnt lgkmcnt(4)
v_mfma_f32_16x16x32_bf16 v[8:11], v[120:123], v[152:155], v[8:11]
v_mfma_f32_16x16x32_bf16 v[12:15], v[120:123], v[156:159], v[12:15]
v_mfma_f32_16x16x32_bf16 v[16:19], v[120:123], v[160:163], v[16:19]
v_mfma_f32_16x16x32_bf16 v[20:23], v[120:123], v[164:167], v[20:23]
v_mfma_f32_16x16x32_bf16 v[24:27], v[124:127], v[152:155], v[24:27]
v_mfma_f32_16x16x32_bf16 v[28:31], v[124:127], v[156:159], v[28:31]
v_mfma_f32_16x16x32_bf16 v[32:35], v[124:127], v[160:163], v[32:35]
v_mfma_f32_16x16x32_bf16 v[36:39], v[124:127], v[164:167], v[36:39]
v_mfma_f32_16x16x32_bf16 v[40:43], v[128:131], v[152:155], v[40:43]
v_mfma_f32_16x16x32_bf16 v[44:47], v[128:131], v[156:159], v[44:47]
v_mfma_f32_16x16x32_bf16 v[48:51], v[128:131], v[160:163], v[48:51]
v_mfma_f32_16x16x32_bf16 v[52:55], v[128:131], v[164:167], v[52:55]
v_mfma_f32_16x16x32_bf16 v[56:59], v[132:135], v[152:155], v[56:59]
v_mfma_f32_16x16x32_bf16 v[60:63], v[132:135], v[156:159], v[60:63]
v_mfma_f32_16x16x32_bf16 v[64:67], v[132:135], v[160:163], v[64:67]
v_mfma_f32_16x16x32_bf16 v[68:71], v[132:135], v[164:167], v[68:71]
v_add_u32 v6, 4096, v6
v_add_u32 v7, 4096, v7
s_add_u32 s40, s40, 1
s_cmp_lt_u32 s40, 4
s_cbranch_scc1 qkvb_loop7
s_waitcnt vmcnt(0) lgkmcnt(0)
v_and_b32 v2, 63, v0
v_and_b32 v3, 15, v2
v_lshrrev_b32 v4, 4, v2
s_lshl_b32 s41, s17, 19
s_lshl_b32 s42, s18, 12
s_add_u32 s41, s41, s42
s_mov_b32 s46, 0x3ea52b5c
s_mov_b32 s47, 0x3ea52b5c
v_lshlrev_b32 v5, 2, v4
v_add_u32 v5, 64, v5
v_mul_u32_u24 v168, 205, v5
v_lshrrev_b32 v168, 12, v168
v_mul_u32_u24 v6, 20, v168
v_sub_u32 v5, v5, v6
v_lshlrev_b32 v168, 17, v168
v_lshrrev_b32 v6, 4, v5
v_lshl_add_u32 v168, v6, 10, v168
v_bfe_u32 v6, v5, 2, 1
v_lshl_add_u32 v168, v6, 9, v168
v_bfe_u32 v6, v5, 3, 1
v_lshl_add_u32 v168, v6, 3, v168
v_lshl_add_u32 v168, v3, 4, v168
v_lshlrev_b32 v5, 2, v4
v_add_u32 v5, 0, v5
v_mul_u32_u24 v169, 205, v5
v_lshrrev_b32 v169, 12, v169
v_mul_u32_u24 v6, 20, v169
v_sub_u32 v5, v5, v6
v_lshlrev_b32 v169, 17, v169
v_lshrrev_b32 v6, 4, v5
v_lshl_add_u32 v169, v6, 10, v169
v_bfe_u32 v6, v5, 2, 1
v_lshl_add_u32 v169, v6, 9, v169
v_bfe_u32 v6, v5, 3, 1
v_lshl_add_u32 v169, v6, 3, v169
v_lshl_add_u32 v169, v3, 4, v169
v_lshlrev_b32 v5, 2, v4
v_add_u32 v5, 16, v5
v_mul_u32_u24 v170, 205, v5
v_lshrrev_b32 v170, 12, v170
v_mul_u32_u24 v6, 20, v170
v_sub_u32 v5, v5, v6
v_lshlrev_b32 v170, 17, v170
v_lshrrev_b32 v6, 4, v5
v_lshl_add_u32 v170, v6, 10, v170
v_bfe_u32 v6, v5, 2, 1
v_lshl_add_u32 v170, v6, 9, v170
v_bfe_u32 v6, v5, 3, 1
v_lshl_add_u32 v170, v6, 3, v170
v_lshl_add_u32 v170, v3, 4, v170
v_lshlrev_b32 v5, 2, v4
v_add_u32 v5, 32, v5
v_mul_u32_u24 v171, 205, v5
v_lshrrev_b32 v171, 12, v171
v_mul_u32_u24 v6, 20, v171
v_sub_u32 v5, v5, v6
v_lshlrev_b32 v171, 17, v171
v_lshrrev_b32 v6, 4, v5
v_lshl_add_u32 v171, v6, 10, v171
v_bfe_u32 v6, v5, 2, 1
v_lshl_add_u32 v171, v6, 9, v171
v_bfe_u32 v6, v5, 3, 1
v_lshl_add_u32 v171, v6, 3, v171
v_lshl_add_u32 v171, v3, 4, v171
v_pk_mul_f32 v[8:9], v[8:9], s[46:47]
v_pk_mul_f32 v[10:11], v[10:11], s[46:47]
v_cvt_pk_bf16_f32 v136, v8, v9
v_cvt_pk_bf16_f32 v137, v10, v11
s_add_u32 s43, s41, 37748736
buffer_store_dwordx2 v[136:137], v168, s[4:7], s43 offen sc1
v_pk_mul_f32 v[12:13], v[12:13], s[46:47]
v_pk_mul_f32 v[14:15], v[14:15], s[46:47]
v_cvt_pk_bf16_f32 v138, v12, v13
v_cvt_pk_bf16_f32 v139, v14, v15
s_add_u32 s43, s41, 37748992
buffer_store_dwordx2 v[138:139], v168, s[4:7], s43 offen sc1
v_pk_mul_f32 v[16:17], v[16:17], s[46:47]
v_pk_mul_f32 v[18:19], v[18:19], s[46:47]
v_cvt_pk_bf16_f32 v140, v16, v17
v_cvt_pk_bf16_f32 v141, v18, v19
s_add_u32 s43, s41, 37750784
buffer_store_dwordx2 v[140:141], v168, s[4:7], s43 offen sc1
v_pk_mul_f32 v[20:21], v[20:21], s[46:47]
v_pk_mul_f32 v[22:23], v[22:23], s[46:47]
v_cvt_pk_bf16_f32 v142, v20, v21
v_cvt_pk_bf16_f32 v143, v22, v23
s_add_u32 s43, s41, 37751040
buffer_store_dwordx2 v[142:143], v168, s[4:7], s43 offen sc1
v_cvt_pk_bf16_f32 v144, v24, v25
v_cvt_pk_bf16_f32 v145, v26, v27
s_add_u32 s43, s41, 41943040
buffer_store_dwordx2 v[144:145], v169, s[4:7], s43 offen sc1
v_cvt_pk_bf16_f32 v146, v28, v29
v_cvt_pk_bf16_f32 v147, v30, v31
s_add_u32 s43, s41, 41943296
buffer_store_dwordx2 v[146:147], v169, s[4:7], s43 offen sc1
v_cvt_pk_bf16_f32 v148, v32, v33
v_cvt_pk_bf16_f32 v149, v34, v35
s_add_u32 s43, s41, 41945088
buffer_store_dwordx2 v[148:149], v169, s[4:7], s43 offen sc1
v_cvt_pk_bf16_f32 v150, v36, v37
v_cvt_pk_bf16_f32 v151, v38, v39
s_add_u32 s43, s41, 41945344
buffer_store_dwordx2 v[150:151], v169, s[4:7], s43 offen sc1
v_cvt_pk_bf16_f32 v136, v40, v41
v_cvt_pk_bf16_f32 v137, v42, v43
s_add_u32 s43, s41, 41943040
buffer_store_dwordx2 v[136:137], v170, s[4:7], s43 offen sc1
v_cvt_pk_bf16_f32 v138, v44, v45
v_cvt_pk_bf16_f32 v139, v46, v47
s_add_u32 s43, s41, 41943296
buffer_store_dwordx2 v[138:139], v170, s[4:7], s43 offen sc1
v_cvt_pk_bf16_f32 v140, v48, v49
v_cvt_pk_bf16_f32 v141, v50, v51
s_add_u32 s43, s41, 41945088
buffer_store_dwordx2 v[140:141], v170, s[4:7], s43 offen sc1
v_cvt_pk_bf16_f32 v142, v52, v53
v_cvt_pk_bf16_f32 v143, v54, v55
s_add_u32 s43, s41, 41945344
buffer_store_dwordx2 v[142:143], v170, s[4:7], s43 offen sc1
v_cvt_pk_bf16_f32 v144, v56, v57
v_cvt_pk_bf16_f32 v145, v58, v59
s_add_u32 s43, s41, 41943040
buffer_store_dwordx2 v[144:145], v171, s[4:7], s43 offen sc1
v_cvt_pk_bf16_f32 v146, v60, v61
v_cvt_pk_bf16_f32 v147, v62, v63
s_add_u32 s43, s41, 41943296
buffer_store_dwordx2 v[146:147], v171, s[4:7], s43 offen sc1
v_cvt_pk_bf16_f32 v148, v64, v65
v_cvt_pk_bf16_f32 v149, v66, v67
s_add_u32 s43, s41, 41945088
buffer_store_dwordx2 v[148:149], v171, s[4:7], s43 offen sc1
v_cvt_pk_bf16_f32 v150, v68, v69
v_cvt_pk_bf16_f32 v151, v70, v71
s_add_u32 s43, s41, 41945344
buffer_store_dwordx2 v[150:151], v171, s[4:7], s43 offen sc1
s_branch qkvb_exit1
qkvb_w2_4:
s_mul_i32 s30, s17, 5
s_add_u32 s30, s30, 43
s_mul_i32 s30, s30, 20480
s_add_u32 s30, s30, 87556096
s_mul_i32 s31, s17, 5
s_add_u32 s31, s31, 44
s_mul_i32 s31, s31, 20480
s_add_u32 s31, s31, 87556096
s_mul_i32 s32, s17, 5
s_add_u32 s32, s32, 80
s_mul_i32 s32, s32, 20480
s_add_u32 s32, s32, 87556096
s_mul_i32 s33, s17, 5
s_add_u32 s33, s33, 81
s_mul_i32 s33, s33, 20480
s_add_u32 s33, s33, 87556096
buffer_load_dwordx4 v[72:75], v1, s[4:7], s30 offen offset:0
buffer_load_dwordx4 v[76:79], v1, s[4:7], s31 offen offset:0
buffer_load_dwordx4 v[80:83], v1, s[4:7], s32 offen offset:0
buffer_load_dwordx4 v[84:87], v1, s[4:7], s33 offen offset:0
buffer_load_dwordx4 v[88:91], v1, s[4:7], s30 offen offset:1024
buffer_load_dwordx4 v[92:95], v1, s[4:7], s31 offen offset:1024
buffer_load_dwordx4 v[96:99], v1, s[4:7], s32 offen offset:1024
buffer_load_dwordx4 v[100:103], v1, s[4:7], s33 offen offset:1024
buffer_load_dwordx4 v[104:107], v1, s[4:7], s30 offen offset:2048
buffer_load_dwordx4 v[108:111], v1, s[4:7], s31 offen offset:2048
buffer_load_dwordx4 v[112:115], v1, s[4:7], s32 offen offset:2048
buffer_load_dwordx4 v[116:119], v1, s[4:7], s33 offen offset:2048
s_add_u32 m0, s22, 4096
s_add_u32 s23, s21, 4096
buffer_load_dwordx4 v1, s[4:7], s23 offen offset:0 lds
buffer_load_dwordx4 v1, s[4:7], s23 offen offset:1024 lds
buffer_load_dwordx4 v1, s[4:7], s23 offen offset:2048 lds
buffer_load_dwordx4 v1, s[4:7], s23 offen offset:3072 lds
s_add_u32 m0, s22, 8192
s_add_u32 s23, s21, 8192
buffer_load_dwordx4 v1, s[4:7], s23 offen offset:0 lds
buffer_load_dwordx4 v1, s[4:7], s23 offen offset:1024 lds
buffer_load_dwordx4 v1, s[4:7], s23 offen offset:2048 lds
buffer_load_dwordx4 v1, s[4:7], s23 offen offset:3072 lds
s_add_u32 m0, s22, 12288
s_add_u32 s23, s21, 12288
buffer_load_dwordx4 v1, s[4:7], s23 offen offset:0 lds
buffer_load_dwordx4 v1, s[4:7], s23 offen offset:1024 lds
buffer_load_dwordx4 v1, s[4:7], s23 offen offset:2048 lds
buffer_load_dwordx4 v1, s[4:7], s23 offen offset:3072 lds
s_add_u32 m0, s22, 16384
s_add_u32 s23, s21, 16384
buffer_load_dwordx4 v1, s[4:7], s23 offen offset:0 lds
buffer_load_dwordx4 v1, s[4:7], s23 offen offset:1024 lds
buffer_load_dwordx4 v1, s[4:7], s23 offen offset:2048 lds
buffer_load_dwordx4 v1, s[4:7], s23 offen offset:3072 lds
s_waitcnt vmcnt(28)
s_barrier
ds_read_b128 v[136:139], v6 offset:0
ds_read_b128 v[140:143], v6 offset:20480
ds_read_b128 v[144:147], v7 offset:0
ds_read_b128 v[148:151], v7 offset:20480
buffer_load_dwordx4 v[120:123], v1, s[4:7], s30 offen offset:3072
buffer_load_dwordx4 v[124:127], v1, s[4:7], s31 offen offset:3072
buffer_load_dwordx4 v[128:131], v1, s[4:7], s32 offen offset:3072
buffer_load_dwordx4 v[132:135], v1, s[4:7], s33 offen offset:3072
s_waitcnt vmcnt(28)
ds_read_b128 v[152:155], v6 offset:1024
ds_read_b128 v[156:159], v6 offset:21504
ds_read_b128 v[160:163], v7 offset:1024
ds_read_b128 v[164:167], v7 offset:21504
s_waitcnt lgkmcnt(4)
v_mfma_f32_16x16x32_bf16 v[8:11], v[72:75], v[136:139], 0
v_mfma_f32_16x16x32_bf16 v[12:15], v[72:75], v[140:143], 0
v_mfma_f32_16x16x32_bf16 v[16:19], v[72:75], v[144:147], 0
v_mfma_f32_16x16x32_bf16 v[20:23], v[72:75], v[148:151], 0
v_mfma_f32_16x16x32_bf16 v[24:27], v[76:79], v[136:139], 0
v_mfma_f32_16x16x32_bf16 v[28:31], v[76:79], v[140:143], 0
v_mfma_f32_16x16x32_bf16 v[32:35], v[76:79], v[144:147], 0
v_mfma_f32_16x16x32_bf16 v[36:39], v[76:79], v[148:151], 0
v_mfma_f32_16x16x32_bf16 v[40:43], v[136:139], v[80:83], 0
v_mfma_f32_16x16x32_bf16 v[44:47], v[140:143], v[80:83], 0
v_mfma_f32_16x16x32_bf16 v[48:51], v[144:147], v[80:83], 0
v_mfma_f32_16x16x32_bf16 v[52:55], v[148:151], v[80:83], 0
v_mfma_f32_16x16x32_bf16 v[56:59], v[136:139], v[84:87], 0
v_mfma_f32_16x16x32_bf16 v[60:63], v[140:143], v[84:87], 0
v_mfma_f32_16x16x32_bf16 v[64:67], v[144:147], v[84:87], 0
v_mfma_f32_16x16x32_bf16 v[68:71], v[148:151], v[84:87], 0
s_add_u32 s30, s30, 4096
s_add_u32 s31, s31, 4096
s_add_u32 s32, s32, 4096
s_add_u32 s33, s33, 4096
buffer_load_dwordx4 v[72:75], v1, s[4:7], s30 offen offset:0
buffer_load_dwordx4 v[76:79], v1, s[4:7], s31 offen offset:0
buffer_load_dwordx4 v[80:83], v1, s[4:7], s32 offen offset:0
buffer_load_dwordx4 v[84:87], v1, s[4:7], s33 offen offset:0
s_waitcnt vmcnt(28)
ds_read_b128 v[136:139], v6 offset:2048
ds_read_b128 v[140:143], v6 offset:22528
ds_read_b128 v[144:147], v7 offset:2048
ds_read_b128 v[148:151], v7 offset:22528
s_waitcnt lgkmcnt(4)
v_mfma_f32_16x16x32_bf16 v[8:11], v[88:91], v[152:155], v[8:11]
v_mfma_f32_16x16x32_bf16 v[12:15], v[88:91], v[156:159], v[12:15]
v_mfma_f32_16x16x32_bf16 v[16:19], v[88:91], v[160:163], v[16:19]
v_mfma_f32_16x16x32_bf16 v[20:23], v[88:91], v[164:167], v[20:23]
v_mfma_f32_16x16x32_bf16 v[24:27], v[92:95], v[152:155], v[24:27]
v_mfma_f32_16x16x32_bf16 v[28:31], v[92:95], v[156:159], v[28:31]
v_mfma_f32_16x16x32_bf16 v[32:35], v[92:95], v[160:163], v[32:35]
v_mfma_f32_16x16x32_bf16 v[36:39], v[92:95], v[164:167], v[36:39]
v_mfma_f32_16x16x32_bf16 v[40:43], v[152:155], v[96:99], v[40:43]
v_mfma_f32_16x16x32_bf16 v[44:47], v[156:159], v[96:99], v[44:47]
v_mfma_f32_16x16x32_bf16 v[48:51], v[160:163], v[96:99], v[48:51]
v_mfma_f32_16x16x32_bf16 v[52:55], v[164:167], v[96:99], v[52:55]
v_mfma_f32_16x16x32_bf16 v[56:59], v[152:155], v[100:103], v[56:59]
v_mfma_f32_16x16x32_bf16 v[60:63], v[156:159], v[100:103], v[60:63]
v_mfma_f32_16x16x32_bf16 v[64:67], v[160:163], v[100:103], v[64:67]
v_mfma_f32_16x16x32_bf16 v[68:71], v[164:167], v[100:103], v[68:71]
buffer_load_dwordx4 v[88:91], v1, s[4:7], s30 offen offset:1024
buffer_load_dwordx4 v[92:95], v1, s[4:7], s31 offen offset:1024
buffer_load_dwordx4 v[96:99], v1, s[4:7], s32 offen offset:1024
buffer_load_dwordx4 v[100:103], v1, s[4:7], s33 offen offset:1024
s_waitcnt vmcnt(28)
ds_read_b128 v[152:155], v6 offset:3072
ds_read_b128 v[156:159], v6 offset:23552
ds_read_b128 v[160:163], v7 offset:3072
ds_read_b128 v[164:167], v7 offset:23552
s_waitcnt lgkmcnt(4)
v_mfma_f32_16x16x32_bf16 v[8:11], v[104:107], v[136:139], v[8:11]
v_mfma_f32_16x16x32_bf16 v[12:15], v[104:107], v[140:143], v[12:15]
v_mfma_f32_16x16x32_bf16 v[16:19], v[104:107], v[144:147], v[16:19]
v_mfma_f32_16x16x32_bf16 v[20:23], v[104:107], v[148:151], v[20:23]
v_mfma_f32_16x16x32_bf16 v[24:27], v[108:111], v[136:139], v[24:27]
v_mfma_f32_16x16x32_bf16 v[28:31], v[108:111], v[140:143], v[28:31]
v_mfma_f32_16x16x32_bf16 v[32:35], v[108:111], v[144:147], v[32:35]
v_mfma_f32_16x16x32_bf16 v[36:39], v[108:111], v[148:151], v[36:39]
v_mfma_f32_16x16x32_bf16 v[40:43], v[136:139], v[112:115], v[40:43]
v_mfma_f32_16x16x32_bf16 v[44:47], v[140:143], v[112:115], v[44:47]
v_mfma_f32_16x16x32_bf16 v[48:51], v[144:147], v[112:115], v[48:51]
v_mfma_f32_16x16x32_bf16 v[52:55], v[148:151], v[112:115], v[52:55]
v_mfma_f32_16x16x32_bf16 v[56:59], v[136:139], v[116:119], v[56:59]
v_mfma_f32_16x16x32_bf16 v[60:63], v[140:143], v[116:119], v[60:63]
v_mfma_f32_16x16x32_bf16 v[64:67], v[144:147], v[116:119], v[64:67]
v_mfma_f32_16x16x32_bf16 v[68:71], v[148:151], v[116:119], v[68:71]
buffer_load_dwordx4 v[104:107], v1, s[4:7], s30 offen offset:2048
buffer_load_dwordx4 v[108:111], v1, s[4:7], s31 offen offset:2048
buffer_load_dwordx4 v[112:115], v1, s[4:7], s32 offen offset:2048
buffer_load_dwordx4 v[116:119], v1, s[4:7], s33 offen offset:2048
s_waitcnt vmcnt(12)
s_barrier
ds_read_b128 v[136:139], v6 offset:4096
ds_read_b128 v[140:143], v6 offset:24576
ds_read_b128 v[144:147], v7 offset:4096
ds_read_b128 v[148:151], v7 offset:24576
s_waitcnt lgkmcnt(4)
v_mfma_f32_16x16x32_bf16 v[8:11], v[120:123], v[152:155], v[8:11]
v_mfma_f32_16x16x32_bf16 v[12:15], v[120:123], v[156:159], v[12:15]
v_mfma_f32_16x16x32_bf16 v[16:19], v[120:123], v[160:163], v[16:19]
v_mfma_f32_16x16x32_bf16 v[20:23], v[120:123], v[164:167], v[20:23]
v_mfma_f32_16x16x32_bf16 v[24:27], v[124:127], v[152:155], v[24:27]
v_mfma_f32_16x16x32_bf16 v[28:31], v[124:127], v[156:159], v[28:31]
v_mfma_f32_16x16x32_bf16 v[32:35], v[124:127], v[160:163], v[32:35]
v_mfma_f32_16x16x32_bf16 v[36:39], v[124:127], v[164:167], v[36:39]
v_mfma_f32_16x16x32_bf16 v[40:43], v[152:155], v[128:131], v[40:43]
v_mfma_f32_16x16x32_bf16 v[44:47], v[156:159], v[128:131], v[44:47]
v_mfma_f32_16x16x32_bf16 v[48:51], v[160:163], v[128:131], v[48:51]
v_mfma_f32_16x16x32_bf16 v[52:55], v[164:167], v[128:131], v[52:55]
v_mfma_f32_16x16x32_bf16 v[56:59], v[152:155], v[132:135], v[56:59]
v_mfma_f32_16x16x32_bf16 v[60:63], v[156:159], v[132:135], v[60:63]
v_mfma_f32_16x16x32_bf16 v[64:67], v[160:163], v[132:135], v[64:67]
v_mfma_f32_16x16x32_bf16 v[68:71], v[164:167], v[132:135], v[68:71]
s_mov_b32 s40, 0
v_add_u32 v6, 4096, v6
v_add_u32 v7, 4096, v7
qkvb_loop8:
buffer_load_dwordx4 v[120:123], v1, s[4:7], s30 offen offset:3072
buffer_load_dwordx4 v[124:127], v1, s[4:7], s31 offen offset:3072
buffer_load_dwordx4 v[128:131], v1, s[4:7], s32 offen offset:3072
buffer_load_dwordx4 v[132:135], v1, s[4:7], s33 offen offset:3072
s_waitcnt vmcnt(12)
ds_read_b128 v[152:155], v6 offset:1024
ds_read_b128 v[156:159], v6 offset:21504
ds_read_b128 v[160:163], v7 offset:1024
ds_read_b128 v[164:167], v7 offset:21504
s_waitcnt lgkmcnt(4)
v_mfma_f32_16x16x32_bf16 v[8:11], v[72:75], v[136:139], v[8:11]
v_mfma_f32_16x16x32_bf16 v[12:15], v[72:75], v[140:143], v[12:15]
v_mfma_f32_16x16x32_bf16 v[16:19], v[72:75], v[144:147], v[16:19]
v_mfma_f32_16x16x32_bf16 v[20:23], v[72:75], v[148:151], v[20:23]
v_mfma_f32_16x16x32_bf16 v[24:27], v[76:79], v[136:139], v[24:27]
v_mfma_f32_16x16x32_bf16 v[28:31], v[76:79], v[140:143], v[28:31]
v_mfma_f32_16x16x32_bf16 v[32:35], v[76:79], v[144:147], v[32:35]
v_mfma_f32_16x16x32_bf16 v[36:39], v[76:79], v[148:151], v[36:39]
v_mfma_f32_16x16x32_bf16 v[40:43], v[136:139], v[80:83], v[40:43]
v_mfma_f32_16x16x32_bf16 v[44:47], v[140:143], v[80:83], v[44:47]
v_mfma_f32_16x16x32_bf16 v[48:51], v[144:147], v[80:83], v[48:51]
v_mfma_f32_16x16x32_bf16 v[52:55], v[148:151], v[80:83], v[52:55]
v_mfma_f32_16x16x32_bf16 v[56:59], v[136:139], v[84:87], v[56:59]
v_mfma_f32_16x16x32_bf16 v[60:63], v[140:143], v[84:87], v[60:63]
v_mfma_f32_16x16x32_bf16 v[64:67], v[144:147], v[84:87], v[64:67]
v_mfma_f32_16x16x32_bf16 v[68:71], v[148:151], v[84:87], v[68:71]
s_add_u32 s30, s30, 4096
s_add_u32 s31, s31, 4096
s_add_u32 s32, s32, 4096
s_add_u32 s33, s33, 4096
buffer_load_dwordx4 v[72:75], v1, s[4:7], s30 offen offset:0
buffer_load_dwordx4 v[76:79], v1, s[4:7], s31 offen offset:0
buffer_load_dwordx4 v[80:83], v1, s[4:7], s32 offen offset:0
buffer_load_dwordx4 v[84:87], v1, s[4:7], s33 offen offset:0
s_waitcnt vmcnt(12)
ds_read_b128 v[136:139], v6 offset:2048
ds_read_b128 v[140:143], v6 offset:22528
ds_read_b128 v[144:147], v7 offset:2048
ds_read_b128 v[148:151], v7 offset:22528
s_waitcnt lgkmcnt(4)
v_mfma_f32_16x16x32_bf16 v[8:11], v[88:91], v[152:155], v[8:11]
v_mfma_f32_16x16x32_bf16 v[12:15], v[88:91], v[156:159], v[12:15]
v_mfma_f32_16x16x32_bf16 v[16:19], v[88:91], v[160:163], v[16:19]
v_mfma_f32_16x16x32_bf16 v[20:23], v[88:91], v[164:167], v[20:23]
v_mfma_f32_16x16x32_bf16 v[24:27], v[92:95], v[152:155], v[24:27]
v_mfma_f32_16x16x32_bf16 v[28:31], v[92:95], v[156:159], v[28:31]
v_mfma_f32_16x16x32_bf16 v[32:35], v[92:95], v[160:163], v[32:35]
v_mfma_f32_16x16x32_bf16 v[36:39], v[92:95], v[164:167], v[36:39]
v_mfma_f32_16x16x32_bf16 v[40:43], v[152:155], v[96:99], v[40:43]
v_mfma_f32_16x16x32_bf16 v[44:47], v[156:159], v[96:99], v[44:47]
v_mfma_f32_16x16x32_bf16 v[48:51], v[160:163], v[96:99], v[48:51]
v_mfma_f32_16x16x32_bf16 v[52:55], v[164:167], v[96:99], v[52:55]
v_mfma_f32_16x16x32_bf16 v[56:59], v[152:155], v[100:103], v[56:59]
v_mfma_f32_16x16x32_bf16 v[60:63], v[156:159], v[100:103], v[60:63]
v_mfma_f32_16x16x32_bf16 v[64:67], v[160:163], v[100:103], v[64:67]
v_mfma_f32_16x16x32_bf16 v[68:71], v[164:167], v[100:103], v[68:71]
buffer_load_dwordx4 v[88:91], v1, s[4:7], s30 offen offset:1024
buffer_load_dwordx4 v[92:95], v1, s[4:7], s31 offen offset:1024
buffer_load_dwordx4 v[96:99], v1, s[4:7], s32 offen offset:1024
buffer_load_dwordx4 v[100:103], v1, s[4:7], s33 offen offset:1024
s_waitcnt vmcnt(12)
ds_read_b128 v[152:155], v6 offset:3072
ds_read_b128 v[156:159], v6 offset:23552
ds_read_b128 v[160:163], v7 offset:3072
ds_read_b128 v[164:167], v7 offset:23552
s_waitcnt lgkmcnt(4)
v_mfma_f32_16x16x32_bf16 v[8:11], v[104:107], v[136:139], v[8:11]
v_mfma_f32_16x16x32_bf16 v[12:15], v[104:107], v[140:143], v[12:15]
v_mfma_f32_16x16x32_bf16 v[16:19], v[104:107], v[144:147], v[16:19]
v_mfma_f32_16x16x32_bf16 v[20:23], v[104:107], v[148:151], v[20:23]
v_mfma_f32_16x16x32_bf16 v[24:27], v[108:111], v[136:139], v[24:27]
v_mfma_f32_16x16x32_bf16 v[28:31], v[108:111], v[140:143], v[28:31]
v_mfma_f32_16x16x32_bf16 v[32:35], v[108:111], v[144:147], v[32:35]
v_mfma_f32_16x16x32_bf16 v[36:39], v[108:111], v[148:151], v[36:39]
v_mfma_f32_16x16x32_bf16 v[40:43], v[136:139], v[112:115], v[40:43]
v_mfma_f32_16x16x32_bf16 v[44:47], v[140:143], v[112:115], v[44:47]
v_mfma_f32_16x16x32_bf16 v[48:51], v[144:147], v[112:115], v[48:51]
v_mfma_f32_16x16x32_bf16 v[52:55], v[148:151], v[112:115], v[52:55]
v_mfma_f32_16x16x32_bf16 v[56:59], v[136:139], v[116:119], v[56:59]
v_mfma_f32_16x16x32_bf16 v[60:63], v[140:143], v[116:119], v[60:63]
v_mfma_f32_16x16x32_bf16 v[64:67], v[144:147], v[116:119], v[64:67]
v_mfma_f32_16x16x32_bf16 v[68:71], v[148:151], v[116:119], v[68:71]
buffer_load_dwordx4 v[104:107], v1, s[4:7], s30 offen offset:2048
buffer_load_dwordx4 v[108:111], v1, s[4:7], s31 offen offset:2048
buffer_load_dwordx4 v[112:115], v1, s[4:7], s32 offen offset:2048
buffer_load_dwordx4 v[116:119], v1, s[4:7], s33 offen offset:2048
s_waitcnt vmcnt(12)
ds_read_b128 v[136:139], v6 offset:4096
ds_read_b128 v[140:143], v6 offset:24576
ds_read_b128 v[144:147], v7 offset:4096
ds_read_b128 v[148:151], v7 offset:24576
s_waitcnt lgkmcnt(4)
v_mfma_f32_16x16x32_bf16 v[8:11], v[120:123], v[152:155], v[8:11]
v_mfma_f32_16x16x32_bf16 v[12:15], v[120:123], v[156:159], v[12:15]
v_mfma_f32_16x16x32_bf16 v[16:19], v[120:123], v[160:163], v[16:19]
v_mfma_f32_16x16x32_bf16 v[20:23], v[120:123], v[164:167], v[20:23]
v_mfma_f32_16x16x32_bf16 v[24:27], v[124:127], v[152:155], v[24:27]
v_mfma_f32_16x16x32_bf16 v[28:31], v[124:127], v[156:159], v[28:31]
v_mfma_f32_16x16x32_bf16 v[32:35], v[124:127], v[160:163], v[32:35]
v_mfma_f32_16x16x32_bf16 v[36:39], v[124:127], v[164:167], v[36:39]
v_mfma_f32_16x16x32_bf16 v[40:43], v[152:155], v[128:131], v[40:43]
v_mfma_f32_16x16x32_bf16 v[44:47], v[156:159], v[128:131], v[44:47]
v_mfma_f32_16x16x32_bf16 v[48:51], v[160:163], v[128:131], v[48:51]
v_mfma_f32_16x16x32_bf16 v[52:55], v[164:167], v[128:131], v[52:55]
v_mfma_f32_16x16x32_bf16 v[56:59], v[152:155], v[132:135], v[56:59]
v_mfma_f32_16x16x32_bf16 v[60:63], v[156:159], v[132:135], v[60:63]
v_mfma_f32_16x16x32_bf16 v[64:67], v[160:163], v[132:135], v[64:67]
v_mfma_f32_16x16x32_bf16 v[68:71], v[164:167], v[132:135], v[68:71]
v_add_u32 v6, 4096, v6
v_add_u32 v7, 4096, v7
s_add_u32 s40, s40, 1
s_cmp_lt_u32 s40, 4
s_cbranch_scc1 qkvb_loop8
s_waitcnt vmcnt(0) lgkmcnt(0)
v_and_b32 v2, 63, v0
v_and_b32 v3, 15, v2
v_lshrrev_b32 v4, 4, v2
s_lshl_b32 s41, s17, 19
s_lshl_b32 s42, s18, 12
s_add_u32 s41, s41, s42
s_mov_b32 s46, 0x3ea52b5c
s_mov_b32 s47, 0x3ea52b5c
v_lshlrev_b32 v5, 2, v4
v_add_u32 v5, 48, v5
v_mul_u32_u24 v168, 205, v5
v_lshrrev_b32 v168, 12, v168
v_mul_u32_u24 v6, 20, v168
v_sub_u32 v5, v5, v6
v_lshlrev_b32 v168, 17, v168
v_lshrrev_b32 v6, 4, v5
v_lshl_add_u32 v168, v6, 10, v168
v_bfe_u32 v6, v5, 2, 1
v_lshl_add_u32 v168, v6, 9, v168
v_bfe_u32 v6, v5, 3, 1
v_lshl_add_u32 v168, v6, 3, v168
v_lshl_add_u32 v168, v3, 4, v168
v_lshlrev_b32 v5, 2, v4
v_add_u32 v5, 64, v5
v_mul_u32_u24 v169, 205, v5
v_lshrrev_b32 v169, 12, v169
v_mul_u32_u24 v6, 20, v169
v_sub_u32 v5, v5, v6
v_lshlrev_b32 v169, 17, v169
v_lshrrev_b32 v6, 4, v5
v_lshl_add_u32 v169, v6, 10, v169
v_bfe_u32 v6, v5, 2, 1
v_lshl_add_u32 v169, v6, 9, v169
v_bfe_u32 v6, v5, 3, 1
v_lshl_add_u32 v169, v6, 3, v169
v_lshl_add_u32 v169, v3, 4, v169
v_add_u32 v5, 0, v3
v_mul_u32_u24 v170, 205, v5
v_lshrrev_b32 v170, 12, v170
v_mul_u32_u24 v6, 20, v170
v_sub_u32 v5, v5, v6
v_lshlrev_b32 v170, 17, v170
v_lshl_add_u32 v170, v5, 4, v170
v_and_b32 v6, 1, v4
v_lshl_add_u32 v170, v6, 9, v170
v_lshrrev_b32 v6, 1, v4
v_lshl_add_u32 v170, v6, 3, v170
v_add_u32 v5, 16, v3
v_mul_u32_u24 v171, 205, v5
v_lshrrev_b32 v171, 12, v171
v_mul_u32_u24 v6, 20, v171
v_sub_u32 v5, v5, v6
v_lshlrev_b32 v171, 17, v171
v_lshl_add_u32 v171, v5, 4, v171
v_and_b32 v6, 1, v4
v_lshl_add_u32 v171, v6, 9, v171
v_lshrrev_b32 v6, 1, v4
v_lshl_add_u32 v171, v6, 3, v171
v_cvt_pk_bf16_f32 v136, v8, v9
v_cvt_pk_bf16_f32 v137, v10, v11
s_add_u32 s43, s41, 41943040
buffer_store_dwordx2 v[136:137], v168, s[4:7], s43 offen sc1
v_cvt_pk_bf16_f32 v138, v12, v13
v_cvt_pk_bf16_f32 v139, v14, v15
s_add_u32 s43, s41, 41943296
buffer_store_dwordx2 v[138:139], v168, s[4:7], s43 offen sc1
v_cvt_pk_bf16_f32 v140, v16, v17
v_cvt_pk_bf16_f32 v141, v18, v19
s_add_u32 s43, s41, 41945088
buffer_store_dwordx2 v[140:141], v168, s[4:7], s43 offen sc1
v_cvt_pk_bf16_f32 v142, v20, v21
v_cvt_pk_bf16_f32 v143, v22, v23
s_add_u32 s43, s41, 41945344
buffer_store_dwordx2 v[142:143], v168, s[4:7], s43 offen sc1
v_cvt_pk_bf16_f32 v144, v24, v25
v_cvt_pk_bf16_f32 v145, v26, v27
s_add_u32 s43, s41, 41943040
buffer_store_dwordx2 v[144:145], v169, s[4:7], s43 offen sc1
v_cvt_pk_bf16_f32 v146, v28, v29
v_cvt_pk_bf16_f32 v147, v30, v31
s_add_u32 s43, s41, 41943296
buffer_store_dwordx2 v[146:147], v169, s[4:7], s43 offen sc1
v_cvt_pk_bf16_f32 v148, v32, v33
v_cvt_pk_bf16_f32 v149, v34, v35
s_add_u32 s43, s41, 41945088
buffer_store_dwordx2 v[148:149], v169, s[4:7], s43 offen sc1
v_cvt_pk_bf16_f32 v150, v36, v37
v_cvt_pk_bf16_f32 v151, v38, v39
s_add_u32 s43, s41, 41945344
buffer_store_dwordx2 v[150:151], v169, s[4:7], s43 offen sc1
v_cvt_pk_bf16_f32 v136, v40, v41
v_cvt_pk_bf16_f32 v137, v42, v43
s_add_u32 s43, s41, 46137344
buffer_store_dwordx2 v[136:137], v170, s[4:7], s43 offen sc1
v_cvt_pk_bf16_f32 v138, v44, v45
v_cvt_pk_bf16_f32 v139, v46, v47
s_add_u32 s43, s41, 46138368
buffer_store_dwordx2 v[138:139], v170, s[4:7], s43 offen sc1
v_cvt_pk_bf16_f32 v140, v48, v49
v_cvt_pk_bf16_f32 v141, v50, v51
s_add_u32 s43, s41, 46139392
buffer_store_dwordx2 v[140:141], v170, s[4:7], s43 offen sc1
v_cvt_pk_bf16_f32 v142, v52, v53
v_cvt_pk_bf16_f32 v143, v54, v55
s_add_u32 s43, s41, 46140416
buffer_store_dwordx2 v[142:143], v170, s[4:7], s43 offen sc1
v_cvt_pk_bf16_f32 v144, v56, v57
v_cvt_pk_bf16_f32 v145, v58, v59
s_add_u32 s43, s41, 46137344
buffer_store_dwordx2 v[144:145], v171, s[4:7], s43 offen sc1
v_cvt_pk_bf16_f32 v146, v60, v61
v_cvt_pk_bf16_f32 v147, v62, v63
s_add_u32 s43, s41, 46138368
buffer_store_dwordx2 v[146:147], v171, s[4:7], s43 offen sc1
v_cvt_pk_bf16_f32 v148, v64, v65
v_cvt_pk_bf16_f32 v149, v66, v67
s_add_u32 s43, s41, 46139392
buffer_store_dwordx2 v[148:149], v171, s[4:7], s43 offen sc1
v_cvt_pk_bf16_f32 v150, v68, v69
v_cvt_pk_bf16_f32 v151, v70, v71
s_add_u32 s43, s41, 46140416
buffer_store_dwordx2 v[150:151], v171, s[4:7], s43 offen sc1
s_branch qkvb_exit1
qkvb_w3_5:
s_mul_i32 s30, s17, 5
s_add_u32 s30, s30, 82
s_mul_i32 s30, s30, 20480
s_add_u32 s30, s30, 87556096
s_mul_i32 s31, s17, 5
s_add_u32 s31, s31, 83
s_mul_i32 s31, s31, 20480
s_add_u32 s31, s31, 87556096
s_mul_i32 s32, s17, 5
s_add_u32 s32, s32, 84
s_mul_i32 s32, s32, 20480
s_add_u32 s32, s32, 87556096
buffer_load_dwordx4 v[72:75], v1, s[4:7], s30 offen offset:0
buffer_load_dwordx4 v[76:79], v1, s[4:7], s31 offen offset:0
buffer_load_dwordx4 v[80:83], v1, s[4:7], s32 offen offset:0
buffer_load_dwordx4 v[88:91], v1, s[4:7], s30 offen offset:1024
buffer_load_dwordx4 v[92:95], v1, s[4:7], s31 offen offset:1024
buffer_load_dwordx4 v[96:99], v1, s[4:7], s32 offen offset:1024
buffer_load_dwordx4 v[104:107], v1, s[4:7], s30 offen offset:2048
buffer_load_dwordx4 v[108:111], v1, s[4:7], s31 offen offset:2048
buffer_load_dwordx4 v[112:115], v1, s[4:7], s32 offen offset:2048
s_add_u32 m0, s22, 4096
s_add_u32 s23, s21, 4096
buffer_load_dwordx4 v1, s[4:7], s23 offen offset:0 lds
buffer_load_dwordx4 v1, s[4:7], s23 offen offset:1024 lds
buffer_load_dwordx4 v1, s[4:7], s23 offen offset:2048 lds
buffer_load_dwordx4 v1, s[4:7], s23 offen offset:3072 lds
s_add_u32 m0, s22, 8192
s_add_u32 s23, s21, 8192
buffer_load_dwordx4 v1, s[4:7], s23 offen offset:0 lds
buffer_load_dwordx4 v1, s[4:7], s23 offen offset:1024 lds
buffer_load_dwordx4 v1, s[4:7], s23 offen offset:2048 lds
buffer_load_dwordx4 v1, s[4:7], s23 offen offset:3072 lds
s_add_u32 m0, s22, 12288
s_add_u32 s23, s21, 12288
buffer_load_dwordx4 v1, s[4:7], s23 offen offset:0 lds
buffer_load_dwordx4 v1, s[4:7], s23 offen offset:1024 lds
buffer_load_dwordx4 v1, s[4:7], s23 offen offset:2048 lds
buffer_load_dwordx4 v1, s[4:7], s23 offen offset:3072 lds
s_add_u32 m0, s22, 16384
s_add_u32 s23, s21, 16384
buffer_load_dwordx4 v1, s[4:7], s23 offen offset:0 lds
buffer_load_dwordx4 v1, s[4:7], s23 offen offset:1024 lds
buffer_load_dwordx4 v1, s[4:7], s23 offen offset:2048 lds
buffer_load_dwordx4 v1, s[4:7], s23 offen offset:3072 lds
s_waitcnt vmcnt(25)
s_barrier
ds_read_b128 v[136:139], v6 offset:0
ds_read_b128 v[140:143], v6 offset:20480
ds_read_b128 v[144:147], v7 offset:0
ds_read_b128 v[148:151], v7 offset:20480
buffer_load_dwordx4 v[120:123], v1, s[4:7], s30 offen offset:3072
buffer_load_dwordx4 v[124:127], v1, s[4:7], s31 offen offset:3072
buffer_load_dwordx4 v[128:131], v1, s[4:7], s32 offen offset:3072
s_waitcnt vmcnt(25)
ds_read_b128 v[152:155], v6 offset:1024
ds_read_b128 v[156:159], v6 offset:21504
ds_read_b128 v[160:163], v7 offset:1024
ds_read_b128 v[164:167], v7 offset:21504
s_waitcnt lgkmcnt(4)
v_mfma_f32_16x16x32_bf16 v[8:11], v[136:139], v[72:75], 0
v_mfma_f32_16x16x32_bf16 v[12:15], v[140:143], v[72:75], 0
v_mfma_f32_16x16x32_bf16 v[16:19], v[144:147], v[72:75], 0
v_mfma_f32_16x16x32_bf16 v[20:23], v[148:151], v[72:75], 0
v_mfma_f32_16x16x32_bf16 v[24:27], v[136:139], v[76:79], 0
v_mfma_f32_16x16x32_bf16 v[28:31], v[140:143], v[76:79], 0
v_mfma_f32_16x16x32_bf16 v[32:35], v[144:147], v[76:79], 0
v_mfma_f32_16x16x32_bf16 v[36:39], v[148:151], v[76:79], 0
v_mfma_f32_16x16x32_bf16 v[40:43], v[136:139], v[80:83], 0
v_mfma_f32_16x16x32_bf16 v[44:47], v[140:143], v[80:83], 0
v_mfma_f32_16x16x32_bf16 v[48:51], v[144:147], v[80:83], 0
v_mfma_f32_16x16x32_bf16 v[52:55], v[148:151], v[80:83], 0
s_add_u32 s30, s30, 4096
s_add_u32 s31, s31, 4096
s_add_u32 s32, s32, 4096
buffer_load_dwordx4 v[72:75], v1, s[4:7], s30 offen offset:0
buffer_load_dwordx4 v[76:79], v1, s[4:7], s31 offen offset:0
buffer_load_dwordx4 v[80:83], v1, s[4:7], s32 offen offset:0
s_waitcnt vmcnt(25)
ds_read_b128 v[136:139], v6 offset:2048
ds_read_b128 v[140:143], v6 offset:22528
ds_read_b128 v[144:147], v7 offset:2048
ds_read_b128 v[148:151], v7 offset:22528
s_waitcnt lgkmcnt(4)
v_mfma_f32_16x16x32_bf16 v[8:11], v[152:155], v[88:91], v[8:11]
v_mfma_f32_16x16x32_bf16 v[12:15], v[156:159], v[88:91], v[12:15]
v_mfma_f32_16x16x32_bf16 v[16:19], v[160:163], v[88:91], v[16:19]
v_mfma_f32_16x16x32_bf16 v[20:23], v[164:167], v[88:91], v[20:23]
v_mfma_f32_16x16x32_bf16 v[24:27], v[152:155], v[92:95], v[24:27]
v_mfma_f32_16x16x32_bf16 v[28:31], v[156:159], v[92:95], v[28:31]
v_mfma_f32_16x16x32_bf16 v[32:35], v[160:163], v[92:95], v[32:35]
v_mfma_f32_16x16x32_bf16 v[36:39], v[164:167], v[92:95], v[36:39]
v_mfma_f32_16x16x32_bf16 v[40:43], v[152:155], v[96:99], v[40:43]
v_mfma_f32_16x16x32_bf16 v[44:47], v[156:159], v[96:99], v[44:47]
v_mfma_f32_16x16x32_bf16 v[48:51], v[160:163], v[96:99], v[48:51]
v_mfma_f32_16x16x32_bf16 v[52:55], v[164:167], v[96:99], v[52:55]
buffer_load_dwordx4 v[88:91], v1, s[4:7], s30 offen offset:1024
buffer_load_dwordx4 v[92:95], v1, s[4:7], s31 offen offset:1024
buffer_load_dwordx4 v[96:99], v1, s[4:7], s32 offen offset:1024
s_waitcnt vmcnt(25)
ds_read_b128 v[152:155], v6 offset:3072
ds_read_b128 v[156:159], v6 offset:23552
ds_read_b128 v[160:163], v7 offset:3072
ds_read_b128 v[164:167], v7 offset:23552
s_waitcnt lgkmcnt(4)
v_mfma_f32_16x16x32_bf16 v[8:11], v[136:139], v[104:107], v[8:11]
v_mfma_f32_16x16x32_bf16 v[12:15], v[140:143], v[104:107], v[12:15]
v_mfma_f32_16x16x32_bf16 v[16:19], v[144:147], v[104:107], v[16:19]
v_mfma_f32_16x16x32_bf16 v[20:23], v[148:151], v[104:107], v[20:23]
v_mfma_f32_16x16x32_bf16 v[24:27], v[136:139], v[108:111], v[24:27]
v_mfma_f32_16x16x32_bf16 v[28:31], v[140:143], v[108:111], v[28:31]
v_mfma_f32_16x16x32_bf16 v[32:35], v[144:147], v[108:111], v[32:35]
v_mfma_f32_16x16x32_bf16 v[36:39], v[148:151], v[108:111], v[36:39]
v_mfma_f32_16x16x32_bf16 v[40:43], v[136:139], v[112:115], v[40:43]
v_mfma_f32_16x16x32_bf16 v[44:47], v[140:143], v[112:115], v[44:47]
v_mfma_f32_16x16x32_bf16 v[48:51], v[144:147], v[112:115], v[48:51]
v_mfma_f32_16x16x32_bf16 v[52:55], v[148:151], v[112:115], v[52:55]
buffer_load_dwordx4 v[104:107], v1, s[4:7], s30 offen offset:2048
buffer_load_dwordx4 v[108:111], v1, s[4:7], s31 offen offset:2048
buffer_load_dwordx4 v[112:115], v1, s[4:7], s32 offen offset:2048
s_waitcnt vmcnt(9)
s_barrier
ds_read_b128 v[136:139], v6 offset:4096
ds_read_b128 v[140:143], v6 offset:24576
ds_read_b128 v[144:147], v7 offset:4096
ds_read_b128 v[148:151], v7 offset:24576
s_waitcnt lgkmcnt(4)
v_mfma_f32_16x16x32_bf16 v[8:11], v[152:155], v[120:123], v[8:11]
v_mfma_f32_16x16x32_bf16 v[12:15], v[156:159], v[120:123], v[12:15]
v_mfma_f32_16x16x32_bf16 v[16:19], v[160:163], v[120:123], v[16:19]
v_mfma_f32_16x16x32_bf16 v[20:23], v[164:167], v[120:123], v[20:23]
v_mfma_f32_16x16x32_bf16 v[24:27], v[152:155], v[124:127], v[24:27]
v_mfma_f32_16x16x32_bf16 v[28:31], v[156:159], v[124:127], v[28:31]
v_mfma_f32_16x16x32_bf16 v[32:35], v[160:163], v[124:127], v[32:35]
v_mfma_f32_16x16x32_bf16 v[36:39], v[164:167], v[124:127], v[36:39]
v_mfma_f32_16x16x32_bf16 v[40:43], v[152:155], v[128:131], v[40:43]
v_mfma_f32_16x16x32_bf16 v[44:47], v[156:159], v[128:131], v[44:47]
v_mfma_f32_16x16x32_bf16 v[48:51], v[160:163], v[128:131], v[48:51]
v_mfma_f32_16x16x32_bf16 v[52:55], v[164:167], v[128:131], v[52:55]
s_mov_b32 s40, 0
v_add_u32 v6, 4096, v6
v_add_u32 v7, 4096, v7
qkvb_loop9:
buffer_load_dwordx4 v[120:123], v1, s[4:7], s30 offen offset:3072
buffer_load_dwordx4 v[124:127], v1, s[4:7], s31 offen offset:3072
buffer_load_dwordx4 v[128:131], v1, s[4:7], s32 offen offset:3072
s_waitcnt vmcnt(9)
ds_read_b128 v[152:155], v6 offset:1024
ds_read_b128 v[156:159], v6 offset:21504
ds_read_b128 v[160:163], v7 offset:1024
ds_read_b128 v[164:167], v7 offset:21504
s_waitcnt lgkmcnt(4)
v_mfma_f32_16x16x32_bf16 v[8:11], v[136:139], v[72:75], v[8:11]
v_mfma_f32_16x16x32_bf16 v[12:15], v[140:143], v[72:75], v[12:15]
v_mfma_f32_16x16x32_bf16 v[16:19], v[144:147], v[72:75], v[16:19]
v_mfma_f32_16x16x32_bf16 v[20:23], v[148:151], v[72:75], v[20:23]
v_mfma_f32_16x16x32_bf16 v[24:27], v[136:139], v[76:79], v[24:27]
v_mfma_f32_16x16x32_bf16 v[28:31], v[140:143], v[76:79], v[28:31]
v_mfma_f32_16x16x32_bf16 v[32:35], v[144:147], v[76:79], v[32:35]
v_mfma_f32_16x16x32_bf16 v[36:39], v[148:151], v[76:79], v[36:39]
v_mfma_f32_16x16x32_bf16 v[40:43], v[136:139], v[80:83], v[40:43]
v_mfma_f32_16x16x32_bf16 v[44:47], v[140:143], v[80:83], v[44:47]
v_mfma_f32_16x16x32_bf16 v[48:51], v[144:147], v[80:83], v[48:51]
v_mfma_f32_16x16x32_bf16 v[52:55], v[148:151], v[80:83], v[52:55]
s_add_u32 s30, s30, 4096
s_add_u32 s31, s31, 4096
s_add_u32 s32, s32, 4096
buffer_load_dwordx4 v[72:75], v1, s[4:7], s30 offen offset:0
buffer_load_dwordx4 v[76:79], v1, s[4:7], s31 offen offset:0
buffer_load_dwordx4 v[80:83], v1, s[4:7], s32 offen offset:0
s_waitcnt vmcnt(9)
ds_read_b128 v[136:139], v6 offset:2048
ds_read_b128 v[140:143], v6 offset:22528
ds_read_b128 v[144:147], v7 offset:2048
ds_read_b128 v[148:151], v7 offset:22528
s_waitcnt lgkmcnt(4)
v_mfma_f32_16x16x32_bf16 v[8:11], v[152:155], v[88:91], v[8:11]
v_mfma_f32_16x16x32_bf16 v[12:15], v[156:159], v[88:91], v[12:15]
v_mfma_f32_16x16x32_bf16 v[16:19], v[160:163], v[88:91], v[16:19]
v_mfma_f32_16x16x32_bf16 v[20:23], v[164:167], v[88:91], v[20:23]
v_mfma_f32_16x16x32_bf16 v[24:27], v[152:155], v[92:95], v[24:27]
v_mfma_f32_16x16x32_bf16 v[28:31], v[156:159], v[92:95], v[28:31]
v_mfma_f32_16x16x32_bf16 v[32:35], v[160:163], v[92:95], v[32:35]
v_mfma_f32_16x16x32_bf16 v[36:39], v[164:167], v[92:95], v[36:39]
v_mfma_f32_16x16x32_bf16 v[40:43], v[152:155], v[96:99], v[40:43]
v_mfma_f32_16x16x32_bf16 v[44:47], v[156:159], v[96:99], v[44:47]
v_mfma_f32_16x16x32_bf16 v[48:51], v[160:163], v[96:99], v[48:51]
v_mfma_f32_16x16x32_bf16 v[52:55], v[164:167], v[96:99], v[52:55]
buffer_load_dwordx4 v[88:91], v1, s[4:7], s30 offen offset:1024
buffer_load_dwordx4 v[92:95], v1, s[4:7], s31 offen offset:1024
buffer_load_dwordx4 v[96:99], v1, s[4:7], s32 offen offset:1024
s_waitcnt vmcnt(9)
ds_read_b128 v[152:155], v6 offset:3072
ds_read_b128 v[156:159], v6 offset:23552
ds_read_b128 v[160:163], v7 offset:3072
ds_read_b128 v[164:167], v7 offset:23552
s_waitcnt lgkmcnt(4)
v_mfma_f32_16x16x32_bf16 v[8:11], v[136:139], v[104:107], v[8:11]
v_mfma_f32_16x16x32_bf16 v[12:15], v[140:143], v[104:107], v[12:15]
v_mfma_f32_16x16x32_bf16 v[16:19], v[144:147], v[104:107], v[16:19]
v_mfma_f32_16x16x32_bf16 v[20:23], v[148:151], v[104:107], v[20:23]
v_mfma_f32_16x16x32_bf16 v[24:27], v[136:139], v[108:111], v[24:27]
v_mfma_f32_16x16x32_bf16 v[28:31], v[140:143], v[108:111], v[28:31]
v_mfma_f32_16x16x32_bf16 v[32:35], v[144:147], v[108:111], v[32:35]
v_mfma_f32_16x16x32_bf16 v[36:39], v[148:151], v[108:111], v[36:39]
v_mfma_f32_16x16x32_bf16 v[40:43], v[136:139], v[112:115], v[40:43]
v_mfma_f32_16x16x32_bf16 v[44:47], v[140:143], v[112:115], v[44:47]
v_mfma_f32_16x16x32_bf16 v[48:51], v[144:147], v[112:115], v[48:51]
v_mfma_f32_16x16x32_bf16 v[52:55], v[148:151], v[112:115], v[52:55]
buffer_load_dwordx4 v[104:107], v1, s[4:7], s30 offen offset:2048
buffer_load_dwordx4 v[108:111], v1, s[4:7], s31 offen offset:2048
buffer_load_dwordx4 v[112:115], v1, s[4:7], s32 offen offset:2048
s_waitcnt vmcnt(9)
ds_read_b128 v[136:139], v6 offset:4096
ds_read_b128 v[140:143], v6 offset:24576
ds_read_b128 v[144:147], v7 offset:4096
ds_read_b128 v[148:151], v7 offset:24576
s_waitcnt lgkmcnt(4)
v_mfma_f32_16x16x32_bf16 v[8:11], v[152:155], v[120:123], v[8:11]
v_mfma_f32_16x16x32_bf16 v[12:15], v[156:159], v[120:123], v[12:15]
v_mfma_f32_16x16x32_bf16 v[16:19], v[160:163], v[120:123], v[16:19]
v_mfma_f32_16x16x32_bf16 v[20:23], v[164:167], v[120:123], v[20:23]
v_mfma_f32_16x16x32_bf16 v[24:27], v[152:155], v[124:127], v[24:27]
v_mfma_f32_16x16x32_bf16 v[28:31], v[156:159], v[124:127], v[28:31]
v_mfma_f32_16x16x32_bf16 v[32:35], v[160:163], v[124:127], v[32:35]
v_mfma_f32_16x16x32_bf16 v[36:39], v[164:167], v[124:127], v[36:39]
v_mfma_f32_16x16x32_bf16 v[40:43], v[152:155], v[128:131], v[40:43]
v_mfma_f32_16x16x32_bf16 v[44:47], v[156:159], v[128:131], v[44:47]
v_mfma_f32_16x16x32_bf16 v[48:51], v[160:163], v[128:131], v[48:51]
v_mfma_f32_16x16x32_bf16 v[52:55], v[164:167], v[128:131], v[52:55]
v_add_u32 v6, 4096, v6
v_add_u32 v7, 4096, v7
s_add_u32 s40, s40, 1
s_cmp_lt_u32 s40, 4
s_cbranch_scc1 qkvb_loop9
s_waitcnt vmcnt(0) lgkmcnt(0)
v_and_b32 v2, 63, v0
v_and_b32 v3, 15, v2
v_lshrrev_b32 v4, 4, v2
s_lshl_b32 s41, s17, 19
s_lshl_b32 s42, s18, 12
s_add_u32 s41, s41, s42
s_mov_b32 s46, 0x3ea52b5c
s_mov_b32 s47, 0x3ea52b5c
v_add_u32 v5, 32, v3
v_mul_u32_u24 v168, 205, v5
v_lshrrev_b32 v168, 12, v168
v_mul_u32_u24 v6, 20, v168
v_sub_u32 v5, v5, v6
v_lshlrev_b32 v168, 17, v168
v_lshl_add_u32 v168, v5, 4, v168
v_and_b32 v6, 1, v4
v_lshl_add_u32 v168, v6, 9, v168
v_lshrrev_b32 v6, 1, v4
v_lshl_add_u32 v168, v6, 3, v168
v_add_u32 v5, 48, v3
v_mul_u32_u24 v169, 205, v5
v_lshrrev_b32 v169, 12, v169
v_mul_u32_u24 v6, 20, v169
v_sub_u32 v5, v5, v6
v_lshlrev_b32 v169, 17, v169
v_lshl_add_u32 v169, v5, 4, v169
v_and_b32 v6, 1, v4
v_lshl_add_u32 v169, v6, 9, v169
v_lshrrev_b32 v6, 1, v4
v_lshl_add_u32 v169, v6, 3, v169
v_add_u32 v5, 64, v3
v_mul_u32_u24 v170, 205, v5
v_lshrrev_b32 v170, 12, v170
v_mul_u32_u24 v6, 20, v170
v_sub_u32 v5, v5, v6
v_lshlrev_b32 v170, 17, v170
v_lshl_add_u32 v170, v5, 4, v170
v_and_b32 v6, 1, v4
v_lshl_add_u32 v170, v6, 9, v170
v_lshrrev_b32 v6, 1, v4
v_lshl_add_u32 v170, v6, 3, v170
v_cvt_pk_bf16_f32 v136, v8, v9
v_cvt_pk_bf16_f32 v137, v10, v11
s_add_u32 s43, s41, 46137344
buffer_store_dwordx2 v[136:137], v168, s[4:7], s43 offen sc1
v_cvt_pk_bf16_f32 v138, v12, v13
v_cvt_pk_bf16_f32 v139, v14, v15
s_add_u32 s43, s41, 46138368
buffer_store_dwordx2 v[138:139], v168, s[4:7], s43 offen sc1
v_cvt_pk_bf16_f32 v140, v16, v17
v_cvt_pk_bf16_f32 v141, v18, v19
s_add_u32 s43, s41, 46139392
buffer_store_dwordx2 v[140:141], v168, s[4:7], s43 offen sc1
v_cvt_pk_bf16_f32 v142, v20, v21
v_cvt_pk_bf16_f32 v143, v22, v23
s_add_u32 s43, s41, 46140416
buffer_store_dwordx2 v[142:143], v168, s[4:7], s43 offen sc1
v_cvt_pk_bf16_f32 v144, v24, v25
v_cvt_pk_bf16_f32 v145, v26, v27
s_add_u32 s43, s41, 46137344
buffer_store_dwordx2 v[144:145], v169, s[4:7], s43 offen sc1
v_cvt_pk_bf16_f32 v146, v28, v29
v_cvt_pk_bf16_f32 v147, v30, v31
s_add_u32 s43, s41, 46138368
buffer_store_dwordx2 v[146:147], v169, s[4:7], s43 offen sc1
v_cvt_pk_bf16_f32 v148, v32, v33
v_cvt_pk_bf16_f32 v149, v34, v35
s_add_u32 s43, s41, 46139392
buffer_store_dwordx2 v[148:149], v169, s[4:7], s43 offen sc1
v_cvt_pk_bf16_f32 v150, v36, v37
v_cvt_pk_bf16_f32 v151, v38, v39
s_add_u32 s43, s41, 46140416
buffer_store_dwordx2 v[150:151], v169, s[4:7], s43 offen sc1
v_cvt_pk_bf16_f32 v136, v40, v41
v_cvt_pk_bf16_f32 v137, v42, v43
s_add_u32 s43, s41, 46137344
buffer_store_dwordx2 v[136:137], v170, s[4:7], s43 offen sc1
v_cvt_pk_bf16_f32 v138, v44, v45
v_cvt_pk_bf16_f32 v139, v46, v47
s_add_u32 s43, s41, 46138368
buffer_store_dwordx2 v[138:139], v170, s[4:7], s43 offen sc1
v_cvt_pk_bf16_f32 v140, v48, v49
v_cvt_pk_bf16_f32 v141, v50, v51
s_add_u32 s43, s41, 46139392
buffer_store_dwordx2 v[140:141], v170, s[4:7], s43 offen sc1
v_cvt_pk_bf16_f32 v142, v52, v53
v_cvt_pk_bf16_f32 v143, v54, v55
s_add_u32 s43, s41, 46140416
buffer_store_dwordx2 v[142:143], v170, s[4:7], s43 offen sc1
v_mov_b32 v72, 0
v_mov_b32 v73, 0
v_mov_b32 v74, 0
v_mov_b32 v75, 0
v_lshlrev_b32 v5, 17, v4
v_lshl_add_u32 v5, v3, 4, v5
v_add_u32 v6, 1032, v5
v_add_u32 v7, 1536, v5
s_add_u32 s43, s41, 37748736
buffer_store_dwordx2 v[72:73], v6, s[4:7], s43 offen sc1
buffer_store_dwordx4 v[72:75], v7, s[4:7], s43 offen sc1
s_add_u32 s43, s41, 37748992
buffer_store_dwordx2 v[72:73], v6, s[4:7], s43 offen sc1
buffer_store_dwordx4 v[72:75], v7, s[4:7], s43 offen sc1
s_add_u32 s43, s41, 37750784
buffer_store_dwordx2 v[72:73], v6, s[4:7], s43 offen sc1
buffer_store_dwordx4 v[72:75], v7, s[4:7], s43 offen sc1
s_add_u32 s43, s41, 37751040
buffer_store_dwordx2 v[72:73], v6, s[4:7], s43 offen sc1
buffer_store_dwordx4 v[72:75], v7, s[4:7], s43 offen sc1
s_add_u32 s43, s41, 41943040
buffer_store_dwordx2 v[72:73], v6, s[4:7], s43 offen sc1
buffer_store_dwordx4 v[72:75], v7, s[4:7], s43 offen sc1
s_add_u32 s43, s41, 41943296
buffer_store_dwordx2 v[72:73], v6, s[4:7], s43 offen sc1
buffer_store_dwordx4 v[72:75], v7, s[4:7], s43 offen sc1
s_add_u32 s43, s41, 41945088
buffer_store_dwordx2 v[72:73], v6, s[4:7], s43 offen sc1
buffer_store_dwordx4 v[72:75], v7, s[4:7], s43 offen sc1
s_add_u32 s43, s41, 41945344
buffer_store_dwordx2 v[72:73], v6, s[4:7], s43 offen sc1
buffer_store_dwordx4 v[72:75], v7, s[4:7], s43 offen sc1
v_and_b32 v6, 1, v4
v_lshlrev_b32 v6, 9, v6
v_add_u32 v5, 20, v3
v_lshl_add_u32 v6, v5, 4, v6
v_lshrrev_b32 v5, 1, v4
v_lshl_add_u32 v6, v5, 17, v6
v_mov_b32 v5, 0x80000000
v_cmp_gt_u32 vcc, 12, v3
s_nop 1
v_cndmask_b32 v6, v5, v6, vcc
v_cmp_eq_u32 vcc, 0, v3
v_mov_b32 v5, 0x3f803f80
s_nop 0
v_cndmask_b32 v76, 0, v5, vcc
v_mov_b32 v77, v76
v_mov_b32 v78, v76
v_mov_b32 v79, v76
s_add_u32 s43, s41, 46137344
buffer_store_dwordx4 v[76:79], v6, s[4:7], s43 offen sc1
s_add_u32 s43, s41, 46138368
buffer_store_dwordx4 v[76:79], v6, s[4:7], s43 offen sc1
s_add_u32 s43, s41, 46139392
buffer_store_dwordx4 v[76:79], v6, s[4:7], s43 offen sc1
s_add_u32 s43, s41, 46140416
buffer_store_dwordx4 v[76:79], v6, s[4:7], s43 offen sc1
s_add_u32 s43, s41, 46399488
buffer_store_dwordx4 v[76:79], v6, s[4:7], s43 offen sc1
s_add_u32 s43, s41, 46400512
buffer_store_dwordx4 v[76:79], v6, s[4:7], s43 offen sc1
s_add_u32 s43, s41, 46401536
buffer_store_dwordx4 v[76:79], v6, s[4:7], s43 offen sc1
s_add_u32 s43, s41, 46402560
buffer_store_dwordx4 v[76:79], v6, s[4:7], s43 offen sc1
s_branch qkvb_exit1
qkvb_exit1:
s_endpgm
.globl attnb_kernel
.p2align 8
.type attnb_kernel,@function
attnb_kernel:
s_cmp_ge_u32 s2, 256
s_cbranch_scc1 attnb_exit1
s_load_dwordx2 s[12:13], s[0:1], 96
v_lshrrev_b32 v2, 6, v0
v_and_b32 v3, 63, v0
s_nop 0
v_readfirstlane_b32 s16, v2
v_lshlrev_b32 v1, 4, v3
s_and_b32 s17, s2, 7
s_lshl_b32 s17, s17, 2
s_lshr_b32 s18, s2, 3
s_and_b32 s19, s18, 3
s_add_u32 s17, s17, s19
s_lshr_b32 s18, s18, 2
s_waitcnt lgkmcnt(0)
s_mov_b32 s4, s12
s_mov_b32 s5, s13
s_mov_b32 s6, 0x10000000
s_mov_b32 s7, 0x20000
s_lshl_b32 s20, s17, 17
s_add_u32 s21, s20, 41943040
s_add_u32 s22, s20, 46137344
s_lshl_b32 s23, s18, 3
s_lshl_b32 s24, s16, 1
s_add_u32 s23, s23, s24
s_lshl_b32 s24, s23, 11
s_add_u32 s24, s24, s20
s_add_u32 s24, s24, 37748736
buffer_load_dwordx4 v[8:11], v1, s[4:7], s24 offen offset:0
buffer_load_dwordx4 v[12:15], v1, s[4:7], s24 offen offset:1024
buffer_load_dwordx4 v[16:19], v1, s[4:7], s24 offen offset:2048
buffer_load_dwordx4 v[20:23], v1, s[4:7], s24 offen offset:3072
s_mov_b32 s25, s21
s_mov_b32 s26, s22
buffer_load_dwordx4 v[136:139], v1, s[4:7], s25 offen
buffer_load_dwordx4 v[140:143], v1, s[4:7], s25 offen offset:1024
buffer_load_dwordx4 v[144:147], v1, s[4:7], s26 offen
buffer_load_dwordx4 v[148:151], v1, s[4:7], s26 offen offset:1024
s_add_u32 s25, s25, 2048
s_add_u32 s26, s26, 2048
s_waitcnt vmcnt(0)
v_mfma_f32_32x32x16_bf16 v[88:103], v[136:139], v[8:11], 0
v_mfma_f32_32x32x16_bf16 v[88:103], v[140:143], v[12:15], v[88:103]
v_mfma_f32_32x32x16_bf16 v[104:119], v[136:139], v[16:19], 0
v_mfma_f32_32x32x16_bf16 v[104:119], v[140:143], v[20:23], v[104:119]
s_nop 9
v_max3_f32 v2, v88, v89, v90
v_max3_f32 v2, v2, v91, v92
v_max3_f32 v2, v2, v93, v94
v_max3_f32 v2, v2, v95, v96
v_max3_f32 v2, v2, v97, v98
v_max3_f32 v2, v2, v99, v100
v_max3_f32 v2, v2, v101, v102
v_max_f32 v2, v2, v103
v_mov_b32 v4, v2
s_nop 1
v_permlane32_swap_b32 v2, v4
v_max_f32 v2, v2, v4
v_sub_f32 v24, 0, v2
v_sub_f32 v25, 0, v2
v_sub_f32 v26, 0, v2
v_sub_f32 v27, 0, v2
v_sub_f32 v28, 0, v2
v_sub_f32 v29, 0, v2
v_sub_f32 v30, 0, v2
v_sub_f32 v31, 0, v2
v_sub_f32 v32, 0, v2
v_sub_f32 v33, 0, v2
v_sub_f32 v34, 0, v2
v_sub_f32 v35, 0, v2
v_sub_f32 v36, 0, v2
v_sub_f32 v37, 0, v2
v_sub_f32 v38, 0, v2
v_sub_f32 v39, 0, v2
v_max3_f32 v3, v104, v105, v106
v_max3_f32 v3, v3, v107, v108
v_max3_f32 v3, v3, v109, v110
v_max3_f32 v3, v3, v111, v112
v_max3_f32 v3, v3, v113, v114
v_max3_f32 v3, v3, v115, v116
v_max3_f32 v3, v3, v117, v118
v_max_f32 v3, v3, v119
v_mov_b32 v4, v3
s_nop 1
v_permlane32_swap_b32 v3, v4
v_max_f32 v3, v3, v4
v_sub_f32 v40, 0, v3
v_sub_f32 v41, 0, v3
v_sub_f32 v42, 0, v3
v_sub_f32 v43, 0, v3
v_sub_f32 v44, 0, v3
v_sub_f32 v45, 0, v3
v_sub_f32 v46, 0, v3
v_sub_f32 v47, 0, v3
v_sub_f32 v48, 0, v3
v_sub_f32 v49, 0, v3
v_sub_f32 v50, 0, v3
v_sub_f32 v51, 0, v3
v_sub_f32 v52, 0, v3
v_sub_f32 v53, 0, v3
v_sub_f32 v54, 0, v3
v_sub_f32 v55, 0, v3
s_mov_b32 s28, 0
attnb_main2:
s_mov_b32 s25, s21
s_mov_b32 s26, s22
buffer_load_dwordx4 v[136:139], v1, s[4:7], s25 offen
buffer_load_dwordx4 v[140:143], v1, s[4:7], s25 offen offset:1024
buffer_load_dwordx4 v[144:147], v1, s[4:7], s26 offen
buffer_load_dwordx4 v[148:151], v1, s[4:7], s26 offen offset:1024
s_add_u32 s25, s25, 2048
s_add_u32 s26, s26, 2048
buffer_load_dwordx4 v[152:155], v1, s[4:7], s25 offen
buffer_load_dwordx4 v[156:159], v1, s[4:7], s25 offen offset:1024
buffer_load_dwordx4 v[160:163], v1, s[4:7], s26 offen
buffer_load_dwordx4 v[164:167], v1, s[4:7], s26 offen offset:1024
s_add_u32 s25, s25, 2048
s_add_u32 s26, s26, 2048
v_mov_b32 v56, 0
v_mov_b32 v57, 0
v_mov_b32 v58, 0
v_mov_b32 v59, 0
v_mov_b32 v60, 0
v_mov_b32 v61, 0
v_mov_b32 v62, 0
v_mov_b32 v63, 0
v_mov_b32 v64, 0
v_mov_b32 v65, 0
v_mov_b32 v66, 0
v_mov_b32 v67, 0
v_mov_b32 v68, 0
v_mov_b32 v69, 0
v_mov_b32 v70, 0
v_mov_b32 v71, 0
v_mov_b32 v72, 0
v_mov_b32 v73, 0
v_mov_b32 v74, 0
v_mov_b32 v75, 0
v_mov_b32 v76, 0
v_mov_b32 v77, 0
v_mov_b32 v78, 0
v_mov_b32 v79, 0
v_mov_b32 v80, 0
v_mov_b32 v81, 0
v_mov_b32 v82, 0
v_mov_b32 v83, 0
v_mov_b32 v84, 0
v_mov_b32 v85, 0
v_mov_b32 v86, 0
v_mov_b32 v87, 0
s_waitcnt vmcnt(4)
v_mfma_f32_32x32x16_bf16 v[88:103], v[136:139], v[8:11], v[24:39]
v_mfma_f32_32x32x16_bf16 v[88:103], v[140:143], v[12:15], v[88:103]
s_nop 11
v_exp_f32 v88, v88
v_exp_f32 v89, v89
v_exp_f32 v90, v90
v_exp_f32 v91, v91
v_exp_f32 v92, v92
v_exp_f32 v93, v93
v_exp_f32 v94, v94
v_exp_f32 v95, v95
v_mfma_f32_32x32x16_bf16 v[104:119], v[136:139], v[16:19], v[40:55]
v_cvt_pk_bf16_f32 v120, v88, v89
v_cvt_pk_bf16_f32 v121, v90, v91
v_cvt_pk_bf16_f32 v122, v92, v93
v_cvt_pk_bf16_f32 v123, v94, v95
v_exp_f32 v96, v96
v_exp_f32 v97, v97
v_mfma_f32_32x32x16_bf16 v[104:119], v[140:143], v[20:23], v[104:119]
v_exp_f32 v98, v98
v_exp_f32 v99, v99
v_exp_f32 v100, v100
v_exp_f32 v101, v101
v_mfma_f32_32x32x16_bf16 v[56:71], v[144:147], v[120:123], v[56:71]
v_exp_f32 v102, v102
v_exp_f32 v103, v103
v_cvt_pk_bf16_f32 v124, v96, v97
v_cvt_pk_bf16_f32 v125, v98, v99
v_cvt_pk_bf16_f32 v126, v100, v101
v_cvt_pk_bf16_f32 v127, v102, v103
buffer_load_dwordx4 v[168:171], v1, s[4:7], s25 offen
buffer_load_dwordx4 v[172:175], v1, s[4:7], s25 offen offset:1024
buffer_load_dwordx4 v[176:179], v1, s[4:7], s26 offen
buffer_load_dwordx4 v[180:183], v1, s[4:7], s26 offen offset:1024
s_add_u32 s25, s25, 2048
s_add_u32 s26, s26, 2048
s_waitcnt vmcnt(4)
v_exp_f32 v104, v104
v_exp_f32 v105, v105
v_exp_f32 v106, v106
v_exp_f32 v107, v107
v_mfma_f32_32x32x16_bf16 v[56:71], v[148:151], v[124:127], v[56:71]
v_exp_f32 v108, v108
v_exp_f32 v109, v109
v_exp_f32 v110, v110
v_exp_f32 v111, v111
v_mfma_f32_32x32x16_bf16 v[88:103], v[152:155], v[8:11], v[24:39]
v_cvt_pk_bf16_f32 v128, v104, v105
v_cvt_pk_bf16_f32 v129, v106, v107
v_cvt_pk_bf16_f32 v130, v108, v109
v_cvt_pk_bf16_f32 v131, v110, v111
v_exp_f32 v112, v112
v_exp_f32 v113, v113
v_mfma_f32_32x32x16_bf16 v[88:103], v[156:159], v[12:15], v[88:103]
v_exp_f32 v114, v114
v_exp_f32 v115, v115
v_exp_f32 v116, v116
v_exp_f32 v117, v117
v_mfma_f32_32x32x16_bf16 v[72:87], v[144:147], v[128:131], v[72:87]
v_exp_f32 v118, v118
v_exp_f32 v119, v119
v_cvt_pk_bf16_f32 v132, v112, v113
v_cvt_pk_bf16_f32 v133, v114, v115
v_cvt_pk_bf16_f32 v134, v116, v117
v_cvt_pk_bf16_f32 v135, v118, v119
s_mov_b32 s27, 0
attnb_loop3:
v_exp_f32 v88, v88
v_exp_f32 v89, v89
v_exp_f32 v90, v90
v_exp_f32 v91, v91
v_mfma_f32_32x32x16_bf16 v[72:87], v[148:151], v[132:135], v[72:87]
v_exp_f32 v92, v92
v_exp_f32 v93, v93
v_exp_f32 v94, v94
v_exp_f32 v95, v95
v_mfma_f32_32x32x16_bf16 v[104:119], v[152:155], v[16:19], v[40:55]
v_cvt_pk_bf16_f32 v120, v88, v89
v_cvt_pk_bf16_f32 v121, v90, v91
v_cvt_pk_bf16_f32 v122, v92, v93
v_cvt_pk_bf16_f32 v123, v94, v95
v_exp_f32 v96, v96
v_exp_f32 v97, v97
v_mfma_f32_32x32x16_bf16 v[104:119], v[156:159], v[20:23], v[104:119]
v_exp_f32 v98, v98
v_exp_f32 v99, v99
v_exp_f32 v100, v100
v_exp_f32 v101, v101
v_mfma_f32_32x32x16_bf16 v[56:71], v[160:163], v[120:123], v[56:71]
v_exp_f32 v102, v102
v_exp_f32 v103, v103
v_cvt_pk_bf16_f32 v124, v96, v97
v_cvt_pk_bf16_f32 v125, v98, v99
v_cvt_pk_bf16_f32 v126, v100, v101
v_cvt_pk_bf16_f32 v127, v102, v103
buffer_load_dwordx4 v[136:139], v1, s[4:7], s25 offen
buffer_load_dwordx4 v[140:143], v1, s[4:7], s25 offen offset:1024
buffer_load_dwordx4 v[144:147], v1, s[4:7], s26 offen
buffer_load_dwordx4 v[148:151], v1, s[4:7], s26 offen offset:1024
s_add_u32 s25, s25, 2048
s_add_u32 s26, s26, 2048
s_waitcnt vmcnt(4)
v_exp_f32 v104, v104
v_exp_f32 v105, v105
v_exp_f32 v106, v106
v_exp_f32 v107, v107
v_mfma_f32_32x32x16_bf16 v[56:71], v[164:167], v[124:127], v[56:71]
v_exp_f32 v108, v108
v_exp_f32 v109, v109
v_exp_f32 v110, v110
v_exp_f32 v111, v111
v_mfma_f32_32x32x16_bf16 v[88:103], v[168:171], v[8:11], v[24:39]
v_cvt_pk_bf16_f32 v128, v104, v105
v_cvt_pk_bf16_f32 v129, v106, v107
v_cvt_pk_bf16_f32 v130, v108, v109
v_cvt_pk_bf16_f32 v131, v110, v111
v_exp_f32 v112, v112
v_exp_f32 v113, v113
v_mfma_f32_32x32x16_bf16 v[88:103], v[172:175], v[12:15], v[88:103]
v_exp_f32 v114, v114
v_exp_f32 v115, v115
v_exp_f32 v116, v116
v_exp_f32 v117, v117
v_mfma_f32_32x32x16_bf16 v[72:87], v[160:163], v[128:131], v[72:87]
v_exp_f32 v118, v118
v_exp_f32 v119, v119
v_cvt_pk_bf16_f32 v132, v112, v113
v_cvt_pk_bf16_f32 v133, v114, v115
v_cvt_pk_bf16_f32 v134, v116, v117
v_cvt_pk_bf16_f32 v135, v118, v119
s_nop 0
v_exp_f32 v88, v88
v_exp_f32 v89, v89
v_exp_f32 v90, v90
v_exp_f32 v91, v91
v_mfma_f32_32x32x16_bf16 v[72:87], v[164:167], v[132:135], v[72:87]
v_exp_f32 v92, v92
v_exp_f32 v93, v93
v_exp_f32 v94, v94
v_exp_f32 v95, v95
v_mfma_f32_32x32x16_bf16 v[104:119], v[168:171], v[16:19], v[40:55]
v_cvt_pk_bf16_f32 v120, v88, v89
v_cvt_pk_bf16_f32 v121, v90, v91
v_cvt_pk_bf16_f32 v122, v92, v93
v_cvt_pk_bf16_f32 v123, v94, v95
v_exp_f32 v96, v96
v_exp_f32 v97, v97
v_mfma_f32_32x32x16_bf16 v[104:119], v[172:175], v[20:23], v[104:119]
v_exp_f32 v98, v98
v_exp_f32 v99, v99
v_exp_f32 v100, v100
v_exp_f32 v101, v101
v_mfma_f32_32x32x16_bf16 v[56:71], v[176:179], v[120:123], v[56:71]
v_exp_f32 v102, v102
v_exp_f32 v103, v103
v_cvt_pk_bf16_f32 v124, v96, v97
v_cvt_pk_bf16_f32 v125, v98, v99
v_cvt_pk_bf16_f32 v126, v100, v101
v_cvt_pk_bf16_f32 v127, v102, v103
buffer_load_dwordx4 v[152:155], v1, s[4:7], s25 offen
buffer_load_dwordx4 v[156:159], v1, s[4:7], s25 offen offset:1024
buffer_load_dwordx4 v[160:163], v1, s[4:7], s26 offen
buffer_load_dwordx4 v[164:167], v1, s[4:7], s26 offen offset:1024
s_add_u32 s25, s25, 2048
s_add_u32 s26, s26, 2048
s_waitcnt vmcnt(4)
v_exp_f32 v104, v104
v_exp_f32 v105, v105
v_exp_f32 v106, v106
v_exp_f32 v107, v107
v_mfma_f32_32x32x16_bf16 v[56:71], v[180:183], v[124:127], v[56:71]
v_exp_f32 v108, v108
v_exp_f32 v109, v109
v_exp_f32 v110, v110
v_exp_f32 v111, v111
v_mfma_f32_32x32x16_bf16 v[88:103], v[136:139], v[8:11], v[24:39]
v_cvt_pk_bf16_f32 v128, v104, v105
v_cvt_pk_bf16_f32 v129, v106, v107
v_cvt_pk_bf16_f32 v130, v108, v109
v_cvt_pk_bf16_f32 v131, v110, v111
v_exp_f32 v112, v112
v_exp_f32 v113, v113
v_mfma_f32_32x32x16_bf16 v[88:103], v[140:143], v[12:15], v[88:103]
v_exp_f32 v114, v114
v_exp_f32 v115, v115
v_exp_f32 v116, v116
v_exp_f32 v117, v117
v_mfma_f32_32x32x16_bf16 v[72:87], v[176:179], v[128:131], v[72:87]
v_exp_f32 v118, v118
v_exp_f32 v119, v119
v_cvt_pk_bf16_f32 v132, v112, v113
v_cvt_pk_bf16_f32 v133, v114, v115
v_cvt_pk_bf16_f32 v134, v116, v117
v_cvt_pk_bf16_f32 v135, v118, v119
s_nop 0
v_exp_f32 v88, v88
v_exp_f32 v89, v89
v_exp_f32 v90, v90
v_exp_f32 v91, v91
v_mfma_f32_32x32x16_bf16 v[72:87], v[180:183], v[132:135], v[72:87]
v_exp_f32 v92, v92
v_exp_f32 v93, v93
v_exp_f32 v94, v94
v_exp_f32 v95, v95
v_mfma_f32_32x32x16_bf16 v[104:119], v[136:139], v[16:19], v[40:55]
v_cvt_pk_bf16_f32 v120, v88, v89
v_cvt_pk_bf16_f32 v121, v90, v91
v_cvt_pk_bf16_f32 v122, v92, v93
v_cvt_pk_bf16_f32 v123, v94, v95
v_exp_f32 v96, v96
v_exp_f32 v97, v97
v_mfma_f32_32x32x16_bf16 v[104:119], v[140:143], v[20:23], v[104:119]
v_exp_f32 v98, v98
v_exp_f32 v99, v99
v_exp_f32 v100, v100
v_exp_f32 v101, v101
v_mfma_f32_32x32x16_bf16 v[56:71], v[144:147], v[120:123], v[56:71]
v_exp_f32 v102, v102
v_exp_f32 v103, v103
v_cvt_pk_bf16_f32 v124, v96, v97
v_cvt_pk_bf16_f32 v125, v98, v99
v_cvt_pk_bf16_f32 v126, v100, v101
v_cvt_pk_bf16_f32 v127, v102, v103
buffer_load_dwordx4 v[168:171], v1, s[4:7], s25 offen
buffer_load_dwordx4 v[172:175], v1, s[4:7], s25 offen offset:1024
buffer_load_dwordx4 v[176:179], v1, s[4:7], s26 offen
buffer_load_dwordx4 v[180:183], v1, s[4:7], s26 offen offset:1024
s_add_u32 s25, s25, 2048
s_add_u32 s26, s26, 2048
s_waitcnt vmcnt(4)
v_exp_f32 v104, v104
v_exp_f32 v105, v105
v_exp_f32 v106, v106
v_exp_f32 v107, v107
v_mfma_f32_32x32x16_bf16 v[56:71], v[148:151], v[124:127], v[56:71]
v_exp_f32 v108, v108
v_exp_f32 v109, v109
v_exp_f32 v110, v110
v_exp_f32 v111, v111
v_mfma_f32_32x32x16_bf16 v[88:103], v[152:155], v[8:11], v[24:39]
v_cvt_pk_bf16_f32 v128, v104, v105
v_cvt_pk_bf16_f32 v129, v106, v107
v_cvt_pk_bf16_f32 v130, v108, v109
v_cvt_pk_bf16_f32 v131, v110, v111
v_exp_f32 v112, v112
v_exp_f32 v113, v113
v_mfma_f32_32x32x16_bf16 v[88:103], v[156:159], v[12:15], v[88:103]
v_exp_f32 v114, v114
v_exp_f32 v115, v115
v_exp_f32 v116, v116
v_exp_f32 v117, v117
v_mfma_f32_32x32x16_bf16 v[72:87], v[144:147], v[128:131], v[72:87]
v_exp_f32 v118, v118
v_exp_f32 v119, v119
v_cvt_pk_bf16_f32 v132, v112, v113
v_cvt_pk_bf16_f32 v133, v114, v115
v_cvt_pk_bf16_f32 v134, v116, v117
v_cvt_pk_bf16_f32 v135, v118, v119
s_add_u32 s27, s27, 1
s_cmp_lt_u32 s27, 20
s_cbranch_scc1 attnb_loop3
v_exp_f32 v88, v88
v_exp_f32 v89, v89
v_exp_f32 v90, v90
v_exp_f32 v91, v91
v_mfma_f32_32x32x16_bf16 v[72:87], v[148:151], v[132:135], v[72:87]
v_exp_f32 v92, v92
v_exp_f32 v93, v93
v_exp_f32 v94, v94
v_exp_f32 v95, v95
v_mfma_f32_32x32x16_bf16 v[104:119], v[152:155], v[16:19], v[40:55]
v_cvt_pk_bf16_f32 v120, v88, v89
v_cvt_pk_bf16_f32 v121, v90, v91
v_cvt_pk_bf16_f32 v122, v92, v93
v_cvt_pk_bf16_f32 v123, v94, v95
v_exp_f32 v96, v96
v_exp_f32 v97, v97
v_mfma_f32_32x32x16_bf16 v[104:119], v[156:159], v[20:23], v[104:119]
v_exp_f32 v98, v98
v_exp_f32 v99, v99
v_exp_f32 v100, v100
v_exp_f32 v101, v101
v_mfma_f32_32x32x16_bf16 v[56:71], v[160:163], v[120:123], v[56:71]
v_exp_f32 v102, v102
v_exp_f32 v103, v103
v_cvt_pk_bf16_f32 v124, v96, v97
v_cvt_pk_bf16_f32 v125, v98, v99
v_cvt_pk_bf16_f32 v126, v100, v101
v_cvt_pk_bf16_f32 v127, v102, v103
buffer_load_dwordx4 v[136:139], v1, s[4:7], s25 offen
buffer_load_dwordx4 v[140:143], v1, s[4:7], s25 offen offset:1024
buffer_load_dwordx4 v[144:147], v1, s[4:7], s26 offen
buffer_load_dwordx4 v[148:151], v1, s[4:7], s26 offen offset:1024
s_add_u32 s25, s25, 2048
s_add_u32 s26, s26, 2048
s_waitcnt vmcnt(4)
v_exp_f32 v104, v104
v_exp_f32 v105, v105
v_exp_f32 v106, v106
v_exp_f32 v107, v107
v_mfma_f32_32x32x16_bf16 v[56:71], v[164:167], v[124:127], v[56:71]
v_exp_f32 v108, v108
v_exp_f32 v109, v109
v_exp_f32 v110, v110
v_exp_f32 v111, v111
v_mfma_f32_32x32x16_bf16 v[88:103], v[168:171], v[8:11], v[24:39]
v_cvt_pk_bf16_f32 v128, v104, v105
v_cvt_pk_bf16_f32 v129, v106, v107
v_cvt_pk_bf16_f32 v130, v108, v109
v_cvt_pk_bf16_f32 v131, v110, v111
v_exp_f32 v112, v112
v_exp_f32 v113, v113
v_mfma_f32_32x32x16_bf16 v[88:103], v[172:175], v[12:15], v[88:103]
v_exp_f32 v114, v114
v_exp_f32 v115, v115
v_exp_f32 v116, v116
v_exp_f32 v117, v117
v_mfma_f32_32x32x16_bf16 v[72:87], v[160:163], v[128:131], v[72:87]
v_exp_f32 v118, v118
v_exp_f32 v119, v119
v_cvt_pk_bf16_f32 v132, v112, v113
v_cvt_pk_bf16_f32 v133, v114, v115
v_cvt_pk_bf16_f32 v134, v116, v117
v_cvt_pk_bf16_f32 v135, v118, v119
s_nop 0
v_exp_f32 v88, v88
v_exp_f32 v89, v89
v_exp_f32 v90, v90
v_exp_f32 v91, v91
v_mfma_f32_32x32x16_bf16 v[72:87], v[164:167], v[132:135], v[72:87]
v_exp_f32 v92, v92
v_exp_f32 v93, v93
v_exp_f32 v94, v94
v_exp_f32 v95, v95
v_mfma_f32_32x32x16_bf16 v[104:119], v[168:171], v[16:19], v[40:55]
v_cvt_pk_bf16_f32 v120, v88, v89
v_cvt_pk_bf16_f32 v121, v90, v91
v_cvt_pk_bf16_f32 v122, v92, v93
v_cvt_pk_bf16_f32 v123, v94, v95
v_exp_f32 v96, v96
v_exp_f32 v97, v97
v_mfma_f32_32x32x16_bf16 v[104:119], v[172:175], v[20:23], v[104:119]
v_exp_f32 v98, v98
v_exp_f32 v99, v99
v_exp_f32 v100, v100
v_exp_f32 v101, v101
v_mfma_f32_32x32x16_bf16 v[56:71], v[176:179], v[120:123], v[56:71]
v_exp_f32 v102, v102
v_exp_f32 v103, v103
v_cvt_pk_bf16_f32 v124, v96, v97
v_cvt_pk_bf16_f32 v125, v98, v99
v_cvt_pk_bf16_f32 v126, v100, v101
v_cvt_pk_bf16_f32 v127, v102, v103
s_waitcnt vmcnt(0)
v_exp_f32 v104, v104
v_exp_f32 v105, v105
v_exp_f32 v106, v106
v_exp_f32 v107, v107
v_mfma_f32_32x32x16_bf16 v[56:71], v[180:183], v[124:127], v[56:71]
v_exp_f32 v108, v108
v_exp_f32 v109, v109
v_exp_f32 v110, v110
v_exp_f32 v111, v111
v_mfma_f32_32x32x16_bf16 v[88:103], v[136:139], v[8:11], v[24:39]
v_cvt_pk_bf16_f32 v128, v104, v105
v_cvt_pk_bf16_f32 v129, v106, v107
v_cvt_pk_bf16_f32 v130, v108, v109
v_cvt_pk_bf16_f32 v131, v110, v111
v_exp_f32 v112, v112
v_exp_f32 v113, v113
v_mfma_f32_32x32x16_bf16 v[88:103], v[140:143], v[12:15], v[88:103]
v_exp_f32 v114, v114
v_exp_f32 v115, v115
v_exp_f32 v116, v116
v_exp_f32 v117, v117
v_mfma_f32_32x32x16_bf16 v[72:87], v[176:179], v[128:131], v[72:87]
v_exp_f32 v118, v118
v_exp_f32 v119, v119
v_cvt_pk_bf16_f32 v132, v112, v113
v_cvt_pk_bf16_f32 v133, v114, v115
v_cvt_pk_bf16_f32 v134, v116, v117
v_cvt_pk_bf16_f32 v135, v118, v119
s_nop 0
v_exp_f32 v88, v88
v_exp_f32 v89, v89
v_exp_f32 v90, v90
v_exp_f32 v91, v91
v_mfma_f32_32x32x16_bf16 v[72:87], v[180:183], v[132:135], v[72:87]
v_exp_f32 v92, v92
v_exp_f32 v93, v93
v_exp_f32 v94, v94
v_exp_f32 v95, v95
v_mfma_f32_32x32x16_bf16 v[104:119], v[136:139], v[16:19], v[40:55]
v_cvt_pk_bf16_f32 v120, v88, v89
v_cvt_pk_bf16_f32 v121, v90, v91
v_cvt_pk_bf16_f32 v122, v92, v93
v_cvt_pk_bf16_f32 v123, v94, v95
v_exp_f32 v96, v96
v_exp_f32 v97, v97
v_mfma_f32_32x32x16_bf16 v[104:119], v[140:143], v[20:23], v[104:119]
v_exp_f32 v98, v98
v_exp_f32 v99, v99
v_exp_f32 v100, v100
v_exp_f32 v101, v101
v_mfma_f32_32x32x16_bf16 v[56:71], v[144:147], v[120:123], v[56:71]
v_exp_f32 v102, v102
v_exp_f32 v103, v103
v_cvt_pk_bf16_f32 v124, v96, v97
v_cvt_pk_bf16_f32 v125, v98, v99
v_cvt_pk_bf16_f32 v126, v100, v101
v_cvt_pk_bf16_f32 v127, v102, v103
s_nop 0
v_exp_f32 v104, v104
v_exp_f32 v105, v105
v_exp_f32 v106, v106
v_exp_f32 v107, v107
v_mfma_f32_32x32x16_bf16 v[56:71], v[148:151], v[124:127], v[56:71]
v_exp_f32 v108, v108
v_exp_f32 v109, v109
v_exp_f32 v110, v110
v_exp_f32 v111, v111
v_cvt_pk_bf16_f32 v128, v104, v105
v_cvt_pk_bf16_f32 v129, v106, v107
v_cvt_pk_bf16_f32 v130, v108, v109
v_cvt_pk_bf16_f32 v131, v110, v111
v_exp_f32 v112, v112
v_exp_f32 v113, v113
v_exp_f32 v114, v114
v_exp_f32 v115, v115
v_exp_f32 v116, v116
v_exp_f32 v117, v117
v_mfma_f32_32x32x16_bf16 v[72:87], v[144:147], v[128:131], v[72:87]
v_exp_f32 v118, v118
v_exp_f32 v119, v119
v_cvt_pk_bf16_f32 v132, v112, v113
v_cvt_pk_bf16_f32 v133, v114, v115
v_cvt_pk_bf16_f32 v134, v116, v117
v_cvt_pk_bf16_f32 v135, v118, v119
s_nop 1
v_mfma_f32_32x32x16_bf16 v[72:87], v[148:151], v[132:135], v[72:87]
v_mov_b32 v2, v64
v_mov_b32 v4, v2
s_nop 1
v_permlane32_swap_b32 v4, v2
s_nop 6
v_mov_b32 v3, v80
v_mov_b32 v4, v3
s_nop 1
v_permlane32_swap_b32 v4, v3
s_cmp_eq_u32 s28, 1
s_cbranch_scc1 attnb_done5
v_max_f32 v4, v2, v3
v_cmp_nge_f32 vcc, 0x4e800000, v4
v_cmp_u_f32 s[30:31], v2, v3
s_nop 3
s_or_b64 s[32:33], vcc, s[30:31]
s_movk_i32 s34, 0x207
v_cmp_class_f32 vcc, v56, s34
s_nop 3
s_or_b64 s[32:33], s[32:33], vcc
v_cmp_class_f32 vcc, v57, s34
s_nop 3
s_or_b64 s[32:33], s[32:33], vcc
v_cmp_class_f32 vcc, v58, s34
s_nop 3
s_or_b64 s[32:33], s[32:33], vcc
v_cmp_class_f32 vcc, v59, s34
s_nop 3
s_or_b64 s[32:33], s[32:33], vcc
v_cmp_class_f32 vcc, v60, s34
s_nop 3
s_or_b64 s[32:33], s[32:33], vcc
v_cmp_class_f32 vcc, v61, s34
s_nop 3
s_or_b64 s[32:33], s[32:33], vcc
v_cmp_class_f32 vcc, v62, s34
s_nop 3
s_or_b64 s[32:33], s[32:33], vcc
v_cmp_class_f32 vcc, v63, s34
s_nop 3
s_or_b64 s[32:33], s[32:33], vcc
v_cmp_class_f32 vcc, v64, s34
s_nop 3
s_or_b64 s[32:33], s[32:33], vcc
v_cmp_class_f32 vcc, v65, s34
s_nop 3
s_or_b64 s[32:33], s[32:33], vcc
v_cmp_class_f32 vcc, v66, s34
s_nop 3
s_or_b64 s[32:33], s[32:33], vcc
v_cmp_class_f32 vcc, v67, s34
s_nop 3
s_or_b64 s[32:33], s[32:33], vcc
v_cmp_class_f32 vcc, v68, s34
s_nop 3
s_or_b64 s[32:33], s[32:33], vcc
v_cmp_class_f32 vcc, v69, s34
s_nop 3
s_or_b64 s[32:33], s[32:33], vcc
v_cmp_class_f32 vcc, v70, s34
s_nop 3
s_or_b64 s[32:33], s[32:33], vcc
v_cmp_class_f32 vcc, v71, s34
s_nop 3
s_or_b64 s[32:33], s[32:33], vcc
v_cmp_class_f32 vcc, v72, s34
s_nop 3
s_or_b64 s[32:33], s[32:33], vcc
v_cmp_class_f32 vcc, v73, s34
s_nop 3
s_or_b64 s[32:33], s[32:33], vcc
v_cmp_class_f32 vcc, v74, s34
s_nop 3
s_or_b64 s[32:33], s[32:33], vcc
v_cmp_class_f32 vcc, v75, s34
s_nop 3
s_or_b64 s[32:33], s[32:33], vcc
v_cmp_class_f32 vcc, v76, s34
s_nop 3
s_or_b64 s[32:33], s[32:33], vcc
v_cmp_class_f32 vcc, v77, s34
s_nop 3
s_or_b64 s[32:33], s[32:33], vcc
v_cmp_class_f32 vcc, v78, s34
s_nop 3
s_or_b64 s[32:33], s[32:33], vcc
v_cmp_class_f32 vcc, v79, s34
s_nop 3
s_or_b64 s[32:33], s[32:33], vcc
v_cmp_class_f32 vcc, v80, s34
s_nop 3
s_or_b64 s[32:33], s[32:33], vcc
v_cmp_class_f32 vcc, v81, s34
s_nop 3
s_or_b64 s[32:33], s[32:33], vcc
v_cmp_class_f32 vcc, v82, s34
s_nop 3
s_or_b64 s[32:33], s[32:33], vcc
v_cmp_class_f32 vcc, v83, s34
s_nop 3
s_or_b64 s[32:33], s[32:33], vcc
v_cmp_class_f32 vcc, v84, s34
s_nop 3
s_or_b64 s[32:33], s[32:33], vcc
v_cmp_class_f32 vcc, v85, s34
s_nop 3
s_or_b64 s[32:33], s[32:33], vcc
v_cmp_class_f32 vcc, v86, s34
s_nop 3
s_or_b64 s[32:33], s[32:33], vcc
v_cmp_class_f32 vcc, v87, s34
s_nop 3
s_or_b64 s[32:33], s[32:33], vcc
s_mov_b64 vcc, s[32:33]
s_cbranch_vccz attnb_done5
s_mov_b32 s25, s21
s_mov_b32 s27, 0
v_mov_b32 v120, 0xff800000
v_mov_b32 v121, 0xff800000
attnb_fb4:
buffer_load_dwordx4 v[136:139], v1, s[4:7], s25 offen
buffer_load_dwordx4 v[140:143], v1, s[4:7], s25 offen offset:1024
s_add_u32 s25, s25, 2048
s_waitcnt vmcnt(0)
v_mfma_f32_32x32x16_bf16 v[88:103], v[136:139], v[8:11], 0
v_mfma_f32_32x32x16_bf16 v[88:103], v[140:143], v[12:15], v[88:103]
v_mfma_f32_32x32x16_bf16 v[104:119], v[136:139], v[16:19], 0
v_mfma_f32_32x32x16_bf16 v[104:119], v[140:143], v[20:23], v[104:119]
s_nop 9
v_max3_f32 v2, v88, v89, v90
v_max3_f32 v2, v2, v91, v92
v_max3_f32 v2, v2, v93, v94
v_max3_f32 v2, v2, v95, v96
v_max3_f32 v2, v2, v97, v98
v_max3_f32 v2, v2, v99, v100
v_max3_f32 v2, v2, v101, v102
v_max_f32 v2, v2, v103
v_max_f32 v120, v120, v2
s_nop 2
v_max3_f32 v3, v104, v105, v106
v_max3_f32 v3, v3, v107, v108
v_max3_f32 v3, v3, v109, v110
v_max3_f32 v3, v3, v111, v112
v_max3_f32 v3, v3, v113, v114
v_max3_f32 v3, v3, v115, v116
v_max3_f32 v3, v3, v117, v118
v_max_f32 v3, v3, v119
v_max_f32 v121, v121, v3
s_add_u32 s27, s27, 1
s_cmp_lt_u32 s27, 64
s_cbranch_scc1 attnb_fb4
v_mov_b32 v4, v120
s_nop 1
v_permlane32_swap_b32 v120, v4
v_max_f32 v120, v120, v4
v_sub_f32 v24, 0, v120
v_sub_f32 v25, 0, v120
v_sub_f32 v26, 0, v120
v_sub_f32 v27, 0, v120
v_sub_f32 v28, 0, v120
v_sub_f32 v29, 0, v120
v_sub_f32 v30, 0, v120
v_sub_f32 v31, 0, v120
v_sub_f32 v32, 0, v120
v_sub_f32 v33, 0, v120
v_sub_f32 v34, 0, v120
v_sub_f32 v35, 0, v120
v_sub_f32 v36, 0, v120
v_sub_f32 v37, 0, v120
v_sub_f32 v38, 0, v120
v_sub_f32 v39, 0, v120
v_mov_b32 v4, v121
s_nop 1
v_permlane32_swap_b32 v121, v4
v_max_f32 v121, v121, v4
v_sub_f32 v40, 0, v121
v_sub_f32 v41, 0, v121
v_sub_f32 v42, 0, v121
v_sub_f32 v43, 0, v121
v_sub_f32 v44, 0, v121
v_sub_f32 v45, 0, v121
v_sub_f32 v46, 0, v121
v_sub_f32 v47, 0, v121
v_sub_f32 v48, 0, v121
v_sub_f32 v49, 0, v121
v_sub_f32 v50, 0, v121
v_sub_f32 v51, 0, v121
v_sub_f32 v52, 0, v121
v_sub_f32 v53, 0, v121
v_sub_f32 v54, 0, v121
v_sub_f32 v55, 0, v121
s_mov_b32 s28, 1
s_branch attnb_main2
attnb_done5:
v_and_b32 v139, 63, v0
v_lshrrev_b32 v140, 5, v139
v_and_b32 v142, 15, v139
v_lshlrev_b32 v142, 4, v142
v_bfe_u32 v141, v139, 4, 1
v_mul_u32_u24 v141, 20480, v141
v_add_u32 v142, v142, v141
s_mul_i32 s25, s17, 20
v_lshlrev_b32 v140, 2, v140
v_add_u32 v141, s25, v140
v_add_u32 v141, 0, v141
v_lshrrev_b32 v136, 5, v141
v_lshlrev_b32 v136, 10, v136
v_bfe_u32 v139, v141, 3, 2
v_lshl_add_u32 v136, v139, 8, v136
v_bfe_u32 v139, v141, 2, 1
v_lshl_add_u32 v136, v139, 3, v136
v_add_u32 v136, v136, v142
v_add_u32 v141, s25, v140
v_add_u32 v141, 8, v141
v_lshrrev_b32 v137, 5, v141
v_lshlrev_b32 v137, 10, v137
v_bfe_u32 v139, v141, 3, 2
v_lshl_add_u32 v137, v139, 8, v137
v_bfe_u32 v139, v141, 2, 1
v_lshl_add_u32 v137, v139, 3, v137
v_add_u32 v137, v137, v142
v_add_u32 v141, s25, v140
v_add_u32 v141, 16, v141
v_lshrrev_b32 v138, 5, v141
v_lshlrev_b32 v138, 10, v138
v_bfe_u32 v139, v141, 3, 2
v_lshl_add_u32 v138, v139, 8, v138
v_bfe_u32 v139, v141, 2, 1
v_lshl_add_u32 v138, v139, 3, v138
v_add_u32 v138, v138, v142
v_cmp_eq_u32 vcc, 0, v140
v_mov_b32 v139, 0x80000000
s_nop 0
v_cndmask_b32 v138, v139, v138, vcc
s_mul_i32 s24, s23, 40960
s_add_u32 s24, s24, 50331648
v_rcp_f32 v4, v2
s_nop 0
v_mul_f32 v56, v56, v4
v_mul_f32 v57, v57, v4
v_mul_f32 v58, v58, v4
v_mul_f32 v59, v59, v4
v_mul_f32 v60, v60, v4
v_mul_f32 v61, v61, v4
v_mul_f32 v62, v62, v4
v_mul_f32 v63, v63, v4
v_mul_f32 v64, v64, v4
v_mul_f32 v65, v65, v4
v_mul_f32 v66, v66, v4
v_mul_f32 v67, v67, v4
v_cvt_pk_bf16_f32 v120, v56, v57
v_cvt_pk_bf16_f32 v121, v58, v59
v_cvt_pk_bf16_f32 v122, v60, v61
v_cvt_pk_bf16_f32 v123, v62, v63
v_cvt_pk_bf16_f32 v124, v64, v65
v_cvt_pk_bf16_f32 v125, v66, v67
buffer_store_dwordx2 v[120:121], v136, s[4:7], s24 offen sc1
buffer_store_dwordx2 v[122:123], v137, s[4:7], s24 offen sc1
buffer_store_dwordx2 v[124:125], v138, s[4:7], s24 offen sc1
v_rcp_f32 v4, v3
s_nop 0
v_mul_f32 v72, v72, v4
v_mul_f32 v73, v73, v4
v_mul_f32 v74, v74, v4
v_mul_f32 v75, v75, v4
v_mul_f32 v76, v76, v4
v_mul_f32 v77, v77, v4
v_mul_f32 v78, v78, v4
v_mul_f32 v79, v79, v4
v_mul_f32 v80, v80, v4
v_mul_f32 v81, v81, v4
v_mul_f32 v82, v82, v4
v_mul_f32 v83, v83, v4
v_cvt_pk_bf16_f32 v128, v72, v73
v_cvt_pk_bf16_f32 v129, v74, v75
v_cvt_pk_bf16_f32 v130, v76, v77
v_cvt_pk_bf16_f32 v131, v78, v79
v_cvt_pk_bf16_f32 v132, v80, v81
v_cvt_pk_bf16_f32 v133, v82, v83
s_add_u32 s24, s24, 40960
buffer_store_dwordx2 v[128:129], v136, s[4:7], s24 offen sc1
buffer_store_dwordx2 v[130:131], v137, s[4:7], s24 offen sc1
buffer_store_dwordx2 v[132:133], v138, s[4:7], s24 offen sc1
attnb_exit1:
s_endpgm
.globl outb1_kernel
.p2align 8
.type outb1_kernel,@function
outb1_kernel:
s_cmp_ge_u32 s2, 256
s_cbranch_scc1 outb1_exit1
s_load_dwordx2 s[12:13], s[0:1], 96
s_load_dwordx2 s[14:15], s[0:1], 0
s_load_dwordx2 s[48:49], s[0:1], 80
v_lshrrev_b32 v3, 6, v0
v_and_b32 v4, 63, v0
s_nop 0
v_readfirstlane_b32 s16, v3
v_lshlrev_b32 v1, 4, v4
s_and_b32 s17, s2, 7
s_lshl_b32 s17, s17, 2
s_lshr_b32 s18, s2, 3
s_and_b32 s19, s18, 3
s_add_u32 s17, s17, s19
s_lshr_b32 s18, s18, 2
s_waitcnt lgkmcnt(0)
s_mov_b32 s4, s12
s_mov_b32 s5, s13
s_mov_b32 s6, 0x10000000
s_mov_b32 s7, 0x20000
s_mov_b32 s8, s12
s_mov_b32 s9, s13
s_mov_b32 s10, 0x10000000
s_mov_b32 s11, 0x20000
s_mov_b32 s20, 82313216
s_mov_b32 s52, s48
s_mov_b32 s53, s49
s_mov_b32 s54, 2621440
s_mov_b32 s55, 0x20000
s_mul_i32 s21, s18, 5
s_mul_i32 s21, s21, 20480
s_add_u32 s24, s21, 90013696
s_add_u32 s25, s24, 20480
s_add_u32 s26, s25, 20480
s_add_u32 s27, s26, 20480
s_add_u32 s28, s27, 20480
s_lshl_b32 s21, s17, 2
s_add_u32 s21, s21, s16
s_mul_i32 s22, s21, 20480
s_add_u32 s22, s22, 50331648
s_lshl_b32 s23, s16, 10
v_add_u32 v2, s23, v1
s_mul_i32 s29, s16, 5120
s_add_u32 m0, s29, 0
s_nop 0
buffer_load_dwordx4 v2, s[4:7], s24 offen lds
s_add_u32 m0, s29, 1024
s_nop 0
buffer_load_dwordx4 v2, s[4:7], s25 offen lds
s_add_u32 m0, s29, 2048
s_nop 0
buffer_load_dwordx4 v2, s[4:7], s26 offen lds
s_add_u32 m0, s29, 3072
s_nop 0
buffer_load_dwordx4 v2, s[4:7], s27 offen lds
s_add_u32 m0, s29, 4096
s_nop 0
buffer_load_dwordx4 v2, s[4:7], s28 offen lds
buffer_load_dwordx4 v[32:35], v1, s[4:7], s22 offen offset:0
buffer_load_dwordx4 v[36:39], v1, s[4:7], s22 offen offset:1024
buffer_load_dwordx4 v[40:43], v1, s[4:7], s22 offen offset:2048
buffer_load_dwordx4 v[44:47], v1, s[4:7], s22 offen offset:3072
v_add_u32 v2, 0x1000, v2
s_add_u32 s22, s22, 4096
s_add_u32 m0, s29, 20480
s_nop 0
buffer_load_dwordx4 v2, s[4:7], s24 offen lds
s_add_u32 m0, s29, 21504
s_nop 0
buffer_load_dwordx4 v2, s[4:7], s25 offen lds
s_add_u32 m0, s29, 22528
s_nop 0
buffer_load_dwordx4 v2, s[4:7], s26 offen lds
s_add_u32 m0, s29, 23552
s_nop 0
buffer_load_dwordx4 v2, s[4:7], s27 offen lds
s_add_u32 m0, s29, 24576
s_nop 0
buffer_load_dwordx4 v2, s[4:7], s28 offen lds
buffer_load_dwordx4 v[48:51], v1, s[4:7], s22 offen offset:0
buffer_load_dwordx4 v[52:55], v1, s[4:7], s22 offen offset:1024
buffer_load_dwordx4 v[56:59], v1, s[4:7], s22 offen offset:2048
buffer_load_dwordx4 v[60:63], v1, s[4:7], s22 offen offset:3072
v_add_u32 v2, 0x1000, v2
s_add_u32 s22, s22, 4096
s_waitcnt vmcnt(9)
s_barrier
s_add_u32 m0, s29, 40960
s_nop 0
buffer_load_dwordx4 v2, s[4:7], s24 offen lds
s_add_u32 m0, s29, 41984
s_nop 0
buffer_load_dwordx4 v2, s[4:7], s25 offen lds
s_add_u32 m0, s29, 43008
s_nop 0
buffer_load_dwordx4 v2, s[4:7], s26 offen lds
s_add_u32 m0, s29, 44032
s_nop 0
buffer_load_dwordx4 v2, s[4:7], s27 offen lds
s_add_u32 m0, s29, 45056
s_nop 0
buffer_load_dwordx4 v2, s[4:7], s28 offen lds
buffer_load_dwordx4 v[64:67], v1, s[4:7], s22 offen offset:0
buffer_load_dwordx4 v[68:71], v1, s[4:7], s22 offen offset:1024
buffer_load_dwordx4 v[72:75], v1, s[4:7], s22 offen offset:2048
buffer_load_dwordx4 v[76:79], v1, s[4:7], s22 offen offset:3072
v_add_u32 v2, 0x1000, v2
s_add_u32 s22, s22, 4096
ds_read_b128 v[80:83], v1 offset:0
ds_read_b128 v[84:87], v1 offset:1024
ds_read_b128 v[88:91], v1 offset:2048
ds_read_b128 v[92:95], v1 offset:3072
ds_read_b128 v[96:99], v1 offset:4096
ds_read_b128 v[100:103], v1 offset:5120
ds_read_b128 v[104:107], v1 offset:6144
ds_read_b128 v[108:111], v1 offset:7168
ds_read_b128 v[112:115], v1 offset:8192
ds_read_b128 v[116:119], v1 offset:9216
s_waitcnt lgkmcnt(5)
v_mfma_f32_16x16x32_bf16 v[8:11], v[80:83], v[32:35], 0
v_mfma_f32_16x16x32_bf16 v[12:15], v[84:87], v[32:35], 0
v_mfma_f32_16x16x32_bf16 v[16:19], v[88:91], v[32:35], 0
v_mfma_f32_16x16x32_bf16 v[20:23], v[92:95], v[32:35], 0
v_mfma_f32_16x16x32_bf16 v[24:27], v[96:99], v[32:35], 0
ds_read_b128 v[80:83], v1 offset:10240
ds_read_b128 v[84:87], v1 offset:11264
ds_read_b128 v[88:91], v1 offset:12288
ds_read_b128 v[92:95], v1 offset:13312
ds_read_b128 v[96:99], v1 offset:14336
s_waitcnt lgkmcnt(5)
v_mfma_f32_16x16x32_bf16 v[8:11], v[100:103], v[36:39], v[8:11]
v_mfma_f32_16x16x32_bf16 v[12:15], v[104:107], v[36:39], v[12:15]
v_mfma_f32_16x16x32_bf16 v[16:19], v[108:111], v[36:39], v[16:19]
v_mfma_f32_16x16x32_bf16 v[20:23], v[112:115], v[36:39], v[20:23]
v_mfma_f32_16x16x32_bf16 v[24:27], v[116:119], v[36:39], v[24:27]
ds_read_b128 v[100:103], v1 offset:15360
ds_read_b128 v[104:107], v1 offset:16384
ds_read_b128 v[108:111], v1 offset:17408
ds_read_b128 v[112:115], v1 offset:18432
ds_read_b128 v[116:119], v1 offset:19456
s_waitcnt lgkmcnt(5)
v_mfma_f32_16x16x32_bf16 v[8:11], v[80:83], v[40:43], v[8:11]
v_mfma_f32_16x16x32_bf16 v[12:15], v[84:87], v[40:43], v[12:15]
v_mfma_f32_16x16x32_bf16 v[16:19], v[88:91], v[40:43], v[16:19]
v_mfma_f32_16x16x32_bf16 v[20:23], v[92:95], v[40:43], v[20:23]
v_mfma_f32_16x16x32_bf16 v[24:27], v[96:99], v[40:43], v[24:27]
s_waitcnt lgkmcnt(0)
v_mfma_f32_16x16x32_bf16 v[8:11], v[100:103], v[44:47], v[8:11]
v_mfma_f32_16x16x32_bf16 v[12:15], v[104:107], v[44:47], v[12:15]
v_mfma_f32_16x16x32_bf16 v[16:19], v[108:111], v[44:47], v[16:19]
v_mfma_f32_16x16x32_bf16 v[20:23], v[112:115], v[44:47], v[20:23]
v_mfma_f32_16x16x32_bf16 v[24:27], v[116:119], v[44:47], v[24:27]
s_waitcnt vmcnt(9)
s_barrier
s_add_u32 m0, s29, 0
s_nop 0
buffer_load_dwordx4 v2, s[4:7], s24 offen lds
s_add_u32 m0, s29, 1024
s_nop 0
buffer_load_dwordx4 v2, s[4:7], s25 offen lds
s_add_u32 m0, s29, 2048
s_nop 0
buffer_load_dwordx4 v2, s[4:7], s26 offen lds
s_add_u32 m0, s29, 3072
s_nop 0
buffer_load_dwordx4 v2, s[4:7], s27 offen lds
s_add_u32 m0, s29, 4096
s_nop 0
buffer_load_dwordx4 v2, s[4:7], s28 offen lds
buffer_load_dwordx4 v[32:35], v1, s[4:7], s22 offen offset:0
buffer_load_dwordx4 v[36:39], v1, s[4:7], s22 offen offset:1024
buffer_load_dwordx4 v[40:43], v1, s[4:7], s22 offen offset:2048
buffer_load_dwordx4 v[44:47], v1, s[4:7], s22 offen offset:3072
v_add_u32 v2, 0x1000, v2
s_add_u32 s22, s22, 4096
ds_read_b128 v[80:83], v1 offset:20480
ds_read_b128 v[84:87], v1 offset:21504
ds_read_b128 v[88:91], v1 offset:22528
ds_read_b128 v[92:95], v1 offset:23552
ds_read_b128 v[96:99], v1 offset:24576
ds_read_b128 v[100:103], v1 offset:25600
ds_read_b128 v[104:107], v1 offset:26624
ds_read_b128 v[108:111], v1 offset:27648
ds_read_b128 v[112:115], v1 offset:28672
ds_read_b128 v[116:119], v1 offset:29696
s_waitcnt lgkmcnt(5)
v_mfma_f32_16x16x32_bf16 v[8:11], v[80:83], v[48:51], v[8:11]
v_mfma_f32_16x16x32_bf16 v[12:15], v[84:87], v[48:51], v[12:15]
v_mfma_f32_16x16x32_bf16 v[16:19], v[88:91], v[48:51], v[16:19]
v_mfma_f32_16x16x32_bf16 v[20:23], v[92:95], v[48:51], v[20:23]
v_mfma_f32_16x16x32_bf16 v[24:27], v[96:99], v[48:51], v[24:27]
ds_read_b128 v[80:83], v1 offset:30720
ds_read_b128 v[84:87], v1 offset:31744
ds_read_b128 v[88:91], v1 offset:32768
ds_read_b128 v[92:95], v1 offset:33792
ds_read_b128 v[96:99], v1 offset:34816
s_waitcnt lgkmcnt(5)
v_mfma_f32_16x16x32_bf16 v[8:11], v[100:103], v[52:55], v[8:11]
v_mfma_f32_16x16x32_bf16 v[12:15], v[104:107], v[52:55], v[12:15]
v_mfma_f32_16x16x32_bf16 v[16:19], v[108:111], v[52:55], v[16:19]
v_mfma_f32_16x16x32_bf16 v[20:23], v[112:115], v[52:55], v[20:23]
v_mfma_f32_16x16x32_bf16 v[24:27], v[116:119], v[52:55], v[24:27]
ds_read_b128 v[100:103], v1 offset:35840
ds_read_b128 v[104:107], v1 offset:36864
ds_read_b128 v[108:111], v1 offset:37888
ds_read_b128 v[112:115], v1 offset:38912
ds_read_b128 v[116:119], v1 offset:39936
s_waitcnt lgkmcnt(5)
v_mfma_f32_16x16x32_bf16 v[8:11], v[80:83], v[56:59], v[8:11]
v_mfma_f32_16x16x32_bf16 v[12:15], v[84:87], v[56:59], v[12:15]
v_mfma_f32_16x16x32_bf16 v[16:19], v[88:91], v[56:59], v[16:19]
v_mfma_f32_16x16x32_bf16 v[20:23], v[92:95], v[56:59], v[20:23]
v_mfma_f32_16x16x32_bf16 v[24:27], v[96:99], v[56:59], v[24:27]
s_waitcnt lgkmcnt(0)
v_mfma_f32_16x16x32_bf16 v[8:11], v[100:103], v[60:63], v[8:11]
v_mfma_f32_16x16x32_bf16 v[12:15], v[104:107], v[60:63], v[12:15]
v_mfma_f32_16x16x32_bf16 v[16:19], v[108:111], v[60:63], v[16:19]
v_mfma_f32_16x16x32_bf16 v[20:23], v[112:115], v[60:63], v[20:23]
v_mfma_f32_16x16x32_bf16 v[24:27], v[116:119], v[60:63], v[24:27]
s_waitcnt vmcnt(9)
s_barrier
s_add_u32 m0, s29, 20480
s_nop 0
buffer_load_dwordx4 v2, s[4:7], s24 offen lds
s_add_u32 m0, s29, 21504
s_nop 0
buffer_load_dwordx4 v2, s[4:7], s25 offen lds
s_add_u32 m0, s29, 22528
s_nop 0
buffer_load_dwordx4 v2, s[4:7], s26 offen lds
s_add_u32 m0, s29, 23552
s_nop 0
buffer_load_dwordx4 v2, s[4:7], s27 offen lds
s_add_u32 m0, s29, 24576
s_nop 0
buffer_load_dwordx4 v2, s[4:7], s28 offen lds
buffer_load_dwordx4 v[48:51], v1, s[4:7], s22 offen offset:0
buffer_load_dwordx4 v[52:55], v1, s[4:7], s22 offen offset:1024
buffer_load_dwordx4 v[56:59], v1, s[4:7], s22 offen offset:2048
buffer_load_dwordx4 v[60:63], v1, s[4:7], s22 offen offset:3072
v_add_u32 v2, 0x1000, v2
s_add_u32 s22, s22, 4096
ds_read_b128 v[80:83], v1 offset:40960
ds_read_b128 v[84:87], v1 offset:41984
ds_read_b128 v[88:91], v1 offset:43008
ds_read_b128 v[92:95], v1 offset:44032
ds_read_b128 v[96:99], v1 offset:45056
ds_read_b128 v[100:103], v1 offset:46080
ds_read_b128 v[104:107], v1 offset:47104
ds_read_b128 v[108:111], v1 offset:48128
ds_read_b128 v[112:115], v1 offset:49152
ds_read_b128 v[116:119], v1 offset:50176
s_waitcnt lgkmcnt(5)
v_mfma_f32_16x16x32_bf16 v[8:11], v[80:83], v[64:67], v[8:11]
v_mfma_f32_16x16x32_bf16 v[12:15], v[84:87], v[64:67], v[12:15]
v_mfma_f32_16x16x32_bf16 v[16:19], v[88:91], v[64:67], v[16:19]
v_mfma_f32_16x16x32_bf16 v[20:23], v[92:95], v[64:67], v[20:23]
v_mfma_f32_16x16x32_bf16 v[24:27], v[96:99], v[64:67], v[24:27]
ds_read_b128 v[80:83], v1 offset:51200
ds_read_b128 v[84:87], v1 offset:52224
ds_read_b128 v[88:91], v1 offset:53248
ds_read_b128 v[92:95], v1 offset:54272
ds_read_b128 v[96:99], v1 offset:55296
s_waitcnt lgkmcnt(5)
v_mfma_f32_16x16x32_bf16 v[8:11], v[100:103], v[68:71], v[8:11]
v_mfma_f32_16x16x32_bf16 v[12:15], v[104:107], v[68:71], v[12:15]
v_mfma_f32_16x16x32_bf16 v[16:19], v[108:111], v[68:71], v[16:19]
v_mfma_f32_16x16x32_bf16 v[20:23], v[112:115], v[68:71], v[20:23]
v_mfma_f32_16x16x32_bf16 v[24:27], v[116:119], v[68:71], v[24:27]
ds_read_b128 v[100:103], v1 offset:56320
ds_read_b128 v[104:107], v1 offset:57344
ds_read_b128 v[108:111], v1 offset:58368
ds_read_b128 v[112:115], v1 offset:59392
ds_read_b128 v[116:119], v1 offset:60416
s_waitcnt lgkmcnt(5)
v_mfma_f32_16x16x32_bf16 v[8:11], v[80:83], v[72:75], v[8:11]
v_mfma_f32_16x16x32_bf16 v[12:15], v[84:87], v[72:75], v[12:15]
v_mfma_f32_16x16x32_bf16 v[16:19], v[88:91], v[72:75], v[16:19]
v_mfma_f32_16x16x32_bf16 v[20:23], v[92:95], v[72:75], v[20:23]
v_mfma_f32_16x16x32_bf16 v[24:27], v[96:99], v[72:75], v[24:27]
s_waitcnt lgkmcnt(0)
v_mfma_f32_16x16x32_bf16 v[8:11], v[100:103], v[76:79], v[8:11]
v_mfma_f32_16x16x32_bf16 v[12:15], v[104:107], v[76:79], v[12:15]
v_mfma_f32_16x16x32_bf16 v[16:19], v[108:111], v[76:79], v[16:19]
v_mfma_f32_16x16x32_bf16 v[20:23], v[112:115], v[76:79], v[20:23]
v_mfma_f32_16x16x32_bf16 v[24:27], v[116:119], v[76:79], v[24:27]
s_waitcnt vmcnt(9)
s_barrier
ds_read_b128 v[80:83], v1 offset:0
ds_read_b128 v[84:87], v1 offset:1024
ds_read_b128 v[88:91], v1 offset:2048
ds_read_b128 v[92:95], v1 offset:3072
ds_read_b128 v[96:99], v1 offset:4096
ds_read_b128 v[100:103], v1 offset:5120
ds_read_b128 v[104:107], v1 offset:6144
ds_read_b128 v[108:111], v1 offset:7168
ds_read_b128 v[112:115], v1 offset:8192
ds_read_b128 v[116:119], v1 offset:9216
s_waitcnt lgkmcnt(5)
v_mfma_f32_16x16x32_bf16 v[8:11], v[80:83], v[32:35], v[8:11]
v_mfma_f32_16x16x32_bf16 v[12:15], v[84:87], v[32:35], v[12:15]
v_mfma_f32_16x16x32_bf16 v[16:19], v[88:91], v[32:35], v[16:19]
v_mfma_f32_16x16x32_bf16 v[20:23], v[92:95], v[32:35], v[20:23]
v_mfma_f32_16x16x32_bf16 v[24:27], v[96:99], v[32:35], v[24:27]
ds_read_b128 v[80:83], v1 offset:10240
ds_read_b128 v[84:87], v1 offset:11264
ds_read_b128 v[88:91], v1 offset:12288
ds_read_b128 v[92:95], v1 offset:13312
ds_read_b128 v[96:99], v1 offset:14336
s_waitcnt lgkmcnt(5)
v_mfma_f32_16x16x32_bf16 v[8:11], v[100:103], v[36:39], v[8:11]
v_mfma_f32_16x16x32_bf16 v[12:15], v[104:107], v[36:39], v[12:15]
v_mfma_f32_16x16x32_bf16 v[16:19], v[108:111], v[36:39], v[16:19]
v_mfma_f32_16x16x32_bf16 v[20:23], v[112:115], v[36:39], v[20:23]
v_mfma_f32_16x16x32_bf16 v[24:27], v[116:119], v[36:39], v[24:27]
ds_read_b128 v[100:103], v1 offset:15360
ds_read_b128 v[104:107], v1 offset:16384
ds_read_b128 v[108:111], v1 offset:17408
ds_read_b128 v[112:115], v1 offset:18432
ds_read_b128 v[116:119], v1 offset:19456
s_waitcnt lgkmcnt(5)
v_mfma_f32_16x16x32_bf16 v[8:11], v[80:83], v[40:43], v[8:11]
v_mfma_f32_16x16x32_bf16 v[12:15], v[84:87], v[40:43], v[12:15]
v_mfma_f32_16x16x32_bf16 v[16:19], v[88:91], v[40:43], v[16:19]
v_mfma_f32_16x16x32_bf16 v[20:23], v[92:95], v[40:43], v[20:23]
v_mfma_f32_16x16x32_bf16 v[24:27], v[96:99], v[40:43], v[24:27]
s_waitcnt lgkmcnt(0)
v_mfma_f32_16x16x32_bf16 v[8:11], v[100:103], v[44:47], v[8:11]
v_mfma_f32_16x16x32_bf16 v[12:15], v[104:107], v[44:47], v[12:15]
v_mfma_f32_16x16x32_bf16 v[16:19], v[108:111], v[44:47], v[16:19]
v_mfma_f32_16x16x32_bf16 v[20:23], v[112:115], v[44:47], v[20:23]
v_mfma_f32_16x16x32_bf16 v[24:27], v[116:119], v[44:47], v[24:27]
s_waitcnt vmcnt(0)
s_barrier
ds_read_b128 v[80:83], v1 offset:20480
ds_read_b128 v[84:87], v1 offset:21504
ds_read_b128 v[88:91], v1 offset:22528
ds_read_b128 v[92:95], v1 offset:23552
ds_read_b128 v[96:99], v1 offset:24576
ds_read_b128 v[100:103], v1 offset:25600
ds_read_b128 v[104:107], v1 offset:26624
ds_read_b128 v[108:111], v1 offset:27648
ds_read_b128 v[112:115], v1 offset:28672
ds_read_b128 v[116:119], v1 offset:29696
s_waitcnt lgkmcnt(5)
v_mfma_f32_16x16x32_bf16 v[8:11], v[80:83], v[48:51], v[8:11]
v_mfma_f32_16x16x32_bf16 v[12:15], v[84:87], v[48:51], v[12:15]
v_mfma_f32_16x16x32_bf16 v[16:19], v[88:91], v[48:51], v[16:19]
v_mfma_f32_16x16x32_bf16 v[20:23], v[92:95], v[48:51], v[20:23]
v_mfma_f32_16x16x32_bf16 v[24:27], v[96:99], v[48:51], v[24:27]
ds_read_b128 v[80:83], v1 offset:30720
ds_read_b128 v[84:87], v1 offset:31744
ds_read_b128 v[88:91], v1 offset:32768
ds_read_b128 v[92:95], v1 offset:33792
ds_read_b128 v[96:99], v1 offset:34816
s_waitcnt lgkmcnt(5)
v_mfma_f32_16x16x32_bf16 v[8:11], v[100:103], v[52:55], v[8:11]
v_mfma_f32_16x16x32_bf16 v[12:15], v[104:107], v[52:55], v[12:15]
v_mfma_f32_16x16x32_bf16 v[16:19], v[108:111], v[52:55], v[16:19]
v_mfma_f32_16x16x32_bf16 v[20:23], v[112:115], v[52:55], v[20:23]
v_mfma_f32_16x16x32_bf16 v[24:27], v[116:119], v[52:55], v[24:27]
ds_read_b128 v[100:103], v1 offset:35840
ds_read_b128 v[104:107], v1 offset:36864
ds_read_b128 v[108:111], v1 offset:37888
ds_read_b128 v[112:115], v1 offset:38912
ds_read_b128 v[116:119], v1 offset:39936
s_waitcnt lgkmcnt(5)
v_mfma_f32_16x16x32_bf16 v[8:11], v[80:83], v[56:59], v[8:11]
v_mfma_f32_16x16x32_bf16 v[12:15], v[84:87], v[56:59], v[12:15]
v_mfma_f32_16x16x32_bf16 v[16:19], v[88:91], v[56:59], v[16:19]
v_mfma_f32_16x16x32_bf16 v[20:23], v[92:95], v[56:59], v[20:23]
v_mfma_f32_16x16x32_bf16 v[24:27], v[96:99], v[56:59], v[24:27]
s_waitcnt lgkmcnt(0)
v_mfma_f32_16x16x32_bf16 v[8:11], v[100:103], v[60:63], v[8:11]
v_mfma_f32_16x16x32_bf16 v[12:15], v[104:107], v[60:63], v[12:15]
v_mfma_f32_16x16x32_bf16 v[16:19], v[108:111], v[60:63], v[16:19]
v_mfma_f32_16x16x32_bf16 v[20:23], v[112:115], v[60:63], v[20:23]
v_mfma_f32_16x16x32_bf16 v[24:27], v[116:119], v[60:63], v[24:27]
v_and_b32 v3, 63, v0
v_and_b32 v4, 15, v3
v_lshrrev_b32 v3, 4, v3
s_lshl_b32 s21, s17, 6
s_lshl_b32 s23, s16, 4
s_add_u32 s21, s21, s23
v_add_u32 v4, s21, v4
v_mul_u32_u24 v6, 1280, v4
v_lshl_add_u32 v6, v3, 4, v6
s_mul_i32 s21, s18, 5
s_add_u32 s23, s21, 0
s_lshr_b32 s31, s23, 1
s_lshl_b32 s31, s31, 6
s_and_b32 s23, s23, 1
s_lshl_b32 s23, s23, 3
s_add_u32 s32, s31, s23
s_add_u32 s40, s32, s20
buffer_load_dwordx2 v[32:33], v6, s[8:11], s40 offen
s_add_u32 s23, s21, 1
s_lshr_b32 s31, s23, 1
s_lshl_b32 s31, s31, 6
s_and_b32 s23, s23, 1
s_lshl_b32 s23, s23, 3
s_add_u32 s33, s31, s23
s_add_u32 s41, s33, s20
buffer_load_dwordx2 v[34:35], v6, s[8:11], s41 offen
s_add_u32 s23, s21, 2
s_lshr_b32 s31, s23, 1
s_lshl_b32 s31, s31, 6
s_and_b32 s23, s23, 1
s_lshl_b32 s23, s23, 3
s_add_u32 s34, s31, s23
s_add_u32 s42, s34, s20
buffer_load_dwordx2 v[36:37], v6, s[8:11], s42 offen
s_add_u32 s23, s21, 3
s_lshr_b32 s31, s23, 1
s_lshl_b32 s31, s31, 6
s_and_b32 s23, s23, 1
s_lshl_b32 s23, s23, 3
s_add_u32 s35, s31, s23
s_add_u32 s43, s35, s20
buffer_load_dwordx2 v[38:39], v6, s[8:11], s43 offen
s_add_u32 s23, s21, 4
s_lshr_b32 s31, s23, 1
s_lshl_b32 s31, s31, 6
s_and_b32 s23, s23, 1
s_lshl_b32 s23, s23, 3
s_add_u32 s36, s31, s23
s_add_u32 s44, s36, s20
buffer_load_dwordx2 v[40:41], v6, s[8:11], s44 offen
s_waitcnt vmcnt(0)
v_cvt_pk_bf16_f32 v80, v8, v9
v_cvt_pk_bf16_f32 v81, v10, v11
v_lshlrev_b32 v8, 16, v80
v_and_b32 v9, 0xffff0000, v80
v_lshlrev_b32 v10, 16, v81
v_and_b32 v11, 0xffff0000, v81
v_lshlrev_b32 v82, 16, v32
v_and_b32 v83, 0xffff0000, v32
v_lshlrev_b32 v84, 16, v33
v_and_b32 v85, 0xffff0000, v33
v_add_f32 v8, v8, v82
v_add_f32 v9, v9, v83
v_add_f32 v10, v10, v84
v_add_f32 v11, v11, v85
v_cvt_pk_bf16_f32 v32, v8, v9
v_cvt_pk_bf16_f32 v33, v10, v11
s_add_u32 s23, s32, 82313216
buffer_store_dwordx2 v[32:33], v6, s[4:7], s23 offen sc1
v_cvt_pk_bf16_f32 v80, v12, v13
v_cvt_pk_bf16_f32 v81, v14, v15
v_lshlrev_b32 v12, 16, v80
v_and_b32 v13, 0xffff0000, v80
v_lshlrev_b32 v14, 16, v81
v_and_b32 v15, 0xffff0000, v81
v_lshlrev_b32 v82, 16, v34
v_and_b32 v83, 0xffff0000, v34
v_lshlrev_b32 v84, 16, v35
v_and_b32 v85, 0xffff0000, v35
v_add_f32 v12, v12, v82
v_add_f32 v13, v13, v83
v_add_f32 v14, v14, v84
v_add_f32 v15, v15, v85
v_cvt_pk_bf16_f32 v34, v12, v13
v_cvt_pk_bf16_f32 v35, v14, v15
s_add_u32 s23, s33, 82313216
buffer_store_dwordx2 v[34:35], v6, s[4:7], s23 offen sc1
v_cvt_pk_bf16_f32 v80, v16, v17
v_cvt_pk_bf16_f32 v81, v18, v19
v_lshlrev_b32 v16, 16, v80
v_and_b32 v17, 0xffff0000, v80
v_lshlrev_b32 v18, 16, v81
v_and_b32 v19, 0xffff0000, v81
v_lshlrev_b32 v82, 16, v36
v_and_b32 v83, 0xffff0000, v36
v_lshlrev_b32 v84, 16, v37
v_and_b32 v85, 0xffff0000, v37
v_add_f32 v16, v16, v82
v_add_f32 v17, v17, v83
v_add_f32 v18, v18, v84
v_add_f32 v19, v19, v85
v_cvt_pk_bf16_f32 v36, v16, v17
v_cvt_pk_bf16_f32 v37, v18, v19
s_add_u32 s23, s34, 82313216
buffer_store_dwordx2 v[36:37], v6, s[4:7], s23 offen sc1
v_cvt_pk_bf16_f32 v80, v20, v21
v_cvt_pk_bf16_f32 v81, v22, v23
v_lshlrev_b32 v20, 16, v80
v_and_b32 v21, 0xffff0000, v80
v_lshlrev_b32 v22, 16, v81
v_and_b32 v23, 0xffff0000, v81
v_lshlrev_b32 v82, 16, v38
v_and_b32 v83, 0xffff0000, v38
v_lshlrev_b32 v84, 16, v39
v_and_b32 v85, 0xffff0000, v39
v_add_f32 v20, v20, v82
v_add_f32 v21, v21, v83
v_add_f32 v22, v22, v84
v_add_f32 v23, v23, v85
v_cvt_pk_bf16_f32 v38, v20, v21
v_cvt_pk_bf16_f32 v39, v22, v23
s_add_u32 s23, s35, 82313216
buffer_store_dwordx2 v[38:39], v6, s[4:7], s23 offen sc1
v_cvt_pk_bf16_f32 v80, v24, v25
v_cvt_pk_bf16_f32 v81, v26, v27
v_lshlrev_b32 v24, 16, v80
v_and_b32 v25, 0xffff0000, v80
v_lshlrev_b32 v26, 16, v81
v_and_b32 v27, 0xffff0000, v81
v_lshlrev_b32 v82, 16, v40
v_and_b32 v83, 0xffff0000, v40
v_lshlrev_b32 v84, 16, v41
v_and_b32 v85, 0xffff0000, v41
v_add_f32 v24, v24, v82
v_add_f32 v25, v25, v83
v_add_f32 v26, v26, v84
v_add_f32 v27, v27, v85
v_cvt_pk_bf16_f32 v40, v24, v25
v_cvt_pk_bf16_f32 v41, v26, v27
s_add_u32 s23, s36, 82313216
buffer_store_dwordx2 v[40:41], v6, s[4:7], s23 offen sc1
outb1_exit1:
s_endpgm
.globl outb2_kernel
.p2align 8
.type outb2_kernel,@function
outb2_kernel:
s_cmp_ge_u32 s2, 256
s_cbranch_scc1 outb2_exit1
s_load_dwordx2 s[12:13], s[0:1], 96
s_load_dwordx2 s[14:15], s[0:1], 0
s_load_dwordx2 s[48:49], s[0:1], 80
v_lshrrev_b32 v3, 6, v0
v_and_b32 v4, 63, v0
s_nop 0
v_readfirstlane_b32 s16, v3
v_lshlrev_b32 v1, 4, v4
s_and_b32 s17, s2, 7
s_lshl_b32 s17, s17, 2
s_lshr_b32 s18, s2, 3
s_and_b32 s19, s18, 3
s_add_u32 s17, s17, s19
s_lshr_b32 s18, s18, 2
s_waitcnt lgkmcnt(0)
s_mov_b32 s4, s12
s_mov_b32 s5, s13
s_mov_b32 s6, 0x10000000
s_mov_b32 s7, 0x20000
s_mov_b32 s8, s12
s_mov_b32 s9, s13
s_mov_b32 s10, 0x10000000
s_mov_b32 s11, 0x20000
s_mov_b32 s20, 82313216
s_mov_b32 s52, s48
s_mov_b32 s53, s49
s_mov_b32 s54, 2621440
s_mov_b32 s55, 0x20000
s_mul_i32 s21, s18, 5
s_mul_i32 s21, s21, 20480
s_add_u32 s24, s21, 90013696
s_add_u32 s25, s24, 20480
s_add_u32 s26, s25, 20480
s_add_u32 s27, s26, 20480
s_add_u32 s28, s27, 20480
s_lshl_b32 s21, s17, 2
s_add_u32 s21, s21, s16
s_mul_i32 s22, s21, 20480
s_add_u32 s22, s22, 50331648
s_lshl_b32 s23, s16, 10
v_add_u32 v2, s23, v1
s_mul_i32 s29, s16, 5120
s_add_u32 m0, s29, 0
s_nop 0
buffer_load_dwordx4 v2, s[4:7], s24 offen lds
s_add_u32 m0, s29, 1024
s_nop 0
buffer_load_dwordx4 v2, s[4:7], s25 offen lds
s_add_u32 m0, s29, 2048
s_nop 0
buffer_load_dwordx4 v2, s[4:7], s26 offen lds
s_add_u32 m0, s29, 3072
s_nop 0
buffer_load_dwordx4 v2, s[4:7], s27 offen lds
s_add_u32 m0, s29, 4096
s_nop 0
buffer_load_dwordx4 v2, s[4:7], s28 offen lds
buffer_load_dwordx4 v[32:35], v1, s[4:7], s22 offen offset:0
buffer_load_dwordx4 v[36:39], v1, s[4:7], s22 offen offset:1024
buffer_load_dwordx4 v[40:43], v1, s[4:7], s22 offen offset:2048
buffer_load_dwordx4 v[44:47], v1, s[4:7], s22 offen offset:3072
v_add_u32 v2, 0x1000, v2
s_add_u32 s22, s22, 4096
s_add_u32 m0, s29, 20480
s_nop 0
buffer_load_dwordx4 v2, s[4:7], s24 offen lds
s_add_u32 m0, s29, 21504
s_nop 0
buffer_load_dwordx4 v2, s[4:7], s25 offen lds
s_add_u32 m0, s29, 22528
s_nop 0
buffer_load_dwordx4 v2, s[4:7], s26 offen lds
s_add_u32 m0, s29, 23552
s_nop 0
buffer_load_dwordx4 v2, s[4:7], s27 offen lds
s_add_u32 m0, s29, 24576
s_nop 0
buffer_load_dwordx4 v2, s[4:7], s28 offen lds
buffer_load_dwordx4 v[48:51], v1, s[4:7], s22 offen offset:0
buffer_load_dwordx4 v[52:55], v1, s[4:7], s22 offen offset:1024
buffer_load_dwordx4 v[56:59], v1, s[4:7], s22 offen offset:2048
buffer_load_dwordx4 v[60:63], v1, s[4:7], s22 offen offset:3072
v_add_u32 v2, 0x1000, v2
s_add_u32 s22, s22, 4096
s_waitcnt vmcnt(9)
s_barrier
s_add_u32 m0, s29, 40960
s_nop 0
buffer_load_dwordx4 v2, s[4:7], s24 offen lds
s_add_u32 m0, s29, 41984
s_nop 0
buffer_load_dwordx4 v2, s[4:7], s25 offen lds
s_add_u32 m0, s29, 43008
s_nop 0
buffer_load_dwordx4 v2, s[4:7], s26 offen lds
s_add_u32 m0, s29, 44032
s_nop 0
buffer_load_dwordx4 v2, s[4:7], s27 offen lds
s_add_u32 m0, s29, 45056
s_nop 0
buffer_load_dwordx4 v2, s[4:7], s28 offen lds
buffer_load_dwordx4 v[64:67], v1, s[4:7], s22 offen offset:0
buffer_load_dwordx4 v[68:71], v1, s[4:7], s22 offen offset:1024
buffer_load_dwordx4 v[72:75], v1, s[4:7], s22 offen offset:2048
buffer_load_dwordx4 v[76:79], v1, s[4:7], s22 offen offset:3072
v_add_u32 v2, 0x1000, v2
s_add_u32 s22, s22, 4096
ds_read_b128 v[80:83], v1 offset:0
ds_read_b128 v[84:87], v1 offset:1024
ds_read_b128 v[88:91], v1 offset:2048
ds_read_b128 v[92:95], v1 offset:3072
ds_read_b128 v[96:99], v1 offset:4096
ds_read_b128 v[100:103], v1 offset:5120
ds_read_b128 v[104:107], v1 offset:6144
ds_read_b128 v[108:111], v1 offset:7168
ds_read_b128 v[112:115], v1 offset:8192
ds_read_b128 v[116:119], v1 offset:9216
s_waitcnt lgkmcnt(5)
v_mfma_f32_16x16x32_bf16 v[8:11], v[80:83], v[32:35], 0
v_mfma_f32_16x16x32_bf16 v[12:15], v[84:87], v[32:35], 0
v_mfma_f32_16x16x32_bf16 v[16:19], v[88:91], v[32:35], 0
v_mfma_f32_16x16x32_bf16 v[20:23], v[92:95], v[32:35], 0
v_mfma_f32_16x16x32_bf16 v[24:27], v[96:99], v[32:35], 0
ds_read_b128 v[80:83], v1 offset:10240
ds_read_b128 v[84:87], v1 offset:11264
ds_read_b128 v[88:91], v1 offset:12288
ds_read_b128 v[92:95], v1 offset:13312
ds_read_b128 v[96:99], v1 offset:14336
s_waitcnt lgkmcnt(5)
v_mfma_f32_16x16x32_bf16 v[8:11], v[100:103], v[36:39], v[8:11]
v_mfma_f32_16x16x32_bf16 v[12:15], v[104:107], v[36:39], v[12:15]
v_mfma_f32_16x16x32_bf16 v[16:19], v[108:111], v[36:39], v[16:19]
v_mfma_f32_16x16x32_bf16 v[20:23], v[112:115], v[36:39], v[20:23]
v_mfma_f32_16x16x32_bf16 v[24:27], v[116:119], v[36:39], v[24:27]
ds_read_b128 v[100:103], v1 offset:15360
ds_read_b128 v[104:107], v1 offset:16384
ds_read_b128 v[108:111], v1 offset:17408
ds_read_b128 v[112:115], v1 offset:18432
ds_read_b128 v[116:119], v1 offset:19456
s_waitcnt lgkmcnt(5)
v_mfma_f32_16x16x32_bf16 v[8:11], v[80:83], v[40:43], v[8:11]
v_mfma_f32_16x16x32_bf16 v[12:15], v[84:87], v[40:43], v[12:15]
v_mfma_f32_16x16x32_bf16 v[16:19], v[88:91], v[40:43], v[16:19]
v_mfma_f32_16x16x32_bf16 v[20:23], v[92:95], v[40:43], v[20:23]
v_mfma_f32_16x16x32_bf16 v[24:27], v[96:99], v[40:43], v[24:27]
s_waitcnt lgkmcnt(0)
v_mfma_f32_16x16x32_bf16 v[8:11], v[100:103], v[44:47], v[8:11]
v_mfma_f32_16x16x32_bf16 v[12:15], v[104:107], v[44:47], v[12:15]
v_mfma_f32_16x16x32_bf16 v[16:19], v[108:111], v[44:47], v[16:19]
v_mfma_f32_16x16x32_bf16 v[20:23], v[112:115], v[44:47], v[20:23]
v_mfma_f32_16x16x32_bf16 v[24:27], v[116:119], v[44:47], v[24:27]
s_waitcnt vmcnt(9)
s_barrier
s_add_u32 m0, s29, 0
s_nop 0
buffer_load_dwordx4 v2, s[4:7], s24 offen lds
s_add_u32 m0, s29, 1024
s_nop 0
buffer_load_dwordx4 v2, s[4:7], s25 offen lds
s_add_u32 m0, s29, 2048
s_nop 0
buffer_load_dwordx4 v2, s[4:7], s26 offen lds
s_add_u32 m0, s29, 3072
s_nop 0
buffer_load_dwordx4 v2, s[4:7], s27 offen lds
s_add_u32 m0, s29, 4096
s_nop 0
buffer_load_dwordx4 v2, s[4:7], s28 offen lds
buffer_load_dwordx4 v[32:35], v1, s[4:7], s22 offen offset:0
buffer_load_dwordx4 v[36:39], v1, s[4:7], s22 offen offset:1024
buffer_load_dwordx4 v[40:43], v1, s[4:7], s22 offen offset:2048
buffer_load_dwordx4 v[44:47], v1, s[4:7], s22 offen offset:3072
v_add_u32 v2, 0x1000, v2
s_add_u32 s22, s22, 4096
ds_read_b128 v[80:83], v1 offset:20480
ds_read_b128 v[84:87], v1 offset:21504
ds_read_b128 v[88:91], v1 offset:22528
ds_read_b128 v[92:95], v1 offset:23552
ds_read_b128 v[96:99], v1 offset:24576
ds_read_b128 v[100:103], v1 offset:25600
ds_read_b128 v[104:107], v1 offset:26624
ds_read_b128 v[108:111], v1 offset:27648
ds_read_b128 v[112:115], v1 offset:28672
ds_read_b128 v[116:119], v1 offset:29696
s_waitcnt lgkmcnt(5)
v_mfma_f32_16x16x32_bf16 v[8:11], v[80:83], v[48:51], v[8:11]
v_mfma_f32_16x16x32_bf16 v[12:15], v[84:87], v[48:51], v[12:15]
v_mfma_f32_16x16x32_bf16 v[16:19], v[88:91], v[48:51], v[16:19]
v_mfma_f32_16x16x32_bf16 v[20:23], v[92:95], v[48:51], v[20:23]
v_mfma_f32_16x16x32_bf16 v[24:27], v[96:99], v[48:51], v[24:27]
ds_read_b128 v[80:83], v1 offset:30720
ds_read_b128 v[84:87], v1 offset:31744
ds_read_b128 v[88:91], v1 offset:32768
ds_read_b128 v[92:95], v1 offset:33792
ds_read_b128 v[96:99], v1 offset:34816
s_waitcnt lgkmcnt(5)
v_mfma_f32_16x16x32_bf16 v[8:11], v[100:103], v[52:55], v[8:11]
v_mfma_f32_16x16x32_bf16 v[12:15], v[104:107], v[52:55], v[12:15]
v_mfma_f32_16x16x32_bf16 v[16:19], v[108:111], v[52:55], v[16:19]
v_mfma_f32_16x16x32_bf16 v[20:23], v[112:115], v[52:55], v[20:23]
v_mfma_f32_16x16x32_bf16 v[24:27], v[116:119], v[52:55], v[24:27]
ds_read_b128 v[100:103], v1 offset:35840
ds_read_b128 v[104:107], v1 offset:36864
ds_read_b128 v[108:111], v1 offset:37888
ds_read_b128 v[112:115], v1 offset:38912
ds_read_b128 v[116:119], v1 offset:39936
s_waitcnt lgkmcnt(5)
v_mfma_f32_16x16x32_bf16 v[8:11], v[80:83], v[56:59], v[8:11]
v_mfma_f32_16x16x32_bf16 v[12:15], v[84:87], v[56:59], v[12:15]
v_mfma_f32_16x16x32_bf16 v[16:19], v[88:91], v[56:59], v[16:19]
v_mfma_f32_16x16x32_bf16 v[20:23], v[92:95], v[56:59], v[20:23]
v_mfma_f32_16x16x32_bf16 v[24:27], v[96:99], v[56:59], v[24:27]
s_waitcnt lgkmcnt(0)
v_mfma_f32_16x16x32_bf16 v[8:11], v[100:103], v[60:63], v[8:11]
v_mfma_f32_16x16x32_bf16 v[12:15], v[104:107], v[60:63], v[12:15]
v_mfma_f32_16x16x32_bf16 v[16:19], v[108:111], v[60:63], v[16:19]
v_mfma_f32_16x16x32_bf16 v[20:23], v[112:115], v[60:63], v[20:23]
v_mfma_f32_16x16x32_bf16 v[24:27], v[116:119], v[60:63], v[24:27]
s_waitcnt vmcnt(9)
s_barrier
s_add_u32 m0, s29, 20480
s_nop 0
buffer_load_dwordx4 v2, s[4:7], s24 offen lds
s_add_u32 m0, s29, 21504
s_nop 0
buffer_load_dwordx4 v2, s[4:7], s25 offen lds
s_add_u32 m0, s29, 22528
s_nop 0
buffer_load_dwordx4 v2, s[4:7], s26 offen lds
s_add_u32 m0, s29, 23552
s_nop 0
buffer_load_dwordx4 v2, s[4:7], s27 offen lds
s_add_u32 m0, s29, 24576
s_nop 0
buffer_load_dwordx4 v2, s[4:7], s28 offen lds
buffer_load_dwordx4 v[48:51], v1, s[4:7], s22 offen offset:0
buffer_load_dwordx4 v[52:55], v1, s[4:7], s22 offen offset:1024
buffer_load_dwordx4 v[56:59], v1, s[4:7], s22 offen offset:2048
buffer_load_dwordx4 v[60:63], v1, s[4:7], s22 offen offset:3072
v_add_u32 v2, 0x1000, v2
s_add_u32 s22, s22, 4096
ds_read_b128 v[80:83], v1 offset:40960
ds_read_b128 v[84:87], v1 offset:41984
ds_read_b128 v[88:91], v1 offset:43008
ds_read_b128 v[92:95], v1 offset:44032
ds_read_b128 v[96:99], v1 offset:45056
ds_read_b128 v[100:103], v1 offset:46080
ds_read_b128 v[104:107], v1 offset:47104
ds_read_b128 v[108:111], v1 offset:48128
ds_read_b128 v[112:115], v1 offset:49152
ds_read_b128 v[116:119], v1 offset:50176
s_waitcnt lgkmcnt(5)
v_mfma_f32_16x16x32_bf16 v[8:11], v[80:83], v[64:67], v[8:11]
v_mfma_f32_16x16x32_bf16 v[12:15], v[84:87], v[64:67], v[12:15]
v_mfma_f32_16x16x32_bf16 v[16:19], v[88:91], v[64:67], v[16:19]
v_mfma_f32_16x16x32_bf16 v[20:23], v[92:95], v[64:67], v[20:23]
v_mfma_f32_16x16x32_bf16 v[24:27], v[96:99], v[64:67], v[24:27]
ds_read_b128 v[80:83], v1 offset:51200
ds_read_b128 v[84:87], v1 offset:52224
ds_read_b128 v[88:91], v1 offset:53248
ds_read_b128 v[92:95], v1 offset:54272
ds_read_b128 v[96:99], v1 offset:55296
s_waitcnt lgkmcnt(5)
v_mfma_f32_16x16x32_bf16 v[8:11], v[100:103], v[68:71], v[8:11]
v_mfma_f32_16x16x32_bf16 v[12:15], v[104:107], v[68:71], v[12:15]
v_mfma_f32_16x16x32_bf16 v[16:19], v[108:111], v[68:71], v[16:19]
v_mfma_f32_16x16x32_bf16 v[20:23], v[112:115], v[68:71], v[20:23]
v_mfma_f32_16x16x32_bf16 v[24:27], v[116:119], v[68:71], v[24:27]
ds_read_b128 v[100:103], v1 offset:56320
ds_read_b128 v[104:107], v1 offset:57344
ds_read_b128 v[108:111], v1 offset:58368
ds_read_b128 v[112:115], v1 offset:59392
ds_read_b128 v[116:119], v1 offset:60416
s_waitcnt lgkmcnt(5)
v_mfma_f32_16x16x32_bf16 v[8:11], v[80:83], v[72:75], v[8:11]
v_mfma_f32_16x16x32_bf16 v[12:15], v[84:87], v[72:75], v[12:15]
v_mfma_f32_16x16x32_bf16 v[16:19], v[88:91], v[72:75], v[16:19]
v_mfma_f32_16x16x32_bf16 v[20:23], v[92:95], v[72:75], v[20:23]
v_mfma_f32_16x16x32_bf16 v[24:27], v[96:99], v[72:75], v[24:27]
s_waitcnt lgkmcnt(0)
v_mfma_f32_16x16x32_bf16 v[8:11], v[100:103], v[76:79], v[8:11]
v_mfma_f32_16x16x32_bf16 v[12:15], v[104:107], v[76:79], v[12:15]
v_mfma_f32_16x16x32_bf16 v[16:19], v[108:111], v[76:79], v[16:19]
v_mfma_f32_16x16x32_bf16 v[20:23], v[112:115], v[76:79], v[20:23]
v_mfma_f32_16x16x32_bf16 v[24:27], v[116:119], v[76:79], v[24:27]
s_waitcnt vmcnt(9)
s_barrier
ds_read_b128 v[80:83], v1 offset:0
ds_read_b128 v[84:87], v1 offset:1024
ds_read_b128 v[88:91], v1 offset:2048
ds_read_b128 v[92:95], v1 offset:3072
ds_read_b128 v[96:99], v1 offset:4096
ds_read_b128 v[100:103], v1 offset:5120
ds_read_b128 v[104:107], v1 offset:6144
ds_read_b128 v[108:111], v1 offset:7168
ds_read_b128 v[112:115], v1 offset:8192
ds_read_b128 v[116:119], v1 offset:9216
s_waitcnt lgkmcnt(5)
v_mfma_f32_16x16x32_bf16 v[8:11], v[80:83], v[32:35], v[8:11]
v_mfma_f32_16x16x32_bf16 v[12:15], v[84:87], v[32:35], v[12:15]
v_mfma_f32_16x16x32_bf16 v[16:19], v[88:91], v[32:35], v[16:19]
v_mfma_f32_16x16x32_bf16 v[20:23], v[92:95], v[32:35], v[20:23]
v_mfma_f32_16x16x32_bf16 v[24:27], v[96:99], v[32:35], v[24:27]
ds_read_b128 v[80:83], v1 offset:10240
ds_read_b128 v[84:87], v1 offset:11264
ds_read_b128 v[88:91], v1 offset:12288
ds_read_b128 v[92:95], v1 offset:13312
ds_read_b128 v[96:99], v1 offset:14336
s_waitcnt lgkmcnt(5)
v_mfma_f32_16x16x32_bf16 v[8:11], v[100:103], v[36:39], v[8:11]
v_mfma_f32_16x16x32_bf16 v[12:15], v[104:107], v[36:39], v[12:15]
v_mfma_f32_16x16x32_bf16 v[16:19], v[108:111], v[36:39], v[16:19]
v_mfma_f32_16x16x32_bf16 v[20:23], v[112:115], v[36:39], v[20:23]
v_mfma_f32_16x16x32_bf16 v[24:27], v[116:119], v[36:39], v[24:27]
ds_read_b128 v[100:103], v1 offset:15360
ds_read_b128 v[104:107], v1 offset:16384
ds_read_b128 v[108:111], v1 offset:17408
ds_read_b128 v[112:115], v1 offset:18432
ds_read_b128 v[116:119], v1 offset:19456
s_waitcnt lgkmcnt(5)
v_mfma_f32_16x16x32_bf16 v[8:11], v[80:83], v[40:43], v[8:11]
v_mfma_f32_16x16x32_bf16 v[12:15], v[84:87], v[40:43], v[12:15]
v_mfma_f32_16x16x32_bf16 v[16:19], v[88:91], v[40:43], v[16:19]
v_mfma_f32_16x16x32_bf16 v[20:23], v[92:95], v[40:43], v[20:23]
v_mfma_f32_16x16x32_bf16 v[24:27], v[96:99], v[40:43], v[24:27]
s_waitcnt lgkmcnt(0)
v_mfma_f32_16x16x32_bf16 v[8:11], v[100:103], v[44:47], v[8:11]
v_mfma_f32_16x16x32_bf16 v[12:15], v[104:107], v[44:47], v[12:15]
v_mfma_f32_16x16x32_bf16 v[16:19], v[108:111], v[44:47], v[16:19]
v_mfma_f32_16x16x32_bf16 v[20:23], v[112:115], v[44:47], v[20:23]
v_mfma_f32_16x16x32_bf16 v[24:27], v[116:119], v[44:47], v[24:27]
s_waitcnt vmcnt(0)
s_barrier
ds_read_b128 v[80:83], v1 offset:20480
ds_read_b128 v[84:87], v1 offset:21504
ds_read_b128 v[88:91], v1 offset:22528
ds_read_b128 v[92:95], v1 offset:23552
ds_read_b128 v[96:99], v1 offset:24576
ds_read_b128 v[100:103], v1 offset:25600
ds_read_b128 v[104:107], v1 offset:26624
ds_read_b128 v[108:111], v1 offset:27648
ds_read_b128 v[112:115], v1 offset:28672
ds_read_b128 v[116:119], v1 offset:29696
s_waitcnt lgkmcnt(5)
v_mfma_f32_16x16x32_bf16 v[8:11], v[80:83], v[48:51], v[8:11]
v_mfma_f32_16x16x32_bf16 v[12:15], v[84:87], v[48:51], v[12:15]
v_mfma_f32_16x16x32_bf16 v[16:19], v[88:91], v[48:51], v[16:19]
v_mfma_f32_16x16x32_bf16 v[20:23], v[92:95], v[48:51], v[20:23]
v_mfma_f32_16x16x32_bf16 v[24:27], v[96:99], v[48:51], v[24:27]
ds_read_b128 v[80:83], v1 offset:30720
ds_read_b128 v[84:87], v1 offset:31744
ds_read_b128 v[88:91], v1 offset:32768
ds_read_b128 v[92:95], v1 offset:33792
ds_read_b128 v[96:99], v1 offset:34816
s_waitcnt lgkmcnt(5)
v_mfma_f32_16x16x32_bf16 v[8:11], v[100:103], v[52:55], v[8:11]
v_mfma_f32_16x16x32_bf16 v[12:15], v[104:107], v[52:55], v[12:15]
v_mfma_f32_16x16x32_bf16 v[16:19], v[108:111], v[52:55], v[16:19]
v_mfma_f32_16x16x32_bf16 v[20:23], v[112:115], v[52:55], v[20:23]
v_mfma_f32_16x16x32_bf16 v[24:27], v[116:119], v[52:55], v[24:27]
ds_read_b128 v[100:103], v1 offset:35840
ds_read_b128 v[104:107], v1 offset:36864
ds_read_b128 v[108:111], v1 offset:37888
ds_read_b128 v[112:115], v1 offset:38912
ds_read_b128 v[116:119], v1 offset:39936
s_waitcnt lgkmcnt(5)
v_mfma_f32_16x16x32_bf16 v[8:11], v[80:83], v[56:59], v[8:11]
v_mfma_f32_16x16x32_bf16 v[12:15], v[84:87], v[56:59], v[12:15]
v_mfma_f32_16x16x32_bf16 v[16:19], v[88:91], v[56:59], v[16:19]
v_mfma_f32_16x16x32_bf16 v[20:23], v[92:95], v[56:59], v[20:23]
v_mfma_f32_16x16x32_bf16 v[24:27], v[96:99], v[56:59], v[24:27]
s_waitcnt lgkmcnt(0)
v_mfma_f32_16x16x32_bf16 v[8:11], v[100:103], v[60:63], v[8:11]
v_mfma_f32_16x16x32_bf16 v[12:15], v[104:107], v[60:63], v[12:15]
v_mfma_f32_16x16x32_bf16 v[16:19], v[108:111], v[60:63], v[16:19]
v_mfma_f32_16x16x32_bf16 v[20:23], v[112:115], v[60:63], v[20:23]
v_mfma_f32_16x16x32_bf16 v[24:27], v[116:119], v[60:63], v[24:27]
v_and_b32 v3, 63, v0
v_and_b32 v4, 15, v3
v_lshrrev_b32 v3, 4, v3
s_lshl_b32 s21, s17, 6
s_lshl_b32 s23, s16, 4
s_add_u32 s21, s21, s23
v_add_u32 v4, s21, v4
v_mul_u32_u24 v6, 1280, v4
v_lshl_add_u32 v6, v3, 4, v6
s_mul_i32 s21, s18, 5
s_add_u32 s23, s21, 0
s_lshr_b32 s31, s23, 1
s_lshl_b32 s31, s31, 6
s_and_b32 s23, s23, 1
s_lshl_b32 s23, s23, 3
s_add_u32 s32, s31, s23
s_add_u32 s40, s32, s20
buffer_load_dwordx2 v[32:33], v6, s[8:11], s40 offen
s_add_u32 s23, s21, 1
s_lshr_b32 s31, s23, 1
s_lshl_b32 s31, s31, 6
s_and_b32 s23, s23, 1
s_lshl_b32 s23, s23, 3
s_add_u32 s33, s31, s23
s_add_u32 s41, s33, s20
buffer_load_dwordx2 v[34:35], v6, s[8:11], s41 offen
s_add_u32 s23, s21, 2
s_lshr_b32 s31, s23, 1
s_lshl_b32 s31, s31, 6
s_and_b32 s23, s23, 1
s_lshl_b32 s23, s23, 3
s_add_u32 s34, s31, s23
s_add_u32 s42, s34, s20
buffer_load_dwordx2 v[36:37], v6, s[8:11], s42 offen
s_add_u32 s23, s21, 3
s_lshr_b32 s31, s23, 1
s_lshl_b32 s31, s31, 6
s_and_b32 s23, s23, 1
s_lshl_b32 s23, s23, 3
s_add_u32 s35, s31, s23
s_add_u32 s43, s35, s20
buffer_load_dwordx2 v[38:39], v6, s[8:11], s43 offen
s_add_u32 s23, s21, 4
s_lshr_b32 s31, s23, 1
s_lshl_b32 s31, s31, 6
s_and_b32 s23, s23, 1
s_lshl_b32 s23, s23, 3
s_add_u32 s36, s31, s23
s_add_u32 s44, s36, s20
buffer_load_dwordx2 v[40:41], v6, s[8:11], s44 offen
s_waitcnt vmcnt(0)
v_cvt_pk_bf16_f32 v80, v8, v9
v_cvt_pk_bf16_f32 v81, v10, v11
v_lshlrev_b32 v8, 16, v80
v_and_b32 v9, 0xffff0000, v80
v_lshlrev_b32 v10, 16, v81
v_and_b32 v11, 0xffff0000, v81
v_lshlrev_b32 v82, 16, v32
v_and_b32 v83, 0xffff0000, v32
v_lshlrev_b32 v84, 16, v33
v_and_b32 v85, 0xffff0000, v33
v_add_f32 v8, v8, v82
v_add_f32 v9, v9, v83
v_add_f32 v10, v10, v84
v_add_f32 v11, v11, v85
v_cvt_pk_bf16_f32 v32, v8, v9
v_cvt_pk_bf16_f32 v33, v10, v11
buffer_store_dwordx2 v[32:33], v6, s[52:55], s32 offen sc1
v_cvt_pk_bf16_f32 v80, v12, v13
v_cvt_pk_bf16_f32 v81, v14, v15
v_lshlrev_b32 v12, 16, v80
v_and_b32 v13, 0xffff0000, v80
v_lshlrev_b32 v14, 16, v81
v_and_b32 v15, 0xffff0000, v81
v_lshlrev_b32 v82, 16, v34
v_and_b32 v83, 0xffff0000, v34
v_lshlrev_b32 v84, 16, v35
v_and_b32 v85, 0xffff0000, v35
v_add_f32 v12, v12, v82
v_add_f32 v13, v13, v83
v_add_f32 v14, v14, v84
v_add_f32 v15, v15, v85
v_cvt_pk_bf16_f32 v34, v12, v13
v_cvt_pk_bf16_f32 v35, v14, v15
buffer_store_dwordx2 v[34:35], v6, s[52:55], s33 offen sc1
v_cvt_pk_bf16_f32 v80, v16, v17
v_cvt_pk_bf16_f32 v81, v18, v19
v_lshlrev_b32 v16, 16, v80
v_and_b32 v17, 0xffff0000, v80
v_lshlrev_b32 v18, 16, v81
v_and_b32 v19, 0xffff0000, v81
v_lshlrev_b32 v82, 16, v36
v_and_b32 v83, 0xffff0000, v36
v_lshlrev_b32 v84, 16, v37
v_and_b32 v85, 0xffff0000, v37
v_add_f32 v16, v16, v82
v_add_f32 v17, v17, v83
v_add_f32 v18, v18, v84
v_add_f32 v19, v19, v85
v_cvt_pk_bf16_f32 v36, v16, v17
v_cvt_pk_bf16_f32 v37, v18, v19
buffer_store_dwordx2 v[36:37], v6, s[52:55], s34 offen sc1
v_cvt_pk_bf16_f32 v80, v20, v21
v_cvt_pk_bf16_f32 v81, v22, v23
v_lshlrev_b32 v20, 16, v80
v_and_b32 v21, 0xffff0000, v80
v_lshlrev_b32 v22, 16, v81
v_and_b32 v23, 0xffff0000, v81
v_lshlrev_b32 v82, 16, v38
v_and_b32 v83, 0xffff0000, v38
v_lshlrev_b32 v84, 16, v39
v_and_b32 v85, 0xffff0000, v39
v_add_f32 v20, v20, v82
v_add_f32 v21, v21, v83
v_add_f32 v22, v22, v84
v_add_f32 v23, v23, v85
v_cvt_pk_bf16_f32 v38, v20, v21
v_cvt_pk_bf16_f32 v39, v22, v23
buffer_store_dwordx2 v[38:39], v6, s[52:55], s35 offen sc1
v_cvt_pk_bf16_f32 v80, v24, v25
v_cvt_pk_bf16_f32 v81, v26, v27
v_lshlrev_b32 v24, 16, v80
v_and_b32 v25, 0xffff0000, v80
v_lshlrev_b32 v26, 16, v81
v_and_b32 v27, 0xffff0000, v81
v_lshlrev_b32 v82, 16, v40
v_and_b32 v83, 0xffff0000, v40
v_lshlrev_b32 v84, 16, v41
v_and_b32 v85, 0xffff0000, v41
v_add_f32 v24, v24, v82
v_add_f32 v25, v25, v83
v_add_f32 v26, v26, v84
v_add_f32 v27, v27, v85
v_cvt_pk_bf16_f32 v40, v24, v25
v_cvt_pk_bf16_f32 v41, v26, v27
buffer_store_dwordx2 v[40:41], v6, s[52:55], s36 offen sc1
outb2_exit1:
s_endpgm
.section .rodata,"a"
.p2align 6
.amdhsa_kernel prep_kernel
  .amdhsa_next_free_vgpr 80
  .amdhsa_next_free_sgpr 64
  .amdhsa_accum_offset 80
  .amdhsa_group_segment_fixed_size 0
  .amdhsa_kernarg_size 104
  .amdhsa_user_sgpr_count 2
  .amdhsa_user_sgpr_kernarg_segment_ptr 1
  .amdhsa_system_sgpr_workgroup_id_x 1
  .amdhsa_float_denorm_mode_32 3
.end_amdhsa_kernel
.p2align 6
.amdhsa_kernel ln2_kernel
  .amdhsa_next_free_vgpr 80
  .amdhsa_next_free_sgpr 40
  .amdhsa_accum_offset 80
  .amdhsa_group_segment_fixed_size 0
  .amdhsa_kernarg_size 104
  .amdhsa_user_sgpr_count 2
  .amdhsa_user_sgpr_kernarg_segment_ptr 1
  .amdhsa_system_sgpr_workgroup_id_x 1
  .amdhsa_float_denorm_mode_32 3
.end_amdhsa_kernel
.p2align 6
.amdhsa_kernel reca_kernel
  .amdhsa_next_free_vgpr 512
  .amdhsa_next_free_sgpr 102
  .amdhsa_accum_offset 256
  .amdhsa_group_segment_fixed_size 0
  .amdhsa_kernarg_size 104
  .amdhsa_user_sgpr_count 2
  .amdhsa_user_sgpr_kernarg_segment_ptr 1
  .amdhsa_system_sgpr_workgroup_id_x 1
  .amdhsa_float_denorm_mode_32 3
.end_amdhsa_kernel
.p2align 6
.amdhsa_kernel fin_kernel
  .amdhsa_next_free_vgpr 496
  .amdhsa_next_free_sgpr 64
  .amdhsa_accum_offset 256
  .amdhsa_group_segment_fixed_size 0
  .amdhsa_kernarg_size 104
  .amdhsa_user_sgpr_count 2
  .amdhsa_user_sgpr_kernarg_segment_ptr 1
  .amdhsa_system_sgpr_workgroup_id_x 1
  .amdhsa_float_denorm_mode_32 3
.end_amdhsa_kernel
.p2align 6
.amdhsa_kernel redln1_kernel
  .amdhsa_next_free_vgpr 248
  .amdhsa_next_free_sgpr 48
  .amdhsa_accum_offset 248
  .amdhsa_group_segment_fixed_size 0
  .amdhsa_kernarg_size 104
  .amdhsa_user_sgpr_count 2
  .amdhsa_user_sgpr_kernarg_segment_ptr 1
  .amdhsa_system_sgpr_workgroup_id_x 1
  .amdhsa_float_denorm_mode_32 3
.end_amdhsa_kernel
.p2align 6
.amdhsa_kernel redln2_kernel
  .amdhsa_next_free_vgpr 248
  .amdhsa_next_free_sgpr 48
  .amdhsa_accum_offset 248
  .amdhsa_group_segment_fixed_size 0
  .amdhsa_kernarg_size 104
  .amdhsa_user_sgpr_count 2
  .amdhsa_user_sgpr_kernarg_segment_ptr 1
  .amdhsa_system_sgpr_workgroup_id_x 1
  .amdhsa_float_denorm_mode_32 3
.end_amdhsa_kernel
.p2align 6
.amdhsa_kernel qkvb_kernel
  .amdhsa_next_free_vgpr 176
  .amdhsa_next_free_sgpr 64
  .amdhsa_accum_offset 176
  .amdhsa_group_segment_fixed_size 0
  .amdhsa_kernarg_size 104
  .amdhsa_user_sgpr_count 2
  .amdhsa_user_sgpr_kernarg_segment_ptr 1
  .amdhsa_system_sgpr_workgroup_id_x 1
  .amdhsa_float_denorm_mode_32 3
.end_amdhsa_kernel
.p2align 6
.amdhsa_kernel attnb_kernel
  .amdhsa_next_free_vgpr 200
  .amdhsa_next_free_sgpr 48
  .amdhsa_accum_offset 200
  .amdhsa_group_segment_fixed_size 0
  .amdhsa_kernarg_size 104
  .amdhsa_user_sgpr_count 2
  .amdhsa_user_sgpr_kernarg_segment_ptr 1
  .amdhsa_system_sgpr_workgroup_id_x 1
  .amdhsa_float_denorm_mode_32 3
.end_amdhsa_kernel
.p2align 6
.amdhsa_kernel outb1_kernel
  .amdhsa_next_free_vgpr 128
  .amdhsa_next_free_sgpr 64
  .amdhsa_accum_offset 128
  .amdhsa_group_segment_fixed_size 0
  .amdhsa_kernarg_size 104
  .amdhsa_user_sgpr_count 2
  .amdhsa_user_sgpr_kernarg_segment_ptr 1
  .amdhsa_system_sgpr_workgroup_id_x 1
  .amdhsa_float_denorm_mode_32 3
.end_amdhsa_kernel
.p2align 6
.amdhsa_kernel outb2_kernel
  .amdhsa_next_free_vgpr 128
  .amdhsa_next_free_sgpr 64
  .amdhsa_accum_offset 128
  .amdhsa_group_segment_fixed_size 0
  .amdhsa_kernarg_size 104
  .amdhsa_user_sgpr_count 2
  .amdhsa_user_sgpr_kernarg_segment_ptr 1
  .amdhsa_system_sgpr_workgroup_id_x 1
  .amdhsa_float_denorm_mode_32 3
.end_amdhsa_kernel
```

```asm
; @launch kernel=prep_kernel grid=(2248,1,1) block=(256,1,1) lds=18944
; @launch kernel=reca_kernel grid=(256,1,1) block=(256,1,1) lds=81920
; @launch kernel=fin_kernel grid=(256,1,1) block=(256,1,1) lds=98304
; @launch kernel=redln1_kernel grid=(256,1,1) block=(128,1,1) lds=128
; @launch kernel=qkvb_kernel grid=(256,1,1) block=(256,1,1) lds=81920
; @launch kernel=attnb_kernel grid=(256,1,1) block=(256,1,1) lds=0
; @launch kernel=outb1_kernel grid=(256,1,1) block=(256,1,1) lds=61440
; @launch kernel=ln2_kernel grid=(128,1,1) block=(256,1,1) lds=512
; @launch kernel=reca_kernel grid=(256,1,1) block=(256,1,1) lds=81920
; @launch kernel=fin_kernel grid=(256,1,1) block=(256,1,1) lds=98304
; @launch kernel=redln2_kernel grid=(256,1,1) block=(128,1,1) lds=128
; @launch kernel=qkvb_kernel grid=(256,1,1) block=(256,1,1) lds=81920
; @launch kernel=attnb_kernel grid=(256,1,1) block=(256,1,1) lds=0
; @launch kernel=outb2_kernel grid=(256,1,1) block=(256,1,1) lds=61440
.amdgcn_target "amdgcn-amd-amdhsa--gfx950"
.text
.globl prep_kernel
.p2align 8
.type prep_kernel,@function
prep_kernel:
s_cmp_ge_u32 s2, 128
s_cbranch_scc1 prep_notln5
s_load_dwordx2 s[12:13], s[0:1], 96
s_load_dwordx2 s[14:15], s[0:1], 0
v_lshrrev_b32 v2, 6, v0
v_and_b32 v3, 63, v0
s_nop 0
v_readfirstlane_b32 s16, v2
s_waitcnt lgkmcnt(0)
s_mov_b32 s4, s12
s_mov_b32 s5, s13
s_mov_b32 s6, 0x10000000
s_mov_b32 s7, 0x20000
s_mov_b32 s8, s14
s_mov_b32 s9, s15
s_mov_b32 s10, 2621440
s_mov_b32 s11, 0x20000
s_mov_b32 s20, 0
v_and_b32 v2, 15, v3
v_lshrrev_b32 v4, 4, v3
s_lshl_b32 s17, s2, 4
v_add_u32 v1, s17, v2
v_mul_u32_u24 v1, 1280, v1
v_lshl_add_u32 v1, v4, 4, v1
s_mul_i32 s17, s16, 320
s_add_u32 s20, s20, s17
buffer_load_dwordx4 v[8:11], v1, s[8:11], s20 offen offset:0
buffer_load_dwordx4 v[12:15], v1, s[8:11], s20 offen offset:64
buffer_load_dwordx4 v[16:19], v1, s[8:11], s20 offen offset:128
buffer_load_dwordx4 v[20:23], v1, s[8:11], s20 offen offset:192
buffer_load_dwordx4 v[24:27], v1, s[8:11], s20 offen offset:256
s_sub_u32 s21, 0, s12
s_and_b32 s21, s21, 0x1fffff
s_add_u32 s21, s21, 2097152
v_mov_b32 v68, -1
v_mov_b32 v69, -1
v_mov_b32 v70, -1
v_mov_b32 v71, -1
v_lshlrev_b32 v72, 4, v0
s_mul_i32 s22, s2, 12096
s_add_u32 s22, s22, 0
s_mul_i32 s23, s2, 12288
s_add_u32 s23, s23, s21
buffer_store_dwordx4 v[68:71], v72, s[4:7], s22 offen sc1
s_add_u32 s22, s22, 4096
buffer_store_dwordx4 v[68:71], v72, s[4:7], s22 offen sc1
s_add_u32 s22, s22, 4096
v_mov_b32 v73, 0x80000000
v_cmp_gt_u32 vcc, 244, v0
s_nop 1
v_cndmask_b32 v73, v73, v72, vcc
buffer_store_dwordx4 v[68:71], v73, s[4:7], s22 offen
buffer_store_dwordx4 v[68:71], v72, s[4:7], s23 offen sc1
s_add_u32 s23, s23, 4096
buffer_store_dwordx4 v[68:71], v72, s[4:7], s23 offen sc1
s_add_u32 s23, s23, 4096
buffer_store_dwordx4 v[68:71], v72, s[4:7], s23 offen sc1
s_add_u32 s23, s23, 4096
s_mul_i32 s23, s2, 2048
s_add_u32 s23, s23, s21
s_add_u32 s23, s23, 1572864
v_mov_b32 v73, 0x80000000
v_cmp_gt_u32 vcc, 128, v0
s_nop 1
v_cndmask_b32 v73, v73, v72, vcc
buffer_store_dwordx4 v[68:71], v73, s[4:7], s23 offen sc1
s_waitcnt vmcnt(7)
s_mul_i32 s17, s16, 320
s_add_u32 s17, s17, 82313216
buffer_store_dwordx4 v[8:11], v1, s[4:7], s17 offen offset:0
buffer_store_dwordx4 v[12:15], v1, s[4:7], s17 offen offset:64
buffer_store_dwordx4 v[16:19], v1, s[4:7], s17 offen offset:128
buffer_store_dwordx4 v[20:23], v1, s[4:7], s17 offen offset:192
buffer_store_dwordx4 v[24:27], v1, s[4:7], s17 offen offset:256
v_lshlrev_b32 v5, 2, v2
s_lshl_b32 s17, s16, 6
v_add_u32 v1, s17, v5
s_waitcnt vmcnt(5)
v_lshlrev_b32 v28, 16, v8
v_and_b32 v29, 0xffff0000, v8
v_lshlrev_b32 v30, 16, v9
v_and_b32 v31, 0xffff0000, v9
v_lshlrev_b32 v32, 16, v10
v_and_b32 v33, 0xffff0000, v10
v_lshlrev_b32 v34, 16, v11
v_and_b32 v35, 0xffff0000, v11
v_lshlrev_b32 v36, 16, v12
v_and_b32 v37, 0xffff0000, v12
v_lshlrev_b32 v38, 16, v13
v_and_b32 v39, 0xffff0000, v13
v_lshlrev_b32 v40, 16, v14
v_and_b32 v41, 0xffff0000, v14
v_lshlrev_b32 v42, 16, v15
v_and_b32 v43, 0xffff0000, v15
v_lshlrev_b32 v44, 16, v16
v_and_b32 v45, 0xffff0000, v16
v_lshlrev_b32 v46, 16, v17
v_and_b32 v47, 0xffff0000, v17
v_lshlrev_b32 v48, 16, v18
v_and_b32 v49, 0xffff0000, v18
v_lshlrev_b32 v50, 16, v19
v_and_b32 v51, 0xffff0000, v19
v_lshlrev_b32 v52, 16, v20
v_and_b32 v53, 0xffff0000, v20
v_lshlrev_b32 v54, 16, v21
v_and_b32 v55, 0xffff0000, v21
v_lshlrev_b32 v56, 16, v22
v_and_b32 v57, 0xffff0000, v22
v_lshlrev_b32 v58, 16, v23
v_and_b32 v59, 0xffff0000, v23
v_lshlrev_b32 v60, 16, v24
v_and_b32 v61, 0xffff0000, v24
v_lshlrev_b32 v62, 16, v25
v_and_b32 v63, 0xffff0000, v25
v_lshlrev_b32 v64, 16, v26
v_and_b32 v65, 0xffff0000, v26
v_lshlrev_b32 v66, 16, v27
v_and_b32 v67, 0xffff0000, v27
v_pk_add_f32 v[6:7], v[28:29], v[30:31]
v_pk_add_f32 v[6:7], v[6:7], v[32:33]
v_pk_add_f32 v[6:7], v[6:7], v[34:35]
v_pk_add_f32 v[6:7], v[6:7], v[36:37]
v_pk_add_f32 v[6:7], v[6:7], v[38:39]
v_pk_add_f32 v[6:7], v[6:7], v[40:41]
v_pk_add_f32 v[6:7], v[6:7], v[42:43]
v_pk_add_f32 v[6:7], v[6:7], v[44:45]
v_pk_add_f32 v[6:7], v[6:7], v[46:47]
v_pk_add_f32 v[6:7], v[6:7], v[48:49]
v_pk_add_f32 v[6:7], v[6:7], v[50:51]
v_pk_add_f32 v[6:7], v[6:7], v[52:53]
v_pk_add_f32 v[6:7], v[6:7], v[54:55]
v_pk_add_f32 v[6:7], v[6:7], v[56:57]
v_pk_add_f32 v[6:7], v[6:7], v[58:59]
v_pk_add_f32 v[6:7], v[6:7], v[60:61]
v_pk_add_f32 v[6:7], v[6:7], v[62:63]
v_pk_add_f32 v[6:7], v[6:7], v[64:65]
v_pk_add_f32 v[6:7], v[6:7], v[66:67]
v_add_f32 v4, v6, v7
v_mov_b32 v2, v4
s_nop 1
v_permlane32_swap_b32 v4, v2
v_add_f32 v4, v4, v2
v_mov_b32 v2, v4
s_nop 1
v_permlane16_swap_b32 v4, v2
v_add_f32 v4, v4, v2
ds_write_b32 v1, v4 offset:0
s_waitcnt lgkmcnt(0)
s_barrier
ds_read_b32 v4, v5 offset:0
ds_read_b32 v2, v5 offset:64
ds_read_b32 v3, v5 offset:128
ds_read_b32 v6, v5 offset:192
s_waitcnt lgkmcnt(0)
v_add_f32 v4, v4, v2
v_add_f32 v3, v3, v6
v_add_f32 v4, v4, v3
v_mul_f32 v4, 0x3acccccd, v4
v_sub_f32 v28, v28, v4
v_sub_f32 v29, v29, v4
v_sub_f32 v30, v30, v4
v_sub_f32 v31, v31, v4
v_sub_f32 v32, v32, v4
v_sub_f32 v33, v33, v4
v_sub_f32 v34, v34, v4
v_sub_f32 v35, v35, v4
v_sub_f32 v36, v36, v4
v_sub_f32 v37, v37, v4
v_sub_f32 v38, v38, v4
v_sub_f32 v39, v39, v4
v_sub_f32 v40, v40, v4
v_sub_f32 v41, v41, v4
v_sub_f32 v42, v42, v4
v_sub_f32 v43, v43, v4
v_sub_f32 v44, v44, v4
v_sub_f32 v45, v45, v4
v_sub_f32 v46, v46, v4
v_sub_f32 v47, v47, v4
v_sub_f32 v48, v48, v4
v_sub_f32 v49, v49, v4
v_sub_f32 v50, v50, v4
v_sub_f32 v51, v51, v4
v_sub_f32 v52, v52, v4
v_sub_f32 v53, v53, v4
v_sub_f32 v54, v54, v4
v_sub_f32 v55, v55, v4
v_sub_f32 v56, v56, v4
v_sub_f32 v57, v57, v4
v_sub_f32 v58, v58, v4
v_sub_f32 v59, v59, v4
v_sub_f32 v60, v60, v4
v_sub_f32 v61, v61, v4
v_sub_f32 v62, v62, v4
v_sub_f32 v63, v63, v4
v_sub_f32 v64, v64, v4
v_sub_f32 v65, v65, v4
v_sub_f32 v66, v66, v4
v_sub_f32 v67, v67, v4
v_mul_f32 v6, v28, v28
v_mul_f32 v7, v29, v29
v_fmac_f32 v6, v30, v30
v_fmac_f32 v7, v31, v31
v_fmac_f32 v6, v32, v32
v_fmac_f32 v7, v33, v33
v_fmac_f32 v6, v34, v34
v_fmac_f32 v7, v35, v35
v_fmac_f32 v6, v36, v36
v_fmac_f32 v7, v37, v37
v_fmac_f32 v6, v38, v38
v_fmac_f32 v7, v39, v39
v_fmac_f32 v6, v40, v40
v_fmac_f32 v7, v41, v41
v_fmac_f32 v6, v42, v42
v_fmac_f32 v7, v43, v43
v_fmac_f32 v6, v44, v44
v_fmac_f32 v7, v45, v45
v_fmac_f32 v6, v46, v46
v_fmac_f32 v7, v47, v47
v_fmac_f32 v6, v48, v48
v_fmac_f32 v7, v49, v49
v_fmac_f32 v6, v50, v50
v_fmac_f32 v7, v51, v51
v_fmac_f32 v6, v52, v52
v_fmac_f32 v7, v53, v53
v_fmac_f32 v6, v54, v54
v_fmac_f32 v7, v55, v55
v_fmac_f32 v6, v56, v56
v_fmac_f32 v7, v57, v57
v_fmac_f32 v6, v58, v58
v_fmac_f32 v7, v59, v59
v_fmac_f32 v6, v60, v60
v_fmac_f32 v7, v61, v61
v_fmac_f32 v6, v62, v62
v_fmac_f32 v7, v63, v63
v_fmac_f32 v6, v64, v64
v_fmac_f32 v7, v65, v65
v_fmac_f32 v6, v66, v66
v_fmac_f32 v7, v67, v67
v_add_f32 v4, v6, v7
v_mov_b32 v2, v4
s_nop 1
v_permlane32_swap_b32 v4, v2
v_add_f32 v4, v4, v2
v_mov_b32 v2, v4
s_nop 1
v_permlane16_swap_b32 v4, v2
v_add_f32 v4, v4, v2
ds_write_b32 v1, v4 offset:256
s_waitcnt lgkmcnt(0)
s_barrier
ds_read_b32 v4, v5 offset:256
ds_read_b32 v2, v5 offset:320
ds_read_b32 v3, v5 offset:384
ds_read_b32 v6, v5 offset:448
s_waitcnt lgkmcnt(0)
v_add_f32 v4, v4, v2
v_add_f32 v3, v3, v6
v_add_f32 v4, v4, v3
v_mov_b32 v2, 0x3727c5ac
v_fmac_f32 v2, 0x3acccccd, v4
v_rsq_f32 v4, v2
s_nop 0
v_mul_f32 v28, v28, v4
v_mul_f32 v29, v29, v4
v_mul_f32 v30, v30, v4
v_mul_f32 v31, v31, v4
v_mul_f32 v32, v32, v4
v_mul_f32 v33, v33, v4
v_mul_f32 v34, v34, v4
v_mul_f32 v35, v35, v4
v_mul_f32 v36, v36, v4
v_mul_f32 v37, v37, v4
v_mul_f32 v38, v38, v4
v_mul_f32 v39, v39, v4
v_mul_f32 v40, v40, v4
v_mul_f32 v41, v41, v4
v_mul_f32 v42, v42, v4
v_mul_f32 v43, v43, v4
v_mul_f32 v44, v44, v4
v_mul_f32 v45, v45, v4
v_mul_f32 v46, v46, v4
v_mul_f32 v47, v47, v4
v_mul_f32 v48, v48, v4
v_mul_f32 v49, v49, v4
v_mul_f32 v50, v50, v4
v_mul_f32 v51, v51, v4
v_mul_f32 v52, v52, v4
v_mul_f32 v53, v53, v4
v_mul_f32 v54, v54, v4
v_mul_f32 v55, v55, v4
v_mul_f32 v56, v56, v4
v_mul_f32 v57, v57, v4
v_mul_f32 v58, v58, v4
v_mul_f32 v59, v59, v4
v_mul_f32 v60, v60, v4
v_mul_f32 v61, v61, v4
v_mul_f32 v62, v62, v4
v_mul_f32 v63, v63, v4
v_mul_f32 v64, v64, v4
v_mul_f32 v65, v65, v4
v_mul_f32 v66, v66, v4
v_mul_f32 v67, v67, v4
v_cvt_pk_bf16_f32 v8, v28, v29
v_cvt_pk_bf16_f32 v9, v30, v31
v_cvt_pk_bf16_f32 v10, v32, v33
v_cvt_pk_bf16_f32 v11, v34, v35
v_cvt_pk_bf16_f32 v12, v36, v37
v_cvt_pk_bf16_f32 v13, v38, v39
v_cvt_pk_bf16_f32 v14, v40, v41
v_cvt_pk_bf16_f32 v15, v42, v43
v_cvt_pk_bf16_f32 v16, v44, v45
v_cvt_pk_bf16_f32 v17, v46, v47
v_cvt_pk_bf16_f32 v18, v48, v49
v_cvt_pk_bf16_f32 v19, v50, v51
v_cvt_pk_bf16_f32 v20, v52, v53
v_cvt_pk_bf16_f32 v21, v54, v55
v_cvt_pk_bf16_f32 v22, v56, v57
v_cvt_pk_bf16_f32 v23, v58, v59
v_cvt_pk_bf16_f32 v24, v60, v61
v_cvt_pk_bf16_f32 v25, v62, v63
v_cvt_pk_bf16_f32 v26, v64, v65
v_cvt_pk_bf16_f32 v27, v66, v67
v_and_b32 v3, 63, v0
v_lshlrev_b32 v1, 4, v3
s_mul_i32 s17, s2, 20480
s_mul_i32 s18, s16, 5120
s_add_u32 s17, s17, s18
s_add_u32 s17, s17, 84934656
buffer_store_dwordx4 v[8:11], v1, s[4:7], s17 offen offset:0 sc1
buffer_store_dwordx4 v[12:15], v1, s[4:7], s17 offen offset:1024 sc1
buffer_store_dwordx4 v[16:19], v1, s[4:7], s17 offen offset:2048 sc1
buffer_store_dwordx4 v[20:23], v1, s[4:7], s17 offen offset:3072 sc1
s_add_u32 s17, s17, 4096
buffer_store_dwordx4 v[24:27], v1, s[4:7], s17 offen offset:0 sc1
s_endpgm
prep_notln5:
s_sub_u32 s2, s2, 128
s_cmp_ge_u32 s2, 2120
s_cbranch_scc1 prep_exit1
s_load_dwordx2 s[12:13], s[0:1], 96
s_load_dwordx4 s[16:19], s[0:1], 16
s_load_dwordx4 s[20:23], s[0:1], 32
s_load_dwordx4 s[24:27], s[0:1], 64
v_lshrrev_b32 v6, 6, v0
v_and_b32 v1, 63, v0
s_nop 0
v_readfirstlane_b32 s14, v6
v_lshlrev_b32 v5, 4, v1
s_lshl_b32 s15, s2, 2
s_nop 1
s_add_u32 s15, s15, s14
s_add_u32 s28, s15, 7680
s_sub_u32 s29, s15, 800
s_cmp_lt_u32 s15, 800
s_cselect_b32 s15, s28, s29
s_waitcnt lgkmcnt(0)
s_mov_b32 s4, s12
s_mov_b32 s5, s13
s_mov_b32 s6, 0x10000000
s_mov_b32 s7, 0x20000
s_mov_b32 s11, 0x20000
v_and_b32 v2, 15, v1
v_lshrrev_b32 v3, 4, v1
s_cmp_ge_u32 s15, 5760
s_cbranch_scc1 prep_s22
s_mul_hi_u32 s31, s15, 2236963
s_mul_i32 s32, s31, 1920
s_sub_u32 s32, s15, s32
s_mul_hi_u32 s34, s32, 44739243
s_mul_i32 s33, s34, 96
s_sub_u32 s33, s32, s33
s_cmp_eq_u32 s31, 0
s_cselect_b32 s8, s16, s18
s_cselect_b32 s9, s17, s19
s_cmp_eq_u32 s31, 2
s_cselect_b32 s8, s20, s8
s_cselect_b32 s9, s21, s9
s_mov_b32 s10, 7864320
s_mul_i32 s35, s31, 7864320
s_add_u32 s35, s35, 6291456
v_lshrrev_b32 v6, 3, v1
s_lshl_b32 s36, s34, 5
v_add_u32 v6, s36, v6
s_mov_b32 s37, 12288
v_mul_lo_u32 v4, v6, s37
s_lshl_b32 s36, s33, 7
v_and_b32 v6, 7, v1
v_lshl_add_u32 v4, v6, 4, v4
v_add_u32 v4, s36, v4
v_lshrrev_b32 v6, 3, v1
v_mul_u32_u24 v12, 144, v6
v_and_b32 v6, 7, v1
v_lshl_add_u32 v12, v6, 4, v12
s_mul_i32 s36, s14, 4608
s_add_u32 s36, s36, 512
v_add_u32 v12, s36, v12
s_mov_b32 s29, 0
buffer_load_dwordx4 v[16:19], v4, s[8:11], s29 offen
s_mov_b32 s29, 98304
buffer_load_dwordx4 v[20:23], v4, s[8:11], s29 offen
s_mov_b32 s29, 196608
buffer_load_dwordx4 v[24:27], v4, s[8:11], s29 offen
s_mov_b32 s29, 294912
buffer_load_dwordx4 v[28:31], v4, s[8:11], s29 offen
v_bfe_u32 v6, v1, 2, 2
v_lshlrev_b32 v13, 3, v3
v_add_u32 v13, v13, v6
v_mul_u32_u24 v13, 144, v13
v_and_b32 v6, 3, v1
v_lshl_add_u32 v13, v6, 3, v13
v_add_u32 v13, s36, v13
s_waitcnt vmcnt(3)
ds_write_b128 v12, v[16:19] offset:0
s_waitcnt vmcnt(2)
ds_write_b128 v12, v[20:23] offset:1152
s_waitcnt vmcnt(1)
ds_write_b128 v12, v[24:27] offset:2304
s_waitcnt vmcnt(0)
ds_write_b128 v12, v[28:31] offset:3456
s_waitcnt lgkmcnt(0)
ds_read_b64_tr_b16 v[48:49], v13 offset:0
ds_read_b64_tr_b16 v[50:51], v13 offset:576
ds_read_b64_tr_b16 v[52:53], v13 offset:32
ds_read_b64_tr_b16 v[54:55], v13 offset:608
ds_read_b64_tr_b16 v[56:57], v13 offset:64
ds_read_b64_tr_b16 v[58:59], v13 offset:640
ds_read_b64_tr_b16 v[60:61], v13 offset:96
ds_read_b64_tr_b16 v[62:63], v13 offset:672
s_waitcnt lgkmcnt(6)
s_lshl_b32 s30, s33, 2
s_add_u32 s30, s30, 0
s_mul_i32 s30, s30, 20
s_add_u32 s30, s30, s34
s_lshl_b32 s30, s30, 10
s_add_u32 s30, s30, s35
buffer_store_dwordx4 v[48:51], v5, s[4:7], s30 offen sc1
s_waitcnt lgkmcnt(4)
s_lshl_b32 s30, s33, 2
s_add_u32 s30, s30, 1
s_mul_i32 s30, s30, 20
s_add_u32 s30, s30, s34
s_lshl_b32 s30, s30, 10
s_add_u32 s30, s30, s35
buffer_store_dwordx4 v[52:55], v5, s[4:7], s30 offen sc1
s_waitcnt lgkmcnt(2)
s_lshl_b32 s30, s33, 2
s_add_u32 s30, s30, 2
s_mul_i32 s30, s30, 20
s_add_u32 s30, s30, s34
s_lshl_b32 s30, s30, 10
s_add_u32 s30, s30, s35
buffer_store_dwordx4 v[56:59], v5, s[4:7], s30 offen sc1
s_waitcnt lgkmcnt(0)
s_lshl_b32 s30, s33, 2
s_add_u32 s30, s30, 3
s_mul_i32 s30, s30, 20
s_add_u32 s30, s30, s34
s_lshl_b32 s30, s30, 10
s_add_u32 s30, s30, s35
buffer_store_dwordx4 v[60:63], v5, s[4:7], s30 offen sc1
s_branch prep_exit1
prep_s22:
s_sub_u32 s15, s15, 5760
s_cmp_ge_u32 s15, 1920
s_cbranch_scc1 prep_s33
s_mul_hi_u32 s34, s15, 429496730
s_mul_i32 s33, s34, 10
s_sub_u32 s33, s15, s33
s_mov_b32 s8, s22
s_mov_b32 s9, s23
s_mov_b32 s10, 7864320
v_lshrrev_b32 v6, 3, v1
s_lshl_b32 s36, s34, 5
v_add_u32 v6, s36, v6
v_mul_u32_u24 v4, 1280, v6
s_lshl_b32 s36, s33, 7
v_and_b32 v6, 7, v1
v_lshl_add_u32 v4, v6, 4, v4
v_add_u32 v4, s36, v4
v_lshrrev_b32 v6, 3, v1
v_mul_u32_u24 v12, 144, v6
v_and_b32 v6, 7, v1
v_lshl_add_u32 v12, v6, 4, v12
s_mul_i32 s36, s14, 4608
s_add_u32 s36, s36, 512
v_add_u32 v12, s36, v12
s_mov_b32 s29, 0
buffer_load_dwordx4 v[16:19], v4, s[8:11], s29 offen
s_mov_b32 s29, 10240
buffer_load_dwordx4 v[20:23], v4, s[8:11], s29 offen
s_mov_b32 s29, 20480
buffer_load_dwordx4 v[24:27], v4, s[8:11], s29 offen
s_mov_b32 s29, 30720
buffer_load_dwordx4 v[28:31], v4, s[8:11], s29 offen
v_bfe_u32 v6, v1, 2, 2
v_lshlrev_b32 v13, 2, v3
v_add_u32 v13, v13, v6
v_mul_u32_u24 v13, 144, v13
v_and_b32 v6, 3, v1
v_lshl_add_u32 v13, v6, 4, v13
v_add_u32 v13, s36, v13
s_waitcnt vmcnt(3)
ds_write_b128 v12, v[16:19] offset:0
s_waitcnt vmcnt(2)
ds_write_b128 v12, v[20:23] offset:1152
s_waitcnt vmcnt(1)
ds_write_b128 v12, v[24:27] offset:2304
s_waitcnt vmcnt(0)
ds_write_b128 v12, v[28:31] offset:3456
s_waitcnt lgkmcnt(0)
ds_read_b64_tr_b16 v[48:49], v13 offset:0
ds_read_b64_tr_b16 v[50:51], v13 offset:2304
ds_read_b64_tr_b16 v[52:53], v13 offset:8
ds_read_b64_tr_b16 v[54:55], v13 offset:2312
ds_read_b64_tr_b16 v[56:57], v13 offset:64
ds_read_b64_tr_b16 v[58:59], v13 offset:2368
ds_read_b64_tr_b16 v[60:61], v13 offset:72
ds_read_b64_tr_b16 v[62:63], v13 offset:2376
s_waitcnt lgkmcnt(6)
s_lshl_b32 s30, s33, 2
s_add_u32 s30, s30, 0
s_mul_i32 s30, s30, 192
s_add_u32 s30, s30, s34
s_lshl_b32 s30, s30, 10
s_add_u32 s30, s30, 29884416
buffer_store_dwordx4 v[48:51], v5, s[4:7], s30 offen sc1
s_waitcnt lgkmcnt(4)
s_lshl_b32 s30, s33, 2
s_add_u32 s30, s30, 1
s_mul_i32 s30, s30, 192
s_add_u32 s30, s30, s34
s_lshl_b32 s30, s30, 10
s_add_u32 s30, s30, 29884416
buffer_store_dwordx4 v[52:55], v5, s[4:7], s30 offen sc1
s_waitcnt lgkmcnt(2)
s_lshl_b32 s30, s33, 2
s_add_u32 s30, s30, 2
s_mul_i32 s30, s30, 192
s_add_u32 s30, s30, s34
s_lshl_b32 s30, s30, 10
s_add_u32 s30, s30, 29884416
buffer_store_dwordx4 v[56:59], v5, s[4:7], s30 offen sc1
s_waitcnt lgkmcnt(0)
s_lshl_b32 s30, s33, 2
s_add_u32 s30, s30, 3
s_mul_i32 s30, s30, 192
s_add_u32 s30, s30, s34
s_lshl_b32 s30, s30, 10
s_add_u32 s30, s30, 29884416
buffer_store_dwordx4 v[60:63], v5, s[4:7], s30 offen sc1
s_branch prep_exit1
prep_s33:
s_sub_u32 s15, s15, 1920
s_cmp_ge_u32 s15, 600
s_cbranch_scc1 prep_s44
s_mul_hi_u32 s34, s15, 143165577
s_mul_i32 s33, s34, 30
s_sub_u32 s33, s15, s33
s_mov_b32 s8, s24
s_mov_b32 s9, s25
s_mov_b32 s10, 2457600
v_lshrrev_b32 v6, 3, v1
s_lshl_b32 s36, s34, 5
v_add_u32 v6, s36, v6
v_mul_u32_u24 v4, 3840, v6
s_lshl_b32 s36, s33, 7
v_and_b32 v6, 7, v1
v_lshl_add_u32 v4, v6, 4, v4
v_add_u32 v4, s36, v4
v_lshrrev_b32 v6, 3, v1
v_mul_u32_u24 v12, 144, v6
v_and_b32 v6, 7, v1
v_lshl_add_u32 v12, v6, 4, v12
s_mul_i32 s36, s14, 4608
s_add_u32 s36, s36, 512
v_add_u32 v12, s36, v12
s_mov_b32 s29, 0
buffer_load_dwordx4 v[16:19], v4, s[8:11], s29 offen
s_mov_b32 s29, 30720
buffer_load_dwordx4 v[20:23], v4, s[8:11], s29 offen
s_mov_b32 s29, 61440
buffer_load_dwordx4 v[24:27], v4, s[8:11], s29 offen
s_mov_b32 s29, 92160
buffer_load_dwordx4 v[28:31], v4, s[8:11], s29 offen
v_bfe_u32 v6, v1, 2, 2
v_lshlrev_b32 v13, 3, v3
v_add_u32 v13, v13, v6
v_mul_u32_u24 v13, 144, v13
v_and_b32 v6, 3, v1
v_lshl_add_u32 v13, v6, 3, v13
v_add_u32 v13, s36, v13
s_waitcnt vmcnt(3)
ds_write_b128 v12, v[16:19] offset:0
s_waitcnt vmcnt(2)
ds_write_b128 v12, v[20:23] offset:1152
s_waitcnt vmcnt(1)
ds_write_b128 v12, v[24:27] offset:2304
s_waitcnt vmcnt(0)
ds_write_b128 v12, v[28:31] offset:3456
s_waitcnt lgkmcnt(0)
ds_read_b64_tr_b16 v[48:49], v13 offset:0
ds_read_b64_tr_b16 v[50:51], v13 offset:576
ds_read_b64_tr_b16 v[52:53], v13 offset:32
ds_read_b64_tr_b16 v[54:55], v13 offset:608
ds_read_b64_tr_b16 v[56:57], v13 offset:64
ds_read_b64_tr_b16 v[58:59], v13 offset:640
ds_read_b64_tr_b16 v[60:61], v13 offset:96
ds_read_b64_tr_b16 v[62:63], v13 offset:672
s_waitcnt lgkmcnt(6)
s_lshl_b32 s30, s33, 2
s_add_u32 s30, s30, 0
s_mul_i32 s30, s30, 20
s_add_u32 s30, s30, s34
s_lshl_b32 s30, s30, 10
s_add_u32 s30, s30, 87556096
buffer_store_dwordx4 v[48:51], v5, s[4:7], s30 offen sc1
s_waitcnt lgkmcnt(4)
s_lshl_b32 s30, s33, 2
s_add_u32 s30, s30, 1
s_mul_i32 s30, s30, 20
s_add_u32 s30, s30, s34
s_lshl_b32 s30, s30, 10
s_add_u32 s30, s30, 87556096
buffer_store_dwordx4 v[52:55], v5, s[4:7], s30 offen sc1
s_waitcnt lgkmcnt(2)
s_lshl_b32 s30, s33, 2
s_add_u32 s30, s30, 2
s_mul_i32 s30, s30, 20
s_add_u32 s30, s30, s34
s_lshl_b32 s30, s30, 10
s_add_u32 s30, s30, 87556096
buffer_store_dwordx4 v[56:59], v5, s[4:7], s30 offen sc1
s_waitcnt lgkmcnt(0)
s_lshl_b32 s30, s33, 2
s_add_u32 s30, s30, 3
s_mul_i32 s30, s30, 20
s_add_u32 s30, s30, s34
s_lshl_b32 s30, s30, 10
s_add_u32 s30, s30, 87556096
buffer_store_dwordx4 v[60:63], v5, s[4:7], s30 offen sc1
s_branch prep_exit1
prep_s44:
s_sub_u32 s15, s15, 600
s_mul_hi_u32 s34, s15, 429496730
s_mul_i32 s33, s34, 10
s_sub_u32 s33, s15, s33
s_mov_b32 s8, s26
s_mov_b32 s9, s27
s_mov_b32 s10, 819200
v_lshrrev_b32 v6, 3, v1
s_lshl_b32 s36, s34, 5
v_add_u32 v6, s36, v6
v_mul_u32_u24 v4, 1280, v6
s_lshl_b32 s36, s33, 7
v_and_b32 v6, 7, v1
v_lshl_add_u32 v4, v6, 4, v4
v_add_u32 v4, s36, v4
v_lshrrev_b32 v6, 3, v1
v_mul_u32_u24 v12, 144, v6
v_and_b32 v6, 7, v1
v_lshl_add_u32 v12, v6, 4, v12
s_mul_i32 s36, s14, 4608
s_add_u32 s36, s36, 512
v_add_u32 v12, s36, v12
s_mov_b32 s29, 0
buffer_load_dwordx4 v[16:19], v4, s[8:11], s29 offen
s_mov_b32 s29, 10240
buffer_load_dwordx4 v[20:23], v4, s[8:11], s29 offen
s_mov_b32 s29, 20480
buffer_load_dwordx4 v[24:27], v4, s[8:11], s29 offen
s_mov_b32 s29, 30720
buffer_load_dwordx4 v[28:31], v4, s[8:11], s29 offen
v_bfe_u32 v6, v1, 2, 2
v_lshlrev_b32 v13, 3, v3
v_add_u32 v13, v13, v6
v_mul_u32_u24 v13, 144, v13
v_and_b32 v6, 3, v1
v_lshl_add_u32 v13, v6, 4, v13
v_add_u32 v13, s36, v13
s_waitcnt vmcnt(3)
ds_write_b128 v12, v[16:19] offset:0
s_waitcnt vmcnt(2)
ds_write_b128 v12, v[20:23] offset:1152
s_waitcnt vmcnt(1)
ds_write_b128 v12, v[24:27] offset:2304
s_waitcnt vmcnt(0)
ds_write_b128 v12, v[28:31] offset:3456
s_waitcnt lgkmcnt(0)
ds_read_b64_tr_b16 v[48:49], v13 offset:0
ds_read_b64_tr_b16 v[50:51], v13 offset:576
ds_read_b64_tr_b16 v[52:53], v13 offset:8
ds_read_b64_tr_b16 v[54:55], v13 offset:584
ds_read_b64_tr_b16 v[56:57], v13 offset:64
ds_read_b64_tr_b16 v[58:59], v13 offset:640
ds_read_b64_tr_b16 v[60:61], v13 offset:72
ds_read_b64_tr_b16 v[62:63], v13 offset:648
s_waitcnt lgkmcnt(6)
s_lshl_b32 s30, s33, 2
s_add_u32 s30, s30, 0
s_mul_i32 s30, s30, 20
s_add_u32 s30, s30, s34
s_lshl_b32 s30, s30, 10
s_add_u32 s30, s30, 90013696
buffer_store_dwordx4 v[48:51], v5, s[4:7], s30 offen sc1
s_waitcnt lgkmcnt(4)
s_lshl_b32 s30, s33, 2
s_add_u32 s30, s30, 1
s_mul_i32 s30, s30, 20
s_add_u32 s30, s30, s34
s_lshl_b32 s30, s30, 10
s_add_u32 s30, s30, 90013696
buffer_store_dwordx4 v[52:55], v5, s[4:7], s30 offen sc1
s_waitcnt lgkmcnt(2)
s_lshl_b32 s30, s33, 2
s_add_u32 s30, s30, 2
s_mul_i32 s30, s30, 20
s_add_u32 s30, s30, s34
s_lshl_b32 s30, s30, 10
s_add_u32 s30, s30, 90013696
buffer_store_dwordx4 v[56:59], v5, s[4:7], s30 offen sc1
s_waitcnt lgkmcnt(0)
s_lshl_b32 s30, s33, 2
s_add_u32 s30, s30, 3
s_mul_i32 s30, s30, 20
s_add_u32 s30, s30, s34
s_lshl_b32 s30, s30, 10
s_add_u32 s30, s30, 90013696
buffer_store_dwordx4 v[60:63], v5, s[4:7], s30 offen sc1
prep_exit1:
s_endpgm
.globl ln2_kernel
.p2align 8
.type ln2_kernel,@function
ln2_kernel:
s_cmp_ge_u32 s2, 128
s_cbranch_scc1 ln2_exit1
s_load_dwordx2 s[12:13], s[0:1], 96
s_load_dwordx2 s[14:15], s[0:1], 0
v_lshrrev_b32 v2, 6, v0
v_and_b32 v3, 63, v0
s_nop 0
v_readfirstlane_b32 s16, v2
s_waitcnt lgkmcnt(0)
s_mov_b32 s4, s12
s_mov_b32 s5, s13
s_mov_b32 s6, 0x10000000
s_mov_b32 s7, 0x20000
s_mov_b32 s8, s12
s_mov_b32 s9, s13
s_mov_b32 s10, 0x10000000
s_mov_b32 s11, 0x20000
s_mov_b32 s20, 82313216
v_and_b32 v2, 15, v3
v_lshrrev_b32 v4, 4, v3
s_lshl_b32 s17, s2, 4
v_add_u32 v1, s17, v2
v_mul_u32_u24 v1, 1280, v1
v_lshl_add_u32 v1, v4, 4, v1
s_mul_i32 s17, s16, 320
s_add_u32 s20, s20, s17
buffer_load_dwordx4 v[8:11], v1, s[8:11], s20 offen offset:0
buffer_load_dwordx4 v[12:15], v1, s[8:11], s20 offen offset:64
buffer_load_dwordx4 v[16:19], v1, s[8:11], s20 offen offset:128
buffer_load_dwordx4 v[20:23], v1, s[8:11], s20 offen offset:192
buffer_load_dwordx4 v[24:27], v1, s[8:11], s20 offen offset:256
s_sub_u32 s21, 0, s12
s_and_b32 s21, s21, 0x1fffff
s_add_u32 s21, s21, 2097152
v_mov_b32 v68, -1
v_mov_b32 v69, -1
v_mov_b32 v70, -1
v_mov_b32 v71, -1
v_lshlrev_b32 v72, 4, v0
s_mul_i32 s22, s2, 12096
s_add_u32 s22, s22, 0
s_mul_i32 s23, s2, 12288
s_add_u32 s23, s23, s21
buffer_store_dwordx4 v[68:71], v72, s[4:7], s22 offen sc1
s_add_u32 s22, s22, 4096
buffer_store_dwordx4 v[68:71], v72, s[4:7], s22 offen sc1
s_add_u32 s22, s22, 4096
v_mov_b32 v73, 0x80000000
v_cmp_gt_u32 vcc, 244, v0
s_nop 1
v_cndmask_b32 v73, v73, v72, vcc
buffer_store_dwordx4 v[68:71], v73, s[4:7], s22 offen
buffer_store_dwordx4 v[68:71], v72, s[4:7], s23 offen sc1
s_add_u32 s23, s23, 4096
buffer_store_dwordx4 v[68:71], v72, s[4:7], s23 offen sc1
s_add_u32 s23, s23, 4096
buffer_store_dwordx4 v[68:71], v72, s[4:7], s23 offen sc1
s_add_u32 s23, s23, 4096
s_mul_i32 s23, s2, 2048
s_add_u32 s23, s23, s21
s_add_u32 s23, s23, 1572864
v_mov_b32 v73, 0x80000000
v_cmp_gt_u32 vcc, 128, v0
s_nop 1
v_cndmask_b32 v73, v73, v72, vcc
buffer_store_dwordx4 v[68:71], v73, s[4:7], s23 offen sc1
v_lshlrev_b32 v5, 2, v2
s_lshl_b32 s17, s16, 6
v_add_u32 v1, s17, v5
s_waitcnt vmcnt(7)
v_lshlrev_b32 v28, 16, v8
v_and_b32 v29, 0xffff0000, v8
v_lshlrev_b32 v30, 16, v9
v_and_b32 v31, 0xffff0000, v9
v_lshlrev_b32 v32, 16, v10
v_and_b32 v33, 0xffff0000, v10
v_lshlrev_b32 v34, 16, v11
v_and_b32 v35, 0xffff0000, v11
v_lshlrev_b32 v36, 16, v12
v_and_b32 v37, 0xffff0000, v12
v_lshlrev_b32 v38, 16, v13
v_and_b32 v39, 0xffff0000, v13
v_lshlrev_b32 v40, 16, v14
v_and_b32 v41, 0xffff0000, v14
v_lshlrev_b32 v42, 16, v15
v_and_b32 v43, 0xffff0000, v15
v_lshlrev_b32 v44, 16, v16
v_and_b32 v45, 0xffff0000, v16
v_lshlrev_b32 v46, 16, v17
v_and_b32 v47, 0xffff0000, v17
v_lshlrev_b32 v48, 16, v18
v_and_b32 v49, 0xffff0000, v18
v_lshlrev_b32 v50, 16, v19
v_and_b32 v51, 0xffff0000, v19
v_lshlrev_b32 v52, 16, v20
v_and_b32 v53, 0xffff0000, v20
v_lshlrev_b32 v54, 16, v21
v_and_b32 v55, 0xffff0000, v21
v_lshlrev_b32 v56, 16, v22
v_and_b32 v57, 0xffff0000, v22
v_lshlrev_b32 v58, 16, v23
v_and_b32 v59, 0xffff0000, v23
v_lshlrev_b32 v60, 16, v24
v_and_b32 v61, 0xffff0000, v24
v_lshlrev_b32 v62, 16, v25
v_and_b32 v63, 0xffff0000, v25
v_lshlrev_b32 v64, 16, v26
v_and_b32 v65, 0xffff0000, v26
v_lshlrev_b32 v66, 16, v27
v_and_b32 v67, 0xffff0000, v27
v_pk_add_f32 v[6:7], v[28:29], v[30:31]
v_pk_add_f32 v[6:7], v[6:7], v[32:33]
v_pk_add_f32 v[6:7], v[6:7], v[34:35]
v_pk_add_f32 v[6:7], v[6:7], v[36:37]
v_pk_add_f32 v[6:7], v[6:7], v[38:39]
v_pk_add_f32 v[6:7], v[6:7], v[40:41]
v_pk_add_f32 v[6:7], v[6:7], v[42:43]
v_pk_add_f32 v[6:7], v[6:7], v[44:45]
v_pk_add_f32 v[6:7], v[6:7], v[46:47]
v_pk_add_f32 v[6:7], v[6:7], v[48:49]
v_pk_add_f32 v[6:7], v[6:7], v[50:51]
v_pk_add_f32 v[6:7], v[6:7], v[52:53]
v_pk_add_f32 v[6:7], v[6:7], v[54:55]
v_pk_add_f32 v[6:7], v[6:7], v[56:57]
v_pk_add_f32 v[6:7], v[6:7], v[58:59]
v_pk_add_f32 v[6:7], v[6:7], v[60:61]
v_pk_add_f32 v[6:7], v[6:7], v[62:63]
v_pk_add_f32 v[6:7], v[6:7], v[64:65]
v_pk_add_f32 v[6:7], v[6:7], v[66:67]
v_add_f32 v4, v6, v7
v_mov_b32 v2, v4
s_nop 1
v_permlane32_swap_b32 v4, v2
v_add_f32 v4, v4, v2
v_mov_b32 v2, v4
s_nop 1
v_permlane16_swap_b32 v4, v2
v_add_f32 v4, v4, v2
ds_write_b32 v1, v4 offset:0
s_waitcnt lgkmcnt(0)
s_barrier
ds_read_b32 v4, v5 offset:0
ds_read_b32 v2, v5 offset:64
ds_read_b32 v3, v5 offset:128
ds_read_b32 v6, v5 offset:192
s_waitcnt lgkmcnt(0)
v_add_f32 v4, v4, v2
v_add_f32 v3, v3, v6
v_add_f32 v4, v4, v3
v_mul_f32 v4, 0x3acccccd, v4
v_sub_f32 v28, v28, v4
v_sub_f32 v29, v29, v4
v_sub_f32 v30, v30, v4
v_sub_f32 v31, v31, v4
v_sub_f32 v32, v32, v4
v_sub_f32 v33, v33, v4
v_sub_f32 v34, v34, v4
v_sub_f32 v35, v35, v4
v_sub_f32 v36, v36, v4
v_sub_f32 v37, v37, v4
v_sub_f32 v38, v38, v4
v_sub_f32 v39, v39, v4
v_sub_f32 v40, v40, v4
v_sub_f32 v41, v41, v4
v_sub_f32 v42, v42, v4
v_sub_f32 v43, v43, v4
v_sub_f32 v44, v44, v4
v_sub_f32 v45, v45, v4
v_sub_f32 v46, v46, v4
v_sub_f32 v47, v47, v4
v_sub_f32 v48, v48, v4
v_sub_f32 v49, v49, v4
v_sub_f32 v50, v50, v4
v_sub_f32 v51, v51, v4
v_sub_f32 v52, v52, v4
v_sub_f32 v53, v53, v4
v_sub_f32 v54, v54, v4
v_sub_f32 v55, v55, v4
v_sub_f32 v56, v56, v4
v_sub_f32 v57, v57, v4
v_sub_f32 v58, v58, v4
v_sub_f32 v59, v59, v4
v_sub_f32 v60, v60, v4
v_sub_f32 v61, v61, v4
v_sub_f32 v62, v62, v4
v_sub_f32 v63, v63, v4
v_sub_f32 v64, v64, v4
v_sub_f32 v65, v65, v4
v_sub_f32 v66, v66, v4
v_sub_f32 v67, v67, v4
v_mul_f32 v6, v28, v28
v_mul_f32 v7, v29, v29
v_fmac_f32 v6, v30, v30
v_fmac_f32 v7, v31, v31
v_fmac_f32 v6, v32, v32
v_fmac_f32 v7, v33, v33
v_fmac_f32 v6, v34, v34
v_fmac_f32 v7, v35, v35
v_fmac_f32 v6, v36, v36
v_fmac_f32 v7, v37, v37
v_fmac_f32 v6, v38, v38
v_fmac_f32 v7, v39, v39
v_fmac_f32 v6, v40, v40
v_fmac_f32 v7, v41, v41
v_fmac_f32 v6, v42, v42
v_fmac_f32 v7, v43, v43
v_fmac_f32 v6, v44, v44
v_fmac_f32 v7, v45, v45
v_fmac_f32 v6, v46, v46
v_fmac_f32 v7, v47, v47
v_fmac_f32 v6, v48, v48
v_fmac_f32 v7, v49, v49
v_fmac_f32 v6, v50, v50
v_fmac_f32 v7, v51, v51
v_fmac_f32 v6, v52, v52
v_fmac_f32 v7, v53, v53
v_fmac_f32 v6, v54, v54
v_fmac_f32 v7, v55, v55
v_fmac_f32 v6, v56, v56
v_fmac_f32 v7, v57, v57
v_fmac_f32 v6, v58, v58
v_fmac_f32 v7, v59, v59
v_fmac_f32 v6, v60, v60
v_fmac_f32 v7, v61, v61
v_fmac_f32 v6, v62, v62
v_fmac_f32 v7, v63, v63
v_fmac_f32 v6, v64, v64
v_fmac_f32 v7, v65, v65
v_fmac_f32 v6, v66, v66
v_fmac_f32 v7, v67, v67
v_add_f32 v4, v6, v7
v_mov_b32 v2, v4
s_nop 1
v_permlane32_swap_b32 v4, v2
v_add_f32 v4, v4, v2
v_mov_b32 v2, v4
s_nop 1
v_permlane16_swap_b32 v4, v2
v_add_f32 v4, v4, v2
ds_write_b32 v1, v4 offset:256
s_waitcnt lgkmcnt(0)
s_barrier
ds_read_b32 v4, v5 offset:256
ds_read_b32 v2, v5 offset:320
ds_read_b32 v3, v5 offset:384
ds_read_b32 v6, v5 offset:448
s_waitcnt lgkmcnt(0)
v_add_f32 v4, v4, v2
v_add_f32 v3, v3, v6
v_add_f32 v4, v4, v3
v_mov_b32 v2, 0x3727c5ac
v_fmac_f32 v2, 0x3acccccd, v4
v_rsq_f32 v4, v2
s_nop 0
v_mul_f32 v28, v28, v4
v_mul_f32 v29, v29, v4
v_mul_f32 v30, v30, v4
v_mul_f32 v31, v31, v4
v_mul_f32 v32, v32, v4
v_mul_f32 v33, v33, v4
v_mul_f32 v34, v34, v4
v_mul_f32 v35, v35, v4
v_mul_f32 v36, v36, v4
v_mul_f32 v37, v37, v4
v_mul_f32 v38, v38, v4
v_mul_f32 v39, v39, v4
v_mul_f32 v40, v40, v4
v_mul_f32 v41, v41, v4
v_mul_f32 v42, v42, v4
v_mul_f32 v43, v43, v4
v_mul_f32 v44, v44, v4
v_mul_f32 v45, v45, v4
v_mul_f32 v46, v46, v4
v_mul_f32 v47, v47, v4
v_mul_f32 v48, v48, v4
v_mul_f32 v49, v49, v4
v_mul_f32 v50, v50, v4
v_mul_f32 v51, v51, v4
v_mul_f32 v52, v52, v4
v_mul_f32 v53, v53, v4
v_mul_f32 v54, v54, v4
v_mul_f32 v55, v55, v4
v_mul_f32 v56, v56, v4
v_mul_f32 v57, v57, v4
v_mul_f32 v58, v58, v4
v_mul_f32 v59, v59, v4
v_mul_f32 v60, v60, v4
v_mul_f32 v61, v61, v4
v_mul_f32 v62, v62, v4
v_mul_f32 v63, v63, v4
v_mul_f32 v64, v64, v4
v_mul_f32 v65, v65, v4
v_mul_f32 v66, v66, v4
v_mul_f32 v67, v67, v4
v_cvt_pk_bf16_f32 v8, v28, v29
v_cvt_pk_bf16_f32 v9, v30, v31
v_cvt_pk_bf16_f32 v10, v32, v33
v_cvt_pk_bf16_f32 v11, v34, v35
v_cvt_pk_bf16_f32 v12, v36, v37
v_cvt_pk_bf16_f32 v13, v38, v39
v_cvt_pk_bf16_f32 v14, v40, v41
v_cvt_pk_bf16_f32 v15, v42, v43
v_cvt_pk_bf16_f32 v16, v44, v45
v_cvt_pk_bf16_f32 v17, v46, v47
v_cvt_pk_bf16_f32 v18, v48, v49
v_cvt_pk_bf16_f32 v19, v50, v51
v_cvt_pk_bf16_f32 v20, v52, v53
v_cvt_pk_bf16_f32 v21, v54, v55
v_cvt_pk_bf16_f32 v22, v56, v57
v_cvt_pk_bf16_f32 v23, v58, v59
v_cvt_pk_bf16_f32 v24, v60, v61
v_cvt_pk_bf16_f32 v25, v62, v63
v_cvt_pk_bf16_f32 v26, v64, v65
v_cvt_pk_bf16_f32 v27, v66, v67
v_and_b32 v3, 63, v0
v_lshlrev_b32 v1, 4, v3
s_mul_i32 s17, s2, 20480
s_mul_i32 s18, s16, 5120
s_add_u32 s17, s17, s18
s_add_u32 s17, s17, 84934656
buffer_store_dwordx4 v[8:11], v1, s[4:7], s17 offen offset:0 sc1
buffer_store_dwordx4 v[12:15], v1, s[4:7], s17 offen offset:1024 sc1
buffer_store_dwordx4 v[16:19], v1, s[4:7], s17 offen offset:2048 sc1
buffer_store_dwordx4 v[20:23], v1, s[4:7], s17 offen offset:3072 sc1
s_add_u32 s17, s17, 4096
buffer_store_dwordx4 v[24:27], v1, s[4:7], s17 offen offset:0 sc1
ln2_exit1:
s_endpgm
.globl reca_kernel
.p2align 8
.type reca_kernel,@function
reca_kernel:
s_cmp_ge_u32 s2, 256
s_cbranch_scc1 reca_exitb3
s_load_dwordx2 s[48:49], s[0:1], 96
s_load_dwordx2 s[50:51], s[0:1], 88
s_load_dwordx2 s[52:53], s[0:1], 8
s_getreg_b32 s42, hwreg(HW_REG_XCC_ID, 0, 3)
v_lshrrev_b32 v28, 6, v0
v_and_b32 v29, 63, v0
s_and_b32 s13, s2, 7
v_readfirstlane_b32 s12, v28
v_lshlrev_b32 v1, 4, v29
s_lshr_b32 s14, s2, 3
s_mov_b32 s18, 0x100000
s_waitcnt lgkmcnt(0)
s_mov_b32 s57, 0
s_mov_b32 s4, s48
s_mov_b32 s5, s49
s_mov_b32 s6, 0x10000000
s_mov_b32 s7, 0x20000
s_mov_b32 s8, s50
s_mov_b32 s9, s51
s_mov_b32 s10, 256
s_mov_b32 s11, 0x20000
v_add_u32 v2, 0x1000, v1
v_add_u32 v3, 0x2000, v1
v_mov_b32 v31, 0x80000000
s_lshl_b32 s34, s42, 3
s_lshl_b64 s[36:37], 1, s34
s_lshl_b32 s34, s13, 3
v_cmp_eq_u32 vcc, 0, v0
v_mov_b32 v30, s34
s_nop 0
v_cndmask_b32 v30, v31, v30, vcc
v_mov_b32 v44, s36
v_mov_b32 v45, s37
buffer_atomic_add_x2 v[44:45], v30, s[8:11], 0 offen
s_sub_u32 s56, 0, s48
s_and_b32 s56, s56, 0x1fffff
s_add_u32 s56, s56, 2097152
s_nop 0
s_cmp_ge_u32 s14, 24
s_cbranch_scc1 reca_proj2
s_mul_i32 s34, s14, 43
s_lshr_b32 s34, s34, 8
s_mul_i32 s35, s34, 6
s_sub_u32 s16, s14, s35
s_lshl_b32 s15, s13, 2
s_add_u32 s15, s15, s34
s_lshr_b32 s19, s12, 1
s_and_b32 s37, s12, 1
s_mul_i32 s34, s15, 12
s_lshl_b32 s35, s16, 1
s_add_u32 s34, s34, s35
s_add_u32 s34, s34, s37
s_mul_i32 s34, s34, 20480
s_mov_b32 s35, 14155776
s_cmp_eq_u32 s19, 0
s_cselect_b32 s35, 6291456, s35
s_add_u32 s35, s35, s34
s_mul_i32 s36, s19, 10240
s_add_u32 s20, s35, s36
s_sub_u32 s36, 10240, s36
s_add_u32 s21, s35, s36
s_add_u32 s22, s34, 22020096
s_mul_i32 s36, s19, 10240
s_add_u32 s22, s22, s36
buffer_load_dwordx4 a[0:3], v1, s[4:7], s20 offen offset:0
buffer_load_dwordx4 a[4:7], v1, s[4:7], s20 offen offset:1024
buffer_load_dwordx4 a[8:11], v1, s[4:7], s20 offen offset:2048
buffer_load_dwordx4 a[12:15], v1, s[4:7], s20 offen offset:3072
buffer_load_dwordx4 a[16:19], v2, s[4:7], s20 offen offset:0
buffer_load_dwordx4 a[20:23], v2, s[4:7], s20 offen offset:1024
buffer_load_dwordx4 a[24:27], v2, s[4:7], s20 offen offset:2048
buffer_load_dwordx4 a[28:31], v2, s[4:7], s20 offen offset:3072
buffer_load_dwordx4 a[32:35], v3, s[4:7], s20 offen offset:0
buffer_load_dwordx4 a[36:39], v3, s[4:7], s20 offen offset:1024
buffer_load_dwordx4 a[40:43], v1, s[4:7], s21 offen offset:0
buffer_load_dwordx4 a[44:47], v1, s[4:7], s21 offen offset:1024
buffer_load_dwordx4 a[48:51], v1, s[4:7], s21 offen offset:2048
buffer_load_dwordx4 a[52:55], v1, s[4:7], s21 offen offset:3072
buffer_load_dwordx4 a[56:59], v2, s[4:7], s21 offen offset:0
buffer_load_dwordx4 a[60:63], v2, s[4:7], s21 offen offset:1024
buffer_load_dwordx4 a[64:67], v2, s[4:7], s21 offen offset:2048
buffer_load_dwordx4 a[68:71], v2, s[4:7], s21 offen offset:3072
buffer_load_dwordx4 a[72:75], v3, s[4:7], s21 offen offset:0
buffer_load_dwordx4 a[76:79], v3, s[4:7], s21 offen offset:1024
buffer_load_dwordx4 a[80:83], v1, s[4:7], s22 offen offset:0
buffer_load_dwordx4 a[84:87], v1, s[4:7], s22 offen offset:1024
buffer_load_dwordx4 a[88:91], v1, s[4:7], s22 offen offset:2048
buffer_load_dwordx4 a[92:95], v1, s[4:7], s22 offen offset:3072
buffer_load_dwordx4 a[96:99], v2, s[4:7], s22 offen offset:0
buffer_load_dwordx4 a[100:103], v2, s[4:7], s22 offen offset:1024
buffer_load_dwordx4 a[104:107], v2, s[4:7], s22 offen offset:2048
buffer_load_dwordx4 a[108:111], v2, s[4:7], s22 offen offset:3072
buffer_load_dwordx4 a[112:115], v3, s[4:7], s22 offen offset:0
buffer_load_dwordx4 a[116:119], v3, s[4:7], s22 offen offset:1024
s_cmp_ge_u32 s14, 20
s_cbranch_scc1 reca_now24
s_cmp_ge_u32 s12, 2
s_cbranch_scc1 reca_now24
s_lshl_b32 s34, s14, 1
s_add_u32 s34, s34, s12
s_mul_i32 s34, s34, 192
s_mul_i32 s35, s13, 24
s_add_u32 s34, s34, s35
s_lshl_b32 s34, s34, 10
s_add_u32 s34, s34, 29884416
buffer_load_dwordx4 a[120:123], v1, s[4:7], s34 offen offset:0
buffer_load_dwordx4 a[124:127], v1, s[4:7], s34 offen offset:1024
buffer_load_dwordx4 a[128:131], v1, s[4:7], s34 offen offset:2048
buffer_load_dwordx4 a[132:135], v1, s[4:7], s34 offen offset:3072
buffer_load_dwordx4 a[136:139], v2, s[4:7], s34 offen offset:0
buffer_load_dwordx4 a[140:143], v2, s[4:7], s34 offen offset:1024
buffer_load_dwordx4 a[144:147], v2, s[4:7], s34 offen offset:2048
buffer_load_dwordx4 a[148:151], v2, s[4:7], s34 offen offset:3072
buffer_load_dwordx4 a[152:155], v3, s[4:7], s34 offen offset:0
buffer_load_dwordx4 a[156:159], v3, s[4:7], s34 offen offset:1024
buffer_load_dwordx4 a[160:163], v3, s[4:7], s34 offen offset:2048
buffer_load_dwordx4 a[164:167], v3, s[4:7], s34 offen offset:3072
s_add_u32 s34, s34, 12288
buffer_load_dwordx4 a[168:171], v1, s[4:7], s34 offen offset:0
buffer_load_dwordx4 a[172:175], v1, s[4:7], s34 offen offset:1024
buffer_load_dwordx4 a[176:179], v1, s[4:7], s34 offen offset:2048
buffer_load_dwordx4 a[180:183], v1, s[4:7], s34 offen offset:3072
buffer_load_dwordx4 a[184:187], v2, s[4:7], s34 offen offset:0
buffer_load_dwordx4 a[188:191], v2, s[4:7], s34 offen offset:1024
buffer_load_dwordx4 a[192:195], v2, s[4:7], s34 offen offset:2048
buffer_load_dwordx4 a[196:199], v2, s[4:7], s34 offen offset:3072
buffer_load_dwordx4 a[200:203], v3, s[4:7], s34 offen offset:0
buffer_load_dwordx4 a[204:207], v3, s[4:7], s34 offen offset:1024
buffer_load_dwordx4 a[208:211], v3, s[4:7], s34 offen offset:2048
buffer_load_dwordx4 a[212:215], v3, s[4:7], s34 offen offset:3072
reca_now24:
v_and_b32 v29, 63, v0
v_and_b32 v28, 15, v29
v_lshrrev_b32 v30, 4, v29
v_mov_b32 v32, -1
v_mov_b32 v33, -1
v_mov_b32 v34, -1
v_mov_b32 v35, -1
s_mul_i32 s34, s12, 2560
v_add_u32 v4, s34, v1
v_and_b32 v44, 31, v29
v_lshlrev_b32 v44, 4, v44
s_add_u32 s34, s34, 2048
v_add_u32 v5, s34, v44
v_and_b32 v44, 7, v29
v_lshlrev_b32 v44, 4, v44
v_lshl_add_u32 v44, v30, 7, v44
s_mul_i32 s34, s19, 5120
v_add_u32 v6, s34, v44
s_sub_u32 s34, 5120, s34
v_add_u32 v7, s34, v44
v_lshrrev_b32 v45, 3, v28
v_lshl_add_u32 v12, v45, 9, v44
s_mul_i32 s34, s19, 5120
v_add_u32 v236, s34, v12
s_sub_u32 s34, 5120, s34
v_add_u32 v237, s34, v12
v_add_u32 v13, 0x1000, v12
v_add_u32 v14, 0x2000, v12
v_cmp_gt_u32 s[54:55], 8, v28
s_lshl_b32 s34, s16, 10
s_lshl_b32 s35, s19, 7
s_add_u32 s34, s34, s35
s_and_b32 s35, s12, 1
s_lshl_b32 s36, s35, 3
s_add_u32 s34, s34, s36
v_lshlrev_b32 v44, 4, v28
v_lshl_add_u32 v45, v30, 8, v44
v_add_u32 v45, s34, v45
v_cndmask_b32 v8, v31, v45, s[54:55]
v_lshl_add_u32 v44, v30, 7, v44
v_add_u32 v45, s36, v44
v_cndmask_b32 v9, v31, v45, s[54:55]
s_lshl_b32 s34, s14, 9
v_add_u32 v45, s34, v44
v_cndmask_b32 v11, v31, v45, s[54:55]
s_mul_i32 s34, s13, 49152
s_lshr_b32 s35, s14, 3
s_lshl_b32 s35, s35, 14
s_add_u32 s34, s34, s35
s_and_b32 s35, s14, 7
s_lshl_b32 s35, s35, 10
s_add_u32 s34, s34, s35
s_lshl_b32 s35, s12, 9
s_add_u32 s34, s34, s35
v_add_u32 v45, s34, v44
v_cndmask_b32 v15, v31, v45, s[54:55]
s_cmp_lt_u32 s14, 20
s_cselect_b32 s34, 0, 0x80000000
v_or_b32 v15, s34, v15
v_lshlrev_b32 v45, 3, v29
v_cmp_gt_u32 vcc, 32, v29
s_nop 1
v_cndmask_b32 v10, v31, v45, vcc
s_sub_u32 s35, s14, 4
s_cmp_lt_u32 s14, 20
s_cselect_b32 s34, s14, s35
s_lshr_b32 s35, s34, 3
s_lshl_b32 s35, s35, 14
s_and_b32 s34, s34, 7
s_lshl_b32 s34, s34, 10
s_add_u32 s34, s34, s35
v_add_u32 v20, s34, v1
v_add_u32 v21, 49152, v20
v_add_u32 v22, 98304, v20
v_add_u32 v23, 147456, v20
v_add_u32 v24, 196608, v20
v_add_u32 v25, 245760, v20
v_add_u32 v26, 294912, v20
v_add_u32 v27, 344064, v20
v_lshrrev_b32 v44, 3, v29
v_and_b32 v44, 3, v44
v_lshlrev_b32 v44, 7, v44
v_and_b32 v45, 7, v29
v_lshl_add_u32 v44, v45, 4, v44
v_lshrrev_b32 v45, 5, v29
v_lshl_add_u32 v44, v45, 3, v44
s_lshl_b32 s34, s14, 9
s_cmp_lt_u32 s14, 20
s_cselect_b32 s34, s34, 0x80000000
v_add_u32 v16, s34, v44
v_cmp_eq_u32 vcc, 0, v29
v_mov_b32 v45, 0
s_nop 0
v_cndmask_b32 v19, v31, v45, vcc
s_lshl_b32 s34, s15, 8
s_add_u32 s34, s34, 1540096
v_and_b32 v45, 1, v29
v_lshlrev_b32 v45, 7, v45
v_add_u32 v233, s34, v45
s_lshl_b32 s34, s12, 10
s_add_u32 s34, s34, 10240
v_add_u32 v17, s34, v1
v_mov_b32 v36, 0x3f803f80
v_mov_b32 v37, 0x3f803f80
v_mov_b32 v38, 0x3f803f80
v_mov_b32 v39, 0x3f803f80
v_mov_b32 v44, 0xf149f2ca
v_cmp_gt_u32 vcc, 2, v30
s_nop 1
v_cndmask_b32 v40, 0, v44, vcc
v_mov_b32 v41, v40
v_mov_b32 v42, v40
v_mov_b32 v43, v40
v_and_b32 v44, 31, v29
v_lshlrev_b32 v44, 4, v44
v_add_u32 v45, 47972352, v44
v_add_u32 v44, 47185920, v44
v_cmp_gt_u32 vcc, 32, v29
s_nop 1
v_cndmask_b32 v238, v45, v44, vcc
s_mov_b32 s41, 0x3dd53b95
s_mul_i32 s38, s13, 40960
s_add_u32 s38, s38, 0
s_mul_i32 s39, s15, 24576
s_add_u32 s39, s39, 327680
s_mul_i32 s40, s13, 49152
s_add_u32 s40, s40, 1114112
s_mov_b32 s60, s52
s_mov_b32 s61, s53
s_mov_b32 s62, 10240
s_mov_b32 s63, 0x20000
v_and_b32 v29, 63, v0
v_and_b32 v44, 7, v29
v_mul_u32_u24 v44, 1280, v44
v_lshrrev_b32 v45, 3, v29
v_and_b32 v45, 3, v45
v_lshl_add_u32 v44, v45, 4, v44
s_mul_i32 s34, s12, 320
v_add_u32 v44, s34, v44
v_add_u32 v46, 256, v44
v_lshrrev_b32 v45, 5, v29
v_lshl_add_u32 v44, v45, 6, v44
buffer_load_dwordx4 v[128:131], v44, s[60:63], 0 offen
buffer_load_dwordx4 v[132:135], v44, s[60:63], 0 offen offset:128
buffer_load_dwordx4 v[136:139], v46, s[60:63], 0 offen
v_and_b32 v44, 63, v0
v_and_b32 v45, 3, v44
v_lshlrev_b32 v45, 21, v45
v_min_u32 v45, 786368, v45
v_add_u32 v46, 47185920, v45
v_add_u32 v45, 47972352, v45
v_cmp_gt_u32 vcc, 4, v44
s_nop 1
v_cndmask_b32 v46, v45, v46, vcc
s_mul_i32 s34, s15, 98304
v_and_b32 v45, 1, v44
v_mul_u32_u24 v45, 98240, v45
v_add_u32 v45, s34, v45
v_add_u32 v28, 37748736, v45
v_add_u32 v45, 40894464, v45
v_cmp_gt_u32 vcc, 10, v44
s_nop 1
v_cndmask_b32 v45, v45, v28, vcc
v_cmp_gt_u32 vcc, 8, v44
s_nop 1
v_cndmask_b32 v46, v45, v46, vcc
v_cmp_gt_u32 vcc, 12, v44
s_nop 1
v_cndmask_b32 v46, v31, v46, vcc
buffer_load_dword v234, v46, s[4:7], 0 offen
v_and_b32 v44, 63, v0
v_lshlrev_b32 v45, 21, v44
v_min_u32 v45, 25165760, v45
v_add_u32 v45, 57147392, v45
s_lshl_b32 s34, s13, 2
s_add_u32 s34, s34, s14
s_sub_u32 s34, s34, 20
s_and_b32 s34, s34, 31
s_mul_i32 s34, s34, 98304
s_add_u32 s34, s34, 44040192
v_and_b32 v46, 1, v44
v_mul_u32_u24 v46, 98240, v46
v_add_u32 v46, s34, v46
v_cmp_gt_u32 vcc, 13, v44
s_nop 1
v_cndmask_b32 v46, v46, v45, vcc
v_cmp_gt_u32 vcc, 15, v44
s_nop 1
v_cndmask_b32 v46, v31, v46, vcc
buffer_load_dword v235, v46, s[4:7], 0 offen
v_and_b32 v30, 7, v0
v_lshlrev_b32 v30, 3, v30
reca_cens5:
buffer_load_dwordx2 v[28:29], v30, s[8:11], 0 offen sc1
s_waitcnt vmcnt(0)
v_sad_u8 v31, v28, 0, 0
v_sad_u8 v31, v29, 0, v31
v_cmp_gt_u32 vcc, 32, v31
s_cbranch_vccz reca_censok6
s_sleep 8
s_sub_u32 s18, s18, 1
s_cbranch_scc0 reca_cens5
s_mov_b32 s18, 0
reca_censok6:
v_and_b32 v28, 0x20202020, v28
v_and_b32 v29, 0x20202020, v29
v_cmp_ne_u32 s[34:35], 0, v28
v_cmp_ne_u32 s[36:37], 0, v29
s_nop 3
s_and_b32 s34, s34, 0xff
s_and_b32 s36, s36, 0xff
s_or_b32 s35, s34, s36
s_lshr_b32 s37, s35, s13
s_and_b32 s37, s37, 1
s_xor_b32 s43, s37, 1
s_cmp_eq_u32 s57, 0
s_cselect_b32 s58, s36, s34
v_mov_b32 v31, 0x80000000
v_add_u32 v232, 0x2000, v15
s_lshr_b32 s44, s2, 4
s_lshl_b32 s44, s44, 14
s_and_b32 s34, s2, 15
s_lshl_b32 s34, s34, 9
s_add_u32 s44, s44, s34
s_add_u32 s44, s44, 1572864
s_add_u32 s44, s44, s56
s_mov_b32 s45, -1
s_mov_b32 s47, -1
s_cmp_lg_u32 s12, 2
s_cbranch_scc1 reca_noprobe7
s_add_u32 s35, s44, 0
s_memtime s[60:61]
s_waitcnt lgkmcnt(0)
buffer_load_dword v28, v19, s[4:7], s35 offen sc1
s_waitcnt vmcnt(0)
s_memtime s[62:63]
s_waitcnt lgkmcnt(0)
s_sub_u32 s36, s62, s60
s_min_u32 s45, s45, s36
s_add_u32 s35, s44, 8192
s_memtime s[60:61]
s_waitcnt lgkmcnt(0)
buffer_load_dword v28, v19, s[4:7], s35 offen sc1
s_waitcnt vmcnt(0)
s_memtime s[62:63]
s_waitcnt lgkmcnt(0)
s_sub_u32 s36, s62, s60
s_min_u32 s47, s47, s36
s_add_u32 s35, s44, 128
s_memtime s[60:61]
s_waitcnt lgkmcnt(0)
buffer_load_dword v28, v19, s[4:7], s35 offen sc1
s_waitcnt vmcnt(0)
s_memtime s[62:63]
s_waitcnt lgkmcnt(0)
s_sub_u32 s36, s62, s60
s_min_u32 s45, s45, s36
s_add_u32 s35, s44, 8320
s_memtime s[60:61]
s_waitcnt lgkmcnt(0)
buffer_load_dword v28, v19, s[4:7], s35 offen sc1
s_waitcnt vmcnt(0)
s_memtime s[62:63]
s_waitcnt lgkmcnt(0)
s_sub_u32 s36, s62, s60
s_min_u32 s47, s47, s36
s_add_u32 s35, s44, 256
s_memtime s[60:61]
s_waitcnt lgkmcnt(0)
buffer_load_dword v28, v19, s[4:7], s35 offen sc1
s_waitcnt vmcnt(0)
s_memtime s[62:63]
s_waitcnt lgkmcnt(0)
s_sub_u32 s36, s62, s60
s_min_u32 s45, s45, s36
s_add_u32 s35, s44, 8448
s_memtime s[60:61]
s_waitcnt lgkmcnt(0)
buffer_load_dword v28, v19, s[4:7], s35 offen sc1
s_waitcnt vmcnt(0)
s_memtime s[62:63]
s_waitcnt lgkmcnt(0)
s_sub_u32 s36, s62, s60
s_min_u32 s47, s47, s36
s_cmp_lt_u32 s47, s45
s_cbranch_scc0 reca_noprobe7
v_add_u32 v20, 0x2000, v20
v_add_u32 v21, 0x2000, v21
v_add_u32 v22, 0x2000, v22
v_add_u32 v23, 0x2000, v23
v_add_u32 v24, 0x2000, v24
v_add_u32 v25, 0x2000, v25
v_add_u32 v26, 0x2000, v26
v_add_u32 v27, 0x2000, v27
reca_noprobe7:
s_lshl_b32 s59, s13, 2
s_add_u32 s59, s59, s14
s_sub_u32 s59, s59, 20
v_and_b32 v29, 63, v0
v_and_b32 v28, 15, v29
v_lshrrev_b32 v30, 4, v29
v_lshlrev_b32 v92, 4, v28
v_lshl_add_u32 v92, v30, 7, v92
v_cmp_gt_u32 vcc, 8, v28
s_nop 1
v_cndmask_b32 v92, v31, v92, vcc
v_lshlrev_b32 v93, 3, v29
v_cmp_gt_u32 vcc, 32, v29
s_nop 1
v_cndmask_b32 v93, v31, v93, vcc
v_mov_b32 v82, 0xf149f2ca
v_cmp_le_u32 vcc, 2, v30
s_nop 1
v_cndmask_b32 v84, 0, v82, vcc
v_mov_b32 v85, v84
v_mov_b32 v86, v84
v_mov_b32 v87, v84
v_lshlrev_b32 v30, 2, v30
v_add_u32 v29, 0, v30
v_cmp_gt_u32 vcc, v29, v28
s_nop 1
v_cndmask_b32 v88, 0, v82, vcc
v_add_u32 v29, 1, v30
v_cmp_gt_u32 vcc, v29, v28
s_nop 1
v_cndmask_b32 v89, 0, v82, vcc
v_add_u32 v29, 2, v30
v_cmp_gt_u32 vcc, v29, v28
s_nop 1
v_cndmask_b32 v90, 0, v82, vcc
v_add_u32 v29, 3, v30
v_cmp_gt_u32 vcc, v29, v28
s_nop 1
v_cndmask_b32 v91, 0, v82, vcc
s_mov_b32 s17, 0
s_cmp_lg_u32 s12, 3
s_cbranch_scc1 reca_nopf08
s_add_u32 s37, s17, 1
reca_pf9:
buffer_load_dword v28, v233, s[4:7], 0 offen sc1
s_waitcnt vmcnt(0)
v_cmp_gt_i32 vcc, s37, v28
s_cbranch_vccz reca_pfok10
s_sleep 1
s_sub_u32 s18, s18, 1
s_cbranch_scc0 reca_pf9
s_mov_b32 s18, 0
reca_pfok10:
s_lshl_b32 s34, s15, 3
s_and_b32 s35, s17, 7
s_add_u32 s34, s34, s35
s_mul_i32 s34, s34, 12288
s_add_u32 s32, s34, 37748736
s_lshl_b32 s35, s16, 11
s_add_u32 s34, s34, s35
s_add_u32 s33, s34, 40894464
buffer_load_dwordx4 a[120:123], v1, s[4:7], s32 offen offset:0 sc1
buffer_load_dwordx4 a[124:127], v1, s[4:7], s32 offen offset:1024 sc1
buffer_load_dwordx4 a[128:131], v1, s[4:7], s32 offen offset:2048 sc1
buffer_load_dwordx4 a[132:135], v1, s[4:7], s32 offen offset:3072 sc1
buffer_load_dwordx4 a[136:139], v2, s[4:7], s32 offen offset:0 sc1
buffer_load_dwordx4 a[140:143], v2, s[4:7], s32 offen offset:1024 sc1
buffer_load_dwordx4 a[144:147], v2, s[4:7], s32 offen offset:2048 sc1
buffer_load_dwordx4 a[148:151], v2, s[4:7], s32 offen offset:3072 sc1
buffer_load_dwordx4 a[152:155], v3, s[4:7], s32 offen offset:0 sc1
buffer_load_dwordx4 a[156:159], v3, s[4:7], s32 offen offset:1024 sc1
buffer_load_dwordx4 a[160:163], v3, s[4:7], s32 offen offset:2048 sc1
buffer_load_dwordx4 a[164:167], v3, s[4:7], s32 offen offset:3072 sc1
buffer_load_dwordx4 a[168:171], v1, s[4:7], s33 offen offset:0 sc1
buffer_load_dwordx4 a[172:175], v1, s[4:7], s33 offen offset:1024 sc1
s_waitcnt vmcnt(0)
reca_nopf08:
s_cmp_lg_u32 s43, 0
s_cbranch_scc1 reca_slow11
s_cmp_ge_u32 s14, 20
s_cbranch_scc1 reca_twinf12
s_branch reca_gotmem15
reca_step14:
s_and_b32 s34, s17, 3
s_mul_i32 s20, s34, 10240
s_add_u32 s20, s20, s38
s_sleep 2
buffer_load_dwordx4 v[128:131], v4, s[4:7], s20 offen sc1
buffer_load_dwordx4 v[132:135], v4, s[4:7], s20 offen offset:1024 sc1
buffer_load_dwordx4 v[136:139], v5, s[4:7], s20 offen sc1
s_waitcnt vmcnt(2)
v_max_u32 v29, v128, v130
v_cmp_eq_u32 vcc, -1, v29
s_cbranch_vccnz reca_retry17
reca_resume18:
s_waitcnt vmcnt(1)
v_max_u32 v29, v132, v134
v_cmp_eq_u32 vcc, -1, v29
ds_write_b128 v4, v[128:131]
s_cbranch_vccnz reca_retry19
reca_resume20:
s_waitcnt vmcnt(0)
v_max_u32 v29, v136, v138
v_cmp_eq_u32 vcc, -1, v29
ds_write_b128 v4, v[132:135] offset:1024
s_cbranch_vccnz reca_retry21
reca_resume22:
ds_write_b128 v5, v[136:139]
s_branch reca_gotmem216
reca_gotmem15:
ds_write_b128 v4, v[128:131]
ds_write_b128 v4, v[132:135] offset:1024
ds_write_b128 v5, v[136:139]
reca_gotmem216:
s_and_b32 s34, s17, 3
s_mul_i32 s21, s34, 6144
s_add_u32 s21, s21, s39
s_mul_i32 s22, s34, 12288
s_add_u32 s22, s22, s40
s_mul_i32 s25, s34, 393216
s_add_u32 s25, s25, s56
s_add_u32 s35, s17, 1
s_and_b32 s35, s35, 3
s_mul_i32 s24, s35, 10240
s_add_u32 s24, s24, s38
s_waitcnt lgkmcnt(0)
s_barrier
ds_read_b128 v[128:131], v236 offset:0
ds_read_b128 v[132:135], v236 offset:1024
ds_read_b128 v[136:139], v236 offset:2048
ds_read_b128 v[140:143], v236 offset:3072
ds_read_b128 v[144:147], v236 offset:4096
ds_read_b128 v[148:151], v237 offset:0
ds_read_b128 v[152:155], v237 offset:1024
ds_read_b128 v[156:159], v237 offset:2048
ds_read_b128 v[160:163], v237 offset:3072
ds_read_b128 v[164:167], v237 offset:4096
s_waitcnt lgkmcnt(9)
v_mfma_f32_16x16x32_bf16 v[44:47], a[0:3], v[128:131], 0
ds_read_b128 v[168:171], v6 offset:0
v_mfma_f32_16x16x32_bf16 v[240:243], a[4:7], v[128:131], 0
s_waitcnt lgkmcnt(9)
v_mfma_f32_16x16x32_bf16 v[44:47], a[8:11], v[132:135], v[44:47]
ds_read_b128 v[172:175], v6 offset:512
v_mfma_f32_16x16x32_bf16 v[240:243], a[12:15], v[132:135], v[240:243]
s_waitcnt lgkmcnt(9)
v_mfma_f32_16x16x32_bf16 v[44:47], a[16:19], v[136:139], v[44:47]
ds_read_b128 v[176:179], v6 offset:1024
v_mfma_f32_16x16x32_bf16 v[240:243], a[20:23], v[136:139], v[240:243]
s_waitcnt lgkmcnt(9)
v_mfma_f32_16x16x32_bf16 v[44:47], a[24:27], v[140:143], v[44:47]
ds_read_b128 v[180:183], v6 offset:1536
v_mfma_f32_16x16x32_bf16 v[240:243], a[28:31], v[140:143], v[240:243]
s_waitcnt lgkmcnt(9)
v_mfma_f32_16x16x32_bf16 v[44:47], a[32:35], v[144:147], v[44:47]
ds_read_b128 v[184:187], v6 offset:2048
v_mfma_f32_16x16x32_bf16 v[240:243], a[36:39], v[144:147], v[240:243]
s_waitcnt lgkmcnt(9)
v_mfma_f32_16x16x32_bf16 v[44:47], a[40:43], v[148:151], v[44:47]
ds_read_b128 v[188:191], v6 offset:2560
v_mfma_f32_16x16x32_bf16 v[240:243], a[44:47], v[148:151], v[240:243]
s_waitcnt lgkmcnt(9)
v_mfma_f32_16x16x32_bf16 v[44:47], a[48:51], v[152:155], v[44:47]
ds_read_b128 v[192:195], v6 offset:3072
v_mfma_f32_16x16x32_bf16 v[240:243], a[52:55], v[152:155], v[240:243]
s_waitcnt lgkmcnt(9)
v_mfma_f32_16x16x32_bf16 v[44:47], a[56:59], v[156:159], v[44:47]
ds_read_b128 v[196:199], v6 offset:3584
v_mfma_f32_16x16x32_bf16 v[240:243], a[60:63], v[156:159], v[240:243]
s_waitcnt lgkmcnt(9)
v_mfma_f32_16x16x32_bf16 v[44:47], a[64:67], v[160:163], v[44:47]
ds_read_b128 v[200:203], v6 offset:4096
v_mfma_f32_16x16x32_bf16 v[240:243], a[68:71], v[160:163], v[240:243]
s_waitcnt lgkmcnt(9)
v_mfma_f32_16x16x32_bf16 v[44:47], a[72:75], v[164:167], v[44:47]
ds_read_b128 v[204:207], v6 offset:4608
v_mfma_f32_16x16x32_bf16 v[240:243], a[76:79], v[164:167], v[240:243]
s_waitcnt lgkmcnt(9)
v_mfma_f32_16x16x32_bf16 v[48:51], v[168:171], a[80:83], 0
s_and_b32 s34, s17, 7
s_lshl_b32 s34, s34, 5
s_add_u32 s34, s34, s15
s_mul_i32 s34, s34, 3072
s_lshl_b32 s35, s16, 9
s_add_u32 s34, s34, s35
s_add_u32 s30, s34, 47185920
s_add_u32 s31, s34, 47972352
v_add_f32_dpp v44, v240, v44 row_ror:8 row_mask:0xf bank_mask:0xf
v_add_f32_dpp v45, v241, v45 row_ror:8 row_mask:0xf bank_mask:0xf
v_add_f32_dpp v46, v242, v46 row_ror:8 row_mask:0xf bank_mask:0xf
v_add_f32_dpp v47, v243, v47 row_ror:8 row_mask:0xf bank_mask:0xf
v_cvt_pk_bf16_f32 v52, v44, v45
v_cvt_pk_bf16_f32 v53, v46, v47
buffer_store_dwordx2 v[52:53], v8, s[4:7], s21 offen
s_waitcnt lgkmcnt(8)
v_mfma_f32_16x16x32_bf16 v[48:51], v[172:175], a[84:87], v[48:51]
s_waitcnt lgkmcnt(7)
v_mfma_f32_16x16x32_bf16 v[48:51], v[176:179], a[88:91], v[48:51]
s_waitcnt lgkmcnt(6)
v_mfma_f32_16x16x32_bf16 v[48:51], v[180:183], a[92:95], v[48:51]
s_waitcnt lgkmcnt(5)
v_mfma_f32_16x16x32_bf16 v[48:51], v[184:187], a[96:99], v[48:51]
s_waitcnt lgkmcnt(4)
v_mfma_f32_16x16x32_bf16 v[48:51], v[188:191], a[100:103], v[48:51]
s_waitcnt lgkmcnt(3)
v_mfma_f32_16x16x32_bf16 v[48:51], v[192:195], a[104:107], v[48:51]
s_waitcnt lgkmcnt(2)
v_mfma_f32_16x16x32_bf16 v[48:51], v[196:199], a[108:111], v[48:51]
s_waitcnt lgkmcnt(1)
v_mfma_f32_16x16x32_bf16 v[48:51], v[200:203], a[112:115], v[48:51]
s_waitcnt lgkmcnt(0)
v_mfma_f32_16x16x32_bf16 v[48:51], v[204:207], a[116:119], v[48:51]
s_cmp_eq_u32 s12, 3
s_cbranch_scc1 reca_swave23
s_nop 5
ds_write_b128 v17, v[48:51]
s_add_u32 s34, s17, 2
s_and_b32 s34, s34, 3
s_mul_i32 s26, s34, 10240
s_add_u32 s26, s26, s38
s_mul_i32 s27, s34, 6144
s_add_u32 s27, s27, s39
s_mul_i32 s28, s34, 12288
s_add_u32 s28, s28, s40
s_mul_i32 s29, s34, 393216
s_add_u32 s29, s29, s56
s_waitcnt lgkmcnt(0)
s_barrier
s_cmp_eq_u32 s17, 63
s_cbranch_scc1 reca_last25
buffer_store_dwordx2 v[32:33], v8, s[4:7], s27 offen
s_cmp_lg_u32 s12, 2
s_cbranch_scc1 reca_b326
buffer_store_dwordx2 v[52:53], v9, s[4:7], s30 offen
buffer_store_dwordx2 v[32:33], v16, s[4:7], s26 offen
s_cmp_lg_u32 s14, 0
s_cbranch_scc1 reca_b326
v_mov_b32 v28, s17
s_lshl_b32 s34, s13, 7
s_add_u32 s34, s34, 1507328
buffer_store_dword v28, v19, s[4:7], s34 offen
s_branch reca_b326
reca_last25:
s_cmp_lg_u32 s12, 2
s_cbranch_scc1 reca_exit1
buffer_store_dwordx2 v[52:53], v9, s[4:7], s30 offen
s_branch reca_exit1
reca_swave23:
s_cmp_lg_u32 s17, 63
s_cbranch_scc1 reca_vmst29
s_barrier
ds_read_b128 v[56:59], v1 offset:10240
ds_read_b128 v[60:63], v1 offset:11264
ds_read_b128 v[64:67], v1 offset:12288
s_waitcnt lgkmcnt(0)
v_add_f32 v56, v56, v64
v_add_f32 v60, v60, v48
v_add_f32 v57, v57, v65
v_add_f32 v61, v61, v49
v_add_f32 v58, v58, v66
v_add_f32 v62, v62, v50
v_add_f32 v59, v59, v67
v_add_f32 v63, v63, v51
v_cvt_pk_bf16_f32 v68, v56, v57
v_cvt_pk_bf16_f32 v69, v58, v59
v_cvt_pk_bf16_f32 v70, v60, v61
v_cvt_pk_bf16_f32 v71, v62, v63
buffer_store_dwordx2 v[52:53], v9, s[4:7], s30 offen
buffer_store_dwordx2 v[68:69], v10, s[4:7], s31 offen
buffer_store_dwordx2 v[70:71], v10, s[4:7], s31 offen offset:256
s_branch reca_exit1
reca_vmst29:
s_sleep 1
buffer_load_dwordx4 v[208:211], v1, s[4:7], s21 offen offset:0 sc1
buffer_load_dwordx4 v[212:215], v1, s[4:7], s21 offen offset:1024 sc1
buffer_load_dwordx4 v[216:219], v1, s[4:7], s21 offen offset:2048 sc1
buffer_load_dwordx4 v[220:223], v1, s[4:7], s21 offen offset:3072 sc1
buffer_load_dwordx4 v[224:227], v2, s[4:7], s21 offen offset:0 sc1
buffer_load_dwordx4 v[228:231], v2, s[4:7], s21 offen offset:1024 sc1
s_waitcnt vmcnt(5)
v_max_u32 v29, v208, v210
v_cmp_eq_u32 vcc, -1, v29
s_cbranch_vccnz reca_retry30
reca_resume31:
s_waitcnt vmcnt(4)
v_max_u32 v29, v212, v214
v_cmp_eq_u32 vcc, -1, v29
v_mfma_f32_16x16x32_bf16 v[76:79], a[120:123], v[208:211], 0
v_mfma_f32_16x16x32_bf16 v[80:83], a[144:147], v[208:211], 0
v_mfma_f32_16x16x32_bf16 v[72:75], v[208:211], v[208:211], v[40:43]
s_cbranch_vccnz reca_retry32
reca_resume33:
s_waitcnt vmcnt(3)
v_max_u32 v29, v216, v218
v_cmp_eq_u32 vcc, -1, v29
v_mfma_f32_16x16x32_bf16 v[76:79], a[124:127], v[212:215], v[76:79]
v_mfma_f32_16x16x32_bf16 v[80:83], a[148:151], v[212:215], v[80:83]
v_mfma_f32_16x16x32_bf16 v[72:75], v[212:215], v[212:215], v[72:75]
s_cbranch_vccnz reca_retry34
reca_resume35:
s_waitcnt vmcnt(2)
v_max_u32 v29, v220, v222
v_cmp_eq_u32 vcc, -1, v29
v_mfma_f32_16x16x32_bf16 v[76:79], a[128:131], v[216:219], v[76:79]
v_mfma_f32_16x16x32_bf16 v[80:83], a[152:155], v[216:219], v[80:83]
v_mfma_f32_16x16x32_bf16 v[72:75], v[216:219], v[216:219], v[72:75]
s_cbranch_vccnz reca_retry36
reca_resume37:
s_waitcnt vmcnt(1)
v_max_u32 v29, v224, v226
v_cmp_eq_u32 vcc, -1, v29
v_mfma_f32_16x16x32_bf16 v[76:79], a[132:135], v[220:223], v[76:79]
v_mfma_f32_16x16x32_bf16 v[80:83], a[156:159], v[220:223], v[80:83]
v_mfma_f32_16x16x32_bf16 v[72:75], v[220:223], v[220:223], v[72:75]
s_cbranch_vccnz reca_retry38
reca_resume39:
s_waitcnt vmcnt(0)
v_max_u32 v29, v228, v230
v_cmp_eq_u32 vcc, -1, v29
v_mfma_f32_16x16x32_bf16 v[76:79], a[136:139], v[224:227], v[76:79]
v_mfma_f32_16x16x32_bf16 v[80:83], a[160:163], v[224:227], v[80:83]
v_mfma_f32_16x16x32_bf16 v[72:75], v[224:227], v[224:227], v[72:75]
s_cbranch_vccnz reca_retry40
reca_resume41:
v_mfma_f32_16x16x32_bf16 v[76:79], a[140:143], v[228:231], v[76:79]
v_mfma_f32_16x16x32_bf16 v[80:83], a[164:167], v[228:231], v[80:83]
v_mfma_f32_16x16x32_bf16 v[72:75], v[228:231], v[228:231], v[72:75]
s_barrier
ds_read_b128 v[56:59], v1 offset:10240
ds_read_b128 v[60:63], v1 offset:11264
ds_read_b128 v[64:67], v1 offset:12288
s_nop 1
v_max3_f32 v28, v76, v77, v78
v_max3_f32 v29, v80, v81, v82
v_max3_f32 v28, v28, v79, v83
v_max3_f32 v29, v29, v72, v73
v_max3_f32 v28, v28, v74, v75
v_max_f32 v28, v28, v29
v_mov_b32 v29, v28
s_nop 1
v_permlane32_swap_b32 v28, v29
v_max_f32 v28, v28, v29
v_mov_b32 v29, v28
s_nop 1
v_permlane16_swap_b32 v28, v29
v_max_f32 v28, v28, v29
v_mul_f32 v28, s41, v28
v_fma_f32 v76, v76, s41, -v28
v_fma_f32 v77, v77, s41, -v28
v_fma_f32 v78, v78, s41, -v28
v_fma_f32 v79, v79, s41, -v28
v_fma_f32 v80, v80, s41, -v28
v_fma_f32 v81, v81, s41, -v28
v_fma_f32 v82, v82, s41, -v28
v_fma_f32 v83, v83, s41, -v28
v_fma_f32 v72, v72, s41, -v28
v_fma_f32 v73, v73, s41, -v28
v_fma_f32 v74, v74, s41, -v28
v_fma_f32 v75, v75, s41, -v28
v_exp_f32 v76, v76
v_exp_f32 v77, v77
v_exp_f32 v78, v78
v_exp_f32 v79, v79
v_exp_f32 v80, v80
v_exp_f32 v81, v81
v_exp_f32 v82, v82
v_exp_f32 v83, v83
v_cvt_pk_bf16_f32 v84, v76, v77
v_cvt_pk_bf16_f32 v85, v78, v79
v_cvt_pk_bf16_f32 v86, v80, v81
v_cvt_pk_bf16_f32 v87, v82, v83
v_exp_f32 v72, v72
v_exp_f32 v73, v73
v_mfma_f32_16x16x32_bf16 v[100:103], v[36:39], v[84:87], 0
v_exp_f32 v74, v74
v_exp_f32 v75, v75
v_mfma_f32_16x16x32_bf16 v[92:95], a[168:171], v[84:87], 0
v_cvt_pk_bf16_f32 v88, v72, v73
v_cvt_pk_bf16_f32 v89, v74, v75
v_mfma_f32_16x16x32_bf16 v[96:99], a[172:175], v[84:87], 0
s_waitcnt lgkmcnt(0)
v_mfma_f32_16x16x16_bf16 v[100:103], v[36:37], v[88:89], v[100:103]
v_add_f32 v56, v56, v64
v_add_f32 v60, v60, v48
v_add_f32 v57, v57, v65
v_add_f32 v61, v61, v49
v_add_f32 v58, v58, v66
v_add_f32 v62, v62, v50
v_add_f32 v59, v59, v67
v_add_f32 v63, v63, v51
v_cvt_pk_bf16_f32 v68, v56, v57
v_cvt_pk_bf16_f32 v69, v58, v59
v_cvt_pk_bf16_f32 v70, v60, v61
v_cvt_pk_bf16_f32 v71, v62, v63
v_mfma_f32_16x16x16_bf16 v[92:95], v[68:69], v[88:89], v[92:95]
v_rcp_f32 v28, v100
v_mfma_f32_16x16x16_bf16 v[96:99], v[70:71], v[88:89], v[96:99]
v_mov_b32 v29, v28
s_nop 4
v_pk_mul_f32 v[92:93], v[92:93], v[28:29]
v_pk_mul_f32 v[94:95], v[94:95], v[28:29]
v_pk_mul_f32 v[96:97], v[96:97], v[28:29]
v_pk_mul_f32 v[98:99], v[98:99], v[28:29]
v_cvt_pk_bf16_f32 v104, v92, v93
v_cvt_pk_bf16_f32 v105, v94, v95
v_cvt_pk_bf16_f32 v106, v96, v97
v_cvt_pk_bf16_f32 v107, v98, v99
buffer_store_dwordx4 v[104:107], v11, s[4:7], s22 offen
reca_b326:
s_barrier
s_cmp_ge_u32 s12, 2
s_cbranch_scc1 reca_notg242
s_sleep 3
buffer_load_dwordx4 v[128:131], v12, s[4:7], s22 offen offset:0 sc1
buffer_load_dwordx4 v[132:135], v12, s[4:7], s22 offen offset:1024 sc1
buffer_load_dwordx4 v[136:139], v12, s[4:7], s22 offen offset:2048 sc1
buffer_load_dwordx4 v[140:143], v12, s[4:7], s22 offen offset:3072 sc1
buffer_load_dwordx4 v[144:147], v13, s[4:7], s22 offen offset:0 sc1
buffer_load_dwordx4 v[148:151], v13, s[4:7], s22 offen offset:1024 sc1
buffer_load_dwordx4 v[152:155], v13, s[4:7], s22 offen offset:2048 sc1
buffer_load_dwordx4 v[156:159], v13, s[4:7], s22 offen offset:3072 sc1
buffer_load_dwordx4 v[160:163], v14, s[4:7], s22 offen offset:0 sc1
buffer_load_dwordx4 v[164:167], v14, s[4:7], s22 offen offset:1024 sc1
buffer_load_dwordx4 v[168:171], v14, s[4:7], s22 offen offset:2048 sc1
buffer_load_dwordx4 v[172:175], v14, s[4:7], s22 offen offset:3072 sc1
s_waitcnt vmcnt(11)
v_cmp_eq_u32 vcc, -1, v128
s_cbranch_vccnz reca_retry43
reca_resume44:
s_waitcnt vmcnt(10)
v_cmp_eq_u32 vcc, -1, v132
v_mfma_f32_16x16x32_bf16 v[108:111], a[120:123], v[128:131], 0
v_mfma_f32_16x16x32_bf16 v[112:115], a[124:127], v[128:131], 0
s_cbranch_vccnz reca_retry45
reca_resume46:
s_waitcnt vmcnt(9)
v_cmp_eq_u32 vcc, -1, v136
v_mfma_f32_16x16x32_bf16 v[108:111], a[128:131], v[132:135], v[108:111]
v_mfma_f32_16x16x32_bf16 v[112:115], a[132:135], v[132:135], v[112:115]
s_cbranch_vccnz reca_retry47
reca_resume48:
s_waitcnt vmcnt(8)
v_cmp_eq_u32 vcc, -1, v140
v_mfma_f32_16x16x32_bf16 v[108:111], a[136:139], v[136:139], v[108:111]
v_mfma_f32_16x16x32_bf16 v[112:115], a[140:143], v[136:139], v[112:115]
s_cbranch_vccnz reca_retry49
reca_resume50:
s_waitcnt vmcnt(7)
v_cmp_eq_u32 vcc, -1, v144
v_mfma_f32_16x16x32_bf16 v[108:111], a[144:147], v[140:143], v[108:111]
v_mfma_f32_16x16x32_bf16 v[112:115], a[148:151], v[140:143], v[112:115]
s_cbranch_vccnz reca_retry51
reca_resume52:
s_waitcnt vmcnt(6)
v_cmp_eq_u32 vcc, -1, v148
v_mfma_f32_16x16x32_bf16 v[108:111], a[152:155], v[144:147], v[108:111]
v_mfma_f32_16x16x32_bf16 v[112:115], a[156:159], v[144:147], v[112:115]
s_cbranch_vccnz reca_retry53
reca_resume54:
s_waitcnt vmcnt(5)
v_cmp_eq_u32 vcc, -1, v152
v_mfma_f32_16x16x32_bf16 v[108:111], a[160:163], v[148:151], v[108:111]
v_mfma_f32_16x16x32_bf16 v[112:115], a[164:167], v[148:151], v[112:115]
s_cbranch_vccnz reca_retry55
reca_resume56:
s_waitcnt vmcnt(4)
v_cmp_eq_u32 vcc, -1, v156
v_mfma_f32_16x16x32_bf16 v[108:111], a[168:171], v[152:155], v[108:111]
v_mfma_f32_16x16x32_bf16 v[112:115], a[172:175], v[152:155], v[112:115]
s_cbranch_vccnz reca_retry57
reca_resume58:
s_waitcnt vmcnt(3)
v_cmp_eq_u32 vcc, -1, v160
v_mfma_f32_16x16x32_bf16 v[108:111], a[176:179], v[156:159], v[108:111]
v_mfma_f32_16x16x32_bf16 v[112:115], a[180:183], v[156:159], v[112:115]
s_cbranch_vccnz reca_retry59
reca_resume60:
s_waitcnt vmcnt(2)
v_cmp_eq_u32 vcc, -1, v164
v_mfma_f32_16x16x32_bf16 v[108:111], a[184:187], v[160:163], v[108:111]
v_mfma_f32_16x16x32_bf16 v[112:115], a[188:191], v[160:163], v[112:115]
s_cbranch_vccnz reca_retry61
reca_resume62:
s_waitcnt vmcnt(1)
v_cmp_eq_u32 vcc, -1, v168
v_mfma_f32_16x16x32_bf16 v[108:111], a[192:195], v[164:167], v[108:111]
v_mfma_f32_16x16x32_bf16 v[112:115], a[196:199], v[164:167], v[112:115]
s_cbranch_vccnz reca_retry63
reca_resume64:
s_waitcnt vmcnt(0)
v_cmp_eq_u32 vcc, -1, v172
v_mfma_f32_16x16x32_bf16 v[108:111], a[200:203], v[168:171], v[108:111]
v_mfma_f32_16x16x32_bf16 v[112:115], a[204:207], v[168:171], v[112:115]
s_cbranch_vccnz reca_retry65
reca_resume66:
v_mfma_f32_16x16x32_bf16 v[108:111], a[208:211], v[172:175], v[108:111]
v_mfma_f32_16x16x32_bf16 v[112:115], a[212:215], v[172:175], v[112:115]
s_nop 7
v_add_f32_dpp v116, v112, v108 row_ror:8 row_mask:0xf bank_mask:0xf
v_add_f32_dpp v117, v113, v109 row_ror:8 row_mask:0xf bank_mask:0xf
v_add_f32_dpp v118, v114, v110 row_ror:8 row_mask:0xf bank_mask:0xf
v_add_f32_dpp v119, v115, v111 row_ror:8 row_mask:0xf bank_mask:0xf
buffer_store_dwordx4 v[116:119], v15, s[4:7], s25 offen sc1
buffer_store_dwordx4 v[116:119], v232, s[4:7], s25 offen sc1
buffer_store_dwordx4 v[32:35], v15, s[4:7], s29 offen sc1
buffer_store_dwordx4 v[32:35], v232, s[4:7], s29 offen sc1
s_branch reca_b427
reca_notg242:
s_cmp_lg_u32 s12, 3
s_cbranch_scc1 reca_b427
s_add_u32 s34, s17, 2
s_and_b32 s34, s34, 3
s_mul_i32 s26, s34, 10240
s_add_u32 s26, s26, s38
s_mul_i32 s27, s34, 6144
s_add_u32 s27, s27, s39
s_mul_i32 s28, s34, 12288
s_add_u32 s28, s28, s40
s_mul_i32 s29, s34, 393216
s_add_u32 s29, s29, s56
buffer_store_dwordx2 v[32:33], v8, s[4:7], s27 offen
buffer_store_dwordx4 v[32:35], v11, s[4:7], s28 offen
reca_b427:
s_barrier
s_cmp_lg_u32 s12, 2
s_cbranch_scc1 reca_not267
s_sleep 8
buffer_load_dwordx4 v[128:131], v20, s[4:7], s25 offen sc1
buffer_load_dwordx4 v[132:135], v21, s[4:7], s25 offen sc1
buffer_load_dwordx4 v[136:139], v22, s[4:7], s25 offen sc1
buffer_load_dwordx4 v[140:143], v23, s[4:7], s25 offen sc1
buffer_load_dwordx4 v[144:147], v24, s[4:7], s25 offen sc1
buffer_load_dwordx4 v[148:151], v25, s[4:7], s25 offen sc1
buffer_load_dwordx4 v[152:155], v26, s[4:7], s25 offen sc1
buffer_load_dwordx4 v[156:159], v27, s[4:7], s25 offen sc1
s_waitcnt vmcnt(7)
v_cmp_eq_u32 vcc, -1, v128
s_cbranch_vccnz reca_retry68
reca_resume69:
s_waitcnt vmcnt(6)
v_cmp_eq_u32 vcc, -1, v132
s_cbranch_vccnz reca_retry70
reca_resume71:
s_waitcnt vmcnt(5)
v_cmp_eq_u32 vcc, -1, v136
v_pk_add_f32 v[116:117], v[128:129], v[132:133]
v_pk_add_f32 v[118:119], v[130:131], v[134:135]
s_cbranch_vccnz reca_retry72
reca_resume73:
s_waitcnt vmcnt(4)
v_cmp_eq_u32 vcc, -1, v140
v_pk_add_f32 v[116:117], v[116:117], v[136:137]
v_pk_add_f32 v[118:119], v[118:119], v[138:139]
s_cbranch_vccnz reca_retry74
reca_resume75:
s_waitcnt vmcnt(3)
v_cmp_eq_u32 vcc, -1, v144
v_pk_add_f32 v[116:117], v[116:117], v[140:141]
v_pk_add_f32 v[118:119], v[118:119], v[142:143]
s_cbranch_vccnz reca_retry76
reca_resume77:
s_waitcnt vmcnt(2)
v_cmp_eq_u32 vcc, -1, v148
v_pk_add_f32 v[116:117], v[116:117], v[144:145]
v_pk_add_f32 v[118:119], v[118:119], v[146:147]
s_cbranch_vccnz reca_retry78
reca_resume79:
s_waitcnt vmcnt(1)
v_cmp_eq_u32 vcc, -1, v152
v_pk_add_f32 v[116:117], v[116:117], v[148:149]
v_pk_add_f32 v[118:119], v[118:119], v[150:151]
s_cbranch_vccnz reca_retry80
reca_resume81:
s_waitcnt vmcnt(0)
v_cmp_eq_u32 vcc, -1, v156
v_pk_add_f32 v[116:117], v[116:117], v[152:153]
v_pk_add_f32 v[118:119], v[118:119], v[154:155]
s_cbranch_vccnz reca_retry82
reca_resume83:
v_pk_add_f32 v[116:117], v[116:117], v[156:157]
v_pk_add_f32 v[118:119], v[118:119], v[158:159]
v_cvt_pk_bf16_f32 v132, v116, v117
v_cvt_pk_bf16_f32 v133, v118, v119
buffer_store_dwordx2 v[132:133], v16, s[4:7], s24 offen
s_branch reca_b528
reca_not267:
s_cmp_lg_u32 s12, 3
s_cbranch_scc1 reca_b528
s_add_u32 s36, s17, 1
s_cmp_ge_u32 s36, 63
s_cbranch_scc1 reca_nopf84
s_add_u32 s37, s36, 1
reca_pf85:
buffer_load_dword v28, v233, s[4:7], 0 offen sc1
s_waitcnt vmcnt(0)
v_cmp_gt_i32 vcc, s37, v28
s_cbranch_vccz reca_pfok86
s_sleep 1
s_sub_u32 s18, s18, 1
s_cbranch_scc0 reca_pf85
s_mov_b32 s18, 0
reca_pfok86:
s_lshl_b32 s34, s15, 3
s_and_b32 s35, s36, 7
s_add_u32 s34, s34, s35
s_mul_i32 s34, s34, 12288
s_add_u32 s32, s34, 37748736
s_lshl_b32 s35, s16, 11
s_add_u32 s34, s34, s35
s_add_u32 s33, s34, 40894464
buffer_load_dwordx4 a[120:123], v1, s[4:7], s32 offen offset:0 sc1
buffer_load_dwordx4 a[124:127], v1, s[4:7], s32 offen offset:1024 sc1
buffer_load_dwordx4 a[128:131], v1, s[4:7], s32 offen offset:2048 sc1
buffer_load_dwordx4 a[132:135], v1, s[4:7], s32 offen offset:3072 sc1
buffer_load_dwordx4 a[136:139], v2, s[4:7], s32 offen offset:0 sc1
buffer_load_dwordx4 a[140:143], v2, s[4:7], s32 offen offset:1024 sc1
buffer_load_dwordx4 a[144:147], v2, s[4:7], s32 offen offset:2048 sc1
buffer_load_dwordx4 a[148:151], v2, s[4:7], s32 offen offset:3072 sc1
buffer_load_dwordx4 a[152:155], v3, s[4:7], s32 offen offset:0 sc1
buffer_load_dwordx4 a[156:159], v3, s[4:7], s32 offen offset:1024 sc1
buffer_load_dwordx4 a[160:163], v3, s[4:7], s32 offen offset:2048 sc1
buffer_load_dwordx4 a[164:167], v3, s[4:7], s32 offen offset:3072 sc1
buffer_load_dwordx4 a[168:171], v1, s[4:7], s33 offen offset:0 sc1
buffer_load_dwordx4 a[172:175], v1, s[4:7], s33 offen offset:1024 sc1
reca_nopf84:
buffer_store_dwordx2 v[52:53], v9, s[4:7], s30 offen
buffer_store_dwordx2 v[68:69], v10, s[4:7], s31 offen
buffer_store_dwordx2 v[70:71], v10, s[4:7], s31 offen offset:256
reca_b528:
s_barrier
s_add_u32 s17, s17, 1
s_branch reca_step14
reca_retry17:
s_sub_u32 s18, s18, 1
s_cbranch_scc1 reca_retry17_to
buffer_load_dwordx4 v[128:131], v4, s[4:7], s20 offen sc1
buffer_load_dwordx4 v[132:135], v4, s[4:7], s20 offen offset:1024 sc1
buffer_load_dwordx4 v[136:139], v5, s[4:7], s20 offen sc1
s_waitcnt vmcnt(2)
v_max_u32 v29, v128, v130
v_cmp_eq_u32 vcc, -1, v29
s_cbranch_vccnz reca_retry17
s_branch reca_resume18
reca_retry17_to:
s_mov_b32 s18, 0
s_waitcnt vmcnt(0)
s_branch reca_resume18
reca_retry19:
s_sub_u32 s18, s18, 1
s_cbranch_scc1 reca_retry19_to
buffer_load_dwordx4 v[132:135], v4, s[4:7], s20 offen offset:1024 sc1
buffer_load_dwordx4 v[136:139], v5, s[4:7], s20 offen sc1
s_waitcnt vmcnt(1)
v_max_u32 v29, v132, v134
v_cmp_eq_u32 vcc, -1, v29
s_cbranch_vccnz reca_retry19
s_branch reca_resume20
reca_retry19_to:
s_mov_b32 s18, 0
s_waitcnt vmcnt(0)
s_branch reca_resume20
reca_retry21:
s_sub_u32 s18, s18, 1
s_cbranch_scc1 reca_retry21_to
buffer_load_dwordx4 v[136:139], v5, s[4:7], s20 offen sc1
s_waitcnt vmcnt(0)
v_max_u32 v29, v136, v138
v_cmp_eq_u32 vcc, -1, v29
s_cbranch_vccnz reca_retry21
s_branch reca_resume22
reca_retry21_to:
s_mov_b32 s18, 0
s_waitcnt vmcnt(0)
s_branch reca_resume22
reca_retry30:
s_sub_u32 s18, s18, 1
s_cbranch_scc1 reca_retry30_to
buffer_load_dwordx4 v[208:211], v1, s[4:7], s21 offen offset:0 sc1
buffer_load_dwordx4 v[212:215], v1, s[4:7], s21 offen offset:1024 sc1
buffer_load_dwordx4 v[216:219], v1, s[4:7], s21 offen offset:2048 sc1
buffer_load_dwordx4 v[220:223], v1, s[4:7], s21 offen offset:3072 sc1
buffer_load_dwordx4 v[224:227], v2, s[4:7], s21 offen offset:0 sc1
buffer_load_dwordx4 v[228:231], v2, s[4:7], s21 offen offset:1024 sc1
s_waitcnt vmcnt(5)
v_max_u32 v29, v208, v210
v_cmp_eq_u32 vcc, -1, v29
s_cbranch_vccnz reca_retry30
s_branch reca_resume31
reca_retry30_to:
s_mov_b32 s18, 0
s_waitcnt vmcnt(0)
s_branch reca_resume31
reca_retry32:
s_sub_u32 s18, s18, 1
s_cbranch_scc1 reca_retry32_to
buffer_load_dwordx4 v[212:215], v1, s[4:7], s21 offen offset:1024 sc1
buffer_load_dwordx4 v[216:219], v1, s[4:7], s21 offen offset:2048 sc1
buffer_load_dwordx4 v[220:223], v1, s[4:7], s21 offen offset:3072 sc1
buffer_load_dwordx4 v[224:227], v2, s[4:7], s21 offen offset:0 sc1
buffer_load_dwordx4 v[228:231], v2, s[4:7], s21 offen offset:1024 sc1
s_waitcnt vmcnt(4)
v_max_u32 v29, v212, v214
v_cmp_eq_u32 vcc, -1, v29
s_cbranch_vccnz reca_retry32
s_branch reca_resume33
reca_retry32_to:
s_mov_b32 s18, 0
s_waitcnt vmcnt(0)
s_branch reca_resume33
reca_retry34:
s_sub_u32 s18, s18, 1
s_cbranch_scc1 reca_retry34_to
buffer_load_dwordx4 v[216:219], v1, s[4:7], s21 offen offset:2048 sc1
buffer_load_dwordx4 v[220:223], v1, s[4:7], s21 offen offset:3072 sc1
buffer_load_dwordx4 v[224:227], v2, s[4:7], s21 offen offset:0 sc1
buffer_load_dwordx4 v[228:231], v2, s[4:7], s21 offen offset:1024 sc1
s_waitcnt vmcnt(3)
v_max_u32 v29, v216, v218
v_cmp_eq_u32 vcc, -1, v29
s_cbranch_vccnz reca_retry34
s_branch reca_resume35
reca_retry34_to:
s_mov_b32 s18, 0
s_waitcnt vmcnt(0)
s_branch reca_resume35
reca_retry36:
s_sub_u32 s18, s18, 1
s_cbranch_scc1 reca_retry36_to
buffer_load_dwordx4 v[220:223], v1, s[4:7], s21 offen offset:3072 sc1
buffer_load_dwordx4 v[224:227], v2, s[4:7], s21 offen offset:0 sc1
buffer_load_dwordx4 v[228:231], v2, s[4:7], s21 offen offset:1024 sc1
s_waitcnt vmcnt(2)
v_max_u32 v29, v220, v222
v_cmp_eq_u32 vcc, -1, v29
s_cbranch_vccnz reca_retry36
s_branch reca_resume37
reca_retry36_to:
s_mov_b32 s18, 0
s_waitcnt vmcnt(0)
s_branch reca_resume37
reca_retry38:
s_sub_u32 s18, s18, 1
s_cbranch_scc1 reca_retry38_to
buffer_load_dwordx4 v[224:227], v2, s[4:7], s21 offen offset:0 sc1
buffer_load_dwordx4 v[228:231], v2, s[4:7], s21 offen offset:1024 sc1
s_waitcnt vmcnt(1)
v_max_u32 v29, v224, v226
v_cmp_eq_u32 vcc, -1, v29
s_cbranch_vccnz reca_retry38
s_branch reca_resume39
reca_retry38_to:
s_mov_b32 s18, 0
s_waitcnt vmcnt(0)
s_branch reca_resume39
reca_retry40:
s_sub_u32 s18, s18, 1
s_cbranch_scc1 reca_retry40_to
buffer_load_dwordx4 v[228:231], v2, s[4:7], s21 offen offset:1024 sc1
s_waitcnt vmcnt(0)
v_max_u32 v29, v228, v230
v_cmp_eq_u32 vcc, -1, v29
s_cbranch_vccnz reca_retry40
s_branch reca_resume41
reca_retry40_to:
s_mov_b32 s18, 0
s_waitcnt vmcnt(0)
s_branch reca_resume41
reca_retry43:
s_sub_u32 s18, s18, 1
s_cbranch_scc1 reca_retry43_to
buffer_load_dwordx4 v[128:131], v12, s[4:7], s22 offen offset:0 sc1
buffer_load_dwordx4 v[132:135], v12, s[4:7], s22 offen offset:1024 sc1
buffer_load_dwordx4 v[136:139], v12, s[4:7], s22 offen offset:2048 sc1
buffer_load_dwordx4 v[140:143], v12, s[4:7], s22 offen offset:3072 sc1
buffer_load_dwordx4 v[144:147], v13, s[4:7], s22 offen offset:0 sc1
buffer_load_dwordx4 v[148:151], v13, s[4:7], s22 offen offset:1024 sc1
buffer_load_dwordx4 v[152:155], v13, s[4:7], s22 offen offset:2048 sc1
buffer_load_dwordx4 v[156:159], v13, s[4:7], s22 offen offset:3072 sc1
buffer_load_dwordx4 v[160:163], v14, s[4:7], s22 offen offset:0 sc1
buffer_load_dwordx4 v[164:167], v14, s[4:7], s22 offen offset:1024 sc1
buffer_load_dwordx4 v[168:171], v14, s[4:7], s22 offen offset:2048 sc1
buffer_load_dwordx4 v[172:175], v14, s[4:7], s22 offen offset:3072 sc1
s_waitcnt vmcnt(11)
v_cmp_eq_u32 vcc, -1, v128
s_cbranch_vccnz reca_retry43
s_branch reca_resume44
reca_retry43_to:
s_mov_b32 s18, 0
s_waitcnt vmcnt(0)
s_branch reca_resume44
reca_retry45:
s_sub_u32 s18, s18, 1
s_cbranch_scc1 reca_retry45_to
buffer_load_dwordx4 v[132:135], v12, s[4:7], s22 offen offset:1024 sc1
buffer_load_dwordx4 v[136:139], v12, s[4:7], s22 offen offset:2048 sc1
buffer_load_dwordx4 v[140:143], v12, s[4:7], s22 offen offset:3072 sc1
buffer_load_dwordx4 v[144:147], v13, s[4:7], s22 offen offset:0 sc1
buffer_load_dwordx4 v[148:151], v13, s[4:7], s22 offen offset:1024 sc1
buffer_load_dwordx4 v[152:155], v13, s[4:7], s22 offen offset:2048 sc1
buffer_load_dwordx4 v[156:159], v13, s[4:7], s22 offen offset:3072 sc1
buffer_load_dwordx4 v[160:163], v14, s[4:7], s22 offen offset:0 sc1
buffer_load_dwordx4 v[164:167], v14, s[4:7], s22 offen offset:1024 sc1
buffer_load_dwordx4 v[168:171], v14, s[4:7], s22 offen offset:2048 sc1
buffer_load_dwordx4 v[172:175], v14, s[4:7], s22 offen offset:3072 sc1
s_waitcnt vmcnt(10)
v_cmp_eq_u32 vcc, -1, v132
s_cbranch_vccnz reca_retry45
s_branch reca_resume46
reca_retry45_to:
s_mov_b32 s18, 0
s_waitcnt vmcnt(0)
s_branch reca_resume46
reca_retry47:
s_sub_u32 s18, s18, 1
s_cbranch_scc1 reca_retry47_to
buffer_load_dwordx4 v[136:139], v12, s[4:7], s22 offen offset:2048 sc1
buffer_load_dwordx4 v[140:143], v12, s[4:7], s22 offen offset:3072 sc1
buffer_load_dwordx4 v[144:147], v13, s[4:7], s22 offen offset:0 sc1
buffer_load_dwordx4 v[148:151], v13, s[4:7], s22 offen offset:1024 sc1
buffer_load_dwordx4 v[152:155], v13, s[4:7], s22 offen offset:2048 sc1
buffer_load_dwordx4 v[156:159], v13, s[4:7], s22 offen offset:3072 sc1
buffer_load_dwordx4 v[160:163], v14, s[4:7], s22 offen offset:0 sc1
buffer_load_dwordx4 v[164:167], v14, s[4:7], s22 offen offset:1024 sc1
buffer_load_dwordx4 v[168:171], v14, s[4:7], s22 offen offset:2048 sc1
buffer_load_dwordx4 v[172:175], v14, s[4:7], s22 offen offset:3072 sc1
s_waitcnt vmcnt(9)
v_cmp_eq_u32 vcc, -1, v136
s_cbranch_vccnz reca_retry47
s_branch reca_resume48
reca_retry47_to:
s_mov_b32 s18, 0
s_waitcnt vmcnt(0)
s_branch reca_resume48
reca_retry49:
s_sub_u32 s18, s18, 1
s_cbranch_scc1 reca_retry49_to
buffer_load_dwordx4 v[140:143], v12, s[4:7], s22 offen offset:3072 sc1
buffer_load_dwordx4 v[144:147], v13, s[4:7], s22 offen offset:0 sc1
buffer_load_dwordx4 v[148:151], v13, s[4:7], s22 offen offset:1024 sc1
buffer_load_dwordx4 v[152:155], v13, s[4:7], s22 offen offset:2048 sc1
buffer_load_dwordx4 v[156:159], v13, s[4:7], s22 offen offset:3072 sc1
buffer_load_dwordx4 v[160:163], v14, s[4:7], s22 offen offset:0 sc1
buffer_load_dwordx4 v[164:167], v14, s[4:7], s22 offen offset:1024 sc1
buffer_load_dwordx4 v[168:171], v14, s[4:7], s22 offen offset:2048 sc1
buffer_load_dwordx4 v[172:175], v14, s[4:7], s22 offen offset:3072 sc1
s_waitcnt vmcnt(8)
v_cmp_eq_u32 vcc, -1, v140
s_cbranch_vccnz reca_retry49
s_branch reca_resume50
reca_retry49_to:
s_mov_b32 s18, 0
s_waitcnt vmcnt(0)
s_branch reca_resume50
reca_retry51:
s_sub_u32 s18, s18, 1
s_cbranch_scc1 reca_retry51_to
buffer_load_dwordx4 v[144:147], v13, s[4:7], s22 offen offset:0 sc1
buffer_load_dwordx4 v[148:151], v13, s[4:7], s22 offen offset:1024 sc1
buffer_load_dwordx4 v[152:155], v13, s[4:7], s22 offen offset:2048 sc1
buffer_load_dwordx4 v[156:159], v13, s[4:7], s22 offen offset:3072 sc1
buffer_load_dwordx4 v[160:163], v14, s[4:7], s22 offen offset:0 sc1
buffer_load_dwordx4 v[164:167], v14, s[4:7], s22 offen offset:1024 sc1
buffer_load_dwordx4 v[168:171], v14, s[4:7], s22 offen offset:2048 sc1
buffer_load_dwordx4 v[172:175], v14, s[4:7], s22 offen offset:3072 sc1
s_waitcnt vmcnt(7)
v_cmp_eq_u32 vcc, -1, v144
s_cbranch_vccnz reca_retry51
s_branch reca_resume52
reca_retry51_to:
s_mov_b32 s18, 0
s_waitcnt vmcnt(0)
s_branch reca_resume52
reca_retry53:
s_sub_u32 s18, s18, 1
s_cbranch_scc1 reca_retry53_to
buffer_load_dwordx4 v[148:151], v13, s[4:7], s22 offen offset:1024 sc1
buffer_load_dwordx4 v[152:155], v13, s[4:7], s22 offen offset:2048 sc1
buffer_load_dwordx4 v[156:159], v13, s[4:7], s22 offen offset:3072 sc1
buffer_load_dwordx4 v[160:163], v14, s[4:7], s22 offen offset:0 sc1
buffer_load_dwordx4 v[164:167], v14, s[4:7], s22 offen offset:1024 sc1
buffer_load_dwordx4 v[168:171], v14, s[4:7], s22 offen offset:2048 sc1
buffer_load_dwordx4 v[172:175], v14, s[4:7], s22 offen offset:3072 sc1
s_waitcnt vmcnt(6)
v_cmp_eq_u32 vcc, -1, v148
s_cbranch_vccnz reca_retry53
s_branch reca_resume54
reca_retry53_to:
s_mov_b32 s18, 0
s_waitcnt vmcnt(0)
s_branch reca_resume54
reca_retry55:
s_sub_u32 s18, s18, 1
s_cbranch_scc1 reca_retry55_to
buffer_load_dwordx4 v[152:155], v13, s[4:7], s22 offen offset:2048 sc1
buffer_load_dwordx4 v[156:159], v13, s[4:7], s22 offen offset:3072 sc1
buffer_load_dwordx4 v[160:163], v14, s[4:7], s22 offen offset:0 sc1
buffer_load_dwordx4 v[164:167], v14, s[4:7], s22 offen offset:1024 sc1
buffer_load_dwordx4 v[168:171], v14, s[4:7], s22 offen offset:2048 sc1
buffer_load_dwordx4 v[172:175], v14, s[4:7], s22 offen offset:3072 sc1
s_waitcnt vmcnt(5)
v_cmp_eq_u32 vcc, -1, v152
s_cbranch_vccnz reca_retry55
s_branch reca_resume56
reca_retry55_to:
s_mov_b32 s18, 0
s_waitcnt vmcnt(0)
s_branch reca_resume56
reca_retry57:
s_sub_u32 s18, s18, 1
s_cbranch_scc1 reca_retry57_to
buffer_load_dwordx4 v[156:159], v13, s[4:7], s22 offen offset:3072 sc1
buffer_load_dwordx4 v[160:163], v14, s[4:7], s22 offen offset:0 sc1
buffer_load_dwordx4 v[164:167], v14, s[4:7], s22 offen offset:1024 sc1
buffer_load_dwordx4 v[168:171], v14, s[4:7], s22 offen offset:2048 sc1
buffer_load_dwordx4 v[172:175], v14, s[4:7], s22 offen offset:3072 sc1
s_waitcnt vmcnt(4)
v_cmp_eq_u32 vcc, -1, v156
s_cbranch_vccnz reca_retry57
s_branch reca_resume58
reca_retry57_to:
s_mov_b32 s18, 0
s_waitcnt vmcnt(0)
s_branch reca_resume58
reca_retry59:
s_sub_u32 s18, s18, 1
s_cbranch_scc1 reca_retry59_to
buffer_load_dwordx4 v[160:163], v14, s[4:7], s22 offen offset:0 sc1
buffer_load_dwordx4 v[164:167], v14, s[4:7], s22 offen offset:1024 sc1
buffer_load_dwordx4 v[168:171], v14, s[4:7], s22 offen offset:2048 sc1
buffer_load_dwordx4 v[172:175], v14, s[4:7], s22 offen offset:3072 sc1
s_waitcnt vmcnt(3)
v_cmp_eq_u32 vcc, -1, v160
s_cbranch_vccnz reca_retry59
s_branch reca_resume60
reca_retry59_to:
s_mov_b32 s18, 0
s_waitcnt vmcnt(0)
s_branch reca_resume60
reca_retry61:
s_sub_u32 s18, s18, 1
s_cbranch_scc1 reca_retry61_to
buffer_load_dwordx4 v[164:167], v14, s[4:7], s22 offen offset:1024 sc1
buffer_load_dwordx4 v[168:171], v14, s[4:7], s22 offen offset:2048 sc1
buffer_load_dwordx4 v[172:175], v14, s[4:7], s22 offen offset:3072 sc1
s_waitcnt vmcnt(2)
v_cmp_eq_u32 vcc, -1, v164
s_cbranch_vccnz reca_retry61
s_branch reca_resume62
reca_retry61_to:
s_mov_b32 s18, 0
s_waitcnt vmcnt(0)
s_branch reca_resume62
reca_retry63:
s_sub_u32 s18, s18, 1
s_cbranch_scc1 reca_retry63_to
buffer_load_dwordx4 v[168:171], v14, s[4:7], s22 offen offset:2048 sc1
buffer_load_dwordx4 v[172:175], v14, s[4:7], s22 offen offset:3072 sc1
s_waitcnt vmcnt(1)
v_cmp_eq_u32 vcc, -1, v168
s_cbranch_vccnz reca_retry63
s_branch reca_resume64
reca_retry63_to:
s_mov_b32 s18, 0
s_waitcnt vmcnt(0)
s_branch reca_resume64
reca_retry65:
s_sub_u32 s18, s18, 1
s_cbranch_scc1 reca_retry65_to
buffer_load_dwordx4 v[172:175], v14, s[4:7], s22 offen offset:3072 sc1
s_waitcnt vmcnt(0)
v_cmp_eq_u32 vcc, -1, v172
s_cbranch_vccnz reca_retry65
s_branch reca_resume66
reca_retry65_to:
s_mov_b32 s18, 0
s_waitcnt vmcnt(0)
s_branch reca_resume66
reca_retry68:
s_sub_u32 s18, s18, 1
s_cbranch_scc1 reca_retry68_to
buffer_load_dwordx4 v[128:131], v20, s[4:7], s25 offen sc1
buffer_load_dwordx4 v[132:135], v21, s[4:7], s25 offen sc1
buffer_load_dwordx4 v[136:139], v22, s[4:7], s25 offen sc1
buffer_load_dwordx4 v[140:143], v23, s[4:7], s25 offen sc1
buffer_load_dwordx4 v[144:147], v24, s[4:7], s25 offen sc1
buffer_load_dwordx4 v[148:151], v25, s[4:7], s25 offen sc1
buffer_load_dwordx4 v[152:155], v26, s[4:7], s25 offen sc1
buffer_load_dwordx4 v[156:159], v27, s[4:7], s25 offen sc1
s_waitcnt vmcnt(7)
v_cmp_eq_u32 vcc, -1, v128
s_cbranch_vccnz reca_retry68
s_branch reca_resume69
reca_retry68_to:
s_mov_b32 s18, 0
s_waitcnt vmcnt(0)
s_branch reca_resume69
reca_retry70:
s_sub_u32 s18, s18, 1
s_cbranch_scc1 reca_retry70_to
buffer_load_dwordx4 v[132:135], v21, s[4:7], s25 offen sc1
buffer_load_dwordx4 v[136:139], v22, s[4:7], s25 offen sc1
buffer_load_dwordx4 v[140:143], v23, s[4:7], s25 offen sc1
buffer_load_dwordx4 v[144:147], v24, s[4:7], s25 offen sc1
buffer_load_dwordx4 v[148:151], v25, s[4:7], s25 offen sc1
buffer_load_dwordx4 v[152:155], v26, s[4:7], s25 offen sc1
buffer_load_dwordx4 v[156:159], v27, s[4:7], s25 offen sc1
s_waitcnt vmcnt(6)
v_cmp_eq_u32 vcc, -1, v132
s_cbranch_vccnz reca_retry70
s_branch reca_resume71
reca_retry70_to:
s_mov_b32 s18, 0
s_waitcnt vmcnt(0)
s_branch reca_resume71
reca_retry72:
s_sub_u32 s18, s18, 1
s_cbranch_scc1 reca_retry72_to
buffer_load_dwordx4 v[136:139], v22, s[4:7], s25 offen sc1
buffer_load_dwordx4 v[140:143], v23, s[4:7], s25 offen sc1
buffer_load_dwordx4 v[144:147], v24, s[4:7], s25 offen sc1
buffer_load_dwordx4 v[148:151], v25, s[4:7], s25 offen sc1
buffer_load_dwordx4 v[152:155], v26, s[4:7], s25 offen sc1
buffer_load_dwordx4 v[156:159], v27, s[4:7], s25 offen sc1
s_waitcnt vmcnt(5)
v_cmp_eq_u32 vcc, -1, v136
s_cbranch_vccnz reca_retry72
s_branch reca_resume73
reca_retry72_to:
s_mov_b32 s18, 0
s_waitcnt vmcnt(0)
s_branch reca_resume73
reca_retry74:
s_sub_u32 s18, s18, 1
s_cbranch_scc1 reca_retry74_to
buffer_load_dwordx4 v[140:143], v23, s[4:7], s25 offen sc1
buffer_load_dwordx4 v[144:147], v24, s[4:7], s25 offen sc1
buffer_load_dwordx4 v[148:151], v25, s[4:7], s25 offen sc1
buffer_load_dwordx4 v[152:155], v26, s[4:7], s25 offen sc1
buffer_load_dwordx4 v[156:159], v27, s[4:7], s25 offen sc1
s_waitcnt vmcnt(4)
v_cmp_eq_u32 vcc, -1, v140
s_cbranch_vccnz reca_retry74
s_branch reca_resume75
reca_retry74_to:
s_mov_b32 s18, 0
s_waitcnt vmcnt(0)
s_branch reca_resume75
reca_retry76:
s_sub_u32 s18, s18, 1
s_cbranch_scc1 reca_retry76_to
buffer_load_dwordx4 v[144:147], v24, s[4:7], s25 offen sc1
buffer_load_dwordx4 v[148:151], v25, s[4:7], s25 offen sc1
buffer_load_dwordx4 v[152:155], v26, s[4:7], s25 offen sc1
buffer_load_dwordx4 v[156:159], v27, s[4:7], s25 offen sc1
s_waitcnt vmcnt(3)
v_cmp_eq_u32 vcc, -1, v144
s_cbranch_vccnz reca_retry76
s_branch reca_resume77
reca_retry76_to:
s_mov_b32 s18, 0
s_waitcnt vmcnt(0)
s_branch reca_resume77
reca_retry78:
s_sub_u32 s18, s18, 1
s_cbranch_scc1 reca_retry78_to
buffer_load_dwordx4 v[148:151], v25, s[4:7], s25 offen sc1
buffer_load_dwordx4 v[152:155], v26, s[4:7], s25 offen sc1
buffer_load_dwordx4 v[156:159], v27, s[4:7], s25 offen sc1
s_waitcnt vmcnt(2)
v_cmp_eq_u32 vcc, -1, v148
s_cbranch_vccnz reca_retry78
s_branch reca_resume79
reca_retry78_to:
s_mov_b32 s18, 0
s_waitcnt vmcnt(0)
s_branch reca_resume79
reca_retry80:
s_sub_u32 s18, s18, 1
s_cbranch_scc1 reca_retry80_to
buffer_load_dwordx4 v[152:155], v26, s[4:7], s25 offen sc1
buffer_load_dwordx4 v[156:159], v27, s[4:7], s25 offen sc1
s_waitcnt vmcnt(1)
v_cmp_eq_u32 vcc, -1, v152
s_cbranch_vccnz reca_retry80
s_branch reca_resume81
reca_retry80_to:
s_mov_b32 s18, 0
s_waitcnt vmcnt(0)
s_branch reca_resume81
reca_retry82:
s_sub_u32 s18, s18, 1
s_cbranch_scc1 reca_retry82_to
buffer_load_dwordx4 v[156:159], v27, s[4:7], s25 offen sc1
s_waitcnt vmcnt(0)
v_cmp_eq_u32 vcc, -1, v156
s_cbranch_vccnz reca_retry82
s_branch reca_resume83
reca_retry82_to:
s_mov_b32 s18, 0
s_waitcnt vmcnt(0)
s_branch reca_resume83
reca_twinf12:
s_branch reca_gotmem88
reca_step87:
s_and_b32 s34, s17, 3
s_mul_i32 s20, s34, 10240
s_add_u32 s20, s20, s38
s_sleep 5
buffer_load_dwordx4 v[128:131], v4, s[4:7], s20 offen sc1
buffer_load_dwordx4 v[132:135], v4, s[4:7], s20 offen offset:1024 sc1
buffer_load_dwordx4 v[136:139], v5, s[4:7], s20 offen sc1
s_waitcnt vmcnt(2)
v_max_u32 v29, v128, v130
v_cmp_eq_u32 vcc, -1, v29
s_cbranch_vccnz reca_retry90
reca_resume91:
s_waitcnt vmcnt(1)
v_max_u32 v29, v132, v134
v_cmp_eq_u32 vcc, -1, v29
ds_write_b128 v4, v[128:131]
s_cbranch_vccnz reca_retry92
reca_resume93:
s_waitcnt vmcnt(0)
v_max_u32 v29, v136, v138
v_cmp_eq_u32 vcc, -1, v29
ds_write_b128 v4, v[132:135] offset:1024
s_cbranch_vccnz reca_retry94
reca_resume95:
ds_write_b128 v5, v[136:139]
s_branch reca_gotmem289
reca_gotmem88:
ds_write_b128 v4, v[128:131]
ds_write_b128 v4, v[132:135] offset:1024
ds_write_b128 v5, v[136:139]
reca_gotmem289:
s_and_b32 s34, s17, 3
s_mul_i32 s21, s34, 6144
s_add_u32 s21, s21, s39
s_mul_i32 s22, s34, 12288
s_add_u32 s22, s22, s40
s_mul_i32 s25, s34, 393216
s_add_u32 s25, s25, s56
s_add_u32 s35, s17, 1
s_and_b32 s35, s35, 3
s_mul_i32 s24, s35, 10240
s_add_u32 s24, s24, s38
s_waitcnt lgkmcnt(0)
s_barrier
ds_read_b128 v[128:131], v236 offset:0
ds_read_b128 v[132:135], v236 offset:1024
ds_read_b128 v[136:139], v236 offset:2048
ds_read_b128 v[140:143], v236 offset:3072
ds_read_b128 v[144:147], v236 offset:4096
ds_read_b128 v[148:151], v237 offset:0
ds_read_b128 v[152:155], v237 offset:1024
ds_read_b128 v[156:159], v237 offset:2048
ds_read_b128 v[160:163], v237 offset:3072
ds_read_b128 v[164:167], v237 offset:4096
s_waitcnt lgkmcnt(9)
v_mfma_f32_16x16x32_bf16 v[44:47], a[0:3], v[128:131], 0
ds_read_b128 v[168:171], v6 offset:0
v_mfma_f32_16x16x32_bf16 v[240:243], a[4:7], v[128:131], 0
s_waitcnt lgkmcnt(9)
v_mfma_f32_16x16x32_bf16 v[44:47], a[8:11], v[132:135], v[44:47]
ds_read_b128 v[172:175], v6 offset:512
v_mfma_f32_16x16x32_bf16 v[240:243], a[12:15], v[132:135], v[240:243]
s_waitcnt lgkmcnt(9)
v_mfma_f32_16x16x32_bf16 v[44:47], a[16:19], v[136:139], v[44:47]
ds_read_b128 v[176:179], v6 offset:1024
v_mfma_f32_16x16x32_bf16 v[240:243], a[20:23], v[136:139], v[240:243]
s_waitcnt lgkmcnt(9)
v_mfma_f32_16x16x32_bf16 v[44:47], a[24:27], v[140:143], v[44:47]
ds_read_b128 v[180:183], v6 offset:1536
v_mfma_f32_16x16x32_bf16 v[240:243], a[28:31], v[140:143], v[240:243]
s_waitcnt lgkmcnt(9)
v_mfma_f32_16x16x32_bf16 v[44:47], a[32:35], v[144:147], v[44:47]
ds_read_b128 v[184:187], v6 offset:2048
v_mfma_f32_16x16x32_bf16 v[240:243], a[36:39], v[144:147], v[240:243]
s_waitcnt lgkmcnt(9)
v_mfma_f32_16x16x32_bf16 v[44:47], a[40:43], v[148:151], v[44:47]
ds_read_b128 v[188:191], v6 offset:2560
v_mfma_f32_16x16x32_bf16 v[240:243], a[44:47], v[148:151], v[240:243]
s_waitcnt lgkmcnt(9)
v_mfma_f32_16x16x32_bf16 v[44:47], a[48:51], v[152:155], v[44:47]
ds_read_b128 v[192:195], v6 offset:3072
v_mfma_f32_16x16x32_bf16 v[240:243], a[52:55], v[152:155], v[240:243]
s_waitcnt lgkmcnt(9)
v_mfma_f32_16x16x32_bf16 v[44:47], a[56:59], v[156:159], v[44:47]
ds_read_b128 v[196:199], v6 offset:3584
v_mfma_f32_16x16x32_bf16 v[240:243], a[60:63], v[156:159], v[240:243]
s_waitcnt lgkmcnt(9)
v_mfma_f32_16x16x32_bf16 v[44:47], a[64:67], v[160:163], v[44:47]
ds_read_b128 v[200:203], v6 offset:4096
v_mfma_f32_16x16x32_bf16 v[240:243], a[68:71], v[160:163], v[240:243]
s_waitcnt lgkmcnt(9)
v_mfma_f32_16x16x32_bf16 v[44:47], a[72:75], v[164:167], v[44:47]
ds_read_b128 v[204:207], v6 offset:4608
v_mfma_f32_16x16x32_bf16 v[240:243], a[76:79], v[164:167], v[240:243]
s_waitcnt lgkmcnt(9)
v_mfma_f32_16x16x32_bf16 v[48:51], v[168:171], a[80:83], 0
s_and_b32 s34, s17, 7
s_lshl_b32 s34, s34, 5
s_add_u32 s34, s34, s15
s_mul_i32 s34, s34, 3072
s_lshl_b32 s35, s16, 9
s_add_u32 s34, s34, s35
s_add_u32 s30, s34, 47185920
s_add_u32 s31, s34, 47972352
v_add_f32_dpp v44, v240, v44 row_ror:8 row_mask:0xf bank_mask:0xf
v_add_f32_dpp v45, v241, v45 row_ror:8 row_mask:0xf bank_mask:0xf
v_add_f32_dpp v46, v242, v46 row_ror:8 row_mask:0xf bank_mask:0xf
v_add_f32_dpp v47, v243, v47 row_ror:8 row_mask:0xf bank_mask:0xf
v_cvt_pk_bf16_f32 v52, v44, v45
v_cvt_pk_bf16_f32 v53, v46, v47
buffer_store_dwordx2 v[52:53], v8, s[4:7], s21 offen
s_waitcnt lgkmcnt(8)
v_mfma_f32_16x16x32_bf16 v[48:51], v[172:175], a[84:87], v[48:51]
s_waitcnt lgkmcnt(7)
v_mfma_f32_16x16x32_bf16 v[48:51], v[176:179], a[88:91], v[48:51]
s_waitcnt lgkmcnt(6)
v_mfma_f32_16x16x32_bf16 v[48:51], v[180:183], a[92:95], v[48:51]
s_waitcnt lgkmcnt(5)
v_mfma_f32_16x16x32_bf16 v[48:51], v[184:187], a[96:99], v[48:51]
s_waitcnt lgkmcnt(4)
v_mfma_f32_16x16x32_bf16 v[48:51], v[188:191], a[100:103], v[48:51]
s_waitcnt lgkmcnt(3)
v_mfma_f32_16x16x32_bf16 v[48:51], v[192:195], a[104:107], v[48:51]
s_waitcnt lgkmcnt(2)
v_mfma_f32_16x16x32_bf16 v[48:51], v[196:199], a[108:111], v[48:51]
s_waitcnt lgkmcnt(1)
v_mfma_f32_16x16x32_bf16 v[48:51], v[200:203], a[112:115], v[48:51]
s_waitcnt lgkmcnt(0)
v_mfma_f32_16x16x32_bf16 v[48:51], v[204:207], a[116:119], v[48:51]
s_cmp_eq_u32 s12, 3
s_cbranch_scc1 reca_swave96
s_nop 5
ds_write_b128 v17, v[48:51]
s_add_u32 s34, s17, 2
s_and_b32 s34, s34, 3
s_mul_i32 s26, s34, 10240
s_add_u32 s26, s26, s38
s_mul_i32 s27, s34, 6144
s_add_u32 s27, s27, s39
s_mul_i32 s28, s34, 12288
s_add_u32 s28, s28, s40
s_mul_i32 s29, s34, 393216
s_add_u32 s29, s29, s56
s_waitcnt lgkmcnt(0)
s_barrier
s_cmp_eq_u32 s17, 63
s_cbranch_scc1 reca_last98
buffer_store_dwordx2 v[32:33], v8, s[4:7], s27 offen
s_cmp_lg_u32 s12, 2
s_cbranch_scc1 reca_tw1102_n
buffer_store_dwordx2 v[52:53], v9, s[4:7], s30 offen
reca_tw1102_n:
s_barrier
s_cmp_eq_u32 s12, 1
s_cbranch_scc1 reca_tw1102
s_cmp_eq_u32 s12, 2
s_cbranch_scc1 reca_tw2103
s_cmp_lt_u32 s17, 2
s_cbranch_scc1 reca_b5101
s_cmp_gt_u32 s17, 61
s_cbranch_scc1 reca_b5101
s_sub_u32 s36, s17, 2
s_and_b32 s36, s36, 7
s_lshl_b32 s34, s59, 3
s_add_u32 s34, s34, s36
s_mul_i32 s34, s34, 12288
s_add_u32 s23, s34, 37748736
s_add_u32 s60, s34, 44040192
s_lshl_b32 s35, s36, 5
s_add_u32 s35, s35, s59
s_mul_i32 s35, s35, 3072
s_add_u32 s61, s35, 47185920
buffer_load_dwordx4 a[120:123], v1, s[4:7], s23 offen offset:0 sc1
buffer_load_dwordx4 a[124:127], v1, s[4:7], s23 offen offset:1024 sc1
buffer_load_dwordx4 a[128:131], v1, s[4:7], s23 offen offset:2048 sc1
buffer_load_dwordx4 a[132:135], v1, s[4:7], s23 offen offset:3072 sc1
buffer_load_dwordx4 a[136:139], v2, s[4:7], s23 offen offset:0 sc1
buffer_load_dwordx4 a[140:143], v2, s[4:7], s23 offen offset:1024 sc1
buffer_load_dwordx4 a[144:147], v2, s[4:7], s23 offen offset:2048 sc1
buffer_load_dwordx4 a[148:151], v2, s[4:7], s23 offen offset:3072 sc1
buffer_load_dwordx4 a[152:155], v3, s[4:7], s23 offen offset:0 sc1
buffer_load_dwordx4 a[156:159], v3, s[4:7], s23 offen offset:1024 sc1
buffer_load_dwordx4 a[160:163], v3, s[4:7], s23 offen offset:2048 sc1
buffer_load_dwordx4 a[164:167], v3, s[4:7], s23 offen offset:3072 sc1
buffer_load_dwordx4 a[216:219], v92, s[4:7], s61 offen offset:0 sc1
buffer_load_dwordx4 a[220:223], v92, s[4:7], s61 offen offset:512 sc1
buffer_load_dwordx4 a[224:227], v92, s[4:7], s61 offen offset:1024 sc1
buffer_load_dwordx4 a[228:231], v92, s[4:7], s61 offen offset:1536 sc1
buffer_load_dwordx4 a[232:235], v92, s[4:7], s61 offen offset:2048 sc1
buffer_load_dwordx4 a[236:239], v92, s[4:7], s61 offen offset:2560 sc1
buffer_load_dwordx4 a[168:171], v1, s[4:7], s60 offen offset:0 sc1
buffer_load_dwordx4 a[172:175], v1, s[4:7], s60 offen offset:1024 sc1
buffer_load_dwordx4 a[176:179], v1, s[4:7], s60 offen offset:2048 sc1
buffer_load_dwordx4 a[180:183], v1, s[4:7], s60 offen offset:3072 sc1
buffer_load_dwordx4 a[184:187], v2, s[4:7], s60 offen offset:0 sc1
buffer_load_dwordx4 a[188:191], v2, s[4:7], s60 offen offset:1024 sc1
buffer_load_dwordx4 a[192:195], v2, s[4:7], s60 offen offset:2048 sc1
buffer_load_dwordx4 a[196:199], v2, s[4:7], s60 offen offset:3072 sc1
buffer_load_dwordx4 a[200:203], v3, s[4:7], s60 offen offset:0 sc1
buffer_load_dwordx4 a[204:207], v3, s[4:7], s60 offen offset:1024 sc1
buffer_load_dwordx4 a[208:211], v3, s[4:7], s60 offen offset:2048 sc1
buffer_load_dwordx4 a[212:215], v3, s[4:7], s60 offen offset:3072 sc1
s_waitcnt vmcnt(5)
v_mfma_f32_16x16x32_bf16 v[128:131], a[216:219], a[168:171], v[84:87]
v_mfma_f32_16x16x32_bf16 v[132:135], a[120:123], a[168:171], v[88:91]
v_mfma_f32_16x16x32_bf16 v[136:139], a[216:219], a[192:195], v[84:87]
v_mfma_f32_16x16x32_bf16 v[140:143], a[120:123], a[192:195], 0
v_mfma_f32_16x16x32_bf16 v[144:147], a[144:147], a[192:195], v[88:91]
s_waitcnt vmcnt(4)
v_mfma_f32_16x16x32_bf16 v[128:131], a[220:223], a[172:175], v[128:131]
v_mfma_f32_16x16x32_bf16 v[132:135], a[124:127], a[172:175], v[132:135]
v_mfma_f32_16x16x32_bf16 v[136:139], a[220:223], a[196:199], v[136:139]
v_mfma_f32_16x16x32_bf16 v[140:143], a[124:127], a[196:199], v[140:143]
v_mfma_f32_16x16x32_bf16 v[144:147], a[148:151], a[196:199], v[144:147]
s_waitcnt vmcnt(3)
v_mfma_f32_16x16x32_bf16 v[128:131], a[224:227], a[176:179], v[128:131]
v_mfma_f32_16x16x32_bf16 v[132:135], a[128:131], a[176:179], v[132:135]
v_mfma_f32_16x16x32_bf16 v[136:139], a[224:227], a[200:203], v[136:139]
v_mfma_f32_16x16x32_bf16 v[140:143], a[128:131], a[200:203], v[140:143]
v_mfma_f32_16x16x32_bf16 v[144:147], a[152:155], a[200:203], v[144:147]
s_waitcnt vmcnt(2)
v_mfma_f32_16x16x32_bf16 v[128:131], a[228:231], a[180:183], v[128:131]
v_mfma_f32_16x16x32_bf16 v[132:135], a[132:135], a[180:183], v[132:135]
v_mfma_f32_16x16x32_bf16 v[136:139], a[228:231], a[204:207], v[136:139]
v_mfma_f32_16x16x32_bf16 v[140:143], a[132:135], a[204:207], v[140:143]
v_mfma_f32_16x16x32_bf16 v[144:147], a[156:159], a[204:207], v[144:147]
s_waitcnt vmcnt(1)
v_mfma_f32_16x16x32_bf16 v[128:131], a[232:235], a[184:187], v[128:131]
v_mfma_f32_16x16x32_bf16 v[132:135], a[136:139], a[184:187], v[132:135]
v_mfma_f32_16x16x32_bf16 v[136:139], a[232:235], a[208:211], v[136:139]
v_mfma_f32_16x16x32_bf16 v[140:143], a[136:139], a[208:211], v[140:143]
v_mfma_f32_16x16x32_bf16 v[144:147], a[160:163], a[208:211], v[144:147]
s_waitcnt vmcnt(0)
v_mfma_f32_16x16x32_bf16 v[128:131], a[236:239], a[188:191], v[128:131]
v_mfma_f32_16x16x32_bf16 v[132:135], a[140:143], a[188:191], v[132:135]
v_mfma_f32_16x16x32_bf16 v[136:139], a[236:239], a[212:215], v[136:139]
v_mfma_f32_16x16x32_bf16 v[140:143], a[140:143], a[212:215], v[140:143]
v_mfma_f32_16x16x32_bf16 v[144:147], a[164:167], a[212:215], v[144:147]
s_nop 3
v_max3_f32 v28, v128, v129, v130
v_max3_f32 v28, v28, v131, v132
v_max3_f32 v28, v28, v133, v134
v_max_f32 v28, v28, v135
v_mov_b32 v29, v28
s_nop 1
v_permlane32_swap_b32 v28, v29
v_max_f32 v28, v28, v29
v_mov_b32 v29, v28
s_nop 1
v_permlane16_swap_b32 v28, v29
v_max_f32 v28, v28, v29
v_mul_f32 v28, s41, v28
v_fma_f32 v128, v128, s41, -v28
v_fma_f32 v129, v129, s41, -v28
v_fma_f32 v130, v130, s41, -v28
v_fma_f32 v131, v131, s41, -v28
v_fma_f32 v132, v132, s41, -v28
v_fma_f32 v133, v133, s41, -v28
v_fma_f32 v134, v134, s41, -v28
v_fma_f32 v135, v135, s41, -v28
v_exp_f32 v128, v128
v_exp_f32 v129, v129
v_exp_f32 v130, v130
v_exp_f32 v131, v131
v_exp_f32 v132, v132
v_exp_f32 v133, v133
v_exp_f32 v134, v134
v_exp_f32 v135, v135
v_max3_f32 v30, v136, v137, v138
v_max3_f32 v30, v30, v139, v140
v_max3_f32 v30, v30, v141, v142
v_max3_f32 v30, v30, v143, v144
v_max3_f32 v30, v30, v145, v146
v_max_f32 v30, v30, v147
v_mov_b32 v29, v30
s_nop 1
v_permlane32_swap_b32 v30, v29
v_max_f32 v30, v30, v29
v_mov_b32 v29, v30
s_nop 1
v_permlane16_swap_b32 v30, v29
v_max_f32 v30, v30, v29
v_mul_f32 v30, s41, v30
v_fma_f32 v136, v136, s41, -v30
v_fma_f32 v137, v137, s41, -v30
v_fma_f32 v138, v138, s41, -v30
v_fma_f32 v139, v139, s41, -v30
v_fma_f32 v140, v140, s41, -v30
v_fma_f32 v141, v141, s41, -v30
v_fma_f32 v142, v142, s41, -v30
v_fma_f32 v143, v143, s41, -v30
v_fma_f32 v144, v144, s41, -v30
v_fma_f32 v145, v145, s41, -v30
v_fma_f32 v146, v146, s41, -v30
v_fma_f32 v147, v147, s41, -v30
v_exp_f32 v136, v136
v_exp_f32 v137, v137
v_exp_f32 v138, v138
v_exp_f32 v139, v139
v_exp_f32 v140, v140
v_exp_f32 v141, v141
v_exp_f32 v142, v142
v_exp_f32 v143, v143
v_exp_f32 v144, v144
v_exp_f32 v145, v145
v_exp_f32 v146, v146
v_exp_f32 v147, v147
v_cvt_pk_bf16_f32 v72, v128, v129
v_cvt_pk_bf16_f32 v73, v130, v131
v_cvt_pk_bf16_f32 v74, v132, v133
v_cvt_pk_bf16_f32 v75, v134, v135
v_cvt_pk_bf16_f32 v76, v136, v137
v_cvt_pk_bf16_f32 v77, v138, v139
v_cvt_pk_bf16_f32 v78, v140, v141
v_cvt_pk_bf16_f32 v79, v142, v143
v_cvt_pk_bf16_f32 v80, v144, v145
v_cvt_pk_bf16_f32 v81, v146, v147
v_mfma_f32_16x16x16_bf16 v[148:151], v[36:37], v[72:73], 0
v_mfma_f32_16x16x16_bf16 v[152:155], v[36:37], v[76:77], 0
v_mfma_f32_16x16x16_bf16 v[148:151], v[36:37], v[74:75], v[148:151]
v_mfma_f32_16x16x32_bf16 v[152:155], v[36:39], v[78:81], v[152:155]
s_nop 6
v_rcp_f32 v82, v148
v_rcp_f32 v83, v152
s_and_b32 s34, s17, 1
s_mul_i32 s34, s34, 3072
v_add_u32 v28, s34, v1
ds_write_b128 v28, v[72:75] offset:16384
ds_write_b128 v28, v[76:79] offset:17408
ds_write_b128 v28, v[80:83] offset:18432
s_waitcnt lgkmcnt(0)
s_branch reca_b5101
reca_tw1102:
s_cmp_lt_u32 s17, 3
s_cbranch_scc1 reca_b5101
s_sub_u32 s36, s17, 3
s_and_b32 s37, s36, 7
s_lshl_b32 s34, s59, 3
s_add_u32 s34, s34, s37
s_mul_i32 s34, s34, 12288
s_add_u32 s23, s34, 40894464
s_lshl_b32 s35, s37, 5
s_add_u32 s35, s35, s59
s_mul_i32 s35, s35, 3072
s_add_u32 s61, s35, 47972352
s_mul_i32 s34, s36, 393216
s_mul_i32 s35, s59, 6144
s_add_u32 s34, s34, s35
s_add_u32 s60, s34, 57147392
s_add_u32 s34, s17, 1
s_and_b32 s34, s34, 1
s_mul_i32 s34, s34, 3072
v_add_u32 v28, s34, v1
ds_read_b128 v[72:75], v28 offset:16384
ds_read_b128 v[76:79], v28 offset:17408
ds_read_b128 v[80:83], v28 offset:18432
buffer_load_dwordx2 a[168:169], v93, s[4:7], s61 offen offset:0 sc1
buffer_load_dwordx4 a[120:123], v1, s[4:7], s23 offen offset:0 sc1
buffer_load_dwordx2 a[170:171], v93, s[4:7], s61 offen offset:256 sc1
buffer_load_dwordx4 a[124:127], v1, s[4:7], s23 offen offset:1024 sc1
buffer_load_dwordx2 a[172:173], v93, s[4:7], s61 offen offset:512 sc1
buffer_load_dwordx4 a[128:131], v1, s[4:7], s23 offen offset:2048 sc1
buffer_load_dwordx2 a[174:175], v93, s[4:7], s61 offen offset:768 sc1
buffer_load_dwordx4 a[132:135], v1, s[4:7], s23 offen offset:3072 sc1
buffer_load_dwordx2 a[176:177], v93, s[4:7], s61 offen offset:1024 sc1
buffer_load_dwordx4 a[136:139], v2, s[4:7], s23 offen offset:0 sc1
buffer_load_dwordx2 a[178:179], v93, s[4:7], s61 offen offset:1280 sc1
buffer_load_dwordx4 a[140:143], v2, s[4:7], s23 offen offset:1024 sc1
s_waitcnt lgkmcnt(0)
s_waitcnt vmcnt(8)
v_mfma_f32_16x16x16_bf16 v[156:159], a[168:169], v[72:73], 0
v_mfma_f32_16x16x16_bf16 v[160:163], a[168:169], v[76:77], 0
v_mfma_f32_16x16x16_bf16 v[156:159], a[120:121], v[74:75], v[156:159]
v_mfma_f32_16x16x32_bf16 v[160:163], a[120:123], v[78:81], v[160:163]
v_mfma_f32_16x16x16_bf16 v[164:167], a[170:171], v[72:73], 0
v_mfma_f32_16x16x16_bf16 v[168:171], a[170:171], v[76:77], 0
v_mfma_f32_16x16x16_bf16 v[164:167], a[124:125], v[74:75], v[164:167]
v_mfma_f32_16x16x32_bf16 v[168:171], a[124:127], v[78:81], v[168:171]
s_nop 2
v_mul_f32 v156, v156, v82
v_mul_f32 v157, v157, v82
v_mul_f32 v158, v158, v82
v_mul_f32 v159, v159, v82
v_cvt_pk_bf16_f32 v172, v156, v157
v_cvt_pk_bf16_f32 v173, v158, v159
v_mul_f32 v164, v164, v82
v_mul_f32 v165, v165, v82
v_mul_f32 v166, v166, v82
v_mul_f32 v167, v167, v82
v_cvt_pk_bf16_f32 v174, v164, v165
v_cvt_pk_bf16_f32 v175, v166, v167
buffer_store_dwordx4 v[172:175], v1, s[4:7], s60 offen offset:0 sc1
v_mul_f32 v160, v160, v83
v_mul_f32 v161, v161, v83
v_mul_f32 v162, v162, v83
v_mul_f32 v163, v163, v83
v_cvt_pk_bf16_f32 v176, v160, v161
v_cvt_pk_bf16_f32 v177, v162, v163
v_mul_f32 v168, v168, v83
v_mul_f32 v169, v169, v83
v_mul_f32 v170, v170, v83
v_mul_f32 v171, v171, v83
v_cvt_pk_bf16_f32 v178, v168, v169
v_cvt_pk_bf16_f32 v179, v170, v171
s_add_u32 s34, s60, 196608
buffer_store_dwordx4 v[176:179], v1, s[4:7], s34 offen offset:0 sc1
s_waitcnt vmcnt(6)
v_mfma_f32_16x16x16_bf16 v[156:159], a[172:173], v[72:73], 0
v_mfma_f32_16x16x16_bf16 v[160:163], a[172:173], v[76:77], 0
v_mfma_f32_16x16x16_bf16 v[156:159], a[128:129], v[74:75], v[156:159]
v_mfma_f32_16x16x32_bf16 v[160:163], a[128:131], v[78:81], v[160:163]
v_mfma_f32_16x16x16_bf16 v[164:167], a[174:175], v[72:73], 0
v_mfma_f32_16x16x16_bf16 v[168:171], a[174:175], v[76:77], 0
v_mfma_f32_16x16x16_bf16 v[164:167], a[132:133], v[74:75], v[164:167]
v_mfma_f32_16x16x32_bf16 v[168:171], a[132:135], v[78:81], v[168:171]
s_nop 2
v_mul_f32 v156, v156, v82
v_mul_f32 v157, v157, v82
v_mul_f32 v158, v158, v82
v_mul_f32 v159, v159, v82
v_cvt_pk_bf16_f32 v172, v156, v157
v_cvt_pk_bf16_f32 v173, v158, v159
v_mul_f32 v164, v164, v82
v_mul_f32 v165, v165, v82
v_mul_f32 v166, v166, v82
v_mul_f32 v167, v167, v82
v_cvt_pk_bf16_f32 v174, v164, v165
v_cvt_pk_bf16_f32 v175, v166, v167
buffer_store_dwordx4 v[172:175], v1, s[4:7], s60 offen offset:1024 sc1
v_mul_f32 v160, v160, v83
v_mul_f32 v161, v161, v83
v_mul_f32 v162, v162, v83
v_mul_f32 v163, v163, v83
v_cvt_pk_bf16_f32 v176, v160, v161
v_cvt_pk_bf16_f32 v177, v162, v163
v_mul_f32 v168, v168, v83
v_mul_f32 v169, v169, v83
v_mul_f32 v170, v170, v83
v_mul_f32 v171, v171, v83
v_cvt_pk_bf16_f32 v178, v168, v169
v_cvt_pk_bf16_f32 v179, v170, v171
s_add_u32 s34, s60, 196608
buffer_store_dwordx4 v[176:179], v1, s[4:7], s34 offen offset:1024 sc1
s_waitcnt vmcnt(4)
v_mfma_f32_16x16x16_bf16 v[156:159], a[176:177], v[72:73], 0
v_mfma_f32_16x16x16_bf16 v[160:163], a[176:177], v[76:77], 0
v_mfma_f32_16x16x16_bf16 v[156:159], a[136:137], v[74:75], v[156:159]
v_mfma_f32_16x16x32_bf16 v[160:163], a[136:139], v[78:81], v[160:163]
v_mfma_f32_16x16x16_bf16 v[164:167], a[178:179], v[72:73], 0
v_mfma_f32_16x16x16_bf16 v[168:171], a[178:179], v[76:77], 0
v_mfma_f32_16x16x16_bf16 v[164:167], a[140:141], v[74:75], v[164:167]
v_mfma_f32_16x16x32_bf16 v[168:171], a[140:143], v[78:81], v[168:171]
s_nop 2
v_mul_f32 v156, v156, v82
v_mul_f32 v157, v157, v82
v_mul_f32 v158, v158, v82
v_mul_f32 v159, v159, v82
v_cvt_pk_bf16_f32 v172, v156, v157
v_cvt_pk_bf16_f32 v173, v158, v159
v_mul_f32 v164, v164, v82
v_mul_f32 v165, v165, v82
v_mul_f32 v166, v166, v82
v_mul_f32 v167, v167, v82
v_cvt_pk_bf16_f32 v174, v164, v165
v_cvt_pk_bf16_f32 v175, v166, v167
buffer_store_dwordx4 v[172:175], v1, s[4:7], s60 offen offset:2048 sc1
v_mul_f32 v160, v160, v83
v_mul_f32 v161, v161, v83
v_mul_f32 v162, v162, v83
v_mul_f32 v163, v163, v83
v_cvt_pk_bf16_f32 v176, v160, v161
v_cvt_pk_bf16_f32 v177, v162, v163
v_mul_f32 v168, v168, v83
v_mul_f32 v169, v169, v83
v_mul_f32 v170, v170, v83
v_mul_f32 v171, v171, v83
v_cvt_pk_bf16_f32 v178, v168, v169
v_cvt_pk_bf16_f32 v179, v170, v171
s_add_u32 s34, s60, 196608
buffer_store_dwordx4 v[176:179], v1, s[4:7], s34 offen offset:2048 sc1
s_branch reca_b5101
reca_tw2103:
s_cmp_lt_u32 s17, 3
s_cbranch_scc1 reca_b5101
s_sub_u32 s36, s17, 3
s_and_b32 s37, s36, 7
s_lshl_b32 s34, s59, 3
s_add_u32 s34, s34, s37
s_mul_i32 s34, s34, 12288
s_add_u32 s23, s34, 40894464
s_lshl_b32 s35, s37, 5
s_add_u32 s35, s35, s59
s_mul_i32 s35, s35, 3072
s_add_u32 s61, s35, 47972352
s_mul_i32 s34, s36, 393216
s_mul_i32 s35, s59, 6144
s_add_u32 s34, s34, s35
s_add_u32 s60, s34, 57147392
s_add_u32 s34, s17, 1
s_and_b32 s34, s34, 1
s_mul_i32 s34, s34, 3072
v_add_u32 v28, s34, v1
ds_read_b128 v[72:75], v28 offset:16384
ds_read_b128 v[76:79], v28 offset:17408
ds_read_b128 v[80:83], v28 offset:18432
buffer_load_dwordx2 a[180:181], v93, s[4:7], s61 offen offset:1536 sc1
buffer_load_dwordx4 a[144:147], v2, s[4:7], s23 offen offset:2048 sc1
buffer_load_dwordx2 a[182:183], v93, s[4:7], s61 offen offset:1792 sc1
buffer_load_dwordx4 a[148:151], v2, s[4:7], s23 offen offset:3072 sc1
buffer_load_dwordx2 a[184:185], v93, s[4:7], s61 offen offset:2048 sc1
buffer_load_dwordx4 a[152:155], v3, s[4:7], s23 offen offset:0 sc1
buffer_load_dwordx2 a[186:187], v93, s[4:7], s61 offen offset:2304 sc1
buffer_load_dwordx4 a[156:159], v3, s[4:7], s23 offen offset:1024 sc1
buffer_load_dwordx2 a[188:189], v93, s[4:7], s61 offen offset:2560 sc1
buffer_load_dwordx4 a[160:163], v3, s[4:7], s23 offen offset:2048 sc1
buffer_load_dwordx2 a[190:191], v93, s[4:7], s61 offen offset:2816 sc1
buffer_load_dwordx4 a[164:167], v3, s[4:7], s23 offen offset:3072 sc1
s_waitcnt lgkmcnt(0)
s_waitcnt vmcnt(8)
v_mfma_f32_16x16x16_bf16 v[156:159], a[180:181], v[72:73], 0
v_mfma_f32_16x16x16_bf16 v[160:163], a[180:181], v[76:77], 0
v_mfma_f32_16x16x16_bf16 v[156:159], a[144:145], v[74:75], v[156:159]
v_mfma_f32_16x16x32_bf16 v[160:163], a[144:147], v[78:81], v[160:163]
v_mfma_f32_16x16x16_bf16 v[164:167], a[182:183], v[72:73], 0
v_mfma_f32_16x16x16_bf16 v[168:171], a[182:183], v[76:77], 0
v_mfma_f32_16x16x16_bf16 v[164:167], a[148:149], v[74:75], v[164:167]
v_mfma_f32_16x16x32_bf16 v[168:171], a[148:151], v[78:81], v[168:171]
s_nop 2
v_mul_f32 v156, v156, v82
v_mul_f32 v157, v157, v82
v_mul_f32 v158, v158, v82
v_mul_f32 v159, v159, v82
v_cvt_pk_bf16_f32 v172, v156, v157
v_cvt_pk_bf16_f32 v173, v158, v159
v_mul_f32 v164, v164, v82
v_mul_f32 v165, v165, v82
v_mul_f32 v166, v166, v82
v_mul_f32 v167, v167, v82
v_cvt_pk_bf16_f32 v174, v164, v165
v_cvt_pk_bf16_f32 v175, v166, v167
buffer_store_dwordx4 v[172:175], v1, s[4:7], s60 offen offset:3072 sc1
v_mul_f32 v160, v160, v83
v_mul_f32 v161, v161, v83
v_mul_f32 v162, v162, v83
v_mul_f32 v163, v163, v83
v_cvt_pk_bf16_f32 v176, v160, v161
v_cvt_pk_bf16_f32 v177, v162, v163
v_mul_f32 v168, v168, v83
v_mul_f32 v169, v169, v83
v_mul_f32 v170, v170, v83
v_mul_f32 v171, v171, v83
v_cvt_pk_bf16_f32 v178, v168, v169
v_cvt_pk_bf16_f32 v179, v170, v171
s_add_u32 s34, s60, 196608
buffer_store_dwordx4 v[176:179], v1, s[4:7], s34 offen offset:3072 sc1
s_waitcnt vmcnt(6)
v_mfma_f32_16x16x16_bf16 v[156:159], a[184:185], v[72:73], 0
v_mfma_f32_16x16x16_bf16 v[160:163], a[184:185], v[76:77], 0
v_mfma_f32_16x16x16_bf16 v[156:159], a[152:153], v[74:75], v[156:159]
v_mfma_f32_16x16x32_bf16 v[160:163], a[152:155], v[78:81], v[160:163]
v_mfma_f32_16x16x16_bf16 v[164:167], a[186:187], v[72:73], 0
v_mfma_f32_16x16x16_bf16 v[168:171], a[186:187], v[76:77], 0
v_mfma_f32_16x16x16_bf16 v[164:167], a[156:157], v[74:75], v[164:167]
v_mfma_f32_16x16x32_bf16 v[168:171], a[156:159], v[78:81], v[168:171]
s_nop 2
v_mul_f32 v156, v156, v82
v_mul_f32 v157, v157, v82
v_mul_f32 v158, v158, v82
v_mul_f32 v159, v159, v82
v_cvt_pk_bf16_f32 v172, v156, v157
v_cvt_pk_bf16_f32 v173, v158, v159
v_mul_f32 v164, v164, v82
v_mul_f32 v165, v165, v82
v_mul_f32 v166, v166, v82
v_mul_f32 v167, v167, v82
v_cvt_pk_bf16_f32 v174, v164, v165
v_cvt_pk_bf16_f32 v175, v166, v167
buffer_store_dwordx4 v[172:175], v2, s[4:7], s60 offen offset:0 sc1
v_mul_f32 v160, v160, v83
v_mul_f32 v161, v161, v83
v_mul_f32 v162, v162, v83
v_mul_f32 v163, v163, v83
v_cvt_pk_bf16_f32 v176, v160, v161
v_cvt_pk_bf16_f32 v177, v162, v163
v_mul_f32 v168, v168, v83
v_mul_f32 v169, v169, v83
v_mul_f32 v170, v170, v83
v_mul_f32 v171, v171, v83
v_cvt_pk_bf16_f32 v178, v168, v169
v_cvt_pk_bf16_f32 v179, v170, v171
s_add_u32 s34, s60, 196608
buffer_store_dwordx4 v[176:179], v2, s[4:7], s34 offen offset:0 sc1
s_waitcnt vmcnt(4)
v_mfma_f32_16x16x16_bf16 v[156:159], a[188:189], v[72:73], 0
v_mfma_f32_16x16x16_bf16 v[160:163], a[188:189], v[76:77], 0
v_mfma_f32_16x16x16_bf16 v[156:159], a[160:161], v[74:75], v[156:159]
v_mfma_f32_16x16x32_bf16 v[160:163], a[160:163], v[78:81], v[160:163]
v_mfma_f32_16x16x16_bf16 v[164:167], a[190:191], v[72:73], 0
v_mfma_f32_16x16x16_bf16 v[168:171], a[190:191], v[76:77], 0
v_mfma_f32_16x16x16_bf16 v[164:167], a[164:165], v[74:75], v[164:167]
v_mfma_f32_16x16x32_bf16 v[168:171], a[164:167], v[78:81], v[168:171]
s_nop 2
v_mul_f32 v156, v156, v82
v_mul_f32 v157, v157, v82
v_mul_f32 v158, v158, v82
v_mul_f32 v159, v159, v82
v_cvt_pk_bf16_f32 v172, v156, v157
v_cvt_pk_bf16_f32 v173, v158, v159
v_mul_f32 v164, v164, v82
v_mul_f32 v165, v165, v82
v_mul_f32 v166, v166, v82
v_mul_f32 v167, v167, v82
v_cvt_pk_bf16_f32 v174, v164, v165
v_cvt_pk_bf16_f32 v175, v166, v167
buffer_store_dwordx4 v[172:175], v2, s[4:7], s60 offen offset:1024 sc1
v_mul_f32 v160, v160, v83
v_mul_f32 v161, v161, v83
v_mul_f32 v162, v162, v83
v_mul_f32 v163, v163, v83
v_cvt_pk_bf16_f32 v176, v160, v161
v_cvt_pk_bf16_f32 v177, v162, v163
v_mul_f32 v168, v168, v83
v_mul_f32 v169, v169, v83
v_mul_f32 v170, v170, v83
v_mul_f32 v171, v171, v83
v_cvt_pk_bf16_f32 v178, v168, v169
v_cvt_pk_bf16_f32 v179, v170, v171
s_add_u32 s34, s60, 196608
buffer_store_dwordx4 v[176:179], v2, s[4:7], s34 offen offset:1024 sc1
s_branch reca_b5101
s_cmp_lg_u32 s12, 2
s_cbranch_scc1 reca_b399
buffer_store_dwordx2 v[52:53], v9, s[4:7], s30 offen
buffer_store_dwordx2 v[32:33], v16, s[4:7], s26 offen
s_cmp_lg_u32 s14, 0
s_cbranch_scc1 reca_b399
v_mov_b32 v28, s17
s_lshl_b32 s34, s13, 7
s_add_u32 s34, s34, 1507328
buffer_store_dword v28, v19, s[4:7], s34 offen
s_branch reca_b399
reca_last98:
s_cmp_lg_u32 s12, 2
s_cbranch_scc1 reca_exit1
buffer_store_dwordx2 v[52:53], v9, s[4:7], s30 offen
s_branch reca_exit1
reca_swave96:
s_cmp_lg_u32 s17, 63
s_cbranch_scc1 reca_vmst104
s_barrier
ds_read_b128 v[56:59], v1 offset:10240
ds_read_b128 v[60:63], v1 offset:11264
ds_read_b128 v[64:67], v1 offset:12288
s_waitcnt lgkmcnt(0)
v_add_f32 v56, v56, v64
v_add_f32 v60, v60, v48
v_add_f32 v57, v57, v65
v_add_f32 v61, v61, v49
v_add_f32 v58, v58, v66
v_add_f32 v62, v62, v50
v_add_f32 v59, v59, v67
v_add_f32 v63, v63, v51
v_cvt_pk_bf16_f32 v68, v56, v57
v_cvt_pk_bf16_f32 v69, v58, v59
v_cvt_pk_bf16_f32 v70, v60, v61
v_cvt_pk_bf16_f32 v71, v62, v63
buffer_store_dwordx2 v[52:53], v9, s[4:7], s30 offen
buffer_store_dwordx2 v[68:69], v10, s[4:7], s31 offen
buffer_store_dwordx2 v[70:71], v10, s[4:7], s31 offen offset:256
s_branch reca_exit1
reca_vmst104:
s_sleep 1
buffer_load_dwordx4 v[208:211], v1, s[4:7], s21 offen offset:0 sc1
buffer_load_dwordx4 v[212:215], v1, s[4:7], s21 offen offset:1024 sc1
buffer_load_dwordx4 v[216:219], v1, s[4:7], s21 offen offset:2048 sc1
buffer_load_dwordx4 v[220:223], v1, s[4:7], s21 offen offset:3072 sc1
buffer_load_dwordx4 v[224:227], v2, s[4:7], s21 offen offset:0 sc1
buffer_load_dwordx4 v[228:231], v2, s[4:7], s21 offen offset:1024 sc1
s_waitcnt vmcnt(5)
v_max_u32 v29, v208, v210
v_cmp_eq_u32 vcc, -1, v29
s_cbranch_vccnz reca_retry105
reca_resume106:
s_waitcnt vmcnt(4)
v_max_u32 v29, v212, v214
v_cmp_eq_u32 vcc, -1, v29
v_mfma_f32_16x16x32_bf16 v[76:79], a[120:123], v[208:211], 0
v_mfma_f32_16x16x32_bf16 v[80:83], a[144:147], v[208:211], 0
v_mfma_f32_16x16x32_bf16 v[72:75], v[208:211], v[208:211], v[40:43]
s_cbranch_vccnz reca_retry107
reca_resume108:
s_waitcnt vmcnt(3)
v_max_u32 v29, v216, v218
v_cmp_eq_u32 vcc, -1, v29
v_mfma_f32_16x16x32_bf16 v[76:79], a[124:127], v[212:215], v[76:79]
v_mfma_f32_16x16x32_bf16 v[80:83], a[148:151], v[212:215], v[80:83]
v_mfma_f32_16x16x32_bf16 v[72:75], v[212:215], v[212:215], v[72:75]
s_cbranch_vccnz reca_retry109
reca_resume110:
s_waitcnt vmcnt(2)
v_max_u32 v29, v220, v222
v_cmp_eq_u32 vcc, -1, v29
v_mfma_f32_16x16x32_bf16 v[76:79], a[128:131], v[216:219], v[76:79]
v_mfma_f32_16x16x32_bf16 v[80:83], a[152:155], v[216:219], v[80:83]
v_mfma_f32_16x16x32_bf16 v[72:75], v[216:219], v[216:219], v[72:75]
s_cbranch_vccnz reca_retry111
reca_resume112:
s_waitcnt vmcnt(1)
v_max_u32 v29, v224, v226
v_cmp_eq_u32 vcc, -1, v29
v_mfma_f32_16x16x32_bf16 v[76:79], a[132:135], v[220:223], v[76:79]
v_mfma_f32_16x16x32_bf16 v[80:83], a[156:159], v[220:223], v[80:83]
v_mfma_f32_16x16x32_bf16 v[72:75], v[220:223], v[220:223], v[72:75]
s_cbranch_vccnz reca_retry113
reca_resume114:
s_waitcnt vmcnt(0)
v_max_u32 v29, v228, v230
v_cmp_eq_u32 vcc, -1, v29
v_mfma_f32_16x16x32_bf16 v[76:79], a[136:139], v[224:227], v[76:79]
v_mfma_f32_16x16x32_bf16 v[80:83], a[160:163], v[224:227], v[80:83]
v_mfma_f32_16x16x32_bf16 v[72:75], v[224:227], v[224:227], v[72:75]
s_cbranch_vccnz reca_retry115
reca_resume116:
v_mfma_f32_16x16x32_bf16 v[76:79], a[140:143], v[228:231], v[76:79]
v_mfma_f32_16x16x32_bf16 v[80:83], a[164:167], v[228:231], v[80:83]
v_mfma_f32_16x16x32_bf16 v[72:75], v[228:231], v[228:231], v[72:75]
s_barrier
ds_read_b128 v[56:59], v1 offset:10240
ds_read_b128 v[60:63], v1 offset:11264
ds_read_b128 v[64:67], v1 offset:12288
s_nop 1
v_max3_f32 v28, v76, v77, v78
v_max3_f32 v29, v80, v81, v82
v_max3_f32 v28, v28, v79, v83
v_max3_f32 v29, v29, v72, v73
v_max3_f32 v28, v28, v74, v75
v_max_f32 v28, v28, v29
v_mov_b32 v29, v28
s_nop 1
v_permlane32_swap_b32 v28, v29
v_max_f32 v28, v28, v29
v_mov_b32 v29, v28
s_nop 1
v_permlane16_swap_b32 v28, v29
v_max_f32 v28, v28, v29
v_mul_f32 v28, s41, v28
v_fma_f32 v76, v76, s41, -v28
v_fma_f32 v77, v77, s41, -v28
v_fma_f32 v78, v78, s41, -v28
v_fma_f32 v79, v79, s41, -v28
v_fma_f32 v80, v80, s41, -v28
v_fma_f32 v81, v81, s41, -v28
v_fma_f32 v82, v82, s41, -v28
v_fma_f32 v83, v83, s41, -v28
v_fma_f32 v72, v72, s41, -v28
v_fma_f32 v73, v73, s41, -v28
v_fma_f32 v74, v74, s41, -v28
v_fma_f32 v75, v75, s41, -v28
v_exp_f32 v76, v76
v_exp_f32 v77, v77
v_exp_f32 v78, v78
v_exp_f32 v79, v79
v_exp_f32 v80, v80
v_exp_f32 v81, v81
v_exp_f32 v82, v82
v_exp_f32 v83, v83
v_cvt_pk_bf16_f32 v84, v76, v77
v_cvt_pk_bf16_f32 v85, v78, v79
v_cvt_pk_bf16_f32 v86, v80, v81
v_cvt_pk_bf16_f32 v87, v82, v83
v_exp_f32 v72, v72
v_exp_f32 v73, v73
v_mfma_f32_16x16x32_bf16 v[100:103], v[36:39], v[84:87], 0
v_exp_f32 v74, v74
v_exp_f32 v75, v75
v_mfma_f32_16x16x32_bf16 v[92:95], a[168:171], v[84:87], 0
v_cvt_pk_bf16_f32 v88, v72, v73
v_cvt_pk_bf16_f32 v89, v74, v75
v_mfma_f32_16x16x32_bf16 v[96:99], a[172:175], v[84:87], 0
s_waitcnt lgkmcnt(0)
v_mfma_f32_16x16x16_bf16 v[100:103], v[36:37], v[88:89], v[100:103]
v_add_f32 v56, v56, v64
v_add_f32 v60, v60, v48
v_add_f32 v57, v57, v65
v_add_f32 v61, v61, v49
v_add_f32 v58, v58, v66
v_add_f32 v62, v62, v50
v_add_f32 v59, v59, v67
v_add_f32 v63, v63, v51
v_cvt_pk_bf16_f32 v68, v56, v57
v_cvt_pk_bf16_f32 v69, v58, v59
v_cvt_pk_bf16_f32 v70, v60, v61
v_cvt_pk_bf16_f32 v71, v62, v63
v_mfma_f32_16x16x16_bf16 v[92:95], v[68:69], v[88:89], v[92:95]
v_rcp_f32 v28, v100
v_mfma_f32_16x16x16_bf16 v[96:99], v[70:71], v[88:89], v[96:99]
v_mov_b32 v29, v28
s_nop 4
v_pk_mul_f32 v[92:93], v[92:93], v[28:29]
v_pk_mul_f32 v[94:95], v[94:95], v[28:29]
v_pk_mul_f32 v[96:97], v[96:97], v[28:29]
v_pk_mul_f32 v[98:99], v[98:99], v[28:29]
v_cvt_pk_bf16_f32 v104, v92, v93
v_cvt_pk_bf16_f32 v105, v94, v95
v_cvt_pk_bf16_f32 v106, v96, v97
v_cvt_pk_bf16_f32 v107, v98, v99
buffer_store_dwordx4 v[104:107], v11, s[4:7], s22 offen
s_barrier
s_add_u32 s34, s17, 2
s_and_b32 s34, s34, 3
s_mul_i32 s26, s34, 10240
s_add_u32 s26, s26, s38
s_mul_i32 s27, s34, 6144
s_add_u32 s27, s27, s39
s_mul_i32 s28, s34, 12288
s_add_u32 s28, s28, s40
s_mul_i32 s29, s34, 393216
s_add_u32 s29, s29, s56
buffer_store_dwordx2 v[32:33], v8, s[4:7], s27 offen
buffer_store_dwordx4 v[32:35], v11, s[4:7], s28 offen
s_add_u32 s36, s17, 1
s_cmp_ge_u32 s36, 63
s_cbranch_scc1 reca_nopf117
s_add_u32 s37, s36, 1
reca_pf118:
buffer_load_dword v28, v233, s[4:7], 0 offen sc1
s_waitcnt vmcnt(0)
v_cmp_gt_i32 vcc, s37, v28
s_cbranch_vccz reca_pfok119
s_sleep 1
s_sub_u32 s18, s18, 1
s_cbranch_scc0 reca_pf118
s_mov_b32 s18, 0
reca_pfok119:
s_lshl_b32 s34, s15, 3
s_and_b32 s35, s36, 7
s_add_u32 s34, s34, s35
s_mul_i32 s34, s34, 12288
s_add_u32 s32, s34, 37748736
s_lshl_b32 s35, s16, 11
s_add_u32 s34, s34, s35
s_add_u32 s33, s34, 40894464
buffer_load_dwordx4 a[120:123], v1, s[4:7], s32 offen offset:0 sc1
buffer_load_dwordx4 a[124:127], v1, s[4:7], s32 offen offset:1024 sc1
buffer_load_dwordx4 a[128:131], v1, s[4:7], s32 offen offset:2048 sc1
buffer_load_dwordx4 a[132:135], v1, s[4:7], s32 offen offset:3072 sc1
buffer_load_dwordx4 a[136:139], v2, s[4:7], s32 offen offset:0 sc1
buffer_load_dwordx4 a[140:143], v2, s[4:7], s32 offen offset:1024 sc1
buffer_load_dwordx4 a[144:147], v2, s[4:7], s32 offen offset:2048 sc1
buffer_load_dwordx4 a[148:151], v2, s[4:7], s32 offen offset:3072 sc1
buffer_load_dwordx4 a[152:155], v3, s[4:7], s32 offen offset:0 sc1
buffer_load_dwordx4 a[156:159], v3, s[4:7], s32 offen offset:1024 sc1
buffer_load_dwordx4 a[160:163], v3, s[4:7], s32 offen offset:2048 sc1
buffer_load_dwordx4 a[164:167], v3, s[4:7], s32 offen offset:3072 sc1
buffer_load_dwordx4 a[168:171], v1, s[4:7], s33 offen offset:0 sc1
buffer_load_dwordx4 a[172:175], v1, s[4:7], s33 offen offset:1024 sc1
reca_nopf117:
buffer_store_dwordx2 v[52:53], v9, s[4:7], s30 offen
buffer_store_dwordx2 v[68:69], v10, s[4:7], s31 offen
buffer_store_dwordx2 v[70:71], v10, s[4:7], s31 offen offset:256
reca_b5101:
s_barrier
s_add_u32 s17, s17, 1
s_branch reca_step87
reca_b399:
s_endpgm
reca_retry90:
s_sub_u32 s18, s18, 1
s_cbranch_scc1 reca_retry90_to
buffer_load_dwordx4 v[128:131], v4, s[4:7], s20 offen sc1
buffer_load_dwordx4 v[132:135], v4, s[4:7], s20 offen offset:1024 sc1
buffer_load_dwordx4 v[136:139], v5, s[4:7], s20 offen sc1
s_waitcnt vmcnt(2)
v_max_u32 v29, v128, v130
v_cmp_eq_u32 vcc, -1, v29
s_cbranch_vccnz reca_retry90
s_branch reca_resume91
reca_retry90_to:
s_mov_b32 s18, 0
s_waitcnt vmcnt(0)
s_branch reca_resume91
reca_retry92:
s_sub_u32 s18, s18, 1
s_cbranch_scc1 reca_retry92_to
buffer_load_dwordx4 v[132:135], v4, s[4:7], s20 offen offset:1024 sc1
buffer_load_dwordx4 v[136:139], v5, s[4:7], s20 offen sc1
s_waitcnt vmcnt(1)
v_max_u32 v29, v132, v134
v_cmp_eq_u32 vcc, -1, v29
s_cbranch_vccnz reca_retry92
s_branch reca_resume93
reca_retry92_to:
s_mov_b32 s18, 0
s_waitcnt vmcnt(0)
s_branch reca_resume93
reca_retry94:
s_sub_u32 s18, s18, 1
s_cbranch_scc1 reca_retry94_to
buffer_load_dwordx4 v[136:139], v5, s[4:7], s20 offen sc1
s_waitcnt vmcnt(0)
v_max_u32 v29, v136, v138
v_cmp_eq_u32 vcc, -1, v29
s_cbranch_vccnz reca_retry94
s_branch reca_resume95
reca_retry94_to:
s_mov_b32 s18, 0
s_waitcnt vmcnt(0)
s_branch reca_resume95
reca_retry105:
s_sub_u32 s18, s18, 1
s_cbranch_scc1 reca_retry105_to
buffer_load_dwordx4 v[208:211], v1, s[4:7], s21 offen offset:0 sc1
buffer_load_dwordx4 v[212:215], v1, s[4:7], s21 offen offset:1024 sc1
buffer_load_dwordx4 v[216:219], v1, s[4:7], s21 offen offset:2048 sc1
buffer_load_dwordx4 v[220:223], v1, s[4:7], s21 offen offset:3072 sc1
buffer_load_dwordx4 v[224:227], v2, s[4:7], s21 offen offset:0 sc1
buffer_load_dwordx4 v[228:231], v2, s[4:7], s21 offen offset:1024 sc1
s_waitcnt vmcnt(5)
v_max_u32 v29, v208, v210
v_cmp_eq_u32 vcc, -1, v29
s_cbranch_vccnz reca_retry105
s_branch reca_resume106
reca_retry105_to:
s_mov_b32 s18, 0
s_waitcnt vmcnt(0)
s_branch reca_resume106
reca_retry107:
s_sub_u32 s18, s18, 1
s_cbranch_scc1 reca_retry107_to
buffer_load_dwordx4 v[212:215], v1, s[4:7], s21 offen offset:1024 sc1
buffer_load_dwordx4 v[216:219], v1, s[4:7], s21 offen offset:2048 sc1
buffer_load_dwordx4 v[220:223], v1, s[4:7], s21 offen offset:3072 sc1
buffer_load_dwordx4 v[224:227], v2, s[4:7], s21 offen offset:0 sc1
buffer_load_dwordx4 v[228:231], v2, s[4:7], s21 offen offset:1024 sc1
s_waitcnt vmcnt(4)
v_max_u32 v29, v212, v214
v_cmp_eq_u32 vcc, -1, v29
s_cbranch_vccnz reca_retry107
s_branch reca_resume108
reca_retry107_to:
s_mov_b32 s18, 0
s_waitcnt vmcnt(0)
s_branch reca_resume108
reca_retry109:
s_sub_u32 s18, s18, 1
s_cbranch_scc1 reca_retry109_to
buffer_load_dwordx4 v[216:219], v1, s[4:7], s21 offen offset:2048 sc1
buffer_load_dwordx4 v[220:223], v1, s[4:7], s21 offen offset:3072 sc1
buffer_load_dwordx4 v[224:227], v2, s[4:7], s21 offen offset:0 sc1
buffer_load_dwordx4 v[228:231], v2, s[4:7], s21 offen offset:1024 sc1
s_waitcnt vmcnt(3)
v_max_u32 v29, v216, v218
v_cmp_eq_u32 vcc, -1, v29
s_cbranch_vccnz reca_retry109
s_branch reca_resume110
reca_retry109_to:
s_mov_b32 s18, 0
s_waitcnt vmcnt(0)
s_branch reca_resume110
reca_retry111:
s_sub_u32 s18, s18, 1
s_cbranch_scc1 reca_retry111_to
buffer_load_dwordx4 v[220:223], v1, s[4:7], s21 offen offset:3072 sc1
buffer_load_dwordx4 v[224:227], v2, s[4:7], s21 offen offset:0 sc1
buffer_load_dwordx4 v[228:231], v2, s[4:7], s21 offen offset:1024 sc1
s_waitcnt vmcnt(2)
v_max_u32 v29, v220, v222
v_cmp_eq_u32 vcc, -1, v29
s_cbranch_vccnz reca_retry111
s_branch reca_resume112
reca_retry111_to:
s_mov_b32 s18, 0
s_waitcnt vmcnt(0)
s_branch reca_resume112
reca_retry113:
s_sub_u32 s18, s18, 1
s_cbranch_scc1 reca_retry113_to
buffer_load_dwordx4 v[224:227], v2, s[4:7], s21 offen offset:0 sc1
buffer_load_dwordx4 v[228:231], v2, s[4:7], s21 offen offset:1024 sc1
s_waitcnt vmcnt(1)
v_max_u32 v29, v224, v226
v_cmp_eq_u32 vcc, -1, v29
s_cbranch_vccnz reca_retry113
s_branch reca_resume114
reca_retry113_to:
s_mov_b32 s18, 0
s_waitcnt vmcnt(0)
s_branch reca_resume114
reca_retry115:
s_sub_u32 s18, s18, 1
s_cbranch_scc1 reca_retry115_to
buffer_load_dwordx4 v[228:231], v2, s[4:7], s21 offen offset:1024 sc1
s_waitcnt vmcnt(0)
v_max_u32 v29, v228, v230
v_cmp_eq_u32 vcc, -1, v29
s_cbranch_vccnz reca_retry115
s_branch reca_resume116
reca_retry115_to:
s_mov_b32 s18, 0
s_waitcnt vmcnt(0)
s_branch reca_resume116
reca_slow11:
s_cmp_ge_u32 s14, 20
s_cbranch_scc1 reca_twins13
s_branch reca_gotmem121
reca_step120:
s_and_b32 s34, s17, 3
s_mul_i32 s20, s34, 10240
s_add_u32 s20, s20, s38
s_sleep 2
buffer_load_dwordx4 v[128:131], v4, s[4:7], s20 offen sc1
buffer_load_dwordx4 v[132:135], v4, s[4:7], s20 offen offset:1024 sc1
buffer_load_dwordx4 v[136:139], v5, s[4:7], s20 offen sc1
s_waitcnt vmcnt(2)
v_max_u32 v29, v128, v130
v_cmp_eq_u32 vcc, -1, v29
s_cbranch_vccnz reca_retry123
reca_resume124:
s_waitcnt vmcnt(1)
v_max_u32 v29, v132, v134
v_cmp_eq_u32 vcc, -1, v29
ds_write_b128 v4, v[128:131]
s_cbranch_vccnz reca_retry125
reca_resume126:
s_waitcnt vmcnt(0)
v_max_u32 v29, v136, v138
v_cmp_eq_u32 vcc, -1, v29
ds_write_b128 v4, v[132:135] offset:1024
s_cbranch_vccnz reca_retry127
reca_resume128:
ds_write_b128 v5, v[136:139]
s_branch reca_gotmem2122
reca_gotmem121:
ds_write_b128 v4, v[128:131]
ds_write_b128 v4, v[132:135] offset:1024
ds_write_b128 v5, v[136:139]
reca_gotmem2122:
s_and_b32 s34, s17, 3
s_mul_i32 s21, s34, 6144
s_add_u32 s21, s21, s39
s_mul_i32 s22, s34, 12288
s_add_u32 s22, s22, s40
s_mul_i32 s25, s34, 393216
s_add_u32 s25, s25, s56
s_add_u32 s35, s17, 1
s_and_b32 s35, s35, 3
s_mul_i32 s24, s35, 10240
s_add_u32 s24, s24, s38
s_waitcnt lgkmcnt(0)
s_barrier
ds_read_b128 v[128:131], v236 offset:0
ds_read_b128 v[132:135], v236 offset:1024
ds_read_b128 v[136:139], v236 offset:2048
ds_read_b128 v[140:143], v236 offset:3072
ds_read_b128 v[144:147], v236 offset:4096
ds_read_b128 v[148:151], v237 offset:0
ds_read_b128 v[152:155], v237 offset:1024
ds_read_b128 v[156:159], v237 offset:2048
ds_read_b128 v[160:163], v237 offset:3072
ds_read_b128 v[164:167], v237 offset:4096
s_waitcnt lgkmcnt(9)
v_mfma_f32_16x16x32_bf16 v[44:47], a[0:3], v[128:131], 0
ds_read_b128 v[168:171], v6 offset:0
v_mfma_f32_16x16x32_bf16 v[240:243], a[4:7], v[128:131], 0
s_waitcnt lgkmcnt(9)
v_mfma_f32_16x16x32_bf16 v[44:47], a[8:11], v[132:135], v[44:47]
ds_read_b128 v[172:175], v6 offset:512
v_mfma_f32_16x16x32_bf16 v[240:243], a[12:15], v[132:135], v[240:243]
s_waitcnt lgkmcnt(9)
v_mfma_f32_16x16x32_bf16 v[44:47], a[16:19], v[136:139], v[44:47]
ds_read_b128 v[176:179], v6 offset:1024
v_mfma_f32_16x16x32_bf16 v[240:243], a[20:23], v[136:139], v[240:243]
s_waitcnt lgkmcnt(9)
v_mfma_f32_16x16x32_bf16 v[44:47], a[24:27], v[140:143], v[44:47]
ds_read_b128 v[180:183], v6 offset:1536
v_mfma_f32_16x16x32_bf16 v[240:243], a[28:31], v[140:143], v[240:243]
s_waitcnt lgkmcnt(9)
v_mfma_f32_16x16x32_bf16 v[44:47], a[32:35], v[144:147], v[44:47]
ds_read_b128 v[184:187], v6 offset:2048
v_mfma_f32_16x16x32_bf16 v[240:243], a[36:39], v[144:147], v[240:243]
s_waitcnt lgkmcnt(9)
v_mfma_f32_16x16x32_bf16 v[44:47], a[40:43], v[148:151], v[44:47]
ds_read_b128 v[188:191], v6 offset:2560
v_mfma_f32_16x16x32_bf16 v[240:243], a[44:47], v[148:151], v[240:243]
s_waitcnt lgkmcnt(9)
v_mfma_f32_16x16x32_bf16 v[44:47], a[48:51], v[152:155], v[44:47]
ds_read_b128 v[192:195], v6 offset:3072
v_mfma_f32_16x16x32_bf16 v[240:243], a[52:55], v[152:155], v[240:243]
s_waitcnt lgkmcnt(9)
v_mfma_f32_16x16x32_bf16 v[44:47], a[56:59], v[156:159], v[44:47]
ds_read_b128 v[196:199], v6 offset:3584
v_mfma_f32_16x16x32_bf16 v[240:243], a[60:63], v[156:159], v[240:243]
s_waitcnt lgkmcnt(9)
v_mfma_f32_16x16x32_bf16 v[44:47], a[64:67], v[160:163], v[44:47]
ds_read_b128 v[200:203], v6 offset:4096
v_mfma_f32_16x16x32_bf16 v[240:243], a[68:71], v[160:163], v[240:243]
s_waitcnt lgkmcnt(9)
v_mfma_f32_16x16x32_bf16 v[44:47], a[72:75], v[164:167], v[44:47]
ds_read_b128 v[204:207], v6 offset:4608
v_mfma_f32_16x16x32_bf16 v[240:243], a[76:79], v[164:167], v[240:243]
s_waitcnt lgkmcnt(9)
v_mfma_f32_16x16x32_bf16 v[48:51], v[168:171], a[80:83], 0
s_and_b32 s34, s17, 7
s_lshl_b32 s34, s34, 5
s_add_u32 s34, s34, s15
s_mul_i32 s34, s34, 3072
s_lshl_b32 s35, s16, 9
s_add_u32 s34, s34, s35
s_add_u32 s30, s34, 47185920
s_add_u32 s31, s34, 47972352
v_add_f32_dpp v44, v240, v44 row_ror:8 row_mask:0xf bank_mask:0xf
v_add_f32_dpp v45, v241, v45 row_ror:8 row_mask:0xf bank_mask:0xf
v_add_f32_dpp v46, v242, v46 row_ror:8 row_mask:0xf bank_mask:0xf
v_add_f32_dpp v47, v243, v47 row_ror:8 row_mask:0xf bank_mask:0xf
v_cvt_pk_bf16_f32 v52, v44, v45
v_cvt_pk_bf16_f32 v53, v46, v47
buffer_store_dwordx2 v[52:53], v8, s[4:7], s21 offen sc1
s_waitcnt lgkmcnt(8)
v_mfma_f32_16x16x32_bf16 v[48:51], v[172:175], a[84:87], v[48:51]
s_waitcnt lgkmcnt(7)
v_mfma_f32_16x16x32_bf16 v[48:51], v[176:179], a[88:91], v[48:51]
s_waitcnt lgkmcnt(6)
v_mfma_f32_16x16x32_bf16 v[48:51], v[180:183], a[92:95], v[48:51]
s_waitcnt lgkmcnt(5)
v_mfma_f32_16x16x32_bf16 v[48:51], v[184:187], a[96:99], v[48:51]
s_waitcnt lgkmcnt(4)
v_mfma_f32_16x16x32_bf16 v[48:51], v[188:191], a[100:103], v[48:51]
s_waitcnt lgkmcnt(3)
v_mfma_f32_16x16x32_bf16 v[48:51], v[192:195], a[104:107], v[48:51]
s_waitcnt lgkmcnt(2)
v_mfma_f32_16x16x32_bf16 v[48:51], v[196:199], a[108:111], v[48:51]
s_waitcnt lgkmcnt(1)
v_mfma_f32_16x16x32_bf16 v[48:51], v[200:203], a[112:115], v[48:51]
s_waitcnt lgkmcnt(0)
v_mfma_f32_16x16x32_bf16 v[48:51], v[204:207], a[116:119], v[48:51]
s_cmp_eq_u32 s12, 3
s_cbranch_scc1 reca_swave129
s_nop 5
ds_write_b128 v17, v[48:51]
s_add_u32 s34, s17, 2
s_and_b32 s34, s34, 3
s_mul_i32 s26, s34, 10240
s_add_u32 s26, s26, s38
s_mul_i32 s27, s34, 6144
s_add_u32 s27, s27, s39
s_mul_i32 s28, s34, 12288
s_add_u32 s28, s28, s40
s_mul_i32 s29, s34, 393216
s_add_u32 s29, s29, s56
s_waitcnt lgkmcnt(0)
s_barrier
s_cmp_eq_u32 s17, 63
s_cbranch_scc1 reca_last131
buffer_store_dwordx2 v[32:33], v8, s[4:7], s27 offen sc1
s_cmp_lg_u32 s12, 2
s_cbranch_scc1 reca_b3132
buffer_store_dwordx2 v[52:53], v9, s[4:7], s30 offen sc1
buffer_store_dwordx2 v[32:33], v16, s[4:7], s26 offen sc1
s_cmp_lg_u32 s14, 0
s_cbranch_scc1 reca_b3132
v_mov_b32 v28, s17
s_lshl_b32 s34, s13, 7
s_add_u32 s34, s34, 1507328
buffer_store_dword v28, v19, s[4:7], s34 offen sc1
s_branch reca_b3132
reca_last131:
s_cmp_lg_u32 s12, 2
s_cbranch_scc1 reca_exit1
buffer_store_dwordx2 v[52:53], v9, s[4:7], s30 offen
s_branch reca_exit1
reca_swave129:
s_cmp_lg_u32 s17, 63
s_cbranch_scc1 reca_vmst135
s_barrier
ds_read_b128 v[56:59], v1 offset:10240
ds_read_b128 v[60:63], v1 offset:11264
ds_read_b128 v[64:67], v1 offset:12288
s_waitcnt lgkmcnt(0)
v_add_f32 v56, v56, v64
v_add_f32 v60, v60, v48
v_add_f32 v57, v57, v65
v_add_f32 v61, v61, v49
v_add_f32 v58, v58, v66
v_add_f32 v62, v62, v50
v_add_f32 v59, v59, v67
v_add_f32 v63, v63, v51
v_cvt_pk_bf16_f32 v68, v56, v57
v_cvt_pk_bf16_f32 v69, v58, v59
v_cvt_pk_bf16_f32 v70, v60, v61
v_cvt_pk_bf16_f32 v71, v62, v63
buffer_store_dwordx2 v[52:53], v9, s[4:7], s30 offen
buffer_store_dwordx2 v[68:69], v10, s[4:7], s31 offen
buffer_store_dwordx2 v[70:71], v10, s[4:7], s31 offen offset:256
s_branch reca_exit1
reca_vmst135:
s_sleep 1
buffer_load_dwordx4 v[208:211], v1, s[4:7], s21 offen offset:0 sc1
buffer_load_dwordx4 v[212:215], v1, s[4:7], s21 offen offset:1024 sc1
buffer_load_dwordx4 v[216:219], v1, s[4:7], s21 offen offset:2048 sc1
buffer_load_dwordx4 v[220:223], v1, s[4:7], s21 offen offset:3072 sc1
buffer_load_dwordx4 v[224:227], v2, s[4:7], s21 offen offset:0 sc1
buffer_load_dwordx4 v[228:231], v2, s[4:7], s21 offen offset:1024 sc1
s_waitcnt vmcnt(5)
v_max_u32 v29, v208, v210
v_cmp_eq_u32 vcc, -1, v29
s_cbranch_vccnz reca_retry136
reca_resume137:
s_waitcnt vmcnt(4)
v_max_u32 v29, v212, v214
v_cmp_eq_u32 vcc, -1, v29
v_mfma_f32_16x16x32_bf16 v[76:79], a[120:123], v[208:211], 0
v_mfma_f32_16x16x32_bf16 v[80:83], a[144:147], v[208:211], 0
v_mfma_f32_16x16x32_bf16 v[72:75], v[208:211], v[208:211], v[40:43]
s_cbranch_vccnz reca_retry138
reca_resume139:
s_waitcnt vmcnt(3)
v_max_u32 v29, v216, v218
v_cmp_eq_u32 vcc, -1, v29
v_mfma_f32_16x16x32_bf16 v[76:79], a[124:127], v[212:215], v[76:79]
v_mfma_f32_16x16x32_bf16 v[80:83], a[148:151], v[212:215], v[80:83]
v_mfma_f32_16x16x32_bf16 v[72:75], v[212:215], v[212:215], v[72:75]
s_cbranch_vccnz reca_retry140
reca_resume141:
s_waitcnt vmcnt(2)
v_max_u32 v29, v220, v222
v_cmp_eq_u32 vcc, -1, v29
v_mfma_f32_16x16x32_bf16 v[76:79], a[128:131], v[216:219], v[76:79]
v_mfma_f32_16x16x32_bf16 v[80:83], a[152:155], v[216:219], v[80:83]
v_mfma_f32_16x16x32_bf16 v[72:75], v[216:219], v[216:219], v[72:75]
s_cbranch_vccnz reca_retry142
reca_resume143:
s_waitcnt vmcnt(1)
v_max_u32 v29, v224, v226
v_cmp_eq_u32 vcc, -1, v29
v_mfma_f32_16x16x32_bf16 v[76:79], a[132:135], v[220:223], v[76:79]
v_mfma_f32_16x16x32_bf16 v[80:83], a[156:159], v[220:223], v[80:83]
v_mfma_f32_16x16x32_bf16 v[72:75], v[220:223], v[220:223], v[72:75]
s_cbranch_vccnz reca_retry144
reca_resume145:
s_waitcnt vmcnt(0)
v_max_u32 v29, v228, v230
v_cmp_eq_u32 vcc, -1, v29
v_mfma_f32_16x16x32_bf16 v[76:79], a[136:139], v[224:227], v[76:79]
v_mfma_f32_16x16x32_bf16 v[80:83], a[160:163], v[224:227], v[80:83]
v_mfma_f32_16x16x32_bf16 v[72:75], v[224:227], v[224:227], v[72:75]
s_cbranch_vccnz reca_retry146
reca_resume147:
v_mfma_f32_16x16x32_bf16 v[76:79], a[140:143], v[228:231], v[76:79]
v_mfma_f32_16x16x32_bf16 v[80:83], a[164:167], v[228:231], v[80:83]
v_mfma_f32_16x16x32_bf16 v[72:75], v[228:231], v[228:231], v[72:75]
s_barrier
ds_read_b128 v[56:59], v1 offset:10240
ds_read_b128 v[60:63], v1 offset:11264
ds_read_b128 v[64:67], v1 offset:12288
s_nop 1
v_max3_f32 v28, v76, v77, v78
v_max3_f32 v29, v80, v81, v82
v_max3_f32 v28, v28, v79, v83
v_max3_f32 v29, v29, v72, v73
v_max3_f32 v28, v28, v74, v75
v_max_f32 v28, v28, v29
v_mov_b32 v29, v28
s_nop 1
v_permlane32_swap_b32 v28, v29
v_max_f32 v28, v28, v29
v_mov_b32 v29, v28
s_nop 1
v_permlane16_swap_b32 v28, v29
v_max_f32 v28, v28, v29
v_mul_f32 v28, s41, v28
v_fma_f32 v76, v76, s41, -v28
v_fma_f32 v77, v77, s41, -v28
v_fma_f32 v78, v78, s41, -v28
v_fma_f32 v79, v79, s41, -v28
v_fma_f32 v80, v80, s41, -v28
v_fma_f32 v81, v81, s41, -v28
v_fma_f32 v82, v82, s41, -v28
v_fma_f32 v83, v83, s41, -v28
v_fma_f32 v72, v72, s41, -v28
v_fma_f32 v73, v73, s41, -v28
v_fma_f32 v74, v74, s41, -v28
v_fma_f32 v75, v75, s41, -v28
v_exp_f32 v76, v76
v_exp_f32 v77, v77
v_exp_f32 v78, v78
v_exp_f32 v79, v79
v_exp_f32 v80, v80
v_exp_f32 v81, v81
v_exp_f32 v82, v82
v_exp_f32 v83, v83
v_cvt_pk_bf16_f32 v84, v76, v77
v_cvt_pk_bf16_f32 v85, v78, v79
v_cvt_pk_bf16_f32 v86, v80, v81
v_cvt_pk_bf16_f32 v87, v82, v83
v_exp_f32 v72, v72
v_exp_f32 v73, v73
v_mfma_f32_16x16x32_bf16 v[100:103], v[36:39], v[84:87], 0
v_exp_f32 v74, v74
v_exp_f32 v75, v75
v_mfma_f32_16x16x32_bf16 v[92:95], a[168:171], v[84:87], 0
v_cvt_pk_bf16_f32 v88, v72, v73
v_cvt_pk_bf16_f32 v89, v74, v75
v_mfma_f32_16x16x32_bf16 v[96:99], a[172:175], v[84:87], 0
s_waitcnt lgkmcnt(0)
v_mfma_f32_16x16x16_bf16 v[100:103], v[36:37], v[88:89], v[100:103]
v_add_f32 v56, v56, v64
v_add_f32 v60, v60, v48
v_add_f32 v57, v57, v65
v_add_f32 v61, v61, v49
v_add_f32 v58, v58, v66
v_add_f32 v62, v62, v50
v_add_f32 v59, v59, v67
v_add_f32 v63, v63, v51
v_cvt_pk_bf16_f32 v68, v56, v57
v_cvt_pk_bf16_f32 v69, v58, v59
v_cvt_pk_bf16_f32 v70, v60, v61
v_cvt_pk_bf16_f32 v71, v62, v63
v_mfma_f32_16x16x16_bf16 v[92:95], v[68:69], v[88:89], v[92:95]
v_rcp_f32 v28, v100
v_mfma_f32_16x16x16_bf16 v[96:99], v[70:71], v[88:89], v[96:99]
v_mov_b32 v29, v28
s_nop 4
v_pk_mul_f32 v[92:93], v[92:93], v[28:29]
v_pk_mul_f32 v[94:95], v[94:95], v[28:29]
v_pk_mul_f32 v[96:97], v[96:97], v[28:29]
v_pk_mul_f32 v[98:99], v[98:99], v[28:29]
v_cvt_pk_bf16_f32 v104, v92, v93
v_cvt_pk_bf16_f32 v105, v94, v95
v_cvt_pk_bf16_f32 v106, v96, v97
v_cvt_pk_bf16_f32 v107, v98, v99
buffer_store_dwordx4 v[104:107], v11, s[4:7], s22 offen sc1
reca_b3132:
s_barrier
s_cmp_ge_u32 s12, 2
s_cbranch_scc1 reca_notg2148
s_sleep 3
buffer_load_dwordx4 v[128:131], v12, s[4:7], s22 offen offset:0 sc1
buffer_load_dwordx4 v[132:135], v12, s[4:7], s22 offen offset:1024 sc1
buffer_load_dwordx4 v[136:139], v12, s[4:7], s22 offen offset:2048 sc1
buffer_load_dwordx4 v[140:143], v12, s[4:7], s22 offen offset:3072 sc1
buffer_load_dwordx4 v[144:147], v13, s[4:7], s22 offen offset:0 sc1
buffer_load_dwordx4 v[148:151], v13, s[4:7], s22 offen offset:1024 sc1
buffer_load_dwordx4 v[152:155], v13, s[4:7], s22 offen offset:2048 sc1
buffer_load_dwordx4 v[156:159], v13, s[4:7], s22 offen offset:3072 sc1
buffer_load_dwordx4 v[160:163], v14, s[4:7], s22 offen offset:0 sc1
buffer_load_dwordx4 v[164:167], v14, s[4:7], s22 offen offset:1024 sc1
buffer_load_dwordx4 v[168:171], v14, s[4:7], s22 offen offset:2048 sc1
buffer_load_dwordx4 v[172:175], v14, s[4:7], s22 offen offset:3072 sc1
s_waitcnt vmcnt(11)
v_cmp_eq_u32 vcc, -1, v128
s_cbranch_vccnz reca_retry149
reca_resume150:
s_waitcnt vmcnt(10)
v_cmp_eq_u32 vcc, -1, v132
v_mfma_f32_16x16x32_bf16 v[108:111], a[120:123], v[128:131], 0
v_mfma_f32_16x16x32_bf16 v[112:115], a[124:127], v[128:131], 0
s_cbranch_vccnz reca_retry151
reca_resume152:
s_waitcnt vmcnt(9)
v_cmp_eq_u32 vcc, -1, v136
v_mfma_f32_16x16x32_bf16 v[108:111], a[128:131], v[132:135], v[108:111]
v_mfma_f32_16x16x32_bf16 v[112:115], a[132:135], v[132:135], v[112:115]
s_cbranch_vccnz reca_retry153
reca_resume154:
s_waitcnt vmcnt(8)
v_cmp_eq_u32 vcc, -1, v140
v_mfma_f32_16x16x32_bf16 v[108:111], a[136:139], v[136:139], v[108:111]
v_mfma_f32_16x16x32_bf16 v[112:115], a[140:143], v[136:139], v[112:115]
s_cbranch_vccnz reca_retry155
reca_resume156:
s_waitcnt vmcnt(7)
v_cmp_eq_u32 vcc, -1, v144
v_mfma_f32_16x16x32_bf16 v[108:111], a[144:147], v[140:143], v[108:111]
v_mfma_f32_16x16x32_bf16 v[112:115], a[148:151], v[140:143], v[112:115]
s_cbranch_vccnz reca_retry157
reca_resume158:
s_waitcnt vmcnt(6)
v_cmp_eq_u32 vcc, -1, v148
v_mfma_f32_16x16x32_bf16 v[108:111], a[152:155], v[144:147], v[108:111]
v_mfma_f32_16x16x32_bf16 v[112:115], a[156:159], v[144:147], v[112:115]
s_cbranch_vccnz reca_retry159
reca_resume160:
s_waitcnt vmcnt(5)
v_cmp_eq_u32 vcc, -1, v152
v_mfma_f32_16x16x32_bf16 v[108:111], a[160:163], v[148:151], v[108:111]
v_mfma_f32_16x16x32_bf16 v[112:115], a[164:167], v[148:151], v[112:115]
s_cbranch_vccnz reca_retry161
reca_resume162:
s_waitcnt vmcnt(4)
v_cmp_eq_u32 vcc, -1, v156
v_mfma_f32_16x16x32_bf16 v[108:111], a[168:171], v[152:155], v[108:111]
v_mfma_f32_16x16x32_bf16 v[112:115], a[172:175], v[152:155], v[112:115]
s_cbranch_vccnz reca_retry163
reca_resume164:
s_waitcnt vmcnt(3)
v_cmp_eq_u32 vcc, -1, v160
v_mfma_f32_16x16x32_bf16 v[108:111], a[176:179], v[156:159], v[108:111]
v_mfma_f32_16x16x32_bf16 v[112:115], a[180:183], v[156:159], v[112:115]
s_cbranch_vccnz reca_retry165
reca_resume166:
s_waitcnt vmcnt(2)
v_cmp_eq_u32 vcc, -1, v164
v_mfma_f32_16x16x32_bf16 v[108:111], a[184:187], v[160:163], v[108:111]
v_mfma_f32_16x16x32_bf16 v[112:115], a[188:191], v[160:163], v[112:115]
s_cbranch_vccnz reca_retry167
reca_resume168:
s_waitcnt vmcnt(1)
v_cmp_eq_u32 vcc, -1, v168
v_mfma_f32_16x16x32_bf16 v[108:111], a[192:195], v[164:167], v[108:111]
v_mfma_f32_16x16x32_bf16 v[112:115], a[196:199], v[164:167], v[112:115]
s_cbranch_vccnz reca_retry169
reca_resume170:
s_waitcnt vmcnt(0)
v_cmp_eq_u32 vcc, -1, v172
v_mfma_f32_16x16x32_bf16 v[108:111], a[200:203], v[168:171], v[108:111]
v_mfma_f32_16x16x32_bf16 v[112:115], a[204:207], v[168:171], v[112:115]
s_cbranch_vccnz reca_retry171
reca_resume172:
v_mfma_f32_16x16x32_bf16 v[108:111], a[208:211], v[172:175], v[108:111]
v_mfma_f32_16x16x32_bf16 v[112:115], a[212:215], v[172:175], v[112:115]
s_nop 7
v_add_f32_dpp v116, v112, v108 row_ror:8 row_mask:0xf bank_mask:0xf
v_add_f32_dpp v117, v113, v109 row_ror:8 row_mask:0xf bank_mask:0xf
v_add_f32_dpp v118, v114, v110 row_ror:8 row_mask:0xf bank_mask:0xf
v_add_f32_dpp v119, v115, v111 row_ror:8 row_mask:0xf bank_mask:0xf
buffer_store_dwordx4 v[116:119], v15, s[4:7], s25 offen sc1
buffer_store_dwordx4 v[116:119], v232, s[4:7], s25 offen sc1
buffer_store_dwordx4 v[32:35], v15, s[4:7], s29 offen sc1
buffer_store_dwordx4 v[32:35], v232, s[4:7], s29 offen sc1
s_branch reca_b4133
reca_notg2148:
s_cmp_lg_u32 s12, 3
s_cbranch_scc1 reca_b4133
s_add_u32 s34, s17, 2
s_and_b32 s34, s34, 3
s_mul_i32 s26, s34, 10240
s_add_u32 s26, s26, s38
s_mul_i32 s27, s34, 6144
s_add_u32 s27, s27, s39
s_mul_i32 s28, s34, 12288
s_add_u32 s28, s28, s40
s_mul_i32 s29, s34, 393216
s_add_u32 s29, s29, s56
buffer_store_dwordx2 v[32:33], v8, s[4:7], s27 offen sc1
buffer_store_dwordx4 v[32:35], v11, s[4:7], s28 offen sc1
reca_b4133:
s_barrier
s_cmp_lg_u32 s12, 2
s_cbranch_scc1 reca_not2173
s_sleep 8
buffer_load_dwordx4 v[128:131], v20, s[4:7], s25 offen sc1
buffer_load_dwordx4 v[132:135], v21, s[4:7], s25 offen sc1
buffer_load_dwordx4 v[136:139], v22, s[4:7], s25 offen sc1
buffer_load_dwordx4 v[140:143], v23, s[4:7], s25 offen sc1
buffer_load_dwordx4 v[144:147], v24, s[4:7], s25 offen sc1
buffer_load_dwordx4 v[148:151], v25, s[4:7], s25 offen sc1
buffer_load_dwordx4 v[152:155], v26, s[4:7], s25 offen sc1
buffer_load_dwordx4 v[156:159], v27, s[4:7], s25 offen sc1
s_waitcnt vmcnt(7)
v_cmp_eq_u32 vcc, -1, v128
s_cbranch_vccnz reca_retry174
reca_resume175:
s_waitcnt vmcnt(6)
v_cmp_eq_u32 vcc, -1, v132
s_cbranch_vccnz reca_retry176
reca_resume177:
s_waitcnt vmcnt(5)
v_cmp_eq_u32 vcc, -1, v136
v_pk_add_f32 v[116:117], v[128:129], v[132:133]
v_pk_add_f32 v[118:119], v[130:131], v[134:135]
s_cbranch_vccnz reca_retry178
reca_resume179:
s_waitcnt vmcnt(4)
v_cmp_eq_u32 vcc, -1, v140
v_pk_add_f32 v[116:117], v[116:117], v[136:137]
v_pk_add_f32 v[118:119], v[118:119], v[138:139]
s_cbranch_vccnz reca_retry180
reca_resume181:
s_waitcnt vmcnt(3)
v_cmp_eq_u32 vcc, -1, v144
v_pk_add_f32 v[116:117], v[116:117], v[140:141]
v_pk_add_f32 v[118:119], v[118:119], v[142:143]
s_cbranch_vccnz reca_retry182
reca_resume183:
s_waitcnt vmcnt(2)
v_cmp_eq_u32 vcc, -1, v148
v_pk_add_f32 v[116:117], v[116:117], v[144:145]
v_pk_add_f32 v[118:119], v[118:119], v[146:147]
s_cbranch_vccnz reca_retry184
reca_resume185:
s_waitcnt vmcnt(1)
v_cmp_eq_u32 vcc, -1, v152
v_pk_add_f32 v[116:117], v[116:117], v[148:149]
v_pk_add_f32 v[118:119], v[118:119], v[150:151]
s_cbranch_vccnz reca_retry186
reca_resume187:
s_waitcnt vmcnt(0)
v_cmp_eq_u32 vcc, -1, v156
v_pk_add_f32 v[116:117], v[116:117], v[152:153]
v_pk_add_f32 v[118:119], v[118:119], v[154:155]
s_cbranch_vccnz reca_retry188
reca_resume189:
v_pk_add_f32 v[116:117], v[116:117], v[156:157]
v_pk_add_f32 v[118:119], v[118:119], v[158:159]
v_cvt_pk_bf16_f32 v132, v116, v117
v_cvt_pk_bf16_f32 v133, v118, v119
buffer_store_dwordx2 v[132:133], v16, s[4:7], s24 offen sc1
s_branch reca_b5134
reca_not2173:
s_cmp_lg_u32 s12, 3
s_cbranch_scc1 reca_b5134
s_add_u32 s36, s17, 1
s_cmp_ge_u32 s36, 63
s_cbranch_scc1 reca_nopf190
s_add_u32 s37, s36, 1
reca_pf191:
buffer_load_dword v28, v233, s[4:7], 0 offen sc1
s_waitcnt vmcnt(0)
v_cmp_gt_i32 vcc, s37, v28
s_cbranch_vccz reca_pfok192
s_sleep 1
s_sub_u32 s18, s18, 1
s_cbranch_scc0 reca_pf191
s_mov_b32 s18, 0
reca_pfok192:
s_lshl_b32 s34, s15, 3
s_and_b32 s35, s36, 7
s_add_u32 s34, s34, s35
s_mul_i32 s34, s34, 12288
s_add_u32 s32, s34, 37748736
s_lshl_b32 s35, s16, 11
s_add_u32 s34, s34, s35
s_add_u32 s33, s34, 40894464
buffer_load_dwordx4 a[120:123], v1, s[4:7], s32 offen offset:0 sc1
buffer_load_dwordx4 a[124:127], v1, s[4:7], s32 offen offset:1024 sc1
buffer_load_dwordx4 a[128:131], v1, s[4:7], s32 offen offset:2048 sc1
buffer_load_dwordx4 a[132:135], v1, s[4:7], s32 offen offset:3072 sc1
buffer_load_dwordx4 a[136:139], v2, s[4:7], s32 offen offset:0 sc1
buffer_load_dwordx4 a[140:143], v2, s[4:7], s32 offen offset:1024 sc1
buffer_load_dwordx4 a[144:147], v2, s[4:7], s32 offen offset:2048 sc1
buffer_load_dwordx4 a[148:151], v2, s[4:7], s32 offen offset:3072 sc1
buffer_load_dwordx4 a[152:155], v3, s[4:7], s32 offen offset:0 sc1
buffer_load_dwordx4 a[156:159], v3, s[4:7], s32 offen offset:1024 sc1
buffer_load_dwordx4 a[160:163], v3, s[4:7], s32 offen offset:2048 sc1
buffer_load_dwordx4 a[164:167], v3, s[4:7], s32 offen offset:3072 sc1
buffer_load_dwordx4 a[168:171], v1, s[4:7], s33 offen offset:0 sc1
buffer_load_dwordx4 a[172:175], v1, s[4:7], s33 offen offset:1024 sc1
reca_nopf190:
buffer_store_dwordx2 v[52:53], v9, s[4:7], s30 offen sc1
buffer_store_dwordx2 v[68:69], v10, s[4:7], s31 offen sc1
buffer_store_dwordx2 v[70:71], v10, s[4:7], s31 offen offset:256 sc1
reca_b5134:
s_barrier
s_add_u32 s17, s17, 1
s_branch reca_step120
reca_retry123:
s_sub_u32 s18, s18, 1
s_cbranch_scc1 reca_retry123_to
buffer_load_dwordx4 v[128:131], v4, s[4:7], s20 offen sc1
buffer_load_dwordx4 v[132:135], v4, s[4:7], s20 offen offset:1024 sc1
buffer_load_dwordx4 v[136:139], v5, s[4:7], s20 offen sc1
s_waitcnt vmcnt(2)
v_max_u32 v29, v128, v130
v_cmp_eq_u32 vcc, -1, v29
s_cbranch_vccnz reca_retry123
s_branch reca_resume124
reca_retry123_to:
s_mov_b32 s18, 0
s_waitcnt vmcnt(0)
s_branch reca_resume124
reca_retry125:
s_sub_u32 s18, s18, 1
s_cbranch_scc1 reca_retry125_to
buffer_load_dwordx4 v[132:135], v4, s[4:7], s20 offen offset:1024 sc1
buffer_load_dwordx4 v[136:139], v5, s[4:7], s20 offen sc1
s_waitcnt vmcnt(1)
v_max_u32 v29, v132, v134
v_cmp_eq_u32 vcc, -1, v29
s_cbranch_vccnz reca_retry125
s_branch reca_resume126
reca_retry125_to:
s_mov_b32 s18, 0
s_waitcnt vmcnt(0)
s_branch reca_resume126
reca_retry127:
s_sub_u32 s18, s18, 1
s_cbranch_scc1 reca_retry127_to
buffer_load_dwordx4 v[136:139], v5, s[4:7], s20 offen sc1
s_waitcnt vmcnt(0)
v_max_u32 v29, v136, v138
v_cmp_eq_u32 vcc, -1, v29
s_cbranch_vccnz reca_retry127
s_branch reca_resume128
reca_retry127_to:
s_mov_b32 s18, 0
s_waitcnt vmcnt(0)
s_branch reca_resume128
reca_retry136:
s_sub_u32 s18, s18, 1
s_cbranch_scc1 reca_retry136_to
buffer_load_dwordx4 v[208:211], v1, s[4:7], s21 offen offset:0 sc1
buffer_load_dwordx4 v[212:215], v1, s[4:7], s21 offen offset:1024 sc1
buffer_load_dwordx4 v[216:219], v1, s[4:7], s21 offen offset:2048 sc1
buffer_load_dwordx4 v[220:223], v1, s[4:7], s21 offen offset:3072 sc1
buffer_load_dwordx4 v[224:227], v2, s[4:7], s21 offen offset:0 sc1
buffer_load_dwordx4 v[228:231], v2, s[4:7], s21 offen offset:1024 sc1
s_waitcnt vmcnt(5)
v_max_u32 v29, v208, v210
v_cmp_eq_u32 vcc, -1, v29
s_cbranch_vccnz reca_retry136
s_branch reca_resume137
reca_retry136_to:
s_mov_b32 s18, 0
s_waitcnt vmcnt(0)
s_branch reca_resume137
reca_retry138:
s_sub_u32 s18, s18, 1
s_cbranch_scc1 reca_retry138_to
buffer_load_dwordx4 v[212:215], v1, s[4:7], s21 offen offset:1024 sc1
buffer_load_dwordx4 v[216:219], v1, s[4:7], s21 offen offset:2048 sc1
buffer_load_dwordx4 v[220:223], v1, s[4:7], s21 offen offset:3072 sc1
buffer_load_dwordx4 v[224:227], v2, s[4:7], s21 offen offset:0 sc1
buffer_load_dwordx4 v[228:231], v2, s[4:7], s21 offen offset:1024 sc1
s_waitcnt vmcnt(4)
v_max_u32 v29, v212, v214
v_cmp_eq_u32 vcc, -1, v29
s_cbranch_vccnz reca_retry138
s_branch reca_resume139
reca_retry138_to:
s_mov_b32 s18, 0
s_waitcnt vmcnt(0)
s_branch reca_resume139
reca_retry140:
s_sub_u32 s18, s18, 1
s_cbranch_scc1 reca_retry140_to
buffer_load_dwordx4 v[216:219], v1, s[4:7], s21 offen offset:2048 sc1
buffer_load_dwordx4 v[220:223], v1, s[4:7], s21 offen offset:3072 sc1
buffer_load_dwordx4 v[224:227], v2, s[4:7], s21 offen offset:0 sc1
buffer_load_dwordx4 v[228:231], v2, s[4:7], s21 offen offset:1024 sc1
s_waitcnt vmcnt(3)
v_max_u32 v29, v216, v218
v_cmp_eq_u32 vcc, -1, v29
s_cbranch_vccnz reca_retry140
s_branch reca_resume141
reca_retry140_to:
s_mov_b32 s18, 0
s_waitcnt vmcnt(0)
s_branch reca_resume141
reca_retry142:
s_sub_u32 s18, s18, 1
s_cbranch_scc1 reca_retry142_to
buffer_load_dwordx4 v[220:223], v1, s[4:7], s21 offen offset:3072 sc1
buffer_load_dwordx4 v[224:227], v2, s[4:7], s21 offen offset:0 sc1
buffer_load_dwordx4 v[228:231], v2, s[4:7], s21 offen offset:1024 sc1
s_waitcnt vmcnt(2)
v_max_u32 v29, v220, v222
v_cmp_eq_u32 vcc, -1, v29
s_cbranch_vccnz reca_retry142
s_branch reca_resume143
reca_retry142_to:
s_mov_b32 s18, 0
s_waitcnt vmcnt(0)
s_branch reca_resume143
reca_retry144:
s_sub_u32 s18, s18, 1
s_cbranch_scc1 reca_retry144_to
buffer_load_dwordx4 v[224:227], v2, s[4:7], s21 offen offset:0 sc1
buffer_load_dwordx4 v[228:231], v2, s[4:7], s21 offen offset:1024 sc1
s_waitcnt vmcnt(1)
v_max_u32 v29, v224, v226
v_cmp_eq_u32 vcc, -1, v29
s_cbranch_vccnz reca_retry144
s_branch reca_resume145
reca_retry144_to:
s_mov_b32 s18, 0
s_waitcnt vmcnt(0)
s_branch reca_resume145
reca_retry146:
s_sub_u32 s18, s18, 1
s_cbranch_scc1 reca_retry146_to
buffer_load_dwordx4 v[228:231], v2, s[4:7], s21 offen offset:1024 sc1
s_waitcnt vmcnt(0)
v_max_u32 v29, v228, v230
v_cmp_eq_u32 vcc, -1, v29
s_cbranch_vccnz reca_retry146
s_branch reca_resume147
reca_retry146_to:
s_mov_b32 s18, 0
s_waitcnt vmcnt(0)
s_branch reca_resume147
reca_retry149:
s_sub_u32 s18, s18, 1
s_cbranch_scc1 reca_retry149_to
buffer_load_dwordx4 v[128:131], v12, s[4:7], s22 offen offset:0 sc1
buffer_load_dwordx4 v[132:135], v12, s[4:7], s22 offen offset:1024 sc1
buffer_load_dwordx4 v[136:139], v12, s[4:7], s22 offen offset:2048 sc1
buffer_load_dwordx4 v[140:143], v12, s[4:7], s22 offen offset:3072 sc1
buffer_load_dwordx4 v[144:147], v13, s[4:7], s22 offen offset:0 sc1
buffer_load_dwordx4 v[148:151], v13, s[4:7], s22 offen offset:1024 sc1
buffer_load_dwordx4 v[152:155], v13, s[4:7], s22 offen offset:2048 sc1
buffer_load_dwordx4 v[156:159], v13, s[4:7], s22 offen offset:3072 sc1
buffer_load_dwordx4 v[160:163], v14, s[4:7], s22 offen offset:0 sc1
buffer_load_dwordx4 v[164:167], v14, s[4:7], s22 offen offset:1024 sc1
buffer_load_dwordx4 v[168:171], v14, s[4:7], s22 offen offset:2048 sc1
buffer_load_dwordx4 v[172:175], v14, s[4:7], s22 offen offset:3072 sc1
s_waitcnt vmcnt(11)
v_cmp_eq_u32 vcc, -1, v128
s_cbranch_vccnz reca_retry149
s_branch reca_resume150
reca_retry149_to:
s_mov_b32 s18, 0
s_waitcnt vmcnt(0)
s_branch reca_resume150
reca_retry151:
s_sub_u32 s18, s18, 1
s_cbranch_scc1 reca_retry151_to
buffer_load_dwordx4 v[132:135], v12, s[4:7], s22 offen offset:1024 sc1
buffer_load_dwordx4 v[136:139], v12, s[4:7], s22 offen offset:2048 sc1
buffer_load_dwordx4 v[140:143], v12, s[4:7], s22 offen offset:3072 sc1
buffer_load_dwordx4 v[144:147], v13, s[4:7], s22 offen offset:0 sc1
buffer_load_dwordx4 v[148:151], v13, s[4:7], s22 offen offset:1024 sc1
buffer_load_dwordx4 v[152:155], v13, s[4:7], s22 offen offset:2048 sc1
buffer_load_dwordx4 v[156:159], v13, s[4:7], s22 offen offset:3072 sc1
buffer_load_dwordx4 v[160:163], v14, s[4:7], s22 offen offset:0 sc1
buffer_load_dwordx4 v[164:167], v14, s[4:7], s22 offen offset:1024 sc1
buffer_load_dwordx4 v[168:171], v14, s[4:7], s22 offen offset:2048 sc1
buffer_load_dwordx4 v[172:175], v14, s[4:7], s22 offen offset:3072 sc1
s_waitcnt vmcnt(10)
v_cmp_eq_u32 vcc, -1, v132
s_cbranch_vccnz reca_retry151
s_branch reca_resume152
reca_retry151_to:
s_mov_b32 s18, 0
s_waitcnt vmcnt(0)
s_branch reca_resume152
reca_retry153:
s_sub_u32 s18, s18, 1
s_cbranch_scc1 reca_retry153_to
buffer_load_dwordx4 v[136:139], v12, s[4:7], s22 offen offset:2048 sc1
buffer_load_dwordx4 v[140:143], v12, s[4:7], s22 offen offset:3072 sc1
buffer_load_dwordx4 v[144:147], v13, s[4:7], s22 offen offset:0 sc1
buffer_load_dwordx4 v[148:151], v13, s[4:7], s22 offen offset:1024 sc1
buffer_load_dwordx4 v[152:155], v13, s[4:7], s22 offen offset:2048 sc1
buffer_load_dwordx4 v[156:159], v13, s[4:7], s22 offen offset:3072 sc1
buffer_load_dwordx4 v[160:163], v14, s[4:7], s22 offen offset:0 sc1
buffer_load_dwordx4 v[164:167], v14, s[4:7], s22 offen offset:1024 sc1
buffer_load_dwordx4 v[168:171], v14, s[4:7], s22 offen offset:2048 sc1
buffer_load_dwordx4 v[172:175], v14, s[4:7], s22 offen offset:3072 sc1
s_waitcnt vmcnt(9)
v_cmp_eq_u32 vcc, -1, v136
s_cbranch_vccnz reca_retry153
s_branch reca_resume154
reca_retry153_to:
s_mov_b32 s18, 0
s_waitcnt vmcnt(0)
s_branch reca_resume154
reca_retry155:
s_sub_u32 s18, s18, 1
s_cbranch_scc1 reca_retry155_to
buffer_load_dwordx4 v[140:143], v12, s[4:7], s22 offen offset:3072 sc1
buffer_load_dwordx4 v[144:147], v13, s[4:7], s22 offen offset:0 sc1
buffer_load_dwordx4 v[148:151], v13, s[4:7], s22 offen offset:1024 sc1
buffer_load_dwordx4 v[152:155], v13, s[4:7], s22 offen offset:2048 sc1
buffer_load_dwordx4 v[156:159], v13, s[4:7], s22 offen offset:3072 sc1
buffer_load_dwordx4 v[160:163], v14, s[4:7], s22 offen offset:0 sc1
buffer_load_dwordx4 v[164:167], v14, s[4:7], s22 offen offset:1024 sc1
buffer_load_dwordx4 v[168:171], v14, s[4:7], s22 offen offset:2048 sc1
buffer_load_dwordx4 v[172:175], v14, s[4:7], s22 offen offset:3072 sc1
s_waitcnt vmcnt(8)
v_cmp_eq_u32 vcc, -1, v140
s_cbranch_vccnz reca_retry155
s_branch reca_resume156
reca_retry155_to:
s_mov_b32 s18, 0
s_waitcnt vmcnt(0)
s_branch reca_resume156
reca_retry157:
s_sub_u32 s18, s18, 1
s_cbranch_scc1 reca_retry157_to
buffer_load_dwordx4 v[144:147], v13, s[4:7], s22 offen offset:0 sc1
buffer_load_dwordx4 v[148:151], v13, s[4:7], s22 offen offset:1024 sc1
buffer_load_dwordx4 v[152:155], v13, s[4:7], s22 offen offset:2048 sc1
buffer_load_dwordx4 v[156:159], v13, s[4:7], s22 offen offset:3072 sc1
buffer_load_dwordx4 v[160:163], v14, s[4:7], s22 offen offset:0 sc1
buffer_load_dwordx4 v[164:167], v14, s[4:7], s22 offen offset:1024 sc1
buffer_load_dwordx4 v[168:171], v14, s[4:7], s22 offen offset:2048 sc1
buffer_load_dwordx4 v[172:175], v14, s[4:7], s22 offen offset:3072 sc1
s_waitcnt vmcnt(7)
v_cmp_eq_u32 vcc, -1, v144
s_cbranch_vccnz reca_retry157
s_branch reca_resume158
reca_retry157_to:
s_mov_b32 s18, 0
s_waitcnt vmcnt(0)
s_branch reca_resume158
reca_retry159:
s_sub_u32 s18, s18, 1
s_cbranch_scc1 reca_retry159_to
buffer_load_dwordx4 v[148:151], v13, s[4:7], s22 offen offset:1024 sc1
buffer_load_dwordx4 v[152:155], v13, s[4:7], s22 offen offset:2048 sc1
buffer_load_dwordx4 v[156:159], v13, s[4:7], s22 offen offset:3072 sc1
buffer_load_dwordx4 v[160:163], v14, s[4:7], s22 offen offset:0 sc1
buffer_load_dwordx4 v[164:167], v14, s[4:7], s22 offen offset:1024 sc1
buffer_load_dwordx4 v[168:171], v14, s[4:7], s22 offen offset:2048 sc1
buffer_load_dwordx4 v[172:175], v14, s[4:7], s22 offen offset:3072 sc1
s_waitcnt vmcnt(6)
v_cmp_eq_u32 vcc, -1, v148
s_cbranch_vccnz reca_retry159
s_branch reca_resume160
reca_retry159_to:
s_mov_b32 s18, 0
s_waitcnt vmcnt(0)
s_branch reca_resume160
reca_retry161:
s_sub_u32 s18, s18, 1
s_cbranch_scc1 reca_retry161_to
buffer_load_dwordx4 v[152:155], v13, s[4:7], s22 offen offset:2048 sc1
buffer_load_dwordx4 v[156:159], v13, s[4:7], s22 offen offset:3072 sc1
buffer_load_dwordx4 v[160:163], v14, s[4:7], s22 offen offset:0 sc1
buffer_load_dwordx4 v[164:167], v14, s[4:7], s22 offen offset:1024 sc1
buffer_load_dwordx4 v[168:171], v14, s[4:7], s22 offen offset:2048 sc1
buffer_load_dwordx4 v[172:175], v14, s[4:7], s22 offen offset:3072 sc1
s_waitcnt vmcnt(5)
v_cmp_eq_u32 vcc, -1, v152
s_cbranch_vccnz reca_retry161
s_branch reca_resume162
reca_retry161_to:
s_mov_b32 s18, 0
s_waitcnt vmcnt(0)
s_branch reca_resume162
reca_retry163:
s_sub_u32 s18, s18, 1
s_cbranch_scc1 reca_retry163_to
buffer_load_dwordx4 v[156:159], v13, s[4:7], s22 offen offset:3072 sc1
buffer_load_dwordx4 v[160:163], v14, s[4:7], s22 offen offset:0 sc1
buffer_load_dwordx4 v[164:167], v14, s[4:7], s22 offen offset:1024 sc1
buffer_load_dwordx4 v[168:171], v14, s[4:7], s22 offen offset:2048 sc1
buffer_load_dwordx4 v[172:175], v14, s[4:7], s22 offen offset:3072 sc1
s_waitcnt vmcnt(4)
v_cmp_eq_u32 vcc, -1, v156
s_cbranch_vccnz reca_retry163
s_branch reca_resume164
reca_retry163_to:
s_mov_b32 s18, 0
s_waitcnt vmcnt(0)
s_branch reca_resume164
reca_retry165:
s_sub_u32 s18, s18, 1
s_cbranch_scc1 reca_retry165_to
buffer_load_dwordx4 v[160:163], v14, s[4:7], s22 offen offset:0 sc1
buffer_load_dwordx4 v[164:167], v14, s[4:7], s22 offen offset:1024 sc1
buffer_load_dwordx4 v[168:171], v14, s[4:7], s22 offen offset:2048 sc1
buffer_load_dwordx4 v[172:175], v14, s[4:7], s22 offen offset:3072 sc1
s_waitcnt vmcnt(3)
v_cmp_eq_u32 vcc, -1, v160
s_cbranch_vccnz reca_retry165
s_branch reca_resume166
reca_retry165_to:
s_mov_b32 s18, 0
s_waitcnt vmcnt(0)
s_branch reca_resume166
reca_retry167:
s_sub_u32 s18, s18, 1
s_cbranch_scc1 reca_retry167_to
buffer_load_dwordx4 v[164:167], v14, s[4:7], s22 offen offset:1024 sc1
buffer_load_dwordx4 v[168:171], v14, s[4:7], s22 offen offset:2048 sc1
buffer_load_dwordx4 v[172:175], v14, s[4:7], s22 offen offset:3072 sc1
s_waitcnt vmcnt(2)
v_cmp_eq_u32 vcc, -1, v164
s_cbranch_vccnz reca_retry167
s_branch reca_resume168
reca_retry167_to:
s_mov_b32 s18, 0
s_waitcnt vmcnt(0)
s_branch reca_resume168
reca_retry169:
s_sub_u32 s18, s18, 1
s_cbranch_scc1 reca_retry169_to
buffer_load_dwordx4 v[168:171], v14, s[4:7], s22 offen offset:2048 sc1
buffer_load_dwordx4 v[172:175], v14, s[4:7], s22 offen offset:3072 sc1
s_waitcnt vmcnt(1)
v_cmp_eq_u32 vcc, -1, v168
s_cbranch_vccnz reca_retry169
s_branch reca_resume170
reca_retry169_to:
s_mov_b32 s18, 0
s_waitcnt vmcnt(0)
s_branch reca_resume170
reca_retry171:
s_sub_u32 s18, s18, 1
s_cbranch_scc1 reca_retry171_to
buffer_load_dwordx4 v[172:175], v14, s[4:7], s22 offen offset:3072 sc1
s_waitcnt vmcnt(0)
v_cmp_eq_u32 vcc, -1, v172
s_cbranch_vccnz reca_retry171
s_branch reca_resume172
reca_retry171_to:
s_mov_b32 s18, 0
s_waitcnt vmcnt(0)
s_branch reca_resume172
reca_retry174:
s_sub_u32 s18, s18, 1
s_cbranch_scc1 reca_retry174_to
buffer_load_dwordx4 v[128:131], v20, s[4:7], s25 offen sc1
buffer_load_dwordx4 v[132:135], v21, s[4:7], s25 offen sc1
buffer_load_dwordx4 v[136:139], v22, s[4:7], s25 offen sc1
buffer_load_dwordx4 v[140:143], v23, s[4:7], s25 offen sc1
buffer_load_dwordx4 v[144:147], v24, s[4:7], s25 offen sc1
buffer_load_dwordx4 v[148:151], v25, s[4:7], s25 offen sc1
buffer_load_dwordx4 v[152:155], v26, s[4:7], s25 offen sc1
buffer_load_dwordx4 v[156:159], v27, s[4:7], s25 offen sc1
s_waitcnt vmcnt(7)
v_cmp_eq_u32 vcc, -1, v128
s_cbranch_vccnz reca_retry174
s_branch reca_resume175
reca_retry174_to:
s_mov_b32 s18, 0
s_waitcnt vmcnt(0)
s_branch reca_resume175
reca_retry176:
s_sub_u32 s18, s18, 1
s_cbranch_scc1 reca_retry176_to
buffer_load_dwordx4 v[132:135], v21, s[4:7], s25 offen sc1
buffer_load_dwordx4 v[136:139], v22, s[4:7], s25 offen sc1
buffer_load_dwordx4 v[140:143], v23, s[4:7], s25 offen sc1
buffer_load_dwordx4 v[144:147], v24, s[4:7], s25 offen sc1
buffer_load_dwordx4 v[148:151], v25, s[4:7], s25 offen sc1
buffer_load_dwordx4 v[152:155], v26, s[4:7], s25 offen sc1
buffer_load_dwordx4 v[156:159], v27, s[4:7], s25 offen sc1
s_waitcnt vmcnt(6)
v_cmp_eq_u32 vcc, -1, v132
s_cbranch_vccnz reca_retry176
s_branch reca_resume177
reca_retry176_to:
s_mov_b32 s18, 0
s_waitcnt vmcnt(0)
s_branch reca_resume177
reca_retry178:
s_sub_u32 s18, s18, 1
s_cbranch_scc1 reca_retry178_to
buffer_load_dwordx4 v[136:139], v22, s[4:7], s25 offen sc1
buffer_load_dwordx4 v[140:143], v23, s[4:7], s25 offen sc1
buffer_load_dwordx4 v[144:147], v24, s[4:7], s25 offen sc1
buffer_load_dwordx4 v[148:151], v25, s[4:7], s25 offen sc1
buffer_load_dwordx4 v[152:155], v26, s[4:7], s25 offen sc1
buffer_load_dwordx4 v[156:159], v27, s[4:7], s25 offen sc1
s_waitcnt vmcnt(5)
v_cmp_eq_u32 vcc, -1, v136
s_cbranch_vccnz reca_retry178
s_branch reca_resume179
reca_retry178_to:
s_mov_b32 s18, 0
s_waitcnt vmcnt(0)
s_branch reca_resume179
reca_retry180:
s_sub_u32 s18, s18, 1
s_cbranch_scc1 reca_retry180_to
buffer_load_dwordx4 v[140:143], v23, s[4:7], s25 offen sc1
buffer_load_dwordx4 v[144:147], v24, s[4:7], s25 offen sc1
buffer_load_dwordx4 v[148:151], v25, s[4:7], s25 offen sc1
buffer_load_dwordx4 v[152:155], v26, s[4:7], s25 offen sc1
buffer_load_dwordx4 v[156:159], v27, s[4:7], s25 offen sc1
s_waitcnt vmcnt(4)
v_cmp_eq_u32 vcc, -1, v140
s_cbranch_vccnz reca_retry180
s_branch reca_resume181
reca_retry180_to:
s_mov_b32 s18, 0
s_waitcnt vmcnt(0)
s_branch reca_resume181
reca_retry182:
s_sub_u32 s18, s18, 1
s_cbranch_scc1 reca_retry182_to
buffer_load_dwordx4 v[144:147], v24, s[4:7], s25 offen sc1
buffer_load_dwordx4 v[148:151], v25, s[4:7], s25 offen sc1
buffer_load_dwordx4 v[152:155], v26, s[4:7], s25 offen sc1
buffer_load_dwordx4 v[156:159], v27, s[4:7], s25 offen sc1
s_waitcnt vmcnt(3)
v_cmp_eq_u32 vcc, -1, v144
s_cbranch_vccnz reca_retry182
s_branch reca_resume183
reca_retry182_to:
s_mov_b32 s18, 0
s_waitcnt vmcnt(0)
s_branch reca_resume183
reca_retry184:
s_sub_u32 s18, s18, 1
s_cbranch_scc1 reca_retry184_to
buffer_load_dwordx4 v[148:151], v25, s[4:7], s25 offen sc1
buffer_load_dwordx4 v[152:155], v26, s[4:7], s25 offen sc1
buffer_load_dwordx4 v[156:159], v27, s[4:7], s25 offen sc1
s_waitcnt vmcnt(2)
v_cmp_eq_u32 vcc, -1, v148
s_cbranch_vccnz reca_retry184
s_branch reca_resume185
reca_retry184_to:
s_mov_b32 s18, 0
s_waitcnt vmcnt(0)
s_branch reca_resume185
reca_retry186:
s_sub_u32 s18, s18, 1
s_cbranch_scc1 reca_retry186_to
buffer_load_dwordx4 v[152:155], v26, s[4:7], s25 offen sc1
buffer_load_dwordx4 v[156:159], v27, s[4:7], s25 offen sc1
s_waitcnt vmcnt(1)
v_cmp_eq_u32 vcc, -1, v152
s_cbranch_vccnz reca_retry186
s_branch reca_resume187
reca_retry186_to:
s_mov_b32 s18, 0
s_waitcnt vmcnt(0)
s_branch reca_resume187
reca_retry188:
s_sub_u32 s18, s18, 1
s_cbranch_scc1 reca_retry188_to
buffer_load_dwordx4 v[156:159], v27, s[4:7], s25 offen sc1
s_waitcnt vmcnt(0)
v_cmp_eq_u32 vcc, -1, v156
s_cbranch_vccnz reca_retry188
s_branch reca_resume189
reca_retry188_to:
s_mov_b32 s18, 0
s_waitcnt vmcnt(0)
s_branch reca_resume189
reca_twins13:
s_branch reca_gotmem194
reca_step193:
s_and_b32 s34, s17, 3
s_mul_i32 s20, s34, 10240
s_add_u32 s20, s20, s38
s_sleep 5
buffer_load_dwordx4 v[128:131], v4, s[4:7], s20 offen sc1
buffer_load_dwordx4 v[132:135], v4, s[4:7], s20 offen offset:1024 sc1
buffer_load_dwordx4 v[136:139], v5, s[4:7], s20 offen sc1
s_waitcnt vmcnt(2)
v_max_u32 v29, v128, v130
v_cmp_eq_u32 vcc, -1, v29
s_cbranch_vccnz reca_retry196
reca_resume197:
s_waitcnt vmcnt(1)
v_max_u32 v29, v132, v134
v_cmp_eq_u32 vcc, -1, v29
ds_write_b128 v4, v[128:131]
s_cbranch_vccnz reca_retry198
reca_resume199:
s_waitcnt vmcnt(0)
v_max_u32 v29, v136, v138
v_cmp_eq_u32 vcc, -1, v29
ds_write_b128 v4, v[132:135] offset:1024
s_cbranch_vccnz reca_retry200
reca_resume201:
ds_write_b128 v5, v[136:139]
s_branch reca_gotmem2195
reca_gotmem194:
ds_write_b128 v4, v[128:131]
ds_write_b128 v4, v[132:135] offset:1024
ds_write_b128 v5, v[136:139]
reca_gotmem2195:
s_and_b32 s34, s17, 3
s_mul_i32 s21, s34, 6144
s_add_u32 s21, s21, s39
s_mul_i32 s22, s34, 12288
s_add_u32 s22, s22, s40
s_mul_i32 s25, s34, 393216
s_add_u32 s25, s25, s56
s_add_u32 s35, s17, 1
s_and_b32 s35, s35, 3
s_mul_i32 s24, s35, 10240
s_add_u32 s24, s24, s38
s_waitcnt lgkmcnt(0)
s_barrier
ds_read_b128 v[128:131], v236 offset:0
ds_read_b128 v[132:135], v236 offset:1024
ds_read_b128 v[136:139], v236 offset:2048
ds_read_b128 v[140:143], v236 offset:3072
ds_read_b128 v[144:147], v236 offset:4096
ds_read_b128 v[148:151], v237 offset:0
ds_read_b128 v[152:155], v237 offset:1024
ds_read_b128 v[156:159], v237 offset:2048
ds_read_b128 v[160:163], v237 offset:3072
ds_read_b128 v[164:167], v237 offset:4096
s_waitcnt lgkmcnt(9)
v_mfma_f32_16x16x32_bf16 v[44:47], a[0:3], v[128:131], 0
ds_read_b128 v[168:171], v6 offset:0
v_mfma_f32_16x16x32_bf16 v[240:243], a[4:7], v[128:131], 0
s_waitcnt lgkmcnt(9)
v_mfma_f32_16x16x32_bf16 v[44:47], a[8:11], v[132:135], v[44:47]
ds_read_b128 v[172:175], v6 offset:512
v_mfma_f32_16x16x32_bf16 v[240:243], a[12:15], v[132:135], v[240:243]
s_waitcnt lgkmcnt(9)
v_mfma_f32_16x16x32_bf16 v[44:47], a[16:19], v[136:139], v[44:47]
ds_read_b128 v[176:179], v6 offset:1024
v_mfma_f32_16x16x32_bf16 v[240:243], a[20:23], v[136:139], v[240:243]
s_waitcnt lgkmcnt(9)
v_mfma_f32_16x16x32_bf16 v[44:47], a[24:27], v[140:143], v[44:47]
ds_read_b128 v[180:183], v6 offset:1536
v_mfma_f32_16x16x32_bf16 v[240:243], a[28:31], v[140:143], v[240:243]
s_waitcnt lgkmcnt(9)
v_mfma_f32_16x16x32_bf16 v[44:47], a[32:35], v[144:147], v[44:47]
ds_read_b128 v[184:187], v6 offset:2048
v_mfma_f32_16x16x32_bf16 v[240:243], a[36:39], v[144:147], v[240:243]
s_waitcnt lgkmcnt(9)
v_mfma_f32_16x16x32_bf16 v[44:47], a[40:43], v[148:151], v[44:47]
ds_read_b128 v[188:191], v6 offset:2560
v_mfma_f32_16x16x32_bf16 v[240:243], a[44:47], v[148:151], v[240:243]
s_waitcnt lgkmcnt(9)
v_mfma_f32_16x16x32_bf16 v[44:47], a[48:51], v[152:155], v[44:47]
ds_read_b128 v[192:195], v6 offset:3072
v_mfma_f32_16x16x32_bf16 v[240:243], a[52:55], v[152:155], v[240:243]
s_waitcnt lgkmcnt(9)
v_mfma_f32_16x16x32_bf16 v[44:47], a[56:59], v[156:159], v[44:47]
ds_read_b128 v[196:199], v6 offset:3584
v_mfma_f32_16x16x32_bf16 v[240:243], a[60:63], v[156:159], v[240:243]
s_waitcnt lgkmcnt(9)
v_mfma_f32_16x16x32_bf16 v[44:47], a[64:67], v[160:163], v[44:47]
ds_read_b128 v[200:203], v6 offset:4096
v_mfma_f32_16x16x32_bf16 v[240:243], a[68:71], v[160:163], v[240:243]
s_waitcnt lgkmcnt(9)
v_mfma_f32_16x16x32_bf16 v[44:47], a[72:75], v[164:167], v[44:47]
ds_read_b128 v[204:207], v6 offset:4608
v_mfma_f32_16x16x32_bf16 v[240:243], a[76:79], v[164:167], v[240:243]
s_waitcnt lgkmcnt(9)
v_mfma_f32_16x16x32_bf16 v[48:51], v[168:171], a[80:83], 0
s_and_b32 s34, s17, 7
s_lshl_b32 s34, s34, 5
s_add_u32 s34, s34, s15
s_mul_i32 s34, s34, 3072
s_lshl_b32 s35, s16, 9
s_add_u32 s34, s34, s35
s_add_u32 s30, s34, 47185920
s_add_u32 s31, s34, 47972352
v_add_f32_dpp v44, v240, v44 row_ror:8 row_mask:0xf bank_mask:0xf
v_add_f32_dpp v45, v241, v45 row_ror:8 row_mask:0xf bank_mask:0xf
v_add_f32_dpp v46, v242, v46 row_ror:8 row_mask:0xf bank_mask:0xf
v_add_f32_dpp v47, v243, v47 row_ror:8 row_mask:0xf bank_mask:0xf
v_cvt_pk_bf16_f32 v52, v44, v45
v_cvt_pk_bf16_f32 v53, v46, v47
buffer_store_dwordx2 v[52:53], v8, s[4:7], s21 offen sc1
s_waitcnt lgkmcnt(8)
v_mfma_f32_16x16x32_bf16 v[48:51], v[172:175], a[84:87], v[48:51]
s_waitcnt lgkmcnt(7)
v_mfma_f32_16x16x32_bf16 v[48:51], v[176:179], a[88:91], v[48:51]
s_waitcnt lgkmcnt(6)
v_mfma_f32_16x16x32_bf16 v[48:51], v[180:183], a[92:95], v[48:51]
s_waitcnt lgkmcnt(5)
v_mfma_f32_16x16x32_bf16 v[48:51], v[184:187], a[96:99], v[48:51]
s_waitcnt lgkmcnt(4)
v_mfma_f32_16x16x32_bf16 v[48:51], v[188:191], a[100:103], v[48:51]
s_waitcnt lgkmcnt(3)
v_mfma_f32_16x16x32_bf16 v[48:51], v[192:195], a[104:107], v[48:51]
s_waitcnt lgkmcnt(2)
v_mfma_f32_16x16x32_bf16 v[48:51], v[196:199], a[108:111], v[48:51]
s_waitcnt lgkmcnt(1)
v_mfma_f32_16x16x32_bf16 v[48:51], v[200:203], a[112:115], v[48:51]
s_waitcnt lgkmcnt(0)
v_mfma_f32_16x16x32_bf16 v[48:51], v[204:207], a[116:119], v[48:51]
s_cmp_eq_u32 s12, 3
s_cbranch_scc1 reca_swave202
s_nop 5
ds_write_b128 v17, v[48:51]
s_add_u32 s34, s17, 2
s_and_b32 s34, s34, 3
s_mul_i32 s26, s34, 10240
s_add_u32 s26, s26, s38
s_mul_i32 s27, s34, 6144
s_add_u32 s27, s27, s39
s_mul_i32 s28, s34, 12288
s_add_u32 s28, s28, s40
s_mul_i32 s29, s34, 393216
s_add_u32 s29, s29, s56
s_waitcnt lgkmcnt(0)
s_barrier
s_cmp_eq_u32 s17, 63
s_cbranch_scc1 reca_last204
buffer_store_dwordx2 v[32:33], v8, s[4:7], s27 offen sc1
s_cmp_lg_u32 s12, 2
s_cbranch_scc1 reca_tw1208_n
buffer_store_dwordx2 v[52:53], v9, s[4:7], s30 offen sc1
reca_tw1208_n:
s_barrier
s_cmp_eq_u32 s12, 1
s_cbranch_scc1 reca_tw1208
s_cmp_eq_u32 s12, 2
s_cbranch_scc1 reca_tw2209
s_cmp_lt_u32 s17, 2
s_cbranch_scc1 reca_b5207
s_cmp_gt_u32 s17, 61
s_cbranch_scc1 reca_b5207
s_sub_u32 s36, s17, 2
s_and_b32 s36, s36, 7
s_lshl_b32 s34, s59, 3
s_add_u32 s34, s34, s36
s_mul_i32 s34, s34, 12288
s_add_u32 s23, s34, 37748736
s_add_u32 s60, s34, 44040192
s_lshl_b32 s35, s36, 5
s_add_u32 s35, s35, s59
s_mul_i32 s35, s35, 3072
s_add_u32 s61, s35, 47185920
buffer_load_dwordx4 a[120:123], v1, s[4:7], s23 offen offset:0 sc1
buffer_load_dwordx4 a[124:127], v1, s[4:7], s23 offen offset:1024 sc1
buffer_load_dwordx4 a[128:131], v1, s[4:7], s23 offen offset:2048 sc1
buffer_load_dwordx4 a[132:135], v1, s[4:7], s23 offen offset:3072 sc1
buffer_load_dwordx4 a[136:139], v2, s[4:7], s23 offen offset:0 sc1
buffer_load_dwordx4 a[140:143], v2, s[4:7], s23 offen offset:1024 sc1
buffer_load_dwordx4 a[144:147], v2, s[4:7], s23 offen offset:2048 sc1
buffer_load_dwordx4 a[148:151], v2, s[4:7], s23 offen offset:3072 sc1
buffer_load_dwordx4 a[152:155], v3, s[4:7], s23 offen offset:0 sc1
buffer_load_dwordx4 a[156:159], v3, s[4:7], s23 offen offset:1024 sc1
buffer_load_dwordx4 a[160:163], v3, s[4:7], s23 offen offset:2048 sc1
buffer_load_dwordx4 a[164:167], v3, s[4:7], s23 offen offset:3072 sc1
buffer_load_dwordx4 a[216:219], v92, s[4:7], s61 offen offset:0 sc1
buffer_load_dwordx4 a[220:223], v92, s[4:7], s61 offen offset:512 sc1
buffer_load_dwordx4 a[224:227], v92, s[4:7], s61 offen offset:1024 sc1
buffer_load_dwordx4 a[228:231], v92, s[4:7], s61 offen offset:1536 sc1
buffer_load_dwordx4 a[232:235], v92, s[4:7], s61 offen offset:2048 sc1
buffer_load_dwordx4 a[236:239], v92, s[4:7], s61 offen offset:2560 sc1
buffer_load_dwordx4 a[168:171], v1, s[4:7], s60 offen offset:0 sc1
buffer_load_dwordx4 a[172:175], v1, s[4:7], s60 offen offset:1024 sc1
buffer_load_dwordx4 a[176:179], v1, s[4:7], s60 offen offset:2048 sc1
buffer_load_dwordx4 a[180:183], v1, s[4:7], s60 offen offset:3072 sc1
buffer_load_dwordx4 a[184:187], v2, s[4:7], s60 offen offset:0 sc1
buffer_load_dwordx4 a[188:191], v2, s[4:7], s60 offen offset:1024 sc1
buffer_load_dwordx4 a[192:195], v2, s[4:7], s60 offen offset:2048 sc1
buffer_load_dwordx4 a[196:199], v2, s[4:7], s60 offen offset:3072 sc1
buffer_load_dwordx4 a[200:203], v3, s[4:7], s60 offen offset:0 sc1
buffer_load_dwordx4 a[204:207], v3, s[4:7], s60 offen offset:1024 sc1
buffer_load_dwordx4 a[208:211], v3, s[4:7], s60 offen offset:2048 sc1
buffer_load_dwordx4 a[212:215], v3, s[4:7], s60 offen offset:3072 sc1
s_waitcnt vmcnt(5)
v_mfma_f32_16x16x32_bf16 v[128:131], a[216:219], a[168:171], v[84:87]
v_mfma_f32_16x16x32_bf16 v[132:135], a[120:123], a[168:171], v[88:91]
v_mfma_f32_16x16x32_bf16 v[136:139], a[216:219], a[192:195], v[84:87]
v_mfma_f32_16x16x32_bf16 v[140:143], a[120:123], a[192:195], 0
v_mfma_f32_16x16x32_bf16 v[144:147], a[144:147], a[192:195], v[88:91]
s_waitcnt vmcnt(4)
v_mfma_f32_16x16x32_bf16 v[128:131], a[220:223], a[172:175], v[128:131]
v_mfma_f32_16x16x32_bf16 v[132:135], a[124:127], a[172:175], v[132:135]
v_mfma_f32_16x16x32_bf16 v[136:139], a[220:223], a[196:199], v[136:139]
v_mfma_f32_16x16x32_bf16 v[140:143], a[124:127], a[196:199], v[140:143]
v_mfma_f32_16x16x32_bf16 v[144:147], a[148:151], a[196:199], v[144:147]
s_waitcnt vmcnt(3)
v_mfma_f32_16x16x32_bf16 v[128:131], a[224:227], a[176:179], v[128:131]
v_mfma_f32_16x16x32_bf16 v[132:135], a[128:131], a[176:179], v[132:135]
v_mfma_f32_16x16x32_bf16 v[136:139], a[224:227], a[200:203], v[136:139]
v_mfma_f32_16x16x32_bf16 v[140:143], a[128:131], a[200:203], v[140:143]
v_mfma_f32_16x16x32_bf16 v[144:147], a[152:155], a[200:203], v[144:147]
s_waitcnt vmcnt(2)
v_mfma_f32_16x16x32_bf16 v[128:131], a[228:231], a[180:183], v[128:131]
v_mfma_f32_16x16x32_bf16 v[132:135], a[132:135], a[180:183], v[132:135]
v_mfma_f32_16x16x32_bf16 v[136:139], a[228:231], a[204:207], v[136:139]
v_mfma_f32_16x16x32_bf16 v[140:143], a[132:135], a[204:207], v[140:143]
v_mfma_f32_16x16x32_bf16 v[144:147], a[156:159], a[204:207], v[144:147]
s_waitcnt vmcnt(1)
v_mfma_f32_16x16x32_bf16 v[128:131], a[232:235], a[184:187], v[128:131]
v_mfma_f32_16x16x32_bf16 v[132:135], a[136:139], a[184:187], v[132:135]
v_mfma_f32_16x16x32_bf16 v[136:139], a[232:235], a[208:211], v[136:139]
v_mfma_f32_16x16x32_bf16 v[140:143], a[136:139], a[208:211], v[140:143]
v_mfma_f32_16x16x32_bf16 v[144:147], a[160:163], a[208:211], v[144:147]
s_waitcnt vmcnt(0)
v_mfma_f32_16x16x32_bf16 v[128:131], a[236:239], a[188:191], v[128:131]
v_mfma_f32_16x16x32_bf16 v[132:135], a[140:143], a[188:191], v[132:135]
v_mfma_f32_16x16x32_bf16 v[136:139], a[236:239], a[212:215], v[136:139]
v_mfma_f32_16x16x32_bf16 v[140:143], a[140:143], a[212:215], v[140:143]
v_mfma_f32_16x16x32_bf16 v[144:147], a[164:167], a[212:215], v[144:147]
s_nop 3
v_max3_f32 v28, v128, v129, v130
v_max3_f32 v28, v28, v131, v132
v_max3_f32 v28, v28, v133, v134
v_max_f32 v28, v28, v135
v_mov_b32 v29, v28
s_nop 1
v_permlane32_swap_b32 v28, v29
v_max_f32 v28, v28, v29
v_mov_b32 v29, v28
s_nop 1
v_permlane16_swap_b32 v28, v29
v_max_f32 v28, v28, v29
v_mul_f32 v28, s41, v28
v_fma_f32 v128, v128, s41, -v28
v_fma_f32 v129, v129, s41, -v28
v_fma_f32 v130, v130, s41, -v28
v_fma_f32 v131, v131, s41, -v28
v_fma_f32 v132, v132, s41, -v28
v_fma_f32 v133, v133, s41, -v28
v_fma_f32 v134, v134, s41, -v28
v_fma_f32 v135, v135, s41, -v28
v_exp_f32 v128, v128
v_exp_f32 v129, v129
v_exp_f32 v130, v130
v_exp_f32 v131, v131
v_exp_f32 v132, v132
v_exp_f32 v133, v133
v_exp_f32 v134, v134
v_exp_f32 v135, v135
v_max3_f32 v30, v136, v137, v138
v_max3_f32 v30, v30, v139, v140
v_max3_f32 v30, v30, v141, v142
v_max3_f32 v30, v30, v143, v144
v_max3_f32 v30, v30, v145, v146
v_max_f32 v30, v30, v147
v_mov_b32 v29, v30
s_nop 1
v_permlane32_swap_b32 v30, v29
v_max_f32 v30, v30, v29
v_mov_b32 v29, v30
s_nop 1
v_permlane16_swap_b32 v30, v29
v_max_f32 v30, v30, v29
v_mul_f32 v30, s41, v30
v_fma_f32 v136, v136, s41, -v30
v_fma_f32 v137, v137, s41, -v30
v_fma_f32 v138, v138, s41, -v30
v_fma_f32 v139, v139, s41, -v30
v_fma_f32 v140, v140, s41, -v30
v_fma_f32 v141, v141, s41, -v30
v_fma_f32 v142, v142, s41, -v30
v_fma_f32 v143, v143, s41, -v30
v_fma_f32 v144, v144, s41, -v30
v_fma_f32 v145, v145, s41, -v30
v_fma_f32 v146, v146, s41, -v30
v_fma_f32 v147, v147, s41, -v30
v_exp_f32 v136, v136
v_exp_f32 v137, v137
v_exp_f32 v138, v138
v_exp_f32 v139, v139
v_exp_f32 v140, v140
v_exp_f32 v141, v141
v_exp_f32 v142, v142
v_exp_f32 v143, v143
v_exp_f32 v144, v144
v_exp_f32 v145, v145
v_exp_f32 v146, v146
v_exp_f32 v147, v147
v_cvt_pk_bf16_f32 v72, v128, v129
v_cvt_pk_bf16_f32 v73, v130, v131
v_cvt_pk_bf16_f32 v74, v132, v133
v_cvt_pk_bf16_f32 v75, v134, v135
v_cvt_pk_bf16_f32 v76, v136, v137
v_cvt_pk_bf16_f32 v77, v138, v139
v_cvt_pk_bf16_f32 v78, v140, v141
v_cvt_pk_bf16_f32 v79, v142, v143
v_cvt_pk_bf16_f32 v80, v144, v145
v_cvt_pk_bf16_f32 v81, v146, v147
v_mfma_f32_16x16x16_bf16 v[148:151], v[36:37], v[72:73], 0
v_mfma_f32_16x16x16_bf16 v[152:155], v[36:37], v[76:77], 0
v_mfma_f32_16x16x16_bf16 v[148:151], v[36:37], v[74:75], v[148:151]
v_mfma_f32_16x16x32_bf16 v[152:155], v[36:39], v[78:81], v[152:155]
s_nop 6
v_rcp_f32 v82, v148
v_rcp_f32 v83, v152
s_and_b32 s34, s17, 1
s_mul_i32 s34, s34, 3072
v_add_u32 v28, s34, v1
ds_write_b128 v28, v[72:75] offset:16384
ds_write_b128 v28, v[76:79] offset:17408
ds_write_b128 v28, v[80:83] offset:18432
s_waitcnt lgkmcnt(0)
s_branch reca_b5207
reca_tw1208:
s_cmp_lt_u32 s17, 3
s_cbranch_scc1 reca_b5207
s_sub_u32 s36, s17, 3
s_and_b32 s37, s36, 7
s_lshl_b32 s34, s59, 3
s_add_u32 s34, s34, s37
s_mul_i32 s34, s34, 12288
s_add_u32 s23, s34, 40894464
s_lshl_b32 s35, s37, 5
s_add_u32 s35, s35, s59
s_mul_i32 s35, s35, 3072
s_add_u32 s61, s35, 47972352
s_mul_i32 s34, s36, 393216
s_mul_i32 s35, s59, 6144
s_add_u32 s34, s34, s35
s_add_u32 s60, s34, 57147392
s_add_u32 s34, s17, 1
s_and_b32 s34, s34, 1
s_mul_i32 s34, s34, 3072
v_add_u32 v28, s34, v1
ds_read_b128 v[72:75], v28 offset:16384
ds_read_b128 v[76:79], v28 offset:17408
ds_read_b128 v[80:83], v28 offset:18432
buffer_load_dwordx2 a[168:169], v93, s[4:7], s61 offen offset:0 sc1
buffer_load_dwordx4 a[120:123], v1, s[4:7], s23 offen offset:0 sc1
buffer_load_dwordx2 a[170:171], v93, s[4:7], s61 offen offset:256 sc1
buffer_load_dwordx4 a[124:127], v1, s[4:7], s23 offen offset:1024 sc1
buffer_load_dwordx2 a[172:173], v93, s[4:7], s61 offen offset:512 sc1
buffer_load_dwordx4 a[128:131], v1, s[4:7], s23 offen offset:2048 sc1
buffer_load_dwordx2 a[174:175], v93, s[4:7], s61 offen offset:768 sc1
buffer_load_dwordx4 a[132:135], v1, s[4:7], s23 offen offset:3072 sc1
buffer_load_dwordx2 a[176:177], v93, s[4:7], s61 offen offset:1024 sc1
buffer_load_dwordx4 a[136:139], v2, s[4:7], s23 offen offset:0 sc1
buffer_load_dwordx2 a[178:179], v93, s[4:7], s61 offen offset:1280 sc1
buffer_load_dwordx4 a[140:143], v2, s[4:7], s23 offen offset:1024 sc1
s_waitcnt lgkmcnt(0)
s_waitcnt vmcnt(8)
v_mfma_f32_16x16x16_bf16 v[156:159], a[168:169], v[72:73], 0
v_mfma_f32_16x16x16_bf16 v[160:163], a[168:169], v[76:77], 0
v_mfma_f32_16x16x16_bf16 v[156:159], a[120:121], v[74:75], v[156:159]
v_mfma_f32_16x16x32_bf16 v[160:163], a[120:123], v[78:81], v[160:163]
v_mfma_f32_16x16x16_bf16 v[164:167], a[170:171], v[72:73], 0
v_mfma_f32_16x16x16_bf16 v[168:171], a[170:171], v[76:77], 0
v_mfma_f32_16x16x16_bf16 v[164:167], a[124:125], v[74:75], v[164:167]
v_mfma_f32_16x16x32_bf16 v[168:171], a[124:127], v[78:81], v[168:171]
s_nop 2
v_mul_f32 v156, v156, v82
v_mul_f32 v157, v157, v82
v_mul_f32 v158, v158, v82
v_mul_f32 v159, v159, v82
v_cvt_pk_bf16_f32 v172, v156, v157
v_cvt_pk_bf16_f32 v173, v158, v159
v_mul_f32 v164, v164, v82
v_mul_f32 v165, v165, v82
v_mul_f32 v166, v166, v82
v_mul_f32 v167, v167, v82
v_cvt_pk_bf16_f32 v174, v164, v165
v_cvt_pk_bf16_f32 v175, v166, v167
buffer_store_dwordx4 v[172:175], v1, s[4:7], s60 offen offset:0 sc1
v_mul_f32 v160, v160, v83
v_mul_f32 v161, v161, v83
v_mul_f32 v162, v162, v83
v_mul_f32 v163, v163, v83
v_cvt_pk_bf16_f32 v176, v160, v161
v_cvt_pk_bf16_f32 v177, v162, v163
v_mul_f32 v168, v168, v83
v_mul_f32 v169, v169, v83
v_mul_f32 v170, v170, v83
v_mul_f32 v171, v171, v83
v_cvt_pk_bf16_f32 v178, v168, v169
v_cvt_pk_bf16_f32 v179, v170, v171
s_add_u32 s34, s60, 196608
buffer_store_dwordx4 v[176:179], v1, s[4:7], s34 offen offset:0 sc1
s_waitcnt vmcnt(6)
v_mfma_f32_16x16x16_bf16 v[156:159], a[172:173], v[72:73], 0
v_mfma_f32_16x16x16_bf16 v[160:163], a[172:173], v[76:77], 0
v_mfma_f32_16x16x16_bf16 v[156:159], a[128:129], v[74:75], v[156:159]
v_mfma_f32_16x16x32_bf16 v[160:163], a[128:131], v[78:81], v[160:163]
v_mfma_f32_16x16x16_bf16 v[164:167], a[174:175], v[72:73], 0
v_mfma_f32_16x16x16_bf16 v[168:171], a[174:175], v[76:77], 0
v_mfma_f32_16x16x16_bf16 v[164:167], a[132:133], v[74:75], v[164:167]
v_mfma_f32_16x16x32_bf16 v[168:171], a[132:135], v[78:81], v[168:171]
s_nop 2
v_mul_f32 v156, v156, v82
v_mul_f32 v157, v157, v82
v_mul_f32 v158, v158, v82
v_mul_f32 v159, v159, v82
v_cvt_pk_bf16_f32 v172, v156, v157
v_cvt_pk_bf16_f32 v173, v158, v159
v_mul_f32 v164, v164, v82
v_mul_f32 v165, v165, v82
v_mul_f32 v166, v166, v82
v_mul_f32 v167, v167, v82
v_cvt_pk_bf16_f32 v174, v164, v165
v_cvt_pk_bf16_f32 v175, v166, v167
buffer_store_dwordx4 v[172:175], v1, s[4:7], s60 offen offset:1024 sc1
v_mul_f32 v160, v160, v83
v_mul_f32 v161, v161, v83
v_mul_f32 v162, v162, v83
v_mul_f32 v163, v163, v83
v_cvt_pk_bf16_f32 v176, v160, v161
v_cvt_pk_bf16_f32 v177, v162, v163
v_mul_f32 v168, v168, v83
v_mul_f32 v169, v169, v83
v_mul_f32 v170, v170, v83
v_mul_f32 v171, v171, v83
v_cvt_pk_bf16_f32 v178, v168, v169
v_cvt_pk_bf16_f32 v179, v170, v171
s_add_u32 s34, s60, 196608
buffer_store_dwordx4 v[176:179], v1, s[4:7], s34 offen offset:1024 sc1
s_waitcnt vmcnt(4)
v_mfma_f32_16x16x16_bf16 v[156:159], a[176:177], v[72:73], 0
v_mfma_f32_16x16x16_bf16 v[160:163], a[176:177], v[76:77], 0
v_mfma_f32_16x16x16_bf16 v[156:159], a[136:137], v[74:75], v[156:159]
v_mfma_f32_16x16x32_bf16 v[160:163], a[136:139], v[78:81], v[160:163]
v_mfma_f32_16x16x16_bf16 v[164:167], a[178:179], v[72:73], 0
v_mfma_f32_16x16x16_bf16 v[168:171], a[178:179], v[76:77], 0
v_mfma_f32_16x16x16_bf16 v[164:167], a[140:141], v[74:75], v[164:167]
v_mfma_f32_16x16x32_bf16 v[168:171], a[140:143], v[78:81], v[168:171]
s_nop 2
v_mul_f32 v156, v156, v82
v_mul_f32 v157, v157, v82
v_mul_f32 v158, v158, v82
v_mul_f32 v159, v159, v82
v_cvt_pk_bf16_f32 v172, v156, v157
v_cvt_pk_bf16_f32 v173, v158, v159
v_mul_f32 v164, v164, v82
v_mul_f32 v165, v165, v82
v_mul_f32 v166, v166, v82
v_mul_f32 v167, v167, v82
v_cvt_pk_bf16_f32 v174, v164, v165
v_cvt_pk_bf16_f32 v175, v166, v167
buffer_store_dwordx4 v[172:175], v1, s[4:7], s60 offen offset:2048 sc1
v_mul_f32 v160, v160, v83
v_mul_f32 v161, v161, v83
v_mul_f32 v162, v162, v83
v_mul_f32 v163, v163, v83
v_cvt_pk_bf16_f32 v176, v160, v161
v_cvt_pk_bf16_f32 v177, v162, v163
v_mul_f32 v168, v168, v83
v_mul_f32 v169, v169, v83
v_mul_f32 v170, v170, v83
v_mul_f32 v171, v171, v83
v_cvt_pk_bf16_f32 v178, v168, v169
v_cvt_pk_bf16_f32 v179, v170, v171
s_add_u32 s34, s60, 196608
buffer_store_dwordx4 v[176:179], v1, s[4:7], s34 offen offset:2048 sc1
s_branch reca_b5207
reca_tw2209:
s_cmp_lt_u32 s17, 3
s_cbranch_scc1 reca_b5207
s_sub_u32 s36, s17, 3
s_and_b32 s37, s36, 7
s_lshl_b32 s34, s59, 3
s_add_u32 s34, s34, s37
s_mul_i32 s34, s34, 12288
s_add_u32 s23, s34, 40894464
s_lshl_b32 s35, s37, 5
s_add_u32 s35, s35, s59
s_mul_i32 s35, s35, 3072
s_add_u32 s61, s35, 47972352
s_mul_i32 s34, s36, 393216
s_mul_i32 s35, s59, 6144
s_add_u32 s34, s34, s35
s_add_u32 s60, s34, 57147392
s_add_u32 s34, s17, 1
s_and_b32 s34, s34, 1
s_mul_i32 s34, s34, 3072
v_add_u32 v28, s34, v1
ds_read_b128 v[72:75], v28 offset:16384
ds_read_b128 v[76:79], v28 offset:17408
ds_read_b128 v[80:83], v28 offset:18432
buffer_load_dwordx2 a[180:181], v93, s[4:7], s61 offen offset:1536 sc1
buffer_load_dwordx4 a[144:147], v2, s[4:7], s23 offen offset:2048 sc1
buffer_load_dwordx2 a[182:183], v93, s[4:7], s61 offen offset:1792 sc1
buffer_load_dwordx4 a[148:151], v2, s[4:7], s23 offen offset:3072 sc1
buffer_load_dwordx2 a[184:185], v93, s[4:7], s61 offen offset:2048 sc1
buffer_load_dwordx4 a[152:155], v3, s[4:7], s23 offen offset:0 sc1
buffer_load_dwordx2 a[186:187], v93, s[4:7], s61 offen offset:2304 sc1
buffer_load_dwordx4 a[156:159], v3, s[4:7], s23 offen offset:1024 sc1
buffer_load_dwordx2 a[188:189], v93, s[4:7], s61 offen offset:2560 sc1
buffer_load_dwordx4 a[160:163], v3, s[4:7], s23 offen offset:2048 sc1
buffer_load_dwordx2 a[190:191], v93, s[4:7], s61 offen offset:2816 sc1
buffer_load_dwordx4 a[164:167], v3, s[4:7], s23 offen offset:3072 sc1
s_waitcnt lgkmcnt(0)
s_waitcnt vmcnt(8)
v_mfma_f32_16x16x16_bf16 v[156:159], a[180:181], v[72:73], 0
v_mfma_f32_16x16x16_bf16 v[160:163], a[180:181], v[76:77], 0
v_mfma_f32_16x16x16_bf16 v[156:159], a[144:145], v[74:75], v[156:159]
v_mfma_f32_16x16x32_bf16 v[160:163], a[144:147], v[78:81], v[160:163]
v_mfma_f32_16x16x16_bf16 v[164:167], a[182:183], v[72:73], 0
v_mfma_f32_16x16x16_bf16 v[168:171], a[182:183], v[76:77], 0
v_mfma_f32_16x16x16_bf16 v[164:167], a[148:149], v[74:75], v[164:167]
v_mfma_f32_16x16x32_bf16 v[168:171], a[148:151], v[78:81], v[168:171]
s_nop 2
v_mul_f32 v156, v156, v82
v_mul_f32 v157, v157, v82
v_mul_f32 v158, v158, v82
v_mul_f32 v159, v159, v82
v_cvt_pk_bf16_f32 v172, v156, v157
v_cvt_pk_bf16_f32 v173, v158, v159
v_mul_f32 v164, v164, v82
v_mul_f32 v165, v165, v82
v_mul_f32 v166, v166, v82
v_mul_f32 v167, v167, v82
v_cvt_pk_bf16_f32 v174, v164, v165
v_cvt_pk_bf16_f32 v175, v166, v167
buffer_store_dwordx4 v[172:175], v1, s[4:7], s60 offen offset:3072 sc1
v_mul_f32 v160, v160, v83
v_mul_f32 v161, v161, v83
v_mul_f32 v162, v162, v83
v_mul_f32 v163, v163, v83
v_cvt_pk_bf16_f32 v176, v160, v161
v_cvt_pk_bf16_f32 v177, v162, v163
v_mul_f32 v168, v168, v83
v_mul_f32 v169, v169, v83
v_mul_f32 v170, v170, v83
v_mul_f32 v171, v171, v83
v_cvt_pk_bf16_f32 v178, v168, v169
v_cvt_pk_bf16_f32 v179, v170, v171
s_add_u32 s34, s60, 196608
buffer_store_dwordx4 v[176:179], v1, s[4:7], s34 offen offset:3072 sc1
s_waitcnt vmcnt(6)
v_mfma_f32_16x16x16_bf16 v[156:159], a[184:185], v[72:73], 0
v_mfma_f32_16x16x16_bf16 v[160:163], a[184:185], v[76:77], 0
v_mfma_f32_16x16x16_bf16 v[156:159], a[152:153], v[74:75], v[156:159]
v_mfma_f32_16x16x32_bf16 v[160:163], a[152:155], v[78:81], v[160:163]
v_mfma_f32_16x16x16_bf16 v[164:167], a[186:187], v[72:73], 0
v_mfma_f32_16x16x16_bf16 v[168:171], a[186:187], v[76:77], 0
v_mfma_f32_16x16x16_bf16 v[164:167], a[156:157], v[74:75], v[164:167]
v_mfma_f32_16x16x32_bf16 v[168:171], a[156:159], v[78:81], v[168:171]
s_nop 2
v_mul_f32 v156, v156, v82
v_mul_f32 v157, v157, v82
v_mul_f32 v158, v158, v82
v_mul_f32 v159, v159, v82
v_cvt_pk_bf16_f32 v172, v156, v157
v_cvt_pk_bf16_f32 v173, v158, v159
v_mul_f32 v164, v164, v82
v_mul_f32 v165, v165, v82
v_mul_f32 v166, v166, v82
v_mul_f32 v167, v167, v82
v_cvt_pk_bf16_f32 v174, v164, v165
v_cvt_pk_bf16_f32 v175, v166, v167
buffer_store_dwordx4 v[172:175], v2, s[4:7], s60 offen offset:0 sc1
v_mul_f32 v160, v160, v83
v_mul_f32 v161, v161, v83
v_mul_f32 v162, v162, v83
v_mul_f32 v163, v163, v83
v_cvt_pk_bf16_f32 v176, v160, v161
v_cvt_pk_bf16_f32 v177, v162, v163
v_mul_f32 v168, v168, v83
v_mul_f32 v169, v169, v83
v_mul_f32 v170, v170, v83
v_mul_f32 v171, v171, v83
v_cvt_pk_bf16_f32 v178, v168, v169
v_cvt_pk_bf16_f32 v179, v170, v171
s_add_u32 s34, s60, 196608
buffer_store_dwordx4 v[176:179], v2, s[4:7], s34 offen offset:0 sc1
s_waitcnt vmcnt(4)
v_mfma_f32_16x16x16_bf16 v[156:159], a[188:189], v[72:73], 0
v_mfma_f32_16x16x16_bf16 v[160:163], a[188:189], v[76:77], 0
v_mfma_f32_16x16x16_bf16 v[156:159], a[160:161], v[74:75], v[156:159]
v_mfma_f32_16x16x32_bf16 v[160:163], a[160:163], v[78:81], v[160:163]
v_mfma_f32_16x16x16_bf16 v[164:167], a[190:191], v[72:73], 0
v_mfma_f32_16x16x16_bf16 v[168:171], a[190:191], v[76:77], 0
v_mfma_f32_16x16x16_bf16 v[164:167], a[164:165], v[74:75], v[164:167]
v_mfma_f32_16x16x32_bf16 v[168:171], a[164:167], v[78:81], v[168:171]
s_nop 2
v_mul_f32 v156, v156, v82
v_mul_f32 v157, v157, v82
v_mul_f32 v158, v158, v82
v_mul_f32 v159, v159, v82
v_cvt_pk_bf16_f32 v172, v156, v157
v_cvt_pk_bf16_f32 v173, v158, v159
v_mul_f32 v164, v164, v82
v_mul_f32 v165, v165, v82
v_mul_f32 v166, v166, v82
v_mul_f32 v167, v167, v82
v_cvt_pk_bf16_f32 v174, v164, v165
v_cvt_pk_bf16_f32 v175, v166, v167
buffer_store_dwordx4 v[172:175], v2, s[4:7], s60 offen offset:1024 sc1
v_mul_f32 v160, v160, v83
v_mul_f32 v161, v161, v83
v_mul_f32 v162, v162, v83
v_mul_f32 v163, v163, v83
v_cvt_pk_bf16_f32 v176, v160, v161
v_cvt_pk_bf16_f32 v177, v162, v163
v_mul_f32 v168, v168, v83
v_mul_f32 v169, v169, v83
v_mul_f32 v170, v170, v83
v_mul_f32 v171, v171, v83
v_cvt_pk_bf16_f32 v178, v168, v169
v_cvt_pk_bf16_f32 v179, v170, v171
s_add_u32 s34, s60, 196608
buffer_store_dwordx4 v[176:179], v2, s[4:7], s34 offen offset:1024 sc1
s_branch reca_b5207
s_cmp_lg_u32 s12, 2
s_cbranch_scc1 reca_b3205
buffer_store_dwordx2 v[52:53], v9, s[4:7], s30 offen sc1
buffer_store_dwordx2 v[32:33], v16, s[4:7], s26 offen sc1
s_cmp_lg_u32 s14, 0
s_cbranch_scc1 reca_b3205
v_mov_b32 v28, s17
s_lshl_b32 s34, s13, 7
s_add_u32 s34, s34, 1507328
buffer_store_dword v28, v19, s[4:7], s34 offen sc1
s_branch reca_b3205
reca_last204:
s_cmp_lg_u32 s12, 2
s_cbranch_scc1 reca_exit1
buffer_store_dwordx2 v[52:53], v9, s[4:7], s30 offen
s_branch reca_exit1
reca_swave202:
s_cmp_lg_u32 s17, 63
s_cbranch_scc1 reca_vmst210
s_barrier
ds_read_b128 v[56:59], v1 offset:10240
ds_read_b128 v[60:63], v1 offset:11264
ds_read_b128 v[64:67], v1 offset:12288
s_waitcnt lgkmcnt(0)
v_add_f32 v56, v56, v64
v_add_f32 v60, v60, v48
v_add_f32 v57, v57, v65
v_add_f32 v61, v61, v49
v_add_f32 v58, v58, v66
v_add_f32 v62, v62, v50
v_add_f32 v59, v59, v67
v_add_f32 v63, v63, v51
v_cvt_pk_bf16_f32 v68, v56, v57
v_cvt_pk_bf16_f32 v69, v58, v59
v_cvt_pk_bf16_f32 v70, v60, v61
v_cvt_pk_bf16_f32 v71, v62, v63
buffer_store_dwordx2 v[52:53], v9, s[4:7], s30 offen
buffer_store_dwordx2 v[68:69], v10, s[4:7], s31 offen
buffer_store_dwordx2 v[70:71], v10, s[4:7], s31 offen offset:256
s_branch reca_exit1
reca_vmst210:
s_sleep 1
buffer_load_dwordx4 v[208:211], v1, s[4:7], s21 offen offset:0 sc1
buffer_load_dwordx4 v[212:215], v1, s[4:7], s21 offen offset:1024 sc1
buffer_load_dwordx4 v[216:219], v1, s[4:7], s21 offen offset:2048 sc1
buffer_load_dwordx4 v[220:223], v1, s[4:7], s21 offen offset:3072 sc1
buffer_load_dwordx4 v[224:227], v2, s[4:7], s21 offen offset:0 sc1
buffer_load_dwordx4 v[228:231], v2, s[4:7], s21 offen offset:1024 sc1
s_waitcnt vmcnt(5)
v_max_u32 v29, v208, v210
v_cmp_eq_u32 vcc, -1, v29
s_cbranch_vccnz reca_retry211
reca_resume212:
s_waitcnt vmcnt(4)
v_max_u32 v29, v212, v214
v_cmp_eq_u32 vcc, -1, v29
v_mfma_f32_16x16x32_bf16 v[76:79], a[120:123], v[208:211], 0
v_mfma_f32_16x16x32_bf16 v[80:83], a[144:147], v[208:211], 0
v_mfma_f32_16x16x32_bf16 v[72:75], v[208:211], v[208:211], v[40:43]
s_cbranch_vccnz reca_retry213
reca_resume214:
s_waitcnt vmcnt(3)
v_max_u32 v29, v216, v218
v_cmp_eq_u32 vcc, -1, v29
v_mfma_f32_16x16x32_bf16 v[76:79], a[124:127], v[212:215], v[76:79]
v_mfma_f32_16x16x32_bf16 v[80:83], a[148:151], v[212:215], v[80:83]
v_mfma_f32_16x16x32_bf16 v[72:75], v[212:215], v[212:215], v[72:75]
s_cbranch_vccnz reca_retry215
reca_resume216:
s_waitcnt vmcnt(2)
v_max_u32 v29, v220, v222
v_cmp_eq_u32 vcc, -1, v29
v_mfma_f32_16x16x32_bf16 v[76:79], a[128:131], v[216:219], v[76:79]
v_mfma_f32_16x16x32_bf16 v[80:83], a[152:155], v[216:219], v[80:83]
v_mfma_f32_16x16x32_bf16 v[72:75], v[216:219], v[216:219], v[72:75]
s_cbranch_vccnz reca_retry217
reca_resume218:
s_waitcnt vmcnt(1)
v_max_u32 v29, v224, v226
v_cmp_eq_u32 vcc, -1, v29
v_mfma_f32_16x16x32_bf16 v[76:79], a[132:135], v[220:223], v[76:79]
v_mfma_f32_16x16x32_bf16 v[80:83], a[156:159], v[220:223], v[80:83]
v_mfma_f32_16x16x32_bf16 v[72:75], v[220:223], v[220:223], v[72:75]
s_cbranch_vccnz reca_retry219
reca_resume220:
s_waitcnt vmcnt(0)
v_max_u32 v29, v228, v230
v_cmp_eq_u32 vcc, -1, v29
v_mfma_f32_16x16x32_bf16 v[76:79], a[136:139], v[224:227], v[76:79]
v_mfma_f32_16x16x32_bf16 v[80:83], a[160:163], v[224:227], v[80:83]
v_mfma_f32_16x16x32_bf16 v[72:75], v[224:227], v[224:227], v[72:75]
s_cbranch_vccnz reca_retry221
reca_resume222:
v_mfma_f32_16x16x32_bf16 v[76:79], a[140:143], v[228:231], v[76:79]
v_mfma_f32_16x16x32_bf16 v[80:83], a[164:167], v[228:231], v[80:83]
v_mfma_f32_16x16x32_bf16 v[72:75], v[228:231], v[228:231], v[72:75]
s_barrier
ds_read_b128 v[56:59], v1 offset:10240
ds_read_b128 v[60:63], v1 offset:11264
ds_read_b128 v[64:67], v1 offset:12288
s_nop 1
v_max3_f32 v28, v76, v77, v78
v_max3_f32 v29, v80, v81, v82
v_max3_f32 v28, v28, v79, v83
v_max3_f32 v29, v29, v72, v73
v_max3_f32 v28, v28, v74, v75
v_max_f32 v28, v28, v29
v_mov_b32 v29, v28
s_nop 1
v_permlane32_swap_b32 v28, v29
v_max_f32 v28, v28, v29
v_mov_b32 v29, v28
s_nop 1
v_permlane16_swap_b32 v28, v29
v_max_f32 v28, v28, v29
v_mul_f32 v28, s41, v28
v_fma_f32 v76, v76, s41, -v28
v_fma_f32 v77, v77, s41, -v28
v_fma_f32 v78, v78, s41, -v28
v_fma_f32 v79, v79, s41, -v28
v_fma_f32 v80, v80, s41, -v28
v_fma_f32 v81, v81, s41, -v28
v_fma_f32 v82, v82, s41, -v28
v_fma_f32 v83, v83, s41, -v28
v_fma_f32 v72, v72, s41, -v28
v_fma_f32 v73, v73, s41, -v28
v_fma_f32 v74, v74, s41, -v28
v_fma_f32 v75, v75, s41, -v28
v_exp_f32 v76, v76
v_exp_f32 v77, v77
v_exp_f32 v78, v78
v_exp_f32 v79, v79
v_exp_f32 v80, v80
v_exp_f32 v81, v81
v_exp_f32 v82, v82
v_exp_f32 v83, v83
v_cvt_pk_bf16_f32 v84, v76, v77
v_cvt_pk_bf16_f32 v85, v78, v79
v_cvt_pk_bf16_f32 v86, v80, v81
v_cvt_pk_bf16_f32 v87, v82, v83
v_exp_f32 v72, v72
v_exp_f32 v73, v73
v_mfma_f32_16x16x32_bf16 v[100:103], v[36:39], v[84:87], 0
v_exp_f32 v74, v74
v_exp_f32 v75, v75
v_mfma_f32_16x16x32_bf16 v[92:95], a[168:171], v[84:87], 0
v_cvt_pk_bf16_f32 v88, v72, v73
v_cvt_pk_bf16_f32 v89, v74, v75
v_mfma_f32_16x16x32_bf16 v[96:99], a[172:175], v[84:87], 0
s_waitcnt lgkmcnt(0)
v_mfma_f32_16x16x16_bf16 v[100:103], v[36:37], v[88:89], v[100:103]
v_add_f32 v56, v56, v64
v_add_f32 v60, v60, v48
v_add_f32 v57, v57, v65
v_add_f32 v61, v61, v49
v_add_f32 v58, v58, v66
v_add_f32 v62, v62, v50
v_add_f32 v59, v59, v67
v_add_f32 v63, v63, v51
v_cvt_pk_bf16_f32 v68, v56, v57
v_cvt_pk_bf16_f32 v69, v58, v59
v_cvt_pk_bf16_f32 v70, v60, v61
v_cvt_pk_bf16_f32 v71, v62, v63
v_mfma_f32_16x16x16_bf16 v[92:95], v[68:69], v[88:89], v[92:95]
v_rcp_f32 v28, v100
v_mfma_f32_16x16x16_bf16 v[96:99], v[70:71], v[88:89], v[96:99]
v_mov_b32 v29, v28
s_nop 4
v_pk_mul_f32 v[92:93], v[92:93], v[28:29]
v_pk_mul_f32 v[94:95], v[94:95], v[28:29]
v_pk_mul_f32 v[96:97], v[96:97], v[28:29]
v_pk_mul_f32 v[98:99], v[98:99], v[28:29]
v_cvt_pk_bf16_f32 v104, v92, v93
v_cvt_pk_bf16_f32 v105, v94, v95
v_cvt_pk_bf16_f32 v106, v96, v97
v_cvt_pk_bf16_f32 v107, v98, v99
buffer_store_dwordx4 v[104:107], v11, s[4:7], s22 offen sc1
s_barrier
s_add_u32 s34, s17, 2
s_and_b32 s34, s34, 3
s_mul_i32 s26, s34, 10240
s_add_u32 s26, s26, s38
s_mul_i32 s27, s34, 6144
s_add_u32 s27, s27, s39
s_mul_i32 s28, s34, 12288
s_add_u32 s28, s28, s40
s_mul_i32 s29, s34, 393216
s_add_u32 s29, s29, s56
buffer_store_dwordx2 v[32:33], v8, s[4:7], s27 offen sc1
buffer_store_dwordx4 v[32:35], v11, s[4:7], s28 offen sc1
s_add_u32 s36, s17, 1
s_cmp_ge_u32 s36, 63
s_cbranch_scc1 reca_nopf223
s_add_u32 s37, s36, 1
reca_pf224:
buffer_load_dword v28, v233, s[4:7], 0 offen sc1
s_waitcnt vmcnt(0)
v_cmp_gt_i32 vcc, s37, v28
s_cbranch_vccz reca_pfok225
s_sleep 1
s_sub_u32 s18, s18, 1
s_cbranch_scc0 reca_pf224
s_mov_b32 s18, 0
reca_pfok225:
s_lshl_b32 s34, s15, 3
s_and_b32 s35, s36, 7
s_add_u32 s34, s34, s35
s_mul_i32 s34, s34, 12288
s_add_u32 s32, s34, 37748736
s_lshl_b32 s35, s16, 11
s_add_u32 s34, s34, s35
s_add_u32 s33, s34, 40894464
buffer_load_dwordx4 a[120:123], v1, s[4:7], s32 offen offset:0 sc1
buffer_load_dwordx4 a[124:127], v1, s[4:7], s32 offen offset:1024 sc1
buffer_load_dwordx4 a[128:131], v1, s[4:7], s32 offen offset:2048 sc1
buffer_load_dwordx4 a[132:135], v1, s[4:7], s32 offen offset:3072 sc1
buffer_load_dwordx4 a[136:139], v2, s[4:7], s32 offen offset:0 sc1
buffer_load_dwordx4 a[140:143], v2, s[4:7], s32 offen offset:1024 sc1
buffer_load_dwordx4 a[144:147], v2, s[4:7], s32 offen offset:2048 sc1
buffer_load_dwordx4 a[148:151], v2, s[4:7], s32 offen offset:3072 sc1
buffer_load_dwordx4 a[152:155], v3, s[4:7], s32 offen offset:0 sc1
buffer_load_dwordx4 a[156:159], v3, s[4:7], s32 offen offset:1024 sc1
buffer_load_dwordx4 a[160:163], v3, s[4:7], s32 offen offset:2048 sc1
buffer_load_dwordx4 a[164:167], v3, s[4:7], s32 offen offset:3072 sc1
buffer_load_dwordx4 a[168:171], v1, s[4:7], s33 offen offset:0 sc1
buffer_load_dwordx4 a[172:175], v1, s[4:7], s33 offen offset:1024 sc1
reca_nopf223:
buffer_store_dwordx2 v[52:53], v9, s[4:7], s30 offen sc1
buffer_store_dwordx2 v[68:69], v10, s[4:7], s31 offen sc1
buffer_store_dwordx2 v[70:71], v10, s[4:7], s31 offen offset:256 sc1
reca_b5207:
s_barrier
s_add_u32 s17, s17, 1
s_branch reca_step193
reca_b3205:
s_endpgm
reca_retry196:
s_sub_u32 s18, s18, 1
s_cbranch_scc1 reca_retry196_to
buffer_load_dwordx4 v[128:131], v4, s[4:7], s20 offen sc1
buffer_load_dwordx4 v[132:135], v4, s[4:7], s20 offen offset:1024 sc1
buffer_load_dwordx4 v[136:139], v5, s[4:7], s20 offen sc1
s_waitcnt vmcnt(2)
v_max_u32 v29, v128, v130
v_cmp_eq_u32 vcc, -1, v29
s_cbranch_vccnz reca_retry196
s_branch reca_resume197
reca_retry196_to:
s_mov_b32 s18, 0
s_waitcnt vmcnt(0)
s_branch reca_resume197
reca_retry198:
s_sub_u32 s18, s18, 1
s_cbranch_scc1 reca_retry198_to
buffer_load_dwordx4 v[132:135], v4, s[4:7], s20 offen offset:1024 sc1
buffer_load_dwordx4 v[136:139], v5, s[4:7], s20 offen sc1
s_waitcnt vmcnt(1)
v_max_u32 v29, v132, v134
v_cmp_eq_u32 vcc, -1, v29
s_cbranch_vccnz reca_retry198
s_branch reca_resume199
reca_retry198_to:
s_mov_b32 s18, 0
s_waitcnt vmcnt(0)
s_branch reca_resume199
reca_retry200:
s_sub_u32 s18, s18, 1
s_cbranch_scc1 reca_retry200_to
buffer_load_dwordx4 v[136:139], v5, s[4:7], s20 offen sc1
s_waitcnt vmcnt(0)
v_max_u32 v29, v136, v138
v_cmp_eq_u32 vcc, -1, v29
s_cbranch_vccnz reca_retry200
s_branch reca_resume201
reca_retry200_to:
s_mov_b32 s18, 0
s_waitcnt vmcnt(0)
s_branch reca_resume201
reca_retry211:
s_sub_u32 s18, s18, 1
s_cbranch_scc1 reca_retry211_to
buffer_load_dwordx4 v[208:211], v1, s[4:7], s21 offen offset:0 sc1
buffer_load_dwordx4 v[212:215], v1, s[4:7], s21 offen offset:1024 sc1
buffer_load_dwordx4 v[216:219], v1, s[4:7], s21 offen offset:2048 sc1
buffer_load_dwordx4 v[220:223], v1, s[4:7], s21 offen offset:3072 sc1
buffer_load_dwordx4 v[224:227], v2, s[4:7], s21 offen offset:0 sc1
buffer_load_dwordx4 v[228:231], v2, s[4:7], s21 offen offset:1024 sc1
s_waitcnt vmcnt(5)
v_max_u32 v29, v208, v210
v_cmp_eq_u32 vcc, -1, v29
s_cbranch_vccnz reca_retry211
s_branch reca_resume212
reca_retry211_to:
s_mov_b32 s18, 0
s_waitcnt vmcnt(0)
s_branch reca_resume212
reca_retry213:
s_sub_u32 s18, s18, 1
s_cbranch_scc1 reca_retry213_to
buffer_load_dwordx4 v[212:215], v1, s[4:7], s21 offen offset:1024 sc1
buffer_load_dwordx4 v[216:219], v1, s[4:7], s21 offen offset:2048 sc1
buffer_load_dwordx4 v[220:223], v1, s[4:7], s21 offen offset:3072 sc1
buffer_load_dwordx4 v[224:227], v2, s[4:7], s21 offen offset:0 sc1
buffer_load_dwordx4 v[228:231], v2, s[4:7], s21 offen offset:1024 sc1
s_waitcnt vmcnt(4)
v_max_u32 v29, v212, v214
v_cmp_eq_u32 vcc, -1, v29
s_cbranch_vccnz reca_retry213
s_branch reca_resume214
reca_retry213_to:
s_mov_b32 s18, 0
s_waitcnt vmcnt(0)
s_branch reca_resume214
reca_retry215:
s_sub_u32 s18, s18, 1
s_cbranch_scc1 reca_retry215_to
buffer_load_dwordx4 v[216:219], v1, s[4:7], s21 offen offset:2048 sc1
buffer_load_dwordx4 v[220:223], v1, s[4:7], s21 offen offset:3072 sc1
buffer_load_dwordx4 v[224:227], v2, s[4:7], s21 offen offset:0 sc1
buffer_load_dwordx4 v[228:231], v2, s[4:7], s21 offen offset:1024 sc1
s_waitcnt vmcnt(3)
v_max_u32 v29, v216, v218
v_cmp_eq_u32 vcc, -1, v29
s_cbranch_vccnz reca_retry215
s_branch reca_resume216
reca_retry215_to:
s_mov_b32 s18, 0
s_waitcnt vmcnt(0)
s_branch reca_resume216
reca_retry217:
s_sub_u32 s18, s18, 1
s_cbranch_scc1 reca_retry217_to
buffer_load_dwordx4 v[220:223], v1, s[4:7], s21 offen offset:3072 sc1
buffer_load_dwordx4 v[224:227], v2, s[4:7], s21 offen offset:0 sc1
buffer_load_dwordx4 v[228:231], v2, s[4:7], s21 offen offset:1024 sc1
s_waitcnt vmcnt(2)
v_max_u32 v29, v220, v222
v_cmp_eq_u32 vcc, -1, v29
s_cbranch_vccnz reca_retry217
s_branch reca_resume218
reca_retry217_to:
s_mov_b32 s18, 0
s_waitcnt vmcnt(0)
s_branch reca_resume218
reca_retry219:
s_sub_u32 s18, s18, 1
s_cbranch_scc1 reca_retry219_to
buffer_load_dwordx4 v[224:227], v2, s[4:7], s21 offen offset:0 sc1
buffer_load_dwordx4 v[228:231], v2, s[4:7], s21 offen offset:1024 sc1
s_waitcnt vmcnt(1)
v_max_u32 v29, v224, v226
v_cmp_eq_u32 vcc, -1, v29
s_cbranch_vccnz reca_retry219
s_branch reca_resume220
reca_retry219_to:
s_mov_b32 s18, 0
s_waitcnt vmcnt(0)
s_branch reca_resume220
reca_retry221:
s_sub_u32 s18, s18, 1
s_cbranch_scc1 reca_retry221_to
buffer_load_dwordx4 v[228:231], v2, s[4:7], s21 offen offset:1024 sc1
s_waitcnt vmcnt(0)
v_max_u32 v29, v228, v230
v_cmp_eq_u32 vcc, -1, v29
s_cbranch_vccnz reca_retry221
s_branch reca_resume222
reca_retry221_to:
s_mov_b32 s18, 0
s_waitcnt vmcnt(0)
s_branch reca_resume222
reca_proj2:
s_sub_u32 s34, s14, 24
s_lshr_b32 s35, s34, 1
s_and_b32 s16, s34, 1
s_lshl_b32 s15, s13, 2
s_add_u32 s15, s15, s35
s_lshl_b32 s24, s13, 3
s_add_u32 s24, s24, s34
s_lshl_b32 s24, s24, 7
s_add_u32 s24, s24, 1540096
s_lshl_b32 s25, s13, 7
s_add_u32 s25, s25, 1507328
v_and_b32 v28, 63, v0
v_lshlrev_b32 v1, 4, v28
v_mov_b32 v29, 0x80000000
v_cmp_eq_u32 vcc, 0, v28
v_mov_b32 v4, 0
s_nop 0
v_cndmask_b32 v4, v29, v4, vcc
v_cmp_gt_u32 vcc, 32, v28
s_nop 1
v_cndmask_b32 v5, v29, v1, vcc
s_cmp_eq_u32 s12, 0
s_cbranch_scc1 reca_pw0_226
s_cmp_eq_u32 s12, 1
s_cbranch_scc1 reca_pw1_227
s_cmp_eq_u32 s12, 2
s_cbranch_scc1 reca_pw2_228
s_branch reca_pw3_229
reca_pw0_226:
s_mov_b32 s17, 0
s_mov_b32 s26, 0
s_mul_i32 s20, s17, 40960
s_add_u32 s20, s20, 84934656
s_add_u32 m0, s26, 0
s_nop 0
buffer_load_dwordx4 v1, s[4:7], s20 offen offset:0 lds
buffer_load_dwordx4 v1, s[4:7], s20 offen offset:1024 lds
buffer_load_dwordx4 v1, s[4:7], s20 offen offset:2048 lds
buffer_load_dwordx4 v1, s[4:7], s20 offen offset:3072 lds
s_add_u32 s20, s20, 4096
s_add_u32 m0, s26, 4096
s_nop 0
buffer_load_dwordx4 v1, s[4:7], s20 offen offset:0 lds
buffer_load_dwordx4 v1, s[4:7], s20 offen offset:1024 lds
buffer_load_dwordx4 v1, s[4:7], s20 offen offset:2048 lds
buffer_load_dwordx4 v1, s[4:7], s20 offen offset:3072 lds
s_add_u32 s20, s20, 4096
s_add_u32 m0, s26, 8192
s_nop 0
buffer_load_dwordx4 v1, s[4:7], s20 offen offset:0 lds
buffer_load_dwordx4 v1, s[4:7], s20 offen offset:1024 lds
s_mul_i32 s34, s15, 12
s_mul_i32 s35, s16, 6
s_add_u32 s34, s34, s35
s_add_u32 s34, s34, 0
s_mul_i32 s34, s34, 20480
s_add_u32 s34, s34, 14155776
buffer_load_dwordx4 a[0:3], v1, s[4:7], s34 offen offset:0
buffer_load_dwordx4 a[4:7], v1, s[4:7], s34 offen offset:1024
buffer_load_dwordx4 a[8:11], v1, s[4:7], s34 offen offset:2048
buffer_load_dwordx4 a[12:15], v1, s[4:7], s34 offen offset:3072
s_add_u32 s34, s34, 4096
buffer_load_dwordx4 a[16:19], v1, s[4:7], s34 offen offset:0
buffer_load_dwordx4 a[20:23], v1, s[4:7], s34 offen offset:1024
buffer_load_dwordx4 a[24:27], v1, s[4:7], s34 offen offset:2048
buffer_load_dwordx4 a[28:31], v1, s[4:7], s34 offen offset:3072
s_add_u32 s34, s34, 4096
buffer_load_dwordx4 a[32:35], v1, s[4:7], s34 offen offset:0
buffer_load_dwordx4 a[36:39], v1, s[4:7], s34 offen offset:1024
buffer_load_dwordx4 a[40:43], v1, s[4:7], s34 offen offset:2048
buffer_load_dwordx4 a[44:47], v1, s[4:7], s34 offen offset:3072
s_add_u32 s34, s34, 4096
buffer_load_dwordx4 a[48:51], v1, s[4:7], s34 offen offset:0
buffer_load_dwordx4 a[52:55], v1, s[4:7], s34 offen offset:1024
buffer_load_dwordx4 a[56:59], v1, s[4:7], s34 offen offset:2048
buffer_load_dwordx4 a[60:63], v1, s[4:7], s34 offen offset:3072
s_add_u32 s34, s34, 4096
buffer_load_dwordx4 a[64:67], v1, s[4:7], s34 offen offset:0
buffer_load_dwordx4 a[68:71], v1, s[4:7], s34 offen offset:1024
buffer_load_dwordx4 a[72:75], v1, s[4:7], s34 offen offset:2048
buffer_load_dwordx4 a[76:79], v1, s[4:7], s34 offen offset:3072
s_mul_i32 s34, s15, 12
s_mul_i32 s35, s16, 6
s_add_u32 s34, s34, s35
s_add_u32 s34, s34, 1
s_mul_i32 s34, s34, 20480
s_add_u32 s34, s34, 14155776
buffer_load_dwordx4 a[80:83], v1, s[4:7], s34 offen offset:0
buffer_load_dwordx4 a[84:87], v1, s[4:7], s34 offen offset:1024
buffer_load_dwordx4 a[88:91], v1, s[4:7], s34 offen offset:2048
buffer_load_dwordx4 a[92:95], v1, s[4:7], s34 offen offset:3072
s_add_u32 s34, s34, 4096
buffer_load_dwordx4 a[96:99], v1, s[4:7], s34 offen offset:0
buffer_load_dwordx4 a[100:103], v1, s[4:7], s34 offen offset:1024
buffer_load_dwordx4 a[104:107], v1, s[4:7], s34 offen offset:2048
buffer_load_dwordx4 a[108:111], v1, s[4:7], s34 offen offset:3072
s_add_u32 s34, s34, 4096
buffer_load_dwordx4 a[112:115], v1, s[4:7], s34 offen offset:0
buffer_load_dwordx4 a[116:119], v1, s[4:7], s34 offen offset:1024
buffer_load_dwordx4 a[120:123], v1, s[4:7], s34 offen offset:2048
buffer_load_dwordx4 a[124:127], v1, s[4:7], s34 offen offset:3072
s_add_u32 s34, s34, 4096
buffer_load_dwordx4 a[128:131], v1, s[4:7], s34 offen offset:0
buffer_load_dwordx4 a[132:135], v1, s[4:7], s34 offen offset:1024
buffer_load_dwordx4 a[136:139], v1, s[4:7], s34 offen offset:2048
buffer_load_dwordx4 a[140:143], v1, s[4:7], s34 offen offset:3072
s_add_u32 s34, s34, 4096
buffer_load_dwordx4 a[144:147], v1, s[4:7], s34 offen offset:0
buffer_load_dwordx4 a[148:151], v1, s[4:7], s34 offen offset:1024
buffer_load_dwordx4 a[152:155], v1, s[4:7], s34 offen offset:2048
buffer_load_dwordx4 a[156:159], v1, s[4:7], s34 offen offset:3072
s_waitcnt vmcnt(20)
s_mul_i32 s34, s15, 12
s_mul_i32 s35, s16, 6
s_add_u32 s34, s34, s35
s_add_u32 s34, s34, 2
s_mul_i32 s34, s34, 20480
s_add_u32 s34, s34, 14155776
buffer_load_dwordx4 a[160:163], v1, s[4:7], s34 offen offset:0
buffer_load_dwordx4 a[164:167], v1, s[4:7], s34 offen offset:1024
buffer_load_dwordx4 a[168:171], v1, s[4:7], s34 offen offset:2048
buffer_load_dwordx4 a[172:175], v1, s[4:7], s34 offen offset:3072
s_add_u32 s34, s34, 4096
buffer_load_dwordx4 a[176:179], v1, s[4:7], s34 offen offset:0
buffer_load_dwordx4 a[180:183], v1, s[4:7], s34 offen offset:1024
buffer_load_dwordx4 a[184:187], v1, s[4:7], s34 offen offset:2048
buffer_load_dwordx4 a[188:191], v1, s[4:7], s34 offen offset:3072
s_add_u32 s34, s34, 4096
buffer_load_dwordx4 a[192:195], v1, s[4:7], s34 offen offset:0
buffer_load_dwordx4 a[196:199], v1, s[4:7], s34 offen offset:1024
buffer_load_dwordx4 a[200:203], v1, s[4:7], s34 offen offset:2048
buffer_load_dwordx4 a[204:207], v1, s[4:7], s34 offen offset:3072
s_add_u32 s34, s34, 4096
buffer_load_dwordx4 a[208:211], v1, s[4:7], s34 offen offset:0
buffer_load_dwordx4 a[212:215], v1, s[4:7], s34 offen offset:1024
buffer_load_dwordx4 a[216:219], v1, s[4:7], s34 offen offset:2048
buffer_load_dwordx4 a[220:223], v1, s[4:7], s34 offen offset:3072
s_add_u32 s34, s34, 4096
buffer_load_dwordx4 a[224:227], v1, s[4:7], s34 offen offset:0
buffer_load_dwordx4 a[228:231], v1, s[4:7], s34 offen offset:1024
buffer_load_dwordx4 a[232:235], v1, s[4:7], s34 offen offset:2048
buffer_load_dwordx4 a[236:239], v1, s[4:7], s34 offen offset:3072
s_waitcnt vmcnt(20)
s_mul_i32 s34, s15, 12
s_mul_i32 s35, s16, 6
s_add_u32 s34, s34, s35
s_add_u32 s34, s34, 3
s_mul_i32 s34, s34, 20480
s_add_u32 s34, s34, 14155776
buffer_load_dwordx4 v[96:99], v1, s[4:7], s34 offen offset:0
buffer_load_dwordx4 v[100:103], v1, s[4:7], s34 offen offset:1024
buffer_load_dwordx4 v[104:107], v1, s[4:7], s34 offen offset:2048
buffer_load_dwordx4 v[108:111], v1, s[4:7], s34 offen offset:3072
s_add_u32 s34, s34, 4096
buffer_load_dwordx4 v[112:115], v1, s[4:7], s34 offen offset:0
buffer_load_dwordx4 v[116:119], v1, s[4:7], s34 offen offset:1024
buffer_load_dwordx4 v[120:123], v1, s[4:7], s34 offen offset:2048
buffer_load_dwordx4 v[124:127], v1, s[4:7], s34 offen offset:3072
s_add_u32 s34, s34, 4096
buffer_load_dwordx4 v[128:131], v1, s[4:7], s34 offen offset:0
buffer_load_dwordx4 v[132:135], v1, s[4:7], s34 offen offset:1024
buffer_load_dwordx4 v[136:139], v1, s[4:7], s34 offen offset:2048
buffer_load_dwordx4 v[140:143], v1, s[4:7], s34 offen offset:3072
s_add_u32 s34, s34, 4096
buffer_load_dwordx4 v[144:147], v1, s[4:7], s34 offen offset:0
buffer_load_dwordx4 v[148:151], v1, s[4:7], s34 offen offset:1024
buffer_load_dwordx4 v[152:155], v1, s[4:7], s34 offen offset:2048
buffer_load_dwordx4 v[156:159], v1, s[4:7], s34 offen offset:3072
s_add_u32 s34, s34, 4096
buffer_load_dwordx4 v[160:163], v1, s[4:7], s34 offen offset:0
buffer_load_dwordx4 v[164:167], v1, s[4:7], s34 offen offset:1024
buffer_load_dwordx4 v[168:171], v1, s[4:7], s34 offen offset:2048
buffer_load_dwordx4 v[172:175], v1, s[4:7], s34 offen offset:3072
s_waitcnt vmcnt(20)
s_mul_i32 s34, s15, 12
s_mul_i32 s35, s16, 6
s_add_u32 s34, s34, s35
s_add_u32 s34, s34, 0
s_mul_i32 s34, s34, 20480
s_add_u32 s34, s34, 22020096
buffer_load_dwordx4 v[176:179], v1, s[4:7], s34 offen offset:0
buffer_load_dwordx4 v[180:183], v1, s[4:7], s34 offen offset:1024
buffer_load_dwordx4 v[184:187], v1, s[4:7], s34 offen offset:2048
buffer_load_dwordx4 v[188:191], v1, s[4:7], s34 offen offset:3072
s_add_u32 s34, s34, 4096
buffer_load_dwordx4 v[192:195], v1, s[4:7], s34 offen offset:0
buffer_load_dwordx4 v[196:199], v1, s[4:7], s34 offen offset:1024
buffer_load_dwordx4 v[200:203], v1, s[4:7], s34 offen offset:2048
buffer_load_dwordx4 v[204:207], v1, s[4:7], s34 offen offset:3072
s_add_u32 s34, s34, 4096
buffer_load_dwordx4 v[208:211], v1, s[4:7], s34 offen offset:0
buffer_load_dwordx4 v[212:215], v1, s[4:7], s34 offen offset:1024
buffer_load_dwordx4 v[216:219], v1, s[4:7], s34 offen offset:2048
buffer_load_dwordx4 v[220:223], v1, s[4:7], s34 offen offset:3072
s_add_u32 s34, s34, 4096
buffer_load_dwordx4 v[224:227], v1, s[4:7], s34 offen offset:0
buffer_load_dwordx4 v[228:231], v1, s[4:7], s34 offen offset:1024
buffer_load_dwordx4 v[232:235], v1, s[4:7], s34 offen offset:2048
buffer_load_dwordx4 v[236:239], v1, s[4:7], s34 offen offset:3072
s_add_u32 s34, s34, 4096
buffer_load_dwordx4 v[240:243], v1, s[4:7], s34 offen offset:0
buffer_load_dwordx4 v[244:247], v1, s[4:7], s34 offen offset:1024
buffer_load_dwordx4 v[248:251], v1, s[4:7], s34 offen offset:2048
buffer_load_dwordx4 v[252:255], v1, s[4:7], s34 offen offset:3072
s_waitcnt vmcnt(20)
v_and_b32 v30, 7, v0
v_lshlrev_b32 v30, 3, v30
reca_cens230:
buffer_load_dwordx2 v[28:29], v30, s[8:11], 0 offen sc1
s_waitcnt vmcnt(0)
v_sad_u8 v31, v28, 0, 0
v_sad_u8 v31, v29, 0, v31
v_cmp_gt_u32 vcc, 32, v31
s_cbranch_vccz reca_censok231
s_sleep 8
s_sub_u32 s18, s18, 1
s_cbranch_scc0 reca_cens230
s_mov_b32 s18, 0
reca_censok231:
v_and_b32 v28, 0x20202020, v28
v_and_b32 v29, 0x20202020, v29
v_cmp_ne_u32 s[34:35], 0, v28
v_cmp_ne_u32 s[36:37], 0, v29
s_nop 3
s_and_b32 s34, s34, 0xff
s_and_b32 s36, s36, 0xff
s_or_b32 s35, s34, s36
s_lshr_b32 s37, s35, s13
s_and_b32 s37, s37, 1
s_xor_b32 s43, s37, 1
s_cmp_eq_u32 s57, 0
s_cselect_b32 s58, s36, s34
v_mov_b32 v31, 0x80000000
s_cmp_lg_u32 s43, 0
s_cbranch_scc1 reca_pslow232
reca_ptop233:
s_cmp_lt_u32 s17, 3
s_cbranch_scc1 reca_pgo234
s_sub_u32 s36, s17, 3
reca_ppoll235:
buffer_load_dword v28, v4, s[4:7], s25 offen sc1
s_waitcnt vmcnt(0)
v_readfirstlane_b32 s34, v28
s_nop 3
s_cmp_ge_i32 s34, s36
s_cbranch_scc1 reca_pgo234
s_sleep 8
s_sub_u32 s18, s18, 1
s_cbranch_scc0 reca_ppoll235
s_mov_b32 s18, 0
reca_pgo234:
s_waitcnt vmcnt(0)
s_barrier
v_add_u32 v7, s26, v1
s_xor_b32 s26, s26, 40960
s_add_u32 s37, s17, 1
s_cmp_ge_u32 s37, 64
s_cbranch_scc1 reca_pnodma236
s_mul_i32 s20, s37, 40960
s_add_u32 s20, s20, 84934656
s_add_u32 m0, s26, 0
s_nop 0
buffer_load_dwordx4 v1, s[4:7], s20 offen offset:0 lds
buffer_load_dwordx4 v1, s[4:7], s20 offen offset:1024 lds
buffer_load_dwordx4 v1, s[4:7], s20 offen offset:2048 lds
buffer_load_dwordx4 v1, s[4:7], s20 offen offset:3072 lds
s_add_u32 s20, s20, 4096
s_add_u32 m0, s26, 4096
s_nop 0
buffer_load_dwordx4 v1, s[4:7], s20 offen offset:0 lds
buffer_load_dwordx4 v1, s[4:7], s20 offen offset:1024 lds
buffer_load_dwordx4 v1, s[4:7], s20 offen offset:2048 lds
buffer_load_dwordx4 v1, s[4:7], s20 offen offset:3072 lds
s_add_u32 s20, s20, 4096
s_add_u32 m0, s26, 8192
s_nop 0
buffer_load_dwordx4 v1, s[4:7], s20 offen offset:0 lds
buffer_load_dwordx4 v1, s[4:7], s20 offen offset:1024 lds
reca_pnodma236:
s_lshl_b32 s34, s15, 3
s_and_b32 s35, s17, 7
s_add_u32 s34, s34, s35
s_mul_i32 s34, s34, 12288
s_mul_i32 s35, s16, 3072
s_add_u32 s35, s35, s34
s_add_u32 s21, s35, 37748736
s_add_u32 s22, s35, 44040192
s_mul_i32 s35, s16, 6144
s_add_u32 s35, s35, s34
s_add_u32 s23, s35, 40894464
ds_read_b128 v[72:75], v7 offset:0
ds_read_b128 v[76:79], v7 offset:20480
ds_read_b128 v[80:83], v7 offset:1024
ds_read_b128 v[84:87], v7 offset:21504
ds_read_b128 v[88:91], v7 offset:2048
ds_read_b128 v[92:95], v7 offset:22528
s_waitcnt lgkmcnt(4)
v_mfma_f32_16x16x32_bf16 v[32:35], a[0:3], v[72:75], 0
v_mfma_f32_16x16x32_bf16 v[36:39], a[0:3], v[76:79], 0
v_mfma_f32_16x16x32_bf16 v[40:43], a[80:83], v[72:75], 0
v_mfma_f32_16x16x32_bf16 v[44:47], a[80:83], v[76:79], 0
v_mfma_f32_16x16x32_bf16 v[48:51], a[160:163], v[72:75], 0
v_mfma_f32_16x16x32_bf16 v[52:55], a[160:163], v[76:79], 0
v_mfma_f32_16x16x32_bf16 v[56:59], v[96:99], v[72:75], 0
v_mfma_f32_16x16x32_bf16 v[60:63], v[96:99], v[76:79], 0
v_mfma_f32_16x16x32_bf16 v[64:67], v[72:75], v[176:179], 0
v_mfma_f32_16x16x32_bf16 v[68:71], v[76:79], v[176:179], 0
ds_read_b128 v[72:75], v7 offset:3072
ds_read_b128 v[76:79], v7 offset:23552
s_waitcnt lgkmcnt(4)
v_mfma_f32_16x16x32_bf16 v[32:35], a[4:7], v[80:83], v[32:35]
v_mfma_f32_16x16x32_bf16 v[36:39], a[4:7], v[84:87], v[36:39]
v_mfma_f32_16x16x32_bf16 v[40:43], a[84:87], v[80:83], v[40:43]
v_mfma_f32_16x16x32_bf16 v[44:47], a[84:87], v[84:87], v[44:47]
v_mfma_f32_16x16x32_bf16 v[48:51], a[164:167], v[80:83], v[48:51]
v_mfma_f32_16x16x32_bf16 v[52:55], a[164:167], v[84:87], v[52:55]
v_mfma_f32_16x16x32_bf16 v[56:59], v[100:103], v[80:83], v[56:59]
v_mfma_f32_16x16x32_bf16 v[60:63], v[100:103], v[84:87], v[60:63]
v_mfma_f32_16x16x32_bf16 v[64:67], v[80:83], v[180:183], v[64:67]
v_mfma_f32_16x16x32_bf16 v[68:71], v[84:87], v[180:183], v[68:71]
ds_read_b128 v[80:83], v7 offset:4096
ds_read_b128 v[84:87], v7 offset:24576
s_waitcnt lgkmcnt(4)
v_mfma_f32_16x16x32_bf16 v[32:35], a[8:11], v[88:91], v[32:35]
v_mfma_f32_16x16x32_bf16 v[36:39], a[8:11], v[92:95], v[36:39]
v_mfma_f32_16x16x32_bf16 v[40:43], a[88:91], v[88:91], v[40:43]
v_mfma_f32_16x16x32_bf16 v[44:47], a[88:91], v[92:95], v[44:47]
v_mfma_f32_16x16x32_bf16 v[48:51], a[168:171], v[88:91], v[48:51]
v_mfma_f32_16x16x32_bf16 v[52:55], a[168:171], v[92:95], v[52:55]
v_mfma_f32_16x16x32_bf16 v[56:59], v[104:107], v[88:91], v[56:59]
v_mfma_f32_16x16x32_bf16 v[60:63], v[104:107], v[92:95], v[60:63]
v_mfma_f32_16x16x32_bf16 v[64:67], v[88:91], v[184:187], v[64:67]
v_mfma_f32_16x16x32_bf16 v[68:71], v[92:95], v[184:187], v[68:71]
ds_read_b128 v[88:91], v7 offset:5120
ds_read_b128 v[92:95], v7 offset:25600
s_waitcnt lgkmcnt(4)
v_mfma_f32_16x16x32_bf16 v[32:35], a[12:15], v[72:75], v[32:35]
v_mfma_f32_16x16x32_bf16 v[36:39], a[12:15], v[76:79], v[36:39]
v_mfma_f32_16x16x32_bf16 v[40:43], a[92:95], v[72:75], v[40:43]
v_mfma_f32_16x16x32_bf16 v[44:47], a[92:95], v[76:79], v[44:47]
v_mfma_f32_16x16x32_bf16 v[48:51], a[172:175], v[72:75], v[48:51]
v_mfma_f32_16x16x32_bf16 v[52:55], a[172:175], v[76:79], v[52:55]
v_mfma_f32_16x16x32_bf16 v[56:59], v[108:111], v[72:75], v[56:59]
v_mfma_f32_16x16x32_bf16 v[60:63], v[108:111], v[76:79], v[60:63]
v_mfma_f32_16x16x32_bf16 v[64:67], v[72:75], v[188:191], v[64:67]
v_mfma_f32_16x16x32_bf16 v[68:71], v[76:79], v[188:191], v[68:71]
ds_read_b128 v[72:75], v7 offset:6144
ds_read_b128 v[76:79], v7 offset:26624
s_waitcnt lgkmcnt(4)
v_mfma_f32_16x16x32_bf16 v[32:35], a[16:19], v[80:83], v[32:35]
v_mfma_f32_16x16x32_bf16 v[36:39], a[16:19], v[84:87], v[36:39]
v_mfma_f32_16x16x32_bf16 v[40:43], a[96:99], v[80:83], v[40:43]
v_mfma_f32_16x16x32_bf16 v[44:47], a[96:99], v[84:87], v[44:47]
v_mfma_f32_16x16x32_bf16 v[48:51], a[176:179], v[80:83], v[48:51]
v_mfma_f32_16x16x32_bf16 v[52:55], a[176:179], v[84:87], v[52:55]
v_mfma_f32_16x16x32_bf16 v[56:59], v[112:115], v[80:83], v[56:59]
v_mfma_f32_16x16x32_bf16 v[60:63], v[112:115], v[84:87], v[60:63]
v_mfma_f32_16x16x32_bf16 v[64:67], v[80:83], v[192:195], v[64:67]
v_mfma_f32_16x16x32_bf16 v[68:71], v[84:87], v[192:195], v[68:71]
ds_read_b128 v[80:83], v7 offset:7168
ds_read_b128 v[84:87], v7 offset:27648
s_waitcnt lgkmcnt(4)
v_mfma_f32_16x16x32_bf16 v[32:35], a[20:23], v[88:91], v[32:35]
v_mfma_f32_16x16x32_bf16 v[36:39], a[20:23], v[92:95], v[36:39]
v_mfma_f32_16x16x32_bf16 v[40:43], a[100:103], v[88:91], v[40:43]
v_mfma_f32_16x16x32_bf16 v[44:47], a[100:103], v[92:95], v[44:47]
v_mfma_f32_16x16x32_bf16 v[48:51], a[180:183], v[88:91], v[48:51]
v_mfma_f32_16x16x32_bf16 v[52:55], a[180:183], v[92:95], v[52:55]
v_mfma_f32_16x16x32_bf16 v[56:59], v[116:119], v[88:91], v[56:59]
v_mfma_f32_16x16x32_bf16 v[60:63], v[116:119], v[92:95], v[60:63]
v_mfma_f32_16x16x32_bf16 v[64:67], v[88:91], v[196:199], v[64:67]
v_mfma_f32_16x16x32_bf16 v[68:71], v[92:95], v[196:199], v[68:71]
ds_read_b128 v[88:91], v7 offset:8192
ds_read_b128 v[92:95], v7 offset:28672
s_waitcnt lgkmcnt(4)
v_mfma_f32_16x16x32_bf16 v[32:35], a[24:27], v[72:75], v[32:35]
v_mfma_f32_16x16x32_bf16 v[36:39], a[24:27], v[76:79], v[36:39]
v_mfma_f32_16x16x32_bf16 v[40:43], a[104:107], v[72:75], v[40:43]
v_mfma_f32_16x16x32_bf16 v[44:47], a[104:107], v[76:79], v[44:47]
v_mfma_f32_16x16x32_bf16 v[48:51], a[184:187], v[72:75], v[48:51]
v_mfma_f32_16x16x32_bf16 v[52:55], a[184:187], v[76:79], v[52:55]
v_mfma_f32_16x16x32_bf16 v[56:59], v[120:123], v[72:75], v[56:59]
v_mfma_f32_16x16x32_bf16 v[60:63], v[120:123], v[76:79], v[60:63]
v_mfma_f32_16x16x32_bf16 v[64:67], v[72:75], v[200:203], v[64:67]
v_mfma_f32_16x16x32_bf16 v[68:71], v[76:79], v[200:203], v[68:71]
ds_read_b128 v[72:75], v7 offset:9216
ds_read_b128 v[76:79], v7 offset:29696
s_waitcnt lgkmcnt(4)
v_mfma_f32_16x16x32_bf16 v[32:35], a[28:31], v[80:83], v[32:35]
v_mfma_f32_16x16x32_bf16 v[36:39], a[28:31], v[84:87], v[36:39]
v_mfma_f32_16x16x32_bf16 v[40:43], a[108:111], v[80:83], v[40:43]
v_mfma_f32_16x16x32_bf16 v[44:47], a[108:111], v[84:87], v[44:47]
v_mfma_f32_16x16x32_bf16 v[48:51], a[188:191], v[80:83], v[48:51]
v_mfma_f32_16x16x32_bf16 v[52:55], a[188:191], v[84:87], v[52:55]
v_mfma_f32_16x16x32_bf16 v[56:59], v[124:127], v[80:83], v[56:59]
v_mfma_f32_16x16x32_bf16 v[60:63], v[124:127], v[84:87], v[60:63]
v_mfma_f32_16x16x32_bf16 v[64:67], v[80:83], v[204:207], v[64:67]
v_mfma_f32_16x16x32_bf16 v[68:71], v[84:87], v[204:207], v[68:71]
ds_read_b128 v[80:83], v7 offset:10240
ds_read_b128 v[84:87], v7 offset:30720
s_waitcnt lgkmcnt(4)
v_mfma_f32_16x16x32_bf16 v[32:35], a[32:35], v[88:91], v[32:35]
v_mfma_f32_16x16x32_bf16 v[36:39], a[32:35], v[92:95], v[36:39]
v_mfma_f32_16x16x32_bf16 v[40:43], a[112:115], v[88:91], v[40:43]
v_mfma_f32_16x16x32_bf16 v[44:47], a[112:115], v[92:95], v[44:47]
v_mfma_f32_16x16x32_bf16 v[48:51], a[192:195], v[88:91], v[48:51]
v_mfma_f32_16x16x32_bf16 v[52:55], a[192:195], v[92:95], v[52:55]
v_mfma_f32_16x16x32_bf16 v[56:59], v[128:131], v[88:91], v[56:59]
v_mfma_f32_16x16x32_bf16 v[60:63], v[128:131], v[92:95], v[60:63]
v_mfma_f32_16x16x32_bf16 v[64:67], v[88:91], v[208:211], v[64:67]
v_mfma_f32_16x16x32_bf16 v[68:71], v[92:95], v[208:211], v[68:71]
ds_read_b128 v[88:91], v7 offset:11264
ds_read_b128 v[92:95], v7 offset:31744
s_waitcnt lgkmcnt(4)
v_mfma_f32_16x16x32_bf16 v[32:35], a[36:39], v[72:75], v[32:35]
v_mfma_f32_16x16x32_bf16 v[36:39], a[36:39], v[76:79], v[36:39]
v_mfma_f32_16x16x32_bf16 v[40:43], a[116:119], v[72:75], v[40:43]
v_mfma_f32_16x16x32_bf16 v[44:47], a[116:119], v[76:79], v[44:47]
v_mfma_f32_16x16x32_bf16 v[48:51], a[196:199], v[72:75], v[48:51]
v_mfma_f32_16x16x32_bf16 v[52:55], a[196:199], v[76:79], v[52:55]
v_mfma_f32_16x16x32_bf16 v[56:59], v[132:135], v[72:75], v[56:59]
v_mfma_f32_16x16x32_bf16 v[60:63], v[132:135], v[76:79], v[60:63]
v_mfma_f32_16x16x32_bf16 v[64:67], v[72:75], v[212:215], v[64:67]
v_mfma_f32_16x16x32_bf16 v[68:71], v[76:79], v[212:215], v[68:71]
ds_read_b128 v[72:75], v7 offset:12288
ds_read_b128 v[76:79], v7 offset:32768
s_waitcnt lgkmcnt(4)
v_mfma_f32_16x16x32_bf16 v[32:35], a[40:43], v[80:83], v[32:35]
v_mfma_f32_16x16x32_bf16 v[36:39], a[40:43], v[84:87], v[36:39]
v_mfma_f32_16x16x32_bf16 v[40:43], a[120:123], v[80:83], v[40:43]
v_mfma_f32_16x16x32_bf16 v[44:47], a[120:123], v[84:87], v[44:47]
v_mfma_f32_16x16x32_bf16 v[48:51], a[200:203], v[80:83], v[48:51]
v_mfma_f32_16x16x32_bf16 v[52:55], a[200:203], v[84:87], v[52:55]
v_mfma_f32_16x16x32_bf16 v[56:59], v[136:139], v[80:83], v[56:59]
v_mfma_f32_16x16x32_bf16 v[60:63], v[136:139], v[84:87], v[60:63]
v_mfma_f32_16x16x32_bf16 v[64:67], v[80:83], v[216:219], v[64:67]
v_mfma_f32_16x16x32_bf16 v[68:71], v[84:87], v[216:219], v[68:71]
ds_read_b128 v[80:83], v7 offset:13312
ds_read_b128 v[84:87], v7 offset:33792
s_waitcnt lgkmcnt(4)
v_mfma_f32_16x16x32_bf16 v[32:35], a[44:47], v[88:91], v[32:35]
v_mfma_f32_16x16x32_bf16 v[36:39], a[44:47], v[92:95], v[36:39]
v_mfma_f32_16x16x32_bf16 v[40:43], a[124:127], v[88:91], v[40:43]
v_mfma_f32_16x16x32_bf16 v[44:47], a[124:127], v[92:95], v[44:47]
v_mfma_f32_16x16x32_bf16 v[48:51], a[204:207], v[88:91], v[48:51]
v_mfma_f32_16x16x32_bf16 v[52:55], a[204:207], v[92:95], v[52:55]
v_mfma_f32_16x16x32_bf16 v[56:59], v[140:143], v[88:91], v[56:59]
v_mfma_f32_16x16x32_bf16 v[60:63], v[140:143], v[92:95], v[60:63]
v_mfma_f32_16x16x32_bf16 v[64:67], v[88:91], v[220:223], v[64:67]
v_mfma_f32_16x16x32_bf16 v[68:71], v[92:95], v[220:223], v[68:71]
ds_read_b128 v[88:91], v7 offset:14336
ds_read_b128 v[92:95], v7 offset:34816
s_waitcnt lgkmcnt(4)
v_mfma_f32_16x16x32_bf16 v[32:35], a[48:51], v[72:75], v[32:35]
v_mfma_f32_16x16x32_bf16 v[36:39], a[48:51], v[76:79], v[36:39]
v_mfma_f32_16x16x32_bf16 v[40:43], a[128:131], v[72:75], v[40:43]
v_mfma_f32_16x16x32_bf16 v[44:47], a[128:131], v[76:79], v[44:47]
v_mfma_f32_16x16x32_bf16 v[48:51], a[208:211], v[72:75], v[48:51]
v_mfma_f32_16x16x32_bf16 v[52:55], a[208:211], v[76:79], v[52:55]
v_mfma_f32_16x16x32_bf16 v[56:59], v[144:147], v[72:75], v[56:59]
v_mfma_f32_16x16x32_bf16 v[60:63], v[144:147], v[76:79], v[60:63]
v_mfma_f32_16x16x32_bf16 v[64:67], v[72:75], v[224:227], v[64:67]
v_mfma_f32_16x16x32_bf16 v[68:71], v[76:79], v[224:227], v[68:71]
ds_read_b128 v[72:75], v7 offset:15360
ds_read_b128 v[76:79], v7 offset:35840
s_waitcnt lgkmcnt(4)
v_mfma_f32_16x16x32_bf16 v[32:35], a[52:55], v[80:83], v[32:35]
v_mfma_f32_16x16x32_bf16 v[36:39], a[52:55], v[84:87], v[36:39]
v_mfma_f32_16x16x32_bf16 v[40:43], a[132:135], v[80:83], v[40:43]
v_mfma_f32_16x16x32_bf16 v[44:47], a[132:135], v[84:87], v[44:47]
v_mfma_f32_16x16x32_bf16 v[48:51], a[212:215], v[80:83], v[48:51]
v_mfma_f32_16x16x32_bf16 v[52:55], a[212:215], v[84:87], v[52:55]
v_mfma_f32_16x16x32_bf16 v[56:59], v[148:151], v[80:83], v[56:59]
v_mfma_f32_16x16x32_bf16 v[60:63], v[148:151], v[84:87], v[60:63]
v_mfma_f32_16x16x32_bf16 v[64:67], v[80:83], v[228:231], v[64:67]
v_mfma_f32_16x16x32_bf16 v[68:71], v[84:87], v[228:231], v[68:71]
ds_read_b128 v[80:83], v7 offset:16384
ds_read_b128 v[84:87], v7 offset:36864
s_waitcnt lgkmcnt(4)
v_mfma_f32_16x16x32_bf16 v[32:35], a[56:59], v[88:91], v[32:35]
v_mfma_f32_16x16x32_bf16 v[36:39], a[56:59], v[92:95], v[36:39]
v_mfma_f32_16x16x32_bf16 v[40:43], a[136:139], v[88:91], v[40:43]
v_mfma_f32_16x16x32_bf16 v[44:47], a[136:139], v[92:95], v[44:47]
v_mfma_f32_16x16x32_bf16 v[48:51], a[216:219], v[88:91], v[48:51]
v_mfma_f32_16x16x32_bf16 v[52:55], a[216:219], v[92:95], v[52:55]
v_mfma_f32_16x16x32_bf16 v[56:59], v[152:155], v[88:91], v[56:59]
v_mfma_f32_16x16x32_bf16 v[60:63], v[152:155], v[92:95], v[60:63]
v_mfma_f32_16x16x32_bf16 v[64:67], v[88:91], v[232:235], v[64:67]
v_mfma_f32_16x16x32_bf16 v[68:71], v[92:95], v[232:235], v[68:71]
ds_read_b128 v[88:91], v7 offset:17408
ds_read_b128 v[92:95], v7 offset:37888
s_waitcnt lgkmcnt(4)
v_mfma_f32_16x16x32_bf16 v[32:35], a[60:63], v[72:75], v[32:35]
v_mfma_f32_16x16x32_bf16 v[36:39], a[60:63], v[76:79], v[36:39]
v_mfma_f32_16x16x32_bf16 v[40:43], a[140:143], v[72:75], v[40:43]
v_mfma_f32_16x16x32_bf16 v[44:47], a[140:143], v[76:79], v[44:47]
v_mfma_f32_16x16x32_bf16 v[48:51], a[220:223], v[72:75], v[48:51]
v_mfma_f32_16x16x32_bf16 v[52:55], a[220:223], v[76:79], v[52:55]
v_mfma_f32_16x16x32_bf16 v[56:59], v[156:159], v[72:75], v[56:59]
v_mfma_f32_16x16x32_bf16 v[60:63], v[156:159], v[76:79], v[60:63]
v_mfma_f32_16x16x32_bf16 v[64:67], v[72:75], v[236:239], v[64:67]
v_mfma_f32_16x16x32_bf16 v[68:71], v[76:79], v[236:239], v[68:71]
ds_read_b128 v[72:75], v7 offset:18432
ds_read_b128 v[76:79], v7 offset:38912
s_waitcnt lgkmcnt(4)
v_mfma_f32_16x16x32_bf16 v[32:35], a[64:67], v[80:83], v[32:35]
v_mfma_f32_16x16x32_bf16 v[36:39], a[64:67], v[84:87], v[36:39]
v_mfma_f32_16x16x32_bf16 v[40:43], a[144:147], v[80:83], v[40:43]
v_mfma_f32_16x16x32_bf16 v[44:47], a[144:147], v[84:87], v[44:47]
v_mfma_f32_16x16x32_bf16 v[48:51], a[224:227], v[80:83], v[48:51]
v_mfma_f32_16x16x32_bf16 v[52:55], a[224:227], v[84:87], v[52:55]
v_mfma_f32_16x16x32_bf16 v[56:59], v[160:163], v[80:83], v[56:59]
v_mfma_f32_16x16x32_bf16 v[60:63], v[160:163], v[84:87], v[60:63]
v_mfma_f32_16x16x32_bf16 v[64:67], v[80:83], v[240:243], v[64:67]
v_mfma_f32_16x16x32_bf16 v[68:71], v[84:87], v[240:243], v[68:71]
ds_read_b128 v[80:83], v7 offset:19456
ds_read_b128 v[84:87], v7 offset:39936
s_waitcnt lgkmcnt(4)
v_mfma_f32_16x16x32_bf16 v[32:35], a[68:71], v[88:91], v[32:35]
v_mfma_f32_16x16x32_bf16 v[36:39], a[68:71], v[92:95], v[36:39]
v_mfma_f32_16x16x32_bf16 v[40:43], a[148:151], v[88:91], v[40:43]
v_mfma_f32_16x16x32_bf16 v[44:47], a[148:151], v[92:95], v[44:47]
v_mfma_f32_16x16x32_bf16 v[48:51], a[228:231], v[88:91], v[48:51]
v_mfma_f32_16x16x32_bf16 v[52:55], a[228:231], v[92:95], v[52:55]
v_mfma_f32_16x16x32_bf16 v[56:59], v[164:167], v[88:91], v[56:59]
v_mfma_f32_16x16x32_bf16 v[60:63], v[164:167], v[92:95], v[60:63]
v_mfma_f32_16x16x32_bf16 v[64:67], v[88:91], v[244:247], v[64:67]
v_mfma_f32_16x16x32_bf16 v[68:71], v[92:95], v[244:247], v[68:71]
s_waitcnt lgkmcnt(2)
v_mfma_f32_16x16x32_bf16 v[32:35], a[72:75], v[72:75], v[32:35]
v_mfma_f32_16x16x32_bf16 v[36:39], a[72:75], v[76:79], v[36:39]
v_mfma_f32_16x16x32_bf16 v[40:43], a[152:155], v[72:75], v[40:43]
v_mfma_f32_16x16x32_bf16 v[44:47], a[152:155], v[76:79], v[44:47]
v_mfma_f32_16x16x32_bf16 v[48:51], a[232:235], v[72:75], v[48:51]
v_mfma_f32_16x16x32_bf16 v[52:55], a[232:235], v[76:79], v[52:55]
v_mfma_f32_16x16x32_bf16 v[56:59], v[168:171], v[72:75], v[56:59]
v_mfma_f32_16x16x32_bf16 v[60:63], v[168:171], v[76:79], v[60:63]
v_mfma_f32_16x16x32_bf16 v[64:67], v[72:75], v[248:251], v[64:67]
v_mfma_f32_16x16x32_bf16 v[68:71], v[76:79], v[248:251], v[68:71]
s_waitcnt lgkmcnt(0)
v_mfma_f32_16x16x32_bf16 v[32:35], a[76:79], v[80:83], v[32:35]
v_mfma_f32_16x16x32_bf16 v[36:39], a[76:79], v[84:87], v[36:39]
v_mfma_f32_16x16x32_bf16 v[40:43], a[156:159], v[80:83], v[40:43]
v_mfma_f32_16x16x32_bf16 v[44:47], a[156:159], v[84:87], v[44:47]
v_mfma_f32_16x16x32_bf16 v[48:51], a[236:239], v[80:83], v[48:51]
v_mfma_f32_16x16x32_bf16 v[52:55], a[236:239], v[84:87], v[52:55]
v_mfma_f32_16x16x32_bf16 v[56:59], v[172:175], v[80:83], v[56:59]
v_mfma_f32_16x16x32_bf16 v[60:63], v[172:175], v[84:87], v[60:63]
v_mfma_f32_16x16x32_bf16 v[64:67], v[80:83], v[252:255], v[64:67]
v_mfma_f32_16x16x32_bf16 v[68:71], v[84:87], v[252:255], v[68:71]
v_cvt_pk_bf16_f32 v8, v32, v33
v_cvt_pk_bf16_f32 v9, v34, v35
v_cvt_pk_bf16_f32 v10, v40, v41
v_cvt_pk_bf16_f32 v11, v42, v43
s_add_u32 s34, s21, 0
buffer_store_dwordx4 v[8:11], v1, s[4:7], s34 offen
v_cvt_pk_bf16_f32 v12, v36, v37
v_cvt_pk_bf16_f32 v13, v38, v39
v_cvt_pk_bf16_f32 v14, v44, v45
v_cvt_pk_bf16_f32 v15, v46, v47
s_add_u32 s34, s21, 6144
buffer_store_dwordx4 v[12:15], v1, s[4:7], s34 offen
v_cvt_pk_bf16_f32 v8, v48, v49
v_cvt_pk_bf16_f32 v9, v50, v51
v_cvt_pk_bf16_f32 v10, v56, v57
v_cvt_pk_bf16_f32 v11, v58, v59
s_add_u32 s34, s21, 1024
buffer_store_dwordx4 v[8:11], v1, s[4:7], s34 offen
v_cvt_pk_bf16_f32 v12, v52, v53
v_cvt_pk_bf16_f32 v13, v54, v55
v_cvt_pk_bf16_f32 v14, v60, v61
v_cvt_pk_bf16_f32 v15, v62, v63
s_add_u32 s34, s21, 7168
buffer_store_dwordx4 v[12:15], v1, s[4:7], s34 offen
v_cvt_pk_bf16_f32 v8, v64, v65
v_cvt_pk_bf16_f32 v9, v66, v67
v_cvt_pk_bf16_f32 v10, v68, v69
v_cvt_pk_bf16_f32 v11, v70, v71
s_add_u32 s34, s23, 0
buffer_store_dwordx4 v[8:11], v1, s[4:7], s34 offen
s_waitcnt vmcnt(0)
s_barrier
s_add_u32 s17, s17, 1
v_mov_b32 v28, s17
buffer_store_dword v28, v4, s[4:7], s24 offen
s_cmp_lt_u32 s17, 64
s_cbranch_scc1 reca_ptop233
s_branch reca_exit1
reca_pslow232:
reca_ptop238:
s_cmp_lt_u32 s17, 3
s_cbranch_scc1 reca_pgo239
s_sub_u32 s36, s17, 3
reca_ppoll240:
buffer_load_dword v28, v4, s[4:7], s25 offen sc1
s_waitcnt vmcnt(0)
v_readfirstlane_b32 s34, v28
s_nop 3
s_cmp_ge_i32 s34, s36
s_cbranch_scc1 reca_pgo239
s_sleep 8
s_sub_u32 s18, s18, 1
s_cbranch_scc0 reca_ppoll240
s_mov_b32 s18, 0
reca_pgo239:
s_waitcnt vmcnt(0)
s_barrier
v_add_u32 v7, s26, v1
s_xor_b32 s26, s26, 40960
s_add_u32 s37, s17, 1
s_cmp_ge_u32 s37, 64
s_cbranch_scc1 reca_pnodma241
s_mul_i32 s20, s37, 40960
s_add_u32 s20, s20, 84934656
s_add_u32 m0, s26, 0
s_nop 0
buffer_load_dwordx4 v1, s[4:7], s20 offen offset:0 lds
buffer_load_dwordx4 v1, s[4:7], s20 offen offset:1024 lds
buffer_load_dwordx4 v1, s[4:7], s20 offen offset:2048 lds
buffer_load_dwordx4 v1, s[4:7], s20 offen offset:3072 lds
s_add_u32 s20, s20, 4096
s_add_u32 m0, s26, 4096
s_nop 0
buffer_load_dwordx4 v1, s[4:7], s20 offen offset:0 lds
buffer_load_dwordx4 v1, s[4:7], s20 offen offset:1024 lds
buffer_load_dwordx4 v1, s[4:7], s20 offen offset:2048 lds
buffer_load_dwordx4 v1, s[4:7], s20 offen offset:3072 lds
s_add_u32 s20, s20, 4096
s_add_u32 m0, s26, 8192
s_nop 0
buffer_load_dwordx4 v1, s[4:7], s20 offen offset:0 lds
buffer_load_dwordx4 v1, s[4:7], s20 offen offset:1024 lds
reca_pnodma241:
s_lshl_b32 s34, s15, 3
s_and_b32 s35, s17, 7
s_add_u32 s34, s34, s35
s_mul_i32 s34, s34, 12288
s_mul_i32 s35, s16, 3072
s_add_u32 s35, s35, s34
s_add_u32 s21, s35, 37748736
s_add_u32 s22, s35, 44040192
s_mul_i32 s35, s16, 6144
s_add_u32 s35, s35, s34
s_add_u32 s23, s35, 40894464
ds_read_b128 v[72:75], v7 offset:0
ds_read_b128 v[76:79], v7 offset:20480
ds_read_b128 v[80:83], v7 offset:1024
ds_read_b128 v[84:87], v7 offset:21504
ds_read_b128 v[88:91], v7 offset:2048
ds_read_b128 v[92:95], v7 offset:22528
s_waitcnt lgkmcnt(4)
v_mfma_f32_16x16x32_bf16 v[32:35], a[0:3], v[72:75], 0
v_mfma_f32_16x16x32_bf16 v[36:39], a[0:3], v[76:79], 0
v_mfma_f32_16x16x32_bf16 v[40:43], a[80:83], v[72:75], 0
v_mfma_f32_16x16x32_bf16 v[44:47], a[80:83], v[76:79], 0
v_mfma_f32_16x16x32_bf16 v[48:51], a[160:163], v[72:75], 0
v_mfma_f32_16x16x32_bf16 v[52:55], a[160:163], v[76:79], 0
v_mfma_f32_16x16x32_bf16 v[56:59], v[96:99], v[72:75], 0
v_mfma_f32_16x16x32_bf16 v[60:63], v[96:99], v[76:79], 0
v_mfma_f32_16x16x32_bf16 v[64:67], v[72:75], v[176:179], 0
v_mfma_f32_16x16x32_bf16 v[68:71], v[76:79], v[176:179], 0
ds_read_b128 v[72:75], v7 offset:3072
ds_read_b128 v[76:79], v7 offset:23552
s_waitcnt lgkmcnt(4)
v_mfma_f32_16x16x32_bf16 v[32:35], a[4:7], v[80:83], v[32:35]
v_mfma_f32_16x16x32_bf16 v[36:39], a[4:7], v[84:87], v[36:39]
v_mfma_f32_16x16x32_bf16 v[40:43], a[84:87], v[80:83], v[40:43]
v_mfma_f32_16x16x32_bf16 v[44:47], a[84:87], v[84:87], v[44:47]
v_mfma_f32_16x16x32_bf16 v[48:51], a[164:167], v[80:83], v[48:51]
v_mfma_f32_16x16x32_bf16 v[52:55], a[164:167], v[84:87], v[52:55]
v_mfma_f32_16x16x32_bf16 v[56:59], v[100:103], v[80:83], v[56:59]
v_mfma_f32_16x16x32_bf16 v[60:63], v[100:103], v[84:87], v[60:63]
v_mfma_f32_16x16x32_bf16 v[64:67], v[80:83], v[180:183], v[64:67]
v_mfma_f32_16x16x32_bf16 v[68:71], v[84:87], v[180:183], v[68:71]
ds_read_b128 v[80:83], v7 offset:4096
ds_read_b128 v[84:87], v7 offset:24576
s_waitcnt lgkmcnt(4)
v_mfma_f32_16x16x32_bf16 v[32:35], a[8:11], v[88:91], v[32:35]
v_mfma_f32_16x16x32_bf16 v[36:39], a[8:11], v[92:95], v[36:39]
v_mfma_f32_16x16x32_bf16 v[40:43], a[88:91], v[88:91], v[40:43]
v_mfma_f32_16x16x32_bf16 v[44:47], a[88:91], v[92:95], v[44:47]
v_mfma_f32_16x16x32_bf16 v[48:51], a[168:171], v[88:91], v[48:51]
v_mfma_f32_16x16x32_bf16 v[52:55], a[168:171], v[92:95], v[52:55]
v_mfma_f32_16x16x32_bf16 v[56:59], v[104:107], v[88:91], v[56:59]
v_mfma_f32_16x16x32_bf16 v[60:63], v[104:107], v[92:95], v[60:63]
v_mfma_f32_16x16x32_bf16 v[64:67], v[88:91], v[184:187], v[64:67]
v_mfma_f32_16x16x32_bf16 v[68:71], v[92:95], v[184:187], v[68:71]
ds_read_b128 v[88:91], v7 offset:5120
ds_read_b128 v[92:95], v7 offset:25600
s_waitcnt lgkmcnt(4)
v_mfma_f32_16x16x32_bf16 v[32:35], a[12:15], v[72:75], v[32:35]
v_mfma_f32_16x16x32_bf16 v[36:39], a[12:15], v[76:79], v[36:39]
v_mfma_f32_16x16x32_bf16 v[40:43], a[92:95], v[72:75], v[40:43]
v_mfma_f32_16x16x32_bf16 v[44:47], a[92:95], v[76:79], v[44:47]
v_mfma_f32_16x16x32_bf16 v[48:51], a[172:175], v[72:75], v[48:51]
v_mfma_f32_16x16x32_bf16 v[52:55], a[172:175], v[76:79], v[52:55]
v_mfma_f32_16x16x32_bf16 v[56:59], v[108:111], v[72:75], v[56:59]
v_mfma_f32_16x16x32_bf16 v[60:63], v[108:111], v[76:79], v[60:63]
v_mfma_f32_16x16x32_bf16 v[64:67], v[72:75], v[188:191], v[64:67]
v_mfma_f32_16x16x32_bf16 v[68:71], v[76:79], v[188:191], v[68:71]
ds_read_b128 v[72:75], v7 offset:6144
ds_read_b128 v[76:79], v7 offset:26624
s_waitcnt lgkmcnt(4)
v_mfma_f32_16x16x32_bf16 v[32:35], a[16:19], v[80:83], v[32:35]
v_mfma_f32_16x16x32_bf16 v[36:39], a[16:19], v[84:87], v[36:39]
v_mfma_f32_16x16x32_bf16 v[40:43], a[96:99], v[80:83], v[40:43]
v_mfma_f32_16x16x32_bf16 v[44:47], a[96:99], v[84:87], v[44:47]
v_mfma_f32_16x16x32_bf16 v[48:51], a[176:179], v[80:83], v[48:51]
v_mfma_f32_16x16x32_bf16 v[52:55], a[176:179], v[84:87], v[52:55]
v_mfma_f32_16x16x32_bf16 v[56:59], v[112:115], v[80:83], v[56:59]
v_mfma_f32_16x16x32_bf16 v[60:63], v[112:115], v[84:87], v[60:63]
v_mfma_f32_16x16x32_bf16 v[64:67], v[80:83], v[192:195], v[64:67]
v_mfma_f32_16x16x32_bf16 v[68:71], v[84:87], v[192:195], v[68:71]
ds_read_b128 v[80:83], v7 offset:7168
ds_read_b128 v[84:87], v7 offset:27648
s_waitcnt lgkmcnt(4)
v_mfma_f32_16x16x32_bf16 v[32:35], a[20:23], v[88:91], v[32:35]
v_mfma_f32_16x16x32_bf16 v[36:39], a[20:23], v[92:95], v[36:39]
v_mfma_f32_16x16x32_bf16 v[40:43], a[100:103], v[88:91], v[40:43]
v_mfma_f32_16x16x32_bf16 v[44:47], a[100:103], v[92:95], v[44:47]
v_mfma_f32_16x16x32_bf16 v[48:51], a[180:183], v[88:91], v[48:51]
v_mfma_f32_16x16x32_bf16 v[52:55], a[180:183], v[92:95], v[52:55]
v_mfma_f32_16x16x32_bf16 v[56:59], v[116:119], v[88:91], v[56:59]
v_mfma_f32_16x16x32_bf16 v[60:63], v[116:119], v[92:95], v[60:63]
v_mfma_f32_16x16x32_bf16 v[64:67], v[88:91], v[196:199], v[64:67]
v_mfma_f32_16x16x32_bf16 v[68:71], v[92:95], v[196:199], v[68:71]
ds_read_b128 v[88:91], v7 offset:8192
ds_read_b128 v[92:95], v7 offset:28672
s_waitcnt lgkmcnt(4)
v_mfma_f32_16x16x32_bf16 v[32:35], a[24:27], v[72:75], v[32:35]
v_mfma_f32_16x16x32_bf16 v[36:39], a[24:27], v[76:79], v[36:39]
v_mfma_f32_16x16x32_bf16 v[40:43], a[104:107], v[72:75], v[40:43]
v_mfma_f32_16x16x32_bf16 v[44:47], a[104:107], v[76:79], v[44:47]
v_mfma_f32_16x16x32_bf16 v[48:51], a[184:187], v[72:75], v[48:51]
v_mfma_f32_16x16x32_bf16 v[52:55], a[184:187], v[76:79], v[52:55]
v_mfma_f32_16x16x32_bf16 v[56:59], v[120:123], v[72:75], v[56:59]
v_mfma_f32_16x16x32_bf16 v[60:63], v[120:123], v[76:79], v[60:63]
v_mfma_f32_16x16x32_bf16 v[64:67], v[72:75], v[200:203], v[64:67]
v_mfma_f32_16x16x32_bf16 v[68:71], v[76:79], v[200:203], v[68:71]
ds_read_b128 v[72:75], v7 offset:9216
ds_read_b128 v[76:79], v7 offset:29696
s_waitcnt lgkmcnt(4)
v_mfma_f32_16x16x32_bf16 v[32:35], a[28:31], v[80:83], v[32:35]
v_mfma_f32_16x16x32_bf16 v[36:39], a[28:31], v[84:87], v[36:39]
v_mfma_f32_16x16x32_bf16 v[40:43], a[108:111], v[80:83], v[40:43]
v_mfma_f32_16x16x32_bf16 v[44:47], a[108:111], v[84:87], v[44:47]
v_mfma_f32_16x16x32_bf16 v[48:51], a[188:191], v[80:83], v[48:51]
v_mfma_f32_16x16x32_bf16 v[52:55], a[188:191], v[84:87], v[52:55]
v_mfma_f32_16x16x32_bf16 v[56:59], v[124:127], v[80:83], v[56:59]
v_mfma_f32_16x16x32_bf16 v[60:63], v[124:127], v[84:87], v[60:63]
v_mfma_f32_16x16x32_bf16 v[64:67], v[80:83], v[204:207], v[64:67]
v_mfma_f32_16x16x32_bf16 v[68:71], v[84:87], v[204:207], v[68:71]
ds_read_b128 v[80:83], v7 offset:10240
ds_read_b128 v[84:87], v7 offset:30720
s_waitcnt lgkmcnt(4)
v_mfma_f32_16x16x32_bf16 v[32:35], a[32:35], v[88:91], v[32:35]
v_mfma_f32_16x16x32_bf16 v[36:39], a[32:35], v[92:95], v[36:39]
v_mfma_f32_16x16x32_bf16 v[40:43], a[112:115], v[88:91], v[40:43]
v_mfma_f32_16x16x32_bf16 v[44:47], a[112:115], v[92:95], v[44:47]
v_mfma_f32_16x16x32_bf16 v[48:51], a[192:195], v[88:91], v[48:51]
v_mfma_f32_16x16x32_bf16 v[52:55], a[192:195], v[92:95], v[52:55]
v_mfma_f32_16x16x32_bf16 v[56:59], v[128:131], v[88:91], v[56:59]
v_mfma_f32_16x16x32_bf16 v[60:63], v[128:131], v[92:95], v[60:63]
v_mfma_f32_16x16x32_bf16 v[64:67], v[88:91], v[208:211], v[64:67]
v_mfma_f32_16x16x32_bf16 v[68:71], v[92:95], v[208:211], v[68:71]
ds_read_b128 v[88:91], v7 offset:11264
ds_read_b128 v[92:95], v7 offset:31744
s_waitcnt lgkmcnt(4)
v_mfma_f32_16x16x32_bf16 v[32:35], a[36:39], v[72:75], v[32:35]
v_mfma_f32_16x16x32_bf16 v[36:39], a[36:39], v[76:79], v[36:39]
v_mfma_f32_16x16x32_bf16 v[40:43], a[116:119], v[72:75], v[40:43]
v_mfma_f32_16x16x32_bf16 v[44:47], a[116:119], v[76:79], v[44:47]
v_mfma_f32_16x16x32_bf16 v[48:51], a[196:199], v[72:75], v[48:51]
v_mfma_f32_16x16x32_bf16 v[52:55], a[196:199], v[76:79], v[52:55]
v_mfma_f32_16x16x32_bf16 v[56:59], v[132:135], v[72:75], v[56:59]
v_mfma_f32_16x16x32_bf16 v[60:63], v[132:135], v[76:79], v[60:63]
v_mfma_f32_16x16x32_bf16 v[64:67], v[72:75], v[212:215], v[64:67]
v_mfma_f32_16x16x32_bf16 v[68:71], v[76:79], v[212:215], v[68:71]
ds_read_b128 v[72:75], v7 offset:12288
ds_read_b128 v[76:79], v7 offset:32768
s_waitcnt lgkmcnt(4)
v_mfma_f32_16x16x32_bf16 v[32:35], a[40:43], v[80:83], v[32:35]
v_mfma_f32_16x16x32_bf16 v[36:39], a[40:43], v[84:87], v[36:39]
v_mfma_f32_16x16x32_bf16 v[40:43], a[120:123], v[80:83], v[40:43]
v_mfma_f32_16x16x32_bf16 v[44:47], a[120:123], v[84:87], v[44:47]
v_mfma_f32_16x16x32_bf16 v[48:51], a[200:203], v[80:83], v[48:51]
v_mfma_f32_16x16x32_bf16 v[52:55], a[200:203], v[84:87], v[52:55]
v_mfma_f32_16x16x32_bf16 v[56:59], v[136:139], v[80:83], v[56:59]
v_mfma_f32_16x16x32_bf16 v[60:63], v[136:139], v[84:87], v[60:63]
v_mfma_f32_16x16x32_bf16 v[64:67], v[80:83], v[216:219], v[64:67]
v_mfma_f32_16x16x32_bf16 v[68:71], v[84:87], v[216:219], v[68:71]
ds_read_b128 v[80:83], v7 offset:13312
ds_read_b128 v[84:87], v7 offset:33792
s_waitcnt lgkmcnt(4)
v_mfma_f32_16x16x32_bf16 v[32:35], a[44:47], v[88:91], v[32:35]
v_mfma_f32_16x16x32_bf16 v[36:39], a[44:47], v[92:95], v[36:39]
v_mfma_f32_16x16x32_bf16 v[40:43], a[124:127], v[88:91], v[40:43]
v_mfma_f32_16x16x32_bf16 v[44:47], a[124:127], v[92:95], v[44:47]
v_mfma_f32_16x16x32_bf16 v[48:51], a[204:207], v[88:91], v[48:51]
v_mfma_f32_16x16x32_bf16 v[52:55], a[204:207], v[92:95], v[52:55]
v_mfma_f32_16x16x32_bf16 v[56:59], v[140:143], v[88:91], v[56:59]
v_mfma_f32_16x16x32_bf16 v[60:63], v[140:143], v[92:95], v[60:63]
v_mfma_f32_16x16x32_bf16 v[64:67], v[88:91], v[220:223], v[64:67]
v_mfma_f32_16x16x32_bf16 v[68:71], v[92:95], v[220:223], v[68:71]
ds_read_b128 v[88:91], v7 offset:14336
ds_read_b128 v[92:95], v7 offset:34816
s_waitcnt lgkmcnt(4)
v_mfma_f32_16x16x32_bf16 v[32:35], a[48:51], v[72:75], v[32:35]
v_mfma_f32_16x16x32_bf16 v[36:39], a[48:51], v[76:79], v[36:39]
v_mfma_f32_16x16x32_bf16 v[40:43], a[128:131], v[72:75], v[40:43]
v_mfma_f32_16x16x32_bf16 v[44:47], a[128:131], v[76:79], v[44:47]
v_mfma_f32_16x16x32_bf16 v[48:51], a[208:211], v[72:75], v[48:51]
v_mfma_f32_16x16x32_bf16 v[52:55], a[208:211], v[76:79], v[52:55]
v_mfma_f32_16x16x32_bf16 v[56:59], v[144:147], v[72:75], v[56:59]
v_mfma_f32_16x16x32_bf16 v[60:63], v[144:147], v[76:79], v[60:63]
v_mfma_f32_16x16x32_bf16 v[64:67], v[72:75], v[224:227], v[64:67]
v_mfma_f32_16x16x32_bf16 v[68:71], v[76:79], v[224:227], v[68:71]
ds_read_b128 v[72:75], v7 offset:15360
ds_read_b128 v[76:79], v7 offset:35840
s_waitcnt lgkmcnt(4)
v_mfma_f32_16x16x32_bf16 v[32:35], a[52:55], v[80:83], v[32:35]
v_mfma_f32_16x16x32_bf16 v[36:39], a[52:55], v[84:87], v[36:39]
v_mfma_f32_16x16x32_bf16 v[40:43], a[132:135], v[80:83], v[40:43]
v_mfma_f32_16x16x32_bf16 v[44:47], a[132:135], v[84:87], v[44:47]
v_mfma_f32_16x16x32_bf16 v[48:51], a[212:215], v[80:83], v[48:51]
v_mfma_f32_16x16x32_bf16 v[52:55], a[212:215], v[84:87], v[52:55]
v_mfma_f32_16x16x32_bf16 v[56:59], v[148:151], v[80:83], v[56:59]
v_mfma_f32_16x16x32_bf16 v[60:63], v[148:151], v[84:87], v[60:63]
v_mfma_f32_16x16x32_bf16 v[64:67], v[80:83], v[228:231], v[64:67]
v_mfma_f32_16x16x32_bf16 v[68:71], v[84:87], v[228:231], v[68:71]
ds_read_b128 v[80:83], v7 offset:16384
ds_read_b128 v[84:87], v7 offset:36864
s_waitcnt lgkmcnt(4)
v_mfma_f32_16x16x32_bf16 v[32:35], a[56:59], v[88:91], v[32:35]
v_mfma_f32_16x16x32_bf16 v[36:39], a[56:59], v[92:95], v[36:39]
v_mfma_f32_16x16x32_bf16 v[40:43], a[136:139], v[88:91], v[40:43]
v_mfma_f32_16x16x32_bf16 v[44:47], a[136:139], v[92:95], v[44:47]
v_mfma_f32_16x16x32_bf16 v[48:51], a[216:219], v[88:91], v[48:51]
v_mfma_f32_16x16x32_bf16 v[52:55], a[216:219], v[92:95], v[52:55]
v_mfma_f32_16x16x32_bf16 v[56:59], v[152:155], v[88:91], v[56:59]
v_mfma_f32_16x16x32_bf16 v[60:63], v[152:155], v[92:95], v[60:63]
v_mfma_f32_16x16x32_bf16 v[64:67], v[88:91], v[232:235], v[64:67]
v_mfma_f32_16x16x32_bf16 v[68:71], v[92:95], v[232:235], v[68:71]
ds_read_b128 v[88:91], v7 offset:17408
ds_read_b128 v[92:95], v7 offset:37888
s_waitcnt lgkmcnt(4)
v_mfma_f32_16x16x32_bf16 v[32:35], a[60:63], v[72:75], v[32:35]
v_mfma_f32_16x16x32_bf16 v[36:39], a[60:63], v[76:79], v[36:39]
v_mfma_f32_16x16x32_bf16 v[40:43], a[140:143], v[72:75], v[40:43]
v_mfma_f32_16x16x32_bf16 v[44:47], a[140:143], v[76:79], v[44:47]
v_mfma_f32_16x16x32_bf16 v[48:51], a[220:223], v[72:75], v[48:51]
v_mfma_f32_16x16x32_bf16 v[52:55], a[220:223], v[76:79], v[52:55]
v_mfma_f32_16x16x32_bf16 v[56:59], v[156:159], v[72:75], v[56:59]
v_mfma_f32_16x16x32_bf16 v[60:63], v[156:159], v[76:79], v[60:63]
v_mfma_f32_16x16x32_bf16 v[64:67], v[72:75], v[236:239], v[64:67]
v_mfma_f32_16x16x32_bf16 v[68:71], v[76:79], v[236:239], v[68:71]
ds_read_b128 v[72:75], v7 offset:18432
ds_read_b128 v[76:79], v7 offset:38912
s_waitcnt lgkmcnt(4)
v_mfma_f32_16x16x32_bf16 v[32:35], a[64:67], v[80:83], v[32:35]
v_mfma_f32_16x16x32_bf16 v[36:39], a[64:67], v[84:87], v[36:39]
v_mfma_f32_16x16x32_bf16 v[40:43], a[144:147], v[80:83], v[40:43]
v_mfma_f32_16x16x32_bf16 v[44:47], a[144:147], v[84:87], v[44:47]
v_mfma_f32_16x16x32_bf16 v[48:51], a[224:227], v[80:83], v[48:51]
v_mfma_f32_16x16x32_bf16 v[52:55], a[224:227], v[84:87], v[52:55]
v_mfma_f32_16x16x32_bf16 v[56:59], v[160:163], v[80:83], v[56:59]
v_mfma_f32_16x16x32_bf16 v[60:63], v[160:163], v[84:87], v[60:63]
v_mfma_f32_16x16x32_bf16 v[64:67], v[80:83], v[240:243], v[64:67]
v_mfma_f32_16x16x32_bf16 v[68:71], v[84:87], v[240:243], v[68:71]
ds_read_b128 v[80:83], v7 offset:19456
ds_read_b128 v[84:87], v7 offset:39936
s_waitcnt lgkmcnt(4)
v_mfma_f32_16x16x32_bf16 v[32:35], a[68:71], v[88:91], v[32:35]
v_mfma_f32_16x16x32_bf16 v[36:39], a[68:71], v[92:95], v[36:39]
v_mfma_f32_16x16x32_bf16 v[40:43], a[148:151], v[88:91], v[40:43]
v_mfma_f32_16x16x32_bf16 v[44:47], a[148:151], v[92:95], v[44:47]
v_mfma_f32_16x16x32_bf16 v[48:51], a[228:231], v[88:91], v[48:51]
v_mfma_f32_16x16x32_bf16 v[52:55], a[228:231], v[92:95], v[52:55]
v_mfma_f32_16x16x32_bf16 v[56:59], v[164:167], v[88:91], v[56:59]
v_mfma_f32_16x16x32_bf16 v[60:63], v[164:167], v[92:95], v[60:63]
v_mfma_f32_16x16x32_bf16 v[64:67], v[88:91], v[244:247], v[64:67]
v_mfma_f32_16x16x32_bf16 v[68:71], v[92:95], v[244:247], v[68:71]
s_waitcnt lgkmcnt(2)
v_mfma_f32_16x16x32_bf16 v[32:35], a[72:75], v[72:75], v[32:35]
v_mfma_f32_16x16x32_bf16 v[36:39], a[72:75], v[76:79], v[36:39]
v_mfma_f32_16x16x32_bf16 v[40:43], a[152:155], v[72:75], v[40:43]
v_mfma_f32_16x16x32_bf16 v[44:47], a[152:155], v[76:79], v[44:47]
v_mfma_f32_16x16x32_bf16 v[48:51], a[232:235], v[72:75], v[48:51]
v_mfma_f32_16x16x32_bf16 v[52:55], a[232:235], v[76:79], v[52:55]
v_mfma_f32_16x16x32_bf16 v[56:59], v[168:171], v[72:75], v[56:59]
v_mfma_f32_16x16x32_bf16 v[60:63], v[168:171], v[76:79], v[60:63]
v_mfma_f32_16x16x32_bf16 v[64:67], v[72:75], v[248:251], v[64:67]
v_mfma_f32_16x16x32_bf16 v[68:71], v[76:79], v[248:251], v[68:71]
s_waitcnt lgkmcnt(0)
v_mfma_f32_16x16x32_bf16 v[32:35], a[76:79], v[80:83], v[32:35]
v_mfma_f32_16x16x32_bf16 v[36:39], a[76:79], v[84:87], v[36:39]
v_mfma_f32_16x16x32_bf16 v[40:43], a[156:159], v[80:83], v[40:43]
v_mfma_f32_16x16x32_bf16 v[44:47], a[156:159], v[84:87], v[44:47]
v_mfma_f32_16x16x32_bf16 v[48:51], a[236:239], v[80:83], v[48:51]
v_mfma_f32_16x16x32_bf16 v[52:55], a[236:239], v[84:87], v[52:55]
v_mfma_f32_16x16x32_bf16 v[56:59], v[172:175], v[80:83], v[56:59]
v_mfma_f32_16x16x32_bf16 v[60:63], v[172:175], v[84:87], v[60:63]
v_mfma_f32_16x16x32_bf16 v[64:67], v[80:83], v[252:255], v[64:67]
v_mfma_f32_16x16x32_bf16 v[68:71], v[84:87], v[252:255], v[68:71]
v_cvt_pk_bf16_f32 v8, v32, v33
v_cvt_pk_bf16_f32 v9, v34, v35
v_cvt_pk_bf16_f32 v10, v40, v41
v_cvt_pk_bf16_f32 v11, v42, v43
s_add_u32 s34, s21, 0
buffer_store_dwordx4 v[8:11], v1, s[4:7], s34 offen sc1
v_cvt_pk_bf16_f32 v12, v36, v37
v_cvt_pk_bf16_f32 v13, v38, v39
v_cvt_pk_bf16_f32 v14, v44, v45
v_cvt_pk_bf16_f32 v15, v46, v47
s_add_u32 s34, s21, 6144
buffer_store_dwordx4 v[12:15], v1, s[4:7], s34 offen sc1
v_cvt_pk_bf16_f32 v8, v48, v49
v_cvt_pk_bf16_f32 v9, v50, v51
v_cvt_pk_bf16_f32 v10, v56, v57
v_cvt_pk_bf16_f32 v11, v58, v59
s_add_u32 s34, s21, 1024
buffer_store_dwordx4 v[8:11], v1, s[4:7], s34 offen sc1
v_cvt_pk_bf16_f32 v12, v52, v53
v_cvt_pk_bf16_f32 v13, v54, v55
v_cvt_pk_bf16_f32 v14, v60, v61
v_cvt_pk_bf16_f32 v15, v62, v63
s_add_u32 s34, s21, 7168
buffer_store_dwordx4 v[12:15], v1, s[4:7], s34 offen sc1
v_cvt_pk_bf16_f32 v8, v64, v65
v_cvt_pk_bf16_f32 v9, v66, v67
v_cvt_pk_bf16_f32 v10, v68, v69
v_cvt_pk_bf16_f32 v11, v70, v71
s_add_u32 s34, s23, 0
buffer_store_dwordx4 v[8:11], v1, s[4:7], s34 offen sc1
s_waitcnt vmcnt(0)
s_barrier
s_add_u32 s17, s17, 1
v_mov_b32 v28, s17
buffer_store_dword v28, v4, s[4:7], s24 offen sc1
s_cmp_lt_u32 s17, 64
s_cbranch_scc1 reca_ptop238
s_branch reca_exit1
reca_pw1_227:
s_mov_b32 s17, 0
s_mov_b32 s26, 0
s_mul_i32 s20, s17, 40960
s_add_u32 s20, s20, 84944896
s_add_u32 m0, s26, 10240
s_nop 0
buffer_load_dwordx4 v1, s[4:7], s20 offen offset:0 lds
buffer_load_dwordx4 v1, s[4:7], s20 offen offset:1024 lds
buffer_load_dwordx4 v1, s[4:7], s20 offen offset:2048 lds
buffer_load_dwordx4 v1, s[4:7], s20 offen offset:3072 lds
s_add_u32 s20, s20, 4096
s_add_u32 m0, s26, 14336
s_nop 0
buffer_load_dwordx4 v1, s[4:7], s20 offen offset:0 lds
buffer_load_dwordx4 v1, s[4:7], s20 offen offset:1024 lds
buffer_load_dwordx4 v1, s[4:7], s20 offen offset:2048 lds
buffer_load_dwordx4 v1, s[4:7], s20 offen offset:3072 lds
s_add_u32 s20, s20, 4096
s_add_u32 m0, s26, 18432
s_nop 0
buffer_load_dwordx4 v1, s[4:7], s20 offen offset:0 lds
buffer_load_dwordx4 v1, s[4:7], s20 offen offset:1024 lds
s_mul_i32 s34, s15, 12
s_mul_i32 s35, s16, 6
s_add_u32 s34, s34, s35
s_add_u32 s34, s34, 4
s_mul_i32 s34, s34, 20480
s_add_u32 s34, s34, 14155776
buffer_load_dwordx4 a[0:3], v1, s[4:7], s34 offen offset:0
buffer_load_dwordx4 a[4:7], v1, s[4:7], s34 offen offset:1024
buffer_load_dwordx4 a[8:11], v1, s[4:7], s34 offen offset:2048
buffer_load_dwordx4 a[12:15], v1, s[4:7], s34 offen offset:3072
s_add_u32 s34, s34, 4096
buffer_load_dwordx4 a[16:19], v1, s[4:7], s34 offen offset:0
buffer_load_dwordx4 a[20:23], v1, s[4:7], s34 offen offset:1024
buffer_load_dwordx4 a[24:27], v1, s[4:7], s34 offen offset:2048
buffer_load_dwordx4 a[28:31], v1, s[4:7], s34 offen offset:3072
s_add_u32 s34, s34, 4096
buffer_load_dwordx4 a[32:35], v1, s[4:7], s34 offen offset:0
buffer_load_dwordx4 a[36:39], v1, s[4:7], s34 offen offset:1024
buffer_load_dwordx4 a[40:43], v1, s[4:7], s34 offen offset:2048
buffer_load_dwordx4 a[44:47], v1, s[4:7], s34 offen offset:3072
s_add_u32 s34, s34, 4096
buffer_load_dwordx4 a[48:51], v1, s[4:7], s34 offen offset:0
buffer_load_dwordx4 a[52:55], v1, s[4:7], s34 offen offset:1024
buffer_load_dwordx4 a[56:59], v1, s[4:7], s34 offen offset:2048
buffer_load_dwordx4 a[60:63], v1, s[4:7], s34 offen offset:3072
s_add_u32 s34, s34, 4096
buffer_load_dwordx4 a[64:67], v1, s[4:7], s34 offen offset:0
buffer_load_dwordx4 a[68:71], v1, s[4:7], s34 offen offset:1024
buffer_load_dwordx4 a[72:75], v1, s[4:7], s34 offen offset:2048
buffer_load_dwordx4 a[76:79], v1, s[4:7], s34 offen offset:3072
s_mul_i32 s34, s15, 12
s_mul_i32 s35, s16, 6
s_add_u32 s34, s34, s35
s_add_u32 s34, s34, 5
s_mul_i32 s34, s34, 20480
s_add_u32 s34, s34, 14155776
buffer_load_dwordx4 a[80:83], v1, s[4:7], s34 offen offset:0
buffer_load_dwordx4 a[84:87], v1, s[4:7], s34 offen offset:1024
buffer_load_dwordx4 a[88:91], v1, s[4:7], s34 offen offset:2048
buffer_load_dwordx4 a[92:95], v1, s[4:7], s34 offen offset:3072
s_add_u32 s34, s34, 4096
buffer_load_dwordx4 a[96:99], v1, s[4:7], s34 offen offset:0
buffer_load_dwordx4 a[100:103], v1, s[4:7], s34 offen offset:1024
buffer_load_dwordx4 a[104:107], v1, s[4:7], s34 offen offset:2048
buffer_load_dwordx4 a[108:111], v1, s[4:7], s34 offen offset:3072
s_add_u32 s34, s34, 4096
buffer_load_dwordx4 a[112:115], v1, s[4:7], s34 offen offset:0
buffer_load_dwordx4 a[116:119], v1, s[4:7], s34 offen offset:1024
buffer_load_dwordx4 a[120:123], v1, s[4:7], s34 offen offset:2048
buffer_load_dwordx4 a[124:127], v1, s[4:7], s34 offen offset:3072
s_add_u32 s34, s34, 4096
buffer_load_dwordx4 a[128:131], v1, s[4:7], s34 offen offset:0
buffer_load_dwordx4 a[132:135], v1, s[4:7], s34 offen offset:1024
buffer_load_dwordx4 a[136:139], v1, s[4:7], s34 offen offset:2048
buffer_load_dwordx4 a[140:143], v1, s[4:7], s34 offen offset:3072
s_add_u32 s34, s34, 4096
buffer_load_dwordx4 a[144:147], v1, s[4:7], s34 offen offset:0
buffer_load_dwordx4 a[148:151], v1, s[4:7], s34 offen offset:1024
buffer_load_dwordx4 a[152:155], v1, s[4:7], s34 offen offset:2048
buffer_load_dwordx4 a[156:159], v1, s[4:7], s34 offen offset:3072
s_waitcnt vmcnt(20)
s_mul_i32 s34, s15, 12
s_mul_i32 s35, s16, 6
s_add_u32 s34, s34, s35
s_add_u32 s34, s34, 1
s_mul_i32 s34, s34, 20480
s_add_u32 s34, s34, 22020096
buffer_load_dwordx4 a[160:163], v1, s[4:7], s34 offen offset:0
buffer_load_dwordx4 a[164:167], v1, s[4:7], s34 offen offset:1024
buffer_load_dwordx4 a[168:171], v1, s[4:7], s34 offen offset:2048
buffer_load_dwordx4 a[172:175], v1, s[4:7], s34 offen offset:3072
s_add_u32 s34, s34, 4096
buffer_load_dwordx4 a[176:179], v1, s[4:7], s34 offen offset:0
buffer_load_dwordx4 a[180:183], v1, s[4:7], s34 offen offset:1024
buffer_load_dwordx4 a[184:187], v1, s[4:7], s34 offen offset:2048
buffer_load_dwordx4 a[188:191], v1, s[4:7], s34 offen offset:3072
s_add_u32 s34, s34, 4096
buffer_load_dwordx4 a[192:195], v1, s[4:7], s34 offen offset:0
buffer_load_dwordx4 a[196:199], v1, s[4:7], s34 offen offset:1024
buffer_load_dwordx4 a[200:203], v1, s[4:7], s34 offen offset:2048
buffer_load_dwordx4 a[204:207], v1, s[4:7], s34 offen offset:3072
s_add_u32 s34, s34, 4096
buffer_load_dwordx4 a[208:211], v1, s[4:7], s34 offen offset:0
buffer_load_dwordx4 a[212:215], v1, s[4:7], s34 offen offset:1024
buffer_load_dwordx4 a[216:219], v1, s[4:7], s34 offen offset:2048
buffer_load_dwordx4 a[220:223], v1, s[4:7], s34 offen offset:3072
s_add_u32 s34, s34, 4096
buffer_load_dwordx4 a[224:227], v1, s[4:7], s34 offen offset:0
buffer_load_dwordx4 a[228:231], v1, s[4:7], s34 offen offset:1024
buffer_load_dwordx4 a[232:235], v1, s[4:7], s34 offen offset:2048
buffer_load_dwordx4 a[236:239], v1, s[4:7], s34 offen offset:3072
s_waitcnt vmcnt(20)
s_mul_i32 s34, s15, 12
s_mul_i32 s35, s16, 6
s_add_u32 s34, s34, s35
s_add_u32 s34, s34, 2
s_mul_i32 s34, s34, 20480
s_add_u32 s34, s34, 22020096
buffer_load_dwordx4 v[96:99], v1, s[4:7], s34 offen offset:0
buffer_load_dwordx4 v[100:103], v1, s[4:7], s34 offen offset:1024
buffer_load_dwordx4 v[104:107], v1, s[4:7], s34 offen offset:2048
buffer_load_dwordx4 v[108:111], v1, s[4:7], s34 offen offset:3072
s_add_u32 s34, s34, 4096
buffer_load_dwordx4 v[112:115], v1, s[4:7], s34 offen offset:0
buffer_load_dwordx4 v[116:119], v1, s[4:7], s34 offen offset:1024
buffer_load_dwordx4 v[120:123], v1, s[4:7], s34 offen offset:2048
buffer_load_dwordx4 v[124:127], v1, s[4:7], s34 offen offset:3072
s_add_u32 s34, s34, 4096
buffer_load_dwordx4 v[128:131], v1, s[4:7], s34 offen offset:0
buffer_load_dwordx4 v[132:135], v1, s[4:7], s34 offen offset:1024
buffer_load_dwordx4 v[136:139], v1, s[4:7], s34 offen offset:2048
buffer_load_dwordx4 v[140:143], v1, s[4:7], s34 offen offset:3072
s_add_u32 s34, s34, 4096
buffer_load_dwordx4 v[144:147], v1, s[4:7], s34 offen offset:0
buffer_load_dwordx4 v[148:151], v1, s[4:7], s34 offen offset:1024
buffer_load_dwordx4 v[152:155], v1, s[4:7], s34 offen offset:2048
buffer_load_dwordx4 v[156:159], v1, s[4:7], s34 offen offset:3072
s_add_u32 s34, s34, 4096
buffer_load_dwordx4 v[160:163], v1, s[4:7], s34 offen offset:0
buffer_load_dwordx4 v[164:167], v1, s[4:7], s34 offen offset:1024
buffer_load_dwordx4 v[168:171], v1, s[4:7], s34 offen offset:2048
buffer_load_dwordx4 v[172:175], v1, s[4:7], s34 offen offset:3072
s_waitcnt vmcnt(20)
s_mul_i32 s34, s15, 12
s_mul_i32 s35, s16, 6
s_add_u32 s34, s34, s35
s_add_u32 s34, s34, 3
s_mul_i32 s34, s34, 20480
s_add_u32 s34, s34, 22020096
buffer_load_dwordx4 v[176:179], v1, s[4:7], s34 offen offset:0
buffer_load_dwordx4 v[180:183], v1, s[4:7], s34 offen offset:1024
buffer_load_dwordx4 v[184:187], v1, s[4:7], s34 offen offset:2048
buffer_load_dwordx4 v[188:191], v1, s[4:7], s34 offen offset:3072
s_add_u32 s34, s34, 4096
buffer_load_dwordx4 v[192:195], v1, s[4:7], s34 offen offset:0
buffer_load_dwordx4 v[196:199], v1, s[4:7], s34 offen offset:1024
buffer_load_dwordx4 v[200:203], v1, s[4:7], s34 offen offset:2048
buffer_load_dwordx4 v[204:207], v1, s[4:7], s34 offen offset:3072
s_add_u32 s34, s34, 4096
buffer_load_dwordx4 v[208:211], v1, s[4:7], s34 offen offset:0
buffer_load_dwordx4 v[212:215], v1, s[4:7], s34 offen offset:1024
buffer_load_dwordx4 v[216:219], v1, s[4:7], s34 offen offset:2048
buffer_load_dwordx4 v[220:223], v1, s[4:7], s34 offen offset:3072
s_add_u32 s34, s34, 4096
buffer_load_dwordx4 v[224:227], v1, s[4:7], s34 offen offset:0
buffer_load_dwordx4 v[228:231], v1, s[4:7], s34 offen offset:1024
buffer_load_dwordx4 v[232:235], v1, s[4:7], s34 offen offset:2048
buffer_load_dwordx4 v[236:239], v1, s[4:7], s34 offen offset:3072
s_add_u32 s34, s34, 4096
buffer_load_dwordx4 v[240:243], v1, s[4:7], s34 offen offset:0
buffer_load_dwordx4 v[244:247], v1, s[4:7], s34 offen offset:1024
buffer_load_dwordx4 v[248:251], v1, s[4:7], s34 offen offset:2048
buffer_load_dwordx4 v[252:255], v1, s[4:7], s34 offen offset:3072
s_waitcnt vmcnt(20)
v_and_b32 v30, 7, v0
v_lshlrev_b32 v30, 3, v30
reca_cens243:
buffer_load_dwordx2 v[28:29], v30, s[8:11], 0 offen sc1
s_waitcnt vmcnt(0)
v_sad_u8 v31, v28, 0, 0
v_sad_u8 v31, v29, 0, v31
v_cmp_gt_u32 vcc, 32, v31
s_cbranch_vccz reca_censok244
s_sleep 8
s_sub_u32 s18, s18, 1
s_cbranch_scc0 reca_cens243
s_mov_b32 s18, 0
reca_censok244:
v_and_b32 v28, 0x20202020, v28
v_and_b32 v29, 0x20202020, v29
v_cmp_ne_u32 s[34:35], 0, v28
v_cmp_ne_u32 s[36:37], 0, v29
s_nop 3
s_and_b32 s34, s34, 0xff
s_and_b32 s36, s36, 0xff
s_or_b32 s35, s34, s36
s_lshr_b32 s37, s35, s13
s_and_b32 s37, s37, 1
s_xor_b32 s43, s37, 1
s_cmp_eq_u32 s57, 0
s_cselect_b32 s58, s36, s34
v_mov_b32 v31, 0x80000000
s_cmp_lg_u32 s43, 0
s_cbranch_scc1 reca_pslow245
reca_ptop246:
s_cmp_lt_u32 s17, 3
s_cbranch_scc1 reca_pgo247
s_sub_u32 s36, s17, 3
reca_ppoll248:
buffer_load_dword v28, v4, s[4:7], s25 offen sc1
s_waitcnt vmcnt(0)
v_readfirstlane_b32 s34, v28
s_nop 3
s_cmp_ge_i32 s34, s36
s_cbranch_scc1 reca_pgo247
s_sleep 8
s_sub_u32 s18, s18, 1
s_cbranch_scc0 reca_ppoll248
s_mov_b32 s18, 0
reca_pgo247:
s_waitcnt vmcnt(0)
s_barrier
v_add_u32 v7, s26, v1
s_xor_b32 s26, s26, 40960
s_add_u32 s37, s17, 1
s_cmp_ge_u32 s37, 64
s_cbranch_scc1 reca_pnodma249
s_mul_i32 s20, s37, 40960
s_add_u32 s20, s20, 84944896
s_add_u32 m0, s26, 10240
s_nop 0
buffer_load_dwordx4 v1, s[4:7], s20 offen offset:0 lds
buffer_load_dwordx4 v1, s[4:7], s20 offen offset:1024 lds
buffer_load_dwordx4 v1, s[4:7], s20 offen offset:2048 lds
buffer_load_dwordx4 v1, s[4:7], s20 offen offset:3072 lds
s_add_u32 s20, s20, 4096
s_add_u32 m0, s26, 14336
s_nop 0
buffer_load_dwordx4 v1, s[4:7], s20 offen offset:0 lds
buffer_load_dwordx4 v1, s[4:7], s20 offen offset:1024 lds
buffer_load_dwordx4 v1, s[4:7], s20 offen offset:2048 lds
buffer_load_dwordx4 v1, s[4:7], s20 offen offset:3072 lds
s_add_u32 s20, s20, 4096
s_add_u32 m0, s26, 18432
s_nop 0
buffer_load_dwordx4 v1, s[4:7], s20 offen offset:0 lds
buffer_load_dwordx4 v1, s[4:7], s20 offen offset:1024 lds
reca_pnodma249:
s_lshl_b32 s34, s15, 3
s_and_b32 s35, s17, 7
s_add_u32 s34, s34, s35
s_mul_i32 s34, s34, 12288
s_mul_i32 s35, s16, 3072
s_add_u32 s35, s35, s34
s_add_u32 s21, s35, 37748736
s_add_u32 s22, s35, 44040192
s_mul_i32 s35, s16, 6144
s_add_u32 s35, s35, s34
s_add_u32 s23, s35, 40894464
ds_read_b128 v[72:75], v7 offset:0
ds_read_b128 v[76:79], v7 offset:20480
ds_read_b128 v[80:83], v7 offset:1024
ds_read_b128 v[84:87], v7 offset:21504
ds_read_b128 v[88:91], v7 offset:2048
ds_read_b128 v[92:95], v7 offset:22528
s_waitcnt lgkmcnt(4)
v_mfma_f32_16x16x32_bf16 v[32:35], a[0:3], v[72:75], 0
v_mfma_f32_16x16x32_bf16 v[36:39], a[0:3], v[76:79], 0
v_mfma_f32_16x16x32_bf16 v[40:43], a[80:83], v[72:75], 0
v_mfma_f32_16x16x32_bf16 v[44:47], a[80:83], v[76:79], 0
v_mfma_f32_16x16x32_bf16 v[48:51], v[72:75], a[160:163], 0
v_mfma_f32_16x16x32_bf16 v[52:55], v[76:79], a[160:163], 0
v_mfma_f32_16x16x32_bf16 v[56:59], v[72:75], v[96:99], 0
v_mfma_f32_16x16x32_bf16 v[60:63], v[76:79], v[96:99], 0
v_mfma_f32_16x16x32_bf16 v[64:67], v[72:75], v[176:179], 0
v_mfma_f32_16x16x32_bf16 v[68:71], v[76:79], v[176:179], 0
ds_read_b128 v[72:75], v7 offset:3072
ds_read_b128 v[76:79], v7 offset:23552
s_waitcnt lgkmcnt(4)
v_mfma_f32_16x16x32_bf16 v[32:35], a[4:7], v[80:83], v[32:35]
v_mfma_f32_16x16x32_bf16 v[36:39], a[4:7], v[84:87], v[36:39]
v_mfma_f32_16x16x32_bf16 v[40:43], a[84:87], v[80:83], v[40:43]
v_mfma_f32_16x16x32_bf16 v[44:47], a[84:87], v[84:87], v[44:47]
v_mfma_f32_16x16x32_bf16 v[48:51], v[80:83], a[164:167], v[48:51]
v_mfma_f32_16x16x32_bf16 v[52:55], v[84:87], a[164:167], v[52:55]
v_mfma_f32_16x16x32_bf16 v[56:59], v[80:83], v[100:103], v[56:59]
v_mfma_f32_16x16x32_bf16 v[60:63], v[84:87], v[100:103], v[60:63]
v_mfma_f32_16x16x32_bf16 v[64:67], v[80:83], v[180:183], v[64:67]
v_mfma_f32_16x16x32_bf16 v[68:71], v[84:87], v[180:183], v[68:71]
ds_read_b128 v[80:83], v7 offset:4096
ds_read_b128 v[84:87], v7 offset:24576
s_waitcnt lgkmcnt(4)
v_mfma_f32_16x16x32_bf16 v[32:35], a[8:11], v[88:91], v[32:35]
v_mfma_f32_16x16x32_bf16 v[36:39], a[8:11], v[92:95], v[36:39]
v_mfma_f32_16x16x32_bf16 v[40:43], a[88:91], v[88:91], v[40:43]
v_mfma_f32_16x16x32_bf16 v[44:47], a[88:91], v[92:95], v[44:47]
v_mfma_f32_16x16x32_bf16 v[48:51], v[88:91], a[168:171], v[48:51]
v_mfma_f32_16x16x32_bf16 v[52:55], v[92:95], a[168:171], v[52:55]
v_mfma_f32_16x16x32_bf16 v[56:59], v[88:91], v[104:107], v[56:59]
v_mfma_f32_16x16x32_bf16 v[60:63], v[92:95], v[104:107], v[60:63]
v_mfma_f32_16x16x32_bf16 v[64:67], v[88:91], v[184:187], v[64:67]
v_mfma_f32_16x16x32_bf16 v[68:71], v[92:95], v[184:187], v[68:71]
ds_read_b128 v[88:91], v7 offset:5120
ds_read_b128 v[92:95], v7 offset:25600
s_waitcnt lgkmcnt(4)
v_mfma_f32_16x16x32_bf16 v[32:35], a[12:15], v[72:75], v[32:35]
v_mfma_f32_16x16x32_bf16 v[36:39], a[12:15], v[76:79], v[36:39]
v_mfma_f32_16x16x32_bf16 v[40:43], a[92:95], v[72:75], v[40:43]
v_mfma_f32_16x16x32_bf16 v[44:47], a[92:95], v[76:79], v[44:47]
v_mfma_f32_16x16x32_bf16 v[48:51], v[72:75], a[172:175], v[48:51]
v_mfma_f32_16x16x32_bf16 v[52:55], v[76:79], a[172:175], v[52:55]
v_mfma_f32_16x16x32_bf16 v[56:59], v[72:75], v[108:111], v[56:59]
v_mfma_f32_16x16x32_bf16 v[60:63], v[76:79], v[108:111], v[60:63]
v_mfma_f32_16x16x32_bf16 v[64:67], v[72:75], v[188:191], v[64:67]
v_mfma_f32_16x16x32_bf16 v[68:71], v[76:79], v[188:191], v[68:71]
ds_read_b128 v[72:75], v7 offset:6144
ds_read_b128 v[76:79], v7 offset:26624
s_waitcnt lgkmcnt(4)
v_mfma_f32_16x16x32_bf16 v[32:35], a[16:19], v[80:83], v[32:35]
v_mfma_f32_16x16x32_bf16 v[36:39], a[16:19], v[84:87], v[36:39]
v_mfma_f32_16x16x32_bf16 v[40:43], a[96:99], v[80:83], v[40:43]
v_mfma_f32_16x16x32_bf16 v[44:47], a[96:99], v[84:87], v[44:47]
v_mfma_f32_16x16x32_bf16 v[48:51], v[80:83], a[176:179], v[48:51]
v_mfma_f32_16x16x32_bf16 v[52:55], v[84:87], a[176:179], v[52:55]
v_mfma_f32_16x16x32_bf16 v[56:59], v[80:83], v[112:115], v[56:59]
v_mfma_f32_16x16x32_bf16 v[60:63], v[84:87], v[112:115], v[60:63]
v_mfma_f32_16x16x32_bf16 v[64:67], v[80:83], v[192:195], v[64:67]
v_mfma_f32_16x16x32_bf16 v[68:71], v[84:87], v[192:195], v[68:71]
ds_read_b128 v[80:83], v7 offset:7168
ds_read_b128 v[84:87], v7 offset:27648
s_waitcnt lgkmcnt(4)
v_mfma_f32_16x16x32_bf16 v[32:35], a[20:23], v[88:91], v[32:35]
v_mfma_f32_16x16x32_bf16 v[36:39], a[20:23], v[92:95], v[36:39]
v_mfma_f32_16x16x32_bf16 v[40:43], a[100:103], v[88:91], v[40:43]
v_mfma_f32_16x16x32_bf16 v[44:47], a[100:103], v[92:95], v[44:47]
v_mfma_f32_16x16x32_bf16 v[48:51], v[88:91], a[180:183], v[48:51]
v_mfma_f32_16x16x32_bf16 v[52:55], v[92:95], a[180:183], v[52:55]
v_mfma_f32_16x16x32_bf16 v[56:59], v[88:91], v[116:119], v[56:59]
v_mfma_f32_16x16x32_bf16 v[60:63], v[92:95], v[116:119], v[60:63]
v_mfma_f32_16x16x32_bf16 v[64:67], v[88:91], v[196:199], v[64:67]
v_mfma_f32_16x16x32_bf16 v[68:71], v[92:95], v[196:199], v[68:71]
ds_read_b128 v[88:91], v7 offset:8192
ds_read_b128 v[92:95], v7 offset:28672
s_waitcnt lgkmcnt(4)
v_mfma_f32_16x16x32_bf16 v[32:35], a[24:27], v[72:75], v[32:35]
v_mfma_f32_16x16x32_bf16 v[36:39], a[24:27], v[76:79], v[36:39]
v_mfma_f32_16x16x32_bf16 v[40:43], a[104:107], v[72:75], v[40:43]
v_mfma_f32_16x16x32_bf16 v[44:47], a[104:107], v[76:79], v[44:47]
v_mfma_f32_16x16x32_bf16 v[48:51], v[72:75], a[184:187], v[48:51]
v_mfma_f32_16x16x32_bf16 v[52:55], v[76:79], a[184:187], v[52:55]
v_mfma_f32_16x16x32_bf16 v[56:59], v[72:75], v[120:123], v[56:59]
v_mfma_f32_16x16x32_bf16 v[60:63], v[76:79], v[120:123], v[60:63]
v_mfma_f32_16x16x32_bf16 v[64:67], v[72:75], v[200:203], v[64:67]
v_mfma_f32_16x16x32_bf16 v[68:71], v[76:79], v[200:203], v[68:71]
ds_read_b128 v[72:75], v7 offset:9216
ds_read_b128 v[76:79], v7 offset:29696
s_waitcnt lgkmcnt(4)
v_mfma_f32_16x16x32_bf16 v[32:35], a[28:31], v[80:83], v[32:35]
v_mfma_f32_16x16x32_bf16 v[36:39], a[28:31], v[84:87], v[36:39]
v_mfma_f32_16x16x32_bf16 v[40:43], a[108:111], v[80:83], v[40:43]
v_mfma_f32_16x16x32_bf16 v[44:47], a[108:111], v[84:87], v[44:47]
v_mfma_f32_16x16x32_bf16 v[48:51], v[80:83], a[188:191], v[48:51]
v_mfma_f32_16x16x32_bf16 v[52:55], v[84:87], a[188:191], v[52:55]
v_mfma_f32_16x16x32_bf16 v[56:59], v[80:83], v[124:127], v[56:59]
v_mfma_f32_16x16x32_bf16 v[60:63], v[84:87], v[124:127], v[60:63]
v_mfma_f32_16x16x32_bf16 v[64:67], v[80:83], v[204:207], v[64:67]
v_mfma_f32_16x16x32_bf16 v[68:71], v[84:87], v[204:207], v[68:71]
ds_read_b128 v[80:83], v7 offset:10240
ds_read_b128 v[84:87], v7 offset:30720
s_waitcnt lgkmcnt(4)
v_mfma_f32_16x16x32_bf16 v[32:35], a[32:35], v[88:91], v[32:35]
v_mfma_f32_16x16x32_bf16 v[36:39], a[32:35], v[92:95], v[36:39]
v_mfma_f32_16x16x32_bf16 v[40:43], a[112:115], v[88:91], v[40:43]
v_mfma_f32_16x16x32_bf16 v[44:47], a[112:115], v[92:95], v[44:47]
v_mfma_f32_16x16x32_bf16 v[48:51], v[88:91], a[192:195], v[48:51]
v_mfma_f32_16x16x32_bf16 v[52:55], v[92:95], a[192:195], v[52:55]
v_mfma_f32_16x16x32_bf16 v[56:59], v[88:91], v[128:131], v[56:59]
v_mfma_f32_16x16x32_bf16 v[60:63], v[92:95], v[128:131], v[60:63]
v_mfma_f32_16x16x32_bf16 v[64:67], v[88:91], v[208:211], v[64:67]
v_mfma_f32_16x16x32_bf16 v[68:71], v[92:95], v[208:211], v[68:71]
ds_read_b128 v[88:91], v7 offset:11264
ds_read_b128 v[92:95], v7 offset:31744
s_waitcnt lgkmcnt(4)
v_mfma_f32_16x16x32_bf16 v[32:35], a[36:39], v[72:75], v[32:35]
v_mfma_f32_16x16x32_bf16 v[36:39], a[36:39], v[76:79], v[36:39]
v_mfma_f32_16x16x32_bf16 v[40:43], a[116:119], v[72:75], v[40:43]
v_mfma_f32_16x16x32_bf16 v[44:47], a[116:119], v[76:79], v[44:47]
v_mfma_f32_16x16x32_bf16 v[48:51], v[72:75], a[196:199], v[48:51]
v_mfma_f32_16x16x32_bf16 v[52:55], v[76:79], a[196:199], v[52:55]
v_mfma_f32_16x16x32_bf16 v[56:59], v[72:75], v[132:135], v[56:59]
v_mfma_f32_16x16x32_bf16 v[60:63], v[76:79], v[132:135], v[60:63]
v_mfma_f32_16x16x32_bf16 v[64:67], v[72:75], v[212:215], v[64:67]
v_mfma_f32_16x16x32_bf16 v[68:71], v[76:79], v[212:215], v[68:71]
ds_read_b128 v[72:75], v7 offset:12288
ds_read_b128 v[76:79], v7 offset:32768
s_waitcnt lgkmcnt(4)
v_mfma_f32_16x16x32_bf16 v[32:35], a[40:43], v[80:83], v[32:35]
v_mfma_f32_16x16x32_bf16 v[36:39], a[40:43], v[84:87], v[36:39]
v_mfma_f32_16x16x32_bf16 v[40:43], a[120:123], v[80:83], v[40:43]
v_mfma_f32_16x16x32_bf16 v[44:47], a[120:123], v[84:87], v[44:47]
v_mfma_f32_16x16x32_bf16 v[48:51], v[80:83], a[200:203], v[48:51]
v_mfma_f32_16x16x32_bf16 v[52:55], v[84:87], a[200:203], v[52:55]
v_mfma_f32_16x16x32_bf16 v[56:59], v[80:83], v[136:139], v[56:59]
v_mfma_f32_16x16x32_bf16 v[60:63], v[84:87], v[136:139], v[60:63]
v_mfma_f32_16x16x32_bf16 v[64:67], v[80:83], v[216:219], v[64:67]
v_mfma_f32_16x16x32_bf16 v[68:71], v[84:87], v[216:219], v[68:71]
ds_read_b128 v[80:83], v7 offset:13312
ds_read_b128 v[84:87], v7 offset:33792
s_waitcnt lgkmcnt(4)
v_mfma_f32_16x16x32_bf16 v[32:35], a[44:47], v[88:91], v[32:35]
v_mfma_f32_16x16x32_bf16 v[36:39], a[44:47], v[92:95], v[36:39]
v_mfma_f32_16x16x32_bf16 v[40:43], a[124:127], v[88:91], v[40:43]
v_mfma_f32_16x16x32_bf16 v[44:47], a[124:127], v[92:95], v[44:47]
v_mfma_f32_16x16x32_bf16 v[48:51], v[88:91], a[204:207], v[48:51]
v_mfma_f32_16x16x32_bf16 v[52:55], v[92:95], a[204:207], v[52:55]
v_mfma_f32_16x16x32_bf16 v[56:59], v[88:91], v[140:143], v[56:59]
v_mfma_f32_16x16x32_bf16 v[60:63], v[92:95], v[140:143], v[60:63]
v_mfma_f32_16x16x32_bf16 v[64:67], v[88:91], v[220:223], v[64:67]
v_mfma_f32_16x16x32_bf16 v[68:71], v[92:95], v[220:223], v[68:71]
ds_read_b128 v[88:91], v7 offset:14336
ds_read_b128 v[92:95], v7 offset:34816
s_waitcnt lgkmcnt(4)
v_mfma_f32_16x16x32_bf16 v[32:35], a[48:51], v[72:75], v[32:35]
v_mfma_f32_16x16x32_bf16 v[36:39], a[48:51], v[76:79], v[36:39]
v_mfma_f32_16x16x32_bf16 v[40:43], a[128:131], v[72:75], v[40:43]
v_mfma_f32_16x16x32_bf16 v[44:47], a[128:131], v[76:79], v[44:47]
v_mfma_f32_16x16x32_bf16 v[48:51], v[72:75], a[208:211], v[48:51]
v_mfma_f32_16x16x32_bf16 v[52:55], v[76:79], a[208:211], v[52:55]
v_mfma_f32_16x16x32_bf16 v[56:59], v[72:75], v[144:147], v[56:59]
v_mfma_f32_16x16x32_bf16 v[60:63], v[76:79], v[144:147], v[60:63]
v_mfma_f32_16x16x32_bf16 v[64:67], v[72:75], v[224:227], v[64:67]
v_mfma_f32_16x16x32_bf16 v[68:71], v[76:79], v[224:227], v[68:71]
ds_read_b128 v[72:75], v7 offset:15360
ds_read_b128 v[76:79], v7 offset:35840
s_waitcnt lgkmcnt(4)
v_mfma_f32_16x16x32_bf16 v[32:35], a[52:55], v[80:83], v[32:35]
v_mfma_f32_16x16x32_bf16 v[36:39], a[52:55], v[84:87], v[36:39]
v_mfma_f32_16x16x32_bf16 v[40:43], a[132:135], v[80:83], v[40:43]
v_mfma_f32_16x16x32_bf16 v[44:47], a[132:135], v[84:87], v[44:47]
v_mfma_f32_16x16x32_bf16 v[48:51], v[80:83], a[212:215], v[48:51]
v_mfma_f32_16x16x32_bf16 v[52:55], v[84:87], a[212:215], v[52:55]
v_mfma_f32_16x16x32_bf16 v[56:59], v[80:83], v[148:151], v[56:59]
v_mfma_f32_16x16x32_bf16 v[60:63], v[84:87], v[148:151], v[60:63]
v_mfma_f32_16x16x32_bf16 v[64:67], v[80:83], v[228:231], v[64:67]
v_mfma_f32_16x16x32_bf16 v[68:71], v[84:87], v[228:231], v[68:71]
ds_read_b128 v[80:83], v7 offset:16384
ds_read_b128 v[84:87], v7 offset:36864
s_waitcnt lgkmcnt(4)
v_mfma_f32_16x16x32_bf16 v[32:35], a[56:59], v[88:91], v[32:35]
v_mfma_f32_16x16x32_bf16 v[36:39], a[56:59], v[92:95], v[36:39]
v_mfma_f32_16x16x32_bf16 v[40:43], a[136:139], v[88:91], v[40:43]
v_mfma_f32_16x16x32_bf16 v[44:47], a[136:139], v[92:95], v[44:47]
v_mfma_f32_16x16x32_bf16 v[48:51], v[88:91], a[216:219], v[48:51]
v_mfma_f32_16x16x32_bf16 v[52:55], v[92:95], a[216:219], v[52:55]
v_mfma_f32_16x16x32_bf16 v[56:59], v[88:91], v[152:155], v[56:59]
v_mfma_f32_16x16x32_bf16 v[60:63], v[92:95], v[152:155], v[60:63]
v_mfma_f32_16x16x32_bf16 v[64:67], v[88:91], v[232:235], v[64:67]
v_mfma_f32_16x16x32_bf16 v[68:71], v[92:95], v[232:235], v[68:71]
ds_read_b128 v[88:91], v7 offset:17408
ds_read_b128 v[92:95], v7 offset:37888
s_waitcnt lgkmcnt(4)
v_mfma_f32_16x16x32_bf16 v[32:35], a[60:63], v[72:75], v[32:35]
v_mfma_f32_16x16x32_bf16 v[36:39], a[60:63], v[76:79], v[36:39]
v_mfma_f32_16x16x32_bf16 v[40:43], a[140:143], v[72:75], v[40:43]
v_mfma_f32_16x16x32_bf16 v[44:47], a[140:143], v[76:79], v[44:47]
v_mfma_f32_16x16x32_bf16 v[48:51], v[72:75], a[220:223], v[48:51]
v_mfma_f32_16x16x32_bf16 v[52:55], v[76:79], a[220:223], v[52:55]
v_mfma_f32_16x16x32_bf16 v[56:59], v[72:75], v[156:159], v[56:59]
v_mfma_f32_16x16x32_bf16 v[60:63], v[76:79], v[156:159], v[60:63]
v_mfma_f32_16x16x32_bf16 v[64:67], v[72:75], v[236:239], v[64:67]
v_mfma_f32_16x16x32_bf16 v[68:71], v[76:79], v[236:239], v[68:71]
ds_read_b128 v[72:75], v7 offset:18432
ds_read_b128 v[76:79], v7 offset:38912
s_waitcnt lgkmcnt(4)
v_mfma_f32_16x16x32_bf16 v[32:35], a[64:67], v[80:83], v[32:35]
v_mfma_f32_16x16x32_bf16 v[36:39], a[64:67], v[84:87], v[36:39]
v_mfma_f32_16x16x32_bf16 v[40:43], a[144:147], v[80:83], v[40:43]
v_mfma_f32_16x16x32_bf16 v[44:47], a[144:147], v[84:87], v[44:47]
v_mfma_f32_16x16x32_bf16 v[48:51], v[80:83], a[224:227], v[48:51]
v_mfma_f32_16x16x32_bf16 v[52:55], v[84:87], a[224:227], v[52:55]
v_mfma_f32_16x16x32_bf16 v[56:59], v[80:83], v[160:163], v[56:59]
v_mfma_f32_16x16x32_bf16 v[60:63], v[84:87], v[160:163], v[60:63]
v_mfma_f32_16x16x32_bf16 v[64:67], v[80:83], v[240:243], v[64:67]
v_mfma_f32_16x16x32_bf16 v[68:71], v[84:87], v[240:243], v[68:71]
ds_read_b128 v[80:83], v7 offset:19456
ds_read_b128 v[84:87], v7 offset:39936
s_waitcnt lgkmcnt(4)
v_mfma_f32_16x16x32_bf16 v[32:35], a[68:71], v[88:91], v[32:35]
v_mfma_f32_16x16x32_bf16 v[36:39], a[68:71], v[92:95], v[36:39]
v_mfma_f32_16x16x32_bf16 v[40:43], a[148:151], v[88:91], v[40:43]
v_mfma_f32_16x16x32_bf16 v[44:47], a[148:151], v[92:95], v[44:47]
v_mfma_f32_16x16x32_bf16 v[48:51], v[88:91], a[228:231], v[48:51]
v_mfma_f32_16x16x32_bf16 v[52:55], v[92:95], a[228:231], v[52:55]
v_mfma_f32_16x16x32_bf16 v[56:59], v[88:91], v[164:167], v[56:59]
v_mfma_f32_16x16x32_bf16 v[60:63], v[92:95], v[164:167], v[60:63]
v_mfma_f32_16x16x32_bf16 v[64:67], v[88:91], v[244:247], v[64:67]
v_mfma_f32_16x16x32_bf16 v[68:71], v[92:95], v[244:247], v[68:71]
s_waitcnt lgkmcnt(2)
v_mfma_f32_16x16x32_bf16 v[32:35], a[72:75], v[72:75], v[32:35]
v_mfma_f32_16x16x32_bf16 v[36:39], a[72:75], v[76:79], v[36:39]
v_mfma_f32_16x16x32_bf16 v[40:43], a[152:155], v[72:75], v[40:43]
v_mfma_f32_16x16x32_bf16 v[44:47], a[152:155], v[76:79], v[44:47]
v_mfma_f32_16x16x32_bf16 v[48:51], v[72:75], a[232:235], v[48:51]
v_mfma_f32_16x16x32_bf16 v[52:55], v[76:79], a[232:235], v[52:55]
v_mfma_f32_16x16x32_bf16 v[56:59], v[72:75], v[168:171], v[56:59]
v_mfma_f32_16x16x32_bf16 v[60:63], v[76:79], v[168:171], v[60:63]
v_mfma_f32_16x16x32_bf16 v[64:67], v[72:75], v[248:251], v[64:67]
v_mfma_f32_16x16x32_bf16 v[68:71], v[76:79], v[248:251], v[68:71]
s_waitcnt lgkmcnt(0)
v_mfma_f32_16x16x32_bf16 v[32:35], a[76:79], v[80:83], v[32:35]
v_mfma_f32_16x16x32_bf16 v[36:39], a[76:79], v[84:87], v[36:39]
v_mfma_f32_16x16x32_bf16 v[40:43], a[156:159], v[80:83], v[40:43]
v_mfma_f32_16x16x32_bf16 v[44:47], a[156:159], v[84:87], v[44:47]
v_mfma_f32_16x16x32_bf16 v[48:51], v[80:83], a[236:239], v[48:51]
v_mfma_f32_16x16x32_bf16 v[52:55], v[84:87], a[236:239], v[52:55]
v_mfma_f32_16x16x32_bf16 v[56:59], v[80:83], v[172:175], v[56:59]
v_mfma_f32_16x16x32_bf16 v[60:63], v[84:87], v[172:175], v[60:63]
v_mfma_f32_16x16x32_bf16 v[64:67], v[80:83], v[252:255], v[64:67]
v_mfma_f32_16x16x32_bf16 v[68:71], v[84:87], v[252:255], v[68:71]
v_cvt_pk_bf16_f32 v8, v32, v33
v_cvt_pk_bf16_f32 v9, v34, v35
v_cvt_pk_bf16_f32 v10, v40, v41
v_cvt_pk_bf16_f32 v11, v42, v43
s_add_u32 s34, s21, 2048
buffer_store_dwordx4 v[8:11], v1, s[4:7], s34 offen
v_cvt_pk_bf16_f32 v12, v36, v37
v_cvt_pk_bf16_f32 v13, v38, v39
v_cvt_pk_bf16_f32 v14, v44, v45
v_cvt_pk_bf16_f32 v15, v46, v47
s_add_u32 s34, s21, 8192
buffer_store_dwordx4 v[12:15], v1, s[4:7], s34 offen
v_cvt_pk_bf16_f32 v8, v48, v49
v_cvt_pk_bf16_f32 v9, v50, v51
v_cvt_pk_bf16_f32 v10, v52, v53
v_cvt_pk_bf16_f32 v11, v54, v55
s_add_u32 s34, s23, 1024
buffer_store_dwordx4 v[8:11], v1, s[4:7], s34 offen
v_cvt_pk_bf16_f32 v12, v56, v57
v_cvt_pk_bf16_f32 v13, v58, v59
v_cvt_pk_bf16_f32 v14, v60, v61
v_cvt_pk_bf16_f32 v15, v62, v63
s_add_u32 s34, s23, 2048
buffer_store_dwordx4 v[12:15], v1, s[4:7], s34 offen
v_cvt_pk_bf16_f32 v8, v64, v65
v_cvt_pk_bf16_f32 v9, v66, v67
v_cvt_pk_bf16_f32 v10, v68, v69
v_cvt_pk_bf16_f32 v11, v70, v71
s_add_u32 s34, s23, 3072
buffer_store_dwordx4 v[8:11], v1, s[4:7], s34 offen
s_waitcnt vmcnt(0)
s_barrier
s_add_u32 s17, s17, 1
s_cmp_lt_u32 s17, 64
s_cbranch_scc1 reca_ptop246
s_branch reca_exit1
reca_pslow245:
reca_ptop251:
s_cmp_lt_u32 s17, 3
s_cbranch_scc1 reca_pgo252
s_sub_u32 s36, s17, 3
reca_ppoll253:
buffer_load_dword v28, v4, s[4:7], s25 offen sc1
s_waitcnt vmcnt(0)
v_readfirstlane_b32 s34, v28
s_nop 3
s_cmp_ge_i32 s34, s36
s_cbranch_scc1 reca_pgo252
s_sleep 8
s_sub_u32 s18, s18, 1
s_cbranch_scc0 reca_ppoll253
s_mov_b32 s18, 0
reca_pgo252:
s_waitcnt vmcnt(0)
s_barrier
v_add_u32 v7, s26, v1
s_xor_b32 s26, s26, 40960
s_add_u32 s37, s17, 1
s_cmp_ge_u32 s37, 64
s_cbranch_scc1 reca_pnodma254
s_mul_i32 s20, s37, 40960
s_add_u32 s20, s20, 84944896
s_add_u32 m0, s26, 10240
s_nop 0
buffer_load_dwordx4 v1, s[4:7], s20 offen offset:0 lds
buffer_load_dwordx4 v1, s[4:7], s20 offen offset:1024 lds
buffer_load_dwordx4 v1, s[4:7], s20 offen offset:2048 lds
buffer_load_dwordx4 v1, s[4:7], s20 offen offset:3072 lds
s_add_u32 s20, s20, 4096
s_add_u32 m0, s26, 14336
s_nop 0
buffer_load_dwordx4 v1, s[4:7], s20 offen offset:0 lds
buffer_load_dwordx4 v1, s[4:7], s20 offen offset:1024 lds
buffer_load_dwordx4 v1, s[4:7], s20 offen offset:2048 lds
buffer_load_dwordx4 v1, s[4:7], s20 offen offset:3072 lds
s_add_u32 s20, s20, 4096
s_add_u32 m0, s26, 18432
s_nop 0
buffer_load_dwordx4 v1, s[4:7], s20 offen offset:0 lds
buffer_load_dwordx4 v1, s[4:7], s20 offen offset:1024 lds
reca_pnodma254:
s_lshl_b32 s34, s15, 3
s_and_b32 s35, s17, 7
s_add_u32 s34, s34, s35
s_mul_i32 s34, s34, 12288
s_mul_i32 s35, s16, 3072
s_add_u32 s35, s35, s34
s_add_u32 s21, s35, 37748736
s_add_u32 s22, s35, 44040192
s_mul_i32 s35, s16, 6144
s_add_u32 s35, s35, s34
s_add_u32 s23, s35, 40894464
ds_read_b128 v[72:75], v7 offset:0
ds_read_b128 v[76:79], v7 offset:20480
ds_read_b128 v[80:83], v7 offset:1024
ds_read_b128 v[84:87], v7 offset:21504
ds_read_b128 v[88:91], v7 offset:2048
ds_read_b128 v[92:95], v7 offset:22528
s_waitcnt lgkmcnt(4)
v_mfma_f32_16x16x32_bf16 v[32:35], a[0:3], v[72:75], 0
v_mfma_f32_16x16x32_bf16 v[36:39], a[0:3], v[76:79], 0
v_mfma_f32_16x16x32_bf16 v[40:43], a[80:83], v[72:75], 0
v_mfma_f32_16x16x32_bf16 v[44:47], a[80:83], v[76:79], 0
v_mfma_f32_16x16x32_bf16 v[48:51], v[72:75], a[160:163], 0
v_mfma_f32_16x16x32_bf16 v[52:55], v[76:79], a[160:163], 0
v_mfma_f32_16x16x32_bf16 v[56:59], v[72:75], v[96:99], 0
v_mfma_f32_16x16x32_bf16 v[60:63], v[76:79], v[96:99], 0
v_mfma_f32_16x16x32_bf16 v[64:67], v[72:75], v[176:179], 0
v_mfma_f32_16x16x32_bf16 v[68:71], v[76:79], v[176:179], 0
ds_read_b128 v[72:75], v7 offset:3072
ds_read_b128 v[76:79], v7 offset:23552
s_waitcnt lgkmcnt(4)
v_mfma_f32_16x16x32_bf16 v[32:35], a[4:7], v[80:83], v[32:35]
v_mfma_f32_16x16x32_bf16 v[36:39], a[4:7], v[84:87], v[36:39]
v_mfma_f32_16x16x32_bf16 v[40:43], a[84:87], v[80:83], v[40:43]
v_mfma_f32_16x16x32_bf16 v[44:47], a[84:87], v[84:87], v[44:47]
v_mfma_f32_16x16x32_bf16 v[48:51], v[80:83], a[164:167], v[48:51]
v_mfma_f32_16x16x32_bf16 v[52:55], v[84:87], a[164:167], v[52:55]
v_mfma_f32_16x16x32_bf16 v[56:59], v[80:83], v[100:103], v[56:59]
v_mfma_f32_16x16x32_bf16 v[60:63], v[84:87], v[100:103], v[60:63]
v_mfma_f32_16x16x32_bf16 v[64:67], v[80:83], v[180:183], v[64:67]
v_mfma_f32_16x16x32_bf16 v[68:71], v[84:87], v[180:183], v[68:71]
ds_read_b128 v[80:83], v7 offset:4096
ds_read_b128 v[84:87], v7 offset:24576
s_waitcnt lgkmcnt(4)
v_mfma_f32_16x16x32_bf16 v[32:35], a[8:11], v[88:91], v[32:35]
v_mfma_f32_16x16x32_bf16 v[36:39], a[8:11], v[92:95], v[36:39]
v_mfma_f32_16x16x32_bf16 v[40:43], a[88:91], v[88:91], v[40:43]
v_mfma_f32_16x16x32_bf16 v[44:47], a[88:91], v[92:95], v[44:47]
v_mfma_f32_16x16x32_bf16 v[48:51], v[88:91], a[168:171], v[48:51]
v_mfma_f32_16x16x32_bf16 v[52:55], v[92:95], a[168:171], v[52:55]
v_mfma_f32_16x16x32_bf16 v[56:59], v[88:91], v[104:107], v[56:59]
v_mfma_f32_16x16x32_bf16 v[60:63], v[92:95], v[104:107], v[60:63]
v_mfma_f32_16x16x32_bf16 v[64:67], v[88:91], v[184:187], v[64:67]
v_mfma_f32_16x16x32_bf16 v[68:71], v[92:95], v[184:187], v[68:71]
ds_read_b128 v[88:91], v7 offset:5120
ds_read_b128 v[92:95], v7 offset:25600
s_waitcnt lgkmcnt(4)
v_mfma_f32_16x16x32_bf16 v[32:35], a[12:15], v[72:75], v[32:35]
v_mfma_f32_16x16x32_bf16 v[36:39], a[12:15], v[76:79], v[36:39]
v_mfma_f32_16x16x32_bf16 v[40:43], a[92:95], v[72:75], v[40:43]
v_mfma_f32_16x16x32_bf16 v[44:47], a[92:95], v[76:79], v[44:47]
v_mfma_f32_16x16x32_bf16 v[48:51], v[72:75], a[172:175], v[48:51]
v_mfma_f32_16x16x32_bf16 v[52:55], v[76:79], a[172:175], v[52:55]
v_mfma_f32_16x16x32_bf16 v[56:59], v[72:75], v[108:111], v[56:59]
v_mfma_f32_16x16x32_bf16 v[60:63], v[76:79], v[108:111], v[60:63]
v_mfma_f32_16x16x32_bf16 v[64:67], v[72:75], v[188:191], v[64:67]
v_mfma_f32_16x16x32_bf16 v[68:71], v[76:79], v[188:191], v[68:71]
ds_read_b128 v[72:75], v7 offset:6144
ds_read_b128 v[76:79], v7 offset:26624
s_waitcnt lgkmcnt(4)
v_mfma_f32_16x16x32_bf16 v[32:35], a[16:19], v[80:83], v[32:35]
v_mfma_f32_16x16x32_bf16 v[36:39], a[16:19], v[84:87], v[36:39]
v_mfma_f32_16x16x32_bf16 v[40:43], a[96:99], v[80:83], v[40:43]
v_mfma_f32_16x16x32_bf16 v[44:47], a[96:99], v[84:87], v[44:47]
v_mfma_f32_16x16x32_bf16 v[48:51], v[80:83], a[176:179], v[48:51]
v_mfma_f32_16x16x32_bf16 v[52:55], v[84:87], a[176:179], v[52:55]
v_mfma_f32_16x16x32_bf16 v[56:59], v[80:83], v[112:115], v[56:59]
v_mfma_f32_16x16x32_bf16 v[60:63], v[84:87], v[112:115], v[60:63]
v_mfma_f32_16x16x32_bf16 v[64:67], v[80:83], v[192:195], v[64:67]
v_mfma_f32_16x16x32_bf16 v[68:71], v[84:87], v[192:195], v[68:71]
ds_read_b128 v[80:83], v7 offset:7168
ds_read_b128 v[84:87], v7 offset:27648
s_waitcnt lgkmcnt(4)
v_mfma_f32_16x16x32_bf16 v[32:35], a[20:23], v[88:91], v[32:35]
v_mfma_f32_16x16x32_bf16 v[36:39], a[20:23], v[92:95], v[36:39]
v_mfma_f32_16x16x32_bf16 v[40:43], a[100:103], v[88:91], v[40:43]
v_mfma_f32_16x16x32_bf16 v[44:47], a[100:103], v[92:95], v[44:47]
v_mfma_f32_16x16x32_bf16 v[48:51], v[88:91], a[180:183], v[48:51]
v_mfma_f32_16x16x32_bf16 v[52:55], v[92:95], a[180:183], v[52:55]
v_mfma_f32_16x16x32_bf16 v[56:59], v[88:91], v[116:119], v[56:59]
v_mfma_f32_16x16x32_bf16 v[60:63], v[92:95], v[116:119], v[60:63]
v_mfma_f32_16x16x32_bf16 v[64:67], v[88:91], v[196:199], v[64:67]
v_mfma_f32_16x16x32_bf16 v[68:71], v[92:95], v[196:199], v[68:71]
ds_read_b128 v[88:91], v7 offset:8192
ds_read_b128 v[92:95], v7 offset:28672
s_waitcnt lgkmcnt(4)
v_mfma_f32_16x16x32_bf16 v[32:35], a[24:27], v[72:75], v[32:35]
v_mfma_f32_16x16x32_bf16 v[36:39], a[24:27], v[76:79], v[36:39]
v_mfma_f32_16x16x32_bf16 v[40:43], a[104:107], v[72:75], v[40:43]
v_mfma_f32_16x16x32_bf16 v[44:47], a[104:107], v[76:79], v[44:47]
v_mfma_f32_16x16x32_bf16 v[48:51], v[72:75], a[184:187], v[48:51]
v_mfma_f32_16x16x32_bf16 v[52:55], v[76:79], a[184:187], v[52:55]
v_mfma_f32_16x16x32_bf16 v[56:59], v[72:75], v[120:123], v[56:59]
v_mfma_f32_16x16x32_bf16 v[60:63], v[76:79], v[120:123], v[60:63]
v_mfma_f32_16x16x32_bf16 v[64:67], v[72:75], v[200:203], v[64:67]
v_mfma_f32_16x16x32_bf16 v[68:71], v[76:79], v[200:203], v[68:71]
ds_read_b128 v[72:75], v7 offset:9216
ds_read_b128 v[76:79], v7 offset:29696
s_waitcnt lgkmcnt(4)
v_mfma_f32_16x16x32_bf16 v[32:35], a[28:31], v[80:83], v[32:35]
v_mfma_f32_16x16x32_bf16 v[36:39], a[28:31], v[84:87], v[36:39]
v_mfma_f32_16x16x32_bf16 v[40:43], a[108:111], v[80:83], v[40:43]
v_mfma_f32_16x16x32_bf16 v[44:47], a[108:111], v[84:87], v[44:47]
v_mfma_f32_16x16x32_bf16 v[48:51], v[80:83], a[188:191], v[48:51]
v_mfma_f32_16x16x32_bf16 v[52:55], v[84:87], a[188:191], v[52:55]
v_mfma_f32_16x16x32_bf16 v[56:59], v[80:83], v[124:127], v[56:59]
v_mfma_f32_16x16x32_bf16 v[60:63], v[84:87], v[124:127], v[60:63]
v_mfma_f32_16x16x32_bf16 v[64:67], v[80:83], v[204:207], v[64:67]
v_mfma_f32_16x16x32_bf16 v[68:71], v[84:87], v[204:207], v[68:71]
ds_read_b128 v[80:83], v7 offset:10240
ds_read_b128 v[84:87], v7 offset:30720
s_waitcnt lgkmcnt(4)
v_mfma_f32_16x16x32_bf16 v[32:35], a[32:35], v[88:91], v[32:35]
v_mfma_f32_16x16x32_bf16 v[36:39], a[32:35], v[92:95], v[36:39]
v_mfma_f32_16x16x32_bf16 v[40:43], a[112:115], v[88:91], v[40:43]
v_mfma_f32_16x16x32_bf16 v[44:47], a[112:115], v[92:95], v[44:47]
v_mfma_f32_16x16x32_bf16 v[48:51], v[88:91], a[192:195], v[48:51]
v_mfma_f32_16x16x32_bf16 v[52:55], v[92:95], a[192:195], v[52:55]
v_mfma_f32_16x16x32_bf16 v[56:59], v[88:91], v[128:131], v[56:59]
v_mfma_f32_16x16x32_bf16 v[60:63], v[92:95], v[128:131], v[60:63]
v_mfma_f32_16x16x32_bf16 v[64:67], v[88:91], v[208:211], v[64:67]
v_mfma_f32_16x16x32_bf16 v[68:71], v[92:95], v[208:211], v[68:71]
ds_read_b128 v[88:91], v7 offset:11264
ds_read_b128 v[92:95], v7 offset:31744
s_waitcnt lgkmcnt(4)
v_mfma_f32_16x16x32_bf16 v[32:35], a[36:39], v[72:75], v[32:35]
v_mfma_f32_16x16x32_bf16 v[36:39], a[36:39], v[76:79], v[36:39]
v_mfma_f32_16x16x32_bf16 v[40:43], a[116:119], v[72:75], v[40:43]
v_mfma_f32_16x16x32_bf16 v[44:47], a[116:119], v[76:79], v[44:47]
v_mfma_f32_16x16x32_bf16 v[48:51], v[72:75], a[196:199], v[48:51]
v_mfma_f32_16x16x32_bf16 v[52:55], v[76:79], a[196:199], v[52:55]
v_mfma_f32_16x16x32_bf16 v[56:59], v[72:75], v[132:135], v[56:59]
v_mfma_f32_16x16x32_bf16 v[60:63], v[76:79], v[132:135], v[60:63]
v_mfma_f32_16x16x32_bf16 v[64:67], v[72:75], v[212:215], v[64:67]
v_mfma_f32_16x16x32_bf16 v[68:71], v[76:79], v[212:215], v[68:71]
ds_read_b128 v[72:75], v7 offset:12288
ds_read_b128 v[76:79], v7 offset:32768
s_waitcnt lgkmcnt(4)
v_mfma_f32_16x16x32_bf16 v[32:35], a[40:43], v[80:83], v[32:35]
v_mfma_f32_16x16x32_bf16 v[36:39], a[40:43], v[84:87], v[36:39]
v_mfma_f32_16x16x32_bf16 v[40:43], a[120:123], v[80:83], v[40:43]
v_mfma_f32_16x16x32_bf16 v[44:47], a[120:123], v[84:87], v[44:47]
v_mfma_f32_16x16x32_bf16 v[48:51], v[80:83], a[200:203], v[48:51]
v_mfma_f32_16x16x32_bf16 v[52:55], v[84:87], a[200:203], v[52:55]
v_mfma_f32_16x16x32_bf16 v[56:59], v[80:83], v[136:139], v[56:59]
v_mfma_f32_16x16x32_bf16 v[60:63], v[84:87], v[136:139], v[60:63]
v_mfma_f32_16x16x32_bf16 v[64:67], v[80:83], v[216:219], v[64:67]
v_mfma_f32_16x16x32_bf16 v[68:71], v[84:87], v[216:219], v[68:71]
ds_read_b128 v[80:83], v7 offset:13312
ds_read_b128 v[84:87], v7 offset:33792
s_waitcnt lgkmcnt(4)
v_mfma_f32_16x16x32_bf16 v[32:35], a[44:47], v[88:91], v[32:35]
v_mfma_f32_16x16x32_bf16 v[36:39], a[44:47], v[92:95], v[36:39]
v_mfma_f32_16x16x32_bf16 v[40:43], a[124:127], v[88:91], v[40:43]
v_mfma_f32_16x16x32_bf16 v[44:47], a[124:127], v[92:95], v[44:47]
v_mfma_f32_16x16x32_bf16 v[48:51], v[88:91], a[204:207], v[48:51]
v_mfma_f32_16x16x32_bf16 v[52:55], v[92:95], a[204:207], v[52:55]
v_mfma_f32_16x16x32_bf16 v[56:59], v[88:91], v[140:143], v[56:59]
v_mfma_f32_16x16x32_bf16 v[60:63], v[92:95], v[140:143], v[60:63]
v_mfma_f32_16x16x32_bf16 v[64:67], v[88:91], v[220:223], v[64:67]
v_mfma_f32_16x16x32_bf16 v[68:71], v[92:95], v[220:223], v[68:71]
ds_read_b128 v[88:91], v7 offset:14336
ds_read_b128 v[92:95], v7 offset:34816
s_waitcnt lgkmcnt(4)
v_mfma_f32_16x16x32_bf16 v[32:35], a[48:51], v[72:75], v[32:35]
v_mfma_f32_16x16x32_bf16 v[36:39], a[48:51], v[76:79], v[36:39]
v_mfma_f32_16x16x32_bf16 v[40:43], a[128:131], v[72:75], v[40:43]
v_mfma_f32_16x16x32_bf16 v[44:47], a[128:131], v[76:79], v[44:47]
v_mfma_f32_16x16x32_bf16 v[48:51], v[72:75], a[208:211], v[48:51]
v_mfma_f32_16x16x32_bf16 v[52:55], v[76:79], a[208:211], v[52:55]
v_mfma_f32_16x16x32_bf16 v[56:59], v[72:75], v[144:147], v[56:59]
v_mfma_f32_16x16x32_bf16 v[60:63], v[76:79], v[144:147], v[60:63]
v_mfma_f32_16x16x32_bf16 v[64:67], v[72:75], v[224:227], v[64:67]
v_mfma_f32_16x16x32_bf16 v[68:71], v[76:79], v[224:227], v[68:71]
ds_read_b128 v[72:75], v7 offset:15360
ds_read_b128 v[76:79], v7 offset:35840
s_waitcnt lgkmcnt(4)
v_mfma_f32_16x16x32_bf16 v[32:35], a[52:55], v[80:83], v[32:35]
v_mfma_f32_16x16x32_bf16 v[36:39], a[52:55], v[84:87], v[36:39]
v_mfma_f32_16x16x32_bf16 v[40:43], a[132:135], v[80:83], v[40:43]
v_mfma_f32_16x16x32_bf16 v[44:47], a[132:135], v[84:87], v[44:47]
v_mfma_f32_16x16x32_bf16 v[48:51], v[80:83], a[212:215], v[48:51]
v_mfma_f32_16x16x32_bf16 v[52:55], v[84:87], a[212:215], v[52:55]
v_mfma_f32_16x16x32_bf16 v[56:59], v[80:83], v[148:151], v[56:59]
v_mfma_f32_16x16x32_bf16 v[60:63], v[84:87], v[148:151], v[60:63]
v_mfma_f32_16x16x32_bf16 v[64:67], v[80:83], v[228:231], v[64:67]
v_mfma_f32_16x16x32_bf16 v[68:71], v[84:87], v[228:231], v[68:71]
ds_read_b128 v[80:83], v7 offset:16384
ds_read_b128 v[84:87], v7 offset:36864
s_waitcnt lgkmcnt(4)
v_mfma_f32_16x16x32_bf16 v[32:35], a[56:59], v[88:91], v[32:35]
v_mfma_f32_16x16x32_bf16 v[36:39], a[56:59], v[92:95], v[36:39]
v_mfma_f32_16x16x32_bf16 v[40:43], a[136:139], v[88:91], v[40:43]
v_mfma_f32_16x16x32_bf16 v[44:47], a[136:139], v[92:95], v[44:47]
v_mfma_f32_16x16x32_bf16 v[48:51], v[88:91], a[216:219], v[48:51]
v_mfma_f32_16x16x32_bf16 v[52:55], v[92:95], a[216:219], v[52:55]
v_mfma_f32_16x16x32_bf16 v[56:59], v[88:91], v[152:155], v[56:59]
v_mfma_f32_16x16x32_bf16 v[60:63], v[92:95], v[152:155], v[60:63]
v_mfma_f32_16x16x32_bf16 v[64:67], v[88:91], v[232:235], v[64:67]
v_mfma_f32_16x16x32_bf16 v[68:71], v[92:95], v[232:235], v[68:71]
ds_read_b128 v[88:91], v7 offset:17408
ds_read_b128 v[92:95], v7 offset:37888
s_waitcnt lgkmcnt(4)
v_mfma_f32_16x16x32_bf16 v[32:35], a[60:63], v[72:75], v[32:35]
v_mfma_f32_16x16x32_bf16 v[36:39], a[60:63], v[76:79], v[36:39]
v_mfma_f32_16x16x32_bf16 v[40:43], a[140:143], v[72:75], v[40:43]
v_mfma_f32_16x16x32_bf16 v[44:47], a[140:143], v[76:79], v[44:47]
v_mfma_f32_16x16x32_bf16 v[48:51], v[72:75], a[220:223], v[48:51]
v_mfma_f32_16x16x32_bf16 v[52:55], v[76:79], a[220:223], v[52:55]
v_mfma_f32_16x16x32_bf16 v[56:59], v[72:75], v[156:159], v[56:59]
v_mfma_f32_16x16x32_bf16 v[60:63], v[76:79], v[156:159], v[60:63]
v_mfma_f32_16x16x32_bf16 v[64:67], v[72:75], v[236:239], v[64:67]
v_mfma_f32_16x16x32_bf16 v[68:71], v[76:79], v[236:239], v[68:71]
ds_read_b128 v[72:75], v7 offset:18432
ds_read_b128 v[76:79], v7 offset:38912
s_waitcnt lgkmcnt(4)
v_mfma_f32_16x16x32_bf16 v[32:35], a[64:67], v[80:83], v[32:35]
v_mfma_f32_16x16x32_bf16 v[36:39], a[64:67], v[84:87], v[36:39]
v_mfma_f32_16x16x32_bf16 v[40:43], a[144:147], v[80:83], v[40:43]
v_mfma_f32_16x16x32_bf16 v[44:47], a[144:147], v[84:87], v[44:47]
v_mfma_f32_16x16x32_bf16 v[48:51], v[80:83], a[224:227], v[48:51]
v_mfma_f32_16x16x32_bf16 v[52:55], v[84:87], a[224:227], v[52:55]
v_mfma_f32_16x16x32_bf16 v[56:59], v[80:83], v[160:163], v[56:59]
v_mfma_f32_16x16x32_bf16 v[60:63], v[84:87], v[160:163], v[60:63]
v_mfma_f32_16x16x32_bf16 v[64:67], v[80:83], v[240:243], v[64:67]
v_mfma_f32_16x16x32_bf16 v[68:71], v[84:87], v[240:243], v[68:71]
ds_read_b128 v[80:83], v7 offset:19456
ds_read_b128 v[84:87], v7 offset:39936
s_waitcnt lgkmcnt(4)
v_mfma_f32_16x16x32_bf16 v[32:35], a[68:71], v[88:91], v[32:35]
v_mfma_f32_16x16x32_bf16 v[36:39], a[68:71], v[92:95], v[36:39]
v_mfma_f32_16x16x32_bf16 v[40:43], a[148:151], v[88:91], v[40:43]
v_mfma_f32_16x16x32_bf16 v[44:47], a[148:151], v[92:95], v[44:47]
v_mfma_f32_16x16x32_bf16 v[48:51], v[88:91], a[228:231], v[48:51]
v_mfma_f32_16x16x32_bf16 v[52:55], v[92:95], a[228:231], v[52:55]
v_mfma_f32_16x16x32_bf16 v[56:59], v[88:91], v[164:167], v[56:59]
v_mfma_f32_16x16x32_bf16 v[60:63], v[92:95], v[164:167], v[60:63]
v_mfma_f32_16x16x32_bf16 v[64:67], v[88:91], v[244:247], v[64:67]
v_mfma_f32_16x16x32_bf16 v[68:71], v[92:95], v[244:247], v[68:71]
s_waitcnt lgkmcnt(2)
v_mfma_f32_16x16x32_bf16 v[32:35], a[72:75], v[72:75], v[32:35]
v_mfma_f32_16x16x32_bf16 v[36:39], a[72:75], v[76:79], v[36:39]
v_mfma_f32_16x16x32_bf16 v[40:43], a[152:155], v[72:75], v[40:43]
v_mfma_f32_16x16x32_bf16 v[44:47], a[152:155], v[76:79], v[44:47]
v_mfma_f32_16x16x32_bf16 v[48:51], v[72:75], a[232:235], v[48:51]
v_mfma_f32_16x16x32_bf16 v[52:55], v[76:79], a[232:235], v[52:55]
v_mfma_f32_16x16x32_bf16 v[56:59], v[72:75], v[168:171], v[56:59]
v_mfma_f32_16x16x32_bf16 v[60:63], v[76:79], v[168:171], v[60:63]
v_mfma_f32_16x16x32_bf16 v[64:67], v[72:75], v[248:251], v[64:67]
v_mfma_f32_16x16x32_bf16 v[68:71], v[76:79], v[248:251], v[68:71]
s_waitcnt lgkmcnt(0)
v_mfma_f32_16x16x32_bf16 v[32:35], a[76:79], v[80:83], v[32:35]
v_mfma_f32_16x16x32_bf16 v[36:39], a[76:79], v[84:87], v[36:39]
v_mfma_f32_16x16x32_bf16 v[40:43], a[156:159], v[80:83], v[40:43]
v_mfma_f32_16x16x32_bf16 v[44:47], a[156:159], v[84:87], v[44:47]
v_mfma_f32_16x16x32_bf16 v[48:51], v[80:83], a[236:239], v[48:51]
v_mfma_f32_16x16x32_bf16 v[52:55], v[84:87], a[236:239], v[52:55]
v_mfma_f32_16x16x32_bf16 v[56:59], v[80:83], v[172:175], v[56:59]
v_mfma_f32_16x16x32_bf16 v[60:63], v[84:87], v[172:175], v[60:63]
v_mfma_f32_16x16x32_bf16 v[64:67], v[80:83], v[252:255], v[64:67]
v_mfma_f32_16x16x32_bf16 v[68:71], v[84:87], v[252:255], v[68:71]
v_cvt_pk_bf16_f32 v8, v32, v33
v_cvt_pk_bf16_f32 v9, v34, v35
v_cvt_pk_bf16_f32 v10, v40, v41
v_cvt_pk_bf16_f32 v11, v42, v43
s_add_u32 s34, s21, 2048
buffer_store_dwordx4 v[8:11], v1, s[4:7], s34 offen sc1
v_cvt_pk_bf16_f32 v12, v36, v37
v_cvt_pk_bf16_f32 v13, v38, v39
v_cvt_pk_bf16_f32 v14, v44, v45
v_cvt_pk_bf16_f32 v15, v46, v47
s_add_u32 s34, s21, 8192
buffer_store_dwordx4 v[12:15], v1, s[4:7], s34 offen sc1
v_cvt_pk_bf16_f32 v8, v48, v49
v_cvt_pk_bf16_f32 v9, v50, v51
v_cvt_pk_bf16_f32 v10, v52, v53
v_cvt_pk_bf16_f32 v11, v54, v55
s_add_u32 s34, s23, 1024
buffer_store_dwordx4 v[8:11], v1, s[4:7], s34 offen sc1
v_cvt_pk_bf16_f32 v12, v56, v57
v_cvt_pk_bf16_f32 v13, v58, v59
v_cvt_pk_bf16_f32 v14, v60, v61
v_cvt_pk_bf16_f32 v15, v62, v63
s_add_u32 s34, s23, 2048
buffer_store_dwordx4 v[12:15], v1, s[4:7], s34 offen sc1
v_cvt_pk_bf16_f32 v8, v64, v65
v_cvt_pk_bf16_f32 v9, v66, v67
v_cvt_pk_bf16_f32 v10, v68, v69
v_cvt_pk_bf16_f32 v11, v70, v71
s_add_u32 s34, s23, 3072
buffer_store_dwordx4 v[8:11], v1, s[4:7], s34 offen sc1
s_waitcnt vmcnt(0)
s_barrier
s_add_u32 s17, s17, 1
s_cmp_lt_u32 s17, 64
s_cbranch_scc1 reca_ptop251
s_branch reca_exit1
reca_pw2_228:
s_mov_b32 s17, 0
s_mov_b32 s26, 0
s_mul_i32 s20, s17, 40960
s_add_u32 s20, s20, 84955136
s_add_u32 m0, s26, 20480
s_nop 0
buffer_load_dwordx4 v1, s[4:7], s20 offen offset:0 lds
buffer_load_dwordx4 v1, s[4:7], s20 offen offset:1024 lds
buffer_load_dwordx4 v1, s[4:7], s20 offen offset:2048 lds
buffer_load_dwordx4 v1, s[4:7], s20 offen offset:3072 lds
s_add_u32 s20, s20, 4096
s_add_u32 m0, s26, 24576
s_nop 0
buffer_load_dwordx4 v1, s[4:7], s20 offen offset:0 lds
buffer_load_dwordx4 v1, s[4:7], s20 offen offset:1024 lds
buffer_load_dwordx4 v1, s[4:7], s20 offen offset:2048 lds
buffer_load_dwordx4 v1, s[4:7], s20 offen offset:3072 lds
s_add_u32 s20, s20, 4096
s_add_u32 m0, s26, 28672
s_nop 0
buffer_load_dwordx4 v1, s[4:7], s20 offen offset:0 lds
buffer_load_dwordx4 v1, s[4:7], s20 offen offset:1024 lds
s_mul_i32 s34, s15, 12
s_mul_i32 s35, s16, 6
s_add_u32 s34, s34, s35
s_add_u32 s34, s34, 0
s_mul_i32 s34, s34, 20480
s_add_u32 s34, s34, 6291456
buffer_load_dwordx4 a[0:3], v1, s[4:7], s34 offen offset:0
buffer_load_dwordx4 a[4:7], v1, s[4:7], s34 offen offset:1024
buffer_load_dwordx4 a[8:11], v1, s[4:7], s34 offen offset:2048
buffer_load_dwordx4 a[12:15], v1, s[4:7], s34 offen offset:3072
s_add_u32 s34, s34, 4096
buffer_load_dwordx4 a[16:19], v1, s[4:7], s34 offen offset:0
buffer_load_dwordx4 a[20:23], v1, s[4:7], s34 offen offset:1024
buffer_load_dwordx4 a[24:27], v1, s[4:7], s34 offen offset:2048
buffer_load_dwordx4 a[28:31], v1, s[4:7], s34 offen offset:3072
s_add_u32 s34, s34, 4096
buffer_load_dwordx4 a[32:35], v1, s[4:7], s34 offen offset:0
buffer_load_dwordx4 a[36:39], v1, s[4:7], s34 offen offset:1024
buffer_load_dwordx4 a[40:43], v1, s[4:7], s34 offen offset:2048
buffer_load_dwordx4 a[44:47], v1, s[4:7], s34 offen offset:3072
s_add_u32 s34, s34, 4096
buffer_load_dwordx4 a[48:51], v1, s[4:7], s34 offen offset:0
buffer_load_dwordx4 a[52:55], v1, s[4:7], s34 offen offset:1024
buffer_load_dwordx4 a[56:59], v1, s[4:7], s34 offen offset:2048
buffer_load_dwordx4 a[60:63], v1, s[4:7], s34 offen offset:3072
s_add_u32 s34, s34, 4096
buffer_load_dwordx4 a[64:67], v1, s[4:7], s34 offen offset:0
buffer_load_dwordx4 a[68:71], v1, s[4:7], s34 offen offset:1024
buffer_load_dwordx4 a[72:75], v1, s[4:7], s34 offen offset:2048
buffer_load_dwordx4 a[76:79], v1, s[4:7], s34 offen offset:3072
s_mul_i32 s34, s15, 12
s_mul_i32 s35, s16, 6
s_add_u32 s34, s34, s35
s_add_u32 s34, s34, 1
s_mul_i32 s34, s34, 20480
s_add_u32 s34, s34, 6291456
buffer_load_dwordx4 a[80:83], v1, s[4:7], s34 offen offset:0
buffer_load_dwordx4 a[84:87], v1, s[4:7], s34 offen offset:1024
buffer_load_dwordx4 a[88:91], v1, s[4:7], s34 offen offset:2048
buffer_load_dwordx4 a[92:95], v1, s[4:7], s34 offen offset:3072
s_add_u32 s34, s34, 4096
buffer_load_dwordx4 a[96:99], v1, s[4:7], s34 offen offset:0
buffer_load_dwordx4 a[100:103], v1, s[4:7], s34 offen offset:1024
buffer_load_dwordx4 a[104:107], v1, s[4:7], s34 offen offset:2048
buffer_load_dwordx4 a[108:111], v1, s[4:7], s34 offen offset:3072
s_add_u32 s34, s34, 4096
buffer_load_dwordx4 a[112:115], v1, s[4:7], s34 offen offset:0
buffer_load_dwordx4 a[116:119], v1, s[4:7], s34 offen offset:1024
buffer_load_dwordx4 a[120:123], v1, s[4:7], s34 offen offset:2048
buffer_load_dwordx4 a[124:127], v1, s[4:7], s34 offen offset:3072
s_add_u32 s34, s34, 4096
buffer_load_dwordx4 a[128:131], v1, s[4:7], s34 offen offset:0
buffer_load_dwordx4 a[132:135], v1, s[4:7], s34 offen offset:1024
buffer_load_dwordx4 a[136:139], v1, s[4:7], s34 offen offset:2048
buffer_load_dwordx4 a[140:143], v1, s[4:7], s34 offen offset:3072
s_add_u32 s34, s34, 4096
buffer_load_dwordx4 a[144:147], v1, s[4:7], s34 offen offset:0
buffer_load_dwordx4 a[148:151], v1, s[4:7], s34 offen offset:1024
buffer_load_dwordx4 a[152:155], v1, s[4:7], s34 offen offset:2048
buffer_load_dwordx4 a[156:159], v1, s[4:7], s34 offen offset:3072
s_waitcnt vmcnt(20)
s_mul_i32 s34, s15, 12
s_mul_i32 s35, s16, 6
s_add_u32 s34, s34, s35
s_add_u32 s34, s34, 4
s_mul_i32 s34, s34, 20480
s_add_u32 s34, s34, 22020096
buffer_load_dwordx4 a[160:163], v1, s[4:7], s34 offen offset:0
buffer_load_dwordx4 a[164:167], v1, s[4:7], s34 offen offset:1024
buffer_load_dwordx4 a[168:171], v1, s[4:7], s34 offen offset:2048
buffer_load_dwordx4 a[172:175], v1, s[4:7], s34 offen offset:3072
s_add_u32 s34, s34, 4096
buffer_load_dwordx4 a[176:179], v1, s[4:7], s34 offen offset:0
buffer_load_dwordx4 a[180:183], v1, s[4:7], s34 offen offset:1024
buffer_load_dwordx4 a[184:187], v1, s[4:7], s34 offen offset:2048
buffer_load_dwordx4 a[188:191], v1, s[4:7], s34 offen offset:3072
s_add_u32 s34, s34, 4096
buffer_load_dwordx4 a[192:195], v1, s[4:7], s34 offen offset:0
buffer_load_dwordx4 a[196:199], v1, s[4:7], s34 offen offset:1024
buffer_load_dwordx4 a[200:203], v1, s[4:7], s34 offen offset:2048
buffer_load_dwordx4 a[204:207], v1, s[4:7], s34 offen offset:3072
s_add_u32 s34, s34, 4096
buffer_load_dwordx4 a[208:211], v1, s[4:7], s34 offen offset:0
buffer_load_dwordx4 a[212:215], v1, s[4:7], s34 offen offset:1024
buffer_load_dwordx4 a[216:219], v1, s[4:7], s34 offen offset:2048
buffer_load_dwordx4 a[220:223], v1, s[4:7], s34 offen offset:3072
s_add_u32 s34, s34, 4096
buffer_load_dwordx4 a[224:227], v1, s[4:7], s34 offen offset:0
buffer_load_dwordx4 a[228:231], v1, s[4:7], s34 offen offset:1024
buffer_load_dwordx4 a[232:235], v1, s[4:7], s34 offen offset:2048
buffer_load_dwordx4 a[236:239], v1, s[4:7], s34 offen offset:3072
s_waitcnt vmcnt(20)
s_mul_i32 s34, s15, 12
s_mul_i32 s35, s16, 6
s_add_u32 s34, s34, s35
s_add_u32 s34, s34, 5
s_mul_i32 s34, s34, 20480
s_add_u32 s34, s34, 22020096
buffer_load_dwordx4 v[96:99], v1, s[4:7], s34 offen offset:0
buffer_load_dwordx4 v[100:103], v1, s[4:7], s34 offen offset:1024
buffer_load_dwordx4 v[104:107], v1, s[4:7], s34 offen offset:2048
buffer_load_dwordx4 v[108:111], v1, s[4:7], s34 offen offset:3072
s_add_u32 s34, s34, 4096
buffer_load_dwordx4 v[112:115], v1, s[4:7], s34 offen offset:0
buffer_load_dwordx4 v[116:119], v1, s[4:7], s34 offen offset:1024
buffer_load_dwordx4 v[120:123], v1, s[4:7], s34 offen offset:2048
buffer_load_dwordx4 v[124:127], v1, s[4:7], s34 offen offset:3072
s_add_u32 s34, s34, 4096
buffer_load_dwordx4 v[128:131], v1, s[4:7], s34 offen offset:0
buffer_load_dwordx4 v[132:135], v1, s[4:7], s34 offen offset:1024
buffer_load_dwordx4 v[136:139], v1, s[4:7], s34 offen offset:2048
buffer_load_dwordx4 v[140:143], v1, s[4:7], s34 offen offset:3072
s_add_u32 s34, s34, 4096
buffer_load_dwordx4 v[144:147], v1, s[4:7], s34 offen offset:0
buffer_load_dwordx4 v[148:151], v1, s[4:7], s34 offen offset:1024
buffer_load_dwordx4 v[152:155], v1, s[4:7], s34 offen offset:2048
buffer_load_dwordx4 v[156:159], v1, s[4:7], s34 offen offset:3072
s_add_u32 s34, s34, 4096
buffer_load_dwordx4 v[160:163], v1, s[4:7], s34 offen offset:0
buffer_load_dwordx4 v[164:167], v1, s[4:7], s34 offen offset:1024
buffer_load_dwordx4 v[168:171], v1, s[4:7], s34 offen offset:2048
buffer_load_dwordx4 v[172:175], v1, s[4:7], s34 offen offset:3072
s_waitcnt vmcnt(20)
v_and_b32 v30, 7, v0
v_lshlrev_b32 v30, 3, v30
reca_cens256:
buffer_load_dwordx2 v[28:29], v30, s[8:11], 0 offen sc1
s_waitcnt vmcnt(0)
v_sad_u8 v31, v28, 0, 0
v_sad_u8 v31, v29, 0, v31
v_cmp_gt_u32 vcc, 32, v31
s_cbranch_vccz reca_censok257
s_sleep 8
s_sub_u32 s18, s18, 1
s_cbranch_scc0 reca_cens256
s_mov_b32 s18, 0
reca_censok257:
v_and_b32 v28, 0x20202020, v28
v_and_b32 v29, 0x20202020, v29
v_cmp_ne_u32 s[34:35], 0, v28
v_cmp_ne_u32 s[36:37], 0, v29
s_nop 3
s_and_b32 s34, s34, 0xff
s_and_b32 s36, s36, 0xff
s_or_b32 s35, s34, s36
s_lshr_b32 s37, s35, s13
s_and_b32 s37, s37, 1
s_xor_b32 s43, s37, 1
s_cmp_eq_u32 s57, 0
s_cselect_b32 s58, s36, s34
v_mov_b32 v31, 0x80000000
s_cmp_lg_u32 s43, 0
s_cbranch_scc1 reca_pslow258
reca_ptop259:
s_cmp_lt_u32 s17, 3
s_cbranch_scc1 reca_pgo260
s_sub_u32 s36, s17, 3
reca_ppoll261:
buffer_load_dword v28, v4, s[4:7], s25 offen sc1
s_waitcnt vmcnt(0)
v_readfirstlane_b32 s34, v28
s_nop 3
s_cmp_ge_i32 s34, s36
s_cbranch_scc1 reca_pgo260
s_sleep 8
s_sub_u32 s18, s18, 1
s_cbranch_scc0 reca_ppoll261
s_mov_b32 s18, 0
reca_pgo260:
s_waitcnt vmcnt(0)
s_barrier
v_add_u32 v7, s26, v1
s_xor_b32 s26, s26, 40960
s_add_u32 s37, s17, 1
s_cmp_ge_u32 s37, 64
s_cbranch_scc1 reca_pnodma262
s_mul_i32 s20, s37, 40960
s_add_u32 s20, s20, 84955136
s_add_u32 m0, s26, 20480
s_nop 0
buffer_load_dwordx4 v1, s[4:7], s20 offen offset:0 lds
buffer_load_dwordx4 v1, s[4:7], s20 offen offset:1024 lds
buffer_load_dwordx4 v1, s[4:7], s20 offen offset:2048 lds
buffer_load_dwordx4 v1, s[4:7], s20 offen offset:3072 lds
s_add_u32 s20, s20, 4096
s_add_u32 m0, s26, 24576
s_nop 0
buffer_load_dwordx4 v1, s[4:7], s20 offen offset:0 lds
buffer_load_dwordx4 v1, s[4:7], s20 offen offset:1024 lds
buffer_load_dwordx4 v1, s[4:7], s20 offen offset:2048 lds
buffer_load_dwordx4 v1, s[4:7], s20 offen offset:3072 lds
s_add_u32 s20, s20, 4096
s_add_u32 m0, s26, 28672
s_nop 0
buffer_load_dwordx4 v1, s[4:7], s20 offen offset:0 lds
buffer_load_dwordx4 v1, s[4:7], s20 offen offset:1024 lds
reca_pnodma262:
s_lshl_b32 s34, s15, 3
s_and_b32 s35, s17, 7
s_add_u32 s34, s34, s35
s_mul_i32 s34, s34, 12288
s_mul_i32 s35, s16, 3072
s_add_u32 s35, s35, s34
s_add_u32 s21, s35, 37748736
s_add_u32 s22, s35, 44040192
s_mul_i32 s35, s16, 6144
s_add_u32 s35, s35, s34
s_add_u32 s23, s35, 40894464
ds_read_b128 v[72:75], v7 offset:0
ds_read_b128 v[76:79], v7 offset:20480
ds_read_b128 v[80:83], v7 offset:1024
ds_read_b128 v[84:87], v7 offset:21504
ds_read_b128 v[88:91], v7 offset:2048
ds_read_b128 v[92:95], v7 offset:22528
s_waitcnt lgkmcnt(4)
v_mfma_f32_16x16x32_bf16 v[32:35], a[0:3], v[72:75], 0
v_mfma_f32_16x16x32_bf16 v[36:39], a[0:3], v[76:79], 0
v_mfma_f32_16x16x32_bf16 v[40:43], a[80:83], v[72:75], 0
v_mfma_f32_16x16x32_bf16 v[44:47], a[80:83], v[76:79], 0
v_mfma_f32_16x16x32_bf16 v[48:51], v[72:75], a[160:163], 0
v_mfma_f32_16x16x32_bf16 v[52:55], v[76:79], a[160:163], 0
v_mfma_f32_16x16x32_bf16 v[56:59], v[72:75], v[96:99], 0
v_mfma_f32_16x16x32_bf16 v[60:63], v[76:79], v[96:99], 0
ds_read_b128 v[72:75], v7 offset:3072
ds_read_b128 v[76:79], v7 offset:23552
s_waitcnt lgkmcnt(4)
v_mfma_f32_16x16x32_bf16 v[32:35], a[4:7], v[80:83], v[32:35]
v_mfma_f32_16x16x32_bf16 v[36:39], a[4:7], v[84:87], v[36:39]
v_mfma_f32_16x16x32_bf16 v[40:43], a[84:87], v[80:83], v[40:43]
v_mfma_f32_16x16x32_bf16 v[44:47], a[84:87], v[84:87], v[44:47]
v_mfma_f32_16x16x32_bf16 v[48:51], v[80:83], a[164:167], v[48:51]
v_mfma_f32_16x16x32_bf16 v[52:55], v[84:87], a[164:167], v[52:55]
v_mfma_f32_16x16x32_bf16 v[56:59], v[80:83], v[100:103], v[56:59]
v_mfma_f32_16x16x32_bf16 v[60:63], v[84:87], v[100:103], v[60:63]
ds_read_b128 v[80:83], v7 offset:4096
ds_read_b128 v[84:87], v7 offset:24576
s_waitcnt lgkmcnt(4)
v_mfma_f32_16x16x32_bf16 v[32:35], a[8:11], v[88:91], v[32:35]
v_mfma_f32_16x16x32_bf16 v[36:39], a[8:11], v[92:95], v[36:39]
v_mfma_f32_16x16x32_bf16 v[40:43], a[88:91], v[88:91], v[40:43]
v_mfma_f32_16x16x32_bf16 v[44:47], a[88:91], v[92:95], v[44:47]
v_mfma_f32_16x16x32_bf16 v[48:51], v[88:91], a[168:171], v[48:51]
v_mfma_f32_16x16x32_bf16 v[52:55], v[92:95], a[168:171], v[52:55]
v_mfma_f32_16x16x32_bf16 v[56:59], v[88:91], v[104:107], v[56:59]
v_mfma_f32_16x16x32_bf16 v[60:63], v[92:95], v[104:107], v[60:63]
ds_read_b128 v[88:91], v7 offset:5120
ds_read_b128 v[92:95], v7 offset:25600
s_waitcnt lgkmcnt(4)
v_mfma_f32_16x16x32_bf16 v[32:35], a[12:15], v[72:75], v[32:35]
v_mfma_f32_16x16x32_bf16 v[36:39], a[12:15], v[76:79], v[36:39]
v_mfma_f32_16x16x32_bf16 v[40:43], a[92:95], v[72:75], v[40:43]
v_mfma_f32_16x16x32_bf16 v[44:47], a[92:95], v[76:79], v[44:47]
v_mfma_f32_16x16x32_bf16 v[48:51], v[72:75], a[172:175], v[48:51]
v_mfma_f32_16x16x32_bf16 v[52:55], v[76:79], a[172:175], v[52:55]
v_mfma_f32_16x16x32_bf16 v[56:59], v[72:75], v[108:111], v[56:59]
v_mfma_f32_16x16x32_bf16 v[60:63], v[76:79], v[108:111], v[60:63]
ds_read_b128 v[72:75], v7 offset:6144
ds_read_b128 v[76:79], v7 offset:26624
s_waitcnt lgkmcnt(4)
v_mfma_f32_16x16x32_bf16 v[32:35], a[16:19], v[80:83], v[32:35]
v_mfma_f32_16x16x32_bf16 v[36:39], a[16:19], v[84:87], v[36:39]
v_mfma_f32_16x16x32_bf16 v[40:43], a[96:99], v[80:83], v[40:43]
v_mfma_f32_16x16x32_bf16 v[44:47], a[96:99], v[84:87], v[44:47]
v_mfma_f32_16x16x32_bf16 v[48:51], v[80:83], a[176:179], v[48:51]
v_mfma_f32_16x16x32_bf16 v[52:55], v[84:87], a[176:179], v[52:55]
v_mfma_f32_16x16x32_bf16 v[56:59], v[80:83], v[112:115], v[56:59]
v_mfma_f32_16x16x32_bf16 v[60:63], v[84:87], v[112:115], v[60:63]
ds_read_b128 v[80:83], v7 offset:7168
ds_read_b128 v[84:87], v7 offset:27648
s_waitcnt lgkmcnt(4)
v_mfma_f32_16x16x32_bf16 v[32:35], a[20:23], v[88:91], v[32:35]
v_mfma_f32_16x16x32_bf16 v[36:39], a[20:23], v[92:95], v[36:39]
v_mfma_f32_16x16x32_bf16 v[40:43], a[100:103], v[88:91], v[40:43]
v_mfma_f32_16x16x32_bf16 v[44:47], a[100:103], v[92:95], v[44:47]
v_mfma_f32_16x16x32_bf16 v[48:51], v[88:91], a[180:183], v[48:51]
v_mfma_f32_16x16x32_bf16 v[52:55], v[92:95], a[180:183], v[52:55]
v_mfma_f32_16x16x32_bf16 v[56:59], v[88:91], v[116:119], v[56:59]
v_mfma_f32_16x16x32_bf16 v[60:63], v[92:95], v[116:119], v[60:63]
ds_read_b128 v[88:91], v7 offset:8192
ds_read_b128 v[92:95], v7 offset:28672
s_waitcnt lgkmcnt(4)
v_mfma_f32_16x16x32_bf16 v[32:35], a[24:27], v[72:75], v[32:35]
v_mfma_f32_16x16x32_bf16 v[36:39], a[24:27], v[76:79], v[36:39]
v_mfma_f32_16x16x32_bf16 v[40:43], a[104:107], v[72:75], v[40:43]
v_mfma_f32_16x16x32_bf16 v[44:47], a[104:107], v[76:79], v[44:47]
v_mfma_f32_16x16x32_bf16 v[48:51], v[72:75], a[184:187], v[48:51]
v_mfma_f32_16x16x32_bf16 v[52:55], v[76:79], a[184:187], v[52:55]
v_mfma_f32_16x16x32_bf16 v[56:59], v[72:75], v[120:123], v[56:59]
v_mfma_f32_16x16x32_bf16 v[60:63], v[76:79], v[120:123], v[60:63]
ds_read_b128 v[72:75], v7 offset:9216
ds_read_b128 v[76:79], v7 offset:29696
s_waitcnt lgkmcnt(4)
v_mfma_f32_16x16x32_bf16 v[32:35], a[28:31], v[80:83], v[32:35]
v_mfma_f32_16x16x32_bf16 v[36:39], a[28:31], v[84:87], v[36:39]
v_mfma_f32_16x16x32_bf16 v[40:43], a[108:111], v[80:83], v[40:43]
v_mfma_f32_16x16x32_bf16 v[44:47], a[108:111], v[84:87], v[44:47]
v_mfma_f32_16x16x32_bf16 v[48:51], v[80:83], a[188:191], v[48:51]
v_mfma_f32_16x16x32_bf16 v[52:55], v[84:87], a[188:191], v[52:55]
v_mfma_f32_16x16x32_bf16 v[56:59], v[80:83], v[124:127], v[56:59]
v_mfma_f32_16x16x32_bf16 v[60:63], v[84:87], v[124:127], v[60:63]
ds_read_b128 v[80:83], v7 offset:10240
ds_read_b128 v[84:87], v7 offset:30720
s_waitcnt lgkmcnt(4)
v_mfma_f32_16x16x32_bf16 v[32:35], a[32:35], v[88:91], v[32:35]
v_mfma_f32_16x16x32_bf16 v[36:39], a[32:35], v[92:95], v[36:39]
v_mfma_f32_16x16x32_bf16 v[40:43], a[112:115], v[88:91], v[40:43]
v_mfma_f32_16x16x32_bf16 v[44:47], a[112:115], v[92:95], v[44:47]
v_mfma_f32_16x16x32_bf16 v[48:51], v[88:91], a[192:195], v[48:51]
v_mfma_f32_16x16x32_bf16 v[52:55], v[92:95], a[192:195], v[52:55]
v_mfma_f32_16x16x32_bf16 v[56:59], v[88:91], v[128:131], v[56:59]
v_mfma_f32_16x16x32_bf16 v[60:63], v[92:95], v[128:131], v[60:63]
ds_read_b128 v[88:91], v7 offset:11264
ds_read_b128 v[92:95], v7 offset:31744
s_waitcnt lgkmcnt(4)
v_mfma_f32_16x16x32_bf16 v[32:35], a[36:39], v[72:75], v[32:35]
v_mfma_f32_16x16x32_bf16 v[36:39], a[36:39], v[76:79], v[36:39]
v_mfma_f32_16x16x32_bf16 v[40:43], a[116:119], v[72:75], v[40:43]
v_mfma_f32_16x16x32_bf16 v[44:47], a[116:119], v[76:79], v[44:47]
v_mfma_f32_16x16x32_bf16 v[48:51], v[72:75], a[196:199], v[48:51]
v_mfma_f32_16x16x32_bf16 v[52:55], v[76:79], a[196:199], v[52:55]
v_mfma_f32_16x16x32_bf16 v[56:59], v[72:75], v[132:135], v[56:59]
v_mfma_f32_16x16x32_bf16 v[60:63], v[76:79], v[132:135], v[60:63]
ds_read_b128 v[72:75], v7 offset:12288
ds_read_b128 v[76:79], v7 offset:32768
s_waitcnt lgkmcnt(4)
v_mfma_f32_16x16x32_bf16 v[32:35], a[40:43], v[80:83], v[32:35]
v_mfma_f32_16x16x32_bf16 v[36:39], a[40:43], v[84:87], v[36:39]
v_mfma_f32_16x16x32_bf16 v[40:43], a[120:123], v[80:83], v[40:43]
v_mfma_f32_16x16x32_bf16 v[44:47], a[120:123], v[84:87], v[44:47]
v_mfma_f32_16x16x32_bf16 v[48:51], v[80:83], a[200:203], v[48:51]
v_mfma_f32_16x16x32_bf16 v[52:55], v[84:87], a[200:203], v[52:55]
v_mfma_f32_16x16x32_bf16 v[56:59], v[80:83], v[136:139], v[56:59]
v_mfma_f32_16x16x32_bf16 v[60:63], v[84:87], v[136:139], v[60:63]
ds_read_b128 v[80:83], v7 offset:13312
ds_read_b128 v[84:87], v7 offset:33792
s_waitcnt lgkmcnt(4)
v_mfma_f32_16x16x32_bf16 v[32:35], a[44:47], v[88:91], v[32:35]
v_mfma_f32_16x16x32_bf16 v[36:39], a[44:47], v[92:95], v[36:39]
v_mfma_f32_16x16x32_bf16 v[40:43], a[124:127], v[88:91], v[40:43]
v_mfma_f32_16x16x32_bf16 v[44:47], a[124:127], v[92:95], v[44:47]
v_mfma_f32_16x16x32_bf16 v[48:51], v[88:91], a[204:207], v[48:51]
v_mfma_f32_16x16x32_bf16 v[52:55], v[92:95], a[204:207], v[52:55]
v_mfma_f32_16x16x32_bf16 v[56:59], v[88:91], v[140:143], v[56:59]
v_mfma_f32_16x16x32_bf16 v[60:63], v[92:95], v[140:143], v[60:63]
ds_read_b128 v[88:91], v7 offset:14336
ds_read_b128 v[92:95], v7 offset:34816
s_waitcnt lgkmcnt(4)
v_mfma_f32_16x16x32_bf16 v[32:35], a[48:51], v[72:75], v[32:35]
v_mfma_f32_16x16x32_bf16 v[36:39], a[48:51], v[76:79], v[36:39]
v_mfma_f32_16x16x32_bf16 v[40:43], a[128:131], v[72:75], v[40:43]
v_mfma_f32_16x16x32_bf16 v[44:47], a[128:131], v[76:79], v[44:47]
v_mfma_f32_16x16x32_bf16 v[48:51], v[72:75], a[208:211], v[48:51]
v_mfma_f32_16x16x32_bf16 v[52:55], v[76:79], a[208:211], v[52:55]
v_mfma_f32_16x16x32_bf16 v[56:59], v[72:75], v[144:147], v[56:59]
v_mfma_f32_16x16x32_bf16 v[60:63], v[76:79], v[144:147], v[60:63]
ds_read_b128 v[72:75], v7 offset:15360
ds_read_b128 v[76:79], v7 offset:35840
s_waitcnt lgkmcnt(4)
v_mfma_f32_16x16x32_bf16 v[32:35], a[52:55], v[80:83], v[32:35]
v_mfma_f32_16x16x32_bf16 v[36:39], a[52:55], v[84:87], v[36:39]
v_mfma_f32_16x16x32_bf16 v[40:43], a[132:135], v[80:83], v[40:43]
v_mfma_f32_16x16x32_bf16 v[44:47], a[132:135], v[84:87], v[44:47]
v_mfma_f32_16x16x32_bf16 v[48:51], v[80:83], a[212:215], v[48:51]
v_mfma_f32_16x16x32_bf16 v[52:55], v[84:87], a[212:215], v[52:55]
v_mfma_f32_16x16x32_bf16 v[56:59], v[80:83], v[148:151], v[56:59]
v_mfma_f32_16x16x32_bf16 v[60:63], v[84:87], v[148:151], v[60:63]
ds_read_b128 v[80:83], v7 offset:16384
ds_read_b128 v[84:87], v7 offset:36864
s_waitcnt lgkmcnt(4)
v_mfma_f32_16x16x32_bf16 v[32:35], a[56:59], v[88:91], v[32:35]
v_mfma_f32_16x16x32_bf16 v[36:39], a[56:59], v[92:95], v[36:39]
v_mfma_f32_16x16x32_bf16 v[40:43], a[136:139], v[88:91], v[40:43]
v_mfma_f32_16x16x32_bf16 v[44:47], a[136:139], v[92:95], v[44:47]
v_mfma_f32_16x16x32_bf16 v[48:51], v[88:91], a[216:219], v[48:51]
v_mfma_f32_16x16x32_bf16 v[52:55], v[92:95], a[216:219], v[52:55]
v_mfma_f32_16x16x32_bf16 v[56:59], v[88:91], v[152:155], v[56:59]
v_mfma_f32_16x16x32_bf16 v[60:63], v[92:95], v[152:155], v[60:63]
ds_read_b128 v[88:91], v7 offset:17408
ds_read_b128 v[92:95], v7 offset:37888
s_waitcnt lgkmcnt(4)
v_mfma_f32_16x16x32_bf16 v[32:35], a[60:63], v[72:75], v[32:35]
v_mfma_f32_16x16x32_bf16 v[36:39], a[60:63], v[76:79], v[36:39]
v_mfma_f32_16x16x32_bf16 v[40:43], a[140:143], v[72:75], v[40:43]
v_mfma_f32_16x16x32_bf16 v[44:47], a[140:143], v[76:79], v[44:47]
v_mfma_f32_16x16x32_bf16 v[48:51], v[72:75], a[220:223], v[48:51]
v_mfma_f32_16x16x32_bf16 v[52:55], v[76:79], a[220:223], v[52:55]
v_mfma_f32_16x16x32_bf16 v[56:59], v[72:75], v[156:159], v[56:59]
v_mfma_f32_16x16x32_bf16 v[60:63], v[76:79], v[156:159], v[60:63]
ds_read_b128 v[72:75], v7 offset:18432
ds_read_b128 v[76:79], v7 offset:38912
s_waitcnt lgkmcnt(4)
v_mfma_f32_16x16x32_bf16 v[32:35], a[64:67], v[80:83], v[32:35]
v_mfma_f32_16x16x32_bf16 v[36:39], a[64:67], v[84:87], v[36:39]
v_mfma_f32_16x16x32_bf16 v[40:43], a[144:147], v[80:83], v[40:43]
v_mfma_f32_16x16x32_bf16 v[44:47], a[144:147], v[84:87], v[44:47]
v_mfma_f32_16x16x32_bf16 v[48:51], v[80:83], a[224:227], v[48:51]
v_mfma_f32_16x16x32_bf16 v[52:55], v[84:87], a[224:227], v[52:55]
v_mfma_f32_16x16x32_bf16 v[56:59], v[80:83], v[160:163], v[56:59]
v_mfma_f32_16x16x32_bf16 v[60:63], v[84:87], v[160:163], v[60:63]
ds_read_b128 v[80:83], v7 offset:19456
ds_read_b128 v[84:87], v7 offset:39936
s_waitcnt lgkmcnt(4)
v_mfma_f32_16x16x32_bf16 v[32:35], a[68:71], v[88:91], v[32:35]
v_mfma_f32_16x16x32_bf16 v[36:39], a[68:71], v[92:95], v[36:39]
v_mfma_f32_16x16x32_bf16 v[40:43], a[148:151], v[88:91], v[40:43]
v_mfma_f32_16x16x32_bf16 v[44:47], a[148:151], v[92:95], v[44:47]
v_mfma_f32_16x16x32_bf16 v[48:51], v[88:91], a[228:231], v[48:51]
v_mfma_f32_16x16x32_bf16 v[52:55], v[92:95], a[228:231], v[52:55]
v_mfma_f32_16x16x32_bf16 v[56:59], v[88:91], v[164:167], v[56:59]
v_mfma_f32_16x16x32_bf16 v[60:63], v[92:95], v[164:167], v[60:63]
s_waitcnt lgkmcnt(2)
v_mfma_f32_16x16x32_bf16 v[32:35], a[72:75], v[72:75], v[32:35]
v_mfma_f32_16x16x32_bf16 v[36:39], a[72:75], v[76:79], v[36:39]
v_mfma_f32_16x16x32_bf16 v[40:43], a[152:155], v[72:75], v[40:43]
v_mfma_f32_16x16x32_bf16 v[44:47], a[152:155], v[76:79], v[44:47]
v_mfma_f32_16x16x32_bf16 v[48:51], v[72:75], a[232:235], v[48:51]
v_mfma_f32_16x16x32_bf16 v[52:55], v[76:79], a[232:235], v[52:55]
v_mfma_f32_16x16x32_bf16 v[56:59], v[72:75], v[168:171], v[56:59]
v_mfma_f32_16x16x32_bf16 v[60:63], v[76:79], v[168:171], v[60:63]
s_waitcnt lgkmcnt(0)
v_mfma_f32_16x16x32_bf16 v[32:35], a[76:79], v[80:83], v[32:35]
v_mfma_f32_16x16x32_bf16 v[36:39], a[76:79], v[84:87], v[36:39]
v_mfma_f32_16x16x32_bf16 v[40:43], a[156:159], v[80:83], v[40:43]
v_mfma_f32_16x16x32_bf16 v[44:47], a[156:159], v[84:87], v[44:47]
v_mfma_f32_16x16x32_bf16 v[48:51], v[80:83], a[236:239], v[48:51]
v_mfma_f32_16x16x32_bf16 v[52:55], v[84:87], a[236:239], v[52:55]
v_mfma_f32_16x16x32_bf16 v[56:59], v[80:83], v[172:175], v[56:59]
v_mfma_f32_16x16x32_bf16 v[60:63], v[84:87], v[172:175], v[60:63]
s_nop 0
v_cvt_pk_bf16_f32 v8, v32, v33
v_cvt_pk_bf16_f32 v9, v34, v35
v_cvt_pk_bf16_f32 v10, v40, v41
v_cvt_pk_bf16_f32 v11, v42, v43
s_add_u32 s34, s22, 0
buffer_store_dwordx4 v[8:11], v1, s[4:7], s34 offen
v_cvt_pk_bf16_f32 v12, v36, v37
v_cvt_pk_bf16_f32 v13, v38, v39
v_cvt_pk_bf16_f32 v14, v44, v45
v_cvt_pk_bf16_f32 v15, v46, v47
s_add_u32 s34, s22, 6144
buffer_store_dwordx4 v[12:15], v1, s[4:7], s34 offen
v_cvt_pk_bf16_f32 v8, v48, v49
v_cvt_pk_bf16_f32 v9, v50, v51
v_cvt_pk_bf16_f32 v10, v52, v53
v_cvt_pk_bf16_f32 v11, v54, v55
s_add_u32 s34, s23, 4096
buffer_store_dwordx4 v[8:11], v1, s[4:7], s34 offen
v_cvt_pk_bf16_f32 v12, v56, v57
v_cvt_pk_bf16_f32 v13, v58, v59
v_cvt_pk_bf16_f32 v14, v60, v61
v_cvt_pk_bf16_f32 v15, v62, v63
s_add_u32 s34, s23, 5120
buffer_store_dwordx4 v[12:15], v1, s[4:7], s34 offen
s_waitcnt vmcnt(0)
s_barrier
s_add_u32 s17, s17, 1
s_cmp_lt_u32 s17, 64
s_cbranch_scc1 reca_ptop259
s_branch reca_exit1
reca_pslow258:
reca_ptop264:
s_cmp_lt_u32 s17, 3
s_cbranch_scc1 reca_pgo265
s_sub_u32 s36, s17, 3
reca_ppoll266:
buffer_load_dword v28, v4, s[4:7], s25 offen sc1
s_waitcnt vmcnt(0)
v_readfirstlane_b32 s34, v28
s_nop 3
s_cmp_ge_i32 s34, s36
s_cbranch_scc1 reca_pgo265
s_sleep 8
s_sub_u32 s18, s18, 1
s_cbranch_scc0 reca_ppoll266
s_mov_b32 s18, 0
reca_pgo265:
s_waitcnt vmcnt(0)
s_barrier
v_add_u32 v7, s26, v1
s_xor_b32 s26, s26, 40960
s_add_u32 s37, s17, 1
s_cmp_ge_u32 s37, 64
s_cbranch_scc1 reca_pnodma267
s_mul_i32 s20, s37, 40960
s_add_u32 s20, s20, 84955136
s_add_u32 m0, s26, 20480
s_nop 0
buffer_load_dwordx4 v1, s[4:7], s20 offen offset:0 lds
buffer_load_dwordx4 v1, s[4:7], s20 offen offset:1024 lds
buffer_load_dwordx4 v1, s[4:7], s20 offen offset:2048 lds
buffer_load_dwordx4 v1, s[4:7], s20 offen offset:3072 lds
s_add_u32 s20, s20, 4096
s_add_u32 m0, s26, 24576
s_nop 0
buffer_load_dwordx4 v1, s[4:7], s20 offen offset:0 lds
buffer_load_dwordx4 v1, s[4:7], s20 offen offset:1024 lds
buffer_load_dwordx4 v1, s[4:7], s20 offen offset:2048 lds
buffer_load_dwordx4 v1, s[4:7], s20 offen offset:3072 lds
s_add_u32 s20, s20, 4096
s_add_u32 m0, s26, 28672
s_nop 0
buffer_load_dwordx4 v1, s[4:7], s20 offen offset:0 lds
buffer_load_dwordx4 v1, s[4:7], s20 offen offset:1024 lds
reca_pnodma267:
s_lshl_b32 s34, s15, 3
s_and_b32 s35, s17, 7
s_add_u32 s34, s34, s35
s_mul_i32 s34, s34, 12288
s_mul_i32 s35, s16, 3072
s_add_u32 s35, s35, s34
s_add_u32 s21, s35, 37748736
s_add_u32 s22, s35, 44040192
s_mul_i32 s35, s16, 6144
s_add_u32 s35, s35, s34
s_add_u32 s23, s35, 40894464
ds_read_b128 v[72:75], v7 offset:0
ds_read_b128 v[76:79], v7 offset:20480
ds_read_b128 v[80:83], v7 offset:1024
ds_read_b128 v[84:87], v7 offset:21504
ds_read_b128 v[88:91], v7 offset:2048
ds_read_b128 v[92:95], v7 offset:22528
s_waitcnt lgkmcnt(4)
v_mfma_f32_16x16x32_bf16 v[32:35], a[0:3], v[72:75], 0
v_mfma_f32_16x16x32_bf16 v[36:39], a[0:3], v[76:79], 0
v_mfma_f32_16x16x32_bf16 v[40:43], a[80:83], v[72:75], 0
v_mfma_f32_16x16x32_bf16 v[44:47], a[80:83], v[76:79], 0
v_mfma_f32_16x16x32_bf16 v[48:51], v[72:75], a[160:163], 0
v_mfma_f32_16x16x32_bf16 v[52:55], v[76:79], a[160:163], 0
v_mfma_f32_16x16x32_bf16 v[56:59], v[72:75], v[96:99], 0
v_mfma_f32_16x16x32_bf16 v[60:63], v[76:79], v[96:99], 0
ds_read_b128 v[72:75], v7 offset:3072
ds_read_b128 v[76:79], v7 offset:23552
s_waitcnt lgkmcnt(4)
v_mfma_f32_16x16x32_bf16 v[32:35], a[4:7], v[80:83], v[32:35]
v_mfma_f32_16x16x32_bf16 v[36:39], a[4:7], v[84:87], v[36:39]
v_mfma_f32_16x16x32_bf16 v[40:43], a[84:87], v[80:83], v[40:43]
v_mfma_f32_16x16x32_bf16 v[44:47], a[84:87], v[84:87], v[44:47]
v_mfma_f32_16x16x32_bf16 v[48:51], v[80:83], a[164:167], v[48:51]
v_mfma_f32_16x16x32_bf16 v[52:55], v[84:87], a[164:167], v[52:55]
v_mfma_f32_16x16x32_bf16 v[56:59], v[80:83], v[100:103], v[56:59]
v_mfma_f32_16x16x32_bf16 v[60:63], v[84:87], v[100:103], v[60:63]
ds_read_b128 v[80:83], v7 offset:4096
ds_read_b128 v[84:87], v7 offset:24576
s_waitcnt lgkmcnt(4)
v_mfma_f32_16x16x32_bf16 v[32:35], a[8:11], v[88:91], v[32:35]
v_mfma_f32_16x16x32_bf16 v[36:39], a[8:11], v[92:95], v[36:39]
v_mfma_f32_16x16x32_bf16 v[40:43], a[88:91], v[88:91], v[40:43]
v_mfma_f32_16x16x32_bf16 v[44:47], a[88:91], v[92:95], v[44:47]
v_mfma_f32_16x16x32_bf16 v[48:51], v[88:91], a[168:171], v[48:51]
v_mfma_f32_16x16x32_bf16 v[52:55], v[92:95], a[168:171], v[52:55]
v_mfma_f32_16x16x32_bf16 v[56:59], v[88:91], v[104:107], v[56:59]
v_mfma_f32_16x16x32_bf16 v[60:63], v[92:95], v[104:107], v[60:63]
ds_read_b128 v[88:91], v7 offset:5120
ds_read_b128 v[92:95], v7 offset:25600
s_waitcnt lgkmcnt(4)
v_mfma_f32_16x16x32_bf16 v[32:35], a[12:15], v[72:75], v[32:35]
v_mfma_f32_16x16x32_bf16 v[36:39], a[12:15], v[76:79], v[36:39]
v_mfma_f32_16x16x32_bf16 v[40:43], a[92:95], v[72:75], v[40:43]
v_mfma_f32_16x16x32_bf16 v[44:47], a[92:95], v[76:79], v[44:47]
v_mfma_f32_16x16x32_bf16 v[48:51], v[72:75], a[172:175], v[48:51]
v_mfma_f32_16x16x32_bf16 v[52:55], v[76:79], a[172:175], v[52:55]
v_mfma_f32_16x16x32_bf16 v[56:59], v[72:75], v[108:111], v[56:59]
v_mfma_f32_16x16x32_bf16 v[60:63], v[76:79], v[108:111], v[60:63]
ds_read_b128 v[72:75], v7 offset:6144
ds_read_b128 v[76:79], v7 offset:26624
s_waitcnt lgkmcnt(4)
v_mfma_f32_16x16x32_bf16 v[32:35], a[16:19], v[80:83], v[32:35]
v_mfma_f32_16x16x32_bf16 v[36:39], a[16:19], v[84:87], v[36:39]
v_mfma_f32_16x16x32_bf16 v[40:43], a[96:99], v[80:83], v[40:43]
v_mfma_f32_16x16x32_bf16 v[44:47], a[96:99], v[84:87], v[44:47]
v_mfma_f32_16x16x32_bf16 v[48:51], v[80:83], a[176:179], v[48:51]
v_mfma_f32_16x16x32_bf16 v[52:55], v[84:87], a[176:179], v[52:55]
v_mfma_f32_16x16x32_bf16 v[56:59], v[80:83], v[112:115], v[56:59]
v_mfma_f32_16x16x32_bf16 v[60:63], v[84:87], v[112:115], v[60:63]
ds_read_b128 v[80:83], v7 offset:7168
ds_read_b128 v[84:87], v7 offset:27648
s_waitcnt lgkmcnt(4)
v_mfma_f32_16x16x32_bf16 v[32:35], a[20:23], v[88:91], v[32:35]
v_mfma_f32_16x16x32_bf16 v[36:39], a[20:23], v[92:95], v[36:39]
v_mfma_f32_16x16x32_bf16 v[40:43], a[100:103], v[88:91], v[40:43]
v_mfma_f32_16x16x32_bf16 v[44:47], a[100:103], v[92:95], v[44:47]
v_mfma_f32_16x16x32_bf16 v[48:51], v[88:91], a[180:183], v[48:51]
v_mfma_f32_16x16x32_bf16 v[52:55], v[92:95], a[180:183], v[52:55]
v_mfma_f32_16x16x32_bf16 v[56:59], v[88:91], v[116:119], v[56:59]
v_mfma_f32_16x16x32_bf16 v[60:63], v[92:95], v[116:119], v[60:63]
ds_read_b128 v[88:91], v7 offset:8192
ds_read_b128 v[92:95], v7 offset:28672
s_waitcnt lgkmcnt(4)
v_mfma_f32_16x16x32_bf16 v[32:35], a[24:27], v[72:75], v[32:35]
v_mfma_f32_16x16x32_bf16 v[36:39], a[24:27], v[76:79], v[36:39]
v_mfma_f32_16x16x32_bf16 v[40:43], a[104:107], v[72:75], v[40:43]
v_mfma_f32_16x16x32_bf16 v[44:47], a[104:107], v[76:79], v[44:47]
v_mfma_f32_16x16x32_bf16 v[48:51], v[72:75], a[184:187], v[48:51]
v_mfma_f32_16x16x32_bf16 v[52:55], v[76:79], a[184:187], v[52:55]
v_mfma_f32_16x16x32_bf16 v[56:59], v[72:75], v[120:123], v[56:59]
v_mfma_f32_16x16x32_bf16 v[60:63], v[76:79], v[120:123], v[60:63]
ds_read_b128 v[72:75], v7 offset:9216
ds_read_b128 v[76:79], v7 offset:29696
s_waitcnt lgkmcnt(4)
v_mfma_f32_16x16x32_bf16 v[32:35], a[28:31], v[80:83], v[32:35]
v_mfma_f32_16x16x32_bf16 v[36:39], a[28:31], v[84:87], v[36:39]
v_mfma_f32_16x16x32_bf16 v[40:43], a[108:111], v[80:83], v[40:43]
v_mfma_f32_16x16x32_bf16 v[44:47], a[108:111], v[84:87], v[44:47]
v_mfma_f32_16x16x32_bf16 v[48:51], v[80:83], a[188:191], v[48:51]
v_mfma_f32_16x16x32_bf16 v[52:55], v[84:87], a[188:191], v[52:55]
v_mfma_f32_16x16x32_bf16 v[56:59], v[80:83], v[124:127], v[56:59]
v_mfma_f32_16x16x32_bf16 v[60:63], v[84:87], v[124:127], v[60:63]
ds_read_b128 v[80:83], v7 offset:10240
ds_read_b128 v[84:87], v7 offset:30720
s_waitcnt lgkmcnt(4)
v_mfma_f32_16x16x32_bf16 v[32:35], a[32:35], v[88:91], v[32:35]
v_mfma_f32_16x16x32_bf16 v[36:39], a[32:35], v[92:95], v[36:39]
v_mfma_f32_16x16x32_bf16 v[40:43], a[112:115], v[88:91], v[40:43]
v_mfma_f32_16x16x32_bf16 v[44:47], a[112:115], v[92:95], v[44:47]
v_mfma_f32_16x16x32_bf16 v[48:51], v[88:91], a[192:195], v[48:51]
v_mfma_f32_16x16x32_bf16 v[52:55], v[92:95], a[192:195], v[52:55]
v_mfma_f32_16x16x32_bf16 v[56:59], v[88:91], v[128:131], v[56:59]
v_mfma_f32_16x16x32_bf16 v[60:63], v[92:95], v[128:131], v[60:63]
ds_read_b128 v[88:91], v7 offset:11264
ds_read_b128 v[92:95], v7 offset:31744
s_waitcnt lgkmcnt(4)
v_mfma_f32_16x16x32_bf16 v[32:35], a[36:39], v[72:75], v[32:35]
v_mfma_f32_16x16x32_bf16 v[36:39], a[36:39], v[76:79], v[36:39]
v_mfma_f32_16x16x32_bf16 v[40:43], a[116:119], v[72:75], v[40:43]
v_mfma_f32_16x16x32_bf16 v[44:47], a[116:119], v[76:79], v[44:47]
v_mfma_f32_16x16x32_bf16 v[48:51], v[72:75], a[196:199], v[48:51]
v_mfma_f32_16x16x32_bf16 v[52:55], v[76:79], a[196:199], v[52:55]
v_mfma_f32_16x16x32_bf16 v[56:59], v[72:75], v[132:135], v[56:59]
v_mfma_f32_16x16x32_bf16 v[60:63], v[76:79], v[132:135], v[60:63]
ds_read_b128 v[72:75], v7 offset:12288
ds_read_b128 v[76:79], v7 offset:32768
s_waitcnt lgkmcnt(4)
v_mfma_f32_16x16x32_bf16 v[32:35], a[40:43], v[80:83], v[32:35]
v_mfma_f32_16x16x32_bf16 v[36:39], a[40:43], v[84:87], v[36:39]
v_mfma_f32_16x16x32_bf16 v[40:43], a[120:123], v[80:83], v[40:43]
v_mfma_f32_16x16x32_bf16 v[44:47], a[120:123], v[84:87], v[44:47]
v_mfma_f32_16x16x32_bf16 v[48:51], v[80:83], a[200:203], v[48:51]
v_mfma_f32_16x16x32_bf16 v[52:55], v[84:87], a[200:203], v[52:55]
v_mfma_f32_16x16x32_bf16 v[56:59], v[80:83], v[136:139], v[56:59]
v_mfma_f32_16x16x32_bf16 v[60:63], v[84:87], v[136:139], v[60:63]
ds_read_b128 v[80:83], v7 offset:13312
ds_read_b128 v[84:87], v7 offset:33792
s_waitcnt lgkmcnt(4)
v_mfma_f32_16x16x32_bf16 v[32:35], a[44:47], v[88:91], v[32:35]
v_mfma_f32_16x16x32_bf16 v[36:39], a[44:47], v[92:95], v[36:39]
v_mfma_f32_16x16x32_bf16 v[40:43], a[124:127], v[88:91], v[40:43]
v_mfma_f32_16x16x32_bf16 v[44:47], a[124:127], v[92:95], v[44:47]
v_mfma_f32_16x16x32_bf16 v[48:51], v[88:91], a[204:207], v[48:51]
v_mfma_f32_16x16x32_bf16 v[52:55], v[92:95], a[204:207], v[52:55]
v_mfma_f32_16x16x32_bf16 v[56:59], v[88:91], v[140:143], v[56:59]
v_mfma_f32_16x16x32_bf16 v[60:63], v[92:95], v[140:143], v[60:63]
ds_read_b128 v[88:91], v7 offset:14336
ds_read_b128 v[92:95], v7 offset:34816
s_waitcnt lgkmcnt(4)
v_mfma_f32_16x16x32_bf16 v[32:35], a[48:51], v[72:75], v[32:35]
v_mfma_f32_16x16x32_bf16 v[36:39], a[48:51], v[76:79], v[36:39]
v_mfma_f32_16x16x32_bf16 v[40:43], a[128:131], v[72:75], v[40:43]
v_mfma_f32_16x16x32_bf16 v[44:47], a[128:131], v[76:79], v[44:47]
v_mfma_f32_16x16x32_bf16 v[48:51], v[72:75], a[208:211], v[48:51]
v_mfma_f32_16x16x32_bf16 v[52:55], v[76:79], a[208:211], v[52:55]
v_mfma_f32_16x16x32_bf16 v[56:59], v[72:75], v[144:147], v[56:59]
v_mfma_f32_16x16x32_bf16 v[60:63], v[76:79], v[144:147], v[60:63]
ds_read_b128 v[72:75], v7 offset:15360
ds_read_b128 v[76:79], v7 offset:35840
s_waitcnt lgkmcnt(4)
v_mfma_f32_16x16x32_bf16 v[32:35], a[52:55], v[80:83], v[32:35]
v_mfma_f32_16x16x32_bf16 v[36:39], a[52:55], v[84:87], v[36:39]
v_mfma_f32_16x16x32_bf16 v[40:43], a[132:135], v[80:83], v[40:43]
v_mfma_f32_16x16x32_bf16 v[44:47], a[132:135], v[84:87], v[44:47]
v_mfma_f32_16x16x32_bf16 v[48:51], v[80:83], a[212:215], v[48:51]
v_mfma_f32_16x16x32_bf16 v[52:55], v[84:87], a[212:215], v[52:55]
v_mfma_f32_16x16x32_bf16 v[56:59], v[80:83], v[148:151], v[56:59]
v_mfma_f32_16x16x32_bf16 v[60:63], v[84:87], v[148:151], v[60:63]
ds_read_b128 v[80:83], v7 offset:16384
ds_read_b128 v[84:87], v7 offset:36864
s_waitcnt lgkmcnt(4)
v_mfma_f32_16x16x32_bf16 v[32:35], a[56:59], v[88:91], v[32:35]
v_mfma_f32_16x16x32_bf16 v[36:39], a[56:59], v[92:95], v[36:39]
v_mfma_f32_16x16x32_bf16 v[40:43], a[136:139], v[88:91], v[40:43]
v_mfma_f32_16x16x32_bf16 v[44:47], a[136:139], v[92:95], v[44:47]
v_mfma_f32_16x16x32_bf16 v[48:51], v[88:91], a[216:219], v[48:51]
v_mfma_f32_16x16x32_bf16 v[52:55], v[92:95], a[216:219], v[52:55]
v_mfma_f32_16x16x32_bf16 v[56:59], v[88:91], v[152:155], v[56:59]
v_mfma_f32_16x16x32_bf16 v[60:63], v[92:95], v[152:155], v[60:63]
ds_read_b128 v[88:91], v7 offset:17408
ds_read_b128 v[92:95], v7 offset:37888
s_waitcnt lgkmcnt(4)
v_mfma_f32_16x16x32_bf16 v[32:35], a[60:63], v[72:75], v[32:35]
v_mfma_f32_16x16x32_bf16 v[36:39], a[60:63], v[76:79], v[36:39]
v_mfma_f32_16x16x32_bf16 v[40:43], a[140:143], v[72:75], v[40:43]
v_mfma_f32_16x16x32_bf16 v[44:47], a[140:143], v[76:79], v[44:47]
v_mfma_f32_16x16x32_bf16 v[48:51], v[72:75], a[220:223], v[48:51]
v_mfma_f32_16x16x32_bf16 v[52:55], v[76:79], a[220:223], v[52:55]
v_mfma_f32_16x16x32_bf16 v[56:59], v[72:75], v[156:159], v[56:59]
v_mfma_f32_16x16x32_bf16 v[60:63], v[76:79], v[156:159], v[60:63]
ds_read_b128 v[72:75], v7 offset:18432
ds_read_b128 v[76:79], v7 offset:38912
s_waitcnt lgkmcnt(4)
v_mfma_f32_16x16x32_bf16 v[32:35], a[64:67], v[80:83], v[32:35]
v_mfma_f32_16x16x32_bf16 v[36:39], a[64:67], v[84:87], v[36:39]
v_mfma_f32_16x16x32_bf16 v[40:43], a[144:147], v[80:83], v[40:43]
v_mfma_f32_16x16x32_bf16 v[44:47], a[144:147], v[84:87], v[44:47]
v_mfma_f32_16x16x32_bf16 v[48:51], v[80:83], a[224:227], v[48:51]
v_mfma_f32_16x16x32_bf16 v[52:55], v[84:87], a[224:227], v[52:55]
v_mfma_f32_16x16x32_bf16 v[56:59], v[80:83], v[160:163], v[56:59]
v_mfma_f32_16x16x32_bf16 v[60:63], v[84:87], v[160:163], v[60:63]
ds_read_b128 v[80:83], v7 offset:19456
ds_read_b128 v[84:87], v7 offset:39936
s_waitcnt lgkmcnt(4)
v_mfma_f32_16x16x32_bf16 v[32:35], a[68:71], v[88:91], v[32:35]
v_mfma_f32_16x16x32_bf16 v[36:39], a[68:71], v[92:95], v[36:39]
v_mfma_f32_16x16x32_bf16 v[40:43], a[148:151], v[88:91], v[40:43]
v_mfma_f32_16x16x32_bf16 v[44:47], a[148:151], v[92:95], v[44:47]
v_mfma_f32_16x16x32_bf16 v[48:51], v[88:91], a[228:231], v[48:51]
v_mfma_f32_16x16x32_bf16 v[52:55], v[92:95], a[228:231], v[52:55]
v_mfma_f32_16x16x32_bf16 v[56:59], v[88:91], v[164:167], v[56:59]
v_mfma_f32_16x16x32_bf16 v[60:63], v[92:95], v[164:167], v[60:63]
s_waitcnt lgkmcnt(2)
v_mfma_f32_16x16x32_bf16 v[32:35], a[72:75], v[72:75], v[32:35]
v_mfma_f32_16x16x32_bf16 v[36:39], a[72:75], v[76:79], v[36:39]
v_mfma_f32_16x16x32_bf16 v[40:43], a[152:155], v[72:75], v[40:43]
v_mfma_f32_16x16x32_bf16 v[44:47], a[152:155], v[76:79], v[44:47]
v_mfma_f32_16x16x32_bf16 v[48:51], v[72:75], a[232:235], v[48:51]
v_mfma_f32_16x16x32_bf16 v[52:55], v[76:79], a[232:235], v[52:55]
v_mfma_f32_16x16x32_bf16 v[56:59], v[72:75], v[168:171], v[56:59]
v_mfma_f32_16x16x32_bf16 v[60:63], v[76:79], v[168:171], v[60:63]
s_waitcnt lgkmcnt(0)
v_mfma_f32_16x16x32_bf16 v[32:35], a[76:79], v[80:83], v[32:35]
v_mfma_f32_16x16x32_bf16 v[36:39], a[76:79], v[84:87], v[36:39]
v_mfma_f32_16x16x32_bf16 v[40:43], a[156:159], v[80:83], v[40:43]
v_mfma_f32_16x16x32_bf16 v[44:47], a[156:159], v[84:87], v[44:47]
v_mfma_f32_16x16x32_bf16 v[48:51], v[80:83], a[236:239], v[48:51]
v_mfma_f32_16x16x32_bf16 v[52:55], v[84:87], a[236:239], v[52:55]
v_mfma_f32_16x16x32_bf16 v[56:59], v[80:83], v[172:175], v[56:59]
v_mfma_f32_16x16x32_bf16 v[60:63], v[84:87], v[172:175], v[60:63]
s_nop 0
v_cvt_pk_bf16_f32 v8, v32, v33
v_cvt_pk_bf16_f32 v9, v34, v35
v_cvt_pk_bf16_f32 v10, v40, v41
v_cvt_pk_bf16_f32 v11, v42, v43
s_add_u32 s34, s22, 0
buffer_store_dwordx4 v[8:11], v1, s[4:7], s34 offen sc1
v_cvt_pk_bf16_f32 v12, v36, v37
v_cvt_pk_bf16_f32 v13, v38, v39
v_cvt_pk_bf16_f32 v14, v44, v45
v_cvt_pk_bf16_f32 v15, v46, v47
s_add_u32 s34, s22, 6144
buffer_store_dwordx4 v[12:15], v1, s[4:7], s34 offen sc1
v_cvt_pk_bf16_f32 v8, v48, v49
v_cvt_pk_bf16_f32 v9, v50, v51
v_cvt_pk_bf16_f32 v10, v52, v53
v_cvt_pk_bf16_f32 v11, v54, v55
s_add_u32 s34, s23, 4096
buffer_store_dwordx4 v[8:11], v1, s[4:7], s34 offen sc1
v_cvt_pk_bf16_f32 v12, v56, v57
v_cvt_pk_bf16_f32 v13, v58, v59
v_cvt_pk_bf16_f32 v14, v60, v61
v_cvt_pk_bf16_f32 v15, v62, v63
s_add_u32 s34, s23, 5120
buffer_store_dwordx4 v[12:15], v1, s[4:7], s34 offen sc1
s_waitcnt vmcnt(0)
s_barrier
s_add_u32 s17, s17, 1
s_cmp_lt_u32 s17, 64
s_cbranch_scc1 reca_ptop264
s_branch reca_exit1
reca_pw3_229:
s_mov_b32 s17, 0
s_mov_b32 s26, 0
s_mul_i32 s20, s17, 40960
s_add_u32 s20, s20, 84965376
s_add_u32 m0, s26, 30720
s_nop 0
buffer_load_dwordx4 v1, s[4:7], s20 offen offset:0 lds
buffer_load_dwordx4 v1, s[4:7], s20 offen offset:1024 lds
buffer_load_dwordx4 v1, s[4:7], s20 offen offset:2048 lds
buffer_load_dwordx4 v1, s[4:7], s20 offen offset:3072 lds
s_add_u32 s20, s20, 4096
s_add_u32 m0, s26, 34816
s_nop 0
buffer_load_dwordx4 v1, s[4:7], s20 offen offset:0 lds
buffer_load_dwordx4 v1, s[4:7], s20 offen offset:1024 lds
buffer_load_dwordx4 v1, s[4:7], s20 offen offset:2048 lds
buffer_load_dwordx4 v1, s[4:7], s20 offen offset:3072 lds
s_add_u32 s20, s20, 4096
s_add_u32 m0, s26, 38912
s_nop 0
buffer_load_dwordx4 v1, s[4:7], s20 offen offset:0 lds
buffer_load_dwordx4 v1, s[4:7], s20 offen offset:1024 lds
s_mul_i32 s34, s15, 12
s_mul_i32 s35, s16, 6
s_add_u32 s34, s34, s35
s_add_u32 s34, s34, 2
s_mul_i32 s34, s34, 20480
s_add_u32 s34, s34, 6291456
buffer_load_dwordx4 a[0:3], v1, s[4:7], s34 offen offset:0
buffer_load_dwordx4 a[4:7], v1, s[4:7], s34 offen offset:1024
buffer_load_dwordx4 a[8:11], v1, s[4:7], s34 offen offset:2048
buffer_load_dwordx4 a[12:15], v1, s[4:7], s34 offen offset:3072
s_add_u32 s34, s34, 4096
buffer_load_dwordx4 a[16:19], v1, s[4:7], s34 offen offset:0
buffer_load_dwordx4 a[20:23], v1, s[4:7], s34 offen offset:1024
buffer_load_dwordx4 a[24:27], v1, s[4:7], s34 offen offset:2048
buffer_load_dwordx4 a[28:31], v1, s[4:7], s34 offen offset:3072
s_add_u32 s34, s34, 4096
buffer_load_dwordx4 a[32:35], v1, s[4:7], s34 offen offset:0
buffer_load_dwordx4 a[36:39], v1, s[4:7], s34 offen offset:1024
buffer_load_dwordx4 a[40:43], v1, s[4:7], s34 offen offset:2048
buffer_load_dwordx4 a[44:47], v1, s[4:7], s34 offen offset:3072
s_add_u32 s34, s34, 4096
buffer_load_dwordx4 a[48:51], v1, s[4:7], s34 offen offset:0
buffer_load_dwordx4 a[52:55], v1, s[4:7], s34 offen offset:1024
buffer_load_dwordx4 a[56:59], v1, s[4:7], s34 offen offset:2048
buffer_load_dwordx4 a[60:63], v1, s[4:7], s34 offen offset:3072
s_add_u32 s34, s34, 4096
buffer_load_dwordx4 a[64:67], v1, s[4:7], s34 offen offset:0
buffer_load_dwordx4 a[68:71], v1, s[4:7], s34 offen offset:1024
buffer_load_dwordx4 a[72:75], v1, s[4:7], s34 offen offset:2048
buffer_load_dwordx4 a[76:79], v1, s[4:7], s34 offen offset:3072
s_mul_i32 s34, s15, 12
s_mul_i32 s35, s16, 6
s_add_u32 s34, s34, s35
s_add_u32 s34, s34, 3
s_mul_i32 s34, s34, 20480
s_add_u32 s34, s34, 6291456
buffer_load_dwordx4 a[80:83], v1, s[4:7], s34 offen offset:0
buffer_load_dwordx4 a[84:87], v1, s[4:7], s34 offen offset:1024
buffer_load_dwordx4 a[88:91], v1, s[4:7], s34 offen offset:2048
buffer_load_dwordx4 a[92:95], v1, s[4:7], s34 offen offset:3072
s_add_u32 s34, s34, 4096
buffer_load_dwordx4 a[96:99], v1, s[4:7], s34 offen offset:0
buffer_load_dwordx4 a[100:103], v1, s[4:7], s34 offen offset:1024
buffer_load_dwordx4 a[104:107], v1, s[4:7], s34 offen offset:2048
buffer_load_dwordx4 a[108:111], v1, s[4:7], s34 offen offset:3072
s_add_u32 s34, s34, 4096
buffer_load_dwordx4 a[112:115], v1, s[4:7], s34 offen offset:0
buffer_load_dwordx4 a[116:119], v1, s[4:7], s34 offen offset:1024
buffer_load_dwordx4 a[120:123], v1, s[4:7], s34 offen offset:2048
buffer_load_dwordx4 a[124:127], v1, s[4:7], s34 offen offset:3072
s_add_u32 s34, s34, 4096
buffer_load_dwordx4 a[128:131], v1, s[4:7], s34 offen offset:0
buffer_load_dwordx4 a[132:135], v1, s[4:7], s34 offen offset:1024
buffer_load_dwordx4 a[136:139], v1, s[4:7], s34 offen offset:2048
buffer_load_dwordx4 a[140:143], v1, s[4:7], s34 offen offset:3072
s_add_u32 s34, s34, 4096
buffer_load_dwordx4 a[144:147], v1, s[4:7], s34 offen offset:0
buffer_load_dwordx4 a[148:151], v1, s[4:7], s34 offen offset:1024
buffer_load_dwordx4 a[152:155], v1, s[4:7], s34 offen offset:2048
buffer_load_dwordx4 a[156:159], v1, s[4:7], s34 offen offset:3072
s_waitcnt vmcnt(20)
s_mul_i32 s34, s15, 12
s_mul_i32 s35, s16, 6
s_add_u32 s34, s34, s35
s_add_u32 s34, s34, 4
s_mul_i32 s34, s34, 20480
s_add_u32 s34, s34, 6291456
buffer_load_dwordx4 a[160:163], v1, s[4:7], s34 offen offset:0
buffer_load_dwordx4 a[164:167], v1, s[4:7], s34 offen offset:1024
buffer_load_dwordx4 a[168:171], v1, s[4:7], s34 offen offset:2048
buffer_load_dwordx4 a[172:175], v1, s[4:7], s34 offen offset:3072
s_add_u32 s34, s34, 4096
buffer_load_dwordx4 a[176:179], v1, s[4:7], s34 offen offset:0
buffer_load_dwordx4 a[180:183], v1, s[4:7], s34 offen offset:1024
buffer_load_dwordx4 a[184:187], v1, s[4:7], s34 offen offset:2048
buffer_load_dwordx4 a[188:191], v1, s[4:7], s34 offen offset:3072
s_add_u32 s34, s34, 4096
buffer_load_dwordx4 a[192:195], v1, s[4:7], s34 offen offset:0
buffer_load_dwordx4 a[196:199], v1, s[4:7], s34 offen offset:1024
buffer_load_dwordx4 a[200:203], v1, s[4:7], s34 offen offset:2048
buffer_load_dwordx4 a[204:207], v1, s[4:7], s34 offen offset:3072
s_add_u32 s34, s34, 4096
buffer_load_dwordx4 a[208:211], v1, s[4:7], s34 offen offset:0
buffer_load_dwordx4 a[212:215], v1, s[4:7], s34 offen offset:1024
buffer_load_dwordx4 a[216:219], v1, s[4:7], s34 offen offset:2048
buffer_load_dwordx4 a[220:223], v1, s[4:7], s34 offen offset:3072
s_add_u32 s34, s34, 4096
buffer_load_dwordx4 a[224:227], v1, s[4:7], s34 offen offset:0
buffer_load_dwordx4 a[228:231], v1, s[4:7], s34 offen offset:1024
buffer_load_dwordx4 a[232:235], v1, s[4:7], s34 offen offset:2048
buffer_load_dwordx4 a[236:239], v1, s[4:7], s34 offen offset:3072
s_waitcnt vmcnt(20)
s_mul_i32 s34, s15, 12
s_mul_i32 s35, s16, 6
s_add_u32 s34, s34, s35
s_add_u32 s34, s34, 5
s_mul_i32 s34, s34, 20480
s_add_u32 s34, s34, 6291456
buffer_load_dwordx4 v[96:99], v1, s[4:7], s34 offen offset:0
buffer_load_dwordx4 v[100:103], v1, s[4:7], s34 offen offset:1024
buffer_load_dwordx4 v[104:107], v1, s[4:7], s34 offen offset:2048
buffer_load_dwordx4 v[108:111], v1, s[4:7], s34 offen offset:3072
s_add_u32 s34, s34, 4096
buffer_load_dwordx4 v[112:115], v1, s[4:7], s34 offen offset:0
buffer_load_dwordx4 v[116:119], v1, s[4:7], s34 offen offset:1024
buffer_load_dwordx4 v[120:123], v1, s[4:7], s34 offen offset:2048
buffer_load_dwordx4 v[124:127], v1, s[4:7], s34 offen offset:3072
s_add_u32 s34, s34, 4096
buffer_load_dwordx4 v[128:131], v1, s[4:7], s34 offen offset:0
buffer_load_dwordx4 v[132:135], v1, s[4:7], s34 offen offset:1024
buffer_load_dwordx4 v[136:139], v1, s[4:7], s34 offen offset:2048
buffer_load_dwordx4 v[140:143], v1, s[4:7], s34 offen offset:3072
s_add_u32 s34, s34, 4096
buffer_load_dwordx4 v[144:147], v1, s[4:7], s34 offen offset:0
buffer_load_dwordx4 v[148:151], v1, s[4:7], s34 offen offset:1024
buffer_load_dwordx4 v[152:155], v1, s[4:7], s34 offen offset:2048
buffer_load_dwordx4 v[156:159], v1, s[4:7], s34 offen offset:3072
s_add_u32 s34, s34, 4096
buffer_load_dwordx4 v[160:163], v1, s[4:7], s34 offen offset:0
buffer_load_dwordx4 v[164:167], v1, s[4:7], s34 offen offset:1024
buffer_load_dwordx4 v[168:171], v1, s[4:7], s34 offen offset:2048
buffer_load_dwordx4 v[172:175], v1, s[4:7], s34 offen offset:3072
s_waitcnt vmcnt(20)
v_and_b32 v30, 7, v0
v_lshlrev_b32 v30, 3, v30
reca_cens269:
buffer_load_dwordx2 v[28:29], v30, s[8:11], 0 offen sc1
s_waitcnt vmcnt(0)
v_sad_u8 v31, v28, 0, 0
v_sad_u8 v31, v29, 0, v31
v_cmp_gt_u32 vcc, 32, v31
s_cbranch_vccz reca_censok270
s_sleep 8
s_sub_u32 s18, s18, 1
s_cbranch_scc0 reca_cens269
s_mov_b32 s18, 0
reca_censok270:
v_and_b32 v28, 0x20202020, v28
v_and_b32 v29, 0x20202020, v29
v_cmp_ne_u32 s[34:35], 0, v28
v_cmp_ne_u32 s[36:37], 0, v29
s_nop 3
s_and_b32 s34, s34, 0xff
s_and_b32 s36, s36, 0xff
s_or_b32 s35, s34, s36
s_lshr_b32 s37, s35, s13
s_and_b32 s37, s37, 1
s_xor_b32 s43, s37, 1
s_cmp_eq_u32 s57, 0
s_cselect_b32 s58, s36, s34
v_mov_b32 v31, 0x80000000
s_cmp_lg_u32 s43, 0
s_cbranch_scc1 reca_pslow271
reca_ptop272:
s_cmp_lt_u32 s17, 3
s_cbranch_scc1 reca_pgo273
s_sub_u32 s36, s17, 3
reca_ppoll274:
buffer_load_dword v28, v4, s[4:7], s25 offen sc1
s_waitcnt vmcnt(0)
v_readfirstlane_b32 s34, v28
s_nop 3
s_cmp_ge_i32 s34, s36
s_cbranch_scc1 reca_pgo273
s_sleep 8
s_sub_u32 s18, s18, 1
s_cbranch_scc0 reca_ppoll274
s_mov_b32 s18, 0
reca_pgo273:
s_waitcnt vmcnt(0)
s_barrier
v_add_u32 v7, s26, v1
s_xor_b32 s26, s26, 40960
s_add_u32 s37, s17, 1
s_cmp_ge_u32 s37, 64
s_cbranch_scc1 reca_pnodma275
s_mul_i32 s20, s37, 40960
s_add_u32 s20, s20, 84965376
s_add_u32 m0, s26, 30720
s_nop 0
buffer_load_dwordx4 v1, s[4:7], s20 offen offset:0 lds
buffer_load_dwordx4 v1, s[4:7], s20 offen offset:1024 lds
buffer_load_dwordx4 v1, s[4:7], s20 offen offset:2048 lds
buffer_load_dwordx4 v1, s[4:7], s20 offen offset:3072 lds
s_add_u32 s20, s20, 4096
s_add_u32 m0, s26, 34816
s_nop 0
buffer_load_dwordx4 v1, s[4:7], s20 offen offset:0 lds
buffer_load_dwordx4 v1, s[4:7], s20 offen offset:1024 lds
buffer_load_dwordx4 v1, s[4:7], s20 offen offset:2048 lds
buffer_load_dwordx4 v1, s[4:7], s20 offen offset:3072 lds
s_add_u32 s20, s20, 4096
s_add_u32 m0, s26, 38912
s_nop 0
buffer_load_dwordx4 v1, s[4:7], s20 offen offset:0 lds
buffer_load_dwordx4 v1, s[4:7], s20 offen offset:1024 lds
reca_pnodma275:
s_lshl_b32 s34, s15, 3
s_and_b32 s35, s17, 7
s_add_u32 s34, s34, s35
s_mul_i32 s34, s34, 12288
s_mul_i32 s35, s16, 3072
s_add_u32 s35, s35, s34
s_add_u32 s21, s35, 37748736
s_add_u32 s22, s35, 44040192
s_mul_i32 s35, s16, 6144
s_add_u32 s35, s35, s34
s_add_u32 s23, s35, 40894464
ds_read_b128 v[72:75], v7 offset:0
ds_read_b128 v[76:79], v7 offset:20480
ds_read_b128 v[80:83], v7 offset:1024
ds_read_b128 v[84:87], v7 offset:21504
ds_read_b128 v[88:91], v7 offset:2048
ds_read_b128 v[92:95], v7 offset:22528
s_waitcnt lgkmcnt(4)
v_mfma_f32_16x16x32_bf16 v[32:35], a[0:3], v[72:75], 0
v_mfma_f32_16x16x32_bf16 v[36:39], a[0:3], v[76:79], 0
v_mfma_f32_16x16x32_bf16 v[40:43], a[80:83], v[72:75], 0
v_mfma_f32_16x16x32_bf16 v[44:47], a[80:83], v[76:79], 0
v_mfma_f32_16x16x32_bf16 v[48:51], a[160:163], v[72:75], 0
v_mfma_f32_16x16x32_bf16 v[52:55], a[160:163], v[76:79], 0
v_mfma_f32_16x16x32_bf16 v[56:59], v[96:99], v[72:75], 0
v_mfma_f32_16x16x32_bf16 v[60:63], v[96:99], v[76:79], 0
ds_read_b128 v[72:75], v7 offset:3072
ds_read_b128 v[76:79], v7 offset:23552
s_waitcnt lgkmcnt(4)
v_mfma_f32_16x16x32_bf16 v[32:35], a[4:7], v[80:83], v[32:35]
v_mfma_f32_16x16x32_bf16 v[36:39], a[4:7], v[84:87], v[36:39]
v_mfma_f32_16x16x32_bf16 v[40:43], a[84:87], v[80:83], v[40:43]
v_mfma_f32_16x16x32_bf16 v[44:47], a[84:87], v[84:87], v[44:47]
v_mfma_f32_16x16x32_bf16 v[48:51], a[164:167], v[80:83], v[48:51]
v_mfma_f32_16x16x32_bf16 v[52:55], a[164:167], v[84:87], v[52:55]
v_mfma_f32_16x16x32_bf16 v[56:59], v[100:103], v[80:83], v[56:59]
v_mfma_f32_16x16x32_bf16 v[60:63], v[100:103], v[84:87], v[60:63]
ds_read_b128 v[80:83], v7 offset:4096
ds_read_b128 v[84:87], v7 offset:24576
s_waitcnt lgkmcnt(4)
v_mfma_f32_16x16x32_bf16 v[32:35], a[8:11], v[88:91], v[32:35]
v_mfma_f32_16x16x32_bf16 v[36:39], a[8:11], v[92:95], v[36:39]
v_mfma_f32_16x16x32_bf16 v[40:43], a[88:91], v[88:91], v[40:43]
v_mfma_f32_16x16x32_bf16 v[44:47], a[88:91], v[92:95], v[44:47]
v_mfma_f32_16x16x32_bf16 v[48:51], a[168:171], v[88:91], v[48:51]
v_mfma_f32_16x16x32_bf16 v[52:55], a[168:171], v[92:95], v[52:55]
v_mfma_f32_16x16x32_bf16 v[56:59], v[104:107], v[88:91], v[56:59]
v_mfma_f32_16x16x32_bf16 v[60:63], v[104:107], v[92:95], v[60:63]
ds_read_b128 v[88:91], v7 offset:5120
ds_read_b128 v[92:95], v7 offset:25600
s_waitcnt lgkmcnt(4)
v_mfma_f32_16x16x32_bf16 v[32:35], a[12:15], v[72:75], v[32:35]
v_mfma_f32_16x16x32_bf16 v[36:39], a[12:15], v[76:79], v[36:39]
v_mfma_f32_16x16x32_bf16 v[40:43], a[92:95], v[72:75], v[40:43]
v_mfma_f32_16x16x32_bf16 v[44:47], a[92:95], v[76:79], v[44:47]
v_mfma_f32_16x16x32_bf16 v[48:51], a[172:175], v[72:75], v[48:51]
v_mfma_f32_16x16x32_bf16 v[52:55], a[172:175], v[76:79], v[52:55]
v_mfma_f32_16x16x32_bf16 v[56:59], v[108:111], v[72:75], v[56:59]
v_mfma_f32_16x16x32_bf16 v[60:63], v[108:111], v[76:79], v[60:63]
ds_read_b128 v[72:75], v7 offset:6144
ds_read_b128 v[76:79], v7 offset:26624
s_waitcnt lgkmcnt(4)
v_mfma_f32_16x16x32_bf16 v[32:35], a[16:19], v[80:83], v[32:35]
v_mfma_f32_16x16x32_bf16 v[36:39], a[16:19], v[84:87], v[36:39]
v_mfma_f32_16x16x32_bf16 v[40:43], a[96:99], v[80:83], v[40:43]
v_mfma_f32_16x16x32_bf16 v[44:47], a[96:99], v[84:87], v[44:47]
v_mfma_f32_16x16x32_bf16 v[48:51], a[176:179], v[80:83], v[48:51]
v_mfma_f32_16x16x32_bf16 v[52:55], a[176:179], v[84:87], v[52:55]
v_mfma_f32_16x16x32_bf16 v[56:59], v[112:115], v[80:83], v[56:59]
v_mfma_f32_16x16x32_bf16 v[60:63], v[112:115], v[84:87], v[60:63]
ds_read_b128 v[80:83], v7 offset:7168
ds_read_b128 v[84:87], v7 offset:27648
s_waitcnt lgkmcnt(4)
v_mfma_f32_16x16x32_bf16 v[32:35], a[20:23], v[88:91], v[32:35]
v_mfma_f32_16x16x32_bf16 v[36:39], a[20:23], v[92:95], v[36:39]
v_mfma_f32_16x16x32_bf16 v[40:43], a[100:103], v[88:91], v[40:43]
v_mfma_f32_16x16x32_bf16 v[44:47], a[100:103], v[92:95], v[44:47]
v_mfma_f32_16x16x32_bf16 v[48:51], a[180:183], v[88:91], v[48:51]
v_mfma_f32_16x16x32_bf16 v[52:55], a[180:183], v[92:95], v[52:55]
v_mfma_f32_16x16x32_bf16 v[56:59], v[116:119], v[88:91], v[56:59]
v_mfma_f32_16x16x32_bf16 v[60:63], v[116:119], v[92:95], v[60:63]
ds_read_b128 v[88:91], v7 offset:8192
ds_read_b128 v[92:95], v7 offset:28672
s_waitcnt lgkmcnt(4)
v_mfma_f32_16x16x32_bf16 v[32:35], a[24:27], v[72:75], v[32:35]
v_mfma_f32_16x16x32_bf16 v[36:39], a[24:27], v[76:79], v[36:39]
v_mfma_f32_16x16x32_bf16 v[40:43], a[104:107], v[72:75], v[40:43]
v_mfma_f32_16x16x32_bf16 v[44:47], a[104:107], v[76:79], v[44:47]
v_mfma_f32_16x16x32_bf16 v[48:51], a[184:187], v[72:75], v[48:51]
v_mfma_f32_16x16x32_bf16 v[52:55], a[184:187], v[76:79], v[52:55]
v_mfma_f32_16x16x32_bf16 v[56:59], v[120:123], v[72:75], v[56:59]
v_mfma_f32_16x16x32_bf16 v[60:63], v[120:123], v[76:79], v[60:63]
ds_read_b128 v[72:75], v7 offset:9216
ds_read_b128 v[76:79], v7 offset:29696
s_waitcnt lgkmcnt(4)
v_mfma_f32_16x16x32_bf16 v[32:35], a[28:31], v[80:83], v[32:35]
v_mfma_f32_16x16x32_bf16 v[36:39], a[28:31], v[84:87], v[36:39]
v_mfma_f32_16x16x32_bf16 v[40:43], a[108:111], v[80:83], v[40:43]
v_mfma_f32_16x16x32_bf16 v[44:47], a[108:111], v[84:87], v[44:47]
v_mfma_f32_16x16x32_bf16 v[48:51], a[188:191], v[80:83], v[48:51]
v_mfma_f32_16x16x32_bf16 v[52:55], a[188:191], v[84:87], v[52:55]
v_mfma_f32_16x16x32_bf16 v[56:59], v[124:127], v[80:83], v[56:59]
v_mfma_f32_16x16x32_bf16 v[60:63], v[124:127], v[84:87], v[60:63]
ds_read_b128 v[80:83], v7 offset:10240
ds_read_b128 v[84:87], v7 offset:30720
s_waitcnt lgkmcnt(4)
v_mfma_f32_16x16x32_bf16 v[32:35], a[32:35], v[88:91], v[32:35]
v_mfma_f32_16x16x32_bf16 v[36:39], a[32:35], v[92:95], v[36:39]
v_mfma_f32_16x16x32_bf16 v[40:43], a[112:115], v[88:91], v[40:43]
v_mfma_f32_16x16x32_bf16 v[44:47], a[112:115], v[92:95], v[44:47]
v_mfma_f32_16x16x32_bf16 v[48:51], a[192:195], v[88:91], v[48:51]
v_mfma_f32_16x16x32_bf16 v[52:55], a[192:195], v[92:95], v[52:55]
v_mfma_f32_16x16x32_bf16 v[56:59], v[128:131], v[88:91], v[56:59]
v_mfma_f32_16x16x32_bf16 v[60:63], v[128:131], v[92:95], v[60:63]
ds_read_b128 v[88:91], v7 offset:11264
ds_read_b128 v[92:95], v7 offset:31744
s_waitcnt lgkmcnt(4)
v_mfma_f32_16x16x32_bf16 v[32:35], a[36:39], v[72:75], v[32:35]
v_mfma_f32_16x16x32_bf16 v[36:39], a[36:39], v[76:79], v[36:39]
v_mfma_f32_16x16x32_bf16 v[40:43], a[116:119], v[72:75], v[40:43]
v_mfma_f32_16x16x32_bf16 v[44:47], a[116:119], v[76:79], v[44:47]
v_mfma_f32_16x16x32_bf16 v[48:51], a[196:199], v[72:75], v[48:51]
v_mfma_f32_16x16x32_bf16 v[52:55], a[196:199], v[76:79], v[52:55]
v_mfma_f32_16x16x32_bf16 v[56:59], v[132:135], v[72:75], v[56:59]
v_mfma_f32_16x16x32_bf16 v[60:63], v[132:135], v[76:79], v[60:63]
ds_read_b128 v[72:75], v7 offset:12288
ds_read_b128 v[76:79], v7 offset:32768
s_waitcnt lgkmcnt(4)
v_mfma_f32_16x16x32_bf16 v[32:35], a[40:43], v[80:83], v[32:35]
v_mfma_f32_16x16x32_bf16 v[36:39], a[40:43], v[84:87], v[36:39]
v_mfma_f32_16x16x32_bf16 v[40:43], a[120:123], v[80:83], v[40:43]
v_mfma_f32_16x16x32_bf16 v[44:47], a[120:123], v[84:87], v[44:47]
v_mfma_f32_16x16x32_bf16 v[48:51], a[200:203], v[80:83], v[48:51]
v_mfma_f32_16x16x32_bf16 v[52:55], a[200:203], v[84:87], v[52:55]
v_mfma_f32_16x16x32_bf16 v[56:59], v[136:139], v[80:83], v[56:59]
v_mfma_f32_16x16x32_bf16 v[60:63], v[136:139], v[84:87], v[60:63]
ds_read_b128 v[80:83], v7 offset:13312
ds_read_b128 v[84:87], v7 offset:33792
s_waitcnt lgkmcnt(4)
v_mfma_f32_16x16x32_bf16 v[32:35], a[44:47], v[88:91], v[32:35]
v_mfma_f32_16x16x32_bf16 v[36:39], a[44:47], v[92:95], v[36:39]
v_mfma_f32_16x16x32_bf16 v[40:43], a[124:127], v[88:91], v[40:43]
v_mfma_f32_16x16x32_bf16 v[44:47], a[124:127], v[92:95], v[44:47]
v_mfma_f32_16x16x32_bf16 v[48:51], a[204:207], v[88:91], v[48:51]
v_mfma_f32_16x16x32_bf16 v[52:55], a[204:207], v[92:95], v[52:55]
v_mfma_f32_16x16x32_bf16 v[56:59], v[140:143], v[88:91], v[56:59]
v_mfma_f32_16x16x32_bf16 v[60:63], v[140:143], v[92:95], v[60:63]
ds_read_b128 v[88:91], v7 offset:14336
ds_read_b128 v[92:95], v7 offset:34816
s_waitcnt lgkmcnt(4)
v_mfma_f32_16x16x32_bf16 v[32:35], a[48:51], v[72:75], v[32:35]
v_mfma_f32_16x16x32_bf16 v[36:39], a[48:51], v[76:79], v[36:39]
v_mfma_f32_16x16x32_bf16 v[40:43], a[128:131], v[72:75], v[40:43]
v_mfma_f32_16x16x32_bf16 v[44:47], a[128:131], v[76:79], v[44:47]
v_mfma_f32_16x16x32_bf16 v[48:51], a[208:211], v[72:75], v[48:51]
v_mfma_f32_16x16x32_bf16 v[52:55], a[208:211], v[76:79], v[52:55]
v_mfma_f32_16x16x32_bf16 v[56:59], v[144:147], v[72:75], v[56:59]
v_mfma_f32_16x16x32_bf16 v[60:63], v[144:147], v[76:79], v[60:63]
ds_read_b128 v[72:75], v7 offset:15360
ds_read_b128 v[76:79], v7 offset:35840
s_waitcnt lgkmcnt(4)
v_mfma_f32_16x16x32_bf16 v[32:35], a[52:55], v[80:83], v[32:35]
v_mfma_f32_16x16x32_bf16 v[36:39], a[52:55], v[84:87], v[36:39]
v_mfma_f32_16x16x32_bf16 v[40:43], a[132:135], v[80:83], v[40:43]
v_mfma_f32_16x16x32_bf16 v[44:47], a[132:135], v[84:87], v[44:47]
v_mfma_f32_16x16x32_bf16 v[48:51], a[212:215], v[80:83], v[48:51]
v_mfma_f32_16x16x32_bf16 v[52:55], a[212:215], v[84:87], v[52:55]
v_mfma_f32_16x16x32_bf16 v[56:59], v[148:151], v[80:83], v[56:59]
v_mfma_f32_16x16x32_bf16 v[60:63], v[148:151], v[84:87], v[60:63]
ds_read_b128 v[80:83], v7 offset:16384
ds_read_b128 v[84:87], v7 offset:36864
s_waitcnt lgkmcnt(4)
v_mfma_f32_16x16x32_bf16 v[32:35], a[56:59], v[88:91], v[32:35]
v_mfma_f32_16x16x32_bf16 v[36:39], a[56:59], v[92:95], v[36:39]
v_mfma_f32_16x16x32_bf16 v[40:43], a[136:139], v[88:91], v[40:43]
v_mfma_f32_16x16x32_bf16 v[44:47], a[136:139], v[92:95], v[44:47]
v_mfma_f32_16x16x32_bf16 v[48:51], a[216:219], v[88:91], v[48:51]
v_mfma_f32_16x16x32_bf16 v[52:55], a[216:219], v[92:95], v[52:55]
v_mfma_f32_16x16x32_bf16 v[56:59], v[152:155], v[88:91], v[56:59]
v_mfma_f32_16x16x32_bf16 v[60:63], v[152:155], v[92:95], v[60:63]
ds_read_b128 v[88:91], v7 offset:17408
ds_read_b128 v[92:95], v7 offset:37888
s_waitcnt lgkmcnt(4)
v_mfma_f32_16x16x32_bf16 v[32:35], a[60:63], v[72:75], v[32:35]
v_mfma_f32_16x16x32_bf16 v[36:39], a[60:63], v[76:79], v[36:39]
v_mfma_f32_16x16x32_bf16 v[40:43], a[140:143], v[72:75], v[40:43]
v_mfma_f32_16x16x32_bf16 v[44:47], a[140:143], v[76:79], v[44:47]
v_mfma_f32_16x16x32_bf16 v[48:51], a[220:223], v[72:75], v[48:51]
v_mfma_f32_16x16x32_bf16 v[52:55], a[220:223], v[76:79], v[52:55]
v_mfma_f32_16x16x32_bf16 v[56:59], v[156:159], v[72:75], v[56:59]
v_mfma_f32_16x16x32_bf16 v[60:63], v[156:159], v[76:79], v[60:63]
ds_read_b128 v[72:75], v7 offset:18432
ds_read_b128 v[76:79], v7 offset:38912
s_waitcnt lgkmcnt(4)
v_mfma_f32_16x16x32_bf16 v[32:35], a[64:67], v[80:83], v[32:35]
v_mfma_f32_16x16x32_bf16 v[36:39], a[64:67], v[84:87], v[36:39]
v_mfma_f32_16x16x32_bf16 v[40:43], a[144:147], v[80:83], v[40:43]
v_mfma_f32_16x16x32_bf16 v[44:47], a[144:147], v[84:87], v[44:47]
v_mfma_f32_16x16x32_bf16 v[48:51], a[224:227], v[80:83], v[48:51]
v_mfma_f32_16x16x32_bf16 v[52:55], a[224:227], v[84:87], v[52:55]
v_mfma_f32_16x16x32_bf16 v[56:59], v[160:163], v[80:83], v[56:59]
v_mfma_f32_16x16x32_bf16 v[60:63], v[160:163], v[84:87], v[60:63]
ds_read_b128 v[80:83], v7 offset:19456
ds_read_b128 v[84:87], v7 offset:39936
s_waitcnt lgkmcnt(4)
v_mfma_f32_16x16x32_bf16 v[32:35], a[68:71], v[88:91], v[32:35]
v_mfma_f32_16x16x32_bf16 v[36:39], a[68:71], v[92:95], v[36:39]
v_mfma_f32_16x16x32_bf16 v[40:43], a[148:151], v[88:91], v[40:43]
v_mfma_f32_16x16x32_bf16 v[44:47], a[148:151], v[92:95], v[44:47]
v_mfma_f32_16x16x32_bf16 v[48:51], a[228:231], v[88:91], v[48:51]
v_mfma_f32_16x16x32_bf16 v[52:55], a[228:231], v[92:95], v[52:55]
v_mfma_f32_16x16x32_bf16 v[56:59], v[164:167], v[88:91], v[56:59]
v_mfma_f32_16x16x32_bf16 v[60:63], v[164:167], v[92:95], v[60:63]
s_waitcnt lgkmcnt(2)
v_mfma_f32_16x16x32_bf16 v[32:35], a[72:75], v[72:75], v[32:35]
v_mfma_f32_16x16x32_bf16 v[36:39], a[72:75], v[76:79], v[36:39]
v_mfma_f32_16x16x32_bf16 v[40:43], a[152:155], v[72:75], v[40:43]
v_mfma_f32_16x16x32_bf16 v[44:47], a[152:155], v[76:79], v[44:47]
v_mfma_f32_16x16x32_bf16 v[48:51], a[232:235], v[72:75], v[48:51]
v_mfma_f32_16x16x32_bf16 v[52:55], a[232:235], v[76:79], v[52:55]
v_mfma_f32_16x16x32_bf16 v[56:59], v[168:171], v[72:75], v[56:59]
v_mfma_f32_16x16x32_bf16 v[60:63], v[168:171], v[76:79], v[60:63]
s_waitcnt lgkmcnt(0)
v_mfma_f32_16x16x32_bf16 v[32:35], a[76:79], v[80:83], v[32:35]
v_mfma_f32_16x16x32_bf16 v[36:39], a[76:79], v[84:87], v[36:39]
v_mfma_f32_16x16x32_bf16 v[40:43], a[156:159], v[80:83], v[40:43]
v_mfma_f32_16x16x32_bf16 v[44:47], a[156:159], v[84:87], v[44:47]
v_mfma_f32_16x16x32_bf16 v[48:51], a[236:239], v[80:83], v[48:51]
v_mfma_f32_16x16x32_bf16 v[52:55], a[236:239], v[84:87], v[52:55]
v_mfma_f32_16x16x32_bf16 v[56:59], v[172:175], v[80:83], v[56:59]
v_mfma_f32_16x16x32_bf16 v[60:63], v[172:175], v[84:87], v[60:63]
s_nop 0
v_cvt_pk_bf16_f32 v8, v32, v33
v_cvt_pk_bf16_f32 v9, v34, v35
v_cvt_pk_bf16_f32 v10, v40, v41
v_cvt_pk_bf16_f32 v11, v42, v43
s_add_u32 s34, s22, 1024
buffer_store_dwordx4 v[8:11], v1, s[4:7], s34 offen
v_cvt_pk_bf16_f32 v12, v36, v37
v_cvt_pk_bf16_f32 v13, v38, v39
v_cvt_pk_bf16_f32 v14, v44, v45
v_cvt_pk_bf16_f32 v15, v46, v47
s_add_u32 s34, s22, 7168
buffer_store_dwordx4 v[12:15], v1, s[4:7], s34 offen
v_cvt_pk_bf16_f32 v8, v48, v49
v_cvt_pk_bf16_f32 v9, v50, v51
v_cvt_pk_bf16_f32 v10, v56, v57
v_cvt_pk_bf16_f32 v11, v58, v59
s_add_u32 s34, s22, 2048
buffer_store_dwordx4 v[8:11], v1, s[4:7], s34 offen
v_cvt_pk_bf16_f32 v12, v52, v53
v_cvt_pk_bf16_f32 v13, v54, v55
v_cvt_pk_bf16_f32 v14, v60, v61
v_cvt_pk_bf16_f32 v15, v62, v63
s_add_u32 s34, s22, 8192
buffer_store_dwordx4 v[12:15], v1, s[4:7], s34 offen
s_waitcnt vmcnt(0)
s_barrier
s_add_u32 s17, s17, 1
s_cmp_lt_u32 s17, 64
s_cbranch_scc1 reca_ptop272
s_branch reca_exit1
reca_pslow271:
reca_ptop277:
s_cmp_lt_u32 s17, 3
s_cbranch_scc1 reca_pgo278
s_sub_u32 s36, s17, 3
reca_ppoll279:
buffer_load_dword v28, v4, s[4:7], s25 offen sc1
s_waitcnt vmcnt(0)
v_readfirstlane_b32 s34, v28
s_nop 3
s_cmp_ge_i32 s34, s36
s_cbranch_scc1 reca_pgo278
s_sleep 8
s_sub_u32 s18, s18, 1
s_cbranch_scc0 reca_ppoll279
s_mov_b32 s18, 0
reca_pgo278:
s_waitcnt vmcnt(0)
s_barrier
v_add_u32 v7, s26, v1
s_xor_b32 s26, s26, 40960
s_add_u32 s37, s17, 1
s_cmp_ge_u32 s37, 64
s_cbranch_scc1 reca_pnodma280
s_mul_i32 s20, s37, 40960
s_add_u32 s20, s20, 84965376
s_add_u32 m0, s26, 30720
s_nop 0
buffer_load_dwordx4 v1, s[4:7], s20 offen offset:0 lds
buffer_load_dwordx4 v1, s[4:7], s20 offen offset:1024 lds
buffer_load_dwordx4 v1, s[4:7], s20 offen offset:2048 lds
buffer_load_dwordx4 v1, s[4:7], s20 offen offset:3072 lds
s_add_u32 s20, s20, 4096
s_add_u32 m0, s26, 34816
s_nop 0
buffer_load_dwordx4 v1, s[4:7], s20 offen offset:0 lds
buffer_load_dwordx4 v1, s[4:7], s20 offen offset:1024 lds
buffer_load_dwordx4 v1, s[4:7], s20 offen offset:2048 lds
buffer_load_dwordx4 v1, s[4:7], s20 offen offset:3072 lds
s_add_u32 s20, s20, 4096
s_add_u32 m0, s26, 38912
s_nop 0
buffer_load_dwordx4 v1, s[4:7], s20 offen offset:0 lds
buffer_load_dwordx4 v1, s[4:7], s20 offen offset:1024 lds
reca_pnodma280:
s_lshl_b32 s34, s15, 3
s_and_b32 s35, s17, 7
s_add_u32 s34, s34, s35
s_mul_i32 s34, s34, 12288
s_mul_i32 s35, s16, 3072
s_add_u32 s35, s35, s34
s_add_u32 s21, s35, 37748736
s_add_u32 s22, s35, 44040192
s_mul_i32 s35, s16, 6144
s_add_u32 s35, s35, s34
s_add_u32 s23, s35, 40894464
ds_read_b128 v[72:75], v7 offset:0
ds_read_b128 v[76:79], v7 offset:20480
ds_read_b128 v[80:83], v7 offset:1024
ds_read_b128 v[84:87], v7 offset:21504
ds_read_b128 v[88:91], v7 offset:2048
ds_read_b128 v[92:95], v7 offset:22528
s_waitcnt lgkmcnt(4)
v_mfma_f32_16x16x32_bf16 v[32:35], a[0:3], v[72:75], 0
v_mfma_f32_16x16x32_bf16 v[36:39], a[0:3], v[76:79], 0
v_mfma_f32_16x16x32_bf16 v[40:43], a[80:83], v[72:75], 0
v_mfma_f32_16x16x32_bf16 v[44:47], a[80:83], v[76:79], 0
v_mfma_f32_16x16x32_bf16 v[48:51], a[160:163], v[72:75], 0
v_mfma_f32_16x16x32_bf16 v[52:55], a[160:163], v[76:79], 0
v_mfma_f32_16x16x32_bf16 v[56:59], v[96:99], v[72:75], 0
v_mfma_f32_16x16x32_bf16 v[60:63], v[96:99], v[76:79], 0
ds_read_b128 v[72:75], v7 offset:3072
ds_read_b128 v[76:79], v7 offset:23552
s_waitcnt lgkmcnt(4)
v_mfma_f32_16x16x32_bf16 v[32:35], a[4:7], v[80:83], v[32:35]
v_mfma_f32_16x16x32_bf16 v[36:39], a[4:7], v[84:87], v[36:39]
v_mfma_f32_16x16x32_bf16 v[40:43], a[84:87], v[80:83], v[40:43]
v_mfma_f32_16x16x32_bf16 v[44:47], a[84:87], v[84:87], v[44:47]
v_mfma_f32_16x16x32_bf16 v[48:51], a[164:167], v[80:83], v[48:51]
v_mfma_f32_16x16x32_bf16 v[52:55], a[164:167], v[84:87], v[52:55]
v_mfma_f32_16x16x32_bf16 v[56:59], v[100:103], v[80:83], v[56:59]
v_mfma_f32_16x16x32_bf16 v[60:63], v[100:103], v[84:87], v[60:63]
ds_read_b128 v[80:83], v7 offset:4096
ds_read_b128 v[84:87], v7 offset:24576
s_waitcnt lgkmcnt(4)
v_mfma_f32_16x16x32_bf16 v[32:35], a[8:11], v[88:91], v[32:35]
v_mfma_f32_16x16x32_bf16 v[36:39], a[8:11], v[92:95], v[36:39]
v_mfma_f32_16x16x32_bf16 v[40:43], a[88:91], v[88:91], v[40:43]
v_mfma_f32_16x16x32_bf16 v[44:47], a[88:91], v[92:95], v[44:47]
v_mfma_f32_16x16x32_bf16 v[48:51], a[168:171], v[88:91], v[48:51]
v_mfma_f32_16x16x32_bf16 v[52:55], a[168:171], v[92:95], v[52:55]
v_mfma_f32_16x16x32_bf16 v[56:59], v[104:107], v[88:91], v[56:59]
v_mfma_f32_16x16x32_bf16 v[60:63], v[104:107], v[92:95], v[60:63]
ds_read_b128 v[88:91], v7 offset:5120
ds_read_b128 v[92:95], v7 offset:25600
s_waitcnt lgkmcnt(4)
v_mfma_f32_16x16x32_bf16 v[32:35], a[12:15], v[72:75], v[32:35]
v_mfma_f32_16x16x32_bf16 v[36:39], a[12:15], v[76:79], v[36:39]
v_mfma_f32_16x16x32_bf16 v[40:43], a[92:95], v[72:75], v[40:43]
v_mfma_f32_16x16x32_bf16 v[44:47], a[92:95], v[76:79], v[44:47]
v_mfma_f32_16x16x32_bf16 v[48:51], a[172:175], v[72:75], v[48:51]
v_mfma_f32_16x16x32_bf16 v[52:55], a[172:175], v[76:79], v[52:55]
v_mfma_f32_16x16x32_bf16 v[56:59], v[108:111], v[72:75], v[56:59]
v_mfma_f32_16x16x32_bf16 v[60:63], v[108:111], v[76:79], v[60:63]
ds_read_b128 v[72:75], v7 offset:6144
ds_read_b128 v[76:79], v7 offset:26624
s_waitcnt lgkmcnt(4)
v_mfma_f32_16x16x32_bf16 v[32:35], a[16:19], v[80:83], v[32:35]
v_mfma_f32_16x16x32_bf16 v[36:39], a[16:19], v[84:87], v[36:39]
v_mfma_f32_16x16x32_bf16 v[40:43], a[96:99], v[80:83], v[40:43]
v_mfma_f32_16x16x32_bf16 v[44:47], a[96:99], v[84:87], v[44:47]
v_mfma_f32_16x16x32_bf16 v[48:51], a[176:179], v[80:83], v[48:51]
v_mfma_f32_16x16x32_bf16 v[52:55], a[176:179], v[84:87], v[52:55]
v_mfma_f32_16x16x32_bf16 v[56:59], v[112:115], v[80:83], v[56:59]
v_mfma_f32_16x16x32_bf16 v[60:63], v[112:115], v[84:87], v[60:63]
ds_read_b128 v[80:83], v7 offset:7168
ds_read_b128 v[84:87], v7 offset:27648
s_waitcnt lgkmcnt(4)
v_mfma_f32_16x16x32_bf16 v[32:35], a[20:23], v[88:91], v[32:35]
v_mfma_f32_16x16x32_bf16 v[36:39], a[20:23], v[92:95], v[36:39]
v_mfma_f32_16x16x32_bf16 v[40:43], a[100:103], v[88:91], v[40:43]
v_mfma_f32_16x16x32_bf16 v[44:47], a[100:103], v[92:95], v[44:47]
v_mfma_f32_16x16x32_bf16 v[48:51], a[180:183], v[88:91], v[48:51]
v_mfma_f32_16x16x32_bf16 v[52:55], a[180:183], v[92:95], v[52:55]
v_mfma_f32_16x16x32_bf16 v[56:59], v[116:119], v[88:91], v[56:59]
v_mfma_f32_16x16x32_bf16 v[60:63], v[116:119], v[92:95], v[60:63]
ds_read_b128 v[88:91], v7 offset:8192
ds_read_b128 v[92:95], v7 offset:28672
s_waitcnt lgkmcnt(4)
v_mfma_f32_16x16x32_bf16 v[32:35], a[24:27], v[72:75], v[32:35]
v_mfma_f32_16x16x32_bf16 v[36:39], a[24:27], v[76:79], v[36:39]
v_mfma_f32_16x16x32_bf16 v[40:43], a[104:107], v[72:75], v[40:43]
v_mfma_f32_16x16x32_bf16 v[44:47], a[104:107], v[76:79], v[44:47]
v_mfma_f32_16x16x32_bf16 v[48:51], a[184:187], v[72:75], v[48:51]
v_mfma_f32_16x16x32_bf16 v[52:55], a[184:187], v[76:79], v[52:55]
v_mfma_f32_16x16x32_bf16 v[56:59], v[120:123], v[72:75], v[56:59]
v_mfma_f32_16x16x32_bf16 v[60:63], v[120:123], v[76:79], v[60:63]
ds_read_b128 v[72:75], v7 offset:9216
ds_read_b128 v[76:79], v7 offset:29696
s_waitcnt lgkmcnt(4)
v_mfma_f32_16x16x32_bf16 v[32:35], a[28:31], v[80:83], v[32:35]
v_mfma_f32_16x16x32_bf16 v[36:39], a[28:31], v[84:87], v[36:39]
v_mfma_f32_16x16x32_bf16 v[40:43], a[108:111], v[80:83], v[40:43]
v_mfma_f32_16x16x32_bf16 v[44:47], a[108:111], v[84:87], v[44:47]
v_mfma_f32_16x16x32_bf16 v[48:51], a[188:191], v[80:83], v[48:51]
v_mfma_f32_16x16x32_bf16 v[52:55], a[188:191], v[84:87], v[52:55]
v_mfma_f32_16x16x32_bf16 v[56:59], v[124:127], v[80:83], v[56:59]
v_mfma_f32_16x16x32_bf16 v[60:63], v[124:127], v[84:87], v[60:63]
ds_read_b128 v[80:83], v7 offset:10240
ds_read_b128 v[84:87], v7 offset:30720
s_waitcnt lgkmcnt(4)
v_mfma_f32_16x16x32_bf16 v[32:35], a[32:35], v[88:91], v[32:35]
v_mfma_f32_16x16x32_bf16 v[36:39], a[32:35], v[92:95], v[36:39]
v_mfma_f32_16x16x32_bf16 v[40:43], a[112:115], v[88:91], v[40:43]
v_mfma_f32_16x16x32_bf16 v[44:47], a[112:115], v[92:95], v[44:47]
v_mfma_f32_16x16x32_bf16 v[48:51], a[192:195], v[88:91], v[48:51]
v_mfma_f32_16x16x32_bf16 v[52:55], a[192:195], v[92:95], v[52:55]
v_mfma_f32_16x16x32_bf16 v[56:59], v[128:131], v[88:91], v[56:59]
v_mfma_f32_16x16x32_bf16 v[60:63], v[128:131], v[92:95], v[60:63]
ds_read_b128 v[88:91], v7 offset:11264
ds_read_b128 v[92:95], v7 offset:31744
s_waitcnt lgkmcnt(4)
v_mfma_f32_16x16x32_bf16 v[32:35], a[36:39], v[72:75], v[32:35]
v_mfma_f32_16x16x32_bf16 v[36:39], a[36:39], v[76:79], v[36:39]
v_mfma_f32_16x16x32_bf16 v[40:43], a[116:119], v[72:75], v[40:43]
v_mfma_f32_16x16x32_bf16 v[44:47], a[116:119], v[76:79], v[44:47]
v_mfma_f32_16x16x32_bf16 v[48:51], a[196:199], v[72:75], v[48:51]
v_mfma_f32_16x16x32_bf16 v[52:55], a[196:199], v[76:79], v[52:55]
v_mfma_f32_16x16x32_bf16 v[56:59], v[132:135], v[72:75], v[56:59]
v_mfma_f32_16x16x32_bf16 v[60:63], v[132:135], v[76:79], v[60:63]
ds_read_b128 v[72:75], v7 offset:12288
ds_read_b128 v[76:79], v7 offset:32768
s_waitcnt lgkmcnt(4)
v_mfma_f32_16x16x32_bf16 v[32:35], a[40:43], v[80:83], v[32:35]
v_mfma_f32_16x16x32_bf16 v[36:39], a[40:43], v[84:87], v[36:39]
v_mfma_f32_16x16x32_bf16 v[40:43], a[120:123], v[80:83], v[40:43]
v_mfma_f32_16x16x32_bf16 v[44:47], a[120:123], v[84:87], v[44:47]
v_mfma_f32_16x16x32_bf16 v[48:51], a[200:203], v[80:83], v[48:51]
v_mfma_f32_16x16x32_bf16 v[52:55], a[200:203], v[84:87], v[52:55]
v_mfma_f32_16x16x32_bf16 v[56:59], v[136:139], v[80:83], v[56:59]
v_mfma_f32_16x16x32_bf16 v[60:63], v[136:139], v[84:87], v[60:63]
ds_read_b128 v[80:83], v7 offset:13312
ds_read_b128 v[84:87], v7 offset:33792
s_waitcnt lgkmcnt(4)
v_mfma_f32_16x16x32_bf16 v[32:35], a[44:47], v[88:91], v[32:35]
v_mfma_f32_16x16x32_bf16 v[36:39], a[44:47], v[92:95], v[36:39]
v_mfma_f32_16x16x32_bf16 v[40:43], a[124:127], v[88:91], v[40:43]
v_mfma_f32_16x16x32_bf16 v[44:47], a[124:127], v[92:95], v[44:47]
v_mfma_f32_16x16x32_bf16 v[48:51], a[204:207], v[88:91], v[48:51]
v_mfma_f32_16x16x32_bf16 v[52:55], a[204:207], v[92:95], v[52:55]
v_mfma_f32_16x16x32_bf16 v[56:59], v[140:143], v[88:91], v[56:59]
v_mfma_f32_16x16x32_bf16 v[60:63], v[140:143], v[92:95], v[60:63]
ds_read_b128 v[88:91], v7 offset:14336
ds_read_b128 v[92:95], v7 offset:34816
s_waitcnt lgkmcnt(4)
v_mfma_f32_16x16x32_bf16 v[32:35], a[48:51], v[72:75], v[32:35]
v_mfma_f32_16x16x32_bf16 v[36:39], a[48:51], v[76:79], v[36:39]
v_mfma_f32_16x16x32_bf16 v[40:43], a[128:131], v[72:75], v[40:43]
v_mfma_f32_16x16x32_bf16 v[44:47], a[128:131], v[76:79], v[44:47]
v_mfma_f32_16x16x32_bf16 v[48:51], a[208:211], v[72:75], v[48:51]
v_mfma_f32_16x16x32_bf16 v[52:55], a[208:211], v[76:79], v[52:55]
v_mfma_f32_16x16x32_bf16 v[56:59], v[144:147], v[72:75], v[56:59]
v_mfma_f32_16x16x32_bf16 v[60:63], v[144:147], v[76:79], v[60:63]
ds_read_b128 v[72:75], v7 offset:15360
ds_read_b128 v[76:79], v7 offset:35840
s_waitcnt lgkmcnt(4)
v_mfma_f32_16x16x32_bf16 v[32:35], a[52:55], v[80:83], v[32:35]
v_mfma_f32_16x16x32_bf16 v[36:39], a[52:55], v[84:87], v[36:39]
v_mfma_f32_16x16x32_bf16 v[40:43], a[132:135], v[80:83], v[40:43]
v_mfma_f32_16x16x32_bf16 v[44:47], a[132:135], v[84:87], v[44:47]
v_mfma_f32_16x16x32_bf16 v[48:51], a[212:215], v[80:83], v[48:51]
v_mfma_f32_16x16x32_bf16 v[52:55], a[212:215], v[84:87], v[52:55]
v_mfma_f32_16x16x32_bf16 v[56:59], v[148:151], v[80:83], v[56:59]
v_mfma_f32_16x16x32_bf16 v[60:63], v[148:151], v[84:87], v[60:63]
ds_read_b128 v[80:83], v7 offset:16384
ds_read_b128 v[84:87], v7 offset:36864
s_waitcnt lgkmcnt(4)
v_mfma_f32_16x16x32_bf16 v[32:35], a[56:59], v[88:91], v[32:35]
v_mfma_f32_16x16x32_bf16 v[36:39], a[56:59], v[92:95], v[36:39]
v_mfma_f32_16x16x32_bf16 v[40:43], a[136:139], v[88:91], v[40:43]
v_mfma_f32_16x16x32_bf16 v[44:47], a[136:139], v[92:95], v[44:47]
v_mfma_f32_16x16x32_bf16 v[48:51], a[216:219], v[88:91], v[48:51]
v_mfma_f32_16x16x32_bf16 v[52:55], a[216:219], v[92:95], v[52:55]
v_mfma_f32_16x16x32_bf16 v[56:59], v[152:155], v[88:91], v[56:59]
v_mfma_f32_16x16x32_bf16 v[60:63], v[152:155], v[92:95], v[60:63]
ds_read_b128 v[88:91], v7 offset:17408
ds_read_b128 v[92:95], v7 offset:37888
s_waitcnt lgkmcnt(4)
v_mfma_f32_16x16x32_bf16 v[32:35], a[60:63], v[72:75], v[32:35]
v_mfma_f32_16x16x32_bf16 v[36:39], a[60:63], v[76:79], v[36:39]
v_mfma_f32_16x16x32_bf16 v[40:43], a[140:143], v[72:75], v[40:43]
v_mfma_f32_16x16x32_bf16 v[44:47], a[140:143], v[76:79], v[44:47]
v_mfma_f32_16x16x32_bf16 v[48:51], a[220:223], v[72:75], v[48:51]
v_mfma_f32_16x16x32_bf16 v[52:55], a[220:223], v[76:79], v[52:55]
v_mfma_f32_16x16x32_bf16 v[56:59], v[156:159], v[72:75], v[56:59]
v_mfma_f32_16x16x32_bf16 v[60:63], v[156:159], v[76:79], v[60:63]
ds_read_b128 v[72:75], v7 offset:18432
ds_read_b128 v[76:79], v7 offset:38912
s_waitcnt lgkmcnt(4)
v_mfma_f32_16x16x32_bf16 v[32:35], a[64:67], v[80:83], v[32:35]
v_mfma_f32_16x16x32_bf16 v[36:39], a[64:67], v[84:87], v[36:39]
v_mfma_f32_16x16x32_bf16 v[40:43], a[144:147], v[80:83], v[40:43]
v_mfma_f32_16x16x32_bf16 v[44:47], a[144:147], v[84:87], v[44:47]
v_mfma_f32_16x16x32_bf16 v[48:51], a[224:227], v[80:83], v[48:51]
v_mfma_f32_16x16x32_bf16 v[52:55], a[224:227], v[84:87], v[52:55]
v_mfma_f32_16x16x32_bf16 v[56:59], v[160:163], v[80:83], v[56:59]
v_mfma_f32_16x16x32_bf16 v[60:63], v[160:163], v[84:87], v[60:63]
ds_read_b128 v[80:83], v7 offset:19456
ds_read_b128 v[84:87], v7 offset:39936
s_waitcnt lgkmcnt(4)
v_mfma_f32_16x16x32_bf16 v[32:35], a[68:71], v[88:91], v[32:35]
v_mfma_f32_16x16x32_bf16 v[36:39], a[68:71], v[92:95], v[36:39]
v_mfma_f32_16x16x32_bf16 v[40:43], a[148:151], v[88:91], v[40:43]
v_mfma_f32_16x16x32_bf16 v[44:47], a[148:151], v[92:95], v[44:47]
v_mfma_f32_16x16x32_bf16 v[48:51], a[228:231], v[88:91], v[48:51]
v_mfma_f32_16x16x32_bf16 v[52:55], a[228:231], v[92:95], v[52:55]
v_mfma_f32_16x16x32_bf16 v[56:59], v[164:167], v[88:91], v[56:59]
v_mfma_f32_16x16x32_bf16 v[60:63], v[164:167], v[92:95], v[60:63]
s_waitcnt lgkmcnt(2)
v_mfma_f32_16x16x32_bf16 v[32:35], a[72:75], v[72:75], v[32:35]
v_mfma_f32_16x16x32_bf16 v[36:39], a[72:75], v[76:79], v[36:39]
v_mfma_f32_16x16x32_bf16 v[40:43], a[152:155], v[72:75], v[40:43]
v_mfma_f32_16x16x32_bf16 v[44:47], a[152:155], v[76:79], v[44:47]
v_mfma_f32_16x16x32_bf16 v[48:51], a[232:235], v[72:75], v[48:51]
v_mfma_f32_16x16x32_bf16 v[52:55], a[232:235], v[76:79], v[52:55]
v_mfma_f32_16x16x32_bf16 v[56:59], v[168:171], v[72:75], v[56:59]
v_mfma_f32_16x16x32_bf16 v[60:63], v[168:171], v[76:79], v[60:63]
s_waitcnt lgkmcnt(0)
v_mfma_f32_16x16x32_bf16 v[32:35], a[76:79], v[80:83], v[32:35]
v_mfma_f32_16x16x32_bf16 v[36:39], a[76:79], v[84:87], v[36:39]
v_mfma_f32_16x16x32_bf16 v[40:43], a[156:159], v[80:83], v[40:43]
v_mfma_f32_16x16x32_bf16 v[44:47], a[156:159], v[84:87], v[44:47]
v_mfma_f32_16x16x32_bf16 v[48:51], a[236:239], v[80:83], v[48:51]
v_mfma_f32_16x16x32_bf16 v[52:55], a[236:239], v[84:87], v[52:55]
v_mfma_f32_16x16x32_bf16 v[56:59], v[172:175], v[80:83], v[56:59]
v_mfma_f32_16x16x32_bf16 v[60:63], v[172:175], v[84:87], v[60:63]
s_nop 0
v_cvt_pk_bf16_f32 v8, v32, v33
v_cvt_pk_bf16_f32 v9, v34, v35
v_cvt_pk_bf16_f32 v10, v40, v41
v_cvt_pk_bf16_f32 v11, v42, v43
s_add_u32 s34, s22, 1024
buffer_store_dwordx4 v[8:11], v1, s[4:7], s34 offen sc1
v_cvt_pk_bf16_f32 v12, v36, v37
v_cvt_pk_bf16_f32 v13, v38, v39
v_cvt_pk_bf16_f32 v14, v44, v45
v_cvt_pk_bf16_f32 v15, v46, v47
s_add_u32 s34, s22, 7168
buffer_store_dwordx4 v[12:15], v1, s[4:7], s34 offen sc1
v_cvt_pk_bf16_f32 v8, v48, v49
v_cvt_pk_bf16_f32 v9, v50, v51
v_cvt_pk_bf16_f32 v10, v56, v57
v_cvt_pk_bf16_f32 v11, v58, v59
s_add_u32 s34, s22, 2048
buffer_store_dwordx4 v[8:11], v1, s[4:7], s34 offen sc1
v_cvt_pk_bf16_f32 v12, v52, v53
v_cvt_pk_bf16_f32 v13, v54, v55
v_cvt_pk_bf16_f32 v14, v60, v61
v_cvt_pk_bf16_f32 v15, v62, v63
s_add_u32 s34, s22, 8192
buffer_store_dwordx4 v[12:15], v1, s[4:7], s34 offen sc1
s_waitcnt vmcnt(0)
s_barrier
s_add_u32 s17, s17, 1
s_cmp_lt_u32 s17, 64
s_cbranch_scc1 reca_ptop277
s_branch reca_exit1
reca_exit1:
reca_exitb3:
s_endpgm
.globl fin_kernel
.p2align 8
.type fin_kernel,@function
fin_kernel:
s_cmp_ge_u32 s2, 256
s_cbranch_scc1 fin_exit1
s_load_dwordx2 s[8:9], s[0:1], 96
v_lshrrev_b32 v6, 6, v0
v_and_b32 v7, 63, v0
s_and_b32 s13, s2, 7
v_readfirstlane_b32 s12, v6
v_lshlrev_b32 v1, 4, v7
v_add_u32 v2, 0x1000, v1
v_add_u32 v3, 0x2000, v1
s_lshr_b32 s14, s2, 3
s_lshl_b32 s15, s13, 2
s_add_u32 s15, s15, s12
s_waitcnt lgkmcnt(0)
s_mov_b32 s4, s8
s_mov_b32 s5, s9
s_mov_b32 s6, 0x10000000
s_mov_b32 s7, 0x20000
s_mov_b32 s27, 0x3dd53b95
v_and_b32 v6, 15, v7
v_lshrrev_b32 v8, 4, v7
v_mov_b32 v9, 0x80000000
v_lshlrev_b32 v10, 4, v6
v_lshl_add_u32 v10, v8, 7, v10
v_cmp_gt_u32 vcc, 8, v6
s_nop 1
v_cndmask_b32 v4, v9, v10, vcc
v_lshlrev_b32 v10, 3, v7
v_cmp_gt_u32 vcc, 32, v7
s_nop 1
v_cndmask_b32 v5, v9, v10, vcc
v_mov_b32 v10, 0xf149f2ca
v_cmp_le_u32 vcc, 2, v8
s_nop 1
v_cndmask_b32 v12, 0, v10, vcc
v_mov_b32 v13, v12
v_mov_b32 v14, v12
v_mov_b32 v15, v12
v_lshlrev_b32 v11, 2, v8
v_add_u32 v7, 0, v11
v_cmp_gt_u32 vcc, v7, v6
s_nop 1
v_cndmask_b32 v16, 0, v10, vcc
v_add_u32 v7, 1, v11
v_cmp_gt_u32 vcc, v7, v6
s_nop 1
v_cndmask_b32 v17, 0, v10, vcc
v_add_u32 v7, 2, v11
v_cmp_gt_u32 vcc, v7, v6
s_nop 1
v_cndmask_b32 v18, 0, v10, vcc
v_add_u32 v7, 3, v11
v_cmp_gt_u32 vcc, v7, v6
s_nop 1
v_cndmask_b32 v19, 0, v10, vcc
v_mov_b32 v20, 0x3f803f80
v_mov_b32 v21, 0x3f803f80
v_mov_b32 v22, 0x3f803f80
v_mov_b32 v23, 0x3f803f80
s_mul_i32 s16, s12, 6144
v_add_u32 v240, s16, v1
v_add_u32 v241, 49152, v240
s_mul_i32 s16, s12, 10
s_mul_i32 s16, s16, 192
s_mul_i32 s17, s13, 24
s_add_u32 s16, s16, s17
s_lshl_b32 s16, s16, 10
s_add_u32 s16, s16, 29884416
s_add_u32 s30, s16, 0
s_add_u32 s31, s16, 196608
s_add_u32 s32, s16, 393216
s_add_u32 s33, s16, 589824
s_add_u32 s34, s16, 786432
s_add_u32 s35, s16, 983040
s_add_u32 s36, s16, 1179648
s_add_u32 s37, s16, 1376256
s_add_u32 s38, s16, 1572864
s_add_u32 s39, s16, 1769472
s_cmp_lt_u32 s14, 30
s_cbranch_scc1 fin_odma3
s_lshl_b32 s17, s14, 1
s_add_u32 s17, s17, 0
s_and_b32 s17, s17, 7
s_lshl_b32 s16, s15, 3
s_add_u32 s16, s16, s17
s_mul_i32 s16, s16, 12288
s_add_u32 s20, s16, 44040192
s_add_u32 s21, s16, 37748736
s_add_u32 s22, s16, 40894464
s_lshl_b32 s17, s17, 5
s_add_u32 s17, s17, s15
s_mul_i32 s17, s17, 3072
s_add_u32 s23, s17, 47185920
s_add_u32 s24, s17, 47972352
s_lshl_b32 s17, s14, 1
s_add_u32 s17, s17, 1
s_and_b32 s17, s17, 7
s_lshl_b32 s16, s15, 3
s_add_u32 s16, s16, s17
s_mul_i32 s16, s16, 12288
s_add_u32 s40, s16, 44040192
s_add_u32 s41, s16, 37748736
s_add_u32 s42, s16, 40894464
s_lshl_b32 s17, s17, 5
s_add_u32 s17, s17, s15
s_mul_i32 s17, s17, 3072
s_add_u32 s43, s17, 47185920
s_add_u32 s44, s17, 47972352
buffer_load_dwordx4 v[136:139], v1, s[4:7], s21 offen offset:0
buffer_load_dwordx4 v[140:143], v1, s[4:7], s21 offen offset:1024
buffer_load_dwordx4 v[144:147], v1, s[4:7], s21 offen offset:2048
buffer_load_dwordx4 v[148:151], v1, s[4:7], s21 offen offset:3072
buffer_load_dwordx4 v[152:155], v2, s[4:7], s21 offen offset:0
buffer_load_dwordx4 v[156:159], v2, s[4:7], s21 offen offset:1024
buffer_load_dwordx4 v[160:163], v2, s[4:7], s21 offen offset:2048
buffer_load_dwordx4 v[164:167], v2, s[4:7], s21 offen offset:3072
buffer_load_dwordx4 v[168:171], v3, s[4:7], s21 offen offset:0
buffer_load_dwordx4 v[172:175], v3, s[4:7], s21 offen offset:1024
buffer_load_dwordx4 v[176:179], v3, s[4:7], s21 offen offset:2048
buffer_load_dwordx4 v[180:183], v3, s[4:7], s21 offen offset:3072
buffer_load_dwordx4 v[184:187], v4, s[4:7], s23 offen offset:0
buffer_load_dwordx4 v[188:191], v4, s[4:7], s23 offen offset:512
buffer_load_dwordx4 v[192:195], v4, s[4:7], s23 offen offset:1024
buffer_load_dwordx4 v[196:199], v4, s[4:7], s23 offen offset:1536
buffer_load_dwordx4 v[200:203], v4, s[4:7], s23 offen offset:2048
buffer_load_dwordx4 v[204:207], v4, s[4:7], s23 offen offset:2560
buffer_load_dwordx4 v[88:91], v1, s[4:7], s20 offen offset:0
buffer_load_dwordx4 v[92:95], v1, s[4:7], s20 offen offset:1024
buffer_load_dwordx4 v[96:99], v1, s[4:7], s20 offen offset:2048
buffer_load_dwordx4 v[100:103], v1, s[4:7], s20 offen offset:3072
buffer_load_dwordx4 v[104:107], v2, s[4:7], s20 offen offset:0
buffer_load_dwordx4 v[108:111], v2, s[4:7], s20 offen offset:1024
buffer_load_dwordx4 v[112:115], v2, s[4:7], s20 offen offset:2048
buffer_load_dwordx4 v[116:119], v2, s[4:7], s20 offen offset:3072
buffer_load_dwordx4 v[120:123], v3, s[4:7], s20 offen offset:0
buffer_load_dwordx4 v[124:127], v3, s[4:7], s20 offen offset:1024
buffer_load_dwordx4 v[128:131], v3, s[4:7], s20 offen offset:2048
buffer_load_dwordx4 v[132:135], v3, s[4:7], s20 offen offset:3072
buffer_load_dwordx4 a[0:3], v1, s[4:7], s41 offen offset:0
buffer_load_dwordx4 a[4:7], v1, s[4:7], s41 offen offset:1024
buffer_load_dwordx4 a[8:11], v1, s[4:7], s41 offen offset:2048
buffer_load_dwordx4 a[12:15], v1, s[4:7], s41 offen offset:3072
buffer_load_dwordx4 a[16:19], v2, s[4:7], s41 offen offset:0
buffer_load_dwordx4 a[20:23], v2, s[4:7], s41 offen offset:1024
buffer_load_dwordx4 a[24:27], v2, s[4:7], s41 offen offset:2048
buffer_load_dwordx4 a[28:31], v2, s[4:7], s41 offen offset:3072
buffer_load_dwordx4 a[32:35], v3, s[4:7], s41 offen offset:0
buffer_load_dwordx4 a[36:39], v3, s[4:7], s41 offen offset:1024
buffer_load_dwordx4 a[40:43], v3, s[4:7], s41 offen offset:2048
buffer_load_dwordx4 a[44:47], v3, s[4:7], s41 offen offset:3072
buffer_load_dwordx4 a[48:51], v4, s[4:7], s43 offen offset:0
buffer_load_dwordx4 a[52:55], v4, s[4:7], s43 offen offset:512
buffer_load_dwordx4 a[56:59], v4, s[4:7], s43 offen offset:1024
buffer_load_dwordx4 a[60:63], v4, s[4:7], s43 offen offset:1536
buffer_load_dwordx4 a[64:67], v4, s[4:7], s43 offen offset:2048
buffer_load_dwordx4 a[68:71], v4, s[4:7], s43 offen offset:2560
buffer_load_dwordx4 a[72:75], v1, s[4:7], s40 offen offset:0
buffer_load_dwordx4 a[76:79], v1, s[4:7], s40 offen offset:1024
buffer_load_dwordx4 a[80:83], v1, s[4:7], s40 offen offset:2048
buffer_load_dwordx4 a[84:87], v1, s[4:7], s40 offen offset:3072
buffer_load_dwordx4 a[88:91], v2, s[4:7], s40 offen offset:0
buffer_load_dwordx4 a[92:95], v2, s[4:7], s40 offen offset:1024
buffer_load_dwordx4 a[96:99], v2, s[4:7], s40 offen offset:2048
buffer_load_dwordx4 a[100:103], v2, s[4:7], s40 offen offset:3072
buffer_load_dwordx4 a[104:107], v3, s[4:7], s40 offen offset:0
buffer_load_dwordx4 a[108:111], v3, s[4:7], s40 offen offset:1024
buffer_load_dwordx4 a[112:115], v3, s[4:7], s40 offen offset:2048
buffer_load_dwordx4 a[116:119], v3, s[4:7], s40 offen offset:3072
s_waitcnt vmcnt(35)
v_mfma_f32_16x16x32_bf16 v[24:27], v[184:187], v[88:91], v[12:15]
v_mfma_f32_16x16x32_bf16 v[28:31], v[136:139], v[88:91], v[16:19]
v_mfma_f32_16x16x32_bf16 v[32:35], v[184:187], v[112:115], v[12:15]
v_mfma_f32_16x16x32_bf16 v[36:39], v[136:139], v[112:115], 0
v_mfma_f32_16x16x32_bf16 v[40:43], v[160:163], v[112:115], v[16:19]
s_waitcnt vmcnt(34)
v_mfma_f32_16x16x32_bf16 v[24:27], v[188:191], v[92:95], v[24:27]
v_mfma_f32_16x16x32_bf16 v[28:31], v[140:143], v[92:95], v[28:31]
v_mfma_f32_16x16x32_bf16 v[32:35], v[188:191], v[116:119], v[32:35]
v_mfma_f32_16x16x32_bf16 v[36:39], v[140:143], v[116:119], v[36:39]
v_mfma_f32_16x16x32_bf16 v[40:43], v[164:167], v[116:119], v[40:43]
s_waitcnt vmcnt(33)
v_mfma_f32_16x16x32_bf16 v[24:27], v[192:195], v[96:99], v[24:27]
v_mfma_f32_16x16x32_bf16 v[28:31], v[144:147], v[96:99], v[28:31]
v_mfma_f32_16x16x32_bf16 v[32:35], v[192:195], v[120:123], v[32:35]
v_mfma_f32_16x16x32_bf16 v[36:39], v[144:147], v[120:123], v[36:39]
v_mfma_f32_16x16x32_bf16 v[40:43], v[168:171], v[120:123], v[40:43]
s_waitcnt vmcnt(32)
v_mfma_f32_16x16x32_bf16 v[24:27], v[196:199], v[100:103], v[24:27]
v_mfma_f32_16x16x32_bf16 v[28:31], v[148:151], v[100:103], v[28:31]
v_mfma_f32_16x16x32_bf16 v[32:35], v[196:199], v[124:127], v[32:35]
v_mfma_f32_16x16x32_bf16 v[36:39], v[148:151], v[124:127], v[36:39]
v_mfma_f32_16x16x32_bf16 v[40:43], v[172:175], v[124:127], v[40:43]
s_waitcnt vmcnt(31)
v_mfma_f32_16x16x32_bf16 v[24:27], v[200:203], v[104:107], v[24:27]
v_mfma_f32_16x16x32_bf16 v[28:31], v[152:155], v[104:107], v[28:31]
v_mfma_f32_16x16x32_bf16 v[32:35], v[200:203], v[128:131], v[32:35]
v_mfma_f32_16x16x32_bf16 v[36:39], v[152:155], v[128:131], v[36:39]
v_mfma_f32_16x16x32_bf16 v[40:43], v[176:179], v[128:131], v[40:43]
s_waitcnt vmcnt(30)
v_mfma_f32_16x16x32_bf16 v[24:27], v[204:207], v[108:111], v[24:27]
v_mfma_f32_16x16x32_bf16 v[28:31], v[156:159], v[108:111], v[28:31]
v_mfma_f32_16x16x32_bf16 v[32:35], v[204:207], v[132:135], v[32:35]
v_mfma_f32_16x16x32_bf16 v[36:39], v[156:159], v[132:135], v[36:39]
v_mfma_f32_16x16x32_bf16 v[40:43], v[180:183], v[132:135], v[40:43]
buffer_load_dwordx4 v[88:91], v1, s[4:7], s22 offen offset:0
buffer_load_dwordx4 v[92:95], v1, s[4:7], s22 offen offset:1024
buffer_load_dwordx4 v[96:99], v1, s[4:7], s22 offen offset:2048
buffer_load_dwordx4 v[100:103], v1, s[4:7], s22 offen offset:3072
buffer_load_dwordx4 v[104:107], v2, s[4:7], s22 offen offset:0
buffer_load_dwordx4 v[108:111], v2, s[4:7], s22 offen offset:1024
buffer_load_dwordx4 v[112:115], v2, s[4:7], s22 offen offset:2048
buffer_load_dwordx4 v[116:119], v2, s[4:7], s22 offen offset:3072
buffer_load_dwordx4 v[120:123], v3, s[4:7], s22 offen offset:0
buffer_load_dwordx4 v[124:127], v3, s[4:7], s22 offen offset:1024
buffer_load_dwordx4 v[128:131], v3, s[4:7], s22 offen offset:2048
buffer_load_dwordx4 v[132:135], v3, s[4:7], s22 offen offset:3072
buffer_load_dwordx2 v[136:137], v5, s[4:7], s24 offen offset:0
buffer_load_dwordx2 v[138:139], v5, s[4:7], s24 offen offset:256
buffer_load_dwordx2 v[140:141], v5, s[4:7], s24 offen offset:512
buffer_load_dwordx2 v[142:143], v5, s[4:7], s24 offen offset:768
buffer_load_dwordx2 v[144:145], v5, s[4:7], s24 offen offset:1024
buffer_load_dwordx2 v[146:147], v5, s[4:7], s24 offen offset:1280
buffer_load_dwordx2 v[148:149], v5, s[4:7], s24 offen offset:1536
buffer_load_dwordx2 v[150:151], v5, s[4:7], s24 offen offset:1792
buffer_load_dwordx2 v[152:153], v5, s[4:7], s24 offen offset:2048
buffer_load_dwordx2 v[154:155], v5, s[4:7], s24 offen offset:2304
buffer_load_dwordx2 v[156:157], v5, s[4:7], s24 offen offset:2560
buffer_load_dwordx2 v[158:159], v5, s[4:7], s24 offen offset:2816
v_max3_f32 v6, v24, v25, v26
v_max3_f32 v6, v6, v27, v28
v_max3_f32 v6, v6, v29, v30
v_max_f32 v6, v6, v31
v_mov_b32 v7, v6
s_nop 1
v_permlane32_swap_b32 v6, v7
v_max_f32 v6, v6, v7
v_mov_b32 v7, v6
s_nop 1
v_permlane16_swap_b32 v6, v7
v_max_f32 v6, v6, v7
v_mul_f32 v6, s27, v6
v_fma_f32 v24, v24, s27, -v6
v_fma_f32 v25, v25, s27, -v6
v_fma_f32 v26, v26, s27, -v6
v_fma_f32 v27, v27, s27, -v6
v_fma_f32 v28, v28, s27, -v6
v_fma_f32 v29, v29, s27, -v6
v_fma_f32 v30, v30, s27, -v6
v_fma_f32 v31, v31, s27, -v6
v_exp_f32 v24, v24
v_exp_f32 v25, v25
v_exp_f32 v26, v26
v_exp_f32 v27, v27
v_exp_f32 v28, v28
v_exp_f32 v29, v29
v_exp_f32 v30, v30
v_exp_f32 v31, v31
v_max3_f32 v8, v32, v33, v34
v_max3_f32 v8, v8, v35, v36
v_max3_f32 v8, v8, v37, v38
v_max3_f32 v8, v8, v39, v40
v_max3_f32 v8, v8, v41, v42
v_max_f32 v8, v8, v43
v_mov_b32 v10, v8
s_nop 1
v_permlane32_swap_b32 v8, v10
v_max_f32 v8, v8, v10
v_mov_b32 v10, v8
s_nop 1
v_permlane16_swap_b32 v8, v10
v_max_f32 v8, v8, v10
v_mul_f32 v8, s27, v8
v_fma_f32 v32, v32, s27, -v8
v_fma_f32 v33, v33, s27, -v8
v_fma_f32 v34, v34, s27, -v8
v_fma_f32 v35, v35, s27, -v8
v_fma_f32 v36, v36, s27, -v8
v_fma_f32 v37, v37, s27, -v8
v_fma_f32 v38, v38, s27, -v8
v_fma_f32 v39, v39, s27, -v8
v_fma_f32 v40, v40, s27, -v8
v_fma_f32 v41, v41, s27, -v8
v_fma_f32 v42, v42, s27, -v8
v_fma_f32 v43, v43, s27, -v8
v_exp_f32 v32, v32
v_exp_f32 v33, v33
v_exp_f32 v34, v34
v_exp_f32 v35, v35
v_exp_f32 v36, v36
v_exp_f32 v37, v37
v_exp_f32 v38, v38
v_exp_f32 v39, v39
v_exp_f32 v40, v40
v_exp_f32 v41, v41
v_exp_f32 v42, v42
v_exp_f32 v43, v43
v_cvt_pk_bf16_f32 v44, v24, v25
v_cvt_pk_bf16_f32 v45, v26, v27
v_cvt_pk_bf16_f32 v46, v28, v29
v_cvt_pk_bf16_f32 v47, v30, v31
v_cvt_pk_bf16_f32 v48, v32, v33
v_cvt_pk_bf16_f32 v49, v34, v35
v_cvt_pk_bf16_f32 v50, v36, v37
v_cvt_pk_bf16_f32 v51, v38, v39
v_cvt_pk_bf16_f32 v52, v40, v41
v_cvt_pk_bf16_f32 v53, v42, v43
v_mfma_f32_16x16x16_bf16 v[56:59], v[20:21], v[44:45], 0
v_mfma_f32_16x16x16_bf16 v[60:63], v[20:21], v[48:49], 0
v_mfma_f32_16x16x16_bf16 v[56:59], v[20:21], v[46:47], v[56:59]
v_mfma_f32_16x16x32_bf16 v[60:63], v[20:23], v[50:53], v[60:63]
s_nop 6
v_rcp_f32 v10, v56
v_rcp_f32 v11, v60
s_waitcnt vmcnt(0)
v_mfma_f32_16x16x16_bf16 v[64:67], v[136:137], v[44:45], 0
v_mfma_f32_16x16x16_bf16 v[68:71], v[136:137], v[48:49], 0
v_mfma_f32_16x16x16_bf16 v[64:67], v[88:89], v[46:47], v[64:67]
v_mfma_f32_16x16x32_bf16 v[68:71], v[88:91], v[50:53], v[68:71]
v_mfma_f32_16x16x16_bf16 v[72:75], v[138:139], v[44:45], 0
v_mfma_f32_16x16x16_bf16 v[76:79], v[138:139], v[48:49], 0
v_mfma_f32_16x16x16_bf16 v[72:75], v[92:93], v[46:47], v[72:75]
v_mfma_f32_16x16x32_bf16 v[76:79], v[92:95], v[50:53], v[76:79]
s_nop 2
v_mul_f32 v64, v64, v10
v_mul_f32 v65, v65, v10
v_mul_f32 v66, v66, v10
v_mul_f32 v67, v67, v10
v_cvt_pk_bf16_f32 v80, v64, v65
v_cvt_pk_bf16_f32 v81, v66, v67
v_mul_f32 v72, v72, v10
v_mul_f32 v73, v73, v10
v_mul_f32 v74, v74, v10
v_mul_f32 v75, v75, v10
v_cvt_pk_bf16_f32 v82, v72, v73
v_cvt_pk_bf16_f32 v83, v74, v75
ds_write_b128 v240, v[80:83] offset:0
v_mul_f32 v68, v68, v11
v_mul_f32 v69, v69, v11
v_mul_f32 v70, v70, v11
v_mul_f32 v71, v71, v11
v_cvt_pk_bf16_f32 v84, v68, v69
v_cvt_pk_bf16_f32 v85, v70, v71
v_mul_f32 v76, v76, v11
v_mul_f32 v77, v77, v11
v_mul_f32 v78, v78, v11
v_mul_f32 v79, v79, v11
v_cvt_pk_bf16_f32 v86, v76, v77
v_cvt_pk_bf16_f32 v87, v78, v79
ds_write_b128 v240, v[84:87] offset:24576
v_mfma_f32_16x16x16_bf16 v[64:67], v[140:141], v[44:45], 0
v_mfma_f32_16x16x16_bf16 v[68:71], v[140:141], v[48:49], 0
v_mfma_f32_16x16x16_bf16 v[64:67], v[96:97], v[46:47], v[64:67]
v_mfma_f32_16x16x32_bf16 v[68:71], v[96:99], v[50:53], v[68:71]
v_mfma_f32_16x16x16_bf16 v[72:75], v[142:143], v[44:45], 0
v_mfma_f32_16x16x16_bf16 v[76:79], v[142:143], v[48:49], 0
v_mfma_f32_16x16x16_bf16 v[72:75], v[100:101], v[46:47], v[72:75]
v_mfma_f32_16x16x32_bf16 v[76:79], v[100:103], v[50:53], v[76:79]
s_nop 2
v_mul_f32 v64, v64, v10
v_mul_f32 v65, v65, v10
v_mul_f32 v66, v66, v10
v_mul_f32 v67, v67, v10
v_cvt_pk_bf16_f32 v80, v64, v65
v_cvt_pk_bf16_f32 v81, v66, v67
v_mul_f32 v72, v72, v10
v_mul_f32 v73, v73, v10
v_mul_f32 v74, v74, v10
v_mul_f32 v75, v75, v10
v_cvt_pk_bf16_f32 v82, v72, v73
v_cvt_pk_bf16_f32 v83, v74, v75
ds_write_b128 v240, v[80:83] offset:1024
v_mul_f32 v68, v68, v11
v_mul_f32 v69, v69, v11
v_mul_f32 v70, v70, v11
v_mul_f32 v71, v71, v11
v_cvt_pk_bf16_f32 v84, v68, v69
v_cvt_pk_bf16_f32 v85, v70, v71
v_mul_f32 v76, v76, v11
v_mul_f32 v77, v77, v11
v_mul_f32 v78, v78, v11
v_mul_f32 v79, v79, v11
v_cvt_pk_bf16_f32 v86, v76, v77
v_cvt_pk_bf16_f32 v87, v78, v79
ds_write_b128 v240, v[84:87] offset:25600
v_mfma_f32_16x16x16_bf16 v[64:67], v[144:145], v[44:45], 0
v_mfma_f32_16x16x16_bf16 v[68:71], v[144:145], v[48:49], 0
v_mfma_f32_16x16x16_bf16 v[64:67], v[104:105], v[46:47], v[64:67]
v_mfma_f32_16x16x32_bf16 v[68:71], v[104:107], v[50:53], v[68:71]
v_mfma_f32_16x16x16_bf16 v[72:75], v[146:147], v[44:45], 0
v_mfma_f32_16x16x16_bf16 v[76:79], v[146:147], v[48:49], 0
v_mfma_f32_16x16x16_bf16 v[72:75], v[108:109], v[46:47], v[72:75]
v_mfma_f32_16x16x32_bf16 v[76:79], v[108:111], v[50:53], v[76:79]
s_nop 2
v_mul_f32 v64, v64, v10
v_mul_f32 v65, v65, v10
v_mul_f32 v66, v66, v10
v_mul_f32 v67, v67, v10
v_cvt_pk_bf16_f32 v80, v64, v65
v_cvt_pk_bf16_f32 v81, v66, v67
v_mul_f32 v72, v72, v10
v_mul_f32 v73, v73, v10
v_mul_f32 v74, v74, v10
v_mul_f32 v75, v75, v10
v_cvt_pk_bf16_f32 v82, v72, v73
v_cvt_pk_bf16_f32 v83, v74, v75
ds_write_b128 v240, v[80:83] offset:2048
v_mul_f32 v68, v68, v11
v_mul_f32 v69, v69, v11
v_mul_f32 v70, v70, v11
v_mul_f32 v71, v71, v11
v_cvt_pk_bf16_f32 v84, v68, v69
v_cvt_pk_bf16_f32 v85, v70, v71
v_mul_f32 v76, v76, v11
v_mul_f32 v77, v77, v11
v_mul_f32 v78, v78, v11
v_mul_f32 v79, v79, v11
v_cvt_pk_bf16_f32 v86, v76, v77
v_cvt_pk_bf16_f32 v87, v78, v79
ds_write_b128 v240, v[84:87] offset:26624
v_mfma_f32_16x16x16_bf16 v[64:67], v[148:149], v[44:45], 0
v_mfma_f32_16x16x16_bf16 v[68:71], v[148:149], v[48:49], 0
v_mfma_f32_16x16x16_bf16 v[64:67], v[112:113], v[46:47], v[64:67]
v_mfma_f32_16x16x32_bf16 v[68:71], v[112:115], v[50:53], v[68:71]
v_mfma_f32_16x16x16_bf16 v[72:75], v[150:151], v[44:45], 0
v_mfma_f32_16x16x16_bf16 v[76:79], v[150:151], v[48:49], 0
v_mfma_f32_16x16x16_bf16 v[72:75], v[116:117], v[46:47], v[72:75]
v_mfma_f32_16x16x32_bf16 v[76:79], v[116:119], v[50:53], v[76:79]
s_nop 2
v_mul_f32 v64, v64, v10
v_mul_f32 v65, v65, v10
v_mul_f32 v66, v66, v10
v_mul_f32 v67, v67, v10
v_cvt_pk_bf16_f32 v80, v64, v65
v_cvt_pk_bf16_f32 v81, v66, v67
v_mul_f32 v72, v72, v10
v_mul_f32 v73, v73, v10
v_mul_f32 v74, v74, v10
v_mul_f32 v75, v75, v10
v_cvt_pk_bf16_f32 v82, v72, v73
v_cvt_pk_bf16_f32 v83, v74, v75
ds_write_b128 v240, v[80:83] offset:3072
v_mul_f32 v68, v68, v11
v_mul_f32 v69, v69, v11
v_mul_f32 v70, v70, v11
v_mul_f32 v71, v71, v11
v_cvt_pk_bf16_f32 v84, v68, v69
v_cvt_pk_bf16_f32 v85, v70, v71
v_mul_f32 v76, v76, v11
v_mul_f32 v77, v77, v11
v_mul_f32 v78, v78, v11
v_mul_f32 v79, v79, v11
v_cvt_pk_bf16_f32 v86, v76, v77
v_cvt_pk_bf16_f32 v87, v78, v79
ds_write_b128 v240, v[84:87] offset:27648
v_mfma_f32_16x16x16_bf16 v[64:67], v[152:153], v[44:45], 0
v_mfma_f32_16x16x16_bf16 v[68:71], v[152:153], v[48:49], 0
v_mfma_f32_16x16x16_bf16 v[64:67], v[120:121], v[46:47], v[64:67]
v_mfma_f32_16x16x32_bf16 v[68:71], v[120:123], v[50:53], v[68:71]
v_mfma_f32_16x16x16_bf16 v[72:75], v[154:155], v[44:45], 0
v_mfma_f32_16x16x16_bf16 v[76:79], v[154:155], v[48:49], 0
v_mfma_f32_16x16x16_bf16 v[72:75], v[124:125], v[46:47], v[72:75]
v_mfma_f32_16x16x32_bf16 v[76:79], v[124:127], v[50:53], v[76:79]
s_nop 2
v_mul_f32 v64, v64, v10
v_mul_f32 v65, v65, v10
v_mul_f32 v66, v66, v10
v_mul_f32 v67, v67, v10
v_cvt_pk_bf16_f32 v80, v64, v65
v_cvt_pk_bf16_f32 v81, v66, v67
v_mul_f32 v72, v72, v10
v_mul_f32 v73, v73, v10
v_mul_f32 v74, v74, v10
v_mul_f32 v75, v75, v10
v_cvt_pk_bf16_f32 v82, v72, v73
v_cvt_pk_bf16_f32 v83, v74, v75
ds_write_b128 v240, v[80:83] offset:4096
v_mul_f32 v68, v68, v11
v_mul_f32 v69, v69, v11
v_mul_f32 v70, v70, v11
v_mul_f32 v71, v71, v11
v_cvt_pk_bf16_f32 v84, v68, v69
v_cvt_pk_bf16_f32 v85, v70, v71
v_mul_f32 v76, v76, v11
v_mul_f32 v77, v77, v11
v_mul_f32 v78, v78, v11
v_mul_f32 v79, v79, v11
v_cvt_pk_bf16_f32 v86, v76, v77
v_cvt_pk_bf16_f32 v87, v78, v79
ds_write_b128 v240, v[84:87] offset:28672
v_mfma_f32_16x16x16_bf16 v[64:67], v[156:157], v[44:45], 0
v_mfma_f32_16x16x16_bf16 v[68:71], v[156:157], v[48:49], 0
v_mfma_f32_16x16x16_bf16 v[64:67], v[128:129], v[46:47], v[64:67]
v_mfma_f32_16x16x32_bf16 v[68:71], v[128:131], v[50:53], v[68:71]
v_mfma_f32_16x16x16_bf16 v[72:75], v[158:159], v[44:45], 0
v_mfma_f32_16x16x16_bf16 v[76:79], v[158:159], v[48:49], 0
v_mfma_f32_16x16x16_bf16 v[72:75], v[132:133], v[46:47], v[72:75]
v_mfma_f32_16x16x32_bf16 v[76:79], v[132:135], v[50:53], v[76:79]
s_nop 2
v_mul_f32 v64, v64, v10
v_mul_f32 v65, v65, v10
v_mul_f32 v66, v66, v10
v_mul_f32 v67, v67, v10
v_cvt_pk_bf16_f32 v80, v64, v65
v_cvt_pk_bf16_f32 v81, v66, v67
v_mul_f32 v72, v72, v10
v_mul_f32 v73, v73, v10
v_mul_f32 v74, v74, v10
v_mul_f32 v75, v75, v10
v_cvt_pk_bf16_f32 v82, v72, v73
v_cvt_pk_bf16_f32 v83, v74, v75
ds_write_b128 v240, v[80:83] offset:5120
v_mul_f32 v68, v68, v11
v_mul_f32 v69, v69, v11
v_mul_f32 v70, v70, v11
v_mul_f32 v71, v71, v11
v_cvt_pk_bf16_f32 v84, v68, v69
v_cvt_pk_bf16_f32 v85, v70, v71
v_mul_f32 v76, v76, v11
v_mul_f32 v77, v77, v11
v_mul_f32 v78, v78, v11
v_mul_f32 v79, v79, v11
v_cvt_pk_bf16_f32 v86, v76, v77
v_cvt_pk_bf16_f32 v87, v78, v79
ds_write_b128 v240, v[84:87] offset:29696
v_mfma_f32_16x16x32_bf16 v[24:27], a[48:51], a[72:75], v[12:15]
v_mfma_f32_16x16x32_bf16 v[28:31], a[0:3], a[72:75], v[16:19]
v_mfma_f32_16x16x32_bf16 v[32:35], a[48:51], a[96:99], v[12:15]
v_mfma_f32_16x16x32_bf16 v[36:39], a[0:3], a[96:99], 0
v_mfma_f32_16x16x32_bf16 v[40:43], a[24:27], a[96:99], v[16:19]
v_mfma_f32_16x16x32_bf16 v[24:27], a[52:55], a[76:79], v[24:27]
v_mfma_f32_16x16x32_bf16 v[28:31], a[4:7], a[76:79], v[28:31]
v_mfma_f32_16x16x32_bf16 v[32:35], a[52:55], a[100:103], v[32:35]
v_mfma_f32_16x16x32_bf16 v[36:39], a[4:7], a[100:103], v[36:39]
v_mfma_f32_16x16x32_bf16 v[40:43], a[28:31], a[100:103], v[40:43]
v_mfma_f32_16x16x32_bf16 v[24:27], a[56:59], a[80:83], v[24:27]
v_mfma_f32_16x16x32_bf16 v[28:31], a[8:11], a[80:83], v[28:31]
v_mfma_f32_16x16x32_bf16 v[32:35], a[56:59], a[104:107], v[32:35]
v_mfma_f32_16x16x32_bf16 v[36:39], a[8:11], a[104:107], v[36:39]
v_mfma_f32_16x16x32_bf16 v[40:43], a[32:35], a[104:107], v[40:43]
v_mfma_f32_16x16x32_bf16 v[24:27], a[60:63], a[84:87], v[24:27]
v_mfma_f32_16x16x32_bf16 v[28:31], a[12:15], a[84:87], v[28:31]
v_mfma_f32_16x16x32_bf16 v[32:35], a[60:63], a[108:111], v[32:35]
v_mfma_f32_16x16x32_bf16 v[36:39], a[12:15], a[108:111], v[36:39]
v_mfma_f32_16x16x32_bf16 v[40:43], a[36:39], a[108:111], v[40:43]
v_mfma_f32_16x16x32_bf16 v[24:27], a[64:67], a[88:91], v[24:27]
v_mfma_f32_16x16x32_bf16 v[28:31], a[16:19], a[88:91], v[28:31]
v_mfma_f32_16x16x32_bf16 v[32:35], a[64:67], a[112:115], v[32:35]
v_mfma_f32_16x16x32_bf16 v[36:39], a[16:19], a[112:115], v[36:39]
v_mfma_f32_16x16x32_bf16 v[40:43], a[40:43], a[112:115], v[40:43]
v_mfma_f32_16x16x32_bf16 v[24:27], a[68:71], a[92:95], v[24:27]
v_mfma_f32_16x16x32_bf16 v[28:31], a[20:23], a[92:95], v[28:31]
v_mfma_f32_16x16x32_bf16 v[32:35], a[68:71], a[116:119], v[32:35]
v_mfma_f32_16x16x32_bf16 v[36:39], a[20:23], a[116:119], v[36:39]
v_mfma_f32_16x16x32_bf16 v[40:43], a[44:47], a[116:119], v[40:43]
buffer_load_dwordx4 v[88:91], v1, s[4:7], s42 offen offset:0
buffer_load_dwordx4 v[92:95], v1, s[4:7], s42 offen offset:1024
buffer_load_dwordx4 v[96:99], v1, s[4:7], s42 offen offset:2048
buffer_load_dwordx4 v[100:103], v1, s[4:7], s42 offen offset:3072
buffer_load_dwordx4 v[104:107], v2, s[4:7], s42 offen offset:0
buffer_load_dwordx4 v[108:111], v2, s[4:7], s42 offen offset:1024
buffer_load_dwordx4 v[112:115], v2, s[4:7], s42 offen offset:2048
buffer_load_dwordx4 v[116:119], v2, s[4:7], s42 offen offset:3072
buffer_load_dwordx4 v[120:123], v3, s[4:7], s42 offen offset:0
buffer_load_dwordx4 v[124:127], v3, s[4:7], s42 offen offset:1024
buffer_load_dwordx4 v[128:131], v3, s[4:7], s42 offen offset:2048
buffer_load_dwordx4 v[132:135], v3, s[4:7], s42 offen offset:3072
buffer_load_dwordx2 v[136:137], v5, s[4:7], s44 offen offset:0
buffer_load_dwordx2 v[138:139], v5, s[4:7], s44 offen offset:256
buffer_load_dwordx2 v[140:141], v5, s[4:7], s44 offen offset:512
buffer_load_dwordx2 v[142:143], v5, s[4:7], s44 offen offset:768
buffer_load_dwordx2 v[144:145], v5, s[4:7], s44 offen offset:1024
buffer_load_dwordx2 v[146:147], v5, s[4:7], s44 offen offset:1280
buffer_load_dwordx2 v[148:149], v5, s[4:7], s44 offen offset:1536
buffer_load_dwordx2 v[150:151], v5, s[4:7], s44 offen offset:1792
buffer_load_dwordx2 v[152:153], v5, s[4:7], s44 offen offset:2048
buffer_load_dwordx2 v[154:155], v5, s[4:7], s44 offen offset:2304
buffer_load_dwordx2 v[156:157], v5, s[4:7], s44 offen offset:2560
buffer_load_dwordx2 v[158:159], v5, s[4:7], s44 offen offset:2816
v_max3_f32 v6, v24, v25, v26
v_max3_f32 v6, v6, v27, v28
v_max3_f32 v6, v6, v29, v30
v_max_f32 v6, v6, v31
v_mov_b32 v7, v6
s_nop 1
v_permlane32_swap_b32 v6, v7
v_max_f32 v6, v6, v7
v_mov_b32 v7, v6
s_nop 1
v_permlane16_swap_b32 v6, v7
v_max_f32 v6, v6, v7
v_mul_f32 v6, s27, v6
v_fma_f32 v24, v24, s27, -v6
v_fma_f32 v25, v25, s27, -v6
v_fma_f32 v26, v26, s27, -v6
v_fma_f32 v27, v27, s27, -v6
v_fma_f32 v28, v28, s27, -v6
v_fma_f32 v29, v29, s27, -v6
v_fma_f32 v30, v30, s27, -v6
v_fma_f32 v31, v31, s27, -v6
v_exp_f32 v24, v24
v_exp_f32 v25, v25
v_exp_f32 v26, v26
v_exp_f32 v27, v27
v_exp_f32 v28, v28
v_exp_f32 v29, v29
v_exp_f32 v30, v30
v_exp_f32 v31, v31
v_max3_f32 v8, v32, v33, v34
v_max3_f32 v8, v8, v35, v36
v_max3_f32 v8, v8, v37, v38
v_max3_f32 v8, v8, v39, v40
v_max3_f32 v8, v8, v41, v42
v_max_f32 v8, v8, v43
v_mov_b32 v10, v8
s_nop 1
v_permlane32_swap_b32 v8, v10
v_max_f32 v8, v8, v10
v_mov_b32 v10, v8
s_nop 1
v_permlane16_swap_b32 v8, v10
v_max_f32 v8, v8, v10
v_mul_f32 v8, s27, v8
v_fma_f32 v32, v32, s27, -v8
v_fma_f32 v33, v33, s27, -v8
v_fma_f32 v34, v34, s27, -v8
v_fma_f32 v35, v35, s27, -v8
v_fma_f32 v36, v36, s27, -v8
v_fma_f32 v37, v37, s27, -v8
v_fma_f32 v38, v38, s27, -v8
v_fma_f32 v39, v39, s27, -v8
v_fma_f32 v40, v40, s27, -v8
v_fma_f32 v41, v41, s27, -v8
v_fma_f32 v42, v42, s27, -v8
v_fma_f32 v43, v43, s27, -v8
v_exp_f32 v32, v32
v_exp_f32 v33, v33
v_exp_f32 v34, v34
v_exp_f32 v35, v35
v_exp_f32 v36, v36
v_exp_f32 v37, v37
v_exp_f32 v38, v38
v_exp_f32 v39, v39
v_exp_f32 v40, v40
v_exp_f32 v41, v41
v_exp_f32 v42, v42
v_exp_f32 v43, v43
v_cvt_pk_bf16_f32 v44, v24, v25
v_cvt_pk_bf16_f32 v45, v26, v27
v_cvt_pk_bf16_f32 v46, v28, v29
v_cvt_pk_bf16_f32 v47, v30, v31
v_cvt_pk_bf16_f32 v48, v32, v33
v_cvt_pk_bf16_f32 v49, v34, v35
v_cvt_pk_bf16_f32 v50, v36, v37
v_cvt_pk_bf16_f32 v51, v38, v39
v_cvt_pk_bf16_f32 v52, v40, v41
v_cvt_pk_bf16_f32 v53, v42, v43
v_mfma_f32_16x16x16_bf16 v[56:59], v[20:21], v[44:45], 0
v_mfma_f32_16x16x16_bf16 v[60:63], v[20:21], v[48:49], 0
v_mfma_f32_16x16x16_bf16 v[56:59], v[20:21], v[46:47], v[56:59]
v_mfma_f32_16x16x32_bf16 v[60:63], v[20:23], v[50:53], v[60:63]
s_nop 6
v_rcp_f32 v10, v56
v_rcp_f32 v11, v60
s_waitcnt vmcnt(0)
buffer_load_dwordx4 a[160:163], v1, s[4:7], s30 offen offset:0
buffer_load_dwordx4 a[164:167], v1, s[4:7], s31 offen offset:0
buffer_load_dwordx4 a[168:171], v1, s[4:7], s32 offen offset:0
buffer_load_dwordx4 a[172:175], v1, s[4:7], s33 offen offset:0
buffer_load_dwordx4 a[176:179], v1, s[4:7], s34 offen offset:0
buffer_load_dwordx4 a[180:183], v1, s[4:7], s35 offen offset:0
buffer_load_dwordx4 a[184:187], v1, s[4:7], s36 offen offset:0
buffer_load_dwordx4 a[188:191], v1, s[4:7], s37 offen offset:0
buffer_load_dwordx4 a[192:195], v1, s[4:7], s38 offen offset:0
buffer_load_dwordx4 a[196:199], v1, s[4:7], s39 offen offset:0
buffer_load_dwordx4 a[200:203], v1, s[4:7], s30 offen offset:1024
buffer_load_dwordx4 a[204:207], v1, s[4:7], s31 offen offset:1024
buffer_load_dwordx4 a[208:211], v1, s[4:7], s32 offen offset:1024
buffer_load_dwordx4 a[212:215], v1, s[4:7], s33 offen offset:1024
buffer_load_dwordx4 a[216:219], v1, s[4:7], s34 offen offset:1024
buffer_load_dwordx4 a[220:223], v1, s[4:7], s35 offen offset:1024
buffer_load_dwordx4 a[224:227], v1, s[4:7], s36 offen offset:1024
buffer_load_dwordx4 a[228:231], v1, s[4:7], s37 offen offset:1024
buffer_load_dwordx4 a[232:235], v1, s[4:7], s38 offen offset:1024
buffer_load_dwordx4 a[236:239], v1, s[4:7], s39 offen offset:1024
v_mfma_f32_16x16x16_bf16 v[64:67], v[136:137], v[44:45], 0
v_mfma_f32_16x16x16_bf16 v[68:71], v[136:137], v[48:49], 0
v_mfma_f32_16x16x16_bf16 v[64:67], v[88:89], v[46:47], v[64:67]
v_mfma_f32_16x16x32_bf16 v[68:71], v[88:91], v[50:53], v[68:71]
v_mfma_f32_16x16x16_bf16 v[72:75], v[138:139], v[44:45], 0
v_mfma_f32_16x16x16_bf16 v[76:79], v[138:139], v[48:49], 0
v_mfma_f32_16x16x16_bf16 v[72:75], v[92:93], v[46:47], v[72:75]
v_mfma_f32_16x16x32_bf16 v[76:79], v[92:95], v[50:53], v[76:79]
s_nop 2
v_mul_f32 v64, v64, v10
v_mul_f32 v65, v65, v10
v_mul_f32 v66, v66, v10
v_mul_f32 v67, v67, v10
v_cvt_pk_bf16_f32 v80, v64, v65
v_cvt_pk_bf16_f32 v81, v66, v67
v_mul_f32 v72, v72, v10
v_mul_f32 v73, v73, v10
v_mul_f32 v74, v74, v10
v_mul_f32 v75, v75, v10
v_cvt_pk_bf16_f32 v82, v72, v73
v_cvt_pk_bf16_f32 v83, v74, v75
ds_write_b128 v241, v[80:83] offset:0
v_mul_f32 v68, v68, v11
v_mul_f32 v69, v69, v11
v_mul_f32 v70, v70, v11
v_mul_f32 v71, v71, v11
v_cvt_pk_bf16_f32 v84, v68, v69
v_cvt_pk_bf16_f32 v85, v70, v71
v_mul_f32 v76, v76, v11
v_mul_f32 v77, v77, v11
v_mul_f32 v78, v78, v11
v_mul_f32 v79, v79, v11
v_cvt_pk_bf16_f32 v86, v76, v77
v_cvt_pk_bf16_f32 v87, v78, v79
ds_write_b128 v241, v[84:87] offset:24576
v_mfma_f32_16x16x16_bf16 v[64:67], v[140:141], v[44:45], 0
v_mfma_f32_16x16x16_bf16 v[68:71], v[140:141], v[48:49], 0
v_mfma_f32_16x16x16_bf16 v[64:67], v[96:97], v[46:47], v[64:67]
v_mfma_f32_16x16x32_bf16 v[68:71], v[96:99], v[50:53], v[68:71]
v_mfma_f32_16x16x16_bf16 v[72:75], v[142:143], v[44:45], 0
v_mfma_f32_16x16x16_bf16 v[76:79], v[142:143], v[48:49], 0
v_mfma_f32_16x16x16_bf16 v[72:75], v[100:101], v[46:47], v[72:75]
v_mfma_f32_16x16x32_bf16 v[76:79], v[100:103], v[50:53], v[76:79]
s_nop 2
v_mul_f32 v64, v64, v10
v_mul_f32 v65, v65, v10
v_mul_f32 v66, v66, v10
v_mul_f32 v67, v67, v10
v_cvt_pk_bf16_f32 v80, v64, v65
v_cvt_pk_bf16_f32 v81, v66, v67
v_mul_f32 v72, v72, v10
v_mul_f32 v73, v73, v10
v_mul_f32 v74, v74, v10
v_mul_f32 v75, v75, v10
v_cvt_pk_bf16_f32 v82, v72, v73
v_cvt_pk_bf16_f32 v83, v74, v75
ds_write_b128 v241, v[80:83] offset:1024
v_mul_f32 v68, v68, v11
v_mul_f32 v69, v69, v11
v_mul_f32 v70, v70, v11
v_mul_f32 v71, v71, v11
v_cvt_pk_bf16_f32 v84, v68, v69
v_cvt_pk_bf16_f32 v85, v70, v71
v_mul_f32 v76, v76, v11
v_mul_f32 v77, v77, v11
v_mul_f32 v78, v78, v11
v_mul_f32 v79, v79, v11
v_cvt_pk_bf16_f32 v86, v76, v77
v_cvt_pk_bf16_f32 v87, v78, v79
ds_write_b128 v241, v[84:87] offset:25600
v_mfma_f32_16x16x16_bf16 v[64:67], v[144:145], v[44:45], 0
v_mfma_f32_16x16x16_bf16 v[68:71], v[144:145], v[48:49], 0
v_mfma_f32_16x16x16_bf16 v[64:67], v[104:105], v[46:47], v[64:67]
v_mfma_f32_16x16x32_bf16 v[68:71], v[104:107], v[50:53], v[68:71]
v_mfma_f32_16x16x16_bf16 v[72:75], v[146:147], v[44:45], 0
v_mfma_f32_16x16x16_bf16 v[76:79], v[146:147], v[48:49], 0
v_mfma_f32_16x16x16_bf16 v[72:75], v[108:109], v[46:47], v[72:75]
v_mfma_f32_16x16x32_bf16 v[76:79], v[108:111], v[50:53], v[76:79]
s_nop 2
v_mul_f32 v64, v64, v10
v_mul_f32 v65, v65, v10
v_mul_f32 v66, v66, v10
v_mul_f32 v67, v67, v10
v_cvt_pk_bf16_f32 v80, v64, v65
v_cvt_pk_bf16_f32 v81, v66, v67
v_mul_f32 v72, v72, v10
v_mul_f32 v73, v73, v10
v_mul_f32 v74, v74, v10
v_mul_f32 v75, v75, v10
v_cvt_pk_bf16_f32 v82, v72, v73
v_cvt_pk_bf16_f32 v83, v74, v75
ds_write_b128 v241, v[80:83] offset:2048
v_mul_f32 v68, v68, v11
v_mul_f32 v69, v69, v11
v_mul_f32 v70, v70, v11
v_mul_f32 v71, v71, v11
v_cvt_pk_bf16_f32 v84, v68, v69
v_cvt_pk_bf16_f32 v85, v70, v71
v_mul_f32 v76, v76, v11
v_mul_f32 v77, v77, v11
v_mul_f32 v78, v78, v11
v_mul_f32 v79, v79, v11
v_cvt_pk_bf16_f32 v86, v76, v77
v_cvt_pk_bf16_f32 v87, v78, v79
ds_write_b128 v241, v[84:87] offset:26624
v_mfma_f32_16x16x16_bf16 v[64:67], v[148:149], v[44:45], 0
v_mfma_f32_16x16x16_bf16 v[68:71], v[148:149], v[48:49], 0
v_mfma_f32_16x16x16_bf16 v[64:67], v[112:113], v[46:47], v[64:67]
v_mfma_f32_16x16x32_bf16 v[68:71], v[112:115], v[50:53], v[68:71]
v_mfma_f32_16x16x16_bf16 v[72:75], v[150:151], v[44:45], 0
v_mfma_f32_16x16x16_bf16 v[76:79], v[150:151], v[48:49], 0
v_mfma_f32_16x16x16_bf16 v[72:75], v[116:117], v[46:47], v[72:75]
v_mfma_f32_16x16x32_bf16 v[76:79], v[116:119], v[50:53], v[76:79]
s_nop 2
v_mul_f32 v64, v64, v10
v_mul_f32 v65, v65, v10
v_mul_f32 v66, v66, v10
v_mul_f32 v67, v67, v10
v_cvt_pk_bf16_f32 v80, v64, v65
v_cvt_pk_bf16_f32 v81, v66, v67
v_mul_f32 v72, v72, v10
v_mul_f32 v73, v73, v10
v_mul_f32 v74, v74, v10
v_mul_f32 v75, v75, v10
v_cvt_pk_bf16_f32 v82, v72, v73
v_cvt_pk_bf16_f32 v83, v74, v75
ds_write_b128 v241, v[80:83] offset:3072
v_mul_f32 v68, v68, v11
v_mul_f32 v69, v69, v11
v_mul_f32 v70, v70, v11
v_mul_f32 v71, v71, v11
v_cvt_pk_bf16_f32 v84, v68, v69
v_cvt_pk_bf16_f32 v85, v70, v71
v_mul_f32 v76, v76, v11
v_mul_f32 v77, v77, v11
v_mul_f32 v78, v78, v11
v_mul_f32 v79, v79, v11
v_cvt_pk_bf16_f32 v86, v76, v77
v_cvt_pk_bf16_f32 v87, v78, v79
ds_write_b128 v241, v[84:87] offset:27648
v_mfma_f32_16x16x16_bf16 v[64:67], v[152:153], v[44:45], 0
v_mfma_f32_16x16x16_bf16 v[68:71], v[152:153], v[48:49], 0
v_mfma_f32_16x16x16_bf16 v[64:67], v[120:121], v[46:47], v[64:67]
v_mfma_f32_16x16x32_bf16 v[68:71], v[120:123], v[50:53], v[68:71]
v_mfma_f32_16x16x16_bf16 v[72:75], v[154:155], v[44:45], 0
v_mfma_f32_16x16x16_bf16 v[76:79], v[154:155], v[48:49], 0
v_mfma_f32_16x16x16_bf16 v[72:75], v[124:125], v[46:47], v[72:75]
v_mfma_f32_16x16x32_bf16 v[76:79], v[124:127], v[50:53], v[76:79]
s_nop 2
v_mul_f32 v64, v64, v10
v_mul_f32 v65, v65, v10
v_mul_f32 v66, v66, v10
v_mul_f32 v67, v67, v10
v_cvt_pk_bf16_f32 v80, v64, v65
v_cvt_pk_bf16_f32 v81, v66, v67
v_mul_f32 v72, v72, v10
v_mul_f32 v73, v73, v10
v_mul_f32 v74, v74, v10
v_mul_f32 v75, v75, v10
v_cvt_pk_bf16_f32 v82, v72, v73
v_cvt_pk_bf16_f32 v83, v74, v75
ds_write_b128 v241, v[80:83] offset:4096
v_mul_f32 v68, v68, v11
v_mul_f32 v69, v69, v11
v_mul_f32 v70, v70, v11
v_mul_f32 v71, v71, v11
v_cvt_pk_bf16_f32 v84, v68, v69
v_cvt_pk_bf16_f32 v85, v70, v71
v_mul_f32 v76, v76, v11
v_mul_f32 v77, v77, v11
v_mul_f32 v78, v78, v11
v_mul_f32 v79, v79, v11
v_cvt_pk_bf16_f32 v86, v76, v77
v_cvt_pk_bf16_f32 v87, v78, v79
ds_write_b128 v241, v[84:87] offset:28672
v_mfma_f32_16x16x16_bf16 v[64:67], v[156:157], v[44:45], 0
v_mfma_f32_16x16x16_bf16 v[68:71], v[156:157], v[48:49], 0
v_mfma_f32_16x16x16_bf16 v[64:67], v[128:129], v[46:47], v[64:67]
v_mfma_f32_16x16x32_bf16 v[68:71], v[128:131], v[50:53], v[68:71]
v_mfma_f32_16x16x16_bf16 v[72:75], v[158:159], v[44:45], 0
v_mfma_f32_16x16x16_bf16 v[76:79], v[158:159], v[48:49], 0
v_mfma_f32_16x16x16_bf16 v[72:75], v[132:133], v[46:47], v[72:75]
v_mfma_f32_16x16x32_bf16 v[76:79], v[132:135], v[50:53], v[76:79]
s_nop 2
v_mul_f32 v64, v64, v10
v_mul_f32 v65, v65, v10
v_mul_f32 v66, v66, v10
v_mul_f32 v67, v67, v10
v_cvt_pk_bf16_f32 v80, v64, v65
v_cvt_pk_bf16_f32 v81, v66, v67
v_mul_f32 v72, v72, v10
v_mul_f32 v73, v73, v10
v_mul_f32 v74, v74, v10
v_mul_f32 v75, v75, v10
v_cvt_pk_bf16_f32 v82, v72, v73
v_cvt_pk_bf16_f32 v83, v74, v75
ds_write_b128 v241, v[80:83] offset:5120
v_mul_f32 v68, v68, v11
v_mul_f32 v69, v69, v11
v_mul_f32 v70, v70, v11
v_mul_f32 v71, v71, v11
v_cvt_pk_bf16_f32 v84, v68, v69
v_cvt_pk_bf16_f32 v85, v70, v71
v_mul_f32 v76, v76, v11
v_mul_f32 v77, v77, v11
v_mul_f32 v78, v78, v11
v_mul_f32 v79, v79, v11
v_cvt_pk_bf16_f32 v86, v76, v77
v_cvt_pk_bf16_f32 v87, v78, v79
ds_write_b128 v241, v[84:87] offset:29696
s_waitcnt lgkmcnt(0)
buffer_load_dwordx4 v[104:107], v1, s[4:7], s30 offen offset:2048
buffer_load_dwordx4 v[108:111], v1, s[4:7], s31 offen offset:2048
buffer_load_dwordx4 v[112:115], v1, s[4:7], s32 offen offset:2048
buffer_load_dwordx4 v[116:119], v1, s[4:7], s33 offen offset:2048
buffer_load_dwordx4 v[120:123], v1, s[4:7], s34 offen offset:2048
buffer_load_dwordx4 v[124:127], v1, s[4:7], s35 offen offset:2048
buffer_load_dwordx4 v[128:131], v1, s[4:7], s36 offen offset:2048
buffer_load_dwordx4 v[132:135], v1, s[4:7], s37 offen offset:2048
buffer_load_dwordx4 v[136:139], v1, s[4:7], s38 offen offset:2048
buffer_load_dwordx4 v[140:143], v1, s[4:7], s39 offen offset:2048
buffer_load_dwordx4 v[144:147], v1, s[4:7], s30 offen offset:3072
buffer_load_dwordx4 v[148:151], v1, s[4:7], s31 offen offset:3072
buffer_load_dwordx4 v[152:155], v1, s[4:7], s32 offen offset:3072
buffer_load_dwordx4 v[156:159], v1, s[4:7], s33 offen offset:3072
buffer_load_dwordx4 v[160:163], v1, s[4:7], s34 offen offset:3072
buffer_load_dwordx4 v[164:167], v1, s[4:7], s35 offen offset:3072
buffer_load_dwordx4 v[168:171], v1, s[4:7], s36 offen offset:3072
buffer_load_dwordx4 v[172:175], v1, s[4:7], s37 offen offset:3072
buffer_load_dwordx4 v[176:179], v1, s[4:7], s38 offen offset:3072
buffer_load_dwordx4 v[180:183], v1, s[4:7], s39 offen offset:3072
s_add_u32 s30, s30, 4096
s_add_u32 s31, s31, 4096
s_add_u32 s32, s32, 4096
s_add_u32 s33, s33, 4096
s_add_u32 s34, s34, 4096
s_add_u32 s35, s35, 4096
s_add_u32 s36, s36, 4096
s_add_u32 s37, s37, 4096
s_add_u32 s38, s38, 4096
s_add_u32 s39, s39, 4096
v_add_u32 v6, 49152, v1
s_barrier
ds_read_b128 v[184:187], v1 offset:0
ds_read_b128 v[188:191], v1 offset:24576
ds_read_b128 v[192:195], v6 offset:0
ds_read_b128 v[196:199], v6 offset:24576
s_waitcnt vmcnt(30) lgkmcnt(0)
v_mfma_f32_16x16x32_bf16 a[0:3], a[160:163], v[184:187], 0
v_mfma_f32_16x16x32_bf16 a[4:7], a[160:163], v[188:191], 0
v_mfma_f32_16x16x32_bf16 a[8:11], a[160:163], v[192:195], 0
v_mfma_f32_16x16x32_bf16 a[12:15], a[160:163], v[196:199], 0
ds_read_b128 v[200:203], v1 offset:1024
buffer_load_dwordx4 v[24:27], v1, s[4:7], s30 offen offset:0
v_mfma_f32_16x16x32_bf16 a[16:19], a[164:167], v[184:187], 0
v_mfma_f32_16x16x32_bf16 a[20:23], a[164:167], v[188:191], 0
v_mfma_f32_16x16x32_bf16 a[24:27], a[164:167], v[192:195], 0
v_mfma_f32_16x16x32_bf16 a[28:31], a[164:167], v[196:199], 0
ds_read_b128 v[204:207], v1 offset:25600
buffer_load_dwordx4 v[28:31], v1, s[4:7], s31 offen offset:0
v_mfma_f32_16x16x32_bf16 a[32:35], a[168:171], v[184:187], 0
v_mfma_f32_16x16x32_bf16 a[36:39], a[168:171], v[188:191], 0
v_mfma_f32_16x16x32_bf16 a[40:43], a[168:171], v[192:195], 0
v_mfma_f32_16x16x32_bf16 a[44:47], a[168:171], v[196:199], 0
ds_read_b128 v[208:211], v6 offset:1024
buffer_load_dwordx4 v[32:35], v1, s[4:7], s32 offen offset:0
v_mfma_f32_16x16x32_bf16 a[48:51], a[172:175], v[184:187], 0
v_mfma_f32_16x16x32_bf16 a[52:55], a[172:175], v[188:191], 0
v_mfma_f32_16x16x32_bf16 a[56:59], a[172:175], v[192:195], 0
v_mfma_f32_16x16x32_bf16 a[60:63], a[172:175], v[196:199], 0
ds_read_b128 v[212:215], v6 offset:25600
buffer_load_dwordx4 v[36:39], v1, s[4:7], s33 offen offset:0
v_mfma_f32_16x16x32_bf16 a[64:67], a[176:179], v[184:187], 0
v_mfma_f32_16x16x32_bf16 a[68:71], a[176:179], v[188:191], 0
v_mfma_f32_16x16x32_bf16 a[72:75], a[176:179], v[192:195], 0
v_mfma_f32_16x16x32_bf16 a[76:79], a[176:179], v[196:199], 0
buffer_load_dwordx4 v[40:43], v1, s[4:7], s34 offen offset:0
v_mfma_f32_16x16x32_bf16 a[80:83], a[180:183], v[184:187], 0
v_mfma_f32_16x16x32_bf16 a[84:87], a[180:183], v[188:191], 0
v_mfma_f32_16x16x32_bf16 a[88:91], a[180:183], v[192:195], 0
v_mfma_f32_16x16x32_bf16 a[92:95], a[180:183], v[196:199], 0
buffer_load_dwordx4 v[44:47], v1, s[4:7], s35 offen offset:0
v_mfma_f32_16x16x32_bf16 a[96:99], a[184:187], v[184:187], 0
v_mfma_f32_16x16x32_bf16 a[100:103], a[184:187], v[188:191], 0
v_mfma_f32_16x16x32_bf16 a[104:107], a[184:187], v[192:195], 0
v_mfma_f32_16x16x32_bf16 a[108:111], a[184:187], v[196:199], 0
buffer_load_dwordx4 v[48:51], v1, s[4:7], s36 offen offset:0
v_mfma_f32_16x16x32_bf16 a[112:115], a[188:191], v[184:187], 0
v_mfma_f32_16x16x32_bf16 a[116:119], a[188:191], v[188:191], 0
v_mfma_f32_16x16x32_bf16 a[120:123], a[188:191], v[192:195], 0
v_mfma_f32_16x16x32_bf16 a[124:127], a[188:191], v[196:199], 0
buffer_load_dwordx4 v[52:55], v1, s[4:7], s37 offen offset:0
v_mfma_f32_16x16x32_bf16 a[128:131], a[192:195], v[184:187], 0
v_mfma_f32_16x16x32_bf16 a[132:135], a[192:195], v[188:191], 0
v_mfma_f32_16x16x32_bf16 a[136:139], a[192:195], v[192:195], 0
v_mfma_f32_16x16x32_bf16 a[140:143], a[192:195], v[196:199], 0
buffer_load_dwordx4 v[56:59], v1, s[4:7], s38 offen offset:0
v_mfma_f32_16x16x32_bf16 a[144:147], a[196:199], v[184:187], 0
v_mfma_f32_16x16x32_bf16 a[148:151], a[196:199], v[188:191], 0
v_mfma_f32_16x16x32_bf16 a[152:155], a[196:199], v[192:195], 0
v_mfma_f32_16x16x32_bf16 a[156:159], a[196:199], v[196:199], 0
buffer_load_dwordx4 v[60:63], v1, s[4:7], s39 offen offset:0
s_waitcnt vmcnt(30) lgkmcnt(0)
v_mfma_f32_16x16x32_bf16 a[0:3], a[200:203], v[200:203], a[0:3]
v_mfma_f32_16x16x32_bf16 a[4:7], a[200:203], v[204:207], a[4:7]
v_mfma_f32_16x16x32_bf16 a[8:11], a[200:203], v[208:211], a[8:11]
v_mfma_f32_16x16x32_bf16 a[12:15], a[200:203], v[212:215], a[12:15]
ds_read_b128 v[184:187], v1 offset:2048
buffer_load_dwordx4 v[64:67], v1, s[4:7], s30 offen offset:1024
v_mfma_f32_16x16x32_bf16 a[16:19], a[204:207], v[200:203], a[16:19]
v_mfma_f32_16x16x32_bf16 a[20:23], a[204:207], v[204:207], a[20:23]
v_mfma_f32_16x16x32_bf16 a[24:27], a[204:207], v[208:211], a[24:27]
v_mfma_f32_16x16x32_bf16 a[28:31], a[204:207], v[212:215], a[28:31]
ds_read_b128 v[188:191], v1 offset:26624
buffer_load_dwordx4 v[68:71], v1, s[4:7], s31 offen offset:1024
v_mfma_f32_16x16x32_bf16 a[32:35], a[208:211], v[200:203], a[32:35]
v_mfma_f32_16x16x32_bf16 a[36:39], a[208:211], v[204:207], a[36:39]
v_mfma_f32_16x16x32_bf16 a[40:43], a[208:211], v[208:211], a[40:43]
v_mfma_f32_16x16x32_bf16 a[44:47], a[208:211], v[212:215], a[44:47]
ds_read_b128 v[192:195], v6 offset:2048
buffer_load_dwordx4 v[72:75], v1, s[4:7], s32 offen offset:1024
v_mfma_f32_16x16x32_bf16 a[48:51], a[212:215], v[200:203], a[48:51]
v_mfma_f32_16x16x32_bf16 a[52:55], a[212:215], v[204:207], a[52:55]
v_mfma_f32_16x16x32_bf16 a[56:59], a[212:215], v[208:211], a[56:59]
v_mfma_f32_16x16x32_bf16 a[60:63], a[212:215], v[212:215], a[60:63]
ds_read_b128 v[196:199], v6 offset:26624
buffer_load_dwordx4 v[76:79], v1, s[4:7], s33 offen offset:1024
v_mfma_f32_16x16x32_bf16 a[64:67], a[216:219], v[200:203], a[64:67]
v_mfma_f32_16x16x32_bf16 a[68:71], a[216:219], v[204:207], a[68:71]
v_mfma_f32_16x16x32_bf16 a[72:75], a[216:219], v[208:211], a[72:75]
v_mfma_f32_16x16x32_bf16 a[76:79], a[216:219], v[212:215], a[76:79]
buffer_load_dwordx4 v[80:83], v1, s[4:7], s34 offen offset:1024
v_mfma_f32_16x16x32_bf16 a[80:83], a[220:223], v[200:203], a[80:83]
v_mfma_f32_16x16x32_bf16 a[84:87], a[220:223], v[204:207], a[84:87]
v_mfma_f32_16x16x32_bf16 a[88:91], a[220:223], v[208:211], a[88:91]
v_mfma_f32_16x16x32_bf16 a[92:95], a[220:223], v[212:215], a[92:95]
buffer_load_dwordx4 v[84:87], v1, s[4:7], s35 offen offset:1024
v_mfma_f32_16x16x32_bf16 a[96:99], a[224:227], v[200:203], a[96:99]
v_mfma_f32_16x16x32_bf16 a[100:103], a[224:227], v[204:207], a[100:103]
v_mfma_f32_16x16x32_bf16 a[104:107], a[224:227], v[208:211], a[104:107]
v_mfma_f32_16x16x32_bf16 a[108:111], a[224:227], v[212:215], a[108:111]
buffer_load_dwordx4 v[88:91], v1, s[4:7], s36 offen offset:1024
v_mfma_f32_16x16x32_bf16 a[112:115], a[228:231], v[200:203], a[112:115]
v_mfma_f32_16x16x32_bf16 a[116:119], a[228:231], v[204:207], a[116:119]
v_mfma_f32_16x16x32_bf16 a[120:123], a[228:231], v[208:211], a[120:123]
v_mfma_f32_16x16x32_bf16 a[124:127], a[228:231], v[212:215], a[124:127]
buffer_load_dwordx4 v[92:95], v1, s[4:7], s37 offen offset:1024
v_mfma_f32_16x16x32_bf16 a[128:131], a[232:235], v[200:203], a[128:131]
v_mfma_f32_16x16x32_bf16 a[132:135], a[232:235], v[204:207], a[132:135]
v_mfma_f32_16x16x32_bf16 a[136:139], a[232:235], v[208:211], a[136:139]
v_mfma_f32_16x16x32_bf16 a[140:143], a[232:235], v[212:215], a[140:143]
buffer_load_dwordx4 v[96:99], v1, s[4:7], s38 offen offset:1024
v_mfma_f32_16x16x32_bf16 a[144:147], a[236:239], v[200:203], a[144:147]
v_mfma_f32_16x16x32_bf16 a[148:151], a[236:239], v[204:207], a[148:151]
v_mfma_f32_16x16x32_bf16 a[152:155], a[236:239], v[208:211], a[152:155]
v_mfma_f32_16x16x32_bf16 a[156:159], a[236:239], v[212:215], a[156:159]
buffer_load_dwordx4 v[100:103], v1, s[4:7], s39 offen offset:1024
s_waitcnt vmcnt(30) lgkmcnt(0)
v_mfma_f32_16x16x32_bf16 a[0:3], v[104:107], v[184:187], a[0:3]
v_mfma_f32_16x16x32_bf16 a[4:7], v[104:107], v[188:191], a[4:7]
v_mfma_f32_16x16x32_bf16 a[8:11], v[104:107], v[192:195], a[8:11]
v_mfma_f32_16x16x32_bf16 a[12:15], v[104:107], v[196:199], a[12:15]
ds_read_b128 v[200:203], v1 offset:3072
buffer_load_dwordx4 v[104:107], v1, s[4:7], s30 offen offset:2048
v_mfma_f32_16x16x32_bf16 a[16:19], v[108:111], v[184:187], a[16:19]
v_mfma_f32_16x16x32_bf16 a[20:23], v[108:111], v[188:191], a[20:23]
v_mfma_f32_16x16x32_bf16 a[24:27], v[108:111], v[192:195], a[24:27]
v_mfma_f32_16x16x32_bf16 a[28:31], v[108:111], v[196:199], a[28:31]
ds_read_b128 v[204:207], v1 offset:27648
buffer_load_dwordx4 v[108:111], v1, s[4:7], s31 offen offset:2048
v_mfma_f32_16x16x32_bf16 a[32:35], v[112:115], v[184:187], a[32:35]
v_mfma_f32_16x16x32_bf16 a[36:39], v[112:115], v[188:191], a[36:39]
v_mfma_f32_16x16x32_bf16 a[40:43], v[112:115], v[192:195], a[40:43]
v_mfma_f32_16x16x32_bf16 a[44:47], v[112:115], v[196:199], a[44:47]
ds_read_b128 v[208:211], v6 offset:3072
buffer_load_dwordx4 v[112:115], v1, s[4:7], s32 offen offset:2048
v_mfma_f32_16x16x32_bf16 a[48:51], v[116:119], v[184:187], a[48:51]
v_mfma_f32_16x16x32_bf16 a[52:55], v[116:119], v[188:191], a[52:55]
v_mfma_f32_16x16x32_bf16 a[56:59], v[116:119], v[192:195], a[56:59]
v_mfma_f32_16x16x32_bf16 a[60:63], v[116:119], v[196:199], a[60:63]
ds_read_b128 v[212:215], v6 offset:27648
buffer_load_dwordx4 v[116:119], v1, s[4:7], s33 offen offset:2048
v_mfma_f32_16x16x32_bf16 a[64:67], v[120:123], v[184:187], a[64:67]
v_mfma_f32_16x16x32_bf16 a[68:71], v[120:123], v[188:191], a[68:71]
v_mfma_f32_16x16x32_bf16 a[72:75], v[120:123], v[192:195], a[72:75]
v_mfma_f32_16x16x32_bf16 a[76:79], v[120:123], v[196:199], a[76:79]
buffer_load_dwordx4 v[120:123], v1, s[4:7], s34 offen offset:2048
v_mfma_f32_16x16x32_bf16 a[80:83], v[124:127], v[184:187], a[80:83]
v_mfma_f32_16x16x32_bf16 a[84:87], v[124:127], v[188:191], a[84:87]
v_mfma_f32_16x16x32_bf16 a[88:91], v[124:127], v[192:195], a[88:91]
v_mfma_f32_16x16x32_bf16 a[92:95], v[124:127], v[196:199], a[92:95]
buffer_load_dwordx4 v[124:127], v1, s[4:7], s35 offen offset:2048
v_mfma_f32_16x16x32_bf16 a[96:99], v[128:131], v[184:187], a[96:99]
v_mfma_f32_16x16x32_bf16 a[100:103], v[128:131], v[188:191], a[100:103]
v_mfma_f32_16x16x32_bf16 a[104:107], v[128:131], v[192:195], a[104:107]
v_mfma_f32_16x16x32_bf16 a[108:111], v[128:131], v[196:199], a[108:111]
buffer_load_dwordx4 v[128:131], v1, s[4:7], s36 offen offset:2048
v_mfma_f32_16x16x32_bf16 a[112:115], v[132:135], v[184:187], a[112:115]
v_mfma_f32_16x16x32_bf16 a[116:119], v[132:135], v[188:191], a[116:119]
v_mfma_f32_16x16x32_bf16 a[120:123], v[132:135], v[192:195], a[120:123]
v_mfma_f32_16x16x32_bf16 a[124:127], v[132:135], v[196:199], a[124:127]
buffer_load_dwordx4 v[132:135], v1, s[4:7], s37 offen offset:2048
v_mfma_f32_16x16x32_bf16 a[128:131], v[136:139], v[184:187], a[128:131]
v_mfma_f32_16x16x32_bf16 a[132:135], v[136:139], v[188:191], a[132:135]
v_mfma_f32_16x16x32_bf16 a[136:139], v[136:139], v[192:195], a[136:139]
v_mfma_f32_16x16x32_bf16 a[140:143], v[136:139], v[196:199], a[140:143]
buffer_load_dwordx4 v[136:139], v1, s[4:7], s38 offen offset:2048
v_mfma_f32_16x16x32_bf16 a[144:147], v[140:143], v[184:187], a[144:147]
v_mfma_f32_16x16x32_bf16 a[148:151], v[140:143], v[188:191], a[148:151]
v_mfma_f32_16x16x32_bf16 a[152:155], v[140:143], v[192:195], a[152:155]
v_mfma_f32_16x16x32_bf16 a[156:159], v[140:143], v[196:199], a[156:159]
buffer_load_dwordx4 v[140:143], v1, s[4:7], s39 offen offset:2048
s_waitcnt vmcnt(30) lgkmcnt(0)
v_mfma_f32_16x16x32_bf16 a[0:3], v[144:147], v[200:203], a[0:3]
v_mfma_f32_16x16x32_bf16 a[4:7], v[144:147], v[204:207], a[4:7]
v_mfma_f32_16x16x32_bf16 a[8:11], v[144:147], v[208:211], a[8:11]
v_mfma_f32_16x16x32_bf16 a[12:15], v[144:147], v[212:215], a[12:15]
ds_read_b128 v[184:187], v1 offset:4096
buffer_load_dwordx4 v[144:147], v1, s[4:7], s30 offen offset:3072
s_add_u32 s30, s30, 4096
v_mfma_f32_16x16x32_bf16 a[16:19], v[148:151], v[200:203], a[16:19]
v_mfma_f32_16x16x32_bf16 a[20:23], v[148:151], v[204:207], a[20:23]
v_mfma_f32_16x16x32_bf16 a[24:27], v[148:151], v[208:211], a[24:27]
v_mfma_f32_16x16x32_bf16 a[28:31], v[148:151], v[212:215], a[28:31]
ds_read_b128 v[188:191], v1 offset:28672
buffer_load_dwordx4 v[148:151], v1, s[4:7], s31 offen offset:3072
s_add_u32 s31, s31, 4096
v_mfma_f32_16x16x32_bf16 a[32:35], v[152:155], v[200:203], a[32:35]
v_mfma_f32_16x16x32_bf16 a[36:39], v[152:155], v[204:207], a[36:39]
v_mfma_f32_16x16x32_bf16 a[40:43], v[152:155], v[208:211], a[40:43]
v_mfma_f32_16x16x32_bf16 a[44:47], v[152:155], v[212:215], a[44:47]
ds_read_b128 v[192:195], v6 offset:4096
buffer_load_dwordx4 v[152:155], v1, s[4:7], s32 offen offset:3072
s_add_u32 s32, s32, 4096
v_mfma_f32_16x16x32_bf16 a[48:51], v[156:159], v[200:203], a[48:51]
v_mfma_f32_16x16x32_bf16 a[52:55], v[156:159], v[204:207], a[52:55]
v_mfma_f32_16x16x32_bf16 a[56:59], v[156:159], v[208:211], a[56:59]
v_mfma_f32_16x16x32_bf16 a[60:63], v[156:159], v[212:215], a[60:63]
ds_read_b128 v[196:199], v6 offset:28672
buffer_load_dwordx4 v[156:159], v1, s[4:7], s33 offen offset:3072
s_add_u32 s33, s33, 4096
v_mfma_f32_16x16x32_bf16 a[64:67], v[160:163], v[200:203], a[64:67]
v_mfma_f32_16x16x32_bf16 a[68:71], v[160:163], v[204:207], a[68:71]
v_mfma_f32_16x16x32_bf16 a[72:75], v[160:163], v[208:211], a[72:75]
v_mfma_f32_16x16x32_bf16 a[76:79], v[160:163], v[212:215], a[76:79]
buffer_load_dwordx4 v[160:163], v1, s[4:7], s34 offen offset:3072
s_add_u32 s34, s34, 4096
v_mfma_f32_16x16x32_bf16 a[80:83], v[164:167], v[200:203], a[80:83]
v_mfma_f32_16x16x32_bf16 a[84:87], v[164:167], v[204:207], a[84:87]
v_mfma_f32_16x16x32_bf16 a[88:91], v[164:167], v[208:211], a[88:91]
v_mfma_f32_16x16x32_bf16 a[92:95], v[164:167], v[212:215], a[92:95]
buffer_load_dwordx4 v[164:167], v1, s[4:7], s35 offen offset:3072
s_add_u32 s35, s35, 4096
v_mfma_f32_16x16x32_bf16 a[96:99], v[168:171], v[200:203], a[96:99]
v_mfma_f32_16x16x32_bf16 a[100:103], v[168:171], v[204:207], a[100:103]
v_mfma_f32_16x16x32_bf16 a[104:107], v[168:171], v[208:211], a[104:107]
v_mfma_f32_16x16x32_bf16 a[108:111], v[168:171], v[212:215], a[108:111]
buffer_load_dwordx4 v[168:171], v1, s[4:7], s36 offen offset:3072
s_add_u32 s36, s36, 4096
v_mfma_f32_16x16x32_bf16 a[112:115], v[172:175], v[200:203], a[112:115]
v_mfma_f32_16x16x32_bf16 a[116:119], v[172:175], v[204:207], a[116:119]
v_mfma_f32_16x16x32_bf16 a[120:123], v[172:175], v[208:211], a[120:123]
v_mfma_f32_16x16x32_bf16 a[124:127], v[172:175], v[212:215], a[124:127]
buffer_load_dwordx4 v[172:175], v1, s[4:7], s37 offen offset:3072
s_add_u32 s37, s37, 4096
v_mfma_f32_16x16x32_bf16 a[128:131], v[176:179], v[200:203], a[128:131]
v_mfma_f32_16x16x32_bf16 a[132:135], v[176:179], v[204:207], a[132:135]
v_mfma_f32_16x16x32_bf16 a[136:139], v[176:179], v[208:211], a[136:139]
v_mfma_f32_16x16x32_bf16 a[140:143], v[176:179], v[212:215], a[140:143]
buffer_load_dwordx4 v[176:179], v1, s[4:7], s38 offen offset:3072
s_add_u32 s38, s38, 4096
v_mfma_f32_16x16x32_bf16 a[144:147], v[180:183], v[200:203], a[144:147]
v_mfma_f32_16x16x32_bf16 a[148:151], v[180:183], v[204:207], a[148:151]
v_mfma_f32_16x16x32_bf16 a[152:155], v[180:183], v[208:211], a[152:155]
v_mfma_f32_16x16x32_bf16 a[156:159], v[180:183], v[212:215], a[156:159]
buffer_load_dwordx4 v[180:183], v1, s[4:7], s39 offen offset:3072
s_add_u32 s39, s39, 4096
s_waitcnt vmcnt(30) lgkmcnt(0)
v_mfma_f32_16x16x32_bf16 a[0:3], v[24:27], v[184:187], a[0:3]
v_mfma_f32_16x16x32_bf16 a[4:7], v[24:27], v[188:191], a[4:7]
v_mfma_f32_16x16x32_bf16 a[8:11], v[24:27], v[192:195], a[8:11]
v_mfma_f32_16x16x32_bf16 a[12:15], v[24:27], v[196:199], a[12:15]
ds_read_b128 v[200:203], v1 offset:5120
buffer_load_dwordx4 v[24:27], v1, s[4:7], s30 offen offset:0
v_mfma_f32_16x16x32_bf16 a[16:19], v[28:31], v[184:187], a[16:19]
v_mfma_f32_16x16x32_bf16 a[20:23], v[28:31], v[188:191], a[20:23]
v_mfma_f32_16x16x32_bf16 a[24:27], v[28:31], v[192:195], a[24:27]
v_mfma_f32_16x16x32_bf16 a[28:31], v[28:31], v[196:199], a[28:31]
ds_read_b128 v[204:207], v1 offset:29696
buffer_load_dwordx4 v[28:31], v1, s[4:7], s31 offen offset:0
v_mfma_f32_16x16x32_bf16 a[32:35], v[32:35], v[184:187], a[32:35]
v_mfma_f32_16x16x32_bf16 a[36:39], v[32:35], v[188:191], a[36:39]
v_mfma_f32_16x16x32_bf16 a[40:43], v[32:35], v[192:195], a[40:43]
v_mfma_f32_16x16x32_bf16 a[44:47], v[32:35], v[196:199], a[44:47]
ds_read_b128 v[208:211], v6 offset:5120
buffer_load_dwordx4 v[32:35], v1, s[4:7], s32 offen offset:0
v_mfma_f32_16x16x32_bf16 a[48:51], v[36:39], v[184:187], a[48:51]
v_mfma_f32_16x16x32_bf16 a[52:55], v[36:39], v[188:191], a[52:55]
v_mfma_f32_16x16x32_bf16 a[56:59], v[36:39], v[192:195], a[56:59]
v_mfma_f32_16x16x32_bf16 a[60:63], v[36:39], v[196:199], a[60:63]
ds_read_b128 v[212:215], v6 offset:29696
buffer_load_dwordx4 v[36:39], v1, s[4:7], s33 offen offset:0
v_mfma_f32_16x16x32_bf16 a[64:67], v[40:43], v[184:187], a[64:67]
v_mfma_f32_16x16x32_bf16 a[68:71], v[40:43], v[188:191], a[68:71]
v_mfma_f32_16x16x32_bf16 a[72:75], v[40:43], v[192:195], a[72:75]
v_mfma_f32_16x16x32_bf16 a[76:79], v[40:43], v[196:199], a[76:79]
buffer_load_dwordx4 v[40:43], v1, s[4:7], s34 offen offset:0
v_mfma_f32_16x16x32_bf16 a[80:83], v[44:47], v[184:187], a[80:83]
v_mfma_f32_16x16x32_bf16 a[84:87], v[44:47], v[188:191], a[84:87]
v_mfma_f32_16x16x32_bf16 a[88:91], v[44:47], v[192:195], a[88:91]
v_mfma_f32_16x16x32_bf16 a[92:95], v[44:47], v[196:199], a[92:95]
buffer_load_dwordx4 v[44:47], v1, s[4:7], s35 offen offset:0
v_mfma_f32_16x16x32_bf16 a[96:99], v[48:51], v[184:187], a[96:99]
v_mfma_f32_16x16x32_bf16 a[100:103], v[48:51], v[188:191], a[100:103]
v_mfma_f32_16x16x32_bf16 a[104:107], v[48:51], v[192:195], a[104:107]
v_mfma_f32_16x16x32_bf16 a[108:111], v[48:51], v[196:199], a[108:111]
buffer_load_dwordx4 v[48:51], v1, s[4:7], s36 offen offset:0
v_mfma_f32_16x16x32_bf16 a[112:115], v[52:55], v[184:187], a[112:115]
v_mfma_f32_16x16x32_bf16 a[116:119], v[52:55], v[188:191], a[116:119]
v_mfma_f32_16x16x32_bf16 a[120:123], v[52:55], v[192:195], a[120:123]
v_mfma_f32_16x16x32_bf16 a[124:127], v[52:55], v[196:199], a[124:127]
buffer_load_dwordx4 v[52:55], v1, s[4:7], s37 offen offset:0
v_mfma_f32_16x16x32_bf16 a[128:131], v[56:59], v[184:187], a[128:131]
v_mfma_f32_16x16x32_bf16 a[132:135], v[56:59], v[188:191], a[132:135]
v_mfma_f32_16x16x32_bf16 a[136:139], v[56:59], v[192:195], a[136:139]
v_mfma_f32_16x16x32_bf16 a[140:143], v[56:59], v[196:199], a[140:143]
buffer_load_dwordx4 v[56:59], v1, s[4:7], s38 offen offset:0
v_mfma_f32_16x16x32_bf16 a[144:147], v[60:63], v[184:187], a[144:147]
v_mfma_f32_16x16x32_bf16 a[148:151], v[60:63], v[188:191], a[148:151]
v_mfma_f32_16x16x32_bf16 a[152:155], v[60:63], v[192:195], a[152:155]
v_mfma_f32_16x16x32_bf16 a[156:159], v[60:63], v[196:199], a[156:159]
buffer_load_dwordx4 v[60:63], v1, s[4:7], s39 offen offset:0
s_waitcnt vmcnt(30) lgkmcnt(0)
v_mfma_f32_16x16x32_bf16 a[0:3], v[64:67], v[200:203], a[0:3]
v_mfma_f32_16x16x32_bf16 a[4:7], v[64:67], v[204:207], a[4:7]
v_mfma_f32_16x16x32_bf16 a[8:11], v[64:67], v[208:211], a[8:11]
v_mfma_f32_16x16x32_bf16 a[12:15], v[64:67], v[212:215], a[12:15]
ds_read_b128 v[184:187], v1 offset:6144
buffer_load_dwordx4 v[64:67], v1, s[4:7], s30 offen offset:1024
v_mfma_f32_16x16x32_bf16 a[16:19], v[68:71], v[200:203], a[16:19]
v_mfma_f32_16x16x32_bf16 a[20:23], v[68:71], v[204:207], a[20:23]
v_mfma_f32_16x16x32_bf16 a[24:27], v[68:71], v[208:211], a[24:27]
v_mfma_f32_16x16x32_bf16 a[28:31], v[68:71], v[212:215], a[28:31]
ds_read_b128 v[188:191], v1 offset:30720
buffer_load_dwordx4 v[68:71], v1, s[4:7], s31 offen offset:1024
v_mfma_f32_16x16x32_bf16 a[32:35], v[72:75], v[200:203], a[32:35]
v_mfma_f32_16x16x32_bf16 a[36:39], v[72:75], v[204:207], a[36:39]
v_mfma_f32_16x16x32_bf16 a[40:43], v[72:75], v[208:211], a[40:43]
v_mfma_f32_16x16x32_bf16 a[44:47], v[72:75], v[212:215], a[44:47]
ds_read_b128 v[192:195], v6 offset:6144
buffer_load_dwordx4 v[72:75], v1, s[4:7], s32 offen offset:1024
v_mfma_f32_16x16x32_bf16 a[48:51], v[76:79], v[200:203], a[48:51]
v_mfma_f32_16x16x32_bf16 a[52:55], v[76:79], v[204:207], a[52:55]
v_mfma_f32_16x16x32_bf16 a[56:59], v[76:79], v[208:211], a[56:59]
v_mfma_f32_16x16x32_bf16 a[60:63], v[76:79], v[212:215], a[60:63]
ds_read_b128 v[196:199], v6 offset:30720
buffer_load_dwordx4 v[76:79], v1, s[4:7], s33 offen offset:1024
v_mfma_f32_16x16x32_bf16 a[64:67], v[80:83], v[200:203], a[64:67]
v_mfma_f32_16x16x32_bf16 a[68:71], v[80:83], v[204:207], a[68:71]
v_mfma_f32_16x16x32_bf16 a[72:75], v[80:83], v[208:211], a[72:75]
v_mfma_f32_16x16x32_bf16 a[76:79], v[80:83], v[212:215], a[76:79]
buffer_load_dwordx4 v[80:83], v1, s[4:7], s34 offen offset:1024
v_mfma_f32_16x16x32_bf16 a[80:83], v[84:87], v[200:203], a[80:83]
v_mfma_f32_16x16x32_bf16 a[84:87], v[84:87], v[204:207], a[84:87]
v_mfma_f32_16x16x32_bf16 a[88:91], v[84:87], v[208:211], a[88:91]
v_mfma_f32_16x16x32_bf16 a[92:95], v[84:87], v[212:215], a[92:95]
buffer_load_dwordx4 v[84:87], v1, s[4:7], s35 offen offset:1024
v_mfma_f32_16x16x32_bf16 a[96:99], v[88:91], v[200:203], a[96:99]
v_mfma_f32_16x16x32_bf16 a[100:103], v[88:91], v[204:207], a[100:103]
v_mfma_f32_16x16x32_bf16 a[104:107], v[88:91], v[208:211], a[104:107]
v_mfma_f32_16x16x32_bf16 a[108:111], v[88:91], v[212:215], a[108:111]
buffer_load_dwordx4 v[88:91], v1, s[4:7], s36 offen offset:1024
v_mfma_f32_16x16x32_bf16 a[112:115], v[92:95], v[200:203], a[112:115]
v_mfma_f32_16x16x32_bf16 a[116:119], v[92:95], v[204:207], a[116:119]
v_mfma_f32_16x16x32_bf16 a[120:123], v[92:95], v[208:211], a[120:123]
v_mfma_f32_16x16x32_bf16 a[124:127], v[92:95], v[212:215], a[124:127]
buffer_load_dwordx4 v[92:95], v1, s[4:7], s37 offen offset:1024
v_mfma_f32_16x16x32_bf16 a[128:131], v[96:99], v[200:203], a[128:131]
v_mfma_f32_16x16x32_bf16 a[132:135], v[96:99], v[204:207], a[132:135]
v_mfma_f32_16x16x32_bf16 a[136:139], v[96:99], v[208:211], a[136:139]
v_mfma_f32_16x16x32_bf16 a[140:143], v[96:99], v[212:215], a[140:143]
buffer_load_dwordx4 v[96:99], v1, s[4:7], s38 offen offset:1024
v_mfma_f32_16x16x32_bf16 a[144:147], v[100:103], v[200:203], a[144:147]
v_mfma_f32_16x16x32_bf16 a[148:151], v[100:103], v[204:207], a[148:151]
v_mfma_f32_16x16x32_bf16 a[152:155], v[100:103], v[208:211], a[152:155]
v_mfma_f32_16x16x32_bf16 a[156:159], v[100:103], v[212:215], a[156:159]
buffer_load_dwordx4 v[100:103], v1, s[4:7], s39 offen offset:1024
s_waitcnt vmcnt(30) lgkmcnt(0)
v_mfma_f32_16x16x32_bf16 a[0:3], v[104:107], v[184:187], a[0:3]
v_mfma_f32_16x16x32_bf16 a[4:7], v[104:107], v[188:191], a[4:7]
v_mfma_f32_16x16x32_bf16 a[8:11], v[104:107], v[192:195], a[8:11]
v_mfma_f32_16x16x32_bf16 a[12:15], v[104:107], v[196:199], a[12:15]
ds_read_b128 v[200:203], v1 offset:7168
buffer_load_dwordx4 v[104:107], v1, s[4:7], s30 offen offset:2048
v_mfma_f32_16x16x32_bf16 a[16:19], v[108:111], v[184:187], a[16:19]
v_mfma_f32_16x16x32_bf16 a[20:23], v[108:111], v[188:191], a[20:23]
v_mfma_f32_16x16x32_bf16 a[24:27], v[108:111], v[192:195], a[24:27]
v_mfma_f32_16x16x32_bf16 a[28:31], v[108:111], v[196:199], a[28:31]
ds_read_b128 v[204:207], v1 offset:31744
buffer_load_dwordx4 v[108:111], v1, s[4:7], s31 offen offset:2048
v_mfma_f32_16x16x32_bf16 a[32:35], v[112:115], v[184:187], a[32:35]
v_mfma_f32_16x16x32_bf16 a[36:39], v[112:115], v[188:191], a[36:39]
v_mfma_f32_16x16x32_bf16 a[40:43], v[112:115], v[192:195], a[40:43]
v_mfma_f32_16x16x32_bf16 a[44:47], v[112:115], v[196:199], a[44:47]
ds_read_b128 v[208:211], v6 offset:7168
buffer_load_dwordx4 v[112:115], v1, s[4:7], s32 offen offset:2048
v_mfma_f32_16x16x32_bf16 a[48:51], v[116:119], v[184:187], a[48:51]
v_mfma_f32_16x16x32_bf16 a[52:55], v[116:119], v[188:191], a[52:55]
v_mfma_f32_16x16x32_bf16 a[56:59], v[116:119], v[192:195], a[56:59]
v_mfma_f32_16x16x32_bf16 a[60:63], v[116:119], v[196:199], a[60:63]
ds_read_b128 v[212:215], v6 offset:31744
buffer_load_dwordx4 v[116:119], v1, s[4:7], s33 offen offset:2048
v_mfma_f32_16x16x32_bf16 a[64:67], v[120:123], v[184:187], a[64:67]
v_mfma_f32_16x16x32_bf16 a[68:71], v[120:123], v[188:191], a[68:71]
v_mfma_f32_16x16x32_bf16 a[72:75], v[120:123], v[192:195], a[72:75]
v_mfma_f32_16x16x32_bf16 a[76:79], v[120:123], v[196:199], a[76:79]
buffer_load_dwordx4 v[120:123], v1, s[4:7], s34 offen offset:2048
v_mfma_f32_16x16x32_bf16 a[80:83], v[124:127], v[184:187], a[80:83]
v_mfma_f32_16x16x32_bf16 a[84:87], v[124:127], v[188:191], a[84:87]
v_mfma_f32_16x16x32_bf16 a[88:91], v[124:127], v[192:195], a[88:91]
v_mfma_f32_16x16x32_bf16 a[92:95], v[124:127], v[196:199], a[92:95]
buffer_load_dwordx4 v[124:127], v1, s[4:7], s35 offen offset:2048
v_mfma_f32_16x16x32_bf16 a[96:99], v[128:131], v[184:187], a[96:99]
v_mfma_f32_16x16x32_bf16 a[100:103], v[128:131], v[188:191], a[100:103]
v_mfma_f32_16x16x32_bf16 a[104:107], v[128:131], v[192:195], a[104:107]
v_mfma_f32_16x16x32_bf16 a[108:111], v[128:131], v[196:199], a[108:111]
buffer_load_dwordx4 v[128:131], v1, s[4:7], s36 offen offset:2048
v_mfma_f32_16x16x32_bf16 a[112:115], v[132:135], v[184:187], a[112:115]
v_mfma_f32_16x16x32_bf16 a[116:119], v[132:135], v[188:191], a[116:119]
v_mfma_f32_16x16x32_bf16 a[120:123], v[132:135], v[192:195], a[120:123]
v_mfma_f32_16x16x32_bf16 a[124:127], v[132:135], v[196:199], a[124:127]
buffer_load_dwordx4 v[132:135], v1, s[4:7], s37 offen offset:2048
v_mfma_f32_16x16x32_bf16 a[128:131], v[136:139], v[184:187], a[128:131]
v_mfma_f32_16x16x32_bf16 a[132:135], v[136:139], v[188:191], a[132:135]
v_mfma_f32_16x16x32_bf16 a[136:139], v[136:139], v[192:195], a[136:139]
v_mfma_f32_16x16x32_bf16 a[140:143], v[136:139], v[196:199], a[140:143]
buffer_load_dwordx4 v[136:139], v1, s[4:7], s38 offen offset:2048
v_mfma_f32_16x16x32_bf16 a[144:147], v[140:143], v[184:187], a[144:147]
v_mfma_f32_16x16x32_bf16 a[148:151], v[140:143], v[188:191], a[148:151]
v_mfma_f32_16x16x32_bf16 a[152:155], v[140:143], v[192:195], a[152:155]
v_mfma_f32_16x16x32_bf16 a[156:159], v[140:143], v[196:199], a[156:159]
buffer_load_dwordx4 v[140:143], v1, s[4:7], s39 offen offset:2048
s_waitcnt vmcnt(30) lgkmcnt(0)
v_mfma_f32_16x16x32_bf16 a[0:3], v[144:147], v[200:203], a[0:3]
v_mfma_f32_16x16x32_bf16 a[4:7], v[144:147], v[204:207], a[4:7]
v_mfma_f32_16x16x32_bf16 a[8:11], v[144:147], v[208:211], a[8:11]
v_mfma_f32_16x16x32_bf16 a[12:15], v[144:147], v[212:215], a[12:15]
ds_read_b128 v[184:187], v1 offset:8192
buffer_load_dwordx4 v[144:147], v1, s[4:7], s30 offen offset:3072
s_add_u32 s30, s30, 4096
v_mfma_f32_16x16x32_bf16 a[16:19], v[148:151], v[200:203], a[16:19]
v_mfma_f32_16x16x32_bf16 a[20:23], v[148:151], v[204:207], a[20:23]
v_mfma_f32_16x16x32_bf16 a[24:27], v[148:151], v[208:211], a[24:27]
v_mfma_f32_16x16x32_bf16 a[28:31], v[148:151], v[212:215], a[28:31]
ds_read_b128 v[188:191], v1 offset:32768
buffer_load_dwordx4 v[148:151], v1, s[4:7], s31 offen offset:3072
s_add_u32 s31, s31, 4096
v_mfma_f32_16x16x32_bf16 a[32:35], v[152:155], v[200:203], a[32:35]
v_mfma_f32_16x16x32_bf16 a[36:39], v[152:155], v[204:207], a[36:39]
v_mfma_f32_16x16x32_bf16 a[40:43], v[152:155], v[208:211], a[40:43]
v_mfma_f32_16x16x32_bf16 a[44:47], v[152:155], v[212:215], a[44:47]
ds_read_b128 v[192:195], v6 offset:8192
buffer_load_dwordx4 v[152:155], v1, s[4:7], s32 offen offset:3072
s_add_u32 s32, s32, 4096
v_mfma_f32_16x16x32_bf16 a[48:51], v[156:159], v[200:203], a[48:51]
v_mfma_f32_16x16x32_bf16 a[52:55], v[156:159], v[204:207], a[52:55]
v_mfma_f32_16x16x32_bf16 a[56:59], v[156:159], v[208:211], a[56:59]
v_mfma_f32_16x16x32_bf16 a[60:63], v[156:159], v[212:215], a[60:63]
ds_read_b128 v[196:199], v6 offset:32768
buffer_load_dwordx4 v[156:159], v1, s[4:7], s33 offen offset:3072
s_add_u32 s33, s33, 4096
v_mfma_f32_16x16x32_bf16 a[64:67], v[160:163], v[200:203], a[64:67]
v_mfma_f32_16x16x32_bf16 a[68:71], v[160:163], v[204:207], a[68:71]
v_mfma_f32_16x16x32_bf16 a[72:75], v[160:163], v[208:211], a[72:75]
v_mfma_f32_16x16x32_bf16 a[76:79], v[160:163], v[212:215], a[76:79]
buffer_load_dwordx4 v[160:163], v1, s[4:7], s34 offen offset:3072
s_add_u32 s34, s34, 4096
v_mfma_f32_16x16x32_bf16 a[80:83], v[164:167], v[200:203], a[80:83]
v_mfma_f32_16x16x32_bf16 a[84:87], v[164:167], v[204:207], a[84:87]
v_mfma_f32_16x16x32_bf16 a[88:91], v[164:167], v[208:211], a[88:91]
v_mfma_f32_16x16x32_bf16 a[92:95], v[164:167], v[212:215], a[92:95]
buffer_load_dwordx4 v[164:167], v1, s[4:7], s35 offen offset:3072
s_add_u32 s35, s35, 4096
v_mfma_f32_16x16x32_bf16 a[96:99], v[168:171], v[200:203], a[96:99]
v_mfma_f32_16x16x32_bf16 a[100:103], v[168:171], v[204:207], a[100:103]
v_mfma_f32_16x16x32_bf16 a[104:107], v[168:171], v[208:211], a[104:107]
v_mfma_f32_16x16x32_bf16 a[108:111], v[168:171], v[212:215], a[108:111]
buffer_load_dwordx4 v[168:171], v1, s[4:7], s36 offen offset:3072
s_add_u32 s36, s36, 4096
v_mfma_f32_16x16x32_bf16 a[112:115], v[172:175], v[200:203], a[112:115]
v_mfma_f32_16x16x32_bf16 a[116:119], v[172:175], v[204:207], a[116:119]
v_mfma_f32_16x16x32_bf16 a[120:123], v[172:175], v[208:211], a[120:123]
v_mfma_f32_16x16x32_bf16 a[124:127], v[172:175], v[212:215], a[124:127]
buffer_load_dwordx4 v[172:175], v1, s[4:7], s37 offen offset:3072
s_add_u32 s37, s37, 4096
v_mfma_f32_16x16x32_bf16 a[128:131], v[176:179], v[200:203], a[128:131]
v_mfma_f32_16x16x32_bf16 a[132:135], v[176:179], v[204:207], a[132:135]
v_mfma_f32_16x16x32_bf16 a[136:139], v[176:179], v[208:211], a[136:139]
v_mfma_f32_16x16x32_bf16 a[140:143], v[176:179], v[212:215], a[140:143]
buffer_load_dwordx4 v[176:179], v1, s[4:7], s38 offen offset:3072
s_add_u32 s38, s38, 4096
v_mfma_f32_16x16x32_bf16 a[144:147], v[180:183], v[200:203], a[144:147]
v_mfma_f32_16x16x32_bf16 a[148:151], v[180:183], v[204:207], a[148:151]
v_mfma_f32_16x16x32_bf16 a[152:155], v[180:183], v[208:211], a[152:155]
v_mfma_f32_16x16x32_bf16 a[156:159], v[180:183], v[212:215], a[156:159]
buffer_load_dwordx4 v[180:183], v1, s[4:7], s39 offen offset:3072
s_add_u32 s39, s39, 4096
s_waitcnt vmcnt(30) lgkmcnt(0)
v_mfma_f32_16x16x32_bf16 a[0:3], v[24:27], v[184:187], a[0:3]
v_mfma_f32_16x16x32_bf16 a[4:7], v[24:27], v[188:191], a[4:7]
v_mfma_f32_16x16x32_bf16 a[8:11], v[24:27], v[192:195], a[8:11]
v_mfma_f32_16x16x32_bf16 a[12:15], v[24:27], v[196:199], a[12:15]
ds_read_b128 v[200:203], v1 offset:9216
buffer_load_dwordx4 v[24:27], v1, s[4:7], s30 offen offset:0
v_mfma_f32_16x16x32_bf16 a[16:19], v[28:31], v[184:187], a[16:19]
v_mfma_f32_16x16x32_bf16 a[20:23], v[28:31], v[188:191], a[20:23]
v_mfma_f32_16x16x32_bf16 a[24:27], v[28:31], v[192:195], a[24:27]
v_mfma_f32_16x16x32_bf16 a[28:31], v[28:31], v[196:199], a[28:31]
ds_read_b128 v[204:207], v1 offset:33792
buffer_load_dwordx4 v[28:31], v1, s[4:7], s31 offen offset:0
v_mfma_f32_16x16x32_bf16 a[32:35], v[32:35], v[184:187], a[32:35]
v_mfma_f32_16x16x32_bf16 a[36:39], v[32:35], v[188:191], a[36:39]
v_mfma_f32_16x16x32_bf16 a[40:43], v[32:35], v[192:195], a[40:43]
v_mfma_f32_16x16x32_bf16 a[44:47], v[32:35], v[196:199], a[44:47]
ds_read_b128 v[208:211], v6 offset:9216
buffer_load_dwordx4 v[32:35], v1, s[4:7], s32 offen offset:0
v_mfma_f32_16x16x32_bf16 a[48:51], v[36:39], v[184:187], a[48:51]
v_mfma_f32_16x16x32_bf16 a[52:55], v[36:39], v[188:191], a[52:55]
v_mfma_f32_16x16x32_bf16 a[56:59], v[36:39], v[192:195], a[56:59]
v_mfma_f32_16x16x32_bf16 a[60:63], v[36:39], v[196:199], a[60:63]
ds_read_b128 v[212:215], v6 offset:33792
buffer_load_dwordx4 v[36:39], v1, s[4:7], s33 offen offset:0
v_mfma_f32_16x16x32_bf16 a[64:67], v[40:43], v[184:187], a[64:67]
v_mfma_f32_16x16x32_bf16 a[68:71], v[40:43], v[188:191], a[68:71]
v_mfma_f32_16x16x32_bf16 a[72:75], v[40:43], v[192:195], a[72:75]
v_mfma_f32_16x16x32_bf16 a[76:79], v[40:43], v[196:199], a[76:79]
buffer_load_dwordx4 v[40:43], v1, s[4:7], s34 offen offset:0
v_mfma_f32_16x16x32_bf16 a[80:83], v[44:47], v[184:187], a[80:83]
v_mfma_f32_16x16x32_bf16 a[84:87], v[44:47], v[188:191], a[84:87]
v_mfma_f32_16x16x32_bf16 a[88:91], v[44:47], v[192:195], a[88:91]
v_mfma_f32_16x16x32_bf16 a[92:95], v[44:47], v[196:199], a[92:95]
buffer_load_dwordx4 v[44:47], v1, s[4:7], s35 offen offset:0
v_mfma_f32_16x16x32_bf16 a[96:99], v[48:51], v[184:187], a[96:99]
v_mfma_f32_16x16x32_bf16 a[100:103], v[48:51], v[188:191], a[100:103]
v_mfma_f32_16x16x32_bf16 a[104:107], v[48:51], v[192:195], a[104:107]
v_mfma_f32_16x16x32_bf16 a[108:111], v[48:51], v[196:199], a[108:111]
buffer_load_dwordx4 v[48:51], v1, s[4:7], s36 offen offset:0
v_mfma_f32_16x16x32_bf16 a[112:115], v[52:55], v[184:187], a[112:115]
v_mfma_f32_16x16x32_bf16 a[116:119], v[52:55], v[188:191], a[116:119]
v_mfma_f32_16x16x32_bf16 a[120:123], v[52:55], v[192:195], a[120:123]
v_mfma_f32_16x16x32_bf16 a[124:127], v[52:55], v[196:199], a[124:127]
buffer_load_dwordx4 v[52:55], v1, s[4:7], s37 offen offset:0
v_mfma_f32_16x16x32_bf16 a[128:131], v[56:59], v[184:187], a[128:131]
v_mfma_f32_16x16x32_bf16 a[132:135], v[56:59], v[188:191], a[132:135]
v_mfma_f32_16x16x32_bf16 a[136:139], v[56:59], v[192:195], a[136:139]
v_mfma_f32_16x16x32_bf16 a[140:143], v[56:59], v[196:199], a[140:143]
buffer_load_dwordx4 v[56:59], v1, s[4:7], s38 offen offset:0
v_mfma_f32_16x16x32_bf16 a[144:147], v[60:63], v[184:187], a[144:147]
v_mfma_f32_16x16x32_bf16 a[148:151], v[60:63], v[188:191], a[148:151]
v_mfma_f32_16x16x32_bf16 a[152:155], v[60:63], v[192:195], a[152:155]
v_mfma_f32_16x16x32_bf16 a[156:159], v[60:63], v[196:199], a[156:159]
buffer_load_dwordx4 v[60:63], v1, s[4:7], s39 offen offset:0
s_waitcnt vmcnt(30) lgkmcnt(0)
v_mfma_f32_16x16x32_bf16 a[0:3], v[64:67], v[200:203], a[0:3]
v_mfma_f32_16x16x32_bf16 a[4:7], v[64:67], v[204:207], a[4:7]
v_mfma_f32_16x16x32_bf16 a[8:11], v[64:67], v[208:211], a[8:11]
v_mfma_f32_16x16x32_bf16 a[12:15], v[64:67], v[212:215], a[12:15]
ds_read_b128 v[184:187], v1 offset:10240
buffer_load_dwordx4 v[64:67], v1, s[4:7], s30 offen offset:1024
v_mfma_f32_16x16x32_bf16 a[16:19], v[68:71], v[200:203], a[16:19]
v_mfma_f32_16x16x32_bf16 a[20:23], v[68:71], v[204:207], a[20:23]
v_mfma_f32_16x16x32_bf16 a[24:27], v[68:71], v[208:211], a[24:27]
v_mfma_f32_16x16x32_bf16 a[28:31], v[68:71], v[212:215], a[28:31]
ds_read_b128 v[188:191], v1 offset:34816
buffer_load_dwordx4 v[68:71], v1, s[4:7], s31 offen offset:1024
v_mfma_f32_16x16x32_bf16 a[32:35], v[72:75], v[200:203], a[32:35]
v_mfma_f32_16x16x32_bf16 a[36:39], v[72:75], v[204:207], a[36:39]
v_mfma_f32_16x16x32_bf16 a[40:43], v[72:75], v[208:211], a[40:43]
v_mfma_f32_16x16x32_bf16 a[44:47], v[72:75], v[212:215], a[44:47]
ds_read_b128 v[192:195], v6 offset:10240
buffer_load_dwordx4 v[72:75], v1, s[4:7], s32 offen offset:1024
v_mfma_f32_16x16x32_bf16 a[48:51], v[76:79], v[200:203], a[48:51]
v_mfma_f32_16x16x32_bf16 a[52:55], v[76:79], v[204:207], a[52:55]
v_mfma_f32_16x16x32_bf16 a[56:59], v[76:79], v[208:211], a[56:59]
v_mfma_f32_16x16x32_bf16 a[60:63], v[76:79], v[212:215], a[60:63]
ds_read_b128 v[196:199], v6 offset:34816
buffer_load_dwordx4 v[76:79], v1, s[4:7], s33 offen offset:1024
v_mfma_f32_16x16x32_bf16 a[64:67], v[80:83], v[200:203], a[64:67]
v_mfma_f32_16x16x32_bf16 a[68:71], v[80:83], v[204:207], a[68:71]
v_mfma_f32_16x16x32_bf16 a[72:75], v[80:83], v[208:211], a[72:75]
v_mfma_f32_16x16x32_bf16 a[76:79], v[80:83], v[212:215], a[76:79]
buffer_load_dwordx4 v[80:83], v1, s[4:7], s34 offen offset:1024
v_mfma_f32_16x16x32_bf16 a[80:83], v[84:87], v[200:203], a[80:83]
v_mfma_f32_16x16x32_bf16 a[84:87], v[84:87], v[204:207], a[84:87]
v_mfma_f32_16x16x32_bf16 a[88:91], v[84:87], v[208:211], a[88:91]
v_mfma_f32_16x16x32_bf16 a[92:95], v[84:87], v[212:215], a[92:95]
buffer_load_dwordx4 v[84:87], v1, s[4:7], s35 offen offset:1024
v_mfma_f32_16x16x32_bf16 a[96:99], v[88:91], v[200:203], a[96:99]
v_mfma_f32_16x16x32_bf16 a[100:103], v[88:91], v[204:207], a[100:103]
v_mfma_f32_16x16x32_bf16 a[104:107], v[88:91], v[208:211], a[104:107]
v_mfma_f32_16x16x32_bf16 a[108:111], v[88:91], v[212:215], a[108:111]
buffer_load_dwordx4 v[88:91], v1, s[4:7], s36 offen offset:1024
v_mfma_f32_16x16x32_bf16 a[112:115], v[92:95], v[200:203], a[112:115]
v_mfma_f32_16x16x32_bf16 a[116:119], v[92:95], v[204:207], a[116:119]
v_mfma_f32_16x16x32_bf16 a[120:123], v[92:95], v[208:211], a[120:123]
v_mfma_f32_16x16x32_bf16 a[124:127], v[92:95], v[212:215], a[124:127]
buffer_load_dwordx4 v[92:95], v1, s[4:7], s37 offen offset:1024
v_mfma_f32_16x16x32_bf16 a[128:131], v[96:99], v[200:203], a[128:131]
v_mfma_f32_16x16x32_bf16 a[132:135], v[96:99], v[204:207], a[132:135]
v_mfma_f32_16x16x32_bf16 a[136:139], v[96:99], v[208:211], a[136:139]
v_mfma_f32_16x16x32_bf16 a[140:143], v[96:99], v[212:215], a[140:143]
buffer_load_dwordx4 v[96:99], v1, s[4:7], s38 offen offset:1024
v_mfma_f32_16x16x32_bf16 a[144:147], v[100:103], v[200:203], a[144:147]
v_mfma_f32_16x16x32_bf16 a[148:151], v[100:103], v[204:207], a[148:151]
v_mfma_f32_16x16x32_bf16 a[152:155], v[100:103], v[208:211], a[152:155]
v_mfma_f32_16x16x32_bf16 a[156:159], v[100:103], v[212:215], a[156:159]
buffer_load_dwordx4 v[100:103], v1, s[4:7], s39 offen offset:1024
s_waitcnt vmcnt(30) lgkmcnt(0)
v_mfma_f32_16x16x32_bf16 a[0:3], v[104:107], v[184:187], a[0:3]
v_mfma_f32_16x16x32_bf16 a[4:7], v[104:107], v[188:191], a[4:7]
v_mfma_f32_16x16x32_bf16 a[8:11], v[104:107], v[192:195], a[8:11]
v_mfma_f32_16x16x32_bf16 a[12:15], v[104:107], v[196:199], a[12:15]
ds_read_b128 v[200:203], v1 offset:11264
buffer_load_dwordx4 v[104:107], v1, s[4:7], s30 offen offset:2048
v_mfma_f32_16x16x32_bf16 a[16:19], v[108:111], v[184:187], a[16:19]
v_mfma_f32_16x16x32_bf16 a[20:23], v[108:111], v[188:191], a[20:23]
v_mfma_f32_16x16x32_bf16 a[24:27], v[108:111], v[192:195], a[24:27]
v_mfma_f32_16x16x32_bf16 a[28:31], v[108:111], v[196:199], a[28:31]
ds_read_b128 v[204:207], v1 offset:35840
buffer_load_dwordx4 v[108:111], v1, s[4:7], s31 offen offset:2048
v_mfma_f32_16x16x32_bf16 a[32:35], v[112:115], v[184:187], a[32:35]
v_mfma_f32_16x16x32_bf16 a[36:39], v[112:115], v[188:191], a[36:39]
v_mfma_f32_16x16x32_bf16 a[40:43], v[112:115], v[192:195], a[40:43]
v_mfma_f32_16x16x32_bf16 a[44:47], v[112:115], v[196:199], a[44:47]
ds_read_b128 v[208:211], v6 offset:11264
buffer_load_dwordx4 v[112:115], v1, s[4:7], s32 offen offset:2048
v_mfma_f32_16x16x32_bf16 a[48:51], v[116:119], v[184:187], a[48:51]
v_mfma_f32_16x16x32_bf16 a[52:55], v[116:119], v[188:191], a[52:55]
v_mfma_f32_16x16x32_bf16 a[56:59], v[116:119], v[192:195], a[56:59]
v_mfma_f32_16x16x32_bf16 a[60:63], v[116:119], v[196:199], a[60:63]
ds_read_b128 v[212:215], v6 offset:35840
buffer_load_dwordx4 v[116:119], v1, s[4:7], s33 offen offset:2048
v_mfma_f32_16x16x32_bf16 a[64:67], v[120:123], v[184:187], a[64:67]
v_mfma_f32_16x16x32_bf16 a[68:71], v[120:123], v[188:191], a[68:71]
v_mfma_f32_16x16x32_bf16 a[72:75], v[120:123], v[192:195], a[72:75]
v_mfma_f32_16x16x32_bf16 a[76:79], v[120:123], v[196:199], a[76:79]
buffer_load_dwordx4 v[120:123], v1, s[4:7], s34 offen offset:2048
v_mfma_f32_16x16x32_bf16 a[80:83], v[124:127], v[184:187], a[80:83]
v_mfma_f32_16x16x32_bf16 a[84:87], v[124:127], v[188:191], a[84:87]
v_mfma_f32_16x16x32_bf16 a[88:91], v[124:127], v[192:195], a[88:91]
v_mfma_f32_16x16x32_bf16 a[92:95], v[124:127], v[196:199], a[92:95]
buffer_load_dwordx4 v[124:127], v1, s[4:7], s35 offen offset:2048
v_mfma_f32_16x16x32_bf16 a[96:99], v[128:131], v[184:187], a[96:99]
v_mfma_f32_16x16x32_bf16 a[100:103], v[128:131], v[188:191], a[100:103]
v_mfma_f32_16x16x32_bf16 a[104:107], v[128:131], v[192:195], a[104:107]
v_mfma_f32_16x16x32_bf16 a[108:111], v[128:131], v[196:199], a[108:111]
buffer_load_dwordx4 v[128:131], v1, s[4:7], s36 offen offset:2048
v_mfma_f32_16x16x32_bf16 a[112:115], v[132:135], v[184:187], a[112:115]
v_mfma_f32_16x16x32_bf16 a[116:119], v[132:135], v[188:191], a[116:119]
v_mfma_f32_16x16x32_bf16 a[120:123], v[132:135], v[192:195], a[120:123]
v_mfma_f32_16x16x32_bf16 a[124:127], v[132:135], v[196:199], a[124:127]
buffer_load_dwordx4 v[132:135], v1, s[4:7], s37 offen offset:2048
v_mfma_f32_16x16x32_bf16 a[128:131], v[136:139], v[184:187], a[128:131]
v_mfma_f32_16x16x32_bf16 a[132:135], v[136:139], v[188:191], a[132:135]
v_mfma_f32_16x16x32_bf16 a[136:139], v[136:139], v[192:195], a[136:139]
v_mfma_f32_16x16x32_bf16 a[140:143], v[136:139], v[196:199], a[140:143]
buffer_load_dwordx4 v[136:139], v1, s[4:7], s38 offen offset:2048
v_mfma_f32_16x16x32_bf16 a[144:147], v[140:143], v[184:187], a[144:147]
v_mfma_f32_16x16x32_bf16 a[148:151], v[140:143], v[188:191], a[148:151]
v_mfma_f32_16x16x32_bf16 a[152:155], v[140:143], v[192:195], a[152:155]
v_mfma_f32_16x16x32_bf16 a[156:159], v[140:143], v[196:199], a[156:159]
buffer_load_dwordx4 v[140:143], v1, s[4:7], s39 offen offset:2048
s_waitcnt vmcnt(30) lgkmcnt(0)
v_mfma_f32_16x16x32_bf16 a[0:3], v[144:147], v[200:203], a[0:3]
v_mfma_f32_16x16x32_bf16 a[4:7], v[144:147], v[204:207], a[4:7]
v_mfma_f32_16x16x32_bf16 a[8:11], v[144:147], v[208:211], a[8:11]
v_mfma_f32_16x16x32_bf16 a[12:15], v[144:147], v[212:215], a[12:15]
ds_read_b128 v[184:187], v1 offset:12288
buffer_load_dwordx4 v[144:147], v1, s[4:7], s30 offen offset:3072
s_add_u32 s30, s30, 4096
v_mfma_f32_16x16x32_bf16 a[16:19], v[148:151], v[200:203], a[16:19]
v_mfma_f32_16x16x32_bf16 a[20:23], v[148:151], v[204:207], a[20:23]
v_mfma_f32_16x16x32_bf16 a[24:27], v[148:151], v[208:211], a[24:27]
v_mfma_f32_16x16x32_bf16 a[28:31], v[148:151], v[212:215], a[28:31]
ds_read_b128 v[188:191], v1 offset:36864
buffer_load_dwordx4 v[148:151], v1, s[4:7], s31 offen offset:3072
s_add_u32 s31, s31, 4096
v_mfma_f32_16x16x32_bf16 a[32:35], v[152:155], v[200:203], a[32:35]
v_mfma_f32_16x16x32_bf16 a[36:39], v[152:155], v[204:207], a[36:39]
v_mfma_f32_16x16x32_bf16 a[40:43], v[152:155], v[208:211], a[40:43]
v_mfma_f32_16x16x32_bf16 a[44:47], v[152:155], v[212:215], a[44:47]
ds_read_b128 v[192:195], v6 offset:12288
buffer_load_dwordx4 v[152:155], v1, s[4:7], s32 offen offset:3072
s_add_u32 s32, s32, 4096
v_mfma_f32_16x16x32_bf16 a[48:51], v[156:159], v[200:203], a[48:51]
v_mfma_f32_16x16x32_bf16 a[52:55], v[156:159], v[204:207], a[52:55]
v_mfma_f32_16x16x32_bf16 a[56:59], v[156:159], v[208:211], a[56:59]
v_mfma_f32_16x16x32_bf16 a[60:63], v[156:159], v[212:215], a[60:63]
ds_read_b128 v[196:199], v6 offset:36864
buffer_load_dwordx4 v[156:159], v1, s[4:7], s33 offen offset:3072
s_add_u32 s33, s33, 4096
v_mfma_f32_16x16x32_bf16 a[64:67], v[160:163], v[200:203], a[64:67]
v_mfma_f32_16x16x32_bf16 a[68:71], v[160:163], v[204:207], a[68:71]
v_mfma_f32_16x16x32_bf16 a[72:75], v[160:163], v[208:211], a[72:75]
v_mfma_f32_16x16x32_bf16 a[76:79], v[160:163], v[212:215], a[76:79]
buffer_load_dwordx4 v[160:163], v1, s[4:7], s34 offen offset:3072
s_add_u32 s34, s34, 4096
v_mfma_f32_16x16x32_bf16 a[80:83], v[164:167], v[200:203], a[80:83]
v_mfma_f32_16x16x32_bf16 a[84:87], v[164:167], v[204:207], a[84:87]
v_mfma_f32_16x16x32_bf16 a[88:91], v[164:167], v[208:211], a[88:91]
v_mfma_f32_16x16x32_bf16 a[92:95], v[164:167], v[212:215], a[92:95]
buffer_load_dwordx4 v[164:167], v1, s[4:7], s35 offen offset:3072
s_add_u32 s35, s35, 4096
v_mfma_f32_16x16x32_bf16 a[96:99], v[168:171], v[200:203], a[96:99]
v_mfma_f32_16x16x32_bf16 a[100:103], v[168:171], v[204:207], a[100:103]
v_mfma_f32_16x16x32_bf16 a[104:107], v[168:171], v[208:211], a[104:107]
v_mfma_f32_16x16x32_bf16 a[108:111], v[168:171], v[212:215], a[108:111]
buffer_load_dwordx4 v[168:171], v1, s[4:7], s36 offen offset:3072
s_add_u32 s36, s36, 4096
v_mfma_f32_16x16x32_bf16 a[112:115], v[172:175], v[200:203], a[112:115]
v_mfma_f32_16x16x32_bf16 a[116:119], v[172:175], v[204:207], a[116:119]
v_mfma_f32_16x16x32_bf16 a[120:123], v[172:175], v[208:211], a[120:123]
v_mfma_f32_16x16x32_bf16 a[124:127], v[172:175], v[212:215], a[124:127]
buffer_load_dwordx4 v[172:175], v1, s[4:7], s37 offen offset:3072
s_add_u32 s37, s37, 4096
v_mfma_f32_16x16x32_bf16 a[128:131], v[176:179], v[200:203], a[128:131]
v_mfma_f32_16x16x32_bf16 a[132:135], v[176:179], v[204:207], a[132:135]
v_mfma_f32_16x16x32_bf16 a[136:139], v[176:179], v[208:211], a[136:139]
v_mfma_f32_16x16x32_bf16 a[140:143], v[176:179], v[212:215], a[140:143]
buffer_load_dwordx4 v[176:179], v1, s[4:7], s38 offen offset:3072
s_add_u32 s38, s38, 4096
v_mfma_f32_16x16x32_bf16 a[144:147], v[180:183], v[200:203], a[144:147]
v_mfma_f32_16x16x32_bf16 a[148:151], v[180:183], v[204:207], a[148:151]
v_mfma_f32_16x16x32_bf16 a[152:155], v[180:183], v[208:211], a[152:155]
v_mfma_f32_16x16x32_bf16 a[156:159], v[180:183], v[212:215], a[156:159]
buffer_load_dwordx4 v[180:183], v1, s[4:7], s39 offen offset:3072
s_add_u32 s39, s39, 4096
s_waitcnt vmcnt(30) lgkmcnt(0)
v_mfma_f32_16x16x32_bf16 a[0:3], v[24:27], v[184:187], a[0:3]
v_mfma_f32_16x16x32_bf16 a[4:7], v[24:27], v[188:191], a[4:7]
v_mfma_f32_16x16x32_bf16 a[8:11], v[24:27], v[192:195], a[8:11]
v_mfma_f32_16x16x32_bf16 a[12:15], v[24:27], v[196:199], a[12:15]
ds_read_b128 v[200:203], v1 offset:13312
buffer_load_dwordx4 v[24:27], v1, s[4:7], s30 offen offset:0
v_mfma_f32_16x16x32_bf16 a[16:19], v[28:31], v[184:187], a[16:19]
v_mfma_f32_16x16x32_bf16 a[20:23], v[28:31], v[188:191], a[20:23]
v_mfma_f32_16x16x32_bf16 a[24:27], v[28:31], v[192:195], a[24:27]
v_mfma_f32_16x16x32_bf16 a[28:31], v[28:31], v[196:199], a[28:31]
ds_read_b128 v[204:207], v1 offset:37888
buffer_load_dwordx4 v[28:31], v1, s[4:7], s31 offen offset:0
v_mfma_f32_16x16x32_bf16 a[32:35], v[32:35], v[184:187], a[32:35]
v_mfma_f32_16x16x32_bf16 a[36:39], v[32:35], v[188:191], a[36:39]
v_mfma_f32_16x16x32_bf16 a[40:43], v[32:35], v[192:195], a[40:43]
v_mfma_f32_16x16x32_bf16 a[44:47], v[32:35], v[196:199], a[44:47]
ds_read_b128 v[208:211], v6 offset:13312
buffer_load_dwordx4 v[32:35], v1, s[4:7], s32 offen offset:0
v_mfma_f32_16x16x32_bf16 a[48:51], v[36:39], v[184:187], a[48:51]
v_mfma_f32_16x16x32_bf16 a[52:55], v[36:39], v[188:191], a[52:55]
v_mfma_f32_16x16x32_bf16 a[56:59], v[36:39], v[192:195], a[56:59]
v_mfma_f32_16x16x32_bf16 a[60:63], v[36:39], v[196:199], a[60:63]
ds_read_b128 v[212:215], v6 offset:37888
buffer_load_dwordx4 v[36:39], v1, s[4:7], s33 offen offset:0
v_mfma_f32_16x16x32_bf16 a[64:67], v[40:43], v[184:187], a[64:67]
v_mfma_f32_16x16x32_bf16 a[68:71], v[40:43], v[188:191], a[68:71]
v_mfma_f32_16x16x32_bf16 a[72:75], v[40:43], v[192:195], a[72:75]
v_mfma_f32_16x16x32_bf16 a[76:79], v[40:43], v[196:199], a[76:79]
buffer_load_dwordx4 v[40:43], v1, s[4:7], s34 offen offset:0
v_mfma_f32_16x16x32_bf16 a[80:83], v[44:47], v[184:187], a[80:83]
v_mfma_f32_16x16x32_bf16 a[84:87], v[44:47], v[188:191], a[84:87]
v_mfma_f32_16x16x32_bf16 a[88:91], v[44:47], v[192:195], a[88:91]
v_mfma_f32_16x16x32_bf16 a[92:95], v[44:47], v[196:199], a[92:95]
buffer_load_dwordx4 v[44:47], v1, s[4:7], s35 offen offset:0
v_mfma_f32_16x16x32_bf16 a[96:99], v[48:51], v[184:187], a[96:99]
v_mfma_f32_16x16x32_bf16 a[100:103], v[48:51], v[188:191], a[100:103]
v_mfma_f32_16x16x32_bf16 a[104:107], v[48:51], v[192:195], a[104:107]
v_mfma_f32_16x16x32_bf16 a[108:111], v[48:51], v[196:199], a[108:111]
buffer_load_dwordx4 v[48:51], v1, s[4:7], s36 offen offset:0
v_mfma_f32_16x16x32_bf16 a[112:115], v[52:55], v[184:187], a[112:115]
v_mfma_f32_16x16x32_bf16 a[116:119], v[52:55], v[188:191], a[116:119]
v_mfma_f32_16x16x32_bf16 a[120:123], v[52:55], v[192:195], a[120:123]
v_mfma_f32_16x16x32_bf16 a[124:127], v[52:55], v[196:199], a[124:127]
buffer_load_dwordx4 v[52:55], v1, s[4:7], s37 offen offset:0
v_mfma_f32_16x16x32_bf16 a[128:131], v[56:59], v[184:187], a[128:131]
v_mfma_f32_16x16x32_bf16 a[132:135], v[56:59], v[188:191], a[132:135]
v_mfma_f32_16x16x32_bf16 a[136:139], v[56:59], v[192:195], a[136:139]
v_mfma_f32_16x16x32_bf16 a[140:143], v[56:59], v[196:199], a[140:143]
buffer_load_dwordx4 v[56:59], v1, s[4:7], s38 offen offset:0
v_mfma_f32_16x16x32_bf16 a[144:147], v[60:63], v[184:187], a[144:147]
v_mfma_f32_16x16x32_bf16 a[148:151], v[60:63], v[188:191], a[148:151]
v_mfma_f32_16x16x32_bf16 a[152:155], v[60:63], v[192:195], a[152:155]
v_mfma_f32_16x16x32_bf16 a[156:159], v[60:63], v[196:199], a[156:159]
buffer_load_dwordx4 v[60:63], v1, s[4:7], s39 offen offset:0
s_waitcnt vmcnt(30) lgkmcnt(0)
v_mfma_f32_16x16x32_bf16 a[0:3], v[64:67], v[200:203], a[0:3]
v_mfma_f32_16x16x32_bf16 a[4:7], v[64:67], v[204:207], a[4:7]
v_mfma_f32_16x16x32_bf16 a[8:11], v[64:67], v[208:211], a[8:11]
v_mfma_f32_16x16x32_bf16 a[12:15], v[64:67], v[212:215], a[12:15]
ds_read_b128 v[184:187], v1 offset:14336
buffer_load_dwordx4 v[64:67], v1, s[4:7], s30 offen offset:1024
v_mfma_f32_16x16x32_bf16 a[16:19], v[68:71], v[200:203], a[16:19]
v_mfma_f32_16x16x32_bf16 a[20:23], v[68:71], v[204:207], a[20:23]
v_mfma_f32_16x16x32_bf16 a[24:27], v[68:71], v[208:211], a[24:27]
v_mfma_f32_16x16x32_bf16 a[28:31], v[68:71], v[212:215], a[28:31]
ds_read_b128 v[188:191], v1 offset:38912
buffer_load_dwordx4 v[68:71], v1, s[4:7], s31 offen offset:1024
v_mfma_f32_16x16x32_bf16 a[32:35], v[72:75], v[200:203], a[32:35]
v_mfma_f32_16x16x32_bf16 a[36:39], v[72:75], v[204:207], a[36:39]
v_mfma_f32_16x16x32_bf16 a[40:43], v[72:75], v[208:211], a[40:43]
v_mfma_f32_16x16x32_bf16 a[44:47], v[72:75], v[212:215], a[44:47]
ds_read_b128 v[192:195], v6 offset:14336
buffer_load_dwordx4 v[72:75], v1, s[4:7], s32 offen offset:1024
v_mfma_f32_16x16x32_bf16 a[48:51], v[76:79], v[200:203], a[48:51]
v_mfma_f32_16x16x32_bf16 a[52:55], v[76:79], v[204:207], a[52:55]
v_mfma_f32_16x16x32_bf16 a[56:59], v[76:79], v[208:211], a[56:59]
v_mfma_f32_16x16x32_bf16 a[60:63], v[76:79], v[212:215], a[60:63]
ds_read_b128 v[196:199], v6 offset:38912
buffer_load_dwordx4 v[76:79], v1, s[4:7], s33 offen offset:1024
v_mfma_f32_16x16x32_bf16 a[64:67], v[80:83], v[200:203], a[64:67]
v_mfma_f32_16x16x32_bf16 a[68:71], v[80:83], v[204:207], a[68:71]
v_mfma_f32_16x16x32_bf16 a[72:75], v[80:83], v[208:211], a[72:75]
v_mfma_f32_16x16x32_bf16 a[76:79], v[80:83], v[212:215], a[76:79]
buffer_load_dwordx4 v[80:83], v1, s[4:7], s34 offen offset:1024
v_mfma_f32_16x16x32_bf16 a[80:83], v[84:87], v[200:203], a[80:83]
v_mfma_f32_16x16x32_bf16 a[84:87], v[84:87], v[204:207], a[84:87]
v_mfma_f32_16x16x32_bf16 a[88:91], v[84:87], v[208:211], a[88:91]
v_mfma_f32_16x16x32_bf16 a[92:95], v[84:87], v[212:215], a[92:95]
buffer_load_dwordx4 v[84:87], v1, s[4:7], s35 offen offset:1024
v_mfma_f32_16x16x32_bf16 a[96:99], v[88:91], v[200:203], a[96:99]
v_mfma_f32_16x16x32_bf16 a[100:103], v[88:91], v[204:207], a[100:103]
v_mfma_f32_16x16x32_bf16 a[104:107], v[88:91], v[208:211], a[104:107]
v_mfma_f32_16x16x32_bf16 a[108:111], v[88:91], v[212:215], a[108:111]
buffer_load_dwordx4 v[88:91], v1, s[4:7], s36 offen offset:1024
v_mfma_f32_16x16x32_bf16 a[112:115], v[92:95], v[200:203], a[112:115]
v_mfma_f32_16x16x32_bf16 a[116:119], v[92:95], v[204:207], a[116:119]
v_mfma_f32_16x16x32_bf16 a[120:123], v[92:95], v[208:211], a[120:123]
v_mfma_f32_16x16x32_bf16 a[124:127], v[92:95], v[212:215], a[124:127]
buffer_load_dwordx4 v[92:95], v1, s[4:7], s37 offen offset:1024
v_mfma_f32_16x16x32_bf16 a[128:131], v[96:99], v[200:203], a[128:131]
v_mfma_f32_16x16x32_bf16 a[132:135], v[96:99], v[204:207], a[132:135]
v_mfma_f32_16x16x32_bf16 a[136:139], v[96:99], v[208:211], a[136:139]
v_mfma_f32_16x16x32_bf16 a[140:143], v[96:99], v[212:215], a[140:143]
buffer_load_dwordx4 v[96:99], v1, s[4:7], s38 offen offset:1024
v_mfma_f32_16x16x32_bf16 a[144:147], v[100:103], v[200:203], a[144:147]
v_mfma_f32_16x16x32_bf16 a[148:151], v[100:103], v[204:207], a[148:151]
v_mfma_f32_16x16x32_bf16 a[152:155], v[100:103], v[208:211], a[152:155]
v_mfma_f32_16x16x32_bf16 a[156:159], v[100:103], v[212:215], a[156:159]
buffer_load_dwordx4 v[100:103], v1, s[4:7], s39 offen offset:1024
s_waitcnt vmcnt(30) lgkmcnt(0)
v_mfma_f32_16x16x32_bf16 a[0:3], v[104:107], v[184:187], a[0:3]
v_mfma_f32_16x16x32_bf16 a[4:7], v[104:107], v[188:191], a[4:7]
v_mfma_f32_16x16x32_bf16 a[8:11], v[104:107], v[192:195], a[8:11]
v_mfma_f32_16x16x32_bf16 a[12:15], v[104:107], v[196:199], a[12:15]
ds_read_b128 v[200:203], v1 offset:15360
buffer_load_dwordx4 v[104:107], v1, s[4:7], s30 offen offset:2048
v_mfma_f32_16x16x32_bf16 a[16:19], v[108:111], v[184:187], a[16:19]
v_mfma_f32_16x16x32_bf16 a[20:23], v[108:111], v[188:191], a[20:23]
v_mfma_f32_16x16x32_bf16 a[24:27], v[108:111], v[192:195], a[24:27]
v_mfma_f32_16x16x32_bf16 a[28:31], v[108:111], v[196:199], a[28:31]
ds_read_b128 v[204:207], v1 offset:39936
buffer_load_dwordx4 v[108:111], v1, s[4:7], s31 offen offset:2048
v_mfma_f32_16x16x32_bf16 a[32:35], v[112:115], v[184:187], a[32:35]
v_mfma_f32_16x16x32_bf16 a[36:39], v[112:115], v[188:191], a[36:39]
v_mfma_f32_16x16x32_bf16 a[40:43], v[112:115], v[192:195], a[40:43]
v_mfma_f32_16x16x32_bf16 a[44:47], v[112:115], v[196:199], a[44:47]
ds_read_b128 v[208:211], v6 offset:15360
buffer_load_dwordx4 v[112:115], v1, s[4:7], s32 offen offset:2048
v_mfma_f32_16x16x32_bf16 a[48:51], v[116:119], v[184:187], a[48:51]
v_mfma_f32_16x16x32_bf16 a[52:55], v[116:119], v[188:191], a[52:55]
v_mfma_f32_16x16x32_bf16 a[56:59], v[116:119], v[192:195], a[56:59]
v_mfma_f32_16x16x32_bf16 a[60:63], v[116:119], v[196:199], a[60:63]
ds_read_b128 v[212:215], v6 offset:39936
buffer_load_dwordx4 v[116:119], v1, s[4:7], s33 offen offset:2048
v_mfma_f32_16x16x32_bf16 a[64:67], v[120:123], v[184:187], a[64:67]
v_mfma_f32_16x16x32_bf16 a[68:71], v[120:123], v[188:191], a[68:71]
v_mfma_f32_16x16x32_bf16 a[72:75], v[120:123], v[192:195], a[72:75]
v_mfma_f32_16x16x32_bf16 a[76:79], v[120:123], v[196:199], a[76:79]
buffer_load_dwordx4 v[120:123], v1, s[4:7], s34 offen offset:2048
v_mfma_f32_16x16x32_bf16 a[80:83], v[124:127], v[184:187], a[80:83]
v_mfma_f32_16x16x32_bf16 a[84:87], v[124:127], v[188:191], a[84:87]
v_mfma_f32_16x16x32_bf16 a[88:91], v[124:127], v[192:195], a[88:91]
v_mfma_f32_16x16x32_bf16 a[92:95], v[124:127], v[196:199], a[92:95]
buffer_load_dwordx4 v[124:127], v1, s[4:7], s35 offen offset:2048
v_mfma_f32_16x16x32_bf16 a[96:99], v[128:131], v[184:187], a[96:99]
v_mfma_f32_16x16x32_bf16 a[100:103], v[128:131], v[188:191], a[100:103]
v_mfma_f32_16x16x32_bf16 a[104:107], v[128:131], v[192:195], a[104:107]
v_mfma_f32_16x16x32_bf16 a[108:111], v[128:131], v[196:199], a[108:111]
buffer_load_dwordx4 v[128:131], v1, s[4:7], s36 offen offset:2048
v_mfma_f32_16x16x32_bf16 a[112:115], v[132:135], v[184:187], a[112:115]
v_mfma_f32_16x16x32_bf16 a[116:119], v[132:135], v[188:191], a[116:119]
v_mfma_f32_16x16x32_bf16 a[120:123], v[132:135], v[192:195], a[120:123]
v_mfma_f32_16x16x32_bf16 a[124:127], v[132:135], v[196:199], a[124:127]
buffer_load_dwordx4 v[132:135], v1, s[4:7], s37 offen offset:2048
v_mfma_f32_16x16x32_bf16 a[128:131], v[136:139], v[184:187], a[128:131]
v_mfma_f32_16x16x32_bf16 a[132:135], v[136:139], v[188:191], a[132:135]
v_mfma_f32_16x16x32_bf16 a[136:139], v[136:139], v[192:195], a[136:139]
v_mfma_f32_16x16x32_bf16 a[140:143], v[136:139], v[196:199], a[140:143]
buffer_load_dwordx4 v[136:139], v1, s[4:7], s38 offen offset:2048
v_mfma_f32_16x16x32_bf16 a[144:147], v[140:143], v[184:187], a[144:147]
v_mfma_f32_16x16x32_bf16 a[148:151], v[140:143], v[188:191], a[148:151]
v_mfma_f32_16x16x32_bf16 a[152:155], v[140:143], v[192:195], a[152:155]
v_mfma_f32_16x16x32_bf16 a[156:159], v[140:143], v[196:199], a[156:159]
buffer_load_dwordx4 v[140:143], v1, s[4:7], s39 offen offset:2048
s_waitcnt vmcnt(30) lgkmcnt(0)
v_mfma_f32_16x16x32_bf16 a[0:3], v[144:147], v[200:203], a[0:3]
v_mfma_f32_16x16x32_bf16 a[4:7], v[144:147], v[204:207], a[4:7]
v_mfma_f32_16x16x32_bf16 a[8:11], v[144:147], v[208:211], a[8:11]
v_mfma_f32_16x16x32_bf16 a[12:15], v[144:147], v[212:215], a[12:15]
ds_read_b128 v[184:187], v1 offset:16384
buffer_load_dwordx4 v[144:147], v1, s[4:7], s30 offen offset:3072
s_add_u32 s30, s30, 4096
v_mfma_f32_16x16x32_bf16 a[16:19], v[148:151], v[200:203], a[16:19]
v_mfma_f32_16x16x32_bf16 a[20:23], v[148:151], v[204:207], a[20:23]
v_mfma_f32_16x16x32_bf16 a[24:27], v[148:151], v[208:211], a[24:27]
v_mfma_f32_16x16x32_bf16 a[28:31], v[148:151], v[212:215], a[28:31]
ds_read_b128 v[188:191], v1 offset:40960
buffer_load_dwordx4 v[148:151], v1, s[4:7], s31 offen offset:3072
s_add_u32 s31, s31, 4096
v_mfma_f32_16x16x32_bf16 a[32:35], v[152:155], v[200:203], a[32:35]
v_mfma_f32_16x16x32_bf16 a[36:39], v[152:155], v[204:207], a[36:39]
v_mfma_f32_16x16x32_bf16 a[40:43], v[152:155], v[208:211], a[40:43]
v_mfma_f32_16x16x32_bf16 a[44:47], v[152:155], v[212:215], a[44:47]
ds_read_b128 v[192:195], v6 offset:16384
buffer_load_dwordx4 v[152:155], v1, s[4:7], s32 offen offset:3072
s_add_u32 s32, s32, 4096
v_mfma_f32_16x16x32_bf16 a[48:51], v[156:159], v[200:203], a[48:51]
v_mfma_f32_16x16x32_bf16 a[52:55], v[156:159], v[204:207], a[52:55]
v_mfma_f32_16x16x32_bf16 a[56:59], v[156:159], v[208:211], a[56:59]
v_mfma_f32_16x16x32_bf16 a[60:63], v[156:159], v[212:215], a[60:63]
ds_read_b128 v[196:199], v6 offset:40960
buffer_load_dwordx4 v[156:159], v1, s[4:7], s33 offen offset:3072
s_add_u32 s33, s33, 4096
v_mfma_f32_16x16x32_bf16 a[64:67], v[160:163], v[200:203], a[64:67]
v_mfma_f32_16x16x32_bf16 a[68:71], v[160:163], v[204:207], a[68:71]
v_mfma_f32_16x16x32_bf16 a[72:75], v[160:163], v[208:211], a[72:75]
v_mfma_f32_16x16x32_bf16 a[76:79], v[160:163], v[212:215], a[76:79]
buffer_load_dwordx4 v[160:163], v1, s[4:7], s34 offen offset:3072
s_add_u32 s34, s34, 4096
v_mfma_f32_16x16x32_bf16 a[80:83], v[164:167], v[200:203], a[80:83]
v_mfma_f32_16x16x32_bf16 a[84:87], v[164:167], v[204:207], a[84:87]
v_mfma_f32_16x16x32_bf16 a[88:91], v[164:167], v[208:211], a[88:91]
v_mfma_f32_16x16x32_bf16 a[92:95], v[164:167], v[212:215], a[92:95]
buffer_load_dwordx4 v[164:167], v1, s[4:7], s35 offen offset:3072
s_add_u32 s35, s35, 4096
v_mfma_f32_16x16x32_bf16 a[96:99], v[168:171], v[200:203], a[96:99]
v_mfma_f32_16x16x32_bf16 a[100:103], v[168:171], v[204:207], a[100:103]
v_mfma_f32_16x16x32_bf16 a[104:107], v[168:171], v[208:211], a[104:107]
v_mfma_f32_16x16x32_bf16 a[108:111], v[168:171], v[212:215], a[108:111]
buffer_load_dwordx4 v[168:171], v1, s[4:7], s36 offen offset:3072
s_add_u32 s36, s36, 4096
v_mfma_f32_16x16x32_bf16 a[112:115], v[172:175], v[200:203], a[112:115]
v_mfma_f32_16x16x32_bf16 a[116:119], v[172:175], v[204:207], a[116:119]
v_mfma_f32_16x16x32_bf16 a[120:123], v[172:175], v[208:211], a[120:123]
v_mfma_f32_16x16x32_bf16 a[124:127], v[172:175], v[212:215], a[124:127]
buffer_load_dwordx4 v[172:175], v1, s[4:7], s37 offen offset:3072
s_add_u32 s37, s37, 4096
v_mfma_f32_16x16x32_bf16 a[128:131], v[176:179], v[200:203], a[128:131]
v_mfma_f32_16x16x32_bf16 a[132:135], v[176:179], v[204:207], a[132:135]
v_mfma_f32_16x16x32_bf16 a[136:139], v[176:179], v[208:211], a[136:139]
v_mfma_f32_16x16x32_bf16 a[140:143], v[176:179], v[212:215], a[140:143]
buffer_load_dwordx4 v[176:179], v1, s[4:7], s38 offen offset:3072
s_add_u32 s38, s38, 4096
v_mfma_f32_16x16x32_bf16 a[144:147], v[180:183], v[200:203], a[144:147]
v_mfma_f32_16x16x32_bf16 a[148:151], v[180:183], v[204:207], a[148:151]
v_mfma_f32_16x16x32_bf16 a[152:155], v[180:183], v[208:211], a[152:155]
v_mfma_f32_16x16x32_bf16 a[156:159], v[180:183], v[212:215], a[156:159]
buffer_load_dwordx4 v[180:183], v1, s[4:7], s39 offen offset:3072
s_add_u32 s39, s39, 4096
s_waitcnt vmcnt(30) lgkmcnt(0)
v_mfma_f32_16x16x32_bf16 a[0:3], v[24:27], v[184:187], a[0:3]
v_mfma_f32_16x16x32_bf16 a[4:7], v[24:27], v[188:191], a[4:7]
v_mfma_f32_16x16x32_bf16 a[8:11], v[24:27], v[192:195], a[8:11]
v_mfma_f32_16x16x32_bf16 a[12:15], v[24:27], v[196:199], a[12:15]
ds_read_b128 v[200:203], v1 offset:17408
buffer_load_dwordx4 v[24:27], v1, s[4:7], s30 offen offset:0
v_mfma_f32_16x16x32_bf16 a[16:19], v[28:31], v[184:187], a[16:19]
v_mfma_f32_16x16x32_bf16 a[20:23], v[28:31], v[188:191], a[20:23]
v_mfma_f32_16x16x32_bf16 a[24:27], v[28:31], v[192:195], a[24:27]
v_mfma_f32_16x16x32_bf16 a[28:31], v[28:31], v[196:199], a[28:31]
ds_read_b128 v[204:207], v1 offset:41984
buffer_load_dwordx4 v[28:31], v1, s[4:7], s31 offen offset:0
v_mfma_f32_16x16x32_bf16 a[32:35], v[32:35], v[184:187], a[32:35]
v_mfma_f32_16x16x32_bf16 a[36:39], v[32:35], v[188:191], a[36:39]
v_mfma_f32_16x16x32_bf16 a[40:43], v[32:35], v[192:195], a[40:43]
v_mfma_f32_16x16x32_bf16 a[44:47], v[32:35], v[196:199], a[44:47]
ds_read_b128 v[208:211], v6 offset:17408
buffer_load_dwordx4 v[32:35], v1, s[4:7], s32 offen offset:0
v_mfma_f32_16x16x32_bf16 a[48:51], v[36:39], v[184:187], a[48:51]
v_mfma_f32_16x16x32_bf16 a[52:55], v[36:39], v[188:191], a[52:55]
v_mfma_f32_16x16x32_bf16 a[56:59], v[36:39], v[192:195], a[56:59]
v_mfma_f32_16x16x32_bf16 a[60:63], v[36:39], v[196:199], a[60:63]
ds_read_b128 v[212:215], v6 offset:41984
buffer_load_dwordx4 v[36:39], v1, s[4:7], s33 offen offset:0
v_mfma_f32_16x16x32_bf16 a[64:67], v[40:43], v[184:187], a[64:67]
v_mfma_f32_16x16x32_bf16 a[68:71], v[40:43], v[188:191], a[68:71]
v_mfma_f32_16x16x32_bf16 a[72:75], v[40:43], v[192:195], a[72:75]
v_mfma_f32_16x16x32_bf16 a[76:79], v[40:43], v[196:199], a[76:79]
buffer_load_dwordx4 v[40:43], v1, s[4:7], s34 offen offset:0
v_mfma_f32_16x16x32_bf16 a[80:83], v[44:47], v[184:187], a[80:83]
v_mfma_f32_16x16x32_bf16 a[84:87], v[44:47], v[188:191], a[84:87]
v_mfma_f32_16x16x32_bf16 a[88:91], v[44:47], v[192:195], a[88:91]
v_mfma_f32_16x16x32_bf16 a[92:95], v[44:47], v[196:199], a[92:95]
buffer_load_dwordx4 v[44:47], v1, s[4:7], s35 offen offset:0
v_mfma_f32_16x16x32_bf16 a[96:99], v[48:51], v[184:187], a[96:99]
v_mfma_f32_16x16x32_bf16 a[100:103], v[48:51], v[188:191], a[100:103]
v_mfma_f32_16x16x32_bf16 a[104:107], v[48:51], v[192:195], a[104:107]
v_mfma_f32_16x16x32_bf16 a[108:111], v[48:51], v[196:199], a[108:111]
buffer_load_dwordx4 v[48:51], v1, s[4:7], s36 offen offset:0
v_mfma_f32_16x16x32_bf16 a[112:115], v[52:55], v[184:187], a[112:115]
v_mfma_f32_16x16x32_bf16 a[116:119], v[52:55], v[188:191], a[116:119]
v_mfma_f32_16x16x32_bf16 a[120:123], v[52:55], v[192:195], a[120:123]
v_mfma_f32_16x16x32_bf16 a[124:127], v[52:55], v[196:199], a[124:127]
buffer_load_dwordx4 v[52:55], v1, s[4:7], s37 offen offset:0
v_mfma_f32_16x16x32_bf16 a[128:131], v[56:59], v[184:187], a[128:131]
v_mfma_f32_16x16x32_bf16 a[132:135], v[56:59], v[188:191], a[132:135]
v_mfma_f32_16x16x32_bf16 a[136:139], v[56:59], v[192:195], a[136:139]
v_mfma_f32_16x16x32_bf16 a[140:143], v[56:59], v[196:199], a[140:143]
buffer_load_dwordx4 v[56:59], v1, s[4:7], s38 offen offset:0
v_mfma_f32_16x16x32_bf16 a[144:147], v[60:63], v[184:187], a[144:147]
v_mfma_f32_16x16x32_bf16 a[148:151], v[60:63], v[188:191], a[148:151]
v_mfma_f32_16x16x32_bf16 a[152:155], v[60:63], v[192:195], a[152:155]
v_mfma_f32_16x16x32_bf16 a[156:159], v[60:63], v[196:199], a[156:159]
buffer_load_dwordx4 v[60:63], v1, s[4:7], s39 offen offset:0
s_waitcnt vmcnt(30) lgkmcnt(0)
v_mfma_f32_16x16x32_bf16 a[0:3], v[64:67], v[200:203], a[0:3]
v_mfma_f32_16x16x32_bf16 a[4:7], v[64:67], v[204:207], a[4:7]
v_mfma_f32_16x16x32_bf16 a[8:11], v[64:67], v[208:211], a[8:11]
v_mfma_f32_16x16x32_bf16 a[12:15], v[64:67], v[212:215], a[12:15]
ds_read_b128 v[184:187], v1 offset:18432
buffer_load_dwordx4 v[64:67], v1, s[4:7], s30 offen offset:1024
v_mfma_f32_16x16x32_bf16 a[16:19], v[68:71], v[200:203], a[16:19]
v_mfma_f32_16x16x32_bf16 a[20:23], v[68:71], v[204:207], a[20:23]
v_mfma_f32_16x16x32_bf16 a[24:27], v[68:71], v[208:211], a[24:27]
v_mfma_f32_16x16x32_bf16 a[28:31], v[68:71], v[212:215], a[28:31]
ds_read_b128 v[188:191], v1 offset:43008
buffer_load_dwordx4 v[68:71], v1, s[4:7], s31 offen offset:1024
v_mfma_f32_16x16x32_bf16 a[32:35], v[72:75], v[200:203], a[32:35]
v_mfma_f32_16x16x32_bf16 a[36:39], v[72:75], v[204:207], a[36:39]
v_mfma_f32_16x16x32_bf16 a[40:43], v[72:75], v[208:211], a[40:43]
v_mfma_f32_16x16x32_bf16 a[44:47], v[72:75], v[212:215], a[44:47]
ds_read_b128 v[192:195], v6 offset:18432
buffer_load_dwordx4 v[72:75], v1, s[4:7], s32 offen offset:1024
v_mfma_f32_16x16x32_bf16 a[48:51], v[76:79], v[200:203], a[48:51]
v_mfma_f32_16x16x32_bf16 a[52:55], v[76:79], v[204:207], a[52:55]
v_mfma_f32_16x16x32_bf16 a[56:59], v[76:79], v[208:211], a[56:59]
v_mfma_f32_16x16x32_bf16 a[60:63], v[76:79], v[212:215], a[60:63]
ds_read_b128 v[196:199], v6 offset:43008
buffer_load_dwordx4 v[76:79], v1, s[4:7], s33 offen offset:1024
v_mfma_f32_16x16x32_bf16 a[64:67], v[80:83], v[200:203], a[64:67]
v_mfma_f32_16x16x32_bf16 a[68:71], v[80:83], v[204:207], a[68:71]
v_mfma_f32_16x16x32_bf16 a[72:75], v[80:83], v[208:211], a[72:75]
v_mfma_f32_16x16x32_bf16 a[76:79], v[80:83], v[212:215], a[76:79]
buffer_load_dwordx4 v[80:83], v1, s[4:7], s34 offen offset:1024
v_mfma_f32_16x16x32_bf16 a[80:83], v[84:87], v[200:203], a[80:83]
v_mfma_f32_16x16x32_bf16 a[84:87], v[84:87], v[204:207], a[84:87]
v_mfma_f32_16x16x32_bf16 a[88:91], v[84:87], v[208:211], a[88:91]
v_mfma_f32_16x16x32_bf16 a[92:95], v[84:87], v[212:215], a[92:95]
buffer_load_dwordx4 v[84:87], v1, s[4:7], s35 offen offset:1024
v_mfma_f32_16x16x32_bf16 a[96:99], v[88:91], v[200:203], a[96:99]
v_mfma_f32_16x16x32_bf16 a[100:103], v[88:91], v[204:207], a[100:103]
v_mfma_f32_16x16x32_bf16 a[104:107], v[88:91], v[208:211], a[104:107]
v_mfma_f32_16x16x32_bf16 a[108:111], v[88:91], v[212:215], a[108:111]
buffer_load_dwordx4 v[88:91], v1, s[4:7], s36 offen offset:1024
v_mfma_f32_16x16x32_bf16 a[112:115], v[92:95], v[200:203], a[112:115]
v_mfma_f32_16x16x32_bf16 a[116:119], v[92:95], v[204:207], a[116:119]
v_mfma_f32_16x16x32_bf16 a[120:123], v[92:95], v[208:211], a[120:123]
v_mfma_f32_16x16x32_bf16 a[124:127], v[92:95], v[212:215], a[124:127]
buffer_load_dwordx4 v[92:95], v1, s[4:7], s37 offen offset:1024
v_mfma_f32_16x16x32_bf16 a[128:131], v[96:99], v[200:203], a[128:131]
v_mfma_f32_16x16x32_bf16 a[132:135], v[96:99], v[204:207], a[132:135]
v_mfma_f32_16x16x32_bf16 a[136:139], v[96:99], v[208:211], a[136:139]
v_mfma_f32_16x16x32_bf16 a[140:143], v[96:99], v[212:215], a[140:143]
buffer_load_dwordx4 v[96:99], v1, s[4:7], s38 offen offset:1024
v_mfma_f32_16x16x32_bf16 a[144:147], v[100:103], v[200:203], a[144:147]
v_mfma_f32_16x16x32_bf16 a[148:151], v[100:103], v[204:207], a[148:151]
v_mfma_f32_16x16x32_bf16 a[152:155], v[100:103], v[208:211], a[152:155]
v_mfma_f32_16x16x32_bf16 a[156:159], v[100:103], v[212:215], a[156:159]
buffer_load_dwordx4 v[100:103], v1, s[4:7], s39 offen offset:1024
s_waitcnt vmcnt(30) lgkmcnt(0)
v_mfma_f32_16x16x32_bf16 a[0:3], v[104:107], v[184:187], a[0:3]
v_mfma_f32_16x16x32_bf16 a[4:7], v[104:107], v[188:191], a[4:7]
v_mfma_f32_16x16x32_bf16 a[8:11], v[104:107], v[192:195], a[8:11]
v_mfma_f32_16x16x32_bf16 a[12:15], v[104:107], v[196:199], a[12:15]
ds_read_b128 v[200:203], v1 offset:19456
buffer_load_dwordx4 v[104:107], v1, s[4:7], s30 offen offset:2048
v_mfma_f32_16x16x32_bf16 a[16:19], v[108:111], v[184:187], a[16:19]
v_mfma_f32_16x16x32_bf16 a[20:23], v[108:111], v[188:191], a[20:23]
v_mfma_f32_16x16x32_bf16 a[24:27], v[108:111], v[192:195], a[24:27]
v_mfma_f32_16x16x32_bf16 a[28:31], v[108:111], v[196:199], a[28:31]
ds_read_b128 v[204:207], v1 offset:44032
buffer_load_dwordx4 v[108:111], v1, s[4:7], s31 offen offset:2048
v_mfma_f32_16x16x32_bf16 a[32:35], v[112:115], v[184:187], a[32:35]
v_mfma_f32_16x16x32_bf16 a[36:39], v[112:115], v[188:191], a[36:39]
v_mfma_f32_16x16x32_bf16 a[40:43], v[112:115], v[192:195], a[40:43]
v_mfma_f32_16x16x32_bf16 a[44:47], v[112:115], v[196:199], a[44:47]
ds_read_b128 v[208:211], v6 offset:19456
buffer_load_dwordx4 v[112:115], v1, s[4:7], s32 offen offset:2048
v_mfma_f32_16x16x32_bf16 a[48:51], v[116:119], v[184:187], a[48:51]
v_mfma_f32_16x16x32_bf16 a[52:55], v[116:119], v[188:191], a[52:55]
v_mfma_f32_16x16x32_bf16 a[56:59], v[116:119], v[192:195], a[56:59]
v_mfma_f32_16x16x32_bf16 a[60:63], v[116:119], v[196:199], a[60:63]
ds_read_b128 v[212:215], v6 offset:44032
buffer_load_dwordx4 v[116:119], v1, s[4:7], s33 offen offset:2048
v_mfma_f32_16x16x32_bf16 a[64:67], v[120:123], v[184:187], a[64:67]
v_mfma_f32_16x16x32_bf16 a[68:71], v[120:123], v[188:191], a[68:71]
v_mfma_f32_16x16x32_bf16 a[72:75], v[120:123], v[192:195], a[72:75]
v_mfma_f32_16x16x32_bf16 a[76:79], v[120:123], v[196:199], a[76:79]
buffer_load_dwordx4 v[120:123], v1, s[4:7], s34 offen offset:2048
v_mfma_f32_16x16x32_bf16 a[80:83], v[124:127], v[184:187], a[80:83]
v_mfma_f32_16x16x32_bf16 a[84:87], v[124:127], v[188:191], a[84:87]
v_mfma_f32_16x16x32_bf16 a[88:91], v[124:127], v[192:195], a[88:91]
v_mfma_f32_16x16x32_bf16 a[92:95], v[124:127], v[196:199], a[92:95]
buffer_load_dwordx4 v[124:127], v1, s[4:7], s35 offen offset:2048
v_mfma_f32_16x16x32_bf16 a[96:99], v[128:131], v[184:187], a[96:99]
v_mfma_f32_16x16x32_bf16 a[100:103], v[128:131], v[188:191], a[100:103]
v_mfma_f32_16x16x32_bf16 a[104:107], v[128:131], v[192:195], a[104:107]
v_mfma_f32_16x16x32_bf16 a[108:111], v[128:131], v[196:199], a[108:111]
buffer_load_dwordx4 v[128:131], v1, s[4:7], s36 offen offset:2048
v_mfma_f32_16x16x32_bf16 a[112:115], v[132:135], v[184:187], a[112:115]
v_mfma_f32_16x16x32_bf16 a[116:119], v[132:135], v[188:191], a[116:119]
v_mfma_f32_16x16x32_bf16 a[120:123], v[132:135], v[192:195], a[120:123]
v_mfma_f32_16x16x32_bf16 a[124:127], v[132:135], v[196:199], a[124:127]
buffer_load_dwordx4 v[132:135], v1, s[4:7], s37 offen offset:2048
v_mfma_f32_16x16x32_bf16 a[128:131], v[136:139], v[184:187], a[128:131]
v_mfma_f32_16x16x32_bf16 a[132:135], v[136:139], v[188:191], a[132:135]
v_mfma_f32_16x16x32_bf16 a[136:139], v[136:139], v[192:195], a[136:139]
v_mfma_f32_16x16x32_bf16 a[140:143], v[136:139], v[196:199], a[140:143]
buffer_load_dwordx4 v[136:139], v1, s[4:7], s38 offen offset:2048
v_mfma_f32_16x16x32_bf16 a[144:147], v[140:143], v[184:187], a[144:147]
v_mfma_f32_16x16x32_bf16 a[148:151], v[140:143], v[188:191], a[148:151]
v_mfma_f32_16x16x32_bf16 a[152:155], v[140:143], v[192:195], a[152:155]
v_mfma_f32_16x16x32_bf16 a[156:159], v[140:143], v[196:199], a[156:159]
buffer_load_dwordx4 v[140:143], v1, s[4:7], s39 offen offset:2048
s_waitcnt vmcnt(30) lgkmcnt(0)
v_mfma_f32_16x16x32_bf16 a[0:3], v[144:147], v[200:203], a[0:3]
v_mfma_f32_16x16x32_bf16 a[4:7], v[144:147], v[204:207], a[4:7]
v_mfma_f32_16x16x32_bf16 a[8:11], v[144:147], v[208:211], a[8:11]
v_mfma_f32_16x16x32_bf16 a[12:15], v[144:147], v[212:215], a[12:15]
ds_read_b128 v[184:187], v1 offset:20480
buffer_load_dwordx4 v[144:147], v1, s[4:7], s30 offen offset:3072
s_add_u32 s30, s30, 4096
v_mfma_f32_16x16x32_bf16 a[16:19], v[148:151], v[200:203], a[16:19]
v_mfma_f32_16x16x32_bf16 a[20:23], v[148:151], v[204:207], a[20:23]
v_mfma_f32_16x16x32_bf16 a[24:27], v[148:151], v[208:211], a[24:27]
v_mfma_f32_16x16x32_bf16 a[28:31], v[148:151], v[212:215], a[28:31]
ds_read_b128 v[188:191], v1 offset:45056
buffer_load_dwordx4 v[148:151], v1, s[4:7], s31 offen offset:3072
s_add_u32 s31, s31, 4096
v_mfma_f32_16x16x32_bf16 a[32:35], v[152:155], v[200:203], a[32:35]
v_mfma_f32_16x16x32_bf16 a[36:39], v[152:155], v[204:207], a[36:39]
v_mfma_f32_16x16x32_bf16 a[40:43], v[152:155], v[208:211], a[40:43]
v_mfma_f32_16x16x32_bf16 a[44:47], v[152:155], v[212:215], a[44:47]
ds_read_b128 v[192:195], v6 offset:20480
buffer_load_dwordx4 v[152:155], v1, s[4:7], s32 offen offset:3072
s_add_u32 s32, s32, 4096
v_mfma_f32_16x16x32_bf16 a[48:51], v[156:159], v[200:203], a[48:51]
v_mfma_f32_16x16x32_bf16 a[52:55], v[156:159], v[204:207], a[52:55]
v_mfma_f32_16x16x32_bf16 a[56:59], v[156:159], v[208:211], a[56:59]
v_mfma_f32_16x16x32_bf16 a[60:63], v[156:159], v[212:215], a[60:63]
ds_read_b128 v[196:199], v6 offset:45056
buffer_load_dwordx4 v[156:159], v1, s[4:7], s33 offen offset:3072
s_add_u32 s33, s33, 4096
v_mfma_f32_16x16x32_bf16 a[64:67], v[160:163], v[200:203], a[64:67]
v_mfma_f32_16x16x32_bf16 a[68:71], v[160:163], v[204:207], a[68:71]
v_mfma_f32_16x16x32_bf16 a[72:75], v[160:163], v[208:211], a[72:75]
v_mfma_f32_16x16x32_bf16 a[76:79], v[160:163], v[212:215], a[76:79]
buffer_load_dwordx4 v[160:163], v1, s[4:7], s34 offen offset:3072
s_add_u32 s34, s34, 4096
v_mfma_f32_16x16x32_bf16 a[80:83], v[164:167], v[200:203], a[80:83]
v_mfma_f32_16x16x32_bf16 a[84:87], v[164:167], v[204:207], a[84:87]
v_mfma_f32_16x16x32_bf16 a[88:91], v[164:167], v[208:211], a[88:91]
v_mfma_f32_16x16x32_bf16 a[92:95], v[164:167], v[212:215], a[92:95]
buffer_load_dwordx4 v[164:167], v1, s[4:7], s35 offen offset:3072
s_add_u32 s35, s35, 4096
v_mfma_f32_16x16x32_bf16 a[96:99], v[168:171], v[200:203], a[96:99]
v_mfma_f32_16x16x32_bf16 a[100:103], v[168:171], v[204:207], a[100:103]
v_mfma_f32_16x16x32_bf16 a[104:107], v[168:171], v[208:211], a[104:107]
v_mfma_f32_16x16x32_bf16 a[108:111], v[168:171], v[212:215], a[108:111]
buffer_load_dwordx4 v[168:171], v1, s[4:7], s36 offen offset:3072
s_add_u32 s36, s36, 4096
v_mfma_f32_16x16x32_bf16 a[112:115], v[172:175], v[200:203], a[112:115]
v_mfma_f32_16x16x32_bf16 a[116:119], v[172:175], v[204:207], a[116:119]
v_mfma_f32_16x16x32_bf16 a[120:123], v[172:175], v[208:211], a[120:123]
v_mfma_f32_16x16x32_bf16 a[124:127], v[172:175], v[212:215], a[124:127]
buffer_load_dwordx4 v[172:175], v1, s[4:7], s37 offen offset:3072
s_add_u32 s37, s37, 4096
v_mfma_f32_16x16x32_bf16 a[128:131], v[176:179], v[200:203], a[128:131]
v_mfma_f32_16x16x32_bf16 a[132:135], v[176:179], v[204:207], a[132:135]
v_mfma_f32_16x16x32_bf16 a[136:139], v[176:179], v[208:211], a[136:139]
v_mfma_f32_16x16x32_bf16 a[140:143], v[176:179], v[212:215], a[140:143]
buffer_load_dwordx4 v[176:179], v1, s[4:7], s38 offen offset:3072
s_add_u32 s38, s38, 4096
v_mfma_f32_16x16x32_bf16 a[144:147], v[180:183], v[200:203], a[144:147]
v_mfma_f32_16x16x32_bf16 a[148:151], v[180:183], v[204:207], a[148:151]
v_mfma_f32_16x16x32_bf16 a[152:155], v[180:183], v[208:211], a[152:155]
v_mfma_f32_16x16x32_bf16 a[156:159], v[180:183], v[212:215], a[156:159]
buffer_load_dwordx4 v[180:183], v1, s[4:7], s39 offen offset:3072
s_add_u32 s39, s39, 4096
s_waitcnt vmcnt(30) lgkmcnt(0)
v_mfma_f32_16x16x32_bf16 a[0:3], v[24:27], v[184:187], a[0:3]
v_mfma_f32_16x16x32_bf16 a[4:7], v[24:27], v[188:191], a[4:7]
v_mfma_f32_16x16x32_bf16 a[8:11], v[24:27], v[192:195], a[8:11]
v_mfma_f32_16x16x32_bf16 a[12:15], v[24:27], v[196:199], a[12:15]
ds_read_b128 v[200:203], v1 offset:21504
v_mfma_f32_16x16x32_bf16 a[16:19], v[28:31], v[184:187], a[16:19]
v_mfma_f32_16x16x32_bf16 a[20:23], v[28:31], v[188:191], a[20:23]
v_mfma_f32_16x16x32_bf16 a[24:27], v[28:31], v[192:195], a[24:27]
v_mfma_f32_16x16x32_bf16 a[28:31], v[28:31], v[196:199], a[28:31]
ds_read_b128 v[204:207], v1 offset:46080
v_mfma_f32_16x16x32_bf16 a[32:35], v[32:35], v[184:187], a[32:35]
v_mfma_f32_16x16x32_bf16 a[36:39], v[32:35], v[188:191], a[36:39]
v_mfma_f32_16x16x32_bf16 a[40:43], v[32:35], v[192:195], a[40:43]
v_mfma_f32_16x16x32_bf16 a[44:47], v[32:35], v[196:199], a[44:47]
ds_read_b128 v[208:211], v6 offset:21504
v_mfma_f32_16x16x32_bf16 a[48:51], v[36:39], v[184:187], a[48:51]
v_mfma_f32_16x16x32_bf16 a[52:55], v[36:39], v[188:191], a[52:55]
v_mfma_f32_16x16x32_bf16 a[56:59], v[36:39], v[192:195], a[56:59]
v_mfma_f32_16x16x32_bf16 a[60:63], v[36:39], v[196:199], a[60:63]
ds_read_b128 v[212:215], v6 offset:46080
v_mfma_f32_16x16x32_bf16 a[64:67], v[40:43], v[184:187], a[64:67]
v_mfma_f32_16x16x32_bf16 a[68:71], v[40:43], v[188:191], a[68:71]
v_mfma_f32_16x16x32_bf16 a[72:75], v[40:43], v[192:195], a[72:75]
v_mfma_f32_16x16x32_bf16 a[76:79], v[40:43], v[196:199], a[76:79]
v_mfma_f32_16x16x32_bf16 a[80:83], v[44:47], v[184:187], a[80:83]
v_mfma_f32_16x16x32_bf16 a[84:87], v[44:47], v[188:191], a[84:87]
v_mfma_f32_16x16x32_bf16 a[88:91], v[44:47], v[192:195], a[88:91]
v_mfma_f32_16x16x32_bf16 a[92:95], v[44:47], v[196:199], a[92:95]
v_mfma_f32_16x16x32_bf16 a[96:99], v[48:51], v[184:187], a[96:99]
v_mfma_f32_16x16x32_bf16 a[100:103], v[48:51], v[188:191], a[100:103]
v_mfma_f32_16x16x32_bf16 a[104:107], v[48:51], v[192:195], a[104:107]
v_mfma_f32_16x16x32_bf16 a[108:111], v[48:51], v[196:199], a[108:111]
v_mfma_f32_16x16x32_bf16 a[112:115], v[52:55], v[184:187], a[112:115]
v_mfma_f32_16x16x32_bf16 a[116:119], v[52:55], v[188:191], a[116:119]
v_mfma_f32_16x16x32_bf16 a[120:123], v[52:55], v[192:195], a[120:123]
v_mfma_f32_16x16x32_bf16 a[124:127], v[52:55], v[196:199], a[124:127]
v_mfma_f32_16x16x32_bf16 a[128:131], v[56:59], v[184:187], a[128:131]
v_mfma_f32_16x16x32_bf16 a[132:135], v[56:59], v[188:191], a[132:135]
v_mfma_f32_16x16x32_bf16 a[136:139], v[56:59], v[192:195], a[136:139]
v_mfma_f32_16x16x32_bf16 a[140:143], v[56:59], v[196:199], a[140:143]
v_mfma_f32_16x16x32_bf16 a[144:147], v[60:63], v[184:187], a[144:147]
v_mfma_f32_16x16x32_bf16 a[148:151], v[60:63], v[188:191], a[148:151]
v_mfma_f32_16x16x32_bf16 a[152:155], v[60:63], v[192:195], a[152:155]
v_mfma_f32_16x16x32_bf16 a[156:159], v[60:63], v[196:199], a[156:159]
s_waitcnt vmcnt(20) lgkmcnt(0)
v_mfma_f32_16x16x32_bf16 a[0:3], v[64:67], v[200:203], a[0:3]
v_mfma_f32_16x16x32_bf16 a[4:7], v[64:67], v[204:207], a[4:7]
v_mfma_f32_16x16x32_bf16 a[8:11], v[64:67], v[208:211], a[8:11]
v_mfma_f32_16x16x32_bf16 a[12:15], v[64:67], v[212:215], a[12:15]
ds_read_b128 v[184:187], v1 offset:22528
v_mfma_f32_16x16x32_bf16 a[16:19], v[68:71], v[200:203], a[16:19]
v_mfma_f32_16x16x32_bf16 a[20:23], v[68:71], v[204:207], a[20:23]
v_mfma_f32_16x16x32_bf16 a[24:27], v[68:71], v[208:211], a[24:27]
v_mfma_f32_16x16x32_bf16 a[28:31], v[68:71], v[212:215], a[28:31]
ds_read_b128 v[188:191], v1 offset:47104
v_mfma_f32_16x16x32_bf16 a[32:35], v[72:75], v[200:203], a[32:35]
v_mfma_f32_16x16x32_bf16 a[36:39], v[72:75], v[204:207], a[36:39]
v_mfma_f32_16x16x32_bf16 a[40:43], v[72:75], v[208:211], a[40:43]
v_mfma_f32_16x16x32_bf16 a[44:47], v[72:75], v[212:215], a[44:47]
ds_read_b128 v[192:195], v6 offset:22528
v_mfma_f32_16x16x32_bf16 a[48:51], v[76:79], v[200:203], a[48:51]
v_mfma_f32_16x16x32_bf16 a[52:55], v[76:79], v[204:207], a[52:55]
v_mfma_f32_16x16x32_bf16 a[56:59], v[76:79], v[208:211], a[56:59]
v_mfma_f32_16x16x32_bf16 a[60:63], v[76:79], v[212:215], a[60:63]
ds_read_b128 v[196:199], v6 offset:47104
v_mfma_f32_16x16x32_bf16 a[64:67], v[80:83], v[200:203], a[64:67]
v_mfma_f32_16x16x32_bf16 a[68:71], v[80:83], v[204:207], a[68:71]
v_mfma_f32_16x16x32_bf16 a[72:75], v[80:83], v[208:211], a[72:75]
v_mfma_f32_16x16x32_bf16 a[76:79], v[80:83], v[212:215], a[76:79]
v_mfma_f32_16x16x32_bf16 a[80:83], v[84:87], v[200:203], a[80:83]
v_mfma_f32_16x16x32_bf16 a[84:87], v[84:87], v[204:207], a[84:87]
v_mfma_f32_16x16x32_bf16 a[88:91], v[84:87], v[208:211], a[88:91]
v_mfma_f32_16x16x32_bf16 a[92:95], v[84:87], v[212:215], a[92:95]
v_mfma_f32_16x16x32_bf16 a[96:99], v[88:91], v[200:203], a[96:99]
v_mfma_f32_16x16x32_bf16 a[100:103], v[88:91], v[204:207], a[100:103]
v_mfma_f32_16x16x32_bf16 a[104:107], v[88:91], v[208:211], a[104:107]
v_mfma_f32_16x16x32_bf16 a[108:111], v[88:91], v[212:215], a[108:111]
v_mfma_f32_16x16x32_bf16 a[112:115], v[92:95], v[200:203], a[112:115]
v_mfma_f32_16x16x32_bf16 a[116:119], v[92:95], v[204:207], a[116:119]
v_mfma_f32_16x16x32_bf16 a[120:123], v[92:95], v[208:211], a[120:123]
v_mfma_f32_16x16x32_bf16 a[124:127], v[92:95], v[212:215], a[124:127]
v_mfma_f32_16x16x32_bf16 a[128:131], v[96:99], v[200:203], a[128:131]
v_mfma_f32_16x16x32_bf16 a[132:135], v[96:99], v[204:207], a[132:135]
v_mfma_f32_16x16x32_bf16 a[136:139], v[96:99], v[208:211], a[136:139]
v_mfma_f32_16x16x32_bf16 a[140:143], v[96:99], v[212:215], a[140:143]
v_mfma_f32_16x16x32_bf16 a[144:147], v[100:103], v[200:203], a[144:147]
v_mfma_f32_16x16x32_bf16 a[148:151], v[100:103], v[204:207], a[148:151]
v_mfma_f32_16x16x32_bf16 a[152:155], v[100:103], v[208:211], a[152:155]
v_mfma_f32_16x16x32_bf16 a[156:159], v[100:103], v[212:215], a[156:159]
s_waitcnt vmcnt(10) lgkmcnt(0)
v_mfma_f32_16x16x32_bf16 a[0:3], v[104:107], v[184:187], a[0:3]
v_mfma_f32_16x16x32_bf16 a[4:7], v[104:107], v[188:191], a[4:7]
v_mfma_f32_16x16x32_bf16 a[8:11], v[104:107], v[192:195], a[8:11]
v_mfma_f32_16x16x32_bf16 a[12:15], v[104:107], v[196:199], a[12:15]
ds_read_b128 v[200:203], v1 offset:23552
v_mfma_f32_16x16x32_bf16 a[16:19], v[108:111], v[184:187], a[16:19]
v_mfma_f32_16x16x32_bf16 a[20:23], v[108:111], v[188:191], a[20:23]
v_mfma_f32_16x16x32_bf16 a[24:27], v[108:111], v[192:195], a[24:27]
v_mfma_f32_16x16x32_bf16 a[28:31], v[108:111], v[196:199], a[28:31]
ds_read_b128 v[204:207], v1 offset:48128
v_mfma_f32_16x16x32_bf16 a[32:35], v[112:115], v[184:187], a[32:35]
v_mfma_f32_16x16x32_bf16 a[36:39], v[112:115], v[188:191], a[36:39]
v_mfma_f32_16x16x32_bf16 a[40:43], v[112:115], v[192:195], a[40:43]
v_mfma_f32_16x16x32_bf16 a[44:47], v[112:115], v[196:199], a[44:47]
ds_read_b128 v[208:211], v6 offset:23552
v_mfma_f32_16x16x32_bf16 a[48:51], v[116:119], v[184:187], a[48:51]
v_mfma_f32_16x16x32_bf16 a[52:55], v[116:119], v[188:191], a[52:55]
v_mfma_f32_16x16x32_bf16 a[56:59], v[116:119], v[192:195], a[56:59]
v_mfma_f32_16x16x32_bf16 a[60:63], v[116:119], v[196:199], a[60:63]
ds_read_b128 v[212:215], v6 offset:48128
v_mfma_f32_16x16x32_bf16 a[64:67], v[120:123], v[184:187], a[64:67]
v_mfma_f32_16x16x32_bf16 a[68:71], v[120:123], v[188:191], a[68:71]
v_mfma_f32_16x16x32_bf16 a[72:75], v[120:123], v[192:195], a[72:75]
v_mfma_f32_16x16x32_bf16 a[76:79], v[120:123], v[196:199], a[76:79]
v_mfma_f32_16x16x32_bf16 a[80:83], v[124:127], v[184:187], a[80:83]
v_mfma_f32_16x16x32_bf16 a[84:87], v[124:127], v[188:191], a[84:87]
v_mfma_f32_16x16x32_bf16 a[88:91], v[124:127], v[192:195], a[88:91]
v_mfma_f32_16x16x32_bf16 a[92:95], v[124:127], v[196:199], a[92:95]
v_mfma_f32_16x16x32_bf16 a[96:99], v[128:131], v[184:187], a[96:99]
v_mfma_f32_16x16x32_bf16 a[100:103], v[128:131], v[188:191], a[100:103]
v_mfma_f32_16x16x32_bf16 a[104:107], v[128:131], v[192:195], a[104:107]
v_mfma_f32_16x16x32_bf16 a[108:111], v[128:131], v[196:199], a[108:111]
v_mfma_f32_16x16x32_bf16 a[112:115], v[132:135], v[184:187], a[112:115]
v_mfma_f32_16x16x32_bf16 a[116:119], v[132:135], v[188:191], a[116:119]
v_mfma_f32_16x16x32_bf16 a[120:123], v[132:135], v[192:195], a[120:123]
v_mfma_f32_16x16x32_bf16 a[124:127], v[132:135], v[196:199], a[124:127]
v_mfma_f32_16x16x32_bf16 a[128:131], v[136:139], v[184:187], a[128:131]
v_mfma_f32_16x16x32_bf16 a[132:135], v[136:139], v[188:191], a[132:135]
v_mfma_f32_16x16x32_bf16 a[136:139], v[136:139], v[192:195], a[136:139]
v_mfma_f32_16x16x32_bf16 a[140:143], v[136:139], v[196:199], a[140:143]
v_mfma_f32_16x16x32_bf16 a[144:147], v[140:143], v[184:187], a[144:147]
v_mfma_f32_16x16x32_bf16 a[148:151], v[140:143], v[188:191], a[148:151]
v_mfma_f32_16x16x32_bf16 a[152:155], v[140:143], v[192:195], a[152:155]
v_mfma_f32_16x16x32_bf16 a[156:159], v[140:143], v[196:199], a[156:159]
s_waitcnt vmcnt(0) lgkmcnt(0)
v_mfma_f32_16x16x32_bf16 a[0:3], v[144:147], v[200:203], a[0:3]
v_mfma_f32_16x16x32_bf16 a[4:7], v[144:147], v[204:207], a[4:7]
v_mfma_f32_16x16x32_bf16 a[8:11], v[144:147], v[208:211], a[8:11]
v_mfma_f32_16x16x32_bf16 a[12:15], v[144:147], v[212:215], a[12:15]
v_mfma_f32_16x16x32_bf16 a[16:19], v[148:151], v[200:203], a[16:19]
v_mfma_f32_16x16x32_bf16 a[20:23], v[148:151], v[204:207], a[20:23]
v_mfma_f32_16x16x32_bf16 a[24:27], v[148:151], v[208:211], a[24:27]
v_mfma_f32_16x16x32_bf16 a[28:31], v[148:151], v[212:215], a[28:31]
v_mfma_f32_16x16x32_bf16 a[32:35], v[152:155], v[200:203], a[32:35]
v_mfma_f32_16x16x32_bf16 a[36:39], v[152:155], v[204:207], a[36:39]
v_mfma_f32_16x16x32_bf16 a[40:43], v[152:155], v[208:211], a[40:43]
v_mfma_f32_16x16x32_bf16 a[44:47], v[152:155], v[212:215], a[44:47]
v_mfma_f32_16x16x32_bf16 a[48:51], v[156:159], v[200:203], a[48:51]
v_mfma_f32_16x16x32_bf16 a[52:55], v[156:159], v[204:207], a[52:55]
v_mfma_f32_16x16x32_bf16 a[56:59], v[156:159], v[208:211], a[56:59]
v_mfma_f32_16x16x32_bf16 a[60:63], v[156:159], v[212:215], a[60:63]
v_mfma_f32_16x16x32_bf16 a[64:67], v[160:163], v[200:203], a[64:67]
v_mfma_f32_16x16x32_bf16 a[68:71], v[160:163], v[204:207], a[68:71]
v_mfma_f32_16x16x32_bf16 a[72:75], v[160:163], v[208:211], a[72:75]
v_mfma_f32_16x16x32_bf16 a[76:79], v[160:163], v[212:215], a[76:79]
v_mfma_f32_16x16x32_bf16 a[80:83], v[164:167], v[200:203], a[80:83]
v_mfma_f32_16x16x32_bf16 a[84:87], v[164:167], v[204:207], a[84:87]
v_mfma_f32_16x16x32_bf16 a[88:91], v[164:167], v[208:211], a[88:91]
v_mfma_f32_16x16x32_bf16 a[92:95], v[164:167], v[212:215], a[92:95]
v_mfma_f32_16x16x32_bf16 a[96:99], v[168:171], v[200:203], a[96:99]
v_mfma_f32_16x16x32_bf16 a[100:103], v[168:171], v[204:207], a[100:103]
v_mfma_f32_16x16x32_bf16 a[104:107], v[168:171], v[208:211], a[104:107]
v_mfma_f32_16x16x32_bf16 a[108:111], v[168:171], v[212:215], a[108:111]
v_mfma_f32_16x16x32_bf16 a[112:115], v[172:175], v[200:203], a[112:115]
v_mfma_f32_16x16x32_bf16 a[116:119], v[172:175], v[204:207], a[116:119]
v_mfma_f32_16x16x32_bf16 a[120:123], v[172:175], v[208:211], a[120:123]
v_mfma_f32_16x16x32_bf16 a[124:127], v[172:175], v[212:215], a[124:127]
v_mfma_f32_16x16x32_bf16 a[128:131], v[176:179], v[200:203], a[128:131]
v_mfma_f32_16x16x32_bf16 a[132:135], v[176:179], v[204:207], a[132:135]
v_mfma_f32_16x16x32_bf16 a[136:139], v[176:179], v[208:211], a[136:139]
v_mfma_f32_16x16x32_bf16 a[140:143], v[176:179], v[212:215], a[140:143]
v_mfma_f32_16x16x32_bf16 a[144:147], v[180:183], v[200:203], a[144:147]
v_mfma_f32_16x16x32_bf16 a[148:151], v[180:183], v[204:207], a[148:151]
v_mfma_f32_16x16x32_bf16 a[152:155], v[180:183], v[208:211], a[152:155]
v_mfma_f32_16x16x32_bf16 a[156:159], v[180:183], v[212:215], a[156:159]
s_branch fin_store4
fin_odma3:
s_lshl_b32 s16, s14, 2
s_add_u32 s16, s16, s12
s_mul_i32 s16, s16, 192
s_mul_i32 s17, s13, 24
s_add_u32 s16, s16, s17
s_lshl_b32 s16, s16, 10
s_add_u32 s16, s16, 57147392
s_mul_i32 s17, s12, 24576
v_add_u32 v6, 49152, v1
s_add_u32 m0, s17, 0
s_add_u32 s18, s16, 0
buffer_load_dwordx4 v1, s[4:7], s18 offen offset:0 lds
buffer_load_dwordx4 v1, s[4:7], s18 offen offset:1024 lds
buffer_load_dwordx4 v1, s[4:7], s18 offen offset:2048 lds
buffer_load_dwordx4 v1, s[4:7], s18 offen offset:3072 lds
s_add_u32 m0, s17, 4096
s_add_u32 s18, s16, 4096
buffer_load_dwordx4 v1, s[4:7], s18 offen offset:0 lds
buffer_load_dwordx4 v1, s[4:7], s18 offen offset:1024 lds
buffer_load_dwordx4 a[160:163], v1, s[4:7], s30 offen offset:0
buffer_load_dwordx4 a[164:167], v1, s[4:7], s31 offen offset:0
buffer_load_dwordx4 a[168:171], v1, s[4:7], s32 offen offset:0
buffer_load_dwordx4 a[172:175], v1, s[4:7], s33 offen offset:0
buffer_load_dwordx4 a[176:179], v1, s[4:7], s34 offen offset:0
buffer_load_dwordx4 a[180:183], v1, s[4:7], s35 offen offset:0
buffer_load_dwordx4 a[184:187], v1, s[4:7], s36 offen offset:0
buffer_load_dwordx4 a[188:191], v1, s[4:7], s37 offen offset:0
buffer_load_dwordx4 a[192:195], v1, s[4:7], s38 offen offset:0
buffer_load_dwordx4 a[196:199], v1, s[4:7], s39 offen offset:0
buffer_load_dwordx4 a[200:203], v1, s[4:7], s30 offen offset:1024
buffer_load_dwordx4 a[204:207], v1, s[4:7], s31 offen offset:1024
buffer_load_dwordx4 a[208:211], v1, s[4:7], s32 offen offset:1024
buffer_load_dwordx4 a[212:215], v1, s[4:7], s33 offen offset:1024
buffer_load_dwordx4 a[216:219], v1, s[4:7], s34 offen offset:1024
buffer_load_dwordx4 a[220:223], v1, s[4:7], s35 offen offset:1024
buffer_load_dwordx4 a[224:227], v1, s[4:7], s36 offen offset:1024
buffer_load_dwordx4 a[228:231], v1, s[4:7], s37 offen offset:1024
buffer_load_dwordx4 a[232:235], v1, s[4:7], s38 offen offset:1024
buffer_load_dwordx4 a[236:239], v1, s[4:7], s39 offen offset:1024
s_add_u32 m0, s17, 6144
s_add_u32 s18, s16, 6144
buffer_load_dwordx4 v1, s[4:7], s18 offen offset:0 lds
buffer_load_dwordx4 v1, s[4:7], s18 offen offset:1024 lds
buffer_load_dwordx4 v1, s[4:7], s18 offen offset:2048 lds
buffer_load_dwordx4 v1, s[4:7], s18 offen offset:3072 lds
s_add_u32 m0, s17, 10240
s_add_u32 s18, s16, 10240
buffer_load_dwordx4 v1, s[4:7], s18 offen offset:0 lds
buffer_load_dwordx4 v1, s[4:7], s18 offen offset:1024 lds
buffer_load_dwordx4 v[104:107], v1, s[4:7], s30 offen offset:2048
buffer_load_dwordx4 v[108:111], v1, s[4:7], s31 offen offset:2048
buffer_load_dwordx4 v[112:115], v1, s[4:7], s32 offen offset:2048
buffer_load_dwordx4 v[116:119], v1, s[4:7], s33 offen offset:2048
buffer_load_dwordx4 v[120:123], v1, s[4:7], s34 offen offset:2048
buffer_load_dwordx4 v[124:127], v1, s[4:7], s35 offen offset:2048
buffer_load_dwordx4 v[128:131], v1, s[4:7], s36 offen offset:2048
buffer_load_dwordx4 v[132:135], v1, s[4:7], s37 offen offset:2048
buffer_load_dwordx4 v[136:139], v1, s[4:7], s38 offen offset:2048
buffer_load_dwordx4 v[140:143], v1, s[4:7], s39 offen offset:2048
s_waitcnt vmcnt(36)
s_barrier
s_add_u32 m0, s17, 12288
s_add_u32 s18, s16, 12288
buffer_load_dwordx4 v1, s[4:7], s18 offen offset:0 lds
buffer_load_dwordx4 v1, s[4:7], s18 offen offset:1024 lds
buffer_load_dwordx4 v1, s[4:7], s18 offen offset:2048 lds
buffer_load_dwordx4 v1, s[4:7], s18 offen offset:3072 lds
s_add_u32 m0, s17, 16384
s_add_u32 s18, s16, 16384
buffer_load_dwordx4 v1, s[4:7], s18 offen offset:0 lds
buffer_load_dwordx4 v1, s[4:7], s18 offen offset:1024 lds
buffer_load_dwordx4 v[144:147], v1, s[4:7], s30 offen offset:3072
buffer_load_dwordx4 v[148:151], v1, s[4:7], s31 offen offset:3072
buffer_load_dwordx4 v[152:155], v1, s[4:7], s32 offen offset:3072
buffer_load_dwordx4 v[156:159], v1, s[4:7], s33 offen offset:3072
buffer_load_dwordx4 v[160:163], v1, s[4:7], s34 offen offset:3072
buffer_load_dwordx4 v[164:167], v1, s[4:7], s35 offen offset:3072
buffer_load_dwordx4 v[168:171], v1, s[4:7], s36 offen offset:3072
buffer_load_dwordx4 v[172:175], v1, s[4:7], s37 offen offset:3072
buffer_load_dwordx4 v[176:179], v1, s[4:7], s38 offen offset:3072
buffer_load_dwordx4 v[180:183], v1, s[4:7], s39 offen offset:3072
s_add_u32 s30, s30, 4096
s_add_u32 s31, s31, 4096
s_add_u32 s32, s32, 4096
s_add_u32 s33, s33, 4096
s_add_u32 s34, s34, 4096
s_add_u32 s35, s35, 4096
s_add_u32 s36, s36, 4096
s_add_u32 s37, s37, 4096
s_add_u32 s38, s38, 4096
s_add_u32 s39, s39, 4096
ds_read_b128 v[184:187], v1 offset:0
ds_read_b128 v[188:191], v1 offset:24576
ds_read_b128 v[192:195], v6 offset:0
ds_read_b128 v[196:199], v6 offset:24576
s_waitcnt vmcnt(42)
s_waitcnt lgkmcnt(0)
v_mfma_f32_16x16x32_bf16 a[0:3], a[160:163], v[184:187], 0
v_mfma_f32_16x16x32_bf16 a[4:7], a[160:163], v[188:191], 0
v_mfma_f32_16x16x32_bf16 a[8:11], a[160:163], v[192:195], 0
v_mfma_f32_16x16x32_bf16 a[12:15], a[160:163], v[196:199], 0
ds_read_b128 v[200:203], v1 offset:1024
buffer_load_dwordx4 v[24:27], v1, s[4:7], s30 offen offset:0
v_mfma_f32_16x16x32_bf16 a[16:19], a[164:167], v[184:187], 0
v_mfma_f32_16x16x32_bf16 a[20:23], a[164:167], v[188:191], 0
v_mfma_f32_16x16x32_bf16 a[24:27], a[164:167], v[192:195], 0
v_mfma_f32_16x16x32_bf16 a[28:31], a[164:167], v[196:199], 0
ds_read_b128 v[204:207], v1 offset:25600
buffer_load_dwordx4 v[28:31], v1, s[4:7], s31 offen offset:0
v_mfma_f32_16x16x32_bf16 a[32:35], a[168:171], v[184:187], 0
v_mfma_f32_16x16x32_bf16 a[36:39], a[168:171], v[188:191], 0
v_mfma_f32_16x16x32_bf16 a[40:43], a[168:171], v[192:195], 0
v_mfma_f32_16x16x32_bf16 a[44:47], a[168:171], v[196:199], 0
ds_read_b128 v[208:211], v6 offset:1024
buffer_load_dwordx4 v[32:35], v1, s[4:7], s32 offen offset:0
v_mfma_f32_16x16x32_bf16 a[48:51], a[172:175], v[184:187], 0
v_mfma_f32_16x16x32_bf16 a[52:55], a[172:175], v[188:191], 0
v_mfma_f32_16x16x32_bf16 a[56:59], a[172:175], v[192:195], 0
v_mfma_f32_16x16x32_bf16 a[60:63], a[172:175], v[196:199], 0
ds_read_b128 v[212:215], v6 offset:25600
buffer_load_dwordx4 v[36:39], v1, s[4:7], s33 offen offset:0
v_mfma_f32_16x16x32_bf16 a[64:67], a[176:179], v[184:187], 0
v_mfma_f32_16x16x32_bf16 a[68:71], a[176:179], v[188:191], 0
v_mfma_f32_16x16x32_bf16 a[72:75], a[176:179], v[192:195], 0
v_mfma_f32_16x16x32_bf16 a[76:79], a[176:179], v[196:199], 0
buffer_load_dwordx4 v[40:43], v1, s[4:7], s34 offen offset:0
v_mfma_f32_16x16x32_bf16 a[80:83], a[180:183], v[184:187], 0
v_mfma_f32_16x16x32_bf16 a[84:87], a[180:183], v[188:191], 0
v_mfma_f32_16x16x32_bf16 a[88:91], a[180:183], v[192:195], 0
v_mfma_f32_16x16x32_bf16 a[92:95], a[180:183], v[196:199], 0
buffer_load_dwordx4 v[44:47], v1, s[4:7], s35 offen offset:0
v_mfma_f32_16x16x32_bf16 a[96:99], a[184:187], v[184:187], 0
v_mfma_f32_16x16x32_bf16 a[100:103], a[184:187], v[188:191], 0
v_mfma_f32_16x16x32_bf16 a[104:107], a[184:187], v[192:195], 0
v_mfma_f32_16x16x32_bf16 a[108:111], a[184:187], v[196:199], 0
buffer_load_dwordx4 v[48:51], v1, s[4:7], s36 offen offset:0
v_mfma_f32_16x16x32_bf16 a[112:115], a[188:191], v[184:187], 0
v_mfma_f32_16x16x32_bf16 a[116:119], a[188:191], v[188:191], 0
v_mfma_f32_16x16x32_bf16 a[120:123], a[188:191], v[192:195], 0
v_mfma_f32_16x16x32_bf16 a[124:127], a[188:191], v[196:199], 0
buffer_load_dwordx4 v[52:55], v1, s[4:7], s37 offen offset:0
v_mfma_f32_16x16x32_bf16 a[128:131], a[192:195], v[184:187], 0
v_mfma_f32_16x16x32_bf16 a[132:135], a[192:195], v[188:191], 0
v_mfma_f32_16x16x32_bf16 a[136:139], a[192:195], v[192:195], 0
v_mfma_f32_16x16x32_bf16 a[140:143], a[192:195], v[196:199], 0
buffer_load_dwordx4 v[56:59], v1, s[4:7], s38 offen offset:0
v_mfma_f32_16x16x32_bf16 a[144:147], a[196:199], v[184:187], 0
v_mfma_f32_16x16x32_bf16 a[148:151], a[196:199], v[188:191], 0
v_mfma_f32_16x16x32_bf16 a[152:155], a[196:199], v[192:195], 0
v_mfma_f32_16x16x32_bf16 a[156:159], a[196:199], v[196:199], 0
buffer_load_dwordx4 v[60:63], v1, s[4:7], s39 offen offset:0
s_add_u32 m0, s17, 18432
s_add_u32 s18, s16, 18432
buffer_load_dwordx4 v1, s[4:7], s18 offen offset:0 lds
buffer_load_dwordx4 v1, s[4:7], s18 offen offset:1024 lds
buffer_load_dwordx4 v1, s[4:7], s18 offen offset:2048 lds
buffer_load_dwordx4 v1, s[4:7], s18 offen offset:3072 lds
s_add_u32 m0, s17, 22528
s_add_u32 s18, s16, 22528
buffer_load_dwordx4 v1, s[4:7], s18 offen offset:0 lds
buffer_load_dwordx4 v1, s[4:7], s18 offen offset:1024 lds
s_waitcnt vmcnt(48)
s_waitcnt lgkmcnt(0)
v_mfma_f32_16x16x32_bf16 a[0:3], a[200:203], v[200:203], a[0:3]
v_mfma_f32_16x16x32_bf16 a[4:7], a[200:203], v[204:207], a[4:7]
v_mfma_f32_16x16x32_bf16 a[8:11], a[200:203], v[208:211], a[8:11]
v_mfma_f32_16x16x32_bf16 a[12:15], a[200:203], v[212:215], a[12:15]
ds_read_b128 v[184:187], v1 offset:2048
buffer_load_dwordx4 v[64:67], v1, s[4:7], s30 offen offset:1024
v_mfma_f32_16x16x32_bf16 a[16:19], a[204:207], v[200:203], a[16:19]
v_mfma_f32_16x16x32_bf16 a[20:23], a[204:207], v[204:207], a[20:23]
v_mfma_f32_16x16x32_bf16 a[24:27], a[204:207], v[208:211], a[24:27]
v_mfma_f32_16x16x32_bf16 a[28:31], a[204:207], v[212:215], a[28:31]
ds_read_b128 v[188:191], v1 offset:26624
buffer_load_dwordx4 v[68:71], v1, s[4:7], s31 offen offset:1024
v_mfma_f32_16x16x32_bf16 a[32:35], a[208:211], v[200:203], a[32:35]
v_mfma_f32_16x16x32_bf16 a[36:39], a[208:211], v[204:207], a[36:39]
v_mfma_f32_16x16x32_bf16 a[40:43], a[208:211], v[208:211], a[40:43]
v_mfma_f32_16x16x32_bf16 a[44:47], a[208:211], v[212:215], a[44:47]
ds_read_b128 v[192:195], v6 offset:2048
buffer_load_dwordx4 v[72:75], v1, s[4:7], s32 offen offset:1024
v_mfma_f32_16x16x32_bf16 a[48:51], a[212:215], v[200:203], a[48:51]
v_mfma_f32_16x16x32_bf16 a[52:55], a[212:215], v[204:207], a[52:55]
v_mfma_f32_16x16x32_bf16 a[56:59], a[212:215], v[208:211], a[56:59]
v_mfma_f32_16x16x32_bf16 a[60:63], a[212:215], v[212:215], a[60:63]
ds_read_b128 v[196:199], v6 offset:26624
buffer_load_dwordx4 v[76:79], v1, s[4:7], s33 offen offset:1024
v_mfma_f32_16x16x32_bf16 a[64:67], a[216:219], v[200:203], a[64:67]
v_mfma_f32_16x16x32_bf16 a[68:71], a[216:219], v[204:207], a[68:71]
v_mfma_f32_16x16x32_bf16 a[72:75], a[216:219], v[208:211], a[72:75]
v_mfma_f32_16x16x32_bf16 a[76:79], a[216:219], v[212:215], a[76:79]
buffer_load_dwordx4 v[80:83], v1, s[4:7], s34 offen offset:1024
v_mfma_f32_16x16x32_bf16 a[80:83], a[220:223], v[200:203], a[80:83]
v_mfma_f32_16x16x32_bf16 a[84:87], a[220:223], v[204:207], a[84:87]
v_mfma_f32_16x16x32_bf16 a[88:91], a[220:223], v[208:211], a[88:91]
v_mfma_f32_16x16x32_bf16 a[92:95], a[220:223], v[212:215], a[92:95]
buffer_load_dwordx4 v[84:87], v1, s[4:7], s35 offen offset:1024
v_mfma_f32_16x16x32_bf16 a[96:99], a[224:227], v[200:203], a[96:99]
v_mfma_f32_16x16x32_bf16 a[100:103], a[224:227], v[204:207], a[100:103]
v_mfma_f32_16x16x32_bf16 a[104:107], a[224:227], v[208:211], a[104:107]
v_mfma_f32_16x16x32_bf16 a[108:111], a[224:227], v[212:215], a[108:111]
buffer_load_dwordx4 v[88:91], v1, s[4:7], s36 offen offset:1024
v_mfma_f32_16x16x32_bf16 a[112:115], a[228:231], v[200:203], a[112:115]
v_mfma_f32_16x16x32_bf16 a[116:119], a[228:231], v[204:207], a[116:119]
v_mfma_f32_16x16x32_bf16 a[120:123], a[228:231], v[208:211], a[120:123]
v_mfma_f32_16x16x32_bf16 a[124:127], a[228:231], v[212:215], a[124:127]
buffer_load_dwordx4 v[92:95], v1, s[4:7], s37 offen offset:1024
v_mfma_f32_16x16x32_bf16 a[128:131], a[232:235], v[200:203], a[128:131]
v_mfma_f32_16x16x32_bf16 a[132:135], a[232:235], v[204:207], a[132:135]
v_mfma_f32_16x16x32_bf16 a[136:139], a[232:235], v[208:211], a[136:139]
v_mfma_f32_16x16x32_bf16 a[140:143], a[232:235], v[212:215], a[140:143]
buffer_load_dwordx4 v[96:99], v1, s[4:7], s38 offen offset:1024
v_mfma_f32_16x16x32_bf16 a[144:147], a[236:239], v[200:203], a[144:147]
v_mfma_f32_16x16x32_bf16 a[148:151], a[236:239], v[204:207], a[148:151]
v_mfma_f32_16x16x32_bf16 a[152:155], a[236:239], v[208:211], a[152:155]
v_mfma_f32_16x16x32_bf16 a[156:159], a[236:239], v[212:215], a[156:159]
buffer_load_dwordx4 v[100:103], v1, s[4:7], s39 offen offset:1024
s_waitcnt vmcnt(42)
s_waitcnt lgkmcnt(0)
v_mfma_f32_16x16x32_bf16 a[0:3], v[104:107], v[184:187], a[0:3]
v_mfma_f32_16x16x32_bf16 a[4:7], v[104:107], v[188:191], a[4:7]
v_mfma_f32_16x16x32_bf16 a[8:11], v[104:107], v[192:195], a[8:11]
v_mfma_f32_16x16x32_bf16 a[12:15], v[104:107], v[196:199], a[12:15]
ds_read_b128 v[200:203], v1 offset:3072
buffer_load_dwordx4 v[104:107], v1, s[4:7], s30 offen offset:2048
v_mfma_f32_16x16x32_bf16 a[16:19], v[108:111], v[184:187], a[16:19]
v_mfma_f32_16x16x32_bf16 a[20:23], v[108:111], v[188:191], a[20:23]
v_mfma_f32_16x16x32_bf16 a[24:27], v[108:111], v[192:195], a[24:27]
v_mfma_f32_16x16x32_bf16 a[28:31], v[108:111], v[196:199], a[28:31]
ds_read_b128 v[204:207], v1 offset:27648
buffer_load_dwordx4 v[108:111], v1, s[4:7], s31 offen offset:2048
v_mfma_f32_16x16x32_bf16 a[32:35], v[112:115], v[184:187], a[32:35]
v_mfma_f32_16x16x32_bf16 a[36:39], v[112:115], v[188:191], a[36:39]
v_mfma_f32_16x16x32_bf16 a[40:43], v[112:115], v[192:195], a[40:43]
v_mfma_f32_16x16x32_bf16 a[44:47], v[112:115], v[196:199], a[44:47]
ds_read_b128 v[208:211], v6 offset:3072
buffer_load_dwordx4 v[112:115], v1, s[4:7], s32 offen offset:2048
v_mfma_f32_16x16x32_bf16 a[48:51], v[116:119], v[184:187], a[48:51]
v_mfma_f32_16x16x32_bf16 a[52:55], v[116:119], v[188:191], a[52:55]
v_mfma_f32_16x16x32_bf16 a[56:59], v[116:119], v[192:195], a[56:59]
v_mfma_f32_16x16x32_bf16 a[60:63], v[116:119], v[196:199], a[60:63]
ds_read_b128 v[212:215], v6 offset:27648
buffer_load_dwordx4 v[116:119], v1, s[4:7], s33 offen offset:2048
v_mfma_f32_16x16x32_bf16 a[64:67], v[120:123], v[184:187], a[64:67]
v_mfma_f32_16x16x32_bf16 a[68:71], v[120:123], v[188:191], a[68:71]
v_mfma_f32_16x16x32_bf16 a[72:75], v[120:123], v[192:195], a[72:75]
v_mfma_f32_16x16x32_bf16 a[76:79], v[120:123], v[196:199], a[76:79]
buffer_load_dwordx4 v[120:123], v1, s[4:7], s34 offen offset:2048
v_mfma_f32_16x16x32_bf16 a[80:83], v[124:127], v[184:187], a[80:83]
v_mfma_f32_16x16x32_bf16 a[84:87], v[124:127], v[188:191], a[84:87]
v_mfma_f32_16x16x32_bf16 a[88:91], v[124:127], v[192:195], a[88:91]
v_mfma_f32_16x16x32_bf16 a[92:95], v[124:127], v[196:199], a[92:95]
buffer_load_dwordx4 v[124:127], v1, s[4:7], s35 offen offset:2048
v_mfma_f32_16x16x32_bf16 a[96:99], v[128:131], v[184:187], a[96:99]
v_mfma_f32_16x16x32_bf16 a[100:103], v[128:131], v[188:191], a[100:103]
v_mfma_f32_16x16x32_bf16 a[104:107], v[128:131], v[192:195], a[104:107]
v_mfma_f32_16x16x32_bf16 a[108:111], v[128:131], v[196:199], a[108:111]
buffer_load_dwordx4 v[128:131], v1, s[4:7], s36 offen offset:2048
v_mfma_f32_16x16x32_bf16 a[112:115], v[132:135], v[184:187], a[112:115]
v_mfma_f32_16x16x32_bf16 a[116:119], v[132:135], v[188:191], a[116:119]
v_mfma_f32_16x16x32_bf16 a[120:123], v[132:135], v[192:195], a[120:123]
v_mfma_f32_16x16x32_bf16 a[124:127], v[132:135], v[196:199], a[124:127]
buffer_load_dwordx4 v[132:135], v1, s[4:7], s37 offen offset:2048
v_mfma_f32_16x16x32_bf16 a[128:131], v[136:139], v[184:187], a[128:131]
v_mfma_f32_16x16x32_bf16 a[132:135], v[136:139], v[188:191], a[132:135]
v_mfma_f32_16x16x32_bf16 a[136:139], v[136:139], v[192:195], a[136:139]
v_mfma_f32_16x16x32_bf16 a[140:143], v[136:139], v[196:199], a[140:143]
buffer_load_dwordx4 v[136:139], v1, s[4:7], s38 offen offset:2048
v_mfma_f32_16x16x32_bf16 a[144:147], v[140:143], v[184:187], a[144:147]
v_mfma_f32_16x16x32_bf16 a[148:151], v[140:143], v[188:191], a[148:151]
v_mfma_f32_16x16x32_bf16 a[152:155], v[140:143], v[192:195], a[152:155]
v_mfma_f32_16x16x32_bf16 a[156:159], v[140:143], v[196:199], a[156:159]
buffer_load_dwordx4 v[140:143], v1, s[4:7], s39 offen offset:2048
s_waitcnt vmcnt(36)
s_waitcnt lgkmcnt(0)
v_mfma_f32_16x16x32_bf16 a[0:3], v[144:147], v[200:203], a[0:3]
v_mfma_f32_16x16x32_bf16 a[4:7], v[144:147], v[204:207], a[4:7]
v_mfma_f32_16x16x32_bf16 a[8:11], v[144:147], v[208:211], a[8:11]
v_mfma_f32_16x16x32_bf16 a[12:15], v[144:147], v[212:215], a[12:15]
ds_read_b128 v[184:187], v1 offset:4096
buffer_load_dwordx4 v[144:147], v1, s[4:7], s30 offen offset:3072
s_add_u32 s30, s30, 4096
v_mfma_f32_16x16x32_bf16 a[16:19], v[148:151], v[200:203], a[16:19]
v_mfma_f32_16x16x32_bf16 a[20:23], v[148:151], v[204:207], a[20:23]
v_mfma_f32_16x16x32_bf16 a[24:27], v[148:151], v[208:211], a[24:27]
v_mfma_f32_16x16x32_bf16 a[28:31], v[148:151], v[212:215], a[28:31]
ds_read_b128 v[188:191], v1 offset:28672
buffer_load_dwordx4 v[148:151], v1, s[4:7], s31 offen offset:3072
s_add_u32 s31, s31, 4096
v_mfma_f32_16x16x32_bf16 a[32:35], v[152:155], v[200:203], a[32:35]
v_mfma_f32_16x16x32_bf16 a[36:39], v[152:155], v[204:207], a[36:39]
v_mfma_f32_16x16x32_bf16 a[40:43], v[152:155], v[208:211], a[40:43]
v_mfma_f32_16x16x32_bf16 a[44:47], v[152:155], v[212:215], a[44:47]
ds_read_b128 v[192:195], v6 offset:4096
buffer_load_dwordx4 v[152:155], v1, s[4:7], s32 offen offset:3072
s_add_u32 s32, s32, 4096
v_mfma_f32_16x16x32_bf16 a[48:51], v[156:159], v[200:203], a[48:51]
v_mfma_f32_16x16x32_bf16 a[52:55], v[156:159], v[204:207], a[52:55]
v_mfma_f32_16x16x32_bf16 a[56:59], v[156:159], v[208:211], a[56:59]
v_mfma_f32_16x16x32_bf16 a[60:63], v[156:159], v[212:215], a[60:63]
ds_read_b128 v[196:199], v6 offset:28672
buffer_load_dwordx4 v[156:159], v1, s[4:7], s33 offen offset:3072
s_add_u32 s33, s33, 4096
v_mfma_f32_16x16x32_bf16 a[64:67], v[160:163], v[200:203], a[64:67]
v_mfma_f32_16x16x32_bf16 a[68:71], v[160:163], v[204:207], a[68:71]
v_mfma_f32_16x16x32_bf16 a[72:75], v[160:163], v[208:211], a[72:75]
v_mfma_f32_16x16x32_bf16 a[76:79], v[160:163], v[212:215], a[76:79]
buffer_load_dwordx4 v[160:163], v1, s[4:7], s34 offen offset:3072
s_add_u32 s34, s34, 4096
v_mfma_f32_16x16x32_bf16 a[80:83], v[164:167], v[200:203], a[80:83]
v_mfma_f32_16x16x32_bf16 a[84:87], v[164:167], v[204:207], a[84:87]
v_mfma_f32_16x16x32_bf16 a[88:91], v[164:167], v[208:211], a[88:91]
v_mfma_f32_16x16x32_bf16 a[92:95], v[164:167], v[212:215], a[92:95]
buffer_load_dwordx4 v[164:167], v1, s[4:7], s35 offen offset:3072
s_add_u32 s35, s35, 4096
v_mfma_f32_16x16x32_bf16 a[96:99], v[168:171], v[200:203], a[96:99]
v_mfma_f32_16x16x32_bf16 a[100:103], v[168:171], v[204:207], a[100:103]
v_mfma_f32_16x16x32_bf16 a[104:107], v[168:171], v[208:211], a[104:107]
v_mfma_f32_16x16x32_bf16 a[108:111], v[168:171], v[212:215], a[108:111]
buffer_load_dwordx4 v[168:171], v1, s[4:7], s36 offen offset:3072
s_add_u32 s36, s36, 4096
v_mfma_f32_16x16x32_bf16 a[112:115], v[172:175], v[200:203], a[112:115]
v_mfma_f32_16x16x32_bf16 a[116:119], v[172:175], v[204:207], a[116:119]
v_mfma_f32_16x16x32_bf16 a[120:123], v[172:175], v[208:211], a[120:123]
v_mfma_f32_16x16x32_bf16 a[124:127], v[172:175], v[212:215], a[124:127]
buffer_load_dwordx4 v[172:175], v1, s[4:7], s37 offen offset:3072
s_add_u32 s37, s37, 4096
v_mfma_f32_16x16x32_bf16 a[128:131], v[176:179], v[200:203], a[128:131]
v_mfma_f32_16x16x32_bf16 a[132:135], v[176:179], v[204:207], a[132:135]
v_mfma_f32_16x16x32_bf16 a[136:139], v[176:179], v[208:211], a[136:139]
v_mfma_f32_16x16x32_bf16 a[140:143], v[176:179], v[212:215], a[140:143]
buffer_load_dwordx4 v[176:179], v1, s[4:7], s38 offen offset:3072
s_add_u32 s38, s38, 4096
v_mfma_f32_16x16x32_bf16 a[144:147], v[180:183], v[200:203], a[144:147]
v_mfma_f32_16x16x32_bf16 a[148:151], v[180:183], v[204:207], a[148:151]
v_mfma_f32_16x16x32_bf16 a[152:155], v[180:183], v[208:211], a[152:155]
v_mfma_f32_16x16x32_bf16 a[156:159], v[180:183], v[212:215], a[156:159]
buffer_load_dwordx4 v[180:183], v1, s[4:7], s39 offen offset:3072
s_add_u32 s39, s39, 4096
s_waitcnt vmcnt(36)
s_waitcnt lgkmcnt(0)
v_mfma_f32_16x16x32_bf16 a[0:3], v[24:27], v[184:187], a[0:3]
v_mfma_f32_16x16x32_bf16 a[4:7], v[24:27], v[188:191], a[4:7]
v_mfma_f32_16x16x32_bf16 a[8:11], v[24:27], v[192:195], a[8:11]
v_mfma_f32_16x16x32_bf16 a[12:15], v[24:27], v[196:199], a[12:15]
ds_read_b128 v[200:203], v1 offset:5120
buffer_load_dwordx4 v[24:27], v1, s[4:7], s30 offen offset:0
v_mfma_f32_16x16x32_bf16 a[16:19], v[28:31], v[184:187], a[16:19]
v_mfma_f32_16x16x32_bf16 a[20:23], v[28:31], v[188:191], a[20:23]
v_mfma_f32_16x16x32_bf16 a[24:27], v[28:31], v[192:195], a[24:27]
v_mfma_f32_16x16x32_bf16 a[28:31], v[28:31], v[196:199], a[28:31]
ds_read_b128 v[204:207], v1 offset:29696
buffer_load_dwordx4 v[28:31], v1, s[4:7], s31 offen offset:0
v_mfma_f32_16x16x32_bf16 a[32:35], v[32:35], v[184:187], a[32:35]
v_mfma_f32_16x16x32_bf16 a[36:39], v[32:35], v[188:191], a[36:39]
v_mfma_f32_16x16x32_bf16 a[40:43], v[32:35], v[192:195], a[40:43]
v_mfma_f32_16x16x32_bf16 a[44:47], v[32:35], v[196:199], a[44:47]
ds_read_b128 v[208:211], v6 offset:5120
buffer_load_dwordx4 v[32:35], v1, s[4:7], s32 offen offset:0
v_mfma_f32_16x16x32_bf16 a[48:51], v[36:39], v[184:187], a[48:51]
v_mfma_f32_16x16x32_bf16 a[52:55], v[36:39], v[188:191], a[52:55]
v_mfma_f32_16x16x32_bf16 a[56:59], v[36:39], v[192:195], a[56:59]
v_mfma_f32_16x16x32_bf16 a[60:63], v[36:39], v[196:199], a[60:63]
ds_read_b128 v[212:215], v6 offset:29696
buffer_load_dwordx4 v[36:39], v1, s[4:7], s33 offen offset:0
v_mfma_f32_16x16x32_bf16 a[64:67], v[40:43], v[184:187], a[64:67]
v_mfma_f32_16x16x32_bf16 a[68:71], v[40:43], v[188:191], a[68:71]
v_mfma_f32_16x16x32_bf16 a[72:75], v[40:43], v[192:195], a[72:75]
v_mfma_f32_16x16x32_bf16 a[76:79], v[40:43], v[196:199], a[76:79]
buffer_load_dwordx4 v[40:43], v1, s[4:7], s34 offen offset:0
v_mfma_f32_16x16x32_bf16 a[80:83], v[44:47], v[184:187], a[80:83]
v_mfma_f32_16x16x32_bf16 a[84:87], v[44:47], v[188:191], a[84:87]
v_mfma_f32_16x16x32_bf16 a[88:91], v[44:47], v[192:195], a[88:91]
v_mfma_f32_16x16x32_bf16 a[92:95], v[44:47], v[196:199], a[92:95]
buffer_load_dwordx4 v[44:47], v1, s[4:7], s35 offen offset:0
v_mfma_f32_16x16x32_bf16 a[96:99], v[48:51], v[184:187], a[96:99]
v_mfma_f32_16x16x32_bf16 a[100:103], v[48:51], v[188:191], a[100:103]
v_mfma_f32_16x16x32_bf16 a[104:107], v[48:51], v[192:195], a[104:107]
v_mfma_f32_16x16x32_bf16 a[108:111], v[48:51], v[196:199], a[108:111]
buffer_load_dwordx4 v[48:51], v1, s[4:7], s36 offen offset:0
v_mfma_f32_16x16x32_bf16 a[112:115], v[52:55], v[184:187], a[112:115]
v_mfma_f32_16x16x32_bf16 a[116:119], v[52:55], v[188:191], a[116:119]
v_mfma_f32_16x16x32_bf16 a[120:123], v[52:55], v[192:195], a[120:123]
v_mfma_f32_16x16x32_bf16 a[124:127], v[52:55], v[196:199], a[124:127]
buffer_load_dwordx4 v[52:55], v1, s[4:7], s37 offen offset:0
v_mfma_f32_16x16x32_bf16 a[128:131], v[56:59], v[184:187], a[128:131]
v_mfma_f32_16x16x32_bf16 a[132:135], v[56:59], v[188:191], a[132:135]
v_mfma_f32_16x16x32_bf16 a[136:139], v[56:59], v[192:195], a[136:139]
v_mfma_f32_16x16x32_bf16 a[140:143], v[56:59], v[196:199], a[140:143]
buffer_load_dwordx4 v[56:59], v1, s[4:7], s38 offen offset:0
v_mfma_f32_16x16x32_bf16 a[144:147], v[60:63], v[184:187], a[144:147]
v_mfma_f32_16x16x32_bf16 a[148:151], v[60:63], v[188:191], a[148:151]
v_mfma_f32_16x16x32_bf16 a[152:155], v[60:63], v[192:195], a[152:155]
v_mfma_f32_16x16x32_bf16 a[156:159], v[60:63], v[196:199], a[156:159]
buffer_load_dwordx4 v[60:63], v1, s[4:7], s39 offen offset:0
s_barrier
s_waitcnt vmcnt(30)
s_waitcnt lgkmcnt(0)
v_mfma_f32_16x16x32_bf16 a[0:3], v[64:67], v[200:203], a[0:3]
v_mfma_f32_16x16x32_bf16 a[4:7], v[64:67], v[204:207], a[4:7]
v_mfma_f32_16x16x32_bf16 a[8:11], v[64:67], v[208:211], a[8:11]
v_mfma_f32_16x16x32_bf16 a[12:15], v[64:67], v[212:215], a[12:15]
ds_read_b128 v[184:187], v1 offset:6144
buffer_load_dwordx4 v[64:67], v1, s[4:7], s30 offen offset:1024
v_mfma_f32_16x16x32_bf16 a[16:19], v[68:71], v[200:203], a[16:19]
v_mfma_f32_16x16x32_bf16 a[20:23], v[68:71], v[204:207], a[20:23]
v_mfma_f32_16x16x32_bf16 a[24:27], v[68:71], v[208:211], a[24:27]
v_mfma_f32_16x16x32_bf16 a[28:31], v[68:71], v[212:215], a[28:31]
ds_read_b128 v[188:191], v1 offset:30720
buffer_load_dwordx4 v[68:71], v1, s[4:7], s31 offen offset:1024
v_mfma_f32_16x16x32_bf16 a[32:35], v[72:75], v[200:203], a[32:35]
v_mfma_f32_16x16x32_bf16 a[36:39], v[72:75], v[204:207], a[36:39]
v_mfma_f32_16x16x32_bf16 a[40:43], v[72:75], v[208:211], a[40:43]
v_mfma_f32_16x16x32_bf16 a[44:47], v[72:75], v[212:215], a[44:47]
ds_read_b128 v[192:195], v6 offset:6144
buffer_load_dwordx4 v[72:75], v1, s[4:7], s32 offen offset:1024
v_mfma_f32_16x16x32_bf16 a[48:51], v[76:79], v[200:203], a[48:51]
v_mfma_f32_16x16x32_bf16 a[52:55], v[76:79], v[204:207], a[52:55]
v_mfma_f32_16x16x32_bf16 a[56:59], v[76:79], v[208:211], a[56:59]
v_mfma_f32_16x16x32_bf16 a[60:63], v[76:79], v[212:215], a[60:63]
ds_read_b128 v[196:199], v6 offset:30720
buffer_load_dwordx4 v[76:79], v1, s[4:7], s33 offen offset:1024
v_mfma_f32_16x16x32_bf16 a[64:67], v[80:83], v[200:203], a[64:67]
v_mfma_f32_16x16x32_bf16 a[68:71], v[80:83], v[204:207], a[68:71]
v_mfma_f32_16x16x32_bf16 a[72:75], v[80:83], v[208:211], a[72:75]
v_mfma_f32_16x16x32_bf16 a[76:79], v[80:83], v[212:215], a[76:79]
buffer_load_dwordx4 v[80:83], v1, s[4:7], s34 offen offset:1024
v_mfma_f32_16x16x32_bf16 a[80:83], v[84:87], v[200:203], a[80:83]
v_mfma_f32_16x16x32_bf16 a[84:87], v[84:87], v[204:207], a[84:87]
v_mfma_f32_16x16x32_bf16 a[88:91], v[84:87], v[208:211], a[88:91]
v_mfma_f32_16x16x32_bf16 a[92:95], v[84:87], v[212:215], a[92:95]
buffer_load_dwordx4 v[84:87], v1, s[4:7], s35 offen offset:1024
v_mfma_f32_16x16x32_bf16 a[96:99], v[88:91], v[200:203], a[96:99]
v_mfma_f32_16x16x32_bf16 a[100:103], v[88:91], v[204:207], a[100:103]
v_mfma_f32_16x16x32_bf16 a[104:107], v[88:91], v[208:211], a[104:107]
v_mfma_f32_16x16x32_bf16 a[108:111], v[88:91], v[212:215], a[108:111]
buffer_load_dwordx4 v[88:91], v1, s[4:7], s36 offen offset:1024
v_mfma_f32_16x16x32_bf16 a[112:115], v[92:95], v[200:203], a[112:115]
v_mfma_f32_16x16x32_bf16 a[116:119], v[92:95], v[204:207], a[116:119]
v_mfma_f32_16x16x32_bf16 a[120:123], v[92:95], v[208:211], a[120:123]
v_mfma_f32_16x16x32_bf16 a[124:127], v[92:95], v[212:215], a[124:127]
buffer_load_dwordx4 v[92:95], v1, s[4:7], s37 offen offset:1024
v_mfma_f32_16x16x32_bf16 a[128:131], v[96:99], v[200:203], a[128:131]
v_mfma_f32_16x16x32_bf16 a[132:135], v[96:99], v[204:207], a[132:135]
v_mfma_f32_16x16x32_bf16 a[136:139], v[96:99], v[208:211], a[136:139]
v_mfma_f32_16x16x32_bf16 a[140:143], v[96:99], v[212:215], a[140:143]
buffer_load_dwordx4 v[96:99], v1, s[4:7], s38 offen offset:1024
v_mfma_f32_16x16x32_bf16 a[144:147], v[100:103], v[200:203], a[144:147]
v_mfma_f32_16x16x32_bf16 a[148:151], v[100:103], v[204:207], a[148:151]
v_mfma_f32_16x16x32_bf16 a[152:155], v[100:103], v[208:211], a[152:155]
v_mfma_f32_16x16x32_bf16 a[156:159], v[100:103], v[212:215], a[156:159]
buffer_load_dwordx4 v[100:103], v1, s[4:7], s39 offen offset:1024
s_waitcnt vmcnt(30)
s_waitcnt lgkmcnt(0)
v_mfma_f32_16x16x32_bf16 a[0:3], v[104:107], v[184:187], a[0:3]
v_mfma_f32_16x16x32_bf16 a[4:7], v[104:107], v[188:191], a[4:7]
v_mfma_f32_16x16x32_bf16 a[8:11], v[104:107], v[192:195], a[8:11]
v_mfma_f32_16x16x32_bf16 a[12:15], v[104:107], v[196:199], a[12:15]
ds_read_b128 v[200:203], v1 offset:7168
buffer_load_dwordx4 v[104:107], v1, s[4:7], s30 offen offset:2048
v_mfma_f32_16x16x32_bf16 a[16:19], v[108:111], v[184:187], a[16:19]
v_mfma_f32_16x16x32_bf16 a[20:23], v[108:111], v[188:191], a[20:23]
v_mfma_f32_16x16x32_bf16 a[24:27], v[108:111], v[192:195], a[24:27]
v_mfma_f32_16x16x32_bf16 a[28:31], v[108:111], v[196:199], a[28:31]
ds_read_b128 v[204:207], v1 offset:31744
buffer_load_dwordx4 v[108:111], v1, s[4:7], s31 offen offset:2048
v_mfma_f32_16x16x32_bf16 a[32:35], v[112:115], v[184:187], a[32:35]
v_mfma_f32_16x16x32_bf16 a[36:39], v[112:115], v[188:191], a[36:39]
v_mfma_f32_16x16x32_bf16 a[40:43], v[112:115], v[192:195], a[40:43]
v_mfma_f32_16x16x32_bf16 a[44:47], v[112:115], v[196:199], a[44:47]
ds_read_b128 v[208:211], v6 offset:7168
buffer_load_dwordx4 v[112:115], v1, s[4:7], s32 offen offset:2048
v_mfma_f32_16x16x32_bf16 a[48:51], v[116:119], v[184:187], a[48:51]
v_mfma_f32_16x16x32_bf16 a[52:55], v[116:119], v[188:191], a[52:55]
v_mfma_f32_16x16x32_bf16 a[56:59], v[116:119], v[192:195], a[56:59]
v_mfma_f32_16x16x32_bf16 a[60:63], v[116:119], v[196:199], a[60:63]
ds_read_b128 v[212:215], v6 offset:31744
buffer_load_dwordx4 v[116:119], v1, s[4:7], s33 offen offset:2048
v_mfma_f32_16x16x32_bf16 a[64:67], v[120:123], v[184:187], a[64:67]
v_mfma_f32_16x16x32_bf16 a[68:71], v[120:123], v[188:191], a[68:71]
v_mfma_f32_16x16x32_bf16 a[72:75], v[120:123], v[192:195], a[72:75]
v_mfma_f32_16x16x32_bf16 a[76:79], v[120:123], v[196:199], a[76:79]
buffer_load_dwordx4 v[120:123], v1, s[4:7], s34 offen offset:2048
v_mfma_f32_16x16x32_bf16 a[80:83], v[124:127], v[184:187], a[80:83]
v_mfma_f32_16x16x32_bf16 a[84:87], v[124:127], v[188:191], a[84:87]
v_mfma_f32_16x16x32_bf16 a[88:91], v[124:127], v[192:195], a[88:91]
v_mfma_f32_16x16x32_bf16 a[92:95], v[124:127], v[196:199], a[92:95]
buffer_load_dwordx4 v[124:127], v1, s[4:7], s35 offen offset:2048
v_mfma_f32_16x16x32_bf16 a[96:99], v[128:131], v[184:187], a[96:99]
v_mfma_f32_16x16x32_bf16 a[100:103], v[128:131], v[188:191], a[100:103]
v_mfma_f32_16x16x32_bf16 a[104:107], v[128:131], v[192:195], a[104:107]
v_mfma_f32_16x16x32_bf16 a[108:111], v[128:131], v[196:199], a[108:111]
buffer_load_dwordx4 v[128:131], v1, s[4:7], s36 offen offset:2048
v_mfma_f32_16x16x32_bf16 a[112:115], v[132:135], v[184:187], a[112:115]
v_mfma_f32_16x16x32_bf16 a[116:119], v[132:135], v[188:191], a[116:119]
v_mfma_f32_16x16x32_bf16 a[120:123], v[132:135], v[192:195], a[120:123]
v_mfma_f32_16x16x32_bf16 a[124:127], v[132:135], v[196:199], a[124:127]
buffer_load_dwordx4 v[132:135], v1, s[4:7], s37 offen offset:2048
v_mfma_f32_16x16x32_bf16 a[128:131], v[136:139], v[184:187], a[128:131]
v_mfma_f32_16x16x32_bf16 a[132:135], v[136:139], v[188:191], a[132:135]
v_mfma_f32_16x16x32_bf16 a[136:139], v[136:139], v[192:195], a[136:139]
v_mfma_f32_16x16x32_bf16 a[140:143], v[136:139], v[196:199], a[140:143]
buffer_load_dwordx4 v[136:139], v1, s[4:7], s38 offen offset:2048
v_mfma_f32_16x16x32_bf16 a[144:147], v[140:143], v[184:187], a[144:147]
v_mfma_f32_16x16x32_bf16 a[148:151], v[140:143], v[188:191], a[148:151]
v_mfma_f32_16x16x32_bf16 a[152:155], v[140:143], v[192:195], a[152:155]
v_mfma_f32_16x16x32_bf16 a[156:159], v[140:143], v[196:199], a[156:159]
buffer_load_dwordx4 v[140:143], v1, s[4:7], s39 offen offset:2048
s_waitcnt vmcnt(30)
s_waitcnt lgkmcnt(0)
v_mfma_f32_16x16x32_bf16 a[0:3], v[144:147], v[200:203], a[0:3]
v_mfma_f32_16x16x32_bf16 a[4:7], v[144:147], v[204:207], a[4:7]
v_mfma_f32_16x16x32_bf16 a[8:11], v[144:147], v[208:211], a[8:11]
v_mfma_f32_16x16x32_bf16 a[12:15], v[144:147], v[212:215], a[12:15]
ds_read_b128 v[184:187], v1 offset:8192
buffer_load_dwordx4 v[144:147], v1, s[4:7], s30 offen offset:3072
s_add_u32 s30, s30, 4096
v_mfma_f32_16x16x32_bf16 a[16:19], v[148:151], v[200:203], a[16:19]
v_mfma_f32_16x16x32_bf16 a[20:23], v[148:151], v[204:207], a[20:23]
v_mfma_f32_16x16x32_bf16 a[24:27], v[148:151], v[208:211], a[24:27]
v_mfma_f32_16x16x32_bf16 a[28:31], v[148:151], v[212:215], a[28:31]
ds_read_b128 v[188:191], v1 offset:32768
buffer_load_dwordx4 v[148:151], v1, s[4:7], s31 offen offset:3072
s_add_u32 s31, s31, 4096
v_mfma_f32_16x16x32_bf16 a[32:35], v[152:155], v[200:203], a[32:35]
v_mfma_f32_16x16x32_bf16 a[36:39], v[152:155], v[204:207], a[36:39]
v_mfma_f32_16x16x32_bf16 a[40:43], v[152:155], v[208:211], a[40:43]
v_mfma_f32_16x16x32_bf16 a[44:47], v[152:155], v[212:215], a[44:47]
ds_read_b128 v[192:195], v6 offset:8192
buffer_load_dwordx4 v[152:155], v1, s[4:7], s32 offen offset:3072
s_add_u32 s32, s32, 4096
v_mfma_f32_16x16x32_bf16 a[48:51], v[156:159], v[200:203], a[48:51]
v_mfma_f32_16x16x32_bf16 a[52:55], v[156:159], v[204:207], a[52:55]
v_mfma_f32_16x16x32_bf16 a[56:59], v[156:159], v[208:211], a[56:59]
v_mfma_f32_16x16x32_bf16 a[60:63], v[156:159], v[212:215], a[60:63]
ds_read_b128 v[196:199], v6 offset:32768
buffer_load_dwordx4 v[156:159], v1, s[4:7], s33 offen offset:3072
s_add_u32 s33, s33, 4096
v_mfma_f32_16x16x32_bf16 a[64:67], v[160:163], v[200:203], a[64:67]
v_mfma_f32_16x16x32_bf16 a[68:71], v[160:163], v[204:207], a[68:71]
v_mfma_f32_16x16x32_bf16 a[72:75], v[160:163], v[208:211], a[72:75]
v_mfma_f32_16x16x32_bf16 a[76:79], v[160:163], v[212:215], a[76:79]
buffer_load_dwordx4 v[160:163], v1, s[4:7], s34 offen offset:3072
s_add_u32 s34, s34, 4096
v_mfma_f32_16x16x32_bf16 a[80:83], v[164:167], v[200:203], a[80:83]
v_mfma_f32_16x16x32_bf16 a[84:87], v[164:167], v[204:207], a[84:87]
v_mfma_f32_16x16x32_bf16 a[88:91], v[164:167], v[208:211], a[88:91]
v_mfma_f32_16x16x32_bf16 a[92:95], v[164:167], v[212:215], a[92:95]
buffer_load_dwordx4 v[164:167], v1, s[4:7], s35 offen offset:3072
s_add_u32 s35, s35, 4096
v_mfma_f32_16x16x32_bf16 a[96:99], v[168:171], v[200:203], a[96:99]
v_mfma_f32_16x16x32_bf16 a[100:103], v[168:171], v[204:207], a[100:103]
v_mfma_f32_16x16x32_bf16 a[104:107], v[168:171], v[208:211], a[104:107]
v_mfma_f32_16x16x32_bf16 a[108:111], v[168:171], v[212:215], a[108:111]
buffer_load_dwordx4 v[168:171], v1, s[4:7], s36 offen offset:3072
s_add_u32 s36, s36, 4096
v_mfma_f32_16x16x32_bf16 a[112:115], v[172:175], v[200:203], a[112:115]
v_mfma_f32_16x16x32_bf16 a[116:119], v[172:175], v[204:207], a[116:119]
v_mfma_f32_16x16x32_bf16 a[120:123], v[172:175], v[208:211], a[120:123]
v_mfma_f32_16x16x32_bf16 a[124:127], v[172:175], v[212:215], a[124:127]
buffer_load_dwordx4 v[172:175], v1, s[4:7], s37 offen offset:3072
s_add_u32 s37, s37, 4096
v_mfma_f32_16x16x32_bf16 a[128:131], v[176:179], v[200:203], a[128:131]
v_mfma_f32_16x16x32_bf16 a[132:135], v[176:179], v[204:207], a[132:135]
v_mfma_f32_16x16x32_bf16 a[136:139], v[176:179], v[208:211], a[136:139]
v_mfma_f32_16x16x32_bf16 a[140:143], v[176:179], v[212:215], a[140:143]
buffer_load_dwordx4 v[176:179], v1, s[4:7], s38 offen offset:3072
s_add_u32 s38, s38, 4096
v_mfma_f32_16x16x32_bf16 a[144:147], v[180:183], v[200:203], a[144:147]
v_mfma_f32_16x16x32_bf16 a[148:151], v[180:183], v[204:207], a[148:151]
v_mfma_f32_16x16x32_bf16 a[152:155], v[180:183], v[208:211], a[152:155]
v_mfma_f32_16x16x32_bf16 a[156:159], v[180:183], v[212:215], a[156:159]
buffer_load_dwordx4 v[180:183], v1, s[4:7], s39 offen offset:3072
s_add_u32 s39, s39, 4096
s_waitcnt vmcnt(30)
s_waitcnt lgkmcnt(0)
v_mfma_f32_16x16x32_bf16 a[0:3], v[24:27], v[184:187], a[0:3]
v_mfma_f32_16x16x32_bf16 a[4:7], v[24:27], v[188:191], a[4:7]
v_mfma_f32_16x16x32_bf16 a[8:11], v[24:27], v[192:195], a[8:11]
v_mfma_f32_16x16x32_bf16 a[12:15], v[24:27], v[196:199], a[12:15]
ds_read_b128 v[200:203], v1 offset:9216
buffer_load_dwordx4 v[24:27], v1, s[4:7], s30 offen offset:0
v_mfma_f32_16x16x32_bf16 a[16:19], v[28:31], v[184:187], a[16:19]
v_mfma_f32_16x16x32_bf16 a[20:23], v[28:31], v[188:191], a[20:23]
v_mfma_f32_16x16x32_bf16 a[24:27], v[28:31], v[192:195], a[24:27]
v_mfma_f32_16x16x32_bf16 a[28:31], v[28:31], v[196:199], a[28:31]
ds_read_b128 v[204:207], v1 offset:33792
buffer_load_dwordx4 v[28:31], v1, s[4:7], s31 offen offset:0
v_mfma_f32_16x16x32_bf16 a[32:35], v[32:35], v[184:187], a[32:35]
v_mfma_f32_16x16x32_bf16 a[36:39], v[32:35], v[188:191], a[36:39]
v_mfma_f32_16x16x32_bf16 a[40:43], v[32:35], v[192:195], a[40:43]
v_mfma_f32_16x16x32_bf16 a[44:47], v[32:35], v[196:199], a[44:47]
ds_read_b128 v[208:211], v6 offset:9216
buffer_load_dwordx4 v[32:35], v1, s[4:7], s32 offen offset:0
v_mfma_f32_16x16x32_bf16 a[48:51], v[36:39], v[184:187], a[48:51]
v_mfma_f32_16x16x32_bf16 a[52:55], v[36:39], v[188:191], a[52:55]
v_mfma_f32_16x16x32_bf16 a[56:59], v[36:39], v[192:195], a[56:59]
v_mfma_f32_16x16x32_bf16 a[60:63], v[36:39], v[196:199], a[60:63]
ds_read_b128 v[212:215], v6 offset:33792
buffer_load_dwordx4 v[36:39], v1, s[4:7], s33 offen offset:0
v_mfma_f32_16x16x32_bf16 a[64:67], v[40:43], v[184:187], a[64:67]
v_mfma_f32_16x16x32_bf16 a[68:71], v[40:43], v[188:191], a[68:71]
v_mfma_f32_16x16x32_bf16 a[72:75], v[40:43], v[192:195], a[72:75]
v_mfma_f32_16x16x32_bf16 a[76:79], v[40:43], v[196:199], a[76:79]
buffer_load_dwordx4 v[40:43], v1, s[4:7], s34 offen offset:0
v_mfma_f32_16x16x32_bf16 a[80:83], v[44:47], v[184:187], a[80:83]
v_mfma_f32_16x16x32_bf16 a[84:87], v[44:47], v[188:191], a[84:87]
v_mfma_f32_16x16x32_bf16 a[88:91], v[44:47], v[192:195], a[88:91]
v_mfma_f32_16x16x32_bf16 a[92:95], v[44:47], v[196:199], a[92:95]
buffer_load_dwordx4 v[44:47], v1, s[4:7], s35 offen offset:0
v_mfma_f32_16x16x32_bf16 a[96:99], v[48:51], v[184:187], a[96:99]
v_mfma_f32_16x16x32_bf16 a[100:103], v[48:51], v[188:191], a[100:103]
v_mfma_f32_16x16x32_bf16 a[104:107], v[48:51], v[192:195], a[104:107]
v_mfma_f32_16x16x32_bf16 a[108:111], v[48:51], v[196:199], a[108:111]
buffer_load_dwordx4 v[48:51], v1, s[4:7], s36 offen offset:0
v_mfma_f32_16x16x32_bf16 a[112:115], v[52:55], v[184:187], a[112:115]
v_mfma_f32_16x16x32_bf16 a[116:119], v[52:55], v[188:191], a[116:119]
v_mfma_f32_16x16x32_bf16 a[120:123], v[52:55], v[192:195], a[120:123]
v_mfma_f32_16x16x32_bf16 a[124:127], v[52:55], v[196:199], a[124:127]
buffer_load_dwordx4 v[52:55], v1, s[4:7], s37 offen offset:0
v_mfma_f32_16x16x32_bf16 a[128:131], v[56:59], v[184:187], a[128:131]
v_mfma_f32_16x16x32_bf16 a[132:135], v[56:59], v[188:191], a[132:135]
v_mfma_f32_16x16x32_bf16 a[136:139], v[56:59], v[192:195], a[136:139]
v_mfma_f32_16x16x32_bf16 a[140:143], v[56:59], v[196:199], a[140:143]
buffer_load_dwordx4 v[56:59], v1, s[4:7], s38 offen offset:0
v_mfma_f32_16x16x32_bf16 a[144:147], v[60:63], v[184:187], a[144:147]
v_mfma_f32_16x16x32_bf16 a[148:151], v[60:63], v[188:191], a[148:151]
v_mfma_f32_16x16x32_bf16 a[152:155], v[60:63], v[192:195], a[152:155]
v_mfma_f32_16x16x32_bf16 a[156:159], v[60:63], v[196:199], a[156:159]
buffer_load_dwordx4 v[60:63], v1, s[4:7], s39 offen offset:0
s_waitcnt vmcnt(30)
s_waitcnt lgkmcnt(0)
v_mfma_f32_16x16x32_bf16 a[0:3], v[64:67], v[200:203], a[0:3]
v_mfma_f32_16x16x32_bf16 a[4:7], v[64:67], v[204:207], a[4:7]
v_mfma_f32_16x16x32_bf16 a[8:11], v[64:67], v[208:211], a[8:11]
v_mfma_f32_16x16x32_bf16 a[12:15], v[64:67], v[212:215], a[12:15]
ds_read_b128 v[184:187], v1 offset:10240
buffer_load_dwordx4 v[64:67], v1, s[4:7], s30 offen offset:1024
v_mfma_f32_16x16x32_bf16 a[16:19], v[68:71], v[200:203], a[16:19]
v_mfma_f32_16x16x32_bf16 a[20:23], v[68:71], v[204:207], a[20:23]
v_mfma_f32_16x16x32_bf16 a[24:27], v[68:71], v[208:211], a[24:27]
v_mfma_f32_16x16x32_bf16 a[28:31], v[68:71], v[212:215], a[28:31]
ds_read_b128 v[188:191], v1 offset:34816
buffer_load_dwordx4 v[68:71], v1, s[4:7], s31 offen offset:1024
v_mfma_f32_16x16x32_bf16 a[32:35], v[72:75], v[200:203], a[32:35]
v_mfma_f32_16x16x32_bf16 a[36:39], v[72:75], v[204:207], a[36:39]
v_mfma_f32_16x16x32_bf16 a[40:43], v[72:75], v[208:211], a[40:43]
v_mfma_f32_16x16x32_bf16 a[44:47], v[72:75], v[212:215], a[44:47]
ds_read_b128 v[192:195], v6 offset:10240
buffer_load_dwordx4 v[72:75], v1, s[4:7], s32 offen offset:1024
v_mfma_f32_16x16x32_bf16 a[48:51], v[76:79], v[200:203], a[48:51]
v_mfma_f32_16x16x32_bf16 a[52:55], v[76:79], v[204:207], a[52:55]
v_mfma_f32_16x16x32_bf16 a[56:59], v[76:79], v[208:211], a[56:59]
v_mfma_f32_16x16x32_bf16 a[60:63], v[76:79], v[212:215], a[60:63]
ds_read_b128 v[196:199], v6 offset:34816
buffer_load_dwordx4 v[76:79], v1, s[4:7], s33 offen offset:1024
v_mfma_f32_16x16x32_bf16 a[64:67], v[80:83], v[200:203], a[64:67]
v_mfma_f32_16x16x32_bf16 a[68:71], v[80:83], v[204:207], a[68:71]
v_mfma_f32_16x16x32_bf16 a[72:75], v[80:83], v[208:211], a[72:75]
v_mfma_f32_16x16x32_bf16 a[76:79], v[80:83], v[212:215], a[76:79]
buffer_load_dwordx4 v[80:83], v1, s[4:7], s34 offen offset:1024
v_mfma_f32_16x16x32_bf16 a[80:83], v[84:87], v[200:203], a[80:83]
v_mfma_f32_16x16x32_bf16 a[84:87], v[84:87], v[204:207], a[84:87]
v_mfma_f32_16x16x32_bf16 a[88:91], v[84:87], v[208:211], a[88:91]
v_mfma_f32_16x16x32_bf16 a[92:95], v[84:87], v[212:215], a[92:95]
buffer_load_dwordx4 v[84:87], v1, s[4:7], s35 offen offset:1024
v_mfma_f32_16x16x32_bf16 a[96:99], v[88:91], v[200:203], a[96:99]
v_mfma_f32_16x16x32_bf16 a[100:103], v[88:91], v[204:207], a[100:103]
v_mfma_f32_16x16x32_bf16 a[104:107], v[88:91], v[208:211], a[104:107]
v_mfma_f32_16x16x32_bf16 a[108:111], v[88:91], v[212:215], a[108:111]
buffer_load_dwordx4 v[88:91], v1, s[4:7], s36 offen offset:1024
v_mfma_f32_16x16x32_bf16 a[112:115], v[92:95], v[200:203], a[112:115]
v_mfma_f32_16x16x32_bf16 a[116:119], v[92:95], v[204:207], a[116:119]
v_mfma_f32_16x16x32_bf16 a[120:123], v[92:95], v[208:211], a[120:123]
v_mfma_f32_16x16x32_bf16 a[124:127], v[92:95], v[212:215], a[124:127]
buffer_load_dwordx4 v[92:95], v1, s[4:7], s37 offen offset:1024
v_mfma_f32_16x16x32_bf16 a[128:131], v[96:99], v[200:203], a[128:131]
v_mfma_f32_16x16x32_bf16 a[132:135], v[96:99], v[204:207], a[132:135]
v_mfma_f32_16x16x32_bf16 a[136:139], v[96:99], v[208:211], a[136:139]
v_mfma_f32_16x16x32_bf16 a[140:143], v[96:99], v[212:215], a[140:143]
buffer_load_dwordx4 v[96:99], v1, s[4:7], s38 offen offset:1024
v_mfma_f32_16x16x32_bf16 a[144:147], v[100:103], v[200:203], a[144:147]
v_mfma_f32_16x16x32_bf16 a[148:151], v[100:103], v[204:207], a[148:151]
v_mfma_f32_16x16x32_bf16 a[152:155], v[100:103], v[208:211], a[152:155]
v_mfma_f32_16x16x32_bf16 a[156:159], v[100:103], v[212:215], a[156:159]
buffer_load_dwordx4 v[100:103], v1, s[4:7], s39 offen offset:1024
s_waitcnt vmcnt(30)
s_waitcnt lgkmcnt(0)
v_mfma_f32_16x16x32_bf16 a[0:3], v[104:107], v[184:187], a[0:3]
v_mfma_f32_16x16x32_bf16 a[4:7], v[104:107], v[188:191], a[4:7]
v_mfma_f32_16x16x32_bf16 a[8:11], v[104:107], v[192:195], a[8:11]
v_mfma_f32_16x16x32_bf16 a[12:15], v[104:107], v[196:199], a[12:15]
ds_read_b128 v[200:203], v1 offset:11264
buffer_load_dwordx4 v[104:107], v1, s[4:7], s30 offen offset:2048
v_mfma_f32_16x16x32_bf16 a[16:19], v[108:111], v[184:187], a[16:19]
v_mfma_f32_16x16x32_bf16 a[20:23], v[108:111], v[188:191], a[20:23]
v_mfma_f32_16x16x32_bf16 a[24:27], v[108:111], v[192:195], a[24:27]
v_mfma_f32_16x16x32_bf16 a[28:31], v[108:111], v[196:199], a[28:31]
ds_read_b128 v[204:207], v1 offset:35840
buffer_load_dwordx4 v[108:111], v1, s[4:7], s31 offen offset:2048
v_mfma_f32_16x16x32_bf16 a[32:35], v[112:115], v[184:187], a[32:35]
v_mfma_f32_16x16x32_bf16 a[36:39], v[112:115], v[188:191], a[36:39]
v_mfma_f32_16x16x32_bf16 a[40:43], v[112:115], v[192:195], a[40:43]
v_mfma_f32_16x16x32_bf16 a[44:47], v[112:115], v[196:199], a[44:47]
ds_read_b128 v[208:211], v6 offset:11264
buffer_load_dwordx4 v[112:115], v1, s[4:7], s32 offen offset:2048
v_mfma_f32_16x16x32_bf16 a[48:51], v[116:119], v[184:187], a[48:51]
v_mfma_f32_16x16x32_bf16 a[52:55], v[116:119], v[188:191], a[52:55]
v_mfma_f32_16x16x32_bf16 a[56:59], v[116:119], v[192:195], a[56:59]
v_mfma_f32_16x16x32_bf16 a[60:63], v[116:119], v[196:199], a[60:63]
ds_read_b128 v[212:215], v6 offset:35840
buffer_load_dwordx4 v[116:119], v1, s[4:7], s33 offen offset:2048
v_mfma_f32_16x16x32_bf16 a[64:67], v[120:123], v[184:187], a[64:67]
v_mfma_f32_16x16x32_bf16 a[68:71], v[120:123], v[188:191], a[68:71]
v_mfma_f32_16x16x32_bf16 a[72:75], v[120:123], v[192:195], a[72:75]
v_mfma_f32_16x16x32_bf16 a[76:79], v[120:123], v[196:199], a[76:79]
buffer_load_dwordx4 v[120:123], v1, s[4:7], s34 offen offset:2048
v_mfma_f32_16x16x32_bf16 a[80:83], v[124:127], v[184:187], a[80:83]
v_mfma_f32_16x16x32_bf16 a[84:87], v[124:127], v[188:191], a[84:87]
v_mfma_f32_16x16x32_bf16 a[88:91], v[124:127], v[192:195], a[88:91]
v_mfma_f32_16x16x32_bf16 a[92:95], v[124:127], v[196:199], a[92:95]
buffer_load_dwordx4 v[124:127], v1, s[4:7], s35 offen offset:2048
v_mfma_f32_16x16x32_bf16 a[96:99], v[128:131], v[184:187], a[96:99]
v_mfma_f32_16x16x32_bf16 a[100:103], v[128:131], v[188:191], a[100:103]
v_mfma_f32_16x16x32_bf16 a[104:107], v[128:131], v[192:195], a[104:107]
v_mfma_f32_16x16x32_bf16 a[108:111], v[128:131], v[196:199], a[108:111]
buffer_load_dwordx4 v[128:131], v1, s[4:7], s36 offen offset:2048
v_mfma_f32_16x16x32_bf16 a[112:115], v[132:135], v[184:187], a[112:115]
v_mfma_f32_16x16x32_bf16 a[116:119], v[132:135], v[188:191], a[116:119]
v_mfma_f32_16x16x32_bf16 a[120:123], v[132:135], v[192:195], a[120:123]
v_mfma_f32_16x16x32_bf16 a[124:127], v[132:135], v[196:199], a[124:127]
buffer_load_dwordx4 v[132:135], v1, s[4:7], s37 offen offset:2048
v_mfma_f32_16x16x32_bf16 a[128:131], v[136:139], v[184:187], a[128:131]
v_mfma_f32_16x16x32_bf16 a[132:135], v[136:139], v[188:191], a[132:135]
v_mfma_f32_16x16x32_bf16 a[136:139], v[136:139], v[192:195], a[136:139]
v_mfma_f32_16x16x32_bf16 a[140:143], v[136:139], v[196:199], a[140:143]
buffer_load_dwordx4 v[136:139], v1, s[4:7], s38 offen offset:2048
v_mfma_f32_16x16x32_bf16 a[144:147], v[140:143], v[184:187], a[144:147]
v_mfma_f32_16x16x32_bf16 a[148:151], v[140:143], v[188:191], a[148:151]
v_mfma_f32_16x16x32_bf16 a[152:155], v[140:143], v[192:195], a[152:155]
v_mfma_f32_16x16x32_bf16 a[156:159], v[140:143], v[196:199], a[156:159]
buffer_load_dwordx4 v[140:143], v1, s[4:7], s39 offen offset:2048
s_barrier
s_waitcnt vmcnt(30)
s_waitcnt lgkmcnt(0)
v_mfma_f32_16x16x32_bf16 a[0:3], v[144:147], v[200:203], a[0:3]
v_mfma_f32_16x16x32_bf16 a[4:7], v[144:147], v[204:207], a[4:7]
v_mfma_f32_16x16x32_bf16 a[8:11], v[144:147], v[208:211], a[8:11]
v_mfma_f32_16x16x32_bf16 a[12:15], v[144:147], v[212:215], a[12:15]
ds_read_b128 v[184:187], v1 offset:12288
buffer_load_dwordx4 v[144:147], v1, s[4:7], s30 offen offset:3072
s_add_u32 s30, s30, 4096
v_mfma_f32_16x16x32_bf16 a[16:19], v[148:151], v[200:203], a[16:19]
v_mfma_f32_16x16x32_bf16 a[20:23], v[148:151], v[204:207], a[20:23]
v_mfma_f32_16x16x32_bf16 a[24:27], v[148:151], v[208:211], a[24:27]
v_mfma_f32_16x16x32_bf16 a[28:31], v[148:151], v[212:215], a[28:31]
ds_read_b128 v[188:191], v1 offset:36864
buffer_load_dwordx4 v[148:151], v1, s[4:7], s31 offen offset:3072
s_add_u32 s31, s31, 4096
v_mfma_f32_16x16x32_bf16 a[32:35], v[152:155], v[200:203], a[32:35]
v_mfma_f32_16x16x32_bf16 a[36:39], v[152:155], v[204:207], a[36:39]
v_mfma_f32_16x16x32_bf16 a[40:43], v[152:155], v[208:211], a[40:43]
v_mfma_f32_16x16x32_bf16 a[44:47], v[152:155], v[212:215], a[44:47]
ds_read_b128 v[192:195], v6 offset:12288
buffer_load_dwordx4 v[152:155], v1, s[4:7], s32 offen offset:3072
s_add_u32 s32, s32, 4096
v_mfma_f32_16x16x32_bf16 a[48:51], v[156:159], v[200:203], a[48:51]
v_mfma_f32_16x16x32_bf16 a[52:55], v[156:159], v[204:207], a[52:55]
v_mfma_f32_16x16x32_bf16 a[56:59], v[156:159], v[208:211], a[56:59]
v_mfma_f32_16x16x32_bf16 a[60:63], v[156:159], v[212:215], a[60:63]
ds_read_b128 v[196:199], v6 offset:36864
buffer_load_dwordx4 v[156:159], v1, s[4:7], s33 offen offset:3072
s_add_u32 s33, s33, 4096
v_mfma_f32_16x16x32_bf16 a[64:67], v[160:163], v[200:203], a[64:67]
v_mfma_f32_16x16x32_bf16 a[68:71], v[160:163], v[204:207], a[68:71]
v_mfma_f32_16x16x32_bf16 a[72:75], v[160:163], v[208:211], a[72:75]
v_mfma_f32_16x16x32_bf16 a[76:79], v[160:163], v[212:215], a[76:79]
buffer_load_dwordx4 v[160:163], v1, s[4:7], s34 offen offset:3072
s_add_u32 s34, s34, 4096
v_mfma_f32_16x16x32_bf16 a[80:83], v[164:167], v[200:203], a[80:83]
v_mfma_f32_16x16x32_bf16 a[84:87], v[164:167], v[204:207], a[84:87]
v_mfma_f32_16x16x32_bf16 a[88:91], v[164:167], v[208:211], a[88:91]
v_mfma_f32_16x16x32_bf16 a[92:95], v[164:167], v[212:215], a[92:95]
buffer_load_dwordx4 v[164:167], v1, s[4:7], s35 offen offset:3072
s_add_u32 s35, s35, 4096
v_mfma_f32_16x16x32_bf16 a[96:99], v[168:171], v[200:203], a[96:99]
v_mfma_f32_16x16x32_bf16 a[100:103], v[168:171], v[204:207], a[100:103]
v_mfma_f32_16x16x32_bf16 a[104:107], v[168:171], v[208:211], a[104:107]
v_mfma_f32_16x16x32_bf16 a[108:111], v[168:171], v[212:215], a[108:111]
buffer_load_dwordx4 v[168:171], v1, s[4:7], s36 offen offset:3072
s_add_u32 s36, s36, 4096
v_mfma_f32_16x16x32_bf16 a[112:115], v[172:175], v[200:203], a[112:115]
v_mfma_f32_16x16x32_bf16 a[116:119], v[172:175], v[204:207], a[116:119]
v_mfma_f32_16x16x32_bf16 a[120:123], v[172:175], v[208:211], a[120:123]
v_mfma_f32_16x16x32_bf16 a[124:127], v[172:175], v[212:215], a[124:127]
buffer_load_dwordx4 v[172:175], v1, s[4:7], s37 offen offset:3072
s_add_u32 s37, s37, 4096
v_mfma_f32_16x16x32_bf16 a[128:131], v[176:179], v[200:203], a[128:131]
v_mfma_f32_16x16x32_bf16 a[132:135], v[176:179], v[204:207], a[132:135]
v_mfma_f32_16x16x32_bf16 a[136:139], v[176:179], v[208:211], a[136:139]
v_mfma_f32_16x16x32_bf16 a[140:143], v[176:179], v[212:215], a[140:143]
buffer_load_dwordx4 v[176:179], v1, s[4:7], s38 offen offset:3072
s_add_u32 s38, s38, 4096
v_mfma_f32_16x16x32_bf16 a[144:147], v[180:183], v[200:203], a[144:147]
v_mfma_f32_16x16x32_bf16 a[148:151], v[180:183], v[204:207], a[148:151]
v_mfma_f32_16x16x32_bf16 a[152:155], v[180:183], v[208:211], a[152:155]
v_mfma_f32_16x16x32_bf16 a[156:159], v[180:183], v[212:215], a[156:159]
buffer_load_dwordx4 v[180:183], v1, s[4:7], s39 offen offset:3072
s_add_u32 s39, s39, 4096
s_waitcnt vmcnt(30)
s_waitcnt lgkmcnt(0)
v_mfma_f32_16x16x32_bf16 a[0:3], v[24:27], v[184:187], a[0:3]
v_mfma_f32_16x16x32_bf16 a[4:7], v[24:27], v[188:191], a[4:7]
v_mfma_f32_16x16x32_bf16 a[8:11], v[24:27], v[192:195], a[8:11]
v_mfma_f32_16x16x32_bf16 a[12:15], v[24:27], v[196:199], a[12:15]
ds_read_b128 v[200:203], v1 offset:13312
buffer_load_dwordx4 v[24:27], v1, s[4:7], s30 offen offset:0
v_mfma_f32_16x16x32_bf16 a[16:19], v[28:31], v[184:187], a[16:19]
v_mfma_f32_16x16x32_bf16 a[20:23], v[28:31], v[188:191], a[20:23]
v_mfma_f32_16x16x32_bf16 a[24:27], v[28:31], v[192:195], a[24:27]
v_mfma_f32_16x16x32_bf16 a[28:31], v[28:31], v[196:199], a[28:31]
ds_read_b128 v[204:207], v1 offset:37888
buffer_load_dwordx4 v[28:31], v1, s[4:7], s31 offen offset:0
v_mfma_f32_16x16x32_bf16 a[32:35], v[32:35], v[184:187], a[32:35]
v_mfma_f32_16x16x32_bf16 a[36:39], v[32:35], v[188:191], a[36:39]
v_mfma_f32_16x16x32_bf16 a[40:43], v[32:35], v[192:195], a[40:43]
v_mfma_f32_16x16x32_bf16 a[44:47], v[32:35], v[196:199], a[44:47]
ds_read_b128 v[208:211], v6 offset:13312
buffer_load_dwordx4 v[32:35], v1, s[4:7], s32 offen offset:0
v_mfma_f32_16x16x32_bf16 a[48:51], v[36:39], v[184:187], a[48:51]
v_mfma_f32_16x16x32_bf16 a[52:55], v[36:39], v[188:191], a[52:55]
v_mfma_f32_16x16x32_bf16 a[56:59], v[36:39], v[192:195], a[56:59]
v_mfma_f32_16x16x32_bf16 a[60:63], v[36:39], v[196:199], a[60:63]
ds_read_b128 v[212:215], v6 offset:37888
buffer_load_dwordx4 v[36:39], v1, s[4:7], s33 offen offset:0
v_mfma_f32_16x16x32_bf16 a[64:67], v[40:43], v[184:187], a[64:67]
v_mfma_f32_16x16x32_bf16 a[68:71], v[40:43], v[188:191], a[68:71]
v_mfma_f32_16x16x32_bf16 a[72:75], v[40:43], v[192:195], a[72:75]
v_mfma_f32_16x16x32_bf16 a[76:79], v[40:43], v[196:199], a[76:79]
buffer_load_dwordx4 v[40:43], v1, s[4:7], s34 offen offset:0
v_mfma_f32_16x16x32_bf16 a[80:83], v[44:47], v[184:187], a[80:83]
v_mfma_f32_16x16x32_bf16 a[84:87], v[44:47], v[188:191], a[84:87]
v_mfma_f32_16x16x32_bf16 a[88:91], v[44:47], v[192:195], a[88:91]
v_mfma_f32_16x16x32_bf16 a[92:95], v[44:47], v[196:199], a[92:95]
buffer_load_dwordx4 v[44:47], v1, s[4:7], s35 offen offset:0
v_mfma_f32_16x16x32_bf16 a[96:99], v[48:51], v[184:187], a[96:99]
v_mfma_f32_16x16x32_bf16 a[100:103], v[48:51], v[188:191], a[100:103]
v_mfma_f32_16x16x32_bf16 a[104:107], v[48:51], v[192:195], a[104:107]
v_mfma_f32_16x16x32_bf16 a[108:111], v[48:51], v[196:199], a[108:111]
buffer_load_dwordx4 v[48:51], v1, s[4:7], s36 offen offset:0
v_mfma_f32_16x16x32_bf16 a[112:115], v[52:55], v[184:187], a[112:115]
v_mfma_f32_16x16x32_bf16 a[116:119], v[52:55], v[188:191], a[116:119]
v_mfma_f32_16x16x32_bf16 a[120:123], v[52:55], v[192:195], a[120:123]
v_mfma_f32_16x16x32_bf16 a[124:127], v[52:55], v[196:199], a[124:127]
buffer_load_dwordx4 v[52:55], v1, s[4:7], s37 offen offset:0
v_mfma_f32_16x16x32_bf16 a[128:131], v[56:59], v[184:187], a[128:131]
v_mfma_f32_16x16x32_bf16 a[132:135], v[56:59], v[188:191], a[132:135]
v_mfma_f32_16x16x32_bf16 a[136:139], v[56:59], v[192:195], a[136:139]
v_mfma_f32_16x16x32_bf16 a[140:143], v[56:59], v[196:199], a[140:143]
buffer_load_dwordx4 v[56:59], v1, s[4:7], s38 offen offset:0
v_mfma_f32_16x16x32_bf16 a[144:147], v[60:63], v[184:187], a[144:147]
v_mfma_f32_16x16x32_bf16 a[148:151], v[60:63], v[188:191], a[148:151]
v_mfma_f32_16x16x32_bf16 a[152:155], v[60:63], v[192:195], a[152:155]
v_mfma_f32_16x16x32_bf16 a[156:159], v[60:63], v[196:199], a[156:159]
buffer_load_dwordx4 v[60:63], v1, s[4:7], s39 offen offset:0
s_waitcnt vmcnt(30)
s_waitcnt lgkmcnt(0)
v_mfma_f32_16x16x32_bf16 a[0:3], v[64:67], v[200:203], a[0:3]
v_mfma_f32_16x16x32_bf16 a[4:7], v[64:67], v[204:207], a[4:7]
v_mfma_f32_16x16x32_bf16 a[8:11], v[64:67], v[208:211], a[8:11]
v_mfma_f32_16x16x32_bf16 a[12:15], v[64:67], v[212:215], a[12:15]
ds_read_b128 v[184:187], v1 offset:14336
buffer_load_dwordx4 v[64:67], v1, s[4:7], s30 offen offset:1024
v_mfma_f32_16x16x32_bf16 a[16:19], v[68:71], v[200:203], a[16:19]
v_mfma_f32_16x16x32_bf16 a[20:23], v[68:71], v[204:207], a[20:23]
v_mfma_f32_16x16x32_bf16 a[24:27], v[68:71], v[208:211], a[24:27]
v_mfma_f32_16x16x32_bf16 a[28:31], v[68:71], v[212:215], a[28:31]
ds_read_b128 v[188:191], v1 offset:38912
buffer_load_dwordx4 v[68:71], v1, s[4:7], s31 offen offset:1024
v_mfma_f32_16x16x32_bf16 a[32:35], v[72:75], v[200:203], a[32:35]
v_mfma_f32_16x16x32_bf16 a[36:39], v[72:75], v[204:207], a[36:39]
v_mfma_f32_16x16x32_bf16 a[40:43], v[72:75], v[208:211], a[40:43]
v_mfma_f32_16x16x32_bf16 a[44:47], v[72:75], v[212:215], a[44:47]
ds_read_b128 v[192:195], v6 offset:14336
buffer_load_dwordx4 v[72:75], v1, s[4:7], s32 offen offset:1024
v_mfma_f32_16x16x32_bf16 a[48:51], v[76:79], v[200:203], a[48:51]
v_mfma_f32_16x16x32_bf16 a[52:55], v[76:79], v[204:207], a[52:55]
v_mfma_f32_16x16x32_bf16 a[56:59], v[76:79], v[208:211], a[56:59]
v_mfma_f32_16x16x32_bf16 a[60:63], v[76:79], v[212:215], a[60:63]
ds_read_b128 v[196:199], v6 offset:38912
buffer_load_dwordx4 v[76:79], v1, s[4:7], s33 offen offset:1024
v_mfma_f32_16x16x32_bf16 a[64:67], v[80:83], v[200:203], a[64:67]
v_mfma_f32_16x16x32_bf16 a[68:71], v[80:83], v[204:207], a[68:71]
v_mfma_f32_16x16x32_bf16 a[72:75], v[80:83], v[208:211], a[72:75]
v_mfma_f32_16x16x32_bf16 a[76:79], v[80:83], v[212:215], a[76:79]
buffer_load_dwordx4 v[80:83], v1, s[4:7], s34 offen offset:1024
v_mfma_f32_16x16x32_bf16 a[80:83], v[84:87], v[200:203], a[80:83]
v_mfma_f32_16x16x32_bf16 a[84:87], v[84:87], v[204:207], a[84:87]
v_mfma_f32_16x16x32_bf16 a[88:91], v[84:87], v[208:211], a[88:91]
v_mfma_f32_16x16x32_bf16 a[92:95], v[84:87], v[212:215], a[92:95]
buffer_load_dwordx4 v[84:87], v1, s[4:7], s35 offen offset:1024
v_mfma_f32_16x16x32_bf16 a[96:99], v[88:91], v[200:203], a[96:99]
v_mfma_f32_16x16x32_bf16 a[100:103], v[88:91], v[204:207], a[100:103]
v_mfma_f32_16x16x32_bf16 a[104:107], v[88:91], v[208:211], a[104:107]
v_mfma_f32_16x16x32_bf16 a[108:111], v[88:91], v[212:215], a[108:111]
buffer_load_dwordx4 v[88:91], v1, s[4:7], s36 offen offset:1024
v_mfma_f32_16x16x32_bf16 a[112:115], v[92:95], v[200:203], a[112:115]
v_mfma_f32_16x16x32_bf16 a[116:119], v[92:95], v[204:207], a[116:119]
v_mfma_f32_16x16x32_bf16 a[120:123], v[92:95], v[208:211], a[120:123]
v_mfma_f32_16x16x32_bf16 a[124:127], v[92:95], v[212:215], a[124:127]
buffer_load_dwordx4 v[92:95], v1, s[4:7], s37 offen offset:1024
v_mfma_f32_16x16x32_bf16 a[128:131], v[96:99], v[200:203], a[128:131]
v_mfma_f32_16x16x32_bf16 a[132:135], v[96:99], v[204:207], a[132:135]
v_mfma_f32_16x16x32_bf16 a[136:139], v[96:99], v[208:211], a[136:139]
v_mfma_f32_16x16x32_bf16 a[140:143], v[96:99], v[212:215], a[140:143]
buffer_load_dwordx4 v[96:99], v1, s[4:7], s38 offen offset:1024
v_mfma_f32_16x16x32_bf16 a[144:147], v[100:103], v[200:203], a[144:147]
v_mfma_f32_16x16x32_bf16 a[148:151], v[100:103], v[204:207], a[148:151]
v_mfma_f32_16x16x32_bf16 a[152:155], v[100:103], v[208:211], a[152:155]
v_mfma_f32_16x16x32_bf16 a[156:159], v[100:103], v[212:215], a[156:159]
buffer_load_dwordx4 v[100:103], v1, s[4:7], s39 offen offset:1024
s_waitcnt vmcnt(30)
s_waitcnt lgkmcnt(0)
v_mfma_f32_16x16x32_bf16 a[0:3], v[104:107], v[184:187], a[0:3]
v_mfma_f32_16x16x32_bf16 a[4:7], v[104:107], v[188:191], a[4:7]
v_mfma_f32_16x16x32_bf16 a[8:11], v[104:107], v[192:195], a[8:11]
v_mfma_f32_16x16x32_bf16 a[12:15], v[104:107], v[196:199], a[12:15]
ds_read_b128 v[200:203], v1 offset:15360
buffer_load_dwordx4 v[104:107], v1, s[4:7], s30 offen offset:2048
v_mfma_f32_16x16x32_bf16 a[16:19], v[108:111], v[184:187], a[16:19]
v_mfma_f32_16x16x32_bf16 a[20:23], v[108:111], v[188:191], a[20:23]
v_mfma_f32_16x16x32_bf16 a[24:27], v[108:111], v[192:195], a[24:27]
v_mfma_f32_16x16x32_bf16 a[28:31], v[108:111], v[196:199], a[28:31]
ds_read_b128 v[204:207], v1 offset:39936
buffer_load_dwordx4 v[108:111], v1, s[4:7], s31 offen offset:2048
v_mfma_f32_16x16x32_bf16 a[32:35], v[112:115], v[184:187], a[32:35]
v_mfma_f32_16x16x32_bf16 a[36:39], v[112:115], v[188:191], a[36:39]
v_mfma_f32_16x16x32_bf16 a[40:43], v[112:115], v[192:195], a[40:43]
v_mfma_f32_16x16x32_bf16 a[44:47], v[112:115], v[196:199], a[44:47]
ds_read_b128 v[208:211], v6 offset:15360
buffer_load_dwordx4 v[112:115], v1, s[4:7], s32 offen offset:2048
v_mfma_f32_16x16x32_bf16 a[48:51], v[116:119], v[184:187], a[48:51]
v_mfma_f32_16x16x32_bf16 a[52:55], v[116:119], v[188:191], a[52:55]
v_mfma_f32_16x16x32_bf16 a[56:59], v[116:119], v[192:195], a[56:59]
v_mfma_f32_16x16x32_bf16 a[60:63], v[116:119], v[196:199], a[60:63]
ds_read_b128 v[212:215], v6 offset:39936
buffer_load_dwordx4 v[116:119], v1, s[4:7], s33 offen offset:2048
v_mfma_f32_16x16x32_bf16 a[64:67], v[120:123], v[184:187], a[64:67]
v_mfma_f32_16x16x32_bf16 a[68:71], v[120:123], v[188:191], a[68:71]
v_mfma_f32_16x16x32_bf16 a[72:75], v[120:123], v[192:195], a[72:75]
v_mfma_f32_16x16x32_bf16 a[76:79], v[120:123], v[196:199], a[76:79]
buffer_load_dwordx4 v[120:123], v1, s[4:7], s34 offen offset:2048
v_mfma_f32_16x16x32_bf16 a[80:83], v[124:127], v[184:187], a[80:83]
v_mfma_f32_16x16x32_bf16 a[84:87], v[124:127], v[188:191], a[84:87]
v_mfma_f32_16x16x32_bf16 a[88:91], v[124:127], v[192:195], a[88:91]
v_mfma_f32_16x16x32_bf16 a[92:95], v[124:127], v[196:199], a[92:95]
buffer_load_dwordx4 v[124:127], v1, s[4:7], s35 offen offset:2048
v_mfma_f32_16x16x32_bf16 a[96:99], v[128:131], v[184:187], a[96:99]
v_mfma_f32_16x16x32_bf16 a[100:103], v[128:131], v[188:191], a[100:103]
v_mfma_f32_16x16x32_bf16 a[104:107], v[128:131], v[192:195], a[104:107]
v_mfma_f32_16x16x32_bf16 a[108:111], v[128:131], v[196:199], a[108:111]
buffer_load_dwordx4 v[128:131], v1, s[4:7], s36 offen offset:2048
v_mfma_f32_16x16x32_bf16 a[112:115], v[132:135], v[184:187], a[112:115]
v_mfma_f32_16x16x32_bf16 a[116:119], v[132:135], v[188:191], a[116:119]
v_mfma_f32_16x16x32_bf16 a[120:123], v[132:135], v[192:195], a[120:123]
v_mfma_f32_16x16x32_bf16 a[124:127], v[132:135], v[196:199], a[124:127]
buffer_load_dwordx4 v[132:135], v1, s[4:7], s37 offen offset:2048
v_mfma_f32_16x16x32_bf16 a[128:131], v[136:139], v[184:187], a[128:131]
v_mfma_f32_16x16x32_bf16 a[132:135], v[136:139], v[188:191], a[132:135]
v_mfma_f32_16x16x32_bf16 a[136:139], v[136:139], v[192:195], a[136:139]
v_mfma_f32_16x16x32_bf16 a[140:143], v[136:139], v[196:199], a[140:143]
buffer_load_dwordx4 v[136:139], v1, s[4:7], s38 offen offset:2048
v_mfma_f32_16x16x32_bf16 a[144:147], v[140:143], v[184:187], a[144:147]
v_mfma_f32_16x16x32_bf16 a[148:151], v[140:143], v[188:191], a[148:151]
v_mfma_f32_16x16x32_bf16 a[152:155], v[140:143], v[192:195], a[152:155]
v_mfma_f32_16x16x32_bf16 a[156:159], v[140:143], v[196:199], a[156:159]
buffer_load_dwordx4 v[140:143], v1, s[4:7], s39 offen offset:2048
s_waitcnt vmcnt(30)
s_waitcnt lgkmcnt(0)
v_mfma_f32_16x16x32_bf16 a[0:3], v[144:147], v[200:203], a[0:3]
v_mfma_f32_16x16x32_bf16 a[4:7], v[144:147], v[204:207], a[4:7]
v_mfma_f32_16x16x32_bf16 a[8:11], v[144:147], v[208:211], a[8:11]
v_mfma_f32_16x16x32_bf16 a[12:15], v[144:147], v[212:215], a[12:15]
ds_read_b128 v[184:187], v1 offset:16384
buffer_load_dwordx4 v[144:147], v1, s[4:7], s30 offen offset:3072
s_add_u32 s30, s30, 4096
v_mfma_f32_16x16x32_bf16 a[16:19], v[148:151], v[200:203], a[16:19]
v_mfma_f32_16x16x32_bf16 a[20:23], v[148:151], v[204:207], a[20:23]
v_mfma_f32_16x16x32_bf16 a[24:27], v[148:151], v[208:211], a[24:27]
v_mfma_f32_16x16x32_bf16 a[28:31], v[148:151], v[212:215], a[28:31]
ds_read_b128 v[188:191], v1 offset:40960
buffer_load_dwordx4 v[148:151], v1, s[4:7], s31 offen offset:3072
s_add_u32 s31, s31, 4096
v_mfma_f32_16x16x32_bf16 a[32:35], v[152:155], v[200:203], a[32:35]
v_mfma_f32_16x16x32_bf16 a[36:39], v[152:155], v[204:207], a[36:39]
v_mfma_f32_16x16x32_bf16 a[40:43], v[152:155], v[208:211], a[40:43]
v_mfma_f32_16x16x32_bf16 a[44:47], v[152:155], v[212:215], a[44:47]
ds_read_b128 v[192:195], v6 offset:16384
buffer_load_dwordx4 v[152:155], v1, s[4:7], s32 offen offset:3072
s_add_u32 s32, s32, 4096
v_mfma_f32_16x16x32_bf16 a[48:51], v[156:159], v[200:203], a[48:51]
v_mfma_f32_16x16x32_bf16 a[52:55], v[156:159], v[204:207], a[52:55]
v_mfma_f32_16x16x32_bf16 a[56:59], v[156:159], v[208:211], a[56:59]
v_mfma_f32_16x16x32_bf16 a[60:63], v[156:159], v[212:215], a[60:63]
ds_read_b128 v[196:199], v6 offset:40960
buffer_load_dwordx4 v[156:159], v1, s[4:7], s33 offen offset:3072
s_add_u32 s33, s33, 4096
v_mfma_f32_16x16x32_bf16 a[64:67], v[160:163], v[200:203], a[64:67]
v_mfma_f32_16x16x32_bf16 a[68:71], v[160:163], v[204:207], a[68:71]
v_mfma_f32_16x16x32_bf16 a[72:75], v[160:163], v[208:211], a[72:75]
v_mfma_f32_16x16x32_bf16 a[76:79], v[160:163], v[212:215], a[76:79]
buffer_load_dwordx4 v[160:163], v1, s[4:7], s34 offen offset:3072
s_add_u32 s34, s34, 4096
v_mfma_f32_16x16x32_bf16 a[80:83], v[164:167], v[200:203], a[80:83]
v_mfma_f32_16x16x32_bf16 a[84:87], v[164:167], v[204:207], a[84:87]
v_mfma_f32_16x16x32_bf16 a[88:91], v[164:167], v[208:211], a[88:91]
v_mfma_f32_16x16x32_bf16 a[92:95], v[164:167], v[212:215], a[92:95]
buffer_load_dwordx4 v[164:167], v1, s[4:7], s35 offen offset:3072
s_add_u32 s35, s35, 4096
v_mfma_f32_16x16x32_bf16 a[96:99], v[168:171], v[200:203], a[96:99]
v_mfma_f32_16x16x32_bf16 a[100:103], v[168:171], v[204:207], a[100:103]
v_mfma_f32_16x16x32_bf16 a[104:107], v[168:171], v[208:211], a[104:107]
v_mfma_f32_16x16x32_bf16 a[108:111], v[168:171], v[212:215], a[108:111]
buffer_load_dwordx4 v[168:171], v1, s[4:7], s36 offen offset:3072
s_add_u32 s36, s36, 4096
v_mfma_f32_16x16x32_bf16 a[112:115], v[172:175], v[200:203], a[112:115]
v_mfma_f32_16x16x32_bf16 a[116:119], v[172:175], v[204:207], a[116:119]
v_mfma_f32_16x16x32_bf16 a[120:123], v[172:175], v[208:211], a[120:123]
v_mfma_f32_16x16x32_bf16 a[124:127], v[172:175], v[212:215], a[124:127]
buffer_load_dwordx4 v[172:175], v1, s[4:7], s37 offen offset:3072
s_add_u32 s37, s37, 4096
v_mfma_f32_16x16x32_bf16 a[128:131], v[176:179], v[200:203], a[128:131]
v_mfma_f32_16x16x32_bf16 a[132:135], v[176:179], v[204:207], a[132:135]
v_mfma_f32_16x16x32_bf16 a[136:139], v[176:179], v[208:211], a[136:139]
v_mfma_f32_16x16x32_bf16 a[140:143], v[176:179], v[212:215], a[140:143]
buffer_load_dwordx4 v[176:179], v1, s[4:7], s38 offen offset:3072
s_add_u32 s38, s38, 4096
v_mfma_f32_16x16x32_bf16 a[144:147], v[180:183], v[200:203], a[144:147]
v_mfma_f32_16x16x32_bf16 a[148:151], v[180:183], v[204:207], a[148:151]
v_mfma_f32_16x16x32_bf16 a[152:155], v[180:183], v[208:211], a[152:155]
v_mfma_f32_16x16x32_bf16 a[156:159], v[180:183], v[212:215], a[156:159]
buffer_load_dwordx4 v[180:183], v1, s[4:7], s39 offen offset:3072
s_add_u32 s39, s39, 4096
s_waitcnt vmcnt(30)
s_waitcnt lgkmcnt(0)
v_mfma_f32_16x16x32_bf16 a[0:3], v[24:27], v[184:187], a[0:3]
v_mfma_f32_16x16x32_bf16 a[4:7], v[24:27], v[188:191], a[4:7]
v_mfma_f32_16x16x32_bf16 a[8:11], v[24:27], v[192:195], a[8:11]
v_mfma_f32_16x16x32_bf16 a[12:15], v[24:27], v[196:199], a[12:15]
ds_read_b128 v[200:203], v1 offset:17408
buffer_load_dwordx4 v[24:27], v1, s[4:7], s30 offen offset:0
v_mfma_f32_16x16x32_bf16 a[16:19], v[28:31], v[184:187], a[16:19]
v_mfma_f32_16x16x32_bf16 a[20:23], v[28:31], v[188:191], a[20:23]
v_mfma_f32_16x16x32_bf16 a[24:27], v[28:31], v[192:195], a[24:27]
v_mfma_f32_16x16x32_bf16 a[28:31], v[28:31], v[196:199], a[28:31]
ds_read_b128 v[204:207], v1 offset:41984
buffer_load_dwordx4 v[28:31], v1, s[4:7], s31 offen offset:0
v_mfma_f32_16x16x32_bf16 a[32:35], v[32:35], v[184:187], a[32:35]
v_mfma_f32_16x16x32_bf16 a[36:39], v[32:35], v[188:191], a[36:39]
v_mfma_f32_16x16x32_bf16 a[40:43], v[32:35], v[192:195], a[40:43]
v_mfma_f32_16x16x32_bf16 a[44:47], v[32:35], v[196:199], a[44:47]
ds_read_b128 v[208:211], v6 offset:17408
buffer_load_dwordx4 v[32:35], v1, s[4:7], s32 offen offset:0
v_mfma_f32_16x16x32_bf16 a[48:51], v[36:39], v[184:187], a[48:51]
v_mfma_f32_16x16x32_bf16 a[52:55], v[36:39], v[188:191], a[52:55]
v_mfma_f32_16x16x32_bf16 a[56:59], v[36:39], v[192:195], a[56:59]
v_mfma_f32_16x16x32_bf16 a[60:63], v[36:39], v[196:199], a[60:63]
ds_read_b128 v[212:215], v6 offset:41984
buffer_load_dwordx4 v[36:39], v1, s[4:7], s33 offen offset:0
v_mfma_f32_16x16x32_bf16 a[64:67], v[40:43], v[184:187], a[64:67]
v_mfma_f32_16x16x32_bf16 a[68:71], v[40:43], v[188:191], a[68:71]
v_mfma_f32_16x16x32_bf16 a[72:75], v[40:43], v[192:195], a[72:75]
v_mfma_f32_16x16x32_bf16 a[76:79], v[40:43], v[196:199], a[76:79]
buffer_load_dwordx4 v[40:43], v1, s[4:7], s34 offen offset:0
v_mfma_f32_16x16x32_bf16 a[80:83], v[44:47], v[184:187], a[80:83]
v_mfma_f32_16x16x32_bf16 a[84:87], v[44:47], v[188:191], a[84:87]
v_mfma_f32_16x16x32_bf16 a[88:91], v[44:47], v[192:195], a[88:91]
v_mfma_f32_16x16x32_bf16 a[92:95], v[44:47], v[196:199], a[92:95]
buffer_load_dwordx4 v[44:47], v1, s[4:7], s35 offen offset:0
v_mfma_f32_16x16x32_bf16 a[96:99], v[48:51], v[184:187], a[96:99]
v_mfma_f32_16x16x32_bf16 a[100:103], v[48:51], v[188:191], a[100:103]
v_mfma_f32_16x16x32_bf16 a[104:107], v[48:51], v[192:195], a[104:107]
v_mfma_f32_16x16x32_bf16 a[108:111], v[48:51], v[196:199], a[108:111]
buffer_load_dwordx4 v[48:51], v1, s[4:7], s36 offen offset:0
v_mfma_f32_16x16x32_bf16 a[112:115], v[52:55], v[184:187], a[112:115]
v_mfma_f32_16x16x32_bf16 a[116:119], v[52:55], v[188:191], a[116:119]
v_mfma_f32_16x16x32_bf16 a[120:123], v[52:55], v[192:195], a[120:123]
v_mfma_f32_16x16x32_bf16 a[124:127], v[52:55], v[196:199], a[124:127]
buffer_load_dwordx4 v[52:55], v1, s[4:7], s37 offen offset:0
v_mfma_f32_16x16x32_bf16 a[128:131], v[56:59], v[184:187], a[128:131]
v_mfma_f32_16x16x32_bf16 a[132:135], v[56:59], v[188:191], a[132:135]
v_mfma_f32_16x16x32_bf16 a[136:139], v[56:59], v[192:195], a[136:139]
v_mfma_f32_16x16x32_bf16 a[140:143], v[56:59], v[196:199], a[140:143]
buffer_load_dwordx4 v[56:59], v1, s[4:7], s38 offen offset:0
v_mfma_f32_16x16x32_bf16 a[144:147], v[60:63], v[184:187], a[144:147]
v_mfma_f32_16x16x32_bf16 a[148:151], v[60:63], v[188:191], a[148:151]
v_mfma_f32_16x16x32_bf16 a[152:155], v[60:63], v[192:195], a[152:155]
v_mfma_f32_16x16x32_bf16 a[156:159], v[60:63], v[196:199], a[156:159]
buffer_load_dwordx4 v[60:63], v1, s[4:7], s39 offen offset:0
s_barrier
s_waitcnt vmcnt(30)
s_waitcnt lgkmcnt(0)
v_mfma_f32_16x16x32_bf16 a[0:3], v[64:67], v[200:203], a[0:3]
v_mfma_f32_16x16x32_bf16 a[4:7], v[64:67], v[204:207], a[4:7]
v_mfma_f32_16x16x32_bf16 a[8:11], v[64:67], v[208:211], a[8:11]
v_mfma_f32_16x16x32_bf16 a[12:15], v[64:67], v[212:215], a[12:15]
ds_read_b128 v[184:187], v1 offset:18432
buffer_load_dwordx4 v[64:67], v1, s[4:7], s30 offen offset:1024
v_mfma_f32_16x16x32_bf16 a[16:19], v[68:71], v[200:203], a[16:19]
v_mfma_f32_16x16x32_bf16 a[20:23], v[68:71], v[204:207], a[20:23]
v_mfma_f32_16x16x32_bf16 a[24:27], v[68:71], v[208:211], a[24:27]
v_mfma_f32_16x16x32_bf16 a[28:31], v[68:71], v[212:215], a[28:31]
ds_read_b128 v[188:191], v1 offset:43008
buffer_load_dwordx4 v[68:71], v1, s[4:7], s31 offen offset:1024
v_mfma_f32_16x16x32_bf16 a[32:35], v[72:75], v[200:203], a[32:35]
v_mfma_f32_16x16x32_bf16 a[36:39], v[72:75], v[204:207], a[36:39]
v_mfma_f32_16x16x32_bf16 a[40:43], v[72:75], v[208:211], a[40:43]
v_mfma_f32_16x16x32_bf16 a[44:47], v[72:75], v[212:215], a[44:47]
ds_read_b128 v[192:195], v6 offset:18432
buffer_load_dwordx4 v[72:75], v1, s[4:7], s32 offen offset:1024
v_mfma_f32_16x16x32_bf16 a[48:51], v[76:79], v[200:203], a[48:51]
v_mfma_f32_16x16x32_bf16 a[52:55], v[76:79], v[204:207], a[52:55]
v_mfma_f32_16x16x32_bf16 a[56:59], v[76:79], v[208:211], a[56:59]
v_mfma_f32_16x16x32_bf16 a[60:63], v[76:79], v[212:215], a[60:63]
ds_read_b128 v[196:199], v6 offset:43008
buffer_load_dwordx4 v[76:79], v1, s[4:7], s33 offen offset:1024
v_mfma_f32_16x16x32_bf16 a[64:67], v[80:83], v[200:203], a[64:67]
v_mfma_f32_16x16x32_bf16 a[68:71], v[80:83], v[204:207], a[68:71]
v_mfma_f32_16x16x32_bf16 a[72:75], v[80:83], v[208:211], a[72:75]
v_mfma_f32_16x16x32_bf16 a[76:79], v[80:83], v[212:215], a[76:79]
buffer_load_dwordx4 v[80:83], v1, s[4:7], s34 offen offset:1024
v_mfma_f32_16x16x32_bf16 a[80:83], v[84:87], v[200:203], a[80:83]
v_mfma_f32_16x16x32_bf16 a[84:87], v[84:87], v[204:207], a[84:87]
v_mfma_f32_16x16x32_bf16 a[88:91], v[84:87], v[208:211], a[88:91]
v_mfma_f32_16x16x32_bf16 a[92:95], v[84:87], v[212:215], a[92:95]
buffer_load_dwordx4 v[84:87], v1, s[4:7], s35 offen offset:1024
v_mfma_f32_16x16x32_bf16 a[96:99], v[88:91], v[200:203], a[96:99]
v_mfma_f32_16x16x32_bf16 a[100:103], v[88:91], v[204:207], a[100:103]
v_mfma_f32_16x16x32_bf16 a[104:107], v[88:91], v[208:211], a[104:107]
v_mfma_f32_16x16x32_bf16 a[108:111], v[88:91], v[212:215], a[108:111]
buffer_load_dwordx4 v[88:91], v1, s[4:7], s36 offen offset:1024
v_mfma_f32_16x16x32_bf16 a[112:115], v[92:95], v[200:203], a[112:115]
v_mfma_f32_16x16x32_bf16 a[116:119], v[92:95], v[204:207], a[116:119]
v_mfma_f32_16x16x32_bf16 a[120:123], v[92:95], v[208:211], a[120:123]
v_mfma_f32_16x16x32_bf16 a[124:127], v[92:95], v[212:215], a[124:127]
buffer_load_dwordx4 v[92:95], v1, s[4:7], s37 offen offset:1024
v_mfma_f32_16x16x32_bf16 a[128:131], v[96:99], v[200:203], a[128:131]
v_mfma_f32_16x16x32_bf16 a[132:135], v[96:99], v[204:207], a[132:135]
v_mfma_f32_16x16x32_bf16 a[136:139], v[96:99], v[208:211], a[136:139]
v_mfma_f32_16x16x32_bf16 a[140:143], v[96:99], v[212:215], a[140:143]
buffer_load_dwordx4 v[96:99], v1, s[4:7], s38 offen offset:1024
v_mfma_f32_16x16x32_bf16 a[144:147], v[100:103], v[200:203], a[144:147]
v_mfma_f32_16x16x32_bf16 a[148:151], v[100:103], v[204:207], a[148:151]
v_mfma_f32_16x16x32_bf16 a[152:155], v[100:103], v[208:211], a[152:155]
v_mfma_f32_16x16x32_bf16 a[156:159], v[100:103], v[212:215], a[156:159]
buffer_load_dwordx4 v[100:103], v1, s[4:7], s39 offen offset:1024
s_waitcnt vmcnt(30)
s_waitcnt lgkmcnt(0)
v_mfma_f32_16x16x32_bf16 a[0:3], v[104:107], v[184:187], a[0:3]
v_mfma_f32_16x16x32_bf16 a[4:7], v[104:107], v[188:191], a[4:7]
v_mfma_f32_16x16x32_bf16 a[8:11], v[104:107], v[192:195], a[8:11]
v_mfma_f32_16x16x32_bf16 a[12:15], v[104:107], v[196:199], a[12:15]
ds_read_b128 v[200:203], v1 offset:19456
buffer_load_dwordx4 v[104:107], v1, s[4:7], s30 offen offset:2048
v_mfma_f32_16x16x32_bf16 a[16:19], v[108:111], v[184:187], a[16:19]
v_mfma_f32_16x16x32_bf16 a[20:23], v[108:111], v[188:191], a[20:23]
v_mfma_f32_16x16x32_bf16 a[24:27], v[108:111], v[192:195], a[24:27]
v_mfma_f32_16x16x32_bf16 a[28:31], v[108:111], v[196:199], a[28:31]
ds_read_b128 v[204:207], v1 offset:44032
buffer_load_dwordx4 v[108:111], v1, s[4:7], s31 offen offset:2048
v_mfma_f32_16x16x32_bf16 a[32:35], v[112:115], v[184:187], a[32:35]
v_mfma_f32_16x16x32_bf16 a[36:39], v[112:115], v[188:191], a[36:39]
v_mfma_f32_16x16x32_bf16 a[40:43], v[112:115], v[192:195], a[40:43]
v_mfma_f32_16x16x32_bf16 a[44:47], v[112:115], v[196:199], a[44:47]
ds_read_b128 v[208:211], v6 offset:19456
buffer_load_dwordx4 v[112:115], v1, s[4:7], s32 offen offset:2048
v_mfma_f32_16x16x32_bf16 a[48:51], v[116:119], v[184:187], a[48:51]
v_mfma_f32_16x16x32_bf16 a[52:55], v[116:119], v[188:191], a[52:55]
v_mfma_f32_16x16x32_bf16 a[56:59], v[116:119], v[192:195], a[56:59]
v_mfma_f32_16x16x32_bf16 a[60:63], v[116:119], v[196:199], a[60:63]
ds_read_b128 v[212:215], v6 offset:44032
buffer_load_dwordx4 v[116:119], v1, s[4:7], s33 offen offset:2048
v_mfma_f32_16x16x32_bf16 a[64:67], v[120:123], v[184:187], a[64:67]
v_mfma_f32_16x16x32_bf16 a[68:71], v[120:123], v[188:191], a[68:71]
v_mfma_f32_16x16x32_bf16 a[72:75], v[120:123], v[192:195], a[72:75]
v_mfma_f32_16x16x32_bf16 a[76:79], v[120:123], v[196:199], a[76:79]
buffer_load_dwordx4 v[120:123], v1, s[4:7], s34 offen offset:2048
v_mfma_f32_16x16x32_bf16 a[80:83], v[124:127], v[184:187], a[80:83]
v_mfma_f32_16x16x32_bf16 a[84:87], v[124:127], v[188:191], a[84:87]
v_mfma_f32_16x16x32_bf16 a[88:91], v[124:127], v[192:195], a[88:91]
v_mfma_f32_16x16x32_bf16 a[92:95], v[124:127], v[196:199], a[92:95]
buffer_load_dwordx4 v[124:127], v1, s[4:7], s35 offen offset:2048
v_mfma_f32_16x16x32_bf16 a[96:99], v[128:131], v[184:187], a[96:99]
v_mfma_f32_16x16x32_bf16 a[100:103], v[128:131], v[188:191], a[100:103]
v_mfma_f32_16x16x32_bf16 a[104:107], v[128:131], v[192:195], a[104:107]
v_mfma_f32_16x16x32_bf16 a[108:111], v[128:131], v[196:199], a[108:111]
buffer_load_dwordx4 v[128:131], v1, s[4:7], s36 offen offset:2048
v_mfma_f32_16x16x32_bf16 a[112:115], v[132:135], v[184:187], a[112:115]
v_mfma_f32_16x16x32_bf16 a[116:119], v[132:135], v[188:191], a[116:119]
v_mfma_f32_16x16x32_bf16 a[120:123], v[132:135], v[192:195], a[120:123]
v_mfma_f32_16x16x32_bf16 a[124:127], v[132:135], v[196:199], a[124:127]
buffer_load_dwordx4 v[132:135], v1, s[4:7], s37 offen offset:2048
v_mfma_f32_16x16x32_bf16 a[128:131], v[136:139], v[184:187], a[128:131]
v_mfma_f32_16x16x32_bf16 a[132:135], v[136:139], v[188:191], a[132:135]
v_mfma_f32_16x16x32_bf16 a[136:139], v[136:139], v[192:195], a[136:139]
v_mfma_f32_16x16x32_bf16 a[140:143], v[136:139], v[196:199], a[140:143]
buffer_load_dwordx4 v[136:139], v1, s[4:7], s38 offen offset:2048
v_mfma_f32_16x16x32_bf16 a[144:147], v[140:143], v[184:187], a[144:147]
v_mfma_f32_16x16x32_bf16 a[148:151], v[140:143], v[188:191], a[148:151]
v_mfma_f32_16x16x32_bf16 a[152:155], v[140:143], v[192:195], a[152:155]
v_mfma_f32_16x16x32_bf16 a[156:159], v[140:143], v[196:199], a[156:159]
buffer_load_dwordx4 v[140:143], v1, s[4:7], s39 offen offset:2048
s_waitcnt vmcnt(30)
s_waitcnt lgkmcnt(0)
v_mfma_f32_16x16x32_bf16 a[0:3], v[144:147], v[200:203], a[0:3]
v_mfma_f32_16x16x32_bf16 a[4:7], v[144:147], v[204:207], a[4:7]
v_mfma_f32_16x16x32_bf16 a[8:11], v[144:147], v[208:211], a[8:11]
v_mfma_f32_16x16x32_bf16 a[12:15], v[144:147], v[212:215], a[12:15]
ds_read_b128 v[184:187], v1 offset:20480
buffer_load_dwordx4 v[144:147], v1, s[4:7], s30 offen offset:3072
s_add_u32 s30, s30, 4096
v_mfma_f32_16x16x32_bf16 a[16:19], v[148:151], v[200:203], a[16:19]
v_mfma_f32_16x16x32_bf16 a[20:23], v[148:151], v[204:207], a[20:23]
v_mfma_f32_16x16x32_bf16 a[24:27], v[148:151], v[208:211], a[24:27]
v_mfma_f32_16x16x32_bf16 a[28:31], v[148:151], v[212:215], a[28:31]
ds_read_b128 v[188:191], v1 offset:45056
buffer_load_dwordx4 v[148:151], v1, s[4:7], s31 offen offset:3072
s_add_u32 s31, s31, 4096
v_mfma_f32_16x16x32_bf16 a[32:35], v[152:155], v[200:203], a[32:35]
v_mfma_f32_16x16x32_bf16 a[36:39], v[152:155], v[204:207], a[36:39]
v_mfma_f32_16x16x32_bf16 a[40:43], v[152:155], v[208:211], a[40:43]
v_mfma_f32_16x16x32_bf16 a[44:47], v[152:155], v[212:215], a[44:47]
ds_read_b128 v[192:195], v6 offset:20480
buffer_load_dwordx4 v[152:155], v1, s[4:7], s32 offen offset:3072
s_add_u32 s32, s32, 4096
v_mfma_f32_16x16x32_bf16 a[48:51], v[156:159], v[200:203], a[48:51]
v_mfma_f32_16x16x32_bf16 a[52:55], v[156:159], v[204:207], a[52:55]
v_mfma_f32_16x16x32_bf16 a[56:59], v[156:159], v[208:211], a[56:59]
v_mfma_f32_16x16x32_bf16 a[60:63], v[156:159], v[212:215], a[60:63]
ds_read_b128 v[196:199], v6 offset:45056
buffer_load_dwordx4 v[156:159], v1, s[4:7], s33 offen offset:3072
s_add_u32 s33, s33, 4096
v_mfma_f32_16x16x32_bf16 a[64:67], v[160:163], v[200:203], a[64:67]
v_mfma_f32_16x16x32_bf16 a[68:71], v[160:163], v[204:207], a[68:71]
v_mfma_f32_16x16x32_bf16 a[72:75], v[160:163], v[208:211], a[72:75]
v_mfma_f32_16x16x32_bf16 a[76:79], v[160:163], v[212:215], a[76:79]
buffer_load_dwordx4 v[160:163], v1, s[4:7], s34 offen offset:3072
s_add_u32 s34, s34, 4096
v_mfma_f32_16x16x32_bf16 a[80:83], v[164:167], v[200:203], a[80:83]
v_mfma_f32_16x16x32_bf16 a[84:87], v[164:167], v[204:207], a[84:87]
v_mfma_f32_16x16x32_bf16 a[88:91], v[164:167], v[208:211], a[88:91]
v_mfma_f32_16x16x32_bf16 a[92:95], v[164:167], v[212:215], a[92:95]
buffer_load_dwordx4 v[164:167], v1, s[4:7], s35 offen offset:3072
s_add_u32 s35, s35, 4096
v_mfma_f32_16x16x32_bf16 a[96:99], v[168:171], v[200:203], a[96:99]
v_mfma_f32_16x16x32_bf16 a[100:103], v[168:171], v[204:207], a[100:103]
v_mfma_f32_16x16x32_bf16 a[104:107], v[168:171], v[208:211], a[104:107]
v_mfma_f32_16x16x32_bf16 a[108:111], v[168:171], v[212:215], a[108:111]
buffer_load_dwordx4 v[168:171], v1, s[4:7], s36 offen offset:3072
s_add_u32 s36, s36, 4096
v_mfma_f32_16x16x32_bf16 a[112:115], v[172:175], v[200:203], a[112:115]
v_mfma_f32_16x16x32_bf16 a[116:119], v[172:175], v[204:207], a[116:119]
v_mfma_f32_16x16x32_bf16 a[120:123], v[172:175], v[208:211], a[120:123]
v_mfma_f32_16x16x32_bf16 a[124:127], v[172:175], v[212:215], a[124:127]
buffer_load_dwordx4 v[172:175], v1, s[4:7], s37 offen offset:3072
s_add_u32 s37, s37, 4096
v_mfma_f32_16x16x32_bf16 a[128:131], v[176:179], v[200:203], a[128:131]
v_mfma_f32_16x16x32_bf16 a[132:135], v[176:179], v[204:207], a[132:135]
v_mfma_f32_16x16x32_bf16 a[136:139], v[176:179], v[208:211], a[136:139]
v_mfma_f32_16x16x32_bf16 a[140:143], v[176:179], v[212:215], a[140:143]
buffer_load_dwordx4 v[176:179], v1, s[4:7], s38 offen offset:3072
s_add_u32 s38, s38, 4096
v_mfma_f32_16x16x32_bf16 a[144:147], v[180:183], v[200:203], a[144:147]
v_mfma_f32_16x16x32_bf16 a[148:151], v[180:183], v[204:207], a[148:151]
v_mfma_f32_16x16x32_bf16 a[152:155], v[180:183], v[208:211], a[152:155]
v_mfma_f32_16x16x32_bf16 a[156:159], v[180:183], v[212:215], a[156:159]
buffer_load_dwordx4 v[180:183], v1, s[4:7], s39 offen offset:3072
s_add_u32 s39, s39, 4096
s_waitcnt vmcnt(30)
s_waitcnt lgkmcnt(0)
v_mfma_f32_16x16x32_bf16 a[0:3], v[24:27], v[184:187], a[0:3]
v_mfma_f32_16x16x32_bf16 a[4:7], v[24:27], v[188:191], a[4:7]
v_mfma_f32_16x16x32_bf16 a[8:11], v[24:27], v[192:195], a[8:11]
v_mfma_f32_16x16x32_bf16 a[12:15], v[24:27], v[196:199], a[12:15]
ds_read_b128 v[200:203], v1 offset:21504
v_mfma_f32_16x16x32_bf16 a[16:19], v[28:31], v[184:187], a[16:19]
v_mfma_f32_16x16x32_bf16 a[20:23], v[28:31], v[188:191], a[20:23]
v_mfma_f32_16x16x32_bf16 a[24:27], v[28:31], v[192:195], a[24:27]
v_mfma_f32_16x16x32_bf16 a[28:31], v[28:31], v[196:199], a[28:31]
ds_read_b128 v[204:207], v1 offset:46080
v_mfma_f32_16x16x32_bf16 a[32:35], v[32:35], v[184:187], a[32:35]
v_mfma_f32_16x16x32_bf16 a[36:39], v[32:35], v[188:191], a[36:39]
v_mfma_f32_16x16x32_bf16 a[40:43], v[32:35], v[192:195], a[40:43]
v_mfma_f32_16x16x32_bf16 a[44:47], v[32:35], v[196:199], a[44:47]
ds_read_b128 v[208:211], v6 offset:21504
v_mfma_f32_16x16x32_bf16 a[48:51], v[36:39], v[184:187], a[48:51]
v_mfma_f32_16x16x32_bf16 a[52:55], v[36:39], v[188:191], a[52:55]
v_mfma_f32_16x16x32_bf16 a[56:59], v[36:39], v[192:195], a[56:59]
v_mfma_f32_16x16x32_bf16 a[60:63], v[36:39], v[196:199], a[60:63]
ds_read_b128 v[212:215], v6 offset:46080
v_mfma_f32_16x16x32_bf16 a[64:67], v[40:43], v[184:187], a[64:67]
v_mfma_f32_16x16x32_bf16 a[68:71], v[40:43], v[188:191], a[68:71]
v_mfma_f32_16x16x32_bf16 a[72:75], v[40:43], v[192:195], a[72:75]
v_mfma_f32_16x16x32_bf16 a[76:79], v[40:43], v[196:199], a[76:79]
v_mfma_f32_16x16x32_bf16 a[80:83], v[44:47], v[184:187], a[80:83]
v_mfma_f32_16x16x32_bf16 a[84:87], v[44:47], v[188:191], a[84:87]
v_mfma_f32_16x16x32_bf16 a[88:91], v[44:47], v[192:195], a[88:91]
v_mfma_f32_16x16x32_bf16 a[92:95], v[44:47], v[196:199], a[92:95]
v_mfma_f32_16x16x32_bf16 a[96:99], v[48:51], v[184:187], a[96:99]
v_mfma_f32_16x16x32_bf16 a[100:103], v[48:51], v[188:191], a[100:103]
v_mfma_f32_16x16x32_bf16 a[104:107], v[48:51], v[192:195], a[104:107]
v_mfma_f32_16x16x32_bf16 a[108:111], v[48:51], v[196:199], a[108:111]
v_mfma_f32_16x16x32_bf16 a[112:115], v[52:55], v[184:187], a[112:115]
v_mfma_f32_16x16x32_bf16 a[116:119], v[52:55], v[188:191], a[116:119]
v_mfma_f32_16x16x32_bf16 a[120:123], v[52:55], v[192:195], a[120:123]
v_mfma_f32_16x16x32_bf16 a[124:127], v[52:55], v[196:199], a[124:127]
v_mfma_f32_16x16x32_bf16 a[128:131], v[56:59], v[184:187], a[128:131]
v_mfma_f32_16x16x32_bf16 a[132:135], v[56:59], v[188:191], a[132:135]
v_mfma_f32_16x16x32_bf16 a[136:139], v[56:59], v[192:195], a[136:139]
v_mfma_f32_16x16x32_bf16 a[140:143], v[56:59], v[196:199], a[140:143]
v_mfma_f32_16x16x32_bf16 a[144:147], v[60:63], v[184:187], a[144:147]
v_mfma_f32_16x16x32_bf16 a[148:151], v[60:63], v[188:191], a[148:151]
v_mfma_f32_16x16x32_bf16 a[152:155], v[60:63], v[192:195], a[152:155]
v_mfma_f32_16x16x32_bf16 a[156:159], v[60:63], v[196:199], a[156:159]
s_waitcnt vmcnt(20)
s_waitcnt lgkmcnt(0)
v_mfma_f32_16x16x32_bf16 a[0:3], v[64:67], v[200:203], a[0:3]
v_mfma_f32_16x16x32_bf16 a[4:7], v[64:67], v[204:207], a[4:7]
v_mfma_f32_16x16x32_bf16 a[8:11], v[64:67], v[208:211], a[8:11]
v_mfma_f32_16x16x32_bf16 a[12:15], v[64:67], v[212:215], a[12:15]
ds_read_b128 v[184:187], v1 offset:22528
v_mfma_f32_16x16x32_bf16 a[16:19], v[68:71], v[200:203], a[16:19]
v_mfma_f32_16x16x32_bf16 a[20:23], v[68:71], v[204:207], a[20:23]
v_mfma_f32_16x16x32_bf16 a[24:27], v[68:71], v[208:211], a[24:27]
v_mfma_f32_16x16x32_bf16 a[28:31], v[68:71], v[212:215], a[28:31]
ds_read_b128 v[188:191], v1 offset:47104
v_mfma_f32_16x16x32_bf16 a[32:35], v[72:75], v[200:203], a[32:35]
v_mfma_f32_16x16x32_bf16 a[36:39], v[72:75], v[204:207], a[36:39]
v_mfma_f32_16x16x32_bf16 a[40:43], v[72:75], v[208:211], a[40:43]
v_mfma_f32_16x16x32_bf16 a[44:47], v[72:75], v[212:215], a[44:47]
ds_read_b128 v[192:195], v6 offset:22528
v_mfma_f32_16x16x32_bf16 a[48:51], v[76:79], v[200:203], a[48:51]
v_mfma_f32_16x16x32_bf16 a[52:55], v[76:79], v[204:207], a[52:55]
v_mfma_f32_16x16x32_bf16 a[56:59], v[76:79], v[208:211], a[56:59]
v_mfma_f32_16x16x32_bf16 a[60:63], v[76:79], v[212:215], a[60:63]
ds_read_b128 v[196:199], v6 offset:47104
v_mfma_f32_16x16x32_bf16 a[64:67], v[80:83], v[200:203], a[64:67]
v_mfma_f32_16x16x32_bf16 a[68:71], v[80:83], v[204:207], a[68:71]
v_mfma_f32_16x16x32_bf16 a[72:75], v[80:83], v[208:211], a[72:75]
v_mfma_f32_16x16x32_bf16 a[76:79], v[80:83], v[212:215], a[76:79]
v_mfma_f32_16x16x32_bf16 a[80:83], v[84:87], v[200:203], a[80:83]
v_mfma_f32_16x16x32_bf16 a[84:87], v[84:87], v[204:207], a[84:87]
v_mfma_f32_16x16x32_bf16 a[88:91], v[84:87], v[208:211], a[88:91]
v_mfma_f32_16x16x32_bf16 a[92:95], v[84:87], v[212:215], a[92:95]
v_mfma_f32_16x16x32_bf16 a[96:99], v[88:91], v[200:203], a[96:99]
v_mfma_f32_16x16x32_bf16 a[100:103], v[88:91], v[204:207], a[100:103]
v_mfma_f32_16x16x32_bf16 a[104:107], v[88:91], v[208:211], a[104:107]
v_mfma_f32_16x16x32_bf16 a[108:111], v[88:91], v[212:215], a[108:111]
v_mfma_f32_16x16x32_bf16 a[112:115], v[92:95], v[200:203], a[112:115]
v_mfma_f32_16x16x32_bf16 a[116:119], v[92:95], v[204:207], a[116:119]
v_mfma_f32_16x16x32_bf16 a[120:123], v[92:95], v[208:211], a[120:123]
v_mfma_f32_16x16x32_bf16 a[124:127], v[92:95], v[212:215], a[124:127]
v_mfma_f32_16x16x32_bf16 a[128:131], v[96:99], v[200:203], a[128:131]
v_mfma_f32_16x16x32_bf16 a[132:135], v[96:99], v[204:207], a[132:135]
v_mfma_f32_16x16x32_bf16 a[136:139], v[96:99], v[208:211], a[136:139]
v_mfma_f32_16x16x32_bf16 a[140:143], v[96:99], v[212:215], a[140:143]
v_mfma_f32_16x16x32_bf16 a[144:147], v[100:103], v[200:203], a[144:147]
v_mfma_f32_16x16x32_bf16 a[148:151], v[100:103], v[204:207], a[148:151]
v_mfma_f32_16x16x32_bf16 a[152:155], v[100:103], v[208:211], a[152:155]
v_mfma_f32_16x16x32_bf16 a[156:159], v[100:103], v[212:215], a[156:159]
s_waitcnt vmcnt(10)
s_waitcnt lgkmcnt(0)
v_mfma_f32_16x16x32_bf16 a[0:3], v[104:107], v[184:187], a[0:3]
v_mfma_f32_16x16x32_bf16 a[4:7], v[104:107], v[188:191], a[4:7]
v_mfma_f32_16x16x32_bf16 a[8:11], v[104:107], v[192:195], a[8:11]
v_mfma_f32_16x16x32_bf16 a[12:15], v[104:107], v[196:199], a[12:15]
ds_read_b128 v[200:203], v1 offset:23552
v_mfma_f32_16x16x32_bf16 a[16:19], v[108:111], v[184:187], a[16:19]
v_mfma_f32_16x16x32_bf16 a[20:23], v[108:111], v[188:191], a[20:23]
v_mfma_f32_16x16x32_bf16 a[24:27], v[108:111], v[192:195], a[24:27]
v_mfma_f32_16x16x32_bf16 a[28:31], v[108:111], v[196:199], a[28:31]
ds_read_b128 v[204:207], v1 offset:48128
v_mfma_f32_16x16x32_bf16 a[32:35], v[112:115], v[184:187], a[32:35]
v_mfma_f32_16x16x32_bf16 a[36:39], v[112:115], v[188:191], a[36:39]
v_mfma_f32_16x16x32_bf16 a[40:43], v[112:115], v[192:195], a[40:43]
v_mfma_f32_16x16x32_bf16 a[44:47], v[112:115], v[196:199], a[44:47]
ds_read_b128 v[208:211], v6 offset:23552
v_mfma_f32_16x16x32_bf16 a[48:51], v[116:119], v[184:187], a[48:51]
v_mfma_f32_16x16x32_bf16 a[52:55], v[116:119], v[188:191], a[52:55]
v_mfma_f32_16x16x32_bf16 a[56:59], v[116:119], v[192:195], a[56:59]
v_mfma_f32_16x16x32_bf16 a[60:63], v[116:119], v[196:199], a[60:63]
ds_read_b128 v[212:215], v6 offset:48128
v_mfma_f32_16x16x32_bf16 a[64:67], v[120:123], v[184:187], a[64:67]
v_mfma_f32_16x16x32_bf16 a[68:71], v[120:123], v[188:191], a[68:71]
v_mfma_f32_16x16x32_bf16 a[72:75], v[120:123], v[192:195], a[72:75]
v_mfma_f32_16x16x32_bf16 a[76:79], v[120:123], v[196:199], a[76:79]
v_mfma_f32_16x16x32_bf16 a[80:83], v[124:127], v[184:187], a[80:83]
v_mfma_f32_16x16x32_bf16 a[84:87], v[124:127], v[188:191], a[84:87]
v_mfma_f32_16x16x32_bf16 a[88:91], v[124:127], v[192:195], a[88:91]
v_mfma_f32_16x16x32_bf16 a[92:95], v[124:127], v[196:199], a[92:95]
v_mfma_f32_16x16x32_bf16 a[96:99], v[128:131], v[184:187], a[96:99]
v_mfma_f32_16x16x32_bf16 a[100:103], v[128:131], v[188:191], a[100:103]
v_mfma_f32_16x16x32_bf16 a[104:107], v[128:131], v[192:195], a[104:107]
v_mfma_f32_16x16x32_bf16 a[108:111], v[128:131], v[196:199], a[108:111]
v_mfma_f32_16x16x32_bf16 a[112:115], v[132:135], v[184:187], a[112:115]
v_mfma_f32_16x16x32_bf16 a[116:119], v[132:135], v[188:191], a[116:119]
v_mfma_f32_16x16x32_bf16 a[120:123], v[132:135], v[192:195], a[120:123]
v_mfma_f32_16x16x32_bf16 a[124:127], v[132:135], v[196:199], a[124:127]
v_mfma_f32_16x16x32_bf16 a[128:131], v[136:139], v[184:187], a[128:131]
v_mfma_f32_16x16x32_bf16 a[132:135], v[136:139], v[188:191], a[132:135]
v_mfma_f32_16x16x32_bf16 a[136:139], v[136:139], v[192:195], a[136:139]
v_mfma_f32_16x16x32_bf16 a[140:143], v[136:139], v[196:199], a[140:143]
v_mfma_f32_16x16x32_bf16 a[144:147], v[140:143], v[184:187], a[144:147]
v_mfma_f32_16x16x32_bf16 a[148:151], v[140:143], v[188:191], a[148:151]
v_mfma_f32_16x16x32_bf16 a[152:155], v[140:143], v[192:195], a[152:155]
v_mfma_f32_16x16x32_bf16 a[156:159], v[140:143], v[196:199], a[156:159]
s_waitcnt vmcnt(0)
s_waitcnt lgkmcnt(0)
v_mfma_f32_16x16x32_bf16 a[0:3], v[144:147], v[200:203], a[0:3]
v_mfma_f32_16x16x32_bf16 a[4:7], v[144:147], v[204:207], a[4:7]
v_mfma_f32_16x16x32_bf16 a[8:11], v[144:147], v[208:211], a[8:11]
v_mfma_f32_16x16x32_bf16 a[12:15], v[144:147], v[212:215], a[12:15]
v_mfma_f32_16x16x32_bf16 a[16:19], v[148:151], v[200:203], a[16:19]
v_mfma_f32_16x16x32_bf16 a[20:23], v[148:151], v[204:207], a[20:23]
v_mfma_f32_16x16x32_bf16 a[24:27], v[148:151], v[208:211], a[24:27]
v_mfma_f32_16x16x32_bf16 a[28:31], v[148:151], v[212:215], a[28:31]
v_mfma_f32_16x16x32_bf16 a[32:35], v[152:155], v[200:203], a[32:35]
v_mfma_f32_16x16x32_bf16 a[36:39], v[152:155], v[204:207], a[36:39]
v_mfma_f32_16x16x32_bf16 a[40:43], v[152:155], v[208:211], a[40:43]
v_mfma_f32_16x16x32_bf16 a[44:47], v[152:155], v[212:215], a[44:47]
v_mfma_f32_16x16x32_bf16 a[48:51], v[156:159], v[200:203], a[48:51]
v_mfma_f32_16x16x32_bf16 a[52:55], v[156:159], v[204:207], a[52:55]
v_mfma_f32_16x16x32_bf16 a[56:59], v[156:159], v[208:211], a[56:59]
v_mfma_f32_16x16x32_bf16 a[60:63], v[156:159], v[212:215], a[60:63]
v_mfma_f32_16x16x32_bf16 a[64:67], v[160:163], v[200:203], a[64:67]
v_mfma_f32_16x16x32_bf16 a[68:71], v[160:163], v[204:207], a[68:71]
v_mfma_f32_16x16x32_bf16 a[72:75], v[160:163], v[208:211], a[72:75]
v_mfma_f32_16x16x32_bf16 a[76:79], v[160:163], v[212:215], a[76:79]
v_mfma_f32_16x16x32_bf16 a[80:83], v[164:167], v[200:203], a[80:83]
v_mfma_f32_16x16x32_bf16 a[84:87], v[164:167], v[204:207], a[84:87]
v_mfma_f32_16x16x32_bf16 a[88:91], v[164:167], v[208:211], a[88:91]
v_mfma_f32_16x16x32_bf16 a[92:95], v[164:167], v[212:215], a[92:95]
v_mfma_f32_16x16x32_bf16 a[96:99], v[168:171], v[200:203], a[96:99]
v_mfma_f32_16x16x32_bf16 a[100:103], v[168:171], v[204:207], a[100:103]
v_mfma_f32_16x16x32_bf16 a[104:107], v[168:171], v[208:211], a[104:107]
v_mfma_f32_16x16x32_bf16 a[108:111], v[168:171], v[212:215], a[108:111]
v_mfma_f32_16x16x32_bf16 a[112:115], v[172:175], v[200:203], a[112:115]
v_mfma_f32_16x16x32_bf16 a[116:119], v[172:175], v[204:207], a[116:119]
v_mfma_f32_16x16x32_bf16 a[120:123], v[172:175], v[208:211], a[120:123]
v_mfma_f32_16x16x32_bf16 a[124:127], v[172:175], v[212:215], a[124:127]
v_mfma_f32_16x16x32_bf16 a[128:131], v[176:179], v[200:203], a[128:131]
v_mfma_f32_16x16x32_bf16 a[132:135], v[176:179], v[204:207], a[132:135]
v_mfma_f32_16x16x32_bf16 a[136:139], v[176:179], v[208:211], a[136:139]
v_mfma_f32_16x16x32_bf16 a[140:143], v[176:179], v[212:215], a[140:143]
v_mfma_f32_16x16x32_bf16 a[144:147], v[180:183], v[200:203], a[144:147]
v_mfma_f32_16x16x32_bf16 a[148:151], v[180:183], v[204:207], a[148:151]
v_mfma_f32_16x16x32_bf16 a[152:155], v[180:183], v[208:211], a[152:155]
v_mfma_f32_16x16x32_bf16 a[156:159], v[180:183], v[212:215], a[156:159]
fin_store4:
s_lshl_b32 s16, s13, 7
s_lshl_b32 s17, s14, 2
s_add_u32 s16, s16, s17
s_mul_i32 s16, s16, 20
s_mul_i32 s17, s12, 5
s_add_u32 s16, s16, s17
s_lshl_b32 s16, s16, 10
s_add_u32 s16, s16, 90832896
s_nop 7
s_add_u32 s17, s16, 0
v_accvgpr_read_b32 v24, a0
v_accvgpr_read_b32 v25, a1
v_accvgpr_read_b32 v26, a2
v_accvgpr_read_b32 v27, a3
v_accvgpr_read_b32 v28, a16
v_accvgpr_read_b32 v29, a17
v_accvgpr_read_b32 v30, a18
v_accvgpr_read_b32 v31, a19
v_cvt_pk_bf16_f32 v32, v24, v25
v_cvt_pk_bf16_f32 v33, v26, v27
v_cvt_pk_bf16_f32 v34, v28, v29
v_cvt_pk_bf16_f32 v35, v30, v31
buffer_store_dwordx4 v[32:35], v1, s[4:7], s17 offen offset:0 sc1
v_accvgpr_read_b32 v36, a32
v_accvgpr_read_b32 v37, a33
v_accvgpr_read_b32 v38, a34
v_accvgpr_read_b32 v39, a35
v_accvgpr_read_b32 v40, a48
v_accvgpr_read_b32 v41, a49
v_accvgpr_read_b32 v42, a50
v_accvgpr_read_b32 v43, a51
v_cvt_pk_bf16_f32 v44, v36, v37
v_cvt_pk_bf16_f32 v45, v38, v39
v_cvt_pk_bf16_f32 v46, v40, v41
v_cvt_pk_bf16_f32 v47, v42, v43
buffer_store_dwordx4 v[44:47], v1, s[4:7], s17 offen offset:1024 sc1
v_accvgpr_read_b32 v48, a64
v_accvgpr_read_b32 v49, a65
v_accvgpr_read_b32 v50, a66
v_accvgpr_read_b32 v51, a67
v_accvgpr_read_b32 v52, a80
v_accvgpr_read_b32 v53, a81
v_accvgpr_read_b32 v54, a82
v_accvgpr_read_b32 v55, a83
v_cvt_pk_bf16_f32 v56, v48, v49
v_cvt_pk_bf16_f32 v57, v50, v51
v_cvt_pk_bf16_f32 v58, v52, v53
v_cvt_pk_bf16_f32 v59, v54, v55
buffer_store_dwordx4 v[56:59], v1, s[4:7], s17 offen offset:2048 sc1
v_accvgpr_read_b32 v60, a96
v_accvgpr_read_b32 v61, a97
v_accvgpr_read_b32 v62, a98
v_accvgpr_read_b32 v63, a99
v_accvgpr_read_b32 v64, a112
v_accvgpr_read_b32 v65, a113
v_accvgpr_read_b32 v66, a114
v_accvgpr_read_b32 v67, a115
v_cvt_pk_bf16_f32 v68, v60, v61
v_cvt_pk_bf16_f32 v69, v62, v63
v_cvt_pk_bf16_f32 v70, v64, v65
v_cvt_pk_bf16_f32 v71, v66, v67
buffer_store_dwordx4 v[68:71], v1, s[4:7], s17 offen offset:3072 sc1
v_accvgpr_read_b32 v24, a128
v_accvgpr_read_b32 v25, a129
v_accvgpr_read_b32 v26, a130
v_accvgpr_read_b32 v27, a131
v_accvgpr_read_b32 v28, a144
v_accvgpr_read_b32 v29, a145
v_accvgpr_read_b32 v30, a146
v_accvgpr_read_b32 v31, a147
v_cvt_pk_bf16_f32 v32, v24, v25
v_cvt_pk_bf16_f32 v33, v26, v27
v_cvt_pk_bf16_f32 v34, v28, v29
v_cvt_pk_bf16_f32 v35, v30, v31
s_add_u32 s17, s17, 4096
buffer_store_dwordx4 v[32:35], v1, s[4:7], s17 offen offset:0 sc1
s_add_u32 s17, s16, 20480
v_accvgpr_read_b32 v36, a4
v_accvgpr_read_b32 v37, a5
v_accvgpr_read_b32 v38, a6
v_accvgpr_read_b32 v39, a7
v_accvgpr_read_b32 v40, a20
v_accvgpr_read_b32 v41, a21
v_accvgpr_read_b32 v42, a22
v_accvgpr_read_b32 v43, a23
v_cvt_pk_bf16_f32 v44, v36, v37
v_cvt_pk_bf16_f32 v45, v38, v39
v_cvt_pk_bf16_f32 v46, v40, v41
v_cvt_pk_bf16_f32 v47, v42, v43
buffer_store_dwordx4 v[44:47], v1, s[4:7], s17 offen offset:0 sc1
v_accvgpr_read_b32 v48, a36
v_accvgpr_read_b32 v49, a37
v_accvgpr_read_b32 v50, a38
v_accvgpr_read_b32 v51, a39
v_accvgpr_read_b32 v52, a52
v_accvgpr_read_b32 v53, a53
v_accvgpr_read_b32 v54, a54
v_accvgpr_read_b32 v55, a55
v_cvt_pk_bf16_f32 v56, v48, v49
v_cvt_pk_bf16_f32 v57, v50, v51
v_cvt_pk_bf16_f32 v58, v52, v53
v_cvt_pk_bf16_f32 v59, v54, v55
buffer_store_dwordx4 v[56:59], v1, s[4:7], s17 offen offset:1024 sc1
v_accvgpr_read_b32 v60, a68
v_accvgpr_read_b32 v61, a69
v_accvgpr_read_b32 v62, a70
v_accvgpr_read_b32 v63, a71
v_accvgpr_read_b32 v64, a84
v_accvgpr_read_b32 v65, a85
v_accvgpr_read_b32 v66, a86
v_accvgpr_read_b32 v67, a87
v_cvt_pk_bf16_f32 v68, v60, v61
v_cvt_pk_bf16_f32 v69, v62, v63
v_cvt_pk_bf16_f32 v70, v64, v65
v_cvt_pk_bf16_f32 v71, v66, v67
buffer_store_dwordx4 v[68:71], v1, s[4:7], s17 offen offset:2048 sc1
v_accvgpr_read_b32 v24, a100
v_accvgpr_read_b32 v25, a101
v_accvgpr_read_b32 v26, a102
v_accvgpr_read_b32 v27, a103
v_accvgpr_read_b32 v28, a116
v_accvgpr_read_b32 v29, a117
v_accvgpr_read_b32 v30, a118
v_accvgpr_read_b32 v31, a119
v_cvt_pk_bf16_f32 v32, v24, v25
v_cvt_pk_bf16_f32 v33, v26, v27
v_cvt_pk_bf16_f32 v34, v28, v29
v_cvt_pk_bf16_f32 v35, v30, v31
buffer_store_dwordx4 v[32:35], v1, s[4:7], s17 offen offset:3072 sc1
v_accvgpr_read_b32 v36, a132
v_accvgpr_read_b32 v37, a133
v_accvgpr_read_b32 v38, a134
v_accvgpr_read_b32 v39, a135
v_accvgpr_read_b32 v40, a148
v_accvgpr_read_b32 v41, a149
v_accvgpr_read_b32 v42, a150
v_accvgpr_read_b32 v43, a151
v_cvt_pk_bf16_f32 v44, v36, v37
v_cvt_pk_bf16_f32 v45, v38, v39
v_cvt_pk_bf16_f32 v46, v40, v41
v_cvt_pk_bf16_f32 v47, v42, v43
s_add_u32 s17, s17, 4096
buffer_store_dwordx4 v[44:47], v1, s[4:7], s17 offen offset:0 sc1
s_add_u32 s17, s16, 40960
v_accvgpr_read_b32 v48, a8
v_accvgpr_read_b32 v49, a9
v_accvgpr_read_b32 v50, a10
v_accvgpr_read_b32 v51, a11
v_accvgpr_read_b32 v52, a24
v_accvgpr_read_b32 v53, a25
v_accvgpr_read_b32 v54, a26
v_accvgpr_read_b32 v55, a27
v_cvt_pk_bf16_f32 v56, v48, v49
v_cvt_pk_bf16_f32 v57, v50, v51
v_cvt_pk_bf16_f32 v58, v52, v53
v_cvt_pk_bf16_f32 v59, v54, v55
buffer_store_dwordx4 v[56:59], v1, s[4:7], s17 offen offset:0 sc1
v_accvgpr_read_b32 v60, a40
v_accvgpr_read_b32 v61, a41
v_accvgpr_read_b32 v62, a42
v_accvgpr_read_b32 v63, a43
v_accvgpr_read_b32 v64, a56
v_accvgpr_read_b32 v65, a57
v_accvgpr_read_b32 v66, a58
v_accvgpr_read_b32 v67, a59
v_cvt_pk_bf16_f32 v68, v60, v61
v_cvt_pk_bf16_f32 v69, v62, v63
v_cvt_pk_bf16_f32 v70, v64, v65
v_cvt_pk_bf16_f32 v71, v66, v67
buffer_store_dwordx4 v[68:71], v1, s[4:7], s17 offen offset:1024 sc1
v_accvgpr_read_b32 v24, a72
v_accvgpr_read_b32 v25, a73
v_accvgpr_read_b32 v26, a74
v_accvgpr_read_b32 v27, a75
v_accvgpr_read_b32 v28, a88
v_accvgpr_read_b32 v29, a89
v_accvgpr_read_b32 v30, a90
v_accvgpr_read_b32 v31, a91
v_cvt_pk_bf16_f32 v32, v24, v25
v_cvt_pk_bf16_f32 v33, v26, v27
v_cvt_pk_bf16_f32 v34, v28, v29
v_cvt_pk_bf16_f32 v35, v30, v31
buffer_store_dwordx4 v[32:35], v1, s[4:7], s17 offen offset:2048 sc1
v_accvgpr_read_b32 v36, a104
v_accvgpr_read_b32 v37, a105
v_accvgpr_read_b32 v38, a106
v_accvgpr_read_b32 v39, a107
v_accvgpr_read_b32 v40, a120
v_accvgpr_read_b32 v41, a121
v_accvgpr_read_b32 v42, a122
v_accvgpr_read_b32 v43, a123
v_cvt_pk_bf16_f32 v44, v36, v37
v_cvt_pk_bf16_f32 v45, v38, v39
v_cvt_pk_bf16_f32 v46, v40, v41
v_cvt_pk_bf16_f32 v47, v42, v43
buffer_store_dwordx4 v[44:47], v1, s[4:7], s17 offen offset:3072 sc1
v_accvgpr_read_b32 v48, a136
v_accvgpr_read_b32 v49, a137
v_accvgpr_read_b32 v50, a138
v_accvgpr_read_b32 v51, a139
v_accvgpr_read_b32 v52, a152
v_accvgpr_read_b32 v53, a153
v_accvgpr_read_b32 v54, a154
v_accvgpr_read_b32 v55, a155
v_cvt_pk_bf16_f32 v56, v48, v49
v_cvt_pk_bf16_f32 v57, v50, v51
v_cvt_pk_bf16_f32 v58, v52, v53
v_cvt_pk_bf16_f32 v59, v54, v55
s_add_u32 s17, s17, 4096
buffer_store_dwordx4 v[56:59], v1, s[4:7], s17 offen offset:0 sc1
s_add_u32 s17, s16, 61440
v_accvgpr_read_b32 v60, a12
v_accvgpr_read_b32 v61, a13
v_accvgpr_read_b32 v62, a14
v_accvgpr_read_b32 v63, a15
v_accvgpr_read_b32 v64, a28
v_accvgpr_read_b32 v65, a29
v_accvgpr_read_b32 v66, a30
v_accvgpr_read_b32 v67, a31
v_cvt_pk_bf16_f32 v68, v60, v61
v_cvt_pk_bf16_f32 v69, v62, v63
v_cvt_pk_bf16_f32 v70, v64, v65
v_cvt_pk_bf16_f32 v71, v66, v67
buffer_store_dwordx4 v[68:71], v1, s[4:7], s17 offen offset:0 sc1
v_accvgpr_read_b32 v24, a44
v_accvgpr_read_b32 v25, a45
v_accvgpr_read_b32 v26, a46
v_accvgpr_read_b32 v27, a47
v_accvgpr_read_b32 v28, a60
v_accvgpr_read_b32 v29, a61
v_accvgpr_read_b32 v30, a62
v_accvgpr_read_b32 v31, a63
v_cvt_pk_bf16_f32 v32, v24, v25
v_cvt_pk_bf16_f32 v33, v26, v27
v_cvt_pk_bf16_f32 v34, v28, v29
v_cvt_pk_bf16_f32 v35, v30, v31
buffer_store_dwordx4 v[32:35], v1, s[4:7], s17 offen offset:1024 sc1
v_accvgpr_read_b32 v36, a76
v_accvgpr_read_b32 v37, a77
v_accvgpr_read_b32 v38, a78
v_accvgpr_read_b32 v39, a79
v_accvgpr_read_b32 v40, a92
v_accvgpr_read_b32 v41, a93
v_accvgpr_read_b32 v42, a94
v_accvgpr_read_b32 v43, a95
v_cvt_pk_bf16_f32 v44, v36, v37
v_cvt_pk_bf16_f32 v45, v38, v39
v_cvt_pk_bf16_f32 v46, v40, v41
v_cvt_pk_bf16_f32 v47, v42, v43
buffer_store_dwordx4 v[44:47], v1, s[4:7], s17 offen offset:2048 sc1
v_accvgpr_read_b32 v48, a108
v_accvgpr_read_b32 v49, a109
v_accvgpr_read_b32 v50, a110
v_accvgpr_read_b32 v51, a111
v_accvgpr_read_b32 v52, a124
v_accvgpr_read_b32 v53, a125
v_accvgpr_read_b32 v54, a126
v_accvgpr_read_b32 v55, a127
v_cvt_pk_bf16_f32 v56, v48, v49
v_cvt_pk_bf16_f32 v57, v50, v51
v_cvt_pk_bf16_f32 v58, v52, v53
v_cvt_pk_bf16_f32 v59, v54, v55
buffer_store_dwordx4 v[56:59], v1, s[4:7], s17 offen offset:3072 sc1
v_accvgpr_read_b32 v60, a140
v_accvgpr_read_b32 v61, a141
v_accvgpr_read_b32 v62, a142
v_accvgpr_read_b32 v63, a143
v_accvgpr_read_b32 v64, a156
v_accvgpr_read_b32 v65, a157
v_accvgpr_read_b32 v66, a158
v_accvgpr_read_b32 v67, a159
v_cvt_pk_bf16_f32 v68, v60, v61
v_cvt_pk_bf16_f32 v69, v62, v63
v_cvt_pk_bf16_f32 v70, v64, v65
v_cvt_pk_bf16_f32 v71, v66, v67
s_add_u32 s17, s17, 4096
buffer_store_dwordx4 v[68:71], v1, s[4:7], s17 offen offset:0 sc1
fin_exit1:
s_endpgm
.globl redln1_kernel
.p2align 8
.type redln1_kernel,@function
redln1_kernel:
s_cmp_ge_u32 s2, 256
s_cbranch_scc1 redln1_exit1
s_load_dwordx2 s[12:13], s[0:1], 96
s_load_dwordx2 s[14:15], s[0:1], 0
v_lshrrev_b32 v2, 6, v0
v_and_b32 v3, 63, v0
s_lshr_b32 s19, s2, 1
v_readfirstlane_b32 s16, v2
s_and_b32 s18, s2, 1
s_waitcnt lgkmcnt(0)
s_mov_b32 s4, s12
s_mov_b32 s5, s13
s_mov_b32 s6, 0x10000000
s_mov_b32 s7, 0x20000
s_mov_b32 s8, s14
s_mov_b32 s9, s15
s_mov_b32 s10, 2621440
s_mov_b32 s11, 0x20000
s_mov_b32 s20, 0
v_and_b32 v2, 7, v3
v_bfe_u32 v4, v3, 3, 2
v_lshrrev_b32 v5, 5, v3
s_lshl_b32 s17, s18, 7
v_lshlrev_b32 v14, 4, v2
v_lshl_add_u32 v14, v4, 8, v14
v_lshl_add_u32 v14, v5, 10, v14
v_add_u32 v14, s17, v14
s_lshl_b32 s17, s2, 3
v_add_u32 v15, s17, v2
v_mul_u32_u24 v15, 1280, v15
v_lshl_add_u32 v15, v4, 4, v15
v_lshl_add_u32 v15, v5, 6, v15
s_mul_i32 s17, s16, 640
s_add_u32 s20, s20, s17
s_add_u32 s21, s17, 82313216
s_mul_i32 s22, s19, 20
s_mul_i32 s23, s16, 10
s_add_u32 s22, s22, s23
s_lshl_b32 s22, s22, 10
s_add_u32 s34, s22, 54525952
s_add_u32 s22, s22, 90832896
s_add_u32 s24, s22, 0
s_add_u32 s25, s22, 2621440
s_add_u32 s26, s22, 5242880
s_add_u32 s27, s22, 7864320
s_add_u32 s28, s22, 10485760
s_add_u32 s29, s22, 13107200
s_add_u32 s30, s22, 15728640
s_add_u32 s31, s22, 18350080
v_add_u32 v6, 0x1000, v14
v_add_u32 v7, 0x2000, v14
buffer_load_dwordx4 v[16:19], v15, s[8:11], s20 offen offset:0
buffer_load_dwordx4 v[20:23], v15, s[8:11], s20 offen offset:128
buffer_load_dwordx4 v[24:27], v15, s[8:11], s20 offen offset:256
buffer_load_dwordx4 v[28:31], v15, s[8:11], s20 offen offset:384
buffer_load_dwordx4 v[32:35], v15, s[8:11], s20 offen offset:512
buffer_load_dwordx4 v[80:83], v14, s[4:7], s24 offen offset:0
buffer_load_dwordx4 v[84:87], v14, s[4:7], s25 offen offset:0
buffer_load_dwordx4 v[88:91], v14, s[4:7], s26 offen offset:0
buffer_load_dwordx4 v[92:95], v14, s[4:7], s27 offen offset:0
buffer_load_dwordx4 v[96:99], v14, s[4:7], s28 offen offset:0
buffer_load_dwordx4 v[100:103], v14, s[4:7], s29 offen offset:0
buffer_load_dwordx4 v[104:107], v14, s[4:7], s30 offen offset:0
buffer_load_dwordx4 v[108:111], v14, s[4:7], s31 offen offset:0
buffer_load_dwordx4 v[112:115], v14, s[4:7], s24 offen offset:2048
buffer_load_dwordx4 v[116:119], v14, s[4:7], s25 offen offset:2048
buffer_load_dwordx4 v[120:123], v14, s[4:7], s26 offen offset:2048
buffer_load_dwordx4 v[124:127], v14, s[4:7], s27 offen offset:2048
buffer_load_dwordx4 v[128:131], v14, s[4:7], s28 offen offset:2048
buffer_load_dwordx4 v[132:135], v14, s[4:7], s29 offen offset:2048
buffer_load_dwordx4 v[136:139], v14, s[4:7], s30 offen offset:2048
buffer_load_dwordx4 v[140:143], v14, s[4:7], s31 offen offset:2048
buffer_load_dwordx4 v[144:147], v6, s[4:7], s24 offen offset:0
buffer_load_dwordx4 v[148:151], v6, s[4:7], s25 offen offset:0
buffer_load_dwordx4 v[152:155], v6, s[4:7], s26 offen offset:0
buffer_load_dwordx4 v[156:159], v6, s[4:7], s27 offen offset:0
buffer_load_dwordx4 v[160:163], v6, s[4:7], s28 offen offset:0
buffer_load_dwordx4 v[164:167], v6, s[4:7], s29 offen offset:0
buffer_load_dwordx4 v[168:171], v6, s[4:7], s30 offen offset:0
buffer_load_dwordx4 v[172:175], v6, s[4:7], s31 offen offset:0
buffer_load_dwordx4 v[176:179], v6, s[4:7], s24 offen offset:2048
buffer_load_dwordx4 v[180:183], v6, s[4:7], s25 offen offset:2048
buffer_load_dwordx4 v[184:187], v6, s[4:7], s26 offen offset:2048
buffer_load_dwordx4 v[188:191], v6, s[4:7], s27 offen offset:2048
buffer_load_dwordx4 v[192:195], v6, s[4:7], s28 offen offset:2048
buffer_load_dwordx4 v[196:199], v6, s[4:7], s29 offen offset:2048
buffer_load_dwordx4 v[200:203], v6, s[4:7], s30 offen offset:2048
buffer_load_dwordx4 v[204:207], v6, s[4:7], s31 offen offset:2048
buffer_load_dwordx4 v[208:211], v7, s[4:7], s24 offen offset:0
buffer_load_dwordx4 v[212:215], v7, s[4:7], s25 offen offset:0
buffer_load_dwordx4 v[216:219], v7, s[4:7], s26 offen offset:0
buffer_load_dwordx4 v[220:223], v7, s[4:7], s27 offen offset:0
buffer_load_dwordx4 v[224:227], v7, s[4:7], s28 offen offset:0
buffer_load_dwordx4 v[228:231], v7, s[4:7], s29 offen offset:0
buffer_load_dwordx4 v[232:235], v7, s[4:7], s30 offen offset:0
buffer_load_dwordx4 v[236:239], v7, s[4:7], s31 offen offset:0
s_waitcnt vmcnt(32)
v_lshlrev_b32 v36, 16, v80
v_and_b32 v37, 0xffff0000, v80
v_lshlrev_b32 v38, 16, v81
v_and_b32 v39, 0xffff0000, v81
v_lshlrev_b32 v40, 16, v82
v_and_b32 v41, 0xffff0000, v82
v_lshlrev_b32 v42, 16, v83
v_and_b32 v43, 0xffff0000, v83
v_lshlrev_b32 v8, 16, v84
v_and_b32 v9, 0xffff0000, v84
v_pk_add_f32 v[36:37], v[36:37], v[8:9]
v_lshlrev_b32 v10, 16, v85
v_and_b32 v11, 0xffff0000, v85
v_pk_add_f32 v[38:39], v[38:39], v[10:11]
v_lshlrev_b32 v8, 16, v86
v_and_b32 v9, 0xffff0000, v86
v_pk_add_f32 v[40:41], v[40:41], v[8:9]
v_lshlrev_b32 v10, 16, v87
v_and_b32 v11, 0xffff0000, v87
v_pk_add_f32 v[42:43], v[42:43], v[10:11]
v_lshlrev_b32 v8, 16, v88
v_and_b32 v9, 0xffff0000, v88
v_pk_add_f32 v[36:37], v[36:37], v[8:9]
v_lshlrev_b32 v10, 16, v89
v_and_b32 v11, 0xffff0000, v89
v_pk_add_f32 v[38:39], v[38:39], v[10:11]
v_lshlrev_b32 v8, 16, v90
v_and_b32 v9, 0xffff0000, v90
v_pk_add_f32 v[40:41], v[40:41], v[8:9]
v_lshlrev_b32 v10, 16, v91
v_and_b32 v11, 0xffff0000, v91
v_pk_add_f32 v[42:43], v[42:43], v[10:11]
v_lshlrev_b32 v8, 16, v92
v_and_b32 v9, 0xffff0000, v92
v_pk_add_f32 v[36:37], v[36:37], v[8:9]
v_lshlrev_b32 v10, 16, v93
v_and_b32 v11, 0xffff0000, v93
v_pk_add_f32 v[38:39], v[38:39], v[10:11]
v_lshlrev_b32 v8, 16, v94
v_and_b32 v9, 0xffff0000, v94
v_pk_add_f32 v[40:41], v[40:41], v[8:9]
v_lshlrev_b32 v10, 16, v95
v_and_b32 v11, 0xffff0000, v95
v_pk_add_f32 v[42:43], v[42:43], v[10:11]
v_lshlrev_b32 v8, 16, v96
v_and_b32 v9, 0xffff0000, v96
v_pk_add_f32 v[36:37], v[36:37], v[8:9]
v_lshlrev_b32 v10, 16, v97
v_and_b32 v11, 0xffff0000, v97
v_pk_add_f32 v[38:39], v[38:39], v[10:11]
v_lshlrev_b32 v8, 16, v98
v_and_b32 v9, 0xffff0000, v98
v_pk_add_f32 v[40:41], v[40:41], v[8:9]
v_lshlrev_b32 v10, 16, v99
v_and_b32 v11, 0xffff0000, v99
v_pk_add_f32 v[42:43], v[42:43], v[10:11]
v_lshlrev_b32 v8, 16, v100
v_and_b32 v9, 0xffff0000, v100
v_pk_add_f32 v[36:37], v[36:37], v[8:9]
v_lshlrev_b32 v10, 16, v101
v_and_b32 v11, 0xffff0000, v101
v_pk_add_f32 v[38:39], v[38:39], v[10:11]
v_lshlrev_b32 v8, 16, v102
v_and_b32 v9, 0xffff0000, v102
v_pk_add_f32 v[40:41], v[40:41], v[8:9]
v_lshlrev_b32 v10, 16, v103
v_and_b32 v11, 0xffff0000, v103
v_pk_add_f32 v[42:43], v[42:43], v[10:11]
v_lshlrev_b32 v8, 16, v104
v_and_b32 v9, 0xffff0000, v104
v_pk_add_f32 v[36:37], v[36:37], v[8:9]
v_lshlrev_b32 v10, 16, v105
v_and_b32 v11, 0xffff0000, v105
v_pk_add_f32 v[38:39], v[38:39], v[10:11]
v_lshlrev_b32 v8, 16, v106
v_and_b32 v9, 0xffff0000, v106
v_pk_add_f32 v[40:41], v[40:41], v[8:9]
v_lshlrev_b32 v10, 16, v107
v_and_b32 v11, 0xffff0000, v107
v_pk_add_f32 v[42:43], v[42:43], v[10:11]
v_lshlrev_b32 v8, 16, v108
v_and_b32 v9, 0xffff0000, v108
v_pk_add_f32 v[36:37], v[36:37], v[8:9]
v_lshlrev_b32 v10, 16, v109
v_and_b32 v11, 0xffff0000, v109
v_pk_add_f32 v[38:39], v[38:39], v[10:11]
v_lshlrev_b32 v8, 16, v110
v_and_b32 v9, 0xffff0000, v110
v_pk_add_f32 v[40:41], v[40:41], v[8:9]
v_lshlrev_b32 v10, 16, v111
v_and_b32 v11, 0xffff0000, v111
v_pk_add_f32 v[42:43], v[42:43], v[10:11]
v_cvt_pk_bf16_f32 v8, v36, v37
v_lshlrev_b32 v36, 16, v8
v_and_b32 v37, 0xffff0000, v8
v_lshlrev_b32 v10, 16, v16
v_and_b32 v11, 0xffff0000, v16
v_pk_add_f32 v[36:37], v[36:37], v[10:11]
v_cvt_pk_bf16_f32 v16, v36, v37
v_lshlrev_b32 v36, 16, v16
v_and_b32 v37, 0xffff0000, v16
v_cvt_pk_bf16_f32 v8, v38, v39
v_lshlrev_b32 v38, 16, v8
v_and_b32 v39, 0xffff0000, v8
v_lshlrev_b32 v10, 16, v17
v_and_b32 v11, 0xffff0000, v17
v_pk_add_f32 v[38:39], v[38:39], v[10:11]
v_cvt_pk_bf16_f32 v17, v38, v39
v_lshlrev_b32 v38, 16, v17
v_and_b32 v39, 0xffff0000, v17
v_cvt_pk_bf16_f32 v8, v40, v41
v_lshlrev_b32 v40, 16, v8
v_and_b32 v41, 0xffff0000, v8
v_lshlrev_b32 v10, 16, v18
v_and_b32 v11, 0xffff0000, v18
v_pk_add_f32 v[40:41], v[40:41], v[10:11]
v_cvt_pk_bf16_f32 v18, v40, v41
v_lshlrev_b32 v40, 16, v18
v_and_b32 v41, 0xffff0000, v18
v_cvt_pk_bf16_f32 v8, v42, v43
v_lshlrev_b32 v42, 16, v8
v_and_b32 v43, 0xffff0000, v8
v_lshlrev_b32 v10, 16, v19
v_and_b32 v11, 0xffff0000, v19
v_pk_add_f32 v[42:43], v[42:43], v[10:11]
v_cvt_pk_bf16_f32 v19, v42, v43
v_lshlrev_b32 v42, 16, v19
v_and_b32 v43, 0xffff0000, v19
buffer_store_dwordx4 v[16:19], v15, s[4:7], s21 offen offset:0 sc1
s_waitcnt vmcnt(25)
v_lshlrev_b32 v44, 16, v112
v_and_b32 v45, 0xffff0000, v112
v_lshlrev_b32 v46, 16, v113
v_and_b32 v47, 0xffff0000, v113
v_lshlrev_b32 v48, 16, v114
v_and_b32 v49, 0xffff0000, v114
v_lshlrev_b32 v50, 16, v115
v_and_b32 v51, 0xffff0000, v115
v_lshlrev_b32 v8, 16, v116
v_and_b32 v9, 0xffff0000, v116
v_pk_add_f32 v[44:45], v[44:45], v[8:9]
v_lshlrev_b32 v10, 16, v117
v_and_b32 v11, 0xffff0000, v117
v_pk_add_f32 v[46:47], v[46:47], v[10:11]
v_lshlrev_b32 v8, 16, v118
v_and_b32 v9, 0xffff0000, v118
v_pk_add_f32 v[48:49], v[48:49], v[8:9]
v_lshlrev_b32 v10, 16, v119
v_and_b32 v11, 0xffff0000, v119
v_pk_add_f32 v[50:51], v[50:51], v[10:11]
v_lshlrev_b32 v8, 16, v120
v_and_b32 v9, 0xffff0000, v120
v_pk_add_f32 v[44:45], v[44:45], v[8:9]
v_lshlrev_b32 v10, 16, v121
v_and_b32 v11, 0xffff0000, v121
v_pk_add_f32 v[46:47], v[46:47], v[10:11]
v_lshlrev_b32 v8, 16, v122
v_and_b32 v9, 0xffff0000, v122
v_pk_add_f32 v[48:49], v[48:49], v[8:9]
v_lshlrev_b32 v10, 16, v123
v_and_b32 v11, 0xffff0000, v123
v_pk_add_f32 v[50:51], v[50:51], v[10:11]
v_lshlrev_b32 v8, 16, v124
v_and_b32 v9, 0xffff0000, v124
v_pk_add_f32 v[44:45], v[44:45], v[8:9]
v_lshlrev_b32 v10, 16, v125
v_and_b32 v11, 0xffff0000, v125
v_pk_add_f32 v[46:47], v[46:47], v[10:11]
v_lshlrev_b32 v8, 16, v126
v_and_b32 v9, 0xffff0000, v126
v_pk_add_f32 v[48:49], v[48:49], v[8:9]
v_lshlrev_b32 v10, 16, v127
v_and_b32 v11, 0xffff0000, v127
v_pk_add_f32 v[50:51], v[50:51], v[10:11]
v_lshlrev_b32 v8, 16, v128
v_and_b32 v9, 0xffff0000, v128
v_pk_add_f32 v[44:45], v[44:45], v[8:9]
v_lshlrev_b32 v10, 16, v129
v_and_b32 v11, 0xffff0000, v129
v_pk_add_f32 v[46:47], v[46:47], v[10:11]
v_lshlrev_b32 v8, 16, v130
v_and_b32 v9, 0xffff0000, v130
v_pk_add_f32 v[48:49], v[48:49], v[8:9]
v_lshlrev_b32 v10, 16, v131
v_and_b32 v11, 0xffff0000, v131
v_pk_add_f32 v[50:51], v[50:51], v[10:11]
v_lshlrev_b32 v8, 16, v132
v_and_b32 v9, 0xffff0000, v132
v_pk_add_f32 v[44:45], v[44:45], v[8:9]
v_lshlrev_b32 v10, 16, v133
v_and_b32 v11, 0xffff0000, v133
v_pk_add_f32 v[46:47], v[46:47], v[10:11]
v_lshlrev_b32 v8, 16, v134
v_and_b32 v9, 0xffff0000, v134
v_pk_add_f32 v[48:49], v[48:49], v[8:9]
v_lshlrev_b32 v10, 16, v135
v_and_b32 v11, 0xffff0000, v135
v_pk_add_f32 v[50:51], v[50:51], v[10:11]
v_lshlrev_b32 v8, 16, v136
v_and_b32 v9, 0xffff0000, v136
v_pk_add_f32 v[44:45], v[44:45], v[8:9]
v_lshlrev_b32 v10, 16, v137
v_and_b32 v11, 0xffff0000, v137
v_pk_add_f32 v[46:47], v[46:47], v[10:11]
v_lshlrev_b32 v8, 16, v138
v_and_b32 v9, 0xffff0000, v138
v_pk_add_f32 v[48:49], v[48:49], v[8:9]
v_lshlrev_b32 v10, 16, v139
v_and_b32 v11, 0xffff0000, v139
v_pk_add_f32 v[50:51], v[50:51], v[10:11]
v_lshlrev_b32 v8, 16, v140
v_and_b32 v9, 0xffff0000, v140
v_pk_add_f32 v[44:45], v[44:45], v[8:9]
v_lshlrev_b32 v10, 16, v141
v_and_b32 v11, 0xffff0000, v141
v_pk_add_f32 v[46:47], v[46:47], v[10:11]
v_lshlrev_b32 v8, 16, v142
v_and_b32 v9, 0xffff0000, v142
v_pk_add_f32 v[48:49], v[48:49], v[8:9]
v_lshlrev_b32 v10, 16, v143
v_and_b32 v11, 0xffff0000, v143
v_pk_add_f32 v[50:51], v[50:51], v[10:11]
v_cvt_pk_bf16_f32 v8, v44, v45
v_lshlrev_b32 v44, 16, v8
v_and_b32 v45, 0xffff0000, v8
v_lshlrev_b32 v10, 16, v20
v_and_b32 v11, 0xffff0000, v20
v_pk_add_f32 v[44:45], v[44:45], v[10:11]
v_cvt_pk_bf16_f32 v20, v44, v45
v_lshlrev_b32 v44, 16, v20
v_and_b32 v45, 0xffff0000, v20
v_cvt_pk_bf16_f32 v8, v46, v47
v_lshlrev_b32 v46, 16, v8
v_and_b32 v47, 0xffff0000, v8
v_lshlrev_b32 v10, 16, v21
v_and_b32 v11, 0xffff0000, v21
v_pk_add_f32 v[46:47], v[46:47], v[10:11]
v_cvt_pk_bf16_f32 v21, v46, v47
v_lshlrev_b32 v46, 16, v21
v_and_b32 v47, 0xffff0000, v21
v_cvt_pk_bf16_f32 v8, v48, v49
v_lshlrev_b32 v48, 16, v8
v_and_b32 v49, 0xffff0000, v8
v_lshlrev_b32 v10, 16, v22
v_and_b32 v11, 0xffff0000, v22
v_pk_add_f32 v[48:49], v[48:49], v[10:11]
v_cvt_pk_bf16_f32 v22, v48, v49
v_lshlrev_b32 v48, 16, v22
v_and_b32 v49, 0xffff0000, v22
v_cvt_pk_bf16_f32 v8, v50, v51
v_lshlrev_b32 v50, 16, v8
v_and_b32 v51, 0xffff0000, v8
v_lshlrev_b32 v10, 16, v23
v_and_b32 v11, 0xffff0000, v23
v_pk_add_f32 v[50:51], v[50:51], v[10:11]
v_cvt_pk_bf16_f32 v23, v50, v51
v_lshlrev_b32 v50, 16, v23
v_and_b32 v51, 0xffff0000, v23
buffer_store_dwordx4 v[20:23], v15, s[4:7], s21 offen offset:128 sc1
s_waitcnt vmcnt(18)
v_lshlrev_b32 v52, 16, v144
v_and_b32 v53, 0xffff0000, v144
v_lshlrev_b32 v54, 16, v145
v_and_b32 v55, 0xffff0000, v145
v_lshlrev_b32 v56, 16, v146
v_and_b32 v57, 0xffff0000, v146
v_lshlrev_b32 v58, 16, v147
v_and_b32 v59, 0xffff0000, v147
v_lshlrev_b32 v8, 16, v148
v_and_b32 v9, 0xffff0000, v148
v_pk_add_f32 v[52:53], v[52:53], v[8:9]
v_lshlrev_b32 v10, 16, v149
v_and_b32 v11, 0xffff0000, v149
v_pk_add_f32 v[54:55], v[54:55], v[10:11]
v_lshlrev_b32 v8, 16, v150
v_and_b32 v9, 0xffff0000, v150
v_pk_add_f32 v[56:57], v[56:57], v[8:9]
v_lshlrev_b32 v10, 16, v151
v_and_b32 v11, 0xffff0000, v151
v_pk_add_f32 v[58:59], v[58:59], v[10:11]
v_lshlrev_b32 v8, 16, v152
v_and_b32 v9, 0xffff0000, v152
v_pk_add_f32 v[52:53], v[52:53], v[8:9]
v_lshlrev_b32 v10, 16, v153
v_and_b32 v11, 0xffff0000, v153
v_pk_add_f32 v[54:55], v[54:55], v[10:11]
v_lshlrev_b32 v8, 16, v154
v_and_b32 v9, 0xffff0000, v154
v_pk_add_f32 v[56:57], v[56:57], v[8:9]
v_lshlrev_b32 v10, 16, v155
v_and_b32 v11, 0xffff0000, v155
v_pk_add_f32 v[58:59], v[58:59], v[10:11]
v_lshlrev_b32 v8, 16, v156
v_and_b32 v9, 0xffff0000, v156
v_pk_add_f32 v[52:53], v[52:53], v[8:9]
v_lshlrev_b32 v10, 16, v157
v_and_b32 v11, 0xffff0000, v157
v_pk_add_f32 v[54:55], v[54:55], v[10:11]
v_lshlrev_b32 v8, 16, v158
v_and_b32 v9, 0xffff0000, v158
v_pk_add_f32 v[56:57], v[56:57], v[8:9]
v_lshlrev_b32 v10, 16, v159
v_and_b32 v11, 0xffff0000, v159
v_pk_add_f32 v[58:59], v[58:59], v[10:11]
v_lshlrev_b32 v8, 16, v160
v_and_b32 v9, 0xffff0000, v160
v_pk_add_f32 v[52:53], v[52:53], v[8:9]
v_lshlrev_b32 v10, 16, v161
v_and_b32 v11, 0xffff0000, v161
v_pk_add_f32 v[54:55], v[54:55], v[10:11]
v_lshlrev_b32 v8, 16, v162
v_and_b32 v9, 0xffff0000, v162
v_pk_add_f32 v[56:57], v[56:57], v[8:9]
v_lshlrev_b32 v10, 16, v163
v_and_b32 v11, 0xffff0000, v163
v_pk_add_f32 v[58:59], v[58:59], v[10:11]
v_lshlrev_b32 v8, 16, v164
v_and_b32 v9, 0xffff0000, v164
v_pk_add_f32 v[52:53], v[52:53], v[8:9]
v_lshlrev_b32 v10, 16, v165
v_and_b32 v11, 0xffff0000, v165
v_pk_add_f32 v[54:55], v[54:55], v[10:11]
v_lshlrev_b32 v8, 16, v166
v_and_b32 v9, 0xffff0000, v166
v_pk_add_f32 v[56:57], v[56:57], v[8:9]
v_lshlrev_b32 v10, 16, v167
v_and_b32 v11, 0xffff0000, v167
v_pk_add_f32 v[58:59], v[58:59], v[10:11]
v_lshlrev_b32 v8, 16, v168
v_and_b32 v9, 0xffff0000, v168
v_pk_add_f32 v[52:53], v[52:53], v[8:9]
v_lshlrev_b32 v10, 16, v169
v_and_b32 v11, 0xffff0000, v169
v_pk_add_f32 v[54:55], v[54:55], v[10:11]
v_lshlrev_b32 v8, 16, v170
v_and_b32 v9, 0xffff0000, v170
v_pk_add_f32 v[56:57], v[56:57], v[8:9]
v_lshlrev_b32 v10, 16, v171
v_and_b32 v11, 0xffff0000, v171
v_pk_add_f32 v[58:59], v[58:59], v[10:11]
v_lshlrev_b32 v8, 16, v172
v_and_b32 v9, 0xffff0000, v172
v_pk_add_f32 v[52:53], v[52:53], v[8:9]
v_lshlrev_b32 v10, 16, v173
v_and_b32 v11, 0xffff0000, v173
v_pk_add_f32 v[54:55], v[54:55], v[10:11]
v_lshlrev_b32 v8, 16, v174
v_and_b32 v9, 0xffff0000, v174
v_pk_add_f32 v[56:57], v[56:57], v[8:9]
v_lshlrev_b32 v10, 16, v175
v_and_b32 v11, 0xffff0000, v175
v_pk_add_f32 v[58:59], v[58:59], v[10:11]
v_cvt_pk_bf16_f32 v8, v52, v53
v_lshlrev_b32 v52, 16, v8
v_and_b32 v53, 0xffff0000, v8
v_lshlrev_b32 v10, 16, v24
v_and_b32 v11, 0xffff0000, v24
v_pk_add_f32 v[52:53], v[52:53], v[10:11]
v_cvt_pk_bf16_f32 v24, v52, v53
v_lshlrev_b32 v52, 16, v24
v_and_b32 v53, 0xffff0000, v24
v_cvt_pk_bf16_f32 v8, v54, v55
v_lshlrev_b32 v54, 16, v8
v_and_b32 v55, 0xffff0000, v8
v_lshlrev_b32 v10, 16, v25
v_and_b32 v11, 0xffff0000, v25
v_pk_add_f32 v[54:55], v[54:55], v[10:11]
v_cvt_pk_bf16_f32 v25, v54, v55
v_lshlrev_b32 v54, 16, v25
v_and_b32 v55, 0xffff0000, v25
v_cvt_pk_bf16_f32 v8, v56, v57
v_lshlrev_b32 v56, 16, v8
v_and_b32 v57, 0xffff0000, v8
v_lshlrev_b32 v10, 16, v26
v_and_b32 v11, 0xffff0000, v26
v_pk_add_f32 v[56:57], v[56:57], v[10:11]
v_cvt_pk_bf16_f32 v26, v56, v57
v_lshlrev_b32 v56, 16, v26
v_and_b32 v57, 0xffff0000, v26
v_cvt_pk_bf16_f32 v8, v58, v59
v_lshlrev_b32 v58, 16, v8
v_and_b32 v59, 0xffff0000, v8
v_lshlrev_b32 v10, 16, v27
v_and_b32 v11, 0xffff0000, v27
v_pk_add_f32 v[58:59], v[58:59], v[10:11]
v_cvt_pk_bf16_f32 v27, v58, v59
v_lshlrev_b32 v58, 16, v27
v_and_b32 v59, 0xffff0000, v27
buffer_store_dwordx4 v[24:27], v15, s[4:7], s21 offen offset:256 sc1
s_waitcnt vmcnt(11)
v_lshlrev_b32 v60, 16, v176
v_and_b32 v61, 0xffff0000, v176
v_lshlrev_b32 v62, 16, v177
v_and_b32 v63, 0xffff0000, v177
v_lshlrev_b32 v64, 16, v178
v_and_b32 v65, 0xffff0000, v178
v_lshlrev_b32 v66, 16, v179
v_and_b32 v67, 0xffff0000, v179
v_lshlrev_b32 v8, 16, v180
v_and_b32 v9, 0xffff0000, v180
v_pk_add_f32 v[60:61], v[60:61], v[8:9]
v_lshlrev_b32 v10, 16, v181
v_and_b32 v11, 0xffff0000, v181
v_pk_add_f32 v[62:63], v[62:63], v[10:11]
v_lshlrev_b32 v8, 16, v182
v_and_b32 v9, 0xffff0000, v182
v_pk_add_f32 v[64:65], v[64:65], v[8:9]
v_lshlrev_b32 v10, 16, v183
v_and_b32 v11, 0xffff0000, v183
v_pk_add_f32 v[66:67], v[66:67], v[10:11]
v_lshlrev_b32 v8, 16, v184
v_and_b32 v9, 0xffff0000, v184
v_pk_add_f32 v[60:61], v[60:61], v[8:9]
v_lshlrev_b32 v10, 16, v185
v_and_b32 v11, 0xffff0000, v185
v_pk_add_f32 v[62:63], v[62:63], v[10:11]
v_lshlrev_b32 v8, 16, v186
v_and_b32 v9, 0xffff0000, v186
v_pk_add_f32 v[64:65], v[64:65], v[8:9]
v_lshlrev_b32 v10, 16, v187
v_and_b32 v11, 0xffff0000, v187
v_pk_add_f32 v[66:67], v[66:67], v[10:11]
v_lshlrev_b32 v8, 16, v188
v_and_b32 v9, 0xffff0000, v188
v_pk_add_f32 v[60:61], v[60:61], v[8:9]
v_lshlrev_b32 v10, 16, v189
v_and_b32 v11, 0xffff0000, v189
v_pk_add_f32 v[62:63], v[62:63], v[10:11]
v_lshlrev_b32 v8, 16, v190
v_and_b32 v9, 0xffff0000, v190
v_pk_add_f32 v[64:65], v[64:65], v[8:9]
v_lshlrev_b32 v10, 16, v191
v_and_b32 v11, 0xffff0000, v191
v_pk_add_f32 v[66:67], v[66:67], v[10:11]
v_lshlrev_b32 v8, 16, v192
v_and_b32 v9, 0xffff0000, v192
v_pk_add_f32 v[60:61], v[60:61], v[8:9]
v_lshlrev_b32 v10, 16, v193
v_and_b32 v11, 0xffff0000, v193
v_pk_add_f32 v[62:63], v[62:63], v[10:11]
v_lshlrev_b32 v8, 16, v194
v_and_b32 v9, 0xffff0000, v194
v_pk_add_f32 v[64:65], v[64:65], v[8:9]
v_lshlrev_b32 v10, 16, v195
v_and_b32 v11, 0xffff0000, v195
v_pk_add_f32 v[66:67], v[66:67], v[10:11]
v_lshlrev_b32 v8, 16, v196
v_and_b32 v9, 0xffff0000, v196
v_pk_add_f32 v[60:61], v[60:61], v[8:9]
v_lshlrev_b32 v10, 16, v197
v_and_b32 v11, 0xffff0000, v197
v_pk_add_f32 v[62:63], v[62:63], v[10:11]
v_lshlrev_b32 v8, 16, v198
v_and_b32 v9, 0xffff0000, v198
v_pk_add_f32 v[64:65], v[64:65], v[8:9]
v_lshlrev_b32 v10, 16, v199
v_and_b32 v11, 0xffff0000, v199
v_pk_add_f32 v[66:67], v[66:67], v[10:11]
v_lshlrev_b32 v8, 16, v200
v_and_b32 v9, 0xffff0000, v200
v_pk_add_f32 v[60:61], v[60:61], v[8:9]
v_lshlrev_b32 v10, 16, v201
v_and_b32 v11, 0xffff0000, v201
v_pk_add_f32 v[62:63], v[62:63], v[10:11]
v_lshlrev_b32 v8, 16, v202
v_and_b32 v9, 0xffff0000, v202
v_pk_add_f32 v[64:65], v[64:65], v[8:9]
v_lshlrev_b32 v10, 16, v203
v_and_b32 v11, 0xffff0000, v203
v_pk_add_f32 v[66:67], v[66:67], v[10:11]
v_lshlrev_b32 v8, 16, v204
v_and_b32 v9, 0xffff0000, v204
v_pk_add_f32 v[60:61], v[60:61], v[8:9]
v_lshlrev_b32 v10, 16, v205
v_and_b32 v11, 0xffff0000, v205
v_pk_add_f32 v[62:63], v[62:63], v[10:11]
v_lshlrev_b32 v8, 16, v206
v_and_b32 v9, 0xffff0000, v206
v_pk_add_f32 v[64:65], v[64:65], v[8:9]
v_lshlrev_b32 v10, 16, v207
v_and_b32 v11, 0xffff0000, v207
v_pk_add_f32 v[66:67], v[66:67], v[10:11]
v_cvt_pk_bf16_f32 v8, v60, v61
v_lshlrev_b32 v60, 16, v8
v_and_b32 v61, 0xffff0000, v8
v_lshlrev_b32 v10, 16, v28
v_and_b32 v11, 0xffff0000, v28
v_pk_add_f32 v[60:61], v[60:61], v[10:11]
v_cvt_pk_bf16_f32 v28, v60, v61
v_lshlrev_b32 v60, 16, v28
v_and_b32 v61, 0xffff0000, v28
v_cvt_pk_bf16_f32 v8, v62, v63
v_lshlrev_b32 v62, 16, v8
v_and_b32 v63, 0xffff0000, v8
v_lshlrev_b32 v10, 16, v29
v_and_b32 v11, 0xffff0000, v29
v_pk_add_f32 v[62:63], v[62:63], v[10:11]
v_cvt_pk_bf16_f32 v29, v62, v63
v_lshlrev_b32 v62, 16, v29
v_and_b32 v63, 0xffff0000, v29
v_cvt_pk_bf16_f32 v8, v64, v65
v_lshlrev_b32 v64, 16, v8
v_and_b32 v65, 0xffff0000, v8
v_lshlrev_b32 v10, 16, v30
v_and_b32 v11, 0xffff0000, v30
v_pk_add_f32 v[64:65], v[64:65], v[10:11]
v_cvt_pk_bf16_f32 v30, v64, v65
v_lshlrev_b32 v64, 16, v30
v_and_b32 v65, 0xffff0000, v30
v_cvt_pk_bf16_f32 v8, v66, v67
v_lshlrev_b32 v66, 16, v8
v_and_b32 v67, 0xffff0000, v8
v_lshlrev_b32 v10, 16, v31
v_and_b32 v11, 0xffff0000, v31
v_pk_add_f32 v[66:67], v[66:67], v[10:11]
v_cvt_pk_bf16_f32 v31, v66, v67
v_lshlrev_b32 v66, 16, v31
v_and_b32 v67, 0xffff0000, v31
buffer_store_dwordx4 v[28:31], v15, s[4:7], s21 offen offset:384 sc1
s_waitcnt vmcnt(4)
v_lshlrev_b32 v68, 16, v208
v_and_b32 v69, 0xffff0000, v208
v_lshlrev_b32 v70, 16, v209
v_and_b32 v71, 0xffff0000, v209
v_lshlrev_b32 v72, 16, v210
v_and_b32 v73, 0xffff0000, v210
v_lshlrev_b32 v74, 16, v211
v_and_b32 v75, 0xffff0000, v211
v_lshlrev_b32 v8, 16, v212
v_and_b32 v9, 0xffff0000, v212
v_pk_add_f32 v[68:69], v[68:69], v[8:9]
v_lshlrev_b32 v10, 16, v213
v_and_b32 v11, 0xffff0000, v213
v_pk_add_f32 v[70:71], v[70:71], v[10:11]
v_lshlrev_b32 v8, 16, v214
v_and_b32 v9, 0xffff0000, v214
v_pk_add_f32 v[72:73], v[72:73], v[8:9]
v_lshlrev_b32 v10, 16, v215
v_and_b32 v11, 0xffff0000, v215
v_pk_add_f32 v[74:75], v[74:75], v[10:11]
v_lshlrev_b32 v8, 16, v216
v_and_b32 v9, 0xffff0000, v216
v_pk_add_f32 v[68:69], v[68:69], v[8:9]
v_lshlrev_b32 v10, 16, v217
v_and_b32 v11, 0xffff0000, v217
v_pk_add_f32 v[70:71], v[70:71], v[10:11]
v_lshlrev_b32 v8, 16, v218
v_and_b32 v9, 0xffff0000, v218
v_pk_add_f32 v[72:73], v[72:73], v[8:9]
v_lshlrev_b32 v10, 16, v219
v_and_b32 v11, 0xffff0000, v219
v_pk_add_f32 v[74:75], v[74:75], v[10:11]
v_lshlrev_b32 v8, 16, v220
v_and_b32 v9, 0xffff0000, v220
v_pk_add_f32 v[68:69], v[68:69], v[8:9]
v_lshlrev_b32 v10, 16, v221
v_and_b32 v11, 0xffff0000, v221
v_pk_add_f32 v[70:71], v[70:71], v[10:11]
v_lshlrev_b32 v8, 16, v222
v_and_b32 v9, 0xffff0000, v222
v_pk_add_f32 v[72:73], v[72:73], v[8:9]
v_lshlrev_b32 v10, 16, v223
v_and_b32 v11, 0xffff0000, v223
v_pk_add_f32 v[74:75], v[74:75], v[10:11]
v_lshlrev_b32 v8, 16, v224
v_and_b32 v9, 0xffff0000, v224
v_pk_add_f32 v[68:69], v[68:69], v[8:9]
v_lshlrev_b32 v10, 16, v225
v_and_b32 v11, 0xffff0000, v225
v_pk_add_f32 v[70:71], v[70:71], v[10:11]
v_lshlrev_b32 v8, 16, v226
v_and_b32 v9, 0xffff0000, v226
v_pk_add_f32 v[72:73], v[72:73], v[8:9]
v_lshlrev_b32 v10, 16, v227
v_and_b32 v11, 0xffff0000, v227
v_pk_add_f32 v[74:75], v[74:75], v[10:11]
v_lshlrev_b32 v8, 16, v228
v_and_b32 v9, 0xffff0000, v228
v_pk_add_f32 v[68:69], v[68:69], v[8:9]
v_lshlrev_b32 v10, 16, v229
v_and_b32 v11, 0xffff0000, v229
v_pk_add_f32 v[70:71], v[70:71], v[10:11]
v_lshlrev_b32 v8, 16, v230
v_and_b32 v9, 0xffff0000, v230
v_pk_add_f32 v[72:73], v[72:73], v[8:9]
v_lshlrev_b32 v10, 16, v231
v_and_b32 v11, 0xffff0000, v231
v_pk_add_f32 v[74:75], v[74:75], v[10:11]
v_lshlrev_b32 v8, 16, v232
v_and_b32 v9, 0xffff0000, v232
v_pk_add_f32 v[68:69], v[68:69], v[8:9]
v_lshlrev_b32 v10, 16, v233
v_and_b32 v11, 0xffff0000, v233
v_pk_add_f32 v[70:71], v[70:71], v[10:11]
v_lshlrev_b32 v8, 16, v234
v_and_b32 v9, 0xffff0000, v234
v_pk_add_f32 v[72:73], v[72:73], v[8:9]
v_lshlrev_b32 v10, 16, v235
v_and_b32 v11, 0xffff0000, v235
v_pk_add_f32 v[74:75], v[74:75], v[10:11]
v_lshlrev_b32 v8, 16, v236
v_and_b32 v9, 0xffff0000, v236
v_pk_add_f32 v[68:69], v[68:69], v[8:9]
v_lshlrev_b32 v10, 16, v237
v_and_b32 v11, 0xffff0000, v237
v_pk_add_f32 v[70:71], v[70:71], v[10:11]
v_lshlrev_b32 v8, 16, v238
v_and_b32 v9, 0xffff0000, v238
v_pk_add_f32 v[72:73], v[72:73], v[8:9]
v_lshlrev_b32 v10, 16, v239
v_and_b32 v11, 0xffff0000, v239
v_pk_add_f32 v[74:75], v[74:75], v[10:11]
v_cvt_pk_bf16_f32 v8, v68, v69
v_lshlrev_b32 v68, 16, v8
v_and_b32 v69, 0xffff0000, v8
v_lshlrev_b32 v10, 16, v32
v_and_b32 v11, 0xffff0000, v32
v_pk_add_f32 v[68:69], v[68:69], v[10:11]
v_cvt_pk_bf16_f32 v32, v68, v69
v_lshlrev_b32 v68, 16, v32
v_and_b32 v69, 0xffff0000, v32
v_cvt_pk_bf16_f32 v8, v70, v71
v_lshlrev_b32 v70, 16, v8
v_and_b32 v71, 0xffff0000, v8
v_lshlrev_b32 v10, 16, v33
v_and_b32 v11, 0xffff0000, v33
v_pk_add_f32 v[70:71], v[70:71], v[10:11]
v_cvt_pk_bf16_f32 v33, v70, v71
v_lshlrev_b32 v70, 16, v33
v_and_b32 v71, 0xffff0000, v33
v_cvt_pk_bf16_f32 v8, v72, v73
v_lshlrev_b32 v72, 16, v8
v_and_b32 v73, 0xffff0000, v8
v_lshlrev_b32 v10, 16, v34
v_and_b32 v11, 0xffff0000, v34
v_pk_add_f32 v[72:73], v[72:73], v[10:11]
v_cvt_pk_bf16_f32 v34, v72, v73
v_lshlrev_b32 v72, 16, v34
v_and_b32 v73, 0xffff0000, v34
v_cvt_pk_bf16_f32 v8, v74, v75
v_lshlrev_b32 v74, 16, v8
v_and_b32 v75, 0xffff0000, v8
v_lshlrev_b32 v10, 16, v35
v_and_b32 v11, 0xffff0000, v35
v_pk_add_f32 v[74:75], v[74:75], v[10:11]
v_cvt_pk_bf16_f32 v35, v74, v75
v_lshlrev_b32 v74, 16, v35
v_and_b32 v75, 0xffff0000, v35
buffer_store_dwordx4 v[32:35], v15, s[4:7], s21 offen offset:512 sc1
v_and_b32 v3, 63, v0
v_and_b32 v2, 7, v3
v_lshlrev_b32 v5, 2, v2
s_lshl_b32 s17, s16, 5
v_add_u32 v1, s17, v5
v_pk_add_f32 v[6:7], v[36:37], v[38:39]
v_pk_add_f32 v[6:7], v[6:7], v[40:41]
v_pk_add_f32 v[6:7], v[6:7], v[42:43]
v_pk_add_f32 v[6:7], v[6:7], v[44:45]
v_pk_add_f32 v[6:7], v[6:7], v[46:47]
v_pk_add_f32 v[6:7], v[6:7], v[48:49]
v_pk_add_f32 v[6:7], v[6:7], v[50:51]
v_pk_add_f32 v[6:7], v[6:7], v[52:53]
v_pk_add_f32 v[6:7], v[6:7], v[54:55]
v_pk_add_f32 v[6:7], v[6:7], v[56:57]
v_pk_add_f32 v[6:7], v[6:7], v[58:59]
v_pk_add_f32 v[6:7], v[6:7], v[60:61]
v_pk_add_f32 v[6:7], v[6:7], v[62:63]
v_pk_add_f32 v[6:7], v[6:7], v[64:65]
v_pk_add_f32 v[6:7], v[6:7], v[66:67]
v_pk_add_f32 v[6:7], v[6:7], v[68:69]
v_pk_add_f32 v[6:7], v[6:7], v[70:71]
v_pk_add_f32 v[6:7], v[6:7], v[72:73]
v_pk_add_f32 v[6:7], v[6:7], v[74:75]
v_add_f32 v4, v6, v7
s_nop 1
v_add_f32_dpp v4, v4, v4 row_ror:8 row_mask:0xf bank_mask:0xf
v_mov_b32 v2, v4
s_nop 1
v_permlane16_swap_b32 v4, v2
v_add_f32 v4, v4, v2
v_mov_b32 v2, v4
s_nop 1
v_permlane32_swap_b32 v4, v2
v_add_f32 v4, v4, v2
ds_write_b32 v1, v4 offset:0
s_waitcnt lgkmcnt(0)
s_barrier
ds_read_b32 v4, v5 offset:0
ds_read_b32 v2, v5 offset:32
s_waitcnt lgkmcnt(0)
v_add_f32 v4, v4, v2
v_mul_f32 v6, 0xbacccccd, v4
v_mov_b32 v7, v6
v_pk_add_f32 v[36:37], v[36:37], v[6:7]
v_pk_add_f32 v[38:39], v[38:39], v[6:7]
v_pk_add_f32 v[40:41], v[40:41], v[6:7]
v_pk_add_f32 v[42:43], v[42:43], v[6:7]
v_pk_add_f32 v[44:45], v[44:45], v[6:7]
v_pk_add_f32 v[46:47], v[46:47], v[6:7]
v_pk_add_f32 v[48:49], v[48:49], v[6:7]
v_pk_add_f32 v[50:51], v[50:51], v[6:7]
v_pk_add_f32 v[52:53], v[52:53], v[6:7]
v_pk_add_f32 v[54:55], v[54:55], v[6:7]
v_pk_add_f32 v[56:57], v[56:57], v[6:7]
v_pk_add_f32 v[58:59], v[58:59], v[6:7]
v_pk_add_f32 v[60:61], v[60:61], v[6:7]
v_pk_add_f32 v[62:63], v[62:63], v[6:7]
v_pk_add_f32 v[64:65], v[64:65], v[6:7]
v_pk_add_f32 v[66:67], v[66:67], v[6:7]
v_pk_add_f32 v[68:69], v[68:69], v[6:7]
v_pk_add_f32 v[70:71], v[70:71], v[6:7]
v_pk_add_f32 v[72:73], v[72:73], v[6:7]
v_pk_add_f32 v[74:75], v[74:75], v[6:7]
v_pk_mul_f32 v[6:7], v[36:37], v[36:37]
v_pk_fma_f32 v[6:7], v[38:39], v[38:39], v[6:7]
v_pk_fma_f32 v[6:7], v[40:41], v[40:41], v[6:7]
v_pk_fma_f32 v[6:7], v[42:43], v[42:43], v[6:7]
v_pk_fma_f32 v[6:7], v[44:45], v[44:45], v[6:7]
v_pk_fma_f32 v[6:7], v[46:47], v[46:47], v[6:7]
v_pk_fma_f32 v[6:7], v[48:49], v[48:49], v[6:7]
v_pk_fma_f32 v[6:7], v[50:51], v[50:51], v[6:7]
v_pk_fma_f32 v[6:7], v[52:53], v[52:53], v[6:7]
v_pk_fma_f32 v[6:7], v[54:55], v[54:55], v[6:7]
v_pk_fma_f32 v[6:7], v[56:57], v[56:57], v[6:7]
v_pk_fma_f32 v[6:7], v[58:59], v[58:59], v[6:7]
v_pk_fma_f32 v[6:7], v[60:61], v[60:61], v[6:7]
v_pk_fma_f32 v[6:7], v[62:63], v[62:63], v[6:7]
v_pk_fma_f32 v[6:7], v[64:65], v[64:65], v[6:7]
v_pk_fma_f32 v[6:7], v[66:67], v[66:67], v[6:7]
v_pk_fma_f32 v[6:7], v[68:69], v[68:69], v[6:7]
v_pk_fma_f32 v[6:7], v[70:71], v[70:71], v[6:7]
v_pk_fma_f32 v[6:7], v[72:73], v[72:73], v[6:7]
v_pk_fma_f32 v[6:7], v[74:75], v[74:75], v[6:7]
v_add_f32 v4, v6, v7
s_nop 1
v_add_f32_dpp v4, v4, v4 row_ror:8 row_mask:0xf bank_mask:0xf
v_mov_b32 v2, v4
s_nop 1
v_permlane16_swap_b32 v4, v2
v_add_f32 v4, v4, v2
v_mov_b32 v2, v4
s_nop 1
v_permlane32_swap_b32 v4, v2
v_add_f32 v4, v4, v2
ds_write_b32 v1, v4 offset:64
s_waitcnt lgkmcnt(0)
s_barrier
ds_read_b32 v4, v5 offset:64
ds_read_b32 v2, v5 offset:96
s_waitcnt lgkmcnt(0)
v_add_f32 v4, v4, v2
v_mov_b32 v2, 0x3727c5ac
v_fmac_f32 v2, 0x3acccccd, v4
v_rsq_f32 v6, v2
s_nop 0
v_mov_b32 v7, v6
v_pk_mul_f32 v[36:37], v[36:37], v[6:7]
v_pk_mul_f32 v[38:39], v[38:39], v[6:7]
v_pk_mul_f32 v[40:41], v[40:41], v[6:7]
v_pk_mul_f32 v[42:43], v[42:43], v[6:7]
v_pk_mul_f32 v[44:45], v[44:45], v[6:7]
v_pk_mul_f32 v[46:47], v[46:47], v[6:7]
v_pk_mul_f32 v[48:49], v[48:49], v[6:7]
v_pk_mul_f32 v[50:51], v[50:51], v[6:7]
v_pk_mul_f32 v[52:53], v[52:53], v[6:7]
v_pk_mul_f32 v[54:55], v[54:55], v[6:7]
v_pk_mul_f32 v[56:57], v[56:57], v[6:7]
v_pk_mul_f32 v[58:59], v[58:59], v[6:7]
v_pk_mul_f32 v[60:61], v[60:61], v[6:7]
v_pk_mul_f32 v[62:63], v[62:63], v[6:7]
v_pk_mul_f32 v[64:65], v[64:65], v[6:7]
v_pk_mul_f32 v[66:67], v[66:67], v[6:7]
v_pk_mul_f32 v[68:69], v[68:69], v[6:7]
v_pk_mul_f32 v[70:71], v[70:71], v[6:7]
v_pk_mul_f32 v[72:73], v[72:73], v[6:7]
v_pk_mul_f32 v[74:75], v[74:75], v[6:7]
v_cvt_pk_bf16_f32 v16, v36, v37
v_cvt_pk_bf16_f32 v17, v38, v39
v_cvt_pk_bf16_f32 v18, v40, v41
v_cvt_pk_bf16_f32 v19, v42, v43
v_cvt_pk_bf16_f32 v20, v44, v45
v_cvt_pk_bf16_f32 v21, v46, v47
v_cvt_pk_bf16_f32 v22, v48, v49
v_cvt_pk_bf16_f32 v23, v50, v51
v_cvt_pk_bf16_f32 v24, v52, v53
v_cvt_pk_bf16_f32 v25, v54, v55
v_cvt_pk_bf16_f32 v26, v56, v57
v_cvt_pk_bf16_f32 v27, v58, v59
v_cvt_pk_bf16_f32 v28, v60, v61
v_cvt_pk_bf16_f32 v29, v62, v63
v_cvt_pk_bf16_f32 v30, v64, v65
v_cvt_pk_bf16_f32 v31, v66, v67
v_cvt_pk_bf16_f32 v32, v68, v69
v_cvt_pk_bf16_f32 v33, v70, v71
v_cvt_pk_bf16_f32 v34, v72, v73
v_cvt_pk_bf16_f32 v35, v74, v75
v_add_u32 v6, 0x1000, v14
v_add_u32 v7, 0x2000, v14
buffer_store_dwordx4 v[16:19], v14, s[4:7], s34 offen offset:0 sc1
buffer_store_dwordx4 v[20:23], v14, s[4:7], s34 offen offset:2048 sc1
buffer_store_dwordx4 v[24:27], v6, s[4:7], s34 offen offset:0 sc1
buffer_store_dwordx4 v[28:31], v6, s[4:7], s34 offen offset:2048 sc1
buffer_store_dwordx4 v[32:35], v7, s[4:7], s34 offen offset:0 sc1
redln1_exit1:
s_endpgm
.globl redln2_kernel
.p2align 8
.type redln2_kernel,@function
redln2_kernel:
s_cmp_ge_u32 s2, 256
s_cbranch_scc1 redln2_exit1
s_load_dwordx2 s[12:13], s[0:1], 96
s_load_dwordx2 s[14:15], s[0:1], 0
v_lshrrev_b32 v2, 6, v0
v_and_b32 v3, 63, v0
s_lshr_b32 s19, s2, 1
v_readfirstlane_b32 s16, v2
s_and_b32 s18, s2, 1
s_waitcnt lgkmcnt(0)
s_mov_b32 s4, s12
s_mov_b32 s5, s13
s_mov_b32 s6, 0x10000000
s_mov_b32 s7, 0x20000
s_mov_b32 s8, s12
s_mov_b32 s9, s13
s_mov_b32 s10, 0x10000000
s_mov_b32 s11, 0x20000
s_mov_b32 s20, 82313216
v_and_b32 v2, 7, v3
v_bfe_u32 v4, v3, 3, 2
v_lshrrev_b32 v5, 5, v3
s_lshl_b32 s17, s18, 7
v_lshlrev_b32 v14, 4, v2
v_lshl_add_u32 v14, v4, 8, v14
v_lshl_add_u32 v14, v5, 10, v14
v_add_u32 v14, s17, v14
s_lshl_b32 s17, s2, 3
v_add_u32 v15, s17, v2
v_mul_u32_u24 v15, 1280, v15
v_lshl_add_u32 v15, v4, 4, v15
v_lshl_add_u32 v15, v5, 6, v15
s_mul_i32 s17, s16, 640
s_add_u32 s20, s20, s17
s_add_u32 s21, s17, 82313216
s_mul_i32 s22, s19, 20
s_mul_i32 s23, s16, 10
s_add_u32 s22, s22, s23
s_lshl_b32 s22, s22, 10
s_add_u32 s34, s22, 54525952
s_add_u32 s22, s22, 90832896
s_add_u32 s24, s22, 0
s_add_u32 s25, s22, 2621440
s_add_u32 s26, s22, 5242880
s_add_u32 s27, s22, 7864320
s_add_u32 s28, s22, 10485760
s_add_u32 s29, s22, 13107200
s_add_u32 s30, s22, 15728640
s_add_u32 s31, s22, 18350080
v_add_u32 v6, 0x1000, v14
v_add_u32 v7, 0x2000, v14
buffer_load_dwordx4 v[16:19], v15, s[8:11], s20 offen offset:0
buffer_load_dwordx4 v[20:23], v15, s[8:11], s20 offen offset:128
buffer_load_dwordx4 v[24:27], v15, s[8:11], s20 offen offset:256
buffer_load_dwordx4 v[28:31], v15, s[8:11], s20 offen offset:384
buffer_load_dwordx4 v[32:35], v15, s[8:11], s20 offen offset:512
buffer_load_dwordx4 v[80:83], v14, s[4:7], s24 offen offset:0
buffer_load_dwordx4 v[84:87], v14, s[4:7], s25 offen offset:0
buffer_load_dwordx4 v[88:91], v14, s[4:7], s26 offen offset:0
buffer_load_dwordx4 v[92:95], v14, s[4:7], s27 offen offset:0
buffer_load_dwordx4 v[96:99], v14, s[4:7], s28 offen offset:0
buffer_load_dwordx4 v[100:103], v14, s[4:7], s29 offen offset:0
buffer_load_dwordx4 v[104:107], v14, s[4:7], s30 offen offset:0
buffer_load_dwordx4 v[108:111], v14, s[4:7], s31 offen offset:0
buffer_load_dwordx4 v[112:115], v14, s[4:7], s24 offen offset:2048
buffer_load_dwordx4 v[116:119], v14, s[4:7], s25 offen offset:2048
buffer_load_dwordx4 v[120:123], v14, s[4:7], s26 offen offset:2048
buffer_load_dwordx4 v[124:127], v14, s[4:7], s27 offen offset:2048
buffer_load_dwordx4 v[128:131], v14, s[4:7], s28 offen offset:2048
buffer_load_dwordx4 v[132:135], v14, s[4:7], s29 offen offset:2048
buffer_load_dwordx4 v[136:139], v14, s[4:7], s30 offen offset:2048
buffer_load_dwordx4 v[140:143], v14, s[4:7], s31 offen offset:2048
buffer_load_dwordx4 v[144:147], v6, s[4:7], s24 offen offset:0
buffer_load_dwordx4 v[148:151], v6, s[4:7], s25 offen offset:0
buffer_load_dwordx4 v[152:155], v6, s[4:7], s26 offen offset:0
buffer_load_dwordx4 v[156:159], v6, s[4:7], s27 offen offset:0
buffer_load_dwordx4 v[160:163], v6, s[4:7], s28 offen offset:0
buffer_load_dwordx4 v[164:167], v6, s[4:7], s29 offen offset:0
buffer_load_dwordx4 v[168:171], v6, s[4:7], s30 offen offset:0
buffer_load_dwordx4 v[172:175], v6, s[4:7], s31 offen offset:0
buffer_load_dwordx4 v[176:179], v6, s[4:7], s24 offen offset:2048
buffer_load_dwordx4 v[180:183], v6, s[4:7], s25 offen offset:2048
buffer_load_dwordx4 v[184:187], v6, s[4:7], s26 offen offset:2048
buffer_load_dwordx4 v[188:191], v6, s[4:7], s27 offen offset:2048
buffer_load_dwordx4 v[192:195], v6, s[4:7], s28 offen offset:2048
buffer_load_dwordx4 v[196:199], v6, s[4:7], s29 offen offset:2048
buffer_load_dwordx4 v[200:203], v6, s[4:7], s30 offen offset:2048
buffer_load_dwordx4 v[204:207], v6, s[4:7], s31 offen offset:2048
buffer_load_dwordx4 v[208:211], v7, s[4:7], s24 offen offset:0
buffer_load_dwordx4 v[212:215], v7, s[4:7], s25 offen offset:0
buffer_load_dwordx4 v[216:219], v7, s[4:7], s26 offen offset:0
buffer_load_dwordx4 v[220:223], v7, s[4:7], s27 offen offset:0
buffer_load_dwordx4 v[224:227], v7, s[4:7], s28 offen offset:0
buffer_load_dwordx4 v[228:231], v7, s[4:7], s29 offen offset:0
buffer_load_dwordx4 v[232:235], v7, s[4:7], s30 offen offset:0
buffer_load_dwordx4 v[236:239], v7, s[4:7], s31 offen offset:0
s_waitcnt vmcnt(32)
v_lshlrev_b32 v36, 16, v80
v_and_b32 v37, 0xffff0000, v80
v_lshlrev_b32 v38, 16, v81
v_and_b32 v39, 0xffff0000, v81
v_lshlrev_b32 v40, 16, v82
v_and_b32 v41, 0xffff0000, v82
v_lshlrev_b32 v42, 16, v83
v_and_b32 v43, 0xffff0000, v83
v_lshlrev_b32 v8, 16, v84
v_and_b32 v9, 0xffff0000, v84
v_pk_add_f32 v[36:37], v[36:37], v[8:9]
v_lshlrev_b32 v10, 16, v85
v_and_b32 v11, 0xffff0000, v85
v_pk_add_f32 v[38:39], v[38:39], v[10:11]
v_lshlrev_b32 v8, 16, v86
v_and_b32 v9, 0xffff0000, v86
v_pk_add_f32 v[40:41], v[40:41], v[8:9]
v_lshlrev_b32 v10, 16, v87
v_and_b32 v11, 0xffff0000, v87
v_pk_add_f32 v[42:43], v[42:43], v[10:11]
v_lshlrev_b32 v8, 16, v88
v_and_b32 v9, 0xffff0000, v88
v_pk_add_f32 v[36:37], v[36:37], v[8:9]
v_lshlrev_b32 v10, 16, v89
v_and_b32 v11, 0xffff0000, v89
v_pk_add_f32 v[38:39], v[38:39], v[10:11]
v_lshlrev_b32 v8, 16, v90
v_and_b32 v9, 0xffff0000, v90
v_pk_add_f32 v[40:41], v[40:41], v[8:9]
v_lshlrev_b32 v10, 16, v91
v_and_b32 v11, 0xffff0000, v91
v_pk_add_f32 v[42:43], v[42:43], v[10:11]
v_lshlrev_b32 v8, 16, v92
v_and_b32 v9, 0xffff0000, v92
v_pk_add_f32 v[36:37], v[36:37], v[8:9]
v_lshlrev_b32 v10, 16, v93
v_and_b32 v11, 0xffff0000, v93
v_pk_add_f32 v[38:39], v[38:39], v[10:11]
v_lshlrev_b32 v8, 16, v94
v_and_b32 v9, 0xffff0000, v94
v_pk_add_f32 v[40:41], v[40:41], v[8:9]
v_lshlrev_b32 v10, 16, v95
v_and_b32 v11, 0xffff0000, v95
v_pk_add_f32 v[42:43], v[42:43], v[10:11]
v_lshlrev_b32 v8, 16, v96
v_and_b32 v9, 0xffff0000, v96
v_pk_add_f32 v[36:37], v[36:37], v[8:9]
v_lshlrev_b32 v10, 16, v97
v_and_b32 v11, 0xffff0000, v97
v_pk_add_f32 v[38:39], v[38:39], v[10:11]
v_lshlrev_b32 v8, 16, v98
v_and_b32 v9, 0xffff0000, v98
v_pk_add_f32 v[40:41], v[40:41], v[8:9]
v_lshlrev_b32 v10, 16, v99
v_and_b32 v11, 0xffff0000, v99
v_pk_add_f32 v[42:43], v[42:43], v[10:11]
v_lshlrev_b32 v8, 16, v100
v_and_b32 v9, 0xffff0000, v100
v_pk_add_f32 v[36:37], v[36:37], v[8:9]
v_lshlrev_b32 v10, 16, v101
v_and_b32 v11, 0xffff0000, v101
v_pk_add_f32 v[38:39], v[38:39], v[10:11]
v_lshlrev_b32 v8, 16, v102
v_and_b32 v9, 0xffff0000, v102
v_pk_add_f32 v[40:41], v[40:41], v[8:9]
v_lshlrev_b32 v10, 16, v103
v_and_b32 v11, 0xffff0000, v103
v_pk_add_f32 v[42:43], v[42:43], v[10:11]
v_lshlrev_b32 v8, 16, v104
v_and_b32 v9, 0xffff0000, v104
v_pk_add_f32 v[36:37], v[36:37], v[8:9]
v_lshlrev_b32 v10, 16, v105
v_and_b32 v11, 0xffff0000, v105
v_pk_add_f32 v[38:39], v[38:39], v[10:11]
v_lshlrev_b32 v8, 16, v106
v_and_b32 v9, 0xffff0000, v106
v_pk_add_f32 v[40:41], v[40:41], v[8:9]
v_lshlrev_b32 v10, 16, v107
v_and_b32 v11, 0xffff0000, v107
v_pk_add_f32 v[42:43], v[42:43], v[10:11]
v_lshlrev_b32 v8, 16, v108
v_and_b32 v9, 0xffff0000, v108
v_pk_add_f32 v[36:37], v[36:37], v[8:9]
v_lshlrev_b32 v10, 16, v109
v_and_b32 v11, 0xffff0000, v109
v_pk_add_f32 v[38:39], v[38:39], v[10:11]
v_lshlrev_b32 v8, 16, v110
v_and_b32 v9, 0xffff0000, v110
v_pk_add_f32 v[40:41], v[40:41], v[8:9]
v_lshlrev_b32 v10, 16, v111
v_and_b32 v11, 0xffff0000, v111
v_pk_add_f32 v[42:43], v[42:43], v[10:11]
v_cvt_pk_bf16_f32 v8, v36, v37
v_lshlrev_b32 v36, 16, v8
v_and_b32 v37, 0xffff0000, v8
v_lshlrev_b32 v10, 16, v16
v_and_b32 v11, 0xffff0000, v16
v_pk_add_f32 v[36:37], v[36:37], v[10:11]
v_cvt_pk_bf16_f32 v16, v36, v37
v_lshlrev_b32 v36, 16, v16
v_and_b32 v37, 0xffff0000, v16
v_cvt_pk_bf16_f32 v8, v38, v39
v_lshlrev_b32 v38, 16, v8
v_and_b32 v39, 0xffff0000, v8
v_lshlrev_b32 v10, 16, v17
v_and_b32 v11, 0xffff0000, v17
v_pk_add_f32 v[38:39], v[38:39], v[10:11]
v_cvt_pk_bf16_f32 v17, v38, v39
v_lshlrev_b32 v38, 16, v17
v_and_b32 v39, 0xffff0000, v17
v_cvt_pk_bf16_f32 v8, v40, v41
v_lshlrev_b32 v40, 16, v8
v_and_b32 v41, 0xffff0000, v8
v_lshlrev_b32 v10, 16, v18
v_and_b32 v11, 0xffff0000, v18
v_pk_add_f32 v[40:41], v[40:41], v[10:11]
v_cvt_pk_bf16_f32 v18, v40, v41
v_lshlrev_b32 v40, 16, v18
v_and_b32 v41, 0xffff0000, v18
v_cvt_pk_bf16_f32 v8, v42, v43
v_lshlrev_b32 v42, 16, v8
v_and_b32 v43, 0xffff0000, v8
v_lshlrev_b32 v10, 16, v19
v_and_b32 v11, 0xffff0000, v19
v_pk_add_f32 v[42:43], v[42:43], v[10:11]
v_cvt_pk_bf16_f32 v19, v42, v43
v_lshlrev_b32 v42, 16, v19
v_and_b32 v43, 0xffff0000, v19
buffer_store_dwordx4 v[16:19], v15, s[4:7], s21 offen offset:0 sc1
s_waitcnt vmcnt(25)
v_lshlrev_b32 v44, 16, v112
v_and_b32 v45, 0xffff0000, v112
v_lshlrev_b32 v46, 16, v113
v_and_b32 v47, 0xffff0000, v113
v_lshlrev_b32 v48, 16, v114
v_and_b32 v49, 0xffff0000, v114
v_lshlrev_b32 v50, 16, v115
v_and_b32 v51, 0xffff0000, v115
v_lshlrev_b32 v8, 16, v116
v_and_b32 v9, 0xffff0000, v116
v_pk_add_f32 v[44:45], v[44:45], v[8:9]
v_lshlrev_b32 v10, 16, v117
v_and_b32 v11, 0xffff0000, v117
v_pk_add_f32 v[46:47], v[46:47], v[10:11]
v_lshlrev_b32 v8, 16, v118
v_and_b32 v9, 0xffff0000, v118
v_pk_add_f32 v[48:49], v[48:49], v[8:9]
v_lshlrev_b32 v10, 16, v119
v_and_b32 v11, 0xffff0000, v119
v_pk_add_f32 v[50:51], v[50:51], v[10:11]
v_lshlrev_b32 v8, 16, v120
v_and_b32 v9, 0xffff0000, v120
v_pk_add_f32 v[44:45], v[44:45], v[8:9]
v_lshlrev_b32 v10, 16, v121
v_and_b32 v11, 0xffff0000, v121
v_pk_add_f32 v[46:47], v[46:47], v[10:11]
v_lshlrev_b32 v8, 16, v122
v_and_b32 v9, 0xffff0000, v122
v_pk_add_f32 v[48:49], v[48:49], v[8:9]
v_lshlrev_b32 v10, 16, v123
v_and_b32 v11, 0xffff0000, v123
v_pk_add_f32 v[50:51], v[50:51], v[10:11]
v_lshlrev_b32 v8, 16, v124
v_and_b32 v9, 0xffff0000, v124
v_pk_add_f32 v[44:45], v[44:45], v[8:9]
v_lshlrev_b32 v10, 16, v125
v_and_b32 v11, 0xffff0000, v125
v_pk_add_f32 v[46:47], v[46:47], v[10:11]
v_lshlrev_b32 v8, 16, v126
v_and_b32 v9, 0xffff0000, v126
v_pk_add_f32 v[48:49], v[48:49], v[8:9]
v_lshlrev_b32 v10, 16, v127
v_and_b32 v11, 0xffff0000, v127
v_pk_add_f32 v[50:51], v[50:51], v[10:11]
v_lshlrev_b32 v8, 16, v128
v_and_b32 v9, 0xffff0000, v128
v_pk_add_f32 v[44:45], v[44:45], v[8:9]
v_lshlrev_b32 v10, 16, v129
v_and_b32 v11, 0xffff0000, v129
v_pk_add_f32 v[46:47], v[46:47], v[10:11]
v_lshlrev_b32 v8, 16, v130
v_and_b32 v9, 0xffff0000, v130
v_pk_add_f32 v[48:49], v[48:49], v[8:9]
v_lshlrev_b32 v10, 16, v131
v_and_b32 v11, 0xffff0000, v131
v_pk_add_f32 v[50:51], v[50:51], v[10:11]
v_lshlrev_b32 v8, 16, v132
v_and_b32 v9, 0xffff0000, v132
v_pk_add_f32 v[44:45], v[44:45], v[8:9]
v_lshlrev_b32 v10, 16, v133
v_and_b32 v11, 0xffff0000, v133
v_pk_add_f32 v[46:47], v[46:47], v[10:11]
v_lshlrev_b32 v8, 16, v134
v_and_b32 v9, 0xffff0000, v134
v_pk_add_f32 v[48:49], v[48:49], v[8:9]
v_lshlrev_b32 v10, 16, v135
v_and_b32 v11, 0xffff0000, v135
v_pk_add_f32 v[50:51], v[50:51], v[10:11]
v_lshlrev_b32 v8, 16, v136
v_and_b32 v9, 0xffff0000, v136
v_pk_add_f32 v[44:45], v[44:45], v[8:9]
v_lshlrev_b32 v10, 16, v137
v_and_b32 v11, 0xffff0000, v137
v_pk_add_f32 v[46:47], v[46:47], v[10:11]
v_lshlrev_b32 v8, 16, v138
v_and_b32 v9, 0xffff0000, v138
v_pk_add_f32 v[48:49], v[48:49], v[8:9]
v_lshlrev_b32 v10, 16, v139
v_and_b32 v11, 0xffff0000, v139
v_pk_add_f32 v[50:51], v[50:51], v[10:11]
v_lshlrev_b32 v8, 16, v140
v_and_b32 v9, 0xffff0000, v140
v_pk_add_f32 v[44:45], v[44:45], v[8:9]
v_lshlrev_b32 v10, 16, v141
v_and_b32 v11, 0xffff0000, v141
v_pk_add_f32 v[46:47], v[46:47], v[10:11]
v_lshlrev_b32 v8, 16, v142
v_and_b32 v9, 0xffff0000, v142
v_pk_add_f32 v[48:49], v[48:49], v[8:9]
v_lshlrev_b32 v10, 16, v143
v_and_b32 v11, 0xffff0000, v143
v_pk_add_f32 v[50:51], v[50:51], v[10:11]
v_cvt_pk_bf16_f32 v8, v44, v45
v_lshlrev_b32 v44, 16, v8
v_and_b32 v45, 0xffff0000, v8
v_lshlrev_b32 v10, 16, v20
v_and_b32 v11, 0xffff0000, v20
v_pk_add_f32 v[44:45], v[44:45], v[10:11]
v_cvt_pk_bf16_f32 v20, v44, v45
v_lshlrev_b32 v44, 16, v20
v_and_b32 v45, 0xffff0000, v20
v_cvt_pk_bf16_f32 v8, v46, v47
v_lshlrev_b32 v46, 16, v8
v_and_b32 v47, 0xffff0000, v8
v_lshlrev_b32 v10, 16, v21
v_and_b32 v11, 0xffff0000, v21
v_pk_add_f32 v[46:47], v[46:47], v[10:11]
v_cvt_pk_bf16_f32 v21, v46, v47
v_lshlrev_b32 v46, 16, v21
v_and_b32 v47, 0xffff0000, v21
v_cvt_pk_bf16_f32 v8, v48, v49
v_lshlrev_b32 v48, 16, v8
v_and_b32 v49, 0xffff0000, v8
v_lshlrev_b32 v10, 16, v22
v_and_b32 v11, 0xffff0000, v22
v_pk_add_f32 v[48:49], v[48:49], v[10:11]
v_cvt_pk_bf16_f32 v22, v48, v49
v_lshlrev_b32 v48, 16, v22
v_and_b32 v49, 0xffff0000, v22
v_cvt_pk_bf16_f32 v8, v50, v51
v_lshlrev_b32 v50, 16, v8
v_and_b32 v51, 0xffff0000, v8
v_lshlrev_b32 v10, 16, v23
v_and_b32 v11, 0xffff0000, v23
v_pk_add_f32 v[50:51], v[50:51], v[10:11]
v_cvt_pk_bf16_f32 v23, v50, v51
v_lshlrev_b32 v50, 16, v23
v_and_b32 v51, 0xffff0000, v23
buffer_store_dwordx4 v[20:23], v15, s[4:7], s21 offen offset:128 sc1
s_waitcnt vmcnt(18)
v_lshlrev_b32 v52, 16, v144
v_and_b32 v53, 0xffff0000, v144
v_lshlrev_b32 v54, 16, v145
v_and_b32 v55, 0xffff0000, v145
v_lshlrev_b32 v56, 16, v146
v_and_b32 v57, 0xffff0000, v146
v_lshlrev_b32 v58, 16, v147
v_and_b32 v59, 0xffff0000, v147
v_lshlrev_b32 v8, 16, v148
v_and_b32 v9, 0xffff0000, v148
v_pk_add_f32 v[52:53], v[52:53], v[8:9]
v_lshlrev_b32 v10, 16, v149
v_and_b32 v11, 0xffff0000, v149
v_pk_add_f32 v[54:55], v[54:55], v[10:11]
v_lshlrev_b32 v8, 16, v150
v_and_b32 v9, 0xffff0000, v150
v_pk_add_f32 v[56:57], v[56:57], v[8:9]
v_lshlrev_b32 v10, 16, v151
v_and_b32 v11, 0xffff0000, v151
v_pk_add_f32 v[58:59], v[58:59], v[10:11]
v_lshlrev_b32 v8, 16, v152
v_and_b32 v9, 0xffff0000, v152
v_pk_add_f32 v[52:53], v[52:53], v[8:9]
v_lshlrev_b32 v10, 16, v153
v_and_b32 v11, 0xffff0000, v153
v_pk_add_f32 v[54:55], v[54:55], v[10:11]
v_lshlrev_b32 v8, 16, v154
v_and_b32 v9, 0xffff0000, v154
v_pk_add_f32 v[56:57], v[56:57], v[8:9]
v_lshlrev_b32 v10, 16, v155
v_and_b32 v11, 0xffff0000, v155
v_pk_add_f32 v[58:59], v[58:59], v[10:11]
v_lshlrev_b32 v8, 16, v156
v_and_b32 v9, 0xffff0000, v156
v_pk_add_f32 v[52:53], v[52:53], v[8:9]
v_lshlrev_b32 v10, 16, v157
v_and_b32 v11, 0xffff0000, v157
v_pk_add_f32 v[54:55], v[54:55], v[10:11]
v_lshlrev_b32 v8, 16, v158
v_and_b32 v9, 0xffff0000, v158
v_pk_add_f32 v[56:57], v[56:57], v[8:9]
v_lshlrev_b32 v10, 16, v159
v_and_b32 v11, 0xffff0000, v159
v_pk_add_f32 v[58:59], v[58:59], v[10:11]
v_lshlrev_b32 v8, 16, v160
v_and_b32 v9, 0xffff0000, v160
v_pk_add_f32 v[52:53], v[52:53], v[8:9]
v_lshlrev_b32 v10, 16, v161
v_and_b32 v11, 0xffff0000, v161
v_pk_add_f32 v[54:55], v[54:55], v[10:11]
v_lshlrev_b32 v8, 16, v162
v_and_b32 v9, 0xffff0000, v162
v_pk_add_f32 v[56:57], v[56:57], v[8:9]
v_lshlrev_b32 v10, 16, v163
v_and_b32 v11, 0xffff0000, v163
v_pk_add_f32 v[58:59], v[58:59], v[10:11]
v_lshlrev_b32 v8, 16, v164
v_and_b32 v9, 0xffff0000, v164
v_pk_add_f32 v[52:53], v[52:53], v[8:9]
v_lshlrev_b32 v10, 16, v165
v_and_b32 v11, 0xffff0000, v165
v_pk_add_f32 v[54:55], v[54:55], v[10:11]
v_lshlrev_b32 v8, 16, v166
v_and_b32 v9, 0xffff0000, v166
v_pk_add_f32 v[56:57], v[56:57], v[8:9]
v_lshlrev_b32 v10, 16, v167
v_and_b32 v11, 0xffff0000, v167
v_pk_add_f32 v[58:59], v[58:59], v[10:11]
v_lshlrev_b32 v8, 16, v168
v_and_b32 v9, 0xffff0000, v168
v_pk_add_f32 v[52:53], v[52:53], v[8:9]
v_lshlrev_b32 v10, 16, v169
v_and_b32 v11, 0xffff0000, v169
v_pk_add_f32 v[54:55], v[54:55], v[10:11]
v_lshlrev_b32 v8, 16, v170
v_and_b32 v9, 0xffff0000, v170
v_pk_add_f32 v[56:57], v[56:57], v[8:9]
v_lshlrev_b32 v10, 16, v171
v_and_b32 v11, 0xffff0000, v171
v_pk_add_f32 v[58:59], v[58:59], v[10:11]
v_lshlrev_b32 v8, 16, v172
v_and_b32 v9, 0xffff0000, v172
v_pk_add_f32 v[52:53], v[52:53], v[8:9]
v_lshlrev_b32 v10, 16, v173
v_and_b32 v11, 0xffff0000, v173
v_pk_add_f32 v[54:55], v[54:55], v[10:11]
v_lshlrev_b32 v8, 16, v174
v_and_b32 v9, 0xffff0000, v174
v_pk_add_f32 v[56:57], v[56:57], v[8:9]
v_lshlrev_b32 v10, 16, v175
v_and_b32 v11, 0xffff0000, v175
v_pk_add_f32 v[58:59], v[58:59], v[10:11]
v_cvt_pk_bf16_f32 v8, v52, v53
v_lshlrev_b32 v52, 16, v8
v_and_b32 v53, 0xffff0000, v8
v_lshlrev_b32 v10, 16, v24
v_and_b32 v11, 0xffff0000, v24
v_pk_add_f32 v[52:53], v[52:53], v[10:11]
v_cvt_pk_bf16_f32 v24, v52, v53
v_lshlrev_b32 v52, 16, v24
v_and_b32 v53, 0xffff0000, v24
v_cvt_pk_bf16_f32 v8, v54, v55
v_lshlrev_b32 v54, 16, v8
v_and_b32 v55, 0xffff0000, v8
v_lshlrev_b32 v10, 16, v25
v_and_b32 v11, 0xffff0000, v25
v_pk_add_f32 v[54:55], v[54:55], v[10:11]
v_cvt_pk_bf16_f32 v25, v54, v55
v_lshlrev_b32 v54, 16, v25
v_and_b32 v55, 0xffff0000, v25
v_cvt_pk_bf16_f32 v8, v56, v57
v_lshlrev_b32 v56, 16, v8
v_and_b32 v57, 0xffff0000, v8
v_lshlrev_b32 v10, 16, v26
v_and_b32 v11, 0xffff0000, v26
v_pk_add_f32 v[56:57], v[56:57], v[10:11]
v_cvt_pk_bf16_f32 v26, v56, v57
v_lshlrev_b32 v56, 16, v26
v_and_b32 v57, 0xffff0000, v26
v_cvt_pk_bf16_f32 v8, v58, v59
v_lshlrev_b32 v58, 16, v8
v_and_b32 v59, 0xffff0000, v8
v_lshlrev_b32 v10, 16, v27
v_and_b32 v11, 0xffff0000, v27
v_pk_add_f32 v[58:59], v[58:59], v[10:11]
v_cvt_pk_bf16_f32 v27, v58, v59
v_lshlrev_b32 v58, 16, v27
v_and_b32 v59, 0xffff0000, v27
buffer_store_dwordx4 v[24:27], v15, s[4:7], s21 offen offset:256 sc1
s_waitcnt vmcnt(11)
v_lshlrev_b32 v60, 16, v176
v_and_b32 v61, 0xffff0000, v176
v_lshlrev_b32 v62, 16, v177
v_and_b32 v63, 0xffff0000, v177
v_lshlrev_b32 v64, 16, v178
v_and_b32 v65, 0xffff0000, v178
v_lshlrev_b32 v66, 16, v179
v_and_b32 v67, 0xffff0000, v179
v_lshlrev_b32 v8, 16, v180
v_and_b32 v9, 0xffff0000, v180
v_pk_add_f32 v[60:61], v[60:61], v[8:9]
v_lshlrev_b32 v10, 16, v181
v_and_b32 v11, 0xffff0000, v181
v_pk_add_f32 v[62:63], v[62:63], v[10:11]
v_lshlrev_b32 v8, 16, v182
v_and_b32 v9, 0xffff0000, v182
v_pk_add_f32 v[64:65], v[64:65], v[8:9]
v_lshlrev_b32 v10, 16, v183
v_and_b32 v11, 0xffff0000, v183
v_pk_add_f32 v[66:67], v[66:67], v[10:11]
v_lshlrev_b32 v8, 16, v184
v_and_b32 v9, 0xffff0000, v184
v_pk_add_f32 v[60:61], v[60:61], v[8:9]
v_lshlrev_b32 v10, 16, v185
v_and_b32 v11, 0xffff0000, v185
v_pk_add_f32 v[62:63], v[62:63], v[10:11]
v_lshlrev_b32 v8, 16, v186
v_and_b32 v9, 0xffff0000, v186
v_pk_add_f32 v[64:65], v[64:65], v[8:9]
v_lshlrev_b32 v10, 16, v187
v_and_b32 v11, 0xffff0000, v187
v_pk_add_f32 v[66:67], v[66:67], v[10:11]
v_lshlrev_b32 v8, 16, v188
v_and_b32 v9, 0xffff0000, v188
v_pk_add_f32 v[60:61], v[60:61], v[8:9]
v_lshlrev_b32 v10, 16, v189
v_and_b32 v11, 0xffff0000, v189
v_pk_add_f32 v[62:63], v[62:63], v[10:11]
v_lshlrev_b32 v8, 16, v190
v_and_b32 v9, 0xffff0000, v190
v_pk_add_f32 v[64:65], v[64:65], v[8:9]
v_lshlrev_b32 v10, 16, v191
v_and_b32 v11, 0xffff0000, v191
v_pk_add_f32 v[66:67], v[66:67], v[10:11]
v_lshlrev_b32 v8, 16, v192
v_and_b32 v9, 0xffff0000, v192
v_pk_add_f32 v[60:61], v[60:61], v[8:9]
v_lshlrev_b32 v10, 16, v193
v_and_b32 v11, 0xffff0000, v193
v_pk_add_f32 v[62:63], v[62:63], v[10:11]
v_lshlrev_b32 v8, 16, v194
v_and_b32 v9, 0xffff0000, v194
v_pk_add_f32 v[64:65], v[64:65], v[8:9]
v_lshlrev_b32 v10, 16, v195
v_and_b32 v11, 0xffff0000, v195
v_pk_add_f32 v[66:67], v[66:67], v[10:11]
v_lshlrev_b32 v8, 16, v196
v_and_b32 v9, 0xffff0000, v196
v_pk_add_f32 v[60:61], v[60:61], v[8:9]
v_lshlrev_b32 v10, 16, v197
v_and_b32 v11, 0xffff0000, v197
v_pk_add_f32 v[62:63], v[62:63], v[10:11]
v_lshlrev_b32 v8, 16, v198
v_and_b32 v9, 0xffff0000, v198
v_pk_add_f32 v[64:65], v[64:65], v[8:9]
v_lshlrev_b32 v10, 16, v199
v_and_b32 v11, 0xffff0000, v199
v_pk_add_f32 v[66:67], v[66:67], v[10:11]
v_lshlrev_b32 v8, 16, v200
v_and_b32 v9, 0xffff0000, v200
v_pk_add_f32 v[60:61], v[60:61], v[8:9]
v_lshlrev_b32 v10, 16, v201
v_and_b32 v11, 0xffff0000, v201
v_pk_add_f32 v[62:63], v[62:63], v[10:11]
v_lshlrev_b32 v8, 16, v202
v_and_b32 v9, 0xffff0000, v202
v_pk_add_f32 v[64:65], v[64:65], v[8:9]
v_lshlrev_b32 v10, 16, v203
v_and_b32 v11, 0xffff0000, v203
v_pk_add_f32 v[66:67], v[66:67], v[10:11]
v_lshlrev_b32 v8, 16, v204
v_and_b32 v9, 0xffff0000, v204
v_pk_add_f32 v[60:61], v[60:61], v[8:9]
v_lshlrev_b32 v10, 16, v205
v_and_b32 v11, 0xffff0000, v205
v_pk_add_f32 v[62:63], v[62:63], v[10:11]
v_lshlrev_b32 v8, 16, v206
v_and_b32 v9, 0xffff0000, v206
v_pk_add_f32 v[64:65], v[64:65], v[8:9]
v_lshlrev_b32 v10, 16, v207
v_and_b32 v11, 0xffff0000, v207
v_pk_add_f32 v[66:67], v[66:67], v[10:11]
v_cvt_pk_bf16_f32 v8, v60, v61
v_lshlrev_b32 v60, 16, v8
v_and_b32 v61, 0xffff0000, v8
v_lshlrev_b32 v10, 16, v28
v_and_b32 v11, 0xffff0000, v28
v_pk_add_f32 v[60:61], v[60:61], v[10:11]
v_cvt_pk_bf16_f32 v28, v60, v61
v_lshlrev_b32 v60, 16, v28
v_and_b32 v61, 0xffff0000, v28
v_cvt_pk_bf16_f32 v8, v62, v63
v_lshlrev_b32 v62, 16, v8
v_and_b32 v63, 0xffff0000, v8
v_lshlrev_b32 v10, 16, v29
v_and_b32 v11, 0xffff0000, v29
v_pk_add_f32 v[62:63], v[62:63], v[10:11]
v_cvt_pk_bf16_f32 v29, v62, v63
v_lshlrev_b32 v62, 16, v29
v_and_b32 v63, 0xffff0000, v29
v_cvt_pk_bf16_f32 v8, v64, v65
v_lshlrev_b32 v64, 16, v8
v_and_b32 v65, 0xffff0000, v8
v_lshlrev_b32 v10, 16, v30
v_and_b32 v11, 0xffff0000, v30
v_pk_add_f32 v[64:65], v[64:65], v[10:11]
v_cvt_pk_bf16_f32 v30, v64, v65
v_lshlrev_b32 v64, 16, v30
v_and_b32 v65, 0xffff0000, v30
v_cvt_pk_bf16_f32 v8, v66, v67
v_lshlrev_b32 v66, 16, v8
v_and_b32 v67, 0xffff0000, v8
v_lshlrev_b32 v10, 16, v31
v_and_b32 v11, 0xffff0000, v31
v_pk_add_f32 v[66:67], v[66:67], v[10:11]
v_cvt_pk_bf16_f32 v31, v66, v67
v_lshlrev_b32 v66, 16, v31
v_and_b32 v67, 0xffff0000, v31
buffer_store_dwordx4 v[28:31], v15, s[4:7], s21 offen offset:384 sc1
s_waitcnt vmcnt(4)
v_lshlrev_b32 v68, 16, v208
v_and_b32 v69, 0xffff0000, v208
v_lshlrev_b32 v70, 16, v209
v_and_b32 v71, 0xffff0000, v209
v_lshlrev_b32 v72, 16, v210
v_and_b32 v73, 0xffff0000, v210
v_lshlrev_b32 v74, 16, v211
v_and_b32 v75, 0xffff0000, v211
v_lshlrev_b32 v8, 16, v212
v_and_b32 v9, 0xffff0000, v212
v_pk_add_f32 v[68:69], v[68:69], v[8:9]
v_lshlrev_b32 v10, 16, v213
v_and_b32 v11, 0xffff0000, v213
v_pk_add_f32 v[70:71], v[70:71], v[10:11]
v_lshlrev_b32 v8, 16, v214
v_and_b32 v9, 0xffff0000, v214
v_pk_add_f32 v[72:73], v[72:73], v[8:9]
v_lshlrev_b32 v10, 16, v215
v_and_b32 v11, 0xffff0000, v215
v_pk_add_f32 v[74:75], v[74:75], v[10:11]
v_lshlrev_b32 v8, 16, v216
v_and_b32 v9, 0xffff0000, v216
v_pk_add_f32 v[68:69], v[68:69], v[8:9]
v_lshlrev_b32 v10, 16, v217
v_and_b32 v11, 0xffff0000, v217
v_pk_add_f32 v[70:71], v[70:71], v[10:11]
v_lshlrev_b32 v8, 16, v218
v_and_b32 v9, 0xffff0000, v218
v_pk_add_f32 v[72:73], v[72:73], v[8:9]
v_lshlrev_b32 v10, 16, v219
v_and_b32 v11, 0xffff0000, v219
v_pk_add_f32 v[74:75], v[74:75], v[10:11]
v_lshlrev_b32 v8, 16, v220
v_and_b32 v9, 0xffff0000, v220
v_pk_add_f32 v[68:69], v[68:69], v[8:9]
v_lshlrev_b32 v10, 16, v221
v_and_b32 v11, 0xffff0000, v221
v_pk_add_f32 v[70:71], v[70:71], v[10:11]
v_lshlrev_b32 v8, 16, v222
v_and_b32 v9, 0xffff0000, v222
v_pk_add_f32 v[72:73], v[72:73], v[8:9]
v_lshlrev_b32 v10, 16, v223
v_and_b32 v11, 0xffff0000, v223
v_pk_add_f32 v[74:75], v[74:75], v[10:11]
v_lshlrev_b32 v8, 16, v224
v_and_b32 v9, 0xffff0000, v224
v_pk_add_f32 v[68:69], v[68:69], v[8:9]
v_lshlrev_b32 v10, 16, v225
v_and_b32 v11, 0xffff0000, v225
v_pk_add_f32 v[70:71], v[70:71], v[10:11]
v_lshlrev_b32 v8, 16, v226
v_and_b32 v9, 0xffff0000, v226
v_pk_add_f32 v[72:73], v[72:73], v[8:9]
v_lshlrev_b32 v10, 16, v227
v_and_b32 v11, 0xffff0000, v227
v_pk_add_f32 v[74:75], v[74:75], v[10:11]
v_lshlrev_b32 v8, 16, v228
v_and_b32 v9, 0xffff0000, v228
v_pk_add_f32 v[68:69], v[68:69], v[8:9]
v_lshlrev_b32 v10, 16, v229
v_and_b32 v11, 0xffff0000, v229
v_pk_add_f32 v[70:71], v[70:71], v[10:11]
v_lshlrev_b32 v8, 16, v230
v_and_b32 v9, 0xffff0000, v230
v_pk_add_f32 v[72:73], v[72:73], v[8:9]
v_lshlrev_b32 v10, 16, v231
v_and_b32 v11, 0xffff0000, v231
v_pk_add_f32 v[74:75], v[74:75], v[10:11]
v_lshlrev_b32 v8, 16, v232
v_and_b32 v9, 0xffff0000, v232
v_pk_add_f32 v[68:69], v[68:69], v[8:9]
v_lshlrev_b32 v10, 16, v233
v_and_b32 v11, 0xffff0000, v233
v_pk_add_f32 v[70:71], v[70:71], v[10:11]
v_lshlrev_b32 v8, 16, v234
v_and_b32 v9, 0xffff0000, v234
v_pk_add_f32 v[72:73], v[72:73], v[8:9]
v_lshlrev_b32 v10, 16, v235
v_and_b32 v11, 0xffff0000, v235
v_pk_add_f32 v[74:75], v[74:75], v[10:11]
v_lshlrev_b32 v8, 16, v236
v_and_b32 v9, 0xffff0000, v236
v_pk_add_f32 v[68:69], v[68:69], v[8:9]
v_lshlrev_b32 v10, 16, v237
v_and_b32 v11, 0xffff0000, v237
v_pk_add_f32 v[70:71], v[70:71], v[10:11]
v_lshlrev_b32 v8, 16, v238
v_and_b32 v9, 0xffff0000, v238
v_pk_add_f32 v[72:73], v[72:73], v[8:9]
v_lshlrev_b32 v10, 16, v239
v_and_b32 v11, 0xffff0000, v239
v_pk_add_f32 v[74:75], v[74:75], v[10:11]
v_cvt_pk_bf16_f32 v8, v68, v69
v_lshlrev_b32 v68, 16, v8
v_and_b32 v69, 0xffff0000, v8
v_lshlrev_b32 v10, 16, v32
v_and_b32 v11, 0xffff0000, v32
v_pk_add_f32 v[68:69], v[68:69], v[10:11]
v_cvt_pk_bf16_f32 v32, v68, v69
v_lshlrev_b32 v68, 16, v32
v_and_b32 v69, 0xffff0000, v32
v_cvt_pk_bf16_f32 v8, v70, v71
v_lshlrev_b32 v70, 16, v8
v_and_b32 v71, 0xffff0000, v8
v_lshlrev_b32 v10, 16, v33
v_and_b32 v11, 0xffff0000, v33
v_pk_add_f32 v[70:71], v[70:71], v[10:11]
v_cvt_pk_bf16_f32 v33, v70, v71
v_lshlrev_b32 v70, 16, v33
v_and_b32 v71, 0xffff0000, v33
v_cvt_pk_bf16_f32 v8, v72, v73
v_lshlrev_b32 v72, 16, v8
v_and_b32 v73, 0xffff0000, v8
v_lshlrev_b32 v10, 16, v34
v_and_b32 v11, 0xffff0000, v34
v_pk_add_f32 v[72:73], v[72:73], v[10:11]
v_cvt_pk_bf16_f32 v34, v72, v73
v_lshlrev_b32 v72, 16, v34
v_and_b32 v73, 0xffff0000, v34
v_cvt_pk_bf16_f32 v8, v74, v75
v_lshlrev_b32 v74, 16, v8
v_and_b32 v75, 0xffff0000, v8
v_lshlrev_b32 v10, 16, v35
v_and_b32 v11, 0xffff0000, v35
v_pk_add_f32 v[74:75], v[74:75], v[10:11]
v_cvt_pk_bf16_f32 v35, v74, v75
v_lshlrev_b32 v74, 16, v35
v_and_b32 v75, 0xffff0000, v35
buffer_store_dwordx4 v[32:35], v15, s[4:7], s21 offen offset:512 sc1
v_and_b32 v3, 63, v0
v_and_b32 v2, 7, v3
v_lshlrev_b32 v5, 2, v2
s_lshl_b32 s17, s16, 5
v_add_u32 v1, s17, v5
v_pk_add_f32 v[6:7], v[36:37], v[38:39]
v_pk_add_f32 v[6:7], v[6:7], v[40:41]
v_pk_add_f32 v[6:7], v[6:7], v[42:43]
v_pk_add_f32 v[6:7], v[6:7], v[44:45]
v_pk_add_f32 v[6:7], v[6:7], v[46:47]
v_pk_add_f32 v[6:7], v[6:7], v[48:49]
v_pk_add_f32 v[6:7], v[6:7], v[50:51]
v_pk_add_f32 v[6:7], v[6:7], v[52:53]
v_pk_add_f32 v[6:7], v[6:7], v[54:55]
v_pk_add_f32 v[6:7], v[6:7], v[56:57]
v_pk_add_f32 v[6:7], v[6:7], v[58:59]
v_pk_add_f32 v[6:7], v[6:7], v[60:61]
v_pk_add_f32 v[6:7], v[6:7], v[62:63]
v_pk_add_f32 v[6:7], v[6:7], v[64:65]
v_pk_add_f32 v[6:7], v[6:7], v[66:67]
v_pk_add_f32 v[6:7], v[6:7], v[68:69]
v_pk_add_f32 v[6:7], v[6:7], v[70:71]
v_pk_add_f32 v[6:7], v[6:7], v[72:73]
v_pk_add_f32 v[6:7], v[6:7], v[74:75]
v_add_f32 v4, v6, v7
s_nop 1
v_add_f32_dpp v4, v4, v4 row_ror:8 row_mask:0xf bank_mask:0xf
v_mov_b32 v2, v4
s_nop 1
v_permlane16_swap_b32 v4, v2
v_add_f32 v4, v4, v2
v_mov_b32 v2, v4
s_nop 1
v_permlane32_swap_b32 v4, v2
v_add_f32 v4, v4, v2
ds_write_b32 v1, v4 offset:0
s_waitcnt lgkmcnt(0)
s_barrier
ds_read_b32 v4, v5 offset:0
ds_read_b32 v2, v5 offset:32
s_waitcnt lgkmcnt(0)
v_add_f32 v4, v4, v2
v_mul_f32 v6, 0xbacccccd, v4
v_mov_b32 v7, v6
v_pk_add_f32 v[36:37], v[36:37], v[6:7]
v_pk_add_f32 v[38:39], v[38:39], v[6:7]
v_pk_add_f32 v[40:41], v[40:41], v[6:7]
v_pk_add_f32 v[42:43], v[42:43], v[6:7]
v_pk_add_f32 v[44:45], v[44:45], v[6:7]
v_pk_add_f32 v[46:47], v[46:47], v[6:7]
v_pk_add_f32 v[48:49], v[48:49], v[6:7]
v_pk_add_f32 v[50:51], v[50:51], v[6:7]
v_pk_add_f32 v[52:53], v[52:53], v[6:7]
v_pk_add_f32 v[54:55], v[54:55], v[6:7]
v_pk_add_f32 v[56:57], v[56:57], v[6:7]
v_pk_add_f32 v[58:59], v[58:59], v[6:7]
v_pk_add_f32 v[60:61], v[60:61], v[6:7]
v_pk_add_f32 v[62:63], v[62:63], v[6:7]
v_pk_add_f32 v[64:65], v[64:65], v[6:7]
v_pk_add_f32 v[66:67], v[66:67], v[6:7]
v_pk_add_f32 v[68:69], v[68:69], v[6:7]
v_pk_add_f32 v[70:71], v[70:71], v[6:7]
v_pk_add_f32 v[72:73], v[72:73], v[6:7]
v_pk_add_f32 v[74:75], v[74:75], v[6:7]
v_pk_mul_f32 v[6:7], v[36:37], v[36:37]
v_pk_fma_f32 v[6:7], v[38:39], v[38:39], v[6:7]
v_pk_fma_f32 v[6:7], v[40:41], v[40:41], v[6:7]
v_pk_fma_f32 v[6:7], v[42:43], v[42:43], v[6:7]
v_pk_fma_f32 v[6:7], v[44:45], v[44:45], v[6:7]
v_pk_fma_f32 v[6:7], v[46:47], v[46:47], v[6:7]
v_pk_fma_f32 v[6:7], v[48:49], v[48:49], v[6:7]
v_pk_fma_f32 v[6:7], v[50:51], v[50:51], v[6:7]
v_pk_fma_f32 v[6:7], v[52:53], v[52:53], v[6:7]
v_pk_fma_f32 v[6:7], v[54:55], v[54:55], v[6:7]
v_pk_fma_f32 v[6:7], v[56:57], v[56:57], v[6:7]
v_pk_fma_f32 v[6:7], v[58:59], v[58:59], v[6:7]
v_pk_fma_f32 v[6:7], v[60:61], v[60:61], v[6:7]
v_pk_fma_f32 v[6:7], v[62:63], v[62:63], v[6:7]
v_pk_fma_f32 v[6:7], v[64:65], v[64:65], v[6:7]
v_pk_fma_f32 v[6:7], v[66:67], v[66:67], v[6:7]
v_pk_fma_f32 v[6:7], v[68:69], v[68:69], v[6:7]
v_pk_fma_f32 v[6:7], v[70:71], v[70:71], v[6:7]
v_pk_fma_f32 v[6:7], v[72:73], v[72:73], v[6:7]
v_pk_fma_f32 v[6:7], v[74:75], v[74:75], v[6:7]
v_add_f32 v4, v6, v7
s_nop 1
v_add_f32_dpp v4, v4, v4 row_ror:8 row_mask:0xf bank_mask:0xf
v_mov_b32 v2, v4
s_nop 1
v_permlane16_swap_b32 v4, v2
v_add_f32 v4, v4, v2
v_mov_b32 v2, v4
s_nop 1
v_permlane32_swap_b32 v4, v2
v_add_f32 v4, v4, v2
ds_write_b32 v1, v4 offset:64
s_waitcnt lgkmcnt(0)
s_barrier
ds_read_b32 v4, v5 offset:64
ds_read_b32 v2, v5 offset:96
s_waitcnt lgkmcnt(0)
v_add_f32 v4, v4, v2
v_mov_b32 v2, 0x3727c5ac
v_fmac_f32 v2, 0x3acccccd, v4
v_rsq_f32 v6, v2
s_nop 0
v_mov_b32 v7, v6
v_pk_mul_f32 v[36:37], v[36:37], v[6:7]
v_pk_mul_f32 v[38:39], v[38:39], v[6:7]
v_pk_mul_f32 v[40:41], v[40:41], v[6:7]
v_pk_mul_f32 v[42:43], v[42:43], v[6:7]
v_pk_mul_f32 v[44:45], v[44:45], v[6:7]
v_pk_mul_f32 v[46:47], v[46:47], v[6:7]
v_pk_mul_f32 v[48:49], v[48:49], v[6:7]
v_pk_mul_f32 v[50:51], v[50:51], v[6:7]
v_pk_mul_f32 v[52:53], v[52:53], v[6:7]
v_pk_mul_f32 v[54:55], v[54:55], v[6:7]
v_pk_mul_f32 v[56:57], v[56:57], v[6:7]
v_pk_mul_f32 v[58:59], v[58:59], v[6:7]
v_pk_mul_f32 v[60:61], v[60:61], v[6:7]
v_pk_mul_f32 v[62:63], v[62:63], v[6:7]
v_pk_mul_f32 v[64:65], v[64:65], v[6:7]
v_pk_mul_f32 v[66:67], v[66:67], v[6:7]
v_pk_mul_f32 v[68:69], v[68:69], v[6:7]
v_pk_mul_f32 v[70:71], v[70:71], v[6:7]
v_pk_mul_f32 v[72:73], v[72:73], v[6:7]
v_pk_mul_f32 v[74:75], v[74:75], v[6:7]
v_cvt_pk_bf16_f32 v16, v36, v37
v_cvt_pk_bf16_f32 v17, v38, v39
v_cvt_pk_bf16_f32 v18, v40, v41
v_cvt_pk_bf16_f32 v19, v42, v43
v_cvt_pk_bf16_f32 v20, v44, v45
v_cvt_pk_bf16_f32 v21, v46, v47
v_cvt_pk_bf16_f32 v22, v48, v49
v_cvt_pk_bf16_f32 v23, v50, v51
v_cvt_pk_bf16_f32 v24, v52, v53
v_cvt_pk_bf16_f32 v25, v54, v55
v_cvt_pk_bf16_f32 v26, v56, v57
v_cvt_pk_bf16_f32 v27, v58, v59
v_cvt_pk_bf16_f32 v28, v60, v61
v_cvt_pk_bf16_f32 v29, v62, v63
v_cvt_pk_bf16_f32 v30, v64, v65
v_cvt_pk_bf16_f32 v31, v66, v67
v_cvt_pk_bf16_f32 v32, v68, v69
v_cvt_pk_bf16_f32 v33, v70, v71
v_cvt_pk_bf16_f32 v34, v72, v73
v_cvt_pk_bf16_f32 v35, v74, v75
v_add_u32 v6, 0x1000, v14
v_add_u32 v7, 0x2000, v14
buffer_store_dwordx4 v[16:19], v14, s[4:7], s34 offen offset:0 sc1
buffer_store_dwordx4 v[20:23], v14, s[4:7], s34 offen offset:2048 sc1
buffer_store_dwordx4 v[24:27], v6, s[4:7], s34 offen offset:0 sc1
buffer_store_dwordx4 v[28:31], v6, s[4:7], s34 offen offset:2048 sc1
buffer_store_dwordx4 v[32:35], v7, s[4:7], s34 offen offset:0 sc1
redln2_exit1:
s_endpgm
.globl qkvb_kernel
.p2align 8
.type qkvb_kernel,@function
qkvb_kernel:
s_cmp_ge_u32 s2, 256
s_cbranch_scc1 qkvb_exit1
s_load_dwordx2 s[12:13], s[0:1], 96
v_lshrrev_b32 v2, 6, v0
v_and_b32 v3, 63, v0
s_and_b32 s17, s2, 7
v_readfirstlane_b32 s16, v2
v_lshlrev_b32 v1, 4, v3
s_lshr_b32 s18, s2, 3
s_waitcnt lgkmcnt(0)
s_mov_b32 s4, s12
s_mov_b32 s5, s13
s_mov_b32 s6, 0x10000000
s_mov_b32 s7, 0x20000
s_lshl_b32 s21, s18, 2
s_add_u32 s21, s21, s16
s_mul_i32 s21, s21, 20480
s_add_u32 s21, s21, 54525952
s_mul_i32 s22, s16, 20480
v_add_u32 v7, 40960, v1
v_mov_b32 v6, v1
s_add_u32 m0, s22, 0
s_add_u32 s23, s21, 0
buffer_load_dwordx4 v1, s[4:7], s23 offen offset:0 lds
buffer_load_dwordx4 v1, s[4:7], s23 offen offset:1024 lds
buffer_load_dwordx4 v1, s[4:7], s23 offen offset:2048 lds
buffer_load_dwordx4 v1, s[4:7], s23 offen offset:3072 lds
s_cmp_eq_u32 s16, 0
s_cbranch_scc1 qkvb_w0_2
s_cmp_eq_u32 s16, 1
s_cbranch_scc1 qkvb_w1_3
s_cmp_eq_u32 s16, 2
s_cbranch_scc1 qkvb_w2_4
s_branch qkvb_w3_5
qkvb_w0_2:
s_mul_i32 s30, s17, 5
s_add_u32 s30, s30, 0
s_mul_i32 s30, s30, 20480
s_add_u32 s30, s30, 87556096
s_mul_i32 s31, s17, 5
s_add_u32 s31, s31, 1
s_mul_i32 s31, s31, 20480
s_add_u32 s31, s31, 87556096
s_mul_i32 s32, s17, 5
s_add_u32 s32, s32, 2
s_mul_i32 s32, s32, 20480
s_add_u32 s32, s32, 87556096
s_mul_i32 s33, s17, 5
s_add_u32 s33, s33, 3
s_mul_i32 s33, s33, 20480
s_add_u32 s33, s33, 87556096
buffer_load_dwordx4 v[72:75], v1, s[4:7], s30 offen offset:0
buffer_load_dwordx4 v[76:79], v1, s[4:7], s31 offen offset:0
buffer_load_dwordx4 v[80:83], v1, s[4:7], s32 offen offset:0
buffer_load_dwordx4 v[84:87], v1, s[4:7], s33 offen offset:0
buffer_load_dwordx4 v[88:91], v1, s[4:7], s30 offen offset:1024
buffer_load_dwordx4 v[92:95], v1, s[4:7], s31 offen offset:1024
buffer_load_dwordx4 v[96:99], v1, s[4:7], s32 offen offset:1024
buffer_load_dwordx4 v[100:103], v1, s[4:7], s33 offen offset:1024
buffer_load_dwordx4 v[104:107], v1, s[4:7], s30 offen offset:2048
buffer_load_dwordx4 v[108:111], v1, s[4:7], s31 offen offset:2048
buffer_load_dwordx4 v[112:115], v1, s[4:7], s32 offen offset:2048
buffer_load_dwordx4 v[116:119], v1, s[4:7], s33 offen offset:2048
s_add_u32 m0, s22, 4096
s_add_u32 s23, s21, 4096
buffer_load_dwordx4 v1, s[4:7], s23 offen offset:0 lds
buffer_load_dwordx4 v1, s[4:7], s23 offen offset:1024 lds
buffer_load_dwordx4 v1, s[4:7], s23 offen offset:2048 lds
buffer_load_dwordx4 v1, s[4:7], s23 offen offset:3072 lds
s_add_u32 m0, s22, 8192
s_add_u32 s23, s21, 8192
buffer_load_dwordx4 v1, s[4:7], s23 offen offset:0 lds
buffer_load_dwordx4 v1, s[4:7], s23 offen offset:1024 lds
buffer_load_dwordx4 v1, s[4:7], s23 offen offset:2048 lds
buffer_load_dwordx4 v1, s[4:7], s23 offen offset:3072 lds
s_add_u32 m0, s22, 12288
s_add_u32 s23, s21, 12288
buffer_load_dwordx4 v1, s[4:7], s23 offen offset:0 lds
buffer_load_dwordx4 v1, s[4:7], s23 offen offset:1024 lds
buffer_load_dwordx4 v1, s[4:7], s23 offen offset:2048 lds
buffer_load_dwordx4 v1, s[4:7], s23 offen offset:3072 lds
s_add_u32 m0, s22, 16384
s_add_u32 s23, s21, 16384
buffer_load_dwordx4 v1, s[4:7], s23 offen offset:0 lds
buffer_load_dwordx4 v1, s[4:7], s23 offen offset:1024 lds
buffer_load_dwordx4 v1, s[4:7], s23 offen offset:2048 lds
buffer_load_dwordx4 v1, s[4:7], s23 offen offset:3072 lds
s_waitcnt vmcnt(28)
s_barrier
buffer_load_dwordx4 v[120:123], v1, s[4:7], s30 offen offset:3072
buffer_load_dwordx4 v[124:127], v1, s[4:7], s31 offen offset:3072
buffer_load_dwordx4 v[128:131], v1, s[4:7], s32 offen offset:3072
buffer_load_dwordx4 v[132:135], v1, s[4:7], s33 offen offset:3072
ds_read_b128 v[136:139], v6 offset:0
ds_read_b128 v[140:143], v6 offset:20480
ds_read_b128 v[144:147], v7 offset:0
ds_read_b128 v[148:151], v7 offset:20480
s_waitcnt vmcnt(28) lgkmcnt(0)
v_mfma_f32_16x16x32_bf16 v[8:11], v[72:75], v[136:139], 0
ds_read_b128 v[152:155], v6 offset:1024
v_mfma_f32_16x16x32_bf16 v[12:15], v[72:75], v[140:143], 0
ds_read_b128 v[156:159], v6 offset:21504
v_mfma_f32_16x16x32_bf16 v[16:19], v[72:75], v[144:147], 0
ds_read_b128 v[160:163], v7 offset:1024
v_mfma_f32_16x16x32_bf16 v[20:23], v[72:75], v[148:151], 0
ds_read_b128 v[164:167], v7 offset:21504
s_add_u32 s30, s30, 4096
buffer_load_dwordx4 v[72:75], v1, s[4:7], s30 offen offset:0
v_mfma_f32_16x16x32_bf16 v[24:27], v[76:79], v[136:139], 0
v_mfma_f32_16x16x32_bf16 v[28:31], v[76:79], v[140:143], 0
v_mfma_f32_16x16x32_bf16 v[32:35], v[76:79], v[144:147], 0
v_mfma_f32_16x16x32_bf16 v[36:39], v[76:79], v[148:151], 0
s_add_u32 s31, s31, 4096
buffer_load_dwordx4 v[76:79], v1, s[4:7], s31 offen offset:0
v_mfma_f32_16x16x32_bf16 v[40:43], v[80:83], v[136:139], 0
v_mfma_f32_16x16x32_bf16 v[44:47], v[80:83], v[140:143], 0
v_mfma_f32_16x16x32_bf16 v[48:51], v[80:83], v[144:147], 0
v_mfma_f32_16x16x32_bf16 v[52:55], v[80:83], v[148:151], 0
s_add_u32 s32, s32, 4096
buffer_load_dwordx4 v[80:83], v1, s[4:7], s32 offen offset:0
v_mfma_f32_16x16x32_bf16 v[56:59], v[84:87], v[136:139], 0
v_mfma_f32_16x16x32_bf16 v[60:63], v[84:87], v[140:143], 0
v_mfma_f32_16x16x32_bf16 v[64:67], v[84:87], v[144:147], 0
v_mfma_f32_16x16x32_bf16 v[68:71], v[84:87], v[148:151], 0
s_add_u32 s33, s33, 4096
buffer_load_dwordx4 v[84:87], v1, s[4:7], s33 offen offset:0
s_waitcnt vmcnt(28) lgkmcnt(0)
v_mfma_f32_16x16x32_bf16 v[8:11], v[88:91], v[152:155], v[8:11]
ds_read_b128 v[136:139], v6 offset:2048
v_mfma_f32_16x16x32_bf16 v[12:15], v[88:91], v[156:159], v[12:15]
ds_read_b128 v[140:143], v6 offset:22528
v_mfma_f32_16x16x32_bf16 v[16:19], v[88:91], v[160:163], v[16:19]
ds_read_b128 v[144:147], v7 offset:2048
v_mfma_f32_16x16x32_bf16 v[20:23], v[88:91], v[164:167], v[20:23]
ds_read_b128 v[148:151], v7 offset:22528
buffer_load_dwordx4 v[88:91], v1, s[4:7], s30 offen offset:1024
v_mfma_f32_16x16x32_bf16 v[24:27], v[92:95], v[152:155], v[24:27]
v_mfma_f32_16x16x32_bf16 v[28:31], v[92:95], v[156:159], v[28:31]
v_mfma_f32_16x16x32_bf16 v[32:35], v[92:95], v[160:163], v[32:35]
v_mfma_f32_16x16x32_bf16 v[36:39], v[92:95], v[164:167], v[36:39]
buffer_load_dwordx4 v[92:95], v1, s[4:7], s31 offen offset:1024
v_mfma_f32_16x16x32_bf16 v[40:43], v[96:99], v[152:155], v[40:43]
v_mfma_f32_16x16x32_bf16 v[44:47], v[96:99], v[156:159], v[44:47]
v_mfma_f32_16x16x32_bf16 v[48:51], v[96:99], v[160:163], v[48:51]
v_mfma_f32_16x16x32_bf16 v[52:55], v[96:99], v[164:167], v[52:55]
buffer_load_dwordx4 v[96:99], v1, s[4:7], s32 offen offset:1024
v_mfma_f32_16x16x32_bf16 v[56:59], v[100:103], v[152:155], v[56:59]
v_mfma_f32_16x16x32_bf16 v[60:63], v[100:103], v[156:159], v[60:63]
v_mfma_f32_16x16x32_bf16 v[64:67], v[100:103], v[160:163], v[64:67]
v_mfma_f32_16x16x32_bf16 v[68:71], v[100:103], v[164:167], v[68:71]
buffer_load_dwordx4 v[100:103], v1, s[4:7], s33 offen offset:1024
s_waitcnt vmcnt(28) lgkmcnt(0)
v_mfma_f32_16x16x32_bf16 v[8:11], v[104:107], v[136:139], v[8:11]
ds_read_b128 v[152:155], v6 offset:3072
v_mfma_f32_16x16x32_bf16 v[12:15], v[104:107], v[140:143], v[12:15]
ds_read_b128 v[156:159], v6 offset:23552
v_mfma_f32_16x16x32_bf16 v[16:19], v[104:107], v[144:147], v[16:19]
ds_read_b128 v[160:163], v7 offset:3072
v_mfma_f32_16x16x32_bf16 v[20:23], v[104:107], v[148:151], v[20:23]
ds_read_b128 v[164:167], v7 offset:23552
buffer_load_dwordx4 v[104:107], v1, s[4:7], s30 offen offset:2048
v_mfma_f32_16x16x32_bf16 v[24:27], v[108:111], v[136:139], v[24:27]
v_mfma_f32_16x16x32_bf16 v[28:31], v[108:111], v[140:143], v[28:31]
v_mfma_f32_16x16x32_bf16 v[32:35], v[108:111], v[144:147], v[32:35]
v_mfma_f32_16x16x32_bf16 v[36:39], v[108:111], v[148:151], v[36:39]
buffer_load_dwordx4 v[108:111], v1, s[4:7], s31 offen offset:2048
v_mfma_f32_16x16x32_bf16 v[40:43], v[112:115], v[136:139], v[40:43]
v_mfma_f32_16x16x32_bf16 v[44:47], v[112:115], v[140:143], v[44:47]
v_mfma_f32_16x16x32_bf16 v[48:51], v[112:115], v[144:147], v[48:51]
v_mfma_f32_16x16x32_bf16 v[52:55], v[112:115], v[148:151], v[52:55]
buffer_load_dwordx4 v[112:115], v1, s[4:7], s32 offen offset:2048
v_mfma_f32_16x16x32_bf16 v[56:59], v[116:119], v[136:139], v[56:59]
v_mfma_f32_16x16x32_bf16 v[60:63], v[116:119], v[140:143], v[60:63]
v_mfma_f32_16x16x32_bf16 v[64:67], v[116:119], v[144:147], v[64:67]
v_mfma_f32_16x16x32_bf16 v[68:71], v[116:119], v[148:151], v[68:71]
buffer_load_dwordx4 v[116:119], v1, s[4:7], s33 offen offset:2048
s_waitcnt vmcnt(12) lgkmcnt(0)
s_barrier
v_mfma_f32_16x16x32_bf16 v[8:11], v[120:123], v[152:155], v[8:11]
ds_read_b128 v[136:139], v6 offset:4096
v_mfma_f32_16x16x32_bf16 v[12:15], v[120:123], v[156:159], v[12:15]
ds_read_b128 v[140:143], v6 offset:24576
v_mfma_f32_16x16x32_bf16 v[16:19], v[120:123], v[160:163], v[16:19]
ds_read_b128 v[144:147], v7 offset:4096
v_mfma_f32_16x16x32_bf16 v[20:23], v[120:123], v[164:167], v[20:23]
ds_read_b128 v[148:151], v7 offset:24576
buffer_load_dwordx4 v[120:123], v1, s[4:7], s30 offen offset:3072
v_mfma_f32_16x16x32_bf16 v[24:27], v[124:127], v[152:155], v[24:27]
v_mfma_f32_16x16x32_bf16 v[28:31], v[124:127], v[156:159], v[28:31]
v_mfma_f32_16x16x32_bf16 v[32:35], v[124:127], v[160:163], v[32:35]
v_mfma_f32_16x16x32_bf16 v[36:39], v[124:127], v[164:167], v[36:39]
buffer_load_dwordx4 v[124:127], v1, s[4:7], s31 offen offset:3072
v_mfma_f32_16x16x32_bf16 v[40:43], v[128:131], v[152:155], v[40:43]
v_mfma_f32_16x16x32_bf16 v[44:47], v[128:131], v[156:159], v[44:47]
v_mfma_f32_16x16x32_bf16 v[48:51], v[128:131], v[160:163], v[48:51]
v_mfma_f32_16x16x32_bf16 v[52:55], v[128:131], v[164:167], v[52:55]
buffer_load_dwordx4 v[128:131], v1, s[4:7], s32 offen offset:3072
v_mfma_f32_16x16x32_bf16 v[56:59], v[132:135], v[152:155], v[56:59]
v_mfma_f32_16x16x32_bf16 v[60:63], v[132:135], v[156:159], v[60:63]
v_mfma_f32_16x16x32_bf16 v[64:67], v[132:135], v[160:163], v[64:67]
v_mfma_f32_16x16x32_bf16 v[68:71], v[132:135], v[164:167], v[68:71]
buffer_load_dwordx4 v[132:135], v1, s[4:7], s33 offen offset:3072
s_mov_b32 s40, 0
v_add_u32 v6, 4096, v6
v_add_u32 v7, 4096, v7
qkvb_loop6:
s_waitcnt vmcnt(12) lgkmcnt(0)
v_mfma_f32_16x16x32_bf16 v[8:11], v[72:75], v[136:139], v[8:11]
ds_read_b128 v[152:155], v6 offset:1024
v_mfma_f32_16x16x32_bf16 v[12:15], v[72:75], v[140:143], v[12:15]
ds_read_b128 v[156:159], v6 offset:21504
v_mfma_f32_16x16x32_bf16 v[16:19], v[72:75], v[144:147], v[16:19]
ds_read_b128 v[160:163], v7 offset:1024
v_mfma_f32_16x16x32_bf16 v[20:23], v[72:75], v[148:151], v[20:23]
ds_read_b128 v[164:167], v7 offset:21504
s_add_u32 s30, s30, 4096
buffer_load_dwordx4 v[72:75], v1, s[4:7], s30 offen offset:0
v_mfma_f32_16x16x32_bf16 v[24:27], v[76:79], v[136:139], v[24:27]
v_mfma_f32_16x16x32_bf16 v[28:31], v[76:79], v[140:143], v[28:31]
v_mfma_f32_16x16x32_bf16 v[32:35], v[76:79], v[144:147], v[32:35]
v_mfma_f32_16x16x32_bf16 v[36:39], v[76:79], v[148:151], v[36:39]
s_add_u32 s31, s31, 4096
buffer_load_dwordx4 v[76:79], v1, s[4:7], s31 offen offset:0
v_mfma_f32_16x16x32_bf16 v[40:43], v[80:83], v[136:139], v[40:43]
v_mfma_f32_16x16x32_bf16 v[44:47], v[80:83], v[140:143], v[44:47]
v_mfma_f32_16x16x32_bf16 v[48:51], v[80:83], v[144:147], v[48:51]
v_mfma_f32_16x16x32_bf16 v[52:55], v[80:83], v[148:151], v[52:55]
s_add_u32 s32, s32, 4096
buffer_load_dwordx4 v[80:83], v1, s[4:7], s32 offen offset:0
v_mfma_f32_16x16x32_bf16 v[56:59], v[84:87], v[136:139], v[56:59]
v_mfma_f32_16x16x32_bf16 v[60:63], v[84:87], v[140:143], v[60:63]
v_mfma_f32_16x16x32_bf16 v[64:67], v[84:87], v[144:147], v[64:67]
v_mfma_f32_16x16x32_bf16 v[68:71], v[84:87], v[148:151], v[68:71]
s_add_u32 s33, s33, 4096
buffer_load_dwordx4 v[84:87], v1, s[4:7], s33 offen offset:0
s_waitcnt vmcnt(12) lgkmcnt(0)
v_mfma_f32_16x16x32_bf16 v[8:11], v[88:91], v[152:155], v[8:11]
ds_read_b128 v[136:139], v6 offset:2048
v_mfma_f32_16x16x32_bf16 v[12:15], v[88:91], v[156:159], v[12:15]
ds_read_b128 v[140:143], v6 offset:22528
v_mfma_f32_16x16x32_bf16 v[16:19], v[88:91], v[160:163], v[16:19]
ds_read_b128 v[144:147], v7 offset:2048
v_mfma_f32_16x16x32_bf16 v[20:23], v[88:91], v[164:167], v[20:23]
ds_read_b128 v[148:151], v7 offset:22528
buffer_load_dwordx4 v[88:91], v1, s[4:7], s30 offen offset:1024
v_mfma_f32_16x16x32_bf16 v[24:27], v[92:95], v[152:155], v[24:27]
v_mfma_f32_16x16x32_bf16 v[28:31], v[92:95], v[156:159], v[28:31]
v_mfma_f32_16x16x32_bf16 v[32:35], v[92:95], v[160:163], v[32:35]
v_mfma_f32_16x16x32_bf16 v[36:39], v[92:95], v[164:167], v[36:39]
buffer_load_dwordx4 v[92:95], v1, s[4:7], s31 offen offset:1024
v_mfma_f32_16x16x32_bf16 v[40:43], v[96:99], v[152:155], v[40:43]
v_mfma_f32_16x16x32_bf16 v[44:47], v[96:99], v[156:159], v[44:47]
v_mfma_f32_16x16x32_bf16 v[48:51], v[96:99], v[160:163], v[48:51]
v_mfma_f32_16x16x32_bf16 v[52:55], v[96:99], v[164:167], v[52:55]
buffer_load_dwordx4 v[96:99], v1, s[4:7], s32 offen offset:1024
v_mfma_f32_16x16x32_bf16 v[56:59], v[100:103], v[152:155], v[56:59]
v_mfma_f32_16x16x32_bf16 v[60:63], v[100:103], v[156:159], v[60:63]
v_mfma_f32_16x16x32_bf16 v[64:67], v[100:103], v[160:163], v[64:67]
v_mfma_f32_16x16x32_bf16 v[68:71], v[100:103], v[164:167], v[68:71]
buffer_load_dwordx4 v[100:103], v1, s[4:7], s33 offen offset:1024
s_waitcnt vmcnt(12) lgkmcnt(0)
v_mfma_f32_16x16x32_bf16 v[8:11], v[104:107], v[136:139], v[8:11]
ds_read_b128 v[152:155], v6 offset:3072
v_mfma_f32_16x16x32_bf16 v[12:15], v[104:107], v[140:143], v[12:15]
ds_read_b128 v[156:159], v6 offset:23552
v_mfma_f32_16x16x32_bf16 v[16:19], v[104:107], v[144:147], v[16:19]
ds_read_b128 v[160:163], v7 offset:3072
v_mfma_f32_16x16x32_bf16 v[20:23], v[104:107], v[148:151], v[20:23]
ds_read_b128 v[164:167], v7 offset:23552
buffer_load_dwordx4 v[104:107], v1, s[4:7], s30 offen offset:2048
v_mfma_f32_16x16x32_bf16 v[24:27], v[108:111], v[136:139], v[24:27]
v_mfma_f32_16x16x32_bf16 v[28:31], v[108:111], v[140:143], v[28:31]
v_mfma_f32_16x16x32_bf16 v[32:35], v[108:111], v[144:147], v[32:35]
v_mfma_f32_16x16x32_bf16 v[36:39], v[108:111], v[148:151], v[36:39]
buffer_load_dwordx4 v[108:111], v1, s[4:7], s31 offen offset:2048
v_mfma_f32_16x16x32_bf16 v[40:43], v[112:115], v[136:139], v[40:43]
v_mfma_f32_16x16x32_bf16 v[44:47], v[112:115], v[140:143], v[44:47]
v_mfma_f32_16x16x32_bf16 v[48:51], v[112:115], v[144:147], v[48:51]
v_mfma_f32_16x16x32_bf16 v[52:55], v[112:115], v[148:151], v[52:55]
buffer_load_dwordx4 v[112:115], v1, s[4:7], s32 offen offset:2048
v_mfma_f32_16x16x32_bf16 v[56:59], v[116:119], v[136:139], v[56:59]
v_mfma_f32_16x16x32_bf16 v[60:63], v[116:119], v[140:143], v[60:63]
v_mfma_f32_16x16x32_bf16 v[64:67], v[116:119], v[144:147], v[64:67]
v_mfma_f32_16x16x32_bf16 v[68:71], v[116:119], v[148:151], v[68:71]
buffer_load_dwordx4 v[116:119], v1, s[4:7], s33 offen offset:2048
s_waitcnt vmcnt(12) lgkmcnt(0)
v_mfma_f32_16x16x32_bf16 v[8:11], v[120:123], v[152:155], v[8:11]
ds_read_b128 v[136:139], v6 offset:4096
v_mfma_f32_16x16x32_bf16 v[12:15], v[120:123], v[156:159], v[12:15]
ds_read_b128 v[140:143], v6 offset:24576
v_mfma_f32_16x16x32_bf16 v[16:19], v[120:123], v[160:163], v[16:19]
ds_read_b128 v[144:147], v7 offset:4096
v_mfma_f32_16x16x32_bf16 v[20:23], v[120:123], v[164:167], v[20:23]
ds_read_b128 v[148:151], v7 offset:24576
buffer_load_dwordx4 v[120:123], v1, s[4:7], s30 offen offset:3072
v_mfma_f32_16x16x32_bf16 v[24:27], v[124:127], v[152:155], v[24:27]
v_mfma_f32_16x16x32_bf16 v[28:31], v[124:127], v[156:159], v[28:31]
v_mfma_f32_16x16x32_bf16 v[32:35], v[124:127], v[160:163], v[32:35]
v_mfma_f32_16x16x32_bf16 v[36:39], v[124:127], v[164:167], v[36:39]
buffer_load_dwordx4 v[124:127], v1, s[4:7], s31 offen offset:3072
v_mfma_f32_16x16x32_bf16 v[40:43], v[128:131], v[152:155], v[40:43]
v_mfma_f32_16x16x32_bf16 v[44:47], v[128:131], v[156:159], v[44:47]
v_mfma_f32_16x16x32_bf16 v[48:51], v[128:131], v[160:163], v[48:51]
v_mfma_f32_16x16x32_bf16 v[52:55], v[128:131], v[164:167], v[52:55]
buffer_load_dwordx4 v[128:131], v1, s[4:7], s32 offen offset:3072
v_mfma_f32_16x16x32_bf16 v[56:59], v[132:135], v[152:155], v[56:59]
v_mfma_f32_16x16x32_bf16 v[60:63], v[132:135], v[156:159], v[60:63]
v_mfma_f32_16x16x32_bf16 v[64:67], v[132:135], v[160:163], v[64:67]
v_mfma_f32_16x16x32_bf16 v[68:71], v[132:135], v[164:167], v[68:71]
buffer_load_dwordx4 v[132:135], v1, s[4:7], s33 offen offset:3072
v_add_u32 v6, 4096, v6
v_add_u32 v7, 4096, v7
s_add_u32 s40, s40, 1
s_cmp_lt_u32 s40, 4
s_cbranch_scc1 qkvb_loop6
s_waitcnt vmcnt(0) lgkmcnt(0)
v_and_b32 v2, 63, v0
v_and_b32 v3, 15, v2
v_lshrrev_b32 v4, 4, v2
s_lshl_b32 s41, s17, 19
s_lshl_b32 s42, s18, 12
s_add_u32 s41, s41, s42
s_mov_b32 s46, 0x3ea52b5c
s_mov_b32 s47, 0x3ea52b5c
v_lshlrev_b32 v5, 2, v4
v_add_u32 v5, 0, v5
v_mul_u32_u24 v168, 205, v5
v_lshrrev_b32 v168, 12, v168
v_mul_u32_u24 v6, 20, v168
v_sub_u32 v5, v5, v6
v_lshlrev_b32 v168, 17, v168
v_lshrrev_b32 v6, 4, v5
v_lshl_add_u32 v168, v6, 10, v168
v_bfe_u32 v6, v5, 2, 1
v_lshl_add_u32 v168, v6, 9, v168
v_bfe_u32 v6, v5, 3, 1
v_lshl_add_u32 v168, v6, 3, v168
v_lshl_add_u32 v168, v3, 4, v168
v_lshlrev_b32 v5, 2, v4
v_add_u32 v5, 16, v5
v_mul_u32_u24 v169, 205, v5
v_lshrrev_b32 v169, 12, v169
v_mul_u32_u24 v6, 20, v169
v_sub_u32 v5, v5, v6
v_lshlrev_b32 v169, 17, v169
v_lshrrev_b32 v6, 4, v5
v_lshl_add_u32 v169, v6, 10, v169
v_bfe_u32 v6, v5, 2, 1
v_lshl_add_u32 v169, v6, 9, v169
v_bfe_u32 v6, v5, 3, 1
v_lshl_add_u32 v169, v6, 3, v169
v_lshl_add_u32 v169, v3, 4, v169
v_lshlrev_b32 v5, 2, v4
v_add_u32 v5, 32, v5
v_mul_u32_u24 v170, 205, v5
v_lshrrev_b32 v170, 12, v170
v_mul_u32_u24 v6, 20, v170
v_sub_u32 v5, v5, v6
v_lshlrev_b32 v170, 17, v170
v_lshrrev_b32 v6, 4, v5
v_lshl_add_u32 v170, v6, 10, v170
v_bfe_u32 v6, v5, 2, 1
v_lshl_add_u32 v170, v6, 9, v170
v_bfe_u32 v6, v5, 3, 1
v_lshl_add_u32 v170, v6, 3, v170
v_lshl_add_u32 v170, v3, 4, v170
v_lshlrev_b32 v5, 2, v4
v_add_u32 v5, 48, v5
v_mul_u32_u24 v171, 205, v5
v_lshrrev_b32 v171, 12, v171
v_mul_u32_u24 v6, 20, v171
v_sub_u32 v5, v5, v6
v_lshlrev_b32 v171, 17, v171
v_lshrrev_b32 v6, 4, v5
v_lshl_add_u32 v171, v6, 10, v171
v_bfe_u32 v6, v5, 2, 1
v_lshl_add_u32 v171, v6, 9, v171
v_bfe_u32 v6, v5, 3, 1
v_lshl_add_u32 v171, v6, 3, v171
v_lshl_add_u32 v171, v3, 4, v171
v_pk_mul_f32 v[8:9], v[8:9], s[46:47]
v_pk_mul_f32 v[10:11], v[10:11], s[46:47]
v_cvt_pk_bf16_f32 v136, v8, v9
v_cvt_pk_bf16_f32 v137, v10, v11
s_add_u32 s43, s41, 37748736
buffer_store_dwordx2 v[136:137], v168, s[4:7], s43 offen sc1
v_pk_mul_f32 v[12:13], v[12:13], s[46:47]
v_pk_mul_f32 v[14:15], v[14:15], s[46:47]
v_cvt_pk_bf16_f32 v138, v12, v13
v_cvt_pk_bf16_f32 v139, v14, v15
s_add_u32 s43, s41, 37748992
buffer_store_dwordx2 v[138:139], v168, s[4:7], s43 offen sc1
v_pk_mul_f32 v[16:17], v[16:17], s[46:47]
v_pk_mul_f32 v[18:19], v[18:19], s[46:47]
v_cvt_pk_bf16_f32 v140, v16, v17
v_cvt_pk_bf16_f32 v141, v18, v19
s_add_u32 s43, s41, 37750784
buffer_store_dwordx2 v[140:141], v168, s[4:7], s43 offen sc1
v_pk_mul_f32 v[20:21], v[20:21], s[46:47]
v_pk_mul_f32 v[22:23], v[22:23], s[46:47]
v_cvt_pk_bf16_f32 v142, v20, v21
v_cvt_pk_bf16_f32 v143, v22, v23
s_add_u32 s43, s41, 37751040
buffer_store_dwordx2 v[142:143], v168, s[4:7], s43 offen sc1
v_pk_mul_f32 v[24:25], v[24:25], s[46:47]
v_pk_mul_f32 v[26:27], v[26:27], s[46:47]
v_cvt_pk_bf16_f32 v144, v24, v25
v_cvt_pk_bf16_f32 v145, v26, v27
s_add_u32 s43, s41, 37748736
buffer_store_dwordx2 v[144:145], v169, s[4:7], s43 offen sc1
v_pk_mul_f32 v[28:29], v[28:29], s[46:47]
v_pk_mul_f32 v[30:31], v[30:31], s[46:47]
v_cvt_pk_bf16_f32 v146, v28, v29
v_cvt_pk_bf16_f32 v147, v30, v31
s_add_u32 s43, s41, 37748992
buffer_store_dwordx2 v[146:147], v169, s[4:7], s43 offen sc1
v_pk_mul_f32 v[32:33], v[32:33], s[46:47]
v_pk_mul_f32 v[34:35], v[34:35], s[46:47]
v_cvt_pk_bf16_f32 v148, v32, v33
v_cvt_pk_bf16_f32 v149, v34, v35
s_add_u32 s43, s41, 37750784
buffer_store_dwordx2 v[148:149], v169, s[4:7], s43 offen sc1
v_pk_mul_f32 v[36:37], v[36:37], s[46:47]
v_pk_mul_f32 v[38:39], v[38:39], s[46:47]
v_cvt_pk_bf16_f32 v150, v36, v37
v_cvt_pk_bf16_f32 v151, v38, v39
s_add_u32 s43, s41, 37751040
buffer_store_dwordx2 v[150:151], v169, s[4:7], s43 offen sc1
v_pk_mul_f32 v[40:41], v[40:41], s[46:47]
v_pk_mul_f32 v[42:43], v[42:43], s[46:47]
v_cvt_pk_bf16_f32 v136, v40, v41
v_cvt_pk_bf16_f32 v137, v42, v43
s_add_u32 s43, s41, 37748736
buffer_store_dwordx2 v[136:137], v170, s[4:7], s43 offen sc1
v_pk_mul_f32 v[44:45], v[44:45], s[46:47]
v_pk_mul_f32 v[46:47], v[46:47], s[46:47]
v_cvt_pk_bf16_f32 v138, v44, v45
v_cvt_pk_bf16_f32 v139, v46, v47
s_add_u32 s43, s41, 37748992
buffer_store_dwordx2 v[138:139], v170, s[4:7], s43 offen sc1
v_pk_mul_f32 v[48:49], v[48:49], s[46:47]
v_pk_mul_f32 v[50:51], v[50:51], s[46:47]
v_cvt_pk_bf16_f32 v140, v48, v49
v_cvt_pk_bf16_f32 v141, v50, v51
s_add_u32 s43, s41, 37750784
buffer_store_dwordx2 v[140:141], v170, s[4:7], s43 offen sc1
v_pk_mul_f32 v[52:53], v[52:53], s[46:47]
v_pk_mul_f32 v[54:55], v[54:55], s[46:47]
v_cvt_pk_bf16_f32 v142, v52, v53
v_cvt_pk_bf16_f32 v143, v54, v55
s_add_u32 s43, s41, 37751040
buffer_store_dwordx2 v[142:143], v170, s[4:7], s43 offen sc1
v_pk_mul_f32 v[56:57], v[56:57], s[46:47]
v_pk_mul_f32 v[58:59], v[58:59], s[46:47]
v_cvt_pk_bf16_f32 v144, v56, v57
v_cvt_pk_bf16_f32 v145, v58, v59
s_add_u32 s43, s41, 37748736
buffer_store_dwordx2 v[144:145], v171, s[4:7], s43 offen sc1
v_pk_mul_f32 v[60:61], v[60:61], s[46:47]
v_pk_mul_f32 v[62:63], v[62:63], s[46:47]
v_cvt_pk_bf16_f32 v146, v60, v61
v_cvt_pk_bf16_f32 v147, v62, v63
s_add_u32 s43, s41, 37748992
buffer_store_dwordx2 v[146:147], v171, s[4:7], s43 offen sc1
v_pk_mul_f32 v[64:65], v[64:65], s[46:47]
v_pk_mul_f32 v[66:67], v[66:67], s[46:47]
v_cvt_pk_bf16_f32 v148, v64, v65
v_cvt_pk_bf16_f32 v149, v66, v67
s_add_u32 s43, s41, 37750784
buffer_store_dwordx2 v[148:149], v171, s[4:7], s43 offen sc1
v_pk_mul_f32 v[68:69], v[68:69], s[46:47]
v_pk_mul_f32 v[70:71], v[70:71], s[46:47]
v_cvt_pk_bf16_f32 v150, v68, v69
v_cvt_pk_bf16_f32 v151, v70, v71
s_add_u32 s43, s41, 37751040
buffer_store_dwordx2 v[150:151], v171, s[4:7], s43 offen sc1
s_branch qkvb_exit1
qkvb_w1_3:
s_mul_i32 s30, s17, 5
s_add_u32 s30, s30, 4
s_mul_i32 s30, s30, 20480
s_add_u32 s30, s30, 87556096
s_mul_i32 s31, s17, 5
s_add_u32 s31, s31, 40
s_mul_i32 s31, s31, 20480
s_add_u32 s31, s31, 87556096
s_mul_i32 s32, s17, 5
s_add_u32 s32, s32, 41
s_mul_i32 s32, s32, 20480
s_add_u32 s32, s32, 87556096
s_mul_i32 s33, s17, 5
s_add_u32 s33, s33, 42
s_mul_i32 s33, s33, 20480
s_add_u32 s33, s33, 87556096
buffer_load_dwordx4 v[72:75], v1, s[4:7], s30 offen offset:0
buffer_load_dwordx4 v[76:79], v1, s[4:7], s31 offen offset:0
buffer_load_dwordx4 v[80:83], v1, s[4:7], s32 offen offset:0
buffer_load_dwordx4 v[84:87], v1, s[4:7], s33 offen offset:0
buffer_load_dwordx4 v[88:91], v1, s[4:7], s30 offen offset:1024
buffer_load_dwordx4 v[92:95], v1, s[4:7], s31 offen offset:1024
buffer_load_dwordx4 v[96:99], v1, s[4:7], s32 offen offset:1024
buffer_load_dwordx4 v[100:103], v1, s[4:7], s33 offen offset:1024
buffer_load_dwordx4 v[104:107], v1, s[4:7], s30 offen offset:2048
buffer_load_dwordx4 v[108:111], v1, s[4:7], s31 offen offset:2048
buffer_load_dwordx4 v[112:115], v1, s[4:7], s32 offen offset:2048
buffer_load_dwordx4 v[116:119], v1, s[4:7], s33 offen offset:2048
s_add_u32 m0, s22, 4096
s_add_u32 s23, s21, 4096
buffer_load_dwordx4 v1, s[4:7], s23 offen offset:0 lds
buffer_load_dwordx4 v1, s[4:7], s23 offen offset:1024 lds
buffer_load_dwordx4 v1, s[4:7], s23 offen offset:2048 lds
buffer_load_dwordx4 v1, s[4:7], s23 offen offset:3072 lds
s_add_u32 m0, s22, 8192
s_add_u32 s23, s21, 8192
buffer_load_dwordx4 v1, s[4:7], s23 offen offset:0 lds
buffer_load_dwordx4 v1, s[4:7], s23 offen offset:1024 lds
buffer_load_dwordx4 v1, s[4:7], s23 offen offset:2048 lds
buffer_load_dwordx4 v1, s[4:7], s23 offen offset:3072 lds
s_add_u32 m0, s22, 12288
s_add_u32 s23, s21, 12288
buffer_load_dwordx4 v1, s[4:7], s23 offen offset:0 lds
buffer_load_dwordx4 v1, s[4:7], s23 offen offset:1024 lds
buffer_load_dwordx4 v1, s[4:7], s23 offen offset:2048 lds
buffer_load_dwordx4 v1, s[4:7], s23 offen offset:3072 lds
s_add_u32 m0, s22, 16384
s_add_u32 s23, s21, 16384
buffer_load_dwordx4 v1, s[4:7], s23 offen offset:0 lds
buffer_load_dwordx4 v1, s[4:7], s23 offen offset:1024 lds
buffer_load_dwordx4 v1, s[4:7], s23 offen offset:2048 lds
buffer_load_dwordx4 v1, s[4:7], s23 offen offset:3072 lds
s_waitcnt vmcnt(28)
s_barrier
buffer_load_dwordx4 v[120:123], v1, s[4:7], s30 offen offset:3072
buffer_load_dwordx4 v[124:127], v1, s[4:7], s31 offen offset:3072
buffer_load_dwordx4 v[128:131], v1, s[4:7], s32 offen offset:3072
buffer_load_dwordx4 v[132:135], v1, s[4:7], s33 offen offset:3072
ds_read_b128 v[136:139], v6 offset:0
ds_read_b128 v[140:143], v6 offset:20480
ds_read_b128 v[144:147], v7 offset:0
ds_read_b128 v[148:151], v7 offset:20480
s_waitcnt vmcnt(28) lgkmcnt(0)
v_mfma_f32_16x16x32_bf16 v[8:11], v[72:75], v[136:139], 0
ds_read_b128 v[152:155], v6 offset:1024
v_mfma_f32_16x16x32_bf16 v[12:15], v[72:75], v[140:143], 0
ds_read_b128 v[156:159], v6 offset:21504
v_mfma_f32_16x16x32_bf16 v[16:19], v[72:75], v[144:147], 0
ds_read_b128 v[160:163], v7 offset:1024
v_mfma_f32_16x16x32_bf16 v[20:23], v[72:75], v[148:151], 0
ds_read_b128 v[164:167], v7 offset:21504
s_add_u32 s30, s30, 4096
buffer_load_dwordx4 v[72:75], v1, s[4:7], s30 offen offset:0
v_mfma_f32_16x16x32_bf16 v[24:27], v[76:79], v[136:139], 0
v_mfma_f32_16x16x32_bf16 v[28:31], v[76:79], v[140:143], 0
v_mfma_f32_16x16x32_bf16 v[32:35], v[76:79], v[144:147], 0
v_mfma_f32_16x16x32_bf16 v[36:39], v[76:79], v[148:151], 0
s_add_u32 s31, s31, 4096
buffer_load_dwordx4 v[76:79], v1, s[4:7], s31 offen offset:0
v_mfma_f32_16x16x32_bf16 v[40:43], v[80:83], v[136:139], 0
v_mfma_f32_16x16x32_bf16 v[44:47], v[80:83], v[140:143], 0
v_mfma_f32_16x16x32_bf16 v[48:51], v[80:83], v[144:147], 0
v_mfma_f32_16x16x32_bf16 v[52:55], v[80:83], v[148:151], 0
s_add_u32 s32, s32, 4096
buffer_load_dwordx4 v[80:83], v1, s[4:7], s32 offen offset:0
v_mfma_f32_16x16x32_bf16 v[56:59], v[84:87], v[136:139], 0
v_mfma_f32_16x16x32_bf16 v[60:63], v[84:87], v[140:143], 0
v_mfma_f32_16x16x32_bf16 v[64:67], v[84:87], v[144:147], 0
v_mfma_f32_16x16x32_bf16 v[68:71], v[84:87], v[148:151], 0
s_add_u32 s33, s33, 4096
buffer_load_dwordx4 v[84:87], v1, s[4:7], s33 offen offset:0
s_waitcnt vmcnt(28) lgkmcnt(0)
v_mfma_f32_16x16x32_bf16 v[8:11], v[88:91], v[152:155], v[8:11]
ds_read_b128 v[136:139], v6 offset:2048
v_mfma_f32_16x16x32_bf16 v[12:15], v[88:91], v[156:159], v[12:15]
ds_read_b128 v[140:143], v6 offset:22528
v_mfma_f32_16x16x32_bf16 v[16:19], v[88:91], v[160:163], v[16:19]
ds_read_b128 v[144:147], v7 offset:2048
v_mfma_f32_16x16x32_bf16 v[20:23], v[88:91], v[164:167], v[20:23]
ds_read_b128 v[148:151], v7 offset:22528
buffer_load_dwordx4 v[88:91], v1, s[4:7], s30 offen offset:1024
v_mfma_f32_16x16x32_bf16 v[24:27], v[92:95], v[152:155], v[24:27]
v_mfma_f32_16x16x32_bf16 v[28:31], v[92:95], v[156:159], v[28:31]
v_mfma_f32_16x16x32_bf16 v[32:35], v[92:95], v[160:163], v[32:35]
v_mfma_f32_16x16x32_bf16 v[36:39], v[92:95], v[164:167], v[36:39]
buffer_load_dwordx4 v[92:95], v1, s[4:7], s31 offen offset:1024
v_mfma_f32_16x16x32_bf16 v[40:43], v[96:99], v[152:155], v[40:43]
v_mfma_f32_16x16x32_bf16 v[44:47], v[96:99], v[156:159], v[44:47]
v_mfma_f32_16x16x32_bf16 v[48:51], v[96:99], v[160:163], v[48:51]
v_mfma_f32_16x16x32_bf16 v[52:55], v[96:99], v[164:167], v[52:55]
buffer_load_dwordx4 v[96:99], v1, s[4:7], s32 offen offset:1024
v_mfma_f32_16x16x32_bf16 v[56:59], v[100:103], v[152:155], v[56:59]
v_mfma_f32_16x16x32_bf16 v[60:63], v[100:103], v[156:159], v[60:63]
v_mfma_f32_16x16x32_bf16 v[64:67], v[100:103], v[160:163], v[64:67]
v_mfma_f32_16x16x32_bf16 v[68:71], v[100:103], v[164:167], v[68:71]
buffer_load_dwordx4 v[100:103], v1, s[4:7], s33 offen offset:1024
s_waitcnt vmcnt(28) lgkmcnt(0)
v_mfma_f32_16x16x32_bf16 v[8:11], v[104:107], v[136:139], v[8:11]
ds_read_b128 v[152:155], v6 offset:3072
v_mfma_f32_16x16x32_bf16 v[12:15], v[104:107], v[140:143], v[12:15]
ds_read_b128 v[156:159], v6 offset:23552
v_mfma_f32_16x16x32_bf16 v[16:19], v[104:107], v[144:147], v[16:19]
ds_read_b128 v[160:163], v7 offset:3072
v_mfma_f32_16x16x32_bf16 v[20:23], v[104:107], v[148:151], v[20:23]
ds_read_b128 v[164:167], v7 offset:23552
buffer_load_dwordx4 v[104:107], v1, s[4:7], s30 offen offset:2048
v_mfma_f32_16x16x32_bf16 v[24:27], v[108:111], v[136:139], v[24:27]
v_mfma_f32_16x16x32_bf16 v[28:31], v[108:111], v[140:143], v[28:31]
v_mfma_f32_16x16x32_bf16 v[32:35], v[108:111], v[144:147], v[32:35]
v_mfma_f32_16x16x32_bf16 v[36:39], v[108:111], v[148:151], v[36:39]
buffer_load_dwordx4 v[108:111], v1, s[4:7], s31 offen offset:2048
v_mfma_f32_16x16x32_bf16 v[40:43], v[112:115], v[136:139], v[40:43]
v_mfma_f32_16x16x32_bf16 v[44:47], v[112:115], v[140:143], v[44:47]
v_mfma_f32_16x16x32_bf16 v[48:51], v[112:115], v[144:147], v[48:51]
v_mfma_f32_16x16x32_bf16 v[52:55], v[112:115], v[148:151], v[52:55]
buffer_load_dwordx4 v[112:115], v1, s[4:7], s32 offen offset:2048
v_mfma_f32_16x16x32_bf16 v[56:59], v[116:119], v[136:139], v[56:59]
v_mfma_f32_16x16x32_bf16 v[60:63], v[116:119], v[140:143], v[60:63]
v_mfma_f32_16x16x32_bf16 v[64:67], v[116:119], v[144:147], v[64:67]
v_mfma_f32_16x16x32_bf16 v[68:71], v[116:119], v[148:151], v[68:71]
buffer_load_dwordx4 v[116:119], v1, s[4:7], s33 offen offset:2048
s_waitcnt vmcnt(12) lgkmcnt(0)
s_barrier
v_mfma_f32_16x16x32_bf16 v[8:11], v[120:123], v[152:155], v[8:11]
ds_read_b128 v[136:139], v6 offset:4096
v_mfma_f32_16x16x32_bf16 v[12:15], v[120:123], v[156:159], v[12:15]
ds_read_b128 v[140:143], v6 offset:24576
v_mfma_f32_16x16x32_bf16 v[16:19], v[120:123], v[160:163], v[16:19]
ds_read_b128 v[144:147], v7 offset:4096
v_mfma_f32_16x16x32_bf16 v[20:23], v[120:123], v[164:167], v[20:23]
ds_read_b128 v[148:151], v7 offset:24576
buffer_load_dwordx4 v[120:123], v1, s[4:7], s30 offen offset:3072
v_mfma_f32_16x16x32_bf16 v[24:27], v[124:127], v[152:155], v[24:27]
v_mfma_f32_16x16x32_bf16 v[28:31], v[124:127], v[156:159], v[28:31]
v_mfma_f32_16x16x32_bf16 v[32:35], v[124:127], v[160:163], v[32:35]
v_mfma_f32_16x16x32_bf16 v[36:39], v[124:127], v[164:167], v[36:39]
buffer_load_dwordx4 v[124:127], v1, s[4:7], s31 offen offset:3072
v_mfma_f32_16x16x32_bf16 v[40:43], v[128:131], v[152:155], v[40:43]
v_mfma_f32_16x16x32_bf16 v[44:47], v[128:131], v[156:159], v[44:47]
v_mfma_f32_16x16x32_bf16 v[48:51], v[128:131], v[160:163], v[48:51]
v_mfma_f32_16x16x32_bf16 v[52:55], v[128:131], v[164:167], v[52:55]
buffer_load_dwordx4 v[128:131], v1, s[4:7], s32 offen offset:3072
v_mfma_f32_16x16x32_bf16 v[56:59], v[132:135], v[152:155], v[56:59]
v_mfma_f32_16x16x32_bf16 v[60:63], v[132:135], v[156:159], v[60:63]
v_mfma_f32_16x16x32_bf16 v[64:67], v[132:135], v[160:163], v[64:67]
v_mfma_f32_16x16x32_bf16 v[68:71], v[132:135], v[164:167], v[68:71]
buffer_load_dwordx4 v[132:135], v1, s[4:7], s33 offen offset:3072
s_mov_b32 s40, 0
v_add_u32 v6, 4096, v6
v_add_u32 v7, 4096, v7
qkvb_loop7:
s_waitcnt vmcnt(12) lgkmcnt(0)
v_mfma_f32_16x16x32_bf16 v[8:11], v[72:75], v[136:139], v[8:11]
ds_read_b128 v[152:155], v6 offset:1024
v_mfma_f32_16x16x32_bf16 v[12:15], v[72:75], v[140:143], v[12:15]
ds_read_b128 v[156:159], v6 offset:21504
v_mfma_f32_16x16x32_bf16 v[16:19], v[72:75], v[144:147], v[16:19]
ds_read_b128 v[160:163], v7 offset:1024
v_mfma_f32_16x16x32_bf16 v[20:23], v[72:75], v[148:151], v[20:23]
ds_read_b128 v[164:167], v7 offset:21504
s_add_u32 s30, s30, 4096
buffer_load_dwordx4 v[72:75], v1, s[4:7], s30 offen offset:0
v_mfma_f32_16x16x32_bf16 v[24:27], v[76:79], v[136:139], v[24:27]
v_mfma_f32_16x16x32_bf16 v[28:31], v[76:79], v[140:143], v[28:31]
v_mfma_f32_16x16x32_bf16 v[32:35], v[76:79], v[144:147], v[32:35]
v_mfma_f32_16x16x32_bf16 v[36:39], v[76:79], v[148:151], v[36:39]
s_add_u32 s31, s31, 4096
buffer_load_dwordx4 v[76:79], v1, s[4:7], s31 offen offset:0
v_mfma_f32_16x16x32_bf16 v[40:43], v[80:83], v[136:139], v[40:43]
v_mfma_f32_16x16x32_bf16 v[44:47], v[80:83], v[140:143], v[44:47]
v_mfma_f32_16x16x32_bf16 v[48:51], v[80:83], v[144:147], v[48:51]
v_mfma_f32_16x16x32_bf16 v[52:55], v[80:83], v[148:151], v[52:55]
s_add_u32 s32, s32, 4096
buffer_load_dwordx4 v[80:83], v1, s[4:7], s32 offen offset:0
v_mfma_f32_16x16x32_bf16 v[56:59], v[84:87], v[136:139], v[56:59]
v_mfma_f32_16x16x32_bf16 v[60:63], v[84:87], v[140:143], v[60:63]
v_mfma_f32_16x16x32_bf16 v[64:67], v[84:87], v[144:147], v[64:67]
v_mfma_f32_16x16x32_bf16 v[68:71], v[84:87], v[148:151], v[68:71]
s_add_u32 s33, s33, 4096
buffer_load_dwordx4 v[84:87], v1, s[4:7], s33 offen offset:0
s_waitcnt vmcnt(12) lgkmcnt(0)
v_mfma_f32_16x16x32_bf16 v[8:11], v[88:91], v[152:155], v[8:11]
ds_read_b128 v[136:139], v6 offset:2048
v_mfma_f32_16x16x32_bf16 v[12:15], v[88:91], v[156:159], v[12:15]
ds_read_b128 v[140:143], v6 offset:22528
v_mfma_f32_16x16x32_bf16 v[16:19], v[88:91], v[160:163], v[16:19]
ds_read_b128 v[144:147], v7 offset:2048
v_mfma_f32_16x16x32_bf16 v[20:23], v[88:91], v[164:167], v[20:23]
ds_read_b128 v[148:151], v7 offset:22528
buffer_load_dwordx4 v[88:91], v1, s[4:7], s30 offen offset:1024
v_mfma_f32_16x16x32_bf16 v[24:27], v[92:95], v[152:155], v[24:27]
v_mfma_f32_16x16x32_bf16 v[28:31], v[92:95], v[156:159], v[28:31]
v_mfma_f32_16x16x32_bf16 v[32:35], v[92:95], v[160:163], v[32:35]
v_mfma_f32_16x16x32_bf16 v[36:39], v[92:95], v[164:167], v[36:39]
buffer_load_dwordx4 v[92:95], v1, s[4:7], s31 offen offset:1024
v_mfma_f32_16x16x32_bf16 v[40:43], v[96:99], v[152:155], v[40:43]
v_mfma_f32_16x16x32_bf16 v[44:47], v[96:99], v[156:159], v[44:47]
v_mfma_f32_16x16x32_bf16 v[48:51], v[96:99], v[160:163], v[48:51]
v_mfma_f32_16x16x32_bf16 v[52:55], v[96:99], v[164:167], v[52:55]
buffer_load_dwordx4 v[96:99], v1, s[4:7], s32 offen offset:1024
v_mfma_f32_16x16x32_bf16 v[56:59], v[100:103], v[152:155], v[56:59]
v_mfma_f32_16x16x32_bf16 v[60:63], v[100:103], v[156:159], v[60:63]
v_mfma_f32_16x16x32_bf16 v[64:67], v[100:103], v[160:163], v[64:67]
v_mfma_f32_16x16x32_bf16 v[68:71], v[100:103], v[164:167], v[68:71]
buffer_load_dwordx4 v[100:103], v1, s[4:7], s33 offen offset:1024
s_waitcnt vmcnt(12) lgkmcnt(0)
v_mfma_f32_16x16x32_bf16 v[8:11], v[104:107], v[136:139], v[8:11]
ds_read_b128 v[152:155], v6 offset:3072
v_mfma_f32_16x16x32_bf16 v[12:15], v[104:107], v[140:143], v[12:15]
ds_read_b128 v[156:159], v6 offset:23552
v_mfma_f32_16x16x32_bf16 v[16:19], v[104:107], v[144:147], v[16:19]
ds_read_b128 v[160:163], v7 offset:3072
v_mfma_f32_16x16x32_bf16 v[20:23], v[104:107], v[148:151], v[20:23]
ds_read_b128 v[164:167], v7 offset:23552
buffer_load_dwordx4 v[104:107], v1, s[4:7], s30 offen offset:2048
v_mfma_f32_16x16x32_bf16 v[24:27], v[108:111], v[136:139], v[24:27]
v_mfma_f32_16x16x32_bf16 v[28:31], v[108:111], v[140:143], v[28:31]
v_mfma_f32_16x16x32_bf16 v[32:35], v[108:111], v[144:147], v[32:35]
v_mfma_f32_16x16x32_bf16 v[36:39], v[108:111], v[148:151], v[36:39]
buffer_load_dwordx4 v[108:111], v1, s[4:7], s31 offen offset:2048
v_mfma_f32_16x16x32_bf16 v[40:43], v[112:115], v[136:139], v[40:43]
v_mfma_f32_16x16x32_bf16 v[44:47], v[112:115], v[140:143], v[44:47]
v_mfma_f32_16x16x32_bf16 v[48:51], v[112:115], v[144:147], v[48:51]
v_mfma_f32_16x16x32_bf16 v[52:55], v[112:115], v[148:151], v[52:55]
buffer_load_dwordx4 v[112:115], v1, s[4:7], s32 offen offset:2048
v_mfma_f32_16x16x32_bf16 v[56:59], v[116:119], v[136:139], v[56:59]
v_mfma_f32_16x16x32_bf16 v[60:63], v[116:119], v[140:143], v[60:63]
v_mfma_f32_16x16x32_bf16 v[64:67], v[116:119], v[144:147], v[64:67]
v_mfma_f32_16x16x32_bf16 v[68:71], v[116:119], v[148:151], v[68:71]
buffer_load_dwordx4 v[116:119], v1, s[4:7], s33 offen offset:2048
s_waitcnt vmcnt(12) lgkmcnt(0)
v_mfma_f32_16x16x32_bf16 v[8:11], v[120:123], v[152:155], v[8:11]
ds_read_b128 v[136:139], v6 offset:4096
v_mfma_f32_16x16x32_bf16 v[12:15], v[120:123], v[156:159], v[12:15]
ds_read_b128 v[140:143], v6 offset:24576
v_mfma_f32_16x16x32_bf16 v[16:19], v[120:123], v[160:163], v[16:19]
ds_read_b128 v[144:147], v7 offset:4096
v_mfma_f32_16x16x32_bf16 v[20:23], v[120:123], v[164:167], v[20:23]
ds_read_b128 v[148:151], v7 offset:24576
buffer_load_dwordx4 v[120:123], v1, s[4:7], s30 offen offset:3072
v_mfma_f32_16x16x32_bf16 v[24:27], v[124:127], v[152:155], v[24:27]
v_mfma_f32_16x16x32_bf16 v[28:31], v[124:127], v[156:159], v[28:31]
v_mfma_f32_16x16x32_bf16 v[32:35], v[124:127], v[160:163], v[32:35]
v_mfma_f32_16x16x32_bf16 v[36:39], v[124:127], v[164:167], v[36:39]
buffer_load_dwordx4 v[124:127], v1, s[4:7], s31 offen offset:3072
v_mfma_f32_16x16x32_bf16 v[40:43], v[128:131], v[152:155], v[40:43]
v_mfma_f32_16x16x32_bf16 v[44:47], v[128:131], v[156:159], v[44:47]
v_mfma_f32_16x16x32_bf16 v[48:51], v[128:131], v[160:163], v[48:51]
v_mfma_f32_16x16x32_bf16 v[52:55], v[128:131], v[164:167], v[52:55]
buffer_load_dwordx4 v[128:131], v1, s[4:7], s32 offen offset:3072
v_mfma_f32_16x16x32_bf16 v[56:59], v[132:135], v[152:155], v[56:59]
v_mfma_f32_16x16x32_bf16 v[60:63], v[132:135], v[156:159], v[60:63]
v_mfma_f32_16x16x32_bf16 v[64:67], v[132:135], v[160:163], v[64:67]
v_mfma_f32_16x16x32_bf16 v[68:71], v[132:135], v[164:167], v[68:71]
buffer_load_dwordx4 v[132:135], v1, s[4:7], s33 offen offset:3072
v_add_u32 v6, 4096, v6
v_add_u32 v7, 4096, v7
s_add_u32 s40, s40, 1
s_cmp_lt_u32 s40, 4
s_cbranch_scc1 qkvb_loop7
s_waitcnt vmcnt(0) lgkmcnt(0)
v_and_b32 v2, 63, v0
v_and_b32 v3, 15, v2
v_lshrrev_b32 v4, 4, v2
s_lshl_b32 s41, s17, 19
s_lshl_b32 s42, s18, 12
s_add_u32 s41, s41, s42
s_mov_b32 s46, 0x3ea52b5c
s_mov_b32 s47, 0x3ea52b5c
v_lshlrev_b32 v5, 2, v4
v_add_u32 v5, 64, v5
v_mul_u32_u24 v168, 205, v5
v_lshrrev_b32 v168, 12, v168
v_mul_u32_u24 v6, 20, v168
v_sub_u32 v5, v5, v6
v_lshlrev_b32 v168, 17, v168
v_lshrrev_b32 v6, 4, v5
v_lshl_add_u32 v168, v6, 10, v168
v_bfe_u32 v6, v5, 2, 1
v_lshl_add_u32 v168, v6, 9, v168
v_bfe_u32 v6, v5, 3, 1
v_lshl_add_u32 v168, v6, 3, v168
v_lshl_add_u32 v168, v3, 4, v168
v_lshlrev_b32 v5, 2, v4
v_add_u32 v5, 0, v5
v_mul_u32_u24 v169, 205, v5
v_lshrrev_b32 v169, 12, v169
v_mul_u32_u24 v6, 20, v169
v_sub_u32 v5, v5, v6
v_lshlrev_b32 v169, 17, v169
v_lshrrev_b32 v6, 4, v5
v_lshl_add_u32 v169, v6, 10, v169
v_bfe_u32 v6, v5, 2, 1
v_lshl_add_u32 v169, v6, 9, v169
v_bfe_u32 v6, v5, 3, 1
v_lshl_add_u32 v169, v6, 3, v169
v_lshl_add_u32 v169, v3, 4, v169
v_lshlrev_b32 v5, 2, v4
v_add_u32 v5, 16, v5
v_mul_u32_u24 v170, 205, v5
v_lshrrev_b32 v170, 12, v170
v_mul_u32_u24 v6, 20, v170
v_sub_u32 v5, v5, v6
v_lshlrev_b32 v170, 17, v170
v_lshrrev_b32 v6, 4, v5
v_lshl_add_u32 v170, v6, 10, v170
v_bfe_u32 v6, v5, 2, 1
v_lshl_add_u32 v170, v6, 9, v170
v_bfe_u32 v6, v5, 3, 1
v_lshl_add_u32 v170, v6, 3, v170
v_lshl_add_u32 v170, v3, 4, v170
v_lshlrev_b32 v5, 2, v4
v_add_u32 v5, 32, v5
v_mul_u32_u24 v171, 205, v5
v_lshrrev_b32 v171, 12, v171
v_mul_u32_u24 v6, 20, v171
v_sub_u32 v5, v5, v6
v_lshlrev_b32 v171, 17, v171
v_lshrrev_b32 v6, 4, v5
v_lshl_add_u32 v171, v6, 10, v171
v_bfe_u32 v6, v5, 2, 1
v_lshl_add_u32 v171, v6, 9, v171
v_bfe_u32 v6, v5, 3, 1
v_lshl_add_u32 v171, v6, 3, v171
v_lshl_add_u32 v171, v3, 4, v171
v_pk_mul_f32 v[8:9], v[8:9], s[46:47]
v_pk_mul_f32 v[10:11], v[10:11], s[46:47]
v_cvt_pk_bf16_f32 v136, v8, v9
v_cvt_pk_bf16_f32 v137, v10, v11
s_add_u32 s43, s41, 37748736
buffer_store_dwordx2 v[136:137], v168, s[4:7], s43 offen sc1
v_pk_mul_f32 v[12:13], v[12:13], s[46:47]
v_pk_mul_f32 v[14:15], v[14:15], s[46:47]
v_cvt_pk_bf16_f32 v138, v12, v13
v_cvt_pk_bf16_f32 v139, v14, v15
s_add_u32 s43, s41, 37748992
buffer_store_dwordx2 v[138:139], v168, s[4:7], s43 offen sc1
v_pk_mul_f32 v[16:17], v[16:17], s[46:47]
v_pk_mul_f32 v[18:19], v[18:19], s[46:47]
v_cvt_pk_bf16_f32 v140, v16, v17
v_cvt_pk_bf16_f32 v141, v18, v19
s_add_u32 s43, s41, 37750784
buffer_store_dwordx2 v[140:141], v168, s[4:7], s43 offen sc1
v_pk_mul_f32 v[20:21], v[20:21], s[46:47]
v_pk_mul_f32 v[22:23], v[22:23], s[46:47]
v_cvt_pk_bf16_f32 v142, v20, v21
v_cvt_pk_bf16_f32 v143, v22, v23
s_add_u32 s43, s41, 37751040
buffer_store_dwordx2 v[142:143], v168, s[4:7], s43 offen sc1
v_cvt_pk_bf16_f32 v144, v24, v25
v_cvt_pk_bf16_f32 v145, v26, v27
s_add_u32 s43, s41, 41943040
buffer_store_dwordx2 v[144:145], v169, s[4:7], s43 offen sc1
v_cvt_pk_bf16_f32 v146, v28, v29
v_cvt_pk_bf16_f32 v147, v30, v31
s_add_u32 s43, s41, 41943296
buffer_store_dwordx2 v[146:147], v169, s[4:7], s43 offen sc1
v_cvt_pk_bf16_f32 v148, v32, v33
v_cvt_pk_bf16_f32 v149, v34, v35
s_add_u32 s43, s41, 41945088
buffer_store_dwordx2 v[148:149], v169, s[4:7], s43 offen sc1
v_cvt_pk_bf16_f32 v150, v36, v37
v_cvt_pk_bf16_f32 v151, v38, v39
s_add_u32 s43, s41, 41945344
buffer_store_dwordx2 v[150:151], v169, s[4:7], s43 offen sc1
v_cvt_pk_bf16_f32 v136, v40, v41
v_cvt_pk_bf16_f32 v137, v42, v43
s_add_u32 s43, s41, 41943040
buffer_store_dwordx2 v[136:137], v170, s[4:7], s43 offen sc1
v_cvt_pk_bf16_f32 v138, v44, v45
v_cvt_pk_bf16_f32 v139, v46, v47
s_add_u32 s43, s41, 41943296
buffer_store_dwordx2 v[138:139], v170, s[4:7], s43 offen sc1
v_cvt_pk_bf16_f32 v140, v48, v49
v_cvt_pk_bf16_f32 v141, v50, v51
s_add_u32 s43, s41, 41945088
buffer_store_dwordx2 v[140:141], v170, s[4:7], s43 offen sc1
v_cvt_pk_bf16_f32 v142, v52, v53
v_cvt_pk_bf16_f32 v143, v54, v55
s_add_u32 s43, s41, 41945344
buffer_store_dwordx2 v[142:143], v170, s[4:7], s43 offen sc1
v_cvt_pk_bf16_f32 v144, v56, v57
v_cvt_pk_bf16_f32 v145, v58, v59
s_add_u32 s43, s41, 41943040
buffer_store_dwordx2 v[144:145], v171, s[4:7], s43 offen sc1
v_cvt_pk_bf16_f32 v146, v60, v61
v_cvt_pk_bf16_f32 v147, v62, v63
s_add_u32 s43, s41, 41943296
buffer_store_dwordx2 v[146:147], v171, s[4:7], s43 offen sc1
v_cvt_pk_bf16_f32 v148, v64, v65
v_cvt_pk_bf16_f32 v149, v66, v67
s_add_u32 s43, s41, 41945088
buffer_store_dwordx2 v[148:149], v171, s[4:7], s43 offen sc1
v_cvt_pk_bf16_f32 v150, v68, v69
v_cvt_pk_bf16_f32 v151, v70, v71
s_add_u32 s43, s41, 41945344
buffer_store_dwordx2 v[150:151], v171, s[4:7], s43 offen sc1
s_branch qkvb_exit1
qkvb_w2_4:
s_mul_i32 s30, s17, 5
s_add_u32 s30, s30, 43
s_mul_i32 s30, s30, 20480
s_add_u32 s30, s30, 87556096
s_mul_i32 s31, s17, 5
s_add_u32 s31, s31, 44
s_mul_i32 s31, s31, 20480
s_add_u32 s31, s31, 87556096
s_mul_i32 s32, s17, 5
s_add_u32 s32, s32, 80
s_mul_i32 s32, s32, 20480
s_add_u32 s32, s32, 87556096
s_mul_i32 s33, s17, 5
s_add_u32 s33, s33, 81
s_mul_i32 s33, s33, 20480
s_add_u32 s33, s33, 87556096
buffer_load_dwordx4 v[72:75], v1, s[4:7], s30 offen offset:0
buffer_load_dwordx4 v[76:79], v1, s[4:7], s31 offen offset:0
buffer_load_dwordx4 v[80:83], v1, s[4:7], s32 offen offset:0
buffer_load_dwordx4 v[84:87], v1, s[4:7], s33 offen offset:0
buffer_load_dwordx4 v[88:91], v1, s[4:7], s30 offen offset:1024
buffer_load_dwordx4 v[92:95], v1, s[4:7], s31 offen offset:1024
buffer_load_dwordx4 v[96:99], v1, s[4:7], s32 offen offset:1024
buffer_load_dwordx4 v[100:103], v1, s[4:7], s33 offen offset:1024
buffer_load_dwordx4 v[104:107], v1, s[4:7], s30 offen offset:2048
buffer_load_dwordx4 v[108:111], v1, s[4:7], s31 offen offset:2048
buffer_load_dwordx4 v[112:115], v1, s[4:7], s32 offen offset:2048
buffer_load_dwordx4 v[116:119], v1, s[4:7], s33 offen offset:2048
s_add_u32 m0, s22, 4096
s_add_u32 s23, s21, 4096
buffer_load_dwordx4 v1, s[4:7], s23 offen offset:0 lds
buffer_load_dwordx4 v1, s[4:7], s23 offen offset:1024 lds
buffer_load_dwordx4 v1, s[4:7], s23 offen offset:2048 lds
buffer_load_dwordx4 v1, s[4:7], s23 offen offset:3072 lds
s_add_u32 m0, s22, 8192
s_add_u32 s23, s21, 8192
buffer_load_dwordx4 v1, s[4:7], s23 offen offset:0 lds
buffer_load_dwordx4 v1, s[4:7], s23 offen offset:1024 lds
buffer_load_dwordx4 v1, s[4:7], s23 offen offset:2048 lds
buffer_load_dwordx4 v1, s[4:7], s23 offen offset:3072 lds
s_add_u32 m0, s22, 12288
s_add_u32 s23, s21, 12288
buffer_load_dwordx4 v1, s[4:7], s23 offen offset:0 lds
buffer_load_dwordx4 v1, s[4:7], s23 offen offset:1024 lds
buffer_load_dwordx4 v1, s[4:7], s23 offen offset:2048 lds
buffer_load_dwordx4 v1, s[4:7], s23 offen offset:3072 lds
s_add_u32 m0, s22, 16384
s_add_u32 s23, s21, 16384
buffer_load_dwordx4 v1, s[4:7], s23 offen offset:0 lds
buffer_load_dwordx4 v1, s[4:7], s23 offen offset:1024 lds
buffer_load_dwordx4 v1, s[4:7], s23 offen offset:2048 lds
buffer_load_dwordx4 v1, s[4:7], s23 offen offset:3072 lds
s_waitcnt vmcnt(28)
s_barrier
buffer_load_dwordx4 v[120:123], v1, s[4:7], s30 offen offset:3072
buffer_load_dwordx4 v[124:127], v1, s[4:7], s31 offen offset:3072
buffer_load_dwordx4 v[128:131], v1, s[4:7], s32 offen offset:3072
buffer_load_dwordx4 v[132:135], v1, s[4:7], s33 offen offset:3072
ds_read_b128 v[136:139], v6 offset:0
ds_read_b128 v[140:143], v6 offset:20480
ds_read_b128 v[144:147], v7 offset:0
ds_read_b128 v[148:151], v7 offset:20480
s_waitcnt vmcnt(28) lgkmcnt(0)
v_mfma_f32_16x16x32_bf16 v[8:11], v[72:75], v[136:139], 0
ds_read_b128 v[152:155], v6 offset:1024
v_mfma_f32_16x16x32_bf16 v[12:15], v[72:75], v[140:143], 0
ds_read_b128 v[156:159], v6 offset:21504
v_mfma_f32_16x16x32_bf16 v[16:19], v[72:75], v[144:147], 0
ds_read_b128 v[160:163], v7 offset:1024
v_mfma_f32_16x16x32_bf16 v[20:23], v[72:75], v[148:151], 0
ds_read_b128 v[164:167], v7 offset:21504
s_add_u32 s30, s30, 4096
buffer_load_dwordx4 v[72:75], v1, s[4:7], s30 offen offset:0
v_mfma_f32_16x16x32_bf16 v[24:27], v[76:79], v[136:139], 0
v_mfma_f32_16x16x32_bf16 v[28:31], v[76:79], v[140:143], 0
v_mfma_f32_16x16x32_bf16 v[32:35], v[76:79], v[144:147], 0
v_mfma_f32_16x16x32_bf16 v[36:39], v[76:79], v[148:151], 0
s_add_u32 s31, s31, 4096
buffer_load_dwordx4 v[76:79], v1, s[4:7], s31 offen offset:0
v_mfma_f32_16x16x32_bf16 v[40:43], v[136:139], v[80:83], 0
v_mfma_f32_16x16x32_bf16 v[44:47], v[140:143], v[80:83], 0
v_mfma_f32_16x16x32_bf16 v[48:51], v[144:147], v[80:83], 0
v_mfma_f32_16x16x32_bf16 v[52:55], v[148:151], v[80:83], 0
s_add_u32 s32, s32, 4096
buffer_load_dwordx4 v[80:83], v1, s[4:7], s32 offen offset:0
v_mfma_f32_16x16x32_bf16 v[56:59], v[136:139], v[84:87], 0
v_mfma_f32_16x16x32_bf16 v[60:63], v[140:143], v[84:87], 0
v_mfma_f32_16x16x32_bf16 v[64:67], v[144:147], v[84:87], 0
v_mfma_f32_16x16x32_bf16 v[68:71], v[148:151], v[84:87], 0
s_add_u32 s33, s33, 4096
buffer_load_dwordx4 v[84:87], v1, s[4:7], s33 offen offset:0
s_waitcnt vmcnt(28) lgkmcnt(0)
v_mfma_f32_16x16x32_bf16 v[8:11], v[88:91], v[152:155], v[8:11]
ds_read_b128 v[136:139], v6 offset:2048
v_mfma_f32_16x16x32_bf16 v[12:15], v[88:91], v[156:159], v[12:15]
ds_read_b128 v[140:143], v6 offset:22528
v_mfma_f32_16x16x32_bf16 v[16:19], v[88:91], v[160:163], v[16:19]
ds_read_b128 v[144:147], v7 offset:2048
v_mfma_f32_16x16x32_bf16 v[20:23], v[88:91], v[164:167], v[20:23]
ds_read_b128 v[148:151], v7 offset:22528
buffer_load_dwordx4 v[88:91], v1, s[4:7], s30 offen offset:1024
v_mfma_f32_16x16x32_bf16 v[24:27], v[92:95], v[152:155], v[24:27]
v_mfma_f32_16x16x32_bf16 v[28:31], v[92:95], v[156:159], v[28:31]
v_mfma_f32_16x16x32_bf16 v[32:35], v[92:95], v[160:163], v[32:35]
v_mfma_f32_16x16x32_bf16 v[36:39], v[92:95], v[164:167], v[36:39]
buffer_load_dwordx4 v[92:95], v1, s[4:7], s31 offen offset:1024
v_mfma_f32_16x16x32_bf16 v[40:43], v[152:155], v[96:99], v[40:43]
v_mfma_f32_16x16x32_bf16 v[44:47], v[156:159], v[96:99], v[44:47]
v_mfma_f32_16x16x32_bf16 v[48:51], v[160:163], v[96:99], v[48:51]
v_mfma_f32_16x16x32_bf16 v[52:55], v[164:167], v[96:99], v[52:55]
buffer_load_dwordx4 v[96:99], v1, s[4:7], s32 offen offset:1024
v_mfma_f32_16x16x32_bf16 v[56:59], v[152:155], v[100:103], v[56:59]
v_mfma_f32_16x16x32_bf16 v[60:63], v[156:159], v[100:103], v[60:63]
v_mfma_f32_16x16x32_bf16 v[64:67], v[160:163], v[100:103], v[64:67]
v_mfma_f32_16x16x32_bf16 v[68:71], v[164:167], v[100:103], v[68:71]
buffer_load_dwordx4 v[100:103], v1, s[4:7], s33 offen offset:1024
s_waitcnt vmcnt(28) lgkmcnt(0)
v_mfma_f32_16x16x32_bf16 v[8:11], v[104:107], v[136:139], v[8:11]
ds_read_b128 v[152:155], v6 offset:3072
v_mfma_f32_16x16x32_bf16 v[12:15], v[104:107], v[140:143], v[12:15]
ds_read_b128 v[156:159], v6 offset:23552
v_mfma_f32_16x16x32_bf16 v[16:19], v[104:107], v[144:147], v[16:19]
ds_read_b128 v[160:163], v7 offset:3072
v_mfma_f32_16x16x32_bf16 v[20:23], v[104:107], v[148:151], v[20:23]
ds_read_b128 v[164:167], v7 offset:23552
buffer_load_dwordx4 v[104:107], v1, s[4:7], s30 offen offset:2048
v_mfma_f32_16x16x32_bf16 v[24:27], v[108:111], v[136:139], v[24:27]
v_mfma_f32_16x16x32_bf16 v[28:31], v[108:111], v[140:143], v[28:31]
v_mfma_f32_16x16x32_bf16 v[32:35], v[108:111], v[144:147], v[32:35]
v_mfma_f32_16x16x32_bf16 v[36:39], v[108:111], v[148:151], v[36:39]
buffer_load_dwordx4 v[108:111], v1, s[4:7], s31 offen offset:2048
v_mfma_f32_16x16x32_bf16 v[40:43], v[136:139], v[112:115], v[40:43]
v_mfma_f32_16x16x32_bf16 v[44:47], v[140:143], v[112:115], v[44:47]
v_mfma_f32_16x16x32_bf16 v[48:51], v[144:147], v[112:115], v[48:51]
v_mfma_f32_16x16x32_bf16 v[52:55], v[148:151], v[112:115], v[52:55]
buffer_load_dwordx4 v[112:115], v1, s[4:7], s32 offen offset:2048
v_mfma_f32_16x16x32_bf16 v[56:59], v[136:139], v[116:119], v[56:59]
v_mfma_f32_16x16x32_bf16 v[60:63], v[140:143], v[116:119], v[60:63]
v_mfma_f32_16x16x32_bf16 v[64:67], v[144:147], v[116:119], v[64:67]
v_mfma_f32_16x16x32_bf16 v[68:71], v[148:151], v[116:119], v[68:71]
buffer_load_dwordx4 v[116:119], v1, s[4:7], s33 offen offset:2048
s_waitcnt vmcnt(12) lgkmcnt(0)
s_barrier
v_mfma_f32_16x16x32_bf16 v[8:11], v[120:123], v[152:155], v[8:11]
ds_read_b128 v[136:139], v6 offset:4096
v_mfma_f32_16x16x32_bf16 v[12:15], v[120:123], v[156:159], v[12:15]
ds_read_b128 v[140:143], v6 offset:24576
v_mfma_f32_16x16x32_bf16 v[16:19], v[120:123], v[160:163], v[16:19]
ds_read_b128 v[144:147], v7 offset:4096
v_mfma_f32_16x16x32_bf16 v[20:23], v[120:123], v[164:167], v[20:23]
ds_read_b128 v[148:151], v7 offset:24576
buffer_load_dwordx4 v[120:123], v1, s[4:7], s30 offen offset:3072
v_mfma_f32_16x16x32_bf16 v[24:27], v[124:127], v[152:155], v[24:27]
v_mfma_f32_16x16x32_bf16 v[28:31], v[124:127], v[156:159], v[28:31]
v_mfma_f32_16x16x32_bf16 v[32:35], v[124:127], v[160:163], v[32:35]
v_mfma_f32_16x16x32_bf16 v[36:39], v[124:127], v[164:167], v[36:39]
buffer_load_dwordx4 v[124:127], v1, s[4:7], s31 offen offset:3072
v_mfma_f32_16x16x32_bf16 v[40:43], v[152:155], v[128:131], v[40:43]
v_mfma_f32_16x16x32_bf16 v[44:47], v[156:159], v[128:131], v[44:47]
v_mfma_f32_16x16x32_bf16 v[48:51], v[160:163], v[128:131], v[48:51]
v_mfma_f32_16x16x32_bf16 v[52:55], v[164:167], v[128:131], v[52:55]
buffer_load_dwordx4 v[128:131], v1, s[4:7], s32 offen offset:3072
v_mfma_f32_16x16x32_bf16 v[56:59], v[152:155], v[132:135], v[56:59]
v_mfma_f32_16x16x32_bf16 v[60:63], v[156:159], v[132:135], v[60:63]
v_mfma_f32_16x16x32_bf16 v[64:67], v[160:163], v[132:135], v[64:67]
v_mfma_f32_16x16x32_bf16 v[68:71], v[164:167], v[132:135], v[68:71]
buffer_load_dwordx4 v[132:135], v1, s[4:7], s33 offen offset:3072
s_mov_b32 s40, 0
v_add_u32 v6, 4096, v6
v_add_u32 v7, 4096, v7
qkvb_loop8:
s_waitcnt vmcnt(12) lgkmcnt(0)
v_mfma_f32_16x16x32_bf16 v[8:11], v[72:75], v[136:139], v[8:11]
ds_read_b128 v[152:155], v6 offset:1024
v_mfma_f32_16x16x32_bf16 v[12:15], v[72:75], v[140:143], v[12:15]
ds_read_b128 v[156:159], v6 offset:21504
v_mfma_f32_16x16x32_bf16 v[16:19], v[72:75], v[144:147], v[16:19]
ds_read_b128 v[160:163], v7 offset:1024
v_mfma_f32_16x16x32_bf16 v[20:23], v[72:75], v[148:151], v[20:23]
ds_read_b128 v[164:167], v7 offset:21504
s_add_u32 s30, s30, 4096
buffer_load_dwordx4 v[72:75], v1, s[4:7], s30 offen offset:0
v_mfma_f32_16x16x32_bf16 v[24:27], v[76:79], v[136:139], v[24:27]
v_mfma_f32_16x16x32_bf16 v[28:31], v[76:79], v[140:143], v[28:31]
v_mfma_f32_16x16x32_bf16 v[32:35], v[76:79], v[144:147], v[32:35]
v_mfma_f32_16x16x32_bf16 v[36:39], v[76:79], v[148:151], v[36:39]
s_add_u32 s31, s31, 4096
buffer_load_dwordx4 v[76:79], v1, s[4:7], s31 offen offset:0
v_mfma_f32_16x16x32_bf16 v[40:43], v[136:139], v[80:83], v[40:43]
v_mfma_f32_16x16x32_bf16 v[44:47], v[140:143], v[80:83], v[44:47]
v_mfma_f32_16x16x32_bf16 v[48:51], v[144:147], v[80:83], v[48:51]
v_mfma_f32_16x16x32_bf16 v[52:55], v[148:151], v[80:83], v[52:55]
s_add_u32 s32, s32, 4096
buffer_load_dwordx4 v[80:83], v1, s[4:7], s32 offen offset:0
v_mfma_f32_16x16x32_bf16 v[56:59], v[136:139], v[84:87], v[56:59]
v_mfma_f32_16x16x32_bf16 v[60:63], v[140:143], v[84:87], v[60:63]
v_mfma_f32_16x16x32_bf16 v[64:67], v[144:147], v[84:87], v[64:67]
v_mfma_f32_16x16x32_bf16 v[68:71], v[148:151], v[84:87], v[68:71]
s_add_u32 s33, s33, 4096
buffer_load_dwordx4 v[84:87], v1, s[4:7], s33 offen offset:0
s_waitcnt vmcnt(12) lgkmcnt(0)
v_mfma_f32_16x16x32_bf16 v[8:11], v[88:91], v[152:155], v[8:11]
ds_read_b128 v[136:139], v6 offset:2048
v_mfma_f32_16x16x32_bf16 v[12:15], v[88:91], v[156:159], v[12:15]
ds_read_b128 v[140:143], v6 offset:22528
v_mfma_f32_16x16x32_bf16 v[16:19], v[88:91], v[160:163], v[16:19]
ds_read_b128 v[144:147], v7 offset:2048
v_mfma_f32_16x16x32_bf16 v[20:23], v[88:91], v[164:167], v[20:23]
ds_read_b128 v[148:151], v7 offset:22528
buffer_load_dwordx4 v[88:91], v1, s[4:7], s30 offen offset:1024
v_mfma_f32_16x16x32_bf16 v[24:27], v[92:95], v[152:155], v[24:27]
v_mfma_f32_16x16x32_bf16 v[28:31], v[92:95], v[156:159], v[28:31]
v_mfma_f32_16x16x32_bf16 v[32:35], v[92:95], v[160:163], v[32:35]
v_mfma_f32_16x16x32_bf16 v[36:39], v[92:95], v[164:167], v[36:39]
buffer_load_dwordx4 v[92:95], v1, s[4:7], s31 offen offset:1024
v_mfma_f32_16x16x32_bf16 v[40:43], v[152:155], v[96:99], v[40:43]
v_mfma_f32_16x16x32_bf16 v[44:47], v[156:159], v[96:99], v[44:47]
v_mfma_f32_16x16x32_bf16 v[48:51], v[160:163], v[96:99], v[48:51]
v_mfma_f32_16x16x32_bf16 v[52:55], v[164:167], v[96:99], v[52:55]
buffer_load_dwordx4 v[96:99], v1, s[4:7], s32 offen offset:1024
v_mfma_f32_16x16x32_bf16 v[56:59], v[152:155], v[100:103], v[56:59]
v_mfma_f32_16x16x32_bf16 v[60:63], v[156:159], v[100:103], v[60:63]
v_mfma_f32_16x16x32_bf16 v[64:67], v[160:163], v[100:103], v[64:67]
v_mfma_f32_16x16x32_bf16 v[68:71], v[164:167], v[100:103], v[68:71]
buffer_load_dwordx4 v[100:103], v1, s[4:7], s33 offen offset:1024
s_waitcnt vmcnt(12) lgkmcnt(0)
v_mfma_f32_16x16x32_bf16 v[8:11], v[104:107], v[136:139], v[8:11]
ds_read_b128 v[152:155], v6 offset:3072
v_mfma_f32_16x16x32_bf16 v[12:15], v[104:107], v[140:143], v[12:15]
ds_read_b128 v[156:159], v6 offset:23552
v_mfma_f32_16x16x32_bf16 v[16:19], v[104:107], v[144:147], v[16:19]
ds_read_b128 v[160:163], v7 offset:3072
v_mfma_f32_16x16x32_bf16 v[20:23], v[104:107], v[148:151], v[20:23]
ds_read_b128 v[164:167], v7 offset:23552
buffer_load_dwordx4 v[104:107], v1, s[4:7], s30 offen offset:2048
v_mfma_f32_16x16x32_bf16 v[24:27], v[108:111], v[136:139], v[24:27]
v_mfma_f32_16x16x32_bf16 v[28:31], v[108:111], v[140:143], v[28:31]
v_mfma_f32_16x16x32_bf16 v[32:35], v[108:111], v[144:147], v[32:35]
v_mfma_f32_16x16x32_bf16 v[36:39], v[108:111], v[148:151], v[36:39]
buffer_load_dwordx4 v[108:111], v1, s[4:7], s31 offen offset:2048
v_mfma_f32_16x16x32_bf16 v[40:43], v[136:139], v[112:115], v[40:43]
v_mfma_f32_16x16x32_bf16 v[44:47], v[140:143], v[112:115], v[44:47]
v_mfma_f32_16x16x32_bf16 v[48:51], v[144:147], v[112:115], v[48:51]
v_mfma_f32_16x16x32_bf16 v[52:55], v[148:151], v[112:115], v[52:55]
buffer_load_dwordx4 v[112:115], v1, s[4:7], s32 offen offset:2048
v_mfma_f32_16x16x32_bf16 v[56:59], v[136:139], v[116:119], v[56:59]
v_mfma_f32_16x16x32_bf16 v[60:63], v[140:143], v[116:119], v[60:63]
v_mfma_f32_16x16x32_bf16 v[64:67], v[144:147], v[116:119], v[64:67]
v_mfma_f32_16x16x32_bf16 v[68:71], v[148:151], v[116:119], v[68:71]
buffer_load_dwordx4 v[116:119], v1, s[4:7], s33 offen offset:2048
s_waitcnt vmcnt(12) lgkmcnt(0)
v_mfma_f32_16x16x32_bf16 v[8:11], v[120:123], v[152:155], v[8:11]
ds_read_b128 v[136:139], v6 offset:4096
v_mfma_f32_16x16x32_bf16 v[12:15], v[120:123], v[156:159], v[12:15]
ds_read_b128 v[140:143], v6 offset:24576
v_mfma_f32_16x16x32_bf16 v[16:19], v[120:123], v[160:163], v[16:19]
ds_read_b128 v[144:147], v7 offset:4096
v_mfma_f32_16x16x32_bf16 v[20:23], v[120:123], v[164:167], v[20:23]
ds_read_b128 v[148:151], v7 offset:24576
buffer_load_dwordx4 v[120:123], v1, s[4:7], s30 offen offset:3072
v_mfma_f32_16x16x32_bf16 v[24:27], v[124:127], v[152:155], v[24:27]
v_mfma_f32_16x16x32_bf16 v[28:31], v[124:127], v[156:159], v[28:31]
v_mfma_f32_16x16x32_bf16 v[32:35], v[124:127], v[160:163], v[32:35]
v_mfma_f32_16x16x32_bf16 v[36:39], v[124:127], v[164:167], v[36:39]
buffer_load_dwordx4 v[124:127], v1, s[4:7], s31 offen offset:3072
v_mfma_f32_16x16x32_bf16 v[40:43], v[152:155], v[128:131], v[40:43]
v_mfma_f32_16x16x32_bf16 v[44:47], v[156:159], v[128:131], v[44:47]
v_mfma_f32_16x16x32_bf16 v[48:51], v[160:163], v[128:131], v[48:51]
v_mfma_f32_16x16x32_bf16 v[52:55], v[164:167], v[128:131], v[52:55]
buffer_load_dwordx4 v[128:131], v1, s[4:7], s32 offen offset:3072
v_mfma_f32_16x16x32_bf16 v[56:59], v[152:155], v[132:135], v[56:59]
v_mfma_f32_16x16x32_bf16 v[60:63], v[156:159], v[132:135], v[60:63]
v_mfma_f32_16x16x32_bf16 v[64:67], v[160:163], v[132:135], v[64:67]
v_mfma_f32_16x16x32_bf16 v[68:71], v[164:167], v[132:135], v[68:71]
buffer_load_dwordx4 v[132:135], v1, s[4:7], s33 offen offset:3072
v_add_u32 v6, 4096, v6
v_add_u32 v7, 4096, v7
s_add_u32 s40, s40, 1
s_cmp_lt_u32 s40, 4
s_cbranch_scc1 qkvb_loop8
s_waitcnt vmcnt(0) lgkmcnt(0)
v_and_b32 v2, 63, v0
v_and_b32 v3, 15, v2
v_lshrrev_b32 v4, 4, v2
s_lshl_b32 s41, s17, 19
s_lshl_b32 s42, s18, 12
s_add_u32 s41, s41, s42
s_mov_b32 s46, 0x3ea52b5c
s_mov_b32 s47, 0x3ea52b5c
v_lshlrev_b32 v5, 2, v4
v_add_u32 v5, 48, v5
v_mul_u32_u24 v168, 205, v5
v_lshrrev_b32 v168, 12, v168
v_mul_u32_u24 v6, 20, v168
v_sub_u32 v5, v5, v6
v_lshlrev_b32 v168, 17, v168
v_lshrrev_b32 v6, 4, v5
v_lshl_add_u32 v168, v6, 10, v168
v_bfe_u32 v6, v5, 2, 1
v_lshl_add_u32 v168, v6, 9, v168
v_bfe_u32 v6, v5, 3, 1
v_lshl_add_u32 v168, v6, 3, v168
v_lshl_add_u32 v168, v3, 4, v168
v_lshlrev_b32 v5, 2, v4
v_add_u32 v5, 64, v5
v_mul_u32_u24 v169, 205, v5
v_lshrrev_b32 v169, 12, v169
v_mul_u32_u24 v6, 20, v169
v_sub_u32 v5, v5, v6
v_lshlrev_b32 v169, 17, v169
v_lshrrev_b32 v6, 4, v5
v_lshl_add_u32 v169, v6, 10, v169
v_bfe_u32 v6, v5, 2, 1
v_lshl_add_u32 v169, v6, 9, v169
v_bfe_u32 v6, v5, 3, 1
v_lshl_add_u32 v169, v6, 3, v169
v_lshl_add_u32 v169, v3, 4, v169
v_add_u32 v5, 0, v3
v_mul_u32_u24 v170, 205, v5
v_lshrrev_b32 v170, 12, v170
v_mul_u32_u24 v6, 20, v170
v_sub_u32 v5, v5, v6
v_lshlrev_b32 v170, 17, v170
v_lshl_add_u32 v170, v5, 4, v170
v_and_b32 v6, 1, v4
v_lshl_add_u32 v170, v6, 9, v170
v_lshrrev_b32 v6, 1, v4
v_lshl_add_u32 v170, v6, 3, v170
v_add_u32 v5, 16, v3
v_mul_u32_u24 v171, 205, v5
v_lshrrev_b32 v171, 12, v171
v_mul_u32_u24 v6, 20, v171
v_sub_u32 v5, v5, v6
v_lshlrev_b32 v171, 17, v171
v_lshl_add_u32 v171, v5, 4, v171
v_and_b32 v6, 1, v4
v_lshl_add_u32 v171, v6, 9, v171
v_lshrrev_b32 v6, 1, v4
v_lshl_add_u32 v171, v6, 3, v171
v_cvt_pk_bf16_f32 v136, v8, v9
v_cvt_pk_bf16_f32 v137, v10, v11
s_add_u32 s43, s41, 41943040
buffer_store_dwordx2 v[136:137], v168, s[4:7], s43 offen sc1
v_cvt_pk_bf16_f32 v138, v12, v13
v_cvt_pk_bf16_f32 v139, v14, v15
s_add_u32 s43, s41, 41943296
buffer_store_dwordx2 v[138:139], v168, s[4:7], s43 offen sc1
v_cvt_pk_bf16_f32 v140, v16, v17
v_cvt_pk_bf16_f32 v141, v18, v19
s_add_u32 s43, s41, 41945088
buffer_store_dwordx2 v[140:141], v168, s[4:7], s43 offen sc1
v_cvt_pk_bf16_f32 v142, v20, v21
v_cvt_pk_bf16_f32 v143, v22, v23
s_add_u32 s43, s41, 41945344
buffer_store_dwordx2 v[142:143], v168, s[4:7], s43 offen sc1
v_cvt_pk_bf16_f32 v144, v24, v25
v_cvt_pk_bf16_f32 v145, v26, v27
s_add_u32 s43, s41, 41943040
buffer_store_dwordx2 v[144:145], v169, s[4:7], s43 offen sc1
v_cvt_pk_bf16_f32 v146, v28, v29
v_cvt_pk_bf16_f32 v147, v30, v31
s_add_u32 s43, s41, 41943296
buffer_store_dwordx2 v[146:147], v169, s[4:7], s43 offen sc1
v_cvt_pk_bf16_f32 v148, v32, v33
v_cvt_pk_bf16_f32 v149, v34, v35
s_add_u32 s43, s41, 41945088
buffer_store_dwordx2 v[148:149], v169, s[4:7], s43 offen sc1
v_cvt_pk_bf16_f32 v150, v36, v37
v_cvt_pk_bf16_f32 v151, v38, v39
s_add_u32 s43, s41, 41945344
buffer_store_dwordx2 v[150:151], v169, s[4:7], s43 offen sc1
v_cvt_pk_bf16_f32 v136, v40, v41
v_cvt_pk_bf16_f32 v137, v42, v43
s_add_u32 s43, s41, 46137344
buffer_store_dwordx2 v[136:137], v170, s[4:7], s43 offen sc1
v_cvt_pk_bf16_f32 v138, v44, v45
v_cvt_pk_bf16_f32 v139, v46, v47
s_add_u32 s43, s41, 46138368
buffer_store_dwordx2 v[138:139], v170, s[4:7], s43 offen sc1
v_cvt_pk_bf16_f32 v140, v48, v49
v_cvt_pk_bf16_f32 v141, v50, v51
s_add_u32 s43, s41, 46139392
buffer_store_dwordx2 v[140:141], v170, s[4:7], s43 offen sc1
v_cvt_pk_bf16_f32 v142, v52, v53
v_cvt_pk_bf16_f32 v143, v54, v55
s_add_u32 s43, s41, 46140416
buffer_store_dwordx2 v[142:143], v170, s[4:7], s43 offen sc1
v_cvt_pk_bf16_f32 v144, v56, v57
v_cvt_pk_bf16_f32 v145, v58, v59
s_add_u32 s43, s41, 46137344
buffer_store_dwordx2 v[144:145], v171, s[4:7], s43 offen sc1
v_cvt_pk_bf16_f32 v146, v60, v61
v_cvt_pk_bf16_f32 v147, v62, v63
s_add_u32 s43, s41, 46138368
buffer_store_dwordx2 v[146:147], v171, s[4:7], s43 offen sc1
v_cvt_pk_bf16_f32 v148, v64, v65
v_cvt_pk_bf16_f32 v149, v66, v67
s_add_u32 s43, s41, 46139392
buffer_store_dwordx2 v[148:149], v171, s[4:7], s43 offen sc1
v_cvt_pk_bf16_f32 v150, v68, v69
v_cvt_pk_bf16_f32 v151, v70, v71
s_add_u32 s43, s41, 46140416
buffer_store_dwordx2 v[150:151], v171, s[4:7], s43 offen sc1
s_branch qkvb_exit1
qkvb_w3_5:
s_mul_i32 s30, s17, 5
s_add_u32 s30, s30, 82
s_mul_i32 s30, s30, 20480
s_add_u32 s30, s30, 87556096
s_mul_i32 s31, s17, 5
s_add_u32 s31, s31, 83
s_mul_i32 s31, s31, 20480
s_add_u32 s31, s31, 87556096
s_mul_i32 s32, s17, 5
s_add_u32 s32, s32, 84
s_mul_i32 s32, s32, 20480
s_add_u32 s32, s32, 87556096
buffer_load_dwordx4 v[72:75], v1, s[4:7], s30 offen offset:0
buffer_load_dwordx4 v[76:79], v1, s[4:7], s31 offen offset:0
buffer_load_dwordx4 v[80:83], v1, s[4:7], s32 offen offset:0
buffer_load_dwordx4 v[88:91], v1, s[4:7], s30 offen offset:1024
buffer_load_dwordx4 v[92:95], v1, s[4:7], s31 offen offset:1024
buffer_load_dwordx4 v[96:99], v1, s[4:7], s32 offen offset:1024
buffer_load_dwordx4 v[104:107], v1, s[4:7], s30 offen offset:2048
buffer_load_dwordx4 v[108:111], v1, s[4:7], s31 offen offset:2048
buffer_load_dwordx4 v[112:115], v1, s[4:7], s32 offen offset:2048
s_add_u32 m0, s22, 4096
s_add_u32 s23, s21, 4096
buffer_load_dwordx4 v1, s[4:7], s23 offen offset:0 lds
buffer_load_dwordx4 v1, s[4:7], s23 offen offset:1024 lds
buffer_load_dwordx4 v1, s[4:7], s23 offen offset:2048 lds
buffer_load_dwordx4 v1, s[4:7], s23 offen offset:3072 lds
s_add_u32 m0, s22, 8192
s_add_u32 s23, s21, 8192
buffer_load_dwordx4 v1, s[4:7], s23 offen offset:0 lds
buffer_load_dwordx4 v1, s[4:7], s23 offen offset:1024 lds
buffer_load_dwordx4 v1, s[4:7], s23 offen offset:2048 lds
buffer_load_dwordx4 v1, s[4:7], s23 offen offset:3072 lds
s_add_u32 m0, s22, 12288
s_add_u32 s23, s21, 12288
buffer_load_dwordx4 v1, s[4:7], s23 offen offset:0 lds
buffer_load_dwordx4 v1, s[4:7], s23 offen offset:1024 lds
buffer_load_dwordx4 v1, s[4:7], s23 offen offset:2048 lds
buffer_load_dwordx4 v1, s[4:7], s23 offen offset:3072 lds
s_add_u32 m0, s22, 16384
s_add_u32 s23, s21, 16384
buffer_load_dwordx4 v1, s[4:7], s23 offen offset:0 lds
buffer_load_dwordx4 v1, s[4:7], s23 offen offset:1024 lds
buffer_load_dwordx4 v1, s[4:7], s23 offen offset:2048 lds
buffer_load_dwordx4 v1, s[4:7], s23 offen offset:3072 lds
s_waitcnt vmcnt(25)
s_barrier
buffer_load_dwordx4 v[120:123], v1, s[4:7], s30 offen offset:3072
buffer_load_dwordx4 v[124:127], v1, s[4:7], s31 offen offset:3072
buffer_load_dwordx4 v[128:131], v1, s[4:7], s32 offen offset:3072
ds_read_b128 v[136:139], v6 offset:0
ds_read_b128 v[140:143], v6 offset:20480
ds_read_b128 v[144:147], v7 offset:0
ds_read_b128 v[148:151], v7 offset:20480
s_waitcnt vmcnt(25) lgkmcnt(0)
v_mfma_f32_16x16x32_bf16 v[8:11], v[136:139], v[72:75], 0
ds_read_b128 v[152:155], v6 offset:1024
v_mfma_f32_16x16x32_bf16 v[12:15], v[140:143], v[72:75], 0
ds_read_b128 v[156:159], v6 offset:21504
v_mfma_f32_16x16x32_bf16 v[16:19], v[144:147], v[72:75], 0
ds_read_b128 v[160:163], v7 offset:1024
v_mfma_f32_16x16x32_bf16 v[20:23], v[148:151], v[72:75], 0
ds_read_b128 v[164:167], v7 offset:21504
s_add_u32 s30, s30, 4096
buffer_load_dwordx4 v[72:75], v1, s[4:7], s30 offen offset:0
v_mfma_f32_16x16x32_bf16 v[24:27], v[136:139], v[76:79], 0
v_mfma_f32_16x16x32_bf16 v[28:31], v[140:143], v[76:79], 0
v_mfma_f32_16x16x32_bf16 v[32:35], v[144:147], v[76:79], 0
v_mfma_f32_16x16x32_bf16 v[36:39], v[148:151], v[76:79], 0
s_add_u32 s31, s31, 4096
buffer_load_dwordx4 v[76:79], v1, s[4:7], s31 offen offset:0
v_mfma_f32_16x16x32_bf16 v[40:43], v[136:139], v[80:83], 0
v_mfma_f32_16x16x32_bf16 v[44:47], v[140:143], v[80:83], 0
v_mfma_f32_16x16x32_bf16 v[48:51], v[144:147], v[80:83], 0
v_mfma_f32_16x16x32_bf16 v[52:55], v[148:151], v[80:83], 0
s_add_u32 s32, s32, 4096
buffer_load_dwordx4 v[80:83], v1, s[4:7], s32 offen offset:0
s_waitcnt vmcnt(25) lgkmcnt(0)
v_mfma_f32_16x16x32_bf16 v[8:11], v[152:155], v[88:91], v[8:11]
ds_read_b128 v[136:139], v6 offset:2048
v_mfma_f32_16x16x32_bf16 v[12:15], v[156:159], v[88:91], v[12:15]
ds_read_b128 v[140:143], v6 offset:22528
v_mfma_f32_16x16x32_bf16 v[16:19], v[160:163], v[88:91], v[16:19]
ds_read_b128 v[144:147], v7 offset:2048
v_mfma_f32_16x16x32_bf16 v[20:23], v[164:167], v[88:91], v[20:23]
ds_read_b128 v[148:151], v7 offset:22528
buffer_load_dwordx4 v[88:91], v1, s[4:7], s30 offen offset:1024
v_mfma_f32_16x16x32_bf16 v[24:27], v[152:155], v[92:95], v[24:27]
v_mfma_f32_16x16x32_bf16 v[28:31], v[156:159], v[92:95], v[28:31]
v_mfma_f32_16x16x32_bf16 v[32:35], v[160:163], v[92:95], v[32:35]
v_mfma_f32_16x16x32_bf16 v[36:39], v[164:167], v[92:95], v[36:39]
buffer_load_dwordx4 v[92:95], v1, s[4:7], s31 offen offset:1024
v_mfma_f32_16x16x32_bf16 v[40:43], v[152:155], v[96:99], v[40:43]
v_mfma_f32_16x16x32_bf16 v[44:47], v[156:159], v[96:99], v[44:47]
v_mfma_f32_16x16x32_bf16 v[48:51], v[160:163], v[96:99], v[48:51]
v_mfma_f32_16x16x32_bf16 v[52:55], v[164:167], v[96:99], v[52:55]
buffer_load_dwordx4 v[96:99], v1, s[4:7], s32 offen offset:1024
s_waitcnt vmcnt(25) lgkmcnt(0)
v_mfma_f32_16x16x32_bf16 v[8:11], v[136:139], v[104:107], v[8:11]
ds_read_b128 v[152:155], v6 offset:3072
v_mfma_f32_16x16x32_bf16 v[12:15], v[140:143], v[104:107], v[12:15]
ds_read_b128 v[156:159], v6 offset:23552
v_mfma_f32_16x16x32_bf16 v[16:19], v[144:147], v[104:107], v[16:19]
ds_read_b128 v[160:163], v7 offset:3072
v_mfma_f32_16x16x32_bf16 v[20:23], v[148:151], v[104:107], v[20:23]
ds_read_b128 v[164:167], v7 offset:23552
buffer_load_dwordx4 v[104:107], v1, s[4:7], s30 offen offset:2048
v_mfma_f32_16x16x32_bf16 v[24:27], v[136:139], v[108:111], v[24:27]
v_mfma_f32_16x16x32_bf16 v[28:31], v[140:143], v[108:111], v[28:31]
v_mfma_f32_16x16x32_bf16 v[32:35], v[144:147], v[108:111], v[32:35]
v_mfma_f32_16x16x32_bf16 v[36:39], v[148:151], v[108:111], v[36:39]
buffer_load_dwordx4 v[108:111], v1, s[4:7], s31 offen offset:2048
v_mfma_f32_16x16x32_bf16 v[40:43], v[136:139], v[112:115], v[40:43]
v_mfma_f32_16x16x32_bf16 v[44:47], v[140:143], v[112:115], v[44:47]
v_mfma_f32_16x16x32_bf16 v[48:51], v[144:147], v[112:115], v[48:51]
v_mfma_f32_16x16x32_bf16 v[52:55], v[148:151], v[112:115], v[52:55]
buffer_load_dwordx4 v[112:115], v1, s[4:7], s32 offen offset:2048
s_waitcnt vmcnt(9) lgkmcnt(0)
s_barrier
v_mfma_f32_16x16x32_bf16 v[8:11], v[152:155], v[120:123], v[8:11]
ds_read_b128 v[136:139], v6 offset:4096
v_mfma_f32_16x16x32_bf16 v[12:15], v[156:159], v[120:123], v[12:15]
ds_read_b128 v[140:143], v6 offset:24576
v_mfma_f32_16x16x32_bf16 v[16:19], v[160:163], v[120:123], v[16:19]
ds_read_b128 v[144:147], v7 offset:4096
v_mfma_f32_16x16x32_bf16 v[20:23], v[164:167], v[120:123], v[20:23]
ds_read_b128 v[148:151], v7 offset:24576
buffer_load_dwordx4 v[120:123], v1, s[4:7], s30 offen offset:3072
v_mfma_f32_16x16x32_bf16 v[24:27], v[152:155], v[124:127], v[24:27]
v_mfma_f32_16x16x32_bf16 v[28:31], v[156:159], v[124:127], v[28:31]
v_mfma_f32_16x16x32_bf16 v[32:35], v[160:163], v[124:127], v[32:35]
v_mfma_f32_16x16x32_bf16 v[36:39], v[164:167], v[124:127], v[36:39]
buffer_load_dwordx4 v[124:127], v1, s[4:7], s31 offen offset:3072
v_mfma_f32_16x16x32_bf16 v[40:43], v[152:155], v[128:131], v[40:43]
v_mfma_f32_16x16x32_bf16 v[44:47], v[156:159], v[128:131], v[44:47]
v_mfma_f32_16x16x32_bf16 v[48:51], v[160:163], v[128:131], v[48:51]
v_mfma_f32_16x16x32_bf16 v[52:55], v[164:167], v[128:131], v[52:55]
buffer_load_dwordx4 v[128:131], v1, s[4:7], s32 offen offset:3072
s_mov_b32 s40, 0
v_add_u32 v6, 4096, v6
v_add_u32 v7, 4096, v7
qkvb_loop9:
s_waitcnt vmcnt(9) lgkmcnt(0)
v_mfma_f32_16x16x32_bf16 v[8:11], v[136:139], v[72:75], v[8:11]
ds_read_b128 v[152:155], v6 offset:1024
v_mfma_f32_16x16x32_bf16 v[12:15], v[140:143], v[72:75], v[12:15]
ds_read_b128 v[156:159], v6 offset:21504
v_mfma_f32_16x16x32_bf16 v[16:19], v[144:147], v[72:75], v[16:19]
ds_read_b128 v[160:163], v7 offset:1024
v_mfma_f32_16x16x32_bf16 v[20:23], v[148:151], v[72:75], v[20:23]
ds_read_b128 v[164:167], v7 offset:21504
s_add_u32 s30, s30, 4096
buffer_load_dwordx4 v[72:75], v1, s[4:7], s30 offen offset:0
v_mfma_f32_16x16x32_bf16 v[24:27], v[136:139], v[76:79], v[24:27]
v_mfma_f32_16x16x32_bf16 v[28:31], v[140:143], v[76:79], v[28:31]
v_mfma_f32_16x16x32_bf16 v[32:35], v[144:147], v[76:79], v[32:35]
v_mfma_f32_16x16x32_bf16 v[36:39], v[148:151], v[76:79], v[36:39]
s_add_u32 s31, s31, 4096
buffer_load_dwordx4 v[76:79], v1, s[4:7], s31 offen offset:0
v_mfma_f32_16x16x32_bf16 v[40:43], v[136:139], v[80:83], v[40:43]
v_mfma_f32_16x16x32_bf16 v[44:47], v[140:143], v[80:83], v[44:47]
v_mfma_f32_16x16x32_bf16 v[48:51], v[144:147], v[80:83], v[48:51]
v_mfma_f32_16x16x32_bf16 v[52:55], v[148:151], v[80:83], v[52:55]
s_add_u32 s32, s32, 4096
buffer_load_dwordx4 v[80:83], v1, s[4:7], s32 offen offset:0
s_waitcnt vmcnt(9) lgkmcnt(0)
v_mfma_f32_16x16x32_bf16 v[8:11], v[152:155], v[88:91], v[8:11]
ds_read_b128 v[136:139], v6 offset:2048
v_mfma_f32_16x16x32_bf16 v[12:15], v[156:159], v[88:91], v[12:15]
ds_read_b128 v[140:143], v6 offset:22528
v_mfma_f32_16x16x32_bf16 v[16:19], v[160:163], v[88:91], v[16:19]
ds_read_b128 v[144:147], v7 offset:2048
v_mfma_f32_16x16x32_bf16 v[20:23], v[164:167], v[88:91], v[20:23]
ds_read_b128 v[148:151], v7 offset:22528
buffer_load_dwordx4 v[88:91], v1, s[4:7], s30 offen offset:1024
v_mfma_f32_16x16x32_bf16 v[24:27], v[152:155], v[92:95], v[24:27]
v_mfma_f32_16x16x32_bf16 v[28:31], v[156:159], v[92:95], v[28:31]
v_mfma_f32_16x16x32_bf16 v[32:35], v[160:163], v[92:95], v[32:35]
v_mfma_f32_16x16x32_bf16 v[36:39], v[164:167], v[92:95], v[36:39]
buffer_load_dwordx4 v[92:95], v1, s[4:7], s31 offen offset:1024
v_mfma_f32_16x16x32_bf16 v[40:43], v[152:155], v[96:99], v[40:43]
v_mfma_f32_16x16x32_bf16 v[44:47], v[156:159], v[96:99], v[44:47]
v_mfma_f32_16x16x32_bf16 v[48:51], v[160:163], v[96:99], v[48:51]
v_mfma_f32_16x16x32_bf16 v[52:55], v[164:167], v[96:99], v[52:55]
buffer_load_dwordx4 v[96:99], v1, s[4:7], s32 offen offset:1024
s_waitcnt vmcnt(9) lgkmcnt(0)
v_mfma_f32_16x16x32_bf16 v[8:11], v[136:139], v[104:107], v[8:11]
ds_read_b128 v[152:155], v6 offset:3072
v_mfma_f32_16x16x32_bf16 v[12:15], v[140:143], v[104:107], v[12:15]
ds_read_b128 v[156:159], v6 offset:23552
v_mfma_f32_16x16x32_bf16 v[16:19], v[144:147], v[104:107], v[16:19]
ds_read_b128 v[160:163], v7 offset:3072
v_mfma_f32_16x16x32_bf16 v[20:23], v[148:151], v[104:107], v[20:23]
ds_read_b128 v[164:167], v7 offset:23552
buffer_load_dwordx4 v[104:107], v1, s[4:7], s30 offen offset:2048
v_mfma_f32_16x16x32_bf16 v[24:27], v[136:139], v[108:111], v[24:27]
v_mfma_f32_16x16x32_bf16 v[28:31], v[140:143], v[108:111], v[28:31]
v_mfma_f32_16x16x32_bf16 v[32:35], v[144:147], v[108:111], v[32:35]
v_mfma_f32_16x16x32_bf16 v[36:39], v[148:151], v[108:111], v[36:39]
buffer_load_dwordx4 v[108:111], v1, s[4:7], s31 offen offset:2048
v_mfma_f32_16x16x32_bf16 v[40:43], v[136:139], v[112:115], v[40:43]
v_mfma_f32_16x16x32_bf16 v[44:47], v[140:143], v[112:115], v[44:47]
v_mfma_f32_16x16x32_bf16 v[48:51], v[144:147], v[112:115], v[48:51]
v_mfma_f32_16x16x32_bf16 v[52:55], v[148:151], v[112:115], v[52:55]
buffer_load_dwordx4 v[112:115], v1, s[4:7], s32 offen offset:2048
s_waitcnt vmcnt(9) lgkmcnt(0)
v_mfma_f32_16x16x32_bf16 v[8:11], v[152:155], v[120:123], v[8:11]
ds_read_b128 v[136:139], v6 offset:4096
v_mfma_f32_16x16x32_bf16 v[12:15], v[156:159], v[120:123], v[12:15]
ds_read_b128 v[140:143], v6 offset:24576
v_mfma_f32_16x16x32_bf16 v[16:19], v[160:163], v[120:123], v[16:19]
ds_read_b128 v[144:147], v7 offset:4096
v_mfma_f32_16x16x32_bf16 v[20:23], v[164:167], v[120:123], v[20:23]
ds_read_b128 v[148:151], v7 offset:24576
buffer_load_dwordx4 v[120:123], v1, s[4:7], s30 offen offset:3072
v_mfma_f32_16x16x32_bf16 v[24:27], v[152:155], v[124:127], v[24:27]
v_mfma_f32_16x16x32_bf16 v[28:31], v[156:159], v[124:127], v[28:31]
v_mfma_f32_16x16x32_bf16 v[32:35], v[160:163], v[124:127], v[32:35]
v_mfma_f32_16x16x32_bf16 v[36:39], v[164:167], v[124:127], v[36:39]
buffer_load_dwordx4 v[124:127], v1, s[4:7], s31 offen offset:3072
v_mfma_f32_16x16x32_bf16 v[40:43], v[152:155], v[128:131], v[40:43]
v_mfma_f32_16x16x32_bf16 v[44:47], v[156:159], v[128:131], v[44:47]
v_mfma_f32_16x16x32_bf16 v[48:51], v[160:163], v[128:131], v[48:51]
v_mfma_f32_16x16x32_bf16 v[52:55], v[164:167], v[128:131], v[52:55]
buffer_load_dwordx4 v[128:131], v1, s[4:7], s32 offen offset:3072
v_add_u32 v6, 4096, v6
v_add_u32 v7, 4096, v7
s_add_u32 s40, s40, 1
s_cmp_lt_u32 s40, 4
s_cbranch_scc1 qkvb_loop9
s_waitcnt vmcnt(0) lgkmcnt(0)
v_and_b32 v2, 63, v0
v_and_b32 v3, 15, v2
v_lshrrev_b32 v4, 4, v2
s_lshl_b32 s41, s17, 19
s_lshl_b32 s42, s18, 12
s_add_u32 s41, s41, s42
s_mov_b32 s46, 0x3ea52b5c
s_mov_b32 s47, 0x3ea52b5c
v_add_u32 v5, 32, v3
v_mul_u32_u24 v168, 205, v5
v_lshrrev_b32 v168, 12, v168
v_mul_u32_u24 v6, 20, v168
v_sub_u32 v5, v5, v6
v_lshlrev_b32 v168, 17, v168
v_lshl_add_u32 v168, v5, 4, v168
v_and_b32 v6, 1, v4
v_lshl_add_u32 v168, v6, 9, v168
v_lshrrev_b32 v6, 1, v4
v_lshl_add_u32 v168, v6, 3, v168
v_add_u32 v5, 48, v3
v_mul_u32_u24 v169, 205, v5
v_lshrrev_b32 v169, 12, v169
v_mul_u32_u24 v6, 20, v169
v_sub_u32 v5, v5, v6
v_lshlrev_b32 v169, 17, v169
v_lshl_add_u32 v169, v5, 4, v169
v_and_b32 v6, 1, v4
v_lshl_add_u32 v169, v6, 9, v169
v_lshrrev_b32 v6, 1, v4
v_lshl_add_u32 v169, v6, 3, v169
v_add_u32 v5, 64, v3
v_mul_u32_u24 v170, 205, v5
v_lshrrev_b32 v170, 12, v170
v_mul_u32_u24 v6, 20, v170
v_sub_u32 v5, v5, v6
v_lshlrev_b32 v170, 17, v170
v_lshl_add_u32 v170, v5, 4, v170
v_and_b32 v6, 1, v4
v_lshl_add_u32 v170, v6, 9, v170
v_lshrrev_b32 v6, 1, v4
v_lshl_add_u32 v170, v6, 3, v170
v_cvt_pk_bf16_f32 v136, v8, v9
v_cvt_pk_bf16_f32 v137, v10, v11
s_add_u32 s43, s41, 46137344
buffer_store_dwordx2 v[136:137], v168, s[4:7], s43 offen sc1
v_cvt_pk_bf16_f32 v138, v12, v13
v_cvt_pk_bf16_f32 v139, v14, v15
s_add_u32 s43, s41, 46138368
buffer_store_dwordx2 v[138:139], v168, s[4:7], s43 offen sc1
v_cvt_pk_bf16_f32 v140, v16, v17
v_cvt_pk_bf16_f32 v141, v18, v19
s_add_u32 s43, s41, 46139392
buffer_store_dwordx2 v[140:141], v168, s[4:7], s43 offen sc1
v_cvt_pk_bf16_f32 v142, v20, v21
v_cvt_pk_bf16_f32 v143, v22, v23
s_add_u32 s43, s41, 46140416
buffer_store_dwordx2 v[142:143], v168, s[4:7], s43 offen sc1
v_cvt_pk_bf16_f32 v144, v24, v25
v_cvt_pk_bf16_f32 v145, v26, v27
s_add_u32 s43, s41, 46137344
buffer_store_dwordx2 v[144:145], v169, s[4:7], s43 offen sc1
v_cvt_pk_bf16_f32 v146, v28, v29
v_cvt_pk_bf16_f32 v147, v30, v31
s_add_u32 s43, s41, 46138368
buffer_store_dwordx2 v[146:147], v169, s[4:7], s43 offen sc1
v_cvt_pk_bf16_f32 v148, v32, v33
v_cvt_pk_bf16_f32 v149, v34, v35
s_add_u32 s43, s41, 46139392
buffer_store_dwordx2 v[148:149], v169, s[4:7], s43 offen sc1
v_cvt_pk_bf16_f32 v150, v36, v37
v_cvt_pk_bf16_f32 v151, v38, v39
s_add_u32 s43, s41, 46140416
buffer_store_dwordx2 v[150:151], v169, s[4:7], s43 offen sc1
v_cvt_pk_bf16_f32 v136, v40, v41
v_cvt_pk_bf16_f32 v137, v42, v43
s_add_u32 s43, s41, 46137344
buffer_store_dwordx2 v[136:137], v170, s[4:7], s43 offen sc1
v_cvt_pk_bf16_f32 v138, v44, v45
v_cvt_pk_bf16_f32 v139, v46, v47
s_add_u32 s43, s41, 46138368
buffer_store_dwordx2 v[138:139], v170, s[4:7], s43 offen sc1
v_cvt_pk_bf16_f32 v140, v48, v49
v_cvt_pk_bf16_f32 v141, v50, v51
s_add_u32 s43, s41, 46139392
buffer_store_dwordx2 v[140:141], v170, s[4:7], s43 offen sc1
v_cvt_pk_bf16_f32 v142, v52, v53
v_cvt_pk_bf16_f32 v143, v54, v55
s_add_u32 s43, s41, 46140416
buffer_store_dwordx2 v[142:143], v170, s[4:7], s43 offen sc1
v_mov_b32 v72, 0
v_mov_b32 v73, 0
v_mov_b32 v74, 0
v_mov_b32 v75, 0
v_lshlrev_b32 v5, 17, v4
v_lshl_add_u32 v5, v3, 4, v5
v_add_u32 v6, 1032, v5
v_add_u32 v7, 1536, v5
s_add_u32 s43, s41, 37748736
buffer_store_dwordx2 v[72:73], v6, s[4:7], s43 offen sc1
buffer_store_dwordx4 v[72:75], v7, s[4:7], s43 offen sc1
s_add_u32 s43, s41, 37748992
buffer_store_dwordx2 v[72:73], v6, s[4:7], s43 offen sc1
buffer_store_dwordx4 v[72:75], v7, s[4:7], s43 offen sc1
s_add_u32 s43, s41, 37750784
buffer_store_dwordx2 v[72:73], v6, s[4:7], s43 offen sc1
buffer_store_dwordx4 v[72:75], v7, s[4:7], s43 offen sc1
s_add_u32 s43, s41, 37751040
buffer_store_dwordx2 v[72:73], v6, s[4:7], s43 offen sc1
buffer_store_dwordx4 v[72:75], v7, s[4:7], s43 offen sc1
s_add_u32 s43, s41, 41943040
buffer_store_dwordx2 v[72:73], v6, s[4:7], s43 offen sc1
buffer_store_dwordx4 v[72:75], v7, s[4:7], s43 offen sc1
s_add_u32 s43, s41, 41943296
buffer_store_dwordx2 v[72:73], v6, s[4:7], s43 offen sc1
buffer_store_dwordx4 v[72:75], v7, s[4:7], s43 offen sc1
s_add_u32 s43, s41, 41945088
buffer_store_dwordx2 v[72:73], v6, s[4:7], s43 offen sc1
buffer_store_dwordx4 v[72:75], v7, s[4:7], s43 offen sc1
s_add_u32 s43, s41, 41945344
buffer_store_dwordx2 v[72:73], v6, s[4:7], s43 offen sc1
buffer_store_dwordx4 v[72:75], v7, s[4:7], s43 offen sc1
v_and_b32 v6, 1, v4
v_lshlrev_b32 v6, 9, v6
v_add_u32 v5, 20, v3
v_lshl_add_u32 v6, v5, 4, v6
v_lshrrev_b32 v5, 1, v4
v_lshl_add_u32 v6, v5, 17, v6
v_mov_b32 v5, 0x80000000
v_cmp_gt_u32 vcc, 12, v3
s_nop 1
v_cndmask_b32 v6, v5, v6, vcc
v_cmp_eq_u32 vcc, 0, v3
v_mov_b32 v5, 0x3f803f80
s_nop 0
v_cndmask_b32 v76, 0, v5, vcc
v_mov_b32 v77, v76
v_mov_b32 v78, v76
v_mov_b32 v79, v76
s_add_u32 s43, s41, 46137344
buffer_store_dwordx4 v[76:79], v6, s[4:7], s43 offen sc1
s_add_u32 s43, s41, 46138368
buffer_store_dwordx4 v[76:79], v6, s[4:7], s43 offen sc1
s_add_u32 s43, s41, 46139392
buffer_store_dwordx4 v[76:79], v6, s[4:7], s43 offen sc1
s_add_u32 s43, s41, 46140416
buffer_store_dwordx4 v[76:79], v6, s[4:7], s43 offen sc1
s_add_u32 s43, s41, 46399488
buffer_store_dwordx4 v[76:79], v6, s[4:7], s43 offen sc1
s_add_u32 s43, s41, 46400512
buffer_store_dwordx4 v[76:79], v6, s[4:7], s43 offen sc1
s_add_u32 s43, s41, 46401536
buffer_store_dwordx4 v[76:79], v6, s[4:7], s43 offen sc1
s_add_u32 s43, s41, 46402560
buffer_store_dwordx4 v[76:79], v6, s[4:7], s43 offen sc1
s_branch qkvb_exit1
qkvb_exit1:
s_endpgm
.globl attnb_kernel
.p2align 8
.type attnb_kernel,@function
attnb_kernel:
s_cmp_ge_u32 s2, 256
s_cbranch_scc1 attnb_exit1
s_load_dwordx2 s[12:13], s[0:1], 96
v_lshrrev_b32 v2, 6, v0
v_and_b32 v3, 63, v0
s_nop 0
v_readfirstlane_b32 s16, v2
v_lshlrev_b32 v1, 4, v3
s_and_b32 s17, s2, 7
s_lshl_b32 s17, s17, 2
s_lshr_b32 s18, s2, 3
s_and_b32 s19, s18, 3
s_add_u32 s17, s17, s19
s_lshr_b32 s18, s18, 2
s_waitcnt lgkmcnt(0)
s_mov_b32 s4, s12
s_mov_b32 s5, s13
s_mov_b32 s6, 0x10000000
s_mov_b32 s7, 0x20000
s_lshl_b32 s20, s17, 17
s_add_u32 s21, s20, 41943040
s_add_u32 s22, s20, 46137344
s_lshl_b32 s23, s18, 3
s_lshl_b32 s24, s16, 1
s_add_u32 s23, s23, s24
s_lshl_b32 s24, s23, 11
s_add_u32 s24, s24, s20
s_add_u32 s24, s24, 37748736
buffer_load_dwordx4 v[8:11], v1, s[4:7], s24 offen offset:0
buffer_load_dwordx4 v[12:15], v1, s[4:7], s24 offen offset:1024
buffer_load_dwordx4 v[16:19], v1, s[4:7], s24 offen offset:2048
buffer_load_dwordx4 v[20:23], v1, s[4:7], s24 offen offset:3072
s_mov_b32 s25, s21
s_mov_b32 s26, s22
buffer_load_dwordx4 v[136:139], v1, s[4:7], s25 offen
buffer_load_dwordx4 v[140:143], v1, s[4:7], s25 offen offset:1024
buffer_load_dwordx4 v[144:147], v1, s[4:7], s26 offen
buffer_load_dwordx4 v[148:151], v1, s[4:7], s26 offen offset:1024
s_add_u32 s25, s25, 2048
s_add_u32 s26, s26, 2048
s_waitcnt vmcnt(0)
v_mfma_f32_32x32x16_bf16 v[88:103], v[136:139], v[8:11], 0
v_mfma_f32_32x32x16_bf16 v[88:103], v[140:143], v[12:15], v[88:103]
v_mfma_f32_32x32x16_bf16 v[104:119], v[136:139], v[16:19], 0
v_mfma_f32_32x32x16_bf16 v[104:119], v[140:143], v[20:23], v[104:119]
s_nop 9
v_max3_f32 v2, v88, v89, v90
v_max3_f32 v2, v2, v91, v92
v_max3_f32 v2, v2, v93, v94
v_max3_f32 v2, v2, v95, v96
v_max3_f32 v2, v2, v97, v98
v_max3_f32 v2, v2, v99, v100
v_max3_f32 v2, v2, v101, v102
v_max_f32 v2, v2, v103
v_mov_b32 v4, v2
s_nop 1
v_permlane32_swap_b32 v2, v4
v_max_f32 v2, v2, v4
v_sub_f32 v24, 0, v2
v_sub_f32 v25, 0, v2
v_sub_f32 v26, 0, v2
v_sub_f32 v27, 0, v2
v_sub_f32 v28, 0, v2
v_sub_f32 v29, 0, v2
v_sub_f32 v30, 0, v2
v_sub_f32 v31, 0, v2
v_sub_f32 v32, 0, v2
v_sub_f32 v33, 0, v2
v_sub_f32 v34, 0, v2
v_sub_f32 v35, 0, v2
v_sub_f32 v36, 0, v2
v_sub_f32 v37, 0, v2
v_sub_f32 v38, 0, v2
v_sub_f32 v39, 0, v2
v_max3_f32 v3, v104, v105, v106
v_max3_f32 v3, v3, v107, v108
v_max3_f32 v3, v3, v109, v110
v_max3_f32 v3, v3, v111, v112
v_max3_f32 v3, v3, v113, v114
v_max3_f32 v3, v3, v115, v116
v_max3_f32 v3, v3, v117, v118
v_max_f32 v3, v3, v119
v_mov_b32 v4, v3
s_nop 1
v_permlane32_swap_b32 v3, v4
v_max_f32 v3, v3, v4
v_sub_f32 v40, 0, v3
v_sub_f32 v41, 0, v3
v_sub_f32 v42, 0, v3
v_sub_f32 v43, 0, v3
v_sub_f32 v44, 0, v3
v_sub_f32 v45, 0, v3
v_sub_f32 v46, 0, v3
v_sub_f32 v47, 0, v3
v_sub_f32 v48, 0, v3
v_sub_f32 v49, 0, v3
v_sub_f32 v50, 0, v3
v_sub_f32 v51, 0, v3
v_sub_f32 v52, 0, v3
v_sub_f32 v53, 0, v3
v_sub_f32 v54, 0, v3
v_sub_f32 v55, 0, v3
s_mov_b32 s28, 0
attnb_main2:
s_mov_b32 s25, s21
s_mov_b32 s26, s22
buffer_load_dwordx4 v[136:139], v1, s[4:7], s25 offen
buffer_load_dwordx4 v[140:143], v1, s[4:7], s25 offen offset:1024
buffer_load_dwordx4 v[144:147], v1, s[4:7], s26 offen
buffer_load_dwordx4 v[148:151], v1, s[4:7], s26 offen offset:1024
s_add_u32 s25, s25, 2048
s_add_u32 s26, s26, 2048
buffer_load_dwordx4 v[152:155], v1, s[4:7], s25 offen
buffer_load_dwordx4 v[156:159], v1, s[4:7], s25 offen offset:1024
buffer_load_dwordx4 v[160:163], v1, s[4:7], s26 offen
buffer_load_dwordx4 v[164:167], v1, s[4:7], s26 offen offset:1024
s_add_u32 s25, s25, 2048
s_add_u32 s26, s26, 2048
v_mov_b32 v56, 0
v_mov_b32 v57, 0
v_mov_b32 v58, 0
v_mov_b32 v59, 0
v_mov_b32 v60, 0
v_mov_b32 v61, 0
v_mov_b32 v62, 0
v_mov_b32 v63, 0
v_mov_b32 v64, 0
v_mov_b32 v65, 0
v_mov_b32 v66, 0
v_mov_b32 v67, 0
v_mov_b32 v68, 0
v_mov_b32 v69, 0
v_mov_b32 v70, 0
v_mov_b32 v71, 0
v_mov_b32 v72, 0
v_mov_b32 v73, 0
v_mov_b32 v74, 0
v_mov_b32 v75, 0
v_mov_b32 v76, 0
v_mov_b32 v77, 0
v_mov_b32 v78, 0
v_mov_b32 v79, 0
v_mov_b32 v80, 0
v_mov_b32 v81, 0
v_mov_b32 v82, 0
v_mov_b32 v83, 0
v_mov_b32 v84, 0
v_mov_b32 v85, 0
v_mov_b32 v86, 0
v_mov_b32 v87, 0
s_waitcnt vmcnt(4)
v_mfma_f32_32x32x16_bf16 v[88:103], v[136:139], v[8:11], v[24:39]
v_mfma_f32_32x32x8_bf16 v[88:103], v[140:141], v[12:13], v[88:103]
s_waitcnt vmcnt(4)
s_nop 10
v_exp_f32 v88, v88
v_exp_f32 v89, v89
v_exp_f32 v90, v90
v_exp_f32 v91, v91
v_exp_f32 v92, v92
v_exp_f32 v93, v93
buffer_load_dwordx4 v[168:171], v1, s[4:7], s25 offen
v_exp_f32 v94, v94
v_exp_f32 v95, v95
v_mfma_f32_32x32x16_bf16 v[104:119], v[136:139], v[16:19], v[40:55]
v_cvt_pk_bf16_f32 v120, v88, v89
v_cvt_pk_bf16_f32 v121, v90, v91
v_cvt_pk_bf16_f32 v122, v92, v93
v_cvt_pk_bf16_f32 v123, v94, v95
v_exp_f32 v96, v96
v_exp_f32 v97, v97
v_mfma_f32_32x32x8_bf16 v[104:119], v[140:141], v[20:21], v[104:119]
v_exp_f32 v98, v98
v_exp_f32 v99, v99
buffer_load_dwordx2 v[172:173], v1, s[4:7], s25 offen offset:1024
s_add_u32 s25, s25, 2048
v_exp_f32 v100, v100
v_exp_f32 v101, v101
v_mfma_f32_32x32x16_bf16 v[56:71], v[144:147], v[120:123], v[56:71]
v_exp_f32 v102, v102
v_exp_f32 v103, v103
v_cvt_pk_bf16_f32 v124, v96, v97
v_cvt_pk_bf16_f32 v125, v98, v99
v_cvt_pk_bf16_f32 v126, v100, v101
v_cvt_pk_bf16_f32 v127, v102, v103
s_waitcnt vmcnt(4)
v_exp_f32 v104, v104
v_exp_f32 v105, v105
v_exp_f32 v106, v106
v_exp_f32 v107, v107
v_mfma_f32_32x32x16_bf16 v[56:71], v[148:151], v[124:127], v[56:71]
v_exp_f32 v108, v108
v_exp_f32 v109, v109
buffer_load_dwordx4 v[176:179], v1, s[4:7], s26 offen
v_exp_f32 v110, v110
v_exp_f32 v111, v111
v_mfma_f32_32x32x16_bf16 v[88:103], v[152:155], v[8:11], v[24:39]
v_cvt_pk_bf16_f32 v128, v104, v105
v_cvt_pk_bf16_f32 v129, v106, v107
v_cvt_pk_bf16_f32 v130, v108, v109
v_cvt_pk_bf16_f32 v131, v110, v111
v_exp_f32 v112, v112
v_exp_f32 v113, v113
v_mfma_f32_32x32x8_bf16 v[88:103], v[156:157], v[12:13], v[88:103]
v_exp_f32 v114, v114
v_exp_f32 v115, v115
buffer_load_dwordx4 v[180:183], v1, s[4:7], s26 offen offset:1024
s_add_u32 s26, s26, 2048
v_exp_f32 v116, v116
v_exp_f32 v117, v117
v_mfma_f32_32x32x16_bf16 v[72:87], v[144:147], v[128:131], v[72:87]
v_exp_f32 v118, v118
v_exp_f32 v119, v119
v_cvt_pk_bf16_f32 v132, v112, v113
v_cvt_pk_bf16_f32 v133, v114, v115
v_cvt_pk_bf16_f32 v134, v116, v117
v_cvt_pk_bf16_f32 v135, v118, v119
s_mov_b32 s27, 0
attnb_loop3:
s_waitcnt vmcnt(4)
v_exp_f32 v88, v88
v_exp_f32 v89, v89
v_exp_f32 v90, v90
v_exp_f32 v91, v91
v_mfma_f32_32x32x16_bf16 v[72:87], v[148:151], v[132:135], v[72:87]
v_exp_f32 v92, v92
v_exp_f32 v93, v93
buffer_load_dwordx4 v[136:139], v1, s[4:7], s25 offen
v_exp_f32 v94, v94
v_exp_f32 v95, v95
v_mfma_f32_32x32x16_bf16 v[104:119], v[152:155], v[16:19], v[40:55]
v_cvt_pk_bf16_f32 v120, v88, v89
v_cvt_pk_bf16_f32 v121, v90, v91
v_cvt_pk_bf16_f32 v122, v92, v93
v_cvt_pk_bf16_f32 v123, v94, v95
v_exp_f32 v96, v96
v_exp_f32 v97, v97
v_mfma_f32_32x32x8_bf16 v[104:119], v[156:157], v[20:21], v[104:119]
v_exp_f32 v98, v98
v_exp_f32 v99, v99
buffer_load_dwordx2 v[140:141], v1, s[4:7], s25 offen offset:1024
s_add_u32 s25, s25, 2048
v_exp_f32 v100, v100
v_exp_f32 v101, v101
v_mfma_f32_32x32x16_bf16 v[56:71], v[160:163], v[120:123], v[56:71]
v_exp_f32 v102, v102
v_exp_f32 v103, v103
v_cvt_pk_bf16_f32 v124, v96, v97
v_cvt_pk_bf16_f32 v125, v98, v99
v_cvt_pk_bf16_f32 v126, v100, v101
v_cvt_pk_bf16_f32 v127, v102, v103
s_waitcnt vmcnt(4)
v_exp_f32 v104, v104
v_exp_f32 v105, v105
v_exp_f32 v106, v106
v_exp_f32 v107, v107
v_mfma_f32_32x32x16_bf16 v[56:71], v[164:167], v[124:127], v[56:71]
v_exp_f32 v108, v108
v_exp_f32 v109, v109
buffer_load_dwordx4 v[144:147], v1, s[4:7], s26 offen
v_exp_f32 v110, v110
v_exp_f32 v111, v111
v_mfma_f32_32x32x16_bf16 v[88:103], v[168:171], v[8:11], v[24:39]
v_cvt_pk_bf16_f32 v128, v104, v105
v_cvt_pk_bf16_f32 v129, v106, v107
v_cvt_pk_bf16_f32 v130, v108, v109
v_cvt_pk_bf16_f32 v131, v110, v111
v_exp_f32 v112, v112
v_exp_f32 v113, v113
v_mfma_f32_32x32x8_bf16 v[88:103], v[172:173], v[12:13], v[88:103]
v_exp_f32 v114, v114
v_exp_f32 v115, v115
buffer_load_dwordx4 v[148:151], v1, s[4:7], s26 offen offset:1024
s_add_u32 s26, s26, 2048
v_exp_f32 v116, v116
v_exp_f32 v117, v117
v_mfma_f32_32x32x16_bf16 v[72:87], v[160:163], v[128:131], v[72:87]
v_exp_f32 v118, v118
v_exp_f32 v119, v119
v_cvt_pk_bf16_f32 v132, v112, v113
v_cvt_pk_bf16_f32 v133, v114, v115
v_cvt_pk_bf16_f32 v134, v116, v117
v_cvt_pk_bf16_f32 v135, v118, v119
s_waitcnt vmcnt(4)
v_exp_f32 v88, v88
v_exp_f32 v89, v89
v_exp_f32 v90, v90
v_exp_f32 v91, v91
v_mfma_f32_32x32x16_bf16 v[72:87], v[164:167], v[132:135], v[72:87]
v_exp_f32 v92, v92
v_exp_f32 v93, v93
buffer_load_dwordx4 v[152:155], v1, s[4:7], s25 offen
v_exp_f32 v94, v94
v_exp_f32 v95, v95
v_mfma_f32_32x32x16_bf16 v[104:119], v[168:171], v[16:19], v[40:55]
v_cvt_pk_bf16_f32 v120, v88, v89
v_cvt_pk_bf16_f32 v121, v90, v91
v_cvt_pk_bf16_f32 v122, v92, v93
v_cvt_pk_bf16_f32 v123, v94, v95
v_exp_f32 v96, v96
v_exp_f32 v97, v97
v_mfma_f32_32x32x8_bf16 v[104:119], v[172:173], v[20:21], v[104:119]
v_exp_f32 v98, v98
v_exp_f32 v99, v99
buffer_load_dwordx2 v[156:157], v1, s[4:7], s25 offen offset:1024
s_add_u32 s25, s25, 2048
v_exp_f32 v100, v100
v_exp_f32 v101, v101
v_mfma_f32_32x32x16_bf16 v[56:71], v[176:179], v[120:123], v[56:71]
v_exp_f32 v102, v102
v_exp_f32 v103, v103
v_cvt_pk_bf16_f32 v124, v96, v97
v_cvt_pk_bf16_f32 v125, v98, v99
v_cvt_pk_bf16_f32 v126, v100, v101
v_cvt_pk_bf16_f32 v127, v102, v103
s_waitcnt vmcnt(4)
v_exp_f32 v104, v104
v_exp_f32 v105, v105
v_exp_f32 v106, v106
v_exp_f32 v107, v107
v_mfma_f32_32x32x16_bf16 v[56:71], v[180:183], v[124:127], v[56:71]
v_exp_f32 v108, v108
v_exp_f32 v109, v109
buffer_load_dwordx4 v[160:163], v1, s[4:7], s26 offen
v_exp_f32 v110, v110
v_exp_f32 v111, v111
v_mfma_f32_32x32x16_bf16 v[88:103], v[136:139], v[8:11], v[24:39]
v_cvt_pk_bf16_f32 v128, v104, v105
v_cvt_pk_bf16_f32 v129, v106, v107
v_cvt_pk_bf16_f32 v130, v108, v109
v_cvt_pk_bf16_f32 v131, v110, v111
v_exp_f32 v112, v112
v_exp_f32 v113, v113
v_mfma_f32_32x32x8_bf16 v[88:103], v[140:141], v[12:13], v[88:103]
v_exp_f32 v114, v114
v_exp_f32 v115, v115
buffer_load_dwordx4 v[164:167], v1, s[4:7], s26 offen offset:1024
s_add_u32 s26, s26, 2048
v_exp_f32 v116, v116
v_exp_f32 v117, v117
v_mfma_f32_32x32x16_bf16 v[72:87], v[176:179], v[128:131], v[72:87]
v_exp_f32 v118, v118
v_exp_f32 v119, v119
v_cvt_pk_bf16_f32 v132, v112, v113
v_cvt_pk_bf16_f32 v133, v114, v115
v_cvt_pk_bf16_f32 v134, v116, v117
v_cvt_pk_bf16_f32 v135, v118, v119
s_waitcnt vmcnt(4)
v_exp_f32 v88, v88
v_exp_f32 v89, v89
v_exp_f32 v90, v90
v_exp_f32 v91, v91
v_mfma_f32_32x32x16_bf16 v[72:87], v[180:183], v[132:135], v[72:87]
v_exp_f32 v92, v92
v_exp_f32 v93, v93
buffer_load_dwordx4 v[168:171], v1, s[4:7], s25 offen
v_exp_f32 v94, v94
v_exp_f32 v95, v95
v_mfma_f32_32x32x16_bf16 v[104:119], v[136:139], v[16:19], v[40:55]
v_cvt_pk_bf16_f32 v120, v88, v89
v_cvt_pk_bf16_f32 v121, v90, v91
v_cvt_pk_bf16_f32 v122, v92, v93
v_cvt_pk_bf16_f32 v123, v94, v95
v_exp_f32 v96, v96
v_exp_f32 v97, v97
v_mfma_f32_32x32x8_bf16 v[104:119], v[140:141], v[20:21], v[104:119]
v_exp_f32 v98, v98
v_exp_f32 v99, v99
buffer_load_dwordx2 v[172:173], v1, s[4:7], s25 offen offset:1024
s_add_u32 s25, s25, 2048
v_exp_f32 v100, v100
v_exp_f32 v101, v101
v_mfma_f32_32x32x16_bf16 v[56:71], v[144:147], v[120:123], v[56:71]
v_exp_f32 v102, v102
v_exp_f32 v103, v103
v_cvt_pk_bf16_f32 v124, v96, v97
v_cvt_pk_bf16_f32 v125, v98, v99
v_cvt_pk_bf16_f32 v126, v100, v101
v_cvt_pk_bf16_f32 v127, v102, v103
s_waitcnt vmcnt(4)
v_exp_f32 v104, v104
v_exp_f32 v105, v105
v_exp_f32 v106, v106
v_exp_f32 v107, v107
v_mfma_f32_32x32x16_bf16 v[56:71], v[148:151], v[124:127], v[56:71]
v_exp_f32 v108, v108
v_exp_f32 v109, v109
buffer_load_dwordx4 v[176:179], v1, s[4:7], s26 offen
v_exp_f32 v110, v110
v_exp_f32 v111, v111
v_mfma_f32_32x32x16_bf16 v[88:103], v[152:155], v[8:11], v[24:39]
v_cvt_pk_bf16_f32 v128, v104, v105
v_cvt_pk_bf16_f32 v129, v106, v107
v_cvt_pk_bf16_f32 v130, v108, v109
v_cvt_pk_bf16_f32 v131, v110, v111
v_exp_f32 v112, v112
v_exp_f32 v113, v113
v_mfma_f32_32x32x8_bf16 v[88:103], v[156:157], v[12:13], v[88:103]
v_exp_f32 v114, v114
v_exp_f32 v115, v115
buffer_load_dwordx4 v[180:183], v1, s[4:7], s26 offen offset:1024
s_add_u32 s26, s26, 2048
v_exp_f32 v116, v116
v_exp_f32 v117, v117
v_mfma_f32_32x32x16_bf16 v[72:87], v[144:147], v[128:131], v[72:87]
v_exp_f32 v118, v118
v_exp_f32 v119, v119
v_cvt_pk_bf16_f32 v132, v112, v113
v_cvt_pk_bf16_f32 v133, v114, v115
v_cvt_pk_bf16_f32 v134, v116, v117
v_cvt_pk_bf16_f32 v135, v118, v119
s_add_u32 s27, s27, 1
s_cmp_lt_u32 s27, 20
s_cbranch_scc1 attnb_loop3
s_waitcnt vmcnt(4)
v_exp_f32 v88, v88
v_exp_f32 v89, v89
v_exp_f32 v90, v90
v_exp_f32 v91, v91
v_mfma_f32_32x32x16_bf16 v[72:87], v[148:151], v[132:135], v[72:87]
v_exp_f32 v92, v92
v_exp_f32 v93, v93
buffer_load_dwordx4 v[136:139], v1, s[4:7], s25 offen
v_exp_f32 v94, v94
v_exp_f32 v95, v95
v_mfma_f32_32x32x16_bf16 v[104:119], v[152:155], v[16:19], v[40:55]
v_cvt_pk_bf16_f32 v120, v88, v89
v_cvt_pk_bf16_f32 v121, v90, v91
v_cvt_pk_bf16_f32 v122, v92, v93
v_cvt_pk_bf16_f32 v123, v94, v95
v_exp_f32 v96, v96
v_exp_f32 v97, v97
v_mfma_f32_32x32x8_bf16 v[104:119], v[156:157], v[20:21], v[104:119]
v_exp_f32 v98, v98
v_exp_f32 v99, v99
buffer_load_dwordx2 v[140:141], v1, s[4:7], s25 offen offset:1024
s_add_u32 s25, s25, 2048
v_exp_f32 v100, v100
v_exp_f32 v101, v101
v_mfma_f32_32x32x16_bf16 v[56:71], v[160:163], v[120:123], v[56:71]
v_exp_f32 v102, v102
v_exp_f32 v103, v103
v_cvt_pk_bf16_f32 v124, v96, v97
v_cvt_pk_bf16_f32 v125, v98, v99
v_cvt_pk_bf16_f32 v126, v100, v101
v_cvt_pk_bf16_f32 v127, v102, v103
s_waitcnt vmcnt(4)
v_exp_f32 v104, v104
v_exp_f32 v105, v105
v_exp_f32 v106, v106
v_exp_f32 v107, v107
v_mfma_f32_32x32x16_bf16 v[56:71], v[164:167], v[124:127], v[56:71]
v_exp_f32 v108, v108
v_exp_f32 v109, v109
buffer_load_dwordx4 v[144:147], v1, s[4:7], s26 offen
v_exp_f32 v110, v110
v_exp_f32 v111, v111
v_mfma_f32_32x32x16_bf16 v[88:103], v[168:171], v[8:11], v[24:39]
v_cvt_pk_bf16_f32 v128, v104, v105
v_cvt_pk_bf16_f32 v129, v106, v107
v_cvt_pk_bf16_f32 v130, v108, v109
v_cvt_pk_bf16_f32 v131, v110, v111
v_exp_f32 v112, v112
v_exp_f32 v113, v113
v_mfma_f32_32x32x8_bf16 v[88:103], v[172:173], v[12:13], v[88:103]
v_exp_f32 v114, v114
v_exp_f32 v115, v115
buffer_load_dwordx4 v[148:151], v1, s[4:7], s26 offen offset:1024
s_add_u32 s26, s26, 2048
v_exp_f32 v116, v116
v_exp_f32 v117, v117
v_mfma_f32_32x32x16_bf16 v[72:87], v[160:163], v[128:131], v[72:87]
v_exp_f32 v118, v118
v_exp_f32 v119, v119
v_cvt_pk_bf16_f32 v132, v112, v113
v_cvt_pk_bf16_f32 v133, v114, v115
v_cvt_pk_bf16_f32 v134, v116, v117
v_cvt_pk_bf16_f32 v135, v118, v119
s_waitcnt vmcnt(4)
v_exp_f32 v88, v88
v_exp_f32 v89, v89
v_exp_f32 v90, v90
v_exp_f32 v91, v91
v_mfma_f32_32x32x16_bf16 v[72:87], v[164:167], v[132:135], v[72:87]
v_exp_f32 v92, v92
v_exp_f32 v93, v93
v_exp_f32 v94, v94
v_exp_f32 v95, v95
v_mfma_f32_32x32x16_bf16 v[104:119], v[168:171], v[16:19], v[40:55]
v_cvt_pk_bf16_f32 v120, v88, v89
v_cvt_pk_bf16_f32 v121, v90, v91
v_cvt_pk_bf16_f32 v122, v92, v93
v_cvt_pk_bf16_f32 v123, v94, v95
v_exp_f32 v96, v96
v_exp_f32 v97, v97
v_mfma_f32_32x32x8_bf16 v[104:119], v[172:173], v[20:21], v[104:119]
v_exp_f32 v98, v98
v_exp_f32 v99, v99
v_exp_f32 v100, v100
v_exp_f32 v101, v101
v_mfma_f32_32x32x16_bf16 v[56:71], v[176:179], v[120:123], v[56:71]
v_exp_f32 v102, v102
v_exp_f32 v103, v103
v_cvt_pk_bf16_f32 v124, v96, v97
v_cvt_pk_bf16_f32 v125, v98, v99
v_cvt_pk_bf16_f32 v126, v100, v101
v_cvt_pk_bf16_f32 v127, v102, v103
s_waitcnt vmcnt(2)
v_exp_f32 v104, v104
v_exp_f32 v105, v105
v_exp_f32 v106, v106
v_exp_f32 v107, v107
v_mfma_f32_32x32x16_bf16 v[56:71], v[180:183], v[124:127], v[56:71]
v_exp_f32 v108, v108
v_exp_f32 v109, v109
v_exp_f32 v110, v110
v_exp_f32 v111, v111
v_mfma_f32_32x32x16_bf16 v[88:103], v[136:139], v[8:11], v[24:39]
v_cvt_pk_bf16_f32 v128, v104, v105
v_cvt_pk_bf16_f32 v129, v106, v107
v_cvt_pk_bf16_f32 v130, v108, v109
v_cvt_pk_bf16_f32 v131, v110, v111
v_exp_f32 v112, v112
v_exp_f32 v113, v113
v_mfma_f32_32x32x8_bf16 v[88:103], v[140:141], v[12:13], v[88:103]
v_exp_f32 v114, v114
v_exp_f32 v115, v115
v_exp_f32 v116, v116
v_exp_f32 v117, v117
v_mfma_f32_32x32x16_bf16 v[72:87], v[176:179], v[128:131], v[72:87]
v_exp_f32 v118, v118
v_exp_f32 v119, v119
v_cvt_pk_bf16_f32 v132, v112, v113
v_cvt_pk_bf16_f32 v133, v114, v115
v_cvt_pk_bf16_f32 v134, v116, v117
v_cvt_pk_bf16_f32 v135, v118, v119
s_waitcnt vmcnt(0)
v_exp_f32 v88, v88
v_exp_f32 v89, v89
v_exp_f32 v90, v90
v_exp_f32 v91, v91
v_mfma_f32_32x32x16_bf16 v[72:87], v[180:183], v[132:135], v[72:87]
v_exp_f32 v92, v92
v_exp_f32 v93, v93
v_exp_f32 v94, v94
v_exp_f32 v95, v95
v_mfma_f32_32x32x16_bf16 v[104:119], v[136:139], v[16:19], v[40:55]
v_cvt_pk_bf16_f32 v120, v88, v89
v_cvt_pk_bf16_f32 v121, v90, v91
v_cvt_pk_bf16_f32 v122, v92, v93
v_cvt_pk_bf16_f32 v123, v94, v95
v_exp_f32 v96, v96
v_exp_f32 v97, v97
v_mfma_f32_32x32x8_bf16 v[104:119], v[140:141], v[20:21], v[104:119]
v_exp_f32 v98, v98
v_exp_f32 v99, v99
v_exp_f32 v100, v100
v_exp_f32 v101, v101
v_mfma_f32_32x32x16_bf16 v[56:71], v[144:147], v[120:123], v[56:71]
v_exp_f32 v102, v102
v_exp_f32 v103, v103
v_cvt_pk_bf16_f32 v124, v96, v97
v_cvt_pk_bf16_f32 v125, v98, v99
v_cvt_pk_bf16_f32 v126, v100, v101
v_cvt_pk_bf16_f32 v127, v102, v103
s_nop 0
v_exp_f32 v104, v104
v_exp_f32 v105, v105
v_exp_f32 v106, v106
v_exp_f32 v107, v107
v_mfma_f32_32x32x16_bf16 v[56:71], v[148:151], v[124:127], v[56:71]
v_exp_f32 v108, v108
v_exp_f32 v109, v109
v_exp_f32 v110, v110
v_exp_f32 v111, v111
v_cvt_pk_bf16_f32 v128, v104, v105
v_cvt_pk_bf16_f32 v129, v106, v107
v_cvt_pk_bf16_f32 v130, v108, v109
v_cvt_pk_bf16_f32 v131, v110, v111
v_exp_f32 v112, v112
v_exp_f32 v113, v113
v_exp_f32 v114, v114
v_exp_f32 v115, v115
v_exp_f32 v116, v116
v_exp_f32 v117, v117
v_mfma_f32_32x32x16_bf16 v[72:87], v[144:147], v[128:131], v[72:87]
v_exp_f32 v118, v118
v_exp_f32 v119, v119
v_cvt_pk_bf16_f32 v132, v112, v113
v_cvt_pk_bf16_f32 v133, v114, v115
v_cvt_pk_bf16_f32 v134, v116, v117
v_cvt_pk_bf16_f32 v135, v118, v119
s_nop 1
v_mfma_f32_32x32x16_bf16 v[72:87], v[148:151], v[132:135], v[72:87]
v_mov_b32 v2, v64
v_mov_b32 v4, v2
s_nop 1
v_permlane32_swap_b32 v4, v2
s_nop 6
v_mov_b32 v3, v80
v_mov_b32 v4, v3
s_nop 1
v_permlane32_swap_b32 v4, v3
s_cmp_eq_u32 s28, 1
s_cbranch_scc1 attnb_done5
v_max_f32 v4, v2, v3
v_cmp_nge_f32 vcc, 0x4e800000, v4
v_cmp_u_f32 s[30:31], v2, v3
s_nop 3
s_or_b64 s[32:33], vcc, s[30:31]
s_movk_i32 s34, 0x207
v_cmp_class_f32 vcc, v56, s34
s_nop 3
s_or_b64 s[32:33], s[32:33], vcc
v_cmp_class_f32 vcc, v57, s34
s_nop 3
s_or_b64 s[32:33], s[32:33], vcc
v_cmp_class_f32 vcc, v58, s34
s_nop 3
s_or_b64 s[32:33], s[32:33], vcc
v_cmp_class_f32 vcc, v59, s34
s_nop 3
s_or_b64 s[32:33], s[32:33], vcc
v_cmp_class_f32 vcc, v60, s34
s_nop 3
s_or_b64 s[32:33], s[32:33], vcc
v_cmp_class_f32 vcc, v61, s34
s_nop 3
s_or_b64 s[32:33], s[32:33], vcc
v_cmp_class_f32 vcc, v62, s34
s_nop 3
s_or_b64 s[32:33], s[32:33], vcc
v_cmp_class_f32 vcc, v63, s34
s_nop 3
s_or_b64 s[32:33], s[32:33], vcc
v_cmp_class_f32 vcc, v64, s34
s_nop 3
s_or_b64 s[32:33], s[32:33], vcc
v_cmp_class_f32 vcc, v65, s34
s_nop 3
s_or_b64 s[32:33], s[32:33], vcc
v_cmp_class_f32 vcc, v66, s34
s_nop 3
s_or_b64 s[32:33], s[32:33], vcc
v_cmp_class_f32 vcc, v67, s34
s_nop 3
s_or_b64 s[32:33], s[32:33], vcc
v_cmp_class_f32 vcc, v68, s34
s_nop 3
s_or_b64 s[32:33], s[32:33], vcc
v_cmp_class_f32 vcc, v69, s34
s_nop 3
s_or_b64 s[32:33], s[32:33], vcc
v_cmp_class_f32 vcc, v70, s34
s_nop 3
s_or_b64 s[32:33], s[32:33], vcc
v_cmp_class_f32 vcc, v71, s34
s_nop 3
s_or_b64 s[32:33], s[32:33], vcc
v_cmp_class_f32 vcc, v72, s34
s_nop 3
s_or_b64 s[32:33], s[32:33], vcc
v_cmp_class_f32 vcc, v73, s34
s_nop 3
s_or_b64 s[32:33], s[32:33], vcc
v_cmp_class_f32 vcc, v74, s34
s_nop 3
s_or_b64 s[32:33], s[32:33], vcc
v_cmp_class_f32 vcc, v75, s34
s_nop 3
s_or_b64 s[32:33], s[32:33], vcc
v_cmp_class_f32 vcc, v76, s34
s_nop 3
s_or_b64 s[32:33], s[32:33], vcc
v_cmp_class_f32 vcc, v77, s34
s_nop 3
s_or_b64 s[32:33], s[32:33], vcc
v_cmp_class_f32 vcc, v78, s34
s_nop 3
s_or_b64 s[32:33], s[32:33], vcc
v_cmp_class_f32 vcc, v79, s34
s_nop 3
s_or_b64 s[32:33], s[32:33], vcc
v_cmp_class_f32 vcc, v80, s34
s_nop 3
s_or_b64 s[32:33], s[32:33], vcc
v_cmp_class_f32 vcc, v81, s34
s_nop 3
s_or_b64 s[32:33], s[32:33], vcc
v_cmp_class_f32 vcc, v82, s34
s_nop 3
s_or_b64 s[32:33], s[32:33], vcc
v_cmp_class_f32 vcc, v83, s34
s_nop 3
s_or_b64 s[32:33], s[32:33], vcc
v_cmp_class_f32 vcc, v84, s34
s_nop 3
s_or_b64 s[32:33], s[32:33], vcc
v_cmp_class_f32 vcc, v85, s34
s_nop 3
s_or_b64 s[32:33], s[32:33], vcc
v_cmp_class_f32 vcc, v86, s34
s_nop 3
s_or_b64 s[32:33], s[32:33], vcc
v_cmp_class_f32 vcc, v87, s34
s_nop 3
s_or_b64 s[32:33], s[32:33], vcc
s_mov_b64 vcc, s[32:33]
s_cbranch_vccz attnb_done5
s_mov_b32 s25, s21
s_mov_b32 s27, 0
v_mov_b32 v120, 0xff800000
v_mov_b32 v121, 0xff800000
attnb_fb4:
buffer_load_dwordx4 v[136:139], v1, s[4:7], s25 offen
buffer_load_dwordx4 v[140:143], v1, s[4:7], s25 offen offset:1024
s_add_u32 s25, s25, 2048
s_waitcnt vmcnt(0)
v_mfma_f32_32x32x16_bf16 v[88:103], v[136:139], v[8:11], 0
v_mfma_f32_32x32x16_bf16 v[88:103], v[140:143], v[12:15], v[88:103]
v_mfma_f32_32x32x16_bf16 v[104:119], v[136:139], v[16:19], 0
v_mfma_f32_32x32x16_bf16 v[104:119], v[140:143], v[20:23], v[104:119]
s_nop 9
v_max3_f32 v2, v88, v89, v90
v_max3_f32 v2, v2, v91, v92
v_max3_f32 v2, v2, v93, v94
v_max3_f32 v2, v2, v95, v96
v_max3_f32 v2, v2, v97, v98
v_max3_f32 v2, v2, v99, v100
v_max3_f32 v2, v2, v101, v102
v_max_f32 v2, v2, v103
v_max_f32 v120, v120, v2
s_nop 2
v_max3_f32 v3, v104, v105, v106
v_max3_f32 v3, v3, v107, v108
v_max3_f32 v3, v3, v109, v110
v_max3_f32 v3, v3, v111, v112
v_max3_f32 v3, v3, v113, v114
v_max3_f32 v3, v3, v115, v116
v_max3_f32 v3, v3, v117, v118
v_max_f32 v3, v3, v119
v_max_f32 v121, v121, v3
s_add_u32 s27, s27, 1
s_cmp_lt_u32 s27, 64
s_cbranch_scc1 attnb_fb4
v_mov_b32 v4, v120
s_nop 1
v_permlane32_swap_b32 v120, v4
v_max_f32 v120, v120, v4
v_sub_f32 v24, 0, v120
v_sub_f32 v25, 0, v120
v_sub_f32 v26, 0, v120
v_sub_f32 v27, 0, v120
v_sub_f32 v28, 0, v120
v_sub_f32 v29, 0, v120
v_sub_f32 v30, 0, v120
v_sub_f32 v31, 0, v120
v_sub_f32 v32, 0, v120
v_sub_f32 v33, 0, v120
v_sub_f32 v34, 0, v120
v_sub_f32 v35, 0, v120
v_sub_f32 v36, 0, v120
v_sub_f32 v37, 0, v120
v_sub_f32 v38, 0, v120
v_sub_f32 v39, 0, v120
v_mov_b32 v4, v121
s_nop 1
v_permlane32_swap_b32 v121, v4
v_max_f32 v121, v121, v4
v_sub_f32 v40, 0, v121
v_sub_f32 v41, 0, v121
v_sub_f32 v42, 0, v121
v_sub_f32 v43, 0, v121
v_sub_f32 v44, 0, v121
v_sub_f32 v45, 0, v121
v_sub_f32 v46, 0, v121
v_sub_f32 v47, 0, v121
v_sub_f32 v48, 0, v121
v_sub_f32 v49, 0, v121
v_sub_f32 v50, 0, v121
v_sub_f32 v51, 0, v121
v_sub_f32 v52, 0, v121
v_sub_f32 v53, 0, v121
v_sub_f32 v54, 0, v121
v_sub_f32 v55, 0, v121
s_mov_b32 s28, 1
s_branch attnb_main2
attnb_done5:
v_and_b32 v139, 63, v0
v_lshrrev_b32 v140, 5, v139
v_and_b32 v142, 15, v139
v_lshlrev_b32 v142, 4, v142
v_bfe_u32 v141, v139, 4, 1
v_mul_u32_u24 v141, 20480, v141
v_add_u32 v142, v142, v141
s_mul_i32 s25, s17, 20
v_lshlrev_b32 v140, 2, v140
v_add_u32 v141, s25, v140
v_add_u32 v141, 0, v141
v_lshrrev_b32 v136, 5, v141
v_lshlrev_b32 v136, 10, v136
v_bfe_u32 v139, v141, 3, 2
v_lshl_add_u32 v136, v139, 8, v136
v_bfe_u32 v139, v141, 2, 1
v_lshl_add_u32 v136, v139, 3, v136
v_add_u32 v136, v136, v142
v_add_u32 v141, s25, v140
v_add_u32 v141, 8, v141
v_lshrrev_b32 v137, 5, v141
v_lshlrev_b32 v137, 10, v137
v_bfe_u32 v139, v141, 3, 2
v_lshl_add_u32 v137, v139, 8, v137
v_bfe_u32 v139, v141, 2, 1
v_lshl_add_u32 v137, v139, 3, v137
v_add_u32 v137, v137, v142
v_add_u32 v141, s25, v140
v_add_u32 v141, 16, v141
v_lshrrev_b32 v138, 5, v141
v_lshlrev_b32 v138, 10, v138
v_bfe_u32 v139, v141, 3, 2
v_lshl_add_u32 v138, v139, 8, v138
v_bfe_u32 v139, v141, 2, 1
v_lshl_add_u32 v138, v139, 3, v138
v_add_u32 v138, v138, v142
v_cmp_eq_u32 vcc, 0, v140
v_mov_b32 v139, 0x80000000
s_nop 0
v_cndmask_b32 v138, v139, v138, vcc
s_mul_i32 s24, s23, 40960
s_add_u32 s24, s24, 50331648
v_rcp_f32 v4, v2
s_nop 0
v_mul_f32 v56, v56, v4
v_mul_f32 v57, v57, v4
v_mul_f32 v58, v58, v4
v_mul_f32 v59, v59, v4
v_mul_f32 v60, v60, v4
v_mul_f32 v61, v61, v4
v_mul_f32 v62, v62, v4
v_mul_f32 v63, v63, v4
v_mul_f32 v64, v64, v4
v_mul_f32 v65, v65, v4
v_mul_f32 v66, v66, v4
v_mul_f32 v67, v67, v4
v_cvt_pk_bf16_f32 v120, v56, v57
v_cvt_pk_bf16_f32 v121, v58, v59
v_cvt_pk_bf16_f32 v122, v60, v61
v_cvt_pk_bf16_f32 v123, v62, v63
v_cvt_pk_bf16_f32 v124, v64, v65
v_cvt_pk_bf16_f32 v125, v66, v67
buffer_store_dwordx2 v[120:121], v136, s[4:7], s24 offen sc1
buffer_store_dwordx2 v[122:123], v137, s[4:7], s24 offen sc1
buffer_store_dwordx2 v[124:125], v138, s[4:7], s24 offen sc1
v_rcp_f32 v4, v3
s_nop 0
v_mul_f32 v72, v72, v4
v_mul_f32 v73, v73, v4
v_mul_f32 v74, v74, v4
v_mul_f32 v75, v75, v4
v_mul_f32 v76, v76, v4
v_mul_f32 v77, v77, v4
v_mul_f32 v78, v78, v4
v_mul_f32 v79, v79, v4
v_mul_f32 v80, v80, v4
v_mul_f32 v81, v81, v4
v_mul_f32 v82, v82, v4
v_mul_f32 v83, v83, v4
v_cvt_pk_bf16_f32 v128, v72, v73
v_cvt_pk_bf16_f32 v129, v74, v75
v_cvt_pk_bf16_f32 v130, v76, v77
v_cvt_pk_bf16_f32 v131, v78, v79
v_cvt_pk_bf16_f32 v132, v80, v81
v_cvt_pk_bf16_f32 v133, v82, v83
s_add_u32 s24, s24, 40960
buffer_store_dwordx2 v[128:129], v136, s[4:7], s24 offen sc1
buffer_store_dwordx2 v[130:131], v137, s[4:7], s24 offen sc1
buffer_store_dwordx2 v[132:133], v138, s[4:7], s24 offen sc1
attnb_exit1:
s_endpgm
.globl outb1_kernel
.p2align 8
.type outb1_kernel,@function
outb1_kernel:
s_cmp_ge_u32 s2, 256
s_cbranch_scc1 outb1_exit1
s_load_dwordx2 s[12:13], s[0:1], 96
s_load_dwordx2 s[14:15], s[0:1], 0
s_load_dwordx2 s[48:49], s[0:1], 80
v_lshrrev_b32 v3, 6, v0
v_and_b32 v4, 63, v0
s_nop 0
v_readfirstlane_b32 s16, v3
v_lshlrev_b32 v1, 4, v4
s_and_b32 s17, s2, 7
s_lshl_b32 s17, s17, 2
s_lshr_b32 s18, s2, 3
s_and_b32 s19, s18, 3
s_add_u32 s17, s17, s19
s_lshr_b32 s18, s18, 2
s_waitcnt lgkmcnt(0)
s_mov_b32 s4, s12
s_mov_b32 s5, s13
s_mov_b32 s6, 0x10000000
s_mov_b32 s7, 0x20000
s_mov_b32 s8, s12
s_mov_b32 s9, s13
s_mov_b32 s10, 0x10000000
s_mov_b32 s11, 0x20000
s_mov_b32 s20, 82313216
s_mov_b32 s52, s48
s_mov_b32 s53, s49
s_mov_b32 s54, 2621440
s_mov_b32 s55, 0x20000
s_mul_i32 s21, s18, 5
s_mul_i32 s21, s21, 20480
s_add_u32 s24, s21, 90013696
s_add_u32 s25, s24, 20480
s_add_u32 s26, s25, 20480
s_add_u32 s27, s26, 20480
s_add_u32 s28, s27, 20480
s_lshl_b32 s21, s17, 2
s_add_u32 s21, s21, s16
s_mul_i32 s22, s21, 20480
s_add_u32 s22, s22, 50331648
s_lshl_b32 s23, s16, 10
v_add_u32 v2, s23, v1
s_mul_i32 s29, s16, 5120
s_add_u32 m0, s29, 0
s_nop 0
buffer_load_dwordx4 v2, s[4:7], s24 offen lds
s_add_u32 m0, s29, 1024
s_nop 0
buffer_load_dwordx4 v2, s[4:7], s25 offen lds
s_add_u32 m0, s29, 2048
s_nop 0
buffer_load_dwordx4 v2, s[4:7], s26 offen lds
s_add_u32 m0, s29, 3072
s_nop 0
buffer_load_dwordx4 v2, s[4:7], s27 offen lds
s_add_u32 m0, s29, 4096
s_nop 0
buffer_load_dwordx4 v2, s[4:7], s28 offen lds
buffer_load_dwordx4 v[32:35], v1, s[4:7], s22 offen offset:0
buffer_load_dwordx4 v[36:39], v1, s[4:7], s22 offen offset:1024
buffer_load_dwordx4 v[40:43], v1, s[4:7], s22 offen offset:2048
buffer_load_dwordx4 v[44:47], v1, s[4:7], s22 offen offset:3072
v_add_u32 v2, 0x1000, v2
s_add_u32 s22, s22, 4096
s_add_u32 m0, s29, 20480
s_nop 0
buffer_load_dwordx4 v2, s[4:7], s24 offen lds
s_add_u32 m0, s29, 21504
s_nop 0
buffer_load_dwordx4 v2, s[4:7], s25 offen lds
s_add_u32 m0, s29, 22528
s_nop 0
buffer_load_dwordx4 v2, s[4:7], s26 offen lds
s_add_u32 m0, s29, 23552
s_nop 0
buffer_load_dwordx4 v2, s[4:7], s27 offen lds
s_add_u32 m0, s29, 24576
s_nop 0
buffer_load_dwordx4 v2, s[4:7], s28 offen lds
buffer_load_dwordx4 v[48:51], v1, s[4:7], s22 offen offset:0
buffer_load_dwordx4 v[52:55], v1, s[4:7], s22 offen offset:1024
buffer_load_dwordx4 v[56:59], v1, s[4:7], s22 offen offset:2048
buffer_load_dwordx4 v[60:63], v1, s[4:7], s22 offen offset:3072
v_add_u32 v2, 0x1000, v2
s_add_u32 s22, s22, 4096
s_waitcnt vmcnt(9)
s_barrier
s_add_u32 m0, s29, 40960
s_nop 0
buffer_load_dwordx4 v2, s[4:7], s24 offen lds
s_add_u32 m0, s29, 41984
s_nop 0
buffer_load_dwordx4 v2, s[4:7], s25 offen lds
s_add_u32 m0, s29, 43008
s_nop 0
buffer_load_dwordx4 v2, s[4:7], s26 offen lds
s_add_u32 m0, s29, 44032
s_nop 0
buffer_load_dwordx4 v2, s[4:7], s27 offen lds
s_add_u32 m0, s29, 45056
s_nop 0
buffer_load_dwordx4 v2, s[4:7], s28 offen lds
buffer_load_dwordx4 v[64:67], v1, s[4:7], s22 offen offset:0
buffer_load_dwordx4 v[68:71], v1, s[4:7], s22 offen offset:1024
buffer_load_dwordx4 v[72:75], v1, s[4:7], s22 offen offset:2048
buffer_load_dwordx4 v[76:79], v1, s[4:7], s22 offen offset:3072
v_add_u32 v2, 0x1000, v2
s_add_u32 s22, s22, 4096
ds_read_b128 v[80:83], v1 offset:0
ds_read_b128 v[84:87], v1 offset:1024
ds_read_b128 v[88:91], v1 offset:2048
ds_read_b128 v[92:95], v1 offset:3072
ds_read_b128 v[96:99], v1 offset:4096
ds_read_b128 v[100:103], v1 offset:5120
ds_read_b128 v[104:107], v1 offset:6144
ds_read_b128 v[108:111], v1 offset:7168
ds_read_b128 v[112:115], v1 offset:8192
ds_read_b128 v[116:119], v1 offset:9216
s_waitcnt lgkmcnt(5)
v_mfma_f32_16x16x32_bf16 v[8:11], v[80:83], v[32:35], 0
v_mfma_f32_16x16x32_bf16 v[12:15], v[84:87], v[32:35], 0
v_mfma_f32_16x16x32_bf16 v[16:19], v[88:91], v[32:35], 0
v_mfma_f32_16x16x32_bf16 v[20:23], v[92:95], v[32:35], 0
v_mfma_f32_16x16x32_bf16 v[24:27], v[96:99], v[32:35], 0
ds_read_b128 v[80:83], v1 offset:10240
ds_read_b128 v[84:87], v1 offset:11264
ds_read_b128 v[88:91], v1 offset:12288
ds_read_b128 v[92:95], v1 offset:13312
ds_read_b128 v[96:99], v1 offset:14336
s_waitcnt lgkmcnt(5)
v_mfma_f32_16x16x32_bf16 v[8:11], v[100:103], v[36:39], v[8:11]
v_mfma_f32_16x16x32_bf16 v[12:15], v[104:107], v[36:39], v[12:15]
v_mfma_f32_16x16x32_bf16 v[16:19], v[108:111], v[36:39], v[16:19]
v_mfma_f32_16x16x32_bf16 v[20:23], v[112:115], v[36:39], v[20:23]
v_mfma_f32_16x16x32_bf16 v[24:27], v[116:119], v[36:39], v[24:27]
ds_read_b128 v[100:103], v1 offset:15360
ds_read_b128 v[104:107], v1 offset:16384
ds_read_b128 v[108:111], v1 offset:17408
ds_read_b128 v[112:115], v1 offset:18432
ds_read_b128 v[116:119], v1 offset:19456
s_waitcnt lgkmcnt(5)
v_mfma_f32_16x16x32_bf16 v[8:11], v[80:83], v[40:43], v[8:11]
v_mfma_f32_16x16x32_bf16 v[12:15], v[84:87], v[40:43], v[12:15]
v_mfma_f32_16x16x32_bf16 v[16:19], v[88:91], v[40:43], v[16:19]
v_mfma_f32_16x16x32_bf16 v[20:23], v[92:95], v[40:43], v[20:23]
v_mfma_f32_16x16x32_bf16 v[24:27], v[96:99], v[40:43], v[24:27]
s_waitcnt lgkmcnt(0)
v_mfma_f32_16x16x32_bf16 v[8:11], v[100:103], v[44:47], v[8:11]
v_mfma_f32_16x16x32_bf16 v[12:15], v[104:107], v[44:47], v[12:15]
v_mfma_f32_16x16x32_bf16 v[16:19], v[108:111], v[44:47], v[16:19]
v_mfma_f32_16x16x32_bf16 v[20:23], v[112:115], v[44:47], v[20:23]
v_mfma_f32_16x16x32_bf16 v[24:27], v[116:119], v[44:47], v[24:27]
s_waitcnt vmcnt(9)
s_barrier
s_add_u32 m0, s29, 0
s_nop 0
buffer_load_dwordx4 v2, s[4:7], s24 offen lds
s_add_u32 m0, s29, 1024
s_nop 0
buffer_load_dwordx4 v2, s[4:7], s25 offen lds
s_add_u32 m0, s29, 2048
s_nop 0
buffer_load_dwordx4 v2, s[4:7], s26 offen lds
s_add_u32 m0, s29, 3072
s_nop 0
buffer_load_dwordx4 v2, s[4:7], s27 offen lds
s_add_u32 m0, s29, 4096
s_nop 0
buffer_load_dwordx4 v2, s[4:7], s28 offen lds
buffer_load_dwordx4 v[32:35], v1, s[4:7], s22 offen offset:0
buffer_load_dwordx4 v[36:39], v1, s[4:7], s22 offen offset:1024
buffer_load_dwordx4 v[40:43], v1, s[4:7], s22 offen offset:2048
buffer_load_dwordx4 v[44:47], v1, s[4:7], s22 offen offset:3072
v_add_u32 v2, 0x1000, v2
s_add_u32 s22, s22, 4096
ds_read_b128 v[80:83], v1 offset:20480
ds_read_b128 v[84:87], v1 offset:21504
ds_read_b128 v[88:91], v1 offset:22528
ds_read_b128 v[92:95], v1 offset:23552
ds_read_b128 v[96:99], v1 offset:24576
ds_read_b128 v[100:103], v1 offset:25600
ds_read_b128 v[104:107], v1 offset:26624
ds_read_b128 v[108:111], v1 offset:27648
ds_read_b128 v[112:115], v1 offset:28672
ds_read_b128 v[116:119], v1 offset:29696
s_waitcnt lgkmcnt(5)
v_mfma_f32_16x16x32_bf16 v[8:11], v[80:83], v[48:51], v[8:11]
v_mfma_f32_16x16x32_bf16 v[12:15], v[84:87], v[48:51], v[12:15]
v_mfma_f32_16x16x32_bf16 v[16:19], v[88:91], v[48:51], v[16:19]
v_mfma_f32_16x16x32_bf16 v[20:23], v[92:95], v[48:51], v[20:23]
v_mfma_f32_16x16x32_bf16 v[24:27], v[96:99], v[48:51], v[24:27]
ds_read_b128 v[80:83], v1 offset:30720
ds_read_b128 v[84:87], v1 offset:31744
ds_read_b128 v[88:91], v1 offset:32768
ds_read_b128 v[92:95], v1 offset:33792
ds_read_b128 v[96:99], v1 offset:34816
s_waitcnt lgkmcnt(5)
v_mfma_f32_16x16x32_bf16 v[8:11], v[100:103], v[52:55], v[8:11]
v_mfma_f32_16x16x32_bf16 v[12:15], v[104:107], v[52:55], v[12:15]
v_mfma_f32_16x16x32_bf16 v[16:19], v[108:111], v[52:55], v[16:19]
v_mfma_f32_16x16x32_bf16 v[20:23], v[112:115], v[52:55], v[20:23]
v_mfma_f32_16x16x32_bf16 v[24:27], v[116:119], v[52:55], v[24:27]
ds_read_b128 v[100:103], v1 offset:35840
ds_read_b128 v[104:107], v1 offset:36864
ds_read_b128 v[108:111], v1 offset:37888
ds_read_b128 v[112:115], v1 offset:38912
ds_read_b128 v[116:119], v1 offset:39936
s_waitcnt lgkmcnt(5)
v_mfma_f32_16x16x32_bf16 v[8:11], v[80:83], v[56:59], v[8:11]
v_mfma_f32_16x16x32_bf16 v[12:15], v[84:87], v[56:59], v[12:15]
v_mfma_f32_16x16x32_bf16 v[16:19], v[88:91], v[56:59], v[16:19]
v_mfma_f32_16x16x32_bf16 v[20:23], v[92:95], v[56:59], v[20:23]
v_mfma_f32_16x16x32_bf16 v[24:27], v[96:99], v[56:59], v[24:27]
s_waitcnt lgkmcnt(0)
v_mfma_f32_16x16x32_bf16 v[8:11], v[100:103], v[60:63], v[8:11]
v_mfma_f32_16x16x32_bf16 v[12:15], v[104:107], v[60:63], v[12:15]
v_mfma_f32_16x16x32_bf16 v[16:19], v[108:111], v[60:63], v[16:19]
v_mfma_f32_16x16x32_bf16 v[20:23], v[112:115], v[60:63], v[20:23]
v_mfma_f32_16x16x32_bf16 v[24:27], v[116:119], v[60:63], v[24:27]
s_waitcnt vmcnt(9)
s_barrier
s_add_u32 m0, s29, 20480
s_nop 0
buffer_load_dwordx4 v2, s[4:7], s24 offen lds
s_add_u32 m0, s29, 21504
s_nop 0
buffer_load_dwordx4 v2, s[4:7], s25 offen lds
s_add_u32 m0, s29, 22528
s_nop 0
buffer_load_dwordx4 v2, s[4:7], s26 offen lds
s_add_u32 m0, s29, 23552
s_nop 0
buffer_load_dwordx4 v2, s[4:7], s27 offen lds
s_add_u32 m0, s29, 24576
s_nop 0
buffer_load_dwordx4 v2, s[4:7], s28 offen lds
buffer_load_dwordx4 v[48:51], v1, s[4:7], s22 offen offset:0
buffer_load_dwordx4 v[52:55], v1, s[4:7], s22 offen offset:1024
buffer_load_dwordx4 v[56:59], v1, s[4:7], s22 offen offset:2048
buffer_load_dwordx4 v[60:63], v1, s[4:7], s22 offen offset:3072
v_add_u32 v2, 0x1000, v2
s_add_u32 s22, s22, 4096
ds_read_b128 v[80:83], v1 offset:40960
ds_read_b128 v[84:87], v1 offset:41984
ds_read_b128 v[88:91], v1 offset:43008
ds_read_b128 v[92:95], v1 offset:44032
ds_read_b128 v[96:99], v1 offset:45056
ds_read_b128 v[100:103], v1 offset:46080
ds_read_b128 v[104:107], v1 offset:47104
ds_read_b128 v[108:111], v1 offset:48128
ds_read_b128 v[112:115], v1 offset:49152
ds_read_b128 v[116:119], v1 offset:50176
s_waitcnt lgkmcnt(5)
v_mfma_f32_16x16x32_bf16 v[8:11], v[80:83], v[64:67], v[8:11]
v_mfma_f32_16x16x32_bf16 v[12:15], v[84:87], v[64:67], v[12:15]
v_mfma_f32_16x16x32_bf16 v[16:19], v[88:91], v[64:67], v[16:19]
v_mfma_f32_16x16x32_bf16 v[20:23], v[92:95], v[64:67], v[20:23]
v_mfma_f32_16x16x32_bf16 v[24:27], v[96:99], v[64:67], v[24:27]
ds_read_b128 v[80:83], v1 offset:51200
ds_read_b128 v[84:87], v1 offset:52224
ds_read_b128 v[88:91], v1 offset:53248
ds_read_b128 v[92:95], v1 offset:54272
ds_read_b128 v[96:99], v1 offset:55296
s_waitcnt lgkmcnt(5)
v_mfma_f32_16x16x32_bf16 v[8:11], v[100:103], v[68:71], v[8:11]
v_mfma_f32_16x16x32_bf16 v[12:15], v[104:107], v[68:71], v[12:15]
v_mfma_f32_16x16x32_bf16 v[16:19], v[108:111], v[68:71], v[16:19]
v_mfma_f32_16x16x32_bf16 v[20:23], v[112:115], v[68:71], v[20:23]
v_mfma_f32_16x16x32_bf16 v[24:27], v[116:119], v[68:71], v[24:27]
ds_read_b128 v[100:103], v1 offset:56320
ds_read_b128 v[104:107], v1 offset:57344
ds_read_b128 v[108:111], v1 offset:58368
ds_read_b128 v[112:115], v1 offset:59392
ds_read_b128 v[116:119], v1 offset:60416
s_waitcnt lgkmcnt(5)
v_mfma_f32_16x16x32_bf16 v[8:11], v[80:83], v[72:75], v[8:11]
v_mfma_f32_16x16x32_bf16 v[12:15], v[84:87], v[72:75], v[12:15]
v_mfma_f32_16x16x32_bf16 v[16:19], v[88:91], v[72:75], v[16:19]
v_mfma_f32_16x16x32_bf16 v[20:23], v[92:95], v[72:75], v[20:23]
v_mfma_f32_16x16x32_bf16 v[24:27], v[96:99], v[72:75], v[24:27]
s_waitcnt lgkmcnt(0)
v_mfma_f32_16x16x32_bf16 v[8:11], v[100:103], v[76:79], v[8:11]
v_mfma_f32_16x16x32_bf16 v[12:15], v[104:107], v[76:79], v[12:15]
v_mfma_f32_16x16x32_bf16 v[16:19], v[108:111], v[76:79], v[16:19]
v_mfma_f32_16x16x32_bf16 v[20:23], v[112:115], v[76:79], v[20:23]
v_mfma_f32_16x16x32_bf16 v[24:27], v[116:119], v[76:79], v[24:27]
s_waitcnt vmcnt(9)
s_barrier
ds_read_b128 v[80:83], v1 offset:0
ds_read_b128 v[84:87], v1 offset:1024
ds_read_b128 v[88:91], v1 offset:2048
ds_read_b128 v[92:95], v1 offset:3072
ds_read_b128 v[96:99], v1 offset:4096
ds_read_b128 v[100:103], v1 offset:5120
ds_read_b128 v[104:107], v1 offset:6144
ds_read_b128 v[108:111], v1 offset:7168
ds_read_b128 v[112:115], v1 offset:8192
ds_read_b128 v[116:119], v1 offset:9216
s_waitcnt lgkmcnt(5)
v_mfma_f32_16x16x32_bf16 v[8:11], v[80:83], v[32:35], v[8:11]
v_mfma_f32_16x16x32_bf16 v[12:15], v[84:87], v[32:35], v[12:15]
v_mfma_f32_16x16x32_bf16 v[16:19], v[88:91], v[32:35], v[16:19]
v_mfma_f32_16x16x32_bf16 v[20:23], v[92:95], v[32:35], v[20:23]
v_mfma_f32_16x16x32_bf16 v[24:27], v[96:99], v[32:35], v[24:27]
ds_read_b128 v[80:83], v1 offset:10240
ds_read_b128 v[84:87], v1 offset:11264
ds_read_b128 v[88:91], v1 offset:12288
ds_read_b128 v[92:95], v1 offset:13312
ds_read_b128 v[96:99], v1 offset:14336
s_waitcnt lgkmcnt(5)
v_mfma_f32_16x16x32_bf16 v[8:11], v[100:103], v[36:39], v[8:11]
v_mfma_f32_16x16x32_bf16 v[12:15], v[104:107], v[36:39], v[12:15]
v_mfma_f32_16x16x32_bf16 v[16:19], v[108:111], v[36:39], v[16:19]
v_mfma_f32_16x16x32_bf16 v[20:23], v[112:115], v[36:39], v[20:23]
v_mfma_f32_16x16x32_bf16 v[24:27], v[116:119], v[36:39], v[24:27]
ds_read_b128 v[100:103], v1 offset:15360
ds_read_b128 v[104:107], v1 offset:16384
ds_read_b128 v[108:111], v1 offset:17408
ds_read_b128 v[112:115], v1 offset:18432
ds_read_b128 v[116:119], v1 offset:19456
s_waitcnt lgkmcnt(5)
v_mfma_f32_16x16x32_bf16 v[8:11], v[80:83], v[40:43], v[8:11]
v_mfma_f32_16x16x32_bf16 v[12:15], v[84:87], v[40:43], v[12:15]
v_mfma_f32_16x16x32_bf16 v[16:19], v[88:91], v[40:43], v[16:19]
v_mfma_f32_16x16x32_bf16 v[20:23], v[92:95], v[40:43], v[20:23]
v_mfma_f32_16x16x32_bf16 v[24:27], v[96:99], v[40:43], v[24:27]
s_waitcnt lgkmcnt(0)
v_mfma_f32_16x16x32_bf16 v[8:11], v[100:103], v[44:47], v[8:11]
v_mfma_f32_16x16x32_bf16 v[12:15], v[104:107], v[44:47], v[12:15]
v_mfma_f32_16x16x32_bf16 v[16:19], v[108:111], v[44:47], v[16:19]
v_mfma_f32_16x16x32_bf16 v[20:23], v[112:115], v[44:47], v[20:23]
v_mfma_f32_16x16x32_bf16 v[24:27], v[116:119], v[44:47], v[24:27]
s_waitcnt vmcnt(0)
s_barrier
ds_read_b128 v[80:83], v1 offset:20480
ds_read_b128 v[84:87], v1 offset:21504
ds_read_b128 v[88:91], v1 offset:22528
ds_read_b128 v[92:95], v1 offset:23552
ds_read_b128 v[96:99], v1 offset:24576
ds_read_b128 v[100:103], v1 offset:25600
ds_read_b128 v[104:107], v1 offset:26624
ds_read_b128 v[108:111], v1 offset:27648
ds_read_b128 v[112:115], v1 offset:28672
ds_read_b128 v[116:119], v1 offset:29696
s_waitcnt lgkmcnt(5)
v_mfma_f32_16x16x32_bf16 v[8:11], v[80:83], v[48:51], v[8:11]
v_mfma_f32_16x16x32_bf16 v[12:15], v[84:87], v[48:51], v[12:15]
v_mfma_f32_16x16x32_bf16 v[16:19], v[88:91], v[48:51], v[16:19]
v_mfma_f32_16x16x32_bf16 v[20:23], v[92:95], v[48:51], v[20:23]
v_mfma_f32_16x16x32_bf16 v[24:27], v[96:99], v[48:51], v[24:27]
ds_read_b128 v[80:83], v1 offset:30720
ds_read_b128 v[84:87], v1 offset:31744
ds_read_b128 v[88:91], v1 offset:32768
ds_read_b128 v[92:95], v1 offset:33792
ds_read_b128 v[96:99], v1 offset:34816
s_waitcnt lgkmcnt(5)
v_mfma_f32_16x16x32_bf16 v[8:11], v[100:103], v[52:55], v[8:11]
v_mfma_f32_16x16x32_bf16 v[12:15], v[104:107], v[52:55], v[12:15]
v_mfma_f32_16x16x32_bf16 v[16:19], v[108:111], v[52:55], v[16:19]
v_mfma_f32_16x16x32_bf16 v[20:23], v[112:115], v[52:55], v[20:23]
v_mfma_f32_16x16x32_bf16 v[24:27], v[116:119], v[52:55], v[24:27]
ds_read_b128 v[100:103], v1 offset:35840
ds_read_b128 v[104:107], v1 offset:36864
ds_read_b128 v[108:111], v1 offset:37888
ds_read_b128 v[112:115], v1 offset:38912
ds_read_b128 v[116:119], v1 offset:39936
s_waitcnt lgkmcnt(5)
v_mfma_f32_16x16x32_bf16 v[8:11], v[80:83], v[56:59], v[8:11]
v_mfma_f32_16x16x32_bf16 v[12:15], v[84:87], v[56:59], v[12:15]
v_mfma_f32_16x16x32_bf16 v[16:19], v[88:91], v[56:59], v[16:19]
v_mfma_f32_16x16x32_bf16 v[20:23], v[92:95], v[56:59], v[20:23]
v_mfma_f32_16x16x32_bf16 v[24:27], v[96:99], v[56:59], v[24:27]
s_waitcnt lgkmcnt(0)
v_mfma_f32_16x16x32_bf16 v[8:11], v[100:103], v[60:63], v[8:11]
v_mfma_f32_16x16x32_bf16 v[12:15], v[104:107], v[60:63], v[12:15]
v_mfma_f32_16x16x32_bf16 v[16:19], v[108:111], v[60:63], v[16:19]
v_mfma_f32_16x16x32_bf16 v[20:23], v[112:115], v[60:63], v[20:23]
v_mfma_f32_16x16x32_bf16 v[24:27], v[116:119], v[60:63], v[24:27]
v_and_b32 v3, 63, v0
v_and_b32 v4, 15, v3
v_lshrrev_b32 v3, 4, v3
s_lshl_b32 s21, s17, 6
s_lshl_b32 s23, s16, 4
s_add_u32 s21, s21, s23
v_add_u32 v4, s21, v4
v_mul_u32_u24 v6, 1280, v4
v_lshl_add_u32 v6, v3, 4, v6
s_mul_i32 s21, s18, 5
s_add_u32 s23, s21, 0
s_lshr_b32 s31, s23, 1
s_lshl_b32 s31, s31, 6
s_and_b32 s23, s23, 1
s_lshl_b32 s23, s23, 3
s_add_u32 s32, s31, s23
s_add_u32 s40, s32, s20
buffer_load_dwordx2 v[32:33], v6, s[8:11], s40 offen
s_add_u32 s23, s21, 1
s_lshr_b32 s31, s23, 1
s_lshl_b32 s31, s31, 6
s_and_b32 s23, s23, 1
s_lshl_b32 s23, s23, 3
s_add_u32 s33, s31, s23
s_add_u32 s41, s33, s20
buffer_load_dwordx2 v[34:35], v6, s[8:11], s41 offen
s_add_u32 s23, s21, 2
s_lshr_b32 s31, s23, 1
s_lshl_b32 s31, s31, 6
s_and_b32 s23, s23, 1
s_lshl_b32 s23, s23, 3
s_add_u32 s34, s31, s23
s_add_u32 s42, s34, s20
buffer_load_dwordx2 v[36:37], v6, s[8:11], s42 offen
s_add_u32 s23, s21, 3
s_lshr_b32 s31, s23, 1
s_lshl_b32 s31, s31, 6
s_and_b32 s23, s23, 1
s_lshl_b32 s23, s23, 3
s_add_u32 s35, s31, s23
s_add_u32 s43, s35, s20
buffer_load_dwordx2 v[38:39], v6, s[8:11], s43 offen
s_add_u32 s23, s21, 4
s_lshr_b32 s31, s23, 1
s_lshl_b32 s31, s31, 6
s_and_b32 s23, s23, 1
s_lshl_b32 s23, s23, 3
s_add_u32 s36, s31, s23
s_add_u32 s44, s36, s20
buffer_load_dwordx2 v[40:41], v6, s[8:11], s44 offen
s_waitcnt vmcnt(0)
v_cvt_pk_bf16_f32 v80, v8, v9
v_cvt_pk_bf16_f32 v81, v10, v11
v_lshlrev_b32 v8, 16, v80
v_and_b32 v9, 0xffff0000, v80
v_lshlrev_b32 v10, 16, v81
v_and_b32 v11, 0xffff0000, v81
v_lshlrev_b32 v82, 16, v32
v_and_b32 v83, 0xffff0000, v32
v_lshlrev_b32 v84, 16, v33
v_and_b32 v85, 0xffff0000, v33
v_add_f32 v8, v8, v82
v_add_f32 v9, v9, v83
v_add_f32 v10, v10, v84
v_add_f32 v11, v11, v85
v_cvt_pk_bf16_f32 v32, v8, v9
v_cvt_pk_bf16_f32 v33, v10, v11
s_add_u32 s23, s32, 82313216
buffer_store_dwordx2 v[32:33], v6, s[4:7], s23 offen sc1
v_cvt_pk_bf16_f32 v80, v12, v13
v_cvt_pk_bf16_f32 v81, v14, v15
v_lshlrev_b32 v12, 16, v80
v_and_b32 v13, 0xffff0000, v80
v_lshlrev_b32 v14, 16, v81
v_and_b32 v15, 0xffff0000, v81
v_lshlrev_b32 v82, 16, v34
v_and_b32 v83, 0xffff0000, v34
v_lshlrev_b32 v84, 16, v35
v_and_b32 v85, 0xffff0000, v35
v_add_f32 v12, v12, v82
v_add_f32 v13, v13, v83
v_add_f32 v14, v14, v84
v_add_f32 v15, v15, v85
v_cvt_pk_bf16_f32 v34, v12, v13
v_cvt_pk_bf16_f32 v35, v14, v15
s_add_u32 s23, s33, 82313216
buffer_store_dwordx2 v[34:35], v6, s[4:7], s23 offen sc1
v_cvt_pk_bf16_f32 v80, v16, v17
v_cvt_pk_bf16_f32 v81, v18, v19
v_lshlrev_b32 v16, 16, v80
v_and_b32 v17, 0xffff0000, v80
v_lshlrev_b32 v18, 16, v81
v_and_b32 v19, 0xffff0000, v81
v_lshlrev_b32 v82, 16, v36
v_and_b32 v83, 0xffff0000, v36
v_lshlrev_b32 v84, 16, v37
v_and_b32 v85, 0xffff0000, v37
v_add_f32 v16, v16, v82
v_add_f32 v17, v17, v83
v_add_f32 v18, v18, v84
v_add_f32 v19, v19, v85
v_cvt_pk_bf16_f32 v36, v16, v17
v_cvt_pk_bf16_f32 v37, v18, v19
s_add_u32 s23, s34, 82313216
buffer_store_dwordx2 v[36:37], v6, s[4:7], s23 offen sc1
v_cvt_pk_bf16_f32 v80, v20, v21
v_cvt_pk_bf16_f32 v81, v22, v23
v_lshlrev_b32 v20, 16, v80
v_and_b32 v21, 0xffff0000, v80
v_lshlrev_b32 v22, 16, v81
v_and_b32 v23, 0xffff0000, v81
v_lshlrev_b32 v82, 16, v38
v_and_b32 v83, 0xffff0000, v38
v_lshlrev_b32 v84, 16, v39
v_and_b32 v85, 0xffff0000, v39
v_add_f32 v20, v20, v82
v_add_f32 v21, v21, v83
v_add_f32 v22, v22, v84
v_add_f32 v23, v23, v85
v_cvt_pk_bf16_f32 v38, v20, v21
v_cvt_pk_bf16_f32 v39, v22, v23
s_add_u32 s23, s35, 82313216
buffer_store_dwordx2 v[38:39], v6, s[4:7], s23 offen sc1
v_cvt_pk_bf16_f32 v80, v24, v25
v_cvt_pk_bf16_f32 v81, v26, v27
v_lshlrev_b32 v24, 16, v80
v_and_b32 v25, 0xffff0000, v80
v_lshlrev_b32 v26, 16, v81
v_and_b32 v27, 0xffff0000, v81
v_lshlrev_b32 v82, 16, v40
v_and_b32 v83, 0xffff0000, v40
v_lshlrev_b32 v84, 16, v41
v_and_b32 v85, 0xffff0000, v41
v_add_f32 v24, v24, v82
v_add_f32 v25, v25, v83
v_add_f32 v26, v26, v84
v_add_f32 v27, v27, v85
v_cvt_pk_bf16_f32 v40, v24, v25
v_cvt_pk_bf16_f32 v41, v26, v27
s_add_u32 s23, s36, 82313216
buffer_store_dwordx2 v[40:41], v6, s[4:7], s23 offen sc1
outb1_exit1:
s_endpgm
.globl outb2_kernel
.p2align 8
.type outb2_kernel,@function
outb2_kernel:
s_cmp_ge_u32 s2, 256
s_cbranch_scc1 outb2_exit1
s_load_dwordx2 s[12:13], s[0:1], 96
s_load_dwordx2 s[14:15], s[0:1], 0
s_load_dwordx2 s[48:49], s[0:1], 80
v_lshrrev_b32 v3, 6, v0
v_and_b32 v4, 63, v0
s_nop 0
v_readfirstlane_b32 s16, v3
v_lshlrev_b32 v1, 4, v4
s_and_b32 s17, s2, 7
s_lshl_b32 s17, s17, 2
s_lshr_b32 s18, s2, 3
s_and_b32 s19, s18, 3
s_add_u32 s17, s17, s19
s_lshr_b32 s18, s18, 2
s_waitcnt lgkmcnt(0)
s_mov_b32 s4, s12
s_mov_b32 s5, s13
s_mov_b32 s6, 0x10000000
s_mov_b32 s7, 0x20000
s_mov_b32 s8, s12
s_mov_b32 s9, s13
s_mov_b32 s10, 0x10000000
s_mov_b32 s11, 0x20000
s_mov_b32 s20, 82313216
s_mov_b32 s52, s48
s_mov_b32 s53, s49
s_mov_b32 s54, 2621440
s_mov_b32 s55, 0x20000
s_mul_i32 s21, s18, 5
s_mul_i32 s21, s21, 20480
s_add_u32 s24, s21, 90013696
s_add_u32 s25, s24, 20480
s_add_u32 s26, s25, 20480
s_add_u32 s27, s26, 20480
s_add_u32 s28, s27, 20480
s_lshl_b32 s21, s17, 2
s_add_u32 s21, s21, s16
s_mul_i32 s22, s21, 20480
s_add_u32 s22, s22, 50331648
s_lshl_b32 s23, s16, 10
v_add_u32 v2, s23, v1
s_mul_i32 s29, s16, 5120
s_add_u32 m0, s29, 0
s_nop 0
buffer_load_dwordx4 v2, s[4:7], s24 offen lds
s_add_u32 m0, s29, 1024
s_nop 0
buffer_load_dwordx4 v2, s[4:7], s25 offen lds
s_add_u32 m0, s29, 2048
s_nop 0
buffer_load_dwordx4 v2, s[4:7], s26 offen lds
s_add_u32 m0, s29, 3072
s_nop 0
buffer_load_dwordx4 v2, s[4:7], s27 offen lds
s_add_u32 m0, s29, 4096
s_nop 0
buffer_load_dwordx4 v2, s[4:7], s28 offen lds
buffer_load_dwordx4 v[32:35], v1, s[4:7], s22 offen offset:0
buffer_load_dwordx4 v[36:39], v1, s[4:7], s22 offen offset:1024
buffer_load_dwordx4 v[40:43], v1, s[4:7], s22 offen offset:2048
buffer_load_dwordx4 v[44:47], v1, s[4:7], s22 offen offset:3072
v_add_u32 v2, 0x1000, v2
s_add_u32 s22, s22, 4096
s_add_u32 m0, s29, 20480
s_nop 0
buffer_load_dwordx4 v2, s[4:7], s24 offen lds
s_add_u32 m0, s29, 21504
s_nop 0
buffer_load_dwordx4 v2, s[4:7], s25 offen lds
s_add_u32 m0, s29, 22528
s_nop 0
buffer_load_dwordx4 v2, s[4:7], s26 offen lds
s_add_u32 m0, s29, 23552
s_nop 0
buffer_load_dwordx4 v2, s[4:7], s27 offen lds
s_add_u32 m0, s29, 24576
s_nop 0
buffer_load_dwordx4 v2, s[4:7], s28 offen lds
buffer_load_dwordx4 v[48:51], v1, s[4:7], s22 offen offset:0
buffer_load_dwordx4 v[52:55], v1, s[4:7], s22 offen offset:1024
buffer_load_dwordx4 v[56:59], v1, s[4:7], s22 offen offset:2048
buffer_load_dwordx4 v[60:63], v1, s[4:7], s22 offen offset:3072
v_add_u32 v2, 0x1000, v2
s_add_u32 s22, s22, 4096
s_waitcnt vmcnt(9)
s_barrier
s_add_u32 m0, s29, 40960
s_nop 0
buffer_load_dwordx4 v2, s[4:7], s24 offen lds
s_add_u32 m0, s29, 41984
s_nop 0
buffer_load_dwordx4 v2, s[4:7], s25 offen lds
s_add_u32 m0, s29, 43008
s_nop 0
buffer_load_dwordx4 v2, s[4:7], s26 offen lds
s_add_u32 m0, s29, 44032
s_nop 0
buffer_load_dwordx4 v2, s[4:7], s27 offen lds
s_add_u32 m0, s29, 45056
s_nop 0
buffer_load_dwordx4 v2, s[4:7], s28 offen lds
buffer_load_dwordx4 v[64:67], v1, s[4:7], s22 offen offset:0
buffer_load_dwordx4 v[68:71], v1, s[4:7], s22 offen offset:1024
buffer_load_dwordx4 v[72:75], v1, s[4:7], s22 offen offset:2048
buffer_load_dwordx4 v[76:79], v1, s[4:7], s22 offen offset:3072
v_add_u32 v2, 0x1000, v2
s_add_u32 s22, s22, 4096
ds_read_b128 v[80:83], v1 offset:0
ds_read_b128 v[84:87], v1 offset:1024
ds_read_b128 v[88:91], v1 offset:2048
ds_read_b128 v[92:95], v1 offset:3072
ds_read_b128 v[96:99], v1 offset:4096
ds_read_b128 v[100:103], v1 offset:5120
ds_read_b128 v[104:107], v1 offset:6144
ds_read_b128 v[108:111], v1 offset:7168
ds_read_b128 v[112:115], v1 offset:8192
ds_read_b128 v[116:119], v1 offset:9216
s_waitcnt lgkmcnt(5)
v_mfma_f32_16x16x32_bf16 v[8:11], v[80:83], v[32:35], 0
v_mfma_f32_16x16x32_bf16 v[12:15], v[84:87], v[32:35], 0
v_mfma_f32_16x16x32_bf16 v[16:19], v[88:91], v[32:35], 0
v_mfma_f32_16x16x32_bf16 v[20:23], v[92:95], v[32:35], 0
v_mfma_f32_16x16x32_bf16 v[24:27], v[96:99], v[32:35], 0
ds_read_b128 v[80:83], v1 offset:10240
ds_read_b128 v[84:87], v1 offset:11264
ds_read_b128 v[88:91], v1 offset:12288
ds_read_b128 v[92:95], v1 offset:13312
ds_read_b128 v[96:99], v1 offset:14336
s_waitcnt lgkmcnt(5)
v_mfma_f32_16x16x32_bf16 v[8:11], v[100:103], v[36:39], v[8:11]
v_mfma_f32_16x16x32_bf16 v[12:15], v[104:107], v[36:39], v[12:15]
v_mfma_f32_16x16x32_bf16 v[16:19], v[108:111], v[36:39], v[16:19]
v_mfma_f32_16x16x32_bf16 v[20:23], v[112:115], v[36:39], v[20:23]
v_mfma_f32_16x16x32_bf16 v[24:27], v[116:119], v[36:39], v[24:27]
ds_read_b128 v[100:103], v1 offset:15360
ds_read_b128 v[104:107], v1 offset:16384
ds_read_b128 v[108:111], v1 offset:17408
ds_read_b128 v[112:115], v1 offset:18432
ds_read_b128 v[116:119], v1 offset:19456
s_waitcnt lgkmcnt(5)
v_mfma_f32_16x16x32_bf16 v[8:11], v[80:83], v[40:43], v[8:11]
v_mfma_f32_16x16x32_bf16 v[12:15], v[84:87], v[40:43], v[12:15]
v_mfma_f32_16x16x32_bf16 v[16:19], v[88:91], v[40:43], v[16:19]
v_mfma_f32_16x16x32_bf16 v[20:23], v[92:95], v[40:43], v[20:23]
v_mfma_f32_16x16x32_bf16 v[24:27], v[96:99], v[40:43], v[24:27]
s_waitcnt lgkmcnt(0)
v_mfma_f32_16x16x32_bf16 v[8:11], v[100:103], v[44:47], v[8:11]
v_mfma_f32_16x16x32_bf16 v[12:15], v[104:107], v[44:47], v[12:15]
v_mfma_f32_16x16x32_bf16 v[16:19], v[108:111], v[44:47], v[16:19]
v_mfma_f32_16x16x32_bf16 v[20:23], v[112:115], v[44:47], v[20:23]
v_mfma_f32_16x16x32_bf16 v[24:27], v[116:119], v[44:47], v[24:27]
s_waitcnt vmcnt(9)
s_barrier
s_add_u32 m0, s29, 0
s_nop 0
buffer_load_dwordx4 v2, s[4:7], s24 offen lds
s_add_u32 m0, s29, 1024
s_nop 0
buffer_load_dwordx4 v2, s[4:7], s25 offen lds
s_add_u32 m0, s29, 2048
s_nop 0
buffer_load_dwordx4 v2, s[4:7], s26 offen lds
s_add_u32 m0, s29, 3072
s_nop 0
buffer_load_dwordx4 v2, s[4:7], s27 offen lds
s_add_u32 m0, s29, 4096
s_nop 0
buffer_load_dwordx4 v2, s[4:7], s28 offen lds
buffer_load_dwordx4 v[32:35], v1, s[4:7], s22 offen offset:0
buffer_load_dwordx4 v[36:39], v1, s[4:7], s22 offen offset:1024
buffer_load_dwordx4 v[40:43], v1, s[4:7], s22 offen offset:2048
buffer_load_dwordx4 v[44:47], v1, s[4:7], s22 offen offset:3072
v_add_u32 v2, 0x1000, v2
s_add_u32 s22, s22, 4096
ds_read_b128 v[80:83], v1 offset:20480
ds_read_b128 v[84:87], v1 offset:21504
ds_read_b128 v[88:91], v1 offset:22528
ds_read_b128 v[92:95], v1 offset:23552
ds_read_b128 v[96:99], v1 offset:24576
ds_read_b128 v[100:103], v1 offset:25600
ds_read_b128 v[104:107], v1 offset:26624
ds_read_b128 v[108:111], v1 offset:27648
ds_read_b128 v[112:115], v1 offset:28672
ds_read_b128 v[116:119], v1 offset:29696
s_waitcnt lgkmcnt(5)
v_mfma_f32_16x16x32_bf16 v[8:11], v[80:83], v[48:51], v[8:11]
v_mfma_f32_16x16x32_bf16 v[12:15], v[84:87], v[48:51], v[12:15]
v_mfma_f32_16x16x32_bf16 v[16:19], v[88:91], v[48:51], v[16:19]
v_mfma_f32_16x16x32_bf16 v[20:23], v[92:95], v[48:51], v[20:23]
v_mfma_f32_16x16x32_bf16 v[24:27], v[96:99], v[48:51], v[24:27]
ds_read_b128 v[80:83], v1 offset:30720
ds_read_b128 v[84:87], v1 offset:31744
ds_read_b128 v[88:91], v1 offset:32768
ds_read_b128 v[92:95], v1 offset:33792
ds_read_b128 v[96:99], v1 offset:34816
s_waitcnt lgkmcnt(5)
v_mfma_f32_16x16x32_bf16 v[8:11], v[100:103], v[52:55], v[8:11]
v_mfma_f32_16x16x32_bf16 v[12:15], v[104:107], v[52:55], v[12:15]
v_mfma_f32_16x16x32_bf16 v[16:19], v[108:111], v[52:55], v[16:19]
v_mfma_f32_16x16x32_bf16 v[20:23], v[112:115], v[52:55], v[20:23]
v_mfma_f32_16x16x32_bf16 v[24:27], v[116:119], v[52:55], v[24:27]
ds_read_b128 v[100:103], v1 offset:35840
ds_read_b128 v[104:107], v1 offset:36864
ds_read_b128 v[108:111], v1 offset:37888
ds_read_b128 v[112:115], v1 offset:38912
ds_read_b128 v[116:119], v1 offset:39936
s_waitcnt lgkmcnt(5)
v_mfma_f32_16x16x32_bf16 v[8:11], v[80:83], v[56:59], v[8:11]
v_mfma_f32_16x16x32_bf16 v[12:15], v[84:87], v[56:59], v[12:15]
v_mfma_f32_16x16x32_bf16 v[16:19], v[88:91], v[56:59], v[16:19]
v_mfma_f32_16x16x32_bf16 v[20:23], v[92:95], v[56:59], v[20:23]
v_mfma_f32_16x16x32_bf16 v[24:27], v[96:99], v[56:59], v[24:27]
s_waitcnt lgkmcnt(0)
v_mfma_f32_16x16x32_bf16 v[8:11], v[100:103], v[60:63], v[8:11]
v_mfma_f32_16x16x32_bf16 v[12:15], v[104:107], v[60:63], v[12:15]
v_mfma_f32_16x16x32_bf16 v[16:19], v[108:111], v[60:63], v[16:19]
v_mfma_f32_16x16x32_bf16 v[20:23], v[112:115], v[60:63], v[20:23]
v_mfma_f32_16x16x32_bf16 v[24:27], v[116:119], v[60:63], v[24:27]
s_waitcnt vmcnt(9)
s_barrier
s_add_u32 m0, s29, 20480
s_nop 0
buffer_load_dwordx4 v2, s[4:7], s24 offen lds
s_add_u32 m0, s29, 21504
s_nop 0
buffer_load_dwordx4 v2, s[4:7], s25 offen lds
s_add_u32 m0, s29, 22528
s_nop 0
buffer_load_dwordx4 v2, s[4:7], s26 offen lds
s_add_u32 m0, s29, 23552
s_nop 0
buffer_load_dwordx4 v2, s[4:7], s27 offen lds
s_add_u32 m0, s29, 24576
s_nop 0
buffer_load_dwordx4 v2, s[4:7], s28 offen lds
buffer_load_dwordx4 v[48:51], v1, s[4:7], s22 offen offset:0
buffer_load_dwordx4 v[52:55], v1, s[4:7], s22 offen offset:1024
buffer_load_dwordx4 v[56:59], v1, s[4:7], s22 offen offset:2048
buffer_load_dwordx4 v[60:63], v1, s[4:7], s22 offen offset:3072
v_add_u32 v2, 0x1000, v2
s_add_u32 s22, s22, 4096
ds_read_b128 v[80:83], v1 offset:40960
ds_read_b128 v[84:87], v1 offset:41984
ds_read_b128 v[88:91], v1 offset:43008
ds_read_b128 v[92:95], v1 offset:44032
ds_read_b128 v[96:99], v1 offset:45056
ds_read_b128 v[100:103], v1 offset:46080
ds_read_b128 v[104:107], v1 offset:47104
ds_read_b128 v[108:111], v1 offset:48128
ds_read_b128 v[112:115], v1 offset:49152
ds_read_b128 v[116:119], v1 offset:50176
s_waitcnt lgkmcnt(5)
v_mfma_f32_16x16x32_bf16 v[8:11], v[80:83], v[64:67], v[8:11]
v_mfma_f32_16x16x32_bf16 v[12:15], v[84:87], v[64:67], v[12:15]
v_mfma_f32_16x16x32_bf16 v[16:19], v[88:91], v[64:67], v[16:19]
v_mfma_f32_16x16x32_bf16 v[20:23], v[92:95], v[64:67], v[20:23]
v_mfma_f32_16x16x32_bf16 v[24:27], v[96:99], v[64:67], v[24:27]
ds_read_b128 v[80:83], v1 offset:51200
ds_read_b128 v[84:87], v1 offset:52224
ds_read_b128 v[88:91], v1 offset:53248
ds_read_b128 v[92:95], v1 offset:54272
ds_read_b128 v[96:99], v1 offset:55296
s_waitcnt lgkmcnt(5)
v_mfma_f32_16x16x32_bf16 v[8:11], v[100:103], v[68:71], v[8:11]
v_mfma_f32_16x16x32_bf16 v[12:15], v[104:107], v[68:71], v[12:15]
v_mfma_f32_16x16x32_bf16 v[16:19], v[108:111], v[68:71], v[16:19]
v_mfma_f32_16x16x32_bf16 v[20:23], v[112:115], v[68:71], v[20:23]
v_mfma_f32_16x16x32_bf16 v[24:27], v[116:119], v[68:71], v[24:27]
ds_read_b128 v[100:103], v1 offset:56320
ds_read_b128 v[104:107], v1 offset:57344
ds_read_b128 v[108:111], v1 offset:58368
ds_read_b128 v[112:115], v1 offset:59392
ds_read_b128 v[116:119], v1 offset:60416
s_waitcnt lgkmcnt(5)
v_mfma_f32_16x16x32_bf16 v[8:11], v[80:83], v[72:75], v[8:11]
v_mfma_f32_16x16x32_bf16 v[12:15], v[84:87], v[72:75], v[12:15]
v_mfma_f32_16x16x32_bf16 v[16:19], v[88:91], v[72:75], v[16:19]
v_mfma_f32_16x16x32_bf16 v[20:23], v[92:95], v[72:75], v[20:23]
v_mfma_f32_16x16x32_bf16 v[24:27], v[96:99], v[72:75], v[24:27]
s_waitcnt lgkmcnt(0)
v_mfma_f32_16x16x32_bf16 v[8:11], v[100:103], v[76:79], v[8:11]
v_mfma_f32_16x16x32_bf16 v[12:15], v[104:107], v[76:79], v[12:15]
v_mfma_f32_16x16x32_bf16 v[16:19], v[108:111], v[76:79], v[16:19]
v_mfma_f32_16x16x32_bf16 v[20:23], v[112:115], v[76:79], v[20:23]
v_mfma_f32_16x16x32_bf16 v[24:27], v[116:119], v[76:79], v[24:27]
s_waitcnt vmcnt(9)
s_barrier
ds_read_b128 v[80:83], v1 offset:0
ds_read_b128 v[84:87], v1 offset:1024
ds_read_b128 v[88:91], v1 offset:2048
ds_read_b128 v[92:95], v1 offset:3072
ds_read_b128 v[96:99], v1 offset:4096
ds_read_b128 v[100:103], v1 offset:5120
ds_read_b128 v[104:107], v1 offset:6144
ds_read_b128 v[108:111], v1 offset:7168
ds_read_b128 v[112:115], v1 offset:8192
ds_read_b128 v[116:119], v1 offset:9216
s_waitcnt lgkmcnt(5)
v_mfma_f32_16x16x32_bf16 v[8:11], v[80:83], v[32:35], v[8:11]
v_mfma_f32_16x16x32_bf16 v[12:15], v[84:87], v[32:35], v[12:15]
v_mfma_f32_16x16x32_bf16 v[16:19], v[88:91], v[32:35], v[16:19]
v_mfma_f32_16x16x32_bf16 v[20:23], v[92:95], v[32:35], v[20:23]
v_mfma_f32_16x16x32_bf16 v[24:27], v[96:99], v[32:35], v[24:27]
ds_read_b128 v[80:83], v1 offset:10240
ds_read_b128 v[84:87], v1 offset:11264
ds_read_b128 v[88:91], v1 offset:12288
ds_read_b128 v[92:95], v1 offset:13312
ds_read_b128 v[96:99], v1 offset:14336
s_waitcnt lgkmcnt(5)
v_mfma_f32_16x16x32_bf16 v[8:11], v[100:103], v[36:39], v[8:11]
v_mfma_f32_16x16x32_bf16 v[12:15], v[104:107], v[36:39], v[12:15]
v_mfma_f32_16x16x32_bf16 v[16:19], v[108:111], v[36:39], v[16:19]
v_mfma_f32_16x16x32_bf16 v[20:23], v[112:115], v[36:39], v[20:23]
v_mfma_f32_16x16x32_bf16 v[24:27], v[116:119], v[36:39], v[24:27]
ds_read_b128 v[100:103], v1 offset:15360
ds_read_b128 v[104:107], v1 offset:16384
ds_read_b128 v[108:111], v1 offset:17408
ds_read_b128 v[112:115], v1 offset:18432
ds_read_b128 v[116:119], v1 offset:19456
s_waitcnt lgkmcnt(5)
v_mfma_f32_16x16x32_bf16 v[8:11], v[80:83], v[40:43], v[8:11]
v_mfma_f32_16x16x32_bf16 v[12:15], v[84:87], v[40:43], v[12:15]
v_mfma_f32_16x16x32_bf16 v[16:19], v[88:91], v[40:43], v[16:19]
v_mfma_f32_16x16x32_bf16 v[20:23], v[92:95], v[40:43], v[20:23]
v_mfma_f32_16x16x32_bf16 v[24:27], v[96:99], v[40:43], v[24:27]
s_waitcnt lgkmcnt(0)
v_mfma_f32_16x16x32_bf16 v[8:11], v[100:103], v[44:47], v[8:11]
v_mfma_f32_16x16x32_bf16 v[12:15], v[104:107], v[44:47], v[12:15]
v_mfma_f32_16x16x32_bf16 v[16:19], v[108:111], v[44:47], v[16:19]
v_mfma_f32_16x16x32_bf16 v[20:23], v[112:115], v[44:47], v[20:23]
v_mfma_f32_16x16x32_bf16 v[24:27], v[116:119], v[44:47], v[24:27]
s_waitcnt vmcnt(0)
s_barrier
ds_read_b128 v[80:83], v1 offset:20480
ds_read_b128 v[84:87], v1 offset:21504
ds_read_b128 v[88:91], v1 offset:22528
ds_read_b128 v[92:95], v1 offset:23552
ds_read_b128 v[96:99], v1 offset:24576
ds_read_b128 v[100:103], v1 offset:25600
ds_read_b128 v[104:107], v1 offset:26624
ds_read_b128 v[108:111], v1 offset:27648
ds_read_b128 v[112:115], v1 offset:28672
ds_read_b128 v[116:119], v1 offset:29696
s_waitcnt lgkmcnt(5)
v_mfma_f32_16x16x32_bf16 v[8:11], v[80:83], v[48:51], v[8:11]
v_mfma_f32_16x16x32_bf16 v[12:15], v[84:87], v[48:51], v[12:15]
v_mfma_f32_16x16x32_bf16 v[16:19], v[88:91], v[48:51], v[16:19]
v_mfma_f32_16x16x32_bf16 v[20:23], v[92:95], v[48:51], v[20:23]
v_mfma_f32_16x16x32_bf16 v[24:27], v[96:99], v[48:51], v[24:27]
ds_read_b128 v[80:83], v1 offset:30720
ds_read_b128 v[84:87], v1 offset:31744
ds_read_b128 v[88:91], v1 offset:32768
ds_read_b128 v[92:95], v1 offset:33792
ds_read_b128 v[96:99], v1 offset:34816
s_waitcnt lgkmcnt(5)
v_mfma_f32_16x16x32_bf16 v[8:11], v[100:103], v[52:55], v[8:11]
v_mfma_f32_16x16x32_bf16 v[12:15], v[104:107], v[52:55], v[12:15]
v_mfma_f32_16x16x32_bf16 v[16:19], v[108:111], v[52:55], v[16:19]
v_mfma_f32_16x16x32_bf16 v[20:23], v[112:115], v[52:55], v[20:23]
v_mfma_f32_16x16x32_bf16 v[24:27], v[116:119], v[52:55], v[24:27]
ds_read_b128 v[100:103], v1 offset:35840
ds_read_b128 v[104:107], v1 offset:36864
ds_read_b128 v[108:111], v1 offset:37888
ds_read_b128 v[112:115], v1 offset:38912
ds_read_b128 v[116:119], v1 offset:39936
s_waitcnt lgkmcnt(5)
v_mfma_f32_16x16x32_bf16 v[8:11], v[80:83], v[56:59], v[8:11]
v_mfma_f32_16x16x32_bf16 v[12:15], v[84:87], v[56:59], v[12:15]
v_mfma_f32_16x16x32_bf16 v[16:19], v[88:91], v[56:59], v[16:19]
v_mfma_f32_16x16x32_bf16 v[20:23], v[92:95], v[56:59], v[20:23]
v_mfma_f32_16x16x32_bf16 v[24:27], v[96:99], v[56:59], v[24:27]
s_waitcnt lgkmcnt(0)
v_mfma_f32_16x16x32_bf16 v[8:11], v[100:103], v[60:63], v[8:11]
v_mfma_f32_16x16x32_bf16 v[12:15], v[104:107], v[60:63], v[12:15]
v_mfma_f32_16x16x32_bf16 v[16:19], v[108:111], v[60:63], v[16:19]
v_mfma_f32_16x16x32_bf16 v[20:23], v[112:115], v[60:63], v[20:23]
v_mfma_f32_16x16x32_bf16 v[24:27], v[116:119], v[60:63], v[24:27]
v_and_b32 v3, 63, v0
v_and_b32 v4, 15, v3
v_lshrrev_b32 v3, 4, v3
s_lshl_b32 s21, s17, 6
s_lshl_b32 s23, s16, 4
s_add_u32 s21, s21, s23
v_add_u32 v4, s21, v4
v_mul_u32_u24 v6, 1280, v4
v_lshl_add_u32 v6, v3, 4, v6
s_mul_i32 s21, s18, 5
s_add_u32 s23, s21, 0
s_lshr_b32 s31, s23, 1
s_lshl_b32 s31, s31, 6
s_and_b32 s23, s23, 1
s_lshl_b32 s23, s23, 3
s_add_u32 s32, s31, s23
s_add_u32 s40, s32, s20
buffer_load_dwordx2 v[32:33], v6, s[8:11], s40 offen
s_add_u32 s23, s21, 1
s_lshr_b32 s31, s23, 1
s_lshl_b32 s31, s31, 6
s_and_b32 s23, s23, 1
s_lshl_b32 s23, s23, 3
s_add_u32 s33, s31, s23
s_add_u32 s41, s33, s20
buffer_load_dwordx2 v[34:35], v6, s[8:11], s41 offen
s_add_u32 s23, s21, 2
s_lshr_b32 s31, s23, 1
s_lshl_b32 s31, s31, 6
s_and_b32 s23, s23, 1
s_lshl_b32 s23, s23, 3
s_add_u32 s34, s31, s23
s_add_u32 s42, s34, s20
buffer_load_dwordx2 v[36:37], v6, s[8:11], s42 offen
s_add_u32 s23, s21, 3
s_lshr_b32 s31, s23, 1
s_lshl_b32 s31, s31, 6
s_and_b32 s23, s23, 1
s_lshl_b32 s23, s23, 3
s_add_u32 s35, s31, s23
s_add_u32 s43, s35, s20
buffer_load_dwordx2 v[38:39], v6, s[8:11], s43 offen
s_add_u32 s23, s21, 4
s_lshr_b32 s31, s23, 1
s_lshl_b32 s31, s31, 6
s_and_b32 s23, s23, 1
s_lshl_b32 s23, s23, 3
s_add_u32 s36, s31, s23
s_add_u32 s44, s36, s20
buffer_load_dwordx2 v[40:41], v6, s[8:11], s44 offen
s_waitcnt vmcnt(0)
v_cvt_pk_bf16_f32 v80, v8, v9
v_cvt_pk_bf16_f32 v81, v10, v11
v_lshlrev_b32 v8, 16, v80
v_and_b32 v9, 0xffff0000, v80
v_lshlrev_b32 v10, 16, v81
v_and_b32 v11, 0xffff0000, v81
v_lshlrev_b32 v82, 16, v32
v_and_b32 v83, 0xffff0000, v32
v_lshlrev_b32 v84, 16, v33
v_and_b32 v85, 0xffff0000, v33
v_add_f32 v8, v8, v82
v_add_f32 v9, v9, v83
v_add_f32 v10, v10, v84
v_add_f32 v11, v11, v85
v_cvt_pk_bf16_f32 v32, v8, v9
v_cvt_pk_bf16_f32 v33, v10, v11
buffer_store_dwordx2 v[32:33], v6, s[52:55], s32 offen sc1
v_cvt_pk_bf16_f32 v80, v12, v13
v_cvt_pk_bf16_f32 v81, v14, v15
v_lshlrev_b32 v12, 16, v80
v_and_b32 v13, 0xffff0000, v80
v_lshlrev_b32 v14, 16, v81
v_and_b32 v15, 0xffff0000, v81
v_lshlrev_b32 v82, 16, v34
v_and_b32 v83, 0xffff0000, v34
v_lshlrev_b32 v84, 16, v35
v_and_b32 v85, 0xffff0000, v35
v_add_f32 v12, v12, v82
v_add_f32 v13, v13, v83
v_add_f32 v14, v14, v84
v_add_f32 v15, v15, v85
v_cvt_pk_bf16_f32 v34, v12, v13
v_cvt_pk_bf16_f32 v35, v14, v15
buffer_store_dwordx2 v[34:35], v6, s[52:55], s33 offen sc1
v_cvt_pk_bf16_f32 v80, v16, v17
v_cvt_pk_bf16_f32 v81, v18, v19
v_lshlrev_b32 v16, 16, v80
v_and_b32 v17, 0xffff0000, v80
v_lshlrev_b32 v18, 16, v81
v_and_b32 v19, 0xffff0000, v81
v_lshlrev_b32 v82, 16, v36
v_and_b32 v83, 0xffff0000, v36
v_lshlrev_b32 v84, 16, v37
v_and_b32 v85, 0xffff0000, v37
v_add_f32 v16, v16, v82
v_add_f32 v17, v17, v83
v_add_f32 v18, v18, v84
v_add_f32 v19, v19, v85
v_cvt_pk_bf16_f32 v36, v16, v17
v_cvt_pk_bf16_f32 v37, v18, v19
buffer_store_dwordx2 v[36:37], v6, s[52:55], s34 offen sc1
v_cvt_pk_bf16_f32 v80, v20, v21
v_cvt_pk_bf16_f32 v81, v22, v23
v_lshlrev_b32 v20, 16, v80
v_and_b32 v21, 0xffff0000, v80
v_lshlrev_b32 v22, 16, v81
v_and_b32 v23, 0xffff0000, v81
v_lshlrev_b32 v82, 16, v38
v_and_b32 v83, 0xffff0000, v38
v_lshlrev_b32 v84, 16, v39
v_and_b32 v85, 0xffff0000, v39
v_add_f32 v20, v20, v82
v_add_f32 v21, v21, v83
v_add_f32 v22, v22, v84
v_add_f32 v23, v23, v85
v_cvt_pk_bf16_f32 v38, v20, v21
v_cvt_pk_bf16_f32 v39, v22, v23
buffer_store_dwordx2 v[38:39], v6, s[52:55], s35 offen sc1
v_cvt_pk_bf16_f32 v80, v24, v25
v_cvt_pk_bf16_f32 v81, v26, v27
v_lshlrev_b32 v24, 16, v80
v_and_b32 v25, 0xffff0000, v80
v_lshlrev_b32 v26, 16, v81
v_and_b32 v27, 0xffff0000, v81
v_lshlrev_b32 v82, 16, v40
v_and_b32 v83, 0xffff0000, v40
v_lshlrev_b32 v84, 16, v41
v_and_b32 v85, 0xffff0000, v41
v_add_f32 v24, v24, v82
v_add_f32 v25, v25, v83
v_add_f32 v26, v26, v84
v_add_f32 v27, v27, v85
v_cvt_pk_bf16_f32 v40, v24, v25
v_cvt_pk_bf16_f32 v41, v26, v27
buffer_store_dwordx2 v[40:41], v6, s[52:55], s36 offen sc1
outb2_exit1:
s_endpgm
.section .rodata,"a"
.p2align 6
.amdhsa_kernel prep_kernel
  .amdhsa_next_free_vgpr 80
  .amdhsa_next_free_sgpr 64
  .amdhsa_accum_offset 80
  .amdhsa_group_segment_fixed_size 0
  .amdhsa_kernarg_size 104
  .amdhsa_user_sgpr_count 2
  .amdhsa_user_sgpr_kernarg_segment_ptr 1
  .amdhsa_system_sgpr_workgroup_id_x 1
  .amdhsa_float_denorm_mode_32 3
.end_amdhsa_kernel
.p2align 6
.amdhsa_kernel ln2_kernel
  .amdhsa_next_free_vgpr 80
  .amdhsa_next_free_sgpr 40
  .amdhsa_accum_offset 80
  .amdhsa_group_segment_fixed_size 0
  .amdhsa_kernarg_size 104
  .amdhsa_user_sgpr_count 2
  .amdhsa_user_sgpr_kernarg_segment_ptr 1
  .amdhsa_system_sgpr_workgroup_id_x 1
  .amdhsa_float_denorm_mode_32 3
.end_amdhsa_kernel
.p2align 6
.amdhsa_kernel reca_kernel
  .amdhsa_next_free_vgpr 512
  .amdhsa_next_free_sgpr 102
  .amdhsa_accum_offset 256
  .amdhsa_group_segment_fixed_size 0
  .amdhsa_kernarg_size 104
  .amdhsa_user_sgpr_count 2
  .amdhsa_user_sgpr_kernarg_segment_ptr 1
  .amdhsa_system_sgpr_workgroup_id_x 1
  .amdhsa_float_denorm_mode_32 3
.end_amdhsa_kernel
.p2align 6
.amdhsa_kernel fin_kernel
  .amdhsa_next_free_vgpr 496
  .amdhsa_next_free_sgpr 64
  .amdhsa_accum_offset 256
  .amdhsa_group_segment_fixed_size 0
  .amdhsa_kernarg_size 104
  .amdhsa_user_sgpr_count 2
  .amdhsa_user_sgpr_kernarg_segment_ptr 1
  .amdhsa_system_sgpr_workgroup_id_x 1
  .amdhsa_float_denorm_mode_32 3
.end_amdhsa_kernel
.p2align 6
.amdhsa_kernel redln1_kernel
  .amdhsa_next_free_vgpr 248
  .amdhsa_next_free_sgpr 48
  .amdhsa_accum_offset 248
  .amdhsa_group_segment_fixed_size 0
  .amdhsa_kernarg_size 104
  .amdhsa_user_sgpr_count 2
  .amdhsa_user_sgpr_kernarg_segment_ptr 1
  .amdhsa_system_sgpr_workgroup_id_x 1
  .amdhsa_float_denorm_mode_32 3
.end_amdhsa_kernel
.p2align 6
.amdhsa_kernel redln2_kernel
  .amdhsa_next_free_vgpr 248
  .amdhsa_next_free_sgpr 48
  .amdhsa_accum_offset 248
  .amdhsa_group_segment_fixed_size 0
  .amdhsa_kernarg_size 104
  .amdhsa_user_sgpr_count 2
  .amdhsa_user_sgpr_kernarg_segment_ptr 1
  .amdhsa_system_sgpr_workgroup_id_x 1
  .amdhsa_float_denorm_mode_32 3
.end_amdhsa_kernel
.p2align 6
.amdhsa_kernel qkvb_kernel
  .amdhsa_next_free_vgpr 176
  .amdhsa_next_free_sgpr 64
  .amdhsa_accum_offset 176
  .amdhsa_group_segment_fixed_size 0
  .amdhsa_kernarg_size 104
  .amdhsa_user_sgpr_count 2
  .amdhsa_user_sgpr_kernarg_segment_ptr 1
  .amdhsa_system_sgpr_workgroup_id_x 1
  .amdhsa_float_denorm_mode_32 3
.end_amdhsa_kernel
.p2align 6
.amdhsa_kernel attnb_kernel
  .amdhsa_next_free_vgpr 200
  .amdhsa_next_free_sgpr 48
  .amdhsa_accum_offset 200
  .amdhsa_group_segment_fixed_size 0
  .amdhsa_kernarg_size 104
  .amdhsa_user_sgpr_count 2
  .amdhsa_user_sgpr_kernarg_segment_ptr 1
  .amdhsa_system_sgpr_workgroup_id_x 1
  .amdhsa_float_denorm_mode_32 3
.end_amdhsa_kernel
.p2align 6
.amdhsa_kernel outb1_kernel
  .amdhsa_next_free_vgpr 128
  .amdhsa_next_free_sgpr 64
  .amdhsa_accum_offset 128
  .amdhsa_group_segment_fixed_size 0
  .amdhsa_kernarg_size 104
  .amdhsa_user_sgpr_count 2
  .amdhsa_user_sgpr_kernarg_segment_ptr 1
  .amdhsa_system_sgpr_workgroup_id_x 1
  .amdhsa_float_denorm_mode_32 3
.end_amdhsa_kernel
.p2align 6
.amdhsa_kernel outb2_kernel
  .amdhsa_next_free_vgpr 128
  .amdhsa_next_free_sgpr 64
  .amdhsa_accum_offset 128
  .amdhsa_group_segment_fixed_size 0
  .amdhsa_kernarg_size 104
  .amdhsa_user_sgpr_count 2
  .amdhsa_user_sgpr_kernarg_segment_ptr 1
  .amdhsa_system_sgpr_workgroup_id_x 1
  .amdhsa_float_denorm_mode_32 3
.end_amdhsa_kernel
```

```asm
; @launch kernel=prep_kernel grid=(2248,1,1) block=(256,1,1) lds=18944
; @launch kernel=reca_kernel grid=(256,1,1) block=(256,1,1) lds=81920
; @launch kernel=fin_kernel grid=(256,1,1) block=(256,1,1) lds=98304
; @launch kernel=redln1_kernel grid=(256,1,1) block=(128,1,1) lds=128
; @launch kernel=qkvb_kernel grid=(256,1,1) block=(256,1,1) lds=81920
; @launch kernel=attnb_kernel grid=(256,1,1) block=(256,1,1) lds=0
; @launch kernel=outb1_kernel grid=(256,1,1) block=(256,1,1) lds=61440
; @launch kernel=ln2_kernel grid=(128,1,1) block=(256,1,1) lds=512
; @launch kernel=reca_kernel grid=(256,1,1) block=(256,1,1) lds=81920
; @launch kernel=fin_kernel grid=(256,1,1) block=(256,1,1) lds=98304
; @launch kernel=redln2_kernel grid=(256,1,1) block=(128,1,1) lds=128
; @launch kernel=qkvb_kernel grid=(256,1,1) block=(256,1,1) lds=81920
; @launch kernel=attnb_kernel grid=(256,1,1) block=(256,1,1) lds=0
; @launch kernel=outb2_kernel grid=(256,1,1) block=(256,1,1) lds=61440
.amdgcn_target "amdgcn-amd-amdhsa--gfx950"
.text
.globl prep_kernel
.p2align 8
.type prep_kernel,@function
prep_kernel:
s_cmp_ge_u32 s2, 128
s_cbranch_scc1 prep_notln5
s_load_dwordx2 s[12:13], s[0:1], 96
s_load_dwordx2 s[14:15], s[0:1], 0
v_lshrrev_b32 v2, 6, v0
v_and_b32 v3, 63, v0
s_nop 0
v_readfirstlane_b32 s16, v2
s_waitcnt lgkmcnt(0)
s_mov_b32 s4, s12
s_mov_b32 s5, s13
s_mov_b32 s6, 0x10000000
s_mov_b32 s7, 0x20000
s_mov_b32 s8, s14
s_mov_b32 s9, s15
s_mov_b32 s10, 2621440
s_mov_b32 s11, 0x20000
s_mov_b32 s20, 0
v_and_b32 v2, 15, v3
v_lshrrev_b32 v4, 4, v3
s_lshl_b32 s17, s2, 4
v_add_u32 v1, s17, v2
v_mul_u32_u24 v1, 1280, v1
v_lshl_add_u32 v1, v4, 4, v1
s_mul_i32 s17, s16, 320
s_add_u32 s20, s20, s17
buffer_load_dwordx4 v[8:11], v1, s[8:11], s20 offen offset:0
buffer_load_dwordx4 v[12:15], v1, s[8:11], s20 offen offset:64
buffer_load_dwordx4 v[16:19], v1, s[8:11], s20 offen offset:128
buffer_load_dwordx4 v[20:23], v1, s[8:11], s20 offen offset:192
buffer_load_dwordx4 v[24:27], v1, s[8:11], s20 offen offset:256
s_sub_u32 s21, 0, s12
s_and_b32 s21, s21, 0x1fffff
s_add_u32 s21, s21, 2097152
v_mov_b32 v68, -1
v_mov_b32 v69, -1
v_mov_b32 v70, -1
v_mov_b32 v71, -1
v_lshlrev_b32 v72, 4, v0
s_mul_i32 s22, s2, 12096
s_add_u32 s22, s22, 0
s_mul_i32 s23, s2, 12288
s_add_u32 s23, s23, s21
buffer_store_dwordx4 v[68:71], v72, s[4:7], s22 offen sc1
s_add_u32 s22, s22, 4096
buffer_store_dwordx4 v[68:71], v72, s[4:7], s22 offen sc1
s_add_u32 s22, s22, 4096
v_mov_b32 v73, 0x80000000
v_cmp_gt_u32 vcc, 244, v0
s_nop 1
v_cndmask_b32 v73, v73, v72, vcc
buffer_store_dwordx4 v[68:71], v73, s[4:7], s22 offen
buffer_store_dwordx4 v[68:71], v72, s[4:7], s23 offen sc1
s_add_u32 s23, s23, 4096
buffer_store_dwordx4 v[68:71], v72, s[4:7], s23 offen sc1
s_add_u32 s23, s23, 4096
buffer_store_dwordx4 v[68:71], v72, s[4:7], s23 offen sc1
s_add_u32 s23, s23, 4096
s_mul_i32 s23, s2, 2048
s_add_u32 s23, s23, s21
s_add_u32 s23, s23, 1572864
v_mov_b32 v73, 0x80000000
v_cmp_gt_u32 vcc, 128, v0
s_nop 1
v_cndmask_b32 v73, v73, v72, vcc
buffer_store_dwordx4 v[68:71], v73, s[4:7], s23 offen sc1
s_waitcnt vmcnt(7)
s_mul_i32 s17, s16, 320
s_add_u32 s17, s17, 82313216
buffer_store_dwordx4 v[8:11], v1, s[4:7], s17 offen offset:0
buffer_store_dwordx4 v[12:15], v1, s[4:7], s17 offen offset:64
buffer_store_dwordx4 v[16:19], v1, s[4:7], s17 offen offset:128
buffer_store_dwordx4 v[20:23], v1, s[4:7], s17 offen offset:192
buffer_store_dwordx4 v[24:27], v1, s[4:7], s17 offen offset:256
v_lshlrev_b32 v5, 2, v2
s_lshl_b32 s17, s16, 6
v_add_u32 v1, s17, v5
s_waitcnt vmcnt(5)
v_lshlrev_b32 v28, 16, v8
v_and_b32 v29, 0xffff0000, v8
v_lshlrev_b32 v30, 16, v9
v_and_b32 v31, 0xffff0000, v9
v_lshlrev_b32 v32, 16, v10
v_and_b32 v33, 0xffff0000, v10
v_lshlrev_b32 v34, 16, v11
v_and_b32 v35, 0xffff0000, v11
v_lshlrev_b32 v36, 16, v12
v_and_b32 v37, 0xffff0000, v12
v_lshlrev_b32 v38, 16, v13
v_and_b32 v39, 0xffff0000, v13
v_lshlrev_b32 v40, 16, v14
v_and_b32 v41, 0xffff0000, v14
v_lshlrev_b32 v42, 16, v15
v_and_b32 v43, 0xffff0000, v15
v_lshlrev_b32 v44, 16, v16
v_and_b32 v45, 0xffff0000, v16
v_lshlrev_b32 v46, 16, v17
v_and_b32 v47, 0xffff0000, v17
v_lshlrev_b32 v48, 16, v18
v_and_b32 v49, 0xffff0000, v18
v_lshlrev_b32 v50, 16, v19
v_and_b32 v51, 0xffff0000, v19
v_lshlrev_b32 v52, 16, v20
v_and_b32 v53, 0xffff0000, v20
v_lshlrev_b32 v54, 16, v21
v_and_b32 v55, 0xffff0000, v21
v_lshlrev_b32 v56, 16, v22
v_and_b32 v57, 0xffff0000, v22
v_lshlrev_b32 v58, 16, v23
v_and_b32 v59, 0xffff0000, v23
v_lshlrev_b32 v60, 16, v24
v_and_b32 v61, 0xffff0000, v24
v_lshlrev_b32 v62, 16, v25
v_and_b32 v63, 0xffff0000, v25
v_lshlrev_b32 v64, 16, v26
v_and_b32 v65, 0xffff0000, v26
v_lshlrev_b32 v66, 16, v27
v_and_b32 v67, 0xffff0000, v27
v_pk_add_f32 v[6:7], v[28:29], v[30:31]
v_pk_add_f32 v[6:7], v[6:7], v[32:33]
v_pk_add_f32 v[6:7], v[6:7], v[34:35]
v_pk_add_f32 v[6:7], v[6:7], v[36:37]
v_pk_add_f32 v[6:7], v[6:7], v[38:39]
v_pk_add_f32 v[6:7], v[6:7], v[40:41]
v_pk_add_f32 v[6:7], v[6:7], v[42:43]
v_pk_add_f32 v[6:7], v[6:7], v[44:45]
v_pk_add_f32 v[6:7], v[6:7], v[46:47]
v_pk_add_f32 v[6:7], v[6:7], v[48:49]
v_pk_add_f32 v[6:7], v[6:7], v[50:51]
v_pk_add_f32 v[6:7], v[6:7], v[52:53]
v_pk_add_f32 v[6:7], v[6:7], v[54:55]
v_pk_add_f32 v[6:7], v[6:7], v[56:57]
v_pk_add_f32 v[6:7], v[6:7], v[58:59]
v_pk_add_f32 v[6:7], v[6:7], v[60:61]
v_pk_add_f32 v[6:7], v[6:7], v[62:63]
v_pk_add_f32 v[6:7], v[6:7], v[64:65]
v_pk_add_f32 v[6:7], v[6:7], v[66:67]
v_add_f32 v4, v6, v7
v_mov_b32 v2, v4
s_nop 1
v_permlane32_swap_b32 v4, v2
v_add_f32 v4, v4, v2
v_mov_b32 v2, v4
s_nop 1
v_permlane16_swap_b32 v4, v2
v_add_f32 v4, v4, v2
ds_write_b32 v1, v4 offset:0
s_waitcnt lgkmcnt(0)
s_barrier
ds_read_b32 v4, v5 offset:0
ds_read_b32 v2, v5 offset:64
ds_read_b32 v3, v5 offset:128
ds_read_b32 v6, v5 offset:192
s_waitcnt lgkmcnt(0)
v_add_f32 v4, v4, v2
v_add_f32 v3, v3, v6
v_add_f32 v4, v4, v3
v_mul_f32 v4, 0x3acccccd, v4
v_sub_f32 v28, v28, v4
v_sub_f32 v29, v29, v4
v_sub_f32 v30, v30, v4
v_sub_f32 v31, v31, v4
v_sub_f32 v32, v32, v4
v_sub_f32 v33, v33, v4
v_sub_f32 v34, v34, v4
v_sub_f32 v35, v35, v4
v_sub_f32 v36, v36, v4
v_sub_f32 v37, v37, v4
v_sub_f32 v38, v38, v4
v_sub_f32 v39, v39, v4
v_sub_f32 v40, v40, v4
v_sub_f32 v41, v41, v4
v_sub_f32 v42, v42, v4
v_sub_f32 v43, v43, v4
v_sub_f32 v44, v44, v4
v_sub_f32 v45, v45, v4
v_sub_f32 v46, v46, v4
v_sub_f32 v47, v47, v4
v_sub_f32 v48, v48, v4
v_sub_f32 v49, v49, v4
v_sub_f32 v50, v50, v4
v_sub_f32 v51, v51, v4
v_sub_f32 v52, v52, v4
v_sub_f32 v53, v53, v4
v_sub_f32 v54, v54, v4
v_sub_f32 v55, v55, v4
v_sub_f32 v56, v56, v4
v_sub_f32 v57, v57, v4
v_sub_f32 v58, v58, v4
v_sub_f32 v59, v59, v4
v_sub_f32 v60, v60, v4
v_sub_f32 v61, v61, v4
v_sub_f32 v62, v62, v4
v_sub_f32 v63, v63, v4
v_sub_f32 v64, v64, v4
v_sub_f32 v65, v65, v4
v_sub_f32 v66, v66, v4
v_sub_f32 v67, v67, v4
v_mul_f32 v6, v28, v28
v_mul_f32 v7, v29, v29
v_fmac_f32 v6, v30, v30
v_fmac_f32 v7, v31, v31
v_fmac_f32 v6, v32, v32
v_fmac_f32 v7, v33, v33
v_fmac_f32 v6, v34, v34
v_fmac_f32 v7, v35, v35
v_fmac_f32 v6, v36, v36
v_fmac_f32 v7, v37, v37
v_fmac_f32 v6, v38, v38
v_fmac_f32 v7, v39, v39
v_fmac_f32 v6, v40, v40
v_fmac_f32 v7, v41, v41
v_fmac_f32 v6, v42, v42
v_fmac_f32 v7, v43, v43
v_fmac_f32 v6, v44, v44
v_fmac_f32 v7, v45, v45
v_fmac_f32 v6, v46, v46
v_fmac_f32 v7, v47, v47
v_fmac_f32 v6, v48, v48
v_fmac_f32 v7, v49, v49
v_fmac_f32 v6, v50, v50
v_fmac_f32 v7, v51, v51
v_fmac_f32 v6, v52, v52
v_fmac_f32 v7, v53, v53
v_fmac_f32 v6, v54, v54
v_fmac_f32 v7, v55, v55
v_fmac_f32 v6, v56, v56
v_fmac_f32 v7, v57, v57
v_fmac_f32 v6, v58, v58
v_fmac_f32 v7, v59, v59
v_fmac_f32 v6, v60, v60
v_fmac_f32 v7, v61, v61
v_fmac_f32 v6, v62, v62
v_fmac_f32 v7, v63, v63
v_fmac_f32 v6, v64, v64
v_fmac_f32 v7, v65, v65
v_fmac_f32 v6, v66, v66
v_fmac_f32 v7, v67, v67
v_add_f32 v4, v6, v7
v_mov_b32 v2, v4
s_nop 1
v_permlane32_swap_b32 v4, v2
v_add_f32 v4, v4, v2
v_mov_b32 v2, v4
s_nop 1
v_permlane16_swap_b32 v4, v2
v_add_f32 v4, v4, v2
ds_write_b32 v1, v4 offset:256
s_waitcnt lgkmcnt(0)
s_barrier
ds_read_b32 v4, v5 offset:256
ds_read_b32 v2, v5 offset:320
ds_read_b32 v3, v5 offset:384
ds_read_b32 v6, v5 offset:448
s_waitcnt lgkmcnt(0)
v_add_f32 v4, v4, v2
v_add_f32 v3, v3, v6
v_add_f32 v4, v4, v3
v_mov_b32 v2, 0x3727c5ac
v_fmac_f32 v2, 0x3acccccd, v4
v_rsq_f32 v4, v2
s_nop 0
v_mul_f32 v28, v28, v4
v_mul_f32 v29, v29, v4
v_mul_f32 v30, v30, v4
v_mul_f32 v31, v31, v4
v_mul_f32 v32, v32, v4
v_mul_f32 v33, v33, v4
v_mul_f32 v34, v34, v4
v_mul_f32 v35, v35, v4
v_mul_f32 v36, v36, v4
v_mul_f32 v37, v37, v4
v_mul_f32 v38, v38, v4
v_mul_f32 v39, v39, v4
v_mul_f32 v40, v40, v4
v_mul_f32 v41, v41, v4
v_mul_f32 v42, v42, v4
v_mul_f32 v43, v43, v4
v_mul_f32 v44, v44, v4
v_mul_f32 v45, v45, v4
v_mul_f32 v46, v46, v4
v_mul_f32 v47, v47, v4
v_mul_f32 v48, v48, v4
v_mul_f32 v49, v49, v4
v_mul_f32 v50, v50, v4
v_mul_f32 v51, v51, v4
v_mul_f32 v52, v52, v4
v_mul_f32 v53, v53, v4
v_mul_f32 v54, v54, v4
v_mul_f32 v55, v55, v4
v_mul_f32 v56, v56, v4
v_mul_f32 v57, v57, v4
v_mul_f32 v58, v58, v4
v_mul_f32 v59, v59, v4
v_mul_f32 v60, v60, v4
v_mul_f32 v61, v61, v4
v_mul_f32 v62, v62, v4
v_mul_f32 v63, v63, v4
v_mul_f32 v64, v64, v4
v_mul_f32 v65, v65, v4
v_mul_f32 v66, v66, v4
v_mul_f32 v67, v67, v4
v_cvt_pk_bf16_f32 v8, v28, v29
v_cvt_pk_bf16_f32 v9, v30, v31
v_cvt_pk_bf16_f32 v10, v32, v33
v_cvt_pk_bf16_f32 v11, v34, v35
v_cvt_pk_bf16_f32 v12, v36, v37
v_cvt_pk_bf16_f32 v13, v38, v39
v_cvt_pk_bf16_f32 v14, v40, v41
v_cvt_pk_bf16_f32 v15, v42, v43
v_cvt_pk_bf16_f32 v16, v44, v45
v_cvt_pk_bf16_f32 v17, v46, v47
v_cvt_pk_bf16_f32 v18, v48, v49
v_cvt_pk_bf16_f32 v19, v50, v51
v_cvt_pk_bf16_f32 v20, v52, v53
v_cvt_pk_bf16_f32 v21, v54, v55
v_cvt_pk_bf16_f32 v22, v56, v57
v_cvt_pk_bf16_f32 v23, v58, v59
v_cvt_pk_bf16_f32 v24, v60, v61
v_cvt_pk_bf16_f32 v25, v62, v63
v_cvt_pk_bf16_f32 v26, v64, v65
v_cvt_pk_bf16_f32 v27, v66, v67
v_and_b32 v3, 63, v0
v_lshlrev_b32 v1, 4, v3
s_mul_i32 s17, s2, 20480
s_mul_i32 s18, s16, 5120
s_add_u32 s17, s17, s18
s_add_u32 s17, s17, 84934656
buffer_store_dwordx4 v[8:11], v1, s[4:7], s17 offen offset:0 sc1
buffer_store_dwordx4 v[12:15], v1, s[4:7], s17 offen offset:1024 sc1
buffer_store_dwordx4 v[16:19], v1, s[4:7], s17 offen offset:2048 sc1
buffer_store_dwordx4 v[20:23], v1, s[4:7], s17 offen offset:3072 sc1
s_add_u32 s17, s17, 4096
buffer_store_dwordx4 v[24:27], v1, s[4:7], s17 offen offset:0 sc1
s_endpgm
prep_notln5:
s_sub_u32 s2, s2, 128
s_cmp_ge_u32 s2, 2120
s_cbranch_scc1 prep_exit1
s_load_dwordx2 s[12:13], s[0:1], 96
s_load_dwordx4 s[16:19], s[0:1], 16
s_load_dwordx4 s[20:23], s[0:1], 32
s_load_dwordx4 s[24:27], s[0:1], 64
v_lshrrev_b32 v6, 6, v0
v_and_b32 v1, 63, v0
s_nop 0
v_readfirstlane_b32 s14, v6
v_lshlrev_b32 v5, 4, v1
s_lshl_b32 s15, s2, 2
s_nop 1
s_add_u32 s15, s15, s14
s_add_u32 s28, s15, 7680
s_sub_u32 s29, s15, 800
s_cmp_lt_u32 s15, 800
s_cselect_b32 s15, s28, s29
s_waitcnt lgkmcnt(0)
s_mov_b32 s4, s12
s_mov_b32 s5, s13
s_mov_b32 s6, 0x10000000
s_mov_b32 s7, 0x20000
s_mov_b32 s11, 0x20000
v_and_b32 v2, 15, v1
v_lshrrev_b32 v3, 4, v1
s_cmp_ge_u32 s15, 5760
s_cbranch_scc1 prep_s22
s_mul_hi_u32 s31, s15, 2236963
s_mul_i32 s32, s31, 1920
s_sub_u32 s32, s15, s32
s_mul_hi_u32 s34, s32, 44739243
s_mul_i32 s33, s34, 96
s_sub_u32 s33, s32, s33
s_cmp_eq_u32 s31, 0
s_cselect_b32 s8, s16, s18
s_cselect_b32 s9, s17, s19
s_cmp_eq_u32 s31, 2
s_cselect_b32 s8, s20, s8
s_cselect_b32 s9, s21, s9
s_mov_b32 s10, 7864320
s_mul_i32 s35, s31, 7864320
s_add_u32 s35, s35, 6291456
v_lshrrev_b32 v6, 3, v1
s_lshl_b32 s36, s34, 5
v_add_u32 v6, s36, v6
s_mov_b32 s37, 12288
v_mul_lo_u32 v4, v6, s37
s_lshl_b32 s36, s33, 7
v_and_b32 v6, 7, v1
v_lshl_add_u32 v4, v6, 4, v4
v_add_u32 v4, s36, v4
v_lshrrev_b32 v6, 3, v1
v_mul_u32_u24 v12, 144, v6
v_and_b32 v6, 7, v1
v_lshl_add_u32 v12, v6, 4, v12
s_mul_i32 s36, s14, 4608
s_add_u32 s36, s36, 512
v_add_u32 v12, s36, v12
s_mov_b32 s29, 0
buffer_load_dwordx4 v[16:19], v4, s[8:11], s29 offen
s_mov_b32 s29, 98304
buffer_load_dwordx4 v[20:23], v4, s[8:11], s29 offen
s_mov_b32 s29, 196608
buffer_load_dwordx4 v[24:27], v4, s[8:11], s29 offen
s_mov_b32 s29, 294912
buffer_load_dwordx4 v[28:31], v4, s[8:11], s29 offen
v_bfe_u32 v6, v1, 2, 2
v_lshlrev_b32 v13, 3, v3
v_add_u32 v13, v13, v6
v_mul_u32_u24 v13, 144, v13
v_and_b32 v6, 3, v1
v_lshl_add_u32 v13, v6, 3, v13
v_add_u32 v13, s36, v13
s_waitcnt vmcnt(3)
ds_write_b128 v12, v[16:19] offset:0
s_waitcnt vmcnt(2)
ds_write_b128 v12, v[20:23] offset:1152
s_waitcnt vmcnt(1)
ds_write_b128 v12, v[24:27] offset:2304
s_waitcnt vmcnt(0)
ds_write_b128 v12, v[28:31] offset:3456
s_waitcnt lgkmcnt(0)
ds_read_b64_tr_b16 v[48:49], v13 offset:0
ds_read_b64_tr_b16 v[50:51], v13 offset:576
ds_read_b64_tr_b16 v[52:53], v13 offset:32
ds_read_b64_tr_b16 v[54:55], v13 offset:608
ds_read_b64_tr_b16 v[56:57], v13 offset:64
ds_read_b64_tr_b16 v[58:59], v13 offset:640
ds_read_b64_tr_b16 v[60:61], v13 offset:96
ds_read_b64_tr_b16 v[62:63], v13 offset:672
s_waitcnt lgkmcnt(6)
s_lshl_b32 s30, s33, 2
s_add_u32 s30, s30, 0
s_mul_i32 s30, s30, 20
s_add_u32 s30, s30, s34
s_lshl_b32 s30, s30, 10
s_add_u32 s30, s30, s35
buffer_store_dwordx4 v[48:51], v5, s[4:7], s30 offen sc1
s_waitcnt lgkmcnt(4)
s_lshl_b32 s30, s33, 2
s_add_u32 s30, s30, 1
s_mul_i32 s30, s30, 20
s_add_u32 s30, s30, s34
s_lshl_b32 s30, s30, 10
s_add_u32 s30, s30, s35
buffer_store_dwordx4 v[52:55], v5, s[4:7], s30 offen sc1
s_waitcnt lgkmcnt(2)
s_lshl_b32 s30, s33, 2
s_add_u32 s30, s30, 2
s_mul_i32 s30, s30, 20
s_add_u32 s30, s30, s34
s_lshl_b32 s30, s30, 10
s_add_u32 s30, s30, s35
buffer_store_dwordx4 v[56:59], v5, s[4:7], s30 offen sc1
s_waitcnt lgkmcnt(0)
s_lshl_b32 s30, s33, 2
s_add_u32 s30, s30, 3
s_mul_i32 s30, s30, 20
s_add_u32 s30, s30, s34
s_lshl_b32 s30, s30, 10
s_add_u32 s30, s30, s35
buffer_store_dwordx4 v[60:63], v5, s[4:7], s30 offen sc1
s_branch prep_exit1
prep_s22:
s_sub_u32 s15, s15, 5760
s_cmp_ge_u32 s15, 1920
s_cbranch_scc1 prep_s33
s_mul_hi_u32 s34, s15, 429496730
s_mul_i32 s33, s34, 10
s_sub_u32 s33, s15, s33
s_mov_b32 s8, s22
s_mov_b32 s9, s23
s_mov_b32 s10, 7864320
v_lshrrev_b32 v6, 3, v1
s_lshl_b32 s36, s34, 5
v_add_u32 v6, s36, v6
v_mul_u32_u24 v4, 1280, v6
s_lshl_b32 s36, s33, 7
v_and_b32 v6, 7, v1
v_lshl_add_u32 v4, v6, 4, v4
v_add_u32 v4, s36, v4
v_lshrrev_b32 v6, 3, v1
v_mul_u32_u24 v12, 144, v6
v_and_b32 v6, 7, v1
v_lshl_add_u32 v12, v6, 4, v12
s_mul_i32 s36, s14, 4608
s_add_u32 s36, s36, 512
v_add_u32 v12, s36, v12
s_mov_b32 s29, 0
buffer_load_dwordx4 v[16:19], v4, s[8:11], s29 offen
s_mov_b32 s29, 10240
buffer_load_dwordx4 v[20:23], v4, s[8:11], s29 offen
s_mov_b32 s29, 20480
buffer_load_dwordx4 v[24:27], v4, s[8:11], s29 offen
s_mov_b32 s29, 30720
buffer_load_dwordx4 v[28:31], v4, s[8:11], s29 offen
v_bfe_u32 v6, v1, 2, 2
v_lshlrev_b32 v13, 2, v3
v_add_u32 v13, v13, v6
v_mul_u32_u24 v13, 144, v13
v_and_b32 v6, 3, v1
v_lshl_add_u32 v13, v6, 4, v13
v_add_u32 v13, s36, v13
s_waitcnt vmcnt(3)
ds_write_b128 v12, v[16:19] offset:0
s_waitcnt vmcnt(2)
ds_write_b128 v12, v[20:23] offset:1152
s_waitcnt vmcnt(1)
ds_write_b128 v12, v[24:27] offset:2304
s_waitcnt vmcnt(0)
ds_write_b128 v12, v[28:31] offset:3456
s_waitcnt lgkmcnt(0)
ds_read_b64_tr_b16 v[48:49], v13 offset:0
ds_read_b64_tr_b16 v[50:51], v13 offset:2304
ds_read_b64_tr_b16 v[52:53], v13 offset:8
ds_read_b64_tr_b16 v[54:55], v13 offset:2312
ds_read_b64_tr_b16 v[56:57], v13 offset:64
ds_read_b64_tr_b16 v[58:59], v13 offset:2368
ds_read_b64_tr_b16 v[60:61], v13 offset:72
ds_read_b64_tr_b16 v[62:63], v13 offset:2376
s_waitcnt lgkmcnt(6)
s_lshl_b32 s30, s33, 2
s_add_u32 s30, s30, 0
s_mul_i32 s30, s30, 192
s_add_u32 s30, s30, s34
s_lshl_b32 s30, s30, 10
s_add_u32 s30, s30, 29884416
buffer_store_dwordx4 v[48:51], v5, s[4:7], s30 offen sc1
s_waitcnt lgkmcnt(4)
s_lshl_b32 s30, s33, 2
s_add_u32 s30, s30, 1
s_mul_i32 s30, s30, 192
s_add_u32 s30, s30, s34
s_lshl_b32 s30, s30, 10
s_add_u32 s30, s30, 29884416
buffer_store_dwordx4 v[52:55], v5, s[4:7], s30 offen sc1
s_waitcnt lgkmcnt(2)
s_lshl_b32 s30, s33, 2
s_add_u32 s30, s30, 2
s_mul_i32 s30, s30, 192
s_add_u32 s30, s30, s34
s_lshl_b32 s30, s30, 10
s_add_u32 s30, s30, 29884416
buffer_store_dwordx4 v[56:59], v5, s[4:7], s30 offen sc1
s_waitcnt lgkmcnt(0)
s_lshl_b32 s30, s33, 2
s_add_u32 s30, s30, 3
s_mul_i32 s30, s30, 192
s_add_u32 s30, s30, s34
s_lshl_b32 s30, s30, 10
s_add_u32 s30, s30, 29884416
buffer_store_dwordx4 v[60:63], v5, s[4:7], s30 offen sc1
s_branch prep_exit1
prep_s33:
s_sub_u32 s15, s15, 1920
s_cmp_ge_u32 s15, 600
s_cbranch_scc1 prep_s44
s_mul_hi_u32 s34, s15, 143165577
s_mul_i32 s33, s34, 30
s_sub_u32 s33, s15, s33
s_mov_b32 s8, s24
s_mov_b32 s9, s25
s_mov_b32 s10, 2457600
v_lshrrev_b32 v6, 3, v1
s_lshl_b32 s36, s34, 5
v_add_u32 v6, s36, v6
v_mul_u32_u24 v4, 3840, v6
s_lshl_b32 s36, s33, 7
v_and_b32 v6, 7, v1
v_lshl_add_u32 v4, v6, 4, v4
v_add_u32 v4, s36, v4
v_lshrrev_b32 v6, 3, v1
v_mul_u32_u24 v12, 144, v6
v_and_b32 v6, 7, v1
v_lshl_add_u32 v12, v6, 4, v12
s_mul_i32 s36, s14, 4608
s_add_u32 s36, s36, 512
v_add_u32 v12, s36, v12
s_mov_b32 s29, 0
buffer_load_dwordx4 v[16:19], v4, s[8:11], s29 offen
s_mov_b32 s29, 30720
buffer_load_dwordx4 v[20:23], v4, s[8:11], s29 offen
s_mov_b32 s29, 61440
buffer_load_dwordx4 v[24:27], v4, s[8:11], s29 offen
s_mov_b32 s29, 92160
buffer_load_dwordx4 v[28:31], v4, s[8:11], s29 offen
v_bfe_u32 v6, v1, 2, 2
v_lshlrev_b32 v13, 3, v3
v_add_u32 v13, v13, v6
v_mul_u32_u24 v13, 144, v13
v_and_b32 v6, 3, v1
v_lshl_add_u32 v13, v6, 3, v13
v_add_u32 v13, s36, v13
s_waitcnt vmcnt(3)
ds_write_b128 v12, v[16:19] offset:0
s_waitcnt vmcnt(2)
ds_write_b128 v12, v[20:23] offset:1152
s_waitcnt vmcnt(1)
ds_write_b128 v12, v[24:27] offset:2304
s_waitcnt vmcnt(0)
ds_write_b128 v12, v[28:31] offset:3456
s_waitcnt lgkmcnt(0)
ds_read_b64_tr_b16 v[48:49], v13 offset:0
ds_read_b64_tr_b16 v[50:51], v13 offset:576
ds_read_b64_tr_b16 v[52:53], v13 offset:32
ds_read_b64_tr_b16 v[54:55], v13 offset:608
ds_read_b64_tr_b16 v[56:57], v13 offset:64
ds_read_b64_tr_b16 v[58:59], v13 offset:640
ds_read_b64_tr_b16 v[60:61], v13 offset:96
ds_read_b64_tr_b16 v[62:63], v13 offset:672
s_waitcnt lgkmcnt(6)
s_lshl_b32 s30, s33, 2
s_add_u32 s30, s30, 0
s_mul_i32 s30, s30, 20
s_add_u32 s30, s30, s34
s_lshl_b32 s30, s30, 10
s_add_u32 s30, s30, 87556096
buffer_store_dwordx4 v[48:51], v5, s[4:7], s30 offen sc1
s_waitcnt lgkmcnt(4)
s_lshl_b32 s30, s33, 2
s_add_u32 s30, s30, 1
s_mul_i32 s30, s30, 20
s_add_u32 s30, s30, s34
s_lshl_b32 s30, s30, 10
s_add_u32 s30, s30, 87556096
buffer_store_dwordx4 v[52:55], v5, s[4:7], s30 offen sc1
s_waitcnt lgkmcnt(2)
s_lshl_b32 s30, s33, 2
s_add_u32 s30, s30, 2
s_mul_i32 s30, s30, 20
s_add_u32 s30, s30, s34
s_lshl_b32 s30, s30, 10
s_add_u32 s30, s30, 87556096
buffer_store_dwordx4 v[56:59], v5, s[4:7], s30 offen sc1
s_waitcnt lgkmcnt(0)
s_lshl_b32 s30, s33, 2
s_add_u32 s30, s30, 3
s_mul_i32 s30, s30, 20
s_add_u32 s30, s30, s34
s_lshl_b32 s30, s30, 10
s_add_u32 s30, s30, 87556096
buffer_store_dwordx4 v[60:63], v5, s[4:7], s30 offen sc1
s_branch prep_exit1
prep_s44:
s_sub_u32 s15, s15, 600
s_mul_hi_u32 s34, s15, 429496730
s_mul_i32 s33, s34, 10
s_sub_u32 s33, s15, s33
s_mov_b32 s8, s26
s_mov_b32 s9, s27
s_mov_b32 s10, 819200
v_lshrrev_b32 v6, 3, v1
s_lshl_b32 s36, s34, 5
v_add_u32 v6, s36, v6
v_mul_u32_u24 v4, 1280, v6
s_lshl_b32 s36, s33, 7
v_and_b32 v6, 7, v1
v_lshl_add_u32 v4, v6, 4, v4
v_add_u32 v4, s36, v4
v_lshrrev_b32 v6, 3, v1
v_mul_u32_u24 v12, 144, v6
v_and_b32 v6, 7, v1
v_lshl_add_u32 v12, v6, 4, v12
s_mul_i32 s36, s14, 4608
s_add_u32 s36, s36, 512
v_add_u32 v12, s36, v12
s_mov_b32 s29, 0
buffer_load_dwordx4 v[16:19], v4, s[8:11], s29 offen
s_mov_b32 s29, 10240
buffer_load_dwordx4 v[20:23], v4, s[8:11], s29 offen
s_mov_b32 s29, 20480
buffer_load_dwordx4 v[24:27], v4, s[8:11], s29 offen
s_mov_b32 s29, 30720
buffer_load_dwordx4 v[28:31], v4, s[8:11], s29 offen
v_bfe_u32 v6, v1, 2, 2
v_lshlrev_b32 v13, 3, v3
v_add_u32 v13, v13, v6
v_mul_u32_u24 v13, 144, v13
v_and_b32 v6, 3, v1
v_lshl_add_u32 v13, v6, 4, v13
v_add_u32 v13, s36, v13
s_waitcnt vmcnt(3)
ds_write_b128 v12, v[16:19] offset:0
s_waitcnt vmcnt(2)
ds_write_b128 v12, v[20:23] offset:1152
s_waitcnt vmcnt(1)
ds_write_b128 v12, v[24:27] offset:2304
s_waitcnt vmcnt(0)
ds_write_b128 v12, v[28:31] offset:3456
s_waitcnt lgkmcnt(0)
ds_read_b64_tr_b16 v[48:49], v13 offset:0
ds_read_b64_tr_b16 v[50:51], v13 offset:576
ds_read_b64_tr_b16 v[52:53], v13 offset:8
ds_read_b64_tr_b16 v[54:55], v13 offset:584
ds_read_b64_tr_b16 v[56:57], v13 offset:64
ds_read_b64_tr_b16 v[58:59], v13 offset:640
ds_read_b64_tr_b16 v[60:61], v13 offset:72
ds_read_b64_tr_b16 v[62:63], v13 offset:648
s_waitcnt lgkmcnt(6)
s_lshl_b32 s30, s33, 2
s_add_u32 s30, s30, 0
s_mul_i32 s30, s30, 20
s_add_u32 s30, s30, s34
s_lshl_b32 s30, s30, 10
s_add_u32 s30, s30, 90013696
buffer_store_dwordx4 v[48:51], v5, s[4:7], s30 offen sc1
s_waitcnt lgkmcnt(4)
s_lshl_b32 s30, s33, 2
s_add_u32 s30, s30, 1
s_mul_i32 s30, s30, 20
s_add_u32 s30, s30, s34
s_lshl_b32 s30, s30, 10
s_add_u32 s30, s30, 90013696
buffer_store_dwordx4 v[52:55], v5, s[4:7], s30 offen sc1
s_waitcnt lgkmcnt(2)
s_lshl_b32 s30, s33, 2
s_add_u32 s30, s30, 2
s_mul_i32 s30, s30, 20
s_add_u32 s30, s30, s34
s_lshl_b32 s30, s30, 10
s_add_u32 s30, s30, 90013696
buffer_store_dwordx4 v[56:59], v5, s[4:7], s30 offen sc1
s_waitcnt lgkmcnt(0)
s_lshl_b32 s30, s33, 2
s_add_u32 s30, s30, 3
s_mul_i32 s30, s30, 20
s_add_u32 s30, s30, s34
s_lshl_b32 s30, s30, 10
s_add_u32 s30, s30, 90013696
buffer_store_dwordx4 v[60:63], v5, s[4:7], s30 offen sc1
prep_exit1:
s_endpgm
.globl ln2_kernel
.p2align 8
.type ln2_kernel,@function
ln2_kernel:
s_cmp_ge_u32 s2, 128
s_cbranch_scc1 ln2_exit1
s_load_dwordx2 s[12:13], s[0:1], 96
s_load_dwordx2 s[14:15], s[0:1], 0
v_lshrrev_b32 v2, 6, v0
v_and_b32 v3, 63, v0
s_nop 0
v_readfirstlane_b32 s16, v2
s_waitcnt lgkmcnt(0)
s_mov_b32 s4, s12
s_mov_b32 s5, s13
s_mov_b32 s6, 0x10000000
s_mov_b32 s7, 0x20000
s_mov_b32 s8, s12
s_mov_b32 s9, s13
s_mov_b32 s10, 0x10000000
s_mov_b32 s11, 0x20000
s_mov_b32 s20, 82313216
v_and_b32 v2, 15, v3
v_lshrrev_b32 v4, 4, v3
s_lshl_b32 s17, s2, 4
v_add_u32 v1, s17, v2
v_mul_u32_u24 v1, 1280, v1
v_lshl_add_u32 v1, v4, 4, v1
s_mul_i32 s17, s16, 320
s_add_u32 s20, s20, s17
buffer_load_dwordx4 v[8:11], v1, s[8:11], s20 offen offset:0
buffer_load_dwordx4 v[12:15], v1, s[8:11], s20 offen offset:64
buffer_load_dwordx4 v[16:19], v1, s[8:11], s20 offen offset:128
buffer_load_dwordx4 v[20:23], v1, s[8:11], s20 offen offset:192
buffer_load_dwordx4 v[24:27], v1, s[8:11], s20 offen offset:256
s_sub_u32 s21, 0, s12
s_and_b32 s21, s21, 0x1fffff
s_add_u32 s21, s21, 2097152
v_mov_b32 v68, -1
v_mov_b32 v69, -1
v_mov_b32 v70, -1
v_mov_b32 v71, -1
v_lshlrev_b32 v72, 4, v0
s_mul_i32 s22, s2, 12096
s_add_u32 s22, s22, 0
s_mul_i32 s23, s2, 12288
s_add_u32 s23, s23, s21
buffer_store_dwordx4 v[68:71], v72, s[4:7], s22 offen sc1
s_add_u32 s22, s22, 4096
buffer_store_dwordx4 v[68:71], v72, s[4:7], s22 offen sc1
s_add_u32 s22, s22, 4096
v_mov_b32 v73, 0x80000000
v_cmp_gt_u32 vcc, 244, v0
s_nop 1
v_cndmask_b32 v73, v73, v72, vcc
buffer_store_dwordx4 v[68:71], v73, s[4:7], s22 offen
buffer_store_dwordx4 v[68:71], v72, s[4:7], s23 offen sc1
s_add_u32 s23, s23, 4096
buffer_store_dwordx4 v[68:71], v72, s[4:7], s23 offen sc1
s_add_u32 s23, s23, 4096
buffer_store_dwordx4 v[68:71], v72, s[4:7], s23 offen sc1
s_add_u32 s23, s23, 4096
s_mul_i32 s23, s2, 2048
s_add_u32 s23, s23, s21
s_add_u32 s23, s23, 1572864
v_mov_b32 v73, 0x80000000
v_cmp_gt_u32 vcc, 128, v0
s_nop 1
v_cndmask_b32 v73, v73, v72, vcc
buffer_store_dwordx4 v[68:71], v73, s[4:7], s23 offen sc1
v_lshlrev_b32 v5, 2, v2
s_lshl_b32 s17, s16, 6
v_add_u32 v1, s17, v5
s_waitcnt vmcnt(7)
v_lshlrev_b32 v28, 16, v8
v_and_b32 v29, 0xffff0000, v8
v_lshlrev_b32 v30, 16, v9
v_and_b32 v31, 0xffff0000, v9
v_lshlrev_b32 v32, 16, v10
v_and_b32 v33, 0xffff0000, v10
v_lshlrev_b32 v34, 16, v11
v_and_b32 v35, 0xffff0000, v11
v_lshlrev_b32 v36, 16, v12
v_and_b32 v37, 0xffff0000, v12
v_lshlrev_b32 v38, 16, v13
v_and_b32 v39, 0xffff0000, v13
v_lshlrev_b32 v40, 16, v14
v_and_b32 v41, 0xffff0000, v14
v_lshlrev_b32 v42, 16, v15
v_and_b32 v43, 0xffff0000, v15
v_lshlrev_b32 v44, 16, v16
v_and_b32 v45, 0xffff0000, v16
v_lshlrev_b32 v46, 16, v17
v_and_b32 v47, 0xffff0000, v17
v_lshlrev_b32 v48, 16, v18
v_and_b32 v49, 0xffff0000, v18
v_lshlrev_b32 v50, 16, v19
v_and_b32 v51, 0xffff0000, v19
v_lshlrev_b32 v52, 16, v20
v_and_b32 v53, 0xffff0000, v20
v_lshlrev_b32 v54, 16, v21
v_and_b32 v55, 0xffff0000, v21
v_lshlrev_b32 v56, 16, v22
v_and_b32 v57, 0xffff0000, v22
v_lshlrev_b32 v58, 16, v23
v_and_b32 v59, 0xffff0000, v23
v_lshlrev_b32 v60, 16, v24
v_and_b32 v61, 0xffff0000, v24
v_lshlrev_b32 v62, 16, v25
v_and_b32 v63, 0xffff0000, v25
v_lshlrev_b32 v64, 16, v26
v_and_b32 v65, 0xffff0000, v26
v_lshlrev_b32 v66, 16, v27
v_and_b32 v67, 0xffff0000, v27
v_pk_add_f32 v[6:7], v[28:29], v[30:31]
v_pk_add_f32 v[6:7], v[6:7], v[32:33]
v_pk_add_f32 v[6:7], v[6:7], v[34:35]
v_pk_add_f32 v[6:7], v[6:7], v[36:37]
v_pk_add_f32 v[6:7], v[6:7], v[38:39]
v_pk_add_f32 v[6:7], v[6:7], v[40:41]
v_pk_add_f32 v[6:7], v[6:7], v[42:43]
v_pk_add_f32 v[6:7], v[6:7], v[44:45]
v_pk_add_f32 v[6:7], v[6:7], v[46:47]
v_pk_add_f32 v[6:7], v[6:7], v[48:49]
v_pk_add_f32 v[6:7], v[6:7], v[50:51]
v_pk_add_f32 v[6:7], v[6:7], v[52:53]
v_pk_add_f32 v[6:7], v[6:7], v[54:55]
v_pk_add_f32 v[6:7], v[6:7], v[56:57]
v_pk_add_f32 v[6:7], v[6:7], v[58:59]
v_pk_add_f32 v[6:7], v[6:7], v[60:61]
v_pk_add_f32 v[6:7], v[6:7], v[62:63]
v_pk_add_f32 v[6:7], v[6:7], v[64:65]
v_pk_add_f32 v[6:7], v[6:7], v[66:67]
v_add_f32 v4, v6, v7
v_mov_b32 v2, v4
s_nop 1
v_permlane32_swap_b32 v4, v2
v_add_f32 v4, v4, v2
v_mov_b32 v2, v4
s_nop 1
v_permlane16_swap_b32 v4, v2
v_add_f32 v4, v4, v2
ds_write_b32 v1, v4 offset:0
s_waitcnt lgkmcnt(0)
s_barrier
ds_read_b32 v4, v5 offset:0
ds_read_b32 v2, v5 offset:64
ds_read_b32 v3, v5 offset:128
ds_read_b32 v6, v5 offset:192
s_waitcnt lgkmcnt(0)
v_add_f32 v4, v4, v2
v_add_f32 v3, v3, v6
v_add_f32 v4, v4, v3
v_mul_f32 v4, 0x3acccccd, v4
v_sub_f32 v28, v28, v4
v_sub_f32 v29, v29, v4
v_sub_f32 v30, v30, v4
v_sub_f32 v31, v31, v4
v_sub_f32 v32, v32, v4
v_sub_f32 v33, v33, v4
v_sub_f32 v34, v34, v4
v_sub_f32 v35, v35, v4
v_sub_f32 v36, v36, v4
v_sub_f32 v37, v37, v4
v_sub_f32 v38, v38, v4
v_sub_f32 v39, v39, v4
v_sub_f32 v40, v40, v4
v_sub_f32 v41, v41, v4
v_sub_f32 v42, v42, v4
v_sub_f32 v43, v43, v4
v_sub_f32 v44, v44, v4
v_sub_f32 v45, v45, v4
v_sub_f32 v46, v46, v4
v_sub_f32 v47, v47, v4
v_sub_f32 v48, v48, v4
v_sub_f32 v49, v49, v4
v_sub_f32 v50, v50, v4
v_sub_f32 v51, v51, v4
v_sub_f32 v52, v52, v4
v_sub_f32 v53, v53, v4
v_sub_f32 v54, v54, v4
v_sub_f32 v55, v55, v4
v_sub_f32 v56, v56, v4
v_sub_f32 v57, v57, v4
v_sub_f32 v58, v58, v4
v_sub_f32 v59, v59, v4
v_sub_f32 v60, v60, v4
v_sub_f32 v61, v61, v4
v_sub_f32 v62, v62, v4
v_sub_f32 v63, v63, v4
v_sub_f32 v64, v64, v4
v_sub_f32 v65, v65, v4
v_sub_f32 v66, v66, v4
v_sub_f32 v67, v67, v4
v_mul_f32 v6, v28, v28
v_mul_f32 v7, v29, v29
v_fmac_f32 v6, v30, v30
v_fmac_f32 v7, v31, v31
v_fmac_f32 v6, v32, v32
v_fmac_f32 v7, v33, v33
v_fmac_f32 v6, v34, v34
v_fmac_f32 v7, v35, v35
v_fmac_f32 v6, v36, v36
v_fmac_f32 v7, v37, v37
v_fmac_f32 v6, v38, v38
v_fmac_f32 v7, v39, v39
v_fmac_f32 v6, v40, v40
v_fmac_f32 v7, v41, v41
v_fmac_f32 v6, v42, v42
v_fmac_f32 v7, v43, v43
v_fmac_f32 v6, v44, v44
v_fmac_f32 v7, v45, v45
v_fmac_f32 v6, v46, v46
v_fmac_f32 v7, v47, v47
v_fmac_f32 v6, v48, v48
v_fmac_f32 v7, v49, v49
v_fmac_f32 v6, v50, v50
v_fmac_f32 v7, v51, v51
v_fmac_f32 v6, v52, v52
v_fmac_f32 v7, v53, v53
v_fmac_f32 v6, v54, v54
v_fmac_f32 v7, v55, v55
v_fmac_f32 v6, v56, v56
v_fmac_f32 v7, v57, v57
v_fmac_f32 v6, v58, v58
v_fmac_f32 v7, v59, v59
v_fmac_f32 v6, v60, v60
v_fmac_f32 v7, v61, v61
v_fmac_f32 v6, v62, v62
v_fmac_f32 v7, v63, v63
v_fmac_f32 v6, v64, v64
v_fmac_f32 v7, v65, v65
v_fmac_f32 v6, v66, v66
v_fmac_f32 v7, v67, v67
v_add_f32 v4, v6, v7
v_mov_b32 v2, v4
s_nop 1
v_permlane32_swap_b32 v4, v2
v_add_f32 v4, v4, v2
v_mov_b32 v2, v4
s_nop 1
v_permlane16_swap_b32 v4, v2
v_add_f32 v4, v4, v2
ds_write_b32 v1, v4 offset:256
s_waitcnt lgkmcnt(0)
s_barrier
ds_read_b32 v4, v5 offset:256
ds_read_b32 v2, v5 offset:320
ds_read_b32 v3, v5 offset:384
ds_read_b32 v6, v5 offset:448
s_waitcnt lgkmcnt(0)
v_add_f32 v4, v4, v2
v_add_f32 v3, v3, v6
v_add_f32 v4, v4, v3
v_mov_b32 v2, 0x3727c5ac
v_fmac_f32 v2, 0x3acccccd, v4
v_rsq_f32 v4, v2
s_nop 0
v_mul_f32 v28, v28, v4
v_mul_f32 v29, v29, v4
v_mul_f32 v30, v30, v4
v_mul_f32 v31, v31, v4
v_mul_f32 v32, v32, v4
v_mul_f32 v33, v33, v4
v_mul_f32 v34, v34, v4
v_mul_f32 v35, v35, v4
v_mul_f32 v36, v36, v4
v_mul_f32 v37, v37, v4
v_mul_f32 v38, v38, v4
v_mul_f32 v39, v39, v4
v_mul_f32 v40, v40, v4
v_mul_f32 v41, v41, v4
v_mul_f32 v42, v42, v4
v_mul_f32 v43, v43, v4
v_mul_f32 v44, v44, v4
v_mul_f32 v45, v45, v4
v_mul_f32 v46, v46, v4
v_mul_f32 v47, v47, v4
v_mul_f32 v48, v48, v4
v_mul_f32 v49, v49, v4
v_mul_f32 v50, v50, v4
v_mul_f32 v51, v51, v4
v_mul_f32 v52, v52, v4
v_mul_f32 v53, v53, v4
v_mul_f32 v54, v54, v4
v_mul_f32 v55, v55, v4
v_mul_f32 v56, v56, v4
v_mul_f32 v57, v57, v4
v_mul_f32 v58, v58, v4
v_mul_f32 v59, v59, v4
v_mul_f32 v60, v60, v4
v_mul_f32 v61, v61, v4
v_mul_f32 v62, v62, v4
v_mul_f32 v63, v63, v4
v_mul_f32 v64, v64, v4
v_mul_f32 v65, v65, v4
v_mul_f32 v66, v66, v4
v_mul_f32 v67, v67, v4
v_cvt_pk_bf16_f32 v8, v28, v29
v_cvt_pk_bf16_f32 v9, v30, v31
v_cvt_pk_bf16_f32 v10, v32, v33
v_cvt_pk_bf16_f32 v11, v34, v35
v_cvt_pk_bf16_f32 v12, v36, v37
v_cvt_pk_bf16_f32 v13, v38, v39
v_cvt_pk_bf16_f32 v14, v40, v41
v_cvt_pk_bf16_f32 v15, v42, v43
v_cvt_pk_bf16_f32 v16, v44, v45
v_cvt_pk_bf16_f32 v17, v46, v47
v_cvt_pk_bf16_f32 v18, v48, v49
v_cvt_pk_bf16_f32 v19, v50, v51
v_cvt_pk_bf16_f32 v20, v52, v53
v_cvt_pk_bf16_f32 v21, v54, v55
v_cvt_pk_bf16_f32 v22, v56, v57
v_cvt_pk_bf16_f32 v23, v58, v59
v_cvt_pk_bf16_f32 v24, v60, v61
v_cvt_pk_bf16_f32 v25, v62, v63
v_cvt_pk_bf16_f32 v26, v64, v65
v_cvt_pk_bf16_f32 v27, v66, v67
v_and_b32 v3, 63, v0
v_lshlrev_b32 v1, 4, v3
s_mul_i32 s17, s2, 20480
s_mul_i32 s18, s16, 5120
s_add_u32 s17, s17, s18
s_add_u32 s17, s17, 84934656
buffer_store_dwordx4 v[8:11], v1, s[4:7], s17 offen offset:0 sc1
buffer_store_dwordx4 v[12:15], v1, s[4:7], s17 offen offset:1024 sc1
buffer_store_dwordx4 v[16:19], v1, s[4:7], s17 offen offset:2048 sc1
buffer_store_dwordx4 v[20:23], v1, s[4:7], s17 offen offset:3072 sc1
s_add_u32 s17, s17, 4096
buffer_store_dwordx4 v[24:27], v1, s[4:7], s17 offen offset:0 sc1
ln2_exit1:
s_endpgm
.globl reca_kernel
.p2align 8
.type reca_kernel,@function
reca_kernel:
s_cmp_ge_u32 s2, 256
s_cbranch_scc1 reca_exitb3
s_load_dwordx2 s[48:49], s[0:1], 96
s_load_dwordx2 s[50:51], s[0:1], 88
s_load_dwordx2 s[52:53], s[0:1], 8
s_getreg_b32 s42, hwreg(HW_REG_XCC_ID, 0, 3)
v_lshrrev_b32 v28, 6, v0
v_and_b32 v29, 63, v0
s_and_b32 s13, s2, 7
v_readfirstlane_b32 s12, v28
v_lshlrev_b32 v1, 4, v29
s_lshr_b32 s14, s2, 3
s_mov_b32 s18, 0x100000
s_waitcnt lgkmcnt(0)
s_mov_b32 s57, 0
s_mov_b32 s4, s48
s_mov_b32 s5, s49
s_mov_b32 s6, 0x10000000
s_mov_b32 s7, 0x20000
s_mov_b32 s8, s50
s_mov_b32 s9, s51
s_mov_b32 s10, 256
s_mov_b32 s11, 0x20000
v_add_u32 v2, 0x1000, v1
v_add_u32 v3, 0x2000, v1
v_mov_b32 v31, 0x80000000
s_lshl_b32 s34, s42, 3
s_lshl_b64 s[36:37], 1, s34
s_lshl_b32 s34, s13, 3
v_cmp_eq_u32 vcc, 0, v0
v_mov_b32 v30, s34
s_nop 0
v_cndmask_b32 v30, v31, v30, vcc
v_mov_b32 v44, s36
v_mov_b32 v45, s37
buffer_atomic_add_x2 v[44:45], v30, s[8:11], 0 offen
s_sub_u32 s56, 0, s48
s_and_b32 s56, s56, 0x1fffff
s_add_u32 s56, s56, 2097152
s_nop 0
s_cmp_ge_u32 s14, 24
s_cbranch_scc1 reca_proj2
s_mul_i32 s34, s14, 43
s_lshr_b32 s34, s34, 8
s_mul_i32 s35, s34, 6
s_sub_u32 s16, s14, s35
s_lshl_b32 s15, s13, 2
s_add_u32 s15, s15, s34
s_lshr_b32 s19, s12, 1
s_and_b32 s37, s12, 1
s_mul_i32 s34, s15, 12
s_lshl_b32 s35, s16, 1
s_add_u32 s34, s34, s35
s_add_u32 s34, s34, s37
s_mul_i32 s34, s34, 20480
s_mov_b32 s35, 14155776
s_cmp_eq_u32 s19, 0
s_cselect_b32 s35, 6291456, s35
s_add_u32 s35, s35, s34
s_mul_i32 s36, s19, 10240
s_add_u32 s20, s35, s36
s_sub_u32 s36, 10240, s36
s_add_u32 s21, s35, s36
s_add_u32 s22, s34, 22020096
s_mul_i32 s36, s19, 10240
s_add_u32 s22, s22, s36
buffer_load_dwordx4 a[0:3], v1, s[4:7], s20 offen offset:0
buffer_load_dwordx4 a[4:7], v1, s[4:7], s20 offen offset:1024
buffer_load_dwordx4 a[8:11], v1, s[4:7], s20 offen offset:2048
buffer_load_dwordx4 a[12:15], v1, s[4:7], s20 offen offset:3072
buffer_load_dwordx4 a[16:19], v2, s[4:7], s20 offen offset:0
buffer_load_dwordx4 a[20:23], v2, s[4:7], s20 offen offset:1024
buffer_load_dwordx4 a[24:27], v2, s[4:7], s20 offen offset:2048
buffer_load_dwordx4 a[28:31], v2, s[4:7], s20 offen offset:3072
buffer_load_dwordx4 a[32:35], v3, s[4:7], s20 offen offset:0
buffer_load_dwordx4 a[36:39], v3, s[4:7], s20 offen offset:1024
buffer_load_dwordx4 a[40:43], v1, s[4:7], s21 offen offset:0
buffer_load_dwordx4 a[44:47], v1, s[4:7], s21 offen offset:1024
buffer_load_dwordx4 a[48:51], v1, s[4:7], s21 offen offset:2048
buffer_load_dwordx4 a[52:55], v1, s[4:7], s21 offen offset:3072
buffer_load_dwordx4 a[56:59], v2, s[4:7], s21 offen offset:0
buffer_load_dwordx4 a[60:63], v2, s[4:7], s21 offen offset:1024
buffer_load_dwordx4 a[64:67], v2, s[4:7], s21 offen offset:2048
buffer_load_dwordx4 a[68:71], v2, s[4:7], s21 offen offset:3072
buffer_load_dwordx4 a[72:75], v3, s[4:7], s21 offen offset:0
buffer_load_dwordx4 a[76:79], v3, s[4:7], s21 offen offset:1024
buffer_load_dwordx4 a[80:83], v1, s[4:7], s22 offen offset:0
buffer_load_dwordx4 a[84:87], v1, s[4:7], s22 offen offset:1024
buffer_load_dwordx4 a[88:91], v1, s[4:7], s22 offen offset:2048
buffer_load_dwordx4 a[92:95], v1, s[4:7], s22 offen offset:3072
buffer_load_dwordx4 a[96:99], v2, s[4:7], s22 offen offset:0
buffer_load_dwordx4 a[100:103], v2, s[4:7], s22 offen offset:1024
buffer_load_dwordx4 a[104:107], v2, s[4:7], s22 offen offset:2048
buffer_load_dwordx4 a[108:111], v2, s[4:7], s22 offen offset:3072
buffer_load_dwordx4 a[112:115], v3, s[4:7], s22 offen offset:0
buffer_load_dwordx4 a[116:119], v3, s[4:7], s22 offen offset:1024
s_cmp_ge_u32 s14, 20
s_cbranch_scc1 reca_now24
s_cmp_ge_u32 s12, 2
s_cbranch_scc1 reca_now24
s_lshl_b32 s34, s14, 1
s_add_u32 s34, s34, s12
s_mul_i32 s34, s34, 192
s_mul_i32 s35, s13, 24
s_add_u32 s34, s34, s35
s_lshl_b32 s34, s34, 10
s_add_u32 s34, s34, 29884416
buffer_load_dwordx4 a[120:123], v1, s[4:7], s34 offen offset:0
buffer_load_dwordx4 a[124:127], v1, s[4:7], s34 offen offset:1024
buffer_load_dwordx4 a[128:131], v1, s[4:7], s34 offen offset:2048
buffer_load_dwordx4 a[132:135], v1, s[4:7], s34 offen offset:3072
buffer_load_dwordx4 a[136:139], v2, s[4:7], s34 offen offset:0
buffer_load_dwordx4 a[140:143], v2, s[4:7], s34 offen offset:1024
buffer_load_dwordx4 a[144:147], v2, s[4:7], s34 offen offset:2048
buffer_load_dwordx4 a[148:151], v2, s[4:7], s34 offen offset:3072
buffer_load_dwordx4 a[152:155], v3, s[4:7], s34 offen offset:0
buffer_load_dwordx4 a[156:159], v3, s[4:7], s34 offen offset:1024
buffer_load_dwordx4 a[160:163], v3, s[4:7], s34 offen offset:2048
buffer_load_dwordx4 a[164:167], v3, s[4:7], s34 offen offset:3072
s_add_u32 s34, s34, 12288
buffer_load_dwordx4 a[168:171], v1, s[4:7], s34 offen offset:0
buffer_load_dwordx4 a[172:175], v1, s[4:7], s34 offen offset:1024
buffer_load_dwordx4 a[176:179], v1, s[4:7], s34 offen offset:2048
buffer_load_dwordx4 a[180:183], v1, s[4:7], s34 offen offset:3072
buffer_load_dwordx4 a[184:187], v2, s[4:7], s34 offen offset:0
buffer_load_dwordx4 a[188:191], v2, s[4:7], s34 offen offset:1024
buffer_load_dwordx4 a[192:195], v2, s[4:7], s34 offen offset:2048
buffer_load_dwordx4 a[196:199], v2, s[4:7], s34 offen offset:3072
buffer_load_dwordx4 a[200:203], v3, s[4:7], s34 offen offset:0
buffer_load_dwordx4 a[204:207], v3, s[4:7], s34 offen offset:1024
buffer_load_dwordx4 a[208:211], v3, s[4:7], s34 offen offset:2048
buffer_load_dwordx4 a[212:215], v3, s[4:7], s34 offen offset:3072
reca_now24:
v_and_b32 v29, 63, v0
v_and_b32 v28, 15, v29
v_lshrrev_b32 v30, 4, v29
v_mov_b32 v32, -1
v_mov_b32 v33, -1
v_mov_b32 v34, -1
v_mov_b32 v35, -1
s_mul_i32 s34, s12, 2560
v_add_u32 v4, s34, v1
v_and_b32 v44, 31, v29
v_lshlrev_b32 v44, 4, v44
s_add_u32 s34, s34, 2048
v_add_u32 v5, s34, v44
v_and_b32 v44, 7, v29
v_lshlrev_b32 v44, 4, v44
v_lshl_add_u32 v44, v30, 7, v44
s_mul_i32 s34, s19, 5120
v_add_u32 v6, s34, v44
s_sub_u32 s34, 5120, s34
v_add_u32 v7, s34, v44
v_lshrrev_b32 v45, 3, v28
v_lshl_add_u32 v12, v45, 9, v44
s_mul_i32 s34, s19, 5120
v_add_u32 v236, s34, v12
s_sub_u32 s34, 5120, s34
v_add_u32 v237, s34, v12
v_add_u32 v13, 0x1000, v12
v_add_u32 v14, 0x2000, v12
v_cmp_gt_u32 s[54:55], 8, v28
s_lshl_b32 s34, s16, 10
s_lshl_b32 s35, s19, 7
s_add_u32 s34, s34, s35
s_and_b32 s35, s12, 1
s_lshl_b32 s36, s35, 3
s_add_u32 s34, s34, s36
v_lshlrev_b32 v44, 4, v28
v_lshl_add_u32 v45, v30, 8, v44
v_add_u32 v45, s34, v45
v_cndmask_b32 v8, v31, v45, s[54:55]
v_lshl_add_u32 v44, v30, 7, v44
v_add_u32 v45, s36, v44
v_cndmask_b32 v9, v31, v45, s[54:55]
s_lshl_b32 s34, s14, 9
v_add_u32 v45, s34, v44
v_cndmask_b32 v11, v31, v45, s[54:55]
s_mul_i32 s34, s13, 49152
s_lshr_b32 s35, s14, 3
s_lshl_b32 s35, s35, 14
s_add_u32 s34, s34, s35
s_and_b32 s35, s14, 7
s_lshl_b32 s35, s35, 10
s_add_u32 s34, s34, s35
s_lshl_b32 s35, s12, 9
s_add_u32 s34, s34, s35
v_add_u32 v45, s34, v44
v_cndmask_b32 v15, v31, v45, s[54:55]
s_cmp_lt_u32 s14, 20
s_cselect_b32 s34, 0, 0x80000000
v_or_b32 v15, s34, v15
v_lshlrev_b32 v45, 3, v29
v_cmp_gt_u32 vcc, 32, v29
s_nop 1
v_cndmask_b32 v10, v31, v45, vcc
s_sub_u32 s35, s14, 4
s_cmp_lt_u32 s14, 20
s_cselect_b32 s34, s14, s35
s_lshr_b32 s35, s34, 3
s_lshl_b32 s35, s35, 14
s_and_b32 s34, s34, 7
s_lshl_b32 s34, s34, 10
s_add_u32 s34, s34, s35
v_add_u32 v20, s34, v1
v_add_u32 v21, 49152, v20
v_add_u32 v22, 98304, v20
v_add_u32 v23, 147456, v20
v_add_u32 v24, 196608, v20
v_add_u32 v25, 245760, v20
v_add_u32 v26, 294912, v20
v_add_u32 v27, 344064, v20
v_lshrrev_b32 v44, 3, v29
v_and_b32 v44, 3, v44
v_lshlrev_b32 v44, 7, v44
v_and_b32 v45, 7, v29
v_lshl_add_u32 v44, v45, 4, v44
v_lshrrev_b32 v45, 5, v29
v_lshl_add_u32 v44, v45, 3, v44
s_lshl_b32 s34, s14, 9
s_cmp_lt_u32 s14, 20
s_cselect_b32 s34, s34, 0x80000000
v_add_u32 v16, s34, v44
v_cmp_eq_u32 vcc, 0, v29
v_mov_b32 v45, 0
s_nop 0
v_cndmask_b32 v19, v31, v45, vcc
s_lshl_b32 s34, s15, 8
s_add_u32 s34, s34, 1540096
v_and_b32 v45, 1, v29
v_lshlrev_b32 v45, 7, v45
v_add_u32 v233, s34, v45
s_lshl_b32 s34, s12, 10
s_add_u32 s34, s34, 10240
v_add_u32 v17, s34, v1
v_mov_b32 v36, 0x3f803f80
v_mov_b32 v37, 0x3f803f80
v_mov_b32 v38, 0x3f803f80
v_mov_b32 v39, 0x3f803f80
v_mov_b32 v44, 0xf149f2ca
v_cmp_gt_u32 vcc, 2, v30
s_nop 1
v_cndmask_b32 v40, 0, v44, vcc
v_mov_b32 v41, v40
v_mov_b32 v42, v40
v_mov_b32 v43, v40
v_and_b32 v44, 31, v29
v_lshlrev_b32 v44, 4, v44
v_add_u32 v45, 47972352, v44
v_add_u32 v44, 47185920, v44
v_cmp_gt_u32 vcc, 32, v29
s_nop 1
v_cndmask_b32 v238, v45, v44, vcc
s_mov_b32 s41, 0x3dd53b95
s_mul_i32 s38, s13, 40960
s_add_u32 s38, s38, 0
s_mul_i32 s39, s15, 24576
s_add_u32 s39, s39, 327680
s_mul_i32 s40, s13, 49152
s_add_u32 s40, s40, 1114112
s_mov_b32 s60, s52
s_mov_b32 s61, s53
s_mov_b32 s62, 10240
s_mov_b32 s63, 0x20000
v_and_b32 v29, 63, v0
v_and_b32 v44, 7, v29
v_mul_u32_u24 v44, 1280, v44
v_lshrrev_b32 v45, 3, v29
v_and_b32 v45, 3, v45
v_lshl_add_u32 v44, v45, 4, v44
s_mul_i32 s34, s12, 320
v_add_u32 v44, s34, v44
v_add_u32 v46, 256, v44
v_lshrrev_b32 v45, 5, v29
v_lshl_add_u32 v44, v45, 6, v44
buffer_load_dwordx4 v[128:131], v44, s[60:63], 0 offen
buffer_load_dwordx4 v[132:135], v44, s[60:63], 0 offen offset:128
buffer_load_dwordx4 v[136:139], v46, s[60:63], 0 offen
v_and_b32 v30, 7, v0
v_lshlrev_b32 v30, 3, v30
reca_cens5:
buffer_load_dwordx2 v[28:29], v30, s[8:11], 0 offen sc1
s_waitcnt vmcnt(0)
v_sad_u8 v31, v28, 0, 0
v_sad_u8 v31, v29, 0, v31
v_cmp_gt_u32 vcc, 32, v31
s_cbranch_vccz reca_censok6
s_sleep 8
s_sub_u32 s18, s18, 1
s_cbranch_scc0 reca_cens5
s_mov_b32 s18, 0
reca_censok6:
v_and_b32 v28, 0x20202020, v28
v_and_b32 v29, 0x20202020, v29
v_cmp_ne_u32 s[34:35], 0, v28
v_cmp_ne_u32 s[36:37], 0, v29
s_nop 3
s_and_b32 s34, s34, 0xff
s_and_b32 s36, s36, 0xff
s_or_b32 s35, s34, s36
s_lshr_b32 s37, s35, s13
s_and_b32 s37, s37, 1
s_xor_b32 s43, s37, 1
s_cmp_eq_u32 s57, 0
s_cselect_b32 s58, s36, s34
v_mov_b32 v31, 0x80000000
v_add_u32 v232, 0x2000, v15
s_lshr_b32 s44, s2, 4
s_lshl_b32 s44, s44, 14
s_and_b32 s34, s2, 15
s_lshl_b32 s34, s34, 9
s_add_u32 s44, s44, s34
s_add_u32 s44, s44, 1572864
s_add_u32 s44, s44, s56
s_mov_b32 s45, -1
s_mov_b32 s47, -1
s_cmp_lg_u32 s12, 2
s_cbranch_scc1 reca_noprobe7
s_add_u32 s35, s44, 0
s_memtime s[60:61]
s_waitcnt lgkmcnt(0)
buffer_load_dword v28, v19, s[4:7], s35 offen sc1
s_waitcnt vmcnt(0)
s_memtime s[62:63]
s_waitcnt lgkmcnt(0)
s_sub_u32 s36, s62, s60
s_min_u32 s45, s45, s36
s_add_u32 s35, s44, 8192
s_memtime s[60:61]
s_waitcnt lgkmcnt(0)
buffer_load_dword v28, v19, s[4:7], s35 offen sc1
s_waitcnt vmcnt(0)
s_memtime s[62:63]
s_waitcnt lgkmcnt(0)
s_sub_u32 s36, s62, s60
s_min_u32 s47, s47, s36
s_add_u32 s35, s44, 128
s_memtime s[60:61]
s_waitcnt lgkmcnt(0)
buffer_load_dword v28, v19, s[4:7], s35 offen sc1
s_waitcnt vmcnt(0)
s_memtime s[62:63]
s_waitcnt lgkmcnt(0)
s_sub_u32 s36, s62, s60
s_min_u32 s45, s45, s36
s_add_u32 s35, s44, 8320
s_memtime s[60:61]
s_waitcnt lgkmcnt(0)
buffer_load_dword v28, v19, s[4:7], s35 offen sc1
s_waitcnt vmcnt(0)
s_memtime s[62:63]
s_waitcnt lgkmcnt(0)
s_sub_u32 s36, s62, s60
s_min_u32 s47, s47, s36
s_add_u32 s35, s44, 256
s_memtime s[60:61]
s_waitcnt lgkmcnt(0)
buffer_load_dword v28, v19, s[4:7], s35 offen sc1
s_waitcnt vmcnt(0)
s_memtime s[62:63]
s_waitcnt lgkmcnt(0)
s_sub_u32 s36, s62, s60
s_min_u32 s45, s45, s36
s_add_u32 s35, s44, 8448
s_memtime s[60:61]
s_waitcnt lgkmcnt(0)
buffer_load_dword v28, v19, s[4:7], s35 offen sc1
s_waitcnt vmcnt(0)
s_memtime s[62:63]
s_waitcnt lgkmcnt(0)
s_sub_u32 s36, s62, s60
s_min_u32 s47, s47, s36
s_cmp_lt_u32 s47, s45
s_cbranch_scc0 reca_noprobe7
v_add_u32 v20, 0x2000, v20
v_add_u32 v21, 0x2000, v21
v_add_u32 v22, 0x2000, v22
v_add_u32 v23, 0x2000, v23
v_add_u32 v24, 0x2000, v24
v_add_u32 v25, 0x2000, v25
v_add_u32 v26, 0x2000, v26
v_add_u32 v27, 0x2000, v27
reca_noprobe7:
s_lshl_b32 s59, s13, 2
s_add_u32 s59, s59, s14
s_sub_u32 s59, s59, 20
v_and_b32 v29, 63, v0
v_and_b32 v28, 15, v29
v_lshrrev_b32 v30, 4, v29
v_lshlrev_b32 v92, 4, v28
v_lshl_add_u32 v92, v30, 7, v92
v_cmp_gt_u32 vcc, 8, v28
s_nop 1
v_cndmask_b32 v92, v31, v92, vcc
v_lshlrev_b32 v93, 3, v29
v_cmp_gt_u32 vcc, 32, v29
s_nop 1
v_cndmask_b32 v93, v31, v93, vcc
v_mov_b32 v82, 0xf149f2ca
v_cmp_le_u32 vcc, 2, v30
s_nop 1
v_cndmask_b32 v84, 0, v82, vcc
v_mov_b32 v85, v84
v_mov_b32 v86, v84
v_mov_b32 v87, v84
v_lshlrev_b32 v30, 2, v30
v_add_u32 v29, 0, v30
v_cmp_gt_u32 vcc, v29, v28
s_nop 1
v_cndmask_b32 v88, 0, v82, vcc
v_add_u32 v29, 1, v30
v_cmp_gt_u32 vcc, v29, v28
s_nop 1
v_cndmask_b32 v89, 0, v82, vcc
v_add_u32 v29, 2, v30
v_cmp_gt_u32 vcc, v29, v28
s_nop 1
v_cndmask_b32 v90, 0, v82, vcc
v_add_u32 v29, 3, v30
v_cmp_gt_u32 vcc, v29, v28
s_nop 1
v_cndmask_b32 v91, 0, v82, vcc
s_mov_b32 s17, 0
s_cmp_lg_u32 s12, 3
s_cbranch_scc1 reca_nopf08
s_add_u32 s37, s17, 1
reca_pf9:
buffer_load_dword v28, v233, s[4:7], 0 offen sc1
s_waitcnt vmcnt(0)
v_cmp_gt_i32 vcc, s37, v28
s_cbranch_vccz reca_pfok10
s_sleep 1
s_sub_u32 s18, s18, 1
s_cbranch_scc0 reca_pf9
s_mov_b32 s18, 0
reca_pfok10:
s_lshl_b32 s34, s15, 3
s_and_b32 s35, s17, 7
s_add_u32 s34, s34, s35
s_mul_i32 s34, s34, 12288
s_add_u32 s32, s34, 37748736
s_lshl_b32 s35, s16, 11
s_add_u32 s34, s34, s35
s_add_u32 s33, s34, 40894464
buffer_load_dwordx4 a[120:123], v1, s[4:7], s32 offen offset:0 sc1
buffer_load_dwordx4 a[124:127], v1, s[4:7], s32 offen offset:1024 sc1
buffer_load_dwordx4 a[128:131], v1, s[4:7], s32 offen offset:2048 sc1
buffer_load_dwordx4 a[132:135], v1, s[4:7], s32 offen offset:3072 sc1
buffer_load_dwordx4 a[136:139], v2, s[4:7], s32 offen offset:0 sc1
buffer_load_dwordx4 a[140:143], v2, s[4:7], s32 offen offset:1024 sc1
buffer_load_dwordx4 a[144:147], v2, s[4:7], s32 offen offset:2048 sc1
buffer_load_dwordx4 a[148:151], v2, s[4:7], s32 offen offset:3072 sc1
buffer_load_dwordx4 a[152:155], v3, s[4:7], s32 offen offset:0 sc1
buffer_load_dwordx4 a[156:159], v3, s[4:7], s32 offen offset:1024 sc1
buffer_load_dwordx4 a[160:163], v3, s[4:7], s32 offen offset:2048 sc1
buffer_load_dwordx4 a[164:167], v3, s[4:7], s32 offen offset:3072 sc1
buffer_load_dwordx4 a[168:171], v1, s[4:7], s33 offen offset:0 sc1
buffer_load_dwordx4 a[172:175], v1, s[4:7], s33 offen offset:1024 sc1
s_waitcnt vmcnt(0)
reca_nopf08:
s_cmp_lg_u32 s43, 0
s_cbranch_scc1 reca_slow11
s_cmp_ge_u32 s14, 20
s_cbranch_scc1 reca_twinf12
s_branch reca_gotmem15
reca_step14:
s_and_b32 s34, s17, 3
s_mul_i32 s20, s34, 10240
s_add_u32 s20, s20, s38
s_sleep 2
buffer_load_dwordx4 v[128:131], v4, s[4:7], s20 offen sc1
buffer_load_dwordx4 v[132:135], v4, s[4:7], s20 offen offset:1024 sc1
buffer_load_dwordx4 v[136:139], v5, s[4:7], s20 offen sc1
s_waitcnt vmcnt(2)
v_max_u32 v29, v128, v130
v_cmp_eq_u32 vcc, -1, v29
s_cbranch_vccnz reca_retry17
reca_resume18:
s_waitcnt vmcnt(1)
v_max_u32 v29, v132, v134
v_cmp_eq_u32 vcc, -1, v29
ds_write_b128 v4, v[128:131]
s_cbranch_vccnz reca_retry19
reca_resume20:
s_waitcnt vmcnt(0)
v_max_u32 v29, v136, v138
v_cmp_eq_u32 vcc, -1, v29
ds_write_b128 v4, v[132:135] offset:1024
s_cbranch_vccnz reca_retry21
reca_resume22:
ds_write_b128 v5, v[136:139]
s_branch reca_gotmem216
reca_gotmem15:
ds_write_b128 v4, v[128:131]
ds_write_b128 v4, v[132:135] offset:1024
ds_write_b128 v5, v[136:139]
reca_gotmem216:
s_and_b32 s34, s17, 3
s_mul_i32 s21, s34, 6144
s_add_u32 s21, s21, s39
s_mul_i32 s22, s34, 12288
s_add_u32 s22, s22, s40
s_mul_i32 s25, s34, 393216
s_add_u32 s25, s25, s56
s_add_u32 s35, s17, 1
s_and_b32 s35, s35, 3
s_mul_i32 s24, s35, 10240
s_add_u32 s24, s24, s38
s_waitcnt lgkmcnt(0)
s_barrier
ds_read_b128 v[128:131], v236 offset:0
ds_read_b128 v[132:135], v236 offset:1024
ds_read_b128 v[136:139], v236 offset:2048
ds_read_b128 v[140:143], v236 offset:3072
ds_read_b128 v[144:147], v236 offset:4096
ds_read_b128 v[148:151], v237 offset:0
ds_read_b128 v[152:155], v237 offset:1024
ds_read_b128 v[156:159], v237 offset:2048
ds_read_b128 v[160:163], v237 offset:3072
ds_read_b128 v[164:167], v237 offset:4096
s_waitcnt lgkmcnt(9)
v_mfma_f32_16x16x32_bf16 v[44:47], a[0:3], v[128:131], 0
ds_read_b128 v[168:171], v6 offset:0
v_mfma_f32_16x16x32_bf16 v[240:243], a[4:7], v[128:131], 0
s_waitcnt lgkmcnt(9)
v_mfma_f32_16x16x32_bf16 v[44:47], a[8:11], v[132:135], v[44:47]
ds_read_b128 v[172:175], v6 offset:512
v_mfma_f32_16x16x32_bf16 v[240:243], a[12:15], v[132:135], v[240:243]
s_waitcnt lgkmcnt(9)
v_mfma_f32_16x16x32_bf16 v[44:47], a[16:19], v[136:139], v[44:47]
ds_read_b128 v[176:179], v6 offset:1024
v_mfma_f32_16x16x32_bf16 v[240:243], a[20:23], v[136:139], v[240:243]
s_waitcnt lgkmcnt(9)
v_mfma_f32_16x16x32_bf16 v[44:47], a[24:27], v[140:143], v[44:47]
ds_read_b128 v[180:183], v6 offset:1536
v_mfma_f32_16x16x32_bf16 v[240:243], a[28:31], v[140:143], v[240:243]
s_waitcnt lgkmcnt(9)
v_mfma_f32_16x16x32_bf16 v[44:47], a[32:35], v[144:147], v[44:47]
ds_read_b128 v[184:187], v6 offset:2048
v_mfma_f32_16x16x32_bf16 v[240:243], a[36:39], v[144:147], v[240:243]
s_waitcnt lgkmcnt(9)
v_mfma_f32_16x16x32_bf16 v[44:47], a[40:43], v[148:151], v[44:47]
ds_read_b128 v[188:191], v6 offset:2560
v_mfma_f32_16x16x32_bf16 v[240:243], a[44:47], v[148:151], v[240:243]
s_waitcnt lgkmcnt(9)
v_mfma_f32_16x16x32_bf16 v[44:47], a[48:51], v[152:155], v[44:47]
ds_read_b128 v[192:195], v6 offset:3072
v_mfma_f32_16x16x32_bf16 v[240:243], a[52:55], v[152:155], v[240:243]
s_waitcnt lgkmcnt(9)
v_mfma_f32_16x16x32_bf16 v[44:47], a[56:59], v[156:159], v[44:47]
ds_read_b128 v[196:199], v6 offset:3584
v_mfma_f32_16x16x32_bf16 v[240:243], a[60:63], v[156:159], v[240:243]
s_waitcnt lgkmcnt(9)
v_mfma_f32_16x16x32_bf16 v[44:47], a[64:67], v[160:163], v[44:47]
ds_read_b128 v[200:203], v6 offset:4096
v_mfma_f32_16x16x32_bf16 v[240:243], a[68:71], v[160:163], v[240:243]
s_waitcnt lgkmcnt(9)
v_mfma_f32_16x16x32_bf16 v[44:47], a[72:75], v[164:167], v[44:47]
ds_read_b128 v[204:207], v6 offset:4608
v_mfma_f32_16x16x32_bf16 v[240:243], a[76:79], v[164:167], v[240:243]
s_waitcnt lgkmcnt(9)
v_mfma_f32_16x16x32_bf16 v[48:51], v[168:171], a[80:83], 0
s_and_b32 s34, s17, 7
s_lshl_b32 s34, s34, 5
s_add_u32 s34, s34, s15
s_mul_i32 s34, s34, 3072
s_lshl_b32 s35, s16, 9
s_add_u32 s34, s34, s35
s_add_u32 s30, s34, 47185920
s_add_u32 s31, s34, 47972352
v_add_f32_dpp v44, v240, v44 row_ror:8 row_mask:0xf bank_mask:0xf
v_add_f32_dpp v45, v241, v45 row_ror:8 row_mask:0xf bank_mask:0xf
v_add_f32_dpp v46, v242, v46 row_ror:8 row_mask:0xf bank_mask:0xf
v_add_f32_dpp v47, v243, v47 row_ror:8 row_mask:0xf bank_mask:0xf
v_cvt_pk_bf16_f32 v52, v44, v45
v_cvt_pk_bf16_f32 v53, v46, v47
buffer_store_dwordx2 v[52:53], v8, s[4:7], s21 offen
s_waitcnt lgkmcnt(8)
v_mfma_f32_16x16x32_bf16 v[48:51], v[172:175], a[84:87], v[48:51]
s_waitcnt lgkmcnt(7)
v_mfma_f32_16x16x32_bf16 v[48:51], v[176:179], a[88:91], v[48:51]
s_waitcnt lgkmcnt(6)
v_mfma_f32_16x16x32_bf16 v[48:51], v[180:183], a[92:95], v[48:51]
s_waitcnt lgkmcnt(5)
v_mfma_f32_16x16x32_bf16 v[48:51], v[184:187], a[96:99], v[48:51]
s_waitcnt lgkmcnt(4)
v_mfma_f32_16x16x32_bf16 v[48:51], v[188:191], a[100:103], v[48:51]
s_waitcnt lgkmcnt(3)
v_mfma_f32_16x16x32_bf16 v[48:51], v[192:195], a[104:107], v[48:51]
s_waitcnt lgkmcnt(2)
v_mfma_f32_16x16x32_bf16 v[48:51], v[196:199], a[108:111], v[48:51]
s_waitcnt lgkmcnt(1)
v_mfma_f32_16x16x32_bf16 v[48:51], v[200:203], a[112:115], v[48:51]
s_waitcnt lgkmcnt(0)
v_mfma_f32_16x16x32_bf16 v[48:51], v[204:207], a[116:119], v[48:51]
s_cmp_eq_u32 s12, 3
s_cbranch_scc1 reca_swave23
s_nop 5
ds_write_b128 v17, v[48:51]
s_add_u32 s34, s17, 2
s_and_b32 s34, s34, 3
s_mul_i32 s26, s34, 10240
s_add_u32 s26, s26, s38
s_mul_i32 s27, s34, 6144
s_add_u32 s27, s27, s39
s_mul_i32 s28, s34, 12288
s_add_u32 s28, s28, s40
s_mul_i32 s29, s34, 393216
s_add_u32 s29, s29, s56
s_waitcnt lgkmcnt(0)
s_barrier
s_cmp_eq_u32 s17, 63
s_cbranch_scc1 reca_last25
buffer_store_dwordx2 v[32:33], v8, s[4:7], s27 offen
s_cmp_lg_u32 s12, 2
s_cbranch_scc1 reca_b326
buffer_store_dwordx2 v[52:53], v9, s[4:7], s30 offen
buffer_store_dwordx2 v[32:33], v16, s[4:7], s26 offen
s_cmp_lg_u32 s14, 0
s_cbranch_scc1 reca_b326
v_mov_b32 v28, s17
s_lshl_b32 s34, s13, 7
s_add_u32 s34, s34, 1507328
buffer_store_dword v28, v19, s[4:7], s34 offen
s_branch reca_b326
reca_last25:
s_cmp_lg_u32 s12, 2
s_cbranch_scc1 reca_exit1
buffer_store_dwordx2 v[52:53], v9, s[4:7], s30 offen
s_branch reca_exit1
reca_swave23:
s_cmp_lg_u32 s17, 63
s_cbranch_scc1 reca_vmst29
s_barrier
ds_read_b128 v[56:59], v1 offset:10240
ds_read_b128 v[60:63], v1 offset:11264
ds_read_b128 v[64:67], v1 offset:12288
s_waitcnt lgkmcnt(0)
v_add_f32 v56, v56, v64
v_add_f32 v60, v60, v48
v_add_f32 v57, v57, v65
v_add_f32 v61, v61, v49
v_add_f32 v58, v58, v66
v_add_f32 v62, v62, v50
v_add_f32 v59, v59, v67
v_add_f32 v63, v63, v51
v_cvt_pk_bf16_f32 v68, v56, v57
v_cvt_pk_bf16_f32 v69, v58, v59
v_cvt_pk_bf16_f32 v70, v60, v61
v_cvt_pk_bf16_f32 v71, v62, v63
buffer_store_dwordx2 v[52:53], v9, s[4:7], s30 offen
buffer_store_dwordx2 v[68:69], v10, s[4:7], s31 offen
buffer_store_dwordx2 v[70:71], v10, s[4:7], s31 offen offset:256
s_branch reca_exit1
reca_vmst29:
s_sleep 1
buffer_load_dwordx4 v[208:211], v1, s[4:7], s21 offen offset:0 sc1
buffer_load_dwordx4 v[212:215], v1, s[4:7], s21 offen offset:1024 sc1
buffer_load_dwordx4 v[216:219], v1, s[4:7], s21 offen offset:2048 sc1
buffer_load_dwordx4 v[220:223], v1, s[4:7], s21 offen offset:3072 sc1
buffer_load_dwordx4 v[224:227], v2, s[4:7], s21 offen offset:0 sc1
buffer_load_dwordx4 v[228:231], v2, s[4:7], s21 offen offset:1024 sc1
s_waitcnt vmcnt(5)
v_max_u32 v29, v208, v210
v_cmp_eq_u32 vcc, -1, v29
s_cbranch_vccnz reca_retry30
reca_resume31:
s_waitcnt vmcnt(4)
v_max_u32 v29, v212, v214
v_cmp_eq_u32 vcc, -1, v29
v_mfma_f32_16x16x32_bf16 v[76:79], a[120:123], v[208:211], 0
v_mfma_f32_16x16x32_bf16 v[80:83], a[144:147], v[208:211], 0
v_mfma_f32_16x16x32_bf16 v[72:75], v[208:211], v[208:211], v[40:43]
s_cbranch_vccnz reca_retry32
reca_resume33:
s_waitcnt vmcnt(3)
v_max_u32 v29, v216, v218
v_cmp_eq_u32 vcc, -1, v29
v_mfma_f32_16x16x32_bf16 v[76:79], a[124:127], v[212:215], v[76:79]
v_mfma_f32_16x16x32_bf16 v[80:83], a[148:151], v[212:215], v[80:83]
v_mfma_f32_16x16x32_bf16 v[72:75], v[212:215], v[212:215], v[72:75]
s_cbranch_vccnz reca_retry34
reca_resume35:
s_waitcnt vmcnt(2)
v_max_u32 v29, v220, v222
v_cmp_eq_u32 vcc, -1, v29
v_mfma_f32_16x16x32_bf16 v[76:79], a[128:131], v[216:219], v[76:79]
v_mfma_f32_16x16x32_bf16 v[80:83], a[152:155], v[216:219], v[80:83]
v_mfma_f32_16x16x32_bf16 v[72:75], v[216:219], v[216:219], v[72:75]
s_cbranch_vccnz reca_retry36
reca_resume37:
s_waitcnt vmcnt(1)
v_max_u32 v29, v224, v226
v_cmp_eq_u32 vcc, -1, v29
v_mfma_f32_16x16x32_bf16 v[76:79], a[132:135], v[220:223], v[76:79]
v_mfma_f32_16x16x32_bf16 v[80:83], a[156:159], v[220:223], v[80:83]
v_mfma_f32_16x16x32_bf16 v[72:75], v[220:223], v[220:223], v[72:75]
s_cbranch_vccnz reca_retry38
reca_resume39:
s_waitcnt vmcnt(0)
v_max_u32 v29, v228, v230
v_cmp_eq_u32 vcc, -1, v29
v_mfma_f32_16x16x32_bf16 v[76:79], a[136:139], v[224:227], v[76:79]
v_mfma_f32_16x16x32_bf16 v[80:83], a[160:163], v[224:227], v[80:83]
v_mfma_f32_16x16x32_bf16 v[72:75], v[224:227], v[224:227], v[72:75]
s_cbranch_vccnz reca_retry40
reca_resume41:
v_mfma_f32_16x16x32_bf16 v[76:79], a[140:143], v[228:231], v[76:79]
v_mfma_f32_16x16x32_bf16 v[80:83], a[164:167], v[228:231], v[80:83]
v_mfma_f32_16x16x32_bf16 v[72:75], v[228:231], v[228:231], v[72:75]
s_barrier
ds_read_b128 v[56:59], v1 offset:10240
ds_read_b128 v[60:63], v1 offset:11264
ds_read_b128 v[64:67], v1 offset:12288
s_nop 1
v_max3_f32 v28, v76, v77, v78
v_max3_f32 v29, v80, v81, v82
v_max3_f32 v28, v28, v79, v83
v_max3_f32 v29, v29, v72, v73
v_max3_f32 v28, v28, v74, v75
v_max_f32 v28, v28, v29
v_mov_b32 v29, v28
s_nop 1
v_permlane32_swap_b32 v28, v29
v_max_f32 v28, v28, v29
v_mov_b32 v29, v28
s_nop 1
v_permlane16_swap_b32 v28, v29
v_max_f32 v28, v28, v29
v_mul_f32 v28, s41, v28
v_fma_f32 v76, v76, s41, -v28
v_fma_f32 v77, v77, s41, -v28
v_fma_f32 v78, v78, s41, -v28
v_fma_f32 v79, v79, s41, -v28
v_fma_f32 v80, v80, s41, -v28
v_fma_f32 v81, v81, s41, -v28
v_fma_f32 v82, v82, s41, -v28
v_fma_f32 v83, v83, s41, -v28
v_fma_f32 v72, v72, s41, -v28
v_fma_f32 v73, v73, s41, -v28
v_fma_f32 v74, v74, s41, -v28
v_fma_f32 v75, v75, s41, -v28
v_exp_f32 v76, v76
v_exp_f32 v77, v77
v_exp_f32 v78, v78
v_exp_f32 v79, v79
v_exp_f32 v80, v80
v_exp_f32 v81, v81
v_exp_f32 v82, v82
v_exp_f32 v83, v83
v_cvt_pk_bf16_f32 v84, v76, v77
v_cvt_pk_bf16_f32 v85, v78, v79
v_cvt_pk_bf16_f32 v86, v80, v81
v_cvt_pk_bf16_f32 v87, v82, v83
v_exp_f32 v72, v72
v_exp_f32 v73, v73
v_mfma_f32_16x16x32_bf16 v[100:103], v[36:39], v[84:87], 0
v_exp_f32 v74, v74
v_exp_f32 v75, v75
v_mfma_f32_16x16x32_bf16 v[92:95], a[168:171], v[84:87], 0
v_cvt_pk_bf16_f32 v88, v72, v73
v_cvt_pk_bf16_f32 v89, v74, v75
v_mfma_f32_16x16x32_bf16 v[96:99], a[172:175], v[84:87], 0
s_waitcnt lgkmcnt(0)
v_mfma_f32_16x16x16_bf16 v[100:103], v[36:37], v[88:89], v[100:103]
v_add_f32 v56, v56, v64
v_add_f32 v60, v60, v48
v_add_f32 v57, v57, v65
v_add_f32 v61, v61, v49
v_add_f32 v58, v58, v66
v_add_f32 v62, v62, v50
v_add_f32 v59, v59, v67
v_add_f32 v63, v63, v51
v_cvt_pk_bf16_f32 v68, v56, v57
v_cvt_pk_bf16_f32 v69, v58, v59
v_cvt_pk_bf16_f32 v70, v60, v61
v_cvt_pk_bf16_f32 v71, v62, v63
v_mfma_f32_16x16x16_bf16 v[92:95], v[68:69], v[88:89], v[92:95]
v_rcp_f32 v28, v100
v_mfma_f32_16x16x16_bf16 v[96:99], v[70:71], v[88:89], v[96:99]
v_mov_b32 v29, v28
s_nop 4
v_pk_mul_f32 v[92:93], v[92:93], v[28:29]
v_pk_mul_f32 v[94:95], v[94:95], v[28:29]
v_pk_mul_f32 v[96:97], v[96:97], v[28:29]
v_pk_mul_f32 v[98:99], v[98:99], v[28:29]
v_cvt_pk_bf16_f32 v104, v92, v93
v_cvt_pk_bf16_f32 v105, v94, v95
v_cvt_pk_bf16_f32 v106, v96, v97
v_cvt_pk_bf16_f32 v107, v98, v99
buffer_store_dwordx4 v[104:107], v11, s[4:7], s22 offen
reca_b326:
s_barrier
s_cmp_ge_u32 s12, 2
s_cbranch_scc1 reca_notg242
s_sleep 3
buffer_load_dwordx4 v[128:131], v12, s[4:7], s22 offen offset:0 sc1
buffer_load_dwordx4 v[132:135], v12, s[4:7], s22 offen offset:1024 sc1
buffer_load_dwordx4 v[136:139], v12, s[4:7], s22 offen offset:2048 sc1
buffer_load_dwordx4 v[140:143], v12, s[4:7], s22 offen offset:3072 sc1
buffer_load_dwordx4 v[144:147], v13, s[4:7], s22 offen offset:0 sc1
buffer_load_dwordx4 v[148:151], v13, s[4:7], s22 offen offset:1024 sc1
buffer_load_dwordx4 v[152:155], v13, s[4:7], s22 offen offset:2048 sc1
buffer_load_dwordx4 v[156:159], v13, s[4:7], s22 offen offset:3072 sc1
buffer_load_dwordx4 v[160:163], v14, s[4:7], s22 offen offset:0 sc1
buffer_load_dwordx4 v[164:167], v14, s[4:7], s22 offen offset:1024 sc1
buffer_load_dwordx4 v[168:171], v14, s[4:7], s22 offen offset:2048 sc1
buffer_load_dwordx4 v[172:175], v14, s[4:7], s22 offen offset:3072 sc1
s_waitcnt vmcnt(11)
v_cmp_eq_u32 vcc, -1, v128
s_cbranch_vccnz reca_retry43
reca_resume44:
s_waitcnt vmcnt(10)
v_cmp_eq_u32 vcc, -1, v132
v_mfma_f32_16x16x32_bf16 v[108:111], a[120:123], v[128:131], 0
v_mfma_f32_16x16x32_bf16 v[112:115], a[124:127], v[128:131], 0
s_cbranch_vccnz reca_retry45
reca_resume46:
s_waitcnt vmcnt(9)
v_cmp_eq_u32 vcc, -1, v136
v_mfma_f32_16x16x32_bf16 v[108:111], a[128:131], v[132:135], v[108:111]
v_mfma_f32_16x16x32_bf16 v[112:115], a[132:135], v[132:135], v[112:115]
s_cbranch_vccnz reca_retry47
reca_resume48:
s_waitcnt vmcnt(8)
v_cmp_eq_u32 vcc, -1, v140
v_mfma_f32_16x16x32_bf16 v[108:111], a[136:139], v[136:139], v[108:111]
v_mfma_f32_16x16x32_bf16 v[112:115], a[140:143], v[136:139], v[112:115]
s_cbranch_vccnz reca_retry49
reca_resume50:
s_waitcnt vmcnt(7)
v_cmp_eq_u32 vcc, -1, v144
v_mfma_f32_16x16x32_bf16 v[108:111], a[144:147], v[140:143], v[108:111]
v_mfma_f32_16x16x32_bf16 v[112:115], a[148:151], v[140:143], v[112:115]
s_cbranch_vccnz reca_retry51
reca_resume52:
s_waitcnt vmcnt(6)
v_cmp_eq_u32 vcc, -1, v148
v_mfma_f32_16x16x32_bf16 v[108:111], a[152:155], v[144:147], v[108:111]
v_mfma_f32_16x16x32_bf16 v[112:115], a[156:159], v[144:147], v[112:115]
s_cbranch_vccnz reca_retry53
reca_resume54:
s_waitcnt vmcnt(5)
v_cmp_eq_u32 vcc, -1, v152
v_mfma_f32_16x16x32_bf16 v[108:111], a[160:163], v[148:151], v[108:111]
v_mfma_f32_16x16x32_bf16 v[112:115], a[164:167], v[148:151], v[112:115]
s_cbranch_vccnz reca_retry55
reca_resume56:
s_waitcnt vmcnt(4)
v_cmp_eq_u32 vcc, -1, v156
v_mfma_f32_16x16x32_bf16 v[108:111], a[168:171], v[152:155], v[108:111]
v_mfma_f32_16x16x32_bf16 v[112:115], a[172:175], v[152:155], v[112:115]
s_cbranch_vccnz reca_retry57
reca_resume58:
s_waitcnt vmcnt(3)
v_cmp_eq_u32 vcc, -1, v160
v_mfma_f32_16x16x32_bf16 v[108:111], a[176:179], v[156:159], v[108:111]
v_mfma_f32_16x16x32_bf16 v[112:115], a[180:183], v[156:159], v[112:115]
s_cbranch_vccnz reca_retry59
reca_resume60:
s_waitcnt vmcnt(2)
v_cmp_eq_u32 vcc, -1, v164
v_mfma_f32_16x16x32_bf16 v[108:111], a[184:187], v[160:163], v[108:111]
v_mfma_f32_16x16x32_bf16 v[112:115], a[188:191], v[160:163], v[112:115]
s_cbranch_vccnz reca_retry61
reca_resume62:
s_waitcnt vmcnt(1)
v_cmp_eq_u32 vcc, -1, v168
v_mfma_f32_16x16x32_bf16 v[108:111], a[192:195], v[164:167], v[108:111]
v_mfma_f32_16x16x32_bf16 v[112:115], a[196:199], v[164:167], v[112:115]
s_cbranch_vccnz reca_retry63
reca_resume64:
s_waitcnt vmcnt(0)
v_cmp_eq_u32 vcc, -1, v172
v_mfma_f32_16x16x32_bf16 v[108:111], a[200:203], v[168:171], v[108:111]
v_mfma_f32_16x16x32_bf16 v[112:115], a[204:207], v[168:171], v[112:115]
s_cbranch_vccnz reca_retry65
reca_resume66:
v_mfma_f32_16x16x32_bf16 v[108:111], a[208:211], v[172:175], v[108:111]
v_mfma_f32_16x16x32_bf16 v[112:115], a[212:215], v[172:175], v[112:115]
s_nop 7
v_add_f32_dpp v116, v112, v108 row_ror:8 row_mask:0xf bank_mask:0xf
v_add_f32_dpp v117, v113, v109 row_ror:8 row_mask:0xf bank_mask:0xf
v_add_f32_dpp v118, v114, v110 row_ror:8 row_mask:0xf bank_mask:0xf
v_add_f32_dpp v119, v115, v111 row_ror:8 row_mask:0xf bank_mask:0xf
buffer_store_dwordx4 v[116:119], v15, s[4:7], s25 offen sc1
buffer_store_dwordx4 v[116:119], v232, s[4:7], s25 offen sc1
buffer_store_dwordx4 v[32:35], v15, s[4:7], s29 offen sc1
buffer_store_dwordx4 v[32:35], v232, s[4:7], s29 offen sc1
s_branch reca_b427
reca_notg242:
s_cmp_lg_u32 s12, 3
s_cbranch_scc1 reca_b427
s_add_u32 s34, s17, 2
s_and_b32 s34, s34, 3
s_mul_i32 s26, s34, 10240
s_add_u32 s26, s26, s38
s_mul_i32 s27, s34, 6144
s_add_u32 s27, s27, s39
s_mul_i32 s28, s34, 12288
s_add_u32 s28, s28, s40
s_mul_i32 s29, s34, 393216
s_add_u32 s29, s29, s56
buffer_store_dwordx2 v[32:33], v8, s[4:7], s27 offen
buffer_store_dwordx4 v[32:35], v11, s[4:7], s28 offen
reca_b427:
s_barrier
s_cmp_lg_u32 s12, 2
s_cbranch_scc1 reca_not267
s_sleep 8
buffer_load_dwordx4 v[128:131], v20, s[4:7], s25 offen sc1
buffer_load_dwordx4 v[132:135], v21, s[4:7], s25 offen sc1
buffer_load_dwordx4 v[136:139], v22, s[4:7], s25 offen sc1
buffer_load_dwordx4 v[140:143], v23, s[4:7], s25 offen sc1
buffer_load_dwordx4 v[144:147], v24, s[4:7], s25 offen sc1
buffer_load_dwordx4 v[148:151], v25, s[4:7], s25 offen sc1
buffer_load_dwordx4 v[152:155], v26, s[4:7], s25 offen sc1
buffer_load_dwordx4 v[156:159], v27, s[4:7], s25 offen sc1
s_waitcnt vmcnt(7)
v_cmp_eq_u32 vcc, -1, v128
s_cbranch_vccnz reca_retry68
reca_resume69:
s_waitcnt vmcnt(6)
v_cmp_eq_u32 vcc, -1, v132
s_cbranch_vccnz reca_retry70
reca_resume71:
s_waitcnt vmcnt(5)
v_cmp_eq_u32 vcc, -1, v136
v_pk_add_f32 v[116:117], v[128:129], v[132:133]
v_pk_add_f32 v[118:119], v[130:131], v[134:135]
s_cbranch_vccnz reca_retry72
reca_resume73:
s_waitcnt vmcnt(4)
v_cmp_eq_u32 vcc, -1, v140
v_pk_add_f32 v[116:117], v[116:117], v[136:137]
v_pk_add_f32 v[118:119], v[118:119], v[138:139]
s_cbranch_vccnz reca_retry74
reca_resume75:
s_waitcnt vmcnt(3)
v_cmp_eq_u32 vcc, -1, v144
v_pk_add_f32 v[116:117], v[116:117], v[140:141]
v_pk_add_f32 v[118:119], v[118:119], v[142:143]
s_cbranch_vccnz reca_retry76
reca_resume77:
s_waitcnt vmcnt(2)
v_cmp_eq_u32 vcc, -1, v148
v_pk_add_f32 v[116:117], v[116:117], v[144:145]
v_pk_add_f32 v[118:119], v[118:119], v[146:147]
s_cbranch_vccnz reca_retry78
reca_resume79:
s_waitcnt vmcnt(1)
v_cmp_eq_u32 vcc, -1, v152
v_pk_add_f32 v[116:117], v[116:117], v[148:149]
v_pk_add_f32 v[118:119], v[118:119], v[150:151]
s_cbranch_vccnz reca_retry80
reca_resume81:
s_waitcnt vmcnt(0)
v_cmp_eq_u32 vcc, -1, v156
v_pk_add_f32 v[116:117], v[116:117], v[152:153]
v_pk_add_f32 v[118:119], v[118:119], v[154:155]
s_cbranch_vccnz reca_retry82
reca_resume83:
v_pk_add_f32 v[116:117], v[116:117], v[156:157]
v_pk_add_f32 v[118:119], v[118:119], v[158:159]
v_cvt_pk_bf16_f32 v132, v116, v117
v_cvt_pk_bf16_f32 v133, v118, v119
buffer_store_dwordx2 v[132:133], v16, s[4:7], s24 offen
s_branch reca_b528
reca_not267:
s_cmp_lg_u32 s12, 3
s_cbranch_scc1 reca_b528
s_add_u32 s36, s17, 1
s_cmp_ge_u32 s36, 63
s_cbranch_scc1 reca_nopf84
s_add_u32 s37, s36, 1
reca_pf85:
buffer_load_dword v28, v233, s[4:7], 0 offen sc1
s_waitcnt vmcnt(0)
v_cmp_gt_i32 vcc, s37, v28
s_cbranch_vccz reca_pfok86
s_sleep 1
s_sub_u32 s18, s18, 1
s_cbranch_scc0 reca_pf85
s_mov_b32 s18, 0
reca_pfok86:
s_lshl_b32 s34, s15, 3
s_and_b32 s35, s36, 7
s_add_u32 s34, s34, s35
s_mul_i32 s34, s34, 12288
s_add_u32 s32, s34, 37748736
s_lshl_b32 s35, s16, 11
s_add_u32 s34, s34, s35
s_add_u32 s33, s34, 40894464
buffer_load_dwordx4 a[120:123], v1, s[4:7], s32 offen offset:0 sc1
buffer_load_dwordx4 a[124:127], v1, s[4:7], s32 offen offset:1024 sc1
buffer_load_dwordx4 a[128:131], v1, s[4:7], s32 offen offset:2048 sc1
buffer_load_dwordx4 a[132:135], v1, s[4:7], s32 offen offset:3072 sc1
buffer_load_dwordx4 a[136:139], v2, s[4:7], s32 offen offset:0 sc1
buffer_load_dwordx4 a[140:143], v2, s[4:7], s32 offen offset:1024 sc1
buffer_load_dwordx4 a[144:147], v2, s[4:7], s32 offen offset:2048 sc1
buffer_load_dwordx4 a[148:151], v2, s[4:7], s32 offen offset:3072 sc1
buffer_load_dwordx4 a[152:155], v3, s[4:7], s32 offen offset:0 sc1
buffer_load_dwordx4 a[156:159], v3, s[4:7], s32 offen offset:1024 sc1
buffer_load_dwordx4 a[160:163], v3, s[4:7], s32 offen offset:2048 sc1
buffer_load_dwordx4 a[164:167], v3, s[4:7], s32 offen offset:3072 sc1
buffer_load_dwordx4 a[168:171], v1, s[4:7], s33 offen offset:0 sc1
buffer_load_dwordx4 a[172:175], v1, s[4:7], s33 offen offset:1024 sc1
reca_nopf84:
buffer_store_dwordx2 v[52:53], v9, s[4:7], s30 offen
buffer_store_dwordx2 v[68:69], v10, s[4:7], s31 offen
buffer_store_dwordx2 v[70:71], v10, s[4:7], s31 offen offset:256
reca_b528:
s_barrier
s_add_u32 s17, s17, 1
s_branch reca_step14
reca_retry17:
s_sub_u32 s18, s18, 1
s_cbranch_scc1 reca_retry17_to
buffer_load_dwordx4 v[128:131], v4, s[4:7], s20 offen sc1
buffer_load_dwordx4 v[132:135], v4, s[4:7], s20 offen offset:1024 sc1
buffer_load_dwordx4 v[136:139], v5, s[4:7], s20 offen sc1
s_waitcnt vmcnt(2)
v_max_u32 v29, v128, v130
v_cmp_eq_u32 vcc, -1, v29
s_cbranch_vccnz reca_retry17
s_branch reca_resume18
reca_retry17_to:
s_mov_b32 s18, 0
s_waitcnt vmcnt(0)
s_branch reca_resume18
reca_retry19:
s_sub_u32 s18, s18, 1
s_cbranch_scc1 reca_retry19_to
buffer_load_dwordx4 v[132:135], v4, s[4:7], s20 offen offset:1024 sc1
buffer_load_dwordx4 v[136:139], v5, s[4:7], s20 offen sc1
s_waitcnt vmcnt(1)
v_max_u32 v29, v132, v134
v_cmp_eq_u32 vcc, -1, v29
s_cbranch_vccnz reca_retry19
s_branch reca_resume20
reca_retry19_to:
s_mov_b32 s18, 0
s_waitcnt vmcnt(0)
s_branch reca_resume20
reca_retry21:
s_sub_u32 s18, s18, 1
s_cbranch_scc1 reca_retry21_to
buffer_load_dwordx4 v[136:139], v5, s[4:7], s20 offen sc1
s_waitcnt vmcnt(0)
v_max_u32 v29, v136, v138
v_cmp_eq_u32 vcc, -1, v29
s_cbranch_vccnz reca_retry21
s_branch reca_resume22
reca_retry21_to:
s_mov_b32 s18, 0
s_waitcnt vmcnt(0)
s_branch reca_resume22
reca_retry30:
s_sub_u32 s18, s18, 1
s_cbranch_scc1 reca_retry30_to
buffer_load_dwordx4 v[208:211], v1, s[4:7], s21 offen offset:0 sc1
buffer_load_dwordx4 v[212:215], v1, s[4:7], s21 offen offset:1024 sc1
buffer_load_dwordx4 v[216:219], v1, s[4:7], s21 offen offset:2048 sc1
buffer_load_dwordx4 v[220:223], v1, s[4:7], s21 offen offset:3072 sc1
buffer_load_dwordx4 v[224:227], v2, s[4:7], s21 offen offset:0 sc1
buffer_load_dwordx4 v[228:231], v2, s[4:7], s21 offen offset:1024 sc1
s_waitcnt vmcnt(5)
v_max_u32 v29, v208, v210
v_cmp_eq_u32 vcc, -1, v29
s_cbranch_vccnz reca_retry30
s_branch reca_resume31
reca_retry30_to:
s_mov_b32 s18, 0
s_waitcnt vmcnt(0)
s_branch reca_resume31
reca_retry32:
s_sub_u32 s18, s18, 1
s_cbranch_scc1 reca_retry32_to
buffer_load_dwordx4 v[212:215], v1, s[4:7], s21 offen offset:1024 sc1
buffer_load_dwordx4 v[216:219], v1, s[4:7], s21 offen offset:2048 sc1
buffer_load_dwordx4 v[220:223], v1, s[4:7], s21 offen offset:3072 sc1
buffer_load_dwordx4 v[224:227], v2, s[4:7], s21 offen offset:0 sc1
buffer_load_dwordx4 v[228:231], v2, s[4:7], s21 offen offset:1024 sc1
s_waitcnt vmcnt(4)
v_max_u32 v29, v212, v214
v_cmp_eq_u32 vcc, -1, v29
s_cbranch_vccnz reca_retry32
s_branch reca_resume33
reca_retry32_to:
s_mov_b32 s18, 0
s_waitcnt vmcnt(0)
s_branch reca_resume33
reca_retry34:
s_sub_u32 s18, s18, 1
s_cbranch_scc1 reca_retry34_to
buffer_load_dwordx4 v[216:219], v1, s[4:7], s21 offen offset:2048 sc1
buffer_load_dwordx4 v[220:223], v1, s[4:7], s21 offen offset:3072 sc1
buffer_load_dwordx4 v[224:227], v2, s[4:7], s21 offen offset:0 sc1
buffer_load_dwordx4 v[228:231], v2, s[4:7], s21 offen offset:1024 sc1
s_waitcnt vmcnt(3)
v_max_u32 v29, v216, v218
v_cmp_eq_u32 vcc, -1, v29
s_cbranch_vccnz reca_retry34
s_branch reca_resume35
reca_retry34_to:
s_mov_b32 s18, 0
s_waitcnt vmcnt(0)
s_branch reca_resume35
reca_retry36:
s_sub_u32 s18, s18, 1
s_cbranch_scc1 reca_retry36_to
buffer_load_dwordx4 v[220:223], v1, s[4:7], s21 offen offset:3072 sc1
buffer_load_dwordx4 v[224:227], v2, s[4:7], s21 offen offset:0 sc1
buffer_load_dwordx4 v[228:231], v2, s[4:7], s21 offen offset:1024 sc1
s_waitcnt vmcnt(2)
v_max_u32 v29, v220, v222
v_cmp_eq_u32 vcc, -1, v29
s_cbranch_vccnz reca_retry36
s_branch reca_resume37
reca_retry36_to:
s_mov_b32 s18, 0
s_waitcnt vmcnt(0)
s_branch reca_resume37
reca_retry38:
s_sub_u32 s18, s18, 1
s_cbranch_scc1 reca_retry38_to
buffer_load_dwordx4 v[224:227], v2, s[4:7], s21 offen offset:0 sc1
buffer_load_dwordx4 v[228:231], v2, s[4:7], s21 offen offset:1024 sc1
s_waitcnt vmcnt(1)
v_max_u32 v29, v224, v226
v_cmp_eq_u32 vcc, -1, v29
s_cbranch_vccnz reca_retry38
s_branch reca_resume39
reca_retry38_to:
s_mov_b32 s18, 0
s_waitcnt vmcnt(0)
s_branch reca_resume39
reca_retry40:
s_sub_u32 s18, s18, 1
s_cbranch_scc1 reca_retry40_to
buffer_load_dwordx4 v[228:231], v2, s[4:7], s21 offen offset:1024 sc1
s_waitcnt vmcnt(0)
v_max_u32 v29, v228, v230
v_cmp_eq_u32 vcc, -1, v29
s_cbranch_vccnz reca_retry40
s_branch reca_resume41
reca_retry40_to:
s_mov_b32 s18, 0
s_waitcnt vmcnt(0)
s_branch reca_resume41
reca_retry43:
s_sub_u32 s18, s18, 1
s_cbranch_scc1 reca_retry43_to
buffer_load_dwordx4 v[128:131], v12, s[4:7], s22 offen offset:0 sc1
buffer_load_dwordx4 v[132:135], v12, s[4:7], s22 offen offset:1024 sc1
buffer_load_dwordx4 v[136:139], v12, s[4:7], s22 offen offset:2048 sc1
buffer_load_dwordx4 v[140:143], v12, s[4:7], s22 offen offset:3072 sc1
buffer_load_dwordx4 v[144:147], v13, s[4:7], s22 offen offset:0 sc1
buffer_load_dwordx4 v[148:151], v13, s[4:7], s22 offen offset:1024 sc1
buffer_load_dwordx4 v[152:155], v13, s[4:7], s22 offen offset:2048 sc1
buffer_load_dwordx4 v[156:159], v13, s[4:7], s22 offen offset:3072 sc1
buffer_load_dwordx4 v[160:163], v14, s[4:7], s22 offen offset:0 sc1
buffer_load_dwordx4 v[164:167], v14, s[4:7], s22 offen offset:1024 sc1
buffer_load_dwordx4 v[168:171], v14, s[4:7], s22 offen offset:2048 sc1
buffer_load_dwordx4 v[172:175], v14, s[4:7], s22 offen offset:3072 sc1
s_waitcnt vmcnt(11)
v_cmp_eq_u32 vcc, -1, v128
s_cbranch_vccnz reca_retry43
s_branch reca_resume44
reca_retry43_to:
s_mov_b32 s18, 0
s_waitcnt vmcnt(0)
s_branch reca_resume44
reca_retry45:
s_sub_u32 s18, s18, 1
s_cbranch_scc1 reca_retry45_to
buffer_load_dwordx4 v[132:135], v12, s[4:7], s22 offen offset:1024 sc1
buffer_load_dwordx4 v[136:139], v12, s[4:7], s22 offen offset:2048 sc1
buffer_load_dwordx4 v[140:143], v12, s[4:7], s22 offen offset:3072 sc1
buffer_load_dwordx4 v[144:147], v13, s[4:7], s22 offen offset:0 sc1
buffer_load_dwordx4 v[148:151], v13, s[4:7], s22 offen offset:1024 sc1
buffer_load_dwordx4 v[152:155], v13, s[4:7], s22 offen offset:2048 sc1
buffer_load_dwordx4 v[156:159], v13, s[4:7], s22 offen offset:3072 sc1
buffer_load_dwordx4 v[160:163], v14, s[4:7], s22 offen offset:0 sc1
buffer_load_dwordx4 v[164:167], v14, s[4:7], s22 offen offset:1024 sc1
buffer_load_dwordx4 v[168:171], v14, s[4:7], s22 offen offset:2048 sc1
buffer_load_dwordx4 v[172:175], v14, s[4:7], s22 offen offset:3072 sc1
s_waitcnt vmcnt(10)
v_cmp_eq_u32 vcc, -1, v132
s_cbranch_vccnz reca_retry45
s_branch reca_resume46
reca_retry45_to:
s_mov_b32 s18, 0
s_waitcnt vmcnt(0)
s_branch reca_resume46
reca_retry47:
s_sub_u32 s18, s18, 1
s_cbranch_scc1 reca_retry47_to
buffer_load_dwordx4 v[136:139], v12, s[4:7], s22 offen offset:2048 sc1
buffer_load_dwordx4 v[140:143], v12, s[4:7], s22 offen offset:3072 sc1
buffer_load_dwordx4 v[144:147], v13, s[4:7], s22 offen offset:0 sc1
buffer_load_dwordx4 v[148:151], v13, s[4:7], s22 offen offset:1024 sc1
buffer_load_dwordx4 v[152:155], v13, s[4:7], s22 offen offset:2048 sc1
buffer_load_dwordx4 v[156:159], v13, s[4:7], s22 offen offset:3072 sc1
buffer_load_dwordx4 v[160:163], v14, s[4:7], s22 offen offset:0 sc1
buffer_load_dwordx4 v[164:167], v14, s[4:7], s22 offen offset:1024 sc1
buffer_load_dwordx4 v[168:171], v14, s[4:7], s22 offen offset:2048 sc1
buffer_load_dwordx4 v[172:175], v14, s[4:7], s22 offen offset:3072 sc1
s_waitcnt vmcnt(9)
v_cmp_eq_u32 vcc, -1, v136
s_cbranch_vccnz reca_retry47
s_branch reca_resume48
reca_retry47_to:
s_mov_b32 s18, 0
s_waitcnt vmcnt(0)
s_branch reca_resume48
reca_retry49:
s_sub_u32 s18, s18, 1
s_cbranch_scc1 reca_retry49_to
buffer_load_dwordx4 v[140:143], v12, s[4:7], s22 offen offset:3072 sc1
buffer_load_dwordx4 v[144:147], v13, s[4:7], s22 offen offset:0 sc1
buffer_load_dwordx4 v[148:151], v13, s[4:7], s22 offen offset:1024 sc1
buffer_load_dwordx4 v[152:155], v13, s[4:7], s22 offen offset:2048 sc1
buffer_load_dwordx4 v[156:159], v13, s[4:7], s22 offen offset:3072 sc1
buffer_load_dwordx4 v[160:163], v14, s[4:7], s22 offen offset:0 sc1
buffer_load_dwordx4 v[164:167], v14, s[4:7], s22 offen offset:1024 sc1
buffer_load_dwordx4 v[168:171], v14, s[4:7], s22 offen offset:2048 sc1
buffer_load_dwordx4 v[172:175], v14, s[4:7], s22 offen offset:3072 sc1
s_waitcnt vmcnt(8)
v_cmp_eq_u32 vcc, -1, v140
s_cbranch_vccnz reca_retry49
s_branch reca_resume50
reca_retry49_to:
s_mov_b32 s18, 0
s_waitcnt vmcnt(0)
s_branch reca_resume50
reca_retry51:
s_sub_u32 s18, s18, 1
s_cbranch_scc1 reca_retry51_to
buffer_load_dwordx4 v[144:147], v13, s[4:7], s22 offen offset:0 sc1
buffer_load_dwordx4 v[148:151], v13, s[4:7], s22 offen offset:1024 sc1
buffer_load_dwordx4 v[152:155], v13, s[4:7], s22 offen offset:2048 sc1
buffer_load_dwordx4 v[156:159], v13, s[4:7], s22 offen offset:3072 sc1
buffer_load_dwordx4 v[160:163], v14, s[4:7], s22 offen offset:0 sc1
buffer_load_dwordx4 v[164:167], v14, s[4:7], s22 offen offset:1024 sc1
buffer_load_dwordx4 v[168:171], v14, s[4:7], s22 offen offset:2048 sc1
buffer_load_dwordx4 v[172:175], v14, s[4:7], s22 offen offset:3072 sc1
s_waitcnt vmcnt(7)
v_cmp_eq_u32 vcc, -1, v144
s_cbranch_vccnz reca_retry51
s_branch reca_resume52
reca_retry51_to:
s_mov_b32 s18, 0
s_waitcnt vmcnt(0)
s_branch reca_resume52
reca_retry53:
s_sub_u32 s18, s18, 1
s_cbranch_scc1 reca_retry53_to
buffer_load_dwordx4 v[148:151], v13, s[4:7], s22 offen offset:1024 sc1
buffer_load_dwordx4 v[152:155], v13, s[4:7], s22 offen offset:2048 sc1
buffer_load_dwordx4 v[156:159], v13, s[4:7], s22 offen offset:3072 sc1
buffer_load_dwordx4 v[160:163], v14, s[4:7], s22 offen offset:0 sc1
buffer_load_dwordx4 v[164:167], v14, s[4:7], s22 offen offset:1024 sc1
buffer_load_dwordx4 v[168:171], v14, s[4:7], s22 offen offset:2048 sc1
buffer_load_dwordx4 v[172:175], v14, s[4:7], s22 offen offset:3072 sc1
s_waitcnt vmcnt(6)
v_cmp_eq_u32 vcc, -1, v148
s_cbranch_vccnz reca_retry53
s_branch reca_resume54
reca_retry53_to:
s_mov_b32 s18, 0
s_waitcnt vmcnt(0)
s_branch reca_resume54
reca_retry55:
s_sub_u32 s18, s18, 1
s_cbranch_scc1 reca_retry55_to
buffer_load_dwordx4 v[152:155], v13, s[4:7], s22 offen offset:2048 sc1
buffer_load_dwordx4 v[156:159], v13, s[4:7], s22 offen offset:3072 sc1
buffer_load_dwordx4 v[160:163], v14, s[4:7], s22 offen offset:0 sc1
buffer_load_dwordx4 v[164:167], v14, s[4:7], s22 offen offset:1024 sc1
buffer_load_dwordx4 v[168:171], v14, s[4:7], s22 offen offset:2048 sc1
buffer_load_dwordx4 v[172:175], v14, s[4:7], s22 offen offset:3072 sc1
s_waitcnt vmcnt(5)
v_cmp_eq_u32 vcc, -1, v152
s_cbranch_vccnz reca_retry55
s_branch reca_resume56
reca_retry55_to:
s_mov_b32 s18, 0
s_waitcnt vmcnt(0)
s_branch reca_resume56
reca_retry57:
s_sub_u32 s18, s18, 1
s_cbranch_scc1 reca_retry57_to
buffer_load_dwordx4 v[156:159], v13, s[4:7], s22 offen offset:3072 sc1
buffer_load_dwordx4 v[160:163], v14, s[4:7], s22 offen offset:0 sc1
buffer_load_dwordx4 v[164:167], v14, s[4:7], s22 offen offset:1024 sc1
buffer_load_dwordx4 v[168:171], v14, s[4:7], s22 offen offset:2048 sc1
buffer_load_dwordx4 v[172:175], v14, s[4:7], s22 offen offset:3072 sc1
s_waitcnt vmcnt(4)
v_cmp_eq_u32 vcc, -1, v156
s_cbranch_vccnz reca_retry57
s_branch reca_resume58
reca_retry57_to:
s_mov_b32 s18, 0
s_waitcnt vmcnt(0)
s_branch reca_resume58
reca_retry59:
s_sub_u32 s18, s18, 1
s_cbranch_scc1 reca_retry59_to
buffer_load_dwordx4 v[160:163], v14, s[4:7], s22 offen offset:0 sc1
buffer_load_dwordx4 v[164:167], v14, s[4:7], s22 offen offset:1024 sc1
buffer_load_dwordx4 v[168:171], v14, s[4:7], s22 offen offset:2048 sc1
buffer_load_dwordx4 v[172:175], v14, s[4:7], s22 offen offset:3072 sc1
s_waitcnt vmcnt(3)
v_cmp_eq_u32 vcc, -1, v160
s_cbranch_vccnz reca_retry59
s_branch reca_resume60
reca_retry59_to:
s_mov_b32 s18, 0
s_waitcnt vmcnt(0)
s_branch reca_resume60
reca_retry61:
s_sub_u32 s18, s18, 1
s_cbranch_scc1 reca_retry61_to
buffer_load_dwordx4 v[164:167], v14, s[4:7], s22 offen offset:1024 sc1
buffer_load_dwordx4 v[168:171], v14, s[4:7], s22 offen offset:2048 sc1
buffer_load_dwordx4 v[172:175], v14, s[4:7], s22 offen offset:3072 sc1
s_waitcnt vmcnt(2)
v_cmp_eq_u32 vcc, -1, v164
s_cbranch_vccnz reca_retry61
s_branch reca_resume62
reca_retry61_to:
s_mov_b32 s18, 0
s_waitcnt vmcnt(0)
s_branch reca_resume62
reca_retry63:
s_sub_u32 s18, s18, 1
s_cbranch_scc1 reca_retry63_to
buffer_load_dwordx4 v[168:171], v14, s[4:7], s22 offen offset:2048 sc1
buffer_load_dwordx4 v[172:175], v14, s[4:7], s22 offen offset:3072 sc1
s_waitcnt vmcnt(1)
v_cmp_eq_u32 vcc, -1, v168
s_cbranch_vccnz reca_retry63
s_branch reca_resume64
reca_retry63_to:
s_mov_b32 s18, 0
s_waitcnt vmcnt(0)
s_branch reca_resume64
reca_retry65:
s_sub_u32 s18, s18, 1
s_cbranch_scc1 reca_retry65_to
buffer_load_dwordx4 v[172:175], v14, s[4:7], s22 offen offset:3072 sc1
s_waitcnt vmcnt(0)
v_cmp_eq_u32 vcc, -1, v172
s_cbranch_vccnz reca_retry65
s_branch reca_resume66
reca_retry65_to:
s_mov_b32 s18, 0
s_waitcnt vmcnt(0)
s_branch reca_resume66
reca_retry68:
s_sub_u32 s18, s18, 1
s_cbranch_scc1 reca_retry68_to
buffer_load_dwordx4 v[128:131], v20, s[4:7], s25 offen sc1
buffer_load_dwordx4 v[132:135], v21, s[4:7], s25 offen sc1
buffer_load_dwordx4 v[136:139], v22, s[4:7], s25 offen sc1
buffer_load_dwordx4 v[140:143], v23, s[4:7], s25 offen sc1
buffer_load_dwordx4 v[144:147], v24, s[4:7], s25 offen sc1
buffer_load_dwordx4 v[148:151], v25, s[4:7], s25 offen sc1
buffer_load_dwordx4 v[152:155], v26, s[4:7], s25 offen sc1
buffer_load_dwordx4 v[156:159], v27, s[4:7], s25 offen sc1
s_waitcnt vmcnt(7)
v_cmp_eq_u32 vcc, -1, v128
s_cbranch_vccnz reca_retry68
s_branch reca_resume69
reca_retry68_to:
s_mov_b32 s18, 0
s_waitcnt vmcnt(0)
s_branch reca_resume69
reca_retry70:
s_sub_u32 s18, s18, 1
s_cbranch_scc1 reca_retry70_to
buffer_load_dwordx4 v[132:135], v21, s[4:7], s25 offen sc1
buffer_load_dwordx4 v[136:139], v22, s[4:7], s25 offen sc1
buffer_load_dwordx4 v[140:143], v23, s[4:7], s25 offen sc1
buffer_load_dwordx4 v[144:147], v24, s[4:7], s25 offen sc1
buffer_load_dwordx4 v[148:151], v25, s[4:7], s25 offen sc1
buffer_load_dwordx4 v[152:155], v26, s[4:7], s25 offen sc1
buffer_load_dwordx4 v[156:159], v27, s[4:7], s25 offen sc1
s_waitcnt vmcnt(6)
v_cmp_eq_u32 vcc, -1, v132
s_cbranch_vccnz reca_retry70
s_branch reca_resume71
reca_retry70_to:
s_mov_b32 s18, 0
s_waitcnt vmcnt(0)
s_branch reca_resume71
reca_retry72:
s_sub_u32 s18, s18, 1
s_cbranch_scc1 reca_retry72_to
buffer_load_dwordx4 v[136:139], v22, s[4:7], s25 offen sc1
buffer_load_dwordx4 v[140:143], v23, s[4:7], s25 offen sc1
buffer_load_dwordx4 v[144:147], v24, s[4:7], s25 offen sc1
buffer_load_dwordx4 v[148:151], v25, s[4:7], s25 offen sc1
buffer_load_dwordx4 v[152:155], v26, s[4:7], s25 offen sc1
buffer_load_dwordx4 v[156:159], v27, s[4:7], s25 offen sc1
s_waitcnt vmcnt(5)
v_cmp_eq_u32 vcc, -1, v136
s_cbranch_vccnz reca_retry72
s_branch reca_resume73
reca_retry72_to:
s_mov_b32 s18, 0
s_waitcnt vmcnt(0)
s_branch reca_resume73
reca_retry74:
s_sub_u32 s18, s18, 1
s_cbranch_scc1 reca_retry74_to
buffer_load_dwordx4 v[140:143], v23, s[4:7], s25 offen sc1
buffer_load_dwordx4 v[144:147], v24, s[4:7], s25 offen sc1
buffer_load_dwordx4 v[148:151], v25, s[4:7], s25 offen sc1
buffer_load_dwordx4 v[152:155], v26, s[4:7], s25 offen sc1
buffer_load_dwordx4 v[156:159], v27, s[4:7], s25 offen sc1
s_waitcnt vmcnt(4)
v_cmp_eq_u32 vcc, -1, v140
s_cbranch_vccnz reca_retry74
s_branch reca_resume75
reca_retry74_to:
s_mov_b32 s18, 0
s_waitcnt vmcnt(0)
s_branch reca_resume75
reca_retry76:
s_sub_u32 s18, s18, 1
s_cbranch_scc1 reca_retry76_to
buffer_load_dwordx4 v[144:147], v24, s[4:7], s25 offen sc1
buffer_load_dwordx4 v[148:151], v25, s[4:7], s25 offen sc1
buffer_load_dwordx4 v[152:155], v26, s[4:7], s25 offen sc1
buffer_load_dwordx4 v[156:159], v27, s[4:7], s25 offen sc1
s_waitcnt vmcnt(3)
v_cmp_eq_u32 vcc, -1, v144
s_cbranch_vccnz reca_retry76
s_branch reca_resume77
reca_retry76_to:
s_mov_b32 s18, 0
s_waitcnt vmcnt(0)
s_branch reca_resume77
reca_retry78:
s_sub_u32 s18, s18, 1
s_cbranch_scc1 reca_retry78_to
buffer_load_dwordx4 v[148:151], v25, s[4:7], s25 offen sc1
buffer_load_dwordx4 v[152:155], v26, s[4:7], s25 offen sc1
buffer_load_dwordx4 v[156:159], v27, s[4:7], s25 offen sc1
s_waitcnt vmcnt(2)
v_cmp_eq_u32 vcc, -1, v148
s_cbranch_vccnz reca_retry78
s_branch reca_resume79
reca_retry78_to:
s_mov_b32 s18, 0
s_waitcnt vmcnt(0)
s_branch reca_resume79
reca_retry80:
s_sub_u32 s18, s18, 1
s_cbranch_scc1 reca_retry80_to
buffer_load_dwordx4 v[152:155], v26, s[4:7], s25 offen sc1
buffer_load_dwordx4 v[156:159], v27, s[4:7], s25 offen sc1
s_waitcnt vmcnt(1)
v_cmp_eq_u32 vcc, -1, v152
s_cbranch_vccnz reca_retry80
s_branch reca_resume81
reca_retry80_to:
s_mov_b32 s18, 0
s_waitcnt vmcnt(0)
s_branch reca_resume81
reca_retry82:
s_sub_u32 s18, s18, 1
s_cbranch_scc1 reca_retry82_to
buffer_load_dwordx4 v[156:159], v27, s[4:7], s25 offen sc1
s_waitcnt vmcnt(0)
v_cmp_eq_u32 vcc, -1, v156
s_cbranch_vccnz reca_retry82
s_branch reca_resume83
reca_retry82_to:
s_mov_b32 s18, 0
s_waitcnt vmcnt(0)
s_branch reca_resume83
reca_twinf12:
s_branch reca_gotmem88
reca_step87:
s_and_b32 s34, s17, 3
s_mul_i32 s20, s34, 10240
s_add_u32 s20, s20, s38
s_sleep 4
buffer_load_dwordx4 v[128:131], v4, s[4:7], s20 offen sc1
buffer_load_dwordx4 v[132:135], v4, s[4:7], s20 offen offset:1024 sc1
buffer_load_dwordx4 v[136:139], v5, s[4:7], s20 offen sc1
s_waitcnt vmcnt(2)
v_max_u32 v29, v128, v130
v_cmp_eq_u32 vcc, -1, v29
s_cbranch_vccnz reca_retry90
reca_resume91:
s_waitcnt vmcnt(1)
v_max_u32 v29, v132, v134
v_cmp_eq_u32 vcc, -1, v29
ds_write_b128 v4, v[128:131]
s_cbranch_vccnz reca_retry92
reca_resume93:
s_waitcnt vmcnt(0)
v_max_u32 v29, v136, v138
v_cmp_eq_u32 vcc, -1, v29
ds_write_b128 v4, v[132:135] offset:1024
s_cbranch_vccnz reca_retry94
reca_resume95:
ds_write_b128 v5, v[136:139]
s_branch reca_gotmem289
reca_gotmem88:
ds_write_b128 v4, v[128:131]
ds_write_b128 v4, v[132:135] offset:1024
ds_write_b128 v5, v[136:139]
reca_gotmem289:
s_and_b32 s34, s17, 3
s_mul_i32 s21, s34, 6144
s_add_u32 s21, s21, s39
s_mul_i32 s22, s34, 12288
s_add_u32 s22, s22, s40
s_mul_i32 s25, s34, 393216
s_add_u32 s25, s25, s56
s_add_u32 s35, s17, 1
s_and_b32 s35, s35, 3
s_mul_i32 s24, s35, 10240
s_add_u32 s24, s24, s38
s_waitcnt lgkmcnt(0)
s_barrier
ds_read_b128 v[128:131], v236 offset:0
ds_read_b128 v[132:135], v236 offset:1024
ds_read_b128 v[136:139], v236 offset:2048
ds_read_b128 v[140:143], v236 offset:3072
ds_read_b128 v[144:147], v236 offset:4096
ds_read_b128 v[148:151], v237 offset:0
ds_read_b128 v[152:155], v237 offset:1024
ds_read_b128 v[156:159], v237 offset:2048
ds_read_b128 v[160:163], v237 offset:3072
ds_read_b128 v[164:167], v237 offset:4096
s_waitcnt lgkmcnt(9)
v_mfma_f32_16x16x32_bf16 v[44:47], a[0:3], v[128:131], 0
ds_read_b128 v[168:171], v6 offset:0
v_mfma_f32_16x16x32_bf16 v[240:243], a[4:7], v[128:131], 0
s_waitcnt lgkmcnt(9)
v_mfma_f32_16x16x32_bf16 v[44:47], a[8:11], v[132:135], v[44:47]
ds_read_b128 v[172:175], v6 offset:512
v_mfma_f32_16x16x32_bf16 v[240:243], a[12:15], v[132:135], v[240:243]
s_waitcnt lgkmcnt(9)
v_mfma_f32_16x16x32_bf16 v[44:47], a[16:19], v[136:139], v[44:47]
ds_read_b128 v[176:179], v6 offset:1024
v_mfma_f32_16x16x32_bf16 v[240:243], a[20:23], v[136:139], v[240:243]
s_waitcnt lgkmcnt(9)
v_mfma_f32_16x16x32_bf16 v[44:47], a[24:27], v[140:143], v[44:47]
ds_read_b128 v[180:183], v6 offset:1536
v_mfma_f32_16x16x32_bf16 v[240:243], a[28:31], v[140:143], v[240:243]
s_waitcnt lgkmcnt(9)
v_mfma_f32_16x16x32_bf16 v[44:47], a[32:35], v[144:147], v[44:47]
ds_read_b128 v[184:187], v6 offset:2048
v_mfma_f32_16x16x32_bf16 v[240:243], a[36:39], v[144:147], v[240:243]
s_waitcnt lgkmcnt(9)
v_mfma_f32_16x16x32_bf16 v[44:47], a[40:43], v[148:151], v[44:47]
ds_read_b128 v[188:191], v6 offset:2560
v_mfma_f32_16x16x32_bf16 v[240:243], a[44:47], v[148:151], v[240:243]
s_waitcnt lgkmcnt(9)
v_mfma_f32_16x16x32_bf16 v[44:47], a[48:51], v[152:155], v[44:47]
ds_read_b128 v[192:195], v6 offset:3072
v_mfma_f32_16x16x32_bf16 v[240:243], a[52:55], v[152:155], v[240:243]
s_waitcnt lgkmcnt(9)
v_mfma_f32_16x16x32_bf16 v[44:47], a[56:59], v[156:159], v[44:47]
ds_read_b128 v[196:199], v6 offset:3584
v_mfma_f32_16x16x32_bf16 v[240:243], a[60:63], v[156:159], v[240:243]
s_waitcnt lgkmcnt(9)
v_mfma_f32_16x16x32_bf16 v[44:47], a[64:67], v[160:163], v[44:47]
ds_read_b128 v[200:203], v6 offset:4096
v_mfma_f32_16x16x32_bf16 v[240:243], a[68:71], v[160:163], v[240:243]
s_waitcnt lgkmcnt(9)
v_mfma_f32_16x16x32_bf16 v[44:47], a[72:75], v[164:167], v[44:47]
ds_read_b128 v[204:207], v6 offset:4608
v_mfma_f32_16x16x32_bf16 v[240:243], a[76:79], v[164:167], v[240:243]
s_waitcnt lgkmcnt(9)
v_mfma_f32_16x16x32_bf16 v[48:51], v[168:171], a[80:83], 0
s_and_b32 s34, s17, 7
s_lshl_b32 s34, s34, 5
s_add_u32 s34, s34, s15
s_mul_i32 s34, s34, 3072
s_lshl_b32 s35, s16, 9
s_add_u32 s34, s34, s35
s_add_u32 s30, s34, 47185920
s_add_u32 s31, s34, 47972352
v_add_f32_dpp v44, v240, v44 row_ror:8 row_mask:0xf bank_mask:0xf
v_add_f32_dpp v45, v241, v45 row_ror:8 row_mask:0xf bank_mask:0xf
v_add_f32_dpp v46, v242, v46 row_ror:8 row_mask:0xf bank_mask:0xf
v_add_f32_dpp v47, v243, v47 row_ror:8 row_mask:0xf bank_mask:0xf
v_cvt_pk_bf16_f32 v52, v44, v45
v_cvt_pk_bf16_f32 v53, v46, v47
buffer_store_dwordx2 v[52:53], v8, s[4:7], s21 offen
s_waitcnt lgkmcnt(8)
v_mfma_f32_16x16x32_bf16 v[48:51], v[172:175], a[84:87], v[48:51]
s_waitcnt lgkmcnt(7)
v_mfma_f32_16x16x32_bf16 v[48:51], v[176:179], a[88:91], v[48:51]
s_waitcnt lgkmcnt(6)
v_mfma_f32_16x16x32_bf16 v[48:51], v[180:183], a[92:95], v[48:51]
s_waitcnt lgkmcnt(5)
v_mfma_f32_16x16x32_bf16 v[48:51], v[184:187], a[96:99], v[48:51]
s_waitcnt lgkmcnt(4)
v_mfma_f32_16x16x32_bf16 v[48:51], v[188:191], a[100:103], v[48:51]
s_waitcnt lgkmcnt(3)
v_mfma_f32_16x16x32_bf16 v[48:51], v[192:195], a[104:107], v[48:51]
s_waitcnt lgkmcnt(2)
v_mfma_f32_16x16x32_bf16 v[48:51], v[196:199], a[108:111], v[48:51]
s_waitcnt lgkmcnt(1)
v_mfma_f32_16x16x32_bf16 v[48:51], v[200:203], a[112:115], v[48:51]
s_waitcnt lgkmcnt(0)
v_mfma_f32_16x16x32_bf16 v[48:51], v[204:207], a[116:119], v[48:51]
s_cmp_eq_u32 s12, 3
s_cbranch_scc1 reca_swave96
s_nop 5
ds_write_b128 v17, v[48:51]
s_add_u32 s34, s17, 2
s_and_b32 s34, s34, 3
s_mul_i32 s26, s34, 10240
s_add_u32 s26, s26, s38
s_mul_i32 s27, s34, 6144
s_add_u32 s27, s27, s39
s_mul_i32 s28, s34, 12288
s_add_u32 s28, s28, s40
s_mul_i32 s29, s34, 393216
s_add_u32 s29, s29, s56
s_waitcnt lgkmcnt(0)
s_barrier
s_cmp_eq_u32 s17, 63
s_cbranch_scc1 reca_last98
buffer_store_dwordx2 v[32:33], v8, s[4:7], s27 offen
s_cmp_lg_u32 s12, 2
s_cbranch_scc1 reca_tw1102_n
buffer_store_dwordx2 v[52:53], v9, s[4:7], s30 offen
reca_tw1102_n:
s_barrier
s_cmp_eq_u32 s12, 1
s_cbranch_scc1 reca_tw1102
s_cmp_eq_u32 s12, 2
s_cbranch_scc1 reca_tw2103
s_cmp_lt_u32 s17, 2
s_cbranch_scc1 reca_b5101
s_cmp_gt_u32 s17, 61
s_cbranch_scc1 reca_b5101
s_sub_u32 s36, s17, 2
s_and_b32 s36, s36, 7
s_lshl_b32 s34, s59, 3
s_add_u32 s34, s34, s36
s_mul_i32 s34, s34, 12288
s_add_u32 s23, s34, 37748736
s_add_u32 s60, s34, 44040192
s_lshl_b32 s35, s36, 5
s_add_u32 s35, s35, s59
s_mul_i32 s35, s35, 3072
s_add_u32 s61, s35, 47185920
buffer_load_dwordx4 a[120:123], v1, s[4:7], s23 offen offset:0 sc1
buffer_load_dwordx4 a[124:127], v1, s[4:7], s23 offen offset:1024 sc1
buffer_load_dwordx4 a[128:131], v1, s[4:7], s23 offen offset:2048 sc1
buffer_load_dwordx4 a[132:135], v1, s[4:7], s23 offen offset:3072 sc1
buffer_load_dwordx4 a[136:139], v2, s[4:7], s23 offen offset:0 sc1
buffer_load_dwordx4 a[140:143], v2, s[4:7], s23 offen offset:1024 sc1
buffer_load_dwordx4 a[144:147], v2, s[4:7], s23 offen offset:2048 sc1
buffer_load_dwordx4 a[148:151], v2, s[4:7], s23 offen offset:3072 sc1
buffer_load_dwordx4 a[152:155], v3, s[4:7], s23 offen offset:0 sc1
buffer_load_dwordx4 a[156:159], v3, s[4:7], s23 offen offset:1024 sc1
buffer_load_dwordx4 a[160:163], v3, s[4:7], s23 offen offset:2048 sc1
buffer_load_dwordx4 a[164:167], v3, s[4:7], s23 offen offset:3072 sc1
buffer_load_dwordx4 a[216:219], v92, s[4:7], s61 offen offset:0 sc1
buffer_load_dwordx4 a[220:223], v92, s[4:7], s61 offen offset:512 sc1
buffer_load_dwordx4 a[224:227], v92, s[4:7], s61 offen offset:1024 sc1
buffer_load_dwordx4 a[228:231], v92, s[4:7], s61 offen offset:1536 sc1
buffer_load_dwordx4 a[232:235], v92, s[4:7], s61 offen offset:2048 sc1
buffer_load_dwordx4 a[236:239], v92, s[4:7], s61 offen offset:2560 sc1
buffer_load_dwordx4 a[168:171], v1, s[4:7], s60 offen offset:0 sc1
buffer_load_dwordx4 a[172:175], v1, s[4:7], s60 offen offset:1024 sc1
buffer_load_dwordx4 a[176:179], v1, s[4:7], s60 offen offset:2048 sc1
buffer_load_dwordx4 a[180:183], v1, s[4:7], s60 offen offset:3072 sc1
buffer_load_dwordx4 a[184:187], v2, s[4:7], s60 offen offset:0 sc1
buffer_load_dwordx4 a[188:191], v2, s[4:7], s60 offen offset:1024 sc1
buffer_load_dwordx4 a[192:195], v2, s[4:7], s60 offen offset:2048 sc1
buffer_load_dwordx4 a[196:199], v2, s[4:7], s60 offen offset:3072 sc1
buffer_load_dwordx4 a[200:203], v3, s[4:7], s60 offen offset:0 sc1
buffer_load_dwordx4 a[204:207], v3, s[4:7], s60 offen offset:1024 sc1
buffer_load_dwordx4 a[208:211], v3, s[4:7], s60 offen offset:2048 sc1
buffer_load_dwordx4 a[212:215], v3, s[4:7], s60 offen offset:3072 sc1
s_waitcnt vmcnt(5)
v_mfma_f32_16x16x32_bf16 v[128:131], a[216:219], a[168:171], v[84:87]
v_mfma_f32_16x16x32_bf16 v[132:135], a[120:123], a[168:171], v[88:91]
v_mfma_f32_16x16x32_bf16 v[136:139], a[216:219], a[192:195], v[84:87]
v_mfma_f32_16x16x32_bf16 v[140:143], a[120:123], a[192:195], 0
v_mfma_f32_16x16x32_bf16 v[144:147], a[144:147], a[192:195], v[88:91]
s_waitcnt vmcnt(4)
v_mfma_f32_16x16x32_bf16 v[128:131], a[220:223], a[172:175], v[128:131]
v_mfma_f32_16x16x32_bf16 v[132:135], a[124:127], a[172:175], v[132:135]
v_mfma_f32_16x16x32_bf16 v[136:139], a[220:223], a[196:199], v[136:139]
v_mfma_f32_16x16x32_bf16 v[140:143], a[124:127], a[196:199], v[140:143]
v_mfma_f32_16x16x32_bf16 v[144:147], a[148:151], a[196:199], v[144:147]
s_waitcnt vmcnt(3)
v_mfma_f32_16x16x32_bf16 v[128:131], a[224:227], a[176:179], v[128:131]
v_mfma_f32_16x16x32_bf16 v[132:135], a[128:131], a[176:179], v[132:135]
v_mfma_f32_16x16x32_bf16 v[136:139], a[224:227], a[200:203], v[136:139]
v_mfma_f32_16x16x32_bf16 v[140:143], a[128:131], a[200:203], v[140:143]
v_mfma_f32_16x16x32_bf16 v[144:147], a[152:155], a[200:203], v[144:147]
s_waitcnt vmcnt(2)
v_mfma_f32_16x16x32_bf16 v[128:131], a[228:231], a[180:183], v[128:131]
v_mfma_f32_16x16x32_bf16 v[132:135], a[132:135], a[180:183], v[132:135]
v_mfma_f32_16x16x32_bf16 v[136:139], a[228:231], a[204:207], v[136:139]
v_mfma_f32_16x16x32_bf16 v[140:143], a[132:135], a[204:207], v[140:143]
v_mfma_f32_16x16x32_bf16 v[144:147], a[156:159], a[204:207], v[144:147]
s_waitcnt vmcnt(1)
v_mfma_f32_16x16x32_bf16 v[128:131], a[232:235], a[184:187], v[128:131]
v_mfma_f32_16x16x32_bf16 v[132:135], a[136:139], a[184:187], v[132:135]
v_mfma_f32_16x16x32_bf16 v[136:139], a[232:235], a[208:211], v[136:139]
v_mfma_f32_16x16x32_bf16 v[140:143], a[136:139], a[208:211], v[140:143]
v_mfma_f32_16x16x32_bf16 v[144:147], a[160:163], a[208:211], v[144:147]
s_waitcnt vmcnt(0)
v_mfma_f32_16x16x32_bf16 v[128:131], a[236:239], a[188:191], v[128:131]
v_mfma_f32_16x16x32_bf16 v[132:135], a[140:143], a[188:191], v[132:135]
v_mfma_f32_16x16x32_bf16 v[136:139], a[236:239], a[212:215], v[136:139]
v_mfma_f32_16x16x32_bf16 v[140:143], a[140:143], a[212:215], v[140:143]
v_mfma_f32_16x16x32_bf16 v[144:147], a[164:167], a[212:215], v[144:147]
s_nop 3
v_max3_f32 v28, v128, v129, v130
v_max3_f32 v28, v28, v131, v132
v_max3_f32 v28, v28, v133, v134
v_max_f32 v28, v28, v135
v_mov_b32 v29, v28
s_nop 1
v_permlane32_swap_b32 v28, v29
v_max_f32 v28, v28, v29
v_mov_b32 v29, v28
s_nop 1
v_permlane16_swap_b32 v28, v29
v_max_f32 v28, v28, v29
v_mul_f32 v28, s41, v28
v_fma_f32 v128, v128, s41, -v28
v_fma_f32 v129, v129, s41, -v28
v_fma_f32 v130, v130, s41, -v28
v_fma_f32 v131, v131, s41, -v28
v_fma_f32 v132, v132, s41, -v28
v_fma_f32 v133, v133, s41, -v28
v_fma_f32 v134, v134, s41, -v28
v_fma_f32 v135, v135, s41, -v28
v_exp_f32 v128, v128
v_exp_f32 v129, v129
v_exp_f32 v130, v130
v_exp_f32 v131, v131
v_exp_f32 v132, v132
v_exp_f32 v133, v133
v_exp_f32 v134, v134
v_exp_f32 v135, v135
v_max3_f32 v30, v136, v137, v138
v_max3_f32 v30, v30, v139, v140
v_max3_f32 v30, v30, v141, v142
v_max3_f32 v30, v30, v143, v144
v_max3_f32 v30, v30, v145, v146
v_max_f32 v30, v30, v147
v_mov_b32 v29, v30
s_nop 1
v_permlane32_swap_b32 v30, v29
v_max_f32 v30, v30, v29
v_mov_b32 v29, v30
s_nop 1
v_permlane16_swap_b32 v30, v29
v_max_f32 v30, v30, v29
v_mul_f32 v30, s41, v30
v_fma_f32 v136, v136, s41, -v30
v_fma_f32 v137, v137, s41, -v30
v_fma_f32 v138, v138, s41, -v30
v_fma_f32 v139, v139, s41, -v30
v_fma_f32 v140, v140, s41, -v30
v_fma_f32 v141, v141, s41, -v30
v_fma_f32 v142, v142, s41, -v30
v_fma_f32 v143, v143, s41, -v30
v_fma_f32 v144, v144, s41, -v30
v_fma_f32 v145, v145, s41, -v30
v_fma_f32 v146, v146, s41, -v30
v_fma_f32 v147, v147, s41, -v30
v_exp_f32 v136, v136
v_exp_f32 v137, v137
v_exp_f32 v138, v138
v_exp_f32 v139, v139
v_exp_f32 v140, v140
v_exp_f32 v141, v141
v_exp_f32 v142, v142
v_exp_f32 v143, v143
v_exp_f32 v144, v144
v_exp_f32 v145, v145
v_exp_f32 v146, v146
v_exp_f32 v147, v147
v_cvt_pk_bf16_f32 v72, v128, v129
v_cvt_pk_bf16_f32 v73, v130, v131
v_cvt_pk_bf16_f32 v74, v132, v133
v_cvt_pk_bf16_f32 v75, v134, v135
v_cvt_pk_bf16_f32 v76, v136, v137
v_cvt_pk_bf16_f32 v77, v138, v139
v_cvt_pk_bf16_f32 v78, v140, v141
v_cvt_pk_bf16_f32 v79, v142, v143
v_cvt_pk_bf16_f32 v80, v144, v145
v_cvt_pk_bf16_f32 v81, v146, v147
v_mfma_f32_16x16x16_bf16 v[148:151], v[36:37], v[72:73], 0
v_mfma_f32_16x16x16_bf16 v[152:155], v[36:37], v[76:77], 0
v_mfma_f32_16x16x16_bf16 v[148:151], v[36:37], v[74:75], v[148:151]
v_mfma_f32_16x16x32_bf16 v[152:155], v[36:39], v[78:81], v[152:155]
s_nop 6
v_rcp_f32 v82, v148
v_rcp_f32 v83, v152
s_and_b32 s34, s17, 1
s_mul_i32 s34, s34, 3072
v_add_u32 v28, s34, v1
ds_write_b128 v28, v[72:75] offset:16384
ds_write_b128 v28, v[76:79] offset:17408
ds_write_b128 v28, v[80:83] offset:18432
s_waitcnt lgkmcnt(0)
s_branch reca_b5101
reca_tw1102:
s_cmp_lt_u32 s17, 3
s_cbranch_scc1 reca_b5101
s_sub_u32 s36, s17, 3
s_and_b32 s37, s36, 7
s_lshl_b32 s34, s59, 3
s_add_u32 s34, s34, s37
s_mul_i32 s34, s34, 12288
s_add_u32 s23, s34, 40894464
s_lshl_b32 s35, s37, 5
s_add_u32 s35, s35, s59
s_mul_i32 s35, s35, 3072
s_add_u32 s61, s35, 47972352
s_mul_i32 s34, s36, 393216
s_mul_i32 s35, s59, 6144
s_add_u32 s34, s34, s35
s_add_u32 s60, s34, 57147392
s_add_u32 s34, s17, 1
s_and_b32 s34, s34, 1
s_mul_i32 s34, s34, 3072
v_add_u32 v28, s34, v1
ds_read_b128 v[72:75], v28 offset:16384
ds_read_b128 v[76:79], v28 offset:17408
ds_read_b128 v[80:83], v28 offset:18432
buffer_load_dwordx2 a[168:169], v93, s[4:7], s61 offen offset:0 sc1
buffer_load_dwordx4 a[120:123], v1, s[4:7], s23 offen offset:0 sc1
buffer_load_dwordx2 a[170:171], v93, s[4:7], s61 offen offset:256 sc1
buffer_load_dwordx4 a[124:127], v1, s[4:7], s23 offen offset:1024 sc1
buffer_load_dwordx2 a[172:173], v93, s[4:7], s61 offen offset:512 sc1
buffer_load_dwordx4 a[128:131], v1, s[4:7], s23 offen offset:2048 sc1
buffer_load_dwordx2 a[174:175], v93, s[4:7], s61 offen offset:768 sc1
buffer_load_dwordx4 a[132:135], v1, s[4:7], s23 offen offset:3072 sc1
buffer_load_dwordx2 a[176:177], v93, s[4:7], s61 offen offset:1024 sc1
buffer_load_dwordx4 a[136:139], v2, s[4:7], s23 offen offset:0 sc1
buffer_load_dwordx2 a[178:179], v93, s[4:7], s61 offen offset:1280 sc1
buffer_load_dwordx4 a[140:143], v2, s[4:7], s23 offen offset:1024 sc1
s_waitcnt lgkmcnt(0)
s_waitcnt vmcnt(8)
v_mfma_f32_16x16x16_bf16 v[156:159], a[168:169], v[72:73], 0
v_mfma_f32_16x16x16_bf16 v[160:163], a[168:169], v[76:77], 0
v_mfma_f32_16x16x16_bf16 v[156:159], a[120:121], v[74:75], v[156:159]
v_mfma_f32_16x16x32_bf16 v[160:163], a[120:123], v[78:81], v[160:163]
v_mfma_f32_16x16x16_bf16 v[164:167], a[170:171], v[72:73], 0
v_mfma_f32_16x16x16_bf16 v[168:171], a[170:171], v[76:77], 0
v_mfma_f32_16x16x16_bf16 v[164:167], a[124:125], v[74:75], v[164:167]
v_mfma_f32_16x16x32_bf16 v[168:171], a[124:127], v[78:81], v[168:171]
s_nop 2
v_mul_f32 v156, v156, v82
v_mul_f32 v157, v157, v82
v_mul_f32 v158, v158, v82
v_mul_f32 v159, v159, v82
v_cvt_pk_bf16_f32 v172, v156, v157
v_cvt_pk_bf16_f32 v173, v158, v159
v_mul_f32 v164, v164, v82
v_mul_f32 v165, v165, v82
v_mul_f32 v166, v166, v82
v_mul_f32 v167, v167, v82
v_cvt_pk_bf16_f32 v174, v164, v165
v_cvt_pk_bf16_f32 v175, v166, v167
buffer_store_dwordx4 v[172:175], v1, s[4:7], s60 offen offset:0 sc1
v_mul_f32 v160, v160, v83
v_mul_f32 v161, v161, v83
v_mul_f32 v162, v162, v83
v_mul_f32 v163, v163, v83
v_cvt_pk_bf16_f32 v176, v160, v161
v_cvt_pk_bf16_f32 v177, v162, v163
v_mul_f32 v168, v168, v83
v_mul_f32 v169, v169, v83
v_mul_f32 v170, v170, v83
v_mul_f32 v171, v171, v83
v_cvt_pk_bf16_f32 v178, v168, v169
v_cvt_pk_bf16_f32 v179, v170, v171
s_add_u32 s34, s60, 196608
buffer_store_dwordx4 v[176:179], v1, s[4:7], s34 offen offset:0 sc1
s_waitcnt vmcnt(6)
v_mfma_f32_16x16x16_bf16 v[156:159], a[172:173], v[72:73], 0
v_mfma_f32_16x16x16_bf16 v[160:163], a[172:173], v[76:77], 0
v_mfma_f32_16x16x16_bf16 v[156:159], a[128:129], v[74:75], v[156:159]
v_mfma_f32_16x16x32_bf16 v[160:163], a[128:131], v[78:81], v[160:163]
v_mfma_f32_16x16x16_bf16 v[164:167], a[174:175], v[72:73], 0
v_mfma_f32_16x16x16_bf16 v[168:171], a[174:175], v[76:77], 0
v_mfma_f32_16x16x16_bf16 v[164:167], a[132:133], v[74:75], v[164:167]
v_mfma_f32_16x16x32_bf16 v[168:171], a[132:135], v[78:81], v[168:171]
s_nop 2
v_mul_f32 v156, v156, v82
v_mul_f32 v157, v157, v82
v_mul_f32 v158, v158, v82
v_mul_f32 v159, v159, v82
v_cvt_pk_bf16_f32 v172, v156, v157
v_cvt_pk_bf16_f32 v173, v158, v159
v_mul_f32 v164, v164, v82
v_mul_f32 v165, v165, v82
v_mul_f32 v166, v166, v82
v_mul_f32 v167, v167, v82
v_cvt_pk_bf16_f32 v174, v164, v165
v_cvt_pk_bf16_f32 v175, v166, v167
buffer_store_dwordx4 v[172:175], v1, s[4:7], s60 offen offset:1024 sc1
v_mul_f32 v160, v160, v83
v_mul_f32 v161, v161, v83
v_mul_f32 v162, v162, v83
v_mul_f32 v163, v163, v83
v_cvt_pk_bf16_f32 v176, v160, v161
v_cvt_pk_bf16_f32 v177, v162, v163
v_mul_f32 v168, v168, v83
v_mul_f32 v169, v169, v83
v_mul_f32 v170, v170, v83
v_mul_f32 v171, v171, v83
v_cvt_pk_bf16_f32 v178, v168, v169
v_cvt_pk_bf16_f32 v179, v170, v171
s_add_u32 s34, s60, 196608
buffer_store_dwordx4 v[176:179], v1, s[4:7], s34 offen offset:1024 sc1
s_waitcnt vmcnt(4)
v_mfma_f32_16x16x16_bf16 v[156:159], a[176:177], v[72:73], 0
v_mfma_f32_16x16x16_bf16 v[160:163], a[176:177], v[76:77], 0
v_mfma_f32_16x16x16_bf16 v[156:159], a[136:137], v[74:75], v[156:159]
v_mfma_f32_16x16x32_bf16 v[160:163], a[136:139], v[78:81], v[160:163]
v_mfma_f32_16x16x16_bf16 v[164:167], a[178:179], v[72:73], 0
v_mfma_f32_16x16x16_bf16 v[168:171], a[178:179], v[76:77], 0
v_mfma_f32_16x16x16_bf16 v[164:167], a[140:141], v[74:75], v[164:167]
v_mfma_f32_16x16x32_bf16 v[168:171], a[140:143], v[78:81], v[168:171]
s_nop 2
v_mul_f32 v156, v156, v82
v_mul_f32 v157, v157, v82
v_mul_f32 v158, v158, v82
v_mul_f32 v159, v159, v82
v_cvt_pk_bf16_f32 v172, v156, v157
v_cvt_pk_bf16_f32 v173, v158, v159
v_mul_f32 v164, v164, v82
v_mul_f32 v165, v165, v82
v_mul_f32 v166, v166, v82
v_mul_f32 v167, v167, v82
v_cvt_pk_bf16_f32 v174, v164, v165
v_cvt_pk_bf16_f32 v175, v166, v167
buffer_store_dwordx4 v[172:175], v1, s[4:7], s60 offen offset:2048 sc1
v_mul_f32 v160, v160, v83
v_mul_f32 v161, v161, v83
v_mul_f32 v162, v162, v83
v_mul_f32 v163, v163, v83
v_cvt_pk_bf16_f32 v176, v160, v161
v_cvt_pk_bf16_f32 v177, v162, v163
v_mul_f32 v168, v168, v83
v_mul_f32 v169, v169, v83
v_mul_f32 v170, v170, v83
v_mul_f32 v171, v171, v83
v_cvt_pk_bf16_f32 v178, v168, v169
v_cvt_pk_bf16_f32 v179, v170, v171
s_add_u32 s34, s60, 196608
buffer_store_dwordx4 v[176:179], v1, s[4:7], s34 offen offset:2048 sc1
s_branch reca_b5101
reca_tw2103:
s_cmp_lt_u32 s17, 3
s_cbranch_scc1 reca_b5101
s_sub_u32 s36, s17, 3
s_and_b32 s37, s36, 7
s_lshl_b32 s34, s59, 3
s_add_u32 s34, s34, s37
s_mul_i32 s34, s34, 12288
s_add_u32 s23, s34, 40894464
s_lshl_b32 s35, s37, 5
s_add_u32 s35, s35, s59
s_mul_i32 s35, s35, 3072
s_add_u32 s61, s35, 47972352
s_mul_i32 s34, s36, 393216
s_mul_i32 s35, s59, 6144
s_add_u32 s34, s34, s35
s_add_u32 s60, s34, 57147392
s_add_u32 s34, s17, 1
s_and_b32 s34, s34, 1
s_mul_i32 s34, s34, 3072
v_add_u32 v28, s34, v1
ds_read_b128 v[72:75], v28 offset:16384
ds_read_b128 v[76:79], v28 offset:17408
ds_read_b128 v[80:83], v28 offset:18432
buffer_load_dwordx2 a[180:181], v93, s[4:7], s61 offen offset:1536 sc1
buffer_load_dwordx4 a[144:147], v2, s[4:7], s23 offen offset:2048 sc1
buffer_load_dwordx2 a[182:183], v93, s[4:7], s61 offen offset:1792 sc1
buffer_load_dwordx4 a[148:151], v2, s[4:7], s23 offen offset:3072 sc1
buffer_load_dwordx2 a[184:185], v93, s[4:7], s61 offen offset:2048 sc1
buffer_load_dwordx4 a[152:155], v3, s[4:7], s23 offen offset:0 sc1
buffer_load_dwordx2 a[186:187], v93, s[4:7], s61 offen offset:2304 sc1
buffer_load_dwordx4 a[156:159], v3, s[4:7], s23 offen offset:1024 sc1
buffer_load_dwordx2 a[188:189], v93, s[4:7], s61 offen offset:2560 sc1
buffer_load_dwordx4 a[160:163], v3, s[4:7], s23 offen offset:2048 sc1
buffer_load_dwordx2 a[190:191], v93, s[4:7], s61 offen offset:2816 sc1
buffer_load_dwordx4 a[164:167], v3, s[4:7], s23 offen offset:3072 sc1
s_waitcnt lgkmcnt(0)
s_waitcnt vmcnt(8)
v_mfma_f32_16x16x16_bf16 v[156:159], a[180:181], v[72:73], 0
v_mfma_f32_16x16x16_bf16 v[160:163], a[180:181], v[76:77], 0
v_mfma_f32_16x16x16_bf16 v[156:159], a[144:145], v[74:75], v[156:159]
v_mfma_f32_16x16x32_bf16 v[160:163], a[144:147], v[78:81], v[160:163]
v_mfma_f32_16x16x16_bf16 v[164:167], a[182:183], v[72:73], 0
v_mfma_f32_16x16x16_bf16 v[168:171], a[182:183], v[76:77], 0
v_mfma_f32_16x16x16_bf16 v[164:167], a[148:149], v[74:75], v[164:167]
v_mfma_f32_16x16x32_bf16 v[168:171], a[148:151], v[78:81], v[168:171]
s_nop 2
v_mul_f32 v156, v156, v82
v_mul_f32 v157, v157, v82
v_mul_f32 v158, v158, v82
v_mul_f32 v159, v159, v82
v_cvt_pk_bf16_f32 v172, v156, v157
v_cvt_pk_bf16_f32 v173, v158, v159
v_mul_f32 v164, v164, v82
v_mul_f32 v165, v165, v82
v_mul_f32 v166, v166, v82
v_mul_f32 v167, v167, v82
v_cvt_pk_bf16_f32 v174, v164, v165
v_cvt_pk_bf16_f32 v175, v166, v167
buffer_store_dwordx4 v[172:175], v1, s[4:7], s60 offen offset:3072 sc1
v_mul_f32 v160, v160, v83
v_mul_f32 v161, v161, v83
v_mul_f32 v162, v162, v83
v_mul_f32 v163, v163, v83
v_cvt_pk_bf16_f32 v176, v160, v161
v_cvt_pk_bf16_f32 v177, v162, v163
v_mul_f32 v168, v168, v83
v_mul_f32 v169, v169, v83
v_mul_f32 v170, v170, v83
v_mul_f32 v171, v171, v83
v_cvt_pk_bf16_f32 v178, v168, v169
v_cvt_pk_bf16_f32 v179, v170, v171
s_add_u32 s34, s60, 196608
buffer_store_dwordx4 v[176:179], v1, s[4:7], s34 offen offset:3072 sc1
s_waitcnt vmcnt(6)
v_mfma_f32_16x16x16_bf16 v[156:159], a[184:185], v[72:73], 0
v_mfma_f32_16x16x16_bf16 v[160:163], a[184:185], v[76:77], 0
v_mfma_f32_16x16x16_bf16 v[156:159], a[152:153], v[74:75], v[156:159]
v_mfma_f32_16x16x32_bf16 v[160:163], a[152:155], v[78:81], v[160:163]
v_mfma_f32_16x16x16_bf16 v[164:167], a[186:187], v[72:73], 0
v_mfma_f32_16x16x16_bf16 v[168:171], a[186:187], v[76:77], 0
v_mfma_f32_16x16x16_bf16 v[164:167], a[156:157], v[74:75], v[164:167]
v_mfma_f32_16x16x32_bf16 v[168:171], a[156:159], v[78:81], v[168:171]
s_nop 2
v_mul_f32 v156, v156, v82
v_mul_f32 v157, v157, v82
v_mul_f32 v158, v158, v82
v_mul_f32 v159, v159, v82
v_cvt_pk_bf16_f32 v172, v156, v157
v_cvt_pk_bf16_f32 v173, v158, v159
v_mul_f32 v164, v164, v82
v_mul_f32 v165, v165, v82
v_mul_f32 v166, v166, v82
v_mul_f32 v167, v167, v82
v_cvt_pk_bf16_f32 v174, v164, v165
v_cvt_pk_bf16_f32 v175, v166, v167
buffer_store_dwordx4 v[172:175], v2, s[4:7], s60 offen offset:0 sc1
v_mul_f32 v160, v160, v83
v_mul_f32 v161, v161, v83
v_mul_f32 v162, v162, v83
v_mul_f32 v163, v163, v83
v_cvt_pk_bf16_f32 v176, v160, v161
v_cvt_pk_bf16_f32 v177, v162, v163
v_mul_f32 v168, v168, v83
v_mul_f32 v169, v169, v83
v_mul_f32 v170, v170, v83
v_mul_f32 v171, v171, v83
v_cvt_pk_bf16_f32 v178, v168, v169
v_cvt_pk_bf16_f32 v179, v170, v171
s_add_u32 s34, s60, 196608
buffer_store_dwordx4 v[176:179], v2, s[4:7], s34 offen offset:0 sc1
s_waitcnt vmcnt(4)
v_mfma_f32_16x16x16_bf16 v[156:159], a[188:189], v[72:73], 0
v_mfma_f32_16x16x16_bf16 v[160:163], a[188:189], v[76:77], 0
v_mfma_f32_16x16x16_bf16 v[156:159], a[160:161], v[74:75], v[156:159]
v_mfma_f32_16x16x32_bf16 v[160:163], a[160:163], v[78:81], v[160:163]
v_mfma_f32_16x16x16_bf16 v[164:167], a[190:191], v[72:73], 0
v_mfma_f32_16x16x16_bf16 v[168:171], a[190:191], v[76:77], 0
v_mfma_f32_16x16x16_bf16 v[164:167], a[164:165], v[74:75], v[164:167]
v_mfma_f32_16x16x32_bf16 v[168:171], a[164:167], v[78:81], v[168:171]
s_nop 2
v_mul_f32 v156, v156, v82
v_mul_f32 v157, v157, v82
v_mul_f32 v158, v158, v82
v_mul_f32 v159, v159, v82
v_cvt_pk_bf16_f32 v172, v156, v157
v_cvt_pk_bf16_f32 v173, v158, v159
v_mul_f32 v164, v164, v82
v_mul_f32 v165, v165, v82
v_mul_f32 v166, v166, v82
v_mul_f32 v167, v167, v82
v_cvt_pk_bf16_f32 v174, v164, v165
v_cvt_pk_bf16_f32 v175, v166, v167
buffer_store_dwordx4 v[172:175], v2, s[4:7], s60 offen offset:1024 sc1
v_mul_f32 v160, v160, v83
v_mul_f32 v161, v161, v83
v_mul_f32 v162, v162, v83
v_mul_f32 v163, v163, v83
v_cvt_pk_bf16_f32 v176, v160, v161
v_cvt_pk_bf16_f32 v177, v162, v163
v_mul_f32 v168, v168, v83
v_mul_f32 v169, v169, v83
v_mul_f32 v170, v170, v83
v_mul_f32 v171, v171, v83
v_cvt_pk_bf16_f32 v178, v168, v169
v_cvt_pk_bf16_f32 v179, v170, v171
s_add_u32 s34, s60, 196608
buffer_store_dwordx4 v[176:179], v2, s[4:7], s34 offen offset:1024 sc1
s_branch reca_b5101
s_cmp_lg_u32 s12, 2
s_cbranch_scc1 reca_b399
buffer_store_dwordx2 v[52:53], v9, s[4:7], s30 offen
buffer_store_dwordx2 v[32:33], v16, s[4:7], s26 offen
s_cmp_lg_u32 s14, 0
s_cbranch_scc1 reca_b399
v_mov_b32 v28, s17
s_lshl_b32 s34, s13, 7
s_add_u32 s34, s34, 1507328
buffer_store_dword v28, v19, s[4:7], s34 offen
s_branch reca_b399
reca_last98:
s_cmp_lg_u32 s12, 2
s_cbranch_scc1 reca_exit1
buffer_store_dwordx2 v[52:53], v9, s[4:7], s30 offen
s_branch reca_exit1
reca_swave96:
s_cmp_lg_u32 s17, 63
s_cbranch_scc1 reca_vmst104
s_barrier
ds_read_b128 v[56:59], v1 offset:10240
ds_read_b128 v[60:63], v1 offset:11264
ds_read_b128 v[64:67], v1 offset:12288
s_waitcnt lgkmcnt(0)
v_add_f32 v56, v56, v64
v_add_f32 v60, v60, v48
v_add_f32 v57, v57, v65
v_add_f32 v61, v61, v49
v_add_f32 v58, v58, v66
v_add_f32 v62, v62, v50
v_add_f32 v59, v59, v67
v_add_f32 v63, v63, v51
v_cvt_pk_bf16_f32 v68, v56, v57
v_cvt_pk_bf16_f32 v69, v58, v59
v_cvt_pk_bf16_f32 v70, v60, v61
v_cvt_pk_bf16_f32 v71, v62, v63
buffer_store_dwordx2 v[52:53], v9, s[4:7], s30 offen
buffer_store_dwordx2 v[68:69], v10, s[4:7], s31 offen
buffer_store_dwordx2 v[70:71], v10, s[4:7], s31 offen offset:256
s_branch reca_exit1
reca_vmst104:
s_sleep 1
buffer_load_dwordx4 v[208:211], v1, s[4:7], s21 offen offset:0 sc1
buffer_load_dwordx4 v[212:215], v1, s[4:7], s21 offen offset:1024 sc1
buffer_load_dwordx4 v[216:219], v1, s[4:7], s21 offen offset:2048 sc1
buffer_load_dwordx4 v[220:223], v1, s[4:7], s21 offen offset:3072 sc1
buffer_load_dwordx4 v[224:227], v2, s[4:7], s21 offen offset:0 sc1
buffer_load_dwordx4 v[228:231], v2, s[4:7], s21 offen offset:1024 sc1
s_waitcnt vmcnt(5)
v_max_u32 v29, v208, v210
v_cmp_eq_u32 vcc, -1, v29
s_cbranch_vccnz reca_retry105
reca_resume106:
s_waitcnt vmcnt(4)
v_max_u32 v29, v212, v214
v_cmp_eq_u32 vcc, -1, v29
v_mfma_f32_16x16x32_bf16 v[76:79], a[120:123], v[208:211], 0
v_mfma_f32_16x16x32_bf16 v[80:83], a[144:147], v[208:211], 0
v_mfma_f32_16x16x32_bf16 v[72:75], v[208:211], v[208:211], v[40:43]
s_cbranch_vccnz reca_retry107
reca_resume108:
s_waitcnt vmcnt(3)
v_max_u32 v29, v216, v218
v_cmp_eq_u32 vcc, -1, v29
v_mfma_f32_16x16x32_bf16 v[76:79], a[124:127], v[212:215], v[76:79]
v_mfma_f32_16x16x32_bf16 v[80:83], a[148:151], v[212:215], v[80:83]
v_mfma_f32_16x16x32_bf16 v[72:75], v[212:215], v[212:215], v[72:75]
s_cbranch_vccnz reca_retry109
reca_resume110:
s_waitcnt vmcnt(2)
v_max_u32 v29, v220, v222
v_cmp_eq_u32 vcc, -1, v29
v_mfma_f32_16x16x32_bf16 v[76:79], a[128:131], v[216:219], v[76:79]
v_mfma_f32_16x16x32_bf16 v[80:83], a[152:155], v[216:219], v[80:83]
v_mfma_f32_16x16x32_bf16 v[72:75], v[216:219], v[216:219], v[72:75]
s_cbranch_vccnz reca_retry111
reca_resume112:
s_waitcnt vmcnt(1)
v_max_u32 v29, v224, v226
v_cmp_eq_u32 vcc, -1, v29
v_mfma_f32_16x16x32_bf16 v[76:79], a[132:135], v[220:223], v[76:79]
v_mfma_f32_16x16x32_bf16 v[80:83], a[156:159], v[220:223], v[80:83]
v_mfma_f32_16x16x32_bf16 v[72:75], v[220:223], v[220:223], v[72:75]
s_cbranch_vccnz reca_retry113
reca_resume114:
s_waitcnt vmcnt(0)
v_max_u32 v29, v228, v230
v_cmp_eq_u32 vcc, -1, v29
v_mfma_f32_16x16x32_bf16 v[76:79], a[136:139], v[224:227], v[76:79]
v_mfma_f32_16x16x32_bf16 v[80:83], a[160:163], v[224:227], v[80:83]
v_mfma_f32_16x16x32_bf16 v[72:75], v[224:227], v[224:227], v[72:75]
s_cbranch_vccnz reca_retry115
reca_resume116:
v_mfma_f32_16x16x32_bf16 v[76:79], a[140:143], v[228:231], v[76:79]
v_mfma_f32_16x16x32_bf16 v[80:83], a[164:167], v[228:231], v[80:83]
v_mfma_f32_16x16x32_bf16 v[72:75], v[228:231], v[228:231], v[72:75]
s_barrier
ds_read_b128 v[56:59], v1 offset:10240
ds_read_b128 v[60:63], v1 offset:11264
ds_read_b128 v[64:67], v1 offset:12288
s_nop 1
v_max3_f32 v28, v76, v77, v78
v_max3_f32 v29, v80, v81, v82
v_max3_f32 v28, v28, v79, v83
v_max3_f32 v29, v29, v72, v73
v_max3_f32 v28, v28, v74, v75
v_max_f32 v28, v28, v29
v_mov_b32 v29, v28
s_nop 1
v_permlane32_swap_b32 v28, v29
v_max_f32 v28, v28, v29
v_mov_b32 v29, v28
s_nop 1
v_permlane16_swap_b32 v28, v29
v_max_f32 v28, v28, v29
v_mul_f32 v28, s41, v28
v_fma_f32 v76, v76, s41, -v28
v_fma_f32 v77, v77, s41, -v28
v_fma_f32 v78, v78, s41, -v28
v_fma_f32 v79, v79, s41, -v28
v_fma_f32 v80, v80, s41, -v28
v_fma_f32 v81, v81, s41, -v28
v_fma_f32 v82, v82, s41, -v28
v_fma_f32 v83, v83, s41, -v28
v_fma_f32 v72, v72, s41, -v28
v_fma_f32 v73, v73, s41, -v28
v_fma_f32 v74, v74, s41, -v28
v_fma_f32 v75, v75, s41, -v28
v_exp_f32 v76, v76
v_exp_f32 v77, v77
v_exp_f32 v78, v78
v_exp_f32 v79, v79
v_exp_f32 v80, v80
v_exp_f32 v81, v81
v_exp_f32 v82, v82
v_exp_f32 v83, v83
v_cvt_pk_bf16_f32 v84, v76, v77
v_cvt_pk_bf16_f32 v85, v78, v79
v_cvt_pk_bf16_f32 v86, v80, v81
v_cvt_pk_bf16_f32 v87, v82, v83
v_exp_f32 v72, v72
v_exp_f32 v73, v73
v_mfma_f32_16x16x32_bf16 v[100:103], v[36:39], v[84:87], 0
v_exp_f32 v74, v74
v_exp_f32 v75, v75
v_mfma_f32_16x16x32_bf16 v[92:95], a[168:171], v[84:87], 0
v_cvt_pk_bf16_f32 v88, v72, v73
v_cvt_pk_bf16_f32 v89, v74, v75
v_mfma_f32_16x16x32_bf16 v[96:99], a[172:175], v[84:87], 0
s_waitcnt lgkmcnt(0)
v_mfma_f32_16x16x16_bf16 v[100:103], v[36:37], v[88:89], v[100:103]
v_add_f32 v56, v56, v64
v_add_f32 v60, v60, v48
v_add_f32 v57, v57, v65
v_add_f32 v61, v61, v49
v_add_f32 v58, v58, v66
v_add_f32 v62, v62, v50
v_add_f32 v59, v59, v67
v_add_f32 v63, v63, v51
v_cvt_pk_bf16_f32 v68, v56, v57
v_cvt_pk_bf16_f32 v69, v58, v59
v_cvt_pk_bf16_f32 v70, v60, v61
v_cvt_pk_bf16_f32 v71, v62, v63
v_mfma_f32_16x16x16_bf16 v[92:95], v[68:69], v[88:89], v[92:95]
v_rcp_f32 v28, v100
v_mfma_f32_16x16x16_bf16 v[96:99], v[70:71], v[88:89], v[96:99]
v_mov_b32 v29, v28
s_nop 4
v_pk_mul_f32 v[92:93], v[92:93], v[28:29]
v_pk_mul_f32 v[94:95], v[94:95], v[28:29]
v_pk_mul_f32 v[96:97], v[96:97], v[28:29]
v_pk_mul_f32 v[98:99], v[98:99], v[28:29]
v_cvt_pk_bf16_f32 v104, v92, v93
v_cvt_pk_bf16_f32 v105, v94, v95
v_cvt_pk_bf16_f32 v106, v96, v97
v_cvt_pk_bf16_f32 v107, v98, v99
buffer_store_dwordx4 v[104:107], v11, s[4:7], s22 offen
s_barrier
s_add_u32 s34, s17, 2
s_and_b32 s34, s34, 3
s_mul_i32 s26, s34, 10240
s_add_u32 s26, s26, s38
s_mul_i32 s27, s34, 6144
s_add_u32 s27, s27, s39
s_mul_i32 s28, s34, 12288
s_add_u32 s28, s28, s40
s_mul_i32 s29, s34, 393216
s_add_u32 s29, s29, s56
buffer_store_dwordx2 v[32:33], v8, s[4:7], s27 offen
buffer_store_dwordx4 v[32:35], v11, s[4:7], s28 offen
s_add_u32 s36, s17, 1
s_cmp_ge_u32 s36, 63
s_cbranch_scc1 reca_nopf117
s_add_u32 s37, s36, 1
reca_pf118:
buffer_load_dword v28, v233, s[4:7], 0 offen sc1
s_waitcnt vmcnt(0)
v_cmp_gt_i32 vcc, s37, v28
s_cbranch_vccz reca_pfok119
s_sleep 1
s_sub_u32 s18, s18, 1
s_cbranch_scc0 reca_pf118
s_mov_b32 s18, 0
reca_pfok119:
s_lshl_b32 s34, s15, 3
s_and_b32 s35, s36, 7
s_add_u32 s34, s34, s35
s_mul_i32 s34, s34, 12288
s_add_u32 s32, s34, 37748736
s_lshl_b32 s35, s16, 11
s_add_u32 s34, s34, s35
s_add_u32 s33, s34, 40894464
buffer_load_dwordx4 a[120:123], v1, s[4:7], s32 offen offset:0 sc1
buffer_load_dwordx4 a[124:127], v1, s[4:7], s32 offen offset:1024 sc1
buffer_load_dwordx4 a[128:131], v1, s[4:7], s32 offen offset:2048 sc1
buffer_load_dwordx4 a[132:135], v1, s[4:7], s32 offen offset:3072 sc1
buffer_load_dwordx4 a[136:139], v2, s[4:7], s32 offen offset:0 sc1
buffer_load_dwordx4 a[140:143], v2, s[4:7], s32 offen offset:1024 sc1
buffer_load_dwordx4 a[144:147], v2, s[4:7], s32 offen offset:2048 sc1
buffer_load_dwordx4 a[148:151], v2, s[4:7], s32 offen offset:3072 sc1
buffer_load_dwordx4 a[152:155], v3, s[4:7], s32 offen offset:0 sc1
buffer_load_dwordx4 a[156:159], v3, s[4:7], s32 offen offset:1024 sc1
buffer_load_dwordx4 a[160:163], v3, s[4:7], s32 offen offset:2048 sc1
buffer_load_dwordx4 a[164:167], v3, s[4:7], s32 offen offset:3072 sc1
buffer_load_dwordx4 a[168:171], v1, s[4:7], s33 offen offset:0 sc1
buffer_load_dwordx4 a[172:175], v1, s[4:7], s33 offen offset:1024 sc1
reca_nopf117:
buffer_store_dwordx2 v[52:53], v9, s[4:7], s30 offen
buffer_store_dwordx2 v[68:69], v10, s[4:7], s31 offen
buffer_store_dwordx2 v[70:71], v10, s[4:7], s31 offen offset:256
reca_b5101:
s_barrier
s_add_u32 s17, s17, 1
s_branch reca_step87
reca_b399:
s_endpgm
reca_retry90:
s_sub_u32 s18, s18, 1
s_cbranch_scc1 reca_retry90_to
buffer_load_dwordx4 v[128:131], v4, s[4:7], s20 offen sc1
buffer_load_dwordx4 v[132:135], v4, s[4:7], s20 offen offset:1024 sc1
buffer_load_dwordx4 v[136:139], v5, s[4:7], s20 offen sc1
s_waitcnt vmcnt(2)
v_max_u32 v29, v128, v130
v_cmp_eq_u32 vcc, -1, v29
s_cbranch_vccnz reca_retry90
s_branch reca_resume91
reca_retry90_to:
s_mov_b32 s18, 0
s_waitcnt vmcnt(0)
s_branch reca_resume91
reca_retry92:
s_sub_u32 s18, s18, 1
s_cbranch_scc1 reca_retry92_to
buffer_load_dwordx4 v[132:135], v4, s[4:7], s20 offen offset:1024 sc1
buffer_load_dwordx4 v[136:139], v5, s[4:7], s20 offen sc1
s_waitcnt vmcnt(1)
v_max_u32 v29, v132, v134
v_cmp_eq_u32 vcc, -1, v29
s_cbranch_vccnz reca_retry92
s_branch reca_resume93
reca_retry92_to:
s_mov_b32 s18, 0
s_waitcnt vmcnt(0)
s_branch reca_resume93
reca_retry94:
s_sub_u32 s18, s18, 1
s_cbranch_scc1 reca_retry94_to
buffer_load_dwordx4 v[136:139], v5, s[4:7], s20 offen sc1
s_waitcnt vmcnt(0)
v_max_u32 v29, v136, v138
v_cmp_eq_u32 vcc, -1, v29
s_cbranch_vccnz reca_retry94
s_branch reca_resume95
reca_retry94_to:
s_mov_b32 s18, 0
s_waitcnt vmcnt(0)
s_branch reca_resume95
reca_retry105:
s_sub_u32 s18, s18, 1
s_cbranch_scc1 reca_retry105_to
buffer_load_dwordx4 v[208:211], v1, s[4:7], s21 offen offset:0 sc1
buffer_load_dwordx4 v[212:215], v1, s[4:7], s21 offen offset:1024 sc1
buffer_load_dwordx4 v[216:219], v1, s[4:7], s21 offen offset:2048 sc1
buffer_load_dwordx4 v[220:223], v1, s[4:7], s21 offen offset:3072 sc1
buffer_load_dwordx4 v[224:227], v2, s[4:7], s21 offen offset:0 sc1
buffer_load_dwordx4 v[228:231], v2, s[4:7], s21 offen offset:1024 sc1
s_waitcnt vmcnt(5)
v_max_u32 v29, v208, v210
v_cmp_eq_u32 vcc, -1, v29
s_cbranch_vccnz reca_retry105
s_branch reca_resume106
reca_retry105_to:
s_mov_b32 s18, 0
s_waitcnt vmcnt(0)
s_branch reca_resume106
reca_retry107:
s_sub_u32 s18, s18, 1
s_cbranch_scc1 reca_retry107_to
buffer_load_dwordx4 v[212:215], v1, s[4:7], s21 offen offset:1024 sc1
buffer_load_dwordx4 v[216:219], v1, s[4:7], s21 offen offset:2048 sc1
buffer_load_dwordx4 v[220:223], v1, s[4:7], s21 offen offset:3072 sc1
buffer_load_dwordx4 v[224:227], v2, s[4:7], s21 offen offset:0 sc1
buffer_load_dwordx4 v[228:231], v2, s[4:7], s21 offen offset:1024 sc1
s_waitcnt vmcnt(4)
v_max_u32 v29, v212, v214
v_cmp_eq_u32 vcc, -1, v29
s_cbranch_vccnz reca_retry107
s_branch reca_resume108
reca_retry107_to:
s_mov_b32 s18, 0
s_waitcnt vmcnt(0)
s_branch reca_resume108
reca_retry109:
s_sub_u32 s18, s18, 1
s_cbranch_scc1 reca_retry109_to
buffer_load_dwordx4 v[216:219], v1, s[4:7], s21 offen offset:2048 sc1
buffer_load_dwordx4 v[220:223], v1, s[4:7], s21 offen offset:3072 sc1
buffer_load_dwordx4 v[224:227], v2, s[4:7], s21 offen offset:0 sc1
buffer_load_dwordx4 v[228:231], v2, s[4:7], s21 offen offset:1024 sc1
s_waitcnt vmcnt(3)
v_max_u32 v29, v216, v218
v_cmp_eq_u32 vcc, -1, v29
s_cbranch_vccnz reca_retry109
s_branch reca_resume110
reca_retry109_to:
s_mov_b32 s18, 0
s_waitcnt vmcnt(0)
s_branch reca_resume110
reca_retry111:
s_sub_u32 s18, s18, 1
s_cbranch_scc1 reca_retry111_to
buffer_load_dwordx4 v[220:223], v1, s[4:7], s21 offen offset:3072 sc1
buffer_load_dwordx4 v[224:227], v2, s[4:7], s21 offen offset:0 sc1
buffer_load_dwordx4 v[228:231], v2, s[4:7], s21 offen offset:1024 sc1
s_waitcnt vmcnt(2)
v_max_u32 v29, v220, v222
v_cmp_eq_u32 vcc, -1, v29
s_cbranch_vccnz reca_retry111
s_branch reca_resume112
reca_retry111_to:
s_mov_b32 s18, 0
s_waitcnt vmcnt(0)
s_branch reca_resume112
reca_retry113:
s_sub_u32 s18, s18, 1
s_cbranch_scc1 reca_retry113_to
buffer_load_dwordx4 v[224:227], v2, s[4:7], s21 offen offset:0 sc1
buffer_load_dwordx4 v[228:231], v2, s[4:7], s21 offen offset:1024 sc1
s_waitcnt vmcnt(1)
v_max_u32 v29, v224, v226
v_cmp_eq_u32 vcc, -1, v29
s_cbranch_vccnz reca_retry113
s_branch reca_resume114
reca_retry113_to:
s_mov_b32 s18, 0
s_waitcnt vmcnt(0)
s_branch reca_resume114
reca_retry115:
s_sub_u32 s18, s18, 1
s_cbranch_scc1 reca_retry115_to
buffer_load_dwordx4 v[228:231], v2, s[4:7], s21 offen offset:1024 sc1
s_waitcnt vmcnt(0)
v_max_u32 v29, v228, v230
v_cmp_eq_u32 vcc, -1, v29
s_cbranch_vccnz reca_retry115
s_branch reca_resume116
reca_retry115_to:
s_mov_b32 s18, 0
s_waitcnt vmcnt(0)
s_branch reca_resume116
reca_slow11:
s_cmp_ge_u32 s14, 20
s_cbranch_scc1 reca_twins13
s_branch reca_gotmem121
reca_step120:
s_and_b32 s34, s17, 3
s_mul_i32 s20, s34, 10240
s_add_u32 s20, s20, s38
s_sleep 2
buffer_load_dwordx4 v[128:131], v4, s[4:7], s20 offen sc1
buffer_load_dwordx4 v[132:135], v4, s[4:7], s20 offen offset:1024 sc1
buffer_load_dwordx4 v[136:139], v5, s[4:7], s20 offen sc1
s_waitcnt vmcnt(2)
v_max_u32 v29, v128, v130
v_cmp_eq_u32 vcc, -1, v29
s_cbranch_vccnz reca_retry123
reca_resume124:
s_waitcnt vmcnt(1)
v_max_u32 v29, v132, v134
v_cmp_eq_u32 vcc, -1, v29
ds_write_b128 v4, v[128:131]
s_cbranch_vccnz reca_retry125
reca_resume126:
s_waitcnt vmcnt(0)
v_max_u32 v29, v136, v138
v_cmp_eq_u32 vcc, -1, v29
ds_write_b128 v4, v[132:135] offset:1024
s_cbranch_vccnz reca_retry127
reca_resume128:
ds_write_b128 v5, v[136:139]
s_branch reca_gotmem2122
reca_gotmem121:
ds_write_b128 v4, v[128:131]
ds_write_b128 v4, v[132:135] offset:1024
ds_write_b128 v5, v[136:139]
reca_gotmem2122:
s_and_b32 s34, s17, 3
s_mul_i32 s21, s34, 6144
s_add_u32 s21, s21, s39
s_mul_i32 s22, s34, 12288
s_add_u32 s22, s22, s40
s_mul_i32 s25, s34, 393216
s_add_u32 s25, s25, s56
s_add_u32 s35, s17, 1
s_and_b32 s35, s35, 3
s_mul_i32 s24, s35, 10240
s_add_u32 s24, s24, s38
s_waitcnt lgkmcnt(0)
s_barrier
ds_read_b128 v[128:131], v236 offset:0
ds_read_b128 v[132:135], v236 offset:1024
ds_read_b128 v[136:139], v236 offset:2048
ds_read_b128 v[140:143], v236 offset:3072
ds_read_b128 v[144:147], v236 offset:4096
ds_read_b128 v[148:151], v237 offset:0
ds_read_b128 v[152:155], v237 offset:1024
ds_read_b128 v[156:159], v237 offset:2048
ds_read_b128 v[160:163], v237 offset:3072
ds_read_b128 v[164:167], v237 offset:4096
s_waitcnt lgkmcnt(9)
v_mfma_f32_16x16x32_bf16 v[44:47], a[0:3], v[128:131], 0
ds_read_b128 v[168:171], v6 offset:0
v_mfma_f32_16x16x32_bf16 v[240:243], a[4:7], v[128:131], 0
s_waitcnt lgkmcnt(9)
v_mfma_f32_16x16x32_bf16 v[44:47], a[8:11], v[132:135], v[44:47]
ds_read_b128 v[172:175], v6 offset:512
v_mfma_f32_16x16x32_bf16 v[240:243], a[12:15], v[132:135], v[240:243]
s_waitcnt lgkmcnt(9)
v_mfma_f32_16x16x32_bf16 v[44:47], a[16:19], v[136:139], v[44:47]
ds_read_b128 v[176:179], v6 offset:1024
v_mfma_f32_16x16x32_bf16 v[240:243], a[20:23], v[136:139], v[240:243]
s_waitcnt lgkmcnt(9)
v_mfma_f32_16x16x32_bf16 v[44:47], a[24:27], v[140:143], v[44:47]
ds_read_b128 v[180:183], v6 offset:1536
v_mfma_f32_16x16x32_bf16 v[240:243], a[28:31], v[140:143], v[240:243]
s_waitcnt lgkmcnt(9)
v_mfma_f32_16x16x32_bf16 v[44:47], a[32:35], v[144:147], v[44:47]
ds_read_b128 v[184:187], v6 offset:2048
v_mfma_f32_16x16x32_bf16 v[240:243], a[36:39], v[144:147], v[240:243]
s_waitcnt lgkmcnt(9)
v_mfma_f32_16x16x32_bf16 v[44:47], a[40:43], v[148:151], v[44:47]
ds_read_b128 v[188:191], v6 offset:2560
v_mfma_f32_16x16x32_bf16 v[240:243], a[44:47], v[148:151], v[240:243]
s_waitcnt lgkmcnt(9)
v_mfma_f32_16x16x32_bf16 v[44:47], a[48:51], v[152:155], v[44:47]
ds_read_b128 v[192:195], v6 offset:3072
v_mfma_f32_16x16x32_bf16 v[240:243], a[52:55], v[152:155], v[240:243]
s_waitcnt lgkmcnt(9)
v_mfma_f32_16x16x32_bf16 v[44:47], a[56:59], v[156:159], v[44:47]
ds_read_b128 v[196:199], v6 offset:3584
v_mfma_f32_16x16x32_bf16 v[240:243], a[60:63], v[156:159], v[240:243]
s_waitcnt lgkmcnt(9)
v_mfma_f32_16x16x32_bf16 v[44:47], a[64:67], v[160:163], v[44:47]
ds_read_b128 v[200:203], v6 offset:4096
v_mfma_f32_16x16x32_bf16 v[240:243], a[68:71], v[160:163], v[240:243]
s_waitcnt lgkmcnt(9)
v_mfma_f32_16x16x32_bf16 v[44:47], a[72:75], v[164:167], v[44:47]
ds_read_b128 v[204:207], v6 offset:4608
v_mfma_f32_16x16x32_bf16 v[240:243], a[76:79], v[164:167], v[240:243]
s_waitcnt lgkmcnt(9)
v_mfma_f32_16x16x32_bf16 v[48:51], v[168:171], a[80:83], 0
s_and_b32 s34, s17, 7
s_lshl_b32 s34, s34, 5
s_add_u32 s34, s34, s15
s_mul_i32 s34, s34, 3072
s_lshl_b32 s35, s16, 9
s_add_u32 s34, s34, s35
s_add_u32 s30, s34, 47185920
s_add_u32 s31, s34, 47972352
v_add_f32_dpp v44, v240, v44 row_ror:8 row_mask:0xf bank_mask:0xf
v_add_f32_dpp v45, v241, v45 row_ror:8 row_mask:0xf bank_mask:0xf
v_add_f32_dpp v46, v242, v46 row_ror:8 row_mask:0xf bank_mask:0xf
v_add_f32_dpp v47, v243, v47 row_ror:8 row_mask:0xf bank_mask:0xf
v_cvt_pk_bf16_f32 v52, v44, v45
v_cvt_pk_bf16_f32 v53, v46, v47
buffer_store_dwordx2 v[52:53], v8, s[4:7], s21 offen sc1
s_waitcnt lgkmcnt(8)
v_mfma_f32_16x16x32_bf16 v[48:51], v[172:175], a[84:87], v[48:51]
s_waitcnt lgkmcnt(7)
v_mfma_f32_16x16x32_bf16 v[48:51], v[176:179], a[88:91], v[48:51]
s_waitcnt lgkmcnt(6)
v_mfma_f32_16x16x32_bf16 v[48:51], v[180:183], a[92:95], v[48:51]
s_waitcnt lgkmcnt(5)
v_mfma_f32_16x16x32_bf16 v[48:51], v[184:187], a[96:99], v[48:51]
s_waitcnt lgkmcnt(4)
v_mfma_f32_16x16x32_bf16 v[48:51], v[188:191], a[100:103], v[48:51]
s_waitcnt lgkmcnt(3)
v_mfma_f32_16x16x32_bf16 v[48:51], v[192:195], a[104:107], v[48:51]
s_waitcnt lgkmcnt(2)
v_mfma_f32_16x16x32_bf16 v[48:51], v[196:199], a[108:111], v[48:51]
s_waitcnt lgkmcnt(1)
v_mfma_f32_16x16x32_bf16 v[48:51], v[200:203], a[112:115], v[48:51]
s_waitcnt lgkmcnt(0)
v_mfma_f32_16x16x32_bf16 v[48:51], v[204:207], a[116:119], v[48:51]
s_cmp_eq_u32 s12, 3
s_cbranch_scc1 reca_swave129
s_nop 5
ds_write_b128 v17, v[48:51]
s_add_u32 s34, s17, 2
s_and_b32 s34, s34, 3
s_mul_i32 s26, s34, 10240
s_add_u32 s26, s26, s38
s_mul_i32 s27, s34, 6144
s_add_u32 s27, s27, s39
s_mul_i32 s28, s34, 12288
s_add_u32 s28, s28, s40
s_mul_i32 s29, s34, 393216
s_add_u32 s29, s29, s56
s_waitcnt lgkmcnt(0)
s_barrier
s_cmp_eq_u32 s17, 63
s_cbranch_scc1 reca_last131
buffer_store_dwordx2 v[32:33], v8, s[4:7], s27 offen sc1
s_cmp_lg_u32 s12, 2
s_cbranch_scc1 reca_b3132
buffer_store_dwordx2 v[52:53], v9, s[4:7], s30 offen sc1
buffer_store_dwordx2 v[32:33], v16, s[4:7], s26 offen sc1
s_cmp_lg_u32 s14, 0
s_cbranch_scc1 reca_b3132
v_mov_b32 v28, s17
s_lshl_b32 s34, s13, 7
s_add_u32 s34, s34, 1507328
buffer_store_dword v28, v19, s[4:7], s34 offen sc1
s_branch reca_b3132
reca_last131:
s_cmp_lg_u32 s12, 2
s_cbranch_scc1 reca_exit1
buffer_store_dwordx2 v[52:53], v9, s[4:7], s30 offen
s_branch reca_exit1
reca_swave129:
s_cmp_lg_u32 s17, 63
s_cbranch_scc1 reca_vmst135
s_barrier
ds_read_b128 v[56:59], v1 offset:10240
ds_read_b128 v[60:63], v1 offset:11264
ds_read_b128 v[64:67], v1 offset:12288
s_waitcnt lgkmcnt(0)
v_add_f32 v56, v56, v64
v_add_f32 v60, v60, v48
v_add_f32 v57, v57, v65
v_add_f32 v61, v61, v49
v_add_f32 v58, v58, v66
v_add_f32 v62, v62, v50
v_add_f32 v59, v59, v67
v_add_f32 v63, v63, v51
v_cvt_pk_bf16_f32 v68, v56, v57
v_cvt_pk_bf16_f32 v69, v58, v59
v_cvt_pk_bf16_f32 v70, v60, v61
v_cvt_pk_bf16_f32 v71, v62, v63
buffer_store_dwordx2 v[52:53], v9, s[4:7], s30 offen
buffer_store_dwordx2 v[68:69], v10, s[4:7], s31 offen
buffer_store_dwordx2 v[70:71], v10, s[4:7], s31 offen offset:256
s_branch reca_exit1
reca_vmst135:
s_sleep 1
buffer_load_dwordx4 v[208:211], v1, s[4:7], s21 offen offset:0 sc1
buffer_load_dwordx4 v[212:215], v1, s[4:7], s21 offen offset:1024 sc1
buffer_load_dwordx4 v[216:219], v1, s[4:7], s21 offen offset:2048 sc1
buffer_load_dwordx4 v[220:223], v1, s[4:7], s21 offen offset:3072 sc1
buffer_load_dwordx4 v[224:227], v2, s[4:7], s21 offen offset:0 sc1
buffer_load_dwordx4 v[228:231], v2, s[4:7], s21 offen offset:1024 sc1
s_waitcnt vmcnt(5)
v_max_u32 v29, v208, v210
v_cmp_eq_u32 vcc, -1, v29
s_cbranch_vccnz reca_retry136
reca_resume137:
s_waitcnt vmcnt(4)
v_max_u32 v29, v212, v214
v_cmp_eq_u32 vcc, -1, v29
v_mfma_f32_16x16x32_bf16 v[76:79], a[120:123], v[208:211], 0
v_mfma_f32_16x16x32_bf16 v[80:83], a[144:147], v[208:211], 0
v_mfma_f32_16x16x32_bf16 v[72:75], v[208:211], v[208:211], v[40:43]
s_cbranch_vccnz reca_retry138
reca_resume139:
s_waitcnt vmcnt(3)
v_max_u32 v29, v216, v218
v_cmp_eq_u32 vcc, -1, v29
v_mfma_f32_16x16x32_bf16 v[76:79], a[124:127], v[212:215], v[76:79]
v_mfma_f32_16x16x32_bf16 v[80:83], a[148:151], v[212:215], v[80:83]
v_mfma_f32_16x16x32_bf16 v[72:75], v[212:215], v[212:215], v[72:75]
s_cbranch_vccnz reca_retry140
reca_resume141:
s_waitcnt vmcnt(2)
v_max_u32 v29, v220, v222
v_cmp_eq_u32 vcc, -1, v29
v_mfma_f32_16x16x32_bf16 v[76:79], a[128:131], v[216:219], v[76:79]
v_mfma_f32_16x16x32_bf16 v[80:83], a[152:155], v[216:219], v[80:83]
v_mfma_f32_16x16x32_bf16 v[72:75], v[216:219], v[216:219], v[72:75]
s_cbranch_vccnz reca_retry142
reca_resume143:
s_waitcnt vmcnt(1)
v_max_u32 v29, v224, v226
v_cmp_eq_u32 vcc, -1, v29
v_mfma_f32_16x16x32_bf16 v[76:79], a[132:135], v[220:223], v[76:79]
v_mfma_f32_16x16x32_bf16 v[80:83], a[156:159], v[220:223], v[80:83]
v_mfma_f32_16x16x32_bf16 v[72:75], v[220:223], v[220:223], v[72:75]
s_cbranch_vccnz reca_retry144
reca_resume145:
s_waitcnt vmcnt(0)
v_max_u32 v29, v228, v230
v_cmp_eq_u32 vcc, -1, v29
v_mfma_f32_16x16x32_bf16 v[76:79], a[136:139], v[224:227], v[76:79]
v_mfma_f32_16x16x32_bf16 v[80:83], a[160:163], v[224:227], v[80:83]
v_mfma_f32_16x16x32_bf16 v[72:75], v[224:227], v[224:227], v[72:75]
s_cbranch_vccnz reca_retry146
reca_resume147:
v_mfma_f32_16x16x32_bf16 v[76:79], a[140:143], v[228:231], v[76:79]
v_mfma_f32_16x16x32_bf16 v[80:83], a[164:167], v[228:231], v[80:83]
v_mfma_f32_16x16x32_bf16 v[72:75], v[228:231], v[228:231], v[72:75]
s_barrier
ds_read_b128 v[56:59], v1 offset:10240
ds_read_b128 v[60:63], v1 offset:11264
ds_read_b128 v[64:67], v1 offset:12288
s_nop 1
v_max3_f32 v28, v76, v77, v78
v_max3_f32 v29, v80, v81, v82
v_max3_f32 v28, v28, v79, v83
v_max3_f32 v29, v29, v72, v73
v_max3_f32 v28, v28, v74, v75
v_max_f32 v28, v28, v29
v_mov_b32 v29, v28
s_nop 1
v_permlane32_swap_b32 v28, v29
v_max_f32 v28, v28, v29
v_mov_b32 v29, v28
s_nop 1
v_permlane16_swap_b32 v28, v29
v_max_f32 v28, v28, v29
v_mul_f32 v28, s41, v28
v_fma_f32 v76, v76, s41, -v28
v_fma_f32 v77, v77, s41, -v28
v_fma_f32 v78, v78, s41, -v28
v_fma_f32 v79, v79, s41, -v28
v_fma_f32 v80, v80, s41, -v28
v_fma_f32 v81, v81, s41, -v28
v_fma_f32 v82, v82, s41, -v28
v_fma_f32 v83, v83, s41, -v28
v_fma_f32 v72, v72, s41, -v28
v_fma_f32 v73, v73, s41, -v28
v_fma_f32 v74, v74, s41, -v28
v_fma_f32 v75, v75, s41, -v28
v_exp_f32 v76, v76
v_exp_f32 v77, v77
v_exp_f32 v78, v78
v_exp_f32 v79, v79
v_exp_f32 v80, v80
v_exp_f32 v81, v81
v_exp_f32 v82, v82
v_exp_f32 v83, v83
v_cvt_pk_bf16_f32 v84, v76, v77
v_cvt_pk_bf16_f32 v85, v78, v79
v_cvt_pk_bf16_f32 v86, v80, v81
v_cvt_pk_bf16_f32 v87, v82, v83
v_exp_f32 v72, v72
v_exp_f32 v73, v73
v_mfma_f32_16x16x32_bf16 v[100:103], v[36:39], v[84:87], 0
v_exp_f32 v74, v74
v_exp_f32 v75, v75
v_mfma_f32_16x16x32_bf16 v[92:95], a[168:171], v[84:87], 0
v_cvt_pk_bf16_f32 v88, v72, v73
v_cvt_pk_bf16_f32 v89, v74, v75
v_mfma_f32_16x16x32_bf16 v[96:99], a[172:175], v[84:87], 0
s_waitcnt lgkmcnt(0)
v_mfma_f32_16x16x16_bf16 v[100:103], v[36:37], v[88:89], v[100:103]
v_add_f32 v56, v56, v64
v_add_f32 v60, v60, v48
v_add_f32 v57, v57, v65
v_add_f32 v61, v61, v49
v_add_f32 v58, v58, v66
v_add_f32 v62, v62, v50
v_add_f32 v59, v59, v67
v_add_f32 v63, v63, v51
v_cvt_pk_bf16_f32 v68, v56, v57
v_cvt_pk_bf16_f32 v69, v58, v59
v_cvt_pk_bf16_f32 v70, v60, v61
v_cvt_pk_bf16_f32 v71, v62, v63
v_mfma_f32_16x16x16_bf16 v[92:95], v[68:69], v[88:89], v[92:95]
v_rcp_f32 v28, v100
v_mfma_f32_16x16x16_bf16 v[96:99], v[70:71], v[88:89], v[96:99]
v_mov_b32 v29, v28
s_nop 4
v_pk_mul_f32 v[92:93], v[92:93], v[28:29]
v_pk_mul_f32 v[94:95], v[94:95], v[28:29]
v_pk_mul_f32 v[96:97], v[96:97], v[28:29]
v_pk_mul_f32 v[98:99], v[98:99], v[28:29]
v_cvt_pk_bf16_f32 v104, v92, v93
v_cvt_pk_bf16_f32 v105, v94, v95
v_cvt_pk_bf16_f32 v106, v96, v97
v_cvt_pk_bf16_f32 v107, v98, v99
buffer_store_dwordx4 v[104:107], v11, s[4:7], s22 offen sc1
reca_b3132:
s_barrier
s_cmp_ge_u32 s12, 2
s_cbranch_scc1 reca_notg2148
s_sleep 3
buffer_load_dwordx4 v[128:131], v12, s[4:7], s22 offen offset:0 sc1
buffer_load_dwordx4 v[132:135], v12, s[4:7], s22 offen offset:1024 sc1
buffer_load_dwordx4 v[136:139], v12, s[4:7], s22 offen offset:2048 sc1
buffer_load_dwordx4 v[140:143], v12, s[4:7], s22 offen offset:3072 sc1
buffer_load_dwordx4 v[144:147], v13, s[4:7], s22 offen offset:0 sc1
buffer_load_dwordx4 v[148:151], v13, s[4:7], s22 offen offset:1024 sc1
buffer_load_dwordx4 v[152:155], v13, s[4:7], s22 offen offset:2048 sc1
buffer_load_dwordx4 v[156:159], v13, s[4:7], s22 offen offset:3072 sc1
buffer_load_dwordx4 v[160:163], v14, s[4:7], s22 offen offset:0 sc1
buffer_load_dwordx4 v[164:167], v14, s[4:7], s22 offen offset:1024 sc1
buffer_load_dwordx4 v[168:171], v14, s[4:7], s22 offen offset:2048 sc1
buffer_load_dwordx4 v[172:175], v14, s[4:7], s22 offen offset:3072 sc1
s_waitcnt vmcnt(11)
v_cmp_eq_u32 vcc, -1, v128
s_cbranch_vccnz reca_retry149
reca_resume150:
s_waitcnt vmcnt(10)
v_cmp_eq_u32 vcc, -1, v132
v_mfma_f32_16x16x32_bf16 v[108:111], a[120:123], v[128:131], 0
v_mfma_f32_16x16x32_bf16 v[112:115], a[124:127], v[128:131], 0
s_cbranch_vccnz reca_retry151
reca_resume152:
s_waitcnt vmcnt(9)
v_cmp_eq_u32 vcc, -1, v136
v_mfma_f32_16x16x32_bf16 v[108:111], a[128:131], v[132:135], v[108:111]
v_mfma_f32_16x16x32_bf16 v[112:115], a[132:135], v[132:135], v[112:115]
s_cbranch_vccnz reca_retry153
reca_resume154:
s_waitcnt vmcnt(8)
v_cmp_eq_u32 vcc, -1, v140
v_mfma_f32_16x16x32_bf16 v[108:111], a[136:139], v[136:139], v[108:111]
v_mfma_f32_16x16x32_bf16 v[112:115], a[140:143], v[136:139], v[112:115]
s_cbranch_vccnz reca_retry155
reca_resume156:
s_waitcnt vmcnt(7)
v_cmp_eq_u32 vcc, -1, v144
v_mfma_f32_16x16x32_bf16 v[108:111], a[144:147], v[140:143], v[108:111]
v_mfma_f32_16x16x32_bf16 v[112:115], a[148:151], v[140:143], v[112:115]
s_cbranch_vccnz reca_retry157
reca_resume158:
s_waitcnt vmcnt(6)
v_cmp_eq_u32 vcc, -1, v148
v_mfma_f32_16x16x32_bf16 v[108:111], a[152:155], v[144:147], v[108:111]
v_mfma_f32_16x16x32_bf16 v[112:115], a[156:159], v[144:147], v[112:115]
s_cbranch_vccnz reca_retry159
reca_resume160:
s_waitcnt vmcnt(5)
v_cmp_eq_u32 vcc, -1, v152
v_mfma_f32_16x16x32_bf16 v[108:111], a[160:163], v[148:151], v[108:111]
v_mfma_f32_16x16x32_bf16 v[112:115], a[164:167], v[148:151], v[112:115]
s_cbranch_vccnz reca_retry161
reca_resume162:
s_waitcnt vmcnt(4)
v_cmp_eq_u32 vcc, -1, v156
v_mfma_f32_16x16x32_bf16 v[108:111], a[168:171], v[152:155], v[108:111]
v_mfma_f32_16x16x32_bf16 v[112:115], a[172:175], v[152:155], v[112:115]
s_cbranch_vccnz reca_retry163
reca_resume164:
s_waitcnt vmcnt(3)
v_cmp_eq_u32 vcc, -1, v160
v_mfma_f32_16x16x32_bf16 v[108:111], a[176:179], v[156:159], v[108:111]
v_mfma_f32_16x16x32_bf16 v[112:115], a[180:183], v[156:159], v[112:115]
s_cbranch_vccnz reca_retry165
reca_resume166:
s_waitcnt vmcnt(2)
v_cmp_eq_u32 vcc, -1, v164
v_mfma_f32_16x16x32_bf16 v[108:111], a[184:187], v[160:163], v[108:111]
v_mfma_f32_16x16x32_bf16 v[112:115], a[188:191], v[160:163], v[112:115]
s_cbranch_vccnz reca_retry167
reca_resume168:
s_waitcnt vmcnt(1)
v_cmp_eq_u32 vcc, -1, v168
v_mfma_f32_16x16x32_bf16 v[108:111], a[192:195], v[164:167], v[108:111]
v_mfma_f32_16x16x32_bf16 v[112:115], a[196:199], v[164:167], v[112:115]
s_cbranch_vccnz reca_retry169
reca_resume170:
s_waitcnt vmcnt(0)
v_cmp_eq_u32 vcc, -1, v172
v_mfma_f32_16x16x32_bf16 v[108:111], a[200:203], v[168:171], v[108:111]
v_mfma_f32_16x16x32_bf16 v[112:115], a[204:207], v[168:171], v[112:115]
s_cbranch_vccnz reca_retry171
reca_resume172:
v_mfma_f32_16x16x32_bf16 v[108:111], a[208:211], v[172:175], v[108:111]
v_mfma_f32_16x16x32_bf16 v[112:115], a[212:215], v[172:175], v[112:115]
s_nop 7
v_add_f32_dpp v116, v112, v108 row_ror:8 row_mask:0xf bank_mask:0xf
v_add_f32_dpp v117, v113, v109 row_ror:8 row_mask:0xf bank_mask:0xf
v_add_f32_dpp v118, v114, v110 row_ror:8 row_mask:0xf bank_mask:0xf
v_add_f32_dpp v119, v115, v111 row_ror:8 row_mask:0xf bank_mask:0xf
buffer_store_dwordx4 v[116:119], v15, s[4:7], s25 offen sc1
buffer_store_dwordx4 v[116:119], v232, s[4:7], s25 offen sc1
buffer_store_dwordx4 v[32:35], v15, s[4:7], s29 offen sc1
buffer_store_dwordx4 v[32:35], v232, s[4:7], s29 offen sc1
s_branch reca_b4133
reca_notg2148:
s_cmp_lg_u32 s12, 3
s_cbranch_scc1 reca_b4133
s_add_u32 s34, s17, 2
s_and_b32 s34, s34, 3
s_mul_i32 s26, s34, 10240
s_add_u32 s26, s26, s38
s_mul_i32 s27, s34, 6144
s_add_u32 s27, s27, s39
s_mul_i32 s28, s34, 12288
s_add_u32 s28, s28, s40
s_mul_i32 s29, s34, 393216
s_add_u32 s29, s29, s56
buffer_store_dwordx2 v[32:33], v8, s[4:7], s27 offen sc1
buffer_store_dwordx4 v[32:35], v11, s[4:7], s28 offen sc1
reca_b4133:
s_barrier
s_cmp_lg_u32 s12, 2
s_cbranch_scc1 reca_not2173
s_sleep 8
buffer_load_dwordx4 v[128:131], v20, s[4:7], s25 offen sc1
buffer_load_dwordx4 v[132:135], v21, s[4:7], s25 offen sc1
buffer_load_dwordx4 v[136:139], v22, s[4:7], s25 offen sc1
buffer_load_dwordx4 v[140:143], v23, s[4:7], s25 offen sc1
buffer_load_dwordx4 v[144:147], v24, s[4:7], s25 offen sc1
buffer_load_dwordx4 v[148:151], v25, s[4:7], s25 offen sc1
buffer_load_dwordx4 v[152:155], v26, s[4:7], s25 offen sc1
buffer_load_dwordx4 v[156:159], v27, s[4:7], s25 offen sc1
s_waitcnt vmcnt(7)
v_cmp_eq_u32 vcc, -1, v128
s_cbranch_vccnz reca_retry174
reca_resume175:
s_waitcnt vmcnt(6)
v_cmp_eq_u32 vcc, -1, v132
s_cbranch_vccnz reca_retry176
reca_resume177:
s_waitcnt vmcnt(5)
v_cmp_eq_u32 vcc, -1, v136
v_pk_add_f32 v[116:117], v[128:129], v[132:133]
v_pk_add_f32 v[118:119], v[130:131], v[134:135]
s_cbranch_vccnz reca_retry178
reca_resume179:
s_waitcnt vmcnt(4)
v_cmp_eq_u32 vcc, -1, v140
v_pk_add_f32 v[116:117], v[116:117], v[136:137]
v_pk_add_f32 v[118:119], v[118:119], v[138:139]
s_cbranch_vccnz reca_retry180
reca_resume181:
s_waitcnt vmcnt(3)
v_cmp_eq_u32 vcc, -1, v144
v_pk_add_f32 v[116:117], v[116:117], v[140:141]
v_pk_add_f32 v[118:119], v[118:119], v[142:143]
s_cbranch_vccnz reca_retry182
reca_resume183:
s_waitcnt vmcnt(2)
v_cmp_eq_u32 vcc, -1, v148
v_pk_add_f32 v[116:117], v[116:117], v[144:145]
v_pk_add_f32 v[118:119], v[118:119], v[146:147]
s_cbranch_vccnz reca_retry184
reca_resume185:
s_waitcnt vmcnt(1)
v_cmp_eq_u32 vcc, -1, v152
v_pk_add_f32 v[116:117], v[116:117], v[148:149]
v_pk_add_f32 v[118:119], v[118:119], v[150:151]
s_cbranch_vccnz reca_retry186
reca_resume187:
s_waitcnt vmcnt(0)
v_cmp_eq_u32 vcc, -1, v156
v_pk_add_f32 v[116:117], v[116:117], v[152:153]
v_pk_add_f32 v[118:119], v[118:119], v[154:155]
s_cbranch_vccnz reca_retry188
reca_resume189:
v_pk_add_f32 v[116:117], v[116:117], v[156:157]
v_pk_add_f32 v[118:119], v[118:119], v[158:159]
v_cvt_pk_bf16_f32 v132, v116, v117
v_cvt_pk_bf16_f32 v133, v118, v119
buffer_store_dwordx2 v[132:133], v16, s[4:7], s24 offen sc1
s_branch reca_b5134
reca_not2173:
s_cmp_lg_u32 s12, 3
s_cbranch_scc1 reca_b5134
s_add_u32 s36, s17, 1
s_cmp_ge_u32 s36, 63
s_cbranch_scc1 reca_nopf190
s_add_u32 s37, s36, 1
reca_pf191:
buffer_load_dword v28, v233, s[4:7], 0 offen sc1
s_waitcnt vmcnt(0)
v_cmp_gt_i32 vcc, s37, v28
s_cbranch_vccz reca_pfok192
s_sleep 1
s_sub_u32 s18, s18, 1
s_cbranch_scc0 reca_pf191
s_mov_b32 s18, 0
reca_pfok192:
s_lshl_b32 s34, s15, 3
s_and_b32 s35, s36, 7
s_add_u32 s34, s34, s35
s_mul_i32 s34, s34, 12288
s_add_u32 s32, s34, 37748736
s_lshl_b32 s35, s16, 11
s_add_u32 s34, s34, s35
s_add_u32 s33, s34, 40894464
buffer_load_dwordx4 a[120:123], v1, s[4:7], s32 offen offset:0 sc1
buffer_load_dwordx4 a[124:127], v1, s[4:7], s32 offen offset:1024 sc1
buffer_load_dwordx4 a[128:131], v1, s[4:7], s32 offen offset:2048 sc1
buffer_load_dwordx4 a[132:135], v1, s[4:7], s32 offen offset:3072 sc1
buffer_load_dwordx4 a[136:139], v2, s[4:7], s32 offen offset:0 sc1
buffer_load_dwordx4 a[140:143], v2, s[4:7], s32 offen offset:1024 sc1
buffer_load_dwordx4 a[144:147], v2, s[4:7], s32 offen offset:2048 sc1
buffer_load_dwordx4 a[148:151], v2, s[4:7], s32 offen offset:3072 sc1
buffer_load_dwordx4 a[152:155], v3, s[4:7], s32 offen offset:0 sc1
buffer_load_dwordx4 a[156:159], v3, s[4:7], s32 offen offset:1024 sc1
buffer_load_dwordx4 a[160:163], v3, s[4:7], s32 offen offset:2048 sc1
buffer_load_dwordx4 a[164:167], v3, s[4:7], s32 offen offset:3072 sc1
buffer_load_dwordx4 a[168:171], v1, s[4:7], s33 offen offset:0 sc1
buffer_load_dwordx4 a[172:175], v1, s[4:7], s33 offen offset:1024 sc1
reca_nopf190:
buffer_store_dwordx2 v[52:53], v9, s[4:7], s30 offen sc1
buffer_store_dwordx2 v[68:69], v10, s[4:7], s31 offen sc1
buffer_store_dwordx2 v[70:71], v10, s[4:7], s31 offen offset:256 sc1
reca_b5134:
s_barrier
s_add_u32 s17, s17, 1
s_branch reca_step120
reca_retry123:
s_sub_u32 s18, s18, 1
s_cbranch_scc1 reca_retry123_to
buffer_load_dwordx4 v[128:131], v4, s[4:7], s20 offen sc1
buffer_load_dwordx4 v[132:135], v4, s[4:7], s20 offen offset:1024 sc1
buffer_load_dwordx4 v[136:139], v5, s[4:7], s20 offen sc1
s_waitcnt vmcnt(2)
v_max_u32 v29, v128, v130
v_cmp_eq_u32 vcc, -1, v29
s_cbranch_vccnz reca_retry123
s_branch reca_resume124
reca_retry123_to:
s_mov_b32 s18, 0
s_waitcnt vmcnt(0)
s_branch reca_resume124
reca_retry125:
s_sub_u32 s18, s18, 1
s_cbranch_scc1 reca_retry125_to
buffer_load_dwordx4 v[132:135], v4, s[4:7], s20 offen offset:1024 sc1
buffer_load_dwordx4 v[136:139], v5, s[4:7], s20 offen sc1
s_waitcnt vmcnt(1)
v_max_u32 v29, v132, v134
v_cmp_eq_u32 vcc, -1, v29
s_cbranch_vccnz reca_retry125
s_branch reca_resume126
reca_retry125_to:
s_mov_b32 s18, 0
s_waitcnt vmcnt(0)
s_branch reca_resume126
reca_retry127:
s_sub_u32 s18, s18, 1
s_cbranch_scc1 reca_retry127_to
buffer_load_dwordx4 v[136:139], v5, s[4:7], s20 offen sc1
s_waitcnt vmcnt(0)
v_max_u32 v29, v136, v138
v_cmp_eq_u32 vcc, -1, v29
s_cbranch_vccnz reca_retry127
s_branch reca_resume128
reca_retry127_to:
s_mov_b32 s18, 0
s_waitcnt vmcnt(0)
s_branch reca_resume128
reca_retry136:
s_sub_u32 s18, s18, 1
s_cbranch_scc1 reca_retry136_to
buffer_load_dwordx4 v[208:211], v1, s[4:7], s21 offen offset:0 sc1
buffer_load_dwordx4 v[212:215], v1, s[4:7], s21 offen offset:1024 sc1
buffer_load_dwordx4 v[216:219], v1, s[4:7], s21 offen offset:2048 sc1
buffer_load_dwordx4 v[220:223], v1, s[4:7], s21 offen offset:3072 sc1
buffer_load_dwordx4 v[224:227], v2, s[4:7], s21 offen offset:0 sc1
buffer_load_dwordx4 v[228:231], v2, s[4:7], s21 offen offset:1024 sc1
s_waitcnt vmcnt(5)
v_max_u32 v29, v208, v210
v_cmp_eq_u32 vcc, -1, v29
s_cbranch_vccnz reca_retry136
s_branch reca_resume137
reca_retry136_to:
s_mov_b32 s18, 0
s_waitcnt vmcnt(0)
s_branch reca_resume137
reca_retry138:
s_sub_u32 s18, s18, 1
s_cbranch_scc1 reca_retry138_to
buffer_load_dwordx4 v[212:215], v1, s[4:7], s21 offen offset:1024 sc1
buffer_load_dwordx4 v[216:219], v1, s[4:7], s21 offen offset:2048 sc1
buffer_load_dwordx4 v[220:223], v1, s[4:7], s21 offen offset:3072 sc1
buffer_load_dwordx4 v[224:227], v2, s[4:7], s21 offen offset:0 sc1
buffer_load_dwordx4 v[228:231], v2, s[4:7], s21 offen offset:1024 sc1
s_waitcnt vmcnt(4)
v_max_u32 v29, v212, v214
v_cmp_eq_u32 vcc, -1, v29
s_cbranch_vccnz reca_retry138
s_branch reca_resume139
reca_retry138_to:
s_mov_b32 s18, 0
s_waitcnt vmcnt(0)
s_branch reca_resume139
reca_retry140:
s_sub_u32 s18, s18, 1
s_cbranch_scc1 reca_retry140_to
buffer_load_dwordx4 v[216:219], v1, s[4:7], s21 offen offset:2048 sc1
buffer_load_dwordx4 v[220:223], v1, s[4:7], s21 offen offset:3072 sc1
buffer_load_dwordx4 v[224:227], v2, s[4:7], s21 offen offset:0 sc1
buffer_load_dwordx4 v[228:231], v2, s[4:7], s21 offen offset:1024 sc1
s_waitcnt vmcnt(3)
v_max_u32 v29, v216, v218
v_cmp_eq_u32 vcc, -1, v29
s_cbranch_vccnz reca_retry140
s_branch reca_resume141
reca_retry140_to:
s_mov_b32 s18, 0
s_waitcnt vmcnt(0)
s_branch reca_resume141
reca_retry142:
s_sub_u32 s18, s18, 1
s_cbranch_scc1 reca_retry142_to
buffer_load_dwordx4 v[220:223], v1, s[4:7], s21 offen offset:3072 sc1
buffer_load_dwordx4 v[224:227], v2, s[4:7], s21 offen offset:0 sc1
buffer_load_dwordx4 v[228:231], v2, s[4:7], s21 offen offset:1024 sc1
s_waitcnt vmcnt(2)
v_max_u32 v29, v220, v222
v_cmp_eq_u32 vcc, -1, v29
s_cbranch_vccnz reca_retry142
s_branch reca_resume143
reca_retry142_to:
s_mov_b32 s18, 0
s_waitcnt vmcnt(0)
s_branch reca_resume143
reca_retry144:
s_sub_u32 s18, s18, 1
s_cbranch_scc1 reca_retry144_to
buffer_load_dwordx4 v[224:227], v2, s[4:7], s21 offen offset:0 sc1
buffer_load_dwordx4 v[228:231], v2, s[4:7], s21 offen offset:1024 sc1
s_waitcnt vmcnt(1)
v_max_u32 v29, v224, v226
v_cmp_eq_u32 vcc, -1, v29
s_cbranch_vccnz reca_retry144
s_branch reca_resume145
reca_retry144_to:
s_mov_b32 s18, 0
s_waitcnt vmcnt(0)
s_branch reca_resume145
reca_retry146:
s_sub_u32 s18, s18, 1
s_cbranch_scc1 reca_retry146_to
buffer_load_dwordx4 v[228:231], v2, s[4:7], s21 offen offset:1024 sc1
s_waitcnt vmcnt(0)
v_max_u32 v29, v228, v230
v_cmp_eq_u32 vcc, -1, v29
s_cbranch_vccnz reca_retry146
s_branch reca_resume147
reca_retry146_to:
s_mov_b32 s18, 0
s_waitcnt vmcnt(0)
s_branch reca_resume147
reca_retry149:
s_sub_u32 s18, s18, 1
s_cbranch_scc1 reca_retry149_to
buffer_load_dwordx4 v[128:131], v12, s[4:7], s22 offen offset:0 sc1
buffer_load_dwordx4 v[132:135], v12, s[4:7], s22 offen offset:1024 sc1
buffer_load_dwordx4 v[136:139], v12, s[4:7], s22 offen offset:2048 sc1
buffer_load_dwordx4 v[140:143], v12, s[4:7], s22 offen offset:3072 sc1
buffer_load_dwordx4 v[144:147], v13, s[4:7], s22 offen offset:0 sc1
buffer_load_dwordx4 v[148:151], v13, s[4:7], s22 offen offset:1024 sc1
buffer_load_dwordx4 v[152:155], v13, s[4:7], s22 offen offset:2048 sc1
buffer_load_dwordx4 v[156:159], v13, s[4:7], s22 offen offset:3072 sc1
buffer_load_dwordx4 v[160:163], v14, s[4:7], s22 offen offset:0 sc1
buffer_load_dwordx4 v[164:167], v14, s[4:7], s22 offen offset:1024 sc1
buffer_load_dwordx4 v[168:171], v14, s[4:7], s22 offen offset:2048 sc1
buffer_load_dwordx4 v[172:175], v14, s[4:7], s22 offen offset:3072 sc1
s_waitcnt vmcnt(11)
v_cmp_eq_u32 vcc, -1, v128
s_cbranch_vccnz reca_retry149
s_branch reca_resume150
reca_retry149_to:
s_mov_b32 s18, 0
s_waitcnt vmcnt(0)
s_branch reca_resume150
reca_retry151:
s_sub_u32 s18, s18, 1
s_cbranch_scc1 reca_retry151_to
buffer_load_dwordx4 v[132:135], v12, s[4:7], s22 offen offset:1024 sc1
buffer_load_dwordx4 v[136:139], v12, s[4:7], s22 offen offset:2048 sc1
buffer_load_dwordx4 v[140:143], v12, s[4:7], s22 offen offset:3072 sc1
buffer_load_dwordx4 v[144:147], v13, s[4:7], s22 offen offset:0 sc1
buffer_load_dwordx4 v[148:151], v13, s[4:7], s22 offen offset:1024 sc1
buffer_load_dwordx4 v[152:155], v13, s[4:7], s22 offen offset:2048 sc1
buffer_load_dwordx4 v[156:159], v13, s[4:7], s22 offen offset:3072 sc1
buffer_load_dwordx4 v[160:163], v14, s[4:7], s22 offen offset:0 sc1
buffer_load_dwordx4 v[164:167], v14, s[4:7], s22 offen offset:1024 sc1
buffer_load_dwordx4 v[168:171], v14, s[4:7], s22 offen offset:2048 sc1
buffer_load_dwordx4 v[172:175], v14, s[4:7], s22 offen offset:3072 sc1
s_waitcnt vmcnt(10)
v_cmp_eq_u32 vcc, -1, v132
s_cbranch_vccnz reca_retry151
s_branch reca_resume152
reca_retry151_to:
s_mov_b32 s18, 0
s_waitcnt vmcnt(0)
s_branch reca_resume152
reca_retry153:
s_sub_u32 s18, s18, 1
s_cbranch_scc1 reca_retry153_to
buffer_load_dwordx4 v[136:139], v12, s[4:7], s22 offen offset:2048 sc1
buffer_load_dwordx4 v[140:143], v12, s[4:7], s22 offen offset:3072 sc1
buffer_load_dwordx4 v[144:147], v13, s[4:7], s22 offen offset:0 sc1
buffer_load_dwordx4 v[148:151], v13, s[4:7], s22 offen offset:1024 sc1
buffer_load_dwordx4 v[152:155], v13, s[4:7], s22 offen offset:2048 sc1
buffer_load_dwordx4 v[156:159], v13, s[4:7], s22 offen offset:3072 sc1
buffer_load_dwordx4 v[160:163], v14, s[4:7], s22 offen offset:0 sc1
buffer_load_dwordx4 v[164:167], v14, s[4:7], s22 offen offset:1024 sc1
buffer_load_dwordx4 v[168:171], v14, s[4:7], s22 offen offset:2048 sc1
buffer_load_dwordx4 v[172:175], v14, s[4:7], s22 offen offset:3072 sc1
s_waitcnt vmcnt(9)
v_cmp_eq_u32 vcc, -1, v136
s_cbranch_vccnz reca_retry153
s_branch reca_resume154
reca_retry153_to:
s_mov_b32 s18, 0
s_waitcnt vmcnt(0)
s_branch reca_resume154
reca_retry155:
s_sub_u32 s18, s18, 1
s_cbranch_scc1 reca_retry155_to
buffer_load_dwordx4 v[140:143], v12, s[4:7], s22 offen offset:3072 sc1
buffer_load_dwordx4 v[144:147], v13, s[4:7], s22 offen offset:0 sc1
buffer_load_dwordx4 v[148:151], v13, s[4:7], s22 offen offset:1024 sc1
buffer_load_dwordx4 v[152:155], v13, s[4:7], s22 offen offset:2048 sc1
buffer_load_dwordx4 v[156:159], v13, s[4:7], s22 offen offset:3072 sc1
buffer_load_dwordx4 v[160:163], v14, s[4:7], s22 offen offset:0 sc1
buffer_load_dwordx4 v[164:167], v14, s[4:7], s22 offen offset:1024 sc1
buffer_load_dwordx4 v[168:171], v14, s[4:7], s22 offen offset:2048 sc1
buffer_load_dwordx4 v[172:175], v14, s[4:7], s22 offen offset:3072 sc1
s_waitcnt vmcnt(8)
v_cmp_eq_u32 vcc, -1, v140
s_cbranch_vccnz reca_retry155
s_branch reca_resume156
reca_retry155_to:
s_mov_b32 s18, 0
s_waitcnt vmcnt(0)
s_branch reca_resume156
reca_retry157:
s_sub_u32 s18, s18, 1
s_cbranch_scc1 reca_retry157_to
buffer_load_dwordx4 v[144:147], v13, s[4:7], s22 offen offset:0 sc1
buffer_load_dwordx4 v[148:151], v13, s[4:7], s22 offen offset:1024 sc1
buffer_load_dwordx4 v[152:155], v13, s[4:7], s22 offen offset:2048 sc1
buffer_load_dwordx4 v[156:159], v13, s[4:7], s22 offen offset:3072 sc1
buffer_load_dwordx4 v[160:163], v14, s[4:7], s22 offen offset:0 sc1
buffer_load_dwordx4 v[164:167], v14, s[4:7], s22 offen offset:1024 sc1
buffer_load_dwordx4 v[168:171], v14, s[4:7], s22 offen offset:2048 sc1
buffer_load_dwordx4 v[172:175], v14, s[4:7], s22 offen offset:3072 sc1
s_waitcnt vmcnt(7)
v_cmp_eq_u32 vcc, -1, v144
s_cbranch_vccnz reca_retry157
s_branch reca_resume158
reca_retry157_to:
s_mov_b32 s18, 0
s_waitcnt vmcnt(0)
s_branch reca_resume158
reca_retry159:
s_sub_u32 s18, s18, 1
s_cbranch_scc1 reca_retry159_to
buffer_load_dwordx4 v[148:151], v13, s[4:7], s22 offen offset:1024 sc1
buffer_load_dwordx4 v[152:155], v13, s[4:7], s22 offen offset:2048 sc1
buffer_load_dwordx4 v[156:159], v13, s[4:7], s22 offen offset:3072 sc1
buffer_load_dwordx4 v[160:163], v14, s[4:7], s22 offen offset:0 sc1
buffer_load_dwordx4 v[164:167], v14, s[4:7], s22 offen offset:1024 sc1
buffer_load_dwordx4 v[168:171], v14, s[4:7], s22 offen offset:2048 sc1
buffer_load_dwordx4 v[172:175], v14, s[4:7], s22 offen offset:3072 sc1
s_waitcnt vmcnt(6)
v_cmp_eq_u32 vcc, -1, v148
s_cbranch_vccnz reca_retry159
s_branch reca_resume160
reca_retry159_to:
s_mov_b32 s18, 0
s_waitcnt vmcnt(0)
s_branch reca_resume160
reca_retry161:
s_sub_u32 s18, s18, 1
s_cbranch_scc1 reca_retry161_to
buffer_load_dwordx4 v[152:155], v13, s[4:7], s22 offen offset:2048 sc1
buffer_load_dwordx4 v[156:159], v13, s[4:7], s22 offen offset:3072 sc1
buffer_load_dwordx4 v[160:163], v14, s[4:7], s22 offen offset:0 sc1
buffer_load_dwordx4 v[164:167], v14, s[4:7], s22 offen offset:1024 sc1
buffer_load_dwordx4 v[168:171], v14, s[4:7], s22 offen offset:2048 sc1
buffer_load_dwordx4 v[172:175], v14, s[4:7], s22 offen offset:3072 sc1
s_waitcnt vmcnt(5)
v_cmp_eq_u32 vcc, -1, v152
s_cbranch_vccnz reca_retry161
s_branch reca_resume162
reca_retry161_to:
s_mov_b32 s18, 0
s_waitcnt vmcnt(0)
s_branch reca_resume162
reca_retry163:
s_sub_u32 s18, s18, 1
s_cbranch_scc1 reca_retry163_to
buffer_load_dwordx4 v[156:159], v13, s[4:7], s22 offen offset:3072 sc1
buffer_load_dwordx4 v[160:163], v14, s[4:7], s22 offen offset:0 sc1
buffer_load_dwordx4 v[164:167], v14, s[4:7], s22 offen offset:1024 sc1
buffer_load_dwordx4 v[168:171], v14, s[4:7], s22 offen offset:2048 sc1
buffer_load_dwordx4 v[172:175], v14, s[4:7], s22 offen offset:3072 sc1
s_waitcnt vmcnt(4)
v_cmp_eq_u32 vcc, -1, v156
s_cbranch_vccnz reca_retry163
s_branch reca_resume164
reca_retry163_to:
s_mov_b32 s18, 0
s_waitcnt vmcnt(0)
s_branch reca_resume164
reca_retry165:
s_sub_u32 s18, s18, 1
s_cbranch_scc1 reca_retry165_to
buffer_load_dwordx4 v[160:163], v14, s[4:7], s22 offen offset:0 sc1
buffer_load_dwordx4 v[164:167], v14, s[4:7], s22 offen offset:1024 sc1
buffer_load_dwordx4 v[168:171], v14, s[4:7], s22 offen offset:2048 sc1
buffer_load_dwordx4 v[172:175], v14, s[4:7], s22 offen offset:3072 sc1
s_waitcnt vmcnt(3)
v_cmp_eq_u32 vcc, -1, v160
s_cbranch_vccnz reca_retry165
s_branch reca_resume166
reca_retry165_to:
s_mov_b32 s18, 0
s_waitcnt vmcnt(0)
s_branch reca_resume166
reca_retry167:
s_sub_u32 s18, s18, 1
s_cbranch_scc1 reca_retry167_to
buffer_load_dwordx4 v[164:167], v14, s[4:7], s22 offen offset:1024 sc1
buffer_load_dwordx4 v[168:171], v14, s[4:7], s22 offen offset:2048 sc1
buffer_load_dwordx4 v[172:175], v14, s[4:7], s22 offen offset:3072 sc1
s_waitcnt vmcnt(2)
v_cmp_eq_u32 vcc, -1, v164
s_cbranch_vccnz reca_retry167
s_branch reca_resume168
reca_retry167_to:
s_mov_b32 s18, 0
s_waitcnt vmcnt(0)
s_branch reca_resume168
reca_retry169:
s_sub_u32 s18, s18, 1
s_cbranch_scc1 reca_retry169_to
buffer_load_dwordx4 v[168:171], v14, s[4:7], s22 offen offset:2048 sc1
buffer_load_dwordx4 v[172:175], v14, s[4:7], s22 offen offset:3072 sc1
s_waitcnt vmcnt(1)
v_cmp_eq_u32 vcc, -1, v168
s_cbranch_vccnz reca_retry169
s_branch reca_resume170
reca_retry169_to:
s_mov_b32 s18, 0
s_waitcnt vmcnt(0)
s_branch reca_resume170
reca_retry171:
s_sub_u32 s18, s18, 1
s_cbranch_scc1 reca_retry171_to
buffer_load_dwordx4 v[172:175], v14, s[4:7], s22 offen offset:3072 sc1
s_waitcnt vmcnt(0)
v_cmp_eq_u32 vcc, -1, v172
s_cbranch_vccnz reca_retry171
s_branch reca_resume172
reca_retry171_to:
s_mov_b32 s18, 0
s_waitcnt vmcnt(0)
s_branch reca_resume172
reca_retry174:
s_sub_u32 s18, s18, 1
s_cbranch_scc1 reca_retry174_to
buffer_load_dwordx4 v[128:131], v20, s[4:7], s25 offen sc1
buffer_load_dwordx4 v[132:135], v21, s[4:7], s25 offen sc1
buffer_load_dwordx4 v[136:139], v22, s[4:7], s25 offen sc1
buffer_load_dwordx4 v[140:143], v23, s[4:7], s25 offen sc1
buffer_load_dwordx4 v[144:147], v24, s[4:7], s25 offen sc1
buffer_load_dwordx4 v[148:151], v25, s[4:7], s25 offen sc1
buffer_load_dwordx4 v[152:155], v26, s[4:7], s25 offen sc1
buffer_load_dwordx4 v[156:159], v27, s[4:7], s25 offen sc1
s_waitcnt vmcnt(7)
v_cmp_eq_u32 vcc, -1, v128
s_cbranch_vccnz reca_retry174
s_branch reca_resume175
reca_retry174_to:
s_mov_b32 s18, 0
s_waitcnt vmcnt(0)
s_branch reca_resume175
reca_retry176:
s_sub_u32 s18, s18, 1
s_cbranch_scc1 reca_retry176_to
buffer_load_dwordx4 v[132:135], v21, s[4:7], s25 offen sc1
buffer_load_dwordx4 v[136:139], v22, s[4:7], s25 offen sc1
buffer_load_dwordx4 v[140:143], v23, s[4:7], s25 offen sc1
buffer_load_dwordx4 v[144:147], v24, s[4:7], s25 offen sc1
buffer_load_dwordx4 v[148:151], v25, s[4:7], s25 offen sc1
buffer_load_dwordx4 v[152:155], v26, s[4:7], s25 offen sc1
buffer_load_dwordx4 v[156:159], v27, s[4:7], s25 offen sc1
s_waitcnt vmcnt(6)
v_cmp_eq_u32 vcc, -1, v132
s_cbranch_vccnz reca_retry176
s_branch reca_resume177
reca_retry176_to:
s_mov_b32 s18, 0
s_waitcnt vmcnt(0)
s_branch reca_resume177
reca_retry178:
s_sub_u32 s18, s18, 1
s_cbranch_scc1 reca_retry178_to
buffer_load_dwordx4 v[136:139], v22, s[4:7], s25 offen sc1
buffer_load_dwordx4 v[140:143], v23, s[4:7], s25 offen sc1
buffer_load_dwordx4 v[144:147], v24, s[4:7], s25 offen sc1
buffer_load_dwordx4 v[148:151], v25, s[4:7], s25 offen sc1
buffer_load_dwordx4 v[152:155], v26, s[4:7], s25 offen sc1
buffer_load_dwordx4 v[156:159], v27, s[4:7], s25 offen sc1
s_waitcnt vmcnt(5)
v_cmp_eq_u32 vcc, -1, v136
s_cbranch_vccnz reca_retry178
s_branch reca_resume179
reca_retry178_to:
s_mov_b32 s18, 0
s_waitcnt vmcnt(0)
s_branch reca_resume179
reca_retry180:
s_sub_u32 s18, s18, 1
s_cbranch_scc1 reca_retry180_to
buffer_load_dwordx4 v[140:143], v23, s[4:7], s25 offen sc1
buffer_load_dwordx4 v[144:147], v24, s[4:7], s25 offen sc1
buffer_load_dwordx4 v[148:151], v25, s[4:7], s25 offen sc1
buffer_load_dwordx4 v[152:155], v26, s[4:7], s25 offen sc1
buffer_load_dwordx4 v[156:159], v27, s[4:7], s25 offen sc1
s_waitcnt vmcnt(4)
v_cmp_eq_u32 vcc, -1, v140
s_cbranch_vccnz reca_retry180
s_branch reca_resume181
reca_retry180_to:
s_mov_b32 s18, 0
s_waitcnt vmcnt(0)
s_branch reca_resume181
reca_retry182:
s_sub_u32 s18, s18, 1
s_cbranch_scc1 reca_retry182_to
buffer_load_dwordx4 v[144:147], v24, s[4:7], s25 offen sc1
buffer_load_dwordx4 v[148:151], v25, s[4:7], s25 offen sc1
buffer_load_dwordx4 v[152:155], v26, s[4:7], s25 offen sc1
buffer_load_dwordx4 v[156:159], v27, s[4:7], s25 offen sc1
s_waitcnt vmcnt(3)
v_cmp_eq_u32 vcc, -1, v144
s_cbranch_vccnz reca_retry182
s_branch reca_resume183
reca_retry182_to:
s_mov_b32 s18, 0
s_waitcnt vmcnt(0)
s_branch reca_resume183
reca_retry184:
s_sub_u32 s18, s18, 1
s_cbranch_scc1 reca_retry184_to
buffer_load_dwordx4 v[148:151], v25, s[4:7], s25 offen sc1
buffer_load_dwordx4 v[152:155], v26, s[4:7], s25 offen sc1
buffer_load_dwordx4 v[156:159], v27, s[4:7], s25 offen sc1
s_waitcnt vmcnt(2)
v_cmp_eq_u32 vcc, -1, v148
s_cbranch_vccnz reca_retry184
s_branch reca_resume185
reca_retry184_to:
s_mov_b32 s18, 0
s_waitcnt vmcnt(0)
s_branch reca_resume185
reca_retry186:
s_sub_u32 s18, s18, 1
s_cbranch_scc1 reca_retry186_to
buffer_load_dwordx4 v[152:155], v26, s[4:7], s25 offen sc1
buffer_load_dwordx4 v[156:159], v27, s[4:7], s25 offen sc1
s_waitcnt vmcnt(1)
v_cmp_eq_u32 vcc, -1, v152
s_cbranch_vccnz reca_retry186
s_branch reca_resume187
reca_retry186_to:
s_mov_b32 s18, 0
s_waitcnt vmcnt(0)
s_branch reca_resume187
reca_retry188:
s_sub_u32 s18, s18, 1
s_cbranch_scc1 reca_retry188_to
buffer_load_dwordx4 v[156:159], v27, s[4:7], s25 offen sc1
s_waitcnt vmcnt(0)
v_cmp_eq_u32 vcc, -1, v156
s_cbranch_vccnz reca_retry188
s_branch reca_resume189
reca_retry188_to:
s_mov_b32 s18, 0
s_waitcnt vmcnt(0)
s_branch reca_resume189
reca_twins13:
s_branch reca_gotmem194
reca_step193:
s_and_b32 s34, s17, 3
s_mul_i32 s20, s34, 10240
s_add_u32 s20, s20, s38
s_sleep 4
buffer_load_dwordx4 v[128:131], v4, s[4:7], s20 offen sc1
buffer_load_dwordx4 v[132:135], v4, s[4:7], s20 offen offset:1024 sc1
buffer_load_dwordx4 v[136:139], v5, s[4:7], s20 offen sc1
s_waitcnt vmcnt(2)
v_max_u32 v29, v128, v130
v_cmp_eq_u32 vcc, -1, v29
s_cbranch_vccnz reca_retry196
reca_resume197:
s_waitcnt vmcnt(1)
v_max_u32 v29, v132, v134
v_cmp_eq_u32 vcc, -1, v29
ds_write_b128 v4, v[128:131]
s_cbranch_vccnz reca_retry198
reca_resume199:
s_waitcnt vmcnt(0)
v_max_u32 v29, v136, v138
v_cmp_eq_u32 vcc, -1, v29
ds_write_b128 v4, v[132:135] offset:1024
s_cbranch_vccnz reca_retry200
reca_resume201:
ds_write_b128 v5, v[136:139]
s_branch reca_gotmem2195
reca_gotmem194:
ds_write_b128 v4, v[128:131]
ds_write_b128 v4, v[132:135] offset:1024
ds_write_b128 v5, v[136:139]
reca_gotmem2195:
s_and_b32 s34, s17, 3
s_mul_i32 s21, s34, 6144
s_add_u32 s21, s21, s39
s_mul_i32 s22, s34, 12288
s_add_u32 s22, s22, s40
s_mul_i32 s25, s34, 393216
s_add_u32 s25, s25, s56
s_add_u32 s35, s17, 1
s_and_b32 s35, s35, 3
s_mul_i32 s24, s35, 10240
s_add_u32 s24, s24, s38
s_waitcnt lgkmcnt(0)
s_barrier
ds_read_b128 v[128:131], v236 offset:0
ds_read_b128 v[132:135], v236 offset:1024
ds_read_b128 v[136:139], v236 offset:2048
ds_read_b128 v[140:143], v236 offset:3072
ds_read_b128 v[144:147], v236 offset:4096
ds_read_b128 v[148:151], v237 offset:0
ds_read_b128 v[152:155], v237 offset:1024
ds_read_b128 v[156:159], v237 offset:2048
ds_read_b128 v[160:163], v237 offset:3072
ds_read_b128 v[164:167], v237 offset:4096
s_waitcnt lgkmcnt(9)
v_mfma_f32_16x16x32_bf16 v[44:47], a[0:3], v[128:131], 0
ds_read_b128 v[168:171], v6 offset:0
v_mfma_f32_16x16x32_bf16 v[240:243], a[4:7], v[128:131], 0
s_waitcnt lgkmcnt(9)
v_mfma_f32_16x16x32_bf16 v[44:47], a[8:11], v[132:135], v[44:47]
ds_read_b128 v[172:175], v6 offset:512
v_mfma_f32_16x16x32_bf16 v[240:243], a[12:15], v[132:135], v[240:243]
s_waitcnt lgkmcnt(9)
v_mfma_f32_16x16x32_bf16 v[44:47], a[16:19], v[136:139], v[44:47]
ds_read_b128 v[176:179], v6 offset:1024
v_mfma_f32_16x16x32_bf16 v[240:243], a[20:23], v[136:139], v[240:243]
s_waitcnt lgkmcnt(9)
v_mfma_f32_16x16x32_bf16 v[44:47], a[24:27], v[140:143], v[44:47]
ds_read_b128 v[180:183], v6 offset:1536
v_mfma_f32_16x16x32_bf16 v[240:243], a[28:31], v[140:143], v[240:243]
s_waitcnt lgkmcnt(9)
v_mfma_f32_16x16x32_bf16 v[44:47], a[32:35], v[144:147], v[44:47]
ds_read_b128 v[184:187], v6 offset:2048
v_mfma_f32_16x16x32_bf16 v[240:243], a[36:39], v[144:147], v[240:243]
s_waitcnt lgkmcnt(9)
v_mfma_f32_16x16x32_bf16 v[44:47], a[40:43], v[148:151], v[44:47]
ds_read_b128 v[188:191], v6 offset:2560
v_mfma_f32_16x16x32_bf16 v[240:243], a[44:47], v[148:151], v[240:243]
s_waitcnt lgkmcnt(9)
v_mfma_f32_16x16x32_bf16 v[44:47], a[48:51], v[152:155], v[44:47]
ds_read_b128 v[192:195], v6 offset:3072
v_mfma_f32_16x16x32_bf16 v[240:243], a[52:55], v[152:155], v[240:243]
s_waitcnt lgkmcnt(9)
v_mfma_f32_16x16x32_bf16 v[44:47], a[56:59], v[156:159], v[44:47]
ds_read_b128 v[196:199], v6 offset:3584
v_mfma_f32_16x16x32_bf16 v[240:243], a[60:63], v[156:159], v[240:243]
s_waitcnt lgkmcnt(9)
v_mfma_f32_16x16x32_bf16 v[44:47], a[64:67], v[160:163], v[44:47]
ds_read_b128 v[200:203], v6 offset:4096
v_mfma_f32_16x16x32_bf16 v[240:243], a[68:71], v[160:163], v[240:243]
s_waitcnt lgkmcnt(9)
v_mfma_f32_16x16x32_bf16 v[44:47], a[72:75], v[164:167], v[44:47]
ds_read_b128 v[204:207], v6 offset:4608
v_mfma_f32_16x16x32_bf16 v[240:243], a[76:79], v[164:167], v[240:243]
s_waitcnt lgkmcnt(9)
v_mfma_f32_16x16x32_bf16 v[48:51], v[168:171], a[80:83], 0
s_and_b32 s34, s17, 7
s_lshl_b32 s34, s34, 5
s_add_u32 s34, s34, s15
s_mul_i32 s34, s34, 3072
s_lshl_b32 s35, s16, 9
s_add_u32 s34, s34, s35
s_add_u32 s30, s34, 47185920
s_add_u32 s31, s34, 47972352
v_add_f32_dpp v44, v240, v44 row_ror:8 row_mask:0xf bank_mask:0xf
v_add_f32_dpp v45, v241, v45 row_ror:8 row_mask:0xf bank_mask:0xf
v_add_f32_dpp v46, v242, v46 row_ror:8 row_mask:0xf bank_mask:0xf
v_add_f32_dpp v47, v243, v47 row_ror:8 row_mask:0xf bank_mask:0xf
v_cvt_pk_bf16_f32 v52, v44, v45
v_cvt_pk_bf16_f32 v53, v46, v47
buffer_store_dwordx2 v[52:53], v8, s[4:7], s21 offen sc1
s_waitcnt lgkmcnt(8)
v_mfma_f32_16x16x32_bf16 v[48:51], v[172:175], a[84:87], v[48:51]
s_waitcnt lgkmcnt(7)
v_mfma_f32_16x16x32_bf16 v[48:51], v[176:179], a[88:91], v[48:51]
s_waitcnt lgkmcnt(6)
v_mfma_f32_16x16x32_bf16 v[48:51], v[180:183], a[92:95], v[48:51]
s_waitcnt lgkmcnt(5)
v_mfma_f32_16x16x32_bf16 v[48:51], v[184:187], a[96:99], v[48:51]
s_waitcnt lgkmcnt(4)
v_mfma_f32_16x16x32_bf16 v[48:51], v[188:191], a[100:103], v[48:51]
s_waitcnt lgkmcnt(3)
v_mfma_f32_16x16x32_bf16 v[48:51], v[192:195], a[104:107], v[48:51]
s_waitcnt lgkmcnt(2)
v_mfma_f32_16x16x32_bf16 v[48:51], v[196:199], a[108:111], v[48:51]
s_waitcnt lgkmcnt(1)
v_mfma_f32_16x16x32_bf16 v[48:51], v[200:203], a[112:115], v[48:51]
s_waitcnt lgkmcnt(0)
v_mfma_f32_16x16x32_bf16 v[48:51], v[204:207], a[116:119], v[48:51]
s_cmp_eq_u32 s12, 3
s_cbranch_scc1 reca_swave202
s_nop 5
ds_write_b128 v17, v[48:51]
s_add_u32 s34, s17, 2
s_and_b32 s34, s34, 3
s_mul_i32 s26, s34, 10240
s_add_u32 s26, s26, s38
s_mul_i32 s27, s34, 6144
s_add_u32 s27, s27, s39
s_mul_i32 s28, s34, 12288
s_add_u32 s28, s28, s40
s_mul_i32 s29, s34, 393216
s_add_u32 s29, s29, s56
s_waitcnt lgkmcnt(0)
s_barrier
s_cmp_eq_u32 s17, 63
s_cbranch_scc1 reca_last204
buffer_store_dwordx2 v[32:33], v8, s[4:7], s27 offen sc1
s_cmp_lg_u32 s12, 2
s_cbranch_scc1 reca_tw1208_n
buffer_store_dwordx2 v[52:53], v9, s[4:7], s30 offen sc1
reca_tw1208_n:
s_barrier
s_cmp_eq_u32 s12, 1
s_cbranch_scc1 reca_tw1208
s_cmp_eq_u32 s12, 2
s_cbranch_scc1 reca_tw2209
s_cmp_lt_u32 s17, 2
s_cbranch_scc1 reca_b5207
s_cmp_gt_u32 s17, 61
s_cbranch_scc1 reca_b5207
s_sub_u32 s36, s17, 2
s_and_b32 s36, s36, 7
s_lshl_b32 s34, s59, 3
s_add_u32 s34, s34, s36
s_mul_i32 s34, s34, 12288
s_add_u32 s23, s34, 37748736
s_add_u32 s60, s34, 44040192
s_lshl_b32 s35, s36, 5
s_add_u32 s35, s35, s59
s_mul_i32 s35, s35, 3072
s_add_u32 s61, s35, 47185920
buffer_load_dwordx4 a[120:123], v1, s[4:7], s23 offen offset:0 sc1
buffer_load_dwordx4 a[124:127], v1, s[4:7], s23 offen offset:1024 sc1
buffer_load_dwordx4 a[128:131], v1, s[4:7], s23 offen offset:2048 sc1
buffer_load_dwordx4 a[132:135], v1, s[4:7], s23 offen offset:3072 sc1
buffer_load_dwordx4 a[136:139], v2, s[4:7], s23 offen offset:0 sc1
buffer_load_dwordx4 a[140:143], v2, s[4:7], s23 offen offset:1024 sc1
buffer_load_dwordx4 a[144:147], v2, s[4:7], s23 offen offset:2048 sc1
buffer_load_dwordx4 a[148:151], v2, s[4:7], s23 offen offset:3072 sc1
buffer_load_dwordx4 a[152:155], v3, s[4:7], s23 offen offset:0 sc1
buffer_load_dwordx4 a[156:159], v3, s[4:7], s23 offen offset:1024 sc1
buffer_load_dwordx4 a[160:163], v3, s[4:7], s23 offen offset:2048 sc1
buffer_load_dwordx4 a[164:167], v3, s[4:7], s23 offen offset:3072 sc1
buffer_load_dwordx4 a[216:219], v92, s[4:7], s61 offen offset:0 sc1
buffer_load_dwordx4 a[220:223], v92, s[4:7], s61 offen offset:512 sc1
buffer_load_dwordx4 a[224:227], v92, s[4:7], s61 offen offset:1024 sc1
buffer_load_dwordx4 a[228:231], v92, s[4:7], s61 offen offset:1536 sc1
buffer_load_dwordx4 a[232:235], v92, s[4:7], s61 offen offset:2048 sc1
buffer_load_dwordx4 a[236:239], v92, s[4:7], s61 offen offset:2560 sc1
buffer_load_dwordx4 a[168:171], v1, s[4:7], s60 offen offset:0 sc1
buffer_load_dwordx4 a[172:175], v1, s[4:7], s60 offen offset:1024 sc1
buffer_load_dwordx4 a[176:179], v1, s[4:7], s60 offen offset:2048 sc1
buffer_load_dwordx4 a[180:183], v1, s[4:7], s60 offen offset:3072 sc1
buffer_load_dwordx4 a[184:187], v2, s[4:7], s60 offen offset:0 sc1
buffer_load_dwordx4 a[188:191], v2, s[4:7], s60 offen offset:1024 sc1
buffer_load_dwordx4 a[192:195], v2, s[4:7], s60 offen offset:2048 sc1
buffer_load_dwordx4 a[196:199], v2, s[4:7], s60 offen offset:3072 sc1
buffer_load_dwordx4 a[200:203], v3, s[4:7], s60 offen offset:0 sc1
buffer_load_dwordx4 a[204:207], v3, s[4:7], s60 offen offset:1024 sc1
buffer_load_dwordx4 a[208:211], v3, s[4:7], s60 offen offset:2048 sc1
buffer_load_dwordx4 a[212:215], v3, s[4:7], s60 offen offset:3072 sc1
s_waitcnt vmcnt(5)
v_mfma_f32_16x16x32_bf16 v[128:131], a[216:219], a[168:171], v[84:87]
v_mfma_f32_16x16x32_bf16 v[132:135], a[120:123], a[168:171], v[88:91]
v_mfma_f32_16x16x32_bf16 v[136:139], a[216:219], a[192:195], v[84:87]
v_mfma_f32_16x16x32_bf16 v[140:143], a[120:123], a[192:195], 0
v_mfma_f32_16x16x32_bf16 v[144:147], a[144:147], a[192:195], v[88:91]
s_waitcnt vmcnt(4)
v_mfma_f32_16x16x32_bf16 v[128:131], a[220:223], a[172:175], v[128:131]
v_mfma_f32_16x16x32_bf16 v[132:135], a[124:127], a[172:175], v[132:135]
v_mfma_f32_16x16x32_bf16 v[136:139], a[220:223], a[196:199], v[136:139]
v_mfma_f32_16x16x32_bf16 v[140:143], a[124:127], a[196:199], v[140:143]
v_mfma_f32_16x16x32_bf16 v[144:147], a[148:151], a[196:199], v[144:147]
s_waitcnt vmcnt(3)
v_mfma_f32_16x16x32_bf16 v[128:131], a[224:227], a[176:179], v[128:131]
v_mfma_f32_16x16x32_bf16 v[132:135], a[128:131], a[176:179], v[132:135]
v_mfma_f32_16x16x32_bf16 v[136:139], a[224:227], a[200:203], v[136:139]
v_mfma_f32_16x16x32_bf16 v[140:143], a[128:131], a[200:203], v[140:143]
v_mfma_f32_16x16x32_bf16 v[144:147], a[152:155], a[200:203], v[144:147]
s_waitcnt vmcnt(2)
v_mfma_f32_16x16x32_bf16 v[128:131], a[228:231], a[180:183], v[128:131]
v_mfma_f32_16x16x32_bf16 v[132:135], a[132:135], a[180:183], v[132:135]
v_mfma_f32_16x16x32_bf16 v[136:139], a[228:231], a[204:207], v[136:139]
v_mfma_f32_16x16x32_bf16 v[140:143], a[132:135], a[204:207], v[140:143]
v_mfma_f32_16x16x32_bf16 v[144:147], a[156:159], a[204:207], v[144:147]
s_waitcnt vmcnt(1)
v_mfma_f32_16x16x32_bf16 v[128:131], a[232:235], a[184:187], v[128:131]
v_mfma_f32_16x16x32_bf16 v[132:135], a[136:139], a[184:187], v[132:135]
v_mfma_f32_16x16x32_bf16 v[136:139], a[232:235], a[208:211], v[136:139]
v_mfma_f32_16x16x32_bf16 v[140:143], a[136:139], a[208:211], v[140:143]
v_mfma_f32_16x16x32_bf16 v[144:147], a[160:163], a[208:211], v[144:147]
s_waitcnt vmcnt(0)
v_mfma_f32_16x16x32_bf16 v[128:131], a[236:239], a[188:191], v[128:131]
v_mfma_f32_16x16x32_bf16 v[132:135], a[140:143], a[188:191], v[132:135]
v_mfma_f32_16x16x32_bf16 v[136:139], a[236:239], a[212:215], v[136:139]
v_mfma_f32_16x16x32_bf16 v[140:143], a[140:143], a[212:215], v[140:143]
v_mfma_f32_16x16x32_bf16 v[144:147], a[164:167], a[212:215], v[144:147]
s_nop 3
v_max3_f32 v28, v128, v129, v130
v_max3_f32 v28, v28, v131, v132
v_max3_f32 v28, v28, v133, v134
v_max_f32 v28, v28, v135
v_mov_b32 v29, v28
s_nop 1
v_permlane32_swap_b32 v28, v29
v_max_f32 v28, v28, v29
v_mov_b32 v29, v28
s_nop 1
v_permlane16_swap_b32 v28, v29
v_max_f32 v28, v28, v29
v_mul_f32 v28, s41, v28
v_fma_f32 v128, v128, s41, -v28
v_fma_f32 v129, v129, s41, -v28
v_fma_f32 v130, v130, s41, -v28
v_fma_f32 v131, v131, s41, -v28
v_fma_f32 v132, v132, s41, -v28
v_fma_f32 v133, v133, s41, -v28
v_fma_f32 v134, v134, s41, -v28
v_fma_f32 v135, v135, s41, -v28
v_exp_f32 v128, v128
v_exp_f32 v129, v129
v_exp_f32 v130, v130
v_exp_f32 v131, v131
v_exp_f32 v132, v132
v_exp_f32 v133, v133
v_exp_f32 v134, v134
v_exp_f32 v135, v135
v_max3_f32 v30, v136, v137, v138
v_max3_f32 v30, v30, v139, v140
v_max3_f32 v30, v30, v141, v142
v_max3_f32 v30, v30, v143, v144
v_max3_f32 v30, v30, v145, v146
v_max_f32 v30, v30, v147
v_mov_b32 v29, v30
s_nop 1
v_permlane32_swap_b32 v30, v29
v_max_f32 v30, v30, v29
v_mov_b32 v29, v30
s_nop 1
v_permlane16_swap_b32 v30, v29
v_max_f32 v30, v30, v29
v_mul_f32 v30, s41, v30
v_fma_f32 v136, v136, s41, -v30
v_fma_f32 v137, v137, s41, -v30
v_fma_f32 v138, v138, s41, -v30
v_fma_f32 v139, v139, s41, -v30
v_fma_f32 v140, v140, s41, -v30
v_fma_f32 v141, v141, s41, -v30
v_fma_f32 v142, v142, s41, -v30
v_fma_f32 v143, v143, s41, -v30
v_fma_f32 v144, v144, s41, -v30
v_fma_f32 v145, v145, s41, -v30
v_fma_f32 v146, v146, s41, -v30
v_fma_f32 v147, v147, s41, -v30
v_exp_f32 v136, v136
v_exp_f32 v137, v137
v_exp_f32 v138, v138
v_exp_f32 v139, v139
v_exp_f32 v140, v140
v_exp_f32 v141, v141
v_exp_f32 v142, v142
v_exp_f32 v143, v143
v_exp_f32 v144, v144
v_exp_f32 v145, v145
v_exp_f32 v146, v146
v_exp_f32 v147, v147
v_cvt_pk_bf16_f32 v72, v128, v129
v_cvt_pk_bf16_f32 v73, v130, v131
v_cvt_pk_bf16_f32 v74, v132, v133
v_cvt_pk_bf16_f32 v75, v134, v135
v_cvt_pk_bf16_f32 v76, v136, v137
v_cvt_pk_bf16_f32 v77, v138, v139
v_cvt_pk_bf16_f32 v78, v140, v141
v_cvt_pk_bf16_f32 v79, v142, v143
v_cvt_pk_bf16_f32 v80, v144, v145
v_cvt_pk_bf16_f32 v81, v146, v147
v_mfma_f32_16x16x16_bf16 v[148:151], v[36:37], v[72:73], 0
v_mfma_f32_16x16x16_bf16 v[152:155], v[36:37], v[76:77], 0
v_mfma_f32_16x16x16_bf16 v[148:151], v[36:37], v[74:75], v[148:151]
v_mfma_f32_16x16x32_bf16 v[152:155], v[36:39], v[78:81], v[152:155]
s_nop 6
v_rcp_f32 v82, v148
v_rcp_f32 v83, v152
s_and_b32 s34, s17, 1
s_mul_i32 s34, s34, 3072
v_add_u32 v28, s34, v1
ds_write_b128 v28, v[72:75] offset:16384
ds_write_b128 v28, v[76:79] offset:17408
ds_write_b128 v28, v[80:83] offset:18432
s_waitcnt lgkmcnt(0)
s_branch reca_b5207
reca_tw1208:
s_cmp_lt_u32 s17, 3
s_cbranch_scc1 reca_b5207
s_sub_u32 s36, s17, 3
s_and_b32 s37, s36, 7
s_lshl_b32 s34, s59, 3
s_add_u32 s34, s34, s37
s_mul_i32 s34, s34, 12288
s_add_u32 s23, s34, 40894464
s_lshl_b32 s35, s37, 5
s_add_u32 s35, s35, s59
s_mul_i32 s35, s35, 3072
s_add_u32 s61, s35, 47972352
s_mul_i32 s34, s36, 393216
s_mul_i32 s35, s59, 6144
s_add_u32 s34, s34, s35
s_add_u32 s60, s34, 57147392
s_add_u32 s34, s17, 1
s_and_b32 s34, s34, 1
s_mul_i32 s34, s34, 3072
v_add_u32 v28, s34, v1
ds_read_b128 v[72:75], v28 offset:16384
ds_read_b128 v[76:79], v28 offset:17408
ds_read_b128 v[80:83], v28 offset:18432
buffer_load_dwordx2 a[168:169], v93, s[4:7], s61 offen offset:0 sc1
buffer_load_dwordx4 a[120:123], v1, s[4:7], s23 offen offset:0 sc1
buffer_load_dwordx2 a[170:171], v93, s[4:7], s61 offen offset:256 sc1
buffer_load_dwordx4 a[124:127], v1, s[4:7], s23 offen offset:1024 sc1
buffer_load_dwordx2 a[172:173], v93, s[4:7], s61 offen offset:512 sc1
buffer_load_dwordx4 a[128:131], v1, s[4:7], s23 offen offset:2048 sc1
buffer_load_dwordx2 a[174:175], v93, s[4:7], s61 offen offset:768 sc1
buffer_load_dwordx4 a[132:135], v1, s[4:7], s23 offen offset:3072 sc1
buffer_load_dwordx2 a[176:177], v93, s[4:7], s61 offen offset:1024 sc1
buffer_load_dwordx4 a[136:139], v2, s[4:7], s23 offen offset:0 sc1
buffer_load_dwordx2 a[178:179], v93, s[4:7], s61 offen offset:1280 sc1
buffer_load_dwordx4 a[140:143], v2, s[4:7], s23 offen offset:1024 sc1
s_waitcnt lgkmcnt(0)
s_waitcnt vmcnt(8)
v_mfma_f32_16x16x16_bf16 v[156:159], a[168:169], v[72:73], 0
v_mfma_f32_16x16x16_bf16 v[160:163], a[168:169], v[76:77], 0
v_mfma_f32_16x16x16_bf16 v[156:159], a[120:121], v[74:75], v[156:159]
v_mfma_f32_16x16x32_bf16 v[160:163], a[120:123], v[78:81], v[160:163]
v_mfma_f32_16x16x16_bf16 v[164:167], a[170:171], v[72:73], 0
v_mfma_f32_16x16x16_bf16 v[168:171], a[170:171], v[76:77], 0
v_mfma_f32_16x16x16_bf16 v[164:167], a[124:125], v[74:75], v[164:167]
v_mfma_f32_16x16x32_bf16 v[168:171], a[124:127], v[78:81], v[168:171]
s_nop 2
v_mul_f32 v156, v156, v82
v_mul_f32 v157, v157, v82
v_mul_f32 v158, v158, v82
v_mul_f32 v159, v159, v82
v_cvt_pk_bf16_f32 v172, v156, v157
v_cvt_pk_bf16_f32 v173, v158, v159
v_mul_f32 v164, v164, v82
v_mul_f32 v165, v165, v82
v_mul_f32 v166, v166, v82
v_mul_f32 v167, v167, v82
v_cvt_pk_bf16_f32 v174, v164, v165
v_cvt_pk_bf16_f32 v175, v166, v167
buffer_store_dwordx4 v[172:175], v1, s[4:7], s60 offen offset:0 sc1
v_mul_f32 v160, v160, v83
v_mul_f32 v161, v161, v83
v_mul_f32 v162, v162, v83
v_mul_f32 v163, v163, v83
v_cvt_pk_bf16_f32 v176, v160, v161
v_cvt_pk_bf16_f32 v177, v162, v163
v_mul_f32 v168, v168, v83
v_mul_f32 v169, v169, v83
v_mul_f32 v170, v170, v83
v_mul_f32 v171, v171, v83
v_cvt_pk_bf16_f32 v178, v168, v169
v_cvt_pk_bf16_f32 v179, v170, v171
s_add_u32 s34, s60, 196608
buffer_store_dwordx4 v[176:179], v1, s[4:7], s34 offen offset:0 sc1
s_waitcnt vmcnt(6)
v_mfma_f32_16x16x16_bf16 v[156:159], a[172:173], v[72:73], 0
v_mfma_f32_16x16x16_bf16 v[160:163], a[172:173], v[76:77], 0
v_mfma_f32_16x16x16_bf16 v[156:159], a[128:129], v[74:75], v[156:159]
v_mfma_f32_16x16x32_bf16 v[160:163], a[128:131], v[78:81], v[160:163]
v_mfma_f32_16x16x16_bf16 v[164:167], a[174:175], v[72:73], 0
v_mfma_f32_16x16x16_bf16 v[168:171], a[174:175], v[76:77], 0
v_mfma_f32_16x16x16_bf16 v[164:167], a[132:133], v[74:75], v[164:167]
v_mfma_f32_16x16x32_bf16 v[168:171], a[132:135], v[78:81], v[168:171]
s_nop 2
v_mul_f32 v156, v156, v82
v_mul_f32 v157, v157, v82
v_mul_f32 v158, v158, v82
v_mul_f32 v159, v159, v82
v_cvt_pk_bf16_f32 v172, v156, v157
v_cvt_pk_bf16_f32 v173, v158, v159
v_mul_f32 v164, v164, v82
v_mul_f32 v165, v165, v82
v_mul_f32 v166, v166, v82
v_mul_f32 v167, v167, v82
v_cvt_pk_bf16_f32 v174, v164, v165
v_cvt_pk_bf16_f32 v175, v166, v167
buffer_store_dwordx4 v[172:175], v1, s[4:7], s60 offen offset:1024 sc1
v_mul_f32 v160, v160, v83
v_mul_f32 v161, v161, v83
v_mul_f32 v162, v162, v83
v_mul_f32 v163, v163, v83
v_cvt_pk_bf16_f32 v176, v160, v161
v_cvt_pk_bf16_f32 v177, v162, v163
v_mul_f32 v168, v168, v83
v_mul_f32 v169, v169, v83
v_mul_f32 v170, v170, v83
v_mul_f32 v171, v171, v83
v_cvt_pk_bf16_f32 v178, v168, v169
v_cvt_pk_bf16_f32 v179, v170, v171
s_add_u32 s34, s60, 196608
buffer_store_dwordx4 v[176:179], v1, s[4:7], s34 offen offset:1024 sc1
s_waitcnt vmcnt(4)
v_mfma_f32_16x16x16_bf16 v[156:159], a[176:177], v[72:73], 0
v_mfma_f32_16x16x16_bf16 v[160:163], a[176:177], v[76:77], 0
v_mfma_f32_16x16x16_bf16 v[156:159], a[136:137], v[74:75], v[156:159]
v_mfma_f32_16x16x32_bf16 v[160:163], a[136:139], v[78:81], v[160:163]
v_mfma_f32_16x16x16_bf16 v[164:167], a[178:179], v[72:73], 0
v_mfma_f32_16x16x16_bf16 v[168:171], a[178:179], v[76:77], 0
v_mfma_f32_16x16x16_bf16 v[164:167], a[140:141], v[74:75], v[164:167]
v_mfma_f32_16x16x32_bf16 v[168:171], a[140:143], v[78:81], v[168:171]
s_nop 2
v_mul_f32 v156, v156, v82
v_mul_f32 v157, v157, v82
v_mul_f32 v158, v158, v82
v_mul_f32 v159, v159, v82
v_cvt_pk_bf16_f32 v172, v156, v157
v_cvt_pk_bf16_f32 v173, v158, v159
v_mul_f32 v164, v164, v82
v_mul_f32 v165, v165, v82
v_mul_f32 v166, v166, v82
v_mul_f32 v167, v167, v82
v_cvt_pk_bf16_f32 v174, v164, v165
v_cvt_pk_bf16_f32 v175, v166, v167
buffer_store_dwordx4 v[172:175], v1, s[4:7], s60 offen offset:2048 sc1
v_mul_f32 v160, v160, v83
v_mul_f32 v161, v161, v83
v_mul_f32 v162, v162, v83
v_mul_f32 v163, v163, v83
v_cvt_pk_bf16_f32 v176, v160, v161
v_cvt_pk_bf16_f32 v177, v162, v163
v_mul_f32 v168, v168, v83
v_mul_f32 v169, v169, v83
v_mul_f32 v170, v170, v83
v_mul_f32 v171, v171, v83
v_cvt_pk_bf16_f32 v178, v168, v169
v_cvt_pk_bf16_f32 v179, v170, v171
s_add_u32 s34, s60, 196608
buffer_store_dwordx4 v[176:179], v1, s[4:7], s34 offen offset:2048 sc1
s_branch reca_b5207
reca_tw2209:
s_cmp_lt_u32 s17, 3
s_cbranch_scc1 reca_b5207
s_sub_u32 s36, s17, 3
s_and_b32 s37, s36, 7
s_lshl_b32 s34, s59, 3
s_add_u32 s34, s34, s37
s_mul_i32 s34, s34, 12288
s_add_u32 s23, s34, 40894464
s_lshl_b32 s35, s37, 5
s_add_u32 s35, s35, s59
s_mul_i32 s35, s35, 3072
s_add_u32 s61, s35, 47972352
s_mul_i32 s34, s36, 393216
s_mul_i32 s35, s59, 6144
s_add_u32 s34, s34, s35
s_add_u32 s60, s34, 57147392
s_add_u32 s34, s17, 1
s_and_b32 s34, s34, 1
s_mul_i32 s34, s34, 3072
v_add_u32 v28, s34, v1
ds_read_b128 v[72:75], v28 offset:16384
ds_read_b128 v[76:79], v28 offset:17408
ds_read_b128 v[80:83], v28 offset:18432
buffer_load_dwordx2 a[180:181], v93, s[4:7], s61 offen offset:1536 sc1
buffer_load_dwordx4 a[144:147], v2, s[4:7], s23 offen offset:2048 sc1
buffer_load_dwordx2 a[182:183], v93, s[4:7], s61 offen offset:1792 sc1
buffer_load_dwordx4 a[148:151], v2, s[4:7], s23 offen offset:3072 sc1
buffer_load_dwordx2 a[184:185], v93, s[4:7], s61 offen offset:2048 sc1
buffer_load_dwordx4 a[152:155], v3, s[4:7], s23 offen offset:0 sc1
buffer_load_dwordx2 a[186:187], v93, s[4:7], s61 offen offset:2304 sc1
buffer_load_dwordx4 a[156:159], v3, s[4:7], s23 offen offset:1024 sc1
buffer_load_dwordx2 a[188:189], v93, s[4:7], s61 offen offset:2560 sc1
buffer_load_dwordx4 a[160:163], v3, s[4:7], s23 offen offset:2048 sc1
buffer_load_dwordx2 a[190:191], v93, s[4:7], s61 offen offset:2816 sc1
buffer_load_dwordx4 a[164:167], v3, s[4:7], s23 offen offset:3072 sc1
s_waitcnt lgkmcnt(0)
s_waitcnt vmcnt(8)
v_mfma_f32_16x16x16_bf16 v[156:159], a[180:181], v[72:73], 0
v_mfma_f32_16x16x16_bf16 v[160:163], a[180:181], v[76:77], 0
v_mfma_f32_16x16x16_bf16 v[156:159], a[144:145], v[74:75], v[156:159]
v_mfma_f32_16x16x32_bf16 v[160:163], a[144:147], v[78:81], v[160:163]
v_mfma_f32_16x16x16_bf16 v[164:167], a[182:183], v[72:73], 0
v_mfma_f32_16x16x16_bf16 v[168:171], a[182:183], v[76:77], 0
v_mfma_f32_16x16x16_bf16 v[164:167], a[148:149], v[74:75], v[164:167]
v_mfma_f32_16x16x32_bf16 v[168:171], a[148:151], v[78:81], v[168:171]
s_nop 2
v_mul_f32 v156, v156, v82
v_mul_f32 v157, v157, v82
v_mul_f32 v158, v158, v82
v_mul_f32 v159, v159, v82
v_cvt_pk_bf16_f32 v172, v156, v157
v_cvt_pk_bf16_f32 v173, v158, v159
v_mul_f32 v164, v164, v82
v_mul_f32 v165, v165, v82
v_mul_f32 v166, v166, v82
v_mul_f32 v167, v167, v82
v_cvt_pk_bf16_f32 v174, v164, v165
v_cvt_pk_bf16_f32 v175, v166, v167
buffer_store_dwordx4 v[172:175], v1, s[4:7], s60 offen offset:3072 sc1
v_mul_f32 v160, v160, v83
v_mul_f32 v161, v161, v83
v_mul_f32 v162, v162, v83
v_mul_f32 v163, v163, v83
v_cvt_pk_bf16_f32 v176, v160, v161
v_cvt_pk_bf16_f32 v177, v162, v163
v_mul_f32 v168, v168, v83
v_mul_f32 v169, v169, v83
v_mul_f32 v170, v170, v83
v_mul_f32 v171, v171, v83
v_cvt_pk_bf16_f32 v178, v168, v169
v_cvt_pk_bf16_f32 v179, v170, v171
s_add_u32 s34, s60, 196608
buffer_store_dwordx4 v[176:179], v1, s[4:7], s34 offen offset:3072 sc1
s_waitcnt vmcnt(6)
v_mfma_f32_16x16x16_bf16 v[156:159], a[184:185], v[72:73], 0
v_mfma_f32_16x16x16_bf16 v[160:163], a[184:185], v[76:77], 0
v_mfma_f32_16x16x16_bf16 v[156:159], a[152:153], v[74:75], v[156:159]
v_mfma_f32_16x16x32_bf16 v[160:163], a[152:155], v[78:81], v[160:163]
v_mfma_f32_16x16x16_bf16 v[164:167], a[186:187], v[72:73], 0
v_mfma_f32_16x16x16_bf16 v[168:171], a[186:187], v[76:77], 0
v_mfma_f32_16x16x16_bf16 v[164:167], a[156:157], v[74:75], v[164:167]
v_mfma_f32_16x16x32_bf16 v[168:171], a[156:159], v[78:81], v[168:171]
s_nop 2
v_mul_f32 v156, v156, v82
v_mul_f32 v157, v157, v82
v_mul_f32 v158, v158, v82
v_mul_f32 v159, v159, v82
v_cvt_pk_bf16_f32 v172, v156, v157
v_cvt_pk_bf16_f32 v173, v158, v159
v_mul_f32 v164, v164, v82
v_mul_f32 v165, v165, v82
v_mul_f32 v166, v166, v82
v_mul_f32 v167, v167, v82
v_cvt_pk_bf16_f32 v174, v164, v165
v_cvt_pk_bf16_f32 v175, v166, v167
buffer_store_dwordx4 v[172:175], v2, s[4:7], s60 offen offset:0 sc1
v_mul_f32 v160, v160, v83
v_mul_f32 v161, v161, v83
v_mul_f32 v162, v162, v83
v_mul_f32 v163, v163, v83
v_cvt_pk_bf16_f32 v176, v160, v161
v_cvt_pk_bf16_f32 v177, v162, v163
v_mul_f32 v168, v168, v83
v_mul_f32 v169, v169, v83
v_mul_f32 v170, v170, v83
v_mul_f32 v171, v171, v83
v_cvt_pk_bf16_f32 v178, v168, v169
v_cvt_pk_bf16_f32 v179, v170, v171
s_add_u32 s34, s60, 196608
buffer_store_dwordx4 v[176:179], v2, s[4:7], s34 offen offset:0 sc1
s_waitcnt vmcnt(4)
v_mfma_f32_16x16x16_bf16 v[156:159], a[188:189], v[72:73], 0
v_mfma_f32_16x16x16_bf16 v[160:163], a[188:189], v[76:77], 0
v_mfma_f32_16x16x16_bf16 v[156:159], a[160:161], v[74:75], v[156:159]
v_mfma_f32_16x16x32_bf16 v[160:163], a[160:163], v[78:81], v[160:163]
v_mfma_f32_16x16x16_bf16 v[164:167], a[190:191], v[72:73], 0
v_mfma_f32_16x16x16_bf16 v[168:171], a[190:191], v[76:77], 0
v_mfma_f32_16x16x16_bf16 v[164:167], a[164:165], v[74:75], v[164:167]
v_mfma_f32_16x16x32_bf16 v[168:171], a[164:167], v[78:81], v[168:171]
s_nop 2
v_mul_f32 v156, v156, v82
v_mul_f32 v157, v157, v82
v_mul_f32 v158, v158, v82
v_mul_f32 v159, v159, v82
v_cvt_pk_bf16_f32 v172, v156, v157
v_cvt_pk_bf16_f32 v173, v158, v159
v_mul_f32 v164, v164, v82
v_mul_f32 v165, v165, v82
v_mul_f32 v166, v166, v82
v_mul_f32 v167, v167, v82
v_cvt_pk_bf16_f32 v174, v164, v165
v_cvt_pk_bf16_f32 v175, v166, v167
buffer_store_dwordx4 v[172:175], v2, s[4:7], s60 offen offset:1024 sc1
v_mul_f32 v160, v160, v83
v_mul_f32 v161, v161, v83
v_mul_f32 v162, v162, v83
v_mul_f32 v163, v163, v83
v_cvt_pk_bf16_f32 v176, v160, v161
v_cvt_pk_bf16_f32 v177, v162, v163
v_mul_f32 v168, v168, v83
v_mul_f32 v169, v169, v83
v_mul_f32 v170, v170, v83
v_mul_f32 v171, v171, v83
v_cvt_pk_bf16_f32 v178, v168, v169
v_cvt_pk_bf16_f32 v179, v170, v171
s_add_u32 s34, s60, 196608
buffer_store_dwordx4 v[176:179], v2, s[4:7], s34 offen offset:1024 sc1
s_branch reca_b5207
s_cmp_lg_u32 s12, 2
s_cbranch_scc1 reca_b3205
buffer_store_dwordx2 v[52:53], v9, s[4:7], s30 offen sc1
buffer_store_dwordx2 v[32:33], v16, s[4:7], s26 offen sc1
s_cmp_lg_u32 s14, 0
s_cbranch_scc1 reca_b3205
v_mov_b32 v28, s17
s_lshl_b32 s34, s13, 7
s_add_u32 s34, s34, 1507328
buffer_store_dword v28, v19, s[4:7], s34 offen sc1
s_branch reca_b3205
reca_last204:
s_cmp_lg_u32 s12, 2
s_cbranch_scc1 reca_exit1
buffer_store_dwordx2 v[52:53], v9, s[4:7], s30 offen
s_branch reca_exit1
reca_swave202:
s_cmp_lg_u32 s17, 63
s_cbranch_scc1 reca_vmst210
s_barrier
ds_read_b128 v[56:59], v1 offset:10240
ds_read_b128 v[60:63], v1 offset:11264
ds_read_b128 v[64:67], v1 offset:12288
s_waitcnt lgkmcnt(0)
v_add_f32 v56, v56, v64
v_add_f32 v60, v60, v48
v_add_f32 v57, v57, v65
v_add_f32 v61, v61, v49
v_add_f32 v58, v58, v66
v_add_f32 v62, v62, v50
v_add_f32 v59, v59, v67
v_add_f32 v63, v63, v51
v_cvt_pk_bf16_f32 v68, v56, v57
v_cvt_pk_bf16_f32 v69, v58, v59
v_cvt_pk_bf16_f32 v70, v60, v61
v_cvt_pk_bf16_f32 v71, v62, v63
buffer_store_dwordx2 v[52:53], v9, s[4:7], s30 offen
buffer_store_dwordx2 v[68:69], v10, s[4:7], s31 offen
buffer_store_dwordx2 v[70:71], v10, s[4:7], s31 offen offset:256
s_branch reca_exit1
reca_vmst210:
s_sleep 1
buffer_load_dwordx4 v[208:211], v1, s[4:7], s21 offen offset:0 sc1
buffer_load_dwordx4 v[212:215], v1, s[4:7], s21 offen offset:1024 sc1
buffer_load_dwordx4 v[216:219], v1, s[4:7], s21 offen offset:2048 sc1
buffer_load_dwordx4 v[220:223], v1, s[4:7], s21 offen offset:3072 sc1
buffer_load_dwordx4 v[224:227], v2, s[4:7], s21 offen offset:0 sc1
buffer_load_dwordx4 v[228:231], v2, s[4:7], s21 offen offset:1024 sc1
s_waitcnt vmcnt(5)
v_max_u32 v29, v208, v210
v_cmp_eq_u32 vcc, -1, v29
s_cbranch_vccnz reca_retry211
reca_resume212:
s_waitcnt vmcnt(4)
v_max_u32 v29, v212, v214
v_cmp_eq_u32 vcc, -1, v29
v_mfma_f32_16x16x32_bf16 v[76:79], a[120:123], v[208:211], 0
v_mfma_f32_16x16x32_bf16 v[80:83], a[144:147], v[208:211], 0
v_mfma_f32_16x16x32_bf16 v[72:75], v[208:211], v[208:211], v[40:43]
s_cbranch_vccnz reca_retry213
reca_resume214:
s_waitcnt vmcnt(3)
v_max_u32 v29, v216, v218
v_cmp_eq_u32 vcc, -1, v29
v_mfma_f32_16x16x32_bf16 v[76:79], a[124:127], v[212:215], v[76:79]
v_mfma_f32_16x16x32_bf16 v[80:83], a[148:151], v[212:215], v[80:83]
v_mfma_f32_16x16x32_bf16 v[72:75], v[212:215], v[212:215], v[72:75]
s_cbranch_vccnz reca_retry215
reca_resume216:
s_waitcnt vmcnt(2)
v_max_u32 v29, v220, v222
v_cmp_eq_u32 vcc, -1, v29
v_mfma_f32_16x16x32_bf16 v[76:79], a[128:131], v[216:219], v[76:79]
v_mfma_f32_16x16x32_bf16 v[80:83], a[152:155], v[216:219], v[80:83]
v_mfma_f32_16x16x32_bf16 v[72:75], v[216:219], v[216:219], v[72:75]
s_cbranch_vccnz reca_retry217
reca_resume218:
s_waitcnt vmcnt(1)
v_max_u32 v29, v224, v226
v_cmp_eq_u32 vcc, -1, v29
v_mfma_f32_16x16x32_bf16 v[76:79], a[132:135], v[220:223], v[76:79]
v_mfma_f32_16x16x32_bf16 v[80:83], a[156:159], v[220:223], v[80:83]
v_mfma_f32_16x16x32_bf16 v[72:75], v[220:223], v[220:223], v[72:75]
s_cbranch_vccnz reca_retry219
reca_resume220:
s_waitcnt vmcnt(0)
v_max_u32 v29, v228, v230
v_cmp_eq_u32 vcc, -1, v29
v_mfma_f32_16x16x32_bf16 v[76:79], a[136:139], v[224:227], v[76:79]
v_mfma_f32_16x16x32_bf16 v[80:83], a[160:163], v[224:227], v[80:83]
v_mfma_f32_16x16x32_bf16 v[72:75], v[224:227], v[224:227], v[72:75]
s_cbranch_vccnz reca_retry221
reca_resume222:
v_mfma_f32_16x16x32_bf16 v[76:79], a[140:143], v[228:231], v[76:79]
v_mfma_f32_16x16x32_bf16 v[80:83], a[164:167], v[228:231], v[80:83]
v_mfma_f32_16x16x32_bf16 v[72:75], v[228:231], v[228:231], v[72:75]
s_barrier
ds_read_b128 v[56:59], v1 offset:10240
ds_read_b128 v[60:63], v1 offset:11264
ds_read_b128 v[64:67], v1 offset:12288
s_nop 1
v_max3_f32 v28, v76, v77, v78
v_max3_f32 v29, v80, v81, v82
v_max3_f32 v28, v28, v79, v83
v_max3_f32 v29, v29, v72, v73
v_max3_f32 v28, v28, v74, v75
v_max_f32 v28, v28, v29
v_mov_b32 v29, v28
s_nop 1
v_permlane32_swap_b32 v28, v29
v_max_f32 v28, v28, v29
v_mov_b32 v29, v28
s_nop 1
v_permlane16_swap_b32 v28, v29
v_max_f32 v28, v28, v29
v_mul_f32 v28, s41, v28
v_fma_f32 v76, v76, s41, -v28
v_fma_f32 v77, v77, s41, -v28
v_fma_f32 v78, v78, s41, -v28
v_fma_f32 v79, v79, s41, -v28
v_fma_f32 v80, v80, s41, -v28
v_fma_f32 v81, v81, s41, -v28
v_fma_f32 v82, v82, s41, -v28
v_fma_f32 v83, v83, s41, -v28
v_fma_f32 v72, v72, s41, -v28
v_fma_f32 v73, v73, s41, -v28
v_fma_f32 v74, v74, s41, -v28
v_fma_f32 v75, v75, s41, -v28
v_exp_f32 v76, v76
v_exp_f32 v77, v77
v_exp_f32 v78, v78
v_exp_f32 v79, v79
v_exp_f32 v80, v80
v_exp_f32 v81, v81
v_exp_f32 v82, v82
v_exp_f32 v83, v83
v_cvt_pk_bf16_f32 v84, v76, v77
v_cvt_pk_bf16_f32 v85, v78, v79
v_cvt_pk_bf16_f32 v86, v80, v81
v_cvt_pk_bf16_f32 v87, v82, v83
v_exp_f32 v72, v72
v_exp_f32 v73, v73
v_mfma_f32_16x16x32_bf16 v[100:103], v[36:39], v[84:87], 0
v_exp_f32 v74, v74
v_exp_f32 v75, v75
v_mfma_f32_16x16x32_bf16 v[92:95], a[168:171], v[84:87], 0
v_cvt_pk_bf16_f32 v88, v72, v73
v_cvt_pk_bf16_f32 v89, v74, v75
v_mfma_f32_16x16x32_bf16 v[96:99], a[172:175], v[84:87], 0
s_waitcnt lgkmcnt(0)
v_mfma_f32_16x16x16_bf16 v[100:103], v[36:37], v[88:89], v[100:103]
v_add_f32 v56, v56, v64
v_add_f32 v60, v60, v48
v_add_f32 v57, v57, v65
v_add_f32 v61, v61, v49
v_add_f32 v58, v58, v66
v_add_f32 v62, v62, v50
v_add_f32 v59, v59, v67
v_add_f32 v63, v63, v51
v_cvt_pk_bf16_f32 v68, v56, v57
v_cvt_pk_bf16_f32 v69, v58, v59
v_cvt_pk_bf16_f32 v70, v60, v61
v_cvt_pk_bf16_f32 v71, v62, v63
v_mfma_f32_16x16x16_bf16 v[92:95], v[68:69], v[88:89], v[92:95]
v_rcp_f32 v28, v100
v_mfma_f32_16x16x16_bf16 v[96:99], v[70:71], v[88:89], v[96:99]
v_mov_b32 v29, v28
s_nop 4
v_pk_mul_f32 v[92:93], v[92:93], v[28:29]
v_pk_mul_f32 v[94:95], v[94:95], v[28:29]
v_pk_mul_f32 v[96:97], v[96:97], v[28:29]
v_pk_mul_f32 v[98:99], v[98:99], v[28:29]
v_cvt_pk_bf16_f32 v104, v92, v93
v_cvt_pk_bf16_f32 v105, v94, v95
v_cvt_pk_bf16_f32 v106, v96, v97
v_cvt_pk_bf16_f32 v107, v98, v99
buffer_store_dwordx4 v[104:107], v11, s[4:7], s22 offen sc1
s_barrier
s_add_u32 s34, s17, 2
s_and_b32 s34, s34, 3
s_mul_i32 s26, s34, 10240
s_add_u32 s26, s26, s38
s_mul_i32 s27, s34, 6144
s_add_u32 s27, s27, s39
s_mul_i32 s28, s34, 12288
s_add_u32 s28, s28, s40
s_mul_i32 s29, s34, 393216
s_add_u32 s29, s29, s56
buffer_store_dwordx2 v[32:33], v8, s[4:7], s27 offen sc1
buffer_store_dwordx4 v[32:35], v11, s[4:7], s28 offen sc1
s_add_u32 s36, s17, 1
s_cmp_ge_u32 s36, 63
s_cbranch_scc1 reca_nopf223
s_add_u32 s37, s36, 1
reca_pf224:
buffer_load_dword v28, v233, s[4:7], 0 offen sc1
s_waitcnt vmcnt(0)
v_cmp_gt_i32 vcc, s37, v28
s_cbranch_vccz reca_pfok225
s_sleep 1
s_sub_u32 s18, s18, 1
s_cbranch_scc0 reca_pf224
s_mov_b32 s18, 0
reca_pfok225:
s_lshl_b32 s34, s15, 3
s_and_b32 s35, s36, 7
s_add_u32 s34, s34, s35
s_mul_i32 s34, s34, 12288
s_add_u32 s32, s34, 37748736
s_lshl_b32 s35, s16, 11
s_add_u32 s34, s34, s35
s_add_u32 s33, s34, 40894464
buffer_load_dwordx4 a[120:123], v1, s[4:7], s32 offen offset:0 sc1
buffer_load_dwordx4 a[124:127], v1, s[4:7], s32 offen offset:1024 sc1
buffer_load_dwordx4 a[128:131], v1, s[4:7], s32 offen offset:2048 sc1
buffer_load_dwordx4 a[132:135], v1, s[4:7], s32 offen offset:3072 sc1
buffer_load_dwordx4 a[136:139], v2, s[4:7], s32 offen offset:0 sc1
buffer_load_dwordx4 a[140:143], v2, s[4:7], s32 offen offset:1024 sc1
buffer_load_dwordx4 a[144:147], v2, s[4:7], s32 offen offset:2048 sc1
buffer_load_dwordx4 a[148:151], v2, s[4:7], s32 offen offset:3072 sc1
buffer_load_dwordx4 a[152:155], v3, s[4:7], s32 offen offset:0 sc1
buffer_load_dwordx4 a[156:159], v3, s[4:7], s32 offen offset:1024 sc1
buffer_load_dwordx4 a[160:163], v3, s[4:7], s32 offen offset:2048 sc1
buffer_load_dwordx4 a[164:167], v3, s[4:7], s32 offen offset:3072 sc1
buffer_load_dwordx4 a[168:171], v1, s[4:7], s33 offen offset:0 sc1
buffer_load_dwordx4 a[172:175], v1, s[4:7], s33 offen offset:1024 sc1
reca_nopf223:
buffer_store_dwordx2 v[52:53], v9, s[4:7], s30 offen sc1
buffer_store_dwordx2 v[68:69], v10, s[4:7], s31 offen sc1
buffer_store_dwordx2 v[70:71], v10, s[4:7], s31 offen offset:256 sc1
reca_b5207:
s_barrier
s_add_u32 s17, s17, 1
s_branch reca_step193
reca_b3205:
s_endpgm
reca_retry196:
s_sub_u32 s18, s18, 1
s_cbranch_scc1 reca_retry196_to
buffer_load_dwordx4 v[128:131], v4, s[4:7], s20 offen sc1
buffer_load_dwordx4 v[132:135], v4, s[4:7], s20 offen offset:1024 sc1
buffer_load_dwordx4 v[136:139], v5, s[4:7], s20 offen sc1
s_waitcnt vmcnt(2)
v_max_u32 v29, v128, v130
v_cmp_eq_u32 vcc, -1, v29
s_cbranch_vccnz reca_retry196
s_branch reca_resume197
reca_retry196_to:
s_mov_b32 s18, 0
s_waitcnt vmcnt(0)
s_branch reca_resume197
reca_retry198:
s_sub_u32 s18, s18, 1
s_cbranch_scc1 reca_retry198_to
buffer_load_dwordx4 v[132:135], v4, s[4:7], s20 offen offset:1024 sc1
buffer_load_dwordx4 v[136:139], v5, s[4:7], s20 offen sc1
s_waitcnt vmcnt(1)
v_max_u32 v29, v132, v134
v_cmp_eq_u32 vcc, -1, v29
s_cbranch_vccnz reca_retry198
s_branch reca_resume199
reca_retry198_to:
s_mov_b32 s18, 0
s_waitcnt vmcnt(0)
s_branch reca_resume199
reca_retry200:
s_sub_u32 s18, s18, 1
s_cbranch_scc1 reca_retry200_to
buffer_load_dwordx4 v[136:139], v5, s[4:7], s20 offen sc1
s_waitcnt vmcnt(0)
v_max_u32 v29, v136, v138
v_cmp_eq_u32 vcc, -1, v29
s_cbranch_vccnz reca_retry200
s_branch reca_resume201
reca_retry200_to:
s_mov_b32 s18, 0
s_waitcnt vmcnt(0)
s_branch reca_resume201
reca_retry211:
s_sub_u32 s18, s18, 1
s_cbranch_scc1 reca_retry211_to
buffer_load_dwordx4 v[208:211], v1, s[4:7], s21 offen offset:0 sc1
buffer_load_dwordx4 v[212:215], v1, s[4:7], s21 offen offset:1024 sc1
buffer_load_dwordx4 v[216:219], v1, s[4:7], s21 offen offset:2048 sc1
buffer_load_dwordx4 v[220:223], v1, s[4:7], s21 offen offset:3072 sc1
buffer_load_dwordx4 v[224:227], v2, s[4:7], s21 offen offset:0 sc1
buffer_load_dwordx4 v[228:231], v2, s[4:7], s21 offen offset:1024 sc1
s_waitcnt vmcnt(5)
v_max_u32 v29, v208, v210
v_cmp_eq_u32 vcc, -1, v29
s_cbranch_vccnz reca_retry211
s_branch reca_resume212
reca_retry211_to:
s_mov_b32 s18, 0
s_waitcnt vmcnt(0)
s_branch reca_resume212
reca_retry213:
s_sub_u32 s18, s18, 1
s_cbranch_scc1 reca_retry213_to
buffer_load_dwordx4 v[212:215], v1, s[4:7], s21 offen offset:1024 sc1
buffer_load_dwordx4 v[216:219], v1, s[4:7], s21 offen offset:2048 sc1
buffer_load_dwordx4 v[220:223], v1, s[4:7], s21 offen offset:3072 sc1
buffer_load_dwordx4 v[224:227], v2, s[4:7], s21 offen offset:0 sc1
buffer_load_dwordx4 v[228:231], v2, s[4:7], s21 offen offset:1024 sc1
s_waitcnt vmcnt(4)
v_max_u32 v29, v212, v214
v_cmp_eq_u32 vcc, -1, v29
s_cbranch_vccnz reca_retry213
s_branch reca_resume214
reca_retry213_to:
s_mov_b32 s18, 0
s_waitcnt vmcnt(0)
s_branch reca_resume214
reca_retry215:
s_sub_u32 s18, s18, 1
s_cbranch_scc1 reca_retry215_to
buffer_load_dwordx4 v[216:219], v1, s[4:7], s21 offen offset:2048 sc1
buffer_load_dwordx4 v[220:223], v1, s[4:7], s21 offen offset:3072 sc1
buffer_load_dwordx4 v[224:227], v2, s[4:7], s21 offen offset:0 sc1
buffer_load_dwordx4 v[228:231], v2, s[4:7], s21 offen offset:1024 sc1
s_waitcnt vmcnt(3)
v_max_u32 v29, v216, v218
v_cmp_eq_u32 vcc, -1, v29
s_cbranch_vccnz reca_retry215
s_branch reca_resume216
reca_retry215_to:
s_mov_b32 s18, 0
s_waitcnt vmcnt(0)
s_branch reca_resume216
reca_retry217:
s_sub_u32 s18, s18, 1
s_cbranch_scc1 reca_retry217_to
buffer_load_dwordx4 v[220:223], v1, s[4:7], s21 offen offset:3072 sc1
buffer_load_dwordx4 v[224:227], v2, s[4:7], s21 offen offset:0 sc1
buffer_load_dwordx4 v[228:231], v2, s[4:7], s21 offen offset:1024 sc1
s_waitcnt vmcnt(2)
v_max_u32 v29, v220, v222
v_cmp_eq_u32 vcc, -1, v29
s_cbranch_vccnz reca_retry217
s_branch reca_resume218
reca_retry217_to:
s_mov_b32 s18, 0
s_waitcnt vmcnt(0)
s_branch reca_resume218
reca_retry219:
s_sub_u32 s18, s18, 1
s_cbranch_scc1 reca_retry219_to
buffer_load_dwordx4 v[224:227], v2, s[4:7], s21 offen offset:0 sc1
buffer_load_dwordx4 v[228:231], v2, s[4:7], s21 offen offset:1024 sc1
s_waitcnt vmcnt(1)
v_max_u32 v29, v224, v226
v_cmp_eq_u32 vcc, -1, v29
s_cbranch_vccnz reca_retry219
s_branch reca_resume220
reca_retry219_to:
s_mov_b32 s18, 0
s_waitcnt vmcnt(0)
s_branch reca_resume220
reca_retry221:
s_sub_u32 s18, s18, 1
s_cbranch_scc1 reca_retry221_to
buffer_load_dwordx4 v[228:231], v2, s[4:7], s21 offen offset:1024 sc1
s_waitcnt vmcnt(0)
v_max_u32 v29, v228, v230
v_cmp_eq_u32 vcc, -1, v29
s_cbranch_vccnz reca_retry221
s_branch reca_resume222
reca_retry221_to:
s_mov_b32 s18, 0
s_waitcnt vmcnt(0)
s_branch reca_resume222
reca_proj2:
s_sub_u32 s34, s14, 24
s_lshr_b32 s35, s34, 1
s_and_b32 s16, s34, 1
s_lshl_b32 s15, s13, 2
s_add_u32 s15, s15, s35
s_lshl_b32 s24, s13, 3
s_add_u32 s24, s24, s34
s_lshl_b32 s24, s24, 7
s_add_u32 s24, s24, 1540096
s_lshl_b32 s25, s13, 7
s_add_u32 s25, s25, 1507328
v_and_b32 v28, 63, v0
v_lshlrev_b32 v1, 4, v28
v_mov_b32 v29, 0x80000000
v_cmp_eq_u32 vcc, 0, v28
v_mov_b32 v4, 0
s_nop 0
v_cndmask_b32 v4, v29, v4, vcc
v_cmp_gt_u32 vcc, 32, v28
s_nop 1
v_cndmask_b32 v5, v29, v1, vcc
s_cmp_eq_u32 s12, 0
s_cbranch_scc1 reca_pw0_226
s_cmp_eq_u32 s12, 1
s_cbranch_scc1 reca_pw1_227
s_cmp_eq_u32 s12, 2
s_cbranch_scc1 reca_pw2_228
s_branch reca_pw3_229
reca_pw0_226:
s_mov_b32 s17, 0
s_mov_b32 s26, 0
s_mul_i32 s20, s17, 40960
s_add_u32 s20, s20, 84934656
s_add_u32 m0, s26, 0
s_nop 0
buffer_load_dwordx4 v1, s[4:7], s20 offen offset:0 lds
buffer_load_dwordx4 v1, s[4:7], s20 offen offset:1024 lds
buffer_load_dwordx4 v1, s[4:7], s20 offen offset:2048 lds
buffer_load_dwordx4 v1, s[4:7], s20 offen offset:3072 lds
s_add_u32 s20, s20, 4096
s_add_u32 m0, s26, 4096
s_nop 0
buffer_load_dwordx4 v1, s[4:7], s20 offen offset:0 lds
buffer_load_dwordx4 v1, s[4:7], s20 offen offset:1024 lds
buffer_load_dwordx4 v1, s[4:7], s20 offen offset:2048 lds
buffer_load_dwordx4 v1, s[4:7], s20 offen offset:3072 lds
s_add_u32 s20, s20, 4096
s_add_u32 m0, s26, 8192
s_nop 0
buffer_load_dwordx4 v1, s[4:7], s20 offen offset:0 lds
buffer_load_dwordx4 v1, s[4:7], s20 offen offset:1024 lds
s_mul_i32 s34, s15, 12
s_mul_i32 s35, s16, 6
s_add_u32 s34, s34, s35
s_add_u32 s34, s34, 0
s_mul_i32 s34, s34, 20480
s_add_u32 s34, s34, 14155776
buffer_load_dwordx4 a[0:3], v1, s[4:7], s34 offen offset:0
buffer_load_dwordx4 a[4:7], v1, s[4:7], s34 offen offset:1024
buffer_load_dwordx4 a[8:11], v1, s[4:7], s34 offen offset:2048
buffer_load_dwordx4 a[12:15], v1, s[4:7], s34 offen offset:3072
s_add_u32 s34, s34, 4096
buffer_load_dwordx4 a[16:19], v1, s[4:7], s34 offen offset:0
buffer_load_dwordx4 a[20:23], v1, s[4:7], s34 offen offset:1024
buffer_load_dwordx4 a[24:27], v1, s[4:7], s34 offen offset:2048
buffer_load_dwordx4 a[28:31], v1, s[4:7], s34 offen offset:3072
s_add_u32 s34, s34, 4096
buffer_load_dwordx4 a[32:35], v1, s[4:7], s34 offen offset:0
buffer_load_dwordx4 a[36:39], v1, s[4:7], s34 offen offset:1024
buffer_load_dwordx4 a[40:43], v1, s[4:7], s34 offen offset:2048
buffer_load_dwordx4 a[44:47], v1, s[4:7], s34 offen offset:3072
s_add_u32 s34, s34, 4096
buffer_load_dwordx4 a[48:51], v1, s[4:7], s34 offen offset:0
buffer_load_dwordx4 a[52:55], v1, s[4:7], s34 offen offset:1024
buffer_load_dwordx4 a[56:59], v1, s[4:7], s34 offen offset:2048
buffer_load_dwordx4 a[60:63], v1, s[4:7], s34 offen offset:3072
s_add_u32 s34, s34, 4096
buffer_load_dwordx4 a[64:67], v1, s[4:7], s34 offen offset:0
buffer_load_dwordx4 a[68:71], v1, s[4:7], s34 offen offset:1024
buffer_load_dwordx4 a[72:75], v1, s[4:7], s34 offen offset:2048
buffer_load_dwordx4 a[76:79], v1, s[4:7], s34 offen offset:3072
s_mul_i32 s34, s15, 12
s_mul_i32 s35, s16, 6
s_add_u32 s34, s34, s35
s_add_u32 s34, s34, 1
s_mul_i32 s34, s34, 20480
s_add_u32 s34, s34, 14155776
buffer_load_dwordx4 a[80:83], v1, s[4:7], s34 offen offset:0
buffer_load_dwordx4 a[84:87], v1, s[4:7], s34 offen offset:1024
buffer_load_dwordx4 a[88:91], v1, s[4:7], s34 offen offset:2048
buffer_load_dwordx4 a[92:95], v1, s[4:7], s34 offen offset:3072
s_add_u32 s34, s34, 4096
buffer_load_dwordx4 a[96:99], v1, s[4:7], s34 offen offset:0
buffer_load_dwordx4 a[100:103], v1, s[4:7], s34 offen offset:1024
buffer_load_dwordx4 a[104:107], v1, s[4:7], s34 offen offset:2048
buffer_load_dwordx4 a[108:111], v1, s[4:7], s34 offen offset:3072
s_add_u32 s34, s34, 4096
buffer_load_dwordx4 a[112:115], v1, s[4:7], s34 offen offset:0
buffer_load_dwordx4 a[116:119], v1, s[4:7], s34 offen offset:1024
buffer_load_dwordx4 a[120:123], v1, s[4:7], s34 offen offset:2048
buffer_load_dwordx4 a[124:127], v1, s[4:7], s34 offen offset:3072
s_add_u32 s34, s34, 4096
buffer_load_dwordx4 a[128:131], v1, s[4:7], s34 offen offset:0
buffer_load_dwordx4 a[132:135], v1, s[4:7], s34 offen offset:1024
buffer_load_dwordx4 a[136:139], v1, s[4:7], s34 offen offset:2048
buffer_load_dwordx4 a[140:143], v1, s[4:7], s34 offen offset:3072
s_add_u32 s34, s34, 4096
buffer_load_dwordx4 a[144:147], v1, s[4:7], s34 offen offset:0
buffer_load_dwordx4 a[148:151], v1, s[4:7], s34 offen offset:1024
buffer_load_dwordx4 a[152:155], v1, s[4:7], s34 offen offset:2048
buffer_load_dwordx4 a[156:159], v1, s[4:7], s34 offen offset:3072
s_waitcnt vmcnt(20)
s_mul_i32 s34, s15, 12
s_mul_i32 s35, s16, 6
s_add_u32 s34, s34, s35
s_add_u32 s34, s34, 2
s_mul_i32 s34, s34, 20480
s_add_u32 s34, s34, 14155776
buffer_load_dwordx4 a[160:163], v1, s[4:7], s34 offen offset:0
buffer_load_dwordx4 a[164:167], v1, s[4:7], s34 offen offset:1024
buffer_load_dwordx4 a[168:171], v1, s[4:7], s34 offen offset:2048
buffer_load_dwordx4 a[172:175], v1, s[4:7], s34 offen offset:3072
s_add_u32 s34, s34, 4096
buffer_load_dwordx4 a[176:179], v1, s[4:7], s34 offen offset:0
buffer_load_dwordx4 a[180:183], v1, s[4:7], s34 offen offset:1024
buffer_load_dwordx4 a[184:187], v1, s[4:7], s34 offen offset:2048
buffer_load_dwordx4 a[188:191], v1, s[4:7], s34 offen offset:3072
s_add_u32 s34, s34, 4096
buffer_load_dwordx4 a[192:195], v1, s[4:7], s34 offen offset:0
buffer_load_dwordx4 a[196:199], v1, s[4:7], s34 offen offset:1024
buffer_load_dwordx4 a[200:203], v1, s[4:7], s34 offen offset:2048
buffer_load_dwordx4 a[204:207], v1, s[4:7], s34 offen offset:3072
s_add_u32 s34, s34, 4096
buffer_load_dwordx4 a[208:211], v1, s[4:7], s34 offen offset:0
buffer_load_dwordx4 a[212:215], v1, s[4:7], s34 offen offset:1024
buffer_load_dwordx4 a[216:219], v1, s[4:7], s34 offen offset:2048
buffer_load_dwordx4 a[220:223], v1, s[4:7], s34 offen offset:3072
s_add_u32 s34, s34, 4096
buffer_load_dwordx4 a[224:227], v1, s[4:7], s34 offen offset:0
buffer_load_dwordx4 a[228:231], v1, s[4:7], s34 offen offset:1024
buffer_load_dwordx4 a[232:235], v1, s[4:7], s34 offen offset:2048
buffer_load_dwordx4 a[236:239], v1, s[4:7], s34 offen offset:3072
s_waitcnt vmcnt(20)
s_mul_i32 s34, s15, 12
s_mul_i32 s35, s16, 6
s_add_u32 s34, s34, s35
s_add_u32 s34, s34, 3
s_mul_i32 s34, s34, 20480
s_add_u32 s34, s34, 14155776
buffer_load_dwordx4 v[96:99], v1, s[4:7], s34 offen offset:0
buffer_load_dwordx4 v[100:103], v1, s[4:7], s34 offen offset:1024
buffer_load_dwordx4 v[104:107], v1, s[4:7], s34 offen offset:2048
buffer_load_dwordx4 v[108:111], v1, s[4:7], s34 offen offset:3072
s_add_u32 s34, s34, 4096
buffer_load_dwordx4 v[112:115], v1, s[4:7], s34 offen offset:0
buffer_load_dwordx4 v[116:119], v1, s[4:7], s34 offen offset:1024
buffer_load_dwordx4 v[120:123], v1, s[4:7], s34 offen offset:2048
buffer_load_dwordx4 v[124:127], v1, s[4:7], s34 offen offset:3072
s_add_u32 s34, s34, 4096
buffer_load_dwordx4 v[128:131], v1, s[4:7], s34 offen offset:0
buffer_load_dwordx4 v[132:135], v1, s[4:7], s34 offen offset:1024
buffer_load_dwordx4 v[136:139], v1, s[4:7], s34 offen offset:2048
buffer_load_dwordx4 v[140:143], v1, s[4:7], s34 offen offset:3072
s_add_u32 s34, s34, 4096
buffer_load_dwordx4 v[144:147], v1, s[4:7], s34 offen offset:0
buffer_load_dwordx4 v[148:151], v1, s[4:7], s34 offen offset:1024
buffer_load_dwordx4 v[152:155], v1, s[4:7], s34 offen offset:2048
buffer_load_dwordx4 v[156:159], v1, s[4:7], s34 offen offset:3072
s_add_u32 s34, s34, 4096
buffer_load_dwordx4 v[160:163], v1, s[4:7], s34 offen offset:0
buffer_load_dwordx4 v[164:167], v1, s[4:7], s34 offen offset:1024
buffer_load_dwordx4 v[168:171], v1, s[4:7], s34 offen offset:2048
buffer_load_dwordx4 v[172:175], v1, s[4:7], s34 offen offset:3072
s_waitcnt vmcnt(20)
s_mul_i32 s34, s15, 12
s_mul_i32 s35, s16, 6
s_add_u32 s34, s34, s35
s_add_u32 s34, s34, 0
s_mul_i32 s34, s34, 20480
s_add_u32 s34, s34, 22020096
buffer_load_dwordx4 v[176:179], v1, s[4:7], s34 offen offset:0
buffer_load_dwordx4 v[180:183], v1, s[4:7], s34 offen offset:1024
buffer_load_dwordx4 v[184:187], v1, s[4:7], s34 offen offset:2048
buffer_load_dwordx4 v[188:191], v1, s[4:7], s34 offen offset:3072
s_add_u32 s34, s34, 4096
buffer_load_dwordx4 v[192:195], v1, s[4:7], s34 offen offset:0
buffer_load_dwordx4 v[196:199], v1, s[4:7], s34 offen offset:1024
buffer_load_dwordx4 v[200:203], v1, s[4:7], s34 offen offset:2048
buffer_load_dwordx4 v[204:207], v1, s[4:7], s34 offen offset:3072
s_add_u32 s34, s34, 4096
buffer_load_dwordx4 v[208:211], v1, s[4:7], s34 offen offset:0
buffer_load_dwordx4 v[212:215], v1, s[4:7], s34 offen offset:1024
buffer_load_dwordx4 v[216:219], v1, s[4:7], s34 offen offset:2048
buffer_load_dwordx4 v[220:223], v1, s[4:7], s34 offen offset:3072
s_add_u32 s34, s34, 4096
buffer_load_dwordx4 v[224:227], v1, s[4:7], s34 offen offset:0
buffer_load_dwordx4 v[228:231], v1, s[4:7], s34 offen offset:1024
buffer_load_dwordx4 v[232:235], v1, s[4:7], s34 offen offset:2048
buffer_load_dwordx4 v[236:239], v1, s[4:7], s34 offen offset:3072
s_add_u32 s34, s34, 4096
buffer_load_dwordx4 v[240:243], v1, s[4:7], s34 offen offset:0
buffer_load_dwordx4 v[244:247], v1, s[4:7], s34 offen offset:1024
buffer_load_dwordx4 v[248:251], v1, s[4:7], s34 offen offset:2048
buffer_load_dwordx4 v[252:255], v1, s[4:7], s34 offen offset:3072
s_waitcnt vmcnt(20)
v_and_b32 v30, 7, v0
v_lshlrev_b32 v30, 3, v30
reca_cens230:
buffer_load_dwordx2 v[28:29], v30, s[8:11], 0 offen sc1
s_waitcnt vmcnt(0)
v_sad_u8 v31, v28, 0, 0
v_sad_u8 v31, v29, 0, v31
v_cmp_gt_u32 vcc, 32, v31
s_cbranch_vccz reca_censok231
s_sleep 8
s_sub_u32 s18, s18, 1
s_cbranch_scc0 reca_cens230
s_mov_b32 s18, 0
reca_censok231:
v_and_b32 v28, 0x20202020, v28
v_and_b32 v29, 0x20202020, v29
v_cmp_ne_u32 s[34:35], 0, v28
v_cmp_ne_u32 s[36:37], 0, v29
s_nop 3
s_and_b32 s34, s34, 0xff
s_and_b32 s36, s36, 0xff
s_or_b32 s35, s34, s36
s_lshr_b32 s37, s35, s13
s_and_b32 s37, s37, 1
s_xor_b32 s43, s37, 1
s_cmp_eq_u32 s57, 0
s_cselect_b32 s58, s36, s34
v_mov_b32 v31, 0x80000000
s_cmp_lg_u32 s43, 0
s_cbranch_scc1 reca_pslow232
reca_ptop233:
s_cmp_lt_u32 s17, 3
s_cbranch_scc1 reca_pgo234
s_sub_u32 s36, s17, 3
reca_ppoll235:
buffer_load_dword v28, v4, s[4:7], s25 offen sc1
s_waitcnt vmcnt(0)
v_readfirstlane_b32 s34, v28
s_nop 3
s_cmp_ge_i32 s34, s36
s_cbranch_scc1 reca_pgo234
s_sleep 8
s_sub_u32 s18, s18, 1
s_cbranch_scc0 reca_ppoll235
s_mov_b32 s18, 0
reca_pgo234:
s_waitcnt vmcnt(0)
s_barrier
v_add_u32 v7, s26, v1
s_xor_b32 s26, s26, 40960
s_add_u32 s37, s17, 1
s_cmp_ge_u32 s37, 64
s_cbranch_scc1 reca_pnodma236
s_mul_i32 s20, s37, 40960
s_add_u32 s20, s20, 84934656
s_add_u32 m0, s26, 0
s_nop 0
buffer_load_dwordx4 v1, s[4:7], s20 offen offset:0 lds
buffer_load_dwordx4 v1, s[4:7], s20 offen offset:1024 lds
buffer_load_dwordx4 v1, s[4:7], s20 offen offset:2048 lds
buffer_load_dwordx4 v1, s[4:7], s20 offen offset:3072 lds
s_add_u32 s20, s20, 4096
s_add_u32 m0, s26, 4096
s_nop 0
buffer_load_dwordx4 v1, s[4:7], s20 offen offset:0 lds
buffer_load_dwordx4 v1, s[4:7], s20 offen offset:1024 lds
buffer_load_dwordx4 v1, s[4:7], s20 offen offset:2048 lds
buffer_load_dwordx4 v1, s[4:7], s20 offen offset:3072 lds
s_add_u32 s20, s20, 4096
s_add_u32 m0, s26, 8192
s_nop 0
buffer_load_dwordx4 v1, s[4:7], s20 offen offset:0 lds
buffer_load_dwordx4 v1, s[4:7], s20 offen offset:1024 lds
reca_pnodma236:
s_lshl_b32 s34, s15, 3
s_and_b32 s35, s17, 7
s_add_u32 s34, s34, s35
s_mul_i32 s34, s34, 12288
s_mul_i32 s35, s16, 3072
s_add_u32 s35, s35, s34
s_add_u32 s21, s35, 37748736
s_add_u32 s22, s35, 44040192
s_mul_i32 s35, s16, 6144
s_add_u32 s35, s35, s34
s_add_u32 s23, s35, 40894464
ds_read_b128 v[72:75], v7 offset:0
ds_read_b128 v[76:79], v7 offset:20480
ds_read_b128 v[80:83], v7 offset:1024
ds_read_b128 v[84:87], v7 offset:21504
ds_read_b128 v[88:91], v7 offset:2048
ds_read_b128 v[92:95], v7 offset:22528
s_waitcnt lgkmcnt(4)
v_mfma_f32_16x16x32_bf16 v[32:35], a[0:3], v[72:75], 0
v_mfma_f32_16x16x32_bf16 v[36:39], a[0:3], v[76:79], 0
v_mfma_f32_16x16x32_bf16 v[40:43], a[80:83], v[72:75], 0
v_mfma_f32_16x16x32_bf16 v[44:47], a[80:83], v[76:79], 0
v_mfma_f32_16x16x32_bf16 v[48:51], a[160:163], v[72:75], 0
v_mfma_f32_16x16x32_bf16 v[52:55], a[160:163], v[76:79], 0
v_mfma_f32_16x16x32_bf16 v[56:59], v[96:99], v[72:75], 0
v_mfma_f32_16x16x32_bf16 v[60:63], v[96:99], v[76:79], 0
v_mfma_f32_16x16x32_bf16 v[64:67], v[72:75], v[176:179], 0
v_mfma_f32_16x16x32_bf16 v[68:71], v[76:79], v[176:179], 0
ds_read_b128 v[72:75], v7 offset:3072
ds_read_b128 v[76:79], v7 offset:23552
s_waitcnt lgkmcnt(4)
v_mfma_f32_16x16x32_bf16 v[32:35], a[4:7], v[80:83], v[32:35]
v_mfma_f32_16x16x32_bf16 v[36:39], a[4:7], v[84:87], v[36:39]
v_mfma_f32_16x16x32_bf16 v[40:43], a[84:87], v[80:83], v[40:43]
v_mfma_f32_16x16x32_bf16 v[44:47], a[84:87], v[84:87], v[44:47]
v_mfma_f32_16x16x32_bf16 v[48:51], a[164:167], v[80:83], v[48:51]
v_mfma_f32_16x16x32_bf16 v[52:55], a[164:167], v[84:87], v[52:55]
v_mfma_f32_16x16x32_bf16 v[56:59], v[100:103], v[80:83], v[56:59]
v_mfma_f32_16x16x32_bf16 v[60:63], v[100:103], v[84:87], v[60:63]
v_mfma_f32_16x16x32_bf16 v[64:67], v[80:83], v[180:183], v[64:67]
v_mfma_f32_16x16x32_bf16 v[68:71], v[84:87], v[180:183], v[68:71]
ds_read_b128 v[80:83], v7 offset:4096
ds_read_b128 v[84:87], v7 offset:24576
s_waitcnt lgkmcnt(4)
v_mfma_f32_16x16x32_bf16 v[32:35], a[8:11], v[88:91], v[32:35]
v_mfma_f32_16x16x32_bf16 v[36:39], a[8:11], v[92:95], v[36:39]
v_mfma_f32_16x16x32_bf16 v[40:43], a[88:91], v[88:91], v[40:43]
v_mfma_f32_16x16x32_bf16 v[44:47], a[88:91], v[92:95], v[44:47]
v_mfma_f32_16x16x32_bf16 v[48:51], a[168:171], v[88:91], v[48:51]
v_mfma_f32_16x16x32_bf16 v[52:55], a[168:171], v[92:95], v[52:55]
v_mfma_f32_16x16x32_bf16 v[56:59], v[104:107], v[88:91], v[56:59]
v_mfma_f32_16x16x32_bf16 v[60:63], v[104:107], v[92:95], v[60:63]
v_mfma_f32_16x16x32_bf16 v[64:67], v[88:91], v[184:187], v[64:67]
v_mfma_f32_16x16x32_bf16 v[68:71], v[92:95], v[184:187], v[68:71]
ds_read_b128 v[88:91], v7 offset:5120
ds_read_b128 v[92:95], v7 offset:25600
s_waitcnt lgkmcnt(4)
v_mfma_f32_16x16x32_bf16 v[32:35], a[12:15], v[72:75], v[32:35]
v_mfma_f32_16x16x32_bf16 v[36:39], a[12:15], v[76:79], v[36:39]
v_mfma_f32_16x16x32_bf16 v[40:43], a[92:95], v[72:75], v[40:43]
v_mfma_f32_16x16x32_bf16 v[44:47], a[92:95], v[76:79], v[44:47]
v_mfma_f32_16x16x32_bf16 v[48:51], a[172:175], v[72:75], v[48:51]
v_mfma_f32_16x16x32_bf16 v[52:55], a[172:175], v[76:79], v[52:55]
v_mfma_f32_16x16x32_bf16 v[56:59], v[108:111], v[72:75], v[56:59]
v_mfma_f32_16x16x32_bf16 v[60:63], v[108:111], v[76:79], v[60:63]
v_mfma_f32_16x16x32_bf16 v[64:67], v[72:75], v[188:191], v[64:67]
v_mfma_f32_16x16x32_bf16 v[68:71], v[76:79], v[188:191], v[68:71]
ds_read_b128 v[72:75], v7 offset:6144
ds_read_b128 v[76:79], v7 offset:26624
s_waitcnt lgkmcnt(4)
v_mfma_f32_16x16x32_bf16 v[32:35], a[16:19], v[80:83], v[32:35]
v_mfma_f32_16x16x32_bf16 v[36:39], a[16:19], v[84:87], v[36:39]
v_mfma_f32_16x16x32_bf16 v[40:43], a[96:99], v[80:83], v[40:43]
v_mfma_f32_16x16x32_bf16 v[44:47], a[96:99], v[84:87], v[44:47]
v_mfma_f32_16x16x32_bf16 v[48:51], a[176:179], v[80:83], v[48:51]
v_mfma_f32_16x16x32_bf16 v[52:55], a[176:179], v[84:87], v[52:55]
v_mfma_f32_16x16x32_bf16 v[56:59], v[112:115], v[80:83], v[56:59]
v_mfma_f32_16x16x32_bf16 v[60:63], v[112:115], v[84:87], v[60:63]
v_mfma_f32_16x16x32_bf16 v[64:67], v[80:83], v[192:195], v[64:67]
v_mfma_f32_16x16x32_bf16 v[68:71], v[84:87], v[192:195], v[68:71]
ds_read_b128 v[80:83], v7 offset:7168
ds_read_b128 v[84:87], v7 offset:27648
s_waitcnt lgkmcnt(4)
v_mfma_f32_16x16x32_bf16 v[32:35], a[20:23], v[88:91], v[32:35]
v_mfma_f32_16x16x32_bf16 v[36:39], a[20:23], v[92:95], v[36:39]
v_mfma_f32_16x16x32_bf16 v[40:43], a[100:103], v[88:91], v[40:43]
v_mfma_f32_16x16x32_bf16 v[44:47], a[100:103], v[92:95], v[44:47]
v_mfma_f32_16x16x32_bf16 v[48:51], a[180:183], v[88:91], v[48:51]
v_mfma_f32_16x16x32_bf16 v[52:55], a[180:183], v[92:95], v[52:55]
v_mfma_f32_16x16x32_bf16 v[56:59], v[116:119], v[88:91], v[56:59]
v_mfma_f32_16x16x32_bf16 v[60:63], v[116:119], v[92:95], v[60:63]
v_mfma_f32_16x16x32_bf16 v[64:67], v[88:91], v[196:199], v[64:67]
v_mfma_f32_16x16x32_bf16 v[68:71], v[92:95], v[196:199], v[68:71]
ds_read_b128 v[88:91], v7 offset:8192
ds_read_b128 v[92:95], v7 offset:28672
s_waitcnt lgkmcnt(4)
v_mfma_f32_16x16x32_bf16 v[32:35], a[24:27], v[72:75], v[32:35]
v_mfma_f32_16x16x32_bf16 v[36:39], a[24:27], v[76:79], v[36:39]
v_mfma_f32_16x16x32_bf16 v[40:43], a[104:107], v[72:75], v[40:43]
v_mfma_f32_16x16x32_bf16 v[44:47], a[104:107], v[76:79], v[44:47]
v_mfma_f32_16x16x32_bf16 v[48:51], a[184:187], v[72:75], v[48:51]
v_mfma_f32_16x16x32_bf16 v[52:55], a[184:187], v[76:79], v[52:55]
v_mfma_f32_16x16x32_bf16 v[56:59], v[120:123], v[72:75], v[56:59]
v_mfma_f32_16x16x32_bf16 v[60:63], v[120:123], v[76:79], v[60:63]
v_mfma_f32_16x16x32_bf16 v[64:67], v[72:75], v[200:203], v[64:67]
v_mfma_f32_16x16x32_bf16 v[68:71], v[76:79], v[200:203], v[68:71]
ds_read_b128 v[72:75], v7 offset:9216
ds_read_b128 v[76:79], v7 offset:29696
s_waitcnt lgkmcnt(4)
v_mfma_f32_16x16x32_bf16 v[32:35], a[28:31], v[80:83], v[32:35]
v_mfma_f32_16x16x32_bf16 v[36:39], a[28:31], v[84:87], v[36:39]
v_mfma_f32_16x16x32_bf16 v[40:43], a[108:111], v[80:83], v[40:43]
v_mfma_f32_16x16x32_bf16 v[44:47], a[108:111], v[84:87], v[44:47]
v_mfma_f32_16x16x32_bf16 v[48:51], a[188:191], v[80:83], v[48:51]
v_mfma_f32_16x16x32_bf16 v[52:55], a[188:191], v[84:87], v[52:55]
v_mfma_f32_16x16x32_bf16 v[56:59], v[124:127], v[80:83], v[56:59]
v_mfma_f32_16x16x32_bf16 v[60:63], v[124:127], v[84:87], v[60:63]
v_mfma_f32_16x16x32_bf16 v[64:67], v[80:83], v[204:207], v[64:67]
v_mfma_f32_16x16x32_bf16 v[68:71], v[84:87], v[204:207], v[68:71]
ds_read_b128 v[80:83], v7 offset:10240
ds_read_b128 v[84:87], v7 offset:30720
s_waitcnt lgkmcnt(4)
v_mfma_f32_16x16x32_bf16 v[32:35], a[32:35], v[88:91], v[32:35]
v_mfma_f32_16x16x32_bf16 v[36:39], a[32:35], v[92:95], v[36:39]
v_mfma_f32_16x16x32_bf16 v[40:43], a[112:115], v[88:91], v[40:43]
v_mfma_f32_16x16x32_bf16 v[44:47], a[112:115], v[92:95], v[44:47]
v_mfma_f32_16x16x32_bf16 v[48:51], a[192:195], v[88:91], v[48:51]
v_mfma_f32_16x16x32_bf16 v[52:55], a[192:195], v[92:95], v[52:55]
v_mfma_f32_16x16x32_bf16 v[56:59], v[128:131], v[88:91], v[56:59]
v_mfma_f32_16x16x32_bf16 v[60:63], v[128:131], v[92:95], v[60:63]
v_mfma_f32_16x16x32_bf16 v[64:67], v[88:91], v[208:211], v[64:67]
v_mfma_f32_16x16x32_bf16 v[68:71], v[92:95], v[208:211], v[68:71]
ds_read_b128 v[88:91], v7 offset:11264
ds_read_b128 v[92:95], v7 offset:31744
s_waitcnt lgkmcnt(4)
v_mfma_f32_16x16x32_bf16 v[32:35], a[36:39], v[72:75], v[32:35]
v_mfma_f32_16x16x32_bf16 v[36:39], a[36:39], v[76:79], v[36:39]
v_mfma_f32_16x16x32_bf16 v[40:43], a[116:119], v[72:75], v[40:43]
v_mfma_f32_16x16x32_bf16 v[44:47], a[116:119], v[76:79], v[44:47]
v_mfma_f32_16x16x32_bf16 v[48:51], a[196:199], v[72:75], v[48:51]
v_mfma_f32_16x16x32_bf16 v[52:55], a[196:199], v[76:79], v[52:55]
v_mfma_f32_16x16x32_bf16 v[56:59], v[132:135], v[72:75], v[56:59]
v_mfma_f32_16x16x32_bf16 v[60:63], v[132:135], v[76:79], v[60:63]
v_mfma_f32_16x16x32_bf16 v[64:67], v[72:75], v[212:215], v[64:67]
v_mfma_f32_16x16x32_bf16 v[68:71], v[76:79], v[212:215], v[68:71]
ds_read_b128 v[72:75], v7 offset:12288
ds_read_b128 v[76:79], v7 offset:32768
s_waitcnt lgkmcnt(4)
v_mfma_f32_16x16x32_bf16 v[32:35], a[40:43], v[80:83], v[32:35]
v_mfma_f32_16x16x32_bf16 v[36:39], a[40:43], v[84:87], v[36:39]
v_mfma_f32_16x16x32_bf16 v[40:43], a[120:123], v[80:83], v[40:43]
v_mfma_f32_16x16x32_bf16 v[44:47], a[120:123], v[84:87], v[44:47]
v_mfma_f32_16x16x32_bf16 v[48:51], a[200:203], v[80:83], v[48:51]
v_mfma_f32_16x16x32_bf16 v[52:55], a[200:203], v[84:87], v[52:55]
v_mfma_f32_16x16x32_bf16 v[56:59], v[136:139], v[80:83], v[56:59]
v_mfma_f32_16x16x32_bf16 v[60:63], v[136:139], v[84:87], v[60:63]
v_mfma_f32_16x16x32_bf16 v[64:67], v[80:83], v[216:219], v[64:67]
v_mfma_f32_16x16x32_bf16 v[68:71], v[84:87], v[216:219], v[68:71]
ds_read_b128 v[80:83], v7 offset:13312
ds_read_b128 v[84:87], v7 offset:33792
s_waitcnt lgkmcnt(4)
v_mfma_f32_16x16x32_bf16 v[32:35], a[44:47], v[88:91], v[32:35]
v_mfma_f32_16x16x32_bf16 v[36:39], a[44:47], v[92:95], v[36:39]
v_mfma_f32_16x16x32_bf16 v[40:43], a[124:127], v[88:91], v[40:43]
v_mfma_f32_16x16x32_bf16 v[44:47], a[124:127], v[92:95], v[44:47]
v_mfma_f32_16x16x32_bf16 v[48:51], a[204:207], v[88:91], v[48:51]
v_mfma_f32_16x16x32_bf16 v[52:55], a[204:207], v[92:95], v[52:55]
v_mfma_f32_16x16x32_bf16 v[56:59], v[140:143], v[88:91], v[56:59]
v_mfma_f32_16x16x32_bf16 v[60:63], v[140:143], v[92:95], v[60:63]
v_mfma_f32_16x16x32_bf16 v[64:67], v[88:91], v[220:223], v[64:67]
v_mfma_f32_16x16x32_bf16 v[68:71], v[92:95], v[220:223], v[68:71]
ds_read_b128 v[88:91], v7 offset:14336
ds_read_b128 v[92:95], v7 offset:34816
s_waitcnt lgkmcnt(4)
v_mfma_f32_16x16x32_bf16 v[32:35], a[48:51], v[72:75], v[32:35]
v_mfma_f32_16x16x32_bf16 v[36:39], a[48:51], v[76:79], v[36:39]
v_mfma_f32_16x16x32_bf16 v[40:43], a[128:131], v[72:75], v[40:43]
v_mfma_f32_16x16x32_bf16 v[44:47], a[128:131], v[76:79], v[44:47]
v_mfma_f32_16x16x32_bf16 v[48:51], a[208:211], v[72:75], v[48:51]
v_mfma_f32_16x16x32_bf16 v[52:55], a[208:211], v[76:79], v[52:55]
v_mfma_f32_16x16x32_bf16 v[56:59], v[144:147], v[72:75], v[56:59]
v_mfma_f32_16x16x32_bf16 v[60:63], v[144:147], v[76:79], v[60:63]
v_mfma_f32_16x16x32_bf16 v[64:67], v[72:75], v[224:227], v[64:67]
v_mfma_f32_16x16x32_bf16 v[68:71], v[76:79], v[224:227], v[68:71]
ds_read_b128 v[72:75], v7 offset:15360
ds_read_b128 v[76:79], v7 offset:35840
s_waitcnt lgkmcnt(4)
v_mfma_f32_16x16x32_bf16 v[32:35], a[52:55], v[80:83], v[32:35]
v_mfma_f32_16x16x32_bf16 v[36:39], a[52:55], v[84:87], v[36:39]
v_mfma_f32_16x16x32_bf16 v[40:43], a[132:135], v[80:83], v[40:43]
v_mfma_f32_16x16x32_bf16 v[44:47], a[132:135], v[84:87], v[44:47]
v_mfma_f32_16x16x32_bf16 v[48:51], a[212:215], v[80:83], v[48:51]
v_mfma_f32_16x16x32_bf16 v[52:55], a[212:215], v[84:87], v[52:55]
v_mfma_f32_16x16x32_bf16 v[56:59], v[148:151], v[80:83], v[56:59]
v_mfma_f32_16x16x32_bf16 v[60:63], v[148:151], v[84:87], v[60:63]
v_mfma_f32_16x16x32_bf16 v[64:67], v[80:83], v[228:231], v[64:67]
v_mfma_f32_16x16x32_bf16 v[68:71], v[84:87], v[228:231], v[68:71]
ds_read_b128 v[80:83], v7 offset:16384
ds_read_b128 v[84:87], v7 offset:36864
s_waitcnt lgkmcnt(4)
v_mfma_f32_16x16x32_bf16 v[32:35], a[56:59], v[88:91], v[32:35]
v_mfma_f32_16x16x32_bf16 v[36:39], a[56:59], v[92:95], v[36:39]
v_mfma_f32_16x16x32_bf16 v[40:43], a[136:139], v[88:91], v[40:43]
v_mfma_f32_16x16x32_bf16 v[44:47], a[136:139], v[92:95], v[44:47]
v_mfma_f32_16x16x32_bf16 v[48:51], a[216:219], v[88:91], v[48:51]
v_mfma_f32_16x16x32_bf16 v[52:55], a[216:219], v[92:95], v[52:55]
v_mfma_f32_16x16x32_bf16 v[56:59], v[152:155], v[88:91], v[56:59]
v_mfma_f32_16x16x32_bf16 v[60:63], v[152:155], v[92:95], v[60:63]
v_mfma_f32_16x16x32_bf16 v[64:67], v[88:91], v[232:235], v[64:67]
v_mfma_f32_16x16x32_bf16 v[68:71], v[92:95], v[232:235], v[68:71]
ds_read_b128 v[88:91], v7 offset:17408
ds_read_b128 v[92:95], v7 offset:37888
s_waitcnt lgkmcnt(4)
v_mfma_f32_16x16x32_bf16 v[32:35], a[60:63], v[72:75], v[32:35]
v_mfma_f32_16x16x32_bf16 v[36:39], a[60:63], v[76:79], v[36:39]
v_mfma_f32_16x16x32_bf16 v[40:43], a[140:143], v[72:75], v[40:43]
v_mfma_f32_16x16x32_bf16 v[44:47], a[140:143], v[76:79], v[44:47]
v_mfma_f32_16x16x32_bf16 v[48:51], a[220:223], v[72:75], v[48:51]
v_mfma_f32_16x16x32_bf16 v[52:55], a[220:223], v[76:79], v[52:55]
v_mfma_f32_16x16x32_bf16 v[56:59], v[156:159], v[72:75], v[56:59]
v_mfma_f32_16x16x32_bf16 v[60:63], v[156:159], v[76:79], v[60:63]
v_mfma_f32_16x16x32_bf16 v[64:67], v[72:75], v[236:239], v[64:67]
v_mfma_f32_16x16x32_bf16 v[68:71], v[76:79], v[236:239], v[68:71]
ds_read_b128 v[72:75], v7 offset:18432
ds_read_b128 v[76:79], v7 offset:38912
s_waitcnt lgkmcnt(4)
v_mfma_f32_16x16x32_bf16 v[32:35], a[64:67], v[80:83], v[32:35]
v_mfma_f32_16x16x32_bf16 v[36:39], a[64:67], v[84:87], v[36:39]
v_mfma_f32_16x16x32_bf16 v[40:43], a[144:147], v[80:83], v[40:43]
v_mfma_f32_16x16x32_bf16 v[44:47], a[144:147], v[84:87], v[44:47]
v_mfma_f32_16x16x32_bf16 v[48:51], a[224:227], v[80:83], v[48:51]
v_mfma_f32_16x16x32_bf16 v[52:55], a[224:227], v[84:87], v[52:55]
v_mfma_f32_16x16x32_bf16 v[56:59], v[160:163], v[80:83], v[56:59]
v_mfma_f32_16x16x32_bf16 v[60:63], v[160:163], v[84:87], v[60:63]
v_mfma_f32_16x16x32_bf16 v[64:67], v[80:83], v[240:243], v[64:67]
v_mfma_f32_16x16x32_bf16 v[68:71], v[84:87], v[240:243], v[68:71]
ds_read_b128 v[80:83], v7 offset:19456
ds_read_b128 v[84:87], v7 offset:39936
s_waitcnt lgkmcnt(4)
v_mfma_f32_16x16x32_bf16 v[32:35], a[68:71], v[88:91], v[32:35]
v_mfma_f32_16x16x32_bf16 v[36:39], a[68:71], v[92:95], v[36:39]
v_mfma_f32_16x16x32_bf16 v[40:43], a[148:151], v[88:91], v[40:43]
v_mfma_f32_16x16x32_bf16 v[44:47], a[148:151], v[92:95], v[44:47]
v_mfma_f32_16x16x32_bf16 v[48:51], a[228:231], v[88:91], v[48:51]
v_mfma_f32_16x16x32_bf16 v[52:55], a[228:231], v[92:95], v[52:55]
v_mfma_f32_16x16x32_bf16 v[56:59], v[164:167], v[88:91], v[56:59]
v_mfma_f32_16x16x32_bf16 v[60:63], v[164:167], v[92:95], v[60:63]
v_mfma_f32_16x16x32_bf16 v[64:67], v[88:91], v[244:247], v[64:67]
v_mfma_f32_16x16x32_bf16 v[68:71], v[92:95], v[244:247], v[68:71]
s_waitcnt lgkmcnt(2)
v_mfma_f32_16x16x32_bf16 v[32:35], a[72:75], v[72:75], v[32:35]
v_mfma_f32_16x16x32_bf16 v[36:39], a[72:75], v[76:79], v[36:39]
v_mfma_f32_16x16x32_bf16 v[40:43], a[152:155], v[72:75], v[40:43]
v_mfma_f32_16x16x32_bf16 v[44:47], a[152:155], v[76:79], v[44:47]
v_mfma_f32_16x16x32_bf16 v[48:51], a[232:235], v[72:75], v[48:51]
v_mfma_f32_16x16x32_bf16 v[52:55], a[232:235], v[76:79], v[52:55]
v_mfma_f32_16x16x32_bf16 v[56:59], v[168:171], v[72:75], v[56:59]
v_mfma_f32_16x16x32_bf16 v[60:63], v[168:171], v[76:79], v[60:63]
v_mfma_f32_16x16x32_bf16 v[64:67], v[72:75], v[248:251], v[64:67]
v_mfma_f32_16x16x32_bf16 v[68:71], v[76:79], v[248:251], v[68:71]
s_waitcnt lgkmcnt(0)
v_mfma_f32_16x16x32_bf16 v[32:35], a[76:79], v[80:83], v[32:35]
v_mfma_f32_16x16x32_bf16 v[36:39], a[76:79], v[84:87], v[36:39]
v_mfma_f32_16x16x32_bf16 v[40:43], a[156:159], v[80:83], v[40:43]
v_mfma_f32_16x16x32_bf16 v[44:47], a[156:159], v[84:87], v[44:47]
v_mfma_f32_16x16x32_bf16 v[48:51], a[236:239], v[80:83], v[48:51]
v_mfma_f32_16x16x32_bf16 v[52:55], a[236:239], v[84:87], v[52:55]
v_mfma_f32_16x16x32_bf16 v[56:59], v[172:175], v[80:83], v[56:59]
v_mfma_f32_16x16x32_bf16 v[60:63], v[172:175], v[84:87], v[60:63]
v_mfma_f32_16x16x32_bf16 v[64:67], v[80:83], v[252:255], v[64:67]
v_mfma_f32_16x16x32_bf16 v[68:71], v[84:87], v[252:255], v[68:71]
v_cvt_pk_bf16_f32 v8, v32, v33
v_cvt_pk_bf16_f32 v9, v34, v35
v_cvt_pk_bf16_f32 v10, v40, v41
v_cvt_pk_bf16_f32 v11, v42, v43
s_add_u32 s34, s21, 0
buffer_store_dwordx4 v[8:11], v1, s[4:7], s34 offen
v_cvt_pk_bf16_f32 v12, v36, v37
v_cvt_pk_bf16_f32 v13, v38, v39
v_cvt_pk_bf16_f32 v14, v44, v45
v_cvt_pk_bf16_f32 v15, v46, v47
s_add_u32 s34, s21, 6144
buffer_store_dwordx4 v[12:15], v1, s[4:7], s34 offen
v_cvt_pk_bf16_f32 v8, v48, v49
v_cvt_pk_bf16_f32 v9, v50, v51
v_cvt_pk_bf16_f32 v10, v56, v57
v_cvt_pk_bf16_f32 v11, v58, v59
s_add_u32 s34, s21, 1024
buffer_store_dwordx4 v[8:11], v1, s[4:7], s34 offen
v_cvt_pk_bf16_f32 v12, v52, v53
v_cvt_pk_bf16_f32 v13, v54, v55
v_cvt_pk_bf16_f32 v14, v60, v61
v_cvt_pk_bf16_f32 v15, v62, v63
s_add_u32 s34, s21, 7168
buffer_store_dwordx4 v[12:15], v1, s[4:7], s34 offen
v_cvt_pk_bf16_f32 v8, v64, v65
v_cvt_pk_bf16_f32 v9, v66, v67
v_cvt_pk_bf16_f32 v10, v68, v69
v_cvt_pk_bf16_f32 v11, v70, v71
s_add_u32 s34, s23, 0
buffer_store_dwordx4 v[8:11], v1, s[4:7], s34 offen
s_waitcnt vmcnt(0)
s_barrier
s_add_u32 s17, s17, 1
v_mov_b32 v28, s17
buffer_store_dword v28, v4, s[4:7], s24 offen
s_cmp_lt_u32 s17, 64
s_cbranch_scc1 reca_ptop233
s_branch reca_exit1
reca_pslow232:
reca_ptop238:
s_cmp_lt_u32 s17, 3
s_cbranch_scc1 reca_pgo239
s_sub_u32 s36, s17, 3
reca_ppoll240:
buffer_load_dword v28, v4, s[4:7], s25 offen sc1
s_waitcnt vmcnt(0)
v_readfirstlane_b32 s34, v28
s_nop 3
s_cmp_ge_i32 s34, s36
s_cbranch_scc1 reca_pgo239
s_sleep 8
s_sub_u32 s18, s18, 1
s_cbranch_scc0 reca_ppoll240
s_mov_b32 s18, 0
reca_pgo239:
s_waitcnt vmcnt(0)
s_barrier
v_add_u32 v7, s26, v1
s_xor_b32 s26, s26, 40960
s_add_u32 s37, s17, 1
s_cmp_ge_u32 s37, 64
s_cbranch_scc1 reca_pnodma241
s_mul_i32 s20, s37, 40960
s_add_u32 s20, s20, 84934656
s_add_u32 m0, s26, 0
s_nop 0
buffer_load_dwordx4 v1, s[4:7], s20 offen offset:0 lds
buffer_load_dwordx4 v1, s[4:7], s20 offen offset:1024 lds
buffer_load_dwordx4 v1, s[4:7], s20 offen offset:2048 lds
buffer_load_dwordx4 v1, s[4:7], s20 offen offset:3072 lds
s_add_u32 s20, s20, 4096
s_add_u32 m0, s26, 4096
s_nop 0
buffer_load_dwordx4 v1, s[4:7], s20 offen offset:0 lds
buffer_load_dwordx4 v1, s[4:7], s20 offen offset:1024 lds
buffer_load_dwordx4 v1, s[4:7], s20 offen offset:2048 lds
buffer_load_dwordx4 v1, s[4:7], s20 offen offset:3072 lds
s_add_u32 s20, s20, 4096
s_add_u32 m0, s26, 8192
s_nop 0
buffer_load_dwordx4 v1, s[4:7], s20 offen offset:0 lds
buffer_load_dwordx4 v1, s[4:7], s20 offen offset:1024 lds
reca_pnodma241:
s_lshl_b32 s34, s15, 3
s_and_b32 s35, s17, 7
s_add_u32 s34, s34, s35
s_mul_i32 s34, s34, 12288
s_mul_i32 s35, s16, 3072
s_add_u32 s35, s35, s34
s_add_u32 s21, s35, 37748736
s_add_u32 s22, s35, 44040192
s_mul_i32 s35, s16, 6144
s_add_u32 s35, s35, s34
s_add_u32 s23, s35, 40894464
ds_read_b128 v[72:75], v7 offset:0
ds_read_b128 v[76:79], v7 offset:20480
ds_read_b128 v[80:83], v7 offset:1024
ds_read_b128 v[84:87], v7 offset:21504
ds_read_b128 v[88:91], v7 offset:2048
ds_read_b128 v[92:95], v7 offset:22528
s_waitcnt lgkmcnt(4)
v_mfma_f32_16x16x32_bf16 v[32:35], a[0:3], v[72:75], 0
v_mfma_f32_16x16x32_bf16 v[36:39], a[0:3], v[76:79], 0
v_mfma_f32_16x16x32_bf16 v[40:43], a[80:83], v[72:75], 0
v_mfma_f32_16x16x32_bf16 v[44:47], a[80:83], v[76:79], 0
v_mfma_f32_16x16x32_bf16 v[48:51], a[160:163], v[72:75], 0
v_mfma_f32_16x16x32_bf16 v[52:55], a[160:163], v[76:79], 0
v_mfma_f32_16x16x32_bf16 v[56:59], v[96:99], v[72:75], 0
v_mfma_f32_16x16x32_bf16 v[60:63], v[96:99], v[76:79], 0
v_mfma_f32_16x16x32_bf16 v[64:67], v[72:75], v[176:179], 0
v_mfma_f32_16x16x32_bf16 v[68:71], v[76:79], v[176:179], 0
ds_read_b128 v[72:75], v7 offset:3072
ds_read_b128 v[76:79], v7 offset:23552
s_waitcnt lgkmcnt(4)
v_mfma_f32_16x16x32_bf16 v[32:35], a[4:7], v[80:83], v[32:35]
v_mfma_f32_16x16x32_bf16 v[36:39], a[4:7], v[84:87], v[36:39]
v_mfma_f32_16x16x32_bf16 v[40:43], a[84:87], v[80:83], v[40:43]
v_mfma_f32_16x16x32_bf16 v[44:47], a[84:87], v[84:87], v[44:47]
v_mfma_f32_16x16x32_bf16 v[48:51], a[164:167], v[80:83], v[48:51]
v_mfma_f32_16x16x32_bf16 v[52:55], a[164:167], v[84:87], v[52:55]
v_mfma_f32_16x16x32_bf16 v[56:59], v[100:103], v[80:83], v[56:59]
v_mfma_f32_16x16x32_bf16 v[60:63], v[100:103], v[84:87], v[60:63]
v_mfma_f32_16x16x32_bf16 v[64:67], v[80:83], v[180:183], v[64:67]
v_mfma_f32_16x16x32_bf16 v[68:71], v[84:87], v[180:183], v[68:71]
ds_read_b128 v[80:83], v7 offset:4096
ds_read_b128 v[84:87], v7 offset:24576
s_waitcnt lgkmcnt(4)
v_mfma_f32_16x16x32_bf16 v[32:35], a[8:11], v[88:91], v[32:35]
v_mfma_f32_16x16x32_bf16 v[36:39], a[8:11], v[92:95], v[36:39]
v_mfma_f32_16x16x32_bf16 v[40:43], a[88:91], v[88:91], v[40:43]
v_mfma_f32_16x16x32_bf16 v[44:47], a[88:91], v[92:95], v[44:47]
v_mfma_f32_16x16x32_bf16 v[48:51], a[168:171], v[88:91], v[48:51]
v_mfma_f32_16x16x32_bf16 v[52:55], a[168:171], v[92:95], v[52:55]
v_mfma_f32_16x16x32_bf16 v[56:59], v[104:107], v[88:91], v[56:59]
v_mfma_f32_16x16x32_bf16 v[60:63], v[104:107], v[92:95], v[60:63]
v_mfma_f32_16x16x32_bf16 v[64:67], v[88:91], v[184:187], v[64:67]
v_mfma_f32_16x16x32_bf16 v[68:71], v[92:95], v[184:187], v[68:71]
ds_read_b128 v[88:91], v7 offset:5120
ds_read_b128 v[92:95], v7 offset:25600
s_waitcnt lgkmcnt(4)
v_mfma_f32_16x16x32_bf16 v[32:35], a[12:15], v[72:75], v[32:35]
v_mfma_f32_16x16x32_bf16 v[36:39], a[12:15], v[76:79], v[36:39]
v_mfma_f32_16x16x32_bf16 v[40:43], a[92:95], v[72:75], v[40:43]
v_mfma_f32_16x16x32_bf16 v[44:47], a[92:95], v[76:79], v[44:47]
v_mfma_f32_16x16x32_bf16 v[48:51], a[172:175], v[72:75], v[48:51]
v_mfma_f32_16x16x32_bf16 v[52:55], a[172:175], v[76:79], v[52:55]
v_mfma_f32_16x16x32_bf16 v[56:59], v[108:111], v[72:75], v[56:59]
v_mfma_f32_16x16x32_bf16 v[60:63], v[108:111], v[76:79], v[60:63]
v_mfma_f32_16x16x32_bf16 v[64:67], v[72:75], v[188:191], v[64:67]
v_mfma_f32_16x16x32_bf16 v[68:71], v[76:79], v[188:191], v[68:71]
ds_read_b128 v[72:75], v7 offset:6144
ds_read_b128 v[76:79], v7 offset:26624
s_waitcnt lgkmcnt(4)
v_mfma_f32_16x16x32_bf16 v[32:35], a[16:19], v[80:83], v[32:35]
v_mfma_f32_16x16x32_bf16 v[36:39], a[16:19], v[84:87], v[36:39]
v_mfma_f32_16x16x32_bf16 v[40:43], a[96:99], v[80:83], v[40:43]
v_mfma_f32_16x16x32_bf16 v[44:47], a[96:99], v[84:87], v[44:47]
v_mfma_f32_16x16x32_bf16 v[48:51], a[176:179], v[80:83], v[48:51]
v_mfma_f32_16x16x32_bf16 v[52:55], a[176:179], v[84:87], v[52:55]
v_mfma_f32_16x16x32_bf16 v[56:59], v[112:115], v[80:83], v[56:59]
v_mfma_f32_16x16x32_bf16 v[60:63], v[112:115], v[84:87], v[60:63]
v_mfma_f32_16x16x32_bf16 v[64:67], v[80:83], v[192:195], v[64:67]
v_mfma_f32_16x16x32_bf16 v[68:71], v[84:87], v[192:195], v[68:71]
ds_read_b128 v[80:83], v7 offset:7168
ds_read_b128 v[84:87], v7 offset:27648
s_waitcnt lgkmcnt(4)
v_mfma_f32_16x16x32_bf16 v[32:35], a[20:23], v[88:91], v[32:35]
v_mfma_f32_16x16x32_bf16 v[36:39], a[20:23], v[92:95], v[36:39]
v_mfma_f32_16x16x32_bf16 v[40:43], a[100:103], v[88:91], v[40:43]
v_mfma_f32_16x16x32_bf16 v[44:47], a[100:103], v[92:95], v[44:47]
v_mfma_f32_16x16x32_bf16 v[48:51], a[180:183], v[88:91], v[48:51]
v_mfma_f32_16x16x32_bf16 v[52:55], a[180:183], v[92:95], v[52:55]
v_mfma_f32_16x16x32_bf16 v[56:59], v[116:119], v[88:91], v[56:59]
v_mfma_f32_16x16x32_bf16 v[60:63], v[116:119], v[92:95], v[60:63]
v_mfma_f32_16x16x32_bf16 v[64:67], v[88:91], v[196:199], v[64:67]
v_mfma_f32_16x16x32_bf16 v[68:71], v[92:95], v[196:199], v[68:71]
ds_read_b128 v[88:91], v7 offset:8192
ds_read_b128 v[92:95], v7 offset:28672
s_waitcnt lgkmcnt(4)
v_mfma_f32_16x16x32_bf16 v[32:35], a[24:27], v[72:75], v[32:35]
v_mfma_f32_16x16x32_bf16 v[36:39], a[24:27], v[76:79], v[36:39]
v_mfma_f32_16x16x32_bf16 v[40:43], a[104:107], v[72:75], v[40:43]
v_mfma_f32_16x16x32_bf16 v[44:47], a[104:107], v[76:79], v[44:47]
v_mfma_f32_16x16x32_bf16 v[48:51], a[184:187], v[72:75], v[48:51]
v_mfma_f32_16x16x32_bf16 v[52:55], a[184:187], v[76:79], v[52:55]
v_mfma_f32_16x16x32_bf16 v[56:59], v[120:123], v[72:75], v[56:59]
v_mfma_f32_16x16x32_bf16 v[60:63], v[120:123], v[76:79], v[60:63]
v_mfma_f32_16x16x32_bf16 v[64:67], v[72:75], v[200:203], v[64:67]
v_mfma_f32_16x16x32_bf16 v[68:71], v[76:79], v[200:203], v[68:71]
ds_read_b128 v[72:75], v7 offset:9216
ds_read_b128 v[76:79], v7 offset:29696
s_waitcnt lgkmcnt(4)
v_mfma_f32_16x16x32_bf16 v[32:35], a[28:31], v[80:83], v[32:35]
v_mfma_f32_16x16x32_bf16 v[36:39], a[28:31], v[84:87], v[36:39]
v_mfma_f32_16x16x32_bf16 v[40:43], a[108:111], v[80:83], v[40:43]
v_mfma_f32_16x16x32_bf16 v[44:47], a[108:111], v[84:87], v[44:47]
v_mfma_f32_16x16x32_bf16 v[48:51], a[188:191], v[80:83], v[48:51]
v_mfma_f32_16x16x32_bf16 v[52:55], a[188:191], v[84:87], v[52:55]
v_mfma_f32_16x16x32_bf16 v[56:59], v[124:127], v[80:83], v[56:59]
v_mfma_f32_16x16x32_bf16 v[60:63], v[124:127], v[84:87], v[60:63]
v_mfma_f32_16x16x32_bf16 v[64:67], v[80:83], v[204:207], v[64:67]
v_mfma_f32_16x16x32_bf16 v[68:71], v[84:87], v[204:207], v[68:71]
ds_read_b128 v[80:83], v7 offset:10240
ds_read_b128 v[84:87], v7 offset:30720
s_waitcnt lgkmcnt(4)
v_mfma_f32_16x16x32_bf16 v[32:35], a[32:35], v[88:91], v[32:35]
v_mfma_f32_16x16x32_bf16 v[36:39], a[32:35], v[92:95], v[36:39]
v_mfma_f32_16x16x32_bf16 v[40:43], a[112:115], v[88:91], v[40:43]
v_mfma_f32_16x16x32_bf16 v[44:47], a[112:115], v[92:95], v[44:47]
v_mfma_f32_16x16x32_bf16 v[48:51], a[192:195], v[88:91], v[48:51]
v_mfma_f32_16x16x32_bf16 v[52:55], a[192:195], v[92:95], v[52:55]
v_mfma_f32_16x16x32_bf16 v[56:59], v[128:131], v[88:91], v[56:59]
v_mfma_f32_16x16x32_bf16 v[60:63], v[128:131], v[92:95], v[60:63]
v_mfma_f32_16x16x32_bf16 v[64:67], v[88:91], v[208:211], v[64:67]
v_mfma_f32_16x16x32_bf16 v[68:71], v[92:95], v[208:211], v[68:71]
ds_read_b128 v[88:91], v7 offset:11264
ds_read_b128 v[92:95], v7 offset:31744
s_waitcnt lgkmcnt(4)
v_mfma_f32_16x16x32_bf16 v[32:35], a[36:39], v[72:75], v[32:35]
v_mfma_f32_16x16x32_bf16 v[36:39], a[36:39], v[76:79], v[36:39]
v_mfma_f32_16x16x32_bf16 v[40:43], a[116:119], v[72:75], v[40:43]
v_mfma_f32_16x16x32_bf16 v[44:47], a[116:119], v[76:79], v[44:47]
v_mfma_f32_16x16x32_bf16 v[48:51], a[196:199], v[72:75], v[48:51]
v_mfma_f32_16x16x32_bf16 v[52:55], a[196:199], v[76:79], v[52:55]
v_mfma_f32_16x16x32_bf16 v[56:59], v[132:135], v[72:75], v[56:59]
v_mfma_f32_16x16x32_bf16 v[60:63], v[132:135], v[76:79], v[60:63]
v_mfma_f32_16x16x32_bf16 v[64:67], v[72:75], v[212:215], v[64:67]
v_mfma_f32_16x16x32_bf16 v[68:71], v[76:79], v[212:215], v[68:71]
ds_read_b128 v[72:75], v7 offset:12288
ds_read_b128 v[76:79], v7 offset:32768
s_waitcnt lgkmcnt(4)
v_mfma_f32_16x16x32_bf16 v[32:35], a[40:43], v[80:83], v[32:35]
v_mfma_f32_16x16x32_bf16 v[36:39], a[40:43], v[84:87], v[36:39]
v_mfma_f32_16x16x32_bf16 v[40:43], a[120:123], v[80:83], v[40:43]
v_mfma_f32_16x16x32_bf16 v[44:47], a[120:123], v[84:87], v[44:47]
v_mfma_f32_16x16x32_bf16 v[48:51], a[200:203], v[80:83], v[48:51]
v_mfma_f32_16x16x32_bf16 v[52:55], a[200:203], v[84:87], v[52:55]
v_mfma_f32_16x16x32_bf16 v[56:59], v[136:139], v[80:83], v[56:59]
v_mfma_f32_16x16x32_bf16 v[60:63], v[136:139], v[84:87], v[60:63]
v_mfma_f32_16x16x32_bf16 v[64:67], v[80:83], v[216:219], v[64:67]
v_mfma_f32_16x16x32_bf16 v[68:71], v[84:87], v[216:219], v[68:71]
ds_read_b128 v[80:83], v7 offset:13312
ds_read_b128 v[84:87], v7 offset:33792
s_waitcnt lgkmcnt(4)
v_mfma_f32_16x16x32_bf16 v[32:35], a[44:47], v[88:91], v[32:35]
v_mfma_f32_16x16x32_bf16 v[36:39], a[44:47], v[92:95], v[36:39]
v_mfma_f32_16x16x32_bf16 v[40:43], a[124:127], v[88:91], v[40:43]
v_mfma_f32_16x16x32_bf16 v[44:47], a[124:127], v[92:95], v[44:47]
v_mfma_f32_16x16x32_bf16 v[48:51], a[204:207], v[88:91], v[48:51]
v_mfma_f32_16x16x32_bf16 v[52:55], a[204:207], v[92:95], v[52:55]
v_mfma_f32_16x16x32_bf16 v[56:59], v[140:143], v[88:91], v[56:59]
v_mfma_f32_16x16x32_bf16 v[60:63], v[140:143], v[92:95], v[60:63]
v_mfma_f32_16x16x32_bf16 v[64:67], v[88:91], v[220:223], v[64:67]
v_mfma_f32_16x16x32_bf16 v[68:71], v[92:95], v[220:223], v[68:71]
ds_read_b128 v[88:91], v7 offset:14336
ds_read_b128 v[92:95], v7 offset:34816
s_waitcnt lgkmcnt(4)
v_mfma_f32_16x16x32_bf16 v[32:35], a[48:51], v[72:75], v[32:35]
v_mfma_f32_16x16x32_bf16 v[36:39], a[48:51], v[76:79], v[36:39]
v_mfma_f32_16x16x32_bf16 v[40:43], a[128:131], v[72:75], v[40:43]
v_mfma_f32_16x16x32_bf16 v[44:47], a[128:131], v[76:79], v[44:47]
v_mfma_f32_16x16x32_bf16 v[48:51], a[208:211], v[72:75], v[48:51]
v_mfma_f32_16x16x32_bf16 v[52:55], a[208:211], v[76:79], v[52:55]
v_mfma_f32_16x16x32_bf16 v[56:59], v[144:147], v[72:75], v[56:59]
v_mfma_f32_16x16x32_bf16 v[60:63], v[144:147], v[76:79], v[60:63]
v_mfma_f32_16x16x32_bf16 v[64:67], v[72:75], v[224:227], v[64:67]
v_mfma_f32_16x16x32_bf16 v[68:71], v[76:79], v[224:227], v[68:71]
ds_read_b128 v[72:75], v7 offset:15360
ds_read_b128 v[76:79], v7 offset:35840
s_waitcnt lgkmcnt(4)
v_mfma_f32_16x16x32_bf16 v[32:35], a[52:55], v[80:83], v[32:35]
v_mfma_f32_16x16x32_bf16 v[36:39], a[52:55], v[84:87], v[36:39]
v_mfma_f32_16x16x32_bf16 v[40:43], a[132:135], v[80:83], v[40:43]
v_mfma_f32_16x16x32_bf16 v[44:47], a[132:135], v[84:87], v[44:47]
v_mfma_f32_16x16x32_bf16 v[48:51], a[212:215], v[80:83], v[48:51]
v_mfma_f32_16x16x32_bf16 v[52:55], a[212:215], v[84:87], v[52:55]
v_mfma_f32_16x16x32_bf16 v[56:59], v[148:151], v[80:83], v[56:59]
v_mfma_f32_16x16x32_bf16 v[60:63], v[148:151], v[84:87], v[60:63]
v_mfma_f32_16x16x32_bf16 v[64:67], v[80:83], v[228:231], v[64:67]
v_mfma_f32_16x16x32_bf16 v[68:71], v[84:87], v[228:231], v[68:71]
ds_read_b128 v[80:83], v7 offset:16384
ds_read_b128 v[84:87], v7 offset:36864
s_waitcnt lgkmcnt(4)
v_mfma_f32_16x16x32_bf16 v[32:35], a[56:59], v[88:91], v[32:35]
v_mfma_f32_16x16x32_bf16 v[36:39], a[56:59], v[92:95], v[36:39]
v_mfma_f32_16x16x32_bf16 v[40:43], a[136:139], v[88:91], v[40:43]
v_mfma_f32_16x16x32_bf16 v[44:47], a[136:139], v[92:95], v[44:47]
v_mfma_f32_16x16x32_bf16 v[48:51], a[216:219], v[88:91], v[48:51]
v_mfma_f32_16x16x32_bf16 v[52:55], a[216:219], v[92:95], v[52:55]
v_mfma_f32_16x16x32_bf16 v[56:59], v[152:155], v[88:91], v[56:59]
v_mfma_f32_16x16x32_bf16 v[60:63], v[152:155], v[92:95], v[60:63]
v_mfma_f32_16x16x32_bf16 v[64:67], v[88:91], v[232:235], v[64:67]
v_mfma_f32_16x16x32_bf16 v[68:71], v[92:95], v[232:235], v[68:71]
ds_read_b128 v[88:91], v7 offset:17408
ds_read_b128 v[92:95], v7 offset:37888
s_waitcnt lgkmcnt(4)
v_mfma_f32_16x16x32_bf16 v[32:35], a[60:63], v[72:75], v[32:35]
v_mfma_f32_16x16x32_bf16 v[36:39], a[60:63], v[76:79], v[36:39]
v_mfma_f32_16x16x32_bf16 v[40:43], a[140:143], v[72:75], v[40:43]
v_mfma_f32_16x16x32_bf16 v[44:47], a[140:143], v[76:79], v[44:47]
v_mfma_f32_16x16x32_bf16 v[48:51], a[220:223], v[72:75], v[48:51]
v_mfma_f32_16x16x32_bf16 v[52:55], a[220:223], v[76:79], v[52:55]
v_mfma_f32_16x16x32_bf16 v[56:59], v[156:159], v[72:75], v[56:59]
v_mfma_f32_16x16x32_bf16 v[60:63], v[156:159], v[76:79], v[60:63]
v_mfma_f32_16x16x32_bf16 v[64:67], v[72:75], v[236:239], v[64:67]
v_mfma_f32_16x16x32_bf16 v[68:71], v[76:79], v[236:239], v[68:71]
ds_read_b128 v[72:75], v7 offset:18432
ds_read_b128 v[76:79], v7 offset:38912
s_waitcnt lgkmcnt(4)
v_mfma_f32_16x16x32_bf16 v[32:35], a[64:67], v[80:83], v[32:35]
v_mfma_f32_16x16x32_bf16 v[36:39], a[64:67], v[84:87], v[36:39]
v_mfma_f32_16x16x32_bf16 v[40:43], a[144:147], v[80:83], v[40:43]
v_mfma_f32_16x16x32_bf16 v[44:47], a[144:147], v[84:87], v[44:47]
v_mfma_f32_16x16x32_bf16 v[48:51], a[224:227], v[80:83], v[48:51]
v_mfma_f32_16x16x32_bf16 v[52:55], a[224:227], v[84:87], v[52:55]
v_mfma_f32_16x16x32_bf16 v[56:59], v[160:163], v[80:83], v[56:59]
v_mfma_f32_16x16x32_bf16 v[60:63], v[160:163], v[84:87], v[60:63]
v_mfma_f32_16x16x32_bf16 v[64:67], v[80:83], v[240:243], v[64:67]
v_mfma_f32_16x16x32_bf16 v[68:71], v[84:87], v[240:243], v[68:71]
ds_read_b128 v[80:83], v7 offset:19456
ds_read_b128 v[84:87], v7 offset:39936
s_waitcnt lgkmcnt(4)
v_mfma_f32_16x16x32_bf16 v[32:35], a[68:71], v[88:91], v[32:35]
v_mfma_f32_16x16x32_bf16 v[36:39], a[68:71], v[92:95], v[36:39]
v_mfma_f32_16x16x32_bf16 v[40:43], a[148:151], v[88:91], v[40:43]
v_mfma_f32_16x16x32_bf16 v[44:47], a[148:151], v[92:95], v[44:47]
v_mfma_f32_16x16x32_bf16 v[48:51], a[228:231], v[88:91], v[48:51]
v_mfma_f32_16x16x32_bf16 v[52:55], a[228:231], v[92:95], v[52:55]
v_mfma_f32_16x16x32_bf16 v[56:59], v[164:167], v[88:91], v[56:59]
v_mfma_f32_16x16x32_bf16 v[60:63], v[164:167], v[92:95], v[60:63]
v_mfma_f32_16x16x32_bf16 v[64:67], v[88:91], v[244:247], v[64:67]
v_mfma_f32_16x16x32_bf16 v[68:71], v[92:95], v[244:247], v[68:71]
s_waitcnt lgkmcnt(2)
v_mfma_f32_16x16x32_bf16 v[32:35], a[72:75], v[72:75], v[32:35]
v_mfma_f32_16x16x32_bf16 v[36:39], a[72:75], v[76:79], v[36:39]
v_mfma_f32_16x16x32_bf16 v[40:43], a[152:155], v[72:75], v[40:43]
v_mfma_f32_16x16x32_bf16 v[44:47], a[152:155], v[76:79], v[44:47]
v_mfma_f32_16x16x32_bf16 v[48:51], a[232:235], v[72:75], v[48:51]
v_mfma_f32_16x16x32_bf16 v[52:55], a[232:235], v[76:79], v[52:55]
v_mfma_f32_16x16x32_bf16 v[56:59], v[168:171], v[72:75], v[56:59]
v_mfma_f32_16x16x32_bf16 v[60:63], v[168:171], v[76:79], v[60:63]
v_mfma_f32_16x16x32_bf16 v[64:67], v[72:75], v[248:251], v[64:67]
v_mfma_f32_16x16x32_bf16 v[68:71], v[76:79], v[248:251], v[68:71]
s_waitcnt lgkmcnt(0)
v_mfma_f32_16x16x32_bf16 v[32:35], a[76:79], v[80:83], v[32:35]
v_mfma_f32_16x16x32_bf16 v[36:39], a[76:79], v[84:87], v[36:39]
v_mfma_f32_16x16x32_bf16 v[40:43], a[156:159], v[80:83], v[40:43]
v_mfma_f32_16x16x32_bf16 v[44:47], a[156:159], v[84:87], v[44:47]
v_mfma_f32_16x16x32_bf16 v[48:51], a[236:239], v[80:83], v[48:51]
v_mfma_f32_16x16x32_bf16 v[52:55], a[236:239], v[84:87], v[52:55]
v_mfma_f32_16x16x32_bf16 v[56:59], v[172:175], v[80:83], v[56:59]
v_mfma_f32_16x16x32_bf16 v[60:63], v[172:175], v[84:87], v[60:63]
v_mfma_f32_16x16x32_bf16 v[64:67], v[80:83], v[252:255], v[64:67]
v_mfma_f32_16x16x32_bf16 v[68:71], v[84:87], v[252:255], v[68:71]
v_cvt_pk_bf16_f32 v8, v32, v33
v_cvt_pk_bf16_f32 v9, v34, v35
v_cvt_pk_bf16_f32 v10, v40, v41
v_cvt_pk_bf16_f32 v11, v42, v43
s_add_u32 s34, s21, 0
buffer_store_dwordx4 v[8:11], v1, s[4:7], s34 offen sc1
v_cvt_pk_bf16_f32 v12, v36, v37
v_cvt_pk_bf16_f32 v13, v38, v39
v_cvt_pk_bf16_f32 v14, v44, v45
v_cvt_pk_bf16_f32 v15, v46, v47
s_add_u32 s34, s21, 6144
buffer_store_dwordx4 v[12:15], v1, s[4:7], s34 offen sc1
v_cvt_pk_bf16_f32 v8, v48, v49
v_cvt_pk_bf16_f32 v9, v50, v51
v_cvt_pk_bf16_f32 v10, v56, v57
v_cvt_pk_bf16_f32 v11, v58, v59
s_add_u32 s34, s21, 1024
buffer_store_dwordx4 v[8:11], v1, s[4:7], s34 offen sc1
v_cvt_pk_bf16_f32 v12, v52, v53
v_cvt_pk_bf16_f32 v13, v54, v55
v_cvt_pk_bf16_f32 v14, v60, v61
v_cvt_pk_bf16_f32 v15, v62, v63
s_add_u32 s34, s21, 7168
buffer_store_dwordx4 v[12:15], v1, s[4:7], s34 offen sc1
v_cvt_pk_bf16_f32 v8, v64, v65
v_cvt_pk_bf16_f32 v9, v66, v67
v_cvt_pk_bf16_f32 v10, v68, v69
v_cvt_pk_bf16_f32 v11, v70, v71
s_add_u32 s34, s23, 0
buffer_store_dwordx4 v[8:11], v1, s[4:7], s34 offen sc1
s_waitcnt vmcnt(0)
s_barrier
s_add_u32 s17, s17, 1
v_mov_b32 v28, s17
buffer_store_dword v28, v4, s[4:7], s24 offen sc1
s_cmp_lt_u32 s17, 64
s_cbranch_scc1 reca_ptop238
s_branch reca_exit1
reca_pw1_227:
s_mov_b32 s17, 0
s_mov_b32 s26, 0
s_mul_i32 s20, s17, 40960
s_add_u32 s20, s20, 84944896
s_add_u32 m0, s26, 10240
s_nop 0
buffer_load_dwordx4 v1, s[4:7], s20 offen offset:0 lds
buffer_load_dwordx4 v1, s[4:7], s20 offen offset:1024 lds
buffer_load_dwordx4 v1, s[4:7], s20 offen offset:2048 lds
buffer_load_dwordx4 v1, s[4:7], s20 offen offset:3072 lds
s_add_u32 s20, s20, 4096
s_add_u32 m0, s26, 14336
s_nop 0
buffer_load_dwordx4 v1, s[4:7], s20 offen offset:0 lds
buffer_load_dwordx4 v1, s[4:7], s20 offen offset:1024 lds
buffer_load_dwordx4 v1, s[4:7], s20 offen offset:2048 lds
buffer_load_dwordx4 v1, s[4:7], s20 offen offset:3072 lds
s_add_u32 s20, s20, 4096
s_add_u32 m0, s26, 18432
s_nop 0
buffer_load_dwordx4 v1, s[4:7], s20 offen offset:0 lds
buffer_load_dwordx4 v1, s[4:7], s20 offen offset:1024 lds
s_mul_i32 s34, s15, 12
s_mul_i32 s35, s16, 6
s_add_u32 s34, s34, s35
s_add_u32 s34, s34, 4
s_mul_i32 s34, s34, 20480
s_add_u32 s34, s34, 14155776
buffer_load_dwordx4 a[0:3], v1, s[4:7], s34 offen offset:0
buffer_load_dwordx4 a[4:7], v1, s[4:7], s34 offen offset:1024
buffer_load_dwordx4 a[8:11], v1, s[4:7], s34 offen offset:2048
buffer_load_dwordx4 a[12:15], v1, s[4:7], s34 offen offset:3072
s_add_u32 s34, s34, 4096
buffer_load_dwordx4 a[16:19], v1, s[4:7], s34 offen offset:0
buffer_load_dwordx4 a[20:23], v1, s[4:7], s34 offen offset:1024
buffer_load_dwordx4 a[24:27], v1, s[4:7], s34 offen offset:2048
buffer_load_dwordx4 a[28:31], v1, s[4:7], s34 offen offset:3072
s_add_u32 s34, s34, 4096
buffer_load_dwordx4 a[32:35], v1, s[4:7], s34 offen offset:0
buffer_load_dwordx4 a[36:39], v1, s[4:7], s34 offen offset:1024
buffer_load_dwordx4 a[40:43], v1, s[4:7], s34 offen offset:2048
buffer_load_dwordx4 a[44:47], v1, s[4:7], s34 offen offset:3072
s_add_u32 s34, s34, 4096
buffer_load_dwordx4 a[48:51], v1, s[4:7], s34 offen offset:0
buffer_load_dwordx4 a[52:55], v1, s[4:7], s34 offen offset:1024
buffer_load_dwordx4 a[56:59], v1, s[4:7], s34 offen offset:2048
buffer_load_dwordx4 a[60:63], v1, s[4:7], s34 offen offset:3072
s_add_u32 s34, s34, 4096
buffer_load_dwordx4 a[64:67], v1, s[4:7], s34 offen offset:0
buffer_load_dwordx4 a[68:71], v1, s[4:7], s34 offen offset:1024
buffer_load_dwordx4 a[72:75], v1, s[4:7], s34 offen offset:2048
buffer_load_dwordx4 a[76:79], v1, s[4:7], s34 offen offset:3072
s_mul_i32 s34, s15, 12
s_mul_i32 s35, s16, 6
s_add_u32 s34, s34, s35
s_add_u32 s34, s34, 5
s_mul_i32 s34, s34, 20480
s_add_u32 s34, s34, 14155776
buffer_load_dwordx4 a[80:83], v1, s[4:7], s34 offen offset:0
buffer_load_dwordx4 a[84:87], v1, s[4:7], s34 offen offset:1024
buffer_load_dwordx4 a[88:91], v1, s[4:7], s34 offen offset:2048
buffer_load_dwordx4 a[92:95], v1, s[4:7], s34 offen offset:3072
s_add_u32 s34, s34, 4096
buffer_load_dwordx4 a[96:99], v1, s[4:7], s34 offen offset:0
buffer_load_dwordx4 a[100:103], v1, s[4:7], s34 offen offset:1024
buffer_load_dwordx4 a[104:107], v1, s[4:7], s34 offen offset:2048
buffer_load_dwordx4 a[108:111], v1, s[4:7], s34 offen offset:3072
s_add_u32 s34, s34, 4096
buffer_load_dwordx4 a[112:115], v1, s[4:7], s34 offen offset:0
buffer_load_dwordx4 a[116:119], v1, s[4:7], s34 offen offset:1024
buffer_load_dwordx4 a[120:123], v1, s[4:7], s34 offen offset:2048
buffer_load_dwordx4 a[124:127], v1, s[4:7], s34 offen offset:3072
s_add_u32 s34, s34, 4096
buffer_load_dwordx4 a[128:131], v1, s[4:7], s34 offen offset:0
buffer_load_dwordx4 a[132:135], v1, s[4:7], s34 offen offset:1024
buffer_load_dwordx4 a[136:139], v1, s[4:7], s34 offen offset:2048
buffer_load_dwordx4 a[140:143], v1, s[4:7], s34 offen offset:3072
s_add_u32 s34, s34, 4096
buffer_load_dwordx4 a[144:147], v1, s[4:7], s34 offen offset:0
buffer_load_dwordx4 a[148:151], v1, s[4:7], s34 offen offset:1024
buffer_load_dwordx4 a[152:155], v1, s[4:7], s34 offen offset:2048
buffer_load_dwordx4 a[156:159], v1, s[4:7], s34 offen offset:3072
s_waitcnt vmcnt(20)
s_mul_i32 s34, s15, 12
s_mul_i32 s35, s16, 6
s_add_u32 s34, s34, s35
s_add_u32 s34, s34, 1
s_mul_i32 s34, s34, 20480
s_add_u32 s34, s34, 22020096
buffer_load_dwordx4 a[160:163], v1, s[4:7], s34 offen offset:0
buffer_load_dwordx4 a[164:167], v1, s[4:7], s34 offen offset:1024
buffer_load_dwordx4 a[168:171], v1, s[4:7], s34 offen offset:2048
buffer_load_dwordx4 a[172:175], v1, s[4:7], s34 offen offset:3072
s_add_u32 s34, s34, 4096
buffer_load_dwordx4 a[176:179], v1, s[4:7], s34 offen offset:0
buffer_load_dwordx4 a[180:183], v1, s[4:7], s34 offen offset:1024
buffer_load_dwordx4 a[184:187], v1, s[4:7], s34 offen offset:2048
buffer_load_dwordx4 a[188:191], v1, s[4:7], s34 offen offset:3072
s_add_u32 s34, s34, 4096
buffer_load_dwordx4 a[192:195], v1, s[4:7], s34 offen offset:0
buffer_load_dwordx4 a[196:199], v1, s[4:7], s34 offen offset:1024
buffer_load_dwordx4 a[200:203], v1, s[4:7], s34 offen offset:2048
buffer_load_dwordx4 a[204:207], v1, s[4:7], s34 offen offset:3072
s_add_u32 s34, s34, 4096
buffer_load_dwordx4 a[208:211], v1, s[4:7], s34 offen offset:0
buffer_load_dwordx4 a[212:215], v1, s[4:7], s34 offen offset:1024
buffer_load_dwordx4 a[216:219], v1, s[4:7], s34 offen offset:2048
buffer_load_dwordx4 a[220:223], v1, s[4:7], s34 offen offset:3072
s_add_u32 s34, s34, 4096
buffer_load_dwordx4 a[224:227], v1, s[4:7], s34 offen offset:0
buffer_load_dwordx4 a[228:231], v1, s[4:7], s34 offen offset:1024
buffer_load_dwordx4 a[232:235], v1, s[4:7], s34 offen offset:2048
buffer_load_dwordx4 a[236:239], v1, s[4:7], s34 offen offset:3072
s_waitcnt vmcnt(20)
s_mul_i32 s34, s15, 12
s_mul_i32 s35, s16, 6
s_add_u32 s34, s34, s35
s_add_u32 s34, s34, 2
s_mul_i32 s34, s34, 20480
s_add_u32 s34, s34, 22020096
buffer_load_dwordx4 v[96:99], v1, s[4:7], s34 offen offset:0
buffer_load_dwordx4 v[100:103], v1, s[4:7], s34 offen offset:1024
buffer_load_dwordx4 v[104:107], v1, s[4:7], s34 offen offset:2048
buffer_load_dwordx4 v[108:111], v1, s[4:7], s34 offen offset:3072
s_add_u32 s34, s34, 4096
buffer_load_dwordx4 v[112:115], v1, s[4:7], s34 offen offset:0
buffer_load_dwordx4 v[116:119], v1, s[4:7], s34 offen offset:1024
buffer_load_dwordx4 v[120:123], v1, s[4:7], s34 offen offset:2048
buffer_load_dwordx4 v[124:127], v1, s[4:7], s34 offen offset:3072
s_add_u32 s34, s34, 4096
buffer_load_dwordx4 v[128:131], v1, s[4:7], s34 offen offset:0
buffer_load_dwordx4 v[132:135], v1, s[4:7], s34 offen offset:1024
buffer_load_dwordx4 v[136:139], v1, s[4:7], s34 offen offset:2048
buffer_load_dwordx4 v[140:143], v1, s[4:7], s34 offen offset:3072
s_add_u32 s34, s34, 4096
buffer_load_dwordx4 v[144:147], v1, s[4:7], s34 offen offset:0
buffer_load_dwordx4 v[148:151], v1, s[4:7], s34 offen offset:1024
buffer_load_dwordx4 v[152:155], v1, s[4:7], s34 offen offset:2048
buffer_load_dwordx4 v[156:159], v1, s[4:7], s34 offen offset:3072
s_add_u32 s34, s34, 4096
buffer_load_dwordx4 v[160:163], v1, s[4:7], s34 offen offset:0
buffer_load_dwordx4 v[164:167], v1, s[4:7], s34 offen offset:1024
buffer_load_dwordx4 v[168:171], v1, s[4:7], s34 offen offset:2048
buffer_load_dwordx4 v[172:175], v1, s[4:7], s34 offen offset:3072
s_waitcnt vmcnt(20)
s_mul_i32 s34, s15, 12
s_mul_i32 s35, s16, 6
s_add_u32 s34, s34, s35
s_add_u32 s34, s34, 3
s_mul_i32 s34, s34, 20480
s_add_u32 s34, s34, 22020096
buffer_load_dwordx4 v[176:179], v1, s[4:7], s34 offen offset:0
buffer_load_dwordx4 v[180:183], v1, s[4:7], s34 offen offset:1024
buffer_load_dwordx4 v[184:187], v1, s[4:7], s34 offen offset:2048
buffer_load_dwordx4 v[188:191], v1, s[4:7], s34 offen offset:3072
s_add_u32 s34, s34, 4096
buffer_load_dwordx4 v[192:195], v1, s[4:7], s34 offen offset:0
buffer_load_dwordx4 v[196:199], v1, s[4:7], s34 offen offset:1024
buffer_load_dwordx4 v[200:203], v1, s[4:7], s34 offen offset:2048
buffer_load_dwordx4 v[204:207], v1, s[4:7], s34 offen offset:3072
s_add_u32 s34, s34, 4096
buffer_load_dwordx4 v[208:211], v1, s[4:7], s34 offen offset:0
buffer_load_dwordx4 v[212:215], v1, s[4:7], s34 offen offset:1024
buffer_load_dwordx4 v[216:219], v1, s[4:7], s34 offen offset:2048
buffer_load_dwordx4 v[220:223], v1, s[4:7], s34 offen offset:3072
s_add_u32 s34, s34, 4096
buffer_load_dwordx4 v[224:227], v1, s[4:7], s34 offen offset:0
buffer_load_dwordx4 v[228:231], v1, s[4:7], s34 offen offset:1024
buffer_load_dwordx4 v[232:235], v1, s[4:7], s34 offen offset:2048
buffer_load_dwordx4 v[236:239], v1, s[4:7], s34 offen offset:3072
s_add_u32 s34, s34, 4096
buffer_load_dwordx4 v[240:243], v1, s[4:7], s34 offen offset:0
buffer_load_dwordx4 v[244:247], v1, s[4:7], s34 offen offset:1024
buffer_load_dwordx4 v[248:251], v1, s[4:7], s34 offen offset:2048
buffer_load_dwordx4 v[252:255], v1, s[4:7], s34 offen offset:3072
s_waitcnt vmcnt(20)
v_and_b32 v30, 7, v0
v_lshlrev_b32 v30, 3, v30
reca_cens243:
buffer_load_dwordx2 v[28:29], v30, s[8:11], 0 offen sc1
s_waitcnt vmcnt(0)
v_sad_u8 v31, v28, 0, 0
v_sad_u8 v31, v29, 0, v31
v_cmp_gt_u32 vcc, 32, v31
s_cbranch_vccz reca_censok244
s_sleep 8
s_sub_u32 s18, s18, 1
s_cbranch_scc0 reca_cens243
s_mov_b32 s18, 0
reca_censok244:
v_and_b32 v28, 0x20202020, v28
v_and_b32 v29, 0x20202020, v29
v_cmp_ne_u32 s[34:35], 0, v28
v_cmp_ne_u32 s[36:37], 0, v29
s_nop 3
s_and_b32 s34, s34, 0xff
s_and_b32 s36, s36, 0xff
s_or_b32 s35, s34, s36
s_lshr_b32 s37, s35, s13
s_and_b32 s37, s37, 1
s_xor_b32 s43, s37, 1
s_cmp_eq_u32 s57, 0
s_cselect_b32 s58, s36, s34
v_mov_b32 v31, 0x80000000
s_cmp_lg_u32 s43, 0
s_cbranch_scc1 reca_pslow245
reca_ptop246:
s_cmp_lt_u32 s17, 3
s_cbranch_scc1 reca_pgo247
s_sub_u32 s36, s17, 3
reca_ppoll248:
buffer_load_dword v28, v4, s[4:7], s25 offen sc1
s_waitcnt vmcnt(0)
v_readfirstlane_b32 s34, v28
s_nop 3
s_cmp_ge_i32 s34, s36
s_cbranch_scc1 reca_pgo247
s_sleep 8
s_sub_u32 s18, s18, 1
s_cbranch_scc0 reca_ppoll248
s_mov_b32 s18, 0
reca_pgo247:
s_waitcnt vmcnt(0)
s_barrier
v_add_u32 v7, s26, v1
s_xor_b32 s26, s26, 40960
s_add_u32 s37, s17, 1
s_cmp_ge_u32 s37, 64
s_cbranch_scc1 reca_pnodma249
s_mul_i32 s20, s37, 40960
s_add_u32 s20, s20, 84944896
s_add_u32 m0, s26, 10240
s_nop 0
buffer_load_dwordx4 v1, s[4:7], s20 offen offset:0 lds
buffer_load_dwordx4 v1, s[4:7], s20 offen offset:1024 lds
buffer_load_dwordx4 v1, s[4:7], s20 offen offset:2048 lds
buffer_load_dwordx4 v1, s[4:7], s20 offen offset:3072 lds
s_add_u32 s20, s20, 4096
s_add_u32 m0, s26, 14336
s_nop 0
buffer_load_dwordx4 v1, s[4:7], s20 offen offset:0 lds
buffer_load_dwordx4 v1, s[4:7], s20 offen offset:1024 lds
buffer_load_dwordx4 v1, s[4:7], s20 offen offset:2048 lds
buffer_load_dwordx4 v1, s[4:7], s20 offen offset:3072 lds
s_add_u32 s20, s20, 4096
s_add_u32 m0, s26, 18432
s_nop 0
buffer_load_dwordx4 v1, s[4:7], s20 offen offset:0 lds
buffer_load_dwordx4 v1, s[4:7], s20 offen offset:1024 lds
reca_pnodma249:
s_lshl_b32 s34, s15, 3
s_and_b32 s35, s17, 7
s_add_u32 s34, s34, s35
s_mul_i32 s34, s34, 12288
s_mul_i32 s35, s16, 3072
s_add_u32 s35, s35, s34
s_add_u32 s21, s35, 37748736
s_add_u32 s22, s35, 44040192
s_mul_i32 s35, s16, 6144
s_add_u32 s35, s35, s34
s_add_u32 s23, s35, 40894464
ds_read_b128 v[72:75], v7 offset:0
ds_read_b128 v[76:79], v7 offset:20480
ds_read_b128 v[80:83], v7 offset:1024
ds_read_b128 v[84:87], v7 offset:21504
ds_read_b128 v[88:91], v7 offset:2048
ds_read_b128 v[92:95], v7 offset:22528
s_waitcnt lgkmcnt(4)
v_mfma_f32_16x16x32_bf16 v[32:35], a[0:3], v[72:75], 0
v_mfma_f32_16x16x32_bf16 v[36:39], a[0:3], v[76:79], 0
v_mfma_f32_16x16x32_bf16 v[40:43], a[80:83], v[72:75], 0
v_mfma_f32_16x16x32_bf16 v[44:47], a[80:83], v[76:79], 0
v_mfma_f32_16x16x32_bf16 v[48:51], v[72:75], a[160:163], 0
v_mfma_f32_16x16x32_bf16 v[52:55], v[76:79], a[160:163], 0
v_mfma_f32_16x16x32_bf16 v[56:59], v[72:75], v[96:99], 0
v_mfma_f32_16x16x32_bf16 v[60:63], v[76:79], v[96:99], 0
v_mfma_f32_16x16x32_bf16 v[64:67], v[72:75], v[176:179], 0
v_mfma_f32_16x16x32_bf16 v[68:71], v[76:79], v[176:179], 0
ds_read_b128 v[72:75], v7 offset:3072
ds_read_b128 v[76:79], v7 offset:23552
s_waitcnt lgkmcnt(4)
v_mfma_f32_16x16x32_bf16 v[32:35], a[4:7], v[80:83], v[32:35]
v_mfma_f32_16x16x32_bf16 v[36:39], a[4:7], v[84:87], v[36:39]
v_mfma_f32_16x16x32_bf16 v[40:43], a[84:87], v[80:83], v[40:43]
v_mfma_f32_16x16x32_bf16 v[44:47], a[84:87], v[84:87], v[44:47]
v_mfma_f32_16x16x32_bf16 v[48:51], v[80:83], a[164:167], v[48:51]
v_mfma_f32_16x16x32_bf16 v[52:55], v[84:87], a[164:167], v[52:55]
v_mfma_f32_16x16x32_bf16 v[56:59], v[80:83], v[100:103], v[56:59]
v_mfma_f32_16x16x32_bf16 v[60:63], v[84:87], v[100:103], v[60:63]
v_mfma_f32_16x16x32_bf16 v[64:67], v[80:83], v[180:183], v[64:67]
v_mfma_f32_16x16x32_bf16 v[68:71], v[84:87], v[180:183], v[68:71]
ds_read_b128 v[80:83], v7 offset:4096
ds_read_b128 v[84:87], v7 offset:24576
s_waitcnt lgkmcnt(4)
v_mfma_f32_16x16x32_bf16 v[32:35], a[8:11], v[88:91], v[32:35]
v_mfma_f32_16x16x32_bf16 v[36:39], a[8:11], v[92:95], v[36:39]
v_mfma_f32_16x16x32_bf16 v[40:43], a[88:91], v[88:91], v[40:43]
v_mfma_f32_16x16x32_bf16 v[44:47], a[88:91], v[92:95], v[44:47]
v_mfma_f32_16x16x32_bf16 v[48:51], v[88:91], a[168:171], v[48:51]
v_mfma_f32_16x16x32_bf16 v[52:55], v[92:95], a[168:171], v[52:55]
v_mfma_f32_16x16x32_bf16 v[56:59], v[88:91], v[104:107], v[56:59]
v_mfma_f32_16x16x32_bf16 v[60:63], v[92:95], v[104:107], v[60:63]
v_mfma_f32_16x16x32_bf16 v[64:67], v[88:91], v[184:187], v[64:67]
v_mfma_f32_16x16x32_bf16 v[68:71], v[92:95], v[184:187], v[68:71]
ds_read_b128 v[88:91], v7 offset:5120
ds_read_b128 v[92:95], v7 offset:25600
s_waitcnt lgkmcnt(4)
v_mfma_f32_16x16x32_bf16 v[32:35], a[12:15], v[72:75], v[32:35]
v_mfma_f32_16x16x32_bf16 v[36:39], a[12:15], v[76:79], v[36:39]
v_mfma_f32_16x16x32_bf16 v[40:43], a[92:95], v[72:75], v[40:43]
v_mfma_f32_16x16x32_bf16 v[44:47], a[92:95], v[76:79], v[44:47]
v_mfma_f32_16x16x32_bf16 v[48:51], v[72:75], a[172:175], v[48:51]
v_mfma_f32_16x16x32_bf16 v[52:55], v[76:79], a[172:175], v[52:55]
v_mfma_f32_16x16x32_bf16 v[56:59], v[72:75], v[108:111], v[56:59]
v_mfma_f32_16x16x32_bf16 v[60:63], v[76:79], v[108:111], v[60:63]
v_mfma_f32_16x16x32_bf16 v[64:67], v[72:75], v[188:191], v[64:67]
v_mfma_f32_16x16x32_bf16 v[68:71], v[76:79], v[188:191], v[68:71]
ds_read_b128 v[72:75], v7 offset:6144
ds_read_b128 v[76:79], v7 offset:26624
s_waitcnt lgkmcnt(4)
v_mfma_f32_16x16x32_bf16 v[32:35], a[16:19], v[80:83], v[32:35]
v_mfma_f32_16x16x32_bf16 v[36:39], a[16:19], v[84:87], v[36:39]
v_mfma_f32_16x16x32_bf16 v[40:43], a[96:99], v[80:83], v[40:43]
v_mfma_f32_16x16x32_bf16 v[44:47], a[96:99], v[84:87], v[44:47]
v_mfma_f32_16x16x32_bf16 v[48:51], v[80:83], a[176:179], v[48:51]
v_mfma_f32_16x16x32_bf16 v[52:55], v[84:87], a[176:179], v[52:55]
v_mfma_f32_16x16x32_bf16 v[56:59], v[80:83], v[112:115], v[56:59]
v_mfma_f32_16x16x32_bf16 v[60:63], v[84:87], v[112:115], v[60:63]
v_mfma_f32_16x16x32_bf16 v[64:67], v[80:83], v[192:195], v[64:67]
v_mfma_f32_16x16x32_bf16 v[68:71], v[84:87], v[192:195], v[68:71]
ds_read_b128 v[80:83], v7 offset:7168
ds_read_b128 v[84:87], v7 offset:27648
s_waitcnt lgkmcnt(4)
v_mfma_f32_16x16x32_bf16 v[32:35], a[20:23], v[88:91], v[32:35]
v_mfma_f32_16x16x32_bf16 v[36:39], a[20:23], v[92:95], v[36:39]
v_mfma_f32_16x16x32_bf16 v[40:43], a[100:103], v[88:91], v[40:43]
v_mfma_f32_16x16x32_bf16 v[44:47], a[100:103], v[92:95], v[44:47]
v_mfma_f32_16x16x32_bf16 v[48:51], v[88:91], a[180:183], v[48:51]
v_mfma_f32_16x16x32_bf16 v[52:55], v[92:95], a[180:183], v[52:55]
v_mfma_f32_16x16x32_bf16 v[56:59], v[88:91], v[116:119], v[56:59]
v_mfma_f32_16x16x32_bf16 v[60:63], v[92:95], v[116:119], v[60:63]
v_mfma_f32_16x16x32_bf16 v[64:67], v[88:91], v[196:199], v[64:67]
v_mfma_f32_16x16x32_bf16 v[68:71], v[92:95], v[196:199], v[68:71]
ds_read_b128 v[88:91], v7 offset:8192
ds_read_b128 v[92:95], v7 offset:28672
s_waitcnt lgkmcnt(4)
v_mfma_f32_16x16x32_bf16 v[32:35], a[24:27], v[72:75], v[32:35]
v_mfma_f32_16x16x32_bf16 v[36:39], a[24:27], v[76:79], v[36:39]
v_mfma_f32_16x16x32_bf16 v[40:43], a[104:107], v[72:75], v[40:43]
v_mfma_f32_16x16x32_bf16 v[44:47], a[104:107], v[76:79], v[44:47]
v_mfma_f32_16x16x32_bf16 v[48:51], v[72:75], a[184:187], v[48:51]
v_mfma_f32_16x16x32_bf16 v[52:55], v[76:79], a[184:187], v[52:55]
v_mfma_f32_16x16x32_bf16 v[56:59], v[72:75], v[120:123], v[56:59]
v_mfma_f32_16x16x32_bf16 v[60:63], v[76:79], v[120:123], v[60:63]
v_mfma_f32_16x16x32_bf16 v[64:67], v[72:75], v[200:203], v[64:67]
v_mfma_f32_16x16x32_bf16 v[68:71], v[76:79], v[200:203], v[68:71]
ds_read_b128 v[72:75], v7 offset:9216
ds_read_b128 v[76:79], v7 offset:29696
s_waitcnt lgkmcnt(4)
v_mfma_f32_16x16x32_bf16 v[32:35], a[28:31], v[80:83], v[32:35]
v_mfma_f32_16x16x32_bf16 v[36:39], a[28:31], v[84:87], v[36:39]
v_mfma_f32_16x16x32_bf16 v[40:43], a[108:111], v[80:83], v[40:43]
v_mfma_f32_16x16x32_bf16 v[44:47], a[108:111], v[84:87], v[44:47]
v_mfma_f32_16x16x32_bf16 v[48:51], v[80:83], a[188:191], v[48:51]
v_mfma_f32_16x16x32_bf16 v[52:55], v[84:87], a[188:191], v[52:55]
v_mfma_f32_16x16x32_bf16 v[56:59], v[80:83], v[124:127], v[56:59]
v_mfma_f32_16x16x32_bf16 v[60:63], v[84:87], v[124:127], v[60:63]
v_mfma_f32_16x16x32_bf16 v[64:67], v[80:83], v[204:207], v[64:67]
v_mfma_f32_16x16x32_bf16 v[68:71], v[84:87], v[204:207], v[68:71]
ds_read_b128 v[80:83], v7 offset:10240
ds_read_b128 v[84:87], v7 offset:30720
s_waitcnt lgkmcnt(4)
v_mfma_f32_16x16x32_bf16 v[32:35], a[32:35], v[88:91], v[32:35]
v_mfma_f32_16x16x32_bf16 v[36:39], a[32:35], v[92:95], v[36:39]
v_mfma_f32_16x16x32_bf16 v[40:43], a[112:115], v[88:91], v[40:43]
v_mfma_f32_16x16x32_bf16 v[44:47], a[112:115], v[92:95], v[44:47]
v_mfma_f32_16x16x32_bf16 v[48:51], v[88:91], a[192:195], v[48:51]
v_mfma_f32_16x16x32_bf16 v[52:55], v[92:95], a[192:195], v[52:55]
v_mfma_f32_16x16x32_bf16 v[56:59], v[88:91], v[128:131], v[56:59]
v_mfma_f32_16x16x32_bf16 v[60:63], v[92:95], v[128:131], v[60:63]
v_mfma_f32_16x16x32_bf16 v[64:67], v[88:91], v[208:211], v[64:67]
v_mfma_f32_16x16x32_bf16 v[68:71], v[92:95], v[208:211], v[68:71]
ds_read_b128 v[88:91], v7 offset:11264
ds_read_b128 v[92:95], v7 offset:31744
s_waitcnt lgkmcnt(4)
v_mfma_f32_16x16x32_bf16 v[32:35], a[36:39], v[72:75], v[32:35]
v_mfma_f32_16x16x32_bf16 v[36:39], a[36:39], v[76:79], v[36:39]
v_mfma_f32_16x16x32_bf16 v[40:43], a[116:119], v[72:75], v[40:43]
v_mfma_f32_16x16x32_bf16 v[44:47], a[116:119], v[76:79], v[44:47]
v_mfma_f32_16x16x32_bf16 v[48:51], v[72:75], a[196:199], v[48:51]
v_mfma_f32_16x16x32_bf16 v[52:55], v[76:79], a[196:199], v[52:55]
v_mfma_f32_16x16x32_bf16 v[56:59], v[72:75], v[132:135], v[56:59]
v_mfma_f32_16x16x32_bf16 v[60:63], v[76:79], v[132:135], v[60:63]
v_mfma_f32_16x16x32_bf16 v[64:67], v[72:75], v[212:215], v[64:67]
v_mfma_f32_16x16x32_bf16 v[68:71], v[76:79], v[212:215], v[68:71]
ds_read_b128 v[72:75], v7 offset:12288
ds_read_b128 v[76:79], v7 offset:32768
s_waitcnt lgkmcnt(4)
v_mfma_f32_16x16x32_bf16 v[32:35], a[40:43], v[80:83], v[32:35]
v_mfma_f32_16x16x32_bf16 v[36:39], a[40:43], v[84:87], v[36:39]
v_mfma_f32_16x16x32_bf16 v[40:43], a[120:123], v[80:83], v[40:43]
v_mfma_f32_16x16x32_bf16 v[44:47], a[120:123], v[84:87], v[44:47]
v_mfma_f32_16x16x32_bf16 v[48:51], v[80:83], a[200:203], v[48:51]
v_mfma_f32_16x16x32_bf16 v[52:55], v[84:87], a[200:203], v[52:55]
v_mfma_f32_16x16x32_bf16 v[56:59], v[80:83], v[136:139], v[56:59]
v_mfma_f32_16x16x32_bf16 v[60:63], v[84:87], v[136:139], v[60:63]
v_mfma_f32_16x16x32_bf16 v[64:67], v[80:83], v[216:219], v[64:67]
v_mfma_f32_16x16x32_bf16 v[68:71], v[84:87], v[216:219], v[68:71]
ds_read_b128 v[80:83], v7 offset:13312
ds_read_b128 v[84:87], v7 offset:33792
s_waitcnt lgkmcnt(4)
v_mfma_f32_16x16x32_bf16 v[32:35], a[44:47], v[88:91], v[32:35]
v_mfma_f32_16x16x32_bf16 v[36:39], a[44:47], v[92:95], v[36:39]
v_mfma_f32_16x16x32_bf16 v[40:43], a[124:127], v[88:91], v[40:43]
v_mfma_f32_16x16x32_bf16 v[44:47], a[124:127], v[92:95], v[44:47]
v_mfma_f32_16x16x32_bf16 v[48:51], v[88:91], a[204:207], v[48:51]
v_mfma_f32_16x16x32_bf16 v[52:55], v[92:95], a[204:207], v[52:55]
v_mfma_f32_16x16x32_bf16 v[56:59], v[88:91], v[140:143], v[56:59]
v_mfma_f32_16x16x32_bf16 v[60:63], v[92:95], v[140:143], v[60:63]
v_mfma_f32_16x16x32_bf16 v[64:67], v[88:91], v[220:223], v[64:67]
v_mfma_f32_16x16x32_bf16 v[68:71], v[92:95], v[220:223], v[68:71]
ds_read_b128 v[88:91], v7 offset:14336
ds_read_b128 v[92:95], v7 offset:34816
s_waitcnt lgkmcnt(4)
v_mfma_f32_16x16x32_bf16 v[32:35], a[48:51], v[72:75], v[32:35]
v_mfma_f32_16x16x32_bf16 v[36:39], a[48:51], v[76:79], v[36:39]
v_mfma_f32_16x16x32_bf16 v[40:43], a[128:131], v[72:75], v[40:43]
v_mfma_f32_16x16x32_bf16 v[44:47], a[128:131], v[76:79], v[44:47]
v_mfma_f32_16x16x32_bf16 v[48:51], v[72:75], a[208:211], v[48:51]
v_mfma_f32_16x16x32_bf16 v[52:55], v[76:79], a[208:211], v[52:55]
v_mfma_f32_16x16x32_bf16 v[56:59], v[72:75], v[144:147], v[56:59]
v_mfma_f32_16x16x32_bf16 v[60:63], v[76:79], v[144:147], v[60:63]
v_mfma_f32_16x16x32_bf16 v[64:67], v[72:75], v[224:227], v[64:67]
v_mfma_f32_16x16x32_bf16 v[68:71], v[76:79], v[224:227], v[68:71]
ds_read_b128 v[72:75], v7 offset:15360
ds_read_b128 v[76:79], v7 offset:35840
s_waitcnt lgkmcnt(4)
v_mfma_f32_16x16x32_bf16 v[32:35], a[52:55], v[80:83], v[32:35]
v_mfma_f32_16x16x32_bf16 v[36:39], a[52:55], v[84:87], v[36:39]
v_mfma_f32_16x16x32_bf16 v[40:43], a[132:135], v[80:83], v[40:43]
v_mfma_f32_16x16x32_bf16 v[44:47], a[132:135], v[84:87], v[44:47]
v_mfma_f32_16x16x32_bf16 v[48:51], v[80:83], a[212:215], v[48:51]
v_mfma_f32_16x16x32_bf16 v[52:55], v[84:87], a[212:215], v[52:55]
v_mfma_f32_16x16x32_bf16 v[56:59], v[80:83], v[148:151], v[56:59]
v_mfma_f32_16x16x32_bf16 v[60:63], v[84:87], v[148:151], v[60:63]
v_mfma_f32_16x16x32_bf16 v[64:67], v[80:83], v[228:231], v[64:67]
v_mfma_f32_16x16x32_bf16 v[68:71], v[84:87], v[228:231], v[68:71]
ds_read_b128 v[80:83], v7 offset:16384
ds_read_b128 v[84:87], v7 offset:36864
s_waitcnt lgkmcnt(4)
v_mfma_f32_16x16x32_bf16 v[32:35], a[56:59], v[88:91], v[32:35]
v_mfma_f32_16x16x32_bf16 v[36:39], a[56:59], v[92:95], v[36:39]
v_mfma_f32_16x16x32_bf16 v[40:43], a[136:139], v[88:91], v[40:43]
v_mfma_f32_16x16x32_bf16 v[44:47], a[136:139], v[92:95], v[44:47]
v_mfma_f32_16x16x32_bf16 v[48:51], v[88:91], a[216:219], v[48:51]
v_mfma_f32_16x16x32_bf16 v[52:55], v[92:95], a[216:219], v[52:55]
v_mfma_f32_16x16x32_bf16 v[56:59], v[88:91], v[152:155], v[56:59]
v_mfma_f32_16x16x32_bf16 v[60:63], v[92:95], v[152:155], v[60:63]
v_mfma_f32_16x16x32_bf16 v[64:67], v[88:91], v[232:235], v[64:67]
v_mfma_f32_16x16x32_bf16 v[68:71], v[92:95], v[232:235], v[68:71]
ds_read_b128 v[88:91], v7 offset:17408
ds_read_b128 v[92:95], v7 offset:37888
s_waitcnt lgkmcnt(4)
v_mfma_f32_16x16x32_bf16 v[32:35], a[60:63], v[72:75], v[32:35]
v_mfma_f32_16x16x32_bf16 v[36:39], a[60:63], v[76:79], v[36:39]
v_mfma_f32_16x16x32_bf16 v[40:43], a[140:143], v[72:75], v[40:43]
v_mfma_f32_16x16x32_bf16 v[44:47], a[140:143], v[76:79], v[44:47]
v_mfma_f32_16x16x32_bf16 v[48:51], v[72:75], a[220:223], v[48:51]
v_mfma_f32_16x16x32_bf16 v[52:55], v[76:79], a[220:223], v[52:55]
v_mfma_f32_16x16x32_bf16 v[56:59], v[72:75], v[156:159], v[56:59]
v_mfma_f32_16x16x32_bf16 v[60:63], v[76:79], v[156:159], v[60:63]
v_mfma_f32_16x16x32_bf16 v[64:67], v[72:75], v[236:239], v[64:67]
v_mfma_f32_16x16x32_bf16 v[68:71], v[76:79], v[236:239], v[68:71]
ds_read_b128 v[72:75], v7 offset:18432
ds_read_b128 v[76:79], v7 offset:38912
s_waitcnt lgkmcnt(4)
v_mfma_f32_16x16x32_bf16 v[32:35], a[64:67], v[80:83], v[32:35]
v_mfma_f32_16x16x32_bf16 v[36:39], a[64:67], v[84:87], v[36:39]
v_mfma_f32_16x16x32_bf16 v[40:43], a[144:147], v[80:83], v[40:43]
v_mfma_f32_16x16x32_bf16 v[44:47], a[144:147], v[84:87], v[44:47]
v_mfma_f32_16x16x32_bf16 v[48:51], v[80:83], a[224:227], v[48:51]
v_mfma_f32_16x16x32_bf16 v[52:55], v[84:87], a[224:227], v[52:55]
v_mfma_f32_16x16x32_bf16 v[56:59], v[80:83], v[160:163], v[56:59]
v_mfma_f32_16x16x32_bf16 v[60:63], v[84:87], v[160:163], v[60:63]
v_mfma_f32_16x16x32_bf16 v[64:67], v[80:83], v[240:243], v[64:67]
v_mfma_f32_16x16x32_bf16 v[68:71], v[84:87], v[240:243], v[68:71]
ds_read_b128 v[80:83], v7 offset:19456
ds_read_b128 v[84:87], v7 offset:39936
s_waitcnt lgkmcnt(4)
v_mfma_f32_16x16x32_bf16 v[32:35], a[68:71], v[88:91], v[32:35]
v_mfma_f32_16x16x32_bf16 v[36:39], a[68:71], v[92:95], v[36:39]
v_mfma_f32_16x16x32_bf16 v[40:43], a[148:151], v[88:91], v[40:43]
v_mfma_f32_16x16x32_bf16 v[44:47], a[148:151], v[92:95], v[44:47]
v_mfma_f32_16x16x32_bf16 v[48:51], v[88:91], a[228:231], v[48:51]
v_mfma_f32_16x16x32_bf16 v[52:55], v[92:95], a[228:231], v[52:55]
v_mfma_f32_16x16x32_bf16 v[56:59], v[88:91], v[164:167], v[56:59]
v_mfma_f32_16x16x32_bf16 v[60:63], v[92:95], v[164:167], v[60:63]
v_mfma_f32_16x16x32_bf16 v[64:67], v[88:91], v[244:247], v[64:67]
v_mfma_f32_16x16x32_bf16 v[68:71], v[92:95], v[244:247], v[68:71]
s_waitcnt lgkmcnt(2)
v_mfma_f32_16x16x32_bf16 v[32:35], a[72:75], v[72:75], v[32:35]
v_mfma_f32_16x16x32_bf16 v[36:39], a[72:75], v[76:79], v[36:39]
v_mfma_f32_16x16x32_bf16 v[40:43], a[152:155], v[72:75], v[40:43]
v_mfma_f32_16x16x32_bf16 v[44:47], a[152:155], v[76:79], v[44:47]
v_mfma_f32_16x16x32_bf16 v[48:51], v[72:75], a[232:235], v[48:51]
v_mfma_f32_16x16x32_bf16 v[52:55], v[76:79], a[232:235], v[52:55]
v_mfma_f32_16x16x32_bf16 v[56:59], v[72:75], v[168:171], v[56:59]
v_mfma_f32_16x16x32_bf16 v[60:63], v[76:79], v[168:171], v[60:63]
v_mfma_f32_16x16x32_bf16 v[64:67], v[72:75], v[248:251], v[64:67]
v_mfma_f32_16x16x32_bf16 v[68:71], v[76:79], v[248:251], v[68:71]
s_waitcnt lgkmcnt(0)
v_mfma_f32_16x16x32_bf16 v[32:35], a[76:79], v[80:83], v[32:35]
v_mfma_f32_16x16x32_bf16 v[36:39], a[76:79], v[84:87], v[36:39]
v_mfma_f32_16x16x32_bf16 v[40:43], a[156:159], v[80:83], v[40:43]
v_mfma_f32_16x16x32_bf16 v[44:47], a[156:159], v[84:87], v[44:47]
v_mfma_f32_16x16x32_bf16 v[48:51], v[80:83], a[236:239], v[48:51]
v_mfma_f32_16x16x32_bf16 v[52:55], v[84:87], a[236:239], v[52:55]
v_mfma_f32_16x16x32_bf16 v[56:59], v[80:83], v[172:175], v[56:59]
v_mfma_f32_16x16x32_bf16 v[60:63], v[84:87], v[172:175], v[60:63]
v_mfma_f32_16x16x32_bf16 v[64:67], v[80:83], v[252:255], v[64:67]
v_mfma_f32_16x16x32_bf16 v[68:71], v[84:87], v[252:255], v[68:71]
v_cvt_pk_bf16_f32 v8, v32, v33
v_cvt_pk_bf16_f32 v9, v34, v35
v_cvt_pk_bf16_f32 v10, v40, v41
v_cvt_pk_bf16_f32 v11, v42, v43
s_add_u32 s34, s21, 2048
buffer_store_dwordx4 v[8:11], v1, s[4:7], s34 offen
v_cvt_pk_bf16_f32 v12, v36, v37
v_cvt_pk_bf16_f32 v13, v38, v39
v_cvt_pk_bf16_f32 v14, v44, v45
v_cvt_pk_bf16_f32 v15, v46, v47
s_add_u32 s34, s21, 8192
buffer_store_dwordx4 v[12:15], v1, s[4:7], s34 offen
v_cvt_pk_bf16_f32 v8, v48, v49
v_cvt_pk_bf16_f32 v9, v50, v51
v_cvt_pk_bf16_f32 v10, v52, v53
v_cvt_pk_bf16_f32 v11, v54, v55
s_add_u32 s34, s23, 1024
buffer_store_dwordx4 v[8:11], v1, s[4:7], s34 offen
v_cvt_pk_bf16_f32 v12, v56, v57
v_cvt_pk_bf16_f32 v13, v58, v59
v_cvt_pk_bf16_f32 v14, v60, v61
v_cvt_pk_bf16_f32 v15, v62, v63
s_add_u32 s34, s23, 2048
buffer_store_dwordx4 v[12:15], v1, s[4:7], s34 offen
v_cvt_pk_bf16_f32 v8, v64, v65
v_cvt_pk_bf16_f32 v9, v66, v67
v_cvt_pk_bf16_f32 v10, v68, v69
v_cvt_pk_bf16_f32 v11, v70, v71
s_add_u32 s34, s23, 3072
buffer_store_dwordx4 v[8:11], v1, s[4:7], s34 offen
s_waitcnt vmcnt(0)
s_barrier
s_add_u32 s17, s17, 1
s_cmp_lt_u32 s17, 64
s_cbranch_scc1 reca_ptop246
s_branch reca_exit1
reca_pslow245:
reca_ptop251:
s_cmp_lt_u32 s17, 3
s_cbranch_scc1 reca_pgo252
s_sub_u32 s36, s17, 3
reca_ppoll253:
buffer_load_dword v28, v4, s[4:7], s25 offen sc1
s_waitcnt vmcnt(0)
v_readfirstlane_b32 s34, v28
s_nop 3
s_cmp_ge_i32 s34, s36
s_cbranch_scc1 reca_pgo252
s_sleep 8
s_sub_u32 s18, s18, 1
s_cbranch_scc0 reca_ppoll253
s_mov_b32 s18, 0
reca_pgo252:
s_waitcnt vmcnt(0)
s_barrier
v_add_u32 v7, s26, v1
s_xor_b32 s26, s26, 40960
s_add_u32 s37, s17, 1
s_cmp_ge_u32 s37, 64
s_cbranch_scc1 reca_pnodma254
s_mul_i32 s20, s37, 40960
s_add_u32 s20, s20, 84944896
s_add_u32 m0, s26, 10240
s_nop 0
buffer_load_dwordx4 v1, s[4:7], s20 offen offset:0 lds
buffer_load_dwordx4 v1, s[4:7], s20 offen offset:1024 lds
buffer_load_dwordx4 v1, s[4:7], s20 offen offset:2048 lds
buffer_load_dwordx4 v1, s[4:7], s20 offen offset:3072 lds
s_add_u32 s20, s20, 4096
s_add_u32 m0, s26, 14336
s_nop 0
buffer_load_dwordx4 v1, s[4:7], s20 offen offset:0 lds
buffer_load_dwordx4 v1, s[4:7], s20 offen offset:1024 lds
buffer_load_dwordx4 v1, s[4:7], s20 offen offset:2048 lds
buffer_load_dwordx4 v1, s[4:7], s20 offen offset:3072 lds
s_add_u32 s20, s20, 4096
s_add_u32 m0, s26, 18432
s_nop 0
buffer_load_dwordx4 v1, s[4:7], s20 offen offset:0 lds
buffer_load_dwordx4 v1, s[4:7], s20 offen offset:1024 lds
reca_pnodma254:
s_lshl_b32 s34, s15, 3
s_and_b32 s35, s17, 7
s_add_u32 s34, s34, s35
s_mul_i32 s34, s34, 12288
s_mul_i32 s35, s16, 3072
s_add_u32 s35, s35, s34
s_add_u32 s21, s35, 37748736
s_add_u32 s22, s35, 44040192
s_mul_i32 s35, s16, 6144
s_add_u32 s35, s35, s34
s_add_u32 s23, s35, 40894464
ds_read_b128 v[72:75], v7 offset:0
ds_read_b128 v[76:79], v7 offset:20480
ds_read_b128 v[80:83], v7 offset:1024
ds_read_b128 v[84:87], v7 offset:21504
ds_read_b128 v[88:91], v7 offset:2048
ds_read_b128 v[92:95], v7 offset:22528
s_waitcnt lgkmcnt(4)
v_mfma_f32_16x16x32_bf16 v[32:35], a[0:3], v[72:75], 0
v_mfma_f32_16x16x32_bf16 v[36:39], a[0:3], v[76:79], 0
v_mfma_f32_16x16x32_bf16 v[40:43], a[80:83], v[72:75], 0
v_mfma_f32_16x16x32_bf16 v[44:47], a[80:83], v[76:79], 0
v_mfma_f32_16x16x32_bf16 v[48:51], v[72:75], a[160:163], 0
v_mfma_f32_16x16x32_bf16 v[52:55], v[76:79], a[160:163], 0
v_mfma_f32_16x16x32_bf16 v[56:59], v[72:75], v[96:99], 0
v_mfma_f32_16x16x32_bf16 v[60:63], v[76:79], v[96:99], 0
v_mfma_f32_16x16x32_bf16 v[64:67], v[72:75], v[176:179], 0
v_mfma_f32_16x16x32_bf16 v[68:71], v[76:79], v[176:179], 0
ds_read_b128 v[72:75], v7 offset:3072
ds_read_b128 v[76:79], v7 offset:23552
s_waitcnt lgkmcnt(4)
v_mfma_f32_16x16x32_bf16 v[32:35], a[4:7], v[80:83], v[32:35]
v_mfma_f32_16x16x32_bf16 v[36:39], a[4:7], v[84:87], v[36:39]
v_mfma_f32_16x16x32_bf16 v[40:43], a[84:87], v[80:83], v[40:43]
v_mfma_f32_16x16x32_bf16 v[44:47], a[84:87], v[84:87], v[44:47]
v_mfma_f32_16x16x32_bf16 v[48:51], v[80:83], a[164:167], v[48:51]
v_mfma_f32_16x16x32_bf16 v[52:55], v[84:87], a[164:167], v[52:55]
v_mfma_f32_16x16x32_bf16 v[56:59], v[80:83], v[100:103], v[56:59]
v_mfma_f32_16x16x32_bf16 v[60:63], v[84:87], v[100:103], v[60:63]
v_mfma_f32_16x16x32_bf16 v[64:67], v[80:83], v[180:183], v[64:67]
v_mfma_f32_16x16x32_bf16 v[68:71], v[84:87], v[180:183], v[68:71]
ds_read_b128 v[80:83], v7 offset:4096
ds_read_b128 v[84:87], v7 offset:24576
s_waitcnt lgkmcnt(4)
v_mfma_f32_16x16x32_bf16 v[32:35], a[8:11], v[88:91], v[32:35]
v_mfma_f32_16x16x32_bf16 v[36:39], a[8:11], v[92:95], v[36:39]
v_mfma_f32_16x16x32_bf16 v[40:43], a[88:91], v[88:91], v[40:43]
v_mfma_f32_16x16x32_bf16 v[44:47], a[88:91], v[92:95], v[44:47]
v_mfma_f32_16x16x32_bf16 v[48:51], v[88:91], a[168:171], v[48:51]
v_mfma_f32_16x16x32_bf16 v[52:55], v[92:95], a[168:171], v[52:55]
v_mfma_f32_16x16x32_bf16 v[56:59], v[88:91], v[104:107], v[56:59]
v_mfma_f32_16x16x32_bf16 v[60:63], v[92:95], v[104:107], v[60:63]
v_mfma_f32_16x16x32_bf16 v[64:67], v[88:91], v[184:187], v[64:67]
v_mfma_f32_16x16x32_bf16 v[68:71], v[92:95], v[184:187], v[68:71]
ds_read_b128 v[88:91], v7 offset:5120
ds_read_b128 v[92:95], v7 offset:25600
s_waitcnt lgkmcnt(4)
v_mfma_f32_16x16x32_bf16 v[32:35], a[12:15], v[72:75], v[32:35]
v_mfma_f32_16x16x32_bf16 v[36:39], a[12:15], v[76:79], v[36:39]
v_mfma_f32_16x16x32_bf16 v[40:43], a[92:95], v[72:75], v[40:43]
v_mfma_f32_16x16x32_bf16 v[44:47], a[92:95], v[76:79], v[44:47]
v_mfma_f32_16x16x32_bf16 v[48:51], v[72:75], a[172:175], v[48:51]
v_mfma_f32_16x16x32_bf16 v[52:55], v[76:79], a[172:175], v[52:55]
v_mfma_f32_16x16x32_bf16 v[56:59], v[72:75], v[108:111], v[56:59]
v_mfma_f32_16x16x32_bf16 v[60:63], v[76:79], v[108:111], v[60:63]
v_mfma_f32_16x16x32_bf16 v[64:67], v[72:75], v[188:191], v[64:67]
v_mfma_f32_16x16x32_bf16 v[68:71], v[76:79], v[188:191], v[68:71]
ds_read_b128 v[72:75], v7 offset:6144
ds_read_b128 v[76:79], v7 offset:26624
s_waitcnt lgkmcnt(4)
v_mfma_f32_16x16x32_bf16 v[32:35], a[16:19], v[80:83], v[32:35]
v_mfma_f32_16x16x32_bf16 v[36:39], a[16:19], v[84:87], v[36:39]
v_mfma_f32_16x16x32_bf16 v[40:43], a[96:99], v[80:83], v[40:43]
v_mfma_f32_16x16x32_bf16 v[44:47], a[96:99], v[84:87], v[44:47]
v_mfma_f32_16x16x32_bf16 v[48:51], v[80:83], a[176:179], v[48:51]
v_mfma_f32_16x16x32_bf16 v[52:55], v[84:87], a[176:179], v[52:55]
v_mfma_f32_16x16x32_bf16 v[56:59], v[80:83], v[112:115], v[56:59]
v_mfma_f32_16x16x32_bf16 v[60:63], v[84:87], v[112:115], v[60:63]
v_mfma_f32_16x16x32_bf16 v[64:67], v[80:83], v[192:195], v[64:67]
v_mfma_f32_16x16x32_bf16 v[68:71], v[84:87], v[192:195], v[68:71]
ds_read_b128 v[80:83], v7 offset:7168
ds_read_b128 v[84:87], v7 offset:27648
s_waitcnt lgkmcnt(4)
v_mfma_f32_16x16x32_bf16 v[32:35], a[20:23], v[88:91], v[32:35]
v_mfma_f32_16x16x32_bf16 v[36:39], a[20:23], v[92:95], v[36:39]
v_mfma_f32_16x16x32_bf16 v[40:43], a[100:103], v[88:91], v[40:43]
v_mfma_f32_16x16x32_bf16 v[44:47], a[100:103], v[92:95], v[44:47]
v_mfma_f32_16x16x32_bf16 v[48:51], v[88:91], a[180:183], v[48:51]
v_mfma_f32_16x16x32_bf16 v[52:55], v[92:95], a[180:183], v[52:55]
v_mfma_f32_16x16x32_bf16 v[56:59], v[88:91], v[116:119], v[56:59]
v_mfma_f32_16x16x32_bf16 v[60:63], v[92:95], v[116:119], v[60:63]
v_mfma_f32_16x16x32_bf16 v[64:67], v[88:91], v[196:199], v[64:67]
v_mfma_f32_16x16x32_bf16 v[68:71], v[92:95], v[196:199], v[68:71]
ds_read_b128 v[88:91], v7 offset:8192
ds_read_b128 v[92:95], v7 offset:28672
s_waitcnt lgkmcnt(4)
v_mfma_f32_16x16x32_bf16 v[32:35], a[24:27], v[72:75], v[32:35]
v_mfma_f32_16x16x32_bf16 v[36:39], a[24:27], v[76:79], v[36:39]
v_mfma_f32_16x16x32_bf16 v[40:43], a[104:107], v[72:75], v[40:43]
v_mfma_f32_16x16x32_bf16 v[44:47], a[104:107], v[76:79], v[44:47]
v_mfma_f32_16x16x32_bf16 v[48:51], v[72:75], a[184:187], v[48:51]
v_mfma_f32_16x16x32_bf16 v[52:55], v[76:79], a[184:187], v[52:55]
v_mfma_f32_16x16x32_bf16 v[56:59], v[72:75], v[120:123], v[56:59]
v_mfma_f32_16x16x32_bf16 v[60:63], v[76:79], v[120:123], v[60:63]
v_mfma_f32_16x16x32_bf16 v[64:67], v[72:75], v[200:203], v[64:67]
v_mfma_f32_16x16x32_bf16 v[68:71], v[76:79], v[200:203], v[68:71]
ds_read_b128 v[72:75], v7 offset:9216
ds_read_b128 v[76:79], v7 offset:29696
s_waitcnt lgkmcnt(4)
v_mfma_f32_16x16x32_bf16 v[32:35], a[28:31], v[80:83], v[32:35]
v_mfma_f32_16x16x32_bf16 v[36:39], a[28:31], v[84:87], v[36:39]
v_mfma_f32_16x16x32_bf16 v[40:43], a[108:111], v[80:83], v[40:43]
v_mfma_f32_16x16x32_bf16 v[44:47], a[108:111], v[84:87], v[44:47]
v_mfma_f32_16x16x32_bf16 v[48:51], v[80:83], a[188:191], v[48:51]
v_mfma_f32_16x16x32_bf16 v[52:55], v[84:87], a[188:191], v[52:55]
v_mfma_f32_16x16x32_bf16 v[56:59], v[80:83], v[124:127], v[56:59]
v_mfma_f32_16x16x32_bf16 v[60:63], v[84:87], v[124:127], v[60:63]
v_mfma_f32_16x16x32_bf16 v[64:67], v[80:83], v[204:207], v[64:67]
v_mfma_f32_16x16x32_bf16 v[68:71], v[84:87], v[204:207], v[68:71]
ds_read_b128 v[80:83], v7 offset:10240
ds_read_b128 v[84:87], v7 offset:30720
s_waitcnt lgkmcnt(4)
v_mfma_f32_16x16x32_bf16 v[32:35], a[32:35], v[88:91], v[32:35]
v_mfma_f32_16x16x32_bf16 v[36:39], a[32:35], v[92:95], v[36:39]
v_mfma_f32_16x16x32_bf16 v[40:43], a[112:115], v[88:91], v[40:43]
v_mfma_f32_16x16x32_bf16 v[44:47], a[112:115], v[92:95], v[44:47]
v_mfma_f32_16x16x32_bf16 v[48:51], v[88:91], a[192:195], v[48:51]
v_mfma_f32_16x16x32_bf16 v[52:55], v[92:95], a[192:195], v[52:55]
v_mfma_f32_16x16x32_bf16 v[56:59], v[88:91], v[128:131], v[56:59]
v_mfma_f32_16x16x32_bf16 v[60:63], v[92:95], v[128:131], v[60:63]
v_mfma_f32_16x16x32_bf16 v[64:67], v[88:91], v[208:211], v[64:67]
v_mfma_f32_16x16x32_bf16 v[68:71], v[92:95], v[208:211], v[68:71]
ds_read_b128 v[88:91], v7 offset:11264
ds_read_b128 v[92:95], v7 offset:31744
s_waitcnt lgkmcnt(4)
v_mfma_f32_16x16x32_bf16 v[32:35], a[36:39], v[72:75], v[32:35]
v_mfma_f32_16x16x32_bf16 v[36:39], a[36:39], v[76:79], v[36:39]
v_mfma_f32_16x16x32_bf16 v[40:43], a[116:119], v[72:75], v[40:43]
v_mfma_f32_16x16x32_bf16 v[44:47], a[116:119], v[76:79], v[44:47]
v_mfma_f32_16x16x32_bf16 v[48:51], v[72:75], a[196:199], v[48:51]
v_mfma_f32_16x16x32_bf16 v[52:55], v[76:79], a[196:199], v[52:55]
v_mfma_f32_16x16x32_bf16 v[56:59], v[72:75], v[132:135], v[56:59]
v_mfma_f32_16x16x32_bf16 v[60:63], v[76:79], v[132:135], v[60:63]
v_mfma_f32_16x16x32_bf16 v[64:67], v[72:75], v[212:215], v[64:67]
v_mfma_f32_16x16x32_bf16 v[68:71], v[76:79], v[212:215], v[68:71]
ds_read_b128 v[72:75], v7 offset:12288
ds_read_b128 v[76:79], v7 offset:32768
s_waitcnt lgkmcnt(4)
v_mfma_f32_16x16x32_bf16 v[32:35], a[40:43], v[80:83], v[32:35]
v_mfma_f32_16x16x32_bf16 v[36:39], a[40:43], v[84:87], v[36:39]
v_mfma_f32_16x16x32_bf16 v[40:43], a[120:123], v[80:83], v[40:43]
v_mfma_f32_16x16x32_bf16 v[44:47], a[120:123], v[84:87], v[44:47]
v_mfma_f32_16x16x32_bf16 v[48:51], v[80:83], a[200:203], v[48:51]
v_mfma_f32_16x16x32_bf16 v[52:55], v[84:87], a[200:203], v[52:55]
v_mfma_f32_16x16x32_bf16 v[56:59], v[80:83], v[136:139], v[56:59]
v_mfma_f32_16x16x32_bf16 v[60:63], v[84:87], v[136:139], v[60:63]
v_mfma_f32_16x16x32_bf16 v[64:67], v[80:83], v[216:219], v[64:67]
v_mfma_f32_16x16x32_bf16 v[68:71], v[84:87], v[216:219], v[68:71]
ds_read_b128 v[80:83], v7 offset:13312
ds_read_b128 v[84:87], v7 offset:33792
s_waitcnt lgkmcnt(4)
v_mfma_f32_16x16x32_bf16 v[32:35], a[44:47], v[88:91], v[32:35]
v_mfma_f32_16x16x32_bf16 v[36:39], a[44:47], v[92:95], v[36:39]
v_mfma_f32_16x16x32_bf16 v[40:43], a[124:127], v[88:91], v[40:43]
v_mfma_f32_16x16x32_bf16 v[44:47], a[124:127], v[92:95], v[44:47]
v_mfma_f32_16x16x32_bf16 v[48:51], v[88:91], a[204:207], v[48:51]
v_mfma_f32_16x16x32_bf16 v[52:55], v[92:95], a[204:207], v[52:55]
v_mfma_f32_16x16x32_bf16 v[56:59], v[88:91], v[140:143], v[56:59]
v_mfma_f32_16x16x32_bf16 v[60:63], v[92:95], v[140:143], v[60:63]
v_mfma_f32_16x16x32_bf16 v[64:67], v[88:91], v[220:223], v[64:67]
v_mfma_f32_16x16x32_bf16 v[68:71], v[92:95], v[220:223], v[68:71]
ds_read_b128 v[88:91], v7 offset:14336
ds_read_b128 v[92:95], v7 offset:34816
s_waitcnt lgkmcnt(4)
v_mfma_f32_16x16x32_bf16 v[32:35], a[48:51], v[72:75], v[32:35]
v_mfma_f32_16x16x32_bf16 v[36:39], a[48:51], v[76:79], v[36:39]
v_mfma_f32_16x16x32_bf16 v[40:43], a[128:131], v[72:75], v[40:43]
v_mfma_f32_16x16x32_bf16 v[44:47], a[128:131], v[76:79], v[44:47]
v_mfma_f32_16x16x32_bf16 v[48:51], v[72:75], a[208:211], v[48:51]
v_mfma_f32_16x16x32_bf16 v[52:55], v[76:79], a[208:211], v[52:55]
v_mfma_f32_16x16x32_bf16 v[56:59], v[72:75], v[144:147], v[56:59]
v_mfma_f32_16x16x32_bf16 v[60:63], v[76:79], v[144:147], v[60:63]
v_mfma_f32_16x16x32_bf16 v[64:67], v[72:75], v[224:227], v[64:67]
v_mfma_f32_16x16x32_bf16 v[68:71], v[76:79], v[224:227], v[68:71]
ds_read_b128 v[72:75], v7 offset:15360
ds_read_b128 v[76:79], v7 offset:35840
s_waitcnt lgkmcnt(4)
v_mfma_f32_16x16x32_bf16 v[32:35], a[52:55], v[80:83], v[32:35]
v_mfma_f32_16x16x32_bf16 v[36:39], a[52:55], v[84:87], v[36:39]
v_mfma_f32_16x16x32_bf16 v[40:43], a[132:135], v[80:83], v[40:43]
v_mfma_f32_16x16x32_bf16 v[44:47], a[132:135], v[84:87], v[44:47]
v_mfma_f32_16x16x32_bf16 v[48:51], v[80:83], a[212:215], v[48:51]
v_mfma_f32_16x16x32_bf16 v[52:55], v[84:87], a[212:215], v[52:55]
v_mfma_f32_16x16x32_bf16 v[56:59], v[80:83], v[148:151], v[56:59]
v_mfma_f32_16x16x32_bf16 v[60:63], v[84:87], v[148:151], v[60:63]
v_mfma_f32_16x16x32_bf16 v[64:67], v[80:83], v[228:231], v[64:67]
v_mfma_f32_16x16x32_bf16 v[68:71], v[84:87], v[228:231], v[68:71]
ds_read_b128 v[80:83], v7 offset:16384
ds_read_b128 v[84:87], v7 offset:36864
s_waitcnt lgkmcnt(4)
v_mfma_f32_16x16x32_bf16 v[32:35], a[56:59], v[88:91], v[32:35]
v_mfma_f32_16x16x32_bf16 v[36:39], a[56:59], v[92:95], v[36:39]
v_mfma_f32_16x16x32_bf16 v[40:43], a[136:139], v[88:91], v[40:43]
v_mfma_f32_16x16x32_bf16 v[44:47], a[136:139], v[92:95], v[44:47]
v_mfma_f32_16x16x32_bf16 v[48:51], v[88:91], a[216:219], v[48:51]
v_mfma_f32_16x16x32_bf16 v[52:55], v[92:95], a[216:219], v[52:55]
v_mfma_f32_16x16x32_bf16 v[56:59], v[88:91], v[152:155], v[56:59]
v_mfma_f32_16x16x32_bf16 v[60:63], v[92:95], v[152:155], v[60:63]
v_mfma_f32_16x16x32_bf16 v[64:67], v[88:91], v[232:235], v[64:67]
v_mfma_f32_16x16x32_bf16 v[68:71], v[92:95], v[232:235], v[68:71]
ds_read_b128 v[88:91], v7 offset:17408
ds_read_b128 v[92:95], v7 offset:37888
s_waitcnt lgkmcnt(4)
v_mfma_f32_16x16x32_bf16 v[32:35], a[60:63], v[72:75], v[32:35]
v_mfma_f32_16x16x32_bf16 v[36:39], a[60:63], v[76:79], v[36:39]
v_mfma_f32_16x16x32_bf16 v[40:43], a[140:143], v[72:75], v[40:43]
v_mfma_f32_16x16x32_bf16 v[44:47], a[140:143], v[76:79], v[44:47]
v_mfma_f32_16x16x32_bf16 v[48:51], v[72:75], a[220:223], v[48:51]
v_mfma_f32_16x16x32_bf16 v[52:55], v[76:79], a[220:223], v[52:55]
v_mfma_f32_16x16x32_bf16 v[56:59], v[72:75], v[156:159], v[56:59]
v_mfma_f32_16x16x32_bf16 v[60:63], v[76:79], v[156:159], v[60:63]
v_mfma_f32_16x16x32_bf16 v[64:67], v[72:75], v[236:239], v[64:67]
v_mfma_f32_16x16x32_bf16 v[68:71], v[76:79], v[236:239], v[68:71]
ds_read_b128 v[72:75], v7 offset:18432
ds_read_b128 v[76:79], v7 offset:38912
s_waitcnt lgkmcnt(4)
v_mfma_f32_16x16x32_bf16 v[32:35], a[64:67], v[80:83], v[32:35]
v_mfma_f32_16x16x32_bf16 v[36:39], a[64:67], v[84:87], v[36:39]
v_mfma_f32_16x16x32_bf16 v[40:43], a[144:147], v[80:83], v[40:43]
v_mfma_f32_16x16x32_bf16 v[44:47], a[144:147], v[84:87], v[44:47]
v_mfma_f32_16x16x32_bf16 v[48:51], v[80:83], a[224:227], v[48:51]
v_mfma_f32_16x16x32_bf16 v[52:55], v[84:87], a[224:227], v[52:55]
v_mfma_f32_16x16x32_bf16 v[56:59], v[80:83], v[160:163], v[56:59]
v_mfma_f32_16x16x32_bf16 v[60:63], v[84:87], v[160:163], v[60:63]
v_mfma_f32_16x16x32_bf16 v[64:67], v[80:83], v[240:243], v[64:67]
v_mfma_f32_16x16x32_bf16 v[68:71], v[84:87], v[240:243], v[68:71]
ds_read_b128 v[80:83], v7 offset:19456
ds_read_b128 v[84:87], v7 offset:39936
s_waitcnt lgkmcnt(4)
v_mfma_f32_16x16x32_bf16 v[32:35], a[68:71], v[88:91], v[32:35]
v_mfma_f32_16x16x32_bf16 v[36:39], a[68:71], v[92:95], v[36:39]
v_mfma_f32_16x16x32_bf16 v[40:43], a[148:151], v[88:91], v[40:43]
v_mfma_f32_16x16x32_bf16 v[44:47], a[148:151], v[92:95], v[44:47]
v_mfma_f32_16x16x32_bf16 v[48:51], v[88:91], a[228:231], v[48:51]
v_mfma_f32_16x16x32_bf16 v[52:55], v[92:95], a[228:231], v[52:55]
v_mfma_f32_16x16x32_bf16 v[56:59], v[88:91], v[164:167], v[56:59]
v_mfma_f32_16x16x32_bf16 v[60:63], v[92:95], v[164:167], v[60:63]
v_mfma_f32_16x16x32_bf16 v[64:67], v[88:91], v[244:247], v[64:67]
v_mfma_f32_16x16x32_bf16 v[68:71], v[92:95], v[244:247], v[68:71]
s_waitcnt lgkmcnt(2)
v_mfma_f32_16x16x32_bf16 v[32:35], a[72:75], v[72:75], v[32:35]
v_mfma_f32_16x16x32_bf16 v[36:39], a[72:75], v[76:79], v[36:39]
v_mfma_f32_16x16x32_bf16 v[40:43], a[152:155], v[72:75], v[40:43]
v_mfma_f32_16x16x32_bf16 v[44:47], a[152:155], v[76:79], v[44:47]
v_mfma_f32_16x16x32_bf16 v[48:51], v[72:75], a[232:235], v[48:51]
v_mfma_f32_16x16x32_bf16 v[52:55], v[76:79], a[232:235], v[52:55]
v_mfma_f32_16x16x32_bf16 v[56:59], v[72:75], v[168:171], v[56:59]
v_mfma_f32_16x16x32_bf16 v[60:63], v[76:79], v[168:171], v[60:63]
v_mfma_f32_16x16x32_bf16 v[64:67], v[72:75], v[248:251], v[64:67]
v_mfma_f32_16x16x32_bf16 v[68:71], v[76:79], v[248:251], v[68:71]
s_waitcnt lgkmcnt(0)
v_mfma_f32_16x16x32_bf16 v[32:35], a[76:79], v[80:83], v[32:35]
v_mfma_f32_16x16x32_bf16 v[36:39], a[76:79], v[84:87], v[36:39]
v_mfma_f32_16x16x32_bf16 v[40:43], a[156:159], v[80:83], v[40:43]
v_mfma_f32_16x16x32_bf16 v[44:47], a[156:159], v[84:87], v[44:47]
v_mfma_f32_16x16x32_bf16 v[48:51], v[80:83], a[236:239], v[48:51]
v_mfma_f32_16x16x32_bf16 v[52:55], v[84:87], a[236:239], v[52:55]
v_mfma_f32_16x16x32_bf16 v[56:59], v[80:83], v[172:175], v[56:59]
v_mfma_f32_16x16x32_bf16 v[60:63], v[84:87], v[172:175], v[60:63]
v_mfma_f32_16x16x32_bf16 v[64:67], v[80:83], v[252:255], v[64:67]
v_mfma_f32_16x16x32_bf16 v[68:71], v[84:87], v[252:255], v[68:71]
v_cvt_pk_bf16_f32 v8, v32, v33
v_cvt_pk_bf16_f32 v9, v34, v35
v_cvt_pk_bf16_f32 v10, v40, v41
v_cvt_pk_bf16_f32 v11, v42, v43
s_add_u32 s34, s21, 2048
buffer_store_dwordx4 v[8:11], v1, s[4:7], s34 offen sc1
v_cvt_pk_bf16_f32 v12, v36, v37
v_cvt_pk_bf16_f32 v13, v38, v39
v_cvt_pk_bf16_f32 v14, v44, v45
v_cvt_pk_bf16_f32 v15, v46, v47
s_add_u32 s34, s21, 8192
buffer_store_dwordx4 v[12:15], v1, s[4:7], s34 offen sc1
v_cvt_pk_bf16_f32 v8, v48, v49
v_cvt_pk_bf16_f32 v9, v50, v51
v_cvt_pk_bf16_f32 v10, v52, v53
v_cvt_pk_bf16_f32 v11, v54, v55
s_add_u32 s34, s23, 1024
buffer_store_dwordx4 v[8:11], v1, s[4:7], s34 offen sc1
v_cvt_pk_bf16_f32 v12, v56, v57
v_cvt_pk_bf16_f32 v13, v58, v59
v_cvt_pk_bf16_f32 v14, v60, v61
v_cvt_pk_bf16_f32 v15, v62, v63
s_add_u32 s34, s23, 2048
buffer_store_dwordx4 v[12:15], v1, s[4:7], s34 offen sc1
v_cvt_pk_bf16_f32 v8, v64, v65
v_cvt_pk_bf16_f32 v9, v66, v67
v_cvt_pk_bf16_f32 v10, v68, v69
v_cvt_pk_bf16_f32 v11, v70, v71
s_add_u32 s34, s23, 3072
buffer_store_dwordx4 v[8:11], v1, s[4:7], s34 offen sc1
s_waitcnt vmcnt(0)
s_barrier
s_add_u32 s17, s17, 1
s_cmp_lt_u32 s17, 64
s_cbranch_scc1 reca_ptop251
s_branch reca_exit1
reca_pw2_228:
s_mov_b32 s17, 0
s_mov_b32 s26, 0
s_mul_i32 s20, s17, 40960
s_add_u32 s20, s20, 84955136
s_add_u32 m0, s26, 20480
s_nop 0
buffer_load_dwordx4 v1, s[4:7], s20 offen offset:0 lds
buffer_load_dwordx4 v1, s[4:7], s20 offen offset:1024 lds
buffer_load_dwordx4 v1, s[4:7], s20 offen offset:2048 lds
buffer_load_dwordx4 v1, s[4:7], s20 offen offset:3072 lds
s_add_u32 s20, s20, 4096
s_add_u32 m0, s26, 24576
s_nop 0
buffer_load_dwordx4 v1, s[4:7], s20 offen offset:0 lds
buffer_load_dwordx4 v1, s[4:7], s20 offen offset:1024 lds
buffer_load_dwordx4 v1, s[4:7], s20 offen offset:2048 lds
buffer_load_dwordx4 v1, s[4:7], s20 offen offset:3072 lds
s_add_u32 s20, s20, 4096
s_add_u32 m0, s26, 28672
s_nop 0
buffer_load_dwordx4 v1, s[4:7], s20 offen offset:0 lds
buffer_load_dwordx4 v1, s[4:7], s20 offen offset:1024 lds
s_mul_i32 s34, s15, 12
s_mul_i32 s35, s16, 6
s_add_u32 s34, s34, s35
s_add_u32 s34, s34, 0
s_mul_i32 s34, s34, 20480
s_add_u32 s34, s34, 6291456
buffer_load_dwordx4 a[0:3], v1, s[4:7], s34 offen offset:0
buffer_load_dwordx4 a[4:7], v1, s[4:7], s34 offen offset:1024
buffer_load_dwordx4 a[8:11], v1, s[4:7], s34 offen offset:2048
buffer_load_dwordx4 a[12:15], v1, s[4:7], s34 offen offset:3072
s_add_u32 s34, s34, 4096
buffer_load_dwordx4 a[16:19], v1, s[4:7], s34 offen offset:0
buffer_load_dwordx4 a[20:23], v1, s[4:7], s34 offen offset:1024
buffer_load_dwordx4 a[24:27], v1, s[4:7], s34 offen offset:2048
buffer_load_dwordx4 a[28:31], v1, s[4:7], s34 offen offset:3072
s_add_u32 s34, s34, 4096
buffer_load_dwordx4 a[32:35], v1, s[4:7], s34 offen offset:0
buffer_load_dwordx4 a[36:39], v1, s[4:7], s34 offen offset:1024
buffer_load_dwordx4 a[40:43], v1, s[4:7], s34 offen offset:2048
buffer_load_dwordx4 a[44:47], v1, s[4:7], s34 offen offset:3072
s_add_u32 s34, s34, 4096
buffer_load_dwordx4 a[48:51], v1, s[4:7], s34 offen offset:0
buffer_load_dwordx4 a[52:55], v1, s[4:7], s34 offen offset:1024
buffer_load_dwordx4 a[56:59], v1, s[4:7], s34 offen offset:2048
buffer_load_dwordx4 a[60:63], v1, s[4:7], s34 offen offset:3072
s_add_u32 s34, s34, 4096
buffer_load_dwordx4 a[64:67], v1, s[4:7], s34 offen offset:0
buffer_load_dwordx4 a[68:71], v1, s[4:7], s34 offen offset:1024
buffer_load_dwordx4 a[72:75], v1, s[4:7], s34 offen offset:2048
buffer_load_dwordx4 a[76:79], v1, s[4:7], s34 offen offset:3072
s_mul_i32 s34, s15, 12
s_mul_i32 s35, s16, 6
s_add_u32 s34, s34, s35
s_add_u32 s34, s34, 1
s_mul_i32 s34, s34, 20480
s_add_u32 s34, s34, 6291456
buffer_load_dwordx4 a[80:83], v1, s[4:7], s34 offen offset:0
buffer_load_dwordx4 a[84:87], v1, s[4:7], s34 offen offset:1024
buffer_load_dwordx4 a[88:91], v1, s[4:7], s34 offen offset:2048
buffer_load_dwordx4 a[92:95], v1, s[4:7], s34 offen offset:3072
s_add_u32 s34, s34, 4096
buffer_load_dwordx4 a[96:99], v1, s[4:7], s34 offen offset:0
buffer_load_dwordx4 a[100:103], v1, s[4:7], s34 offen offset:1024
buffer_load_dwordx4 a[104:107], v1, s[4:7], s34 offen offset:2048
buffer_load_dwordx4 a[108:111], v1, s[4:7], s34 offen offset:3072
s_add_u32 s34, s34, 4096
buffer_load_dwordx4 a[112:115], v1, s[4:7], s34 offen offset:0
buffer_load_dwordx4 a[116:119], v1, s[4:7], s34 offen offset:1024
buffer_load_dwordx4 a[120:123], v1, s[4:7], s34 offen offset:2048
buffer_load_dwordx4 a[124:127], v1, s[4:7], s34 offen offset:3072
s_add_u32 s34, s34, 4096
buffer_load_dwordx4 a[128:131], v1, s[4:7], s34 offen offset:0
buffer_load_dwordx4 a[132:135], v1, s[4:7], s34 offen offset:1024
buffer_load_dwordx4 a[136:139], v1, s[4:7], s34 offen offset:2048
buffer_load_dwordx4 a[140:143], v1, s[4:7], s34 offen offset:3072
s_add_u32 s34, s34, 4096
buffer_load_dwordx4 a[144:147], v1, s[4:7], s34 offen offset:0
buffer_load_dwordx4 a[148:151], v1, s[4:7], s34 offen offset:1024
buffer_load_dwordx4 a[152:155], v1, s[4:7], s34 offen offset:2048
buffer_load_dwordx4 a[156:159], v1, s[4:7], s34 offen offset:3072
s_waitcnt vmcnt(20)
s_mul_i32 s34, s15, 12
s_mul_i32 s35, s16, 6
s_add_u32 s34, s34, s35
s_add_u32 s34, s34, 4
s_mul_i32 s34, s34, 20480
s_add_u32 s34, s34, 22020096
buffer_load_dwordx4 a[160:163], v1, s[4:7], s34 offen offset:0
buffer_load_dwordx4 a[164:167], v1, s[4:7], s34 offen offset:1024
buffer_load_dwordx4 a[168:171], v1, s[4:7], s34 offen offset:2048
buffer_load_dwordx4 a[172:175], v1, s[4:7], s34 offen offset:3072
s_add_u32 s34, s34, 4096
buffer_load_dwordx4 a[176:179], v1, s[4:7], s34 offen offset:0
buffer_load_dwordx4 a[180:183], v1, s[4:7], s34 offen offset:1024
buffer_load_dwordx4 a[184:187], v1, s[4:7], s34 offen offset:2048
buffer_load_dwordx4 a[188:191], v1, s[4:7], s34 offen offset:3072
s_add_u32 s34, s34, 4096
buffer_load_dwordx4 a[192:195], v1, s[4:7], s34 offen offset:0
buffer_load_dwordx4 a[196:199], v1, s[4:7], s34 offen offset:1024
buffer_load_dwordx4 a[200:203], v1, s[4:7], s34 offen offset:2048
buffer_load_dwordx4 a[204:207], v1, s[4:7], s34 offen offset:3072
s_add_u32 s34, s34, 4096
buffer_load_dwordx4 a[208:211], v1, s[4:7], s34 offen offset:0
buffer_load_dwordx4 a[212:215], v1, s[4:7], s34 offen offset:1024
buffer_load_dwordx4 a[216:219], v1, s[4:7], s34 offen offset:2048
buffer_load_dwordx4 a[220:223], v1, s[4:7], s34 offen offset:3072
s_add_u32 s34, s34, 4096
buffer_load_dwordx4 a[224:227], v1, s[4:7], s34 offen offset:0
buffer_load_dwordx4 a[228:231], v1, s[4:7], s34 offen offset:1024
buffer_load_dwordx4 a[232:235], v1, s[4:7], s34 offen offset:2048
buffer_load_dwordx4 a[236:239], v1, s[4:7], s34 offen offset:3072
s_waitcnt vmcnt(20)
s_mul_i32 s34, s15, 12
s_mul_i32 s35, s16, 6
s_add_u32 s34, s34, s35
s_add_u32 s34, s34, 5
s_mul_i32 s34, s34, 20480
s_add_u32 s34, s34, 22020096
buffer_load_dwordx4 v[96:99], v1, s[4:7], s34 offen offset:0
buffer_load_dwordx4 v[100:103], v1, s[4:7], s34 offen offset:1024
buffer_load_dwordx4 v[104:107], v1, s[4:7], s34 offen offset:2048
buffer_load_dwordx4 v[108:111], v1, s[4:7], s34 offen offset:3072
s_add_u32 s34, s34, 4096
buffer_load_dwordx4 v[112:115], v1, s[4:7], s34 offen offset:0
buffer_load_dwordx4 v[116:119], v1, s[4:7], s34 offen offset:1024
buffer_load_dwordx4 v[120:123], v1, s[4:7], s34 offen offset:2048
buffer_load_dwordx4 v[124:127], v1, s[4:7], s34 offen offset:3072
s_add_u32 s34, s34, 4096
buffer_load_dwordx4 v[128:131], v1, s[4:7], s34 offen offset:0
buffer_load_dwordx4 v[132:135], v1, s[4:7], s34 offen offset:1024
buffer_load_dwordx4 v[136:139], v1, s[4:7], s34 offen offset:2048
buffer_load_dwordx4 v[140:143], v1, s[4:7], s34 offen offset:3072
s_add_u32 s34, s34, 4096
buffer_load_dwordx4 v[144:147], v1, s[4:7], s34 offen offset:0
buffer_load_dwordx4 v[148:151], v1, s[4:7], s34 offen offset:1024
buffer_load_dwordx4 v[152:155], v1, s[4:7], s34 offen offset:2048
buffer_load_dwordx4 v[156:159], v1, s[4:7], s34 offen offset:3072
s_add_u32 s34, s34, 4096
buffer_load_dwordx4 v[160:163], v1, s[4:7], s34 offen offset:0
buffer_load_dwordx4 v[164:167], v1, s[4:7], s34 offen offset:1024
buffer_load_dwordx4 v[168:171], v1, s[4:7], s34 offen offset:2048
buffer_load_dwordx4 v[172:175], v1, s[4:7], s34 offen offset:3072
s_waitcnt vmcnt(20)
v_and_b32 v30, 7, v0
v_lshlrev_b32 v30, 3, v30
reca_cens256:
buffer_load_dwordx2 v[28:29], v30, s[8:11], 0 offen sc1
s_waitcnt vmcnt(0)
v_sad_u8 v31, v28, 0, 0
v_sad_u8 v31, v29, 0, v31
v_cmp_gt_u32 vcc, 32, v31
s_cbranch_vccz reca_censok257
s_sleep 8
s_sub_u32 s18, s18, 1
s_cbranch_scc0 reca_cens256
s_mov_b32 s18, 0
reca_censok257:
v_and_b32 v28, 0x20202020, v28
v_and_b32 v29, 0x20202020, v29
v_cmp_ne_u32 s[34:35], 0, v28
v_cmp_ne_u32 s[36:37], 0, v29
s_nop 3
s_and_b32 s34, s34, 0xff
s_and_b32 s36, s36, 0xff
s_or_b32 s35, s34, s36
s_lshr_b32 s37, s35, s13
s_and_b32 s37, s37, 1
s_xor_b32 s43, s37, 1
s_cmp_eq_u32 s57, 0
s_cselect_b32 s58, s36, s34
v_mov_b32 v31, 0x80000000
s_cmp_lg_u32 s43, 0
s_cbranch_scc1 reca_pslow258
reca_ptop259:
s_cmp_lt_u32 s17, 3
s_cbranch_scc1 reca_pgo260
s_sub_u32 s36, s17, 3
reca_ppoll261:
buffer_load_dword v28, v4, s[4:7], s25 offen sc1
s_waitcnt vmcnt(0)
v_readfirstlane_b32 s34, v28
s_nop 3
s_cmp_ge_i32 s34, s36
s_cbranch_scc1 reca_pgo260
s_sleep 8
s_sub_u32 s18, s18, 1
s_cbranch_scc0 reca_ppoll261
s_mov_b32 s18, 0
reca_pgo260:
s_waitcnt vmcnt(0)
s_barrier
v_add_u32 v7, s26, v1
s_xor_b32 s26, s26, 40960
s_add_u32 s37, s17, 1
s_cmp_ge_u32 s37, 64
s_cbranch_scc1 reca_pnodma262
s_mul_i32 s20, s37, 40960
s_add_u32 s20, s20, 84955136
s_add_u32 m0, s26, 20480
s_nop 0
buffer_load_dwordx4 v1, s[4:7], s20 offen offset:0 lds
buffer_load_dwordx4 v1, s[4:7], s20 offen offset:1024 lds
buffer_load_dwordx4 v1, s[4:7], s20 offen offset:2048 lds
buffer_load_dwordx4 v1, s[4:7], s20 offen offset:3072 lds
s_add_u32 s20, s20, 4096
s_add_u32 m0, s26, 24576
s_nop 0
buffer_load_dwordx4 v1, s[4:7], s20 offen offset:0 lds
buffer_load_dwordx4 v1, s[4:7], s20 offen offset:1024 lds
buffer_load_dwordx4 v1, s[4:7], s20 offen offset:2048 lds
buffer_load_dwordx4 v1, s[4:7], s20 offen offset:3072 lds
s_add_u32 s20, s20, 4096
s_add_u32 m0, s26, 28672
s_nop 0
buffer_load_dwordx4 v1, s[4:7], s20 offen offset:0 lds
buffer_load_dwordx4 v1, s[4:7], s20 offen offset:1024 lds
reca_pnodma262:
s_lshl_b32 s34, s15, 3
s_and_b32 s35, s17, 7
s_add_u32 s34, s34, s35
s_mul_i32 s34, s34, 12288
s_mul_i32 s35, s16, 3072
s_add_u32 s35, s35, s34
s_add_u32 s21, s35, 37748736
s_add_u32 s22, s35, 44040192
s_mul_i32 s35, s16, 6144
s_add_u32 s35, s35, s34
s_add_u32 s23, s35, 40894464
ds_read_b128 v[72:75], v7 offset:0
ds_read_b128 v[76:79], v7 offset:20480
ds_read_b128 v[80:83], v7 offset:1024
ds_read_b128 v[84:87], v7 offset:21504
ds_read_b128 v[88:91], v7 offset:2048
ds_read_b128 v[92:95], v7 offset:22528
s_waitcnt lgkmcnt(4)
v_mfma_f32_16x16x32_bf16 v[32:35], a[0:3], v[72:75], 0
v_mfma_f32_16x16x32_bf16 v[36:39], a[0:3], v[76:79], 0
v_mfma_f32_16x16x32_bf16 v[40:43], a[80:83], v[72:75], 0
v_mfma_f32_16x16x32_bf16 v[44:47], a[80:83], v[76:79], 0
v_mfma_f32_16x16x32_bf16 v[48:51], v[72:75], a[160:163], 0
v_mfma_f32_16x16x32_bf16 v[52:55], v[76:79], a[160:163], 0
v_mfma_f32_16x16x32_bf16 v[56:59], v[72:75], v[96:99], 0
v_mfma_f32_16x16x32_bf16 v[60:63], v[76:79], v[96:99], 0
ds_read_b128 v[72:75], v7 offset:3072
ds_read_b128 v[76:79], v7 offset:23552
s_waitcnt lgkmcnt(4)
v_mfma_f32_16x16x32_bf16 v[32:35], a[4:7], v[80:83], v[32:35]
v_mfma_f32_16x16x32_bf16 v[36:39], a[4:7], v[84:87], v[36:39]
v_mfma_f32_16x16x32_bf16 v[40:43], a[84:87], v[80:83], v[40:43]
v_mfma_f32_16x16x32_bf16 v[44:47], a[84:87], v[84:87], v[44:47]
v_mfma_f32_16x16x32_bf16 v[48:51], v[80:83], a[164:167], v[48:51]
v_mfma_f32_16x16x32_bf16 v[52:55], v[84:87], a[164:167], v[52:55]
v_mfma_f32_16x16x32_bf16 v[56:59], v[80:83], v[100:103], v[56:59]
v_mfma_f32_16x16x32_bf16 v[60:63], v[84:87], v[100:103], v[60:63]
ds_read_b128 v[80:83], v7 offset:4096
ds_read_b128 v[84:87], v7 offset:24576
s_waitcnt lgkmcnt(4)
v_mfma_f32_16x16x32_bf16 v[32:35], a[8:11], v[88:91], v[32:35]
v_mfma_f32_16x16x32_bf16 v[36:39], a[8:11], v[92:95], v[36:39]
v_mfma_f32_16x16x32_bf16 v[40:43], a[88:91], v[88:91], v[40:43]
v_mfma_f32_16x16x32_bf16 v[44:47], a[88:91], v[92:95], v[44:47]
v_mfma_f32_16x16x32_bf16 v[48:51], v[88:91], a[168:171], v[48:51]
v_mfma_f32_16x16x32_bf16 v[52:55], v[92:95], a[168:171], v[52:55]
v_mfma_f32_16x16x32_bf16 v[56:59], v[88:91], v[104:107], v[56:59]
v_mfma_f32_16x16x32_bf16 v[60:63], v[92:95], v[104:107], v[60:63]
ds_read_b128 v[88:91], v7 offset:5120
ds_read_b128 v[92:95], v7 offset:25600
s_waitcnt lgkmcnt(4)
v_mfma_f32_16x16x32_bf16 v[32:35], a[12:15], v[72:75], v[32:35]
v_mfma_f32_16x16x32_bf16 v[36:39], a[12:15], v[76:79], v[36:39]
v_mfma_f32_16x16x32_bf16 v[40:43], a[92:95], v[72:75], v[40:43]
v_mfma_f32_16x16x32_bf16 v[44:47], a[92:95], v[76:79], v[44:47]
v_mfma_f32_16x16x32_bf16 v[48:51], v[72:75], a[172:175], v[48:51]
v_mfma_f32_16x16x32_bf16 v[52:55], v[76:79], a[172:175], v[52:55]
v_mfma_f32_16x16x32_bf16 v[56:59], v[72:75], v[108:111], v[56:59]
v_mfma_f32_16x16x32_bf16 v[60:63], v[76:79], v[108:111], v[60:63]
ds_read_b128 v[72:75], v7 offset:6144
ds_read_b128 v[76:79], v7 offset:26624
s_waitcnt lgkmcnt(4)
v_mfma_f32_16x16x32_bf16 v[32:35], a[16:19], v[80:83], v[32:35]
v_mfma_f32_16x16x32_bf16 v[36:39], a[16:19], v[84:87], v[36:39]
v_mfma_f32_16x16x32_bf16 v[40:43], a[96:99], v[80:83], v[40:43]
v_mfma_f32_16x16x32_bf16 v[44:47], a[96:99], v[84:87], v[44:47]
v_mfma_f32_16x16x32_bf16 v[48:51], v[80:83], a[176:179], v[48:51]
v_mfma_f32_16x16x32_bf16 v[52:55], v[84:87], a[176:179], v[52:55]
v_mfma_f32_16x16x32_bf16 v[56:59], v[80:83], v[112:115], v[56:59]
v_mfma_f32_16x16x32_bf16 v[60:63], v[84:87], v[112:115], v[60:63]
ds_read_b128 v[80:83], v7 offset:7168
ds_read_b128 v[84:87], v7 offset:27648
s_waitcnt lgkmcnt(4)
v_mfma_f32_16x16x32_bf16 v[32:35], a[20:23], v[88:91], v[32:35]
v_mfma_f32_16x16x32_bf16 v[36:39], a[20:23], v[92:95], v[36:39]
v_mfma_f32_16x16x32_bf16 v[40:43], a[100:103], v[88:91], v[40:43]
v_mfma_f32_16x16x32_bf16 v[44:47], a[100:103], v[92:95], v[44:47]
v_mfma_f32_16x16x32_bf16 v[48:51], v[88:91], a[180:183], v[48:51]
v_mfma_f32_16x16x32_bf16 v[52:55], v[92:95], a[180:183], v[52:55]
v_mfma_f32_16x16x32_bf16 v[56:59], v[88:91], v[116:119], v[56:59]
v_mfma_f32_16x16x32_bf16 v[60:63], v[92:95], v[116:119], v[60:63]
ds_read_b128 v[88:91], v7 offset:8192
ds_read_b128 v[92:95], v7 offset:28672
s_waitcnt lgkmcnt(4)
v_mfma_f32_16x16x32_bf16 v[32:35], a[24:27], v[72:75], v[32:35]
v_mfma_f32_16x16x32_bf16 v[36:39], a[24:27], v[76:79], v[36:39]
v_mfma_f32_16x16x32_bf16 v[40:43], a[104:107], v[72:75], v[40:43]
v_mfma_f32_16x16x32_bf16 v[44:47], a[104:107], v[76:79], v[44:47]
v_mfma_f32_16x16x32_bf16 v[48:51], v[72:75], a[184:187], v[48:51]
v_mfma_f32_16x16x32_bf16 v[52:55], v[76:79], a[184:187], v[52:55]
v_mfma_f32_16x16x32_bf16 v[56:59], v[72:75], v[120:123], v[56:59]
v_mfma_f32_16x16x32_bf16 v[60:63], v[76:79], v[120:123], v[60:63]
ds_read_b128 v[72:75], v7 offset:9216
ds_read_b128 v[76:79], v7 offset:29696
s_waitcnt lgkmcnt(4)
v_mfma_f32_16x16x32_bf16 v[32:35], a[28:31], v[80:83], v[32:35]
v_mfma_f32_16x16x32_bf16 v[36:39], a[28:31], v[84:87], v[36:39]
v_mfma_f32_16x16x32_bf16 v[40:43], a[108:111], v[80:83], v[40:43]
v_mfma_f32_16x16x32_bf16 v[44:47], a[108:111], v[84:87], v[44:47]
v_mfma_f32_16x16x32_bf16 v[48:51], v[80:83], a[188:191], v[48:51]
v_mfma_f32_16x16x32_bf16 v[52:55], v[84:87], a[188:191], v[52:55]
v_mfma_f32_16x16x32_bf16 v[56:59], v[80:83], v[124:127], v[56:59]
v_mfma_f32_16x16x32_bf16 v[60:63], v[84:87], v[124:127], v[60:63]
ds_read_b128 v[80:83], v7 offset:10240
ds_read_b128 v[84:87], v7 offset:30720
s_waitcnt lgkmcnt(4)
v_mfma_f32_16x16x32_bf16 v[32:35], a[32:35], v[88:91], v[32:35]
v_mfma_f32_16x16x32_bf16 v[36:39], a[32:35], v[92:95], v[36:39]
v_mfma_f32_16x16x32_bf16 v[40:43], a[112:115], v[88:91], v[40:43]
v_mfma_f32_16x16x32_bf16 v[44:47], a[112:115], v[92:95], v[44:47]
v_mfma_f32_16x16x32_bf16 v[48:51], v[88:91], a[192:195], v[48:51]
v_mfma_f32_16x16x32_bf16 v[52:55], v[92:95], a[192:195], v[52:55]
v_mfma_f32_16x16x32_bf16 v[56:59], v[88:91], v[128:131], v[56:59]
v_mfma_f32_16x16x32_bf16 v[60:63], v[92:95], v[128:131], v[60:63]
ds_read_b128 v[88:91], v7 offset:11264
ds_read_b128 v[92:95], v7 offset:31744
s_waitcnt lgkmcnt(4)
v_mfma_f32_16x16x32_bf16 v[32:35], a[36:39], v[72:75], v[32:35]
v_mfma_f32_16x16x32_bf16 v[36:39], a[36:39], v[76:79], v[36:39]
v_mfma_f32_16x16x32_bf16 v[40:43], a[116:119], v[72:75], v[40:43]
v_mfma_f32_16x16x32_bf16 v[44:47], a[116:119], v[76:79], v[44:47]
v_mfma_f32_16x16x32_bf16 v[48:51], v[72:75], a[196:199], v[48:51]
v_mfma_f32_16x16x32_bf16 v[52:55], v[76:79], a[196:199], v[52:55]
v_mfma_f32_16x16x32_bf16 v[56:59], v[72:75], v[132:135], v[56:59]
v_mfma_f32_16x16x32_bf16 v[60:63], v[76:79], v[132:135], v[60:63]
ds_read_b128 v[72:75], v7 offset:12288
ds_read_b128 v[76:79], v7 offset:32768
s_waitcnt lgkmcnt(4)
v_mfma_f32_16x16x32_bf16 v[32:35], a[40:43], v[80:83], v[32:35]
v_mfma_f32_16x16x32_bf16 v[36:39], a[40:43], v[84:87], v[36:39]
v_mfma_f32_16x16x32_bf16 v[40:43], a[120:123], v[80:83], v[40:43]
v_mfma_f32_16x16x32_bf16 v[44:47], a[120:123], v[84:87], v[44:47]
v_mfma_f32_16x16x32_bf16 v[48:51], v[80:83], a[200:203], v[48:51]
v_mfma_f32_16x16x32_bf16 v[52:55], v[84:87], a[200:203], v[52:55]
v_mfma_f32_16x16x32_bf16 v[56:59], v[80:83], v[136:139], v[56:59]
v_mfma_f32_16x16x32_bf16 v[60:63], v[84:87], v[136:139], v[60:63]
ds_read_b128 v[80:83], v7 offset:13312
ds_read_b128 v[84:87], v7 offset:33792
s_waitcnt lgkmcnt(4)
v_mfma_f32_16x16x32_bf16 v[32:35], a[44:47], v[88:91], v[32:35]
v_mfma_f32_16x16x32_bf16 v[36:39], a[44:47], v[92:95], v[36:39]
v_mfma_f32_16x16x32_bf16 v[40:43], a[124:127], v[88:91], v[40:43]
v_mfma_f32_16x16x32_bf16 v[44:47], a[124:127], v[92:95], v[44:47]
v_mfma_f32_16x16x32_bf16 v[48:51], v[88:91], a[204:207], v[48:51]
v_mfma_f32_16x16x32_bf16 v[52:55], v[92:95], a[204:207], v[52:55]
v_mfma_f32_16x16x32_bf16 v[56:59], v[88:91], v[140:143], v[56:59]
v_mfma_f32_16x16x32_bf16 v[60:63], v[92:95], v[140:143], v[60:63]
ds_read_b128 v[88:91], v7 offset:14336
ds_read_b128 v[92:95], v7 offset:34816
s_waitcnt lgkmcnt(4)
v_mfma_f32_16x16x32_bf16 v[32:35], a[48:51], v[72:75], v[32:35]
v_mfma_f32_16x16x32_bf16 v[36:39], a[48:51], v[76:79], v[36:39]
v_mfma_f32_16x16x32_bf16 v[40:43], a[128:131], v[72:75], v[40:43]
v_mfma_f32_16x16x32_bf16 v[44:47], a[128:131], v[76:79], v[44:47]
v_mfma_f32_16x16x32_bf16 v[48:51], v[72:75], a[208:211], v[48:51]
v_mfma_f32_16x16x32_bf16 v[52:55], v[76:79], a[208:211], v[52:55]
v_mfma_f32_16x16x32_bf16 v[56:59], v[72:75], v[144:147], v[56:59]
v_mfma_f32_16x16x32_bf16 v[60:63], v[76:79], v[144:147], v[60:63]
ds_read_b128 v[72:75], v7 offset:15360
ds_read_b128 v[76:79], v7 offset:35840
s_waitcnt lgkmcnt(4)
v_mfma_f32_16x16x32_bf16 v[32:35], a[52:55], v[80:83], v[32:35]
v_mfma_f32_16x16x32_bf16 v[36:39], a[52:55], v[84:87], v[36:39]
v_mfma_f32_16x16x32_bf16 v[40:43], a[132:135], v[80:83], v[40:43]
v_mfma_f32_16x16x32_bf16 v[44:47], a[132:135], v[84:87], v[44:47]
v_mfma_f32_16x16x32_bf16 v[48:51], v[80:83], a[212:215], v[48:51]
v_mfma_f32_16x16x32_bf16 v[52:55], v[84:87], a[212:215], v[52:55]
v_mfma_f32_16x16x32_bf16 v[56:59], v[80:83], v[148:151], v[56:59]
v_mfma_f32_16x16x32_bf16 v[60:63], v[84:87], v[148:151], v[60:63]
ds_read_b128 v[80:83], v7 offset:16384
ds_read_b128 v[84:87], v7 offset:36864
s_waitcnt lgkmcnt(4)
v_mfma_f32_16x16x32_bf16 v[32:35], a[56:59], v[88:91], v[32:35]
v_mfma_f32_16x16x32_bf16 v[36:39], a[56:59], v[92:95], v[36:39]
v_mfma_f32_16x16x32_bf16 v[40:43], a[136:139], v[88:91], v[40:43]
v_mfma_f32_16x16x32_bf16 v[44:47], a[136:139], v[92:95], v[44:47]
v_mfma_f32_16x16x32_bf16 v[48:51], v[88:91], a[216:219], v[48:51]
v_mfma_f32_16x16x32_bf16 v[52:55], v[92:95], a[216:219], v[52:55]
v_mfma_f32_16x16x32_bf16 v[56:59], v[88:91], v[152:155], v[56:59]
v_mfma_f32_16x16x32_bf16 v[60:63], v[92:95], v[152:155], v[60:63]
ds_read_b128 v[88:91], v7 offset:17408
ds_read_b128 v[92:95], v7 offset:37888
s_waitcnt lgkmcnt(4)
v_mfma_f32_16x16x32_bf16 v[32:35], a[60:63], v[72:75], v[32:35]
v_mfma_f32_16x16x32_bf16 v[36:39], a[60:63], v[76:79], v[36:39]
v_mfma_f32_16x16x32_bf16 v[40:43], a[140:143], v[72:75], v[40:43]
v_mfma_f32_16x16x32_bf16 v[44:47], a[140:143], v[76:79], v[44:47]
v_mfma_f32_16x16x32_bf16 v[48:51], v[72:75], a[220:223], v[48:51]
v_mfma_f32_16x16x32_bf16 v[52:55], v[76:79], a[220:223], v[52:55]
v_mfma_f32_16x16x32_bf16 v[56:59], v[72:75], v[156:159], v[56:59]
v_mfma_f32_16x16x32_bf16 v[60:63], v[76:79], v[156:159], v[60:63]
ds_read_b128 v[72:75], v7 offset:18432
ds_read_b128 v[76:79], v7 offset:38912
s_waitcnt lgkmcnt(4)
v_mfma_f32_16x16x32_bf16 v[32:35], a[64:67], v[80:83], v[32:35]
v_mfma_f32_16x16x32_bf16 v[36:39], a[64:67], v[84:87], v[36:39]
v_mfma_f32_16x16x32_bf16 v[40:43], a[144:147], v[80:83], v[40:43]
v_mfma_f32_16x16x32_bf16 v[44:47], a[144:147], v[84:87], v[44:47]
v_mfma_f32_16x16x32_bf16 v[48:51], v[80:83], a[224:227], v[48:51]
v_mfma_f32_16x16x32_bf16 v[52:55], v[84:87], a[224:227], v[52:55]
v_mfma_f32_16x16x32_bf16 v[56:59], v[80:83], v[160:163], v[56:59]
v_mfma_f32_16x16x32_bf16 v[60:63], v[84:87], v[160:163], v[60:63]
ds_read_b128 v[80:83], v7 offset:19456
ds_read_b128 v[84:87], v7 offset:39936
s_waitcnt lgkmcnt(4)
v_mfma_f32_16x16x32_bf16 v[32:35], a[68:71], v[88:91], v[32:35]
v_mfma_f32_16x16x32_bf16 v[36:39], a[68:71], v[92:95], v[36:39]
v_mfma_f32_16x16x32_bf16 v[40:43], a[148:151], v[88:91], v[40:43]
v_mfma_f32_16x16x32_bf16 v[44:47], a[148:151], v[92:95], v[44:47]
v_mfma_f32_16x16x32_bf16 v[48:51], v[88:91], a[228:231], v[48:51]
v_mfma_f32_16x16x32_bf16 v[52:55], v[92:95], a[228:231], v[52:55]
v_mfma_f32_16x16x32_bf16 v[56:59], v[88:91], v[164:167], v[56:59]
v_mfma_f32_16x16x32_bf16 v[60:63], v[92:95], v[164:167], v[60:63]
s_waitcnt lgkmcnt(2)
v_mfma_f32_16x16x32_bf16 v[32:35], a[72:75], v[72:75], v[32:35]
v_mfma_f32_16x16x32_bf16 v[36:39], a[72:75], v[76:79], v[36:39]
v_mfma_f32_16x16x32_bf16 v[40:43], a[152:155], v[72:75], v[40:43]
v_mfma_f32_16x16x32_bf16 v[44:47], a[152:155], v[76:79], v[44:47]
v_mfma_f32_16x16x32_bf16 v[48:51], v[72:75], a[232:235], v[48:51]
v_mfma_f32_16x16x32_bf16 v[52:55], v[76:79], a[232:235], v[52:55]
v_mfma_f32_16x16x32_bf16 v[56:59], v[72:75], v[168:171], v[56:59]
v_mfma_f32_16x16x32_bf16 v[60:63], v[76:79], v[168:171], v[60:63]
s_waitcnt lgkmcnt(0)
v_mfma_f32_16x16x32_bf16 v[32:35], a[76:79], v[80:83], v[32:35]
v_mfma_f32_16x16x32_bf16 v[36:39], a[76:79], v[84:87], v[36:39]
v_mfma_f32_16x16x32_bf16 v[40:43], a[156:159], v[80:83], v[40:43]
v_mfma_f32_16x16x32_bf16 v[44:47], a[156:159], v[84:87], v[44:47]
v_mfma_f32_16x16x32_bf16 v[48:51], v[80:83], a[236:239], v[48:51]
v_mfma_f32_16x16x32_bf16 v[52:55], v[84:87], a[236:239], v[52:55]
v_mfma_f32_16x16x32_bf16 v[56:59], v[80:83], v[172:175], v[56:59]
v_mfma_f32_16x16x32_bf16 v[60:63], v[84:87], v[172:175], v[60:63]
s_nop 0
v_cvt_pk_bf16_f32 v8, v32, v33
v_cvt_pk_bf16_f32 v9, v34, v35
v_cvt_pk_bf16_f32 v10, v40, v41
v_cvt_pk_bf16_f32 v11, v42, v43
s_add_u32 s34, s22, 0
buffer_store_dwordx4 v[8:11], v1, s[4:7], s34 offen
v_cvt_pk_bf16_f32 v12, v36, v37
v_cvt_pk_bf16_f32 v13, v38, v39
v_cvt_pk_bf16_f32 v14, v44, v45
v_cvt_pk_bf16_f32 v15, v46, v47
s_add_u32 s34, s22, 6144
buffer_store_dwordx4 v[12:15], v1, s[4:7], s34 offen
v_cvt_pk_bf16_f32 v8, v48, v49
v_cvt_pk_bf16_f32 v9, v50, v51
v_cvt_pk_bf16_f32 v10, v52, v53
v_cvt_pk_bf16_f32 v11, v54, v55
s_add_u32 s34, s23, 4096
buffer_store_dwordx4 v[8:11], v1, s[4:7], s34 offen
v_cvt_pk_bf16_f32 v12, v56, v57
v_cvt_pk_bf16_f32 v13, v58, v59
v_cvt_pk_bf16_f32 v14, v60, v61
v_cvt_pk_bf16_f32 v15, v62, v63
s_add_u32 s34, s23, 5120
buffer_store_dwordx4 v[12:15], v1, s[4:7], s34 offen
s_waitcnt vmcnt(0)
s_barrier
s_add_u32 s17, s17, 1
s_cmp_lt_u32 s17, 64
s_cbranch_scc1 reca_ptop259
s_branch reca_exit1
reca_pslow258:
reca_ptop264:
s_cmp_lt_u32 s17, 3
s_cbranch_scc1 reca_pgo265
s_sub_u32 s36, s17, 3
reca_ppoll266:
buffer_load_dword v28, v4, s[4:7], s25 offen sc1
s_waitcnt vmcnt(0)
v_readfirstlane_b32 s34, v28
s_nop 3
s_cmp_ge_i32 s34, s36
s_cbranch_scc1 reca_pgo265
s_sleep 8
s_sub_u32 s18, s18, 1
s_cbranch_scc0 reca_ppoll266
s_mov_b32 s18, 0
reca_pgo265:
s_waitcnt vmcnt(0)
s_barrier
v_add_u32 v7, s26, v1
s_xor_b32 s26, s26, 40960
s_add_u32 s37, s17, 1
s_cmp_ge_u32 s37, 64
s_cbranch_scc1 reca_pnodma267
s_mul_i32 s20, s37, 40960
s_add_u32 s20, s20, 84955136
s_add_u32 m0, s26, 20480
s_nop 0
buffer_load_dwordx4 v1, s[4:7], s20 offen offset:0 lds
buffer_load_dwordx4 v1, s[4:7], s20 offen offset:1024 lds
buffer_load_dwordx4 v1, s[4:7], s20 offen offset:2048 lds
buffer_load_dwordx4 v1, s[4:7], s20 offen offset:3072 lds
s_add_u32 s20, s20, 4096
s_add_u32 m0, s26, 24576
s_nop 0
buffer_load_dwordx4 v1, s[4:7], s20 offen offset:0 lds
buffer_load_dwordx4 v1, s[4:7], s20 offen offset:1024 lds
buffer_load_dwordx4 v1, s[4:7], s20 offen offset:2048 lds
buffer_load_dwordx4 v1, s[4:7], s20 offen offset:3072 lds
s_add_u32 s20, s20, 4096
s_add_u32 m0, s26, 28672
s_nop 0
buffer_load_dwordx4 v1, s[4:7], s20 offen offset:0 lds
buffer_load_dwordx4 v1, s[4:7], s20 offen offset:1024 lds
reca_pnodma267:
s_lshl_b32 s34, s15, 3
s_and_b32 s35, s17, 7
s_add_u32 s34, s34, s35
s_mul_i32 s34, s34, 12288
s_mul_i32 s35, s16, 3072
s_add_u32 s35, s35, s34
s_add_u32 s21, s35, 37748736
s_add_u32 s22, s35, 44040192
s_mul_i32 s35, s16, 6144
s_add_u32 s35, s35, s34
s_add_u32 s23, s35, 40894464
ds_read_b128 v[72:75], v7 offset:0
ds_read_b128 v[76:79], v7 offset:20480
ds_read_b128 v[80:83], v7 offset:1024
ds_read_b128 v[84:87], v7 offset:21504
ds_read_b128 v[88:91], v7 offset:2048
ds_read_b128 v[92:95], v7 offset:22528
s_waitcnt lgkmcnt(4)
v_mfma_f32_16x16x32_bf16 v[32:35], a[0:3], v[72:75], 0
v_mfma_f32_16x16x32_bf16 v[36:39], a[0:3], v[76:79], 0
v_mfma_f32_16x16x32_bf16 v[40:43], a[80:83], v[72:75], 0
v_mfma_f32_16x16x32_bf16 v[44:47], a[80:83], v[76:79], 0
v_mfma_f32_16x16x32_bf16 v[48:51], v[72:75], a[160:163], 0
v_mfma_f32_16x16x32_bf16 v[52:55], v[76:79], a[160:163], 0
v_mfma_f32_16x16x32_bf16 v[56:59], v[72:75], v[96:99], 0
v_mfma_f32_16x16x32_bf16 v[60:63], v[76:79], v[96:99], 0
ds_read_b128 v[72:75], v7 offset:3072
ds_read_b128 v[76:79], v7 offset:23552
s_waitcnt lgkmcnt(4)
v_mfma_f32_16x16x32_bf16 v[32:35], a[4:7], v[80:83], v[32:35]
v_mfma_f32_16x16x32_bf16 v[36:39], a[4:7], v[84:87], v[36:39]
v_mfma_f32_16x16x32_bf16 v[40:43], a[84:87], v[80:83], v[40:43]
v_mfma_f32_16x16x32_bf16 v[44:47], a[84:87], v[84:87], v[44:47]
v_mfma_f32_16x16x32_bf16 v[48:51], v[80:83], a[164:167], v[48:51]
v_mfma_f32_16x16x32_bf16 v[52:55], v[84:87], a[164:167], v[52:55]
v_mfma_f32_16x16x32_bf16 v[56:59], v[80:83], v[100:103], v[56:59]
v_mfma_f32_16x16x32_bf16 v[60:63], v[84:87], v[100:103], v[60:63]
ds_read_b128 v[80:83], v7 offset:4096
ds_read_b128 v[84:87], v7 offset:24576
s_waitcnt lgkmcnt(4)
v_mfma_f32_16x16x32_bf16 v[32:35], a[8:11], v[88:91], v[32:35]
v_mfma_f32_16x16x32_bf16 v[36:39], a[8:11], v[92:95], v[36:39]
v_mfma_f32_16x16x32_bf16 v[40:43], a[88:91], v[88:91], v[40:43]
v_mfma_f32_16x16x32_bf16 v[44:47], a[88:91], v[92:95], v[44:47]
v_mfma_f32_16x16x32_bf16 v[48:51], v[88:91], a[168:171], v[48:51]
v_mfma_f32_16x16x32_bf16 v[52:55], v[92:95], a[168:171], v[52:55]
v_mfma_f32_16x16x32_bf16 v[56:59], v[88:91], v[104:107], v[56:59]
v_mfma_f32_16x16x32_bf16 v[60:63], v[92:95], v[104:107], v[60:63]
ds_read_b128 v[88:91], v7 offset:5120
ds_read_b128 v[92:95], v7 offset:25600
s_waitcnt lgkmcnt(4)
v_mfma_f32_16x16x32_bf16 v[32:35], a[12:15], v[72:75], v[32:35]
v_mfma_f32_16x16x32_bf16 v[36:39], a[12:15], v[76:79], v[36:39]
v_mfma_f32_16x16x32_bf16 v[40:43], a[92:95], v[72:75], v[40:43]
v_mfma_f32_16x16x32_bf16 v[44:47], a[92:95], v[76:79], v[44:47]
v_mfma_f32_16x16x32_bf16 v[48:51], v[72:75], a[172:175], v[48:51]
v_mfma_f32_16x16x32_bf16 v[52:55], v[76:79], a[172:175], v[52:55]
v_mfma_f32_16x16x32_bf16 v[56:59], v[72:75], v[108:111], v[56:59]
v_mfma_f32_16x16x32_bf16 v[60:63], v[76:79], v[108:111], v[60:63]
ds_read_b128 v[72:75], v7 offset:6144
ds_read_b128 v[76:79], v7 offset:26624
s_waitcnt lgkmcnt(4)
v_mfma_f32_16x16x32_bf16 v[32:35], a[16:19], v[80:83], v[32:35]
v_mfma_f32_16x16x32_bf16 v[36:39], a[16:19], v[84:87], v[36:39]
v_mfma_f32_16x16x32_bf16 v[40:43], a[96:99], v[80:83], v[40:43]
v_mfma_f32_16x16x32_bf16 v[44:47], a[96:99], v[84:87], v[44:47]
v_mfma_f32_16x16x32_bf16 v[48:51], v[80:83], a[176:179], v[48:51]
v_mfma_f32_16x16x32_bf16 v[52:55], v[84:87], a[176:179], v[52:55]
v_mfma_f32_16x16x32_bf16 v[56:59], v[80:83], v[112:115], v[56:59]
v_mfma_f32_16x16x32_bf16 v[60:63], v[84:87], v[112:115], v[60:63]
ds_read_b128 v[80:83], v7 offset:7168
ds_read_b128 v[84:87], v7 offset:27648
s_waitcnt lgkmcnt(4)
v_mfma_f32_16x16x32_bf16 v[32:35], a[20:23], v[88:91], v[32:35]
v_mfma_f32_16x16x32_bf16 v[36:39], a[20:23], v[92:95], v[36:39]
v_mfma_f32_16x16x32_bf16 v[40:43], a[100:103], v[88:91], v[40:43]
v_mfma_f32_16x16x32_bf16 v[44:47], a[100:103], v[92:95], v[44:47]
v_mfma_f32_16x16x32_bf16 v[48:51], v[88:91], a[180:183], v[48:51]
v_mfma_f32_16x16x32_bf16 v[52:55], v[92:95], a[180:183], v[52:55]
v_mfma_f32_16x16x32_bf16 v[56:59], v[88:91], v[116:119], v[56:59]
v_mfma_f32_16x16x32_bf16 v[60:63], v[92:95], v[116:119], v[60:63]
ds_read_b128 v[88:91], v7 offset:8192
ds_read_b128 v[92:95], v7 offset:28672
s_waitcnt lgkmcnt(4)
v_mfma_f32_16x16x32_bf16 v[32:35], a[24:27], v[72:75], v[32:35]
v_mfma_f32_16x16x32_bf16 v[36:39], a[24:27], v[76:79], v[36:39]
v_mfma_f32_16x16x32_bf16 v[40:43], a[104:107], v[72:75], v[40:43]
v_mfma_f32_16x16x32_bf16 v[44:47], a[104:107], v[76:79], v[44:47]
v_mfma_f32_16x16x32_bf16 v[48:51], v[72:75], a[184:187], v[48:51]
v_mfma_f32_16x16x32_bf16 v[52:55], v[76:79], a[184:187], v[52:55]
v_mfma_f32_16x16x32_bf16 v[56:59], v[72:75], v[120:123], v[56:59]
v_mfma_f32_16x16x32_bf16 v[60:63], v[76:79], v[120:123], v[60:63]
ds_read_b128 v[72:75], v7 offset:9216
ds_read_b128 v[76:79], v7 offset:29696
s_waitcnt lgkmcnt(4)
v_mfma_f32_16x16x32_bf16 v[32:35], a[28:31], v[80:83], v[32:35]
v_mfma_f32_16x16x32_bf16 v[36:39], a[28:31], v[84:87], v[36:39]
v_mfma_f32_16x16x32_bf16 v[40:43], a[108:111], v[80:83], v[40:43]
v_mfma_f32_16x16x32_bf16 v[44:47], a[108:111], v[84:87], v[44:47]
v_mfma_f32_16x16x32_bf16 v[48:51], v[80:83], a[188:191], v[48:51]
v_mfma_f32_16x16x32_bf16 v[52:55], v[84:87], a[188:191], v[52:55]
v_mfma_f32_16x16x32_bf16 v[56:59], v[80:83], v[124:127], v[56:59]
v_mfma_f32_16x16x32_bf16 v[60:63], v[84:87], v[124:127], v[60:63]
ds_read_b128 v[80:83], v7 offset:10240
ds_read_b128 v[84:87], v7 offset:30720
s_waitcnt lgkmcnt(4)
v_mfma_f32_16x16x32_bf16 v[32:35], a[32:35], v[88:91], v[32:35]
v_mfma_f32_16x16x32_bf16 v[36:39], a[32:35], v[92:95], v[36:39]
v_mfma_f32_16x16x32_bf16 v[40:43], a[112:115], v[88:91], v[40:43]
v_mfma_f32_16x16x32_bf16 v[44:47], a[112:115], v[92:95], v[44:47]
v_mfma_f32_16x16x32_bf16 v[48:51], v[88:91], a[192:195], v[48:51]
v_mfma_f32_16x16x32_bf16 v[52:55], v[92:95], a[192:195], v[52:55]
v_mfma_f32_16x16x32_bf16 v[56:59], v[88:91], v[128:131], v[56:59]
v_mfma_f32_16x16x32_bf16 v[60:63], v[92:95], v[128:131], v[60:63]
ds_read_b128 v[88:91], v7 offset:11264
ds_read_b128 v[92:95], v7 offset:31744
s_waitcnt lgkmcnt(4)
v_mfma_f32_16x16x32_bf16 v[32:35], a[36:39], v[72:75], v[32:35]
v_mfma_f32_16x16x32_bf16 v[36:39], a[36:39], v[76:79], v[36:39]
v_mfma_f32_16x16x32_bf16 v[40:43], a[116:119], v[72:75], v[40:43]
v_mfma_f32_16x16x32_bf16 v[44:47], a[116:119], v[76:79], v[44:47]
v_mfma_f32_16x16x32_bf16 v[48:51], v[72:75], a[196:199], v[48:51]
v_mfma_f32_16x16x32_bf16 v[52:55], v[76:79], a[196:199], v[52:55]
v_mfma_f32_16x16x32_bf16 v[56:59], v[72:75], v[132:135], v[56:59]
v_mfma_f32_16x16x32_bf16 v[60:63], v[76:79], v[132:135], v[60:63]
ds_read_b128 v[72:75], v7 offset:12288
ds_read_b128 v[76:79], v7 offset:32768
s_waitcnt lgkmcnt(4)
v_mfma_f32_16x16x32_bf16 v[32:35], a[40:43], v[80:83], v[32:35]
v_mfma_f32_16x16x32_bf16 v[36:39], a[40:43], v[84:87], v[36:39]
v_mfma_f32_16x16x32_bf16 v[40:43], a[120:123], v[80:83], v[40:43]
v_mfma_f32_16x16x32_bf16 v[44:47], a[120:123], v[84:87], v[44:47]
v_mfma_f32_16x16x32_bf16 v[48:51], v[80:83], a[200:203], v[48:51]
v_mfma_f32_16x16x32_bf16 v[52:55], v[84:87], a[200:203], v[52:55]
v_mfma_f32_16x16x32_bf16 v[56:59], v[80:83], v[136:139], v[56:59]
v_mfma_f32_16x16x32_bf16 v[60:63], v[84:87], v[136:139], v[60:63]
ds_read_b128 v[80:83], v7 offset:13312
ds_read_b128 v[84:87], v7 offset:33792
s_waitcnt lgkmcnt(4)
v_mfma_f32_16x16x32_bf16 v[32:35], a[44:47], v[88:91], v[32:35]
v_mfma_f32_16x16x32_bf16 v[36:39], a[44:47], v[92:95], v[36:39]
v_mfma_f32_16x16x32_bf16 v[40:43], a[124:127], v[88:91], v[40:43]
v_mfma_f32_16x16x32_bf16 v[44:47], a[124:127], v[92:95], v[44:47]
v_mfma_f32_16x16x32_bf16 v[48:51], v[88:91], a[204:207], v[48:51]
v_mfma_f32_16x16x32_bf16 v[52:55], v[92:95], a[204:207], v[52:55]
v_mfma_f32_16x16x32_bf16 v[56:59], v[88:91], v[140:143], v[56:59]
v_mfma_f32_16x16x32_bf16 v[60:63], v[92:95], v[140:143], v[60:63]
ds_read_b128 v[88:91], v7 offset:14336
ds_read_b128 v[92:95], v7 offset:34816
s_waitcnt lgkmcnt(4)
v_mfma_f32_16x16x32_bf16 v[32:35], a[48:51], v[72:75], v[32:35]
v_mfma_f32_16x16x32_bf16 v[36:39], a[48:51], v[76:79], v[36:39]
v_mfma_f32_16x16x32_bf16 v[40:43], a[128:131], v[72:75], v[40:43]
v_mfma_f32_16x16x32_bf16 v[44:47], a[128:131], v[76:79], v[44:47]
v_mfma_f32_16x16x32_bf16 v[48:51], v[72:75], a[208:211], v[48:51]
v_mfma_f32_16x16x32_bf16 v[52:55], v[76:79], a[208:211], v[52:55]
v_mfma_f32_16x16x32_bf16 v[56:59], v[72:75], v[144:147], v[56:59]
v_mfma_f32_16x16x32_bf16 v[60:63], v[76:79], v[144:147], v[60:63]
ds_read_b128 v[72:75], v7 offset:15360
ds_read_b128 v[76:79], v7 offset:35840
s_waitcnt lgkmcnt(4)
v_mfma_f32_16x16x32_bf16 v[32:35], a[52:55], v[80:83], v[32:35]
v_mfma_f32_16x16x32_bf16 v[36:39], a[52:55], v[84:87], v[36:39]
v_mfma_f32_16x16x32_bf16 v[40:43], a[132:135], v[80:83], v[40:43]
v_mfma_f32_16x16x32_bf16 v[44:47], a[132:135], v[84:87], v[44:47]
v_mfma_f32_16x16x32_bf16 v[48:51], v[80:83], a[212:215], v[48:51]
v_mfma_f32_16x16x32_bf16 v[52:55], v[84:87], a[212:215], v[52:55]
v_mfma_f32_16x16x32_bf16 v[56:59], v[80:83], v[148:151], v[56:59]
v_mfma_f32_16x16x32_bf16 v[60:63], v[84:87], v[148:151], v[60:63]
ds_read_b128 v[80:83], v7 offset:16384
ds_read_b128 v[84:87], v7 offset:36864
s_waitcnt lgkmcnt(4)
v_mfma_f32_16x16x32_bf16 v[32:35], a[56:59], v[88:91], v[32:35]
v_mfma_f32_16x16x32_bf16 v[36:39], a[56:59], v[92:95], v[36:39]
v_mfma_f32_16x16x32_bf16 v[40:43], a[136:139], v[88:91], v[40:43]
v_mfma_f32_16x16x32_bf16 v[44:47], a[136:139], v[92:95], v[44:47]
v_mfma_f32_16x16x32_bf16 v[48:51], v[88:91], a[216:219], v[48:51]
v_mfma_f32_16x16x32_bf16 v[52:55], v[92:95], a[216:219], v[52:55]
v_mfma_f32_16x16x32_bf16 v[56:59], v[88:91], v[152:155], v[56:59]
v_mfma_f32_16x16x32_bf16 v[60:63], v[92:95], v[152:155], v[60:63]
ds_read_b128 v[88:91], v7 offset:17408
ds_read_b128 v[92:95], v7 offset:37888
s_waitcnt lgkmcnt(4)
v_mfma_f32_16x16x32_bf16 v[32:35], a[60:63], v[72:75], v[32:35]
v_mfma_f32_16x16x32_bf16 v[36:39], a[60:63], v[76:79], v[36:39]
v_mfma_f32_16x16x32_bf16 v[40:43], a[140:143], v[72:75], v[40:43]
v_mfma_f32_16x16x32_bf16 v[44:47], a[140:143], v[76:79], v[44:47]
v_mfma_f32_16x16x32_bf16 v[48:51], v[72:75], a[220:223], v[48:51]
v_mfma_f32_16x16x32_bf16 v[52:55], v[76:79], a[220:223], v[52:55]
v_mfma_f32_16x16x32_bf16 v[56:59], v[72:75], v[156:159], v[56:59]
v_mfma_f32_16x16x32_bf16 v[60:63], v[76:79], v[156:159], v[60:63]
ds_read_b128 v[72:75], v7 offset:18432
ds_read_b128 v[76:79], v7 offset:38912
s_waitcnt lgkmcnt(4)
v_mfma_f32_16x16x32_bf16 v[32:35], a[64:67], v[80:83], v[32:35]
v_mfma_f32_16x16x32_bf16 v[36:39], a[64:67], v[84:87], v[36:39]
v_mfma_f32_16x16x32_bf16 v[40:43], a[144:147], v[80:83], v[40:43]
v_mfma_f32_16x16x32_bf16 v[44:47], a[144:147], v[84:87], v[44:47]
v_mfma_f32_16x16x32_bf16 v[48:51], v[80:83], a[224:227], v[48:51]
v_mfma_f32_16x16x32_bf16 v[52:55], v[84:87], a[224:227], v[52:55]
v_mfma_f32_16x16x32_bf16 v[56:59], v[80:83], v[160:163], v[56:59]
v_mfma_f32_16x16x32_bf16 v[60:63], v[84:87], v[160:163], v[60:63]
ds_read_b128 v[80:83], v7 offset:19456
ds_read_b128 v[84:87], v7 offset:39936
s_waitcnt lgkmcnt(4)
v_mfma_f32_16x16x32_bf16 v[32:35], a[68:71], v[88:91], v[32:35]
v_mfma_f32_16x16x32_bf16 v[36:39], a[68:71], v[92:95], v[36:39]
v_mfma_f32_16x16x32_bf16 v[40:43], a[148:151], v[88:91], v[40:43]
v_mfma_f32_16x16x32_bf16 v[44:47], a[148:151], v[92:95], v[44:47]
v_mfma_f32_16x16x32_bf16 v[48:51], v[88:91], a[228:231], v[48:51]
v_mfma_f32_16x16x32_bf16 v[52:55], v[92:95], a[228:231], v[52:55]
v_mfma_f32_16x16x32_bf16 v[56:59], v[88:91], v[164:167], v[56:59]
v_mfma_f32_16x16x32_bf16 v[60:63], v[92:95], v[164:167], v[60:63]
s_waitcnt lgkmcnt(2)
v_mfma_f32_16x16x32_bf16 v[32:35], a[72:75], v[72:75], v[32:35]
v_mfma_f32_16x16x32_bf16 v[36:39], a[72:75], v[76:79], v[36:39]
v_mfma_f32_16x16x32_bf16 v[40:43], a[152:155], v[72:75], v[40:43]
v_mfma_f32_16x16x32_bf16 v[44:47], a[152:155], v[76:79], v[44:47]
v_mfma_f32_16x16x32_bf16 v[48:51], v[72:75], a[232:235], v[48:51]
v_mfma_f32_16x16x32_bf16 v[52:55], v[76:79], a[232:235], v[52:55]
v_mfma_f32_16x16x32_bf16 v[56:59], v[72:75], v[168:171], v[56:59]
v_mfma_f32_16x16x32_bf16 v[60:63], v[76:79], v[168:171], v[60:63]
s_waitcnt lgkmcnt(0)
v_mfma_f32_16x16x32_bf16 v[32:35], a[76:79], v[80:83], v[32:35]
v_mfma_f32_16x16x32_bf16 v[36:39], a[76:79], v[84:87], v[36:39]
v_mfma_f32_16x16x32_bf16 v[40:43], a[156:159], v[80:83], v[40:43]
v_mfma_f32_16x16x32_bf16 v[44:47], a[156:159], v[84:87], v[44:47]
v_mfma_f32_16x16x32_bf16 v[48:51], v[80:83], a[236:239], v[48:51]
v_mfma_f32_16x16x32_bf16 v[52:55], v[84:87], a[236:239], v[52:55]
v_mfma_f32_16x16x32_bf16 v[56:59], v[80:83], v[172:175], v[56:59]
v_mfma_f32_16x16x32_bf16 v[60:63], v[84:87], v[172:175], v[60:63]
s_nop 0
v_cvt_pk_bf16_f32 v8, v32, v33
v_cvt_pk_bf16_f32 v9, v34, v35
v_cvt_pk_bf16_f32 v10, v40, v41
v_cvt_pk_bf16_f32 v11, v42, v43
s_add_u32 s34, s22, 0
buffer_store_dwordx4 v[8:11], v1, s[4:7], s34 offen sc1
v_cvt_pk_bf16_f32 v12, v36, v37
v_cvt_pk_bf16_f32 v13, v38, v39
v_cvt_pk_bf16_f32 v14, v44, v45
v_cvt_pk_bf16_f32 v15, v46, v47
s_add_u32 s34, s22, 6144
buffer_store_dwordx4 v[12:15], v1, s[4:7], s34 offen sc1
v_cvt_pk_bf16_f32 v8, v48, v49
v_cvt_pk_bf16_f32 v9, v50, v51
v_cvt_pk_bf16_f32 v10, v52, v53
v_cvt_pk_bf16_f32 v11, v54, v55
s_add_u32 s34, s23, 4096
buffer_store_dwordx4 v[8:11], v1, s[4:7], s34 offen sc1
v_cvt_pk_bf16_f32 v12, v56, v57
v_cvt_pk_bf16_f32 v13, v58, v59
v_cvt_pk_bf16_f32 v14, v60, v61
v_cvt_pk_bf16_f32 v15, v62, v63
s_add_u32 s34, s23, 5120
buffer_store_dwordx4 v[12:15], v1, s[4:7], s34 offen sc1
s_waitcnt vmcnt(0)
s_barrier
s_add_u32 s17, s17, 1
s_cmp_lt_u32 s17, 64
s_cbranch_scc1 reca_ptop264
s_branch reca_exit1
reca_pw3_229:
s_mov_b32 s17, 0
s_mov_b32 s26, 0
s_mul_i32 s20, s17, 40960
s_add_u32 s20, s20, 84965376
s_add_u32 m0, s26, 30720
s_nop 0
buffer_load_dwordx4 v1, s[4:7], s20 offen offset:0 lds
buffer_load_dwordx4 v1, s[4:7], s20 offen offset:1024 lds
buffer_load_dwordx4 v1, s[4:7], s20 offen offset:2048 lds
buffer_load_dwordx4 v1, s[4:7], s20 offen offset:3072 lds
s_add_u32 s20, s20, 4096
s_add_u32 m0, s26, 34816
s_nop 0
buffer_load_dwordx4 v1, s[4:7], s20 offen offset:0 lds
buffer_load_dwordx4 v1, s[4:7], s20 offen offset:1024 lds
buffer_load_dwordx4 v1, s[4:7], s20 offen offset:2048 lds
buffer_load_dwordx4 v1, s[4:7], s20 offen offset:3072 lds
s_add_u32 s20, s20, 4096
s_add_u32 m0, s26, 38912
s_nop 0
buffer_load_dwordx4 v1, s[4:7], s20 offen offset:0 lds
buffer_load_dwordx4 v1, s[4:7], s20 offen offset:1024 lds
s_mul_i32 s34, s15, 12
s_mul_i32 s35, s16, 6
s_add_u32 s34, s34, s35
s_add_u32 s34, s34, 2
s_mul_i32 s34, s34, 20480
s_add_u32 s34, s34, 6291456
buffer_load_dwordx4 a[0:3], v1, s[4:7], s34 offen offset:0
buffer_load_dwordx4 a[4:7], v1, s[4:7], s34 offen offset:1024
buffer_load_dwordx4 a[8:11], v1, s[4:7], s34 offen offset:2048
buffer_load_dwordx4 a[12:15], v1, s[4:7], s34 offen offset:3072
s_add_u32 s34, s34, 4096
buffer_load_dwordx4 a[16:19], v1, s[4:7], s34 offen offset:0
buffer_load_dwordx4 a[20:23], v1, s[4:7], s34 offen offset:1024
buffer_load_dwordx4 a[24:27], v1, s[4:7], s34 offen offset:2048
buffer_load_dwordx4 a[28:31], v1, s[4:7], s34 offen offset:3072
s_add_u32 s34, s34, 4096
buffer_load_dwordx4 a[32:35], v1, s[4:7], s34 offen offset:0
buffer_load_dwordx4 a[36:39], v1, s[4:7], s34 offen offset:1024
buffer_load_dwordx4 a[40:43], v1, s[4:7], s34 offen offset:2048
buffer_load_dwordx4 a[44:47], v1, s[4:7], s34 offen offset:3072
s_add_u32 s34, s34, 4096
buffer_load_dwordx4 a[48:51], v1, s[4:7], s34 offen offset:0
buffer_load_dwordx4 a[52:55], v1, s[4:7], s34 offen offset:1024
buffer_load_dwordx4 a[56:59], v1, s[4:7], s34 offen offset:2048
buffer_load_dwordx4 a[60:63], v1, s[4:7], s34 offen offset:3072
s_add_u32 s34, s34, 4096
buffer_load_dwordx4 a[64:67], v1, s[4:7], s34 offen offset:0
buffer_load_dwordx4 a[68:71], v1, s[4:7], s34 offen offset:1024
buffer_load_dwordx4 a[72:75], v1, s[4:7], s34 offen offset:2048
buffer_load_dwordx4 a[76:79], v1, s[4:7], s34 offen offset:3072
s_mul_i32 s34, s15, 12
s_mul_i32 s35, s16, 6
s_add_u32 s34, s34, s35
s_add_u32 s34, s34, 3
s_mul_i32 s34, s34, 20480
s_add_u32 s34, s34, 6291456
buffer_load_dwordx4 a[80:83], v1, s[4:7], s34 offen offset:0
buffer_load_dwordx4 a[84:87], v1, s[4:7], s34 offen offset:1024
buffer_load_dwordx4 a[88:91], v1, s[4:7], s34 offen offset:2048
buffer_load_dwordx4 a[92:95], v1, s[4:7], s34 offen offset:3072
s_add_u32 s34, s34, 4096
buffer_load_dwordx4 a[96:99], v1, s[4:7], s34 offen offset:0
buffer_load_dwordx4 a[100:103], v1, s[4:7], s34 offen offset:1024
buffer_load_dwordx4 a[104:107], v1, s[4:7], s34 offen offset:2048
buffer_load_dwordx4 a[108:111], v1, s[4:7], s34 offen offset:3072
s_add_u32 s34, s34, 4096
buffer_load_dwordx4 a[112:115], v1, s[4:7], s34 offen offset:0
buffer_load_dwordx4 a[116:119], v1, s[4:7], s34 offen offset:1024
buffer_load_dwordx4 a[120:123], v1, s[4:7], s34 offen offset:2048
buffer_load_dwordx4 a[124:127], v1, s[4:7], s34 offen offset:3072
s_add_u32 s34, s34, 4096
buffer_load_dwordx4 a[128:131], v1, s[4:7], s34 offen offset:0
buffer_load_dwordx4 a[132:135], v1, s[4:7], s34 offen offset:1024
buffer_load_dwordx4 a[136:139], v1, s[4:7], s34 offen offset:2048
buffer_load_dwordx4 a[140:143], v1, s[4:7], s34 offen offset:3072
s_add_u32 s34, s34, 4096
buffer_load_dwordx4 a[144:147], v1, s[4:7], s34 offen offset:0
buffer_load_dwordx4 a[148:151], v1, s[4:7], s34 offen offset:1024
buffer_load_dwordx4 a[152:155], v1, s[4:7], s34 offen offset:2048
buffer_load_dwordx4 a[156:159], v1, s[4:7], s34 offen offset:3072
s_waitcnt vmcnt(20)
s_mul_i32 s34, s15, 12
s_mul_i32 s35, s16, 6
s_add_u32 s34, s34, s35
s_add_u32 s34, s34, 4
s_mul_i32 s34, s34, 20480
s_add_u32 s34, s34, 6291456
buffer_load_dwordx4 a[160:163], v1, s[4:7], s34 offen offset:0
buffer_load_dwordx4 a[164:167], v1, s[4:7], s34 offen offset:1024
buffer_load_dwordx4 a[168:171], v1, s[4:7], s34 offen offset:2048
buffer_load_dwordx4 a[172:175], v1, s[4:7], s34 offen offset:3072
s_add_u32 s34, s34, 4096
buffer_load_dwordx4 a[176:179], v1, s[4:7], s34 offen offset:0
buffer_load_dwordx4 a[180:183], v1, s[4:7], s34 offen offset:1024
buffer_load_dwordx4 a[184:187], v1, s[4:7], s34 offen offset:2048
buffer_load_dwordx4 a[188:191], v1, s[4:7], s34 offen offset:3072
s_add_u32 s34, s34, 4096
buffer_load_dwordx4 a[192:195], v1, s[4:7], s34 offen offset:0
buffer_load_dwordx4 a[196:199], v1, s[4:7], s34 offen offset:1024
buffer_load_dwordx4 a[200:203], v1, s[4:7], s34 offen offset:2048
buffer_load_dwordx4 a[204:207], v1, s[4:7], s34 offen offset:3072
s_add_u32 s34, s34, 4096
buffer_load_dwordx4 a[208:211], v1, s[4:7], s34 offen offset:0
buffer_load_dwordx4 a[212:215], v1, s[4:7], s34 offen offset:1024
buffer_load_dwordx4 a[216:219], v1, s[4:7], s34 offen offset:2048
buffer_load_dwordx4 a[220:223], v1, s[4:7], s34 offen offset:3072
s_add_u32 s34, s34, 4096
buffer_load_dwordx4 a[224:227], v1, s[4:7], s34 offen offset:0
buffer_load_dwordx4 a[228:231], v1, s[4:7], s34 offen offset:1024
buffer_load_dwordx4 a[232:235], v1, s[4:7], s34 offen offset:2048
buffer_load_dwordx4 a[236:239], v1, s[4:7], s34 offen offset:3072
s_waitcnt vmcnt(20)
s_mul_i32 s34, s15, 12
s_mul_i32 s35, s16, 6
s_add_u32 s34, s34, s35
s_add_u32 s34, s34, 5
s_mul_i32 s34, s34, 20480
s_add_u32 s34, s34, 6291456
buffer_load_dwordx4 v[96:99], v1, s[4:7], s34 offen offset:0
buffer_load_dwordx4 v[100:103], v1, s[4:7], s34 offen offset:1024
buffer_load_dwordx4 v[104:107], v1, s[4:7], s34 offen offset:2048
buffer_load_dwordx4 v[108:111], v1, s[4:7], s34 offen offset:3072
s_add_u32 s34, s34, 4096
buffer_load_dwordx4 v[112:115], v1, s[4:7], s34 offen offset:0
buffer_load_dwordx4 v[116:119], v1, s[4:7], s34 offen offset:1024
buffer_load_dwordx4 v[120:123], v1, s[4:7], s34 offen offset:2048
buffer_load_dwordx4 v[124:127], v1, s[4:7], s34 offen offset:3072
s_add_u32 s34, s34, 4096
buffer_load_dwordx4 v[128:131], v1, s[4:7], s34 offen offset:0
buffer_load_dwordx4 v[132:135], v1, s[4:7], s34 offen offset:1024
buffer_load_dwordx4 v[136:139], v1, s[4:7], s34 offen offset:2048
buffer_load_dwordx4 v[140:143], v1, s[4:7], s34 offen offset:3072
s_add_u32 s34, s34, 4096
buffer_load_dwordx4 v[144:147], v1, s[4:7], s34 offen offset:0
buffer_load_dwordx4 v[148:151], v1, s[4:7], s34 offen offset:1024
buffer_load_dwordx4 v[152:155], v1, s[4:7], s34 offen offset:2048
buffer_load_dwordx4 v[156:159], v1, s[4:7], s34 offen offset:3072
s_add_u32 s34, s34, 4096
buffer_load_dwordx4 v[160:163], v1, s[4:7], s34 offen offset:0
buffer_load_dwordx4 v[164:167], v1, s[4:7], s34 offen offset:1024
buffer_load_dwordx4 v[168:171], v1, s[4:7], s34 offen offset:2048
buffer_load_dwordx4 v[172:175], v1, s[4:7], s34 offen offset:3072
s_waitcnt vmcnt(20)
v_and_b32 v30, 7, v0
v_lshlrev_b32 v30, 3, v30
reca_cens269:
buffer_load_dwordx2 v[28:29], v30, s[8:11], 0 offen sc1
s_waitcnt vmcnt(0)
v_sad_u8 v31, v28, 0, 0
v_sad_u8 v31, v29, 0, v31
v_cmp_gt_u32 vcc, 32, v31
s_cbranch_vccz reca_censok270
s_sleep 8
s_sub_u32 s18, s18, 1
s_cbranch_scc0 reca_cens269
s_mov_b32 s18, 0
reca_censok270:
v_and_b32 v28, 0x20202020, v28
v_and_b32 v29, 0x20202020, v29
v_cmp_ne_u32 s[34:35], 0, v28
v_cmp_ne_u32 s[36:37], 0, v29
s_nop 3
s_and_b32 s34, s34, 0xff
s_and_b32 s36, s36, 0xff
s_or_b32 s35, s34, s36
s_lshr_b32 s37, s35, s13
s_and_b32 s37, s37, 1
s_xor_b32 s43, s37, 1
s_cmp_eq_u32 s57, 0
s_cselect_b32 s58, s36, s34
v_mov_b32 v31, 0x80000000
s_cmp_lg_u32 s43, 0
s_cbranch_scc1 reca_pslow271
reca_ptop272:
s_cmp_lt_u32 s17, 3
s_cbranch_scc1 reca_pgo273
s_sub_u32 s36, s17, 3
reca_ppoll274:
buffer_load_dword v28, v4, s[4:7], s25 offen sc1
s_waitcnt vmcnt(0)
v_readfirstlane_b32 s34, v28
s_nop 3
s_cmp_ge_i32 s34, s36
s_cbranch_scc1 reca_pgo273
s_sleep 8
s_sub_u32 s18, s18, 1
s_cbranch_scc0 reca_ppoll274
s_mov_b32 s18, 0
reca_pgo273:
s_waitcnt vmcnt(0)
s_barrier
v_add_u32 v7, s26, v1
s_xor_b32 s26, s26, 40960
s_add_u32 s37, s17, 1
s_cmp_ge_u32 s37, 64
s_cbranch_scc1 reca_pnodma275
s_mul_i32 s20, s37, 40960
s_add_u32 s20, s20, 84965376
s_add_u32 m0, s26, 30720
s_nop 0
buffer_load_dwordx4 v1, s[4:7], s20 offen offset:0 lds
buffer_load_dwordx4 v1, s[4:7], s20 offen offset:1024 lds
buffer_load_dwordx4 v1, s[4:7], s20 offen offset:2048 lds
buffer_load_dwordx4 v1, s[4:7], s20 offen offset:3072 lds
s_add_u32 s20, s20, 4096
s_add_u32 m0, s26, 34816
s_nop 0
buffer_load_dwordx4 v1, s[4:7], s20 offen offset:0 lds
buffer_load_dwordx4 v1, s[4:7], s20 offen offset:1024 lds
buffer_load_dwordx4 v1, s[4:7], s20 offen offset:2048 lds
buffer_load_dwordx4 v1, s[4:7], s20 offen offset:3072 lds
s_add_u32 s20, s20, 4096
s_add_u32 m0, s26, 38912
s_nop 0
buffer_load_dwordx4 v1, s[4:7], s20 offen offset:0 lds
buffer_load_dwordx4 v1, s[4:7], s20 offen offset:1024 lds
reca_pnodma275:
s_lshl_b32 s34, s15, 3
s_and_b32 s35, s17, 7
s_add_u32 s34, s34, s35
s_mul_i32 s34, s34, 12288
s_mul_i32 s35, s16, 3072
s_add_u32 s35, s35, s34
s_add_u32 s21, s35, 37748736
s_add_u32 s22, s35, 44040192
s_mul_i32 s35, s16, 6144
s_add_u32 s35, s35, s34
s_add_u32 s23, s35, 40894464
ds_read_b128 v[72:75], v7 offset:0
ds_read_b128 v[76:79], v7 offset:20480
ds_read_b128 v[80:83], v7 offset:1024
ds_read_b128 v[84:87], v7 offset:21504
ds_read_b128 v[88:91], v7 offset:2048
ds_read_b128 v[92:95], v7 offset:22528
s_waitcnt lgkmcnt(4)
v_mfma_f32_16x16x32_bf16 v[32:35], a[0:3], v[72:75], 0
v_mfma_f32_16x16x32_bf16 v[36:39], a[0:3], v[76:79], 0
v_mfma_f32_16x16x32_bf16 v[40:43], a[80:83], v[72:75], 0
v_mfma_f32_16x16x32_bf16 v[44:47], a[80:83], v[76:79], 0
v_mfma_f32_16x16x32_bf16 v[48:51], a[160:163], v[72:75], 0
v_mfma_f32_16x16x32_bf16 v[52:55], a[160:163], v[76:79], 0
v_mfma_f32_16x16x32_bf16 v[56:59], v[96:99], v[72:75], 0
v_mfma_f32_16x16x32_bf16 v[60:63], v[96:99], v[76:79], 0
ds_read_b128 v[72:75], v7 offset:3072
ds_read_b128 v[76:79], v7 offset:23552
s_waitcnt lgkmcnt(4)
v_mfma_f32_16x16x32_bf16 v[32:35], a[4:7], v[80:83], v[32:35]
v_mfma_f32_16x16x32_bf16 v[36:39], a[4:7], v[84:87], v[36:39]
v_mfma_f32_16x16x32_bf16 v[40:43], a[84:87], v[80:83], v[40:43]
v_mfma_f32_16x16x32_bf16 v[44:47], a[84:87], v[84:87], v[44:47]
v_mfma_f32_16x16x32_bf16 v[48:51], a[164:167], v[80:83], v[48:51]
v_mfma_f32_16x16x32_bf16 v[52:55], a[164:167], v[84:87], v[52:55]
v_mfma_f32_16x16x32_bf16 v[56:59], v[100:103], v[80:83], v[56:59]
v_mfma_f32_16x16x32_bf16 v[60:63], v[100:103], v[84:87], v[60:63]
ds_read_b128 v[80:83], v7 offset:4096
ds_read_b128 v[84:87], v7 offset:24576
s_waitcnt lgkmcnt(4)
v_mfma_f32_16x16x32_bf16 v[32:35], a[8:11], v[88:91], v[32:35]
v_mfma_f32_16x16x32_bf16 v[36:39], a[8:11], v[92:95], v[36:39]
v_mfma_f32_16x16x32_bf16 v[40:43], a[88:91], v[88:91], v[40:43]
v_mfma_f32_16x16x32_bf16 v[44:47], a[88:91], v[92:95], v[44:47]
v_mfma_f32_16x16x32_bf16 v[48:51], a[168:171], v[88:91], v[48:51]
v_mfma_f32_16x16x32_bf16 v[52:55], a[168:171], v[92:95], v[52:55]
v_mfma_f32_16x16x32_bf16 v[56:59], v[104:107], v[88:91], v[56:59]
v_mfma_f32_16x16x32_bf16 v[60:63], v[104:107], v[92:95], v[60:63]
ds_read_b128 v[88:91], v7 offset:5120
ds_read_b128 v[92:95], v7 offset:25600
s_waitcnt lgkmcnt(4)
v_mfma_f32_16x16x32_bf16 v[32:35], a[12:15], v[72:75], v[32:35]
v_mfma_f32_16x16x32_bf16 v[36:39], a[12:15], v[76:79], v[36:39]
v_mfma_f32_16x16x32_bf16 v[40:43], a[92:95], v[72:75], v[40:43]
v_mfma_f32_16x16x32_bf16 v[44:47], a[92:95], v[76:79], v[44:47]
v_mfma_f32_16x16x32_bf16 v[48:51], a[172:175], v[72:75], v[48:51]
v_mfma_f32_16x16x32_bf16 v[52:55], a[172:175], v[76:79], v[52:55]
v_mfma_f32_16x16x32_bf16 v[56:59], v[108:111], v[72:75], v[56:59]
v_mfma_f32_16x16x32_bf16 v[60:63], v[108:111], v[76:79], v[60:63]
ds_read_b128 v[72:75], v7 offset:6144
ds_read_b128 v[76:79], v7 offset:26624
s_waitcnt lgkmcnt(4)
v_mfma_f32_16x16x32_bf16 v[32:35], a[16:19], v[80:83], v[32:35]
v_mfma_f32_16x16x32_bf16 v[36:39], a[16:19], v[84:87], v[36:39]
v_mfma_f32_16x16x32_bf16 v[40:43], a[96:99], v[80:83], v[40:43]
v_mfma_f32_16x16x32_bf16 v[44:47], a[96:99], v[84:87], v[44:47]
v_mfma_f32_16x16x32_bf16 v[48:51], a[176:179], v[80:83], v[48:51]
v_mfma_f32_16x16x32_bf16 v[52:55], a[176:179], v[84:87], v[52:55]
v_mfma_f32_16x16x32_bf16 v[56:59], v[112:115], v[80:83], v[56:59]
v_mfma_f32_16x16x32_bf16 v[60:63], v[112:115], v[84:87], v[60:63]
ds_read_b128 v[80:83], v7 offset:7168
ds_read_b128 v[84:87], v7 offset:27648
s_waitcnt lgkmcnt(4)
v_mfma_f32_16x16x32_bf16 v[32:35], a[20:23], v[88:91], v[32:35]
v_mfma_f32_16x16x32_bf16 v[36:39], a[20:23], v[92:95], v[36:39]
v_mfma_f32_16x16x32_bf16 v[40:43], a[100:103], v[88:91], v[40:43]
v_mfma_f32_16x16x32_bf16 v[44:47], a[100:103], v[92:95], v[44:47]
v_mfma_f32_16x16x32_bf16 v[48:51], a[180:183], v[88:91], v[48:51]
v_mfma_f32_16x16x32_bf16 v[52:55], a[180:183], v[92:95], v[52:55]
v_mfma_f32_16x16x32_bf16 v[56:59], v[116:119], v[88:91], v[56:59]
v_mfma_f32_16x16x32_bf16 v[60:63], v[116:119], v[92:95], v[60:63]
ds_read_b128 v[88:91], v7 offset:8192
ds_read_b128 v[92:95], v7 offset:28672
s_waitcnt lgkmcnt(4)
v_mfma_f32_16x16x32_bf16 v[32:35], a[24:27], v[72:75], v[32:35]
v_mfma_f32_16x16x32_bf16 v[36:39], a[24:27], v[76:79], v[36:39]
v_mfma_f32_16x16x32_bf16 v[40:43], a[104:107], v[72:75], v[40:43]
v_mfma_f32_16x16x32_bf16 v[44:47], a[104:107], v[76:79], v[44:47]
v_mfma_f32_16x16x32_bf16 v[48:51], a[184:187], v[72:75], v[48:51]
v_mfma_f32_16x16x32_bf16 v[52:55], a[184:187], v[76:79], v[52:55]
v_mfma_f32_16x16x32_bf16 v[56:59], v[120:123], v[72:75], v[56:59]
v_mfma_f32_16x16x32_bf16 v[60:63], v[120:123], v[76:79], v[60:63]
ds_read_b128 v[72:75], v7 offset:9216
ds_read_b128 v[76:79], v7 offset:29696
s_waitcnt lgkmcnt(4)
v_mfma_f32_16x16x32_bf16 v[32:35], a[28:31], v[80:83], v[32:35]
v_mfma_f32_16x16x32_bf16 v[36:39], a[28:31], v[84:87], v[36:39]
v_mfma_f32_16x16x32_bf16 v[40:43], a[108:111], v[80:83], v[40:43]
v_mfma_f32_16x16x32_bf16 v[44:47], a[108:111], v[84:87], v[44:47]
v_mfma_f32_16x16x32_bf16 v[48:51], a[188:191], v[80:83], v[48:51]
v_mfma_f32_16x16x32_bf16 v[52:55], a[188:191], v[84:87], v[52:55]
v_mfma_f32_16x16x32_bf16 v[56:59], v[124:127], v[80:83], v[56:59]
v_mfma_f32_16x16x32_bf16 v[60:63], v[124:127], v[84:87], v[60:63]
ds_read_b128 v[80:83], v7 offset:10240
ds_read_b128 v[84:87], v7 offset:30720
s_waitcnt lgkmcnt(4)
v_mfma_f32_16x16x32_bf16 v[32:35], a[32:35], v[88:91], v[32:35]
v_mfma_f32_16x16x32_bf16 v[36:39], a[32:35], v[92:95], v[36:39]
v_mfma_f32_16x16x32_bf16 v[40:43], a[112:115], v[88:91], v[40:43]
v_mfma_f32_16x16x32_bf16 v[44:47], a[112:115], v[92:95], v[44:47]
v_mfma_f32_16x16x32_bf16 v[48:51], a[192:195], v[88:91], v[48:51]
v_mfma_f32_16x16x32_bf16 v[52:55], a[192:195], v[92:95], v[52:55]
v_mfma_f32_16x16x32_bf16 v[56:59], v[128:131], v[88:91], v[56:59]
v_mfma_f32_16x16x32_bf16 v[60:63], v[128:131], v[92:95], v[60:63]
ds_read_b128 v[88:91], v7 offset:11264
ds_read_b128 v[92:95], v7 offset:31744
s_waitcnt lgkmcnt(4)
v_mfma_f32_16x16x32_bf16 v[32:35], a[36:39], v[72:75], v[32:35]
v_mfma_f32_16x16x32_bf16 v[36:39], a[36:39], v[76:79], v[36:39]
v_mfma_f32_16x16x32_bf16 v[40:43], a[116:119], v[72:75], v[40:43]
v_mfma_f32_16x16x32_bf16 v[44:47], a[116:119], v[76:79], v[44:47]
v_mfma_f32_16x16x32_bf16 v[48:51], a[196:199], v[72:75], v[48:51]
v_mfma_f32_16x16x32_bf16 v[52:55], a[196:199], v[76:79], v[52:55]
v_mfma_f32_16x16x32_bf16 v[56:59], v[132:135], v[72:75], v[56:59]
v_mfma_f32_16x16x32_bf16 v[60:63], v[132:135], v[76:79], v[60:63]
ds_read_b128 v[72:75], v7 offset:12288
ds_read_b128 v[76:79], v7 offset:32768
s_waitcnt lgkmcnt(4)
v_mfma_f32_16x16x32_bf16 v[32:35], a[40:43], v[80:83], v[32:35]
v_mfma_f32_16x16x32_bf16 v[36:39], a[40:43], v[84:87], v[36:39]
v_mfma_f32_16x16x32_bf16 v[40:43], a[120:123], v[80:83], v[40:43]
v_mfma_f32_16x16x32_bf16 v[44:47], a[120:123], v[84:87], v[44:47]
v_mfma_f32_16x16x32_bf16 v[48:51], a[200:203], v[80:83], v[48:51]
v_mfma_f32_16x16x32_bf16 v[52:55], a[200:203], v[84:87], v[52:55]
v_mfma_f32_16x16x32_bf16 v[56:59], v[136:139], v[80:83], v[56:59]
v_mfma_f32_16x16x32_bf16 v[60:63], v[136:139], v[84:87], v[60:63]
ds_read_b128 v[80:83], v7 offset:13312
ds_read_b128 v[84:87], v7 offset:33792
s_waitcnt lgkmcnt(4)
v_mfma_f32_16x16x32_bf16 v[32:35], a[44:47], v[88:91], v[32:35]
v_mfma_f32_16x16x32_bf16 v[36:39], a[44:47], v[92:95], v[36:39]
v_mfma_f32_16x16x32_bf16 v[40:43], a[124:127], v[88:91], v[40:43]
v_mfma_f32_16x16x32_bf16 v[44:47], a[124:127], v[92:95], v[44:47]
v_mfma_f32_16x16x32_bf16 v[48:51], a[204:207], v[88:91], v[48:51]
v_mfma_f32_16x16x32_bf16 v[52:55], a[204:207], v[92:95], v[52:55]
v_mfma_f32_16x16x32_bf16 v[56:59], v[140:143], v[88:91], v[56:59]
v_mfma_f32_16x16x32_bf16 v[60:63], v[140:143], v[92:95], v[60:63]
ds_read_b128 v[88:91], v7 offset:14336
ds_read_b128 v[92:95], v7 offset:34816
s_waitcnt lgkmcnt(4)
v_mfma_f32_16x16x32_bf16 v[32:35], a[48:51], v[72:75], v[32:35]
v_mfma_f32_16x16x32_bf16 v[36:39], a[48:51], v[76:79], v[36:39]
v_mfma_f32_16x16x32_bf16 v[40:43], a[128:131], v[72:75], v[40:43]
v_mfma_f32_16x16x32_bf16 v[44:47], a[128:131], v[76:79], v[44:47]
v_mfma_f32_16x16x32_bf16 v[48:51], a[208:211], v[72:75], v[48:51]
v_mfma_f32_16x16x32_bf16 v[52:55], a[208:211], v[76:79], v[52:55]
v_mfma_f32_16x16x32_bf16 v[56:59], v[144:147], v[72:75], v[56:59]
v_mfma_f32_16x16x32_bf16 v[60:63], v[144:147], v[76:79], v[60:63]
ds_read_b128 v[72:75], v7 offset:15360
ds_read_b128 v[76:79], v7 offset:35840
s_waitcnt lgkmcnt(4)
v_mfma_f32_16x16x32_bf16 v[32:35], a[52:55], v[80:83], v[32:35]
v_mfma_f32_16x16x32_bf16 v[36:39], a[52:55], v[84:87], v[36:39]
v_mfma_f32_16x16x32_bf16 v[40:43], a[132:135], v[80:83], v[40:43]
v_mfma_f32_16x16x32_bf16 v[44:47], a[132:135], v[84:87], v[44:47]
v_mfma_f32_16x16x32_bf16 v[48:51], a[212:215], v[80:83], v[48:51]
v_mfma_f32_16x16x32_bf16 v[52:55], a[212:215], v[84:87], v[52:55]
v_mfma_f32_16x16x32_bf16 v[56:59], v[148:151], v[80:83], v[56:59]
v_mfma_f32_16x16x32_bf16 v[60:63], v[148:151], v[84:87], v[60:63]
ds_read_b128 v[80:83], v7 offset:16384
ds_read_b128 v[84:87], v7 offset:36864
s_waitcnt lgkmcnt(4)
v_mfma_f32_16x16x32_bf16 v[32:35], a[56:59], v[88:91], v[32:35]
v_mfma_f32_16x16x32_bf16 v[36:39], a[56:59], v[92:95], v[36:39]
v_mfma_f32_16x16x32_bf16 v[40:43], a[136:139], v[88:91], v[40:43]
v_mfma_f32_16x16x32_bf16 v[44:47], a[136:139], v[92:95], v[44:47]
v_mfma_f32_16x16x32_bf16 v[48:51], a[216:219], v[88:91], v[48:51]
v_mfma_f32_16x16x32_bf16 v[52:55], a[216:219], v[92:95], v[52:55]
v_mfma_f32_16x16x32_bf16 v[56:59], v[152:155], v[88:91], v[56:59]
v_mfma_f32_16x16x32_bf16 v[60:63], v[152:155], v[92:95], v[60:63]
ds_read_b128 v[88:91], v7 offset:17408
ds_read_b128 v[92:95], v7 offset:37888
s_waitcnt lgkmcnt(4)
v_mfma_f32_16x16x32_bf16 v[32:35], a[60:63], v[72:75], v[32:35]
v_mfma_f32_16x16x32_bf16 v[36:39], a[60:63], v[76:79], v[36:39]
v_mfma_f32_16x16x32_bf16 v[40:43], a[140:143], v[72:75], v[40:43]
v_mfma_f32_16x16x32_bf16 v[44:47], a[140:143], v[76:79], v[44:47]
v_mfma_f32_16x16x32_bf16 v[48:51], a[220:223], v[72:75], v[48:51]
v_mfma_f32_16x16x32_bf16 v[52:55], a[220:223], v[76:79], v[52:55]
v_mfma_f32_16x16x32_bf16 v[56:59], v[156:159], v[72:75], v[56:59]
v_mfma_f32_16x16x32_bf16 v[60:63], v[156:159], v[76:79], v[60:63]
ds_read_b128 v[72:75], v7 offset:18432
ds_read_b128 v[76:79], v7 offset:38912
s_waitcnt lgkmcnt(4)
v_mfma_f32_16x16x32_bf16 v[32:35], a[64:67], v[80:83], v[32:35]
v_mfma_f32_16x16x32_bf16 v[36:39], a[64:67], v[84:87], v[36:39]
v_mfma_f32_16x16x32_bf16 v[40:43], a[144:147], v[80:83], v[40:43]
v_mfma_f32_16x16x32_bf16 v[44:47], a[144:147], v[84:87], v[44:47]
v_mfma_f32_16x16x32_bf16 v[48:51], a[224:227], v[80:83], v[48:51]
v_mfma_f32_16x16x32_bf16 v[52:55], a[224:227], v[84:87], v[52:55]
v_mfma_f32_16x16x32_bf16 v[56:59], v[160:163], v[80:83], v[56:59]
v_mfma_f32_16x16x32_bf16 v[60:63], v[160:163], v[84:87], v[60:63]
ds_read_b128 v[80:83], v7 offset:19456
ds_read_b128 v[84:87], v7 offset:39936
s_waitcnt lgkmcnt(4)
v_mfma_f32_16x16x32_bf16 v[32:35], a[68:71], v[88:91], v[32:35]
v_mfma_f32_16x16x32_bf16 v[36:39], a[68:71], v[92:95], v[36:39]
v_mfma_f32_16x16x32_bf16 v[40:43], a[148:151], v[88:91], v[40:43]
v_mfma_f32_16x16x32_bf16 v[44:47], a[148:151], v[92:95], v[44:47]
v_mfma_f32_16x16x32_bf16 v[48:51], a[228:231], v[88:91], v[48:51]
v_mfma_f32_16x16x32_bf16 v[52:55], a[228:231], v[92:95], v[52:55]
v_mfma_f32_16x16x32_bf16 v[56:59], v[164:167], v[88:91], v[56:59]
v_mfma_f32_16x16x32_bf16 v[60:63], v[164:167], v[92:95], v[60:63]
s_waitcnt lgkmcnt(2)
v_mfma_f32_16x16x32_bf16 v[32:35], a[72:75], v[72:75], v[32:35]
v_mfma_f32_16x16x32_bf16 v[36:39], a[72:75], v[76:79], v[36:39]
v_mfma_f32_16x16x32_bf16 v[40:43], a[152:155], v[72:75], v[40:43]
v_mfma_f32_16x16x32_bf16 v[44:47], a[152:155], v[76:79], v[44:47]
v_mfma_f32_16x16x32_bf16 v[48:51], a[232:235], v[72:75], v[48:51]
v_mfma_f32_16x16x32_bf16 v[52:55], a[232:235], v[76:79], v[52:55]
v_mfma_f32_16x16x32_bf16 v[56:59], v[168:171], v[72:75], v[56:59]
v_mfma_f32_16x16x32_bf16 v[60:63], v[168:171], v[76:79], v[60:63]
s_waitcnt lgkmcnt(0)
v_mfma_f32_16x16x32_bf16 v[32:35], a[76:79], v[80:83], v[32:35]
v_mfma_f32_16x16x32_bf16 v[36:39], a[76:79], v[84:87], v[36:39]
v_mfma_f32_16x16x32_bf16 v[40:43], a[156:159], v[80:83], v[40:43]
v_mfma_f32_16x16x32_bf16 v[44:47], a[156:159], v[84:87], v[44:47]
v_mfma_f32_16x16x32_bf16 v[48:51], a[236:239], v[80:83], v[48:51]
v_mfma_f32_16x16x32_bf16 v[52:55], a[236:239], v[84:87], v[52:55]
v_mfma_f32_16x16x32_bf16 v[56:59], v[172:175], v[80:83], v[56:59]
v_mfma_f32_16x16x32_bf16 v[60:63], v[172:175], v[84:87], v[60:63]
s_nop 0
v_cvt_pk_bf16_f32 v8, v32, v33
v_cvt_pk_bf16_f32 v9, v34, v35
v_cvt_pk_bf16_f32 v10, v40, v41
v_cvt_pk_bf16_f32 v11, v42, v43
s_add_u32 s34, s22, 1024
buffer_store_dwordx4 v[8:11], v1, s[4:7], s34 offen
v_cvt_pk_bf16_f32 v12, v36, v37
v_cvt_pk_bf16_f32 v13, v38, v39
v_cvt_pk_bf16_f32 v14, v44, v45
v_cvt_pk_bf16_f32 v15, v46, v47
s_add_u32 s34, s22, 7168
buffer_store_dwordx4 v[12:15], v1, s[4:7], s34 offen
v_cvt_pk_bf16_f32 v8, v48, v49
v_cvt_pk_bf16_f32 v9, v50, v51
v_cvt_pk_bf16_f32 v10, v56, v57
v_cvt_pk_bf16_f32 v11, v58, v59
s_add_u32 s34, s22, 2048
buffer_store_dwordx4 v[8:11], v1, s[4:7], s34 offen
v_cvt_pk_bf16_f32 v12, v52, v53
v_cvt_pk_bf16_f32 v13, v54, v55
v_cvt_pk_bf16_f32 v14, v60, v61
v_cvt_pk_bf16_f32 v15, v62, v63
s_add_u32 s34, s22, 8192
buffer_store_dwordx4 v[12:15], v1, s[4:7], s34 offen
s_waitcnt vmcnt(0)
s_barrier
s_add_u32 s17, s17, 1
s_cmp_lt_u32 s17, 64
s_cbranch_scc1 reca_ptop272
s_branch reca_exit1
reca_pslow271:
reca_ptop277:
s_cmp_lt_u32 s17, 3
s_cbranch_scc1 reca_pgo278
s_sub_u32 s36, s17, 3
reca_ppoll279:
buffer_load_dword v28, v4, s[4:7], s25 offen sc1
s_waitcnt vmcnt(0)
v_readfirstlane_b32 s34, v28
s_nop 3
s_cmp_ge_i32 s34, s36
s_cbranch_scc1 reca_pgo278
s_sleep 8
s_sub_u32 s18, s18, 1
s_cbranch_scc0 reca_ppoll279
s_mov_b32 s18, 0
reca_pgo278:
s_waitcnt vmcnt(0)
s_barrier
v_add_u32 v7, s26, v1
s_xor_b32 s26, s26, 40960
s_add_u32 s37, s17, 1
s_cmp_ge_u32 s37, 64
s_cbranch_scc1 reca_pnodma280
s_mul_i32 s20, s37, 40960
s_add_u32 s20, s20, 84965376
s_add_u32 m0, s26, 30720
s_nop 0
buffer_load_dwordx4 v1, s[4:7], s20 offen offset:0 lds
buffer_load_dwordx4 v1, s[4:7], s20 offen offset:1024 lds
buffer_load_dwordx4 v1, s[4:7], s20 offen offset:2048 lds
buffer_load_dwordx4 v1, s[4:7], s20 offen offset:3072 lds
s_add_u32 s20, s20, 4096
s_add_u32 m0, s26, 34816
s_nop 0
buffer_load_dwordx4 v1, s[4:7], s20 offen offset:0 lds
buffer_load_dwordx4 v1, s[4:7], s20 offen offset:1024 lds
buffer_load_dwordx4 v1, s[4:7], s20 offen offset:2048 lds
buffer_load_dwordx4 v1, s[4:7], s20 offen offset:3072 lds
s_add_u32 s20, s20, 4096
s_add_u32 m0, s26, 38912
s_nop 0
buffer_load_dwordx4 v1, s[4:7], s20 offen offset:0 lds
buffer_load_dwordx4 v1, s[4:7], s20 offen offset:1024 lds
reca_pnodma280:
s_lshl_b32 s34, s15, 3
s_and_b32 s35, s17, 7
s_add_u32 s34, s34, s35
s_mul_i32 s34, s34, 12288
s_mul_i32 s35, s16, 3072
s_add_u32 s35, s35, s34
s_add_u32 s21, s35, 37748736
s_add_u32 s22, s35, 44040192
s_mul_i32 s35, s16, 6144
s_add_u32 s35, s35, s34
s_add_u32 s23, s35, 40894464
ds_read_b128 v[72:75], v7 offset:0
ds_read_b128 v[76:79], v7 offset:20480
ds_read_b128 v[80:83], v7 offset:1024
ds_read_b128 v[84:87], v7 offset:21504
ds_read_b128 v[88:91], v7 offset:2048
ds_read_b128 v[92:95], v7 offset:22528
s_waitcnt lgkmcnt(4)
v_mfma_f32_16x16x32_bf16 v[32:35], a[0:3], v[72:75], 0
v_mfma_f32_16x16x32_bf16 v[36:39], a[0:3], v[76:79], 0
v_mfma_f32_16x16x32_bf16 v[40:43], a[80:83], v[72:75], 0
v_mfma_f32_16x16x32_bf16 v[44:47], a[80:83], v[76:79], 0
v_mfma_f32_16x16x32_bf16 v[48:51], a[160:163], v[72:75], 0
v_mfma_f32_16x16x32_bf16 v[52:55], a[160:163], v[76:79], 0
v_mfma_f32_16x16x32_bf16 v[56:59], v[96:99], v[72:75], 0
v_mfma_f32_16x16x32_bf16 v[60:63], v[96:99], v[76:79], 0
ds_read_b128 v[72:75], v7 offset:3072
ds_read_b128 v[76:79], v7 offset:23552
s_waitcnt lgkmcnt(4)
v_mfma_f32_16x16x32_bf16 v[32:35], a[4:7], v[80:83], v[32:35]
v_mfma_f32_16x16x32_bf16 v[36:39], a[4:7], v[84:87], v[36:39]
v_mfma_f32_16x16x32_bf16 v[40:43], a[84:87], v[80:83], v[40:43]
v_mfma_f32_16x16x32_bf16 v[44:47], a[84:87], v[84:87], v[44:47]
v_mfma_f32_16x16x32_bf16 v[48:51], a[164:167], v[80:83], v[48:51]
v_mfma_f32_16x16x32_bf16 v[52:55], a[164:167], v[84:87], v[52:55]
v_mfma_f32_16x16x32_bf16 v[56:59], v[100:103], v[80:83], v[56:59]
v_mfma_f32_16x16x32_bf16 v[60:63], v[100:103], v[84:87], v[60:63]
ds_read_b128 v[80:83], v7 offset:4096
ds_read_b128 v[84:87], v7 offset:24576
s_waitcnt lgkmcnt(4)
v_mfma_f32_16x16x32_bf16 v[32:35], a[8:11], v[88:91], v[32:35]
v_mfma_f32_16x16x32_bf16 v[36:39], a[8:11], v[92:95], v[36:39]
v_mfma_f32_16x16x32_bf16 v[40:43], a[88:91], v[88:91], v[40:43]
v_mfma_f32_16x16x32_bf16 v[44:47], a[88:91], v[92:95], v[44:47]
v_mfma_f32_16x16x32_bf16 v[48:51], a[168:171], v[88:91], v[48:51]
v_mfma_f32_16x16x32_bf16 v[52:55], a[168:171], v[92:95], v[52:55]
v_mfma_f32_16x16x32_bf16 v[56:59], v[104:107], v[88:91], v[56:59]
v_mfma_f32_16x16x32_bf16 v[60:63], v[104:107], v[92:95], v[60:63]
ds_read_b128 v[88:91], v7 offset:5120
ds_read_b128 v[92:95], v7 offset:25600
s_waitcnt lgkmcnt(4)
v_mfma_f32_16x16x32_bf16 v[32:35], a[12:15], v[72:75], v[32:35]
v_mfma_f32_16x16x32_bf16 v[36:39], a[12:15], v[76:79], v[36:39]
v_mfma_f32_16x16x32_bf16 v[40:43], a[92:95], v[72:75], v[40:43]
v_mfma_f32_16x16x32_bf16 v[44:47], a[92:95], v[76:79], v[44:47]
v_mfma_f32_16x16x32_bf16 v[48:51], a[172:175], v[72:75], v[48:51]
v_mfma_f32_16x16x32_bf16 v[52:55], a[172:175], v[76:79], v[52:55]
v_mfma_f32_16x16x32_bf16 v[56:59], v[108:111], v[72:75], v[56:59]
v_mfma_f32_16x16x32_bf16 v[60:63], v[108:111], v[76:79], v[60:63]
ds_read_b128 v[72:75], v7 offset:6144
ds_read_b128 v[76:79], v7 offset:26624
s_waitcnt lgkmcnt(4)
v_mfma_f32_16x16x32_bf16 v[32:35], a[16:19], v[80:83], v[32:35]
v_mfma_f32_16x16x32_bf16 v[36:39], a[16:19], v[84:87], v[36:39]
v_mfma_f32_16x16x32_bf16 v[40:43], a[96:99], v[80:83], v[40:43]
v_mfma_f32_16x16x32_bf16 v[44:47], a[96:99], v[84:87], v[44:47]
v_mfma_f32_16x16x32_bf16 v[48:51], a[176:179], v[80:83], v[48:51]
v_mfma_f32_16x16x32_bf16 v[52:55], a[176:179], v[84:87], v[52:55]
v_mfma_f32_16x16x32_bf16 v[56:59], v[112:115], v[80:83], v[56:59]
v_mfma_f32_16x16x32_bf16 v[60:63], v[112:115], v[84:87], v[60:63]
ds_read_b128 v[80:83], v7 offset:7168
ds_read_b128 v[84:87], v7 offset:27648
s_waitcnt lgkmcnt(4)
v_mfma_f32_16x16x32_bf16 v[32:35], a[20:23], v[88:91], v[32:35]
v_mfma_f32_16x16x32_bf16 v[36:39], a[20:23], v[92:95], v[36:39]
v_mfma_f32_16x16x32_bf16 v[40:43], a[100:103], v[88:91], v[40:43]
v_mfma_f32_16x16x32_bf16 v[44:47], a[100:103], v[92:95], v[44:47]
v_mfma_f32_16x16x32_bf16 v[48:51], a[180:183], v[88:91], v[48:51]
v_mfma_f32_16x16x32_bf16 v[52:55], a[180:183], v[92:95], v[52:55]
v_mfma_f32_16x16x32_bf16 v[56:59], v[116:119], v[88:91], v[56:59]
v_mfma_f32_16x16x32_bf16 v[60:63], v[116:119], v[92:95], v[60:63]
ds_read_b128 v[88:91], v7 offset:8192
ds_read_b128 v[92:95], v7 offset:28672
s_waitcnt lgkmcnt(4)
v_mfma_f32_16x16x32_bf16 v[32:35], a[24:27], v[72:75], v[32:35]
v_mfma_f32_16x16x32_bf16 v[36:39], a[24:27], v[76:79], v[36:39]
v_mfma_f32_16x16x32_bf16 v[40:43], a[104:107], v[72:75], v[40:43]
v_mfma_f32_16x16x32_bf16 v[44:47], a[104:107], v[76:79], v[44:47]
v_mfma_f32_16x16x32_bf16 v[48:51], a[184:187], v[72:75], v[48:51]
v_mfma_f32_16x16x32_bf16 v[52:55], a[184:187], v[76:79], v[52:55]
v_mfma_f32_16x16x32_bf16 v[56:59], v[120:123], v[72:75], v[56:59]
v_mfma_f32_16x16x32_bf16 v[60:63], v[120:123], v[76:79], v[60:63]
ds_read_b128 v[72:75], v7 offset:9216
ds_read_b128 v[76:79], v7 offset:29696
s_waitcnt lgkmcnt(4)
v_mfma_f32_16x16x32_bf16 v[32:35], a[28:31], v[80:83], v[32:35]
v_mfma_f32_16x16x32_bf16 v[36:39], a[28:31], v[84:87], v[36:39]
v_mfma_f32_16x16x32_bf16 v[40:43], a[108:111], v[80:83], v[40:43]
v_mfma_f32_16x16x32_bf16 v[44:47], a[108:111], v[84:87], v[44:47]
v_mfma_f32_16x16x32_bf16 v[48:51], a[188:191], v[80:83], v[48:51]
v_mfma_f32_16x16x32_bf16 v[52:55], a[188:191], v[84:87], v[52:55]
v_mfma_f32_16x16x32_bf16 v[56:59], v[124:127], v[80:83], v[56:59]
v_mfma_f32_16x16x32_bf16 v[60:63], v[124:127], v[84:87], v[60:63]
ds_read_b128 v[80:83], v7 offset:10240
ds_read_b128 v[84:87], v7 offset:30720
s_waitcnt lgkmcnt(4)
v_mfma_f32_16x16x32_bf16 v[32:35], a[32:35], v[88:91], v[32:35]
v_mfma_f32_16x16x32_bf16 v[36:39], a[32:35], v[92:95], v[36:39]
v_mfma_f32_16x16x32_bf16 v[40:43], a[112:115], v[88:91], v[40:43]
v_mfma_f32_16x16x32_bf16 v[44:47], a[112:115], v[92:95], v[44:47]
v_mfma_f32_16x16x32_bf16 v[48:51], a[192:195], v[88:91], v[48:51]
v_mfma_f32_16x16x32_bf16 v[52:55], a[192:195], v[92:95], v[52:55]
v_mfma_f32_16x16x32_bf16 v[56:59], v[128:131], v[88:91], v[56:59]
v_mfma_f32_16x16x32_bf16 v[60:63], v[128:131], v[92:95], v[60:63]
ds_read_b128 v[88:91], v7 offset:11264
ds_read_b128 v[92:95], v7 offset:31744
s_waitcnt lgkmcnt(4)
v_mfma_f32_16x16x32_bf16 v[32:35], a[36:39], v[72:75], v[32:35]
v_mfma_f32_16x16x32_bf16 v[36:39], a[36:39], v[76:79], v[36:39]
v_mfma_f32_16x16x32_bf16 v[40:43], a[116:119], v[72:75], v[40:43]
v_mfma_f32_16x16x32_bf16 v[44:47], a[116:119], v[76:79], v[44:47]
v_mfma_f32_16x16x32_bf16 v[48:51], a[196:199], v[72:75], v[48:51]
v_mfma_f32_16x16x32_bf16 v[52:55], a[196:199], v[76:79], v[52:55]
v_mfma_f32_16x16x32_bf16 v[56:59], v[132:135], v[72:75], v[56:59]
v_mfma_f32_16x16x32_bf16 v[60:63], v[132:135], v[76:79], v[60:63]
ds_read_b128 v[72:75], v7 offset:12288
ds_read_b128 v[76:79], v7 offset:32768
s_waitcnt lgkmcnt(4)
v_mfma_f32_16x16x32_bf16 v[32:35], a[40:43], v[80:83], v[32:35]
v_mfma_f32_16x16x32_bf16 v[36:39], a[40:43], v[84:87], v[36:39]
v_mfma_f32_16x16x32_bf16 v[40:43], a[120:123], v[80:83], v[40:43]
v_mfma_f32_16x16x32_bf16 v[44:47], a[120:123], v[84:87], v[44:47]
v_mfma_f32_16x16x32_bf16 v[48:51], a[200:203], v[80:83], v[48:51]
v_mfma_f32_16x16x32_bf16 v[52:55], a[200:203], v[84:87], v[52:55]
v_mfma_f32_16x16x32_bf16 v[56:59], v[136:139], v[80:83], v[56:59]
v_mfma_f32_16x16x32_bf16 v[60:63], v[136:139], v[84:87], v[60:63]
ds_read_b128 v[80:83], v7 offset:13312
ds_read_b128 v[84:87], v7 offset:33792
s_waitcnt lgkmcnt(4)
v_mfma_f32_16x16x32_bf16 v[32:35], a[44:47], v[88:91], v[32:35]
v_mfma_f32_16x16x32_bf16 v[36:39], a[44:47], v[92:95], v[36:39]
v_mfma_f32_16x16x32_bf16 v[40:43], a[124:127], v[88:91], v[40:43]
v_mfma_f32_16x16x32_bf16 v[44:47], a[124:127], v[92:95], v[44:47]
v_mfma_f32_16x16x32_bf16 v[48:51], a[204:207], v[88:91], v[48:51]
v_mfma_f32_16x16x32_bf16 v[52:55], a[204:207], v[92:95], v[52:55]
v_mfma_f32_16x16x32_bf16 v[56:59], v[140:143], v[88:91], v[56:59]
v_mfma_f32_16x16x32_bf16 v[60:63], v[140:143], v[92:95], v[60:63]
ds_read_b128 v[88:91], v7 offset:14336
ds_read_b128 v[92:95], v7 offset:34816
s_waitcnt lgkmcnt(4)
v_mfma_f32_16x16x32_bf16 v[32:35], a[48:51], v[72:75], v[32:35]
v_mfma_f32_16x16x32_bf16 v[36:39], a[48:51], v[76:79], v[36:39]
v_mfma_f32_16x16x32_bf16 v[40:43], a[128:131], v[72:75], v[40:43]
v_mfma_f32_16x16x32_bf16 v[44:47], a[128:131], v[76:79], v[44:47]
v_mfma_f32_16x16x32_bf16 v[48:51], a[208:211], v[72:75], v[48:51]
v_mfma_f32_16x16x32_bf16 v[52:55], a[208:211], v[76:79], v[52:55]
v_mfma_f32_16x16x32_bf16 v[56:59], v[144:147], v[72:75], v[56:59]
v_mfma_f32_16x16x32_bf16 v[60:63], v[144:147], v[76:79], v[60:63]
ds_read_b128 v[72:75], v7 offset:15360
ds_read_b128 v[76:79], v7 offset:35840
s_waitcnt lgkmcnt(4)
v_mfma_f32_16x16x32_bf16 v[32:35], a[52:55], v[80:83], v[32:35]
v_mfma_f32_16x16x32_bf16 v[36:39], a[52:55], v[84:87], v[36:39]
v_mfma_f32_16x16x32_bf16 v[40:43], a[132:135], v[80:83], v[40:43]
v_mfma_f32_16x16x32_bf16 v[44:47], a[132:135], v[84:87], v[44:47]
v_mfma_f32_16x16x32_bf16 v[48:51], a[212:215], v[80:83], v[48:51]
v_mfma_f32_16x16x32_bf16 v[52:55], a[212:215], v[84:87], v[52:55]
v_mfma_f32_16x16x32_bf16 v[56:59], v[148:151], v[80:83], v[56:59]
v_mfma_f32_16x16x32_bf16 v[60:63], v[148:151], v[84:87], v[60:63]
ds_read_b128 v[80:83], v7 offset:16384
ds_read_b128 v[84:87], v7 offset:36864
s_waitcnt lgkmcnt(4)
v_mfma_f32_16x16x32_bf16 v[32:35], a[56:59], v[88:91], v[32:35]
v_mfma_f32_16x16x32_bf16 v[36:39], a[56:59], v[92:95], v[36:39]
v_mfma_f32_16x16x32_bf16 v[40:43], a[136:139], v[88:91], v[40:43]
v_mfma_f32_16x16x32_bf16 v[44:47], a[136:139], v[92:95], v[44:47]
v_mfma_f32_16x16x32_bf16 v[48:51], a[216:219], v[88:91], v[48:51]
v_mfma_f32_16x16x32_bf16 v[52:55], a[216:219], v[92:95], v[52:55]
v_mfma_f32_16x16x32_bf16 v[56:59], v[152:155], v[88:91], v[56:59]
v_mfma_f32_16x16x32_bf16 v[60:63], v[152:155], v[92:95], v[60:63]
ds_read_b128 v[88:91], v7 offset:17408
ds_read_b128 v[92:95], v7 offset:37888
s_waitcnt lgkmcnt(4)
v_mfma_f32_16x16x32_bf16 v[32:35], a[60:63], v[72:75], v[32:35]
v_mfma_f32_16x16x32_bf16 v[36:39], a[60:63], v[76:79], v[36:39]
v_mfma_f32_16x16x32_bf16 v[40:43], a[140:143], v[72:75], v[40:43]
v_mfma_f32_16x16x32_bf16 v[44:47], a[140:143], v[76:79], v[44:47]
v_mfma_f32_16x16x32_bf16 v[48:51], a[220:223], v[72:75], v[48:51]
v_mfma_f32_16x16x32_bf16 v[52:55], a[220:223], v[76:79], v[52:55]
v_mfma_f32_16x16x32_bf16 v[56:59], v[156:159], v[72:75], v[56:59]
v_mfma_f32_16x16x32_bf16 v[60:63], v[156:159], v[76:79], v[60:63]
ds_read_b128 v[72:75], v7 offset:18432
ds_read_b128 v[76:79], v7 offset:38912
s_waitcnt lgkmcnt(4)
v_mfma_f32_16x16x32_bf16 v[32:35], a[64:67], v[80:83], v[32:35]
v_mfma_f32_16x16x32_bf16 v[36:39], a[64:67], v[84:87], v[36:39]
v_mfma_f32_16x16x32_bf16 v[40:43], a[144:147], v[80:83], v[40:43]
v_mfma_f32_16x16x32_bf16 v[44:47], a[144:147], v[84:87], v[44:47]
v_mfma_f32_16x16x32_bf16 v[48:51], a[224:227], v[80:83], v[48:51]
v_mfma_f32_16x16x32_bf16 v[52:55], a[224:227], v[84:87], v[52:55]
v_mfma_f32_16x16x32_bf16 v[56:59], v[160:163], v[80:83], v[56:59]
v_mfma_f32_16x16x32_bf16 v[60:63], v[160:163], v[84:87], v[60:63]
ds_read_b128 v[80:83], v7 offset:19456
ds_read_b128 v[84:87], v7 offset:39936
s_waitcnt lgkmcnt(4)
v_mfma_f32_16x16x32_bf16 v[32:35], a[68:71], v[88:91], v[32:35]
v_mfma_f32_16x16x32_bf16 v[36:39], a[68:71], v[92:95], v[36:39]
v_mfma_f32_16x16x32_bf16 v[40:43], a[148:151], v[88:91], v[40:43]
v_mfma_f32_16x16x32_bf16 v[44:47], a[148:151], v[92:95], v[44:47]
v_mfma_f32_16x16x32_bf16 v[48:51], a[228:231], v[88:91], v[48:51]
v_mfma_f32_16x16x32_bf16 v[52:55], a[228:231], v[92:95], v[52:55]
v_mfma_f32_16x16x32_bf16 v[56:59], v[164:167], v[88:91], v[56:59]
v_mfma_f32_16x16x32_bf16 v[60:63], v[164:167], v[92:95], v[60:63]
s_waitcnt lgkmcnt(2)
v_mfma_f32_16x16x32_bf16 v[32:35], a[72:75], v[72:75], v[32:35]
v_mfma_f32_16x16x32_bf16 v[36:39], a[72:75], v[76:79], v[36:39]
v_mfma_f32_16x16x32_bf16 v[40:43], a[152:155], v[72:75], v[40:43]
v_mfma_f32_16x16x32_bf16 v[44:47], a[152:155], v[76:79], v[44:47]
v_mfma_f32_16x16x32_bf16 v[48:51], a[232:235], v[72:75], v[48:51]
v_mfma_f32_16x16x32_bf16 v[52:55], a[232:235], v[76:79], v[52:55]
v_mfma_f32_16x16x32_bf16 v[56:59], v[168:171], v[72:75], v[56:59]
v_mfma_f32_16x16x32_bf16 v[60:63], v[168:171], v[76:79], v[60:63]
s_waitcnt lgkmcnt(0)
v_mfma_f32_16x16x32_bf16 v[32:35], a[76:79], v[80:83], v[32:35]
v_mfma_f32_16x16x32_bf16 v[36:39], a[76:79], v[84:87], v[36:39]
v_mfma_f32_16x16x32_bf16 v[40:43], a[156:159], v[80:83], v[40:43]
v_mfma_f32_16x16x32_bf16 v[44:47], a[156:159], v[84:87], v[44:47]
v_mfma_f32_16x16x32_bf16 v[48:51], a[236:239], v[80:83], v[48:51]
v_mfma_f32_16x16x32_bf16 v[52:55], a[236:239], v[84:87], v[52:55]
v_mfma_f32_16x16x32_bf16 v[56:59], v[172:175], v[80:83], v[56:59]
v_mfma_f32_16x16x32_bf16 v[60:63], v[172:175], v[84:87], v[60:63]
s_nop 0
v_cvt_pk_bf16_f32 v8, v32, v33
v_cvt_pk_bf16_f32 v9, v34, v35
v_cvt_pk_bf16_f32 v10, v40, v41
v_cvt_pk_bf16_f32 v11, v42, v43
s_add_u32 s34, s22, 1024
buffer_store_dwordx4 v[8:11], v1, s[4:7], s34 offen sc1
v_cvt_pk_bf16_f32 v12, v36, v37
v_cvt_pk_bf16_f32 v13, v38, v39
v_cvt_pk_bf16_f32 v14, v44, v45
v_cvt_pk_bf16_f32 v15, v46, v47
s_add_u32 s34, s22, 7168
buffer_store_dwordx4 v[12:15], v1, s[4:7], s34 offen sc1
v_cvt_pk_bf16_f32 v8, v48, v49
v_cvt_pk_bf16_f32 v9, v50, v51
v_cvt_pk_bf16_f32 v10, v56, v57
v_cvt_pk_bf16_f32 v11, v58, v59
s_add_u32 s34, s22, 2048
buffer_store_dwordx4 v[8:11], v1, s[4:7], s34 offen sc1
v_cvt_pk_bf16_f32 v12, v52, v53
v_cvt_pk_bf16_f32 v13, v54, v55
v_cvt_pk_bf16_f32 v14, v60, v61
v_cvt_pk_bf16_f32 v15, v62, v63
s_add_u32 s34, s22, 8192
buffer_store_dwordx4 v[12:15], v1, s[4:7], s34 offen sc1
s_waitcnt vmcnt(0)
s_barrier
s_add_u32 s17, s17, 1
s_cmp_lt_u32 s17, 64
s_cbranch_scc1 reca_ptop277
s_branch reca_exit1
reca_exit1:
reca_exitb3:
s_endpgm
.globl fin_kernel
.p2align 8
.type fin_kernel,@function
fin_kernel:
s_cmp_ge_u32 s2, 256
s_cbranch_scc1 fin_exit1
s_load_dwordx2 s[8:9], s[0:1], 96
v_lshrrev_b32 v6, 6, v0
v_and_b32 v7, 63, v0
s_and_b32 s13, s2, 7
v_readfirstlane_b32 s12, v6
v_lshlrev_b32 v1, 4, v7
v_add_u32 v2, 0x1000, v1
v_add_u32 v3, 0x2000, v1
s_lshr_b32 s14, s2, 3
s_lshl_b32 s15, s13, 2
s_add_u32 s15, s15, s12
s_waitcnt lgkmcnt(0)
s_mov_b32 s4, s8
s_mov_b32 s5, s9
s_mov_b32 s6, 0x10000000
s_mov_b32 s7, 0x20000
s_mov_b32 s27, 0x3dd53b95
v_and_b32 v6, 15, v7
v_lshrrev_b32 v8, 4, v7
v_mov_b32 v9, 0x80000000
v_lshlrev_b32 v10, 4, v6
v_lshl_add_u32 v10, v8, 7, v10
v_cmp_gt_u32 vcc, 8, v6
s_nop 1
v_cndmask_b32 v4, v9, v10, vcc
v_lshlrev_b32 v10, 3, v7
v_cmp_gt_u32 vcc, 32, v7
s_nop 1
v_cndmask_b32 v5, v9, v10, vcc
v_mov_b32 v10, 0xf149f2ca
v_cmp_le_u32 vcc, 2, v8
s_nop 1
v_cndmask_b32 v12, 0, v10, vcc
v_mov_b32 v13, v12
v_mov_b32 v14, v12
v_mov_b32 v15, v12
v_lshlrev_b32 v11, 2, v8
v_add_u32 v7, 0, v11
v_cmp_gt_u32 vcc, v7, v6
s_nop 1
v_cndmask_b32 v16, 0, v10, vcc
v_add_u32 v7, 1, v11
v_cmp_gt_u32 vcc, v7, v6
s_nop 1
v_cndmask_b32 v17, 0, v10, vcc
v_add_u32 v7, 2, v11
v_cmp_gt_u32 vcc, v7, v6
s_nop 1
v_cndmask_b32 v18, 0, v10, vcc
v_add_u32 v7, 3, v11
v_cmp_gt_u32 vcc, v7, v6
s_nop 1
v_cndmask_b32 v19, 0, v10, vcc
v_mov_b32 v20, 0x3f803f80
v_mov_b32 v21, 0x3f803f80
v_mov_b32 v22, 0x3f803f80
v_mov_b32 v23, 0x3f803f80
s_mul_i32 s16, s12, 6144
v_add_u32 v240, s16, v1
v_add_u32 v241, 49152, v240
s_mul_i32 s16, s12, 10
s_mul_i32 s16, s16, 192
s_mul_i32 s17, s13, 24
s_add_u32 s16, s16, s17
s_lshl_b32 s16, s16, 10
s_add_u32 s16, s16, 29884416
s_add_u32 s30, s16, 0
s_add_u32 s31, s16, 196608
s_add_u32 s32, s16, 393216
s_add_u32 s33, s16, 589824
s_add_u32 s34, s16, 786432
s_add_u32 s35, s16, 983040
s_add_u32 s36, s16, 1179648
s_add_u32 s37, s16, 1376256
s_add_u32 s38, s16, 1572864
s_add_u32 s39, s16, 1769472
s_cmp_lt_u32 s14, 30
s_cbranch_scc1 fin_odma3
s_lshl_b32 s17, s14, 1
s_add_u32 s17, s17, 0
s_and_b32 s17, s17, 7
s_lshl_b32 s16, s15, 3
s_add_u32 s16, s16, s17
s_mul_i32 s16, s16, 12288
s_add_u32 s20, s16, 44040192
s_add_u32 s21, s16, 37748736
s_add_u32 s22, s16, 40894464
s_lshl_b32 s17, s17, 5
s_add_u32 s17, s17, s15
s_mul_i32 s17, s17, 3072
s_add_u32 s23, s17, 47185920
s_add_u32 s24, s17, 47972352
s_lshl_b32 s17, s14, 1
s_add_u32 s17, s17, 1
s_and_b32 s17, s17, 7
s_lshl_b32 s16, s15, 3
s_add_u32 s16, s16, s17
s_mul_i32 s16, s16, 12288
s_add_u32 s40, s16, 44040192
s_add_u32 s41, s16, 37748736
s_add_u32 s42, s16, 40894464
s_lshl_b32 s17, s17, 5
s_add_u32 s17, s17, s15
s_mul_i32 s17, s17, 3072
s_add_u32 s43, s17, 47185920
s_add_u32 s44, s17, 47972352
buffer_load_dwordx4 v[136:139], v1, s[4:7], s21 offen offset:0
buffer_load_dwordx4 v[140:143], v1, s[4:7], s21 offen offset:1024
buffer_load_dwordx4 v[144:147], v1, s[4:7], s21 offen offset:2048
buffer_load_dwordx4 v[148:151], v1, s[4:7], s21 offen offset:3072
buffer_load_dwordx4 v[152:155], v2, s[4:7], s21 offen offset:0
buffer_load_dwordx4 v[156:159], v2, s[4:7], s21 offen offset:1024
buffer_load_dwordx4 v[160:163], v2, s[4:7], s21 offen offset:2048
buffer_load_dwordx4 v[164:167], v2, s[4:7], s21 offen offset:3072
buffer_load_dwordx4 v[168:171], v3, s[4:7], s21 offen offset:0
buffer_load_dwordx4 v[172:175], v3, s[4:7], s21 offen offset:1024
buffer_load_dwordx4 v[176:179], v3, s[4:7], s21 offen offset:2048
buffer_load_dwordx4 v[180:183], v3, s[4:7], s21 offen offset:3072
buffer_load_dwordx4 v[184:187], v4, s[4:7], s23 offen offset:0
buffer_load_dwordx4 v[188:191], v4, s[4:7], s23 offen offset:512
buffer_load_dwordx4 v[192:195], v4, s[4:7], s23 offen offset:1024
buffer_load_dwordx4 v[196:199], v4, s[4:7], s23 offen offset:1536
buffer_load_dwordx4 v[200:203], v4, s[4:7], s23 offen offset:2048
buffer_load_dwordx4 v[204:207], v4, s[4:7], s23 offen offset:2560
buffer_load_dwordx4 v[88:91], v1, s[4:7], s20 offen offset:0
buffer_load_dwordx4 v[92:95], v1, s[4:7], s20 offen offset:1024
buffer_load_dwordx4 v[96:99], v1, s[4:7], s20 offen offset:2048
buffer_load_dwordx4 v[100:103], v1, s[4:7], s20 offen offset:3072
buffer_load_dwordx4 v[104:107], v2, s[4:7], s20 offen offset:0
buffer_load_dwordx4 v[108:111], v2, s[4:7], s20 offen offset:1024
buffer_load_dwordx4 v[112:115], v2, s[4:7], s20 offen offset:2048
buffer_load_dwordx4 v[116:119], v2, s[4:7], s20 offen offset:3072
buffer_load_dwordx4 v[120:123], v3, s[4:7], s20 offen offset:0
buffer_load_dwordx4 v[124:127], v3, s[4:7], s20 offen offset:1024
buffer_load_dwordx4 v[128:131], v3, s[4:7], s20 offen offset:2048
buffer_load_dwordx4 v[132:135], v3, s[4:7], s20 offen offset:3072
buffer_load_dwordx4 a[0:3], v1, s[4:7], s41 offen offset:0
buffer_load_dwordx4 a[4:7], v1, s[4:7], s41 offen offset:1024
buffer_load_dwordx4 a[8:11], v1, s[4:7], s41 offen offset:2048
buffer_load_dwordx4 a[12:15], v1, s[4:7], s41 offen offset:3072
buffer_load_dwordx4 a[16:19], v2, s[4:7], s41 offen offset:0
buffer_load_dwordx4 a[20:23], v2, s[4:7], s41 offen offset:1024
buffer_load_dwordx4 a[24:27], v2, s[4:7], s41 offen offset:2048
buffer_load_dwordx4 a[28:31], v2, s[4:7], s41 offen offset:3072
buffer_load_dwordx4 a[32:35], v3, s[4:7], s41 offen offset:0
buffer_load_dwordx4 a[36:39], v3, s[4:7], s41 offen offset:1024
buffer_load_dwordx4 a[40:43], v3, s[4:7], s41 offen offset:2048
buffer_load_dwordx4 a[44:47], v3, s[4:7], s41 offen offset:3072
buffer_load_dwordx4 a[48:51], v4, s[4:7], s43 offen offset:0
buffer_load_dwordx4 a[52:55], v4, s[4:7], s43 offen offset:512
buffer_load_dwordx4 a[56:59], v4, s[4:7], s43 offen offset:1024
buffer_load_dwordx4 a[60:63], v4, s[4:7], s43 offen offset:1536
buffer_load_dwordx4 a[64:67], v4, s[4:7], s43 offen offset:2048
buffer_load_dwordx4 a[68:71], v4, s[4:7], s43 offen offset:2560
buffer_load_dwordx4 a[72:75], v1, s[4:7], s40 offen offset:0
buffer_load_dwordx4 a[76:79], v1, s[4:7], s40 offen offset:1024
buffer_load_dwordx4 a[80:83], v1, s[4:7], s40 offen offset:2048
buffer_load_dwordx4 a[84:87], v1, s[4:7], s40 offen offset:3072
buffer_load_dwordx4 a[88:91], v2, s[4:7], s40 offen offset:0
buffer_load_dwordx4 a[92:95], v2, s[4:7], s40 offen offset:1024
buffer_load_dwordx4 a[96:99], v2, s[4:7], s40 offen offset:2048
buffer_load_dwordx4 a[100:103], v2, s[4:7], s40 offen offset:3072
buffer_load_dwordx4 a[104:107], v3, s[4:7], s40 offen offset:0
buffer_load_dwordx4 a[108:111], v3, s[4:7], s40 offen offset:1024
buffer_load_dwordx4 a[112:115], v3, s[4:7], s40 offen offset:2048
buffer_load_dwordx4 a[116:119], v3, s[4:7], s40 offen offset:3072
s_waitcnt vmcnt(35)
v_mfma_f32_16x16x32_bf16 v[24:27], v[184:187], v[88:91], v[12:15]
v_mfma_f32_16x16x32_bf16 v[28:31], v[136:139], v[88:91], v[16:19]
v_mfma_f32_16x16x32_bf16 v[32:35], v[184:187], v[112:115], v[12:15]
v_mfma_f32_16x16x32_bf16 v[36:39], v[136:139], v[112:115], 0
v_mfma_f32_16x16x32_bf16 v[40:43], v[160:163], v[112:115], v[16:19]
s_waitcnt vmcnt(34)
v_mfma_f32_16x16x32_bf16 v[24:27], v[188:191], v[92:95], v[24:27]
v_mfma_f32_16x16x32_bf16 v[28:31], v[140:143], v[92:95], v[28:31]
v_mfma_f32_16x16x32_bf16 v[32:35], v[188:191], v[116:119], v[32:35]
v_mfma_f32_16x16x32_bf16 v[36:39], v[140:143], v[116:119], v[36:39]
v_mfma_f32_16x16x32_bf16 v[40:43], v[164:167], v[116:119], v[40:43]
s_waitcnt vmcnt(33)
v_mfma_f32_16x16x32_bf16 v[24:27], v[192:195], v[96:99], v[24:27]
v_mfma_f32_16x16x32_bf16 v[28:31], v[144:147], v[96:99], v[28:31]
v_mfma_f32_16x16x32_bf16 v[32:35], v[192:195], v[120:123], v[32:35]
v_mfma_f32_16x16x32_bf16 v[36:39], v[144:147], v[120:123], v[36:39]
v_mfma_f32_16x16x32_bf16 v[40:43], v[168:171], v[120:123], v[40:43]
s_waitcnt vmcnt(32)
v_mfma_f32_16x16x32_bf16 v[24:27], v[196:199], v[100:103], v[24:27]
v_mfma_f32_16x16x32_bf16 v[28:31], v[148:151], v[100:103], v[28:31]
v_mfma_f32_16x16x32_bf16 v[32:35], v[196:199], v[124:127], v[32:35]
v_mfma_f32_16x16x32_bf16 v[36:39], v[148:151], v[124:127], v[36:39]
v_mfma_f32_16x16x32_bf16 v[40:43], v[172:175], v[124:127], v[40:43]
s_waitcnt vmcnt(31)
v_mfma_f32_16x16x32_bf16 v[24:27], v[200:203], v[104:107], v[24:27]
v_mfma_f32_16x16x32_bf16 v[28:31], v[152:155], v[104:107], v[28:31]
v_mfma_f32_16x16x32_bf16 v[32:35], v[200:203], v[128:131], v[32:35]
v_mfma_f32_16x16x32_bf16 v[36:39], v[152:155], v[128:131], v[36:39]
v_mfma_f32_16x16x32_bf16 v[40:43], v[176:179], v[128:131], v[40:43]
s_waitcnt vmcnt(30)
v_mfma_f32_16x16x32_bf16 v[24:27], v[204:207], v[108:111], v[24:27]
v_mfma_f32_16x16x32_bf16 v[28:31], v[156:159], v[108:111], v[28:31]
v_mfma_f32_16x16x32_bf16 v[32:35], v[204:207], v[132:135], v[32:35]
v_mfma_f32_16x16x32_bf16 v[36:39], v[156:159], v[132:135], v[36:39]
v_mfma_f32_16x16x32_bf16 v[40:43], v[180:183], v[132:135], v[40:43]
buffer_load_dwordx4 v[88:91], v1, s[4:7], s22 offen offset:0
buffer_load_dwordx4 v[92:95], v1, s[4:7], s22 offen offset:1024
buffer_load_dwordx4 v[96:99], v1, s[4:7], s22 offen offset:2048
buffer_load_dwordx4 v[100:103], v1, s[4:7], s22 offen offset:3072
buffer_load_dwordx4 v[104:107], v2, s[4:7], s22 offen offset:0
buffer_load_dwordx4 v[108:111], v2, s[4:7], s22 offen offset:1024
buffer_load_dwordx4 v[112:115], v2, s[4:7], s22 offen offset:2048
buffer_load_dwordx4 v[116:119], v2, s[4:7], s22 offen offset:3072
buffer_load_dwordx4 v[120:123], v3, s[4:7], s22 offen offset:0
buffer_load_dwordx4 v[124:127], v3, s[4:7], s22 offen offset:1024
buffer_load_dwordx4 v[128:131], v3, s[4:7], s22 offen offset:2048
buffer_load_dwordx4 v[132:135], v3, s[4:7], s22 offen offset:3072
buffer_load_dwordx2 v[136:137], v5, s[4:7], s24 offen offset:0
buffer_load_dwordx2 v[138:139], v5, s[4:7], s24 offen offset:256
buffer_load_dwordx2 v[140:141], v5, s[4:7], s24 offen offset:512
buffer_load_dwordx2 v[142:143], v5, s[4:7], s24 offen offset:768
buffer_load_dwordx2 v[144:145], v5, s[4:7], s24 offen offset:1024
buffer_load_dwordx2 v[146:147], v5, s[4:7], s24 offen offset:1280
buffer_load_dwordx2 v[148:149], v5, s[4:7], s24 offen offset:1536
buffer_load_dwordx2 v[150:151], v5, s[4:7], s24 offen offset:1792
buffer_load_dwordx2 v[152:153], v5, s[4:7], s24 offen offset:2048
buffer_load_dwordx2 v[154:155], v5, s[4:7], s24 offen offset:2304
buffer_load_dwordx2 v[156:157], v5, s[4:7], s24 offen offset:2560
buffer_load_dwordx2 v[158:159], v5, s[4:7], s24 offen offset:2816
v_max3_f32 v6, v24, v25, v26
v_max3_f32 v6, v6, v27, v28
v_max3_f32 v6, v6, v29, v30
v_max_f32 v6, v6, v31
v_mov_b32 v7, v6
s_nop 1
v_permlane32_swap_b32 v6, v7
v_max_f32 v6, v6, v7
v_mov_b32 v7, v6
s_nop 1
v_permlane16_swap_b32 v6, v7
v_max_f32 v6, v6, v7
v_mul_f32 v6, s27, v6
v_fma_f32 v24, v24, s27, -v6
v_fma_f32 v25, v25, s27, -v6
v_fma_f32 v26, v26, s27, -v6
v_fma_f32 v27, v27, s27, -v6
v_fma_f32 v28, v28, s27, -v6
v_fma_f32 v29, v29, s27, -v6
v_fma_f32 v30, v30, s27, -v6
v_fma_f32 v31, v31, s27, -v6
v_exp_f32 v24, v24
v_exp_f32 v25, v25
v_exp_f32 v26, v26
v_exp_f32 v27, v27
v_exp_f32 v28, v28
v_exp_f32 v29, v29
v_exp_f32 v30, v30
v_exp_f32 v31, v31
v_max3_f32 v8, v32, v33, v34
v_max3_f32 v8, v8, v35, v36
v_max3_f32 v8, v8, v37, v38
v_max3_f32 v8, v8, v39, v40
v_max3_f32 v8, v8, v41, v42
v_max_f32 v8, v8, v43
v_mov_b32 v10, v8
s_nop 1
v_permlane32_swap_b32 v8, v10
v_max_f32 v8, v8, v10
v_mov_b32 v10, v8
s_nop 1
v_permlane16_swap_b32 v8, v10
v_max_f32 v8, v8, v10
v_mul_f32 v8, s27, v8
v_fma_f32 v32, v32, s27, -v8
v_fma_f32 v33, v33, s27, -v8
v_fma_f32 v34, v34, s27, -v8
v_fma_f32 v35, v35, s27, -v8
v_fma_f32 v36, v36, s27, -v8
v_fma_f32 v37, v37, s27, -v8
v_fma_f32 v38, v38, s27, -v8
v_fma_f32 v39, v39, s27, -v8
v_fma_f32 v40, v40, s27, -v8
v_fma_f32 v41, v41, s27, -v8
v_fma_f32 v42, v42, s27, -v8
v_fma_f32 v43, v43, s27, -v8
v_exp_f32 v32, v32
v_exp_f32 v33, v33
v_exp_f32 v34, v34
v_exp_f32 v35, v35
v_exp_f32 v36, v36
v_exp_f32 v37, v37
v_exp_f32 v38, v38
v_exp_f32 v39, v39
v_exp_f32 v40, v40
v_exp_f32 v41, v41
v_exp_f32 v42, v42
v_exp_f32 v43, v43
v_cvt_pk_bf16_f32 v44, v24, v25
v_cvt_pk_bf16_f32 v45, v26, v27
v_cvt_pk_bf16_f32 v46, v28, v29
v_cvt_pk_bf16_f32 v47, v30, v31
v_cvt_pk_bf16_f32 v48, v32, v33
v_cvt_pk_bf16_f32 v49, v34, v35
v_cvt_pk_bf16_f32 v50, v36, v37
v_cvt_pk_bf16_f32 v51, v38, v39
v_cvt_pk_bf16_f32 v52, v40, v41
v_cvt_pk_bf16_f32 v53, v42, v43
v_mfma_f32_16x16x16_bf16 v[56:59], v[20:21], v[44:45], 0
v_mfma_f32_16x16x16_bf16 v[60:63], v[20:21], v[48:49], 0
v_mfma_f32_16x16x16_bf16 v[56:59], v[20:21], v[46:47], v[56:59]
v_mfma_f32_16x16x32_bf16 v[60:63], v[20:23], v[50:53], v[60:63]
s_nop 6
v_rcp_f32 v10, v56
v_rcp_f32 v11, v60
s_waitcnt vmcnt(0)
v_mfma_f32_16x16x16_bf16 v[64:67], v[136:137], v[44:45], 0
v_mfma_f32_16x16x16_bf16 v[68:71], v[136:137], v[48:49], 0
v_mfma_f32_16x16x16_bf16 v[64:67], v[88:89], v[46:47], v[64:67]
v_mfma_f32_16x16x32_bf16 v[68:71], v[88:91], v[50:53], v[68:71]
v_mfma_f32_16x16x16_bf16 v[72:75], v[138:139], v[44:45], 0
v_mfma_f32_16x16x16_bf16 v[76:79], v[138:139], v[48:49], 0
v_mfma_f32_16x16x16_bf16 v[72:75], v[92:93], v[46:47], v[72:75]
v_mfma_f32_16x16x32_bf16 v[76:79], v[92:95], v[50:53], v[76:79]
s_nop 2
v_mul_f32 v64, v64, v10
v_mul_f32 v65, v65, v10
v_mul_f32 v66, v66, v10
v_mul_f32 v67, v67, v10
v_cvt_pk_bf16_f32 v80, v64, v65
v_cvt_pk_bf16_f32 v81, v66, v67
v_mul_f32 v72, v72, v10
v_mul_f32 v73, v73, v10
v_mul_f32 v74, v74, v10
v_mul_f32 v75, v75, v10
v_cvt_pk_bf16_f32 v82, v72, v73
v_cvt_pk_bf16_f32 v83, v74, v75
ds_write_b128 v240, v[80:83] offset:0
v_mul_f32 v68, v68, v11
v_mul_f32 v69, v69, v11
v_mul_f32 v70, v70, v11
v_mul_f32 v71, v71, v11
v_cvt_pk_bf16_f32 v84, v68, v69
v_cvt_pk_bf16_f32 v85, v70, v71
v_mul_f32 v76, v76, v11
v_mul_f32 v77, v77, v11
v_mul_f32 v78, v78, v11
v_mul_f32 v79, v79, v11
v_cvt_pk_bf16_f32 v86, v76, v77
v_cvt_pk_bf16_f32 v87, v78, v79
ds_write_b128 v240, v[84:87] offset:24576
v_mfma_f32_16x16x16_bf16 v[64:67], v[140:141], v[44:45], 0
v_mfma_f32_16x16x16_bf16 v[68:71], v[140:141], v[48:49], 0
v_mfma_f32_16x16x16_bf16 v[64:67], v[96:97], v[46:47], v[64:67]
v_mfma_f32_16x16x32_bf16 v[68:71], v[96:99], v[50:53], v[68:71]
v_mfma_f32_16x16x16_bf16 v[72:75], v[142:143], v[44:45], 0
v_mfma_f32_16x16x16_bf16 v[76:79], v[142:143], v[48:49], 0
v_mfma_f32_16x16x16_bf16 v[72:75], v[100:101], v[46:47], v[72:75]
v_mfma_f32_16x16x32_bf16 v[76:79], v[100:103], v[50:53], v[76:79]
s_nop 2
v_mul_f32 v64, v64, v10
v_mul_f32 v65, v65, v10
v_mul_f32 v66, v66, v10
v_mul_f32 v67, v67, v10
v_cvt_pk_bf16_f32 v80, v64, v65
v_cvt_pk_bf16_f32 v81, v66, v67
v_mul_f32 v72, v72, v10
v_mul_f32 v73, v73, v10
v_mul_f32 v74, v74, v10
v_mul_f32 v75, v75, v10
v_cvt_pk_bf16_f32 v82, v72, v73
v_cvt_pk_bf16_f32 v83, v74, v75
ds_write_b128 v240, v[80:83] offset:1024
v_mul_f32 v68, v68, v11
v_mul_f32 v69, v69, v11
v_mul_f32 v70, v70, v11
v_mul_f32 v71, v71, v11
v_cvt_pk_bf16_f32 v84, v68, v69
v_cvt_pk_bf16_f32 v85, v70, v71
v_mul_f32 v76, v76, v11
v_mul_f32 v77, v77, v11
v_mul_f32 v78, v78, v11
v_mul_f32 v79, v79, v11
v_cvt_pk_bf16_f32 v86, v76, v77
v_cvt_pk_bf16_f32 v87, v78, v79
ds_write_b128 v240, v[84:87] offset:25600
v_mfma_f32_16x16x16_bf16 v[64:67], v[144:145], v[44:45], 0
v_mfma_f32_16x16x16_bf16 v[68:71], v[144:145], v[48:49], 0
v_mfma_f32_16x16x16_bf16 v[64:67], v[104:105], v[46:47], v[64:67]
v_mfma_f32_16x16x32_bf16 v[68:71], v[104:107], v[50:53], v[68:71]
v_mfma_f32_16x16x16_bf16 v[72:75], v[146:147], v[44:45], 0
v_mfma_f32_16x16x16_bf16 v[76:79], v[146:147], v[48:49], 0
v_mfma_f32_16x16x16_bf16 v[72:75], v[108:109], v[46:47], v[72:75]
v_mfma_f32_16x16x32_bf16 v[76:79], v[108:111], v[50:53], v[76:79]
s_nop 2
v_mul_f32 v64, v64, v10
v_mul_f32 v65, v65, v10
v_mul_f32 v66, v66, v10
v_mul_f32 v67, v67, v10
v_cvt_pk_bf16_f32 v80, v64, v65
v_cvt_pk_bf16_f32 v81, v66, v67
v_mul_f32 v72, v72, v10
v_mul_f32 v73, v73, v10
v_mul_f32 v74, v74, v10
v_mul_f32 v75, v75, v10
v_cvt_pk_bf16_f32 v82, v72, v73
v_cvt_pk_bf16_f32 v83, v74, v75
ds_write_b128 v240, v[80:83] offset:2048
v_mul_f32 v68, v68, v11
v_mul_f32 v69, v69, v11
v_mul_f32 v70, v70, v11
v_mul_f32 v71, v71, v11
v_cvt_pk_bf16_f32 v84, v68, v69
v_cvt_pk_bf16_f32 v85, v70, v71
v_mul_f32 v76, v76, v11
v_mul_f32 v77, v77, v11
v_mul_f32 v78, v78, v11
v_mul_f32 v79, v79, v11
v_cvt_pk_bf16_f32 v86, v76, v77
v_cvt_pk_bf16_f32 v87, v78, v79
ds_write_b128 v240, v[84:87] offset:26624
v_mfma_f32_16x16x16_bf16 v[64:67], v[148:149], v[44:45], 0
v_mfma_f32_16x16x16_bf16 v[68:71], v[148:149], v[48:49], 0
v_mfma_f32_16x16x16_bf16 v[64:67], v[112:113], v[46:47], v[64:67]
v_mfma_f32_16x16x32_bf16 v[68:71], v[112:115], v[50:53], v[68:71]
v_mfma_f32_16x16x16_bf16 v[72:75], v[150:151], v[44:45], 0
v_mfma_f32_16x16x16_bf16 v[76:79], v[150:151], v[48:49], 0
v_mfma_f32_16x16x16_bf16 v[72:75], v[116:117], v[46:47], v[72:75]
v_mfma_f32_16x16x32_bf16 v[76:79], v[116:119], v[50:53], v[76:79]
s_nop 2
v_mul_f32 v64, v64, v10
v_mul_f32 v65, v65, v10
v_mul_f32 v66, v66, v10
v_mul_f32 v67, v67, v10
v_cvt_pk_bf16_f32 v80, v64, v65
v_cvt_pk_bf16_f32 v81, v66, v67
v_mul_f32 v72, v72, v10
v_mul_f32 v73, v73, v10
v_mul_f32 v74, v74, v10
v_mul_f32 v75, v75, v10
v_cvt_pk_bf16_f32 v82, v72, v73
v_cvt_pk_bf16_f32 v83, v74, v75
ds_write_b128 v240, v[80:83] offset:3072
v_mul_f32 v68, v68, v11
v_mul_f32 v69, v69, v11
v_mul_f32 v70, v70, v11
v_mul_f32 v71, v71, v11
v_cvt_pk_bf16_f32 v84, v68, v69
v_cvt_pk_bf16_f32 v85, v70, v71
v_mul_f32 v76, v76, v11
v_mul_f32 v77, v77, v11
v_mul_f32 v78, v78, v11
v_mul_f32 v79, v79, v11
v_cvt_pk_bf16_f32 v86, v76, v77
v_cvt_pk_bf16_f32 v87, v78, v79
ds_write_b128 v240, v[84:87] offset:27648
v_mfma_f32_16x16x16_bf16 v[64:67], v[152:153], v[44:45], 0
v_mfma_f32_16x16x16_bf16 v[68:71], v[152:153], v[48:49], 0
v_mfma_f32_16x16x16_bf16 v[64:67], v[120:121], v[46:47], v[64:67]
v_mfma_f32_16x16x32_bf16 v[68:71], v[120:123], v[50:53], v[68:71]
v_mfma_f32_16x16x16_bf16 v[72:75], v[154:155], v[44:45], 0
v_mfma_f32_16x16x16_bf16 v[76:79], v[154:155], v[48:49], 0
v_mfma_f32_16x16x16_bf16 v[72:75], v[124:125], v[46:47], v[72:75]
v_mfma_f32_16x16x32_bf16 v[76:79], v[124:127], v[50:53], v[76:79]
s_nop 2
v_mul_f32 v64, v64, v10
v_mul_f32 v65, v65, v10
v_mul_f32 v66, v66, v10
v_mul_f32 v67, v67, v10
v_cvt_pk_bf16_f32 v80, v64, v65
v_cvt_pk_bf16_f32 v81, v66, v67
v_mul_f32 v72, v72, v10
v_mul_f32 v73, v73, v10
v_mul_f32 v74, v74, v10
v_mul_f32 v75, v75, v10
v_cvt_pk_bf16_f32 v82, v72, v73
v_cvt_pk_bf16_f32 v83, v74, v75
ds_write_b128 v240, v[80:83] offset:4096
v_mul_f32 v68, v68, v11
v_mul_f32 v69, v69, v11
v_mul_f32 v70, v70, v11
v_mul_f32 v71, v71, v11
v_cvt_pk_bf16_f32 v84, v68, v69
v_cvt_pk_bf16_f32 v85, v70, v71
v_mul_f32 v76, v76, v11
v_mul_f32 v77, v77, v11
v_mul_f32 v78, v78, v11
v_mul_f32 v79, v79, v11
v_cvt_pk_bf16_f32 v86, v76, v77
v_cvt_pk_bf16_f32 v87, v78, v79
ds_write_b128 v240, v[84:87] offset:28672
v_mfma_f32_16x16x16_bf16 v[64:67], v[156:157], v[44:45], 0
v_mfma_f32_16x16x16_bf16 v[68:71], v[156:157], v[48:49], 0
v_mfma_f32_16x16x16_bf16 v[64:67], v[128:129], v[46:47], v[64:67]
v_mfma_f32_16x16x32_bf16 v[68:71], v[128:131], v[50:53], v[68:71]
v_mfma_f32_16x16x16_bf16 v[72:75], v[158:159], v[44:45], 0
v_mfma_f32_16x16x16_bf16 v[76:79], v[158:159], v[48:49], 0
v_mfma_f32_16x16x16_bf16 v[72:75], v[132:133], v[46:47], v[72:75]
v_mfma_f32_16x16x32_bf16 v[76:79], v[132:135], v[50:53], v[76:79]
s_nop 2
v_mul_f32 v64, v64, v10
v_mul_f32 v65, v65, v10
v_mul_f32 v66, v66, v10
v_mul_f32 v67, v67, v10
v_cvt_pk_bf16_f32 v80, v64, v65
v_cvt_pk_bf16_f32 v81, v66, v67
v_mul_f32 v72, v72, v10
v_mul_f32 v73, v73, v10
v_mul_f32 v74, v74, v10
v_mul_f32 v75, v75, v10
v_cvt_pk_bf16_f32 v82, v72, v73
v_cvt_pk_bf16_f32 v83, v74, v75
ds_write_b128 v240, v[80:83] offset:5120
v_mul_f32 v68, v68, v11
v_mul_f32 v69, v69, v11
v_mul_f32 v70, v70, v11
v_mul_f32 v71, v71, v11
v_cvt_pk_bf16_f32 v84, v68, v69
v_cvt_pk_bf16_f32 v85, v70, v71
v_mul_f32 v76, v76, v11
v_mul_f32 v77, v77, v11
v_mul_f32 v78, v78, v11
v_mul_f32 v79, v79, v11
v_cvt_pk_bf16_f32 v86, v76, v77
v_cvt_pk_bf16_f32 v87, v78, v79
ds_write_b128 v240, v[84:87] offset:29696
v_mfma_f32_16x16x32_bf16 v[24:27], a[48:51], a[72:75], v[12:15]
v_mfma_f32_16x16x32_bf16 v[28:31], a[0:3], a[72:75], v[16:19]
v_mfma_f32_16x16x32_bf16 v[32:35], a[48:51], a[96:99], v[12:15]
v_mfma_f32_16x16x32_bf16 v[36:39], a[0:3], a[96:99], 0
v_mfma_f32_16x16x32_bf16 v[40:43], a[24:27], a[96:99], v[16:19]
v_mfma_f32_16x16x32_bf16 v[24:27], a[52:55], a[76:79], v[24:27]
v_mfma_f32_16x16x32_bf16 v[28:31], a[4:7], a[76:79], v[28:31]
v_mfma_f32_16x16x32_bf16 v[32:35], a[52:55], a[100:103], v[32:35]
v_mfma_f32_16x16x32_bf16 v[36:39], a[4:7], a[100:103], v[36:39]
v_mfma_f32_16x16x32_bf16 v[40:43], a[28:31], a[100:103], v[40:43]
v_mfma_f32_16x16x32_bf16 v[24:27], a[56:59], a[80:83], v[24:27]
v_mfma_f32_16x16x32_bf16 v[28:31], a[8:11], a[80:83], v[28:31]
v_mfma_f32_16x16x32_bf16 v[32:35], a[56:59], a[104:107], v[32:35]
v_mfma_f32_16x16x32_bf16 v[36:39], a[8:11], a[104:107], v[36:39]
v_mfma_f32_16x16x32_bf16 v[40:43], a[32:35], a[104:107], v[40:43]
v_mfma_f32_16x16x32_bf16 v[24:27], a[60:63], a[84:87], v[24:27]
v_mfma_f32_16x16x32_bf16 v[28:31], a[12:15], a[84:87], v[28:31]
v_mfma_f32_16x16x32_bf16 v[32:35], a[60:63], a[108:111], v[32:35]
v_mfma_f32_16x16x32_bf16 v[36:39], a[12:15], a[108:111], v[36:39]
v_mfma_f32_16x16x32_bf16 v[40:43], a[36:39], a[108:111], v[40:43]
v_mfma_f32_16x16x32_bf16 v[24:27], a[64:67], a[88:91], v[24:27]
v_mfma_f32_16x16x32_bf16 v[28:31], a[16:19], a[88:91], v[28:31]
v_mfma_f32_16x16x32_bf16 v[32:35], a[64:67], a[112:115], v[32:35]
v_mfma_f32_16x16x32_bf16 v[36:39], a[16:19], a[112:115], v[36:39]
v_mfma_f32_16x16x32_bf16 v[40:43], a[40:43], a[112:115], v[40:43]
v_mfma_f32_16x16x32_bf16 v[24:27], a[68:71], a[92:95], v[24:27]
v_mfma_f32_16x16x32_bf16 v[28:31], a[20:23], a[92:95], v[28:31]
v_mfma_f32_16x16x32_bf16 v[32:35], a[68:71], a[116:119], v[32:35]
v_mfma_f32_16x16x32_bf16 v[36:39], a[20:23], a[116:119], v[36:39]
v_mfma_f32_16x16x32_bf16 v[40:43], a[44:47], a[116:119], v[40:43]
buffer_load_dwordx4 v[88:91], v1, s[4:7], s42 offen offset:0
buffer_load_dwordx4 v[92:95], v1, s[4:7], s42 offen offset:1024
buffer_load_dwordx4 v[96:99], v1, s[4:7], s42 offen offset:2048
buffer_load_dwordx4 v[100:103], v1, s[4:7], s42 offen offset:3072
buffer_load_dwordx4 v[104:107], v2, s[4:7], s42 offen offset:0
buffer_load_dwordx4 v[108:111], v2, s[4:7], s42 offen offset:1024
buffer_load_dwordx4 v[112:115], v2, s[4:7], s42 offen offset:2048
buffer_load_dwordx4 v[116:119], v2, s[4:7], s42 offen offset:3072
buffer_load_dwordx4 v[120:123], v3, s[4:7], s42 offen offset:0
buffer_load_dwordx4 v[124:127], v3, s[4:7], s42 offen offset:1024
buffer_load_dwordx4 v[128:131], v3, s[4:7], s42 offen offset:2048
buffer_load_dwordx4 v[132:135], v3, s[4:7], s42 offen offset:3072
buffer_load_dwordx2 v[136:137], v5, s[4:7], s44 offen offset:0
buffer_load_dwordx2 v[138:139], v5, s[4:7], s44 offen offset:256
buffer_load_dwordx2 v[140:141], v5, s[4:7], s44 offen offset:512
buffer_load_dwordx2 v[142:143], v5, s[4:7], s44 offen offset:768
buffer_load_dwordx2 v[144:145], v5, s[4:7], s44 offen offset:1024
buffer_load_dwordx2 v[146:147], v5, s[4:7], s44 offen offset:1280
buffer_load_dwordx2 v[148:149], v5, s[4:7], s44 offen offset:1536
buffer_load_dwordx2 v[150:151], v5, s[4:7], s44 offen offset:1792
buffer_load_dwordx2 v[152:153], v5, s[4:7], s44 offen offset:2048
buffer_load_dwordx2 v[154:155], v5, s[4:7], s44 offen offset:2304
buffer_load_dwordx2 v[156:157], v5, s[4:7], s44 offen offset:2560
buffer_load_dwordx2 v[158:159], v5, s[4:7], s44 offen offset:2816
v_max3_f32 v6, v24, v25, v26
v_max3_f32 v6, v6, v27, v28
v_max3_f32 v6, v6, v29, v30
v_max_f32 v6, v6, v31
v_mov_b32 v7, v6
s_nop 1
v_permlane32_swap_b32 v6, v7
v_max_f32 v6, v6, v7
v_mov_b32 v7, v6
s_nop 1
v_permlane16_swap_b32 v6, v7
v_max_f32 v6, v6, v7
v_mul_f32 v6, s27, v6
v_fma_f32 v24, v24, s27, -v6
v_fma_f32 v25, v25, s27, -v6
v_fma_f32 v26, v26, s27, -v6
v_fma_f32 v27, v27, s27, -v6
v_fma_f32 v28, v28, s27, -v6
v_fma_f32 v29, v29, s27, -v6
v_fma_f32 v30, v30, s27, -v6
v_fma_f32 v31, v31, s27, -v6
v_exp_f32 v24, v24
v_exp_f32 v25, v25
v_exp_f32 v26, v26
v_exp_f32 v27, v27
v_exp_f32 v28, v28
v_exp_f32 v29, v29
v_exp_f32 v30, v30
v_exp_f32 v31, v31
v_max3_f32 v8, v32, v33, v34
v_max3_f32 v8, v8, v35, v36
v_max3_f32 v8, v8, v37, v38
v_max3_f32 v8, v8, v39, v40
v_max3_f32 v8, v8, v41, v42
v_max_f32 v8, v8, v43
v_mov_b32 v10, v8
s_nop 1
v_permlane32_swap_b32 v8, v10
v_max_f32 v8, v8, v10
v_mov_b32 v10, v8
s_nop 1
v_permlane16_swap_b32 v8, v10
v_max_f32 v8, v8, v10
v_mul_f32 v8, s27, v8
v_fma_f32 v32, v32, s27, -v8
v_fma_f32 v33, v33, s27, -v8
v_fma_f32 v34, v34, s27, -v8
v_fma_f32 v35, v35, s27, -v8
v_fma_f32 v36, v36, s27, -v8
v_fma_f32 v37, v37, s27, -v8
v_fma_f32 v38, v38, s27, -v8
v_fma_f32 v39, v39, s27, -v8
v_fma_f32 v40, v40, s27, -v8
v_fma_f32 v41, v41, s27, -v8
v_fma_f32 v42, v42, s27, -v8
v_fma_f32 v43, v43, s27, -v8
v_exp_f32 v32, v32
v_exp_f32 v33, v33
v_exp_f32 v34, v34
v_exp_f32 v35, v35
v_exp_f32 v36, v36
v_exp_f32 v37, v37
v_exp_f32 v38, v38
v_exp_f32 v39, v39
v_exp_f32 v40, v40
v_exp_f32 v41, v41
v_exp_f32 v42, v42
v_exp_f32 v43, v43
v_cvt_pk_bf16_f32 v44, v24, v25
v_cvt_pk_bf16_f32 v45, v26, v27
v_cvt_pk_bf16_f32 v46, v28, v29
v_cvt_pk_bf16_f32 v47, v30, v31
v_cvt_pk_bf16_f32 v48, v32, v33
v_cvt_pk_bf16_f32 v49, v34, v35
v_cvt_pk_bf16_f32 v50, v36, v37
v_cvt_pk_bf16_f32 v51, v38, v39
v_cvt_pk_bf16_f32 v52, v40, v41
v_cvt_pk_bf16_f32 v53, v42, v43
v_mfma_f32_16x16x16_bf16 v[56:59], v[20:21], v[44:45], 0
v_mfma_f32_16x16x16_bf16 v[60:63], v[20:21], v[48:49], 0
v_mfma_f32_16x16x16_bf16 v[56:59], v[20:21], v[46:47], v[56:59]
v_mfma_f32_16x16x32_bf16 v[60:63], v[20:23], v[50:53], v[60:63]
s_nop 6
v_rcp_f32 v10, v56
v_rcp_f32 v11, v60
s_waitcnt vmcnt(0)
buffer_load_dwordx4 a[160:163], v1, s[4:7], s30 offen offset:0
buffer_load_dwordx4 a[164:167], v1, s[4:7], s31 offen offset:0
buffer_load_dwordx4 a[168:171], v1, s[4:7], s32 offen offset:0
buffer_load_dwordx4 a[172:175], v1, s[4:7], s33 offen offset:0
buffer_load_dwordx4 a[176:179], v1, s[4:7], s34 offen offset:0
buffer_load_dwordx4 a[180:183], v1, s[4:7], s35 offen offset:0
buffer_load_dwordx4 a[184:187], v1, s[4:7], s36 offen offset:0
buffer_load_dwordx4 a[188:191], v1, s[4:7], s37 offen offset:0
buffer_load_dwordx4 a[192:195], v1, s[4:7], s38 offen offset:0
buffer_load_dwordx4 a[196:199], v1, s[4:7], s39 offen offset:0
buffer_load_dwordx4 a[200:203], v1, s[4:7], s30 offen offset:1024
buffer_load_dwordx4 a[204:207], v1, s[4:7], s31 offen offset:1024
buffer_load_dwordx4 a[208:211], v1, s[4:7], s32 offen offset:1024
buffer_load_dwordx4 a[212:215], v1, s[4:7], s33 offen offset:1024
buffer_load_dwordx4 a[216:219], v1, s[4:7], s34 offen offset:1024
buffer_load_dwordx4 a[220:223], v1, s[4:7], s35 offen offset:1024
buffer_load_dwordx4 a[224:227], v1, s[4:7], s36 offen offset:1024
buffer_load_dwordx4 a[228:231], v1, s[4:7], s37 offen offset:1024
buffer_load_dwordx4 a[232:235], v1, s[4:7], s38 offen offset:1024
buffer_load_dwordx4 a[236:239], v1, s[4:7], s39 offen offset:1024
v_mfma_f32_16x16x16_bf16 v[64:67], v[136:137], v[44:45], 0
v_mfma_f32_16x16x16_bf16 v[68:71], v[136:137], v[48:49], 0
v_mfma_f32_16x16x16_bf16 v[64:67], v[88:89], v[46:47], v[64:67]
v_mfma_f32_16x16x32_bf16 v[68:71], v[88:91], v[50:53], v[68:71]
v_mfma_f32_16x16x16_bf16 v[72:75], v[138:139], v[44:45], 0
v_mfma_f32_16x16x16_bf16 v[76:79], v[138:139], v[48:49], 0
v_mfma_f32_16x16x16_bf16 v[72:75], v[92:93], v[46:47], v[72:75]
v_mfma_f32_16x16x32_bf16 v[76:79], v[92:95], v[50:53], v[76:79]
s_nop 2
v_mul_f32 v64, v64, v10
v_mul_f32 v65, v65, v10
v_mul_f32 v66, v66, v10
v_mul_f32 v67, v67, v10
v_cvt_pk_bf16_f32 v80, v64, v65
v_cvt_pk_bf16_f32 v81, v66, v67
v_mul_f32 v72, v72, v10
v_mul_f32 v73, v73, v10
v_mul_f32 v74, v74, v10
v_mul_f32 v75, v75, v10
v_cvt_pk_bf16_f32 v82, v72, v73
v_cvt_pk_bf16_f32 v83, v74, v75
ds_write_b128 v241, v[80:83] offset:0
v_mul_f32 v68, v68, v11
v_mul_f32 v69, v69, v11
v_mul_f32 v70, v70, v11
v_mul_f32 v71, v71, v11
v_cvt_pk_bf16_f32 v84, v68, v69
v_cvt_pk_bf16_f32 v85, v70, v71
v_mul_f32 v76, v76, v11
v_mul_f32 v77, v77, v11
v_mul_f32 v78, v78, v11
v_mul_f32 v79, v79, v11
v_cvt_pk_bf16_f32 v86, v76, v77
v_cvt_pk_bf16_f32 v87, v78, v79
ds_write_b128 v241, v[84:87] offset:24576
v_mfma_f32_16x16x16_bf16 v[64:67], v[140:141], v[44:45], 0
v_mfma_f32_16x16x16_bf16 v[68:71], v[140:141], v[48:49], 0
v_mfma_f32_16x16x16_bf16 v[64:67], v[96:97], v[46:47], v[64:67]
v_mfma_f32_16x16x32_bf16 v[68:71], v[96:99], v[50:53], v[68:71]
v_mfma_f32_16x16x16_bf16 v[72:75], v[142:143], v[44:45], 0
v_mfma_f32_16x16x16_bf16 v[76:79], v[142:143], v[48:49], 0
v_mfma_f32_16x16x16_bf16 v[72:75], v[100:101], v[46:47], v[72:75]
v_mfma_f32_16x16x32_bf16 v[76:79], v[100:103], v[50:53], v[76:79]
s_nop 2
v_mul_f32 v64, v64, v10
v_mul_f32 v65, v65, v10
v_mul_f32 v66, v66, v10
v_mul_f32 v67, v67, v10
v_cvt_pk_bf16_f32 v80, v64, v65
v_cvt_pk_bf16_f32 v81, v66, v67
v_mul_f32 v72, v72, v10
v_mul_f32 v73, v73, v10
v_mul_f32 v74, v74, v10
v_mul_f32 v75, v75, v10
v_cvt_pk_bf16_f32 v82, v72, v73
v_cvt_pk_bf16_f32 v83, v74, v75
ds_write_b128 v241, v[80:83] offset:1024
v_mul_f32 v68, v68, v11
v_mul_f32 v69, v69, v11
v_mul_f32 v70, v70, v11
v_mul_f32 v71, v71, v11
v_cvt_pk_bf16_f32 v84, v68, v69
v_cvt_pk_bf16_f32 v85, v70, v71
v_mul_f32 v76, v76, v11
v_mul_f32 v77, v77, v11
v_mul_f32 v78, v78, v11
v_mul_f32 v79, v79, v11
v_cvt_pk_bf16_f32 v86, v76, v77
v_cvt_pk_bf16_f32 v87, v78, v79
ds_write_b128 v241, v[84:87] offset:25600
v_mfma_f32_16x16x16_bf16 v[64:67], v[144:145], v[44:45], 0
v_mfma_f32_16x16x16_bf16 v[68:71], v[144:145], v[48:49], 0
v_mfma_f32_16x16x16_bf16 v[64:67], v[104:105], v[46:47], v[64:67]
v_mfma_f32_16x16x32_bf16 v[68:71], v[104:107], v[50:53], v[68:71]
v_mfma_f32_16x16x16_bf16 v[72:75], v[146:147], v[44:45], 0
v_mfma_f32_16x16x16_bf16 v[76:79], v[146:147], v[48:49], 0
v_mfma_f32_16x16x16_bf16 v[72:75], v[108:109], v[46:47], v[72:75]
v_mfma_f32_16x16x32_bf16 v[76:79], v[108:111], v[50:53], v[76:79]
s_nop 2
v_mul_f32 v64, v64, v10
v_mul_f32 v65, v65, v10
v_mul_f32 v66, v66, v10
v_mul_f32 v67, v67, v10
v_cvt_pk_bf16_f32 v80, v64, v65
v_cvt_pk_bf16_f32 v81, v66, v67
v_mul_f32 v72, v72, v10
v_mul_f32 v73, v73, v10
v_mul_f32 v74, v74, v10
v_mul_f32 v75, v75, v10
v_cvt_pk_bf16_f32 v82, v72, v73
v_cvt_pk_bf16_f32 v83, v74, v75
ds_write_b128 v241, v[80:83] offset:2048
v_mul_f32 v68, v68, v11
v_mul_f32 v69, v69, v11
v_mul_f32 v70, v70, v11
v_mul_f32 v71, v71, v11
v_cvt_pk_bf16_f32 v84, v68, v69
v_cvt_pk_bf16_f32 v85, v70, v71
v_mul_f32 v76, v76, v11
v_mul_f32 v77, v77, v11
v_mul_f32 v78, v78, v11
v_mul_f32 v79, v79, v11
v_cvt_pk_bf16_f32 v86, v76, v77
v_cvt_pk_bf16_f32 v87, v78, v79
ds_write_b128 v241, v[84:87] offset:26624
v_mfma_f32_16x16x16_bf16 v[64:67], v[148:149], v[44:45], 0
v_mfma_f32_16x16x16_bf16 v[68:71], v[148:149], v[48:49], 0
v_mfma_f32_16x16x16_bf16 v[64:67], v[112:113], v[46:47], v[64:67]
v_mfma_f32_16x16x32_bf16 v[68:71], v[112:115], v[50:53], v[68:71]
v_mfma_f32_16x16x16_bf16 v[72:75], v[150:151], v[44:45], 0
v_mfma_f32_16x16x16_bf16 v[76:79], v[150:151], v[48:49], 0
v_mfma_f32_16x16x16_bf16 v[72:75], v[116:117], v[46:47], v[72:75]
v_mfma_f32_16x16x32_bf16 v[76:79], v[116:119], v[50:53], v[76:79]
s_nop 2
v_mul_f32 v64, v64, v10
v_mul_f32 v65, v65, v10
v_mul_f32 v66, v66, v10
v_mul_f32 v67, v67, v10
v_cvt_pk_bf16_f32 v80, v64, v65
v_cvt_pk_bf16_f32 v81, v66, v67
v_mul_f32 v72, v72, v10
v_mul_f32 v73, v73, v10
v_mul_f32 v74, v74, v10
v_mul_f32 v75, v75, v10
v_cvt_pk_bf16_f32 v82, v72, v73
v_cvt_pk_bf16_f32 v83, v74, v75
ds_write_b128 v241, v[80:83] offset:3072
v_mul_f32 v68, v68, v11
v_mul_f32 v69, v69, v11
v_mul_f32 v70, v70, v11
v_mul_f32 v71, v71, v11
v_cvt_pk_bf16_f32 v84, v68, v69
v_cvt_pk_bf16_f32 v85, v70, v71
v_mul_f32 v76, v76, v11
v_mul_f32 v77, v77, v11
v_mul_f32 v78, v78, v11
v_mul_f32 v79, v79, v11
v_cvt_pk_bf16_f32 v86, v76, v77
v_cvt_pk_bf16_f32 v87, v78, v79
ds_write_b128 v241, v[84:87] offset:27648
v_mfma_f32_16x16x16_bf16 v[64:67], v[152:153], v[44:45], 0
v_mfma_f32_16x16x16_bf16 v[68:71], v[152:153], v[48:49], 0
v_mfma_f32_16x16x16_bf16 v[64:67], v[120:121], v[46:47], v[64:67]
v_mfma_f32_16x16x32_bf16 v[68:71], v[120:123], v[50:53], v[68:71]
v_mfma_f32_16x16x16_bf16 v[72:75], v[154:155], v[44:45], 0
v_mfma_f32_16x16x16_bf16 v[76:79], v[154:155], v[48:49], 0
v_mfma_f32_16x16x16_bf16 v[72:75], v[124:125], v[46:47], v[72:75]
v_mfma_f32_16x16x32_bf16 v[76:79], v[124:127], v[50:53], v[76:79]
s_nop 2
v_mul_f32 v64, v64, v10
v_mul_f32 v65, v65, v10
v_mul_f32 v66, v66, v10
v_mul_f32 v67, v67, v10
v_cvt_pk_bf16_f32 v80, v64, v65
v_cvt_pk_bf16_f32 v81, v66, v67
v_mul_f32 v72, v72, v10
v_mul_f32 v73, v73, v10
v_mul_f32 v74, v74, v10
v_mul_f32 v75, v75, v10
v_cvt_pk_bf16_f32 v82, v72, v73
v_cvt_pk_bf16_f32 v83, v74, v75
ds_write_b128 v241, v[80:83] offset:4096
v_mul_f32 v68, v68, v11
v_mul_f32 v69, v69, v11
v_mul_f32 v70, v70, v11
v_mul_f32 v71, v71, v11
v_cvt_pk_bf16_f32 v84, v68, v69
v_cvt_pk_bf16_f32 v85, v70, v71
v_mul_f32 v76, v76, v11
v_mul_f32 v77, v77, v11
v_mul_f32 v78, v78, v11
v_mul_f32 v79, v79, v11
v_cvt_pk_bf16_f32 v86, v76, v77
v_cvt_pk_bf16_f32 v87, v78, v79
ds_write_b128 v241, v[84:87] offset:28672
v_mfma_f32_16x16x16_bf16 v[64:67], v[156:157], v[44:45], 0
v_mfma_f32_16x16x16_bf16 v[68:71], v[156:157], v[48:49], 0
v_mfma_f32_16x16x16_bf16 v[64:67], v[128:129], v[46:47], v[64:67]
v_mfma_f32_16x16x32_bf16 v[68:71], v[128:131], v[50:53], v[68:71]
v_mfma_f32_16x16x16_bf16 v[72:75], v[158:159], v[44:45], 0
v_mfma_f32_16x16x16_bf16 v[76:79], v[158:159], v[48:49], 0
v_mfma_f32_16x16x16_bf16 v[72:75], v[132:133], v[46:47], v[72:75]
v_mfma_f32_16x16x32_bf16 v[76:79], v[132:135], v[50:53], v[76:79]
s_nop 2
v_mul_f32 v64, v64, v10
v_mul_f32 v65, v65, v10
v_mul_f32 v66, v66, v10
v_mul_f32 v67, v67, v10
v_cvt_pk_bf16_f32 v80, v64, v65
v_cvt_pk_bf16_f32 v81, v66, v67
v_mul_f32 v72, v72, v10
v_mul_f32 v73, v73, v10
v_mul_f32 v74, v74, v10
v_mul_f32 v75, v75, v10
v_cvt_pk_bf16_f32 v82, v72, v73
v_cvt_pk_bf16_f32 v83, v74, v75
ds_write_b128 v241, v[80:83] offset:5120
v_mul_f32 v68, v68, v11
v_mul_f32 v69, v69, v11
v_mul_f32 v70, v70, v11
v_mul_f32 v71, v71, v11
v_cvt_pk_bf16_f32 v84, v68, v69
v_cvt_pk_bf16_f32 v85, v70, v71
v_mul_f32 v76, v76, v11
v_mul_f32 v77, v77, v11
v_mul_f32 v78, v78, v11
v_mul_f32 v79, v79, v11
v_cvt_pk_bf16_f32 v86, v76, v77
v_cvt_pk_bf16_f32 v87, v78, v79
ds_write_b128 v241, v[84:87] offset:29696
s_waitcnt lgkmcnt(0)
buffer_load_dwordx4 v[104:107], v1, s[4:7], s30 offen offset:2048
buffer_load_dwordx4 v[108:111], v1, s[4:7], s31 offen offset:2048
buffer_load_dwordx4 v[112:115], v1, s[4:7], s32 offen offset:2048
buffer_load_dwordx4 v[116:119], v1, s[4:7], s33 offen offset:2048
buffer_load_dwordx4 v[120:123], v1, s[4:7], s34 offen offset:2048
buffer_load_dwordx4 v[124:127], v1, s[4:7], s35 offen offset:2048
buffer_load_dwordx4 v[128:131], v1, s[4:7], s36 offen offset:2048
buffer_load_dwordx4 v[132:135], v1, s[4:7], s37 offen offset:2048
buffer_load_dwordx4 v[136:139], v1, s[4:7], s38 offen offset:2048
buffer_load_dwordx4 v[140:143], v1, s[4:7], s39 offen offset:2048
buffer_load_dwordx4 v[144:147], v1, s[4:7], s30 offen offset:3072
buffer_load_dwordx4 v[148:151], v1, s[4:7], s31 offen offset:3072
buffer_load_dwordx4 v[152:155], v1, s[4:7], s32 offen offset:3072
buffer_load_dwordx4 v[156:159], v1, s[4:7], s33 offen offset:3072
buffer_load_dwordx4 v[160:163], v1, s[4:7], s34 offen offset:3072
buffer_load_dwordx4 v[164:167], v1, s[4:7], s35 offen offset:3072
buffer_load_dwordx4 v[168:171], v1, s[4:7], s36 offen offset:3072
buffer_load_dwordx4 v[172:175], v1, s[4:7], s37 offen offset:3072
buffer_load_dwordx4 v[176:179], v1, s[4:7], s38 offen offset:3072
buffer_load_dwordx4 v[180:183], v1, s[4:7], s39 offen offset:3072
s_add_u32 s30, s30, 4096
s_add_u32 s31, s31, 4096
s_add_u32 s32, s32, 4096
s_add_u32 s33, s33, 4096
s_add_u32 s34, s34, 4096
s_add_u32 s35, s35, 4096
s_add_u32 s36, s36, 4096
s_add_u32 s37, s37, 4096
s_add_u32 s38, s38, 4096
s_add_u32 s39, s39, 4096
v_add_u32 v6, 49152, v1
s_barrier
ds_read_b128 v[184:187], v1 offset:0
ds_read_b128 v[188:191], v1 offset:24576
ds_read_b128 v[192:195], v6 offset:0
ds_read_b128 v[196:199], v6 offset:24576
s_waitcnt vmcnt(30) lgkmcnt(0)
v_mfma_f32_16x16x32_bf16 a[0:3], a[160:163], v[184:187], 0
v_mfma_f32_16x16x32_bf16 a[4:7], a[160:163], v[188:191], 0
v_mfma_f32_16x16x32_bf16 a[8:11], a[160:163], v[192:195], 0
v_mfma_f32_16x16x32_bf16 a[12:15], a[160:163], v[196:199], 0
ds_read_b128 v[200:203], v1 offset:1024
buffer_load_dwordx4 v[24:27], v1, s[4:7], s30 offen offset:0
v_mfma_f32_16x16x32_bf16 a[16:19], a[164:167], v[184:187], 0
v_mfma_f32_16x16x32_bf16 a[20:23], a[164:167], v[188:191], 0
v_mfma_f32_16x16x32_bf16 a[24:27], a[164:167], v[192:195], 0
v_mfma_f32_16x16x32_bf16 a[28:31], a[164:167], v[196:199], 0
ds_read_b128 v[204:207], v1 offset:25600
buffer_load_dwordx4 v[28:31], v1, s[4:7], s31 offen offset:0
v_mfma_f32_16x16x32_bf16 a[32:35], a[168:171], v[184:187], 0
v_mfma_f32_16x16x32_bf16 a[36:39], a[168:171], v[188:191], 0
v_mfma_f32_16x16x32_bf16 a[40:43], a[168:171], v[192:195], 0
v_mfma_f32_16x16x32_bf16 a[44:47], a[168:171], v[196:199], 0
ds_read_b128 v[208:211], v6 offset:1024
buffer_load_dwordx4 v[32:35], v1, s[4:7], s32 offen offset:0
v_mfma_f32_16x16x32_bf16 a[48:51], a[172:175], v[184:187], 0
v_mfma_f32_16x16x32_bf16 a[52:55], a[172:175], v[188:191], 0
v_mfma_f32_16x16x32_bf16 a[56:59], a[172:175], v[192:195], 0
v_mfma_f32_16x16x32_bf16 a[60:63], a[172:175], v[196:199], 0
ds_read_b128 v[212:215], v6 offset:25600
buffer_load_dwordx4 v[36:39], v1, s[4:7], s33 offen offset:0
v_mfma_f32_16x16x32_bf16 a[64:67], a[176:179], v[184:187], 0
v_mfma_f32_16x16x32_bf16 a[68:71], a[176:179], v[188:191], 0
v_mfma_f32_16x16x32_bf16 a[72:75], a[176:179], v[192:195], 0
v_mfma_f32_16x16x32_bf16 a[76:79], a[176:179], v[196:199], 0
buffer_load_dwordx4 v[40:43], v1, s[4:7], s34 offen offset:0
v_mfma_f32_16x16x32_bf16 a[80:83], a[180:183], v[184:187], 0
v_mfma_f32_16x16x32_bf16 a[84:87], a[180:183], v[188:191], 0
v_mfma_f32_16x16x32_bf16 a[88:91], a[180:183], v[192:195], 0
v_mfma_f32_16x16x32_bf16 a[92:95], a[180:183], v[196:199], 0
buffer_load_dwordx4 v[44:47], v1, s[4:7], s35 offen offset:0
v_mfma_f32_16x16x32_bf16 a[96:99], a[184:187], v[184:187], 0
v_mfma_f32_16x16x32_bf16 a[100:103], a[184:187], v[188:191], 0
v_mfma_f32_16x16x32_bf16 a[104:107], a[184:187], v[192:195], 0
v_mfma_f32_16x16x32_bf16 a[108:111], a[184:187], v[196:199], 0
buffer_load_dwordx4 v[48:51], v1, s[4:7], s36 offen offset:0
v_mfma_f32_16x16x32_bf16 a[112:115], a[188:191], v[184:187], 0
v_mfma_f32_16x16x32_bf16 a[116:119], a[188:191], v[188:191], 0
v_mfma_f32_16x16x32_bf16 a[120:123], a[188:191], v[192:195], 0
v_mfma_f32_16x16x32_bf16 a[124:127], a[188:191], v[196:199], 0
buffer_load_dwordx4 v[52:55], v1, s[4:7], s37 offen offset:0
v_mfma_f32_16x16x32_bf16 a[128:131], a[192:195], v[184:187], 0
v_mfma_f32_16x16x32_bf16 a[132:135], a[192:195], v[188:191], 0
v_mfma_f32_16x16x32_bf16 a[136:139], a[192:195], v[192:195], 0
v_mfma_f32_16x16x32_bf16 a[140:143], a[192:195], v[196:199], 0
buffer_load_dwordx4 v[56:59], v1, s[4:7], s38 offen offset:0
v_mfma_f32_16x16x32_bf16 a[144:147], a[196:199], v[184:187], 0
v_mfma_f32_16x16x32_bf16 a[148:151], a[196:199], v[188:191], 0
v_mfma_f32_16x16x32_bf16 a[152:155], a[196:199], v[192:195], 0
v_mfma_f32_16x16x32_bf16 a[156:159], a[196:199], v[196:199], 0
buffer_load_dwordx4 v[60:63], v1, s[4:7], s39 offen offset:0
s_waitcnt vmcnt(30) lgkmcnt(0)
v_mfma_f32_16x16x32_bf16 a[0:3], a[200:203], v[200:203], a[0:3]
v_mfma_f32_16x16x32_bf16 a[4:7], a[200:203], v[204:207], a[4:7]
v_mfma_f32_16x16x32_bf16 a[8:11], a[200:203], v[208:211], a[8:11]
v_mfma_f32_16x16x32_bf16 a[12:15], a[200:203], v[212:215], a[12:15]
ds_read_b128 v[184:187], v1 offset:2048
buffer_load_dwordx4 v[64:67], v1, s[4:7], s30 offen offset:1024
v_mfma_f32_16x16x32_bf16 a[16:19], a[204:207], v[200:203], a[16:19]
v_mfma_f32_16x16x32_bf16 a[20:23], a[204:207], v[204:207], a[20:23]
v_mfma_f32_16x16x32_bf16 a[24:27], a[204:207], v[208:211], a[24:27]
v_mfma_f32_16x16x32_bf16 a[28:31], a[204:207], v[212:215], a[28:31]
ds_read_b128 v[188:191], v1 offset:26624
buffer_load_dwordx4 v[68:71], v1, s[4:7], s31 offen offset:1024
v_mfma_f32_16x16x32_bf16 a[32:35], a[208:211], v[200:203], a[32:35]
v_mfma_f32_16x16x32_bf16 a[36:39], a[208:211], v[204:207], a[36:39]
v_mfma_f32_16x16x32_bf16 a[40:43], a[208:211], v[208:211], a[40:43]
v_mfma_f32_16x16x32_bf16 a[44:47], a[208:211], v[212:215], a[44:47]
ds_read_b128 v[192:195], v6 offset:2048
buffer_load_dwordx4 v[72:75], v1, s[4:7], s32 offen offset:1024
v_mfma_f32_16x16x32_bf16 a[48:51], a[212:215], v[200:203], a[48:51]
v_mfma_f32_16x16x32_bf16 a[52:55], a[212:215], v[204:207], a[52:55]
v_mfma_f32_16x16x32_bf16 a[56:59], a[212:215], v[208:211], a[56:59]
v_mfma_f32_16x16x32_bf16 a[60:63], a[212:215], v[212:215], a[60:63]
ds_read_b128 v[196:199], v6 offset:26624
buffer_load_dwordx4 v[76:79], v1, s[4:7], s33 offen offset:1024
v_mfma_f32_16x16x32_bf16 a[64:67], a[216:219], v[200:203], a[64:67]
v_mfma_f32_16x16x32_bf16 a[68:71], a[216:219], v[204:207], a[68:71]
v_mfma_f32_16x16x32_bf16 a[72:75], a[216:219], v[208:211], a[72:75]
v_mfma_f32_16x16x32_bf16 a[76:79], a[216:219], v[212:215], a[76:79]
buffer_load_dwordx4 v[80:83], v1, s[4:7], s34 offen offset:1024
v_mfma_f32_16x16x32_bf16 a[80:83], a[220:223], v[200:203], a[80:83]
v_mfma_f32_16x16x32_bf16 a[84:87], a[220:223], v[204:207], a[84:87]
v_mfma_f32_16x16x32_bf16 a[88:91], a[220:223], v[208:211], a[88:91]
v_mfma_f32_16x16x32_bf16 a[92:95], a[220:223], v[212:215], a[92:95]
buffer_load_dwordx4 v[84:87], v1, s[4:7], s35 offen offset:1024
v_mfma_f32_16x16x32_bf16 a[96:99], a[224:227], v[200:203], a[96:99]
v_mfma_f32_16x16x32_bf16 a[100:103], a[224:227], v[204:207], a[100:103]
v_mfma_f32_16x16x32_bf16 a[104:107], a[224:227], v[208:211], a[104:107]
v_mfma_f32_16x16x32_bf16 a[108:111], a[224:227], v[212:215], a[108:111]
buffer_load_dwordx4 v[88:91], v1, s[4:7], s36 offen offset:1024
v_mfma_f32_16x16x32_bf16 a[112:115], a[228:231], v[200:203], a[112:115]
v_mfma_f32_16x16x32_bf16 a[116:119], a[228:231], v[204:207], a[116:119]
v_mfma_f32_16x16x32_bf16 a[120:123], a[228:231], v[208:211], a[120:123]
v_mfma_f32_16x16x32_bf16 a[124:127], a[228:231], v[212:215], a[124:127]
buffer_load_dwordx4 v[92:95], v1, s[4:7], s37 offen offset:1024
v_mfma_f32_16x16x32_bf16 a[128:131], a[232:235], v[200:203], a[128:131]
v_mfma_f32_16x16x32_bf16 a[132:135], a[232:235], v[204:207], a[132:135]
v_mfma_f32_16x16x32_bf16 a[136:139], a[232:235], v[208:211], a[136:139]
v_mfma_f32_16x16x32_bf16 a[140:143], a[232:235], v[212:215], a[140:143]
buffer_load_dwordx4 v[96:99], v1, s[4:7], s38 offen offset:1024
v_mfma_f32_16x16x32_bf16 a[144:147], a[236:239], v[200:203], a[144:147]
v_mfma_f32_16x16x32_bf16 a[148:151], a[236:239], v[204:207], a[148:151]
v_mfma_f32_16x16x32_bf16 a[152:155], a[236:239], v[208:211], a[152:155]
v_mfma_f32_16x16x32_bf16 a[156:159], a[236:239], v[212:215], a[156:159]
buffer_load_dwordx4 v[100:103], v1, s[4:7], s39 offen offset:1024
s_waitcnt vmcnt(30) lgkmcnt(0)
v_mfma_f32_16x16x32_bf16 a[0:3], v[104:107], v[184:187], a[0:3]
v_mfma_f32_16x16x32_bf16 a[4:7], v[104:107], v[188:191], a[4:7]
v_mfma_f32_16x16x32_bf16 a[8:11], v[104:107], v[192:195], a[8:11]
v_mfma_f32_16x16x32_bf16 a[12:15], v[104:107], v[196:199], a[12:15]
ds_read_b128 v[200:203], v1 offset:3072
buffer_load_dwordx4 v[104:107], v1, s[4:7], s30 offen offset:2048
v_mfma_f32_16x16x32_bf16 a[16:19], v[108:111], v[184:187], a[16:19]
v_mfma_f32_16x16x32_bf16 a[20:23], v[108:111], v[188:191], a[20:23]
v_mfma_f32_16x16x32_bf16 a[24:27], v[108:111], v[192:195], a[24:27]
v_mfma_f32_16x16x32_bf16 a[28:31], v[108:111], v[196:199], a[28:31]
ds_read_b128 v[204:207], v1 offset:27648
buffer_load_dwordx4 v[108:111], v1, s[4:7], s31 offen offset:2048
v_mfma_f32_16x16x32_bf16 a[32:35], v[112:115], v[184:187], a[32:35]
v_mfma_f32_16x16x32_bf16 a[36:39], v[112:115], v[188:191], a[36:39]
v_mfma_f32_16x16x32_bf16 a[40:43], v[112:115], v[192:195], a[40:43]
v_mfma_f32_16x16x32_bf16 a[44:47], v[112:115], v[196:199], a[44:47]
ds_read_b128 v[208:211], v6 offset:3072
buffer_load_dwordx4 v[112:115], v1, s[4:7], s32 offen offset:2048
v_mfma_f32_16x16x32_bf16 a[48:51], v[116:119], v[184:187], a[48:51]
v_mfma_f32_16x16x32_bf16 a[52:55], v[116:119], v[188:191], a[52:55]
v_mfma_f32_16x16x32_bf16 a[56:59], v[116:119], v[192:195], a[56:59]
v_mfma_f32_16x16x32_bf16 a[60:63], v[116:119], v[196:199], a[60:63]
ds_read_b128 v[212:215], v6 offset:27648
buffer_load_dwordx4 v[116:119], v1, s[4:7], s33 offen offset:2048
v_mfma_f32_16x16x32_bf16 a[64:67], v[120:123], v[184:187], a[64:67]
v_mfma_f32_16x16x32_bf16 a[68:71], v[120:123], v[188:191], a[68:71]
v_mfma_f32_16x16x32_bf16 a[72:75], v[120:123], v[192:195], a[72:75]
v_mfma_f32_16x16x32_bf16 a[76:79], v[120:123], v[196:199], a[76:79]
buffer_load_dwordx4 v[120:123], v1, s[4:7], s34 offen offset:2048
v_mfma_f32_16x16x32_bf16 a[80:83], v[124:127], v[184:187], a[80:83]
v_mfma_f32_16x16x32_bf16 a[84:87], v[124:127], v[188:191], a[84:87]
v_mfma_f32_16x16x32_bf16 a[88:91], v[124:127], v[192:195], a[88:91]
v_mfma_f32_16x16x32_bf16 a[92:95], v[124:127], v[196:199], a[92:95]
buffer_load_dwordx4 v[124:127], v1, s[4:7], s35 offen offset:2048
v_mfma_f32_16x16x32_bf16 a[96:99], v[128:131], v[184:187], a[96:99]
v_mfma_f32_16x16x32_bf16 a[100:103], v[128:131], v[188:191], a[100:103]
v_mfma_f32_16x16x32_bf16 a[104:107], v[128:131], v[192:195], a[104:107]
v_mfma_f32_16x16x32_bf16 a[108:111], v[128:131], v[196:199], a[108:111]
buffer_load_dwordx4 v[128:131], v1, s[4:7], s36 offen offset:2048
v_mfma_f32_16x16x32_bf16 a[112:115], v[132:135], v[184:187], a[112:115]
v_mfma_f32_16x16x32_bf16 a[116:119], v[132:135], v[188:191], a[116:119]
v_mfma_f32_16x16x32_bf16 a[120:123], v[132:135], v[192:195], a[120:123]
v_mfma_f32_16x16x32_bf16 a[124:127], v[132:135], v[196:199], a[124:127]
buffer_load_dwordx4 v[132:135], v1, s[4:7], s37 offen offset:2048
v_mfma_f32_16x16x32_bf16 a[128:131], v[136:139], v[184:187], a[128:131]
v_mfma_f32_16x16x32_bf16 a[132:135], v[136:139], v[188:191], a[132:135]
v_mfma_f32_16x16x32_bf16 a[136:139], v[136:139], v[192:195], a[136:139]
v_mfma_f32_16x16x32_bf16 a[140:143], v[136:139], v[196:199], a[140:143]
buffer_load_dwordx4 v[136:139], v1, s[4:7], s38 offen offset:2048
v_mfma_f32_16x16x32_bf16 a[144:147], v[140:143], v[184:187], a[144:147]
v_mfma_f32_16x16x32_bf16 a[148:151], v[140:143], v[188:191], a[148:151]
v_mfma_f32_16x16x32_bf16 a[152:155], v[140:143], v[192:195], a[152:155]
v_mfma_f32_16x16x32_bf16 a[156:159], v[140:143], v[196:199], a[156:159]
buffer_load_dwordx4 v[140:143], v1, s[4:7], s39 offen offset:2048
s_waitcnt vmcnt(30) lgkmcnt(0)
v_mfma_f32_16x16x32_bf16 a[0:3], v[144:147], v[200:203], a[0:3]
v_mfma_f32_16x16x32_bf16 a[4:7], v[144:147], v[204:207], a[4:7]
v_mfma_f32_16x16x32_bf16 a[8:11], v[144:147], v[208:211], a[8:11]
v_mfma_f32_16x16x32_bf16 a[12:15], v[144:147], v[212:215], a[12:15]
ds_read_b128 v[184:187], v1 offset:4096
buffer_load_dwordx4 v[144:147], v1, s[4:7], s30 offen offset:3072
s_add_u32 s30, s30, 4096
v_mfma_f32_16x16x32_bf16 a[16:19], v[148:151], v[200:203], a[16:19]
v_mfma_f32_16x16x32_bf16 a[20:23], v[148:151], v[204:207], a[20:23]
v_mfma_f32_16x16x32_bf16 a[24:27], v[148:151], v[208:211], a[24:27]
v_mfma_f32_16x16x32_bf16 a[28:31], v[148:151], v[212:215], a[28:31]
ds_read_b128 v[188:191], v1 offset:28672
buffer_load_dwordx4 v[148:151], v1, s[4:7], s31 offen offset:3072
s_add_u32 s31, s31, 4096
v_mfma_f32_16x16x32_bf16 a[32:35], v[152:155], v[200:203], a[32:35]
v_mfma_f32_16x16x32_bf16 a[36:39], v[152:155], v[204:207], a[36:39]
v_mfma_f32_16x16x32_bf16 a[40:43], v[152:155], v[208:211], a[40:43]
v_mfma_f32_16x16x32_bf16 a[44:47], v[152:155], v[212:215], a[44:47]
ds_read_b128 v[192:195], v6 offset:4096
buffer_load_dwordx4 v[152:155], v1, s[4:7], s32 offen offset:3072
s_add_u32 s32, s32, 4096
v_mfma_f32_16x16x32_bf16 a[48:51], v[156:159], v[200:203], a[48:51]
v_mfma_f32_16x16x32_bf16 a[52:55], v[156:159], v[204:207], a[52:55]
v_mfma_f32_16x16x32_bf16 a[56:59], v[156:159], v[208:211], a[56:59]
v_mfma_f32_16x16x32_bf16 a[60:63], v[156:159], v[212:215], a[60:63]
ds_read_b128 v[196:199], v6 offset:28672
buffer_load_dwordx4 v[156:159], v1, s[4:7], s33 offen offset:3072
s_add_u32 s33, s33, 4096
v_mfma_f32_16x16x32_bf16 a[64:67], v[160:163], v[200:203], a[64:67]
v_mfma_f32_16x16x32_bf16 a[68:71], v[160:163], v[204:207], a[68:71]
v_mfma_f32_16x16x32_bf16 a[72:75], v[160:163], v[208:211], a[72:75]
v_mfma_f32_16x16x32_bf16 a[76:79], v[160:163], v[212:215], a[76:79]
buffer_load_dwordx4 v[160:163], v1, s[4:7], s34 offen offset:3072
s_add_u32 s34, s34, 4096
v_mfma_f32_16x16x32_bf16 a[80:83], v[164:167], v[200:203], a[80:83]
v_mfma_f32_16x16x32_bf16 a[84:87], v[164:167], v[204:207], a[84:87]
v_mfma_f32_16x16x32_bf16 a[88:91], v[164:167], v[208:211], a[88:91]
v_mfma_f32_16x16x32_bf16 a[92:95], v[164:167], v[212:215], a[92:95]
buffer_load_dwordx4 v[164:167], v1, s[4:7], s35 offen offset:3072
s_add_u32 s35, s35, 4096
v_mfma_f32_16x16x32_bf16 a[96:99], v[168:171], v[200:203], a[96:99]
v_mfma_f32_16x16x32_bf16 a[100:103], v[168:171], v[204:207], a[100:103]
v_mfma_f32_16x16x32_bf16 a[104:107], v[168:171], v[208:211], a[104:107]
v_mfma_f32_16x16x32_bf16 a[108:111], v[168:171], v[212:215], a[108:111]
buffer_load_dwordx4 v[168:171], v1, s[4:7], s36 offen offset:3072
s_add_u32 s36, s36, 4096
v_mfma_f32_16x16x32_bf16 a[112:115], v[172:175], v[200:203], a[112:115]
v_mfma_f32_16x16x32_bf16 a[116:119], v[172:175], v[204:207], a[116:119]
v_mfma_f32_16x16x32_bf16 a[120:123], v[172:175], v[208:211], a[120:123]
v_mfma_f32_16x16x32_bf16 a[124:127], v[172:175], v[212:215], a[124:127]
buffer_load_dwordx4 v[172:175], v1, s[4:7], s37 offen offset:3072
s_add_u32 s37, s37, 4096
v_mfma_f32_16x16x32_bf16 a[128:131], v[176:179], v[200:203], a[128:131]
v_mfma_f32_16x16x32_bf16 a[132:135], v[176:179], v[204:207], a[132:135]
v_mfma_f32_16x16x32_bf16 a[136:139], v[176:179], v[208:211], a[136:139]
v_mfma_f32_16x16x32_bf16 a[140:143], v[176:179], v[212:215], a[140:143]
buffer_load_dwordx4 v[176:179], v1, s[4:7], s38 offen offset:3072
s_add_u32 s38, s38, 4096
v_mfma_f32_16x16x32_bf16 a[144:147], v[180:183], v[200:203], a[144:147]
v_mfma_f32_16x16x32_bf16 a[148:151], v[180:183], v[204:207], a[148:151]
v_mfma_f32_16x16x32_bf16 a[152:155], v[180:183], v[208:211], a[152:155]
v_mfma_f32_16x16x32_bf16 a[156:159], v[180:183], v[212:215], a[156:159]
buffer_load_dwordx4 v[180:183], v1, s[4:7], s39 offen offset:3072
s_add_u32 s39, s39, 4096
s_waitcnt vmcnt(30) lgkmcnt(0)
v_mfma_f32_16x16x32_bf16 a[0:3], v[24:27], v[184:187], a[0:3]
v_mfma_f32_16x16x32_bf16 a[4:7], v[24:27], v[188:191], a[4:7]
v_mfma_f32_16x16x32_bf16 a[8:11], v[24:27], v[192:195], a[8:11]
v_mfma_f32_16x16x32_bf16 a[12:15], v[24:27], v[196:199], a[12:15]
ds_read_b128 v[200:203], v1 offset:5120
buffer_load_dwordx4 v[24:27], v1, s[4:7], s30 offen offset:0
v_mfma_f32_16x16x32_bf16 a[16:19], v[28:31], v[184:187], a[16:19]
v_mfma_f32_16x16x32_bf16 a[20:23], v[28:31], v[188:191], a[20:23]
v_mfma_f32_16x16x32_bf16 a[24:27], v[28:31], v[192:195], a[24:27]
v_mfma_f32_16x16x32_bf16 a[28:31], v[28:31], v[196:199], a[28:31]
ds_read_b128 v[204:207], v1 offset:29696
buffer_load_dwordx4 v[28:31], v1, s[4:7], s31 offen offset:0
v_mfma_f32_16x16x32_bf16 a[32:35], v[32:35], v[184:187], a[32:35]
v_mfma_f32_16x16x32_bf16 a[36:39], v[32:35], v[188:191], a[36:39]
v_mfma_f32_16x16x32_bf16 a[40:43], v[32:35], v[192:195], a[40:43]
v_mfma_f32_16x16x32_bf16 a[44:47], v[32:35], v[196:199], a[44:47]
ds_read_b128 v[208:211], v6 offset:5120
buffer_load_dwordx4 v[32:35], v1, s[4:7], s32 offen offset:0
v_mfma_f32_16x16x32_bf16 a[48:51], v[36:39], v[184:187], a[48:51]
v_mfma_f32_16x16x32_bf16 a[52:55], v[36:39], v[188:191], a[52:55]
v_mfma_f32_16x16x32_bf16 a[56:59], v[36:39], v[192:195], a[56:59]
v_mfma_f32_16x16x32_bf16 a[60:63], v[36:39], v[196:199], a[60:63]
ds_read_b128 v[212:215], v6 offset:29696
buffer_load_dwordx4 v[36:39], v1, s[4:7], s33 offen offset:0
v_mfma_f32_16x16x32_bf16 a[64:67], v[40:43], v[184:187], a[64:67]
v_mfma_f32_16x16x32_bf16 a[68:71], v[40:43], v[188:191], a[68:71]
v_mfma_f32_16x16x32_bf16 a[72:75], v[40:43], v[192:195], a[72:75]
v_mfma_f32_16x16x32_bf16 a[76:79], v[40:43], v[196:199], a[76:79]
buffer_load_dwordx4 v[40:43], v1, s[4:7], s34 offen offset:0
v_mfma_f32_16x16x32_bf16 a[80:83], v[44:47], v[184:187], a[80:83]
v_mfma_f32_16x16x32_bf16 a[84:87], v[44:47], v[188:191], a[84:87]
v_mfma_f32_16x16x32_bf16 a[88:91], v[44:47], v[192:195], a[88:91]
v_mfma_f32_16x16x32_bf16 a[92:95], v[44:47], v[196:199], a[92:95]
buffer_load_dwordx4 v[44:47], v1, s[4:7], s35 offen offset:0
v_mfma_f32_16x16x32_bf16 a[96:99], v[48:51], v[184:187], a[96:99]
v_mfma_f32_16x16x32_bf16 a[100:103], v[48:51], v[188:191], a[100:103]
v_mfma_f32_16x16x32_bf16 a[104:107], v[48:51], v[192:195], a[104:107]
v_mfma_f32_16x16x32_bf16 a[108:111], v[48:51], v[196:199], a[108:111]
buffer_load_dwordx4 v[48:51], v1, s[4:7], s36 offen offset:0
v_mfma_f32_16x16x32_bf16 a[112:115], v[52:55], v[184:187], a[112:115]
v_mfma_f32_16x16x32_bf16 a[116:119], v[52:55], v[188:191], a[116:119]
v_mfma_f32_16x16x32_bf16 a[120:123], v[52:55], v[192:195], a[120:123]
v_mfma_f32_16x16x32_bf16 a[124:127], v[52:55], v[196:199], a[124:127]
buffer_load_dwordx4 v[52:55], v1, s[4:7], s37 offen offset:0
v_mfma_f32_16x16x32_bf16 a[128:131], v[56:59], v[184:187], a[128:131]
v_mfma_f32_16x16x32_bf16 a[132:135], v[56:59], v[188:191], a[132:135]
v_mfma_f32_16x16x32_bf16 a[136:139], v[56:59], v[192:195], a[136:139]
v_mfma_f32_16x16x32_bf16 a[140:143], v[56:59], v[196:199], a[140:143]
buffer_load_dwordx4 v[56:59], v1, s[4:7], s38 offen offset:0
v_mfma_f32_16x16x32_bf16 a[144:147], v[60:63], v[184:187], a[144:147]
v_mfma_f32_16x16x32_bf16 a[148:151], v[60:63], v[188:191], a[148:151]
v_mfma_f32_16x16x32_bf16 a[152:155], v[60:63], v[192:195], a[152:155]
v_mfma_f32_16x16x32_bf16 a[156:159], v[60:63], v[196:199], a[156:159]
buffer_load_dwordx4 v[60:63], v1, s[4:7], s39 offen offset:0
s_waitcnt vmcnt(30) lgkmcnt(0)
v_mfma_f32_16x16x32_bf16 a[0:3], v[64:67], v[200:203], a[0:3]
v_mfma_f32_16x16x32_bf16 a[4:7], v[64:67], v[204:207], a[4:7]
v_mfma_f32_16x16x32_bf16 a[8:11], v[64:67], v[208:211], a[8:11]
v_mfma_f32_16x16x32_bf16 a[12:15], v[64:67], v[212:215], a[12:15]
ds_read_b128 v[184:187], v1 offset:6144
buffer_load_dwordx4 v[64:67], v1, s[4:7], s30 offen offset:1024
v_mfma_f32_16x16x32_bf16 a[16:19], v[68:71], v[200:203], a[16:19]
v_mfma_f32_16x16x32_bf16 a[20:23], v[68:71], v[204:207], a[20:23]
v_mfma_f32_16x16x32_bf16 a[24:27], v[68:71], v[208:211], a[24:27]
v_mfma_f32_16x16x32_bf16 a[28:31], v[68:71], v[212:215], a[28:31]
ds_read_b128 v[188:191], v1 offset:30720
buffer_load_dwordx4 v[68:71], v1, s[4:7], s31 offen offset:1024
v_mfma_f32_16x16x32_bf16 a[32:35], v[72:75], v[200:203], a[32:35]
v_mfma_f32_16x16x32_bf16 a[36:39], v[72:75], v[204:207], a[36:39]
v_mfma_f32_16x16x32_bf16 a[40:43], v[72:75], v[208:211], a[40:43]
v_mfma_f32_16x16x32_bf16 a[44:47], v[72:75], v[212:215], a[44:47]
ds_read_b128 v[192:195], v6 offset:6144
buffer_load_dwordx4 v[72:75], v1, s[4:7], s32 offen offset:1024
v_mfma_f32_16x16x32_bf16 a[48:51], v[76:79], v[200:203], a[48:51]
v_mfma_f32_16x16x32_bf16 a[52:55], v[76:79], v[204:207], a[52:55]
v_mfma_f32_16x16x32_bf16 a[56:59], v[76:79], v[208:211], a[56:59]
v_mfma_f32_16x16x32_bf16 a[60:63], v[76:79], v[212:215], a[60:63]
ds_read_b128 v[196:199], v6 offset:30720
buffer_load_dwordx4 v[76:79], v1, s[4:7], s33 offen offset:1024
v_mfma_f32_16x16x32_bf16 a[64:67], v[80:83], v[200:203], a[64:67]
v_mfma_f32_16x16x32_bf16 a[68:71], v[80:83], v[204:207], a[68:71]
v_mfma_f32_16x16x32_bf16 a[72:75], v[80:83], v[208:211], a[72:75]
v_mfma_f32_16x16x32_bf16 a[76:79], v[80:83], v[212:215], a[76:79]
buffer_load_dwordx4 v[80:83], v1, s[4:7], s34 offen offset:1024
v_mfma_f32_16x16x32_bf16 a[80:83], v[84:87], v[200:203], a[80:83]
v_mfma_f32_16x16x32_bf16 a[84:87], v[84:87], v[204:207], a[84:87]
v_mfma_f32_16x16x32_bf16 a[88:91], v[84:87], v[208:211], a[88:91]
v_mfma_f32_16x16x32_bf16 a[92:95], v[84:87], v[212:215], a[92:95]
buffer_load_dwordx4 v[84:87], v1, s[4:7], s35 offen offset:1024
v_mfma_f32_16x16x32_bf16 a[96:99], v[88:91], v[200:203], a[96:99]
v_mfma_f32_16x16x32_bf16 a[100:103], v[88:91], v[204:207], a[100:103]
v_mfma_f32_16x16x32_bf16 a[104:107], v[88:91], v[208:211], a[104:107]
v_mfma_f32_16x16x32_bf16 a[108:111], v[88:91], v[212:215], a[108:111]
buffer_load_dwordx4 v[88:91], v1, s[4:7], s36 offen offset:1024
v_mfma_f32_16x16x32_bf16 a[112:115], v[92:95], v[200:203], a[112:115]
v_mfma_f32_16x16x32_bf16 a[116:119], v[92:95], v[204:207], a[116:119]
v_mfma_f32_16x16x32_bf16 a[120:123], v[92:95], v[208:211], a[120:123]
v_mfma_f32_16x16x32_bf16 a[124:127], v[92:95], v[212:215], a[124:127]
buffer_load_dwordx4 v[92:95], v1, s[4:7], s37 offen offset:1024
v_mfma_f32_16x16x32_bf16 a[128:131], v[96:99], v[200:203], a[128:131]
v_mfma_f32_16x16x32_bf16 a[132:135], v[96:99], v[204:207], a[132:135]
v_mfma_f32_16x16x32_bf16 a[136:139], v[96:99], v[208:211], a[136:139]
v_mfma_f32_16x16x32_bf16 a[140:143], v[96:99], v[212:215], a[140:143]
buffer_load_dwordx4 v[96:99], v1, s[4:7], s38 offen offset:1024
v_mfma_f32_16x16x32_bf16 a[144:147], v[100:103], v[200:203], a[144:147]
v_mfma_f32_16x16x32_bf16 a[148:151], v[100:103], v[204:207], a[148:151]
v_mfma_f32_16x16x32_bf16 a[152:155], v[100:103], v[208:211], a[152:155]
v_mfma_f32_16x16x32_bf16 a[156:159], v[100:103], v[212:215], a[156:159]
buffer_load_dwordx4 v[100:103], v1, s[4:7], s39 offen offset:1024
s_waitcnt vmcnt(30) lgkmcnt(0)
v_mfma_f32_16x16x32_bf16 a[0:3], v[104:107], v[184:187], a[0:3]
v_mfma_f32_16x16x32_bf16 a[4:7], v[104:107], v[188:191], a[4:7]
v_mfma_f32_16x16x32_bf16 a[8:11], v[104:107], v[192:195], a[8:11]
v_mfma_f32_16x16x32_bf16 a[12:15], v[104:107], v[196:199], a[12:15]
ds_read_b128 v[200:203], v1 offset:7168
buffer_load_dwordx4 v[104:107], v1, s[4:7], s30 offen offset:2048
v_mfma_f32_16x16x32_bf16 a[16:19], v[108:111], v[184:187], a[16:19]
v_mfma_f32_16x16x32_bf16 a[20:23], v[108:111], v[188:191], a[20:23]
v_mfma_f32_16x16x32_bf16 a[24:27], v[108:111], v[192:195], a[24:27]
v_mfma_f32_16x16x32_bf16 a[28:31], v[108:111], v[196:199], a[28:31]
ds_read_b128 v[204:207], v1 offset:31744
buffer_load_dwordx4 v[108:111], v1, s[4:7], s31 offen offset:2048
v_mfma_f32_16x16x32_bf16 a[32:35], v[112:115], v[184:187], a[32:35]
v_mfma_f32_16x16x32_bf16 a[36:39], v[112:115], v[188:191], a[36:39]
v_mfma_f32_16x16x32_bf16 a[40:43], v[112:115], v[192:195], a[40:43]
v_mfma_f32_16x16x32_bf16 a[44:47], v[112:115], v[196:199], a[44:47]
ds_read_b128 v[208:211], v6 offset:7168
buffer_load_dwordx4 v[112:115], v1, s[4:7], s32 offen offset:2048
v_mfma_f32_16x16x32_bf16 a[48:51], v[116:119], v[184:187], a[48:51]
v_mfma_f32_16x16x32_bf16 a[52:55], v[116:119], v[188:191], a[52:55]
v_mfma_f32_16x16x32_bf16 a[56:59], v[116:119], v[192:195], a[56:59]
v_mfma_f32_16x16x32_bf16 a[60:63], v[116:119], v[196:199], a[60:63]
ds_read_b128 v[212:215], v6 offset:31744
buffer_load_dwordx4 v[116:119], v1, s[4:7], s33 offen offset:2048
v_mfma_f32_16x16x32_bf16 a[64:67], v[120:123], v[184:187], a[64:67]
v_mfma_f32_16x16x32_bf16 a[68:71], v[120:123], v[188:191], a[68:71]
v_mfma_f32_16x16x32_bf16 a[72:75], v[120:123], v[192:195], a[72:75]
v_mfma_f32_16x16x32_bf16 a[76:79], v[120:123], v[196:199], a[76:79]
buffer_load_dwordx4 v[120:123], v1, s[4:7], s34 offen offset:2048
v_mfma_f32_16x16x32_bf16 a[80:83], v[124:127], v[184:187], a[80:83]
v_mfma_f32_16x16x32_bf16 a[84:87], v[124:127], v[188:191], a[84:87]
v_mfma_f32_16x16x32_bf16 a[88:91], v[124:127], v[192:195], a[88:91]
v_mfma_f32_16x16x32_bf16 a[92:95], v[124:127], v[196:199], a[92:95]
buffer_load_dwordx4 v[124:127], v1, s[4:7], s35 offen offset:2048
v_mfma_f32_16x16x32_bf16 a[96:99], v[128:131], v[184:187], a[96:99]
v_mfma_f32_16x16x32_bf16 a[100:103], v[128:131], v[188:191], a[100:103]
v_mfma_f32_16x16x32_bf16 a[104:107], v[128:131], v[192:195], a[104:107]
v_mfma_f32_16x16x32_bf16 a[108:111], v[128:131], v[196:199], a[108:111]
buffer_load_dwordx4 v[128:131], v1, s[4:7], s36 offen offset:2048
v_mfma_f32_16x16x32_bf16 a[112:115], v[132:135], v[184:187], a[112:115]
v_mfma_f32_16x16x32_bf16 a[116:119], v[132:135], v[188:191], a[116:119]
v_mfma_f32_16x16x32_bf16 a[120:123], v[132:135], v[192:195], a[120:123]
v_mfma_f32_16x16x32_bf16 a[124:127], v[132:135], v[196:199], a[124:127]
buffer_load_dwordx4 v[132:135], v1, s[4:7], s37 offen offset:2048
v_mfma_f32_16x16x32_bf16 a[128:131], v[136:139], v[184:187], a[128:131]
v_mfma_f32_16x16x32_bf16 a[132:135], v[136:139], v[188:191], a[132:135]
v_mfma_f32_16x16x32_bf16 a[136:139], v[136:139], v[192:195], a[136:139]
v_mfma_f32_16x16x32_bf16 a[140:143], v[136:139], v[196:199], a[140:143]
buffer_load_dwordx4 v[136:139], v1, s[4:7], s38 offen offset:2048
v_mfma_f32_16x16x32_bf16 a[144:147], v[140:143], v[184:187], a[144:147]
v_mfma_f32_16x16x32_bf16 a[148:151], v[140:143], v[188:191], a[148:151]
v_mfma_f32_16x16x32_bf16 a[152:155], v[140:143], v[192:195], a[152:155]
v_mfma_f32_16x16x32_bf16 a[156:159], v[140:143], v[196:199], a[156:159]
buffer_load_dwordx4 v[140:143], v1, s[4:7], s39 offen offset:2048
s_waitcnt vmcnt(30) lgkmcnt(0)
v_mfma_f32_16x16x32_bf16 a[0:3], v[144:147], v[200:203], a[0:3]
v_mfma_f32_16x16x32_bf16 a[4:7], v[144:147], v[204:207], a[4:7]
v_mfma_f32_16x16x32_bf16 a[8:11], v[144:147], v[208:211], a[8:11]
v_mfma_f32_16x16x32_bf16 a[12:15], v[144:147], v[212:215], a[12:15]
ds_read_b128 v[184:187], v1 offset:8192
buffer_load_dwordx4 v[144:147], v1, s[4:7], s30 offen offset:3072
s_add_u32 s30, s30, 4096
v_mfma_f32_16x16x32_bf16 a[16:19], v[148:151], v[200:203], a[16:19]
v_mfma_f32_16x16x32_bf16 a[20:23], v[148:151], v[204:207], a[20:23]
v_mfma_f32_16x16x32_bf16 a[24:27], v[148:151], v[208:211], a[24:27]
v_mfma_f32_16x16x32_bf16 a[28:31], v[148:151], v[212:215], a[28:31]
ds_read_b128 v[188:191], v1 offset:32768
buffer_load_dwordx4 v[148:151], v1, s[4:7], s31 offen offset:3072
s_add_u32 s31, s31, 4096
v_mfma_f32_16x16x32_bf16 a[32:35], v[152:155], v[200:203], a[32:35]
v_mfma_f32_16x16x32_bf16 a[36:39], v[152:155], v[204:207], a[36:39]
v_mfma_f32_16x16x32_bf16 a[40:43], v[152:155], v[208:211], a[40:43]
v_mfma_f32_16x16x32_bf16 a[44:47], v[152:155], v[212:215], a[44:47]
ds_read_b128 v[192:195], v6 offset:8192
buffer_load_dwordx4 v[152:155], v1, s[4:7], s32 offen offset:3072
s_add_u32 s32, s32, 4096
v_mfma_f32_16x16x32_bf16 a[48:51], v[156:159], v[200:203], a[48:51]
v_mfma_f32_16x16x32_bf16 a[52:55], v[156:159], v[204:207], a[52:55]
v_mfma_f32_16x16x32_bf16 a[56:59], v[156:159], v[208:211], a[56:59]
v_mfma_f32_16x16x32_bf16 a[60:63], v[156:159], v[212:215], a[60:63]
ds_read_b128 v[196:199], v6 offset:32768
buffer_load_dwordx4 v[156:159], v1, s[4:7], s33 offen offset:3072
s_add_u32 s33, s33, 4096
v_mfma_f32_16x16x32_bf16 a[64:67], v[160:163], v[200:203], a[64:67]
v_mfma_f32_16x16x32_bf16 a[68:71], v[160:163], v[204:207], a[68:71]
v_mfma_f32_16x16x32_bf16 a[72:75], v[160:163], v[208:211], a[72:75]
v_mfma_f32_16x16x32_bf16 a[76:79], v[160:163], v[212:215], a[76:79]
buffer_load_dwordx4 v[160:163], v1, s[4:7], s34 offen offset:3072
s_add_u32 s34, s34, 4096
v_mfma_f32_16x16x32_bf16 a[80:83], v[164:167], v[200:203], a[80:83]
v_mfma_f32_16x16x32_bf16 a[84:87], v[164:167], v[204:207], a[84:87]
v_mfma_f32_16x16x32_bf16 a[88:91], v[164:167], v[208:211], a[88:91]
v_mfma_f32_16x16x32_bf16 a[92:95], v[164:167], v[212:215], a[92:95]
buffer_load_dwordx4 v[164:167], v1, s[4:7], s35 offen offset:3072
s_add_u32 s35, s35, 4096
v_mfma_f32_16x16x32_bf16 a[96:99], v[168:171], v[200:203], a[96:99]
v_mfma_f32_16x16x32_bf16 a[100:103], v[168:171], v[204:207], a[100:103]
v_mfma_f32_16x16x32_bf16 a[104:107], v[168:171], v[208:211], a[104:107]
v_mfma_f32_16x16x32_bf16 a[108:111], v[168:171], v[212:215], a[108:111]
buffer_load_dwordx4 v[168:171], v1, s[4:7], s36 offen offset:3072
s_add_u32 s36, s36, 4096
v_mfma_f32_16x16x32_bf16 a[112:115], v[172:175], v[200:203], a[112:115]
v_mfma_f32_16x16x32_bf16 a[116:119], v[172:175], v[204:207], a[116:119]
v_mfma_f32_16x16x32_bf16 a[120:123], v[172:175], v[208:211], a[120:123]
v_mfma_f32_16x16x32_bf16 a[124:127], v[172:175], v[212:215], a[124:127]
buffer_load_dwordx4 v[172:175], v1, s[4:7], s37 offen offset:3072
s_add_u32 s37, s37, 4096
v_mfma_f32_16x16x32_bf16 a[128:131], v[176:179], v[200:203], a[128:131]
v_mfma_f32_16x16x32_bf16 a[132:135], v[176:179], v[204:207], a[132:135]
v_mfma_f32_16x16x32_bf16 a[136:139], v[176:179], v[208:211], a[136:139]
v_mfma_f32_16x16x32_bf16 a[140:143], v[176:179], v[212:215], a[140:143]
buffer_load_dwordx4 v[176:179], v1, s[4:7], s38 offen offset:3072
s_add_u32 s38, s38, 4096
v_mfma_f32_16x16x32_bf16 a[144:147], v[180:183], v[200:203], a[144:147]
v_mfma_f32_16x16x32_bf16 a[148:151], v[180:183], v[204:207], a[148:151]
v_mfma_f32_16x16x32_bf16 a[152:155], v[180:183], v[208:211], a[152:155]
v_mfma_f32_16x16x32_bf16 a[156:159], v[180:183], v[212:215], a[156:159]
buffer_load_dwordx4 v[180:183], v1, s[4:7], s39 offen offset:3072
s_add_u32 s39, s39, 4096
s_waitcnt vmcnt(30) lgkmcnt(0)
v_mfma_f32_16x16x32_bf16 a[0:3], v[24:27], v[184:187], a[0:3]
v_mfma_f32_16x16x32_bf16 a[4:7], v[24:27], v[188:191], a[4:7]
v_mfma_f32_16x16x32_bf16 a[8:11], v[24:27], v[192:195], a[8:11]
v_mfma_f32_16x16x32_bf16 a[12:15], v[24:27], v[196:199], a[12:15]
ds_read_b128 v[200:203], v1 offset:9216
buffer_load_dwordx4 v[24:27], v1, s[4:7], s30 offen offset:0
v_mfma_f32_16x16x32_bf16 a[16:19], v[28:31], v[184:187], a[16:19]
v_mfma_f32_16x16x32_bf16 a[20:23], v[28:31], v[188:191], a[20:23]
v_mfma_f32_16x16x32_bf16 a[24:27], v[28:31], v[192:195], a[24:27]
v_mfma_f32_16x16x32_bf16 a[28:31], v[28:31], v[196:199], a[28:31]
ds_read_b128 v[204:207], v1 offset:33792
buffer_load_dwordx4 v[28:31], v1, s[4:7], s31 offen offset:0
v_mfma_f32_16x16x32_bf16 a[32:35], v[32:35], v[184:187], a[32:35]
v_mfma_f32_16x16x32_bf16 a[36:39], v[32:35], v[188:191], a[36:39]
v_mfma_f32_16x16x32_bf16 a[40:43], v[32:35], v[192:195], a[40:43]
v_mfma_f32_16x16x32_bf16 a[44:47], v[32:35], v[196:199], a[44:47]
ds_read_b128 v[208:211], v6 offset:9216
buffer_load_dwordx4 v[32:35], v1, s[4:7], s32 offen offset:0
v_mfma_f32_16x16x32_bf16 a[48:51], v[36:39], v[184:187], a[48:51]
v_mfma_f32_16x16x32_bf16 a[52:55], v[36:39], v[188:191], a[52:55]
v_mfma_f32_16x16x32_bf16 a[56:59], v[36:39], v[192:195], a[56:59]
v_mfma_f32_16x16x32_bf16 a[60:63], v[36:39], v[196:199], a[60:63]
ds_read_b128 v[212:215], v6 offset:33792
buffer_load_dwordx4 v[36:39], v1, s[4:7], s33 offen offset:0
v_mfma_f32_16x16x32_bf16 a[64:67], v[40:43], v[184:187], a[64:67]
v_mfma_f32_16x16x32_bf16 a[68:71], v[40:43], v[188:191], a[68:71]
v_mfma_f32_16x16x32_bf16 a[72:75], v[40:43], v[192:195], a[72:75]
v_mfma_f32_16x16x32_bf16 a[76:79], v[40:43], v[196:199], a[76:79]
buffer_load_dwordx4 v[40:43], v1, s[4:7], s34 offen offset:0
v_mfma_f32_16x16x32_bf16 a[80:83], v[44:47], v[184:187], a[80:83]
v_mfma_f32_16x16x32_bf16 a[84:87], v[44:47], v[188:191], a[84:87]
v_mfma_f32_16x16x32_bf16 a[88:91], v[44:47], v[192:195], a[88:91]
v_mfma_f32_16x16x32_bf16 a[92:95], v[44:47], v[196:199], a[92:95]
buffer_load_dwordx4 v[44:47], v1, s[4:7], s35 offen offset:0
v_mfma_f32_16x16x32_bf16 a[96:99], v[48:51], v[184:187], a[96:99]
v_mfma_f32_16x16x32_bf16 a[100:103], v[48:51], v[188:191], a[100:103]
v_mfma_f32_16x16x32_bf16 a[104:107], v[48:51], v[192:195], a[104:107]
v_mfma_f32_16x16x32_bf16 a[108:111], v[48:51], v[196:199], a[108:111]
buffer_load_dwordx4 v[48:51], v1, s[4:7], s36 offen offset:0
v_mfma_f32_16x16x32_bf16 a[112:115], v[52:55], v[184:187], a[112:115]
v_mfma_f32_16x16x32_bf16 a[116:119], v[52:55], v[188:191], a[116:119]
v_mfma_f32_16x16x32_bf16 a[120:123], v[52:55], v[192:195], a[120:123]
v_mfma_f32_16x16x32_bf16 a[124:127], v[52:55], v[196:199], a[124:127]
buffer_load_dwordx4 v[52:55], v1, s[4:7], s37 offen offset:0
v_mfma_f32_16x16x32_bf16 a[128:131], v[56:59], v[184:187], a[128:131]
v_mfma_f32_16x16x32_bf16 a[132:135], v[56:59], v[188:191], a[132:135]
v_mfma_f32_16x16x32_bf16 a[136:139], v[56:59], v[192:195], a[136:139]
v_mfma_f32_16x16x32_bf16 a[140:143], v[56:59], v[196:199], a[140:143]
buffer_load_dwordx4 v[56:59], v1, s[4:7], s38 offen offset:0
v_mfma_f32_16x16x32_bf16 a[144:147], v[60:63], v[184:187], a[144:147]
v_mfma_f32_16x16x32_bf16 a[148:151], v[60:63], v[188:191], a[148:151]
v_mfma_f32_16x16x32_bf16 a[152:155], v[60:63], v[192:195], a[152:155]
v_mfma_f32_16x16x32_bf16 a[156:159], v[60:63], v[196:199], a[156:159]
buffer_load_dwordx4 v[60:63], v1, s[4:7], s39 offen offset:0
s_waitcnt vmcnt(30) lgkmcnt(0)
v_mfma_f32_16x16x32_bf16 a[0:3], v[64:67], v[200:203], a[0:3]
v_mfma_f32_16x16x32_bf16 a[4:7], v[64:67], v[204:207], a[4:7]
v_mfma_f32_16x16x32_bf16 a[8:11], v[64:67], v[208:211], a[8:11]
v_mfma_f32_16x16x32_bf16 a[12:15], v[64:67], v[212:215], a[12:15]
ds_read_b128 v[184:187], v1 offset:10240
buffer_load_dwordx4 v[64:67], v1, s[4:7], s30 offen offset:1024
v_mfma_f32_16x16x32_bf16 a[16:19], v[68:71], v[200:203], a[16:19]
v_mfma_f32_16x16x32_bf16 a[20:23], v[68:71], v[204:207], a[20:23]
v_mfma_f32_16x16x32_bf16 a[24:27], v[68:71], v[208:211], a[24:27]
v_mfma_f32_16x16x32_bf16 a[28:31], v[68:71], v[212:215], a[28:31]
ds_read_b128 v[188:191], v1 offset:34816
buffer_load_dwordx4 v[68:71], v1, s[4:7], s31 offen offset:1024
v_mfma_f32_16x16x32_bf16 a[32:35], v[72:75], v[200:203], a[32:35]
v_mfma_f32_16x16x32_bf16 a[36:39], v[72:75], v[204:207], a[36:39]
v_mfma_f32_16x16x32_bf16 a[40:43], v[72:75], v[208:211], a[40:43]
v_mfma_f32_16x16x32_bf16 a[44:47], v[72:75], v[212:215], a[44:47]
ds_read_b128 v[192:195], v6 offset:10240
buffer_load_dwordx4 v[72:75], v1, s[4:7], s32 offen offset:1024
v_mfma_f32_16x16x32_bf16 a[48:51], v[76:79], v[200:203], a[48:51]
v_mfma_f32_16x16x32_bf16 a[52:55], v[76:79], v[204:207], a[52:55]
v_mfma_f32_16x16x32_bf16 a[56:59], v[76:79], v[208:211], a[56:59]
v_mfma_f32_16x16x32_bf16 a[60:63], v[76:79], v[212:215], a[60:63]
ds_read_b128 v[196:199], v6 offset:34816
buffer_load_dwordx4 v[76:79], v1, s[4:7], s33 offen offset:1024
v_mfma_f32_16x16x32_bf16 a[64:67], v[80:83], v[200:203], a[64:67]
v_mfma_f32_16x16x32_bf16 a[68:71], v[80:83], v[204:207], a[68:71]
v_mfma_f32_16x16x32_bf16 a[72:75], v[80:83], v[208:211], a[72:75]
v_mfma_f32_16x16x32_bf16 a[76:79], v[80:83], v[212:215], a[76:79]
buffer_load_dwordx4 v[80:83], v1, s[4:7], s34 offen offset:1024
v_mfma_f32_16x16x32_bf16 a[80:83], v[84:87], v[200:203], a[80:83]
v_mfma_f32_16x16x32_bf16 a[84:87], v[84:87], v[204:207], a[84:87]
v_mfma_f32_16x16x32_bf16 a[88:91], v[84:87], v[208:211], a[88:91]
v_mfma_f32_16x16x32_bf16 a[92:95], v[84:87], v[212:215], a[92:95]
buffer_load_dwordx4 v[84:87], v1, s[4:7], s35 offen offset:1024
v_mfma_f32_16x16x32_bf16 a[96:99], v[88:91], v[200:203], a[96:99]
v_mfma_f32_16x16x32_bf16 a[100:103], v[88:91], v[204:207], a[100:103]
v_mfma_f32_16x16x32_bf16 a[104:107], v[88:91], v[208:211], a[104:107]
v_mfma_f32_16x16x32_bf16 a[108:111], v[88:91], v[212:215], a[108:111]
buffer_load_dwordx4 v[88:91], v1, s[4:7], s36 offen offset:1024
v_mfma_f32_16x16x32_bf16 a[112:115], v[92:95], v[200:203], a[112:115]
v_mfma_f32_16x16x32_bf16 a[116:119], v[92:95], v[204:207], a[116:119]
v_mfma_f32_16x16x32_bf16 a[120:123], v[92:95], v[208:211], a[120:123]
v_mfma_f32_16x16x32_bf16 a[124:127], v[92:95], v[212:215], a[124:127]
buffer_load_dwordx4 v[92:95], v1, s[4:7], s37 offen offset:1024
v_mfma_f32_16x16x32_bf16 a[128:131], v[96:99], v[200:203], a[128:131]
v_mfma_f32_16x16x32_bf16 a[132:135], v[96:99], v[204:207], a[132:135]
v_mfma_f32_16x16x32_bf16 a[136:139], v[96:99], v[208:211], a[136:139]
v_mfma_f32_16x16x32_bf16 a[140:143], v[96:99], v[212:215], a[140:143]
buffer_load_dwordx4 v[96:99], v1, s[4:7], s38 offen offset:1024
v_mfma_f32_16x16x32_bf16 a[144:147], v[100:103], v[200:203], a[144:147]
v_mfma_f32_16x16x32_bf16 a[148:151], v[100:103], v[204:207], a[148:151]
v_mfma_f32_16x16x32_bf16 a[152:155], v[100:103], v[208:211], a[152:155]
v_mfma_f32_16x16x32_bf16 a[156:159], v[100:103], v[212:215], a[156:159]
buffer_load_dwordx4 v[100:103], v1, s[4:7], s39 offen offset:1024
s_waitcnt vmcnt(30) lgkmcnt(0)
v_mfma_f32_16x16x32_bf16 a[0:3], v[104:107], v[184:187], a[0:3]
v_mfma_f32_16x16x32_bf16 a[4:7], v[104:107], v[188:191], a[4:7]
v_mfma_f32_16x16x32_bf16 a[8:11], v[104:107], v[192:195], a[8:11]
v_mfma_f32_16x16x32_bf16 a[12:15], v[104:107], v[196:199], a[12:15]
ds_read_b128 v[200:203], v1 offset:11264
buffer_load_dwordx4 v[104:107], v1, s[4:7], s30 offen offset:2048
v_mfma_f32_16x16x32_bf16 a[16:19], v[108:111], v[184:187], a[16:19]
v_mfma_f32_16x16x32_bf16 a[20:23], v[108:111], v[188:191], a[20:23]
v_mfma_f32_16x16x32_bf16 a[24:27], v[108:111], v[192:195], a[24:27]
v_mfma_f32_16x16x32_bf16 a[28:31], v[108:111], v[196:199], a[28:31]
ds_read_b128 v[204:207], v1 offset:35840
buffer_load_dwordx4 v[108:111], v1, s[4:7], s31 offen offset:2048
v_mfma_f32_16x16x32_bf16 a[32:35], v[112:115], v[184:187], a[32:35]
v_mfma_f32_16x16x32_bf16 a[36:39], v[112:115], v[188:191], a[36:39]
v_mfma_f32_16x16x32_bf16 a[40:43], v[112:115], v[192:195], a[40:43]
v_mfma_f32_16x16x32_bf16 a[44:47], v[112:115], v[196:199], a[44:47]
ds_read_b128 v[208:211], v6 offset:11264
buffer_load_dwordx4 v[112:115], v1, s[4:7], s32 offen offset:2048
v_mfma_f32_16x16x32_bf16 a[48:51], v[116:119], v[184:187], a[48:51]
v_mfma_f32_16x16x32_bf16 a[52:55], v[116:119], v[188:191], a[52:55]
v_mfma_f32_16x16x32_bf16 a[56:59], v[116:119], v[192:195], a[56:59]
v_mfma_f32_16x16x32_bf16 a[60:63], v[116:119], v[196:199], a[60:63]
ds_read_b128 v[212:215], v6 offset:35840
buffer_load_dwordx4 v[116:119], v1, s[4:7], s33 offen offset:2048
v_mfma_f32_16x16x32_bf16 a[64:67], v[120:123], v[184:187], a[64:67]
v_mfma_f32_16x16x32_bf16 a[68:71], v[120:123], v[188:191], a[68:71]
v_mfma_f32_16x16x32_bf16 a[72:75], v[120:123], v[192:195], a[72:75]
v_mfma_f32_16x16x32_bf16 a[76:79], v[120:123], v[196:199], a[76:79]
buffer_load_dwordx4 v[120:123], v1, s[4:7], s34 offen offset:2048
v_mfma_f32_16x16x32_bf16 a[80:83], v[124:127], v[184:187], a[80:83]
v_mfma_f32_16x16x32_bf16 a[84:87], v[124:127], v[188:191], a[84:87]
v_mfma_f32_16x16x32_bf16 a[88:91], v[124:127], v[192:195], a[88:91]
v_mfma_f32_16x16x32_bf16 a[92:95], v[124:127], v[196:199], a[92:95]
buffer_load_dwordx4 v[124:127], v1, s[4:7], s35 offen offset:2048
v_mfma_f32_16x16x32_bf16 a[96:99], v[128:131], v[184:187], a[96:99]
v_mfma_f32_16x16x32_bf16 a[100:103], v[128:131], v[188:191], a[100:103]
v_mfma_f32_16x16x32_bf16 a[104:107], v[128:131], v[192:195], a[104:107]
v_mfma_f32_16x16x32_bf16 a[108:111], v[128:131], v[196:199], a[108:111]
buffer_load_dwordx4 v[128:131], v1, s[4:7], s36 offen offset:2048
v_mfma_f32_16x16x32_bf16 a[112:115], v[132:135], v[184:187], a[112:115]
v_mfma_f32_16x16x32_bf16 a[116:119], v[132:135], v[188:191], a[116:119]
v_mfma_f32_16x16x32_bf16 a[120:123], v[132:135], v[192:195], a[120:123]
v_mfma_f32_16x16x32_bf16 a[124:127], v[132:135], v[196:199], a[124:127]
buffer_load_dwordx4 v[132:135], v1, s[4:7], s37 offen offset:2048
v_mfma_f32_16x16x32_bf16 a[128:131], v[136:139], v[184:187], a[128:131]
v_mfma_f32_16x16x32_bf16 a[132:135], v[136:139], v[188:191], a[132:135]
v_mfma_f32_16x16x32_bf16 a[136:139], v[136:139], v[192:195], a[136:139]
v_mfma_f32_16x16x32_bf16 a[140:143], v[136:139], v[196:199], a[140:143]
buffer_load_dwordx4 v[136:139], v1, s[4:7], s38 offen offset:2048
v_mfma_f32_16x16x32_bf16 a[144:147], v[140:143], v[184:187], a[144:147]
v_mfma_f32_16x16x32_bf16 a[148:151], v[140:143], v[188:191], a[148:151]
v_mfma_f32_16x16x32_bf16 a[152:155], v[140:143], v[192:195], a[152:155]
v_mfma_f32_16x16x32_bf16 a[156:159], v[140:143], v[196:199], a[156:159]
buffer_load_dwordx4 v[140:143], v1, s[4:7], s39 offen offset:2048
s_waitcnt vmcnt(30) lgkmcnt(0)
v_mfma_f32_16x16x32_bf16 a[0:3], v[144:147], v[200:203], a[0:3]
v_mfma_f32_16x16x32_bf16 a[4:7], v[144:147], v[204:207], a[4:7]
v_mfma_f32_16x16x32_bf16 a[8:11], v[144:147], v[208:211], a[8:11]
v_mfma_f32_16x16x32_bf16 a[12:15], v[144:147], v[212:215], a[12:15]
ds_read_b128 v[184:187], v1 offset:12288
buffer_load_dwordx4 v[144:147], v1, s[4:7], s30 offen offset:3072
s_add_u32 s30, s30, 4096
v_mfma_f32_16x16x32_bf16 a[16:19], v[148:151], v[200:203], a[16:19]
v_mfma_f32_16x16x32_bf16 a[20:23], v[148:151], v[204:207], a[20:23]
v_mfma_f32_16x16x32_bf16 a[24:27], v[148:151], v[208:211], a[24:27]
v_mfma_f32_16x16x32_bf16 a[28:31], v[148:151], v[212:215], a[28:31]
ds_read_b128 v[188:191], v1 offset:36864
buffer_load_dwordx4 v[148:151], v1, s[4:7], s31 offen offset:3072
s_add_u32 s31, s31, 4096
v_mfma_f32_16x16x32_bf16 a[32:35], v[152:155], v[200:203], a[32:35]
v_mfma_f32_16x16x32_bf16 a[36:39], v[152:155], v[204:207], a[36:39]
v_mfma_f32_16x16x32_bf16 a[40:43], v[152:155], v[208:211], a[40:43]
v_mfma_f32_16x16x32_bf16 a[44:47], v[152:155], v[212:215], a[44:47]
ds_read_b128 v[192:195], v6 offset:12288
buffer_load_dwordx4 v[152:155], v1, s[4:7], s32 offen offset:3072
s_add_u32 s32, s32, 4096
v_mfma_f32_16x16x32_bf16 a[48:51], v[156:159], v[200:203], a[48:51]
v_mfma_f32_16x16x32_bf16 a[52:55], v[156:159], v[204:207], a[52:55]
v_mfma_f32_16x16x32_bf16 a[56:59], v[156:159], v[208:211], a[56:59]
v_mfma_f32_16x16x32_bf16 a[60:63], v[156:159], v[212:215], a[60:63]
ds_read_b128 v[196:199], v6 offset:36864
buffer_load_dwordx4 v[156:159], v1, s[4:7], s33 offen offset:3072
s_add_u32 s33, s33, 4096
v_mfma_f32_16x16x32_bf16 a[64:67], v[160:163], v[200:203], a[64:67]
v_mfma_f32_16x16x32_bf16 a[68:71], v[160:163], v[204:207], a[68:71]
v_mfma_f32_16x16x32_bf16 a[72:75], v[160:163], v[208:211], a[72:75]
v_mfma_f32_16x16x32_bf16 a[76:79], v[160:163], v[212:215], a[76:79]
buffer_load_dwordx4 v[160:163], v1, s[4:7], s34 offen offset:3072
s_add_u32 s34, s34, 4096
v_mfma_f32_16x16x32_bf16 a[80:83], v[164:167], v[200:203], a[80:83]
v_mfma_f32_16x16x32_bf16 a[84:87], v[164:167], v[204:207], a[84:87]
v_mfma_f32_16x16x32_bf16 a[88:91], v[164:167], v[208:211], a[88:91]
v_mfma_f32_16x16x32_bf16 a[92:95], v[164:167], v[212:215], a[92:95]
buffer_load_dwordx4 v[164:167], v1, s[4:7], s35 offen offset:3072
s_add_u32 s35, s35, 4096
v_mfma_f32_16x16x32_bf16 a[96:99], v[168:171], v[200:203], a[96:99]
v_mfma_f32_16x16x32_bf16 a[100:103], v[168:171], v[204:207], a[100:103]
v_mfma_f32_16x16x32_bf16 a[104:107], v[168:171], v[208:211], a[104:107]
v_mfma_f32_16x16x32_bf16 a[108:111], v[168:171], v[212:215], a[108:111]
buffer_load_dwordx4 v[168:171], v1, s[4:7], s36 offen offset:3072
s_add_u32 s36, s36, 4096
v_mfma_f32_16x16x32_bf16 a[112:115], v[172:175], v[200:203], a[112:115]
v_mfma_f32_16x16x32_bf16 a[116:119], v[172:175], v[204:207], a[116:119]
v_mfma_f32_16x16x32_bf16 a[120:123], v[172:175], v[208:211], a[120:123]
v_mfma_f32_16x16x32_bf16 a[124:127], v[172:175], v[212:215], a[124:127]
buffer_load_dwordx4 v[172:175], v1, s[4:7], s37 offen offset:3072
s_add_u32 s37, s37, 4096
v_mfma_f32_16x16x32_bf16 a[128:131], v[176:179], v[200:203], a[128:131]
v_mfma_f32_16x16x32_bf16 a[132:135], v[176:179], v[204:207], a[132:135]
v_mfma_f32_16x16x32_bf16 a[136:139], v[176:179], v[208:211], a[136:139]
v_mfma_f32_16x16x32_bf16 a[140:143], v[176:179], v[212:215], a[140:143]
buffer_load_dwordx4 v[176:179], v1, s[4:7], s38 offen offset:3072
s_add_u32 s38, s38, 4096
v_mfma_f32_16x16x32_bf16 a[144:147], v[180:183], v[200:203], a[144:147]
v_mfma_f32_16x16x32_bf16 a[148:151], v[180:183], v[204:207], a[148:151]
v_mfma_f32_16x16x32_bf16 a[152:155], v[180:183], v[208:211], a[152:155]
v_mfma_f32_16x16x32_bf16 a[156:159], v[180:183], v[212:215], a[156:159]
buffer_load_dwordx4 v[180:183], v1, s[4:7], s39 offen offset:3072
s_add_u32 s39, s39, 4096
s_waitcnt vmcnt(30) lgkmcnt(0)
v_mfma_f32_16x16x32_bf16 a[0:3], v[24:27], v[184:187], a[0:3]
v_mfma_f32_16x16x32_bf16 a[4:7], v[24:27], v[188:191], a[4:7]
v_mfma_f32_16x16x32_bf16 a[8:11], v[24:27], v[192:195], a[8:11]
v_mfma_f32_16x16x32_bf16 a[12:15], v[24:27], v[196:199], a[12:15]
ds_read_b128 v[200:203], v1 offset:13312
buffer_load_dwordx4 v[24:27], v1, s[4:7], s30 offen offset:0
v_mfma_f32_16x16x32_bf16 a[16:19], v[28:31], v[184:187], a[16:19]
v_mfma_f32_16x16x32_bf16 a[20:23], v[28:31], v[188:191], a[20:23]
v_mfma_f32_16x16x32_bf16 a[24:27], v[28:31], v[192:195], a[24:27]
v_mfma_f32_16x16x32_bf16 a[28:31], v[28:31], v[196:199], a[28:31]
ds_read_b128 v[204:207], v1 offset:37888
buffer_load_dwordx4 v[28:31], v1, s[4:7], s31 offen offset:0
v_mfma_f32_16x16x32_bf16 a[32:35], v[32:35], v[184:187], a[32:35]
v_mfma_f32_16x16x32_bf16 a[36:39], v[32:35], v[188:191], a[36:39]
v_mfma_f32_16x16x32_bf16 a[40:43], v[32:35], v[192:195], a[40:43]
v_mfma_f32_16x16x32_bf16 a[44:47], v[32:35], v[196:199], a[44:47]
ds_read_b128 v[208:211], v6 offset:13312
buffer_load_dwordx4 v[32:35], v1, s[4:7], s32 offen offset:0
v_mfma_f32_16x16x32_bf16 a[48:51], v[36:39], v[184:187], a[48:51]
v_mfma_f32_16x16x32_bf16 a[52:55], v[36:39], v[188:191], a[52:55]
v_mfma_f32_16x16x32_bf16 a[56:59], v[36:39], v[192:195], a[56:59]
v_mfma_f32_16x16x32_bf16 a[60:63], v[36:39], v[196:199], a[60:63]
ds_read_b128 v[212:215], v6 offset:37888
buffer_load_dwordx4 v[36:39], v1, s[4:7], s33 offen offset:0
v_mfma_f32_16x16x32_bf16 a[64:67], v[40:43], v[184:187], a[64:67]
v_mfma_f32_16x16x32_bf16 a[68:71], v[40:43], v[188:191], a[68:71]
v_mfma_f32_16x16x32_bf16 a[72:75], v[40:43], v[192:195], a[72:75]
v_mfma_f32_16x16x32_bf16 a[76:79], v[40:43], v[196:199], a[76:79]
buffer_load_dwordx4 v[40:43], v1, s[4:7], s34 offen offset:0
v_mfma_f32_16x16x32_bf16 a[80:83], v[44:47], v[184:187], a[80:83]
v_mfma_f32_16x16x32_bf16 a[84:87], v[44:47], v[188:191], a[84:87]
v_mfma_f32_16x16x32_bf16 a[88:91], v[44:47], v[192:195], a[88:91]
v_mfma_f32_16x16x32_bf16 a[92:95], v[44:47], v[196:199], a[92:95]
buffer_load_dwordx4 v[44:47], v1, s[4:7], s35 offen offset:0
v_mfma_f32_16x16x32_bf16 a[96:99], v[48:51], v[184:187], a[96:99]
v_mfma_f32_16x16x32_bf16 a[100:103], v[48:51], v[188:191], a[100:103]
v_mfma_f32_16x16x32_bf16 a[104:107], v[48:51], v[192:195], a[104:107]
v_mfma_f32_16x16x32_bf16 a[108:111], v[48:51], v[196:199], a[108:111]
buffer_load_dwordx4 v[48:51], v1, s[4:7], s36 offen offset:0
v_mfma_f32_16x16x32_bf16 a[112:115], v[52:55], v[184:187], a[112:115]
v_mfma_f32_16x16x32_bf16 a[116:119], v[52:55], v[188:191], a[116:119]
v_mfma_f32_16x16x32_bf16 a[120:123], v[52:55], v[192:195], a[120:123]
v_mfma_f32_16x16x32_bf16 a[124:127], v[52:55], v[196:199], a[124:127]
buffer_load_dwordx4 v[52:55], v1, s[4:7], s37 offen offset:0
v_mfma_f32_16x16x32_bf16 a[128:131], v[56:59], v[184:187], a[128:131]
v_mfma_f32_16x16x32_bf16 a[132:135], v[56:59], v[188:191], a[132:135]
v_mfma_f32_16x16x32_bf16 a[136:139], v[56:59], v[192:195], a[136:139]
v_mfma_f32_16x16x32_bf16 a[140:143], v[56:59], v[196:199], a[140:143]
buffer_load_dwordx4 v[56:59], v1, s[4:7], s38 offen offset:0
v_mfma_f32_16x16x32_bf16 a[144:147], v[60:63], v[184:187], a[144:147]
v_mfma_f32_16x16x32_bf16 a[148:151], v[60:63], v[188:191], a[148:151]
v_mfma_f32_16x16x32_bf16 a[152:155], v[60:63], v[192:195], a[152:155]
v_mfma_f32_16x16x32_bf16 a[156:159], v[60:63], v[196:199], a[156:159]
buffer_load_dwordx4 v[60:63], v1, s[4:7], s39 offen offset:0
s_waitcnt vmcnt(30) lgkmcnt(0)
v_mfma_f32_16x16x32_bf16 a[0:3], v[64:67], v[200:203], a[0:3]
v_mfma_f32_16x16x32_bf16 a[4:7], v[64:67], v[204:207], a[4:7]
v_mfma_f32_16x16x32_bf16 a[8:11], v[64:67], v[208:211], a[8:11]
v_mfma_f32_16x16x32_bf16 a[12:15], v[64:67], v[212:215], a[12:15]
ds_read_b128 v[184:187], v1 offset:14336
buffer_load_dwordx4 v[64:67], v1, s[4:7], s30 offen offset:1024
v_mfma_f32_16x16x32_bf16 a[16:19], v[68:71], v[200:203], a[16:19]
v_mfma_f32_16x16x32_bf16 a[20:23], v[68:71], v[204:207], a[20:23]
v_mfma_f32_16x16x32_bf16 a[24:27], v[68:71], v[208:211], a[24:27]
v_mfma_f32_16x16x32_bf16 a[28:31], v[68:71], v[212:215], a[28:31]
ds_read_b128 v[188:191], v1 offset:38912
buffer_load_dwordx4 v[68:71], v1, s[4:7], s31 offen offset:1024
v_mfma_f32_16x16x32_bf16 a[32:35], v[72:75], v[200:203], a[32:35]
v_mfma_f32_16x16x32_bf16 a[36:39], v[72:75], v[204:207], a[36:39]
v_mfma_f32_16x16x32_bf16 a[40:43], v[72:75], v[208:211], a[40:43]
v_mfma_f32_16x16x32_bf16 a[44:47], v[72:75], v[212:215], a[44:47]
ds_read_b128 v[192:195], v6 offset:14336
buffer_load_dwordx4 v[72:75], v1, s[4:7], s32 offen offset:1024
v_mfma_f32_16x16x32_bf16 a[48:51], v[76:79], v[200:203], a[48:51]
v_mfma_f32_16x16x32_bf16 a[52:55], v[76:79], v[204:207], a[52:55]
v_mfma_f32_16x16x32_bf16 a[56:59], v[76:79], v[208:211], a[56:59]
v_mfma_f32_16x16x32_bf16 a[60:63], v[76:79], v[212:215], a[60:63]
ds_read_b128 v[196:199], v6 offset:38912
buffer_load_dwordx4 v[76:79], v1, s[4:7], s33 offen offset:1024
v_mfma_f32_16x16x32_bf16 a[64:67], v[80:83], v[200:203], a[64:67]
v_mfma_f32_16x16x32_bf16 a[68:71], v[80:83], v[204:207], a[68:71]
v_mfma_f32_16x16x32_bf16 a[72:75], v[80:83], v[208:211], a[72:75]
v_mfma_f32_16x16x32_bf16 a[76:79], v[80:83], v[212:215], a[76:79]
buffer_load_dwordx4 v[80:83], v1, s[4:7], s34 offen offset:1024
v_mfma_f32_16x16x32_bf16 a[80:83], v[84:87], v[200:203], a[80:83]
v_mfma_f32_16x16x32_bf16 a[84:87], v[84:87], v[204:207], a[84:87]
v_mfma_f32_16x16x32_bf16 a[88:91], v[84:87], v[208:211], a[88:91]
v_mfma_f32_16x16x32_bf16 a[92:95], v[84:87], v[212:215], a[92:95]
buffer_load_dwordx4 v[84:87], v1, s[4:7], s35 offen offset:1024
v_mfma_f32_16x16x32_bf16 a[96:99], v[88:91], v[200:203], a[96:99]
v_mfma_f32_16x16x32_bf16 a[100:103], v[88:91], v[204:207], a[100:103]
v_mfma_f32_16x16x32_bf16 a[104:107], v[88:91], v[208:211], a[104:107]
v_mfma_f32_16x16x32_bf16 a[108:111], v[88:91], v[212:215], a[108:111]
buffer_load_dwordx4 v[88:91], v1, s[4:7], s36 offen offset:1024
v_mfma_f32_16x16x32_bf16 a[112:115], v[92:95], v[200:203], a[112:115]
v_mfma_f32_16x16x32_bf16 a[116:119], v[92:95], v[204:207], a[116:119]
v_mfma_f32_16x16x32_bf16 a[120:123], v[92:95], v[208:211], a[120:123]
v_mfma_f32_16x16x32_bf16 a[124:127], v[92:95], v[212:215], a[124:127]
buffer_load_dwordx4 v[92:95], v1, s[4:7], s37 offen offset:1024
v_mfma_f32_16x16x32_bf16 a[128:131], v[96:99], v[200:203], a[128:131]
v_mfma_f32_16x16x32_bf16 a[132:135], v[96:99], v[204:207], a[132:135]
v_mfma_f32_16x16x32_bf16 a[136:139], v[96:99], v[208:211], a[136:139]
v_mfma_f32_16x16x32_bf16 a[140:143], v[96:99], v[212:215], a[140:143]
buffer_load_dwordx4 v[96:99], v1, s[4:7], s38 offen offset:1024
v_mfma_f32_16x16x32_bf16 a[144:147], v[100:103], v[200:203], a[144:147]
v_mfma_f32_16x16x32_bf16 a[148:151], v[100:103], v[204:207], a[148:151]
v_mfma_f32_16x16x32_bf16 a[152:155], v[100:103], v[208:211], a[152:155]
v_mfma_f32_16x16x32_bf16 a[156:159], v[100:103], v[212:215], a[156:159]
buffer_load_dwordx4 v[100:103], v1, s[4:7], s39 offen offset:1024
s_waitcnt vmcnt(30) lgkmcnt(0)
v_mfma_f32_16x16x32_bf16 a[0:3], v[104:107], v[184:187], a[0:3]
v_mfma_f32_16x16x32_bf16 a[4:7], v[104:107], v[188:191], a[4:7]
v_mfma_f32_16x16x32_bf16 a[8:11], v[104:107], v[192:195], a[8:11]
v_mfma_f32_16x16x32_bf16 a[12:15], v[104:107], v[196:199], a[12:15]
ds_read_b128 v[200:203], v1 offset:15360
buffer_load_dwordx4 v[104:107], v1, s[4:7], s30 offen offset:2048
v_mfma_f32_16x16x32_bf16 a[16:19], v[108:111], v[184:187], a[16:19]
v_mfma_f32_16x16x32_bf16 a[20:23], v[108:111], v[188:191], a[20:23]
v_mfma_f32_16x16x32_bf16 a[24:27], v[108:111], v[192:195], a[24:27]
v_mfma_f32_16x16x32_bf16 a[28:31], v[108:111], v[196:199], a[28:31]
ds_read_b128 v[204:207], v1 offset:39936
buffer_load_dwordx4 v[108:111], v1, s[4:7], s31 offen offset:2048
v_mfma_f32_16x16x32_bf16 a[32:35], v[112:115], v[184:187], a[32:35]
v_mfma_f32_16x16x32_bf16 a[36:39], v[112:115], v[188:191], a[36:39]
v_mfma_f32_16x16x32_bf16 a[40:43], v[112:115], v[192:195], a[40:43]
v_mfma_f32_16x16x32_bf16 a[44:47], v[112:115], v[196:199], a[44:47]
ds_read_b128 v[208:211], v6 offset:15360
buffer_load_dwordx4 v[112:115], v1, s[4:7], s32 offen offset:2048
v_mfma_f32_16x16x32_bf16 a[48:51], v[116:119], v[184:187], a[48:51]
v_mfma_f32_16x16x32_bf16 a[52:55], v[116:119], v[188:191], a[52:55]
v_mfma_f32_16x16x32_bf16 a[56:59], v[116:119], v[192:195], a[56:59]
v_mfma_f32_16x16x32_bf16 a[60:63], v[116:119], v[196:199], a[60:63]
ds_read_b128 v[212:215], v6 offset:39936
buffer_load_dwordx4 v[116:119], v1, s[4:7], s33 offen offset:2048
v_mfma_f32_16x16x32_bf16 a[64:67], v[120:123], v[184:187], a[64:67]
v_mfma_f32_16x16x32_bf16 a[68:71], v[120:123], v[188:191], a[68:71]
v_mfma_f32_16x16x32_bf16 a[72:75], v[120:123], v[192:195], a[72:75]
v_mfma_f32_16x16x32_bf16 a[76:79], v[120:123], v[196:199], a[76:79]
buffer_load_dwordx4 v[120:123], v1, s[4:7], s34 offen offset:2048
v_mfma_f32_16x16x32_bf16 a[80:83], v[124:127], v[184:187], a[80:83]
v_mfma_f32_16x16x32_bf16 a[84:87], v[124:127], v[188:191], a[84:87]
v_mfma_f32_16x16x32_bf16 a[88:91], v[124:127], v[192:195], a[88:91]
v_mfma_f32_16x16x32_bf16 a[92:95], v[124:127], v[196:199], a[92:95]
buffer_load_dwordx4 v[124:127], v1, s[4:7], s35 offen offset:2048
v_mfma_f32_16x16x32_bf16 a[96:99], v[128:131], v[184:187], a[96:99]
v_mfma_f32_16x16x32_bf16 a[100:103], v[128:131], v[188:191], a[100:103]
v_mfma_f32_16x16x32_bf16 a[104:107], v[128:131], v[192:195], a[104:107]
v_mfma_f32_16x16x32_bf16 a[108:111], v[128:131], v[196:199], a[108:111]
buffer_load_dwordx4 v[128:131], v1, s[4:7], s36 offen offset:2048
v_mfma_f32_16x16x32_bf16 a[112:115], v[132:135], v[184:187], a[112:115]
v_mfma_f32_16x16x32_bf16 a[116:119], v[132:135], v[188:191], a[116:119]
v_mfma_f32_16x16x32_bf16 a[120:123], v[132:135], v[192:195], a[120:123]
v_mfma_f32_16x16x32_bf16 a[124:127], v[132:135], v[196:199], a[124:127]
buffer_load_dwordx4 v[132:135], v1, s[4:7], s37 offen offset:2048
v_mfma_f32_16x16x32_bf16 a[128:131], v[136:139], v[184:187], a[128:131]
v_mfma_f32_16x16x32_bf16 a[132:135], v[136:139], v[188:191], a[132:135]
v_mfma_f32_16x16x32_bf16 a[136:139], v[136:139], v[192:195], a[136:139]
v_mfma_f32_16x16x32_bf16 a[140:143], v[136:139], v[196:199], a[140:143]
buffer_load_dwordx4 v[136:139], v1, s[4:7], s38 offen offset:2048
v_mfma_f32_16x16x32_bf16 a[144:147], v[140:143], v[184:187], a[144:147]
v_mfma_f32_16x16x32_bf16 a[148:151], v[140:143], v[188:191], a[148:151]
v_mfma_f32_16x16x32_bf16 a[152:155], v[140:143], v[192:195], a[152:155]
v_mfma_f32_16x16x32_bf16 a[156:159], v[140:143], v[196:199], a[156:159]
buffer_load_dwordx4 v[140:143], v1, s[4:7], s39 offen offset:2048
s_waitcnt vmcnt(30) lgkmcnt(0)
v_mfma_f32_16x16x32_bf16 a[0:3], v[144:147], v[200:203], a[0:3]
v_mfma_f32_16x16x32_bf16 a[4:7], v[144:147], v[204:207], a[4:7]
v_mfma_f32_16x16x32_bf16 a[8:11], v[144:147], v[208:211], a[8:11]
v_mfma_f32_16x16x32_bf16 a[12:15], v[144:147], v[212:215], a[12:15]
ds_read_b128 v[184:187], v1 offset:16384
buffer_load_dwordx4 v[144:147], v1, s[4:7], s30 offen offset:3072
s_add_u32 s30, s30, 4096
v_mfma_f32_16x16x32_bf16 a[16:19], v[148:151], v[200:203], a[16:19]
v_mfma_f32_16x16x32_bf16 a[20:23], v[148:151], v[204:207], a[20:23]
v_mfma_f32_16x16x32_bf16 a[24:27], v[148:151], v[208:211], a[24:27]
v_mfma_f32_16x16x32_bf16 a[28:31], v[148:151], v[212:215], a[28:31]
ds_read_b128 v[188:191], v1 offset:40960
buffer_load_dwordx4 v[148:151], v1, s[4:7], s31 offen offset:3072
s_add_u32 s31, s31, 4096
v_mfma_f32_16x16x32_bf16 a[32:35], v[152:155], v[200:203], a[32:35]
v_mfma_f32_16x16x32_bf16 a[36:39], v[152:155], v[204:207], a[36:39]
v_mfma_f32_16x16x32_bf16 a[40:43], v[152:155], v[208:211], a[40:43]
v_mfma_f32_16x16x32_bf16 a[44:47], v[152:155], v[212:215], a[44:47]
ds_read_b128 v[192:195], v6 offset:16384
buffer_load_dwordx4 v[152:155], v1, s[4:7], s32 offen offset:3072
s_add_u32 s32, s32, 4096
v_mfma_f32_16x16x32_bf16 a[48:51], v[156:159], v[200:203], a[48:51]
v_mfma_f32_16x16x32_bf16 a[52:55], v[156:159], v[204:207], a[52:55]
v_mfma_f32_16x16x32_bf16 a[56:59], v[156:159], v[208:211], a[56:59]
v_mfma_f32_16x16x32_bf16 a[60:63], v[156:159], v[212:215], a[60:63]
ds_read_b128 v[196:199], v6 offset:40960
buffer_load_dwordx4 v[156:159], v1, s[4:7], s33 offen offset:3072
s_add_u32 s33, s33, 4096
v_mfma_f32_16x16x32_bf16 a[64:67], v[160:163], v[200:203], a[64:67]
v_mfma_f32_16x16x32_bf16 a[68:71], v[160:163], v[204:207], a[68:71]
v_mfma_f32_16x16x32_bf16 a[72:75], v[160:163], v[208:211], a[72:75]
v_mfma_f32_16x16x32_bf16 a[76:79], v[160:163], v[212:215], a[76:79]
buffer_load_dwordx4 v[160:163], v1, s[4:7], s34 offen offset:3072
s_add_u32 s34, s34, 4096
v_mfma_f32_16x16x32_bf16 a[80:83], v[164:167], v[200:203], a[80:83]
v_mfma_f32_16x16x32_bf16 a[84:87], v[164:167], v[204:207], a[84:87]
v_mfma_f32_16x16x32_bf16 a[88:91], v[164:167], v[208:211], a[88:91]
v_mfma_f32_16x16x32_bf16 a[92:95], v[164:167], v[212:215], a[92:95]
buffer_load_dwordx4 v[164:167], v1, s[4:7], s35 offen offset:3072
s_add_u32 s35, s35, 4096
v_mfma_f32_16x16x32_bf16 a[96:99], v[168:171], v[200:203], a[96:99]
v_mfma_f32_16x16x32_bf16 a[100:103], v[168:171], v[204:207], a[100:103]
v_mfma_f32_16x16x32_bf16 a[104:107], v[168:171], v[208:211], a[104:107]
v_mfma_f32_16x16x32_bf16 a[108:111], v[168:171], v[212:215], a[108:111]
buffer_load_dwordx4 v[168:171], v1, s[4:7], s36 offen offset:3072
s_add_u32 s36, s36, 4096
v_mfma_f32_16x16x32_bf16 a[112:115], v[172:175], v[200:203], a[112:115]
v_mfma_f32_16x16x32_bf16 a[116:119], v[172:175], v[204:207], a[116:119]
v_mfma_f32_16x16x32_bf16 a[120:123], v[172:175], v[208:211], a[120:123]
v_mfma_f32_16x16x32_bf16 a[124:127], v[172:175], v[212:215], a[124:127]
buffer_load_dwordx4 v[172:175], v1, s[4:7], s37 offen offset:3072
s_add_u32 s37, s37, 4096
v_mfma_f32_16x16x32_bf16 a[128:131], v[176:179], v[200:203], a[128:131]
v_mfma_f32_16x16x32_bf16 a[132:135], v[176:179], v[204:207], a[132:135]
v_mfma_f32_16x16x32_bf16 a[136:139], v[176:179], v[208:211], a[136:139]
v_mfma_f32_16x16x32_bf16 a[140:143], v[176:179], v[212:215], a[140:143]
buffer_load_dwordx4 v[176:179], v1, s[4:7], s38 offen offset:3072
s_add_u32 s38, s38, 4096
v_mfma_f32_16x16x32_bf16 a[144:147], v[180:183], v[200:203], a[144:147]
v_mfma_f32_16x16x32_bf16 a[148:151], v[180:183], v[204:207], a[148:151]
v_mfma_f32_16x16x32_bf16 a[152:155], v[180:183], v[208:211], a[152:155]
v_mfma_f32_16x16x32_bf16 a[156:159], v[180:183], v[212:215], a[156:159]
buffer_load_dwordx4 v[180:183], v1, s[4:7], s39 offen offset:3072
s_add_u32 s39, s39, 4096
s_waitcnt vmcnt(30) lgkmcnt(0)
v_mfma_f32_16x16x32_bf16 a[0:3], v[24:27], v[184:187], a[0:3]
v_mfma_f32_16x16x32_bf16 a[4:7], v[24:27], v[188:191], a[4:7]
v_mfma_f32_16x16x32_bf16 a[8:11], v[24:27], v[192:195], a[8:11]
v_mfma_f32_16x16x32_bf16 a[12:15], v[24:27], v[196:199], a[12:15]
ds_read_b128 v[200:203], v1 offset:17408
buffer_load_dwordx4 v[24:27], v1, s[4:7], s30 offen offset:0
v_mfma_f32_16x16x32_bf16 a[16:19], v[28:31], v[184:187], a[16:19]
v_mfma_f32_16x16x32_bf16 a[20:23], v[28:31], v[188:191], a[20:23]
v_mfma_f32_16x16x32_bf16 a[24:27], v[28:31], v[192:195], a[24:27]
v_mfma_f32_16x16x32_bf16 a[28:31], v[28:31], v[196:199], a[28:31]
ds_read_b128 v[204:207], v1 offset:41984
buffer_load_dwordx4 v[28:31], v1, s[4:7], s31 offen offset:0
v_mfma_f32_16x16x32_bf16 a[32:35], v[32:35], v[184:187], a[32:35]
v_mfma_f32_16x16x32_bf16 a[36:39], v[32:35], v[188:191], a[36:39]
v_mfma_f32_16x16x32_bf16 a[40:43], v[32:35], v[192:195], a[40:43]
v_mfma_f32_16x16x32_bf16 a[44:47], v[32:35], v[196:199], a[44:47]
ds_read_b128 v[208:211], v6 offset:17408
buffer_load_dwordx4 v[32:35], v1, s[4:7], s32 offen offset:0
v_mfma_f32_16x16x32_bf16 a[48:51], v[36:39], v[184:187], a[48:51]
v_mfma_f32_16x16x32_bf16 a[52:55], v[36:39], v[188:191], a[52:55]
v_mfma_f32_16x16x32_bf16 a[56:59], v[36:39], v[192:195], a[56:59]
v_mfma_f32_16x16x32_bf16 a[60:63], v[36:39], v[196:199], a[60:63]
ds_read_b128 v[212:215], v6 offset:41984
buffer_load_dwordx4 v[36:39], v1, s[4:7], s33 offen offset:0
v_mfma_f32_16x16x32_bf16 a[64:67], v[40:43], v[184:187], a[64:67]
v_mfma_f32_16x16x32_bf16 a[68:71], v[40:43], v[188:191], a[68:71]
v_mfma_f32_16x16x32_bf16 a[72:75], v[40:43], v[192:195], a[72:75]
v_mfma_f32_16x16x32_bf16 a[76:79], v[40:43], v[196:199], a[76:79]
buffer_load_dwordx4 v[40:43], v1, s[4:7], s34 offen offset:0
v_mfma_f32_16x16x32_bf16 a[80:83], v[44:47], v[184:187], a[80:83]
v_mfma_f32_16x16x32_bf16 a[84:87], v[44:47], v[188:191], a[84:87]
v_mfma_f32_16x16x32_bf16 a[88:91], v[44:47], v[192:195], a[88:91]
v_mfma_f32_16x16x32_bf16 a[92:95], v[44:47], v[196:199], a[92:95]
buffer_load_dwordx4 v[44:47], v1, s[4:7], s35 offen offset:0
v_mfma_f32_16x16x32_bf16 a[96:99], v[48:51], v[184:187], a[96:99]
v_mfma_f32_16x16x32_bf16 a[100:103], v[48:51], v[188:191], a[100:103]
v_mfma_f32_16x16x32_bf16 a[104:107], v[48:51], v[192:195], a[104:107]
v_mfma_f32_16x16x32_bf16 a[108:111], v[48:51], v[196:199], a[108:111]
buffer_load_dwordx4 v[48:51], v1, s[4:7], s36 offen offset:0
v_mfma_f32_16x16x32_bf16 a[112:115], v[52:55], v[184:187], a[112:115]
v_mfma_f32_16x16x32_bf16 a[116:119], v[52:55], v[188:191], a[116:119]
v_mfma_f32_16x16x32_bf16 a[120:123], v[52:55], v[192:195], a[120:123]
v_mfma_f32_16x16x32_bf16 a[124:127], v[52:55], v[196:199], a[124:127]
buffer_load_dwordx4 v[52:55], v1, s[4:7], s37 offen offset:0
v_mfma_f32_16x16x32_bf16 a[128:131], v[56:59], v[184:187], a[128:131]
v_mfma_f32_16x16x32_bf16 a[132:135], v[56:59], v[188:191], a[132:135]
v_mfma_f32_16x16x32_bf16 a[136:139], v[56:59], v[192:195], a[136:139]
v_mfma_f32_16x16x32_bf16 a[140:143], v[56:59], v[196:199], a[140:143]
buffer_load_dwordx4 v[56:59], v1, s[4:7], s38 offen offset:0
v_mfma_f32_16x16x32_bf16 a[144:147], v[60:63], v[184:187], a[144:147]
v_mfma_f32_16x16x32_bf16 a[148:151], v[60:63], v[188:191], a[148:151]
v_mfma_f32_16x16x32_bf16 a[152:155], v[60:63], v[192:195], a[152:155]
v_mfma_f32_16x16x32_bf16 a[156:159], v[60:63], v[196:199], a[156:159]
buffer_load_dwordx4 v[60:63], v1, s[4:7], s39 offen offset:0
s_waitcnt vmcnt(30) lgkmcnt(0)
v_mfma_f32_16x16x32_bf16 a[0:3], v[64:67], v[200:203], a[0:3]
v_mfma_f32_16x16x32_bf16 a[4:7], v[64:67], v[204:207], a[4:7]
v_mfma_f32_16x16x32_bf16 a[8:11], v[64:67], v[208:211], a[8:11]
v_mfma_f32_16x16x32_bf16 a[12:15], v[64:67], v[212:215], a[12:15]
ds_read_b128 v[184:187], v1 offset:18432
buffer_load_dwordx4 v[64:67], v1, s[4:7], s30 offen offset:1024
v_mfma_f32_16x16x32_bf16 a[16:19], v[68:71], v[200:203], a[16:19]
v_mfma_f32_16x16x32_bf16 a[20:23], v[68:71], v[204:207], a[20:23]
v_mfma_f32_16x16x32_bf16 a[24:27], v[68:71], v[208:211], a[24:27]
v_mfma_f32_16x16x32_bf16 a[28:31], v[68:71], v[212:215], a[28:31]
ds_read_b128 v[188:191], v1 offset:43008
buffer_load_dwordx4 v[68:71], v1, s[4:7], s31 offen offset:1024
v_mfma_f32_16x16x32_bf16 a[32:35], v[72:75], v[200:203], a[32:35]
v_mfma_f32_16x16x32_bf16 a[36:39], v[72:75], v[204:207], a[36:39]
v_mfma_f32_16x16x32_bf16 a[40:43], v[72:75], v[208:211], a[40:43]
v_mfma_f32_16x16x32_bf16 a[44:47], v[72:75], v[212:215], a[44:47]
ds_read_b128 v[192:195], v6 offset:18432
buffer_load_dwordx4 v[72:75], v1, s[4:7], s32 offen offset:1024
v_mfma_f32_16x16x32_bf16 a[48:51], v[76:79], v[200:203], a[48:51]
v_mfma_f32_16x16x32_bf16 a[52:55], v[76:79], v[204:207], a[52:55]
v_mfma_f32_16x16x32_bf16 a[56:59], v[76:79], v[208:211], a[56:59]
v_mfma_f32_16x16x32_bf16 a[60:63], v[76:79], v[212:215], a[60:63]
ds_read_b128 v[196:199], v6 offset:43008
buffer_load_dwordx4 v[76:79], v1, s[4:7], s33 offen offset:1024
v_mfma_f32_16x16x32_bf16 a[64:67], v[80:83], v[200:203], a[64:67]
v_mfma_f32_16x16x32_bf16 a[68:71], v[80:83], v[204:207], a[68:71]
v_mfma_f32_16x16x32_bf16 a[72:75], v[80:83], v[208:211], a[72:75]
v_mfma_f32_16x16x32_bf16 a[76:79], v[80:83], v[212:215], a[76:79]
buffer_load_dwordx4 v[80:83], v1, s[4:7], s34 offen offset:1024
v_mfma_f32_16x16x32_bf16 a[80:83], v[84:87], v[200:203], a[80:83]
v_mfma_f32_16x16x32_bf16 a[84:87], v[84:87], v[204:207], a[84:87]
v_mfma_f32_16x16x32_bf16 a[88:91], v[84:87], v[208:211], a[88:91]
v_mfma_f32_16x16x32_bf16 a[92:95], v[84:87], v[212:215], a[92:95]
buffer_load_dwordx4 v[84:87], v1, s[4:7], s35 offen offset:1024
v_mfma_f32_16x16x32_bf16 a[96:99], v[88:91], v[200:203], a[96:99]
v_mfma_f32_16x16x32_bf16 a[100:103], v[88:91], v[204:207], a[100:103]
v_mfma_f32_16x16x32_bf16 a[104:107], v[88:91], v[208:211], a[104:107]
v_mfma_f32_16x16x32_bf16 a[108:111], v[88:91], v[212:215], a[108:111]
buffer_load_dwordx4 v[88:91], v1, s[4:7], s36 offen offset:1024
v_mfma_f32_16x16x32_bf16 a[112:115], v[92:95], v[200:203], a[112:115]
v_mfma_f32_16x16x32_bf16 a[116:119], v[92:95], v[204:207], a[116:119]
v_mfma_f32_16x16x32_bf16 a[120:123], v[92:95], v[208:211], a[120:123]
v_mfma_f32_16x16x32_bf16 a[124:127], v[92:95], v[212:215], a[124:127]
buffer_load_dwordx4 v[92:95], v1, s[4:7], s37 offen offset:1024
v_mfma_f32_16x16x32_bf16 a[128:131], v[96:99], v[200:203], a[128:131]
v_mfma_f32_16x16x32_bf16 a[132:135], v[96:99], v[204:207], a[132:135]
v_mfma_f32_16x16x32_bf16 a[136:139], v[96:99], v[208:211], a[136:139]
v_mfma_f32_16x16x32_bf16 a[140:143], v[96:99], v[212:215], a[140:143]
buffer_load_dwordx4 v[96:99], v1, s[4:7], s38 offen offset:1024
v_mfma_f32_16x16x32_bf16 a[144:147], v[100:103], v[200:203], a[144:147]
v_mfma_f32_16x16x32_bf16 a[148:151], v[100:103], v[204:207], a[148:151]
v_mfma_f32_16x16x32_bf16 a[152:155], v[100:103], v[208:211], a[152:155]
v_mfma_f32_16x16x32_bf16 a[156:159], v[100:103], v[212:215], a[156:159]
buffer_load_dwordx4 v[100:103], v1, s[4:7], s39 offen offset:1024
s_waitcnt vmcnt(30) lgkmcnt(0)
v_mfma_f32_16x16x32_bf16 a[0:3], v[104:107], v[184:187], a[0:3]
v_mfma_f32_16x16x32_bf16 a[4:7], v[104:107], v[188:191], a[4:7]
v_mfma_f32_16x16x32_bf16 a[8:11], v[104:107], v[192:195], a[8:11]
v_mfma_f32_16x16x32_bf16 a[12:15], v[104:107], v[196:199], a[12:15]
ds_read_b128 v[200:203], v1 offset:19456
buffer_load_dwordx4 v[104:107], v1, s[4:7], s30 offen offset:2048
v_mfma_f32_16x16x32_bf16 a[16:19], v[108:111], v[184:187], a[16:19]
v_mfma_f32_16x16x32_bf16 a[20:23], v[108:111], v[188:191], a[20:23]
v_mfma_f32_16x16x32_bf16 a[24:27], v[108:111], v[192:195], a[24:27]
v_mfma_f32_16x16x32_bf16 a[28:31], v[108:111], v[196:199], a[28:31]
ds_read_b128 v[204:207], v1 offset:44032
buffer_load_dwordx4 v[108:111], v1, s[4:7], s31 offen offset:2048
v_mfma_f32_16x16x32_bf16 a[32:35], v[112:115], v[184:187], a[32:35]
v_mfma_f32_16x16x32_bf16 a[36:39], v[112:115], v[188:191], a[36:39]
v_mfma_f32_16x16x32_bf16 a[40:43], v[112:115], v[192:195], a[40:43]
v_mfma_f32_16x16x32_bf16 a[44:47], v[112:115], v[196:199], a[44:47]
ds_read_b128 v[208:211], v6 offset:19456
buffer_load_dwordx4 v[112:115], v1, s[4:7], s32 offen offset:2048
v_mfma_f32_16x16x32_bf16 a[48:51], v[116:119], v[184:187], a[48:51]
v_mfma_f32_16x16x32_bf16 a[52:55], v[116:119], v[188:191], a[52:55]
v_mfma_f32_16x16x32_bf16 a[56:59], v[116:119], v[192:195], a[56:59]
v_mfma_f32_16x16x32_bf16 a[60:63], v[116:119], v[196:199], a[60:63]
ds_read_b128 v[212:215], v6 offset:44032
buffer_load_dwordx4 v[116:119], v1, s[4:7], s33 offen offset:2048
v_mfma_f32_16x16x32_bf16 a[64:67], v[120:123], v[184:187], a[64:67]
v_mfma_f32_16x16x32_bf16 a[68:71], v[120:123], v[188:191], a[68:71]
v_mfma_f32_16x16x32_bf16 a[72:75], v[120:123], v[192:195], a[72:75]
v_mfma_f32_16x16x32_bf16 a[76:79], v[120:123], v[196:199], a[76:79]
buffer_load_dwordx4 v[120:123], v1, s[4:7], s34 offen offset:2048
v_mfma_f32_16x16x32_bf16 a[80:83], v[124:127], v[184:187], a[80:83]
v_mfma_f32_16x16x32_bf16 a[84:87], v[124:127], v[188:191], a[84:87]
v_mfma_f32_16x16x32_bf16 a[88:91], v[124:127], v[192:195], a[88:91]
v_mfma_f32_16x16x32_bf16 a[92:95], v[124:127], v[196:199], a[92:95]
buffer_load_dwordx4 v[124:127], v1, s[4:7], s35 offen offset:2048
v_mfma_f32_16x16x32_bf16 a[96:99], v[128:131], v[184:187], a[96:99]
v_mfma_f32_16x16x32_bf16 a[100:103], v[128:131], v[188:191], a[100:103]
v_mfma_f32_16x16x32_bf16 a[104:107], v[128:131], v[192:195], a[104:107]
v_mfma_f32_16x16x32_bf16 a[108:111], v[128:131], v[196:199], a[108:111]
buffer_load_dwordx4 v[128:131], v1, s[4:7], s36 offen offset:2048
v_mfma_f32_16x16x32_bf16 a[112:115], v[132:135], v[184:187], a[112:115]
v_mfma_f32_16x16x32_bf16 a[116:119], v[132:135], v[188:191], a[116:119]
v_mfma_f32_16x16x32_bf16 a[120:123], v[132:135], v[192:195], a[120:123]
v_mfma_f32_16x16x32_bf16 a[124:127], v[132:135], v[196:199], a[124:127]
buffer_load_dwordx4 v[132:135], v1, s[4:7], s37 offen offset:2048
v_mfma_f32_16x16x32_bf16 a[128:131], v[136:139], v[184:187], a[128:131]
v_mfma_f32_16x16x32_bf16 a[132:135], v[136:139], v[188:191], a[132:135]
v_mfma_f32_16x16x32_bf16 a[136:139], v[136:139], v[192:195], a[136:139]
v_mfma_f32_16x16x32_bf16 a[140:143], v[136:139], v[196:199], a[140:143]
buffer_load_dwordx4 v[136:139], v1, s[4:7], s38 offen offset:2048
v_mfma_f32_16x16x32_bf16 a[144:147], v[140:143], v[184:187], a[144:147]
v_mfma_f32_16x16x32_bf16 a[148:151], v[140:143], v[188:191], a[148:151]
v_mfma_f32_16x16x32_bf16 a[152:155], v[140:143], v[192:195], a[152:155]
v_mfma_f32_16x16x32_bf16 a[156:159], v[140:143], v[196:199], a[156:159]
buffer_load_dwordx4 v[140:143], v1, s[4:7], s39 offen offset:2048
s_waitcnt vmcnt(30) lgkmcnt(0)
v_mfma_f32_16x16x32_bf16 a[0:3], v[144:147], v[200:203], a[0:3]
v_mfma_f32_16x16x32_bf16 a[4:7], v[144:147], v[204:207], a[4:7]
v_mfma_f32_16x16x32_bf16 a[8:11], v[144:147], v[208:211], a[8:11]
v_mfma_f32_16x16x32_bf16 a[12:15], v[144:147], v[212:215], a[12:15]
ds_read_b128 v[184:187], v1 offset:20480
buffer_load_dwordx4 v[144:147], v1, s[4:7], s30 offen offset:3072
s_add_u32 s30, s30, 4096
v_mfma_f32_16x16x32_bf16 a[16:19], v[148:151], v[200:203], a[16:19]
v_mfma_f32_16x16x32_bf16 a[20:23], v[148:151], v[204:207], a[20:23]
v_mfma_f32_16x16x32_bf16 a[24:27], v[148:151], v[208:211], a[24:27]
v_mfma_f32_16x16x32_bf16 a[28:31], v[148:151], v[212:215], a[28:31]
ds_read_b128 v[188:191], v1 offset:45056
buffer_load_dwordx4 v[148:151], v1, s[4:7], s31 offen offset:3072
s_add_u32 s31, s31, 4096
v_mfma_f32_16x16x32_bf16 a[32:35], v[152:155], v[200:203], a[32:35]
v_mfma_f32_16x16x32_bf16 a[36:39], v[152:155], v[204:207], a[36:39]
v_mfma_f32_16x16x32_bf16 a[40:43], v[152:155], v[208:211], a[40:43]
v_mfma_f32_16x16x32_bf16 a[44:47], v[152:155], v[212:215], a[44:47]
ds_read_b128 v[192:195], v6 offset:20480
buffer_load_dwordx4 v[152:155], v1, s[4:7], s32 offen offset:3072
s_add_u32 s32, s32, 4096
v_mfma_f32_16x16x32_bf16 a[48:51], v[156:159], v[200:203], a[48:51]
v_mfma_f32_16x16x32_bf16 a[52:55], v[156:159], v[204:207], a[52:55]
v_mfma_f32_16x16x32_bf16 a[56:59], v[156:159], v[208:211], a[56:59]
v_mfma_f32_16x16x32_bf16 a[60:63], v[156:159], v[212:215], a[60:63]
ds_read_b128 v[196:199], v6 offset:45056
buffer_load_dwordx4 v[156:159], v1, s[4:7], s33 offen offset:3072
s_add_u32 s33, s33, 4096
v_mfma_f32_16x16x32_bf16 a[64:67], v[160:163], v[200:203], a[64:67]
v_mfma_f32_16x16x32_bf16 a[68:71], v[160:163], v[204:207], a[68:71]
v_mfma_f32_16x16x32_bf16 a[72:75], v[160:163], v[208:211], a[72:75]
v_mfma_f32_16x16x32_bf16 a[76:79], v[160:163], v[212:215], a[76:79]
buffer_load_dwordx4 v[160:163], v1, s[4:7], s34 offen offset:3072
s_add_u32 s34, s34, 4096
v_mfma_f32_16x16x32_bf16 a[80:83], v[164:167], v[200:203], a[80:83]
v_mfma_f32_16x16x32_bf16 a[84:87], v[164:167], v[204:207], a[84:87]
v_mfma_f32_16x16x32_bf16 a[88:91], v[164:167], v[208:211], a[88:91]
v_mfma_f32_16x16x32_bf16 a[92:95], v[164:167], v[212:215], a[92:95]
buffer_load_dwordx4 v[164:167], v1, s[4:7], s35 offen offset:3072
s_add_u32 s35, s35, 4096
v_mfma_f32_16x16x32_bf16 a[96:99], v[168:171], v[200:203], a[96:99]
v_mfma_f32_16x16x32_bf16 a[100:103], v[168:171], v[204:207], a[100:103]
v_mfma_f32_16x16x32_bf16 a[104:107], v[168:171], v[208:211], a[104:107]
v_mfma_f32_16x16x32_bf16 a[108:111], v[168:171], v[212:215], a[108:111]
buffer_load_dwordx4 v[168:171], v1, s[4:7], s36 offen offset:3072
s_add_u32 s36, s36, 4096
v_mfma_f32_16x16x32_bf16 a[112:115], v[172:175], v[200:203], a[112:115]
v_mfma_f32_16x16x32_bf16 a[116:119], v[172:175], v[204:207], a[116:119]
v_mfma_f32_16x16x32_bf16 a[120:123], v[172:175], v[208:211], a[120:123]
v_mfma_f32_16x16x32_bf16 a[124:127], v[172:175], v[212:215], a[124:127]
buffer_load_dwordx4 v[172:175], v1, s[4:7], s37 offen offset:3072
s_add_u32 s37, s37, 4096
v_mfma_f32_16x16x32_bf16 a[128:131], v[176:179], v[200:203], a[128:131]
v_mfma_f32_16x16x32_bf16 a[132:135], v[176:179], v[204:207], a[132:135]
v_mfma_f32_16x16x32_bf16 a[136:139], v[176:179], v[208:211], a[136:139]
v_mfma_f32_16x16x32_bf16 a[140:143], v[176:179], v[212:215], a[140:143]
buffer_load_dwordx4 v[176:179], v1, s[4:7], s38 offen offset:3072
s_add_u32 s38, s38, 4096
v_mfma_f32_16x16x32_bf16 a[144:147], v[180:183], v[200:203], a[144:147]
v_mfma_f32_16x16x32_bf16 a[148:151], v[180:183], v[204:207], a[148:151]
v_mfma_f32_16x16x32_bf16 a[152:155], v[180:183], v[208:211], a[152:155]
v_mfma_f32_16x16x32_bf16 a[156:159], v[180:183], v[212:215], a[156:159]
buffer_load_dwordx4 v[180:183], v1, s[4:7], s39 offen offset:3072
s_add_u32 s39, s39, 4096
s_waitcnt vmcnt(30) lgkmcnt(0)
v_mfma_f32_16x16x32_bf16 a[0:3], v[24:27], v[184:187], a[0:3]
v_mfma_f32_16x16x32_bf16 a[4:7], v[24:27], v[188:191], a[4:7]
v_mfma_f32_16x16x32_bf16 a[8:11], v[24:27], v[192:195], a[8:11]
v_mfma_f32_16x16x32_bf16 a[12:15], v[24:27], v[196:199], a[12:15]
ds_read_b128 v[200:203], v1 offset:21504
v_mfma_f32_16x16x32_bf16 a[16:19], v[28:31], v[184:187], a[16:19]
v_mfma_f32_16x16x32_bf16 a[20:23], v[28:31], v[188:191], a[20:23]
v_mfma_f32_16x16x32_bf16 a[24:27], v[28:31], v[192:195], a[24:27]
v_mfma_f32_16x16x32_bf16 a[28:31], v[28:31], v[196:199], a[28:31]
ds_read_b128 v[204:207], v1 offset:46080
v_mfma_f32_16x16x32_bf16 a[32:35], v[32:35], v[184:187], a[32:35]
v_mfma_f32_16x16x32_bf16 a[36:39], v[32:35], v[188:191], a[36:39]
v_mfma_f32_16x16x32_bf16 a[40:43], v[32:35], v[192:195], a[40:43]
v_mfma_f32_16x16x32_bf16 a[44:47], v[32:35], v[196:199], a[44:47]
ds_read_b128 v[208:211], v6 offset:21504
v_mfma_f32_16x16x32_bf16 a[48:51], v[36:39], v[184:187], a[48:51]
v_mfma_f32_16x16x32_bf16 a[52:55], v[36:39], v[188:191], a[52:55]
v_mfma_f32_16x16x32_bf16 a[56:59], v[36:39], v[192:195], a[56:59]
v_mfma_f32_16x16x32_bf16 a[60:63], v[36:39], v[196:199], a[60:63]
ds_read_b128 v[212:215], v6 offset:46080
v_mfma_f32_16x16x32_bf16 a[64:67], v[40:43], v[184:187], a[64:67]
v_mfma_f32_16x16x32_bf16 a[68:71], v[40:43], v[188:191], a[68:71]
v_mfma_f32_16x16x32_bf16 a[72:75], v[40:43], v[192:195], a[72:75]
v_mfma_f32_16x16x32_bf16 a[76:79], v[40:43], v[196:199], a[76:79]
v_mfma_f32_16x16x32_bf16 a[80:83], v[44:47], v[184:187], a[80:83]
v_mfma_f32_16x16x32_bf16 a[84:87], v[44:47], v[188:191], a[84:87]
v_mfma_f32_16x16x32_bf16 a[88:91], v[44:47], v[192:195], a[88:91]
v_mfma_f32_16x16x32_bf16 a[92:95], v[44:47], v[196:199], a[92:95]
v_mfma_f32_16x16x32_bf16 a[96:99], v[48:51], v[184:187], a[96:99]
v_mfma_f32_16x16x32_bf16 a[100:103], v[48:51], v[188:191], a[100:103]
v_mfma_f32_16x16x32_bf16 a[104:107], v[48:51], v[192:195], a[104:107]
v_mfma_f32_16x16x32_bf16 a[108:111], v[48:51], v[196:199], a[108:111]
v_mfma_f32_16x16x32_bf16 a[112:115], v[52:55], v[184:187], a[112:115]
v_mfma_f32_16x16x32_bf16 a[116:119], v[52:55], v[188:191], a[116:119]
v_mfma_f32_16x16x32_bf16 a[120:123], v[52:55], v[192:195], a[120:123]
v_mfma_f32_16x16x32_bf16 a[124:127], v[52:55], v[196:199], a[124:127]
v_mfma_f32_16x16x32_bf16 a[128:131], v[56:59], v[184:187], a[128:131]
v_mfma_f32_16x16x32_bf16 a[132:135], v[56:59], v[188:191], a[132:135]
v_mfma_f32_16x16x32_bf16 a[136:139], v[56:59], v[192:195], a[136:139]
v_mfma_f32_16x16x32_bf16 a[140:143], v[56:59], v[196:199], a[140:143]
v_mfma_f32_16x16x32_bf16 a[144:147], v[60:63], v[184:187], a[144:147]
v_mfma_f32_16x16x32_bf16 a[148:151], v[60:63], v[188:191], a[148:151]
v_mfma_f32_16x16x32_bf16 a[152:155], v[60:63], v[192:195], a[152:155]
v_mfma_f32_16x16x32_bf16 a[156:159], v[60:63], v[196:199], a[156:159]
s_waitcnt vmcnt(20) lgkmcnt(0)
v_mfma_f32_16x16x32_bf16 a[0:3], v[64:67], v[200:203], a[0:3]
v_mfma_f32_16x16x32_bf16 a[4:7], v[64:67], v[204:207], a[4:7]
v_mfma_f32_16x16x32_bf16 a[8:11], v[64:67], v[208:211], a[8:11]
v_mfma_f32_16x16x32_bf16 a[12:15], v[64:67], v[212:215], a[12:15]
ds_read_b128 v[184:187], v1 offset:22528
v_mfma_f32_16x16x32_bf16 a[16:19], v[68:71], v[200:203], a[16:19]
v_mfma_f32_16x16x32_bf16 a[20:23], v[68:71], v[204:207], a[20:23]
v_mfma_f32_16x16x32_bf16 a[24:27], v[68:71], v[208:211], a[24:27]
v_mfma_f32_16x16x32_bf16 a[28:31], v[68:71], v[212:215], a[28:31]
ds_read_b128 v[188:191], v1 offset:47104
v_mfma_f32_16x16x32_bf16 a[32:35], v[72:75], v[200:203], a[32:35]
v_mfma_f32_16x16x32_bf16 a[36:39], v[72:75], v[204:207], a[36:39]
v_mfma_f32_16x16x32_bf16 a[40:43], v[72:75], v[208:211], a[40:43]
v_mfma_f32_16x16x32_bf16 a[44:47], v[72:75], v[212:215], a[44:47]
ds_read_b128 v[192:195], v6 offset:22528
v_mfma_f32_16x16x32_bf16 a[48:51], v[76:79], v[200:203], a[48:51]
v_mfma_f32_16x16x32_bf16 a[52:55], v[76:79], v[204:207], a[52:55]
v_mfma_f32_16x16x32_bf16 a[56:59], v[76:79], v[208:211], a[56:59]
v_mfma_f32_16x16x32_bf16 a[60:63], v[76:79], v[212:215], a[60:63]
ds_read_b128 v[196:199], v6 offset:47104
v_mfma_f32_16x16x32_bf16 a[64:67], v[80:83], v[200:203], a[64:67]
v_mfma_f32_16x16x32_bf16 a[68:71], v[80:83], v[204:207], a[68:71]
v_mfma_f32_16x16x32_bf16 a[72:75], v[80:83], v[208:211], a[72:75]
v_mfma_f32_16x16x32_bf16 a[76:79], v[80:83], v[212:215], a[76:79]
v_mfma_f32_16x16x32_bf16 a[80:83], v[84:87], v[200:203], a[80:83]
v_mfma_f32_16x16x32_bf16 a[84:87], v[84:87], v[204:207], a[84:87]
v_mfma_f32_16x16x32_bf16 a[88:91], v[84:87], v[208:211], a[88:91]
v_mfma_f32_16x16x32_bf16 a[92:95], v[84:87], v[212:215], a[92:95]
v_mfma_f32_16x16x32_bf16 a[96:99], v[88:91], v[200:203], a[96:99]
v_mfma_f32_16x16x32_bf16 a[100:103], v[88:91], v[204:207], a[100:103]
v_mfma_f32_16x16x32_bf16 a[104:107], v[88:91], v[208:211], a[104:107]
v_mfma_f32_16x16x32_bf16 a[108:111], v[88:91], v[212:215], a[108:111]
v_mfma_f32_16x16x32_bf16 a[112:115], v[92:95], v[200:203], a[112:115]
v_mfma_f32_16x16x32_bf16 a[116:119], v[92:95], v[204:207], a[116:119]
v_mfma_f32_16x16x32_bf16 a[120:123], v[92:95], v[208:211], a[120:123]
v_mfma_f32_16x16x32_bf16 a[124:127], v[92:95], v[212:215], a[124:127]
v_mfma_f32_16x16x32_bf16 a[128:131], v[96:99], v[200:203], a[128:131]
v_mfma_f32_16x16x32_bf16 a[132:135], v[96:99], v[204:207], a[132:135]
v_mfma_f32_16x16x32_bf16 a[136:139], v[96:99], v[208:211], a[136:139]
v_mfma_f32_16x16x32_bf16 a[140:143], v[96:99], v[212:215], a[140:143]
v_mfma_f32_16x16x32_bf16 a[144:147], v[100:103], v[200:203], a[144:147]
v_mfma_f32_16x16x32_bf16 a[148:151], v[100:103], v[204:207], a[148:151]
v_mfma_f32_16x16x32_bf16 a[152:155], v[100:103], v[208:211], a[152:155]
v_mfma_f32_16x16x32_bf16 a[156:159], v[100:103], v[212:215], a[156:159]
s_waitcnt vmcnt(10) lgkmcnt(0)
v_mfma_f32_16x16x32_bf16 a[0:3], v[104:107], v[184:187], a[0:3]
v_mfma_f32_16x16x32_bf16 a[4:7], v[104:107], v[188:191], a[4:7]
v_mfma_f32_16x16x32_bf16 a[8:11], v[104:107], v[192:195], a[8:11]
v_mfma_f32_16x16x32_bf16 a[12:15], v[104:107], v[196:199], a[12:15]
ds_read_b128 v[200:203], v1 offset:23552
v_mfma_f32_16x16x32_bf16 a[16:19], v[108:111], v[184:187], a[16:19]
v_mfma_f32_16x16x32_bf16 a[20:23], v[108:111], v[188:191], a[20:23]
v_mfma_f32_16x16x32_bf16 a[24:27], v[108:111], v[192:195], a[24:27]
v_mfma_f32_16x16x32_bf16 a[28:31], v[108:111], v[196:199], a[28:31]
ds_read_b128 v[204:207], v1 offset:48128
v_mfma_f32_16x16x32_bf16 a[32:35], v[112:115], v[184:187], a[32:35]
v_mfma_f32_16x16x32_bf16 a[36:39], v[112:115], v[188:191], a[36:39]
v_mfma_f32_16x16x32_bf16 a[40:43], v[112:115], v[192:195], a[40:43]
v_mfma_f32_16x16x32_bf16 a[44:47], v[112:115], v[196:199], a[44:47]
ds_read_b128 v[208:211], v6 offset:23552
v_mfma_f32_16x16x32_bf16 a[48:51], v[116:119], v[184:187], a[48:51]
v_mfma_f32_16x16x32_bf16 a[52:55], v[116:119], v[188:191], a[52:55]
v_mfma_f32_16x16x32_bf16 a[56:59], v[116:119], v[192:195], a[56:59]
v_mfma_f32_16x16x32_bf16 a[60:63], v[116:119], v[196:199], a[60:63]
ds_read_b128 v[212:215], v6 offset:48128
v_mfma_f32_16x16x32_bf16 a[64:67], v[120:123], v[184:187], a[64:67]
v_mfma_f32_16x16x32_bf16 a[68:71], v[120:123], v[188:191], a[68:71]
v_mfma_f32_16x16x32_bf16 a[72:75], v[120:123], v[192:195], a[72:75]
v_mfma_f32_16x16x32_bf16 a[76:79], v[120:123], v[196:199], a[76:79]
v_mfma_f32_16x16x32_bf16 a[80:83], v[124:127], v[184:187], a[80:83]
v_mfma_f32_16x16x32_bf16 a[84:87], v[124:127], v[188:191], a[84:87]
v_mfma_f32_16x16x32_bf16 a[88:91], v[124:127], v[192:195], a[88:91]
v_mfma_f32_16x16x32_bf16 a[92:95], v[124:127], v[196:199], a[92:95]
v_mfma_f32_16x16x32_bf16 a[96:99], v[128:131], v[184:187], a[96:99]
v_mfma_f32_16x16x32_bf16 a[100:103], v[128:131], v[188:191], a[100:103]
v_mfma_f32_16x16x32_bf16 a[104:107], v[128:131], v[192:195], a[104:107]
v_mfma_f32_16x16x32_bf16 a[108:111], v[128:131], v[196:199], a[108:111]
v_mfma_f32_16x16x32_bf16 a[112:115], v[132:135], v[184:187], a[112:115]
v_mfma_f32_16x16x32_bf16 a[116:119], v[132:135], v[188:191], a[116:119]
v_mfma_f32_16x16x32_bf16 a[120:123], v[132:135], v[192:195], a[120:123]
v_mfma_f32_16x16x32_bf16 a[124:127], v[132:135], v[196:199], a[124:127]
v_mfma_f32_16x16x32_bf16 a[128:131], v[136:139], v[184:187], a[128:131]
v_mfma_f32_16x16x32_bf16 a[132:135], v[136:139], v[188:191], a[132:135]
v_mfma_f32_16x16x32_bf16 a[136:139], v[136:139], v[192:195], a[136:139]
v_mfma_f32_16x16x32_bf16 a[140:143], v[136:139], v[196:199], a[140:143]
v_mfma_f32_16x16x32_bf16 a[144:147], v[140:143], v[184:187], a[144:147]
v_mfma_f32_16x16x32_bf16 a[148:151], v[140:143], v[188:191], a[148:151]
v_mfma_f32_16x16x32_bf16 a[152:155], v[140:143], v[192:195], a[152:155]
v_mfma_f32_16x16x32_bf16 a[156:159], v[140:143], v[196:199], a[156:159]
s_waitcnt vmcnt(0) lgkmcnt(0)
v_mfma_f32_16x16x32_bf16 a[0:3], v[144:147], v[200:203], a[0:3]
v_mfma_f32_16x16x32_bf16 a[4:7], v[144:147], v[204:207], a[4:7]
v_mfma_f32_16x16x32_bf16 a[8:11], v[144:147], v[208:211], a[8:11]
v_mfma_f32_16x16x32_bf16 a[12:15], v[144:147], v[212:215], a[12:15]
v_mfma_f32_16x16x32_bf16 a[16:19], v[148:151], v[200:203], a[16:19]
v_mfma_f32_16x16x32_bf16 a[20:23], v[148:151], v[204:207], a[20:23]
v_mfma_f32_16x16x32_bf16 a[24:27], v[148:151], v[208:211], a[24:27]
v_mfma_f32_16x16x32_bf16 a[28:31], v[148:151], v[212:215], a[28:31]
v_mfma_f32_16x16x32_bf16 a[32:35], v[152:155], v[200:203], a[32:35]
v_mfma_f32_16x16x32_bf16 a[36:39], v[152:155], v[204:207], a[36:39]
v_mfma_f32_16x16x32_bf16 a[40:43], v[152:155], v[208:211], a[40:43]
v_mfma_f32_16x16x32_bf16 a[44:47], v[152:155], v[212:215], a[44:47]
v_mfma_f32_16x16x32_bf16 a[48:51], v[156:159], v[200:203], a[48:51]
v_mfma_f32_16x16x32_bf16 a[52:55], v[156:159], v[204:207], a[52:55]
v_mfma_f32_16x16x32_bf16 a[56:59], v[156:159], v[208:211], a[56:59]
v_mfma_f32_16x16x32_bf16 a[60:63], v[156:159], v[212:215], a[60:63]
v_mfma_f32_16x16x32_bf16 a[64:67], v[160:163], v[200:203], a[64:67]
v_mfma_f32_16x16x32_bf16 a[68:71], v[160:163], v[204:207], a[68:71]
v_mfma_f32_16x16x32_bf16 a[72:75], v[160:163], v[208:211], a[72:75]
v_mfma_f32_16x16x32_bf16 a[76:79], v[160:163], v[212:215], a[76:79]
v_mfma_f32_16x16x32_bf16 a[80:83], v[164:167], v[200:203], a[80:83]
v_mfma_f32_16x16x32_bf16 a[84:87], v[164:167], v[204:207], a[84:87]
v_mfma_f32_16x16x32_bf16 a[88:91], v[164:167], v[208:211], a[88:91]
v_mfma_f32_16x16x32_bf16 a[92:95], v[164:167], v[212:215], a[92:95]
v_mfma_f32_16x16x32_bf16 a[96:99], v[168:171], v[200:203], a[96:99]
v_mfma_f32_16x16x32_bf16 a[100:103], v[168:171], v[204:207], a[100:103]
v_mfma_f32_16x16x32_bf16 a[104:107], v[168:171], v[208:211], a[104:107]
v_mfma_f32_16x16x32_bf16 a[108:111], v[168:171], v[212:215], a[108:111]
v_mfma_f32_16x16x32_bf16 a[112:115], v[172:175], v[200:203], a[112:115]
v_mfma_f32_16x16x32_bf16 a[116:119], v[172:175], v[204:207], a[116:119]
v_mfma_f32_16x16x32_bf16 a[120:123], v[172:175], v[208:211], a[120:123]
v_mfma_f32_16x16x32_bf16 a[124:127], v[172:175], v[212:215], a[124:127]
v_mfma_f32_16x16x32_bf16 a[128:131], v[176:179], v[200:203], a[128:131]
v_mfma_f32_16x16x32_bf16 a[132:135], v[176:179], v[204:207], a[132:135]
v_mfma_f32_16x16x32_bf16 a[136:139], v[176:179], v[208:211], a[136:139]
v_mfma_f32_16x16x32_bf16 a[140:143], v[176:179], v[212:215], a[140:143]
v_mfma_f32_16x16x32_bf16 a[144:147], v[180:183], v[200:203], a[144:147]
v_mfma_f32_16x16x32_bf16 a[148:151], v[180:183], v[204:207], a[148:151]
v_mfma_f32_16x16x32_bf16 a[152:155], v[180:183], v[208:211], a[152:155]
v_mfma_f32_16x16x32_bf16 a[156:159], v[180:183], v[212:215], a[156:159]
s_branch fin_store4
fin_odma3:
s_lshl_b32 s16, s14, 2
s_add_u32 s16, s16, s12
s_mul_i32 s16, s16, 192
s_mul_i32 s17, s13, 24
s_add_u32 s16, s16, s17
s_lshl_b32 s16, s16, 10
s_add_u32 s16, s16, 57147392
s_mul_i32 s17, s12, 24576
v_add_u32 v6, 49152, v1
s_add_u32 m0, s17, 0
s_add_u32 s18, s16, 0
buffer_load_dwordx4 v1, s[4:7], s18 offen offset:0 lds
buffer_load_dwordx4 v1, s[4:7], s18 offen offset:1024 lds
buffer_load_dwordx4 v1, s[4:7], s18 offen offset:2048 lds
buffer_load_dwordx4 v1, s[4:7], s18 offen offset:3072 lds
s_add_u32 m0, s17, 4096
s_add_u32 s18, s16, 4096
buffer_load_dwordx4 v1, s[4:7], s18 offen offset:0 lds
buffer_load_dwordx4 v1, s[4:7], s18 offen offset:1024 lds
buffer_load_dwordx4 a[160:163], v1, s[4:7], s30 offen offset:0
buffer_load_dwordx4 a[164:167], v1, s[4:7], s31 offen offset:0
buffer_load_dwordx4 a[168:171], v1, s[4:7], s32 offen offset:0
buffer_load_dwordx4 a[172:175], v1, s[4:7], s33 offen offset:0
buffer_load_dwordx4 a[176:179], v1, s[4:7], s34 offen offset:0
buffer_load_dwordx4 a[180:183], v1, s[4:7], s35 offen offset:0
buffer_load_dwordx4 a[184:187], v1, s[4:7], s36 offen offset:0
buffer_load_dwordx4 a[188:191], v1, s[4:7], s37 offen offset:0
buffer_load_dwordx4 a[192:195], v1, s[4:7], s38 offen offset:0
buffer_load_dwordx4 a[196:199], v1, s[4:7], s39 offen offset:0
buffer_load_dwordx4 a[200:203], v1, s[4:7], s30 offen offset:1024
buffer_load_dwordx4 a[204:207], v1, s[4:7], s31 offen offset:1024
buffer_load_dwordx4 a[208:211], v1, s[4:7], s32 offen offset:1024
buffer_load_dwordx4 a[212:215], v1, s[4:7], s33 offen offset:1024
buffer_load_dwordx4 a[216:219], v1, s[4:7], s34 offen offset:1024
buffer_load_dwordx4 a[220:223], v1, s[4:7], s35 offen offset:1024
buffer_load_dwordx4 a[224:227], v1, s[4:7], s36 offen offset:1024
buffer_load_dwordx4 a[228:231], v1, s[4:7], s37 offen offset:1024
buffer_load_dwordx4 a[232:235], v1, s[4:7], s38 offen offset:1024
buffer_load_dwordx4 a[236:239], v1, s[4:7], s39 offen offset:1024
s_add_u32 m0, s17, 6144
s_add_u32 s18, s16, 6144
buffer_load_dwordx4 v1, s[4:7], s18 offen offset:0 lds
buffer_load_dwordx4 v1, s[4:7], s18 offen offset:1024 lds
buffer_load_dwordx4 v1, s[4:7], s18 offen offset:2048 lds
buffer_load_dwordx4 v1, s[4:7], s18 offen offset:3072 lds
s_add_u32 m0, s17, 10240
s_add_u32 s18, s16, 10240
buffer_load_dwordx4 v1, s[4:7], s18 offen offset:0 lds
buffer_load_dwordx4 v1, s[4:7], s18 offen offset:1024 lds
buffer_load_dwordx4 v[104:107], v1, s[4:7], s30 offen offset:2048
buffer_load_dwordx4 v[108:111], v1, s[4:7], s31 offen offset:2048
buffer_load_dwordx4 v[112:115], v1, s[4:7], s32 offen offset:2048
buffer_load_dwordx4 v[116:119], v1, s[4:7], s33 offen offset:2048
buffer_load_dwordx4 v[120:123], v1, s[4:7], s34 offen offset:2048
buffer_load_dwordx4 v[124:127], v1, s[4:7], s35 offen offset:2048
buffer_load_dwordx4 v[128:131], v1, s[4:7], s36 offen offset:2048
buffer_load_dwordx4 v[132:135], v1, s[4:7], s37 offen offset:2048
buffer_load_dwordx4 v[136:139], v1, s[4:7], s38 offen offset:2048
buffer_load_dwordx4 v[140:143], v1, s[4:7], s39 offen offset:2048
s_waitcnt vmcnt(36)
s_barrier
s_add_u32 m0, s17, 12288
s_add_u32 s18, s16, 12288
buffer_load_dwordx4 v1, s[4:7], s18 offen offset:0 lds
buffer_load_dwordx4 v1, s[4:7], s18 offen offset:1024 lds
buffer_load_dwordx4 v1, s[4:7], s18 offen offset:2048 lds
buffer_load_dwordx4 v1, s[4:7], s18 offen offset:3072 lds
s_add_u32 m0, s17, 16384
s_add_u32 s18, s16, 16384
buffer_load_dwordx4 v1, s[4:7], s18 offen offset:0 lds
buffer_load_dwordx4 v1, s[4:7], s18 offen offset:1024 lds
buffer_load_dwordx4 v[144:147], v1, s[4:7], s30 offen offset:3072
buffer_load_dwordx4 v[148:151], v1, s[4:7], s31 offen offset:3072
buffer_load_dwordx4 v[152:155], v1, s[4:7], s32 offen offset:3072
buffer_load_dwordx4 v[156:159], v1, s[4:7], s33 offen offset:3072
buffer_load_dwordx4 v[160:163], v1, s[4:7], s34 offen offset:3072
buffer_load_dwordx4 v[164:167], v1, s[4:7], s35 offen offset:3072
buffer_load_dwordx4 v[168:171], v1, s[4:7], s36 offen offset:3072
buffer_load_dwordx4 v[172:175], v1, s[4:7], s37 offen offset:3072
buffer_load_dwordx4 v[176:179], v1, s[4:7], s38 offen offset:3072
buffer_load_dwordx4 v[180:183], v1, s[4:7], s39 offen offset:3072
s_add_u32 s30, s30, 4096
s_add_u32 s31, s31, 4096
s_add_u32 s32, s32, 4096
s_add_u32 s33, s33, 4096
s_add_u32 s34, s34, 4096
s_add_u32 s35, s35, 4096
s_add_u32 s36, s36, 4096
s_add_u32 s37, s37, 4096
s_add_u32 s38, s38, 4096
s_add_u32 s39, s39, 4096
ds_read_b128 v[184:187], v1 offset:0
ds_read_b128 v[188:191], v1 offset:24576
ds_read_b128 v[192:195], v6 offset:0
ds_read_b128 v[196:199], v6 offset:24576
s_waitcnt vmcnt(42)
s_waitcnt lgkmcnt(0)
v_mfma_f32_16x16x32_bf16 a[0:3], a[160:163], v[184:187], 0
v_mfma_f32_16x16x32_bf16 a[4:7], a[160:163], v[188:191], 0
v_mfma_f32_16x16x32_bf16 a[8:11], a[160:163], v[192:195], 0
v_mfma_f32_16x16x32_bf16 a[12:15], a[160:163], v[196:199], 0
ds_read_b128 v[200:203], v1 offset:1024
buffer_load_dwordx4 v[24:27], v1, s[4:7], s30 offen offset:0
v_mfma_f32_16x16x32_bf16 a[16:19], a[164:167], v[184:187], 0
v_mfma_f32_16x16x32_bf16 a[20:23], a[164:167], v[188:191], 0
v_mfma_f32_16x16x32_bf16 a[24:27], a[164:167], v[192:195], 0
v_mfma_f32_16x16x32_bf16 a[28:31], a[164:167], v[196:199], 0
ds_read_b128 v[204:207], v1 offset:25600
buffer_load_dwordx4 v[28:31], v1, s[4:7], s31 offen offset:0
v_mfma_f32_16x16x32_bf16 a[32:35], a[168:171], v[184:187], 0
v_mfma_f32_16x16x32_bf16 a[36:39], a[168:171], v[188:191], 0
v_mfma_f32_16x16x32_bf16 a[40:43], a[168:171], v[192:195], 0
v_mfma_f32_16x16x32_bf16 a[44:47], a[168:171], v[196:199], 0
ds_read_b128 v[208:211], v6 offset:1024
buffer_load_dwordx4 v[32:35], v1, s[4:7], s32 offen offset:0
v_mfma_f32_16x16x32_bf16 a[48:51], a[172:175], v[184:187], 0
v_mfma_f32_16x16x32_bf16 a[52:55], a[172:175], v[188:191], 0
v_mfma_f32_16x16x32_bf16 a[56:59], a[172:175], v[192:195], 0
v_mfma_f32_16x16x32_bf16 a[60:63], a[172:175], v[196:199], 0
ds_read_b128 v[212:215], v6 offset:25600
buffer_load_dwordx4 v[36:39], v1, s[4:7], s33 offen offset:0
v_mfma_f32_16x16x32_bf16 a[64:67], a[176:179], v[184:187], 0
v_mfma_f32_16x16x32_bf16 a[68:71], a[176:179], v[188:191], 0
v_mfma_f32_16x16x32_bf16 a[72:75], a[176:179], v[192:195], 0
v_mfma_f32_16x16x32_bf16 a[76:79], a[176:179], v[196:199], 0
buffer_load_dwordx4 v[40:43], v1, s[4:7], s34 offen offset:0
v_mfma_f32_16x16x32_bf16 a[80:83], a[180:183], v[184:187], 0
v_mfma_f32_16x16x32_bf16 a[84:87], a[180:183], v[188:191], 0
v_mfma_f32_16x16x32_bf16 a[88:91], a[180:183], v[192:195], 0
v_mfma_f32_16x16x32_bf16 a[92:95], a[180:183], v[196:199], 0
buffer_load_dwordx4 v[44:47], v1, s[4:7], s35 offen offset:0
v_mfma_f32_16x16x32_bf16 a[96:99], a[184:187], v[184:187], 0
v_mfma_f32_16x16x32_bf16 a[100:103], a[184:187], v[188:191], 0
v_mfma_f32_16x16x32_bf16 a[104:107], a[184:187], v[192:195], 0
v_mfma_f32_16x16x32_bf16 a[108:111], a[184:187], v[196:199], 0
buffer_load_dwordx4 v[48:51], v1, s[4:7], s36 offen offset:0
v_mfma_f32_16x16x32_bf16 a[112:115], a[188:191], v[184:187], 0
v_mfma_f32_16x16x32_bf16 a[116:119], a[188:191], v[188:191], 0
v_mfma_f32_16x16x32_bf16 a[120:123], a[188:191], v[192:195], 0
v_mfma_f32_16x16x32_bf16 a[124:127], a[188:191], v[196:199], 0
buffer_load_dwordx4 v[52:55], v1, s[4:7], s37 offen offset:0
v_mfma_f32_16x16x32_bf16 a[128:131], a[192:195], v[184:187], 0
v_mfma_f32_16x16x32_bf16 a[132:135], a[192:195], v[188:191], 0
v_mfma_f32_16x16x32_bf16 a[136:139], a[192:195], v[192:195], 0
v_mfma_f32_16x16x32_bf16 a[140:143], a[192:195], v[196:199], 0
buffer_load_dwordx4 v[56:59], v1, s[4:7], s38 offen offset:0
v_mfma_f32_16x16x32_bf16 a[144:147], a[196:199], v[184:187], 0
v_mfma_f32_16x16x32_bf16 a[148:151], a[196:199], v[188:191], 0
v_mfma_f32_16x16x32_bf16 a[152:155], a[196:199], v[192:195], 0
v_mfma_f32_16x16x32_bf16 a[156:159], a[196:199], v[196:199], 0
buffer_load_dwordx4 v[60:63], v1, s[4:7], s39 offen offset:0
s_add_u32 m0, s17, 18432
s_add_u32 s18, s16, 18432
buffer_load_dwordx4 v1, s[4:7], s18 offen offset:0 lds
buffer_load_dwordx4 v1, s[4:7], s18 offen offset:1024 lds
buffer_load_dwordx4 v1, s[4:7], s18 offen offset:2048 lds
buffer_load_dwordx4 v1, s[4:7], s18 offen offset:3072 lds
s_add_u32 m0, s17, 22528
s_add_u32 s18, s16, 22528
buffer_load_dwordx4 v1, s[4:7], s18 offen offset:0 lds
buffer_load_dwordx4 v1, s[4:7], s18 offen offset:1024 lds
s_waitcnt vmcnt(48)
s_waitcnt lgkmcnt(0)
v_mfma_f32_16x16x32_bf16 a[0:3], a[200:203], v[200:203], a[0:3]
v_mfma_f32_16x16x32_bf16 a[4:7], a[200:203], v[204:207], a[4:7]
v_mfma_f32_16x16x32_bf16 a[8:11], a[200:203], v[208:211], a[8:11]
v_mfma_f32_16x16x32_bf16 a[12:15], a[200:203], v[212:215], a[12:15]
ds_read_b128 v[184:187], v1 offset:2048
buffer_load_dwordx4 v[64:67], v1, s[4:7], s30 offen offset:1024
v_mfma_f32_16x16x32_bf16 a[16:19], a[204:207], v[200:203], a[16:19]
v_mfma_f32_16x16x32_bf16 a[20:23], a[204:207], v[204:207], a[20:23]
v_mfma_f32_16x16x32_bf16 a[24:27], a[204:207], v[208:211], a[24:27]
v_mfma_f32_16x16x32_bf16 a[28:31], a[204:207], v[212:215], a[28:31]
ds_read_b128 v[188:191], v1 offset:26624
buffer_load_dwordx4 v[68:71], v1, s[4:7], s31 offen offset:1024
v_mfma_f32_16x16x32_bf16 a[32:35], a[208:211], v[200:203], a[32:35]
v_mfma_f32_16x16x32_bf16 a[36:39], a[208:211], v[204:207], a[36:39]
v_mfma_f32_16x16x32_bf16 a[40:43], a[208:211], v[208:211], a[40:43]
v_mfma_f32_16x16x32_bf16 a[44:47], a[208:211], v[212:215], a[44:47]
ds_read_b128 v[192:195], v6 offset:2048
buffer_load_dwordx4 v[72:75], v1, s[4:7], s32 offen offset:1024
v_mfma_f32_16x16x32_bf16 a[48:51], a[212:215], v[200:203], a[48:51]
v_mfma_f32_16x16x32_bf16 a[52:55], a[212:215], v[204:207], a[52:55]
v_mfma_f32_16x16x32_bf16 a[56:59], a[212:215], v[208:211], a[56:59]
v_mfma_f32_16x16x32_bf16 a[60:63], a[212:215], v[212:215], a[60:63]
ds_read_b128 v[196:199], v6 offset:26624
buffer_load_dwordx4 v[76:79], v1, s[4:7], s33 offen offset:1024
v_mfma_f32_16x16x32_bf16 a[64:67], a[216:219], v[200:203], a[64:67]
v_mfma_f32_16x16x32_bf16 a[68:71], a[216:219], v[204:207], a[68:71]
v_mfma_f32_16x16x32_bf16 a[72:75], a[216:219], v[208:211], a[72:75]
v_mfma_f32_16x16x32_bf16 a[76:79], a[216:219], v[212:215], a[76:79]
buffer_load_dwordx4 v[80:83], v1, s[4:7], s34 offen offset:1024
v_mfma_f32_16x16x32_bf16 a[80:83], a[220:223], v[200:203], a[80:83]
v_mfma_f32_16x16x32_bf16 a[84:87], a[220:223], v[204:207], a[84:87]
v_mfma_f32_16x16x32_bf16 a[88:91], a[220:223], v[208:211], a[88:91]
v_mfma_f32_16x16x32_bf16 a[92:95], a[220:223], v[212:215], a[92:95]
buffer_load_dwordx4 v[84:87], v1, s[4:7], s35 offen offset:1024
v_mfma_f32_16x16x32_bf16 a[96:99], a[224:227], v[200:203], a[96:99]
v_mfma_f32_16x16x32_bf16 a[100:103], a[224:227], v[204:207], a[100:103]
v_mfma_f32_16x16x32_bf16 a[104:107], a[224:227], v[208:211], a[104:107]
v_mfma_f32_16x16x32_bf16 a[108:111], a[224:227], v[212:215], a[108:111]
buffer_load_dwordx4 v[88:91], v1, s[4:7], s36 offen offset:1024
v_mfma_f32_16x16x32_bf16 a[112:115], a[228:231], v[200:203], a[112:115]
v_mfma_f32_16x16x32_bf16 a[116:119], a[228:231], v[204:207], a[116:119]
v_mfma_f32_16x16x32_bf16 a[120:123], a[228:231], v[208:211], a[120:123]
v_mfma_f32_16x16x32_bf16 a[124:127], a[228:231], v[212:215], a[124:127]
buffer_load_dwordx4 v[92:95], v1, s[4:7], s37 offen offset:1024
v_mfma_f32_16x16x32_bf16 a[128:131], a[232:235], v[200:203], a[128:131]
v_mfma_f32_16x16x32_bf16 a[132:135], a[232:235], v[204:207], a[132:135]
v_mfma_f32_16x16x32_bf16 a[136:139], a[232:235], v[208:211], a[136:139]
v_mfma_f32_16x16x32_bf16 a[140:143], a[232:235], v[212:215], a[140:143]
buffer_load_dwordx4 v[96:99], v1, s[4:7], s38 offen offset:1024
v_mfma_f32_16x16x32_bf16 a[144:147], a[236:239], v[200:203], a[144:147]
v_mfma_f32_16x16x32_bf16 a[148:151], a[236:239], v[204:207], a[148:151]
v_mfma_f32_16x16x32_bf16 a[152:155], a[236:239], v[208:211], a[152:155]
v_mfma_f32_16x16x32_bf16 a[156:159], a[236:239], v[212:215], a[156:159]
buffer_load_dwordx4 v[100:103], v1, s[4:7], s39 offen offset:1024
s_waitcnt vmcnt(42)
s_waitcnt lgkmcnt(0)
v_mfma_f32_16x16x32_bf16 a[0:3], v[104:107], v[184:187], a[0:3]
v_mfma_f32_16x16x32_bf16 a[4:7], v[104:107], v[188:191], a[4:7]
v_mfma_f32_16x16x32_bf16 a[8:11], v[104:107], v[192:195], a[8:11]
v_mfma_f32_16x16x32_bf16 a[12:15], v[104:107], v[196:199], a[12:15]
ds_read_b128 v[200:203], v1 offset:3072
buffer_load_dwordx4 v[104:107], v1, s[4:7], s30 offen offset:2048
v_mfma_f32_16x16x32_bf16 a[16:19], v[108:111], v[184:187], a[16:19]
v_mfma_f32_16x16x32_bf16 a[20:23], v[108:111], v[188:191], a[20:23]
v_mfma_f32_16x16x32_bf16 a[24:27], v[108:111], v[192:195], a[24:27]
v_mfma_f32_16x16x32_bf16 a[28:31], v[108:111], v[196:199], a[28:31]
ds_read_b128 v[204:207], v1 offset:27648
buffer_load_dwordx4 v[108:111], v1, s[4:7], s31 offen offset:2048
v_mfma_f32_16x16x32_bf16 a[32:35], v[112:115], v[184:187], a[32:35]
v_mfma_f32_16x16x32_bf16 a[36:39], v[112:115], v[188:191], a[36:39]
v_mfma_f32_16x16x32_bf16 a[40:43], v[112:115], v[192:195], a[40:43]
v_mfma_f32_16x16x32_bf16 a[44:47], v[112:115], v[196:199], a[44:47]
ds_read_b128 v[208:211], v6 offset:3072
buffer_load_dwordx4 v[112:115], v1, s[4:7], s32 offen offset:2048
v_mfma_f32_16x16x32_bf16 a[48:51], v[116:119], v[184:187], a[48:51]
v_mfma_f32_16x16x32_bf16 a[52:55], v[116:119], v[188:191], a[52:55]
v_mfma_f32_16x16x32_bf16 a[56:59], v[116:119], v[192:195], a[56:59]
v_mfma_f32_16x16x32_bf16 a[60:63], v[116:119], v[196:199], a[60:63]
ds_read_b128 v[212:215], v6 offset:27648
buffer_load_dwordx4 v[116:119], v1, s[4:7], s33 offen offset:2048
v_mfma_f32_16x16x32_bf16 a[64:67], v[120:123], v[184:187], a[64:67]
v_mfma_f32_16x16x32_bf16 a[68:71], v[120:123], v[188:191], a[68:71]
v_mfma_f32_16x16x32_bf16 a[72:75], v[120:123], v[192:195], a[72:75]
v_mfma_f32_16x16x32_bf16 a[76:79], v[120:123], v[196:199], a[76:79]
buffer_load_dwordx4 v[120:123], v1, s[4:7], s34 offen offset:2048
v_mfma_f32_16x16x32_bf16 a[80:83], v[124:127], v[184:187], a[80:83]
v_mfma_f32_16x16x32_bf16 a[84:87], v[124:127], v[188:191], a[84:87]
v_mfma_f32_16x16x32_bf16 a[88:91], v[124:127], v[192:195], a[88:91]
v_mfma_f32_16x16x32_bf16 a[92:95], v[124:127], v[196:199], a[92:95]
buffer_load_dwordx4 v[124:127], v1, s[4:7], s35 offen offset:2048
v_mfma_f32_16x16x32_bf16 a[96:99], v[128:131], v[184:187], a[96:99]
v_mfma_f32_16x16x32_bf16 a[100:103], v[128:131], v[188:191], a[100:103]
v_mfma_f32_16x16x32_bf16 a[104:107], v[128:131], v[192:195], a[104:107]
v_mfma_f32_16x16x32_bf16 a[108:111], v[128:131], v[196:199], a[108:111]
buffer_load_dwordx4 v[128:131], v1, s[4:7], s36 offen offset:2048
v_mfma_f32_16x16x32_bf16 a[112:115], v[132:135], v[184:187], a[112:115]
v_mfma_f32_16x16x32_bf16 a[116:119], v[132:135], v[188:191], a[116:119]
v_mfma_f32_16x16x32_bf16 a[120:123], v[132:135], v[192:195], a[120:123]
v_mfma_f32_16x16x32_bf16 a[124:127], v[132:135], v[196:199], a[124:127]
buffer_load_dwordx4 v[132:135], v1, s[4:7], s37 offen offset:2048
v_mfma_f32_16x16x32_bf16 a[128:131], v[136:139], v[184:187], a[128:131]
v_mfma_f32_16x16x32_bf16 a[132:135], v[136:139], v[188:191], a[132:135]
v_mfma_f32_16x16x32_bf16 a[136:139], v[136:139], v[192:195], a[136:139]
v_mfma_f32_16x16x32_bf16 a[140:143], v[136:139], v[196:199], a[140:143]
buffer_load_dwordx4 v[136:139], v1, s[4:7], s38 offen offset:2048
v_mfma_f32_16x16x32_bf16 a[144:147], v[140:143], v[184:187], a[144:147]
v_mfma_f32_16x16x32_bf16 a[148:151], v[140:143], v[188:191], a[148:151]
v_mfma_f32_16x16x32_bf16 a[152:155], v[140:143], v[192:195], a[152:155]
v_mfma_f32_16x16x32_bf16 a[156:159], v[140:143], v[196:199], a[156:159]
buffer_load_dwordx4 v[140:143], v1, s[4:7], s39 offen offset:2048
s_waitcnt vmcnt(36)
s_waitcnt lgkmcnt(0)
v_mfma_f32_16x16x32_bf16 a[0:3], v[144:147], v[200:203], a[0:3]
v_mfma_f32_16x16x32_bf16 a[4:7], v[144:147], v[204:207], a[4:7]
v_mfma_f32_16x16x32_bf16 a[8:11], v[144:147], v[208:211], a[8:11]
v_mfma_f32_16x16x32_bf16 a[12:15], v[144:147], v[212:215], a[12:15]
ds_read_b128 v[184:187], v1 offset:4096
buffer_load_dwordx4 v[144:147], v1, s[4:7], s30 offen offset:3072
s_add_u32 s30, s30, 4096
v_mfma_f32_16x16x32_bf16 a[16:19], v[148:151], v[200:203], a[16:19]
v_mfma_f32_16x16x32_bf16 a[20:23], v[148:151], v[204:207], a[20:23]
v_mfma_f32_16x16x32_bf16 a[24:27], v[148:151], v[208:211], a[24:27]
v_mfma_f32_16x16x32_bf16 a[28:31], v[148:151], v[212:215], a[28:31]
ds_read_b128 v[188:191], v1 offset:28672
buffer_load_dwordx4 v[148:151], v1, s[4:7], s31 offen offset:3072
s_add_u32 s31, s31, 4096
v_mfma_f32_16x16x32_bf16 a[32:35], v[152:155], v[200:203], a[32:35]
v_mfma_f32_16x16x32_bf16 a[36:39], v[152:155], v[204:207], a[36:39]
v_mfma_f32_16x16x32_bf16 a[40:43], v[152:155], v[208:211], a[40:43]
v_mfma_f32_16x16x32_bf16 a[44:47], v[152:155], v[212:215], a[44:47]
ds_read_b128 v[192:195], v6 offset:4096
buffer_load_dwordx4 v[152:155], v1, s[4:7], s32 offen offset:3072
s_add_u32 s32, s32, 4096
v_mfma_f32_16x16x32_bf16 a[48:51], v[156:159], v[200:203], a[48:51]
v_mfma_f32_16x16x32_bf16 a[52:55], v[156:159], v[204:207], a[52:55]
v_mfma_f32_16x16x32_bf16 a[56:59], v[156:159], v[208:211], a[56:59]
v_mfma_f32_16x16x32_bf16 a[60:63], v[156:159], v[212:215], a[60:63]
ds_read_b128 v[196:199], v6 offset:28672
buffer_load_dwordx4 v[156:159], v1, s[4:7], s33 offen offset:3072
s_add_u32 s33, s33, 4096
v_mfma_f32_16x16x32_bf16 a[64:67], v[160:163], v[200:203], a[64:67]
v_mfma_f32_16x16x32_bf16 a[68:71], v[160:163], v[204:207], a[68:71]
v_mfma_f32_16x16x32_bf16 a[72:75], v[160:163], v[208:211], a[72:75]
v_mfma_f32_16x16x32_bf16 a[76:79], v[160:163], v[212:215], a[76:79]
buffer_load_dwordx4 v[160:163], v1, s[4:7], s34 offen offset:3072
s_add_u32 s34, s34, 4096
v_mfma_f32_16x16x32_bf16 a[80:83], v[164:167], v[200:203], a[80:83]
v_mfma_f32_16x16x32_bf16 a[84:87], v[164:167], v[204:207], a[84:87]
v_mfma_f32_16x16x32_bf16 a[88:91], v[164:167], v[208:211], a[88:91]
v_mfma_f32_16x16x32_bf16 a[92:95], v[164:167], v[212:215], a[92:95]
buffer_load_dwordx4 v[164:167], v1, s[4:7], s35 offen offset:3072
s_add_u32 s35, s35, 4096
v_mfma_f32_16x16x32_bf16 a[96:99], v[168:171], v[200:203], a[96:99]
v_mfma_f32_16x16x32_bf16 a[100:103], v[168:171], v[204:207], a[100:103]
v_mfma_f32_16x16x32_bf16 a[104:107], v[168:171], v[208:211], a[104:107]
v_mfma_f32_16x16x32_bf16 a[108:111], v[168:171], v[212:215], a[108:111]
buffer_load_dwordx4 v[168:171], v1, s[4:7], s36 offen offset:3072
s_add_u32 s36, s36, 4096
v_mfma_f32_16x16x32_bf16 a[112:115], v[172:175], v[200:203], a[112:115]
v_mfma_f32_16x16x32_bf16 a[116:119], v[172:175], v[204:207], a[116:119]
v_mfma_f32_16x16x32_bf16 a[120:123], v[172:175], v[208:211], a[120:123]
v_mfma_f32_16x16x32_bf16 a[124:127], v[172:175], v[212:215], a[124:127]
buffer_load_dwordx4 v[172:175], v1, s[4:7], s37 offen offset:3072
s_add_u32 s37, s37, 4096
v_mfma_f32_16x16x32_bf16 a[128:131], v[176:179], v[200:203], a[128:131]
v_mfma_f32_16x16x32_bf16 a[132:135], v[176:179], v[204:207], a[132:135]
v_mfma_f32_16x16x32_bf16 a[136:139], v[176:179], v[208:211], a[136:139]
v_mfma_f32_16x16x32_bf16 a[140:143], v[176:179], v[212:215], a[140:143]
buffer_load_dwordx4 v[176:179], v1, s[4:7], s38 offen offset:3072
s_add_u32 s38, s38, 4096
v_mfma_f32_16x16x32_bf16 a[144:147], v[180:183], v[200:203], a[144:147]
v_mfma_f32_16x16x32_bf16 a[148:151], v[180:183], v[204:207], a[148:151]
v_mfma_f32_16x16x32_bf16 a[152:155], v[180:183], v[208:211], a[152:155]
v_mfma_f32_16x16x32_bf16 a[156:159], v[180:183], v[212:215], a[156:159]
buffer_load_dwordx4 v[180:183], v1, s[4:7], s39 offen offset:3072
s_add_u32 s39, s39, 4096
s_waitcnt vmcnt(36)
s_waitcnt lgkmcnt(0)
v_mfma_f32_16x16x32_bf16 a[0:3], v[24:27], v[184:187], a[0:3]
v_mfma_f32_16x16x32_bf16 a[4:7], v[24:27], v[188:191], a[4:7]
v_mfma_f32_16x16x32_bf16 a[8:11], v[24:27], v[192:195], a[8:11]
v_mfma_f32_16x16x32_bf16 a[12:15], v[24:27], v[196:199], a[12:15]
ds_read_b128 v[200:203], v1 offset:5120
buffer_load_dwordx4 v[24:27], v1, s[4:7], s30 offen offset:0
v_mfma_f32_16x16x32_bf16 a[16:19], v[28:31], v[184:187], a[16:19]
v_mfma_f32_16x16x32_bf16 a[20:23], v[28:31], v[188:191], a[20:23]
v_mfma_f32_16x16x32_bf16 a[24:27], v[28:31], v[192:195], a[24:27]
v_mfma_f32_16x16x32_bf16 a[28:31], v[28:31], v[196:199], a[28:31]
ds_read_b128 v[204:207], v1 offset:29696
buffer_load_dwordx4 v[28:31], v1, s[4:7], s31 offen offset:0
v_mfma_f32_16x16x32_bf16 a[32:35], v[32:35], v[184:187], a[32:35]
v_mfma_f32_16x16x32_bf16 a[36:39], v[32:35], v[188:191], a[36:39]
v_mfma_f32_16x16x32_bf16 a[40:43], v[32:35], v[192:195], a[40:43]
v_mfma_f32_16x16x32_bf16 a[44:47], v[32:35], v[196:199], a[44:47]
ds_read_b128 v[208:211], v6 offset:5120
buffer_load_dwordx4 v[32:35], v1, s[4:7], s32 offen offset:0
v_mfma_f32_16x16x32_bf16 a[48:51], v[36:39], v[184:187], a[48:51]
v_mfma_f32_16x16x32_bf16 a[52:55], v[36:39], v[188:191], a[52:55]
v_mfma_f32_16x16x32_bf16 a[56:59], v[36:39], v[192:195], a[56:59]
v_mfma_f32_16x16x32_bf16 a[60:63], v[36:39], v[196:199], a[60:63]
ds_read_b128 v[212:215], v6 offset:29696
buffer_load_dwordx4 v[36:39], v1, s[4:7], s33 offen offset:0
v_mfma_f32_16x16x32_bf16 a[64:67], v[40:43], v[184:187], a[64:67]
v_mfma_f32_16x16x32_bf16 a[68:71], v[40:43], v[188:191], a[68:71]
v_mfma_f32_16x16x32_bf16 a[72:75], v[40:43], v[192:195], a[72:75]
v_mfma_f32_16x16x32_bf16 a[76:79], v[40:43], v[196:199], a[76:79]
buffer_load_dwordx4 v[40:43], v1, s[4:7], s34 offen offset:0
v_mfma_f32_16x16x32_bf16 a[80:83], v[44:47], v[184:187], a[80:83]
v_mfma_f32_16x16x32_bf16 a[84:87], v[44:47], v[188:191], a[84:87]
v_mfma_f32_16x16x32_bf16 a[88:91], v[44:47], v[192:195], a[88:91]
v_mfma_f32_16x16x32_bf16 a[92:95], v[44:47], v[196:199], a[92:95]
buffer_load_dwordx4 v[44:47], v1, s[4:7], s35 offen offset:0
v_mfma_f32_16x16x32_bf16 a[96:99], v[48:51], v[184:187], a[96:99]
v_mfma_f32_16x16x32_bf16 a[100:103], v[48:51], v[188:191], a[100:103]
v_mfma_f32_16x16x32_bf16 a[104:107], v[48:51], v[192:195], a[104:107]
v_mfma_f32_16x16x32_bf16 a[108:111], v[48:51], v[196:199], a[108:111]
buffer_load_dwordx4 v[48:51], v1, s[4:7], s36 offen offset:0
v_mfma_f32_16x16x32_bf16 a[112:115], v[52:55], v[184:187], a[112:115]
v_mfma_f32_16x16x32_bf16 a[116:119], v[52:55], v[188:191], a[116:119]
v_mfma_f32_16x16x32_bf16 a[120:123], v[52:55], v[192:195], a[120:123]
v_mfma_f32_16x16x32_bf16 a[124:127], v[52:55], v[196:199], a[124:127]
buffer_load_dwordx4 v[52:55], v1, s[4:7], s37 offen offset:0
v_mfma_f32_16x16x32_bf16 a[128:131], v[56:59], v[184:187], a[128:131]
v_mfma_f32_16x16x32_bf16 a[132:135], v[56:59], v[188:191], a[132:135]
v_mfma_f32_16x16x32_bf16 a[136:139], v[56:59], v[192:195], a[136:139]
v_mfma_f32_16x16x32_bf16 a[140:143], v[56:59], v[196:199], a[140:143]
buffer_load_dwordx4 v[56:59], v1, s[4:7], s38 offen offset:0
v_mfma_f32_16x16x32_bf16 a[144:147], v[60:63], v[184:187], a[144:147]
v_mfma_f32_16x16x32_bf16 a[148:151], v[60:63], v[188:191], a[148:151]
v_mfma_f32_16x16x32_bf16 a[152:155], v[60:63], v[192:195], a[152:155]
v_mfma_f32_16x16x32_bf16 a[156:159], v[60:63], v[196:199], a[156:159]
buffer_load_dwordx4 v[60:63], v1, s[4:7], s39 offen offset:0
s_barrier
s_waitcnt vmcnt(30)
s_waitcnt lgkmcnt(0)
v_mfma_f32_16x16x32_bf16 a[0:3], v[64:67], v[200:203], a[0:3]
v_mfma_f32_16x16x32_bf16 a[4:7], v[64:67], v[204:207], a[4:7]
v_mfma_f32_16x16x32_bf16 a[8:11], v[64:67], v[208:211], a[8:11]
v_mfma_f32_16x16x32_bf16 a[12:15], v[64:67], v[212:215], a[12:15]
ds_read_b128 v[184:187], v1 offset:6144
buffer_load_dwordx4 v[64:67], v1, s[4:7], s30 offen offset:1024
v_mfma_f32_16x16x32_bf16 a[16:19], v[68:71], v[200:203], a[16:19]
v_mfma_f32_16x16x32_bf16 a[20:23], v[68:71], v[204:207], a[20:23]
v_mfma_f32_16x16x32_bf16 a[24:27], v[68:71], v[208:211], a[24:27]
v_mfma_f32_16x16x32_bf16 a[28:31], v[68:71], v[212:215], a[28:31]
ds_read_b128 v[188:191], v1 offset:30720
buffer_load_dwordx4 v[68:71], v1, s[4:7], s31 offen offset:1024
v_mfma_f32_16x16x32_bf16 a[32:35], v[72:75], v[200:203], a[32:35]
v_mfma_f32_16x16x32_bf16 a[36:39], v[72:75], v[204:207], a[36:39]
v_mfma_f32_16x16x32_bf16 a[40:43], v[72:75], v[208:211], a[40:43]
v_mfma_f32_16x16x32_bf16 a[44:47], v[72:75], v[212:215], a[44:47]
ds_read_b128 v[192:195], v6 offset:6144
buffer_load_dwordx4 v[72:75], v1, s[4:7], s32 offen offset:1024
v_mfma_f32_16x16x32_bf16 a[48:51], v[76:79], v[200:203], a[48:51]
v_mfma_f32_16x16x32_bf16 a[52:55], v[76:79], v[204:207], a[52:55]
v_mfma_f32_16x16x32_bf16 a[56:59], v[76:79], v[208:211], a[56:59]
v_mfma_f32_16x16x32_bf16 a[60:63], v[76:79], v[212:215], a[60:63]
ds_read_b128 v[196:199], v6 offset:30720
buffer_load_dwordx4 v[76:79], v1, s[4:7], s33 offen offset:1024
v_mfma_f32_16x16x32_bf16 a[64:67], v[80:83], v[200:203], a[64:67]
v_mfma_f32_16x16x32_bf16 a[68:71], v[80:83], v[204:207], a[68:71]
v_mfma_f32_16x16x32_bf16 a[72:75], v[80:83], v[208:211], a[72:75]
v_mfma_f32_16x16x32_bf16 a[76:79], v[80:83], v[212:215], a[76:79]
buffer_load_dwordx4 v[80:83], v1, s[4:7], s34 offen offset:1024
v_mfma_f32_16x16x32_bf16 a[80:83], v[84:87], v[200:203], a[80:83]
v_mfma_f32_16x16x32_bf16 a[84:87], v[84:87], v[204:207], a[84:87]
v_mfma_f32_16x16x32_bf16 a[88:91], v[84:87], v[208:211], a[88:91]
v_mfma_f32_16x16x32_bf16 a[92:95], v[84:87], v[212:215], a[92:95]
buffer_load_dwordx4 v[84:87], v1, s[4:7], s35 offen offset:1024
v_mfma_f32_16x16x32_bf16 a[96:99], v[88:91], v[200:203], a[96:99]
v_mfma_f32_16x16x32_bf16 a[100:103], v[88:91], v[204:207], a[100:103]
v_mfma_f32_16x16x32_bf16 a[104:107], v[88:91], v[208:211], a[104:107]
v_mfma_f32_16x16x32_bf16 a[108:111], v[88:91], v[212:215], a[108:111]
buffer_load_dwordx4 v[88:91], v1, s[4:7], s36 offen offset:1024
v_mfma_f32_16x16x32_bf16 a[112:115], v[92:95], v[200:203], a[112:115]
v_mfma_f32_16x16x32_bf16 a[116:119], v[92:95], v[204:207], a[116:119]
v_mfma_f32_16x16x32_bf16 a[120:123], v[92:95], v[208:211], a[120:123]
v_mfma_f32_16x16x32_bf16 a[124:127], v[92:95], v[212:215], a[124:127]
buffer_load_dwordx4 v[92:95], v1, s[4:7], s37 offen offset:1024
v_mfma_f32_16x16x32_bf16 a[128:131], v[96:99], v[200:203], a[128:131]
v_mfma_f32_16x16x32_bf16 a[132:135], v[96:99], v[204:207], a[132:135]
v_mfma_f32_16x16x32_bf16 a[136:139], v[96:99], v[208:211], a[136:139]
v_mfma_f32_16x16x32_bf16 a[140:143], v[96:99], v[212:215], a[140:143]
buffer_load_dwordx4 v[96:99], v1, s[4:7], s38 offen offset:1024
v_mfma_f32_16x16x32_bf16 a[144:147], v[100:103], v[200:203], a[144:147]
v_mfma_f32_16x16x32_bf16 a[148:151], v[100:103], v[204:207], a[148:151]
v_mfma_f32_16x16x32_bf16 a[152:155], v[100:103], v[208:211], a[152:155]
v_mfma_f32_16x16x32_bf16 a[156:159], v[100:103], v[212:215], a[156:159]
buffer_load_dwordx4 v[100:103], v1, s[4:7], s39 offen offset:1024
s_waitcnt vmcnt(30)
s_waitcnt lgkmcnt(0)
v_mfma_f32_16x16x32_bf16 a[0:3], v[104:107], v[184:187], a[0:3]
v_mfma_f32_16x16x32_bf16 a[4:7], v[104:107], v[188:191], a[4:7]
v_mfma_f32_16x16x32_bf16 a[8:11], v[104:107], v[192:195], a[8:11]
v_mfma_f32_16x16x32_bf16 a[12:15], v[104:107], v[196:199], a[12:15]
ds_read_b128 v[200:203], v1 offset:7168
buffer_load_dwordx4 v[104:107], v1, s[4:7], s30 offen offset:2048
v_mfma_f32_16x16x32_bf16 a[16:19], v[108:111], v[184:187], a[16:19]
v_mfma_f32_16x16x32_bf16 a[20:23], v[108:111], v[188:191], a[20:23]
v_mfma_f32_16x16x32_bf16 a[24:27], v[108:111], v[192:195], a[24:27]
v_mfma_f32_16x16x32_bf16 a[28:31], v[108:111], v[196:199], a[28:31]
ds_read_b128 v[204:207], v1 offset:31744
buffer_load_dwordx4 v[108:111], v1, s[4:7], s31 offen offset:2048
v_mfma_f32_16x16x32_bf16 a[32:35], v[112:115], v[184:187], a[32:35]
v_mfma_f32_16x16x32_bf16 a[36:39], v[112:115], v[188:191], a[36:39]
v_mfma_f32_16x16x32_bf16 a[40:43], v[112:115], v[192:195], a[40:43]
v_mfma_f32_16x16x32_bf16 a[44:47], v[112:115], v[196:199], a[44:47]
ds_read_b128 v[208:211], v6 offset:7168
buffer_load_dwordx4 v[112:115], v1, s[4:7], s32 offen offset:2048
v_mfma_f32_16x16x32_bf16 a[48:51], v[116:119], v[184:187], a[48:51]
v_mfma_f32_16x16x32_bf16 a[52:55], v[116:119], v[188:191], a[52:55]
v_mfma_f32_16x16x32_bf16 a[56:59], v[116:119], v[192:195], a[56:59]
v_mfma_f32_16x16x32_bf16 a[60:63], v[116:119], v[196:199], a[60:63]
ds_read_b128 v[212:215], v6 offset:31744
buffer_load_dwordx4 v[116:119], v1, s[4:7], s33 offen offset:2048
v_mfma_f32_16x16x32_bf16 a[64:67], v[120:123], v[184:187], a[64:67]
v_mfma_f32_16x16x32_bf16 a[68:71], v[120:123], v[188:191], a[68:71]
v_mfma_f32_16x16x32_bf16 a[72:75], v[120:123], v[192:195], a[72:75]
v_mfma_f32_16x16x32_bf16 a[76:79], v[120:123], v[196:199], a[76:79]
buffer_load_dwordx4 v[120:123], v1, s[4:7], s34 offen offset:2048
v_mfma_f32_16x16x32_bf16 a[80:83], v[124:127], v[184:187], a[80:83]
v_mfma_f32_16x16x32_bf16 a[84:87], v[124:127], v[188:191], a[84:87]
v_mfma_f32_16x16x32_bf16 a[88:91], v[124:127], v[192:195], a[88:91]
v_mfma_f32_16x16x32_bf16 a[92:95], v[124:127], v[196:199], a[92:95]
buffer_load_dwordx4 v[124:127], v1, s[4:7], s35 offen offset:2048
v_mfma_f32_16x16x32_bf16 a[96:99], v[128:131], v[184:187], a[96:99]
v_mfma_f32_16x16x32_bf16 a[100:103], v[128:131], v[188:191], a[100:103]
v_mfma_f32_16x16x32_bf16 a[104:107], v[128:131], v[192:195], a[104:107]
v_mfma_f32_16x16x32_bf16 a[108:111], v[128:131], v[196:199], a[108:111]
buffer_load_dwordx4 v[128:131], v1, s[4:7], s36 offen offset:2048
v_mfma_f32_16x16x32_bf16 a[112:115], v[132:135], v[184:187], a[112:115]
v_mfma_f32_16x16x32_bf16 a[116:119], v[132:135], v[188:191], a[116:119]
v_mfma_f32_16x16x32_bf16 a[120:123], v[132:135], v[192:195], a[120:123]
v_mfma_f32_16x16x32_bf16 a[124:127], v[132:135], v[196:199], a[124:127]
buffer_load_dwordx4 v[132:135], v1, s[4:7], s37 offen offset:2048
v_mfma_f32_16x16x32_bf16 a[128:131], v[136:139], v[184:187], a[128:131]
v_mfma_f32_16x16x32_bf16 a[132:135], v[136:139], v[188:191], a[132:135]
v_mfma_f32_16x16x32_bf16 a[136:139], v[136:139], v[192:195], a[136:139]
v_mfma_f32_16x16x32_bf16 a[140:143], v[136:139], v[196:199], a[140:143]
buffer_load_dwordx4 v[136:139], v1, s[4:7], s38 offen offset:2048
v_mfma_f32_16x16x32_bf16 a[144:147], v[140:143], v[184:187], a[144:147]
v_mfma_f32_16x16x32_bf16 a[148:151], v[140:143], v[188:191], a[148:151]
v_mfma_f32_16x16x32_bf16 a[152:155], v[140:143], v[192:195], a[152:155]
v_mfma_f32_16x16x32_bf16 a[156:159], v[140:143], v[196:199], a[156:159]
buffer_load_dwordx4 v[140:143], v1, s[4:7], s39 offen offset:2048
s_waitcnt vmcnt(30)
s_waitcnt lgkmcnt(0)
v_mfma_f32_16x16x32_bf16 a[0:3], v[144:147], v[200:203], a[0:3]
v_mfma_f32_16x16x32_bf16 a[4:7], v[144:147], v[204:207], a[4:7]
v_mfma_f32_16x16x32_bf16 a[8:11], v[144:147], v[208:211], a[8:11]
v_mfma_f32_16x16x32_bf16 a[12:15], v[144:147], v[212:215], a[12:15]
ds_read_b128 v[184:187], v1 offset:8192
buffer_load_dwordx4 v[144:147], v1, s[4:7], s30 offen offset:3072
s_add_u32 s30, s30, 4096
v_mfma_f32_16x16x32_bf16 a[16:19], v[148:151], v[200:203], a[16:19]
v_mfma_f32_16x16x32_bf16 a[20:23], v[148:151], v[204:207], a[20:23]
v_mfma_f32_16x16x32_bf16 a[24:27], v[148:151], v[208:211], a[24:27]
v_mfma_f32_16x16x32_bf16 a[28:31], v[148:151], v[212:215], a[28:31]
ds_read_b128 v[188:191], v1 offset:32768
buffer_load_dwordx4 v[148:151], v1, s[4:7], s31 offen offset:3072
s_add_u32 s31, s31, 4096
v_mfma_f32_16x16x32_bf16 a[32:35], v[152:155], v[200:203], a[32:35]
v_mfma_f32_16x16x32_bf16 a[36:39], v[152:155], v[204:207], a[36:39]
v_mfma_f32_16x16x32_bf16 a[40:43], v[152:155], v[208:211], a[40:43]
v_mfma_f32_16x16x32_bf16 a[44:47], v[152:155], v[212:215], a[44:47]
ds_read_b128 v[192:195], v6 offset:8192
buffer_load_dwordx4 v[152:155], v1, s[4:7], s32 offen offset:3072
s_add_u32 s32, s32, 4096
v_mfma_f32_16x16x32_bf16 a[48:51], v[156:159], v[200:203], a[48:51]
v_mfma_f32_16x16x32_bf16 a[52:55], v[156:159], v[204:207], a[52:55]
v_mfma_f32_16x16x32_bf16 a[56:59], v[156:159], v[208:211], a[56:59]
v_mfma_f32_16x16x32_bf16 a[60:63], v[156:159], v[212:215], a[60:63]
ds_read_b128 v[196:199], v6 offset:32768
buffer_load_dwordx4 v[156:159], v1, s[4:7], s33 offen offset:3072
s_add_u32 s33, s33, 4096
v_mfma_f32_16x16x32_bf16 a[64:67], v[160:163], v[200:203], a[64:67]
v_mfma_f32_16x16x32_bf16 a[68:71], v[160:163], v[204:207], a[68:71]
v_mfma_f32_16x16x32_bf16 a[72:75], v[160:163], v[208:211], a[72:75]
v_mfma_f32_16x16x32_bf16 a[76:79], v[160:163], v[212:215], a[76:79]
buffer_load_dwordx4 v[160:163], v1, s[4:7], s34 offen offset:3072
s_add_u32 s34, s34, 4096
v_mfma_f32_16x16x32_bf16 a[80:83], v[164:167], v[200:203], a[80:83]
v_mfma_f32_16x16x32_bf16 a[84:87], v[164:167], v[204:207], a[84:87]
v_mfma_f32_16x16x32_bf16 a[88:91], v[164:167], v[208:211], a[88:91]
v_mfma_f32_16x16x32_bf16 a[92:95], v[164:167], v[212:215], a[92:95]
buffer_load_dwordx4 v[164:167], v1, s[4:7], s35 offen offset:3072
s_add_u32 s35, s35, 4096
v_mfma_f32_16x16x32_bf16 a[96:99], v[168:171], v[200:203], a[96:99]
v_mfma_f32_16x16x32_bf16 a[100:103], v[168:171], v[204:207], a[100:103]
v_mfma_f32_16x16x32_bf16 a[104:107], v[168:171], v[208:211], a[104:107]
v_mfma_f32_16x16x32_bf16 a[108:111], v[168:171], v[212:215], a[108:111]
buffer_load_dwordx4 v[168:171], v1, s[4:7], s36 offen offset:3072
s_add_u32 s36, s36, 4096
v_mfma_f32_16x16x32_bf16 a[112:115], v[172:175], v[200:203], a[112:115]
v_mfma_f32_16x16x32_bf16 a[116:119], v[172:175], v[204:207], a[116:119]
v_mfma_f32_16x16x32_bf16 a[120:123], v[172:175], v[208:211], a[120:123]
v_mfma_f32_16x16x32_bf16 a[124:127], v[172:175], v[212:215], a[124:127]
buffer_load_dwordx4 v[172:175], v1, s[4:7], s37 offen offset:3072
s_add_u32 s37, s37, 4096
v_mfma_f32_16x16x32_bf16 a[128:131], v[176:179], v[200:203], a[128:131]
v_mfma_f32_16x16x32_bf16 a[132:135], v[176:179], v[204:207], a[132:135]
v_mfma_f32_16x16x32_bf16 a[136:139], v[176:179], v[208:211], a[136:139]
v_mfma_f32_16x16x32_bf16 a[140:143], v[176:179], v[212:215], a[140:143]
buffer_load_dwordx4 v[176:179], v1, s[4:7], s38 offen offset:3072
s_add_u32 s38, s38, 4096
v_mfma_f32_16x16x32_bf16 a[144:147], v[180:183], v[200:203], a[144:147]
v_mfma_f32_16x16x32_bf16 a[148:151], v[180:183], v[204:207], a[148:151]
v_mfma_f32_16x16x32_bf16 a[152:155], v[180:183], v[208:211], a[152:155]
v_mfma_f32_16x16x32_bf16 a[156:159], v[180:183], v[212:215], a[156:159]
buffer_load_dwordx4 v[180:183], v1, s[4:7], s39 offen offset:3072
s_add_u32 s39, s39, 4096
s_waitcnt vmcnt(30)
s_waitcnt lgkmcnt(0)
v_mfma_f32_16x16x32_bf16 a[0:3], v[24:27], v[184:187], a[0:3]
v_mfma_f32_16x16x32_bf16 a[4:7], v[24:27], v[188:191], a[4:7]
v_mfma_f32_16x16x32_bf16 a[8:11], v[24:27], v[192:195], a[8:11]
v_mfma_f32_16x16x32_bf16 a[12:15], v[24:27], v[196:199], a[12:15]
ds_read_b128 v[200:203], v1 offset:9216
buffer_load_dwordx4 v[24:27], v1, s[4:7], s30 offen offset:0
v_mfma_f32_16x16x32_bf16 a[16:19], v[28:31], v[184:187], a[16:19]
v_mfma_f32_16x16x32_bf16 a[20:23], v[28:31], v[188:191], a[20:23]
v_mfma_f32_16x16x32_bf16 a[24:27], v[28:31], v[192:195], a[24:27]
v_mfma_f32_16x16x32_bf16 a[28:31], v[28:31], v[196:199], a[28:31]
ds_read_b128 v[204:207], v1 offset:33792
buffer_load_dwordx4 v[28:31], v1, s[4:7], s31 offen offset:0
v_mfma_f32_16x16x32_bf16 a[32:35], v[32:35], v[184:187], a[32:35]
v_mfma_f32_16x16x32_bf16 a[36:39], v[32:35], v[188:191], a[36:39]
v_mfma_f32_16x16x32_bf16 a[40:43], v[32:35], v[192:195], a[40:43]
v_mfma_f32_16x16x32_bf16 a[44:47], v[32:35], v[196:199], a[44:47]
ds_read_b128 v[208:211], v6 offset:9216
buffer_load_dwordx4 v[32:35], v1, s[4:7], s32 offen offset:0
v_mfma_f32_16x16x32_bf16 a[48:51], v[36:39], v[184:187], a[48:51]
v_mfma_f32_16x16x32_bf16 a[52:55], v[36:39], v[188:191], a[52:55]
v_mfma_f32_16x16x32_bf16 a[56:59], v[36:39], v[192:195], a[56:59]
v_mfma_f32_16x16x32_bf16 a[60:63], v[36:39], v[196:199], a[60:63]
ds_read_b128 v[212:215], v6 offset:33792
buffer_load_dwordx4 v[36:39], v1, s[4:7], s33 offen offset:0
v_mfma_f32_16x16x32_bf16 a[64:67], v[40:43], v[184:187], a[64:67]
v_mfma_f32_16x16x32_bf16 a[68:71], v[40:43], v[188:191], a[68:71]
v_mfma_f32_16x16x32_bf16 a[72:75], v[40:43], v[192:195], a[72:75]
v_mfma_f32_16x16x32_bf16 a[76:79], v[40:43], v[196:199], a[76:79]
buffer_load_dwordx4 v[40:43], v1, s[4:7], s34 offen offset:0
v_mfma_f32_16x16x32_bf16 a[80:83], v[44:47], v[184:187], a[80:83]
v_mfma_f32_16x16x32_bf16 a[84:87], v[44:47], v[188:191], a[84:87]
v_mfma_f32_16x16x32_bf16 a[88:91], v[44:47], v[192:195], a[88:91]
v_mfma_f32_16x16x32_bf16 a[92:95], v[44:47], v[196:199], a[92:95]
buffer_load_dwordx4 v[44:47], v1, s[4:7], s35 offen offset:0
v_mfma_f32_16x16x32_bf16 a[96:99], v[48:51], v[184:187], a[96:99]
v_mfma_f32_16x16x32_bf16 a[100:103], v[48:51], v[188:191], a[100:103]
v_mfma_f32_16x16x32_bf16 a[104:107], v[48:51], v[192:195], a[104:107]
v_mfma_f32_16x16x32_bf16 a[108:111], v[48:51], v[196:199], a[108:111]
buffer_load_dwordx4 v[48:51], v1, s[4:7], s36 offen offset:0
v_mfma_f32_16x16x32_bf16 a[112:115], v[52:55], v[184:187], a[112:115]
v_mfma_f32_16x16x32_bf16 a[116:119], v[52:55], v[188:191], a[116:119]
v_mfma_f32_16x16x32_bf16 a[120:123], v[52:55], v[192:195], a[120:123]
v_mfma_f32_16x16x32_bf16 a[124:127], v[52:55], v[196:199], a[124:127]
buffer_load_dwordx4 v[52:55], v1, s[4:7], s37 offen offset:0
v_mfma_f32_16x16x32_bf16 a[128:131], v[56:59], v[184:187], a[128:131]
v_mfma_f32_16x16x32_bf16 a[132:135], v[56:59], v[188:191], a[132:135]
v_mfma_f32_16x16x32_bf16 a[136:139], v[56:59], v[192:195], a[136:139]
v_mfma_f32_16x16x32_bf16 a[140:143], v[56:59], v[196:199], a[140:143]
buffer_load_dwordx4 v[56:59], v1, s[4:7], s38 offen offset:0
v_mfma_f32_16x16x32_bf16 a[144:147], v[60:63], v[184:187], a[144:147]
v_mfma_f32_16x16x32_bf16 a[148:151], v[60:63], v[188:191], a[148:151]
v_mfma_f32_16x16x32_bf16 a[152:155], v[60:63], v[192:195], a[152:155]
v_mfma_f32_16x16x32_bf16 a[156:159], v[60:63], v[196:199], a[156:159]
buffer_load_dwordx4 v[60:63], v1, s[4:7], s39 offen offset:0
s_waitcnt vmcnt(30)
s_waitcnt lgkmcnt(0)
v_mfma_f32_16x16x32_bf16 a[0:3], v[64:67], v[200:203], a[0:3]
v_mfma_f32_16x16x32_bf16 a[4:7], v[64:67], v[204:207], a[4:7]
v_mfma_f32_16x16x32_bf16 a[8:11], v[64:67], v[208:211], a[8:11]
v_mfma_f32_16x16x32_bf16 a[12:15], v[64:67], v[212:215], a[12:15]
ds_read_b128 v[184:187], v1 offset:10240
buffer_load_dwordx4 v[64:67], v1, s[4:7], s30 offen offset:1024
v_mfma_f32_16x16x32_bf16 a[16:19], v[68:71], v[200:203], a[16:19]
v_mfma_f32_16x16x32_bf16 a[20:23], v[68:71], v[204:207], a[20:23]
v_mfma_f32_16x16x32_bf16 a[24:27], v[68:71], v[208:211], a[24:27]
v_mfma_f32_16x16x32_bf16 a[28:31], v[68:71], v[212:215], a[28:31]
ds_read_b128 v[188:191], v1 offset:34816
buffer_load_dwordx4 v[68:71], v1, s[4:7], s31 offen offset:1024
v_mfma_f32_16x16x32_bf16 a[32:35], v[72:75], v[200:203], a[32:35]
v_mfma_f32_16x16x32_bf16 a[36:39], v[72:75], v[204:207], a[36:39]
v_mfma_f32_16x16x32_bf16 a[40:43], v[72:75], v[208:211], a[40:43]
v_mfma_f32_16x16x32_bf16 a[44:47], v[72:75], v[212:215], a[44:47]
ds_read_b128 v[192:195], v6 offset:10240
buffer_load_dwordx4 v[72:75], v1, s[4:7], s32 offen offset:1024
v_mfma_f32_16x16x32_bf16 a[48:51], v[76:79], v[200:203], a[48:51]
v_mfma_f32_16x16x32_bf16 a[52:55], v[76:79], v[204:207], a[52:55]
v_mfma_f32_16x16x32_bf16 a[56:59], v[76:79], v[208:211], a[56:59]
v_mfma_f32_16x16x32_bf16 a[60:63], v[76:79], v[212:215], a[60:63]
ds_read_b128 v[196:199], v6 offset:34816
buffer_load_dwordx4 v[76:79], v1, s[4:7], s33 offen offset:1024
v_mfma_f32_16x16x32_bf16 a[64:67], v[80:83], v[200:203], a[64:67]
v_mfma_f32_16x16x32_bf16 a[68:71], v[80:83], v[204:207], a[68:71]
v_mfma_f32_16x16x32_bf16 a[72:75], v[80:83], v[208:211], a[72:75]
v_mfma_f32_16x16x32_bf16 a[76:79], v[80:83], v[212:215], a[76:79]
buffer_load_dwordx4 v[80:83], v1, s[4:7], s34 offen offset:1024
v_mfma_f32_16x16x32_bf16 a[80:83], v[84:87], v[200:203], a[80:83]
v_mfma_f32_16x16x32_bf16 a[84:87], v[84:87], v[204:207], a[84:87]
v_mfma_f32_16x16x32_bf16 a[88:91], v[84:87], v[208:211], a[88:91]
v_mfma_f32_16x16x32_bf16 a[92:95], v[84:87], v[212:215], a[92:95]
buffer_load_dwordx4 v[84:87], v1, s[4:7], s35 offen offset:1024
v_mfma_f32_16x16x32_bf16 a[96:99], v[88:91], v[200:203], a[96:99]
v_mfma_f32_16x16x32_bf16 a[100:103], v[88:91], v[204:207], a[100:103]
v_mfma_f32_16x16x32_bf16 a[104:107], v[88:91], v[208:211], a[104:107]
v_mfma_f32_16x16x32_bf16 a[108:111], v[88:91], v[212:215], a[108:111]
buffer_load_dwordx4 v[88:91], v1, s[4:7], s36 offen offset:1024
v_mfma_f32_16x16x32_bf16 a[112:115], v[92:95], v[200:203], a[112:115]
v_mfma_f32_16x16x32_bf16 a[116:119], v[92:95], v[204:207], a[116:119]
v_mfma_f32_16x16x32_bf16 a[120:123], v[92:95], v[208:211], a[120:123]
v_mfma_f32_16x16x32_bf16 a[124:127], v[92:95], v[212:215], a[124:127]
buffer_load_dwordx4 v[92:95], v1, s[4:7], s37 offen offset:1024
v_mfma_f32_16x16x32_bf16 a[128:131], v[96:99], v[200:203], a[128:131]
v_mfma_f32_16x16x32_bf16 a[132:135], v[96:99], v[204:207], a[132:135]
v_mfma_f32_16x16x32_bf16 a[136:139], v[96:99], v[208:211], a[136:139]
v_mfma_f32_16x16x32_bf16 a[140:143], v[96:99], v[212:215], a[140:143]
buffer_load_dwordx4 v[96:99], v1, s[4:7], s38 offen offset:1024
v_mfma_f32_16x16x32_bf16 a[144:147], v[100:103], v[200:203], a[144:147]
v_mfma_f32_16x16x32_bf16 a[148:151], v[100:103], v[204:207], a[148:151]
v_mfma_f32_16x16x32_bf16 a[152:155], v[100:103], v[208:211], a[152:155]
v_mfma_f32_16x16x32_bf16 a[156:159], v[100:103], v[212:215], a[156:159]
buffer_load_dwordx4 v[100:103], v1, s[4:7], s39 offen offset:1024
s_waitcnt vmcnt(30)
s_waitcnt lgkmcnt(0)
v_mfma_f32_16x16x32_bf16 a[0:3], v[104:107], v[184:187], a[0:3]
v_mfma_f32_16x16x32_bf16 a[4:7], v[104:107], v[188:191], a[4:7]
v_mfma_f32_16x16x32_bf16 a[8:11], v[104:107], v[192:195], a[8:11]
v_mfma_f32_16x16x32_bf16 a[12:15], v[104:107], v[196:199], a[12:15]
ds_read_b128 v[200:203], v1 offset:11264
buffer_load_dwordx4 v[104:107], v1, s[4:7], s30 offen offset:2048
v_mfma_f32_16x16x32_bf16 a[16:19], v[108:111], v[184:187], a[16:19]
v_mfma_f32_16x16x32_bf16 a[20:23], v[108:111], v[188:191], a[20:23]
v_mfma_f32_16x16x32_bf16 a[24:27], v[108:111], v[192:195], a[24:27]
v_mfma_f32_16x16x32_bf16 a[28:31], v[108:111], v[196:199], a[28:31]
ds_read_b128 v[204:207], v1 offset:35840
buffer_load_dwordx4 v[108:111], v1, s[4:7], s31 offen offset:2048
v_mfma_f32_16x16x32_bf16 a[32:35], v[112:115], v[184:187], a[32:35]
v_mfma_f32_16x16x32_bf16 a[36:39], v[112:115], v[188:191], a[36:39]
v_mfma_f32_16x16x32_bf16 a[40:43], v[112:115], v[192:195], a[40:43]
v_mfma_f32_16x16x32_bf16 a[44:47], v[112:115], v[196:199], a[44:47]
ds_read_b128 v[208:211], v6 offset:11264
buffer_load_dwordx4 v[112:115], v1, s[4:7], s32 offen offset:2048
v_mfma_f32_16x16x32_bf16 a[48:51], v[116:119], v[184:187], a[48:51]
v_mfma_f32_16x16x32_bf16 a[52:55], v[116:119], v[188:191], a[52:55]
v_mfma_f32_16x16x32_bf16 a[56:59], v[116:119], v[192:195], a[56:59]
v_mfma_f32_16x16x32_bf16 a[60:63], v[116:119], v[196:199], a[60:63]
ds_read_b128 v[212:215], v6 offset:35840
buffer_load_dwordx4 v[116:119], v1, s[4:7], s33 offen offset:2048
v_mfma_f32_16x16x32_bf16 a[64:67], v[120:123], v[184:187], a[64:67]
v_mfma_f32_16x16x32_bf16 a[68:71], v[120:123], v[188:191], a[68:71]
v_mfma_f32_16x16x32_bf16 a[72:75], v[120:123], v[192:195], a[72:75]
v_mfma_f32_16x16x32_bf16 a[76:79], v[120:123], v[196:199], a[76:79]
buffer_load_dwordx4 v[120:123], v1, s[4:7], s34 offen offset:2048
v_mfma_f32_16x16x32_bf16 a[80:83], v[124:127], v[184:187], a[80:83]
v_mfma_f32_16x16x32_bf16 a[84:87], v[124:127], v[188:191], a[84:87]
v_mfma_f32_16x16x32_bf16 a[88:91], v[124:127], v[192:195], a[88:91]
v_mfma_f32_16x16x32_bf16 a[92:95], v[124:127], v[196:199], a[92:95]
buffer_load_dwordx4 v[124:127], v1, s[4:7], s35 offen offset:2048
v_mfma_f32_16x16x32_bf16 a[96:99], v[128:131], v[184:187], a[96:99]
v_mfma_f32_16x16x32_bf16 a[100:103], v[128:131], v[188:191], a[100:103]
v_mfma_f32_16x16x32_bf16 a[104:107], v[128:131], v[192:195], a[104:107]
v_mfma_f32_16x16x32_bf16 a[108:111], v[128:131], v[196:199], a[108:111]
buffer_load_dwordx4 v[128:131], v1, s[4:7], s36 offen offset:2048
v_mfma_f32_16x16x32_bf16 a[112:115], v[132:135], v[184:187], a[112:115]
v_mfma_f32_16x16x32_bf16 a[116:119], v[132:135], v[188:191], a[116:119]
v_mfma_f32_16x16x32_bf16 a[120:123], v[132:135], v[192:195], a[120:123]
v_mfma_f32_16x16x32_bf16 a[124:127], v[132:135], v[196:199], a[124:127]
buffer_load_dwordx4 v[132:135], v1, s[4:7], s37 offen offset:2048
v_mfma_f32_16x16x32_bf16 a[128:131], v[136:139], v[184:187], a[128:131]
v_mfma_f32_16x16x32_bf16 a[132:135], v[136:139], v[188:191], a[132:135]
v_mfma_f32_16x16x32_bf16 a[136:139], v[136:139], v[192:195], a[136:139]
v_mfma_f32_16x16x32_bf16 a[140:143], v[136:139], v[196:199], a[140:143]
buffer_load_dwordx4 v[136:139], v1, s[4:7], s38 offen offset:2048
v_mfma_f32_16x16x32_bf16 a[144:147], v[140:143], v[184:187], a[144:147]
v_mfma_f32_16x16x32_bf16 a[148:151], v[140:143], v[188:191], a[148:151]
v_mfma_f32_16x16x32_bf16 a[152:155], v[140:143], v[192:195], a[152:155]
v_mfma_f32_16x16x32_bf16 a[156:159], v[140:143], v[196:199], a[156:159]
buffer_load_dwordx4 v[140:143], v1, s[4:7], s39 offen offset:2048
s_barrier
s_waitcnt vmcnt(30)
s_waitcnt lgkmcnt(0)
v_mfma_f32_16x16x32_bf16 a[0:3], v[144:147], v[200:203], a[0:3]
v_mfma_f32_16x16x32_bf16 a[4:7], v[144:147], v[204:207], a[4:7]
v_mfma_f32_16x16x32_bf16 a[8:11], v[144:147], v[208:211], a[8:11]
v_mfma_f32_16x16x32_bf16 a[12:15], v[144:147], v[212:215], a[12:15]
ds_read_b128 v[184:187], v1 offset:12288
buffer_load_dwordx4 v[144:147], v1, s[4:7], s30 offen offset:3072
s_add_u32 s30, s30, 4096
v_mfma_f32_16x16x32_bf16 a[16:19], v[148:151], v[200:203], a[16:19]
v_mfma_f32_16x16x32_bf16 a[20:23], v[148:151], v[204:207], a[20:23]
v_mfma_f32_16x16x32_bf16 a[24:27], v[148:151], v[208:211], a[24:27]
v_mfma_f32_16x16x32_bf16 a[28:31], v[148:151], v[212:215], a[28:31]
ds_read_b128 v[188:191], v1 offset:36864
buffer_load_dwordx4 v[148:151], v1, s[4:7], s31 offen offset:3072
s_add_u32 s31, s31, 4096
v_mfma_f32_16x16x32_bf16 a[32:35], v[152:155], v[200:203], a[32:35]
v_mfma_f32_16x16x32_bf16 a[36:39], v[152:155], v[204:207], a[36:39]
v_mfma_f32_16x16x32_bf16 a[40:43], v[152:155], v[208:211], a[40:43]
v_mfma_f32_16x16x32_bf16 a[44:47], v[152:155], v[212:215], a[44:47]
ds_read_b128 v[192:195], v6 offset:12288
buffer_load_dwordx4 v[152:155], v1, s[4:7], s32 offen offset:3072
s_add_u32 s32, s32, 4096
v_mfma_f32_16x16x32_bf16 a[48:51], v[156:159], v[200:203], a[48:51]
v_mfma_f32_16x16x32_bf16 a[52:55], v[156:159], v[204:207], a[52:55]
v_mfma_f32_16x16x32_bf16 a[56:59], v[156:159], v[208:211], a[56:59]
v_mfma_f32_16x16x32_bf16 a[60:63], v[156:159], v[212:215], a[60:63]
ds_read_b128 v[196:199], v6 offset:36864
buffer_load_dwordx4 v[156:159], v1, s[4:7], s33 offen offset:3072
s_add_u32 s33, s33, 4096
v_mfma_f32_16x16x32_bf16 a[64:67], v[160:163], v[200:203], a[64:67]
v_mfma_f32_16x16x32_bf16 a[68:71], v[160:163], v[204:207], a[68:71]
v_mfma_f32_16x16x32_bf16 a[72:75], v[160:163], v[208:211], a[72:75]
v_mfma_f32_16x16x32_bf16 a[76:79], v[160:163], v[212:215], a[76:79]
buffer_load_dwordx4 v[160:163], v1, s[4:7], s34 offen offset:3072
s_add_u32 s34, s34, 4096
v_mfma_f32_16x16x32_bf16 a[80:83], v[164:167], v[200:203], a[80:83]
v_mfma_f32_16x16x32_bf16 a[84:87], v[164:167], v[204:207], a[84:87]
v_mfma_f32_16x16x32_bf16 a[88:91], v[164:167], v[208:211], a[88:91]
v_mfma_f32_16x16x32_bf16 a[92:95], v[164:167], v[212:215], a[92:95]
buffer_load_dwordx4 v[164:167], v1, s[4:7], s35 offen offset:3072
s_add_u32 s35, s35, 4096
v_mfma_f32_16x16x32_bf16 a[96:99], v[168:171], v[200:203], a[96:99]
v_mfma_f32_16x16x32_bf16 a[100:103], v[168:171], v[204:207], a[100:103]
v_mfma_f32_16x16x32_bf16 a[104:107], v[168:171], v[208:211], a[104:107]
v_mfma_f32_16x16x32_bf16 a[108:111], v[168:171], v[212:215], a[108:111]
buffer_load_dwordx4 v[168:171], v1, s[4:7], s36 offen offset:3072
s_add_u32 s36, s36, 4096
v_mfma_f32_16x16x32_bf16 a[112:115], v[172:175], v[200:203], a[112:115]
v_mfma_f32_16x16x32_bf16 a[116:119], v[172:175], v[204:207], a[116:119]
v_mfma_f32_16x16x32_bf16 a[120:123], v[172:175], v[208:211], a[120:123]
v_mfma_f32_16x16x32_bf16 a[124:127], v[172:175], v[212:215], a[124:127]
buffer_load_dwordx4 v[172:175], v1, s[4:7], s37 offen offset:3072
s_add_u32 s37, s37, 4096
v_mfma_f32_16x16x32_bf16 a[128:131], v[176:179], v[200:203], a[128:131]
v_mfma_f32_16x16x32_bf16 a[132:135], v[176:179], v[204:207], a[132:135]
v_mfma_f32_16x16x32_bf16 a[136:139], v[176:179], v[208:211], a[136:139]
v_mfma_f32_16x16x32_bf16 a[140:143], v[176:179], v[212:215], a[140:143]
buffer_load_dwordx4 v[176:179], v1, s[4:7], s38 offen offset:3072
s_add_u32 s38, s38, 4096
v_mfma_f32_16x16x32_bf16 a[144:147], v[180:183], v[200:203], a[144:147]
v_mfma_f32_16x16x32_bf16 a[148:151], v[180:183], v[204:207], a[148:151]
v_mfma_f32_16x16x32_bf16 a[152:155], v[180:183], v[208:211], a[152:155]
v_mfma_f32_16x16x32_bf16 a[156:159], v[180:183], v[212:215], a[156:159]
buffer_load_dwordx4 v[180:183], v1, s[4:7], s39 offen offset:3072
s_add_u32 s39, s39, 4096
s_waitcnt vmcnt(30)
s_waitcnt lgkmcnt(0)
v_mfma_f32_16x16x32_bf16 a[0:3], v[24:27], v[184:187], a[0:3]
v_mfma_f32_16x16x32_bf16 a[4:7], v[24:27], v[188:191], a[4:7]
v_mfma_f32_16x16x32_bf16 a[8:11], v[24:27], v[192:195], a[8:11]
v_mfma_f32_16x16x32_bf16 a[12:15], v[24:27], v[196:199], a[12:15]
ds_read_b128 v[200:203], v1 offset:13312
buffer_load_dwordx4 v[24:27], v1, s[4:7], s30 offen offset:0
v_mfma_f32_16x16x32_bf16 a[16:19], v[28:31], v[184:187], a[16:19]
v_mfma_f32_16x16x32_bf16 a[20:23], v[28:31], v[188:191], a[20:23]
v_mfma_f32_16x16x32_bf16 a[24:27], v[28:31], v[192:195], a[24:27]
v_mfma_f32_16x16x32_bf16 a[28:31], v[28:31], v[196:199], a[28:31]
ds_read_b128 v[204:207], v1 offset:37888
buffer_load_dwordx4 v[28:31], v1, s[4:7], s31 offen offset:0
v_mfma_f32_16x16x32_bf16 a[32:35], v[32:35], v[184:187], a[32:35]
v_mfma_f32_16x16x32_bf16 a[36:39], v[32:35], v[188:191], a[36:39]
v_mfma_f32_16x16x32_bf16 a[40:43], v[32:35], v[192:195], a[40:43]
v_mfma_f32_16x16x32_bf16 a[44:47], v[32:35], v[196:199], a[44:47]
ds_read_b128 v[208:211], v6 offset:13312
buffer_load_dwordx4 v[32:35], v1, s[4:7], s32 offen offset:0
v_mfma_f32_16x16x32_bf16 a[48:51], v[36:39], v[184:187], a[48:51]
v_mfma_f32_16x16x32_bf16 a[52:55], v[36:39], v[188:191], a[52:55]
v_mfma_f32_16x16x32_bf16 a[56:59], v[36:39], v[192:195], a[56:59]
v_mfma_f32_16x16x32_bf16 a[60:63], v[36:39], v[196:199], a[60:63]
ds_read_b128 v[212:215], v6 offset:37888
buffer_load_dwordx4 v[36:39], v1, s[4:7], s33 offen offset:0
v_mfma_f32_16x16x32_bf16 a[64:67], v[40:43], v[184:187], a[64:67]
v_mfma_f32_16x16x32_bf16 a[68:71], v[40:43], v[188:191], a[68:71]
v_mfma_f32_16x16x32_bf16 a[72:75], v[40:43], v[192:195], a[72:75]
v_mfma_f32_16x16x32_bf16 a[76:79], v[40:43], v[196:199], a[76:79]
buffer_load_dwordx4 v[40:43], v1, s[4:7], s34 offen offset:0
v_mfma_f32_16x16x32_bf16 a[80:83], v[44:47], v[184:187], a[80:83]
v_mfma_f32_16x16x32_bf16 a[84:87], v[44:47], v[188:191], a[84:87]
v_mfma_f32_16x16x32_bf16 a[88:91], v[44:47], v[192:195], a[88:91]
v_mfma_f32_16x16x32_bf16 a[92:95], v[44:47], v[196:199], a[92:95]
buffer_load_dwordx4 v[44:47], v1, s[4:7], s35 offen offset:0
v_mfma_f32_16x16x32_bf16 a[96:99], v[48:51], v[184:187], a[96:99]
v_mfma_f32_16x16x32_bf16 a[100:103], v[48:51], v[188:191], a[100:103]
v_mfma_f32_16x16x32_bf16 a[104:107], v[48:51], v[192:195], a[104:107]
v_mfma_f32_16x16x32_bf16 a[108:111], v[48:51], v[196:199], a[108:111]
buffer_load_dwordx4 v[48:51], v1, s[4:7], s36 offen offset:0
v_mfma_f32_16x16x32_bf16 a[112:115], v[52:55], v[184:187], a[112:115]
v_mfma_f32_16x16x32_bf16 a[116:119], v[52:55], v[188:191], a[116:119]
v_mfma_f32_16x16x32_bf16 a[120:123], v[52:55], v[192:195], a[120:123]
v_mfma_f32_16x16x32_bf16 a[124:127], v[52:55], v[196:199], a[124:127]
buffer_load_dwordx4 v[52:55], v1, s[4:7], s37 offen offset:0
v_mfma_f32_16x16x32_bf16 a[128:131], v[56:59], v[184:187], a[128:131]
v_mfma_f32_16x16x32_bf16 a[132:135], v[56:59], v[188:191], a[132:135]
v_mfma_f32_16x16x32_bf16 a[136:139], v[56:59], v[192:195], a[136:139]
v_mfma_f32_16x16x32_bf16 a[140:143], v[56:59], v[196:199], a[140:143]
buffer_load_dwordx4 v[56:59], v1, s[4:7], s38 offen offset:0
v_mfma_f32_16x16x32_bf16 a[144:147], v[60:63], v[184:187], a[144:147]
v_mfma_f32_16x16x32_bf16 a[148:151], v[60:63], v[188:191], a[148:151]
v_mfma_f32_16x16x32_bf16 a[152:155], v[60:63], v[192:195], a[152:155]
v_mfma_f32_16x16x32_bf16 a[156:159], v[60:63], v[196:199], a[156:159]
buffer_load_dwordx4 v[60:63], v1, s[4:7], s39 offen offset:0
s_waitcnt vmcnt(30)
s_waitcnt lgkmcnt(0)
v_mfma_f32_16x16x32_bf16 a[0:3], v[64:67], v[200:203], a[0:3]
v_mfma_f32_16x16x32_bf16 a[4:7], v[64:67], v[204:207], a[4:7]
v_mfma_f32_16x16x32_bf16 a[8:11], v[64:67], v[208:211], a[8:11]
v_mfma_f32_16x16x32_bf16 a[12:15], v[64:67], v[212:215], a[12:15]
ds_read_b128 v[184:187], v1 offset:14336
buffer_load_dwordx4 v[64:67], v1, s[4:7], s30 offen offset:1024
v_mfma_f32_16x16x32_bf16 a[16:19], v[68:71], v[200:203], a[16:19]
v_mfma_f32_16x16x32_bf16 a[20:23], v[68:71], v[204:207], a[20:23]
v_mfma_f32_16x16x32_bf16 a[24:27], v[68:71], v[208:211], a[24:27]
v_mfma_f32_16x16x32_bf16 a[28:31], v[68:71], v[212:215], a[28:31]
ds_read_b128 v[188:191], v1 offset:38912
buffer_load_dwordx4 v[68:71], v1, s[4:7], s31 offen offset:1024
v_mfma_f32_16x16x32_bf16 a[32:35], v[72:75], v[200:203], a[32:35]
v_mfma_f32_16x16x32_bf16 a[36:39], v[72:75], v[204:207], a[36:39]
v_mfma_f32_16x16x32_bf16 a[40:43], v[72:75], v[208:211], a[40:43]
v_mfma_f32_16x16x32_bf16 a[44:47], v[72:75], v[212:215], a[44:47]
ds_read_b128 v[192:195], v6 offset:14336
buffer_load_dwordx4 v[72:75], v1, s[4:7], s32 offen offset:1024
v_mfma_f32_16x16x32_bf16 a[48:51], v[76:79], v[200:203], a[48:51]
v_mfma_f32_16x16x32_bf16 a[52:55], v[76:79], v[204:207], a[52:55]
v_mfma_f32_16x16x32_bf16 a[56:59], v[76:79], v[208:211], a[56:59]
v_mfma_f32_16x16x32_bf16 a[60:63], v[76:79], v[212:215], a[60:63]
ds_read_b128 v[196:199], v6 offset:38912
buffer_load_dwordx4 v[76:79], v1, s[4:7], s33 offen offset:1024
v_mfma_f32_16x16x32_bf16 a[64:67], v[80:83], v[200:203], a[64:67]
v_mfma_f32_16x16x32_bf16 a[68:71], v[80:83], v[204:207], a[68:71]
v_mfma_f32_16x16x32_bf16 a[72:75], v[80:83], v[208:211], a[72:75]
v_mfma_f32_16x16x32_bf16 a[76:79], v[80:83], v[212:215], a[76:79]
buffer_load_dwordx4 v[80:83], v1, s[4:7], s34 offen offset:1024
v_mfma_f32_16x16x32_bf16 a[80:83], v[84:87], v[200:203], a[80:83]
v_mfma_f32_16x16x32_bf16 a[84:87], v[84:87], v[204:207], a[84:87]
v_mfma_f32_16x16x32_bf16 a[88:91], v[84:87], v[208:211], a[88:91]
v_mfma_f32_16x16x32_bf16 a[92:95], v[84:87], v[212:215], a[92:95]
buffer_load_dwordx4 v[84:87], v1, s[4:7], s35 offen offset:1024
v_mfma_f32_16x16x32_bf16 a[96:99], v[88:91], v[200:203], a[96:99]
v_mfma_f32_16x16x32_bf16 a[100:103], v[88:91], v[204:207], a[100:103]
v_mfma_f32_16x16x32_bf16 a[104:107], v[88:91], v[208:211], a[104:107]
v_mfma_f32_16x16x32_bf16 a[108:111], v[88:91], v[212:215], a[108:111]
buffer_load_dwordx4 v[88:91], v1, s[4:7], s36 offen offset:1024
v_mfma_f32_16x16x32_bf16 a[112:115], v[92:95], v[200:203], a[112:115]
v_mfma_f32_16x16x32_bf16 a[116:119], v[92:95], v[204:207], a[116:119]
v_mfma_f32_16x16x32_bf16 a[120:123], v[92:95], v[208:211], a[120:123]
v_mfma_f32_16x16x32_bf16 a[124:127], v[92:95], v[212:215], a[124:127]
buffer_load_dwordx4 v[92:95], v1, s[4:7], s37 offen offset:1024
v_mfma_f32_16x16x32_bf16 a[128:131], v[96:99], v[200:203], a[128:131]
v_mfma_f32_16x16x32_bf16 a[132:135], v[96:99], v[204:207], a[132:135]
v_mfma_f32_16x16x32_bf16 a[136:139], v[96:99], v[208:211], a[136:139]
v_mfma_f32_16x16x32_bf16 a[140:143], v[96:99], v[212:215], a[140:143]
buffer_load_dwordx4 v[96:99], v1, s[4:7], s38 offen offset:1024
v_mfma_f32_16x16x32_bf16 a[144:147], v[100:103], v[200:203], a[144:147]
v_mfma_f32_16x16x32_bf16 a[148:151], v[100:103], v[204:207], a[148:151]
v_mfma_f32_16x16x32_bf16 a[152:155], v[100:103], v[208:211], a[152:155]
v_mfma_f32_16x16x32_bf16 a[156:159], v[100:103], v[212:215], a[156:159]
buffer_load_dwordx4 v[100:103], v1, s[4:7], s39 offen offset:1024
s_waitcnt vmcnt(30)
s_waitcnt lgkmcnt(0)
v_mfma_f32_16x16x32_bf16 a[0:3], v[104:107], v[184:187], a[0:3]
v_mfma_f32_16x16x32_bf16 a[4:7], v[104:107], v[188:191], a[4:7]
v_mfma_f32_16x16x32_bf16 a[8:11], v[104:107], v[192:195], a[8:11]
v_mfma_f32_16x16x32_bf16 a[12:15], v[104:107], v[196:199], a[12:15]
ds_read_b128 v[200:203], v1 offset:15360
buffer_load_dwordx4 v[104:107], v1, s[4:7], s30 offen offset:2048
v_mfma_f32_16x16x32_bf16 a[16:19], v[108:111], v[184:187], a[16:19]
v_mfma_f32_16x16x32_bf16 a[20:23], v[108:111], v[188:191], a[20:23]
v_mfma_f32_16x16x32_bf16 a[24:27], v[108:111], v[192:195], a[24:27]
v_mfma_f32_16x16x32_bf16 a[28:31], v[108:111], v[196:199], a[28:31]
ds_read_b128 v[204:207], v1 offset:39936
buffer_load_dwordx4 v[108:111], v1, s[4:7], s31 offen offset:2048
v_mfma_f32_16x16x32_bf16 a[32:35], v[112:115], v[184:187], a[32:35]
v_mfma_f32_16x16x32_bf16 a[36:39], v[112:115], v[188:191], a[36:39]
v_mfma_f32_16x16x32_bf16 a[40:43], v[112:115], v[192:195], a[40:43]
v_mfma_f32_16x16x32_bf16 a[44:47], v[112:115], v[196:199], a[44:47]
ds_read_b128 v[208:211], v6 offset:15360
buffer_load_dwordx4 v[112:115], v1, s[4:7], s32 offen offset:2048
v_mfma_f32_16x16x32_bf16 a[48:51], v[116:119], v[184:187], a[48:51]
v_mfma_f32_16x16x32_bf16 a[52:55], v[116:119], v[188:191], a[52:55]
v_mfma_f32_16x16x32_bf16 a[56:59], v[116:119], v[192:195], a[56:59]
v_mfma_f32_16x16x32_bf16 a[60:63], v[116:119], v[196:199], a[60:63]
ds_read_b128 v[212:215], v6 offset:39936
buffer_load_dwordx4 v[116:119], v1, s[4:7], s33 offen offset:2048
v_mfma_f32_16x16x32_bf16 a[64:67], v[120:123], v[184:187], a[64:67]
v_mfma_f32_16x16x32_bf16 a[68:71], v[120:123], v[188:191], a[68:71]
v_mfma_f32_16x16x32_bf16 a[72:75], v[120:123], v[192:195], a[72:75]
v_mfma_f32_16x16x32_bf16 a[76:79], v[120:123], v[196:199], a[76:79]
buffer_load_dwordx4 v[120:123], v1, s[4:7], s34 offen offset:2048
v_mfma_f32_16x16x32_bf16 a[80:83], v[124:127], v[184:187], a[80:83]
v_mfma_f32_16x16x32_bf16 a[84:87], v[124:127], v[188:191], a[84:87]
v_mfma_f32_16x16x32_bf16 a[88:91], v[124:127], v[192:195], a[88:91]
v_mfma_f32_16x16x32_bf16 a[92:95], v[124:127], v[196:199], a[92:95]
buffer_load_dwordx4 v[124:127], v1, s[4:7], s35 offen offset:2048
v_mfma_f32_16x16x32_bf16 a[96:99], v[128:131], v[184:187], a[96:99]
v_mfma_f32_16x16x32_bf16 a[100:103], v[128:131], v[188:191], a[100:103]
v_mfma_f32_16x16x32_bf16 a[104:107], v[128:131], v[192:195], a[104:107]
v_mfma_f32_16x16x32_bf16 a[108:111], v[128:131], v[196:199], a[108:111]
buffer_load_dwordx4 v[128:131], v1, s[4:7], s36 offen offset:2048
v_mfma_f32_16x16x32_bf16 a[112:115], v[132:135], v[184:187], a[112:115]
v_mfma_f32_16x16x32_bf16 a[116:119], v[132:135], v[188:191], a[116:119]
v_mfma_f32_16x16x32_bf16 a[120:123], v[132:135], v[192:195], a[120:123]
v_mfma_f32_16x16x32_bf16 a[124:127], v[132:135], v[196:199], a[124:127]
buffer_load_dwordx4 v[132:135], v1, s[4:7], s37 offen offset:2048
v_mfma_f32_16x16x32_bf16 a[128:131], v[136:139], v[184:187], a[128:131]
v_mfma_f32_16x16x32_bf16 a[132:135], v[136:139], v[188:191], a[132:135]
v_mfma_f32_16x16x32_bf16 a[136:139], v[136:139], v[192:195], a[136:139]
v_mfma_f32_16x16x32_bf16 a[140:143], v[136:139], v[196:199], a[140:143]
buffer_load_dwordx4 v[136:139], v1, s[4:7], s38 offen offset:2048
v_mfma_f32_16x16x32_bf16 a[144:147], v[140:143], v[184:187], a[144:147]
v_mfma_f32_16x16x32_bf16 a[148:151], v[140:143], v[188:191], a[148:151]
v_mfma_f32_16x16x32_bf16 a[152:155], v[140:143], v[192:195], a[152:155]
v_mfma_f32_16x16x32_bf16 a[156:159], v[140:143], v[196:199], a[156:159]
buffer_load_dwordx4 v[140:143], v1, s[4:7], s39 offen offset:2048
s_waitcnt vmcnt(30)
s_waitcnt lgkmcnt(0)
v_mfma_f32_16x16x32_bf16 a[0:3], v[144:147], v[200:203], a[0:3]
v_mfma_f32_16x16x32_bf16 a[4:7], v[144:147], v[204:207], a[4:7]
v_mfma_f32_16x16x32_bf16 a[8:11], v[144:147], v[208:211], a[8:11]
v_mfma_f32_16x16x32_bf16 a[12:15], v[144:147], v[212:215], a[12:15]
ds_read_b128 v[184:187], v1 offset:16384
buffer_load_dwordx4 v[144:147], v1, s[4:7], s30 offen offset:3072
s_add_u32 s30, s30, 4096
v_mfma_f32_16x16x32_bf16 a[16:19], v[148:151], v[200:203], a[16:19]
v_mfma_f32_16x16x32_bf16 a[20:23], v[148:151], v[204:207], a[20:23]
v_mfma_f32_16x16x32_bf16 a[24:27], v[148:151], v[208:211], a[24:27]
v_mfma_f32_16x16x32_bf16 a[28:31], v[148:151], v[212:215], a[28:31]
ds_read_b128 v[188:191], v1 offset:40960
buffer_load_dwordx4 v[148:151], v1, s[4:7], s31 offen offset:3072
s_add_u32 s31, s31, 4096
v_mfma_f32_16x16x32_bf16 a[32:35], v[152:155], v[200:203], a[32:35]
v_mfma_f32_16x16x32_bf16 a[36:39], v[152:155], v[204:207], a[36:39]
v_mfma_f32_16x16x32_bf16 a[40:43], v[152:155], v[208:211], a[40:43]
v_mfma_f32_16x16x32_bf16 a[44:47], v[152:155], v[212:215], a[44:47]
ds_read_b128 v[192:195], v6 offset:16384
buffer_load_dwordx4 v[152:155], v1, s[4:7], s32 offen offset:3072
s_add_u32 s32, s32, 4096
v_mfma_f32_16x16x32_bf16 a[48:51], v[156:159], v[200:203], a[48:51]
v_mfma_f32_16x16x32_bf16 a[52:55], v[156:159], v[204:207], a[52:55]
v_mfma_f32_16x16x32_bf16 a[56:59], v[156:159], v[208:211], a[56:59]
v_mfma_f32_16x16x32_bf16 a[60:63], v[156:159], v[212:215], a[60:63]
ds_read_b128 v[196:199], v6 offset:40960
buffer_load_dwordx4 v[156:159], v1, s[4:7], s33 offen offset:3072
s_add_u32 s33, s33, 4096
v_mfma_f32_16x16x32_bf16 a[64:67], v[160:163], v[200:203], a[64:67]
v_mfma_f32_16x16x32_bf16 a[68:71], v[160:163], v[204:207], a[68:71]
v_mfma_f32_16x16x32_bf16 a[72:75], v[160:163], v[208:211], a[72:75]
v_mfma_f32_16x16x32_bf16 a[76:79], v[160:163], v[212:215], a[76:79]
buffer_load_dwordx4 v[160:163], v1, s[4:7], s34 offen offset:3072
s_add_u32 s34, s34, 4096
v_mfma_f32_16x16x32_bf16 a[80:83], v[164:167], v[200:203], a[80:83]
v_mfma_f32_16x16x32_bf16 a[84:87], v[164:167], v[204:207], a[84:87]
v_mfma_f32_16x16x32_bf16 a[88:91], v[164:167], v[208:211], a[88:91]
v_mfma_f32_16x16x32_bf16 a[92:95], v[164:167], v[212:215], a[92:95]
buffer_load_dwordx4 v[164:167], v1, s[4:7], s35 offen offset:3072
s_add_u32 s35, s35, 4096
v_mfma_f32_16x16x32_bf16 a[96:99], v[168:171], v[200:203], a[96:99]
v_mfma_f32_16x16x32_bf16 a[100:103], v[168:171], v[204:207], a[100:103]
v_mfma_f32_16x16x32_bf16 a[104:107], v[168:171], v[208:211], a[104:107]
v_mfma_f32_16x16x32_bf16 a[108:111], v[168:171], v[212:215], a[108:111]
buffer_load_dwordx4 v[168:171], v1, s[4:7], s36 offen offset:3072
s_add_u32 s36, s36, 4096
v_mfma_f32_16x16x32_bf16 a[112:115], v[172:175], v[200:203], a[112:115]
v_mfma_f32_16x16x32_bf16 a[116:119], v[172:175], v[204:207], a[116:119]
v_mfma_f32_16x16x32_bf16 a[120:123], v[172:175], v[208:211], a[120:123]
v_mfma_f32_16x16x32_bf16 a[124:127], v[172:175], v[212:215], a[124:127]
buffer_load_dwordx4 v[172:175], v1, s[4:7], s37 offen offset:3072
s_add_u32 s37, s37, 4096
v_mfma_f32_16x16x32_bf16 a[128:131], v[176:179], v[200:203], a[128:131]
v_mfma_f32_16x16x32_bf16 a[132:135], v[176:179], v[204:207], a[132:135]
v_mfma_f32_16x16x32_bf16 a[136:139], v[176:179], v[208:211], a[136:139]
v_mfma_f32_16x16x32_bf16 a[140:143], v[176:179], v[212:215], a[140:143]
buffer_load_dwordx4 v[176:179], v1, s[4:7], s38 offen offset:3072
s_add_u32 s38, s38, 4096
v_mfma_f32_16x16x32_bf16 a[144:147], v[180:183], v[200:203], a[144:147]
v_mfma_f32_16x16x32_bf16 a[148:151], v[180:183], v[204:207], a[148:151]
v_mfma_f32_16x16x32_bf16 a[152:155], v[180:183], v[208:211], a[152:155]
v_mfma_f32_16x16x32_bf16 a[156:159], v[180:183], v[212:215], a[156:159]
buffer_load_dwordx4 v[180:183], v1, s[4:7], s39 offen offset:3072
s_add_u32 s39, s39, 4096
s_waitcnt vmcnt(30)
s_waitcnt lgkmcnt(0)
v_mfma_f32_16x16x32_bf16 a[0:3], v[24:27], v[184:187], a[0:3]
v_mfma_f32_16x16x32_bf16 a[4:7], v[24:27], v[188:191], a[4:7]
v_mfma_f32_16x16x32_bf16 a[8:11], v[24:27], v[192:195], a[8:11]
v_mfma_f32_16x16x32_bf16 a[12:15], v[24:27], v[196:199], a[12:15]
ds_read_b128 v[200:203], v1 offset:17408
buffer_load_dwordx4 v[24:27], v1, s[4:7], s30 offen offset:0
v_mfma_f32_16x16x32_bf16 a[16:19], v[28:31], v[184:187], a[16:19]
v_mfma_f32_16x16x32_bf16 a[20:23], v[28:31], v[188:191], a[20:23]
v_mfma_f32_16x16x32_bf16 a[24:27], v[28:31], v[192:195], a[24:27]
v_mfma_f32_16x16x32_bf16 a[28:31], v[28:31], v[196:199], a[28:31]
ds_read_b128 v[204:207], v1 offset:41984
buffer_load_dwordx4 v[28:31], v1, s[4:7], s31 offen offset:0
v_mfma_f32_16x16x32_bf16 a[32:35], v[32:35], v[184:187], a[32:35]
v_mfma_f32_16x16x32_bf16 a[36:39], v[32:35], v[188:191], a[36:39]
v_mfma_f32_16x16x32_bf16 a[40:43], v[32:35], v[192:195], a[40:43]
v_mfma_f32_16x16x32_bf16 a[44:47], v[32:35], v[196:199], a[44:47]
ds_read_b128 v[208:211], v6 offset:17408
buffer_load_dwordx4 v[32:35], v1, s[4:7], s32 offen offset:0
v_mfma_f32_16x16x32_bf16 a[48:51], v[36:39], v[184:187], a[48:51]
v_mfma_f32_16x16x32_bf16 a[52:55], v[36:39], v[188:191], a[52:55]
v_mfma_f32_16x16x32_bf16 a[56:59], v[36:39], v[192:195], a[56:59]
v_mfma_f32_16x16x32_bf16 a[60:63], v[36:39], v[196:199], a[60:63]
ds_read_b128 v[212:215], v6 offset:41984
buffer_load_dwordx4 v[36:39], v1, s[4:7], s33 offen offset:0
v_mfma_f32_16x16x32_bf16 a[64:67], v[40:43], v[184:187], a[64:67]
v_mfma_f32_16x16x32_bf16 a[68:71], v[40:43], v[188:191], a[68:71]
v_mfma_f32_16x16x32_bf16 a[72:75], v[40:43], v[192:195], a[72:75]
v_mfma_f32_16x16x32_bf16 a[76:79], v[40:43], v[196:199], a[76:79]
buffer_load_dwordx4 v[40:43], v1, s[4:7], s34 offen offset:0
v_mfma_f32_16x16x32_bf16 a[80:83], v[44:47], v[184:187], a[80:83]
v_mfma_f32_16x16x32_bf16 a[84:87], v[44:47], v[188:191], a[84:87]
v_mfma_f32_16x16x32_bf16 a[88:91], v[44:47], v[192:195], a[88:91]
v_mfma_f32_16x16x32_bf16 a[92:95], v[44:47], v[196:199], a[92:95]
buffer_load_dwordx4 v[44:47], v1, s[4:7], s35 offen offset:0
v_mfma_f32_16x16x32_bf16 a[96:99], v[48:51], v[184:187], a[96:99]
v_mfma_f32_16x16x32_bf16 a[100:103], v[48:51], v[188:191], a[100:103]
v_mfma_f32_16x16x32_bf16 a[104:107], v[48:51], v[192:195], a[104:107]
v_mfma_f32_16x16x32_bf16 a[108:111], v[48:51], v[196:199], a[108:111]
buffer_load_dwordx4 v[48:51], v1, s[4:7], s36 offen offset:0
v_mfma_f32_16x16x32_bf16 a[112:115], v[52:55], v[184:187], a[112:115]
v_mfma_f32_16x16x32_bf16 a[116:119], v[52:55], v[188:191], a[116:119]
v_mfma_f32_16x16x32_bf16 a[120:123], v[52:55], v[192:195], a[120:123]
v_mfma_f32_16x16x32_bf16 a[124:127], v[52:55], v[196:199], a[124:127]
buffer_load_dwordx4 v[52:55], v1, s[4:7], s37 offen offset:0
v_mfma_f32_16x16x32_bf16 a[128:131], v[56:59], v[184:187], a[128:131]
v_mfma_f32_16x16x32_bf16 a[132:135], v[56:59], v[188:191], a[132:135]
v_mfma_f32_16x16x32_bf16 a[136:139], v[56:59], v[192:195], a[136:139]
v_mfma_f32_16x16x32_bf16 a[140:143], v[56:59], v[196:199], a[140:143]
buffer_load_dwordx4 v[56:59], v1, s[4:7], s38 offen offset:0
v_mfma_f32_16x16x32_bf16 a[144:147], v[60:63], v[184:187], a[144:147]
v_mfma_f32_16x16x32_bf16 a[148:151], v[60:63], v[188:191], a[148:151]
v_mfma_f32_16x16x32_bf16 a[152:155], v[60:63], v[192:195], a[152:155]
v_mfma_f32_16x16x32_bf16 a[156:159], v[60:63], v[196:199], a[156:159]
buffer_load_dwordx4 v[60:63], v1, s[4:7], s39 offen offset:0
s_barrier
s_waitcnt vmcnt(30)
s_waitcnt lgkmcnt(0)
v_mfma_f32_16x16x32_bf16 a[0:3], v[64:67], v[200:203], a[0:3]
v_mfma_f32_16x16x32_bf16 a[4:7], v[64:67], v[204:207], a[4:7]
v_mfma_f32_16x16x32_bf16 a[8:11], v[64:67], v[208:211], a[8:11]
v_mfma_f32_16x16x32_bf16 a[12:15], v[64:67], v[212:215], a[12:15]
ds_read_b128 v[184:187], v1 offset:18432
buffer_load_dwordx4 v[64:67], v1, s[4:7], s30 offen offset:1024
v_mfma_f32_16x16x32_bf16 a[16:19], v[68:71], v[200:203], a[16:19]
v_mfma_f32_16x16x32_bf16 a[20:23], v[68:71], v[204:207], a[20:23]
v_mfma_f32_16x16x32_bf16 a[24:27], v[68:71], v[208:211], a[24:27]
v_mfma_f32_16x16x32_bf16 a[28:31], v[68:71], v[212:215], a[28:31]
ds_read_b128 v[188:191], v1 offset:43008
buffer_load_dwordx4 v[68:71], v1, s[4:7], s31 offen offset:1024
v_mfma_f32_16x16x32_bf16 a[32:35], v[72:75], v[200:203], a[32:35]
v_mfma_f32_16x16x32_bf16 a[36:39], v[72:75], v[204:207], a[36:39]
v_mfma_f32_16x16x32_bf16 a[40:43], v[72:75], v[208:211], a[40:43]
v_mfma_f32_16x16x32_bf16 a[44:47], v[72:75], v[212:215], a[44:47]
ds_read_b128 v[192:195], v6 offset:18432
buffer_load_dwordx4 v[72:75], v1, s[4:7], s32 offen offset:1024
v_mfma_f32_16x16x32_bf16 a[48:51], v[76:79], v[200:203], a[48:51]
v_mfma_f32_16x16x32_bf16 a[52:55], v[76:79], v[204:207], a[52:55]
v_mfma_f32_16x16x32_bf16 a[56:59], v[76:79], v[208:211], a[56:59]
v_mfma_f32_16x16x32_bf16 a[60:63], v[76:79], v[212:215], a[60:63]
ds_read_b128 v[196:199], v6 offset:43008
buffer_load_dwordx4 v[76:79], v1, s[4:7], s33 offen offset:1024
v_mfma_f32_16x16x32_bf16 a[64:67], v[80:83], v[200:203], a[64:67]
v_mfma_f32_16x16x32_bf16 a[68:71], v[80:83], v[204:207], a[68:71]
v_mfma_f32_16x16x32_bf16 a[72:75], v[80:83], v[208:211], a[72:75]
v_mfma_f32_16x16x32_bf16 a[76:79], v[80:83], v[212:215], a[76:79]
buffer_load_dwordx4 v[80:83], v1, s[4:7], s34 offen offset:1024
v_mfma_f32_16x16x32_bf16 a[80:83], v[84:87], v[200:203], a[80:83]
v_mfma_f32_16x16x32_bf16 a[84:87], v[84:87], v[204:207], a[84:87]
v_mfma_f32_16x16x32_bf16 a[88:91], v[84:87], v[208:211], a[88:91]
v_mfma_f32_16x16x32_bf16 a[92:95], v[84:87], v[212:215], a[92:95]
buffer_load_dwordx4 v[84:87], v1, s[4:7], s35 offen offset:1024
v_mfma_f32_16x16x32_bf16 a[96:99], v[88:91], v[200:203], a[96:99]
v_mfma_f32_16x16x32_bf16 a[100:103], v[88:91], v[204:207], a[100:103]
v_mfma_f32_16x16x32_bf16 a[104:107], v[88:91], v[208:211], a[104:107]
v_mfma_f32_16x16x32_bf16 a[108:111], v[88:91], v[212:215], a[108:111]
buffer_load_dwordx4 v[88:91], v1, s[4:7], s36 offen offset:1024
v_mfma_f32_16x16x32_bf16 a[112:115], v[92:95], v[200:203], a[112:115]
v_mfma_f32_16x16x32_bf16 a[116:119], v[92:95], v[204:207], a[116:119]
v_mfma_f32_16x16x32_bf16 a[120:123], v[92:95], v[208:211], a[120:123]
v_mfma_f32_16x16x32_bf16 a[124:127], v[92:95], v[212:215], a[124:127]
buffer_load_dwordx4 v[92:95], v1, s[4:7], s37 offen offset:1024
v_mfma_f32_16x16x32_bf16 a[128:131], v[96:99], v[200:203], a[128:131]
v_mfma_f32_16x16x32_bf16 a[132:135], v[96:99], v[204:207], a[132:135]
v_mfma_f32_16x16x32_bf16 a[136:139], v[96:99], v[208:211], a[136:139]
v_mfma_f32_16x16x32_bf16 a[140:143], v[96:99], v[212:215], a[140:143]
buffer_load_dwordx4 v[96:99], v1, s[4:7], s38 offen offset:1024
v_mfma_f32_16x16x32_bf16 a[144:147], v[100:103], v[200:203], a[144:147]
v_mfma_f32_16x16x32_bf16 a[148:151], v[100:103], v[204:207], a[148:151]
v_mfma_f32_16x16x32_bf16 a[152:155], v[100:103], v[208:211], a[152:155]
v_mfma_f32_16x16x32_bf16 a[156:159], v[100:103], v[212:215], a[156:159]
buffer_load_dwordx4 v[100:103], v1, s[4:7], s39 offen offset:1024
s_waitcnt vmcnt(30)
s_waitcnt lgkmcnt(0)
v_mfma_f32_16x16x32_bf16 a[0:3], v[104:107], v[184:187], a[0:3]
v_mfma_f32_16x16x32_bf16 a[4:7], v[104:107], v[188:191], a[4:7]
v_mfma_f32_16x16x32_bf16 a[8:11], v[104:107], v[192:195], a[8:11]
v_mfma_f32_16x16x32_bf16 a[12:15], v[104:107], v[196:199], a[12:15]
ds_read_b128 v[200:203], v1 offset:19456
buffer_load_dwordx4 v[104:107], v1, s[4:7], s30 offen offset:2048
v_mfma_f32_16x16x32_bf16 a[16:19], v[108:111], v[184:187], a[16:19]
v_mfma_f32_16x16x32_bf16 a[20:23], v[108:111], v[188:191], a[20:23]
v_mfma_f32_16x16x32_bf16 a[24:27], v[108:111], v[192:195], a[24:27]
v_mfma_f32_16x16x32_bf16 a[28:31], v[108:111], v[196:199], a[28:31]
ds_read_b128 v[204:207], v1 offset:44032
buffer_load_dwordx4 v[108:111], v1, s[4:7], s31 offen offset:2048
v_mfma_f32_16x16x32_bf16 a[32:35], v[112:115], v[184:187], a[32:35]
v_mfma_f32_16x16x32_bf16 a[36:39], v[112:115], v[188:191], a[36:39]
v_mfma_f32_16x16x32_bf16 a[40:43], v[112:115], v[192:195], a[40:43]
v_mfma_f32_16x16x32_bf16 a[44:47], v[112:115], v[196:199], a[44:47]
ds_read_b128 v[208:211], v6 offset:19456
buffer_load_dwordx4 v[112:115], v1, s[4:7], s32 offen offset:2048
v_mfma_f32_16x16x32_bf16 a[48:51], v[116:119], v[184:187], a[48:51]
v_mfma_f32_16x16x32_bf16 a[52:55], v[116:119], v[188:191], a[52:55]
v_mfma_f32_16x16x32_bf16 a[56:59], v[116:119], v[192:195], a[56:59]
v_mfma_f32_16x16x32_bf16 a[60:63], v[116:119], v[196:199], a[60:63]
ds_read_b128 v[212:215], v6 offset:44032
buffer_load_dwordx4 v[116:119], v1, s[4:7], s33 offen offset:2048
v_mfma_f32_16x16x32_bf16 a[64:67], v[120:123], v[184:187], a[64:67]
v_mfma_f32_16x16x32_bf16 a[68:71], v[120:123], v[188:191], a[68:71]
v_mfma_f32_16x16x32_bf16 a[72:75], v[120:123], v[192:195], a[72:75]
v_mfma_f32_16x16x32_bf16 a[76:79], v[120:123], v[196:199], a[76:79]
buffer_load_dwordx4 v[120:123], v1, s[4:7], s34 offen offset:2048
v_mfma_f32_16x16x32_bf16 a[80:83], v[124:127], v[184:187], a[80:83]
v_mfma_f32_16x16x32_bf16 a[84:87], v[124:127], v[188:191], a[84:87]
v_mfma_f32_16x16x32_bf16 a[88:91], v[124:127], v[192:195], a[88:91]
v_mfma_f32_16x16x32_bf16 a[92:95], v[124:127], v[196:199], a[92:95]
buffer_load_dwordx4 v[124:127], v1, s[4:7], s35 offen offset:2048
v_mfma_f32_16x16x32_bf16 a[96:99], v[128:131], v[184:187], a[96:99]
v_mfma_f32_16x16x32_bf16 a[100:103], v[128:131], v[188:191], a[100:103]
v_mfma_f32_16x16x32_bf16 a[104:107], v[128:131], v[192:195], a[104:107]
v_mfma_f32_16x16x32_bf16 a[108:111], v[128:131], v[196:199], a[108:111]
buffer_load_dwordx4 v[128:131], v1, s[4:7], s36 offen offset:2048
v_mfma_f32_16x16x32_bf16 a[112:115], v[132:135], v[184:187], a[112:115]
v_mfma_f32_16x16x32_bf16 a[116:119], v[132:135], v[188:191], a[116:119]
v_mfma_f32_16x16x32_bf16 a[120:123], v[132:135], v[192:195], a[120:123]
v_mfma_f32_16x16x32_bf16 a[124:127], v[132:135], v[196:199], a[124:127]
buffer_load_dwordx4 v[132:135], v1, s[4:7], s37 offen offset:2048
v_mfma_f32_16x16x32_bf16 a[128:131], v[136:139], v[184:187], a[128:131]
v_mfma_f32_16x16x32_bf16 a[132:135], v[136:139], v[188:191], a[132:135]
v_mfma_f32_16x16x32_bf16 a[136:139], v[136:139], v[192:195], a[136:139]
v_mfma_f32_16x16x32_bf16 a[140:143], v[136:139], v[196:199], a[140:143]
buffer_load_dwordx4 v[136:139], v1, s[4:7], s38 offen offset:2048
v_mfma_f32_16x16x32_bf16 a[144:147], v[140:143], v[184:187], a[144:147]
v_mfma_f32_16x16x32_bf16 a[148:151], v[140:143], v[188:191], a[148:151]
v_mfma_f32_16x16x32_bf16 a[152:155], v[140:143], v[192:195], a[152:155]
v_mfma_f32_16x16x32_bf16 a[156:159], v[140:143], v[196:199], a[156:159]
buffer_load_dwordx4 v[140:143], v1, s[4:7], s39 offen offset:2048
s_waitcnt vmcnt(30)
s_waitcnt lgkmcnt(0)
v_mfma_f32_16x16x32_bf16 a[0:3], v[144:147], v[200:203], a[0:3]
v_mfma_f32_16x16x32_bf16 a[4:7], v[144:147], v[204:207], a[4:7]
v_mfma_f32_16x16x32_bf16 a[8:11], v[144:147], v[208:211], a[8:11]
v_mfma_f32_16x16x32_bf16 a[12:15], v[144:147], v[212:215], a[12:15]
ds_read_b128 v[184:187], v1 offset:20480
buffer_load_dwordx4 v[144:147], v1, s[4:7], s30 offen offset:3072
s_add_u32 s30, s30, 4096
v_mfma_f32_16x16x32_bf16 a[16:19], v[148:151], v[200:203], a[16:19]
v_mfma_f32_16x16x32_bf16 a[20:23], v[148:151], v[204:207], a[20:23]
v_mfma_f32_16x16x32_bf16 a[24:27], v[148:151], v[208:211], a[24:27]
v_mfma_f32_16x16x32_bf16 a[28:31], v[148:151], v[212:215], a[28:31]
ds_read_b128 v[188:191], v1 offset:45056
buffer_load_dwordx4 v[148:151], v1, s[4:7], s31 offen offset:3072
s_add_u32 s31, s31, 4096
v_mfma_f32_16x16x32_bf16 a[32:35], v[152:155], v[200:203], a[32:35]
v_mfma_f32_16x16x32_bf16 a[36:39], v[152:155], v[204:207], a[36:39]
v_mfma_f32_16x16x32_bf16 a[40:43], v[152:155], v[208:211], a[40:43]
v_mfma_f32_16x16x32_bf16 a[44:47], v[152:155], v[212:215], a[44:47]
ds_read_b128 v[192:195], v6 offset:20480
buffer_load_dwordx4 v[152:155], v1, s[4:7], s32 offen offset:3072
s_add_u32 s32, s32, 4096
v_mfma_f32_16x16x32_bf16 a[48:51], v[156:159], v[200:203], a[48:51]
v_mfma_f32_16x16x32_bf16 a[52:55], v[156:159], v[204:207], a[52:55]
v_mfma_f32_16x16x32_bf16 a[56:59], v[156:159], v[208:211], a[56:59]
v_mfma_f32_16x16x32_bf16 a[60:63], v[156:159], v[212:215], a[60:63]
ds_read_b128 v[196:199], v6 offset:45056
buffer_load_dwordx4 v[156:159], v1, s[4:7], s33 offen offset:3072
s_add_u32 s33, s33, 4096
v_mfma_f32_16x16x32_bf16 a[64:67], v[160:163], v[200:203], a[64:67]
v_mfma_f32_16x16x32_bf16 a[68:71], v[160:163], v[204:207], a[68:71]
v_mfma_f32_16x16x32_bf16 a[72:75], v[160:163], v[208:211], a[72:75]
v_mfma_f32_16x16x32_bf16 a[76:79], v[160:163], v[212:215], a[76:79]
buffer_load_dwordx4 v[160:163], v1, s[4:7], s34 offen offset:3072
s_add_u32 s34, s34, 4096
v_mfma_f32_16x16x32_bf16 a[80:83], v[164:167], v[200:203], a[80:83]
v_mfma_f32_16x16x32_bf16 a[84:87], v[164:167], v[204:207], a[84:87]
v_mfma_f32_16x16x32_bf16 a[88:91], v[164:167], v[208:211], a[88:91]
v_mfma_f32_16x16x32_bf16 a[92:95], v[164:167], v[212:215], a[92:95]
buffer_load_dwordx4 v[164:167], v1, s[4:7], s35 offen offset:3072
s_add_u32 s35, s35, 4096
v_mfma_f32_16x16x32_bf16 a[96:99], v[168:171], v[200:203], a[96:99]
v_mfma_f32_16x16x32_bf16 a[100:103], v[168:171], v[204:207], a[100:103]
v_mfma_f32_16x16x32_bf16 a[104:107], v[168:171], v[208:211], a[104:107]
v_mfma_f32_16x16x32_bf16 a[108:111], v[168:171], v[212:215], a[108:111]
buffer_load_dwordx4 v[168:171], v1, s[4:7], s36 offen offset:3072
s_add_u32 s36, s36, 4096
v_mfma_f32_16x16x32_bf16 a[112:115], v[172:175], v[200:203], a[112:115]
v_mfma_f32_16x16x32_bf16 a[116:119], v[172:175], v[204:207], a[116:119]
v_mfma_f32_16x16x32_bf16 a[120:123], v[172:175], v[208:211], a[120:123]
v_mfma_f32_16x16x32_bf16 a[124:127], v[172:175], v[212:215], a[124:127]
buffer_load_dwordx4 v[172:175], v1, s[4:7], s37 offen offset:3072
s_add_u32 s37, s37, 4096
v_mfma_f32_16x16x32_bf16 a[128:131], v[176:179], v[200:203], a[128:131]
v_mfma_f32_16x16x32_bf16 a[132:135], v[176:179], v[204:207], a[132:135]
v_mfma_f32_16x16x32_bf16 a[136:139], v[176:179], v[208:211], a[136:139]
v_mfma_f32_16x16x32_bf16 a[140:143], v[176:179], v[212:215], a[140:143]
buffer_load_dwordx4 v[176:179], v1, s[4:7], s38 offen offset:3072
s_add_u32 s38, s38, 4096
v_mfma_f32_16x16x32_bf16 a[144:147], v[180:183], v[200:203], a[144:147]
v_mfma_f32_16x16x32_bf16 a[148:151], v[180:183], v[204:207], a[148:151]
v_mfma_f32_16x16x32_bf16 a[152:155], v[180:183], v[208:211], a[152:155]
v_mfma_f32_16x16x32_bf16 a[156:159], v[180:183], v[212:215], a[156:159]
buffer_load_dwordx4 v[180:183], v1, s[4:7], s39 offen offset:3072
s_add_u32 s39, s39, 4096
s_waitcnt vmcnt(30)
s_waitcnt lgkmcnt(0)
v_mfma_f32_16x16x32_bf16 a[0:3], v[24:27], v[184:187], a[0:3]
v_mfma_f32_16x16x32_bf16 a[4:7], v[24:27], v[188:191], a[4:7]
v_mfma_f32_16x16x32_bf16 a[8:11], v[24:27], v[192:195], a[8:11]
v_mfma_f32_16x16x32_bf16 a[12:15], v[24:27], v[196:199], a[12:15]
ds_read_b128 v[200:203], v1 offset:21504
v_mfma_f32_16x16x32_bf16 a[16:19], v[28:31], v[184:187], a[16:19]
v_mfma_f32_16x16x32_bf16 a[20:23], v[28:31], v[188:191], a[20:23]
v_mfma_f32_16x16x32_bf16 a[24:27], v[28:31], v[192:195], a[24:27]
v_mfma_f32_16x16x32_bf16 a[28:31], v[28:31], v[196:199], a[28:31]
ds_read_b128 v[204:207], v1 offset:46080
v_mfma_f32_16x16x32_bf16 a[32:35], v[32:35], v[184:187], a[32:35]
v_mfma_f32_16x16x32_bf16 a[36:39], v[32:35], v[188:191], a[36:39]
v_mfma_f32_16x16x32_bf16 a[40:43], v[32:35], v[192:195], a[40:43]
v_mfma_f32_16x16x32_bf16 a[44:47], v[32:35], v[196:199], a[44:47]
ds_read_b128 v[208:211], v6 offset:21504
v_mfma_f32_16x16x32_bf16 a[48:51], v[36:39], v[184:187], a[48:51]
v_mfma_f32_16x16x32_bf16 a[52:55], v[36:39], v[188:191], a[52:55]
v_mfma_f32_16x16x32_bf16 a[56:59], v[36:39], v[192:195], a[56:59]
v_mfma_f32_16x16x32_bf16 a[60:63], v[36:39], v[196:199], a[60:63]
ds_read_b128 v[212:215], v6 offset:46080
v_mfma_f32_16x16x32_bf16 a[64:67], v[40:43], v[184:187], a[64:67]
v_mfma_f32_16x16x32_bf16 a[68:71], v[40:43], v[188:191], a[68:71]
v_mfma_f32_16x16x32_bf16 a[72:75], v[40:43], v[192:195], a[72:75]
v_mfma_f32_16x16x32_bf16 a[76:79], v[40:43], v[196:199], a[76:79]
v_mfma_f32_16x16x32_bf16 a[80:83], v[44:47], v[184:187], a[80:83]
v_mfma_f32_16x16x32_bf16 a[84:87], v[44:47], v[188:191], a[84:87]
v_mfma_f32_16x16x32_bf16 a[88:91], v[44:47], v[192:195], a[88:91]
v_mfma_f32_16x16x32_bf16 a[92:95], v[44:47], v[196:199], a[92:95]
v_mfma_f32_16x16x32_bf16 a[96:99], v[48:51], v[184:187], a[96:99]
v_mfma_f32_16x16x32_bf16 a[100:103], v[48:51], v[188:191], a[100:103]
v_mfma_f32_16x16x32_bf16 a[104:107], v[48:51], v[192:195], a[104:107]
v_mfma_f32_16x16x32_bf16 a[108:111], v[48:51], v[196:199], a[108:111]
v_mfma_f32_16x16x32_bf16 a[112:115], v[52:55], v[184:187], a[112:115]
v_mfma_f32_16x16x32_bf16 a[116:119], v[52:55], v[188:191], a[116:119]
v_mfma_f32_16x16x32_bf16 a[120:123], v[52:55], v[192:195], a[120:123]
v_mfma_f32_16x16x32_bf16 a[124:127], v[52:55], v[196:199], a[124:127]
v_mfma_f32_16x16x32_bf16 a[128:131], v[56:59], v[184:187], a[128:131]
v_mfma_f32_16x16x32_bf16 a[132:135], v[56:59], v[188:191], a[132:135]
v_mfma_f32_16x16x32_bf16 a[136:139], v[56:59], v[192:195], a[136:139]
v_mfma_f32_16x16x32_bf16 a[140:143], v[56:59], v[196:199], a[140:143]
v_mfma_f32_16x16x32_bf16 a[144:147], v[60:63], v[184:187], a[144:147]
v_mfma_f32_16x16x32_bf16 a[148:151], v[60:63], v[188:191], a[148:151]
v_mfma_f32_16x16x32_bf16 a[152:155], v[60:63], v[192:195], a[152:155]
v_mfma_f32_16x16x32_bf16 a[156:159], v[60:63], v[196:199], a[156:159]
s_waitcnt vmcnt(20)
s_waitcnt lgkmcnt(0)
v_mfma_f32_16x16x32_bf16 a[0:3], v[64:67], v[200:203], a[0:3]
v_mfma_f32_16x16x32_bf16 a[4:7], v[64:67], v[204:207], a[4:7]
v_mfma_f32_16x16x32_bf16 a[8:11], v[64:67], v[208:211], a[8:11]
v_mfma_f32_16x16x32_bf16 a[12:15], v[64:67], v[212:215], a[12:15]
ds_read_b128 v[184:187], v1 offset:22528
v_mfma_f32_16x16x32_bf16 a[16:19], v[68:71], v[200:203], a[16:19]
v_mfma_f32_16x16x32_bf16 a[20:23], v[68:71], v[204:207], a[20:23]
v_mfma_f32_16x16x32_bf16 a[24:27], v[68:71], v[208:211], a[24:27]
v_mfma_f32_16x16x32_bf16 a[28:31], v[68:71], v[212:215], a[28:31]
ds_read_b128 v[188:191], v1 offset:47104
v_mfma_f32_16x16x32_bf16 a[32:35], v[72:75], v[200:203], a[32:35]
v_mfma_f32_16x16x32_bf16 a[36:39], v[72:75], v[204:207], a[36:39]
v_mfma_f32_16x16x32_bf16 a[40:43], v[72:75], v[208:211], a[40:43]
v_mfma_f32_16x16x32_bf16 a[44:47], v[72:75], v[212:215], a[44:47]
ds_read_b128 v[192:195], v6 offset:22528
v_mfma_f32_16x16x32_bf16 a[48:51], v[76:79], v[200:203], a[48:51]
v_mfma_f32_16x16x32_bf16 a[52:55], v[76:79], v[204:207], a[52:55]
v_mfma_f32_16x16x32_bf16 a[56:59], v[76:79], v[208:211], a[56:59]
v_mfma_f32_16x16x32_bf16 a[60:63], v[76:79], v[212:215], a[60:63]
ds_read_b128 v[196:199], v6 offset:47104
v_mfma_f32_16x16x32_bf16 a[64:67], v[80:83], v[200:203], a[64:67]
v_mfma_f32_16x16x32_bf16 a[68:71], v[80:83], v[204:207], a[68:71]
v_mfma_f32_16x16x32_bf16 a[72:75], v[80:83], v[208:211], a[72:75]
v_mfma_f32_16x16x32_bf16 a[76:79], v[80:83], v[212:215], a[76:79]
v_mfma_f32_16x16x32_bf16 a[80:83], v[84:87], v[200:203], a[80:83]
v_mfma_f32_16x16x32_bf16 a[84:87], v[84:87], v[204:207], a[84:87]
v_mfma_f32_16x16x32_bf16 a[88:91], v[84:87], v[208:211], a[88:91]
v_mfma_f32_16x16x32_bf16 a[92:95], v[84:87], v[212:215], a[92:95]
v_mfma_f32_16x16x32_bf16 a[96:99], v[88:91], v[200:203], a[96:99]
v_mfma_f32_16x16x32_bf16 a[100:103], v[88:91], v[204:207], a[100:103]
v_mfma_f32_16x16x32_bf16 a[104:107], v[88:91], v[208:211], a[104:107]
v_mfma_f32_16x16x32_bf16 a[108:111], v[88:91], v[212:215], a[108:111]
v_mfma_f32_16x16x32_bf16 a[112:115], v[92:95], v[200:203], a[112:115]
v_mfma_f32_16x16x32_bf16 a[116:119], v[92:95], v[204:207], a[116:119]
v_mfma_f32_16x16x32_bf16 a[120:123], v[92:95], v[208:211], a[120:123]
v_mfma_f32_16x16x32_bf16 a[124:127], v[92:95], v[212:215], a[124:127]
v_mfma_f32_16x16x32_bf16 a[128:131], v[96:99], v[200:203], a[128:131]
v_mfma_f32_16x16x32_bf16 a[132:135], v[96:99], v[204:207], a[132:135]
v_mfma_f32_16x16x32_bf16 a[136:139], v[96:99], v[208:211], a[136:139]
v_mfma_f32_16x16x32_bf16 a[140:143], v[96:99], v[212:215], a[140:143]
v_mfma_f32_16x16x32_bf16 a[144:147], v[100:103], v[200:203], a[144:147]
v_mfma_f32_16x16x32_bf16 a[148:151], v[100:103], v[204:207], a[148:151]
v_mfma_f32_16x16x32_bf16 a[152:155], v[100:103], v[208:211], a[152:155]
v_mfma_f32_16x16x32_bf16 a[156:159], v[100:103], v[212:215], a[156:159]
s_waitcnt vmcnt(10)
s_waitcnt lgkmcnt(0)
v_mfma_f32_16x16x32_bf16 a[0:3], v[104:107], v[184:187], a[0:3]
v_mfma_f32_16x16x32_bf16 a[4:7], v[104:107], v[188:191], a[4:7]
v_mfma_f32_16x16x32_bf16 a[8:11], v[104:107], v[192:195], a[8:11]
v_mfma_f32_16x16x32_bf16 a[12:15], v[104:107], v[196:199], a[12:15]
ds_read_b128 v[200:203], v1 offset:23552
v_mfma_f32_16x16x32_bf16 a[16:19], v[108:111], v[184:187], a[16:19]
v_mfma_f32_16x16x32_bf16 a[20:23], v[108:111], v[188:191], a[20:23]
v_mfma_f32_16x16x32_bf16 a[24:27], v[108:111], v[192:195], a[24:27]
v_mfma_f32_16x16x32_bf16 a[28:31], v[108:111], v[196:199], a[28:31]
ds_read_b128 v[204:207], v1 offset:48128
v_mfma_f32_16x16x32_bf16 a[32:35], v[112:115], v[184:187], a[32:35]
v_mfma_f32_16x16x32_bf16 a[36:39], v[112:115], v[188:191], a[36:39]
v_mfma_f32_16x16x32_bf16 a[40:43], v[112:115], v[192:195], a[40:43]
v_mfma_f32_16x16x32_bf16 a[44:47], v[112:115], v[196:199], a[44:47]
ds_read_b128 v[208:211], v6 offset:23552
v_mfma_f32_16x16x32_bf16 a[48:51], v[116:119], v[184:187], a[48:51]
v_mfma_f32_16x16x32_bf16 a[52:55], v[116:119], v[188:191], a[52:55]
v_mfma_f32_16x16x32_bf16 a[56:59], v[116:119], v[192:195], a[56:59]
v_mfma_f32_16x16x32_bf16 a[60:63], v[116:119], v[196:199], a[60:63]
ds_read_b128 v[212:215], v6 offset:48128
v_mfma_f32_16x16x32_bf16 a[64:67], v[120:123], v[184:187], a[64:67]
v_mfma_f32_16x16x32_bf16 a[68:71], v[120:123], v[188:191], a[68:71]
v_mfma_f32_16x16x32_bf16 a[72:75], v[120:123], v[192:195], a[72:75]
v_mfma_f32_16x16x32_bf16 a[76:79], v[120:123], v[196:199], a[76:79]
v_mfma_f32_16x16x32_bf16 a[80:83], v[124:127], v[184:187], a[80:83]
v_mfma_f32_16x16x32_bf16 a[84:87], v[124:127], v[188:191], a[84:87]
v_mfma_f32_16x16x32_bf16 a[88:91], v[124:127], v[192:195], a[88:91]
v_mfma_f32_16x16x32_bf16 a[92:95], v[124:127], v[196:199], a[92:95]
v_mfma_f32_16x16x32_bf16 a[96:99], v[128:131], v[184:187], a[96:99]
v_mfma_f32_16x16x32_bf16 a[100:103], v[128:131], v[188:191], a[100:103]
v_mfma_f32_16x16x32_bf16 a[104:107], v[128:131], v[192:195], a[104:107]
v_mfma_f32_16x16x32_bf16 a[108:111], v[128:131], v[196:199], a[108:111]
v_mfma_f32_16x16x32_bf16 a[112:115], v[132:135], v[184:187], a[112:115]
v_mfma_f32_16x16x32_bf16 a[116:119], v[132:135], v[188:191], a[116:119]
v_mfma_f32_16x16x32_bf16 a[120:123], v[132:135], v[192:195], a[120:123]
v_mfma_f32_16x16x32_bf16 a[124:127], v[132:135], v[196:199], a[124:127]
v_mfma_f32_16x16x32_bf16 a[128:131], v[136:139], v[184:187], a[128:131]
v_mfma_f32_16x16x32_bf16 a[132:135], v[136:139], v[188:191], a[132:135]
v_mfma_f32_16x16x32_bf16 a[136:139], v[136:139], v[192:195], a[136:139]
v_mfma_f32_16x16x32_bf16 a[140:143], v[136:139], v[196:199], a[140:143]
v_mfma_f32_16x16x32_bf16 a[144:147], v[140:143], v[184:187], a[144:147]
v_mfma_f32_16x16x32_bf16 a[148:151], v[140:143], v[188:191], a[148:151]
v_mfma_f32_16x16x32_bf16 a[152:155], v[140:143], v[192:195], a[152:155]
v_mfma_f32_16x16x32_bf16 a[156:159], v[140:143], v[196:199], a[156:159]
s_waitcnt vmcnt(0)
s_waitcnt lgkmcnt(0)
v_mfma_f32_16x16x32_bf16 a[0:3], v[144:147], v[200:203], a[0:3]
v_mfma_f32_16x16x32_bf16 a[4:7], v[144:147], v[204:207], a[4:7]
v_mfma_f32_16x16x32_bf16 a[8:11], v[144:147], v[208:211], a[8:11]
v_mfma_f32_16x16x32_bf16 a[12:15], v[144:147], v[212:215], a[12:15]
v_mfma_f32_16x16x32_bf16 a[16:19], v[148:151], v[200:203], a[16:19]
v_mfma_f32_16x16x32_bf16 a[20:23], v[148:151], v[204:207], a[20:23]
v_mfma_f32_16x16x32_bf16 a[24:27], v[148:151], v[208:211], a[24:27]
v_mfma_f32_16x16x32_bf16 a[28:31], v[148:151], v[212:215], a[28:31]
v_mfma_f32_16x16x32_bf16 a[32:35], v[152:155], v[200:203], a[32:35]
v_mfma_f32_16x16x32_bf16 a[36:39], v[152:155], v[204:207], a[36:39]
v_mfma_f32_16x16x32_bf16 a[40:43], v[152:155], v[208:211], a[40:43]
v_mfma_f32_16x16x32_bf16 a[44:47], v[152:155], v[212:215], a[44:47]
v_mfma_f32_16x16x32_bf16 a[48:51], v[156:159], v[200:203], a[48:51]
v_mfma_f32_16x16x32_bf16 a[52:55], v[156:159], v[204:207], a[52:55]
v_mfma_f32_16x16x32_bf16 a[56:59], v[156:159], v[208:211], a[56:59]
v_mfma_f32_16x16x32_bf16 a[60:63], v[156:159], v[212:215], a[60:63]
v_mfma_f32_16x16x32_bf16 a[64:67], v[160:163], v[200:203], a[64:67]
v_mfma_f32_16x16x32_bf16 a[68:71], v[160:163], v[204:207], a[68:71]
v_mfma_f32_16x16x32_bf16 a[72:75], v[160:163], v[208:211], a[72:75]
v_mfma_f32_16x16x32_bf16 a[76:79], v[160:163], v[212:215], a[76:79]
v_mfma_f32_16x16x32_bf16 a[80:83], v[164:167], v[200:203], a[80:83]
v_mfma_f32_16x16x32_bf16 a[84:87], v[164:167], v[204:207], a[84:87]
v_mfma_f32_16x16x32_bf16 a[88:91], v[164:167], v[208:211], a[88:91]
v_mfma_f32_16x16x32_bf16 a[92:95], v[164:167], v[212:215], a[92:95]
v_mfma_f32_16x16x32_bf16 a[96:99], v[168:171], v[200:203], a[96:99]
v_mfma_f32_16x16x32_bf16 a[100:103], v[168:171], v[204:207], a[100:103]
v_mfma_f32_16x16x32_bf16 a[104:107], v[168:171], v[208:211], a[104:107]
v_mfma_f32_16x16x32_bf16 a[108:111], v[168:171], v[212:215], a[108:111]
v_mfma_f32_16x16x32_bf16 a[112:115], v[172:175], v[200:203], a[112:115]
v_mfma_f32_16x16x32_bf16 a[116:119], v[172:175], v[204:207], a[116:119]
v_mfma_f32_16x16x32_bf16 a[120:123], v[172:175], v[208:211], a[120:123]
v_mfma_f32_16x16x32_bf16 a[124:127], v[172:175], v[212:215], a[124:127]
v_mfma_f32_16x16x32_bf16 a[128:131], v[176:179], v[200:203], a[128:131]
v_mfma_f32_16x16x32_bf16 a[132:135], v[176:179], v[204:207], a[132:135]
v_mfma_f32_16x16x32_bf16 a[136:139], v[176:179], v[208:211], a[136:139]
v_mfma_f32_16x16x32_bf16 a[140:143], v[176:179], v[212:215], a[140:143]
v_mfma_f32_16x16x32_bf16 a[144:147], v[180:183], v[200:203], a[144:147]
v_mfma_f32_16x16x32_bf16 a[148:151], v[180:183], v[204:207], a[148:151]
v_mfma_f32_16x16x32_bf16 a[152:155], v[180:183], v[208:211], a[152:155]
v_mfma_f32_16x16x32_bf16 a[156:159], v[180:183], v[212:215], a[156:159]
fin_store4:
s_lshl_b32 s16, s13, 7
s_lshl_b32 s17, s14, 2
s_add_u32 s16, s16, s17
s_mul_i32 s16, s16, 20
s_mul_i32 s17, s12, 5
s_add_u32 s16, s16, s17
s_lshl_b32 s16, s16, 10
s_add_u32 s16, s16, 90832896
s_nop 7
s_add_u32 s17, s16, 0
v_accvgpr_read_b32 v24, a0
v_accvgpr_read_b32 v25, a1
v_accvgpr_read_b32 v26, a2
v_accvgpr_read_b32 v27, a3
v_accvgpr_read_b32 v28, a16
v_accvgpr_read_b32 v29, a17
v_accvgpr_read_b32 v30, a18
v_accvgpr_read_b32 v31, a19
v_cvt_pk_bf16_f32 v32, v24, v25
v_cvt_pk_bf16_f32 v33, v26, v27
v_cvt_pk_bf16_f32 v34, v28, v29
v_cvt_pk_bf16_f32 v35, v30, v31
buffer_store_dwordx4 v[32:35], v1, s[4:7], s17 offen offset:0 sc1
v_accvgpr_read_b32 v36, a32
v_accvgpr_read_b32 v37, a33
v_accvgpr_read_b32 v38, a34
v_accvgpr_read_b32 v39, a35
v_accvgpr_read_b32 v40, a48
v_accvgpr_read_b32 v41, a49
v_accvgpr_read_b32 v42, a50
v_accvgpr_read_b32 v43, a51
v_cvt_pk_bf16_f32 v44, v36, v37
v_cvt_pk_bf16_f32 v45, v38, v39
v_cvt_pk_bf16_f32 v46, v40, v41
v_cvt_pk_bf16_f32 v47, v42, v43
buffer_store_dwordx4 v[44:47], v1, s[4:7], s17 offen offset:1024 sc1
v_accvgpr_read_b32 v48, a64
v_accvgpr_read_b32 v49, a65
v_accvgpr_read_b32 v50, a66
v_accvgpr_read_b32 v51, a67
v_accvgpr_read_b32 v52, a80
v_accvgpr_read_b32 v53, a81
v_accvgpr_read_b32 v54, a82
v_accvgpr_read_b32 v55, a83
v_cvt_pk_bf16_f32 v56, v48, v49
v_cvt_pk_bf16_f32 v57, v50, v51
v_cvt_pk_bf16_f32 v58, v52, v53
v_cvt_pk_bf16_f32 v59, v54, v55
buffer_store_dwordx4 v[56:59], v1, s[4:7], s17 offen offset:2048 sc1
v_accvgpr_read_b32 v60, a96
v_accvgpr_read_b32 v61, a97
v_accvgpr_read_b32 v62, a98
v_accvgpr_read_b32 v63, a99
v_accvgpr_read_b32 v64, a112
v_accvgpr_read_b32 v65, a113
v_accvgpr_read_b32 v66, a114
v_accvgpr_read_b32 v67, a115
v_cvt_pk_bf16_f32 v68, v60, v61
v_cvt_pk_bf16_f32 v69, v62, v63
v_cvt_pk_bf16_f32 v70, v64, v65
v_cvt_pk_bf16_f32 v71, v66, v67
buffer_store_dwordx4 v[68:71], v1, s[4:7], s17 offen offset:3072 sc1
v_accvgpr_read_b32 v24, a128
v_accvgpr_read_b32 v25, a129
v_accvgpr_read_b32 v26, a130
v_accvgpr_read_b32 v27, a131
v_accvgpr_read_b32 v28, a144
v_accvgpr_read_b32 v29, a145
v_accvgpr_read_b32 v30, a146
v_accvgpr_read_b32 v31, a147
v_cvt_pk_bf16_f32 v32, v24, v25
v_cvt_pk_bf16_f32 v33, v26, v27
v_cvt_pk_bf16_f32 v34, v28, v29
v_cvt_pk_bf16_f32 v35, v30, v31
s_add_u32 s17, s17, 4096
buffer_store_dwordx4 v[32:35], v1, s[4:7], s17 offen offset:0 sc1
s_add_u32 s17, s16, 20480
v_accvgpr_read_b32 v36, a4
v_accvgpr_read_b32 v37, a5
v_accvgpr_read_b32 v38, a6
v_accvgpr_read_b32 v39, a7
v_accvgpr_read_b32 v40, a20
v_accvgpr_read_b32 v41, a21
v_accvgpr_read_b32 v42, a22
v_accvgpr_read_b32 v43, a23
v_cvt_pk_bf16_f32 v44, v36, v37
v_cvt_pk_bf16_f32 v45, v38, v39
v_cvt_pk_bf16_f32 v46, v40, v41
v_cvt_pk_bf16_f32 v47, v42, v43
buffer_store_dwordx4 v[44:47], v1, s[4:7], s17 offen offset:0 sc1
v_accvgpr_read_b32 v48, a36
v_accvgpr_read_b32 v49, a37
v_accvgpr_read_b32 v50, a38
v_accvgpr_read_b32 v51, a39
v_accvgpr_read_b32 v52, a52
v_accvgpr_read_b32 v53, a53
v_accvgpr_read_b32 v54, a54
v_accvgpr_read_b32 v55, a55
v_cvt_pk_bf16_f32 v56, v48, v49
v_cvt_pk_bf16_f32 v57, v50, v51
v_cvt_pk_bf16_f32 v58, v52, v53
v_cvt_pk_bf16_f32 v59, v54, v55
buffer_store_dwordx4 v[56:59], v1, s[4:7], s17 offen offset:1024 sc1
v_accvgpr_read_b32 v60, a68
v_accvgpr_read_b32 v61, a69
v_accvgpr_read_b32 v62, a70
v_accvgpr_read_b32 v63, a71
v_accvgpr_read_b32 v64, a84
v_accvgpr_read_b32 v65, a85
v_accvgpr_read_b32 v66, a86
v_accvgpr_read_b32 v67, a87
v_cvt_pk_bf16_f32 v68, v60, v61
v_cvt_pk_bf16_f32 v69, v62, v63
v_cvt_pk_bf16_f32 v70, v64, v65
v_cvt_pk_bf16_f32 v71, v66, v67
buffer_store_dwordx4 v[68:71], v1, s[4:7], s17 offen offset:2048 sc1
v_accvgpr_read_b32 v24, a100
v_accvgpr_read_b32 v25, a101
v_accvgpr_read_b32 v26, a102
v_accvgpr_read_b32 v27, a103
v_accvgpr_read_b32 v28, a116
v_accvgpr_read_b32 v29, a117
v_accvgpr_read_b32 v30, a118
v_accvgpr_read_b32 v31, a119
v_cvt_pk_bf16_f32 v32, v24, v25
v_cvt_pk_bf16_f32 v33, v26, v27
v_cvt_pk_bf16_f32 v34, v28, v29
v_cvt_pk_bf16_f32 v35, v30, v31
buffer_store_dwordx4 v[32:35], v1, s[4:7], s17 offen offset:3072 sc1
v_accvgpr_read_b32 v36, a132
v_accvgpr_read_b32 v37, a133
v_accvgpr_read_b32 v38, a134
v_accvgpr_read_b32 v39, a135
v_accvgpr_read_b32 v40, a148
v_accvgpr_read_b32 v41, a149
v_accvgpr_read_b32 v42, a150
v_accvgpr_read_b32 v43, a151
v_cvt_pk_bf16_f32 v44, v36, v37
v_cvt_pk_bf16_f32 v45, v38, v39
v_cvt_pk_bf16_f32 v46, v40, v41
v_cvt_pk_bf16_f32 v47, v42, v43
s_add_u32 s17, s17, 4096
buffer_store_dwordx4 v[44:47], v1, s[4:7], s17 offen offset:0 sc1
s_add_u32 s17, s16, 40960
v_accvgpr_read_b32 v48, a8
v_accvgpr_read_b32 v49, a9
v_accvgpr_read_b32 v50, a10
v_accvgpr_read_b32 v51, a11
v_accvgpr_read_b32 v52, a24
v_accvgpr_read_b32 v53, a25
v_accvgpr_read_b32 v54, a26
v_accvgpr_read_b32 v55, a27
v_cvt_pk_bf16_f32 v56, v48, v49
v_cvt_pk_bf16_f32 v57, v50, v51
v_cvt_pk_bf16_f32 v58, v52, v53
v_cvt_pk_bf16_f32 v59, v54, v55
buffer_store_dwordx4 v[56:59], v1, s[4:7], s17 offen offset:0 sc1
v_accvgpr_read_b32 v60, a40
v_accvgpr_read_b32 v61, a41
v_accvgpr_read_b32 v62, a42
v_accvgpr_read_b32 v63, a43
v_accvgpr_read_b32 v64, a56
v_accvgpr_read_b32 v65, a57
v_accvgpr_read_b32 v66, a58
v_accvgpr_read_b32 v67, a59
v_cvt_pk_bf16_f32 v68, v60, v61
v_cvt_pk_bf16_f32 v69, v62, v63
v_cvt_pk_bf16_f32 v70, v64, v65
v_cvt_pk_bf16_f32 v71, v66, v67
buffer_store_dwordx4 v[68:71], v1, s[4:7], s17 offen offset:1024 sc1
v_accvgpr_read_b32 v24, a72
v_accvgpr_read_b32 v25, a73
v_accvgpr_read_b32 v26, a74
v_accvgpr_read_b32 v27, a75
v_accvgpr_read_b32 v28, a88
v_accvgpr_read_b32 v29, a89
v_accvgpr_read_b32 v30, a90
v_accvgpr_read_b32 v31, a91
v_cvt_pk_bf16_f32 v32, v24, v25
v_cvt_pk_bf16_f32 v33, v26, v27
v_cvt_pk_bf16_f32 v34, v28, v29
v_cvt_pk_bf16_f32 v35, v30, v31
buffer_store_dwordx4 v[32:35], v1, s[4:7], s17 offen offset:2048 sc1
v_accvgpr_read_b32 v36, a104
v_accvgpr_read_b32 v37, a105
v_accvgpr_read_b32 v38, a106
v_accvgpr_read_b32 v39, a107
v_accvgpr_read_b32 v40, a120
v_accvgpr_read_b32 v41, a121
v_accvgpr_read_b32 v42, a122
v_accvgpr_read_b32 v43, a123
v_cvt_pk_bf16_f32 v44, v36, v37
v_cvt_pk_bf16_f32 v45, v38, v39
v_cvt_pk_bf16_f32 v46, v40, v41
v_cvt_pk_bf16_f32 v47, v42, v43
buffer_store_dwordx4 v[44:47], v1, s[4:7], s17 offen offset:3072 sc1
v_accvgpr_read_b32 v48, a136
v_accvgpr_read_b32 v49, a137
v_accvgpr_read_b32 v50, a138
v_accvgpr_read_b32 v51, a139
v_accvgpr_read_b32 v52, a152
v_accvgpr_read_b32 v53, a153
v_accvgpr_read_b32 v54, a154
v_accvgpr_read_b32 v55, a155
v_cvt_pk_bf16_f32 v56, v48, v49
v_cvt_pk_bf16_f32 v57, v50, v51
v_cvt_pk_bf16_f32 v58, v52, v53
v_cvt_pk_bf16_f32 v59, v54, v55
s_add_u32 s17, s17, 4096
buffer_store_dwordx4 v[56:59], v1, s[4:7], s17 offen offset:0 sc1
s_add_u32 s17, s16, 61440
v_accvgpr_read_b32 v60, a12
v_accvgpr_read_b32 v61, a13
v_accvgpr_read_b32 v62, a14
v_accvgpr_read_b32 v63, a15
v_accvgpr_read_b32 v64, a28
v_accvgpr_read_b32 v65, a29
v_accvgpr_read_b32 v66, a30
v_accvgpr_read_b32 v67, a31
v_cvt_pk_bf16_f32 v68, v60, v61
v_cvt_pk_bf16_f32 v69, v62, v63
v_cvt_pk_bf16_f32 v70, v64, v65
v_cvt_pk_bf16_f32 v71, v66, v67
buffer_store_dwordx4 v[68:71], v1, s[4:7], s17 offen offset:0 sc1
v_accvgpr_read_b32 v24, a44
v_accvgpr_read_b32 v25, a45
v_accvgpr_read_b32 v26, a46
v_accvgpr_read_b32 v27, a47
v_accvgpr_read_b32 v28, a60
v_accvgpr_read_b32 v29, a61
v_accvgpr_read_b32 v30, a62
v_accvgpr_read_b32 v31, a63
v_cvt_pk_bf16_f32 v32, v24, v25
v_cvt_pk_bf16_f32 v33, v26, v27
v_cvt_pk_bf16_f32 v34, v28, v29
v_cvt_pk_bf16_f32 v35, v30, v31
buffer_store_dwordx4 v[32:35], v1, s[4:7], s17 offen offset:1024 sc1
v_accvgpr_read_b32 v36, a76
v_accvgpr_read_b32 v37, a77
v_accvgpr_read_b32 v38, a78
v_accvgpr_read_b32 v39, a79
v_accvgpr_read_b32 v40, a92
v_accvgpr_read_b32 v41, a93
v_accvgpr_read_b32 v42, a94
v_accvgpr_read_b32 v43, a95
v_cvt_pk_bf16_f32 v44, v36, v37
v_cvt_pk_bf16_f32 v45, v38, v39
v_cvt_pk_bf16_f32 v46, v40, v41
v_cvt_pk_bf16_f32 v47, v42, v43
buffer_store_dwordx4 v[44:47], v1, s[4:7], s17 offen offset:2048 sc1
v_accvgpr_read_b32 v48, a108
v_accvgpr_read_b32 v49, a109
v_accvgpr_read_b32 v50, a110
v_accvgpr_read_b32 v51, a111
v_accvgpr_read_b32 v52, a124
v_accvgpr_read_b32 v53, a125
v_accvgpr_read_b32 v54, a126
v_accvgpr_read_b32 v55, a127
v_cvt_pk_bf16_f32 v56, v48, v49
v_cvt_pk_bf16_f32 v57, v50, v51
v_cvt_pk_bf16_f32 v58, v52, v53
v_cvt_pk_bf16_f32 v59, v54, v55
buffer_store_dwordx4 v[56:59], v1, s[4:7], s17 offen offset:3072 sc1
v_accvgpr_read_b32 v60, a140
v_accvgpr_read_b32 v61, a141
v_accvgpr_read_b32 v62, a142
v_accvgpr_read_b32 v63, a143
v_accvgpr_read_b32 v64, a156
v_accvgpr_read_b32 v65, a157
v_accvgpr_read_b32 v66, a158
v_accvgpr_read_b32 v67, a159
v_cvt_pk_bf16_f32 v68, v60, v61
v_cvt_pk_bf16_f32 v69, v62, v63
v_cvt_pk_bf16_f32 v70, v64, v65
v_cvt_pk_bf16_f32 v71, v66, v67
s_add_u32 s17, s17, 4096
buffer_store_dwordx4 v[68:71], v1, s[4:7], s17 offen offset:0 sc1
fin_exit1:
s_endpgm
.globl redln1_kernel
.p2align 8
.type redln1_kernel,@function
redln1_kernel:
s_cmp_ge_u32 s2, 256
s_cbranch_scc1 redln1_exit1
s_load_dwordx2 s[12:13], s[0:1], 96
s_load_dwordx2 s[14:15], s[0:1], 0
v_lshrrev_b32 v2, 6, v0
v_and_b32 v3, 63, v0
s_lshr_b32 s19, s2, 1
v_readfirstlane_b32 s16, v2
s_and_b32 s18, s2, 1
s_waitcnt lgkmcnt(0)
s_mov_b32 s4, s12
s_mov_b32 s5, s13
s_mov_b32 s6, 0x10000000
s_mov_b32 s7, 0x20000
s_mov_b32 s8, s14
s_mov_b32 s9, s15
s_mov_b32 s10, 2621440
s_mov_b32 s11, 0x20000
s_mov_b32 s20, 0
v_and_b32 v2, 7, v3
v_bfe_u32 v4, v3, 3, 2
v_lshrrev_b32 v5, 5, v3
s_lshl_b32 s17, s18, 7
v_lshlrev_b32 v14, 4, v2
v_lshl_add_u32 v14, v4, 8, v14
v_lshl_add_u32 v14, v5, 10, v14
v_add_u32 v14, s17, v14
s_lshl_b32 s17, s2, 3
v_add_u32 v15, s17, v2
v_mul_u32_u24 v15, 1280, v15
v_lshl_add_u32 v15, v4, 4, v15
v_lshl_add_u32 v15, v5, 6, v15
s_mul_i32 s17, s16, 640
s_add_u32 s20, s20, s17
s_add_u32 s21, s17, 82313216
s_mul_i32 s22, s19, 20
s_mul_i32 s23, s16, 10
s_add_u32 s22, s22, s23
s_lshl_b32 s22, s22, 10
s_add_u32 s34, s22, 54525952
s_add_u32 s22, s22, 90832896
s_add_u32 s24, s22, 0
s_add_u32 s25, s22, 2621440
s_add_u32 s26, s22, 5242880
s_add_u32 s27, s22, 7864320
s_add_u32 s28, s22, 10485760
s_add_u32 s29, s22, 13107200
s_add_u32 s30, s22, 15728640
s_add_u32 s31, s22, 18350080
v_add_u32 v6, 0x1000, v14
v_add_u32 v7, 0x2000, v14
buffer_load_dwordx4 v[16:19], v15, s[8:11], s20 offen offset:0
buffer_load_dwordx4 v[20:23], v15, s[8:11], s20 offen offset:128
buffer_load_dwordx4 v[24:27], v15, s[8:11], s20 offen offset:256
buffer_load_dwordx4 v[28:31], v15, s[8:11], s20 offen offset:384
buffer_load_dwordx4 v[32:35], v15, s[8:11], s20 offen offset:512
buffer_load_dwordx4 v[80:83], v14, s[4:7], s24 offen offset:0
buffer_load_dwordx4 v[84:87], v14, s[4:7], s25 offen offset:0
buffer_load_dwordx4 v[88:91], v14, s[4:7], s26 offen offset:0
buffer_load_dwordx4 v[92:95], v14, s[4:7], s27 offen offset:0
buffer_load_dwordx4 v[96:99], v14, s[4:7], s28 offen offset:0
buffer_load_dwordx4 v[100:103], v14, s[4:7], s29 offen offset:0
buffer_load_dwordx4 v[104:107], v14, s[4:7], s30 offen offset:0
buffer_load_dwordx4 v[108:111], v14, s[4:7], s31 offen offset:0
buffer_load_dwordx4 v[112:115], v14, s[4:7], s24 offen offset:2048
buffer_load_dwordx4 v[116:119], v14, s[4:7], s25 offen offset:2048
buffer_load_dwordx4 v[120:123], v14, s[4:7], s26 offen offset:2048
buffer_load_dwordx4 v[124:127], v14, s[4:7], s27 offen offset:2048
buffer_load_dwordx4 v[128:131], v14, s[4:7], s28 offen offset:2048
buffer_load_dwordx4 v[132:135], v14, s[4:7], s29 offen offset:2048
buffer_load_dwordx4 v[136:139], v14, s[4:7], s30 offen offset:2048
buffer_load_dwordx4 v[140:143], v14, s[4:7], s31 offen offset:2048
buffer_load_dwordx4 v[144:147], v6, s[4:7], s24 offen offset:0
buffer_load_dwordx4 v[148:151], v6, s[4:7], s25 offen offset:0
buffer_load_dwordx4 v[152:155], v6, s[4:7], s26 offen offset:0
buffer_load_dwordx4 v[156:159], v6, s[4:7], s27 offen offset:0
buffer_load_dwordx4 v[160:163], v6, s[4:7], s28 offen offset:0
buffer_load_dwordx4 v[164:167], v6, s[4:7], s29 offen offset:0
buffer_load_dwordx4 v[168:171], v6, s[4:7], s30 offen offset:0
buffer_load_dwordx4 v[172:175], v6, s[4:7], s31 offen offset:0
buffer_load_dwordx4 v[176:179], v6, s[4:7], s24 offen offset:2048
buffer_load_dwordx4 v[180:183], v6, s[4:7], s25 offen offset:2048
buffer_load_dwordx4 v[184:187], v6, s[4:7], s26 offen offset:2048
buffer_load_dwordx4 v[188:191], v6, s[4:7], s27 offen offset:2048
buffer_load_dwordx4 v[192:195], v6, s[4:7], s28 offen offset:2048
buffer_load_dwordx4 v[196:199], v6, s[4:7], s29 offen offset:2048
buffer_load_dwordx4 v[200:203], v6, s[4:7], s30 offen offset:2048
buffer_load_dwordx4 v[204:207], v6, s[4:7], s31 offen offset:2048
buffer_load_dwordx4 v[208:211], v7, s[4:7], s24 offen offset:0
buffer_load_dwordx4 v[212:215], v7, s[4:7], s25 offen offset:0
buffer_load_dwordx4 v[216:219], v7, s[4:7], s26 offen offset:0
buffer_load_dwordx4 v[220:223], v7, s[4:7], s27 offen offset:0
buffer_load_dwordx4 v[224:227], v7, s[4:7], s28 offen offset:0
buffer_load_dwordx4 v[228:231], v7, s[4:7], s29 offen offset:0
buffer_load_dwordx4 v[232:235], v7, s[4:7], s30 offen offset:0
buffer_load_dwordx4 v[236:239], v7, s[4:7], s31 offen offset:0
s_waitcnt vmcnt(32)
v_lshlrev_b32 v36, 16, v80
v_and_b32 v37, 0xffff0000, v80
v_lshlrev_b32 v38, 16, v81
v_and_b32 v39, 0xffff0000, v81
v_lshlrev_b32 v40, 16, v82
v_and_b32 v41, 0xffff0000, v82
v_lshlrev_b32 v42, 16, v83
v_and_b32 v43, 0xffff0000, v83
v_lshlrev_b32 v8, 16, v84
v_and_b32 v9, 0xffff0000, v84
v_pk_add_f32 v[36:37], v[36:37], v[8:9]
v_lshlrev_b32 v10, 16, v85
v_and_b32 v11, 0xffff0000, v85
v_pk_add_f32 v[38:39], v[38:39], v[10:11]
v_lshlrev_b32 v8, 16, v86
v_and_b32 v9, 0xffff0000, v86
v_pk_add_f32 v[40:41], v[40:41], v[8:9]
v_lshlrev_b32 v10, 16, v87
v_and_b32 v11, 0xffff0000, v87
v_pk_add_f32 v[42:43], v[42:43], v[10:11]
v_lshlrev_b32 v8, 16, v88
v_and_b32 v9, 0xffff0000, v88
v_pk_add_f32 v[36:37], v[36:37], v[8:9]
v_lshlrev_b32 v10, 16, v89
v_and_b32 v11, 0xffff0000, v89
v_pk_add_f32 v[38:39], v[38:39], v[10:11]
v_lshlrev_b32 v8, 16, v90
v_and_b32 v9, 0xffff0000, v90
v_pk_add_f32 v[40:41], v[40:41], v[8:9]
v_lshlrev_b32 v10, 16, v91
v_and_b32 v11, 0xffff0000, v91
v_pk_add_f32 v[42:43], v[42:43], v[10:11]
v_lshlrev_b32 v8, 16, v92
v_and_b32 v9, 0xffff0000, v92
v_pk_add_f32 v[36:37], v[36:37], v[8:9]
v_lshlrev_b32 v10, 16, v93
v_and_b32 v11, 0xffff0000, v93
v_pk_add_f32 v[38:39], v[38:39], v[10:11]
v_lshlrev_b32 v8, 16, v94
v_and_b32 v9, 0xffff0000, v94
v_pk_add_f32 v[40:41], v[40:41], v[8:9]
v_lshlrev_b32 v10, 16, v95
v_and_b32 v11, 0xffff0000, v95
v_pk_add_f32 v[42:43], v[42:43], v[10:11]
v_lshlrev_b32 v8, 16, v96
v_and_b32 v9, 0xffff0000, v96
v_pk_add_f32 v[36:37], v[36:37], v[8:9]
v_lshlrev_b32 v10, 16, v97
v_and_b32 v11, 0xffff0000, v97
v_pk_add_f32 v[38:39], v[38:39], v[10:11]
v_lshlrev_b32 v8, 16, v98
v_and_b32 v9, 0xffff0000, v98
v_pk_add_f32 v[40:41], v[40:41], v[8:9]
v_lshlrev_b32 v10, 16, v99
v_and_b32 v11, 0xffff0000, v99
v_pk_add_f32 v[42:43], v[42:43], v[10:11]
v_lshlrev_b32 v8, 16, v100
v_and_b32 v9, 0xffff0000, v100
v_pk_add_f32 v[36:37], v[36:37], v[8:9]
v_lshlrev_b32 v10, 16, v101
v_and_b32 v11, 0xffff0000, v101
v_pk_add_f32 v[38:39], v[38:39], v[10:11]
v_lshlrev_b32 v8, 16, v102
v_and_b32 v9, 0xffff0000, v102
v_pk_add_f32 v[40:41], v[40:41], v[8:9]
v_lshlrev_b32 v10, 16, v103
v_and_b32 v11, 0xffff0000, v103
v_pk_add_f32 v[42:43], v[42:43], v[10:11]
v_lshlrev_b32 v8, 16, v104
v_and_b32 v9, 0xffff0000, v104
v_pk_add_f32 v[36:37], v[36:37], v[8:9]
v_lshlrev_b32 v10, 16, v105
v_and_b32 v11, 0xffff0000, v105
v_pk_add_f32 v[38:39], v[38:39], v[10:11]
v_lshlrev_b32 v8, 16, v106
v_and_b32 v9, 0xffff0000, v106
v_pk_add_f32 v[40:41], v[40:41], v[8:9]
v_lshlrev_b32 v10, 16, v107
v_and_b32 v11, 0xffff0000, v107
v_pk_add_f32 v[42:43], v[42:43], v[10:11]
v_lshlrev_b32 v8, 16, v108
v_and_b32 v9, 0xffff0000, v108
v_pk_add_f32 v[36:37], v[36:37], v[8:9]
v_lshlrev_b32 v10, 16, v109
v_and_b32 v11, 0xffff0000, v109
v_pk_add_f32 v[38:39], v[38:39], v[10:11]
v_lshlrev_b32 v8, 16, v110
v_and_b32 v9, 0xffff0000, v110
v_pk_add_f32 v[40:41], v[40:41], v[8:9]
v_lshlrev_b32 v10, 16, v111
v_and_b32 v11, 0xffff0000, v111
v_pk_add_f32 v[42:43], v[42:43], v[10:11]
v_cvt_pk_bf16_f32 v8, v36, v37
v_lshlrev_b32 v36, 16, v8
v_and_b32 v37, 0xffff0000, v8
v_lshlrev_b32 v10, 16, v16
v_and_b32 v11, 0xffff0000, v16
v_pk_add_f32 v[36:37], v[36:37], v[10:11]
v_cvt_pk_bf16_f32 v16, v36, v37
v_lshlrev_b32 v36, 16, v16
v_and_b32 v37, 0xffff0000, v16
v_cvt_pk_bf16_f32 v8, v38, v39
v_lshlrev_b32 v38, 16, v8
v_and_b32 v39, 0xffff0000, v8
v_lshlrev_b32 v10, 16, v17
v_and_b32 v11, 0xffff0000, v17
v_pk_add_f32 v[38:39], v[38:39], v[10:11]
v_cvt_pk_bf16_f32 v17, v38, v39
v_lshlrev_b32 v38, 16, v17
v_and_b32 v39, 0xffff0000, v17
v_cvt_pk_bf16_f32 v8, v40, v41
v_lshlrev_b32 v40, 16, v8
v_and_b32 v41, 0xffff0000, v8
v_lshlrev_b32 v10, 16, v18
v_and_b32 v11, 0xffff0000, v18
v_pk_add_f32 v[40:41], v[40:41], v[10:11]
v_cvt_pk_bf16_f32 v18, v40, v41
v_lshlrev_b32 v40, 16, v18
v_and_b32 v41, 0xffff0000, v18
v_cvt_pk_bf16_f32 v8, v42, v43
v_lshlrev_b32 v42, 16, v8
v_and_b32 v43, 0xffff0000, v8
v_lshlrev_b32 v10, 16, v19
v_and_b32 v11, 0xffff0000, v19
v_pk_add_f32 v[42:43], v[42:43], v[10:11]
v_cvt_pk_bf16_f32 v19, v42, v43
v_lshlrev_b32 v42, 16, v19
v_and_b32 v43, 0xffff0000, v19
buffer_store_dwordx4 v[16:19], v15, s[4:7], s21 offen offset:0 sc1
s_waitcnt vmcnt(25)
v_lshlrev_b32 v44, 16, v112
v_and_b32 v45, 0xffff0000, v112
v_lshlrev_b32 v46, 16, v113
v_and_b32 v47, 0xffff0000, v113
v_lshlrev_b32 v48, 16, v114
v_and_b32 v49, 0xffff0000, v114
v_lshlrev_b32 v50, 16, v115
v_and_b32 v51, 0xffff0000, v115
v_lshlrev_b32 v8, 16, v116
v_and_b32 v9, 0xffff0000, v116
v_pk_add_f32 v[44:45], v[44:45], v[8:9]
v_lshlrev_b32 v10, 16, v117
v_and_b32 v11, 0xffff0000, v117
v_pk_add_f32 v[46:47], v[46:47], v[10:11]
v_lshlrev_b32 v8, 16, v118
v_and_b32 v9, 0xffff0000, v118
v_pk_add_f32 v[48:49], v[48:49], v[8:9]
v_lshlrev_b32 v10, 16, v119
v_and_b32 v11, 0xffff0000, v119
v_pk_add_f32 v[50:51], v[50:51], v[10:11]
v_lshlrev_b32 v8, 16, v120
v_and_b32 v9, 0xffff0000, v120
v_pk_add_f32 v[44:45], v[44:45], v[8:9]
v_lshlrev_b32 v10, 16, v121
v_and_b32 v11, 0xffff0000, v121
v_pk_add_f32 v[46:47], v[46:47], v[10:11]
v_lshlrev_b32 v8, 16, v122
v_and_b32 v9, 0xffff0000, v122
v_pk_add_f32 v[48:49], v[48:49], v[8:9]
v_lshlrev_b32 v10, 16, v123
v_and_b32 v11, 0xffff0000, v123
v_pk_add_f32 v[50:51], v[50:51], v[10:11]
v_lshlrev_b32 v8, 16, v124
v_and_b32 v9, 0xffff0000, v124
v_pk_add_f32 v[44:45], v[44:45], v[8:9]
v_lshlrev_b32 v10, 16, v125
v_and_b32 v11, 0xffff0000, v125
v_pk_add_f32 v[46:47], v[46:47], v[10:11]
v_lshlrev_b32 v8, 16, v126
v_and_b32 v9, 0xffff0000, v126
v_pk_add_f32 v[48:49], v[48:49], v[8:9]
v_lshlrev_b32 v10, 16, v127
v_and_b32 v11, 0xffff0000, v127
v_pk_add_f32 v[50:51], v[50:51], v[10:11]
v_lshlrev_b32 v8, 16, v128
v_and_b32 v9, 0xffff0000, v128
v_pk_add_f32 v[44:45], v[44:45], v[8:9]
v_lshlrev_b32 v10, 16, v129
v_and_b32 v11, 0xffff0000, v129
v_pk_add_f32 v[46:47], v[46:47], v[10:11]
v_lshlrev_b32 v8, 16, v130
v_and_b32 v9, 0xffff0000, v130
v_pk_add_f32 v[48:49], v[48:49], v[8:9]
v_lshlrev_b32 v10, 16, v131
v_and_b32 v11, 0xffff0000, v131
v_pk_add_f32 v[50:51], v[50:51], v[10:11]
v_lshlrev_b32 v8, 16, v132
v_and_b32 v9, 0xffff0000, v132
v_pk_add_f32 v[44:45], v[44:45], v[8:9]
v_lshlrev_b32 v10, 16, v133
v_and_b32 v11, 0xffff0000, v133
v_pk_add_f32 v[46:47], v[46:47], v[10:11]
v_lshlrev_b32 v8, 16, v134
v_and_b32 v9, 0xffff0000, v134
v_pk_add_f32 v[48:49], v[48:49], v[8:9]
v_lshlrev_b32 v10, 16, v135
v_and_b32 v11, 0xffff0000, v135
v_pk_add_f32 v[50:51], v[50:51], v[10:11]
v_lshlrev_b32 v8, 16, v136
v_and_b32 v9, 0xffff0000, v136
v_pk_add_f32 v[44:45], v[44:45], v[8:9]
v_lshlrev_b32 v10, 16, v137
v_and_b32 v11, 0xffff0000, v137
v_pk_add_f32 v[46:47], v[46:47], v[10:11]
v_lshlrev_b32 v8, 16, v138
v_and_b32 v9, 0xffff0000, v138
v_pk_add_f32 v[48:49], v[48:49], v[8:9]
v_lshlrev_b32 v10, 16, v139
v_and_b32 v11, 0xffff0000, v139
v_pk_add_f32 v[50:51], v[50:51], v[10:11]
v_lshlrev_b32 v8, 16, v140
v_and_b32 v9, 0xffff0000, v140
v_pk_add_f32 v[44:45], v[44:45], v[8:9]
v_lshlrev_b32 v10, 16, v141
v_and_b32 v11, 0xffff0000, v141
v_pk_add_f32 v[46:47], v[46:47], v[10:11]
v_lshlrev_b32 v8, 16, v142
v_and_b32 v9, 0xffff0000, v142
v_pk_add_f32 v[48:49], v[48:49], v[8:9]
v_lshlrev_b32 v10, 16, v143
v_and_b32 v11, 0xffff0000, v143
v_pk_add_f32 v[50:51], v[50:51], v[10:11]
v_cvt_pk_bf16_f32 v8, v44, v45
v_lshlrev_b32 v44, 16, v8
v_and_b32 v45, 0xffff0000, v8
v_lshlrev_b32 v10, 16, v20
v_and_b32 v11, 0xffff0000, v20
v_pk_add_f32 v[44:45], v[44:45], v[10:11]
v_cvt_pk_bf16_f32 v20, v44, v45
v_lshlrev_b32 v44, 16, v20
v_and_b32 v45, 0xffff0000, v20
v_cvt_pk_bf16_f32 v8, v46, v47
v_lshlrev_b32 v46, 16, v8
v_and_b32 v47, 0xffff0000, v8
v_lshlrev_b32 v10, 16, v21
v_and_b32 v11, 0xffff0000, v21
v_pk_add_f32 v[46:47], v[46:47], v[10:11]
v_cvt_pk_bf16_f32 v21, v46, v47
v_lshlrev_b32 v46, 16, v21
v_and_b32 v47, 0xffff0000, v21
v_cvt_pk_bf16_f32 v8, v48, v49
v_lshlrev_b32 v48, 16, v8
v_and_b32 v49, 0xffff0000, v8
v_lshlrev_b32 v10, 16, v22
v_and_b32 v11, 0xffff0000, v22
v_pk_add_f32 v[48:49], v[48:49], v[10:11]
v_cvt_pk_bf16_f32 v22, v48, v49
v_lshlrev_b32 v48, 16, v22
v_and_b32 v49, 0xffff0000, v22
v_cvt_pk_bf16_f32 v8, v50, v51
v_lshlrev_b32 v50, 16, v8
v_and_b32 v51, 0xffff0000, v8
v_lshlrev_b32 v10, 16, v23
v_and_b32 v11, 0xffff0000, v23
v_pk_add_f32 v[50:51], v[50:51], v[10:11]
v_cvt_pk_bf16_f32 v23, v50, v51
v_lshlrev_b32 v50, 16, v23
v_and_b32 v51, 0xffff0000, v23
buffer_store_dwordx4 v[20:23], v15, s[4:7], s21 offen offset:128 sc1
s_waitcnt vmcnt(18)
v_lshlrev_b32 v52, 16, v144
v_and_b32 v53, 0xffff0000, v144
v_lshlrev_b32 v54, 16, v145
v_and_b32 v55, 0xffff0000, v145
v_lshlrev_b32 v56, 16, v146
v_and_b32 v57, 0xffff0000, v146
v_lshlrev_b32 v58, 16, v147
v_and_b32 v59, 0xffff0000, v147
v_lshlrev_b32 v8, 16, v148
v_and_b32 v9, 0xffff0000, v148
v_pk_add_f32 v[52:53], v[52:53], v[8:9]
v_lshlrev_b32 v10, 16, v149
v_and_b32 v11, 0xffff0000, v149
v_pk_add_f32 v[54:55], v[54:55], v[10:11]
v_lshlrev_b32 v8, 16, v150
v_and_b32 v9, 0xffff0000, v150
v_pk_add_f32 v[56:57], v[56:57], v[8:9]
v_lshlrev_b32 v10, 16, v151
v_and_b32 v11, 0xffff0000, v151
v_pk_add_f32 v[58:59], v[58:59], v[10:11]
v_lshlrev_b32 v8, 16, v152
v_and_b32 v9, 0xffff0000, v152
v_pk_add_f32 v[52:53], v[52:53], v[8:9]
v_lshlrev_b32 v10, 16, v153
v_and_b32 v11, 0xffff0000, v153
v_pk_add_f32 v[54:55], v[54:55], v[10:11]
v_lshlrev_b32 v8, 16, v154
v_and_b32 v9, 0xffff0000, v154
v_pk_add_f32 v[56:57], v[56:57], v[8:9]
v_lshlrev_b32 v10, 16, v155
v_and_b32 v11, 0xffff0000, v155
v_pk_add_f32 v[58:59], v[58:59], v[10:11]
v_lshlrev_b32 v8, 16, v156
v_and_b32 v9, 0xffff0000, v156
v_pk_add_f32 v[52:53], v[52:53], v[8:9]
v_lshlrev_b32 v10, 16, v157
v_and_b32 v11, 0xffff0000, v157
v_pk_add_f32 v[54:55], v[54:55], v[10:11]
v_lshlrev_b32 v8, 16, v158
v_and_b32 v9, 0xffff0000, v158
v_pk_add_f32 v[56:57], v[56:57], v[8:9]
v_lshlrev_b32 v10, 16, v159
v_and_b32 v11, 0xffff0000, v159
v_pk_add_f32 v[58:59], v[58:59], v[10:11]
v_lshlrev_b32 v8, 16, v160
v_and_b32 v9, 0xffff0000, v160
v_pk_add_f32 v[52:53], v[52:53], v[8:9]
v_lshlrev_b32 v10, 16, v161
v_and_b32 v11, 0xffff0000, v161
v_pk_add_f32 v[54:55], v[54:55], v[10:11]
v_lshlrev_b32 v8, 16, v162
v_and_b32 v9, 0xffff0000, v162
v_pk_add_f32 v[56:57], v[56:57], v[8:9]
v_lshlrev_b32 v10, 16, v163
v_and_b32 v11, 0xffff0000, v163
v_pk_add_f32 v[58:59], v[58:59], v[10:11]
v_lshlrev_b32 v8, 16, v164
v_and_b32 v9, 0xffff0000, v164
v_pk_add_f32 v[52:53], v[52:53], v[8:9]
v_lshlrev_b32 v10, 16, v165
v_and_b32 v11, 0xffff0000, v165
v_pk_add_f32 v[54:55], v[54:55], v[10:11]
v_lshlrev_b32 v8, 16, v166
v_and_b32 v9, 0xffff0000, v166
v_pk_add_f32 v[56:57], v[56:57], v[8:9]
v_lshlrev_b32 v10, 16, v167
v_and_b32 v11, 0xffff0000, v167
v_pk_add_f32 v[58:59], v[58:59], v[10:11]
v_lshlrev_b32 v8, 16, v168
v_and_b32 v9, 0xffff0000, v168
v_pk_add_f32 v[52:53], v[52:53], v[8:9]
v_lshlrev_b32 v10, 16, v169
v_and_b32 v11, 0xffff0000, v169
v_pk_add_f32 v[54:55], v[54:55], v[10:11]
v_lshlrev_b32 v8, 16, v170
v_and_b32 v9, 0xffff0000, v170
v_pk_add_f32 v[56:57], v[56:57], v[8:9]
v_lshlrev_b32 v10, 16, v171
v_and_b32 v11, 0xffff0000, v171
v_pk_add_f32 v[58:59], v[58:59], v[10:11]
v_lshlrev_b32 v8, 16, v172
v_and_b32 v9, 0xffff0000, v172
v_pk_add_f32 v[52:53], v[52:53], v[8:9]
v_lshlrev_b32 v10, 16, v173
v_and_b32 v11, 0xffff0000, v173
v_pk_add_f32 v[54:55], v[54:55], v[10:11]
v_lshlrev_b32 v8, 16, v174
v_and_b32 v9, 0xffff0000, v174
v_pk_add_f32 v[56:57], v[56:57], v[8:9]
v_lshlrev_b32 v10, 16, v175
v_and_b32 v11, 0xffff0000, v175
v_pk_add_f32 v[58:59], v[58:59], v[10:11]
v_cvt_pk_bf16_f32 v8, v52, v53
v_lshlrev_b32 v52, 16, v8
v_and_b32 v53, 0xffff0000, v8
v_lshlrev_b32 v10, 16, v24
v_and_b32 v11, 0xffff0000, v24
v_pk_add_f32 v[52:53], v[52:53], v[10:11]
v_cvt_pk_bf16_f32 v24, v52, v53
v_lshlrev_b32 v52, 16, v24
v_and_b32 v53, 0xffff0000, v24
v_cvt_pk_bf16_f32 v8, v54, v55
v_lshlrev_b32 v54, 16, v8
v_and_b32 v55, 0xffff0000, v8
v_lshlrev_b32 v10, 16, v25
v_and_b32 v11, 0xffff0000, v25
v_pk_add_f32 v[54:55], v[54:55], v[10:11]
v_cvt_pk_bf16_f32 v25, v54, v55
v_lshlrev_b32 v54, 16, v25
v_and_b32 v55, 0xffff0000, v25
v_cvt_pk_bf16_f32 v8, v56, v57
v_lshlrev_b32 v56, 16, v8
v_and_b32 v57, 0xffff0000, v8
v_lshlrev_b32 v10, 16, v26
v_and_b32 v11, 0xffff0000, v26
v_pk_add_f32 v[56:57], v[56:57], v[10:11]
v_cvt_pk_bf16_f32 v26, v56, v57
v_lshlrev_b32 v56, 16, v26
v_and_b32 v57, 0xffff0000, v26
v_cvt_pk_bf16_f32 v8, v58, v59
v_lshlrev_b32 v58, 16, v8
v_and_b32 v59, 0xffff0000, v8
v_lshlrev_b32 v10, 16, v27
v_and_b32 v11, 0xffff0000, v27
v_pk_add_f32 v[58:59], v[58:59], v[10:11]
v_cvt_pk_bf16_f32 v27, v58, v59
v_lshlrev_b32 v58, 16, v27
v_and_b32 v59, 0xffff0000, v27
buffer_store_dwordx4 v[24:27], v15, s[4:7], s21 offen offset:256 sc1
s_waitcnt vmcnt(11)
v_lshlrev_b32 v60, 16, v176
v_and_b32 v61, 0xffff0000, v176
v_lshlrev_b32 v62, 16, v177
v_and_b32 v63, 0xffff0000, v177
v_lshlrev_b32 v64, 16, v178
v_and_b32 v65, 0xffff0000, v178
v_lshlrev_b32 v66, 16, v179
v_and_b32 v67, 0xffff0000, v179
v_lshlrev_b32 v8, 16, v180
v_and_b32 v9, 0xffff0000, v180
v_pk_add_f32 v[60:61], v[60:61], v[8:9]
v_lshlrev_b32 v10, 16, v181
v_and_b32 v11, 0xffff0000, v181
v_pk_add_f32 v[62:63], v[62:63], v[10:11]
v_lshlrev_b32 v8, 16, v182
v_and_b32 v9, 0xffff0000, v182
v_pk_add_f32 v[64:65], v[64:65], v[8:9]
v_lshlrev_b32 v10, 16, v183
v_and_b32 v11, 0xffff0000, v183
v_pk_add_f32 v[66:67], v[66:67], v[10:11]
v_lshlrev_b32 v8, 16, v184
v_and_b32 v9, 0xffff0000, v184
v_pk_add_f32 v[60:61], v[60:61], v[8:9]
v_lshlrev_b32 v10, 16, v185
v_and_b32 v11, 0xffff0000, v185
v_pk_add_f32 v[62:63], v[62:63], v[10:11]
v_lshlrev_b32 v8, 16, v186
v_and_b32 v9, 0xffff0000, v186
v_pk_add_f32 v[64:65], v[64:65], v[8:9]
v_lshlrev_b32 v10, 16, v187
v_and_b32 v11, 0xffff0000, v187
v_pk_add_f32 v[66:67], v[66:67], v[10:11]
v_lshlrev_b32 v8, 16, v188
v_and_b32 v9, 0xffff0000, v188
v_pk_add_f32 v[60:61], v[60:61], v[8:9]
v_lshlrev_b32 v10, 16, v189
v_and_b32 v11, 0xffff0000, v189
v_pk_add_f32 v[62:63], v[62:63], v[10:11]
v_lshlrev_b32 v8, 16, v190
v_and_b32 v9, 0xffff0000, v190
v_pk_add_f32 v[64:65], v[64:65], v[8:9]
v_lshlrev_b32 v10, 16, v191
v_and_b32 v11, 0xffff0000, v191
v_pk_add_f32 v[66:67], v[66:67], v[10:11]
v_lshlrev_b32 v8, 16, v192
v_and_b32 v9, 0xffff0000, v192
v_pk_add_f32 v[60:61], v[60:61], v[8:9]
v_lshlrev_b32 v10, 16, v193
v_and_b32 v11, 0xffff0000, v193
v_pk_add_f32 v[62:63], v[62:63], v[10:11]
v_lshlrev_b32 v8, 16, v194
v_and_b32 v9, 0xffff0000, v194
v_pk_add_f32 v[64:65], v[64:65], v[8:9]
v_lshlrev_b32 v10, 16, v195
v_and_b32 v11, 0xffff0000, v195
v_pk_add_f32 v[66:67], v[66:67], v[10:11]
v_lshlrev_b32 v8, 16, v196
v_and_b32 v9, 0xffff0000, v196
v_pk_add_f32 v[60:61], v[60:61], v[8:9]
v_lshlrev_b32 v10, 16, v197
v_and_b32 v11, 0xffff0000, v197
v_pk_add_f32 v[62:63], v[62:63], v[10:11]
v_lshlrev_b32 v8, 16, v198
v_and_b32 v9, 0xffff0000, v198
v_pk_add_f32 v[64:65], v[64:65], v[8:9]
v_lshlrev_b32 v10, 16, v199
v_and_b32 v11, 0xffff0000, v199
v_pk_add_f32 v[66:67], v[66:67], v[10:11]
v_lshlrev_b32 v8, 16, v200
v_and_b32 v9, 0xffff0000, v200
v_pk_add_f32 v[60:61], v[60:61], v[8:9]
v_lshlrev_b32 v10, 16, v201
v_and_b32 v11, 0xffff0000, v201
v_pk_add_f32 v[62:63], v[62:63], v[10:11]
v_lshlrev_b32 v8, 16, v202
v_and_b32 v9, 0xffff0000, v202
v_pk_add_f32 v[64:65], v[64:65], v[8:9]
v_lshlrev_b32 v10, 16, v203
v_and_b32 v11, 0xffff0000, v203
v_pk_add_f32 v[66:67], v[66:67], v[10:11]
v_lshlrev_b32 v8, 16, v204
v_and_b32 v9, 0xffff0000, v204
v_pk_add_f32 v[60:61], v[60:61], v[8:9]
v_lshlrev_b32 v10, 16, v205
v_and_b32 v11, 0xffff0000, v205
v_pk_add_f32 v[62:63], v[62:63], v[10:11]
v_lshlrev_b32 v8, 16, v206
v_and_b32 v9, 0xffff0000, v206
v_pk_add_f32 v[64:65], v[64:65], v[8:9]
v_lshlrev_b32 v10, 16, v207
v_and_b32 v11, 0xffff0000, v207
v_pk_add_f32 v[66:67], v[66:67], v[10:11]
v_cvt_pk_bf16_f32 v8, v60, v61
v_lshlrev_b32 v60, 16, v8
v_and_b32 v61, 0xffff0000, v8
v_lshlrev_b32 v10, 16, v28
v_and_b32 v11, 0xffff0000, v28
v_pk_add_f32 v[60:61], v[60:61], v[10:11]
v_cvt_pk_bf16_f32 v28, v60, v61
v_lshlrev_b32 v60, 16, v28
v_and_b32 v61, 0xffff0000, v28
v_cvt_pk_bf16_f32 v8, v62, v63
v_lshlrev_b32 v62, 16, v8
v_and_b32 v63, 0xffff0000, v8
v_lshlrev_b32 v10, 16, v29
v_and_b32 v11, 0xffff0000, v29
v_pk_add_f32 v[62:63], v[62:63], v[10:11]
v_cvt_pk_bf16_f32 v29, v62, v63
v_lshlrev_b32 v62, 16, v29
v_and_b32 v63, 0xffff0000, v29
v_cvt_pk_bf16_f32 v8, v64, v65
v_lshlrev_b32 v64, 16, v8
v_and_b32 v65, 0xffff0000, v8
v_lshlrev_b32 v10, 16, v30
v_and_b32 v11, 0xffff0000, v30
v_pk_add_f32 v[64:65], v[64:65], v[10:11]
v_cvt_pk_bf16_f32 v30, v64, v65
v_lshlrev_b32 v64, 16, v30
v_and_b32 v65, 0xffff0000, v30
v_cvt_pk_bf16_f32 v8, v66, v67
v_lshlrev_b32 v66, 16, v8
v_and_b32 v67, 0xffff0000, v8
v_lshlrev_b32 v10, 16, v31
v_and_b32 v11, 0xffff0000, v31
v_pk_add_f32 v[66:67], v[66:67], v[10:11]
v_cvt_pk_bf16_f32 v31, v66, v67
v_lshlrev_b32 v66, 16, v31
v_and_b32 v67, 0xffff0000, v31
buffer_store_dwordx4 v[28:31], v15, s[4:7], s21 offen offset:384 sc1
s_waitcnt vmcnt(4)
v_lshlrev_b32 v68, 16, v208
v_and_b32 v69, 0xffff0000, v208
v_lshlrev_b32 v70, 16, v209
v_and_b32 v71, 0xffff0000, v209
v_lshlrev_b32 v72, 16, v210
v_and_b32 v73, 0xffff0000, v210
v_lshlrev_b32 v74, 16, v211
v_and_b32 v75, 0xffff0000, v211
v_lshlrev_b32 v8, 16, v212
v_and_b32 v9, 0xffff0000, v212
v_pk_add_f32 v[68:69], v[68:69], v[8:9]
v_lshlrev_b32 v10, 16, v213
v_and_b32 v11, 0xffff0000, v213
v_pk_add_f32 v[70:71], v[70:71], v[10:11]
v_lshlrev_b32 v8, 16, v214
v_and_b32 v9, 0xffff0000, v214
v_pk_add_f32 v[72:73], v[72:73], v[8:9]
v_lshlrev_b32 v10, 16, v215
v_and_b32 v11, 0xffff0000, v215
v_pk_add_f32 v[74:75], v[74:75], v[10:11]
v_lshlrev_b32 v8, 16, v216
v_and_b32 v9, 0xffff0000, v216
v_pk_add_f32 v[68:69], v[68:69], v[8:9]
v_lshlrev_b32 v10, 16, v217
v_and_b32 v11, 0xffff0000, v217
v_pk_add_f32 v[70:71], v[70:71], v[10:11]
v_lshlrev_b32 v8, 16, v218
v_and_b32 v9, 0xffff0000, v218
v_pk_add_f32 v[72:73], v[72:73], v[8:9]
v_lshlrev_b32 v10, 16, v219
v_and_b32 v11, 0xffff0000, v219
v_pk_add_f32 v[74:75], v[74:75], v[10:11]
v_lshlrev_b32 v8, 16, v220
v_and_b32 v9, 0xffff0000, v220
v_pk_add_f32 v[68:69], v[68:69], v[8:9]
v_lshlrev_b32 v10, 16, v221
v_and_b32 v11, 0xffff0000, v221
v_pk_add_f32 v[70:71], v[70:71], v[10:11]
v_lshlrev_b32 v8, 16, v222
v_and_b32 v9, 0xffff0000, v222
v_pk_add_f32 v[72:73], v[72:73], v[8:9]
v_lshlrev_b32 v10, 16, v223
v_and_b32 v11, 0xffff0000, v223
v_pk_add_f32 v[74:75], v[74:75], v[10:11]
v_lshlrev_b32 v8, 16, v224
v_and_b32 v9, 0xffff0000, v224
v_pk_add_f32 v[68:69], v[68:69], v[8:9]
v_lshlrev_b32 v10, 16, v225
v_and_b32 v11, 0xffff0000, v225
v_pk_add_f32 v[70:71], v[70:71], v[10:11]
v_lshlrev_b32 v8, 16, v226
v_and_b32 v9, 0xffff0000, v226
v_pk_add_f32 v[72:73], v[72:73], v[8:9]
v_lshlrev_b32 v10, 16, v227
v_and_b32 v11, 0xffff0000, v227
v_pk_add_f32 v[74:75], v[74:75], v[10:11]
v_lshlrev_b32 v8, 16, v228
v_and_b32 v9, 0xffff0000, v228
v_pk_add_f32 v[68:69], v[68:69], v[8:9]
v_lshlrev_b32 v10, 16, v229
v_and_b32 v11, 0xffff0000, v229
v_pk_add_f32 v[70:71], v[70:71], v[10:11]
v_lshlrev_b32 v8, 16, v230
v_and_b32 v9, 0xffff0000, v230
v_pk_add_f32 v[72:73], v[72:73], v[8:9]
v_lshlrev_b32 v10, 16, v231
v_and_b32 v11, 0xffff0000, v231
v_pk_add_f32 v[74:75], v[74:75], v[10:11]
v_lshlrev_b32 v8, 16, v232
v_and_b32 v9, 0xffff0000, v232
v_pk_add_f32 v[68:69], v[68:69], v[8:9]
v_lshlrev_b32 v10, 16, v233
v_and_b32 v11, 0xffff0000, v233
v_pk_add_f32 v[70:71], v[70:71], v[10:11]
v_lshlrev_b32 v8, 16, v234
v_and_b32 v9, 0xffff0000, v234
v_pk_add_f32 v[72:73], v[72:73], v[8:9]
v_lshlrev_b32 v10, 16, v235
v_and_b32 v11, 0xffff0000, v235
v_pk_add_f32 v[74:75], v[74:75], v[10:11]
v_lshlrev_b32 v8, 16, v236
v_and_b32 v9, 0xffff0000, v236
v_pk_add_f32 v[68:69], v[68:69], v[8:9]
v_lshlrev_b32 v10, 16, v237
v_and_b32 v11, 0xffff0000, v237
v_pk_add_f32 v[70:71], v[70:71], v[10:11]
v_lshlrev_b32 v8, 16, v238
v_and_b32 v9, 0xffff0000, v238
v_pk_add_f32 v[72:73], v[72:73], v[8:9]
v_lshlrev_b32 v10, 16, v239
v_and_b32 v11, 0xffff0000, v239
v_pk_add_f32 v[74:75], v[74:75], v[10:11]
v_cvt_pk_bf16_f32 v8, v68, v69
v_lshlrev_b32 v68, 16, v8
v_and_b32 v69, 0xffff0000, v8
v_lshlrev_b32 v10, 16, v32
v_and_b32 v11, 0xffff0000, v32
v_pk_add_f32 v[68:69], v[68:69], v[10:11]
v_cvt_pk_bf16_f32 v32, v68, v69
v_lshlrev_b32 v68, 16, v32
v_and_b32 v69, 0xffff0000, v32
v_cvt_pk_bf16_f32 v8, v70, v71
v_lshlrev_b32 v70, 16, v8
v_and_b32 v71, 0xffff0000, v8
v_lshlrev_b32 v10, 16, v33
v_and_b32 v11, 0xffff0000, v33
v_pk_add_f32 v[70:71], v[70:71], v[10:11]
v_cvt_pk_bf16_f32 v33, v70, v71
v_lshlrev_b32 v70, 16, v33
v_and_b32 v71, 0xffff0000, v33
v_cvt_pk_bf16_f32 v8, v72, v73
v_lshlrev_b32 v72, 16, v8
v_and_b32 v73, 0xffff0000, v8
v_lshlrev_b32 v10, 16, v34
v_and_b32 v11, 0xffff0000, v34
v_pk_add_f32 v[72:73], v[72:73], v[10:11]
v_cvt_pk_bf16_f32 v34, v72, v73
v_lshlrev_b32 v72, 16, v34
v_and_b32 v73, 0xffff0000, v34
v_cvt_pk_bf16_f32 v8, v74, v75
v_lshlrev_b32 v74, 16, v8
v_and_b32 v75, 0xffff0000, v8
v_lshlrev_b32 v10, 16, v35
v_and_b32 v11, 0xffff0000, v35
v_pk_add_f32 v[74:75], v[74:75], v[10:11]
v_cvt_pk_bf16_f32 v35, v74, v75
v_lshlrev_b32 v74, 16, v35
v_and_b32 v75, 0xffff0000, v35
buffer_store_dwordx4 v[32:35], v15, s[4:7], s21 offen offset:512 sc1
v_and_b32 v3, 63, v0
v_and_b32 v2, 7, v3
v_lshlrev_b32 v5, 2, v2
s_lshl_b32 s17, s16, 5
v_add_u32 v1, s17, v5
v_pk_add_f32 v[6:7], v[36:37], v[38:39]
v_pk_add_f32 v[6:7], v[6:7], v[40:41]
v_pk_add_f32 v[6:7], v[6:7], v[42:43]
v_pk_add_f32 v[6:7], v[6:7], v[44:45]
v_pk_add_f32 v[6:7], v[6:7], v[46:47]
v_pk_add_f32 v[6:7], v[6:7], v[48:49]
v_pk_add_f32 v[6:7], v[6:7], v[50:51]
v_pk_add_f32 v[6:7], v[6:7], v[52:53]
v_pk_add_f32 v[6:7], v[6:7], v[54:55]
v_pk_add_f32 v[6:7], v[6:7], v[56:57]
v_pk_add_f32 v[6:7], v[6:7], v[58:59]
v_pk_add_f32 v[6:7], v[6:7], v[60:61]
v_pk_add_f32 v[6:7], v[6:7], v[62:63]
v_pk_add_f32 v[6:7], v[6:7], v[64:65]
v_pk_add_f32 v[6:7], v[6:7], v[66:67]
v_pk_add_f32 v[6:7], v[6:7], v[68:69]
v_pk_add_f32 v[6:7], v[6:7], v[70:71]
v_pk_add_f32 v[6:7], v[6:7], v[72:73]
v_pk_add_f32 v[6:7], v[6:7], v[74:75]
v_add_f32 v4, v6, v7
s_nop 1
v_add_f32_dpp v4, v4, v4 row_ror:8 row_mask:0xf bank_mask:0xf
v_mov_b32 v2, v4
s_nop 1
v_permlane16_swap_b32 v4, v2
v_add_f32 v4, v4, v2
v_mov_b32 v2, v4
s_nop 1
v_permlane32_swap_b32 v4, v2
v_add_f32 v4, v4, v2
ds_write_b32 v1, v4 offset:0
s_waitcnt lgkmcnt(0)
s_barrier
ds_read_b32 v4, v5 offset:0
ds_read_b32 v2, v5 offset:32
s_waitcnt lgkmcnt(0)
v_add_f32 v4, v4, v2
v_mul_f32 v6, 0xbacccccd, v4
v_mov_b32 v7, v6
v_pk_add_f32 v[36:37], v[36:37], v[6:7]
v_pk_add_f32 v[38:39], v[38:39], v[6:7]
v_pk_add_f32 v[40:41], v[40:41], v[6:7]
v_pk_add_f32 v[42:43], v[42:43], v[6:7]
v_pk_add_f32 v[44:45], v[44:45], v[6:7]
v_pk_add_f32 v[46:47], v[46:47], v[6:7]
v_pk_add_f32 v[48:49], v[48:49], v[6:7]
v_pk_add_f32 v[50:51], v[50:51], v[6:7]
v_pk_add_f32 v[52:53], v[52:53], v[6:7]
v_pk_add_f32 v[54:55], v[54:55], v[6:7]
v_pk_add_f32 v[56:57], v[56:57], v[6:7]
v_pk_add_f32 v[58:59], v[58:59], v[6:7]
v_pk_add_f32 v[60:61], v[60:61], v[6:7]
v_pk_add_f32 v[62:63], v[62:63], v[6:7]
v_pk_add_f32 v[64:65], v[64:65], v[6:7]
v_pk_add_f32 v[66:67], v[66:67], v[6:7]
v_pk_add_f32 v[68:69], v[68:69], v[6:7]
v_pk_add_f32 v[70:71], v[70:71], v[6:7]
v_pk_add_f32 v[72:73], v[72:73], v[6:7]
v_pk_add_f32 v[74:75], v[74:75], v[6:7]
v_pk_mul_f32 v[6:7], v[36:37], v[36:37]
v_pk_fma_f32 v[6:7], v[38:39], v[38:39], v[6:7]
v_pk_fma_f32 v[6:7], v[40:41], v[40:41], v[6:7]
v_pk_fma_f32 v[6:7], v[42:43], v[42:43], v[6:7]
v_pk_fma_f32 v[6:7], v[44:45], v[44:45], v[6:7]
v_pk_fma_f32 v[6:7], v[46:47], v[46:47], v[6:7]
v_pk_fma_f32 v[6:7], v[48:49], v[48:49], v[6:7]
v_pk_fma_f32 v[6:7], v[50:51], v[50:51], v[6:7]
v_pk_fma_f32 v[6:7], v[52:53], v[52:53], v[6:7]
v_pk_fma_f32 v[6:7], v[54:55], v[54:55], v[6:7]
v_pk_fma_f32 v[6:7], v[56:57], v[56:57], v[6:7]
v_pk_fma_f32 v[6:7], v[58:59], v[58:59], v[6:7]
v_pk_fma_f32 v[6:7], v[60:61], v[60:61], v[6:7]
v_pk_fma_f32 v[6:7], v[62:63], v[62:63], v[6:7]
v_pk_fma_f32 v[6:7], v[64:65], v[64:65], v[6:7]
v_pk_fma_f32 v[6:7], v[66:67], v[66:67], v[6:7]
v_pk_fma_f32 v[6:7], v[68:69], v[68:69], v[6:7]
v_pk_fma_f32 v[6:7], v[70:71], v[70:71], v[6:7]
v_pk_fma_f32 v[6:7], v[72:73], v[72:73], v[6:7]
v_pk_fma_f32 v[6:7], v[74:75], v[74:75], v[6:7]
v_add_f32 v4, v6, v7
s_nop 1
v_add_f32_dpp v4, v4, v4 row_ror:8 row_mask:0xf bank_mask:0xf
v_mov_b32 v2, v4
s_nop 1
v_permlane16_swap_b32 v4, v2
v_add_f32 v4, v4, v2
v_mov_b32 v2, v4
s_nop 1
v_permlane32_swap_b32 v4, v2
v_add_f32 v4, v4, v2
ds_write_b32 v1, v4 offset:64
s_waitcnt lgkmcnt(0)
s_barrier
ds_read_b32 v4, v5 offset:64
ds_read_b32 v2, v5 offset:96
s_waitcnt lgkmcnt(0)
v_add_f32 v4, v4, v2
v_mov_b32 v2, 0x3727c5ac
v_fmac_f32 v2, 0x3acccccd, v4
v_rsq_f32 v6, v2
s_nop 0
v_mov_b32 v7, v6
v_pk_mul_f32 v[36:37], v[36:37], v[6:7]
v_pk_mul_f32 v[38:39], v[38:39], v[6:7]
v_pk_mul_f32 v[40:41], v[40:41], v[6:7]
v_pk_mul_f32 v[42:43], v[42:43], v[6:7]
v_pk_mul_f32 v[44:45], v[44:45], v[6:7]
v_pk_mul_f32 v[46:47], v[46:47], v[6:7]
v_pk_mul_f32 v[48:49], v[48:49], v[6:7]
v_pk_mul_f32 v[50:51], v[50:51], v[6:7]
v_pk_mul_f32 v[52:53], v[52:53], v[6:7]
v_pk_mul_f32 v[54:55], v[54:55], v[6:7]
v_pk_mul_f32 v[56:57], v[56:57], v[6:7]
v_pk_mul_f32 v[58:59], v[58:59], v[6:7]
v_pk_mul_f32 v[60:61], v[60:61], v[6:7]
v_pk_mul_f32 v[62:63], v[62:63], v[6:7]
v_pk_mul_f32 v[64:65], v[64:65], v[6:7]
v_pk_mul_f32 v[66:67], v[66:67], v[6:7]
v_pk_mul_f32 v[68:69], v[68:69], v[6:7]
v_pk_mul_f32 v[70:71], v[70:71], v[6:7]
v_pk_mul_f32 v[72:73], v[72:73], v[6:7]
v_pk_mul_f32 v[74:75], v[74:75], v[6:7]
v_cvt_pk_bf16_f32 v16, v36, v37
v_cvt_pk_bf16_f32 v17, v38, v39
v_cvt_pk_bf16_f32 v18, v40, v41
v_cvt_pk_bf16_f32 v19, v42, v43
v_cvt_pk_bf16_f32 v20, v44, v45
v_cvt_pk_bf16_f32 v21, v46, v47
v_cvt_pk_bf16_f32 v22, v48, v49
v_cvt_pk_bf16_f32 v23, v50, v51
v_cvt_pk_bf16_f32 v24, v52, v53
v_cvt_pk_bf16_f32 v25, v54, v55
v_cvt_pk_bf16_f32 v26, v56, v57
v_cvt_pk_bf16_f32 v27, v58, v59
v_cvt_pk_bf16_f32 v28, v60, v61
v_cvt_pk_bf16_f32 v29, v62, v63
v_cvt_pk_bf16_f32 v30, v64, v65
v_cvt_pk_bf16_f32 v31, v66, v67
v_cvt_pk_bf16_f32 v32, v68, v69
v_cvt_pk_bf16_f32 v33, v70, v71
v_cvt_pk_bf16_f32 v34, v72, v73
v_cvt_pk_bf16_f32 v35, v74, v75
v_add_u32 v6, 0x1000, v14
v_add_u32 v7, 0x2000, v14
buffer_store_dwordx4 v[16:19], v14, s[4:7], s34 offen offset:0 sc1
buffer_store_dwordx4 v[20:23], v14, s[4:7], s34 offen offset:2048 sc1
buffer_store_dwordx4 v[24:27], v6, s[4:7], s34 offen offset:0 sc1
buffer_store_dwordx4 v[28:31], v6, s[4:7], s34 offen offset:2048 sc1
buffer_store_dwordx4 v[32:35], v7, s[4:7], s34 offen offset:0 sc1
redln1_exit1:
s_endpgm
.globl redln2_kernel
.p2align 8
.type redln2_kernel,@function
redln2_kernel:
s_cmp_ge_u32 s2, 256
s_cbranch_scc1 redln2_exit1
s_load_dwordx2 s[12:13], s[0:1], 96
s_load_dwordx2 s[14:15], s[0:1], 0
v_lshrrev_b32 v2, 6, v0
v_and_b32 v3, 63, v0
s_lshr_b32 s19, s2, 1
v_readfirstlane_b32 s16, v2
s_and_b32 s18, s2, 1
s_waitcnt lgkmcnt(0)
s_mov_b32 s4, s12
s_mov_b32 s5, s13
s_mov_b32 s6, 0x10000000
s_mov_b32 s7, 0x20000
s_mov_b32 s8, s12
s_mov_b32 s9, s13
s_mov_b32 s10, 0x10000000
s_mov_b32 s11, 0x20000
s_mov_b32 s20, 82313216
v_and_b32 v2, 7, v3
v_bfe_u32 v4, v3, 3, 2
v_lshrrev_b32 v5, 5, v3
s_lshl_b32 s17, s18, 7
v_lshlrev_b32 v14, 4, v2
v_lshl_add_u32 v14, v4, 8, v14
v_lshl_add_u32 v14, v5, 10, v14
v_add_u32 v14, s17, v14
s_lshl_b32 s17, s2, 3
v_add_u32 v15, s17, v2
v_mul_u32_u24 v15, 1280, v15
v_lshl_add_u32 v15, v4, 4, v15
v_lshl_add_u32 v15, v5, 6, v15
s_mul_i32 s17, s16, 640
s_add_u32 s20, s20, s17
s_add_u32 s21, s17, 82313216
s_mul_i32 s22, s19, 20
s_mul_i32 s23, s16, 10
s_add_u32 s22, s22, s23
s_lshl_b32 s22, s22, 10
s_add_u32 s34, s22, 54525952
s_add_u32 s22, s22, 90832896
s_add_u32 s24, s22, 0
s_add_u32 s25, s22, 2621440
s_add_u32 s26, s22, 5242880
s_add_u32 s27, s22, 7864320
s_add_u32 s28, s22, 10485760
s_add_u32 s29, s22, 13107200
s_add_u32 s30, s22, 15728640
s_add_u32 s31, s22, 18350080
v_add_u32 v6, 0x1000, v14
v_add_u32 v7, 0x2000, v14
buffer_load_dwordx4 v[16:19], v15, s[8:11], s20 offen offset:0
buffer_load_dwordx4 v[20:23], v15, s[8:11], s20 offen offset:128
buffer_load_dwordx4 v[24:27], v15, s[8:11], s20 offen offset:256
buffer_load_dwordx4 v[28:31], v15, s[8:11], s20 offen offset:384
buffer_load_dwordx4 v[32:35], v15, s[8:11], s20 offen offset:512
buffer_load_dwordx4 v[80:83], v14, s[4:7], s24 offen offset:0
buffer_load_dwordx4 v[84:87], v14, s[4:7], s25 offen offset:0
buffer_load_dwordx4 v[88:91], v14, s[4:7], s26 offen offset:0
buffer_load_dwordx4 v[92:95], v14, s[4:7], s27 offen offset:0
buffer_load_dwordx4 v[96:99], v14, s[4:7], s28 offen offset:0
buffer_load_dwordx4 v[100:103], v14, s[4:7], s29 offen offset:0
buffer_load_dwordx4 v[104:107], v14, s[4:7], s30 offen offset:0
buffer_load_dwordx4 v[108:111], v14, s[4:7], s31 offen offset:0
buffer_load_dwordx4 v[112:115], v14, s[4:7], s24 offen offset:2048
buffer_load_dwordx4 v[116:119], v14, s[4:7], s25 offen offset:2048
buffer_load_dwordx4 v[120:123], v14, s[4:7], s26 offen offset:2048
buffer_load_dwordx4 v[124:127], v14, s[4:7], s27 offen offset:2048
buffer_load_dwordx4 v[128:131], v14, s[4:7], s28 offen offset:2048
buffer_load_dwordx4 v[132:135], v14, s[4:7], s29 offen offset:2048
buffer_load_dwordx4 v[136:139], v14, s[4:7], s30 offen offset:2048
buffer_load_dwordx4 v[140:143], v14, s[4:7], s31 offen offset:2048
buffer_load_dwordx4 v[144:147], v6, s[4:7], s24 offen offset:0
buffer_load_dwordx4 v[148:151], v6, s[4:7], s25 offen offset:0
buffer_load_dwordx4 v[152:155], v6, s[4:7], s26 offen offset:0
buffer_load_dwordx4 v[156:159], v6, s[4:7], s27 offen offset:0
buffer_load_dwordx4 v[160:163], v6, s[4:7], s28 offen offset:0
buffer_load_dwordx4 v[164:167], v6, s[4:7], s29 offen offset:0
buffer_load_dwordx4 v[168:171], v6, s[4:7], s30 offen offset:0
buffer_load_dwordx4 v[172:175], v6, s[4:7], s31 offen offset:0
buffer_load_dwordx4 v[176:179], v6, s[4:7], s24 offen offset:2048
buffer_load_dwordx4 v[180:183], v6, s[4:7], s25 offen offset:2048
buffer_load_dwordx4 v[184:187], v6, s[4:7], s26 offen offset:2048
buffer_load_dwordx4 v[188:191], v6, s[4:7], s27 offen offset:2048
buffer_load_dwordx4 v[192:195], v6, s[4:7], s28 offen offset:2048
buffer_load_dwordx4 v[196:199], v6, s[4:7], s29 offen offset:2048
buffer_load_dwordx4 v[200:203], v6, s[4:7], s30 offen offset:2048
buffer_load_dwordx4 v[204:207], v6, s[4:7], s31 offen offset:2048
buffer_load_dwordx4 v[208:211], v7, s[4:7], s24 offen offset:0
buffer_load_dwordx4 v[212:215], v7, s[4:7], s25 offen offset:0
buffer_load_dwordx4 v[216:219], v7, s[4:7], s26 offen offset:0
buffer_load_dwordx4 v[220:223], v7, s[4:7], s27 offen offset:0
buffer_load_dwordx4 v[224:227], v7, s[4:7], s28 offen offset:0
buffer_load_dwordx4 v[228:231], v7, s[4:7], s29 offen offset:0
buffer_load_dwordx4 v[232:235], v7, s[4:7], s30 offen offset:0
buffer_load_dwordx4 v[236:239], v7, s[4:7], s31 offen offset:0
s_waitcnt vmcnt(32)
v_lshlrev_b32 v36, 16, v80
v_and_b32 v37, 0xffff0000, v80
v_lshlrev_b32 v38, 16, v81
v_and_b32 v39, 0xffff0000, v81
v_lshlrev_b32 v40, 16, v82
v_and_b32 v41, 0xffff0000, v82
v_lshlrev_b32 v42, 16, v83
v_and_b32 v43, 0xffff0000, v83
v_lshlrev_b32 v8, 16, v84
v_and_b32 v9, 0xffff0000, v84
v_pk_add_f32 v[36:37], v[36:37], v[8:9]
v_lshlrev_b32 v10, 16, v85
v_and_b32 v11, 0xffff0000, v85
v_pk_add_f32 v[38:39], v[38:39], v[10:11]
v_lshlrev_b32 v8, 16, v86
v_and_b32 v9, 0xffff0000, v86
v_pk_add_f32 v[40:41], v[40:41], v[8:9]
v_lshlrev_b32 v10, 16, v87
v_and_b32 v11, 0xffff0000, v87
v_pk_add_f32 v[42:43], v[42:43], v[10:11]
v_lshlrev_b32 v8, 16, v88
v_and_b32 v9, 0xffff0000, v88
v_pk_add_f32 v[36:37], v[36:37], v[8:9]
v_lshlrev_b32 v10, 16, v89
v_and_b32 v11, 0xffff0000, v89
v_pk_add_f32 v[38:39], v[38:39], v[10:11]
v_lshlrev_b32 v8, 16, v90
v_and_b32 v9, 0xffff0000, v90
v_pk_add_f32 v[40:41], v[40:41], v[8:9]
v_lshlrev_b32 v10, 16, v91
v_and_b32 v11, 0xffff0000, v91
v_pk_add_f32 v[42:43], v[42:43], v[10:11]
v_lshlrev_b32 v8, 16, v92
v_and_b32 v9, 0xffff0000, v92
v_pk_add_f32 v[36:37], v[36:37], v[8:9]
v_lshlrev_b32 v10, 16, v93
v_and_b32 v11, 0xffff0000, v93
v_pk_add_f32 v[38:39], v[38:39], v[10:11]
v_lshlrev_b32 v8, 16, v94
v_and_b32 v9, 0xffff0000, v94
v_pk_add_f32 v[40:41], v[40:41], v[8:9]
v_lshlrev_b32 v10, 16, v95
v_and_b32 v11, 0xffff0000, v95
v_pk_add_f32 v[42:43], v[42:43], v[10:11]
v_lshlrev_b32 v8, 16, v96
v_and_b32 v9, 0xffff0000, v96
v_pk_add_f32 v[36:37], v[36:37], v[8:9]
v_lshlrev_b32 v10, 16, v97
v_and_b32 v11, 0xffff0000, v97
v_pk_add_f32 v[38:39], v[38:39], v[10:11]
v_lshlrev_b32 v8, 16, v98
v_and_b32 v9, 0xffff0000, v98
v_pk_add_f32 v[40:41], v[40:41], v[8:9]
v_lshlrev_b32 v10, 16, v99
v_and_b32 v11, 0xffff0000, v99
v_pk_add_f32 v[42:43], v[42:43], v[10:11]
v_lshlrev_b32 v8, 16, v100
v_and_b32 v9, 0xffff0000, v100
v_pk_add_f32 v[36:37], v[36:37], v[8:9]
v_lshlrev_b32 v10, 16, v101
v_and_b32 v11, 0xffff0000, v101
v_pk_add_f32 v[38:39], v[38:39], v[10:11]
v_lshlrev_b32 v8, 16, v102
v_and_b32 v9, 0xffff0000, v102
v_pk_add_f32 v[40:41], v[40:41], v[8:9]
v_lshlrev_b32 v10, 16, v103
v_and_b32 v11, 0xffff0000, v103
v_pk_add_f32 v[42:43], v[42:43], v[10:11]
v_lshlrev_b32 v8, 16, v104
v_and_b32 v9, 0xffff0000, v104
v_pk_add_f32 v[36:37], v[36:37], v[8:9]
v_lshlrev_b32 v10, 16, v105
v_and_b32 v11, 0xffff0000, v105
v_pk_add_f32 v[38:39], v[38:39], v[10:11]
v_lshlrev_b32 v8, 16, v106
v_and_b32 v9, 0xffff0000, v106
v_pk_add_f32 v[40:41], v[40:41], v[8:9]
v_lshlrev_b32 v10, 16, v107
v_and_b32 v11, 0xffff0000, v107
v_pk_add_f32 v[42:43], v[42:43], v[10:11]
v_lshlrev_b32 v8, 16, v108
v_and_b32 v9, 0xffff0000, v108
v_pk_add_f32 v[36:37], v[36:37], v[8:9]
v_lshlrev_b32 v10, 16, v109
v_and_b32 v11, 0xffff0000, v109
v_pk_add_f32 v[38:39], v[38:39], v[10:11]
v_lshlrev_b32 v8, 16, v110
v_and_b32 v9, 0xffff0000, v110
v_pk_add_f32 v[40:41], v[40:41], v[8:9]
v_lshlrev_b32 v10, 16, v111
v_and_b32 v11, 0xffff0000, v111
v_pk_add_f32 v[42:43], v[42:43], v[10:11]
v_cvt_pk_bf16_f32 v8, v36, v37
v_lshlrev_b32 v36, 16, v8
v_and_b32 v37, 0xffff0000, v8
v_lshlrev_b32 v10, 16, v16
v_and_b32 v11, 0xffff0000, v16
v_pk_add_f32 v[36:37], v[36:37], v[10:11]
v_cvt_pk_bf16_f32 v16, v36, v37
v_lshlrev_b32 v36, 16, v16
v_and_b32 v37, 0xffff0000, v16
v_cvt_pk_bf16_f32 v8, v38, v39
v_lshlrev_b32 v38, 16, v8
v_and_b32 v39, 0xffff0000, v8
v_lshlrev_b32 v10, 16, v17
v_and_b32 v11, 0xffff0000, v17
v_pk_add_f32 v[38:39], v[38:39], v[10:11]
v_cvt_pk_bf16_f32 v17, v38, v39
v_lshlrev_b32 v38, 16, v17
v_and_b32 v39, 0xffff0000, v17
v_cvt_pk_bf16_f32 v8, v40, v41
v_lshlrev_b32 v40, 16, v8
v_and_b32 v41, 0xffff0000, v8
v_lshlrev_b32 v10, 16, v18
v_and_b32 v11, 0xffff0000, v18
v_pk_add_f32 v[40:41], v[40:41], v[10:11]
v_cvt_pk_bf16_f32 v18, v40, v41
v_lshlrev_b32 v40, 16, v18
v_and_b32 v41, 0xffff0000, v18
v_cvt_pk_bf16_f32 v8, v42, v43
v_lshlrev_b32 v42, 16, v8
v_and_b32 v43, 0xffff0000, v8
v_lshlrev_b32 v10, 16, v19
v_and_b32 v11, 0xffff0000, v19
v_pk_add_f32 v[42:43], v[42:43], v[10:11]
v_cvt_pk_bf16_f32 v19, v42, v43
v_lshlrev_b32 v42, 16, v19
v_and_b32 v43, 0xffff0000, v19
buffer_store_dwordx4 v[16:19], v15, s[4:7], s21 offen offset:0 sc1
s_waitcnt vmcnt(25)
v_lshlrev_b32 v44, 16, v112
v_and_b32 v45, 0xffff0000, v112
v_lshlrev_b32 v46, 16, v113
v_and_b32 v47, 0xffff0000, v113
v_lshlrev_b32 v48, 16, v114
v_and_b32 v49, 0xffff0000, v114
v_lshlrev_b32 v50, 16, v115
v_and_b32 v51, 0xffff0000, v115
v_lshlrev_b32 v8, 16, v116
v_and_b32 v9, 0xffff0000, v116
v_pk_add_f32 v[44:45], v[44:45], v[8:9]
v_lshlrev_b32 v10, 16, v117
v_and_b32 v11, 0xffff0000, v117
v_pk_add_f32 v[46:47], v[46:47], v[10:11]
v_lshlrev_b32 v8, 16, v118
v_and_b32 v9, 0xffff0000, v118
v_pk_add_f32 v[48:49], v[48:49], v[8:9]
v_lshlrev_b32 v10, 16, v119
v_and_b32 v11, 0xffff0000, v119
v_pk_add_f32 v[50:51], v[50:51], v[10:11]
v_lshlrev_b32 v8, 16, v120
v_and_b32 v9, 0xffff0000, v120
v_pk_add_f32 v[44:45], v[44:45], v[8:9]
v_lshlrev_b32 v10, 16, v121
v_and_b32 v11, 0xffff0000, v121
v_pk_add_f32 v[46:47], v[46:47], v[10:11]
v_lshlrev_b32 v8, 16, v122
v_and_b32 v9, 0xffff0000, v122
v_pk_add_f32 v[48:49], v[48:49], v[8:9]
v_lshlrev_b32 v10, 16, v123
v_and_b32 v11, 0xffff0000, v123
v_pk_add_f32 v[50:51], v[50:51], v[10:11]
v_lshlrev_b32 v8, 16, v124
v_and_b32 v9, 0xffff0000, v124
v_pk_add_f32 v[44:45], v[44:45], v[8:9]
v_lshlrev_b32 v10, 16, v125
v_and_b32 v11, 0xffff0000, v125
v_pk_add_f32 v[46:47], v[46:47], v[10:11]
v_lshlrev_b32 v8, 16, v126
v_and_b32 v9, 0xffff0000, v126
v_pk_add_f32 v[48:49], v[48:49], v[8:9]
v_lshlrev_b32 v10, 16, v127
v_and_b32 v11, 0xffff0000, v127
v_pk_add_f32 v[50:51], v[50:51], v[10:11]
v_lshlrev_b32 v8, 16, v128
v_and_b32 v9, 0xffff0000, v128
v_pk_add_f32 v[44:45], v[44:45], v[8:9]
v_lshlrev_b32 v10, 16, v129
v_and_b32 v11, 0xffff0000, v129
v_pk_add_f32 v[46:47], v[46:47], v[10:11]
v_lshlrev_b32 v8, 16, v130
v_and_b32 v9, 0xffff0000, v130
v_pk_add_f32 v[48:49], v[48:49], v[8:9]
v_lshlrev_b32 v10, 16, v131
v_and_b32 v11, 0xffff0000, v131
v_pk_add_f32 v[50:51], v[50:51], v[10:11]
v_lshlrev_b32 v8, 16, v132
v_and_b32 v9, 0xffff0000, v132
v_pk_add_f32 v[44:45], v[44:45], v[8:9]
v_lshlrev_b32 v10, 16, v133
v_and_b32 v11, 0xffff0000, v133
v_pk_add_f32 v[46:47], v[46:47], v[10:11]
v_lshlrev_b32 v8, 16, v134
v_and_b32 v9, 0xffff0000, v134
v_pk_add_f32 v[48:49], v[48:49], v[8:9]
v_lshlrev_b32 v10, 16, v135
v_and_b32 v11, 0xffff0000, v135
v_pk_add_f32 v[50:51], v[50:51], v[10:11]
v_lshlrev_b32 v8, 16, v136
v_and_b32 v9, 0xffff0000, v136
v_pk_add_f32 v[44:45], v[44:45], v[8:9]
v_lshlrev_b32 v10, 16, v137
v_and_b32 v11, 0xffff0000, v137
v_pk_add_f32 v[46:47], v[46:47], v[10:11]
v_lshlrev_b32 v8, 16, v138
v_and_b32 v9, 0xffff0000, v138
v_pk_add_f32 v[48:49], v[48:49], v[8:9]
v_lshlrev_b32 v10, 16, v139
v_and_b32 v11, 0xffff0000, v139
v_pk_add_f32 v[50:51], v[50:51], v[10:11]
v_lshlrev_b32 v8, 16, v140
v_and_b32 v9, 0xffff0000, v140
v_pk_add_f32 v[44:45], v[44:45], v[8:9]
v_lshlrev_b32 v10, 16, v141
v_and_b32 v11, 0xffff0000, v141
v_pk_add_f32 v[46:47], v[46:47], v[10:11]
v_lshlrev_b32 v8, 16, v142
v_and_b32 v9, 0xffff0000, v142
v_pk_add_f32 v[48:49], v[48:49], v[8:9]
v_lshlrev_b32 v10, 16, v143
v_and_b32 v11, 0xffff0000, v143
v_pk_add_f32 v[50:51], v[50:51], v[10:11]
v_cvt_pk_bf16_f32 v8, v44, v45
v_lshlrev_b32 v44, 16, v8
v_and_b32 v45, 0xffff0000, v8
v_lshlrev_b32 v10, 16, v20
v_and_b32 v11, 0xffff0000, v20
v_pk_add_f32 v[44:45], v[44:45], v[10:11]
v_cvt_pk_bf16_f32 v20, v44, v45
v_lshlrev_b32 v44, 16, v20
v_and_b32 v45, 0xffff0000, v20
v_cvt_pk_bf16_f32 v8, v46, v47
v_lshlrev_b32 v46, 16, v8
v_and_b32 v47, 0xffff0000, v8
v_lshlrev_b32 v10, 16, v21
v_and_b32 v11, 0xffff0000, v21
v_pk_add_f32 v[46:47], v[46:47], v[10:11]
v_cvt_pk_bf16_f32 v21, v46, v47
v_lshlrev_b32 v46, 16, v21
v_and_b32 v47, 0xffff0000, v21
v_cvt_pk_bf16_f32 v8, v48, v49
v_lshlrev_b32 v48, 16, v8
v_and_b32 v49, 0xffff0000, v8
v_lshlrev_b32 v10, 16, v22
v_and_b32 v11, 0xffff0000, v22
v_pk_add_f32 v[48:49], v[48:49], v[10:11]
v_cvt_pk_bf16_f32 v22, v48, v49
v_lshlrev_b32 v48, 16, v22
v_and_b32 v49, 0xffff0000, v22
v_cvt_pk_bf16_f32 v8, v50, v51
v_lshlrev_b32 v50, 16, v8
v_and_b32 v51, 0xffff0000, v8
v_lshlrev_b32 v10, 16, v23
v_and_b32 v11, 0xffff0000, v23
v_pk_add_f32 v[50:51], v[50:51], v[10:11]
v_cvt_pk_bf16_f32 v23, v50, v51
v_lshlrev_b32 v50, 16, v23
v_and_b32 v51, 0xffff0000, v23
buffer_store_dwordx4 v[20:23], v15, s[4:7], s21 offen offset:128 sc1
s_waitcnt vmcnt(18)
v_lshlrev_b32 v52, 16, v144
v_and_b32 v53, 0xffff0000, v144
v_lshlrev_b32 v54, 16, v145
v_and_b32 v55, 0xffff0000, v145
v_lshlrev_b32 v56, 16, v146
v_and_b32 v57, 0xffff0000, v146
v_lshlrev_b32 v58, 16, v147
v_and_b32 v59, 0xffff0000, v147
v_lshlrev_b32 v8, 16, v148
v_and_b32 v9, 0xffff0000, v148
v_pk_add_f32 v[52:53], v[52:53], v[8:9]
v_lshlrev_b32 v10, 16, v149
v_and_b32 v11, 0xffff0000, v149
v_pk_add_f32 v[54:55], v[54:55], v[10:11]
v_lshlrev_b32 v8, 16, v150
v_and_b32 v9, 0xffff0000, v150
v_pk_add_f32 v[56:57], v[56:57], v[8:9]
v_lshlrev_b32 v10, 16, v151
v_and_b32 v11, 0xffff0000, v151
v_pk_add_f32 v[58:59], v[58:59], v[10:11]
v_lshlrev_b32 v8, 16, v152
v_and_b32 v9, 0xffff0000, v152
v_pk_add_f32 v[52:53], v[52:53], v[8:9]
v_lshlrev_b32 v10, 16, v153
v_and_b32 v11, 0xffff0000, v153
v_pk_add_f32 v[54:55], v[54:55], v[10:11]
v_lshlrev_b32 v8, 16, v154
v_and_b32 v9, 0xffff0000, v154
v_pk_add_f32 v[56:57], v[56:57], v[8:9]
v_lshlrev_b32 v10, 16, v155
v_and_b32 v11, 0xffff0000, v155
v_pk_add_f32 v[58:59], v[58:59], v[10:11]
v_lshlrev_b32 v8, 16, v156
v_and_b32 v9, 0xffff0000, v156
v_pk_add_f32 v[52:53], v[52:53], v[8:9]
v_lshlrev_b32 v10, 16, v157
v_and_b32 v11, 0xffff0000, v157
v_pk_add_f32 v[54:55], v[54:55], v[10:11]
v_lshlrev_b32 v8, 16, v158
v_and_b32 v9, 0xffff0000, v158
v_pk_add_f32 v[56:57], v[56:57], v[8:9]
v_lshlrev_b32 v10, 16, v159
v_and_b32 v11, 0xffff0000, v159
v_pk_add_f32 v[58:59], v[58:59], v[10:11]
v_lshlrev_b32 v8, 16, v160
v_and_b32 v9, 0xffff0000, v160
v_pk_add_f32 v[52:53], v[52:53], v[8:9]
v_lshlrev_b32 v10, 16, v161
v_and_b32 v11, 0xffff0000, v161
v_pk_add_f32 v[54:55], v[54:55], v[10:11]
v_lshlrev_b32 v8, 16, v162
v_and_b32 v9, 0xffff0000, v162
v_pk_add_f32 v[56:57], v[56:57], v[8:9]
v_lshlrev_b32 v10, 16, v163
v_and_b32 v11, 0xffff0000, v163
v_pk_add_f32 v[58:59], v[58:59], v[10:11]
v_lshlrev_b32 v8, 16, v164
v_and_b32 v9, 0xffff0000, v164
v_pk_add_f32 v[52:53], v[52:53], v[8:9]
v_lshlrev_b32 v10, 16, v165
v_and_b32 v11, 0xffff0000, v165
v_pk_add_f32 v[54:55], v[54:55], v[10:11]
v_lshlrev_b32 v8, 16, v166
v_and_b32 v9, 0xffff0000, v166
v_pk_add_f32 v[56:57], v[56:57], v[8:9]
v_lshlrev_b32 v10, 16, v167
v_and_b32 v11, 0xffff0000, v167
v_pk_add_f32 v[58:59], v[58:59], v[10:11]
v_lshlrev_b32 v8, 16, v168
v_and_b32 v9, 0xffff0000, v168
v_pk_add_f32 v[52:53], v[52:53], v[8:9]
v_lshlrev_b32 v10, 16, v169
v_and_b32 v11, 0xffff0000, v169
v_pk_add_f32 v[54:55], v[54:55], v[10:11]
v_lshlrev_b32 v8, 16, v170
v_and_b32 v9, 0xffff0000, v170
v_pk_add_f32 v[56:57], v[56:57], v[8:9]
v_lshlrev_b32 v10, 16, v171
v_and_b32 v11, 0xffff0000, v171
v_pk_add_f32 v[58:59], v[58:59], v[10:11]
v_lshlrev_b32 v8, 16, v172
v_and_b32 v9, 0xffff0000, v172
v_pk_add_f32 v[52:53], v[52:53], v[8:9]
v_lshlrev_b32 v10, 16, v173
v_and_b32 v11, 0xffff0000, v173
v_pk_add_f32 v[54:55], v[54:55], v[10:11]
v_lshlrev_b32 v8, 16, v174
v_and_b32 v9, 0xffff0000, v174
v_pk_add_f32 v[56:57], v[56:57], v[8:9]
v_lshlrev_b32 v10, 16, v175
v_and_b32 v11, 0xffff0000, v175
v_pk_add_f32 v[58:59], v[58:59], v[10:11]
v_cvt_pk_bf16_f32 v8, v52, v53
v_lshlrev_b32 v52, 16, v8
v_and_b32 v53, 0xffff0000, v8
v_lshlrev_b32 v10, 16, v24
v_and_b32 v11, 0xffff0000, v24
v_pk_add_f32 v[52:53], v[52:53], v[10:11]
v_cvt_pk_bf16_f32 v24, v52, v53
v_lshlrev_b32 v52, 16, v24
v_and_b32 v53, 0xffff0000, v24
v_cvt_pk_bf16_f32 v8, v54, v55
v_lshlrev_b32 v54, 16, v8
v_and_b32 v55, 0xffff0000, v8
v_lshlrev_b32 v10, 16, v25
v_and_b32 v11, 0xffff0000, v25
v_pk_add_f32 v[54:55], v[54:55], v[10:11]
v_cvt_pk_bf16_f32 v25, v54, v55
v_lshlrev_b32 v54, 16, v25
v_and_b32 v55, 0xffff0000, v25
v_cvt_pk_bf16_f32 v8, v56, v57
v_lshlrev_b32 v56, 16, v8
v_and_b32 v57, 0xffff0000, v8
v_lshlrev_b32 v10, 16, v26
v_and_b32 v11, 0xffff0000, v26
v_pk_add_f32 v[56:57], v[56:57], v[10:11]
v_cvt_pk_bf16_f32 v26, v56, v57
v_lshlrev_b32 v56, 16, v26
v_and_b32 v57, 0xffff0000, v26
v_cvt_pk_bf16_f32 v8, v58, v59
v_lshlrev_b32 v58, 16, v8
v_and_b32 v59, 0xffff0000, v8
v_lshlrev_b32 v10, 16, v27
v_and_b32 v11, 0xffff0000, v27
v_pk_add_f32 v[58:59], v[58:59], v[10:11]
v_cvt_pk_bf16_f32 v27, v58, v59
v_lshlrev_b32 v58, 16, v27
v_and_b32 v59, 0xffff0000, v27
buffer_store_dwordx4 v[24:27], v15, s[4:7], s21 offen offset:256 sc1
s_waitcnt vmcnt(11)
v_lshlrev_b32 v60, 16, v176
v_and_b32 v61, 0xffff0000, v176
v_lshlrev_b32 v62, 16, v177
v_and_b32 v63, 0xffff0000, v177
v_lshlrev_b32 v64, 16, v178
v_and_b32 v65, 0xffff0000, v178
v_lshlrev_b32 v66, 16, v179
v_and_b32 v67, 0xffff0000, v179
v_lshlrev_b32 v8, 16, v180
v_and_b32 v9, 0xffff0000, v180
v_pk_add_f32 v[60:61], v[60:61], v[8:9]
v_lshlrev_b32 v10, 16, v181
v_and_b32 v11, 0xffff0000, v181
v_pk_add_f32 v[62:63], v[62:63], v[10:11]
v_lshlrev_b32 v8, 16, v182
v_and_b32 v9, 0xffff0000, v182
v_pk_add_f32 v[64:65], v[64:65], v[8:9]
v_lshlrev_b32 v10, 16, v183
v_and_b32 v11, 0xffff0000, v183
v_pk_add_f32 v[66:67], v[66:67], v[10:11]
v_lshlrev_b32 v8, 16, v184
v_and_b32 v9, 0xffff0000, v184
v_pk_add_f32 v[60:61], v[60:61], v[8:9]
v_lshlrev_b32 v10, 16, v185
v_and_b32 v11, 0xffff0000, v185
v_pk_add_f32 v[62:63], v[62:63], v[10:11]
v_lshlrev_b32 v8, 16, v186
v_and_b32 v9, 0xffff0000, v186
v_pk_add_f32 v[64:65], v[64:65], v[8:9]
v_lshlrev_b32 v10, 16, v187
v_and_b32 v11, 0xffff0000, v187
v_pk_add_f32 v[66:67], v[66:67], v[10:11]
v_lshlrev_b32 v8, 16, v188
v_and_b32 v9, 0xffff0000, v188
v_pk_add_f32 v[60:61], v[60:61], v[8:9]
v_lshlrev_b32 v10, 16, v189
v_and_b32 v11, 0xffff0000, v189
v_pk_add_f32 v[62:63], v[62:63], v[10:11]
v_lshlrev_b32 v8, 16, v190
v_and_b32 v9, 0xffff0000, v190
v_pk_add_f32 v[64:65], v[64:65], v[8:9]
v_lshlrev_b32 v10, 16, v191
v_and_b32 v11, 0xffff0000, v191
v_pk_add_f32 v[66:67], v[66:67], v[10:11]
v_lshlrev_b32 v8, 16, v192
v_and_b32 v9, 0xffff0000, v192
v_pk_add_f32 v[60:61], v[60:61], v[8:9]
v_lshlrev_b32 v10, 16, v193
v_and_b32 v11, 0xffff0000, v193
v_pk_add_f32 v[62:63], v[62:63], v[10:11]
v_lshlrev_b32 v8, 16, v194
v_and_b32 v9, 0xffff0000, v194
v_pk_add_f32 v[64:65], v[64:65], v[8:9]
v_lshlrev_b32 v10, 16, v195
v_and_b32 v11, 0xffff0000, v195
v_pk_add_f32 v[66:67], v[66:67], v[10:11]
v_lshlrev_b32 v8, 16, v196
v_and_b32 v9, 0xffff0000, v196
v_pk_add_f32 v[60:61], v[60:61], v[8:9]
v_lshlrev_b32 v10, 16, v197
v_and_b32 v11, 0xffff0000, v197
v_pk_add_f32 v[62:63], v[62:63], v[10:11]
v_lshlrev_b32 v8, 16, v198
v_and_b32 v9, 0xffff0000, v198
v_pk_add_f32 v[64:65], v[64:65], v[8:9]
v_lshlrev_b32 v10, 16, v199
v_and_b32 v11, 0xffff0000, v199
v_pk_add_f32 v[66:67], v[66:67], v[10:11]
v_lshlrev_b32 v8, 16, v200
v_and_b32 v9, 0xffff0000, v200
v_pk_add_f32 v[60:61], v[60:61], v[8:9]
v_lshlrev_b32 v10, 16, v201
v_and_b32 v11, 0xffff0000, v201
v_pk_add_f32 v[62:63], v[62:63], v[10:11]
v_lshlrev_b32 v8, 16, v202
v_and_b32 v9, 0xffff0000, v202
v_pk_add_f32 v[64:65], v[64:65], v[8:9]
v_lshlrev_b32 v10, 16, v203
v_and_b32 v11, 0xffff0000, v203
v_pk_add_f32 v[66:67], v[66:67], v[10:11]
v_lshlrev_b32 v8, 16, v204
v_and_b32 v9, 0xffff0000, v204
v_pk_add_f32 v[60:61], v[60:61], v[8:9]
v_lshlrev_b32 v10, 16, v205
v_and_b32 v11, 0xffff0000, v205
v_pk_add_f32 v[62:63], v[62:63], v[10:11]
v_lshlrev_b32 v8, 16, v206
v_and_b32 v9, 0xffff0000, v206
v_pk_add_f32 v[64:65], v[64:65], v[8:9]
v_lshlrev_b32 v10, 16, v207
v_and_b32 v11, 0xffff0000, v207
v_pk_add_f32 v[66:67], v[66:67], v[10:11]
v_cvt_pk_bf16_f32 v8, v60, v61
v_lshlrev_b32 v60, 16, v8
v_and_b32 v61, 0xffff0000, v8
v_lshlrev_b32 v10, 16, v28
v_and_b32 v11, 0xffff0000, v28
v_pk_add_f32 v[60:61], v[60:61], v[10:11]
v_cvt_pk_bf16_f32 v28, v60, v61
v_lshlrev_b32 v60, 16, v28
v_and_b32 v61, 0xffff0000, v28
v_cvt_pk_bf16_f32 v8, v62, v63
v_lshlrev_b32 v62, 16, v8
v_and_b32 v63, 0xffff0000, v8
v_lshlrev_b32 v10, 16, v29
v_and_b32 v11, 0xffff0000, v29
v_pk_add_f32 v[62:63], v[62:63], v[10:11]
v_cvt_pk_bf16_f32 v29, v62, v63
v_lshlrev_b32 v62, 16, v29
v_and_b32 v63, 0xffff0000, v29
v_cvt_pk_bf16_f32 v8, v64, v65
v_lshlrev_b32 v64, 16, v8
v_and_b32 v65, 0xffff0000, v8
v_lshlrev_b32 v10, 16, v30
v_and_b32 v11, 0xffff0000, v30
v_pk_add_f32 v[64:65], v[64:65], v[10:11]
v_cvt_pk_bf16_f32 v30, v64, v65
v_lshlrev_b32 v64, 16, v30
v_and_b32 v65, 0xffff0000, v30
v_cvt_pk_bf16_f32 v8, v66, v67
v_lshlrev_b32 v66, 16, v8
v_and_b32 v67, 0xffff0000, v8
v_lshlrev_b32 v10, 16, v31
v_and_b32 v11, 0xffff0000, v31
v_pk_add_f32 v[66:67], v[66:67], v[10:11]
v_cvt_pk_bf16_f32 v31, v66, v67
v_lshlrev_b32 v66, 16, v31
v_and_b32 v67, 0xffff0000, v31
buffer_store_dwordx4 v[28:31], v15, s[4:7], s21 offen offset:384 sc1
s_waitcnt vmcnt(4)
v_lshlrev_b32 v68, 16, v208
v_and_b32 v69, 0xffff0000, v208
v_lshlrev_b32 v70, 16, v209
v_and_b32 v71, 0xffff0000, v209
v_lshlrev_b32 v72, 16, v210
v_and_b32 v73, 0xffff0000, v210
v_lshlrev_b32 v74, 16, v211
v_and_b32 v75, 0xffff0000, v211
v_lshlrev_b32 v8, 16, v212
v_and_b32 v9, 0xffff0000, v212
v_pk_add_f32 v[68:69], v[68:69], v[8:9]
v_lshlrev_b32 v10, 16, v213
v_and_b32 v11, 0xffff0000, v213
v_pk_add_f32 v[70:71], v[70:71], v[10:11]
v_lshlrev_b32 v8, 16, v214
v_and_b32 v9, 0xffff0000, v214
v_pk_add_f32 v[72:73], v[72:73], v[8:9]
v_lshlrev_b32 v10, 16, v215
v_and_b32 v11, 0xffff0000, v215
v_pk_add_f32 v[74:75], v[74:75], v[10:11]
v_lshlrev_b32 v8, 16, v216
v_and_b32 v9, 0xffff0000, v216
v_pk_add_f32 v[68:69], v[68:69], v[8:9]
v_lshlrev_b32 v10, 16, v217
v_and_b32 v11, 0xffff0000, v217
v_pk_add_f32 v[70:71], v[70:71], v[10:11]
v_lshlrev_b32 v8, 16, v218
v_and_b32 v9, 0xffff0000, v218
v_pk_add_f32 v[72:73], v[72:73], v[8:9]
v_lshlrev_b32 v10, 16, v219
v_and_b32 v11, 0xffff0000, v219
v_pk_add_f32 v[74:75], v[74:75], v[10:11]
v_lshlrev_b32 v8, 16, v220
v_and_b32 v9, 0xffff0000, v220
v_pk_add_f32 v[68:69], v[68:69], v[8:9]
v_lshlrev_b32 v10, 16, v221
v_and_b32 v11, 0xffff0000, v221
v_pk_add_f32 v[70:71], v[70:71], v[10:11]
v_lshlrev_b32 v8, 16, v222
v_and_b32 v9, 0xffff0000, v222
v_pk_add_f32 v[72:73], v[72:73], v[8:9]
v_lshlrev_b32 v10, 16, v223
v_and_b32 v11, 0xffff0000, v223
v_pk_add_f32 v[74:75], v[74:75], v[10:11]
v_lshlrev_b32 v8, 16, v224
v_and_b32 v9, 0xffff0000, v224
v_pk_add_f32 v[68:69], v[68:69], v[8:9]
v_lshlrev_b32 v10, 16, v225
v_and_b32 v11, 0xffff0000, v225
v_pk_add_f32 v[70:71], v[70:71], v[10:11]
v_lshlrev_b32 v8, 16, v226
v_and_b32 v9, 0xffff0000, v226
v_pk_add_f32 v[72:73], v[72:73], v[8:9]
v_lshlrev_b32 v10, 16, v227
v_and_b32 v11, 0xffff0000, v227
v_pk_add_f32 v[74:75], v[74:75], v[10:11]
v_lshlrev_b32 v8, 16, v228
v_and_b32 v9, 0xffff0000, v228
v_pk_add_f32 v[68:69], v[68:69], v[8:9]
v_lshlrev_b32 v10, 16, v229
v_and_b32 v11, 0xffff0000, v229
v_pk_add_f32 v[70:71], v[70:71], v[10:11]
v_lshlrev_b32 v8, 16, v230
v_and_b32 v9, 0xffff0000, v230
v_pk_add_f32 v[72:73], v[72:73], v[8:9]
v_lshlrev_b32 v10, 16, v231
v_and_b32 v11, 0xffff0000, v231
v_pk_add_f32 v[74:75], v[74:75], v[10:11]
v_lshlrev_b32 v8, 16, v232
v_and_b32 v9, 0xffff0000, v232
v_pk_add_f32 v[68:69], v[68:69], v[8:9]
v_lshlrev_b32 v10, 16, v233
v_and_b32 v11, 0xffff0000, v233
v_pk_add_f32 v[70:71], v[70:71], v[10:11]
v_lshlrev_b32 v8, 16, v234
v_and_b32 v9, 0xffff0000, v234
v_pk_add_f32 v[72:73], v[72:73], v[8:9]
v_lshlrev_b32 v10, 16, v235
v_and_b32 v11, 0xffff0000, v235
v_pk_add_f32 v[74:75], v[74:75], v[10:11]
v_lshlrev_b32 v8, 16, v236
v_and_b32 v9, 0xffff0000, v236
v_pk_add_f32 v[68:69], v[68:69], v[8:9]
v_lshlrev_b32 v10, 16, v237
v_and_b32 v11, 0xffff0000, v237
v_pk_add_f32 v[70:71], v[70:71], v[10:11]
v_lshlrev_b32 v8, 16, v238
v_and_b32 v9, 0xffff0000, v238
v_pk_add_f32 v[72:73], v[72:73], v[8:9]
v_lshlrev_b32 v10, 16, v239
v_and_b32 v11, 0xffff0000, v239
v_pk_add_f32 v[74:75], v[74:75], v[10:11]
v_cvt_pk_bf16_f32 v8, v68, v69
v_lshlrev_b32 v68, 16, v8
v_and_b32 v69, 0xffff0000, v8
v_lshlrev_b32 v10, 16, v32
v_and_b32 v11, 0xffff0000, v32
v_pk_add_f32 v[68:69], v[68:69], v[10:11]
v_cvt_pk_bf16_f32 v32, v68, v69
v_lshlrev_b32 v68, 16, v32
v_and_b32 v69, 0xffff0000, v32
v_cvt_pk_bf16_f32 v8, v70, v71
v_lshlrev_b32 v70, 16, v8
v_and_b32 v71, 0xffff0000, v8
v_lshlrev_b32 v10, 16, v33
v_and_b32 v11, 0xffff0000, v33
v_pk_add_f32 v[70:71], v[70:71], v[10:11]
v_cvt_pk_bf16_f32 v33, v70, v71
v_lshlrev_b32 v70, 16, v33
v_and_b32 v71, 0xffff0000, v33
v_cvt_pk_bf16_f32 v8, v72, v73
v_lshlrev_b32 v72, 16, v8
v_and_b32 v73, 0xffff0000, v8
v_lshlrev_b32 v10, 16, v34
v_and_b32 v11, 0xffff0000, v34
v_pk_add_f32 v[72:73], v[72:73], v[10:11]
v_cvt_pk_bf16_f32 v34, v72, v73
v_lshlrev_b32 v72, 16, v34
v_and_b32 v73, 0xffff0000, v34
v_cvt_pk_bf16_f32 v8, v74, v75
v_lshlrev_b32 v74, 16, v8
v_and_b32 v75, 0xffff0000, v8
v_lshlrev_b32 v10, 16, v35
v_and_b32 v11, 0xffff0000, v35
v_pk_add_f32 v[74:75], v[74:75], v[10:11]
v_cvt_pk_bf16_f32 v35, v74, v75
v_lshlrev_b32 v74, 16, v35
v_and_b32 v75, 0xffff0000, v35
buffer_store_dwordx4 v[32:35], v15, s[4:7], s21 offen offset:512 sc1
v_and_b32 v3, 63, v0
v_and_b32 v2, 7, v3
v_lshlrev_b32 v5, 2, v2
s_lshl_b32 s17, s16, 5
v_add_u32 v1, s17, v5
v_pk_add_f32 v[6:7], v[36:37], v[38:39]
v_pk_add_f32 v[6:7], v[6:7], v[40:41]
v_pk_add_f32 v[6:7], v[6:7], v[42:43]
v_pk_add_f32 v[6:7], v[6:7], v[44:45]
v_pk_add_f32 v[6:7], v[6:7], v[46:47]
v_pk_add_f32 v[6:7], v[6:7], v[48:49]
v_pk_add_f32 v[6:7], v[6:7], v[50:51]
v_pk_add_f32 v[6:7], v[6:7], v[52:53]
v_pk_add_f32 v[6:7], v[6:7], v[54:55]
v_pk_add_f32 v[6:7], v[6:7], v[56:57]
v_pk_add_f32 v[6:7], v[6:7], v[58:59]
v_pk_add_f32 v[6:7], v[6:7], v[60:61]
v_pk_add_f32 v[6:7], v[6:7], v[62:63]
v_pk_add_f32 v[6:7], v[6:7], v[64:65]
v_pk_add_f32 v[6:7], v[6:7], v[66:67]
v_pk_add_f32 v[6:7], v[6:7], v[68:69]
v_pk_add_f32 v[6:7], v[6:7], v[70:71]
v_pk_add_f32 v[6:7], v[6:7], v[72:73]
v_pk_add_f32 v[6:7], v[6:7], v[74:75]
v_add_f32 v4, v6, v7
s_nop 1
v_add_f32_dpp v4, v4, v4 row_ror:8 row_mask:0xf bank_mask:0xf
v_mov_b32 v2, v4
s_nop 1
v_permlane16_swap_b32 v4, v2
v_add_f32 v4, v4, v2
v_mov_b32 v2, v4
s_nop 1
v_permlane32_swap_b32 v4, v2
v_add_f32 v4, v4, v2
ds_write_b32 v1, v4 offset:0
s_waitcnt lgkmcnt(0)
s_barrier
ds_read_b32 v4, v5 offset:0
ds_read_b32 v2, v5 offset:32
s_waitcnt lgkmcnt(0)
v_add_f32 v4, v4, v2
v_mul_f32 v6, 0xbacccccd, v4
v_mov_b32 v7, v6
v_pk_add_f32 v[36:37], v[36:37], v[6:7]
v_pk_add_f32 v[38:39], v[38:39], v[6:7]
v_pk_add_f32 v[40:41], v[40:41], v[6:7]
v_pk_add_f32 v[42:43], v[42:43], v[6:7]
v_pk_add_f32 v[44:45], v[44:45], v[6:7]
v_pk_add_f32 v[46:47], v[46:47], v[6:7]
v_pk_add_f32 v[48:49], v[48:49], v[6:7]
v_pk_add_f32 v[50:51], v[50:51], v[6:7]
v_pk_add_f32 v[52:53], v[52:53], v[6:7]
v_pk_add_f32 v[54:55], v[54:55], v[6:7]
v_pk_add_f32 v[56:57], v[56:57], v[6:7]
v_pk_add_f32 v[58:59], v[58:59], v[6:7]
v_pk_add_f32 v[60:61], v[60:61], v[6:7]
v_pk_add_f32 v[62:63], v[62:63], v[6:7]
v_pk_add_f32 v[64:65], v[64:65], v[6:7]
v_pk_add_f32 v[66:67], v[66:67], v[6:7]
v_pk_add_f32 v[68:69], v[68:69], v[6:7]
v_pk_add_f32 v[70:71], v[70:71], v[6:7]
v_pk_add_f32 v[72:73], v[72:73], v[6:7]
v_pk_add_f32 v[74:75], v[74:75], v[6:7]
v_pk_mul_f32 v[6:7], v[36:37], v[36:37]
v_pk_fma_f32 v[6:7], v[38:39], v[38:39], v[6:7]
v_pk_fma_f32 v[6:7], v[40:41], v[40:41], v[6:7]
v_pk_fma_f32 v[6:7], v[42:43], v[42:43], v[6:7]
v_pk_fma_f32 v[6:7], v[44:45], v[44:45], v[6:7]
v_pk_fma_f32 v[6:7], v[46:47], v[46:47], v[6:7]
v_pk_fma_f32 v[6:7], v[48:49], v[48:49], v[6:7]
v_pk_fma_f32 v[6:7], v[50:51], v[50:51], v[6:7]
v_pk_fma_f32 v[6:7], v[52:53], v[52:53], v[6:7]
v_pk_fma_f32 v[6:7], v[54:55], v[54:55], v[6:7]
v_pk_fma_f32 v[6:7], v[56:57], v[56:57], v[6:7]
v_pk_fma_f32 v[6:7], v[58:59], v[58:59], v[6:7]
v_pk_fma_f32 v[6:7], v[60:61], v[60:61], v[6:7]
v_pk_fma_f32 v[6:7], v[62:63], v[62:63], v[6:7]
v_pk_fma_f32 v[6:7], v[64:65], v[64:65], v[6:7]
v_pk_fma_f32 v[6:7], v[66:67], v[66:67], v[6:7]
v_pk_fma_f32 v[6:7], v[68:69], v[68:69], v[6:7]
v_pk_fma_f32 v[6:7], v[70:71], v[70:71], v[6:7]
v_pk_fma_f32 v[6:7], v[72:73], v[72:73], v[6:7]
v_pk_fma_f32 v[6:7], v[74:75], v[74:75], v[6:7]
v_add_f32 v4, v6, v7
s_nop 1
v_add_f32_dpp v4, v4, v4 row_ror:8 row_mask:0xf bank_mask:0xf
v_mov_b32 v2, v4
s_nop 1
v_permlane16_swap_b32 v4, v2
v_add_f32 v4, v4, v2
v_mov_b32 v2, v4
s_nop 1
v_permlane32_swap_b32 v4, v2
v_add_f32 v4, v4, v2
ds_write_b32 v1, v4 offset:64
s_waitcnt lgkmcnt(0)
s_barrier
ds_read_b32 v4, v5 offset:64
ds_read_b32 v2, v5 offset:96
s_waitcnt lgkmcnt(0)
v_add_f32 v4, v4, v2
v_mov_b32 v2, 0x3727c5ac
v_fmac_f32 v2, 0x3acccccd, v4
v_rsq_f32 v6, v2
s_nop 0
v_mov_b32 v7, v6
v_pk_mul_f32 v[36:37], v[36:37], v[6:7]
v_pk_mul_f32 v[38:39], v[38:39], v[6:7]
v_pk_mul_f32 v[40:41], v[40:41], v[6:7]
v_pk_mul_f32 v[42:43], v[42:43], v[6:7]
v_pk_mul_f32 v[44:45], v[44:45], v[6:7]
v_pk_mul_f32 v[46:47], v[46:47], v[6:7]
v_pk_mul_f32 v[48:49], v[48:49], v[6:7]
v_pk_mul_f32 v[50:51], v[50:51], v[6:7]
v_pk_mul_f32 v[52:53], v[52:53], v[6:7]
v_pk_mul_f32 v[54:55], v[54:55], v[6:7]
v_pk_mul_f32 v[56:57], v[56:57], v[6:7]
v_pk_mul_f32 v[58:59], v[58:59], v[6:7]
v_pk_mul_f32 v[60:61], v[60:61], v[6:7]
v_pk_mul_f32 v[62:63], v[62:63], v[6:7]
v_pk_mul_f32 v[64:65], v[64:65], v[6:7]
v_pk_mul_f32 v[66:67], v[66:67], v[6:7]
v_pk_mul_f32 v[68:69], v[68:69], v[6:7]
v_pk_mul_f32 v[70:71], v[70:71], v[6:7]
v_pk_mul_f32 v[72:73], v[72:73], v[6:7]
v_pk_mul_f32 v[74:75], v[74:75], v[6:7]
v_cvt_pk_bf16_f32 v16, v36, v37
v_cvt_pk_bf16_f32 v17, v38, v39
v_cvt_pk_bf16_f32 v18, v40, v41
v_cvt_pk_bf16_f32 v19, v42, v43
v_cvt_pk_bf16_f32 v20, v44, v45
v_cvt_pk_bf16_f32 v21, v46, v47
v_cvt_pk_bf16_f32 v22, v48, v49
v_cvt_pk_bf16_f32 v23, v50, v51
v_cvt_pk_bf16_f32 v24, v52, v53
v_cvt_pk_bf16_f32 v25, v54, v55
v_cvt_pk_bf16_f32 v26, v56, v57
v_cvt_pk_bf16_f32 v27, v58, v59
v_cvt_pk_bf16_f32 v28, v60, v61
v_cvt_pk_bf16_f32 v29, v62, v63
v_cvt_pk_bf16_f32 v30, v64, v65
v_cvt_pk_bf16_f32 v31, v66, v67
v_cvt_pk_bf16_f32 v32, v68, v69
v_cvt_pk_bf16_f32 v33, v70, v71
v_cvt_pk_bf16_f32 v34, v72, v73
v_cvt_pk_bf16_f32 v35, v74, v75
v_add_u32 v6, 0x1000, v14
v_add_u32 v7, 0x2000, v14
buffer_store_dwordx4 v[16:19], v14, s[4:7], s34 offen offset:0 sc1
buffer_store_dwordx4 v[20:23], v14, s[4:7], s34 offen offset:2048 sc1
buffer_store_dwordx4 v[24:27], v6, s[4:7], s34 offen offset:0 sc1
buffer_store_dwordx4 v[28:31], v6, s[4:7], s34 offen offset:2048 sc1
buffer_store_dwordx4 v[32:35], v7, s[4:7], s34 offen offset:0 sc1
redln2_exit1:
s_endpgm
.globl qkvb_kernel
.p2align 8
.type qkvb_kernel,@function
qkvb_kernel:
s_cmp_ge_u32 s2, 256
s_cbranch_scc1 qkvb_exit1
s_load_dwordx2 s[12:13], s[0:1], 96
v_lshrrev_b32 v2, 6, v0
v_and_b32 v3, 63, v0
s_and_b32 s17, s2, 7
v_readfirstlane_b32 s16, v2
v_lshlrev_b32 v1, 4, v3
s_lshr_b32 s18, s2, 3
s_waitcnt lgkmcnt(0)
s_mov_b32 s4, s12
s_mov_b32 s5, s13
s_mov_b32 s6, 0x10000000
s_mov_b32 s7, 0x20000
s_lshl_b32 s21, s18, 2
s_add_u32 s21, s21, s16
s_mul_i32 s21, s21, 20480
s_add_u32 s21, s21, 54525952
s_mul_i32 s22, s16, 20480
v_add_u32 v7, 40960, v1
v_mov_b32 v6, v1
s_add_u32 m0, s22, 0
s_add_u32 s23, s21, 0
buffer_load_dwordx4 v1, s[4:7], s23 offen offset:0 lds
buffer_load_dwordx4 v1, s[4:7], s23 offen offset:1024 lds
buffer_load_dwordx4 v1, s[4:7], s23 offen offset:2048 lds
buffer_load_dwordx4 v1, s[4:7], s23 offen offset:3072 lds
s_cmp_eq_u32 s16, 0
s_cbranch_scc1 qkvb_w0_2
s_cmp_eq_u32 s16, 1
s_cbranch_scc1 qkvb_w1_3
s_cmp_eq_u32 s16, 2
s_cbranch_scc1 qkvb_w2_4
s_branch qkvb_w3_5
qkvb_w0_2:
s_mul_i32 s30, s17, 5
s_add_u32 s30, s30, 0
s_mul_i32 s30, s30, 20480
s_add_u32 s30, s30, 87556096
s_mul_i32 s31, s17, 5
s_add_u32 s31, s31, 1
s_mul_i32 s31, s31, 20480
s_add_u32 s31, s31, 87556096
s_mul_i32 s32, s17, 5
s_add_u32 s32, s32, 2
s_mul_i32 s32, s32, 20480
s_add_u32 s32, s32, 87556096
s_mul_i32 s33, s17, 5
s_add_u32 s33, s33, 3
s_mul_i32 s33, s33, 20480
s_add_u32 s33, s33, 87556096
buffer_load_dwordx4 v[72:75], v1, s[4:7], s30 offen offset:0
buffer_load_dwordx4 v[76:79], v1, s[4:7], s31 offen offset:0
buffer_load_dwordx4 v[80:83], v1, s[4:7], s32 offen offset:0
buffer_load_dwordx4 v[84:87], v1, s[4:7], s33 offen offset:0
buffer_load_dwordx4 v[88:91], v1, s[4:7], s30 offen offset:1024
buffer_load_dwordx4 v[92:95], v1, s[4:7], s31 offen offset:1024
buffer_load_dwordx4 v[96:99], v1, s[4:7], s32 offen offset:1024
buffer_load_dwordx4 v[100:103], v1, s[4:7], s33 offen offset:1024
buffer_load_dwordx4 v[104:107], v1, s[4:7], s30 offen offset:2048
buffer_load_dwordx4 v[108:111], v1, s[4:7], s31 offen offset:2048
buffer_load_dwordx4 v[112:115], v1, s[4:7], s32 offen offset:2048
buffer_load_dwordx4 v[116:119], v1, s[4:7], s33 offen offset:2048
s_add_u32 m0, s22, 4096
s_add_u32 s23, s21, 4096
buffer_load_dwordx4 v1, s[4:7], s23 offen offset:0 lds
buffer_load_dwordx4 v1, s[4:7], s23 offen offset:1024 lds
buffer_load_dwordx4 v1, s[4:7], s23 offen offset:2048 lds
buffer_load_dwordx4 v1, s[4:7], s23 offen offset:3072 lds
s_add_u32 m0, s22, 8192
s_add_u32 s23, s21, 8192
buffer_load_dwordx4 v1, s[4:7], s23 offen offset:0 lds
buffer_load_dwordx4 v1, s[4:7], s23 offen offset:1024 lds
buffer_load_dwordx4 v1, s[4:7], s23 offen offset:2048 lds
buffer_load_dwordx4 v1, s[4:7], s23 offen offset:3072 lds
s_add_u32 m0, s22, 12288
s_add_u32 s23, s21, 12288
buffer_load_dwordx4 v1, s[4:7], s23 offen offset:0 lds
buffer_load_dwordx4 v1, s[4:7], s23 offen offset:1024 lds
buffer_load_dwordx4 v1, s[4:7], s23 offen offset:2048 lds
buffer_load_dwordx4 v1, s[4:7], s23 offen offset:3072 lds
s_add_u32 m0, s22, 16384
s_add_u32 s23, s21, 16384
buffer_load_dwordx4 v1, s[4:7], s23 offen offset:0 lds
buffer_load_dwordx4 v1, s[4:7], s23 offen offset:1024 lds
buffer_load_dwordx4 v1, s[4:7], s23 offen offset:2048 lds
buffer_load_dwordx4 v1, s[4:7], s23 offen offset:3072 lds
s_waitcnt vmcnt(28)
s_barrier
buffer_load_dwordx4 v[120:123], v1, s[4:7], s30 offen offset:3072
buffer_load_dwordx4 v[124:127], v1, s[4:7], s31 offen offset:3072
buffer_load_dwordx4 v[128:131], v1, s[4:7], s32 offen offset:3072
buffer_load_dwordx4 v[132:135], v1, s[4:7], s33 offen offset:3072
ds_read_b128 v[136:139], v6 offset:0
ds_read_b128 v[140:143], v6 offset:20480
ds_read_b128 v[144:147], v7 offset:0
ds_read_b128 v[148:151], v7 offset:20480
s_waitcnt vmcnt(28) lgkmcnt(0)
v_mfma_f32_16x16x32_bf16 v[8:11], v[72:75], v[136:139], 0
ds_read_b128 v[152:155], v6 offset:1024
v_mfma_f32_16x16x32_bf16 v[12:15], v[72:75], v[140:143], 0
ds_read_b128 v[156:159], v6 offset:21504
v_mfma_f32_16x16x32_bf16 v[16:19], v[72:75], v[144:147], 0
ds_read_b128 v[160:163], v7 offset:1024
v_mfma_f32_16x16x32_bf16 v[20:23], v[72:75], v[148:151], 0
ds_read_b128 v[164:167], v7 offset:21504
s_add_u32 s30, s30, 4096
buffer_load_dwordx4 v[72:75], v1, s[4:7], s30 offen offset:0
v_mfma_f32_16x16x32_bf16 v[24:27], v[76:79], v[136:139], 0
v_mfma_f32_16x16x32_bf16 v[28:31], v[76:79], v[140:143], 0
v_mfma_f32_16x16x32_bf16 v[32:35], v[76:79], v[144:147], 0
v_mfma_f32_16x16x32_bf16 v[36:39], v[76:79], v[148:151], 0
s_add_u32 s31, s31, 4096
buffer_load_dwordx4 v[76:79], v1, s[4:7], s31 offen offset:0
v_mfma_f32_16x16x32_bf16 v[40:43], v[80:83], v[136:139], 0
v_mfma_f32_16x16x32_bf16 v[44:47], v[80:83], v[140:143], 0
v_mfma_f32_16x16x32_bf16 v[48:51], v[80:83], v[144:147], 0
v_mfma_f32_16x16x32_bf16 v[52:55], v[80:83], v[148:151], 0
s_add_u32 s32, s32, 4096
buffer_load_dwordx4 v[80:83], v1, s[4:7], s32 offen offset:0
v_mfma_f32_16x16x32_bf16 v[56:59], v[84:87], v[136:139], 0
v_mfma_f32_16x16x32_bf16 v[60:63], v[84:87], v[140:143], 0
v_mfma_f32_16x16x32_bf16 v[64:67], v[84:87], v[144:147], 0
v_mfma_f32_16x16x32_bf16 v[68:71], v[84:87], v[148:151], 0
s_add_u32 s33, s33, 4096
buffer_load_dwordx4 v[84:87], v1, s[4:7], s33 offen offset:0
s_waitcnt vmcnt(28) lgkmcnt(0)
v_mfma_f32_16x16x32_bf16 v[8:11], v[88:91], v[152:155], v[8:11]
ds_read_b128 v[136:139], v6 offset:2048
v_mfma_f32_16x16x32_bf16 v[12:15], v[88:91], v[156:159], v[12:15]
ds_read_b128 v[140:143], v6 offset:22528
v_mfma_f32_16x16x32_bf16 v[16:19], v[88:91], v[160:163], v[16:19]
ds_read_b128 v[144:147], v7 offset:2048
v_mfma_f32_16x16x32_bf16 v[20:23], v[88:91], v[164:167], v[20:23]
ds_read_b128 v[148:151], v7 offset:22528
buffer_load_dwordx4 v[88:91], v1, s[4:7], s30 offen offset:1024
v_mfma_f32_16x16x32_bf16 v[24:27], v[92:95], v[152:155], v[24:27]
v_mfma_f32_16x16x32_bf16 v[28:31], v[92:95], v[156:159], v[28:31]
v_mfma_f32_16x16x32_bf16 v[32:35], v[92:95], v[160:163], v[32:35]
v_mfma_f32_16x16x32_bf16 v[36:39], v[92:95], v[164:167], v[36:39]
buffer_load_dwordx4 v[92:95], v1, s[4:7], s31 offen offset:1024
v_mfma_f32_16x16x32_bf16 v[40:43], v[96:99], v[152:155], v[40:43]
v_mfma_f32_16x16x32_bf16 v[44:47], v[96:99], v[156:159], v[44:47]
v_mfma_f32_16x16x32_bf16 v[48:51], v[96:99], v[160:163], v[48:51]
v_mfma_f32_16x16x32_bf16 v[52:55], v[96:99], v[164:167], v[52:55]
buffer_load_dwordx4 v[96:99], v1, s[4:7], s32 offen offset:1024
v_mfma_f32_16x16x32_bf16 v[56:59], v[100:103], v[152:155], v[56:59]
v_mfma_f32_16x16x32_bf16 v[60:63], v[100:103], v[156:159], v[60:63]
v_mfma_f32_16x16x32_bf16 v[64:67], v[100:103], v[160:163], v[64:67]
v_mfma_f32_16x16x32_bf16 v[68:71], v[100:103], v[164:167], v[68:71]
buffer_load_dwordx4 v[100:103], v1, s[4:7], s33 offen offset:1024
s_waitcnt vmcnt(28) lgkmcnt(0)
v_mfma_f32_16x16x32_bf16 v[8:11], v[104:107], v[136:139], v[8:11]
ds_read_b128 v[152:155], v6 offset:3072
v_mfma_f32_16x16x32_bf16 v[12:15], v[104:107], v[140:143], v[12:15]
ds_read_b128 v[156:159], v6 offset:23552
v_mfma_f32_16x16x32_bf16 v[16:19], v[104:107], v[144:147], v[16:19]
ds_read_b128 v[160:163], v7 offset:3072
v_mfma_f32_16x16x32_bf16 v[20:23], v[104:107], v[148:151], v[20:23]
ds_read_b128 v[164:167], v7 offset:23552
buffer_load_dwordx4 v[104:107], v1, s[4:7], s30 offen offset:2048
v_mfma_f32_16x16x32_bf16 v[24:27], v[108:111], v[136:139], v[24:27]
v_mfma_f32_16x16x32_bf16 v[28:31], v[108:111], v[140:143], v[28:31]
v_mfma_f32_16x16x32_bf16 v[32:35], v[108:111], v[144:147], v[32:35]
v_mfma_f32_16x16x32_bf16 v[36:39], v[108:111], v[148:151], v[36:39]
buffer_load_dwordx4 v[108:111], v1, s[4:7], s31 offen offset:2048
v_mfma_f32_16x16x32_bf16 v[40:43], v[112:115], v[136:139], v[40:43]
v_mfma_f32_16x16x32_bf16 v[44:47], v[112:115], v[140:143], v[44:47]
v_mfma_f32_16x16x32_bf16 v[48:51], v[112:115], v[144:147], v[48:51]
v_mfma_f32_16x16x32_bf16 v[52:55], v[112:115], v[148:151], v[52:55]
buffer_load_dwordx4 v[112:115], v1, s[4:7], s32 offen offset:2048
v_mfma_f32_16x16x32_bf16 v[56:59], v[116:119], v[136:139], v[56:59]
v_mfma_f32_16x16x32_bf16 v[60:63], v[116:119], v[140:143], v[60:63]
v_mfma_f32_16x16x32_bf16 v[64:67], v[116:119], v[144:147], v[64:67]
v_mfma_f32_16x16x32_bf16 v[68:71], v[116:119], v[148:151], v[68:71]
buffer_load_dwordx4 v[116:119], v1, s[4:7], s33 offen offset:2048
s_waitcnt vmcnt(12) lgkmcnt(0)
s_barrier
v_mfma_f32_16x16x32_bf16 v[8:11], v[120:123], v[152:155], v[8:11]
ds_read_b128 v[136:139], v6 offset:4096
v_mfma_f32_16x16x32_bf16 v[12:15], v[120:123], v[156:159], v[12:15]
ds_read_b128 v[140:143], v6 offset:24576
v_mfma_f32_16x16x32_bf16 v[16:19], v[120:123], v[160:163], v[16:19]
ds_read_b128 v[144:147], v7 offset:4096
v_mfma_f32_16x16x32_bf16 v[20:23], v[120:123], v[164:167], v[20:23]
ds_read_b128 v[148:151], v7 offset:24576
buffer_load_dwordx4 v[120:123], v1, s[4:7], s30 offen offset:3072
v_mfma_f32_16x16x32_bf16 v[24:27], v[124:127], v[152:155], v[24:27]
v_mfma_f32_16x16x32_bf16 v[28:31], v[124:127], v[156:159], v[28:31]
v_mfma_f32_16x16x32_bf16 v[32:35], v[124:127], v[160:163], v[32:35]
v_mfma_f32_16x16x32_bf16 v[36:39], v[124:127], v[164:167], v[36:39]
buffer_load_dwordx4 v[124:127], v1, s[4:7], s31 offen offset:3072
v_mfma_f32_16x16x32_bf16 v[40:43], v[128:131], v[152:155], v[40:43]
v_mfma_f32_16x16x32_bf16 v[44:47], v[128:131], v[156:159], v[44:47]
v_mfma_f32_16x16x32_bf16 v[48:51], v[128:131], v[160:163], v[48:51]
v_mfma_f32_16x16x32_bf16 v[52:55], v[128:131], v[164:167], v[52:55]
buffer_load_dwordx4 v[128:131], v1, s[4:7], s32 offen offset:3072
v_mfma_f32_16x16x32_bf16 v[56:59], v[132:135], v[152:155], v[56:59]
v_mfma_f32_16x16x32_bf16 v[60:63], v[132:135], v[156:159], v[60:63]
v_mfma_f32_16x16x32_bf16 v[64:67], v[132:135], v[160:163], v[64:67]
v_mfma_f32_16x16x32_bf16 v[68:71], v[132:135], v[164:167], v[68:71]
buffer_load_dwordx4 v[132:135], v1, s[4:7], s33 offen offset:3072
s_mov_b32 s40, 0
v_add_u32 v6, 4096, v6
v_add_u32 v7, 4096, v7
qkvb_loop6:
s_waitcnt vmcnt(12) lgkmcnt(0)
v_mfma_f32_16x16x32_bf16 v[8:11], v[72:75], v[136:139], v[8:11]
ds_read_b128 v[152:155], v6 offset:1024
v_mfma_f32_16x16x32_bf16 v[12:15], v[72:75], v[140:143], v[12:15]
ds_read_b128 v[156:159], v6 offset:21504
v_mfma_f32_16x16x32_bf16 v[16:19], v[72:75], v[144:147], v[16:19]
ds_read_b128 v[160:163], v7 offset:1024
v_mfma_f32_16x16x32_bf16 v[20:23], v[72:75], v[148:151], v[20:23]
ds_read_b128 v[164:167], v7 offset:21504
s_add_u32 s30, s30, 4096
buffer_load_dwordx4 v[72:75], v1, s[4:7], s30 offen offset:0
v_mfma_f32_16x16x32_bf16 v[24:27], v[76:79], v[136:139], v[24:27]
v_mfma_f32_16x16x32_bf16 v[28:31], v[76:79], v[140:143], v[28:31]
v_mfma_f32_16x16x32_bf16 v[32:35], v[76:79], v[144:147], v[32:35]
v_mfma_f32_16x16x32_bf16 v[36:39], v[76:79], v[148:151], v[36:39]
s_add_u32 s31, s31, 4096
buffer_load_dwordx4 v[76:79], v1, s[4:7], s31 offen offset:0
v_mfma_f32_16x16x32_bf16 v[40:43], v[80:83], v[136:139], v[40:43]
v_mfma_f32_16x16x32_bf16 v[44:47], v[80:83], v[140:143], v[44:47]
v_mfma_f32_16x16x32_bf16 v[48:51], v[80:83], v[144:147], v[48:51]
v_mfma_f32_16x16x32_bf16 v[52:55], v[80:83], v[148:151], v[52:55]
s_add_u32 s32, s32, 4096
buffer_load_dwordx4 v[80:83], v1, s[4:7], s32 offen offset:0
v_mfma_f32_16x16x32_bf16 v[56:59], v[84:87], v[136:139], v[56:59]
v_mfma_f32_16x16x32_bf16 v[60:63], v[84:87], v[140:143], v[60:63]
v_mfma_f32_16x16x32_bf16 v[64:67], v[84:87], v[144:147], v[64:67]
v_mfma_f32_16x16x32_bf16 v[68:71], v[84:87], v[148:151], v[68:71]
s_add_u32 s33, s33, 4096
buffer_load_dwordx4 v[84:87], v1, s[4:7], s33 offen offset:0
s_waitcnt vmcnt(12) lgkmcnt(0)
v_mfma_f32_16x16x32_bf16 v[8:11], v[88:91], v[152:155], v[8:11]
ds_read_b128 v[136:139], v6 offset:2048
v_mfma_f32_16x16x32_bf16 v[12:15], v[88:91], v[156:159], v[12:15]
ds_read_b128 v[140:143], v6 offset:22528
v_mfma_f32_16x16x32_bf16 v[16:19], v[88:91], v[160:163], v[16:19]
ds_read_b128 v[144:147], v7 offset:2048
v_mfma_f32_16x16x32_bf16 v[20:23], v[88:91], v[164:167], v[20:23]
ds_read_b128 v[148:151], v7 offset:22528
buffer_load_dwordx4 v[88:91], v1, s[4:7], s30 offen offset:1024
v_mfma_f32_16x16x32_bf16 v[24:27], v[92:95], v[152:155], v[24:27]
v_mfma_f32_16x16x32_bf16 v[28:31], v[92:95], v[156:159], v[28:31]
v_mfma_f32_16x16x32_bf16 v[32:35], v[92:95], v[160:163], v[32:35]
v_mfma_f32_16x16x32_bf16 v[36:39], v[92:95], v[164:167], v[36:39]
buffer_load_dwordx4 v[92:95], v1, s[4:7], s31 offen offset:1024
v_mfma_f32_16x16x32_bf16 v[40:43], v[96:99], v[152:155], v[40:43]
v_mfma_f32_16x16x32_bf16 v[44:47], v[96:99], v[156:159], v[44:47]
v_mfma_f32_16x16x32_bf16 v[48:51], v[96:99], v[160:163], v[48:51]
v_mfma_f32_16x16x32_bf16 v[52:55], v[96:99], v[164:167], v[52:55]
buffer_load_dwordx4 v[96:99], v1, s[4:7], s32 offen offset:1024
v_mfma_f32_16x16x32_bf16 v[56:59], v[100:103], v[152:155], v[56:59]
v_mfma_f32_16x16x32_bf16 v[60:63], v[100:103], v[156:159], v[60:63]
v_mfma_f32_16x16x32_bf16 v[64:67], v[100:103], v[160:163], v[64:67]
v_mfma_f32_16x16x32_bf16 v[68:71], v[100:103], v[164:167], v[68:71]
buffer_load_dwordx4 v[100:103], v1, s[4:7], s33 offen offset:1024
s_waitcnt vmcnt(12) lgkmcnt(0)
v_mfma_f32_16x16x32_bf16 v[8:11], v[104:107], v[136:139], v[8:11]
ds_read_b128 v[152:155], v6 offset:3072
v_mfma_f32_16x16x32_bf16 v[12:15], v[104:107], v[140:143], v[12:15]
ds_read_b128 v[156:159], v6 offset:23552
v_mfma_f32_16x16x32_bf16 v[16:19], v[104:107], v[144:147], v[16:19]
ds_read_b128 v[160:163], v7 offset:3072
v_mfma_f32_16x16x32_bf16 v[20:23], v[104:107], v[148:151], v[20:23]
ds_read_b128 v[164:167], v7 offset:23552
buffer_load_dwordx4 v[104:107], v1, s[4:7], s30 offen offset:2048
v_mfma_f32_16x16x32_bf16 v[24:27], v[108:111], v[136:139], v[24:27]
v_mfma_f32_16x16x32_bf16 v[28:31], v[108:111], v[140:143], v[28:31]
v_mfma_f32_16x16x32_bf16 v[32:35], v[108:111], v[144:147], v[32:35]
v_mfma_f32_16x16x32_bf16 v[36:39], v[108:111], v[148:151], v[36:39]
buffer_load_dwordx4 v[108:111], v1, s[4:7], s31 offen offset:2048
v_mfma_f32_16x16x32_bf16 v[40:43], v[112:115], v[136:139], v[40:43]
v_mfma_f32_16x16x32_bf16 v[44:47], v[112:115], v[140:143], v[44:47]
v_mfma_f32_16x16x32_bf16 v[48:51], v[112:115], v[144:147], v[48:51]
v_mfma_f32_16x16x32_bf16 v[52:55], v[112:115], v[148:151], v[52:55]
buffer_load_dwordx4 v[112:115], v1, s[4:7], s32 offen offset:2048
v_mfma_f32_16x16x32_bf16 v[56:59], v[116:119], v[136:139], v[56:59]
v_mfma_f32_16x16x32_bf16 v[60:63], v[116:119], v[140:143], v[60:63]
v_mfma_f32_16x16x32_bf16 v[64:67], v[116:119], v[144:147], v[64:67]
v_mfma_f32_16x16x32_bf16 v[68:71], v[116:119], v[148:151], v[68:71]
buffer_load_dwordx4 v[116:119], v1, s[4:7], s33 offen offset:2048
s_waitcnt vmcnt(12) lgkmcnt(0)
v_mfma_f32_16x16x32_bf16 v[8:11], v[120:123], v[152:155], v[8:11]
ds_read_b128 v[136:139], v6 offset:4096
v_mfma_f32_16x16x32_bf16 v[12:15], v[120:123], v[156:159], v[12:15]
ds_read_b128 v[140:143], v6 offset:24576
v_mfma_f32_16x16x32_bf16 v[16:19], v[120:123], v[160:163], v[16:19]
ds_read_b128 v[144:147], v7 offset:4096
v_mfma_f32_16x16x32_bf16 v[20:23], v[120:123], v[164:167], v[20:23]
ds_read_b128 v[148:151], v7 offset:24576
buffer_load_dwordx4 v[120:123], v1, s[4:7], s30 offen offset:3072
v_mfma_f32_16x16x32_bf16 v[24:27], v[124:127], v[152:155], v[24:27]
v_mfma_f32_16x16x32_bf16 v[28:31], v[124:127], v[156:159], v[28:31]
v_mfma_f32_16x16x32_bf16 v[32:35], v[124:127], v[160:163], v[32:35]
v_mfma_f32_16x16x32_bf16 v[36:39], v[124:127], v[164:167], v[36:39]
buffer_load_dwordx4 v[124:127], v1, s[4:7], s31 offen offset:3072
v_mfma_f32_16x16x32_bf16 v[40:43], v[128:131], v[152:155], v[40:43]
v_mfma_f32_16x16x32_bf16 v[44:47], v[128:131], v[156:159], v[44:47]
v_mfma_f32_16x16x32_bf16 v[48:51], v[128:131], v[160:163], v[48:51]
v_mfma_f32_16x16x32_bf16 v[52:55], v[128:131], v[164:167], v[52:55]
buffer_load_dwordx4 v[128:131], v1, s[4:7], s32 offen offset:3072
v_mfma_f32_16x16x32_bf16 v[56:59], v[132:135], v[152:155], v[56:59]
v_mfma_f32_16x16x32_bf16 v[60:63], v[132:135], v[156:159], v[60:63]
v_mfma_f32_16x16x32_bf16 v[64:67], v[132:135], v[160:163], v[64:67]
v_mfma_f32_16x16x32_bf16 v[68:71], v[132:135], v[164:167], v[68:71]
buffer_load_dwordx4 v[132:135], v1, s[4:7], s33 offen offset:3072
v_add_u32 v6, 4096, v6
v_add_u32 v7, 4096, v7
s_add_u32 s40, s40, 1
s_cmp_lt_u32 s40, 4
s_cbranch_scc1 qkvb_loop6
s_waitcnt vmcnt(0) lgkmcnt(0)
v_and_b32 v2, 63, v0
v_and_b32 v3, 15, v2
v_lshrrev_b32 v4, 4, v2
s_lshl_b32 s41, s17, 19
s_lshl_b32 s42, s18, 12
s_add_u32 s41, s41, s42
s_mov_b32 s46, 0x3ea52b5c
s_mov_b32 s47, 0x3ea52b5c
v_lshlrev_b32 v5, 2, v4
v_add_u32 v5, 0, v5
v_mul_u32_u24 v168, 205, v5
v_lshrrev_b32 v168, 12, v168
v_mul_u32_u24 v6, 20, v168
v_sub_u32 v5, v5, v6
v_lshlrev_b32 v168, 17, v168
v_lshrrev_b32 v6, 4, v5
v_lshl_add_u32 v168, v6, 10, v168
v_bfe_u32 v6, v5, 2, 1
v_lshl_add_u32 v168, v6, 9, v168
v_bfe_u32 v6, v5, 3, 1
v_lshl_add_u32 v168, v6, 3, v168
v_lshl_add_u32 v168, v3, 4, v168
v_lshlrev_b32 v5, 2, v4
v_add_u32 v5, 16, v5
v_mul_u32_u24 v169, 205, v5
v_lshrrev_b32 v169, 12, v169
v_mul_u32_u24 v6, 20, v169
v_sub_u32 v5, v5, v6
v_lshlrev_b32 v169, 17, v169
v_lshrrev_b32 v6, 4, v5
v_lshl_add_u32 v169, v6, 10, v169
v_bfe_u32 v6, v5, 2, 1
v_lshl_add_u32 v169, v6, 9, v169
v_bfe_u32 v6, v5, 3, 1
v_lshl_add_u32 v169, v6, 3, v169
v_lshl_add_u32 v169, v3, 4, v169
v_lshlrev_b32 v5, 2, v4
v_add_u32 v5, 32, v5
v_mul_u32_u24 v170, 205, v5
v_lshrrev_b32 v170, 12, v170
v_mul_u32_u24 v6, 20, v170
v_sub_u32 v5, v5, v6
v_lshlrev_b32 v170, 17, v170
v_lshrrev_b32 v6, 4, v5
v_lshl_add_u32 v170, v6, 10, v170
v_bfe_u32 v6, v5, 2, 1
v_lshl_add_u32 v170, v6, 9, v170
v_bfe_u32 v6, v5, 3, 1
v_lshl_add_u32 v170, v6, 3, v170
v_lshl_add_u32 v170, v3, 4, v170
v_lshlrev_b32 v5, 2, v4
v_add_u32 v5, 48, v5
v_mul_u32_u24 v171, 205, v5
v_lshrrev_b32 v171, 12, v171
v_mul_u32_u24 v6, 20, v171
v_sub_u32 v5, v5, v6
v_lshlrev_b32 v171, 17, v171
v_lshrrev_b32 v6, 4, v5
v_lshl_add_u32 v171, v6, 10, v171
v_bfe_u32 v6, v5, 2, 1
v_lshl_add_u32 v171, v6, 9, v171
v_bfe_u32 v6, v5, 3, 1
v_lshl_add_u32 v171, v6, 3, v171
v_lshl_add_u32 v171, v3, 4, v171
v_pk_mul_f32 v[8:9], v[8:9], s[46:47]
v_pk_mul_f32 v[10:11], v[10:11], s[46:47]
v_cvt_pk_bf16_f32 v136, v8, v9
v_cvt_pk_bf16_f32 v137, v10, v11
s_add_u32 s43, s41, 37748736
buffer_store_dwordx2 v[136:137], v168, s[4:7], s43 offen sc1
v_pk_mul_f32 v[12:13], v[12:13], s[46:47]
v_pk_mul_f32 v[14:15], v[14:15], s[46:47]
v_cvt_pk_bf16_f32 v138, v12, v13
v_cvt_pk_bf16_f32 v139, v14, v15
s_add_u32 s43, s41, 37748992
buffer_store_dwordx2 v[138:139], v168, s[4:7], s43 offen sc1
v_pk_mul_f32 v[16:17], v[16:17], s[46:47]
v_pk_mul_f32 v[18:19], v[18:19], s[46:47]
v_cvt_pk_bf16_f32 v140, v16, v17
v_cvt_pk_bf16_f32 v141, v18, v19
s_add_u32 s43, s41, 37750784
buffer_store_dwordx2 v[140:141], v168, s[4:7], s43 offen sc1
v_pk_mul_f32 v[20:21], v[20:21], s[46:47]
v_pk_mul_f32 v[22:23], v[22:23], s[46:47]
v_cvt_pk_bf16_f32 v142, v20, v21
v_cvt_pk_bf16_f32 v143, v22, v23
s_add_u32 s43, s41, 37751040
buffer_store_dwordx2 v[142:143], v168, s[4:7], s43 offen sc1
v_pk_mul_f32 v[24:25], v[24:25], s[46:47]
v_pk_mul_f32 v[26:27], v[26:27], s[46:47]
v_cvt_pk_bf16_f32 v144, v24, v25
v_cvt_pk_bf16_f32 v145, v26, v27
s_add_u32 s43, s41, 37748736
buffer_store_dwordx2 v[144:145], v169, s[4:7], s43 offen sc1
v_pk_mul_f32 v[28:29], v[28:29], s[46:47]
v_pk_mul_f32 v[30:31], v[30:31], s[46:47]
v_cvt_pk_bf16_f32 v146, v28, v29
v_cvt_pk_bf16_f32 v147, v30, v31
s_add_u32 s43, s41, 37748992
buffer_store_dwordx2 v[146:147], v169, s[4:7], s43 offen sc1
v_pk_mul_f32 v[32:33], v[32:33], s[46:47]
v_pk_mul_f32 v[34:35], v[34:35], s[46:47]
v_cvt_pk_bf16_f32 v148, v32, v33
v_cvt_pk_bf16_f32 v149, v34, v35
s_add_u32 s43, s41, 37750784
buffer_store_dwordx2 v[148:149], v169, s[4:7], s43 offen sc1
v_pk_mul_f32 v[36:37], v[36:37], s[46:47]
v_pk_mul_f32 v[38:39], v[38:39], s[46:47]
v_cvt_pk_bf16_f32 v150, v36, v37
v_cvt_pk_bf16_f32 v151, v38, v39
s_add_u32 s43, s41, 37751040
buffer_store_dwordx2 v[150:151], v169, s[4:7], s43 offen sc1
v_pk_mul_f32 v[40:41], v[40:41], s[46:47]
v_pk_mul_f32 v[42:43], v[42:43], s[46:47]
v_cvt_pk_bf16_f32 v136, v40, v41
v_cvt_pk_bf16_f32 v137, v42, v43
s_add_u32 s43, s41, 37748736
buffer_store_dwordx2 v[136:137], v170, s[4:7], s43 offen sc1
v_pk_mul_f32 v[44:45], v[44:45], s[46:47]
v_pk_mul_f32 v[46:47], v[46:47], s[46:47]
v_cvt_pk_bf16_f32 v138, v44, v45
v_cvt_pk_bf16_f32 v139, v46, v47
s_add_u32 s43, s41, 37748992
buffer_store_dwordx2 v[138:139], v170, s[4:7], s43 offen sc1
v_pk_mul_f32 v[48:49], v[48:49], s[46:47]
v_pk_mul_f32 v[50:51], v[50:51], s[46:47]
v_cvt_pk_bf16_f32 v140, v48, v49
v_cvt_pk_bf16_f32 v141, v50, v51
s_add_u32 s43, s41, 37750784
buffer_store_dwordx2 v[140:141], v170, s[4:7], s43 offen sc1
v_pk_mul_f32 v[52:53], v[52:53], s[46:47]
v_pk_mul_f32 v[54:55], v[54:55], s[46:47]
v_cvt_pk_bf16_f32 v142, v52, v53
v_cvt_pk_bf16_f32 v143, v54, v55
s_add_u32 s43, s41, 37751040
buffer_store_dwordx2 v[142:143], v170, s[4:7], s43 offen sc1
v_pk_mul_f32 v[56:57], v[56:57], s[46:47]
v_pk_mul_f32 v[58:59], v[58:59], s[46:47]
v_cvt_pk_bf16_f32 v144, v56, v57
v_cvt_pk_bf16_f32 v145, v58, v59
s_add_u32 s43, s41, 37748736
buffer_store_dwordx2 v[144:145], v171, s[4:7], s43 offen sc1
v_pk_mul_f32 v[60:61], v[60:61], s[46:47]
v_pk_mul_f32 v[62:63], v[62:63], s[46:47]
v_cvt_pk_bf16_f32 v146, v60, v61
v_cvt_pk_bf16_f32 v147, v62, v63
s_add_u32 s43, s41, 37748992
buffer_store_dwordx2 v[146:147], v171, s[4:7], s43 offen sc1
v_pk_mul_f32 v[64:65], v[64:65], s[46:47]
v_pk_mul_f32 v[66:67], v[66:67], s[46:47]
v_cvt_pk_bf16_f32 v148, v64, v65
v_cvt_pk_bf16_f32 v149, v66, v67
s_add_u32 s43, s41, 37750784
buffer_store_dwordx2 v[148:149], v171, s[4:7], s43 offen sc1
v_pk_mul_f32 v[68:69], v[68:69], s[46:47]
v_pk_mul_f32 v[70:71], v[70:71], s[46:47]
v_cvt_pk_bf16_f32 v150, v68, v69
v_cvt_pk_bf16_f32 v151, v70, v71
s_add_u32 s43, s41, 37751040
buffer_store_dwordx2 v[150:151], v171, s[4:7], s43 offen sc1
s_branch qkvb_exit1
qkvb_w1_3:
s_mul_i32 s30, s17, 5
s_add_u32 s30, s30, 4
s_mul_i32 s30, s30, 20480
s_add_u32 s30, s30, 87556096
s_mul_i32 s31, s17, 5
s_add_u32 s31, s31, 40
s_mul_i32 s31, s31, 20480
s_add_u32 s31, s31, 87556096
s_mul_i32 s32, s17, 5
s_add_u32 s32, s32, 41
s_mul_i32 s32, s32, 20480
s_add_u32 s32, s32, 87556096
s_mul_i32 s33, s17, 5
s_add_u32 s33, s33, 42
s_mul_i32 s33, s33, 20480
s_add_u32 s33, s33, 87556096
buffer_load_dwordx4 v[72:75], v1, s[4:7], s30 offen offset:0
buffer_load_dwordx4 v[76:79], v1, s[4:7], s31 offen offset:0
buffer_load_dwordx4 v[80:83], v1, s[4:7], s32 offen offset:0
buffer_load_dwordx4 v[84:87], v1, s[4:7], s33 offen offset:0
buffer_load_dwordx4 v[88:91], v1, s[4:7], s30 offen offset:1024
buffer_load_dwordx4 v[92:95], v1, s[4:7], s31 offen offset:1024
buffer_load_dwordx4 v[96:99], v1, s[4:7], s32 offen offset:1024
buffer_load_dwordx4 v[100:103], v1, s[4:7], s33 offen offset:1024
buffer_load_dwordx4 v[104:107], v1, s[4:7], s30 offen offset:2048
buffer_load_dwordx4 v[108:111], v1, s[4:7], s31 offen offset:2048
buffer_load_dwordx4 v[112:115], v1, s[4:7], s32 offen offset:2048
buffer_load_dwordx4 v[116:119], v1, s[4:7], s33 offen offset:2048
s_add_u32 m0, s22, 4096
s_add_u32 s23, s21, 4096
buffer_load_dwordx4 v1, s[4:7], s23 offen offset:0 lds
buffer_load_dwordx4 v1, s[4:7], s23 offen offset:1024 lds
buffer_load_dwordx4 v1, s[4:7], s23 offen offset:2048 lds
buffer_load_dwordx4 v1, s[4:7], s23 offen offset:3072 lds
s_add_u32 m0, s22, 8192
s_add_u32 s23, s21, 8192
buffer_load_dwordx4 v1, s[4:7], s23 offen offset:0 lds
buffer_load_dwordx4 v1, s[4:7], s23 offen offset:1024 lds
buffer_load_dwordx4 v1, s[4:7], s23 offen offset:2048 lds
buffer_load_dwordx4 v1, s[4:7], s23 offen offset:3072 lds
s_add_u32 m0, s22, 12288
s_add_u32 s23, s21, 12288
buffer_load_dwordx4 v1, s[4:7], s23 offen offset:0 lds
buffer_load_dwordx4 v1, s[4:7], s23 offen offset:1024 lds
buffer_load_dwordx4 v1, s[4:7], s23 offen offset:2048 lds
buffer_load_dwordx4 v1, s[4:7], s23 offen offset:3072 lds
s_add_u32 m0, s22, 16384
s_add_u32 s23, s21, 16384
buffer_load_dwordx4 v1, s[4:7], s23 offen offset:0 lds
buffer_load_dwordx4 v1, s[4:7], s23 offen offset:1024 lds
buffer_load_dwordx4 v1, s[4:7], s23 offen offset:2048 lds
buffer_load_dwordx4 v1, s[4:7], s23 offen offset:3072 lds
s_waitcnt vmcnt(28)
s_barrier
buffer_load_dwordx4 v[120:123], v1, s[4:7], s30 offen offset:3072
buffer_load_dwordx4 v[124:127], v1, s[4:7], s31 offen offset:3072
buffer_load_dwordx4 v[128:131], v1, s[4:7], s32 offen offset:3072
buffer_load_dwordx4 v[132:135], v1, s[4:7], s33 offen offset:3072
ds_read_b128 v[136:139], v6 offset:0
ds_read_b128 v[140:143], v6 offset:20480
ds_read_b128 v[144:147], v7 offset:0
ds_read_b128 v[148:151], v7 offset:20480
s_waitcnt vmcnt(28) lgkmcnt(0)
v_mfma_f32_16x16x32_bf16 v[8:11], v[72:75], v[136:139], 0
ds_read_b128 v[152:155], v6 offset:1024
v_mfma_f32_16x16x32_bf16 v[12:15], v[72:75], v[140:143], 0
ds_read_b128 v[156:159], v6 offset:21504
v_mfma_f32_16x16x32_bf16 v[16:19], v[72:75], v[144:147], 0
ds_read_b128 v[160:163], v7 offset:1024
v_mfma_f32_16x16x32_bf16 v[20:23], v[72:75], v[148:151], 0
ds_read_b128 v[164:167], v7 offset:21504
s_add_u32 s30, s30, 4096
buffer_load_dwordx4 v[72:75], v1, s[4:7], s30 offen offset:0
v_mfma_f32_16x16x32_bf16 v[24:27], v[76:79], v[136:139], 0
v_mfma_f32_16x16x32_bf16 v[28:31], v[76:79], v[140:143], 0
v_mfma_f32_16x16x32_bf16 v[32:35], v[76:79], v[144:147], 0
v_mfma_f32_16x16x32_bf16 v[36:39], v[76:79], v[148:151], 0
s_add_u32 s31, s31, 4096
buffer_load_dwordx4 v[76:79], v1, s[4:7], s31 offen offset:0
v_mfma_f32_16x16x32_bf16 v[40:43], v[80:83], v[136:139], 0
v_mfma_f32_16x16x32_bf16 v[44:47], v[80:83], v[140:143], 0
v_mfma_f32_16x16x32_bf16 v[48:51], v[80:83], v[144:147], 0
v_mfma_f32_16x16x32_bf16 v[52:55], v[80:83], v[148:151], 0
s_add_u32 s32, s32, 4096
buffer_load_dwordx4 v[80:83], v1, s[4:7], s32 offen offset:0
v_mfma_f32_16x16x32_bf16 v[56:59], v[84:87], v[136:139], 0
v_mfma_f32_16x16x32_bf16 v[60:63], v[84:87], v[140:143], 0
v_mfma_f32_16x16x32_bf16 v[64:67], v[84:87], v[144:147], 0
v_mfma_f32_16x16x32_bf16 v[68:71], v[84:87], v[148:151], 0
s_add_u32 s33, s33, 4096
buffer_load_dwordx4 v[84:87], v1, s[4:7], s33 offen offset:0
s_waitcnt vmcnt(28) lgkmcnt(0)
v_mfma_f32_16x16x32_bf16 v[8:11], v[88:91], v[152:155], v[8:11]
ds_read_b128 v[136:139], v6 offset:2048
v_mfma_f32_16x16x32_bf16 v[12:15], v[88:91], v[156:159], v[12:15]
ds_read_b128 v[140:143], v6 offset:22528
v_mfma_f32_16x16x32_bf16 v[16:19], v[88:91], v[160:163], v[16:19]
ds_read_b128 v[144:147], v7 offset:2048
v_mfma_f32_16x16x32_bf16 v[20:23], v[88:91], v[164:167], v[20:23]
ds_read_b128 v[148:151], v7 offset:22528
buffer_load_dwordx4 v[88:91], v1, s[4:7], s30 offen offset:1024
v_mfma_f32_16x16x32_bf16 v[24:27], v[92:95], v[152:155], v[24:27]
v_mfma_f32_16x16x32_bf16 v[28:31], v[92:95], v[156:159], v[28:31]
v_mfma_f32_16x16x32_bf16 v[32:35], v[92:95], v[160:163], v[32:35]
v_mfma_f32_16x16x32_bf16 v[36:39], v[92:95], v[164:167], v[36:39]
buffer_load_dwordx4 v[92:95], v1, s[4:7], s31 offen offset:1024
v_mfma_f32_16x16x32_bf16 v[40:43], v[96:99], v[152:155], v[40:43]
v_mfma_f32_16x16x32_bf16 v[44:47], v[96:99], v[156:159], v[44:47]
v_mfma_f32_16x16x32_bf16 v[48:51], v[96:99], v[160:163], v[48:51]
v_mfma_f32_16x16x32_bf16 v[52:55], v[96:99], v[164:167], v[52:55]
buffer_load_dwordx4 v[96:99], v1, s[4:7], s32 offen offset:1024
v_mfma_f32_16x16x32_bf16 v[56:59], v[100:103], v[152:155], v[56:59]
v_mfma_f32_16x16x32_bf16 v[60:63], v[100:103], v[156:159], v[60:63]
v_mfma_f32_16x16x32_bf16 v[64:67], v[100:103], v[160:163], v[64:67]
v_mfma_f32_16x16x32_bf16 v[68:71], v[100:103], v[164:167], v[68:71]
buffer_load_dwordx4 v[100:103], v1, s[4:7], s33 offen offset:1024
s_waitcnt vmcnt(28) lgkmcnt(0)
v_mfma_f32_16x16x32_bf16 v[8:11], v[104:107], v[136:139], v[8:11]
ds_read_b128 v[152:155], v6 offset:3072
v_mfma_f32_16x16x32_bf16 v[12:15], v[104:107], v[140:143], v[12:15]
ds_read_b128 v[156:159], v6 offset:23552
v_mfma_f32_16x16x32_bf16 v[16:19], v[104:107], v[144:147], v[16:19]
ds_read_b128 v[160:163], v7 offset:3072
v_mfma_f32_16x16x32_bf16 v[20:23], v[104:107], v[148:151], v[20:23]
ds_read_b128 v[164:167], v7 offset:23552
buffer_load_dwordx4 v[104:107], v1, s[4:7], s30 offen offset:2048
v_mfma_f32_16x16x32_bf16 v[24:27], v[108:111], v[136:139], v[24:27]
v_mfma_f32_16x16x32_bf16 v[28:31], v[108:111], v[140:143], v[28:31]
v_mfma_f32_16x16x32_bf16 v[32:35], v[108:111], v[144:147], v[32:35]
v_mfma_f32_16x16x32_bf16 v[36:39], v[108:111], v[148:151], v[36:39]
buffer_load_dwordx4 v[108:111], v1, s[4:7], s31 offen offset:2048
v_mfma_f32_16x16x32_bf16 v[40:43], v[112:115], v[136:139], v[40:43]
v_mfma_f32_16x16x32_bf16 v[44:47], v[112:115], v[140:143], v[44:47]
v_mfma_f32_16x16x32_bf16 v[48:51], v[112:115], v[144:147], v[48:51]
v_mfma_f32_16x16x32_bf16 v[52:55], v[112:115], v[148:151], v[52:55]
buffer_load_dwordx4 v[112:115], v1, s[4:7], s32 offen offset:2048
v_mfma_f32_16x16x32_bf16 v[56:59], v[116:119], v[136:139], v[56:59]
v_mfma_f32_16x16x32_bf16 v[60:63], v[116:119], v[140:143], v[60:63]
v_mfma_f32_16x16x32_bf16 v[64:67], v[116:119], v[144:147], v[64:67]
v_mfma_f32_16x16x32_bf16 v[68:71], v[116:119], v[148:151], v[68:71]
buffer_load_dwordx4 v[116:119], v1, s[4:7], s33 offen offset:2048
s_waitcnt vmcnt(12) lgkmcnt(0)
s_barrier
v_mfma_f32_16x16x32_bf16 v[8:11], v[120:123], v[152:155], v[8:11]
ds_read_b128 v[136:139], v6 offset:4096
v_mfma_f32_16x16x32_bf16 v[12:15], v[120:123], v[156:159], v[12:15]
ds_read_b128 v[140:143], v6 offset:24576
v_mfma_f32_16x16x32_bf16 v[16:19], v[120:123], v[160:163], v[16:19]
ds_read_b128 v[144:147], v7 offset:4096
v_mfma_f32_16x16x32_bf16 v[20:23], v[120:123], v[164:167], v[20:23]
ds_read_b128 v[148:151], v7 offset:24576
buffer_load_dwordx4 v[120:123], v1, s[4:7], s30 offen offset:3072
v_mfma_f32_16x16x32_bf16 v[24:27], v[124:127], v[152:155], v[24:27]
v_mfma_f32_16x16x32_bf16 v[28:31], v[124:127], v[156:159], v[28:31]
v_mfma_f32_16x16x32_bf16 v[32:35], v[124:127], v[160:163], v[32:35]
v_mfma_f32_16x16x32_bf16 v[36:39], v[124:127], v[164:167], v[36:39]
buffer_load_dwordx4 v[124:127], v1, s[4:7], s31 offen offset:3072
v_mfma_f32_16x16x32_bf16 v[40:43], v[128:131], v[152:155], v[40:43]
v_mfma_f32_16x16x32_bf16 v[44:47], v[128:131], v[156:159], v[44:47]
v_mfma_f32_16x16x32_bf16 v[48:51], v[128:131], v[160:163], v[48:51]
v_mfma_f32_16x16x32_bf16 v[52:55], v[128:131], v[164:167], v[52:55]
buffer_load_dwordx4 v[128:131], v1, s[4:7], s32 offen offset:3072
v_mfma_f32_16x16x32_bf16 v[56:59], v[132:135], v[152:155], v[56:59]
v_mfma_f32_16x16x32_bf16 v[60:63], v[132:135], v[156:159], v[60:63]
v_mfma_f32_16x16x32_bf16 v[64:67], v[132:135], v[160:163], v[64:67]
v_mfma_f32_16x16x32_bf16 v[68:71], v[132:135], v[164:167], v[68:71]
buffer_load_dwordx4 v[132:135], v1, s[4:7], s33 offen offset:3072
s_mov_b32 s40, 0
v_add_u32 v6, 4096, v6
v_add_u32 v7, 4096, v7
qkvb_loop7:
s_waitcnt vmcnt(12) lgkmcnt(0)
v_mfma_f32_16x16x32_bf16 v[8:11], v[72:75], v[136:139], v[8:11]
ds_read_b128 v[152:155], v6 offset:1024
v_mfma_f32_16x16x32_bf16 v[12:15], v[72:75], v[140:143], v[12:15]
ds_read_b128 v[156:159], v6 offset:21504
v_mfma_f32_16x16x32_bf16 v[16:19], v[72:75], v[144:147], v[16:19]
ds_read_b128 v[160:163], v7 offset:1024
v_mfma_f32_16x16x32_bf16 v[20:23], v[72:75], v[148:151], v[20:23]
ds_read_b128 v[164:167], v7 offset:21504
s_add_u32 s30, s30, 4096
buffer_load_dwordx4 v[72:75], v1, s[4:7], s30 offen offset:0
v_mfma_f32_16x16x32_bf16 v[24:27], v[76:79], v[136:139], v[24:27]
v_mfma_f32_16x16x32_bf16 v[28:31], v[76:79], v[140:143], v[28:31]
v_mfma_f32_16x16x32_bf16 v[32:35], v[76:79], v[144:147], v[32:35]
v_mfma_f32_16x16x32_bf16 v[36:39], v[76:79], v[148:151], v[36:39]
s_add_u32 s31, s31, 4096
buffer_load_dwordx4 v[76:79], v1, s[4:7], s31 offen offset:0
v_mfma_f32_16x16x32_bf16 v[40:43], v[80:83], v[136:139], v[40:43]
v_mfma_f32_16x16x32_bf16 v[44:47], v[80:83], v[140:143], v[44:47]
v_mfma_f32_16x16x32_bf16 v[48:51], v[80:83], v[144:147], v[48:51]
v_mfma_f32_16x16x32_bf16 v[52:55], v[80:83], v[148:151], v[52:55]
s_add_u32 s32, s32, 4096
buffer_load_dwordx4 v[80:83], v1, s[4:7], s32 offen offset:0
v_mfma_f32_16x16x32_bf16 v[56:59], v[84:87], v[136:139], v[56:59]
v_mfma_f32_16x16x32_bf16 v[60:63], v[84:87], v[140:143], v[60:63]
v_mfma_f32_16x16x32_bf16 v[64:67], v[84:87], v[144:147], v[64:67]
v_mfma_f32_16x16x32_bf16 v[68:71], v[84:87], v[148:151], v[68:71]
s_add_u32 s33, s33, 4096
buffer_load_dwordx4 v[84:87], v1, s[4:7], s33 offen offset:0
s_waitcnt vmcnt(12) lgkmcnt(0)
v_mfma_f32_16x16x32_bf16 v[8:11], v[88:91], v[152:155], v[8:11]
ds_read_b128 v[136:139], v6 offset:2048
v_mfma_f32_16x16x32_bf16 v[12:15], v[88:91], v[156:159], v[12:15]
ds_read_b128 v[140:143], v6 offset:22528
v_mfma_f32_16x16x32_bf16 v[16:19], v[88:91], v[160:163], v[16:19]
ds_read_b128 v[144:147], v7 offset:2048
v_mfma_f32_16x16x32_bf16 v[20:23], v[88:91], v[164:167], v[20:23]
ds_read_b128 v[148:151], v7 offset:22528
buffer_load_dwordx4 v[88:91], v1, s[4:7], s30 offen offset:1024
v_mfma_f32_16x16x32_bf16 v[24:27], v[92:95], v[152:155], v[24:27]
v_mfma_f32_16x16x32_bf16 v[28:31], v[92:95], v[156:159], v[28:31]
v_mfma_f32_16x16x32_bf16 v[32:35], v[92:95], v[160:163], v[32:35]
v_mfma_f32_16x16x32_bf16 v[36:39], v[92:95], v[164:167], v[36:39]
buffer_load_dwordx4 v[92:95], v1, s[4:7], s31 offen offset:1024
v_mfma_f32_16x16x32_bf16 v[40:43], v[96:99], v[152:155], v[40:43]
v_mfma_f32_16x16x32_bf16 v[44:47], v[96:99], v[156:159], v[44:47]
v_mfma_f32_16x16x32_bf16 v[48:51], v[96:99], v[160:163], v[48:51]
v_mfma_f32_16x16x32_bf16 v[52:55], v[96:99], v[164:167], v[52:55]
buffer_load_dwordx4 v[96:99], v1, s[4:7], s32 offen offset:1024
v_mfma_f32_16x16x32_bf16 v[56:59], v[100:103], v[152:155], v[56:59]
v_mfma_f32_16x16x32_bf16 v[60:63], v[100:103], v[156:159], v[60:63]
v_mfma_f32_16x16x32_bf16 v[64:67], v[100:103], v[160:163], v[64:67]
v_mfma_f32_16x16x32_bf16 v[68:71], v[100:103], v[164:167], v[68:71]
buffer_load_dwordx4 v[100:103], v1, s[4:7], s33 offen offset:1024
s_waitcnt vmcnt(12) lgkmcnt(0)
v_mfma_f32_16x16x32_bf16 v[8:11], v[104:107], v[136:139], v[8:11]
ds_read_b128 v[152:155], v6 offset:3072
v_mfma_f32_16x16x32_bf16 v[12:15], v[104:107], v[140:143], v[12:15]
ds_read_b128 v[156:159], v6 offset:23552
v_mfma_f32_16x16x32_bf16 v[16:19], v[104:107], v[144:147], v[16:19]
ds_read_b128 v[160:163], v7 offset:3072
v_mfma_f32_16x16x32_bf16 v[20:23], v[104:107], v[148:151], v[20:23]
ds_read_b128 v[164:167], v7 offset:23552
buffer_load_dwordx4 v[104:107], v1, s[4:7], s30 offen offset:2048
v_mfma_f32_16x16x32_bf16 v[24:27], v[108:111], v[136:139], v[24:27]
v_mfma_f32_16x16x32_bf16 v[28:31], v[108:111], v[140:143], v[28:31]
v_mfma_f32_16x16x32_bf16 v[32:35], v[108:111], v[144:147], v[32:35]
v_mfma_f32_16x16x32_bf16 v[36:39], v[108:111], v[148:151], v[36:39]
buffer_load_dwordx4 v[108:111], v1, s[4:7], s31 offen offset:2048
v_mfma_f32_16x16x32_bf16 v[40:43], v[112:115], v[136:139], v[40:43]
v_mfma_f32_16x16x32_bf16 v[44:47], v[112:115], v[140:143], v[44:47]
v_mfma_f32_16x16x32_bf16 v[48:51], v[112:115], v[144:147], v[48:51]
v_mfma_f32_16x16x32_bf16 v[52:55], v[112:115], v[148:151], v[52:55]
buffer_load_dwordx4 v[112:115], v1, s[4:7], s32 offen offset:2048
v_mfma_f32_16x16x32_bf16 v[56:59], v[116:119], v[136:139], v[56:59]
v_mfma_f32_16x16x32_bf16 v[60:63], v[116:119], v[140:143], v[60:63]
v_mfma_f32_16x16x32_bf16 v[64:67], v[116:119], v[144:147], v[64:67]
v_mfma_f32_16x16x32_bf16 v[68:71], v[116:119], v[148:151], v[68:71]
buffer_load_dwordx4 v[116:119], v1, s[4:7], s33 offen offset:2048
s_waitcnt vmcnt(12) lgkmcnt(0)
v_mfma_f32_16x16x32_bf16 v[8:11], v[120:123], v[152:155], v[8:11]
ds_read_b128 v[136:139], v6 offset:4096
v_mfma_f32_16x16x32_bf16 v[12:15], v[120:123], v[156:159], v[12:15]
ds_read_b128 v[140:143], v6 offset:24576
v_mfma_f32_16x16x32_bf16 v[16:19], v[120:123], v[160:163], v[16:19]
ds_read_b128 v[144:147], v7 offset:4096
v_mfma_f32_16x16x32_bf16 v[20:23], v[120:123], v[164:167], v[20:23]
ds_read_b128 v[148:151], v7 offset:24576
buffer_load_dwordx4 v[120:123], v1, s[4:7], s30 offen offset:3072
v_mfma_f32_16x16x32_bf16 v[24:27], v[124:127], v[152:155], v[24:27]
v_mfma_f32_16x16x32_bf16 v[28:31], v[124:127], v[156:159], v[28:31]
v_mfma_f32_16x16x32_bf16 v[32:35], v[124:127], v[160:163], v[32:35]
v_mfma_f32_16x16x32_bf16 v[36:39], v[124:127], v[164:167], v[36:39]
buffer_load_dwordx4 v[124:127], v1, s[4:7], s31 offen offset:3072
v_mfma_f32_16x16x32_bf16 v[40:43], v[128:131], v[152:155], v[40:43]
v_mfma_f32_16x16x32_bf16 v[44:47], v[128:131], v[156:159], v[44:47]
v_mfma_f32_16x16x32_bf16 v[48:51], v[128:131], v[160:163], v[48:51]
v_mfma_f32_16x16x32_bf16 v[52:55], v[128:131], v[164:167], v[52:55]
buffer_load_dwordx4 v[128:131], v1, s[4:7], s32 offen offset:3072
v_mfma_f32_16x16x32_bf16 v[56:59], v[132:135], v[152:155], v[56:59]
v_mfma_f32_16x16x32_bf16 v[60:63], v[132:135], v[156:159], v[60:63]
v_mfma_f32_16x16x32_bf16 v[64:67], v[132:135], v[160:163], v[64:67]
v_mfma_f32_16x16x32_bf16 v[68:71], v[132:135], v[164:167], v[68:71]
buffer_load_dwordx4 v[132:135], v1, s[4:7], s33 offen offset:3072
v_add_u32 v6, 4096, v6
v_add_u32 v7, 4096, v7
s_add_u32 s40, s40, 1
s_cmp_lt_u32 s40, 4
s_cbranch_scc1 qkvb_loop7
s_waitcnt vmcnt(0) lgkmcnt(0)
v_and_b32 v2, 63, v0
v_and_b32 v3, 15, v2
v_lshrrev_b32 v4, 4, v2
s_lshl_b32 s41, s17, 19
s_lshl_b32 s42, s18, 12
s_add_u32 s41, s41, s42
s_mov_b32 s46, 0x3ea52b5c
s_mov_b32 s47, 0x3ea52b5c
v_lshlrev_b32 v5, 2, v4
v_add_u32 v5, 64, v5
v_mul_u32_u24 v168, 205, v5
v_lshrrev_b32 v168, 12, v168
v_mul_u32_u24 v6, 20, v168
v_sub_u32 v5, v5, v6
v_lshlrev_b32 v168, 17, v168
v_lshrrev_b32 v6, 4, v5
v_lshl_add_u32 v168, v6, 10, v168
v_bfe_u32 v6, v5, 2, 1
v_lshl_add_u32 v168, v6, 9, v168
v_bfe_u32 v6, v5, 3, 1
v_lshl_add_u32 v168, v6, 3, v168
v_lshl_add_u32 v168, v3, 4, v168
v_lshlrev_b32 v5, 2, v4
v_add_u32 v5, 0, v5
v_mul_u32_u24 v169, 205, v5
v_lshrrev_b32 v169, 12, v169
v_mul_u32_u24 v6, 20, v169
v_sub_u32 v5, v5, v6
v_lshlrev_b32 v169, 17, v169
v_lshrrev_b32 v6, 4, v5
v_lshl_add_u32 v169, v6, 10, v169
v_bfe_u32 v6, v5, 2, 1
v_lshl_add_u32 v169, v6, 9, v169
v_bfe_u32 v6, v5, 3, 1
v_lshl_add_u32 v169, v6, 3, v169
v_lshl_add_u32 v169, v3, 4, v169
v_lshlrev_b32 v5, 2, v4
v_add_u32 v5, 16, v5
v_mul_u32_u24 v170, 205, v5
v_lshrrev_b32 v170, 12, v170
v_mul_u32_u24 v6, 20, v170
v_sub_u32 v5, v5, v6
v_lshlrev_b32 v170, 17, v170
v_lshrrev_b32 v6, 4, v5
v_lshl_add_u32 v170, v6, 10, v170
v_bfe_u32 v6, v5, 2, 1
v_lshl_add_u32 v170, v6, 9, v170
v_bfe_u32 v6, v5, 3, 1
v_lshl_add_u32 v170, v6, 3, v170
v_lshl_add_u32 v170, v3, 4, v170
v_lshlrev_b32 v5, 2, v4
v_add_u32 v5, 32, v5
v_mul_u32_u24 v171, 205, v5
v_lshrrev_b32 v171, 12, v171
v_mul_u32_u24 v6, 20, v171
v_sub_u32 v5, v5, v6
v_lshlrev_b32 v171, 17, v171
v_lshrrev_b32 v6, 4, v5
v_lshl_add_u32 v171, v6, 10, v171
v_bfe_u32 v6, v5, 2, 1
v_lshl_add_u32 v171, v6, 9, v171
v_bfe_u32 v6, v5, 3, 1
v_lshl_add_u32 v171, v6, 3, v171
v_lshl_add_u32 v171, v3, 4, v171
v_pk_mul_f32 v[8:9], v[8:9], s[46:47]
v_pk_mul_f32 v[10:11], v[10:11], s[46:47]
v_cvt_pk_bf16_f32 v136, v8, v9
v_cvt_pk_bf16_f32 v137, v10, v11
s_add_u32 s43, s41, 37748736
buffer_store_dwordx2 v[136:137], v168, s[4:7], s43 offen sc1
v_pk_mul_f32 v[12:13], v[12:13], s[46:47]
v_pk_mul_f32 v[14:15], v[14:15], s[46:47]
v_cvt_pk_bf16_f32 v138, v12, v13
v_cvt_pk_bf16_f32 v139, v14, v15
s_add_u32 s43, s41, 37748992
buffer_store_dwordx2 v[138:139], v168, s[4:7], s43 offen sc1
v_pk_mul_f32 v[16:17], v[16:17], s[46:47]
v_pk_mul_f32 v[18:19], v[18:19], s[46:47]
v_cvt_pk_bf16_f32 v140, v16, v17
v_cvt_pk_bf16_f32 v141, v18, v19
s_add_u32 s43, s41, 37750784
buffer_store_dwordx2 v[140:141], v168, s[4:7], s43 offen sc1
v_pk_mul_f32 v[20:21], v[20:21], s[46:47]
v_pk_mul_f32 v[22:23], v[22:23], s[46:47]
v_cvt_pk_bf16_f32 v142, v20, v21
v_cvt_pk_bf16_f32 v143, v22, v23
s_add_u32 s43, s41, 37751040
buffer_store_dwordx2 v[142:143], v168, s[4:7], s43 offen sc1
v_cvt_pk_bf16_f32 v144, v24, v25
v_cvt_pk_bf16_f32 v145, v26, v27
s_add_u32 s43, s41, 41943040
buffer_store_dwordx2 v[144:145], v169, s[4:7], s43 offen sc1
v_cvt_pk_bf16_f32 v146, v28, v29
v_cvt_pk_bf16_f32 v147, v30, v31
s_add_u32 s43, s41, 41943296
buffer_store_dwordx2 v[146:147], v169, s[4:7], s43 offen sc1
v_cvt_pk_bf16_f32 v148, v32, v33
v_cvt_pk_bf16_f32 v149, v34, v35
s_add_u32 s43, s41, 41945088
buffer_store_dwordx2 v[148:149], v169, s[4:7], s43 offen sc1
v_cvt_pk_bf16_f32 v150, v36, v37
v_cvt_pk_bf16_f32 v151, v38, v39
s_add_u32 s43, s41, 41945344
buffer_store_dwordx2 v[150:151], v169, s[4:7], s43 offen sc1
v_cvt_pk_bf16_f32 v136, v40, v41
v_cvt_pk_bf16_f32 v137, v42, v43
s_add_u32 s43, s41, 41943040
buffer_store_dwordx2 v[136:137], v170, s[4:7], s43 offen sc1
v_cvt_pk_bf16_f32 v138, v44, v45
v_cvt_pk_bf16_f32 v139, v46, v47
s_add_u32 s43, s41, 41943296
buffer_store_dwordx2 v[138:139], v170, s[4:7], s43 offen sc1
v_cvt_pk_bf16_f32 v140, v48, v49
v_cvt_pk_bf16_f32 v141, v50, v51
s_add_u32 s43, s41, 41945088
buffer_store_dwordx2 v[140:141], v170, s[4:7], s43 offen sc1
v_cvt_pk_bf16_f32 v142, v52, v53
v_cvt_pk_bf16_f32 v143, v54, v55
s_add_u32 s43, s41, 41945344
buffer_store_dwordx2 v[142:143], v170, s[4:7], s43 offen sc1
v_cvt_pk_bf16_f32 v144, v56, v57
v_cvt_pk_bf16_f32 v145, v58, v59
s_add_u32 s43, s41, 41943040
buffer_store_dwordx2 v[144:145], v171, s[4:7], s43 offen sc1
v_cvt_pk_bf16_f32 v146, v60, v61
v_cvt_pk_bf16_f32 v147, v62, v63
s_add_u32 s43, s41, 41943296
buffer_store_dwordx2 v[146:147], v171, s[4:7], s43 offen sc1
v_cvt_pk_bf16_f32 v148, v64, v65
v_cvt_pk_bf16_f32 v149, v66, v67
s_add_u32 s43, s41, 41945088
buffer_store_dwordx2 v[148:149], v171, s[4:7], s43 offen sc1
v_cvt_pk_bf16_f32 v150, v68, v69
v_cvt_pk_bf16_f32 v151, v70, v71
s_add_u32 s43, s41, 41945344
buffer_store_dwordx2 v[150:151], v171, s[4:7], s43 offen sc1
s_branch qkvb_exit1
qkvb_w2_4:
s_mul_i32 s30, s17, 5
s_add_u32 s30, s30, 43
s_mul_i32 s30, s30, 20480
s_add_u32 s30, s30, 87556096
s_mul_i32 s31, s17, 5
s_add_u32 s31, s31, 44
s_mul_i32 s31, s31, 20480
s_add_u32 s31, s31, 87556096
s_mul_i32 s32, s17, 5
s_add_u32 s32, s32, 80
s_mul_i32 s32, s32, 20480
s_add_u32 s32, s32, 87556096
s_mul_i32 s33, s17, 5
s_add_u32 s33, s33, 81
s_mul_i32 s33, s33, 20480
s_add_u32 s33, s33, 87556096
buffer_load_dwordx4 v[72:75], v1, s[4:7], s30 offen offset:0
buffer_load_dwordx4 v[76:79], v1, s[4:7], s31 offen offset:0
buffer_load_dwordx4 v[80:83], v1, s[4:7], s32 offen offset:0
buffer_load_dwordx4 v[84:87], v1, s[4:7], s33 offen offset:0
buffer_load_dwordx4 v[88:91], v1, s[4:7], s30 offen offset:1024
buffer_load_dwordx4 v[92:95], v1, s[4:7], s31 offen offset:1024
buffer_load_dwordx4 v[96:99], v1, s[4:7], s32 offen offset:1024
buffer_load_dwordx4 v[100:103], v1, s[4:7], s33 offen offset:1024
buffer_load_dwordx4 v[104:107], v1, s[4:7], s30 offen offset:2048
buffer_load_dwordx4 v[108:111], v1, s[4:7], s31 offen offset:2048
buffer_load_dwordx4 v[112:115], v1, s[4:7], s32 offen offset:2048
buffer_load_dwordx4 v[116:119], v1, s[4:7], s33 offen offset:2048
s_add_u32 m0, s22, 4096
s_add_u32 s23, s21, 4096
buffer_load_dwordx4 v1, s[4:7], s23 offen offset:0 lds
buffer_load_dwordx4 v1, s[4:7], s23 offen offset:1024 lds
buffer_load_dwordx4 v1, s[4:7], s23 offen offset:2048 lds
buffer_load_dwordx4 v1, s[4:7], s23 offen offset:3072 lds
s_add_u32 m0, s22, 8192
s_add_u32 s23, s21, 8192
buffer_load_dwordx4 v1, s[4:7], s23 offen offset:0 lds
buffer_load_dwordx4 v1, s[4:7], s23 offen offset:1024 lds
buffer_load_dwordx4 v1, s[4:7], s23 offen offset:2048 lds
buffer_load_dwordx4 v1, s[4:7], s23 offen offset:3072 lds
s_add_u32 m0, s22, 12288
s_add_u32 s23, s21, 12288
buffer_load_dwordx4 v1, s[4:7], s23 offen offset:0 lds
buffer_load_dwordx4 v1, s[4:7], s23 offen offset:1024 lds
buffer_load_dwordx4 v1, s[4:7], s23 offen offset:2048 lds
buffer_load_dwordx4 v1, s[4:7], s23 offen offset:3072 lds
s_add_u32 m0, s22, 16384
s_add_u32 s23, s21, 16384
buffer_load_dwordx4 v1, s[4:7], s23 offen offset:0 lds
buffer_load_dwordx4 v1, s[4:7], s23 offen offset:1024 lds
buffer_load_dwordx4 v1, s[4:7], s23 offen offset:2048 lds
buffer_load_dwordx4 v1, s[4:7], s23 offen offset:3072 lds
s_waitcnt vmcnt(28)
s_barrier
buffer_load_dwordx4 v[120:123], v1, s[4:7], s30 offen offset:3072
buffer_load_dwordx4 v[124:127], v1, s[4:7], s31 offen offset:3072
buffer_load_dwordx4 v[128:131], v1, s[4:7], s32 offen offset:3072
buffer_load_dwordx4 v[132:135], v1, s[4:7], s33 offen offset:3072
ds_read_b128 v[136:139], v6 offset:0
ds_read_b128 v[140:143], v6 offset:20480
ds_read_b128 v[144:147], v7 offset:0
ds_read_b128 v[148:151], v7 offset:20480
s_waitcnt vmcnt(28) lgkmcnt(0)
v_mfma_f32_16x16x32_bf16 v[8:11], v[72:75], v[136:139], 0
ds_read_b128 v[152:155], v6 offset:1024
v_mfma_f32_16x16x32_bf16 v[12:15], v[72:75], v[140:143], 0
ds_read_b128 v[156:159], v6 offset:21504
v_mfma_f32_16x16x32_bf16 v[16:19], v[72:75], v[144:147], 0
ds_read_b128 v[160:163], v7 offset:1024
v_mfma_f32_16x16x32_bf16 v[20:23], v[72:75], v[148:151], 0
ds_read_b128 v[164:167], v7 offset:21504
s_add_u32 s30, s30, 4096
buffer_load_dwordx4 v[72:75], v1, s[4:7], s30 offen offset:0
v_mfma_f32_16x16x32_bf16 v[24:27], v[76:79], v[136:139], 0
v_mfma_f32_16x16x32_bf16 v[28:31], v[76:79], v[140:143], 0
v_mfma_f32_16x16x32_bf16 v[32:35], v[76:79], v[144:147], 0
v_mfma_f32_16x16x32_bf16 v[36:39], v[76:79], v[148:151], 0
s_add_u32 s31, s31, 4096
buffer_load_dwordx4 v[76:79], v1, s[4:7], s31 offen offset:0
v_mfma_f32_16x16x32_bf16 v[40:43], v[136:139], v[80:83], 0
v_mfma_f32_16x16x32_bf16 v[44:47], v[140:143], v[80:83], 0
v_mfma_f32_16x16x32_bf16 v[48:51], v[144:147], v[80:83], 0
v_mfma_f32_16x16x32_bf16 v[52:55], v[148:151], v[80:83], 0
s_add_u32 s32, s32, 4096
buffer_load_dwordx4 v[80:83], v1, s[4:7], s32 offen offset:0
v_mfma_f32_16x16x32_bf16 v[56:59], v[136:139], v[84:87], 0
v_mfma_f32_16x16x32_bf16 v[60:63], v[140:143], v[84:87], 0
v_mfma_f32_16x16x32_bf16 v[64:67], v[144:147], v[84:87], 0
v_mfma_f32_16x16x32_bf16 v[68:71], v[148:151], v[84:87], 0
s_add_u32 s33, s33, 4096
buffer_load_dwordx4 v[84:87], v1, s[4:7], s33 offen offset:0
s_waitcnt vmcnt(28) lgkmcnt(0)
v_mfma_f32_16x16x32_bf16 v[8:11], v[88:91], v[152:155], v[8:11]
ds_read_b128 v[136:139], v6 offset:2048
v_mfma_f32_16x16x32_bf16 v[12:15], v[88:91], v[156:159], v[12:15]
ds_read_b128 v[140:143], v6 offset:22528
v_mfma_f32_16x16x32_bf16 v[16:19], v[88:91], v[160:163], v[16:19]
ds_read_b128 v[144:147], v7 offset:2048
v_mfma_f32_16x16x32_bf16 v[20:23], v[88:91], v[164:167], v[20:23]
ds_read_b128 v[148:151], v7 offset:22528
buffer_load_dwordx4 v[88:91], v1, s[4:7], s30 offen offset:1024
v_mfma_f32_16x16x32_bf16 v[24:27], v[92:95], v[152:155], v[24:27]
v_mfma_f32_16x16x32_bf16 v[28:31], v[92:95], v[156:159], v[28:31]
v_mfma_f32_16x16x32_bf16 v[32:35], v[92:95], v[160:163], v[32:35]
v_mfma_f32_16x16x32_bf16 v[36:39], v[92:95], v[164:167], v[36:39]
buffer_load_dwordx4 v[92:95], v1, s[4:7], s31 offen offset:1024
v_mfma_f32_16x16x32_bf16 v[40:43], v[152:155], v[96:99], v[40:43]
v_mfma_f32_16x16x32_bf16 v[44:47], v[156:159], v[96:99], v[44:47]
v_mfma_f32_16x16x32_bf16 v[48:51], v[160:163], v[96:99], v[48:51]
v_mfma_f32_16x16x32_bf16 v[52:55], v[164:167], v[96:99], v[52:55]
buffer_load_dwordx4 v[96:99], v1, s[4:7], s32 offen offset:1024
v_mfma_f32_16x16x32_bf16 v[56:59], v[152:155], v[100:103], v[56:59]
v_mfma_f32_16x16x32_bf16 v[60:63], v[156:159], v[100:103], v[60:63]
v_mfma_f32_16x16x32_bf16 v[64:67], v[160:163], v[100:103], v[64:67]
v_mfma_f32_16x16x32_bf16 v[68:71], v[164:167], v[100:103], v[68:71]
buffer_load_dwordx4 v[100:103], v1, s[4:7], s33 offen offset:1024
s_waitcnt vmcnt(28) lgkmcnt(0)
v_mfma_f32_16x16x32_bf16 v[8:11], v[104:107], v[136:139], v[8:11]
ds_read_b128 v[152:155], v6 offset:3072
v_mfma_f32_16x16x32_bf16 v[12:15], v[104:107], v[140:143], v[12:15]
ds_read_b128 v[156:159], v6 offset:23552
v_mfma_f32_16x16x32_bf16 v[16:19], v[104:107], v[144:147], v[16:19]
ds_read_b128 v[160:163], v7 offset:3072
v_mfma_f32_16x16x32_bf16 v[20:23], v[104:107], v[148:151], v[20:23]
ds_read_b128 v[164:167], v7 offset:23552
buffer_load_dwordx4 v[104:107], v1, s[4:7], s30 offen offset:2048
v_mfma_f32_16x16x32_bf16 v[24:27], v[108:111], v[136:139], v[24:27]
v_mfma_f32_16x16x32_bf16 v[28:31], v[108:111], v[140:143], v[28:31]
v_mfma_f32_16x16x32_bf16 v[32:35], v[108:111], v[144:147], v[32:35]
v_mfma_f32_16x16x32_bf16 v[36:39], v[108:111], v[148:151], v[36:39]
buffer_load_dwordx4 v[108:111], v1, s[4:7], s31 offen offset:2048
v_mfma_f32_16x16x32_bf16 v[40:43], v[136:139], v[112:115], v[40:43]
v_mfma_f32_16x16x32_bf16 v[44:47], v[140:143], v[112:115], v[44:47]
v_mfma_f32_16x16x32_bf16 v[48:51], v[144:147], v[112:115], v[48:51]
v_mfma_f32_16x16x32_bf16 v[52:55], v[148:151], v[112:115], v[52:55]
buffer_load_dwordx4 v[112:115], v1, s[4:7], s32 offen offset:2048
v_mfma_f32_16x16x32_bf16 v[56:59], v[136:139], v[116:119], v[56:59]
v_mfma_f32_16x16x32_bf16 v[60:63], v[140:143], v[116:119], v[60:63]
v_mfma_f32_16x16x32_bf16 v[64:67], v[144:147], v[116:119], v[64:67]
v_mfma_f32_16x16x32_bf16 v[68:71], v[148:151], v[116:119], v[68:71]
buffer_load_dwordx4 v[116:119], v1, s[4:7], s33 offen offset:2048
s_waitcnt vmcnt(12) lgkmcnt(0)
s_barrier
v_mfma_f32_16x16x32_bf16 v[8:11], v[120:123], v[152:155], v[8:11]
ds_read_b128 v[136:139], v6 offset:4096
v_mfma_f32_16x16x32_bf16 v[12:15], v[120:123], v[156:159], v[12:15]
ds_read_b128 v[140:143], v6 offset:24576
v_mfma_f32_16x16x32_bf16 v[16:19], v[120:123], v[160:163], v[16:19]
ds_read_b128 v[144:147], v7 offset:4096
v_mfma_f32_16x16x32_bf16 v[20:23], v[120:123], v[164:167], v[20:23]
ds_read_b128 v[148:151], v7 offset:24576
buffer_load_dwordx4 v[120:123], v1, s[4:7], s30 offen offset:3072
v_mfma_f32_16x16x32_bf16 v[24:27], v[124:127], v[152:155], v[24:27]
v_mfma_f32_16x16x32_bf16 v[28:31], v[124:127], v[156:159], v[28:31]
v_mfma_f32_16x16x32_bf16 v[32:35], v[124:127], v[160:163], v[32:35]
v_mfma_f32_16x16x32_bf16 v[36:39], v[124:127], v[164:167], v[36:39]
buffer_load_dwordx4 v[124:127], v1, s[4:7], s31 offen offset:3072
v_mfma_f32_16x16x32_bf16 v[40:43], v[152:155], v[128:131], v[40:43]
v_mfma_f32_16x16x32_bf16 v[44:47], v[156:159], v[128:131], v[44:47]
v_mfma_f32_16x16x32_bf16 v[48:51], v[160:163], v[128:131], v[48:51]
v_mfma_f32_16x16x32_bf16 v[52:55], v[164:167], v[128:131], v[52:55]
buffer_load_dwordx4 v[128:131], v1, s[4:7], s32 offen offset:3072
v_mfma_f32_16x16x32_bf16 v[56:59], v[152:155], v[132:135], v[56:59]
v_mfma_f32_16x16x32_bf16 v[60:63], v[156:159], v[132:135], v[60:63]
v_mfma_f32_16x16x32_bf16 v[64:67], v[160:163], v[132:135], v[64:67]
v_mfma_f32_16x16x32_bf16 v[68:71], v[164:167], v[132:135], v[68:71]
buffer_load_dwordx4 v[132:135], v1, s[4:7], s33 offen offset:3072
s_mov_b32 s40, 0
v_add_u32 v6, 4096, v6
v_add_u32 v7, 4096, v7
qkvb_loop8:
s_waitcnt vmcnt(12) lgkmcnt(0)
v_mfma_f32_16x16x32_bf16 v[8:11], v[72:75], v[136:139], v[8:11]
ds_read_b128 v[152:155], v6 offset:1024
v_mfma_f32_16x16x32_bf16 v[12:15], v[72:75], v[140:143], v[12:15]
ds_read_b128 v[156:159], v6 offset:21504
v_mfma_f32_16x16x32_bf16 v[16:19], v[72:75], v[144:147], v[16:19]
ds_read_b128 v[160:163], v7 offset:1024
v_mfma_f32_16x16x32_bf16 v[20:23], v[72:75], v[148:151], v[20:23]
ds_read_b128 v[164:167], v7 offset:21504
s_add_u32 s30, s30, 4096
buffer_load_dwordx4 v[72:75], v1, s[4:7], s30 offen offset:0
v_mfma_f32_16x16x32_bf16 v[24:27], v[76:79], v[136:139], v[24:27]
v_mfma_f32_16x16x32_bf16 v[28:31], v[76:79], v[140:143], v[28:31]
v_mfma_f32_16x16x32_bf16 v[32:35], v[76:79], v[144:147], v[32:35]
v_mfma_f32_16x16x32_bf16 v[36:39], v[76:79], v[148:151], v[36:39]
s_add_u32 s31, s31, 4096
buffer_load_dwordx4 v[76:79], v1, s[4:7], s31 offen offset:0
v_mfma_f32_16x16x32_bf16 v[40:43], v[136:139], v[80:83], v[40:43]
v_mfma_f32_16x16x32_bf16 v[44:47], v[140:143], v[80:83], v[44:47]
v_mfma_f32_16x16x32_bf16 v[48:51], v[144:147], v[80:83], v[48:51]
v_mfma_f32_16x16x32_bf16 v[52:55], v[148:151], v[80:83], v[52:55]
s_add_u32 s32, s32, 4096
buffer_load_dwordx4 v[80:83], v1, s[4:7], s32 offen offset:0
v_mfma_f32_16x16x32_bf16 v[56:59], v[136:139], v[84:87], v[56:59]
v_mfma_f32_16x16x32_bf16 v[60:63], v[140:143], v[84:87], v[60:63]
v_mfma_f32_16x16x32_bf16 v[64:67], v[144:147], v[84:87], v[64:67]
v_mfma_f32_16x16x32_bf16 v[68:71], v[148:151], v[84:87], v[68:71]
s_add_u32 s33, s33, 4096
buffer_load_dwordx4 v[84:87], v1, s[4:7], s33 offen offset:0
s_waitcnt vmcnt(12) lgkmcnt(0)
v_mfma_f32_16x16x32_bf16 v[8:11], v[88:91], v[152:155], v[8:11]
ds_read_b128 v[136:139], v6 offset:2048
v_mfma_f32_16x16x32_bf16 v[12:15], v[88:91], v[156:159], v[12:15]
ds_read_b128 v[140:143], v6 offset:22528
v_mfma_f32_16x16x32_bf16 v[16:19], v[88:91], v[160:163], v[16:19]
ds_read_b128 v[144:147], v7 offset:2048
v_mfma_f32_16x16x32_bf16 v[20:23], v[88:91], v[164:167], v[20:23]
ds_read_b128 v[148:151], v7 offset:22528
buffer_load_dwordx4 v[88:91], v1, s[4:7], s30 offen offset:1024
v_mfma_f32_16x16x32_bf16 v[24:27], v[92:95], v[152:155], v[24:27]
v_mfma_f32_16x16x32_bf16 v[28:31], v[92:95], v[156:159], v[28:31]
v_mfma_f32_16x16x32_bf16 v[32:35], v[92:95], v[160:163], v[32:35]
v_mfma_f32_16x16x32_bf16 v[36:39], v[92:95], v[164:167], v[36:39]
buffer_load_dwordx4 v[92:95], v1, s[4:7], s31 offen offset:1024
v_mfma_f32_16x16x32_bf16 v[40:43], v[152:155], v[96:99], v[40:43]
v_mfma_f32_16x16x32_bf16 v[44:47], v[156:159], v[96:99], v[44:47]
v_mfma_f32_16x16x32_bf16 v[48:51], v[160:163], v[96:99], v[48:51]
v_mfma_f32_16x16x32_bf16 v[52:55], v[164:167], v[96:99], v[52:55]
buffer_load_dwordx4 v[96:99], v1, s[4:7], s32 offen offset:1024
v_mfma_f32_16x16x32_bf16 v[56:59], v[152:155], v[100:103], v[56:59]
v_mfma_f32_16x16x32_bf16 v[60:63], v[156:159], v[100:103], v[60:63]
v_mfma_f32_16x16x32_bf16 v[64:67], v[160:163], v[100:103], v[64:67]
v_mfma_f32_16x16x32_bf16 v[68:71], v[164:167], v[100:103], v[68:71]
buffer_load_dwordx4 v[100:103], v1, s[4:7], s33 offen offset:1024
s_waitcnt vmcnt(12) lgkmcnt(0)
v_mfma_f32_16x16x32_bf16 v[8:11], v[104:107], v[136:139], v[8:11]
ds_read_b128 v[152:155], v6 offset:3072
v_mfma_f32_16x16x32_bf16 v[12:15], v[104:107], v[140:143], v[12:15]
ds_read_b128 v[156:159], v6 offset:23552
v_mfma_f32_16x16x32_bf16 v[16:19], v[104:107], v[144:147], v[16:19]
ds_read_b128 v[160:163], v7 offset:3072
v_mfma_f32_16x16x32_bf16 v[20:23], v[104:107], v[148:151], v[20:23]
ds_read_b128 v[164:167], v7 offset:23552
buffer_load_dwordx4 v[104:107], v1, s[4:7], s30 offen offset:2048
v_mfma_f32_16x16x32_bf16 v[24:27], v[108:111], v[136:139], v[24:27]
v_mfma_f32_16x16x32_bf16 v[28:31], v[108:111], v[140:143], v[28:31]
v_mfma_f32_16x16x32_bf16 v[32:35], v[108:111], v[144:147], v[32:35]
v_mfma_f32_16x16x32_bf16 v[36:39], v[108:111], v[148:151], v[36:39]
buffer_load_dwordx4 v[108:111], v1, s[4:7], s31 offen offset:2048
v_mfma_f32_16x16x32_bf16 v[40:43], v[136:139], v[112:115], v[40:43]
v_mfma_f32_16x16x32_bf16 v[44:47], v[140:143], v[112:115], v[44:47]
v_mfma_f32_16x16x32_bf16 v[48:51], v[144:147], v[112:115], v[48:51]
v_mfma_f32_16x16x32_bf16 v[52:55], v[148:151], v[112:115], v[52:55]
buffer_load_dwordx4 v[112:115], v1, s[4:7], s32 offen offset:2048
v_mfma_f32_16x16x32_bf16 v[56:59], v[136:139], v[116:119], v[56:59]
v_mfma_f32_16x16x32_bf16 v[60:63], v[140:143], v[116:119], v[60:63]
v_mfma_f32_16x16x32_bf16 v[64:67], v[144:147], v[116:119], v[64:67]
v_mfma_f32_16x16x32_bf16 v[68:71], v[148:151], v[116:119], v[68:71]
buffer_load_dwordx4 v[116:119], v1, s[4:7], s33 offen offset:2048
s_waitcnt vmcnt(12) lgkmcnt(0)
v_mfma_f32_16x16x32_bf16 v[8:11], v[120:123], v[152:155], v[8:11]
ds_read_b128 v[136:139], v6 offset:4096
v_mfma_f32_16x16x32_bf16 v[12:15], v[120:123], v[156:159], v[12:15]
ds_read_b128 v[140:143], v6 offset:24576
v_mfma_f32_16x16x32_bf16 v[16:19], v[120:123], v[160:163], v[16:19]
ds_read_b128 v[144:147], v7 offset:4096
v_mfma_f32_16x16x32_bf16 v[20:23], v[120:123], v[164:167], v[20:23]
ds_read_b128 v[148:151], v7 offset:24576
buffer_load_dwordx4 v[120:123], v1, s[4:7], s30 offen offset:3072
v_mfma_f32_16x16x32_bf16 v[24:27], v[124:127], v[152:155], v[24:27]
v_mfma_f32_16x16x32_bf16 v[28:31], v[124:127], v[156:159], v[28:31]
v_mfma_f32_16x16x32_bf16 v[32:35], v[124:127], v[160:163], v[32:35]
v_mfma_f32_16x16x32_bf16 v[36:39], v[124:127], v[164:167], v[36:39]
buffer_load_dwordx4 v[124:127], v1, s[4:7], s31 offen offset:3072
v_mfma_f32_16x16x32_bf16 v[40:43], v[152:155], v[128:131], v[40:43]
v_mfma_f32_16x16x32_bf16 v[44:47], v[156:159], v[128:131], v[44:47]
v_mfma_f32_16x16x32_bf16 v[48:51], v[160:163], v[128:131], v[48:51]
v_mfma_f32_16x16x32_bf16 v[52:55], v[164:167], v[128:131], v[52:55]
buffer_load_dwordx4 v[128:131], v1, s[4:7], s32 offen offset:3072
v_mfma_f32_16x16x32_bf16 v[56:59], v[152:155], v[132:135], v[56:59]
v_mfma_f32_16x16x32_bf16 v[60:63], v[156:159], v[132:135], v[60:63]
v_mfma_f32_16x16x32_bf16 v[64:67], v[160:163], v[132:135], v[64:67]
v_mfma_f32_16x16x32_bf16 v[68:71], v[164:167], v[132:135], v[68:71]
buffer_load_dwordx4 v[132:135], v1, s[4:7], s33 offen offset:3072
v_add_u32 v6, 4096, v6
v_add_u32 v7, 4096, v7
s_add_u32 s40, s40, 1
s_cmp_lt_u32 s40, 4
s_cbranch_scc1 qkvb_loop8
s_waitcnt vmcnt(0) lgkmcnt(0)
v_and_b32 v2, 63, v0
v_and_b32 v3, 15, v2
v_lshrrev_b32 v4, 4, v2
s_lshl_b32 s41, s17, 19
s_lshl_b32 s42, s18, 12
s_add_u32 s41, s41, s42
s_mov_b32 s46, 0x3ea52b5c
s_mov_b32 s47, 0x3ea52b5c
v_lshlrev_b32 v5, 2, v4
v_add_u32 v5, 48, v5
v_mul_u32_u24 v168, 205, v5
v_lshrrev_b32 v168, 12, v168
v_mul_u32_u24 v6, 20, v168
v_sub_u32 v5, v5, v6
v_lshlrev_b32 v168, 17, v168
v_lshrrev_b32 v6, 4, v5
v_lshl_add_u32 v168, v6, 10, v168
v_bfe_u32 v6, v5, 2, 1
v_lshl_add_u32 v168, v6, 9, v168
v_bfe_u32 v6, v5, 3, 1
v_lshl_add_u32 v168, v6, 3, v168
v_lshl_add_u32 v168, v3, 4, v168
v_lshlrev_b32 v5, 2, v4
v_add_u32 v5, 64, v5
v_mul_u32_u24 v169, 205, v5
v_lshrrev_b32 v169, 12, v169
v_mul_u32_u24 v6, 20, v169
v_sub_u32 v5, v5, v6
v_lshlrev_b32 v169, 17, v169
v_lshrrev_b32 v6, 4, v5
v_lshl_add_u32 v169, v6, 10, v169
v_bfe_u32 v6, v5, 2, 1
v_lshl_add_u32 v169, v6, 9, v169
v_bfe_u32 v6, v5, 3, 1
v_lshl_add_u32 v169, v6, 3, v169
v_lshl_add_u32 v169, v3, 4, v169
v_add_u32 v5, 0, v3
v_mul_u32_u24 v170, 205, v5
v_lshrrev_b32 v170, 12, v170
v_mul_u32_u24 v6, 20, v170
v_sub_u32 v5, v5, v6
v_lshlrev_b32 v170, 17, v170
v_lshl_add_u32 v170, v5, 4, v170
v_and_b32 v6, 1, v4
v_lshl_add_u32 v170, v6, 9, v170
v_lshrrev_b32 v6, 1, v4
v_lshl_add_u32 v170, v6, 3, v170
v_add_u32 v5, 16, v3
v_mul_u32_u24 v171, 205, v5
v_lshrrev_b32 v171, 12, v171
v_mul_u32_u24 v6, 20, v171
v_sub_u32 v5, v5, v6
v_lshlrev_b32 v171, 17, v171
v_lshl_add_u32 v171, v5, 4, v171
v_and_b32 v6, 1, v4
v_lshl_add_u32 v171, v6, 9, v171
v_lshrrev_b32 v6, 1, v4
v_lshl_add_u32 v171, v6, 3, v171
v_cvt_pk_bf16_f32 v136, v8, v9
v_cvt_pk_bf16_f32 v137, v10, v11
s_add_u32 s43, s41, 41943040
buffer_store_dwordx2 v[136:137], v168, s[4:7], s43 offen sc1
v_cvt_pk_bf16_f32 v138, v12, v13
v_cvt_pk_bf16_f32 v139, v14, v15
s_add_u32 s43, s41, 41943296
buffer_store_dwordx2 v[138:139], v168, s[4:7], s43 offen sc1
v_cvt_pk_bf16_f32 v140, v16, v17
v_cvt_pk_bf16_f32 v141, v18, v19
s_add_u32 s43, s41, 41945088
buffer_store_dwordx2 v[140:141], v168, s[4:7], s43 offen sc1
v_cvt_pk_bf16_f32 v142, v20, v21
v_cvt_pk_bf16_f32 v143, v22, v23
s_add_u32 s43, s41, 41945344
buffer_store_dwordx2 v[142:143], v168, s[4:7], s43 offen sc1
v_cvt_pk_bf16_f32 v144, v24, v25
v_cvt_pk_bf16_f32 v145, v26, v27
s_add_u32 s43, s41, 41943040
buffer_store_dwordx2 v[144:145], v169, s[4:7], s43 offen sc1
v_cvt_pk_bf16_f32 v146, v28, v29
v_cvt_pk_bf16_f32 v147, v30, v31
s_add_u32 s43, s41, 41943296
buffer_store_dwordx2 v[146:147], v169, s[4:7], s43 offen sc1
v_cvt_pk_bf16_f32 v148, v32, v33
v_cvt_pk_bf16_f32 v149, v34, v35
s_add_u32 s43, s41, 41945088
buffer_store_dwordx2 v[148:149], v169, s[4:7], s43 offen sc1
v_cvt_pk_bf16_f32 v150, v36, v37
v_cvt_pk_bf16_f32 v151, v38, v39
s_add_u32 s43, s41, 41945344
buffer_store_dwordx2 v[150:151], v169, s[4:7], s43 offen sc1
v_cvt_pk_bf16_f32 v136, v40, v41
v_cvt_pk_bf16_f32 v137, v42, v43
s_add_u32 s43, s41, 46137344
buffer_store_dwordx2 v[136:137], v170, s[4:7], s43 offen sc1
v_cvt_pk_bf16_f32 v138, v44, v45
v_cvt_pk_bf16_f32 v139, v46, v47
s_add_u32 s43, s41, 46138368
buffer_store_dwordx2 v[138:139], v170, s[4:7], s43 offen sc1
v_cvt_pk_bf16_f32 v140, v48, v49
v_cvt_pk_bf16_f32 v141, v50, v51
s_add_u32 s43, s41, 46139392
buffer_store_dwordx2 v[140:141], v170, s[4:7], s43 offen sc1
v_cvt_pk_bf16_f32 v142, v52, v53
v_cvt_pk_bf16_f32 v143, v54, v55
s_add_u32 s43, s41, 46140416
buffer_store_dwordx2 v[142:143], v170, s[4:7], s43 offen sc1
v_cvt_pk_bf16_f32 v144, v56, v57
v_cvt_pk_bf16_f32 v145, v58, v59
s_add_u32 s43, s41, 46137344
buffer_store_dwordx2 v[144:145], v171, s[4:7], s43 offen sc1
v_cvt_pk_bf16_f32 v146, v60, v61
v_cvt_pk_bf16_f32 v147, v62, v63
s_add_u32 s43, s41, 46138368
buffer_store_dwordx2 v[146:147], v171, s[4:7], s43 offen sc1
v_cvt_pk_bf16_f32 v148, v64, v65
v_cvt_pk_bf16_f32 v149, v66, v67
s_add_u32 s43, s41, 46139392
buffer_store_dwordx2 v[148:149], v171, s[4:7], s43 offen sc1
v_cvt_pk_bf16_f32 v150, v68, v69
v_cvt_pk_bf16_f32 v151, v70, v71
s_add_u32 s43, s41, 46140416
buffer_store_dwordx2 v[150:151], v171, s[4:7], s43 offen sc1
s_branch qkvb_exit1
qkvb_w3_5:
s_mul_i32 s30, s17, 5
s_add_u32 s30, s30, 82
s_mul_i32 s30, s30, 20480
s_add_u32 s30, s30, 87556096
s_mul_i32 s31, s17, 5
s_add_u32 s31, s31, 83
s_mul_i32 s31, s31, 20480
s_add_u32 s31, s31, 87556096
s_mul_i32 s32, s17, 5
s_add_u32 s32, s32, 84
s_mul_i32 s32, s32, 20480
s_add_u32 s32, s32, 87556096
buffer_load_dwordx4 v[72:75], v1, s[4:7], s30 offen offset:0
buffer_load_dwordx4 v[76:79], v1, s[4:7], s31 offen offset:0
buffer_load_dwordx4 v[80:83], v1, s[4:7], s32 offen offset:0
buffer_load_dwordx4 v[88:91], v1, s[4:7], s30 offen offset:1024
buffer_load_dwordx4 v[92:95], v1, s[4:7], s31 offen offset:1024
buffer_load_dwordx4 v[96:99], v1, s[4:7], s32 offen offset:1024
buffer_load_dwordx4 v[104:107], v1, s[4:7], s30 offen offset:2048
buffer_load_dwordx4 v[108:111], v1, s[4:7], s31 offen offset:2048
buffer_load_dwordx4 v[112:115], v1, s[4:7], s32 offen offset:2048
s_add_u32 m0, s22, 4096
s_add_u32 s23, s21, 4096
buffer_load_dwordx4 v1, s[4:7], s23 offen offset:0 lds
buffer_load_dwordx4 v1, s[4:7], s23 offen offset:1024 lds
buffer_load_dwordx4 v1, s[4:7], s23 offen offset:2048 lds
buffer_load_dwordx4 v1, s[4:7], s23 offen offset:3072 lds
s_add_u32 m0, s22, 8192
s_add_u32 s23, s21, 8192
buffer_load_dwordx4 v1, s[4:7], s23 offen offset:0 lds
buffer_load_dwordx4 v1, s[4:7], s23 offen offset:1024 lds
buffer_load_dwordx4 v1, s[4:7], s23 offen offset:2048 lds
buffer_load_dwordx4 v1, s[4:7], s23 offen offset:3072 lds
s_add_u32 m0, s22, 12288
s_add_u32 s23, s21, 12288
buffer_load_dwordx4 v1, s[4:7], s23 offen offset:0 lds
buffer_load_dwordx4 v1, s[4:7], s23 offen offset:1024 lds
buffer_load_dwordx4 v1, s[4:7], s23 offen offset:2048 lds
buffer_load_dwordx4 v1, s[4:7], s23 offen offset:3072 lds
s_add_u32 m0, s22, 16384
s_add_u32 s23, s21, 16384
buffer_load_dwordx4 v1, s[4:7], s23 offen offset:0 lds
buffer_load_dwordx4 v1, s[4:7], s23 offen offset:1024 lds
buffer_load_dwordx4 v1, s[4:7], s23 offen offset:2048 lds
buffer_load_dwordx4 v1, s[4:7], s23 offen offset:3072 lds
s_waitcnt vmcnt(25)
s_barrier
buffer_load_dwordx4 v[120:123], v1, s[4:7], s30 offen offset:3072
buffer_load_dwordx4 v[124:127], v1, s[4:7], s31 offen offset:3072
buffer_load_dwordx4 v[128:131], v1, s[4:7], s32 offen offset:3072
ds_read_b128 v[136:139], v6 offset:0
ds_read_b128 v[140:143], v6 offset:20480
ds_read_b128 v[144:147], v7 offset:0
ds_read_b128 v[148:151], v7 offset:20480
s_waitcnt vmcnt(25) lgkmcnt(0)
v_mfma_f32_16x16x32_bf16 v[8:11], v[136:139], v[72:75], 0
ds_read_b128 v[152:155], v6 offset:1024
v_mfma_f32_16x16x32_bf16 v[12:15], v[140:143], v[72:75], 0
ds_read_b128 v[156:159], v6 offset:21504
v_mfma_f32_16x16x32_bf16 v[16:19], v[144:147], v[72:75], 0
ds_read_b128 v[160:163], v7 offset:1024
v_mfma_f32_16x16x32_bf16 v[20:23], v[148:151], v[72:75], 0
ds_read_b128 v[164:167], v7 offset:21504
s_add_u32 s30, s30, 4096
buffer_load_dwordx4 v[72:75], v1, s[4:7], s30 offen offset:0
v_mfma_f32_16x16x32_bf16 v[24:27], v[136:139], v[76:79], 0
v_mfma_f32_16x16x32_bf16 v[28:31], v[140:143], v[76:79], 0
v_mfma_f32_16x16x32_bf16 v[32:35], v[144:147], v[76:79], 0
v_mfma_f32_16x16x32_bf16 v[36:39], v[148:151], v[76:79], 0
s_add_u32 s31, s31, 4096
buffer_load_dwordx4 v[76:79], v1, s[4:7], s31 offen offset:0
v_mfma_f32_16x16x32_bf16 v[40:43], v[136:139], v[80:83], 0
v_mfma_f32_16x16x32_bf16 v[44:47], v[140:143], v[80:83], 0
v_mfma_f32_16x16x32_bf16 v[48:51], v[144:147], v[80:83], 0
v_mfma_f32_16x16x32_bf16 v[52:55], v[148:151], v[80:83], 0
s_add_u32 s32, s32, 4096
buffer_load_dwordx4 v[80:83], v1, s[4:7], s32 offen offset:0
s_waitcnt vmcnt(25) lgkmcnt(0)
v_mfma_f32_16x16x32_bf16 v[8:11], v[152:155], v[88:91], v[8:11]
ds_read_b128 v[136:139], v6 offset:2048
v_mfma_f32_16x16x32_bf16 v[12:15], v[156:159], v[88:91], v[12:15]
ds_read_b128 v[140:143], v6 offset:22528
v_mfma_f32_16x16x32_bf16 v[16:19], v[160:163], v[88:91], v[16:19]
ds_read_b128 v[144:147], v7 offset:2048
v_mfma_f32_16x16x32_bf16 v[20:23], v[164:167], v[88:91], v[20:23]
ds_read_b128 v[148:151], v7 offset:22528
buffer_load_dwordx4 v[88:91], v1, s[4:7], s30 offen offset:1024
v_mfma_f32_16x16x32_bf16 v[24:27], v[152:155], v[92:95], v[24:27]
v_mfma_f32_16x16x32_bf16 v[28:31], v[156:159], v[92:95], v[28:31]
v_mfma_f32_16x16x32_bf16 v[32:35], v[160:163], v[92:95], v[32:35]
v_mfma_f32_16x16x32_bf16 v[36:39], v[164:167], v[92:95], v[36:39]
buffer_load_dwordx4 v[92:95], v1, s[4:7], s31 offen offset:1024
v_mfma_f32_16x16x32_bf16 v[40:43], v[152:155], v[96:99], v[40:43]
v_mfma_f32_16x16x32_bf16 v[44:47], v[156:159], v[96:99], v[44:47]
v_mfma_f32_16x16x32_bf16 v[48:51], v[160:163], v[96:99], v[48:51]
v_mfma_f32_16x16x32_bf16 v[52:55], v[164:167], v[96:99], v[52:55]
buffer_load_dwordx4 v[96:99], v1, s[4:7], s32 offen offset:1024
s_waitcnt vmcnt(25) lgkmcnt(0)
v_mfma_f32_16x16x32_bf16 v[8:11], v[136:139], v[104:107], v[8:11]
ds_read_b128 v[152:155], v6 offset:3072
v_mfma_f32_16x16x32_bf16 v[12:15], v[140:143], v[104:107], v[12:15]
ds_read_b128 v[156:159], v6 offset:23552
v_mfma_f32_16x16x32_bf16 v[16:19], v[144:147], v[104:107], v[16:19]
ds_read_b128 v[160:163], v7 offset:3072
v_mfma_f32_16x16x32_bf16 v[20:23], v[148:151], v[104:107], v[20:23]
ds_read_b128 v[164:167], v7 offset:23552
buffer_load_dwordx4 v[104:107], v1, s[4:7], s30 offen offset:2048
v_mfma_f32_16x16x32_bf16 v[24:27], v[136:139], v[108:111], v[24:27]
v_mfma_f32_16x16x32_bf16 v[28:31], v[140:143], v[108:111], v[28:31]
v_mfma_f32_16x16x32_bf16 v[32:35], v[144:147], v[108:111], v[32:35]
v_mfma_f32_16x16x32_bf16 v[36:39], v[148:151], v[108:111], v[36:39]
buffer_load_dwordx4 v[108:111], v1, s[4:7], s31 offen offset:2048
v_mfma_f32_16x16x32_bf16 v[40:43], v[136:139], v[112:115], v[40:43]
v_mfma_f32_16x16x32_bf16 v[44:47], v[140:143], v[112:115], v[44:47]
v_mfma_f32_16x16x32_bf16 v[48:51], v[144:147], v[112:115], v[48:51]
v_mfma_f32_16x16x32_bf16 v[52:55], v[148:151], v[112:115], v[52:55]
buffer_load_dwordx4 v[112:115], v1, s[4:7], s32 offen offset:2048
s_waitcnt vmcnt(9) lgkmcnt(0)
s_barrier
v_mfma_f32_16x16x32_bf16 v[8:11], v[152:155], v[120:123], v[8:11]
ds_read_b128 v[136:139], v6 offset:4096
v_mfma_f32_16x16x32_bf16 v[12:15], v[156:159], v[120:123], v[12:15]
ds_read_b128 v[140:143], v6 offset:24576
v_mfma_f32_16x16x32_bf16 v[16:19], v[160:163], v[120:123], v[16:19]
ds_read_b128 v[144:147], v7 offset:4096
v_mfma_f32_16x16x32_bf16 v[20:23], v[164:167], v[120:123], v[20:23]
ds_read_b128 v[148:151], v7 offset:24576
buffer_load_dwordx4 v[120:123], v1, s[4:7], s30 offen offset:3072
v_mfma_f32_16x16x32_bf16 v[24:27], v[152:155], v[124:127], v[24:27]
v_mfma_f32_16x16x32_bf16 v[28:31], v[156:159], v[124:127], v[28:31]
v_mfma_f32_16x16x32_bf16 v[32:35], v[160:163], v[124:127], v[32:35]
v_mfma_f32_16x16x32_bf16 v[36:39], v[164:167], v[124:127], v[36:39]
buffer_load_dwordx4 v[124:127], v1, s[4:7], s31 offen offset:3072
v_mfma_f32_16x16x32_bf16 v[40:43], v[152:155], v[128:131], v[40:43]
v_mfma_f32_16x16x32_bf16 v[44:47], v[156:159], v[128:131], v[44:47]
v_mfma_f32_16x16x32_bf16 v[48:51], v[160:163], v[128:131], v[48:51]
v_mfma_f32_16x16x32_bf16 v[52:55], v[164:167], v[128:131], v[52:55]
buffer_load_dwordx4 v[128:131], v1, s[4:7], s32 offen offset:3072
s_mov_b32 s40, 0
v_add_u32 v6, 4096, v6
v_add_u32 v7, 4096, v7
qkvb_loop9:
s_waitcnt vmcnt(9) lgkmcnt(0)
v_mfma_f32_16x16x32_bf16 v[8:11], v[136:139], v[72:75], v[8:11]
ds_read_b128 v[152:155], v6 offset:1024
v_mfma_f32_16x16x32_bf16 v[12:15], v[140:143], v[72:75], v[12:15]
ds_read_b128 v[156:159], v6 offset:21504
v_mfma_f32_16x16x32_bf16 v[16:19], v[144:147], v[72:75], v[16:19]
ds_read_b128 v[160:163], v7 offset:1024
v_mfma_f32_16x16x32_bf16 v[20:23], v[148:151], v[72:75], v[20:23]
ds_read_b128 v[164:167], v7 offset:21504
s_add_u32 s30, s30, 4096
buffer_load_dwordx4 v[72:75], v1, s[4:7], s30 offen offset:0
v_mfma_f32_16x16x32_bf16 v[24:27], v[136:139], v[76:79], v[24:27]
v_mfma_f32_16x16x32_bf16 v[28:31], v[140:143], v[76:79], v[28:31]
v_mfma_f32_16x16x32_bf16 v[32:35], v[144:147], v[76:79], v[32:35]
v_mfma_f32_16x16x32_bf16 v[36:39], v[148:151], v[76:79], v[36:39]
s_add_u32 s31, s31, 4096
buffer_load_dwordx4 v[76:79], v1, s[4:7], s31 offen offset:0
v_mfma_f32_16x16x32_bf16 v[40:43], v[136:139], v[80:83], v[40:43]
v_mfma_f32_16x16x32_bf16 v[44:47], v[140:143], v[80:83], v[44:47]
v_mfma_f32_16x16x32_bf16 v[48:51], v[144:147], v[80:83], v[48:51]
v_mfma_f32_16x16x32_bf16 v[52:55], v[148:151], v[80:83], v[52:55]
s_add_u32 s32, s32, 4096
buffer_load_dwordx4 v[80:83], v1, s[4:7], s32 offen offset:0
s_waitcnt vmcnt(9) lgkmcnt(0)
v_mfma_f32_16x16x32_bf16 v[8:11], v[152:155], v[88:91], v[8:11]
ds_read_b128 v[136:139], v6 offset:2048
v_mfma_f32_16x16x32_bf16 v[12:15], v[156:159], v[88:91], v[12:15]
ds_read_b128 v[140:143], v6 offset:22528
v_mfma_f32_16x16x32_bf16 v[16:19], v[160:163], v[88:91], v[16:19]
ds_read_b128 v[144:147], v7 offset:2048
v_mfma_f32_16x16x32_bf16 v[20:23], v[164:167], v[88:91], v[20:23]
ds_read_b128 v[148:151], v7 offset:22528
buffer_load_dwordx4 v[88:91], v1, s[4:7], s30 offen offset:1024
v_mfma_f32_16x16x32_bf16 v[24:27], v[152:155], v[92:95], v[24:27]
v_mfma_f32_16x16x32_bf16 v[28:31], v[156:159], v[92:95], v[28:31]
v_mfma_f32_16x16x32_bf16 v[32:35], v[160:163], v[92:95], v[32:35]
v_mfma_f32_16x16x32_bf16 v[36:39], v[164:167], v[92:95], v[36:39]
buffer_load_dwordx4 v[92:95], v1, s[4:7], s31 offen offset:1024
v_mfma_f32_16x16x32_bf16 v[40:43], v[152:155], v[96:99], v[40:43]
v_mfma_f32_16x16x32_bf16 v[44:47], v[156:159], v[96:99], v[44:47]
v_mfma_f32_16x16x32_bf16 v[48:51], v[160:163], v[96:99], v[48:51]
v_mfma_f32_16x16x32_bf16 v[52:55], v[164:167], v[96:99], v[52:55]
buffer_load_dwordx4 v[96:99], v1, s[4:7], s32 offen offset:1024
s_waitcnt vmcnt(9) lgkmcnt(0)
v_mfma_f32_16x16x32_bf16 v[8:11], v[136:139], v[104:107], v[8:11]
ds_read_b128 v[152:155], v6 offset:3072
v_mfma_f32_16x16x32_bf16 v[12:15], v[140:143], v[104:107], v[12:15]
ds_read_b128 v[156:159], v6 offset:23552
v_mfma_f32_16x16x32_bf16 v[16:19], v[144:147], v[104:107], v[16:19]
ds_read_b128 v[160:163], v7 offset:3072
v_mfma_f32_16x16x32_bf16 v[20:23], v[148:151], v[104:107], v[20:23]
ds_read_b128 v[164:167], v7 offset:23552
buffer_load_dwordx4 v[104:107], v1, s[4:7], s30 offen offset:2048
v_mfma_f32_16x16x32_bf16 v[24:27], v[136:139], v[108:111], v[24:27]
v_mfma_f32_16x16x32_bf16 v[28:31], v[140:143], v[108:111], v[28:31]
v_mfma_f32_16x16x32_bf16 v[32:35], v[144:147], v[108:111], v[32:35]
v_mfma_f32_16x16x32_bf16 v[36:39], v[148:151], v[108:111], v[36:39]
buffer_load_dwordx4 v[108:111], v1, s[4:7], s31 offen offset:2048
v_mfma_f32_16x16x32_bf16 v[40:43], v[136:139], v[112:115], v[40:43]
v_mfma_f32_16x16x32_bf16 v[44:47], v[140:143], v[112:115], v[44:47]
v_mfma_f32_16x16x32_bf16 v[48:51], v[144:147], v[112:115], v[48:51]
v_mfma_f32_16x16x32_bf16 v[52:55], v[148:151], v[112:115], v[52:55]
buffer_load_dwordx4 v[112:115], v1, s[4:7], s32 offen offset:2048
s_waitcnt vmcnt(9) lgkmcnt(0)
v_mfma_f32_16x16x32_bf16 v[8:11], v[152:155], v[120:123], v[8:11]
ds_read_b128 v[136:139], v6 offset:4096
v_mfma_f32_16x16x32_bf16 v[12:15], v[156:159], v[120:123], v[12:15]
ds_read_b128 v[140:143], v6 offset:24576
v_mfma_f32_16x16x32_bf16 v[16:19], v[160:163], v[120:123], v[16:19]
ds_read_b128 v[144:147], v7 offset:4096
v_mfma_f32_16x16x32_bf16 v[20:23], v[164:167], v[120:123], v[20:23]
ds_read_b128 v[148:151], v7 offset:24576
buffer_load_dwordx4 v[120:123], v1, s[4:7], s30 offen offset:3072
v_mfma_f32_16x16x32_bf16 v[24:27], v[152:155], v[124:127], v[24:27]
v_mfma_f32_16x16x32_bf16 v[28:31], v[156:159], v[124:127], v[28:31]
v_mfma_f32_16x16x32_bf16 v[32:35], v[160:163], v[124:127], v[32:35]
v_mfma_f32_16x16x32_bf16 v[36:39], v[164:167], v[124:127], v[36:39]
buffer_load_dwordx4 v[124:127], v1, s[4:7], s31 offen offset:3072
v_mfma_f32_16x16x32_bf16 v[40:43], v[152:155], v[128:131], v[40:43]
v_mfma_f32_16x16x32_bf16 v[44:47], v[156:159], v[128:131], v[44:47]
v_mfma_f32_16x16x32_bf16 v[48:51], v[160:163], v[128:131], v[48:51]
v_mfma_f32_16x16x32_bf16 v[52:55], v[164:167], v[128:131], v[52:55]
buffer_load_dwordx4 v[128:131], v1, s[4:7], s32 offen offset:3072
v_add_u32 v6, 4096, v6
v_add_u32 v7, 4096, v7
s_add_u32 s40, s40, 1
s_cmp_lt_u32 s40, 4
s_cbranch_scc1 qkvb_loop9
s_waitcnt vmcnt(0) lgkmcnt(0)
v_and_b32 v2, 63, v0
v_and_b32 v3, 15, v2
v_lshrrev_b32 v4, 4, v2
s_lshl_b32 s41, s17, 19
s_lshl_b32 s42, s18, 12
s_add_u32 s41, s41, s42
s_mov_b32 s46, 0x3ea52b5c
s_mov_b32 s47, 0x3ea52b5c
v_add_u32 v5, 32, v3
v_mul_u32_u24 v168, 205, v5
v_lshrrev_b32 v168, 12, v168
v_mul_u32_u24 v6, 20, v168
v_sub_u32 v5, v5, v6
v_lshlrev_b32 v168, 17, v168
v_lshl_add_u32 v168, v5, 4, v168
v_and_b32 v6, 1, v4
v_lshl_add_u32 v168, v6, 9, v168
v_lshrrev_b32 v6, 1, v4
v_lshl_add_u32 v168, v6, 3, v168
v_add_u32 v5, 48, v3
v_mul_u32_u24 v169, 205, v5
v_lshrrev_b32 v169, 12, v169
v_mul_u32_u24 v6, 20, v169
v_sub_u32 v5, v5, v6
v_lshlrev_b32 v169, 17, v169
v_lshl_add_u32 v169, v5, 4, v169
v_and_b32 v6, 1, v4
v_lshl_add_u32 v169, v6, 9, v169
v_lshrrev_b32 v6, 1, v4
v_lshl_add_u32 v169, v6, 3, v169
v_add_u32 v5, 64, v3
v_mul_u32_u24 v170, 205, v5
v_lshrrev_b32 v170, 12, v170
v_mul_u32_u24 v6, 20, v170
v_sub_u32 v5, v5, v6
v_lshlrev_b32 v170, 17, v170
v_lshl_add_u32 v170, v5, 4, v170
v_and_b32 v6, 1, v4
v_lshl_add_u32 v170, v6, 9, v170
v_lshrrev_b32 v6, 1, v4
v_lshl_add_u32 v170, v6, 3, v170
v_cvt_pk_bf16_f32 v136, v8, v9
v_cvt_pk_bf16_f32 v137, v10, v11
s_add_u32 s43, s41, 46137344
buffer_store_dwordx2 v[136:137], v168, s[4:7], s43 offen sc1
v_cvt_pk_bf16_f32 v138, v12, v13
v_cvt_pk_bf16_f32 v139, v14, v15
s_add_u32 s43, s41, 46138368
buffer_store_dwordx2 v[138:139], v168, s[4:7], s43 offen sc1
v_cvt_pk_bf16_f32 v140, v16, v17
v_cvt_pk_bf16_f32 v141, v18, v19
s_add_u32 s43, s41, 46139392
buffer_store_dwordx2 v[140:141], v168, s[4:7], s43 offen sc1
v_cvt_pk_bf16_f32 v142, v20, v21
v_cvt_pk_bf16_f32 v143, v22, v23
s_add_u32 s43, s41, 46140416
buffer_store_dwordx2 v[142:143], v168, s[4:7], s43 offen sc1
v_cvt_pk_bf16_f32 v144, v24, v25
v_cvt_pk_bf16_f32 v145, v26, v27
s_add_u32 s43, s41, 46137344
buffer_store_dwordx2 v[144:145], v169, s[4:7], s43 offen sc1
v_cvt_pk_bf16_f32 v146, v28, v29
v_cvt_pk_bf16_f32 v147, v30, v31
s_add_u32 s43, s41, 46138368
buffer_store_dwordx2 v[146:147], v169, s[4:7], s43 offen sc1
v_cvt_pk_bf16_f32 v148, v32, v33
v_cvt_pk_bf16_f32 v149, v34, v35
s_add_u32 s43, s41, 46139392
buffer_store_dwordx2 v[148:149], v169, s[4:7], s43 offen sc1
v_cvt_pk_bf16_f32 v150, v36, v37
v_cvt_pk_bf16_f32 v151, v38, v39
s_add_u32 s43, s41, 46140416
buffer_store_dwordx2 v[150:151], v169, s[4:7], s43 offen sc1
v_cvt_pk_bf16_f32 v136, v40, v41
v_cvt_pk_bf16_f32 v137, v42, v43
s_add_u32 s43, s41, 46137344
buffer_store_dwordx2 v[136:137], v170, s[4:7], s43 offen sc1
v_cvt_pk_bf16_f32 v138, v44, v45
v_cvt_pk_bf16_f32 v139, v46, v47
s_add_u32 s43, s41, 46138368
buffer_store_dwordx2 v[138:139], v170, s[4:7], s43 offen sc1
v_cvt_pk_bf16_f32 v140, v48, v49
v_cvt_pk_bf16_f32 v141, v50, v51
s_add_u32 s43, s41, 46139392
buffer_store_dwordx2 v[140:141], v170, s[4:7], s43 offen sc1
v_cvt_pk_bf16_f32 v142, v52, v53
v_cvt_pk_bf16_f32 v143, v54, v55
s_add_u32 s43, s41, 46140416
buffer_store_dwordx2 v[142:143], v170, s[4:7], s43 offen sc1
v_mov_b32 v72, 0
v_mov_b32 v73, 0
v_mov_b32 v74, 0
v_mov_b32 v75, 0
v_lshlrev_b32 v5, 17, v4
v_lshl_add_u32 v5, v3, 4, v5
v_add_u32 v6, 1032, v5
v_add_u32 v7, 1536, v5
s_add_u32 s43, s41, 37748736
buffer_store_dwordx2 v[72:73], v6, s[4:7], s43 offen sc1
buffer_store_dwordx4 v[72:75], v7, s[4:7], s43 offen sc1
s_add_u32 s43, s41, 37748992
buffer_store_dwordx2 v[72:73], v6, s[4:7], s43 offen sc1
buffer_store_dwordx4 v[72:75], v7, s[4:7], s43 offen sc1
s_add_u32 s43, s41, 37750784
buffer_store_dwordx2 v[72:73], v6, s[4:7], s43 offen sc1
buffer_store_dwordx4 v[72:75], v7, s[4:7], s43 offen sc1
s_add_u32 s43, s41, 37751040
buffer_store_dwordx2 v[72:73], v6, s[4:7], s43 offen sc1
buffer_store_dwordx4 v[72:75], v7, s[4:7], s43 offen sc1
s_add_u32 s43, s41, 41943040
buffer_store_dwordx2 v[72:73], v6, s[4:7], s43 offen sc1
buffer_store_dwordx4 v[72:75], v7, s[4:7], s43 offen sc1
s_add_u32 s43, s41, 41943296
buffer_store_dwordx2 v[72:73], v6, s[4:7], s43 offen sc1
buffer_store_dwordx4 v[72:75], v7, s[4:7], s43 offen sc1
s_add_u32 s43, s41, 41945088
buffer_store_dwordx2 v[72:73], v6, s[4:7], s43 offen sc1
buffer_store_dwordx4 v[72:75], v7, s[4:7], s43 offen sc1
s_add_u32 s43, s41, 41945344
buffer_store_dwordx2 v[72:73], v6, s[4:7], s43 offen sc1
buffer_store_dwordx4 v[72:75], v7, s[4:7], s43 offen sc1
v_and_b32 v6, 1, v4
v_lshlrev_b32 v6, 9, v6
v_add_u32 v5, 20, v3
v_lshl_add_u32 v6, v5, 4, v6
v_lshrrev_b32 v5, 1, v4
v_lshl_add_u32 v6, v5, 17, v6
v_mov_b32 v5, 0x80000000
v_cmp_gt_u32 vcc, 12, v3
s_nop 1
v_cndmask_b32 v6, v5, v6, vcc
v_cmp_eq_u32 vcc, 0, v3
v_mov_b32 v5, 0x3f803f80
s_nop 0
v_cndmask_b32 v76, 0, v5, vcc
v_mov_b32 v77, v76
v_mov_b32 v78, v76
v_mov_b32 v79, v76
s_add_u32 s43, s41, 46137344
buffer_store_dwordx4 v[76:79], v6, s[4:7], s43 offen sc1
s_add_u32 s43, s41, 46138368
buffer_store_dwordx4 v[76:79], v6, s[4:7], s43 offen sc1
s_add_u32 s43, s41, 46139392
buffer_store_dwordx4 v[76:79], v6, s[4:7], s43 offen sc1
s_add_u32 s43, s41, 46140416
buffer_store_dwordx4 v[76:79], v6, s[4:7], s43 offen sc1
s_add_u32 s43, s41, 46399488
buffer_store_dwordx4 v[76:79], v6, s[4:7], s43 offen sc1
s_add_u32 s43, s41, 46400512
buffer_store_dwordx4 v[76:79], v6, s[4:7], s43 offen sc1
s_add_u32 s43, s41, 46401536
buffer_store_dwordx4 v[76:79], v6, s[4:7], s43 offen sc1
s_add_u32 s43, s41, 46402560
buffer_store_dwordx4 v[76:79], v6, s[4:7], s43 offen sc1
s_branch qkvb_exit1
qkvb_exit1:
s_endpgm
.globl attnb_kernel
.p2align 8
.type attnb_kernel,@function
attnb_kernel:
s_cmp_ge_u32 s2, 256
s_cbranch_scc1 attnb_exit1
s_load_dwordx2 s[12:13], s[0:1], 96
v_lshrrev_b32 v2, 6, v0
v_and_b32 v3, 63, v0
s_nop 0
v_readfirstlane_b32 s16, v2
v_lshlrev_b32 v1, 4, v3
s_and_b32 s17, s2, 7
s_lshl_b32 s17, s17, 2
s_lshr_b32 s18, s2, 3
s_and_b32 s19, s18, 3
s_add_u32 s17, s17, s19
s_lshr_b32 s18, s18, 2
s_waitcnt lgkmcnt(0)
s_mov_b32 s4, s12
s_mov_b32 s5, s13
s_mov_b32 s6, 0x10000000
s_mov_b32 s7, 0x20000
s_lshl_b32 s20, s17, 17
s_add_u32 s21, s20, 41943040
s_add_u32 s22, s20, 46137344
s_lshl_b32 s23, s18, 3
s_lshl_b32 s24, s16, 1
s_add_u32 s23, s23, s24
s_lshl_b32 s24, s23, 11
s_add_u32 s24, s24, s20
s_add_u32 s24, s24, 37748736
buffer_load_dwordx4 v[8:11], v1, s[4:7], s24 offen offset:0
buffer_load_dwordx4 v[12:15], v1, s[4:7], s24 offen offset:1024
buffer_load_dwordx4 v[16:19], v1, s[4:7], s24 offen offset:2048
buffer_load_dwordx4 v[20:23], v1, s[4:7], s24 offen offset:3072
s_mov_b32 s25, s21
s_mov_b32 s26, s22
buffer_load_dwordx4 v[136:139], v1, s[4:7], s25 offen
buffer_load_dwordx4 v[140:143], v1, s[4:7], s25 offen offset:1024
buffer_load_dwordx4 v[144:147], v1, s[4:7], s26 offen
buffer_load_dwordx4 v[148:151], v1, s[4:7], s26 offen offset:1024
s_add_u32 s25, s25, 2048
s_add_u32 s26, s26, 2048
s_waitcnt vmcnt(0)
v_mfma_f32_32x32x16_bf16 v[88:103], v[136:139], v[8:11], 0
v_mfma_f32_32x32x16_bf16 v[88:103], v[140:143], v[12:15], v[88:103]
v_mfma_f32_32x32x16_bf16 v[104:119], v[136:139], v[16:19], 0
v_mfma_f32_32x32x16_bf16 v[104:119], v[140:143], v[20:23], v[104:119]
s_nop 9
v_max3_f32 v2, v88, v89, v90
v_max3_f32 v2, v2, v91, v92
v_max3_f32 v2, v2, v93, v94
v_max3_f32 v2, v2, v95, v96
v_max3_f32 v2, v2, v97, v98
v_max3_f32 v2, v2, v99, v100
v_max3_f32 v2, v2, v101, v102
v_max_f32 v2, v2, v103
v_mov_b32 v4, v2
s_nop 1
v_permlane32_swap_b32 v2, v4
v_max_f32 v2, v2, v4
v_sub_f32 v24, 0, v2
v_sub_f32 v25, 0, v2
v_sub_f32 v26, 0, v2
v_sub_f32 v27, 0, v2
v_sub_f32 v28, 0, v2
v_sub_f32 v29, 0, v2
v_sub_f32 v30, 0, v2
v_sub_f32 v31, 0, v2
v_sub_f32 v32, 0, v2
v_sub_f32 v33, 0, v2
v_sub_f32 v34, 0, v2
v_sub_f32 v35, 0, v2
v_sub_f32 v36, 0, v2
v_sub_f32 v37, 0, v2
v_sub_f32 v38, 0, v2
v_sub_f32 v39, 0, v2
v_max3_f32 v3, v104, v105, v106
v_max3_f32 v3, v3, v107, v108
v_max3_f32 v3, v3, v109, v110
v_max3_f32 v3, v3, v111, v112
v_max3_f32 v3, v3, v113, v114
v_max3_f32 v3, v3, v115, v116
v_max3_f32 v3, v3, v117, v118
v_max_f32 v3, v3, v119
v_mov_b32 v4, v3
s_nop 1
v_permlane32_swap_b32 v3, v4
v_max_f32 v3, v3, v4
v_sub_f32 v40, 0, v3
v_sub_f32 v41, 0, v3
v_sub_f32 v42, 0, v3
v_sub_f32 v43, 0, v3
v_sub_f32 v44, 0, v3
v_sub_f32 v45, 0, v3
v_sub_f32 v46, 0, v3
v_sub_f32 v47, 0, v3
v_sub_f32 v48, 0, v3
v_sub_f32 v49, 0, v3
v_sub_f32 v50, 0, v3
v_sub_f32 v51, 0, v3
v_sub_f32 v52, 0, v3
v_sub_f32 v53, 0, v3
v_sub_f32 v54, 0, v3
v_sub_f32 v55, 0, v3
s_mov_b32 s28, 0
attnb_main2:
s_mov_b32 s25, s21
s_mov_b32 s26, s22
buffer_load_dwordx4 v[136:139], v1, s[4:7], s25 offen
buffer_load_dwordx4 v[140:143], v1, s[4:7], s25 offen offset:1024
buffer_load_dwordx4 v[144:147], v1, s[4:7], s26 offen
buffer_load_dwordx4 v[148:151], v1, s[4:7], s26 offen offset:1024
s_add_u32 s25, s25, 2048
s_add_u32 s26, s26, 2048
buffer_load_dwordx4 v[152:155], v1, s[4:7], s25 offen
buffer_load_dwordx4 v[156:159], v1, s[4:7], s25 offen offset:1024
buffer_load_dwordx4 v[160:163], v1, s[4:7], s26 offen
buffer_load_dwordx4 v[164:167], v1, s[4:7], s26 offen offset:1024
s_add_u32 s25, s25, 2048
s_add_u32 s26, s26, 2048
v_mov_b32 v56, 0
v_mov_b32 v57, 0
v_mov_b32 v58, 0
v_mov_b32 v59, 0
v_mov_b32 v60, 0
v_mov_b32 v61, 0
v_mov_b32 v62, 0
v_mov_b32 v63, 0
v_mov_b32 v64, 0
v_mov_b32 v65, 0
v_mov_b32 v66, 0
v_mov_b32 v67, 0
v_mov_b32 v68, 0
v_mov_b32 v69, 0
v_mov_b32 v70, 0
v_mov_b32 v71, 0
v_mov_b32 v72, 0
v_mov_b32 v73, 0
v_mov_b32 v74, 0
v_mov_b32 v75, 0
v_mov_b32 v76, 0
v_mov_b32 v77, 0
v_mov_b32 v78, 0
v_mov_b32 v79, 0
v_mov_b32 v80, 0
v_mov_b32 v81, 0
v_mov_b32 v82, 0
v_mov_b32 v83, 0
v_mov_b32 v84, 0
v_mov_b32 v85, 0
v_mov_b32 v86, 0
v_mov_b32 v87, 0
s_waitcnt vmcnt(4)
v_mfma_f32_32x32x16_bf16 v[88:103], v[136:139], v[8:11], v[24:39]
v_mfma_f32_32x32x8_bf16 v[88:103], v[140:141], v[12:13], v[88:103]
s_waitcnt vmcnt(4)
s_nop 10
v_exp_f32 v88, v88
v_exp_f32 v89, v89
v_exp_f32 v90, v90
v_exp_f32 v91, v91
v_exp_f32 v92, v92
v_exp_f32 v93, v93
buffer_load_dwordx4 v[168:171], v1, s[4:7], s25 offen
v_exp_f32 v94, v94
v_exp_f32 v95, v95
v_mfma_f32_32x32x16_bf16 v[104:119], v[136:139], v[16:19], v[40:55]
v_cvt_pk_bf16_f32 v120, v88, v89
v_cvt_pk_bf16_f32 v121, v90, v91
v_cvt_pk_bf16_f32 v122, v92, v93
v_cvt_pk_bf16_f32 v123, v94, v95
v_exp_f32 v96, v96
v_exp_f32 v97, v97
v_mfma_f32_32x32x8_bf16 v[104:119], v[140:141], v[20:21], v[104:119]
v_exp_f32 v98, v98
v_exp_f32 v99, v99
buffer_load_dwordx2 v[172:173], v1, s[4:7], s25 offen offset:1024
s_add_u32 s25, s25, 2048
v_exp_f32 v100, v100
v_exp_f32 v101, v101
v_mfma_f32_32x32x16_bf16 v[56:71], v[144:147], v[120:123], v[56:71]
v_exp_f32 v102, v102
v_exp_f32 v103, v103
v_cvt_pk_bf16_f32 v124, v96, v97
v_cvt_pk_bf16_f32 v125, v98, v99
v_cvt_pk_bf16_f32 v126, v100, v101
v_cvt_pk_bf16_f32 v127, v102, v103
s_waitcnt vmcnt(4)
v_exp_f32 v104, v104
v_exp_f32 v105, v105
v_exp_f32 v106, v106
v_exp_f32 v107, v107
v_mfma_f32_32x32x16_bf16 v[56:71], v[148:151], v[124:127], v[56:71]
v_exp_f32 v108, v108
v_exp_f32 v109, v109
buffer_load_dwordx4 v[176:179], v1, s[4:7], s26 offen
v_exp_f32 v110, v110
v_exp_f32 v111, v111
v_mfma_f32_32x32x16_bf16 v[88:103], v[152:155], v[8:11], v[24:39]
v_cvt_pk_bf16_f32 v128, v104, v105
v_cvt_pk_bf16_f32 v129, v106, v107
v_cvt_pk_bf16_f32 v130, v108, v109
v_cvt_pk_bf16_f32 v131, v110, v111
v_exp_f32 v112, v112
v_exp_f32 v113, v113
v_mfma_f32_32x32x8_bf16 v[88:103], v[156:157], v[12:13], v[88:103]
v_exp_f32 v114, v114
v_exp_f32 v115, v115
buffer_load_dwordx4 v[180:183], v1, s[4:7], s26 offen offset:1024
s_add_u32 s26, s26, 2048
v_exp_f32 v116, v116
v_exp_f32 v117, v117
v_mfma_f32_32x32x16_bf16 v[72:87], v[144:147], v[128:131], v[72:87]
v_exp_f32 v118, v118
v_exp_f32 v119, v119
v_cvt_pk_bf16_f32 v132, v112, v113
v_cvt_pk_bf16_f32 v133, v114, v115
v_cvt_pk_bf16_f32 v134, v116, v117
v_cvt_pk_bf16_f32 v135, v118, v119
s_mov_b32 s27, 0
attnb_loop3:
s_waitcnt vmcnt(4)
v_exp_f32 v88, v88
v_exp_f32 v89, v89
v_exp_f32 v90, v90
v_exp_f32 v91, v91
v_mfma_f32_32x32x16_bf16 v[72:87], v[148:151], v[132:135], v[72:87]
v_exp_f32 v92, v92
v_exp_f32 v93, v93
buffer_load_dwordx4 v[136:139], v1, s[4:7], s25 offen
v_exp_f32 v94, v94
v_exp_f32 v95, v95
v_mfma_f32_32x32x16_bf16 v[104:119], v[152:155], v[16:19], v[40:55]
v_cvt_pk_bf16_f32 v120, v88, v89
v_cvt_pk_bf16_f32 v121, v90, v91
v_cvt_pk_bf16_f32 v122, v92, v93
v_cvt_pk_bf16_f32 v123, v94, v95
v_exp_f32 v96, v96
v_exp_f32 v97, v97
v_mfma_f32_32x32x8_bf16 v[104:119], v[156:157], v[20:21], v[104:119]
v_exp_f32 v98, v98
v_exp_f32 v99, v99
buffer_load_dwordx2 v[140:141], v1, s[4:7], s25 offen offset:1024
s_add_u32 s25, s25, 2048
v_exp_f32 v100, v100
v_exp_f32 v101, v101
v_mfma_f32_32x32x16_bf16 v[56:71], v[160:163], v[120:123], v[56:71]
v_exp_f32 v102, v102
v_exp_f32 v103, v103
v_cvt_pk_bf16_f32 v124, v96, v97
v_cvt_pk_bf16_f32 v125, v98, v99
v_cvt_pk_bf16_f32 v126, v100, v101
v_cvt_pk_bf16_f32 v127, v102, v103
s_waitcnt vmcnt(4)
v_exp_f32 v104, v104
v_exp_f32 v105, v105
v_exp_f32 v106, v106
v_exp_f32 v107, v107
v_mfma_f32_32x32x16_bf16 v[56:71], v[164:167], v[124:127], v[56:71]
v_exp_f32 v108, v108
v_exp_f32 v109, v109
buffer_load_dwordx4 v[144:147], v1, s[4:7], s26 offen
v_exp_f32 v110, v110
v_exp_f32 v111, v111
v_mfma_f32_32x32x16_bf16 v[88:103], v[168:171], v[8:11], v[24:39]
v_cvt_pk_bf16_f32 v128, v104, v105
v_cvt_pk_bf16_f32 v129, v106, v107
v_cvt_pk_bf16_f32 v130, v108, v109
v_cvt_pk_bf16_f32 v131, v110, v111
v_exp_f32 v112, v112
v_exp_f32 v113, v113
v_mfma_f32_32x32x8_bf16 v[88:103], v[172:173], v[12:13], v[88:103]
v_exp_f32 v114, v114
v_exp_f32 v115, v115
buffer_load_dwordx4 v[148:151], v1, s[4:7], s26 offen offset:1024
s_add_u32 s26, s26, 2048
v_exp_f32 v116, v116
v_exp_f32 v117, v117
v_mfma_f32_32x32x16_bf16 v[72:87], v[160:163], v[128:131], v[72:87]
v_exp_f32 v118, v118
v_exp_f32 v119, v119
v_cvt_pk_bf16_f32 v132, v112, v113
v_cvt_pk_bf16_f32 v133, v114, v115
v_cvt_pk_bf16_f32 v134, v116, v117
v_cvt_pk_bf16_f32 v135, v118, v119
s_waitcnt vmcnt(4)
v_exp_f32 v88, v88
v_exp_f32 v89, v89
v_exp_f32 v90, v90
v_exp_f32 v91, v91
v_mfma_f32_32x32x16_bf16 v[72:87], v[164:167], v[132:135], v[72:87]
v_exp_f32 v92, v92
v_exp_f32 v93, v93
buffer_load_dwordx4 v[152:155], v1, s[4:7], s25 offen
v_exp_f32 v94, v94
v_exp_f32 v95, v95
v_mfma_f32_32x32x16_bf16 v[104:119], v[168:171], v[16:19], v[40:55]
v_cvt_pk_bf16_f32 v120, v88, v89
v_cvt_pk_bf16_f32 v121, v90, v91
v_cvt_pk_bf16_f32 v122, v92, v93
v_cvt_pk_bf16_f32 v123, v94, v95
v_exp_f32 v96, v96
v_exp_f32 v97, v97
v_mfma_f32_32x32x8_bf16 v[104:119], v[172:173], v[20:21], v[104:119]
v_exp_f32 v98, v98
v_exp_f32 v99, v99
buffer_load_dwordx2 v[156:157], v1, s[4:7], s25 offen offset:1024
s_add_u32 s25, s25, 2048
v_exp_f32 v100, v100
v_exp_f32 v101, v101
v_mfma_f32_32x32x16_bf16 v[56:71], v[176:179], v[120:123], v[56:71]
v_exp_f32 v102, v102
v_exp_f32 v103, v103
v_cvt_pk_bf16_f32 v124, v96, v97
v_cvt_pk_bf16_f32 v125, v98, v99
v_cvt_pk_bf16_f32 v126, v100, v101
v_cvt_pk_bf16_f32 v127, v102, v103
s_waitcnt vmcnt(4)
v_exp_f32 v104, v104
v_exp_f32 v105, v105
v_exp_f32 v106, v106
v_exp_f32 v107, v107
v_mfma_f32_32x32x16_bf16 v[56:71], v[180:183], v[124:127], v[56:71]
v_exp_f32 v108, v108
v_exp_f32 v109, v109
buffer_load_dwordx4 v[160:163], v1, s[4:7], s26 offen
v_exp_f32 v110, v110
v_exp_f32 v111, v111
v_mfma_f32_32x32x16_bf16 v[88:103], v[136:139], v[8:11], v[24:39]
v_cvt_pk_bf16_f32 v128, v104, v105
v_cvt_pk_bf16_f32 v129, v106, v107
v_cvt_pk_bf16_f32 v130, v108, v109
v_cvt_pk_bf16_f32 v131, v110, v111
v_exp_f32 v112, v112
v_exp_f32 v113, v113
v_mfma_f32_32x32x8_bf16 v[88:103], v[140:141], v[12:13], v[88:103]
v_exp_f32 v114, v114
v_exp_f32 v115, v115
buffer_load_dwordx4 v[164:167], v1, s[4:7], s26 offen offset:1024
s_add_u32 s26, s26, 2048
v_exp_f32 v116, v116
v_exp_f32 v117, v117
v_mfma_f32_32x32x16_bf16 v[72:87], v[176:179], v[128:131], v[72:87]
v_exp_f32 v118, v118
v_exp_f32 v119, v119
v_cvt_pk_bf16_f32 v132, v112, v113
v_cvt_pk_bf16_f32 v133, v114, v115
v_cvt_pk_bf16_f32 v134, v116, v117
v_cvt_pk_bf16_f32 v135, v118, v119
s_waitcnt vmcnt(4)
v_exp_f32 v88, v88
v_exp_f32 v89, v89
v_exp_f32 v90, v90
v_exp_f32 v91, v91
v_mfma_f32_32x32x16_bf16 v[72:87], v[180:183], v[132:135], v[72:87]
v_exp_f32 v92, v92
v_exp_f32 v93, v93
buffer_load_dwordx4 v[168:171], v1, s[4:7], s25 offen
v_exp_f32 v94, v94
v_exp_f32 v95, v95
v_mfma_f32_32x32x16_bf16 v[104:119], v[136:139], v[16:19], v[40:55]
v_cvt_pk_bf16_f32 v120, v88, v89
v_cvt_pk_bf16_f32 v121, v90, v91
v_cvt_pk_bf16_f32 v122, v92, v93
v_cvt_pk_bf16_f32 v123, v94, v95
v_exp_f32 v96, v96
v_exp_f32 v97, v97
v_mfma_f32_32x32x8_bf16 v[104:119], v[140:141], v[20:21], v[104:119]
v_exp_f32 v98, v98
v_exp_f32 v99, v99
buffer_load_dwordx2 v[172:173], v1, s[4:7], s25 offen offset:1024
s_add_u32 s25, s25, 2048
v_exp_f32 v100, v100
v_exp_f32 v101, v101
v_mfma_f32_32x32x16_bf16 v[56:71], v[144:147], v[120:123], v[56:71]
v_exp_f32 v102, v102
v_exp_f32 v103, v103
v_cvt_pk_bf16_f32 v124, v96, v97
v_cvt_pk_bf16_f32 v125, v98, v99
v_cvt_pk_bf16_f32 v126, v100, v101
v_cvt_pk_bf16_f32 v127, v102, v103
s_waitcnt vmcnt(4)
v_exp_f32 v104, v104
v_exp_f32 v105, v105
v_exp_f32 v106, v106
v_exp_f32 v107, v107
v_mfma_f32_32x32x16_bf16 v[56:71], v[148:151], v[124:127], v[56:71]
v_exp_f32 v108, v108
v_exp_f32 v109, v109
buffer_load_dwordx4 v[176:179], v1, s[4:7], s26 offen
v_exp_f32 v110, v110
v_exp_f32 v111, v111
v_mfma_f32_32x32x16_bf16 v[88:103], v[152:155], v[8:11], v[24:39]
v_cvt_pk_bf16_f32 v128, v104, v105
v_cvt_pk_bf16_f32 v129, v106, v107
v_cvt_pk_bf16_f32 v130, v108, v109
v_cvt_pk_bf16_f32 v131, v110, v111
v_exp_f32 v112, v112
v_exp_f32 v113, v113
v_mfma_f32_32x32x8_bf16 v[88:103], v[156:157], v[12:13], v[88:103]
v_exp_f32 v114, v114
v_exp_f32 v115, v115
buffer_load_dwordx4 v[180:183], v1, s[4:7], s26 offen offset:1024
s_add_u32 s26, s26, 2048
v_exp_f32 v116, v116
v_exp_f32 v117, v117
v_mfma_f32_32x32x16_bf16 v[72:87], v[144:147], v[128:131], v[72:87]
v_exp_f32 v118, v118
v_exp_f32 v119, v119
v_cvt_pk_bf16_f32 v132, v112, v113
v_cvt_pk_bf16_f32 v133, v114, v115
v_cvt_pk_bf16_f32 v134, v116, v117
v_cvt_pk_bf16_f32 v135, v118, v119
s_add_u32 s27, s27, 1
s_cmp_lt_u32 s27, 20
s_cbranch_scc1 attnb_loop3
s_waitcnt vmcnt(4)
v_exp_f32 v88, v88
v_exp_f32 v89, v89
v_exp_f32 v90, v90
v_exp_f32 v91, v91
v_mfma_f32_32x32x16_bf16 v[72:87], v[148:151], v[132:135], v[72:87]
v_exp_f32 v92, v92
v_exp_f32 v93, v93
buffer_load_dwordx4 v[136:139], v1, s[4:7], s25 offen
v_exp_f32 v94, v94
v_exp_f32 v95, v95
v_mfma_f32_32x32x16_bf16 v[104:119], v[152:155], v[16:19], v[40:55]
v_cvt_pk_bf16_f32 v120, v88, v89
v_cvt_pk_bf16_f32 v121, v90, v91
v_cvt_pk_bf16_f32 v122, v92, v93
v_cvt_pk_bf16_f32 v123, v94, v95
v_exp_f32 v96, v96
v_exp_f32 v97, v97
v_mfma_f32_32x32x8_bf16 v[104:119], v[156:157], v[20:21], v[104:119]
v_exp_f32 v98, v98
v_exp_f32 v99, v99
buffer_load_dwordx2 v[140:141], v1, s[4:7], s25 offen offset:1024
s_add_u32 s25, s25, 2048
v_exp_f32 v100, v100
v_exp_f32 v101, v101
v_mfma_f32_32x32x16_bf16 v[56:71], v[160:163], v[120:123], v[56:71]
v_exp_f32 v102, v102
v_exp_f32 v103, v103
v_cvt_pk_bf16_f32 v124, v96, v97
v_cvt_pk_bf16_f32 v125, v98, v99
v_cvt_pk_bf16_f32 v126, v100, v101
v_cvt_pk_bf16_f32 v127, v102, v103
s_waitcnt vmcnt(4)
v_exp_f32 v104, v104
v_exp_f32 v105, v105
v_exp_f32 v106, v106
v_exp_f32 v107, v107
v_mfma_f32_32x32x16_bf16 v[56:71], v[164:167], v[124:127], v[56:71]
v_exp_f32 v108, v108
v_exp_f32 v109, v109
buffer_load_dwordx4 v[144:147], v1, s[4:7], s26 offen
v_exp_f32 v110, v110
v_exp_f32 v111, v111
v_mfma_f32_32x32x16_bf16 v[88:103], v[168:171], v[8:11], v[24:39]
v_cvt_pk_bf16_f32 v128, v104, v105
v_cvt_pk_bf16_f32 v129, v106, v107
v_cvt_pk_bf16_f32 v130, v108, v109
v_cvt_pk_bf16_f32 v131, v110, v111
v_exp_f32 v112, v112
v_exp_f32 v113, v113
v_mfma_f32_32x32x8_bf16 v[88:103], v[172:173], v[12:13], v[88:103]
v_exp_f32 v114, v114
v_exp_f32 v115, v115
buffer_load_dwordx4 v[148:151], v1, s[4:7], s26 offen offset:1024
s_add_u32 s26, s26, 2048
v_exp_f32 v116, v116
v_exp_f32 v117, v117
v_mfma_f32_32x32x16_bf16 v[72:87], v[160:163], v[128:131], v[72:87]
v_exp_f32 v118, v118
v_exp_f32 v119, v119
v_cvt_pk_bf16_f32 v132, v112, v113
v_cvt_pk_bf16_f32 v133, v114, v115
v_cvt_pk_bf16_f32 v134, v116, v117
v_cvt_pk_bf16_f32 v135, v118, v119
s_waitcnt vmcnt(4)
v_exp_f32 v88, v88
v_exp_f32 v89, v89
v_exp_f32 v90, v90
v_exp_f32 v91, v91
v_mfma_f32_32x32x16_bf16 v[72:87], v[164:167], v[132:135], v[72:87]
v_exp_f32 v92, v92
v_exp_f32 v93, v93
v_exp_f32 v94, v94
v_exp_f32 v95, v95
v_mfma_f32_32x32x16_bf16 v[104:119], v[168:171], v[16:19], v[40:55]
v_cvt_pk_bf16_f32 v120, v88, v89
v_cvt_pk_bf16_f32 v121, v90, v91
v_cvt_pk_bf16_f32 v122, v92, v93
v_cvt_pk_bf16_f32 v123, v94, v95
v_exp_f32 v96, v96
v_exp_f32 v97, v97
v_mfma_f32_32x32x8_bf16 v[104:119], v[172:173], v[20:21], v[104:119]
v_exp_f32 v98, v98
v_exp_f32 v99, v99
v_exp_f32 v100, v100
v_exp_f32 v101, v101
v_mfma_f32_32x32x16_bf16 v[56:71], v[176:179], v[120:123], v[56:71]
v_exp_f32 v102, v102
v_exp_f32 v103, v103
v_cvt_pk_bf16_f32 v124, v96, v97
v_cvt_pk_bf16_f32 v125, v98, v99
v_cvt_pk_bf16_f32 v126, v100, v101
v_cvt_pk_bf16_f32 v127, v102, v103
s_waitcnt vmcnt(2)
v_exp_f32 v104, v104
v_exp_f32 v105, v105
v_exp_f32 v106, v106
v_exp_f32 v107, v107
v_mfma_f32_32x32x16_bf16 v[56:71], v[180:183], v[124:127], v[56:71]
v_exp_f32 v108, v108
v_exp_f32 v109, v109
v_exp_f32 v110, v110
v_exp_f32 v111, v111
v_mfma_f32_32x32x16_bf16 v[88:103], v[136:139], v[8:11], v[24:39]
v_cvt_pk_bf16_f32 v128, v104, v105
v_cvt_pk_bf16_f32 v129, v106, v107
v_cvt_pk_bf16_f32 v130, v108, v109
v_cvt_pk_bf16_f32 v131, v110, v111
v_exp_f32 v112, v112
v_exp_f32 v113, v113
v_mfma_f32_32x32x8_bf16 v[88:103], v[140:141], v[12:13], v[88:103]
v_exp_f32 v114, v114
v_exp_f32 v115, v115
v_exp_f32 v116, v116
v_exp_f32 v117, v117
v_mfma_f32_32x32x16_bf16 v[72:87], v[176:179], v[128:131], v[72:87]
v_exp_f32 v118, v118
v_exp_f32 v119, v119
v_cvt_pk_bf16_f32 v132, v112, v113
v_cvt_pk_bf16_f32 v133, v114, v115
v_cvt_pk_bf16_f32 v134, v116, v117
v_cvt_pk_bf16_f32 v135, v118, v119
s_waitcnt vmcnt(0)
v_exp_f32 v88, v88
v_exp_f32 v89, v89
v_exp_f32 v90, v90
v_exp_f32 v91, v91
v_mfma_f32_32x32x16_bf16 v[72:87], v[180:183], v[132:135], v[72:87]
v_exp_f32 v92, v92
v_exp_f32 v93, v93
v_exp_f32 v94, v94
v_exp_f32 v95, v95
v_mfma_f32_32x32x16_bf16 v[104:119], v[136:139], v[16:19], v[40:55]
v_cvt_pk_bf16_f32 v120, v88, v89
v_cvt_pk_bf16_f32 v121, v90, v91
v_cvt_pk_bf16_f32 v122, v92, v93
v_cvt_pk_bf16_f32 v123, v94, v95
v_exp_f32 v96, v96
v_exp_f32 v97, v97
v_mfma_f32_32x32x8_bf16 v[104:119], v[140:141], v[20:21], v[104:119]
v_exp_f32 v98, v98
v_exp_f32 v99, v99
v_exp_f32 v100, v100
v_exp_f32 v101, v101
v_mfma_f32_32x32x16_bf16 v[56:71], v[144:147], v[120:123], v[56:71]
v_exp_f32 v102, v102
v_exp_f32 v103, v103
v_cvt_pk_bf16_f32 v124, v96, v97
v_cvt_pk_bf16_f32 v125, v98, v99
v_cvt_pk_bf16_f32 v126, v100, v101
v_cvt_pk_bf16_f32 v127, v102, v103
s_nop 0
v_exp_f32 v104, v104
v_exp_f32 v105, v105
v_exp_f32 v106, v106
v_exp_f32 v107, v107
v_mfma_f32_32x32x16_bf16 v[56:71], v[148:151], v[124:127], v[56:71]
v_exp_f32 v108, v108
v_exp_f32 v109, v109
v_exp_f32 v110, v110
v_exp_f32 v111, v111
v_cvt_pk_bf16_f32 v128, v104, v105
v_cvt_pk_bf16_f32 v129, v106, v107
v_cvt_pk_bf16_f32 v130, v108, v109
v_cvt_pk_bf16_f32 v131, v110, v111
v_exp_f32 v112, v112
v_exp_f32 v113, v113
v_exp_f32 v114, v114
v_exp_f32 v115, v115
v_exp_f32 v116, v116
v_exp_f32 v117, v117
v_mfma_f32_32x32x16_bf16 v[72:87], v[144:147], v[128:131], v[72:87]
v_exp_f32 v118, v118
v_exp_f32 v119, v119
v_cvt_pk_bf16_f32 v132, v112, v113
v_cvt_pk_bf16_f32 v133, v114, v115
v_cvt_pk_bf16_f32 v134, v116, v117
v_cvt_pk_bf16_f32 v135, v118, v119
s_nop 1
v_mfma_f32_32x32x16_bf16 v[72:87], v[148:151], v[132:135], v[72:87]
v_mov_b32 v2, v64
v_mov_b32 v4, v2
s_nop 1
v_permlane32_swap_b32 v4, v2
s_nop 6
v_mov_b32 v3, v80
v_mov_b32 v4, v3
s_nop 1
v_permlane32_swap_b32 v4, v3
s_cmp_eq_u32 s28, 1
s_cbranch_scc1 attnb_done5
v_max_f32 v4, v2, v3
v_cmp_nge_f32 vcc, 0x4e800000, v4
v_cmp_u_f32 s[30:31], v2, v3
s_nop 3
s_or_b64 s[32:33], vcc, s[30:31]
s_movk_i32 s34, 0x207
v_cmp_class_f32 vcc, v56, s34
s_nop 3
s_or_b64 s[32:33], s[32:33], vcc
v_cmp_class_f32 vcc, v57, s34
s_nop 3
s_or_b64 s[32:33], s[32:33], vcc
v_cmp_class_f32 vcc, v58, s34
s_nop 3
s_or_b64 s[32:33], s[32:33], vcc
v_cmp_class_f32 vcc, v59, s34
s_nop 3
s_or_b64 s[32:33], s[32:33], vcc
v_cmp_class_f32 vcc, v60, s34
s_nop 3
s_or_b64 s[32:33], s[32:33], vcc
v_cmp_class_f32 vcc, v61, s34
s_nop 3
s_or_b64 s[32:33], s[32:33], vcc
v_cmp_class_f32 vcc, v62, s34
s_nop 3
s_or_b64 s[32:33], s[32:33], vcc
v_cmp_class_f32 vcc, v63, s34
s_nop 3
s_or_b64 s[32:33], s[32:33], vcc
v_cmp_class_f32 vcc, v64, s34
s_nop 3
s_or_b64 s[32:33], s[32:33], vcc
v_cmp_class_f32 vcc, v65, s34
s_nop 3
s_or_b64 s[32:33], s[32:33], vcc
v_cmp_class_f32 vcc, v66, s34
s_nop 3
s_or_b64 s[32:33], s[32:33], vcc
v_cmp_class_f32 vcc, v67, s34
s_nop 3
s_or_b64 s[32:33], s[32:33], vcc
v_cmp_class_f32 vcc, v68, s34
s_nop 3
s_or_b64 s[32:33], s[32:33], vcc
v_cmp_class_f32 vcc, v69, s34
s_nop 3
s_or_b64 s[32:33], s[32:33], vcc
v_cmp_class_f32 vcc, v70, s34
s_nop 3
s_or_b64 s[32:33], s[32:33], vcc
v_cmp_class_f32 vcc, v71, s34
s_nop 3
s_or_b64 s[32:33], s[32:33], vcc
v_cmp_class_f32 vcc, v72, s34
s_nop 3
s_or_b64 s[32:33], s[32:33], vcc
v_cmp_class_f32 vcc, v73, s34
s_nop 3
s_or_b64 s[32:33], s[32:33], vcc
v_cmp_class_f32 vcc, v74, s34
s_nop 3
s_or_b64 s[32:33], s[32:33], vcc
v_cmp_class_f32 vcc, v75, s34
s_nop 3
s_or_b64 s[32:33], s[32:33], vcc
v_cmp_class_f32 vcc, v76, s34
s_nop 3
s_or_b64 s[32:33], s[32:33], vcc
v_cmp_class_f32 vcc, v77, s34
s_nop 3
s_or_b64 s[32:33], s[32:33], vcc
v_cmp_class_f32 vcc, v78, s34
s_nop 3
s_or_b64 s[32:33], s[32:33], vcc
v_cmp_class_f32 vcc, v79, s34
s_nop 3
s_or_b64 s[32:33], s[32:33], vcc
v_cmp_class_f32 vcc, v80, s34
s_nop 3
s_or_b64 s[32:33], s[32:33], vcc
v_cmp_class_f32 vcc, v81, s34
s_nop 3
s_or_b64 s[32:33], s[32:33], vcc
v_cmp_class_f32 vcc, v82, s34
s_nop 3
s_or_b64 s[32:33], s[32:33], vcc
v_cmp_class_f32 vcc, v83, s34
s_nop 3
s_or_b64 s[32:33], s[32:33], vcc
v_cmp_class_f32 vcc, v84, s34
s_nop 3
s_or_b64 s[32:33], s[32:33], vcc
v_cmp_class_f32 vcc, v85, s34
s_nop 3
s_or_b64 s[32:33], s[32:33], vcc
v_cmp_class_f32 vcc, v86, s34
s_nop 3
s_or_b64 s[32:33], s[32:33], vcc
v_cmp_class_f32 vcc, v87, s34
s_nop 3
s_or_b64 s[32:33], s[32:33], vcc
s_mov_b64 vcc, s[32:33]
s_cbranch_vccz attnb_done5
s_mov_b32 s25, s21
s_mov_b32 s27, 0
v_mov_b32 v120, 0xff800000
v_mov_b32 v121, 0xff800000
attnb_fb4:
buffer_load_dwordx4 v[136:139], v1, s[4:7], s25 offen
buffer_load_dwordx4 v[140:143], v1, s[4:7], s25 offen offset:1024
s_add_u32 s25, s25, 2048
s_waitcnt vmcnt(0)
v_mfma_f32_32x32x16_bf16 v[88:103], v[136:139], v[8:11], 0
v_mfma_f32_32x32x16_bf16 v[88:103], v[140:143], v[12:15], v[88:103]
v_mfma_f32_32x32x16_bf16 v[104:119], v[136:139], v[16:19], 0
v_mfma_f32_32x32x16_bf16 v[104:119], v[140:143], v[20:23], v[104:119]
s_nop 9
v_max3_f32 v2, v88, v89, v90
v_max3_f32 v2, v2, v91, v92
v_max3_f32 v2, v2, v93, v94
v_max3_f32 v2, v2, v95, v96
v_max3_f32 v2, v2, v97, v98
v_max3_f32 v2, v2, v99, v100
v_max3_f32 v2, v2, v101, v102
v_max_f32 v2, v2, v103
v_max_f32 v120, v120, v2
s_nop 2
v_max3_f32 v3, v104, v105, v106
v_max3_f32 v3, v3, v107, v108
v_max3_f32 v3, v3, v109, v110
v_max3_f32 v3, v3, v111, v112
v_max3_f32 v3, v3, v113, v114
v_max3_f32 v3, v3, v115, v116
v_max3_f32 v3, v3, v117, v118
v_max_f32 v3, v3, v119
v_max_f32 v121, v121, v3
s_add_u32 s27, s27, 1
s_cmp_lt_u32 s27, 64
s_cbranch_scc1 attnb_fb4
v_mov_b32 v4, v120
s_nop 1
v_permlane32_swap_b32 v120, v4
v_max_f32 v120, v120, v4
v_sub_f32 v24, 0, v120
v_sub_f32 v25, 0, v120
v_sub_f32 v26, 0, v120
v_sub_f32 v27, 0, v120
v_sub_f32 v28, 0, v120
v_sub_f32 v29, 0, v120
v_sub_f32 v30, 0, v120
v_sub_f32 v31, 0, v120
v_sub_f32 v32, 0, v120
v_sub_f32 v33, 0, v120
v_sub_f32 v34, 0, v120
v_sub_f32 v35, 0, v120
v_sub_f32 v36, 0, v120
v_sub_f32 v37, 0, v120
v_sub_f32 v38, 0, v120
v_sub_f32 v39, 0, v120
v_mov_b32 v4, v121
s_nop 1
v_permlane32_swap_b32 v121, v4
v_max_f32 v121, v121, v4
v_sub_f32 v40, 0, v121
v_sub_f32 v41, 0, v121
v_sub_f32 v42, 0, v121
v_sub_f32 v43, 0, v121
v_sub_f32 v44, 0, v121
v_sub_f32 v45, 0, v121
v_sub_f32 v46, 0, v121
v_sub_f32 v47, 0, v121
v_sub_f32 v48, 0, v121
v_sub_f32 v49, 0, v121
v_sub_f32 v50, 0, v121
v_sub_f32 v51, 0, v121
v_sub_f32 v52, 0, v121
v_sub_f32 v53, 0, v121
v_sub_f32 v54, 0, v121
v_sub_f32 v55, 0, v121
s_mov_b32 s28, 1
s_branch attnb_main2
attnb_done5:
v_and_b32 v139, 63, v0
v_lshrrev_b32 v140, 5, v139
v_and_b32 v142, 15, v139
v_lshlrev_b32 v142, 4, v142
v_bfe_u32 v141, v139, 4, 1
v_mul_u32_u24 v141, 20480, v141
v_add_u32 v142, v142, v141
s_mul_i32 s25, s17, 20
v_lshlrev_b32 v140, 2, v140
v_add_u32 v141, s25, v140
v_add_u32 v141, 0, v141
v_lshrrev_b32 v136, 5, v141
v_lshlrev_b32 v136, 10, v136
v_bfe_u32 v139, v141, 3, 2
v_lshl_add_u32 v136, v139, 8, v136
v_bfe_u32 v139, v141, 2, 1
v_lshl_add_u32 v136, v139, 3, v136
v_add_u32 v136, v136, v142
v_add_u32 v141, s25, v140
v_add_u32 v141, 8, v141
v_lshrrev_b32 v137, 5, v141
v_lshlrev_b32 v137, 10, v137
v_bfe_u32 v139, v141, 3, 2
v_lshl_add_u32 v137, v139, 8, v137
v_bfe_u32 v139, v141, 2, 1
v_lshl_add_u32 v137, v139, 3, v137
v_add_u32 v137, v137, v142
v_add_u32 v141, s25, v140
v_add_u32 v141, 16, v141
v_lshrrev_b32 v138, 5, v141
v_lshlrev_b32 v138, 10, v138
v_bfe_u32 v139, v141, 3, 2
v_lshl_add_u32 v138, v139, 8, v138
v_bfe_u32 v139, v141, 2, 1
v_lshl_add_u32 v138, v139, 3, v138
v_add_u32 v138, v138, v142
v_cmp_eq_u32 vcc, 0, v140
v_mov_b32 v139, 0x80000000
s_nop 0
v_cndmask_b32 v138, v139, v138, vcc
s_mul_i32 s24, s23, 40960
s_add_u32 s24, s24, 50331648
v_rcp_f32 v4, v2
s_nop 0
v_mul_f32 v56, v56, v4
v_mul_f32 v57, v57, v4
v_mul_f32 v58, v58, v4
v_mul_f32 v59, v59, v4
v_mul_f32 v60, v60, v4
v_mul_f32 v61, v61, v4
v_mul_f32 v62, v62, v4
v_mul_f32 v63, v63, v4
v_mul_f32 v64, v64, v4
v_mul_f32 v65, v65, v4
v_mul_f32 v66, v66, v4
v_mul_f32 v67, v67, v4
v_cvt_pk_bf16_f32 v120, v56, v57
v_cvt_pk_bf16_f32 v121, v58, v59
v_cvt_pk_bf16_f32 v122, v60, v61
v_cvt_pk_bf16_f32 v123, v62, v63
v_cvt_pk_bf16_f32 v124, v64, v65
v_cvt_pk_bf16_f32 v125, v66, v67
buffer_store_dwordx2 v[120:121], v136, s[4:7], s24 offen sc1
buffer_store_dwordx2 v[122:123], v137, s[4:7], s24 offen sc1
buffer_store_dwordx2 v[124:125], v138, s[4:7], s24 offen sc1
v_rcp_f32 v4, v3
s_nop 0
v_mul_f32 v72, v72, v4
v_mul_f32 v73, v73, v4
v_mul_f32 v74, v74, v4
v_mul_f32 v75, v75, v4
v_mul_f32 v76, v76, v4
v_mul_f32 v77, v77, v4
v_mul_f32 v78, v78, v4
v_mul_f32 v79, v79, v4
v_mul_f32 v80, v80, v4
v_mul_f32 v81, v81, v4
v_mul_f32 v82, v82, v4
v_mul_f32 v83, v83, v4
v_cvt_pk_bf16_f32 v128, v72, v73
v_cvt_pk_bf16_f32 v129, v74, v75
v_cvt_pk_bf16_f32 v130, v76, v77
v_cvt_pk_bf16_f32 v131, v78, v79
v_cvt_pk_bf16_f32 v132, v80, v81
v_cvt_pk_bf16_f32 v133, v82, v83
s_add_u32 s24, s24, 40960
buffer_store_dwordx2 v[128:129], v136, s[4:7], s24 offen sc1
buffer_store_dwordx2 v[130:131], v137, s[4:7], s24 offen sc1
buffer_store_dwordx2 v[132:133], v138, s[4:7], s24 offen sc1
attnb_exit1:
s_endpgm
.globl outb1_kernel
.p2align 8
.type outb1_kernel,@function
outb1_kernel:
s_cmp_ge_u32 s2, 256
s_cbranch_scc1 outb1_exit1
s_load_dwordx2 s[12:13], s[0:1], 96
s_load_dwordx2 s[14:15], s[0:1], 0
s_load_dwordx2 s[48:49], s[0:1], 80
v_lshrrev_b32 v3, 6, v0
v_and_b32 v4, 63, v0
s_nop 0
v_readfirstlane_b32 s16, v3
v_lshlrev_b32 v1, 4, v4
s_and_b32 s17, s2, 7
s_lshl_b32 s17, s17, 2
s_lshr_b32 s18, s2, 3
s_and_b32 s19, s18, 3
s_add_u32 s17, s17, s19
s_lshr_b32 s18, s18, 2
s_waitcnt lgkmcnt(0)
s_mov_b32 s4, s12
s_mov_b32 s5, s13
s_mov_b32 s6, 0x10000000
s_mov_b32 s7, 0x20000
s_mov_b32 s8, s12
s_mov_b32 s9, s13
s_mov_b32 s10, 0x10000000
s_mov_b32 s11, 0x20000
s_mov_b32 s20, 82313216
s_mov_b32 s52, s48
s_mov_b32 s53, s49
s_mov_b32 s54, 2621440
s_mov_b32 s55, 0x20000
s_mul_i32 s21, s18, 5
s_mul_i32 s21, s21, 20480
s_add_u32 s24, s21, 90013696
s_add_u32 s25, s24, 20480
s_add_u32 s26, s25, 20480
s_add_u32 s27, s26, 20480
s_add_u32 s28, s27, 20480
s_lshl_b32 s21, s17, 2
s_add_u32 s21, s21, s16
s_mul_i32 s22, s21, 20480
s_add_u32 s22, s22, 50331648
s_lshl_b32 s23, s16, 10
v_add_u32 v2, s23, v1
s_mul_i32 s29, s16, 5120
s_add_u32 m0, s29, 0
s_nop 0
buffer_load_dwordx4 v2, s[4:7], s24 offen lds
s_add_u32 m0, s29, 1024
s_nop 0
buffer_load_dwordx4 v2, s[4:7], s25 offen lds
s_add_u32 m0, s29, 2048
s_nop 0
buffer_load_dwordx4 v2, s[4:7], s26 offen lds
s_add_u32 m0, s29, 3072
s_nop 0
buffer_load_dwordx4 v2, s[4:7], s27 offen lds
s_add_u32 m0, s29, 4096
s_nop 0
buffer_load_dwordx4 v2, s[4:7], s28 offen lds
buffer_load_dwordx4 v[32:35], v1, s[4:7], s22 offen offset:0
buffer_load_dwordx4 v[36:39], v1, s[4:7], s22 offen offset:1024
buffer_load_dwordx4 v[40:43], v1, s[4:7], s22 offen offset:2048
buffer_load_dwordx4 v[44:47], v1, s[4:7], s22 offen offset:3072
v_add_u32 v2, 0x1000, v2
s_add_u32 s22, s22, 4096
s_add_u32 m0, s29, 20480
s_nop 0
buffer_load_dwordx4 v2, s[4:7], s24 offen lds
s_add_u32 m0, s29, 21504
s_nop 0
buffer_load_dwordx4 v2, s[4:7], s25 offen lds
s_add_u32 m0, s29, 22528
s_nop 0
buffer_load_dwordx4 v2, s[4:7], s26 offen lds
s_add_u32 m0, s29, 23552
s_nop 0
buffer_load_dwordx4 v2, s[4:7], s27 offen lds
s_add_u32 m0, s29, 24576
s_nop 0
buffer_load_dwordx4 v2, s[4:7], s28 offen lds
buffer_load_dwordx4 v[48:51], v1, s[4:7], s22 offen offset:0
buffer_load_dwordx4 v[52:55], v1, s[4:7], s22 offen offset:1024
buffer_load_dwordx4 v[56:59], v1, s[4:7], s22 offen offset:2048
buffer_load_dwordx4 v[60:63], v1, s[4:7], s22 offen offset:3072
v_add_u32 v2, 0x1000, v2
s_add_u32 s22, s22, 4096
s_waitcnt vmcnt(9)
s_barrier
s_add_u32 m0, s29, 40960
s_nop 0
buffer_load_dwordx4 v2, s[4:7], s24 offen lds
s_add_u32 m0, s29, 41984
s_nop 0
buffer_load_dwordx4 v2, s[4:7], s25 offen lds
s_add_u32 m0, s29, 43008
s_nop 0
buffer_load_dwordx4 v2, s[4:7], s26 offen lds
s_add_u32 m0, s29, 44032
s_nop 0
buffer_load_dwordx4 v2, s[4:7], s27 offen lds
s_add_u32 m0, s29, 45056
s_nop 0
buffer_load_dwordx4 v2, s[4:7], s28 offen lds
buffer_load_dwordx4 v[64:67], v1, s[4:7], s22 offen offset:0
buffer_load_dwordx4 v[68:71], v1, s[4:7], s22 offen offset:1024
buffer_load_dwordx4 v[72:75], v1, s[4:7], s22 offen offset:2048
buffer_load_dwordx4 v[76:79], v1, s[4:7], s22 offen offset:3072
v_add_u32 v2, 0x1000, v2
s_add_u32 s22, s22, 4096
ds_read_b128 v[80:83], v1 offset:0
ds_read_b128 v[84:87], v1 offset:1024
ds_read_b128 v[88:91], v1 offset:2048
ds_read_b128 v[92:95], v1 offset:3072
ds_read_b128 v[96:99], v1 offset:4096
ds_read_b128 v[100:103], v1 offset:5120
ds_read_b128 v[104:107], v1 offset:6144
ds_read_b128 v[108:111], v1 offset:7168
ds_read_b128 v[112:115], v1 offset:8192
ds_read_b128 v[116:119], v1 offset:9216
s_waitcnt lgkmcnt(5)
v_mfma_f32_16x16x32_bf16 v[8:11], v[80:83], v[32:35], 0
v_mfma_f32_16x16x32_bf16 v[12:15], v[84:87], v[32:35], 0
v_mfma_f32_16x16x32_bf16 v[16:19], v[88:91], v[32:35], 0
v_mfma_f32_16x16x32_bf16 v[20:23], v[92:95], v[32:35], 0
v_mfma_f32_16x16x32_bf16 v[24:27], v[96:99], v[32:35], 0
ds_read_b128 v[80:83], v1 offset:10240
ds_read_b128 v[84:87], v1 offset:11264
ds_read_b128 v[88:91], v1 offset:12288
ds_read_b128 v[92:95], v1 offset:13312
ds_read_b128 v[96:99], v1 offset:14336
s_waitcnt lgkmcnt(5)
v_mfma_f32_16x16x32_bf16 v[8:11], v[100:103], v[36:39], v[8:11]
v_mfma_f32_16x16x32_bf16 v[12:15], v[104:107], v[36:39], v[12:15]
v_mfma_f32_16x16x32_bf16 v[16:19], v[108:111], v[36:39], v[16:19]
v_mfma_f32_16x16x32_bf16 v[20:23], v[112:115], v[36:39], v[20:23]
v_mfma_f32_16x16x32_bf16 v[24:27], v[116:119], v[36:39], v[24:27]
ds_read_b128 v[100:103], v1 offset:15360
ds_read_b128 v[104:107], v1 offset:16384
ds_read_b128 v[108:111], v1 offset:17408
ds_read_b128 v[112:115], v1 offset:18432
ds_read_b128 v[116:119], v1 offset:19456
s_waitcnt lgkmcnt(5)
v_mfma_f32_16x16x32_bf16 v[8:11], v[80:83], v[40:43], v[8:11]
v_mfma_f32_16x16x32_bf16 v[12:15], v[84:87], v[40:43], v[12:15]
v_mfma_f32_16x16x32_bf16 v[16:19], v[88:91], v[40:43], v[16:19]
v_mfma_f32_16x16x32_bf16 v[20:23], v[92:95], v[40:43], v[20:23]
v_mfma_f32_16x16x32_bf16 v[24:27], v[96:99], v[40:43], v[24:27]
s_waitcnt lgkmcnt(0)
v_mfma_f32_16x16x32_bf16 v[8:11], v[100:103], v[44:47], v[8:11]
v_mfma_f32_16x16x32_bf16 v[12:15], v[104:107], v[44:47], v[12:15]
v_mfma_f32_16x16x32_bf16 v[16:19], v[108:111], v[44:47], v[16:19]
v_mfma_f32_16x16x32_bf16 v[20:23], v[112:115], v[44:47], v[20:23]
v_mfma_f32_16x16x32_bf16 v[24:27], v[116:119], v[44:47], v[24:27]
s_waitcnt vmcnt(9)
s_barrier
s_add_u32 m0, s29, 0
s_nop 0
buffer_load_dwordx4 v2, s[4:7], s24 offen lds
s_add_u32 m0, s29, 1024
s_nop 0
buffer_load_dwordx4 v2, s[4:7], s25 offen lds
s_add_u32 m0, s29, 2048
s_nop 0
buffer_load_dwordx4 v2, s[4:7], s26 offen lds
s_add_u32 m0, s29, 3072
s_nop 0
buffer_load_dwordx4 v2, s[4:7], s27 offen lds
s_add_u32 m0, s29, 4096
s_nop 0
buffer_load_dwordx4 v2, s[4:7], s28 offen lds
buffer_load_dwordx4 v[32:35], v1, s[4:7], s22 offen offset:0
buffer_load_dwordx4 v[36:39], v1, s[4:7], s22 offen offset:1024
buffer_load_dwordx4 v[40:43], v1, s[4:7], s22 offen offset:2048
buffer_load_dwordx4 v[44:47], v1, s[4:7], s22 offen offset:3072
v_add_u32 v2, 0x1000, v2
s_add_u32 s22, s22, 4096
ds_read_b128 v[80:83], v1 offset:20480
ds_read_b128 v[84:87], v1 offset:21504
ds_read_b128 v[88:91], v1 offset:22528
ds_read_b128 v[92:95], v1 offset:23552
ds_read_b128 v[96:99], v1 offset:24576
ds_read_b128 v[100:103], v1 offset:25600
ds_read_b128 v[104:107], v1 offset:26624
ds_read_b128 v[108:111], v1 offset:27648
ds_read_b128 v[112:115], v1 offset:28672
ds_read_b128 v[116:119], v1 offset:29696
s_waitcnt lgkmcnt(5)
v_mfma_f32_16x16x32_bf16 v[8:11], v[80:83], v[48:51], v[8:11]
v_mfma_f32_16x16x32_bf16 v[12:15], v[84:87], v[48:51], v[12:15]
v_mfma_f32_16x16x32_bf16 v[16:19], v[88:91], v[48:51], v[16:19]
v_mfma_f32_16x16x32_bf16 v[20:23], v[92:95], v[48:51], v[20:23]
v_mfma_f32_16x16x32_bf16 v[24:27], v[96:99], v[48:51], v[24:27]
ds_read_b128 v[80:83], v1 offset:30720
ds_read_b128 v[84:87], v1 offset:31744
ds_read_b128 v[88:91], v1 offset:32768
ds_read_b128 v[92:95], v1 offset:33792
ds_read_b128 v[96:99], v1 offset:34816
s_waitcnt lgkmcnt(5)
v_mfma_f32_16x16x32_bf16 v[8:11], v[100:103], v[52:55], v[8:11]
v_mfma_f32_16x16x32_bf16 v[12:15], v[104:107], v[52:55], v[12:15]
v_mfma_f32_16x16x32_bf16 v[16:19], v[108:111], v[52:55], v[16:19]
v_mfma_f32_16x16x32_bf16 v[20:23], v[112:115], v[52:55], v[20:23]
v_mfma_f32_16x16x32_bf16 v[24:27], v[116:119], v[52:55], v[24:27]
ds_read_b128 v[100:103], v1 offset:35840
ds_read_b128 v[104:107], v1 offset:36864
ds_read_b128 v[108:111], v1 offset:37888
ds_read_b128 v[112:115], v1 offset:38912
ds_read_b128 v[116:119], v1 offset:39936
s_waitcnt lgkmcnt(5)
v_mfma_f32_16x16x32_bf16 v[8:11], v[80:83], v[56:59], v[8:11]
v_mfma_f32_16x16x32_bf16 v[12:15], v[84:87], v[56:59], v[12:15]
v_mfma_f32_16x16x32_bf16 v[16:19], v[88:91], v[56:59], v[16:19]
v_mfma_f32_16x16x32_bf16 v[20:23], v[92:95], v[56:59], v[20:23]
v_mfma_f32_16x16x32_bf16 v[24:27], v[96:99], v[56:59], v[24:27]
s_waitcnt lgkmcnt(0)
v_mfma_f32_16x16x32_bf16 v[8:11], v[100:103], v[60:63], v[8:11]
v_mfma_f32_16x16x32_bf16 v[12:15], v[104:107], v[60:63], v[12:15]
v_mfma_f32_16x16x32_bf16 v[16:19], v[108:111], v[60:63], v[16:19]
v_mfma_f32_16x16x32_bf16 v[20:23], v[112:115], v[60:63], v[20:23]
v_mfma_f32_16x16x32_bf16 v[24:27], v[116:119], v[60:63], v[24:27]
s_waitcnt vmcnt(9)
s_barrier
s_add_u32 m0, s29, 20480
s_nop 0
buffer_load_dwordx4 v2, s[4:7], s24 offen lds
s_add_u32 m0, s29, 21504
s_nop 0
buffer_load_dwordx4 v2, s[4:7], s25 offen lds
s_add_u32 m0, s29, 22528
s_nop 0
buffer_load_dwordx4 v2, s[4:7], s26 offen lds
s_add_u32 m0, s29, 23552
s_nop 0
buffer_load_dwordx4 v2, s[4:7], s27 offen lds
s_add_u32 m0, s29, 24576
s_nop 0
buffer_load_dwordx4 v2, s[4:7], s28 offen lds
buffer_load_dwordx4 v[48:51], v1, s[4:7], s22 offen offset:0
buffer_load_dwordx4 v[52:55], v1, s[4:7], s22 offen offset:1024
buffer_load_dwordx4 v[56:59], v1, s[4:7], s22 offen offset:2048
buffer_load_dwordx4 v[60:63], v1, s[4:7], s22 offen offset:3072
v_add_u32 v2, 0x1000, v2
s_add_u32 s22, s22, 4096
ds_read_b128 v[80:83], v1 offset:40960
ds_read_b128 v[84:87], v1 offset:41984
ds_read_b128 v[88:91], v1 offset:43008
ds_read_b128 v[92:95], v1 offset:44032
ds_read_b128 v[96:99], v1 offset:45056
ds_read_b128 v[100:103], v1 offset:46080
ds_read_b128 v[104:107], v1 offset:47104
ds_read_b128 v[108:111], v1 offset:48128
ds_read_b128 v[112:115], v1 offset:49152
ds_read_b128 v[116:119], v1 offset:50176
s_waitcnt lgkmcnt(5)
v_mfma_f32_16x16x32_bf16 v[8:11], v[80:83], v[64:67], v[8:11]
v_mfma_f32_16x16x32_bf16 v[12:15], v[84:87], v[64:67], v[12:15]
v_mfma_f32_16x16x32_bf16 v[16:19], v[88:91], v[64:67], v[16:19]
v_mfma_f32_16x16x32_bf16 v[20:23], v[92:95], v[64:67], v[20:23]
v_mfma_f32_16x16x32_bf16 v[24:27], v[96:99], v[64:67], v[24:27]
ds_read_b128 v[80:83], v1 offset:51200
ds_read_b128 v[84:87], v1 offset:52224
ds_read_b128 v[88:91], v1 offset:53248
ds_read_b128 v[92:95], v1 offset:54272
ds_read_b128 v[96:99], v1 offset:55296
s_waitcnt lgkmcnt(5)
v_mfma_f32_16x16x32_bf16 v[8:11], v[100:103], v[68:71], v[8:11]
v_mfma_f32_16x16x32_bf16 v[12:15], v[104:107], v[68:71], v[12:15]
v_mfma_f32_16x16x32_bf16 v[16:19], v[108:111], v[68:71], v[16:19]
v_mfma_f32_16x16x32_bf16 v[20:23], v[112:115], v[68:71], v[20:23]
v_mfma_f32_16x16x32_bf16 v[24:27], v[116:119], v[68:71], v[24:27]
ds_read_b128 v[100:103], v1 offset:56320
ds_read_b128 v[104:107], v1 offset:57344
ds_read_b128 v[108:111], v1 offset:58368
ds_read_b128 v[112:115], v1 offset:59392
ds_read_b128 v[116:119], v1 offset:60416
s_waitcnt lgkmcnt(5)
v_mfma_f32_16x16x32_bf16 v[8:11], v[80:83], v[72:75], v[8:11]
v_mfma_f32_16x16x32_bf16 v[12:15], v[84:87], v[72:75], v[12:15]
v_mfma_f32_16x16x32_bf16 v[16:19], v[88:91], v[72:75], v[16:19]
v_mfma_f32_16x16x32_bf16 v[20:23], v[92:95], v[72:75], v[20:23]
v_mfma_f32_16x16x32_bf16 v[24:27], v[96:99], v[72:75], v[24:27]
s_waitcnt lgkmcnt(0)
v_mfma_f32_16x16x32_bf16 v[8:11], v[100:103], v[76:79], v[8:11]
v_mfma_f32_16x16x32_bf16 v[12:15], v[104:107], v[76:79], v[12:15]
v_mfma_f32_16x16x32_bf16 v[16:19], v[108:111], v[76:79], v[16:19]
v_mfma_f32_16x16x32_bf16 v[20:23], v[112:115], v[76:79], v[20:23]
v_mfma_f32_16x16x32_bf16 v[24:27], v[116:119], v[76:79], v[24:27]
s_waitcnt vmcnt(9)
s_barrier
ds_read_b128 v[80:83], v1 offset:0
ds_read_b128 v[84:87], v1 offset:1024
ds_read_b128 v[88:91], v1 offset:2048
ds_read_b128 v[92:95], v1 offset:3072
ds_read_b128 v[96:99], v1 offset:4096
ds_read_b128 v[100:103], v1 offset:5120
ds_read_b128 v[104:107], v1 offset:6144
ds_read_b128 v[108:111], v1 offset:7168
ds_read_b128 v[112:115], v1 offset:8192
ds_read_b128 v[116:119], v1 offset:9216
s_waitcnt lgkmcnt(5)
v_mfma_f32_16x16x32_bf16 v[8:11], v[80:83], v[32:35], v[8:11]
v_mfma_f32_16x16x32_bf16 v[12:15], v[84:87], v[32:35], v[12:15]
v_mfma_f32_16x16x32_bf16 v[16:19], v[88:91], v[32:35], v[16:19]
v_mfma_f32_16x16x32_bf16 v[20:23], v[92:95], v[32:35], v[20:23]
v_mfma_f32_16x16x32_bf16 v[24:27], v[96:99], v[32:35], v[24:27]
ds_read_b128 v[80:83], v1 offset:10240
ds_read_b128 v[84:87], v1 offset:11264
ds_read_b128 v[88:91], v1 offset:12288
ds_read_b128 v[92:95], v1 offset:13312
ds_read_b128 v[96:99], v1 offset:14336
s_waitcnt lgkmcnt(5)
v_mfma_f32_16x16x32_bf16 v[8:11], v[100:103], v[36:39], v[8:11]
v_mfma_f32_16x16x32_bf16 v[12:15], v[104:107], v[36:39], v[12:15]
v_mfma_f32_16x16x32_bf16 v[16:19], v[108:111], v[36:39], v[16:19]
v_mfma_f32_16x16x32_bf16 v[20:23], v[112:115], v[36:39], v[20:23]
v_mfma_f32_16x16x32_bf16 v[24:27], v[116:119], v[36:39], v[24:27]
ds_read_b128 v[100:103], v1 offset:15360
ds_read_b128 v[104:107], v1 offset:16384
ds_read_b128 v[108:111], v1 offset:17408
ds_read_b128 v[112:115], v1 offset:18432
ds_read_b128 v[116:119], v1 offset:19456
s_waitcnt lgkmcnt(5)
v_mfma_f32_16x16x32_bf16 v[8:11], v[80:83], v[40:43], v[8:11]
v_mfma_f32_16x16x32_bf16 v[12:15], v[84:87], v[40:43], v[12:15]
v_mfma_f32_16x16x32_bf16 v[16:19], v[88:91], v[40:43], v[16:19]
v_mfma_f32_16x16x32_bf16 v[20:23], v[92:95], v[40:43], v[20:23]
v_mfma_f32_16x16x32_bf16 v[24:27], v[96:99], v[40:43], v[24:27]
s_waitcnt lgkmcnt(0)
v_mfma_f32_16x16x32_bf16 v[8:11], v[100:103], v[44:47], v[8:11]
v_mfma_f32_16x16x32_bf16 v[12:15], v[104:107], v[44:47], v[12:15]
v_mfma_f32_16x16x32_bf16 v[16:19], v[108:111], v[44:47], v[16:19]
v_mfma_f32_16x16x32_bf16 v[20:23], v[112:115], v[44:47], v[20:23]
v_mfma_f32_16x16x32_bf16 v[24:27], v[116:119], v[44:47], v[24:27]
s_waitcnt vmcnt(0)
s_barrier
ds_read_b128 v[80:83], v1 offset:20480
ds_read_b128 v[84:87], v1 offset:21504
ds_read_b128 v[88:91], v1 offset:22528
ds_read_b128 v[92:95], v1 offset:23552
ds_read_b128 v[96:99], v1 offset:24576
ds_read_b128 v[100:103], v1 offset:25600
ds_read_b128 v[104:107], v1 offset:26624
ds_read_b128 v[108:111], v1 offset:27648
ds_read_b128 v[112:115], v1 offset:28672
ds_read_b128 v[116:119], v1 offset:29696
s_waitcnt lgkmcnt(5)
v_mfma_f32_16x16x32_bf16 v[8:11], v[80:83], v[48:51], v[8:11]
v_mfma_f32_16x16x32_bf16 v[12:15], v[84:87], v[48:51], v[12:15]
v_mfma_f32_16x16x32_bf16 v[16:19], v[88:91], v[48:51], v[16:19]
v_mfma_f32_16x16x32_bf16 v[20:23], v[92:95], v[48:51], v[20:23]
v_mfma_f32_16x16x32_bf16 v[24:27], v[96:99], v[48:51], v[24:27]
ds_read_b128 v[80:83], v1 offset:30720
ds_read_b128 v[84:87], v1 offset:31744
ds_read_b128 v[88:91], v1 offset:32768
ds_read_b128 v[92:95], v1 offset:33792
ds_read_b128 v[96:99], v1 offset:34816
s_waitcnt lgkmcnt(5)
v_mfma_f32_16x16x32_bf16 v[8:11], v[100:103], v[52:55], v[8:11]
v_mfma_f32_16x16x32_bf16 v[12:15], v[104:107], v[52:55], v[12:15]
v_mfma_f32_16x16x32_bf16 v[16:19], v[108:111], v[52:55], v[16:19]
v_mfma_f32_16x16x32_bf16 v[20:23], v[112:115], v[52:55], v[20:23]
v_mfma_f32_16x16x32_bf16 v[24:27], v[116:119], v[52:55], v[24:27]
ds_read_b128 v[100:103], v1 offset:35840
ds_read_b128 v[104:107], v1 offset:36864
ds_read_b128 v[108:111], v1 offset:37888
ds_read_b128 v[112:115], v1 offset:38912
ds_read_b128 v[116:119], v1 offset:39936
s_waitcnt lgkmcnt(5)
v_mfma_f32_16x16x32_bf16 v[8:11], v[80:83], v[56:59], v[8:11]
v_mfma_f32_16x16x32_bf16 v[12:15], v[84:87], v[56:59], v[12:15]
v_mfma_f32_16x16x32_bf16 v[16:19], v[88:91], v[56:59], v[16:19]
v_mfma_f32_16x16x32_bf16 v[20:23], v[92:95], v[56:59], v[20:23]
v_mfma_f32_16x16x32_bf16 v[24:27], v[96:99], v[56:59], v[24:27]
s_waitcnt lgkmcnt(0)
v_mfma_f32_16x16x32_bf16 v[8:11], v[100:103], v[60:63], v[8:11]
v_mfma_f32_16x16x32_bf16 v[12:15], v[104:107], v[60:63], v[12:15]
v_mfma_f32_16x16x32_bf16 v[16:19], v[108:111], v[60:63], v[16:19]
v_mfma_f32_16x16x32_bf16 v[20:23], v[112:115], v[60:63], v[20:23]
v_mfma_f32_16x16x32_bf16 v[24:27], v[116:119], v[60:63], v[24:27]
v_and_b32 v3, 63, v0
v_and_b32 v4, 15, v3
v_lshrrev_b32 v3, 4, v3
s_lshl_b32 s21, s17, 6
s_lshl_b32 s23, s16, 4
s_add_u32 s21, s21, s23
v_add_u32 v4, s21, v4
v_mul_u32_u24 v6, 1280, v4
v_lshl_add_u32 v6, v3, 4, v6
s_mul_i32 s21, s18, 5
s_add_u32 s23, s21, 0
s_lshr_b32 s31, s23, 1
s_lshl_b32 s31, s31, 6
s_and_b32 s23, s23, 1
s_lshl_b32 s23, s23, 3
s_add_u32 s32, s31, s23
s_add_u32 s40, s32, s20
buffer_load_dwordx2 v[32:33], v6, s[8:11], s40 offen
s_add_u32 s23, s21, 1
s_lshr_b32 s31, s23, 1
s_lshl_b32 s31, s31, 6
s_and_b32 s23, s23, 1
s_lshl_b32 s23, s23, 3
s_add_u32 s33, s31, s23
s_add_u32 s41, s33, s20
buffer_load_dwordx2 v[34:35], v6, s[8:11], s41 offen
s_add_u32 s23, s21, 2
s_lshr_b32 s31, s23, 1
s_lshl_b32 s31, s31, 6
s_and_b32 s23, s23, 1
s_lshl_b32 s23, s23, 3
s_add_u32 s34, s31, s23
s_add_u32 s42, s34, s20
buffer_load_dwordx2 v[36:37], v6, s[8:11], s42 offen
s_add_u32 s23, s21, 3
s_lshr_b32 s31, s23, 1
s_lshl_b32 s31, s31, 6
s_and_b32 s23, s23, 1
s_lshl_b32 s23, s23, 3
s_add_u32 s35, s31, s23
s_add_u32 s43, s35, s20
buffer_load_dwordx2 v[38:39], v6, s[8:11], s43 offen
s_add_u32 s23, s21, 4
s_lshr_b32 s31, s23, 1
s_lshl_b32 s31, s31, 6
s_and_b32 s23, s23, 1
s_lshl_b32 s23, s23, 3
s_add_u32 s36, s31, s23
s_add_u32 s44, s36, s20
buffer_load_dwordx2 v[40:41], v6, s[8:11], s44 offen
s_waitcnt vmcnt(0)
v_cvt_pk_bf16_f32 v80, v8, v9
v_cvt_pk_bf16_f32 v81, v10, v11
v_lshlrev_b32 v8, 16, v80
v_and_b32 v9, 0xffff0000, v80
v_lshlrev_b32 v10, 16, v81
v_and_b32 v11, 0xffff0000, v81
v_lshlrev_b32 v82, 16, v32
v_and_b32 v83, 0xffff0000, v32
v_lshlrev_b32 v84, 16, v33
v_and_b32 v85, 0xffff0000, v33
v_add_f32 v8, v8, v82
v_add_f32 v9, v9, v83
v_add_f32 v10, v10, v84
v_add_f32 v11, v11, v85
v_cvt_pk_bf16_f32 v32, v8, v9
v_cvt_pk_bf16_f32 v33, v10, v11
s_add_u32 s23, s32, 82313216
buffer_store_dwordx2 v[32:33], v6, s[4:7], s23 offen sc1
v_cvt_pk_bf16_f32 v80, v12, v13
v_cvt_pk_bf16_f32 v81, v14, v15
v_lshlrev_b32 v12, 16, v80
v_and_b32 v13, 0xffff0000, v80
v_lshlrev_b32 v14, 16, v81
v_and_b32 v15, 0xffff0000, v81
v_lshlrev_b32 v82, 16, v34
v_and_b32 v83, 0xffff0000, v34
v_lshlrev_b32 v84, 16, v35
v_and_b32 v85, 0xffff0000, v35
v_add_f32 v12, v12, v82
v_add_f32 v13, v13, v83
v_add_f32 v14, v14, v84
v_add_f32 v15, v15, v85
v_cvt_pk_bf16_f32 v34, v12, v13
v_cvt_pk_bf16_f32 v35, v14, v15
s_add_u32 s23, s33, 82313216
buffer_store_dwordx2 v[34:35], v6, s[4:7], s23 offen sc1
v_cvt_pk_bf16_f32 v80, v16, v17
v_cvt_pk_bf16_f32 v81, v18, v19
v_lshlrev_b32 v16, 16, v80
v_and_b32 v17, 0xffff0000, v80
v_lshlrev_b32 v18, 16, v81
v_and_b32 v19, 0xffff0000, v81
v_lshlrev_b32 v82, 16, v36
v_and_b32 v83, 0xffff0000, v36
v_lshlrev_b32 v84, 16, v37
v_and_b32 v85, 0xffff0000, v37
v_add_f32 v16, v16, v82
v_add_f32 v17, v17, v83
v_add_f32 v18, v18, v84
v_add_f32 v19, v19, v85
v_cvt_pk_bf16_f32 v36, v16, v17
v_cvt_pk_bf16_f32 v37, v18, v19
s_add_u32 s23, s34, 82313216
buffer_store_dwordx2 v[36:37], v6, s[4:7], s23 offen sc1
v_cvt_pk_bf16_f32 v80, v20, v21
v_cvt_pk_bf16_f32 v81, v22, v23
v_lshlrev_b32 v20, 16, v80
v_and_b32 v21, 0xffff0000, v80
v_lshlrev_b32 v22, 16, v81
v_and_b32 v23, 0xffff0000, v81
v_lshlrev_b32 v82, 16, v38
v_and_b32 v83, 0xffff0000, v38
v_lshlrev_b32 v84, 16, v39
v_and_b32 v85, 0xffff0000, v39
v_add_f32 v20, v20, v82
v_add_f32 v21, v21, v83
v_add_f32 v22, v22, v84
v_add_f32 v23, v23, v85
v_cvt_pk_bf16_f32 v38, v20, v21
v_cvt_pk_bf16_f32 v39, v22, v23
s_add_u32 s23, s35, 82313216
buffer_store_dwordx2 v[38:39], v6, s[4:7], s23 offen sc1
v_cvt_pk_bf16_f32 v80, v24, v25
v_cvt_pk_bf16_f32 v81, v26, v27
v_lshlrev_b32 v24, 16, v80
v_and_b32 v25, 0xffff0000, v80
v_lshlrev_b32 v26, 16, v81
v_and_b32 v27, 0xffff0000, v81
v_lshlrev_b32 v82, 16, v40
v_and_b32 v83, 0xffff0000, v40
v_lshlrev_b32 v84, 16, v41
v_and_b32 v85, 0xffff0000, v41
v_add_f32 v24, v24, v82
v_add_f32 v25, v25, v83
v_add_f32 v26, v26, v84
v_add_f32 v27, v27, v85
v_cvt_pk_bf16_f32 v40, v24, v25
v_cvt_pk_bf16_f32 v41, v26, v27
s_add_u32 s23, s36, 82313216
buffer_store_dwordx2 v[40:41], v6, s[4:7], s23 offen sc1
outb1_exit1:
s_endpgm
.globl outb2_kernel
.p2align 8
.type outb2_kernel,@function
outb2_kernel:
s_cmp_ge_u32 s2, 256
s_cbranch_scc1 outb2_exit1
s_load_dwordx2 s[12:13], s[0:1], 96
s_load_dwordx2 s[14:15], s[0:1], 0
s_load_dwordx2 s[48:49], s[0:1], 80
v_lshrrev_b32 v3, 6, v0
v_and_b32 v4, 63, v0
s_nop 0
v_readfirstlane_b32 s16, v3
v_lshlrev_b32 v1, 4, v4
s_and_b32 s17, s2, 7
s_lshl_b32 s17, s17, 2
s_lshr_b32 s18, s2, 3
s_and_b32 s19, s18, 3
s_add_u32 s17, s17, s19
s_lshr_b32 s18, s18, 2
s_waitcnt lgkmcnt(0)
s_mov_b32 s4, s12
s_mov_b32 s5, s13
s_mov_b32 s6, 0x10000000
s_mov_b32 s7, 0x20000
s_mov_b32 s8, s12
s_mov_b32 s9, s13
s_mov_b32 s10, 0x10000000
s_mov_b32 s11, 0x20000
s_mov_b32 s20, 82313216
s_mov_b32 s52, s48
s_mov_b32 s53, s49
s_mov_b32 s54, 2621440
s_mov_b32 s55, 0x20000
s_mul_i32 s21, s18, 5
s_mul_i32 s21, s21, 20480
s_add_u32 s24, s21, 90013696
s_add_u32 s25, s24, 20480
s_add_u32 s26, s25, 20480
s_add_u32 s27, s26, 20480
s_add_u32 s28, s27, 20480
s_lshl_b32 s21, s17, 2
s_add_u32 s21, s21, s16
s_mul_i32 s22, s21, 20480
s_add_u32 s22, s22, 50331648
s_lshl_b32 s23, s16, 10
v_add_u32 v2, s23, v1
s_mul_i32 s29, s16, 5120
s_add_u32 m0, s29, 0
s_nop 0
buffer_load_dwordx4 v2, s[4:7], s24 offen lds
s_add_u32 m0, s29, 1024
s_nop 0
buffer_load_dwordx4 v2, s[4:7], s25 offen lds
s_add_u32 m0, s29, 2048
s_nop 0
buffer_load_dwordx4 v2, s[4:7], s26 offen lds
s_add_u32 m0, s29, 3072
s_nop 0
buffer_load_dwordx4 v2, s[4:7], s27 offen lds
s_add_u32 m0, s29, 4096
s_nop 0
buffer_load_dwordx4 v2, s[4:7], s28 offen lds
buffer_load_dwordx4 v[32:35], v1, s[4:7], s22 offen offset:0
buffer_load_dwordx4 v[36:39], v1, s[4:7], s22 offen offset:1024
buffer_load_dwordx4 v[40:43], v1, s[4:7], s22 offen offset:2048
buffer_load_dwordx4 v[44:47], v1, s[4:7], s22 offen offset:3072
v_add_u32 v2, 0x1000, v2
s_add_u32 s22, s22, 4096
s_add_u32 m0, s29, 20480
s_nop 0
buffer_load_dwordx4 v2, s[4:7], s24 offen lds
s_add_u32 m0, s29, 21504
s_nop 0
buffer_load_dwordx4 v2, s[4:7], s25 offen lds
s_add_u32 m0, s29, 22528
s_nop 0
buffer_load_dwordx4 v2, s[4:7], s26 offen lds
s_add_u32 m0, s29, 23552
s_nop 0
buffer_load_dwordx4 v2, s[4:7], s27 offen lds
s_add_u32 m0, s29, 24576
s_nop 0
buffer_load_dwordx4 v2, s[4:7], s28 offen lds
buffer_load_dwordx4 v[48:51], v1, s[4:7], s22 offen offset:0
buffer_load_dwordx4 v[52:55], v1, s[4:7], s22 offen offset:1024
buffer_load_dwordx4 v[56:59], v1, s[4:7], s22 offen offset:2048
buffer_load_dwordx4 v[60:63], v1, s[4:7], s22 offen offset:3072
v_add_u32 v2, 0x1000, v2
s_add_u32 s22, s22, 4096
s_waitcnt vmcnt(9)
s_barrier
s_add_u32 m0, s29, 40960
s_nop 0
buffer_load_dwordx4 v2, s[4:7], s24 offen lds
s_add_u32 m0, s29, 41984
s_nop 0
buffer_load_dwordx4 v2, s[4:7], s25 offen lds
s_add_u32 m0, s29, 43008
s_nop 0
buffer_load_dwordx4 v2, s[4:7], s26 offen lds
s_add_u32 m0, s29, 44032
s_nop 0
buffer_load_dwordx4 v2, s[4:7], s27 offen lds
s_add_u32 m0, s29, 45056
s_nop 0
buffer_load_dwordx4 v2, s[4:7], s28 offen lds
buffer_load_dwordx4 v[64:67], v1, s[4:7], s22 offen offset:0
buffer_load_dwordx4 v[68:71], v1, s[4:7], s22 offen offset:1024
buffer_load_dwordx4 v[72:75], v1, s[4:7], s22 offen offset:2048
buffer_load_dwordx4 v[76:79], v1, s[4:7], s22 offen offset:3072
v_add_u32 v2, 0x1000, v2
s_add_u32 s22, s22, 4096
ds_read_b128 v[80:83], v1 offset:0
ds_read_b128 v[84:87], v1 offset:1024
ds_read_b128 v[88:91], v1 offset:2048
ds_read_b128 v[92:95], v1 offset:3072
ds_read_b128 v[96:99], v1 offset:4096
ds_read_b128 v[100:103], v1 offset:5120
ds_read_b128 v[104:107], v1 offset:6144
ds_read_b128 v[108:111], v1 offset:7168
ds_read_b128 v[112:115], v1 offset:8192
ds_read_b128 v[116:119], v1 offset:9216
s_waitcnt lgkmcnt(5)
v_mfma_f32_16x16x32_bf16 v[8:11], v[80:83], v[32:35], 0
v_mfma_f32_16x16x32_bf16 v[12:15], v[84:87], v[32:35], 0
v_mfma_f32_16x16x32_bf16 v[16:19], v[88:91], v[32:35], 0
v_mfma_f32_16x16x32_bf16 v[20:23], v[92:95], v[32:35], 0
v_mfma_f32_16x16x32_bf16 v[24:27], v[96:99], v[32:35], 0
ds_read_b128 v[80:83], v1 offset:10240
ds_read_b128 v[84:87], v1 offset:11264
ds_read_b128 v[88:91], v1 offset:12288
ds_read_b128 v[92:95], v1 offset:13312
ds_read_b128 v[96:99], v1 offset:14336
s_waitcnt lgkmcnt(5)
v_mfma_f32_16x16x32_bf16 v[8:11], v[100:103], v[36:39], v[8:11]
v_mfma_f32_16x16x32_bf16 v[12:15], v[104:107], v[36:39], v[12:15]
v_mfma_f32_16x16x32_bf16 v[16:19], v[108:111], v[36:39], v[16:19]
v_mfma_f32_16x16x32_bf16 v[20:23], v[112:115], v[36:39], v[20:23]
v_mfma_f32_16x16x32_bf16 v[24:27], v[116:119], v[36:39], v[24:27]
ds_read_b128 v[100:103], v1 offset:15360
ds_read_b128 v[104:107], v1 offset:16384
ds_read_b128 v[108:111], v1 offset:17408
ds_read_b128 v[112:115], v1 offset:18432
ds_read_b128 v[116:119], v1 offset:19456
s_waitcnt lgkmcnt(5)
v_mfma_f32_16x16x32_bf16 v[8:11], v[80:83], v[40:43], v[8:11]
v_mfma_f32_16x16x32_bf16 v[12:15], v[84:87], v[40:43], v[12:15]
v_mfma_f32_16x16x32_bf16 v[16:19], v[88:91], v[40:43], v[16:19]
v_mfma_f32_16x16x32_bf16 v[20:23], v[92:95], v[40:43], v[20:23]
v_mfma_f32_16x16x32_bf16 v[24:27], v[96:99], v[40:43], v[24:27]
s_waitcnt lgkmcnt(0)
v_mfma_f32_16x16x32_bf16 v[8:11], v[100:103], v[44:47], v[8:11]
v_mfma_f32_16x16x32_bf16 v[12:15], v[104:107], v[44:47], v[12:15]
v_mfma_f32_16x16x32_bf16 v[16:19], v[108:111], v[44:47], v[16:19]
v_mfma_f32_16x16x32_bf16 v[20:23], v[112:115], v[44:47], v[20:23]
v_mfma_f32_16x16x32_bf16 v[24:27], v[116:119], v[44:47], v[24:27]
s_waitcnt vmcnt(9)
s_barrier
s_add_u32 m0, s29, 0
s_nop 0
buffer_load_dwordx4 v2, s[4:7], s24 offen lds
s_add_u32 m0, s29, 1024
s_nop 0
buffer_load_dwordx4 v2, s[4:7], s25 offen lds
s_add_u32 m0, s29, 2048
s_nop 0
buffer_load_dwordx4 v2, s[4:7], s26 offen lds
s_add_u32 m0, s29, 3072
s_nop 0
buffer_load_dwordx4 v2, s[4:7], s27 offen lds
s_add_u32 m0, s29, 4096
s_nop 0
buffer_load_dwordx4 v2, s[4:7], s28 offen lds
buffer_load_dwordx4 v[32:35], v1, s[4:7], s22 offen offset:0
buffer_load_dwordx4 v[36:39], v1, s[4:7], s22 offen offset:1024
buffer_load_dwordx4 v[40:43], v1, s[4:7], s22 offen offset:2048
buffer_load_dwordx4 v[44:47], v1, s[4:7], s22 offen offset:3072
v_add_u32 v2, 0x1000, v2
s_add_u32 s22, s22, 4096
ds_read_b128 v[80:83], v1 offset:20480
ds_read_b128 v[84:87], v1 offset:21504
ds_read_b128 v[88:91], v1 offset:22528
ds_read_b128 v[92:95], v1 offset:23552
ds_read_b128 v[96:99], v1 offset:24576
ds_read_b128 v[100:103], v1 offset:25600
ds_read_b128 v[104:107], v1 offset:26624
ds_read_b128 v[108:111], v1 offset:27648
ds_read_b128 v[112:115], v1 offset:28672
ds_read_b128 v[116:119], v1 offset:29696
s_waitcnt lgkmcnt(5)
v_mfma_f32_16x16x32_bf16 v[8:11], v[80:83], v[48:51], v[8:11]
v_mfma_f32_16x16x32_bf16 v[12:15], v[84:87], v[48:51], v[12:15]
v_mfma_f32_16x16x32_bf16 v[16:19], v[88:91], v[48:51], v[16:19]
v_mfma_f32_16x16x32_bf16 v[20:23], v[92:95], v[48:51], v[20:23]
v_mfma_f32_16x16x32_bf16 v[24:27], v[96:99], v[48:51], v[24:27]
ds_read_b128 v[80:83], v1 offset:30720
ds_read_b128 v[84:87], v1 offset:31744
ds_read_b128 v[88:91], v1 offset:32768
ds_read_b128 v[92:95], v1 offset:33792
ds_read_b128 v[96:99], v1 offset:34816
s_waitcnt lgkmcnt(5)
v_mfma_f32_16x16x32_bf16 v[8:11], v[100:103], v[52:55], v[8:11]
v_mfma_f32_16x16x32_bf16 v[12:15], v[104:107], v[52:55], v[12:15]
v_mfma_f32_16x16x32_bf16 v[16:19], v[108:111], v[52:55], v[16:19]
v_mfma_f32_16x16x32_bf16 v[20:23], v[112:115], v[52:55], v[20:23]
v_mfma_f32_16x16x32_bf16 v[24:27], v[116:119], v[52:55], v[24:27]
ds_read_b128 v[100:103], v1 offset:35840
ds_read_b128 v[104:107], v1 offset:36864
ds_read_b128 v[108:111], v1 offset:37888
ds_read_b128 v[112:115], v1 offset:38912
ds_read_b128 v[116:119], v1 offset:39936
s_waitcnt lgkmcnt(5)
v_mfma_f32_16x16x32_bf16 v[8:11], v[80:83], v[56:59], v[8:11]
v_mfma_f32_16x16x32_bf16 v[12:15], v[84:87], v[56:59], v[12:15]
v_mfma_f32_16x16x32_bf16 v[16:19], v[88:91], v[56:59], v[16:19]
v_mfma_f32_16x16x32_bf16 v[20:23], v[92:95], v[56:59], v[20:23]
v_mfma_f32_16x16x32_bf16 v[24:27], v[96:99], v[56:59], v[24:27]
s_waitcnt lgkmcnt(0)
v_mfma_f32_16x16x32_bf16 v[8:11], v[100:103], v[60:63], v[8:11]
v_mfma_f32_16x16x32_bf16 v[12:15], v[104:107], v[60:63], v[12:15]
v_mfma_f32_16x16x32_bf16 v[16:19], v[108:111], v[60:63], v[16:19]
v_mfma_f32_16x16x32_bf16 v[20:23], v[112:115], v[60:63], v[20:23]
v_mfma_f32_16x16x32_bf16 v[24:27], v[116:119], v[60:63], v[24:27]
s_waitcnt vmcnt(9)
s_barrier
s_add_u32 m0, s29, 20480
s_nop 0
buffer_load_dwordx4 v2, s[4:7], s24 offen lds
s_add_u32 m0, s29, 21504
s_nop 0
buffer_load_dwordx4 v2, s[4:7], s25 offen lds
s_add_u32 m0, s29, 22528
s_nop 0
buffer_load_dwordx4 v2, s[4:7], s26 offen lds
s_add_u32 m0, s29, 23552
s_nop 0
buffer_load_dwordx4 v2, s[4:7], s27 offen lds
s_add_u32 m0, s29, 24576
s_nop 0
buffer_load_dwordx4 v2, s[4:7], s28 offen lds
buffer_load_dwordx4 v[48:51], v1, s[4:7], s22 offen offset:0
buffer_load_dwordx4 v[52:55], v1, s[4:7], s22 offen offset:1024
buffer_load_dwordx4 v[56:59], v1, s[4:7], s22 offen offset:2048
buffer_load_dwordx4 v[60:63], v1, s[4:7], s22 offen offset:3072
v_add_u32 v2, 0x1000, v2
s_add_u32 s22, s22, 4096
ds_read_b128 v[80:83], v1 offset:40960
ds_read_b128 v[84:87], v1 offset:41984
ds_read_b128 v[88:91], v1 offset:43008
ds_read_b128 v[92:95], v1 offset:44032
ds_read_b128 v[96:99], v1 offset:45056
ds_read_b128 v[100:103], v1 offset:46080
ds_read_b128 v[104:107], v1 offset:47104
ds_read_b128 v[108:111], v1 offset:48128
ds_read_b128 v[112:115], v1 offset:49152
ds_read_b128 v[116:119], v1 offset:50176
s_waitcnt lgkmcnt(5)
v_mfma_f32_16x16x32_bf16 v[8:11], v[80:83], v[64:67], v[8:11]
v_mfma_f32_16x16x32_bf16 v[12:15], v[84:87], v[64:67], v[12:15]
v_mfma_f32_16x16x32_bf16 v[16:19], v[88:91], v[64:67], v[16:19]
v_mfma_f32_16x16x32_bf16 v[20:23], v[92:95], v[64:67], v[20:23]
v_mfma_f32_16x16x32_bf16 v[24:27], v[96:99], v[64:67], v[24:27]
ds_read_b128 v[80:83], v1 offset:51200
ds_read_b128 v[84:87], v1 offset:52224
ds_read_b128 v[88:91], v1 offset:53248
ds_read_b128 v[92:95], v1 offset:54272
ds_read_b128 v[96:99], v1 offset:55296
s_waitcnt lgkmcnt(5)
v_mfma_f32_16x16x32_bf16 v[8:11], v[100:103], v[68:71], v[8:11]
v_mfma_f32_16x16x32_bf16 v[12:15], v[104:107], v[68:71], v[12:15]
v_mfma_f32_16x16x32_bf16 v[16:19], v[108:111], v[68:71], v[16:19]
v_mfma_f32_16x16x32_bf16 v[20:23], v[112:115], v[68:71], v[20:23]
v_mfma_f32_16x16x32_bf16 v[24:27], v[116:119], v[68:71], v[24:27]
ds_read_b128 v[100:103], v1 offset:56320
ds_read_b128 v[104:107], v1 offset:57344
ds_read_b128 v[108:111], v1 offset:58368
ds_read_b128 v[112:115], v1 offset:59392
ds_read_b128 v[116:119], v1 offset:60416
s_waitcnt lgkmcnt(5)
v_mfma_f32_16x16x32_bf16 v[8:11], v[80:83], v[72:75], v[8:11]
v_mfma_f32_16x16x32_bf16 v[12:15], v[84:87], v[72:75], v[12:15]
v_mfma_f32_16x16x32_bf16 v[16:19], v[88:91], v[72:75], v[16:19]
v_mfma_f32_16x16x32_bf16 v[20:23], v[92:95], v[72:75], v[20:23]
v_mfma_f32_16x16x32_bf16 v[24:27], v[96:99], v[72:75], v[24:27]
s_waitcnt lgkmcnt(0)
v_mfma_f32_16x16x32_bf16 v[8:11], v[100:103], v[76:79], v[8:11]
v_mfma_f32_16x16x32_bf16 v[12:15], v[104:107], v[76:79], v[12:15]
v_mfma_f32_16x16x32_bf16 v[16:19], v[108:111], v[76:79], v[16:19]
v_mfma_f32_16x16x32_bf16 v[20:23], v[112:115], v[76:79], v[20:23]
v_mfma_f32_16x16x32_bf16 v[24:27], v[116:119], v[76:79], v[24:27]
s_waitcnt vmcnt(9)
s_barrier
ds_read_b128 v[80:83], v1 offset:0
ds_read_b128 v[84:87], v1 offset:1024
ds_read_b128 v[88:91], v1 offset:2048
ds_read_b128 v[92:95], v1 offset:3072
ds_read_b128 v[96:99], v1 offset:4096
ds_read_b128 v[100:103], v1 offset:5120
ds_read_b128 v[104:107], v1 offset:6144
ds_read_b128 v[108:111], v1 offset:7168
ds_read_b128 v[112:115], v1 offset:8192
ds_read_b128 v[116:119], v1 offset:9216
s_waitcnt lgkmcnt(5)
v_mfma_f32_16x16x32_bf16 v[8:11], v[80:83], v[32:35], v[8:11]
v_mfma_f32_16x16x32_bf16 v[12:15], v[84:87], v[32:35], v[12:15]
v_mfma_f32_16x16x32_bf16 v[16:19], v[88:91], v[32:35], v[16:19]
v_mfma_f32_16x16x32_bf16 v[20:23], v[92:95], v[32:35], v[20:23]
v_mfma_f32_16x16x32_bf16 v[24:27], v[96:99], v[32:35], v[24:27]
ds_read_b128 v[80:83], v1 offset:10240
ds_read_b128 v[84:87], v1 offset:11264
ds_read_b128 v[88:91], v1 offset:12288
ds_read_b128 v[92:95], v1 offset:13312
ds_read_b128 v[96:99], v1 offset:14336
s_waitcnt lgkmcnt(5)
v_mfma_f32_16x16x32_bf16 v[8:11], v[100:103], v[36:39], v[8:11]
v_mfma_f32_16x16x32_bf16 v[12:15], v[104:107], v[36:39], v[12:15]
v_mfma_f32_16x16x32_bf16 v[16:19], v[108:111], v[36:39], v[16:19]
v_mfma_f32_16x16x32_bf16 v[20:23], v[112:115], v[36:39], v[20:23]
v_mfma_f32_16x16x32_bf16 v[24:27], v[116:119], v[36:39], v[24:27]
ds_read_b128 v[100:103], v1 offset:15360
ds_read_b128 v[104:107], v1 offset:16384
ds_read_b128 v[108:111], v1 offset:17408
ds_read_b128 v[112:115], v1 offset:18432
ds_read_b128 v[116:119], v1 offset:19456
s_waitcnt lgkmcnt(5)
v_mfma_f32_16x16x32_bf16 v[8:11], v[80:83], v[40:43], v[8:11]
v_mfma_f32_16x16x32_bf16 v[12:15], v[84:87], v[40:43], v[12:15]
v_mfma_f32_16x16x32_bf16 v[16:19], v[88:91], v[40:43], v[16:19]
v_mfma_f32_16x16x32_bf16 v[20:23], v[92:95], v[40:43], v[20:23]
v_mfma_f32_16x16x32_bf16 v[24:27], v[96:99], v[40:43], v[24:27]
s_waitcnt lgkmcnt(0)
v_mfma_f32_16x16x32_bf16 v[8:11], v[100:103], v[44:47], v[8:11]
v_mfma_f32_16x16x32_bf16 v[12:15], v[104:107], v[44:47], v[12:15]
v_mfma_f32_16x16x32_bf16 v[16:19], v[108:111], v[44:47], v[16:19]
v_mfma_f32_16x16x32_bf16 v[20:23], v[112:115], v[44:47], v[20:23]
v_mfma_f32_16x16x32_bf16 v[24:27], v[116:119], v[44:47], v[24:27]
s_waitcnt vmcnt(0)
s_barrier
ds_read_b128 v[80:83], v1 offset:20480
ds_read_b128 v[84:87], v1 offset:21504
ds_read_b128 v[88:91], v1 offset:22528
ds_read_b128 v[92:95], v1 offset:23552
ds_read_b128 v[96:99], v1 offset:24576
ds_read_b128 v[100:103], v1 offset:25600
ds_read_b128 v[104:107], v1 offset:26624
ds_read_b128 v[108:111], v1 offset:27648
ds_read_b128 v[112:115], v1 offset:28672
ds_read_b128 v[116:119], v1 offset:29696
s_waitcnt lgkmcnt(5)
v_mfma_f32_16x16x32_bf16 v[8:11], v[80:83], v[48:51], v[8:11]
v_mfma_f32_16x16x32_bf16 v[12:15], v[84:87], v[48:51], v[12:15]
v_mfma_f32_16x16x32_bf16 v[16:19], v[88:91], v[48:51], v[16:19]
v_mfma_f32_16x16x32_bf16 v[20:23], v[92:95], v[48:51], v[20:23]
v_mfma_f32_16x16x32_bf16 v[24:27], v[96:99], v[48:51], v[24:27]
ds_read_b128 v[80:83], v1 offset:30720
ds_read_b128 v[84:87], v1 offset:31744
ds_read_b128 v[88:91], v1 offset:32768
ds_read_b128 v[92:95], v1 offset:33792
ds_read_b128 v[96:99], v1 offset:34816
s_waitcnt lgkmcnt(5)
v_mfma_f32_16x16x32_bf16 v[8:11], v[100:103], v[52:55], v[8:11]
v_mfma_f32_16x16x32_bf16 v[12:15], v[104:107], v[52:55], v[12:15]
v_mfma_f32_16x16x32_bf16 v[16:19], v[108:111], v[52:55], v[16:19]
v_mfma_f32_16x16x32_bf16 v[20:23], v[112:115], v[52:55], v[20:23]
v_mfma_f32_16x16x32_bf16 v[24:27], v[116:119], v[52:55], v[24:27]
ds_read_b128 v[100:103], v1 offset:35840
ds_read_b128 v[104:107], v1 offset:36864
ds_read_b128 v[108:111], v1 offset:37888
ds_read_b128 v[112:115], v1 offset:38912
ds_read_b128 v[116:119], v1 offset:39936
s_waitcnt lgkmcnt(5)
v_mfma_f32_16x16x32_bf16 v[8:11], v[80:83], v[56:59], v[8:11]
v_mfma_f32_16x16x32_bf16 v[12:15], v[84:87], v[56:59], v[12:15]
v_mfma_f32_16x16x32_bf16 v[16:19], v[88:91], v[56:59], v[16:19]
v_mfma_f32_16x16x32_bf16 v[20:23], v[92:95], v[56:59], v[20:23]
v_mfma_f32_16x16x32_bf16 v[24:27], v[96:99], v[56:59], v[24:27]
s_waitcnt lgkmcnt(0)
v_mfma_f32_16x16x32_bf16 v[8:11], v[100:103], v[60:63], v[8:11]
v_mfma_f32_16x16x32_bf16 v[12:15], v[104:107], v[60:63], v[12:15]
v_mfma_f32_16x16x32_bf16 v[16:19], v[108:111], v[60:63], v[16:19]
v_mfma_f32_16x16x32_bf16 v[20:23], v[112:115], v[60:63], v[20:23]
v_mfma_f32_16x16x32_bf16 v[24:27], v[116:119], v[60:63], v[24:27]
v_and_b32 v3, 63, v0
v_and_b32 v4, 15, v3
v_lshrrev_b32 v3, 4, v3
s_lshl_b32 s21, s17, 6
s_lshl_b32 s23, s16, 4
s_add_u32 s21, s21, s23
v_add_u32 v4, s21, v4
v_mul_u32_u24 v6, 1280, v4
v_lshl_add_u32 v6, v3, 4, v6
s_mul_i32 s21, s18, 5
s_add_u32 s23, s21, 0
s_lshr_b32 s31, s23, 1
s_lshl_b32 s31, s31, 6
s_and_b32 s23, s23, 1
s_lshl_b32 s23, s23, 3
s_add_u32 s32, s31, s23
s_add_u32 s40, s32, s20
buffer_load_dwordx2 v[32:33], v6, s[8:11], s40 offen
s_add_u32 s23, s21, 1
s_lshr_b32 s31, s23, 1
s_lshl_b32 s31, s31, 6
s_and_b32 s23, s23, 1
s_lshl_b32 s23, s23, 3
s_add_u32 s33, s31, s23
s_add_u32 s41, s33, s20
buffer_load_dwordx2 v[34:35], v6, s[8:11], s41 offen
s_add_u32 s23, s21, 2
s_lshr_b32 s31, s23, 1
s_lshl_b32 s31, s31, 6
s_and_b32 s23, s23, 1
s_lshl_b32 s23, s23, 3
s_add_u32 s34, s31, s23
s_add_u32 s42, s34, s20
buffer_load_dwordx2 v[36:37], v6, s[8:11], s42 offen
s_add_u32 s23, s21, 3
s_lshr_b32 s31, s23, 1
s_lshl_b32 s31, s31, 6
s_and_b32 s23, s23, 1
s_lshl_b32 s23, s23, 3
s_add_u32 s35, s31, s23
s_add_u32 s43, s35, s20
buffer_load_dwordx2 v[38:39], v6, s[8:11], s43 offen
s_add_u32 s23, s21, 4
s_lshr_b32 s31, s23, 1
s_lshl_b32 s31, s31, 6
s_and_b32 s23, s23, 1
s_lshl_b32 s23, s23, 3
s_add_u32 s36, s31, s23
s_add_u32 s44, s36, s20
buffer_load_dwordx2 v[40:41], v6, s[8:11], s44 offen
s_waitcnt vmcnt(0)
v_cvt_pk_bf16_f32 v80, v8, v9
v_cvt_pk_bf16_f32 v81, v10, v11
v_lshlrev_b32 v8, 16, v80
v_and_b32 v9, 0xffff0000, v80
v_lshlrev_b32 v10, 16, v81
v_and_b32 v11, 0xffff0000, v81
v_lshlrev_b32 v82, 16, v32
v_and_b32 v83, 0xffff0000, v32
v_lshlrev_b32 v84, 16, v33
v_and_b32 v85, 0xffff0000, v33
v_add_f32 v8, v8, v82
v_add_f32 v9, v9, v83
v_add_f32 v10, v10, v84
v_add_f32 v11, v11, v85
v_cvt_pk_bf16_f32 v32, v8, v9
v_cvt_pk_bf16_f32 v33, v10, v11
buffer_store_dwordx2 v[32:33], v6, s[52:55], s32 offen sc1
v_cvt_pk_bf16_f32 v80, v12, v13
v_cvt_pk_bf16_f32 v81, v14, v15
v_lshlrev_b32 v12, 16, v80
v_and_b32 v13, 0xffff0000, v80
v_lshlrev_b32 v14, 16, v81
v_and_b32 v15, 0xffff0000, v81
v_lshlrev_b32 v82, 16, v34
v_and_b32 v83, 0xffff0000, v34
v_lshlrev_b32 v84, 16, v35
v_and_b32 v85, 0xffff0000, v35
v_add_f32 v12, v12, v82
v_add_f32 v13, v13, v83
v_add_f32 v14, v14, v84
v_add_f32 v15, v15, v85
v_cvt_pk_bf16_f32 v34, v12, v13
v_cvt_pk_bf16_f32 v35, v14, v15
buffer_store_dwordx2 v[34:35], v6, s[52:55], s33 offen sc1
v_cvt_pk_bf16_f32 v80, v16, v17
v_cvt_pk_bf16_f32 v81, v18, v19
v_lshlrev_b32 v16, 16, v80
v_and_b32 v17, 0xffff0000, v80
v_lshlrev_b32 v18, 16, v81
v_and_b32 v19, 0xffff0000, v81
v_lshlrev_b32 v82, 16, v36
v_and_b32 v83, 0xffff0000, v36
v_lshlrev_b32 v84, 16, v37
v_and_b32 v85, 0xffff0000, v37
v_add_f32 v16, v16, v82
v_add_f32 v17, v17, v83
v_add_f32 v18, v18, v84
v_add_f32 v19, v19, v85
v_cvt_pk_bf16_f32 v36, v16, v17
v_cvt_pk_bf16_f32 v37, v18, v19
buffer_store_dwordx2 v[36:37], v6, s[52:55], s34 offen sc1
v_cvt_pk_bf16_f32 v80, v20, v21
v_cvt_pk_bf16_f32 v81, v22, v23
v_lshlrev_b32 v20, 16, v80
v_and_b32 v21, 0xffff0000, v80
v_lshlrev_b32 v22, 16, v81
v_and_b32 v23, 0xffff0000, v81
v_lshlrev_b32 v82, 16, v38
v_and_b32 v83, 0xffff0000, v38
v_lshlrev_b32 v84, 16, v39
v_and_b32 v85, 0xffff0000, v39
v_add_f32 v20, v20, v82
v_add_f32 v21, v21, v83
v_add_f32 v22, v22, v84
v_add_f32 v23, v23, v85
v_cvt_pk_bf16_f32 v38, v20, v21
v_cvt_pk_bf16_f32 v39, v22, v23
buffer_store_dwordx2 v[38:39], v6, s[52:55], s35 offen sc1
v_cvt_pk_bf16_f32 v80, v24, v25
v_cvt_pk_bf16_f32 v81, v26, v27
v_lshlrev_b32 v24, 16, v80
v_and_b32 v25, 0xffff0000, v80
v_lshlrev_b32 v26, 16, v81
v_and_b32 v27, 0xffff0000, v81
v_lshlrev_b32 v82, 16, v40
v_and_b32 v83, 0xffff0000, v40
v_lshlrev_b32 v84, 16, v41
v_and_b32 v85, 0xffff0000, v41
v_add_f32 v24, v24, v82
v_add_f32 v25, v25, v83
v_add_f32 v26, v26, v84
v_add_f32 v27, v27, v85
v_cvt_pk_bf16_f32 v40, v24, v25
v_cvt_pk_bf16_f32 v41, v26, v27
buffer_store_dwordx2 v[40:41], v6, s[52:55], s36 offen sc1
outb2_exit1:
s_endpgm
.section .rodata,"a"
.p2align 6
.amdhsa_kernel prep_kernel
  .amdhsa_next_free_vgpr 80
  .amdhsa_next_free_sgpr 64
  .amdhsa_accum_offset 80
  .amdhsa_group_segment_fixed_size 0
  .amdhsa_kernarg_size 104
  .amdhsa_user_sgpr_count 2
  .amdhsa_user_sgpr_kernarg_segment_ptr 1
  .amdhsa_system_sgpr_workgroup_id_x 1
  .amdhsa_float_denorm_mode_32 3
.end_amdhsa_kernel
.p2align 6
.amdhsa_kernel ln2_kernel
  .amdhsa_next_free_vgpr 80
  .amdhsa_next_free_sgpr 40
  .amdhsa_accum_offset 80
  .amdhsa_group_segment_fixed_size 0
  .amdhsa_kernarg_size 104
  .amdhsa_user_sgpr_count 2
  .amdhsa_user_sgpr_kernarg_segment_ptr 1
  .amdhsa_system_sgpr_workgroup_id_x 1
  .amdhsa_float_denorm_mode_32 3
.end_amdhsa_kernel
.p2align 6
.amdhsa_kernel reca_kernel
  .amdhsa_next_free_vgpr 512
  .amdhsa_next_free_sgpr 102
  .amdhsa_accum_offset 256
  .amdhsa_group_segment_fixed_size 0
  .amdhsa_kernarg_size 104
  .amdhsa_user_sgpr_count 2
  .amdhsa_user_sgpr_kernarg_segment_ptr 1
  .amdhsa_system_sgpr_workgroup_id_x 1
  .amdhsa_float_denorm_mode_32 3
.end_amdhsa_kernel
.p2align 6
.amdhsa_kernel fin_kernel
  .amdhsa_next_free_vgpr 496
  .amdhsa_next_free_sgpr 64
  .amdhsa_accum_offset 256
  .amdhsa_group_segment_fixed_size 0
  .amdhsa_kernarg_size 104
  .amdhsa_user_sgpr_count 2
  .amdhsa_user_sgpr_kernarg_segment_ptr 1
  .amdhsa_system_sgpr_workgroup_id_x 1
  .amdhsa_float_denorm_mode_32 3
.end_amdhsa_kernel
.p2align 6
.amdhsa_kernel redln1_kernel
  .amdhsa_next_free_vgpr 248
  .amdhsa_next_free_sgpr 48
  .amdhsa_accum_offset 248
  .amdhsa_group_segment_fixed_size 0
  .amdhsa_kernarg_size 104
  .amdhsa_user_sgpr_count 2
  .amdhsa_user_sgpr_kernarg_segment_ptr 1
  .amdhsa_system_sgpr_workgroup_id_x 1
  .amdhsa_float_denorm_mode_32 3
.end_amdhsa_kernel
.p2align 6
.amdhsa_kernel redln2_kernel
  .amdhsa_next_free_vgpr 248
  .amdhsa_next_free_sgpr 48
  .amdhsa_accum_offset 248
  .amdhsa_group_segment_fixed_size 0
  .amdhsa_kernarg_size 104
  .amdhsa_user_sgpr_count 2
  .amdhsa_user_sgpr_kernarg_segment_ptr 1
  .amdhsa_system_sgpr_workgroup_id_x 1
  .amdhsa_float_denorm_mode_32 3
.end_amdhsa_kernel
.p2align 6
.amdhsa_kernel qkvb_kernel
  .amdhsa_next_free_vgpr 176
  .amdhsa_next_free_sgpr 64
  .amdhsa_accum_offset 176
  .amdhsa_group_segment_fixed_size 0
  .amdhsa_kernarg_size 104
  .amdhsa_user_sgpr_count 2
  .amdhsa_user_sgpr_kernarg_segment_ptr 1
  .amdhsa_system_sgpr_workgroup_id_x 1
  .amdhsa_float_denorm_mode_32 3
.end_amdhsa_kernel
.p2align 6
.amdhsa_kernel attnb_kernel
  .amdhsa_next_free_vgpr 200
  .amdhsa_next_free_sgpr 48
  .amdhsa_accum_offset 200
  .amdhsa_group_segment_fixed_size 0
  .amdhsa_kernarg_size 104
  .amdhsa_user_sgpr_count 2
  .amdhsa_user_sgpr_kernarg_segment_ptr 1
  .amdhsa_system_sgpr_workgroup_id_x 1
  .amdhsa_float_denorm_mode_32 3
.end_amdhsa_kernel
.p2align 6
.amdhsa_kernel outb1_kernel
  .amdhsa_next_free_vgpr 128
  .amdhsa_next_free_sgpr 64
  .amdhsa_accum_offset 128
  .amdhsa_group_segment_fixed_size 0
  .amdhsa_kernarg_size 104
  .amdhsa_user_sgpr_count 2
  .amdhsa_user_sgpr_kernarg_segment_ptr 1
  .amdhsa_system_sgpr_workgroup_id_x 1
  .amdhsa_float_denorm_mode_32 3
.end_amdhsa_kernel
.p2align 6
.amdhsa_kernel outb2_kernel
  .amdhsa_next_free_vgpr 128
  .amdhsa_next_free_sgpr 64
  .amdhsa_accum_offset 128
  .amdhsa_group_segment_fixed_size 0
  .amdhsa_kernarg_size 104
  .amdhsa_user_sgpr_count 2
  .amdhsa_user_sgpr_kernarg_segment_ptr 1
  .amdhsa_system_sgpr_workgroup_id_x 1
  .amdhsa_float_denorm_mode_32 3
.end_amdhsa_kernel
```

```asm
; @launch kernel=prep_kernel grid=(2248,1,1) block=(256,1,1) lds=18944
; @launch kernel=reca_kernel grid=(256,1,1) block=(256,1,1) lds=81920
; @launch kernel=fin_kernel grid=(256,1,1) block=(256,1,1) lds=98304
; @launch kernel=redln1_kernel grid=(256,1,1) block=(128,1,1) lds=128
; @launch kernel=qkvb_kernel grid=(256,1,1) block=(256,1,1) lds=81920
; @launch kernel=attnb_kernel grid=(256,1,1) block=(256,1,1) lds=0
; @launch kernel=outb1_kernel grid=(256,1,1) block=(256,1,1) lds=61440
; @launch kernel=ln2_kernel grid=(128,1,1) block=(256,1,1) lds=512
; @launch kernel=reca_kernel grid=(256,1,1) block=(256,1,1) lds=81920
; @launch kernel=fin_kernel grid=(256,1,1) block=(256,1,1) lds=98304
; @launch kernel=redln2_kernel grid=(256,1,1) block=(128,1,1) lds=128
; @launch kernel=qkvb_kernel grid=(256,1,1) block=(256,1,1) lds=81920
; @launch kernel=attnb_kernel grid=(256,1,1) block=(256,1,1) lds=0
; @launch kernel=outb2_kernel grid=(256,1,1) block=(256,1,1) lds=61440
.amdgcn_target "amdgcn-amd-amdhsa--gfx950"
.text
.globl prep_kernel
.p2align 8
.type prep_kernel,@function
prep_kernel:
s_cmp_ge_u32 s2, 128
s_cbranch_scc1 prep_notln5
s_load_dwordx2 s[12:13], s[0:1], 96
s_load_dwordx2 s[14:15], s[0:1], 0
v_lshrrev_b32 v2, 6, v0
v_and_b32 v3, 63, v0
s_nop 0
v_readfirstlane_b32 s16, v2
s_waitcnt lgkmcnt(0)
s_mov_b32 s4, s12
s_mov_b32 s5, s13
s_mov_b32 s6, 0x10000000
s_mov_b32 s7, 0x20000
s_mov_b32 s8, s14
s_mov_b32 s9, s15
s_mov_b32 s10, 2621440
s_mov_b32 s11, 0x20000
s_mov_b32 s20, 0
v_and_b32 v2, 15, v3
v_lshrrev_b32 v4, 4, v3
s_lshl_b32 s17, s2, 4
v_add_u32 v1, s17, v2
v_mul_u32_u24 v1, 1280, v1
v_lshl_add_u32 v1, v4, 4, v1
s_mul_i32 s17, s16, 320
s_add_u32 s20, s20, s17
buffer_load_dwordx4 v[8:11], v1, s[8:11], s20 offen offset:0
buffer_load_dwordx4 v[12:15], v1, s[8:11], s20 offen offset:64
buffer_load_dwordx4 v[16:19], v1, s[8:11], s20 offen offset:128
buffer_load_dwordx4 v[20:23], v1, s[8:11], s20 offen offset:192
buffer_load_dwordx4 v[24:27], v1, s[8:11], s20 offen offset:256
s_sub_u32 s21, 0, s12
s_and_b32 s21, s21, 0x1fffff
s_add_u32 s21, s21, 2097152
v_mov_b32 v68, -1
v_mov_b32 v69, -1
v_mov_b32 v70, -1
v_mov_b32 v71, -1
v_lshlrev_b32 v72, 4, v0
s_mul_i32 s22, s2, 12096
s_add_u32 s22, s22, 0
s_mul_i32 s23, s2, 12288
s_add_u32 s23, s23, s21
buffer_store_dwordx4 v[68:71], v72, s[4:7], s22 offen sc1
s_add_u32 s22, s22, 4096
buffer_store_dwordx4 v[68:71], v72, s[4:7], s22 offen sc1
s_add_u32 s22, s22, 4096
v_mov_b32 v73, 0x80000000
v_cmp_gt_u32 vcc, 244, v0
s_nop 1
v_cndmask_b32 v73, v73, v72, vcc
buffer_store_dwordx4 v[68:71], v73, s[4:7], s22 offen
buffer_store_dwordx4 v[68:71], v72, s[4:7], s23 offen sc1
s_add_u32 s23, s23, 4096
buffer_store_dwordx4 v[68:71], v72, s[4:7], s23 offen sc1
s_add_u32 s23, s23, 4096
buffer_store_dwordx4 v[68:71], v72, s[4:7], s23 offen sc1
s_add_u32 s23, s23, 4096
s_mul_i32 s23, s2, 2048
s_add_u32 s23, s23, s21
s_add_u32 s23, s23, 1572864
v_mov_b32 v73, 0x80000000
v_cmp_gt_u32 vcc, 128, v0
s_nop 1
v_cndmask_b32 v73, v73, v72, vcc
buffer_store_dwordx4 v[68:71], v73, s[4:7], s23 offen sc1
v_lshlrev_b32 v5, 2, v2
s_lshl_b32 s17, s16, 6
v_add_u32 v1, s17, v5
s_waitcnt vmcnt(7)
v_lshlrev_b32 v28, 16, v8
v_and_b32 v29, 0xffff0000, v8
v_lshlrev_b32 v30, 16, v9
v_and_b32 v31, 0xffff0000, v9
v_lshlrev_b32 v32, 16, v10
v_and_b32 v33, 0xffff0000, v10
v_lshlrev_b32 v34, 16, v11
v_and_b32 v35, 0xffff0000, v11
v_lshlrev_b32 v36, 16, v12
v_and_b32 v37, 0xffff0000, v12
v_lshlrev_b32 v38, 16, v13
v_and_b32 v39, 0xffff0000, v13
v_lshlrev_b32 v40, 16, v14
v_and_b32 v41, 0xffff0000, v14
v_lshlrev_b32 v42, 16, v15
v_and_b32 v43, 0xffff0000, v15
v_lshlrev_b32 v44, 16, v16
v_and_b32 v45, 0xffff0000, v16
v_lshlrev_b32 v46, 16, v17
v_and_b32 v47, 0xffff0000, v17
v_lshlrev_b32 v48, 16, v18
v_and_b32 v49, 0xffff0000, v18
v_lshlrev_b32 v50, 16, v19
v_and_b32 v51, 0xffff0000, v19
v_lshlrev_b32 v52, 16, v20
v_and_b32 v53, 0xffff0000, v20
v_lshlrev_b32 v54, 16, v21
v_and_b32 v55, 0xffff0000, v21
v_lshlrev_b32 v56, 16, v22
v_and_b32 v57, 0xffff0000, v22
v_lshlrev_b32 v58, 16, v23
v_and_b32 v59, 0xffff0000, v23
v_lshlrev_b32 v60, 16, v24
v_and_b32 v61, 0xffff0000, v24
v_lshlrev_b32 v62, 16, v25
v_and_b32 v63, 0xffff0000, v25
v_lshlrev_b32 v64, 16, v26
v_and_b32 v65, 0xffff0000, v26
v_lshlrev_b32 v66, 16, v27
v_and_b32 v67, 0xffff0000, v27
v_pk_add_f32 v[6:7], v[28:29], v[30:31]
v_pk_add_f32 v[6:7], v[6:7], v[32:33]
v_pk_add_f32 v[6:7], v[6:7], v[34:35]
v_pk_add_f32 v[6:7], v[6:7], v[36:37]
v_pk_add_f32 v[6:7], v[6:7], v[38:39]
v_pk_add_f32 v[6:7], v[6:7], v[40:41]
v_pk_add_f32 v[6:7], v[6:7], v[42:43]
v_pk_add_f32 v[6:7], v[6:7], v[44:45]
v_pk_add_f32 v[6:7], v[6:7], v[46:47]
v_pk_add_f32 v[6:7], v[6:7], v[48:49]
v_pk_add_f32 v[6:7], v[6:7], v[50:51]
v_pk_add_f32 v[6:7], v[6:7], v[52:53]
v_pk_add_f32 v[6:7], v[6:7], v[54:55]
v_pk_add_f32 v[6:7], v[6:7], v[56:57]
v_pk_add_f32 v[6:7], v[6:7], v[58:59]
v_pk_add_f32 v[6:7], v[6:7], v[60:61]
v_pk_add_f32 v[6:7], v[6:7], v[62:63]
v_pk_add_f32 v[6:7], v[6:7], v[64:65]
v_pk_add_f32 v[6:7], v[6:7], v[66:67]
v_add_f32 v4, v6, v7
v_mov_b32 v2, v4
s_nop 1
v_permlane32_swap_b32 v4, v2
v_add_f32 v4, v4, v2
v_mov_b32 v2, v4
s_nop 1
v_permlane16_swap_b32 v4, v2
v_add_f32 v4, v4, v2
ds_write_b32 v1, v4 offset:0
s_waitcnt lgkmcnt(0)
s_barrier
ds_read_b32 v4, v5 offset:0
ds_read_b32 v2, v5 offset:64
ds_read_b32 v3, v5 offset:128
ds_read_b32 v6, v5 offset:192
s_waitcnt lgkmcnt(0)
v_add_f32 v4, v4, v2
v_add_f32 v3, v3, v6
v_add_f32 v4, v4, v3
v_mul_f32 v4, 0x3acccccd, v4
v_sub_f32 v28, v28, v4
v_sub_f32 v29, v29, v4
v_sub_f32 v30, v30, v4
v_sub_f32 v31, v31, v4
v_sub_f32 v32, v32, v4
v_sub_f32 v33, v33, v4
v_sub_f32 v34, v34, v4
v_sub_f32 v35, v35, v4
v_sub_f32 v36, v36, v4
v_sub_f32 v37, v37, v4
v_sub_f32 v38, v38, v4
v_sub_f32 v39, v39, v4
v_sub_f32 v40, v40, v4
v_sub_f32 v41, v41, v4
v_sub_f32 v42, v42, v4
v_sub_f32 v43, v43, v4
v_sub_f32 v44, v44, v4
v_sub_f32 v45, v45, v4
v_sub_f32 v46, v46, v4
v_sub_f32 v47, v47, v4
v_sub_f32 v48, v48, v4
v_sub_f32 v49, v49, v4
v_sub_f32 v50, v50, v4
v_sub_f32 v51, v51, v4
v_sub_f32 v52, v52, v4
v_sub_f32 v53, v53, v4
v_sub_f32 v54, v54, v4
v_sub_f32 v55, v55, v4
v_sub_f32 v56, v56, v4
v_sub_f32 v57, v57, v4
v_sub_f32 v58, v58, v4
v_sub_f32 v59, v59, v4
v_sub_f32 v60, v60, v4
v_sub_f32 v61, v61, v4
v_sub_f32 v62, v62, v4
v_sub_f32 v63, v63, v4
v_sub_f32 v64, v64, v4
v_sub_f32 v65, v65, v4
v_sub_f32 v66, v66, v4
v_sub_f32 v67, v67, v4
v_mul_f32 v6, v28, v28
v_mul_f32 v7, v29, v29
v_fmac_f32 v6, v30, v30
v_fmac_f32 v7, v31, v31
v_fmac_f32 v6, v32, v32
v_fmac_f32 v7, v33, v33
v_fmac_f32 v6, v34, v34
v_fmac_f32 v7, v35, v35
v_fmac_f32 v6, v36, v36
v_fmac_f32 v7, v37, v37
v_fmac_f32 v6, v38, v38
v_fmac_f32 v7, v39, v39
v_fmac_f32 v6, v40, v40
v_fmac_f32 v7, v41, v41
v_fmac_f32 v6, v42, v42
v_fmac_f32 v7, v43, v43
v_fmac_f32 v6, v44, v44
v_fmac_f32 v7, v45, v45
v_fmac_f32 v6, v46, v46
v_fmac_f32 v7, v47, v47
v_fmac_f32 v6, v48, v48
v_fmac_f32 v7, v49, v49
v_fmac_f32 v6, v50, v50
v_fmac_f32 v7, v51, v51
v_fmac_f32 v6, v52, v52
v_fmac_f32 v7, v53, v53
v_fmac_f32 v6, v54, v54
v_fmac_f32 v7, v55, v55
v_fmac_f32 v6, v56, v56
v_fmac_f32 v7, v57, v57
v_fmac_f32 v6, v58, v58
v_fmac_f32 v7, v59, v59
v_fmac_f32 v6, v60, v60
v_fmac_f32 v7, v61, v61
v_fmac_f32 v6, v62, v62
v_fmac_f32 v7, v63, v63
v_fmac_f32 v6, v64, v64
v_fmac_f32 v7, v65, v65
v_fmac_f32 v6, v66, v66
v_fmac_f32 v7, v67, v67
v_add_f32 v4, v6, v7
v_mov_b32 v2, v4
s_nop 1
v_permlane32_swap_b32 v4, v2
v_add_f32 v4, v4, v2
v_mov_b32 v2, v4
s_nop 1
v_permlane16_swap_b32 v4, v2
v_add_f32 v4, v4, v2
ds_write_b32 v1, v4 offset:256
s_waitcnt lgkmcnt(0)
s_barrier
ds_read_b32 v4, v5 offset:256
ds_read_b32 v2, v5 offset:320
ds_read_b32 v3, v5 offset:384
ds_read_b32 v6, v5 offset:448
s_waitcnt lgkmcnt(0)
v_add_f32 v4, v4, v2
v_add_f32 v3, v3, v6
v_add_f32 v4, v4, v3
v_mov_b32 v2, 0x3727c5ac
v_fmac_f32 v2, 0x3acccccd, v4
v_rsq_f32 v4, v2
s_nop 0
v_mul_f32 v28, v28, v4
v_mul_f32 v29, v29, v4
v_mul_f32 v30, v30, v4
v_mul_f32 v31, v31, v4
v_mul_f32 v32, v32, v4
v_mul_f32 v33, v33, v4
v_mul_f32 v34, v34, v4
v_mul_f32 v35, v35, v4
v_mul_f32 v36, v36, v4
v_mul_f32 v37, v37, v4
v_mul_f32 v38, v38, v4
v_mul_f32 v39, v39, v4
v_mul_f32 v40, v40, v4
v_mul_f32 v41, v41, v4
v_mul_f32 v42, v42, v4
v_mul_f32 v43, v43, v4
v_mul_f32 v44, v44, v4
v_mul_f32 v45, v45, v4
v_mul_f32 v46, v46, v4
v_mul_f32 v47, v47, v4
v_mul_f32 v48, v48, v4
v_mul_f32 v49, v49, v4
v_mul_f32 v50, v50, v4
v_mul_f32 v51, v51, v4
v_mul_f32 v52, v52, v4
v_mul_f32 v53, v53, v4
v_mul_f32 v54, v54, v4
v_mul_f32 v55, v55, v4
v_mul_f32 v56, v56, v4
v_mul_f32 v57, v57, v4
v_mul_f32 v58, v58, v4
v_mul_f32 v59, v59, v4
v_mul_f32 v60, v60, v4
v_mul_f32 v61, v61, v4
v_mul_f32 v62, v62, v4
v_mul_f32 v63, v63, v4
v_mul_f32 v64, v64, v4
v_mul_f32 v65, v65, v4
v_mul_f32 v66, v66, v4
v_mul_f32 v67, v67, v4
v_cvt_pk_bf16_f32 v8, v28, v29
v_cvt_pk_bf16_f32 v9, v30, v31
v_cvt_pk_bf16_f32 v10, v32, v33
v_cvt_pk_bf16_f32 v11, v34, v35
v_cvt_pk_bf16_f32 v12, v36, v37
v_cvt_pk_bf16_f32 v13, v38, v39
v_cvt_pk_bf16_f32 v14, v40, v41
v_cvt_pk_bf16_f32 v15, v42, v43
v_cvt_pk_bf16_f32 v16, v44, v45
v_cvt_pk_bf16_f32 v17, v46, v47
v_cvt_pk_bf16_f32 v18, v48, v49
v_cvt_pk_bf16_f32 v19, v50, v51
v_cvt_pk_bf16_f32 v20, v52, v53
v_cvt_pk_bf16_f32 v21, v54, v55
v_cvt_pk_bf16_f32 v22, v56, v57
v_cvt_pk_bf16_f32 v23, v58, v59
v_cvt_pk_bf16_f32 v24, v60, v61
v_cvt_pk_bf16_f32 v25, v62, v63
v_cvt_pk_bf16_f32 v26, v64, v65
v_cvt_pk_bf16_f32 v27, v66, v67
v_and_b32 v3, 63, v0
v_lshlrev_b32 v1, 4, v3
s_mul_i32 s17, s2, 20480
s_mul_i32 s18, s16, 5120
s_add_u32 s17, s17, s18
s_add_u32 s17, s17, 84934656
buffer_store_dwordx4 v[8:11], v1, s[4:7], s17 offen offset:0 sc1
buffer_store_dwordx4 v[12:15], v1, s[4:7], s17 offen offset:1024 sc1
buffer_store_dwordx4 v[16:19], v1, s[4:7], s17 offen offset:2048 sc1
buffer_store_dwordx4 v[20:23], v1, s[4:7], s17 offen offset:3072 sc1
s_add_u32 s17, s17, 4096
buffer_store_dwordx4 v[24:27], v1, s[4:7], s17 offen offset:0 sc1
s_endpgm
prep_notln5:
s_sub_u32 s2, s2, 128
s_cmp_ge_u32 s2, 2120
s_cbranch_scc1 prep_exit1
s_load_dwordx2 s[12:13], s[0:1], 96
s_load_dwordx4 s[16:19], s[0:1], 16
s_load_dwordx4 s[20:23], s[0:1], 32
s_load_dwordx4 s[24:27], s[0:1], 64
v_lshrrev_b32 v6, 6, v0
v_and_b32 v1, 63, v0
s_nop 0
v_readfirstlane_b32 s14, v6
v_lshlrev_b32 v5, 4, v1
s_lshl_b32 s15, s2, 2
s_nop 1
s_add_u32 s15, s15, s14
s_add_u32 s28, s15, 7680
s_sub_u32 s29, s15, 800
s_cmp_lt_u32 s15, 800
s_cselect_b32 s15, s28, s29
s_waitcnt lgkmcnt(0)
s_mov_b32 s4, s12
s_mov_b32 s5, s13
s_mov_b32 s6, 0x10000000
s_mov_b32 s7, 0x20000
s_mov_b32 s11, 0x20000
v_and_b32 v2, 15, v1
v_lshrrev_b32 v3, 4, v1
s_cmp_ge_u32 s15, 5760
s_cbranch_scc1 prep_s22
s_mul_hi_u32 s31, s15, 2236963
s_mul_i32 s32, s31, 1920
s_sub_u32 s32, s15, s32
s_mul_hi_u32 s34, s32, 44739243
s_mul_i32 s33, s34, 96
s_sub_u32 s33, s32, s33
s_cmp_eq_u32 s31, 0
s_cselect_b32 s8, s16, s18
s_cselect_b32 s9, s17, s19
s_cmp_eq_u32 s31, 2
s_cselect_b32 s8, s20, s8
s_cselect_b32 s9, s21, s9
s_mov_b32 s10, 7864320
s_mul_i32 s35, s31, 7864320
s_add_u32 s35, s35, 6291456
v_lshrrev_b32 v6, 3, v1
s_lshl_b32 s36, s34, 5
v_add_u32 v6, s36, v6
s_mov_b32 s37, 12288
v_mul_lo_u32 v4, v6, s37
s_lshl_b32 s36, s33, 7
v_and_b32 v6, 7, v1
v_lshl_add_u32 v4, v6, 4, v4
v_add_u32 v4, s36, v4
v_lshrrev_b32 v6, 3, v1
v_mul_u32_u24 v12, 144, v6
v_and_b32 v6, 7, v1
v_lshl_add_u32 v12, v6, 4, v12
s_mul_i32 s36, s14, 4608
s_add_u32 s36, s36, 512
v_add_u32 v12, s36, v12
s_mov_b32 s29, 0
buffer_load_dwordx4 v[16:19], v4, s[8:11], s29 offen
s_mov_b32 s29, 98304
buffer_load_dwordx4 v[20:23], v4, s[8:11], s29 offen
s_mov_b32 s29, 196608
buffer_load_dwordx4 v[24:27], v4, s[8:11], s29 offen
s_mov_b32 s29, 294912
buffer_load_dwordx4 v[28:31], v4, s[8:11], s29 offen
v_bfe_u32 v6, v1, 2, 2
v_lshlrev_b32 v13, 3, v3
v_add_u32 v13, v13, v6
v_mul_u32_u24 v13, 144, v13
v_and_b32 v6, 3, v1
v_lshl_add_u32 v13, v6, 3, v13
v_add_u32 v13, s36, v13
s_waitcnt vmcnt(3)
ds_write_b128 v12, v[16:19] offset:0
s_waitcnt vmcnt(2)
ds_write_b128 v12, v[20:23] offset:1152
s_waitcnt vmcnt(1)
ds_write_b128 v12, v[24:27] offset:2304
s_waitcnt vmcnt(0)
ds_write_b128 v12, v[28:31] offset:3456
s_waitcnt lgkmcnt(0)
ds_read_b64_tr_b16 v[48:49], v13 offset:0
ds_read_b64_tr_b16 v[50:51], v13 offset:576
ds_read_b64_tr_b16 v[52:53], v13 offset:32
ds_read_b64_tr_b16 v[54:55], v13 offset:608
ds_read_b64_tr_b16 v[56:57], v13 offset:64
ds_read_b64_tr_b16 v[58:59], v13 offset:640
ds_read_b64_tr_b16 v[60:61], v13 offset:96
ds_read_b64_tr_b16 v[62:63], v13 offset:672
s_waitcnt lgkmcnt(6)
s_lshl_b32 s30, s33, 2
s_add_u32 s30, s30, 0
s_mul_i32 s30, s30, 20
s_add_u32 s30, s30, s34
s_lshl_b32 s30, s30, 10
s_add_u32 s30, s30, s35
buffer_store_dwordx4 v[48:51], v5, s[4:7], s30 offen sc1
s_waitcnt lgkmcnt(4)
s_lshl_b32 s30, s33, 2
s_add_u32 s30, s30, 1
s_mul_i32 s30, s30, 20
s_add_u32 s30, s30, s34
s_lshl_b32 s30, s30, 10
s_add_u32 s30, s30, s35
buffer_store_dwordx4 v[52:55], v5, s[4:7], s30 offen sc1
s_waitcnt lgkmcnt(2)
s_lshl_b32 s30, s33, 2
s_add_u32 s30, s30, 2
s_mul_i32 s30, s30, 20
s_add_u32 s30, s30, s34
s_lshl_b32 s30, s30, 10
s_add_u32 s30, s30, s35
buffer_store_dwordx4 v[56:59], v5, s[4:7], s30 offen sc1
s_waitcnt lgkmcnt(0)
s_lshl_b32 s30, s33, 2
s_add_u32 s30, s30, 3
s_mul_i32 s30, s30, 20
s_add_u32 s30, s30, s34
s_lshl_b32 s30, s30, 10
s_add_u32 s30, s30, s35
buffer_store_dwordx4 v[60:63], v5, s[4:7], s30 offen sc1
s_branch prep_exit1
prep_s22:
s_sub_u32 s15, s15, 5760
s_cmp_ge_u32 s15, 1920
s_cbranch_scc1 prep_s33
s_mul_hi_u32 s34, s15, 429496730
s_mul_i32 s33, s34, 10
s_sub_u32 s33, s15, s33
s_mov_b32 s8, s22
s_mov_b32 s9, s23
s_mov_b32 s10, 7864320
v_lshrrev_b32 v6, 3, v1
s_lshl_b32 s36, s34, 5
v_add_u32 v6, s36, v6
v_mul_u32_u24 v4, 1280, v6
s_lshl_b32 s36, s33, 7
v_and_b32 v6, 7, v1
v_lshl_add_u32 v4, v6, 4, v4
v_add_u32 v4, s36, v4
v_lshrrev_b32 v6, 3, v1
v_mul_u32_u24 v12, 144, v6
v_and_b32 v6, 7, v1
v_lshl_add_u32 v12, v6, 4, v12
s_mul_i32 s36, s14, 4608
s_add_u32 s36, s36, 512
v_add_u32 v12, s36, v12
s_mov_b32 s29, 0
buffer_load_dwordx4 v[16:19], v4, s[8:11], s29 offen
s_mov_b32 s29, 10240
buffer_load_dwordx4 v[20:23], v4, s[8:11], s29 offen
s_mov_b32 s29, 20480
buffer_load_dwordx4 v[24:27], v4, s[8:11], s29 offen
s_mov_b32 s29, 30720
buffer_load_dwordx4 v[28:31], v4, s[8:11], s29 offen
v_bfe_u32 v6, v1, 2, 2
v_lshlrev_b32 v13, 2, v3
v_add_u32 v13, v13, v6
v_mul_u32_u24 v13, 144, v13
v_and_b32 v6, 3, v1
v_lshl_add_u32 v13, v6, 4, v13
v_add_u32 v13, s36, v13
s_waitcnt vmcnt(3)
ds_write_b128 v12, v[16:19] offset:0
s_waitcnt vmcnt(2)
ds_write_b128 v12, v[20:23] offset:1152
s_waitcnt vmcnt(1)
ds_write_b128 v12, v[24:27] offset:2304
s_waitcnt vmcnt(0)
ds_write_b128 v12, v[28:31] offset:3456
s_waitcnt lgkmcnt(0)
ds_read_b64_tr_b16 v[48:49], v13 offset:0
ds_read_b64_tr_b16 v[50:51], v13 offset:2304
ds_read_b64_tr_b16 v[52:53], v13 offset:8
ds_read_b64_tr_b16 v[54:55], v13 offset:2312
ds_read_b64_tr_b16 v[56:57], v13 offset:64
ds_read_b64_tr_b16 v[58:59], v13 offset:2368
ds_read_b64_tr_b16 v[60:61], v13 offset:72
ds_read_b64_tr_b16 v[62:63], v13 offset:2376
s_waitcnt lgkmcnt(6)
s_lshl_b32 s30, s33, 2
s_add_u32 s30, s30, 0
s_mul_i32 s30, s30, 192
s_add_u32 s30, s30, s34
s_lshl_b32 s30, s30, 10
s_add_u32 s30, s30, 29884416
buffer_store_dwordx4 v[48:51], v5, s[4:7], s30 offen sc1
s_waitcnt lgkmcnt(4)
s_lshl_b32 s30, s33, 2
s_add_u32 s30, s30, 1
s_mul_i32 s30, s30, 192
s_add_u32 s30, s30, s34
s_lshl_b32 s30, s30, 10
s_add_u32 s30, s30, 29884416
buffer_store_dwordx4 v[52:55], v5, s[4:7], s30 offen sc1
s_waitcnt lgkmcnt(2)
s_lshl_b32 s30, s33, 2
s_add_u32 s30, s30, 2
s_mul_i32 s30, s30, 192
s_add_u32 s30, s30, s34
s_lshl_b32 s30, s30, 10
s_add_u32 s30, s30, 29884416
buffer_store_dwordx4 v[56:59], v5, s[4:7], s30 offen sc1
s_waitcnt lgkmcnt(0)
s_lshl_b32 s30, s33, 2
s_add_u32 s30, s30, 3
s_mul_i32 s30, s30, 192
s_add_u32 s30, s30, s34
s_lshl_b32 s30, s30, 10
s_add_u32 s30, s30, 29884416
buffer_store_dwordx4 v[60:63], v5, s[4:7], s30 offen sc1
s_branch prep_exit1
prep_s33:
s_sub_u32 s15, s15, 1920
s_cmp_ge_u32 s15, 600
s_cbranch_scc1 prep_s44
s_mul_hi_u32 s34, s15, 143165577
s_mul_i32 s33, s34, 30
s_sub_u32 s33, s15, s33
s_mov_b32 s8, s24
s_mov_b32 s9, s25
s_mov_b32 s10, 2457600
v_lshrrev_b32 v6, 3, v1
s_lshl_b32 s36, s34, 5
v_add_u32 v6, s36, v6
v_mul_u32_u24 v4, 3840, v6
s_lshl_b32 s36, s33, 7
v_and_b32 v6, 7, v1
v_lshl_add_u32 v4, v6, 4, v4
v_add_u32 v4, s36, v4
v_lshrrev_b32 v6, 3, v1
v_mul_u32_u24 v12, 144, v6
v_and_b32 v6, 7, v1
v_lshl_add_u32 v12, v6, 4, v12
s_mul_i32 s36, s14, 4608
s_add_u32 s36, s36, 512
v_add_u32 v12, s36, v12
s_mov_b32 s29, 0
buffer_load_dwordx4 v[16:19], v4, s[8:11], s29 offen
s_mov_b32 s29, 30720
buffer_load_dwordx4 v[20:23], v4, s[8:11], s29 offen
s_mov_b32 s29, 61440
buffer_load_dwordx4 v[24:27], v4, s[8:11], s29 offen
s_mov_b32 s29, 92160
buffer_load_dwordx4 v[28:31], v4, s[8:11], s29 offen
v_bfe_u32 v6, v1, 2, 2
v_lshlrev_b32 v13, 3, v3
v_add_u32 v13, v13, v6
v_mul_u32_u24 v13, 144, v13
v_and_b32 v6, 3, v1
v_lshl_add_u32 v13, v6, 3, v13
v_add_u32 v13, s36, v13
s_waitcnt vmcnt(3)
ds_write_b128 v12, v[16:19] offset:0
s_waitcnt vmcnt(2)
ds_write_b128 v12, v[20:23] offset:1152
s_waitcnt vmcnt(1)
ds_write_b128 v12, v[24:27] offset:2304
s_waitcnt vmcnt(0)
ds_write_b128 v12, v[28:31] offset:3456
s_waitcnt lgkmcnt(0)
ds_read_b64_tr_b16 v[48:49], v13 offset:0
ds_read_b64_tr_b16 v[50:51], v13 offset:576
ds_read_b64_tr_b16 v[52:53], v13 offset:32
ds_read_b64_tr_b16 v[54:55], v13 offset:608
ds_read_b64_tr_b16 v[56:57], v13 offset:64
ds_read_b64_tr_b16 v[58:59], v13 offset:640
ds_read_b64_tr_b16 v[60:61], v13 offset:96
ds_read_b64_tr_b16 v[62:63], v13 offset:672
s_waitcnt lgkmcnt(6)
s_lshl_b32 s30, s33, 2
s_add_u32 s30, s30, 0
s_mul_i32 s30, s30, 20
s_add_u32 s30, s30, s34
s_lshl_b32 s30, s30, 10
s_add_u32 s30, s30, 87556096
buffer_store_dwordx4 v[48:51], v5, s[4:7], s30 offen sc1
s_waitcnt lgkmcnt(4)
s_lshl_b32 s30, s33, 2
s_add_u32 s30, s30, 1
s_mul_i32 s30, s30, 20
s_add_u32 s30, s30, s34
s_lshl_b32 s30, s30, 10
s_add_u32 s30, s30, 87556096
buffer_store_dwordx4 v[52:55], v5, s[4:7], s30 offen sc1
s_waitcnt lgkmcnt(2)
s_lshl_b32 s30, s33, 2
s_add_u32 s30, s30, 2
s_mul_i32 s30, s30, 20
s_add_u32 s30, s30, s34
s_lshl_b32 s30, s30, 10
s_add_u32 s30, s30, 87556096
buffer_store_dwordx4 v[56:59], v5, s[4:7], s30 offen sc1
s_waitcnt lgkmcnt(0)
s_lshl_b32 s30, s33, 2
s_add_u32 s30, s30, 3
s_mul_i32 s30, s30, 20
s_add_u32 s30, s30, s34
s_lshl_b32 s30, s30, 10
s_add_u32 s30, s30, 87556096
buffer_store_dwordx4 v[60:63], v5, s[4:7], s30 offen sc1
s_branch prep_exit1
prep_s44:
s_sub_u32 s15, s15, 600
s_mul_hi_u32 s34, s15, 429496730
s_mul_i32 s33, s34, 10
s_sub_u32 s33, s15, s33
s_mov_b32 s8, s26
s_mov_b32 s9, s27
s_mov_b32 s10, 819200
v_lshrrev_b32 v6, 3, v1
s_lshl_b32 s36, s34, 5
v_add_u32 v6, s36, v6
v_mul_u32_u24 v4, 1280, v6
s_lshl_b32 s36, s33, 7
v_and_b32 v6, 7, v1
v_lshl_add_u32 v4, v6, 4, v4
v_add_u32 v4, s36, v4
v_lshrrev_b32 v6, 3, v1
v_mul_u32_u24 v12, 144, v6
v_and_b32 v6, 7, v1
v_lshl_add_u32 v12, v6, 4, v12
s_mul_i32 s36, s14, 4608
s_add_u32 s36, s36, 512
v_add_u32 v12, s36, v12
s_mov_b32 s29, 0
buffer_load_dwordx4 v[16:19], v4, s[8:11], s29 offen
s_mov_b32 s29, 10240
buffer_load_dwordx4 v[20:23], v4, s[8:11], s29 offen
s_mov_b32 s29, 20480
buffer_load_dwordx4 v[24:27], v4, s[8:11], s29 offen
s_mov_b32 s29, 30720
buffer_load_dwordx4 v[28:31], v4, s[8:11], s29 offen
v_bfe_u32 v6, v1, 2, 2
v_lshlrev_b32 v13, 3, v3
v_add_u32 v13, v13, v6
v_mul_u32_u24 v13, 144, v13
v_and_b32 v6, 3, v1
v_lshl_add_u32 v13, v6, 4, v13
v_add_u32 v13, s36, v13
s_waitcnt vmcnt(3)
ds_write_b128 v12, v[16:19] offset:0
s_waitcnt vmcnt(2)
ds_write_b128 v12, v[20:23] offset:1152
s_waitcnt vmcnt(1)
ds_write_b128 v12, v[24:27] offset:2304
s_waitcnt vmcnt(0)
ds_write_b128 v12, v[28:31] offset:3456
s_waitcnt lgkmcnt(0)
ds_read_b64_tr_b16 v[48:49], v13 offset:0
ds_read_b64_tr_b16 v[50:51], v13 offset:576
ds_read_b64_tr_b16 v[52:53], v13 offset:8
ds_read_b64_tr_b16 v[54:55], v13 offset:584
ds_read_b64_tr_b16 v[56:57], v13 offset:64
ds_read_b64_tr_b16 v[58:59], v13 offset:640
ds_read_b64_tr_b16 v[60:61], v13 offset:72
ds_read_b64_tr_b16 v[62:63], v13 offset:648
s_waitcnt lgkmcnt(6)
s_lshl_b32 s30, s33, 2
s_add_u32 s30, s30, 0
s_mul_i32 s30, s30, 20
s_add_u32 s30, s30, s34
s_lshl_b32 s30, s30, 10
s_add_u32 s30, s30, 90013696
buffer_store_dwordx4 v[48:51], v5, s[4:7], s30 offen sc1
s_waitcnt lgkmcnt(4)
s_lshl_b32 s30, s33, 2
s_add_u32 s30, s30, 1
s_mul_i32 s30, s30, 20
s_add_u32 s30, s30, s34
s_lshl_b32 s30, s30, 10
s_add_u32 s30, s30, 90013696
buffer_store_dwordx4 v[52:55], v5, s[4:7], s30 offen sc1
s_waitcnt lgkmcnt(2)
s_lshl_b32 s30, s33, 2
s_add_u32 s30, s30, 2
s_mul_i32 s30, s30, 20
s_add_u32 s30, s30, s34
s_lshl_b32 s30, s30, 10
s_add_u32 s30, s30, 90013696
buffer_store_dwordx4 v[56:59], v5, s[4:7], s30 offen sc1
s_waitcnt lgkmcnt(0)
s_lshl_b32 s30, s33, 2
s_add_u32 s30, s30, 3
s_mul_i32 s30, s30, 20
s_add_u32 s30, s30, s34
s_lshl_b32 s30, s30, 10
s_add_u32 s30, s30, 90013696
buffer_store_dwordx4 v[60:63], v5, s[4:7], s30 offen sc1
prep_exit1:
s_endpgm
.globl ln2_kernel
.p2align 8
.type ln2_kernel,@function
ln2_kernel:
s_cmp_ge_u32 s2, 128
s_cbranch_scc1 ln2_exit1
s_load_dwordx2 s[12:13], s[0:1], 96
s_load_dwordx2 s[14:15], s[0:1], 0
v_lshrrev_b32 v2, 6, v0
v_and_b32 v3, 63, v0
s_nop 0
v_readfirstlane_b32 s16, v2
s_waitcnt lgkmcnt(0)
s_mov_b32 s4, s12
s_mov_b32 s5, s13
s_mov_b32 s6, 0x10000000
s_mov_b32 s7, 0x20000
s_mov_b32 s8, s12
s_mov_b32 s9, s13
s_mov_b32 s10, 0x10000000
s_mov_b32 s11, 0x20000
s_mov_b32 s20, 82313216
v_and_b32 v2, 15, v3
v_lshrrev_b32 v4, 4, v3
s_lshl_b32 s17, s2, 4
v_add_u32 v1, s17, v2
v_mul_u32_u24 v1, 1280, v1
v_lshl_add_u32 v1, v4, 4, v1
s_mul_i32 s17, s16, 320
s_add_u32 s20, s20, s17
buffer_load_dwordx4 v[8:11], v1, s[8:11], s20 offen offset:0
buffer_load_dwordx4 v[12:15], v1, s[8:11], s20 offen offset:64
buffer_load_dwordx4 v[16:19], v1, s[8:11], s20 offen offset:128
buffer_load_dwordx4 v[20:23], v1, s[8:11], s20 offen offset:192
buffer_load_dwordx4 v[24:27], v1, s[8:11], s20 offen offset:256
s_sub_u32 s21, 0, s12
s_and_b32 s21, s21, 0x1fffff
s_add_u32 s21, s21, 2097152
v_mov_b32 v68, -1
v_mov_b32 v69, -1
v_mov_b32 v70, -1
v_mov_b32 v71, -1
v_lshlrev_b32 v72, 4, v0
s_mul_i32 s22, s2, 12096
s_add_u32 s22, s22, 0
s_mul_i32 s23, s2, 12288
s_add_u32 s23, s23, s21
buffer_store_dwordx4 v[68:71], v72, s[4:7], s22 offen sc1
s_add_u32 s22, s22, 4096
buffer_store_dwordx4 v[68:71], v72, s[4:7], s22 offen sc1
s_add_u32 s22, s22, 4096
v_mov_b32 v73, 0x80000000
v_cmp_gt_u32 vcc, 244, v0
s_nop 1
v_cndmask_b32 v73, v73, v72, vcc
buffer_store_dwordx4 v[68:71], v73, s[4:7], s22 offen
buffer_store_dwordx4 v[68:71], v72, s[4:7], s23 offen sc1
s_add_u32 s23, s23, 4096
buffer_store_dwordx4 v[68:71], v72, s[4:7], s23 offen sc1
s_add_u32 s23, s23, 4096
buffer_store_dwordx4 v[68:71], v72, s[4:7], s23 offen sc1
s_add_u32 s23, s23, 4096
s_mul_i32 s23, s2, 2048
s_add_u32 s23, s23, s21
s_add_u32 s23, s23, 1572864
v_mov_b32 v73, 0x80000000
v_cmp_gt_u32 vcc, 128, v0
s_nop 1
v_cndmask_b32 v73, v73, v72, vcc
buffer_store_dwordx4 v[68:71], v73, s[4:7], s23 offen sc1
v_lshlrev_b32 v5, 2, v2
s_lshl_b32 s17, s16, 6
v_add_u32 v1, s17, v5
s_waitcnt vmcnt(7)
v_lshlrev_b32 v28, 16, v8
v_and_b32 v29, 0xffff0000, v8
v_lshlrev_b32 v30, 16, v9
v_and_b32 v31, 0xffff0000, v9
v_lshlrev_b32 v32, 16, v10
v_and_b32 v33, 0xffff0000, v10
v_lshlrev_b32 v34, 16, v11
v_and_b32 v35, 0xffff0000, v11
v_lshlrev_b32 v36, 16, v12
v_and_b32 v37, 0xffff0000, v12
v_lshlrev_b32 v38, 16, v13
v_and_b32 v39, 0xffff0000, v13
v_lshlrev_b32 v40, 16, v14
v_and_b32 v41, 0xffff0000, v14
v_lshlrev_b32 v42, 16, v15
v_and_b32 v43, 0xffff0000, v15
v_lshlrev_b32 v44, 16, v16
v_and_b32 v45, 0xffff0000, v16
v_lshlrev_b32 v46, 16, v17
v_and_b32 v47, 0xffff0000, v17
v_lshlrev_b32 v48, 16, v18
v_and_b32 v49, 0xffff0000, v18
v_lshlrev_b32 v50, 16, v19
v_and_b32 v51, 0xffff0000, v19
v_lshlrev_b32 v52, 16, v20
v_and_b32 v53, 0xffff0000, v20
v_lshlrev_b32 v54, 16, v21
v_and_b32 v55, 0xffff0000, v21
v_lshlrev_b32 v56, 16, v22
v_and_b32 v57, 0xffff0000, v22
v_lshlrev_b32 v58, 16, v23
v_and_b32 v59, 0xffff0000, v23
v_lshlrev_b32 v60, 16, v24
v_and_b32 v61, 0xffff0000, v24
v_lshlrev_b32 v62, 16, v25
v_and_b32 v63, 0xffff0000, v25
v_lshlrev_b32 v64, 16, v26
v_and_b32 v65, 0xffff0000, v26
v_lshlrev_b32 v66, 16, v27
v_and_b32 v67, 0xffff0000, v27
v_pk_add_f32 v[6:7], v[28:29], v[30:31]
v_pk_add_f32 v[6:7], v[6:7], v[32:33]
v_pk_add_f32 v[6:7], v[6:7], v[34:35]
v_pk_add_f32 v[6:7], v[6:7], v[36:37]
v_pk_add_f32 v[6:7], v[6:7], v[38:39]
v_pk_add_f32 v[6:7], v[6:7], v[40:41]
v_pk_add_f32 v[6:7], v[6:7], v[42:43]
v_pk_add_f32 v[6:7], v[6:7], v[44:45]
v_pk_add_f32 v[6:7], v[6:7], v[46:47]
v_pk_add_f32 v[6:7], v[6:7], v[48:49]
v_pk_add_f32 v[6:7], v[6:7], v[50:51]
v_pk_add_f32 v[6:7], v[6:7], v[52:53]
v_pk_add_f32 v[6:7], v[6:7], v[54:55]
v_pk_add_f32 v[6:7], v[6:7], v[56:57]
v_pk_add_f32 v[6:7], v[6:7], v[58:59]
v_pk_add_f32 v[6:7], v[6:7], v[60:61]
v_pk_add_f32 v[6:7], v[6:7], v[62:63]
v_pk_add_f32 v[6:7], v[6:7], v[64:65]
v_pk_add_f32 v[6:7], v[6:7], v[66:67]
v_add_f32 v4, v6, v7
v_mov_b32 v2, v4
s_nop 1
v_permlane32_swap_b32 v4, v2
v_add_f32 v4, v4, v2
v_mov_b32 v2, v4
s_nop 1
v_permlane16_swap_b32 v4, v2
v_add_f32 v4, v4, v2
ds_write_b32 v1, v4 offset:0
s_waitcnt lgkmcnt(0)
s_barrier
ds_read_b32 v4, v5 offset:0
ds_read_b32 v2, v5 offset:64
ds_read_b32 v3, v5 offset:128
ds_read_b32 v6, v5 offset:192
s_waitcnt lgkmcnt(0)
v_add_f32 v4, v4, v2
v_add_f32 v3, v3, v6
v_add_f32 v4, v4, v3
v_mul_f32 v4, 0x3acccccd, v4
v_sub_f32 v28, v28, v4
v_sub_f32 v29, v29, v4
v_sub_f32 v30, v30, v4
v_sub_f32 v31, v31, v4
v_sub_f32 v32, v32, v4
v_sub_f32 v33, v33, v4
v_sub_f32 v34, v34, v4
v_sub_f32 v35, v35, v4
v_sub_f32 v36, v36, v4
v_sub_f32 v37, v37, v4
v_sub_f32 v38, v38, v4
v_sub_f32 v39, v39, v4
v_sub_f32 v40, v40, v4
v_sub_f32 v41, v41, v4
v_sub_f32 v42, v42, v4
v_sub_f32 v43, v43, v4
v_sub_f32 v44, v44, v4
v_sub_f32 v45, v45, v4
v_sub_f32 v46, v46, v4
v_sub_f32 v47, v47, v4
v_sub_f32 v48, v48, v4
v_sub_f32 v49, v49, v4
v_sub_f32 v50, v50, v4
v_sub_f32 v51, v51, v4
v_sub_f32 v52, v52, v4
v_sub_f32 v53, v53, v4
v_sub_f32 v54, v54, v4
v_sub_f32 v55, v55, v4
v_sub_f32 v56, v56, v4
v_sub_f32 v57, v57, v4
v_sub_f32 v58, v58, v4
v_sub_f32 v59, v59, v4
v_sub_f32 v60, v60, v4
v_sub_f32 v61, v61, v4
v_sub_f32 v62, v62, v4
v_sub_f32 v63, v63, v4
v_sub_f32 v64, v64, v4
v_sub_f32 v65, v65, v4
v_sub_f32 v66, v66, v4
v_sub_f32 v67, v67, v4
v_mul_f32 v6, v28, v28
v_mul_f32 v7, v29, v29
v_fmac_f32 v6, v30, v30
v_fmac_f32 v7, v31, v31
v_fmac_f32 v6, v32, v32
v_fmac_f32 v7, v33, v33
v_fmac_f32 v6, v34, v34
v_fmac_f32 v7, v35, v35
v_fmac_f32 v6, v36, v36
v_fmac_f32 v7, v37, v37
v_fmac_f32 v6, v38, v38
v_fmac_f32 v7, v39, v39
v_fmac_f32 v6, v40, v40
v_fmac_f32 v7, v41, v41
v_fmac_f32 v6, v42, v42
v_fmac_f32 v7, v43, v43
v_fmac_f32 v6, v44, v44
v_fmac_f32 v7, v45, v45
v_fmac_f32 v6, v46, v46
v_fmac_f32 v7, v47, v47
v_fmac_f32 v6, v48, v48
v_fmac_f32 v7, v49, v49
v_fmac_f32 v6, v50, v50
v_fmac_f32 v7, v51, v51
v_fmac_f32 v6, v52, v52
v_fmac_f32 v7, v53, v53
v_fmac_f32 v6, v54, v54
v_fmac_f32 v7, v55, v55
v_fmac_f32 v6, v56, v56
v_fmac_f32 v7, v57, v57
v_fmac_f32 v6, v58, v58
v_fmac_f32 v7, v59, v59
v_fmac_f32 v6, v60, v60
v_fmac_f32 v7, v61, v61
v_fmac_f32 v6, v62, v62
v_fmac_f32 v7, v63, v63
v_fmac_f32 v6, v64, v64
v_fmac_f32 v7, v65, v65
v_fmac_f32 v6, v66, v66
v_fmac_f32 v7, v67, v67
v_add_f32 v4, v6, v7
v_mov_b32 v2, v4
s_nop 1
v_permlane32_swap_b32 v4, v2
v_add_f32 v4, v4, v2
v_mov_b32 v2, v4
s_nop 1
v_permlane16_swap_b32 v4, v2
v_add_f32 v4, v4, v2
ds_write_b32 v1, v4 offset:256
s_waitcnt lgkmcnt(0)
s_barrier
ds_read_b32 v4, v5 offset:256
ds_read_b32 v2, v5 offset:320
ds_read_b32 v3, v5 offset:384
ds_read_b32 v6, v5 offset:448
s_waitcnt lgkmcnt(0)
v_add_f32 v4, v4, v2
v_add_f32 v3, v3, v6
v_add_f32 v4, v4, v3
v_mov_b32 v2, 0x3727c5ac
v_fmac_f32 v2, 0x3acccccd, v4
v_rsq_f32 v4, v2
s_nop 0
v_mul_f32 v28, v28, v4
v_mul_f32 v29, v29, v4
v_mul_f32 v30, v30, v4
v_mul_f32 v31, v31, v4
v_mul_f32 v32, v32, v4
v_mul_f32 v33, v33, v4
v_mul_f32 v34, v34, v4
v_mul_f32 v35, v35, v4
v_mul_f32 v36, v36, v4
v_mul_f32 v37, v37, v4
v_mul_f32 v38, v38, v4
v_mul_f32 v39, v39, v4
v_mul_f32 v40, v40, v4
v_mul_f32 v41, v41, v4
v_mul_f32 v42, v42, v4
v_mul_f32 v43, v43, v4
v_mul_f32 v44, v44, v4
v_mul_f32 v45, v45, v4
v_mul_f32 v46, v46, v4
v_mul_f32 v47, v47, v4
v_mul_f32 v48, v48, v4
v_mul_f32 v49, v49, v4
v_mul_f32 v50, v50, v4
v_mul_f32 v51, v51, v4
v_mul_f32 v52, v52, v4
v_mul_f32 v53, v53, v4
v_mul_f32 v54, v54, v4
v_mul_f32 v55, v55, v4
v_mul_f32 v56, v56, v4
v_mul_f32 v57, v57, v4
v_mul_f32 v58, v58, v4
v_mul_f32 v59, v59, v4
v_mul_f32 v60, v60, v4
v_mul_f32 v61, v61, v4
v_mul_f32 v62, v62, v4
v_mul_f32 v63, v63, v4
v_mul_f32 v64, v64, v4
v_mul_f32 v65, v65, v4
v_mul_f32 v66, v66, v4
v_mul_f32 v67, v67, v4
v_cvt_pk_bf16_f32 v8, v28, v29
v_cvt_pk_bf16_f32 v9, v30, v31
v_cvt_pk_bf16_f32 v10, v32, v33
v_cvt_pk_bf16_f32 v11, v34, v35
v_cvt_pk_bf16_f32 v12, v36, v37
v_cvt_pk_bf16_f32 v13, v38, v39
v_cvt_pk_bf16_f32 v14, v40, v41
v_cvt_pk_bf16_f32 v15, v42, v43
v_cvt_pk_bf16_f32 v16, v44, v45
v_cvt_pk_bf16_f32 v17, v46, v47
v_cvt_pk_bf16_f32 v18, v48, v49
v_cvt_pk_bf16_f32 v19, v50, v51
v_cvt_pk_bf16_f32 v20, v52, v53
v_cvt_pk_bf16_f32 v21, v54, v55
v_cvt_pk_bf16_f32 v22, v56, v57
v_cvt_pk_bf16_f32 v23, v58, v59
v_cvt_pk_bf16_f32 v24, v60, v61
v_cvt_pk_bf16_f32 v25, v62, v63
v_cvt_pk_bf16_f32 v26, v64, v65
v_cvt_pk_bf16_f32 v27, v66, v67
v_and_b32 v3, 63, v0
v_lshlrev_b32 v1, 4, v3
s_mul_i32 s17, s2, 20480
s_mul_i32 s18, s16, 5120
s_add_u32 s17, s17, s18
s_add_u32 s17, s17, 84934656
buffer_store_dwordx4 v[8:11], v1, s[4:7], s17 offen offset:0 sc1
buffer_store_dwordx4 v[12:15], v1, s[4:7], s17 offen offset:1024 sc1
buffer_store_dwordx4 v[16:19], v1, s[4:7], s17 offen offset:2048 sc1
buffer_store_dwordx4 v[20:23], v1, s[4:7], s17 offen offset:3072 sc1
s_add_u32 s17, s17, 4096
buffer_store_dwordx4 v[24:27], v1, s[4:7], s17 offen offset:0 sc1
ln2_exit1:
s_endpgm
.globl reca_kernel
.p2align 8
.type reca_kernel,@function
reca_kernel:
s_cmp_ge_u32 s2, 256
s_cbranch_scc1 reca_exitb3
s_load_dwordx2 s[48:49], s[0:1], 96
s_load_dwordx2 s[50:51], s[0:1], 88
s_load_dwordx2 s[52:53], s[0:1], 8
s_getreg_b32 s42, hwreg(HW_REG_XCC_ID, 0, 3)
v_lshrrev_b32 v28, 6, v0
v_and_b32 v29, 63, v0
s_and_b32 s13, s2, 7
v_readfirstlane_b32 s12, v28
v_lshlrev_b32 v1, 4, v29
s_lshr_b32 s14, s2, 3
s_mov_b32 s18, 0x100000
s_waitcnt lgkmcnt(0)
s_mov_b32 s57, 0
s_mov_b32 s4, s48
s_mov_b32 s5, s49
s_mov_b32 s6, 0x10000000
s_mov_b32 s7, 0x20000
s_mov_b32 s8, s50
s_mov_b32 s9, s51
s_mov_b32 s10, 256
s_mov_b32 s11, 0x20000
v_add_u32 v2, 0x1000, v1
v_add_u32 v3, 0x2000, v1
v_mov_b32 v31, 0x80000000
s_lshl_b32 s34, s42, 3
s_lshl_b64 s[36:37], 1, s34
s_lshl_b32 s34, s13, 3
v_cmp_eq_u32 vcc, 0, v0
v_mov_b32 v30, s34
s_nop 0
v_cndmask_b32 v30, v31, v30, vcc
v_mov_b32 v44, s36
v_mov_b32 v45, s37
buffer_atomic_add_x2 v[44:45], v30, s[8:11], 0 offen
s_sub_u32 s56, 0, s48
s_and_b32 s56, s56, 0x1fffff
s_add_u32 s56, s56, 2097152
s_nop 0
s_cmp_ge_u32 s14, 24
s_cbranch_scc1 reca_proj2
s_mul_i32 s34, s14, 43
s_lshr_b32 s34, s34, 8
s_mul_i32 s35, s34, 6
s_sub_u32 s16, s14, s35
s_lshl_b32 s15, s13, 2
s_add_u32 s15, s15, s34
s_lshr_b32 s19, s12, 1
s_and_b32 s37, s12, 1
s_mul_i32 s34, s15, 12
s_lshl_b32 s35, s16, 1
s_add_u32 s34, s34, s35
s_add_u32 s34, s34, s37
s_mul_i32 s34, s34, 20480
s_mov_b32 s35, 14155776
s_cmp_eq_u32 s19, 0
s_cselect_b32 s35, 6291456, s35
s_add_u32 s35, s35, s34
s_mul_i32 s36, s19, 10240
s_add_u32 s20, s35, s36
s_sub_u32 s36, 10240, s36
s_add_u32 s21, s35, s36
s_add_u32 s22, s34, 22020096
s_mul_i32 s36, s19, 10240
s_add_u32 s22, s22, s36
buffer_load_dwordx4 a[0:3], v1, s[4:7], s20 offen offset:0
buffer_load_dwordx4 a[4:7], v1, s[4:7], s20 offen offset:1024
buffer_load_dwordx4 a[8:11], v1, s[4:7], s20 offen offset:2048
buffer_load_dwordx4 a[12:15], v1, s[4:7], s20 offen offset:3072
buffer_load_dwordx4 a[16:19], v2, s[4:7], s20 offen offset:0
buffer_load_dwordx4 a[20:23], v2, s[4:7], s20 offen offset:1024
buffer_load_dwordx4 a[24:27], v2, s[4:7], s20 offen offset:2048
buffer_load_dwordx4 a[28:31], v2, s[4:7], s20 offen offset:3072
buffer_load_dwordx4 a[32:35], v3, s[4:7], s20 offen offset:0
buffer_load_dwordx4 a[36:39], v3, s[4:7], s20 offen offset:1024
buffer_load_dwordx4 a[40:43], v1, s[4:7], s21 offen offset:0
buffer_load_dwordx4 a[44:47], v1, s[4:7], s21 offen offset:1024
buffer_load_dwordx4 a[48:51], v1, s[4:7], s21 offen offset:2048
buffer_load_dwordx4 a[52:55], v1, s[4:7], s21 offen offset:3072
buffer_load_dwordx4 a[56:59], v2, s[4:7], s21 offen offset:0
buffer_load_dwordx4 a[60:63], v2, s[4:7], s21 offen offset:1024
buffer_load_dwordx4 a[64:67], v2, s[4:7], s21 offen offset:2048
buffer_load_dwordx4 a[68:71], v2, s[4:7], s21 offen offset:3072
buffer_load_dwordx4 a[72:75], v3, s[4:7], s21 offen offset:0
buffer_load_dwordx4 a[76:79], v3, s[4:7], s21 offen offset:1024
buffer_load_dwordx4 a[80:83], v1, s[4:7], s22 offen offset:0
buffer_load_dwordx4 a[84:87], v1, s[4:7], s22 offen offset:1024
buffer_load_dwordx4 a[88:91], v1, s[4:7], s22 offen offset:2048
buffer_load_dwordx4 a[92:95], v1, s[4:7], s22 offen offset:3072
buffer_load_dwordx4 a[96:99], v2, s[4:7], s22 offen offset:0
buffer_load_dwordx4 a[100:103], v2, s[4:7], s22 offen offset:1024
buffer_load_dwordx4 a[104:107], v2, s[4:7], s22 offen offset:2048
buffer_load_dwordx4 a[108:111], v2, s[4:7], s22 offen offset:3072
buffer_load_dwordx4 a[112:115], v3, s[4:7], s22 offen offset:0
buffer_load_dwordx4 a[116:119], v3, s[4:7], s22 offen offset:1024
s_cmp_ge_u32 s14, 20
s_cbranch_scc1 reca_now24
s_cmp_ge_u32 s12, 2
s_cbranch_scc1 reca_now24
s_lshl_b32 s34, s14, 1
s_add_u32 s34, s34, s12
s_mul_i32 s34, s34, 192
s_mul_i32 s35, s13, 24
s_add_u32 s34, s34, s35
s_lshl_b32 s34, s34, 10
s_add_u32 s34, s34, 29884416
buffer_load_dwordx4 a[120:123], v1, s[4:7], s34 offen offset:0
buffer_load_dwordx4 a[124:127], v1, s[4:7], s34 offen offset:1024
buffer_load_dwordx4 a[128:131], v1, s[4:7], s34 offen offset:2048
buffer_load_dwordx4 a[132:135], v1, s[4:7], s34 offen offset:3072
buffer_load_dwordx4 a[136:139], v2, s[4:7], s34 offen offset:0
buffer_load_dwordx4 a[140:143], v2, s[4:7], s34 offen offset:1024
buffer_load_dwordx4 a[144:147], v2, s[4:7], s34 offen offset:2048
buffer_load_dwordx4 a[148:151], v2, s[4:7], s34 offen offset:3072
buffer_load_dwordx4 a[152:155], v3, s[4:7], s34 offen offset:0
buffer_load_dwordx4 a[156:159], v3, s[4:7], s34 offen offset:1024
buffer_load_dwordx4 a[160:163], v3, s[4:7], s34 offen offset:2048
buffer_load_dwordx4 a[164:167], v3, s[4:7], s34 offen offset:3072
s_add_u32 s34, s34, 12288
buffer_load_dwordx4 a[168:171], v1, s[4:7], s34 offen offset:0
buffer_load_dwordx4 a[172:175], v1, s[4:7], s34 offen offset:1024
buffer_load_dwordx4 a[176:179], v1, s[4:7], s34 offen offset:2048
buffer_load_dwordx4 a[180:183], v1, s[4:7], s34 offen offset:3072
buffer_load_dwordx4 a[184:187], v2, s[4:7], s34 offen offset:0
buffer_load_dwordx4 a[188:191], v2, s[4:7], s34 offen offset:1024
buffer_load_dwordx4 a[192:195], v2, s[4:7], s34 offen offset:2048
buffer_load_dwordx4 a[196:199], v2, s[4:7], s34 offen offset:3072
buffer_load_dwordx4 a[200:203], v3, s[4:7], s34 offen offset:0
buffer_load_dwordx4 a[204:207], v3, s[4:7], s34 offen offset:1024
buffer_load_dwordx4 a[208:211], v3, s[4:7], s34 offen offset:2048
buffer_load_dwordx4 a[212:215], v3, s[4:7], s34 offen offset:3072
reca_now24:
v_and_b32 v29, 63, v0
v_and_b32 v28, 15, v29
v_lshrrev_b32 v30, 4, v29
v_mov_b32 v32, -1
v_mov_b32 v33, -1
v_mov_b32 v34, -1
v_mov_b32 v35, -1
s_mul_i32 s34, s12, 2560
v_add_u32 v4, s34, v1
v_and_b32 v44, 31, v29
v_lshlrev_b32 v44, 4, v44
s_add_u32 s34, s34, 2048
v_add_u32 v5, s34, v44
v_and_b32 v44, 7, v29
v_lshlrev_b32 v44, 4, v44
v_lshl_add_u32 v44, v30, 7, v44
s_mul_i32 s34, s19, 5120
v_add_u32 v6, s34, v44
s_sub_u32 s34, 5120, s34
v_add_u32 v7, s34, v44
v_lshrrev_b32 v45, 3, v28
v_lshl_add_u32 v12, v45, 9, v44
s_mul_i32 s34, s19, 5120
v_add_u32 v236, s34, v12
s_sub_u32 s34, 5120, s34
v_add_u32 v237, s34, v12
v_add_u32 v13, 0x1000, v12
v_add_u32 v14, 0x2000, v12
v_cmp_gt_u32 s[54:55], 8, v28
s_lshl_b32 s34, s16, 10
s_lshl_b32 s35, s19, 7
s_add_u32 s34, s34, s35
s_and_b32 s35, s12, 1
s_lshl_b32 s36, s35, 3
s_add_u32 s34, s34, s36
v_lshlrev_b32 v44, 4, v28
v_lshl_add_u32 v45, v30, 8, v44
v_add_u32 v45, s34, v45
v_cndmask_b32 v8, v31, v45, s[54:55]
v_lshl_add_u32 v44, v30, 7, v44
v_add_u32 v45, s36, v44
v_cndmask_b32 v9, v31, v45, s[54:55]
s_lshl_b32 s34, s14, 9
v_add_u32 v45, s34, v44
v_cndmask_b32 v11, v31, v45, s[54:55]
s_mul_i32 s34, s13, 49152
s_lshr_b32 s35, s14, 3
s_lshl_b32 s35, s35, 14
s_add_u32 s34, s34, s35
s_and_b32 s35, s14, 7
s_lshl_b32 s35, s35, 10
s_add_u32 s34, s34, s35
s_lshl_b32 s35, s12, 9
s_add_u32 s34, s34, s35
v_add_u32 v45, s34, v44
v_cndmask_b32 v15, v31, v45, s[54:55]
s_cmp_lt_u32 s14, 20
s_cselect_b32 s34, 0, 0x80000000
v_or_b32 v15, s34, v15
v_lshlrev_b32 v45, 3, v29
v_cmp_gt_u32 vcc, 32, v29
s_nop 1
v_cndmask_b32 v10, v31, v45, vcc
s_sub_u32 s35, s14, 4
s_cmp_lt_u32 s14, 20
s_cselect_b32 s34, s14, s35
s_lshr_b32 s35, s34, 3
s_lshl_b32 s35, s35, 14
s_and_b32 s34, s34, 7
s_lshl_b32 s34, s34, 10
s_add_u32 s34, s34, s35
v_add_u32 v20, s34, v1
v_add_u32 v21, 49152, v20
v_add_u32 v22, 98304, v20
v_add_u32 v23, 147456, v20
v_add_u32 v24, 196608, v20
v_add_u32 v25, 245760, v20
v_add_u32 v26, 294912, v20
v_add_u32 v27, 344064, v20
v_lshrrev_b32 v44, 3, v29
v_and_b32 v44, 3, v44
v_lshlrev_b32 v44, 7, v44
v_and_b32 v45, 7, v29
v_lshl_add_u32 v44, v45, 4, v44
v_lshrrev_b32 v45, 5, v29
v_lshl_add_u32 v44, v45, 3, v44
s_lshl_b32 s34, s14, 9
s_cmp_lt_u32 s14, 20
s_cselect_b32 s34, s34, 0x80000000
v_add_u32 v16, s34, v44
v_cmp_eq_u32 vcc, 0, v29
v_mov_b32 v45, 0
s_nop 0
v_cndmask_b32 v19, v31, v45, vcc
s_lshl_b32 s34, s15, 8
s_add_u32 s34, s34, 1540096
v_and_b32 v45, 1, v29
v_lshlrev_b32 v45, 7, v45
v_add_u32 v233, s34, v45
s_lshl_b32 s34, s12, 10
s_add_u32 s34, s34, 10240
v_add_u32 v17, s34, v1
v_mov_b32 v36, 0x3f803f80
v_mov_b32 v37, 0x3f803f80
v_mov_b32 v38, 0x3f803f80
v_mov_b32 v39, 0x3f803f80
v_mov_b32 v44, 0xf149f2ca
v_cmp_gt_u32 vcc, 2, v30
s_nop 1
v_cndmask_b32 v40, 0, v44, vcc
v_mov_b32 v41, v40
v_mov_b32 v42, v40
v_mov_b32 v43, v40
v_and_b32 v44, 31, v29
v_lshlrev_b32 v44, 4, v44
v_add_u32 v45, 47972352, v44
v_add_u32 v44, 47185920, v44
v_cmp_gt_u32 vcc, 32, v29
s_nop 1
v_cndmask_b32 v238, v45, v44, vcc
s_mov_b32 s41, 0x3dd53b95
s_mul_i32 s38, s13, 40960
s_add_u32 s38, s38, 0
s_mul_i32 s39, s15, 24576
s_add_u32 s39, s39, 327680
s_mul_i32 s40, s13, 49152
s_add_u32 s40, s40, 1114112
s_mov_b32 s60, s52
s_mov_b32 s61, s53
s_mov_b32 s62, 10240
s_mov_b32 s63, 0x20000
v_and_b32 v29, 63, v0
v_and_b32 v44, 7, v29
v_mul_u32_u24 v44, 1280, v44
v_lshrrev_b32 v45, 3, v29
v_and_b32 v45, 3, v45
v_lshl_add_u32 v44, v45, 4, v44
s_mul_i32 s34, s12, 320
v_add_u32 v44, s34, v44
v_add_u32 v46, 256, v44
v_lshrrev_b32 v45, 5, v29
v_lshl_add_u32 v44, v45, 6, v44
buffer_load_dwordx4 v[128:131], v44, s[60:63], 0 offen
buffer_load_dwordx4 v[132:135], v44, s[60:63], 0 offen offset:128
buffer_load_dwordx4 v[136:139], v46, s[60:63], 0 offen
v_and_b32 v30, 7, v0
v_lshlrev_b32 v30, 3, v30
reca_cens5:
buffer_load_dwordx2 v[28:29], v30, s[8:11], 0 offen sc1
s_waitcnt vmcnt(0)
v_sad_u8 v31, v28, 0, 0
v_sad_u8 v31, v29, 0, v31
v_cmp_gt_u32 vcc, 32, v31
s_cbranch_vccz reca_censok6
s_sleep 8
s_sub_u32 s18, s18, 1
s_cbranch_scc0 reca_cens5
s_mov_b32 s18, 0
reca_censok6:
v_and_b32 v28, 0x20202020, v28
v_and_b32 v29, 0x20202020, v29
v_cmp_ne_u32 s[34:35], 0, v28
v_cmp_ne_u32 s[36:37], 0, v29
s_nop 3
s_and_b32 s34, s34, 0xff
s_and_b32 s36, s36, 0xff
s_or_b32 s35, s34, s36
s_lshr_b32 s37, s35, s13
s_and_b32 s37, s37, 1
s_xor_b32 s43, s37, 1
s_cmp_eq_u32 s57, 0
s_cselect_b32 s58, s36, s34
v_mov_b32 v31, 0x80000000
v_add_u32 v232, 0x2000, v15
s_lshr_b32 s44, s2, 4
s_lshl_b32 s44, s44, 14
s_and_b32 s34, s2, 15
s_lshl_b32 s34, s34, 9
s_add_u32 s44, s44, s34
s_add_u32 s44, s44, 1572864
s_add_u32 s44, s44, s56
s_mov_b32 s45, -1
s_mov_b32 s47, -1
s_cmp_lg_u32 s12, 2
s_cbranch_scc1 reca_noprobe7
s_add_u32 s35, s44, 0
s_memtime s[60:61]
s_waitcnt lgkmcnt(0)
buffer_load_dword v28, v19, s[4:7], s35 offen sc1
s_waitcnt vmcnt(0)
s_memtime s[62:63]
s_waitcnt lgkmcnt(0)
s_sub_u32 s36, s62, s60
s_min_u32 s45, s45, s36
s_add_u32 s35, s44, 8192
s_memtime s[60:61]
s_waitcnt lgkmcnt(0)
buffer_load_dword v28, v19, s[4:7], s35 offen sc1
s_waitcnt vmcnt(0)
s_memtime s[62:63]
s_waitcnt lgkmcnt(0)
s_sub_u32 s36, s62, s60
s_min_u32 s47, s47, s36
s_add_u32 s35, s44, 128
s_memtime s[60:61]
s_waitcnt lgkmcnt(0)
buffer_load_dword v28, v19, s[4:7], s35 offen sc1
s_waitcnt vmcnt(0)
s_memtime s[62:63]
s_waitcnt lgkmcnt(0)
s_sub_u32 s36, s62, s60
s_min_u32 s45, s45, s36
s_add_u32 s35, s44, 8320
s_memtime s[60:61]
s_waitcnt lgkmcnt(0)
buffer_load_dword v28, v19, s[4:7], s35 offen sc1
s_waitcnt vmcnt(0)
s_memtime s[62:63]
s_waitcnt lgkmcnt(0)
s_sub_u32 s36, s62, s60
s_min_u32 s47, s47, s36
s_add_u32 s35, s44, 256
s_memtime s[60:61]
s_waitcnt lgkmcnt(0)
buffer_load_dword v28, v19, s[4:7], s35 offen sc1
s_waitcnt vmcnt(0)
s_memtime s[62:63]
s_waitcnt lgkmcnt(0)
s_sub_u32 s36, s62, s60
s_min_u32 s45, s45, s36
s_add_u32 s35, s44, 8448
s_memtime s[60:61]
s_waitcnt lgkmcnt(0)
buffer_load_dword v28, v19, s[4:7], s35 offen sc1
s_waitcnt vmcnt(0)
s_memtime s[62:63]
s_waitcnt lgkmcnt(0)
s_sub_u32 s36, s62, s60
s_min_u32 s47, s47, s36
s_cmp_lt_u32 s47, s45
s_cbranch_scc0 reca_noprobe7
v_add_u32 v20, 0x2000, v20
v_add_u32 v21, 0x2000, v21
v_add_u32 v22, 0x2000, v22
v_add_u32 v23, 0x2000, v23
v_add_u32 v24, 0x2000, v24
v_add_u32 v25, 0x2000, v25
v_add_u32 v26, 0x2000, v26
v_add_u32 v27, 0x2000, v27
reca_noprobe7:
s_lshl_b32 s59, s13, 2
s_add_u32 s59, s59, s14
s_sub_u32 s59, s59, 20
v_and_b32 v29, 63, v0
v_and_b32 v28, 15, v29
v_lshrrev_b32 v30, 4, v29
v_lshlrev_b32 v92, 4, v28
v_lshl_add_u32 v92, v30, 7, v92
v_cmp_gt_u32 vcc, 8, v28
s_nop 1
v_cndmask_b32 v92, v31, v92, vcc
v_lshlrev_b32 v93, 3, v29
v_cmp_gt_u32 vcc, 32, v29
s_nop 1
v_cndmask_b32 v93, v31, v93, vcc
v_mov_b32 v82, 0xf149f2ca
v_cmp_le_u32 vcc, 2, v30
s_nop 1
v_cndmask_b32 v84, 0, v82, vcc
v_mov_b32 v85, v84
v_mov_b32 v86, v84
v_mov_b32 v87, v84
v_lshlrev_b32 v30, 2, v30
v_add_u32 v29, 0, v30
v_cmp_gt_u32 vcc, v29, v28
s_nop 1
v_cndmask_b32 v88, 0, v82, vcc
v_add_u32 v29, 1, v30
v_cmp_gt_u32 vcc, v29, v28
s_nop 1
v_cndmask_b32 v89, 0, v82, vcc
v_add_u32 v29, 2, v30
v_cmp_gt_u32 vcc, v29, v28
s_nop 1
v_cndmask_b32 v90, 0, v82, vcc
v_add_u32 v29, 3, v30
v_cmp_gt_u32 vcc, v29, v28
s_nop 1
v_cndmask_b32 v91, 0, v82, vcc
s_mov_b32 s17, 0
s_cmp_lg_u32 s12, 3
s_cbranch_scc1 reca_nopf08
s_add_u32 s37, s17, 1
reca_pf9:
buffer_load_dword v28, v233, s[4:7], 0 offen sc1
s_waitcnt vmcnt(0)
v_cmp_gt_i32 vcc, s37, v28
s_cbranch_vccz reca_pfok10
s_sleep 1
s_sub_u32 s18, s18, 1
s_cbranch_scc0 reca_pf9
s_mov_b32 s18, 0
reca_pfok10:
s_lshl_b32 s34, s15, 3
s_and_b32 s35, s17, 7
s_add_u32 s34, s34, s35
s_mul_i32 s34, s34, 12288
s_add_u32 s32, s34, 37748736
s_lshl_b32 s35, s16, 11
s_add_u32 s34, s34, s35
s_add_u32 s33, s34, 40894464
buffer_load_dwordx4 a[120:123], v1, s[4:7], s32 offen offset:0 sc1
buffer_load_dwordx4 a[124:127], v1, s[4:7], s32 offen offset:1024 sc1
buffer_load_dwordx4 a[128:131], v1, s[4:7], s32 offen offset:2048 sc1
buffer_load_dwordx4 a[132:135], v1, s[4:7], s32 offen offset:3072 sc1
buffer_load_dwordx4 a[136:139], v2, s[4:7], s32 offen offset:0 sc1
buffer_load_dwordx4 a[140:143], v2, s[4:7], s32 offen offset:1024 sc1
buffer_load_dwordx4 a[144:147], v2, s[4:7], s32 offen offset:2048 sc1
buffer_load_dwordx4 a[148:151], v2, s[4:7], s32 offen offset:3072 sc1
buffer_load_dwordx4 a[152:155], v3, s[4:7], s32 offen offset:0 sc1
buffer_load_dwordx4 a[156:159], v3, s[4:7], s32 offen offset:1024 sc1
buffer_load_dwordx4 a[160:163], v3, s[4:7], s32 offen offset:2048 sc1
buffer_load_dwordx4 a[164:167], v3, s[4:7], s32 offen offset:3072 sc1
buffer_load_dwordx4 a[168:171], v1, s[4:7], s33 offen offset:0 sc1
buffer_load_dwordx4 a[172:175], v1, s[4:7], s33 offen offset:1024 sc1
s_waitcnt vmcnt(0)
reca_nopf08:
s_cmp_lg_u32 s43, 0
s_cbranch_scc1 reca_slow11
s_cmp_ge_u32 s14, 20
s_cbranch_scc1 reca_twinf12
s_branch reca_gotmem15
reca_step14:
s_and_b32 s34, s17, 3
s_mul_i32 s20, s34, 10240
s_add_u32 s20, s20, s38
s_sleep 2
buffer_load_dwordx4 v[128:131], v4, s[4:7], s20 offen sc1
buffer_load_dwordx4 v[132:135], v4, s[4:7], s20 offen offset:1024 sc1
buffer_load_dwordx4 v[136:139], v5, s[4:7], s20 offen sc1
s_waitcnt vmcnt(2)
v_max_u32 v29, v128, v130
v_cmp_eq_u32 vcc, -1, v29
s_cbranch_vccnz reca_retry17
reca_resume18:
s_waitcnt vmcnt(1)
v_max_u32 v29, v132, v134
v_cmp_eq_u32 vcc, -1, v29
ds_write_b128 v4, v[128:131]
s_cbranch_vccnz reca_retry19
reca_resume20:
s_waitcnt vmcnt(0)
v_max_u32 v29, v136, v138
v_cmp_eq_u32 vcc, -1, v29
ds_write_b128 v4, v[132:135] offset:1024
s_cbranch_vccnz reca_retry21
reca_resume22:
ds_write_b128 v5, v[136:139]
s_branch reca_gotmem216
reca_gotmem15:
ds_write_b128 v4, v[128:131]
ds_write_b128 v4, v[132:135] offset:1024
ds_write_b128 v5, v[136:139]
reca_gotmem216:
s_and_b32 s34, s17, 3
s_mul_i32 s21, s34, 6144
s_add_u32 s21, s21, s39
s_mul_i32 s22, s34, 12288
s_add_u32 s22, s22, s40
s_mul_i32 s25, s34, 393216
s_add_u32 s25, s25, s56
s_add_u32 s35, s17, 1
s_and_b32 s35, s35, 3
s_mul_i32 s24, s35, 10240
s_add_u32 s24, s24, s38
s_waitcnt lgkmcnt(0)
s_barrier
ds_read_b128 v[128:131], v236 offset:0
ds_read_b128 v[132:135], v236 offset:1024
ds_read_b128 v[136:139], v236 offset:2048
ds_read_b128 v[140:143], v236 offset:3072
ds_read_b128 v[144:147], v236 offset:4096
ds_read_b128 v[148:151], v237 offset:0
ds_read_b128 v[152:155], v237 offset:1024
ds_read_b128 v[156:159], v237 offset:2048
ds_read_b128 v[160:163], v237 offset:3072
ds_read_b128 v[164:167], v237 offset:4096
s_waitcnt lgkmcnt(9)
v_mfma_f32_16x16x32_bf16 v[44:47], a[0:3], v[128:131], 0
ds_read_b128 v[168:171], v6 offset:0
v_mfma_f32_16x16x32_bf16 v[240:243], a[4:7], v[128:131], 0
s_waitcnt lgkmcnt(9)
v_mfma_f32_16x16x32_bf16 v[44:47], a[8:11], v[132:135], v[44:47]
ds_read_b128 v[172:175], v6 offset:512
v_mfma_f32_16x16x32_bf16 v[240:243], a[12:15], v[132:135], v[240:243]
s_waitcnt lgkmcnt(9)
v_mfma_f32_16x16x32_bf16 v[44:47], a[16:19], v[136:139], v[44:47]
ds_read_b128 v[176:179], v6 offset:1024
v_mfma_f32_16x16x32_bf16 v[240:243], a[20:23], v[136:139], v[240:243]
s_waitcnt lgkmcnt(9)
v_mfma_f32_16x16x32_bf16 v[44:47], a[24:27], v[140:143], v[44:47]
ds_read_b128 v[180:183], v6 offset:1536
v_mfma_f32_16x16x32_bf16 v[240:243], a[28:31], v[140:143], v[240:243]
s_waitcnt lgkmcnt(9)
v_mfma_f32_16x16x32_bf16 v[44:47], a[32:35], v[144:147], v[44:47]
ds_read_b128 v[184:187], v6 offset:2048
v_mfma_f32_16x16x32_bf16 v[240:243], a[36:39], v[144:147], v[240:243]
s_waitcnt lgkmcnt(9)
v_mfma_f32_16x16x32_bf16 v[44:47], a[40:43], v[148:151], v[44:47]
ds_read_b128 v[188:191], v6 offset:2560
v_mfma_f32_16x16x32_bf16 v[240:243], a[44:47], v[148:151], v[240:243]
s_waitcnt lgkmcnt(9)
v_mfma_f32_16x16x32_bf16 v[44:47], a[48:51], v[152:155], v[44:47]
ds_read_b128 v[192:195], v6 offset:3072
v_mfma_f32_16x16x32_bf16 v[240:243], a[52:55], v[152:155], v[240:243]
s_waitcnt lgkmcnt(9)
v_mfma_f32_16x16x32_bf16 v[44:47], a[56:59], v[156:159], v[44:47]
ds_read_b128 v[196:199], v6 offset:3584
v_mfma_f32_16x16x32_bf16 v[240:243], a[60:63], v[156:159], v[240:243]
s_waitcnt lgkmcnt(9)
v_mfma_f32_16x16x32_bf16 v[44:47], a[64:67], v[160:163], v[44:47]
ds_read_b128 v[200:203], v6 offset:4096
v_mfma_f32_16x16x32_bf16 v[240:243], a[68:71], v[160:163], v[240:243]
s_waitcnt lgkmcnt(9)
v_mfma_f32_16x16x32_bf16 v[44:47], a[72:75], v[164:167], v[44:47]
ds_read_b128 v[204:207], v6 offset:4608
v_mfma_f32_16x16x32_bf16 v[240:243], a[76:79], v[164:167], v[240:243]
s_waitcnt lgkmcnt(9)
v_mfma_f32_16x16x32_bf16 v[48:51], v[168:171], a[80:83], 0
s_and_b32 s34, s17, 7
s_lshl_b32 s34, s34, 5
s_add_u32 s34, s34, s15
s_mul_i32 s34, s34, 3072
s_lshl_b32 s35, s16, 9
s_add_u32 s34, s34, s35
s_add_u32 s30, s34, 47185920
s_add_u32 s31, s34, 47972352
v_add_f32_dpp v44, v240, v44 row_ror:8 row_mask:0xf bank_mask:0xf
v_add_f32_dpp v45, v241, v45 row_ror:8 row_mask:0xf bank_mask:0xf
v_add_f32_dpp v46, v242, v46 row_ror:8 row_mask:0xf bank_mask:0xf
v_add_f32_dpp v47, v243, v47 row_ror:8 row_mask:0xf bank_mask:0xf
v_cvt_pk_bf16_f32 v52, v44, v45
v_cvt_pk_bf16_f32 v53, v46, v47
buffer_store_dwordx2 v[52:53], v8, s[4:7], s21 offen
s_waitcnt lgkmcnt(8)
v_mfma_f32_16x16x32_bf16 v[48:51], v[172:175], a[84:87], v[48:51]
s_waitcnt lgkmcnt(7)
v_mfma_f32_16x16x32_bf16 v[48:51], v[176:179], a[88:91], v[48:51]
s_waitcnt lgkmcnt(6)
v_mfma_f32_16x16x32_bf16 v[48:51], v[180:183], a[92:95], v[48:51]
s_waitcnt lgkmcnt(5)
v_mfma_f32_16x16x32_bf16 v[48:51], v[184:187], a[96:99], v[48:51]
s_waitcnt lgkmcnt(4)
v_mfma_f32_16x16x32_bf16 v[48:51], v[188:191], a[100:103], v[48:51]
s_waitcnt lgkmcnt(3)
v_mfma_f32_16x16x32_bf16 v[48:51], v[192:195], a[104:107], v[48:51]
s_waitcnt lgkmcnt(2)
v_mfma_f32_16x16x32_bf16 v[48:51], v[196:199], a[108:111], v[48:51]
s_waitcnt lgkmcnt(1)
v_mfma_f32_16x16x32_bf16 v[48:51], v[200:203], a[112:115], v[48:51]
s_waitcnt lgkmcnt(0)
v_mfma_f32_16x16x32_bf16 v[48:51], v[204:207], a[116:119], v[48:51]
s_cmp_eq_u32 s12, 3
s_cbranch_scc1 reca_swave23
s_nop 5
ds_write_b128 v17, v[48:51]
s_add_u32 s34, s17, 2
s_and_b32 s34, s34, 3
s_mul_i32 s26, s34, 10240
s_add_u32 s26, s26, s38
s_mul_i32 s27, s34, 6144
s_add_u32 s27, s27, s39
s_mul_i32 s28, s34, 12288
s_add_u32 s28, s28, s40
s_mul_i32 s29, s34, 393216
s_add_u32 s29, s29, s56
s_waitcnt lgkmcnt(0)
s_barrier
s_cmp_eq_u32 s17, 63
s_cbranch_scc1 reca_last25
buffer_store_dwordx2 v[32:33], v8, s[4:7], s27 offen
s_cmp_lg_u32 s12, 2
s_cbranch_scc1 reca_b326
buffer_store_dwordx2 v[52:53], v9, s[4:7], s30 offen
buffer_store_dwordx2 v[32:33], v16, s[4:7], s26 offen
s_cmp_lg_u32 s14, 0
s_cbranch_scc1 reca_b326
v_mov_b32 v28, s17
s_lshl_b32 s34, s13, 7
s_add_u32 s34, s34, 1507328
buffer_store_dword v28, v19, s[4:7], s34 offen
s_branch reca_b326
reca_last25:
s_cmp_lg_u32 s12, 2
s_cbranch_scc1 reca_exit1
buffer_store_dwordx2 v[52:53], v9, s[4:7], s30 offen
s_branch reca_exit1
reca_swave23:
s_cmp_lg_u32 s17, 63
s_cbranch_scc1 reca_vmst29
s_barrier
ds_read_b128 v[56:59], v1 offset:10240
ds_read_b128 v[60:63], v1 offset:11264
ds_read_b128 v[64:67], v1 offset:12288
s_waitcnt lgkmcnt(0)
v_add_f32 v56, v56, v64
v_add_f32 v60, v60, v48
v_add_f32 v57, v57, v65
v_add_f32 v61, v61, v49
v_add_f32 v58, v58, v66
v_add_f32 v62, v62, v50
v_add_f32 v59, v59, v67
v_add_f32 v63, v63, v51
v_cvt_pk_bf16_f32 v68, v56, v57
v_cvt_pk_bf16_f32 v69, v58, v59
v_cvt_pk_bf16_f32 v70, v60, v61
v_cvt_pk_bf16_f32 v71, v62, v63
buffer_store_dwordx2 v[52:53], v9, s[4:7], s30 offen
buffer_store_dwordx2 v[68:69], v10, s[4:7], s31 offen
buffer_store_dwordx2 v[70:71], v10, s[4:7], s31 offen offset:256
s_branch reca_exit1
reca_vmst29:
s_sleep 1
buffer_load_dwordx4 v[208:211], v1, s[4:7], s21 offen offset:0 sc1
buffer_load_dwordx4 v[212:215], v1, s[4:7], s21 offen offset:1024 sc1
buffer_load_dwordx4 v[216:219], v1, s[4:7], s21 offen offset:2048 sc1
buffer_load_dwordx4 v[220:223], v1, s[4:7], s21 offen offset:3072 sc1
buffer_load_dwordx4 v[224:227], v2, s[4:7], s21 offen offset:0 sc1
buffer_load_dwordx4 v[228:231], v2, s[4:7], s21 offen offset:1024 sc1
s_waitcnt vmcnt(5)
v_max_u32 v29, v208, v210
v_cmp_eq_u32 vcc, -1, v29
s_cbranch_vccnz reca_retry30
reca_resume31:
s_waitcnt vmcnt(4)
v_max_u32 v29, v212, v214
v_cmp_eq_u32 vcc, -1, v29
v_mfma_f32_16x16x32_bf16 v[76:79], a[120:123], v[208:211], 0
v_mfma_f32_16x16x32_bf16 v[80:83], a[144:147], v[208:211], 0
v_mfma_f32_16x16x32_bf16 v[72:75], v[208:211], v[208:211], v[40:43]
s_cbranch_vccnz reca_retry32
reca_resume33:
s_waitcnt vmcnt(3)
v_max_u32 v29, v216, v218
v_cmp_eq_u32 vcc, -1, v29
v_mfma_f32_16x16x32_bf16 v[76:79], a[124:127], v[212:215], v[76:79]
v_mfma_f32_16x16x32_bf16 v[80:83], a[148:151], v[212:215], v[80:83]
v_mfma_f32_16x16x32_bf16 v[72:75], v[212:215], v[212:215], v[72:75]
s_cbranch_vccnz reca_retry34
reca_resume35:
s_waitcnt vmcnt(2)
v_max_u32 v29, v220, v222
v_cmp_eq_u32 vcc, -1, v29
v_mfma_f32_16x16x32_bf16 v[76:79], a[128:131], v[216:219], v[76:79]
v_mfma_f32_16x16x32_bf16 v[80:83], a[152:155], v[216:219], v[80:83]
v_mfma_f32_16x16x32_bf16 v[72:75], v[216:219], v[216:219], v[72:75]
s_cbranch_vccnz reca_retry36
reca_resume37:
s_waitcnt vmcnt(1)
v_max_u32 v29, v224, v226
v_cmp_eq_u32 vcc, -1, v29
v_mfma_f32_16x16x32_bf16 v[76:79], a[132:135], v[220:223], v[76:79]
v_mfma_f32_16x16x32_bf16 v[80:83], a[156:159], v[220:223], v[80:83]
v_mfma_f32_16x16x32_bf16 v[72:75], v[220:223], v[220:223], v[72:75]
s_cbranch_vccnz reca_retry38
reca_resume39:
s_waitcnt vmcnt(0)
v_max_u32 v29, v228, v230
v_cmp_eq_u32 vcc, -1, v29
v_mfma_f32_16x16x32_bf16 v[76:79], a[136:139], v[224:227], v[76:79]
v_mfma_f32_16x16x32_bf16 v[80:83], a[160:163], v[224:227], v[80:83]
v_mfma_f32_16x16x32_bf16 v[72:75], v[224:227], v[224:227], v[72:75]
s_cbranch_vccnz reca_retry40
reca_resume41:
v_mfma_f32_16x16x32_bf16 v[76:79], a[140:143], v[228:231], v[76:79]
v_mfma_f32_16x16x32_bf16 v[80:83], a[164:167], v[228:231], v[80:83]
v_mfma_f32_16x16x32_bf16 v[72:75], v[228:231], v[228:231], v[72:75]
s_barrier
ds_read_b128 v[56:59], v1 offset:10240
ds_read_b128 v[60:63], v1 offset:11264
ds_read_b128 v[64:67], v1 offset:12288
s_nop 1
v_max3_f32 v28, v76, v77, v78
v_max3_f32 v29, v80, v81, v82
v_max3_f32 v28, v28, v79, v83
v_max3_f32 v29, v29, v72, v73
v_max3_f32 v28, v28, v74, v75
v_max_f32 v28, v28, v29
v_mov_b32 v29, v28
s_nop 1
v_permlane32_swap_b32 v28, v29
v_max_f32 v28, v28, v29
v_mov_b32 v29, v28
s_nop 1
v_permlane16_swap_b32 v28, v29
v_max_f32 v28, v28, v29
v_mul_f32 v28, s41, v28
v_fma_f32 v76, v76, s41, -v28
v_fma_f32 v77, v77, s41, -v28
v_fma_f32 v78, v78, s41, -v28
v_fma_f32 v79, v79, s41, -v28
v_fma_f32 v80, v80, s41, -v28
v_fma_f32 v81, v81, s41, -v28
v_fma_f32 v82, v82, s41, -v28
v_fma_f32 v83, v83, s41, -v28
v_fma_f32 v72, v72, s41, -v28
v_fma_f32 v73, v73, s41, -v28
v_fma_f32 v74, v74, s41, -v28
v_fma_f32 v75, v75, s41, -v28
v_exp_f32 v76, v76
v_exp_f32 v77, v77
v_exp_f32 v78, v78
v_exp_f32 v79, v79
v_exp_f32 v80, v80
v_exp_f32 v81, v81
v_exp_f32 v82, v82
v_exp_f32 v83, v83
v_cvt_pk_bf16_f32 v84, v76, v77
v_cvt_pk_bf16_f32 v85, v78, v79
v_cvt_pk_bf16_f32 v86, v80, v81
v_cvt_pk_bf16_f32 v87, v82, v83
v_exp_f32 v72, v72
v_exp_f32 v73, v73
v_mfma_f32_16x16x32_bf16 v[100:103], v[36:39], v[84:87], 0
v_exp_f32 v74, v74
v_exp_f32 v75, v75
v_mfma_f32_16x16x32_bf16 v[92:95], a[168:171], v[84:87], 0
v_cvt_pk_bf16_f32 v88, v72, v73
v_cvt_pk_bf16_f32 v89, v74, v75
v_mfma_f32_16x16x32_bf16 v[96:99], a[172:175], v[84:87], 0
s_waitcnt lgkmcnt(0)
v_mfma_f32_16x16x16_bf16 v[100:103], v[36:37], v[88:89], v[100:103]
v_add_f32 v56, v56, v64
v_add_f32 v60, v60, v48
v_add_f32 v57, v57, v65
v_add_f32 v61, v61, v49
v_add_f32 v58, v58, v66
v_add_f32 v62, v62, v50
v_add_f32 v59, v59, v67
v_add_f32 v63, v63, v51
v_cvt_pk_bf16_f32 v68, v56, v57
v_cvt_pk_bf16_f32 v69, v58, v59
v_cvt_pk_bf16_f32 v70, v60, v61
v_cvt_pk_bf16_f32 v71, v62, v63
v_mfma_f32_16x16x16_bf16 v[92:95], v[68:69], v[88:89], v[92:95]
v_rcp_f32 v28, v100
v_mfma_f32_16x16x16_bf16 v[96:99], v[70:71], v[88:89], v[96:99]
v_mov_b32 v29, v28
s_nop 4
v_pk_mul_f32 v[92:93], v[92:93], v[28:29]
v_pk_mul_f32 v[94:95], v[94:95], v[28:29]
v_pk_mul_f32 v[96:97], v[96:97], v[28:29]
v_pk_mul_f32 v[98:99], v[98:99], v[28:29]
v_cvt_pk_bf16_f32 v104, v92, v93
v_cvt_pk_bf16_f32 v105, v94, v95
v_cvt_pk_bf16_f32 v106, v96, v97
v_cvt_pk_bf16_f32 v107, v98, v99
buffer_store_dwordx4 v[104:107], v11, s[4:7], s22 offen
reca_b326:
s_barrier
s_cmp_ge_u32 s12, 2
s_cbranch_scc1 reca_notg242
s_sleep 3
buffer_load_dwordx4 v[128:131], v12, s[4:7], s22 offen offset:0 sc1
buffer_load_dwordx4 v[132:135], v12, s[4:7], s22 offen offset:1024 sc1
buffer_load_dwordx4 v[136:139], v12, s[4:7], s22 offen offset:2048 sc1
buffer_load_dwordx4 v[140:143], v12, s[4:7], s22 offen offset:3072 sc1
buffer_load_dwordx4 v[144:147], v13, s[4:7], s22 offen offset:0 sc1
buffer_load_dwordx4 v[148:151], v13, s[4:7], s22 offen offset:1024 sc1
buffer_load_dwordx4 v[152:155], v13, s[4:7], s22 offen offset:2048 sc1
buffer_load_dwordx4 v[156:159], v13, s[4:7], s22 offen offset:3072 sc1
buffer_load_dwordx4 v[160:163], v14, s[4:7], s22 offen offset:0 sc1
buffer_load_dwordx4 v[164:167], v14, s[4:7], s22 offen offset:1024 sc1
buffer_load_dwordx4 v[168:171], v14, s[4:7], s22 offen offset:2048 sc1
buffer_load_dwordx4 v[172:175], v14, s[4:7], s22 offen offset:3072 sc1
s_waitcnt vmcnt(11)
v_cmp_eq_u32 vcc, -1, v128
s_cbranch_vccnz reca_retry43
reca_resume44:
s_waitcnt vmcnt(10)
v_cmp_eq_u32 vcc, -1, v132
v_mfma_f32_16x16x32_bf16 v[108:111], a[120:123], v[128:131], 0
v_mfma_f32_16x16x32_bf16 v[112:115], a[124:127], v[128:131], 0
s_cbranch_vccnz reca_retry45
reca_resume46:
s_waitcnt vmcnt(9)
v_cmp_eq_u32 vcc, -1, v136
v_mfma_f32_16x16x32_bf16 v[108:111], a[128:131], v[132:135], v[108:111]
v_mfma_f32_16x16x32_bf16 v[112:115], a[132:135], v[132:135], v[112:115]
s_cbranch_vccnz reca_retry47
reca_resume48:
s_waitcnt vmcnt(8)
v_cmp_eq_u32 vcc, -1, v140
v_mfma_f32_16x16x32_bf16 v[108:111], a[136:139], v[136:139], v[108:111]
v_mfma_f32_16x16x32_bf16 v[112:115], a[140:143], v[136:139], v[112:115]
s_cbranch_vccnz reca_retry49
reca_resume50:
s_waitcnt vmcnt(7)
v_cmp_eq_u32 vcc, -1, v144
v_mfma_f32_16x16x32_bf16 v[108:111], a[144:147], v[140:143], v[108:111]
v_mfma_f32_16x16x32_bf16 v[112:115], a[148:151], v[140:143], v[112:115]
s_cbranch_vccnz reca_retry51
reca_resume52:
s_waitcnt vmcnt(6)
v_cmp_eq_u32 vcc, -1, v148
v_mfma_f32_16x16x32_bf16 v[108:111], a[152:155], v[144:147], v[108:111]
v_mfma_f32_16x16x32_bf16 v[112:115], a[156:159], v[144:147], v[112:115]
s_cbranch_vccnz reca_retry53
reca_resume54:
s_waitcnt vmcnt(5)
v_cmp_eq_u32 vcc, -1, v152
v_mfma_f32_16x16x32_bf16 v[108:111], a[160:163], v[148:151], v[108:111]
v_mfma_f32_16x16x32_bf16 v[112:115], a[164:167], v[148:151], v[112:115]
s_cbranch_vccnz reca_retry55
reca_resume56:
s_waitcnt vmcnt(4)
v_cmp_eq_u32 vcc, -1, v156
v_mfma_f32_16x16x32_bf16 v[108:111], a[168:171], v[152:155], v[108:111]
v_mfma_f32_16x16x32_bf16 v[112:115], a[172:175], v[152:155], v[112:115]
s_cbranch_vccnz reca_retry57
reca_resume58:
s_waitcnt vmcnt(3)
v_cmp_eq_u32 vcc, -1, v160
v_mfma_f32_16x16x32_bf16 v[108:111], a[176:179], v[156:159], v[108:111]
v_mfma_f32_16x16x32_bf16 v[112:115], a[180:183], v[156:159], v[112:115]
s_cbranch_vccnz reca_retry59
reca_resume60:
s_waitcnt vmcnt(2)
v_cmp_eq_u32 vcc, -1, v164
v_mfma_f32_16x16x32_bf16 v[108:111], a[184:187], v[160:163], v[108:111]
v_mfma_f32_16x16x32_bf16 v[112:115], a[188:191], v[160:163], v[112:115]
s_cbranch_vccnz reca_retry61
reca_resume62:
s_waitcnt vmcnt(1)
v_cmp_eq_u32 vcc, -1, v168
v_mfma_f32_16x16x32_bf16 v[108:111], a[192:195], v[164:167], v[108:111]
v_mfma_f32_16x16x32_bf16 v[112:115], a[196:199], v[164:167], v[112:115]
s_cbranch_vccnz reca_retry63
reca_resume64:
s_waitcnt vmcnt(0)
v_cmp_eq_u32 vcc, -1, v172
v_mfma_f32_16x16x32_bf16 v[108:111], a[200:203], v[168:171], v[108:111]
v_mfma_f32_16x16x32_bf16 v[112:115], a[204:207], v[168:171], v[112:115]
s_cbranch_vccnz reca_retry65
reca_resume66:
v_mfma_f32_16x16x32_bf16 v[108:111], a[208:211], v[172:175], v[108:111]
v_mfma_f32_16x16x32_bf16 v[112:115], a[212:215], v[172:175], v[112:115]
s_nop 7
v_add_f32_dpp v116, v112, v108 row_ror:8 row_mask:0xf bank_mask:0xf
v_add_f32_dpp v117, v113, v109 row_ror:8 row_mask:0xf bank_mask:0xf
v_add_f32_dpp v118, v114, v110 row_ror:8 row_mask:0xf bank_mask:0xf
v_add_f32_dpp v119, v115, v111 row_ror:8 row_mask:0xf bank_mask:0xf
buffer_store_dwordx4 v[116:119], v15, s[4:7], s25 offen sc1
buffer_store_dwordx4 v[116:119], v232, s[4:7], s25 offen sc1
buffer_store_dwordx4 v[32:35], v15, s[4:7], s29 offen sc1
buffer_store_dwordx4 v[32:35], v232, s[4:7], s29 offen sc1
s_branch reca_b427
reca_notg242:
s_cmp_lg_u32 s12, 3
s_cbranch_scc1 reca_b427
s_add_u32 s34, s17, 2
s_and_b32 s34, s34, 3
s_mul_i32 s26, s34, 10240
s_add_u32 s26, s26, s38
s_mul_i32 s27, s34, 6144
s_add_u32 s27, s27, s39
s_mul_i32 s28, s34, 12288
s_add_u32 s28, s28, s40
s_mul_i32 s29, s34, 393216
s_add_u32 s29, s29, s56
buffer_store_dwordx2 v[32:33], v8, s[4:7], s27 offen
buffer_store_dwordx4 v[32:35], v11, s[4:7], s28 offen
reca_b427:
s_barrier
s_cmp_lg_u32 s12, 2
s_cbranch_scc1 reca_not267
s_sleep 8
buffer_load_dwordx4 v[128:131], v20, s[4:7], s25 offen sc1
buffer_load_dwordx4 v[132:135], v21, s[4:7], s25 offen sc1
buffer_load_dwordx4 v[136:139], v22, s[4:7], s25 offen sc1
buffer_load_dwordx4 v[140:143], v23, s[4:7], s25 offen sc1
buffer_load_dwordx4 v[144:147], v24, s[4:7], s25 offen sc1
buffer_load_dwordx4 v[148:151], v25, s[4:7], s25 offen sc1
buffer_load_dwordx4 v[152:155], v26, s[4:7], s25 offen sc1
buffer_load_dwordx4 v[156:159], v27, s[4:7], s25 offen sc1
s_waitcnt vmcnt(7)
v_cmp_eq_u32 vcc, -1, v128
s_cbranch_vccnz reca_retry68
reca_resume69:
s_waitcnt vmcnt(6)
v_cmp_eq_u32 vcc, -1, v132
s_cbranch_vccnz reca_retry70
reca_resume71:
s_waitcnt vmcnt(5)
v_cmp_eq_u32 vcc, -1, v136
v_pk_add_f32 v[116:117], v[128:129], v[132:133]
v_pk_add_f32 v[118:119], v[130:131], v[134:135]
s_cbranch_vccnz reca_retry72
reca_resume73:
s_waitcnt vmcnt(4)
v_cmp_eq_u32 vcc, -1, v140
v_pk_add_f32 v[116:117], v[116:117], v[136:137]
v_pk_add_f32 v[118:119], v[118:119], v[138:139]
s_cbranch_vccnz reca_retry74
reca_resume75:
s_waitcnt vmcnt(3)
v_cmp_eq_u32 vcc, -1, v144
v_pk_add_f32 v[116:117], v[116:117], v[140:141]
v_pk_add_f32 v[118:119], v[118:119], v[142:143]
s_cbranch_vccnz reca_retry76
reca_resume77:
s_waitcnt vmcnt(2)
v_cmp_eq_u32 vcc, -1, v148
v_pk_add_f32 v[116:117], v[116:117], v[144:145]
v_pk_add_f32 v[118:119], v[118:119], v[146:147]
s_cbranch_vccnz reca_retry78
reca_resume79:
s_waitcnt vmcnt(1)
v_cmp_eq_u32 vcc, -1, v152
v_pk_add_f32 v[116:117], v[116:117], v[148:149]
v_pk_add_f32 v[118:119], v[118:119], v[150:151]
s_cbranch_vccnz reca_retry80
reca_resume81:
s_waitcnt vmcnt(0)
v_cmp_eq_u32 vcc, -1, v156
v_pk_add_f32 v[116:117], v[116:117], v[152:153]
v_pk_add_f32 v[118:119], v[118:119], v[154:155]
s_cbranch_vccnz reca_retry82
reca_resume83:
v_pk_add_f32 v[116:117], v[116:117], v[156:157]
v_pk_add_f32 v[118:119], v[118:119], v[158:159]
v_cvt_pk_bf16_f32 v132, v116, v117
v_cvt_pk_bf16_f32 v133, v118, v119
buffer_store_dwordx2 v[132:133], v16, s[4:7], s24 offen
s_branch reca_b528
reca_not267:
s_cmp_lg_u32 s12, 3
s_cbranch_scc1 reca_b528
s_add_u32 s36, s17, 1
s_cmp_ge_u32 s36, 63
s_cbranch_scc1 reca_nopf84
s_add_u32 s37, s36, 1
reca_pf85:
buffer_load_dword v28, v233, s[4:7], 0 offen sc1
s_waitcnt vmcnt(0)
v_cmp_gt_i32 vcc, s37, v28
s_cbranch_vccz reca_pfok86
s_sleep 1
s_sub_u32 s18, s18, 1
s_cbranch_scc0 reca_pf85
s_mov_b32 s18, 0
reca_pfok86:
s_lshl_b32 s34, s15, 3
s_and_b32 s35, s36, 7
s_add_u32 s34, s34, s35
s_mul_i32 s34, s34, 12288
s_add_u32 s32, s34, 37748736
s_lshl_b32 s35, s16, 11
s_add_u32 s34, s34, s35
s_add_u32 s33, s34, 40894464
buffer_load_dwordx4 a[120:123], v1, s[4:7], s32 offen offset:0 sc1
buffer_load_dwordx4 a[124:127], v1, s[4:7], s32 offen offset:1024 sc1
buffer_load_dwordx4 a[128:131], v1, s[4:7], s32 offen offset:2048 sc1
buffer_load_dwordx4 a[132:135], v1, s[4:7], s32 offen offset:3072 sc1
buffer_load_dwordx4 a[136:139], v2, s[4:7], s32 offen offset:0 sc1
buffer_load_dwordx4 a[140:143], v2, s[4:7], s32 offen offset:1024 sc1
buffer_load_dwordx4 a[144:147], v2, s[4:7], s32 offen offset:2048 sc1
buffer_load_dwordx4 a[148:151], v2, s[4:7], s32 offen offset:3072 sc1
buffer_load_dwordx4 a[152:155], v3, s[4:7], s32 offen offset:0 sc1
buffer_load_dwordx4 a[156:159], v3, s[4:7], s32 offen offset:1024 sc1
buffer_load_dwordx4 a[160:163], v3, s[4:7], s32 offen offset:2048 sc1
buffer_load_dwordx4 a[164:167], v3, s[4:7], s32 offen offset:3072 sc1
buffer_load_dwordx4 a[168:171], v1, s[4:7], s33 offen offset:0 sc1
buffer_load_dwordx4 a[172:175], v1, s[4:7], s33 offen offset:1024 sc1
reca_nopf84:
buffer_store_dwordx2 v[52:53], v9, s[4:7], s30 offen
buffer_store_dwordx2 v[68:69], v10, s[4:7], s31 offen
buffer_store_dwordx2 v[70:71], v10, s[4:7], s31 offen offset:256
reca_b528:
s_barrier
s_add_u32 s17, s17, 1
s_branch reca_step14
reca_retry17:
s_sub_u32 s18, s18, 1
s_cbranch_scc1 reca_retry17_to
buffer_load_dwordx4 v[128:131], v4, s[4:7], s20 offen sc1
buffer_load_dwordx4 v[132:135], v4, s[4:7], s20 offen offset:1024 sc1
buffer_load_dwordx4 v[136:139], v5, s[4:7], s20 offen sc1
s_waitcnt vmcnt(2)
v_max_u32 v29, v128, v130
v_cmp_eq_u32 vcc, -1, v29
s_cbranch_vccnz reca_retry17
s_branch reca_resume18
reca_retry17_to:
s_mov_b32 s18, 0
s_waitcnt vmcnt(0)
s_branch reca_resume18
reca_retry19:
s_sub_u32 s18, s18, 1
s_cbranch_scc1 reca_retry19_to
buffer_load_dwordx4 v[132:135], v4, s[4:7], s20 offen offset:1024 sc1
buffer_load_dwordx4 v[136:139], v5, s[4:7], s20 offen sc1
s_waitcnt vmcnt(1)
v_max_u32 v29, v132, v134
v_cmp_eq_u32 vcc, -1, v29
s_cbranch_vccnz reca_retry19
s_branch reca_resume20
reca_retry19_to:
s_mov_b32 s18, 0
s_waitcnt vmcnt(0)
s_branch reca_resume20
reca_retry21:
s_sub_u32 s18, s18, 1
s_cbranch_scc1 reca_retry21_to
buffer_load_dwordx4 v[136:139], v5, s[4:7], s20 offen sc1
s_waitcnt vmcnt(0)
v_max_u32 v29, v136, v138
v_cmp_eq_u32 vcc, -1, v29
s_cbranch_vccnz reca_retry21
s_branch reca_resume22
reca_retry21_to:
s_mov_b32 s18, 0
s_waitcnt vmcnt(0)
s_branch reca_resume22
reca_retry30:
s_sub_u32 s18, s18, 1
s_cbranch_scc1 reca_retry30_to
buffer_load_dwordx4 v[208:211], v1, s[4:7], s21 offen offset:0 sc1
buffer_load_dwordx4 v[212:215], v1, s[4:7], s21 offen offset:1024 sc1
buffer_load_dwordx4 v[216:219], v1, s[4:7], s21 offen offset:2048 sc1
buffer_load_dwordx4 v[220:223], v1, s[4:7], s21 offen offset:3072 sc1
buffer_load_dwordx4 v[224:227], v2, s[4:7], s21 offen offset:0 sc1
buffer_load_dwordx4 v[228:231], v2, s[4:7], s21 offen offset:1024 sc1
s_waitcnt vmcnt(5)
v_max_u32 v29, v208, v210
v_cmp_eq_u32 vcc, -1, v29
s_cbranch_vccnz reca_retry30
s_branch reca_resume31
reca_retry30_to:
s_mov_b32 s18, 0
s_waitcnt vmcnt(0)
s_branch reca_resume31
reca_retry32:
s_sub_u32 s18, s18, 1
s_cbranch_scc1 reca_retry32_to
buffer_load_dwordx4 v[212:215], v1, s[4:7], s21 offen offset:1024 sc1
buffer_load_dwordx4 v[216:219], v1, s[4:7], s21 offen offset:2048 sc1
buffer_load_dwordx4 v[220:223], v1, s[4:7], s21 offen offset:3072 sc1
buffer_load_dwordx4 v[224:227], v2, s[4:7], s21 offen offset:0 sc1
buffer_load_dwordx4 v[228:231], v2, s[4:7], s21 offen offset:1024 sc1
s_waitcnt vmcnt(4)
v_max_u32 v29, v212, v214
v_cmp_eq_u32 vcc, -1, v29
s_cbranch_vccnz reca_retry32
s_branch reca_resume33
reca_retry32_to:
s_mov_b32 s18, 0
s_waitcnt vmcnt(0)
s_branch reca_resume33
reca_retry34:
s_sub_u32 s18, s18, 1
s_cbranch_scc1 reca_retry34_to
buffer_load_dwordx4 v[216:219], v1, s[4:7], s21 offen offset:2048 sc1
buffer_load_dwordx4 v[220:223], v1, s[4:7], s21 offen offset:3072 sc1
buffer_load_dwordx4 v[224:227], v2, s[4:7], s21 offen offset:0 sc1
buffer_load_dwordx4 v[228:231], v2, s[4:7], s21 offen offset:1024 sc1
s_waitcnt vmcnt(3)
v_max_u32 v29, v216, v218
v_cmp_eq_u32 vcc, -1, v29
s_cbranch_vccnz reca_retry34
s_branch reca_resume35
reca_retry34_to:
s_mov_b32 s18, 0
s_waitcnt vmcnt(0)
s_branch reca_resume35
reca_retry36:
s_sub_u32 s18, s18, 1
s_cbranch_scc1 reca_retry36_to
buffer_load_dwordx4 v[220:223], v1, s[4:7], s21 offen offset:3072 sc1
buffer_load_dwordx4 v[224:227], v2, s[4:7], s21 offen offset:0 sc1
buffer_load_dwordx4 v[228:231], v2, s[4:7], s21 offen offset:1024 sc1
s_waitcnt vmcnt(2)
v_max_u32 v29, v220, v222
v_cmp_eq_u32 vcc, -1, v29
s_cbranch_vccnz reca_retry36
s_branch reca_resume37
reca_retry36_to:
s_mov_b32 s18, 0
s_waitcnt vmcnt(0)
s_branch reca_resume37
reca_retry38:
s_sub_u32 s18, s18, 1
s_cbranch_scc1 reca_retry38_to
buffer_load_dwordx4 v[224:227], v2, s[4:7], s21 offen offset:0 sc1
buffer_load_dwordx4 v[228:231], v2, s[4:7], s21 offen offset:1024 sc1
s_waitcnt vmcnt(1)
v_max_u32 v29, v224, v226
v_cmp_eq_u32 vcc, -1, v29
s_cbranch_vccnz reca_retry38
s_branch reca_resume39
reca_retry38_to:
s_mov_b32 s18, 0
s_waitcnt vmcnt(0)
s_branch reca_resume39
reca_retry40:
s_sub_u32 s18, s18, 1
s_cbranch_scc1 reca_retry40_to
buffer_load_dwordx4 v[228:231], v2, s[4:7], s21 offen offset:1024 sc1
s_waitcnt vmcnt(0)
v_max_u32 v29, v228, v230
v_cmp_eq_u32 vcc, -1, v29
s_cbranch_vccnz reca_retry40
s_branch reca_resume41
reca_retry40_to:
s_mov_b32 s18, 0
s_waitcnt vmcnt(0)
s_branch reca_resume41
reca_retry43:
s_sub_u32 s18, s18, 1
s_cbranch_scc1 reca_retry43_to
buffer_load_dwordx4 v[128:131], v12, s[4:7], s22 offen offset:0 sc1
buffer_load_dwordx4 v[132:135], v12, s[4:7], s22 offen offset:1024 sc1
buffer_load_dwordx4 v[136:139], v12, s[4:7], s22 offen offset:2048 sc1
buffer_load_dwordx4 v[140:143], v12, s[4:7], s22 offen offset:3072 sc1
buffer_load_dwordx4 v[144:147], v13, s[4:7], s22 offen offset:0 sc1
buffer_load_dwordx4 v[148:151], v13, s[4:7], s22 offen offset:1024 sc1
buffer_load_dwordx4 v[152:155], v13, s[4:7], s22 offen offset:2048 sc1
buffer_load_dwordx4 v[156:159], v13, s[4:7], s22 offen offset:3072 sc1
buffer_load_dwordx4 v[160:163], v14, s[4:7], s22 offen offset:0 sc1
buffer_load_dwordx4 v[164:167], v14, s[4:7], s22 offen offset:1024 sc1
buffer_load_dwordx4 v[168:171], v14, s[4:7], s22 offen offset:2048 sc1
buffer_load_dwordx4 v[172:175], v14, s[4:7], s22 offen offset:3072 sc1
s_waitcnt vmcnt(11)
v_cmp_eq_u32 vcc, -1, v128
s_cbranch_vccnz reca_retry43
s_branch reca_resume44
reca_retry43_to:
s_mov_b32 s18, 0
s_waitcnt vmcnt(0)
s_branch reca_resume44
reca_retry45:
s_sub_u32 s18, s18, 1
s_cbranch_scc1 reca_retry45_to
buffer_load_dwordx4 v[132:135], v12, s[4:7], s22 offen offset:1024 sc1
buffer_load_dwordx4 v[136:139], v12, s[4:7], s22 offen offset:2048 sc1
buffer_load_dwordx4 v[140:143], v12, s[4:7], s22 offen offset:3072 sc1
buffer_load_dwordx4 v[144:147], v13, s[4:7], s22 offen offset:0 sc1
buffer_load_dwordx4 v[148:151], v13, s[4:7], s22 offen offset:1024 sc1
buffer_load_dwordx4 v[152:155], v13, s[4:7], s22 offen offset:2048 sc1
buffer_load_dwordx4 v[156:159], v13, s[4:7], s22 offen offset:3072 sc1
buffer_load_dwordx4 v[160:163], v14, s[4:7], s22 offen offset:0 sc1
buffer_load_dwordx4 v[164:167], v14, s[4:7], s22 offen offset:1024 sc1
buffer_load_dwordx4 v[168:171], v14, s[4:7], s22 offen offset:2048 sc1
buffer_load_dwordx4 v[172:175], v14, s[4:7], s22 offen offset:3072 sc1
s_waitcnt vmcnt(10)
v_cmp_eq_u32 vcc, -1, v132
s_cbranch_vccnz reca_retry45
s_branch reca_resume46
reca_retry45_to:
s_mov_b32 s18, 0
s_waitcnt vmcnt(0)
s_branch reca_resume46
reca_retry47:
s_sub_u32 s18, s18, 1
s_cbranch_scc1 reca_retry47_to
buffer_load_dwordx4 v[136:139], v12, s[4:7], s22 offen offset:2048 sc1
buffer_load_dwordx4 v[140:143], v12, s[4:7], s22 offen offset:3072 sc1
buffer_load_dwordx4 v[144:147], v13, s[4:7], s22 offen offset:0 sc1
buffer_load_dwordx4 v[148:151], v13, s[4:7], s22 offen offset:1024 sc1
buffer_load_dwordx4 v[152:155], v13, s[4:7], s22 offen offset:2048 sc1
buffer_load_dwordx4 v[156:159], v13, s[4:7], s22 offen offset:3072 sc1
buffer_load_dwordx4 v[160:163], v14, s[4:7], s22 offen offset:0 sc1
buffer_load_dwordx4 v[164:167], v14, s[4:7], s22 offen offset:1024 sc1
buffer_load_dwordx4 v[168:171], v14, s[4:7], s22 offen offset:2048 sc1
buffer_load_dwordx4 v[172:175], v14, s[4:7], s22 offen offset:3072 sc1
s_waitcnt vmcnt(9)
v_cmp_eq_u32 vcc, -1, v136
s_cbranch_vccnz reca_retry47
s_branch reca_resume48
reca_retry47_to:
s_mov_b32 s18, 0
s_waitcnt vmcnt(0)
s_branch reca_resume48
reca_retry49:
s_sub_u32 s18, s18, 1
s_cbranch_scc1 reca_retry49_to
buffer_load_dwordx4 v[140:143], v12, s[4:7], s22 offen offset:3072 sc1
buffer_load_dwordx4 v[144:147], v13, s[4:7], s22 offen offset:0 sc1
buffer_load_dwordx4 v[148:151], v13, s[4:7], s22 offen offset:1024 sc1
buffer_load_dwordx4 v[152:155], v13, s[4:7], s22 offen offset:2048 sc1
buffer_load_dwordx4 v[156:159], v13, s[4:7], s22 offen offset:3072 sc1
buffer_load_dwordx4 v[160:163], v14, s[4:7], s22 offen offset:0 sc1
buffer_load_dwordx4 v[164:167], v14, s[4:7], s22 offen offset:1024 sc1
buffer_load_dwordx4 v[168:171], v14, s[4:7], s22 offen offset:2048 sc1
buffer_load_dwordx4 v[172:175], v14, s[4:7], s22 offen offset:3072 sc1
s_waitcnt vmcnt(8)
v_cmp_eq_u32 vcc, -1, v140
s_cbranch_vccnz reca_retry49
s_branch reca_resume50
reca_retry49_to:
s_mov_b32 s18, 0
s_waitcnt vmcnt(0)
s_branch reca_resume50
reca_retry51:
s_sub_u32 s18, s18, 1
s_cbranch_scc1 reca_retry51_to
buffer_load_dwordx4 v[144:147], v13, s[4:7], s22 offen offset:0 sc1
buffer_load_dwordx4 v[148:151], v13, s[4:7], s22 offen offset:1024 sc1
buffer_load_dwordx4 v[152:155], v13, s[4:7], s22 offen offset:2048 sc1
buffer_load_dwordx4 v[156:159], v13, s[4:7], s22 offen offset:3072 sc1
buffer_load_dwordx4 v[160:163], v14, s[4:7], s22 offen offset:0 sc1
buffer_load_dwordx4 v[164:167], v14, s[4:7], s22 offen offset:1024 sc1
buffer_load_dwordx4 v[168:171], v14, s[4:7], s22 offen offset:2048 sc1
buffer_load_dwordx4 v[172:175], v14, s[4:7], s22 offen offset:3072 sc1
s_waitcnt vmcnt(7)
v_cmp_eq_u32 vcc, -1, v144
s_cbranch_vccnz reca_retry51
s_branch reca_resume52
reca_retry51_to:
s_mov_b32 s18, 0
s_waitcnt vmcnt(0)
s_branch reca_resume52
reca_retry53:
s_sub_u32 s18, s18, 1
s_cbranch_scc1 reca_retry53_to
buffer_load_dwordx4 v[148:151], v13, s[4:7], s22 offen offset:1024 sc1
buffer_load_dwordx4 v[152:155], v13, s[4:7], s22 offen offset:2048 sc1
buffer_load_dwordx4 v[156:159], v13, s[4:7], s22 offen offset:3072 sc1
buffer_load_dwordx4 v[160:163], v14, s[4:7], s22 offen offset:0 sc1
buffer_load_dwordx4 v[164:167], v14, s[4:7], s22 offen offset:1024 sc1
buffer_load_dwordx4 v[168:171], v14, s[4:7], s22 offen offset:2048 sc1
buffer_load_dwordx4 v[172:175], v14, s[4:7], s22 offen offset:3072 sc1
s_waitcnt vmcnt(6)
v_cmp_eq_u32 vcc, -1, v148
s_cbranch_vccnz reca_retry53
s_branch reca_resume54
reca_retry53_to:
s_mov_b32 s18, 0
s_waitcnt vmcnt(0)
s_branch reca_resume54
reca_retry55:
s_sub_u32 s18, s18, 1
s_cbranch_scc1 reca_retry55_to
buffer_load_dwordx4 v[152:155], v13, s[4:7], s22 offen offset:2048 sc1
buffer_load_dwordx4 v[156:159], v13, s[4:7], s22 offen offset:3072 sc1
buffer_load_dwordx4 v[160:163], v14, s[4:7], s22 offen offset:0 sc1
buffer_load_dwordx4 v[164:167], v14, s[4:7], s22 offen offset:1024 sc1
buffer_load_dwordx4 v[168:171], v14, s[4:7], s22 offen offset:2048 sc1
buffer_load_dwordx4 v[172:175], v14, s[4:7], s22 offen offset:3072 sc1
s_waitcnt vmcnt(5)
v_cmp_eq_u32 vcc, -1, v152
s_cbranch_vccnz reca_retry55
s_branch reca_resume56
reca_retry55_to:
s_mov_b32 s18, 0
s_waitcnt vmcnt(0)
s_branch reca_resume56
reca_retry57:
s_sub_u32 s18, s18, 1
s_cbranch_scc1 reca_retry57_to
buffer_load_dwordx4 v[156:159], v13, s[4:7], s22 offen offset:3072 sc1
buffer_load_dwordx4 v[160:163], v14, s[4:7], s22 offen offset:0 sc1
buffer_load_dwordx4 v[164:167], v14, s[4:7], s22 offen offset:1024 sc1
buffer_load_dwordx4 v[168:171], v14, s[4:7], s22 offen offset:2048 sc1
buffer_load_dwordx4 v[172:175], v14, s[4:7], s22 offen offset:3072 sc1
s_waitcnt vmcnt(4)
v_cmp_eq_u32 vcc, -1, v156
s_cbranch_vccnz reca_retry57
s_branch reca_resume58
reca_retry57_to:
s_mov_b32 s18, 0
s_waitcnt vmcnt(0)
s_branch reca_resume58
reca_retry59:
s_sub_u32 s18, s18, 1
s_cbranch_scc1 reca_retry59_to
buffer_load_dwordx4 v[160:163], v14, s[4:7], s22 offen offset:0 sc1
buffer_load_dwordx4 v[164:167], v14, s[4:7], s22 offen offset:1024 sc1
buffer_load_dwordx4 v[168:171], v14, s[4:7], s22 offen offset:2048 sc1
buffer_load_dwordx4 v[172:175], v14, s[4:7], s22 offen offset:3072 sc1
s_waitcnt vmcnt(3)
v_cmp_eq_u32 vcc, -1, v160
s_cbranch_vccnz reca_retry59
s_branch reca_resume60
reca_retry59_to:
s_mov_b32 s18, 0
s_waitcnt vmcnt(0)
s_branch reca_resume60
reca_retry61:
s_sub_u32 s18, s18, 1
s_cbranch_scc1 reca_retry61_to
buffer_load_dwordx4 v[164:167], v14, s[4:7], s22 offen offset:1024 sc1
buffer_load_dwordx4 v[168:171], v14, s[4:7], s22 offen offset:2048 sc1
buffer_load_dwordx4 v[172:175], v14, s[4:7], s22 offen offset:3072 sc1
s_waitcnt vmcnt(2)
v_cmp_eq_u32 vcc, -1, v164
s_cbranch_vccnz reca_retry61
s_branch reca_resume62
reca_retry61_to:
s_mov_b32 s18, 0
s_waitcnt vmcnt(0)
s_branch reca_resume62
reca_retry63:
s_sub_u32 s18, s18, 1
s_cbranch_scc1 reca_retry63_to
buffer_load_dwordx4 v[168:171], v14, s[4:7], s22 offen offset:2048 sc1
buffer_load_dwordx4 v[172:175], v14, s[4:7], s22 offen offset:3072 sc1
s_waitcnt vmcnt(1)
v_cmp_eq_u32 vcc, -1, v168
s_cbranch_vccnz reca_retry63
s_branch reca_resume64
reca_retry63_to:
s_mov_b32 s18, 0
s_waitcnt vmcnt(0)
s_branch reca_resume64
reca_retry65:
s_sub_u32 s18, s18, 1
s_cbranch_scc1 reca_retry65_to
buffer_load_dwordx4 v[172:175], v14, s[4:7], s22 offen offset:3072 sc1
s_waitcnt vmcnt(0)
v_cmp_eq_u32 vcc, -1, v172
s_cbranch_vccnz reca_retry65
s_branch reca_resume66
reca_retry65_to:
s_mov_b32 s18, 0
s_waitcnt vmcnt(0)
s_branch reca_resume66
reca_retry68:
s_sub_u32 s18, s18, 1
s_cbranch_scc1 reca_retry68_to
buffer_load_dwordx4 v[128:131], v20, s[4:7], s25 offen sc1
buffer_load_dwordx4 v[132:135], v21, s[4:7], s25 offen sc1
buffer_load_dwordx4 v[136:139], v22, s[4:7], s25 offen sc1
buffer_load_dwordx4 v[140:143], v23, s[4:7], s25 offen sc1
buffer_load_dwordx4 v[144:147], v24, s[4:7], s25 offen sc1
buffer_load_dwordx4 v[148:151], v25, s[4:7], s25 offen sc1
buffer_load_dwordx4 v[152:155], v26, s[4:7], s25 offen sc1
buffer_load_dwordx4 v[156:159], v27, s[4:7], s25 offen sc1
s_waitcnt vmcnt(7)
v_cmp_eq_u32 vcc, -1, v128
s_cbranch_vccnz reca_retry68
s_branch reca_resume69
reca_retry68_to:
s_mov_b32 s18, 0
s_waitcnt vmcnt(0)
s_branch reca_resume69
reca_retry70:
s_sub_u32 s18, s18, 1
s_cbranch_scc1 reca_retry70_to
buffer_load_dwordx4 v[132:135], v21, s[4:7], s25 offen sc1
buffer_load_dwordx4 v[136:139], v22, s[4:7], s25 offen sc1
buffer_load_dwordx4 v[140:143], v23, s[4:7], s25 offen sc1
buffer_load_dwordx4 v[144:147], v24, s[4:7], s25 offen sc1
buffer_load_dwordx4 v[148:151], v25, s[4:7], s25 offen sc1
buffer_load_dwordx4 v[152:155], v26, s[4:7], s25 offen sc1
buffer_load_dwordx4 v[156:159], v27, s[4:7], s25 offen sc1
s_waitcnt vmcnt(6)
v_cmp_eq_u32 vcc, -1, v132
s_cbranch_vccnz reca_retry70
s_branch reca_resume71
reca_retry70_to:
s_mov_b32 s18, 0
s_waitcnt vmcnt(0)
s_branch reca_resume71
reca_retry72:
s_sub_u32 s18, s18, 1
s_cbranch_scc1 reca_retry72_to
buffer_load_dwordx4 v[136:139], v22, s[4:7], s25 offen sc1
buffer_load_dwordx4 v[140:143], v23, s[4:7], s25 offen sc1
buffer_load_dwordx4 v[144:147], v24, s[4:7], s25 offen sc1
buffer_load_dwordx4 v[148:151], v25, s[4:7], s25 offen sc1
buffer_load_dwordx4 v[152:155], v26, s[4:7], s25 offen sc1
buffer_load_dwordx4 v[156:159], v27, s[4:7], s25 offen sc1
s_waitcnt vmcnt(5)
v_cmp_eq_u32 vcc, -1, v136
s_cbranch_vccnz reca_retry72
s_branch reca_resume73
reca_retry72_to:
s_mov_b32 s18, 0
s_waitcnt vmcnt(0)
s_branch reca_resume73
reca_retry74:
s_sub_u32 s18, s18, 1
s_cbranch_scc1 reca_retry74_to
buffer_load_dwordx4 v[140:143], v23, s[4:7], s25 offen sc1
buffer_load_dwordx4 v[144:147], v24, s[4:7], s25 offen sc1
buffer_load_dwordx4 v[148:151], v25, s[4:7], s25 offen sc1
buffer_load_dwordx4 v[152:155], v26, s[4:7], s25 offen sc1
buffer_load_dwordx4 v[156:159], v27, s[4:7], s25 offen sc1
s_waitcnt vmcnt(4)
v_cmp_eq_u32 vcc, -1, v140
s_cbranch_vccnz reca_retry74
s_branch reca_resume75
reca_retry74_to:
s_mov_b32 s18, 0
s_waitcnt vmcnt(0)
s_branch reca_resume75
reca_retry76:
s_sub_u32 s18, s18, 1
s_cbranch_scc1 reca_retry76_to
buffer_load_dwordx4 v[144:147], v24, s[4:7], s25 offen sc1
buffer_load_dwordx4 v[148:151], v25, s[4:7], s25 offen sc1
buffer_load_dwordx4 v[152:155], v26, s[4:7], s25 offen sc1
buffer_load_dwordx4 v[156:159], v27, s[4:7], s25 offen sc1
s_waitcnt vmcnt(3)
v_cmp_eq_u32 vcc, -1, v144
s_cbranch_vccnz reca_retry76
s_branch reca_resume77
reca_retry76_to:
s_mov_b32 s18, 0
s_waitcnt vmcnt(0)
s_branch reca_resume77
reca_retry78:
s_sub_u32 s18, s18, 1
s_cbranch_scc1 reca_retry78_to
buffer_load_dwordx4 v[148:151], v25, s[4:7], s25 offen sc1
buffer_load_dwordx4 v[152:155], v26, s[4:7], s25 offen sc1
buffer_load_dwordx4 v[156:159], v27, s[4:7], s25 offen sc1
s_waitcnt vmcnt(2)
v_cmp_eq_u32 vcc, -1, v148
s_cbranch_vccnz reca_retry78
s_branch reca_resume79
reca_retry78_to:
s_mov_b32 s18, 0
s_waitcnt vmcnt(0)
s_branch reca_resume79
reca_retry80:
s_sub_u32 s18, s18, 1
s_cbranch_scc1 reca_retry80_to
buffer_load_dwordx4 v[152:155], v26, s[4:7], s25 offen sc1
buffer_load_dwordx4 v[156:159], v27, s[4:7], s25 offen sc1
s_waitcnt vmcnt(1)
v_cmp_eq_u32 vcc, -1, v152
s_cbranch_vccnz reca_retry80
s_branch reca_resume81
reca_retry80_to:
s_mov_b32 s18, 0
s_waitcnt vmcnt(0)
s_branch reca_resume81
reca_retry82:
s_sub_u32 s18, s18, 1
s_cbranch_scc1 reca_retry82_to
buffer_load_dwordx4 v[156:159], v27, s[4:7], s25 offen sc1
s_waitcnt vmcnt(0)
v_cmp_eq_u32 vcc, -1, v156
s_cbranch_vccnz reca_retry82
s_branch reca_resume83
reca_retry82_to:
s_mov_b32 s18, 0
s_waitcnt vmcnt(0)
s_branch reca_resume83
reca_twinf12:
s_branch reca_gotmem88
reca_step87:
s_and_b32 s34, s17, 3
s_mul_i32 s20, s34, 10240
s_add_u32 s20, s20, s38
s_sleep 4
buffer_load_dwordx4 v[128:131], v4, s[4:7], s20 offen sc1
buffer_load_dwordx4 v[132:135], v4, s[4:7], s20 offen offset:1024 sc1
buffer_load_dwordx4 v[136:139], v5, s[4:7], s20 offen sc1
s_waitcnt vmcnt(2)
v_max_u32 v29, v128, v130
v_cmp_eq_u32 vcc, -1, v29
s_cbranch_vccnz reca_retry90
reca_resume91:
s_waitcnt vmcnt(1)
v_max_u32 v29, v132, v134
v_cmp_eq_u32 vcc, -1, v29
ds_write_b128 v4, v[128:131]
s_cbranch_vccnz reca_retry92
reca_resume93:
s_waitcnt vmcnt(0)
v_max_u32 v29, v136, v138
v_cmp_eq_u32 vcc, -1, v29
ds_write_b128 v4, v[132:135] offset:1024
s_cbranch_vccnz reca_retry94
reca_resume95:
ds_write_b128 v5, v[136:139]
s_branch reca_gotmem289
reca_gotmem88:
ds_write_b128 v4, v[128:131]
ds_write_b128 v4, v[132:135] offset:1024
ds_write_b128 v5, v[136:139]
reca_gotmem289:
s_and_b32 s34, s17, 3
s_mul_i32 s21, s34, 6144
s_add_u32 s21, s21, s39
s_mul_i32 s22, s34, 12288
s_add_u32 s22, s22, s40
s_mul_i32 s25, s34, 393216
s_add_u32 s25, s25, s56
s_add_u32 s35, s17, 1
s_and_b32 s35, s35, 3
s_mul_i32 s24, s35, 10240
s_add_u32 s24, s24, s38
s_waitcnt lgkmcnt(0)
s_barrier
ds_read_b128 v[128:131], v236 offset:0
ds_read_b128 v[132:135], v236 offset:1024
ds_read_b128 v[136:139], v236 offset:2048
ds_read_b128 v[140:143], v236 offset:3072
ds_read_b128 v[144:147], v236 offset:4096
ds_read_b128 v[148:151], v237 offset:0
ds_read_b128 v[152:155], v237 offset:1024
ds_read_b128 v[156:159], v237 offset:2048
ds_read_b128 v[160:163], v237 offset:3072
ds_read_b128 v[164:167], v237 offset:4096
s_waitcnt lgkmcnt(9)
v_mfma_f32_16x16x32_bf16 v[44:47], a[0:3], v[128:131], 0
ds_read_b128 v[168:171], v6 offset:0
v_mfma_f32_16x16x32_bf16 v[240:243], a[4:7], v[128:131], 0
s_waitcnt lgkmcnt(9)
v_mfma_f32_16x16x32_bf16 v[44:47], a[8:11], v[132:135], v[44:47]
ds_read_b128 v[172:175], v6 offset:512
v_mfma_f32_16x16x32_bf16 v[240:243], a[12:15], v[132:135], v[240:243]
s_waitcnt lgkmcnt(9)
v_mfma_f32_16x16x32_bf16 v[44:47], a[16:19], v[136:139], v[44:47]
ds_read_b128 v[176:179], v6 offset:1024
v_mfma_f32_16x16x32_bf16 v[240:243], a[20:23], v[136:139], v[240:243]
s_waitcnt lgkmcnt(9)
v_mfma_f32_16x16x32_bf16 v[44:47], a[24:27], v[140:143], v[44:47]
ds_read_b128 v[180:183], v6 offset:1536
v_mfma_f32_16x16x32_bf16 v[240:243], a[28:31], v[140:143], v[240:243]
s_waitcnt lgkmcnt(9)
v_mfma_f32_16x16x32_bf16 v[44:47], a[32:35], v[144:147], v[44:47]
ds_read_b128 v[184:187], v6 offset:2048
v_mfma_f32_16x16x32_bf16 v[240:243], a[36:39], v[144:147], v[240:243]
s_waitcnt lgkmcnt(9)
v_mfma_f32_16x16x32_bf16 v[44:47], a[40:43], v[148:151], v[44:47]
ds_read_b128 v[188:191], v6 offset:2560
v_mfma_f32_16x16x32_bf16 v[240:243], a[44:47], v[148:151], v[240:243]
s_waitcnt lgkmcnt(9)
v_mfma_f32_16x16x32_bf16 v[44:47], a[48:51], v[152:155], v[44:47]
ds_read_b128 v[192:195], v6 offset:3072
v_mfma_f32_16x16x32_bf16 v[240:243], a[52:55], v[152:155], v[240:243]
s_waitcnt lgkmcnt(9)
v_mfma_f32_16x16x32_bf16 v[44:47], a[56:59], v[156:159], v[44:47]
ds_read_b128 v[196:199], v6 offset:3584
v_mfma_f32_16x16x32_bf16 v[240:243], a[60:63], v[156:159], v[240:243]
s_waitcnt lgkmcnt(9)
v_mfma_f32_16x16x32_bf16 v[44:47], a[64:67], v[160:163], v[44:47]
ds_read_b128 v[200:203], v6 offset:4096
v_mfma_f32_16x16x32_bf16 v[240:243], a[68:71], v[160:163], v[240:243]
s_waitcnt lgkmcnt(9)
v_mfma_f32_16x16x32_bf16 v[44:47], a[72:75], v[164:167], v[44:47]
ds_read_b128 v[204:207], v6 offset:4608
v_mfma_f32_16x16x32_bf16 v[240:243], a[76:79], v[164:167], v[240:243]
s_waitcnt lgkmcnt(9)
v_mfma_f32_16x16x32_bf16 v[48:51], v[168:171], a[80:83], 0
s_and_b32 s34, s17, 7
s_lshl_b32 s34, s34, 5
s_add_u32 s34, s34, s15
s_mul_i32 s34, s34, 3072
s_lshl_b32 s35, s16, 9
s_add_u32 s34, s34, s35
s_add_u32 s30, s34, 47185920
s_add_u32 s31, s34, 47972352
v_add_f32_dpp v44, v240, v44 row_ror:8 row_mask:0xf bank_mask:0xf
v_add_f32_dpp v45, v241, v45 row_ror:8 row_mask:0xf bank_mask:0xf
v_add_f32_dpp v46, v242, v46 row_ror:8 row_mask:0xf bank_mask:0xf
v_add_f32_dpp v47, v243, v47 row_ror:8 row_mask:0xf bank_mask:0xf
v_cvt_pk_bf16_f32 v52, v44, v45
v_cvt_pk_bf16_f32 v53, v46, v47
buffer_store_dwordx2 v[52:53], v8, s[4:7], s21 offen
s_waitcnt lgkmcnt(8)
v_mfma_f32_16x16x32_bf16 v[48:51], v[172:175], a[84:87], v[48:51]
s_waitcnt lgkmcnt(7)
v_mfma_f32_16x16x32_bf16 v[48:51], v[176:179], a[88:91], v[48:51]
s_waitcnt lgkmcnt(6)
v_mfma_f32_16x16x32_bf16 v[48:51], v[180:183], a[92:95], v[48:51]
s_waitcnt lgkmcnt(5)
v_mfma_f32_16x16x32_bf16 v[48:51], v[184:187], a[96:99], v[48:51]
s_waitcnt lgkmcnt(4)
v_mfma_f32_16x16x32_bf16 v[48:51], v[188:191], a[100:103], v[48:51]
s_waitcnt lgkmcnt(3)
v_mfma_f32_16x16x32_bf16 v[48:51], v[192:195], a[104:107], v[48:51]
s_waitcnt lgkmcnt(2)
v_mfma_f32_16x16x32_bf16 v[48:51], v[196:199], a[108:111], v[48:51]
s_waitcnt lgkmcnt(1)
v_mfma_f32_16x16x32_bf16 v[48:51], v[200:203], a[112:115], v[48:51]
s_waitcnt lgkmcnt(0)
v_mfma_f32_16x16x32_bf16 v[48:51], v[204:207], a[116:119], v[48:51]
s_cmp_eq_u32 s12, 3
s_cbranch_scc1 reca_swave96
s_nop 5
ds_write_b128 v17, v[48:51]
s_add_u32 s34, s17, 2
s_and_b32 s34, s34, 3
s_mul_i32 s26, s34, 10240
s_add_u32 s26, s26, s38
s_mul_i32 s27, s34, 6144
s_add_u32 s27, s27, s39
s_mul_i32 s28, s34, 12288
s_add_u32 s28, s28, s40
s_mul_i32 s29, s34, 393216
s_add_u32 s29, s29, s56
s_waitcnt lgkmcnt(0)
s_barrier
s_cmp_eq_u32 s17, 63
s_cbranch_scc1 reca_last98
buffer_store_dwordx2 v[32:33], v8, s[4:7], s27 offen
s_cmp_lg_u32 s12, 2
s_cbranch_scc1 reca_tw1102_n
buffer_store_dwordx2 v[52:53], v9, s[4:7], s30 offen
reca_tw1102_n:
s_barrier
s_cmp_eq_u32 s12, 1
s_cbranch_scc1 reca_tw1102
s_cmp_eq_u32 s12, 2
s_cbranch_scc1 reca_tw2103
s_cmp_lt_u32 s17, 2
s_cbranch_scc1 reca_b5101
s_cmp_gt_u32 s17, 61
s_cbranch_scc1 reca_b5101
s_sub_u32 s36, s17, 2
s_and_b32 s36, s36, 7
s_lshl_b32 s34, s59, 3
s_add_u32 s34, s34, s36
s_mul_i32 s34, s34, 12288
s_add_u32 s23, s34, 37748736
s_add_u32 s60, s34, 44040192
s_lshl_b32 s35, s36, 5
s_add_u32 s35, s35, s59
s_mul_i32 s35, s35, 3072
s_add_u32 s61, s35, 47185920
buffer_load_dwordx4 a[120:123], v1, s[4:7], s23 offen offset:0 sc1
buffer_load_dwordx4 a[124:127], v1, s[4:7], s23 offen offset:1024 sc1
buffer_load_dwordx4 a[128:131], v1, s[4:7], s23 offen offset:2048 sc1
buffer_load_dwordx4 a[132:135], v1, s[4:7], s23 offen offset:3072 sc1
buffer_load_dwordx4 a[136:139], v2, s[4:7], s23 offen offset:0 sc1
buffer_load_dwordx4 a[140:143], v2, s[4:7], s23 offen offset:1024 sc1
buffer_load_dwordx4 a[144:147], v2, s[4:7], s23 offen offset:2048 sc1
buffer_load_dwordx4 a[148:151], v2, s[4:7], s23 offen offset:3072 sc1
buffer_load_dwordx4 a[152:155], v3, s[4:7], s23 offen offset:0 sc1
buffer_load_dwordx4 a[156:159], v3, s[4:7], s23 offen offset:1024 sc1
buffer_load_dwordx4 a[160:163], v3, s[4:7], s23 offen offset:2048 sc1
buffer_load_dwordx4 a[164:167], v3, s[4:7], s23 offen offset:3072 sc1
buffer_load_dwordx4 a[216:219], v92, s[4:7], s61 offen offset:0 sc1
buffer_load_dwordx4 a[220:223], v92, s[4:7], s61 offen offset:512 sc1
buffer_load_dwordx4 a[224:227], v92, s[4:7], s61 offen offset:1024 sc1
buffer_load_dwordx4 a[228:231], v92, s[4:7], s61 offen offset:1536 sc1
buffer_load_dwordx4 a[232:235], v92, s[4:7], s61 offen offset:2048 sc1
buffer_load_dwordx4 a[236:239], v92, s[4:7], s61 offen offset:2560 sc1
buffer_load_dwordx4 a[168:171], v1, s[4:7], s60 offen offset:0 sc1
buffer_load_dwordx4 a[172:175], v1, s[4:7], s60 offen offset:1024 sc1
buffer_load_dwordx4 a[176:179], v1, s[4:7], s60 offen offset:2048 sc1
buffer_load_dwordx4 a[180:183], v1, s[4:7], s60 offen offset:3072 sc1
buffer_load_dwordx4 a[184:187], v2, s[4:7], s60 offen offset:0 sc1
buffer_load_dwordx4 a[188:191], v2, s[4:7], s60 offen offset:1024 sc1
buffer_load_dwordx4 a[192:195], v2, s[4:7], s60 offen offset:2048 sc1
buffer_load_dwordx4 a[196:199], v2, s[4:7], s60 offen offset:3072 sc1
buffer_load_dwordx4 a[200:203], v3, s[4:7], s60 offen offset:0 sc1
buffer_load_dwordx4 a[204:207], v3, s[4:7], s60 offen offset:1024 sc1
buffer_load_dwordx4 a[208:211], v3, s[4:7], s60 offen offset:2048 sc1
buffer_load_dwordx4 a[212:215], v3, s[4:7], s60 offen offset:3072 sc1
s_waitcnt vmcnt(5)
v_mfma_f32_16x16x32_bf16 v[128:131], a[216:219], a[168:171], v[84:87]
v_mfma_f32_16x16x32_bf16 v[132:135], a[120:123], a[168:171], v[88:91]
v_mfma_f32_16x16x32_bf16 v[136:139], a[216:219], a[192:195], v[84:87]
v_mfma_f32_16x16x32_bf16 v[140:143], a[120:123], a[192:195], 0
v_mfma_f32_16x16x32_bf16 v[144:147], a[144:147], a[192:195], v[88:91]
s_waitcnt vmcnt(4)
v_mfma_f32_16x16x32_bf16 v[128:131], a[220:223], a[172:175], v[128:131]
v_mfma_f32_16x16x32_bf16 v[132:135], a[124:127], a[172:175], v[132:135]
v_mfma_f32_16x16x32_bf16 v[136:139], a[220:223], a[196:199], v[136:139]
v_mfma_f32_16x16x32_bf16 v[140:143], a[124:127], a[196:199], v[140:143]
v_mfma_f32_16x16x32_bf16 v[144:147], a[148:151], a[196:199], v[144:147]
s_waitcnt vmcnt(3)
v_mfma_f32_16x16x32_bf16 v[128:131], a[224:227], a[176:179], v[128:131]
v_mfma_f32_16x16x32_bf16 v[132:135], a[128:131], a[176:179], v[132:135]
v_mfma_f32_16x16x32_bf16 v[136:139], a[224:227], a[200:203], v[136:139]
v_mfma_f32_16x16x32_bf16 v[140:143], a[128:131], a[200:203], v[140:143]
v_mfma_f32_16x16x32_bf16 v[144:147], a[152:155], a[200:203], v[144:147]
s_waitcnt vmcnt(2)
v_mfma_f32_16x16x32_bf16 v[128:131], a[228:231], a[180:183], v[128:131]
v_mfma_f32_16x16x32_bf16 v[132:135], a[132:135], a[180:183], v[132:135]
v_mfma_f32_16x16x32_bf16 v[136:139], a[228:231], a[204:207], v[136:139]
v_mfma_f32_16x16x32_bf16 v[140:143], a[132:135], a[204:207], v[140:143]
v_mfma_f32_16x16x32_bf16 v[144:147], a[156:159], a[204:207], v[144:147]
s_waitcnt vmcnt(1)
v_mfma_f32_16x16x32_bf16 v[128:131], a[232:235], a[184:187], v[128:131]
v_mfma_f32_16x16x32_bf16 v[132:135], a[136:139], a[184:187], v[132:135]
v_mfma_f32_16x16x32_bf16 v[136:139], a[232:235], a[208:211], v[136:139]
v_mfma_f32_16x16x32_bf16 v[140:143], a[136:139], a[208:211], v[140:143]
v_mfma_f32_16x16x32_bf16 v[144:147], a[160:163], a[208:211], v[144:147]
s_waitcnt vmcnt(0)
v_mfma_f32_16x16x32_bf16 v[128:131], a[236:239], a[188:191], v[128:131]
v_mfma_f32_16x16x32_bf16 v[132:135], a[140:143], a[188:191], v[132:135]
v_mfma_f32_16x16x32_bf16 v[136:139], a[236:239], a[212:215], v[136:139]
v_mfma_f32_16x16x32_bf16 v[140:143], a[140:143], a[212:215], v[140:143]
v_mfma_f32_16x16x32_bf16 v[144:147], a[164:167], a[212:215], v[144:147]
s_nop 3
v_max3_f32 v28, v128, v129, v130
v_max3_f32 v28, v28, v131, v132
v_max3_f32 v28, v28, v133, v134
v_max_f32 v28, v28, v135
v_mov_b32 v29, v28
s_nop 1
v_permlane32_swap_b32 v28, v29
v_max_f32 v28, v28, v29
v_mov_b32 v29, v28
s_nop 1
v_permlane16_swap_b32 v28, v29
v_max_f32 v28, v28, v29
v_mul_f32 v28, s41, v28
v_fma_f32 v128, v128, s41, -v28
v_fma_f32 v129, v129, s41, -v28
v_fma_f32 v130, v130, s41, -v28
v_fma_f32 v131, v131, s41, -v28
v_fma_f32 v132, v132, s41, -v28
v_fma_f32 v133, v133, s41, -v28
v_fma_f32 v134, v134, s41, -v28
v_fma_f32 v135, v135, s41, -v28
v_exp_f32 v128, v128
v_exp_f32 v129, v129
v_exp_f32 v130, v130
v_exp_f32 v131, v131
v_exp_f32 v132, v132
v_exp_f32 v133, v133
v_exp_f32 v134, v134
v_exp_f32 v135, v135
v_max3_f32 v30, v136, v137, v138
v_max3_f32 v30, v30, v139, v140
v_max3_f32 v30, v30, v141, v142
v_max3_f32 v30, v30, v143, v144
v_max3_f32 v30, v30, v145, v146
v_max_f32 v30, v30, v147
v_mov_b32 v29, v30
s_nop 1
v_permlane32_swap_b32 v30, v29
v_max_f32 v30, v30, v29
v_mov_b32 v29, v30
s_nop 1
v_permlane16_swap_b32 v30, v29
v_max_f32 v30, v30, v29
v_mul_f32 v30, s41, v30
v_fma_f32 v136, v136, s41, -v30
v_fma_f32 v137, v137, s41, -v30
v_fma_f32 v138, v138, s41, -v30
v_fma_f32 v139, v139, s41, -v30
v_fma_f32 v140, v140, s41, -v30
v_fma_f32 v141, v141, s41, -v30
v_fma_f32 v142, v142, s41, -v30
v_fma_f32 v143, v143, s41, -v30
v_fma_f32 v144, v144, s41, -v30
v_fma_f32 v145, v145, s41, -v30
v_fma_f32 v146, v146, s41, -v30
v_fma_f32 v147, v147, s41, -v30
v_exp_f32 v136, v136
v_exp_f32 v137, v137
v_exp_f32 v138, v138
v_exp_f32 v139, v139
v_exp_f32 v140, v140
v_exp_f32 v141, v141
v_exp_f32 v142, v142
v_exp_f32 v143, v143
v_exp_f32 v144, v144
v_exp_f32 v145, v145
v_exp_f32 v146, v146
v_exp_f32 v147, v147
v_cvt_pk_bf16_f32 v72, v128, v129
v_cvt_pk_bf16_f32 v73, v130, v131
v_cvt_pk_bf16_f32 v74, v132, v133
v_cvt_pk_bf16_f32 v75, v134, v135
v_cvt_pk_bf16_f32 v76, v136, v137
v_cvt_pk_bf16_f32 v77, v138, v139
v_cvt_pk_bf16_f32 v78, v140, v141
v_cvt_pk_bf16_f32 v79, v142, v143
v_cvt_pk_bf16_f32 v80, v144, v145
v_cvt_pk_bf16_f32 v81, v146, v147
v_mfma_f32_16x16x16_bf16 v[148:151], v[36:37], v[72:73], 0
v_mfma_f32_16x16x16_bf16 v[152:155], v[36:37], v[76:77], 0
v_mfma_f32_16x16x16_bf16 v[148:151], v[36:37], v[74:75], v[148:151]
v_mfma_f32_16x16x32_bf16 v[152:155], v[36:39], v[78:81], v[152:155]
s_nop 6
v_rcp_f32 v82, v148
v_rcp_f32 v83, v152
s_and_b32 s34, s17, 1
s_mul_i32 s34, s34, 3072
v_add_u32 v28, s34, v1
ds_write_b128 v28, v[72:75] offset:16384
ds_write_b128 v28, v[76:79] offset:17408
ds_write_b128 v28, v[80:83] offset:18432
s_waitcnt lgkmcnt(0)
s_branch reca_b5101
reca_tw1102:
s_cmp_lt_u32 s17, 3
s_cbranch_scc1 reca_b5101
s_sub_u32 s36, s17, 3
s_and_b32 s37, s36, 7
s_lshl_b32 s34, s59, 3
s_add_u32 s34, s34, s37
s_mul_i32 s34, s34, 12288
s_add_u32 s23, s34, 40894464
s_lshl_b32 s35, s37, 5
s_add_u32 s35, s35, s59
s_mul_i32 s35, s35, 3072
s_add_u32 s61, s35, 47972352
s_mul_i32 s34, s36, 393216
s_mul_i32 s35, s59, 6144
s_add_u32 s34, s34, s35
s_add_u32 s60, s34, 57147392
s_add_u32 s34, s17, 1
s_and_b32 s34, s34, 1
s_mul_i32 s34, s34, 3072
v_add_u32 v28, s34, v1
ds_read_b128 v[72:75], v28 offset:16384
ds_read_b128 v[76:79], v28 offset:17408
ds_read_b128 v[80:83], v28 offset:18432
buffer_load_dwordx2 a[168:169], v93, s[4:7], s61 offen offset:0 sc1
buffer_load_dwordx4 a[120:123], v1, s[4:7], s23 offen offset:0 sc1
buffer_load_dwordx2 a[170:171], v93, s[4:7], s61 offen offset:256 sc1
buffer_load_dwordx4 a[124:127], v1, s[4:7], s23 offen offset:1024 sc1
buffer_load_dwordx2 a[172:173], v93, s[4:7], s61 offen offset:512 sc1
buffer_load_dwordx4 a[128:131], v1, s[4:7], s23 offen offset:2048 sc1
buffer_load_dwordx2 a[174:175], v93, s[4:7], s61 offen offset:768 sc1
buffer_load_dwordx4 a[132:135], v1, s[4:7], s23 offen offset:3072 sc1
buffer_load_dwordx2 a[176:177], v93, s[4:7], s61 offen offset:1024 sc1
buffer_load_dwordx4 a[136:139], v2, s[4:7], s23 offen offset:0 sc1
buffer_load_dwordx2 a[178:179], v93, s[4:7], s61 offen offset:1280 sc1
buffer_load_dwordx4 a[140:143], v2, s[4:7], s23 offen offset:1024 sc1
s_waitcnt lgkmcnt(0)
s_waitcnt vmcnt(8)
v_mfma_f32_16x16x16_bf16 v[156:159], a[168:169], v[72:73], 0
v_mfma_f32_16x16x16_bf16 v[160:163], a[168:169], v[76:77], 0
v_mfma_f32_16x16x16_bf16 v[156:159], a[120:121], v[74:75], v[156:159]
v_mfma_f32_16x16x32_bf16 v[160:163], a[120:123], v[78:81], v[160:163]
v_mfma_f32_16x16x16_bf16 v[164:167], a[170:171], v[72:73], 0
v_mfma_f32_16x16x16_bf16 v[168:171], a[170:171], v[76:77], 0
v_mfma_f32_16x16x16_bf16 v[164:167], a[124:125], v[74:75], v[164:167]
v_mfma_f32_16x16x32_bf16 v[168:171], a[124:127], v[78:81], v[168:171]
s_nop 2
v_mul_f32 v156, v156, v82
v_mul_f32 v157, v157, v82
v_mul_f32 v158, v158, v82
v_mul_f32 v159, v159, v82
v_cvt_pk_bf16_f32 v172, v156, v157
v_cvt_pk_bf16_f32 v173, v158, v159
v_mul_f32 v164, v164, v82
v_mul_f32 v165, v165, v82
v_mul_f32 v166, v166, v82
v_mul_f32 v167, v167, v82
v_cvt_pk_bf16_f32 v174, v164, v165
v_cvt_pk_bf16_f32 v175, v166, v167
buffer_store_dwordx4 v[172:175], v1, s[4:7], s60 offen offset:0 sc1
v_mul_f32 v160, v160, v83
v_mul_f32 v161, v161, v83
v_mul_f32 v162, v162, v83
v_mul_f32 v163, v163, v83
v_cvt_pk_bf16_f32 v176, v160, v161
v_cvt_pk_bf16_f32 v177, v162, v163
v_mul_f32 v168, v168, v83
v_mul_f32 v169, v169, v83
v_mul_f32 v170, v170, v83
v_mul_f32 v171, v171, v83
v_cvt_pk_bf16_f32 v178, v168, v169
v_cvt_pk_bf16_f32 v179, v170, v171
s_add_u32 s34, s60, 196608
buffer_store_dwordx4 v[176:179], v1, s[4:7], s34 offen offset:0 sc1
s_waitcnt vmcnt(6)
v_mfma_f32_16x16x16_bf16 v[156:159], a[172:173], v[72:73], 0
v_mfma_f32_16x16x16_bf16 v[160:163], a[172:173], v[76:77], 0
v_mfma_f32_16x16x16_bf16 v[156:159], a[128:129], v[74:75], v[156:159]
v_mfma_f32_16x16x32_bf16 v[160:163], a[128:131], v[78:81], v[160:163]
v_mfma_f32_16x16x16_bf16 v[164:167], a[174:175], v[72:73], 0
v_mfma_f32_16x16x16_bf16 v[168:171], a[174:175], v[76:77], 0
v_mfma_f32_16x16x16_bf16 v[164:167], a[132:133], v[74:75], v[164:167]
v_mfma_f32_16x16x32_bf16 v[168:171], a[132:135], v[78:81], v[168:171]
s_nop 2
v_mul_f32 v156, v156, v82
v_mul_f32 v157, v157, v82
v_mul_f32 v158, v158, v82
v_mul_f32 v159, v159, v82
v_cvt_pk_bf16_f32 v172, v156, v157
v_cvt_pk_bf16_f32 v173, v158, v159
v_mul_f32 v164, v164, v82
v_mul_f32 v165, v165, v82
v_mul_f32 v166, v166, v82
v_mul_f32 v167, v167, v82
v_cvt_pk_bf16_f32 v174, v164, v165
v_cvt_pk_bf16_f32 v175, v166, v167
buffer_store_dwordx4 v[172:175], v1, s[4:7], s60 offen offset:1024 sc1
v_mul_f32 v160, v160, v83
v_mul_f32 v161, v161, v83
v_mul_f32 v162, v162, v83
v_mul_f32 v163, v163, v83
v_cvt_pk_bf16_f32 v176, v160, v161
v_cvt_pk_bf16_f32 v177, v162, v163
v_mul_f32 v168, v168, v83
v_mul_f32 v169, v169, v83
v_mul_f32 v170, v170, v83
v_mul_f32 v171, v171, v83
v_cvt_pk_bf16_f32 v178, v168, v169
v_cvt_pk_bf16_f32 v179, v170, v171
s_add_u32 s34, s60, 196608
buffer_store_dwordx4 v[176:179], v1, s[4:7], s34 offen offset:1024 sc1
s_waitcnt vmcnt(4)
v_mfma_f32_16x16x16_bf16 v[156:159], a[176:177], v[72:73], 0
v_mfma_f32_16x16x16_bf16 v[160:163], a[176:177], v[76:77], 0
v_mfma_f32_16x16x16_bf16 v[156:159], a[136:137], v[74:75], v[156:159]
v_mfma_f32_16x16x32_bf16 v[160:163], a[136:139], v[78:81], v[160:163]
v_mfma_f32_16x16x16_bf16 v[164:167], a[178:179], v[72:73], 0
v_mfma_f32_16x16x16_bf16 v[168:171], a[178:179], v[76:77], 0
v_mfma_f32_16x16x16_bf16 v[164:167], a[140:141], v[74:75], v[164:167]
v_mfma_f32_16x16x32_bf16 v[168:171], a[140:143], v[78:81], v[168:171]
s_nop 2
v_mul_f32 v156, v156, v82
v_mul_f32 v157, v157, v82
v_mul_f32 v158, v158, v82
v_mul_f32 v159, v159, v82
v_cvt_pk_bf16_f32 v172, v156, v157
v_cvt_pk_bf16_f32 v173, v158, v159
v_mul_f32 v164, v164, v82
v_mul_f32 v165, v165, v82
v_mul_f32 v166, v166, v82
v_mul_f32 v167, v167, v82
v_cvt_pk_bf16_f32 v174, v164, v165
v_cvt_pk_bf16_f32 v175, v166, v167
buffer_store_dwordx4 v[172:175], v1, s[4:7], s60 offen offset:2048 sc1
v_mul_f32 v160, v160, v83
v_mul_f32 v161, v161, v83
v_mul_f32 v162, v162, v83
v_mul_f32 v163, v163, v83
v_cvt_pk_bf16_f32 v176, v160, v161
v_cvt_pk_bf16_f32 v177, v162, v163
v_mul_f32 v168, v168, v83
v_mul_f32 v169, v169, v83
v_mul_f32 v170, v170, v83
v_mul_f32 v171, v171, v83
v_cvt_pk_bf16_f32 v178, v168, v169
v_cvt_pk_bf16_f32 v179, v170, v171
s_add_u32 s34, s60, 196608
buffer_store_dwordx4 v[176:179], v1, s[4:7], s34 offen offset:2048 sc1
s_branch reca_b5101
reca_tw2103:
s_cmp_lt_u32 s17, 3
s_cbranch_scc1 reca_b5101
s_sub_u32 s36, s17, 3
s_and_b32 s37, s36, 7
s_lshl_b32 s34, s59, 3
s_add_u32 s34, s34, s37
s_mul_i32 s34, s34, 12288
s_add_u32 s23, s34, 40894464
s_lshl_b32 s35, s37, 5
s_add_u32 s35, s35, s59
s_mul_i32 s35, s35, 3072
s_add_u32 s61, s35, 47972352
s_mul_i32 s34, s36, 393216
s_mul_i32 s35, s59, 6144
s_add_u32 s34, s34, s35
s_add_u32 s60, s34, 57147392
s_add_u32 s34, s17, 1
s_and_b32 s34, s34, 1
s_mul_i32 s34, s34, 3072
v_add_u32 v28, s34, v1
ds_read_b128 v[72:75], v28 offset:16384
ds_read_b128 v[76:79], v28 offset:17408
ds_read_b128 v[80:83], v28 offset:18432
buffer_load_dwordx2 a[180:181], v93, s[4:7], s61 offen offset:1536 sc1
buffer_load_dwordx4 a[144:147], v2, s[4:7], s23 offen offset:2048 sc1
buffer_load_dwordx2 a[182:183], v93, s[4:7], s61 offen offset:1792 sc1
buffer_load_dwordx4 a[148:151], v2, s[4:7], s23 offen offset:3072 sc1
buffer_load_dwordx2 a[184:185], v93, s[4:7], s61 offen offset:2048 sc1
buffer_load_dwordx4 a[152:155], v3, s[4:7], s23 offen offset:0 sc1
buffer_load_dwordx2 a[186:187], v93, s[4:7], s61 offen offset:2304 sc1
buffer_load_dwordx4 a[156:159], v3, s[4:7], s23 offen offset:1024 sc1
buffer_load_dwordx2 a[188:189], v93, s[4:7], s61 offen offset:2560 sc1
buffer_load_dwordx4 a[160:163], v3, s[4:7], s23 offen offset:2048 sc1
buffer_load_dwordx2 a[190:191], v93, s[4:7], s61 offen offset:2816 sc1
buffer_load_dwordx4 a[164:167], v3, s[4:7], s23 offen offset:3072 sc1
s_waitcnt lgkmcnt(0)
s_waitcnt vmcnt(8)
v_mfma_f32_16x16x16_bf16 v[156:159], a[180:181], v[72:73], 0
v_mfma_f32_16x16x16_bf16 v[160:163], a[180:181], v[76:77], 0
v_mfma_f32_16x16x16_bf16 v[156:159], a[144:145], v[74:75], v[156:159]
v_mfma_f32_16x16x32_bf16 v[160:163], a[144:147], v[78:81], v[160:163]
v_mfma_f32_16x16x16_bf16 v[164:167], a[182:183], v[72:73], 0
v_mfma_f32_16x16x16_bf16 v[168:171], a[182:183], v[76:77], 0
v_mfma_f32_16x16x16_bf16 v[164:167], a[148:149], v[74:75], v[164:167]
v_mfma_f32_16x16x32_bf16 v[168:171], a[148:151], v[78:81], v[168:171]
s_nop 2
v_mul_f32 v156, v156, v82
v_mul_f32 v157, v157, v82
v_mul_f32 v158, v158, v82
v_mul_f32 v159, v159, v82
v_cvt_pk_bf16_f32 v172, v156, v157
v_cvt_pk_bf16_f32 v173, v158, v159
v_mul_f32 v164, v164, v82
v_mul_f32 v165, v165, v82
v_mul_f32 v166, v166, v82
v_mul_f32 v167, v167, v82
v_cvt_pk_bf16_f32 v174, v164, v165
v_cvt_pk_bf16_f32 v175, v166, v167
buffer_store_dwordx4 v[172:175], v1, s[4:7], s60 offen offset:3072 sc1
v_mul_f32 v160, v160, v83
v_mul_f32 v161, v161, v83
v_mul_f32 v162, v162, v83
v_mul_f32 v163, v163, v83
v_cvt_pk_bf16_f32 v176, v160, v161
v_cvt_pk_bf16_f32 v177, v162, v163
v_mul_f32 v168, v168, v83
v_mul_f32 v169, v169, v83
v_mul_f32 v170, v170, v83
v_mul_f32 v171, v171, v83
v_cvt_pk_bf16_f32 v178, v168, v169
v_cvt_pk_bf16_f32 v179, v170, v171
s_add_u32 s34, s60, 196608
buffer_store_dwordx4 v[176:179], v1, s[4:7], s34 offen offset:3072 sc1
s_waitcnt vmcnt(6)
v_mfma_f32_16x16x16_bf16 v[156:159], a[184:185], v[72:73], 0
v_mfma_f32_16x16x16_bf16 v[160:163], a[184:185], v[76:77], 0
v_mfma_f32_16x16x16_bf16 v[156:159], a[152:153], v[74:75], v[156:159]
v_mfma_f32_16x16x32_bf16 v[160:163], a[152:155], v[78:81], v[160:163]
v_mfma_f32_16x16x16_bf16 v[164:167], a[186:187], v[72:73], 0
v_mfma_f32_16x16x16_bf16 v[168:171], a[186:187], v[76:77], 0
v_mfma_f32_16x16x16_bf16 v[164:167], a[156:157], v[74:75], v[164:167]
v_mfma_f32_16x16x32_bf16 v[168:171], a[156:159], v[78:81], v[168:171]
s_nop 2
v_mul_f32 v156, v156, v82
v_mul_f32 v157, v157, v82
v_mul_f32 v158, v158, v82
v_mul_f32 v159, v159, v82
v_cvt_pk_bf16_f32 v172, v156, v157
v_cvt_pk_bf16_f32 v173, v158, v159
v_mul_f32 v164, v164, v82
v_mul_f32 v165, v165, v82
v_mul_f32 v166, v166, v82
v_mul_f32 v167, v167, v82
v_cvt_pk_bf16_f32 v174, v164, v165
v_cvt_pk_bf16_f32 v175, v166, v167
buffer_store_dwordx4 v[172:175], v2, s[4:7], s60 offen offset:0 sc1
v_mul_f32 v160, v160, v83
v_mul_f32 v161, v161, v83
v_mul_f32 v162, v162, v83
v_mul_f32 v163, v163, v83
v_cvt_pk_bf16_f32 v176, v160, v161
v_cvt_pk_bf16_f32 v177, v162, v163
v_mul_f32 v168, v168, v83
v_mul_f32 v169, v169, v83
v_mul_f32 v170, v170, v83
v_mul_f32 v171, v171, v83
v_cvt_pk_bf16_f32 v178, v168, v169
v_cvt_pk_bf16_f32 v179, v170, v171
s_add_u32 s34, s60, 196608
buffer_store_dwordx4 v[176:179], v2, s[4:7], s34 offen offset:0 sc1
s_waitcnt vmcnt(4)
v_mfma_f32_16x16x16_bf16 v[156:159], a[188:189], v[72:73], 0
v_mfma_f32_16x16x16_bf16 v[160:163], a[188:189], v[76:77], 0
v_mfma_f32_16x16x16_bf16 v[156:159], a[160:161], v[74:75], v[156:159]
v_mfma_f32_16x16x32_bf16 v[160:163], a[160:163], v[78:81], v[160:163]
v_mfma_f32_16x16x16_bf16 v[164:167], a[190:191], v[72:73], 0
v_mfma_f32_16x16x16_bf16 v[168:171], a[190:191], v[76:77], 0
v_mfma_f32_16x16x16_bf16 v[164:167], a[164:165], v[74:75], v[164:167]
v_mfma_f32_16x16x32_bf16 v[168:171], a[164:167], v[78:81], v[168:171]
s_nop 2
v_mul_f32 v156, v156, v82
v_mul_f32 v157, v157, v82
v_mul_f32 v158, v158, v82
v_mul_f32 v159, v159, v82
v_cvt_pk_bf16_f32 v172, v156, v157
v_cvt_pk_bf16_f32 v173, v158, v159
v_mul_f32 v164, v164, v82
v_mul_f32 v165, v165, v82
v_mul_f32 v166, v166, v82
v_mul_f32 v167, v167, v82
v_cvt_pk_bf16_f32 v174, v164, v165
v_cvt_pk_bf16_f32 v175, v166, v167
buffer_store_dwordx4 v[172:175], v2, s[4:7], s60 offen offset:1024 sc1
v_mul_f32 v160, v160, v83
v_mul_f32 v161, v161, v83
v_mul_f32 v162, v162, v83
v_mul_f32 v163, v163, v83
v_cvt_pk_bf16_f32 v176, v160, v161
v_cvt_pk_bf16_f32 v177, v162, v163
v_mul_f32 v168, v168, v83
v_mul_f32 v169, v169, v83
v_mul_f32 v170, v170, v83
v_mul_f32 v171, v171, v83
v_cvt_pk_bf16_f32 v178, v168, v169
v_cvt_pk_bf16_f32 v179, v170, v171
s_add_u32 s34, s60, 196608
buffer_store_dwordx4 v[176:179], v2, s[4:7], s34 offen offset:1024 sc1
s_branch reca_b5101
s_cmp_lg_u32 s12, 2
s_cbranch_scc1 reca_b399
buffer_store_dwordx2 v[52:53], v9, s[4:7], s30 offen
buffer_store_dwordx2 v[32:33], v16, s[4:7], s26 offen
s_cmp_lg_u32 s14, 0
s_cbranch_scc1 reca_b399
v_mov_b32 v28, s17
s_lshl_b32 s34, s13, 7
s_add_u32 s34, s34, 1507328
buffer_store_dword v28, v19, s[4:7], s34 offen
s_branch reca_b399
reca_last98:
s_cmp_lg_u32 s12, 2
s_cbranch_scc1 reca_exit1
buffer_store_dwordx2 v[52:53], v9, s[4:7], s30 offen
s_branch reca_exit1
reca_swave96:
s_cmp_lg_u32 s17, 63
s_cbranch_scc1 reca_vmst104
s_barrier
ds_read_b128 v[56:59], v1 offset:10240
ds_read_b128 v[60:63], v1 offset:11264
ds_read_b128 v[64:67], v1 offset:12288
s_waitcnt lgkmcnt(0)
v_add_f32 v56, v56, v64
v_add_f32 v60, v60, v48
v_add_f32 v57, v57, v65
v_add_f32 v61, v61, v49
v_add_f32 v58, v58, v66
v_add_f32 v62, v62, v50
v_add_f32 v59, v59, v67
v_add_f32 v63, v63, v51
v_cvt_pk_bf16_f32 v68, v56, v57
v_cvt_pk_bf16_f32 v69, v58, v59
v_cvt_pk_bf16_f32 v70, v60, v61
v_cvt_pk_bf16_f32 v71, v62, v63
buffer_store_dwordx2 v[52:53], v9, s[4:7], s30 offen
buffer_store_dwordx2 v[68:69], v10, s[4:7], s31 offen
buffer_store_dwordx2 v[70:71], v10, s[4:7], s31 offen offset:256
s_branch reca_exit1
reca_vmst104:
s_sleep 1
buffer_load_dwordx4 v[208:211], v1, s[4:7], s21 offen offset:0 sc1
buffer_load_dwordx4 v[212:215], v1, s[4:7], s21 offen offset:1024 sc1
buffer_load_dwordx4 v[216:219], v1, s[4:7], s21 offen offset:2048 sc1
buffer_load_dwordx4 v[220:223], v1, s[4:7], s21 offen offset:3072 sc1
buffer_load_dwordx4 v[224:227], v2, s[4:7], s21 offen offset:0 sc1
buffer_load_dwordx4 v[228:231], v2, s[4:7], s21 offen offset:1024 sc1
s_waitcnt vmcnt(5)
v_max_u32 v29, v208, v210
v_cmp_eq_u32 vcc, -1, v29
s_cbranch_vccnz reca_retry105
reca_resume106:
s_waitcnt vmcnt(4)
v_max_u32 v29, v212, v214
v_cmp_eq_u32 vcc, -1, v29
v_mfma_f32_16x16x32_bf16 v[76:79], a[120:123], v[208:211], 0
v_mfma_f32_16x16x32_bf16 v[80:83], a[144:147], v[208:211], 0
v_mfma_f32_16x16x32_bf16 v[72:75], v[208:211], v[208:211], v[40:43]
s_cbranch_vccnz reca_retry107
reca_resume108:
s_waitcnt vmcnt(3)
v_max_u32 v29, v216, v218
v_cmp_eq_u32 vcc, -1, v29
v_mfma_f32_16x16x32_bf16 v[76:79], a[124:127], v[212:215], v[76:79]
v_mfma_f32_16x16x32_bf16 v[80:83], a[148:151], v[212:215], v[80:83]
v_mfma_f32_16x16x32_bf16 v[72:75], v[212:215], v[212:215], v[72:75]
s_cbranch_vccnz reca_retry109
reca_resume110:
s_waitcnt vmcnt(2)
v_max_u32 v29, v220, v222
v_cmp_eq_u32 vcc, -1, v29
v_mfma_f32_16x16x32_bf16 v[76:79], a[128:131], v[216:219], v[76:79]
v_mfma_f32_16x16x32_bf16 v[80:83], a[152:155], v[216:219], v[80:83]
v_mfma_f32_16x16x32_bf16 v[72:75], v[216:219], v[216:219], v[72:75]
s_cbranch_vccnz reca_retry111
reca_resume112:
s_waitcnt vmcnt(1)
v_max_u32 v29, v224, v226
v_cmp_eq_u32 vcc, -1, v29
v_mfma_f32_16x16x32_bf16 v[76:79], a[132:135], v[220:223], v[76:79]
v_mfma_f32_16x16x32_bf16 v[80:83], a[156:159], v[220:223], v[80:83]
v_mfma_f32_16x16x32_bf16 v[72:75], v[220:223], v[220:223], v[72:75]
s_cbranch_vccnz reca_retry113
reca_resume114:
s_waitcnt vmcnt(0)
v_max_u32 v29, v228, v230
v_cmp_eq_u32 vcc, -1, v29
v_mfma_f32_16x16x32_bf16 v[76:79], a[136:139], v[224:227], v[76:79]
v_mfma_f32_16x16x32_bf16 v[80:83], a[160:163], v[224:227], v[80:83]
v_mfma_f32_16x16x32_bf16 v[72:75], v[224:227], v[224:227], v[72:75]
s_cbranch_vccnz reca_retry115
reca_resume116:
v_mfma_f32_16x16x32_bf16 v[76:79], a[140:143], v[228:231], v[76:79]
v_mfma_f32_16x16x32_bf16 v[80:83], a[164:167], v[228:231], v[80:83]
v_mfma_f32_16x16x32_bf16 v[72:75], v[228:231], v[228:231], v[72:75]
s_barrier
ds_read_b128 v[56:59], v1 offset:10240
ds_read_b128 v[60:63], v1 offset:11264
ds_read_b128 v[64:67], v1 offset:12288
s_nop 1
v_max3_f32 v28, v76, v77, v78
v_max3_f32 v29, v80, v81, v82
v_max3_f32 v28, v28, v79, v83
v_max3_f32 v29, v29, v72, v73
v_max3_f32 v28, v28, v74, v75
v_max_f32 v28, v28, v29
v_mov_b32 v29, v28
s_nop 1
v_permlane32_swap_b32 v28, v29
v_max_f32 v28, v28, v29
v_mov_b32 v29, v28
s_nop 1
v_permlane16_swap_b32 v28, v29
v_max_f32 v28, v28, v29
v_mul_f32 v28, s41, v28
v_fma_f32 v76, v76, s41, -v28
v_fma_f32 v77, v77, s41, -v28
v_fma_f32 v78, v78, s41, -v28
v_fma_f32 v79, v79, s41, -v28
v_fma_f32 v80, v80, s41, -v28
v_fma_f32 v81, v81, s41, -v28
v_fma_f32 v82, v82, s41, -v28
v_fma_f32 v83, v83, s41, -v28
v_fma_f32 v72, v72, s41, -v28
v_fma_f32 v73, v73, s41, -v28
v_fma_f32 v74, v74, s41, -v28
v_fma_f32 v75, v75, s41, -v28
v_exp_f32 v76, v76
v_exp_f32 v77, v77
v_exp_f32 v78, v78
v_exp_f32 v79, v79
v_exp_f32 v80, v80
v_exp_f32 v81, v81
v_exp_f32 v82, v82
v_exp_f32 v83, v83
v_cvt_pk_bf16_f32 v84, v76, v77
v_cvt_pk_bf16_f32 v85, v78, v79
v_cvt_pk_bf16_f32 v86, v80, v81
v_cvt_pk_bf16_f32 v87, v82, v83
v_exp_f32 v72, v72
v_exp_f32 v73, v73
v_mfma_f32_16x16x32_bf16 v[100:103], v[36:39], v[84:87], 0
v_exp_f32 v74, v74
v_exp_f32 v75, v75
v_mfma_f32_16x16x32_bf16 v[92:95], a[168:171], v[84:87], 0
v_cvt_pk_bf16_f32 v88, v72, v73
v_cvt_pk_bf16_f32 v89, v74, v75
v_mfma_f32_16x16x32_bf16 v[96:99], a[172:175], v[84:87], 0
s_waitcnt lgkmcnt(0)
v_mfma_f32_16x16x16_bf16 v[100:103], v[36:37], v[88:89], v[100:103]
v_add_f32 v56, v56, v64
v_add_f32 v60, v60, v48
v_add_f32 v57, v57, v65
v_add_f32 v61, v61, v49
v_add_f32 v58, v58, v66
v_add_f32 v62, v62, v50
v_add_f32 v59, v59, v67
v_add_f32 v63, v63, v51
v_cvt_pk_bf16_f32 v68, v56, v57
v_cvt_pk_bf16_f32 v69, v58, v59
v_cvt_pk_bf16_f32 v70, v60, v61
v_cvt_pk_bf16_f32 v71, v62, v63
v_mfma_f32_16x16x16_bf16 v[92:95], v[68:69], v[88:89], v[92:95]
v_rcp_f32 v28, v100
v_mfma_f32_16x16x16_bf16 v[96:99], v[70:71], v[88:89], v[96:99]
v_mov_b32 v29, v28
s_nop 4
v_pk_mul_f32 v[92:93], v[92:93], v[28:29]
v_pk_mul_f32 v[94:95], v[94:95], v[28:29]
v_pk_mul_f32 v[96:97], v[96:97], v[28:29]
v_pk_mul_f32 v[98:99], v[98:99], v[28:29]
v_cvt_pk_bf16_f32 v104, v92, v93
v_cvt_pk_bf16_f32 v105, v94, v95
v_cvt_pk_bf16_f32 v106, v96, v97
v_cvt_pk_bf16_f32 v107, v98, v99
buffer_store_dwordx4 v[104:107], v11, s[4:7], s22 offen
s_barrier
s_add_u32 s34, s17, 2
s_and_b32 s34, s34, 3
s_mul_i32 s26, s34, 10240
s_add_u32 s26, s26, s38
s_mul_i32 s27, s34, 6144
s_add_u32 s27, s27, s39
s_mul_i32 s28, s34, 12288
s_add_u32 s28, s28, s40
s_mul_i32 s29, s34, 393216
s_add_u32 s29, s29, s56
buffer_store_dwordx2 v[32:33], v8, s[4:7], s27 offen
buffer_store_dwordx4 v[32:35], v11, s[4:7], s28 offen
s_add_u32 s36, s17, 1
s_cmp_ge_u32 s36, 63
s_cbranch_scc1 reca_nopf117
s_add_u32 s37, s36, 1
reca_pf118:
buffer_load_dword v28, v233, s[4:7], 0 offen sc1
s_waitcnt vmcnt(0)
v_cmp_gt_i32 vcc, s37, v28
s_cbranch_vccz reca_pfok119
s_sleep 1
s_sub_u32 s18, s18, 1
s_cbranch_scc0 reca_pf118
s_mov_b32 s18, 0
reca_pfok119:
s_lshl_b32 s34, s15, 3
s_and_b32 s35, s36, 7
s_add_u32 s34, s34, s35
s_mul_i32 s34, s34, 12288
s_add_u32 s32, s34, 37748736
s_lshl_b32 s35, s16, 11
s_add_u32 s34, s34, s35
s_add_u32 s33, s34, 40894464
buffer_load_dwordx4 a[120:123], v1, s[4:7], s32 offen offset:0 sc1
buffer_load_dwordx4 a[124:127], v1, s[4:7], s32 offen offset:1024 sc1
buffer_load_dwordx4 a[128:131], v1, s[4:7], s32 offen offset:2048 sc1
buffer_load_dwordx4 a[132:135], v1, s[4:7], s32 offen offset:3072 sc1
buffer_load_dwordx4 a[136:139], v2, s[4:7], s32 offen offset:0 sc1
buffer_load_dwordx4 a[140:143], v2, s[4:7], s32 offen offset:1024 sc1
buffer_load_dwordx4 a[144:147], v2, s[4:7], s32 offen offset:2048 sc1
buffer_load_dwordx4 a[148:151], v2, s[4:7], s32 offen offset:3072 sc1
buffer_load_dwordx4 a[152:155], v3, s[4:7], s32 offen offset:0 sc1
buffer_load_dwordx4 a[156:159], v3, s[4:7], s32 offen offset:1024 sc1
buffer_load_dwordx4 a[160:163], v3, s[4:7], s32 offen offset:2048 sc1
buffer_load_dwordx4 a[164:167], v3, s[4:7], s32 offen offset:3072 sc1
buffer_load_dwordx4 a[168:171], v1, s[4:7], s33 offen offset:0 sc1
buffer_load_dwordx4 a[172:175], v1, s[4:7], s33 offen offset:1024 sc1
reca_nopf117:
buffer_store_dwordx2 v[52:53], v9, s[4:7], s30 offen
buffer_store_dwordx2 v[68:69], v10, s[4:7], s31 offen
buffer_store_dwordx2 v[70:71], v10, s[4:7], s31 offen offset:256
reca_b5101:
s_barrier
s_add_u32 s17, s17, 1
s_branch reca_step87
reca_b399:
s_endpgm
reca_retry90:
s_sub_u32 s18, s18, 1
s_cbranch_scc1 reca_retry90_to
buffer_load_dwordx4 v[128:131], v4, s[4:7], s20 offen sc1
buffer_load_dwordx4 v[132:135], v4, s[4:7], s20 offen offset:1024 sc1
buffer_load_dwordx4 v[136:139], v5, s[4:7], s20 offen sc1
s_waitcnt vmcnt(2)
v_max_u32 v29, v128, v130
v_cmp_eq_u32 vcc, -1, v29
s_cbranch_vccnz reca_retry90
s_branch reca_resume91
reca_retry90_to:
s_mov_b32 s18, 0
s_waitcnt vmcnt(0)
s_branch reca_resume91
reca_retry92:
s_sub_u32 s18, s18, 1
s_cbranch_scc1 reca_retry92_to
buffer_load_dwordx4 v[132:135], v4, s[4:7], s20 offen offset:1024 sc1
buffer_load_dwordx4 v[136:139], v5, s[4:7], s20 offen sc1
s_waitcnt vmcnt(1)
v_max_u32 v29, v132, v134
v_cmp_eq_u32 vcc, -1, v29
s_cbranch_vccnz reca_retry92
s_branch reca_resume93
reca_retry92_to:
s_mov_b32 s18, 0
s_waitcnt vmcnt(0)
s_branch reca_resume93
reca_retry94:
s_sub_u32 s18, s18, 1
s_cbranch_scc1 reca_retry94_to
buffer_load_dwordx4 v[136:139], v5, s[4:7], s20 offen sc1
s_waitcnt vmcnt(0)
v_max_u32 v29, v136, v138
v_cmp_eq_u32 vcc, -1, v29
s_cbranch_vccnz reca_retry94
s_branch reca_resume95
reca_retry94_to:
s_mov_b32 s18, 0
s_waitcnt vmcnt(0)
s_branch reca_resume95
reca_retry105:
s_sub_u32 s18, s18, 1
s_cbranch_scc1 reca_retry105_to
buffer_load_dwordx4 v[208:211], v1, s[4:7], s21 offen offset:0 sc1
buffer_load_dwordx4 v[212:215], v1, s[4:7], s21 offen offset:1024 sc1
buffer_load_dwordx4 v[216:219], v1, s[4:7], s21 offen offset:2048 sc1
buffer_load_dwordx4 v[220:223], v1, s[4:7], s21 offen offset:3072 sc1
buffer_load_dwordx4 v[224:227], v2, s[4:7], s21 offen offset:0 sc1
buffer_load_dwordx4 v[228:231], v2, s[4:7], s21 offen offset:1024 sc1
s_waitcnt vmcnt(5)
v_max_u32 v29, v208, v210
v_cmp_eq_u32 vcc, -1, v29
s_cbranch_vccnz reca_retry105
s_branch reca_resume106
reca_retry105_to:
s_mov_b32 s18, 0
s_waitcnt vmcnt(0)
s_branch reca_resume106
reca_retry107:
s_sub_u32 s18, s18, 1
s_cbranch_scc1 reca_retry107_to
buffer_load_dwordx4 v[212:215], v1, s[4:7], s21 offen offset:1024 sc1
buffer_load_dwordx4 v[216:219], v1, s[4:7], s21 offen offset:2048 sc1
buffer_load_dwordx4 v[220:223], v1, s[4:7], s21 offen offset:3072 sc1
buffer_load_dwordx4 v[224:227], v2, s[4:7], s21 offen offset:0 sc1
buffer_load_dwordx4 v[228:231], v2, s[4:7], s21 offen offset:1024 sc1
s_waitcnt vmcnt(4)
v_max_u32 v29, v212, v214
v_cmp_eq_u32 vcc, -1, v29
s_cbranch_vccnz reca_retry107
s_branch reca_resume108
reca_retry107_to:
s_mov_b32 s18, 0
s_waitcnt vmcnt(0)
s_branch reca_resume108
reca_retry109:
s_sub_u32 s18, s18, 1
s_cbranch_scc1 reca_retry109_to
buffer_load_dwordx4 v[216:219], v1, s[4:7], s21 offen offset:2048 sc1
buffer_load_dwordx4 v[220:223], v1, s[4:7], s21 offen offset:3072 sc1
buffer_load_dwordx4 v[224:227], v2, s[4:7], s21 offen offset:0 sc1
buffer_load_dwordx4 v[228:231], v2, s[4:7], s21 offen offset:1024 sc1
s_waitcnt vmcnt(3)
v_max_u32 v29, v216, v218
v_cmp_eq_u32 vcc, -1, v29
s_cbranch_vccnz reca_retry109
s_branch reca_resume110
reca_retry109_to:
s_mov_b32 s18, 0
s_waitcnt vmcnt(0)
s_branch reca_resume110
reca_retry111:
s_sub_u32 s18, s18, 1
s_cbranch_scc1 reca_retry111_to
buffer_load_dwordx4 v[220:223], v1, s[4:7], s21 offen offset:3072 sc1
buffer_load_dwordx4 v[224:227], v2, s[4:7], s21 offen offset:0 sc1
buffer_load_dwordx4 v[228:231], v2, s[4:7], s21 offen offset:1024 sc1
s_waitcnt vmcnt(2)
v_max_u32 v29, v220, v222
v_cmp_eq_u32 vcc, -1, v29
s_cbranch_vccnz reca_retry111
s_branch reca_resume112
reca_retry111_to:
s_mov_b32 s18, 0
s_waitcnt vmcnt(0)
s_branch reca_resume112
reca_retry113:
s_sub_u32 s18, s18, 1
s_cbranch_scc1 reca_retry113_to
buffer_load_dwordx4 v[224:227], v2, s[4:7], s21 offen offset:0 sc1
buffer_load_dwordx4 v[228:231], v2, s[4:7], s21 offen offset:1024 sc1
s_waitcnt vmcnt(1)
v_max_u32 v29, v224, v226
v_cmp_eq_u32 vcc, -1, v29
s_cbranch_vccnz reca_retry113
s_branch reca_resume114
reca_retry113_to:
s_mov_b32 s18, 0
s_waitcnt vmcnt(0)
s_branch reca_resume114
reca_retry115:
s_sub_u32 s18, s18, 1
s_cbranch_scc1 reca_retry115_to
buffer_load_dwordx4 v[228:231], v2, s[4:7], s21 offen offset:1024 sc1
s_waitcnt vmcnt(0)
v_max_u32 v29, v228, v230
v_cmp_eq_u32 vcc, -1, v29
s_cbranch_vccnz reca_retry115
s_branch reca_resume116
reca_retry115_to:
s_mov_b32 s18, 0
s_waitcnt vmcnt(0)
s_branch reca_resume116
reca_slow11:
s_cmp_ge_u32 s14, 20
s_cbranch_scc1 reca_twins13
s_branch reca_gotmem121
reca_step120:
s_and_b32 s34, s17, 3
s_mul_i32 s20, s34, 10240
s_add_u32 s20, s20, s38
s_sleep 2
buffer_load_dwordx4 v[128:131], v4, s[4:7], s20 offen sc1
buffer_load_dwordx4 v[132:135], v4, s[4:7], s20 offen offset:1024 sc1
buffer_load_dwordx4 v[136:139], v5, s[4:7], s20 offen sc1
s_waitcnt vmcnt(2)
v_max_u32 v29, v128, v130
v_cmp_eq_u32 vcc, -1, v29
s_cbranch_vccnz reca_retry123
reca_resume124:
s_waitcnt vmcnt(1)
v_max_u32 v29, v132, v134
v_cmp_eq_u32 vcc, -1, v29
ds_write_b128 v4, v[128:131]
s_cbranch_vccnz reca_retry125
reca_resume126:
s_waitcnt vmcnt(0)
v_max_u32 v29, v136, v138
v_cmp_eq_u32 vcc, -1, v29
ds_write_b128 v4, v[132:135] offset:1024
s_cbranch_vccnz reca_retry127
reca_resume128:
ds_write_b128 v5, v[136:139]
s_branch reca_gotmem2122
reca_gotmem121:
ds_write_b128 v4, v[128:131]
ds_write_b128 v4, v[132:135] offset:1024
ds_write_b128 v5, v[136:139]
reca_gotmem2122:
s_and_b32 s34, s17, 3
s_mul_i32 s21, s34, 6144
s_add_u32 s21, s21, s39
s_mul_i32 s22, s34, 12288
s_add_u32 s22, s22, s40
s_mul_i32 s25, s34, 393216
s_add_u32 s25, s25, s56
s_add_u32 s35, s17, 1
s_and_b32 s35, s35, 3
s_mul_i32 s24, s35, 10240
s_add_u32 s24, s24, s38
s_waitcnt lgkmcnt(0)
s_barrier
ds_read_b128 v[128:131], v236 offset:0
ds_read_b128 v[132:135], v236 offset:1024
ds_read_b128 v[136:139], v236 offset:2048
ds_read_b128 v[140:143], v236 offset:3072
ds_read_b128 v[144:147], v236 offset:4096
ds_read_b128 v[148:151], v237 offset:0
ds_read_b128 v[152:155], v237 offset:1024
ds_read_b128 v[156:159], v237 offset:2048
ds_read_b128 v[160:163], v237 offset:3072
ds_read_b128 v[164:167], v237 offset:4096
s_waitcnt lgkmcnt(9)
v_mfma_f32_16x16x32_bf16 v[44:47], a[0:3], v[128:131], 0
ds_read_b128 v[168:171], v6 offset:0
v_mfma_f32_16x16x32_bf16 v[240:243], a[4:7], v[128:131], 0
s_waitcnt lgkmcnt(9)
v_mfma_f32_16x16x32_bf16 v[44:47], a[8:11], v[132:135], v[44:47]
ds_read_b128 v[172:175], v6 offset:512
v_mfma_f32_16x16x32_bf16 v[240:243], a[12:15], v[132:135], v[240:243]
s_waitcnt lgkmcnt(9)
v_mfma_f32_16x16x32_bf16 v[44:47], a[16:19], v[136:139], v[44:47]
ds_read_b128 v[176:179], v6 offset:1024
v_mfma_f32_16x16x32_bf16 v[240:243], a[20:23], v[136:139], v[240:243]
s_waitcnt lgkmcnt(9)
v_mfma_f32_16x16x32_bf16 v[44:47], a[24:27], v[140:143], v[44:47]
ds_read_b128 v[180:183], v6 offset:1536
v_mfma_f32_16x16x32_bf16 v[240:243], a[28:31], v[140:143], v[240:243]
s_waitcnt lgkmcnt(9)
v_mfma_f32_16x16x32_bf16 v[44:47], a[32:35], v[144:147], v[44:47]
ds_read_b128 v[184:187], v6 offset:2048
v_mfma_f32_16x16x32_bf16 v[240:243], a[36:39], v[144:147], v[240:243]
s_waitcnt lgkmcnt(9)
v_mfma_f32_16x16x32_bf16 v[44:47], a[40:43], v[148:151], v[44:47]
ds_read_b128 v[188:191], v6 offset:2560
v_mfma_f32_16x16x32_bf16 v[240:243], a[44:47], v[148:151], v[240:243]
s_waitcnt lgkmcnt(9)
v_mfma_f32_16x16x32_bf16 v[44:47], a[48:51], v[152:155], v[44:47]
ds_read_b128 v[192:195], v6 offset:3072
v_mfma_f32_16x16x32_bf16 v[240:243], a[52:55], v[152:155], v[240:243]
s_waitcnt lgkmcnt(9)
v_mfma_f32_16x16x32_bf16 v[44:47], a[56:59], v[156:159], v[44:47]
ds_read_b128 v[196:199], v6 offset:3584
v_mfma_f32_16x16x32_bf16 v[240:243], a[60:63], v[156:159], v[240:243]
s_waitcnt lgkmcnt(9)
v_mfma_f32_16x16x32_bf16 v[44:47], a[64:67], v[160:163], v[44:47]
ds_read_b128 v[200:203], v6 offset:4096
v_mfma_f32_16x16x32_bf16 v[240:243], a[68:71], v[160:163], v[240:243]
s_waitcnt lgkmcnt(9)
v_mfma_f32_16x16x32_bf16 v[44:47], a[72:75], v[164:167], v[44:47]
ds_read_b128 v[204:207], v6 offset:4608
v_mfma_f32_16x16x32_bf16 v[240:243], a[76:79], v[164:167], v[240:243]
s_waitcnt lgkmcnt(9)
v_mfma_f32_16x16x32_bf16 v[48:51], v[168:171], a[80:83], 0
s_and_b32 s34, s17, 7
s_lshl_b32 s34, s34, 5
s_add_u32 s34, s34, s15
s_mul_i32 s34, s34, 3072
s_lshl_b32 s35, s16, 9
s_add_u32 s34, s34, s35
s_add_u32 s30, s34, 47185920
s_add_u32 s31, s34, 47972352
v_add_f32_dpp v44, v240, v44 row_ror:8 row_mask:0xf bank_mask:0xf
v_add_f32_dpp v45, v241, v45 row_ror:8 row_mask:0xf bank_mask:0xf
v_add_f32_dpp v46, v242, v46 row_ror:8 row_mask:0xf bank_mask:0xf
v_add_f32_dpp v47, v243, v47 row_ror:8 row_mask:0xf bank_mask:0xf
v_cvt_pk_bf16_f32 v52, v44, v45
v_cvt_pk_bf16_f32 v53, v46, v47
buffer_store_dwordx2 v[52:53], v8, s[4:7], s21 offen sc1
s_waitcnt lgkmcnt(8)
v_mfma_f32_16x16x32_bf16 v[48:51], v[172:175], a[84:87], v[48:51]
s_waitcnt lgkmcnt(7)
v_mfma_f32_16x16x32_bf16 v[48:51], v[176:179], a[88:91], v[48:51]
s_waitcnt lgkmcnt(6)
v_mfma_f32_16x16x32_bf16 v[48:51], v[180:183], a[92:95], v[48:51]
s_waitcnt lgkmcnt(5)
v_mfma_f32_16x16x32_bf16 v[48:51], v[184:187], a[96:99], v[48:51]
s_waitcnt lgkmcnt(4)
v_mfma_f32_16x16x32_bf16 v[48:51], v[188:191], a[100:103], v[48:51]
s_waitcnt lgkmcnt(3)
v_mfma_f32_16x16x32_bf16 v[48:51], v[192:195], a[104:107], v[48:51]
s_waitcnt lgkmcnt(2)
v_mfma_f32_16x16x32_bf16 v[48:51], v[196:199], a[108:111], v[48:51]
s_waitcnt lgkmcnt(1)
v_mfma_f32_16x16x32_bf16 v[48:51], v[200:203], a[112:115], v[48:51]
s_waitcnt lgkmcnt(0)
v_mfma_f32_16x16x32_bf16 v[48:51], v[204:207], a[116:119], v[48:51]
s_cmp_eq_u32 s12, 3
s_cbranch_scc1 reca_swave129
s_nop 5
ds_write_b128 v17, v[48:51]
s_add_u32 s34, s17, 2
s_and_b32 s34, s34, 3
s_mul_i32 s26, s34, 10240
s_add_u32 s26, s26, s38
s_mul_i32 s27, s34, 6144
s_add_u32 s27, s27, s39
s_mul_i32 s28, s34, 12288
s_add_u32 s28, s28, s40
s_mul_i32 s29, s34, 393216
s_add_u32 s29, s29, s56
s_waitcnt lgkmcnt(0)
s_barrier
s_cmp_eq_u32 s17, 63
s_cbranch_scc1 reca_last131
buffer_store_dwordx2 v[32:33], v8, s[4:7], s27 offen sc1
s_cmp_lg_u32 s12, 2
s_cbranch_scc1 reca_b3132
buffer_store_dwordx2 v[52:53], v9, s[4:7], s30 offen sc1
buffer_store_dwordx2 v[32:33], v16, s[4:7], s26 offen sc1
s_cmp_lg_u32 s14, 0
s_cbranch_scc1 reca_b3132
v_mov_b32 v28, s17
s_lshl_b32 s34, s13, 7
s_add_u32 s34, s34, 1507328
buffer_store_dword v28, v19, s[4:7], s34 offen sc1
s_branch reca_b3132
reca_last131:
s_cmp_lg_u32 s12, 2
s_cbranch_scc1 reca_exit1
buffer_store_dwordx2 v[52:53], v9, s[4:7], s30 offen
s_branch reca_exit1
reca_swave129:
s_cmp_lg_u32 s17, 63
s_cbranch_scc1 reca_vmst135
s_barrier
ds_read_b128 v[56:59], v1 offset:10240
ds_read_b128 v[60:63], v1 offset:11264
ds_read_b128 v[64:67], v1 offset:12288
s_waitcnt lgkmcnt(0)
v_add_f32 v56, v56, v64
v_add_f32 v60, v60, v48
v_add_f32 v57, v57, v65
v_add_f32 v61, v61, v49
v_add_f32 v58, v58, v66
v_add_f32 v62, v62, v50
v_add_f32 v59, v59, v67
v_add_f32 v63, v63, v51
v_cvt_pk_bf16_f32 v68, v56, v57
v_cvt_pk_bf16_f32 v69, v58, v59
v_cvt_pk_bf16_f32 v70, v60, v61
v_cvt_pk_bf16_f32 v71, v62, v63
buffer_store_dwordx2 v[52:53], v9, s[4:7], s30 offen
buffer_store_dwordx2 v[68:69], v10, s[4:7], s31 offen
buffer_store_dwordx2 v[70:71], v10, s[4:7], s31 offen offset:256
s_branch reca_exit1
reca_vmst135:
s_sleep 1
buffer_load_dwordx4 v[208:211], v1, s[4:7], s21 offen offset:0 sc1
buffer_load_dwordx4 v[212:215], v1, s[4:7], s21 offen offset:1024 sc1
buffer_load_dwordx4 v[216:219], v1, s[4:7], s21 offen offset:2048 sc1
buffer_load_dwordx4 v[220:223], v1, s[4:7], s21 offen offset:3072 sc1
buffer_load_dwordx4 v[224:227], v2, s[4:7], s21 offen offset:0 sc1
buffer_load_dwordx4 v[228:231], v2, s[4:7], s21 offen offset:1024 sc1
s_waitcnt vmcnt(5)
v_max_u32 v29, v208, v210
v_cmp_eq_u32 vcc, -1, v29
s_cbranch_vccnz reca_retry136
reca_resume137:
s_waitcnt vmcnt(4)
v_max_u32 v29, v212, v214
v_cmp_eq_u32 vcc, -1, v29
v_mfma_f32_16x16x32_bf16 v[76:79], a[120:123], v[208:211], 0
v_mfma_f32_16x16x32_bf16 v[80:83], a[144:147], v[208:211], 0
v_mfma_f32_16x16x32_bf16 v[72:75], v[208:211], v[208:211], v[40:43]
s_cbranch_vccnz reca_retry138
reca_resume139:
s_waitcnt vmcnt(3)
v_max_u32 v29, v216, v218
v_cmp_eq_u32 vcc, -1, v29
v_mfma_f32_16x16x32_bf16 v[76:79], a[124:127], v[212:215], v[76:79]
v_mfma_f32_16x16x32_bf16 v[80:83], a[148:151], v[212:215], v[80:83]
v_mfma_f32_16x16x32_bf16 v[72:75], v[212:215], v[212:215], v[72:75]
s_cbranch_vccnz reca_retry140
reca_resume141:
s_waitcnt vmcnt(2)
v_max_u32 v29, v220, v222
v_cmp_eq_u32 vcc, -1, v29
v_mfma_f32_16x16x32_bf16 v[76:79], a[128:131], v[216:219], v[76:79]
v_mfma_f32_16x16x32_bf16 v[80:83], a[152:155], v[216:219], v[80:83]
v_mfma_f32_16x16x32_bf16 v[72:75], v[216:219], v[216:219], v[72:75]
s_cbranch_vccnz reca_retry142
reca_resume143:
s_waitcnt vmcnt(1)
v_max_u32 v29, v224, v226
v_cmp_eq_u32 vcc, -1, v29
v_mfma_f32_16x16x32_bf16 v[76:79], a[132:135], v[220:223], v[76:79]
v_mfma_f32_16x16x32_bf16 v[80:83], a[156:159], v[220:223], v[80:83]
v_mfma_f32_16x16x32_bf16 v[72:75], v[220:223], v[220:223], v[72:75]
s_cbranch_vccnz reca_retry144
reca_resume145:
s_waitcnt vmcnt(0)
v_max_u32 v29, v228, v230
v_cmp_eq_u32 vcc, -1, v29
v_mfma_f32_16x16x32_bf16 v[76:79], a[136:139], v[224:227], v[76:79]
v_mfma_f32_16x16x32_bf16 v[80:83], a[160:163], v[224:227], v[80:83]
v_mfma_f32_16x16x32_bf16 v[72:75], v[224:227], v[224:227], v[72:75]
s_cbranch_vccnz reca_retry146
reca_resume147:
v_mfma_f32_16x16x32_bf16 v[76:79], a[140:143], v[228:231], v[76:79]
v_mfma_f32_16x16x32_bf16 v[80:83], a[164:167], v[228:231], v[80:83]
v_mfma_f32_16x16x32_bf16 v[72:75], v[228:231], v[228:231], v[72:75]
s_barrier
ds_read_b128 v[56:59], v1 offset:10240
ds_read_b128 v[60:63], v1 offset:11264
ds_read_b128 v[64:67], v1 offset:12288
s_nop 1
v_max3_f32 v28, v76, v77, v78
v_max3_f32 v29, v80, v81, v82
v_max3_f32 v28, v28, v79, v83
v_max3_f32 v29, v29, v72, v73
v_max3_f32 v28, v28, v74, v75
v_max_f32 v28, v28, v29
v_mov_b32 v29, v28
s_nop 1
v_permlane32_swap_b32 v28, v29
v_max_f32 v28, v28, v29
v_mov_b32 v29, v28
s_nop 1
v_permlane16_swap_b32 v28, v29
v_max_f32 v28, v28, v29
v_mul_f32 v28, s41, v28
v_fma_f32 v76, v76, s41, -v28
v_fma_f32 v77, v77, s41, -v28
v_fma_f32 v78, v78, s41, -v28
v_fma_f32 v79, v79, s41, -v28
v_fma_f32 v80, v80, s41, -v28
v_fma_f32 v81, v81, s41, -v28
v_fma_f32 v82, v82, s41, -v28
v_fma_f32 v83, v83, s41, -v28
v_fma_f32 v72, v72, s41, -v28
v_fma_f32 v73, v73, s41, -v28
v_fma_f32 v74, v74, s41, -v28
v_fma_f32 v75, v75, s41, -v28
v_exp_f32 v76, v76
v_exp_f32 v77, v77
v_exp_f32 v78, v78
v_exp_f32 v79, v79
v_exp_f32 v80, v80
v_exp_f32 v81, v81
v_exp_f32 v82, v82
v_exp_f32 v83, v83
v_cvt_pk_bf16_f32 v84, v76, v77
v_cvt_pk_bf16_f32 v85, v78, v79
v_cvt_pk_bf16_f32 v86, v80, v81
v_cvt_pk_bf16_f32 v87, v82, v83
v_exp_f32 v72, v72
v_exp_f32 v73, v73
v_mfma_f32_16x16x32_bf16 v[100:103], v[36:39], v[84:87], 0
v_exp_f32 v74, v74
v_exp_f32 v75, v75
v_mfma_f32_16x16x32_bf16 v[92:95], a[168:171], v[84:87], 0
v_cvt_pk_bf16_f32 v88, v72, v73
v_cvt_pk_bf16_f32 v89, v74, v75
v_mfma_f32_16x16x32_bf16 v[96:99], a[172:175], v[84:87], 0
s_waitcnt lgkmcnt(0)
v_mfma_f32_16x16x16_bf16 v[100:103], v[36:37], v[88:89], v[100:103]
v_add_f32 v56, v56, v64
v_add_f32 v60, v60, v48
v_add_f32 v57, v57, v65
v_add_f32 v61, v61, v49
v_add_f32 v58, v58, v66
v_add_f32 v62, v62, v50
v_add_f32 v59, v59, v67
v_add_f32 v63, v63, v51
v_cvt_pk_bf16_f32 v68, v56, v57
v_cvt_pk_bf16_f32 v69, v58, v59
v_cvt_pk_bf16_f32 v70, v60, v61
v_cvt_pk_bf16_f32 v71, v62, v63
v_mfma_f32_16x16x16_bf16 v[92:95], v[68:69], v[88:89], v[92:95]
v_rcp_f32 v28, v100
v_mfma_f32_16x16x16_bf16 v[96:99], v[70:71], v[88:89], v[96:99]
v_mov_b32 v29, v28
s_nop 4
v_pk_mul_f32 v[92:93], v[92:93], v[28:29]
v_pk_mul_f32 v[94:95], v[94:95], v[28:29]
v_pk_mul_f32 v[96:97], v[96:97], v[28:29]
v_pk_mul_f32 v[98:99], v[98:99], v[28:29]
v_cvt_pk_bf16_f32 v104, v92, v93
v_cvt_pk_bf16_f32 v105, v94, v95
v_cvt_pk_bf16_f32 v106, v96, v97
v_cvt_pk_bf16_f32 v107, v98, v99
buffer_store_dwordx4 v[104:107], v11, s[4:7], s22 offen sc1
reca_b3132:
s_barrier
s_cmp_ge_u32 s12, 2
s_cbranch_scc1 reca_notg2148
s_sleep 3
buffer_load_dwordx4 v[128:131], v12, s[4:7], s22 offen offset:0 sc1
buffer_load_dwordx4 v[132:135], v12, s[4:7], s22 offen offset:1024 sc1
buffer_load_dwordx4 v[136:139], v12, s[4:7], s22 offen offset:2048 sc1
buffer_load_dwordx4 v[140:143], v12, s[4:7], s22 offen offset:3072 sc1
buffer_load_dwordx4 v[144:147], v13, s[4:7], s22 offen offset:0 sc1
buffer_load_dwordx4 v[148:151], v13, s[4:7], s22 offen offset:1024 sc1
buffer_load_dwordx4 v[152:155], v13, s[4:7], s22 offen offset:2048 sc1
buffer_load_dwordx4 v[156:159], v13, s[4:7], s22 offen offset:3072 sc1
buffer_load_dwordx4 v[160:163], v14, s[4:7], s22 offen offset:0 sc1
buffer_load_dwordx4 v[164:167], v14, s[4:7], s22 offen offset:1024 sc1
buffer_load_dwordx4 v[168:171], v14, s[4:7], s22 offen offset:2048 sc1
buffer_load_dwordx4 v[172:175], v14, s[4:7], s22 offen offset:3072 sc1
s_waitcnt vmcnt(11)
v_cmp_eq_u32 vcc, -1, v128
s_cbranch_vccnz reca_retry149
reca_resume150:
s_waitcnt vmcnt(10)
v_cmp_eq_u32 vcc, -1, v132
v_mfma_f32_16x16x32_bf16 v[108:111], a[120:123], v[128:131], 0
v_mfma_f32_16x16x32_bf16 v[112:115], a[124:127], v[128:131], 0
s_cbranch_vccnz reca_retry151
reca_resume152:
s_waitcnt vmcnt(9)
v_cmp_eq_u32 vcc, -1, v136
v_mfma_f32_16x16x32_bf16 v[108:111], a[128:131], v[132:135], v[108:111]
v_mfma_f32_16x16x32_bf16 v[112:115], a[132:135], v[132:135], v[112:115]
s_cbranch_vccnz reca_retry153
reca_resume154:
s_waitcnt vmcnt(8)
v_cmp_eq_u32 vcc, -1, v140
v_mfma_f32_16x16x32_bf16 v[108:111], a[136:139], v[136:139], v[108:111]
v_mfma_f32_16x16x32_bf16 v[112:115], a[140:143], v[136:139], v[112:115]
s_cbranch_vccnz reca_retry155
reca_resume156:
s_waitcnt vmcnt(7)
v_cmp_eq_u32 vcc, -1, v144
v_mfma_f32_16x16x32_bf16 v[108:111], a[144:147], v[140:143], v[108:111]
v_mfma_f32_16x16x32_bf16 v[112:115], a[148:151], v[140:143], v[112:115]
s_cbranch_vccnz reca_retry157
reca_resume158:
s_waitcnt vmcnt(6)
v_cmp_eq_u32 vcc, -1, v148
v_mfma_f32_16x16x32_bf16 v[108:111], a[152:155], v[144:147], v[108:111]
v_mfma_f32_16x16x32_bf16 v[112:115], a[156:159], v[144:147], v[112:115]
s_cbranch_vccnz reca_retry159
reca_resume160:
s_waitcnt vmcnt(5)
v_cmp_eq_u32 vcc, -1, v152
v_mfma_f32_16x16x32_bf16 v[108:111], a[160:163], v[148:151], v[108:111]
v_mfma_f32_16x16x32_bf16 v[112:115], a[164:167], v[148:151], v[112:115]
s_cbranch_vccnz reca_retry161
reca_resume162:
s_waitcnt vmcnt(4)
v_cmp_eq_u32 vcc, -1, v156
v_mfma_f32_16x16x32_bf16 v[108:111], a[168:171], v[152:155], v[108:111]
v_mfma_f32_16x16x32_bf16 v[112:115], a[172:175], v[152:155], v[112:115]
s_cbranch_vccnz reca_retry163
reca_resume164:
s_waitcnt vmcnt(3)
v_cmp_eq_u32 vcc, -1, v160
v_mfma_f32_16x16x32_bf16 v[108:111], a[176:179], v[156:159], v[108:111]
v_mfma_f32_16x16x32_bf16 v[112:115], a[180:183], v[156:159], v[112:115]
s_cbranch_vccnz reca_retry165
reca_resume166:
s_waitcnt vmcnt(2)
v_cmp_eq_u32 vcc, -1, v164
v_mfma_f32_16x16x32_bf16 v[108:111], a[184:187], v[160:163], v[108:111]
v_mfma_f32_16x16x32_bf16 v[112:115], a[188:191], v[160:163], v[112:115]
s_cbranch_vccnz reca_retry167
reca_resume168:
s_waitcnt vmcnt(1)
v_cmp_eq_u32 vcc, -1, v168
v_mfma_f32_16x16x32_bf16 v[108:111], a[192:195], v[164:167], v[108:111]
v_mfma_f32_16x16x32_bf16 v[112:115], a[196:199], v[164:167], v[112:115]
s_cbranch_vccnz reca_retry169
reca_resume170:
s_waitcnt vmcnt(0)
v_cmp_eq_u32 vcc, -1, v172
v_mfma_f32_16x16x32_bf16 v[108:111], a[200:203], v[168:171], v[108:111]
v_mfma_f32_16x16x32_bf16 v[112:115], a[204:207], v[168:171], v[112:115]
s_cbranch_vccnz reca_retry171
reca_resume172:
v_mfma_f32_16x16x32_bf16 v[108:111], a[208:211], v[172:175], v[108:111]
v_mfma_f32_16x16x32_bf16 v[112:115], a[212:215], v[172:175], v[112:115]
s_nop 7
v_add_f32_dpp v116, v112, v108 row_ror:8 row_mask:0xf bank_mask:0xf
v_add_f32_dpp v117, v113, v109 row_ror:8 row_mask:0xf bank_mask:0xf
v_add_f32_dpp v118, v114, v110 row_ror:8 row_mask:0xf bank_mask:0xf
v_add_f32_dpp v119, v115, v111 row_ror:8 row_mask:0xf bank_mask:0xf
buffer_store_dwordx4 v[116:119], v15, s[4:7], s25 offen sc1
buffer_store_dwordx4 v[116:119], v232, s[4:7], s25 offen sc1
buffer_store_dwordx4 v[32:35], v15, s[4:7], s29 offen sc1
buffer_store_dwordx4 v[32:35], v232, s[4:7], s29 offen sc1
s_branch reca_b4133
reca_notg2148:
s_cmp_lg_u32 s12, 3
s_cbranch_scc1 reca_b4133
s_add_u32 s34, s17, 2
s_and_b32 s34, s34, 3
s_mul_i32 s26, s34, 10240
s_add_u32 s26, s26, s38
s_mul_i32 s27, s34, 6144
s_add_u32 s27, s27, s39
s_mul_i32 s28, s34, 12288
s_add_u32 s28, s28, s40
s_mul_i32 s29, s34, 393216
s_add_u32 s29, s29, s56
buffer_store_dwordx2 v[32:33], v8, s[4:7], s27 offen sc1
buffer_store_dwordx4 v[32:35], v11, s[4:7], s28 offen sc1
reca_b4133:
s_barrier
s_cmp_lg_u32 s12, 2
s_cbranch_scc1 reca_not2173
s_sleep 8
buffer_load_dwordx4 v[128:131], v20, s[4:7], s25 offen sc1
buffer_load_dwordx4 v[132:135], v21, s[4:7], s25 offen sc1
buffer_load_dwordx4 v[136:139], v22, s[4:7], s25 offen sc1
buffer_load_dwordx4 v[140:143], v23, s[4:7], s25 offen sc1
buffer_load_dwordx4 v[144:147], v24, s[4:7], s25 offen sc1
buffer_load_dwordx4 v[148:151], v25, s[4:7], s25 offen sc1
buffer_load_dwordx4 v[152:155], v26, s[4:7], s25 offen sc1
buffer_load_dwordx4 v[156:159], v27, s[4:7], s25 offen sc1
s_waitcnt vmcnt(7)
v_cmp_eq_u32 vcc, -1, v128
s_cbranch_vccnz reca_retry174
reca_resume175:
s_waitcnt vmcnt(6)
v_cmp_eq_u32 vcc, -1, v132
s_cbranch_vccnz reca_retry176
reca_resume177:
s_waitcnt vmcnt(5)
v_cmp_eq_u32 vcc, -1, v136
v_pk_add_f32 v[116:117], v[128:129], v[132:133]
v_pk_add_f32 v[118:119], v[130:131], v[134:135]
s_cbranch_vccnz reca_retry178
reca_resume179:
s_waitcnt vmcnt(4)
v_cmp_eq_u32 vcc, -1, v140
v_pk_add_f32 v[116:117], v[116:117], v[136:137]
v_pk_add_f32 v[118:119], v[118:119], v[138:139]
s_cbranch_vccnz reca_retry180
reca_resume181:
s_waitcnt vmcnt(3)
v_cmp_eq_u32 vcc, -1, v144
v_pk_add_f32 v[116:117], v[116:117], v[140:141]
v_pk_add_f32 v[118:119], v[118:119], v[142:143]
s_cbranch_vccnz reca_retry182
reca_resume183:
s_waitcnt vmcnt(2)
v_cmp_eq_u32 vcc, -1, v148
v_pk_add_f32 v[116:117], v[116:117], v[144:145]
v_pk_add_f32 v[118:119], v[118:119], v[146:147]
s_cbranch_vccnz reca_retry184
reca_resume185:
s_waitcnt vmcnt(1)
v_cmp_eq_u32 vcc, -1, v152
v_pk_add_f32 v[116:117], v[116:117], v[148:149]
v_pk_add_f32 v[118:119], v[118:119], v[150:151]
s_cbranch_vccnz reca_retry186
reca_resume187:
s_waitcnt vmcnt(0)
v_cmp_eq_u32 vcc, -1, v156
v_pk_add_f32 v[116:117], v[116:117], v[152:153]
v_pk_add_f32 v[118:119], v[118:119], v[154:155]
s_cbranch_vccnz reca_retry188
reca_resume189:
v_pk_add_f32 v[116:117], v[116:117], v[156:157]
v_pk_add_f32 v[118:119], v[118:119], v[158:159]
v_cvt_pk_bf16_f32 v132, v116, v117
v_cvt_pk_bf16_f32 v133, v118, v119
buffer_store_dwordx2 v[132:133], v16, s[4:7], s24 offen sc1
s_branch reca_b5134
reca_not2173:
s_cmp_lg_u32 s12, 3
s_cbranch_scc1 reca_b5134
s_add_u32 s36, s17, 1
s_cmp_ge_u32 s36, 63
s_cbranch_scc1 reca_nopf190
s_add_u32 s37, s36, 1
reca_pf191:
buffer_load_dword v28, v233, s[4:7], 0 offen sc1
s_waitcnt vmcnt(0)
v_cmp_gt_i32 vcc, s37, v28
s_cbranch_vccz reca_pfok192
s_sleep 1
s_sub_u32 s18, s18, 1
s_cbranch_scc0 reca_pf191
s_mov_b32 s18, 0
reca_pfok192:
s_lshl_b32 s34, s15, 3
s_and_b32 s35, s36, 7
s_add_u32 s34, s34, s35
s_mul_i32 s34, s34, 12288
s_add_u32 s32, s34, 37748736
s_lshl_b32 s35, s16, 11
s_add_u32 s34, s34, s35
s_add_u32 s33, s34, 40894464
buffer_load_dwordx4 a[120:123], v1, s[4:7], s32 offen offset:0 sc1
buffer_load_dwordx4 a[124:127], v1, s[4:7], s32 offen offset:1024 sc1
buffer_load_dwordx4 a[128:131], v1, s[4:7], s32 offen offset:2048 sc1
buffer_load_dwordx4 a[132:135], v1, s[4:7], s32 offen offset:3072 sc1
buffer_load_dwordx4 a[136:139], v2, s[4:7], s32 offen offset:0 sc1
buffer_load_dwordx4 a[140:143], v2, s[4:7], s32 offen offset:1024 sc1
buffer_load_dwordx4 a[144:147], v2, s[4:7], s32 offen offset:2048 sc1
buffer_load_dwordx4 a[148:151], v2, s[4:7], s32 offen offset:3072 sc1
buffer_load_dwordx4 a[152:155], v3, s[4:7], s32 offen offset:0 sc1
buffer_load_dwordx4 a[156:159], v3, s[4:7], s32 offen offset:1024 sc1
buffer_load_dwordx4 a[160:163], v3, s[4:7], s32 offen offset:2048 sc1
buffer_load_dwordx4 a[164:167], v3, s[4:7], s32 offen offset:3072 sc1
buffer_load_dwordx4 a[168:171], v1, s[4:7], s33 offen offset:0 sc1
buffer_load_dwordx4 a[172:175], v1, s[4:7], s33 offen offset:1024 sc1
reca_nopf190:
buffer_store_dwordx2 v[52:53], v9, s[4:7], s30 offen sc1
buffer_store_dwordx2 v[68:69], v10, s[4:7], s31 offen sc1
buffer_store_dwordx2 v[70:71], v10, s[4:7], s31 offen offset:256 sc1
reca_b5134:
s_barrier
s_add_u32 s17, s17, 1
s_branch reca_step120
reca_retry123:
s_sub_u32 s18, s18, 1
s_cbranch_scc1 reca_retry123_to
buffer_load_dwordx4 v[128:131], v4, s[4:7], s20 offen sc1
buffer_load_dwordx4 v[132:135], v4, s[4:7], s20 offen offset:1024 sc1
buffer_load_dwordx4 v[136:139], v5, s[4:7], s20 offen sc1
s_waitcnt vmcnt(2)
v_max_u32 v29, v128, v130
v_cmp_eq_u32 vcc, -1, v29
s_cbranch_vccnz reca_retry123
s_branch reca_resume124
reca_retry123_to:
s_mov_b32 s18, 0
s_waitcnt vmcnt(0)
s_branch reca_resume124
reca_retry125:
s_sub_u32 s18, s18, 1
s_cbranch_scc1 reca_retry125_to
buffer_load_dwordx4 v[132:135], v4, s[4:7], s20 offen offset:1024 sc1
buffer_load_dwordx4 v[136:139], v5, s[4:7], s20 offen sc1
s_waitcnt vmcnt(1)
v_max_u32 v29, v132, v134
v_cmp_eq_u32 vcc, -1, v29
s_cbranch_vccnz reca_retry125
s_branch reca_resume126
reca_retry125_to:
s_mov_b32 s18, 0
s_waitcnt vmcnt(0)
s_branch reca_resume126
reca_retry127:
s_sub_u32 s18, s18, 1
s_cbranch_scc1 reca_retry127_to
buffer_load_dwordx4 v[136:139], v5, s[4:7], s20 offen sc1
s_waitcnt vmcnt(0)
v_max_u32 v29, v136, v138
v_cmp_eq_u32 vcc, -1, v29
s_cbranch_vccnz reca_retry127
s_branch reca_resume128
reca_retry127_to:
s_mov_b32 s18, 0
s_waitcnt vmcnt(0)
s_branch reca_resume128
reca_retry136:
s_sub_u32 s18, s18, 1
s_cbranch_scc1 reca_retry136_to
buffer_load_dwordx4 v[208:211], v1, s[4:7], s21 offen offset:0 sc1
buffer_load_dwordx4 v[212:215], v1, s[4:7], s21 offen offset:1024 sc1
buffer_load_dwordx4 v[216:219], v1, s[4:7], s21 offen offset:2048 sc1
buffer_load_dwordx4 v[220:223], v1, s[4:7], s21 offen offset:3072 sc1
buffer_load_dwordx4 v[224:227], v2, s[4:7], s21 offen offset:0 sc1
buffer_load_dwordx4 v[228:231], v2, s[4:7], s21 offen offset:1024 sc1
s_waitcnt vmcnt(5)
v_max_u32 v29, v208, v210
v_cmp_eq_u32 vcc, -1, v29
s_cbranch_vccnz reca_retry136
s_branch reca_resume137
reca_retry136_to:
s_mov_b32 s18, 0
s_waitcnt vmcnt(0)
s_branch reca_resume137
reca_retry138:
s_sub_u32 s18, s18, 1
s_cbranch_scc1 reca_retry138_to
buffer_load_dwordx4 v[212:215], v1, s[4:7], s21 offen offset:1024 sc1
buffer_load_dwordx4 v[216:219], v1, s[4:7], s21 offen offset:2048 sc1
buffer_load_dwordx4 v[220:223], v1, s[4:7], s21 offen offset:3072 sc1
buffer_load_dwordx4 v[224:227], v2, s[4:7], s21 offen offset:0 sc1
buffer_load_dwordx4 v[228:231], v2, s[4:7], s21 offen offset:1024 sc1
s_waitcnt vmcnt(4)
v_max_u32 v29, v212, v214
v_cmp_eq_u32 vcc, -1, v29
s_cbranch_vccnz reca_retry138
s_branch reca_resume139
reca_retry138_to:
s_mov_b32 s18, 0
s_waitcnt vmcnt(0)
s_branch reca_resume139
reca_retry140:
s_sub_u32 s18, s18, 1
s_cbranch_scc1 reca_retry140_to
buffer_load_dwordx4 v[216:219], v1, s[4:7], s21 offen offset:2048 sc1
buffer_load_dwordx4 v[220:223], v1, s[4:7], s21 offen offset:3072 sc1
buffer_load_dwordx4 v[224:227], v2, s[4:7], s21 offen offset:0 sc1
buffer_load_dwordx4 v[228:231], v2, s[4:7], s21 offen offset:1024 sc1
s_waitcnt vmcnt(3)
v_max_u32 v29, v216, v218
v_cmp_eq_u32 vcc, -1, v29
s_cbranch_vccnz reca_retry140
s_branch reca_resume141
reca_retry140_to:
s_mov_b32 s18, 0
s_waitcnt vmcnt(0)
s_branch reca_resume141
reca_retry142:
s_sub_u32 s18, s18, 1
s_cbranch_scc1 reca_retry142_to
buffer_load_dwordx4 v[220:223], v1, s[4:7], s21 offen offset:3072 sc1
buffer_load_dwordx4 v[224:227], v2, s[4:7], s21 offen offset:0 sc1
buffer_load_dwordx4 v[228:231], v2, s[4:7], s21 offen offset:1024 sc1
s_waitcnt vmcnt(2)
v_max_u32 v29, v220, v222
v_cmp_eq_u32 vcc, -1, v29
s_cbranch_vccnz reca_retry142
s_branch reca_resume143
reca_retry142_to:
s_mov_b32 s18, 0
s_waitcnt vmcnt(0)
s_branch reca_resume143
reca_retry144:
s_sub_u32 s18, s18, 1
s_cbranch_scc1 reca_retry144_to
buffer_load_dwordx4 v[224:227], v2, s[4:7], s21 offen offset:0 sc1
buffer_load_dwordx4 v[228:231], v2, s[4:7], s21 offen offset:1024 sc1
s_waitcnt vmcnt(1)
v_max_u32 v29, v224, v226
v_cmp_eq_u32 vcc, -1, v29
s_cbranch_vccnz reca_retry144
s_branch reca_resume145
reca_retry144_to:
s_mov_b32 s18, 0
s_waitcnt vmcnt(0)
s_branch reca_resume145
reca_retry146:
s_sub_u32 s18, s18, 1
s_cbranch_scc1 reca_retry146_to
buffer_load_dwordx4 v[228:231], v2, s[4:7], s21 offen offset:1024 sc1
s_waitcnt vmcnt(0)
v_max_u32 v29, v228, v230
v_cmp_eq_u32 vcc, -1, v29
s_cbranch_vccnz reca_retry146
s_branch reca_resume147
reca_retry146_to:
s_mov_b32 s18, 0
s_waitcnt vmcnt(0)
s_branch reca_resume147
reca_retry149:
s_sub_u32 s18, s18, 1
s_cbranch_scc1 reca_retry149_to
buffer_load_dwordx4 v[128:131], v12, s[4:7], s22 offen offset:0 sc1
buffer_load_dwordx4 v[132:135], v12, s[4:7], s22 offen offset:1024 sc1
buffer_load_dwordx4 v[136:139], v12, s[4:7], s22 offen offset:2048 sc1
buffer_load_dwordx4 v[140:143], v12, s[4:7], s22 offen offset:3072 sc1
buffer_load_dwordx4 v[144:147], v13, s[4:7], s22 offen offset:0 sc1
buffer_load_dwordx4 v[148:151], v13, s[4:7], s22 offen offset:1024 sc1
buffer_load_dwordx4 v[152:155], v13, s[4:7], s22 offen offset:2048 sc1
buffer_load_dwordx4 v[156:159], v13, s[4:7], s22 offen offset:3072 sc1
buffer_load_dwordx4 v[160:163], v14, s[4:7], s22 offen offset:0 sc1
buffer_load_dwordx4 v[164:167], v14, s[4:7], s22 offen offset:1024 sc1
buffer_load_dwordx4 v[168:171], v14, s[4:7], s22 offen offset:2048 sc1
buffer_load_dwordx4 v[172:175], v14, s[4:7], s22 offen offset:3072 sc1
s_waitcnt vmcnt(11)
v_cmp_eq_u32 vcc, -1, v128
s_cbranch_vccnz reca_retry149
s_branch reca_resume150
reca_retry149_to:
s_mov_b32 s18, 0
s_waitcnt vmcnt(0)
s_branch reca_resume150
reca_retry151:
s_sub_u32 s18, s18, 1
s_cbranch_scc1 reca_retry151_to
buffer_load_dwordx4 v[132:135], v12, s[4:7], s22 offen offset:1024 sc1
buffer_load_dwordx4 v[136:139], v12, s[4:7], s22 offen offset:2048 sc1
buffer_load_dwordx4 v[140:143], v12, s[4:7], s22 offen offset:3072 sc1
buffer_load_dwordx4 v[144:147], v13, s[4:7], s22 offen offset:0 sc1
buffer_load_dwordx4 v[148:151], v13, s[4:7], s22 offen offset:1024 sc1
buffer_load_dwordx4 v[152:155], v13, s[4:7], s22 offen offset:2048 sc1
buffer_load_dwordx4 v[156:159], v13, s[4:7], s22 offen offset:3072 sc1
buffer_load_dwordx4 v[160:163], v14, s[4:7], s22 offen offset:0 sc1
buffer_load_dwordx4 v[164:167], v14, s[4:7], s22 offen offset:1024 sc1
buffer_load_dwordx4 v[168:171], v14, s[4:7], s22 offen offset:2048 sc1
buffer_load_dwordx4 v[172:175], v14, s[4:7], s22 offen offset:3072 sc1
s_waitcnt vmcnt(10)
v_cmp_eq_u32 vcc, -1, v132
s_cbranch_vccnz reca_retry151
s_branch reca_resume152
reca_retry151_to:
s_mov_b32 s18, 0
s_waitcnt vmcnt(0)
s_branch reca_resume152
reca_retry153:
s_sub_u32 s18, s18, 1
s_cbranch_scc1 reca_retry153_to
buffer_load_dwordx4 v[136:139], v12, s[4:7], s22 offen offset:2048 sc1
buffer_load_dwordx4 v[140:143], v12, s[4:7], s22 offen offset:3072 sc1
buffer_load_dwordx4 v[144:147], v13, s[4:7], s22 offen offset:0 sc1
buffer_load_dwordx4 v[148:151], v13, s[4:7], s22 offen offset:1024 sc1
buffer_load_dwordx4 v[152:155], v13, s[4:7], s22 offen offset:2048 sc1
buffer_load_dwordx4 v[156:159], v13, s[4:7], s22 offen offset:3072 sc1
buffer_load_dwordx4 v[160:163], v14, s[4:7], s22 offen offset:0 sc1
buffer_load_dwordx4 v[164:167], v14, s[4:7], s22 offen offset:1024 sc1
buffer_load_dwordx4 v[168:171], v14, s[4:7], s22 offen offset:2048 sc1
buffer_load_dwordx4 v[172:175], v14, s[4:7], s22 offen offset:3072 sc1
s_waitcnt vmcnt(9)
v_cmp_eq_u32 vcc, -1, v136
s_cbranch_vccnz reca_retry153
s_branch reca_resume154
reca_retry153_to:
s_mov_b32 s18, 0
s_waitcnt vmcnt(0)
s_branch reca_resume154
reca_retry155:
s_sub_u32 s18, s18, 1
s_cbranch_scc1 reca_retry155_to
buffer_load_dwordx4 v[140:143], v12, s[4:7], s22 offen offset:3072 sc1
buffer_load_dwordx4 v[144:147], v13, s[4:7], s22 offen offset:0 sc1
buffer_load_dwordx4 v[148:151], v13, s[4:7], s22 offen offset:1024 sc1
buffer_load_dwordx4 v[152:155], v13, s[4:7], s22 offen offset:2048 sc1
buffer_load_dwordx4 v[156:159], v13, s[4:7], s22 offen offset:3072 sc1
buffer_load_dwordx4 v[160:163], v14, s[4:7], s22 offen offset:0 sc1
buffer_load_dwordx4 v[164:167], v14, s[4:7], s22 offen offset:1024 sc1
buffer_load_dwordx4 v[168:171], v14, s[4:7], s22 offen offset:2048 sc1
buffer_load_dwordx4 v[172:175], v14, s[4:7], s22 offen offset:3072 sc1
s_waitcnt vmcnt(8)
v_cmp_eq_u32 vcc, -1, v140
s_cbranch_vccnz reca_retry155
s_branch reca_resume156
reca_retry155_to:
s_mov_b32 s18, 0
s_waitcnt vmcnt(0)
s_branch reca_resume156
reca_retry157:
s_sub_u32 s18, s18, 1
s_cbranch_scc1 reca_retry157_to
buffer_load_dwordx4 v[144:147], v13, s[4:7], s22 offen offset:0 sc1
buffer_load_dwordx4 v[148:151], v13, s[4:7], s22 offen offset:1024 sc1
buffer_load_dwordx4 v[152:155], v13, s[4:7], s22 offen offset:2048 sc1
buffer_load_dwordx4 v[156:159], v13, s[4:7], s22 offen offset:3072 sc1
buffer_load_dwordx4 v[160:163], v14, s[4:7], s22 offen offset:0 sc1
buffer_load_dwordx4 v[164:167], v14, s[4:7], s22 offen offset:1024 sc1
buffer_load_dwordx4 v[168:171], v14, s[4:7], s22 offen offset:2048 sc1
buffer_load_dwordx4 v[172:175], v14, s[4:7], s22 offen offset:3072 sc1
s_waitcnt vmcnt(7)
v_cmp_eq_u32 vcc, -1, v144
s_cbranch_vccnz reca_retry157
s_branch reca_resume158
reca_retry157_to:
s_mov_b32 s18, 0
s_waitcnt vmcnt(0)
s_branch reca_resume158
reca_retry159:
s_sub_u32 s18, s18, 1
s_cbranch_scc1 reca_retry159_to
buffer_load_dwordx4 v[148:151], v13, s[4:7], s22 offen offset:1024 sc1
buffer_load_dwordx4 v[152:155], v13, s[4:7], s22 offen offset:2048 sc1
buffer_load_dwordx4 v[156:159], v13, s[4:7], s22 offen offset:3072 sc1
buffer_load_dwordx4 v[160:163], v14, s[4:7], s22 offen offset:0 sc1
buffer_load_dwordx4 v[164:167], v14, s[4:7], s22 offen offset:1024 sc1
buffer_load_dwordx4 v[168:171], v14, s[4:7], s22 offen offset:2048 sc1
buffer_load_dwordx4 v[172:175], v14, s[4:7], s22 offen offset:3072 sc1
s_waitcnt vmcnt(6)
v_cmp_eq_u32 vcc, -1, v148
s_cbranch_vccnz reca_retry159
s_branch reca_resume160
reca_retry159_to:
s_mov_b32 s18, 0
s_waitcnt vmcnt(0)
s_branch reca_resume160
reca_retry161:
s_sub_u32 s18, s18, 1
s_cbranch_scc1 reca_retry161_to
buffer_load_dwordx4 v[152:155], v13, s[4:7], s22 offen offset:2048 sc1
buffer_load_dwordx4 v[156:159], v13, s[4:7], s22 offen offset:3072 sc1
buffer_load_dwordx4 v[160:163], v14, s[4:7], s22 offen offset:0 sc1
buffer_load_dwordx4 v[164:167], v14, s[4:7], s22 offen offset:1024 sc1
buffer_load_dwordx4 v[168:171], v14, s[4:7], s22 offen offset:2048 sc1
buffer_load_dwordx4 v[172:175], v14, s[4:7], s22 offen offset:3072 sc1
s_waitcnt vmcnt(5)
v_cmp_eq_u32 vcc, -1, v152
s_cbranch_vccnz reca_retry161
s_branch reca_resume162
reca_retry161_to:
s_mov_b32 s18, 0
s_waitcnt vmcnt(0)
s_branch reca_resume162
reca_retry163:
s_sub_u32 s18, s18, 1
s_cbranch_scc1 reca_retry163_to
buffer_load_dwordx4 v[156:159], v13, s[4:7], s22 offen offset:3072 sc1
buffer_load_dwordx4 v[160:163], v14, s[4:7], s22 offen offset:0 sc1
buffer_load_dwordx4 v[164:167], v14, s[4:7], s22 offen offset:1024 sc1
buffer_load_dwordx4 v[168:171], v14, s[4:7], s22 offen offset:2048 sc1
buffer_load_dwordx4 v[172:175], v14, s[4:7], s22 offen offset:3072 sc1
s_waitcnt vmcnt(4)
v_cmp_eq_u32 vcc, -1, v156
s_cbranch_vccnz reca_retry163
s_branch reca_resume164
reca_retry163_to:
s_mov_b32 s18, 0
s_waitcnt vmcnt(0)
s_branch reca_resume164
reca_retry165:
s_sub_u32 s18, s18, 1
s_cbranch_scc1 reca_retry165_to
buffer_load_dwordx4 v[160:163], v14, s[4:7], s22 offen offset:0 sc1
buffer_load_dwordx4 v[164:167], v14, s[4:7], s22 offen offset:1024 sc1
buffer_load_dwordx4 v[168:171], v14, s[4:7], s22 offen offset:2048 sc1
buffer_load_dwordx4 v[172:175], v14, s[4:7], s22 offen offset:3072 sc1
s_waitcnt vmcnt(3)
v_cmp_eq_u32 vcc, -1, v160
s_cbranch_vccnz reca_retry165
s_branch reca_resume166
reca_retry165_to:
s_mov_b32 s18, 0
s_waitcnt vmcnt(0)
s_branch reca_resume166
reca_retry167:
s_sub_u32 s18, s18, 1
s_cbranch_scc1 reca_retry167_to
buffer_load_dwordx4 v[164:167], v14, s[4:7], s22 offen offset:1024 sc1
buffer_load_dwordx4 v[168:171], v14, s[4:7], s22 offen offset:2048 sc1
buffer_load_dwordx4 v[172:175], v14, s[4:7], s22 offen offset:3072 sc1
s_waitcnt vmcnt(2)
v_cmp_eq_u32 vcc, -1, v164
s_cbranch_vccnz reca_retry167
s_branch reca_resume168
reca_retry167_to:
s_mov_b32 s18, 0
s_waitcnt vmcnt(0)
s_branch reca_resume168
reca_retry169:
s_sub_u32 s18, s18, 1
s_cbranch_scc1 reca_retry169_to
buffer_load_dwordx4 v[168:171], v14, s[4:7], s22 offen offset:2048 sc1
buffer_load_dwordx4 v[172:175], v14, s[4:7], s22 offen offset:3072 sc1
s_waitcnt vmcnt(1)
v_cmp_eq_u32 vcc, -1, v168
s_cbranch_vccnz reca_retry169
s_branch reca_resume170
reca_retry169_to:
s_mov_b32 s18, 0
s_waitcnt vmcnt(0)
s_branch reca_resume170
reca_retry171:
s_sub_u32 s18, s18, 1
s_cbranch_scc1 reca_retry171_to
buffer_load_dwordx4 v[172:175], v14, s[4:7], s22 offen offset:3072 sc1
s_waitcnt vmcnt(0)
v_cmp_eq_u32 vcc, -1, v172
s_cbranch_vccnz reca_retry171
s_branch reca_resume172
reca_retry171_to:
s_mov_b32 s18, 0
s_waitcnt vmcnt(0)
s_branch reca_resume172
reca_retry174:
s_sub_u32 s18, s18, 1
s_cbranch_scc1 reca_retry174_to
buffer_load_dwordx4 v[128:131], v20, s[4:7], s25 offen sc1
buffer_load_dwordx4 v[132:135], v21, s[4:7], s25 offen sc1
buffer_load_dwordx4 v[136:139], v22, s[4:7], s25 offen sc1
buffer_load_dwordx4 v[140:143], v23, s[4:7], s25 offen sc1
buffer_load_dwordx4 v[144:147], v24, s[4:7], s25 offen sc1
buffer_load_dwordx4 v[148:151], v25, s[4:7], s25 offen sc1
buffer_load_dwordx4 v[152:155], v26, s[4:7], s25 offen sc1
buffer_load_dwordx4 v[156:159], v27, s[4:7], s25 offen sc1
s_waitcnt vmcnt(7)
v_cmp_eq_u32 vcc, -1, v128
s_cbranch_vccnz reca_retry174
s_branch reca_resume175
reca_retry174_to:
s_mov_b32 s18, 0
s_waitcnt vmcnt(0)
s_branch reca_resume175
reca_retry176:
s_sub_u32 s18, s18, 1
s_cbranch_scc1 reca_retry176_to
buffer_load_dwordx4 v[132:135], v21, s[4:7], s25 offen sc1
buffer_load_dwordx4 v[136:139], v22, s[4:7], s25 offen sc1
buffer_load_dwordx4 v[140:143], v23, s[4:7], s25 offen sc1
buffer_load_dwordx4 v[144:147], v24, s[4:7], s25 offen sc1
buffer_load_dwordx4 v[148:151], v25, s[4:7], s25 offen sc1
buffer_load_dwordx4 v[152:155], v26, s[4:7], s25 offen sc1
buffer_load_dwordx4 v[156:159], v27, s[4:7], s25 offen sc1
s_waitcnt vmcnt(6)
v_cmp_eq_u32 vcc, -1, v132
s_cbranch_vccnz reca_retry176
s_branch reca_resume177
reca_retry176_to:
s_mov_b32 s18, 0
s_waitcnt vmcnt(0)
s_branch reca_resume177
reca_retry178:
s_sub_u32 s18, s18, 1
s_cbranch_scc1 reca_retry178_to
buffer_load_dwordx4 v[136:139], v22, s[4:7], s25 offen sc1
buffer_load_dwordx4 v[140:143], v23, s[4:7], s25 offen sc1
buffer_load_dwordx4 v[144:147], v24, s[4:7], s25 offen sc1
buffer_load_dwordx4 v[148:151], v25, s[4:7], s25 offen sc1
buffer_load_dwordx4 v[152:155], v26, s[4:7], s25 offen sc1
buffer_load_dwordx4 v[156:159], v27, s[4:7], s25 offen sc1
s_waitcnt vmcnt(5)
v_cmp_eq_u32 vcc, -1, v136
s_cbranch_vccnz reca_retry178
s_branch reca_resume179
reca_retry178_to:
s_mov_b32 s18, 0
s_waitcnt vmcnt(0)
s_branch reca_resume179
reca_retry180:
s_sub_u32 s18, s18, 1
s_cbranch_scc1 reca_retry180_to
buffer_load_dwordx4 v[140:143], v23, s[4:7], s25 offen sc1
buffer_load_dwordx4 v[144:147], v24, s[4:7], s25 offen sc1
buffer_load_dwordx4 v[148:151], v25, s[4:7], s25 offen sc1
buffer_load_dwordx4 v[152:155], v26, s[4:7], s25 offen sc1
buffer_load_dwordx4 v[156:159], v27, s[4:7], s25 offen sc1
s_waitcnt vmcnt(4)
v_cmp_eq_u32 vcc, -1, v140
s_cbranch_vccnz reca_retry180
s_branch reca_resume181
reca_retry180_to:
s_mov_b32 s18, 0
s_waitcnt vmcnt(0)
s_branch reca_resume181
reca_retry182:
s_sub_u32 s18, s18, 1
s_cbranch_scc1 reca_retry182_to
buffer_load_dwordx4 v[144:147], v24, s[4:7], s25 offen sc1
buffer_load_dwordx4 v[148:151], v25, s[4:7], s25 offen sc1
buffer_load_dwordx4 v[152:155], v26, s[4:7], s25 offen sc1
buffer_load_dwordx4 v[156:159], v27, s[4:7], s25 offen sc1
s_waitcnt vmcnt(3)
v_cmp_eq_u32 vcc, -1, v144
s_cbranch_vccnz reca_retry182
s_branch reca_resume183
reca_retry182_to:
s_mov_b32 s18, 0
s_waitcnt vmcnt(0)
s_branch reca_resume183
reca_retry184:
s_sub_u32 s18, s18, 1
s_cbranch_scc1 reca_retry184_to
buffer_load_dwordx4 v[148:151], v25, s[4:7], s25 offen sc1
buffer_load_dwordx4 v[152:155], v26, s[4:7], s25 offen sc1
buffer_load_dwordx4 v[156:159], v27, s[4:7], s25 offen sc1
s_waitcnt vmcnt(2)
v_cmp_eq_u32 vcc, -1, v148
s_cbranch_vccnz reca_retry184
s_branch reca_resume185
reca_retry184_to:
s_mov_b32 s18, 0
s_waitcnt vmcnt(0)
s_branch reca_resume185
reca_retry186:
s_sub_u32 s18, s18, 1
s_cbranch_scc1 reca_retry186_to
buffer_load_dwordx4 v[152:155], v26, s[4:7], s25 offen sc1
buffer_load_dwordx4 v[156:159], v27, s[4:7], s25 offen sc1
s_waitcnt vmcnt(1)
v_cmp_eq_u32 vcc, -1, v152
s_cbranch_vccnz reca_retry186
s_branch reca_resume187
reca_retry186_to:
s_mov_b32 s18, 0
s_waitcnt vmcnt(0)
s_branch reca_resume187
reca_retry188:
s_sub_u32 s18, s18, 1
s_cbranch_scc1 reca_retry188_to
buffer_load_dwordx4 v[156:159], v27, s[4:7], s25 offen sc1
s_waitcnt vmcnt(0)
v_cmp_eq_u32 vcc, -1, v156
s_cbranch_vccnz reca_retry188
s_branch reca_resume189
reca_retry188_to:
s_mov_b32 s18, 0
s_waitcnt vmcnt(0)
s_branch reca_resume189
reca_twins13:
s_branch reca_gotmem194
reca_step193:
s_and_b32 s34, s17, 3
s_mul_i32 s20, s34, 10240
s_add_u32 s20, s20, s38
s_sleep 4
buffer_load_dwordx4 v[128:131], v4, s[4:7], s20 offen sc1
buffer_load_dwordx4 v[132:135], v4, s[4:7], s20 offen offset:1024 sc1
buffer_load_dwordx4 v[136:139], v5, s[4:7], s20 offen sc1
s_waitcnt vmcnt(2)
v_max_u32 v29, v128, v130
v_cmp_eq_u32 vcc, -1, v29
s_cbranch_vccnz reca_retry196
reca_resume197:
s_waitcnt vmcnt(1)
v_max_u32 v29, v132, v134
v_cmp_eq_u32 vcc, -1, v29
ds_write_b128 v4, v[128:131]
s_cbranch_vccnz reca_retry198
reca_resume199:
s_waitcnt vmcnt(0)
v_max_u32 v29, v136, v138
v_cmp_eq_u32 vcc, -1, v29
ds_write_b128 v4, v[132:135] offset:1024
s_cbranch_vccnz reca_retry200
reca_resume201:
ds_write_b128 v5, v[136:139]
s_branch reca_gotmem2195
reca_gotmem194:
ds_write_b128 v4, v[128:131]
ds_write_b128 v4, v[132:135] offset:1024
ds_write_b128 v5, v[136:139]
reca_gotmem2195:
s_and_b32 s34, s17, 3
s_mul_i32 s21, s34, 6144
s_add_u32 s21, s21, s39
s_mul_i32 s22, s34, 12288
s_add_u32 s22, s22, s40
s_mul_i32 s25, s34, 393216
s_add_u32 s25, s25, s56
s_add_u32 s35, s17, 1
s_and_b32 s35, s35, 3
s_mul_i32 s24, s35, 10240
s_add_u32 s24, s24, s38
s_waitcnt lgkmcnt(0)
s_barrier
ds_read_b128 v[128:131], v236 offset:0
ds_read_b128 v[132:135], v236 offset:1024
ds_read_b128 v[136:139], v236 offset:2048
ds_read_b128 v[140:143], v236 offset:3072
ds_read_b128 v[144:147], v236 offset:4096
ds_read_b128 v[148:151], v237 offset:0
ds_read_b128 v[152:155], v237 offset:1024
ds_read_b128 v[156:159], v237 offset:2048
ds_read_b128 v[160:163], v237 offset:3072
ds_read_b128 v[164:167], v237 offset:4096
s_waitcnt lgkmcnt(9)
v_mfma_f32_16x16x32_bf16 v[44:47], a[0:3], v[128:131], 0
ds_read_b128 v[168:171], v6 offset:0
v_mfma_f32_16x16x32_bf16 v[240:243], a[4:7], v[128:131], 0
s_waitcnt lgkmcnt(9)
v_mfma_f32_16x16x32_bf16 v[44:47], a[8:11], v[132:135], v[44:47]
ds_read_b128 v[172:175], v6 offset:512
v_mfma_f32_16x16x32_bf16 v[240:243], a[12:15], v[132:135], v[240:243]
s_waitcnt lgkmcnt(9)
v_mfma_f32_16x16x32_bf16 v[44:47], a[16:19], v[136:139], v[44:47]
ds_read_b128 v[176:179], v6 offset:1024
v_mfma_f32_16x16x32_bf16 v[240:243], a[20:23], v[136:139], v[240:243]
s_waitcnt lgkmcnt(9)
v_mfma_f32_16x16x32_bf16 v[44:47], a[24:27], v[140:143], v[44:47]
ds_read_b128 v[180:183], v6 offset:1536
v_mfma_f32_16x16x32_bf16 v[240:243], a[28:31], v[140:143], v[240:243]
s_waitcnt lgkmcnt(9)
v_mfma_f32_16x16x32_bf16 v[44:47], a[32:35], v[144:147], v[44:47]
ds_read_b128 v[184:187], v6 offset:2048
v_mfma_f32_16x16x32_bf16 v[240:243], a[36:39], v[144:147], v[240:243]
s_waitcnt lgkmcnt(9)
v_mfma_f32_16x16x32_bf16 v[44:47], a[40:43], v[148:151], v[44:47]
ds_read_b128 v[188:191], v6 offset:2560
v_mfma_f32_16x16x32_bf16 v[240:243], a[44:47], v[148:151], v[240:243]
s_waitcnt lgkmcnt(9)
v_mfma_f32_16x16x32_bf16 v[44:47], a[48:51], v[152:155], v[44:47]
ds_read_b128 v[192:195], v6 offset:3072
v_mfma_f32_16x16x32_bf16 v[240:243], a[52:55], v[152:155], v[240:243]
s_waitcnt lgkmcnt(9)
v_mfma_f32_16x16x32_bf16 v[44:47], a[56:59], v[156:159], v[44:47]
ds_read_b128 v[196:199], v6 offset:3584
v_mfma_f32_16x16x32_bf16 v[240:243], a[60:63], v[156:159], v[240:243]
s_waitcnt lgkmcnt(9)
v_mfma_f32_16x16x32_bf16 v[44:47], a[64:67], v[160:163], v[44:47]
ds_read_b128 v[200:203], v6 offset:4096
v_mfma_f32_16x16x32_bf16 v[240:243], a[68:71], v[160:163], v[240:243]
s_waitcnt lgkmcnt(9)
v_mfma_f32_16x16x32_bf16 v[44:47], a[72:75], v[164:167], v[44:47]
ds_read_b128 v[204:207], v6 offset:4608
v_mfma_f32_16x16x32_bf16 v[240:243], a[76:79], v[164:167], v[240:243]
s_waitcnt lgkmcnt(9)
v_mfma_f32_16x16x32_bf16 v[48:51], v[168:171], a[80:83], 0
s_and_b32 s34, s17, 7
s_lshl_b32 s34, s34, 5
s_add_u32 s34, s34, s15
s_mul_i32 s34, s34, 3072
s_lshl_b32 s35, s16, 9
s_add_u32 s34, s34, s35
s_add_u32 s30, s34, 47185920
s_add_u32 s31, s34, 47972352
v_add_f32_dpp v44, v240, v44 row_ror:8 row_mask:0xf bank_mask:0xf
v_add_f32_dpp v45, v241, v45 row_ror:8 row_mask:0xf bank_mask:0xf
v_add_f32_dpp v46, v242, v46 row_ror:8 row_mask:0xf bank_mask:0xf
v_add_f32_dpp v47, v243, v47 row_ror:8 row_mask:0xf bank_mask:0xf
v_cvt_pk_bf16_f32 v52, v44, v45
v_cvt_pk_bf16_f32 v53, v46, v47
buffer_store_dwordx2 v[52:53], v8, s[4:7], s21 offen sc1
s_waitcnt lgkmcnt(8)
v_mfma_f32_16x16x32_bf16 v[48:51], v[172:175], a[84:87], v[48:51]
s_waitcnt lgkmcnt(7)
v_mfma_f32_16x16x32_bf16 v[48:51], v[176:179], a[88:91], v[48:51]
s_waitcnt lgkmcnt(6)
v_mfma_f32_16x16x32_bf16 v[48:51], v[180:183], a[92:95], v[48:51]
s_waitcnt lgkmcnt(5)
v_mfma_f32_16x16x32_bf16 v[48:51], v[184:187], a[96:99], v[48:51]
s_waitcnt lgkmcnt(4)
v_mfma_f32_16x16x32_bf16 v[48:51], v[188:191], a[100:103], v[48:51]
s_waitcnt lgkmcnt(3)
v_mfma_f32_16x16x32_bf16 v[48:51], v[192:195], a[104:107], v[48:51]
s_waitcnt lgkmcnt(2)
v_mfma_f32_16x16x32_bf16 v[48:51], v[196:199], a[108:111], v[48:51]
s_waitcnt lgkmcnt(1)
v_mfma_f32_16x16x32_bf16 v[48:51], v[200:203], a[112:115], v[48:51]
s_waitcnt lgkmcnt(0)
v_mfma_f32_16x16x32_bf16 v[48:51], v[204:207], a[116:119], v[48:51]
s_cmp_eq_u32 s12, 3
s_cbranch_scc1 reca_swave202
s_nop 5
ds_write_b128 v17, v[48:51]
s_add_u32 s34, s17, 2
s_and_b32 s34, s34, 3
s_mul_i32 s26, s34, 10240
s_add_u32 s26, s26, s38
s_mul_i32 s27, s34, 6144
s_add_u32 s27, s27, s39
s_mul_i32 s28, s34, 12288
s_add_u32 s28, s28, s40
s_mul_i32 s29, s34, 393216
s_add_u32 s29, s29, s56
s_waitcnt lgkmcnt(0)
s_barrier
s_cmp_eq_u32 s17, 63
s_cbranch_scc1 reca_last204
buffer_store_dwordx2 v[32:33], v8, s[4:7], s27 offen sc1
s_cmp_lg_u32 s12, 2
s_cbranch_scc1 reca_tw1208_n
buffer_store_dwordx2 v[52:53], v9, s[4:7], s30 offen sc1
reca_tw1208_n:
s_barrier
s_cmp_eq_u32 s12, 1
s_cbranch_scc1 reca_tw1208
s_cmp_eq_u32 s12, 2
s_cbranch_scc1 reca_tw2209
s_cmp_lt_u32 s17, 2
s_cbranch_scc1 reca_b5207
s_cmp_gt_u32 s17, 61
s_cbranch_scc1 reca_b5207
s_sub_u32 s36, s17, 2
s_and_b32 s36, s36, 7
s_lshl_b32 s34, s59, 3
s_add_u32 s34, s34, s36
s_mul_i32 s34, s34, 12288
s_add_u32 s23, s34, 37748736
s_add_u32 s60, s34, 44040192
s_lshl_b32 s35, s36, 5
s_add_u32 s35, s35, s59
s_mul_i32 s35, s35, 3072
s_add_u32 s61, s35, 47185920
buffer_load_dwordx4 a[120:123], v1, s[4:7], s23 offen offset:0 sc1
buffer_load_dwordx4 a[124:127], v1, s[4:7], s23 offen offset:1024 sc1
buffer_load_dwordx4 a[128:131], v1, s[4:7], s23 offen offset:2048 sc1
buffer_load_dwordx4 a[132:135], v1, s[4:7], s23 offen offset:3072 sc1
buffer_load_dwordx4 a[136:139], v2, s[4:7], s23 offen offset:0 sc1
buffer_load_dwordx4 a[140:143], v2, s[4:7], s23 offen offset:1024 sc1
buffer_load_dwordx4 a[144:147], v2, s[4:7], s23 offen offset:2048 sc1
buffer_load_dwordx4 a[148:151], v2, s[4:7], s23 offen offset:3072 sc1
buffer_load_dwordx4 a[152:155], v3, s[4:7], s23 offen offset:0 sc1
buffer_load_dwordx4 a[156:159], v3, s[4:7], s23 offen offset:1024 sc1
buffer_load_dwordx4 a[160:163], v3, s[4:7], s23 offen offset:2048 sc1
buffer_load_dwordx4 a[164:167], v3, s[4:7], s23 offen offset:3072 sc1
buffer_load_dwordx4 a[216:219], v92, s[4:7], s61 offen offset:0 sc1
buffer_load_dwordx4 a[220:223], v92, s[4:7], s61 offen offset:512 sc1
buffer_load_dwordx4 a[224:227], v92, s[4:7], s61 offen offset:1024 sc1
buffer_load_dwordx4 a[228:231], v92, s[4:7], s61 offen offset:1536 sc1
buffer_load_dwordx4 a[232:235], v92, s[4:7], s61 offen offset:2048 sc1
buffer_load_dwordx4 a[236:239], v92, s[4:7], s61 offen offset:2560 sc1
buffer_load_dwordx4 a[168:171], v1, s[4:7], s60 offen offset:0 sc1
buffer_load_dwordx4 a[172:175], v1, s[4:7], s60 offen offset:1024 sc1
buffer_load_dwordx4 a[176:179], v1, s[4:7], s60 offen offset:2048 sc1
buffer_load_dwordx4 a[180:183], v1, s[4:7], s60 offen offset:3072 sc1
buffer_load_dwordx4 a[184:187], v2, s[4:7], s60 offen offset:0 sc1
buffer_load_dwordx4 a[188:191], v2, s[4:7], s60 offen offset:1024 sc1
buffer_load_dwordx4 a[192:195], v2, s[4:7], s60 offen offset:2048 sc1
buffer_load_dwordx4 a[196:199], v2, s[4:7], s60 offen offset:3072 sc1
buffer_load_dwordx4 a[200:203], v3, s[4:7], s60 offen offset:0 sc1
buffer_load_dwordx4 a[204:207], v3, s[4:7], s60 offen offset:1024 sc1
buffer_load_dwordx4 a[208:211], v3, s[4:7], s60 offen offset:2048 sc1
buffer_load_dwordx4 a[212:215], v3, s[4:7], s60 offen offset:3072 sc1
s_waitcnt vmcnt(5)
v_mfma_f32_16x16x32_bf16 v[128:131], a[216:219], a[168:171], v[84:87]
v_mfma_f32_16x16x32_bf16 v[132:135], a[120:123], a[168:171], v[88:91]
v_mfma_f32_16x16x32_bf16 v[136:139], a[216:219], a[192:195], v[84:87]
v_mfma_f32_16x16x32_bf16 v[140:143], a[120:123], a[192:195], 0
v_mfma_f32_16x16x32_bf16 v[144:147], a[144:147], a[192:195], v[88:91]
s_waitcnt vmcnt(4)
v_mfma_f32_16x16x32_bf16 v[128:131], a[220:223], a[172:175], v[128:131]
v_mfma_f32_16x16x32_bf16 v[132:135], a[124:127], a[172:175], v[132:135]
v_mfma_f32_16x16x32_bf16 v[136:139], a[220:223], a[196:199], v[136:139]
v_mfma_f32_16x16x32_bf16 v[140:143], a[124:127], a[196:199], v[140:143]
v_mfma_f32_16x16x32_bf16 v[144:147], a[148:151], a[196:199], v[144:147]
s_waitcnt vmcnt(3)
v_mfma_f32_16x16x32_bf16 v[128:131], a[224:227], a[176:179], v[128:131]
v_mfma_f32_16x16x32_bf16 v[132:135], a[128:131], a[176:179], v[132:135]
v_mfma_f32_16x16x32_bf16 v[136:139], a[224:227], a[200:203], v[136:139]
v_mfma_f32_16x16x32_bf16 v[140:143], a[128:131], a[200:203], v[140:143]
v_mfma_f32_16x16x32_bf16 v[144:147], a[152:155], a[200:203], v[144:147]
s_waitcnt vmcnt(2)
v_mfma_f32_16x16x32_bf16 v[128:131], a[228:231], a[180:183], v[128:131]
v_mfma_f32_16x16x32_bf16 v[132:135], a[132:135], a[180:183], v[132:135]
v_mfma_f32_16x16x32_bf16 v[136:139], a[228:231], a[204:207], v[136:139]
v_mfma_f32_16x16x32_bf16 v[140:143], a[132:135], a[204:207], v[140:143]
v_mfma_f32_16x16x32_bf16 v[144:147], a[156:159], a[204:207], v[144:147]
s_waitcnt vmcnt(1)
v_mfma_f32_16x16x32_bf16 v[128:131], a[232:235], a[184:187], v[128:131]
v_mfma_f32_16x16x32_bf16 v[132:135], a[136:139], a[184:187], v[132:135]
v_mfma_f32_16x16x32_bf16 v[136:139], a[232:235], a[208:211], v[136:139]
v_mfma_f32_16x16x32_bf16 v[140:143], a[136:139], a[208:211], v[140:143]
v_mfma_f32_16x16x32_bf16 v[144:147], a[160:163], a[208:211], v[144:147]
s_waitcnt vmcnt(0)
v_mfma_f32_16x16x32_bf16 v[128:131], a[236:239], a[188:191], v[128:131]
v_mfma_f32_16x16x32_bf16 v[132:135], a[140:143], a[188:191], v[132:135]
v_mfma_f32_16x16x32_bf16 v[136:139], a[236:239], a[212:215], v[136:139]
v_mfma_f32_16x16x32_bf16 v[140:143], a[140:143], a[212:215], v[140:143]
v_mfma_f32_16x16x32_bf16 v[144:147], a[164:167], a[212:215], v[144:147]
s_nop 3
v_max3_f32 v28, v128, v129, v130
v_max3_f32 v28, v28, v131, v132
v_max3_f32 v28, v28, v133, v134
v_max_f32 v28, v28, v135
v_mov_b32 v29, v28
s_nop 1
v_permlane32_swap_b32 v28, v29
v_max_f32 v28, v28, v29
v_mov_b32 v29, v28
s_nop 1
v_permlane16_swap_b32 v28, v29
v_max_f32 v28, v28, v29
v_mul_f32 v28, s41, v28
v_fma_f32 v128, v128, s41, -v28
v_fma_f32 v129, v129, s41, -v28
v_fma_f32 v130, v130, s41, -v28
v_fma_f32 v131, v131, s41, -v28
v_fma_f32 v132, v132, s41, -v28
v_fma_f32 v133, v133, s41, -v28
v_fma_f32 v134, v134, s41, -v28
v_fma_f32 v135, v135, s41, -v28
v_exp_f32 v128, v128
v_exp_f32 v129, v129
v_exp_f32 v130, v130
v_exp_f32 v131, v131
v_exp_f32 v132, v132
v_exp_f32 v133, v133
v_exp_f32 v134, v134
v_exp_f32 v135, v135
v_max3_f32 v30, v136, v137, v138
v_max3_f32 v30, v30, v139, v140
v_max3_f32 v30, v30, v141, v142
v_max3_f32 v30, v30, v143, v144
v_max3_f32 v30, v30, v145, v146
v_max_f32 v30, v30, v147
v_mov_b32 v29, v30
s_nop 1
v_permlane32_swap_b32 v30, v29
v_max_f32 v30, v30, v29
v_mov_b32 v29, v30
s_nop 1
v_permlane16_swap_b32 v30, v29
v_max_f32 v30, v30, v29
v_mul_f32 v30, s41, v30
v_fma_f32 v136, v136, s41, -v30
v_fma_f32 v137, v137, s41, -v30
v_fma_f32 v138, v138, s41, -v30
v_fma_f32 v139, v139, s41, -v30
v_fma_f32 v140, v140, s41, -v30
v_fma_f32 v141, v141, s41, -v30
v_fma_f32 v142, v142, s41, -v30
v_fma_f32 v143, v143, s41, -v30
v_fma_f32 v144, v144, s41, -v30
v_fma_f32 v145, v145, s41, -v30
v_fma_f32 v146, v146, s41, -v30
v_fma_f32 v147, v147, s41, -v30
v_exp_f32 v136, v136
v_exp_f32 v137, v137
v_exp_f32 v138, v138
v_exp_f32 v139, v139
v_exp_f32 v140, v140
v_exp_f32 v141, v141
v_exp_f32 v142, v142
v_exp_f32 v143, v143
v_exp_f32 v144, v144
v_exp_f32 v145, v145
v_exp_f32 v146, v146
v_exp_f32 v147, v147
v_cvt_pk_bf16_f32 v72, v128, v129
v_cvt_pk_bf16_f32 v73, v130, v131
v_cvt_pk_bf16_f32 v74, v132, v133
v_cvt_pk_bf16_f32 v75, v134, v135
v_cvt_pk_bf16_f32 v76, v136, v137
v_cvt_pk_bf16_f32 v77, v138, v139
v_cvt_pk_bf16_f32 v78, v140, v141
v_cvt_pk_bf16_f32 v79, v142, v143
v_cvt_pk_bf16_f32 v80, v144, v145
v_cvt_pk_bf16_f32 v81, v146, v147
v_mfma_f32_16x16x16_bf16 v[148:151], v[36:37], v[72:73], 0
v_mfma_f32_16x16x16_bf16 v[152:155], v[36:37], v[76:77], 0
v_mfma_f32_16x16x16_bf16 v[148:151], v[36:37], v[74:75], v[148:151]
v_mfma_f32_16x16x32_bf16 v[152:155], v[36:39], v[78:81], v[152:155]
s_nop 6
v_rcp_f32 v82, v148
v_rcp_f32 v83, v152
s_and_b32 s34, s17, 1
s_mul_i32 s34, s34, 3072
v_add_u32 v28, s34, v1
ds_write_b128 v28, v[72:75] offset:16384
ds_write_b128 v28, v[76:79] offset:17408
ds_write_b128 v28, v[80:83] offset:18432
s_waitcnt lgkmcnt(0)
s_branch reca_b5207
reca_tw1208:
s_cmp_lt_u32 s17, 3
s_cbranch_scc1 reca_b5207
s_sub_u32 s36, s17, 3
s_and_b32 s37, s36, 7
s_lshl_b32 s34, s59, 3
s_add_u32 s34, s34, s37
s_mul_i32 s34, s34, 12288
s_add_u32 s23, s34, 40894464
s_lshl_b32 s35, s37, 5
s_add_u32 s35, s35, s59
s_mul_i32 s35, s35, 3072
s_add_u32 s61, s35, 47972352
s_mul_i32 s34, s36, 393216
s_mul_i32 s35, s59, 6144
s_add_u32 s34, s34, s35
s_add_u32 s60, s34, 57147392
s_add_u32 s34, s17, 1
s_and_b32 s34, s34, 1
s_mul_i32 s34, s34, 3072
v_add_u32 v28, s34, v1
ds_read_b128 v[72:75], v28 offset:16384
ds_read_b128 v[76:79], v28 offset:17408
ds_read_b128 v[80:83], v28 offset:18432
buffer_load_dwordx2 a[168:169], v93, s[4:7], s61 offen offset:0 sc1
buffer_load_dwordx4 a[120:123], v1, s[4:7], s23 offen offset:0 sc1
buffer_load_dwordx2 a[170:171], v93, s[4:7], s61 offen offset:256 sc1
buffer_load_dwordx4 a[124:127], v1, s[4:7], s23 offen offset:1024 sc1
buffer_load_dwordx2 a[172:173], v93, s[4:7], s61 offen offset:512 sc1
buffer_load_dwordx4 a[128:131], v1, s[4:7], s23 offen offset:2048 sc1
buffer_load_dwordx2 a[174:175], v93, s[4:7], s61 offen offset:768 sc1
buffer_load_dwordx4 a[132:135], v1, s[4:7], s23 offen offset:3072 sc1
buffer_load_dwordx2 a[176:177], v93, s[4:7], s61 offen offset:1024 sc1
buffer_load_dwordx4 a[136:139], v2, s[4:7], s23 offen offset:0 sc1
buffer_load_dwordx2 a[178:179], v93, s[4:7], s61 offen offset:1280 sc1
buffer_load_dwordx4 a[140:143], v2, s[4:7], s23 offen offset:1024 sc1
s_waitcnt lgkmcnt(0)
s_waitcnt vmcnt(8)
v_mfma_f32_16x16x16_bf16 v[156:159], a[168:169], v[72:73], 0
v_mfma_f32_16x16x16_bf16 v[160:163], a[168:169], v[76:77], 0
v_mfma_f32_16x16x16_bf16 v[156:159], a[120:121], v[74:75], v[156:159]
v_mfma_f32_16x16x32_bf16 v[160:163], a[120:123], v[78:81], v[160:163]
v_mfma_f32_16x16x16_bf16 v[164:167], a[170:171], v[72:73], 0
v_mfma_f32_16x16x16_bf16 v[168:171], a[170:171], v[76:77], 0
v_mfma_f32_16x16x16_bf16 v[164:167], a[124:125], v[74:75], v[164:167]
v_mfma_f32_16x16x32_bf16 v[168:171], a[124:127], v[78:81], v[168:171]
s_nop 2
v_mul_f32 v156, v156, v82
v_mul_f32 v157, v157, v82
v_mul_f32 v158, v158, v82
v_mul_f32 v159, v159, v82
v_cvt_pk_bf16_f32 v172, v156, v157
v_cvt_pk_bf16_f32 v173, v158, v159
v_mul_f32 v164, v164, v82
v_mul_f32 v165, v165, v82
v_mul_f32 v166, v166, v82
v_mul_f32 v167, v167, v82
v_cvt_pk_bf16_f32 v174, v164, v165
v_cvt_pk_bf16_f32 v175, v166, v167
buffer_store_dwordx4 v[172:175], v1, s[4:7], s60 offen offset:0 sc1
v_mul_f32 v160, v160, v83
v_mul_f32 v161, v161, v83
v_mul_f32 v162, v162, v83
v_mul_f32 v163, v163, v83
v_cvt_pk_bf16_f32 v176, v160, v161
v_cvt_pk_bf16_f32 v177, v162, v163
v_mul_f32 v168, v168, v83
v_mul_f32 v169, v169, v83
v_mul_f32 v170, v170, v83
v_mul_f32 v171, v171, v83
v_cvt_pk_bf16_f32 v178, v168, v169
v_cvt_pk_bf16_f32 v179, v170, v171
s_add_u32 s34, s60, 196608
buffer_store_dwordx4 v[176:179], v1, s[4:7], s34 offen offset:0 sc1
s_waitcnt vmcnt(6)
v_mfma_f32_16x16x16_bf16 v[156:159], a[172:173], v[72:73], 0
v_mfma_f32_16x16x16_bf16 v[160:163], a[172:173], v[76:77], 0
v_mfma_f32_16x16x16_bf16 v[156:159], a[128:129], v[74:75], v[156:159]
v_mfma_f32_16x16x32_bf16 v[160:163], a[128:131], v[78:81], v[160:163]
v_mfma_f32_16x16x16_bf16 v[164:167], a[174:175], v[72:73], 0
v_mfma_f32_16x16x16_bf16 v[168:171], a[174:175], v[76:77], 0
v_mfma_f32_16x16x16_bf16 v[164:167], a[132:133], v[74:75], v[164:167]
v_mfma_f32_16x16x32_bf16 v[168:171], a[132:135], v[78:81], v[168:171]
s_nop 2
v_mul_f32 v156, v156, v82
v_mul_f32 v157, v157, v82
v_mul_f32 v158, v158, v82
v_mul_f32 v159, v159, v82
v_cvt_pk_bf16_f32 v172, v156, v157
v_cvt_pk_bf16_f32 v173, v158, v159
v_mul_f32 v164, v164, v82
v_mul_f32 v165, v165, v82
v_mul_f32 v166, v166, v82
v_mul_f32 v167, v167, v82
v_cvt_pk_bf16_f32 v174, v164, v165
v_cvt_pk_bf16_f32 v175, v166, v167
buffer_store_dwordx4 v[172:175], v1, s[4:7], s60 offen offset:1024 sc1
v_mul_f32 v160, v160, v83
v_mul_f32 v161, v161, v83
v_mul_f32 v162, v162, v83
v_mul_f32 v163, v163, v83
v_cvt_pk_bf16_f32 v176, v160, v161
v_cvt_pk_bf16_f32 v177, v162, v163
v_mul_f32 v168, v168, v83
v_mul_f32 v169, v169, v83
v_mul_f32 v170, v170, v83
v_mul_f32 v171, v171, v83
v_cvt_pk_bf16_f32 v178, v168, v169
v_cvt_pk_bf16_f32 v179, v170, v171
s_add_u32 s34, s60, 196608
buffer_store_dwordx4 v[176:179], v1, s[4:7], s34 offen offset:1024 sc1
s_waitcnt vmcnt(4)
v_mfma_f32_16x16x16_bf16 v[156:159], a[176:177], v[72:73], 0
v_mfma_f32_16x16x16_bf16 v[160:163], a[176:177], v[76:77], 0
v_mfma_f32_16x16x16_bf16 v[156:159], a[136:137], v[74:75], v[156:159]
v_mfma_f32_16x16x32_bf16 v[160:163], a[136:139], v[78:81], v[160:163]
v_mfma_f32_16x16x16_bf16 v[164:167], a[178:179], v[72:73], 0
v_mfma_f32_16x16x16_bf16 v[168:171], a[178:179], v[76:77], 0
v_mfma_f32_16x16x16_bf16 v[164:167], a[140:141], v[74:75], v[164:167]
v_mfma_f32_16x16x32_bf16 v[168:171], a[140:143], v[78:81], v[168:171]
s_nop 2
v_mul_f32 v156, v156, v82
v_mul_f32 v157, v157, v82
v_mul_f32 v158, v158, v82
v_mul_f32 v159, v159, v82
v_cvt_pk_bf16_f32 v172, v156, v157
v_cvt_pk_bf16_f32 v173, v158, v159
v_mul_f32 v164, v164, v82
v_mul_f32 v165, v165, v82
v_mul_f32 v166, v166, v82
v_mul_f32 v167, v167, v82
v_cvt_pk_bf16_f32 v174, v164, v165
v_cvt_pk_bf16_f32 v175, v166, v167
buffer_store_dwordx4 v[172:175], v1, s[4:7], s60 offen offset:2048 sc1
v_mul_f32 v160, v160, v83
v_mul_f32 v161, v161, v83
v_mul_f32 v162, v162, v83
v_mul_f32 v163, v163, v83
v_cvt_pk_bf16_f32 v176, v160, v161
v_cvt_pk_bf16_f32 v177, v162, v163
v_mul_f32 v168, v168, v83
v_mul_f32 v169, v169, v83
v_mul_f32 v170, v170, v83
v_mul_f32 v171, v171, v83
v_cvt_pk_bf16_f32 v178, v168, v169
v_cvt_pk_bf16_f32 v179, v170, v171
s_add_u32 s34, s60, 196608
buffer_store_dwordx4 v[176:179], v1, s[4:7], s34 offen offset:2048 sc1
s_branch reca_b5207
reca_tw2209:
s_cmp_lt_u32 s17, 3
s_cbranch_scc1 reca_b5207
s_sub_u32 s36, s17, 3
s_and_b32 s37, s36, 7
s_lshl_b32 s34, s59, 3
s_add_u32 s34, s34, s37
s_mul_i32 s34, s34, 12288
s_add_u32 s23, s34, 40894464
s_lshl_b32 s35, s37, 5
s_add_u32 s35, s35, s59
s_mul_i32 s35, s35, 3072
s_add_u32 s61, s35, 47972352
s_mul_i32 s34, s36, 393216
s_mul_i32 s35, s59, 6144
s_add_u32 s34, s34, s35
s_add_u32 s60, s34, 57147392
s_add_u32 s34, s17, 1
s_and_b32 s34, s34, 1
s_mul_i32 s34, s34, 3072
v_add_u32 v28, s34, v1
ds_read_b128 v[72:75], v28 offset:16384
ds_read_b128 v[76:79], v28 offset:17408
ds_read_b128 v[80:83], v28 offset:18432
buffer_load_dwordx2 a[180:181], v93, s[4:7], s61 offen offset:1536 sc1
buffer_load_dwordx4 a[144:147], v2, s[4:7], s23 offen offset:2048 sc1
buffer_load_dwordx2 a[182:183], v93, s[4:7], s61 offen offset:1792 sc1
buffer_load_dwordx4 a[148:151], v2, s[4:7], s23 offen offset:3072 sc1
buffer_load_dwordx2 a[184:185], v93, s[4:7], s61 offen offset:2048 sc1
buffer_load_dwordx4 a[152:155], v3, s[4:7], s23 offen offset:0 sc1
buffer_load_dwordx2 a[186:187], v93, s[4:7], s61 offen offset:2304 sc1
buffer_load_dwordx4 a[156:159], v3, s[4:7], s23 offen offset:1024 sc1
buffer_load_dwordx2 a[188:189], v93, s[4:7], s61 offen offset:2560 sc1
buffer_load_dwordx4 a[160:163], v3, s[4:7], s23 offen offset:2048 sc1
buffer_load_dwordx2 a[190:191], v93, s[4:7], s61 offen offset:2816 sc1
buffer_load_dwordx4 a[164:167], v3, s[4:7], s23 offen offset:3072 sc1
s_waitcnt lgkmcnt(0)
s_waitcnt vmcnt(8)
v_mfma_f32_16x16x16_bf16 v[156:159], a[180:181], v[72:73], 0
v_mfma_f32_16x16x16_bf16 v[160:163], a[180:181], v[76:77], 0
v_mfma_f32_16x16x16_bf16 v[156:159], a[144:145], v[74:75], v[156:159]
v_mfma_f32_16x16x32_bf16 v[160:163], a[144:147], v[78:81], v[160:163]
v_mfma_f32_16x16x16_bf16 v[164:167], a[182:183], v[72:73], 0
v_mfma_f32_16x16x16_bf16 v[168:171], a[182:183], v[76:77], 0
v_mfma_f32_16x16x16_bf16 v[164:167], a[148:149], v[74:75], v[164:167]
v_mfma_f32_16x16x32_bf16 v[168:171], a[148:151], v[78:81], v[168:171]
s_nop 2
v_mul_f32 v156, v156, v82
v_mul_f32 v157, v157, v82
v_mul_f32 v158, v158, v82
v_mul_f32 v159, v159, v82
v_cvt_pk_bf16_f32 v172, v156, v157
v_cvt_pk_bf16_f32 v173, v158, v159
v_mul_f32 v164, v164, v82
v_mul_f32 v165, v165, v82
v_mul_f32 v166, v166, v82
v_mul_f32 v167, v167, v82
v_cvt_pk_bf16_f32 v174, v164, v165
v_cvt_pk_bf16_f32 v175, v166, v167
buffer_store_dwordx4 v[172:175], v1, s[4:7], s60 offen offset:3072 sc1
v_mul_f32 v160, v160, v83
v_mul_f32 v161, v161, v83
v_mul_f32 v162, v162, v83
v_mul_f32 v163, v163, v83
v_cvt_pk_bf16_f32 v176, v160, v161
v_cvt_pk_bf16_f32 v177, v162, v163
v_mul_f32 v168, v168, v83
v_mul_f32 v169, v169, v83
v_mul_f32 v170, v170, v83
v_mul_f32 v171, v171, v83
v_cvt_pk_bf16_f32 v178, v168, v169
v_cvt_pk_bf16_f32 v179, v170, v171
s_add_u32 s34, s60, 196608
buffer_store_dwordx4 v[176:179], v1, s[4:7], s34 offen offset:3072 sc1
s_waitcnt vmcnt(6)
v_mfma_f32_16x16x16_bf16 v[156:159], a[184:185], v[72:73], 0
v_mfma_f32_16x16x16_bf16 v[160:163], a[184:185], v[76:77], 0
v_mfma_f32_16x16x16_bf16 v[156:159], a[152:153], v[74:75], v[156:159]
v_mfma_f32_16x16x32_bf16 v[160:163], a[152:155], v[78:81], v[160:163]
v_mfma_f32_16x16x16_bf16 v[164:167], a[186:187], v[72:73], 0
v_mfma_f32_16x16x16_bf16 v[168:171], a[186:187], v[76:77], 0
v_mfma_f32_16x16x16_bf16 v[164:167], a[156:157], v[74:75], v[164:167]
v_mfma_f32_16x16x32_bf16 v[168:171], a[156:159], v[78:81], v[168:171]
s_nop 2
v_mul_f32 v156, v156, v82
v_mul_f32 v157, v157, v82
v_mul_f32 v158, v158, v82
v_mul_f32 v159, v159, v82
v_cvt_pk_bf16_f32 v172, v156, v157
v_cvt_pk_bf16_f32 v173, v158, v159
v_mul_f32 v164, v164, v82
v_mul_f32 v165, v165, v82
v_mul_f32 v166, v166, v82
v_mul_f32 v167, v167, v82
v_cvt_pk_bf16_f32 v174, v164, v165
v_cvt_pk_bf16_f32 v175, v166, v167
buffer_store_dwordx4 v[172:175], v2, s[4:7], s60 offen offset:0 sc1
v_mul_f32 v160, v160, v83
v_mul_f32 v161, v161, v83
v_mul_f32 v162, v162, v83
v_mul_f32 v163, v163, v83
v_cvt_pk_bf16_f32 v176, v160, v161
v_cvt_pk_bf16_f32 v177, v162, v163
v_mul_f32 v168, v168, v83
v_mul_f32 v169, v169, v83
v_mul_f32 v170, v170, v83
v_mul_f32 v171, v171, v83
v_cvt_pk_bf16_f32 v178, v168, v169
v_cvt_pk_bf16_f32 v179, v170, v171
s_add_u32 s34, s60, 196608
buffer_store_dwordx4 v[176:179], v2, s[4:7], s34 offen offset:0 sc1
s_waitcnt vmcnt(4)
v_mfma_f32_16x16x16_bf16 v[156:159], a[188:189], v[72:73], 0
v_mfma_f32_16x16x16_bf16 v[160:163], a[188:189], v[76:77], 0
v_mfma_f32_16x16x16_bf16 v[156:159], a[160:161], v[74:75], v[156:159]
v_mfma_f32_16x16x32_bf16 v[160:163], a[160:163], v[78:81], v[160:163]
v_mfma_f32_16x16x16_bf16 v[164:167], a[190:191], v[72:73], 0
v_mfma_f32_16x16x16_bf16 v[168:171], a[190:191], v[76:77], 0
v_mfma_f32_16x16x16_bf16 v[164:167], a[164:165], v[74:75], v[164:167]
v_mfma_f32_16x16x32_bf16 v[168:171], a[164:167], v[78:81], v[168:171]
s_nop 2
v_mul_f32 v156, v156, v82
v_mul_f32 v157, v157, v82
v_mul_f32 v158, v158, v82
v_mul_f32 v159, v159, v82
v_cvt_pk_bf16_f32 v172, v156, v157
v_cvt_pk_bf16_f32 v173, v158, v159
v_mul_f32 v164, v164, v82
v_mul_f32 v165, v165, v82
v_mul_f32 v166, v166, v82
v_mul_f32 v167, v167, v82
v_cvt_pk_bf16_f32 v174, v164, v165
v_cvt_pk_bf16_f32 v175, v166, v167
buffer_store_dwordx4 v[172:175], v2, s[4:7], s60 offen offset:1024 sc1
v_mul_f32 v160, v160, v83
v_mul_f32 v161, v161, v83
v_mul_f32 v162, v162, v83
v_mul_f32 v163, v163, v83
v_cvt_pk_bf16_f32 v176, v160, v161
v_cvt_pk_bf16_f32 v177, v162, v163
v_mul_f32 v168, v168, v83
v_mul_f32 v169, v169, v83
v_mul_f32 v170, v170, v83
v_mul_f32 v171, v171, v83
v_cvt_pk_bf16_f32 v178, v168, v169
v_cvt_pk_bf16_f32 v179, v170, v171
s_add_u32 s34, s60, 196608
buffer_store_dwordx4 v[176:179], v2, s[4:7], s34 offen offset:1024 sc1
s_branch reca_b5207
s_cmp_lg_u32 s12, 2
s_cbranch_scc1 reca_b3205
buffer_store_dwordx2 v[52:53], v9, s[4:7], s30 offen sc1
buffer_store_dwordx2 v[32:33], v16, s[4:7], s26 offen sc1
s_cmp_lg_u32 s14, 0
s_cbranch_scc1 reca_b3205
v_mov_b32 v28, s17
s_lshl_b32 s34, s13, 7
s_add_u32 s34, s34, 1507328
buffer_store_dword v28, v19, s[4:7], s34 offen sc1
s_branch reca_b3205
reca_last204:
s_cmp_lg_u32 s12, 2
s_cbranch_scc1 reca_exit1
buffer_store_dwordx2 v[52:53], v9, s[4:7], s30 offen
s_branch reca_exit1
reca_swave202:
s_cmp_lg_u32 s17, 63
s_cbranch_scc1 reca_vmst210
s_barrier
ds_read_b128 v[56:59], v1 offset:10240
ds_read_b128 v[60:63], v1 offset:11264
ds_read_b128 v[64:67], v1 offset:12288
s_waitcnt lgkmcnt(0)
v_add_f32 v56, v56, v64
v_add_f32 v60, v60, v48
v_add_f32 v57, v57, v65
v_add_f32 v61, v61, v49
v_add_f32 v58, v58, v66
v_add_f32 v62, v62, v50
v_add_f32 v59, v59, v67
v_add_f32 v63, v63, v51
v_cvt_pk_bf16_f32 v68, v56, v57
v_cvt_pk_bf16_f32 v69, v58, v59
v_cvt_pk_bf16_f32 v70, v60, v61
v_cvt_pk_bf16_f32 v71, v62, v63
buffer_store_dwordx2 v[52:53], v9, s[4:7], s30 offen
buffer_store_dwordx2 v[68:69], v10, s[4:7], s31 offen
buffer_store_dwordx2 v[70:71], v10, s[4:7], s31 offen offset:256
s_branch reca_exit1
reca_vmst210:
s_sleep 1
buffer_load_dwordx4 v[208:211], v1, s[4:7], s21 offen offset:0 sc1
buffer_load_dwordx4 v[212:215], v1, s[4:7], s21 offen offset:1024 sc1
buffer_load_dwordx4 v[216:219], v1, s[4:7], s21 offen offset:2048 sc1
buffer_load_dwordx4 v[220:223], v1, s[4:7], s21 offen offset:3072 sc1
buffer_load_dwordx4 v[224:227], v2, s[4:7], s21 offen offset:0 sc1
buffer_load_dwordx4 v[228:231], v2, s[4:7], s21 offen offset:1024 sc1
s_waitcnt vmcnt(5)
v_max_u32 v29, v208, v210
v_cmp_eq_u32 vcc, -1, v29
s_cbranch_vccnz reca_retry211
reca_resume212:
s_waitcnt vmcnt(4)
v_max_u32 v29, v212, v214
v_cmp_eq_u32 vcc, -1, v29
v_mfma_f32_16x16x32_bf16 v[76:79], a[120:123], v[208:211], 0
v_mfma_f32_16x16x32_bf16 v[80:83], a[144:147], v[208:211], 0
v_mfma_f32_16x16x32_bf16 v[72:75], v[208:211], v[208:211], v[40:43]
s_cbranch_vccnz reca_retry213
reca_resume214:
s_waitcnt vmcnt(3)
v_max_u32 v29, v216, v218
v_cmp_eq_u32 vcc, -1, v29
v_mfma_f32_16x16x32_bf16 v[76:79], a[124:127], v[212:215], v[76:79]
v_mfma_f32_16x16x32_bf16 v[80:83], a[148:151], v[212:215], v[80:83]
v_mfma_f32_16x16x32_bf16 v[72:75], v[212:215], v[212:215], v[72:75]
s_cbranch_vccnz reca_retry215
reca_resume216:
s_waitcnt vmcnt(2)
v_max_u32 v29, v220, v222
v_cmp_eq_u32 vcc, -1, v29
v_mfma_f32_16x16x32_bf16 v[76:79], a[128:131], v[216:219], v[76:79]
v_mfma_f32_16x16x32_bf16 v[80:83], a[152:155], v[216:219], v[80:83]
v_mfma_f32_16x16x32_bf16 v[72:75], v[216:219], v[216:219], v[72:75]
s_cbranch_vccnz reca_retry217
reca_resume218:
s_waitcnt vmcnt(1)
v_max_u32 v29, v224, v226
v_cmp_eq_u32 vcc, -1, v29
v_mfma_f32_16x16x32_bf16 v[76:79], a[132:135], v[220:223], v[76:79]
v_mfma_f32_16x16x32_bf16 v[80:83], a[156:159], v[220:223], v[80:83]
v_mfma_f32_16x16x32_bf16 v[72:75], v[220:223], v[220:223], v[72:75]
s_cbranch_vccnz reca_retry219
reca_resume220:
s_waitcnt vmcnt(0)
v_max_u32 v29, v228, v230
v_cmp_eq_u32 vcc, -1, v29
v_mfma_f32_16x16x32_bf16 v[76:79], a[136:139], v[224:227], v[76:79]
v_mfma_f32_16x16x32_bf16 v[80:83], a[160:163], v[224:227], v[80:83]
v_mfma_f32_16x16x32_bf16 v[72:75], v[224:227], v[224:227], v[72:75]
s_cbranch_vccnz reca_retry221
reca_resume222:
v_mfma_f32_16x16x32_bf16 v[76:79], a[140:143], v[228:231], v[76:79]
v_mfma_f32_16x16x32_bf16 v[80:83], a[164:167], v[228:231], v[80:83]
v_mfma_f32_16x16x32_bf16 v[72:75], v[228:231], v[228:231], v[72:75]
s_barrier
ds_read_b128 v[56:59], v1 offset:10240
ds_read_b128 v[60:63], v1 offset:11264
ds_read_b128 v[64:67], v1 offset:12288
s_nop 1
v_max3_f32 v28, v76, v77, v78
v_max3_f32 v29, v80, v81, v82
v_max3_f32 v28, v28, v79, v83
v_max3_f32 v29, v29, v72, v73
v_max3_f32 v28, v28, v74, v75
v_max_f32 v28, v28, v29
v_mov_b32 v29, v28
s_nop 1
v_permlane32_swap_b32 v28, v29
v_max_f32 v28, v28, v29
v_mov_b32 v29, v28
s_nop 1
v_permlane16_swap_b32 v28, v29
v_max_f32 v28, v28, v29
v_mul_f32 v28, s41, v28
v_fma_f32 v76, v76, s41, -v28
v_fma_f32 v77, v77, s41, -v28
v_fma_f32 v78, v78, s41, -v28
v_fma_f32 v79, v79, s41, -v28
v_fma_f32 v80, v80, s41, -v28
v_fma_f32 v81, v81, s41, -v28
v_fma_f32 v82, v82, s41, -v28
v_fma_f32 v83, v83, s41, -v28
v_fma_f32 v72, v72, s41, -v28
v_fma_f32 v73, v73, s41, -v28
v_fma_f32 v74, v74, s41, -v28
v_fma_f32 v75, v75, s41, -v28
v_exp_f32 v76, v76
v_exp_f32 v77, v77
v_exp_f32 v78, v78
v_exp_f32 v79, v79
v_exp_f32 v80, v80
v_exp_f32 v81, v81
v_exp_f32 v82, v82
v_exp_f32 v83, v83
v_cvt_pk_bf16_f32 v84, v76, v77
v_cvt_pk_bf16_f32 v85, v78, v79
v_cvt_pk_bf16_f32 v86, v80, v81
v_cvt_pk_bf16_f32 v87, v82, v83
v_exp_f32 v72, v72
v_exp_f32 v73, v73
v_mfma_f32_16x16x32_bf16 v[100:103], v[36:39], v[84:87], 0
v_exp_f32 v74, v74
v_exp_f32 v75, v75
v_mfma_f32_16x16x32_bf16 v[92:95], a[168:171], v[84:87], 0
v_cvt_pk_bf16_f32 v88, v72, v73
v_cvt_pk_bf16_f32 v89, v74, v75
v_mfma_f32_16x16x32_bf16 v[96:99], a[172:175], v[84:87], 0
s_waitcnt lgkmcnt(0)
v_mfma_f32_16x16x16_bf16 v[100:103], v[36:37], v[88:89], v[100:103]
v_add_f32 v56, v56, v64
v_add_f32 v60, v60, v48
v_add_f32 v57, v57, v65
v_add_f32 v61, v61, v49
v_add_f32 v58, v58, v66
v_add_f32 v62, v62, v50
v_add_f32 v59, v59, v67
v_add_f32 v63, v63, v51
v_cvt_pk_bf16_f32 v68, v56, v57
v_cvt_pk_bf16_f32 v69, v58, v59
v_cvt_pk_bf16_f32 v70, v60, v61
v_cvt_pk_bf16_f32 v71, v62, v63
v_mfma_f32_16x16x16_bf16 v[92:95], v[68:69], v[88:89], v[92:95]
v_rcp_f32 v28, v100
v_mfma_f32_16x16x16_bf16 v[96:99], v[70:71], v[88:89], v[96:99]
v_mov_b32 v29, v28
s_nop 4
v_pk_mul_f32 v[92:93], v[92:93], v[28:29]
v_pk_mul_f32 v[94:95], v[94:95], v[28:29]
v_pk_mul_f32 v[96:97], v[96:97], v[28:29]
v_pk_mul_f32 v[98:99], v[98:99], v[28:29]
v_cvt_pk_bf16_f32 v104, v92, v93
v_cvt_pk_bf16_f32 v105, v94, v95
v_cvt_pk_bf16_f32 v106, v96, v97
v_cvt_pk_bf16_f32 v107, v98, v99
buffer_store_dwordx4 v[104:107], v11, s[4:7], s22 offen sc1
s_barrier
s_add_u32 s34, s17, 2
s_and_b32 s34, s34, 3
s_mul_i32 s26, s34, 10240
s_add_u32 s26, s26, s38
s_mul_i32 s27, s34, 6144
s_add_u32 s27, s27, s39
s_mul_i32 s28, s34, 12288
s_add_u32 s28, s28, s40
s_mul_i32 s29, s34, 393216
s_add_u32 s29, s29, s56
buffer_store_dwordx2 v[32:33], v8, s[4:7], s27 offen sc1
buffer_store_dwordx4 v[32:35], v11, s[4:7], s28 offen sc1
s_add_u32 s36, s17, 1
s_cmp_ge_u32 s36, 63
s_cbranch_scc1 reca_nopf223
s_add_u32 s37, s36, 1
reca_pf224:
buffer_load_dword v28, v233, s[4:7], 0 offen sc1
s_waitcnt vmcnt(0)
v_cmp_gt_i32 vcc, s37, v28
s_cbranch_vccz reca_pfok225
s_sleep 1
s_sub_u32 s18, s18, 1
s_cbranch_scc0 reca_pf224
s_mov_b32 s18, 0
reca_pfok225:
s_lshl_b32 s34, s15, 3
s_and_b32 s35, s36, 7
s_add_u32 s34, s34, s35
s_mul_i32 s34, s34, 12288
s_add_u32 s32, s34, 37748736
s_lshl_b32 s35, s16, 11
s_add_u32 s34, s34, s35
s_add_u32 s33, s34, 40894464
buffer_load_dwordx4 a[120:123], v1, s[4:7], s32 offen offset:0 sc1
buffer_load_dwordx4 a[124:127], v1, s[4:7], s32 offen offset:1024 sc1
buffer_load_dwordx4 a[128:131], v1, s[4:7], s32 offen offset:2048 sc1
buffer_load_dwordx4 a[132:135], v1, s[4:7], s32 offen offset:3072 sc1
buffer_load_dwordx4 a[136:139], v2, s[4:7], s32 offen offset:0 sc1
buffer_load_dwordx4 a[140:143], v2, s[4:7], s32 offen offset:1024 sc1
buffer_load_dwordx4 a[144:147], v2, s[4:7], s32 offen offset:2048 sc1
buffer_load_dwordx4 a[148:151], v2, s[4:7], s32 offen offset:3072 sc1
buffer_load_dwordx4 a[152:155], v3, s[4:7], s32 offen offset:0 sc1
buffer_load_dwordx4 a[156:159], v3, s[4:7], s32 offen offset:1024 sc1
buffer_load_dwordx4 a[160:163], v3, s[4:7], s32 offen offset:2048 sc1
buffer_load_dwordx4 a[164:167], v3, s[4:7], s32 offen offset:3072 sc1
buffer_load_dwordx4 a[168:171], v1, s[4:7], s33 offen offset:0 sc1
buffer_load_dwordx4 a[172:175], v1, s[4:7], s33 offen offset:1024 sc1
reca_nopf223:
buffer_store_dwordx2 v[52:53], v9, s[4:7], s30 offen sc1
buffer_store_dwordx2 v[68:69], v10, s[4:7], s31 offen sc1
buffer_store_dwordx2 v[70:71], v10, s[4:7], s31 offen offset:256 sc1
reca_b5207:
s_barrier
s_add_u32 s17, s17, 1
s_branch reca_step193
reca_b3205:
s_endpgm
reca_retry196:
s_sub_u32 s18, s18, 1
s_cbranch_scc1 reca_retry196_to
buffer_load_dwordx4 v[128:131], v4, s[4:7], s20 offen sc1
buffer_load_dwordx4 v[132:135], v4, s[4:7], s20 offen offset:1024 sc1
buffer_load_dwordx4 v[136:139], v5, s[4:7], s20 offen sc1
s_waitcnt vmcnt(2)
v_max_u32 v29, v128, v130
v_cmp_eq_u32 vcc, -1, v29
s_cbranch_vccnz reca_retry196
s_branch reca_resume197
reca_retry196_to:
s_mov_b32 s18, 0
s_waitcnt vmcnt(0)
s_branch reca_resume197
reca_retry198:
s_sub_u32 s18, s18, 1
s_cbranch_scc1 reca_retry198_to
buffer_load_dwordx4 v[132:135], v4, s[4:7], s20 offen offset:1024 sc1
buffer_load_dwordx4 v[136:139], v5, s[4:7], s20 offen sc1
s_waitcnt vmcnt(1)
v_max_u32 v29, v132, v134
v_cmp_eq_u32 vcc, -1, v29
s_cbranch_vccnz reca_retry198
s_branch reca_resume199
reca_retry198_to:
s_mov_b32 s18, 0
s_waitcnt vmcnt(0)
s_branch reca_resume199
reca_retry200:
s_sub_u32 s18, s18, 1
s_cbranch_scc1 reca_retry200_to
buffer_load_dwordx4 v[136:139], v5, s[4:7], s20 offen sc1
s_waitcnt vmcnt(0)
v_max_u32 v29, v136, v138
v_cmp_eq_u32 vcc, -1, v29
s_cbranch_vccnz reca_retry200
s_branch reca_resume201
reca_retry200_to:
s_mov_b32 s18, 0
s_waitcnt vmcnt(0)
s_branch reca_resume201
reca_retry211:
s_sub_u32 s18, s18, 1
s_cbranch_scc1 reca_retry211_to
buffer_load_dwordx4 v[208:211], v1, s[4:7], s21 offen offset:0 sc1
buffer_load_dwordx4 v[212:215], v1, s[4:7], s21 offen offset:1024 sc1
buffer_load_dwordx4 v[216:219], v1, s[4:7], s21 offen offset:2048 sc1
buffer_load_dwordx4 v[220:223], v1, s[4:7], s21 offen offset:3072 sc1
buffer_load_dwordx4 v[224:227], v2, s[4:7], s21 offen offset:0 sc1
buffer_load_dwordx4 v[228:231], v2, s[4:7], s21 offen offset:1024 sc1
s_waitcnt vmcnt(5)
v_max_u32 v29, v208, v210
v_cmp_eq_u32 vcc, -1, v29
s_cbranch_vccnz reca_retry211
s_branch reca_resume212
reca_retry211_to:
s_mov_b32 s18, 0
s_waitcnt vmcnt(0)
s_branch reca_resume212
reca_retry213:
s_sub_u32 s18, s18, 1
s_cbranch_scc1 reca_retry213_to
buffer_load_dwordx4 v[212:215], v1, s[4:7], s21 offen offset:1024 sc1
buffer_load_dwordx4 v[216:219], v1, s[4:7], s21 offen offset:2048 sc1
buffer_load_dwordx4 v[220:223], v1, s[4:7], s21 offen offset:3072 sc1
buffer_load_dwordx4 v[224:227], v2, s[4:7], s21 offen offset:0 sc1
buffer_load_dwordx4 v[228:231], v2, s[4:7], s21 offen offset:1024 sc1
s_waitcnt vmcnt(4)
v_max_u32 v29, v212, v214
v_cmp_eq_u32 vcc, -1, v29
s_cbranch_vccnz reca_retry213
s_branch reca_resume214
reca_retry213_to:
s_mov_b32 s18, 0
s_waitcnt vmcnt(0)
s_branch reca_resume214
reca_retry215:
s_sub_u32 s18, s18, 1
s_cbranch_scc1 reca_retry215_to
buffer_load_dwordx4 v[216:219], v1, s[4:7], s21 offen offset:2048 sc1
buffer_load_dwordx4 v[220:223], v1, s[4:7], s21 offen offset:3072 sc1
buffer_load_dwordx4 v[224:227], v2, s[4:7], s21 offen offset:0 sc1
buffer_load_dwordx4 v[228:231], v2, s[4:7], s21 offen offset:1024 sc1
s_waitcnt vmcnt(3)
v_max_u32 v29, v216, v218
v_cmp_eq_u32 vcc, -1, v29
s_cbranch_vccnz reca_retry215
s_branch reca_resume216
reca_retry215_to:
s_mov_b32 s18, 0
s_waitcnt vmcnt(0)
s_branch reca_resume216
reca_retry217:
s_sub_u32 s18, s18, 1
s_cbranch_scc1 reca_retry217_to
buffer_load_dwordx4 v[220:223], v1, s[4:7], s21 offen offset:3072 sc1
buffer_load_dwordx4 v[224:227], v2, s[4:7], s21 offen offset:0 sc1
buffer_load_dwordx4 v[228:231], v2, s[4:7], s21 offen offset:1024 sc1
s_waitcnt vmcnt(2)
v_max_u32 v29, v220, v222
v_cmp_eq_u32 vcc, -1, v29
s_cbranch_vccnz reca_retry217
s_branch reca_resume218
reca_retry217_to:
s_mov_b32 s18, 0
s_waitcnt vmcnt(0)
s_branch reca_resume218
reca_retry219:
s_sub_u32 s18, s18, 1
s_cbranch_scc1 reca_retry219_to
buffer_load_dwordx4 v[224:227], v2, s[4:7], s21 offen offset:0 sc1
buffer_load_dwordx4 v[228:231], v2, s[4:7], s21 offen offset:1024 sc1
s_waitcnt vmcnt(1)
v_max_u32 v29, v224, v226
v_cmp_eq_u32 vcc, -1, v29
s_cbranch_vccnz reca_retry219
s_branch reca_resume220
reca_retry219_to:
s_mov_b32 s18, 0
s_waitcnt vmcnt(0)
s_branch reca_resume220
reca_retry221:
s_sub_u32 s18, s18, 1
s_cbranch_scc1 reca_retry221_to
buffer_load_dwordx4 v[228:231], v2, s[4:7], s21 offen offset:1024 sc1
s_waitcnt vmcnt(0)
v_max_u32 v29, v228, v230
v_cmp_eq_u32 vcc, -1, v29
s_cbranch_vccnz reca_retry221
s_branch reca_resume222
reca_retry221_to:
s_mov_b32 s18, 0
s_waitcnt vmcnt(0)
s_branch reca_resume222
reca_proj2:
s_sub_u32 s34, s14, 24
s_lshr_b32 s35, s34, 1
s_and_b32 s16, s34, 1
s_lshl_b32 s15, s13, 2
s_add_u32 s15, s15, s35
s_lshl_b32 s24, s13, 3
s_add_u32 s24, s24, s34
s_lshl_b32 s24, s24, 7
s_add_u32 s24, s24, 1540096
s_lshl_b32 s25, s13, 7
s_add_u32 s25, s25, 1507328
v_and_b32 v28, 63, v0
v_lshlrev_b32 v1, 4, v28
v_mov_b32 v29, 0x80000000
v_cmp_eq_u32 vcc, 0, v28
v_mov_b32 v4, 0
s_nop 0
v_cndmask_b32 v4, v29, v4, vcc
v_cmp_gt_u32 vcc, 32, v28
s_nop 1
v_cndmask_b32 v5, v29, v1, vcc
s_cmp_eq_u32 s12, 0
s_cbranch_scc1 reca_pw0_226
s_cmp_eq_u32 s12, 1
s_cbranch_scc1 reca_pw1_227
s_cmp_eq_u32 s12, 2
s_cbranch_scc1 reca_pw2_228
s_branch reca_pw3_229
reca_pw0_226:
s_mov_b32 s17, 0
s_mov_b32 s26, 0
s_mul_i32 s20, s17, 40960
s_add_u32 s20, s20, 84934656
s_add_u32 m0, s26, 0
s_nop 0
buffer_load_dwordx4 v1, s[4:7], s20 offen offset:0 lds
buffer_load_dwordx4 v1, s[4:7], s20 offen offset:1024 lds
buffer_load_dwordx4 v1, s[4:7], s20 offen offset:2048 lds
buffer_load_dwordx4 v1, s[4:7], s20 offen offset:3072 lds
s_add_u32 s20, s20, 4096
s_add_u32 m0, s26, 4096
s_nop 0
buffer_load_dwordx4 v1, s[4:7], s20 offen offset:0 lds
buffer_load_dwordx4 v1, s[4:7], s20 offen offset:1024 lds
buffer_load_dwordx4 v1, s[4:7], s20 offen offset:2048 lds
buffer_load_dwordx4 v1, s[4:7], s20 offen offset:3072 lds
s_add_u32 s20, s20, 4096
s_add_u32 m0, s26, 8192
s_nop 0
buffer_load_dwordx4 v1, s[4:7], s20 offen offset:0 lds
buffer_load_dwordx4 v1, s[4:7], s20 offen offset:1024 lds
s_mul_i32 s34, s15, 12
s_mul_i32 s35, s16, 6
s_add_u32 s34, s34, s35
s_add_u32 s34, s34, 0
s_mul_i32 s34, s34, 20480
s_add_u32 s34, s34, 14155776
buffer_load_dwordx4 a[0:3], v1, s[4:7], s34 offen offset:0
buffer_load_dwordx4 a[4:7], v1, s[4:7], s34 offen offset:1024
buffer_load_dwordx4 a[8:11], v1, s[4:7], s34 offen offset:2048
buffer_load_dwordx4 a[12:15], v1, s[4:7], s34 offen offset:3072
s_add_u32 s34, s34, 4096
buffer_load_dwordx4 a[16:19], v1, s[4:7], s34 offen offset:0
buffer_load_dwordx4 a[20:23], v1, s[4:7], s34 offen offset:1024
buffer_load_dwordx4 a[24:27], v1, s[4:7], s34 offen offset:2048
buffer_load_dwordx4 a[28:31], v1, s[4:7], s34 offen offset:3072
s_add_u32 s34, s34, 4096
buffer_load_dwordx4 a[32:35], v1, s[4:7], s34 offen offset:0
buffer_load_dwordx4 a[36:39], v1, s[4:7], s34 offen offset:1024
buffer_load_dwordx4 a[40:43], v1, s[4:7], s34 offen offset:2048
buffer_load_dwordx4 a[44:47], v1, s[4:7], s34 offen offset:3072
s_add_u32 s34, s34, 4096
buffer_load_dwordx4 a[48:51], v1, s[4:7], s34 offen offset:0
buffer_load_dwordx4 a[52:55], v1, s[4:7], s34 offen offset:1024
buffer_load_dwordx4 a[56:59], v1, s[4:7], s34 offen offset:2048
buffer_load_dwordx4 a[60:63], v1, s[4:7], s34 offen offset:3072
s_add_u32 s34, s34, 4096
buffer_load_dwordx4 a[64:67], v1, s[4:7], s34 offen offset:0
buffer_load_dwordx4 a[68:71], v1, s[4:7], s34 offen offset:1024
buffer_load_dwordx4 a[72:75], v1, s[4:7], s34 offen offset:2048
buffer_load_dwordx4 a[76:79], v1, s[4:7], s34 offen offset:3072
s_mul_i32 s34, s15, 12
s_mul_i32 s35, s16, 6
s_add_u32 s34, s34, s35
s_add_u32 s34, s34, 1
s_mul_i32 s34, s34, 20480
s_add_u32 s34, s34, 14155776
buffer_load_dwordx4 a[80:83], v1, s[4:7], s34 offen offset:0
buffer_load_dwordx4 a[84:87], v1, s[4:7], s34 offen offset:1024
buffer_load_dwordx4 a[88:91], v1, s[4:7], s34 offen offset:2048
buffer_load_dwordx4 a[92:95], v1, s[4:7], s34 offen offset:3072
s_add_u32 s34, s34, 4096
buffer_load_dwordx4 a[96:99], v1, s[4:7], s34 offen offset:0
buffer_load_dwordx4 a[100:103], v1, s[4:7], s34 offen offset:1024
buffer_load_dwordx4 a[104:107], v1, s[4:7], s34 offen offset:2048
buffer_load_dwordx4 a[108:111], v1, s[4:7], s34 offen offset:3072
s_add_u32 s34, s34, 4096
buffer_load_dwordx4 a[112:115], v1, s[4:7], s34 offen offset:0
buffer_load_dwordx4 a[116:119], v1, s[4:7], s34 offen offset:1024
buffer_load_dwordx4 a[120:123], v1, s[4:7], s34 offen offset:2048
buffer_load_dwordx4 a[124:127], v1, s[4:7], s34 offen offset:3072
s_add_u32 s34, s34, 4096
buffer_load_dwordx4 a[128:131], v1, s[4:7], s34 offen offset:0
buffer_load_dwordx4 a[132:135], v1, s[4:7], s34 offen offset:1024
buffer_load_dwordx4 a[136:139], v1, s[4:7], s34 offen offset:2048
buffer_load_dwordx4 a[140:143], v1, s[4:7], s34 offen offset:3072
s_add_u32 s34, s34, 4096
buffer_load_dwordx4 a[144:147], v1, s[4:7], s34 offen offset:0
buffer_load_dwordx4 a[148:151], v1, s[4:7], s34 offen offset:1024
buffer_load_dwordx4 a[152:155], v1, s[4:7], s34 offen offset:2048
buffer_load_dwordx4 a[156:159], v1, s[4:7], s34 offen offset:3072
s_waitcnt vmcnt(20)
s_mul_i32 s34, s15, 12
s_mul_i32 s35, s16, 6
s_add_u32 s34, s34, s35
s_add_u32 s34, s34, 2
s_mul_i32 s34, s34, 20480
s_add_u32 s34, s34, 14155776
buffer_load_dwordx4 a[160:163], v1, s[4:7], s34 offen offset:0
buffer_load_dwordx4 a[164:167], v1, s[4:7], s34 offen offset:1024
buffer_load_dwordx4 a[168:171], v1, s[4:7], s34 offen offset:2048
buffer_load_dwordx4 a[172:175], v1, s[4:7], s34 offen offset:3072
s_add_u32 s34, s34, 4096
buffer_load_dwordx4 a[176:179], v1, s[4:7], s34 offen offset:0
buffer_load_dwordx4 a[180:183], v1, s[4:7], s34 offen offset:1024
buffer_load_dwordx4 a[184:187], v1, s[4:7], s34 offen offset:2048
buffer_load_dwordx4 a[188:191], v1, s[4:7], s34 offen offset:3072
s_add_u32 s34, s34, 4096
buffer_load_dwordx4 a[192:195], v1, s[4:7], s34 offen offset:0
buffer_load_dwordx4 a[196:199], v1, s[4:7], s34 offen offset:1024
buffer_load_dwordx4 a[200:203], v1, s[4:7], s34 offen offset:2048
buffer_load_dwordx4 a[204:207], v1, s[4:7], s34 offen offset:3072
s_add_u32 s34, s34, 4096
buffer_load_dwordx4 a[208:211], v1, s[4:7], s34 offen offset:0
buffer_load_dwordx4 a[212:215], v1, s[4:7], s34 offen offset:1024
buffer_load_dwordx4 a[216:219], v1, s[4:7], s34 offen offset:2048
buffer_load_dwordx4 a[220:223], v1, s[4:7], s34 offen offset:3072
s_add_u32 s34, s34, 4096
buffer_load_dwordx4 a[224:227], v1, s[4:7], s34 offen offset:0
buffer_load_dwordx4 a[228:231], v1, s[4:7], s34 offen offset:1024
buffer_load_dwordx4 a[232:235], v1, s[4:7], s34 offen offset:2048
buffer_load_dwordx4 a[236:239], v1, s[4:7], s34 offen offset:3072
s_waitcnt vmcnt(20)
s_mul_i32 s34, s15, 12
s_mul_i32 s35, s16, 6
s_add_u32 s34, s34, s35
s_add_u32 s34, s34, 3
s_mul_i32 s34, s34, 20480
s_add_u32 s34, s34, 14155776
buffer_load_dwordx4 v[96:99], v1, s[4:7], s34 offen offset:0
buffer_load_dwordx4 v[100:103], v1, s[4:7], s34 offen offset:1024
buffer_load_dwordx4 v[104:107], v1, s[4:7], s34 offen offset:2048
buffer_load_dwordx4 v[108:111], v1, s[4:7], s34 offen offset:3072
s_add_u32 s34, s34, 4096
buffer_load_dwordx4 v[112:115], v1, s[4:7], s34 offen offset:0
buffer_load_dwordx4 v[116:119], v1, s[4:7], s34 offen offset:1024
buffer_load_dwordx4 v[120:123], v1, s[4:7], s34 offen offset:2048
buffer_load_dwordx4 v[124:127], v1, s[4:7], s34 offen offset:3072
s_add_u32 s34, s34, 4096
buffer_load_dwordx4 v[128:131], v1, s[4:7], s34 offen offset:0
buffer_load_dwordx4 v[132:135], v1, s[4:7], s34 offen offset:1024
buffer_load_dwordx4 v[136:139], v1, s[4:7], s34 offen offset:2048
buffer_load_dwordx4 v[140:143], v1, s[4:7], s34 offen offset:3072
s_add_u32 s34, s34, 4096
buffer_load_dwordx4 v[144:147], v1, s[4:7], s34 offen offset:0
buffer_load_dwordx4 v[148:151], v1, s[4:7], s34 offen offset:1024
buffer_load_dwordx4 v[152:155], v1, s[4:7], s34 offen offset:2048
buffer_load_dwordx4 v[156:159], v1, s[4:7], s34 offen offset:3072
s_add_u32 s34, s34, 4096
buffer_load_dwordx4 v[160:163], v1, s[4:7], s34 offen offset:0
buffer_load_dwordx4 v[164:167], v1, s[4:7], s34 offen offset:1024
buffer_load_dwordx4 v[168:171], v1, s[4:7], s34 offen offset:2048
buffer_load_dwordx4 v[172:175], v1, s[4:7], s34 offen offset:3072
s_waitcnt vmcnt(20)
s_mul_i32 s34, s15, 12
s_mul_i32 s35, s16, 6
s_add_u32 s34, s34, s35
s_add_u32 s34, s34, 0
s_mul_i32 s34, s34, 20480
s_add_u32 s34, s34, 22020096
buffer_load_dwordx4 v[176:179], v1, s[4:7], s34 offen offset:0
buffer_load_dwordx4 v[180:183], v1, s[4:7], s34 offen offset:1024
buffer_load_dwordx4 v[184:187], v1, s[4:7], s34 offen offset:2048
buffer_load_dwordx4 v[188:191], v1, s[4:7], s34 offen offset:3072
s_add_u32 s34, s34, 4096
buffer_load_dwordx4 v[192:195], v1, s[4:7], s34 offen offset:0
buffer_load_dwordx4 v[196:199], v1, s[4:7], s34 offen offset:1024
buffer_load_dwordx4 v[200:203], v1, s[4:7], s34 offen offset:2048
buffer_load_dwordx4 v[204:207], v1, s[4:7], s34 offen offset:3072
s_add_u32 s34, s34, 4096
buffer_load_dwordx4 v[208:211], v1, s[4:7], s34 offen offset:0
buffer_load_dwordx4 v[212:215], v1, s[4:7], s34 offen offset:1024
buffer_load_dwordx4 v[216:219], v1, s[4:7], s34 offen offset:2048
buffer_load_dwordx4 v[220:223], v1, s[4:7], s34 offen offset:3072
s_add_u32 s34, s34, 4096
buffer_load_dwordx4 v[224:227], v1, s[4:7], s34 offen offset:0
buffer_load_dwordx4 v[228:231], v1, s[4:7], s34 offen offset:1024
buffer_load_dwordx4 v[232:235], v1, s[4:7], s34 offen offset:2048
buffer_load_dwordx4 v[236:239], v1, s[4:7], s34 offen offset:3072
s_add_u32 s34, s34, 4096
buffer_load_dwordx4 v[240:243], v1, s[4:7], s34 offen offset:0
buffer_load_dwordx4 v[244:247], v1, s[4:7], s34 offen offset:1024
buffer_load_dwordx4 v[248:251], v1, s[4:7], s34 offen offset:2048
buffer_load_dwordx4 v[252:255], v1, s[4:7], s34 offen offset:3072
s_waitcnt vmcnt(20)
v_and_b32 v30, 7, v0
v_lshlrev_b32 v30, 3, v30
reca_cens230:
buffer_load_dwordx2 v[28:29], v30, s[8:11], 0 offen sc1
s_waitcnt vmcnt(0)
v_sad_u8 v31, v28, 0, 0
v_sad_u8 v31, v29, 0, v31
v_cmp_gt_u32 vcc, 32, v31
s_cbranch_vccz reca_censok231
s_sleep 8
s_sub_u32 s18, s18, 1
s_cbranch_scc0 reca_cens230
s_mov_b32 s18, 0
reca_censok231:
v_and_b32 v28, 0x20202020, v28
v_and_b32 v29, 0x20202020, v29
v_cmp_ne_u32 s[34:35], 0, v28
v_cmp_ne_u32 s[36:37], 0, v29
s_nop 3
s_and_b32 s34, s34, 0xff
s_and_b32 s36, s36, 0xff
s_or_b32 s35, s34, s36
s_lshr_b32 s37, s35, s13
s_and_b32 s37, s37, 1
s_xor_b32 s43, s37, 1
s_cmp_eq_u32 s57, 0
s_cselect_b32 s58, s36, s34
v_mov_b32 v31, 0x80000000
s_cmp_lg_u32 s43, 0
s_cbranch_scc1 reca_pslow232
reca_ptop233:
s_cmp_lt_u32 s17, 3
s_cbranch_scc1 reca_pgo234
s_sub_u32 s36, s17, 3
reca_ppoll235:
buffer_load_dword v28, v4, s[4:7], s25 offen sc1
s_waitcnt vmcnt(0)
v_readfirstlane_b32 s34, v28
s_nop 3
s_cmp_ge_i32 s34, s36
s_cbranch_scc1 reca_pgo234
s_sleep 8
s_sub_u32 s18, s18, 1
s_cbranch_scc0 reca_ppoll235
s_mov_b32 s18, 0
reca_pgo234:
s_waitcnt vmcnt(0)
s_barrier
v_add_u32 v7, s26, v1
s_xor_b32 s26, s26, 40960
s_add_u32 s37, s17, 1
s_cmp_ge_u32 s37, 64
s_cbranch_scc1 reca_pnodma236
s_mul_i32 s20, s37, 40960
s_add_u32 s20, s20, 84934656
s_add_u32 m0, s26, 0
s_nop 0
buffer_load_dwordx4 v1, s[4:7], s20 offen offset:0 lds
buffer_load_dwordx4 v1, s[4:7], s20 offen offset:1024 lds
buffer_load_dwordx4 v1, s[4:7], s20 offen offset:2048 lds
buffer_load_dwordx4 v1, s[4:7], s20 offen offset:3072 lds
s_add_u32 s20, s20, 4096
s_add_u32 m0, s26, 4096
s_nop 0
buffer_load_dwordx4 v1, s[4:7], s20 offen offset:0 lds
buffer_load_dwordx4 v1, s[4:7], s20 offen offset:1024 lds
buffer_load_dwordx4 v1, s[4:7], s20 offen offset:2048 lds
buffer_load_dwordx4 v1, s[4:7], s20 offen offset:3072 lds
s_add_u32 s20, s20, 4096
s_add_u32 m0, s26, 8192
s_nop 0
buffer_load_dwordx4 v1, s[4:7], s20 offen offset:0 lds
buffer_load_dwordx4 v1, s[4:7], s20 offen offset:1024 lds
reca_pnodma236:
s_lshl_b32 s34, s15, 3
s_and_b32 s35, s17, 7
s_add_u32 s34, s34, s35
s_mul_i32 s34, s34, 12288
s_mul_i32 s35, s16, 3072
s_add_u32 s35, s35, s34
s_add_u32 s21, s35, 37748736
s_add_u32 s22, s35, 44040192
s_mul_i32 s35, s16, 6144
s_add_u32 s35, s35, s34
s_add_u32 s23, s35, 40894464
ds_read_b128 v[72:75], v7 offset:0
ds_read_b128 v[76:79], v7 offset:20480
ds_read_b128 v[80:83], v7 offset:1024
ds_read_b128 v[84:87], v7 offset:21504
ds_read_b128 v[88:91], v7 offset:2048
ds_read_b128 v[92:95], v7 offset:22528
s_waitcnt lgkmcnt(4)
v_mfma_f32_16x16x32_bf16 v[32:35], a[0:3], v[72:75], 0
v_mfma_f32_16x16x32_bf16 v[36:39], a[0:3], v[76:79], 0
v_mfma_f32_16x16x32_bf16 v[40:43], a[80:83], v[72:75], 0
v_mfma_f32_16x16x32_bf16 v[44:47], a[80:83], v[76:79], 0
v_mfma_f32_16x16x32_bf16 v[48:51], a[160:163], v[72:75], 0
v_mfma_f32_16x16x32_bf16 v[52:55], a[160:163], v[76:79], 0
v_mfma_f32_16x16x32_bf16 v[56:59], v[96:99], v[72:75], 0
v_mfma_f32_16x16x32_bf16 v[60:63], v[96:99], v[76:79], 0
v_mfma_f32_16x16x32_bf16 v[64:67], v[72:75], v[176:179], 0
v_mfma_f32_16x16x32_bf16 v[68:71], v[76:79], v[176:179], 0
ds_read_b128 v[72:75], v7 offset:3072
ds_read_b128 v[76:79], v7 offset:23552
s_waitcnt lgkmcnt(4)
v_mfma_f32_16x16x32_bf16 v[32:35], a[4:7], v[80:83], v[32:35]
v_mfma_f32_16x16x32_bf16 v[36:39], a[4:7], v[84:87], v[36:39]
v_mfma_f32_16x16x32_bf16 v[40:43], a[84:87], v[80:83], v[40:43]
v_mfma_f32_16x16x32_bf16 v[44:47], a[84:87], v[84:87], v[44:47]
v_mfma_f32_16x16x32_bf16 v[48:51], a[164:167], v[80:83], v[48:51]
v_mfma_f32_16x16x32_bf16 v[52:55], a[164:167], v[84:87], v[52:55]
v_mfma_f32_16x16x32_bf16 v[56:59], v[100:103], v[80:83], v[56:59]
v_mfma_f32_16x16x32_bf16 v[60:63], v[100:103], v[84:87], v[60:63]
v_mfma_f32_16x16x32_bf16 v[64:67], v[80:83], v[180:183], v[64:67]
v_mfma_f32_16x16x32_bf16 v[68:71], v[84:87], v[180:183], v[68:71]
ds_read_b128 v[80:83], v7 offset:4096
ds_read_b128 v[84:87], v7 offset:24576
s_waitcnt lgkmcnt(4)
v_mfma_f32_16x16x32_bf16 v[32:35], a[8:11], v[88:91], v[32:35]
v_mfma_f32_16x16x32_bf16 v[36:39], a[8:11], v[92:95], v[36:39]
v_mfma_f32_16x16x32_bf16 v[40:43], a[88:91], v[88:91], v[40:43]
v_mfma_f32_16x16x32_bf16 v[44:47], a[88:91], v[92:95], v[44:47]
v_mfma_f32_16x16x32_bf16 v[48:51], a[168:171], v[88:91], v[48:51]
v_mfma_f32_16x16x32_bf16 v[52:55], a[168:171], v[92:95], v[52:55]
v_mfma_f32_16x16x32_bf16 v[56:59], v[104:107], v[88:91], v[56:59]
v_mfma_f32_16x16x32_bf16 v[60:63], v[104:107], v[92:95], v[60:63]
v_mfma_f32_16x16x32_bf16 v[64:67], v[88:91], v[184:187], v[64:67]
v_mfma_f32_16x16x32_bf16 v[68:71], v[92:95], v[184:187], v[68:71]
ds_read_b128 v[88:91], v7 offset:5120
ds_read_b128 v[92:95], v7 offset:25600
s_waitcnt lgkmcnt(4)
v_mfma_f32_16x16x32_bf16 v[32:35], a[12:15], v[72:75], v[32:35]
v_mfma_f32_16x16x32_bf16 v[36:39], a[12:15], v[76:79], v[36:39]
v_mfma_f32_16x16x32_bf16 v[40:43], a[92:95], v[72:75], v[40:43]
v_mfma_f32_16x16x32_bf16 v[44:47], a[92:95], v[76:79], v[44:47]
v_mfma_f32_16x16x32_bf16 v[48:51], a[172:175], v[72:75], v[48:51]
v_mfma_f32_16x16x32_bf16 v[52:55], a[172:175], v[76:79], v[52:55]
v_mfma_f32_16x16x32_bf16 v[56:59], v[108:111], v[72:75], v[56:59]
v_mfma_f32_16x16x32_bf16 v[60:63], v[108:111], v[76:79], v[60:63]
v_mfma_f32_16x16x32_bf16 v[64:67], v[72:75], v[188:191], v[64:67]
v_mfma_f32_16x16x32_bf16 v[68:71], v[76:79], v[188:191], v[68:71]
ds_read_b128 v[72:75], v7 offset:6144
ds_read_b128 v[76:79], v7 offset:26624
s_waitcnt lgkmcnt(4)
v_mfma_f32_16x16x32_bf16 v[32:35], a[16:19], v[80:83], v[32:35]
v_mfma_f32_16x16x32_bf16 v[36:39], a[16:19], v[84:87], v[36:39]
v_mfma_f32_16x16x32_bf16 v[40:43], a[96:99], v[80:83], v[40:43]
v_mfma_f32_16x16x32_bf16 v[44:47], a[96:99], v[84:87], v[44:47]
v_mfma_f32_16x16x32_bf16 v[48:51], a[176:179], v[80:83], v[48:51]
v_mfma_f32_16x16x32_bf16 v[52:55], a[176:179], v[84:87], v[52:55]
v_mfma_f32_16x16x32_bf16 v[56:59], v[112:115], v[80:83], v[56:59]
v_mfma_f32_16x16x32_bf16 v[60:63], v[112:115], v[84:87], v[60:63]
v_mfma_f32_16x16x32_bf16 v[64:67], v[80:83], v[192:195], v[64:67]
v_mfma_f32_16x16x32_bf16 v[68:71], v[84:87], v[192:195], v[68:71]
ds_read_b128 v[80:83], v7 offset:7168
ds_read_b128 v[84:87], v7 offset:27648
s_waitcnt lgkmcnt(4)
v_mfma_f32_16x16x32_bf16 v[32:35], a[20:23], v[88:91], v[32:35]
v_mfma_f32_16x16x32_bf16 v[36:39], a[20:23], v[92:95], v[36:39]
v_mfma_f32_16x16x32_bf16 v[40:43], a[100:103], v[88:91], v[40:43]
v_mfma_f32_16x16x32_bf16 v[44:47], a[100:103], v[92:95], v[44:47]
v_mfma_f32_16x16x32_bf16 v[48:51], a[180:183], v[88:91], v[48:51]
v_mfma_f32_16x16x32_bf16 v[52:55], a[180:183], v[92:95], v[52:55]
v_mfma_f32_16x16x32_bf16 v[56:59], v[116:119], v[88:91], v[56:59]
v_mfma_f32_16x16x32_bf16 v[60:63], v[116:119], v[92:95], v[60:63]
v_mfma_f32_16x16x32_bf16 v[64:67], v[88:91], v[196:199], v[64:67]
v_mfma_f32_16x16x32_bf16 v[68:71], v[92:95], v[196:199], v[68:71]
ds_read_b128 v[88:91], v7 offset:8192
ds_read_b128 v[92:95], v7 offset:28672
s_waitcnt lgkmcnt(4)
v_mfma_f32_16x16x32_bf16 v[32:35], a[24:27], v[72:75], v[32:35]
v_mfma_f32_16x16x32_bf16 v[36:39], a[24:27], v[76:79], v[36:39]
v_mfma_f32_16x16x32_bf16 v[40:43], a[104:107], v[72:75], v[40:43]
v_mfma_f32_16x16x32_bf16 v[44:47], a[104:107], v[76:79], v[44:47]
v_mfma_f32_16x16x32_bf16 v[48:51], a[184:187], v[72:75], v[48:51]
v_mfma_f32_16x16x32_bf16 v[52:55], a[184:187], v[76:79], v[52:55]
v_mfma_f32_16x16x32_bf16 v[56:59], v[120:123], v[72:75], v[56:59]
v_mfma_f32_16x16x32_bf16 v[60:63], v[120:123], v[76:79], v[60:63]
v_mfma_f32_16x16x32_bf16 v[64:67], v[72:75], v[200:203], v[64:67]
v_mfma_f32_16x16x32_bf16 v[68:71], v[76:79], v[200:203], v[68:71]
ds_read_b128 v[72:75], v7 offset:9216
ds_read_b128 v[76:79], v7 offset:29696
s_waitcnt lgkmcnt(4)
v_mfma_f32_16x16x32_bf16 v[32:35], a[28:31], v[80:83], v[32:35]
v_mfma_f32_16x16x32_bf16 v[36:39], a[28:31], v[84:87], v[36:39]
v_mfma_f32_16x16x32_bf16 v[40:43], a[108:111], v[80:83], v[40:43]
v_mfma_f32_16x16x32_bf16 v[44:47], a[108:111], v[84:87], v[44:47]
v_mfma_f32_16x16x32_bf16 v[48:51], a[188:191], v[80:83], v[48:51]
v_mfma_f32_16x16x32_bf16 v[52:55], a[188:191], v[84:87], v[52:55]
v_mfma_f32_16x16x32_bf16 v[56:59], v[124:127], v[80:83], v[56:59]
v_mfma_f32_16x16x32_bf16 v[60:63], v[124:127], v[84:87], v[60:63]
v_mfma_f32_16x16x32_bf16 v[64:67], v[80:83], v[204:207], v[64:67]
v_mfma_f32_16x16x32_bf16 v[68:71], v[84:87], v[204:207], v[68:71]
ds_read_b128 v[80:83], v7 offset:10240
ds_read_b128 v[84:87], v7 offset:30720
s_waitcnt lgkmcnt(4)
v_mfma_f32_16x16x32_bf16 v[32:35], a[32:35], v[88:91], v[32:35]
v_mfma_f32_16x16x32_bf16 v[36:39], a[32:35], v[92:95], v[36:39]
v_mfma_f32_16x16x32_bf16 v[40:43], a[112:115], v[88:91], v[40:43]
v_mfma_f32_16x16x32_bf16 v[44:47], a[112:115], v[92:95], v[44:47]
v_mfma_f32_16x16x32_bf16 v[48:51], a[192:195], v[88:91], v[48:51]
v_mfma_f32_16x16x32_bf16 v[52:55], a[192:195], v[92:95], v[52:55]
v_mfma_f32_16x16x32_bf16 v[56:59], v[128:131], v[88:91], v[56:59]
v_mfma_f32_16x16x32_bf16 v[60:63], v[128:131], v[92:95], v[60:63]
v_mfma_f32_16x16x32_bf16 v[64:67], v[88:91], v[208:211], v[64:67]
v_mfma_f32_16x16x32_bf16 v[68:71], v[92:95], v[208:211], v[68:71]
ds_read_b128 v[88:91], v7 offset:11264
ds_read_b128 v[92:95], v7 offset:31744
s_waitcnt lgkmcnt(4)
v_mfma_f32_16x16x32_bf16 v[32:35], a[36:39], v[72:75], v[32:35]
v_mfma_f32_16x16x32_bf16 v[36:39], a[36:39], v[76:79], v[36:39]
v_mfma_f32_16x16x32_bf16 v[40:43], a[116:119], v[72:75], v[40:43]
v_mfma_f32_16x16x32_bf16 v[44:47], a[116:119], v[76:79], v[44:47]
v_mfma_f32_16x16x32_bf16 v[48:51], a[196:199], v[72:75], v[48:51]
v_mfma_f32_16x16x32_bf16 v[52:55], a[196:199], v[76:79], v[52:55]
v_mfma_f32_16x16x32_bf16 v[56:59], v[132:135], v[72:75], v[56:59]
v_mfma_f32_16x16x32_bf16 v[60:63], v[132:135], v[76:79], v[60:63]
v_mfma_f32_16x16x32_bf16 v[64:67], v[72:75], v[212:215], v[64:67]
v_mfma_f32_16x16x32_bf16 v[68:71], v[76:79], v[212:215], v[68:71]
ds_read_b128 v[72:75], v7 offset:12288
ds_read_b128 v[76:79], v7 offset:32768
s_waitcnt lgkmcnt(4)
v_mfma_f32_16x16x32_bf16 v[32:35], a[40:43], v[80:83], v[32:35]
v_mfma_f32_16x16x32_bf16 v[36:39], a[40:43], v[84:87], v[36:39]
v_mfma_f32_16x16x32_bf16 v[40:43], a[120:123], v[80:83], v[40:43]
v_mfma_f32_16x16x32_bf16 v[44:47], a[120:123], v[84:87], v[44:47]
v_mfma_f32_16x16x32_bf16 v[48:51], a[200:203], v[80:83], v[48:51]
v_mfma_f32_16x16x32_bf16 v[52:55], a[200:203], v[84:87], v[52:55]
v_mfma_f32_16x16x32_bf16 v[56:59], v[136:139], v[80:83], v[56:59]
v_mfma_f32_16x16x32_bf16 v[60:63], v[136:139], v[84:87], v[60:63]
v_mfma_f32_16x16x32_bf16 v[64:67], v[80:83], v[216:219], v[64:67]
v_mfma_f32_16x16x32_bf16 v[68:71], v[84:87], v[216:219], v[68:71]
ds_read_b128 v[80:83], v7 offset:13312
ds_read_b128 v[84:87], v7 offset:33792
s_waitcnt lgkmcnt(4)
v_mfma_f32_16x16x32_bf16 v[32:35], a[44:47], v[88:91], v[32:35]
v_mfma_f32_16x16x32_bf16 v[36:39], a[44:47], v[92:95], v[36:39]
v_mfma_f32_16x16x32_bf16 v[40:43], a[124:127], v[88:91], v[40:43]
v_mfma_f32_16x16x32_bf16 v[44:47], a[124:127], v[92:95], v[44:47]
v_mfma_f32_16x16x32_bf16 v[48:51], a[204:207], v[88:91], v[48:51]
v_mfma_f32_16x16x32_bf16 v[52:55], a[204:207], v[92:95], v[52:55]
v_mfma_f32_16x16x32_bf16 v[56:59], v[140:143], v[88:91], v[56:59]
v_mfma_f32_16x16x32_bf16 v[60:63], v[140:143], v[92:95], v[60:63]
v_mfma_f32_16x16x32_bf16 v[64:67], v[88:91], v[220:223], v[64:67]
v_mfma_f32_16x16x32_bf16 v[68:71], v[92:95], v[220:223], v[68:71]
ds_read_b128 v[88:91], v7 offset:14336
ds_read_b128 v[92:95], v7 offset:34816
s_waitcnt lgkmcnt(4)
v_mfma_f32_16x16x32_bf16 v[32:35], a[48:51], v[72:75], v[32:35]
v_mfma_f32_16x16x32_bf16 v[36:39], a[48:51], v[76:79], v[36:39]
v_mfma_f32_16x16x32_bf16 v[40:43], a[128:131], v[72:75], v[40:43]
v_mfma_f32_16x16x32_bf16 v[44:47], a[128:131], v[76:79], v[44:47]
v_mfma_f32_16x16x32_bf16 v[48:51], a[208:211], v[72:75], v[48:51]
v_mfma_f32_16x16x32_bf16 v[52:55], a[208:211], v[76:79], v[52:55]
v_mfma_f32_16x16x32_bf16 v[56:59], v[144:147], v[72:75], v[56:59]
v_mfma_f32_16x16x32_bf16 v[60:63], v[144:147], v[76:79], v[60:63]
v_mfma_f32_16x16x32_bf16 v[64:67], v[72:75], v[224:227], v[64:67]
v_mfma_f32_16x16x32_bf16 v[68:71], v[76:79], v[224:227], v[68:71]
ds_read_b128 v[72:75], v7 offset:15360
ds_read_b128 v[76:79], v7 offset:35840
s_waitcnt lgkmcnt(4)
v_mfma_f32_16x16x32_bf16 v[32:35], a[52:55], v[80:83], v[32:35]
v_mfma_f32_16x16x32_bf16 v[36:39], a[52:55], v[84:87], v[36:39]
v_mfma_f32_16x16x32_bf16 v[40:43], a[132:135], v[80:83], v[40:43]
v_mfma_f32_16x16x32_bf16 v[44:47], a[132:135], v[84:87], v[44:47]
v_mfma_f32_16x16x32_bf16 v[48:51], a[212:215], v[80:83], v[48:51]
v_mfma_f32_16x16x32_bf16 v[52:55], a[212:215], v[84:87], v[52:55]
v_mfma_f32_16x16x32_bf16 v[56:59], v[148:151], v[80:83], v[56:59]
v_mfma_f32_16x16x32_bf16 v[60:63], v[148:151], v[84:87], v[60:63]
v_mfma_f32_16x16x32_bf16 v[64:67], v[80:83], v[228:231], v[64:67]
v_mfma_f32_16x16x32_bf16 v[68:71], v[84:87], v[228:231], v[68:71]
ds_read_b128 v[80:83], v7 offset:16384
ds_read_b128 v[84:87], v7 offset:36864
s_waitcnt lgkmcnt(4)
v_mfma_f32_16x16x32_bf16 v[32:35], a[56:59], v[88:91], v[32:35]
v_mfma_f32_16x16x32_bf16 v[36:39], a[56:59], v[92:95], v[36:39]
v_mfma_f32_16x16x32_bf16 v[40:43], a[136:139], v[88:91], v[40:43]
v_mfma_f32_16x16x32_bf16 v[44:47], a[136:139], v[92:95], v[44:47]
v_mfma_f32_16x16x32_bf16 v[48:51], a[216:219], v[88:91], v[48:51]
v_mfma_f32_16x16x32_bf16 v[52:55], a[216:219], v[92:95], v[52:55]
v_mfma_f32_16x16x32_bf16 v[56:59], v[152:155], v[88:91], v[56:59]
v_mfma_f32_16x16x32_bf16 v[60:63], v[152:155], v[92:95], v[60:63]
v_mfma_f32_16x16x32_bf16 v[64:67], v[88:91], v[232:235], v[64:67]
v_mfma_f32_16x16x32_bf16 v[68:71], v[92:95], v[232:235], v[68:71]
ds_read_b128 v[88:91], v7 offset:17408
ds_read_b128 v[92:95], v7 offset:37888
s_waitcnt lgkmcnt(4)
v_mfma_f32_16x16x32_bf16 v[32:35], a[60:63], v[72:75], v[32:35]
v_mfma_f32_16x16x32_bf16 v[36:39], a[60:63], v[76:79], v[36:39]
v_mfma_f32_16x16x32_bf16 v[40:43], a[140:143], v[72:75], v[40:43]
v_mfma_f32_16x16x32_bf16 v[44:47], a[140:143], v[76:79], v[44:47]
v_mfma_f32_16x16x32_bf16 v[48:51], a[220:223], v[72:75], v[48:51]
v_mfma_f32_16x16x32_bf16 v[52:55], a[220:223], v[76:79], v[52:55]
v_mfma_f32_16x16x32_bf16 v[56:59], v[156:159], v[72:75], v[56:59]
v_mfma_f32_16x16x32_bf16 v[60:63], v[156:159], v[76:79], v[60:63]
v_mfma_f32_16x16x32_bf16 v[64:67], v[72:75], v[236:239], v[64:67]
v_mfma_f32_16x16x32_bf16 v[68:71], v[76:79], v[236:239], v[68:71]
ds_read_b128 v[72:75], v7 offset:18432
ds_read_b128 v[76:79], v7 offset:38912
s_waitcnt lgkmcnt(4)
v_mfma_f32_16x16x32_bf16 v[32:35], a[64:67], v[80:83], v[32:35]
v_mfma_f32_16x16x32_bf16 v[36:39], a[64:67], v[84:87], v[36:39]
v_mfma_f32_16x16x32_bf16 v[40:43], a[144:147], v[80:83], v[40:43]
v_mfma_f32_16x16x32_bf16 v[44:47], a[144:147], v[84:87], v[44:47]
v_mfma_f32_16x16x32_bf16 v[48:51], a[224:227], v[80:83], v[48:51]
v_mfma_f32_16x16x32_bf16 v[52:55], a[224:227], v[84:87], v[52:55]
v_mfma_f32_16x16x32_bf16 v[56:59], v[160:163], v[80:83], v[56:59]
v_mfma_f32_16x16x32_bf16 v[60:63], v[160:163], v[84:87], v[60:63]
v_mfma_f32_16x16x32_bf16 v[64:67], v[80:83], v[240:243], v[64:67]
v_mfma_f32_16x16x32_bf16 v[68:71], v[84:87], v[240:243], v[68:71]
ds_read_b128 v[80:83], v7 offset:19456
ds_read_b128 v[84:87], v7 offset:39936
s_waitcnt lgkmcnt(4)
v_mfma_f32_16x16x32_bf16 v[32:35], a[68:71], v[88:91], v[32:35]
v_mfma_f32_16x16x32_bf16 v[36:39], a[68:71], v[92:95], v[36:39]
v_mfma_f32_16x16x32_bf16 v[40:43], a[148:151], v[88:91], v[40:43]
v_mfma_f32_16x16x32_bf16 v[44:47], a[148:151], v[92:95], v[44:47]
v_mfma_f32_16x16x32_bf16 v[48:51], a[228:231], v[88:91], v[48:51]
v_mfma_f32_16x16x32_bf16 v[52:55], a[228:231], v[92:95], v[52:55]
v_mfma_f32_16x16x32_bf16 v[56:59], v[164:167], v[88:91], v[56:59]
v_mfma_f32_16x16x32_bf16 v[60:63], v[164:167], v[92:95], v[60:63]
v_mfma_f32_16x16x32_bf16 v[64:67], v[88:91], v[244:247], v[64:67]
v_mfma_f32_16x16x32_bf16 v[68:71], v[92:95], v[244:247], v[68:71]
s_waitcnt lgkmcnt(2)
v_mfma_f32_16x16x32_bf16 v[32:35], a[72:75], v[72:75], v[32:35]
v_mfma_f32_16x16x32_bf16 v[36:39], a[72:75], v[76:79], v[36:39]
v_mfma_f32_16x16x32_bf16 v[40:43], a[152:155], v[72:75], v[40:43]
v_mfma_f32_16x16x32_bf16 v[44:47], a[152:155], v[76:79], v[44:47]
v_mfma_f32_16x16x32_bf16 v[48:51], a[232:235], v[72:75], v[48:51]
v_mfma_f32_16x16x32_bf16 v[52:55], a[232:235], v[76:79], v[52:55]
v_mfma_f32_16x16x32_bf16 v[56:59], v[168:171], v[72:75], v[56:59]
v_mfma_f32_16x16x32_bf16 v[60:63], v[168:171], v[76:79], v[60:63]
v_mfma_f32_16x16x32_bf16 v[64:67], v[72:75], v[248:251], v[64:67]
v_mfma_f32_16x16x32_bf16 v[68:71], v[76:79], v[248:251], v[68:71]
s_waitcnt lgkmcnt(0)
v_mfma_f32_16x16x32_bf16 v[32:35], a[76:79], v[80:83], v[32:35]
v_mfma_f32_16x16x32_bf16 v[36:39], a[76:79], v[84:87], v[36:39]
v_mfma_f32_16x16x32_bf16 v[40:43], a[156:159], v[80:83], v[40:43]
v_mfma_f32_16x16x32_bf16 v[44:47], a[156:159], v[84:87], v[44:47]
v_mfma_f32_16x16x32_bf16 v[48:51], a[236:239], v[80:83], v[48:51]
v_mfma_f32_16x16x32_bf16 v[52:55], a[236:239], v[84:87], v[52:55]
v_mfma_f32_16x16x32_bf16 v[56:59], v[172:175], v[80:83], v[56:59]
v_mfma_f32_16x16x32_bf16 v[60:63], v[172:175], v[84:87], v[60:63]
v_mfma_f32_16x16x32_bf16 v[64:67], v[80:83], v[252:255], v[64:67]
v_mfma_f32_16x16x32_bf16 v[68:71], v[84:87], v[252:255], v[68:71]
v_cvt_pk_bf16_f32 v8, v32, v33
v_cvt_pk_bf16_f32 v9, v34, v35
v_cvt_pk_bf16_f32 v10, v40, v41
v_cvt_pk_bf16_f32 v11, v42, v43
s_add_u32 s34, s21, 0
buffer_store_dwordx4 v[8:11], v1, s[4:7], s34 offen
v_cvt_pk_bf16_f32 v12, v36, v37
v_cvt_pk_bf16_f32 v13, v38, v39
v_cvt_pk_bf16_f32 v14, v44, v45
v_cvt_pk_bf16_f32 v15, v46, v47
s_add_u32 s34, s21, 6144
buffer_store_dwordx4 v[12:15], v1, s[4:7], s34 offen
v_cvt_pk_bf16_f32 v8, v48, v49
v_cvt_pk_bf16_f32 v9, v50, v51
v_cvt_pk_bf16_f32 v10, v56, v57
v_cvt_pk_bf16_f32 v11, v58, v59
s_add_u32 s34, s21, 1024
buffer_store_dwordx4 v[8:11], v1, s[4:7], s34 offen
v_cvt_pk_bf16_f32 v12, v52, v53
v_cvt_pk_bf16_f32 v13, v54, v55
v_cvt_pk_bf16_f32 v14, v60, v61
v_cvt_pk_bf16_f32 v15, v62, v63
s_add_u32 s34, s21, 7168
buffer_store_dwordx4 v[12:15], v1, s[4:7], s34 offen
v_cvt_pk_bf16_f32 v8, v64, v65
v_cvt_pk_bf16_f32 v9, v66, v67
v_cvt_pk_bf16_f32 v10, v68, v69
v_cvt_pk_bf16_f32 v11, v70, v71
s_add_u32 s34, s23, 0
buffer_store_dwordx4 v[8:11], v1, s[4:7], s34 offen
s_waitcnt vmcnt(0)
s_barrier
s_add_u32 s17, s17, 1
v_mov_b32 v28, s17
buffer_store_dword v28, v4, s[4:7], s24 offen
s_cmp_lt_u32 s17, 64
s_cbranch_scc1 reca_ptop233
s_branch reca_exit1
reca_pslow232:
reca_ptop238:
s_cmp_lt_u32 s17, 3
s_cbranch_scc1 reca_pgo239
s_sub_u32 s36, s17, 3
reca_ppoll240:
buffer_load_dword v28, v4, s[4:7], s25 offen sc1
s_waitcnt vmcnt(0)
v_readfirstlane_b32 s34, v28
s_nop 3
s_cmp_ge_i32 s34, s36
s_cbranch_scc1 reca_pgo239
s_sleep 8
s_sub_u32 s18, s18, 1
s_cbranch_scc0 reca_ppoll240
s_mov_b32 s18, 0
reca_pgo239:
s_waitcnt vmcnt(0)
s_barrier
v_add_u32 v7, s26, v1
s_xor_b32 s26, s26, 40960
s_add_u32 s37, s17, 1
s_cmp_ge_u32 s37, 64
s_cbranch_scc1 reca_pnodma241
s_mul_i32 s20, s37, 40960
s_add_u32 s20, s20, 84934656
s_add_u32 m0, s26, 0
s_nop 0
buffer_load_dwordx4 v1, s[4:7], s20 offen offset:0 lds
buffer_load_dwordx4 v1, s[4:7], s20 offen offset:1024 lds
buffer_load_dwordx4 v1, s[4:7], s20 offen offset:2048 lds
buffer_load_dwordx4 v1, s[4:7], s20 offen offset:3072 lds
s_add_u32 s20, s20, 4096
s_add_u32 m0, s26, 4096
s_nop 0
buffer_load_dwordx4 v1, s[4:7], s20 offen offset:0 lds
buffer_load_dwordx4 v1, s[4:7], s20 offen offset:1024 lds
buffer_load_dwordx4 v1, s[4:7], s20 offen offset:2048 lds
buffer_load_dwordx4 v1, s[4:7], s20 offen offset:3072 lds
s_add_u32 s20, s20, 4096
s_add_u32 m0, s26, 8192
s_nop 0
buffer_load_dwordx4 v1, s[4:7], s20 offen offset:0 lds
buffer_load_dwordx4 v1, s[4:7], s20 offen offset:1024 lds
reca_pnodma241:
s_lshl_b32 s34, s15, 3
s_and_b32 s35, s17, 7
s_add_u32 s34, s34, s35
s_mul_i32 s34, s34, 12288
s_mul_i32 s35, s16, 3072
s_add_u32 s35, s35, s34
s_add_u32 s21, s35, 37748736
s_add_u32 s22, s35, 44040192
s_mul_i32 s35, s16, 6144
s_add_u32 s35, s35, s34
s_add_u32 s23, s35, 40894464
ds_read_b128 v[72:75], v7 offset:0
ds_read_b128 v[76:79], v7 offset:20480
ds_read_b128 v[80:83], v7 offset:1024
ds_read_b128 v[84:87], v7 offset:21504
ds_read_b128 v[88:91], v7 offset:2048
ds_read_b128 v[92:95], v7 offset:22528
s_waitcnt lgkmcnt(4)
v_mfma_f32_16x16x32_bf16 v[32:35], a[0:3], v[72:75], 0
v_mfma_f32_16x16x32_bf16 v[36:39], a[0:3], v[76:79], 0
v_mfma_f32_16x16x32_bf16 v[40:43], a[80:83], v[72:75], 0
v_mfma_f32_16x16x32_bf16 v[44:47], a[80:83], v[76:79], 0
v_mfma_f32_16x16x32_bf16 v[48:51], a[160:163], v[72:75], 0
v_mfma_f32_16x16x32_bf16 v[52:55], a[160:163], v[76:79], 0
v_mfma_f32_16x16x32_bf16 v[56:59], v[96:99], v[72:75], 0
v_mfma_f32_16x16x32_bf16 v[60:63], v[96:99], v[76:79], 0
v_mfma_f32_16x16x32_bf16 v[64:67], v[72:75], v[176:179], 0
v_mfma_f32_16x16x32_bf16 v[68:71], v[76:79], v[176:179], 0
ds_read_b128 v[72:75], v7 offset:3072
ds_read_b128 v[76:79], v7 offset:23552
s_waitcnt lgkmcnt(4)
v_mfma_f32_16x16x32_bf16 v[32:35], a[4:7], v[80:83], v[32:35]
v_mfma_f32_16x16x32_bf16 v[36:39], a[4:7], v[84:87], v[36:39]
v_mfma_f32_16x16x32_bf16 v[40:43], a[84:87], v[80:83], v[40:43]
v_mfma_f32_16x16x32_bf16 v[44:47], a[84:87], v[84:87], v[44:47]
v_mfma_f32_16x16x32_bf16 v[48:51], a[164:167], v[80:83], v[48:51]
v_mfma_f32_16x16x32_bf16 v[52:55], a[164:167], v[84:87], v[52:55]
v_mfma_f32_16x16x32_bf16 v[56:59], v[100:103], v[80:83], v[56:59]
v_mfma_f32_16x16x32_bf16 v[60:63], v[100:103], v[84:87], v[60:63]
v_mfma_f32_16x16x32_bf16 v[64:67], v[80:83], v[180:183], v[64:67]
v_mfma_f32_16x16x32_bf16 v[68:71], v[84:87], v[180:183], v[68:71]
ds_read_b128 v[80:83], v7 offset:4096
ds_read_b128 v[84:87], v7 offset:24576
s_waitcnt lgkmcnt(4)
v_mfma_f32_16x16x32_bf16 v[32:35], a[8:11], v[88:91], v[32:35]
v_mfma_f32_16x16x32_bf16 v[36:39], a[8:11], v[92:95], v[36:39]
v_mfma_f32_16x16x32_bf16 v[40:43], a[88:91], v[88:91], v[40:43]
v_mfma_f32_16x16x32_bf16 v[44:47], a[88:91], v[92:95], v[44:47]
v_mfma_f32_16x16x32_bf16 v[48:51], a[168:171], v[88:91], v[48:51]
v_mfma_f32_16x16x32_bf16 v[52:55], a[168:171], v[92:95], v[52:55]
v_mfma_f32_16x16x32_bf16 v[56:59], v[104:107], v[88:91], v[56:59]
v_mfma_f32_16x16x32_bf16 v[60:63], v[104:107], v[92:95], v[60:63]
v_mfma_f32_16x16x32_bf16 v[64:67], v[88:91], v[184:187], v[64:67]
v_mfma_f32_16x16x32_bf16 v[68:71], v[92:95], v[184:187], v[68:71]
ds_read_b128 v[88:91], v7 offset:5120
ds_read_b128 v[92:95], v7 offset:25600
s_waitcnt lgkmcnt(4)
v_mfma_f32_16x16x32_bf16 v[32:35], a[12:15], v[72:75], v[32:35]
v_mfma_f32_16x16x32_bf16 v[36:39], a[12:15], v[76:79], v[36:39]
v_mfma_f32_16x16x32_bf16 v[40:43], a[92:95], v[72:75], v[40:43]
v_mfma_f32_16x16x32_bf16 v[44:47], a[92:95], v[76:79], v[44:47]
v_mfma_f32_16x16x32_bf16 v[48:51], a[172:175], v[72:75], v[48:51]
v_mfma_f32_16x16x32_bf16 v[52:55], a[172:175], v[76:79], v[52:55]
v_mfma_f32_16x16x32_bf16 v[56:59], v[108:111], v[72:75], v[56:59]
v_mfma_f32_16x16x32_bf16 v[60:63], v[108:111], v[76:79], v[60:63]
v_mfma_f32_16x16x32_bf16 v[64:67], v[72:75], v[188:191], v[64:67]
v_mfma_f32_16x16x32_bf16 v[68:71], v[76:79], v[188:191], v[68:71]
ds_read_b128 v[72:75], v7 offset:6144
ds_read_b128 v[76:79], v7 offset:26624
s_waitcnt lgkmcnt(4)
v_mfma_f32_16x16x32_bf16 v[32:35], a[16:19], v[80:83], v[32:35]
v_mfma_f32_16x16x32_bf16 v[36:39], a[16:19], v[84:87], v[36:39]
v_mfma_f32_16x16x32_bf16 v[40:43], a[96:99], v[80:83], v[40:43]
v_mfma_f32_16x16x32_bf16 v[44:47], a[96:99], v[84:87], v[44:47]
v_mfma_f32_16x16x32_bf16 v[48:51], a[176:179], v[80:83], v[48:51]
v_mfma_f32_16x16x32_bf16 v[52:55], a[176:179], v[84:87], v[52:55]
v_mfma_f32_16x16x32_bf16 v[56:59], v[112:115], v[80:83], v[56:59]
v_mfma_f32_16x16x32_bf16 v[60:63], v[112:115], v[84:87], v[60:63]
v_mfma_f32_16x16x32_bf16 v[64:67], v[80:83], v[192:195], v[64:67]
v_mfma_f32_16x16x32_bf16 v[68:71], v[84:87], v[192:195], v[68:71]
ds_read_b128 v[80:83], v7 offset:7168
ds_read_b128 v[84:87], v7 offset:27648
s_waitcnt lgkmcnt(4)
v_mfma_f32_16x16x32_bf16 v[32:35], a[20:23], v[88:91], v[32:35]
v_mfma_f32_16x16x32_bf16 v[36:39], a[20:23], v[92:95], v[36:39]
v_mfma_f32_16x16x32_bf16 v[40:43], a[100:103], v[88:91], v[40:43]
v_mfma_f32_16x16x32_bf16 v[44:47], a[100:103], v[92:95], v[44:47]
v_mfma_f32_16x16x32_bf16 v[48:51], a[180:183], v[88:91], v[48:51]
v_mfma_f32_16x16x32_bf16 v[52:55], a[180:183], v[92:95], v[52:55]
v_mfma_f32_16x16x32_bf16 v[56:59], v[116:119], v[88:91], v[56:59]
v_mfma_f32_16x16x32_bf16 v[60:63], v[116:119], v[92:95], v[60:63]
v_mfma_f32_16x16x32_bf16 v[64:67], v[88:91], v[196:199], v[64:67]
v_mfma_f32_16x16x32_bf16 v[68:71], v[92:95], v[196:199], v[68:71]
ds_read_b128 v[88:91], v7 offset:8192
ds_read_b128 v[92:95], v7 offset:28672
s_waitcnt lgkmcnt(4)
v_mfma_f32_16x16x32_bf16 v[32:35], a[24:27], v[72:75], v[32:35]
v_mfma_f32_16x16x32_bf16 v[36:39], a[24:27], v[76:79], v[36:39]
v_mfma_f32_16x16x32_bf16 v[40:43], a[104:107], v[72:75], v[40:43]
v_mfma_f32_16x16x32_bf16 v[44:47], a[104:107], v[76:79], v[44:47]
v_mfma_f32_16x16x32_bf16 v[48:51], a[184:187], v[72:75], v[48:51]
v_mfma_f32_16x16x32_bf16 v[52:55], a[184:187], v[76:79], v[52:55]
v_mfma_f32_16x16x32_bf16 v[56:59], v[120:123], v[72:75], v[56:59]
v_mfma_f32_16x16x32_bf16 v[60:63], v[120:123], v[76:79], v[60:63]
v_mfma_f32_16x16x32_bf16 v[64:67], v[72:75], v[200:203], v[64:67]
v_mfma_f32_16x16x32_bf16 v[68:71], v[76:79], v[200:203], v[68:71]
ds_read_b128 v[72:75], v7 offset:9216
ds_read_b128 v[76:79], v7 offset:29696
s_waitcnt lgkmcnt(4)
v_mfma_f32_16x16x32_bf16 v[32:35], a[28:31], v[80:83], v[32:35]
v_mfma_f32_16x16x32_bf16 v[36:39], a[28:31], v[84:87], v[36:39]
v_mfma_f32_16x16x32_bf16 v[40:43], a[108:111], v[80:83], v[40:43]
v_mfma_f32_16x16x32_bf16 v[44:47], a[108:111], v[84:87], v[44:47]
v_mfma_f32_16x16x32_bf16 v[48:51], a[188:191], v[80:83], v[48:51]
v_mfma_f32_16x16x32_bf16 v[52:55], a[188:191], v[84:87], v[52:55]
v_mfma_f32_16x16x32_bf16 v[56:59], v[124:127], v[80:83], v[56:59]
v_mfma_f32_16x16x32_bf16 v[60:63], v[124:127], v[84:87], v[60:63]
v_mfma_f32_16x16x32_bf16 v[64:67], v[80:83], v[204:207], v[64:67]
v_mfma_f32_16x16x32_bf16 v[68:71], v[84:87], v[204:207], v[68:71]
ds_read_b128 v[80:83], v7 offset:10240
ds_read_b128 v[84:87], v7 offset:30720
s_waitcnt lgkmcnt(4)
v_mfma_f32_16x16x32_bf16 v[32:35], a[32:35], v[88:91], v[32:35]
v_mfma_f32_16x16x32_bf16 v[36:39], a[32:35], v[92:95], v[36:39]
v_mfma_f32_16x16x32_bf16 v[40:43], a[112:115], v[88:91], v[40:43]
v_mfma_f32_16x16x32_bf16 v[44:47], a[112:115], v[92:95], v[44:47]
v_mfma_f32_16x16x32_bf16 v[48:51], a[192:195], v[88:91], v[48:51]
v_mfma_f32_16x16x32_bf16 v[52:55], a[192:195], v[92:95], v[52:55]
v_mfma_f32_16x16x32_bf16 v[56:59], v[128:131], v[88:91], v[56:59]
v_mfma_f32_16x16x32_bf16 v[60:63], v[128:131], v[92:95], v[60:63]
v_mfma_f32_16x16x32_bf16 v[64:67], v[88:91], v[208:211], v[64:67]
v_mfma_f32_16x16x32_bf16 v[68:71], v[92:95], v[208:211], v[68:71]
ds_read_b128 v[88:91], v7 offset:11264
ds_read_b128 v[92:95], v7 offset:31744
s_waitcnt lgkmcnt(4)
v_mfma_f32_16x16x32_bf16 v[32:35], a[36:39], v[72:75], v[32:35]
v_mfma_f32_16x16x32_bf16 v[36:39], a[36:39], v[76:79], v[36:39]
v_mfma_f32_16x16x32_bf16 v[40:43], a[116:119], v[72:75], v[40:43]
v_mfma_f32_16x16x32_bf16 v[44:47], a[116:119], v[76:79], v[44:47]
v_mfma_f32_16x16x32_bf16 v[48:51], a[196:199], v[72:75], v[48:51]
v_mfma_f32_16x16x32_bf16 v[52:55], a[196:199], v[76:79], v[52:55]
v_mfma_f32_16x16x32_bf16 v[56:59], v[132:135], v[72:75], v[56:59]
v_mfma_f32_16x16x32_bf16 v[60:63], v[132:135], v[76:79], v[60:63]
v_mfma_f32_16x16x32_bf16 v[64:67], v[72:75], v[212:215], v[64:67]
v_mfma_f32_16x16x32_bf16 v[68:71], v[76:79], v[212:215], v[68:71]
ds_read_b128 v[72:75], v7 offset:12288
ds_read_b128 v[76:79], v7 offset:32768
s_waitcnt lgkmcnt(4)
v_mfma_f32_16x16x32_bf16 v[32:35], a[40:43], v[80:83], v[32:35]
v_mfma_f32_16x16x32_bf16 v[36:39], a[40:43], v[84:87], v[36:39]
v_mfma_f32_16x16x32_bf16 v[40:43], a[120:123], v[80:83], v[40:43]
v_mfma_f32_16x16x32_bf16 v[44:47], a[120:123], v[84:87], v[44:47]
v_mfma_f32_16x16x32_bf16 v[48:51], a[200:203], v[80:83], v[48:51]
v_mfma_f32_16x16x32_bf16 v[52:55], a[200:203], v[84:87], v[52:55]
v_mfma_f32_16x16x32_bf16 v[56:59], v[136:139], v[80:83], v[56:59]
v_mfma_f32_16x16x32_bf16 v[60:63], v[136:139], v[84:87], v[60:63]
v_mfma_f32_16x16x32_bf16 v[64:67], v[80:83], v[216:219], v[64:67]
v_mfma_f32_16x16x32_bf16 v[68:71], v[84:87], v[216:219], v[68:71]
ds_read_b128 v[80:83], v7 offset:13312
ds_read_b128 v[84:87], v7 offset:33792
s_waitcnt lgkmcnt(4)
v_mfma_f32_16x16x32_bf16 v[32:35], a[44:47], v[88:91], v[32:35]
v_mfma_f32_16x16x32_bf16 v[36:39], a[44:47], v[92:95], v[36:39]
v_mfma_f32_16x16x32_bf16 v[40:43], a[124:127], v[88:91], v[40:43]
v_mfma_f32_16x16x32_bf16 v[44:47], a[124:127], v[92:95], v[44:47]
v_mfma_f32_16x16x32_bf16 v[48:51], a[204:207], v[88:91], v[48:51]
v_mfma_f32_16x16x32_bf16 v[52:55], a[204:207], v[92:95], v[52:55]
v_mfma_f32_16x16x32_bf16 v[56:59], v[140:143], v[88:91], v[56:59]
v_mfma_f32_16x16x32_bf16 v[60:63], v[140:143], v[92:95], v[60:63]
v_mfma_f32_16x16x32_bf16 v[64:67], v[88:91], v[220:223], v[64:67]
v_mfma_f32_16x16x32_bf16 v[68:71], v[92:95], v[220:223], v[68:71]
ds_read_b128 v[88:91], v7 offset:14336
ds_read_b128 v[92:95], v7 offset:34816
s_waitcnt lgkmcnt(4)
v_mfma_f32_16x16x32_bf16 v[32:35], a[48:51], v[72:75], v[32:35]
v_mfma_f32_16x16x32_bf16 v[36:39], a[48:51], v[76:79], v[36:39]
v_mfma_f32_16x16x32_bf16 v[40:43], a[128:131], v[72:75], v[40:43]
v_mfma_f32_16x16x32_bf16 v[44:47], a[128:131], v[76:79], v[44:47]
v_mfma_f32_16x16x32_bf16 v[48:51], a[208:211], v[72:75], v[48:51]
v_mfma_f32_16x16x32_bf16 v[52:55], a[208:211], v[76:79], v[52:55]
v_mfma_f32_16x16x32_bf16 v[56:59], v[144:147], v[72:75], v[56:59]
v_mfma_f32_16x16x32_bf16 v[60:63], v[144:147], v[76:79], v[60:63]
v_mfma_f32_16x16x32_bf16 v[64:67], v[72:75], v[224:227], v[64:67]
v_mfma_f32_16x16x32_bf16 v[68:71], v[76:79], v[224:227], v[68:71]
ds_read_b128 v[72:75], v7 offset:15360
ds_read_b128 v[76:79], v7 offset:35840
s_waitcnt lgkmcnt(4)
v_mfma_f32_16x16x32_bf16 v[32:35], a[52:55], v[80:83], v[32:35]
v_mfma_f32_16x16x32_bf16 v[36:39], a[52:55], v[84:87], v[36:39]
v_mfma_f32_16x16x32_bf16 v[40:43], a[132:135], v[80:83], v[40:43]
v_mfma_f32_16x16x32_bf16 v[44:47], a[132:135], v[84:87], v[44:47]
v_mfma_f32_16x16x32_bf16 v[48:51], a[212:215], v[80:83], v[48:51]
v_mfma_f32_16x16x32_bf16 v[52:55], a[212:215], v[84:87], v[52:55]
v_mfma_f32_16x16x32_bf16 v[56:59], v[148:151], v[80:83], v[56:59]
v_mfma_f32_16x16x32_bf16 v[60:63], v[148:151], v[84:87], v[60:63]
v_mfma_f32_16x16x32_bf16 v[64:67], v[80:83], v[228:231], v[64:67]
v_mfma_f32_16x16x32_bf16 v[68:71], v[84:87], v[228:231], v[68:71]
ds_read_b128 v[80:83], v7 offset:16384
ds_read_b128 v[84:87], v7 offset:36864
s_waitcnt lgkmcnt(4)
v_mfma_f32_16x16x32_bf16 v[32:35], a[56:59], v[88:91], v[32:35]
v_mfma_f32_16x16x32_bf16 v[36:39], a[56:59], v[92:95], v[36:39]
v_mfma_f32_16x16x32_bf16 v[40:43], a[136:139], v[88:91], v[40:43]
v_mfma_f32_16x16x32_bf16 v[44:47], a[136:139], v[92:95], v[44:47]
v_mfma_f32_16x16x32_bf16 v[48:51], a[216:219], v[88:91], v[48:51]
v_mfma_f32_16x16x32_bf16 v[52:55], a[216:219], v[92:95], v[52:55]
v_mfma_f32_16x16x32_bf16 v[56:59], v[152:155], v[88:91], v[56:59]
v_mfma_f32_16x16x32_bf16 v[60:63], v[152:155], v[92:95], v[60:63]
v_mfma_f32_16x16x32_bf16 v[64:67], v[88:91], v[232:235], v[64:67]
v_mfma_f32_16x16x32_bf16 v[68:71], v[92:95], v[232:235], v[68:71]
ds_read_b128 v[88:91], v7 offset:17408
ds_read_b128 v[92:95], v7 offset:37888
s_waitcnt lgkmcnt(4)
v_mfma_f32_16x16x32_bf16 v[32:35], a[60:63], v[72:75], v[32:35]
v_mfma_f32_16x16x32_bf16 v[36:39], a[60:63], v[76:79], v[36:39]
v_mfma_f32_16x16x32_bf16 v[40:43], a[140:143], v[72:75], v[40:43]
v_mfma_f32_16x16x32_bf16 v[44:47], a[140:143], v[76:79], v[44:47]
v_mfma_f32_16x16x32_bf16 v[48:51], a[220:223], v[72:75], v[48:51]
v_mfma_f32_16x16x32_bf16 v[52:55], a[220:223], v[76:79], v[52:55]
v_mfma_f32_16x16x32_bf16 v[56:59], v[156:159], v[72:75], v[56:59]
v_mfma_f32_16x16x32_bf16 v[60:63], v[156:159], v[76:79], v[60:63]
v_mfma_f32_16x16x32_bf16 v[64:67], v[72:75], v[236:239], v[64:67]
v_mfma_f32_16x16x32_bf16 v[68:71], v[76:79], v[236:239], v[68:71]
ds_read_b128 v[72:75], v7 offset:18432
ds_read_b128 v[76:79], v7 offset:38912
s_waitcnt lgkmcnt(4)
v_mfma_f32_16x16x32_bf16 v[32:35], a[64:67], v[80:83], v[32:35]
v_mfma_f32_16x16x32_bf16 v[36:39], a[64:67], v[84:87], v[36:39]
v_mfma_f32_16x16x32_bf16 v[40:43], a[144:147], v[80:83], v[40:43]
v_mfma_f32_16x16x32_bf16 v[44:47], a[144:147], v[84:87], v[44:47]
v_mfma_f32_16x16x32_bf16 v[48:51], a[224:227], v[80:83], v[48:51]
v_mfma_f32_16x16x32_bf16 v[52:55], a[224:227], v[84:87], v[52:55]
v_mfma_f32_16x16x32_bf16 v[56:59], v[160:163], v[80:83], v[56:59]
v_mfma_f32_16x16x32_bf16 v[60:63], v[160:163], v[84:87], v[60:63]
v_mfma_f32_16x16x32_bf16 v[64:67], v[80:83], v[240:243], v[64:67]
v_mfma_f32_16x16x32_bf16 v[68:71], v[84:87], v[240:243], v[68:71]
ds_read_b128 v[80:83], v7 offset:19456
ds_read_b128 v[84:87], v7 offset:39936
s_waitcnt lgkmcnt(4)
v_mfma_f32_16x16x32_bf16 v[32:35], a[68:71], v[88:91], v[32:35]
v_mfma_f32_16x16x32_bf16 v[36:39], a[68:71], v[92:95], v[36:39]
v_mfma_f32_16x16x32_bf16 v[40:43], a[148:151], v[88:91], v[40:43]
v_mfma_f32_16x16x32_bf16 v[44:47], a[148:151], v[92:95], v[44:47]
v_mfma_f32_16x16x32_bf16 v[48:51], a[228:231], v[88:91], v[48:51]
v_mfma_f32_16x16x32_bf16 v[52:55], a[228:231], v[92:95], v[52:55]
v_mfma_f32_16x16x32_bf16 v[56:59], v[164:167], v[88:91], v[56:59]
v_mfma_f32_16x16x32_bf16 v[60:63], v[164:167], v[92:95], v[60:63]
v_mfma_f32_16x16x32_bf16 v[64:67], v[88:91], v[244:247], v[64:67]
v_mfma_f32_16x16x32_bf16 v[68:71], v[92:95], v[244:247], v[68:71]
s_waitcnt lgkmcnt(2)
v_mfma_f32_16x16x32_bf16 v[32:35], a[72:75], v[72:75], v[32:35]
v_mfma_f32_16x16x32_bf16 v[36:39], a[72:75], v[76:79], v[36:39]
v_mfma_f32_16x16x32_bf16 v[40:43], a[152:155], v[72:75], v[40:43]
v_mfma_f32_16x16x32_bf16 v[44:47], a[152:155], v[76:79], v[44:47]
v_mfma_f32_16x16x32_bf16 v[48:51], a[232:235], v[72:75], v[48:51]
v_mfma_f32_16x16x32_bf16 v[52:55], a[232:235], v[76:79], v[52:55]
v_mfma_f32_16x16x32_bf16 v[56:59], v[168:171], v[72:75], v[56:59]
v_mfma_f32_16x16x32_bf16 v[60:63], v[168:171], v[76:79], v[60:63]
v_mfma_f32_16x16x32_bf16 v[64:67], v[72:75], v[248:251], v[64:67]
v_mfma_f32_16x16x32_bf16 v[68:71], v[76:79], v[248:251], v[68:71]
s_waitcnt lgkmcnt(0)
v_mfma_f32_16x16x32_bf16 v[32:35], a[76:79], v[80:83], v[32:35]
v_mfma_f32_16x16x32_bf16 v[36:39], a[76:79], v[84:87], v[36:39]
v_mfma_f32_16x16x32_bf16 v[40:43], a[156:159], v[80:83], v[40:43]
v_mfma_f32_16x16x32_bf16 v[44:47], a[156:159], v[84:87], v[44:47]
v_mfma_f32_16x16x32_bf16 v[48:51], a[236:239], v[80:83], v[48:51]
v_mfma_f32_16x16x32_bf16 v[52:55], a[236:239], v[84:87], v[52:55]
v_mfma_f32_16x16x32_bf16 v[56:59], v[172:175], v[80:83], v[56:59]
v_mfma_f32_16x16x32_bf16 v[60:63], v[172:175], v[84:87], v[60:63]
v_mfma_f32_16x16x32_bf16 v[64:67], v[80:83], v[252:255], v[64:67]
v_mfma_f32_16x16x32_bf16 v[68:71], v[84:87], v[252:255], v[68:71]
v_cvt_pk_bf16_f32 v8, v32, v33
v_cvt_pk_bf16_f32 v9, v34, v35
v_cvt_pk_bf16_f32 v10, v40, v41
v_cvt_pk_bf16_f32 v11, v42, v43
s_add_u32 s34, s21, 0
buffer_store_dwordx4 v[8:11], v1, s[4:7], s34 offen sc1
v_cvt_pk_bf16_f32 v12, v36, v37
v_cvt_pk_bf16_f32 v13, v38, v39
v_cvt_pk_bf16_f32 v14, v44, v45
v_cvt_pk_bf16_f32 v15, v46, v47
s_add_u32 s34, s21, 6144
buffer_store_dwordx4 v[12:15], v1, s[4:7], s34 offen sc1
v_cvt_pk_bf16_f32 v8, v48, v49
v_cvt_pk_bf16_f32 v9, v50, v51
v_cvt_pk_bf16_f32 v10, v56, v57
v_cvt_pk_bf16_f32 v11, v58, v59
s_add_u32 s34, s21, 1024
buffer_store_dwordx4 v[8:11], v1, s[4:7], s34 offen sc1
v_cvt_pk_bf16_f32 v12, v52, v53
v_cvt_pk_bf16_f32 v13, v54, v55
v_cvt_pk_bf16_f32 v14, v60, v61
v_cvt_pk_bf16_f32 v15, v62, v63
s_add_u32 s34, s21, 7168
buffer_store_dwordx4 v[12:15], v1, s[4:7], s34 offen sc1
v_cvt_pk_bf16_f32 v8, v64, v65
v_cvt_pk_bf16_f32 v9, v66, v67
v_cvt_pk_bf16_f32 v10, v68, v69
v_cvt_pk_bf16_f32 v11, v70, v71
s_add_u32 s34, s23, 0
buffer_store_dwordx4 v[8:11], v1, s[4:7], s34 offen sc1
s_waitcnt vmcnt(0)
s_barrier
s_add_u32 s17, s17, 1
v_mov_b32 v28, s17
buffer_store_dword v28, v4, s[4:7], s24 offen sc1
s_cmp_lt_u32 s17, 64
s_cbranch_scc1 reca_ptop238
s_branch reca_exit1
reca_pw1_227:
s_mov_b32 s17, 0
s_mov_b32 s26, 0
s_mul_i32 s20, s17, 40960
s_add_u32 s20, s20, 84944896
s_add_u32 m0, s26, 10240
s_nop 0
buffer_load_dwordx4 v1, s[4:7], s20 offen offset:0 lds
buffer_load_dwordx4 v1, s[4:7], s20 offen offset:1024 lds
buffer_load_dwordx4 v1, s[4:7], s20 offen offset:2048 lds
buffer_load_dwordx4 v1, s[4:7], s20 offen offset:3072 lds
s_add_u32 s20, s20, 4096
s_add_u32 m0, s26, 14336
s_nop 0
buffer_load_dwordx4 v1, s[4:7], s20 offen offset:0 lds
buffer_load_dwordx4 v1, s[4:7], s20 offen offset:1024 lds
buffer_load_dwordx4 v1, s[4:7], s20 offen offset:2048 lds
buffer_load_dwordx4 v1, s[4:7], s20 offen offset:3072 lds
s_add_u32 s20, s20, 4096
s_add_u32 m0, s26, 18432
s_nop 0
buffer_load_dwordx4 v1, s[4:7], s20 offen offset:0 lds
buffer_load_dwordx4 v1, s[4:7], s20 offen offset:1024 lds
s_mul_i32 s34, s15, 12
s_mul_i32 s35, s16, 6
s_add_u32 s34, s34, s35
s_add_u32 s34, s34, 4
s_mul_i32 s34, s34, 20480
s_add_u32 s34, s34, 14155776
buffer_load_dwordx4 a[0:3], v1, s[4:7], s34 offen offset:0
buffer_load_dwordx4 a[4:7], v1, s[4:7], s34 offen offset:1024
buffer_load_dwordx4 a[8:11], v1, s[4:7], s34 offen offset:2048
buffer_load_dwordx4 a[12:15], v1, s[4:7], s34 offen offset:3072
s_add_u32 s34, s34, 4096
buffer_load_dwordx4 a[16:19], v1, s[4:7], s34 offen offset:0
buffer_load_dwordx4 a[20:23], v1, s[4:7], s34 offen offset:1024
buffer_load_dwordx4 a[24:27], v1, s[4:7], s34 offen offset:2048
buffer_load_dwordx4 a[28:31], v1, s[4:7], s34 offen offset:3072
s_add_u32 s34, s34, 4096
buffer_load_dwordx4 a[32:35], v1, s[4:7], s34 offen offset:0
buffer_load_dwordx4 a[36:39], v1, s[4:7], s34 offen offset:1024
buffer_load_dwordx4 a[40:43], v1, s[4:7], s34 offen offset:2048
buffer_load_dwordx4 a[44:47], v1, s[4:7], s34 offen offset:3072
s_add_u32 s34, s34, 4096
buffer_load_dwordx4 a[48:51], v1, s[4:7], s34 offen offset:0
buffer_load_dwordx4 a[52:55], v1, s[4:7], s34 offen offset:1024
buffer_load_dwordx4 a[56:59], v1, s[4:7], s34 offen offset:2048
buffer_load_dwordx4 a[60:63], v1, s[4:7], s34 offen offset:3072
s_add_u32 s34, s34, 4096
buffer_load_dwordx4 a[64:67], v1, s[4:7], s34 offen offset:0
buffer_load_dwordx4 a[68:71], v1, s[4:7], s34 offen offset:1024
buffer_load_dwordx4 a[72:75], v1, s[4:7], s34 offen offset:2048
buffer_load_dwordx4 a[76:79], v1, s[4:7], s34 offen offset:3072
s_mul_i32 s34, s15, 12
s_mul_i32 s35, s16, 6
s_add_u32 s34, s34, s35
s_add_u32 s34, s34, 5
s_mul_i32 s34, s34, 20480
s_add_u32 s34, s34, 14155776
buffer_load_dwordx4 a[80:83], v1, s[4:7], s34 offen offset:0
buffer_load_dwordx4 a[84:87], v1, s[4:7], s34 offen offset:1024
buffer_load_dwordx4 a[88:91], v1, s[4:7], s34 offen offset:2048
buffer_load_dwordx4 a[92:95], v1, s[4:7], s34 offen offset:3072
s_add_u32 s34, s34, 4096
buffer_load_dwordx4 a[96:99], v1, s[4:7], s34 offen offset:0
buffer_load_dwordx4 a[100:103], v1, s[4:7], s34 offen offset:1024
buffer_load_dwordx4 a[104:107], v1, s[4:7], s34 offen offset:2048
buffer_load_dwordx4 a[108:111], v1, s[4:7], s34 offen offset:3072
s_add_u32 s34, s34, 4096
buffer_load_dwordx4 a[112:115], v1, s[4:7], s34 offen offset:0
buffer_load_dwordx4 a[116:119], v1, s[4:7], s34 offen offset:1024
buffer_load_dwordx4 a[120:123], v1, s[4:7], s34 offen offset:2048
buffer_load_dwordx4 a[124:127], v1, s[4:7], s34 offen offset:3072
s_add_u32 s34, s34, 4096
buffer_load_dwordx4 a[128:131], v1, s[4:7], s34 offen offset:0
buffer_load_dwordx4 a[132:135], v1, s[4:7], s34 offen offset:1024
buffer_load_dwordx4 a[136:139], v1, s[4:7], s34 offen offset:2048
buffer_load_dwordx4 a[140:143], v1, s[4:7], s34 offen offset:3072
s_add_u32 s34, s34, 4096
buffer_load_dwordx4 a[144:147], v1, s[4:7], s34 offen offset:0
buffer_load_dwordx4 a[148:151], v1, s[4:7], s34 offen offset:1024
buffer_load_dwordx4 a[152:155], v1, s[4:7], s34 offen offset:2048
buffer_load_dwordx4 a[156:159], v1, s[4:7], s34 offen offset:3072
s_waitcnt vmcnt(20)
s_mul_i32 s34, s15, 12
s_mul_i32 s35, s16, 6
s_add_u32 s34, s34, s35
s_add_u32 s34, s34, 1
s_mul_i32 s34, s34, 20480
s_add_u32 s34, s34, 22020096
buffer_load_dwordx4 a[160:163], v1, s[4:7], s34 offen offset:0
buffer_load_dwordx4 a[164:167], v1, s[4:7], s34 offen offset:1024
buffer_load_dwordx4 a[168:171], v1, s[4:7], s34 offen offset:2048
buffer_load_dwordx4 a[172:175], v1, s[4:7], s34 offen offset:3072
s_add_u32 s34, s34, 4096
buffer_load_dwordx4 a[176:179], v1, s[4:7], s34 offen offset:0
buffer_load_dwordx4 a[180:183], v1, s[4:7], s34 offen offset:1024
buffer_load_dwordx4 a[184:187], v1, s[4:7], s34 offen offset:2048
buffer_load_dwordx4 a[188:191], v1, s[4:7], s34 offen offset:3072
s_add_u32 s34, s34, 4096
buffer_load_dwordx4 a[192:195], v1, s[4:7], s34 offen offset:0
buffer_load_dwordx4 a[196:199], v1, s[4:7], s34 offen offset:1024
buffer_load_dwordx4 a[200:203], v1, s[4:7], s34 offen offset:2048
buffer_load_dwordx4 a[204:207], v1, s[4:7], s34 offen offset:3072
s_add_u32 s34, s34, 4096
buffer_load_dwordx4 a[208:211], v1, s[4:7], s34 offen offset:0
buffer_load_dwordx4 a[212:215], v1, s[4:7], s34 offen offset:1024
buffer_load_dwordx4 a[216:219], v1, s[4:7], s34 offen offset:2048
buffer_load_dwordx4 a[220:223], v1, s[4:7], s34 offen offset:3072
s_add_u32 s34, s34, 4096
buffer_load_dwordx4 a[224:227], v1, s[4:7], s34 offen offset:0
buffer_load_dwordx4 a[228:231], v1, s[4:7], s34 offen offset:1024
buffer_load_dwordx4 a[232:235], v1, s[4:7], s34 offen offset:2048
buffer_load_dwordx4 a[236:239], v1, s[4:7], s34 offen offset:3072
s_waitcnt vmcnt(20)
s_mul_i32 s34, s15, 12
s_mul_i32 s35, s16, 6
s_add_u32 s34, s34, s35
s_add_u32 s34, s34, 2
s_mul_i32 s34, s34, 20480
s_add_u32 s34, s34, 22020096
buffer_load_dwordx4 v[96:99], v1, s[4:7], s34 offen offset:0
buffer_load_dwordx4 v[100:103], v1, s[4:7], s34 offen offset:1024
buffer_load_dwordx4 v[104:107], v1, s[4:7], s34 offen offset:2048
buffer_load_dwordx4 v[108:111], v1, s[4:7], s34 offen offset:3072
s_add_u32 s34, s34, 4096
buffer_load_dwordx4 v[112:115], v1, s[4:7], s34 offen offset:0
buffer_load_dwordx4 v[116:119], v1, s[4:7], s34 offen offset:1024
buffer_load_dwordx4 v[120:123], v1, s[4:7], s34 offen offset:2048
buffer_load_dwordx4 v[124:127], v1, s[4:7], s34 offen offset:3072
s_add_u32 s34, s34, 4096
buffer_load_dwordx4 v[128:131], v1, s[4:7], s34 offen offset:0
buffer_load_dwordx4 v[132:135], v1, s[4:7], s34 offen offset:1024
buffer_load_dwordx4 v[136:139], v1, s[4:7], s34 offen offset:2048
buffer_load_dwordx4 v[140:143], v1, s[4:7], s34 offen offset:3072
s_add_u32 s34, s34, 4096
buffer_load_dwordx4 v[144:147], v1, s[4:7], s34 offen offset:0
buffer_load_dwordx4 v[148:151], v1, s[4:7], s34 offen offset:1024
buffer_load_dwordx4 v[152:155], v1, s[4:7], s34 offen offset:2048
buffer_load_dwordx4 v[156:159], v1, s[4:7], s34 offen offset:3072
s_add_u32 s34, s34, 4096
buffer_load_dwordx4 v[160:163], v1, s[4:7], s34 offen offset:0
buffer_load_dwordx4 v[164:167], v1, s[4:7], s34 offen offset:1024
buffer_load_dwordx4 v[168:171], v1, s[4:7], s34 offen offset:2048
buffer_load_dwordx4 v[172:175], v1, s[4:7], s34 offen offset:3072
s_waitcnt vmcnt(20)
s_mul_i32 s34, s15, 12
s_mul_i32 s35, s16, 6
s_add_u32 s34, s34, s35
s_add_u32 s34, s34, 3
s_mul_i32 s34, s34, 20480
s_add_u32 s34, s34, 22020096
buffer_load_dwordx4 v[176:179], v1, s[4:7], s34 offen offset:0
buffer_load_dwordx4 v[180:183], v1, s[4:7], s34 offen offset:1024
buffer_load_dwordx4 v[184:187], v1, s[4:7], s34 offen offset:2048
buffer_load_dwordx4 v[188:191], v1, s[4:7], s34 offen offset:3072
s_add_u32 s34, s34, 4096
buffer_load_dwordx4 v[192:195], v1, s[4:7], s34 offen offset:0
buffer_load_dwordx4 v[196:199], v1, s[4:7], s34 offen offset:1024
buffer_load_dwordx4 v[200:203], v1, s[4:7], s34 offen offset:2048
buffer_load_dwordx4 v[204:207], v1, s[4:7], s34 offen offset:3072
s_add_u32 s34, s34, 4096
buffer_load_dwordx4 v[208:211], v1, s[4:7], s34 offen offset:0
buffer_load_dwordx4 v[212:215], v1, s[4:7], s34 offen offset:1024
buffer_load_dwordx4 v[216:219], v1, s[4:7], s34 offen offset:2048
buffer_load_dwordx4 v[220:223], v1, s[4:7], s34 offen offset:3072
s_add_u32 s34, s34, 4096
buffer_load_dwordx4 v[224:227], v1, s[4:7], s34 offen offset:0
buffer_load_dwordx4 v[228:231], v1, s[4:7], s34 offen offset:1024
buffer_load_dwordx4 v[232:235], v1, s[4:7], s34 offen offset:2048
buffer_load_dwordx4 v[236:239], v1, s[4:7], s34 offen offset:3072
s_add_u32 s34, s34, 4096
buffer_load_dwordx4 v[240:243], v1, s[4:7], s34 offen offset:0
buffer_load_dwordx4 v[244:247], v1, s[4:7], s34 offen offset:1024
buffer_load_dwordx4 v[248:251], v1, s[4:7], s34 offen offset:2048
buffer_load_dwordx4 v[252:255], v1, s[4:7], s34 offen offset:3072
s_waitcnt vmcnt(20)
v_and_b32 v30, 7, v0
v_lshlrev_b32 v30, 3, v30
reca_cens243:
buffer_load_dwordx2 v[28:29], v30, s[8:11], 0 offen sc1
s_waitcnt vmcnt(0)
v_sad_u8 v31, v28, 0, 0
v_sad_u8 v31, v29, 0, v31
v_cmp_gt_u32 vcc, 32, v31
s_cbranch_vccz reca_censok244
s_sleep 8
s_sub_u32 s18, s18, 1
s_cbranch_scc0 reca_cens243
s_mov_b32 s18, 0
reca_censok244:
v_and_b32 v28, 0x20202020, v28
v_and_b32 v29, 0x20202020, v29
v_cmp_ne_u32 s[34:35], 0, v28
v_cmp_ne_u32 s[36:37], 0, v29
s_nop 3
s_and_b32 s34, s34, 0xff
s_and_b32 s36, s36, 0xff
s_or_b32 s35, s34, s36
s_lshr_b32 s37, s35, s13
s_and_b32 s37, s37, 1
s_xor_b32 s43, s37, 1
s_cmp_eq_u32 s57, 0
s_cselect_b32 s58, s36, s34
v_mov_b32 v31, 0x80000000
s_cmp_lg_u32 s43, 0
s_cbranch_scc1 reca_pslow245
reca_ptop246:
s_cmp_lt_u32 s17, 3
s_cbranch_scc1 reca_pgo247
s_sub_u32 s36, s17, 3
reca_ppoll248:
buffer_load_dword v28, v4, s[4:7], s25 offen sc1
s_waitcnt vmcnt(0)
v_readfirstlane_b32 s34, v28
s_nop 3
s_cmp_ge_i32 s34, s36
s_cbranch_scc1 reca_pgo247
s_sleep 8
s_sub_u32 s18, s18, 1
s_cbranch_scc0 reca_ppoll248
s_mov_b32 s18, 0
reca_pgo247:
s_waitcnt vmcnt(0)
s_barrier
v_add_u32 v7, s26, v1
s_xor_b32 s26, s26, 40960
s_add_u32 s37, s17, 1
s_cmp_ge_u32 s37, 64
s_cbranch_scc1 reca_pnodma249
s_mul_i32 s20, s37, 40960
s_add_u32 s20, s20, 84944896
s_add_u32 m0, s26, 10240
s_nop 0
buffer_load_dwordx4 v1, s[4:7], s20 offen offset:0 lds
buffer_load_dwordx4 v1, s[4:7], s20 offen offset:1024 lds
buffer_load_dwordx4 v1, s[4:7], s20 offen offset:2048 lds
buffer_load_dwordx4 v1, s[4:7], s20 offen offset:3072 lds
s_add_u32 s20, s20, 4096
s_add_u32 m0, s26, 14336
s_nop 0
buffer_load_dwordx4 v1, s[4:7], s20 offen offset:0 lds
buffer_load_dwordx4 v1, s[4:7], s20 offen offset:1024 lds
buffer_load_dwordx4 v1, s[4:7], s20 offen offset:2048 lds
buffer_load_dwordx4 v1, s[4:7], s20 offen offset:3072 lds
s_add_u32 s20, s20, 4096
s_add_u32 m0, s26, 18432
s_nop 0
buffer_load_dwordx4 v1, s[4:7], s20 offen offset:0 lds
buffer_load_dwordx4 v1, s[4:7], s20 offen offset:1024 lds
reca_pnodma249:
s_lshl_b32 s34, s15, 3
s_and_b32 s35, s17, 7
s_add_u32 s34, s34, s35
s_mul_i32 s34, s34, 12288
s_mul_i32 s35, s16, 3072
s_add_u32 s35, s35, s34
s_add_u32 s21, s35, 37748736
s_add_u32 s22, s35, 44040192
s_mul_i32 s35, s16, 6144
s_add_u32 s35, s35, s34
s_add_u32 s23, s35, 40894464
ds_read_b128 v[72:75], v7 offset:0
ds_read_b128 v[76:79], v7 offset:20480
ds_read_b128 v[80:83], v7 offset:1024
ds_read_b128 v[84:87], v7 offset:21504
ds_read_b128 v[88:91], v7 offset:2048
ds_read_b128 v[92:95], v7 offset:22528
s_waitcnt lgkmcnt(4)
v_mfma_f32_16x16x32_bf16 v[32:35], a[0:3], v[72:75], 0
v_mfma_f32_16x16x32_bf16 v[36:39], a[0:3], v[76:79], 0
v_mfma_f32_16x16x32_bf16 v[40:43], a[80:83], v[72:75], 0
v_mfma_f32_16x16x32_bf16 v[44:47], a[80:83], v[76:79], 0
v_mfma_f32_16x16x32_bf16 v[48:51], v[72:75], a[160:163], 0
v_mfma_f32_16x16x32_bf16 v[52:55], v[76:79], a[160:163], 0
v_mfma_f32_16x16x32_bf16 v[56:59], v[72:75], v[96:99], 0
v_mfma_f32_16x16x32_bf16 v[60:63], v[76:79], v[96:99], 0
v_mfma_f32_16x16x32_bf16 v[64:67], v[72:75], v[176:179], 0
v_mfma_f32_16x16x32_bf16 v[68:71], v[76:79], v[176:179], 0
ds_read_b128 v[72:75], v7 offset:3072
ds_read_b128 v[76:79], v7 offset:23552
s_waitcnt lgkmcnt(4)
v_mfma_f32_16x16x32_bf16 v[32:35], a[4:7], v[80:83], v[32:35]
v_mfma_f32_16x16x32_bf16 v[36:39], a[4:7], v[84:87], v[36:39]
v_mfma_f32_16x16x32_bf16 v[40:43], a[84:87], v[80:83], v[40:43]
v_mfma_f32_16x16x32_bf16 v[44:47], a[84:87], v[84:87], v[44:47]
v_mfma_f32_16x16x32_bf16 v[48:51], v[80:83], a[164:167], v[48:51]
v_mfma_f32_16x16x32_bf16 v[52:55], v[84:87], a[164:167], v[52:55]
v_mfma_f32_16x16x32_bf16 v[56:59], v[80:83], v[100:103], v[56:59]
v_mfma_f32_16x16x32_bf16 v[60:63], v[84:87], v[100:103], v[60:63]
v_mfma_f32_16x16x32_bf16 v[64:67], v[80:83], v[180:183], v[64:67]
v_mfma_f32_16x16x32_bf16 v[68:71], v[84:87], v[180:183], v[68:71]
ds_read_b128 v[80:83], v7 offset:4096
ds_read_b128 v[84:87], v7 offset:24576
s_waitcnt lgkmcnt(4)
v_mfma_f32_16x16x32_bf16 v[32:35], a[8:11], v[88:91], v[32:35]
v_mfma_f32_16x16x32_bf16 v[36:39], a[8:11], v[92:95], v[36:39]
v_mfma_f32_16x16x32_bf16 v[40:43], a[88:91], v[88:91], v[40:43]
v_mfma_f32_16x16x32_bf16 v[44:47], a[88:91], v[92:95], v[44:47]
v_mfma_f32_16x16x32_bf16 v[48:51], v[88:91], a[168:171], v[48:51]
v_mfma_f32_16x16x32_bf16 v[52:55], v[92:95], a[168:171], v[52:55]
v_mfma_f32_16x16x32_bf16 v[56:59], v[88:91], v[104:107], v[56:59]
v_mfma_f32_16x16x32_bf16 v[60:63], v[92:95], v[104:107], v[60:63]
v_mfma_f32_16x16x32_bf16 v[64:67], v[88:91], v[184:187], v[64:67]
v_mfma_f32_16x16x32_bf16 v[68:71], v[92:95], v[184:187], v[68:71]
ds_read_b128 v[88:91], v7 offset:5120
ds_read_b128 v[92:95], v7 offset:25600
s_waitcnt lgkmcnt(4)
v_mfma_f32_16x16x32_bf16 v[32:35], a[12:15], v[72:75], v[32:35]
v_mfma_f32_16x16x32_bf16 v[36:39], a[12:15], v[76:79], v[36:39]
v_mfma_f32_16x16x32_bf16 v[40:43], a[92:95], v[72:75], v[40:43]
v_mfma_f32_16x16x32_bf16 v[44:47], a[92:95], v[76:79], v[44:47]
v_mfma_f32_16x16x32_bf16 v[48:51], v[72:75], a[172:175], v[48:51]
v_mfma_f32_16x16x32_bf16 v[52:55], v[76:79], a[172:175], v[52:55]
v_mfma_f32_16x16x32_bf16 v[56:59], v[72:75], v[108:111], v[56:59]
v_mfma_f32_16x16x32_bf16 v[60:63], v[76:79], v[108:111], v[60:63]
v_mfma_f32_16x16x32_bf16 v[64:67], v[72:75], v[188:191], v[64:67]
v_mfma_f32_16x16x32_bf16 v[68:71], v[76:79], v[188:191], v[68:71]
ds_read_b128 v[72:75], v7 offset:6144
ds_read_b128 v[76:79], v7 offset:26624
s_waitcnt lgkmcnt(4)
v_mfma_f32_16x16x32_bf16 v[32:35], a[16:19], v[80:83], v[32:35]
v_mfma_f32_16x16x32_bf16 v[36:39], a[16:19], v[84:87], v[36:39]
v_mfma_f32_16x16x32_bf16 v[40:43], a[96:99], v[80:83], v[40:43]
v_mfma_f32_16x16x32_bf16 v[44:47], a[96:99], v[84:87], v[44:47]
v_mfma_f32_16x16x32_bf16 v[48:51], v[80:83], a[176:179], v[48:51]
v_mfma_f32_16x16x32_bf16 v[52:55], v[84:87], a[176:179], v[52:55]
v_mfma_f32_16x16x32_bf16 v[56:59], v[80:83], v[112:115], v[56:59]
v_mfma_f32_16x16x32_bf16 v[60:63], v[84:87], v[112:115], v[60:63]
v_mfma_f32_16x16x32_bf16 v[64:67], v[80:83], v[192:195], v[64:67]
v_mfma_f32_16x16x32_bf16 v[68:71], v[84:87], v[192:195], v[68:71]
ds_read_b128 v[80:83], v7 offset:7168
ds_read_b128 v[84:87], v7 offset:27648
s_waitcnt lgkmcnt(4)
v_mfma_f32_16x16x32_bf16 v[32:35], a[20:23], v[88:91], v[32:35]
v_mfma_f32_16x16x32_bf16 v[36:39], a[20:23], v[92:95], v[36:39]
v_mfma_f32_16x16x32_bf16 v[40:43], a[100:103], v[88:91], v[40:43]
v_mfma_f32_16x16x32_bf16 v[44:47], a[100:103], v[92:95], v[44:47]
v_mfma_f32_16x16x32_bf16 v[48:51], v[88:91], a[180:183], v[48:51]
v_mfma_f32_16x16x32_bf16 v[52:55], v[92:95], a[180:183], v[52:55]
v_mfma_f32_16x16x32_bf16 v[56:59], v[88:91], v[116:119], v[56:59]
v_mfma_f32_16x16x32_bf16 v[60:63], v[92:95], v[116:119], v[60:63]
v_mfma_f32_16x16x32_bf16 v[64:67], v[88:91], v[196:199], v[64:67]
v_mfma_f32_16x16x32_bf16 v[68:71], v[92:95], v[196:199], v[68:71]
ds_read_b128 v[88:91], v7 offset:8192
ds_read_b128 v[92:95], v7 offset:28672
s_waitcnt lgkmcnt(4)
v_mfma_f32_16x16x32_bf16 v[32:35], a[24:27], v[72:75], v[32:35]
v_mfma_f32_16x16x32_bf16 v[36:39], a[24:27], v[76:79], v[36:39]
v_mfma_f32_16x16x32_bf16 v[40:43], a[104:107], v[72:75], v[40:43]
v_mfma_f32_16x16x32_bf16 v[44:47], a[104:107], v[76:79], v[44:47]
v_mfma_f32_16x16x32_bf16 v[48:51], v[72:75], a[184:187], v[48:51]
v_mfma_f32_16x16x32_bf16 v[52:55], v[76:79], a[184:187], v[52:55]
v_mfma_f32_16x16x32_bf16 v[56:59], v[72:75], v[120:123], v[56:59]
v_mfma_f32_16x16x32_bf16 v[60:63], v[76:79], v[120:123], v[60:63]
v_mfma_f32_16x16x32_bf16 v[64:67], v[72:75], v[200:203], v[64:67]
v_mfma_f32_16x16x32_bf16 v[68:71], v[76:79], v[200:203], v[68:71]
ds_read_b128 v[72:75], v7 offset:9216
ds_read_b128 v[76:79], v7 offset:29696
s_waitcnt lgkmcnt(4)
v_mfma_f32_16x16x32_bf16 v[32:35], a[28:31], v[80:83], v[32:35]
v_mfma_f32_16x16x32_bf16 v[36:39], a[28:31], v[84:87], v[36:39]
v_mfma_f32_16x16x32_bf16 v[40:43], a[108:111], v[80:83], v[40:43]
v_mfma_f32_16x16x32_bf16 v[44:47], a[108:111], v[84:87], v[44:47]
v_mfma_f32_16x16x32_bf16 v[48:51], v[80:83], a[188:191], v[48:51]
v_mfma_f32_16x16x32_bf16 v[52:55], v[84:87], a[188:191], v[52:55]
v_mfma_f32_16x16x32_bf16 v[56:59], v[80:83], v[124:127], v[56:59]
v_mfma_f32_16x16x32_bf16 v[60:63], v[84:87], v[124:127], v[60:63]
v_mfma_f32_16x16x32_bf16 v[64:67], v[80:83], v[204:207], v[64:67]
v_mfma_f32_16x16x32_bf16 v[68:71], v[84:87], v[204:207], v[68:71]
ds_read_b128 v[80:83], v7 offset:10240
ds_read_b128 v[84:87], v7 offset:30720
s_waitcnt lgkmcnt(4)
v_mfma_f32_16x16x32_bf16 v[32:35], a[32:35], v[88:91], v[32:35]
v_mfma_f32_16x16x32_bf16 v[36:39], a[32:35], v[92:95], v[36:39]
v_mfma_f32_16x16x32_bf16 v[40:43], a[112:115], v[88:91], v[40:43]
v_mfma_f32_16x16x32_bf16 v[44:47], a[112:115], v[92:95], v[44:47]
v_mfma_f32_16x16x32_bf16 v[48:51], v[88:91], a[192:195], v[48:51]
v_mfma_f32_16x16x32_bf16 v[52:55], v[92:95], a[192:195], v[52:55]
v_mfma_f32_16x16x32_bf16 v[56:59], v[88:91], v[128:131], v[56:59]
v_mfma_f32_16x16x32_bf16 v[60:63], v[92:95], v[128:131], v[60:63]
v_mfma_f32_16x16x32_bf16 v[64:67], v[88:91], v[208:211], v[64:67]
v_mfma_f32_16x16x32_bf16 v[68:71], v[92:95], v[208:211], v[68:71]
ds_read_b128 v[88:91], v7 offset:11264
ds_read_b128 v[92:95], v7 offset:31744
s_waitcnt lgkmcnt(4)
v_mfma_f32_16x16x32_bf16 v[32:35], a[36:39], v[72:75], v[32:35]
v_mfma_f32_16x16x32_bf16 v[36:39], a[36:39], v[76:79], v[36:39]
v_mfma_f32_16x16x32_bf16 v[40:43], a[116:119], v[72:75], v[40:43]
v_mfma_f32_16x16x32_bf16 v[44:47], a[116:119], v[76:79], v[44:47]
v_mfma_f32_16x16x32_bf16 v[48:51], v[72:75], a[196:199], v[48:51]
v_mfma_f32_16x16x32_bf16 v[52:55], v[76:79], a[196:199], v[52:55]
v_mfma_f32_16x16x32_bf16 v[56:59], v[72:75], v[132:135], v[56:59]
v_mfma_f32_16x16x32_bf16 v[60:63], v[76:79], v[132:135], v[60:63]
v_mfma_f32_16x16x32_bf16 v[64:67], v[72:75], v[212:215], v[64:67]
v_mfma_f32_16x16x32_bf16 v[68:71], v[76:79], v[212:215], v[68:71]
ds_read_b128 v[72:75], v7 offset:12288
ds_read_b128 v[76:79], v7 offset:32768
s_waitcnt lgkmcnt(4)
v_mfma_f32_16x16x32_bf16 v[32:35], a[40:43], v[80:83], v[32:35]
v_mfma_f32_16x16x32_bf16 v[36:39], a[40:43], v[84:87], v[36:39]
v_mfma_f32_16x16x32_bf16 v[40:43], a[120:123], v[80:83], v[40:43]
v_mfma_f32_16x16x32_bf16 v[44:47], a[120:123], v[84:87], v[44:47]
v_mfma_f32_16x16x32_bf16 v[48:51], v[80:83], a[200:203], v[48:51]
v_mfma_f32_16x16x32_bf16 v[52:55], v[84:87], a[200:203], v[52:55]
v_mfma_f32_16x16x32_bf16 v[56:59], v[80:83], v[136:139], v[56:59]
v_mfma_f32_16x16x32_bf16 v[60:63], v[84:87], v[136:139], v[60:63]
v_mfma_f32_16x16x32_bf16 v[64:67], v[80:83], v[216:219], v[64:67]
v_mfma_f32_16x16x32_bf16 v[68:71], v[84:87], v[216:219], v[68:71]
ds_read_b128 v[80:83], v7 offset:13312
ds_read_b128 v[84:87], v7 offset:33792
s_waitcnt lgkmcnt(4)
v_mfma_f32_16x16x32_bf16 v[32:35], a[44:47], v[88:91], v[32:35]
v_mfma_f32_16x16x32_bf16 v[36:39], a[44:47], v[92:95], v[36:39]
v_mfma_f32_16x16x32_bf16 v[40:43], a[124:127], v[88:91], v[40:43]
v_mfma_f32_16x16x32_bf16 v[44:47], a[124:127], v[92:95], v[44:47]
v_mfma_f32_16x16x32_bf16 v[48:51], v[88:91], a[204:207], v[48:51]
v_mfma_f32_16x16x32_bf16 v[52:55], v[92:95], a[204:207], v[52:55]
v_mfma_f32_16x16x32_bf16 v[56:59], v[88:91], v[140:143], v[56:59]
v_mfma_f32_16x16x32_bf16 v[60:63], v[92:95], v[140:143], v[60:63]
v_mfma_f32_16x16x32_bf16 v[64:67], v[88:91], v[220:223], v[64:67]
v_mfma_f32_16x16x32_bf16 v[68:71], v[92:95], v[220:223], v[68:71]
ds_read_b128 v[88:91], v7 offset:14336
ds_read_b128 v[92:95], v7 offset:34816
s_waitcnt lgkmcnt(4)
v_mfma_f32_16x16x32_bf16 v[32:35], a[48:51], v[72:75], v[32:35]
v_mfma_f32_16x16x32_bf16 v[36:39], a[48:51], v[76:79], v[36:39]
v_mfma_f32_16x16x32_bf16 v[40:43], a[128:131], v[72:75], v[40:43]
v_mfma_f32_16x16x32_bf16 v[44:47], a[128:131], v[76:79], v[44:47]
v_mfma_f32_16x16x32_bf16 v[48:51], v[72:75], a[208:211], v[48:51]
v_mfma_f32_16x16x32_bf16 v[52:55], v[76:79], a[208:211], v[52:55]
v_mfma_f32_16x16x32_bf16 v[56:59], v[72:75], v[144:147], v[56:59]
v_mfma_f32_16x16x32_bf16 v[60:63], v[76:79], v[144:147], v[60:63]
v_mfma_f32_16x16x32_bf16 v[64:67], v[72:75], v[224:227], v[64:67]
v_mfma_f32_16x16x32_bf16 v[68:71], v[76:79], v[224:227], v[68:71]
ds_read_b128 v[72:75], v7 offset:15360
ds_read_b128 v[76:79], v7 offset:35840
s_waitcnt lgkmcnt(4)
v_mfma_f32_16x16x32_bf16 v[32:35], a[52:55], v[80:83], v[32:35]
v_mfma_f32_16x16x32_bf16 v[36:39], a[52:55], v[84:87], v[36:39]
v_mfma_f32_16x16x32_bf16 v[40:43], a[132:135], v[80:83], v[40:43]
v_mfma_f32_16x16x32_bf16 v[44:47], a[132:135], v[84:87], v[44:47]
v_mfma_f32_16x16x32_bf16 v[48:51], v[80:83], a[212:215], v[48:51]
v_mfma_f32_16x16x32_bf16 v[52:55], v[84:87], a[212:215], v[52:55]
v_mfma_f32_16x16x32_bf16 v[56:59], v[80:83], v[148:151], v[56:59]
v_mfma_f32_16x16x32_bf16 v[60:63], v[84:87], v[148:151], v[60:63]
v_mfma_f32_16x16x32_bf16 v[64:67], v[80:83], v[228:231], v[64:67]
v_mfma_f32_16x16x32_bf16 v[68:71], v[84:87], v[228:231], v[68:71]
ds_read_b128 v[80:83], v7 offset:16384
ds_read_b128 v[84:87], v7 offset:36864
s_waitcnt lgkmcnt(4)
v_mfma_f32_16x16x32_bf16 v[32:35], a[56:59], v[88:91], v[32:35]
v_mfma_f32_16x16x32_bf16 v[36:39], a[56:59], v[92:95], v[36:39]
v_mfma_f32_16x16x32_bf16 v[40:43], a[136:139], v[88:91], v[40:43]
v_mfma_f32_16x16x32_bf16 v[44:47], a[136:139], v[92:95], v[44:47]
v_mfma_f32_16x16x32_bf16 v[48:51], v[88:91], a[216:219], v[48:51]
v_mfma_f32_16x16x32_bf16 v[52:55], v[92:95], a[216:219], v[52:55]
v_mfma_f32_16x16x32_bf16 v[56:59], v[88:91], v[152:155], v[56:59]
v_mfma_f32_16x16x32_bf16 v[60:63], v[92:95], v[152:155], v[60:63]
v_mfma_f32_16x16x32_bf16 v[64:67], v[88:91], v[232:235], v[64:67]
v_mfma_f32_16x16x32_bf16 v[68:71], v[92:95], v[232:235], v[68:71]
ds_read_b128 v[88:91], v7 offset:17408
ds_read_b128 v[92:95], v7 offset:37888
s_waitcnt lgkmcnt(4)
v_mfma_f32_16x16x32_bf16 v[32:35], a[60:63], v[72:75], v[32:35]
v_mfma_f32_16x16x32_bf16 v[36:39], a[60:63], v[76:79], v[36:39]
v_mfma_f32_16x16x32_bf16 v[40:43], a[140:143], v[72:75], v[40:43]
v_mfma_f32_16x16x32_bf16 v[44:47], a[140:143], v[76:79], v[44:47]
v_mfma_f32_16x16x32_bf16 v[48:51], v[72:75], a[220:223], v[48:51]
v_mfma_f32_16x16x32_bf16 v[52:55], v[76:79], a[220:223], v[52:55]
v_mfma_f32_16x16x32_bf16 v[56:59], v[72:75], v[156:159], v[56:59]
v_mfma_f32_16x16x32_bf16 v[60:63], v[76:79], v[156:159], v[60:63]
v_mfma_f32_16x16x32_bf16 v[64:67], v[72:75], v[236:239], v[64:67]
v_mfma_f32_16x16x32_bf16 v[68:71], v[76:79], v[236:239], v[68:71]
ds_read_b128 v[72:75], v7 offset:18432
ds_read_b128 v[76:79], v7 offset:38912
s_waitcnt lgkmcnt(4)
v_mfma_f32_16x16x32_bf16 v[32:35], a[64:67], v[80:83], v[32:35]
v_mfma_f32_16x16x32_bf16 v[36:39], a[64:67], v[84:87], v[36:39]
v_mfma_f32_16x16x32_bf16 v[40:43], a[144:147], v[80:83], v[40:43]
v_mfma_f32_16x16x32_bf16 v[44:47], a[144:147], v[84:87], v[44:47]
v_mfma_f32_16x16x32_bf16 v[48:51], v[80:83], a[224:227], v[48:51]
v_mfma_f32_16x16x32_bf16 v[52:55], v[84:87], a[224:227], v[52:55]
v_mfma_f32_16x16x32_bf16 v[56:59], v[80:83], v[160:163], v[56:59]
v_mfma_f32_16x16x32_bf16 v[60:63], v[84:87], v[160:163], v[60:63]
v_mfma_f32_16x16x32_bf16 v[64:67], v[80:83], v[240:243], v[64:67]
v_mfma_f32_16x16x32_bf16 v[68:71], v[84:87], v[240:243], v[68:71]
ds_read_b128 v[80:83], v7 offset:19456
ds_read_b128 v[84:87], v7 offset:39936
s_waitcnt lgkmcnt(4)
v_mfma_f32_16x16x32_bf16 v[32:35], a[68:71], v[88:91], v[32:35]
v_mfma_f32_16x16x32_bf16 v[36:39], a[68:71], v[92:95], v[36:39]
v_mfma_f32_16x16x32_bf16 v[40:43], a[148:151], v[88:91], v[40:43]
v_mfma_f32_16x16x32_bf16 v[44:47], a[148:151], v[92:95], v[44:47]
v_mfma_f32_16x16x32_bf16 v[48:51], v[88:91], a[228:231], v[48:51]
v_mfma_f32_16x16x32_bf16 v[52:55], v[92:95], a[228:231], v[52:55]
v_mfma_f32_16x16x32_bf16 v[56:59], v[88:91], v[164:167], v[56:59]
v_mfma_f32_16x16x32_bf16 v[60:63], v[92:95], v[164:167], v[60:63]
v_mfma_f32_16x16x32_bf16 v[64:67], v[88:91], v[244:247], v[64:67]
v_mfma_f32_16x16x32_bf16 v[68:71], v[92:95], v[244:247], v[68:71]
s_waitcnt lgkmcnt(2)
v_mfma_f32_16x16x32_bf16 v[32:35], a[72:75], v[72:75], v[32:35]
v_mfma_f32_16x16x32_bf16 v[36:39], a[72:75], v[76:79], v[36:39]
v_mfma_f32_16x16x32_bf16 v[40:43], a[152:155], v[72:75], v[40:43]
v_mfma_f32_16x16x32_bf16 v[44:47], a[152:155], v[76:79], v[44:47]
v_mfma_f32_16x16x32_bf16 v[48:51], v[72:75], a[232:235], v[48:51]
v_mfma_f32_16x16x32_bf16 v[52:55], v[76:79], a[232:235], v[52:55]
v_mfma_f32_16x16x32_bf16 v[56:59], v[72:75], v[168:171], v[56:59]
v_mfma_f32_16x16x32_bf16 v[60:63], v[76:79], v[168:171], v[60:63]
v_mfma_f32_16x16x32_bf16 v[64:67], v[72:75], v[248:251], v[64:67]
v_mfma_f32_16x16x32_bf16 v[68:71], v[76:79], v[248:251], v[68:71]
s_waitcnt lgkmcnt(0)
v_mfma_f32_16x16x32_bf16 v[32:35], a[76:79], v[80:83], v[32:35]
v_mfma_f32_16x16x32_bf16 v[36:39], a[76:79], v[84:87], v[36:39]
v_mfma_f32_16x16x32_bf16 v[40:43], a[156:159], v[80:83], v[40:43]
v_mfma_f32_16x16x32_bf16 v[44:47], a[156:159], v[84:87], v[44:47]
v_mfma_f32_16x16x32_bf16 v[48:51], v[80:83], a[236:239], v[48:51]
v_mfma_f32_16x16x32_bf16 v[52:55], v[84:87], a[236:239], v[52:55]
v_mfma_f32_16x16x32_bf16 v[56:59], v[80:83], v[172:175], v[56:59]
v_mfma_f32_16x16x32_bf16 v[60:63], v[84:87], v[172:175], v[60:63]
v_mfma_f32_16x16x32_bf16 v[64:67], v[80:83], v[252:255], v[64:67]
v_mfma_f32_16x16x32_bf16 v[68:71], v[84:87], v[252:255], v[68:71]
v_cvt_pk_bf16_f32 v8, v32, v33
v_cvt_pk_bf16_f32 v9, v34, v35
v_cvt_pk_bf16_f32 v10, v40, v41
v_cvt_pk_bf16_f32 v11, v42, v43
s_add_u32 s34, s21, 2048
buffer_store_dwordx4 v[8:11], v1, s[4:7], s34 offen
v_cvt_pk_bf16_f32 v12, v36, v37
v_cvt_pk_bf16_f32 v13, v38, v39
v_cvt_pk_bf16_f32 v14, v44, v45
v_cvt_pk_bf16_f32 v15, v46, v47
s_add_u32 s34, s21, 8192
buffer_store_dwordx4 v[12:15], v1, s[4:7], s34 offen
v_cvt_pk_bf16_f32 v8, v48, v49
v_cvt_pk_bf16_f32 v9, v50, v51
v_cvt_pk_bf16_f32 v10, v52, v53
v_cvt_pk_bf16_f32 v11, v54, v55
s_add_u32 s34, s23, 1024
buffer_store_dwordx4 v[8:11], v1, s[4:7], s34 offen
v_cvt_pk_bf16_f32 v12, v56, v57
v_cvt_pk_bf16_f32 v13, v58, v59
v_cvt_pk_bf16_f32 v14, v60, v61
v_cvt_pk_bf16_f32 v15, v62, v63
s_add_u32 s34, s23, 2048
buffer_store_dwordx4 v[12:15], v1, s[4:7], s34 offen
v_cvt_pk_bf16_f32 v8, v64, v65
v_cvt_pk_bf16_f32 v9, v66, v67
v_cvt_pk_bf16_f32 v10, v68, v69
v_cvt_pk_bf16_f32 v11, v70, v71
s_add_u32 s34, s23, 3072
buffer_store_dwordx4 v[8:11], v1, s[4:7], s34 offen
s_waitcnt vmcnt(0)
s_barrier
s_add_u32 s17, s17, 1
s_cmp_lt_u32 s17, 64
s_cbranch_scc1 reca_ptop246
s_branch reca_exit1
reca_pslow245:
reca_ptop251:
s_cmp_lt_u32 s17, 3
s_cbranch_scc1 reca_pgo252
s_sub_u32 s36, s17, 3
reca_ppoll253:
buffer_load_dword v28, v4, s[4:7], s25 offen sc1
s_waitcnt vmcnt(0)
v_readfirstlane_b32 s34, v28
s_nop 3
s_cmp_ge_i32 s34, s36
s_cbranch_scc1 reca_pgo252
s_sleep 8
s_sub_u32 s18, s18, 1
s_cbranch_scc0 reca_ppoll253
s_mov_b32 s18, 0
reca_pgo252:
s_waitcnt vmcnt(0)
s_barrier
v_add_u32 v7, s26, v1
s_xor_b32 s26, s26, 40960
s_add_u32 s37, s17, 1
s_cmp_ge_u32 s37, 64
s_cbranch_scc1 reca_pnodma254
s_mul_i32 s20, s37, 40960
s_add_u32 s20, s20, 84944896
s_add_u32 m0, s26, 10240
s_nop 0
buffer_load_dwordx4 v1, s[4:7], s20 offen offset:0 lds
buffer_load_dwordx4 v1, s[4:7], s20 offen offset:1024 lds
buffer_load_dwordx4 v1, s[4:7], s20 offen offset:2048 lds
buffer_load_dwordx4 v1, s[4:7], s20 offen offset:3072 lds
s_add_u32 s20, s20, 4096
s_add_u32 m0, s26, 14336
s_nop 0
buffer_load_dwordx4 v1, s[4:7], s20 offen offset:0 lds
buffer_load_dwordx4 v1, s[4:7], s20 offen offset:1024 lds
buffer_load_dwordx4 v1, s[4:7], s20 offen offset:2048 lds
buffer_load_dwordx4 v1, s[4:7], s20 offen offset:3072 lds
s_add_u32 s20, s20, 4096
s_add_u32 m0, s26, 18432
s_nop 0
buffer_load_dwordx4 v1, s[4:7], s20 offen offset:0 lds
buffer_load_dwordx4 v1, s[4:7], s20 offen offset:1024 lds
reca_pnodma254:
s_lshl_b32 s34, s15, 3
s_and_b32 s35, s17, 7
s_add_u32 s34, s34, s35
s_mul_i32 s34, s34, 12288
s_mul_i32 s35, s16, 3072
s_add_u32 s35, s35, s34
s_add_u32 s21, s35, 37748736
s_add_u32 s22, s35, 44040192
s_mul_i32 s35, s16, 6144
s_add_u32 s35, s35, s34
s_add_u32 s23, s35, 40894464
ds_read_b128 v[72:75], v7 offset:0
ds_read_b128 v[76:79], v7 offset:20480
ds_read_b128 v[80:83], v7 offset:1024
ds_read_b128 v[84:87], v7 offset:21504
ds_read_b128 v[88:91], v7 offset:2048
ds_read_b128 v[92:95], v7 offset:22528
s_waitcnt lgkmcnt(4)
v_mfma_f32_16x16x32_bf16 v[32:35], a[0:3], v[72:75], 0
v_mfma_f32_16x16x32_bf16 v[36:39], a[0:3], v[76:79], 0
v_mfma_f32_16x16x32_bf16 v[40:43], a[80:83], v[72:75], 0
v_mfma_f32_16x16x32_bf16 v[44:47], a[80:83], v[76:79], 0
v_mfma_f32_16x16x32_bf16 v[48:51], v[72:75], a[160:163], 0
v_mfma_f32_16x16x32_bf16 v[52:55], v[76:79], a[160:163], 0
v_mfma_f32_16x16x32_bf16 v[56:59], v[72:75], v[96:99], 0
v_mfma_f32_16x16x32_bf16 v[60:63], v[76:79], v[96:99], 0
v_mfma_f32_16x16x32_bf16 v[64:67], v[72:75], v[176:179], 0
v_mfma_f32_16x16x32_bf16 v[68:71], v[76:79], v[176:179], 0
ds_read_b128 v[72:75], v7 offset:3072
ds_read_b128 v[76:79], v7 offset:23552
s_waitcnt lgkmcnt(4)
v_mfma_f32_16x16x32_bf16 v[32:35], a[4:7], v[80:83], v[32:35]
v_mfma_f32_16x16x32_bf16 v[36:39], a[4:7], v[84:87], v[36:39]
v_mfma_f32_16x16x32_bf16 v[40:43], a[84:87], v[80:83], v[40:43]
v_mfma_f32_16x16x32_bf16 v[44:47], a[84:87], v[84:87], v[44:47]
v_mfma_f32_16x16x32_bf16 v[48:51], v[80:83], a[164:167], v[48:51]
v_mfma_f32_16x16x32_bf16 v[52:55], v[84:87], a[164:167], v[52:55]
v_mfma_f32_16x16x32_bf16 v[56:59], v[80:83], v[100:103], v[56:59]
v_mfma_f32_16x16x32_bf16 v[60:63], v[84:87], v[100:103], v[60:63]
v_mfma_f32_16x16x32_bf16 v[64:67], v[80:83], v[180:183], v[64:67]
v_mfma_f32_16x16x32_bf16 v[68:71], v[84:87], v[180:183], v[68:71]
ds_read_b128 v[80:83], v7 offset:4096
ds_read_b128 v[84:87], v7 offset:24576
s_waitcnt lgkmcnt(4)
v_mfma_f32_16x16x32_bf16 v[32:35], a[8:11], v[88:91], v[32:35]
v_mfma_f32_16x16x32_bf16 v[36:39], a[8:11], v[92:95], v[36:39]
v_mfma_f32_16x16x32_bf16 v[40:43], a[88:91], v[88:91], v[40:43]
v_mfma_f32_16x16x32_bf16 v[44:47], a[88:91], v[92:95], v[44:47]
v_mfma_f32_16x16x32_bf16 v[48:51], v[88:91], a[168:171], v[48:51]
v_mfma_f32_16x16x32_bf16 v[52:55], v[92:95], a[168:171], v[52:55]
v_mfma_f32_16x16x32_bf16 v[56:59], v[88:91], v[104:107], v[56:59]
v_mfma_f32_16x16x32_bf16 v[60:63], v[92:95], v[104:107], v[60:63]
v_mfma_f32_16x16x32_bf16 v[64:67], v[88:91], v[184:187], v[64:67]
v_mfma_f32_16x16x32_bf16 v[68:71], v[92:95], v[184:187], v[68:71]
ds_read_b128 v[88:91], v7 offset:5120
ds_read_b128 v[92:95], v7 offset:25600
s_waitcnt lgkmcnt(4)
v_mfma_f32_16x16x32_bf16 v[32:35], a[12:15], v[72:75], v[32:35]
v_mfma_f32_16x16x32_bf16 v[36:39], a[12:15], v[76:79], v[36:39]
v_mfma_f32_16x16x32_bf16 v[40:43], a[92:95], v[72:75], v[40:43]
v_mfma_f32_16x16x32_bf16 v[44:47], a[92:95], v[76:79], v[44:47]
v_mfma_f32_16x16x32_bf16 v[48:51], v[72:75], a[172:175], v[48:51]
v_mfma_f32_16x16x32_bf16 v[52:55], v[76:79], a[172:175], v[52:55]
v_mfma_f32_16x16x32_bf16 v[56:59], v[72:75], v[108:111], v[56:59]
v_mfma_f32_16x16x32_bf16 v[60:63], v[76:79], v[108:111], v[60:63]
v_mfma_f32_16x16x32_bf16 v[64:67], v[72:75], v[188:191], v[64:67]
v_mfma_f32_16x16x32_bf16 v[68:71], v[76:79], v[188:191], v[68:71]
ds_read_b128 v[72:75], v7 offset:6144
ds_read_b128 v[76:79], v7 offset:26624
s_waitcnt lgkmcnt(4)
v_mfma_f32_16x16x32_bf16 v[32:35], a[16:19], v[80:83], v[32:35]
v_mfma_f32_16x16x32_bf16 v[36:39], a[16:19], v[84:87], v[36:39]
v_mfma_f32_16x16x32_bf16 v[40:43], a[96:99], v[80:83], v[40:43]
v_mfma_f32_16x16x32_bf16 v[44:47], a[96:99], v[84:87], v[44:47]
v_mfma_f32_16x16x32_bf16 v[48:51], v[80:83], a[176:179], v[48:51]
v_mfma_f32_16x16x32_bf16 v[52:55], v[84:87], a[176:179], v[52:55]
v_mfma_f32_16x16x32_bf16 v[56:59], v[80:83], v[112:115], v[56:59]
v_mfma_f32_16x16x32_bf16 v[60:63], v[84:87], v[112:115], v[60:63]
v_mfma_f32_16x16x32_bf16 v[64:67], v[80:83], v[192:195], v[64:67]
v_mfma_f32_16x16x32_bf16 v[68:71], v[84:87], v[192:195], v[68:71]
ds_read_b128 v[80:83], v7 offset:7168
ds_read_b128 v[84:87], v7 offset:27648
s_waitcnt lgkmcnt(4)
v_mfma_f32_16x16x32_bf16 v[32:35], a[20:23], v[88:91], v[32:35]
v_mfma_f32_16x16x32_bf16 v[36:39], a[20:23], v[92:95], v[36:39]
v_mfma_f32_16x16x32_bf16 v[40:43], a[100:103], v[88:91], v[40:43]
v_mfma_f32_16x16x32_bf16 v[44:47], a[100:103], v[92:95], v[44:47]
v_mfma_f32_16x16x32_bf16 v[48:51], v[88:91], a[180:183], v[48:51]
v_mfma_f32_16x16x32_bf16 v[52:55], v[92:95], a[180:183], v[52:55]
v_mfma_f32_16x16x32_bf16 v[56:59], v[88:91], v[116:119], v[56:59]
v_mfma_f32_16x16x32_bf16 v[60:63], v[92:95], v[116:119], v[60:63]
v_mfma_f32_16x16x32_bf16 v[64:67], v[88:91], v[196:199], v[64:67]
v_mfma_f32_16x16x32_bf16 v[68:71], v[92:95], v[196:199], v[68:71]
ds_read_b128 v[88:91], v7 offset:8192
ds_read_b128 v[92:95], v7 offset:28672
s_waitcnt lgkmcnt(4)
v_mfma_f32_16x16x32_bf16 v[32:35], a[24:27], v[72:75], v[32:35]
v_mfma_f32_16x16x32_bf16 v[36:39], a[24:27], v[76:79], v[36:39]
v_mfma_f32_16x16x32_bf16 v[40:43], a[104:107], v[72:75], v[40:43]
v_mfma_f32_16x16x32_bf16 v[44:47], a[104:107], v[76:79], v[44:47]
v_mfma_f32_16x16x32_bf16 v[48:51], v[72:75], a[184:187], v[48:51]
v_mfma_f32_16x16x32_bf16 v[52:55], v[76:79], a[184:187], v[52:55]
v_mfma_f32_16x16x32_bf16 v[56:59], v[72:75], v[120:123], v[56:59]
v_mfma_f32_16x16x32_bf16 v[60:63], v[76:79], v[120:123], v[60:63]
v_mfma_f32_16x16x32_bf16 v[64:67], v[72:75], v[200:203], v[64:67]
v_mfma_f32_16x16x32_bf16 v[68:71], v[76:79], v[200:203], v[68:71]
ds_read_b128 v[72:75], v7 offset:9216
ds_read_b128 v[76:79], v7 offset:29696
s_waitcnt lgkmcnt(4)
v_mfma_f32_16x16x32_bf16 v[32:35], a[28:31], v[80:83], v[32:35]
v_mfma_f32_16x16x32_bf16 v[36:39], a[28:31], v[84:87], v[36:39]
v_mfma_f32_16x16x32_bf16 v[40:43], a[108:111], v[80:83], v[40:43]
v_mfma_f32_16x16x32_bf16 v[44:47], a[108:111], v[84:87], v[44:47]
v_mfma_f32_16x16x32_bf16 v[48:51], v[80:83], a[188:191], v[48:51]
v_mfma_f32_16x16x32_bf16 v[52:55], v[84:87], a[188:191], v[52:55]
v_mfma_f32_16x16x32_bf16 v[56:59], v[80:83], v[124:127], v[56:59]
v_mfma_f32_16x16x32_bf16 v[60:63], v[84:87], v[124:127], v[60:63]
v_mfma_f32_16x16x32_bf16 v[64:67], v[80:83], v[204:207], v[64:67]
v_mfma_f32_16x16x32_bf16 v[68:71], v[84:87], v[204:207], v[68:71]
ds_read_b128 v[80:83], v7 offset:10240
ds_read_b128 v[84:87], v7 offset:30720
s_waitcnt lgkmcnt(4)
v_mfma_f32_16x16x32_bf16 v[32:35], a[32:35], v[88:91], v[32:35]
v_mfma_f32_16x16x32_bf16 v[36:39], a[32:35], v[92:95], v[36:39]
v_mfma_f32_16x16x32_bf16 v[40:43], a[112:115], v[88:91], v[40:43]
v_mfma_f32_16x16x32_bf16 v[44:47], a[112:115], v[92:95], v[44:47]
v_mfma_f32_16x16x32_bf16 v[48:51], v[88:91], a[192:195], v[48:51]
v_mfma_f32_16x16x32_bf16 v[52:55], v[92:95], a[192:195], v[52:55]
v_mfma_f32_16x16x32_bf16 v[56:59], v[88:91], v[128:131], v[56:59]
v_mfma_f32_16x16x32_bf16 v[60:63], v[92:95], v[128:131], v[60:63]
v_mfma_f32_16x16x32_bf16 v[64:67], v[88:91], v[208:211], v[64:67]
v_mfma_f32_16x16x32_bf16 v[68:71], v[92:95], v[208:211], v[68:71]
ds_read_b128 v[88:91], v7 offset:11264
ds_read_b128 v[92:95], v7 offset:31744
s_waitcnt lgkmcnt(4)
v_mfma_f32_16x16x32_bf16 v[32:35], a[36:39], v[72:75], v[32:35]
v_mfma_f32_16x16x32_bf16 v[36:39], a[36:39], v[76:79], v[36:39]
v_mfma_f32_16x16x32_bf16 v[40:43], a[116:119], v[72:75], v[40:43]
v_mfma_f32_16x16x32_bf16 v[44:47], a[116:119], v[76:79], v[44:47]
v_mfma_f32_16x16x32_bf16 v[48:51], v[72:75], a[196:199], v[48:51]
v_mfma_f32_16x16x32_bf16 v[52:55], v[76:79], a[196:199], v[52:55]
v_mfma_f32_16x16x32_bf16 v[56:59], v[72:75], v[132:135], v[56:59]
v_mfma_f32_16x16x32_bf16 v[60:63], v[76:79], v[132:135], v[60:63]
v_mfma_f32_16x16x32_bf16 v[64:67], v[72:75], v[212:215], v[64:67]
v_mfma_f32_16x16x32_bf16 v[68:71], v[76:79], v[212:215], v[68:71]
ds_read_b128 v[72:75], v7 offset:12288
ds_read_b128 v[76:79], v7 offset:32768
s_waitcnt lgkmcnt(4)
v_mfma_f32_16x16x32_bf16 v[32:35], a[40:43], v[80:83], v[32:35]
v_mfma_f32_16x16x32_bf16 v[36:39], a[40:43], v[84:87], v[36:39]
v_mfma_f32_16x16x32_bf16 v[40:43], a[120:123], v[80:83], v[40:43]
v_mfma_f32_16x16x32_bf16 v[44:47], a[120:123], v[84:87], v[44:47]
v_mfma_f32_16x16x32_bf16 v[48:51], v[80:83], a[200:203], v[48:51]
v_mfma_f32_16x16x32_bf16 v[52:55], v[84:87], a[200:203], v[52:55]
v_mfma_f32_16x16x32_bf16 v[56:59], v[80:83], v[136:139], v[56:59]
v_mfma_f32_16x16x32_bf16 v[60:63], v[84:87], v[136:139], v[60:63]
v_mfma_f32_16x16x32_bf16 v[64:67], v[80:83], v[216:219], v[64:67]
v_mfma_f32_16x16x32_bf16 v[68:71], v[84:87], v[216:219], v[68:71]
ds_read_b128 v[80:83], v7 offset:13312
ds_read_b128 v[84:87], v7 offset:33792
s_waitcnt lgkmcnt(4)
v_mfma_f32_16x16x32_bf16 v[32:35], a[44:47], v[88:91], v[32:35]
v_mfma_f32_16x16x32_bf16 v[36:39], a[44:47], v[92:95], v[36:39]
v_mfma_f32_16x16x32_bf16 v[40:43], a[124:127], v[88:91], v[40:43]
v_mfma_f32_16x16x32_bf16 v[44:47], a[124:127], v[92:95], v[44:47]
v_mfma_f32_16x16x32_bf16 v[48:51], v[88:91], a[204:207], v[48:51]
v_mfma_f32_16x16x32_bf16 v[52:55], v[92:95], a[204:207], v[52:55]
v_mfma_f32_16x16x32_bf16 v[56:59], v[88:91], v[140:143], v[56:59]
v_mfma_f32_16x16x32_bf16 v[60:63], v[92:95], v[140:143], v[60:63]
v_mfma_f32_16x16x32_bf16 v[64:67], v[88:91], v[220:223], v[64:67]
v_mfma_f32_16x16x32_bf16 v[68:71], v[92:95], v[220:223], v[68:71]
ds_read_b128 v[88:91], v7 offset:14336
ds_read_b128 v[92:95], v7 offset:34816
s_waitcnt lgkmcnt(4)
v_mfma_f32_16x16x32_bf16 v[32:35], a[48:51], v[72:75], v[32:35]
v_mfma_f32_16x16x32_bf16 v[36:39], a[48:51], v[76:79], v[36:39]
v_mfma_f32_16x16x32_bf16 v[40:43], a[128:131], v[72:75], v[40:43]
v_mfma_f32_16x16x32_bf16 v[44:47], a[128:131], v[76:79], v[44:47]
v_mfma_f32_16x16x32_bf16 v[48:51], v[72:75], a[208:211], v[48:51]
v_mfma_f32_16x16x32_bf16 v[52:55], v[76:79], a[208:211], v[52:55]
v_mfma_f32_16x16x32_bf16 v[56:59], v[72:75], v[144:147], v[56:59]
v_mfma_f32_16x16x32_bf16 v[60:63], v[76:79], v[144:147], v[60:63]
v_mfma_f32_16x16x32_bf16 v[64:67], v[72:75], v[224:227], v[64:67]
v_mfma_f32_16x16x32_bf16 v[68:71], v[76:79], v[224:227], v[68:71]
ds_read_b128 v[72:75], v7 offset:15360
ds_read_b128 v[76:79], v7 offset:35840
s_waitcnt lgkmcnt(4)
v_mfma_f32_16x16x32_bf16 v[32:35], a[52:55], v[80:83], v[32:35]
v_mfma_f32_16x16x32_bf16 v[36:39], a[52:55], v[84:87], v[36:39]
v_mfma_f32_16x16x32_bf16 v[40:43], a[132:135], v[80:83], v[40:43]
v_mfma_f32_16x16x32_bf16 v[44:47], a[132:135], v[84:87], v[44:47]
v_mfma_f32_16x16x32_bf16 v[48:51], v[80:83], a[212:215], v[48:51]
v_mfma_f32_16x16x32_bf16 v[52:55], v[84:87], a[212:215], v[52:55]
v_mfma_f32_16x16x32_bf16 v[56:59], v[80:83], v[148:151], v[56:59]
v_mfma_f32_16x16x32_bf16 v[60:63], v[84:87], v[148:151], v[60:63]
v_mfma_f32_16x16x32_bf16 v[64:67], v[80:83], v[228:231], v[64:67]
v_mfma_f32_16x16x32_bf16 v[68:71], v[84:87], v[228:231], v[68:71]
ds_read_b128 v[80:83], v7 offset:16384
ds_read_b128 v[84:87], v7 offset:36864
s_waitcnt lgkmcnt(4)
v_mfma_f32_16x16x32_bf16 v[32:35], a[56:59], v[88:91], v[32:35]
v_mfma_f32_16x16x32_bf16 v[36:39], a[56:59], v[92:95], v[36:39]
v_mfma_f32_16x16x32_bf16 v[40:43], a[136:139], v[88:91], v[40:43]
v_mfma_f32_16x16x32_bf16 v[44:47], a[136:139], v[92:95], v[44:47]
v_mfma_f32_16x16x32_bf16 v[48:51], v[88:91], a[216:219], v[48:51]
v_mfma_f32_16x16x32_bf16 v[52:55], v[92:95], a[216:219], v[52:55]
v_mfma_f32_16x16x32_bf16 v[56:59], v[88:91], v[152:155], v[56:59]
v_mfma_f32_16x16x32_bf16 v[60:63], v[92:95], v[152:155], v[60:63]
v_mfma_f32_16x16x32_bf16 v[64:67], v[88:91], v[232:235], v[64:67]
v_mfma_f32_16x16x32_bf16 v[68:71], v[92:95], v[232:235], v[68:71]
ds_read_b128 v[88:91], v7 offset:17408
ds_read_b128 v[92:95], v7 offset:37888
s_waitcnt lgkmcnt(4)
v_mfma_f32_16x16x32_bf16 v[32:35], a[60:63], v[72:75], v[32:35]
v_mfma_f32_16x16x32_bf16 v[36:39], a[60:63], v[76:79], v[36:39]
v_mfma_f32_16x16x32_bf16 v[40:43], a[140:143], v[72:75], v[40:43]
v_mfma_f32_16x16x32_bf16 v[44:47], a[140:143], v[76:79], v[44:47]
v_mfma_f32_16x16x32_bf16 v[48:51], v[72:75], a[220:223], v[48:51]
v_mfma_f32_16x16x32_bf16 v[52:55], v[76:79], a[220:223], v[52:55]
v_mfma_f32_16x16x32_bf16 v[56:59], v[72:75], v[156:159], v[56:59]
v_mfma_f32_16x16x32_bf16 v[60:63], v[76:79], v[156:159], v[60:63]
v_mfma_f32_16x16x32_bf16 v[64:67], v[72:75], v[236:239], v[64:67]
v_mfma_f32_16x16x32_bf16 v[68:71], v[76:79], v[236:239], v[68:71]
ds_read_b128 v[72:75], v7 offset:18432
ds_read_b128 v[76:79], v7 offset:38912
s_waitcnt lgkmcnt(4)
v_mfma_f32_16x16x32_bf16 v[32:35], a[64:67], v[80:83], v[32:35]
v_mfma_f32_16x16x32_bf16 v[36:39], a[64:67], v[84:87], v[36:39]
v_mfma_f32_16x16x32_bf16 v[40:43], a[144:147], v[80:83], v[40:43]
v_mfma_f32_16x16x32_bf16 v[44:47], a[144:147], v[84:87], v[44:47]
v_mfma_f32_16x16x32_bf16 v[48:51], v[80:83], a[224:227], v[48:51]
v_mfma_f32_16x16x32_bf16 v[52:55], v[84:87], a[224:227], v[52:55]
v_mfma_f32_16x16x32_bf16 v[56:59], v[80:83], v[160:163], v[56:59]
v_mfma_f32_16x16x32_bf16 v[60:63], v[84:87], v[160:163], v[60:63]
v_mfma_f32_16x16x32_bf16 v[64:67], v[80:83], v[240:243], v[64:67]
v_mfma_f32_16x16x32_bf16 v[68:71], v[84:87], v[240:243], v[68:71]
ds_read_b128 v[80:83], v7 offset:19456
ds_read_b128 v[84:87], v7 offset:39936
s_waitcnt lgkmcnt(4)
v_mfma_f32_16x16x32_bf16 v[32:35], a[68:71], v[88:91], v[32:35]
v_mfma_f32_16x16x32_bf16 v[36:39], a[68:71], v[92:95], v[36:39]
v_mfma_f32_16x16x32_bf16 v[40:43], a[148:151], v[88:91], v[40:43]
v_mfma_f32_16x16x32_bf16 v[44:47], a[148:151], v[92:95], v[44:47]
v_mfma_f32_16x16x32_bf16 v[48:51], v[88:91], a[228:231], v[48:51]
v_mfma_f32_16x16x32_bf16 v[52:55], v[92:95], a[228:231], v[52:55]
v_mfma_f32_16x16x32_bf16 v[56:59], v[88:91], v[164:167], v[56:59]
v_mfma_f32_16x16x32_bf16 v[60:63], v[92:95], v[164:167], v[60:63]
v_mfma_f32_16x16x32_bf16 v[64:67], v[88:91], v[244:247], v[64:67]
v_mfma_f32_16x16x32_bf16 v[68:71], v[92:95], v[244:247], v[68:71]
s_waitcnt lgkmcnt(2)
v_mfma_f32_16x16x32_bf16 v[32:35], a[72:75], v[72:75], v[32:35]
v_mfma_f32_16x16x32_bf16 v[36:39], a[72:75], v[76:79], v[36:39]
v_mfma_f32_16x16x32_bf16 v[40:43], a[152:155], v[72:75], v[40:43]
v_mfma_f32_16x16x32_bf16 v[44:47], a[152:155], v[76:79], v[44:47]
v_mfma_f32_16x16x32_bf16 v[48:51], v[72:75], a[232:235], v[48:51]
v_mfma_f32_16x16x32_bf16 v[52:55], v[76:79], a[232:235], v[52:55]
v_mfma_f32_16x16x32_bf16 v[56:59], v[72:75], v[168:171], v[56:59]
v_mfma_f32_16x16x32_bf16 v[60:63], v[76:79], v[168:171], v[60:63]
v_mfma_f32_16x16x32_bf16 v[64:67], v[72:75], v[248:251], v[64:67]
v_mfma_f32_16x16x32_bf16 v[68:71], v[76:79], v[248:251], v[68:71]
s_waitcnt lgkmcnt(0)
v_mfma_f32_16x16x32_bf16 v[32:35], a[76:79], v[80:83], v[32:35]
v_mfma_f32_16x16x32_bf16 v[36:39], a[76:79], v[84:87], v[36:39]
v_mfma_f32_16x16x32_bf16 v[40:43], a[156:159], v[80:83], v[40:43]
v_mfma_f32_16x16x32_bf16 v[44:47], a[156:159], v[84:87], v[44:47]
v_mfma_f32_16x16x32_bf16 v[48:51], v[80:83], a[236:239], v[48:51]
v_mfma_f32_16x16x32_bf16 v[52:55], v[84:87], a[236:239], v[52:55]
v_mfma_f32_16x16x32_bf16 v[56:59], v[80:83], v[172:175], v[56:59]
v_mfma_f32_16x16x32_bf16 v[60:63], v[84:87], v[172:175], v[60:63]
v_mfma_f32_16x16x32_bf16 v[64:67], v[80:83], v[252:255], v[64:67]
v_mfma_f32_16x16x32_bf16 v[68:71], v[84:87], v[252:255], v[68:71]
v_cvt_pk_bf16_f32 v8, v32, v33
v_cvt_pk_bf16_f32 v9, v34, v35
v_cvt_pk_bf16_f32 v10, v40, v41
v_cvt_pk_bf16_f32 v11, v42, v43
s_add_u32 s34, s21, 2048
buffer_store_dwordx4 v[8:11], v1, s[4:7], s34 offen sc1
v_cvt_pk_bf16_f32 v12, v36, v37
v_cvt_pk_bf16_f32 v13, v38, v39
v_cvt_pk_bf16_f32 v14, v44, v45
v_cvt_pk_bf16_f32 v15, v46, v47
s_add_u32 s34, s21, 8192
buffer_store_dwordx4 v[12:15], v1, s[4:7], s34 offen sc1
v_cvt_pk_bf16_f32 v8, v48, v49
v_cvt_pk_bf16_f32 v9, v50, v51
v_cvt_pk_bf16_f32 v10, v52, v53
v_cvt_pk_bf16_f32 v11, v54, v55
s_add_u32 s34, s23, 1024
buffer_store_dwordx4 v[8:11], v1, s[4:7], s34 offen sc1
v_cvt_pk_bf16_f32 v12, v56, v57
v_cvt_pk_bf16_f32 v13, v58, v59
v_cvt_pk_bf16_f32 v14, v60, v61
v_cvt_pk_bf16_f32 v15, v62, v63
s_add_u32 s34, s23, 2048
buffer_store_dwordx4 v[12:15], v1, s[4:7], s34 offen sc1
v_cvt_pk_bf16_f32 v8, v64, v65
v_cvt_pk_bf16_f32 v9, v66, v67
v_cvt_pk_bf16_f32 v10, v68, v69
v_cvt_pk_bf16_f32 v11, v70, v71
s_add_u32 s34, s23, 3072
buffer_store_dwordx4 v[8:11], v1, s[4:7], s34 offen sc1
s_waitcnt vmcnt(0)
s_barrier
s_add_u32 s17, s17, 1
s_cmp_lt_u32 s17, 64
s_cbranch_scc1 reca_ptop251
s_branch reca_exit1
reca_pw2_228:
s_mov_b32 s17, 0
s_mov_b32 s26, 0
s_mul_i32 s20, s17, 40960
s_add_u32 s20, s20, 84955136
s_add_u32 m0, s26, 20480
s_nop 0
buffer_load_dwordx4 v1, s[4:7], s20 offen offset:0 lds
buffer_load_dwordx4 v1, s[4:7], s20 offen offset:1024 lds
buffer_load_dwordx4 v1, s[4:7], s20 offen offset:2048 lds
buffer_load_dwordx4 v1, s[4:7], s20 offen offset:3072 lds
s_add_u32 s20, s20, 4096
s_add_u32 m0, s26, 24576
s_nop 0
buffer_load_dwordx4 v1, s[4:7], s20 offen offset:0 lds
buffer_load_dwordx4 v1, s[4:7], s20 offen offset:1024 lds
buffer_load_dwordx4 v1, s[4:7], s20 offen offset:2048 lds
buffer_load_dwordx4 v1, s[4:7], s20 offen offset:3072 lds
s_add_u32 s20, s20, 4096
s_add_u32 m0, s26, 28672
s_nop 0
buffer_load_dwordx4 v1, s[4:7], s20 offen offset:0 lds
buffer_load_dwordx4 v1, s[4:7], s20 offen offset:1024 lds
s_mul_i32 s34, s15, 12
s_mul_i32 s35, s16, 6
s_add_u32 s34, s34, s35
s_add_u32 s34, s34, 0
s_mul_i32 s34, s34, 20480
s_add_u32 s34, s34, 6291456
buffer_load_dwordx4 a[0:3], v1, s[4:7], s34 offen offset:0
buffer_load_dwordx4 a[4:7], v1, s[4:7], s34 offen offset:1024
buffer_load_dwordx4 a[8:11], v1, s[4:7], s34 offen offset:2048
buffer_load_dwordx4 a[12:15], v1, s[4:7], s34 offen offset:3072
s_add_u32 s34, s34, 4096
buffer_load_dwordx4 a[16:19], v1, s[4:7], s34 offen offset:0
buffer_load_dwordx4 a[20:23], v1, s[4:7], s34 offen offset:1024
buffer_load_dwordx4 a[24:27], v1, s[4:7], s34 offen offset:2048
buffer_load_dwordx4 a[28:31], v1, s[4:7], s34 offen offset:3072
s_add_u32 s34, s34, 4096
buffer_load_dwordx4 a[32:35], v1, s[4:7], s34 offen offset:0
buffer_load_dwordx4 a[36:39], v1, s[4:7], s34 offen offset:1024
buffer_load_dwordx4 a[40:43], v1, s[4:7], s34 offen offset:2048
buffer_load_dwordx4 a[44:47], v1, s[4:7], s34 offen offset:3072
s_add_u32 s34, s34, 4096
buffer_load_dwordx4 a[48:51], v1, s[4:7], s34 offen offset:0
buffer_load_dwordx4 a[52:55], v1, s[4:7], s34 offen offset:1024
buffer_load_dwordx4 a[56:59], v1, s[4:7], s34 offen offset:2048
buffer_load_dwordx4 a[60:63], v1, s[4:7], s34 offen offset:3072
s_add_u32 s34, s34, 4096
buffer_load_dwordx4 a[64:67], v1, s[4:7], s34 offen offset:0
buffer_load_dwordx4 a[68:71], v1, s[4:7], s34 offen offset:1024
buffer_load_dwordx4 a[72:75], v1, s[4:7], s34 offen offset:2048
buffer_load_dwordx4 a[76:79], v1, s[4:7], s34 offen offset:3072
s_mul_i32 s34, s15, 12
s_mul_i32 s35, s16, 6
s_add_u32 s34, s34, s35
s_add_u32 s34, s34, 1
s_mul_i32 s34, s34, 20480
s_add_u32 s34, s34, 6291456
buffer_load_dwordx4 a[80:83], v1, s[4:7], s34 offen offset:0
buffer_load_dwordx4 a[84:87], v1, s[4:7], s34 offen offset:1024
buffer_load_dwordx4 a[88:91], v1, s[4:7], s34 offen offset:2048
buffer_load_dwordx4 a[92:95], v1, s[4:7], s34 offen offset:3072
s_add_u32 s34, s34, 4096
buffer_load_dwordx4 a[96:99], v1, s[4:7], s34 offen offset:0
buffer_load_dwordx4 a[100:103], v1, s[4:7], s34 offen offset:1024
buffer_load_dwordx4 a[104:107], v1, s[4:7], s34 offen offset:2048
buffer_load_dwordx4 a[108:111], v1, s[4:7], s34 offen offset:3072
s_add_u32 s34, s34, 4096
buffer_load_dwordx4 a[112:115], v1, s[4:7], s34 offen offset:0
buffer_load_dwordx4 a[116:119], v1, s[4:7], s34 offen offset:1024
buffer_load_dwordx4 a[120:123], v1, s[4:7], s34 offen offset:2048
buffer_load_dwordx4 a[124:127], v1, s[4:7], s34 offen offset:3072
s_add_u32 s34, s34, 4096
buffer_load_dwordx4 a[128:131], v1, s[4:7], s34 offen offset:0
buffer_load_dwordx4 a[132:135], v1, s[4:7], s34 offen offset:1024
buffer_load_dwordx4 a[136:139], v1, s[4:7], s34 offen offset:2048
buffer_load_dwordx4 a[140:143], v1, s[4:7], s34 offen offset:3072
s_add_u32 s34, s34, 4096
buffer_load_dwordx4 a[144:147], v1, s[4:7], s34 offen offset:0
buffer_load_dwordx4 a[148:151], v1, s[4:7], s34 offen offset:1024
buffer_load_dwordx4 a[152:155], v1, s[4:7], s34 offen offset:2048
buffer_load_dwordx4 a[156:159], v1, s[4:7], s34 offen offset:3072
s_waitcnt vmcnt(20)
s_mul_i32 s34, s15, 12
s_mul_i32 s35, s16, 6
s_add_u32 s34, s34, s35
s_add_u32 s34, s34, 4
s_mul_i32 s34, s34, 20480
s_add_u32 s34, s34, 22020096
buffer_load_dwordx4 a[160:163], v1, s[4:7], s34 offen offset:0
buffer_load_dwordx4 a[164:167], v1, s[4:7], s34 offen offset:1024
buffer_load_dwordx4 a[168:171], v1, s[4:7], s34 offen offset:2048
buffer_load_dwordx4 a[172:175], v1, s[4:7], s34 offen offset:3072
s_add_u32 s34, s34, 4096
buffer_load_dwordx4 a[176:179], v1, s[4:7], s34 offen offset:0
buffer_load_dwordx4 a[180:183], v1, s[4:7], s34 offen offset:1024
buffer_load_dwordx4 a[184:187], v1, s[4:7], s34 offen offset:2048
buffer_load_dwordx4 a[188:191], v1, s[4:7], s34 offen offset:3072
s_add_u32 s34, s34, 4096
buffer_load_dwordx4 a[192:195], v1, s[4:7], s34 offen offset:0
buffer_load_dwordx4 a[196:199], v1, s[4:7], s34 offen offset:1024
buffer_load_dwordx4 a[200:203], v1, s[4:7], s34 offen offset:2048
buffer_load_dwordx4 a[204:207], v1, s[4:7], s34 offen offset:3072
s_add_u32 s34, s34, 4096
buffer_load_dwordx4 a[208:211], v1, s[4:7], s34 offen offset:0
buffer_load_dwordx4 a[212:215], v1, s[4:7], s34 offen offset:1024
buffer_load_dwordx4 a[216:219], v1, s[4:7], s34 offen offset:2048
buffer_load_dwordx4 a[220:223], v1, s[4:7], s34 offen offset:3072
s_add_u32 s34, s34, 4096
buffer_load_dwordx4 a[224:227], v1, s[4:7], s34 offen offset:0
buffer_load_dwordx4 a[228:231], v1, s[4:7], s34 offen offset:1024
buffer_load_dwordx4 a[232:235], v1, s[4:7], s34 offen offset:2048
buffer_load_dwordx4 a[236:239], v1, s[4:7], s34 offen offset:3072
s_waitcnt vmcnt(20)
s_mul_i32 s34, s15, 12
s_mul_i32 s35, s16, 6
s_add_u32 s34, s34, s35
s_add_u32 s34, s34, 5
s_mul_i32 s34, s34, 20480
s_add_u32 s34, s34, 22020096
buffer_load_dwordx4 v[96:99], v1, s[4:7], s34 offen offset:0
buffer_load_dwordx4 v[100:103], v1, s[4:7], s34 offen offset:1024
buffer_load_dwordx4 v[104:107], v1, s[4:7], s34 offen offset:2048
buffer_load_dwordx4 v[108:111], v1, s[4:7], s34 offen offset:3072
s_add_u32 s34, s34, 4096
buffer_load_dwordx4 v[112:115], v1, s[4:7], s34 offen offset:0
buffer_load_dwordx4 v[116:119], v1, s[4:7], s34 offen offset:1024
buffer_load_dwordx4 v[120:123], v1, s[4:7], s34 offen offset:2048
buffer_load_dwordx4 v[124:127], v1, s[4:7], s34 offen offset:3072
s_add_u32 s34, s34, 4096
buffer_load_dwordx4 v[128:131], v1, s[4:7], s34 offen offset:0
buffer_load_dwordx4 v[132:135], v1, s[4:7], s34 offen offset:1024
buffer_load_dwordx4 v[136:139], v1, s[4:7], s34 offen offset:2048
buffer_load_dwordx4 v[140:143], v1, s[4:7], s34 offen offset:3072
s_add_u32 s34, s34, 4096
buffer_load_dwordx4 v[144:147], v1, s[4:7], s34 offen offset:0
buffer_load_dwordx4 v[148:151], v1, s[4:7], s34 offen offset:1024
buffer_load_dwordx4 v[152:155], v1, s[4:7], s34 offen offset:2048
buffer_load_dwordx4 v[156:159], v1, s[4:7], s34 offen offset:3072
s_add_u32 s34, s34, 4096
buffer_load_dwordx4 v[160:163], v1, s[4:7], s34 offen offset:0
buffer_load_dwordx4 v[164:167], v1, s[4:7], s34 offen offset:1024
buffer_load_dwordx4 v[168:171], v1, s[4:7], s34 offen offset:2048
buffer_load_dwordx4 v[172:175], v1, s[4:7], s34 offen offset:3072
s_waitcnt vmcnt(20)
v_and_b32 v30, 7, v0
v_lshlrev_b32 v30, 3, v30
reca_cens256:
buffer_load_dwordx2 v[28:29], v30, s[8:11], 0 offen sc1
s_waitcnt vmcnt(0)
v_sad_u8 v31, v28, 0, 0
v_sad_u8 v31, v29, 0, v31
v_cmp_gt_u32 vcc, 32, v31
s_cbranch_vccz reca_censok257
s_sleep 8
s_sub_u32 s18, s18, 1
s_cbranch_scc0 reca_cens256
s_mov_b32 s18, 0
reca_censok257:
v_and_b32 v28, 0x20202020, v28
v_and_b32 v29, 0x20202020, v29
v_cmp_ne_u32 s[34:35], 0, v28
v_cmp_ne_u32 s[36:37], 0, v29
s_nop 3
s_and_b32 s34, s34, 0xff
s_and_b32 s36, s36, 0xff
s_or_b32 s35, s34, s36
s_lshr_b32 s37, s35, s13
s_and_b32 s37, s37, 1
s_xor_b32 s43, s37, 1
s_cmp_eq_u32 s57, 0
s_cselect_b32 s58, s36, s34
v_mov_b32 v31, 0x80000000
s_cmp_lg_u32 s43, 0
s_cbranch_scc1 reca_pslow258
reca_ptop259:
s_cmp_lt_u32 s17, 3
s_cbranch_scc1 reca_pgo260
s_sub_u32 s36, s17, 3
reca_ppoll261:
buffer_load_dword v28, v4, s[4:7], s25 offen sc1
s_waitcnt vmcnt(0)
v_readfirstlane_b32 s34, v28
s_nop 3
s_cmp_ge_i32 s34, s36
s_cbranch_scc1 reca_pgo260
s_sleep 8
s_sub_u32 s18, s18, 1
s_cbranch_scc0 reca_ppoll261
s_mov_b32 s18, 0
reca_pgo260:
s_waitcnt vmcnt(0)
s_barrier
v_add_u32 v7, s26, v1
s_xor_b32 s26, s26, 40960
s_add_u32 s37, s17, 1
s_cmp_ge_u32 s37, 64
s_cbranch_scc1 reca_pnodma262
s_mul_i32 s20, s37, 40960
s_add_u32 s20, s20, 84955136
s_add_u32 m0, s26, 20480
s_nop 0
buffer_load_dwordx4 v1, s[4:7], s20 offen offset:0 lds
buffer_load_dwordx4 v1, s[4:7], s20 offen offset:1024 lds
buffer_load_dwordx4 v1, s[4:7], s20 offen offset:2048 lds
buffer_load_dwordx4 v1, s[4:7], s20 offen offset:3072 lds
s_add_u32 s20, s20, 4096
s_add_u32 m0, s26, 24576
s_nop 0
buffer_load_dwordx4 v1, s[4:7], s20 offen offset:0 lds
buffer_load_dwordx4 v1, s[4:7], s20 offen offset:1024 lds
buffer_load_dwordx4 v1, s[4:7], s20 offen offset:2048 lds
buffer_load_dwordx4 v1, s[4:7], s20 offen offset:3072 lds
s_add_u32 s20, s20, 4096
s_add_u32 m0, s26, 28672
s_nop 0
buffer_load_dwordx4 v1, s[4:7], s20 offen offset:0 lds
buffer_load_dwordx4 v1, s[4:7], s20 offen offset:1024 lds
reca_pnodma262:
s_lshl_b32 s34, s15, 3
s_and_b32 s35, s17, 7
s_add_u32 s34, s34, s35
s_mul_i32 s34, s34, 12288
s_mul_i32 s35, s16, 3072
s_add_u32 s35, s35, s34
s_add_u32 s21, s35, 37748736
s_add_u32 s22, s35, 44040192
s_mul_i32 s35, s16, 6144
s_add_u32 s35, s35, s34
s_add_u32 s23, s35, 40894464
ds_read_b128 v[72:75], v7 offset:0
ds_read_b128 v[76:79], v7 offset:20480
ds_read_b128 v[80:83], v7 offset:1024
ds_read_b128 v[84:87], v7 offset:21504
ds_read_b128 v[88:91], v7 offset:2048
ds_read_b128 v[92:95], v7 offset:22528
s_waitcnt lgkmcnt(4)
v_mfma_f32_16x16x32_bf16 v[32:35], a[0:3], v[72:75], 0
v_mfma_f32_16x16x32_bf16 v[36:39], a[0:3], v[76:79], 0
v_mfma_f32_16x16x32_bf16 v[40:43], a[80:83], v[72:75], 0
v_mfma_f32_16x16x32_bf16 v[44:47], a[80:83], v[76:79], 0
v_mfma_f32_16x16x32_bf16 v[48:51], v[72:75], a[160:163], 0
v_mfma_f32_16x16x32_bf16 v[52:55], v[76:79], a[160:163], 0
v_mfma_f32_16x16x32_bf16 v[56:59], v[72:75], v[96:99], 0
v_mfma_f32_16x16x32_bf16 v[60:63], v[76:79], v[96:99], 0
ds_read_b128 v[72:75], v7 offset:3072
ds_read_b128 v[76:79], v7 offset:23552
s_waitcnt lgkmcnt(4)
v_mfma_f32_16x16x32_bf16 v[32:35], a[4:7], v[80:83], v[32:35]
v_mfma_f32_16x16x32_bf16 v[36:39], a[4:7], v[84:87], v[36:39]
v_mfma_f32_16x16x32_bf16 v[40:43], a[84:87], v[80:83], v[40:43]
v_mfma_f32_16x16x32_bf16 v[44:47], a[84:87], v[84:87], v[44:47]
v_mfma_f32_16x16x32_bf16 v[48:51], v[80:83], a[164:167], v[48:51]
v_mfma_f32_16x16x32_bf16 v[52:55], v[84:87], a[164:167], v[52:55]
v_mfma_f32_16x16x32_bf16 v[56:59], v[80:83], v[100:103], v[56:59]
v_mfma_f32_16x16x32_bf16 v[60:63], v[84:87], v[100:103], v[60:63]
ds_read_b128 v[80:83], v7 offset:4096
ds_read_b128 v[84:87], v7 offset:24576
s_waitcnt lgkmcnt(4)
v_mfma_f32_16x16x32_bf16 v[32:35], a[8:11], v[88:91], v[32:35]
v_mfma_f32_16x16x32_bf16 v[36:39], a[8:11], v[92:95], v[36:39]
v_mfma_f32_16x16x32_bf16 v[40:43], a[88:91], v[88:91], v[40:43]
v_mfma_f32_16x16x32_bf16 v[44:47], a[88:91], v[92:95], v[44:47]
v_mfma_f32_16x16x32_bf16 v[48:51], v[88:91], a[168:171], v[48:51]
v_mfma_f32_16x16x32_bf16 v[52:55], v[92:95], a[168:171], v[52:55]
v_mfma_f32_16x16x32_bf16 v[56:59], v[88:91], v[104:107], v[56:59]
v_mfma_f32_16x16x32_bf16 v[60:63], v[92:95], v[104:107], v[60:63]
ds_read_b128 v[88:91], v7 offset:5120
ds_read_b128 v[92:95], v7 offset:25600
s_waitcnt lgkmcnt(4)
v_mfma_f32_16x16x32_bf16 v[32:35], a[12:15], v[72:75], v[32:35]
v_mfma_f32_16x16x32_bf16 v[36:39], a[12:15], v[76:79], v[36:39]
v_mfma_f32_16x16x32_bf16 v[40:43], a[92:95], v[72:75], v[40:43]
v_mfma_f32_16x16x32_bf16 v[44:47], a[92:95], v[76:79], v[44:47]
v_mfma_f32_16x16x32_bf16 v[48:51], v[72:75], a[172:175], v[48:51]
v_mfma_f32_16x16x32_bf16 v[52:55], v[76:79], a[172:175], v[52:55]
v_mfma_f32_16x16x32_bf16 v[56:59], v[72:75], v[108:111], v[56:59]
v_mfma_f32_16x16x32_bf16 v[60:63], v[76:79], v[108:111], v[60:63]
ds_read_b128 v[72:75], v7 offset:6144
ds_read_b128 v[76:79], v7 offset:26624
s_waitcnt lgkmcnt(4)
v_mfma_f32_16x16x32_bf16 v[32:35], a[16:19], v[80:83], v[32:35]
v_mfma_f32_16x16x32_bf16 v[36:39], a[16:19], v[84:87], v[36:39]
v_mfma_f32_16x16x32_bf16 v[40:43], a[96:99], v[80:83], v[40:43]
v_mfma_f32_16x16x32_bf16 v[44:47], a[96:99], v[84:87], v[44:47]
v_mfma_f32_16x16x32_bf16 v[48:51], v[80:83], a[176:179], v[48:51]
v_mfma_f32_16x16x32_bf16 v[52:55], v[84:87], a[176:179], v[52:55]
v_mfma_f32_16x16x32_bf16 v[56:59], v[80:83], v[112:115], v[56:59]
v_mfma_f32_16x16x32_bf16 v[60:63], v[84:87], v[112:115], v[60:63]
ds_read_b128 v[80:83], v7 offset:7168
ds_read_b128 v[84:87], v7 offset:27648
s_waitcnt lgkmcnt(4)
v_mfma_f32_16x16x32_bf16 v[32:35], a[20:23], v[88:91], v[32:35]
v_mfma_f32_16x16x32_bf16 v[36:39], a[20:23], v[92:95], v[36:39]
v_mfma_f32_16x16x32_bf16 v[40:43], a[100:103], v[88:91], v[40:43]
v_mfma_f32_16x16x32_bf16 v[44:47], a[100:103], v[92:95], v[44:47]
v_mfma_f32_16x16x32_bf16 v[48:51], v[88:91], a[180:183], v[48:51]
v_mfma_f32_16x16x32_bf16 v[52:55], v[92:95], a[180:183], v[52:55]
v_mfma_f32_16x16x32_bf16 v[56:59], v[88:91], v[116:119], v[56:59]
v_mfma_f32_16x16x32_bf16 v[60:63], v[92:95], v[116:119], v[60:63]
ds_read_b128 v[88:91], v7 offset:8192
ds_read_b128 v[92:95], v7 offset:28672
s_waitcnt lgkmcnt(4)
v_mfma_f32_16x16x32_bf16 v[32:35], a[24:27], v[72:75], v[32:35]
v_mfma_f32_16x16x32_bf16 v[36:39], a[24:27], v[76:79], v[36:39]
v_mfma_f32_16x16x32_bf16 v[40:43], a[104:107], v[72:75], v[40:43]
v_mfma_f32_16x16x32_bf16 v[44:47], a[104:107], v[76:79], v[44:47]
v_mfma_f32_16x16x32_bf16 v[48:51], v[72:75], a[184:187], v[48:51]
v_mfma_f32_16x16x32_bf16 v[52:55], v[76:79], a[184:187], v[52:55]
v_mfma_f32_16x16x32_bf16 v[56:59], v[72:75], v[120:123], v[56:59]
v_mfma_f32_16x16x32_bf16 v[60:63], v[76:79], v[120:123], v[60:63]
ds_read_b128 v[72:75], v7 offset:9216
ds_read_b128 v[76:79], v7 offset:29696
s_waitcnt lgkmcnt(4)
v_mfma_f32_16x16x32_bf16 v[32:35], a[28:31], v[80:83], v[32:35]
v_mfma_f32_16x16x32_bf16 v[36:39], a[28:31], v[84:87], v[36:39]
v_mfma_f32_16x16x32_bf16 v[40:43], a[108:111], v[80:83], v[40:43]
v_mfma_f32_16x16x32_bf16 v[44:47], a[108:111], v[84:87], v[44:47]
v_mfma_f32_16x16x32_bf16 v[48:51], v[80:83], a[188:191], v[48:51]
v_mfma_f32_16x16x32_bf16 v[52:55], v[84:87], a[188:191], v[52:55]
v_mfma_f32_16x16x32_bf16 v[56:59], v[80:83], v[124:127], v[56:59]
v_mfma_f32_16x16x32_bf16 v[60:63], v[84:87], v[124:127], v[60:63]
ds_read_b128 v[80:83], v7 offset:10240
ds_read_b128 v[84:87], v7 offset:30720
s_waitcnt lgkmcnt(4)
v_mfma_f32_16x16x32_bf16 v[32:35], a[32:35], v[88:91], v[32:35]
v_mfma_f32_16x16x32_bf16 v[36:39], a[32:35], v[92:95], v[36:39]
v_mfma_f32_16x16x32_bf16 v[40:43], a[112:115], v[88:91], v[40:43]
v_mfma_f32_16x16x32_bf16 v[44:47], a[112:115], v[92:95], v[44:47]
v_mfma_f32_16x16x32_bf16 v[48:51], v[88:91], a[192:195], v[48:51]
v_mfma_f32_16x16x32_bf16 v[52:55], v[92:95], a[192:195], v[52:55]
v_mfma_f32_16x16x32_bf16 v[56:59], v[88:91], v[128:131], v[56:59]
v_mfma_f32_16x16x32_bf16 v[60:63], v[92:95], v[128:131], v[60:63]
ds_read_b128 v[88:91], v7 offset:11264
ds_read_b128 v[92:95], v7 offset:31744
s_waitcnt lgkmcnt(4)
v_mfma_f32_16x16x32_bf16 v[32:35], a[36:39], v[72:75], v[32:35]
v_mfma_f32_16x16x32_bf16 v[36:39], a[36:39], v[76:79], v[36:39]
v_mfma_f32_16x16x32_bf16 v[40:43], a[116:119], v[72:75], v[40:43]
v_mfma_f32_16x16x32_bf16 v[44:47], a[116:119], v[76:79], v[44:47]
v_mfma_f32_16x16x32_bf16 v[48:51], v[72:75], a[196:199], v[48:51]
v_mfma_f32_16x16x32_bf16 v[52:55], v[76:79], a[196:199], v[52:55]
v_mfma_f32_16x16x32_bf16 v[56:59], v[72:75], v[132:135], v[56:59]
v_mfma_f32_16x16x32_bf16 v[60:63], v[76:79], v[132:135], v[60:63]
ds_read_b128 v[72:75], v7 offset:12288
ds_read_b128 v[76:79], v7 offset:32768
s_waitcnt lgkmcnt(4)
v_mfma_f32_16x16x32_bf16 v[32:35], a[40:43], v[80:83], v[32:35]
v_mfma_f32_16x16x32_bf16 v[36:39], a[40:43], v[84:87], v[36:39]
v_mfma_f32_16x16x32_bf16 v[40:43], a[120:123], v[80:83], v[40:43]
v_mfma_f32_16x16x32_bf16 v[44:47], a[120:123], v[84:87], v[44:47]
v_mfma_f32_16x16x32_bf16 v[48:51], v[80:83], a[200:203], v[48:51]
v_mfma_f32_16x16x32_bf16 v[52:55], v[84:87], a[200:203], v[52:55]
v_mfma_f32_16x16x32_bf16 v[56:59], v[80:83], v[136:139], v[56:59]
v_mfma_f32_16x16x32_bf16 v[60:63], v[84:87], v[136:139], v[60:63]
ds_read_b128 v[80:83], v7 offset:13312
ds_read_b128 v[84:87], v7 offset:33792
s_waitcnt lgkmcnt(4)
v_mfma_f32_16x16x32_bf16 v[32:35], a[44:47], v[88:91], v[32:35]
v_mfma_f32_16x16x32_bf16 v[36:39], a[44:47], v[92:95], v[36:39]
v_mfma_f32_16x16x32_bf16 v[40:43], a[124:127], v[88:91], v[40:43]
v_mfma_f32_16x16x32_bf16 v[44:47], a[124:127], v[92:95], v[44:47]
v_mfma_f32_16x16x32_bf16 v[48:51], v[88:91], a[204:207], v[48:51]
v_mfma_f32_16x16x32_bf16 v[52:55], v[92:95], a[204:207], v[52:55]
v_mfma_f32_16x16x32_bf16 v[56:59], v[88:91], v[140:143], v[56:59]
v_mfma_f32_16x16x32_bf16 v[60:63], v[92:95], v[140:143], v[60:63]
ds_read_b128 v[88:91], v7 offset:14336
ds_read_b128 v[92:95], v7 offset:34816
s_waitcnt lgkmcnt(4)
v_mfma_f32_16x16x32_bf16 v[32:35], a[48:51], v[72:75], v[32:35]
v_mfma_f32_16x16x32_bf16 v[36:39], a[48:51], v[76:79], v[36:39]
v_mfma_f32_16x16x32_bf16 v[40:43], a[128:131], v[72:75], v[40:43]
v_mfma_f32_16x16x32_bf16 v[44:47], a[128:131], v[76:79], v[44:47]
v_mfma_f32_16x16x32_bf16 v[48:51], v[72:75], a[208:211], v[48:51]
v_mfma_f32_16x16x32_bf16 v[52:55], v[76:79], a[208:211], v[52:55]
v_mfma_f32_16x16x32_bf16 v[56:59], v[72:75], v[144:147], v[56:59]
v_mfma_f32_16x16x32_bf16 v[60:63], v[76:79], v[144:147], v[60:63]
ds_read_b128 v[72:75], v7 offset:15360
ds_read_b128 v[76:79], v7 offset:35840
s_waitcnt lgkmcnt(4)
v_mfma_f32_16x16x32_bf16 v[32:35], a[52:55], v[80:83], v[32:35]
v_mfma_f32_16x16x32_bf16 v[36:39], a[52:55], v[84:87], v[36:39]
v_mfma_f32_16x16x32_bf16 v[40:43], a[132:135], v[80:83], v[40:43]
v_mfma_f32_16x16x32_bf16 v[44:47], a[132:135], v[84:87], v[44:47]
v_mfma_f32_16x16x32_bf16 v[48:51], v[80:83], a[212:215], v[48:51]
v_mfma_f32_16x16x32_bf16 v[52:55], v[84:87], a[212:215], v[52:55]
v_mfma_f32_16x16x32_bf16 v[56:59], v[80:83], v[148:151], v[56:59]
v_mfma_f32_16x16x32_bf16 v[60:63], v[84:87], v[148:151], v[60:63]
ds_read_b128 v[80:83], v7 offset:16384
ds_read_b128 v[84:87], v7 offset:36864
s_waitcnt lgkmcnt(4)
v_mfma_f32_16x16x32_bf16 v[32:35], a[56:59], v[88:91], v[32:35]
v_mfma_f32_16x16x32_bf16 v[36:39], a[56:59], v[92:95], v[36:39]
v_mfma_f32_16x16x32_bf16 v[40:43], a[136:139], v[88:91], v[40:43]
v_mfma_f32_16x16x32_bf16 v[44:47], a[136:139], v[92:95], v[44:47]
v_mfma_f32_16x16x32_bf16 v[48:51], v[88:91], a[216:219], v[48:51]
v_mfma_f32_16x16x32_bf16 v[52:55], v[92:95], a[216:219], v[52:55]
v_mfma_f32_16x16x32_bf16 v[56:59], v[88:91], v[152:155], v[56:59]
v_mfma_f32_16x16x32_bf16 v[60:63], v[92:95], v[152:155], v[60:63]
ds_read_b128 v[88:91], v7 offset:17408
ds_read_b128 v[92:95], v7 offset:37888
s_waitcnt lgkmcnt(4)
v_mfma_f32_16x16x32_bf16 v[32:35], a[60:63], v[72:75], v[32:35]
v_mfma_f32_16x16x32_bf16 v[36:39], a[60:63], v[76:79], v[36:39]
v_mfma_f32_16x16x32_bf16 v[40:43], a[140:143], v[72:75], v[40:43]
v_mfma_f32_16x16x32_bf16 v[44:47], a[140:143], v[76:79], v[44:47]
v_mfma_f32_16x16x32_bf16 v[48:51], v[72:75], a[220:223], v[48:51]
v_mfma_f32_16x16x32_bf16 v[52:55], v[76:79], a[220:223], v[52:55]
v_mfma_f32_16x16x32_bf16 v[56:59], v[72:75], v[156:159], v[56:59]
v_mfma_f32_16x16x32_bf16 v[60:63], v[76:79], v[156:159], v[60:63]
ds_read_b128 v[72:75], v7 offset:18432
ds_read_b128 v[76:79], v7 offset:38912
s_waitcnt lgkmcnt(4)
v_mfma_f32_16x16x32_bf16 v[32:35], a[64:67], v[80:83], v[32:35]
v_mfma_f32_16x16x32_bf16 v[36:39], a[64:67], v[84:87], v[36:39]
v_mfma_f32_16x16x32_bf16 v[40:43], a[144:147], v[80:83], v[40:43]
v_mfma_f32_16x16x32_bf16 v[44:47], a[144:147], v[84:87], v[44:47]
v_mfma_f32_16x16x32_bf16 v[48:51], v[80:83], a[224:227], v[48:51]
v_mfma_f32_16x16x32_bf16 v[52:55], v[84:87], a[224:227], v[52:55]
v_mfma_f32_16x16x32_bf16 v[56:59], v[80:83], v[160:163], v[56:59]
v_mfma_f32_16x16x32_bf16 v[60:63], v[84:87], v[160:163], v[60:63]
ds_read_b128 v[80:83], v7 offset:19456
ds_read_b128 v[84:87], v7 offset:39936
s_waitcnt lgkmcnt(4)
v_mfma_f32_16x16x32_bf16 v[32:35], a[68:71], v[88:91], v[32:35]
v_mfma_f32_16x16x32_bf16 v[36:39], a[68:71], v[92:95], v[36:39]
v_mfma_f32_16x16x32_bf16 v[40:43], a[148:151], v[88:91], v[40:43]
v_mfma_f32_16x16x32_bf16 v[44:47], a[148:151], v[92:95], v[44:47]
v_mfma_f32_16x16x32_bf16 v[48:51], v[88:91], a[228:231], v[48:51]
v_mfma_f32_16x16x32_bf16 v[52:55], v[92:95], a[228:231], v[52:55]
v_mfma_f32_16x16x32_bf16 v[56:59], v[88:91], v[164:167], v[56:59]
v_mfma_f32_16x16x32_bf16 v[60:63], v[92:95], v[164:167], v[60:63]
s_waitcnt lgkmcnt(2)
v_mfma_f32_16x16x32_bf16 v[32:35], a[72:75], v[72:75], v[32:35]
v_mfma_f32_16x16x32_bf16 v[36:39], a[72:75], v[76:79], v[36:39]
v_mfma_f32_16x16x32_bf16 v[40:43], a[152:155], v[72:75], v[40:43]
v_mfma_f32_16x16x32_bf16 v[44:47], a[152:155], v[76:79], v[44:47]
v_mfma_f32_16x16x32_bf16 v[48:51], v[72:75], a[232:235], v[48:51]
v_mfma_f32_16x16x32_bf16 v[52:55], v[76:79], a[232:235], v[52:55]
v_mfma_f32_16x16x32_bf16 v[56:59], v[72:75], v[168:171], v[56:59]
v_mfma_f32_16x16x32_bf16 v[60:63], v[76:79], v[168:171], v[60:63]
s_waitcnt lgkmcnt(0)
v_mfma_f32_16x16x32_bf16 v[32:35], a[76:79], v[80:83], v[32:35]
v_mfma_f32_16x16x32_bf16 v[36:39], a[76:79], v[84:87], v[36:39]
v_mfma_f32_16x16x32_bf16 v[40:43], a[156:159], v[80:83], v[40:43]
v_mfma_f32_16x16x32_bf16 v[44:47], a[156:159], v[84:87], v[44:47]
v_mfma_f32_16x16x32_bf16 v[48:51], v[80:83], a[236:239], v[48:51]
v_mfma_f32_16x16x32_bf16 v[52:55], v[84:87], a[236:239], v[52:55]
v_mfma_f32_16x16x32_bf16 v[56:59], v[80:83], v[172:175], v[56:59]
v_mfma_f32_16x16x32_bf16 v[60:63], v[84:87], v[172:175], v[60:63]
s_nop 0
v_cvt_pk_bf16_f32 v8, v32, v33
v_cvt_pk_bf16_f32 v9, v34, v35
v_cvt_pk_bf16_f32 v10, v40, v41
v_cvt_pk_bf16_f32 v11, v42, v43
s_add_u32 s34, s22, 0
buffer_store_dwordx4 v[8:11], v1, s[4:7], s34 offen
v_cvt_pk_bf16_f32 v12, v36, v37
v_cvt_pk_bf16_f32 v13, v38, v39
v_cvt_pk_bf16_f32 v14, v44, v45
v_cvt_pk_bf16_f32 v15, v46, v47
s_add_u32 s34, s22, 6144
buffer_store_dwordx4 v[12:15], v1, s[4:7], s34 offen
v_cvt_pk_bf16_f32 v8, v48, v49
v_cvt_pk_bf16_f32 v9, v50, v51
v_cvt_pk_bf16_f32 v10, v52, v53
v_cvt_pk_bf16_f32 v11, v54, v55
s_add_u32 s34, s23, 4096
buffer_store_dwordx4 v[8:11], v1, s[4:7], s34 offen
v_cvt_pk_bf16_f32 v12, v56, v57
v_cvt_pk_bf16_f32 v13, v58, v59
v_cvt_pk_bf16_f32 v14, v60, v61
v_cvt_pk_bf16_f32 v15, v62, v63
s_add_u32 s34, s23, 5120
buffer_store_dwordx4 v[12:15], v1, s[4:7], s34 offen
s_waitcnt vmcnt(0)
s_barrier
s_add_u32 s17, s17, 1
s_cmp_lt_u32 s17, 64
s_cbranch_scc1 reca_ptop259
s_branch reca_exit1
reca_pslow258:
reca_ptop264:
s_cmp_lt_u32 s17, 3
s_cbranch_scc1 reca_pgo265
s_sub_u32 s36, s17, 3
reca_ppoll266:
buffer_load_dword v28, v4, s[4:7], s25 offen sc1
s_waitcnt vmcnt(0)
v_readfirstlane_b32 s34, v28
s_nop 3
s_cmp_ge_i32 s34, s36
s_cbranch_scc1 reca_pgo265
s_sleep 8
s_sub_u32 s18, s18, 1
s_cbranch_scc0 reca_ppoll266
s_mov_b32 s18, 0
reca_pgo265:
s_waitcnt vmcnt(0)
s_barrier
v_add_u32 v7, s26, v1
s_xor_b32 s26, s26, 40960
s_add_u32 s37, s17, 1
s_cmp_ge_u32 s37, 64
s_cbranch_scc1 reca_pnodma267
s_mul_i32 s20, s37, 40960
s_add_u32 s20, s20, 84955136
s_add_u32 m0, s26, 20480
s_nop 0
buffer_load_dwordx4 v1, s[4:7], s20 offen offset:0 lds
buffer_load_dwordx4 v1, s[4:7], s20 offen offset:1024 lds
buffer_load_dwordx4 v1, s[4:7], s20 offen offset:2048 lds
buffer_load_dwordx4 v1, s[4:7], s20 offen offset:3072 lds
s_add_u32 s20, s20, 4096
s_add_u32 m0, s26, 24576
s_nop 0
buffer_load_dwordx4 v1, s[4:7], s20 offen offset:0 lds
buffer_load_dwordx4 v1, s[4:7], s20 offen offset:1024 lds
buffer_load_dwordx4 v1, s[4:7], s20 offen offset:2048 lds
buffer_load_dwordx4 v1, s[4:7], s20 offen offset:3072 lds
s_add_u32 s20, s20, 4096
s_add_u32 m0, s26, 28672
s_nop 0
buffer_load_dwordx4 v1, s[4:7], s20 offen offset:0 lds
buffer_load_dwordx4 v1, s[4:7], s20 offen offset:1024 lds
reca_pnodma267:
s_lshl_b32 s34, s15, 3
s_and_b32 s35, s17, 7
s_add_u32 s34, s34, s35
s_mul_i32 s34, s34, 12288
s_mul_i32 s35, s16, 3072
s_add_u32 s35, s35, s34
s_add_u32 s21, s35, 37748736
s_add_u32 s22, s35, 44040192
s_mul_i32 s35, s16, 6144
s_add_u32 s35, s35, s34
s_add_u32 s23, s35, 40894464
ds_read_b128 v[72:75], v7 offset:0
ds_read_b128 v[76:79], v7 offset:20480
ds_read_b128 v[80:83], v7 offset:1024
ds_read_b128 v[84:87], v7 offset:21504
ds_read_b128 v[88:91], v7 offset:2048
ds_read_b128 v[92:95], v7 offset:22528
s_waitcnt lgkmcnt(4)
v_mfma_f32_16x16x32_bf16 v[32:35], a[0:3], v[72:75], 0
v_mfma_f32_16x16x32_bf16 v[36:39], a[0:3], v[76:79], 0
v_mfma_f32_16x16x32_bf16 v[40:43], a[80:83], v[72:75], 0
v_mfma_f32_16x16x32_bf16 v[44:47], a[80:83], v[76:79], 0
v_mfma_f32_16x16x32_bf16 v[48:51], v[72:75], a[160:163], 0
v_mfma_f32_16x16x32_bf16 v[52:55], v[76:79], a[160:163], 0
v_mfma_f32_16x16x32_bf16 v[56:59], v[72:75], v[96:99], 0
v_mfma_f32_16x16x32_bf16 v[60:63], v[76:79], v[96:99], 0
ds_read_b128 v[72:75], v7 offset:3072
ds_read_b128 v[76:79], v7 offset:23552
s_waitcnt lgkmcnt(4)
v_mfma_f32_16x16x32_bf16 v[32:35], a[4:7], v[80:83], v[32:35]
v_mfma_f32_16x16x32_bf16 v[36:39], a[4:7], v[84:87], v[36:39]
v_mfma_f32_16x16x32_bf16 v[40:43], a[84:87], v[80:83], v[40:43]
v_mfma_f32_16x16x32_bf16 v[44:47], a[84:87], v[84:87], v[44:47]
v_mfma_f32_16x16x32_bf16 v[48:51], v[80:83], a[164:167], v[48:51]
v_mfma_f32_16x16x32_bf16 v[52:55], v[84:87], a[164:167], v[52:55]
v_mfma_f32_16x16x32_bf16 v[56:59], v[80:83], v[100:103], v[56:59]
v_mfma_f32_16x16x32_bf16 v[60:63], v[84:87], v[100:103], v[60:63]
ds_read_b128 v[80:83], v7 offset:4096
ds_read_b128 v[84:87], v7 offset:24576
s_waitcnt lgkmcnt(4)
v_mfma_f32_16x16x32_bf16 v[32:35], a[8:11], v[88:91], v[32:35]
v_mfma_f32_16x16x32_bf16 v[36:39], a[8:11], v[92:95], v[36:39]
v_mfma_f32_16x16x32_bf16 v[40:43], a[88:91], v[88:91], v[40:43]
v_mfma_f32_16x16x32_bf16 v[44:47], a[88:91], v[92:95], v[44:47]
v_mfma_f32_16x16x32_bf16 v[48:51], v[88:91], a[168:171], v[48:51]
v_mfma_f32_16x16x32_bf16 v[52:55], v[92:95], a[168:171], v[52:55]
v_mfma_f32_16x16x32_bf16 v[56:59], v[88:91], v[104:107], v[56:59]
v_mfma_f32_16x16x32_bf16 v[60:63], v[92:95], v[104:107], v[60:63]
ds_read_b128 v[88:91], v7 offset:5120
ds_read_b128 v[92:95], v7 offset:25600
s_waitcnt lgkmcnt(4)
v_mfma_f32_16x16x32_bf16 v[32:35], a[12:15], v[72:75], v[32:35]
v_mfma_f32_16x16x32_bf16 v[36:39], a[12:15], v[76:79], v[36:39]
v_mfma_f32_16x16x32_bf16 v[40:43], a[92:95], v[72:75], v[40:43]
v_mfma_f32_16x16x32_bf16 v[44:47], a[92:95], v[76:79], v[44:47]
v_mfma_f32_16x16x32_bf16 v[48:51], v[72:75], a[172:175], v[48:51]
v_mfma_f32_16x16x32_bf16 v[52:55], v[76:79], a[172:175], v[52:55]
v_mfma_f32_16x16x32_bf16 v[56:59], v[72:75], v[108:111], v[56:59]
v_mfma_f32_16x16x32_bf16 v[60:63], v[76:79], v[108:111], v[60:63]
ds_read_b128 v[72:75], v7 offset:6144
ds_read_b128 v[76:79], v7 offset:26624
s_waitcnt lgkmcnt(4)
v_mfma_f32_16x16x32_bf16 v[32:35], a[16:19], v[80:83], v[32:35]
v_mfma_f32_16x16x32_bf16 v[36:39], a[16:19], v[84:87], v[36:39]
v_mfma_f32_16x16x32_bf16 v[40:43], a[96:99], v[80:83], v[40:43]
v_mfma_f32_16x16x32_bf16 v[44:47], a[96:99], v[84:87], v[44:47]
v_mfma_f32_16x16x32_bf16 v[48:51], v[80:83], a[176:179], v[48:51]
v_mfma_f32_16x16x32_bf16 v[52:55], v[84:87], a[176:179], v[52:55]
v_mfma_f32_16x16x32_bf16 v[56:59], v[80:83], v[112:115], v[56:59]
v_mfma_f32_16x16x32_bf16 v[60:63], v[84:87], v[112:115], v[60:63]
ds_read_b128 v[80:83], v7 offset:7168
ds_read_b128 v[84:87], v7 offset:27648
s_waitcnt lgkmcnt(4)
v_mfma_f32_16x16x32_bf16 v[32:35], a[20:23], v[88:91], v[32:35]
v_mfma_f32_16x16x32_bf16 v[36:39], a[20:23], v[92:95], v[36:39]
v_mfma_f32_16x16x32_bf16 v[40:43], a[100:103], v[88:91], v[40:43]
v_mfma_f32_16x16x32_bf16 v[44:47], a[100:103], v[92:95], v[44:47]
v_mfma_f32_16x16x32_bf16 v[48:51], v[88:91], a[180:183], v[48:51]
v_mfma_f32_16x16x32_bf16 v[52:55], v[92:95], a[180:183], v[52:55]
v_mfma_f32_16x16x32_bf16 v[56:59], v[88:91], v[116:119], v[56:59]
v_mfma_f32_16x16x32_bf16 v[60:63], v[92:95], v[116:119], v[60:63]
ds_read_b128 v[88:91], v7 offset:8192
ds_read_b128 v[92:95], v7 offset:28672
s_waitcnt lgkmcnt(4)
v_mfma_f32_16x16x32_bf16 v[32:35], a[24:27], v[72:75], v[32:35]
v_mfma_f32_16x16x32_bf16 v[36:39], a[24:27], v[76:79], v[36:39]
v_mfma_f32_16x16x32_bf16 v[40:43], a[104:107], v[72:75], v[40:43]
v_mfma_f32_16x16x32_bf16 v[44:47], a[104:107], v[76:79], v[44:47]
v_mfma_f32_16x16x32_bf16 v[48:51], v[72:75], a[184:187], v[48:51]
v_mfma_f32_16x16x32_bf16 v[52:55], v[76:79], a[184:187], v[52:55]
v_mfma_f32_16x16x32_bf16 v[56:59], v[72:75], v[120:123], v[56:59]
v_mfma_f32_16x16x32_bf16 v[60:63], v[76:79], v[120:123], v[60:63]
ds_read_b128 v[72:75], v7 offset:9216
ds_read_b128 v[76:79], v7 offset:29696
s_waitcnt lgkmcnt(4)
v_mfma_f32_16x16x32_bf16 v[32:35], a[28:31], v[80:83], v[32:35]
v_mfma_f32_16x16x32_bf16 v[36:39], a[28:31], v[84:87], v[36:39]
v_mfma_f32_16x16x32_bf16 v[40:43], a[108:111], v[80:83], v[40:43]
v_mfma_f32_16x16x32_bf16 v[44:47], a[108:111], v[84:87], v[44:47]
v_mfma_f32_16x16x32_bf16 v[48:51], v[80:83], a[188:191], v[48:51]
v_mfma_f32_16x16x32_bf16 v[52:55], v[84:87], a[188:191], v[52:55]
v_mfma_f32_16x16x32_bf16 v[56:59], v[80:83], v[124:127], v[56:59]
v_mfma_f32_16x16x32_bf16 v[60:63], v[84:87], v[124:127], v[60:63]
ds_read_b128 v[80:83], v7 offset:10240
ds_read_b128 v[84:87], v7 offset:30720
s_waitcnt lgkmcnt(4)
v_mfma_f32_16x16x32_bf16 v[32:35], a[32:35], v[88:91], v[32:35]
v_mfma_f32_16x16x32_bf16 v[36:39], a[32:35], v[92:95], v[36:39]
v_mfma_f32_16x16x32_bf16 v[40:43], a[112:115], v[88:91], v[40:43]
v_mfma_f32_16x16x32_bf16 v[44:47], a[112:115], v[92:95], v[44:47]
v_mfma_f32_16x16x32_bf16 v[48:51], v[88:91], a[192:195], v[48:51]
v_mfma_f32_16x16x32_bf16 v[52:55], v[92:95], a[192:195], v[52:55]
v_mfma_f32_16x16x32_bf16 v[56:59], v[88:91], v[128:131], v[56:59]
v_mfma_f32_16x16x32_bf16 v[60:63], v[92:95], v[128:131], v[60:63]
ds_read_b128 v[88:91], v7 offset:11264
ds_read_b128 v[92:95], v7 offset:31744
s_waitcnt lgkmcnt(4)
v_mfma_f32_16x16x32_bf16 v[32:35], a[36:39], v[72:75], v[32:35]
v_mfma_f32_16x16x32_bf16 v[36:39], a[36:39], v[76:79], v[36:39]
v_mfma_f32_16x16x32_bf16 v[40:43], a[116:119], v[72:75], v[40:43]
v_mfma_f32_16x16x32_bf16 v[44:47], a[116:119], v[76:79], v[44:47]
v_mfma_f32_16x16x32_bf16 v[48:51], v[72:75], a[196:199], v[48:51]
v_mfma_f32_16x16x32_bf16 v[52:55], v[76:79], a[196:199], v[52:55]
v_mfma_f32_16x16x32_bf16 v[56:59], v[72:75], v[132:135], v[56:59]
v_mfma_f32_16x16x32_bf16 v[60:63], v[76:79], v[132:135], v[60:63]
ds_read_b128 v[72:75], v7 offset:12288
ds_read_b128 v[76:79], v7 offset:32768
s_waitcnt lgkmcnt(4)
v_mfma_f32_16x16x32_bf16 v[32:35], a[40:43], v[80:83], v[32:35]
v_mfma_f32_16x16x32_bf16 v[36:39], a[40:43], v[84:87], v[36:39]
v_mfma_f32_16x16x32_bf16 v[40:43], a[120:123], v[80:83], v[40:43]
v_mfma_f32_16x16x32_bf16 v[44:47], a[120:123], v[84:87], v[44:47]
v_mfma_f32_16x16x32_bf16 v[48:51], v[80:83], a[200:203], v[48:51]
v_mfma_f32_16x16x32_bf16 v[52:55], v[84:87], a[200:203], v[52:55]
v_mfma_f32_16x16x32_bf16 v[56:59], v[80:83], v[136:139], v[56:59]
v_mfma_f32_16x16x32_bf16 v[60:63], v[84:87], v[136:139], v[60:63]
ds_read_b128 v[80:83], v7 offset:13312
ds_read_b128 v[84:87], v7 offset:33792
s_waitcnt lgkmcnt(4)
v_mfma_f32_16x16x32_bf16 v[32:35], a[44:47], v[88:91], v[32:35]
v_mfma_f32_16x16x32_bf16 v[36:39], a[44:47], v[92:95], v[36:39]
v_mfma_f32_16x16x32_bf16 v[40:43], a[124:127], v[88:91], v[40:43]
v_mfma_f32_16x16x32_bf16 v[44:47], a[124:127], v[92:95], v[44:47]
v_mfma_f32_16x16x32_bf16 v[48:51], v[88:91], a[204:207], v[48:51]
v_mfma_f32_16x16x32_bf16 v[52:55], v[92:95], a[204:207], v[52:55]
v_mfma_f32_16x16x32_bf16 v[56:59], v[88:91], v[140:143], v[56:59]
v_mfma_f32_16x16x32_bf16 v[60:63], v[92:95], v[140:143], v[60:63]
ds_read_b128 v[88:91], v7 offset:14336
ds_read_b128 v[92:95], v7 offset:34816
s_waitcnt lgkmcnt(4)
v_mfma_f32_16x16x32_bf16 v[32:35], a[48:51], v[72:75], v[32:35]
v_mfma_f32_16x16x32_bf16 v[36:39], a[48:51], v[76:79], v[36:39]
v_mfma_f32_16x16x32_bf16 v[40:43], a[128:131], v[72:75], v[40:43]
v_mfma_f32_16x16x32_bf16 v[44:47], a[128:131], v[76:79], v[44:47]
v_mfma_f32_16x16x32_bf16 v[48:51], v[72:75], a[208:211], v[48:51]
v_mfma_f32_16x16x32_bf16 v[52:55], v[76:79], a[208:211], v[52:55]
v_mfma_f32_16x16x32_bf16 v[56:59], v[72:75], v[144:147], v[56:59]
v_mfma_f32_16x16x32_bf16 v[60:63], v[76:79], v[144:147], v[60:63]
ds_read_b128 v[72:75], v7 offset:15360
ds_read_b128 v[76:79], v7 offset:35840
s_waitcnt lgkmcnt(4)
v_mfma_f32_16x16x32_bf16 v[32:35], a[52:55], v[80:83], v[32:35]
v_mfma_f32_16x16x32_bf16 v[36:39], a[52:55], v[84:87], v[36:39]
v_mfma_f32_16x16x32_bf16 v[40:43], a[132:135], v[80:83], v[40:43]
v_mfma_f32_16x16x32_bf16 v[44:47], a[132:135], v[84:87], v[44:47]
v_mfma_f32_16x16x32_bf16 v[48:51], v[80:83], a[212:215], v[48:51]
v_mfma_f32_16x16x32_bf16 v[52:55], v[84:87], a[212:215], v[52:55]
v_mfma_f32_16x16x32_bf16 v[56:59], v[80:83], v[148:151], v[56:59]
v_mfma_f32_16x16x32_bf16 v[60:63], v[84:87], v[148:151], v[60:63]
ds_read_b128 v[80:83], v7 offset:16384
ds_read_b128 v[84:87], v7 offset:36864
s_waitcnt lgkmcnt(4)
v_mfma_f32_16x16x32_bf16 v[32:35], a[56:59], v[88:91], v[32:35]
v_mfma_f32_16x16x32_bf16 v[36:39], a[56:59], v[92:95], v[36:39]
v_mfma_f32_16x16x32_bf16 v[40:43], a[136:139], v[88:91], v[40:43]
v_mfma_f32_16x16x32_bf16 v[44:47], a[136:139], v[92:95], v[44:47]
v_mfma_f32_16x16x32_bf16 v[48:51], v[88:91], a[216:219], v[48:51]
v_mfma_f32_16x16x32_bf16 v[52:55], v[92:95], a[216:219], v[52:55]
v_mfma_f32_16x16x32_bf16 v[56:59], v[88:91], v[152:155], v[56:59]
v_mfma_f32_16x16x32_bf16 v[60:63], v[92:95], v[152:155], v[60:63]
ds_read_b128 v[88:91], v7 offset:17408
ds_read_b128 v[92:95], v7 offset:37888
s_waitcnt lgkmcnt(4)
v_mfma_f32_16x16x32_bf16 v[32:35], a[60:63], v[72:75], v[32:35]
v_mfma_f32_16x16x32_bf16 v[36:39], a[60:63], v[76:79], v[36:39]
v_mfma_f32_16x16x32_bf16 v[40:43], a[140:143], v[72:75], v[40:43]
v_mfma_f32_16x16x32_bf16 v[44:47], a[140:143], v[76:79], v[44:47]
v_mfma_f32_16x16x32_bf16 v[48:51], v[72:75], a[220:223], v[48:51]
v_mfma_f32_16x16x32_bf16 v[52:55], v[76:79], a[220:223], v[52:55]
v_mfma_f32_16x16x32_bf16 v[56:59], v[72:75], v[156:159], v[56:59]
v_mfma_f32_16x16x32_bf16 v[60:63], v[76:79], v[156:159], v[60:63]
ds_read_b128 v[72:75], v7 offset:18432
ds_read_b128 v[76:79], v7 offset:38912
s_waitcnt lgkmcnt(4)
v_mfma_f32_16x16x32_bf16 v[32:35], a[64:67], v[80:83], v[32:35]
v_mfma_f32_16x16x32_bf16 v[36:39], a[64:67], v[84:87], v[36:39]
v_mfma_f32_16x16x32_bf16 v[40:43], a[144:147], v[80:83], v[40:43]
v_mfma_f32_16x16x32_bf16 v[44:47], a[144:147], v[84:87], v[44:47]
v_mfma_f32_16x16x32_bf16 v[48:51], v[80:83], a[224:227], v[48:51]
v_mfma_f32_16x16x32_bf16 v[52:55], v[84:87], a[224:227], v[52:55]
v_mfma_f32_16x16x32_bf16 v[56:59], v[80:83], v[160:163], v[56:59]
v_mfma_f32_16x16x32_bf16 v[60:63], v[84:87], v[160:163], v[60:63]
ds_read_b128 v[80:83], v7 offset:19456
ds_read_b128 v[84:87], v7 offset:39936
s_waitcnt lgkmcnt(4)
v_mfma_f32_16x16x32_bf16 v[32:35], a[68:71], v[88:91], v[32:35]
v_mfma_f32_16x16x32_bf16 v[36:39], a[68:71], v[92:95], v[36:39]
v_mfma_f32_16x16x32_bf16 v[40:43], a[148:151], v[88:91], v[40:43]
v_mfma_f32_16x16x32_bf16 v[44:47], a[148:151], v[92:95], v[44:47]
v_mfma_f32_16x16x32_bf16 v[48:51], v[88:91], a[228:231], v[48:51]
v_mfma_f32_16x16x32_bf16 v[52:55], v[92:95], a[228:231], v[52:55]
v_mfma_f32_16x16x32_bf16 v[56:59], v[88:91], v[164:167], v[56:59]
v_mfma_f32_16x16x32_bf16 v[60:63], v[92:95], v[164:167], v[60:63]
s_waitcnt lgkmcnt(2)
v_mfma_f32_16x16x32_bf16 v[32:35], a[72:75], v[72:75], v[32:35]
v_mfma_f32_16x16x32_bf16 v[36:39], a[72:75], v[76:79], v[36:39]
v_mfma_f32_16x16x32_bf16 v[40:43], a[152:155], v[72:75], v[40:43]
v_mfma_f32_16x16x32_bf16 v[44:47], a[152:155], v[76:79], v[44:47]
v_mfma_f32_16x16x32_bf16 v[48:51], v[72:75], a[232:235], v[48:51]
v_mfma_f32_16x16x32_bf16 v[52:55], v[76:79], a[232:235], v[52:55]
v_mfma_f32_16x16x32_bf16 v[56:59], v[72:75], v[168:171], v[56:59]
v_mfma_f32_16x16x32_bf16 v[60:63], v[76:79], v[168:171], v[60:63]
s_waitcnt lgkmcnt(0)
v_mfma_f32_16x16x32_bf16 v[32:35], a[76:79], v[80:83], v[32:35]
v_mfma_f32_16x16x32_bf16 v[36:39], a[76:79], v[84:87], v[36:39]
v_mfma_f32_16x16x32_bf16 v[40:43], a[156:159], v[80:83], v[40:43]
v_mfma_f32_16x16x32_bf16 v[44:47], a[156:159], v[84:87], v[44:47]
v_mfma_f32_16x16x32_bf16 v[48:51], v[80:83], a[236:239], v[48:51]
v_mfma_f32_16x16x32_bf16 v[52:55], v[84:87], a[236:239], v[52:55]
v_mfma_f32_16x16x32_bf16 v[56:59], v[80:83], v[172:175], v[56:59]
v_mfma_f32_16x16x32_bf16 v[60:63], v[84:87], v[172:175], v[60:63]
s_nop 0
v_cvt_pk_bf16_f32 v8, v32, v33
v_cvt_pk_bf16_f32 v9, v34, v35
v_cvt_pk_bf16_f32 v10, v40, v41
v_cvt_pk_bf16_f32 v11, v42, v43
s_add_u32 s34, s22, 0
buffer_store_dwordx4 v[8:11], v1, s[4:7], s34 offen sc1
v_cvt_pk_bf16_f32 v12, v36, v37
v_cvt_pk_bf16_f32 v13, v38, v39
v_cvt_pk_bf16_f32 v14, v44, v45
v_cvt_pk_bf16_f32 v15, v46, v47
s_add_u32 s34, s22, 6144
buffer_store_dwordx4 v[12:15], v1, s[4:7], s34 offen sc1
v_cvt_pk_bf16_f32 v8, v48, v49
v_cvt_pk_bf16_f32 v9, v50, v51
v_cvt_pk_bf16_f32 v10, v52, v53
v_cvt_pk_bf16_f32 v11, v54, v55
s_add_u32 s34, s23, 4096
buffer_store_dwordx4 v[8:11], v1, s[4:7], s34 offen sc1
v_cvt_pk_bf16_f32 v12, v56, v57
v_cvt_pk_bf16_f32 v13, v58, v59
v_cvt_pk_bf16_f32 v14, v60, v61
v_cvt_pk_bf16_f32 v15, v62, v63
s_add_u32 s34, s23, 5120
buffer_store_dwordx4 v[12:15], v1, s[4:7], s34 offen sc1
s_waitcnt vmcnt(0)
s_barrier
s_add_u32 s17, s17, 1
s_cmp_lt_u32 s17, 64
s_cbranch_scc1 reca_ptop264
s_branch reca_exit1
reca_pw3_229:
s_mov_b32 s17, 0
s_mov_b32 s26, 0
s_mul_i32 s20, s17, 40960
s_add_u32 s20, s20, 84965376
s_add_u32 m0, s26, 30720
s_nop 0
buffer_load_dwordx4 v1, s[4:7], s20 offen offset:0 lds
buffer_load_dwordx4 v1, s[4:7], s20 offen offset:1024 lds
buffer_load_dwordx4 v1, s[4:7], s20 offen offset:2048 lds
buffer_load_dwordx4 v1, s[4:7], s20 offen offset:3072 lds
s_add_u32 s20, s20, 4096
s_add_u32 m0, s26, 34816
s_nop 0
buffer_load_dwordx4 v1, s[4:7], s20 offen offset:0 lds
buffer_load_dwordx4 v1, s[4:7], s20 offen offset:1024 lds
buffer_load_dwordx4 v1, s[4:7], s20 offen offset:2048 lds
buffer_load_dwordx4 v1, s[4:7], s20 offen offset:3072 lds
s_add_u32 s20, s20, 4096
s_add_u32 m0, s26, 38912
s_nop 0
buffer_load_dwordx4 v1, s[4:7], s20 offen offset:0 lds
buffer_load_dwordx4 v1, s[4:7], s20 offen offset:1024 lds
s_mul_i32 s34, s15, 12
s_mul_i32 s35, s16, 6
s_add_u32 s34, s34, s35
s_add_u32 s34, s34, 2
s_mul_i32 s34, s34, 20480
s_add_u32 s34, s34, 6291456
buffer_load_dwordx4 a[0:3], v1, s[4:7], s34 offen offset:0
buffer_load_dwordx4 a[4:7], v1, s[4:7], s34 offen offset:1024
buffer_load_dwordx4 a[8:11], v1, s[4:7], s34 offen offset:2048
buffer_load_dwordx4 a[12:15], v1, s[4:7], s34 offen offset:3072
s_add_u32 s34, s34, 4096
buffer_load_dwordx4 a[16:19], v1, s[4:7], s34 offen offset:0
buffer_load_dwordx4 a[20:23], v1, s[4:7], s34 offen offset:1024
buffer_load_dwordx4 a[24:27], v1, s[4:7], s34 offen offset:2048
buffer_load_dwordx4 a[28:31], v1, s[4:7], s34 offen offset:3072
s_add_u32 s34, s34, 4096
buffer_load_dwordx4 a[32:35], v1, s[4:7], s34 offen offset:0
buffer_load_dwordx4 a[36:39], v1, s[4:7], s34 offen offset:1024
buffer_load_dwordx4 a[40:43], v1, s[4:7], s34 offen offset:2048
buffer_load_dwordx4 a[44:47], v1, s[4:7], s34 offen offset:3072
s_add_u32 s34, s34, 4096
buffer_load_dwordx4 a[48:51], v1, s[4:7], s34 offen offset:0
buffer_load_dwordx4 a[52:55], v1, s[4:7], s34 offen offset:1024
buffer_load_dwordx4 a[56:59], v1, s[4:7], s34 offen offset:2048
buffer_load_dwordx4 a[60:63], v1, s[4:7], s34 offen offset:3072
s_add_u32 s34, s34, 4096
buffer_load_dwordx4 a[64:67], v1, s[4:7], s34 offen offset:0
buffer_load_dwordx4 a[68:71], v1, s[4:7], s34 offen offset:1024
buffer_load_dwordx4 a[72:75], v1, s[4:7], s34 offen offset:2048
buffer_load_dwordx4 a[76:79], v1, s[4:7], s34 offen offset:3072
s_mul_i32 s34, s15, 12
s_mul_i32 s35, s16, 6
s_add_u32 s34, s34, s35
s_add_u32 s34, s34, 3
s_mul_i32 s34, s34, 20480
s_add_u32 s34, s34, 6291456
buffer_load_dwordx4 a[80:83], v1, s[4:7], s34 offen offset:0
buffer_load_dwordx4 a[84:87], v1, s[4:7], s34 offen offset:1024
buffer_load_dwordx4 a[88:91], v1, s[4:7], s34 offen offset:2048
buffer_load_dwordx4 a[92:95], v1, s[4:7], s34 offen offset:3072
s_add_u32 s34, s34, 4096
buffer_load_dwordx4 a[96:99], v1, s[4:7], s34 offen offset:0
buffer_load_dwordx4 a[100:103], v1, s[4:7], s34 offen offset:1024
buffer_load_dwordx4 a[104:107], v1, s[4:7], s34 offen offset:2048
buffer_load_dwordx4 a[108:111], v1, s[4:7], s34 offen offset:3072
s_add_u32 s34, s34, 4096
buffer_load_dwordx4 a[112:115], v1, s[4:7], s34 offen offset:0
buffer_load_dwordx4 a[116:119], v1, s[4:7], s34 offen offset:1024
buffer_load_dwordx4 a[120:123], v1, s[4:7], s34 offen offset:2048
buffer_load_dwordx4 a[124:127], v1, s[4:7], s34 offen offset:3072
s_add_u32 s34, s34, 4096
buffer_load_dwordx4 a[128:131], v1, s[4:7], s34 offen offset:0
buffer_load_dwordx4 a[132:135], v1, s[4:7], s34 offen offset:1024
buffer_load_dwordx4 a[136:139], v1, s[4:7], s34 offen offset:2048
buffer_load_dwordx4 a[140:143], v1, s[4:7], s34 offen offset:3072
s_add_u32 s34, s34, 4096
buffer_load_dwordx4 a[144:147], v1, s[4:7], s34 offen offset:0
buffer_load_dwordx4 a[148:151], v1, s[4:7], s34 offen offset:1024
buffer_load_dwordx4 a[152:155], v1, s[4:7], s34 offen offset:2048
buffer_load_dwordx4 a[156:159], v1, s[4:7], s34 offen offset:3072
s_waitcnt vmcnt(20)
s_mul_i32 s34, s15, 12
s_mul_i32 s35, s16, 6
s_add_u32 s34, s34, s35
s_add_u32 s34, s34, 4
s_mul_i32 s34, s34, 20480
s_add_u32 s34, s34, 6291456
buffer_load_dwordx4 a[160:163], v1, s[4:7], s34 offen offset:0
buffer_load_dwordx4 a[164:167], v1, s[4:7], s34 offen offset:1024
buffer_load_dwordx4 a[168:171], v1, s[4:7], s34 offen offset:2048
buffer_load_dwordx4 a[172:175], v1, s[4:7], s34 offen offset:3072
s_add_u32 s34, s34, 4096
buffer_load_dwordx4 a[176:179], v1, s[4:7], s34 offen offset:0
buffer_load_dwordx4 a[180:183], v1, s[4:7], s34 offen offset:1024
buffer_load_dwordx4 a[184:187], v1, s[4:7], s34 offen offset:2048
buffer_load_dwordx4 a[188:191], v1, s[4:7], s34 offen offset:3072
s_add_u32 s34, s34, 4096
buffer_load_dwordx4 a[192:195], v1, s[4:7], s34 offen offset:0
buffer_load_dwordx4 a[196:199], v1, s[4:7], s34 offen offset:1024
buffer_load_dwordx4 a[200:203], v1, s[4:7], s34 offen offset:2048
buffer_load_dwordx4 a[204:207], v1, s[4:7], s34 offen offset:3072
s_add_u32 s34, s34, 4096
buffer_load_dwordx4 a[208:211], v1, s[4:7], s34 offen offset:0
buffer_load_dwordx4 a[212:215], v1, s[4:7], s34 offen offset:1024
buffer_load_dwordx4 a[216:219], v1, s[4:7], s34 offen offset:2048
buffer_load_dwordx4 a[220:223], v1, s[4:7], s34 offen offset:3072
s_add_u32 s34, s34, 4096
buffer_load_dwordx4 a[224:227], v1, s[4:7], s34 offen offset:0
buffer_load_dwordx4 a[228:231], v1, s[4:7], s34 offen offset:1024
buffer_load_dwordx4 a[232:235], v1, s[4:7], s34 offen offset:2048
buffer_load_dwordx4 a[236:239], v1, s[4:7], s34 offen offset:3072
s_waitcnt vmcnt(20)
s_mul_i32 s34, s15, 12
s_mul_i32 s35, s16, 6
s_add_u32 s34, s34, s35
s_add_u32 s34, s34, 5
s_mul_i32 s34, s34, 20480
s_add_u32 s34, s34, 6291456
buffer_load_dwordx4 v[96:99], v1, s[4:7], s34 offen offset:0
buffer_load_dwordx4 v[100:103], v1, s[4:7], s34 offen offset:1024
buffer_load_dwordx4 v[104:107], v1, s[4:7], s34 offen offset:2048
buffer_load_dwordx4 v[108:111], v1, s[4:7], s34 offen offset:3072
s_add_u32 s34, s34, 4096
buffer_load_dwordx4 v[112:115], v1, s[4:7], s34 offen offset:0
buffer_load_dwordx4 v[116:119], v1, s[4:7], s34 offen offset:1024
buffer_load_dwordx4 v[120:123], v1, s[4:7], s34 offen offset:2048
buffer_load_dwordx4 v[124:127], v1, s[4:7], s34 offen offset:3072
s_add_u32 s34, s34, 4096
buffer_load_dwordx4 v[128:131], v1, s[4:7], s34 offen offset:0
buffer_load_dwordx4 v[132:135], v1, s[4:7], s34 offen offset:1024
buffer_load_dwordx4 v[136:139], v1, s[4:7], s34 offen offset:2048
buffer_load_dwordx4 v[140:143], v1, s[4:7], s34 offen offset:3072
s_add_u32 s34, s34, 4096
buffer_load_dwordx4 v[144:147], v1, s[4:7], s34 offen offset:0
buffer_load_dwordx4 v[148:151], v1, s[4:7], s34 offen offset:1024
buffer_load_dwordx4 v[152:155], v1, s[4:7], s34 offen offset:2048
buffer_load_dwordx4 v[156:159], v1, s[4:7], s34 offen offset:3072
s_add_u32 s34, s34, 4096
buffer_load_dwordx4 v[160:163], v1, s[4:7], s34 offen offset:0
buffer_load_dwordx4 v[164:167], v1, s[4:7], s34 offen offset:1024
buffer_load_dwordx4 v[168:171], v1, s[4:7], s34 offen offset:2048
buffer_load_dwordx4 v[172:175], v1, s[4:7], s34 offen offset:3072
s_waitcnt vmcnt(20)
v_and_b32 v30, 7, v0
v_lshlrev_b32 v30, 3, v30
reca_cens269:
buffer_load_dwordx2 v[28:29], v30, s[8:11], 0 offen sc1
s_waitcnt vmcnt(0)
v_sad_u8 v31, v28, 0, 0
v_sad_u8 v31, v29, 0, v31
v_cmp_gt_u32 vcc, 32, v31
s_cbranch_vccz reca_censok270
s_sleep 8
s_sub_u32 s18, s18, 1
s_cbranch_scc0 reca_cens269
s_mov_b32 s18, 0
reca_censok270:
v_and_b32 v28, 0x20202020, v28
v_and_b32 v29, 0x20202020, v29
v_cmp_ne_u32 s[34:35], 0, v28
v_cmp_ne_u32 s[36:37], 0, v29
s_nop 3
s_and_b32 s34, s34, 0xff
s_and_b32 s36, s36, 0xff
s_or_b32 s35, s34, s36
s_lshr_b32 s37, s35, s13
s_and_b32 s37, s37, 1
s_xor_b32 s43, s37, 1
s_cmp_eq_u32 s57, 0
s_cselect_b32 s58, s36, s34
v_mov_b32 v31, 0x80000000
s_cmp_lg_u32 s43, 0
s_cbranch_scc1 reca_pslow271
reca_ptop272:
s_cmp_lt_u32 s17, 3
s_cbranch_scc1 reca_pgo273
s_sub_u32 s36, s17, 3
reca_ppoll274:
buffer_load_dword v28, v4, s[4:7], s25 offen sc1
s_waitcnt vmcnt(0)
v_readfirstlane_b32 s34, v28
s_nop 3
s_cmp_ge_i32 s34, s36
s_cbranch_scc1 reca_pgo273
s_sleep 8
s_sub_u32 s18, s18, 1
s_cbranch_scc0 reca_ppoll274
s_mov_b32 s18, 0
reca_pgo273:
s_waitcnt vmcnt(0)
s_barrier
v_add_u32 v7, s26, v1
s_xor_b32 s26, s26, 40960
s_add_u32 s37, s17, 1
s_cmp_ge_u32 s37, 64
s_cbranch_scc1 reca_pnodma275
s_mul_i32 s20, s37, 40960
s_add_u32 s20, s20, 84965376
s_add_u32 m0, s26, 30720
s_nop 0
buffer_load_dwordx4 v1, s[4:7], s20 offen offset:0 lds
buffer_load_dwordx4 v1, s[4:7], s20 offen offset:1024 lds
buffer_load_dwordx4 v1, s[4:7], s20 offen offset:2048 lds
buffer_load_dwordx4 v1, s[4:7], s20 offen offset:3072 lds
s_add_u32 s20, s20, 4096
s_add_u32 m0, s26, 34816
s_nop 0
buffer_load_dwordx4 v1, s[4:7], s20 offen offset:0 lds
buffer_load_dwordx4 v1, s[4:7], s20 offen offset:1024 lds
buffer_load_dwordx4 v1, s[4:7], s20 offen offset:2048 lds
buffer_load_dwordx4 v1, s[4:7], s20 offen offset:3072 lds
s_add_u32 s20, s20, 4096
s_add_u32 m0, s26, 38912
s_nop 0
buffer_load_dwordx4 v1, s[4:7], s20 offen offset:0 lds
buffer_load_dwordx4 v1, s[4:7], s20 offen offset:1024 lds
reca_pnodma275:
s_lshl_b32 s34, s15, 3
s_and_b32 s35, s17, 7
s_add_u32 s34, s34, s35
s_mul_i32 s34, s34, 12288
s_mul_i32 s35, s16, 3072
s_add_u32 s35, s35, s34
s_add_u32 s21, s35, 37748736
s_add_u32 s22, s35, 44040192
s_mul_i32 s35, s16, 6144
s_add_u32 s35, s35, s34
s_add_u32 s23, s35, 40894464
ds_read_b128 v[72:75], v7 offset:0
ds_read_b128 v[76:79], v7 offset:20480
ds_read_b128 v[80:83], v7 offset:1024
ds_read_b128 v[84:87], v7 offset:21504
ds_read_b128 v[88:91], v7 offset:2048
ds_read_b128 v[92:95], v7 offset:22528
s_waitcnt lgkmcnt(4)
v_mfma_f32_16x16x32_bf16 v[32:35], a[0:3], v[72:75], 0
v_mfma_f32_16x16x32_bf16 v[36:39], a[0:3], v[76:79], 0
v_mfma_f32_16x16x32_bf16 v[40:43], a[80:83], v[72:75], 0
v_mfma_f32_16x16x32_bf16 v[44:47], a[80:83], v[76:79], 0
v_mfma_f32_16x16x32_bf16 v[48:51], a[160:163], v[72:75], 0
v_mfma_f32_16x16x32_bf16 v[52:55], a[160:163], v[76:79], 0
v_mfma_f32_16x16x32_bf16 v[56:59], v[96:99], v[72:75], 0
v_mfma_f32_16x16x32_bf16 v[60:63], v[96:99], v[76:79], 0
ds_read_b128 v[72:75], v7 offset:3072
ds_read_b128 v[76:79], v7 offset:23552
s_waitcnt lgkmcnt(4)
v_mfma_f32_16x16x32_bf16 v[32:35], a[4:7], v[80:83], v[32:35]
v_mfma_f32_16x16x32_bf16 v[36:39], a[4:7], v[84:87], v[36:39]
v_mfma_f32_16x16x32_bf16 v[40:43], a[84:87], v[80:83], v[40:43]
v_mfma_f32_16x16x32_bf16 v[44:47], a[84:87], v[84:87], v[44:47]
v_mfma_f32_16x16x32_bf16 v[48:51], a[164:167], v[80:83], v[48:51]
v_mfma_f32_16x16x32_bf16 v[52:55], a[164:167], v[84:87], v[52:55]
v_mfma_f32_16x16x32_bf16 v[56:59], v[100:103], v[80:83], v[56:59]
v_mfma_f32_16x16x32_bf16 v[60:63], v[100:103], v[84:87], v[60:63]
ds_read_b128 v[80:83], v7 offset:4096
ds_read_b128 v[84:87], v7 offset:24576
s_waitcnt lgkmcnt(4)
v_mfma_f32_16x16x32_bf16 v[32:35], a[8:11], v[88:91], v[32:35]
v_mfma_f32_16x16x32_bf16 v[36:39], a[8:11], v[92:95], v[36:39]
v_mfma_f32_16x16x32_bf16 v[40:43], a[88:91], v[88:91], v[40:43]
v_mfma_f32_16x16x32_bf16 v[44:47], a[88:91], v[92:95], v[44:47]
v_mfma_f32_16x16x32_bf16 v[48:51], a[168:171], v[88:91], v[48:51]
v_mfma_f32_16x16x32_bf16 v[52:55], a[168:171], v[92:95], v[52:55]
v_mfma_f32_16x16x32_bf16 v[56:59], v[104:107], v[88:91], v[56:59]
v_mfma_f32_16x16x32_bf16 v[60:63], v[104:107], v[92:95], v[60:63]
ds_read_b128 v[88:91], v7 offset:5120
ds_read_b128 v[92:95], v7 offset:25600
s_waitcnt lgkmcnt(4)
v_mfma_f32_16x16x32_bf16 v[32:35], a[12:15], v[72:75], v[32:35]
v_mfma_f32_16x16x32_bf16 v[36:39], a[12:15], v[76:79], v[36:39]
v_mfma_f32_16x16x32_bf16 v[40:43], a[92:95], v[72:75], v[40:43]
v_mfma_f32_16x16x32_bf16 v[44:47], a[92:95], v[76:79], v[44:47]
v_mfma_f32_16x16x32_bf16 v[48:51], a[172:175], v[72:75], v[48:51]
v_mfma_f32_16x16x32_bf16 v[52:55], a[172:175], v[76:79], v[52:55]
v_mfma_f32_16x16x32_bf16 v[56:59], v[108:111], v[72:75], v[56:59]
v_mfma_f32_16x16x32_bf16 v[60:63], v[108:111], v[76:79], v[60:63]
ds_read_b128 v[72:75], v7 offset:6144
ds_read_b128 v[76:79], v7 offset:26624
s_waitcnt lgkmcnt(4)
v_mfma_f32_16x16x32_bf16 v[32:35], a[16:19], v[80:83], v[32:35]
v_mfma_f32_16x16x32_bf16 v[36:39], a[16:19], v[84:87], v[36:39]
v_mfma_f32_16x16x32_bf16 v[40:43], a[96:99], v[80:83], v[40:43]
v_mfma_f32_16x16x32_bf16 v[44:47], a[96:99], v[84:87], v[44:47]
v_mfma_f32_16x16x32_bf16 v[48:51], a[176:179], v[80:83], v[48:51]
v_mfma_f32_16x16x32_bf16 v[52:55], a[176:179], v[84:87], v[52:55]
v_mfma_f32_16x16x32_bf16 v[56:59], v[112:115], v[80:83], v[56:59]
v_mfma_f32_16x16x32_bf16 v[60:63], v[112:115], v[84:87], v[60:63]
ds_read_b128 v[80:83], v7 offset:7168
ds_read_b128 v[84:87], v7 offset:27648
s_waitcnt lgkmcnt(4)
v_mfma_f32_16x16x32_bf16 v[32:35], a[20:23], v[88:91], v[32:35]
v_mfma_f32_16x16x32_bf16 v[36:39], a[20:23], v[92:95], v[36:39]
v_mfma_f32_16x16x32_bf16 v[40:43], a[100:103], v[88:91], v[40:43]
v_mfma_f32_16x16x32_bf16 v[44:47], a[100:103], v[92:95], v[44:47]
v_mfma_f32_16x16x32_bf16 v[48:51], a[180:183], v[88:91], v[48:51]
v_mfma_f32_16x16x32_bf16 v[52:55], a[180:183], v[92:95], v[52:55]
v_mfma_f32_16x16x32_bf16 v[56:59], v[116:119], v[88:91], v[56:59]
v_mfma_f32_16x16x32_bf16 v[60:63], v[116:119], v[92:95], v[60:63]
ds_read_b128 v[88:91], v7 offset:8192
ds_read_b128 v[92:95], v7 offset:28672
s_waitcnt lgkmcnt(4)
v_mfma_f32_16x16x32_bf16 v[32:35], a[24:27], v[72:75], v[32:35]
v_mfma_f32_16x16x32_bf16 v[36:39], a[24:27], v[76:79], v[36:39]
v_mfma_f32_16x16x32_bf16 v[40:43], a[104:107], v[72:75], v[40:43]
v_mfma_f32_16x16x32_bf16 v[44:47], a[104:107], v[76:79], v[44:47]
v_mfma_f32_16x16x32_bf16 v[48:51], a[184:187], v[72:75], v[48:51]
v_mfma_f32_16x16x32_bf16 v[52:55], a[184:187], v[76:79], v[52:55]
v_mfma_f32_16x16x32_bf16 v[56:59], v[120:123], v[72:75], v[56:59]
v_mfma_f32_16x16x32_bf16 v[60:63], v[120:123], v[76:79], v[60:63]
ds_read_b128 v[72:75], v7 offset:9216
ds_read_b128 v[76:79], v7 offset:29696
s_waitcnt lgkmcnt(4)
v_mfma_f32_16x16x32_bf16 v[32:35], a[28:31], v[80:83], v[32:35]
v_mfma_f32_16x16x32_bf16 v[36:39], a[28:31], v[84:87], v[36:39]
v_mfma_f32_16x16x32_bf16 v[40:43], a[108:111], v[80:83], v[40:43]
v_mfma_f32_16x16x32_bf16 v[44:47], a[108:111], v[84:87], v[44:47]
v_mfma_f32_16x16x32_bf16 v[48:51], a[188:191], v[80:83], v[48:51]
v_mfma_f32_16x16x32_bf16 v[52:55], a[188:191], v[84:87], v[52:55]
v_mfma_f32_16x16x32_bf16 v[56:59], v[124:127], v[80:83], v[56:59]
v_mfma_f32_16x16x32_bf16 v[60:63], v[124:127], v[84:87], v[60:63]
ds_read_b128 v[80:83], v7 offset:10240
ds_read_b128 v[84:87], v7 offset:30720
s_waitcnt lgkmcnt(4)
v_mfma_f32_16x16x32_bf16 v[32:35], a[32:35], v[88:91], v[32:35]
v_mfma_f32_16x16x32_bf16 v[36:39], a[32:35], v[92:95], v[36:39]
v_mfma_f32_16x16x32_bf16 v[40:43], a[112:115], v[88:91], v[40:43]
v_mfma_f32_16x16x32_bf16 v[44:47], a[112:115], v[92:95], v[44:47]
v_mfma_f32_16x16x32_bf16 v[48:51], a[192:195], v[88:91], v[48:51]
v_mfma_f32_16x16x32_bf16 v[52:55], a[192:195], v[92:95], v[52:55]
v_mfma_f32_16x16x32_bf16 v[56:59], v[128:131], v[88:91], v[56:59]
v_mfma_f32_16x16x32_bf16 v[60:63], v[128:131], v[92:95], v[60:63]
ds_read_b128 v[88:91], v7 offset:11264
ds_read_b128 v[92:95], v7 offset:31744
s_waitcnt lgkmcnt(4)
v_mfma_f32_16x16x32_bf16 v[32:35], a[36:39], v[72:75], v[32:35]
v_mfma_f32_16x16x32_bf16 v[36:39], a[36:39], v[76:79], v[36:39]
v_mfma_f32_16x16x32_bf16 v[40:43], a[116:119], v[72:75], v[40:43]
v_mfma_f32_16x16x32_bf16 v[44:47], a[116:119], v[76:79], v[44:47]
v_mfma_f32_16x16x32_bf16 v[48:51], a[196:199], v[72:75], v[48:51]
v_mfma_f32_16x16x32_bf16 v[52:55], a[196:199], v[76:79], v[52:55]
v_mfma_f32_16x16x32_bf16 v[56:59], v[132:135], v[72:75], v[56:59]
v_mfma_f32_16x16x32_bf16 v[60:63], v[132:135], v[76:79], v[60:63]
ds_read_b128 v[72:75], v7 offset:12288
ds_read_b128 v[76:79], v7 offset:32768
s_waitcnt lgkmcnt(4)
v_mfma_f32_16x16x32_bf16 v[32:35], a[40:43], v[80:83], v[32:35]
v_mfma_f32_16x16x32_bf16 v[36:39], a[40:43], v[84:87], v[36:39]
v_mfma_f32_16x16x32_bf16 v[40:43], a[120:123], v[80:83], v[40:43]
v_mfma_f32_16x16x32_bf16 v[44:47], a[120:123], v[84:87], v[44:47]
v_mfma_f32_16x16x32_bf16 v[48:51], a[200:203], v[80:83], v[48:51]
v_mfma_f32_16x16x32_bf16 v[52:55], a[200:203], v[84:87], v[52:55]
v_mfma_f32_16x16x32_bf16 v[56:59], v[136:139], v[80:83], v[56:59]
v_mfma_f32_16x16x32_bf16 v[60:63], v[136:139], v[84:87], v[60:63]
ds_read_b128 v[80:83], v7 offset:13312
ds_read_b128 v[84:87], v7 offset:33792
s_waitcnt lgkmcnt(4)
v_mfma_f32_16x16x32_bf16 v[32:35], a[44:47], v[88:91], v[32:35]
v_mfma_f32_16x16x32_bf16 v[36:39], a[44:47], v[92:95], v[36:39]
v_mfma_f32_16x16x32_bf16 v[40:43], a[124:127], v[88:91], v[40:43]
v_mfma_f32_16x16x32_bf16 v[44:47], a[124:127], v[92:95], v[44:47]
v_mfma_f32_16x16x32_bf16 v[48:51], a[204:207], v[88:91], v[48:51]
v_mfma_f32_16x16x32_bf16 v[52:55], a[204:207], v[92:95], v[52:55]
v_mfma_f32_16x16x32_bf16 v[56:59], v[140:143], v[88:91], v[56:59]
v_mfma_f32_16x16x32_bf16 v[60:63], v[140:143], v[92:95], v[60:63]
ds_read_b128 v[88:91], v7 offset:14336
ds_read_b128 v[92:95], v7 offset:34816
s_waitcnt lgkmcnt(4)
v_mfma_f32_16x16x32_bf16 v[32:35], a[48:51], v[72:75], v[32:35]
v_mfma_f32_16x16x32_bf16 v[36:39], a[48:51], v[76:79], v[36:39]
v_mfma_f32_16x16x32_bf16 v[40:43], a[128:131], v[72:75], v[40:43]
v_mfma_f32_16x16x32_bf16 v[44:47], a[128:131], v[76:79], v[44:47]
v_mfma_f32_16x16x32_bf16 v[48:51], a[208:211], v[72:75], v[48:51]
v_mfma_f32_16x16x32_bf16 v[52:55], a[208:211], v[76:79], v[52:55]
v_mfma_f32_16x16x32_bf16 v[56:59], v[144:147], v[72:75], v[56:59]
v_mfma_f32_16x16x32_bf16 v[60:63], v[144:147], v[76:79], v[60:63]
ds_read_b128 v[72:75], v7 offset:15360
ds_read_b128 v[76:79], v7 offset:35840
s_waitcnt lgkmcnt(4)
v_mfma_f32_16x16x32_bf16 v[32:35], a[52:55], v[80:83], v[32:35]
v_mfma_f32_16x16x32_bf16 v[36:39], a[52:55], v[84:87], v[36:39]
v_mfma_f32_16x16x32_bf16 v[40:43], a[132:135], v[80:83], v[40:43]
v_mfma_f32_16x16x32_bf16 v[44:47], a[132:135], v[84:87], v[44:47]
v_mfma_f32_16x16x32_bf16 v[48:51], a[212:215], v[80:83], v[48:51]
v_mfma_f32_16x16x32_bf16 v[52:55], a[212:215], v[84:87], v[52:55]
v_mfma_f32_16x16x32_bf16 v[56:59], v[148:151], v[80:83], v[56:59]
v_mfma_f32_16x16x32_bf16 v[60:63], v[148:151], v[84:87], v[60:63]
ds_read_b128 v[80:83], v7 offset:16384
ds_read_b128 v[84:87], v7 offset:36864
s_waitcnt lgkmcnt(4)
v_mfma_f32_16x16x32_bf16 v[32:35], a[56:59], v[88:91], v[32:35]
v_mfma_f32_16x16x32_bf16 v[36:39], a[56:59], v[92:95], v[36:39]
v_mfma_f32_16x16x32_bf16 v[40:43], a[136:139], v[88:91], v[40:43]
v_mfma_f32_16x16x32_bf16 v[44:47], a[136:139], v[92:95], v[44:47]
v_mfma_f32_16x16x32_bf16 v[48:51], a[216:219], v[88:91], v[48:51]
v_mfma_f32_16x16x32_bf16 v[52:55], a[216:219], v[92:95], v[52:55]
v_mfma_f32_16x16x32_bf16 v[56:59], v[152:155], v[88:91], v[56:59]
v_mfma_f32_16x16x32_bf16 v[60:63], v[152:155], v[92:95], v[60:63]
ds_read_b128 v[88:91], v7 offset:17408
ds_read_b128 v[92:95], v7 offset:37888
s_waitcnt lgkmcnt(4)
v_mfma_f32_16x16x32_bf16 v[32:35], a[60:63], v[72:75], v[32:35]
v_mfma_f32_16x16x32_bf16 v[36:39], a[60:63], v[76:79], v[36:39]
v_mfma_f32_16x16x32_bf16 v[40:43], a[140:143], v[72:75], v[40:43]
v_mfma_f32_16x16x32_bf16 v[44:47], a[140:143], v[76:79], v[44:47]
v_mfma_f32_16x16x32_bf16 v[48:51], a[220:223], v[72:75], v[48:51]
v_mfma_f32_16x16x32_bf16 v[52:55], a[220:223], v[76:79], v[52:55]
v_mfma_f32_16x16x32_bf16 v[56:59], v[156:159], v[72:75], v[56:59]
v_mfma_f32_16x16x32_bf16 v[60:63], v[156:159], v[76:79], v[60:63]
ds_read_b128 v[72:75], v7 offset:18432
ds_read_b128 v[76:79], v7 offset:38912
s_waitcnt lgkmcnt(4)
v_mfma_f32_16x16x32_bf16 v[32:35], a[64:67], v[80:83], v[32:35]
v_mfma_f32_16x16x32_bf16 v[36:39], a[64:67], v[84:87], v[36:39]
v_mfma_f32_16x16x32_bf16 v[40:43], a[144:147], v[80:83], v[40:43]
v_mfma_f32_16x16x32_bf16 v[44:47], a[144:147], v[84:87], v[44:47]
v_mfma_f32_16x16x32_bf16 v[48:51], a[224:227], v[80:83], v[48:51]
v_mfma_f32_16x16x32_bf16 v[52:55], a[224:227], v[84:87], v[52:55]
v_mfma_f32_16x16x32_bf16 v[56:59], v[160:163], v[80:83], v[56:59]
v_mfma_f32_16x16x32_bf16 v[60:63], v[160:163], v[84:87], v[60:63]
ds_read_b128 v[80:83], v7 offset:19456
ds_read_b128 v[84:87], v7 offset:39936
s_waitcnt lgkmcnt(4)
v_mfma_f32_16x16x32_bf16 v[32:35], a[68:71], v[88:91], v[32:35]
v_mfma_f32_16x16x32_bf16 v[36:39], a[68:71], v[92:95], v[36:39]
v_mfma_f32_16x16x32_bf16 v[40:43], a[148:151], v[88:91], v[40:43]
v_mfma_f32_16x16x32_bf16 v[44:47], a[148:151], v[92:95], v[44:47]
v_mfma_f32_16x16x32_bf16 v[48:51], a[228:231], v[88:91], v[48:51]
v_mfma_f32_16x16x32_bf16 v[52:55], a[228:231], v[92:95], v[52:55]
v_mfma_f32_16x16x32_bf16 v[56:59], v[164:167], v[88:91], v[56:59]
v_mfma_f32_16x16x32_bf16 v[60:63], v[164:167], v[92:95], v[60:63]
s_waitcnt lgkmcnt(2)
v_mfma_f32_16x16x32_bf16 v[32:35], a[72:75], v[72:75], v[32:35]
v_mfma_f32_16x16x32_bf16 v[36:39], a[72:75], v[76:79], v[36:39]
v_mfma_f32_16x16x32_bf16 v[40:43], a[152:155], v[72:75], v[40:43]
v_mfma_f32_16x16x32_bf16 v[44:47], a[152:155], v[76:79], v[44:47]
v_mfma_f32_16x16x32_bf16 v[48:51], a[232:235], v[72:75], v[48:51]
v_mfma_f32_16x16x32_bf16 v[52:55], a[232:235], v[76:79], v[52:55]
v_mfma_f32_16x16x32_bf16 v[56:59], v[168:171], v[72:75], v[56:59]
v_mfma_f32_16x16x32_bf16 v[60:63], v[168:171], v[76:79], v[60:63]
s_waitcnt lgkmcnt(0)
v_mfma_f32_16x16x32_bf16 v[32:35], a[76:79], v[80:83], v[32:35]
v_mfma_f32_16x16x32_bf16 v[36:39], a[76:79], v[84:87], v[36:39]
v_mfma_f32_16x16x32_bf16 v[40:43], a[156:159], v[80:83], v[40:43]
v_mfma_f32_16x16x32_bf16 v[44:47], a[156:159], v[84:87], v[44:47]
v_mfma_f32_16x16x32_bf16 v[48:51], a[236:239], v[80:83], v[48:51]
v_mfma_f32_16x16x32_bf16 v[52:55], a[236:239], v[84:87], v[52:55]
v_mfma_f32_16x16x32_bf16 v[56:59], v[172:175], v[80:83], v[56:59]
v_mfma_f32_16x16x32_bf16 v[60:63], v[172:175], v[84:87], v[60:63]
s_nop 0
v_cvt_pk_bf16_f32 v8, v32, v33
v_cvt_pk_bf16_f32 v9, v34, v35
v_cvt_pk_bf16_f32 v10, v40, v41
v_cvt_pk_bf16_f32 v11, v42, v43
s_add_u32 s34, s22, 1024
buffer_store_dwordx4 v[8:11], v1, s[4:7], s34 offen
v_cvt_pk_bf16_f32 v12, v36, v37
v_cvt_pk_bf16_f32 v13, v38, v39
v_cvt_pk_bf16_f32 v14, v44, v45
v_cvt_pk_bf16_f32 v15, v46, v47
s_add_u32 s34, s22, 7168
buffer_store_dwordx4 v[12:15], v1, s[4:7], s34 offen
v_cvt_pk_bf16_f32 v8, v48, v49
v_cvt_pk_bf16_f32 v9, v50, v51
v_cvt_pk_bf16_f32 v10, v56, v57
v_cvt_pk_bf16_f32 v11, v58, v59
s_add_u32 s34, s22, 2048
buffer_store_dwordx4 v[8:11], v1, s[4:7], s34 offen
v_cvt_pk_bf16_f32 v12, v52, v53
v_cvt_pk_bf16_f32 v13, v54, v55
v_cvt_pk_bf16_f32 v14, v60, v61
v_cvt_pk_bf16_f32 v15, v62, v63
s_add_u32 s34, s22, 8192
buffer_store_dwordx4 v[12:15], v1, s[4:7], s34 offen
s_waitcnt vmcnt(0)
s_barrier
s_add_u32 s17, s17, 1
s_cmp_lt_u32 s17, 64
s_cbranch_scc1 reca_ptop272
s_branch reca_exit1
reca_pslow271:
reca_ptop277:
s_cmp_lt_u32 s17, 3
s_cbranch_scc1 reca_pgo278
s_sub_u32 s36, s17, 3
reca_ppoll279:
buffer_load_dword v28, v4, s[4:7], s25 offen sc1
s_waitcnt vmcnt(0)
v_readfirstlane_b32 s34, v28
s_nop 3
s_cmp_ge_i32 s34, s36
s_cbranch_scc1 reca_pgo278
s_sleep 8
s_sub_u32 s18, s18, 1
s_cbranch_scc0 reca_ppoll279
s_mov_b32 s18, 0
reca_pgo278:
s_waitcnt vmcnt(0)
s_barrier
v_add_u32 v7, s26, v1
s_xor_b32 s26, s26, 40960
s_add_u32 s37, s17, 1
s_cmp_ge_u32 s37, 64
s_cbranch_scc1 reca_pnodma280
s_mul_i32 s20, s37, 40960
s_add_u32 s20, s20, 84965376
s_add_u32 m0, s26, 30720
s_nop 0
buffer_load_dwordx4 v1, s[4:7], s20 offen offset:0 lds
buffer_load_dwordx4 v1, s[4:7], s20 offen offset:1024 lds
buffer_load_dwordx4 v1, s[4:7], s20 offen offset:2048 lds
buffer_load_dwordx4 v1, s[4:7], s20 offen offset:3072 lds
s_add_u32 s20, s20, 4096
s_add_u32 m0, s26, 34816
s_nop 0
buffer_load_dwordx4 v1, s[4:7], s20 offen offset:0 lds
buffer_load_dwordx4 v1, s[4:7], s20 offen offset:1024 lds
buffer_load_dwordx4 v1, s[4:7], s20 offen offset:2048 lds
buffer_load_dwordx4 v1, s[4:7], s20 offen offset:3072 lds
s_add_u32 s20, s20, 4096
s_add_u32 m0, s26, 38912
s_nop 0
buffer_load_dwordx4 v1, s[4:7], s20 offen offset:0 lds
buffer_load_dwordx4 v1, s[4:7], s20 offen offset:1024 lds
reca_pnodma280:
s_lshl_b32 s34, s15, 3
s_and_b32 s35, s17, 7
s_add_u32 s34, s34, s35
s_mul_i32 s34, s34, 12288
s_mul_i32 s35, s16, 3072
s_add_u32 s35, s35, s34
s_add_u32 s21, s35, 37748736
s_add_u32 s22, s35, 44040192
s_mul_i32 s35, s16, 6144
s_add_u32 s35, s35, s34
s_add_u32 s23, s35, 40894464
ds_read_b128 v[72:75], v7 offset:0
ds_read_b128 v[76:79], v7 offset:20480
ds_read_b128 v[80:83], v7 offset:1024
ds_read_b128 v[84:87], v7 offset:21504
ds_read_b128 v[88:91], v7 offset:2048
ds_read_b128 v[92:95], v7 offset:22528
s_waitcnt lgkmcnt(4)
v_mfma_f32_16x16x32_bf16 v[32:35], a[0:3], v[72:75], 0
v_mfma_f32_16x16x32_bf16 v[36:39], a[0:3], v[76:79], 0
v_mfma_f32_16x16x32_bf16 v[40:43], a[80:83], v[72:75], 0
v_mfma_f32_16x16x32_bf16 v[44:47], a[80:83], v[76:79], 0
v_mfma_f32_16x16x32_bf16 v[48:51], a[160:163], v[72:75], 0
v_mfma_f32_16x16x32_bf16 v[52:55], a[160:163], v[76:79], 0
v_mfma_f32_16x16x32_bf16 v[56:59], v[96:99], v[72:75], 0
v_mfma_f32_16x16x32_bf16 v[60:63], v[96:99], v[76:79], 0
ds_read_b128 v[72:75], v7 offset:3072
ds_read_b128 v[76:79], v7 offset:23552
s_waitcnt lgkmcnt(4)
v_mfma_f32_16x16x32_bf16 v[32:35], a[4:7], v[80:83], v[32:35]
v_mfma_f32_16x16x32_bf16 v[36:39], a[4:7], v[84:87], v[36:39]
v_mfma_f32_16x16x32_bf16 v[40:43], a[84:87], v[80:83], v[40:43]
v_mfma_f32_16x16x32_bf16 v[44:47], a[84:87], v[84:87], v[44:47]
v_mfma_f32_16x16x32_bf16 v[48:51], a[164:167], v[80:83], v[48:51]
v_mfma_f32_16x16x32_bf16 v[52:55], a[164:167], v[84:87], v[52:55]
v_mfma_f32_16x16x32_bf16 v[56:59], v[100:103], v[80:83], v[56:59]
v_mfma_f32_16x16x32_bf16 v[60:63], v[100:103], v[84:87], v[60:63]
ds_read_b128 v[80:83], v7 offset:4096
ds_read_b128 v[84:87], v7 offset:24576
s_waitcnt lgkmcnt(4)
v_mfma_f32_16x16x32_bf16 v[32:35], a[8:11], v[88:91], v[32:35]
v_mfma_f32_16x16x32_bf16 v[36:39], a[8:11], v[92:95], v[36:39]
v_mfma_f32_16x16x32_bf16 v[40:43], a[88:91], v[88:91], v[40:43]
v_mfma_f32_16x16x32_bf16 v[44:47], a[88:91], v[92:95], v[44:47]
v_mfma_f32_16x16x32_bf16 v[48:51], a[168:171], v[88:91], v[48:51]
v_mfma_f32_16x16x32_bf16 v[52:55], a[168:171], v[92:95], v[52:55]
v_mfma_f32_16x16x32_bf16 v[56:59], v[104:107], v[88:91], v[56:59]
v_mfma_f32_16x16x32_bf16 v[60:63], v[104:107], v[92:95], v[60:63]
ds_read_b128 v[88:91], v7 offset:5120
ds_read_b128 v[92:95], v7 offset:25600
s_waitcnt lgkmcnt(4)
v_mfma_f32_16x16x32_bf16 v[32:35], a[12:15], v[72:75], v[32:35]
v_mfma_f32_16x16x32_bf16 v[36:39], a[12:15], v[76:79], v[36:39]
v_mfma_f32_16x16x32_bf16 v[40:43], a[92:95], v[72:75], v[40:43]
v_mfma_f32_16x16x32_bf16 v[44:47], a[92:95], v[76:79], v[44:47]
v_mfma_f32_16x16x32_bf16 v[48:51], a[172:175], v[72:75], v[48:51]
v_mfma_f32_16x16x32_bf16 v[52:55], a[172:175], v[76:79], v[52:55]
v_mfma_f32_16x16x32_bf16 v[56:59], v[108:111], v[72:75], v[56:59]
v_mfma_f32_16x16x32_bf16 v[60:63], v[108:111], v[76:79], v[60:63]
ds_read_b128 v[72:75], v7 offset:6144
ds_read_b128 v[76:79], v7 offset:26624
s_waitcnt lgkmcnt(4)
v_mfma_f32_16x16x32_bf16 v[32:35], a[16:19], v[80:83], v[32:35]
v_mfma_f32_16x16x32_bf16 v[36:39], a[16:19], v[84:87], v[36:39]
v_mfma_f32_16x16x32_bf16 v[40:43], a[96:99], v[80:83], v[40:43]
v_mfma_f32_16x16x32_bf16 v[44:47], a[96:99], v[84:87], v[44:47]
v_mfma_f32_16x16x32_bf16 v[48:51], a[176:179], v[80:83], v[48:51]
v_mfma_f32_16x16x32_bf16 v[52:55], a[176:179], v[84:87], v[52:55]
v_mfma_f32_16x16x32_bf16 v[56:59], v[112:115], v[80:83], v[56:59]
v_mfma_f32_16x16x32_bf16 v[60:63], v[112:115], v[84:87], v[60:63]
ds_read_b128 v[80:83], v7 offset:7168
ds_read_b128 v[84:87], v7 offset:27648
s_waitcnt lgkmcnt(4)
v_mfma_f32_16x16x32_bf16 v[32:35], a[20:23], v[88:91], v[32:35]
v_mfma_f32_16x16x32_bf16 v[36:39], a[20:23], v[92:95], v[36:39]
v_mfma_f32_16x16x32_bf16 v[40:43], a[100:103], v[88:91], v[40:43]
v_mfma_f32_16x16x32_bf16 v[44:47], a[100:103], v[92:95], v[44:47]
v_mfma_f32_16x16x32_bf16 v[48:51], a[180:183], v[88:91], v[48:51]
v_mfma_f32_16x16x32_bf16 v[52:55], a[180:183], v[92:95], v[52:55]
v_mfma_f32_16x16x32_bf16 v[56:59], v[116:119], v[88:91], v[56:59]
v_mfma_f32_16x16x32_bf16 v[60:63], v[116:119], v[92:95], v[60:63]
ds_read_b128 v[88:91], v7 offset:8192
ds_read_b128 v[92:95], v7 offset:28672
s_waitcnt lgkmcnt(4)
v_mfma_f32_16x16x32_bf16 v[32:35], a[24:27], v[72:75], v[32:35]
v_mfma_f32_16x16x32_bf16 v[36:39], a[24:27], v[76:79], v[36:39]
v_mfma_f32_16x16x32_bf16 v[40:43], a[104:107], v[72:75], v[40:43]
v_mfma_f32_16x16x32_bf16 v[44:47], a[104:107], v[76:79], v[44:47]
v_mfma_f32_16x16x32_bf16 v[48:51], a[184:187], v[72:75], v[48:51]
v_mfma_f32_16x16x32_bf16 v[52:55], a[184:187], v[76:79], v[52:55]
v_mfma_f32_16x16x32_bf16 v[56:59], v[120:123], v[72:75], v[56:59]
v_mfma_f32_16x16x32_bf16 v[60:63], v[120:123], v[76:79], v[60:63]
ds_read_b128 v[72:75], v7 offset:9216
ds_read_b128 v[76:79], v7 offset:29696
s_waitcnt lgkmcnt(4)
v_mfma_f32_16x16x32_bf16 v[32:35], a[28:31], v[80:83], v[32:35]
v_mfma_f32_16x16x32_bf16 v[36:39], a[28:31], v[84:87], v[36:39]
v_mfma_f32_16x16x32_bf16 v[40:43], a[108:111], v[80:83], v[40:43]
v_mfma_f32_16x16x32_bf16 v[44:47], a[108:111], v[84:87], v[44:47]
v_mfma_f32_16x16x32_bf16 v[48:51], a[188:191], v[80:83], v[48:51]
v_mfma_f32_16x16x32_bf16 v[52:55], a[188:191], v[84:87], v[52:55]
v_mfma_f32_16x16x32_bf16 v[56:59], v[124:127], v[80:83], v[56:59]
v_mfma_f32_16x16x32_bf16 v[60:63], v[124:127], v[84:87], v[60:63]
ds_read_b128 v[80:83], v7 offset:10240
ds_read_b128 v[84:87], v7 offset:30720
s_waitcnt lgkmcnt(4)
v_mfma_f32_16x16x32_bf16 v[32:35], a[32:35], v[88:91], v[32:35]
v_mfma_f32_16x16x32_bf16 v[36:39], a[32:35], v[92:95], v[36:39]
v_mfma_f32_16x16x32_bf16 v[40:43], a[112:115], v[88:91], v[40:43]
v_mfma_f32_16x16x32_bf16 v[44:47], a[112:115], v[92:95], v[44:47]
v_mfma_f32_16x16x32_bf16 v[48:51], a[192:195], v[88:91], v[48:51]
v_mfma_f32_16x16x32_bf16 v[52:55], a[192:195], v[92:95], v[52:55]
v_mfma_f32_16x16x32_bf16 v[56:59], v[128:131], v[88:91], v[56:59]
v_mfma_f32_16x16x32_bf16 v[60:63], v[128:131], v[92:95], v[60:63]
ds_read_b128 v[88:91], v7 offset:11264
ds_read_b128 v[92:95], v7 offset:31744
s_waitcnt lgkmcnt(4)
v_mfma_f32_16x16x32_bf16 v[32:35], a[36:39], v[72:75], v[32:35]
v_mfma_f32_16x16x32_bf16 v[36:39], a[36:39], v[76:79], v[36:39]
v_mfma_f32_16x16x32_bf16 v[40:43], a[116:119], v[72:75], v[40:43]
v_mfma_f32_16x16x32_bf16 v[44:47], a[116:119], v[76:79], v[44:47]
v_mfma_f32_16x16x32_bf16 v[48:51], a[196:199], v[72:75], v[48:51]
v_mfma_f32_16x16x32_bf16 v[52:55], a[196:199], v[76:79], v[52:55]
v_mfma_f32_16x16x32_bf16 v[56:59], v[132:135], v[72:75], v[56:59]
v_mfma_f32_16x16x32_bf16 v[60:63], v[132:135], v[76:79], v[60:63]
ds_read_b128 v[72:75], v7 offset:12288
ds_read_b128 v[76:79], v7 offset:32768
s_waitcnt lgkmcnt(4)
v_mfma_f32_16x16x32_bf16 v[32:35], a[40:43], v[80:83], v[32:35]
v_mfma_f32_16x16x32_bf16 v[36:39], a[40:43], v[84:87], v[36:39]
v_mfma_f32_16x16x32_bf16 v[40:43], a[120:123], v[80:83], v[40:43]
v_mfma_f32_16x16x32_bf16 v[44:47], a[120:123], v[84:87], v[44:47]
v_mfma_f32_16x16x32_bf16 v[48:51], a[200:203], v[80:83], v[48:51]
v_mfma_f32_16x16x32_bf16 v[52:55], a[200:203], v[84:87], v[52:55]
v_mfma_f32_16x16x32_bf16 v[56:59], v[136:139], v[80:83], v[56:59]
v_mfma_f32_16x16x32_bf16 v[60:63], v[136:139], v[84:87], v[60:63]
ds_read_b128 v[80:83], v7 offset:13312
ds_read_b128 v[84:87], v7 offset:33792
s_waitcnt lgkmcnt(4)
v_mfma_f32_16x16x32_bf16 v[32:35], a[44:47], v[88:91], v[32:35]
v_mfma_f32_16x16x32_bf16 v[36:39], a[44:47], v[92:95], v[36:39]
v_mfma_f32_16x16x32_bf16 v[40:43], a[124:127], v[88:91], v[40:43]
v_mfma_f32_16x16x32_bf16 v[44:47], a[124:127], v[92:95], v[44:47]
v_mfma_f32_16x16x32_bf16 v[48:51], a[204:207], v[88:91], v[48:51]
v_mfma_f32_16x16x32_bf16 v[52:55], a[204:207], v[92:95], v[52:55]
v_mfma_f32_16x16x32_bf16 v[56:59], v[140:143], v[88:91], v[56:59]
v_mfma_f32_16x16x32_bf16 v[60:63], v[140:143], v[92:95], v[60:63]
ds_read_b128 v[88:91], v7 offset:14336
ds_read_b128 v[92:95], v7 offset:34816
s_waitcnt lgkmcnt(4)
v_mfma_f32_16x16x32_bf16 v[32:35], a[48:51], v[72:75], v[32:35]
v_mfma_f32_16x16x32_bf16 v[36:39], a[48:51], v[76:79], v[36:39]
v_mfma_f32_16x16x32_bf16 v[40:43], a[128:131], v[72:75], v[40:43]
v_mfma_f32_16x16x32_bf16 v[44:47], a[128:131], v[76:79], v[44:47]
v_mfma_f32_16x16x32_bf16 v[48:51], a[208:211], v[72:75], v[48:51]
v_mfma_f32_16x16x32_bf16 v[52:55], a[208:211], v[76:79], v[52:55]
v_mfma_f32_16x16x32_bf16 v[56:59], v[144:147], v[72:75], v[56:59]
v_mfma_f32_16x16x32_bf16 v[60:63], v[144:147], v[76:79], v[60:63]
ds_read_b128 v[72:75], v7 offset:15360
ds_read_b128 v[76:79], v7 offset:35840
s_waitcnt lgkmcnt(4)
v_mfma_f32_16x16x32_bf16 v[32:35], a[52:55], v[80:83], v[32:35]
v_mfma_f32_16x16x32_bf16 v[36:39], a[52:55], v[84:87], v[36:39]
v_mfma_f32_16x16x32_bf16 v[40:43], a[132:135], v[80:83], v[40:43]
v_mfma_f32_16x16x32_bf16 v[44:47], a[132:135], v[84:87], v[44:47]
v_mfma_f32_16x16x32_bf16 v[48:51], a[212:215], v[80:83], v[48:51]
v_mfma_f32_16x16x32_bf16 v[52:55], a[212:215], v[84:87], v[52:55]
v_mfma_f32_16x16x32_bf16 v[56:59], v[148:151], v[80:83], v[56:59]
v_mfma_f32_16x16x32_bf16 v[60:63], v[148:151], v[84:87], v[60:63]
ds_read_b128 v[80:83], v7 offset:16384
ds_read_b128 v[84:87], v7 offset:36864
s_waitcnt lgkmcnt(4)
v_mfma_f32_16x16x32_bf16 v[32:35], a[56:59], v[88:91], v[32:35]
v_mfma_f32_16x16x32_bf16 v[36:39], a[56:59], v[92:95], v[36:39]
v_mfma_f32_16x16x32_bf16 v[40:43], a[136:139], v[88:91], v[40:43]
v_mfma_f32_16x16x32_bf16 v[44:47], a[136:139], v[92:95], v[44:47]
v_mfma_f32_16x16x32_bf16 v[48:51], a[216:219], v[88:91], v[48:51]
v_mfma_f32_16x16x32_bf16 v[52:55], a[216:219], v[92:95], v[52:55]
v_mfma_f32_16x16x32_bf16 v[56:59], v[152:155], v[88:91], v[56:59]
v_mfma_f32_16x16x32_bf16 v[60:63], v[152:155], v[92:95], v[60:63]
ds_read_b128 v[88:91], v7 offset:17408
ds_read_b128 v[92:95], v7 offset:37888
s_waitcnt lgkmcnt(4)
v_mfma_f32_16x16x32_bf16 v[32:35], a[60:63], v[72:75], v[32:35]
v_mfma_f32_16x16x32_bf16 v[36:39], a[60:63], v[76:79], v[36:39]
v_mfma_f32_16x16x32_bf16 v[40:43], a[140:143], v[72:75], v[40:43]
v_mfma_f32_16x16x32_bf16 v[44:47], a[140:143], v[76:79], v[44:47]
v_mfma_f32_16x16x32_bf16 v[48:51], a[220:223], v[72:75], v[48:51]
v_mfma_f32_16x16x32_bf16 v[52:55], a[220:223], v[76:79], v[52:55]
v_mfma_f32_16x16x32_bf16 v[56:59], v[156:159], v[72:75], v[56:59]
v_mfma_f32_16x16x32_bf16 v[60:63], v[156:159], v[76:79], v[60:63]
ds_read_b128 v[72:75], v7 offset:18432
ds_read_b128 v[76:79], v7 offset:38912
s_waitcnt lgkmcnt(4)
v_mfma_f32_16x16x32_bf16 v[32:35], a[64:67], v[80:83], v[32:35]
v_mfma_f32_16x16x32_bf16 v[36:39], a[64:67], v[84:87], v[36:39]
v_mfma_f32_16x16x32_bf16 v[40:43], a[144:147], v[80:83], v[40:43]
v_mfma_f32_16x16x32_bf16 v[44:47], a[144:147], v[84:87], v[44:47]
v_mfma_f32_16x16x32_bf16 v[48:51], a[224:227], v[80:83], v[48:51]
v_mfma_f32_16x16x32_bf16 v[52:55], a[224:227], v[84:87], v[52:55]
v_mfma_f32_16x16x32_bf16 v[56:59], v[160:163], v[80:83], v[56:59]
v_mfma_f32_16x16x32_bf16 v[60:63], v[160:163], v[84:87], v[60:63]
ds_read_b128 v[80:83], v7 offset:19456
ds_read_b128 v[84:87], v7 offset:39936
s_waitcnt lgkmcnt(4)
v_mfma_f32_16x16x32_bf16 v[32:35], a[68:71], v[88:91], v[32:35]
v_mfma_f32_16x16x32_bf16 v[36:39], a[68:71], v[92:95], v[36:39]
v_mfma_f32_16x16x32_bf16 v[40:43], a[148:151], v[88:91], v[40:43]
v_mfma_f32_16x16x32_bf16 v[44:47], a[148:151], v[92:95], v[44:47]
v_mfma_f32_16x16x32_bf16 v[48:51], a[228:231], v[88:91], v[48:51]
v_mfma_f32_16x16x32_bf16 v[52:55], a[228:231], v[92:95], v[52:55]
v_mfma_f32_16x16x32_bf16 v[56:59], v[164:167], v[88:91], v[56:59]
v_mfma_f32_16x16x32_bf16 v[60:63], v[164:167], v[92:95], v[60:63]
s_waitcnt lgkmcnt(2)
v_mfma_f32_16x16x32_bf16 v[32:35], a[72:75], v[72:75], v[32:35]
v_mfma_f32_16x16x32_bf16 v[36:39], a[72:75], v[76:79], v[36:39]
v_mfma_f32_16x16x32_bf16 v[40:43], a[152:155], v[72:75], v[40:43]
v_mfma_f32_16x16x32_bf16 v[44:47], a[152:155], v[76:79], v[44:47]
v_mfma_f32_16x16x32_bf16 v[48:51], a[232:235], v[72:75], v[48:51]
v_mfma_f32_16x16x32_bf16 v[52:55], a[232:235], v[76:79], v[52:55]
v_mfma_f32_16x16x32_bf16 v[56:59], v[168:171], v[72:75], v[56:59]
v_mfma_f32_16x16x32_bf16 v[60:63], v[168:171], v[76:79], v[60:63]
s_waitcnt lgkmcnt(0)
v_mfma_f32_16x16x32_bf16 v[32:35], a[76:79], v[80:83], v[32:35]
v_mfma_f32_16x16x32_bf16 v[36:39], a[76:79], v[84:87], v[36:39]
v_mfma_f32_16x16x32_bf16 v[40:43], a[156:159], v[80:83], v[40:43]
v_mfma_f32_16x16x32_bf16 v[44:47], a[156:159], v[84:87], v[44:47]
v_mfma_f32_16x16x32_bf16 v[48:51], a[236:239], v[80:83], v[48:51]
v_mfma_f32_16x16x32_bf16 v[52:55], a[236:239], v[84:87], v[52:55]
v_mfma_f32_16x16x32_bf16 v[56:59], v[172:175], v[80:83], v[56:59]
v_mfma_f32_16x16x32_bf16 v[60:63], v[172:175], v[84:87], v[60:63]
s_nop 0
v_cvt_pk_bf16_f32 v8, v32, v33
v_cvt_pk_bf16_f32 v9, v34, v35
v_cvt_pk_bf16_f32 v10, v40, v41
v_cvt_pk_bf16_f32 v11, v42, v43
s_add_u32 s34, s22, 1024
buffer_store_dwordx4 v[8:11], v1, s[4:7], s34 offen sc1
v_cvt_pk_bf16_f32 v12, v36, v37
v_cvt_pk_bf16_f32 v13, v38, v39
v_cvt_pk_bf16_f32 v14, v44, v45
v_cvt_pk_bf16_f32 v15, v46, v47
s_add_u32 s34, s22, 7168
buffer_store_dwordx4 v[12:15], v1, s[4:7], s34 offen sc1
v_cvt_pk_bf16_f32 v8, v48, v49
v_cvt_pk_bf16_f32 v9, v50, v51
v_cvt_pk_bf16_f32 v10, v56, v57
v_cvt_pk_bf16_f32 v11, v58, v59
s_add_u32 s34, s22, 2048
buffer_store_dwordx4 v[8:11], v1, s[4:7], s34 offen sc1
v_cvt_pk_bf16_f32 v12, v52, v53
v_cvt_pk_bf16_f32 v13, v54, v55
v_cvt_pk_bf16_f32 v14, v60, v61
v_cvt_pk_bf16_f32 v15, v62, v63
s_add_u32 s34, s22, 8192
buffer_store_dwordx4 v[12:15], v1, s[4:7], s34 offen sc1
s_waitcnt vmcnt(0)
s_barrier
s_add_u32 s17, s17, 1
s_cmp_lt_u32 s17, 64
s_cbranch_scc1 reca_ptop277
s_branch reca_exit1
reca_exit1:
reca_exitb3:
s_endpgm
.globl fin_kernel
.p2align 8
.type fin_kernel,@function
fin_kernel:
s_cmp_ge_u32 s2, 256
s_cbranch_scc1 fin_exit1
s_load_dwordx2 s[8:9], s[0:1], 96
v_lshrrev_b32 v6, 6, v0
v_and_b32 v7, 63, v0
s_and_b32 s13, s2, 7
v_readfirstlane_b32 s12, v6
v_lshlrev_b32 v1, 4, v7
v_add_u32 v2, 0x1000, v1
v_add_u32 v3, 0x2000, v1
s_lshr_b32 s14, s2, 3
s_lshl_b32 s15, s13, 2
s_add_u32 s15, s15, s12
s_waitcnt lgkmcnt(0)
s_mov_b32 s4, s8
s_mov_b32 s5, s9
s_mov_b32 s6, 0x10000000
s_mov_b32 s7, 0x20000
s_mov_b32 s27, 0x3dd53b95
v_and_b32 v6, 15, v7
v_lshrrev_b32 v8, 4, v7
v_mov_b32 v9, 0x80000000
v_lshlrev_b32 v10, 4, v6
v_lshl_add_u32 v10, v8, 7, v10
v_cmp_gt_u32 vcc, 8, v6
s_nop 1
v_cndmask_b32 v4, v9, v10, vcc
v_lshlrev_b32 v10, 3, v7
v_cmp_gt_u32 vcc, 32, v7
s_nop 1
v_cndmask_b32 v5, v9, v10, vcc
v_mov_b32 v10, 0xf149f2ca
v_cmp_le_u32 vcc, 2, v8
s_nop 1
v_cndmask_b32 v12, 0, v10, vcc
v_mov_b32 v13, v12
v_mov_b32 v14, v12
v_mov_b32 v15, v12
v_lshlrev_b32 v11, 2, v8
v_add_u32 v7, 0, v11
v_cmp_gt_u32 vcc, v7, v6
s_nop 1
v_cndmask_b32 v16, 0, v10, vcc
v_add_u32 v7, 1, v11
v_cmp_gt_u32 vcc, v7, v6
s_nop 1
v_cndmask_b32 v17, 0, v10, vcc
v_add_u32 v7, 2, v11
v_cmp_gt_u32 vcc, v7, v6
s_nop 1
v_cndmask_b32 v18, 0, v10, vcc
v_add_u32 v7, 3, v11
v_cmp_gt_u32 vcc, v7, v6
s_nop 1
v_cndmask_b32 v19, 0, v10, vcc
v_mov_b32 v20, 0x3f803f80
v_mov_b32 v21, 0x3f803f80
v_mov_b32 v22, 0x3f803f80
v_mov_b32 v23, 0x3f803f80
s_mul_i32 s16, s12, 6144
v_add_u32 v240, s16, v1
v_add_u32 v241, 49152, v240
s_mul_i32 s16, s12, 10
s_mul_i32 s16, s16, 192
s_mul_i32 s17, s13, 24
s_add_u32 s16, s16, s17
s_lshl_b32 s16, s16, 10
s_add_u32 s16, s16, 29884416
s_add_u32 s30, s16, 0
s_add_u32 s31, s16, 196608
s_add_u32 s32, s16, 393216
s_add_u32 s33, s16, 589824
s_add_u32 s34, s16, 786432
s_add_u32 s35, s16, 983040
s_add_u32 s36, s16, 1179648
s_add_u32 s37, s16, 1376256
s_add_u32 s38, s16, 1572864
s_add_u32 s39, s16, 1769472
s_cmp_lt_u32 s14, 30
s_cbranch_scc1 fin_odma3
s_lshl_b32 s17, s14, 1
s_add_u32 s17, s17, 0
s_and_b32 s17, s17, 7
s_lshl_b32 s16, s15, 3
s_add_u32 s16, s16, s17
s_mul_i32 s16, s16, 12288
s_add_u32 s20, s16, 44040192
s_add_u32 s21, s16, 37748736
s_add_u32 s22, s16, 40894464
s_lshl_b32 s17, s17, 5
s_add_u32 s17, s17, s15
s_mul_i32 s17, s17, 3072
s_add_u32 s23, s17, 47185920
s_add_u32 s24, s17, 47972352
s_lshl_b32 s17, s14, 1
s_add_u32 s17, s17, 1
s_and_b32 s17, s17, 7
s_lshl_b32 s16, s15, 3
s_add_u32 s16, s16, s17
s_mul_i32 s16, s16, 12288
s_add_u32 s40, s16, 44040192
s_add_u32 s41, s16, 37748736
s_add_u32 s42, s16, 40894464
s_lshl_b32 s17, s17, 5
s_add_u32 s17, s17, s15
s_mul_i32 s17, s17, 3072
s_add_u32 s43, s17, 47185920
s_add_u32 s44, s17, 47972352
buffer_load_dwordx4 v[136:139], v1, s[4:7], s21 offen offset:0
buffer_load_dwordx4 v[140:143], v1, s[4:7], s21 offen offset:1024
buffer_load_dwordx4 v[144:147], v1, s[4:7], s21 offen offset:2048
buffer_load_dwordx4 v[148:151], v1, s[4:7], s21 offen offset:3072
buffer_load_dwordx4 v[152:155], v2, s[4:7], s21 offen offset:0
buffer_load_dwordx4 v[156:159], v2, s[4:7], s21 offen offset:1024
buffer_load_dwordx4 v[160:163], v2, s[4:7], s21 offen offset:2048
buffer_load_dwordx4 v[164:167], v2, s[4:7], s21 offen offset:3072
buffer_load_dwordx4 v[168:171], v3, s[4:7], s21 offen offset:0
buffer_load_dwordx4 v[172:175], v3, s[4:7], s21 offen offset:1024
buffer_load_dwordx4 v[176:179], v3, s[4:7], s21 offen offset:2048
buffer_load_dwordx4 v[180:183], v3, s[4:7], s21 offen offset:3072
buffer_load_dwordx4 v[184:187], v4, s[4:7], s23 offen offset:0
buffer_load_dwordx4 v[188:191], v4, s[4:7], s23 offen offset:512
buffer_load_dwordx4 v[192:195], v4, s[4:7], s23 offen offset:1024
buffer_load_dwordx4 v[196:199], v4, s[4:7], s23 offen offset:1536
buffer_load_dwordx4 v[200:203], v4, s[4:7], s23 offen offset:2048
buffer_load_dwordx4 v[204:207], v4, s[4:7], s23 offen offset:2560
buffer_load_dwordx4 v[88:91], v1, s[4:7], s20 offen offset:0
buffer_load_dwordx4 v[92:95], v1, s[4:7], s20 offen offset:1024
buffer_load_dwordx4 v[96:99], v1, s[4:7], s20 offen offset:2048
buffer_load_dwordx4 v[100:103], v1, s[4:7], s20 offen offset:3072
buffer_load_dwordx4 v[104:107], v2, s[4:7], s20 offen offset:0
buffer_load_dwordx4 v[108:111], v2, s[4:7], s20 offen offset:1024
buffer_load_dwordx4 v[112:115], v2, s[4:7], s20 offen offset:2048
buffer_load_dwordx4 v[116:119], v2, s[4:7], s20 offen offset:3072
buffer_load_dwordx4 v[120:123], v3, s[4:7], s20 offen offset:0
buffer_load_dwordx4 v[124:127], v3, s[4:7], s20 offen offset:1024
buffer_load_dwordx4 v[128:131], v3, s[4:7], s20 offen offset:2048
buffer_load_dwordx4 v[132:135], v3, s[4:7], s20 offen offset:3072
buffer_load_dwordx4 a[0:3], v1, s[4:7], s41 offen offset:0
buffer_load_dwordx4 a[4:7], v1, s[4:7], s41 offen offset:1024
buffer_load_dwordx4 a[8:11], v1, s[4:7], s41 offen offset:2048
buffer_load_dwordx4 a[12:15], v1, s[4:7], s41 offen offset:3072
buffer_load_dwordx4 a[16:19], v2, s[4:7], s41 offen offset:0
buffer_load_dwordx4 a[20:23], v2, s[4:7], s41 offen offset:1024
buffer_load_dwordx4 a[24:27], v2, s[4:7], s41 offen offset:2048
buffer_load_dwordx4 a[28:31], v2, s[4:7], s41 offen offset:3072
buffer_load_dwordx4 a[32:35], v3, s[4:7], s41 offen offset:0
buffer_load_dwordx4 a[36:39], v3, s[4:7], s41 offen offset:1024
buffer_load_dwordx4 a[40:43], v3, s[4:7], s41 offen offset:2048
buffer_load_dwordx4 a[44:47], v3, s[4:7], s41 offen offset:3072
buffer_load_dwordx4 a[48:51], v4, s[4:7], s43 offen offset:0
buffer_load_dwordx4 a[52:55], v4, s[4:7], s43 offen offset:512
buffer_load_dwordx4 a[56:59], v4, s[4:7], s43 offen offset:1024
buffer_load_dwordx4 a[60:63], v4, s[4:7], s43 offen offset:1536
buffer_load_dwordx4 a[64:67], v4, s[4:7], s43 offen offset:2048
buffer_load_dwordx4 a[68:71], v4, s[4:7], s43 offen offset:2560
buffer_load_dwordx4 a[72:75], v1, s[4:7], s40 offen offset:0
buffer_load_dwordx4 a[76:79], v1, s[4:7], s40 offen offset:1024
buffer_load_dwordx4 a[80:83], v1, s[4:7], s40 offen offset:2048
buffer_load_dwordx4 a[84:87], v1, s[4:7], s40 offen offset:3072
buffer_load_dwordx4 a[88:91], v2, s[4:7], s40 offen offset:0
buffer_load_dwordx4 a[92:95], v2, s[4:7], s40 offen offset:1024
buffer_load_dwordx4 a[96:99], v2, s[4:7], s40 offen offset:2048
buffer_load_dwordx4 a[100:103], v2, s[4:7], s40 offen offset:3072
buffer_load_dwordx4 a[104:107], v3, s[4:7], s40 offen offset:0
buffer_load_dwordx4 a[108:111], v3, s[4:7], s40 offen offset:1024
buffer_load_dwordx4 a[112:115], v3, s[4:7], s40 offen offset:2048
buffer_load_dwordx4 a[116:119], v3, s[4:7], s40 offen offset:3072
s_waitcnt vmcnt(35)
v_mfma_f32_16x16x32_bf16 v[24:27], v[184:187], v[88:91], v[12:15]
v_mfma_f32_16x16x32_bf16 v[28:31], v[136:139], v[88:91], v[16:19]
v_mfma_f32_16x16x32_bf16 v[32:35], v[184:187], v[112:115], v[12:15]
v_mfma_f32_16x16x32_bf16 v[36:39], v[136:139], v[112:115], 0
v_mfma_f32_16x16x32_bf16 v[40:43], v[160:163], v[112:115], v[16:19]
s_waitcnt vmcnt(34)
v_mfma_f32_16x16x32_bf16 v[24:27], v[188:191], v[92:95], v[24:27]
v_mfma_f32_16x16x32_bf16 v[28:31], v[140:143], v[92:95], v[28:31]
v_mfma_f32_16x16x32_bf16 v[32:35], v[188:191], v[116:119], v[32:35]
v_mfma_f32_16x16x32_bf16 v[36:39], v[140:143], v[116:119], v[36:39]
v_mfma_f32_16x16x32_bf16 v[40:43], v[164:167], v[116:119], v[40:43]
s_waitcnt vmcnt(33)
v_mfma_f32_16x16x32_bf16 v[24:27], v[192:195], v[96:99], v[24:27]
v_mfma_f32_16x16x32_bf16 v[28:31], v[144:147], v[96:99], v[28:31]
v_mfma_f32_16x16x32_bf16 v[32:35], v[192:195], v[120:123], v[32:35]
v_mfma_f32_16x16x32_bf16 v[36:39], v[144:147], v[120:123], v[36:39]
v_mfma_f32_16x16x32_bf16 v[40:43], v[168:171], v[120:123], v[40:43]
s_waitcnt vmcnt(32)
v_mfma_f32_16x16x32_bf16 v[24:27], v[196:199], v[100:103], v[24:27]
v_mfma_f32_16x16x32_bf16 v[28:31], v[148:151], v[100:103], v[28:31]
v_mfma_f32_16x16x32_bf16 v[32:35], v[196:199], v[124:127], v[32:35]
v_mfma_f32_16x16x32_bf16 v[36:39], v[148:151], v[124:127], v[36:39]
v_mfma_f32_16x16x32_bf16 v[40:43], v[172:175], v[124:127], v[40:43]
s_waitcnt vmcnt(31)
v_mfma_f32_16x16x32_bf16 v[24:27], v[200:203], v[104:107], v[24:27]
v_mfma_f32_16x16x32_bf16 v[28:31], v[152:155], v[104:107], v[28:31]
v_mfma_f32_16x16x32_bf16 v[32:35], v[200:203], v[128:131], v[32:35]
v_mfma_f32_16x16x32_bf16 v[36:39], v[152:155], v[128:131], v[36:39]
v_mfma_f32_16x16x32_bf16 v[40:43], v[176:179], v[128:131], v[40:43]
s_waitcnt vmcnt(30)
v_mfma_f32_16x16x32_bf16 v[24:27], v[204:207], v[108:111], v[24:27]
v_mfma_f32_16x16x32_bf16 v[28:31], v[156:159], v[108:111], v[28:31]
v_mfma_f32_16x16x32_bf16 v[32:35], v[204:207], v[132:135], v[32:35]
v_mfma_f32_16x16x32_bf16 v[36:39], v[156:159], v[132:135], v[36:39]
v_mfma_f32_16x16x32_bf16 v[40:43], v[180:183], v[132:135], v[40:43]
buffer_load_dwordx4 v[88:91], v1, s[4:7], s22 offen offset:0
buffer_load_dwordx4 v[92:95], v1, s[4:7], s22 offen offset:1024
buffer_load_dwordx4 v[96:99], v1, s[4:7], s22 offen offset:2048
buffer_load_dwordx4 v[100:103], v1, s[4:7], s22 offen offset:3072
buffer_load_dwordx4 v[104:107], v2, s[4:7], s22 offen offset:0
buffer_load_dwordx4 v[108:111], v2, s[4:7], s22 offen offset:1024
buffer_load_dwordx4 v[112:115], v2, s[4:7], s22 offen offset:2048
buffer_load_dwordx4 v[116:119], v2, s[4:7], s22 offen offset:3072
buffer_load_dwordx4 v[120:123], v3, s[4:7], s22 offen offset:0
buffer_load_dwordx4 v[124:127], v3, s[4:7], s22 offen offset:1024
buffer_load_dwordx4 v[128:131], v3, s[4:7], s22 offen offset:2048
buffer_load_dwordx4 v[132:135], v3, s[4:7], s22 offen offset:3072
buffer_load_dwordx2 v[136:137], v5, s[4:7], s24 offen offset:0
buffer_load_dwordx2 v[138:139], v5, s[4:7], s24 offen offset:256
buffer_load_dwordx2 v[140:141], v5, s[4:7], s24 offen offset:512
buffer_load_dwordx2 v[142:143], v5, s[4:7], s24 offen offset:768
buffer_load_dwordx2 v[144:145], v5, s[4:7], s24 offen offset:1024
buffer_load_dwordx2 v[146:147], v5, s[4:7], s24 offen offset:1280
buffer_load_dwordx2 v[148:149], v5, s[4:7], s24 offen offset:1536
buffer_load_dwordx2 v[150:151], v5, s[4:7], s24 offen offset:1792
buffer_load_dwordx2 v[152:153], v5, s[4:7], s24 offen offset:2048
buffer_load_dwordx2 v[154:155], v5, s[4:7], s24 offen offset:2304
buffer_load_dwordx2 v[156:157], v5, s[4:7], s24 offen offset:2560
buffer_load_dwordx2 v[158:159], v5, s[4:7], s24 offen offset:2816
v_max3_f32 v6, v24, v25, v26
v_max3_f32 v6, v6, v27, v28
v_max3_f32 v6, v6, v29, v30
v_max_f32 v6, v6, v31
v_mov_b32 v7, v6
s_nop 1
v_permlane32_swap_b32 v6, v7
v_max_f32 v6, v6, v7
v_mov_b32 v7, v6
s_nop 1
v_permlane16_swap_b32 v6, v7
v_max_f32 v6, v6, v7
v_mul_f32 v6, s27, v6
v_fma_f32 v24, v24, s27, -v6
v_fma_f32 v25, v25, s27, -v6
v_fma_f32 v26, v26, s27, -v6
v_fma_f32 v27, v27, s27, -v6
v_fma_f32 v28, v28, s27, -v6
v_fma_f32 v29, v29, s27, -v6
v_fma_f32 v30, v30, s27, -v6
v_fma_f32 v31, v31, s27, -v6
v_exp_f32 v24, v24
v_exp_f32 v25, v25
v_exp_f32 v26, v26
v_exp_f32 v27, v27
v_exp_f32 v28, v28
v_exp_f32 v29, v29
v_exp_f32 v30, v30
v_exp_f32 v31, v31
v_max3_f32 v8, v32, v33, v34
v_max3_f32 v8, v8, v35, v36
v_max3_f32 v8, v8, v37, v38
v_max3_f32 v8, v8, v39, v40
v_max3_f32 v8, v8, v41, v42
v_max_f32 v8, v8, v43
v_mov_b32 v10, v8
s_nop 1
v_permlane32_swap_b32 v8, v10
v_max_f32 v8, v8, v10
v_mov_b32 v10, v8
s_nop 1
v_permlane16_swap_b32 v8, v10
v_max_f32 v8, v8, v10
v_mul_f32 v8, s27, v8
v_fma_f32 v32, v32, s27, -v8
v_fma_f32 v33, v33, s27, -v8
v_fma_f32 v34, v34, s27, -v8
v_fma_f32 v35, v35, s27, -v8
v_fma_f32 v36, v36, s27, -v8
v_fma_f32 v37, v37, s27, -v8
v_fma_f32 v38, v38, s27, -v8
v_fma_f32 v39, v39, s27, -v8
v_fma_f32 v40, v40, s27, -v8
v_fma_f32 v41, v41, s27, -v8
v_fma_f32 v42, v42, s27, -v8
v_fma_f32 v43, v43, s27, -v8
v_exp_f32 v32, v32
v_exp_f32 v33, v33
v_exp_f32 v34, v34
v_exp_f32 v35, v35
v_exp_f32 v36, v36
v_exp_f32 v37, v37
v_exp_f32 v38, v38
v_exp_f32 v39, v39
v_exp_f32 v40, v40
v_exp_f32 v41, v41
v_exp_f32 v42, v42
v_exp_f32 v43, v43
v_cvt_pk_bf16_f32 v44, v24, v25
v_cvt_pk_bf16_f32 v45, v26, v27
v_cvt_pk_bf16_f32 v46, v28, v29
v_cvt_pk_bf16_f32 v47, v30, v31
v_cvt_pk_bf16_f32 v48, v32, v33
v_cvt_pk_bf16_f32 v49, v34, v35
v_cvt_pk_bf16_f32 v50, v36, v37
v_cvt_pk_bf16_f32 v51, v38, v39
v_cvt_pk_bf16_f32 v52, v40, v41
v_cvt_pk_bf16_f32 v53, v42, v43
v_mfma_f32_16x16x16_bf16 v[56:59], v[20:21], v[44:45], 0
v_mfma_f32_16x16x16_bf16 v[60:63], v[20:21], v[48:49], 0
v_mfma_f32_16x16x16_bf16 v[56:59], v[20:21], v[46:47], v[56:59]
v_mfma_f32_16x16x32_bf16 v[60:63], v[20:23], v[50:53], v[60:63]
s_nop 6
v_rcp_f32 v10, v56
v_rcp_f32 v11, v60
s_waitcnt vmcnt(0)
v_mfma_f32_16x16x16_bf16 v[64:67], v[136:137], v[44:45], 0
v_mfma_f32_16x16x16_bf16 v[68:71], v[136:137], v[48:49], 0
v_mfma_f32_16x16x16_bf16 v[64:67], v[88:89], v[46:47], v[64:67]
v_mfma_f32_16x16x32_bf16 v[68:71], v[88:91], v[50:53], v[68:71]
v_mfma_f32_16x16x16_bf16 v[72:75], v[138:139], v[44:45], 0
v_mfma_f32_16x16x16_bf16 v[76:79], v[138:139], v[48:49], 0
v_mfma_f32_16x16x16_bf16 v[72:75], v[92:93], v[46:47], v[72:75]
v_mfma_f32_16x16x32_bf16 v[76:79], v[92:95], v[50:53], v[76:79]
s_nop 2
v_mul_f32 v64, v64, v10
v_mul_f32 v65, v65, v10
v_mul_f32 v66, v66, v10
v_mul_f32 v67, v67, v10
v_cvt_pk_bf16_f32 v80, v64, v65
v_cvt_pk_bf16_f32 v81, v66, v67
v_mul_f32 v72, v72, v10
v_mul_f32 v73, v73, v10
v_mul_f32 v74, v74, v10
v_mul_f32 v75, v75, v10
v_cvt_pk_bf16_f32 v82, v72, v73
v_cvt_pk_bf16_f32 v83, v74, v75
ds_write_b128 v240, v[80:83] offset:0
v_mul_f32 v68, v68, v11
v_mul_f32 v69, v69, v11
v_mul_f32 v70, v70, v11
v_mul_f32 v71, v71, v11
v_cvt_pk_bf16_f32 v84, v68, v69
v_cvt_pk_bf16_f32 v85, v70, v71
v_mul_f32 v76, v76, v11
v_mul_f32 v77, v77, v11
v_mul_f32 v78, v78, v11
v_mul_f32 v79, v79, v11
v_cvt_pk_bf16_f32 v86, v76, v77
v_cvt_pk_bf16_f32 v87, v78, v79
ds_write_b128 v240, v[84:87] offset:24576
v_mfma_f32_16x16x16_bf16 v[64:67], v[140:141], v[44:45], 0
v_mfma_f32_16x16x16_bf16 v[68:71], v[140:141], v[48:49], 0
v_mfma_f32_16x16x16_bf16 v[64:67], v[96:97], v[46:47], v[64:67]
v_mfma_f32_16x16x32_bf16 v[68:71], v[96:99], v[50:53], v[68:71]
v_mfma_f32_16x16x16_bf16 v[72:75], v[142:143], v[44:45], 0
v_mfma_f32_16x16x16_bf16 v[76:79], v[142:143], v[48:49], 0
v_mfma_f32_16x16x16_bf16 v[72:75], v[100:101], v[46:47], v[72:75]
v_mfma_f32_16x16x32_bf16 v[76:79], v[100:103], v[50:53], v[76:79]
s_nop 2
v_mul_f32 v64, v64, v10
v_mul_f32 v65, v65, v10
v_mul_f32 v66, v66, v10
v_mul_f32 v67, v67, v10
v_cvt_pk_bf16_f32 v80, v64, v65
v_cvt_pk_bf16_f32 v81, v66, v67
v_mul_f32 v72, v72, v10
v_mul_f32 v73, v73, v10
v_mul_f32 v74, v74, v10
v_mul_f32 v75, v75, v10
v_cvt_pk_bf16_f32 v82, v72, v73
v_cvt_pk_bf16_f32 v83, v74, v75
ds_write_b128 v240, v[80:83] offset:1024
v_mul_f32 v68, v68, v11
v_mul_f32 v69, v69, v11
v_mul_f32 v70, v70, v11
v_mul_f32 v71, v71, v11
v_cvt_pk_bf16_f32 v84, v68, v69
v_cvt_pk_bf16_f32 v85, v70, v71
v_mul_f32 v76, v76, v11
v_mul_f32 v77, v77, v11
v_mul_f32 v78, v78, v11
v_mul_f32 v79, v79, v11
v_cvt_pk_bf16_f32 v86, v76, v77
v_cvt_pk_bf16_f32 v87, v78, v79
ds_write_b128 v240, v[84:87] offset:25600
v_mfma_f32_16x16x16_bf16 v[64:67], v[144:145], v[44:45], 0
v_mfma_f32_16x16x16_bf16 v[68:71], v[144:145], v[48:49], 0
v_mfma_f32_16x16x16_bf16 v[64:67], v[104:105], v[46:47], v[64:67]
v_mfma_f32_16x16x32_bf16 v[68:71], v[104:107], v[50:53], v[68:71]
v_mfma_f32_16x16x16_bf16 v[72:75], v[146:147], v[44:45], 0
v_mfma_f32_16x16x16_bf16 v[76:79], v[146:147], v[48:49], 0
v_mfma_f32_16x16x16_bf16 v[72:75], v[108:109], v[46:47], v[72:75]
v_mfma_f32_16x16x32_bf16 v[76:79], v[108:111], v[50:53], v[76:79]
s_nop 2
v_mul_f32 v64, v64, v10
v_mul_f32 v65, v65, v10
v_mul_f32 v66, v66, v10
v_mul_f32 v67, v67, v10
v_cvt_pk_bf16_f32 v80, v64, v65
v_cvt_pk_bf16_f32 v81, v66, v67
v_mul_f32 v72, v72, v10
v_mul_f32 v73, v73, v10
v_mul_f32 v74, v74, v10
v_mul_f32 v75, v75, v10
v_cvt_pk_bf16_f32 v82, v72, v73
v_cvt_pk_bf16_f32 v83, v74, v75
ds_write_b128 v240, v[80:83] offset:2048
v_mul_f32 v68, v68, v11
v_mul_f32 v69, v69, v11
v_mul_f32 v70, v70, v11
v_mul_f32 v71, v71, v11
v_cvt_pk_bf16_f32 v84, v68, v69
v_cvt_pk_bf16_f32 v85, v70, v71
v_mul_f32 v76, v76, v11
v_mul_f32 v77, v77, v11
v_mul_f32 v78, v78, v11
v_mul_f32 v79, v79, v11
v_cvt_pk_bf16_f32 v86, v76, v77
v_cvt_pk_bf16_f32 v87, v78, v79
ds_write_b128 v240, v[84:87] offset:26624
v_mfma_f32_16x16x16_bf16 v[64:67], v[148:149], v[44:45], 0
v_mfma_f32_16x16x16_bf16 v[68:71], v[148:149], v[48:49], 0
v_mfma_f32_16x16x16_bf16 v[64:67], v[112:113], v[46:47], v[64:67]
v_mfma_f32_16x16x32_bf16 v[68:71], v[112:115], v[50:53], v[68:71]
v_mfma_f32_16x16x16_bf16 v[72:75], v[150:151], v[44:45], 0
v_mfma_f32_16x16x16_bf16 v[76:79], v[150:151], v[48:49], 0
v_mfma_f32_16x16x16_bf16 v[72:75], v[116:117], v[46:47], v[72:75]
v_mfma_f32_16x16x32_bf16 v[76:79], v[116:119], v[50:53], v[76:79]
s_nop 2
v_mul_f32 v64, v64, v10
v_mul_f32 v65, v65, v10
v_mul_f32 v66, v66, v10
v_mul_f32 v67, v67, v10
v_cvt_pk_bf16_f32 v80, v64, v65
v_cvt_pk_bf16_f32 v81, v66, v67
v_mul_f32 v72, v72, v10
v_mul_f32 v73, v73, v10
v_mul_f32 v74, v74, v10
v_mul_f32 v75, v75, v10
v_cvt_pk_bf16_f32 v82, v72, v73
v_cvt_pk_bf16_f32 v83, v74, v75
ds_write_b128 v240, v[80:83] offset:3072
v_mul_f32 v68, v68, v11
v_mul_f32 v69, v69, v11
v_mul_f32 v70, v70, v11
v_mul_f32 v71, v71, v11
v_cvt_pk_bf16_f32 v84, v68, v69
v_cvt_pk_bf16_f32 v85, v70, v71
v_mul_f32 v76, v76, v11
v_mul_f32 v77, v77, v11
v_mul_f32 v78, v78, v11
v_mul_f32 v79, v79, v11
v_cvt_pk_bf16_f32 v86, v76, v77
v_cvt_pk_bf16_f32 v87, v78, v79
ds_write_b128 v240, v[84:87] offset:27648
v_mfma_f32_16x16x16_bf16 v[64:67], v[152:153], v[44:45], 0
v_mfma_f32_16x16x16_bf16 v[68:71], v[152:153], v[48:49], 0
v_mfma_f32_16x16x16_bf16 v[64:67], v[120:121], v[46:47], v[64:67]
v_mfma_f32_16x16x32_bf16 v[68:71], v[120:123], v[50:53], v[68:71]
v_mfma_f32_16x16x16_bf16 v[72:75], v[154:155], v[44:45], 0
v_mfma_f32_16x16x16_bf16 v[76:79], v[154:155], v[48:49], 0
v_mfma_f32_16x16x16_bf16 v[72:75], v[124:125], v[46:47], v[72:75]
v_mfma_f32_16x16x32_bf16 v[76:79], v[124:127], v[50:53], v[76:79]
s_nop 2
v_mul_f32 v64, v64, v10
v_mul_f32 v65, v65, v10
v_mul_f32 v66, v66, v10
v_mul_f32 v67, v67, v10
v_cvt_pk_bf16_f32 v80, v64, v65
v_cvt_pk_bf16_f32 v81, v66, v67
v_mul_f32 v72, v72, v10
v_mul_f32 v73, v73, v10
v_mul_f32 v74, v74, v10
v_mul_f32 v75, v75, v10
v_cvt_pk_bf16_f32 v82, v72, v73
v_cvt_pk_bf16_f32 v83, v74, v75
ds_write_b128 v240, v[80:83] offset:4096
v_mul_f32 v68, v68, v11
v_mul_f32 v69, v69, v11
v_mul_f32 v70, v70, v11
v_mul_f32 v71, v71, v11
v_cvt_pk_bf16_f32 v84, v68, v69
v_cvt_pk_bf16_f32 v85, v70, v71
v_mul_f32 v76, v76, v11
v_mul_f32 v77, v77, v11
v_mul_f32 v78, v78, v11
v_mul_f32 v79, v79, v11
v_cvt_pk_bf16_f32 v86, v76, v77
v_cvt_pk_bf16_f32 v87, v78, v79
ds_write_b128 v240, v[84:87] offset:28672
v_mfma_f32_16x16x16_bf16 v[64:67], v[156:157], v[44:45], 0
v_mfma_f32_16x16x16_bf16 v[68:71], v[156:157], v[48:49], 0
v_mfma_f32_16x16x16_bf16 v[64:67], v[128:129], v[46:47], v[64:67]
v_mfma_f32_16x16x32_bf16 v[68:71], v[128:131], v[50:53], v[68:71]
v_mfma_f32_16x16x16_bf16 v[72:75], v[158:159], v[44:45], 0
v_mfma_f32_16x16x16_bf16 v[76:79], v[158:159], v[48:49], 0
v_mfma_f32_16x16x16_bf16 v[72:75], v[132:133], v[46:47], v[72:75]
v_mfma_f32_16x16x32_bf16 v[76:79], v[132:135], v[50:53], v[76:79]
s_nop 2
v_mul_f32 v64, v64, v10
v_mul_f32 v65, v65, v10
v_mul_f32 v66, v66, v10
v_mul_f32 v67, v67, v10
v_cvt_pk_bf16_f32 v80, v64, v65
v_cvt_pk_bf16_f32 v81, v66, v67
v_mul_f32 v72, v72, v10
v_mul_f32 v73, v73, v10
v_mul_f32 v74, v74, v10
v_mul_f32 v75, v75, v10
v_cvt_pk_bf16_f32 v82, v72, v73
v_cvt_pk_bf16_f32 v83, v74, v75
ds_write_b128 v240, v[80:83] offset:5120
v_mul_f32 v68, v68, v11
v_mul_f32 v69, v69, v11
v_mul_f32 v70, v70, v11
v_mul_f32 v71, v71, v11
v_cvt_pk_bf16_f32 v84, v68, v69
v_cvt_pk_bf16_f32 v85, v70, v71
v_mul_f32 v76, v76, v11
v_mul_f32 v77, v77, v11
v_mul_f32 v78, v78, v11
v_mul_f32 v79, v79, v11
v_cvt_pk_bf16_f32 v86, v76, v77
v_cvt_pk_bf16_f32 v87, v78, v79
ds_write_b128 v240, v[84:87] offset:29696
v_mfma_f32_16x16x32_bf16 v[24:27], a[48:51], a[72:75], v[12:15]
v_mfma_f32_16x16x32_bf16 v[28:31], a[0:3], a[72:75], v[16:19]
v_mfma_f32_16x16x32_bf16 v[32:35], a[48:51], a[96:99], v[12:15]
v_mfma_f32_16x16x32_bf16 v[36:39], a[0:3], a[96:99], 0
v_mfma_f32_16x16x32_bf16 v[40:43], a[24:27], a[96:99], v[16:19]
v_mfma_f32_16x16x32_bf16 v[24:27], a[52:55], a[76:79], v[24:27]
v_mfma_f32_16x16x32_bf16 v[28:31], a[4:7], a[76:79], v[28:31]
v_mfma_f32_16x16x32_bf16 v[32:35], a[52:55], a[100:103], v[32:35]
v_mfma_f32_16x16x32_bf16 v[36:39], a[4:7], a[100:103], v[36:39]
v_mfma_f32_16x16x32_bf16 v[40:43], a[28:31], a[100:103], v[40:43]
v_mfma_f32_16x16x32_bf16 v[24:27], a[56:59], a[80:83], v[24:27]
v_mfma_f32_16x16x32_bf16 v[28:31], a[8:11], a[80:83], v[28:31]
v_mfma_f32_16x16x32_bf16 v[32:35], a[56:59], a[104:107], v[32:35]
v_mfma_f32_16x16x32_bf16 v[36:39], a[8:11], a[104:107], v[36:39]
v_mfma_f32_16x16x32_bf16 v[40:43], a[32:35], a[104:107], v[40:43]
v_mfma_f32_16x16x32_bf16 v[24:27], a[60:63], a[84:87], v[24:27]
v_mfma_f32_16x16x32_bf16 v[28:31], a[12:15], a[84:87], v[28:31]
v_mfma_f32_16x16x32_bf16 v[32:35], a[60:63], a[108:111], v[32:35]
v_mfma_f32_16x16x32_bf16 v[36:39], a[12:15], a[108:111], v[36:39]
v_mfma_f32_16x16x32_bf16 v[40:43], a[36:39], a[108:111], v[40:43]
v_mfma_f32_16x16x32_bf16 v[24:27], a[64:67], a[88:91], v[24:27]
v_mfma_f32_16x16x32_bf16 v[28:31], a[16:19], a[88:91], v[28:31]
v_mfma_f32_16x16x32_bf16 v[32:35], a[64:67], a[112:115], v[32:35]
v_mfma_f32_16x16x32_bf16 v[36:39], a[16:19], a[112:115], v[36:39]
v_mfma_f32_16x16x32_bf16 v[40:43], a[40:43], a[112:115], v[40:43]
v_mfma_f32_16x16x32_bf16 v[24:27], a[68:71], a[92:95], v[24:27]
v_mfma_f32_16x16x32_bf16 v[28:31], a[20:23], a[92:95], v[28:31]
v_mfma_f32_16x16x32_bf16 v[32:35], a[68:71], a[116:119], v[32:35]
v_mfma_f32_16x16x32_bf16 v[36:39], a[20:23], a[116:119], v[36:39]
v_mfma_f32_16x16x32_bf16 v[40:43], a[44:47], a[116:119], v[40:43]
buffer_load_dwordx4 v[88:91], v1, s[4:7], s42 offen offset:0
buffer_load_dwordx4 v[92:95], v1, s[4:7], s42 offen offset:1024
buffer_load_dwordx4 v[96:99], v1, s[4:7], s42 offen offset:2048
buffer_load_dwordx4 v[100:103], v1, s[4:7], s42 offen offset:3072
buffer_load_dwordx4 v[104:107], v2, s[4:7], s42 offen offset:0
buffer_load_dwordx4 v[108:111], v2, s[4:7], s42 offen offset:1024
buffer_load_dwordx4 v[112:115], v2, s[4:7], s42 offen offset:2048
buffer_load_dwordx4 v[116:119], v2, s[4:7], s42 offen offset:3072
buffer_load_dwordx4 v[120:123], v3, s[4:7], s42 offen offset:0
buffer_load_dwordx4 v[124:127], v3, s[4:7], s42 offen offset:1024
buffer_load_dwordx4 v[128:131], v3, s[4:7], s42 offen offset:2048
buffer_load_dwordx4 v[132:135], v3, s[4:7], s42 offen offset:3072
buffer_load_dwordx2 v[136:137], v5, s[4:7], s44 offen offset:0
buffer_load_dwordx2 v[138:139], v5, s[4:7], s44 offen offset:256
buffer_load_dwordx2 v[140:141], v5, s[4:7], s44 offen offset:512
buffer_load_dwordx2 v[142:143], v5, s[4:7], s44 offen offset:768
buffer_load_dwordx2 v[144:145], v5, s[4:7], s44 offen offset:1024
buffer_load_dwordx2 v[146:147], v5, s[4:7], s44 offen offset:1280
buffer_load_dwordx2 v[148:149], v5, s[4:7], s44 offen offset:1536
buffer_load_dwordx2 v[150:151], v5, s[4:7], s44 offen offset:1792
buffer_load_dwordx2 v[152:153], v5, s[4:7], s44 offen offset:2048
buffer_load_dwordx2 v[154:155], v5, s[4:7], s44 offen offset:2304
buffer_load_dwordx2 v[156:157], v5, s[4:7], s44 offen offset:2560
buffer_load_dwordx2 v[158:159], v5, s[4:7], s44 offen offset:2816
v_max3_f32 v6, v24, v25, v26
v_max3_f32 v6, v6, v27, v28
v_max3_f32 v6, v6, v29, v30
v_max_f32 v6, v6, v31
v_mov_b32 v7, v6
s_nop 1
v_permlane32_swap_b32 v6, v7
v_max_f32 v6, v6, v7
v_mov_b32 v7, v6
s_nop 1
v_permlane16_swap_b32 v6, v7
v_max_f32 v6, v6, v7
v_mul_f32 v6, s27, v6
v_fma_f32 v24, v24, s27, -v6
v_fma_f32 v25, v25, s27, -v6
v_fma_f32 v26, v26, s27, -v6
v_fma_f32 v27, v27, s27, -v6
v_fma_f32 v28, v28, s27, -v6
v_fma_f32 v29, v29, s27, -v6
v_fma_f32 v30, v30, s27, -v6
v_fma_f32 v31, v31, s27, -v6
v_exp_f32 v24, v24
v_exp_f32 v25, v25
v_exp_f32 v26, v26
v_exp_f32 v27, v27
v_exp_f32 v28, v28
v_exp_f32 v29, v29
v_exp_f32 v30, v30
v_exp_f32 v31, v31
v_max3_f32 v8, v32, v33, v34
v_max3_f32 v8, v8, v35, v36
v_max3_f32 v8, v8, v37, v38
v_max3_f32 v8, v8, v39, v40
v_max3_f32 v8, v8, v41, v42
v_max_f32 v8, v8, v43
v_mov_b32 v10, v8
s_nop 1
v_permlane32_swap_b32 v8, v10
v_max_f32 v8, v8, v10
v_mov_b32 v10, v8
s_nop 1
v_permlane16_swap_b32 v8, v10
v_max_f32 v8, v8, v10
v_mul_f32 v8, s27, v8
v_fma_f32 v32, v32, s27, -v8
v_fma_f32 v33, v33, s27, -v8
v_fma_f32 v34, v34, s27, -v8
v_fma_f32 v35, v35, s27, -v8
v_fma_f32 v36, v36, s27, -v8
v_fma_f32 v37, v37, s27, -v8
v_fma_f32 v38, v38, s27, -v8
v_fma_f32 v39, v39, s27, -v8
v_fma_f32 v40, v40, s27, -v8
v_fma_f32 v41, v41, s27, -v8
v_fma_f32 v42, v42, s27, -v8
v_fma_f32 v43, v43, s27, -v8
v_exp_f32 v32, v32
v_exp_f32 v33, v33
v_exp_f32 v34, v34
v_exp_f32 v35, v35
v_exp_f32 v36, v36
v_exp_f32 v37, v37
v_exp_f32 v38, v38
v_exp_f32 v39, v39
v_exp_f32 v40, v40
v_exp_f32 v41, v41
v_exp_f32 v42, v42
v_exp_f32 v43, v43
v_cvt_pk_bf16_f32 v44, v24, v25
v_cvt_pk_bf16_f32 v45, v26, v27
v_cvt_pk_bf16_f32 v46, v28, v29
v_cvt_pk_bf16_f32 v47, v30, v31
v_cvt_pk_bf16_f32 v48, v32, v33
v_cvt_pk_bf16_f32 v49, v34, v35
v_cvt_pk_bf16_f32 v50, v36, v37
v_cvt_pk_bf16_f32 v51, v38, v39
v_cvt_pk_bf16_f32 v52, v40, v41
v_cvt_pk_bf16_f32 v53, v42, v43
v_mfma_f32_16x16x16_bf16 v[56:59], v[20:21], v[44:45], 0
v_mfma_f32_16x16x16_bf16 v[60:63], v[20:21], v[48:49], 0
v_mfma_f32_16x16x16_bf16 v[56:59], v[20:21], v[46:47], v[56:59]
v_mfma_f32_16x16x32_bf16 v[60:63], v[20:23], v[50:53], v[60:63]
s_nop 6
v_rcp_f32 v10, v56
v_rcp_f32 v11, v60
s_waitcnt vmcnt(0)
buffer_load_dwordx4 a[160:163], v1, s[4:7], s30 offen offset:0
buffer_load_dwordx4 a[164:167], v1, s[4:7], s31 offen offset:0
buffer_load_dwordx4 a[168:171], v1, s[4:7], s32 offen offset:0
buffer_load_dwordx4 a[172:175], v1, s[4:7], s33 offen offset:0
buffer_load_dwordx4 a[176:179], v1, s[4:7], s34 offen offset:0
buffer_load_dwordx4 a[180:183], v1, s[4:7], s35 offen offset:0
buffer_load_dwordx4 a[184:187], v1, s[4:7], s36 offen offset:0
buffer_load_dwordx4 a[188:191], v1, s[4:7], s37 offen offset:0
buffer_load_dwordx4 a[192:195], v1, s[4:7], s38 offen offset:0
buffer_load_dwordx4 a[196:199], v1, s[4:7], s39 offen offset:0
buffer_load_dwordx4 a[200:203], v1, s[4:7], s30 offen offset:1024
buffer_load_dwordx4 a[204:207], v1, s[4:7], s31 offen offset:1024
buffer_load_dwordx4 a[208:211], v1, s[4:7], s32 offen offset:1024
buffer_load_dwordx4 a[212:215], v1, s[4:7], s33 offen offset:1024
buffer_load_dwordx4 a[216:219], v1, s[4:7], s34 offen offset:1024
buffer_load_dwordx4 a[220:223], v1, s[4:7], s35 offen offset:1024
buffer_load_dwordx4 a[224:227], v1, s[4:7], s36 offen offset:1024
buffer_load_dwordx4 a[228:231], v1, s[4:7], s37 offen offset:1024
buffer_load_dwordx4 a[232:235], v1, s[4:7], s38 offen offset:1024
buffer_load_dwordx4 a[236:239], v1, s[4:7], s39 offen offset:1024
v_mfma_f32_16x16x16_bf16 v[64:67], v[136:137], v[44:45], 0
v_mfma_f32_16x16x16_bf16 v[68:71], v[136:137], v[48:49], 0
v_mfma_f32_16x16x16_bf16 v[64:67], v[88:89], v[46:47], v[64:67]
v_mfma_f32_16x16x32_bf16 v[68:71], v[88:91], v[50:53], v[68:71]
v_mfma_f32_16x16x16_bf16 v[72:75], v[138:139], v[44:45], 0
v_mfma_f32_16x16x16_bf16 v[76:79], v[138:139], v[48:49], 0
v_mfma_f32_16x16x16_bf16 v[72:75], v[92:93], v[46:47], v[72:75]
v_mfma_f32_16x16x32_bf16 v[76:79], v[92:95], v[50:53], v[76:79]
s_nop 2
v_mul_f32 v64, v64, v10
v_mul_f32 v65, v65, v10
v_mul_f32 v66, v66, v10
v_mul_f32 v67, v67, v10
v_cvt_pk_bf16_f32 v80, v64, v65
v_cvt_pk_bf16_f32 v81, v66, v67
v_mul_f32 v72, v72, v10
v_mul_f32 v73, v73, v10
v_mul_f32 v74, v74, v10
v_mul_f32 v75, v75, v10
v_cvt_pk_bf16_f32 v82, v72, v73
v_cvt_pk_bf16_f32 v83, v74, v75
ds_write_b128 v241, v[80:83] offset:0
v_mul_f32 v68, v68, v11
v_mul_f32 v69, v69, v11
v_mul_f32 v70, v70, v11
v_mul_f32 v71, v71, v11
v_cvt_pk_bf16_f32 v84, v68, v69
v_cvt_pk_bf16_f32 v85, v70, v71
v_mul_f32 v76, v76, v11
v_mul_f32 v77, v77, v11
v_mul_f32 v78, v78, v11
v_mul_f32 v79, v79, v11
v_cvt_pk_bf16_f32 v86, v76, v77
v_cvt_pk_bf16_f32 v87, v78, v79
ds_write_b128 v241, v[84:87] offset:24576
v_mfma_f32_16x16x16_bf16 v[64:67], v[140:141], v[44:45], 0
v_mfma_f32_16x16x16_bf16 v[68:71], v[140:141], v[48:49], 0
v_mfma_f32_16x16x16_bf16 v[64:67], v[96:97], v[46:47], v[64:67]
v_mfma_f32_16x16x32_bf16 v[68:71], v[96:99], v[50:53], v[68:71]
v_mfma_f32_16x16x16_bf16 v[72:75], v[142:143], v[44:45], 0
v_mfma_f32_16x16x16_bf16 v[76:79], v[142:143], v[48:49], 0
v_mfma_f32_16x16x16_bf16 v[72:75], v[100:101], v[46:47], v[72:75]
v_mfma_f32_16x16x32_bf16 v[76:79], v[100:103], v[50:53], v[76:79]
s_nop 2
v_mul_f32 v64, v64, v10
v_mul_f32 v65, v65, v10
v_mul_f32 v66, v66, v10
v_mul_f32 v67, v67, v10
v_cvt_pk_bf16_f32 v80, v64, v65
v_cvt_pk_bf16_f32 v81, v66, v67
v_mul_f32 v72, v72, v10
v_mul_f32 v73, v73, v10
v_mul_f32 v74, v74, v10
v_mul_f32 v75, v75, v10
v_cvt_pk_bf16_f32 v82, v72, v73
v_cvt_pk_bf16_f32 v83, v74, v75
ds_write_b128 v241, v[80:83] offset:1024
v_mul_f32 v68, v68, v11
v_mul_f32 v69, v69, v11
v_mul_f32 v70, v70, v11
v_mul_f32 v71, v71, v11
v_cvt_pk_bf16_f32 v84, v68, v69
v_cvt_pk_bf16_f32 v85, v70, v71
v_mul_f32 v76, v76, v11
v_mul_f32 v77, v77, v11
v_mul_f32 v78, v78, v11
v_mul_f32 v79, v79, v11
v_cvt_pk_bf16_f32 v86, v76, v77
v_cvt_pk_bf16_f32 v87, v78, v79
ds_write_b128 v241, v[84:87] offset:25600
v_mfma_f32_16x16x16_bf16 v[64:67], v[144:145], v[44:45], 0
v_mfma_f32_16x16x16_bf16 v[68:71], v[144:145], v[48:49], 0
v_mfma_f32_16x16x16_bf16 v[64:67], v[104:105], v[46:47], v[64:67]
v_mfma_f32_16x16x32_bf16 v[68:71], v[104:107], v[50:53], v[68:71]
v_mfma_f32_16x16x16_bf16 v[72:75], v[146:147], v[44:45], 0
v_mfma_f32_16x16x16_bf16 v[76:79], v[146:147], v[48:49], 0
v_mfma_f32_16x16x16_bf16 v[72:75], v[108:109], v[46:47], v[72:75]
v_mfma_f32_16x16x32_bf16 v[76:79], v[108:111], v[50:53], v[76:79]
s_nop 2
v_mul_f32 v64, v64, v10
v_mul_f32 v65, v65, v10
v_mul_f32 v66, v66, v10
v_mul_f32 v67, v67, v10
v_cvt_pk_bf16_f32 v80, v64, v65
v_cvt_pk_bf16_f32 v81, v66, v67
v_mul_f32 v72, v72, v10
v_mul_f32 v73, v73, v10
v_mul_f32 v74, v74, v10
v_mul_f32 v75, v75, v10
v_cvt_pk_bf16_f32 v82, v72, v73
v_cvt_pk_bf16_f32 v83, v74, v75
ds_write_b128 v241, v[80:83] offset:2048
v_mul_f32 v68, v68, v11
v_mul_f32 v69, v69, v11
v_mul_f32 v70, v70, v11
v_mul_f32 v71, v71, v11
v_cvt_pk_bf16_f32 v84, v68, v69
v_cvt_pk_bf16_f32 v85, v70, v71
v_mul_f32 v76, v76, v11
v_mul_f32 v77, v77, v11
v_mul_f32 v78, v78, v11
v_mul_f32 v79, v79, v11
v_cvt_pk_bf16_f32 v86, v76, v77
v_cvt_pk_bf16_f32 v87, v78, v79
ds_write_b128 v241, v[84:87] offset:26624
v_mfma_f32_16x16x16_bf16 v[64:67], v[148:149], v[44:45], 0
v_mfma_f32_16x16x16_bf16 v[68:71], v[148:149], v[48:49], 0
v_mfma_f32_16x16x16_bf16 v[64:67], v[112:113], v[46:47], v[64:67]
v_mfma_f32_16x16x32_bf16 v[68:71], v[112:115], v[50:53], v[68:71]
v_mfma_f32_16x16x16_bf16 v[72:75], v[150:151], v[44:45], 0
v_mfma_f32_16x16x16_bf16 v[76:79], v[150:151], v[48:49], 0
v_mfma_f32_16x16x16_bf16 v[72:75], v[116:117], v[46:47], v[72:75]
v_mfma_f32_16x16x32_bf16 v[76:79], v[116:119], v[50:53], v[76:79]
s_nop 2
v_mul_f32 v64, v64, v10
v_mul_f32 v65, v65, v10
v_mul_f32 v66, v66, v10
v_mul_f32 v67, v67, v10
v_cvt_pk_bf16_f32 v80, v64, v65
v_cvt_pk_bf16_f32 v81, v66, v67
v_mul_f32 v72, v72, v10
v_mul_f32 v73, v73, v10
v_mul_f32 v74, v74, v10
v_mul_f32 v75, v75, v10
v_cvt_pk_bf16_f32 v82, v72, v73
v_cvt_pk_bf16_f32 v83, v74, v75
ds_write_b128 v241, v[80:83] offset:3072
v_mul_f32 v68, v68, v11
v_mul_f32 v69, v69, v11
v_mul_f32 v70, v70, v11
v_mul_f32 v71, v71, v11
v_cvt_pk_bf16_f32 v84, v68, v69
v_cvt_pk_bf16_f32 v85, v70, v71
v_mul_f32 v76, v76, v11
v_mul_f32 v77, v77, v11
v_mul_f32 v78, v78, v11
v_mul_f32 v79, v79, v11
v_cvt_pk_bf16_f32 v86, v76, v77
v_cvt_pk_bf16_f32 v87, v78, v79
ds_write_b128 v241, v[84:87] offset:27648
v_mfma_f32_16x16x16_bf16 v[64:67], v[152:153], v[44:45], 0
v_mfma_f32_16x16x16_bf16 v[68:71], v[152:153], v[48:49], 0
v_mfma_f32_16x16x16_bf16 v[64:67], v[120:121], v[46:47], v[64:67]
v_mfma_f32_16x16x32_bf16 v[68:71], v[120:123], v[50:53], v[68:71]
v_mfma_f32_16x16x16_bf16 v[72:75], v[154:155], v[44:45], 0
v_mfma_f32_16x16x16_bf16 v[76:79], v[154:155], v[48:49], 0
v_mfma_f32_16x16x16_bf16 v[72:75], v[124:125], v[46:47], v[72:75]
v_mfma_f32_16x16x32_bf16 v[76:79], v[124:127], v[50:53], v[76:79]
s_nop 2
v_mul_f32 v64, v64, v10
v_mul_f32 v65, v65, v10
v_mul_f32 v66, v66, v10
v_mul_f32 v67, v67, v10
v_cvt_pk_bf16_f32 v80, v64, v65
v_cvt_pk_bf16_f32 v81, v66, v67
v_mul_f32 v72, v72, v10
v_mul_f32 v73, v73, v10
v_mul_f32 v74, v74, v10
v_mul_f32 v75, v75, v10
v_cvt_pk_bf16_f32 v82, v72, v73
v_cvt_pk_bf16_f32 v83, v74, v75
ds_write_b128 v241, v[80:83] offset:4096
v_mul_f32 v68, v68, v11
v_mul_f32 v69, v69, v11
v_mul_f32 v70, v70, v11
v_mul_f32 v71, v71, v11
v_cvt_pk_bf16_f32 v84, v68, v69
v_cvt_pk_bf16_f32 v85, v70, v71
v_mul_f32 v76, v76, v11
v_mul_f32 v77, v77, v11
v_mul_f32 v78, v78, v11
v_mul_f32 v79, v79, v11
v_cvt_pk_bf16_f32 v86, v76, v77
v_cvt_pk_bf16_f32 v87, v78, v79
ds_write_b128 v241, v[84:87] offset:28672
v_mfma_f32_16x16x16_bf16 v[64:67], v[156:157], v[44:45], 0
v_mfma_f32_16x16x16_bf16 v[68:71], v[156:157], v[48:49], 0
v_mfma_f32_16x16x16_bf16 v[64:67], v[128:129], v[46:47], v[64:67]
v_mfma_f32_16x16x32_bf16 v[68:71], v[128:131], v[50:53], v[68:71]
v_mfma_f32_16x16x16_bf16 v[72:75], v[158:159], v[44:45], 0
v_mfma_f32_16x16x16_bf16 v[76:79], v[158:159], v[48:49], 0
v_mfma_f32_16x16x16_bf16 v[72:75], v[132:133], v[46:47], v[72:75]
v_mfma_f32_16x16x32_bf16 v[76:79], v[132:135], v[50:53], v[76:79]
s_nop 2
v_mul_f32 v64, v64, v10
v_mul_f32 v65, v65, v10
v_mul_f32 v66, v66, v10
v_mul_f32 v67, v67, v10
v_cvt_pk_bf16_f32 v80, v64, v65
v_cvt_pk_bf16_f32 v81, v66, v67
v_mul_f32 v72, v72, v10
v_mul_f32 v73, v73, v10
v_mul_f32 v74, v74, v10
v_mul_f32 v75, v75, v10
v_cvt_pk_bf16_f32 v82, v72, v73
v_cvt_pk_bf16_f32 v83, v74, v75
ds_write_b128 v241, v[80:83] offset:5120
v_mul_f32 v68, v68, v11
v_mul_f32 v69, v69, v11
v_mul_f32 v70, v70, v11
v_mul_f32 v71, v71, v11
v_cvt_pk_bf16_f32 v84, v68, v69
v_cvt_pk_bf16_f32 v85, v70, v71
v_mul_f32 v76, v76, v11
v_mul_f32 v77, v77, v11
v_mul_f32 v78, v78, v11
v_mul_f32 v79, v79, v11
v_cvt_pk_bf16_f32 v86, v76, v77
v_cvt_pk_bf16_f32 v87, v78, v79
ds_write_b128 v241, v[84:87] offset:29696
s_waitcnt lgkmcnt(0)
buffer_load_dwordx4 v[104:107], v1, s[4:7], s30 offen offset:2048
buffer_load_dwordx4 v[108:111], v1, s[4:7], s31 offen offset:2048
buffer_load_dwordx4 v[112:115], v1, s[4:7], s32 offen offset:2048
buffer_load_dwordx4 v[116:119], v1, s[4:7], s33 offen offset:2048
buffer_load_dwordx4 v[120:123], v1, s[4:7], s34 offen offset:2048
buffer_load_dwordx4 v[124:127], v1, s[4:7], s35 offen offset:2048
buffer_load_dwordx4 v[128:131], v1, s[4:7], s36 offen offset:2048
buffer_load_dwordx4 v[132:135], v1, s[4:7], s37 offen offset:2048
buffer_load_dwordx4 v[136:139], v1, s[4:7], s38 offen offset:2048
buffer_load_dwordx4 v[140:143], v1, s[4:7], s39 offen offset:2048
buffer_load_dwordx4 v[144:147], v1, s[4:7], s30 offen offset:3072
buffer_load_dwordx4 v[148:151], v1, s[4:7], s31 offen offset:3072
buffer_load_dwordx4 v[152:155], v1, s[4:7], s32 offen offset:3072
buffer_load_dwordx4 v[156:159], v1, s[4:7], s33 offen offset:3072
buffer_load_dwordx4 v[160:163], v1, s[4:7], s34 offen offset:3072
buffer_load_dwordx4 v[164:167], v1, s[4:7], s35 offen offset:3072
buffer_load_dwordx4 v[168:171], v1, s[4:7], s36 offen offset:3072
buffer_load_dwordx4 v[172:175], v1, s[4:7], s37 offen offset:3072
buffer_load_dwordx4 v[176:179], v1, s[4:7], s38 offen offset:3072
buffer_load_dwordx4 v[180:183], v1, s[4:7], s39 offen offset:3072
s_add_u32 s30, s30, 4096
s_add_u32 s31, s31, 4096
s_add_u32 s32, s32, 4096
s_add_u32 s33, s33, 4096
s_add_u32 s34, s34, 4096
s_add_u32 s35, s35, 4096
s_add_u32 s36, s36, 4096
s_add_u32 s37, s37, 4096
s_add_u32 s38, s38, 4096
s_add_u32 s39, s39, 4096
v_add_u32 v6, 49152, v1
s_barrier
ds_read_b128 v[184:187], v1 offset:0
ds_read_b128 v[188:191], v1 offset:24576
ds_read_b128 v[192:195], v6 offset:0
ds_read_b128 v[196:199], v6 offset:24576
s_waitcnt vmcnt(30) lgkmcnt(0)
v_mfma_f32_16x16x32_bf16 a[0:3], a[160:163], v[184:187], 0
v_mfma_f32_16x16x32_bf16 a[4:7], a[160:163], v[188:191], 0
v_mfma_f32_16x16x32_bf16 a[8:11], a[160:163], v[192:195], 0
v_mfma_f32_16x16x32_bf16 a[12:15], a[160:163], v[196:199], 0
ds_read_b128 v[200:203], v1 offset:1024
buffer_load_dwordx4 v[24:27], v1, s[4:7], s30 offen offset:0
v_mfma_f32_16x16x32_bf16 a[16:19], a[164:167], v[184:187], 0
v_mfma_f32_16x16x32_bf16 a[20:23], a[164:167], v[188:191], 0
v_mfma_f32_16x16x32_bf16 a[24:27], a[164:167], v[192:195], 0
v_mfma_f32_16x16x32_bf16 a[28:31], a[164:167], v[196:199], 0
ds_read_b128 v[204:207], v1 offset:25600
buffer_load_dwordx4 v[28:31], v1, s[4:7], s31 offen offset:0
v_mfma_f32_16x16x32_bf16 a[32:35], a[168:171], v[184:187], 0
v_mfma_f32_16x16x32_bf16 a[36:39], a[168:171], v[188:191], 0
v_mfma_f32_16x16x32_bf16 a[40:43], a[168:171], v[192:195], 0
v_mfma_f32_16x16x32_bf16 a[44:47], a[168:171], v[196:199], 0
ds_read_b128 v[208:211], v6 offset:1024
buffer_load_dwordx4 v[32:35], v1, s[4:7], s32 offen offset:0
v_mfma_f32_16x16x32_bf16 a[48:51], a[172:175], v[184:187], 0
v_mfma_f32_16x16x32_bf16 a[52:55], a[172:175], v[188:191], 0
v_mfma_f32_16x16x32_bf16 a[56:59], a[172:175], v[192:195], 0
v_mfma_f32_16x16x32_bf16 a[60:63], a[172:175], v[196:199], 0
ds_read_b128 v[212:215], v6 offset:25600
buffer_load_dwordx4 v[36:39], v1, s[4:7], s33 offen offset:0
v_mfma_f32_16x16x32_bf16 a[64:67], a[176:179], v[184:187], 0
v_mfma_f32_16x16x32_bf16 a[68:71], a[176:179], v[188:191], 0
v_mfma_f32_16x16x32_bf16 a[72:75], a[176:179], v[192:195], 0
v_mfma_f32_16x16x32_bf16 a[76:79], a[176:179], v[196:199], 0
buffer_load_dwordx4 v[40:43], v1, s[4:7], s34 offen offset:0
v_mfma_f32_16x16x32_bf16 a[80:83], a[180:183], v[184:187], 0
v_mfma_f32_16x16x32_bf16 a[84:87], a[180:183], v[188:191], 0
v_mfma_f32_16x16x32_bf16 a[88:91], a[180:183], v[192:195], 0
v_mfma_f32_16x16x32_bf16 a[92:95], a[180:183], v[196:199], 0
buffer_load_dwordx4 v[44:47], v1, s[4:7], s35 offen offset:0
v_mfma_f32_16x16x32_bf16 a[96:99], a[184:187], v[184:187], 0
v_mfma_f32_16x16x32_bf16 a[100:103], a[184:187], v[188:191], 0
v_mfma_f32_16x16x32_bf16 a[104:107], a[184:187], v[192:195], 0
v_mfma_f32_16x16x32_bf16 a[108:111], a[184:187], v[196:199], 0
buffer_load_dwordx4 v[48:51], v1, s[4:7], s36 offen offset:0
v_mfma_f32_16x16x32_bf16 a[112:115], a[188:191], v[184:187], 0
v_mfma_f32_16x16x32_bf16 a[116:119], a[188:191], v[188:191], 0
v_mfma_f32_16x16x32_bf16 a[120:123], a[188:191], v[192:195], 0
v_mfma_f32_16x16x32_bf16 a[124:127], a[188:191], v[196:199], 0
buffer_load_dwordx4 v[52:55], v1, s[4:7], s37 offen offset:0
v_mfma_f32_16x16x32_bf16 a[128:131], a[192:195], v[184:187], 0
v_mfma_f32_16x16x32_bf16 a[132:135], a[192:195], v[188:191], 0
v_mfma_f32_16x16x32_bf16 a[136:139], a[192:195], v[192:195], 0
v_mfma_f32_16x16x32_bf16 a[140:143], a[192:195], v[196:199], 0
buffer_load_dwordx4 v[56:59], v1, s[4:7], s38 offen offset:0
v_mfma_f32_16x16x32_bf16 a[144:147], a[196:199], v[184:187], 0
v_mfma_f32_16x16x32_bf16 a[148:151], a[196:199], v[188:191], 0
v_mfma_f32_16x16x32_bf16 a[152:155], a[196:199], v[192:195], 0
v_mfma_f32_16x16x32_bf16 a[156:159], a[196:199], v[196:199], 0
buffer_load_dwordx4 v[60:63], v1, s[4:7], s39 offen offset:0
s_waitcnt vmcnt(30) lgkmcnt(0)
v_mfma_f32_16x16x32_bf16 a[0:3], a[200:203], v[200:203], a[0:3]
v_mfma_f32_16x16x32_bf16 a[4:7], a[200:203], v[204:207], a[4:7]
v_mfma_f32_16x16x32_bf16 a[8:11], a[200:203], v[208:211], a[8:11]
v_mfma_f32_16x16x32_bf16 a[12:15], a[200:203], v[212:215], a[12:15]
ds_read_b128 v[184:187], v1 offset:2048
buffer_load_dwordx4 v[64:67], v1, s[4:7], s30 offen offset:1024
v_mfma_f32_16x16x32_bf16 a[16:19], a[204:207], v[200:203], a[16:19]
v_mfma_f32_16x16x32_bf16 a[20:23], a[204:207], v[204:207], a[20:23]
v_mfma_f32_16x16x32_bf16 a[24:27], a[204:207], v[208:211], a[24:27]
v_mfma_f32_16x16x32_bf16 a[28:31], a[204:207], v[212:215], a[28:31]
ds_read_b128 v[188:191], v1 offset:26624
buffer_load_dwordx4 v[68:71], v1, s[4:7], s31 offen offset:1024
v_mfma_f32_16x16x32_bf16 a[32:35], a[208:211], v[200:203], a[32:35]
v_mfma_f32_16x16x32_bf16 a[36:39], a[208:211], v[204:207], a[36:39]
v_mfma_f32_16x16x32_bf16 a[40:43], a[208:211], v[208:211], a[40:43]
v_mfma_f32_16x16x32_bf16 a[44:47], a[208:211], v[212:215], a[44:47]
ds_read_b128 v[192:195], v6 offset:2048
buffer_load_dwordx4 v[72:75], v1, s[4:7], s32 offen offset:1024
v_mfma_f32_16x16x32_bf16 a[48:51], a[212:215], v[200:203], a[48:51]
v_mfma_f32_16x16x32_bf16 a[52:55], a[212:215], v[204:207], a[52:55]
v_mfma_f32_16x16x32_bf16 a[56:59], a[212:215], v[208:211], a[56:59]
v_mfma_f32_16x16x32_bf16 a[60:63], a[212:215], v[212:215], a[60:63]
ds_read_b128 v[196:199], v6 offset:26624
buffer_load_dwordx4 v[76:79], v1, s[4:7], s33 offen offset:1024
v_mfma_f32_16x16x32_bf16 a[64:67], a[216:219], v[200:203], a[64:67]
v_mfma_f32_16x16x32_bf16 a[68:71], a[216:219], v[204:207], a[68:71]
v_mfma_f32_16x16x32_bf16 a[72:75], a[216:219], v[208:211], a[72:75]
v_mfma_f32_16x16x32_bf16 a[76:79], a[216:219], v[212:215], a[76:79]
buffer_load_dwordx4 v[80:83], v1, s[4:7], s34 offen offset:1024
v_mfma_f32_16x16x32_bf16 a[80:83], a[220:223], v[200:203], a[80:83]
v_mfma_f32_16x16x32_bf16 a[84:87], a[220:223], v[204:207], a[84:87]
v_mfma_f32_16x16x32_bf16 a[88:91], a[220:223], v[208:211], a[88:91]
v_mfma_f32_16x16x32_bf16 a[92:95], a[220:223], v[212:215], a[92:95]
buffer_load_dwordx4 v[84:87], v1, s[4:7], s35 offen offset:1024
v_mfma_f32_16x16x32_bf16 a[96:99], a[224:227], v[200:203], a[96:99]
v_mfma_f32_16x16x32_bf16 a[100:103], a[224:227], v[204:207], a[100:103]
v_mfma_f32_16x16x32_bf16 a[104:107], a[224:227], v[208:211], a[104:107]
v_mfma_f32_16x16x32_bf16 a[108:111], a[224:227], v[212:215], a[108:111]
buffer_load_dwordx4 v[88:91], v1, s[4:7], s36 offen offset:1024
v_mfma_f32_16x16x32_bf16 a[112:115], a[228:231], v[200:203], a[112:115]
v_mfma_f32_16x16x32_bf16 a[116:119], a[228:231], v[204:207], a[116:119]
v_mfma_f32_16x16x32_bf16 a[120:123], a[228:231], v[208:211], a[120:123]
v_mfma_f32_16x16x32_bf16 a[124:127], a[228:231], v[212:215], a[124:127]
buffer_load_dwordx4 v[92:95], v1, s[4:7], s37 offen offset:1024
v_mfma_f32_16x16x32_bf16 a[128:131], a[232:235], v[200:203], a[128:131]
v_mfma_f32_16x16x32_bf16 a[132:135], a[232:235], v[204:207], a[132:135]
v_mfma_f32_16x16x32_bf16 a[136:139], a[232:235], v[208:211], a[136:139]
v_mfma_f32_16x16x32_bf16 a[140:143], a[232:235], v[212:215], a[140:143]
buffer_load_dwordx4 v[96:99], v1, s[4:7], s38 offen offset:1024
v_mfma_f32_16x16x32_bf16 a[144:147], a[236:239], v[200:203], a[144:147]
v_mfma_f32_16x16x32_bf16 a[148:151], a[236:239], v[204:207], a[148:151]
v_mfma_f32_16x16x32_bf16 a[152:155], a[236:239], v[208:211], a[152:155]
v_mfma_f32_16x16x32_bf16 a[156:159], a[236:239], v[212:215], a[156:159]
buffer_load_dwordx4 v[100:103], v1, s[4:7], s39 offen offset:1024
s_waitcnt vmcnt(30) lgkmcnt(0)
v_mfma_f32_16x16x32_bf16 a[0:3], v[104:107], v[184:187], a[0:3]
v_mfma_f32_16x16x32_bf16 a[4:7], v[104:107], v[188:191], a[4:7]
v_mfma_f32_16x16x32_bf16 a[8:11], v[104:107], v[192:195], a[8:11]
v_mfma_f32_16x16x32_bf16 a[12:15], v[104:107], v[196:199], a[12:15]
ds_read_b128 v[200:203], v1 offset:3072
buffer_load_dwordx4 v[104:107], v1, s[4:7], s30 offen offset:2048
v_mfma_f32_16x16x32_bf16 a[16:19], v[108:111], v[184:187], a[16:19]
v_mfma_f32_16x16x32_bf16 a[20:23], v[108:111], v[188:191], a[20:23]
v_mfma_f32_16x16x32_bf16 a[24:27], v[108:111], v[192:195], a[24:27]
v_mfma_f32_16x16x32_bf16 a[28:31], v[108:111], v[196:199], a[28:31]
ds_read_b128 v[204:207], v1 offset:27648
buffer_load_dwordx4 v[108:111], v1, s[4:7], s31 offen offset:2048
v_mfma_f32_16x16x32_bf16 a[32:35], v[112:115], v[184:187], a[32:35]
v_mfma_f32_16x16x32_bf16 a[36:39], v[112:115], v[188:191], a[36:39]
v_mfma_f32_16x16x32_bf16 a[40:43], v[112:115], v[192:195], a[40:43]
v_mfma_f32_16x16x32_bf16 a[44:47], v[112:115], v[196:199], a[44:47]
ds_read_b128 v[208:211], v6 offset:3072
buffer_load_dwordx4 v[112:115], v1, s[4:7], s32 offen offset:2048
v_mfma_f32_16x16x32_bf16 a[48:51], v[116:119], v[184:187], a[48:51]
v_mfma_f32_16x16x32_bf16 a[52:55], v[116:119], v[188:191], a[52:55]
v_mfma_f32_16x16x32_bf16 a[56:59], v[116:119], v[192:195], a[56:59]
v_mfma_f32_16x16x32_bf16 a[60:63], v[116:119], v[196:199], a[60:63]
ds_read_b128 v[212:215], v6 offset:27648
buffer_load_dwordx4 v[116:119], v1, s[4:7], s33 offen offset:2048
v_mfma_f32_16x16x32_bf16 a[64:67], v[120:123], v[184:187], a[64:67]
v_mfma_f32_16x16x32_bf16 a[68:71], v[120:123], v[188:191], a[68:71]
v_mfma_f32_16x16x32_bf16 a[72:75], v[120:123], v[192:195], a[72:75]
v_mfma_f32_16x16x32_bf16 a[76:79], v[120:123], v[196:199], a[76:79]
buffer_load_dwordx4 v[120:123], v1, s[4:7], s34 offen offset:2048
v_mfma_f32_16x16x32_bf16 a[80:83], v[124:127], v[184:187], a[80:83]
v_mfma_f32_16x16x32_bf16 a[84:87], v[124:127], v[188:191], a[84:87]
v_mfma_f32_16x16x32_bf16 a[88:91], v[124:127], v[192:195], a[88:91]
v_mfma_f32_16x16x32_bf16 a[92:95], v[124:127], v[196:199], a[92:95]
buffer_load_dwordx4 v[124:127], v1, s[4:7], s35 offen offset:2048
v_mfma_f32_16x16x32_bf16 a[96:99], v[128:131], v[184:187], a[96:99]
v_mfma_f32_16x16x32_bf16 a[100:103], v[128:131], v[188:191], a[100:103]
v_mfma_f32_16x16x32_bf16 a[104:107], v[128:131], v[192:195], a[104:107]
v_mfma_f32_16x16x32_bf16 a[108:111], v[128:131], v[196:199], a[108:111]
buffer_load_dwordx4 v[128:131], v1, s[4:7], s36 offen offset:2048
v_mfma_f32_16x16x32_bf16 a[112:115], v[132:135], v[184:187], a[112:115]
v_mfma_f32_16x16x32_bf16 a[116:119], v[132:135], v[188:191], a[116:119]
v_mfma_f32_16x16x32_bf16 a[120:123], v[132:135], v[192:195], a[120:123]
v_mfma_f32_16x16x32_bf16 a[124:127], v[132:135], v[196:199], a[124:127]
buffer_load_dwordx4 v[132:135], v1, s[4:7], s37 offen offset:2048
v_mfma_f32_16x16x32_bf16 a[128:131], v[136:139], v[184:187], a[128:131]
v_mfma_f32_16x16x32_bf16 a[132:135], v[136:139], v[188:191], a[132:135]
v_mfma_f32_16x16x32_bf16 a[136:139], v[136:139], v[192:195], a[136:139]
v_mfma_f32_16x16x32_bf16 a[140:143], v[136:139], v[196:199], a[140:143]
buffer_load_dwordx4 v[136:139], v1, s[4:7], s38 offen offset:2048
v_mfma_f32_16x16x32_bf16 a[144:147], v[140:143], v[184:187], a[144:147]
v_mfma_f32_16x16x32_bf16 a[148:151], v[140:143], v[188:191], a[148:151]
v_mfma_f32_16x16x32_bf16 a[152:155], v[140:143], v[192:195], a[152:155]
v_mfma_f32_16x16x32_bf16 a[156:159], v[140:143], v[196:199], a[156:159]
buffer_load_dwordx4 v[140:143], v1, s[4:7], s39 offen offset:2048
s_waitcnt vmcnt(30) lgkmcnt(0)
v_mfma_f32_16x16x32_bf16 a[0:3], v[144:147], v[200:203], a[0:3]
v_mfma_f32_16x16x32_bf16 a[4:7], v[144:147], v[204:207], a[4:7]
v_mfma_f32_16x16x32_bf16 a[8:11], v[144:147], v[208:211], a[8:11]
v_mfma_f32_16x16x32_bf16 a[12:15], v[144:147], v[212:215], a[12:15]
ds_read_b128 v[184:187], v1 offset:4096
buffer_load_dwordx4 v[144:147], v1, s[4:7], s30 offen offset:3072
s_add_u32 s30, s30, 4096
v_mfma_f32_16x16x32_bf16 a[16:19], v[148:151], v[200:203], a[16:19]
v_mfma_f32_16x16x32_bf16 a[20:23], v[148:151], v[204:207], a[20:23]
v_mfma_f32_16x16x32_bf16 a[24:27], v[148:151], v[208:211], a[24:27]
v_mfma_f32_16x16x32_bf16 a[28:31], v[148:151], v[212:215], a[28:31]
ds_read_b128 v[188:191], v1 offset:28672
buffer_load_dwordx4 v[148:151], v1, s[4:7], s31 offen offset:3072
s_add_u32 s31, s31, 4096
v_mfma_f32_16x16x32_bf16 a[32:35], v[152:155], v[200:203], a[32:35]
v_mfma_f32_16x16x32_bf16 a[36:39], v[152:155], v[204:207], a[36:39]
v_mfma_f32_16x16x32_bf16 a[40:43], v[152:155], v[208:211], a[40:43]
v_mfma_f32_16x16x32_bf16 a[44:47], v[152:155], v[212:215], a[44:47]
ds_read_b128 v[192:195], v6 offset:4096
buffer_load_dwordx4 v[152:155], v1, s[4:7], s32 offen offset:3072
s_add_u32 s32, s32, 4096
v_mfma_f32_16x16x32_bf16 a[48:51], v[156:159], v[200:203], a[48:51]
v_mfma_f32_16x16x32_bf16 a[52:55], v[156:159], v[204:207], a[52:55]
v_mfma_f32_16x16x32_bf16 a[56:59], v[156:159], v[208:211], a[56:59]
v_mfma_f32_16x16x32_bf16 a[60:63], v[156:159], v[212:215], a[60:63]
ds_read_b128 v[196:199], v6 offset:28672
buffer_load_dwordx4 v[156:159], v1, s[4:7], s33 offen offset:3072
s_add_u32 s33, s33, 4096
v_mfma_f32_16x16x32_bf16 a[64:67], v[160:163], v[200:203], a[64:67]
v_mfma_f32_16x16x32_bf16 a[68:71], v[160:163], v[204:207], a[68:71]
v_mfma_f32_16x16x32_bf16 a[72:75], v[160:163], v[208:211], a[72:75]
v_mfma_f32_16x16x32_bf16 a[76:79], v[160:163], v[212:215], a[76:79]
buffer_load_dwordx4 v[160:163], v1, s[4:7], s34 offen offset:3072
s_add_u32 s34, s34, 4096
v_mfma_f32_16x16x32_bf16 a[80:83], v[164:167], v[200:203], a[80:83]
v_mfma_f32_16x16x32_bf16 a[84:87], v[164:167], v[204:207], a[84:87]
v_mfma_f32_16x16x32_bf16 a[88:91], v[164:167], v[208:211], a[88:91]
v_mfma_f32_16x16x32_bf16 a[92:95], v[164:167], v[212:215], a[92:95]
buffer_load_dwordx4 v[164:167], v1, s[4:7], s35 offen offset:3072
s_add_u32 s35, s35, 4096
v_mfma_f32_16x16x32_bf16 a[96:99], v[168:171], v[200:203], a[96:99]
v_mfma_f32_16x16x32_bf16 a[100:103], v[168:171], v[204:207], a[100:103]
v_mfma_f32_16x16x32_bf16 a[104:107], v[168:171], v[208:211], a[104:107]
v_mfma_f32_16x16x32_bf16 a[108:111], v[168:171], v[212:215], a[108:111]
buffer_load_dwordx4 v[168:171], v1, s[4:7], s36 offen offset:3072
s_add_u32 s36, s36, 4096
v_mfma_f32_16x16x32_bf16 a[112:115], v[172:175], v[200:203], a[112:115]
v_mfma_f32_16x16x32_bf16 a[116:119], v[172:175], v[204:207], a[116:119]
v_mfma_f32_16x16x32_bf16 a[120:123], v[172:175], v[208:211], a[120:123]
v_mfma_f32_16x16x32_bf16 a[124:127], v[172:175], v[212:215], a[124:127]
buffer_load_dwordx4 v[172:175], v1, s[4:7], s37 offen offset:3072
s_add_u32 s37, s37, 4096
v_mfma_f32_16x16x32_bf16 a[128:131], v[176:179], v[200:203], a[128:131]
v_mfma_f32_16x16x32_bf16 a[132:135], v[176:179], v[204:207], a[132:135]
v_mfma_f32_16x16x32_bf16 a[136:139], v[176:179], v[208:211], a[136:139]
v_mfma_f32_16x16x32_bf16 a[140:143], v[176:179], v[212:215], a[140:143]
buffer_load_dwordx4 v[176:179], v1, s[4:7], s38 offen offset:3072
s_add_u32 s38, s38, 4096
v_mfma_f32_16x16x32_bf16 a[144:147], v[180:183], v[200:203], a[144:147]
v_mfma_f32_16x16x32_bf16 a[148:151], v[180:183], v[204:207], a[148:151]
v_mfma_f32_16x16x32_bf16 a[152:155], v[180:183], v[208:211], a[152:155]
v_mfma_f32_16x16x32_bf16 a[156:159], v[180:183], v[212:215], a[156:159]
buffer_load_dwordx4 v[180:183], v1, s[4:7], s39 offen offset:3072
s_add_u32 s39, s39, 4096
s_waitcnt vmcnt(30) lgkmcnt(0)
v_mfma_f32_16x16x32_bf16 a[0:3], v[24:27], v[184:187], a[0:3]
v_mfma_f32_16x16x32_bf16 a[4:7], v[24:27], v[188:191], a[4:7]
v_mfma_f32_16x16x32_bf16 a[8:11], v[24:27], v[192:195], a[8:11]
v_mfma_f32_16x16x32_bf16 a[12:15], v[24:27], v[196:199], a[12:15]
ds_read_b128 v[200:203], v1 offset:5120
buffer_load_dwordx4 v[24:27], v1, s[4:7], s30 offen offset:0
v_mfma_f32_16x16x32_bf16 a[16:19], v[28:31], v[184:187], a[16:19]
v_mfma_f32_16x16x32_bf16 a[20:23], v[28:31], v[188:191], a[20:23]
v_mfma_f32_16x16x32_bf16 a[24:27], v[28:31], v[192:195], a[24:27]
v_mfma_f32_16x16x32_bf16 a[28:31], v[28:31], v[196:199], a[28:31]
ds_read_b128 v[204:207], v1 offset:29696
buffer_load_dwordx4 v[28:31], v1, s[4:7], s31 offen offset:0
v_mfma_f32_16x16x32_bf16 a[32:35], v[32:35], v[184:187], a[32:35]
v_mfma_f32_16x16x32_bf16 a[36:39], v[32:35], v[188:191], a[36:39]
v_mfma_f32_16x16x32_bf16 a[40:43], v[32:35], v[192:195], a[40:43]
v_mfma_f32_16x16x32_bf16 a[44:47], v[32:35], v[196:199], a[44:47]
ds_read_b128 v[208:211], v6 offset:5120
buffer_load_dwordx4 v[32:35], v1, s[4:7], s32 offen offset:0
v_mfma_f32_16x16x32_bf16 a[48:51], v[36:39], v[184:187], a[48:51]
v_mfma_f32_16x16x32_bf16 a[52:55], v[36:39], v[188:191], a[52:55]
v_mfma_f32_16x16x32_bf16 a[56:59], v[36:39], v[192:195], a[56:59]
v_mfma_f32_16x16x32_bf16 a[60:63], v[36:39], v[196:199], a[60:63]
ds_read_b128 v[212:215], v6 offset:29696
buffer_load_dwordx4 v[36:39], v1, s[4:7], s33 offen offset:0
v_mfma_f32_16x16x32_bf16 a[64:67], v[40:43], v[184:187], a[64:67]
v_mfma_f32_16x16x32_bf16 a[68:71], v[40:43], v[188:191], a[68:71]
v_mfma_f32_16x16x32_bf16 a[72:75], v[40:43], v[192:195], a[72:75]
v_mfma_f32_16x16x32_bf16 a[76:79], v[40:43], v[196:199], a[76:79]
buffer_load_dwordx4 v[40:43], v1, s[4:7], s34 offen offset:0
v_mfma_f32_16x16x32_bf16 a[80:83], v[44:47], v[184:187], a[80:83]
v_mfma_f32_16x16x32_bf16 a[84:87], v[44:47], v[188:191], a[84:87]
v_mfma_f32_16x16x32_bf16 a[88:91], v[44:47], v[192:195], a[88:91]
v_mfma_f32_16x16x32_bf16 a[92:95], v[44:47], v[196:199], a[92:95]
buffer_load_dwordx4 v[44:47], v1, s[4:7], s35 offen offset:0
v_mfma_f32_16x16x32_bf16 a[96:99], v[48:51], v[184:187], a[96:99]
v_mfma_f32_16x16x32_bf16 a[100:103], v[48:51], v[188:191], a[100:103]
v_mfma_f32_16x16x32_bf16 a[104:107], v[48:51], v[192:195], a[104:107]
v_mfma_f32_16x16x32_bf16 a[108:111], v[48:51], v[196:199], a[108:111]
buffer_load_dwordx4 v[48:51], v1, s[4:7], s36 offen offset:0
v_mfma_f32_16x16x32_bf16 a[112:115], v[52:55], v[184:187], a[112:115]
v_mfma_f32_16x16x32_bf16 a[116:119], v[52:55], v[188:191], a[116:119]
v_mfma_f32_16x16x32_bf16 a[120:123], v[52:55], v[192:195], a[120:123]
v_mfma_f32_16x16x32_bf16 a[124:127], v[52:55], v[196:199], a[124:127]
buffer_load_dwordx4 v[52:55], v1, s[4:7], s37 offen offset:0
v_mfma_f32_16x16x32_bf16 a[128:131], v[56:59], v[184:187], a[128:131]
v_mfma_f32_16x16x32_bf16 a[132:135], v[56:59], v[188:191], a[132:135]
v_mfma_f32_16x16x32_bf16 a[136:139], v[56:59], v[192:195], a[136:139]
v_mfma_f32_16x16x32_bf16 a[140:143], v[56:59], v[196:199], a[140:143]
buffer_load_dwordx4 v[56:59], v1, s[4:7], s38 offen offset:0
v_mfma_f32_16x16x32_bf16 a[144:147], v[60:63], v[184:187], a[144:147]
v_mfma_f32_16x16x32_bf16 a[148:151], v[60:63], v[188:191], a[148:151]
v_mfma_f32_16x16x32_bf16 a[152:155], v[60:63], v[192:195], a[152:155]
v_mfma_f32_16x16x32_bf16 a[156:159], v[60:63], v[196:199], a[156:159]
buffer_load_dwordx4 v[60:63], v1, s[4:7], s39 offen offset:0
s_waitcnt vmcnt(30) lgkmcnt(0)
v_mfma_f32_16x16x32_bf16 a[0:3], v[64:67], v[200:203], a[0:3]
v_mfma_f32_16x16x32_bf16 a[4:7], v[64:67], v[204:207], a[4:7]
v_mfma_f32_16x16x32_bf16 a[8:11], v[64:67], v[208:211], a[8:11]
v_mfma_f32_16x16x32_bf16 a[12:15], v[64:67], v[212:215], a[12:15]
ds_read_b128 v[184:187], v1 offset:6144
buffer_load_dwordx4 v[64:67], v1, s[4:7], s30 offen offset:1024
v_mfma_f32_16x16x32_bf16 a[16:19], v[68:71], v[200:203], a[16:19]
v_mfma_f32_16x16x32_bf16 a[20:23], v[68:71], v[204:207], a[20:23]
v_mfma_f32_16x16x32_bf16 a[24:27], v[68:71], v[208:211], a[24:27]
v_mfma_f32_16x16x32_bf16 a[28:31], v[68:71], v[212:215], a[28:31]
ds_read_b128 v[188:191], v1 offset:30720
buffer_load_dwordx4 v[68:71], v1, s[4:7], s31 offen offset:1024
v_mfma_f32_16x16x32_bf16 a[32:35], v[72:75], v[200:203], a[32:35]
v_mfma_f32_16x16x32_bf16 a[36:39], v[72:75], v[204:207], a[36:39]
v_mfma_f32_16x16x32_bf16 a[40:43], v[72:75], v[208:211], a[40:43]
v_mfma_f32_16x16x32_bf16 a[44:47], v[72:75], v[212:215], a[44:47]
ds_read_b128 v[192:195], v6 offset:6144
buffer_load_dwordx4 v[72:75], v1, s[4:7], s32 offen offset:1024
v_mfma_f32_16x16x32_bf16 a[48:51], v[76:79], v[200:203], a[48:51]
v_mfma_f32_16x16x32_bf16 a[52:55], v[76:79], v[204:207], a[52:55]
v_mfma_f32_16x16x32_bf16 a[56:59], v[76:79], v[208:211], a[56:59]
v_mfma_f32_16x16x32_bf16 a[60:63], v[76:79], v[212:215], a[60:63]
ds_read_b128 v[196:199], v6 offset:30720
buffer_load_dwordx4 v[76:79], v1, s[4:7], s33 offen offset:1024
v_mfma_f32_16x16x32_bf16 a[64:67], v[80:83], v[200:203], a[64:67]
v_mfma_f32_16x16x32_bf16 a[68:71], v[80:83], v[204:207], a[68:71]
v_mfma_f32_16x16x32_bf16 a[72:75], v[80:83], v[208:211], a[72:75]
v_mfma_f32_16x16x32_bf16 a[76:79], v[80:83], v[212:215], a[76:79]
buffer_load_dwordx4 v[80:83], v1, s[4:7], s34 offen offset:1024
v_mfma_f32_16x16x32_bf16 a[80:83], v[84:87], v[200:203], a[80:83]
v_mfma_f32_16x16x32_bf16 a[84:87], v[84:87], v[204:207], a[84:87]
v_mfma_f32_16x16x32_bf16 a[88:91], v[84:87], v[208:211], a[88:91]
v_mfma_f32_16x16x32_bf16 a[92:95], v[84:87], v[212:215], a[92:95]
buffer_load_dwordx4 v[84:87], v1, s[4:7], s35 offen offset:1024
v_mfma_f32_16x16x32_bf16 a[96:99], v[88:91], v[200:203], a[96:99]
v_mfma_f32_16x16x32_bf16 a[100:103], v[88:91], v[204:207], a[100:103]
v_mfma_f32_16x16x32_bf16 a[104:107], v[88:91], v[208:211], a[104:107]
v_mfma_f32_16x16x32_bf16 a[108:111], v[88:91], v[212:215], a[108:111]
buffer_load_dwordx4 v[88:91], v1, s[4:7], s36 offen offset:1024
v_mfma_f32_16x16x32_bf16 a[112:115], v[92:95], v[200:203], a[112:115]
v_mfma_f32_16x16x32_bf16 a[116:119], v[92:95], v[204:207], a[116:119]
v_mfma_f32_16x16x32_bf16 a[120:123], v[92:95], v[208:211], a[120:123]
v_mfma_f32_16x16x32_bf16 a[124:127], v[92:95], v[212:215], a[124:127]
buffer_load_dwordx4 v[92:95], v1, s[4:7], s37 offen offset:1024
v_mfma_f32_16x16x32_bf16 a[128:131], v[96:99], v[200:203], a[128:131]
v_mfma_f32_16x16x32_bf16 a[132:135], v[96:99], v[204:207], a[132:135]
v_mfma_f32_16x16x32_bf16 a[136:139], v[96:99], v[208:211], a[136:139]
v_mfma_f32_16x16x32_bf16 a[140:143], v[96:99], v[212:215], a[140:143]
buffer_load_dwordx4 v[96:99], v1, s[4:7], s38 offen offset:1024
v_mfma_f32_16x16x32_bf16 a[144:147], v[100:103], v[200:203], a[144:147]
v_mfma_f32_16x16x32_bf16 a[148:151], v[100:103], v[204:207], a[148:151]
v_mfma_f32_16x16x32_bf16 a[152:155], v[100:103], v[208:211], a[152:155]
v_mfma_f32_16x16x32_bf16 a[156:159], v[100:103], v[212:215], a[156:159]
buffer_load_dwordx4 v[100:103], v1, s[4:7], s39 offen offset:1024
s_waitcnt vmcnt(30) lgkmcnt(0)
v_mfma_f32_16x16x32_bf16 a[0:3], v[104:107], v[184:187], a[0:3]
v_mfma_f32_16x16x32_bf16 a[4:7], v[104:107], v[188:191], a[4:7]
v_mfma_f32_16x16x32_bf16 a[8:11], v[104:107], v[192:195], a[8:11]
v_mfma_f32_16x16x32_bf16 a[12:15], v[104:107], v[196:199], a[12:15]
ds_read_b128 v[200:203], v1 offset:7168
buffer_load_dwordx4 v[104:107], v1, s[4:7], s30 offen offset:2048
v_mfma_f32_16x16x32_bf16 a[16:19], v[108:111], v[184:187], a[16:19]
v_mfma_f32_16x16x32_bf16 a[20:23], v[108:111], v[188:191], a[20:23]
v_mfma_f32_16x16x32_bf16 a[24:27], v[108:111], v[192:195], a[24:27]
v_mfma_f32_16x16x32_bf16 a[28:31], v[108:111], v[196:199], a[28:31]
ds_read_b128 v[204:207], v1 offset:31744
buffer_load_dwordx4 v[108:111], v1, s[4:7], s31 offen offset:2048
v_mfma_f32_16x16x32_bf16 a[32:35], v[112:115], v[184:187], a[32:35]
v_mfma_f32_16x16x32_bf16 a[36:39], v[112:115], v[188:191], a[36:39]
v_mfma_f32_16x16x32_bf16 a[40:43], v[112:115], v[192:195], a[40:43]
v_mfma_f32_16x16x32_bf16 a[44:47], v[112:115], v[196:199], a[44:47]
ds_read_b128 v[208:211], v6 offset:7168
buffer_load_dwordx4 v[112:115], v1, s[4:7], s32 offen offset:2048
v_mfma_f32_16x16x32_bf16 a[48:51], v[116:119], v[184:187], a[48:51]
v_mfma_f32_16x16x32_bf16 a[52:55], v[116:119], v[188:191], a[52:55]
v_mfma_f32_16x16x32_bf16 a[56:59], v[116:119], v[192:195], a[56:59]
v_mfma_f32_16x16x32_bf16 a[60:63], v[116:119], v[196:199], a[60:63]
ds_read_b128 v[212:215], v6 offset:31744
buffer_load_dwordx4 v[116:119], v1, s[4:7], s33 offen offset:2048
v_mfma_f32_16x16x32_bf16 a[64:67], v[120:123], v[184:187], a[64:67]
v_mfma_f32_16x16x32_bf16 a[68:71], v[120:123], v[188:191], a[68:71]
v_mfma_f32_16x16x32_bf16 a[72:75], v[120:123], v[192:195], a[72:75]
v_mfma_f32_16x16x32_bf16 a[76:79], v[120:123], v[196:199], a[76:79]
buffer_load_dwordx4 v[120:123], v1, s[4:7], s34 offen offset:2048
v_mfma_f32_16x16x32_bf16 a[80:83], v[124:127], v[184:187], a[80:83]
v_mfma_f32_16x16x32_bf16 a[84:87], v[124:127], v[188:191], a[84:87]
v_mfma_f32_16x16x32_bf16 a[88:91], v[124:127], v[192:195], a[88:91]
v_mfma_f32_16x16x32_bf16 a[92:95], v[124:127], v[196:199], a[92:95]
buffer_load_dwordx4 v[124:127], v1, s[4:7], s35 offen offset:2048
v_mfma_f32_16x16x32_bf16 a[96:99], v[128:131], v[184:187], a[96:99]
v_mfma_f32_16x16x32_bf16 a[100:103], v[128:131], v[188:191], a[100:103]
v_mfma_f32_16x16x32_bf16 a[104:107], v[128:131], v[192:195], a[104:107]
v_mfma_f32_16x16x32_bf16 a[108:111], v[128:131], v[196:199], a[108:111]
buffer_load_dwordx4 v[128:131], v1, s[4:7], s36 offen offset:2048
v_mfma_f32_16x16x32_bf16 a[112:115], v[132:135], v[184:187], a[112:115]
v_mfma_f32_16x16x32_bf16 a[116:119], v[132:135], v[188:191], a[116:119]
v_mfma_f32_16x16x32_bf16 a[120:123], v[132:135], v[192:195], a[120:123]
v_mfma_f32_16x16x32_bf16 a[124:127], v[132:135], v[196:199], a[124:127]
buffer_load_dwordx4 v[132:135], v1, s[4:7], s37 offen offset:2048
v_mfma_f32_16x16x32_bf16 a[128:131], v[136:139], v[184:187], a[128:131]
v_mfma_f32_16x16x32_bf16 a[132:135], v[136:139], v[188:191], a[132:135]
v_mfma_f32_16x16x32_bf16 a[136:139], v[136:139], v[192:195], a[136:139]
v_mfma_f32_16x16x32_bf16 a[140:143], v[136:139], v[196:199], a[140:143]
buffer_load_dwordx4 v[136:139], v1, s[4:7], s38 offen offset:2048
v_mfma_f32_16x16x32_bf16 a[144:147], v[140:143], v[184:187], a[144:147]
v_mfma_f32_16x16x32_bf16 a[148:151], v[140:143], v[188:191], a[148:151]
v_mfma_f32_16x16x32_bf16 a[152:155], v[140:143], v[192:195], a[152:155]
v_mfma_f32_16x16x32_bf16 a[156:159], v[140:143], v[196:199], a[156:159]
buffer_load_dwordx4 v[140:143], v1, s[4:7], s39 offen offset:2048
s_waitcnt vmcnt(30) lgkmcnt(0)
v_mfma_f32_16x16x32_bf16 a[0:3], v[144:147], v[200:203], a[0:3]
v_mfma_f32_16x16x32_bf16 a[4:7], v[144:147], v[204:207], a[4:7]
v_mfma_f32_16x16x32_bf16 a[8:11], v[144:147], v[208:211], a[8:11]
v_mfma_f32_16x16x32_bf16 a[12:15], v[144:147], v[212:215], a[12:15]
ds_read_b128 v[184:187], v1 offset:8192
buffer_load_dwordx4 v[144:147], v1, s[4:7], s30 offen offset:3072
s_add_u32 s30, s30, 4096
v_mfma_f32_16x16x32_bf16 a[16:19], v[148:151], v[200:203], a[16:19]
v_mfma_f32_16x16x32_bf16 a[20:23], v[148:151], v[204:207], a[20:23]
v_mfma_f32_16x16x32_bf16 a[24:27], v[148:151], v[208:211], a[24:27]
v_mfma_f32_16x16x32_bf16 a[28:31], v[148:151], v[212:215], a[28:31]
ds_read_b128 v[188:191], v1 offset:32768
buffer_load_dwordx4 v[148:151], v1, s[4:7], s31 offen offset:3072
s_add_u32 s31, s31, 4096
v_mfma_f32_16x16x32_bf16 a[32:35], v[152:155], v[200:203], a[32:35]
v_mfma_f32_16x16x32_bf16 a[36:39], v[152:155], v[204:207], a[36:39]
v_mfma_f32_16x16x32_bf16 a[40:43], v[152:155], v[208:211], a[40:43]
v_mfma_f32_16x16x32_bf16 a[44:47], v[152:155], v[212:215], a[44:47]
ds_read_b128 v[192:195], v6 offset:8192
buffer_load_dwordx4 v[152:155], v1, s[4:7], s32 offen offset:3072
s_add_u32 s32, s32, 4096
v_mfma_f32_16x16x32_bf16 a[48:51], v[156:159], v[200:203], a[48:51]
v_mfma_f32_16x16x32_bf16 a[52:55], v[156:159], v[204:207], a[52:55]
v_mfma_f32_16x16x32_bf16 a[56:59], v[156:159], v[208:211], a[56:59]
v_mfma_f32_16x16x32_bf16 a[60:63], v[156:159], v[212:215], a[60:63]
ds_read_b128 v[196:199], v6 offset:32768
buffer_load_dwordx4 v[156:159], v1, s[4:7], s33 offen offset:3072
s_add_u32 s33, s33, 4096
v_mfma_f32_16x16x32_bf16 a[64:67], v[160:163], v[200:203], a[64:67]
v_mfma_f32_16x16x32_bf16 a[68:71], v[160:163], v[204:207], a[68:71]
v_mfma_f32_16x16x32_bf16 a[72:75], v[160:163], v[208:211], a[72:75]
v_mfma_f32_16x16x32_bf16 a[76:79], v[160:163], v[212:215], a[76:79]
buffer_load_dwordx4 v[160:163], v1, s[4:7], s34 offen offset:3072
s_add_u32 s34, s34, 4096
v_mfma_f32_16x16x32_bf16 a[80:83], v[164:167], v[200:203], a[80:83]
v_mfma_f32_16x16x32_bf16 a[84:87], v[164:167], v[204:207], a[84:87]
v_mfma_f32_16x16x32_bf16 a[88:91], v[164:167], v[208:211], a[88:91]
v_mfma_f32_16x16x32_bf16 a[92:95], v[164:167], v[212:215], a[92:95]
buffer_load_dwordx4 v[164:167], v1, s[4:7], s35 offen offset:3072
s_add_u32 s35, s35, 4096
v_mfma_f32_16x16x32_bf16 a[96:99], v[168:171], v[200:203], a[96:99]
v_mfma_f32_16x16x32_bf16 a[100:103], v[168:171], v[204:207], a[100:103]
v_mfma_f32_16x16x32_bf16 a[104:107], v[168:171], v[208:211], a[104:107]
v_mfma_f32_16x16x32_bf16 a[108:111], v[168:171], v[212:215], a[108:111]
buffer_load_dwordx4 v[168:171], v1, s[4:7], s36 offen offset:3072
s_add_u32 s36, s36, 4096
v_mfma_f32_16x16x32_bf16 a[112:115], v[172:175], v[200:203], a[112:115]
v_mfma_f32_16x16x32_bf16 a[116:119], v[172:175], v[204:207], a[116:119]
v_mfma_f32_16x16x32_bf16 a[120:123], v[172:175], v[208:211], a[120:123]
v_mfma_f32_16x16x32_bf16 a[124:127], v[172:175], v[212:215], a[124:127]
buffer_load_dwordx4 v[172:175], v1, s[4:7], s37 offen offset:3072
s_add_u32 s37, s37, 4096
v_mfma_f32_16x16x32_bf16 a[128:131], v[176:179], v[200:203], a[128:131]
v_mfma_f32_16x16x32_bf16 a[132:135], v[176:179], v[204:207], a[132:135]
v_mfma_f32_16x16x32_bf16 a[136:139], v[176:179], v[208:211], a[136:139]
v_mfma_f32_16x16x32_bf16 a[140:143], v[176:179], v[212:215], a[140:143]
buffer_load_dwordx4 v[176:179], v1, s[4:7], s38 offen offset:3072
s_add_u32 s38, s38, 4096
v_mfma_f32_16x16x32_bf16 a[144:147], v[180:183], v[200:203], a[144:147]
v_mfma_f32_16x16x32_bf16 a[148:151], v[180:183], v[204:207], a[148:151]
v_mfma_f32_16x16x32_bf16 a[152:155], v[180:183], v[208:211], a[152:155]
v_mfma_f32_16x16x32_bf16 a[156:159], v[180:183], v[212:215], a[156:159]
buffer_load_dwordx4 v[180:183], v1, s[4:7], s39 offen offset:3072
s_add_u32 s39, s39, 4096
s_waitcnt vmcnt(30) lgkmcnt(0)
v_mfma_f32_16x16x32_bf16 a[0:3], v[24:27], v[184:187], a[0:3]
v_mfma_f32_16x16x32_bf16 a[4:7], v[24:27], v[188:191], a[4:7]
v_mfma_f32_16x16x32_bf16 a[8:11], v[24:27], v[192:195], a[8:11]
v_mfma_f32_16x16x32_bf16 a[12:15], v[24:27], v[196:199], a[12:15]
ds_read_b128 v[200:203], v1 offset:9216
buffer_load_dwordx4 v[24:27], v1, s[4:7], s30 offen offset:0
v_mfma_f32_16x16x32_bf16 a[16:19], v[28:31], v[184:187], a[16:19]
v_mfma_f32_16x16x32_bf16 a[20:23], v[28:31], v[188:191], a[20:23]
v_mfma_f32_16x16x32_bf16 a[24:27], v[28:31], v[192:195], a[24:27]
v_mfma_f32_16x16x32_bf16 a[28:31], v[28:31], v[196:199], a[28:31]
ds_read_b128 v[204:207], v1 offset:33792
buffer_load_dwordx4 v[28:31], v1, s[4:7], s31 offen offset:0
v_mfma_f32_16x16x32_bf16 a[32:35], v[32:35], v[184:187], a[32:35]
v_mfma_f32_16x16x32_bf16 a[36:39], v[32:35], v[188:191], a[36:39]
v_mfma_f32_16x16x32_bf16 a[40:43], v[32:35], v[192:195], a[40:43]
v_mfma_f32_16x16x32_bf16 a[44:47], v[32:35], v[196:199], a[44:47]
ds_read_b128 v[208:211], v6 offset:9216
buffer_load_dwordx4 v[32:35], v1, s[4:7], s32 offen offset:0
v_mfma_f32_16x16x32_bf16 a[48:51], v[36:39], v[184:187], a[48:51]
v_mfma_f32_16x16x32_bf16 a[52:55], v[36:39], v[188:191], a[52:55]
v_mfma_f32_16x16x32_bf16 a[56:59], v[36:39], v[192:195], a[56:59]
v_mfma_f32_16x16x32_bf16 a[60:63], v[36:39], v[196:199], a[60:63]
ds_read_b128 v[212:215], v6 offset:33792
buffer_load_dwordx4 v[36:39], v1, s[4:7], s33 offen offset:0
v_mfma_f32_16x16x32_bf16 a[64:67], v[40:43], v[184:187], a[64:67]
v_mfma_f32_16x16x32_bf16 a[68:71], v[40:43], v[188:191], a[68:71]
v_mfma_f32_16x16x32_bf16 a[72:75], v[40:43], v[192:195], a[72:75]
v_mfma_f32_16x16x32_bf16 a[76:79], v[40:43], v[196:199], a[76:79]
buffer_load_dwordx4 v[40:43], v1, s[4:7], s34 offen offset:0
v_mfma_f32_16x16x32_bf16 a[80:83], v[44:47], v[184:187], a[80:83]
v_mfma_f32_16x16x32_bf16 a[84:87], v[44:47], v[188:191], a[84:87]
v_mfma_f32_16x16x32_bf16 a[88:91], v[44:47], v[192:195], a[88:91]
v_mfma_f32_16x16x32_bf16 a[92:95], v[44:47], v[196:199], a[92:95]
buffer_load_dwordx4 v[44:47], v1, s[4:7], s35 offen offset:0
v_mfma_f32_16x16x32_bf16 a[96:99], v[48:51], v[184:187], a[96:99]
v_mfma_f32_16x16x32_bf16 a[100:103], v[48:51], v[188:191], a[100:103]
v_mfma_f32_16x16x32_bf16 a[104:107], v[48:51], v[192:195], a[104:107]
v_mfma_f32_16x16x32_bf16 a[108:111], v[48:51], v[196:199], a[108:111]
buffer_load_dwordx4 v[48:51], v1, s[4:7], s36 offen offset:0
v_mfma_f32_16x16x32_bf16 a[112:115], v[52:55], v[184:187], a[112:115]
v_mfma_f32_16x16x32_bf16 a[116:119], v[52:55], v[188:191], a[116:119]
v_mfma_f32_16x16x32_bf16 a[120:123], v[52:55], v[192:195], a[120:123]
v_mfma_f32_16x16x32_bf16 a[124:127], v[52:55], v[196:199], a[124:127]
buffer_load_dwordx4 v[52:55], v1, s[4:7], s37 offen offset:0
v_mfma_f32_16x16x32_bf16 a[128:131], v[56:59], v[184:187], a[128:131]
v_mfma_f32_16x16x32_bf16 a[132:135], v[56:59], v[188:191], a[132:135]
v_mfma_f32_16x16x32_bf16 a[136:139], v[56:59], v[192:195], a[136:139]
v_mfma_f32_16x16x32_bf16 a[140:143], v[56:59], v[196:199], a[140:143]
buffer_load_dwordx4 v[56:59], v1, s[4:7], s38 offen offset:0
v_mfma_f32_16x16x32_bf16 a[144:147], v[60:63], v[184:187], a[144:147]
v_mfma_f32_16x16x32_bf16 a[148:151], v[60:63], v[188:191], a[148:151]
v_mfma_f32_16x16x32_bf16 a[152:155], v[60:63], v[192:195], a[152:155]
v_mfma_f32_16x16x32_bf16 a[156:159], v[60:63], v[196:199], a[156:159]
buffer_load_dwordx4 v[60:63], v1, s[4:7], s39 offen offset:0
s_waitcnt vmcnt(30) lgkmcnt(0)
v_mfma_f32_16x16x32_bf16 a[0:3], v[64:67], v[200:203], a[0:3]
v_mfma_f32_16x16x32_bf16 a[4:7], v[64:67], v[204:207], a[4:7]
v_mfma_f32_16x16x32_bf16 a[8:11], v[64:67], v[208:211], a[8:11]
v_mfma_f32_16x16x32_bf16 a[12:15], v[64:67], v[212:215], a[12:15]
ds_read_b128 v[184:187], v1 offset:10240
buffer_load_dwordx4 v[64:67], v1, s[4:7], s30 offen offset:1024
v_mfma_f32_16x16x32_bf16 a[16:19], v[68:71], v[200:203], a[16:19]
v_mfma_f32_16x16x32_bf16 a[20:23], v[68:71], v[204:207], a[20:23]
v_mfma_f32_16x16x32_bf16 a[24:27], v[68:71], v[208:211], a[24:27]
v_mfma_f32_16x16x32_bf16 a[28:31], v[68:71], v[212:215], a[28:31]
ds_read_b128 v[188:191], v1 offset:34816
buffer_load_dwordx4 v[68:71], v1, s[4:7], s31 offen offset:1024
v_mfma_f32_16x16x32_bf16 a[32:35], v[72:75], v[200:203], a[32:35]
v_mfma_f32_16x16x32_bf16 a[36:39], v[72:75], v[204:207], a[36:39]
v_mfma_f32_16x16x32_bf16 a[40:43], v[72:75], v[208:211], a[40:43]
v_mfma_f32_16x16x32_bf16 a[44:47], v[72:75], v[212:215], a[44:47]
ds_read_b128 v[192:195], v6 offset:10240
buffer_load_dwordx4 v[72:75], v1, s[4:7], s32 offen offset:1024
v_mfma_f32_16x16x32_bf16 a[48:51], v[76:79], v[200:203], a[48:51]
v_mfma_f32_16x16x32_bf16 a[52:55], v[76:79], v[204:207], a[52:55]
v_mfma_f32_16x16x32_bf16 a[56:59], v[76:79], v[208:211], a[56:59]
v_mfma_f32_16x16x32_bf16 a[60:63], v[76:79], v[212:215], a[60:63]
ds_read_b128 v[196:199], v6 offset:34816
buffer_load_dwordx4 v[76:79], v1, s[4:7], s33 offen offset:1024
v_mfma_f32_16x16x32_bf16 a[64:67], v[80:83], v[200:203], a[64:67]
v_mfma_f32_16x16x32_bf16 a[68:71], v[80:83], v[204:207], a[68:71]
v_mfma_f32_16x16x32_bf16 a[72:75], v[80:83], v[208:211], a[72:75]
v_mfma_f32_16x16x32_bf16 a[76:79], v[80:83], v[212:215], a[76:79]
buffer_load_dwordx4 v[80:83], v1, s[4:7], s34 offen offset:1024
v_mfma_f32_16x16x32_bf16 a[80:83], v[84:87], v[200:203], a[80:83]
v_mfma_f32_16x16x32_bf16 a[84:87], v[84:87], v[204:207], a[84:87]
v_mfma_f32_16x16x32_bf16 a[88:91], v[84:87], v[208:211], a[88:91]
v_mfma_f32_16x16x32_bf16 a[92:95], v[84:87], v[212:215], a[92:95]
buffer_load_dwordx4 v[84:87], v1, s[4:7], s35 offen offset:1024
v_mfma_f32_16x16x32_bf16 a[96:99], v[88:91], v[200:203], a[96:99]
v_mfma_f32_16x16x32_bf16 a[100:103], v[88:91], v[204:207], a[100:103]
v_mfma_f32_16x16x32_bf16 a[104:107], v[88:91], v[208:211], a[104:107]
v_mfma_f32_16x16x32_bf16 a[108:111], v[88:91], v[212:215], a[108:111]
buffer_load_dwordx4 v[88:91], v1, s[4:7], s36 offen offset:1024
v_mfma_f32_16x16x32_bf16 a[112:115], v[92:95], v[200:203], a[112:115]
v_mfma_f32_16x16x32_bf16 a[116:119], v[92:95], v[204:207], a[116:119]
v_mfma_f32_16x16x32_bf16 a[120:123], v[92:95], v[208:211], a[120:123]
v_mfma_f32_16x16x32_bf16 a[124:127], v[92:95], v[212:215], a[124:127]
buffer_load_dwordx4 v[92:95], v1, s[4:7], s37 offen offset:1024
v_mfma_f32_16x16x32_bf16 a[128:131], v[96:99], v[200:203], a[128:131]
v_mfma_f32_16x16x32_bf16 a[132:135], v[96:99], v[204:207], a[132:135]
v_mfma_f32_16x16x32_bf16 a[136:139], v[96:99], v[208:211], a[136:139]
v_mfma_f32_16x16x32_bf16 a[140:143], v[96:99], v[212:215], a[140:143]
buffer_load_dwordx4 v[96:99], v1, s[4:7], s38 offen offset:1024
v_mfma_f32_16x16x32_bf16 a[144:147], v[100:103], v[200:203], a[144:147]
v_mfma_f32_16x16x32_bf16 a[148:151], v[100:103], v[204:207], a[148:151]
v_mfma_f32_16x16x32_bf16 a[152:155], v[100:103], v[208:211], a[152:155]
v_mfma_f32_16x16x32_bf16 a[156:159], v[100:103], v[212:215], a[156:159]
buffer_load_dwordx4 v[100:103], v1, s[4:7], s39 offen offset:1024
s_waitcnt vmcnt(30) lgkmcnt(0)
v_mfma_f32_16x16x32_bf16 a[0:3], v[104:107], v[184:187], a[0:3]
v_mfma_f32_16x16x32_bf16 a[4:7], v[104:107], v[188:191], a[4:7]
v_mfma_f32_16x16x32_bf16 a[8:11], v[104:107], v[192:195], a[8:11]
v_mfma_f32_16x16x32_bf16 a[12:15], v[104:107], v[196:199], a[12:15]
ds_read_b128 v[200:203], v1 offset:11264
buffer_load_dwordx4 v[104:107], v1, s[4:7], s30 offen offset:2048
v_mfma_f32_16x16x32_bf16 a[16:19], v[108:111], v[184:187], a[16:19]
v_mfma_f32_16x16x32_bf16 a[20:23], v[108:111], v[188:191], a[20:23]
v_mfma_f32_16x16x32_bf16 a[24:27], v[108:111], v[192:195], a[24:27]
v_mfma_f32_16x16x32_bf16 a[28:31], v[108:111], v[196:199], a[28:31]
ds_read_b128 v[204:207], v1 offset:35840
buffer_load_dwordx4 v[108:111], v1, s[4:7], s31 offen offset:2048
v_mfma_f32_16x16x32_bf16 a[32:35], v[112:115], v[184:187], a[32:35]
v_mfma_f32_16x16x32_bf16 a[36:39], v[112:115], v[188:191], a[36:39]
v_mfma_f32_16x16x32_bf16 a[40:43], v[112:115], v[192:195], a[40:43]
v_mfma_f32_16x16x32_bf16 a[44:47], v[112:115], v[196:199], a[44:47]
ds_read_b128 v[208:211], v6 offset:11264
buffer_load_dwordx4 v[112:115], v1, s[4:7], s32 offen offset:2048
v_mfma_f32_16x16x32_bf16 a[48:51], v[116:119], v[184:187], a[48:51]
v_mfma_f32_16x16x32_bf16 a[52:55], v[116:119], v[188:191], a[52:55]
v_mfma_f32_16x16x32_bf16 a[56:59], v[116:119], v[192:195], a[56:59]
v_mfma_f32_16x16x32_bf16 a[60:63], v[116:119], v[196:199], a[60:63]
ds_read_b128 v[212:215], v6 offset:35840
buffer_load_dwordx4 v[116:119], v1, s[4:7], s33 offen offset:2048
v_mfma_f32_16x16x32_bf16 a[64:67], v[120:123], v[184:187], a[64:67]
v_mfma_f32_16x16x32_bf16 a[68:71], v[120:123], v[188:191], a[68:71]
v_mfma_f32_16x16x32_bf16 a[72:75], v[120:123], v[192:195], a[72:75]
v_mfma_f32_16x16x32_bf16 a[76:79], v[120:123], v[196:199], a[76:79]
buffer_load_dwordx4 v[120:123], v1, s[4:7], s34 offen offset:2048
v_mfma_f32_16x16x32_bf16 a[80:83], v[124:127], v[184:187], a[80:83]
v_mfma_f32_16x16x32_bf16 a[84:87], v[124:127], v[188:191], a[84:87]
v_mfma_f32_16x16x32_bf16 a[88:91], v[124:127], v[192:195], a[88:91]
v_mfma_f32_16x16x32_bf16 a[92:95], v[124:127], v[196:199], a[92:95]
buffer_load_dwordx4 v[124:127], v1, s[4:7], s35 offen offset:2048
v_mfma_f32_16x16x32_bf16 a[96:99], v[128:131], v[184:187], a[96:99]
v_mfma_f32_16x16x32_bf16 a[100:103], v[128:131], v[188:191], a[100:103]
v_mfma_f32_16x16x32_bf16 a[104:107], v[128:131], v[192:195], a[104:107]
v_mfma_f32_16x16x32_bf16 a[108:111], v[128:131], v[196:199], a[108:111]
buffer_load_dwordx4 v[128:131], v1, s[4:7], s36 offen offset:2048
v_mfma_f32_16x16x32_bf16 a[112:115], v[132:135], v[184:187], a[112:115]
v_mfma_f32_16x16x32_bf16 a[116:119], v[132:135], v[188:191], a[116:119]
v_mfma_f32_16x16x32_bf16 a[120:123], v[132:135], v[192:195], a[120:123]
v_mfma_f32_16x16x32_bf16 a[124:127], v[132:135], v[196:199], a[124:127]
buffer_load_dwordx4 v[132:135], v1, s[4:7], s37 offen offset:2048
v_mfma_f32_16x16x32_bf16 a[128:131], v[136:139], v[184:187], a[128:131]
v_mfma_f32_16x16x32_bf16 a[132:135], v[136:139], v[188:191], a[132:135]
v_mfma_f32_16x16x32_bf16 a[136:139], v[136:139], v[192:195], a[136:139]
v_mfma_f32_16x16x32_bf16 a[140:143], v[136:139], v[196:199], a[140:143]
buffer_load_dwordx4 v[136:139], v1, s[4:7], s38 offen offset:2048
v_mfma_f32_16x16x32_bf16 a[144:147], v[140:143], v[184:187], a[144:147]
v_mfma_f32_16x16x32_bf16 a[148:151], v[140:143], v[188:191], a[148:151]
v_mfma_f32_16x16x32_bf16 a[152:155], v[140:143], v[192:195], a[152:155]
v_mfma_f32_16x16x32_bf16 a[156:159], v[140:143], v[196:199], a[156:159]
buffer_load_dwordx4 v[140:143], v1, s[4:7], s39 offen offset:2048
s_waitcnt vmcnt(30) lgkmcnt(0)
v_mfma_f32_16x16x32_bf16 a[0:3], v[144:147], v[200:203], a[0:3]
v_mfma_f32_16x16x32_bf16 a[4:7], v[144:147], v[204:207], a[4:7]
v_mfma_f32_16x16x32_bf16 a[8:11], v[144:147], v[208:211], a[8:11]
v_mfma_f32_16x16x32_bf16 a[12:15], v[144:147], v[212:215], a[12:15]
ds_read_b128 v[184:187], v1 offset:12288
buffer_load_dwordx4 v[144:147], v1, s[4:7], s30 offen offset:3072
s_add_u32 s30, s30, 4096
v_mfma_f32_16x16x32_bf16 a[16:19], v[148:151], v[200:203], a[16:19]
v_mfma_f32_16x16x32_bf16 a[20:23], v[148:151], v[204:207], a[20:23]
v_mfma_f32_16x16x32_bf16 a[24:27], v[148:151], v[208:211], a[24:27]
v_mfma_f32_16x16x32_bf16 a[28:31], v[148:151], v[212:215], a[28:31]
ds_read_b128 v[188:191], v1 offset:36864
buffer_load_dwordx4 v[148:151], v1, s[4:7], s31 offen offset:3072
s_add_u32 s31, s31, 4096
v_mfma_f32_16x16x32_bf16 a[32:35], v[152:155], v[200:203], a[32:35]
v_mfma_f32_16x16x32_bf16 a[36:39], v[152:155], v[204:207], a[36:39]
v_mfma_f32_16x16x32_bf16 a[40:43], v[152:155], v[208:211], a[40:43]
v_mfma_f32_16x16x32_bf16 a[44:47], v[152:155], v[212:215], a[44:47]
ds_read_b128 v[192:195], v6 offset:12288
buffer_load_dwordx4 v[152:155], v1, s[4:7], s32 offen offset:3072
s_add_u32 s32, s32, 4096
v_mfma_f32_16x16x32_bf16 a[48:51], v[156:159], v[200:203], a[48:51]
v_mfma_f32_16x16x32_bf16 a[52:55], v[156:159], v[204:207], a[52:55]
v_mfma_f32_16x16x32_bf16 a[56:59], v[156:159], v[208:211], a[56:59]
v_mfma_f32_16x16x32_bf16 a[60:63], v[156:159], v[212:215], a[60:63]
ds_read_b128 v[196:199], v6 offset:36864
buffer_load_dwordx4 v[156:159], v1, s[4:7], s33 offen offset:3072
s_add_u32 s33, s33, 4096
v_mfma_f32_16x16x32_bf16 a[64:67], v[160:163], v[200:203], a[64:67]
v_mfma_f32_16x16x32_bf16 a[68:71], v[160:163], v[204:207], a[68:71]
v_mfma_f32_16x16x32_bf16 a[72:75], v[160:163], v[208:211], a[72:75]
v_mfma_f32_16x16x32_bf16 a[76:79], v[160:163], v[212:215], a[76:79]
buffer_load_dwordx4 v[160:163], v1, s[4:7], s34 offen offset:3072
s_add_u32 s34, s34, 4096
v_mfma_f32_16x16x32_bf16 a[80:83], v[164:167], v[200:203], a[80:83]
v_mfma_f32_16x16x32_bf16 a[84:87], v[164:167], v[204:207], a[84:87]
v_mfma_f32_16x16x32_bf16 a[88:91], v[164:167], v[208:211], a[88:91]
v_mfma_f32_16x16x32_bf16 a[92:95], v[164:167], v[212:215], a[92:95]
buffer_load_dwordx4 v[164:167], v1, s[4:7], s35 offen offset:3072
s_add_u32 s35, s35, 4096
v_mfma_f32_16x16x32_bf16 a[96:99], v[168:171], v[200:203], a[96:99]
v_mfma_f32_16x16x32_bf16 a[100:103], v[168:171], v[204:207], a[100:103]
v_mfma_f32_16x16x32_bf16 a[104:107], v[168:171], v[208:211], a[104:107]
v_mfma_f32_16x16x32_bf16 a[108:111], v[168:171], v[212:215], a[108:111]
buffer_load_dwordx4 v[168:171], v1, s[4:7], s36 offen offset:3072
s_add_u32 s36, s36, 4096
v_mfma_f32_16x16x32_bf16 a[112:115], v[172:175], v[200:203], a[112:115]
v_mfma_f32_16x16x32_bf16 a[116:119], v[172:175], v[204:207], a[116:119]
v_mfma_f32_16x16x32_bf16 a[120:123], v[172:175], v[208:211], a[120:123]
v_mfma_f32_16x16x32_bf16 a[124:127], v[172:175], v[212:215], a[124:127]
buffer_load_dwordx4 v[172:175], v1, s[4:7], s37 offen offset:3072
s_add_u32 s37, s37, 4096
v_mfma_f32_16x16x32_bf16 a[128:131], v[176:179], v[200:203], a[128:131]
v_mfma_f32_16x16x32_bf16 a[132:135], v[176:179], v[204:207], a[132:135]
v_mfma_f32_16x16x32_bf16 a[136:139], v[176:179], v[208:211], a[136:139]
v_mfma_f32_16x16x32_bf16 a[140:143], v[176:179], v[212:215], a[140:143]
buffer_load_dwordx4 v[176:179], v1, s[4:7], s38 offen offset:3072
s_add_u32 s38, s38, 4096
v_mfma_f32_16x16x32_bf16 a[144:147], v[180:183], v[200:203], a[144:147]
v_mfma_f32_16x16x32_bf16 a[148:151], v[180:183], v[204:207], a[148:151]
v_mfma_f32_16x16x32_bf16 a[152:155], v[180:183], v[208:211], a[152:155]
v_mfma_f32_16x16x32_bf16 a[156:159], v[180:183], v[212:215], a[156:159]
buffer_load_dwordx4 v[180:183], v1, s[4:7], s39 offen offset:3072
s_add_u32 s39, s39, 4096
s_waitcnt vmcnt(30) lgkmcnt(0)
v_mfma_f32_16x16x32_bf16 a[0:3], v[24:27], v[184:187], a[0:3]
v_mfma_f32_16x16x32_bf16 a[4:7], v[24:27], v[188:191], a[4:7]
v_mfma_f32_16x16x32_bf16 a[8:11], v[24:27], v[192:195], a[8:11]
v_mfma_f32_16x16x32_bf16 a[12:15], v[24:27], v[196:199], a[12:15]
ds_read_b128 v[200:203], v1 offset:13312
buffer_load_dwordx4 v[24:27], v1, s[4:7], s30 offen offset:0
v_mfma_f32_16x16x32_bf16 a[16:19], v[28:31], v[184:187], a[16:19]
v_mfma_f32_16x16x32_bf16 a[20:23], v[28:31], v[188:191], a[20:23]
v_mfma_f32_16x16x32_bf16 a[24:27], v[28:31], v[192:195], a[24:27]
v_mfma_f32_16x16x32_bf16 a[28:31], v[28:31], v[196:199], a[28:31]
ds_read_b128 v[204:207], v1 offset:37888
buffer_load_dwordx4 v[28:31], v1, s[4:7], s31 offen offset:0
v_mfma_f32_16x16x32_bf16 a[32:35], v[32:35], v[184:187], a[32:35]
v_mfma_f32_16x16x32_bf16 a[36:39], v[32:35], v[188:191], a[36:39]
v_mfma_f32_16x16x32_bf16 a[40:43], v[32:35], v[192:195], a[40:43]
v_mfma_f32_16x16x32_bf16 a[44:47], v[32:35], v[196:199], a[44:47]
ds_read_b128 v[208:211], v6 offset:13312
buffer_load_dwordx4 v[32:35], v1, s[4:7], s32 offen offset:0
v_mfma_f32_16x16x32_bf16 a[48:51], v[36:39], v[184:187], a[48:51]
v_mfma_f32_16x16x32_bf16 a[52:55], v[36:39], v[188:191], a[52:55]
v_mfma_f32_16x16x32_bf16 a[56:59], v[36:39], v[192:195], a[56:59]
v_mfma_f32_16x16x32_bf16 a[60:63], v[36:39], v[196:199], a[60:63]
ds_read_b128 v[212:215], v6 offset:37888
buffer_load_dwordx4 v[36:39], v1, s[4:7], s33 offen offset:0
v_mfma_f32_16x16x32_bf16 a[64:67], v[40:43], v[184:187], a[64:67]
v_mfma_f32_16x16x32_bf16 a[68:71], v[40:43], v[188:191], a[68:71]
v_mfma_f32_16x16x32_bf16 a[72:75], v[40:43], v[192:195], a[72:75]
v_mfma_f32_16x16x32_bf16 a[76:79], v[40:43], v[196:199], a[76:79]
buffer_load_dwordx4 v[40:43], v1, s[4:7], s34 offen offset:0
v_mfma_f32_16x16x32_bf16 a[80:83], v[44:47], v[184:187], a[80:83]
v_mfma_f32_16x16x32_bf16 a[84:87], v[44:47], v[188:191], a[84:87]
v_mfma_f32_16x16x32_bf16 a[88:91], v[44:47], v[192:195], a[88:91]
v_mfma_f32_16x16x32_bf16 a[92:95], v[44:47], v[196:199], a[92:95]
buffer_load_dwordx4 v[44:47], v1, s[4:7], s35 offen offset:0
v_mfma_f32_16x16x32_bf16 a[96:99], v[48:51], v[184:187], a[96:99]
v_mfma_f32_16x16x32_bf16 a[100:103], v[48:51], v[188:191], a[100:103]
v_mfma_f32_16x16x32_bf16 a[104:107], v[48:51], v[192:195], a[104:107]
v_mfma_f32_16x16x32_bf16 a[108:111], v[48:51], v[196:199], a[108:111]
buffer_load_dwordx4 v[48:51], v1, s[4:7], s36 offen offset:0
v_mfma_f32_16x16x32_bf16 a[112:115], v[52:55], v[184:187], a[112:115]
v_mfma_f32_16x16x32_bf16 a[116:119], v[52:55], v[188:191], a[116:119]
v_mfma_f32_16x16x32_bf16 a[120:123], v[52:55], v[192:195], a[120:123]
v_mfma_f32_16x16x32_bf16 a[124:127], v[52:55], v[196:199], a[124:127]
buffer_load_dwordx4 v[52:55], v1, s[4:7], s37 offen offset:0
v_mfma_f32_16x16x32_bf16 a[128:131], v[56:59], v[184:187], a[128:131]
v_mfma_f32_16x16x32_bf16 a[132:135], v[56:59], v[188:191], a[132:135]
v_mfma_f32_16x16x32_bf16 a[136:139], v[56:59], v[192:195], a[136:139]
v_mfma_f32_16x16x32_bf16 a[140:143], v[56:59], v[196:199], a[140:143]
buffer_load_dwordx4 v[56:59], v1, s[4:7], s38 offen offset:0
v_mfma_f32_16x16x32_bf16 a[144:147], v[60:63], v[184:187], a[144:147]
v_mfma_f32_16x16x32_bf16 a[148:151], v[60:63], v[188:191], a[148:151]
v_mfma_f32_16x16x32_bf16 a[152:155], v[60:63], v[192:195], a[152:155]
v_mfma_f32_16x16x32_bf16 a[156:159], v[60:63], v[196:199], a[156:159]
buffer_load_dwordx4 v[60:63], v1, s[4:7], s39 offen offset:0
s_waitcnt vmcnt(30) lgkmcnt(0)
v_mfma_f32_16x16x32_bf16 a[0:3], v[64:67], v[200:203], a[0:3]
v_mfma_f32_16x16x32_bf16 a[4:7], v[64:67], v[204:207], a[4:7]
v_mfma_f32_16x16x32_bf16 a[8:11], v[64:67], v[208:211], a[8:11]
v_mfma_f32_16x16x32_bf16 a[12:15], v[64:67], v[212:215], a[12:15]
ds_read_b128 v[184:187], v1 offset:14336
buffer_load_dwordx4 v[64:67], v1, s[4:7], s30 offen offset:1024
v_mfma_f32_16x16x32_bf16 a[16:19], v[68:71], v[200:203], a[16:19]
v_mfma_f32_16x16x32_bf16 a[20:23], v[68:71], v[204:207], a[20:23]
v_mfma_f32_16x16x32_bf16 a[24:27], v[68:71], v[208:211], a[24:27]
v_mfma_f32_16x16x32_bf16 a[28:31], v[68:71], v[212:215], a[28:31]
ds_read_b128 v[188:191], v1 offset:38912
buffer_load_dwordx4 v[68:71], v1, s[4:7], s31 offen offset:1024
v_mfma_f32_16x16x32_bf16 a[32:35], v[72:75], v[200:203], a[32:35]
v_mfma_f32_16x16x32_bf16 a[36:39], v[72:75], v[204:207], a[36:39]
v_mfma_f32_16x16x32_bf16 a[40:43], v[72:75], v[208:211], a[40:43]
v_mfma_f32_16x16x32_bf16 a[44:47], v[72:75], v[212:215], a[44:47]
ds_read_b128 v[192:195], v6 offset:14336
buffer_load_dwordx4 v[72:75], v1, s[4:7], s32 offen offset:1024
v_mfma_f32_16x16x32_bf16 a[48:51], v[76:79], v[200:203], a[48:51]
v_mfma_f32_16x16x32_bf16 a[52:55], v[76:79], v[204:207], a[52:55]
v_mfma_f32_16x16x32_bf16 a[56:59], v[76:79], v[208:211], a[56:59]
v_mfma_f32_16x16x32_bf16 a[60:63], v[76:79], v[212:215], a[60:63]
ds_read_b128 v[196:199], v6 offset:38912
buffer_load_dwordx4 v[76:79], v1, s[4:7], s33 offen offset:1024
v_mfma_f32_16x16x32_bf16 a[64:67], v[80:83], v[200:203], a[64:67]
v_mfma_f32_16x16x32_bf16 a[68:71], v[80:83], v[204:207], a[68:71]
v_mfma_f32_16x16x32_bf16 a[72:75], v[80:83], v[208:211], a[72:75]
v_mfma_f32_16x16x32_bf16 a[76:79], v[80:83], v[212:215], a[76:79]
buffer_load_dwordx4 v[80:83], v1, s[4:7], s34 offen offset:1024
v_mfma_f32_16x16x32_bf16 a[80:83], v[84:87], v[200:203], a[80:83]
v_mfma_f32_16x16x32_bf16 a[84:87], v[84:87], v[204:207], a[84:87]
v_mfma_f32_16x16x32_bf16 a[88:91], v[84:87], v[208:211], a[88:91]
v_mfma_f32_16x16x32_bf16 a[92:95], v[84:87], v[212:215], a[92:95]
buffer_load_dwordx4 v[84:87], v1, s[4:7], s35 offen offset:1024
v_mfma_f32_16x16x32_bf16 a[96:99], v[88:91], v[200:203], a[96:99]
v_mfma_f32_16x16x32_bf16 a[100:103], v[88:91], v[204:207], a[100:103]
v_mfma_f32_16x16x32_bf16 a[104:107], v[88:91], v[208:211], a[104:107]
v_mfma_f32_16x16x32_bf16 a[108:111], v[88:91], v[212:215], a[108:111]
buffer_load_dwordx4 v[88:91], v1, s[4:7], s36 offen offset:1024
v_mfma_f32_16x16x32_bf16 a[112:115], v[92:95], v[200:203], a[112:115]
v_mfma_f32_16x16x32_bf16 a[116:119], v[92:95], v[204:207], a[116:119]
v_mfma_f32_16x16x32_bf16 a[120:123], v[92:95], v[208:211], a[120:123]
v_mfma_f32_16x16x32_bf16 a[124:127], v[92:95], v[212:215], a[124:127]
buffer_load_dwordx4 v[92:95], v1, s[4:7], s37 offen offset:1024
v_mfma_f32_16x16x32_bf16 a[128:131], v[96:99], v[200:203], a[128:131]
v_mfma_f32_16x16x32_bf16 a[132:135], v[96:99], v[204:207], a[132:135]
v_mfma_f32_16x16x32_bf16 a[136:139], v[96:99], v[208:211], a[136:139]
v_mfma_f32_16x16x32_bf16 a[140:143], v[96:99], v[212:215], a[140:143]
buffer_load_dwordx4 v[96:99], v1, s[4:7], s38 offen offset:1024
v_mfma_f32_16x16x32_bf16 a[144:147], v[100:103], v[200:203], a[144:147]
v_mfma_f32_16x16x32_bf16 a[148:151], v[100:103], v[204:207], a[148:151]
v_mfma_f32_16x16x32_bf16 a[152:155], v[100:103], v[208:211], a[152:155]
v_mfma_f32_16x16x32_bf16 a[156:159], v[100:103], v[212:215], a[156:159]
buffer_load_dwordx4 v[100:103], v1, s[4:7], s39 offen offset:1024
s_waitcnt vmcnt(30) lgkmcnt(0)
v_mfma_f32_16x16x32_bf16 a[0:3], v[104:107], v[184:187], a[0:3]
v_mfma_f32_16x16x32_bf16 a[4:7], v[104:107], v[188:191], a[4:7]
v_mfma_f32_16x16x32_bf16 a[8:11], v[104:107], v[192:195], a[8:11]
v_mfma_f32_16x16x32_bf16 a[12:15], v[104:107], v[196:199], a[12:15]
ds_read_b128 v[200:203], v1 offset:15360
buffer_load_dwordx4 v[104:107], v1, s[4:7], s30 offen offset:2048
v_mfma_f32_16x16x32_bf16 a[16:19], v[108:111], v[184:187], a[16:19]
v_mfma_f32_16x16x32_bf16 a[20:23], v[108:111], v[188:191], a[20:23]
v_mfma_f32_16x16x32_bf16 a[24:27], v[108:111], v[192:195], a[24:27]
v_mfma_f32_16x16x32_bf16 a[28:31], v[108:111], v[196:199], a[28:31]
ds_read_b128 v[204:207], v1 offset:39936
buffer_load_dwordx4 v[108:111], v1, s[4:7], s31 offen offset:2048
v_mfma_f32_16x16x32_bf16 a[32:35], v[112:115], v[184:187], a[32:35]
v_mfma_f32_16x16x32_bf16 a[36:39], v[112:115], v[188:191], a[36:39]
v_mfma_f32_16x16x32_bf16 a[40:43], v[112:115], v[192:195], a[40:43]
v_mfma_f32_16x16x32_bf16 a[44:47], v[112:115], v[196:199], a[44:47]
ds_read_b128 v[208:211], v6 offset:15360
buffer_load_dwordx4 v[112:115], v1, s[4:7], s32 offen offset:2048
v_mfma_f32_16x16x32_bf16 a[48:51], v[116:119], v[184:187], a[48:51]
v_mfma_f32_16x16x32_bf16 a[52:55], v[116:119], v[188:191], a[52:55]
v_mfma_f32_16x16x32_bf16 a[56:59], v[116:119], v[192:195], a[56:59]
v_mfma_f32_16x16x32_bf16 a[60:63], v[116:119], v[196:199], a[60:63]
ds_read_b128 v[212:215], v6 offset:39936
buffer_load_dwordx4 v[116:119], v1, s[4:7], s33 offen offset:2048
v_mfma_f32_16x16x32_bf16 a[64:67], v[120:123], v[184:187], a[64:67]
v_mfma_f32_16x16x32_bf16 a[68:71], v[120:123], v[188:191], a[68:71]
v_mfma_f32_16x16x32_bf16 a[72:75], v[120:123], v[192:195], a[72:75]
v_mfma_f32_16x16x32_bf16 a[76:79], v[120:123], v[196:199], a[76:79]
buffer_load_dwordx4 v[120:123], v1, s[4:7], s34 offen offset:2048
v_mfma_f32_16x16x32_bf16 a[80:83], v[124:127], v[184:187], a[80:83]
v_mfma_f32_16x16x32_bf16 a[84:87], v[124:127], v[188:191], a[84:87]
v_mfma_f32_16x16x32_bf16 a[88:91], v[124:127], v[192:195], a[88:91]
v_mfma_f32_16x16x32_bf16 a[92:95], v[124:127], v[196:199], a[92:95]
buffer_load_dwordx4 v[124:127], v1, s[4:7], s35 offen offset:2048
v_mfma_f32_16x16x32_bf16 a[96:99], v[128:131], v[184:187], a[96:99]
v_mfma_f32_16x16x32_bf16 a[100:103], v[128:131], v[188:191], a[100:103]
v_mfma_f32_16x16x32_bf16 a[104:107], v[128:131], v[192:195], a[104:107]
v_mfma_f32_16x16x32_bf16 a[108:111], v[128:131], v[196:199], a[108:111]
buffer_load_dwordx4 v[128:131], v1, s[4:7], s36 offen offset:2048
v_mfma_f32_16x16x32_bf16 a[112:115], v[132:135], v[184:187], a[112:115]
v_mfma_f32_16x16x32_bf16 a[116:119], v[132:135], v[188:191], a[116:119]
v_mfma_f32_16x16x32_bf16 a[120:123], v[132:135], v[192:195], a[120:123]
v_mfma_f32_16x16x32_bf16 a[124:127], v[132:135], v[196:199], a[124:127]
buffer_load_dwordx4 v[132:135], v1, s[4:7], s37 offen offset:2048
v_mfma_f32_16x16x32_bf16 a[128:131], v[136:139], v[184:187], a[128:131]
v_mfma_f32_16x16x32_bf16 a[132:135], v[136:139], v[188:191], a[132:135]
v_mfma_f32_16x16x32_bf16 a[136:139], v[136:139], v[192:195], a[136:139]
v_mfma_f32_16x16x32_bf16 a[140:143], v[136:139], v[196:199], a[140:143]
buffer_load_dwordx4 v[136:139], v1, s[4:7], s38 offen offset:2048
v_mfma_f32_16x16x32_bf16 a[144:147], v[140:143], v[184:187], a[144:147]
v_mfma_f32_16x16x32_bf16 a[148:151], v[140:143], v[188:191], a[148:151]
v_mfma_f32_16x16x32_bf16 a[152:155], v[140:143], v[192:195], a[152:155]
v_mfma_f32_16x16x32_bf16 a[156:159], v[140:143], v[196:199], a[156:159]
buffer_load_dwordx4 v[140:143], v1, s[4:7], s39 offen offset:2048
s_waitcnt vmcnt(30) lgkmcnt(0)
v_mfma_f32_16x16x32_bf16 a[0:3], v[144:147], v[200:203], a[0:3]
v_mfma_f32_16x16x32_bf16 a[4:7], v[144:147], v[204:207], a[4:7]
v_mfma_f32_16x16x32_bf16 a[8:11], v[144:147], v[208:211], a[8:11]
v_mfma_f32_16x16x32_bf16 a[12:15], v[144:147], v[212:215], a[12:15]
ds_read_b128 v[184:187], v1 offset:16384
buffer_load_dwordx4 v[144:147], v1, s[4:7], s30 offen offset:3072
s_add_u32 s30, s30, 4096
v_mfma_f32_16x16x32_bf16 a[16:19], v[148:151], v[200:203], a[16:19]
v_mfma_f32_16x16x32_bf16 a[20:23], v[148:151], v[204:207], a[20:23]
v_mfma_f32_16x16x32_bf16 a[24:27], v[148:151], v[208:211], a[24:27]
v_mfma_f32_16x16x32_bf16 a[28:31], v[148:151], v[212:215], a[28:31]
ds_read_b128 v[188:191], v1 offset:40960
buffer_load_dwordx4 v[148:151], v1, s[4:7], s31 offen offset:3072
s_add_u32 s31, s31, 4096
v_mfma_f32_16x16x32_bf16 a[32:35], v[152:155], v[200:203], a[32:35]
v_mfma_f32_16x16x32_bf16 a[36:39], v[152:155], v[204:207], a[36:39]
v_mfma_f32_16x16x32_bf16 a[40:43], v[152:155], v[208:211], a[40:43]
v_mfma_f32_16x16x32_bf16 a[44:47], v[152:155], v[212:215], a[44:47]
ds_read_b128 v[192:195], v6 offset:16384
buffer_load_dwordx4 v[152:155], v1, s[4:7], s32 offen offset:3072
s_add_u32 s32, s32, 4096
v_mfma_f32_16x16x32_bf16 a[48:51], v[156:159], v[200:203], a[48:51]
v_mfma_f32_16x16x32_bf16 a[52:55], v[156:159], v[204:207], a[52:55]
v_mfma_f32_16x16x32_bf16 a[56:59], v[156:159], v[208:211], a[56:59]
v_mfma_f32_16x16x32_bf16 a[60:63], v[156:159], v[212:215], a[60:63]
ds_read_b128 v[196:199], v6 offset:40960
buffer_load_dwordx4 v[156:159], v1, s[4:7], s33 offen offset:3072
s_add_u32 s33, s33, 4096
v_mfma_f32_16x16x32_bf16 a[64:67], v[160:163], v[200:203], a[64:67]
v_mfma_f32_16x16x32_bf16 a[68:71], v[160:163], v[204:207], a[68:71]
v_mfma_f32_16x16x32_bf16 a[72:75], v[160:163], v[208:211], a[72:75]
v_mfma_f32_16x16x32_bf16 a[76:79], v[160:163], v[212:215], a[76:79]
buffer_load_dwordx4 v[160:163], v1, s[4:7], s34 offen offset:3072
s_add_u32 s34, s34, 4096
v_mfma_f32_16x16x32_bf16 a[80:83], v[164:167], v[200:203], a[80:83]
v_mfma_f32_16x16x32_bf16 a[84:87], v[164:167], v[204:207], a[84:87]
v_mfma_f32_16x16x32_bf16 a[88:91], v[164:167], v[208:211], a[88:91]
v_mfma_f32_16x16x32_bf16 a[92:95], v[164:167], v[212:215], a[92:95]
buffer_load_dwordx4 v[164:167], v1, s[4:7], s35 offen offset:3072
s_add_u32 s35, s35, 4096
v_mfma_f32_16x16x32_bf16 a[96:99], v[168:171], v[200:203], a[96:99]
v_mfma_f32_16x16x32_bf16 a[100:103], v[168:171], v[204:207], a[100:103]
v_mfma_f32_16x16x32_bf16 a[104:107], v[168:171], v[208:211], a[104:107]
v_mfma_f32_16x16x32_bf16 a[108:111], v[168:171], v[212:215], a[108:111]
buffer_load_dwordx4 v[168:171], v1, s[4:7], s36 offen offset:3072
s_add_u32 s36, s36, 4096
v_mfma_f32_16x16x32_bf16 a[112:115], v[172:175], v[200:203], a[112:115]
v_mfma_f32_16x16x32_bf16 a[116:119], v[172:175], v[204:207], a[116:119]
v_mfma_f32_16x16x32_bf16 a[120:123], v[172:175], v[208:211], a[120:123]
v_mfma_f32_16x16x32_bf16 a[124:127], v[172:175], v[212:215], a[124:127]
buffer_load_dwordx4 v[172:175], v1, s[4:7], s37 offen offset:3072
s_add_u32 s37, s37, 4096
v_mfma_f32_16x16x32_bf16 a[128:131], v[176:179], v[200:203], a[128:131]
v_mfma_f32_16x16x32_bf16 a[132:135], v[176:179], v[204:207], a[132:135]
v_mfma_f32_16x16x32_bf16 a[136:139], v[176:179], v[208:211], a[136:139]
v_mfma_f32_16x16x32_bf16 a[140:143], v[176:179], v[212:215], a[140:143]
buffer_load_dwordx4 v[176:179], v1, s[4:7], s38 offen offset:3072
s_add_u32 s38, s38, 4096
v_mfma_f32_16x16x32_bf16 a[144:147], v[180:183], v[200:203], a[144:147]
v_mfma_f32_16x16x32_bf16 a[148:151], v[180:183], v[204:207], a[148:151]
v_mfma_f32_16x16x32_bf16 a[152:155], v[180:183], v[208:211], a[152:155]
v_mfma_f32_16x16x32_bf16 a[156:159], v[180:183], v[212:215], a[156:159]
buffer_load_dwordx4 v[180:183], v1, s[4:7], s39 offen offset:3072
s_add_u32 s39, s39, 4096
s_waitcnt vmcnt(30) lgkmcnt(0)
v_mfma_f32_16x16x32_bf16 a[0:3], v[24:27], v[184:187], a[0:3]
v_mfma_f32_16x16x32_bf16 a[4:7], v[24:27], v[188:191], a[4:7]
v_mfma_f32_16x16x32_bf16 a[8:11], v[24:27], v[192:195], a[8:11]
v_mfma_f32_16x16x32_bf16 a[12:15], v[24:27], v[196:199], a[12:15]
ds_read_b128 v[200:203], v1 offset:17408
buffer_load_dwordx4 v[24:27], v1, s[4:7], s30 offen offset:0
v_mfma_f32_16x16x32_bf16 a[16:19], v[28:31], v[184:187], a[16:19]
v_mfma_f32_16x16x32_bf16 a[20:23], v[28:31], v[188:191], a[20:23]
v_mfma_f32_16x16x32_bf16 a[24:27], v[28:31], v[192:195], a[24:27]
v_mfma_f32_16x16x32_bf16 a[28:31], v[28:31], v[196:199], a[28:31]
ds_read_b128 v[204:207], v1 offset:41984
buffer_load_dwordx4 v[28:31], v1, s[4:7], s31 offen offset:0
v_mfma_f32_16x16x32_bf16 a[32:35], v[32:35], v[184:187], a[32:35]
v_mfma_f32_16x16x32_bf16 a[36:39], v[32:35], v[188:191], a[36:39]
v_mfma_f32_16x16x32_bf16 a[40:43], v[32:35], v[192:195], a[40:43]
v_mfma_f32_16x16x32_bf16 a[44:47], v[32:35], v[196:199], a[44:47]
ds_read_b128 v[208:211], v6 offset:17408
buffer_load_dwordx4 v[32:35], v1, s[4:7], s32 offen offset:0
v_mfma_f32_16x16x32_bf16 a[48:51], v[36:39], v[184:187], a[48:51]
v_mfma_f32_16x16x32_bf16 a[52:55], v[36:39], v[188:191], a[52:55]
v_mfma_f32_16x16x32_bf16 a[56:59], v[36:39], v[192:195], a[56:59]
v_mfma_f32_16x16x32_bf16 a[60:63], v[36:39], v[196:199], a[60:63]
ds_read_b128 v[212:215], v6 offset:41984
buffer_load_dwordx4 v[36:39], v1, s[4:7], s33 offen offset:0
v_mfma_f32_16x16x32_bf16 a[64:67], v[40:43], v[184:187], a[64:67]
v_mfma_f32_16x16x32_bf16 a[68:71], v[40:43], v[188:191], a[68:71]
v_mfma_f32_16x16x32_bf16 a[72:75], v[40:43], v[192:195], a[72:75]
v_mfma_f32_16x16x32_bf16 a[76:79], v[40:43], v[196:199], a[76:79]
buffer_load_dwordx4 v[40:43], v1, s[4:7], s34 offen offset:0
v_mfma_f32_16x16x32_bf16 a[80:83], v[44:47], v[184:187], a[80:83]
v_mfma_f32_16x16x32_bf16 a[84:87], v[44:47], v[188:191], a[84:87]
v_mfma_f32_16x16x32_bf16 a[88:91], v[44:47], v[192:195], a[88:91]
v_mfma_f32_16x16x32_bf16 a[92:95], v[44:47], v[196:199], a[92:95]
buffer_load_dwordx4 v[44:47], v1, s[4:7], s35 offen offset:0
v_mfma_f32_16x16x32_bf16 a[96:99], v[48:51], v[184:187], a[96:99]
v_mfma_f32_16x16x32_bf16 a[100:103], v[48:51], v[188:191], a[100:103]
v_mfma_f32_16x16x32_bf16 a[104:107], v[48:51], v[192:195], a[104:107]
v_mfma_f32_16x16x32_bf16 a[108:111], v[48:51], v[196:199], a[108:111]
buffer_load_dwordx4 v[48:51], v1, s[4:7], s36 offen offset:0
v_mfma_f32_16x16x32_bf16 a[112:115], v[52:55], v[184:187], a[112:115]
v_mfma_f32_16x16x32_bf16 a[116:119], v[52:55], v[188:191], a[116:119]
v_mfma_f32_16x16x32_bf16 a[120:123], v[52:55], v[192:195], a[120:123]
v_mfma_f32_16x16x32_bf16 a[124:127], v[52:55], v[196:199], a[124:127]
buffer_load_dwordx4 v[52:55], v1, s[4:7], s37 offen offset:0
v_mfma_f32_16x16x32_bf16 a[128:131], v[56:59], v[184:187], a[128:131]
v_mfma_f32_16x16x32_bf16 a[132:135], v[56:59], v[188:191], a[132:135]
v_mfma_f32_16x16x32_bf16 a[136:139], v[56:59], v[192:195], a[136:139]
v_mfma_f32_16x16x32_bf16 a[140:143], v[56:59], v[196:199], a[140:143]
buffer_load_dwordx4 v[56:59], v1, s[4:7], s38 offen offset:0
v_mfma_f32_16x16x32_bf16 a[144:147], v[60:63], v[184:187], a[144:147]
v_mfma_f32_16x16x32_bf16 a[148:151], v[60:63], v[188:191], a[148:151]
v_mfma_f32_16x16x32_bf16 a[152:155], v[60:63], v[192:195], a[152:155]
v_mfma_f32_16x16x32_bf16 a[156:159], v[60:63], v[196:199], a[156:159]
buffer_load_dwordx4 v[60:63], v1, s[4:7], s39 offen offset:0
s_waitcnt vmcnt(30) lgkmcnt(0)
v_mfma_f32_16x16x32_bf16 a[0:3], v[64:67], v[200:203], a[0:3]
v_mfma_f32_16x16x32_bf16 a[4:7], v[64:67], v[204:207], a[4:7]
v_mfma_f32_16x16x32_bf16 a[8:11], v[64:67], v[208:211], a[8:11]
v_mfma_f32_16x16x32_bf16 a[12:15], v[64:67], v[212:215], a[12:15]
ds_read_b128 v[184:187], v1 offset:18432
buffer_load_dwordx4 v[64:67], v1, s[4:7], s30 offen offset:1024
v_mfma_f32_16x16x32_bf16 a[16:19], v[68:71], v[200:203], a[16:19]
v_mfma_f32_16x16x32_bf16 a[20:23], v[68:71], v[204:207], a[20:23]
v_mfma_f32_16x16x32_bf16 a[24:27], v[68:71], v[208:211], a[24:27]
v_mfma_f32_16x16x32_bf16 a[28:31], v[68:71], v[212:215], a[28:31]
ds_read_b128 v[188:191], v1 offset:43008
buffer_load_dwordx4 v[68:71], v1, s[4:7], s31 offen offset:1024
v_mfma_f32_16x16x32_bf16 a[32:35], v[72:75], v[200:203], a[32:35]
v_mfma_f32_16x16x32_bf16 a[36:39], v[72:75], v[204:207], a[36:39]
v_mfma_f32_16x16x32_bf16 a[40:43], v[72:75], v[208:211], a[40:43]
v_mfma_f32_16x16x32_bf16 a[44:47], v[72:75], v[212:215], a[44:47]
ds_read_b128 v[192:195], v6 offset:18432
buffer_load_dwordx4 v[72:75], v1, s[4:7], s32 offen offset:1024
v_mfma_f32_16x16x32_bf16 a[48:51], v[76:79], v[200:203], a[48:51]
v_mfma_f32_16x16x32_bf16 a[52:55], v[76:79], v[204:207], a[52:55]
v_mfma_f32_16x16x32_bf16 a[56:59], v[76:79], v[208:211], a[56:59]
v_mfma_f32_16x16x32_bf16 a[60:63], v[76:79], v[212:215], a[60:63]
ds_read_b128 v[196:199], v6 offset:43008
buffer_load_dwordx4 v[76:79], v1, s[4:7], s33 offen offset:1024
v_mfma_f32_16x16x32_bf16 a[64:67], v[80:83], v[200:203], a[64:67]
v_mfma_f32_16x16x32_bf16 a[68:71], v[80:83], v[204:207], a[68:71]
v_mfma_f32_16x16x32_bf16 a[72:75], v[80:83], v[208:211], a[72:75]
v_mfma_f32_16x16x32_bf16 a[76:79], v[80:83], v[212:215], a[76:79]
buffer_load_dwordx4 v[80:83], v1, s[4:7], s34 offen offset:1024
v_mfma_f32_16x16x32_bf16 a[80:83], v[84:87], v[200:203], a[80:83]
v_mfma_f32_16x16x32_bf16 a[84:87], v[84:87], v[204:207], a[84:87]
v_mfma_f32_16x16x32_bf16 a[88:91], v[84:87], v[208:211], a[88:91]
v_mfma_f32_16x16x32_bf16 a[92:95], v[84:87], v[212:215], a[92:95]
buffer_load_dwordx4 v[84:87], v1, s[4:7], s35 offen offset:1024
v_mfma_f32_16x16x32_bf16 a[96:99], v[88:91], v[200:203], a[96:99]
v_mfma_f32_16x16x32_bf16 a[100:103], v[88:91], v[204:207], a[100:103]
v_mfma_f32_16x16x32_bf16 a[104:107], v[88:91], v[208:211], a[104:107]
v_mfma_f32_16x16x32_bf16 a[108:111], v[88:91], v[212:215], a[108:111]
buffer_load_dwordx4 v[88:91], v1, s[4:7], s36 offen offset:1024
v_mfma_f32_16x16x32_bf16 a[112:115], v[92:95], v[200:203], a[112:115]
v_mfma_f32_16x16x32_bf16 a[116:119], v[92:95], v[204:207], a[116:119]
v_mfma_f32_16x16x32_bf16 a[120:123], v[92:95], v[208:211], a[120:123]
v_mfma_f32_16x16x32_bf16 a[124:127], v[92:95], v[212:215], a[124:127]
buffer_load_dwordx4 v[92:95], v1, s[4:7], s37 offen offset:1024
v_mfma_f32_16x16x32_bf16 a[128:131], v[96:99], v[200:203], a[128:131]
v_mfma_f32_16x16x32_bf16 a[132:135], v[96:99], v[204:207], a[132:135]
v_mfma_f32_16x16x32_bf16 a[136:139], v[96:99], v[208:211], a[136:139]
v_mfma_f32_16x16x32_bf16 a[140:143], v[96:99], v[212:215], a[140:143]
buffer_load_dwordx4 v[96:99], v1, s[4:7], s38 offen offset:1024
v_mfma_f32_16x16x32_bf16 a[144:147], v[100:103], v[200:203], a[144:147]
v_mfma_f32_16x16x32_bf16 a[148:151], v[100:103], v[204:207], a[148:151]
v_mfma_f32_16x16x32_bf16 a[152:155], v[100:103], v[208:211], a[152:155]
v_mfma_f32_16x16x32_bf16 a[156:159], v[100:103], v[212:215], a[156:159]
buffer_load_dwordx4 v[100:103], v1, s[4:7], s39 offen offset:1024
s_waitcnt vmcnt(30) lgkmcnt(0)
v_mfma_f32_16x16x32_bf16 a[0:3], v[104:107], v[184:187], a[0:3]
v_mfma_f32_16x16x32_bf16 a[4:7], v[104:107], v[188:191], a[4:7]
v_mfma_f32_16x16x32_bf16 a[8:11], v[104:107], v[192:195], a[8:11]
v_mfma_f32_16x16x32_bf16 a[12:15], v[104:107], v[196:199], a[12:15]
ds_read_b128 v[200:203], v1 offset:19456
buffer_load_dwordx4 v[104:107], v1, s[4:7], s30 offen offset:2048
v_mfma_f32_16x16x32_bf16 a[16:19], v[108:111], v[184:187], a[16:19]
v_mfma_f32_16x16x32_bf16 a[20:23], v[108:111], v[188:191], a[20:23]
v_mfma_f32_16x16x32_bf16 a[24:27], v[108:111], v[192:195], a[24:27]
v_mfma_f32_16x16x32_bf16 a[28:31], v[108:111], v[196:199], a[28:31]
ds_read_b128 v[204:207], v1 offset:44032
buffer_load_dwordx4 v[108:111], v1, s[4:7], s31 offen offset:2048
v_mfma_f32_16x16x32_bf16 a[32:35], v[112:115], v[184:187], a[32:35]
v_mfma_f32_16x16x32_bf16 a[36:39], v[112:115], v[188:191], a[36:39]
v_mfma_f32_16x16x32_bf16 a[40:43], v[112:115], v[192:195], a[40:43]
v_mfma_f32_16x16x32_bf16 a[44:47], v[112:115], v[196:199], a[44:47]
ds_read_b128 v[208:211], v6 offset:19456
buffer_load_dwordx4 v[112:115], v1, s[4:7], s32 offen offset:2048
v_mfma_f32_16x16x32_bf16 a[48:51], v[116:119], v[184:187], a[48:51]
v_mfma_f32_16x16x32_bf16 a[52:55], v[116:119], v[188:191], a[52:55]
v_mfma_f32_16x16x32_bf16 a[56:59], v[116:119], v[192:195], a[56:59]
v_mfma_f32_16x16x32_bf16 a[60:63], v[116:119], v[196:199], a[60:63]
ds_read_b128 v[212:215], v6 offset:44032
buffer_load_dwordx4 v[116:119], v1, s[4:7], s33 offen offset:2048
v_mfma_f32_16x16x32_bf16 a[64:67], v[120:123], v[184:187], a[64:67]
v_mfma_f32_16x16x32_bf16 a[68:71], v[120:123], v[188:191], a[68:71]
v_mfma_f32_16x16x32_bf16 a[72:75], v[120:123], v[192:195], a[72:75]
v_mfma_f32_16x16x32_bf16 a[76:79], v[120:123], v[196:199], a[76:79]
buffer_load_dwordx4 v[120:123], v1, s[4:7], s34 offen offset:2048
v_mfma_f32_16x16x32_bf16 a[80:83], v[124:127], v[184:187], a[80:83]
v_mfma_f32_16x16x32_bf16 a[84:87], v[124:127], v[188:191], a[84:87]
v_mfma_f32_16x16x32_bf16 a[88:91], v[124:127], v[192:195], a[88:91]
v_mfma_f32_16x16x32_bf16 a[92:95], v[124:127], v[196:199], a[92:95]
buffer_load_dwordx4 v[124:127], v1, s[4:7], s35 offen offset:2048
v_mfma_f32_16x16x32_bf16 a[96:99], v[128:131], v[184:187], a[96:99]
v_mfma_f32_16x16x32_bf16 a[100:103], v[128:131], v[188:191], a[100:103]
v_mfma_f32_16x16x32_bf16 a[104:107], v[128:131], v[192:195], a[104:107]
v_mfma_f32_16x16x32_bf16 a[108:111], v[128:131], v[196:199], a[108:111]
buffer_load_dwordx4 v[128:131], v1, s[4:7], s36 offen offset:2048
v_mfma_f32_16x16x32_bf16 a[112:115], v[132:135], v[184:187], a[112:115]
v_mfma_f32_16x16x32_bf16 a[116:119], v[132:135], v[188:191], a[116:119]
v_mfma_f32_16x16x32_bf16 a[120:123], v[132:135], v[192:195], a[120:123]
v_mfma_f32_16x16x32_bf16 a[124:127], v[132:135], v[196:199], a[124:127]
buffer_load_dwordx4 v[132:135], v1, s[4:7], s37 offen offset:2048
v_mfma_f32_16x16x32_bf16 a[128:131], v[136:139], v[184:187], a[128:131]
v_mfma_f32_16x16x32_bf16 a[132:135], v[136:139], v[188:191], a[132:135]
v_mfma_f32_16x16x32_bf16 a[136:139], v[136:139], v[192:195], a[136:139]
v_mfma_f32_16x16x32_bf16 a[140:143], v[136:139], v[196:199], a[140:143]
buffer_load_dwordx4 v[136:139], v1, s[4:7], s38 offen offset:2048
v_mfma_f32_16x16x32_bf16 a[144:147], v[140:143], v[184:187], a[144:147]
v_mfma_f32_16x16x32_bf16 a[148:151], v[140:143], v[188:191], a[148:151]
v_mfma_f32_16x16x32_bf16 a[152:155], v[140:143], v[192:195], a[152:155]
v_mfma_f32_16x16x32_bf16 a[156:159], v[140:143], v[196:199], a[156:159]
buffer_load_dwordx4 v[140:143], v1, s[4:7], s39 offen offset:2048
s_waitcnt vmcnt(30) lgkmcnt(0)
v_mfma_f32_16x16x32_bf16 a[0:3], v[144:147], v[200:203], a[0:3]
v_mfma_f32_16x16x32_bf16 a[4:7], v[144:147], v[204:207], a[4:7]
v_mfma_f32_16x16x32_bf16 a[8:11], v[144:147], v[208:211], a[8:11]
v_mfma_f32_16x16x32_bf16 a[12:15], v[144:147], v[212:215], a[12:15]
ds_read_b128 v[184:187], v1 offset:20480
buffer_load_dwordx4 v[144:147], v1, s[4:7], s30 offen offset:3072
s_add_u32 s30, s30, 4096
v_mfma_f32_16x16x32_bf16 a[16:19], v[148:151], v[200:203], a[16:19]
v_mfma_f32_16x16x32_bf16 a[20:23], v[148:151], v[204:207], a[20:23]
v_mfma_f32_16x16x32_bf16 a[24:27], v[148:151], v[208:211], a[24:27]
v_mfma_f32_16x16x32_bf16 a[28:31], v[148:151], v[212:215], a[28:31]
ds_read_b128 v[188:191], v1 offset:45056
buffer_load_dwordx4 v[148:151], v1, s[4:7], s31 offen offset:3072
s_add_u32 s31, s31, 4096
v_mfma_f32_16x16x32_bf16 a[32:35], v[152:155], v[200:203], a[32:35]
v_mfma_f32_16x16x32_bf16 a[36:39], v[152:155], v[204:207], a[36:39]
v_mfma_f32_16x16x32_bf16 a[40:43], v[152:155], v[208:211], a[40:43]
v_mfma_f32_16x16x32_bf16 a[44:47], v[152:155], v[212:215], a[44:47]
ds_read_b128 v[192:195], v6 offset:20480
buffer_load_dwordx4 v[152:155], v1, s[4:7], s32 offen offset:3072
s_add_u32 s32, s32, 4096
v_mfma_f32_16x16x32_bf16 a[48:51], v[156:159], v[200:203], a[48:51]
v_mfma_f32_16x16x32_bf16 a[52:55], v[156:159], v[204:207], a[52:55]
v_mfma_f32_16x16x32_bf16 a[56:59], v[156:159], v[208:211], a[56:59]
v_mfma_f32_16x16x32_bf16 a[60:63], v[156:159], v[212:215], a[60:63]
ds_read_b128 v[196:199], v6 offset:45056
buffer_load_dwordx4 v[156:159], v1, s[4:7], s33 offen offset:3072
s_add_u32 s33, s33, 4096
v_mfma_f32_16x16x32_bf16 a[64:67], v[160:163], v[200:203], a[64:67]
v_mfma_f32_16x16x32_bf16 a[68:71], v[160:163], v[204:207], a[68:71]
v_mfma_f32_16x16x32_bf16 a[72:75], v[160:163], v[208:211], a[72:75]
v_mfma_f32_16x16x32_bf16 a[76:79], v[160:163], v[212:215], a[76:79]
buffer_load_dwordx4 v[160:163], v1, s[4:7], s34 offen offset:3072
s_add_u32 s34, s34, 4096
v_mfma_f32_16x16x32_bf16 a[80:83], v[164:167], v[200:203], a[80:83]
v_mfma_f32_16x16x32_bf16 a[84:87], v[164:167], v[204:207], a[84:87]
v_mfma_f32_16x16x32_bf16 a[88:91], v[164:167], v[208:211], a[88:91]
v_mfma_f32_16x16x32_bf16 a[92:95], v[164:167], v[212:215], a[92:95]
buffer_load_dwordx4 v[164:167], v1, s[4:7], s35 offen offset:3072
s_add_u32 s35, s35, 4096
v_mfma_f32_16x16x32_bf16 a[96:99], v[168:171], v[200:203], a[96:99]
v_mfma_f32_16x16x32_bf16 a[100:103], v[168:171], v[204:207], a[100:103]
v_mfma_f32_16x16x32_bf16 a[104:107], v[168:171], v[208:211], a[104:107]
v_mfma_f32_16x16x32_bf16 a[108:111], v[168:171], v[212:215], a[108:111]
buffer_load_dwordx4 v[168:171], v1, s[4:7], s36 offen offset:3072
s_add_u32 s36, s36, 4096
v_mfma_f32_16x16x32_bf16 a[112:115], v[172:175], v[200:203], a[112:115]
v_mfma_f32_16x16x32_bf16 a[116:119], v[172:175], v[204:207], a[116:119]
v_mfma_f32_16x16x32_bf16 a[120:123], v[172:175], v[208:211], a[120:123]
v_mfma_f32_16x16x32_bf16 a[124:127], v[172:175], v[212:215], a[124:127]
buffer_load_dwordx4 v[172:175], v1, s[4:7], s37 offen offset:3072
s_add_u32 s37, s37, 4096
v_mfma_f32_16x16x32_bf16 a[128:131], v[176:179], v[200:203], a[128:131]
v_mfma_f32_16x16x32_bf16 a[132:135], v[176:179], v[204:207], a[132:135]
v_mfma_f32_16x16x32_bf16 a[136:139], v[176:179], v[208:211], a[136:139]
v_mfma_f32_16x16x32_bf16 a[140:143], v[176:179], v[212:215], a[140:143]
buffer_load_dwordx4 v[176:179], v1, s[4:7], s38 offen offset:3072
s_add_u32 s38, s38, 4096
v_mfma_f32_16x16x32_bf16 a[144:147], v[180:183], v[200:203], a[144:147]
v_mfma_f32_16x16x32_bf16 a[148:151], v[180:183], v[204:207], a[148:151]
v_mfma_f32_16x16x32_bf16 a[152:155], v[180:183], v[208:211], a[152:155]
v_mfma_f32_16x16x32_bf16 a[156:159], v[180:183], v[212:215], a[156:159]
buffer_load_dwordx4 v[180:183], v1, s[4:7], s39 offen offset:3072
s_add_u32 s39, s39, 4096
s_waitcnt vmcnt(30) lgkmcnt(0)
v_mfma_f32_16x16x32_bf16 a[0:3], v[24:27], v[184:187], a[0:3]
v_mfma_f32_16x16x32_bf16 a[4:7], v[24:27], v[188:191], a[4:7]
v_mfma_f32_16x16x32_bf16 a[8:11], v[24:27], v[192:195], a[8:11]
v_mfma_f32_16x16x32_bf16 a[12:15], v[24:27], v[196:199], a[12:15]
ds_read_b128 v[200:203], v1 offset:21504
v_mfma_f32_16x16x32_bf16 a[16:19], v[28:31], v[184:187], a[16:19]
v_mfma_f32_16x16x32_bf16 a[20:23], v[28:31], v[188:191], a[20:23]
v_mfma_f32_16x16x32_bf16 a[24:27], v[28:31], v[192:195], a[24:27]
v_mfma_f32_16x16x32_bf16 a[28:31], v[28:31], v[196:199], a[28:31]
ds_read_b128 v[204:207], v1 offset:46080
v_mfma_f32_16x16x32_bf16 a[32:35], v[32:35], v[184:187], a[32:35]
v_mfma_f32_16x16x32_bf16 a[36:39], v[32:35], v[188:191], a[36:39]
v_mfma_f32_16x16x32_bf16 a[40:43], v[32:35], v[192:195], a[40:43]
v_mfma_f32_16x16x32_bf16 a[44:47], v[32:35], v[196:199], a[44:47]
ds_read_b128 v[208:211], v6 offset:21504
v_mfma_f32_16x16x32_bf16 a[48:51], v[36:39], v[184:187], a[48:51]
v_mfma_f32_16x16x32_bf16 a[52:55], v[36:39], v[188:191], a[52:55]
v_mfma_f32_16x16x32_bf16 a[56:59], v[36:39], v[192:195], a[56:59]
v_mfma_f32_16x16x32_bf16 a[60:63], v[36:39], v[196:199], a[60:63]
ds_read_b128 v[212:215], v6 offset:46080
v_mfma_f32_16x16x32_bf16 a[64:67], v[40:43], v[184:187], a[64:67]
v_mfma_f32_16x16x32_bf16 a[68:71], v[40:43], v[188:191], a[68:71]
v_mfma_f32_16x16x32_bf16 a[72:75], v[40:43], v[192:195], a[72:75]
v_mfma_f32_16x16x32_bf16 a[76:79], v[40:43], v[196:199], a[76:79]
v_mfma_f32_16x16x32_bf16 a[80:83], v[44:47], v[184:187], a[80:83]
v_mfma_f32_16x16x32_bf16 a[84:87], v[44:47], v[188:191], a[84:87]
v_mfma_f32_16x16x32_bf16 a[88:91], v[44:47], v[192:195], a[88:91]
v_mfma_f32_16x16x32_bf16 a[92:95], v[44:47], v[196:199], a[92:95]
v_mfma_f32_16x16x32_bf16 a[96:99], v[48:51], v[184:187], a[96:99]
v_mfma_f32_16x16x32_bf16 a[100:103], v[48:51], v[188:191], a[100:103]
v_mfma_f32_16x16x32_bf16 a[104:107], v[48:51], v[192:195], a[104:107]
v_mfma_f32_16x16x32_bf16 a[108:111], v[48:51], v[196:199], a[108:111]
v_mfma_f32_16x16x32_bf16 a[112:115], v[52:55], v[184:187], a[112:115]
v_mfma_f32_16x16x32_bf16 a[116:119], v[52:55], v[188:191], a[116:119]
v_mfma_f32_16x16x32_bf16 a[120:123], v[52:55], v[192:195], a[120:123]
v_mfma_f32_16x16x32_bf16 a[124:127], v[52:55], v[196:199], a[124:127]
v_mfma_f32_16x16x32_bf16 a[128:131], v[56:59], v[184:187], a[128:131]
v_mfma_f32_16x16x32_bf16 a[132:135], v[56:59], v[188:191], a[132:135]
v_mfma_f32_16x16x32_bf16 a[136:139], v[56:59], v[192:195], a[136:139]
v_mfma_f32_16x16x32_bf16 a[140:143], v[56:59], v[196:199], a[140:143]
v_mfma_f32_16x16x32_bf16 a[144:147], v[60:63], v[184:187], a[144:147]
v_mfma_f32_16x16x32_bf16 a[148:151], v[60:63], v[188:191], a[148:151]
v_mfma_f32_16x16x32_bf16 a[152:155], v[60:63], v[192:195], a[152:155]
v_mfma_f32_16x16x32_bf16 a[156:159], v[60:63], v[196:199], a[156:159]
s_waitcnt vmcnt(20) lgkmcnt(0)
v_mfma_f32_16x16x32_bf16 a[0:3], v[64:67], v[200:203], a[0:3]
v_mfma_f32_16x16x32_bf16 a[4:7], v[64:67], v[204:207], a[4:7]
v_mfma_f32_16x16x32_bf16 a[8:11], v[64:67], v[208:211], a[8:11]
v_mfma_f32_16x16x32_bf16 a[12:15], v[64:67], v[212:215], a[12:15]
ds_read_b128 v[184:187], v1 offset:22528
v_mfma_f32_16x16x32_bf16 a[16:19], v[68:71], v[200:203], a[16:19]
v_mfma_f32_16x16x32_bf16 a[20:23], v[68:71], v[204:207], a[20:23]
v_mfma_f32_16x16x32_bf16 a[24:27], v[68:71], v[208:211], a[24:27]
v_mfma_f32_16x16x32_bf16 a[28:31], v[68:71], v[212:215], a[28:31]
ds_read_b128 v[188:191], v1 offset:47104
v_mfma_f32_16x16x32_bf16 a[32:35], v[72:75], v[200:203], a[32:35]
v_mfma_f32_16x16x32_bf16 a[36:39], v[72:75], v[204:207], a[36:39]
v_mfma_f32_16x16x32_bf16 a[40:43], v[72:75], v[208:211], a[40:43]
v_mfma_f32_16x16x32_bf16 a[44:47], v[72:75], v[212:215], a[44:47]
ds_read_b128 v[192:195], v6 offset:22528
v_mfma_f32_16x16x32_bf16 a[48:51], v[76:79], v[200:203], a[48:51]
v_mfma_f32_16x16x32_bf16 a[52:55], v[76:79], v[204:207], a[52:55]
v_mfma_f32_16x16x32_bf16 a[56:59], v[76:79], v[208:211], a[56:59]
v_mfma_f32_16x16x32_bf16 a[60:63], v[76:79], v[212:215], a[60:63]
ds_read_b128 v[196:199], v6 offset:47104
v_mfma_f32_16x16x32_bf16 a[64:67], v[80:83], v[200:203], a[64:67]
v_mfma_f32_16x16x32_bf16 a[68:71], v[80:83], v[204:207], a[68:71]
v_mfma_f32_16x16x32_bf16 a[72:75], v[80:83], v[208:211], a[72:75]
v_mfma_f32_16x16x32_bf16 a[76:79], v[80:83], v[212:215], a[76:79]
v_mfma_f32_16x16x32_bf16 a[80:83], v[84:87], v[200:203], a[80:83]
v_mfma_f32_16x16x32_bf16 a[84:87], v[84:87], v[204:207], a[84:87]
v_mfma_f32_16x16x32_bf16 a[88:91], v[84:87], v[208:211], a[88:91]
v_mfma_f32_16x16x32_bf16 a[92:95], v[84:87], v[212:215], a[92:95]
v_mfma_f32_16x16x32_bf16 a[96:99], v[88:91], v[200:203], a[96:99]
v_mfma_f32_16x16x32_bf16 a[100:103], v[88:91], v[204:207], a[100:103]
v_mfma_f32_16x16x32_bf16 a[104:107], v[88:91], v[208:211], a[104:107]
v_mfma_f32_16x16x32_bf16 a[108:111], v[88:91], v[212:215], a[108:111]
v_mfma_f32_16x16x32_bf16 a[112:115], v[92:95], v[200:203], a[112:115]
v_mfma_f32_16x16x32_bf16 a[116:119], v[92:95], v[204:207], a[116:119]
v_mfma_f32_16x16x32_bf16 a[120:123], v[92:95], v[208:211], a[120:123]
v_mfma_f32_16x16x32_bf16 a[124:127], v[92:95], v[212:215], a[124:127]
v_mfma_f32_16x16x32_bf16 a[128:131], v[96:99], v[200:203], a[128:131]
v_mfma_f32_16x16x32_bf16 a[132:135], v[96:99], v[204:207], a[132:135]
v_mfma_f32_16x16x32_bf16 a[136:139], v[96:99], v[208:211], a[136:139]
v_mfma_f32_16x16x32_bf16 a[140:143], v[96:99], v[212:215], a[140:143]
v_mfma_f32_16x16x32_bf16 a[144:147], v[100:103], v[200:203], a[144:147]
v_mfma_f32_16x16x32_bf16 a[148:151], v[100:103], v[204:207], a[148:151]
v_mfma_f32_16x16x32_bf16 a[152:155], v[100:103], v[208:211], a[152:155]
v_mfma_f32_16x16x32_bf16 a[156:159], v[100:103], v[212:215], a[156:159]
s_waitcnt vmcnt(10) lgkmcnt(0)
v_mfma_f32_16x16x32_bf16 a[0:3], v[104:107], v[184:187], a[0:3]
v_mfma_f32_16x16x32_bf16 a[4:7], v[104:107], v[188:191], a[4:7]
v_mfma_f32_16x16x32_bf16 a[8:11], v[104:107], v[192:195], a[8:11]
v_mfma_f32_16x16x32_bf16 a[12:15], v[104:107], v[196:199], a[12:15]
ds_read_b128 v[200:203], v1 offset:23552
v_mfma_f32_16x16x32_bf16 a[16:19], v[108:111], v[184:187], a[16:19]
v_mfma_f32_16x16x32_bf16 a[20:23], v[108:111], v[188:191], a[20:23]
v_mfma_f32_16x16x32_bf16 a[24:27], v[108:111], v[192:195], a[24:27]
v_mfma_f32_16x16x32_bf16 a[28:31], v[108:111], v[196:199], a[28:31]
ds_read_b128 v[204:207], v1 offset:48128
v_mfma_f32_16x16x32_bf16 a[32:35], v[112:115], v[184:187], a[32:35]
v_mfma_f32_16x16x32_bf16 a[36:39], v[112:115], v[188:191], a[36:39]
v_mfma_f32_16x16x32_bf16 a[40:43], v[112:115], v[192:195], a[40:43]
v_mfma_f32_16x16x32_bf16 a[44:47], v[112:115], v[196:199], a[44:47]
ds_read_b128 v[208:211], v6 offset:23552
v_mfma_f32_16x16x32_bf16 a[48:51], v[116:119], v[184:187], a[48:51]
v_mfma_f32_16x16x32_bf16 a[52:55], v[116:119], v[188:191], a[52:55]
v_mfma_f32_16x16x32_bf16 a[56:59], v[116:119], v[192:195], a[56:59]
v_mfma_f32_16x16x32_bf16 a[60:63], v[116:119], v[196:199], a[60:63]
ds_read_b128 v[212:215], v6 offset:48128
v_mfma_f32_16x16x32_bf16 a[64:67], v[120:123], v[184:187], a[64:67]
v_mfma_f32_16x16x32_bf16 a[68:71], v[120:123], v[188:191], a[68:71]
v_mfma_f32_16x16x32_bf16 a[72:75], v[120:123], v[192:195], a[72:75]
v_mfma_f32_16x16x32_bf16 a[76:79], v[120:123], v[196:199], a[76:79]
v_mfma_f32_16x16x32_bf16 a[80:83], v[124:127], v[184:187], a[80:83]
v_mfma_f32_16x16x32_bf16 a[84:87], v[124:127], v[188:191], a[84:87]
v_mfma_f32_16x16x32_bf16 a[88:91], v[124:127], v[192:195], a[88:91]
v_mfma_f32_16x16x32_bf16 a[92:95], v[124:127], v[196:199], a[92:95]
v_mfma_f32_16x16x32_bf16 a[96:99], v[128:131], v[184:187], a[96:99]
v_mfma_f32_16x16x32_bf16 a[100:103], v[128:131], v[188:191], a[100:103]
v_mfma_f32_16x16x32_bf16 a[104:107], v[128:131], v[192:195], a[104:107]
v_mfma_f32_16x16x32_bf16 a[108:111], v[128:131], v[196:199], a[108:111]
v_mfma_f32_16x16x32_bf16 a[112:115], v[132:135], v[184:187], a[112:115]
v_mfma_f32_16x16x32_bf16 a[116:119], v[132:135], v[188:191], a[116:119]
v_mfma_f32_16x16x32_bf16 a[120:123], v[132:135], v[192:195], a[120:123]
v_mfma_f32_16x16x32_bf16 a[124:127], v[132:135], v[196:199], a[124:127]
v_mfma_f32_16x16x32_bf16 a[128:131], v[136:139], v[184:187], a[128:131]
v_mfma_f32_16x16x32_bf16 a[132:135], v[136:139], v[188:191], a[132:135]
v_mfma_f32_16x16x32_bf16 a[136:139], v[136:139], v[192:195], a[136:139]
v_mfma_f32_16x16x32_bf16 a[140:143], v[136:139], v[196:199], a[140:143]
v_mfma_f32_16x16x32_bf16 a[144:147], v[140:143], v[184:187], a[144:147]
v_mfma_f32_16x16x32_bf16 a[148:151], v[140:143], v[188:191], a[148:151]
v_mfma_f32_16x16x32_bf16 a[152:155], v[140:143], v[192:195], a[152:155]
v_mfma_f32_16x16x32_bf16 a[156:159], v[140:143], v[196:199], a[156:159]
s_waitcnt vmcnt(0) lgkmcnt(0)
v_mfma_f32_16x16x32_bf16 a[0:3], v[144:147], v[200:203], a[0:3]
v_mfma_f32_16x16x32_bf16 a[4:7], v[144:147], v[204:207], a[4:7]
v_mfma_f32_16x16x32_bf16 a[8:11], v[144:147], v[208:211], a[8:11]
v_mfma_f32_16x16x32_bf16 a[12:15], v[144:147], v[212:215], a[12:15]
v_mfma_f32_16x16x32_bf16 a[16:19], v[148:151], v[200:203], a[16:19]
v_mfma_f32_16x16x32_bf16 a[20:23], v[148:151], v[204:207], a[20:23]
v_mfma_f32_16x16x32_bf16 a[24:27], v[148:151], v[208:211], a[24:27]
v_mfma_f32_16x16x32_bf16 a[28:31], v[148:151], v[212:215], a[28:31]
v_mfma_f32_16x16x32_bf16 a[32:35], v[152:155], v[200:203], a[32:35]
v_mfma_f32_16x16x32_bf16 a[36:39], v[152:155], v[204:207], a[36:39]
v_mfma_f32_16x16x32_bf16 a[40:43], v[152:155], v[208:211], a[40:43]
v_mfma_f32_16x16x32_bf16 a[44:47], v[152:155], v[212:215], a[44:47]
v_mfma_f32_16x16x32_bf16 a[48:51], v[156:159], v[200:203], a[48:51]
v_mfma_f32_16x16x32_bf16 a[52:55], v[156:159], v[204:207], a[52:55]
v_mfma_f32_16x16x32_bf16 a[56:59], v[156:159], v[208:211], a[56:59]
v_mfma_f32_16x16x32_bf16 a[60:63], v[156:159], v[212:215], a[60:63]
v_mfma_f32_16x16x32_bf16 a[64:67], v[160:163], v[200:203], a[64:67]
v_mfma_f32_16x16x32_bf16 a[68:71], v[160:163], v[204:207], a[68:71]
v_mfma_f32_16x16x32_bf16 a[72:75], v[160:163], v[208:211], a[72:75]
v_mfma_f32_16x16x32_bf16 a[76:79], v[160:163], v[212:215], a[76:79]
v_mfma_f32_16x16x32_bf16 a[80:83], v[164:167], v[200:203], a[80:83]
v_mfma_f32_16x16x32_bf16 a[84:87], v[164:167], v[204:207], a[84:87]
v_mfma_f32_16x16x32_bf16 a[88:91], v[164:167], v[208:211], a[88:91]
v_mfma_f32_16x16x32_bf16 a[92:95], v[164:167], v[212:215], a[92:95]
v_mfma_f32_16x16x32_bf16 a[96:99], v[168:171], v[200:203], a[96:99]
v_mfma_f32_16x16x32_bf16 a[100:103], v[168:171], v[204:207], a[100:103]
v_mfma_f32_16x16x32_bf16 a[104:107], v[168:171], v[208:211], a[104:107]
v_mfma_f32_16x16x32_bf16 a[108:111], v[168:171], v[212:215], a[108:111]
v_mfma_f32_16x16x32_bf16 a[112:115], v[172:175], v[200:203], a[112:115]
v_mfma_f32_16x16x32_bf16 a[116:119], v[172:175], v[204:207], a[116:119]
v_mfma_f32_16x16x32_bf16 a[120:123], v[172:175], v[208:211], a[120:123]
v_mfma_f32_16x16x32_bf16 a[124:127], v[172:175], v[212:215], a[124:127]
v_mfma_f32_16x16x32_bf16 a[128:131], v[176:179], v[200:203], a[128:131]
v_mfma_f32_16x16x32_bf16 a[132:135], v[176:179], v[204:207], a[132:135]
v_mfma_f32_16x16x32_bf16 a[136:139], v[176:179], v[208:211], a[136:139]
v_mfma_f32_16x16x32_bf16 a[140:143], v[176:179], v[212:215], a[140:143]
v_mfma_f32_16x16x32_bf16 a[144:147], v[180:183], v[200:203], a[144:147]
v_mfma_f32_16x16x32_bf16 a[148:151], v[180:183], v[204:207], a[148:151]
v_mfma_f32_16x16x32_bf16 a[152:155], v[180:183], v[208:211], a[152:155]
v_mfma_f32_16x16x32_bf16 a[156:159], v[180:183], v[212:215], a[156:159]
s_branch fin_store4
fin_odma3:
s_lshl_b32 s16, s14, 2
s_add_u32 s16, s16, s12
s_mul_i32 s16, s16, 192
s_mul_i32 s17, s13, 24
s_add_u32 s16, s16, s17
s_lshl_b32 s16, s16, 10
s_add_u32 s16, s16, 57147392
s_mul_i32 s17, s12, 24576
v_add_u32 v6, 49152, v1
s_add_u32 m0, s17, 0
s_add_u32 s18, s16, 0
buffer_load_dwordx4 v1, s[4:7], s18 offen offset:0 lds
buffer_load_dwordx4 v1, s[4:7], s18 offen offset:1024 lds
buffer_load_dwordx4 v1, s[4:7], s18 offen offset:2048 lds
buffer_load_dwordx4 v1, s[4:7], s18 offen offset:3072 lds
s_add_u32 m0, s17, 4096
s_add_u32 s18, s16, 4096
buffer_load_dwordx4 v1, s[4:7], s18 offen offset:0 lds
buffer_load_dwordx4 v1, s[4:7], s18 offen offset:1024 lds
buffer_load_dwordx4 a[160:163], v1, s[4:7], s30 offen offset:0
buffer_load_dwordx4 a[164:167], v1, s[4:7], s31 offen offset:0
buffer_load_dwordx4 a[168:171], v1, s[4:7], s32 offen offset:0
buffer_load_dwordx4 a[172:175], v1, s[4:7], s33 offen offset:0
buffer_load_dwordx4 a[176:179], v1, s[4:7], s34 offen offset:0
buffer_load_dwordx4 a[180:183], v1, s[4:7], s35 offen offset:0
buffer_load_dwordx4 a[184:187], v1, s[4:7], s36 offen offset:0
buffer_load_dwordx4 a[188:191], v1, s[4:7], s37 offen offset:0
buffer_load_dwordx4 a[192:195], v1, s[4:7], s38 offen offset:0
buffer_load_dwordx4 a[196:199], v1, s[4:7], s39 offen offset:0
buffer_load_dwordx4 a[200:203], v1, s[4:7], s30 offen offset:1024
buffer_load_dwordx4 a[204:207], v1, s[4:7], s31 offen offset:1024
buffer_load_dwordx4 a[208:211], v1, s[4:7], s32 offen offset:1024
buffer_load_dwordx4 a[212:215], v1, s[4:7], s33 offen offset:1024
buffer_load_dwordx4 a[216:219], v1, s[4:7], s34 offen offset:1024
buffer_load_dwordx4 a[220:223], v1, s[4:7], s35 offen offset:1024
buffer_load_dwordx4 a[224:227], v1, s[4:7], s36 offen offset:1024
buffer_load_dwordx4 a[228:231], v1, s[4:7], s37 offen offset:1024
buffer_load_dwordx4 a[232:235], v1, s[4:7], s38 offen offset:1024
buffer_load_dwordx4 a[236:239], v1, s[4:7], s39 offen offset:1024
s_add_u32 m0, s17, 6144
s_add_u32 s18, s16, 6144
buffer_load_dwordx4 v1, s[4:7], s18 offen offset:0 lds
buffer_load_dwordx4 v1, s[4:7], s18 offen offset:1024 lds
buffer_load_dwordx4 v1, s[4:7], s18 offen offset:2048 lds
buffer_load_dwordx4 v1, s[4:7], s18 offen offset:3072 lds
s_add_u32 m0, s17, 10240
s_add_u32 s18, s16, 10240
buffer_load_dwordx4 v1, s[4:7], s18 offen offset:0 lds
buffer_load_dwordx4 v1, s[4:7], s18 offen offset:1024 lds
buffer_load_dwordx4 v[104:107], v1, s[4:7], s30 offen offset:2048
buffer_load_dwordx4 v[108:111], v1, s[4:7], s31 offen offset:2048
buffer_load_dwordx4 v[112:115], v1, s[4:7], s32 offen offset:2048
buffer_load_dwordx4 v[116:119], v1, s[4:7], s33 offen offset:2048
buffer_load_dwordx4 v[120:123], v1, s[4:7], s34 offen offset:2048
buffer_load_dwordx4 v[124:127], v1, s[4:7], s35 offen offset:2048
buffer_load_dwordx4 v[128:131], v1, s[4:7], s36 offen offset:2048
buffer_load_dwordx4 v[132:135], v1, s[4:7], s37 offen offset:2048
buffer_load_dwordx4 v[136:139], v1, s[4:7], s38 offen offset:2048
buffer_load_dwordx4 v[140:143], v1, s[4:7], s39 offen offset:2048
s_waitcnt vmcnt(36)
s_barrier
s_add_u32 m0, s17, 12288
s_add_u32 s18, s16, 12288
buffer_load_dwordx4 v1, s[4:7], s18 offen offset:0 lds
buffer_load_dwordx4 v1, s[4:7], s18 offen offset:1024 lds
buffer_load_dwordx4 v1, s[4:7], s18 offen offset:2048 lds
buffer_load_dwordx4 v1, s[4:7], s18 offen offset:3072 lds
s_add_u32 m0, s17, 16384
s_add_u32 s18, s16, 16384
buffer_load_dwordx4 v1, s[4:7], s18 offen offset:0 lds
buffer_load_dwordx4 v1, s[4:7], s18 offen offset:1024 lds
buffer_load_dwordx4 v[144:147], v1, s[4:7], s30 offen offset:3072
buffer_load_dwordx4 v[148:151], v1, s[4:7], s31 offen offset:3072
buffer_load_dwordx4 v[152:155], v1, s[4:7], s32 offen offset:3072
buffer_load_dwordx4 v[156:159], v1, s[4:7], s33 offen offset:3072
buffer_load_dwordx4 v[160:163], v1, s[4:7], s34 offen offset:3072
buffer_load_dwordx4 v[164:167], v1, s[4:7], s35 offen offset:3072
buffer_load_dwordx4 v[168:171], v1, s[4:7], s36 offen offset:3072
buffer_load_dwordx4 v[172:175], v1, s[4:7], s37 offen offset:3072
buffer_load_dwordx4 v[176:179], v1, s[4:7], s38 offen offset:3072
buffer_load_dwordx4 v[180:183], v1, s[4:7], s39 offen offset:3072
s_add_u32 s30, s30, 4096
s_add_u32 s31, s31, 4096
s_add_u32 s32, s32, 4096
s_add_u32 s33, s33, 4096
s_add_u32 s34, s34, 4096
s_add_u32 s35, s35, 4096
s_add_u32 s36, s36, 4096
s_add_u32 s37, s37, 4096
s_add_u32 s38, s38, 4096
s_add_u32 s39, s39, 4096
ds_read_b128 v[184:187], v1 offset:0
ds_read_b128 v[188:191], v1 offset:24576
ds_read_b128 v[192:195], v6 offset:0
ds_read_b128 v[196:199], v6 offset:24576
s_waitcnt vmcnt(42)
s_waitcnt lgkmcnt(0)
v_mfma_f32_16x16x32_bf16 a[0:3], a[160:163], v[184:187], 0
v_mfma_f32_16x16x32_bf16 a[4:7], a[160:163], v[188:191], 0
v_mfma_f32_16x16x32_bf16 a[8:11], a[160:163], v[192:195], 0
v_mfma_f32_16x16x32_bf16 a[12:15], a[160:163], v[196:199], 0
ds_read_b128 v[200:203], v1 offset:1024
buffer_load_dwordx4 v[24:27], v1, s[4:7], s30 offen offset:0
v_mfma_f32_16x16x32_bf16 a[16:19], a[164:167], v[184:187], 0
v_mfma_f32_16x16x32_bf16 a[20:23], a[164:167], v[188:191], 0
v_mfma_f32_16x16x32_bf16 a[24:27], a[164:167], v[192:195], 0
v_mfma_f32_16x16x32_bf16 a[28:31], a[164:167], v[196:199], 0
ds_read_b128 v[204:207], v1 offset:25600
buffer_load_dwordx4 v[28:31], v1, s[4:7], s31 offen offset:0
v_mfma_f32_16x16x32_bf16 a[32:35], a[168:171], v[184:187], 0
v_mfma_f32_16x16x32_bf16 a[36:39], a[168:171], v[188:191], 0
v_mfma_f32_16x16x32_bf16 a[40:43], a[168:171], v[192:195], 0
v_mfma_f32_16x16x32_bf16 a[44:47], a[168:171], v[196:199], 0
ds_read_b128 v[208:211], v6 offset:1024
buffer_load_dwordx4 v[32:35], v1, s[4:7], s32 offen offset:0
v_mfma_f32_16x16x32_bf16 a[48:51], a[172:175], v[184:187], 0
v_mfma_f32_16x16x32_bf16 a[52:55], a[172:175], v[188:191], 0
v_mfma_f32_16x16x32_bf16 a[56:59], a[172:175], v[192:195], 0
v_mfma_f32_16x16x32_bf16 a[60:63], a[172:175], v[196:199], 0
ds_read_b128 v[212:215], v6 offset:25600
buffer_load_dwordx4 v[36:39], v1, s[4:7], s33 offen offset:0
v_mfma_f32_16x16x32_bf16 a[64:67], a[176:179], v[184:187], 0
v_mfma_f32_16x16x32_bf16 a[68:71], a[176:179], v[188:191], 0
v_mfma_f32_16x16x32_bf16 a[72:75], a[176:179], v[192:195], 0
v_mfma_f32_16x16x32_bf16 a[76:79], a[176:179], v[196:199], 0
buffer_load_dwordx4 v[40:43], v1, s[4:7], s34 offen offset:0
v_mfma_f32_16x16x32_bf16 a[80:83], a[180:183], v[184:187], 0
v_mfma_f32_16x16x32_bf16 a[84:87], a[180:183], v[188:191], 0
v_mfma_f32_16x16x32_bf16 a[88:91], a[180:183], v[192:195], 0
v_mfma_f32_16x16x32_bf16 a[92:95], a[180:183], v[196:199], 0
buffer_load_dwordx4 v[44:47], v1, s[4:7], s35 offen offset:0
v_mfma_f32_16x16x32_bf16 a[96:99], a[184:187], v[184:187], 0
v_mfma_f32_16x16x32_bf16 a[100:103], a[184:187], v[188:191], 0
v_mfma_f32_16x16x32_bf16 a[104:107], a[184:187], v[192:195], 0
v_mfma_f32_16x16x32_bf16 a[108:111], a[184:187], v[196:199], 0
buffer_load_dwordx4 v[48:51], v1, s[4:7], s36 offen offset:0
v_mfma_f32_16x16x32_bf16 a[112:115], a[188:191], v[184:187], 0
v_mfma_f32_16x16x32_bf16 a[116:119], a[188:191], v[188:191], 0
v_mfma_f32_16x16x32_bf16 a[120:123], a[188:191], v[192:195], 0
v_mfma_f32_16x16x32_bf16 a[124:127], a[188:191], v[196:199], 0
buffer_load_dwordx4 v[52:55], v1, s[4:7], s37 offen offset:0
v_mfma_f32_16x16x32_bf16 a[128:131], a[192:195], v[184:187], 0
v_mfma_f32_16x16x32_bf16 a[132:135], a[192:195], v[188:191], 0
v_mfma_f32_16x16x32_bf16 a[136:139], a[192:195], v[192:195], 0
v_mfma_f32_16x16x32_bf16 a[140:143], a[192:195], v[196:199], 0
buffer_load_dwordx4 v[56:59], v1, s[4:7], s38 offen offset:0
v_mfma_f32_16x16x32_bf16 a[144:147], a[196:199], v[184:187], 0
v_mfma_f32_16x16x32_bf16 a[148:151], a[196:199], v[188:191], 0
v_mfma_f32_16x16x32_bf16 a[152:155], a[196:199], v[192:195], 0
v_mfma_f32_16x16x32_bf16 a[156:159], a[196:199], v[196:199], 0
buffer_load_dwordx4 v[60:63], v1, s[4:7], s39 offen offset:0
s_add_u32 m0, s17, 18432
s_add_u32 s18, s16, 18432
buffer_load_dwordx4 v1, s[4:7], s18 offen offset:0 lds
buffer_load_dwordx4 v1, s[4:7], s18 offen offset:1024 lds
buffer_load_dwordx4 v1, s[4:7], s18 offen offset:2048 lds
buffer_load_dwordx4 v1, s[4:7], s18 offen offset:3072 lds
s_add_u32 m0, s17, 22528
s_add_u32 s18, s16, 22528
buffer_load_dwordx4 v1, s[4:7], s18 offen offset:0 lds
buffer_load_dwordx4 v1, s[4:7], s18 offen offset:1024 lds
s_waitcnt vmcnt(48)
s_waitcnt lgkmcnt(0)
v_mfma_f32_16x16x32_bf16 a[0:3], a[200:203], v[200:203], a[0:3]
v_mfma_f32_16x16x32_bf16 a[4:7], a[200:203], v[204:207], a[4:7]
v_mfma_f32_16x16x32_bf16 a[8:11], a[200:203], v[208:211], a[8:11]
v_mfma_f32_16x16x32_bf16 a[12:15], a[200:203], v[212:215], a[12:15]
ds_read_b128 v[184:187], v1 offset:2048
buffer_load_dwordx4 v[64:67], v1, s[4:7], s30 offen offset:1024
v_mfma_f32_16x16x32_bf16 a[16:19], a[204:207], v[200:203], a[16:19]
v_mfma_f32_16x16x32_bf16 a[20:23], a[204:207], v[204:207], a[20:23]
v_mfma_f32_16x16x32_bf16 a[24:27], a[204:207], v[208:211], a[24:27]
v_mfma_f32_16x16x32_bf16 a[28:31], a[204:207], v[212:215], a[28:31]
ds_read_b128 v[188:191], v1 offset:26624
buffer_load_dwordx4 v[68:71], v1, s[4:7], s31 offen offset:1024
v_mfma_f32_16x16x32_bf16 a[32:35], a[208:211], v[200:203], a[32:35]
v_mfma_f32_16x16x32_bf16 a[36:39], a[208:211], v[204:207], a[36:39]
v_mfma_f32_16x16x32_bf16 a[40:43], a[208:211], v[208:211], a[40:43]
v_mfma_f32_16x16x32_bf16 a[44:47], a[208:211], v[212:215], a[44:47]
ds_read_b128 v[192:195], v6 offset:2048
buffer_load_dwordx4 v[72:75], v1, s[4:7], s32 offen offset:1024
v_mfma_f32_16x16x32_bf16 a[48:51], a[212:215], v[200:203], a[48:51]
v_mfma_f32_16x16x32_bf16 a[52:55], a[212:215], v[204:207], a[52:55]
v_mfma_f32_16x16x32_bf16 a[56:59], a[212:215], v[208:211], a[56:59]
v_mfma_f32_16x16x32_bf16 a[60:63], a[212:215], v[212:215], a[60:63]
ds_read_b128 v[196:199], v6 offset:26624
buffer_load_dwordx4 v[76:79], v1, s[4:7], s33 offen offset:1024
v_mfma_f32_16x16x32_bf16 a[64:67], a[216:219], v[200:203], a[64:67]
v_mfma_f32_16x16x32_bf16 a[68:71], a[216:219], v[204:207], a[68:71]
v_mfma_f32_16x16x32_bf16 a[72:75], a[216:219], v[208:211], a[72:75]
v_mfma_f32_16x16x32_bf16 a[76:79], a[216:219], v[212:215], a[76:79]
buffer_load_dwordx4 v[80:83], v1, s[4:7], s34 offen offset:1024
v_mfma_f32_16x16x32_bf16 a[80:83], a[220:223], v[200:203], a[80:83]
v_mfma_f32_16x16x32_bf16 a[84:87], a[220:223], v[204:207], a[84:87]
v_mfma_f32_16x16x32_bf16 a[88:91], a[220:223], v[208:211], a[88:91]
v_mfma_f32_16x16x32_bf16 a[92:95], a[220:223], v[212:215], a[92:95]
buffer_load_dwordx4 v[84:87], v1, s[4:7], s35 offen offset:1024
v_mfma_f32_16x16x32_bf16 a[96:99], a[224:227], v[200:203], a[96:99]
v_mfma_f32_16x16x32_bf16 a[100:103], a[224:227], v[204:207], a[100:103]
v_mfma_f32_16x16x32_bf16 a[104:107], a[224:227], v[208:211], a[104:107]
v_mfma_f32_16x16x32_bf16 a[108:111], a[224:227], v[212:215], a[108:111]
buffer_load_dwordx4 v[88:91], v1, s[4:7], s36 offen offset:1024
v_mfma_f32_16x16x32_bf16 a[112:115], a[228:231], v[200:203], a[112:115]
v_mfma_f32_16x16x32_bf16 a[116:119], a[228:231], v[204:207], a[116:119]
v_mfma_f32_16x16x32_bf16 a[120:123], a[228:231], v[208:211], a[120:123]
v_mfma_f32_16x16x32_bf16 a[124:127], a[228:231], v[212:215], a[124:127]
buffer_load_dwordx4 v[92:95], v1, s[4:7], s37 offen offset:1024
v_mfma_f32_16x16x32_bf16 a[128:131], a[232:235], v[200:203], a[128:131]
v_mfma_f32_16x16x32_bf16 a[132:135], a[232:235], v[204:207], a[132:135]
v_mfma_f32_16x16x32_bf16 a[136:139], a[232:235], v[208:211], a[136:139]
v_mfma_f32_16x16x32_bf16 a[140:143], a[232:235], v[212:215], a[140:143]
buffer_load_dwordx4 v[96:99], v1, s[4:7], s38 offen offset:1024
v_mfma_f32_16x16x32_bf16 a[144:147], a[236:239], v[200:203], a[144:147]
v_mfma_f32_16x16x32_bf16 a[148:151], a[236:239], v[204:207], a[148:151]
v_mfma_f32_16x16x32_bf16 a[152:155], a[236:239], v[208:211], a[152:155]
v_mfma_f32_16x16x32_bf16 a[156:159], a[236:239], v[212:215], a[156:159]
buffer_load_dwordx4 v[100:103], v1, s[4:7], s39 offen offset:1024
s_waitcnt vmcnt(42)
s_waitcnt lgkmcnt(0)
v_mfma_f32_16x16x32_bf16 a[0:3], v[104:107], v[184:187], a[0:3]
v_mfma_f32_16x16x32_bf16 a[4:7], v[104:107], v[188:191], a[4:7]
v_mfma_f32_16x16x32_bf16 a[8:11], v[104:107], v[192:195], a[8:11]
v_mfma_f32_16x16x32_bf16 a[12:15], v[104:107], v[196:199], a[12:15]
ds_read_b128 v[200:203], v1 offset:3072
buffer_load_dwordx4 v[104:107], v1, s[4:7], s30 offen offset:2048
v_mfma_f32_16x16x32_bf16 a[16:19], v[108:111], v[184:187], a[16:19]
v_mfma_f32_16x16x32_bf16 a[20:23], v[108:111], v[188:191], a[20:23]
v_mfma_f32_16x16x32_bf16 a[24:27], v[108:111], v[192:195], a[24:27]
v_mfma_f32_16x16x32_bf16 a[28:31], v[108:111], v[196:199], a[28:31]
ds_read_b128 v[204:207], v1 offset:27648
buffer_load_dwordx4 v[108:111], v1, s[4:7], s31 offen offset:2048
v_mfma_f32_16x16x32_bf16 a[32:35], v[112:115], v[184:187], a[32:35]
v_mfma_f32_16x16x32_bf16 a[36:39], v[112:115], v[188:191], a[36:39]
v_mfma_f32_16x16x32_bf16 a[40:43], v[112:115], v[192:195], a[40:43]
v_mfma_f32_16x16x32_bf16 a[44:47], v[112:115], v[196:199], a[44:47]
ds_read_b128 v[208:211], v6 offset:3072
buffer_load_dwordx4 v[112:115], v1, s[4:7], s32 offen offset:2048
v_mfma_f32_16x16x32_bf16 a[48:51], v[116:119], v[184:187], a[48:51]
v_mfma_f32_16x16x32_bf16 a[52:55], v[116:119], v[188:191], a[52:55]
v_mfma_f32_16x16x32_bf16 a[56:59], v[116:119], v[192:195], a[56:59]
v_mfma_f32_16x16x32_bf16 a[60:63], v[116:119], v[196:199], a[60:63]
ds_read_b128 v[212:215], v6 offset:27648
buffer_load_dwordx4 v[116:119], v1, s[4:7], s33 offen offset:2048
v_mfma_f32_16x16x32_bf16 a[64:67], v[120:123], v[184:187], a[64:67]
v_mfma_f32_16x16x32_bf16 a[68:71], v[120:123], v[188:191], a[68:71]
v_mfma_f32_16x16x32_bf16 a[72:75], v[120:123], v[192:195], a[72:75]
v_mfma_f32_16x16x32_bf16 a[76:79], v[120:123], v[196:199], a[76:79]
buffer_load_dwordx4 v[120:123], v1, s[4:7], s34 offen offset:2048
v_mfma_f32_16x16x32_bf16 a[80:83], v[124:127], v[184:187], a[80:83]
v_mfma_f32_16x16x32_bf16 a[84:87], v[124:127], v[188:191], a[84:87]
v_mfma_f32_16x16x32_bf16 a[88:91], v[124:127], v[192:195], a[88:91]
v_mfma_f32_16x16x32_bf16 a[92:95], v[124:127], v[196:199], a[92:95]
buffer_load_dwordx4 v[124:127], v1, s[4:7], s35 offen offset:2048
v_mfma_f32_16x16x32_bf16 a[96:99], v[128:131], v[184:187], a[96:99]
v_mfma_f32_16x16x32_bf16 a[100:103], v[128:131], v[188:191], a[100:103]
v_mfma_f32_16x16x32_bf16 a[104:107], v[128:131], v[192:195], a[104:107]
v_mfma_f32_16x16x32_bf16 a[108:111], v[128:131], v[196:199], a[108:111]
buffer_load_dwordx4 v[128:131], v1, s[4:7], s36 offen offset:2048
v_mfma_f32_16x16x32_bf16 a[112:115], v[132:135], v[184:187], a[112:115]
v_mfma_f32_16x16x32_bf16 a[116:119], v[132:135], v[188:191], a[116:119]
v_mfma_f32_16x16x32_bf16 a[120:123], v[132:135], v[192:195], a[120:123]
v_mfma_f32_16x16x32_bf16 a[124:127], v[132:135], v[196:199], a[124:127]
buffer_load_dwordx4 v[132:135], v1, s[4:7], s37 offen offset:2048
v_mfma_f32_16x16x32_bf16 a[128:131], v[136:139], v[184:187], a[128:131]
v_mfma_f32_16x16x32_bf16 a[132:135], v[136:139], v[188:191], a[132:135]
v_mfma_f32_16x16x32_bf16 a[136:139], v[136:139], v[192:195], a[136:139]
v_mfma_f32_16x16x32_bf16 a[140:143], v[136:139], v[196:199], a[140:143]
buffer_load_dwordx4 v[136:139], v1, s[4:7], s38 offen offset:2048
v_mfma_f32_16x16x32_bf16 a[144:147], v[140:143], v[184:187], a[144:147]
v_mfma_f32_16x16x32_bf16 a[148:151], v[140:143], v[188:191], a[148:151]
v_mfma_f32_16x16x32_bf16 a[152:155], v[140:143], v[192:195], a[152:155]
v_mfma_f32_16x16x32_bf16 a[156:159], v[140:143], v[196:199], a[156:159]
buffer_load_dwordx4 v[140:143], v1, s[4:7], s39 offen offset:2048
s_waitcnt vmcnt(36)
s_waitcnt lgkmcnt(0)
v_mfma_f32_16x16x32_bf16 a[0:3], v[144:147], v[200:203], a[0:3]
v_mfma_f32_16x16x32_bf16 a[4:7], v[144:147], v[204:207], a[4:7]
v_mfma_f32_16x16x32_bf16 a[8:11], v[144:147], v[208:211], a[8:11]
v_mfma_f32_16x16x32_bf16 a[12:15], v[144:147], v[212:215], a[12:15]
ds_read_b128 v[184:187], v1 offset:4096
buffer_load_dwordx4 v[144:147], v1, s[4:7], s30 offen offset:3072
s_add_u32 s30, s30, 4096
v_mfma_f32_16x16x32_bf16 a[16:19], v[148:151], v[200:203], a[16:19]
v_mfma_f32_16x16x32_bf16 a[20:23], v[148:151], v[204:207], a[20:23]
v_mfma_f32_16x16x32_bf16 a[24:27], v[148:151], v[208:211], a[24:27]
v_mfma_f32_16x16x32_bf16 a[28:31], v[148:151], v[212:215], a[28:31]
ds_read_b128 v[188:191], v1 offset:28672
buffer_load_dwordx4 v[148:151], v1, s[4:7], s31 offen offset:3072
s_add_u32 s31, s31, 4096
v_mfma_f32_16x16x32_bf16 a[32:35], v[152:155], v[200:203], a[32:35]
v_mfma_f32_16x16x32_bf16 a[36:39], v[152:155], v[204:207], a[36:39]
v_mfma_f32_16x16x32_bf16 a[40:43], v[152:155], v[208:211], a[40:43]
v_mfma_f32_16x16x32_bf16 a[44:47], v[152:155], v[212:215], a[44:47]
ds_read_b128 v[192:195], v6 offset:4096
buffer_load_dwordx4 v[152:155], v1, s[4:7], s32 offen offset:3072
s_add_u32 s32, s32, 4096
v_mfma_f32_16x16x32_bf16 a[48:51], v[156:159], v[200:203], a[48:51]
v_mfma_f32_16x16x32_bf16 a[52:55], v[156:159], v[204:207], a[52:55]
v_mfma_f32_16x16x32_bf16 a[56:59], v[156:159], v[208:211], a[56:59]
v_mfma_f32_16x16x32_bf16 a[60:63], v[156:159], v[212:215], a[60:63]
ds_read_b128 v[196:199], v6 offset:28672
buffer_load_dwordx4 v[156:159], v1, s[4:7], s33 offen offset:3072
s_add_u32 s33, s33, 4096
v_mfma_f32_16x16x32_bf16 a[64:67], v[160:163], v[200:203], a[64:67]
v_mfma_f32_16x16x32_bf16 a[68:71], v[160:163], v[204:207], a[68:71]
v_mfma_f32_16x16x32_bf16 a[72:75], v[160:163], v[208:211], a[72:75]
v_mfma_f32_16x16x32_bf16 a[76:79], v[160:163], v[212:215], a[76:79]
buffer_load_dwordx4 v[160:163], v1, s[4:7], s34 offen offset:3072
s_add_u32 s34, s34, 4096
v_mfma_f32_16x16x32_bf16 a[80:83], v[164:167], v[200:203], a[80:83]
v_mfma_f32_16x16x32_bf16 a[84:87], v[164:167], v[204:207], a[84:87]
v_mfma_f32_16x16x32_bf16 a[88:91], v[164:167], v[208:211], a[88:91]
v_mfma_f32_16x16x32_bf16 a[92:95], v[164:167], v[212:215], a[92:95]
buffer_load_dwordx4 v[164:167], v1, s[4:7], s35 offen offset:3072
s_add_u32 s35, s35, 4096
v_mfma_f32_16x16x32_bf16 a[96:99], v[168:171], v[200:203], a[96:99]
v_mfma_f32_16x16x32_bf16 a[100:103], v[168:171], v[204:207], a[100:103]
v_mfma_f32_16x16x32_bf16 a[104:107], v[168:171], v[208:211], a[104:107]
v_mfma_f32_16x16x32_bf16 a[108:111], v[168:171], v[212:215], a[108:111]
buffer_load_dwordx4 v[168:171], v1, s[4:7], s36 offen offset:3072
s_add_u32 s36, s36, 4096
v_mfma_f32_16x16x32_bf16 a[112:115], v[172:175], v[200:203], a[112:115]
v_mfma_f32_16x16x32_bf16 a[116:119], v[172:175], v[204:207], a[116:119]
v_mfma_f32_16x16x32_bf16 a[120:123], v[172:175], v[208:211], a[120:123]
v_mfma_f32_16x16x32_bf16 a[124:127], v[172:175], v[212:215], a[124:127]
buffer_load_dwordx4 v[172:175], v1, s[4:7], s37 offen offset:3072
s_add_u32 s37, s37, 4096
v_mfma_f32_16x16x32_bf16 a[128:131], v[176:179], v[200:203], a[128:131]
v_mfma_f32_16x16x32_bf16 a[132:135], v[176:179], v[204:207], a[132:135]
v_mfma_f32_16x16x32_bf16 a[136:139], v[176:179], v[208:211], a[136:139]
v_mfma_f32_16x16x32_bf16 a[140:143], v[176:179], v[212:215], a[140:143]
buffer_load_dwordx4 v[176:179], v1, s[4:7], s38 offen offset:3072
s_add_u32 s38, s38, 4096
v_mfma_f32_16x16x32_bf16 a[144:147], v[180:183], v[200:203], a[144:147]
v_mfma_f32_16x16x32_bf16 a[148:151], v[180:183], v[204:207], a[148:151]
v_mfma_f32_16x16x32_bf16 a[152:155], v[180:183], v[208:211], a[152:155]
v_mfma_f32_16x16x32_bf16 a[156:159], v[180:183], v[212:215], a[156:159]
buffer_load_dwordx4 v[180:183], v1, s[4:7], s39 offen offset:3072
s_add_u32 s39, s39, 4096
s_waitcnt vmcnt(36)
s_waitcnt lgkmcnt(0)
v_mfma_f32_16x16x32_bf16 a[0:3], v[24:27], v[184:187], a[0:3]
v_mfma_f32_16x16x32_bf16 a[4:7], v[24:27], v[188:191], a[4:7]
v_mfma_f32_16x16x32_bf16 a[8:11], v[24:27], v[192:195], a[8:11]
v_mfma_f32_16x16x32_bf16 a[12:15], v[24:27], v[196:199], a[12:15]
ds_read_b128 v[200:203], v1 offset:5120
buffer_load_dwordx4 v[24:27], v1, s[4:7], s30 offen offset:0
v_mfma_f32_16x16x32_bf16 a[16:19], v[28:31], v[184:187], a[16:19]
v_mfma_f32_16x16x32_bf16 a[20:23], v[28:31], v[188:191], a[20:23]
v_mfma_f32_16x16x32_bf16 a[24:27], v[28:31], v[192:195], a[24:27]
v_mfma_f32_16x16x32_bf16 a[28:31], v[28:31], v[196:199], a[28:31]
ds_read_b128 v[204:207], v1 offset:29696
buffer_load_dwordx4 v[28:31], v1, s[4:7], s31 offen offset:0
v_mfma_f32_16x16x32_bf16 a[32:35], v[32:35], v[184:187], a[32:35]
v_mfma_f32_16x16x32_bf16 a[36:39], v[32:35], v[188:191], a[36:39]
v_mfma_f32_16x16x32_bf16 a[40:43], v[32:35], v[192:195], a[40:43]
v_mfma_f32_16x16x32_bf16 a[44:47], v[32:35], v[196:199], a[44:47]
ds_read_b128 v[208:211], v6 offset:5120
buffer_load_dwordx4 v[32:35], v1, s[4:7], s32 offen offset:0
v_mfma_f32_16x16x32_bf16 a[48:51], v[36:39], v[184:187], a[48:51]
v_mfma_f32_16x16x32_bf16 a[52:55], v[36:39], v[188:191], a[52:55]
v_mfma_f32_16x16x32_bf16 a[56:59], v[36:39], v[192:195], a[56:59]
v_mfma_f32_16x16x32_bf16 a[60:63], v[36:39], v[196:199], a[60:63]
ds_read_b128 v[212:215], v6 offset:29696
buffer_load_dwordx4 v[36:39], v1, s[4:7], s33 offen offset:0
v_mfma_f32_16x16x32_bf16 a[64:67], v[40:43], v[184:187], a[64:67]
v_mfma_f32_16x16x32_bf16 a[68:71], v[40:43], v[188:191], a[68:71]
v_mfma_f32_16x16x32_bf16 a[72:75], v[40:43], v[192:195], a[72:75]
v_mfma_f32_16x16x32_bf16 a[76:79], v[40:43], v[196:199], a[76:79]
buffer_load_dwordx4 v[40:43], v1, s[4:7], s34 offen offset:0
v_mfma_f32_16x16x32_bf16 a[80:83], v[44:47], v[184:187], a[80:83]
v_mfma_f32_16x16x32_bf16 a[84:87], v[44:47], v[188:191], a[84:87]
v_mfma_f32_16x16x32_bf16 a[88:91], v[44:47], v[192:195], a[88:91]
v_mfma_f32_16x16x32_bf16 a[92:95], v[44:47], v[196:199], a[92:95]
buffer_load_dwordx4 v[44:47], v1, s[4:7], s35 offen offset:0
v_mfma_f32_16x16x32_bf16 a[96:99], v[48:51], v[184:187], a[96:99]
v_mfma_f32_16x16x32_bf16 a[100:103], v[48:51], v[188:191], a[100:103]
v_mfma_f32_16x16x32_bf16 a[104:107], v[48:51], v[192:195], a[104:107]
v_mfma_f32_16x16x32_bf16 a[108:111], v[48:51], v[196:199], a[108:111]
buffer_load_dwordx4 v[48:51], v1, s[4:7], s36 offen offset:0
v_mfma_f32_16x16x32_bf16 a[112:115], v[52:55], v[184:187], a[112:115]
v_mfma_f32_16x16x32_bf16 a[116:119], v[52:55], v[188:191], a[116:119]
v_mfma_f32_16x16x32_bf16 a[120:123], v[52:55], v[192:195], a[120:123]
v_mfma_f32_16x16x32_bf16 a[124:127], v[52:55], v[196:199], a[124:127]
buffer_load_dwordx4 v[52:55], v1, s[4:7], s37 offen offset:0
v_mfma_f32_16x16x32_bf16 a[128:131], v[56:59], v[184:187], a[128:131]
v_mfma_f32_16x16x32_bf16 a[132:135], v[56:59], v[188:191], a[132:135]
v_mfma_f32_16x16x32_bf16 a[136:139], v[56:59], v[192:195], a[136:139]
v_mfma_f32_16x16x32_bf16 a[140:143], v[56:59], v[196:199], a[140:143]
buffer_load_dwordx4 v[56:59], v1, s[4:7], s38 offen offset:0
v_mfma_f32_16x16x32_bf16 a[144:147], v[60:63], v[184:187], a[144:147]
v_mfma_f32_16x16x32_bf16 a[148:151], v[60:63], v[188:191], a[148:151]
v_mfma_f32_16x16x32_bf16 a[152:155], v[60:63], v[192:195], a[152:155]
v_mfma_f32_16x16x32_bf16 a[156:159], v[60:63], v[196:199], a[156:159]
buffer_load_dwordx4 v[60:63], v1, s[4:7], s39 offen offset:0
s_barrier
s_waitcnt vmcnt(30)
s_waitcnt lgkmcnt(0)
v_mfma_f32_16x16x32_bf16 a[0:3], v[64:67], v[200:203], a[0:3]
v_mfma_f32_16x16x32_bf16 a[4:7], v[64:67], v[204:207], a[4:7]
v_mfma_f32_16x16x32_bf16 a[8:11], v[64:67], v[208:211], a[8:11]
v_mfma_f32_16x16x32_bf16 a[12:15], v[64:67], v[212:215], a[12:15]
ds_read_b128 v[184:187], v1 offset:6144
buffer_load_dwordx4 v[64:67], v1, s[4:7], s30 offen offset:1024
v_mfma_f32_16x16x32_bf16 a[16:19], v[68:71], v[200:203], a[16:19]
v_mfma_f32_16x16x32_bf16 a[20:23], v[68:71], v[204:207], a[20:23]
v_mfma_f32_16x16x32_bf16 a[24:27], v[68:71], v[208:211], a[24:27]
v_mfma_f32_16x16x32_bf16 a[28:31], v[68:71], v[212:215], a[28:31]
ds_read_b128 v[188:191], v1 offset:30720
buffer_load_dwordx4 v[68:71], v1, s[4:7], s31 offen offset:1024
v_mfma_f32_16x16x32_bf16 a[32:35], v[72:75], v[200:203], a[32:35]
v_mfma_f32_16x16x32_bf16 a[36:39], v[72:75], v[204:207], a[36:39]
v_mfma_f32_16x16x32_bf16 a[40:43], v[72:75], v[208:211], a[40:43]
v_mfma_f32_16x16x32_bf16 a[44:47], v[72:75], v[212:215], a[44:47]
ds_read_b128 v[192:195], v6 offset:6144
buffer_load_dwordx4 v[72:75], v1, s[4:7], s32 offen offset:1024
v_mfma_f32_16x16x32_bf16 a[48:51], v[76:79], v[200:203], a[48:51]
v_mfma_f32_16x16x32_bf16 a[52:55], v[76:79], v[204:207], a[52:55]
v_mfma_f32_16x16x32_bf16 a[56:59], v[76:79], v[208:211], a[56:59]
v_mfma_f32_16x16x32_bf16 a[60:63], v[76:79], v[212:215], a[60:63]
ds_read_b128 v[196:199], v6 offset:30720
buffer_load_dwordx4 v[76:79], v1, s[4:7], s33 offen offset:1024
v_mfma_f32_16x16x32_bf16 a[64:67], v[80:83], v[200:203], a[64:67]
v_mfma_f32_16x16x32_bf16 a[68:71], v[80:83], v[204:207], a[68:71]
v_mfma_f32_16x16x32_bf16 a[72:75], v[80:83], v[208:211], a[72:75]
v_mfma_f32_16x16x32_bf16 a[76:79], v[80:83], v[212:215], a[76:79]
buffer_load_dwordx4 v[80:83], v1, s[4:7], s34 offen offset:1024
v_mfma_f32_16x16x32_bf16 a[80:83], v[84:87], v[200:203], a[80:83]
v_mfma_f32_16x16x32_bf16 a[84:87], v[84:87], v[204:207], a[84:87]
v_mfma_f32_16x16x32_bf16 a[88:91], v[84:87], v[208:211], a[88:91]
v_mfma_f32_16x16x32_bf16 a[92:95], v[84:87], v[212:215], a[92:95]
buffer_load_dwordx4 v[84:87], v1, s[4:7], s35 offen offset:1024
v_mfma_f32_16x16x32_bf16 a[96:99], v[88:91], v[200:203], a[96:99]
v_mfma_f32_16x16x32_bf16 a[100:103], v[88:91], v[204:207], a[100:103]
v_mfma_f32_16x16x32_bf16 a[104:107], v[88:91], v[208:211], a[104:107]
v_mfma_f32_16x16x32_bf16 a[108:111], v[88:91], v[212:215], a[108:111]
buffer_load_dwordx4 v[88:91], v1, s[4:7], s36 offen offset:1024
v_mfma_f32_16x16x32_bf16 a[112:115], v[92:95], v[200:203], a[112:115]
v_mfma_f32_16x16x32_bf16 a[116:119], v[92:95], v[204:207], a[116:119]
v_mfma_f32_16x16x32_bf16 a[120:123], v[92:95], v[208:211], a[120:123]
v_mfma_f32_16x16x32_bf16 a[124:127], v[92:95], v[212:215], a[124:127]
buffer_load_dwordx4 v[92:95], v1, s[4:7], s37 offen offset:1024
v_mfma_f32_16x16x32_bf16 a[128:131], v[96:99], v[200:203], a[128:131]
v_mfma_f32_16x16x32_bf16 a[132:135], v[96:99], v[204:207], a[132:135]
v_mfma_f32_16x16x32_bf16 a[136:139], v[96:99], v[208:211], a[136:139]
v_mfma_f32_16x16x32_bf16 a[140:143], v[96:99], v[212:215], a[140:143]
buffer_load_dwordx4 v[96:99], v1, s[4:7], s38 offen offset:1024
v_mfma_f32_16x16x32_bf16 a[144:147], v[100:103], v[200:203], a[144:147]
v_mfma_f32_16x16x32_bf16 a[148:151], v[100:103], v[204:207], a[148:151]
v_mfma_f32_16x16x32_bf16 a[152:155], v[100:103], v[208:211], a[152:155]
v_mfma_f32_16x16x32_bf16 a[156:159], v[100:103], v[212:215], a[156:159]
buffer_load_dwordx4 v[100:103], v1, s[4:7], s39 offen offset:1024
s_waitcnt vmcnt(30)
s_waitcnt lgkmcnt(0)
v_mfma_f32_16x16x32_bf16 a[0:3], v[104:107], v[184:187], a[0:3]
v_mfma_f32_16x16x32_bf16 a[4:7], v[104:107], v[188:191], a[4:7]
v_mfma_f32_16x16x32_bf16 a[8:11], v[104:107], v[192:195], a[8:11]
v_mfma_f32_16x16x32_bf16 a[12:15], v[104:107], v[196:199], a[12:15]
ds_read_b128 v[200:203], v1 offset:7168
buffer_load_dwordx4 v[104:107], v1, s[4:7], s30 offen offset:2048
v_mfma_f32_16x16x32_bf16 a[16:19], v[108:111], v[184:187], a[16:19]
v_mfma_f32_16x16x32_bf16 a[20:23], v[108:111], v[188:191], a[20:23]
v_mfma_f32_16x16x32_bf16 a[24:27], v[108:111], v[192:195], a[24:27]
v_mfma_f32_16x16x32_bf16 a[28:31], v[108:111], v[196:199], a[28:31]
ds_read_b128 v[204:207], v1 offset:31744
buffer_load_dwordx4 v[108:111], v1, s[4:7], s31 offen offset:2048
v_mfma_f32_16x16x32_bf16 a[32:35], v[112:115], v[184:187], a[32:35]
v_mfma_f32_16x16x32_bf16 a[36:39], v[112:115], v[188:191], a[36:39]
v_mfma_f32_16x16x32_bf16 a[40:43], v[112:115], v[192:195], a[40:43]
v_mfma_f32_16x16x32_bf16 a[44:47], v[112:115], v[196:199], a[44:47]
ds_read_b128 v[208:211], v6 offset:7168
buffer_load_dwordx4 v[112:115], v1, s[4:7], s32 offen offset:2048
v_mfma_f32_16x16x32_bf16 a[48:51], v[116:119], v[184:187], a[48:51]
v_mfma_f32_16x16x32_bf16 a[52:55], v[116:119], v[188:191], a[52:55]
v_mfma_f32_16x16x32_bf16 a[56:59], v[116:119], v[192:195], a[56:59]
v_mfma_f32_16x16x32_bf16 a[60:63], v[116:119], v[196:199], a[60:63]
ds_read_b128 v[212:215], v6 offset:31744
buffer_load_dwordx4 v[116:119], v1, s[4:7], s33 offen offset:2048
v_mfma_f32_16x16x32_bf16 a[64:67], v[120:123], v[184:187], a[64:67]
v_mfma_f32_16x16x32_bf16 a[68:71], v[120:123], v[188:191], a[68:71]
v_mfma_f32_16x16x32_bf16 a[72:75], v[120:123], v[192:195], a[72:75]
v_mfma_f32_16x16x32_bf16 a[76:79], v[120:123], v[196:199], a[76:79]
buffer_load_dwordx4 v[120:123], v1, s[4:7], s34 offen offset:2048
v_mfma_f32_16x16x32_bf16 a[80:83], v[124:127], v[184:187], a[80:83]
v_mfma_f32_16x16x32_bf16 a[84:87], v[124:127], v[188:191], a[84:87]
v_mfma_f32_16x16x32_bf16 a[88:91], v[124:127], v[192:195], a[88:91]
v_mfma_f32_16x16x32_bf16 a[92:95], v[124:127], v[196:199], a[92:95]
buffer_load_dwordx4 v[124:127], v1, s[4:7], s35 offen offset:2048
v_mfma_f32_16x16x32_bf16 a[96:99], v[128:131], v[184:187], a[96:99]
v_mfma_f32_16x16x32_bf16 a[100:103], v[128:131], v[188:191], a[100:103]
v_mfma_f32_16x16x32_bf16 a[104:107], v[128:131], v[192:195], a[104:107]
v_mfma_f32_16x16x32_bf16 a[108:111], v[128:131], v[196:199], a[108:111]
buffer_load_dwordx4 v[128:131], v1, s[4:7], s36 offen offset:2048
v_mfma_f32_16x16x32_bf16 a[112:115], v[132:135], v[184:187], a[112:115]
v_mfma_f32_16x16x32_bf16 a[116:119], v[132:135], v[188:191], a[116:119]
v_mfma_f32_16x16x32_bf16 a[120:123], v[132:135], v[192:195], a[120:123]
v_mfma_f32_16x16x32_bf16 a[124:127], v[132:135], v[196:199], a[124:127]
buffer_load_dwordx4 v[132:135], v1, s[4:7], s37 offen offset:2048
v_mfma_f32_16x16x32_bf16 a[128:131], v[136:139], v[184:187], a[128:131]
v_mfma_f32_16x16x32_bf16 a[132:135], v[136:139], v[188:191], a[132:135]
v_mfma_f32_16x16x32_bf16 a[136:139], v[136:139], v[192:195], a[136:139]
v_mfma_f32_16x16x32_bf16 a[140:143], v[136:139], v[196:199], a[140:143]
buffer_load_dwordx4 v[136:139], v1, s[4:7], s38 offen offset:2048
v_mfma_f32_16x16x32_bf16 a[144:147], v[140:143], v[184:187], a[144:147]
v_mfma_f32_16x16x32_bf16 a[148:151], v[140:143], v[188:191], a[148:151]
v_mfma_f32_16x16x32_bf16 a[152:155], v[140:143], v[192:195], a[152:155]
v_mfma_f32_16x16x32_bf16 a[156:159], v[140:143], v[196:199], a[156:159]
buffer_load_dwordx4 v[140:143], v1, s[4:7], s39 offen offset:2048
s_waitcnt vmcnt(30)
s_waitcnt lgkmcnt(0)
v_mfma_f32_16x16x32_bf16 a[0:3], v[144:147], v[200:203], a[0:3]
v_mfma_f32_16x16x32_bf16 a[4:7], v[144:147], v[204:207], a[4:7]
v_mfma_f32_16x16x32_bf16 a[8:11], v[144:147], v[208:211], a[8:11]
v_mfma_f32_16x16x32_bf16 a[12:15], v[144:147], v[212:215], a[12:15]
ds_read_b128 v[184:187], v1 offset:8192
buffer_load_dwordx4 v[144:147], v1, s[4:7], s30 offen offset:3072
s_add_u32 s30, s30, 4096
v_mfma_f32_16x16x32_bf16 a[16:19], v[148:151], v[200:203], a[16:19]
v_mfma_f32_16x16x32_bf16 a[20:23], v[148:151], v[204:207], a[20:23]
v_mfma_f32_16x16x32_bf16 a[24:27], v[148:151], v[208:211], a[24:27]
v_mfma_f32_16x16x32_bf16 a[28:31], v[148:151], v[212:215], a[28:31]
ds_read_b128 v[188:191], v1 offset:32768
buffer_load_dwordx4 v[148:151], v1, s[4:7], s31 offen offset:3072
s_add_u32 s31, s31, 4096
v_mfma_f32_16x16x32_bf16 a[32:35], v[152:155], v[200:203], a[32:35]
v_mfma_f32_16x16x32_bf16 a[36:39], v[152:155], v[204:207], a[36:39]
v_mfma_f32_16x16x32_bf16 a[40:43], v[152:155], v[208:211], a[40:43]
v_mfma_f32_16x16x32_bf16 a[44:47], v[152:155], v[212:215], a[44:47]
ds_read_b128 v[192:195], v6 offset:8192
buffer_load_dwordx4 v[152:155], v1, s[4:7], s32 offen offset:3072
s_add_u32 s32, s32, 4096
v_mfma_f32_16x16x32_bf16 a[48:51], v[156:159], v[200:203], a[48:51]
v_mfma_f32_16x16x32_bf16 a[52:55], v[156:159], v[204:207], a[52:55]
v_mfma_f32_16x16x32_bf16 a[56:59], v[156:159], v[208:211], a[56:59]
v_mfma_f32_16x16x32_bf16 a[60:63], v[156:159], v[212:215], a[60:63]
ds_read_b128 v[196:199], v6 offset:32768
buffer_load_dwordx4 v[156:159], v1, s[4:7], s33 offen offset:3072
s_add_u32 s33, s33, 4096
v_mfma_f32_16x16x32_bf16 a[64:67], v[160:163], v[200:203], a[64:67]
v_mfma_f32_16x16x32_bf16 a[68:71], v[160:163], v[204:207], a[68:71]
v_mfma_f32_16x16x32_bf16 a[72:75], v[160:163], v[208:211], a[72:75]
v_mfma_f32_16x16x32_bf16 a[76:79], v[160:163], v[212:215], a[76:79]
buffer_load_dwordx4 v[160:163], v1, s[4:7], s34 offen offset:3072
s_add_u32 s34, s34, 4096
v_mfma_f32_16x16x32_bf16 a[80:83], v[164:167], v[200:203], a[80:83]
v_mfma_f32_16x16x32_bf16 a[84:87], v[164:167], v[204:207], a[84:87]
v_mfma_f32_16x16x32_bf16 a[88:91], v[164:167], v[208:211], a[88:91]
v_mfma_f32_16x16x32_bf16 a[92:95], v[164:167], v[212:215], a[92:95]
buffer_load_dwordx4 v[164:167], v1, s[4:7], s35 offen offset:3072
s_add_u32 s35, s35, 4096
v_mfma_f32_16x16x32_bf16 a[96:99], v[168:171], v[200:203], a[96:99]
v_mfma_f32_16x16x32_bf16 a[100:103], v[168:171], v[204:207], a[100:103]
v_mfma_f32_16x16x32_bf16 a[104:107], v[168:171], v[208:211], a[104:107]
v_mfma_f32_16x16x32_bf16 a[108:111], v[168:171], v[212:215], a[108:111]
buffer_load_dwordx4 v[168:171], v1, s[4:7], s36 offen offset:3072
s_add_u32 s36, s36, 4096
v_mfma_f32_16x16x32_bf16 a[112:115], v[172:175], v[200:203], a[112:115]
v_mfma_f32_16x16x32_bf16 a[116:119], v[172:175], v[204:207], a[116:119]
v_mfma_f32_16x16x32_bf16 a[120:123], v[172:175], v[208:211], a[120:123]
v_mfma_f32_16x16x32_bf16 a[124:127], v[172:175], v[212:215], a[124:127]
buffer_load_dwordx4 v[172:175], v1, s[4:7], s37 offen offset:3072
s_add_u32 s37, s37, 4096
v_mfma_f32_16x16x32_bf16 a[128:131], v[176:179], v[200:203], a[128:131]
v_mfma_f32_16x16x32_bf16 a[132:135], v[176:179], v[204:207], a[132:135]
v_mfma_f32_16x16x32_bf16 a[136:139], v[176:179], v[208:211], a[136:139]
v_mfma_f32_16x16x32_bf16 a[140:143], v[176:179], v[212:215], a[140:143]
buffer_load_dwordx4 v[176:179], v1, s[4:7], s38 offen offset:3072
s_add_u32 s38, s38, 4096
v_mfma_f32_16x16x32_bf16 a[144:147], v[180:183], v[200:203], a[144:147]
v_mfma_f32_16x16x32_bf16 a[148:151], v[180:183], v[204:207], a[148:151]
v_mfma_f32_16x16x32_bf16 a[152:155], v[180:183], v[208:211], a[152:155]
v_mfma_f32_16x16x32_bf16 a[156:159], v[180:183], v[212:215], a[156:159]
buffer_load_dwordx4 v[180:183], v1, s[4:7], s39 offen offset:3072
s_add_u32 s39, s39, 4096
s_waitcnt vmcnt(30)
s_waitcnt lgkmcnt(0)
v_mfma_f32_16x16x32_bf16 a[0:3], v[24:27], v[184:187], a[0:3]
v_mfma_f32_16x16x32_bf16 a[4:7], v[24:27], v[188:191], a[4:7]
v_mfma_f32_16x16x32_bf16 a[8:11], v[24:27], v[192:195], a[8:11]
v_mfma_f32_16x16x32_bf16 a[12:15], v[24:27], v[196:199], a[12:15]
ds_read_b128 v[200:203], v1 offset:9216
buffer_load_dwordx4 v[24:27], v1, s[4:7], s30 offen offset:0
v_mfma_f32_16x16x32_bf16 a[16:19], v[28:31], v[184:187], a[16:19]
v_mfma_f32_16x16x32_bf16 a[20:23], v[28:31], v[188:191], a[20:23]
v_mfma_f32_16x16x32_bf16 a[24:27], v[28:31], v[192:195], a[24:27]
v_mfma_f32_16x16x32_bf16 a[28:31], v[28:31], v[196:199], a[28:31]
ds_read_b128 v[204:207], v1 offset:33792
buffer_load_dwordx4 v[28:31], v1, s[4:7], s31 offen offset:0
v_mfma_f32_16x16x32_bf16 a[32:35], v[32:35], v[184:187], a[32:35]
v_mfma_f32_16x16x32_bf16 a[36:39], v[32:35], v[188:191], a[36:39]
v_mfma_f32_16x16x32_bf16 a[40:43], v[32:35], v[192:195], a[40:43]
v_mfma_f32_16x16x32_bf16 a[44:47], v[32:35], v[196:199], a[44:47]
ds_read_b128 v[208:211], v6 offset:9216
buffer_load_dwordx4 v[32:35], v1, s[4:7], s32 offen offset:0
v_mfma_f32_16x16x32_bf16 a[48:51], v[36:39], v[184:187], a[48:51]
v_mfma_f32_16x16x32_bf16 a[52:55], v[36:39], v[188:191], a[52:55]
v_mfma_f32_16x16x32_bf16 a[56:59], v[36:39], v[192:195], a[56:59]
v_mfma_f32_16x16x32_bf16 a[60:63], v[36:39], v[196:199], a[60:63]
ds_read_b128 v[212:215], v6 offset:33792
buffer_load_dwordx4 v[36:39], v1, s[4:7], s33 offen offset:0
v_mfma_f32_16x16x32_bf16 a[64:67], v[40:43], v[184:187], a[64:67]
v_mfma_f32_16x16x32_bf16 a[68:71], v[40:43], v[188:191], a[68:71]
v_mfma_f32_16x16x32_bf16 a[72:75], v[40:43], v[192:195], a[72:75]
v_mfma_f32_16x16x32_bf16 a[76:79], v[40:43], v[196:199], a[76:79]
buffer_load_dwordx4 v[40:43], v1, s[4:7], s34 offen offset:0
v_mfma_f32_16x16x32_bf16 a[80:83], v[44:47], v[184:187], a[80:83]
v_mfma_f32_16x16x32_bf16 a[84:87], v[44:47], v[188:191], a[84:87]
v_mfma_f32_16x16x32_bf16 a[88:91], v[44:47], v[192:195], a[88:91]
v_mfma_f32_16x16x32_bf16 a[92:95], v[44:47], v[196:199], a[92:95]
buffer_load_dwordx4 v[44:47], v1, s[4:7], s35 offen offset:0
v_mfma_f32_16x16x32_bf16 a[96:99], v[48:51], v[184:187], a[96:99]
v_mfma_f32_16x16x32_bf16 a[100:103], v[48:51], v[188:191], a[100:103]
v_mfma_f32_16x16x32_bf16 a[104:107], v[48:51], v[192:195], a[104:107]
v_mfma_f32_16x16x32_bf16 a[108:111], v[48:51], v[196:199], a[108:111]
buffer_load_dwordx4 v[48:51], v1, s[4:7], s36 offen offset:0
v_mfma_f32_16x16x32_bf16 a[112:115], v[52:55], v[184:187], a[112:115]
v_mfma_f32_16x16x32_bf16 a[116:119], v[52:55], v[188:191], a[116:119]
v_mfma_f32_16x16x32_bf16 a[120:123], v[52:55], v[192:195], a[120:123]
v_mfma_f32_16x16x32_bf16 a[124:127], v[52:55], v[196:199], a[124:127]
buffer_load_dwordx4 v[52:55], v1, s[4:7], s37 offen offset:0
v_mfma_f32_16x16x32_bf16 a[128:131], v[56:59], v[184:187], a[128:131]
v_mfma_f32_16x16x32_bf16 a[132:135], v[56:59], v[188:191], a[132:135]
v_mfma_f32_16x16x32_bf16 a[136:139], v[56:59], v[192:195], a[136:139]
v_mfma_f32_16x16x32_bf16 a[140:143], v[56:59], v[196:199], a[140:143]
buffer_load_dwordx4 v[56:59], v1, s[4:7], s38 offen offset:0
v_mfma_f32_16x16x32_bf16 a[144:147], v[60:63], v[184:187], a[144:147]
v_mfma_f32_16x16x32_bf16 a[148:151], v[60:63], v[188:191], a[148:151]
v_mfma_f32_16x16x32_bf16 a[152:155], v[60:63], v[192:195], a[152:155]
v_mfma_f32_16x16x32_bf16 a[156:159], v[60:63], v[196:199], a[156:159]
buffer_load_dwordx4 v[60:63], v1, s[4:7], s39 offen offset:0
s_waitcnt vmcnt(30)
s_waitcnt lgkmcnt(0)
v_mfma_f32_16x16x32_bf16 a[0:3], v[64:67], v[200:203], a[0:3]
v_mfma_f32_16x16x32_bf16 a[4:7], v[64:67], v[204:207], a[4:7]
v_mfma_f32_16x16x32_bf16 a[8:11], v[64:67], v[208:211], a[8:11]
v_mfma_f32_16x16x32_bf16 a[12:15], v[64:67], v[212:215], a[12:15]
ds_read_b128 v[184:187], v1 offset:10240
buffer_load_dwordx4 v[64:67], v1, s[4:7], s30 offen offset:1024
v_mfma_f32_16x16x32_bf16 a[16:19], v[68:71], v[200:203], a[16:19]
v_mfma_f32_16x16x32_bf16 a[20:23], v[68:71], v[204:207], a[20:23]
v_mfma_f32_16x16x32_bf16 a[24:27], v[68:71], v[208:211], a[24:27]
v_mfma_f32_16x16x32_bf16 a[28:31], v[68:71], v[212:215], a[28:31]
ds_read_b128 v[188:191], v1 offset:34816
buffer_load_dwordx4 v[68:71], v1, s[4:7], s31 offen offset:1024
v_mfma_f32_16x16x32_bf16 a[32:35], v[72:75], v[200:203], a[32:35]
v_mfma_f32_16x16x32_bf16 a[36:39], v[72:75], v[204:207], a[36:39]
v_mfma_f32_16x16x32_bf16 a[40:43], v[72:75], v[208:211], a[40:43]
v_mfma_f32_16x16x32_bf16 a[44:47], v[72:75], v[212:215], a[44:47]
ds_read_b128 v[192:195], v6 offset:10240
buffer_load_dwordx4 v[72:75], v1, s[4:7], s32 offen offset:1024
v_mfma_f32_16x16x32_bf16 a[48:51], v[76:79], v[200:203], a[48:51]
v_mfma_f32_16x16x32_bf16 a[52:55], v[76:79], v[204:207], a[52:55]
v_mfma_f32_16x16x32_bf16 a[56:59], v[76:79], v[208:211], a[56:59]
v_mfma_f32_16x16x32_bf16 a[60:63], v[76:79], v[212:215], a[60:63]
ds_read_b128 v[196:199], v6 offset:34816
buffer_load_dwordx4 v[76:79], v1, s[4:7], s33 offen offset:1024
v_mfma_f32_16x16x32_bf16 a[64:67], v[80:83], v[200:203], a[64:67]
v_mfma_f32_16x16x32_bf16 a[68:71], v[80:83], v[204:207], a[68:71]
v_mfma_f32_16x16x32_bf16 a[72:75], v[80:83], v[208:211], a[72:75]
v_mfma_f32_16x16x32_bf16 a[76:79], v[80:83], v[212:215], a[76:79]
buffer_load_dwordx4 v[80:83], v1, s[4:7], s34 offen offset:1024
v_mfma_f32_16x16x32_bf16 a[80:83], v[84:87], v[200:203], a[80:83]
v_mfma_f32_16x16x32_bf16 a[84:87], v[84:87], v[204:207], a[84:87]
v_mfma_f32_16x16x32_bf16 a[88:91], v[84:87], v[208:211], a[88:91]
v_mfma_f32_16x16x32_bf16 a[92:95], v[84:87], v[212:215], a[92:95]
buffer_load_dwordx4 v[84:87], v1, s[4:7], s35 offen offset:1024
v_mfma_f32_16x16x32_bf16 a[96:99], v[88:91], v[200:203], a[96:99]
v_mfma_f32_16x16x32_bf16 a[100:103], v[88:91], v[204:207], a[100:103]
v_mfma_f32_16x16x32_bf16 a[104:107], v[88:91], v[208:211], a[104:107]
v_mfma_f32_16x16x32_bf16 a[108:111], v[88:91], v[212:215], a[108:111]
buffer_load_dwordx4 v[88:91], v1, s[4:7], s36 offen offset:1024
v_mfma_f32_16x16x32_bf16 a[112:115], v[92:95], v[200:203], a[112:115]
v_mfma_f32_16x16x32_bf16 a[116:119], v[92:95], v[204:207], a[116:119]
v_mfma_f32_16x16x32_bf16 a[120:123], v[92:95], v[208:211], a[120:123]
v_mfma_f32_16x16x32_bf16 a[124:127], v[92:95], v[212:215], a[124:127]
buffer_load_dwordx4 v[92:95], v1, s[4:7], s37 offen offset:1024
v_mfma_f32_16x16x32_bf16 a[128:131], v[96:99], v[200:203], a[128:131]
v_mfma_f32_16x16x32_bf16 a[132:135], v[96:99], v[204:207], a[132:135]
v_mfma_f32_16x16x32_bf16 a[136:139], v[96:99], v[208:211], a[136:139]
v_mfma_f32_16x16x32_bf16 a[140:143], v[96:99], v[212:215], a[140:143]
buffer_load_dwordx4 v[96:99], v1, s[4:7], s38 offen offset:1024
v_mfma_f32_16x16x32_bf16 a[144:147], v[100:103], v[200:203], a[144:147]
v_mfma_f32_16x16x32_bf16 a[148:151], v[100:103], v[204:207], a[148:151]
v_mfma_f32_16x16x32_bf16 a[152:155], v[100:103], v[208:211], a[152:155]
v_mfma_f32_16x16x32_bf16 a[156:159], v[100:103], v[212:215], a[156:159]
buffer_load_dwordx4 v[100:103], v1, s[4:7], s39 offen offset:1024
s_waitcnt vmcnt(30)
s_waitcnt lgkmcnt(0)
v_mfma_f32_16x16x32_bf16 a[0:3], v[104:107], v[184:187], a[0:3]
v_mfma_f32_16x16x32_bf16 a[4:7], v[104:107], v[188:191], a[4:7]
v_mfma_f32_16x16x32_bf16 a[8:11], v[104:107], v[192:195], a[8:11]
v_mfma_f32_16x16x32_bf16 a[12:15], v[104:107], v[196:199], a[12:15]
ds_read_b128 v[200:203], v1 offset:11264
buffer_load_dwordx4 v[104:107], v1, s[4:7], s30 offen offset:2048
v_mfma_f32_16x16x32_bf16 a[16:19], v[108:111], v[184:187], a[16:19]
v_mfma_f32_16x16x32_bf16 a[20:23], v[108:111], v[188:191], a[20:23]
v_mfma_f32_16x16x32_bf16 a[24:27], v[108:111], v[192:195], a[24:27]
v_mfma_f32_16x16x32_bf16 a[28:31], v[108:111], v[196:199], a[28:31]
ds_read_b128 v[204:207], v1 offset:35840
buffer_load_dwordx4 v[108:111], v1, s[4:7], s31 offen offset:2048
v_mfma_f32_16x16x32_bf16 a[32:35], v[112:115], v[184:187], a[32:35]
v_mfma_f32_16x16x32_bf16 a[36:39], v[112:115], v[188:191], a[36:39]
v_mfma_f32_16x16x32_bf16 a[40:43], v[112:115], v[192:195], a[40:43]
v_mfma_f32_16x16x32_bf16 a[44:47], v[112:115], v[196:199], a[44:47]
ds_read_b128 v[208:211], v6 offset:11264
buffer_load_dwordx4 v[112:115], v1, s[4:7], s32 offen offset:2048
v_mfma_f32_16x16x32_bf16 a[48:51], v[116:119], v[184:187], a[48:51]
v_mfma_f32_16x16x32_bf16 a[52:55], v[116:119], v[188:191], a[52:55]
v_mfma_f32_16x16x32_bf16 a[56:59], v[116:119], v[192:195], a[56:59]
v_mfma_f32_16x16x32_bf16 a[60:63], v[116:119], v[196:199], a[60:63]
ds_read_b128 v[212:215], v6 offset:35840
buffer_load_dwordx4 v[116:119], v1, s[4:7], s33 offen offset:2048
v_mfma_f32_16x16x32_bf16 a[64:67], v[120:123], v[184:187], a[64:67]
v_mfma_f32_16x16x32_bf16 a[68:71], v[120:123], v[188:191], a[68:71]
v_mfma_f32_16x16x32_bf16 a[72:75], v[120:123], v[192:195], a[72:75]
v_mfma_f32_16x16x32_bf16 a[76:79], v[120:123], v[196:199], a[76:79]
buffer_load_dwordx4 v[120:123], v1, s[4:7], s34 offen offset:2048
v_mfma_f32_16x16x32_bf16 a[80:83], v[124:127], v[184:187], a[80:83]
v_mfma_f32_16x16x32_bf16 a[84:87], v[124:127], v[188:191], a[84:87]
v_mfma_f32_16x16x32_bf16 a[88:91], v[124:127], v[192:195], a[88:91]
v_mfma_f32_16x16x32_bf16 a[92:95], v[124:127], v[196:199], a[92:95]
buffer_load_dwordx4 v[124:127], v1, s[4:7], s35 offen offset:2048
v_mfma_f32_16x16x32_bf16 a[96:99], v[128:131], v[184:187], a[96:99]
v_mfma_f32_16x16x32_bf16 a[100:103], v[128:131], v[188:191], a[100:103]
v_mfma_f32_16x16x32_bf16 a[104:107], v[128:131], v[192:195], a[104:107]
v_mfma_f32_16x16x32_bf16 a[108:111], v[128:131], v[196:199], a[108:111]
buffer_load_dwordx4 v[128:131], v1, s[4:7], s36 offen offset:2048
v_mfma_f32_16x16x32_bf16 a[112:115], v[132:135], v[184:187], a[112:115]
v_mfma_f32_16x16x32_bf16 a[116:119], v[132:135], v[188:191], a[116:119]
v_mfma_f32_16x16x32_bf16 a[120:123], v[132:135], v[192:195], a[120:123]
v_mfma_f32_16x16x32_bf16 a[124:127], v[132:135], v[196:199], a[124:127]
buffer_load_dwordx4 v[132:135], v1, s[4:7], s37 offen offset:2048
v_mfma_f32_16x16x32_bf16 a[128:131], v[136:139], v[184:187], a[128:131]
v_mfma_f32_16x16x32_bf16 a[132:135], v[136:139], v[188:191], a[132:135]
v_mfma_f32_16x16x32_bf16 a[136:139], v[136:139], v[192:195], a[136:139]
v_mfma_f32_16x16x32_bf16 a[140:143], v[136:139], v[196:199], a[140:143]
buffer_load_dwordx4 v[136:139], v1, s[4:7], s38 offen offset:2048
v_mfma_f32_16x16x32_bf16 a[144:147], v[140:143], v[184:187], a[144:147]
v_mfma_f32_16x16x32_bf16 a[148:151], v[140:143], v[188:191], a[148:151]
v_mfma_f32_16x16x32_bf16 a[152:155], v[140:143], v[192:195], a[152:155]
v_mfma_f32_16x16x32_bf16 a[156:159], v[140:143], v[196:199], a[156:159]
buffer_load_dwordx4 v[140:143], v1, s[4:7], s39 offen offset:2048
s_barrier
s_waitcnt vmcnt(30)
s_waitcnt lgkmcnt(0)
v_mfma_f32_16x16x32_bf16 a[0:3], v[144:147], v[200:203], a[0:3]
v_mfma_f32_16x16x32_bf16 a[4:7], v[144:147], v[204:207], a[4:7]
v_mfma_f32_16x16x32_bf16 a[8:11], v[144:147], v[208:211], a[8:11]
v_mfma_f32_16x16x32_bf16 a[12:15], v[144:147], v[212:215], a[12:15]
ds_read_b128 v[184:187], v1 offset:12288
buffer_load_dwordx4 v[144:147], v1, s[4:7], s30 offen offset:3072
s_add_u32 s30, s30, 4096
v_mfma_f32_16x16x32_bf16 a[16:19], v[148:151], v[200:203], a[16:19]
v_mfma_f32_16x16x32_bf16 a[20:23], v[148:151], v[204:207], a[20:23]
v_mfma_f32_16x16x32_bf16 a[24:27], v[148:151], v[208:211], a[24:27]
v_mfma_f32_16x16x32_bf16 a[28:31], v[148:151], v[212:215], a[28:31]
ds_read_b128 v[188:191], v1 offset:36864
buffer_load_dwordx4 v[148:151], v1, s[4:7], s31 offen offset:3072
s_add_u32 s31, s31, 4096
v_mfma_f32_16x16x32_bf16 a[32:35], v[152:155], v[200:203], a[32:35]
v_mfma_f32_16x16x32_bf16 a[36:39], v[152:155], v[204:207], a[36:39]
v_mfma_f32_16x16x32_bf16 a[40:43], v[152:155], v[208:211], a[40:43]
v_mfma_f32_16x16x32_bf16 a[44:47], v[152:155], v[212:215], a[44:47]
ds_read_b128 v[192:195], v6 offset:12288
buffer_load_dwordx4 v[152:155], v1, s[4:7], s32 offen offset:3072
s_add_u32 s32, s32, 4096
v_mfma_f32_16x16x32_bf16 a[48:51], v[156:159], v[200:203], a[48:51]
v_mfma_f32_16x16x32_bf16 a[52:55], v[156:159], v[204:207], a[52:55]
v_mfma_f32_16x16x32_bf16 a[56:59], v[156:159], v[208:211], a[56:59]
v_mfma_f32_16x16x32_bf16 a[60:63], v[156:159], v[212:215], a[60:63]
ds_read_b128 v[196:199], v6 offset:36864
buffer_load_dwordx4 v[156:159], v1, s[4:7], s33 offen offset:3072
s_add_u32 s33, s33, 4096
v_mfma_f32_16x16x32_bf16 a[64:67], v[160:163], v[200:203], a[64:67]
v_mfma_f32_16x16x32_bf16 a[68:71], v[160:163], v[204:207], a[68:71]
v_mfma_f32_16x16x32_bf16 a[72:75], v[160:163], v[208:211], a[72:75]
v_mfma_f32_16x16x32_bf16 a[76:79], v[160:163], v[212:215], a[76:79]
buffer_load_dwordx4 v[160:163], v1, s[4:7], s34 offen offset:3072
s_add_u32 s34, s34, 4096
v_mfma_f32_16x16x32_bf16 a[80:83], v[164:167], v[200:203], a[80:83]
v_mfma_f32_16x16x32_bf16 a[84:87], v[164:167], v[204:207], a[84:87]
v_mfma_f32_16x16x32_bf16 a[88:91], v[164:167], v[208:211], a[88:91]
v_mfma_f32_16x16x32_bf16 a[92:95], v[164:167], v[212:215], a[92:95]
buffer_load_dwordx4 v[164:167], v1, s[4:7], s35 offen offset:3072
s_add_u32 s35, s35, 4096
v_mfma_f32_16x16x32_bf16 a[96:99], v[168:171], v[200:203], a[96:99]
v_mfma_f32_16x16x32_bf16 a[100:103], v[168:171], v[204:207], a[100:103]
v_mfma_f32_16x16x32_bf16 a[104:107], v[168:171], v[208:211], a[104:107]
v_mfma_f32_16x16x32_bf16 a[108:111], v[168:171], v[212:215], a[108:111]
buffer_load_dwordx4 v[168:171], v1, s[4:7], s36 offen offset:3072
s_add_u32 s36, s36, 4096
v_mfma_f32_16x16x32_bf16 a[112:115], v[172:175], v[200:203], a[112:115]
v_mfma_f32_16x16x32_bf16 a[116:119], v[172:175], v[204:207], a[116:119]
v_mfma_f32_16x16x32_bf16 a[120:123], v[172:175], v[208:211], a[120:123]
v_mfma_f32_16x16x32_bf16 a[124:127], v[172:175], v[212:215], a[124:127]
buffer_load_dwordx4 v[172:175], v1, s[4:7], s37 offen offset:3072
s_add_u32 s37, s37, 4096
v_mfma_f32_16x16x32_bf16 a[128:131], v[176:179], v[200:203], a[128:131]
v_mfma_f32_16x16x32_bf16 a[132:135], v[176:179], v[204:207], a[132:135]
v_mfma_f32_16x16x32_bf16 a[136:139], v[176:179], v[208:211], a[136:139]
v_mfma_f32_16x16x32_bf16 a[140:143], v[176:179], v[212:215], a[140:143]
buffer_load_dwordx4 v[176:179], v1, s[4:7], s38 offen offset:3072
s_add_u32 s38, s38, 4096
v_mfma_f32_16x16x32_bf16 a[144:147], v[180:183], v[200:203], a[144:147]
v_mfma_f32_16x16x32_bf16 a[148:151], v[180:183], v[204:207], a[148:151]
v_mfma_f32_16x16x32_bf16 a[152:155], v[180:183], v[208:211], a[152:155]
v_mfma_f32_16x16x32_bf16 a[156:159], v[180:183], v[212:215], a[156:159]
buffer_load_dwordx4 v[180:183], v1, s[4:7], s39 offen offset:3072
s_add_u32 s39, s39, 4096
s_waitcnt vmcnt(30)
s_waitcnt lgkmcnt(0)
v_mfma_f32_16x16x32_bf16 a[0:3], v[24:27], v[184:187], a[0:3]
v_mfma_f32_16x16x32_bf16 a[4:7], v[24:27], v[188:191], a[4:7]
v_mfma_f32_16x16x32_bf16 a[8:11], v[24:27], v[192:195], a[8:11]
v_mfma_f32_16x16x32_bf16 a[12:15], v[24:27], v[196:199], a[12:15]
ds_read_b128 v[200:203], v1 offset:13312
buffer_load_dwordx4 v[24:27], v1, s[4:7], s30 offen offset:0
v_mfma_f32_16x16x32_bf16 a[16:19], v[28:31], v[184:187], a[16:19]
v_mfma_f32_16x16x32_bf16 a[20:23], v[28:31], v[188:191], a[20:23]
v_mfma_f32_16x16x32_bf16 a[24:27], v[28:31], v[192:195], a[24:27]
v_mfma_f32_16x16x32_bf16 a[28:31], v[28:31], v[196:199], a[28:31]
ds_read_b128 v[204:207], v1 offset:37888
buffer_load_dwordx4 v[28:31], v1, s[4:7], s31 offen offset:0
v_mfma_f32_16x16x32_bf16 a[32:35], v[32:35], v[184:187], a[32:35]
v_mfma_f32_16x16x32_bf16 a[36:39], v[32:35], v[188:191], a[36:39]
v_mfma_f32_16x16x32_bf16 a[40:43], v[32:35], v[192:195], a[40:43]
v_mfma_f32_16x16x32_bf16 a[44:47], v[32:35], v[196:199], a[44:47]
ds_read_b128 v[208:211], v6 offset:13312
buffer_load_dwordx4 v[32:35], v1, s[4:7], s32 offen offset:0
v_mfma_f32_16x16x32_bf16 a[48:51], v[36:39], v[184:187], a[48:51]
v_mfma_f32_16x16x32_bf16 a[52:55], v[36:39], v[188:191], a[52:55]
v_mfma_f32_16x16x32_bf16 a[56:59], v[36:39], v[192:195], a[56:59]
v_mfma_f32_16x16x32_bf16 a[60:63], v[36:39], v[196:199], a[60:63]
ds_read_b128 v[212:215], v6 offset:37888
buffer_load_dwordx4 v[36:39], v1, s[4:7], s33 offen offset:0
v_mfma_f32_16x16x32_bf16 a[64:67], v[40:43], v[184:187], a[64:67]
v_mfma_f32_16x16x32_bf16 a[68:71], v[40:43], v[188:191], a[68:71]
v_mfma_f32_16x16x32_bf16 a[72:75], v[40:43], v[192:195], a[72:75]
v_mfma_f32_16x16x32_bf16 a[76:79], v[40:43], v[196:199], a[76:79]
buffer_load_dwordx4 v[40:43], v1, s[4:7], s34 offen offset:0
v_mfma_f32_16x16x32_bf16 a[80:83], v[44:47], v[184:187], a[80:83]
v_mfma_f32_16x16x32_bf16 a[84:87], v[44:47], v[188:191], a[84:87]
v_mfma_f32_16x16x32_bf16 a[88:91], v[44:47], v[192:195], a[88:91]
v_mfma_f32_16x16x32_bf16 a[92:95], v[44:47], v[196:199], a[92:95]
buffer_load_dwordx4 v[44:47], v1, s[4:7], s35 offen offset:0
v_mfma_f32_16x16x32_bf16 a[96:99], v[48:51], v[184:187], a[96:99]
v_mfma_f32_16x16x32_bf16 a[100:103], v[48:51], v[188:191], a[100:103]
v_mfma_f32_16x16x32_bf16 a[104:107], v[48:51], v[192:195], a[104:107]
v_mfma_f32_16x16x32_bf16 a[108:111], v[48:51], v[196:199], a[108:111]
buffer_load_dwordx4 v[48:51], v1, s[4:7], s36 offen offset:0
v_mfma_f32_16x16x32_bf16 a[112:115], v[52:55], v[184:187], a[112:115]
v_mfma_f32_16x16x32_bf16 a[116:119], v[52:55], v[188:191], a[116:119]
v_mfma_f32_16x16x32_bf16 a[120:123], v[52:55], v[192:195], a[120:123]
v_mfma_f32_16x16x32_bf16 a[124:127], v[52:55], v[196:199], a[124:127]
buffer_load_dwordx4 v[52:55], v1, s[4:7], s37 offen offset:0
v_mfma_f32_16x16x32_bf16 a[128:131], v[56:59], v[184:187], a[128:131]
v_mfma_f32_16x16x32_bf16 a[132:135], v[56:59], v[188:191], a[132:135]
v_mfma_f32_16x16x32_bf16 a[136:139], v[56:59], v[192:195], a[136:139]
v_mfma_f32_16x16x32_bf16 a[140:143], v[56:59], v[196:199], a[140:143]
buffer_load_dwordx4 v[56:59], v1, s[4:7], s38 offen offset:0
v_mfma_f32_16x16x32_bf16 a[144:147], v[60:63], v[184:187], a[144:147]
v_mfma_f32_16x16x32_bf16 a[148:151], v[60:63], v[188:191], a[148:151]
v_mfma_f32_16x16x32_bf16 a[152:155], v[60:63], v[192:195], a[152:155]
v_mfma_f32_16x16x32_bf16 a[156:159], v[60:63], v[196:199], a[156:159]
buffer_load_dwordx4 v[60:63], v1, s[4:7], s39 offen offset:0
s_waitcnt vmcnt(30)
s_waitcnt lgkmcnt(0)
v_mfma_f32_16x16x32_bf16 a[0:3], v[64:67], v[200:203], a[0:3]
v_mfma_f32_16x16x32_bf16 a[4:7], v[64:67], v[204:207], a[4:7]
v_mfma_f32_16x16x32_bf16 a[8:11], v[64:67], v[208:211], a[8:11]
v_mfma_f32_16x16x32_bf16 a[12:15], v[64:67], v[212:215], a[12:15]
ds_read_b128 v[184:187], v1 offset:14336
buffer_load_dwordx4 v[64:67], v1, s[4:7], s30 offen offset:1024
v_mfma_f32_16x16x32_bf16 a[16:19], v[68:71], v[200:203], a[16:19]
v_mfma_f32_16x16x32_bf16 a[20:23], v[68:71], v[204:207], a[20:23]
v_mfma_f32_16x16x32_bf16 a[24:27], v[68:71], v[208:211], a[24:27]
v_mfma_f32_16x16x32_bf16 a[28:31], v[68:71], v[212:215], a[28:31]
ds_read_b128 v[188:191], v1 offset:38912
buffer_load_dwordx4 v[68:71], v1, s[4:7], s31 offen offset:1024
v_mfma_f32_16x16x32_bf16 a[32:35], v[72:75], v[200:203], a[32:35]
v_mfma_f32_16x16x32_bf16 a[36:39], v[72:75], v[204:207], a[36:39]
v_mfma_f32_16x16x32_bf16 a[40:43], v[72:75], v[208:211], a[40:43]
v_mfma_f32_16x16x32_bf16 a[44:47], v[72:75], v[212:215], a[44:47]
ds_read_b128 v[192:195], v6 offset:14336
buffer_load_dwordx4 v[72:75], v1, s[4:7], s32 offen offset:1024
v_mfma_f32_16x16x32_bf16 a[48:51], v[76:79], v[200:203], a[48:51]
v_mfma_f32_16x16x32_bf16 a[52:55], v[76:79], v[204:207], a[52:55]
v_mfma_f32_16x16x32_bf16 a[56:59], v[76:79], v[208:211], a[56:59]
v_mfma_f32_16x16x32_bf16 a[60:63], v[76:79], v[212:215], a[60:63]
ds_read_b128 v[196:199], v6 offset:38912
buffer_load_dwordx4 v[76:79], v1, s[4:7], s33 offen offset:1024
v_mfma_f32_16x16x32_bf16 a[64:67], v[80:83], v[200:203], a[64:67]
v_mfma_f32_16x16x32_bf16 a[68:71], v[80:83], v[204:207], a[68:71]
v_mfma_f32_16x16x32_bf16 a[72:75], v[80:83], v[208:211], a[72:75]
v_mfma_f32_16x16x32_bf16 a[76:79], v[80:83], v[212:215], a[76:79]
buffer_load_dwordx4 v[80:83], v1, s[4:7], s34 offen offset:1024
v_mfma_f32_16x16x32_bf16 a[80:83], v[84:87], v[200:203], a[80:83]
v_mfma_f32_16x16x32_bf16 a[84:87], v[84:87], v[204:207], a[84:87]
v_mfma_f32_16x16x32_bf16 a[88:91], v[84:87], v[208:211], a[88:91]
v_mfma_f32_16x16x32_bf16 a[92:95], v[84:87], v[212:215], a[92:95]
buffer_load_dwordx4 v[84:87], v1, s[4:7], s35 offen offset:1024
v_mfma_f32_16x16x32_bf16 a[96:99], v[88:91], v[200:203], a[96:99]
v_mfma_f32_16x16x32_bf16 a[100:103], v[88:91], v[204:207], a[100:103]
v_mfma_f32_16x16x32_bf16 a[104:107], v[88:91], v[208:211], a[104:107]
v_mfma_f32_16x16x32_bf16 a[108:111], v[88:91], v[212:215], a[108:111]
buffer_load_dwordx4 v[88:91], v1, s[4:7], s36 offen offset:1024
v_mfma_f32_16x16x32_bf16 a[112:115], v[92:95], v[200:203], a[112:115]
v_mfma_f32_16x16x32_bf16 a[116:119], v[92:95], v[204:207], a[116:119]
v_mfma_f32_16x16x32_bf16 a[120:123], v[92:95], v[208:211], a[120:123]
v_mfma_f32_16x16x32_bf16 a[124:127], v[92:95], v[212:215], a[124:127]
buffer_load_dwordx4 v[92:95], v1, s[4:7], s37 offen offset:1024
v_mfma_f32_16x16x32_bf16 a[128:131], v[96:99], v[200:203], a[128:131]
v_mfma_f32_16x16x32_bf16 a[132:135], v[96:99], v[204:207], a[132:135]
v_mfma_f32_16x16x32_bf16 a[136:139], v[96:99], v[208:211], a[136:139]
v_mfma_f32_16x16x32_bf16 a[140:143], v[96:99], v[212:215], a[140:143]
buffer_load_dwordx4 v[96:99], v1, s[4:7], s38 offen offset:1024
v_mfma_f32_16x16x32_bf16 a[144:147], v[100:103], v[200:203], a[144:147]
v_mfma_f32_16x16x32_bf16 a[148:151], v[100:103], v[204:207], a[148:151]
v_mfma_f32_16x16x32_bf16 a[152:155], v[100:103], v[208:211], a[152:155]
v_mfma_f32_16x16x32_bf16 a[156:159], v[100:103], v[212:215], a[156:159]
buffer_load_dwordx4 v[100:103], v1, s[4:7], s39 offen offset:1024
s_waitcnt vmcnt(30)
s_waitcnt lgkmcnt(0)
v_mfma_f32_16x16x32_bf16 a[0:3], v[104:107], v[184:187], a[0:3]
v_mfma_f32_16x16x32_bf16 a[4:7], v[104:107], v[188:191], a[4:7]
v_mfma_f32_16x16x32_bf16 a[8:11], v[104:107], v[192:195], a[8:11]
v_mfma_f32_16x16x32_bf16 a[12:15], v[104:107], v[196:199], a[12:15]
ds_read_b128 v[200:203], v1 offset:15360
buffer_load_dwordx4 v[104:107], v1, s[4:7], s30 offen offset:2048
v_mfma_f32_16x16x32_bf16 a[16:19], v[108:111], v[184:187], a[16:19]
v_mfma_f32_16x16x32_bf16 a[20:23], v[108:111], v[188:191], a[20:23]
v_mfma_f32_16x16x32_bf16 a[24:27], v[108:111], v[192:195], a[24:27]
v_mfma_f32_16x16x32_bf16 a[28:31], v[108:111], v[196:199], a[28:31]
ds_read_b128 v[204:207], v1 offset:39936
buffer_load_dwordx4 v[108:111], v1, s[4:7], s31 offen offset:2048
v_mfma_f32_16x16x32_bf16 a[32:35], v[112:115], v[184:187], a[32:35]
v_mfma_f32_16x16x32_bf16 a[36:39], v[112:115], v[188:191], a[36:39]
v_mfma_f32_16x16x32_bf16 a[40:43], v[112:115], v[192:195], a[40:43]
v_mfma_f32_16x16x32_bf16 a[44:47], v[112:115], v[196:199], a[44:47]
ds_read_b128 v[208:211], v6 offset:15360
buffer_load_dwordx4 v[112:115], v1, s[4:7], s32 offen offset:2048
v_mfma_f32_16x16x32_bf16 a[48:51], v[116:119], v[184:187], a[48:51]
v_mfma_f32_16x16x32_bf16 a[52:55], v[116:119], v[188:191], a[52:55]
v_mfma_f32_16x16x32_bf16 a[56:59], v[116:119], v[192:195], a[56:59]
v_mfma_f32_16x16x32_bf16 a[60:63], v[116:119], v[196:199], a[60:63]
ds_read_b128 v[212:215], v6 offset:39936
buffer_load_dwordx4 v[116:119], v1, s[4:7], s33 offen offset:2048
v_mfma_f32_16x16x32_bf16 a[64:67], v[120:123], v[184:187], a[64:67]
v_mfma_f32_16x16x32_bf16 a[68:71], v[120:123], v[188:191], a[68:71]
v_mfma_f32_16x16x32_bf16 a[72:75], v[120:123], v[192:195], a[72:75]
v_mfma_f32_16x16x32_bf16 a[76:79], v[120:123], v[196:199], a[76:79]
buffer_load_dwordx4 v[120:123], v1, s[4:7], s34 offen offset:2048
v_mfma_f32_16x16x32_bf16 a[80:83], v[124:127], v[184:187], a[80:83]
v_mfma_f32_16x16x32_bf16 a[84:87], v[124:127], v[188:191], a[84:87]
v_mfma_f32_16x16x32_bf16 a[88:91], v[124:127], v[192:195], a[88:91]
v_mfma_f32_16x16x32_bf16 a[92:95], v[124:127], v[196:199], a[92:95]
buffer_load_dwordx4 v[124:127], v1, s[4:7], s35 offen offset:2048
v_mfma_f32_16x16x32_bf16 a[96:99], v[128:131], v[184:187], a[96:99]
v_mfma_f32_16x16x32_bf16 a[100:103], v[128:131], v[188:191], a[100:103]
v_mfma_f32_16x16x32_bf16 a[104:107], v[128:131], v[192:195], a[104:107]
v_mfma_f32_16x16x32_bf16 a[108:111], v[128:131], v[196:199], a[108:111]
buffer_load_dwordx4 v[128:131], v1, s[4:7], s36 offen offset:2048
v_mfma_f32_16x16x32_bf16 a[112:115], v[132:135], v[184:187], a[112:115]
v_mfma_f32_16x16x32_bf16 a[116:119], v[132:135], v[188:191], a[116:119]
v_mfma_f32_16x16x32_bf16 a[120:123], v[132:135], v[192:195], a[120:123]
v_mfma_f32_16x16x32_bf16 a[124:127], v[132:135], v[196:199], a[124:127]
buffer_load_dwordx4 v[132:135], v1, s[4:7], s37 offen offset:2048
v_mfma_f32_16x16x32_bf16 a[128:131], v[136:139], v[184:187], a[128:131]
v_mfma_f32_16x16x32_bf16 a[132:135], v[136:139], v[188:191], a[132:135]
v_mfma_f32_16x16x32_bf16 a[136:139], v[136:139], v[192:195], a[136:139]
v_mfma_f32_16x16x32_bf16 a[140:143], v[136:139], v[196:199], a[140:143]
buffer_load_dwordx4 v[136:139], v1, s[4:7], s38 offen offset:2048
v_mfma_f32_16x16x32_bf16 a[144:147], v[140:143], v[184:187], a[144:147]
v_mfma_f32_16x16x32_bf16 a[148:151], v[140:143], v[188:191], a[148:151]
v_mfma_f32_16x16x32_bf16 a[152:155], v[140:143], v[192:195], a[152:155]
v_mfma_f32_16x16x32_bf16 a[156:159], v[140:143], v[196:199], a[156:159]
buffer_load_dwordx4 v[140:143], v1, s[4:7], s39 offen offset:2048
s_waitcnt vmcnt(30)
s_waitcnt lgkmcnt(0)
v_mfma_f32_16x16x32_bf16 a[0:3], v[144:147], v[200:203], a[0:3]
v_mfma_f32_16x16x32_bf16 a[4:7], v[144:147], v[204:207], a[4:7]
v_mfma_f32_16x16x32_bf16 a[8:11], v[144:147], v[208:211], a[8:11]
v_mfma_f32_16x16x32_bf16 a[12:15], v[144:147], v[212:215], a[12:15]
ds_read_b128 v[184:187], v1 offset:16384
buffer_load_dwordx4 v[144:147], v1, s[4:7], s30 offen offset:3072
s_add_u32 s30, s30, 4096
v_mfma_f32_16x16x32_bf16 a[16:19], v[148:151], v[200:203], a[16:19]
v_mfma_f32_16x16x32_bf16 a[20:23], v[148:151], v[204:207], a[20:23]
v_mfma_f32_16x16x32_bf16 a[24:27], v[148:151], v[208:211], a[24:27]
v_mfma_f32_16x16x32_bf16 a[28:31], v[148:151], v[212:215], a[28:31]
ds_read_b128 v[188:191], v1 offset:40960
buffer_load_dwordx4 v[148:151], v1, s[4:7], s31 offen offset:3072
s_add_u32 s31, s31, 4096
v_mfma_f32_16x16x32_bf16 a[32:35], v[152:155], v[200:203], a[32:35]
v_mfma_f32_16x16x32_bf16 a[36:39], v[152:155], v[204:207], a[36:39]
v_mfma_f32_16x16x32_bf16 a[40:43], v[152:155], v[208:211], a[40:43]
v_mfma_f32_16x16x32_bf16 a[44:47], v[152:155], v[212:215], a[44:47]
ds_read_b128 v[192:195], v6 offset:16384
buffer_load_dwordx4 v[152:155], v1, s[4:7], s32 offen offset:3072
s_add_u32 s32, s32, 4096
v_mfma_f32_16x16x32_bf16 a[48:51], v[156:159], v[200:203], a[48:51]
v_mfma_f32_16x16x32_bf16 a[52:55], v[156:159], v[204:207], a[52:55]
v_mfma_f32_16x16x32_bf16 a[56:59], v[156:159], v[208:211], a[56:59]
v_mfma_f32_16x16x32_bf16 a[60:63], v[156:159], v[212:215], a[60:63]
ds_read_b128 v[196:199], v6 offset:40960
buffer_load_dwordx4 v[156:159], v1, s[4:7], s33 offen offset:3072
s_add_u32 s33, s33, 4096
v_mfma_f32_16x16x32_bf16 a[64:67], v[160:163], v[200:203], a[64:67]
v_mfma_f32_16x16x32_bf16 a[68:71], v[160:163], v[204:207], a[68:71]
v_mfma_f32_16x16x32_bf16 a[72:75], v[160:163], v[208:211], a[72:75]
v_mfma_f32_16x16x32_bf16 a[76:79], v[160:163], v[212:215], a[76:79]
buffer_load_dwordx4 v[160:163], v1, s[4:7], s34 offen offset:3072
s_add_u32 s34, s34, 4096
v_mfma_f32_16x16x32_bf16 a[80:83], v[164:167], v[200:203], a[80:83]
v_mfma_f32_16x16x32_bf16 a[84:87], v[164:167], v[204:207], a[84:87]
v_mfma_f32_16x16x32_bf16 a[88:91], v[164:167], v[208:211], a[88:91]
v_mfma_f32_16x16x32_bf16 a[92:95], v[164:167], v[212:215], a[92:95]
buffer_load_dwordx4 v[164:167], v1, s[4:7], s35 offen offset:3072
s_add_u32 s35, s35, 4096
v_mfma_f32_16x16x32_bf16 a[96:99], v[168:171], v[200:203], a[96:99]
v_mfma_f32_16x16x32_bf16 a[100:103], v[168:171], v[204:207], a[100:103]
v_mfma_f32_16x16x32_bf16 a[104:107], v[168:171], v[208:211], a[104:107]
v_mfma_f32_16x16x32_bf16 a[108:111], v[168:171], v[212:215], a[108:111]
buffer_load_dwordx4 v[168:171], v1, s[4:7], s36 offen offset:3072
s_add_u32 s36, s36, 4096
v_mfma_f32_16x16x32_bf16 a[112:115], v[172:175], v[200:203], a[112:115]
v_mfma_f32_16x16x32_bf16 a[116:119], v[172:175], v[204:207], a[116:119]
v_mfma_f32_16x16x32_bf16 a[120:123], v[172:175], v[208:211], a[120:123]
v_mfma_f32_16x16x32_bf16 a[124:127], v[172:175], v[212:215], a[124:127]
buffer_load_dwordx4 v[172:175], v1, s[4:7], s37 offen offset:3072
s_add_u32 s37, s37, 4096
v_mfma_f32_16x16x32_bf16 a[128:131], v[176:179], v[200:203], a[128:131]
v_mfma_f32_16x16x32_bf16 a[132:135], v[176:179], v[204:207], a[132:135]
v_mfma_f32_16x16x32_bf16 a[136:139], v[176:179], v[208:211], a[136:139]
v_mfma_f32_16x16x32_bf16 a[140:143], v[176:179], v[212:215], a[140:143]
buffer_load_dwordx4 v[176:179], v1, s[4:7], s38 offen offset:3072
s_add_u32 s38, s38, 4096
v_mfma_f32_16x16x32_bf16 a[144:147], v[180:183], v[200:203], a[144:147]
v_mfma_f32_16x16x32_bf16 a[148:151], v[180:183], v[204:207], a[148:151]
v_mfma_f32_16x16x32_bf16 a[152:155], v[180:183], v[208:211], a[152:155]
v_mfma_f32_16x16x32_bf16 a[156:159], v[180:183], v[212:215], a[156:159]
buffer_load_dwordx4 v[180:183], v1, s[4:7], s39 offen offset:3072
s_add_u32 s39, s39, 4096
s_waitcnt vmcnt(30)
s_waitcnt lgkmcnt(0)
v_mfma_f32_16x16x32_bf16 a[0:3], v[24:27], v[184:187], a[0:3]
v_mfma_f32_16x16x32_bf16 a[4:7], v[24:27], v[188:191], a[4:7]
v_mfma_f32_16x16x32_bf16 a[8:11], v[24:27], v[192:195], a[8:11]
v_mfma_f32_16x16x32_bf16 a[12:15], v[24:27], v[196:199], a[12:15]
ds_read_b128 v[200:203], v1 offset:17408
buffer_load_dwordx4 v[24:27], v1, s[4:7], s30 offen offset:0
v_mfma_f32_16x16x32_bf16 a[16:19], v[28:31], v[184:187], a[16:19]
v_mfma_f32_16x16x32_bf16 a[20:23], v[28:31], v[188:191], a[20:23]
v_mfma_f32_16x16x32_bf16 a[24:27], v[28:31], v[192:195], a[24:27]
v_mfma_f32_16x16x32_bf16 a[28:31], v[28:31], v[196:199], a[28:31]
ds_read_b128 v[204:207], v1 offset:41984
buffer_load_dwordx4 v[28:31], v1, s[4:7], s31 offen offset:0
v_mfma_f32_16x16x32_bf16 a[32:35], v[32:35], v[184:187], a[32:35]
v_mfma_f32_16x16x32_bf16 a[36:39], v[32:35], v[188:191], a[36:39]
v_mfma_f32_16x16x32_bf16 a[40:43], v[32:35], v[192:195], a[40:43]
v_mfma_f32_16x16x32_bf16 a[44:47], v[32:35], v[196:199], a[44:47]
ds_read_b128 v[208:211], v6 offset:17408
buffer_load_dwordx4 v[32:35], v1, s[4:7], s32 offen offset:0
v_mfma_f32_16x16x32_bf16 a[48:51], v[36:39], v[184:187], a[48:51]
v_mfma_f32_16x16x32_bf16 a[52:55], v[36:39], v[188:191], a[52:55]
v_mfma_f32_16x16x32_bf16 a[56:59], v[36:39], v[192:195], a[56:59]
v_mfma_f32_16x16x32_bf16 a[60:63], v[36:39], v[196:199], a[60:63]
ds_read_b128 v[212:215], v6 offset:41984
buffer_load_dwordx4 v[36:39], v1, s[4:7], s33 offen offset:0
v_mfma_f32_16x16x32_bf16 a[64:67], v[40:43], v[184:187], a[64:67]
v_mfma_f32_16x16x32_bf16 a[68:71], v[40:43], v[188:191], a[68:71]
v_mfma_f32_16x16x32_bf16 a[72:75], v[40:43], v[192:195], a[72:75]
v_mfma_f32_16x16x32_bf16 a[76:79], v[40:43], v[196:199], a[76:79]
buffer_load_dwordx4 v[40:43], v1, s[4:7], s34 offen offset:0
v_mfma_f32_16x16x32_bf16 a[80:83], v[44:47], v[184:187], a[80:83]
v_mfma_f32_16x16x32_bf16 a[84:87], v[44:47], v[188:191], a[84:87]
v_mfma_f32_16x16x32_bf16 a[88:91], v[44:47], v[192:195], a[88:91]
v_mfma_f32_16x16x32_bf16 a[92:95], v[44:47], v[196:199], a[92:95]
buffer_load_dwordx4 v[44:47], v1, s[4:7], s35 offen offset:0
v_mfma_f32_16x16x32_bf16 a[96:99], v[48:51], v[184:187], a[96:99]
v_mfma_f32_16x16x32_bf16 a[100:103], v[48:51], v[188:191], a[100:103]
v_mfma_f32_16x16x32_bf16 a[104:107], v[48:51], v[192:195], a[104:107]
v_mfma_f32_16x16x32_bf16 a[108:111], v[48:51], v[196:199], a[108:111]
buffer_load_dwordx4 v[48:51], v1, s[4:7], s36 offen offset:0
v_mfma_f32_16x16x32_bf16 a[112:115], v[52:55], v[184:187], a[112:115]
v_mfma_f32_16x16x32_bf16 a[116:119], v[52:55], v[188:191], a[116:119]
v_mfma_f32_16x16x32_bf16 a[120:123], v[52:55], v[192:195], a[120:123]
v_mfma_f32_16x16x32_bf16 a[124:127], v[52:55], v[196:199], a[124:127]
buffer_load_dwordx4 v[52:55], v1, s[4:7], s37 offen offset:0
v_mfma_f32_16x16x32_bf16 a[128:131], v[56:59], v[184:187], a[128:131]
v_mfma_f32_16x16x32_bf16 a[132:135], v[56:59], v[188:191], a[132:135]
v_mfma_f32_16x16x32_bf16 a[136:139], v[56:59], v[192:195], a[136:139]
v_mfma_f32_16x16x32_bf16 a[140:143], v[56:59], v[196:199], a[140:143]
buffer_load_dwordx4 v[56:59], v1, s[4:7], s38 offen offset:0
v_mfma_f32_16x16x32_bf16 a[144:147], v[60:63], v[184:187], a[144:147]
v_mfma_f32_16x16x32_bf16 a[148:151], v[60:63], v[188:191], a[148:151]
v_mfma_f32_16x16x32_bf16 a[152:155], v[60:63], v[192:195], a[152:155]
v_mfma_f32_16x16x32_bf16 a[156:159], v[60:63], v[196:199], a[156:159]
buffer_load_dwordx4 v[60:63], v1, s[4:7], s39 offen offset:0
s_barrier
s_waitcnt vmcnt(30)
s_waitcnt lgkmcnt(0)
v_mfma_f32_16x16x32_bf16 a[0:3], v[64:67], v[200:203], a[0:3]
v_mfma_f32_16x16x32_bf16 a[4:7], v[64:67], v[204:207], a[4:7]
v_mfma_f32_16x16x32_bf16 a[8:11], v[64:67], v[208:211], a[8:11]
v_mfma_f32_16x16x32_bf16 a[12:15], v[64:67], v[212:215], a[12:15]
ds_read_b128 v[184:187], v1 offset:18432
buffer_load_dwordx4 v[64:67], v1, s[4:7], s30 offen offset:1024
v_mfma_f32_16x16x32_bf16 a[16:19], v[68:71], v[200:203], a[16:19]
v_mfma_f32_16x16x32_bf16 a[20:23], v[68:71], v[204:207], a[20:23]
v_mfma_f32_16x16x32_bf16 a[24:27], v[68:71], v[208:211], a[24:27]
v_mfma_f32_16x16x32_bf16 a[28:31], v[68:71], v[212:215], a[28:31]
ds_read_b128 v[188:191], v1 offset:43008
buffer_load_dwordx4 v[68:71], v1, s[4:7], s31 offen offset:1024
v_mfma_f32_16x16x32_bf16 a[32:35], v[72:75], v[200:203], a[32:35]
v_mfma_f32_16x16x32_bf16 a[36:39], v[72:75], v[204:207], a[36:39]
v_mfma_f32_16x16x32_bf16 a[40:43], v[72:75], v[208:211], a[40:43]
v_mfma_f32_16x16x32_bf16 a[44:47], v[72:75], v[212:215], a[44:47]
ds_read_b128 v[192:195], v6 offset:18432
buffer_load_dwordx4 v[72:75], v1, s[4:7], s32 offen offset:1024
v_mfma_f32_16x16x32_bf16 a[48:51], v[76:79], v[200:203], a[48:51]
v_mfma_f32_16x16x32_bf16 a[52:55], v[76:79], v[204:207], a[52:55]
v_mfma_f32_16x16x32_bf16 a[56:59], v[76:79], v[208:211], a[56:59]
v_mfma_f32_16x16x32_bf16 a[60:63], v[76:79], v[212:215], a[60:63]
ds_read_b128 v[196:199], v6 offset:43008
buffer_load_dwordx4 v[76:79], v1, s[4:7], s33 offen offset:1024
v_mfma_f32_16x16x32_bf16 a[64:67], v[80:83], v[200:203], a[64:67]
v_mfma_f32_16x16x32_bf16 a[68:71], v[80:83], v[204:207], a[68:71]
v_mfma_f32_16x16x32_bf16 a[72:75], v[80:83], v[208:211], a[72:75]
v_mfma_f32_16x16x32_bf16 a[76:79], v[80:83], v[212:215], a[76:79]
buffer_load_dwordx4 v[80:83], v1, s[4:7], s34 offen offset:1024
v_mfma_f32_16x16x32_bf16 a[80:83], v[84:87], v[200:203], a[80:83]
v_mfma_f32_16x16x32_bf16 a[84:87], v[84:87], v[204:207], a[84:87]
v_mfma_f32_16x16x32_bf16 a[88:91], v[84:87], v[208:211], a[88:91]
v_mfma_f32_16x16x32_bf16 a[92:95], v[84:87], v[212:215], a[92:95]
buffer_load_dwordx4 v[84:87], v1, s[4:7], s35 offen offset:1024
v_mfma_f32_16x16x32_bf16 a[96:99], v[88:91], v[200:203], a[96:99]
v_mfma_f32_16x16x32_bf16 a[100:103], v[88:91], v[204:207], a[100:103]
v_mfma_f32_16x16x32_bf16 a[104:107], v[88:91], v[208:211], a[104:107]
v_mfma_f32_16x16x32_bf16 a[108:111], v[88:91], v[212:215], a[108:111]
buffer_load_dwordx4 v[88:91], v1, s[4:7], s36 offen offset:1024
v_mfma_f32_16x16x32_bf16 a[112:115], v[92:95], v[200:203], a[112:115]
v_mfma_f32_16x16x32_bf16 a[116:119], v[92:95], v[204:207], a[116:119]
v_mfma_f32_16x16x32_bf16 a[120:123], v[92:95], v[208:211], a[120:123]
v_mfma_f32_16x16x32_bf16 a[124:127], v[92:95], v[212:215], a[124:127]
buffer_load_dwordx4 v[92:95], v1, s[4:7], s37 offen offset:1024
v_mfma_f32_16x16x32_bf16 a[128:131], v[96:99], v[200:203], a[128:131]
v_mfma_f32_16x16x32_bf16 a[132:135], v[96:99], v[204:207], a[132:135]
v_mfma_f32_16x16x32_bf16 a[136:139], v[96:99], v[208:211], a[136:139]
v_mfma_f32_16x16x32_bf16 a[140:143], v[96:99], v[212:215], a[140:143]
buffer_load_dwordx4 v[96:99], v1, s[4:7], s38 offen offset:1024
v_mfma_f32_16x16x32_bf16 a[144:147], v[100:103], v[200:203], a[144:147]
v_mfma_f32_16x16x32_bf16 a[148:151], v[100:103], v[204:207], a[148:151]
v_mfma_f32_16x16x32_bf16 a[152:155], v[100:103], v[208:211], a[152:155]
v_mfma_f32_16x16x32_bf16 a[156:159], v[100:103], v[212:215], a[156:159]
buffer_load_dwordx4 v[100:103], v1, s[4:7], s39 offen offset:1024
s_waitcnt vmcnt(30)
s_waitcnt lgkmcnt(0)
v_mfma_f32_16x16x32_bf16 a[0:3], v[104:107], v[184:187], a[0:3]
v_mfma_f32_16x16x32_bf16 a[4:7], v[104:107], v[188:191], a[4:7]
v_mfma_f32_16x16x32_bf16 a[8:11], v[104:107], v[192:195], a[8:11]
v_mfma_f32_16x16x32_bf16 a[12:15], v[104:107], v[196:199], a[12:15]
ds_read_b128 v[200:203], v1 offset:19456
buffer_load_dwordx4 v[104:107], v1, s[4:7], s30 offen offset:2048
v_mfma_f32_16x16x32_bf16 a[16:19], v[108:111], v[184:187], a[16:19]
v_mfma_f32_16x16x32_bf16 a[20:23], v[108:111], v[188:191], a[20:23]
v_mfma_f32_16x16x32_bf16 a[24:27], v[108:111], v[192:195], a[24:27]
v_mfma_f32_16x16x32_bf16 a[28:31], v[108:111], v[196:199], a[28:31]
ds_read_b128 v[204:207], v1 offset:44032
buffer_load_dwordx4 v[108:111], v1, s[4:7], s31 offen offset:2048
v_mfma_f32_16x16x32_bf16 a[32:35], v[112:115], v[184:187], a[32:35]
v_mfma_f32_16x16x32_bf16 a[36:39], v[112:115], v[188:191], a[36:39]
v_mfma_f32_16x16x32_bf16 a[40:43], v[112:115], v[192:195], a[40:43]
v_mfma_f32_16x16x32_bf16 a[44:47], v[112:115], v[196:199], a[44:47]
ds_read_b128 v[208:211], v6 offset:19456
buffer_load_dwordx4 v[112:115], v1, s[4:7], s32 offen offset:2048
v_mfma_f32_16x16x32_bf16 a[48:51], v[116:119], v[184:187], a[48:51]
v_mfma_f32_16x16x32_bf16 a[52:55], v[116:119], v[188:191], a[52:55]
v_mfma_f32_16x16x32_bf16 a[56:59], v[116:119], v[192:195], a[56:59]
v_mfma_f32_16x16x32_bf16 a[60:63], v[116:119], v[196:199], a[60:63]
ds_read_b128 v[212:215], v6 offset:44032
buffer_load_dwordx4 v[116:119], v1, s[4:7], s33 offen offset:2048
v_mfma_f32_16x16x32_bf16 a[64:67], v[120:123], v[184:187], a[64:67]
v_mfma_f32_16x16x32_bf16 a[68:71], v[120:123], v[188:191], a[68:71]
v_mfma_f32_16x16x32_bf16 a[72:75], v[120:123], v[192:195], a[72:75]
v_mfma_f32_16x16x32_bf16 a[76:79], v[120:123], v[196:199], a[76:79]
buffer_load_dwordx4 v[120:123], v1, s[4:7], s34 offen offset:2048
v_mfma_f32_16x16x32_bf16 a[80:83], v[124:127], v[184:187], a[80:83]
v_mfma_f32_16x16x32_bf16 a[84:87], v[124:127], v[188:191], a[84:87]
v_mfma_f32_16x16x32_bf16 a[88:91], v[124:127], v[192:195], a[88:91]
v_mfma_f32_16x16x32_bf16 a[92:95], v[124:127], v[196:199], a[92:95]
buffer_load_dwordx4 v[124:127], v1, s[4:7], s35 offen offset:2048
v_mfma_f32_16x16x32_bf16 a[96:99], v[128:131], v[184:187], a[96:99]
v_mfma_f32_16x16x32_bf16 a[100:103], v[128:131], v[188:191], a[100:103]
v_mfma_f32_16x16x32_bf16 a[104:107], v[128:131], v[192:195], a[104:107]
v_mfma_f32_16x16x32_bf16 a[108:111], v[128:131], v[196:199], a[108:111]
buffer_load_dwordx4 v[128:131], v1, s[4:7], s36 offen offset:2048
v_mfma_f32_16x16x32_bf16 a[112:115], v[132:135], v[184:187], a[112:115]
v_mfma_f32_16x16x32_bf16 a[116:119], v[132:135], v[188:191], a[116:119]
v_mfma_f32_16x16x32_bf16 a[120:123], v[132:135], v[192:195], a[120:123]
v_mfma_f32_16x16x32_bf16 a[124:127], v[132:135], v[196:199], a[124:127]
buffer_load_dwordx4 v[132:135], v1, s[4:7], s37 offen offset:2048
v_mfma_f32_16x16x32_bf16 a[128:131], v[136:139], v[184:187], a[128:131]
v_mfma_f32_16x16x32_bf16 a[132:135], v[136:139], v[188:191], a[132:135]
v_mfma_f32_16x16x32_bf16 a[136:139], v[136:139], v[192:195], a[136:139]
v_mfma_f32_16x16x32_bf16 a[140:143], v[136:139], v[196:199], a[140:143]
buffer_load_dwordx4 v[136:139], v1, s[4:7], s38 offen offset:2048
v_mfma_f32_16x16x32_bf16 a[144:147], v[140:143], v[184:187], a[144:147]
v_mfma_f32_16x16x32_bf16 a[148:151], v[140:143], v[188:191], a[148:151]
v_mfma_f32_16x16x32_bf16 a[152:155], v[140:143], v[192:195], a[152:155]
v_mfma_f32_16x16x32_bf16 a[156:159], v[140:143], v[196:199], a[156:159]
buffer_load_dwordx4 v[140:143], v1, s[4:7], s39 offen offset:2048
s_waitcnt vmcnt(30)
s_waitcnt lgkmcnt(0)
v_mfma_f32_16x16x32_bf16 a[0:3], v[144:147], v[200:203], a[0:3]
v_mfma_f32_16x16x32_bf16 a[4:7], v[144:147], v[204:207], a[4:7]
v_mfma_f32_16x16x32_bf16 a[8:11], v[144:147], v[208:211], a[8:11]
v_mfma_f32_16x16x32_bf16 a[12:15], v[144:147], v[212:215], a[12:15]
ds_read_b128 v[184:187], v1 offset:20480
buffer_load_dwordx4 v[144:147], v1, s[4:7], s30 offen offset:3072
s_add_u32 s30, s30, 4096
v_mfma_f32_16x16x32_bf16 a[16:19], v[148:151], v[200:203], a[16:19]
v_mfma_f32_16x16x32_bf16 a[20:23], v[148:151], v[204:207], a[20:23]
v_mfma_f32_16x16x32_bf16 a[24:27], v[148:151], v[208:211], a[24:27]
v_mfma_f32_16x16x32_bf16 a[28:31], v[148:151], v[212:215], a[28:31]
ds_read_b128 v[188:191], v1 offset:45056
buffer_load_dwordx4 v[148:151], v1, s[4:7], s31 offen offset:3072
s_add_u32 s31, s31, 4096
v_mfma_f32_16x16x32_bf16 a[32:35], v[152:155], v[200:203], a[32:35]
v_mfma_f32_16x16x32_bf16 a[36:39], v[152:155], v[204:207], a[36:39]
v_mfma_f32_16x16x32_bf16 a[40:43], v[152:155], v[208:211], a[40:43]
v_mfma_f32_16x16x32_bf16 a[44:47], v[152:155], v[212:215], a[44:47]
ds_read_b128 v[192:195], v6 offset:20480
buffer_load_dwordx4 v[152:155], v1, s[4:7], s32 offen offset:3072
s_add_u32 s32, s32, 4096
v_mfma_f32_16x16x32_bf16 a[48:51], v[156:159], v[200:203], a[48:51]
v_mfma_f32_16x16x32_bf16 a[52:55], v[156:159], v[204:207], a[52:55]
v_mfma_f32_16x16x32_bf16 a[56:59], v[156:159], v[208:211], a[56:59]
v_mfma_f32_16x16x32_bf16 a[60:63], v[156:159], v[212:215], a[60:63]
ds_read_b128 v[196:199], v6 offset:45056
buffer_load_dwordx4 v[156:159], v1, s[4:7], s33 offen offset:3072
s_add_u32 s33, s33, 4096
v_mfma_f32_16x16x32_bf16 a[64:67], v[160:163], v[200:203], a[64:67]
v_mfma_f32_16x16x32_bf16 a[68:71], v[160:163], v[204:207], a[68:71]
v_mfma_f32_16x16x32_bf16 a[72:75], v[160:163], v[208:211], a[72:75]
v_mfma_f32_16x16x32_bf16 a[76:79], v[160:163], v[212:215], a[76:79]
buffer_load_dwordx4 v[160:163], v1, s[4:7], s34 offen offset:3072
s_add_u32 s34, s34, 4096
v_mfma_f32_16x16x32_bf16 a[80:83], v[164:167], v[200:203], a[80:83]
v_mfma_f32_16x16x32_bf16 a[84:87], v[164:167], v[204:207], a[84:87]
v_mfma_f32_16x16x32_bf16 a[88:91], v[164:167], v[208:211], a[88:91]
v_mfma_f32_16x16x32_bf16 a[92:95], v[164:167], v[212:215], a[92:95]
buffer_load_dwordx4 v[164:167], v1, s[4:7], s35 offen offset:3072
s_add_u32 s35, s35, 4096
v_mfma_f32_16x16x32_bf16 a[96:99], v[168:171], v[200:203], a[96:99]
v_mfma_f32_16x16x32_bf16 a[100:103], v[168:171], v[204:207], a[100:103]
v_mfma_f32_16x16x32_bf16 a[104:107], v[168:171], v[208:211], a[104:107]
v_mfma_f32_16x16x32_bf16 a[108:111], v[168:171], v[212:215], a[108:111]
buffer_load_dwordx4 v[168:171], v1, s[4:7], s36 offen offset:3072
s_add_u32 s36, s36, 4096
v_mfma_f32_16x16x32_bf16 a[112:115], v[172:175], v[200:203], a[112:115]
v_mfma_f32_16x16x32_bf16 a[116:119], v[172:175], v[204:207], a[116:119]
v_mfma_f32_16x16x32_bf16 a[120:123], v[172:175], v[208:211], a[120:123]
v_mfma_f32_16x16x32_bf16 a[124:127], v[172:175], v[212:215], a[124:127]
buffer_load_dwordx4 v[172:175], v1, s[4:7], s37 offen offset:3072
s_add_u32 s37, s37, 4096
v_mfma_f32_16x16x32_bf16 a[128:131], v[176:179], v[200:203], a[128:131]
v_mfma_f32_16x16x32_bf16 a[132:135], v[176:179], v[204:207], a[132:135]
v_mfma_f32_16x16x32_bf16 a[136:139], v[176:179], v[208:211], a[136:139]
v_mfma_f32_16x16x32_bf16 a[140:143], v[176:179], v[212:215], a[140:143]
buffer_load_dwordx4 v[176:179], v1, s[4:7], s38 offen offset:3072
s_add_u32 s38, s38, 4096
v_mfma_f32_16x16x32_bf16 a[144:147], v[180:183], v[200:203], a[144:147]
v_mfma_f32_16x16x32_bf16 a[148:151], v[180:183], v[204:207], a[148:151]
v_mfma_f32_16x16x32_bf16 a[152:155], v[180:183], v[208:211], a[152:155]
v_mfma_f32_16x16x32_bf16 a[156:159], v[180:183], v[212:215], a[156:159]
buffer_load_dwordx4 v[180:183], v1, s[4:7], s39 offen offset:3072
s_add_u32 s39, s39, 4096
s_waitcnt vmcnt(30)
s_waitcnt lgkmcnt(0)
v_mfma_f32_16x16x32_bf16 a[0:3], v[24:27], v[184:187], a[0:3]
v_mfma_f32_16x16x32_bf16 a[4:7], v[24:27], v[188:191], a[4:7]
v_mfma_f32_16x16x32_bf16 a[8:11], v[24:27], v[192:195], a[8:11]
v_mfma_f32_16x16x32_bf16 a[12:15], v[24:27], v[196:199], a[12:15]
ds_read_b128 v[200:203], v1 offset:21504
v_mfma_f32_16x16x32_bf16 a[16:19], v[28:31], v[184:187], a[16:19]
v_mfma_f32_16x16x32_bf16 a[20:23], v[28:31], v[188:191], a[20:23]
v_mfma_f32_16x16x32_bf16 a[24:27], v[28:31], v[192:195], a[24:27]
v_mfma_f32_16x16x32_bf16 a[28:31], v[28:31], v[196:199], a[28:31]
ds_read_b128 v[204:207], v1 offset:46080
v_mfma_f32_16x16x32_bf16 a[32:35], v[32:35], v[184:187], a[32:35]
v_mfma_f32_16x16x32_bf16 a[36:39], v[32:35], v[188:191], a[36:39]
v_mfma_f32_16x16x32_bf16 a[40:43], v[32:35], v[192:195], a[40:43]
v_mfma_f32_16x16x32_bf16 a[44:47], v[32:35], v[196:199], a[44:47]
ds_read_b128 v[208:211], v6 offset:21504
v_mfma_f32_16x16x32_bf16 a[48:51], v[36:39], v[184:187], a[48:51]
v_mfma_f32_16x16x32_bf16 a[52:55], v[36:39], v[188:191], a[52:55]
v_mfma_f32_16x16x32_bf16 a[56:59], v[36:39], v[192:195], a[56:59]
v_mfma_f32_16x16x32_bf16 a[60:63], v[36:39], v[196:199], a[60:63]
ds_read_b128 v[212:215], v6 offset:46080
v_mfma_f32_16x16x32_bf16 a[64:67], v[40:43], v[184:187], a[64:67]
v_mfma_f32_16x16x32_bf16 a[68:71], v[40:43], v[188:191], a[68:71]
v_mfma_f32_16x16x32_bf16 a[72:75], v[40:43], v[192:195], a[72:75]
v_mfma_f32_16x16x32_bf16 a[76:79], v[40:43], v[196:199], a[76:79]
v_mfma_f32_16x16x32_bf16 a[80:83], v[44:47], v[184:187], a[80:83]
v_mfma_f32_16x16x32_bf16 a[84:87], v[44:47], v[188:191], a[84:87]
v_mfma_f32_16x16x32_bf16 a[88:91], v[44:47], v[192:195], a[88:91]
v_mfma_f32_16x16x32_bf16 a[92:95], v[44:47], v[196:199], a[92:95]
v_mfma_f32_16x16x32_bf16 a[96:99], v[48:51], v[184:187], a[96:99]
v_mfma_f32_16x16x32_bf16 a[100:103], v[48:51], v[188:191], a[100:103]
v_mfma_f32_16x16x32_bf16 a[104:107], v[48:51], v[192:195], a[104:107]
v_mfma_f32_16x16x32_bf16 a[108:111], v[48:51], v[196:199], a[108:111]
v_mfma_f32_16x16x32_bf16 a[112:115], v[52:55], v[184:187], a[112:115]
v_mfma_f32_16x16x32_bf16 a[116:119], v[52:55], v[188:191], a[116:119]
v_mfma_f32_16x16x32_bf16 a[120:123], v[52:55], v[192:195], a[120:123]
v_mfma_f32_16x16x32_bf16 a[124:127], v[52:55], v[196:199], a[124:127]
v_mfma_f32_16x16x32_bf16 a[128:131], v[56:59], v[184:187], a[128:131]
v_mfma_f32_16x16x32_bf16 a[132:135], v[56:59], v[188:191], a[132:135]
v_mfma_f32_16x16x32_bf16 a[136:139], v[56:59], v[192:195], a[136:139]
v_mfma_f32_16x16x32_bf16 a[140:143], v[56:59], v[196:199], a[140:143]
v_mfma_f32_16x16x32_bf16 a[144:147], v[60:63], v[184:187], a[144:147]
v_mfma_f32_16x16x32_bf16 a[148:151], v[60:63], v[188:191], a[148:151]
v_mfma_f32_16x16x32_bf16 a[152:155], v[60:63], v[192:195], a[152:155]
v_mfma_f32_16x16x32_bf16 a[156:159], v[60:63], v[196:199], a[156:159]
s_waitcnt vmcnt(20)
s_waitcnt lgkmcnt(0)
v_mfma_f32_16x16x32_bf16 a[0:3], v[64:67], v[200:203], a[0:3]
v_mfma_f32_16x16x32_bf16 a[4:7], v[64:67], v[204:207], a[4:7]
v_mfma_f32_16x16x32_bf16 a[8:11], v[64:67], v[208:211], a[8:11]
v_mfma_f32_16x16x32_bf16 a[12:15], v[64:67], v[212:215], a[12:15]
ds_read_b128 v[184:187], v1 offset:22528
v_mfma_f32_16x16x32_bf16 a[16:19], v[68:71], v[200:203], a[16:19]
v_mfma_f32_16x16x32_bf16 a[20:23], v[68:71], v[204:207], a[20:23]
v_mfma_f32_16x16x32_bf16 a[24:27], v[68:71], v[208:211], a[24:27]
v_mfma_f32_16x16x32_bf16 a[28:31], v[68:71], v[212:215], a[28:31]
ds_read_b128 v[188:191], v1 offset:47104
v_mfma_f32_16x16x32_bf16 a[32:35], v[72:75], v[200:203], a[32:35]
v_mfma_f32_16x16x32_bf16 a[36:39], v[72:75], v[204:207], a[36:39]
v_mfma_f32_16x16x32_bf16 a[40:43], v[72:75], v[208:211], a[40:43]
v_mfma_f32_16x16x32_bf16 a[44:47], v[72:75], v[212:215], a[44:47]
ds_read_b128 v[192:195], v6 offset:22528
v_mfma_f32_16x16x32_bf16 a[48:51], v[76:79], v[200:203], a[48:51]
v_mfma_f32_16x16x32_bf16 a[52:55], v[76:79], v[204:207], a[52:55]
v_mfma_f32_16x16x32_bf16 a[56:59], v[76:79], v[208:211], a[56:59]
v_mfma_f32_16x16x32_bf16 a[60:63], v[76:79], v[212:215], a[60:63]
ds_read_b128 v[196:199], v6 offset:47104
v_mfma_f32_16x16x32_bf16 a[64:67], v[80:83], v[200:203], a[64:67]
v_mfma_f32_16x16x32_bf16 a[68:71], v[80:83], v[204:207], a[68:71]
v_mfma_f32_16x16x32_bf16 a[72:75], v[80:83], v[208:211], a[72:75]
v_mfma_f32_16x16x32_bf16 a[76:79], v[80:83], v[212:215], a[76:79]
v_mfma_f32_16x16x32_bf16 a[80:83], v[84:87], v[200:203], a[80:83]
v_mfma_f32_16x16x32_bf16 a[84:87], v[84:87], v[204:207], a[84:87]
v_mfma_f32_16x16x32_bf16 a[88:91], v[84:87], v[208:211], a[88:91]
v_mfma_f32_16x16x32_bf16 a[92:95], v[84:87], v[212:215], a[92:95]
v_mfma_f32_16x16x32_bf16 a[96:99], v[88:91], v[200:203], a[96:99]
v_mfma_f32_16x16x32_bf16 a[100:103], v[88:91], v[204:207], a[100:103]
v_mfma_f32_16x16x32_bf16 a[104:107], v[88:91], v[208:211], a[104:107]
v_mfma_f32_16x16x32_bf16 a[108:111], v[88:91], v[212:215], a[108:111]
v_mfma_f32_16x16x32_bf16 a[112:115], v[92:95], v[200:203], a[112:115]
v_mfma_f32_16x16x32_bf16 a[116:119], v[92:95], v[204:207], a[116:119]
v_mfma_f32_16x16x32_bf16 a[120:123], v[92:95], v[208:211], a[120:123]
v_mfma_f32_16x16x32_bf16 a[124:127], v[92:95], v[212:215], a[124:127]
v_mfma_f32_16x16x32_bf16 a[128:131], v[96:99], v[200:203], a[128:131]
v_mfma_f32_16x16x32_bf16 a[132:135], v[96:99], v[204:207], a[132:135]
v_mfma_f32_16x16x32_bf16 a[136:139], v[96:99], v[208:211], a[136:139]
v_mfma_f32_16x16x32_bf16 a[140:143], v[96:99], v[212:215], a[140:143]
v_mfma_f32_16x16x32_bf16 a[144:147], v[100:103], v[200:203], a[144:147]
v_mfma_f32_16x16x32_bf16 a[148:151], v[100:103], v[204:207], a[148:151]
v_mfma_f32_16x16x32_bf16 a[152:155], v[100:103], v[208:211], a[152:155]
v_mfma_f32_16x16x32_bf16 a[156:159], v[100:103], v[212:215], a[156:159]
s_waitcnt vmcnt(10)
s_waitcnt lgkmcnt(0)
v_mfma_f32_16x16x32_bf16 a[0:3], v[104:107], v[184:187], a[0:3]
v_mfma_f32_16x16x32_bf16 a[4:7], v[104:107], v[188:191], a[4:7]
v_mfma_f32_16x16x32_bf16 a[8:11], v[104:107], v[192:195], a[8:11]
v_mfma_f32_16x16x32_bf16 a[12:15], v[104:107], v[196:199], a[12:15]
ds_read_b128 v[200:203], v1 offset:23552
v_mfma_f32_16x16x32_bf16 a[16:19], v[108:111], v[184:187], a[16:19]
v_mfma_f32_16x16x32_bf16 a[20:23], v[108:111], v[188:191], a[20:23]
v_mfma_f32_16x16x32_bf16 a[24:27], v[108:111], v[192:195], a[24:27]
v_mfma_f32_16x16x32_bf16 a[28:31], v[108:111], v[196:199], a[28:31]
ds_read_b128 v[204:207], v1 offset:48128
v_mfma_f32_16x16x32_bf16 a[32:35], v[112:115], v[184:187], a[32:35]
v_mfma_f32_16x16x32_bf16 a[36:39], v[112:115], v[188:191], a[36:39]
v_mfma_f32_16x16x32_bf16 a[40:43], v[112:115], v[192:195], a[40:43]
v_mfma_f32_16x16x32_bf16 a[44:47], v[112:115], v[196:199], a[44:47]
ds_read_b128 v[208:211], v6 offset:23552
v_mfma_f32_16x16x32_bf16 a[48:51], v[116:119], v[184:187], a[48:51]
v_mfma_f32_16x16x32_bf16 a[52:55], v[116:119], v[188:191], a[52:55]
v_mfma_f32_16x16x32_bf16 a[56:59], v[116:119], v[192:195], a[56:59]
v_mfma_f32_16x16x32_bf16 a[60:63], v[116:119], v[196:199], a[60:63]
ds_read_b128 v[212:215], v6 offset:48128
v_mfma_f32_16x16x32_bf16 a[64:67], v[120:123], v[184:187], a[64:67]
v_mfma_f32_16x16x32_bf16 a[68:71], v[120:123], v[188:191], a[68:71]
v_mfma_f32_16x16x32_bf16 a[72:75], v[120:123], v[192:195], a[72:75]
v_mfma_f32_16x16x32_bf16 a[76:79], v[120:123], v[196:199], a[76:79]
v_mfma_f32_16x16x32_bf16 a[80:83], v[124:127], v[184:187], a[80:83]
v_mfma_f32_16x16x32_bf16 a[84:87], v[124:127], v[188:191], a[84:87]
v_mfma_f32_16x16x32_bf16 a[88:91], v[124:127], v[192:195], a[88:91]
v_mfma_f32_16x16x32_bf16 a[92:95], v[124:127], v[196:199], a[92:95]
v_mfma_f32_16x16x32_bf16 a[96:99], v[128:131], v[184:187], a[96:99]
v_mfma_f32_16x16x32_bf16 a[100:103], v[128:131], v[188:191], a[100:103]
v_mfma_f32_16x16x32_bf16 a[104:107], v[128:131], v[192:195], a[104:107]
v_mfma_f32_16x16x32_bf16 a[108:111], v[128:131], v[196:199], a[108:111]
v_mfma_f32_16x16x32_bf16 a[112:115], v[132:135], v[184:187], a[112:115]
v_mfma_f32_16x16x32_bf16 a[116:119], v[132:135], v[188:191], a[116:119]
v_mfma_f32_16x16x32_bf16 a[120:123], v[132:135], v[192:195], a[120:123]
v_mfma_f32_16x16x32_bf16 a[124:127], v[132:135], v[196:199], a[124:127]
v_mfma_f32_16x16x32_bf16 a[128:131], v[136:139], v[184:187], a[128:131]
v_mfma_f32_16x16x32_bf16 a[132:135], v[136:139], v[188:191], a[132:135]
v_mfma_f32_16x16x32_bf16 a[136:139], v[136:139], v[192:195], a[136:139]
v_mfma_f32_16x16x32_bf16 a[140:143], v[136:139], v[196:199], a[140:143]
v_mfma_f32_16x16x32_bf16 a[144:147], v[140:143], v[184:187], a[144:147]
v_mfma_f32_16x16x32_bf16 a[148:151], v[140:143], v[188:191], a[148:151]
v_mfma_f32_16x16x32_bf16 a[152:155], v[140:143], v[192:195], a[152:155]
v_mfma_f32_16x16x32_bf16 a[156:159], v[140:143], v[196:199], a[156:159]
s_waitcnt vmcnt(0)
s_waitcnt lgkmcnt(0)
v_mfma_f32_16x16x32_bf16 a[0:3], v[144:147], v[200:203], a[0:3]
v_mfma_f32_16x16x32_bf16 a[4:7], v[144:147], v[204:207], a[4:7]
v_mfma_f32_16x16x32_bf16 a[8:11], v[144:147], v[208:211], a[8:11]
v_mfma_f32_16x16x32_bf16 a[12:15], v[144:147], v[212:215], a[12:15]
v_mfma_f32_16x16x32_bf16 a[16:19], v[148:151], v[200:203], a[16:19]
v_mfma_f32_16x16x32_bf16 a[20:23], v[148:151], v[204:207], a[20:23]
v_mfma_f32_16x16x32_bf16 a[24:27], v[148:151], v[208:211], a[24:27]
v_mfma_f32_16x16x32_bf16 a[28:31], v[148:151], v[212:215], a[28:31]
v_mfma_f32_16x16x32_bf16 a[32:35], v[152:155], v[200:203], a[32:35]
v_mfma_f32_16x16x32_bf16 a[36:39], v[152:155], v[204:207], a[36:39]
v_mfma_f32_16x16x32_bf16 a[40:43], v[152:155], v[208:211], a[40:43]
v_mfma_f32_16x16x32_bf16 a[44:47], v[152:155], v[212:215], a[44:47]
v_mfma_f32_16x16x32_bf16 a[48:51], v[156:159], v[200:203], a[48:51]
v_mfma_f32_16x16x32_bf16 a[52:55], v[156:159], v[204:207], a[52:55]
v_mfma_f32_16x16x32_bf16 a[56:59], v[156:159], v[208:211], a[56:59]
v_mfma_f32_16x16x32_bf16 a[60:63], v[156:159], v[212:215], a[60:63]
v_mfma_f32_16x16x32_bf16 a[64:67], v[160:163], v[200:203], a[64:67]
v_mfma_f32_16x16x32_bf16 a[68:71], v[160:163], v[204:207], a[68:71]
v_mfma_f32_16x16x32_bf16 a[72:75], v[160:163], v[208:211], a[72:75]
v_mfma_f32_16x16x32_bf16 a[76:79], v[160:163], v[212:215], a[76:79]
v_mfma_f32_16x16x32_bf16 a[80:83], v[164:167], v[200:203], a[80:83]
v_mfma_f32_16x16x32_bf16 a[84:87], v[164:167], v[204:207], a[84:87]
v_mfma_f32_16x16x32_bf16 a[88:91], v[164:167], v[208:211], a[88:91]
v_mfma_f32_16x16x32_bf16 a[92:95], v[164:167], v[212:215], a[92:95]
v_mfma_f32_16x16x32_bf16 a[96:99], v[168:171], v[200:203], a[96:99]
v_mfma_f32_16x16x32_bf16 a[100:103], v[168:171], v[204:207], a[100:103]
v_mfma_f32_16x16x32_bf16 a[104:107], v[168:171], v[208:211], a[104:107]
v_mfma_f32_16x16x32_bf16 a[108:111], v[168:171], v[212:215], a[108:111]
v_mfma_f32_16x16x32_bf16 a[112:115], v[172:175], v[200:203], a[112:115]
v_mfma_f32_16x16x32_bf16 a[116:119], v[172:175], v[204:207], a[116:119]
v_mfma_f32_16x16x32_bf16 a[120:123], v[172:175], v[208:211], a[120:123]
v_mfma_f32_16x16x32_bf16 a[124:127], v[172:175], v[212:215], a[124:127]
v_mfma_f32_16x16x32_bf16 a[128:131], v[176:179], v[200:203], a[128:131]
v_mfma_f32_16x16x32_bf16 a[132:135], v[176:179], v[204:207], a[132:135]
v_mfma_f32_16x16x32_bf16 a[136:139], v[176:179], v[208:211], a[136:139]
v_mfma_f32_16x16x32_bf16 a[140:143], v[176:179], v[212:215], a[140:143]
v_mfma_f32_16x16x32_bf16 a[144:147], v[180:183], v[200:203], a[144:147]
v_mfma_f32_16x16x32_bf16 a[148:151], v[180:183], v[204:207], a[148:151]
v_mfma_f32_16x16x32_bf16 a[152:155], v[180:183], v[208:211], a[152:155]
v_mfma_f32_16x16x32_bf16 a[156:159], v[180:183], v[212:215], a[156:159]
fin_store4:
s_lshl_b32 s16, s13, 7
s_lshl_b32 s17, s14, 2
s_add_u32 s16, s16, s17
s_mul_i32 s16, s16, 20
s_mul_i32 s17, s12, 5
s_add_u32 s16, s16, s17
s_lshl_b32 s16, s16, 10
s_add_u32 s16, s16, 90832896
s_nop 7
s_add_u32 s17, s16, 0
v_accvgpr_read_b32 v24, a0
v_accvgpr_read_b32 v25, a1
v_accvgpr_read_b32 v26, a2
v_accvgpr_read_b32 v27, a3
v_accvgpr_read_b32 v28, a16
v_accvgpr_read_b32 v29, a17
v_accvgpr_read_b32 v30, a18
v_accvgpr_read_b32 v31, a19
v_cvt_pk_bf16_f32 v32, v24, v25
v_cvt_pk_bf16_f32 v33, v26, v27
v_cvt_pk_bf16_f32 v34, v28, v29
v_cvt_pk_bf16_f32 v35, v30, v31
buffer_store_dwordx4 v[32:35], v1, s[4:7], s17 offen offset:0 sc1
v_accvgpr_read_b32 v36, a32
v_accvgpr_read_b32 v37, a33
v_accvgpr_read_b32 v38, a34
v_accvgpr_read_b32 v39, a35
v_accvgpr_read_b32 v40, a48
v_accvgpr_read_b32 v41, a49
v_accvgpr_read_b32 v42, a50
v_accvgpr_read_b32 v43, a51
v_cvt_pk_bf16_f32 v44, v36, v37
v_cvt_pk_bf16_f32 v45, v38, v39
v_cvt_pk_bf16_f32 v46, v40, v41
v_cvt_pk_bf16_f32 v47, v42, v43
buffer_store_dwordx4 v[44:47], v1, s[4:7], s17 offen offset:1024 sc1
v_accvgpr_read_b32 v48, a64
v_accvgpr_read_b32 v49, a65
v_accvgpr_read_b32 v50, a66
v_accvgpr_read_b32 v51, a67
v_accvgpr_read_b32 v52, a80
v_accvgpr_read_b32 v53, a81
v_accvgpr_read_b32 v54, a82
v_accvgpr_read_b32 v55, a83
v_cvt_pk_bf16_f32 v56, v48, v49
v_cvt_pk_bf16_f32 v57, v50, v51
v_cvt_pk_bf16_f32 v58, v52, v53
v_cvt_pk_bf16_f32 v59, v54, v55
buffer_store_dwordx4 v[56:59], v1, s[4:7], s17 offen offset:2048 sc1
v_accvgpr_read_b32 v60, a96
v_accvgpr_read_b32 v61, a97
v_accvgpr_read_b32 v62, a98
v_accvgpr_read_b32 v63, a99
v_accvgpr_read_b32 v64, a112
v_accvgpr_read_b32 v65, a113
v_accvgpr_read_b32 v66, a114
v_accvgpr_read_b32 v67, a115
v_cvt_pk_bf16_f32 v68, v60, v61
v_cvt_pk_bf16_f32 v69, v62, v63
v_cvt_pk_bf16_f32 v70, v64, v65
v_cvt_pk_bf16_f32 v71, v66, v67
buffer_store_dwordx4 v[68:71], v1, s[4:7], s17 offen offset:3072 sc1
v_accvgpr_read_b32 v24, a128
v_accvgpr_read_b32 v25, a129
v_accvgpr_read_b32 v26, a130
v_accvgpr_read_b32 v27, a131
v_accvgpr_read_b32 v28, a144
v_accvgpr_read_b32 v29, a145
v_accvgpr_read_b32 v30, a146
v_accvgpr_read_b32 v31, a147
v_cvt_pk_bf16_f32 v32, v24, v25
v_cvt_pk_bf16_f32 v33, v26, v27
v_cvt_pk_bf16_f32 v34, v28, v29
v_cvt_pk_bf16_f32 v35, v30, v31
s_add_u32 s17, s17, 4096
buffer_store_dwordx4 v[32:35], v1, s[4:7], s17 offen offset:0 sc1
s_add_u32 s17, s16, 20480
v_accvgpr_read_b32 v36, a4
v_accvgpr_read_b32 v37, a5
v_accvgpr_read_b32 v38, a6
v_accvgpr_read_b32 v39, a7
v_accvgpr_read_b32 v40, a20
v_accvgpr_read_b32 v41, a21
v_accvgpr_read_b32 v42, a22
v_accvgpr_read_b32 v43, a23
v_cvt_pk_bf16_f32 v44, v36, v37
v_cvt_pk_bf16_f32 v45, v38, v39
v_cvt_pk_bf16_f32 v46, v40, v41
v_cvt_pk_bf16_f32 v47, v42, v43
buffer_store_dwordx4 v[44:47], v1, s[4:7], s17 offen offset:0 sc1
v_accvgpr_read_b32 v48, a36
v_accvgpr_read_b32 v49, a37
v_accvgpr_read_b32 v50, a38
v_accvgpr_read_b32 v51, a39
v_accvgpr_read_b32 v52, a52
v_accvgpr_read_b32 v53, a53
v_accvgpr_read_b32 v54, a54
v_accvgpr_read_b32 v55, a55
v_cvt_pk_bf16_f32 v56, v48, v49
v_cvt_pk_bf16_f32 v57, v50, v51
v_cvt_pk_bf16_f32 v58, v52, v53
v_cvt_pk_bf16_f32 v59, v54, v55
buffer_store_dwordx4 v[56:59], v1, s[4:7], s17 offen offset:1024 sc1
v_accvgpr_read_b32 v60, a68
v_accvgpr_read_b32 v61, a69
v_accvgpr_read_b32 v62, a70
v_accvgpr_read_b32 v63, a71
v_accvgpr_read_b32 v64, a84
v_accvgpr_read_b32 v65, a85
v_accvgpr_read_b32 v66, a86
v_accvgpr_read_b32 v67, a87
v_cvt_pk_bf16_f32 v68, v60, v61
v_cvt_pk_bf16_f32 v69, v62, v63
v_cvt_pk_bf16_f32 v70, v64, v65
v_cvt_pk_bf16_f32 v71, v66, v67
buffer_store_dwordx4 v[68:71], v1, s[4:7], s17 offen offset:2048 sc1
v_accvgpr_read_b32 v24, a100
v_accvgpr_read_b32 v25, a101
v_accvgpr_read_b32 v26, a102
v_accvgpr_read_b32 v27, a103
v_accvgpr_read_b32 v28, a116
v_accvgpr_read_b32 v29, a117
v_accvgpr_read_b32 v30, a118
v_accvgpr_read_b32 v31, a119
v_cvt_pk_bf16_f32 v32, v24, v25
v_cvt_pk_bf16_f32 v33, v26, v27
v_cvt_pk_bf16_f32 v34, v28, v29
v_cvt_pk_bf16_f32 v35, v30, v31
buffer_store_dwordx4 v[32:35], v1, s[4:7], s17 offen offset:3072 sc1
v_accvgpr_read_b32 v36, a132
v_accvgpr_read_b32 v37, a133
v_accvgpr_read_b32 v38, a134
v_accvgpr_read_b32 v39, a135
v_accvgpr_read_b32 v40, a148
v_accvgpr_read_b32 v41, a149
v_accvgpr_read_b32 v42, a150
v_accvgpr_read_b32 v43, a151
v_cvt_pk_bf16_f32 v44, v36, v37
v_cvt_pk_bf16_f32 v45, v38, v39
v_cvt_pk_bf16_f32 v46, v40, v41
v_cvt_pk_bf16_f32 v47, v42, v43
s_add_u32 s17, s17, 4096
buffer_store_dwordx4 v[44:47], v1, s[4:7], s17 offen offset:0 sc1
s_add_u32 s17, s16, 40960
v_accvgpr_read_b32 v48, a8
v_accvgpr_read_b32 v49, a9
v_accvgpr_read_b32 v50, a10
v_accvgpr_read_b32 v51, a11
v_accvgpr_read_b32 v52, a24
v_accvgpr_read_b32 v53, a25
v_accvgpr_read_b32 v54, a26
v_accvgpr_read_b32 v55, a27
v_cvt_pk_bf16_f32 v56, v48, v49
v_cvt_pk_bf16_f32 v57, v50, v51
v_cvt_pk_bf16_f32 v58, v52, v53
v_cvt_pk_bf16_f32 v59, v54, v55
buffer_store_dwordx4 v[56:59], v1, s[4:7], s17 offen offset:0 sc1
v_accvgpr_read_b32 v60, a40
v_accvgpr_read_b32 v61, a41
v_accvgpr_read_b32 v62, a42
v_accvgpr_read_b32 v63, a43
v_accvgpr_read_b32 v64, a56
v_accvgpr_read_b32 v65, a57
v_accvgpr_read_b32 v66, a58
v_accvgpr_read_b32 v67, a59
v_cvt_pk_bf16_f32 v68, v60, v61
v_cvt_pk_bf16_f32 v69, v62, v63
v_cvt_pk_bf16_f32 v70, v64, v65
v_cvt_pk_bf16_f32 v71, v66, v67
buffer_store_dwordx4 v[68:71], v1, s[4:7], s17 offen offset:1024 sc1
v_accvgpr_read_b32 v24, a72
v_accvgpr_read_b32 v25, a73
v_accvgpr_read_b32 v26, a74
v_accvgpr_read_b32 v27, a75
v_accvgpr_read_b32 v28, a88
v_accvgpr_read_b32 v29, a89
v_accvgpr_read_b32 v30, a90
v_accvgpr_read_b32 v31, a91
v_cvt_pk_bf16_f32 v32, v24, v25
v_cvt_pk_bf16_f32 v33, v26, v27
v_cvt_pk_bf16_f32 v34, v28, v29
v_cvt_pk_bf16_f32 v35, v30, v31
buffer_store_dwordx4 v[32:35], v1, s[4:7], s17 offen offset:2048 sc1
v_accvgpr_read_b32 v36, a104
v_accvgpr_read_b32 v37, a105
v_accvgpr_read_b32 v38, a106
v_accvgpr_read_b32 v39, a107
v_accvgpr_read_b32 v40, a120
v_accvgpr_read_b32 v41, a121
v_accvgpr_read_b32 v42, a122
v_accvgpr_read_b32 v43, a123
v_cvt_pk_bf16_f32 v44, v36, v37
v_cvt_pk_bf16_f32 v45, v38, v39
v_cvt_pk_bf16_f32 v46, v40, v41
v_cvt_pk_bf16_f32 v47, v42, v43
buffer_store_dwordx4 v[44:47], v1, s[4:7], s17 offen offset:3072 sc1
v_accvgpr_read_b32 v48, a136
v_accvgpr_read_b32 v49, a137
v_accvgpr_read_b32 v50, a138
v_accvgpr_read_b32 v51, a139
v_accvgpr_read_b32 v52, a152
v_accvgpr_read_b32 v53, a153
v_accvgpr_read_b32 v54, a154
v_accvgpr_read_b32 v55, a155
v_cvt_pk_bf16_f32 v56, v48, v49
v_cvt_pk_bf16_f32 v57, v50, v51
v_cvt_pk_bf16_f32 v58, v52, v53
v_cvt_pk_bf16_f32 v59, v54, v55
s_add_u32 s17, s17, 4096
buffer_store_dwordx4 v[56:59], v1, s[4:7], s17 offen offset:0 sc1
s_add_u32 s17, s16, 61440
v_accvgpr_read_b32 v60, a12
v_accvgpr_read_b32 v61, a13
v_accvgpr_read_b32 v62, a14
v_accvgpr_read_b32 v63, a15
v_accvgpr_read_b32 v64, a28
v_accvgpr_read_b32 v65, a29
v_accvgpr_read_b32 v66, a30
v_accvgpr_read_b32 v67, a31
v_cvt_pk_bf16_f32 v68, v60, v61
v_cvt_pk_bf16_f32 v69, v62, v63
v_cvt_pk_bf16_f32 v70, v64, v65
v_cvt_pk_bf16_f32 v71, v66, v67
buffer_store_dwordx4 v[68:71], v1, s[4:7], s17 offen offset:0 sc1
v_accvgpr_read_b32 v24, a44
v_accvgpr_read_b32 v25, a45
v_accvgpr_read_b32 v26, a46
v_accvgpr_read_b32 v27, a47
v_accvgpr_read_b32 v28, a60
v_accvgpr_read_b32 v29, a61
v_accvgpr_read_b32 v30, a62
v_accvgpr_read_b32 v31, a63
v_cvt_pk_bf16_f32 v32, v24, v25
v_cvt_pk_bf16_f32 v33, v26, v27
v_cvt_pk_bf16_f32 v34, v28, v29
v_cvt_pk_bf16_f32 v35, v30, v31
buffer_store_dwordx4 v[32:35], v1, s[4:7], s17 offen offset:1024 sc1
v_accvgpr_read_b32 v36, a76
v_accvgpr_read_b32 v37, a77
v_accvgpr_read_b32 v38, a78
v_accvgpr_read_b32 v39, a79
v_accvgpr_read_b32 v40, a92
v_accvgpr_read_b32 v41, a93
v_accvgpr_read_b32 v42, a94
v_accvgpr_read_b32 v43, a95
v_cvt_pk_bf16_f32 v44, v36, v37
v_cvt_pk_bf16_f32 v45, v38, v39
v_cvt_pk_bf16_f32 v46, v40, v41
v_cvt_pk_bf16_f32 v47, v42, v43
buffer_store_dwordx4 v[44:47], v1, s[4:7], s17 offen offset:2048 sc1
v_accvgpr_read_b32 v48, a108
v_accvgpr_read_b32 v49, a109
v_accvgpr_read_b32 v50, a110
v_accvgpr_read_b32 v51, a111
v_accvgpr_read_b32 v52, a124
v_accvgpr_read_b32 v53, a125
v_accvgpr_read_b32 v54, a126
v_accvgpr_read_b32 v55, a127
v_cvt_pk_bf16_f32 v56, v48, v49
v_cvt_pk_bf16_f32 v57, v50, v51
v_cvt_pk_bf16_f32 v58, v52, v53
v_cvt_pk_bf16_f32 v59, v54, v55
buffer_store_dwordx4 v[56:59], v1, s[4:7], s17 offen offset:3072 sc1
v_accvgpr_read_b32 v60, a140
v_accvgpr_read_b32 v61, a141
v_accvgpr_read_b32 v62, a142
v_accvgpr_read_b32 v63, a143
v_accvgpr_read_b32 v64, a156
v_accvgpr_read_b32 v65, a157
v_accvgpr_read_b32 v66, a158
v_accvgpr_read_b32 v67, a159
v_cvt_pk_bf16_f32 v68, v60, v61
v_cvt_pk_bf16_f32 v69, v62, v63
v_cvt_pk_bf16_f32 v70, v64, v65
v_cvt_pk_bf16_f32 v71, v66, v67
s_add_u32 s17, s17, 4096
buffer_store_dwordx4 v[68:71], v1, s[4:7], s17 offen offset:0 sc1
fin_exit1:
s_endpgm
.globl redln1_kernel
.p2align 8
.type redln1_kernel,@function
redln1_kernel:
s_cmp_ge_u32 s2, 256
s_cbranch_scc1 redln1_exit1
s_load_dwordx2 s[12:13], s[0:1], 96
s_load_dwordx2 s[14:15], s[0:1], 0
v_lshrrev_b32 v2, 6, v0
v_and_b32 v3, 63, v0
s_lshr_b32 s19, s2, 1
v_readfirstlane_b32 s16, v2
s_and_b32 s18, s2, 1
s_waitcnt lgkmcnt(0)
s_mov_b32 s4, s12
s_mov_b32 s5, s13
s_mov_b32 s6, 0x10000000
s_mov_b32 s7, 0x20000
s_mov_b32 s8, s14
s_mov_b32 s9, s15
s_mov_b32 s10, 2621440
s_mov_b32 s11, 0x20000
s_mov_b32 s20, 0
v_and_b32 v2, 7, v3
v_bfe_u32 v4, v3, 3, 2
v_lshrrev_b32 v5, 5, v3
s_lshl_b32 s17, s18, 7
v_lshlrev_b32 v14, 4, v2
v_lshl_add_u32 v14, v4, 8, v14
v_lshl_add_u32 v14, v5, 10, v14
v_add_u32 v14, s17, v14
s_lshl_b32 s17, s2, 3
v_add_u32 v15, s17, v2
v_mul_u32_u24 v15, 1280, v15
v_lshl_add_u32 v15, v4, 4, v15
v_lshl_add_u32 v15, v5, 6, v15
s_mul_i32 s17, s16, 640
s_add_u32 s20, s20, s17
s_add_u32 s21, s17, 82313216
s_mul_i32 s22, s19, 20
s_mul_i32 s23, s16, 10
s_add_u32 s22, s22, s23
s_lshl_b32 s22, s22, 10
s_add_u32 s34, s22, 54525952
s_add_u32 s22, s22, 90832896
s_add_u32 s24, s22, 0
s_add_u32 s25, s22, 2621440
s_add_u32 s26, s22, 5242880
s_add_u32 s27, s22, 7864320
s_add_u32 s28, s22, 10485760
s_add_u32 s29, s22, 13107200
s_add_u32 s30, s22, 15728640
s_add_u32 s31, s22, 18350080
v_add_u32 v6, 0x1000, v14
v_add_u32 v7, 0x2000, v14
buffer_load_dwordx4 v[16:19], v15, s[8:11], s20 offen offset:0
buffer_load_dwordx4 v[20:23], v15, s[8:11], s20 offen offset:128
buffer_load_dwordx4 v[24:27], v15, s[8:11], s20 offen offset:256
buffer_load_dwordx4 v[28:31], v15, s[8:11], s20 offen offset:384
buffer_load_dwordx4 v[32:35], v15, s[8:11], s20 offen offset:512
buffer_load_dwordx4 v[80:83], v14, s[4:7], s24 offen offset:0
buffer_load_dwordx4 v[84:87], v14, s[4:7], s25 offen offset:0
buffer_load_dwordx4 v[88:91], v14, s[4:7], s26 offen offset:0
buffer_load_dwordx4 v[92:95], v14, s[4:7], s27 offen offset:0
buffer_load_dwordx4 v[96:99], v14, s[4:7], s28 offen offset:0
buffer_load_dwordx4 v[100:103], v14, s[4:7], s29 offen offset:0
buffer_load_dwordx4 v[104:107], v14, s[4:7], s30 offen offset:0
buffer_load_dwordx4 v[108:111], v14, s[4:7], s31 offen offset:0
buffer_load_dwordx4 v[112:115], v14, s[4:7], s24 offen offset:2048
buffer_load_dwordx4 v[116:119], v14, s[4:7], s25 offen offset:2048
buffer_load_dwordx4 v[120:123], v14, s[4:7], s26 offen offset:2048
buffer_load_dwordx4 v[124:127], v14, s[4:7], s27 offen offset:2048
buffer_load_dwordx4 v[128:131], v14, s[4:7], s28 offen offset:2048
buffer_load_dwordx4 v[132:135], v14, s[4:7], s29 offen offset:2048
buffer_load_dwordx4 v[136:139], v14, s[4:7], s30 offen offset:2048
buffer_load_dwordx4 v[140:143], v14, s[4:7], s31 offen offset:2048
buffer_load_dwordx4 v[144:147], v6, s[4:7], s24 offen offset:0
buffer_load_dwordx4 v[148:151], v6, s[4:7], s25 offen offset:0
buffer_load_dwordx4 v[152:155], v6, s[4:7], s26 offen offset:0
buffer_load_dwordx4 v[156:159], v6, s[4:7], s27 offen offset:0
buffer_load_dwordx4 v[160:163], v6, s[4:7], s28 offen offset:0
buffer_load_dwordx4 v[164:167], v6, s[4:7], s29 offen offset:0
buffer_load_dwordx4 v[168:171], v6, s[4:7], s30 offen offset:0
buffer_load_dwordx4 v[172:175], v6, s[4:7], s31 offen offset:0
buffer_load_dwordx4 v[176:179], v6, s[4:7], s24 offen offset:2048
buffer_load_dwordx4 v[180:183], v6, s[4:7], s25 offen offset:2048
buffer_load_dwordx4 v[184:187], v6, s[4:7], s26 offen offset:2048
buffer_load_dwordx4 v[188:191], v6, s[4:7], s27 offen offset:2048
buffer_load_dwordx4 v[192:195], v6, s[4:7], s28 offen offset:2048
buffer_load_dwordx4 v[196:199], v6, s[4:7], s29 offen offset:2048
buffer_load_dwordx4 v[200:203], v6, s[4:7], s30 offen offset:2048
buffer_load_dwordx4 v[204:207], v6, s[4:7], s31 offen offset:2048
buffer_load_dwordx4 v[208:211], v7, s[4:7], s24 offen offset:0
buffer_load_dwordx4 v[212:215], v7, s[4:7], s25 offen offset:0
buffer_load_dwordx4 v[216:219], v7, s[4:7], s26 offen offset:0
buffer_load_dwordx4 v[220:223], v7, s[4:7], s27 offen offset:0
buffer_load_dwordx4 v[224:227], v7, s[4:7], s28 offen offset:0
buffer_load_dwordx4 v[228:231], v7, s[4:7], s29 offen offset:0
buffer_load_dwordx4 v[232:235], v7, s[4:7], s30 offen offset:0
buffer_load_dwordx4 v[236:239], v7, s[4:7], s31 offen offset:0
s_waitcnt vmcnt(32)
v_lshlrev_b32 v36, 16, v80
v_and_b32 v37, 0xffff0000, v80
v_lshlrev_b32 v38, 16, v81
v_and_b32 v39, 0xffff0000, v81
v_lshlrev_b32 v40, 16, v82
v_and_b32 v41, 0xffff0000, v82
v_lshlrev_b32 v42, 16, v83
v_and_b32 v43, 0xffff0000, v83
v_lshlrev_b32 v8, 16, v84
v_and_b32 v9, 0xffff0000, v84
v_pk_add_f32 v[36:37], v[36:37], v[8:9]
v_lshlrev_b32 v10, 16, v85
v_and_b32 v11, 0xffff0000, v85
v_pk_add_f32 v[38:39], v[38:39], v[10:11]
v_lshlrev_b32 v8, 16, v86
v_and_b32 v9, 0xffff0000, v86
v_pk_add_f32 v[40:41], v[40:41], v[8:9]
v_lshlrev_b32 v10, 16, v87
v_and_b32 v11, 0xffff0000, v87
v_pk_add_f32 v[42:43], v[42:43], v[10:11]
v_lshlrev_b32 v8, 16, v88
v_and_b32 v9, 0xffff0000, v88
v_pk_add_f32 v[36:37], v[36:37], v[8:9]
v_lshlrev_b32 v10, 16, v89
v_and_b32 v11, 0xffff0000, v89
v_pk_add_f32 v[38:39], v[38:39], v[10:11]
v_lshlrev_b32 v8, 16, v90
v_and_b32 v9, 0xffff0000, v90
v_pk_add_f32 v[40:41], v[40:41], v[8:9]
v_lshlrev_b32 v10, 16, v91
v_and_b32 v11, 0xffff0000, v91
v_pk_add_f32 v[42:43], v[42:43], v[10:11]
v_lshlrev_b32 v8, 16, v92
v_and_b32 v9, 0xffff0000, v92
v_pk_add_f32 v[36:37], v[36:37], v[8:9]
v_lshlrev_b32 v10, 16, v93
v_and_b32 v11, 0xffff0000, v93
v_pk_add_f32 v[38:39], v[38:39], v[10:11]
v_lshlrev_b32 v8, 16, v94
v_and_b32 v9, 0xffff0000, v94
v_pk_add_f32 v[40:41], v[40:41], v[8:9]
v_lshlrev_b32 v10, 16, v95
v_and_b32 v11, 0xffff0000, v95
v_pk_add_f32 v[42:43], v[42:43], v[10:11]
v_lshlrev_b32 v8, 16, v96
v_and_b32 v9, 0xffff0000, v96
v_pk_add_f32 v[36:37], v[36:37], v[8:9]
v_lshlrev_b32 v10, 16, v97
v_and_b32 v11, 0xffff0000, v97
v_pk_add_f32 v[38:39], v[38:39], v[10:11]
v_lshlrev_b32 v8, 16, v98
v_and_b32 v9, 0xffff0000, v98
v_pk_add_f32 v[40:41], v[40:41], v[8:9]
v_lshlrev_b32 v10, 16, v99
v_and_b32 v11, 0xffff0000, v99
v_pk_add_f32 v[42:43], v[42:43], v[10:11]
v_lshlrev_b32 v8, 16, v100
v_and_b32 v9, 0xffff0000, v100
v_pk_add_f32 v[36:37], v[36:37], v[8:9]
v_lshlrev_b32 v10, 16, v101
v_and_b32 v11, 0xffff0000, v101
v_pk_add_f32 v[38:39], v[38:39], v[10:11]
v_lshlrev_b32 v8, 16, v102
v_and_b32 v9, 0xffff0000, v102
v_pk_add_f32 v[40:41], v[40:41], v[8:9]
v_lshlrev_b32 v10, 16, v103
v_and_b32 v11, 0xffff0000, v103
v_pk_add_f32 v[42:43], v[42:43], v[10:11]
v_lshlrev_b32 v8, 16, v104
v_and_b32 v9, 0xffff0000, v104
v_pk_add_f32 v[36:37], v[36:37], v[8:9]
v_lshlrev_b32 v10, 16, v105
v_and_b32 v11, 0xffff0000, v105
v_pk_add_f32 v[38:39], v[38:39], v[10:11]
v_lshlrev_b32 v8, 16, v106
v_and_b32 v9, 0xffff0000, v106
v_pk_add_f32 v[40:41], v[40:41], v[8:9]
v_lshlrev_b32 v10, 16, v107
v_and_b32 v11, 0xffff0000, v107
v_pk_add_f32 v[42:43], v[42:43], v[10:11]
v_lshlrev_b32 v8, 16, v108
v_and_b32 v9, 0xffff0000, v108
v_pk_add_f32 v[36:37], v[36:37], v[8:9]
v_lshlrev_b32 v10, 16, v109
v_and_b32 v11, 0xffff0000, v109
v_pk_add_f32 v[38:39], v[38:39], v[10:11]
v_lshlrev_b32 v8, 16, v110
v_and_b32 v9, 0xffff0000, v110
v_pk_add_f32 v[40:41], v[40:41], v[8:9]
v_lshlrev_b32 v10, 16, v111
v_and_b32 v11, 0xffff0000, v111
v_pk_add_f32 v[42:43], v[42:43], v[10:11]
v_cvt_pk_bf16_f32 v8, v36, v37
v_lshlrev_b32 v36, 16, v8
v_and_b32 v37, 0xffff0000, v8
v_lshlrev_b32 v10, 16, v16
v_and_b32 v11, 0xffff0000, v16
v_pk_add_f32 v[36:37], v[36:37], v[10:11]
v_cvt_pk_bf16_f32 v16, v36, v37
v_lshlrev_b32 v36, 16, v16
v_and_b32 v37, 0xffff0000, v16
v_cvt_pk_bf16_f32 v8, v38, v39
v_lshlrev_b32 v38, 16, v8
v_and_b32 v39, 0xffff0000, v8
v_lshlrev_b32 v10, 16, v17
v_and_b32 v11, 0xffff0000, v17
v_pk_add_f32 v[38:39], v[38:39], v[10:11]
v_cvt_pk_bf16_f32 v17, v38, v39
v_lshlrev_b32 v38, 16, v17
v_and_b32 v39, 0xffff0000, v17
v_cvt_pk_bf16_f32 v8, v40, v41
v_lshlrev_b32 v40, 16, v8
v_and_b32 v41, 0xffff0000, v8
v_lshlrev_b32 v10, 16, v18
v_and_b32 v11, 0xffff0000, v18
v_pk_add_f32 v[40:41], v[40:41], v[10:11]
v_cvt_pk_bf16_f32 v18, v40, v41
v_lshlrev_b32 v40, 16, v18
v_and_b32 v41, 0xffff0000, v18
v_cvt_pk_bf16_f32 v8, v42, v43
v_lshlrev_b32 v42, 16, v8
v_and_b32 v43, 0xffff0000, v8
v_lshlrev_b32 v10, 16, v19
v_and_b32 v11, 0xffff0000, v19
v_pk_add_f32 v[42:43], v[42:43], v[10:11]
v_cvt_pk_bf16_f32 v19, v42, v43
v_lshlrev_b32 v42, 16, v19
v_and_b32 v43, 0xffff0000, v19
buffer_store_dwordx4 v[16:19], v15, s[4:7], s21 offen offset:0 sc1
s_waitcnt vmcnt(25)
v_lshlrev_b32 v44, 16, v112
v_and_b32 v45, 0xffff0000, v112
v_lshlrev_b32 v46, 16, v113
v_and_b32 v47, 0xffff0000, v113
v_lshlrev_b32 v48, 16, v114
v_and_b32 v49, 0xffff0000, v114
v_lshlrev_b32 v50, 16, v115
v_and_b32 v51, 0xffff0000, v115
v_lshlrev_b32 v8, 16, v116
v_and_b32 v9, 0xffff0000, v116
v_pk_add_f32 v[44:45], v[44:45], v[8:9]
v_lshlrev_b32 v10, 16, v117
v_and_b32 v11, 0xffff0000, v117
v_pk_add_f32 v[46:47], v[46:47], v[10:11]
v_lshlrev_b32 v8, 16, v118
v_and_b32 v9, 0xffff0000, v118
v_pk_add_f32 v[48:49], v[48:49], v[8:9]
v_lshlrev_b32 v10, 16, v119
v_and_b32 v11, 0xffff0000, v119
v_pk_add_f32 v[50:51], v[50:51], v[10:11]
v_lshlrev_b32 v8, 16, v120
v_and_b32 v9, 0xffff0000, v120
v_pk_add_f32 v[44:45], v[44:45], v[8:9]
v_lshlrev_b32 v10, 16, v121
v_and_b32 v11, 0xffff0000, v121
v_pk_add_f32 v[46:47], v[46:47], v[10:11]
v_lshlrev_b32 v8, 16, v122
v_and_b32 v9, 0xffff0000, v122
v_pk_add_f32 v[48:49], v[48:49], v[8:9]
v_lshlrev_b32 v10, 16, v123
v_and_b32 v11, 0xffff0000, v123
v_pk_add_f32 v[50:51], v[50:51], v[10:11]
v_lshlrev_b32 v8, 16, v124
v_and_b32 v9, 0xffff0000, v124
v_pk_add_f32 v[44:45], v[44:45], v[8:9]
v_lshlrev_b32 v10, 16, v125
v_and_b32 v11, 0xffff0000, v125
v_pk_add_f32 v[46:47], v[46:47], v[10:11]
v_lshlrev_b32 v8, 16, v126
v_and_b32 v9, 0xffff0000, v126
v_pk_add_f32 v[48:49], v[48:49], v[8:9]
v_lshlrev_b32 v10, 16, v127
v_and_b32 v11, 0xffff0000, v127
v_pk_add_f32 v[50:51], v[50:51], v[10:11]
v_lshlrev_b32 v8, 16, v128
v_and_b32 v9, 0xffff0000, v128
v_pk_add_f32 v[44:45], v[44:45], v[8:9]
v_lshlrev_b32 v10, 16, v129
v_and_b32 v11, 0xffff0000, v129
v_pk_add_f32 v[46:47], v[46:47], v[10:11]
v_lshlrev_b32 v8, 16, v130
v_and_b32 v9, 0xffff0000, v130
v_pk_add_f32 v[48:49], v[48:49], v[8:9]
v_lshlrev_b32 v10, 16, v131
v_and_b32 v11, 0xffff0000, v131
v_pk_add_f32 v[50:51], v[50:51], v[10:11]
v_lshlrev_b32 v8, 16, v132
v_and_b32 v9, 0xffff0000, v132
v_pk_add_f32 v[44:45], v[44:45], v[8:9]
v_lshlrev_b32 v10, 16, v133
v_and_b32 v11, 0xffff0000, v133
v_pk_add_f32 v[46:47], v[46:47], v[10:11]
v_lshlrev_b32 v8, 16, v134
v_and_b32 v9, 0xffff0000, v134
v_pk_add_f32 v[48:49], v[48:49], v[8:9]
v_lshlrev_b32 v10, 16, v135
v_and_b32 v11, 0xffff0000, v135
v_pk_add_f32 v[50:51], v[50:51], v[10:11]
v_lshlrev_b32 v8, 16, v136
v_and_b32 v9, 0xffff0000, v136
v_pk_add_f32 v[44:45], v[44:45], v[8:9]
v_lshlrev_b32 v10, 16, v137
v_and_b32 v11, 0xffff0000, v137
v_pk_add_f32 v[46:47], v[46:47], v[10:11]
v_lshlrev_b32 v8, 16, v138
v_and_b32 v9, 0xffff0000, v138
v_pk_add_f32 v[48:49], v[48:49], v[8:9]
v_lshlrev_b32 v10, 16, v139
v_and_b32 v11, 0xffff0000, v139
v_pk_add_f32 v[50:51], v[50:51], v[10:11]
v_lshlrev_b32 v8, 16, v140
v_and_b32 v9, 0xffff0000, v140
v_pk_add_f32 v[44:45], v[44:45], v[8:9]
v_lshlrev_b32 v10, 16, v141
v_and_b32 v11, 0xffff0000, v141
v_pk_add_f32 v[46:47], v[46:47], v[10:11]
v_lshlrev_b32 v8, 16, v142
v_and_b32 v9, 0xffff0000, v142
v_pk_add_f32 v[48:49], v[48:49], v[8:9]
v_lshlrev_b32 v10, 16, v143
v_and_b32 v11, 0xffff0000, v143
v_pk_add_f32 v[50:51], v[50:51], v[10:11]
v_cvt_pk_bf16_f32 v8, v44, v45
v_lshlrev_b32 v44, 16, v8
v_and_b32 v45, 0xffff0000, v8
v_lshlrev_b32 v10, 16, v20
v_and_b32 v11, 0xffff0000, v20
v_pk_add_f32 v[44:45], v[44:45], v[10:11]
v_cvt_pk_bf16_f32 v20, v44, v45
v_lshlrev_b32 v44, 16, v20
v_and_b32 v45, 0xffff0000, v20
v_cvt_pk_bf16_f32 v8, v46, v47
v_lshlrev_b32 v46, 16, v8
v_and_b32 v47, 0xffff0000, v8
v_lshlrev_b32 v10, 16, v21
v_and_b32 v11, 0xffff0000, v21
v_pk_add_f32 v[46:47], v[46:47], v[10:11]
v_cvt_pk_bf16_f32 v21, v46, v47
v_lshlrev_b32 v46, 16, v21
v_and_b32 v47, 0xffff0000, v21
v_cvt_pk_bf16_f32 v8, v48, v49
v_lshlrev_b32 v48, 16, v8
v_and_b32 v49, 0xffff0000, v8
v_lshlrev_b32 v10, 16, v22
v_and_b32 v11, 0xffff0000, v22
v_pk_add_f32 v[48:49], v[48:49], v[10:11]
v_cvt_pk_bf16_f32 v22, v48, v49
v_lshlrev_b32 v48, 16, v22
v_and_b32 v49, 0xffff0000, v22
v_cvt_pk_bf16_f32 v8, v50, v51
v_lshlrev_b32 v50, 16, v8
v_and_b32 v51, 0xffff0000, v8
v_lshlrev_b32 v10, 16, v23
v_and_b32 v11, 0xffff0000, v23
v_pk_add_f32 v[50:51], v[50:51], v[10:11]
v_cvt_pk_bf16_f32 v23, v50, v51
v_lshlrev_b32 v50, 16, v23
v_and_b32 v51, 0xffff0000, v23
buffer_store_dwordx4 v[20:23], v15, s[4:7], s21 offen offset:128 sc1
s_waitcnt vmcnt(18)
v_lshlrev_b32 v52, 16, v144
v_and_b32 v53, 0xffff0000, v144
v_lshlrev_b32 v54, 16, v145
v_and_b32 v55, 0xffff0000, v145
v_lshlrev_b32 v56, 16, v146
v_and_b32 v57, 0xffff0000, v146
v_lshlrev_b32 v58, 16, v147
v_and_b32 v59, 0xffff0000, v147
v_lshlrev_b32 v8, 16, v148
v_and_b32 v9, 0xffff0000, v148
v_pk_add_f32 v[52:53], v[52:53], v[8:9]
v_lshlrev_b32 v10, 16, v149
v_and_b32 v11, 0xffff0000, v149
v_pk_add_f32 v[54:55], v[54:55], v[10:11]
v_lshlrev_b32 v8, 16, v150
v_and_b32 v9, 0xffff0000, v150
v_pk_add_f32 v[56:57], v[56:57], v[8:9]
v_lshlrev_b32 v10, 16, v151
v_and_b32 v11, 0xffff0000, v151
v_pk_add_f32 v[58:59], v[58:59], v[10:11]
v_lshlrev_b32 v8, 16, v152
v_and_b32 v9, 0xffff0000, v152
v_pk_add_f32 v[52:53], v[52:53], v[8:9]
v_lshlrev_b32 v10, 16, v153
v_and_b32 v11, 0xffff0000, v153
v_pk_add_f32 v[54:55], v[54:55], v[10:11]
v_lshlrev_b32 v8, 16, v154
v_and_b32 v9, 0xffff0000, v154
v_pk_add_f32 v[56:57], v[56:57], v[8:9]
v_lshlrev_b32 v10, 16, v155
v_and_b32 v11, 0xffff0000, v155
v_pk_add_f32 v[58:59], v[58:59], v[10:11]
v_lshlrev_b32 v8, 16, v156
v_and_b32 v9, 0xffff0000, v156
v_pk_add_f32 v[52:53], v[52:53], v[8:9]
v_lshlrev_b32 v10, 16, v157
v_and_b32 v11, 0xffff0000, v157
v_pk_add_f32 v[54:55], v[54:55], v[10:11]
v_lshlrev_b32 v8, 16, v158
v_and_b32 v9, 0xffff0000, v158
v_pk_add_f32 v[56:57], v[56:57], v[8:9]
v_lshlrev_b32 v10, 16, v159
v_and_b32 v11, 0xffff0000, v159
v_pk_add_f32 v[58:59], v[58:59], v[10:11]
v_lshlrev_b32 v8, 16, v160
v_and_b32 v9, 0xffff0000, v160
v_pk_add_f32 v[52:53], v[52:53], v[8:9]
v_lshlrev_b32 v10, 16, v161
v_and_b32 v11, 0xffff0000, v161
v_pk_add_f32 v[54:55], v[54:55], v[10:11]
v_lshlrev_b32 v8, 16, v162
v_and_b32 v9, 0xffff0000, v162
v_pk_add_f32 v[56:57], v[56:57], v[8:9]
v_lshlrev_b32 v10, 16, v163
v_and_b32 v11, 0xffff0000, v163
v_pk_add_f32 v[58:59], v[58:59], v[10:11]
v_lshlrev_b32 v8, 16, v164
v_and_b32 v9, 0xffff0000, v164
v_pk_add_f32 v[52:53], v[52:53], v[8:9]
v_lshlrev_b32 v10, 16, v165
v_and_b32 v11, 0xffff0000, v165
v_pk_add_f32 v[54:55], v[54:55], v[10:11]
v_lshlrev_b32 v8, 16, v166
v_and_b32 v9, 0xffff0000, v166
v_pk_add_f32 v[56:57], v[56:57], v[8:9]
v_lshlrev_b32 v10, 16, v167
v_and_b32 v11, 0xffff0000, v167
v_pk_add_f32 v[58:59], v[58:59], v[10:11]
v_lshlrev_b32 v8, 16, v168
v_and_b32 v9, 0xffff0000, v168
v_pk_add_f32 v[52:53], v[52:53], v[8:9]
v_lshlrev_b32 v10, 16, v169
v_and_b32 v11, 0xffff0000, v169
v_pk_add_f32 v[54:55], v[54:55], v[10:11]
v_lshlrev_b32 v8, 16, v170
v_and_b32 v9, 0xffff0000, v170
v_pk_add_f32 v[56:57], v[56:57], v[8:9]
v_lshlrev_b32 v10, 16, v171
v_and_b32 v11, 0xffff0000, v171
v_pk_add_f32 v[58:59], v[58:59], v[10:11]
v_lshlrev_b32 v8, 16, v172
v_and_b32 v9, 0xffff0000, v172
v_pk_add_f32 v[52:53], v[52:53], v[8:9]
v_lshlrev_b32 v10, 16, v173
v_and_b32 v11, 0xffff0000, v173
v_pk_add_f32 v[54:55], v[54:55], v[10:11]
v_lshlrev_b32 v8, 16, v174
v_and_b32 v9, 0xffff0000, v174
v_pk_add_f32 v[56:57], v[56:57], v[8:9]
v_lshlrev_b32 v10, 16, v175
v_and_b32 v11, 0xffff0000, v175
v_pk_add_f32 v[58:59], v[58:59], v[10:11]
v_cvt_pk_bf16_f32 v8, v52, v53
v_lshlrev_b32 v52, 16, v8
v_and_b32 v53, 0xffff0000, v8
v_lshlrev_b32 v10, 16, v24
v_and_b32 v11, 0xffff0000, v24
v_pk_add_f32 v[52:53], v[52:53], v[10:11]
v_cvt_pk_bf16_f32 v24, v52, v53
v_lshlrev_b32 v52, 16, v24
v_and_b32 v53, 0xffff0000, v24
v_cvt_pk_bf16_f32 v8, v54, v55
v_lshlrev_b32 v54, 16, v8
v_and_b32 v55, 0xffff0000, v8
v_lshlrev_b32 v10, 16, v25
v_and_b32 v11, 0xffff0000, v25
v_pk_add_f32 v[54:55], v[54:55], v[10:11]
v_cvt_pk_bf16_f32 v25, v54, v55
v_lshlrev_b32 v54, 16, v25
v_and_b32 v55, 0xffff0000, v25
v_cvt_pk_bf16_f32 v8, v56, v57
v_lshlrev_b32 v56, 16, v8
v_and_b32 v57, 0xffff0000, v8
v_lshlrev_b32 v10, 16, v26
v_and_b32 v11, 0xffff0000, v26
v_pk_add_f32 v[56:57], v[56:57], v[10:11]
v_cvt_pk_bf16_f32 v26, v56, v57
v_lshlrev_b32 v56, 16, v26
v_and_b32 v57, 0xffff0000, v26
v_cvt_pk_bf16_f32 v8, v58, v59
v_lshlrev_b32 v58, 16, v8
v_and_b32 v59, 0xffff0000, v8
v_lshlrev_b32 v10, 16, v27
v_and_b32 v11, 0xffff0000, v27
v_pk_add_f32 v[58:59], v[58:59], v[10:11]
v_cvt_pk_bf16_f32 v27, v58, v59
v_lshlrev_b32 v58, 16, v27
v_and_b32 v59, 0xffff0000, v27
buffer_store_dwordx4 v[24:27], v15, s[4:7], s21 offen offset:256 sc1
s_waitcnt vmcnt(11)
v_lshlrev_b32 v60, 16, v176
v_and_b32 v61, 0xffff0000, v176
v_lshlrev_b32 v62, 16, v177
v_and_b32 v63, 0xffff0000, v177
v_lshlrev_b32 v64, 16, v178
v_and_b32 v65, 0xffff0000, v178
v_lshlrev_b32 v66, 16, v179
v_and_b32 v67, 0xffff0000, v179
v_lshlrev_b32 v8, 16, v180
v_and_b32 v9, 0xffff0000, v180
v_pk_add_f32 v[60:61], v[60:61], v[8:9]
v_lshlrev_b32 v10, 16, v181
v_and_b32 v11, 0xffff0000, v181
v_pk_add_f32 v[62:63], v[62:63], v[10:11]
v_lshlrev_b32 v8, 16, v182
v_and_b32 v9, 0xffff0000, v182
v_pk_add_f32 v[64:65], v[64:65], v[8:9]
v_lshlrev_b32 v10, 16, v183
v_and_b32 v11, 0xffff0000, v183
v_pk_add_f32 v[66:67], v[66:67], v[10:11]
v_lshlrev_b32 v8, 16, v184
v_and_b32 v9, 0xffff0000, v184
v_pk_add_f32 v[60:61], v[60:61], v[8:9]
v_lshlrev_b32 v10, 16, v185
v_and_b32 v11, 0xffff0000, v185
v_pk_add_f32 v[62:63], v[62:63], v[10:11]
v_lshlrev_b32 v8, 16, v186
v_and_b32 v9, 0xffff0000, v186
v_pk_add_f32 v[64:65], v[64:65], v[8:9]
v_lshlrev_b32 v10, 16, v187
v_and_b32 v11, 0xffff0000, v187
v_pk_add_f32 v[66:67], v[66:67], v[10:11]
v_lshlrev_b32 v8, 16, v188
v_and_b32 v9, 0xffff0000, v188
v_pk_add_f32 v[60:61], v[60:61], v[8:9]
v_lshlrev_b32 v10, 16, v189
v_and_b32 v11, 0xffff0000, v189
v_pk_add_f32 v[62:63], v[62:63], v[10:11]
v_lshlrev_b32 v8, 16, v190
v_and_b32 v9, 0xffff0000, v190
v_pk_add_f32 v[64:65], v[64:65], v[8:9]
v_lshlrev_b32 v10, 16, v191
v_and_b32 v11, 0xffff0000, v191
v_pk_add_f32 v[66:67], v[66:67], v[10:11]
v_lshlrev_b32 v8, 16, v192
v_and_b32 v9, 0xffff0000, v192
v_pk_add_f32 v[60:61], v[60:61], v[8:9]
v_lshlrev_b32 v10, 16, v193
v_and_b32 v11, 0xffff0000, v193
v_pk_add_f32 v[62:63], v[62:63], v[10:11]
v_lshlrev_b32 v8, 16, v194
v_and_b32 v9, 0xffff0000, v194
v_pk_add_f32 v[64:65], v[64:65], v[8:9]
v_lshlrev_b32 v10, 16, v195
v_and_b32 v11, 0xffff0000, v195
v_pk_add_f32 v[66:67], v[66:67], v[10:11]
v_lshlrev_b32 v8, 16, v196
v_and_b32 v9, 0xffff0000, v196
v_pk_add_f32 v[60:61], v[60:61], v[8:9]
v_lshlrev_b32 v10, 16, v197
v_and_b32 v11, 0xffff0000, v197
v_pk_add_f32 v[62:63], v[62:63], v[10:11]
v_lshlrev_b32 v8, 16, v198
v_and_b32 v9, 0xffff0000, v198
v_pk_add_f32 v[64:65], v[64:65], v[8:9]
v_lshlrev_b32 v10, 16, v199
v_and_b32 v11, 0xffff0000, v199
v_pk_add_f32 v[66:67], v[66:67], v[10:11]
v_lshlrev_b32 v8, 16, v200
v_and_b32 v9, 0xffff0000, v200
v_pk_add_f32 v[60:61], v[60:61], v[8:9]
v_lshlrev_b32 v10, 16, v201
v_and_b32 v11, 0xffff0000, v201
v_pk_add_f32 v[62:63], v[62:63], v[10:11]
v_lshlrev_b32 v8, 16, v202
v_and_b32 v9, 0xffff0000, v202
v_pk_add_f32 v[64:65], v[64:65], v[8:9]
v_lshlrev_b32 v10, 16, v203
v_and_b32 v11, 0xffff0000, v203
v_pk_add_f32 v[66:67], v[66:67], v[10:11]
v_lshlrev_b32 v8, 16, v204
v_and_b32 v9, 0xffff0000, v204
v_pk_add_f32 v[60:61], v[60:61], v[8:9]
v_lshlrev_b32 v10, 16, v205
v_and_b32 v11, 0xffff0000, v205
v_pk_add_f32 v[62:63], v[62:63], v[10:11]
v_lshlrev_b32 v8, 16, v206
v_and_b32 v9, 0xffff0000, v206
v_pk_add_f32 v[64:65], v[64:65], v[8:9]
v_lshlrev_b32 v10, 16, v207
v_and_b32 v11, 0xffff0000, v207
v_pk_add_f32 v[66:67], v[66:67], v[10:11]
v_cvt_pk_bf16_f32 v8, v60, v61
v_lshlrev_b32 v60, 16, v8
v_and_b32 v61, 0xffff0000, v8
v_lshlrev_b32 v10, 16, v28
v_and_b32 v11, 0xffff0000, v28
v_pk_add_f32 v[60:61], v[60:61], v[10:11]
v_cvt_pk_bf16_f32 v28, v60, v61
v_lshlrev_b32 v60, 16, v28
v_and_b32 v61, 0xffff0000, v28
v_cvt_pk_bf16_f32 v8, v62, v63
v_lshlrev_b32 v62, 16, v8
v_and_b32 v63, 0xffff0000, v8
v_lshlrev_b32 v10, 16, v29
v_and_b32 v11, 0xffff0000, v29
v_pk_add_f32 v[62:63], v[62:63], v[10:11]
v_cvt_pk_bf16_f32 v29, v62, v63
v_lshlrev_b32 v62, 16, v29
v_and_b32 v63, 0xffff0000, v29
v_cvt_pk_bf16_f32 v8, v64, v65
v_lshlrev_b32 v64, 16, v8
v_and_b32 v65, 0xffff0000, v8
v_lshlrev_b32 v10, 16, v30
v_and_b32 v11, 0xffff0000, v30
v_pk_add_f32 v[64:65], v[64:65], v[10:11]
v_cvt_pk_bf16_f32 v30, v64, v65
v_lshlrev_b32 v64, 16, v30
v_and_b32 v65, 0xffff0000, v30
v_cvt_pk_bf16_f32 v8, v66, v67
v_lshlrev_b32 v66, 16, v8
v_and_b32 v67, 0xffff0000, v8
v_lshlrev_b32 v10, 16, v31
v_and_b32 v11, 0xffff0000, v31
v_pk_add_f32 v[66:67], v[66:67], v[10:11]
v_cvt_pk_bf16_f32 v31, v66, v67
v_lshlrev_b32 v66, 16, v31
v_and_b32 v67, 0xffff0000, v31
buffer_store_dwordx4 v[28:31], v15, s[4:7], s21 offen offset:384 sc1
s_waitcnt vmcnt(4)
v_lshlrev_b32 v68, 16, v208
v_and_b32 v69, 0xffff0000, v208
v_lshlrev_b32 v70, 16, v209
v_and_b32 v71, 0xffff0000, v209
v_lshlrev_b32 v72, 16, v210
v_and_b32 v73, 0xffff0000, v210
v_lshlrev_b32 v74, 16, v211
v_and_b32 v75, 0xffff0000, v211
v_lshlrev_b32 v8, 16, v212
v_and_b32 v9, 0xffff0000, v212
v_pk_add_f32 v[68:69], v[68:69], v[8:9]
v_lshlrev_b32 v10, 16, v213
v_and_b32 v11, 0xffff0000, v213
v_pk_add_f32 v[70:71], v[70:71], v[10:11]
v_lshlrev_b32 v8, 16, v214
v_and_b32 v9, 0xffff0000, v214
v_pk_add_f32 v[72:73], v[72:73], v[8:9]
v_lshlrev_b32 v10, 16, v215
v_and_b32 v11, 0xffff0000, v215
v_pk_add_f32 v[74:75], v[74:75], v[10:11]
v_lshlrev_b32 v8, 16, v216
v_and_b32 v9, 0xffff0000, v216
v_pk_add_f32 v[68:69], v[68:69], v[8:9]
v_lshlrev_b32 v10, 16, v217
v_and_b32 v11, 0xffff0000, v217
v_pk_add_f32 v[70:71], v[70:71], v[10:11]
v_lshlrev_b32 v8, 16, v218
v_and_b32 v9, 0xffff0000, v218
v_pk_add_f32 v[72:73], v[72:73], v[8:9]
v_lshlrev_b32 v10, 16, v219
v_and_b32 v11, 0xffff0000, v219
v_pk_add_f32 v[74:75], v[74:75], v[10:11]
v_lshlrev_b32 v8, 16, v220
v_and_b32 v9, 0xffff0000, v220
v_pk_add_f32 v[68:69], v[68:69], v[8:9]
v_lshlrev_b32 v10, 16, v221
v_and_b32 v11, 0xffff0000, v221
v_pk_add_f32 v[70:71], v[70:71], v[10:11]
v_lshlrev_b32 v8, 16, v222
v_and_b32 v9, 0xffff0000, v222
v_pk_add_f32 v[72:73], v[72:73], v[8:9]
v_lshlrev_b32 v10, 16, v223
v_and_b32 v11, 0xffff0000, v223
v_pk_add_f32 v[74:75], v[74:75], v[10:11]
v_lshlrev_b32 v8, 16, v224
v_and_b32 v9, 0xffff0000, v224
v_pk_add_f32 v[68:69], v[68:69], v[8:9]
v_lshlrev_b32 v10, 16, v225
v_and_b32 v11, 0xffff0000, v225
v_pk_add_f32 v[70:71], v[70:71], v[10:11]
v_lshlrev_b32 v8, 16, v226
v_and_b32 v9, 0xffff0000, v226
v_pk_add_f32 v[72:73], v[72:73], v[8:9]
v_lshlrev_b32 v10, 16, v227
v_and_b32 v11, 0xffff0000, v227
v_pk_add_f32 v[74:75], v[74:75], v[10:11]
v_lshlrev_b32 v8, 16, v228
v_and_b32 v9, 0xffff0000, v228
v_pk_add_f32 v[68:69], v[68:69], v[8:9]
v_lshlrev_b32 v10, 16, v229
v_and_b32 v11, 0xffff0000, v229
v_pk_add_f32 v[70:71], v[70:71], v[10:11]
v_lshlrev_b32 v8, 16, v230
v_and_b32 v9, 0xffff0000, v230
v_pk_add_f32 v[72:73], v[72:73], v[8:9]
v_lshlrev_b32 v10, 16, v231
v_and_b32 v11, 0xffff0000, v231
v_pk_add_f32 v[74:75], v[74:75], v[10:11]
v_lshlrev_b32 v8, 16, v232
v_and_b32 v9, 0xffff0000, v232
v_pk_add_f32 v[68:69], v[68:69], v[8:9]
v_lshlrev_b32 v10, 16, v233
v_and_b32 v11, 0xffff0000, v233
v_pk_add_f32 v[70:71], v[70:71], v[10:11]
v_lshlrev_b32 v8, 16, v234
v_and_b32 v9, 0xffff0000, v234
v_pk_add_f32 v[72:73], v[72:73], v[8:9]
v_lshlrev_b32 v10, 16, v235
v_and_b32 v11, 0xffff0000, v235
v_pk_add_f32 v[74:75], v[74:75], v[10:11]
v_lshlrev_b32 v8, 16, v236
v_and_b32 v9, 0xffff0000, v236
v_pk_add_f32 v[68:69], v[68:69], v[8:9]
v_lshlrev_b32 v10, 16, v237
v_and_b32 v11, 0xffff0000, v237
v_pk_add_f32 v[70:71], v[70:71], v[10:11]
v_lshlrev_b32 v8, 16, v238
v_and_b32 v9, 0xffff0000, v238
v_pk_add_f32 v[72:73], v[72:73], v[8:9]
v_lshlrev_b32 v10, 16, v239
v_and_b32 v11, 0xffff0000, v239
v_pk_add_f32 v[74:75], v[74:75], v[10:11]
v_cvt_pk_bf16_f32 v8, v68, v69
v_lshlrev_b32 v68, 16, v8
v_and_b32 v69, 0xffff0000, v8
v_lshlrev_b32 v10, 16, v32
v_and_b32 v11, 0xffff0000, v32
v_pk_add_f32 v[68:69], v[68:69], v[10:11]
v_cvt_pk_bf16_f32 v32, v68, v69
v_lshlrev_b32 v68, 16, v32
v_and_b32 v69, 0xffff0000, v32
v_cvt_pk_bf16_f32 v8, v70, v71
v_lshlrev_b32 v70, 16, v8
v_and_b32 v71, 0xffff0000, v8
v_lshlrev_b32 v10, 16, v33
v_and_b32 v11, 0xffff0000, v33
v_pk_add_f32 v[70:71], v[70:71], v[10:11]
v_cvt_pk_bf16_f32 v33, v70, v71
v_lshlrev_b32 v70, 16, v33
v_and_b32 v71, 0xffff0000, v33
v_cvt_pk_bf16_f32 v8, v72, v73
v_lshlrev_b32 v72, 16, v8
v_and_b32 v73, 0xffff0000, v8
v_lshlrev_b32 v10, 16, v34
v_and_b32 v11, 0xffff0000, v34
v_pk_add_f32 v[72:73], v[72:73], v[10:11]
v_cvt_pk_bf16_f32 v34, v72, v73
v_lshlrev_b32 v72, 16, v34
v_and_b32 v73, 0xffff0000, v34
v_cvt_pk_bf16_f32 v8, v74, v75
v_lshlrev_b32 v74, 16, v8
v_and_b32 v75, 0xffff0000, v8
v_lshlrev_b32 v10, 16, v35
v_and_b32 v11, 0xffff0000, v35
v_pk_add_f32 v[74:75], v[74:75], v[10:11]
v_cvt_pk_bf16_f32 v35, v74, v75
v_lshlrev_b32 v74, 16, v35
v_and_b32 v75, 0xffff0000, v35
buffer_store_dwordx4 v[32:35], v15, s[4:7], s21 offen offset:512 sc1
v_and_b32 v3, 63, v0
v_and_b32 v2, 7, v3
v_lshlrev_b32 v5, 2, v2
s_lshl_b32 s17, s16, 5
v_add_u32 v1, s17, v5
v_pk_add_f32 v[6:7], v[36:37], v[38:39]
v_pk_add_f32 v[6:7], v[6:7], v[40:41]
v_pk_add_f32 v[6:7], v[6:7], v[42:43]
v_pk_add_f32 v[6:7], v[6:7], v[44:45]
v_pk_add_f32 v[6:7], v[6:7], v[46:47]
v_pk_add_f32 v[6:7], v[6:7], v[48:49]
v_pk_add_f32 v[6:7], v[6:7], v[50:51]
v_pk_add_f32 v[6:7], v[6:7], v[52:53]
v_pk_add_f32 v[6:7], v[6:7], v[54:55]
v_pk_add_f32 v[6:7], v[6:7], v[56:57]
v_pk_add_f32 v[6:7], v[6:7], v[58:59]
v_pk_add_f32 v[6:7], v[6:7], v[60:61]
v_pk_add_f32 v[6:7], v[6:7], v[62:63]
v_pk_add_f32 v[6:7], v[6:7], v[64:65]
v_pk_add_f32 v[6:7], v[6:7], v[66:67]
v_pk_add_f32 v[6:7], v[6:7], v[68:69]
v_pk_add_f32 v[6:7], v[6:7], v[70:71]
v_pk_add_f32 v[6:7], v[6:7], v[72:73]
v_pk_add_f32 v[6:7], v[6:7], v[74:75]
v_add_f32 v4, v6, v7
s_nop 1
v_add_f32_dpp v4, v4, v4 row_ror:8 row_mask:0xf bank_mask:0xf
v_mov_b32 v2, v4
s_nop 1
v_permlane16_swap_b32 v4, v2
v_add_f32 v4, v4, v2
v_mov_b32 v2, v4
s_nop 1
v_permlane32_swap_b32 v4, v2
v_add_f32 v4, v4, v2
ds_write_b32 v1, v4 offset:0
s_waitcnt lgkmcnt(0)
s_barrier
ds_read_b32 v4, v5 offset:0
ds_read_b32 v2, v5 offset:32
s_waitcnt lgkmcnt(0)
v_add_f32 v4, v4, v2
v_mul_f32 v6, 0xbacccccd, v4
v_mov_b32 v7, v6
v_pk_add_f32 v[36:37], v[36:37], v[6:7]
v_pk_add_f32 v[38:39], v[38:39], v[6:7]
v_pk_add_f32 v[40:41], v[40:41], v[6:7]
v_pk_add_f32 v[42:43], v[42:43], v[6:7]
v_pk_add_f32 v[44:45], v[44:45], v[6:7]
v_pk_add_f32 v[46:47], v[46:47], v[6:7]
v_pk_add_f32 v[48:49], v[48:49], v[6:7]
v_pk_add_f32 v[50:51], v[50:51], v[6:7]
v_pk_add_f32 v[52:53], v[52:53], v[6:7]
v_pk_add_f32 v[54:55], v[54:55], v[6:7]
v_pk_add_f32 v[56:57], v[56:57], v[6:7]
v_pk_add_f32 v[58:59], v[58:59], v[6:7]
v_pk_add_f32 v[60:61], v[60:61], v[6:7]
v_pk_add_f32 v[62:63], v[62:63], v[6:7]
v_pk_add_f32 v[64:65], v[64:65], v[6:7]
v_pk_add_f32 v[66:67], v[66:67], v[6:7]
v_pk_add_f32 v[68:69], v[68:69], v[6:7]
v_pk_add_f32 v[70:71], v[70:71], v[6:7]
v_pk_add_f32 v[72:73], v[72:73], v[6:7]
v_pk_add_f32 v[74:75], v[74:75], v[6:7]
v_pk_mul_f32 v[6:7], v[36:37], v[36:37]
v_pk_fma_f32 v[6:7], v[38:39], v[38:39], v[6:7]
v_pk_fma_f32 v[6:7], v[40:41], v[40:41], v[6:7]
v_pk_fma_f32 v[6:7], v[42:43], v[42:43], v[6:7]
v_pk_fma_f32 v[6:7], v[44:45], v[44:45], v[6:7]
v_pk_fma_f32 v[6:7], v[46:47], v[46:47], v[6:7]
v_pk_fma_f32 v[6:7], v[48:49], v[48:49], v[6:7]
v_pk_fma_f32 v[6:7], v[50:51], v[50:51], v[6:7]
v_pk_fma_f32 v[6:7], v[52:53], v[52:53], v[6:7]
v_pk_fma_f32 v[6:7], v[54:55], v[54:55], v[6:7]
v_pk_fma_f32 v[6:7], v[56:57], v[56:57], v[6:7]
v_pk_fma_f32 v[6:7], v[58:59], v[58:59], v[6:7]
v_pk_fma_f32 v[6:7], v[60:61], v[60:61], v[6:7]
v_pk_fma_f32 v[6:7], v[62:63], v[62:63], v[6:7]
v_pk_fma_f32 v[6:7], v[64:65], v[64:65], v[6:7]
v_pk_fma_f32 v[6:7], v[66:67], v[66:67], v[6:7]
v_pk_fma_f32 v[6:7], v[68:69], v[68:69], v[6:7]
v_pk_fma_f32 v[6:7], v[70:71], v[70:71], v[6:7]
v_pk_fma_f32 v[6:7], v[72:73], v[72:73], v[6:7]
v_pk_fma_f32 v[6:7], v[74:75], v[74:75], v[6:7]
v_add_f32 v4, v6, v7
s_nop 1
v_add_f32_dpp v4, v4, v4 row_ror:8 row_mask:0xf bank_mask:0xf
v_mov_b32 v2, v4
s_nop 1
v_permlane16_swap_b32 v4, v2
v_add_f32 v4, v4, v2
v_mov_b32 v2, v4
s_nop 1
v_permlane32_swap_b32 v4, v2
v_add_f32 v4, v4, v2
ds_write_b32 v1, v4 offset:64
s_waitcnt lgkmcnt(0)
s_barrier
ds_read_b32 v4, v5 offset:64
ds_read_b32 v2, v5 offset:96
s_waitcnt lgkmcnt(0)
v_add_f32 v4, v4, v2
v_mov_b32 v2, 0x3727c5ac
v_fmac_f32 v2, 0x3acccccd, v4
v_rsq_f32 v6, v2
s_nop 0
v_mov_b32 v7, v6
v_pk_mul_f32 v[36:37], v[36:37], v[6:7]
v_pk_mul_f32 v[38:39], v[38:39], v[6:7]
v_pk_mul_f32 v[40:41], v[40:41], v[6:7]
v_pk_mul_f32 v[42:43], v[42:43], v[6:7]
v_pk_mul_f32 v[44:45], v[44:45], v[6:7]
v_pk_mul_f32 v[46:47], v[46:47], v[6:7]
v_pk_mul_f32 v[48:49], v[48:49], v[6:7]
v_pk_mul_f32 v[50:51], v[50:51], v[6:7]
v_pk_mul_f32 v[52:53], v[52:53], v[6:7]
v_pk_mul_f32 v[54:55], v[54:55], v[6:7]
v_pk_mul_f32 v[56:57], v[56:57], v[6:7]
v_pk_mul_f32 v[58:59], v[58:59], v[6:7]
v_pk_mul_f32 v[60:61], v[60:61], v[6:7]
v_pk_mul_f32 v[62:63], v[62:63], v[6:7]
v_pk_mul_f32 v[64:65], v[64:65], v[6:7]
v_pk_mul_f32 v[66:67], v[66:67], v[6:7]
v_pk_mul_f32 v[68:69], v[68:69], v[6:7]
v_pk_mul_f32 v[70:71], v[70:71], v[6:7]
v_pk_mul_f32 v[72:73], v[72:73], v[6:7]
v_pk_mul_f32 v[74:75], v[74:75], v[6:7]
v_cvt_pk_bf16_f32 v16, v36, v37
v_cvt_pk_bf16_f32 v17, v38, v39
v_cvt_pk_bf16_f32 v18, v40, v41
v_cvt_pk_bf16_f32 v19, v42, v43
v_cvt_pk_bf16_f32 v20, v44, v45
v_cvt_pk_bf16_f32 v21, v46, v47
v_cvt_pk_bf16_f32 v22, v48, v49
v_cvt_pk_bf16_f32 v23, v50, v51
v_cvt_pk_bf16_f32 v24, v52, v53
v_cvt_pk_bf16_f32 v25, v54, v55
v_cvt_pk_bf16_f32 v26, v56, v57
v_cvt_pk_bf16_f32 v27, v58, v59
v_cvt_pk_bf16_f32 v28, v60, v61
v_cvt_pk_bf16_f32 v29, v62, v63
v_cvt_pk_bf16_f32 v30, v64, v65
v_cvt_pk_bf16_f32 v31, v66, v67
v_cvt_pk_bf16_f32 v32, v68, v69
v_cvt_pk_bf16_f32 v33, v70, v71
v_cvt_pk_bf16_f32 v34, v72, v73
v_cvt_pk_bf16_f32 v35, v74, v75
v_add_u32 v6, 0x1000, v14
v_add_u32 v7, 0x2000, v14
buffer_store_dwordx4 v[16:19], v14, s[4:7], s34 offen offset:0 sc1
buffer_store_dwordx4 v[20:23], v14, s[4:7], s34 offen offset:2048 sc1
buffer_store_dwordx4 v[24:27], v6, s[4:7], s34 offen offset:0 sc1
buffer_store_dwordx4 v[28:31], v6, s[4:7], s34 offen offset:2048 sc1
buffer_store_dwordx4 v[32:35], v7, s[4:7], s34 offen offset:0 sc1
redln1_exit1:
s_endpgm
.globl redln2_kernel
.p2align 8
.type redln2_kernel,@function
redln2_kernel:
s_cmp_ge_u32 s2, 256
s_cbranch_scc1 redln2_exit1
s_load_dwordx2 s[12:13], s[0:1], 96
s_load_dwordx2 s[14:15], s[0:1], 0
v_lshrrev_b32 v2, 6, v0
v_and_b32 v3, 63, v0
s_lshr_b32 s19, s2, 1
v_readfirstlane_b32 s16, v2
s_and_b32 s18, s2, 1
s_waitcnt lgkmcnt(0)
s_mov_b32 s4, s12
s_mov_b32 s5, s13
s_mov_b32 s6, 0x10000000
s_mov_b32 s7, 0x20000
s_mov_b32 s8, s12
s_mov_b32 s9, s13
s_mov_b32 s10, 0x10000000
s_mov_b32 s11, 0x20000
s_mov_b32 s20, 82313216
v_and_b32 v2, 7, v3
v_bfe_u32 v4, v3, 3, 2
v_lshrrev_b32 v5, 5, v3
s_lshl_b32 s17, s18, 7
v_lshlrev_b32 v14, 4, v2
v_lshl_add_u32 v14, v4, 8, v14
v_lshl_add_u32 v14, v5, 10, v14
v_add_u32 v14, s17, v14
s_lshl_b32 s17, s2, 3
v_add_u32 v15, s17, v2
v_mul_u32_u24 v15, 1280, v15
v_lshl_add_u32 v15, v4, 4, v15
v_lshl_add_u32 v15, v5, 6, v15
s_mul_i32 s17, s16, 640
s_add_u32 s20, s20, s17
s_add_u32 s21, s17, 82313216
s_mul_i32 s22, s19, 20
s_mul_i32 s23, s16, 10
s_add_u32 s22, s22, s23
s_lshl_b32 s22, s22, 10
s_add_u32 s34, s22, 54525952
s_add_u32 s22, s22, 90832896
s_add_u32 s24, s22, 0
s_add_u32 s25, s22, 2621440
s_add_u32 s26, s22, 5242880
s_add_u32 s27, s22, 7864320
s_add_u32 s28, s22, 10485760
s_add_u32 s29, s22, 13107200
s_add_u32 s30, s22, 15728640
s_add_u32 s31, s22, 18350080
v_add_u32 v6, 0x1000, v14
v_add_u32 v7, 0x2000, v14
buffer_load_dwordx4 v[16:19], v15, s[8:11], s20 offen offset:0
buffer_load_dwordx4 v[20:23], v15, s[8:11], s20 offen offset:128
buffer_load_dwordx4 v[24:27], v15, s[8:11], s20 offen offset:256
buffer_load_dwordx4 v[28:31], v15, s[8:11], s20 offen offset:384
buffer_load_dwordx4 v[32:35], v15, s[8:11], s20 offen offset:512
buffer_load_dwordx4 v[80:83], v14, s[4:7], s24 offen offset:0
buffer_load_dwordx4 v[84:87], v14, s[4:7], s25 offen offset:0
buffer_load_dwordx4 v[88:91], v14, s[4:7], s26 offen offset:0
buffer_load_dwordx4 v[92:95], v14, s[4:7], s27 offen offset:0
buffer_load_dwordx4 v[96:99], v14, s[4:7], s28 offen offset:0
buffer_load_dwordx4 v[100:103], v14, s[4:7], s29 offen offset:0
buffer_load_dwordx4 v[104:107], v14, s[4:7], s30 offen offset:0
buffer_load_dwordx4 v[108:111], v14, s[4:7], s31 offen offset:0
buffer_load_dwordx4 v[112:115], v14, s[4:7], s24 offen offset:2048
buffer_load_dwordx4 v[116:119], v14, s[4:7], s25 offen offset:2048
buffer_load_dwordx4 v[120:123], v14, s[4:7], s26 offen offset:2048
buffer_load_dwordx4 v[124:127], v14, s[4:7], s27 offen offset:2048
buffer_load_dwordx4 v[128:131], v14, s[4:7], s28 offen offset:2048
buffer_load_dwordx4 v[132:135], v14, s[4:7], s29 offen offset:2048
buffer_load_dwordx4 v[136:139], v14, s[4:7], s30 offen offset:2048
buffer_load_dwordx4 v[140:143], v14, s[4:7], s31 offen offset:2048
buffer_load_dwordx4 v[144:147], v6, s[4:7], s24 offen offset:0
buffer_load_dwordx4 v[148:151], v6, s[4:7], s25 offen offset:0
buffer_load_dwordx4 v[152:155], v6, s[4:7], s26 offen offset:0
buffer_load_dwordx4 v[156:159], v6, s[4:7], s27 offen offset:0
buffer_load_dwordx4 v[160:163], v6, s[4:7], s28 offen offset:0
buffer_load_dwordx4 v[164:167], v6, s[4:7], s29 offen offset:0
buffer_load_dwordx4 v[168:171], v6, s[4:7], s30 offen offset:0
buffer_load_dwordx4 v[172:175], v6, s[4:7], s31 offen offset:0
buffer_load_dwordx4 v[176:179], v6, s[4:7], s24 offen offset:2048
buffer_load_dwordx4 v[180:183], v6, s[4:7], s25 offen offset:2048
buffer_load_dwordx4 v[184:187], v6, s[4:7], s26 offen offset:2048
buffer_load_dwordx4 v[188:191], v6, s[4:7], s27 offen offset:2048
buffer_load_dwordx4 v[192:195], v6, s[4:7], s28 offen offset:2048
buffer_load_dwordx4 v[196:199], v6, s[4:7], s29 offen offset:2048
buffer_load_dwordx4 v[200:203], v6, s[4:7], s30 offen offset:2048
buffer_load_dwordx4 v[204:207], v6, s[4:7], s31 offen offset:2048
buffer_load_dwordx4 v[208:211], v7, s[4:7], s24 offen offset:0
buffer_load_dwordx4 v[212:215], v7, s[4:7], s25 offen offset:0
buffer_load_dwordx4 v[216:219], v7, s[4:7], s26 offen offset:0
buffer_load_dwordx4 v[220:223], v7, s[4:7], s27 offen offset:0
buffer_load_dwordx4 v[224:227], v7, s[4:7], s28 offen offset:0
buffer_load_dwordx4 v[228:231], v7, s[4:7], s29 offen offset:0
buffer_load_dwordx4 v[232:235], v7, s[4:7], s30 offen offset:0
buffer_load_dwordx4 v[236:239], v7, s[4:7], s31 offen offset:0
s_waitcnt vmcnt(32)
v_lshlrev_b32 v36, 16, v80
v_and_b32 v37, 0xffff0000, v80
v_lshlrev_b32 v38, 16, v81
v_and_b32 v39, 0xffff0000, v81
v_lshlrev_b32 v40, 16, v82
v_and_b32 v41, 0xffff0000, v82
v_lshlrev_b32 v42, 16, v83
v_and_b32 v43, 0xffff0000, v83
v_lshlrev_b32 v8, 16, v84
v_and_b32 v9, 0xffff0000, v84
v_pk_add_f32 v[36:37], v[36:37], v[8:9]
v_lshlrev_b32 v10, 16, v85
v_and_b32 v11, 0xffff0000, v85
v_pk_add_f32 v[38:39], v[38:39], v[10:11]
v_lshlrev_b32 v8, 16, v86
v_and_b32 v9, 0xffff0000, v86
v_pk_add_f32 v[40:41], v[40:41], v[8:9]
v_lshlrev_b32 v10, 16, v87
v_and_b32 v11, 0xffff0000, v87
v_pk_add_f32 v[42:43], v[42:43], v[10:11]
v_lshlrev_b32 v8, 16, v88
v_and_b32 v9, 0xffff0000, v88
v_pk_add_f32 v[36:37], v[36:37], v[8:9]
v_lshlrev_b32 v10, 16, v89
v_and_b32 v11, 0xffff0000, v89
v_pk_add_f32 v[38:39], v[38:39], v[10:11]
v_lshlrev_b32 v8, 16, v90
v_and_b32 v9, 0xffff0000, v90
v_pk_add_f32 v[40:41], v[40:41], v[8:9]
v_lshlrev_b32 v10, 16, v91
v_and_b32 v11, 0xffff0000, v91
v_pk_add_f32 v[42:43], v[42:43], v[10:11]
v_lshlrev_b32 v8, 16, v92
v_and_b32 v9, 0xffff0000, v92
v_pk_add_f32 v[36:37], v[36:37], v[8:9]
v_lshlrev_b32 v10, 16, v93
v_and_b32 v11, 0xffff0000, v93
v_pk_add_f32 v[38:39], v[38:39], v[10:11]
v_lshlrev_b32 v8, 16, v94
v_and_b32 v9, 0xffff0000, v94
v_pk_add_f32 v[40:41], v[40:41], v[8:9]
v_lshlrev_b32 v10, 16, v95
v_and_b32 v11, 0xffff0000, v95
v_pk_add_f32 v[42:43], v[42:43], v[10:11]
v_lshlrev_b32 v8, 16, v96
v_and_b32 v9, 0xffff0000, v96
v_pk_add_f32 v[36:37], v[36:37], v[8:9]
v_lshlrev_b32 v10, 16, v97
v_and_b32 v11, 0xffff0000, v97
v_pk_add_f32 v[38:39], v[38:39], v[10:11]
v_lshlrev_b32 v8, 16, v98
v_and_b32 v9, 0xffff0000, v98
v_pk_add_f32 v[40:41], v[40:41], v[8:9]
v_lshlrev_b32 v10, 16, v99
v_and_b32 v11, 0xffff0000, v99
v_pk_add_f32 v[42:43], v[42:43], v[10:11]
v_lshlrev_b32 v8, 16, v100
v_and_b32 v9, 0xffff0000, v100
v_pk_add_f32 v[36:37], v[36:37], v[8:9]
v_lshlrev_b32 v10, 16, v101
v_and_b32 v11, 0xffff0000, v101
v_pk_add_f32 v[38:39], v[38:39], v[10:11]
v_lshlrev_b32 v8, 16, v102
v_and_b32 v9, 0xffff0000, v102
v_pk_add_f32 v[40:41], v[40:41], v[8:9]
v_lshlrev_b32 v10, 16, v103
v_and_b32 v11, 0xffff0000, v103
v_pk_add_f32 v[42:43], v[42:43], v[10:11]
v_lshlrev_b32 v8, 16, v104
v_and_b32 v9, 0xffff0000, v104
v_pk_add_f32 v[36:37], v[36:37], v[8:9]
v_lshlrev_b32 v10, 16, v105
v_and_b32 v11, 0xffff0000, v105
v_pk_add_f32 v[38:39], v[38:39], v[10:11]
v_lshlrev_b32 v8, 16, v106
v_and_b32 v9, 0xffff0000, v106
v_pk_add_f32 v[40:41], v[40:41], v[8:9]
v_lshlrev_b32 v10, 16, v107
v_and_b32 v11, 0xffff0000, v107
v_pk_add_f32 v[42:43], v[42:43], v[10:11]
v_lshlrev_b32 v8, 16, v108
v_and_b32 v9, 0xffff0000, v108
v_pk_add_f32 v[36:37], v[36:37], v[8:9]
v_lshlrev_b32 v10, 16, v109
v_and_b32 v11, 0xffff0000, v109
v_pk_add_f32 v[38:39], v[38:39], v[10:11]
v_lshlrev_b32 v8, 16, v110
v_and_b32 v9, 0xffff0000, v110
v_pk_add_f32 v[40:41], v[40:41], v[8:9]
v_lshlrev_b32 v10, 16, v111
v_and_b32 v11, 0xffff0000, v111
v_pk_add_f32 v[42:43], v[42:43], v[10:11]
v_cvt_pk_bf16_f32 v8, v36, v37
v_lshlrev_b32 v36, 16, v8
v_and_b32 v37, 0xffff0000, v8
v_lshlrev_b32 v10, 16, v16
v_and_b32 v11, 0xffff0000, v16
v_pk_add_f32 v[36:37], v[36:37], v[10:11]
v_cvt_pk_bf16_f32 v16, v36, v37
v_lshlrev_b32 v36, 16, v16
v_and_b32 v37, 0xffff0000, v16
v_cvt_pk_bf16_f32 v8, v38, v39
v_lshlrev_b32 v38, 16, v8
v_and_b32 v39, 0xffff0000, v8
v_lshlrev_b32 v10, 16, v17
v_and_b32 v11, 0xffff0000, v17
v_pk_add_f32 v[38:39], v[38:39], v[10:11]
v_cvt_pk_bf16_f32 v17, v38, v39
v_lshlrev_b32 v38, 16, v17
v_and_b32 v39, 0xffff0000, v17
v_cvt_pk_bf16_f32 v8, v40, v41
v_lshlrev_b32 v40, 16, v8
v_and_b32 v41, 0xffff0000, v8
v_lshlrev_b32 v10, 16, v18
v_and_b32 v11, 0xffff0000, v18
v_pk_add_f32 v[40:41], v[40:41], v[10:11]
v_cvt_pk_bf16_f32 v18, v40, v41
v_lshlrev_b32 v40, 16, v18
v_and_b32 v41, 0xffff0000, v18
v_cvt_pk_bf16_f32 v8, v42, v43
v_lshlrev_b32 v42, 16, v8
v_and_b32 v43, 0xffff0000, v8
v_lshlrev_b32 v10, 16, v19
v_and_b32 v11, 0xffff0000, v19
v_pk_add_f32 v[42:43], v[42:43], v[10:11]
v_cvt_pk_bf16_f32 v19, v42, v43
v_lshlrev_b32 v42, 16, v19
v_and_b32 v43, 0xffff0000, v19
buffer_store_dwordx4 v[16:19], v15, s[4:7], s21 offen offset:0 sc1
s_waitcnt vmcnt(25)
v_lshlrev_b32 v44, 16, v112
v_and_b32 v45, 0xffff0000, v112
v_lshlrev_b32 v46, 16, v113
v_and_b32 v47, 0xffff0000, v113
v_lshlrev_b32 v48, 16, v114
v_and_b32 v49, 0xffff0000, v114
v_lshlrev_b32 v50, 16, v115
v_and_b32 v51, 0xffff0000, v115
v_lshlrev_b32 v8, 16, v116
v_and_b32 v9, 0xffff0000, v116
v_pk_add_f32 v[44:45], v[44:45], v[8:9]
v_lshlrev_b32 v10, 16, v117
v_and_b32 v11, 0xffff0000, v117
v_pk_add_f32 v[46:47], v[46:47], v[10:11]
v_lshlrev_b32 v8, 16, v118
v_and_b32 v9, 0xffff0000, v118
v_pk_add_f32 v[48:49], v[48:49], v[8:9]
v_lshlrev_b32 v10, 16, v119
v_and_b32 v11, 0xffff0000, v119
v_pk_add_f32 v[50:51], v[50:51], v[10:11]
v_lshlrev_b32 v8, 16, v120
v_and_b32 v9, 0xffff0000, v120
v_pk_add_f32 v[44:45], v[44:45], v[8:9]
v_lshlrev_b32 v10, 16, v121
v_and_b32 v11, 0xffff0000, v121
v_pk_add_f32 v[46:47], v[46:47], v[10:11]
v_lshlrev_b32 v8, 16, v122
v_and_b32 v9, 0xffff0000, v122
v_pk_add_f32 v[48:49], v[48:49], v[8:9]
v_lshlrev_b32 v10, 16, v123
v_and_b32 v11, 0xffff0000, v123
v_pk_add_f32 v[50:51], v[50:51], v[10:11]
v_lshlrev_b32 v8, 16, v124
v_and_b32 v9, 0xffff0000, v124
v_pk_add_f32 v[44:45], v[44:45], v[8:9]
v_lshlrev_b32 v10, 16, v125
v_and_b32 v11, 0xffff0000, v125
v_pk_add_f32 v[46:47], v[46:47], v[10:11]
v_lshlrev_b32 v8, 16, v126
v_and_b32 v9, 0xffff0000, v126
v_pk_add_f32 v[48:49], v[48:49], v[8:9]
v_lshlrev_b32 v10, 16, v127
v_and_b32 v11, 0xffff0000, v127
v_pk_add_f32 v[50:51], v[50:51], v[10:11]
v_lshlrev_b32 v8, 16, v128
v_and_b32 v9, 0xffff0000, v128
v_pk_add_f32 v[44:45], v[44:45], v[8:9]
v_lshlrev_b32 v10, 16, v129
v_and_b32 v11, 0xffff0000, v129
v_pk_add_f32 v[46:47], v[46:47], v[10:11]
v_lshlrev_b32 v8, 16, v130
v_and_b32 v9, 0xffff0000, v130
v_pk_add_f32 v[48:49], v[48:49], v[8:9]
v_lshlrev_b32 v10, 16, v131
v_and_b32 v11, 0xffff0000, v131
v_pk_add_f32 v[50:51], v[50:51], v[10:11]
v_lshlrev_b32 v8, 16, v132
v_and_b32 v9, 0xffff0000, v132
v_pk_add_f32 v[44:45], v[44:45], v[8:9]
v_lshlrev_b32 v10, 16, v133
v_and_b32 v11, 0xffff0000, v133
v_pk_add_f32 v[46:47], v[46:47], v[10:11]
v_lshlrev_b32 v8, 16, v134
v_and_b32 v9, 0xffff0000, v134
v_pk_add_f32 v[48:49], v[48:49], v[8:9]
v_lshlrev_b32 v10, 16, v135
v_and_b32 v11, 0xffff0000, v135
v_pk_add_f32 v[50:51], v[50:51], v[10:11]
v_lshlrev_b32 v8, 16, v136
v_and_b32 v9, 0xffff0000, v136
v_pk_add_f32 v[44:45], v[44:45], v[8:9]
v_lshlrev_b32 v10, 16, v137
v_and_b32 v11, 0xffff0000, v137
v_pk_add_f32 v[46:47], v[46:47], v[10:11]
v_lshlrev_b32 v8, 16, v138
v_and_b32 v9, 0xffff0000, v138
v_pk_add_f32 v[48:49], v[48:49], v[8:9]
v_lshlrev_b32 v10, 16, v139
v_and_b32 v11, 0xffff0000, v139
v_pk_add_f32 v[50:51], v[50:51], v[10:11]
v_lshlrev_b32 v8, 16, v140
v_and_b32 v9, 0xffff0000, v140
v_pk_add_f32 v[44:45], v[44:45], v[8:9]
v_lshlrev_b32 v10, 16, v141
v_and_b32 v11, 0xffff0000, v141
v_pk_add_f32 v[46:47], v[46:47], v[10:11]
v_lshlrev_b32 v8, 16, v142
v_and_b32 v9, 0xffff0000, v142
v_pk_add_f32 v[48:49], v[48:49], v[8:9]
v_lshlrev_b32 v10, 16, v143
v_and_b32 v11, 0xffff0000, v143
v_pk_add_f32 v[50:51], v[50:51], v[10:11]
v_cvt_pk_bf16_f32 v8, v44, v45
v_lshlrev_b32 v44, 16, v8
v_and_b32 v45, 0xffff0000, v8
v_lshlrev_b32 v10, 16, v20
v_and_b32 v11, 0xffff0000, v20
v_pk_add_f32 v[44:45], v[44:45], v[10:11]
v_cvt_pk_bf16_f32 v20, v44, v45
v_lshlrev_b32 v44, 16, v20
v_and_b32 v45, 0xffff0000, v20
v_cvt_pk_bf16_f32 v8, v46, v47
v_lshlrev_b32 v46, 16, v8
v_and_b32 v47, 0xffff0000, v8
v_lshlrev_b32 v10, 16, v21
v_and_b32 v11, 0xffff0000, v21
v_pk_add_f32 v[46:47], v[46:47], v[10:11]
v_cvt_pk_bf16_f32 v21, v46, v47
v_lshlrev_b32 v46, 16, v21
v_and_b32 v47, 0xffff0000, v21
v_cvt_pk_bf16_f32 v8, v48, v49
v_lshlrev_b32 v48, 16, v8
v_and_b32 v49, 0xffff0000, v8
v_lshlrev_b32 v10, 16, v22
v_and_b32 v11, 0xffff0000, v22
v_pk_add_f32 v[48:49], v[48:49], v[10:11]
v_cvt_pk_bf16_f32 v22, v48, v49
v_lshlrev_b32 v48, 16, v22
v_and_b32 v49, 0xffff0000, v22
v_cvt_pk_bf16_f32 v8, v50, v51
v_lshlrev_b32 v50, 16, v8
v_and_b32 v51, 0xffff0000, v8
v_lshlrev_b32 v10, 16, v23
v_and_b32 v11, 0xffff0000, v23
v_pk_add_f32 v[50:51], v[50:51], v[10:11]
v_cvt_pk_bf16_f32 v23, v50, v51
v_lshlrev_b32 v50, 16, v23
v_and_b32 v51, 0xffff0000, v23
buffer_store_dwordx4 v[20:23], v15, s[4:7], s21 offen offset:128 sc1
s_waitcnt vmcnt(18)
v_lshlrev_b32 v52, 16, v144
v_and_b32 v53, 0xffff0000, v144
v_lshlrev_b32 v54, 16, v145
v_and_b32 v55, 0xffff0000, v145
v_lshlrev_b32 v56, 16, v146
v_and_b32 v57, 0xffff0000, v146
v_lshlrev_b32 v58, 16, v147
v_and_b32 v59, 0xffff0000, v147
v_lshlrev_b32 v8, 16, v148
v_and_b32 v9, 0xffff0000, v148
v_pk_add_f32 v[52:53], v[52:53], v[8:9]
v_lshlrev_b32 v10, 16, v149
v_and_b32 v11, 0xffff0000, v149
v_pk_add_f32 v[54:55], v[54:55], v[10:11]
v_lshlrev_b32 v8, 16, v150
v_and_b32 v9, 0xffff0000, v150
v_pk_add_f32 v[56:57], v[56:57], v[8:9]
v_lshlrev_b32 v10, 16, v151
v_and_b32 v11, 0xffff0000, v151
v_pk_add_f32 v[58:59], v[58:59], v[10:11]
v_lshlrev_b32 v8, 16, v152
v_and_b32 v9, 0xffff0000, v152
v_pk_add_f32 v[52:53], v[52:53], v[8:9]
v_lshlrev_b32 v10, 16, v153
v_and_b32 v11, 0xffff0000, v153
v_pk_add_f32 v[54:55], v[54:55], v[10:11]
v_lshlrev_b32 v8, 16, v154
v_and_b32 v9, 0xffff0000, v154
v_pk_add_f32 v[56:57], v[56:57], v[8:9]
v_lshlrev_b32 v10, 16, v155
v_and_b32 v11, 0xffff0000, v155
v_pk_add_f32 v[58:59], v[58:59], v[10:11]
v_lshlrev_b32 v8, 16, v156
v_and_b32 v9, 0xffff0000, v156
v_pk_add_f32 v[52:53], v[52:53], v[8:9]
v_lshlrev_b32 v10, 16, v157
v_and_b32 v11, 0xffff0000, v157
v_pk_add_f32 v[54:55], v[54:55], v[10:11]
v_lshlrev_b32 v8, 16, v158
v_and_b32 v9, 0xffff0000, v158
v_pk_add_f32 v[56:57], v[56:57], v[8:9]
v_lshlrev_b32 v10, 16, v159
v_and_b32 v11, 0xffff0000, v159
v_pk_add_f32 v[58:59], v[58:59], v[10:11]
v_lshlrev_b32 v8, 16, v160
v_and_b32 v9, 0xffff0000, v160
v_pk_add_f32 v[52:53], v[52:53], v[8:9]
v_lshlrev_b32 v10, 16, v161
v_and_b32 v11, 0xffff0000, v161
v_pk_add_f32 v[54:55], v[54:55], v[10:11]
v_lshlrev_b32 v8, 16, v162
v_and_b32 v9, 0xffff0000, v162
v_pk_add_f32 v[56:57], v[56:57], v[8:9]
v_lshlrev_b32 v10, 16, v163
v_and_b32 v11, 0xffff0000, v163
v_pk_add_f32 v[58:59], v[58:59], v[10:11]
v_lshlrev_b32 v8, 16, v164
v_and_b32 v9, 0xffff0000, v164
v_pk_add_f32 v[52:53], v[52:53], v[8:9]
v_lshlrev_b32 v10, 16, v165
v_and_b32 v11, 0xffff0000, v165
v_pk_add_f32 v[54:55], v[54:55], v[10:11]
v_lshlrev_b32 v8, 16, v166
v_and_b32 v9, 0xffff0000, v166
v_pk_add_f32 v[56:57], v[56:57], v[8:9]
v_lshlrev_b32 v10, 16, v167
v_and_b32 v11, 0xffff0000, v167
v_pk_add_f32 v[58:59], v[58:59], v[10:11]
v_lshlrev_b32 v8, 16, v168
v_and_b32 v9, 0xffff0000, v168
v_pk_add_f32 v[52:53], v[52:53], v[8:9]
v_lshlrev_b32 v10, 16, v169
v_and_b32 v11, 0xffff0000, v169
v_pk_add_f32 v[54:55], v[54:55], v[10:11]
v_lshlrev_b32 v8, 16, v170
v_and_b32 v9, 0xffff0000, v170
v_pk_add_f32 v[56:57], v[56:57], v[8:9]
v_lshlrev_b32 v10, 16, v171
v_and_b32 v11, 0xffff0000, v171
v_pk_add_f32 v[58:59], v[58:59], v[10:11]
v_lshlrev_b32 v8, 16, v172
v_and_b32 v9, 0xffff0000, v172
v_pk_add_f32 v[52:53], v[52:53], v[8:9]
v_lshlrev_b32 v10, 16, v173
v_and_b32 v11, 0xffff0000, v173
v_pk_add_f32 v[54:55], v[54:55], v[10:11]
v_lshlrev_b32 v8, 16, v174
v_and_b32 v9, 0xffff0000, v174
v_pk_add_f32 v[56:57], v[56:57], v[8:9]
v_lshlrev_b32 v10, 16, v175
v_and_b32 v11, 0xffff0000, v175
v_pk_add_f32 v[58:59], v[58:59], v[10:11]
v_cvt_pk_bf16_f32 v8, v52, v53
v_lshlrev_b32 v52, 16, v8
v_and_b32 v53, 0xffff0000, v8
v_lshlrev_b32 v10, 16, v24
v_and_b32 v11, 0xffff0000, v24
v_pk_add_f32 v[52:53], v[52:53], v[10:11]
v_cvt_pk_bf16_f32 v24, v52, v53
v_lshlrev_b32 v52, 16, v24
v_and_b32 v53, 0xffff0000, v24
v_cvt_pk_bf16_f32 v8, v54, v55
v_lshlrev_b32 v54, 16, v8
v_and_b32 v55, 0xffff0000, v8
v_lshlrev_b32 v10, 16, v25
v_and_b32 v11, 0xffff0000, v25
v_pk_add_f32 v[54:55], v[54:55], v[10:11]
v_cvt_pk_bf16_f32 v25, v54, v55
v_lshlrev_b32 v54, 16, v25
v_and_b32 v55, 0xffff0000, v25
v_cvt_pk_bf16_f32 v8, v56, v57
v_lshlrev_b32 v56, 16, v8
v_and_b32 v57, 0xffff0000, v8
v_lshlrev_b32 v10, 16, v26
v_and_b32 v11, 0xffff0000, v26
v_pk_add_f32 v[56:57], v[56:57], v[10:11]
v_cvt_pk_bf16_f32 v26, v56, v57
v_lshlrev_b32 v56, 16, v26
v_and_b32 v57, 0xffff0000, v26
v_cvt_pk_bf16_f32 v8, v58, v59
v_lshlrev_b32 v58, 16, v8
v_and_b32 v59, 0xffff0000, v8
v_lshlrev_b32 v10, 16, v27
v_and_b32 v11, 0xffff0000, v27
v_pk_add_f32 v[58:59], v[58:59], v[10:11]
v_cvt_pk_bf16_f32 v27, v58, v59
v_lshlrev_b32 v58, 16, v27
v_and_b32 v59, 0xffff0000, v27
buffer_store_dwordx4 v[24:27], v15, s[4:7], s21 offen offset:256 sc1
s_waitcnt vmcnt(11)
v_lshlrev_b32 v60, 16, v176
v_and_b32 v61, 0xffff0000, v176
v_lshlrev_b32 v62, 16, v177
v_and_b32 v63, 0xffff0000, v177
v_lshlrev_b32 v64, 16, v178
v_and_b32 v65, 0xffff0000, v178
v_lshlrev_b32 v66, 16, v179
v_and_b32 v67, 0xffff0000, v179
v_lshlrev_b32 v8, 16, v180
v_and_b32 v9, 0xffff0000, v180
v_pk_add_f32 v[60:61], v[60:61], v[8:9]
v_lshlrev_b32 v10, 16, v181
v_and_b32 v11, 0xffff0000, v181
v_pk_add_f32 v[62:63], v[62:63], v[10:11]
v_lshlrev_b32 v8, 16, v182
v_and_b32 v9, 0xffff0000, v182
v_pk_add_f32 v[64:65], v[64:65], v[8:9]
v_lshlrev_b32 v10, 16, v183
v_and_b32 v11, 0xffff0000, v183
v_pk_add_f32 v[66:67], v[66:67], v[10:11]
v_lshlrev_b32 v8, 16, v184
v_and_b32 v9, 0xffff0000, v184
v_pk_add_f32 v[60:61], v[60:61], v[8:9]
v_lshlrev_b32 v10, 16, v185
v_and_b32 v11, 0xffff0000, v185
v_pk_add_f32 v[62:63], v[62:63], v[10:11]
v_lshlrev_b32 v8, 16, v186
v_and_b32 v9, 0xffff0000, v186
v_pk_add_f32 v[64:65], v[64:65], v[8:9]
v_lshlrev_b32 v10, 16, v187
v_and_b32 v11, 0xffff0000, v187
v_pk_add_f32 v[66:67], v[66:67], v[10:11]
v_lshlrev_b32 v8, 16, v188
v_and_b32 v9, 0xffff0000, v188
v_pk_add_f32 v[60:61], v[60:61], v[8:9]
v_lshlrev_b32 v10, 16, v189
v_and_b32 v11, 0xffff0000, v189
v_pk_add_f32 v[62:63], v[62:63], v[10:11]
v_lshlrev_b32 v8, 16, v190
v_and_b32 v9, 0xffff0000, v190
v_pk_add_f32 v[64:65], v[64:65], v[8:9]
v_lshlrev_b32 v10, 16, v191
v_and_b32 v11, 0xffff0000, v191
v_pk_add_f32 v[66:67], v[66:67], v[10:11]
v_lshlrev_b32 v8, 16, v192
v_and_b32 v9, 0xffff0000, v192
v_pk_add_f32 v[60:61], v[60:61], v[8:9]
v_lshlrev_b32 v10, 16, v193
v_and_b32 v11, 0xffff0000, v193
v_pk_add_f32 v[62:63], v[62:63], v[10:11]
v_lshlrev_b32 v8, 16, v194
v_and_b32 v9, 0xffff0000, v194
v_pk_add_f32 v[64:65], v[64:65], v[8:9]
v_lshlrev_b32 v10, 16, v195
v_and_b32 v11, 0xffff0000, v195
v_pk_add_f32 v[66:67], v[66:67], v[10:11]
v_lshlrev_b32 v8, 16, v196
v_and_b32 v9, 0xffff0000, v196
v_pk_add_f32 v[60:61], v[60:61], v[8:9]
v_lshlrev_b32 v10, 16, v197
v_and_b32 v11, 0xffff0000, v197
v_pk_add_f32 v[62:63], v[62:63], v[10:11]
v_lshlrev_b32 v8, 16, v198
v_and_b32 v9, 0xffff0000, v198
v_pk_add_f32 v[64:65], v[64:65], v[8:9]
v_lshlrev_b32 v10, 16, v199
v_and_b32 v11, 0xffff0000, v199
v_pk_add_f32 v[66:67], v[66:67], v[10:11]
v_lshlrev_b32 v8, 16, v200
v_and_b32 v9, 0xffff0000, v200
v_pk_add_f32 v[60:61], v[60:61], v[8:9]
v_lshlrev_b32 v10, 16, v201
v_and_b32 v11, 0xffff0000, v201
v_pk_add_f32 v[62:63], v[62:63], v[10:11]
v_lshlrev_b32 v8, 16, v202
v_and_b32 v9, 0xffff0000, v202
v_pk_add_f32 v[64:65], v[64:65], v[8:9]
v_lshlrev_b32 v10, 16, v203
v_and_b32 v11, 0xffff0000, v203
v_pk_add_f32 v[66:67], v[66:67], v[10:11]
v_lshlrev_b32 v8, 16, v204
v_and_b32 v9, 0xffff0000, v204
v_pk_add_f32 v[60:61], v[60:61], v[8:9]
v_lshlrev_b32 v10, 16, v205
v_and_b32 v11, 0xffff0000, v205
v_pk_add_f32 v[62:63], v[62:63], v[10:11]
v_lshlrev_b32 v8, 16, v206
v_and_b32 v9, 0xffff0000, v206
v_pk_add_f32 v[64:65], v[64:65], v[8:9]
v_lshlrev_b32 v10, 16, v207
v_and_b32 v11, 0xffff0000, v207
v_pk_add_f32 v[66:67], v[66:67], v[10:11]
v_cvt_pk_bf16_f32 v8, v60, v61
v_lshlrev_b32 v60, 16, v8
v_and_b32 v61, 0xffff0000, v8
v_lshlrev_b32 v10, 16, v28
v_and_b32 v11, 0xffff0000, v28
v_pk_add_f32 v[60:61], v[60:61], v[10:11]
v_cvt_pk_bf16_f32 v28, v60, v61
v_lshlrev_b32 v60, 16, v28
v_and_b32 v61, 0xffff0000, v28
v_cvt_pk_bf16_f32 v8, v62, v63
v_lshlrev_b32 v62, 16, v8
v_and_b32 v63, 0xffff0000, v8
v_lshlrev_b32 v10, 16, v29
v_and_b32 v11, 0xffff0000, v29
v_pk_add_f32 v[62:63], v[62:63], v[10:11]
v_cvt_pk_bf16_f32 v29, v62, v63
v_lshlrev_b32 v62, 16, v29
v_and_b32 v63, 0xffff0000, v29
v_cvt_pk_bf16_f32 v8, v64, v65
v_lshlrev_b32 v64, 16, v8
v_and_b32 v65, 0xffff0000, v8
v_lshlrev_b32 v10, 16, v30
v_and_b32 v11, 0xffff0000, v30
v_pk_add_f32 v[64:65], v[64:65], v[10:11]
v_cvt_pk_bf16_f32 v30, v64, v65
v_lshlrev_b32 v64, 16, v30
v_and_b32 v65, 0xffff0000, v30
v_cvt_pk_bf16_f32 v8, v66, v67
v_lshlrev_b32 v66, 16, v8
v_and_b32 v67, 0xffff0000, v8
v_lshlrev_b32 v10, 16, v31
v_and_b32 v11, 0xffff0000, v31
v_pk_add_f32 v[66:67], v[66:67], v[10:11]
v_cvt_pk_bf16_f32 v31, v66, v67
v_lshlrev_b32 v66, 16, v31
v_and_b32 v67, 0xffff0000, v31
buffer_store_dwordx4 v[28:31], v15, s[4:7], s21 offen offset:384 sc1
s_waitcnt vmcnt(4)
v_lshlrev_b32 v68, 16, v208
v_and_b32 v69, 0xffff0000, v208
v_lshlrev_b32 v70, 16, v209
v_and_b32 v71, 0xffff0000, v209
v_lshlrev_b32 v72, 16, v210
v_and_b32 v73, 0xffff0000, v210
v_lshlrev_b32 v74, 16, v211
v_and_b32 v75, 0xffff0000, v211
v_lshlrev_b32 v8, 16, v212
v_and_b32 v9, 0xffff0000, v212
v_pk_add_f32 v[68:69], v[68:69], v[8:9]
v_lshlrev_b32 v10, 16, v213
v_and_b32 v11, 0xffff0000, v213
v_pk_add_f32 v[70:71], v[70:71], v[10:11]
v_lshlrev_b32 v8, 16, v214
v_and_b32 v9, 0xffff0000, v214
v_pk_add_f32 v[72:73], v[72:73], v[8:9]
v_lshlrev_b32 v10, 16, v215
v_and_b32 v11, 0xffff0000, v215
v_pk_add_f32 v[74:75], v[74:75], v[10:11]
v_lshlrev_b32 v8, 16, v216
v_and_b32 v9, 0xffff0000, v216
v_pk_add_f32 v[68:69], v[68:69], v[8:9]
v_lshlrev_b32 v10, 16, v217
v_and_b32 v11, 0xffff0000, v217
v_pk_add_f32 v[70:71], v[70:71], v[10:11]
v_lshlrev_b32 v8, 16, v218
v_and_b32 v9, 0xffff0000, v218
v_pk_add_f32 v[72:73], v[72:73], v[8:9]
v_lshlrev_b32 v10, 16, v219
v_and_b32 v11, 0xffff0000, v219
v_pk_add_f32 v[74:75], v[74:75], v[10:11]
v_lshlrev_b32 v8, 16, v220
v_and_b32 v9, 0xffff0000, v220
v_pk_add_f32 v[68:69], v[68:69], v[8:9]
v_lshlrev_b32 v10, 16, v221
v_and_b32 v11, 0xffff0000, v221
v_pk_add_f32 v[70:71], v[70:71], v[10:11]
v_lshlrev_b32 v8, 16, v222
v_and_b32 v9, 0xffff0000, v222
v_pk_add_f32 v[72:73], v[72:73], v[8:9]
v_lshlrev_b32 v10, 16, v223
v_and_b32 v11, 0xffff0000, v223
v_pk_add_f32 v[74:75], v[74:75], v[10:11]
v_lshlrev_b32 v8, 16, v224
v_and_b32 v9, 0xffff0000, v224
v_pk_add_f32 v[68:69], v[68:69], v[8:9]
v_lshlrev_b32 v10, 16, v225
v_and_b32 v11, 0xffff0000, v225
v_pk_add_f32 v[70:71], v[70:71], v[10:11]
v_lshlrev_b32 v8, 16, v226
v_and_b32 v9, 0xffff0000, v226
v_pk_add_f32 v[72:73], v[72:73], v[8:9]
v_lshlrev_b32 v10, 16, v227
v_and_b32 v11, 0xffff0000, v227
v_pk_add_f32 v[74:75], v[74:75], v[10:11]
v_lshlrev_b32 v8, 16, v228
v_and_b32 v9, 0xffff0000, v228
v_pk_add_f32 v[68:69], v[68:69], v[8:9]
v_lshlrev_b32 v10, 16, v229
v_and_b32 v11, 0xffff0000, v229
v_pk_add_f32 v[70:71], v[70:71], v[10:11]
v_lshlrev_b32 v8, 16, v230
v_and_b32 v9, 0xffff0000, v230
v_pk_add_f32 v[72:73], v[72:73], v[8:9]
v_lshlrev_b32 v10, 16, v231
v_and_b32 v11, 0xffff0000, v231
v_pk_add_f32 v[74:75], v[74:75], v[10:11]
v_lshlrev_b32 v8, 16, v232
v_and_b32 v9, 0xffff0000, v232
v_pk_add_f32 v[68:69], v[68:69], v[8:9]
v_lshlrev_b32 v10, 16, v233
v_and_b32 v11, 0xffff0000, v233
v_pk_add_f32 v[70:71], v[70:71], v[10:11]
v_lshlrev_b32 v8, 16, v234
v_and_b32 v9, 0xffff0000, v234
v_pk_add_f32 v[72:73], v[72:73], v[8:9]
v_lshlrev_b32 v10, 16, v235
v_and_b32 v11, 0xffff0000, v235
v_pk_add_f32 v[74:75], v[74:75], v[10:11]
v_lshlrev_b32 v8, 16, v236
v_and_b32 v9, 0xffff0000, v236
v_pk_add_f32 v[68:69], v[68:69], v[8:9]
v_lshlrev_b32 v10, 16, v237
v_and_b32 v11, 0xffff0000, v237
v_pk_add_f32 v[70:71], v[70:71], v[10:11]
v_lshlrev_b32 v8, 16, v238
v_and_b32 v9, 0xffff0000, v238
v_pk_add_f32 v[72:73], v[72:73], v[8:9]
v_lshlrev_b32 v10, 16, v239
v_and_b32 v11, 0xffff0000, v239
v_pk_add_f32 v[74:75], v[74:75], v[10:11]
v_cvt_pk_bf16_f32 v8, v68, v69
v_lshlrev_b32 v68, 16, v8
v_and_b32 v69, 0xffff0000, v8
v_lshlrev_b32 v10, 16, v32
v_and_b32 v11, 0xffff0000, v32
v_pk_add_f32 v[68:69], v[68:69], v[10:11]
v_cvt_pk_bf16_f32 v32, v68, v69
v_lshlrev_b32 v68, 16, v32
v_and_b32 v69, 0xffff0000, v32
v_cvt_pk_bf16_f32 v8, v70, v71
v_lshlrev_b32 v70, 16, v8
v_and_b32 v71, 0xffff0000, v8
v_lshlrev_b32 v10, 16, v33
v_and_b32 v11, 0xffff0000, v33
v_pk_add_f32 v[70:71], v[70:71], v[10:11]
v_cvt_pk_bf16_f32 v33, v70, v71
v_lshlrev_b32 v70, 16, v33
v_and_b32 v71, 0xffff0000, v33
v_cvt_pk_bf16_f32 v8, v72, v73
v_lshlrev_b32 v72, 16, v8
v_and_b32 v73, 0xffff0000, v8
v_lshlrev_b32 v10, 16, v34
v_and_b32 v11, 0xffff0000, v34
v_pk_add_f32 v[72:73], v[72:73], v[10:11]
v_cvt_pk_bf16_f32 v34, v72, v73
v_lshlrev_b32 v72, 16, v34
v_and_b32 v73, 0xffff0000, v34
v_cvt_pk_bf16_f32 v8, v74, v75
v_lshlrev_b32 v74, 16, v8
v_and_b32 v75, 0xffff0000, v8
v_lshlrev_b32 v10, 16, v35
v_and_b32 v11, 0xffff0000, v35
v_pk_add_f32 v[74:75], v[74:75], v[10:11]
v_cvt_pk_bf16_f32 v35, v74, v75
v_lshlrev_b32 v74, 16, v35
v_and_b32 v75, 0xffff0000, v35
buffer_store_dwordx4 v[32:35], v15, s[4:7], s21 offen offset:512 sc1
v_and_b32 v3, 63, v0
v_and_b32 v2, 7, v3
v_lshlrev_b32 v5, 2, v2
s_lshl_b32 s17, s16, 5
v_add_u32 v1, s17, v5
v_pk_add_f32 v[6:7], v[36:37], v[38:39]
v_pk_add_f32 v[6:7], v[6:7], v[40:41]
v_pk_add_f32 v[6:7], v[6:7], v[42:43]
v_pk_add_f32 v[6:7], v[6:7], v[44:45]
v_pk_add_f32 v[6:7], v[6:7], v[46:47]
v_pk_add_f32 v[6:7], v[6:7], v[48:49]
v_pk_add_f32 v[6:7], v[6:7], v[50:51]
v_pk_add_f32 v[6:7], v[6:7], v[52:53]
v_pk_add_f32 v[6:7], v[6:7], v[54:55]
v_pk_add_f32 v[6:7], v[6:7], v[56:57]
v_pk_add_f32 v[6:7], v[6:7], v[58:59]
v_pk_add_f32 v[6:7], v[6:7], v[60:61]
v_pk_add_f32 v[6:7], v[6:7], v[62:63]
v_pk_add_f32 v[6:7], v[6:7], v[64:65]
v_pk_add_f32 v[6:7], v[6:7], v[66:67]
v_pk_add_f32 v[6:7], v[6:7], v[68:69]
v_pk_add_f32 v[6:7], v[6:7], v[70:71]
v_pk_add_f32 v[6:7], v[6:7], v[72:73]
v_pk_add_f32 v[6:7], v[6:7], v[74:75]
v_add_f32 v4, v6, v7
s_nop 1
v_add_f32_dpp v4, v4, v4 row_ror:8 row_mask:0xf bank_mask:0xf
v_mov_b32 v2, v4
s_nop 1
v_permlane16_swap_b32 v4, v2
v_add_f32 v4, v4, v2
v_mov_b32 v2, v4
s_nop 1
v_permlane32_swap_b32 v4, v2
v_add_f32 v4, v4, v2
ds_write_b32 v1, v4 offset:0
s_waitcnt lgkmcnt(0)
s_barrier
ds_read_b32 v4, v5 offset:0
ds_read_b32 v2, v5 offset:32
s_waitcnt lgkmcnt(0)
v_add_f32 v4, v4, v2
v_mul_f32 v6, 0xbacccccd, v4
v_mov_b32 v7, v6
v_pk_add_f32 v[36:37], v[36:37], v[6:7]
v_pk_add_f32 v[38:39], v[38:39], v[6:7]
v_pk_add_f32 v[40:41], v[40:41], v[6:7]
v_pk_add_f32 v[42:43], v[42:43], v[6:7]
v_pk_add_f32 v[44:45], v[44:45], v[6:7]
v_pk_add_f32 v[46:47], v[46:47], v[6:7]
v_pk_add_f32 v[48:49], v[48:49], v[6:7]
v_pk_add_f32 v[50:51], v[50:51], v[6:7]
v_pk_add_f32 v[52:53], v[52:53], v[6:7]
v_pk_add_f32 v[54:55], v[54:55], v[6:7]
v_pk_add_f32 v[56:57], v[56:57], v[6:7]
v_pk_add_f32 v[58:59], v[58:59], v[6:7]
v_pk_add_f32 v[60:61], v[60:61], v[6:7]
v_pk_add_f32 v[62:63], v[62:63], v[6:7]
v_pk_add_f32 v[64:65], v[64:65], v[6:7]
v_pk_add_f32 v[66:67], v[66:67], v[6:7]
v_pk_add_f32 v[68:69], v[68:69], v[6:7]
v_pk_add_f32 v[70:71], v[70:71], v[6:7]
v_pk_add_f32 v[72:73], v[72:73], v[6:7]
v_pk_add_f32 v[74:75], v[74:75], v[6:7]
v_pk_mul_f32 v[6:7], v[36:37], v[36:37]
v_pk_fma_f32 v[6:7], v[38:39], v[38:39], v[6:7]
v_pk_fma_f32 v[6:7], v[40:41], v[40:41], v[6:7]
v_pk_fma_f32 v[6:7], v[42:43], v[42:43], v[6:7]
v_pk_fma_f32 v[6:7], v[44:45], v[44:45], v[6:7]
v_pk_fma_f32 v[6:7], v[46:47], v[46:47], v[6:7]
v_pk_fma_f32 v[6:7], v[48:49], v[48:49], v[6:7]
v_pk_fma_f32 v[6:7], v[50:51], v[50:51], v[6:7]
v_pk_fma_f32 v[6:7], v[52:53], v[52:53], v[6:7]
v_pk_fma_f32 v[6:7], v[54:55], v[54:55], v[6:7]
v_pk_fma_f32 v[6:7], v[56:57], v[56:57], v[6:7]
v_pk_fma_f32 v[6:7], v[58:59], v[58:59], v[6:7]
v_pk_fma_f32 v[6:7], v[60:61], v[60:61], v[6:7]
v_pk_fma_f32 v[6:7], v[62:63], v[62:63], v[6:7]
v_pk_fma_f32 v[6:7], v[64:65], v[64:65], v[6:7]
v_pk_fma_f32 v[6:7], v[66:67], v[66:67], v[6:7]
v_pk_fma_f32 v[6:7], v[68:69], v[68:69], v[6:7]
v_pk_fma_f32 v[6:7], v[70:71], v[70:71], v[6:7]
v_pk_fma_f32 v[6:7], v[72:73], v[72:73], v[6:7]
v_pk_fma_f32 v[6:7], v[74:75], v[74:75], v[6:7]
v_add_f32 v4, v6, v7
s_nop 1
v_add_f32_dpp v4, v4, v4 row_ror:8 row_mask:0xf bank_mask:0xf
v_mov_b32 v2, v4
s_nop 1
v_permlane16_swap_b32 v4, v2
v_add_f32 v4, v4, v2
v_mov_b32 v2, v4
s_nop 1
v_permlane32_swap_b32 v4, v2
v_add_f32 v4, v4, v2
ds_write_b32 v1, v4 offset:64
s_waitcnt lgkmcnt(0)
s_barrier
ds_read_b32 v4, v5 offset:64
ds_read_b32 v2, v5 offset:96
s_waitcnt lgkmcnt(0)
v_add_f32 v4, v4, v2
v_mov_b32 v2, 0x3727c5ac
v_fmac_f32 v2, 0x3acccccd, v4
v_rsq_f32 v6, v2
s_nop 0
v_mov_b32 v7, v6
v_pk_mul_f32 v[36:37], v[36:37], v[6:7]
v_pk_mul_f32 v[38:39], v[38:39], v[6:7]
v_pk_mul_f32 v[40:41], v[40:41], v[6:7]
v_pk_mul_f32 v[42:43], v[42:43], v[6:7]
v_pk_mul_f32 v[44:45], v[44:45], v[6:7]
v_pk_mul_f32 v[46:47], v[46:47], v[6:7]
v_pk_mul_f32 v[48:49], v[48:49], v[6:7]
v_pk_mul_f32 v[50:51], v[50:51], v[6:7]
v_pk_mul_f32 v[52:53], v[52:53], v[6:7]
v_pk_mul_f32 v[54:55], v[54:55], v[6:7]
v_pk_mul_f32 v[56:57], v[56:57], v[6:7]
v_pk_mul_f32 v[58:59], v[58:59], v[6:7]
v_pk_mul_f32 v[60:61], v[60:61], v[6:7]
v_pk_mul_f32 v[62:63], v[62:63], v[6:7]
v_pk_mul_f32 v[64:65], v[64:65], v[6:7]
v_pk_mul_f32 v[66:67], v[66:67], v[6:7]
v_pk_mul_f32 v[68:69], v[68:69], v[6:7]
v_pk_mul_f32 v[70:71], v[70:71], v[6:7]
v_pk_mul_f32 v[72:73], v[72:73], v[6:7]
v_pk_mul_f32 v[74:75], v[74:75], v[6:7]
v_cvt_pk_bf16_f32 v16, v36, v37
v_cvt_pk_bf16_f32 v17, v38, v39
v_cvt_pk_bf16_f32 v18, v40, v41
v_cvt_pk_bf16_f32 v19, v42, v43
v_cvt_pk_bf16_f32 v20, v44, v45
v_cvt_pk_bf16_f32 v21, v46, v47
v_cvt_pk_bf16_f32 v22, v48, v49
v_cvt_pk_bf16_f32 v23, v50, v51
v_cvt_pk_bf16_f32 v24, v52, v53
v_cvt_pk_bf16_f32 v25, v54, v55
v_cvt_pk_bf16_f32 v26, v56, v57
v_cvt_pk_bf16_f32 v27, v58, v59
v_cvt_pk_bf16_f32 v28, v60, v61
v_cvt_pk_bf16_f32 v29, v62, v63
v_cvt_pk_bf16_f32 v30, v64, v65
v_cvt_pk_bf16_f32 v31, v66, v67
v_cvt_pk_bf16_f32 v32, v68, v69
v_cvt_pk_bf16_f32 v33, v70, v71
v_cvt_pk_bf16_f32 v34, v72, v73
v_cvt_pk_bf16_f32 v35, v74, v75
v_add_u32 v6, 0x1000, v14
v_add_u32 v7, 0x2000, v14
buffer_store_dwordx4 v[16:19], v14, s[4:7], s34 offen offset:0 sc1
buffer_store_dwordx4 v[20:23], v14, s[4:7], s34 offen offset:2048 sc1
buffer_store_dwordx4 v[24:27], v6, s[4:7], s34 offen offset:0 sc1
buffer_store_dwordx4 v[28:31], v6, s[4:7], s34 offen offset:2048 sc1
buffer_store_dwordx4 v[32:35], v7, s[4:7], s34 offen offset:0 sc1
redln2_exit1:
s_endpgm
.globl qkvb_kernel
.p2align 8
.type qkvb_kernel,@function
qkvb_kernel:
s_cmp_ge_u32 s2, 256
s_cbranch_scc1 qkvb_exit1
s_load_dwordx2 s[12:13], s[0:1], 96
v_lshrrev_b32 v2, 6, v0
v_and_b32 v3, 63, v0
s_and_b32 s17, s2, 7
v_readfirstlane_b32 s16, v2
v_lshlrev_b32 v1, 4, v3
s_lshr_b32 s18, s2, 3
s_waitcnt lgkmcnt(0)
s_mov_b32 s4, s12
s_mov_b32 s5, s13
s_mov_b32 s6, 0x10000000
s_mov_b32 s7, 0x20000
s_lshl_b32 s21, s18, 2
s_add_u32 s21, s21, s16
s_mul_i32 s21, s21, 20480
s_add_u32 s21, s21, 54525952
s_mul_i32 s22, s16, 20480
v_add_u32 v7, 40960, v1
v_mov_b32 v6, v1
s_add_u32 m0, s22, 0
s_add_u32 s23, s21, 0
buffer_load_dwordx4 v1, s[4:7], s23 offen offset:0 lds
buffer_load_dwordx4 v1, s[4:7], s23 offen offset:1024 lds
buffer_load_dwordx4 v1, s[4:7], s23 offen offset:2048 lds
buffer_load_dwordx4 v1, s[4:7], s23 offen offset:3072 lds
s_cmp_eq_u32 s16, 0
s_cbranch_scc1 qkvb_w0_2
s_cmp_eq_u32 s16, 1
s_cbranch_scc1 qkvb_w1_3
s_cmp_eq_u32 s16, 2
s_cbranch_scc1 qkvb_w2_4
s_branch qkvb_w3_5
qkvb_w0_2:
s_mul_i32 s30, s17, 5
s_add_u32 s30, s30, 0
s_mul_i32 s30, s30, 20480
s_add_u32 s30, s30, 87556096
s_mul_i32 s31, s17, 5
s_add_u32 s31, s31, 1
s_mul_i32 s31, s31, 20480
s_add_u32 s31, s31, 87556096
s_mul_i32 s32, s17, 5
s_add_u32 s32, s32, 2
s_mul_i32 s32, s32, 20480
s_add_u32 s32, s32, 87556096
s_mul_i32 s33, s17, 5
s_add_u32 s33, s33, 3
s_mul_i32 s33, s33, 20480
s_add_u32 s33, s33, 87556096
buffer_load_dwordx4 v[72:75], v1, s[4:7], s30 offen offset:0
buffer_load_dwordx4 v[76:79], v1, s[4:7], s31 offen offset:0
buffer_load_dwordx4 v[80:83], v1, s[4:7], s32 offen offset:0
buffer_load_dwordx4 v[84:87], v1, s[4:7], s33 offen offset:0
buffer_load_dwordx4 v[88:91], v1, s[4:7], s30 offen offset:1024
buffer_load_dwordx4 v[92:95], v1, s[4:7], s31 offen offset:1024
buffer_load_dwordx4 v[96:99], v1, s[4:7], s32 offen offset:1024
buffer_load_dwordx4 v[100:103], v1, s[4:7], s33 offen offset:1024
buffer_load_dwordx4 v[104:107], v1, s[4:7], s30 offen offset:2048
buffer_load_dwordx4 v[108:111], v1, s[4:7], s31 offen offset:2048
buffer_load_dwordx4 v[112:115], v1, s[4:7], s32 offen offset:2048
buffer_load_dwordx4 v[116:119], v1, s[4:7], s33 offen offset:2048
s_add_u32 m0, s22, 4096
s_add_u32 s23, s21, 4096
buffer_load_dwordx4 v1, s[4:7], s23 offen offset:0 lds
buffer_load_dwordx4 v1, s[4:7], s23 offen offset:1024 lds
buffer_load_dwordx4 v1, s[4:7], s23 offen offset:2048 lds
buffer_load_dwordx4 v1, s[4:7], s23 offen offset:3072 lds
s_add_u32 m0, s22, 8192
s_add_u32 s23, s21, 8192
buffer_load_dwordx4 v1, s[4:7], s23 offen offset:0 lds
buffer_load_dwordx4 v1, s[4:7], s23 offen offset:1024 lds
buffer_load_dwordx4 v1, s[4:7], s23 offen offset:2048 lds
buffer_load_dwordx4 v1, s[4:7], s23 offen offset:3072 lds
s_add_u32 m0, s22, 12288
s_add_u32 s23, s21, 12288
buffer_load_dwordx4 v1, s[4:7], s23 offen offset:0 lds
buffer_load_dwordx4 v1, s[4:7], s23 offen offset:1024 lds
buffer_load_dwordx4 v1, s[4:7], s23 offen offset:2048 lds
buffer_load_dwordx4 v1, s[4:7], s23 offen offset:3072 lds
s_add_u32 m0, s22, 16384
s_add_u32 s23, s21, 16384
buffer_load_dwordx4 v1, s[4:7], s23 offen offset:0 lds
buffer_load_dwordx4 v1, s[4:7], s23 offen offset:1024 lds
buffer_load_dwordx4 v1, s[4:7], s23 offen offset:2048 lds
buffer_load_dwordx4 v1, s[4:7], s23 offen offset:3072 lds
s_waitcnt vmcnt(28)
s_barrier
buffer_load_dwordx4 v[120:123], v1, s[4:7], s30 offen offset:3072
buffer_load_dwordx4 v[124:127], v1, s[4:7], s31 offen offset:3072
buffer_load_dwordx4 v[128:131], v1, s[4:7], s32 offen offset:3072
buffer_load_dwordx4 v[132:135], v1, s[4:7], s33 offen offset:3072
ds_read_b128 v[136:139], v6 offset:0
ds_read_b128 v[140:143], v6 offset:20480
ds_read_b128 v[144:147], v7 offset:0
ds_read_b128 v[148:151], v7 offset:20480
s_waitcnt vmcnt(28) lgkmcnt(0)
v_mfma_f32_16x16x32_bf16 v[8:11], v[72:75], v[136:139], 0
ds_read_b128 v[152:155], v6 offset:1024
v_mfma_f32_16x16x32_bf16 v[12:15], v[72:75], v[140:143], 0
ds_read_b128 v[156:159], v6 offset:21504
v_mfma_f32_16x16x32_bf16 v[16:19], v[72:75], v[144:147], 0
ds_read_b128 v[160:163], v7 offset:1024
v_mfma_f32_16x16x32_bf16 v[20:23], v[72:75], v[148:151], 0
ds_read_b128 v[164:167], v7 offset:21504
s_add_u32 s30, s30, 4096
buffer_load_dwordx4 v[72:75], v1, s[4:7], s30 offen offset:0
v_mfma_f32_16x16x32_bf16 v[24:27], v[76:79], v[136:139], 0
v_mfma_f32_16x16x32_bf16 v[28:31], v[76:79], v[140:143], 0
v_mfma_f32_16x16x32_bf16 v[32:35], v[76:79], v[144:147], 0
v_mfma_f32_16x16x32_bf16 v[36:39], v[76:79], v[148:151], 0
s_add_u32 s31, s31, 4096
buffer_load_dwordx4 v[76:79], v1, s[4:7], s31 offen offset:0
v_mfma_f32_16x16x32_bf16 v[40:43], v[80:83], v[136:139], 0
v_mfma_f32_16x16x32_bf16 v[44:47], v[80:83], v[140:143], 0
v_mfma_f32_16x16x32_bf16 v[48:51], v[80:83], v[144:147], 0
v_mfma_f32_16x16x32_bf16 v[52:55], v[80:83], v[148:151], 0
s_add_u32 s32, s32, 4096
buffer_load_dwordx4 v[80:83], v1, s[4:7], s32 offen offset:0
v_mfma_f32_16x16x32_bf16 v[56:59], v[84:87], v[136:139], 0
v_mfma_f32_16x16x32_bf16 v[60:63], v[84:87], v[140:143], 0
v_mfma_f32_16x16x32_bf16 v[64:67], v[84:87], v[144:147], 0
v_mfma_f32_16x16x32_bf16 v[68:71], v[84:87], v[148:151], 0
s_add_u32 s33, s33, 4096
buffer_load_dwordx4 v[84:87], v1, s[4:7], s33 offen offset:0
s_waitcnt vmcnt(28) lgkmcnt(0)
v_mfma_f32_16x16x32_bf16 v[8:11], v[88:91], v[152:155], v[8:11]
ds_read_b128 v[136:139], v6 offset:2048
v_mfma_f32_16x16x32_bf16 v[12:15], v[88:91], v[156:159], v[12:15]
ds_read_b128 v[140:143], v6 offset:22528
v_mfma_f32_16x16x32_bf16 v[16:19], v[88:91], v[160:163], v[16:19]
ds_read_b128 v[144:147], v7 offset:2048
v_mfma_f32_16x16x32_bf16 v[20:23], v[88:91], v[164:167], v[20:23]
ds_read_b128 v[148:151], v7 offset:22528
buffer_load_dwordx4 v[88:91], v1, s[4:7], s30 offen offset:1024
v_mfma_f32_16x16x32_bf16 v[24:27], v[92:95], v[152:155], v[24:27]
v_mfma_f32_16x16x32_bf16 v[28:31], v[92:95], v[156:159], v[28:31]
v_mfma_f32_16x16x32_bf16 v[32:35], v[92:95], v[160:163], v[32:35]
v_mfma_f32_16x16x32_bf16 v[36:39], v[92:95], v[164:167], v[36:39]
buffer_load_dwordx4 v[92:95], v1, s[4:7], s31 offen offset:1024
v_mfma_f32_16x16x32_bf16 v[40:43], v[96:99], v[152:155], v[40:43]
v_mfma_f32_16x16x32_bf16 v[44:47], v[96:99], v[156:159], v[44:47]
v_mfma_f32_16x16x32_bf16 v[48:51], v[96:99], v[160:163], v[48:51]
v_mfma_f32_16x16x32_bf16 v[52:55], v[96:99], v[164:167], v[52:55]
buffer_load_dwordx4 v[96:99], v1, s[4:7], s32 offen offset:1024
v_mfma_f32_16x16x32_bf16 v[56:59], v[100:103], v[152:155], v[56:59]
v_mfma_f32_16x16x32_bf16 v[60:63], v[100:103], v[156:159], v[60:63]
v_mfma_f32_16x16x32_bf16 v[64:67], v[100:103], v[160:163], v[64:67]
v_mfma_f32_16x16x32_bf16 v[68:71], v[100:103], v[164:167], v[68:71]
buffer_load_dwordx4 v[100:103], v1, s[4:7], s33 offen offset:1024
s_waitcnt vmcnt(28) lgkmcnt(0)
v_mfma_f32_16x16x32_bf16 v[8:11], v[104:107], v[136:139], v[8:11]
ds_read_b128 v[152:155], v6 offset:3072
v_mfma_f32_16x16x32_bf16 v[12:15], v[104:107], v[140:143], v[12:15]
ds_read_b128 v[156:159], v6 offset:23552
v_mfma_f32_16x16x32_bf16 v[16:19], v[104:107], v[144:147], v[16:19]
ds_read_b128 v[160:163], v7 offset:3072
v_mfma_f32_16x16x32_bf16 v[20:23], v[104:107], v[148:151], v[20:23]
ds_read_b128 v[164:167], v7 offset:23552
buffer_load_dwordx4 v[104:107], v1, s[4:7], s30 offen offset:2048
v_mfma_f32_16x16x32_bf16 v[24:27], v[108:111], v[136:139], v[24:27]
v_mfma_f32_16x16x32_bf16 v[28:31], v[108:111], v[140:143], v[28:31]
v_mfma_f32_16x16x32_bf16 v[32:35], v[108:111], v[144:147], v[32:35]
v_mfma_f32_16x16x32_bf16 v[36:39], v[108:111], v[148:151], v[36:39]
buffer_load_dwordx4 v[108:111], v1, s[4:7], s31 offen offset:2048
v_mfma_f32_16x16x32_bf16 v[40:43], v[112:115], v[136:139], v[40:43]
v_mfma_f32_16x16x32_bf16 v[44:47], v[112:115], v[140:143], v[44:47]
v_mfma_f32_16x16x32_bf16 v[48:51], v[112:115], v[144:147], v[48:51]
v_mfma_f32_16x16x32_bf16 v[52:55], v[112:115], v[148:151], v[52:55]
buffer_load_dwordx4 v[112:115], v1, s[4:7], s32 offen offset:2048
v_mfma_f32_16x16x32_bf16 v[56:59], v[116:119], v[136:139], v[56:59]
v_mfma_f32_16x16x32_bf16 v[60:63], v[116:119], v[140:143], v[60:63]
v_mfma_f32_16x16x32_bf16 v[64:67], v[116:119], v[144:147], v[64:67]
v_mfma_f32_16x16x32_bf16 v[68:71], v[116:119], v[148:151], v[68:71]
buffer_load_dwordx4 v[116:119], v1, s[4:7], s33 offen offset:2048
s_waitcnt vmcnt(12) lgkmcnt(0)
s_barrier
v_mfma_f32_16x16x32_bf16 v[8:11], v[120:123], v[152:155], v[8:11]
ds_read_b128 v[136:139], v6 offset:4096
v_mfma_f32_16x16x32_bf16 v[12:15], v[120:123], v[156:159], v[12:15]
ds_read_b128 v[140:143], v6 offset:24576
v_mfma_f32_16x16x32_bf16 v[16:19], v[120:123], v[160:163], v[16:19]
ds_read_b128 v[144:147], v7 offset:4096
v_mfma_f32_16x16x32_bf16 v[20:23], v[120:123], v[164:167], v[20:23]
ds_read_b128 v[148:151], v7 offset:24576
buffer_load_dwordx4 v[120:123], v1, s[4:7], s30 offen offset:3072
v_mfma_f32_16x16x32_bf16 v[24:27], v[124:127], v[152:155], v[24:27]
v_mfma_f32_16x16x32_bf16 v[28:31], v[124:127], v[156:159], v[28:31]
v_mfma_f32_16x16x32_bf16 v[32:35], v[124:127], v[160:163], v[32:35]
v_mfma_f32_16x16x32_bf16 v[36:39], v[124:127], v[164:167], v[36:39]
buffer_load_dwordx4 v[124:127], v1, s[4:7], s31 offen offset:3072
v_mfma_f32_16x16x32_bf16 v[40:43], v[128:131], v[152:155], v[40:43]
v_mfma_f32_16x16x32_bf16 v[44:47], v[128:131], v[156:159], v[44:47]
v_mfma_f32_16x16x32_bf16 v[48:51], v[128:131], v[160:163], v[48:51]
v_mfma_f32_16x16x32_bf16 v[52:55], v[128:131], v[164:167], v[52:55]
buffer_load_dwordx4 v[128:131], v1, s[4:7], s32 offen offset:3072
v_mfma_f32_16x16x32_bf16 v[56:59], v[132:135], v[152:155], v[56:59]
v_mfma_f32_16x16x32_bf16 v[60:63], v[132:135], v[156:159], v[60:63]
v_mfma_f32_16x16x32_bf16 v[64:67], v[132:135], v[160:163], v[64:67]
v_mfma_f32_16x16x32_bf16 v[68:71], v[132:135], v[164:167], v[68:71]
buffer_load_dwordx4 v[132:135], v1, s[4:7], s33 offen offset:3072
s_mov_b32 s40, 0
v_add_u32 v6, 4096, v6
v_add_u32 v7, 4096, v7
qkvb_loop6:
s_waitcnt vmcnt(12) lgkmcnt(0)
v_mfma_f32_16x16x32_bf16 v[8:11], v[72:75], v[136:139], v[8:11]
ds_read_b128 v[152:155], v6 offset:1024
v_mfma_f32_16x16x32_bf16 v[12:15], v[72:75], v[140:143], v[12:15]
ds_read_b128 v[156:159], v6 offset:21504
v_mfma_f32_16x16x32_bf16 v[16:19], v[72:75], v[144:147], v[16:19]
ds_read_b128 v[160:163], v7 offset:1024
v_mfma_f32_16x16x32_bf16 v[20:23], v[72:75], v[148:151], v[20:23]
ds_read_b128 v[164:167], v7 offset:21504
s_add_u32 s30, s30, 4096
buffer_load_dwordx4 v[72:75], v1, s[4:7], s30 offen offset:0
v_mfma_f32_16x16x32_bf16 v[24:27], v[76:79], v[136:139], v[24:27]
v_mfma_f32_16x16x32_bf16 v[28:31], v[76:79], v[140:143], v[28:31]
v_mfma_f32_16x16x32_bf16 v[32:35], v[76:79], v[144:147], v[32:35]
v_mfma_f32_16x16x32_bf16 v[36:39], v[76:79], v[148:151], v[36:39]
s_add_u32 s31, s31, 4096
buffer_load_dwordx4 v[76:79], v1, s[4:7], s31 offen offset:0
v_mfma_f32_16x16x32_bf16 v[40:43], v[80:83], v[136:139], v[40:43]
v_mfma_f32_16x16x32_bf16 v[44:47], v[80:83], v[140:143], v[44:47]
v_mfma_f32_16x16x32_bf16 v[48:51], v[80:83], v[144:147], v[48:51]
v_mfma_f32_16x16x32_bf16 v[52:55], v[80:83], v[148:151], v[52:55]
s_add_u32 s32, s32, 4096
buffer_load_dwordx4 v[80:83], v1, s[4:7], s32 offen offset:0
v_mfma_f32_16x16x32_bf16 v[56:59], v[84:87], v[136:139], v[56:59]
v_mfma_f32_16x16x32_bf16 v[60:63], v[84:87], v[140:143], v[60:63]
v_mfma_f32_16x16x32_bf16 v[64:67], v[84:87], v[144:147], v[64:67]
v_mfma_f32_16x16x32_bf16 v[68:71], v[84:87], v[148:151], v[68:71]
s_add_u32 s33, s33, 4096
buffer_load_dwordx4 v[84:87], v1, s[4:7], s33 offen offset:0
s_waitcnt vmcnt(12) lgkmcnt(0)
v_mfma_f32_16x16x32_bf16 v[8:11], v[88:91], v[152:155], v[8:11]
ds_read_b128 v[136:139], v6 offset:2048
v_mfma_f32_16x16x32_bf16 v[12:15], v[88:91], v[156:159], v[12:15]
ds_read_b128 v[140:143], v6 offset:22528
v_mfma_f32_16x16x32_bf16 v[16:19], v[88:91], v[160:163], v[16:19]
ds_read_b128 v[144:147], v7 offset:2048
v_mfma_f32_16x16x32_bf16 v[20:23], v[88:91], v[164:167], v[20:23]
ds_read_b128 v[148:151], v7 offset:22528
buffer_load_dwordx4 v[88:91], v1, s[4:7], s30 offen offset:1024
v_mfma_f32_16x16x32_bf16 v[24:27], v[92:95], v[152:155], v[24:27]
v_mfma_f32_16x16x32_bf16 v[28:31], v[92:95], v[156:159], v[28:31]
v_mfma_f32_16x16x32_bf16 v[32:35], v[92:95], v[160:163], v[32:35]
v_mfma_f32_16x16x32_bf16 v[36:39], v[92:95], v[164:167], v[36:39]
buffer_load_dwordx4 v[92:95], v1, s[4:7], s31 offen offset:1024
v_mfma_f32_16x16x32_bf16 v[40:43], v[96:99], v[152:155], v[40:43]
v_mfma_f32_16x16x32_bf16 v[44:47], v[96:99], v[156:159], v[44:47]
v_mfma_f32_16x16x32_bf16 v[48:51], v[96:99], v[160:163], v[48:51]
v_mfma_f32_16x16x32_bf16 v[52:55], v[96:99], v[164:167], v[52:55]
buffer_load_dwordx4 v[96:99], v1, s[4:7], s32 offen offset:1024
v_mfma_f32_16x16x32_bf16 v[56:59], v[100:103], v[152:155], v[56:59]
v_mfma_f32_16x16x32_bf16 v[60:63], v[100:103], v[156:159], v[60:63]
v_mfma_f32_16x16x32_bf16 v[64:67], v[100:103], v[160:163], v[64:67]
v_mfma_f32_16x16x32_bf16 v[68:71], v[100:103], v[164:167], v[68:71]
buffer_load_dwordx4 v[100:103], v1, s[4:7], s33 offen offset:1024
s_waitcnt vmcnt(12) lgkmcnt(0)
v_mfma_f32_16x16x32_bf16 v[8:11], v[104:107], v[136:139], v[8:11]
ds_read_b128 v[152:155], v6 offset:3072
v_mfma_f32_16x16x32_bf16 v[12:15], v[104:107], v[140:143], v[12:15]
ds_read_b128 v[156:159], v6 offset:23552
v_mfma_f32_16x16x32_bf16 v[16:19], v[104:107], v[144:147], v[16:19]
ds_read_b128 v[160:163], v7 offset:3072
v_mfma_f32_16x16x32_bf16 v[20:23], v[104:107], v[148:151], v[20:23]
ds_read_b128 v[164:167], v7 offset:23552
buffer_load_dwordx4 v[104:107], v1, s[4:7], s30 offen offset:2048
v_mfma_f32_16x16x32_bf16 v[24:27], v[108:111], v[136:139], v[24:27]
v_mfma_f32_16x16x32_bf16 v[28:31], v[108:111], v[140:143], v[28:31]
v_mfma_f32_16x16x32_bf16 v[32:35], v[108:111], v[144:147], v[32:35]
v_mfma_f32_16x16x32_bf16 v[36:39], v[108:111], v[148:151], v[36:39]
buffer_load_dwordx4 v[108:111], v1, s[4:7], s31 offen offset:2048
v_mfma_f32_16x16x32_bf16 v[40:43], v[112:115], v[136:139], v[40:43]
v_mfma_f32_16x16x32_bf16 v[44:47], v[112:115], v[140:143], v[44:47]
v_mfma_f32_16x16x32_bf16 v[48:51], v[112:115], v[144:147], v[48:51]
v_mfma_f32_16x16x32_bf16 v[52:55], v[112:115], v[148:151], v[52:55]
buffer_load_dwordx4 v[112:115], v1, s[4:7], s32 offen offset:2048
v_mfma_f32_16x16x32_bf16 v[56:59], v[116:119], v[136:139], v[56:59]
v_mfma_f32_16x16x32_bf16 v[60:63], v[116:119], v[140:143], v[60:63]
v_mfma_f32_16x16x32_bf16 v[64:67], v[116:119], v[144:147], v[64:67]
v_mfma_f32_16x16x32_bf16 v[68:71], v[116:119], v[148:151], v[68:71]
buffer_load_dwordx4 v[116:119], v1, s[4:7], s33 offen offset:2048
s_waitcnt vmcnt(12) lgkmcnt(0)
v_mfma_f32_16x16x32_bf16 v[8:11], v[120:123], v[152:155], v[8:11]
ds_read_b128 v[136:139], v6 offset:4096
v_mfma_f32_16x16x32_bf16 v[12:15], v[120:123], v[156:159], v[12:15]
ds_read_b128 v[140:143], v6 offset:24576
v_mfma_f32_16x16x32_bf16 v[16:19], v[120:123], v[160:163], v[16:19]
ds_read_b128 v[144:147], v7 offset:4096
v_mfma_f32_16x16x32_bf16 v[20:23], v[120:123], v[164:167], v[20:23]
ds_read_b128 v[148:151], v7 offset:24576
buffer_load_dwordx4 v[120:123], v1, s[4:7], s30 offen offset:3072
v_mfma_f32_16x16x32_bf16 v[24:27], v[124:127], v[152:155], v[24:27]
v_mfma_f32_16x16x32_bf16 v[28:31], v[124:127], v[156:159], v[28:31]
v_mfma_f32_16x16x32_bf16 v[32:35], v[124:127], v[160:163], v[32:35]
v_mfma_f32_16x16x32_bf16 v[36:39], v[124:127], v[164:167], v[36:39]
buffer_load_dwordx4 v[124:127], v1, s[4:7], s31 offen offset:3072
v_mfma_f32_16x16x32_bf16 v[40:43], v[128:131], v[152:155], v[40:43]
v_mfma_f32_16x16x32_bf16 v[44:47], v[128:131], v[156:159], v[44:47]
v_mfma_f32_16x16x32_bf16 v[48:51], v[128:131], v[160:163], v[48:51]
v_mfma_f32_16x16x32_bf16 v[52:55], v[128:131], v[164:167], v[52:55]
buffer_load_dwordx4 v[128:131], v1, s[4:7], s32 offen offset:3072
v_mfma_f32_16x16x32_bf16 v[56:59], v[132:135], v[152:155], v[56:59]
v_mfma_f32_16x16x32_bf16 v[60:63], v[132:135], v[156:159], v[60:63]
v_mfma_f32_16x16x32_bf16 v[64:67], v[132:135], v[160:163], v[64:67]
v_mfma_f32_16x16x32_bf16 v[68:71], v[132:135], v[164:167], v[68:71]
buffer_load_dwordx4 v[132:135], v1, s[4:7], s33 offen offset:3072
v_add_u32 v6, 4096, v6
v_add_u32 v7, 4096, v7
s_add_u32 s40, s40, 1
s_cmp_lt_u32 s40, 4
s_cbranch_scc1 qkvb_loop6
s_waitcnt vmcnt(0) lgkmcnt(0)
v_and_b32 v2, 63, v0
v_and_b32 v3, 15, v2
v_lshrrev_b32 v4, 4, v2
s_lshl_b32 s41, s17, 19
s_lshl_b32 s42, s18, 12
s_add_u32 s41, s41, s42
s_mov_b32 s46, 0x3ea52b5c
s_mov_b32 s47, 0x3ea52b5c
v_lshlrev_b32 v5, 2, v4
v_add_u32 v5, 0, v5
v_mul_u32_u24 v168, 205, v5
v_lshrrev_b32 v168, 12, v168
v_mul_u32_u24 v6, 20, v168
v_sub_u32 v5, v5, v6
v_lshlrev_b32 v168, 17, v168
v_lshrrev_b32 v6, 4, v5
v_lshl_add_u32 v168, v6, 10, v168
v_bfe_u32 v6, v5, 2, 1
v_lshl_add_u32 v168, v6, 9, v168
v_bfe_u32 v6, v5, 3, 1
v_lshl_add_u32 v168, v6, 3, v168
v_lshl_add_u32 v168, v3, 4, v168
v_lshlrev_b32 v5, 2, v4
v_add_u32 v5, 16, v5
v_mul_u32_u24 v169, 205, v5
v_lshrrev_b32 v169, 12, v169
v_mul_u32_u24 v6, 20, v169
v_sub_u32 v5, v5, v6
v_lshlrev_b32 v169, 17, v169
v_lshrrev_b32 v6, 4, v5
v_lshl_add_u32 v169, v6, 10, v169
v_bfe_u32 v6, v5, 2, 1
v_lshl_add_u32 v169, v6, 9, v169
v_bfe_u32 v6, v5, 3, 1
v_lshl_add_u32 v169, v6, 3, v169
v_lshl_add_u32 v169, v3, 4, v169
v_lshlrev_b32 v5, 2, v4
v_add_u32 v5, 32, v5
v_mul_u32_u24 v170, 205, v5
v_lshrrev_b32 v170, 12, v170
v_mul_u32_u24 v6, 20, v170
v_sub_u32 v5, v5, v6
v_lshlrev_b32 v170, 17, v170
v_lshrrev_b32 v6, 4, v5
v_lshl_add_u32 v170, v6, 10, v170
v_bfe_u32 v6, v5, 2, 1
v_lshl_add_u32 v170, v6, 9, v170
v_bfe_u32 v6, v5, 3, 1
v_lshl_add_u32 v170, v6, 3, v170
v_lshl_add_u32 v170, v3, 4, v170
v_lshlrev_b32 v5, 2, v4
v_add_u32 v5, 48, v5
v_mul_u32_u24 v171, 205, v5
v_lshrrev_b32 v171, 12, v171
v_mul_u32_u24 v6, 20, v171
v_sub_u32 v5, v5, v6
v_lshlrev_b32 v171, 17, v171
v_lshrrev_b32 v6, 4, v5
v_lshl_add_u32 v171, v6, 10, v171
v_bfe_u32 v6, v5, 2, 1
v_lshl_add_u32 v171, v6, 9, v171
v_bfe_u32 v6, v5, 3, 1
v_lshl_add_u32 v171, v6, 3, v171
v_lshl_add_u32 v171, v3, 4, v171
v_pk_mul_f32 v[8:9], v[8:9], s[46:47]
v_pk_mul_f32 v[10:11], v[10:11], s[46:47]
v_cvt_pk_bf16_f32 v136, v8, v9
v_cvt_pk_bf16_f32 v137, v10, v11
s_add_u32 s43, s41, 37748736
buffer_store_dwordx2 v[136:137], v168, s[4:7], s43 offen sc1
v_pk_mul_f32 v[12:13], v[12:13], s[46:47]
v_pk_mul_f32 v[14:15], v[14:15], s[46:47]
v_cvt_pk_bf16_f32 v138, v12, v13
v_cvt_pk_bf16_f32 v139, v14, v15
s_add_u32 s43, s41, 37748992
buffer_store_dwordx2 v[138:139], v168, s[4:7], s43 offen sc1
v_pk_mul_f32 v[16:17], v[16:17], s[46:47]
v_pk_mul_f32 v[18:19], v[18:19], s[46:47]
v_cvt_pk_bf16_f32 v140, v16, v17
v_cvt_pk_bf16_f32 v141, v18, v19
s_add_u32 s43, s41, 37750784
buffer_store_dwordx2 v[140:141], v168, s[4:7], s43 offen sc1
v_pk_mul_f32 v[20:21], v[20:21], s[46:47]
v_pk_mul_f32 v[22:23], v[22:23], s[46:47]
v_cvt_pk_bf16_f32 v142, v20, v21
v_cvt_pk_bf16_f32 v143, v22, v23
s_add_u32 s43, s41, 37751040
buffer_store_dwordx2 v[142:143], v168, s[4:7], s43 offen sc1
v_pk_mul_f32 v[24:25], v[24:25], s[46:47]
v_pk_mul_f32 v[26:27], v[26:27], s[46:47]
v_cvt_pk_bf16_f32 v144, v24, v25
v_cvt_pk_bf16_f32 v145, v26, v27
s_add_u32 s43, s41, 37748736
buffer_store_dwordx2 v[144:145], v169, s[4:7], s43 offen sc1
v_pk_mul_f32 v[28:29], v[28:29], s[46:47]
v_pk_mul_f32 v[30:31], v[30:31], s[46:47]
v_cvt_pk_bf16_f32 v146, v28, v29
v_cvt_pk_bf16_f32 v147, v30, v31
s_add_u32 s43, s41, 37748992
buffer_store_dwordx2 v[146:147], v169, s[4:7], s43 offen sc1
v_pk_mul_f32 v[32:33], v[32:33], s[46:47]
v_pk_mul_f32 v[34:35], v[34:35], s[46:47]
v_cvt_pk_bf16_f32 v148, v32, v33
v_cvt_pk_bf16_f32 v149, v34, v35
s_add_u32 s43, s41, 37750784
buffer_store_dwordx2 v[148:149], v169, s[4:7], s43 offen sc1
v_pk_mul_f32 v[36:37], v[36:37], s[46:47]
v_pk_mul_f32 v[38:39], v[38:39], s[46:47]
v_cvt_pk_bf16_f32 v150, v36, v37
v_cvt_pk_bf16_f32 v151, v38, v39
s_add_u32 s43, s41, 37751040
buffer_store_dwordx2 v[150:151], v169, s[4:7], s43 offen sc1
v_pk_mul_f32 v[40:41], v[40:41], s[46:47]
v_pk_mul_f32 v[42:43], v[42:43], s[46:47]
v_cvt_pk_bf16_f32 v136, v40, v41
v_cvt_pk_bf16_f32 v137, v42, v43
s_add_u32 s43, s41, 37748736
buffer_store_dwordx2 v[136:137], v170, s[4:7], s43 offen sc1
v_pk_mul_f32 v[44:45], v[44:45], s[46:47]
v_pk_mul_f32 v[46:47], v[46:47], s[46:47]
v_cvt_pk_bf16_f32 v138, v44, v45
v_cvt_pk_bf16_f32 v139, v46, v47
s_add_u32 s43, s41, 37748992
buffer_store_dwordx2 v[138:139], v170, s[4:7], s43 offen sc1
v_pk_mul_f32 v[48:49], v[48:49], s[46:47]
v_pk_mul_f32 v[50:51], v[50:51], s[46:47]
v_cvt_pk_bf16_f32 v140, v48, v49
v_cvt_pk_bf16_f32 v141, v50, v51
s_add_u32 s43, s41, 37750784
buffer_store_dwordx2 v[140:141], v170, s[4:7], s43 offen sc1
v_pk_mul_f32 v[52:53], v[52:53], s[46:47]
v_pk_mul_f32 v[54:55], v[54:55], s[46:47]
v_cvt_pk_bf16_f32 v142, v52, v53
v_cvt_pk_bf16_f32 v143, v54, v55
s_add_u32 s43, s41, 37751040
buffer_store_dwordx2 v[142:143], v170, s[4:7], s43 offen sc1
v_pk_mul_f32 v[56:57], v[56:57], s[46:47]
v_pk_mul_f32 v[58:59], v[58:59], s[46:47]
v_cvt_pk_bf16_f32 v144, v56, v57
v_cvt_pk_bf16_f32 v145, v58, v59
s_add_u32 s43, s41, 37748736
buffer_store_dwordx2 v[144:145], v171, s[4:7], s43 offen sc1
v_pk_mul_f32 v[60:61], v[60:61], s[46:47]
v_pk_mul_f32 v[62:63], v[62:63], s[46:47]
v_cvt_pk_bf16_f32 v146, v60, v61
v_cvt_pk_bf16_f32 v147, v62, v63
s_add_u32 s43, s41, 37748992
buffer_store_dwordx2 v[146:147], v171, s[4:7], s43 offen sc1
v_pk_mul_f32 v[64:65], v[64:65], s[46:47]
v_pk_mul_f32 v[66:67], v[66:67], s[46:47]
v_cvt_pk_bf16_f32 v148, v64, v65
v_cvt_pk_bf16_f32 v149, v66, v67
s_add_u32 s43, s41, 37750784
buffer_store_dwordx2 v[148:149], v171, s[4:7], s43 offen sc1
v_pk_mul_f32 v[68:69], v[68:69], s[46:47]
v_pk_mul_f32 v[70:71], v[70:71], s[46:47]
v_cvt_pk_bf16_f32 v150, v68, v69
v_cvt_pk_bf16_f32 v151, v70, v71
s_add_u32 s43, s41, 37751040
buffer_store_dwordx2 v[150:151], v171, s[4:7], s43 offen sc1
s_branch qkvb_exit1
qkvb_w1_3:
s_mul_i32 s30, s17, 5
s_add_u32 s30, s30, 4
s_mul_i32 s30, s30, 20480
s_add_u32 s30, s30, 87556096
s_mul_i32 s31, s17, 5
s_add_u32 s31, s31, 40
s_mul_i32 s31, s31, 20480
s_add_u32 s31, s31, 87556096
s_mul_i32 s32, s17, 5
s_add_u32 s32, s32, 41
s_mul_i32 s32, s32, 20480
s_add_u32 s32, s32, 87556096
s_mul_i32 s33, s17, 5
s_add_u32 s33, s33, 42
s_mul_i32 s33, s33, 20480
s_add_u32 s33, s33, 87556096
buffer_load_dwordx4 v[72:75], v1, s[4:7], s30 offen offset:0
buffer_load_dwordx4 v[76:79], v1, s[4:7], s31 offen offset:0
buffer_load_dwordx4 v[80:83], v1, s[4:7], s32 offen offset:0
buffer_load_dwordx4 v[84:87], v1, s[4:7], s33 offen offset:0
buffer_load_dwordx4 v[88:91], v1, s[4:7], s30 offen offset:1024
buffer_load_dwordx4 v[92:95], v1, s[4:7], s31 offen offset:1024
buffer_load_dwordx4 v[96:99], v1, s[4:7], s32 offen offset:1024
buffer_load_dwordx4 v[100:103], v1, s[4:7], s33 offen offset:1024
buffer_load_dwordx4 v[104:107], v1, s[4:7], s30 offen offset:2048
buffer_load_dwordx4 v[108:111], v1, s[4:7], s31 offen offset:2048
buffer_load_dwordx4 v[112:115], v1, s[4:7], s32 offen offset:2048
buffer_load_dwordx4 v[116:119], v1, s[4:7], s33 offen offset:2048
s_add_u32 m0, s22, 4096
s_add_u32 s23, s21, 4096
buffer_load_dwordx4 v1, s[4:7], s23 offen offset:0 lds
buffer_load_dwordx4 v1, s[4:7], s23 offen offset:1024 lds
buffer_load_dwordx4 v1, s[4:7], s23 offen offset:2048 lds
buffer_load_dwordx4 v1, s[4:7], s23 offen offset:3072 lds
s_add_u32 m0, s22, 8192
s_add_u32 s23, s21, 8192
buffer_load_dwordx4 v1, s[4:7], s23 offen offset:0 lds
buffer_load_dwordx4 v1, s[4:7], s23 offen offset:1024 lds
buffer_load_dwordx4 v1, s[4:7], s23 offen offset:2048 lds
buffer_load_dwordx4 v1, s[4:7], s23 offen offset:3072 lds
s_add_u32 m0, s22, 12288
s_add_u32 s23, s21, 12288
buffer_load_dwordx4 v1, s[4:7], s23 offen offset:0 lds
buffer_load_dwordx4 v1, s[4:7], s23 offen offset:1024 lds
buffer_load_dwordx4 v1, s[4:7], s23 offen offset:2048 lds
buffer_load_dwordx4 v1, s[4:7], s23 offen offset:3072 lds
s_add_u32 m0, s22, 16384
s_add_u32 s23, s21, 16384
buffer_load_dwordx4 v1, s[4:7], s23 offen offset:0 lds
buffer_load_dwordx4 v1, s[4:7], s23 offen offset:1024 lds
buffer_load_dwordx4 v1, s[4:7], s23 offen offset:2048 lds
buffer_load_dwordx4 v1, s[4:7], s23 offen offset:3072 lds
s_waitcnt vmcnt(28)
s_barrier
buffer_load_dwordx4 v[120:123], v1, s[4:7], s30 offen offset:3072
buffer_load_dwordx4 v[124:127], v1, s[4:7], s31 offen offset:3072
buffer_load_dwordx4 v[128:131], v1, s[4:7], s32 offen offset:3072
buffer_load_dwordx4 v[132:135], v1, s[4:7], s33 offen offset:3072
ds_read_b128 v[136:139], v6 offset:0
ds_read_b128 v[140:143], v6 offset:20480
ds_read_b128 v[144:147], v7 offset:0
ds_read_b128 v[148:151], v7 offset:20480
s_waitcnt vmcnt(28) lgkmcnt(0)
v_mfma_f32_16x16x32_bf16 v[8:11], v[72:75], v[136:139], 0
ds_read_b128 v[152:155], v6 offset:1024
v_mfma_f32_16x16x32_bf16 v[12:15], v[72:75], v[140:143], 0
ds_read_b128 v[156:159], v6 offset:21504
v_mfma_f32_16x16x32_bf16 v[16:19], v[72:75], v[144:147], 0
ds_read_b128 v[160:163], v7 offset:1024
v_mfma_f32_16x16x32_bf16 v[20:23], v[72:75], v[148:151], 0
ds_read_b128 v[164:167], v7 offset:21504
s_add_u32 s30, s30, 4096
buffer_load_dwordx4 v[72:75], v1, s[4:7], s30 offen offset:0
v_mfma_f32_16x16x32_bf16 v[24:27], v[76:79], v[136:139], 0
v_mfma_f32_16x16x32_bf16 v[28:31], v[76:79], v[140:143], 0
v_mfma_f32_16x16x32_bf16 v[32:35], v[76:79], v[144:147], 0
v_mfma_f32_16x16x32_bf16 v[36:39], v[76:79], v[148:151], 0
s_add_u32 s31, s31, 4096
buffer_load_dwordx4 v[76:79], v1, s[4:7], s31 offen offset:0
v_mfma_f32_16x16x32_bf16 v[40:43], v[80:83], v[136:139], 0
v_mfma_f32_16x16x32_bf16 v[44:47], v[80:83], v[140:143], 0
v_mfma_f32_16x16x32_bf16 v[48:51], v[80:83], v[144:147], 0
v_mfma_f32_16x16x32_bf16 v[52:55], v[80:83], v[148:151], 0
s_add_u32 s32, s32, 4096
buffer_load_dwordx4 v[80:83], v1, s[4:7], s32 offen offset:0
v_mfma_f32_16x16x32_bf16 v[56:59], v[84:87], v[136:139], 0
v_mfma_f32_16x16x32_bf16 v[60:63], v[84:87], v[140:143], 0
v_mfma_f32_16x16x32_bf16 v[64:67], v[84:87], v[144:147], 0
v_mfma_f32_16x16x32_bf16 v[68:71], v[84:87], v[148:151], 0
s_add_u32 s33, s33, 4096
buffer_load_dwordx4 v[84:87], v1, s[4:7], s33 offen offset:0
s_waitcnt vmcnt(28) lgkmcnt(0)
v_mfma_f32_16x16x32_bf16 v[8:11], v[88:91], v[152:155], v[8:11]
ds_read_b128 v[136:139], v6 offset:2048
v_mfma_f32_16x16x32_bf16 v[12:15], v[88:91], v[156:159], v[12:15]
ds_read_b128 v[140:143], v6 offset:22528
v_mfma_f32_16x16x32_bf16 v[16:19], v[88:91], v[160:163], v[16:19]
ds_read_b128 v[144:147], v7 offset:2048
v_mfma_f32_16x16x32_bf16 v[20:23], v[88:91], v[164:167], v[20:23]
ds_read_b128 v[148:151], v7 offset:22528
buffer_load_dwordx4 v[88:91], v1, s[4:7], s30 offen offset:1024
v_mfma_f32_16x16x32_bf16 v[24:27], v[92:95], v[152:155], v[24:27]
v_mfma_f32_16x16x32_bf16 v[28:31], v[92:95], v[156:159], v[28:31]
v_mfma_f32_16x16x32_bf16 v[32:35], v[92:95], v[160:163], v[32:35]
v_mfma_f32_16x16x32_bf16 v[36:39], v[92:95], v[164:167], v[36:39]
buffer_load_dwordx4 v[92:95], v1, s[4:7], s31 offen offset:1024
v_mfma_f32_16x16x32_bf16 v[40:43], v[96:99], v[152:155], v[40:43]
v_mfma_f32_16x16x32_bf16 v[44:47], v[96:99], v[156:159], v[44:47]
v_mfma_f32_16x16x32_bf16 v[48:51], v[96:99], v[160:163], v[48:51]
v_mfma_f32_16x16x32_bf16 v[52:55], v[96:99], v[164:167], v[52:55]
buffer_load_dwordx4 v[96:99], v1, s[4:7], s32 offen offset:1024
v_mfma_f32_16x16x32_bf16 v[56:59], v[100:103], v[152:155], v[56:59]
v_mfma_f32_16x16x32_bf16 v[60:63], v[100:103], v[156:159], v[60:63]
v_mfma_f32_16x16x32_bf16 v[64:67], v[100:103], v[160:163], v[64:67]
v_mfma_f32_16x16x32_bf16 v[68:71], v[100:103], v[164:167], v[68:71]
buffer_load_dwordx4 v[100:103], v1, s[4:7], s33 offen offset:1024
s_waitcnt vmcnt(28) lgkmcnt(0)
v_mfma_f32_16x16x32_bf16 v[8:11], v[104:107], v[136:139], v[8:11]
ds_read_b128 v[152:155], v6 offset:3072
v_mfma_f32_16x16x32_bf16 v[12:15], v[104:107], v[140:143], v[12:15]
ds_read_b128 v[156:159], v6 offset:23552
v_mfma_f32_16x16x32_bf16 v[16:19], v[104:107], v[144:147], v[16:19]
ds_read_b128 v[160:163], v7 offset:3072
v_mfma_f32_16x16x32_bf16 v[20:23], v[104:107], v[148:151], v[20:23]
ds_read_b128 v[164:167], v7 offset:23552
buffer_load_dwordx4 v[104:107], v1, s[4:7], s30 offen offset:2048
v_mfma_f32_16x16x32_bf16 v[24:27], v[108:111], v[136:139], v[24:27]
v_mfma_f32_16x16x32_bf16 v[28:31], v[108:111], v[140:143], v[28:31]
v_mfma_f32_16x16x32_bf16 v[32:35], v[108:111], v[144:147], v[32:35]
v_mfma_f32_16x16x32_bf16 v[36:39], v[108:111], v[148:151], v[36:39]
buffer_load_dwordx4 v[108:111], v1, s[4:7], s31 offen offset:2048
v_mfma_f32_16x16x32_bf16 v[40:43], v[112:115], v[136:139], v[40:43]
v_mfma_f32_16x16x32_bf16 v[44:47], v[112:115], v[140:143], v[44:47]
v_mfma_f32_16x16x32_bf16 v[48:51], v[112:115], v[144:147], v[48:51]
v_mfma_f32_16x16x32_bf16 v[52:55], v[112:115], v[148:151], v[52:55]
buffer_load_dwordx4 v[112:115], v1, s[4:7], s32 offen offset:2048
v_mfma_f32_16x16x32_bf16 v[56:59], v[116:119], v[136:139], v[56:59]
v_mfma_f32_16x16x32_bf16 v[60:63], v[116:119], v[140:143], v[60:63]
v_mfma_f32_16x16x32_bf16 v[64:67], v[116:119], v[144:147], v[64:67]
v_mfma_f32_16x16x32_bf16 v[68:71], v[116:119], v[148:151], v[68:71]
buffer_load_dwordx4 v[116:119], v1, s[4:7], s33 offen offset:2048
s_waitcnt vmcnt(12) lgkmcnt(0)
s_barrier
v_mfma_f32_16x16x32_bf16 v[8:11], v[120:123], v[152:155], v[8:11]
ds_read_b128 v[136:139], v6 offset:4096
v_mfma_f32_16x16x32_bf16 v[12:15], v[120:123], v[156:159], v[12:15]
ds_read_b128 v[140:143], v6 offset:24576
v_mfma_f32_16x16x32_bf16 v[16:19], v[120:123], v[160:163], v[16:19]
ds_read_b128 v[144:147], v7 offset:4096
v_mfma_f32_16x16x32_bf16 v[20:23], v[120:123], v[164:167], v[20:23]
ds_read_b128 v[148:151], v7 offset:24576
buffer_load_dwordx4 v[120:123], v1, s[4:7], s30 offen offset:3072
v_mfma_f32_16x16x32_bf16 v[24:27], v[124:127], v[152:155], v[24:27]
v_mfma_f32_16x16x32_bf16 v[28:31], v[124:127], v[156:159], v[28:31]
v_mfma_f32_16x16x32_bf16 v[32:35], v[124:127], v[160:163], v[32:35]
v_mfma_f32_16x16x32_bf16 v[36:39], v[124:127], v[164:167], v[36:39]
buffer_load_dwordx4 v[124:127], v1, s[4:7], s31 offen offset:3072
v_mfma_f32_16x16x32_bf16 v[40:43], v[128:131], v[152:155], v[40:43]
v_mfma_f32_16x16x32_bf16 v[44:47], v[128:131], v[156:159], v[44:47]
v_mfma_f32_16x16x32_bf16 v[48:51], v[128:131], v[160:163], v[48:51]
v_mfma_f32_16x16x32_bf16 v[52:55], v[128:131], v[164:167], v[52:55]
buffer_load_dwordx4 v[128:131], v1, s[4:7], s32 offen offset:3072
v_mfma_f32_16x16x32_bf16 v[56:59], v[132:135], v[152:155], v[56:59]
v_mfma_f32_16x16x32_bf16 v[60:63], v[132:135], v[156:159], v[60:63]
v_mfma_f32_16x16x32_bf16 v[64:67], v[132:135], v[160:163], v[64:67]
v_mfma_f32_16x16x32_bf16 v[68:71], v[132:135], v[164:167], v[68:71]
buffer_load_dwordx4 v[132:135], v1, s[4:7], s33 offen offset:3072
s_mov_b32 s40, 0
v_add_u32 v6, 4096, v6
v_add_u32 v7, 4096, v7
qkvb_loop7:
s_waitcnt vmcnt(12) lgkmcnt(0)
v_mfma_f32_16x16x32_bf16 v[8:11], v[72:75], v[136:139], v[8:11]
ds_read_b128 v[152:155], v6 offset:1024
v_mfma_f32_16x16x32_bf16 v[12:15], v[72:75], v[140:143], v[12:15]
ds_read_b128 v[156:159], v6 offset:21504
v_mfma_f32_16x16x32_bf16 v[16:19], v[72:75], v[144:147], v[16:19]
ds_read_b128 v[160:163], v7 offset:1024
v_mfma_f32_16x16x32_bf16 v[20:23], v[72:75], v[148:151], v[20:23]
ds_read_b128 v[164:167], v7 offset:21504
s_add_u32 s30, s30, 4096
buffer_load_dwordx4 v[72:75], v1, s[4:7], s30 offen offset:0
v_mfma_f32_16x16x32_bf16 v[24:27], v[76:79], v[136:139], v[24:27]
v_mfma_f32_16x16x32_bf16 v[28:31], v[76:79], v[140:143], v[28:31]
v_mfma_f32_16x16x32_bf16 v[32:35], v[76:79], v[144:147], v[32:35]
v_mfma_f32_16x16x32_bf16 v[36:39], v[76:79], v[148:151], v[36:39]
s_add_u32 s31, s31, 4096
buffer_load_dwordx4 v[76:79], v1, s[4:7], s31 offen offset:0
v_mfma_f32_16x16x32_bf16 v[40:43], v[80:83], v[136:139], v[40:43]
v_mfma_f32_16x16x32_bf16 v[44:47], v[80:83], v[140:143], v[44:47]
v_mfma_f32_16x16x32_bf16 v[48:51], v[80:83], v[144:147], v[48:51]
v_mfma_f32_16x16x32_bf16 v[52:55], v[80:83], v[148:151], v[52:55]
s_add_u32 s32, s32, 4096
buffer_load_dwordx4 v[80:83], v1, s[4:7], s32 offen offset:0
v_mfma_f32_16x16x32_bf16 v[56:59], v[84:87], v[136:139], v[56:59]
v_mfma_f32_16x16x32_bf16 v[60:63], v[84:87], v[140:143], v[60:63]
v_mfma_f32_16x16x32_bf16 v[64:67], v[84:87], v[144:147], v[64:67]
v_mfma_f32_16x16x32_bf16 v[68:71], v[84:87], v[148:151], v[68:71]
s_add_u32 s33, s33, 4096
buffer_load_dwordx4 v[84:87], v1, s[4:7], s33 offen offset:0
s_waitcnt vmcnt(12) lgkmcnt(0)
v_mfma_f32_16x16x32_bf16 v[8:11], v[88:91], v[152:155], v[8:11]
ds_read_b128 v[136:139], v6 offset:2048
v_mfma_f32_16x16x32_bf16 v[12:15], v[88:91], v[156:159], v[12:15]
ds_read_b128 v[140:143], v6 offset:22528
v_mfma_f32_16x16x32_bf16 v[16:19], v[88:91], v[160:163], v[16:19]
ds_read_b128 v[144:147], v7 offset:2048
v_mfma_f32_16x16x32_bf16 v[20:23], v[88:91], v[164:167], v[20:23]
ds_read_b128 v[148:151], v7 offset:22528
buffer_load_dwordx4 v[88:91], v1, s[4:7], s30 offen offset:1024
v_mfma_f32_16x16x32_bf16 v[24:27], v[92:95], v[152:155], v[24:27]
v_mfma_f32_16x16x32_bf16 v[28:31], v[92:95], v[156:159], v[28:31]
v_mfma_f32_16x16x32_bf16 v[32:35], v[92:95], v[160:163], v[32:35]
v_mfma_f32_16x16x32_bf16 v[36:39], v[92:95], v[164:167], v[36:39]
buffer_load_dwordx4 v[92:95], v1, s[4:7], s31 offen offset:1024
v_mfma_f32_16x16x32_bf16 v[40:43], v[96:99], v[152:155], v[40:43]
v_mfma_f32_16x16x32_bf16 v[44:47], v[96:99], v[156:159], v[44:47]
v_mfma_f32_16x16x32_bf16 v[48:51], v[96:99], v[160:163], v[48:51]
v_mfma_f32_16x16x32_bf16 v[52:55], v[96:99], v[164:167], v[52:55]
buffer_load_dwordx4 v[96:99], v1, s[4:7], s32 offen offset:1024
v_mfma_f32_16x16x32_bf16 v[56:59], v[100:103], v[152:155], v[56:59]
v_mfma_f32_16x16x32_bf16 v[60:63], v[100:103], v[156:159], v[60:63]
v_mfma_f32_16x16x32_bf16 v[64:67], v[100:103], v[160:163], v[64:67]
v_mfma_f32_16x16x32_bf16 v[68:71], v[100:103], v[164:167], v[68:71]
buffer_load_dwordx4 v[100:103], v1, s[4:7], s33 offen offset:1024
s_waitcnt vmcnt(12) lgkmcnt(0)
v_mfma_f32_16x16x32_bf16 v[8:11], v[104:107], v[136:139], v[8:11]
ds_read_b128 v[152:155], v6 offset:3072
v_mfma_f32_16x16x32_bf16 v[12:15], v[104:107], v[140:143], v[12:15]
ds_read_b128 v[156:159], v6 offset:23552
v_mfma_f32_16x16x32_bf16 v[16:19], v[104:107], v[144:147], v[16:19]
ds_read_b128 v[160:163], v7 offset:3072
v_mfma_f32_16x16x32_bf16 v[20:23], v[104:107], v[148:151], v[20:23]
ds_read_b128 v[164:167], v7 offset:23552
buffer_load_dwordx4 v[104:107], v1, s[4:7], s30 offen offset:2048
v_mfma_f32_16x16x32_bf16 v[24:27], v[108:111], v[136:139], v[24:27]
v_mfma_f32_16x16x32_bf16 v[28:31], v[108:111], v[140:143], v[28:31]
v_mfma_f32_16x16x32_bf16 v[32:35], v[108:111], v[144:147], v[32:35]
v_mfma_f32_16x16x32_bf16 v[36:39], v[108:111], v[148:151], v[36:39]
buffer_load_dwordx4 v[108:111], v1, s[4:7], s31 offen offset:2048
v_mfma_f32_16x16x32_bf16 v[40:43], v[112:115], v[136:139], v[40:43]
v_mfma_f32_16x16x32_bf16 v[44:47], v[112:115], v[140:143], v[44:47]
v_mfma_f32_16x16x32_bf16 v[48:51], v[112:115], v[144:147], v[48:51]
v_mfma_f32_16x16x32_bf16 v[52:55], v[112:115], v[148:151], v[52:55]
buffer_load_dwordx4 v[112:115], v1, s[4:7], s32 offen offset:2048
v_mfma_f32_16x16x32_bf16 v[56:59], v[116:119], v[136:139], v[56:59]
v_mfma_f32_16x16x32_bf16 v[60:63], v[116:119], v[140:143], v[60:63]
v_mfma_f32_16x16x32_bf16 v[64:67], v[116:119], v[144:147], v[64:67]
v_mfma_f32_16x16x32_bf16 v[68:71], v[116:119], v[148:151], v[68:71]
buffer_load_dwordx4 v[116:119], v1, s[4:7], s33 offen offset:2048
s_waitcnt vmcnt(12) lgkmcnt(0)
v_mfma_f32_16x16x32_bf16 v[8:11], v[120:123], v[152:155], v[8:11]
ds_read_b128 v[136:139], v6 offset:4096
v_mfma_f32_16x16x32_bf16 v[12:15], v[120:123], v[156:159], v[12:15]
ds_read_b128 v[140:143], v6 offset:24576
v_mfma_f32_16x16x32_bf16 v[16:19], v[120:123], v[160:163], v[16:19]
ds_read_b128 v[144:147], v7 offset:4096
v_mfma_f32_16x16x32_bf16 v[20:23], v[120:123], v[164:167], v[20:23]
ds_read_b128 v[148:151], v7 offset:24576
buffer_load_dwordx4 v[120:123], v1, s[4:7], s30 offen offset:3072
v_mfma_f32_16x16x32_bf16 v[24:27], v[124:127], v[152:155], v[24:27]
v_mfma_f32_16x16x32_bf16 v[28:31], v[124:127], v[156:159], v[28:31]
v_mfma_f32_16x16x32_bf16 v[32:35], v[124:127], v[160:163], v[32:35]
v_mfma_f32_16x16x32_bf16 v[36:39], v[124:127], v[164:167], v[36:39]
buffer_load_dwordx4 v[124:127], v1, s[4:7], s31 offen offset:3072
v_mfma_f32_16x16x32_bf16 v[40:43], v[128:131], v[152:155], v[40:43]
v_mfma_f32_16x16x32_bf16 v[44:47], v[128:131], v[156:159], v[44:47]
v_mfma_f32_16x16x32_bf16 v[48:51], v[128:131], v[160:163], v[48:51]
v_mfma_f32_16x16x32_bf16 v[52:55], v[128:131], v[164:167], v[52:55]
buffer_load_dwordx4 v[128:131], v1, s[4:7], s32 offen offset:3072
v_mfma_f32_16x16x32_bf16 v[56:59], v[132:135], v[152:155], v[56:59]
v_mfma_f32_16x16x32_bf16 v[60:63], v[132:135], v[156:159], v[60:63]
v_mfma_f32_16x16x32_bf16 v[64:67], v[132:135], v[160:163], v[64:67]
v_mfma_f32_16x16x32_bf16 v[68:71], v[132:135], v[164:167], v[68:71]
buffer_load_dwordx4 v[132:135], v1, s[4:7], s33 offen offset:3072
v_add_u32 v6, 4096, v6
v_add_u32 v7, 4096, v7
s_add_u32 s40, s40, 1
s_cmp_lt_u32 s40, 4
s_cbranch_scc1 qkvb_loop7
s_waitcnt vmcnt(0) lgkmcnt(0)
v_and_b32 v2, 63, v0
v_and_b32 v3, 15, v2
v_lshrrev_b32 v4, 4, v2
s_lshl_b32 s41, s17, 19
s_lshl_b32 s42, s18, 12
s_add_u32 s41, s41, s42
s_mov_b32 s46, 0x3ea52b5c
s_mov_b32 s47, 0x3ea52b5c
v_lshlrev_b32 v5, 2, v4
v_add_u32 v5, 64, v5
v_mul_u32_u24 v168, 205, v5
v_lshrrev_b32 v168, 12, v168
v_mul_u32_u24 v6, 20, v168
v_sub_u32 v5, v5, v6
v_lshlrev_b32 v168, 17, v168
v_lshrrev_b32 v6, 4, v5
v_lshl_add_u32 v168, v6, 10, v168
v_bfe_u32 v6, v5, 2, 1
v_lshl_add_u32 v168, v6, 9, v168
v_bfe_u32 v6, v5, 3, 1
v_lshl_add_u32 v168, v6, 3, v168
v_lshl_add_u32 v168, v3, 4, v168
v_lshlrev_b32 v5, 2, v4
v_add_u32 v5, 0, v5
v_mul_u32_u24 v169, 205, v5
v_lshrrev_b32 v169, 12, v169
v_mul_u32_u24 v6, 20, v169
v_sub_u32 v5, v5, v6
v_lshlrev_b32 v169, 17, v169
v_lshrrev_b32 v6, 4, v5
v_lshl_add_u32 v169, v6, 10, v169
v_bfe_u32 v6, v5, 2, 1
v_lshl_add_u32 v169, v6, 9, v169
v_bfe_u32 v6, v5, 3, 1
v_lshl_add_u32 v169, v6, 3, v169
v_lshl_add_u32 v169, v3, 4, v169
v_lshlrev_b32 v5, 2, v4
v_add_u32 v5, 16, v5
v_mul_u32_u24 v170, 205, v5
v_lshrrev_b32 v170, 12, v170
v_mul_u32_u24 v6, 20, v170
v_sub_u32 v5, v5, v6
v_lshlrev_b32 v170, 17, v170
v_lshrrev_b32 v6, 4, v5
v_lshl_add_u32 v170, v6, 10, v170
v_bfe_u32 v6, v5, 2, 1
v_lshl_add_u32 v170, v6, 9, v170
v_bfe_u32 v6, v5, 3, 1
v_lshl_add_u32 v170, v6, 3, v170
v_lshl_add_u32 v170, v3, 4, v170
v_lshlrev_b32 v5, 2, v4
v_add_u32 v5, 32, v5
v_mul_u32_u24 v171, 205, v5
v_lshrrev_b32 v171, 12, v171
v_mul_u32_u24 v6, 20, v171
v_sub_u32 v5, v5, v6
v_lshlrev_b32 v171, 17, v171
v_lshrrev_b32 v6, 4, v5
v_lshl_add_u32 v171, v6, 10, v171
v_bfe_u32 v6, v5, 2, 1
v_lshl_add_u32 v171, v6, 9, v171
v_bfe_u32 v6, v5, 3, 1
v_lshl_add_u32 v171, v6, 3, v171
v_lshl_add_u32 v171, v3, 4, v171
v_pk_mul_f32 v[8:9], v[8:9], s[46:47]
v_pk_mul_f32 v[10:11], v[10:11], s[46:47]
v_cvt_pk_bf16_f32 v136, v8, v9
v_cvt_pk_bf16_f32 v137, v10, v11
s_add_u32 s43, s41, 37748736
buffer_store_dwordx2 v[136:137], v168, s[4:7], s43 offen sc1
v_pk_mul_f32 v[12:13], v[12:13], s[46:47]
v_pk_mul_f32 v[14:15], v[14:15], s[46:47]
v_cvt_pk_bf16_f32 v138, v12, v13
v_cvt_pk_bf16_f32 v139, v14, v15
s_add_u32 s43, s41, 37748992
buffer_store_dwordx2 v[138:139], v168, s[4:7], s43 offen sc1
v_pk_mul_f32 v[16:17], v[16:17], s[46:47]
v_pk_mul_f32 v[18:19], v[18:19], s[46:47]
v_cvt_pk_bf16_f32 v140, v16, v17
v_cvt_pk_bf16_f32 v141, v18, v19
s_add_u32 s43, s41, 37750784
buffer_store_dwordx2 v[140:141], v168, s[4:7], s43 offen sc1
v_pk_mul_f32 v[20:21], v[20:21], s[46:47]
v_pk_mul_f32 v[22:23], v[22:23], s[46:47]
v_cvt_pk_bf16_f32 v142, v20, v21
v_cvt_pk_bf16_f32 v143, v22, v23
s_add_u32 s43, s41, 37751040
buffer_store_dwordx2 v[142:143], v168, s[4:7], s43 offen sc1
v_cvt_pk_bf16_f32 v144, v24, v25
v_cvt_pk_bf16_f32 v145, v26, v27
s_add_u32 s43, s41, 41943040
buffer_store_dwordx2 v[144:145], v169, s[4:7], s43 offen sc1
v_cvt_pk_bf16_f32 v146, v28, v29
v_cvt_pk_bf16_f32 v147, v30, v31
s_add_u32 s43, s41, 41943296
buffer_store_dwordx2 v[146:147], v169, s[4:7], s43 offen sc1
v_cvt_pk_bf16_f32 v148, v32, v33
v_cvt_pk_bf16_f32 v149, v34, v35
s_add_u32 s43, s41, 41945088
buffer_store_dwordx2 v[148:149], v169, s[4:7], s43 offen sc1
v_cvt_pk_bf16_f32 v150, v36, v37
v_cvt_pk_bf16_f32 v151, v38, v39
s_add_u32 s43, s41, 41945344
buffer_store_dwordx2 v[150:151], v169, s[4:7], s43 offen sc1
v_cvt_pk_bf16_f32 v136, v40, v41
v_cvt_pk_bf16_f32 v137, v42, v43
s_add_u32 s43, s41, 41943040
buffer_store_dwordx2 v[136:137], v170, s[4:7], s43 offen sc1
v_cvt_pk_bf16_f32 v138, v44, v45
v_cvt_pk_bf16_f32 v139, v46, v47
s_add_u32 s43, s41, 41943296
buffer_store_dwordx2 v[138:139], v170, s[4:7], s43 offen sc1
v_cvt_pk_bf16_f32 v140, v48, v49
v_cvt_pk_bf16_f32 v141, v50, v51
s_add_u32 s43, s41, 41945088
buffer_store_dwordx2 v[140:141], v170, s[4:7], s43 offen sc1
v_cvt_pk_bf16_f32 v142, v52, v53
v_cvt_pk_bf16_f32 v143, v54, v55
s_add_u32 s43, s41, 41945344
buffer_store_dwordx2 v[142:143], v170, s[4:7], s43 offen sc1
v_cvt_pk_bf16_f32 v144, v56, v57
v_cvt_pk_bf16_f32 v145, v58, v59
s_add_u32 s43, s41, 41943040
buffer_store_dwordx2 v[144:145], v171, s[4:7], s43 offen sc1
v_cvt_pk_bf16_f32 v146, v60, v61
v_cvt_pk_bf16_f32 v147, v62, v63
s_add_u32 s43, s41, 41943296
buffer_store_dwordx2 v[146:147], v171, s[4:7], s43 offen sc1
v_cvt_pk_bf16_f32 v148, v64, v65
v_cvt_pk_bf16_f32 v149, v66, v67
s_add_u32 s43, s41, 41945088
buffer_store_dwordx2 v[148:149], v171, s[4:7], s43 offen sc1
v_cvt_pk_bf16_f32 v150, v68, v69
v_cvt_pk_bf16_f32 v151, v70, v71
s_add_u32 s43, s41, 41945344
buffer_store_dwordx2 v[150:151], v171, s[4:7], s43 offen sc1
s_branch qkvb_exit1
qkvb_w2_4:
s_mul_i32 s30, s17, 5
s_add_u32 s30, s30, 43
s_mul_i32 s30, s30, 20480
s_add_u32 s30, s30, 87556096
s_mul_i32 s31, s17, 5
s_add_u32 s31, s31, 44
s_mul_i32 s31, s31, 20480
s_add_u32 s31, s31, 87556096
s_mul_i32 s32, s17, 5
s_add_u32 s32, s32, 80
s_mul_i32 s32, s32, 20480
s_add_u32 s32, s32, 87556096
s_mul_i32 s33, s17, 5
s_add_u32 s33, s33, 81
s_mul_i32 s33, s33, 20480
s_add_u32 s33, s33, 87556096
buffer_load_dwordx4 v[72:75], v1, s[4:7], s30 offen offset:0
buffer_load_dwordx4 v[76:79], v1, s[4:7], s31 offen offset:0
buffer_load_dwordx4 v[80:83], v1, s[4:7], s32 offen offset:0
buffer_load_dwordx4 v[84:87], v1, s[4:7], s33 offen offset:0
buffer_load_dwordx4 v[88:91], v1, s[4:7], s30 offen offset:1024
buffer_load_dwordx4 v[92:95], v1, s[4:7], s31 offen offset:1024
buffer_load_dwordx4 v[96:99], v1, s[4:7], s32 offen offset:1024
buffer_load_dwordx4 v[100:103], v1, s[4:7], s33 offen offset:1024
buffer_load_dwordx4 v[104:107], v1, s[4:7], s30 offen offset:2048
buffer_load_dwordx4 v[108:111], v1, s[4:7], s31 offen offset:2048
buffer_load_dwordx4 v[112:115], v1, s[4:7], s32 offen offset:2048
buffer_load_dwordx4 v[116:119], v1, s[4:7], s33 offen offset:2048
s_add_u32 m0, s22, 4096
s_add_u32 s23, s21, 4096
buffer_load_dwordx4 v1, s[4:7], s23 offen offset:0 lds
buffer_load_dwordx4 v1, s[4:7], s23 offen offset:1024 lds
buffer_load_dwordx4 v1, s[4:7], s23 offen offset:2048 lds
buffer_load_dwordx4 v1, s[4:7], s23 offen offset:3072 lds
s_add_u32 m0, s22, 8192
s_add_u32 s23, s21, 8192
buffer_load_dwordx4 v1, s[4:7], s23 offen offset:0 lds
buffer_load_dwordx4 v1, s[4:7], s23 offen offset:1024 lds
buffer_load_dwordx4 v1, s[4:7], s23 offen offset:2048 lds
buffer_load_dwordx4 v1, s[4:7], s23 offen offset:3072 lds
s_add_u32 m0, s22, 12288
s_add_u32 s23, s21, 12288
buffer_load_dwordx4 v1, s[4:7], s23 offen offset:0 lds
buffer_load_dwordx4 v1, s[4:7], s23 offen offset:1024 lds
buffer_load_dwordx4 v1, s[4:7], s23 offen offset:2048 lds
buffer_load_dwordx4 v1, s[4:7], s23 offen offset:3072 lds
s_add_u32 m0, s22, 16384
s_add_u32 s23, s21, 16384
buffer_load_dwordx4 v1, s[4:7], s23 offen offset:0 lds
buffer_load_dwordx4 v1, s[4:7], s23 offen offset:1024 lds
buffer_load_dwordx4 v1, s[4:7], s23 offen offset:2048 lds
buffer_load_dwordx4 v1, s[4:7], s23 offen offset:3072 lds
s_waitcnt vmcnt(28)
s_barrier
buffer_load_dwordx4 v[120:123], v1, s[4:7], s30 offen offset:3072
buffer_load_dwordx4 v[124:127], v1, s[4:7], s31 offen offset:3072
buffer_load_dwordx4 v[128:131], v1, s[4:7], s32 offen offset:3072
buffer_load_dwordx4 v[132:135], v1, s[4:7], s33 offen offset:3072
ds_read_b128 v[136:139], v6 offset:0
ds_read_b128 v[140:143], v6 offset:20480
ds_read_b128 v[144:147], v7 offset:0
ds_read_b128 v[148:151], v7 offset:20480
s_waitcnt vmcnt(28) lgkmcnt(0)
v_mfma_f32_16x16x32_bf16 v[8:11], v[72:75], v[136:139], 0
ds_read_b128 v[152:155], v6 offset:1024
v_mfma_f32_16x16x32_bf16 v[12:15], v[72:75], v[140:143], 0
ds_read_b128 v[156:159], v6 offset:21504
v_mfma_f32_16x16x32_bf16 v[16:19], v[72:75], v[144:147], 0
ds_read_b128 v[160:163], v7 offset:1024
v_mfma_f32_16x16x32_bf16 v[20:23], v[72:75], v[148:151], 0
ds_read_b128 v[164:167], v7 offset:21504
s_add_u32 s30, s30, 4096
buffer_load_dwordx4 v[72:75], v1, s[4:7], s30 offen offset:0
v_mfma_f32_16x16x32_bf16 v[24:27], v[76:79], v[136:139], 0
v_mfma_f32_16x16x32_bf16 v[28:31], v[76:79], v[140:143], 0
v_mfma_f32_16x16x32_bf16 v[32:35], v[76:79], v[144:147], 0
v_mfma_f32_16x16x32_bf16 v[36:39], v[76:79], v[148:151], 0
s_add_u32 s31, s31, 4096
buffer_load_dwordx4 v[76:79], v1, s[4:7], s31 offen offset:0
v_mfma_f32_16x16x32_bf16 v[40:43], v[136:139], v[80:83], 0
v_mfma_f32_16x16x32_bf16 v[44:47], v[140:143], v[80:83], 0
v_mfma_f32_16x16x32_bf16 v[48:51], v[144:147], v[80:83], 0
v_mfma_f32_16x16x32_bf16 v[52:55], v[148:151], v[80:83], 0
s_add_u32 s32, s32, 4096
buffer_load_dwordx4 v[80:83], v1, s[4:7], s32 offen offset:0
v_mfma_f32_16x16x32_bf16 v[56:59], v[136:139], v[84:87], 0
v_mfma_f32_16x16x32_bf16 v[60:63], v[140:143], v[84:87], 0
v_mfma_f32_16x16x32_bf16 v[64:67], v[144:147], v[84:87], 0
v_mfma_f32_16x16x32_bf16 v[68:71], v[148:151], v[84:87], 0
s_add_u32 s33, s33, 4096
buffer_load_dwordx4 v[84:87], v1, s[4:7], s33 offen offset:0
s_waitcnt vmcnt(28) lgkmcnt(0)
v_mfma_f32_16x16x32_bf16 v[8:11], v[88:91], v[152:155], v[8:11]
ds_read_b128 v[136:139], v6 offset:2048
v_mfma_f32_16x16x32_bf16 v[12:15], v[88:91], v[156:159], v[12:15]
ds_read_b128 v[140:143], v6 offset:22528
v_mfma_f32_16x16x32_bf16 v[16:19], v[88:91], v[160:163], v[16:19]
ds_read_b128 v[144:147], v7 offset:2048
v_mfma_f32_16x16x32_bf16 v[20:23], v[88:91], v[164:167], v[20:23]
ds_read_b128 v[148:151], v7 offset:22528
buffer_load_dwordx4 v[88:91], v1, s[4:7], s30 offen offset:1024
v_mfma_f32_16x16x32_bf16 v[24:27], v[92:95], v[152:155], v[24:27]
v_mfma_f32_16x16x32_bf16 v[28:31], v[92:95], v[156:159], v[28:31]
v_mfma_f32_16x16x32_bf16 v[32:35], v[92:95], v[160:163], v[32:35]
v_mfma_f32_16x16x32_bf16 v[36:39], v[92:95], v[164:167], v[36:39]
buffer_load_dwordx4 v[92:95], v1, s[4:7], s31 offen offset:1024
v_mfma_f32_16x16x32_bf16 v[40:43], v[152:155], v[96:99], v[40:43]
v_mfma_f32_16x16x32_bf16 v[44:47], v[156:159], v[96:99], v[44:47]
v_mfma_f32_16x16x32_bf16 v[48:51], v[160:163], v[96:99], v[48:51]
v_mfma_f32_16x16x32_bf16 v[52:55], v[164:167], v[96:99], v[52:55]
buffer_load_dwordx4 v[96:99], v1, s[4:7], s32 offen offset:1024
v_mfma_f32_16x16x32_bf16 v[56:59], v[152:155], v[100:103], v[56:59]
v_mfma_f32_16x16x32_bf16 v[60:63], v[156:159], v[100:103], v[60:63]
v_mfma_f32_16x16x32_bf16 v[64:67], v[160:163], v[100:103], v[64:67]
v_mfma_f32_16x16x32_bf16 v[68:71], v[164:167], v[100:103], v[68:71]
buffer_load_dwordx4 v[100:103], v1, s[4:7], s33 offen offset:1024
s_waitcnt vmcnt(28) lgkmcnt(0)
v_mfma_f32_16x16x32_bf16 v[8:11], v[104:107], v[136:139], v[8:11]
ds_read_b128 v[152:155], v6 offset:3072
v_mfma_f32_16x16x32_bf16 v[12:15], v[104:107], v[140:143], v[12:15]
ds_read_b128 v[156:159], v6 offset:23552
v_mfma_f32_16x16x32_bf16 v[16:19], v[104:107], v[144:147], v[16:19]
ds_read_b128 v[160:163], v7 offset:3072
v_mfma_f32_16x16x32_bf16 v[20:23], v[104:107], v[148:151], v[20:23]
ds_read_b128 v[164:167], v7 offset:23552
buffer_load_dwordx4 v[104:107], v1, s[4:7], s30 offen offset:2048
v_mfma_f32_16x16x32_bf16 v[24:27], v[108:111], v[136:139], v[24:27]
v_mfma_f32_16x16x32_bf16 v[28:31], v[108:111], v[140:143], v[28:31]
v_mfma_f32_16x16x32_bf16 v[32:35], v[108:111], v[144:147], v[32:35]
v_mfma_f32_16x16x32_bf16 v[36:39], v[108:111], v[148:151], v[36:39]
buffer_load_dwordx4 v[108:111], v1, s[4:7], s31 offen offset:2048
v_mfma_f32_16x16x32_bf16 v[40:43], v[136:139], v[112:115], v[40:43]
v_mfma_f32_16x16x32_bf16 v[44:47], v[140:143], v[112:115], v[44:47]
v_mfma_f32_16x16x32_bf16 v[48:51], v[144:147], v[112:115], v[48:51]
v_mfma_f32_16x16x32_bf16 v[52:55], v[148:151], v[112:115], v[52:55]
buffer_load_dwordx4 v[112:115], v1, s[4:7], s32 offen offset:2048
v_mfma_f32_16x16x32_bf16 v[56:59], v[136:139], v[116:119], v[56:59]
v_mfma_f32_16x16x32_bf16 v[60:63], v[140:143], v[116:119], v[60:63]
v_mfma_f32_16x16x32_bf16 v[64:67], v[144:147], v[116:119], v[64:67]
v_mfma_f32_16x16x32_bf16 v[68:71], v[148:151], v[116:119], v[68:71]
buffer_load_dwordx4 v[116:119], v1, s[4:7], s33 offen offset:2048
s_waitcnt vmcnt(12) lgkmcnt(0)
s_barrier
v_mfma_f32_16x16x32_bf16 v[8:11], v[120:123], v[152:155], v[8:11]
ds_read_b128 v[136:139], v6 offset:4096
v_mfma_f32_16x16x32_bf16 v[12:15], v[120:123], v[156:159], v[12:15]
ds_read_b128 v[140:143], v6 offset:24576
v_mfma_f32_16x16x32_bf16 v[16:19], v[120:123], v[160:163], v[16:19]
ds_read_b128 v[144:147], v7 offset:4096
v_mfma_f32_16x16x32_bf16 v[20:23], v[120:123], v[164:167], v[20:23]
ds_read_b128 v[148:151], v7 offset:24576
buffer_load_dwordx4 v[120:123], v1, s[4:7], s30 offen offset:3072
v_mfma_f32_16x16x32_bf16 v[24:27], v[124:127], v[152:155], v[24:27]
v_mfma_f32_16x16x32_bf16 v[28:31], v[124:127], v[156:159], v[28:31]
v_mfma_f32_16x16x32_bf16 v[32:35], v[124:127], v[160:163], v[32:35]
v_mfma_f32_16x16x32_bf16 v[36:39], v[124:127], v[164:167], v[36:39]
buffer_load_dwordx4 v[124:127], v1, s[4:7], s31 offen offset:3072
v_mfma_f32_16x16x32_bf16 v[40:43], v[152:155], v[128:131], v[40:43]
v_mfma_f32_16x16x32_bf16 v[44:47], v[156:159], v[128:131], v[44:47]
v_mfma_f32_16x16x32_bf16 v[48:51], v[160:163], v[128:131], v[48:51]
v_mfma_f32_16x16x32_bf16 v[52:55], v[164:167], v[128:131], v[52:55]
buffer_load_dwordx4 v[128:131], v1, s[4:7], s32 offen offset:3072
v_mfma_f32_16x16x32_bf16 v[56:59], v[152:155], v[132:135], v[56:59]
v_mfma_f32_16x16x32_bf16 v[60:63], v[156:159], v[132:135], v[60:63]
v_mfma_f32_16x16x32_bf16 v[64:67], v[160:163], v[132:135], v[64:67]
v_mfma_f32_16x16x32_bf16 v[68:71], v[164:167], v[132:135], v[68:71]
buffer_load_dwordx4 v[132:135], v1, s[4:7], s33 offen offset:3072
s_mov_b32 s40, 0
v_add_u32 v6, 4096, v6
v_add_u32 v7, 4096, v7
qkvb_loop8:
s_waitcnt vmcnt(12) lgkmcnt(0)
v_mfma_f32_16x16x32_bf16 v[8:11], v[72:75], v[136:139], v[8:11]
ds_read_b128 v[152:155], v6 offset:1024
v_mfma_f32_16x16x32_bf16 v[12:15], v[72:75], v[140:143], v[12:15]
ds_read_b128 v[156:159], v6 offset:21504
v_mfma_f32_16x16x32_bf16 v[16:19], v[72:75], v[144:147], v[16:19]
ds_read_b128 v[160:163], v7 offset:1024
v_mfma_f32_16x16x32_bf16 v[20:23], v[72:75], v[148:151], v[20:23]
ds_read_b128 v[164:167], v7 offset:21504
s_add_u32 s30, s30, 4096
buffer_load_dwordx4 v[72:75], v1, s[4:7], s30 offen offset:0
v_mfma_f32_16x16x32_bf16 v[24:27], v[76:79], v[136:139], v[24:27]
v_mfma_f32_16x16x32_bf16 v[28:31], v[76:79], v[140:143], v[28:31]
v_mfma_f32_16x16x32_bf16 v[32:35], v[76:79], v[144:147], v[32:35]
v_mfma_f32_16x16x32_bf16 v[36:39], v[76:79], v[148:151], v[36:39]
s_add_u32 s31, s31, 4096
buffer_load_dwordx4 v[76:79], v1, s[4:7], s31 offen offset:0
v_mfma_f32_16x16x32_bf16 v[40:43], v[136:139], v[80:83], v[40:43]
v_mfma_f32_16x16x32_bf16 v[44:47], v[140:143], v[80:83], v[44:47]
v_mfma_f32_16x16x32_bf16 v[48:51], v[144:147], v[80:83], v[48:51]
v_mfma_f32_16x16x32_bf16 v[52:55], v[148:151], v[80:83], v[52:55]
s_add_u32 s32, s32, 4096
buffer_load_dwordx4 v[80:83], v1, s[4:7], s32 offen offset:0
v_mfma_f32_16x16x32_bf16 v[56:59], v[136:139], v[84:87], v[56:59]
v_mfma_f32_16x16x32_bf16 v[60:63], v[140:143], v[84:87], v[60:63]
v_mfma_f32_16x16x32_bf16 v[64:67], v[144:147], v[84:87], v[64:67]
v_mfma_f32_16x16x32_bf16 v[68:71], v[148:151], v[84:87], v[68:71]
s_add_u32 s33, s33, 4096
buffer_load_dwordx4 v[84:87], v1, s[4:7], s33 offen offset:0
s_waitcnt vmcnt(12) lgkmcnt(0)
v_mfma_f32_16x16x32_bf16 v[8:11], v[88:91], v[152:155], v[8:11]
ds_read_b128 v[136:139], v6 offset:2048
v_mfma_f32_16x16x32_bf16 v[12:15], v[88:91], v[156:159], v[12:15]
ds_read_b128 v[140:143], v6 offset:22528
v_mfma_f32_16x16x32_bf16 v[16:19], v[88:91], v[160:163], v[16:19]
ds_read_b128 v[144:147], v7 offset:2048
v_mfma_f32_16x16x32_bf16 v[20:23], v[88:91], v[164:167], v[20:23]
ds_read_b128 v[148:151], v7 offset:22528
buffer_load_dwordx4 v[88:91], v1, s[4:7], s30 offen offset:1024
v_mfma_f32_16x16x32_bf16 v[24:27], v[92:95], v[152:155], v[24:27]
v_mfma_f32_16x16x32_bf16 v[28:31], v[92:95], v[156:159], v[28:31]
v_mfma_f32_16x16x32_bf16 v[32:35], v[92:95], v[160:163], v[32:35]
v_mfma_f32_16x16x32_bf16 v[36:39], v[92:95], v[164:167], v[36:39]
buffer_load_dwordx4 v[92:95], v1, s[4:7], s31 offen offset:1024
v_mfma_f32_16x16x32_bf16 v[40:43], v[152:155], v[96:99], v[40:43]
v_mfma_f32_16x16x32_bf16 v[44:47], v[156:159], v[96:99], v[44:47]
v_mfma_f32_16x16x32_bf16 v[48:51], v[160:163], v[96:99], v[48:51]
v_mfma_f32_16x16x32_bf16 v[52:55], v[164:167], v[96:99], v[52:55]
buffer_load_dwordx4 v[96:99], v1, s[4:7], s32 offen offset:1024
v_mfma_f32_16x16x32_bf16 v[56:59], v[152:155], v[100:103], v[56:59]
v_mfma_f32_16x16x32_bf16 v[60:63], v[156:159], v[100:103], v[60:63]
v_mfma_f32_16x16x32_bf16 v[64:67], v[160:163], v[100:103], v[64:67]
v_mfma_f32_16x16x32_bf16 v[68:71], v[164:167], v[100:103], v[68:71]
buffer_load_dwordx4 v[100:103], v1, s[4:7], s33 offen offset:1024
s_waitcnt vmcnt(12) lgkmcnt(0)
v_mfma_f32_16x16x32_bf16 v[8:11], v[104:107], v[136:139], v[8:11]
ds_read_b128 v[152:155], v6 offset:3072
v_mfma_f32_16x16x32_bf16 v[12:15], v[104:107], v[140:143], v[12:15]
ds_read_b128 v[156:159], v6 offset:23552
v_mfma_f32_16x16x32_bf16 v[16:19], v[104:107], v[144:147], v[16:19]
ds_read_b128 v[160:163], v7 offset:3072
v_mfma_f32_16x16x32_bf16 v[20:23], v[104:107], v[148:151], v[20:23]
ds_read_b128 v[164:167], v7 offset:23552
buffer_load_dwordx4 v[104:107], v1, s[4:7], s30 offen offset:2048
v_mfma_f32_16x16x32_bf16 v[24:27], v[108:111], v[136:139], v[24:27]
v_mfma_f32_16x16x32_bf16 v[28:31], v[108:111], v[140:143], v[28:31]
v_mfma_f32_16x16x32_bf16 v[32:35], v[108:111], v[144:147], v[32:35]
v_mfma_f32_16x16x32_bf16 v[36:39], v[108:111], v[148:151], v[36:39]
buffer_load_dwordx4 v[108:111], v1, s[4:7], s31 offen offset:2048
v_mfma_f32_16x16x32_bf16 v[40:43], v[136:139], v[112:115], v[40:43]
v_mfma_f32_16x16x32_bf16 v[44:47], v[140:143], v[112:115], v[44:47]
v_mfma_f32_16x16x32_bf16 v[48:51], v[144:147], v[112:115], v[48:51]
v_mfma_f32_16x16x32_bf16 v[52:55], v[148:151], v[112:115], v[52:55]
buffer_load_dwordx4 v[112:115], v1, s[4:7], s32 offen offset:2048
v_mfma_f32_16x16x32_bf16 v[56:59], v[136:139], v[116:119], v[56:59]
v_mfma_f32_16x16x32_bf16 v[60:63], v[140:143], v[116:119], v[60:63]
v_mfma_f32_16x16x32_bf16 v[64:67], v[144:147], v[116:119], v[64:67]
v_mfma_f32_16x16x32_bf16 v[68:71], v[148:151], v[116:119], v[68:71]
buffer_load_dwordx4 v[116:119], v1, s[4:7], s33 offen offset:2048
s_waitcnt vmcnt(12) lgkmcnt(0)
v_mfma_f32_16x16x32_bf16 v[8:11], v[120:123], v[152:155], v[8:11]
ds_read_b128 v[136:139], v6 offset:4096
v_mfma_f32_16x16x32_bf16 v[12:15], v[120:123], v[156:159], v[12:15]
ds_read_b128 v[140:143], v6 offset:24576
v_mfma_f32_16x16x32_bf16 v[16:19], v[120:123], v[160:163], v[16:19]
ds_read_b128 v[144:147], v7 offset:4096
v_mfma_f32_16x16x32_bf16 v[20:23], v[120:123], v[164:167], v[20:23]
ds_read_b128 v[148:151], v7 offset:24576
buffer_load_dwordx4 v[120:123], v1, s[4:7], s30 offen offset:3072
v_mfma_f32_16x16x32_bf16 v[24:27], v[124:127], v[152:155], v[24:27]
v_mfma_f32_16x16x32_bf16 v[28:31], v[124:127], v[156:159], v[28:31]
v_mfma_f32_16x16x32_bf16 v[32:35], v[124:127], v[160:163], v[32:35]
v_mfma_f32_16x16x32_bf16 v[36:39], v[124:127], v[164:167], v[36:39]
buffer_load_dwordx4 v[124:127], v1, s[4:7], s31 offen offset:3072
v_mfma_f32_16x16x32_bf16 v[40:43], v[152:155], v[128:131], v[40:43]
v_mfma_f32_16x16x32_bf16 v[44:47], v[156:159], v[128:131], v[44:47]
v_mfma_f32_16x16x32_bf16 v[48:51], v[160:163], v[128:131], v[48:51]
v_mfma_f32_16x16x32_bf16 v[52:55], v[164:167], v[128:131], v[52:55]
buffer_load_dwordx4 v[128:131], v1, s[4:7], s32 offen offset:3072
v_mfma_f32_16x16x32_bf16 v[56:59], v[152:155], v[132:135], v[56:59]
v_mfma_f32_16x16x32_bf16 v[60:63], v[156:159], v[132:135], v[60:63]
v_mfma_f32_16x16x32_bf16 v[64:67], v[160:163], v[132:135], v[64:67]
v_mfma_f32_16x16x32_bf16 v[68:71], v[164:167], v[132:135], v[68:71]
buffer_load_dwordx4 v[132:135], v1, s[4:7], s33 offen offset:3072
v_add_u32 v6, 4096, v6
v_add_u32 v7, 4096, v7
s_add_u32 s40, s40, 1
s_cmp_lt_u32 s40, 4
s_cbranch_scc1 qkvb_loop8
s_waitcnt vmcnt(0) lgkmcnt(0)
v_and_b32 v2, 63, v0
v_and_b32 v3, 15, v2
v_lshrrev_b32 v4, 4, v2
s_lshl_b32 s41, s17, 19
s_lshl_b32 s42, s18, 12
s_add_u32 s41, s41, s42
s_mov_b32 s46, 0x3ea52b5c
s_mov_b32 s47, 0x3ea52b5c
v_lshlrev_b32 v5, 2, v4
v_add_u32 v5, 48, v5
v_mul_u32_u24 v168, 205, v5
v_lshrrev_b32 v168, 12, v168
v_mul_u32_u24 v6, 20, v168
v_sub_u32 v5, v5, v6
v_lshlrev_b32 v168, 17, v168
v_lshrrev_b32 v6, 4, v5
v_lshl_add_u32 v168, v6, 10, v168
v_bfe_u32 v6, v5, 2, 1
v_lshl_add_u32 v168, v6, 9, v168
v_bfe_u32 v6, v5, 3, 1
v_lshl_add_u32 v168, v6, 3, v168
v_lshl_add_u32 v168, v3, 4, v168
v_lshlrev_b32 v5, 2, v4
v_add_u32 v5, 64, v5
v_mul_u32_u24 v169, 205, v5
v_lshrrev_b32 v169, 12, v169
v_mul_u32_u24 v6, 20, v169
v_sub_u32 v5, v5, v6
v_lshlrev_b32 v169, 17, v169
v_lshrrev_b32 v6, 4, v5
v_lshl_add_u32 v169, v6, 10, v169
v_bfe_u32 v6, v5, 2, 1
v_lshl_add_u32 v169, v6, 9, v169
v_bfe_u32 v6, v5, 3, 1
v_lshl_add_u32 v169, v6, 3, v169
v_lshl_add_u32 v169, v3, 4, v169
v_add_u32 v5, 0, v3
v_mul_u32_u24 v170, 205, v5
v_lshrrev_b32 v170, 12, v170
v_mul_u32_u24 v6, 20, v170
v_sub_u32 v5, v5, v6
v_lshlrev_b32 v170, 17, v170
v_lshl_add_u32 v170, v5, 4, v170
v_and_b32 v6, 1, v4
v_lshl_add_u32 v170, v6, 9, v170
v_lshrrev_b32 v6, 1, v4
v_lshl_add_u32 v170, v6, 3, v170
v_add_u32 v5, 16, v3
v_mul_u32_u24 v171, 205, v5
v_lshrrev_b32 v171, 12, v171
v_mul_u32_u24 v6, 20, v171
v_sub_u32 v5, v5, v6
v_lshlrev_b32 v171, 17, v171
v_lshl_add_u32 v171, v5, 4, v171
v_and_b32 v6, 1, v4
v_lshl_add_u32 v171, v6, 9, v171
v_lshrrev_b32 v6, 1, v4
v_lshl_add_u32 v171, v6, 3, v171
v_cvt_pk_bf16_f32 v136, v8, v9
v_cvt_pk_bf16_f32 v137, v10, v11
s_add_u32 s43, s41, 41943040
buffer_store_dwordx2 v[136:137], v168, s[4:7], s43 offen sc1
v_cvt_pk_bf16_f32 v138, v12, v13
v_cvt_pk_bf16_f32 v139, v14, v15
s_add_u32 s43, s41, 41943296
buffer_store_dwordx2 v[138:139], v168, s[4:7], s43 offen sc1
v_cvt_pk_bf16_f32 v140, v16, v17
v_cvt_pk_bf16_f32 v141, v18, v19
s_add_u32 s43, s41, 41945088
buffer_store_dwordx2 v[140:141], v168, s[4:7], s43 offen sc1
v_cvt_pk_bf16_f32 v142, v20, v21
v_cvt_pk_bf16_f32 v143, v22, v23
s_add_u32 s43, s41, 41945344
buffer_store_dwordx2 v[142:143], v168, s[4:7], s43 offen sc1
v_cvt_pk_bf16_f32 v144, v24, v25
v_cvt_pk_bf16_f32 v145, v26, v27
s_add_u32 s43, s41, 41943040
buffer_store_dwordx2 v[144:145], v169, s[4:7], s43 offen sc1
v_cvt_pk_bf16_f32 v146, v28, v29
v_cvt_pk_bf16_f32 v147, v30, v31
s_add_u32 s43, s41, 41943296
buffer_store_dwordx2 v[146:147], v169, s[4:7], s43 offen sc1
v_cvt_pk_bf16_f32 v148, v32, v33
v_cvt_pk_bf16_f32 v149, v34, v35
s_add_u32 s43, s41, 41945088
buffer_store_dwordx2 v[148:149], v169, s[4:7], s43 offen sc1
v_cvt_pk_bf16_f32 v150, v36, v37
v_cvt_pk_bf16_f32 v151, v38, v39
s_add_u32 s43, s41, 41945344
buffer_store_dwordx2 v[150:151], v169, s[4:7], s43 offen sc1
v_cvt_pk_bf16_f32 v136, v40, v41
v_cvt_pk_bf16_f32 v137, v42, v43
s_add_u32 s43, s41, 46137344
buffer_store_dwordx2 v[136:137], v170, s[4:7], s43 offen sc1
v_cvt_pk_bf16_f32 v138, v44, v45
v_cvt_pk_bf16_f32 v139, v46, v47
s_add_u32 s43, s41, 46138368
buffer_store_dwordx2 v[138:139], v170, s[4:7], s43 offen sc1
v_cvt_pk_bf16_f32 v140, v48, v49
v_cvt_pk_bf16_f32 v141, v50, v51
s_add_u32 s43, s41, 46139392
buffer_store_dwordx2 v[140:141], v170, s[4:7], s43 offen sc1
v_cvt_pk_bf16_f32 v142, v52, v53
v_cvt_pk_bf16_f32 v143, v54, v55
s_add_u32 s43, s41, 46140416
buffer_store_dwordx2 v[142:143], v170, s[4:7], s43 offen sc1
v_cvt_pk_bf16_f32 v144, v56, v57
v_cvt_pk_bf16_f32 v145, v58, v59
s_add_u32 s43, s41, 46137344
buffer_store_dwordx2 v[144:145], v171, s[4:7], s43 offen sc1
v_cvt_pk_bf16_f32 v146, v60, v61
v_cvt_pk_bf16_f32 v147, v62, v63
s_add_u32 s43, s41, 46138368
buffer_store_dwordx2 v[146:147], v171, s[4:7], s43 offen sc1
v_cvt_pk_bf16_f32 v148, v64, v65
v_cvt_pk_bf16_f32 v149, v66, v67
s_add_u32 s43, s41, 46139392
buffer_store_dwordx2 v[148:149], v171, s[4:7], s43 offen sc1
v_cvt_pk_bf16_f32 v150, v68, v69
v_cvt_pk_bf16_f32 v151, v70, v71
s_add_u32 s43, s41, 46140416
buffer_store_dwordx2 v[150:151], v171, s[4:7], s43 offen sc1
s_branch qkvb_exit1
qkvb_w3_5:
s_mul_i32 s30, s17, 5
s_add_u32 s30, s30, 82
s_mul_i32 s30, s30, 20480
s_add_u32 s30, s30, 87556096
s_mul_i32 s31, s17, 5
s_add_u32 s31, s31, 83
s_mul_i32 s31, s31, 20480
s_add_u32 s31, s31, 87556096
s_mul_i32 s32, s17, 5
s_add_u32 s32, s32, 84
s_mul_i32 s32, s32, 20480
s_add_u32 s32, s32, 87556096
buffer_load_dwordx4 v[72:75], v1, s[4:7], s30 offen offset:0
buffer_load_dwordx4 v[76:79], v1, s[4:7], s31 offen offset:0
buffer_load_dwordx4 v[80:83], v1, s[4:7], s32 offen offset:0
buffer_load_dwordx4 v[88:91], v1, s[4:7], s30 offen offset:1024
buffer_load_dwordx4 v[92:95], v1, s[4:7], s31 offen offset:1024
buffer_load_dwordx4 v[96:99], v1, s[4:7], s32 offen offset:1024
buffer_load_dwordx4 v[104:107], v1, s[4:7], s30 offen offset:2048
buffer_load_dwordx4 v[108:111], v1, s[4:7], s31 offen offset:2048
buffer_load_dwordx4 v[112:115], v1, s[4:7], s32 offen offset:2048
s_add_u32 m0, s22, 4096
s_add_u32 s23, s21, 4096
buffer_load_dwordx4 v1, s[4:7], s23 offen offset:0 lds
buffer_load_dwordx4 v1, s[4:7], s23 offen offset:1024 lds
buffer_load_dwordx4 v1, s[4:7], s23 offen offset:2048 lds
buffer_load_dwordx4 v1, s[4:7], s23 offen offset:3072 lds
s_add_u32 m0, s22, 8192
s_add_u32 s23, s21, 8192
buffer_load_dwordx4 v1, s[4:7], s23 offen offset:0 lds
buffer_load_dwordx4 v1, s[4:7], s23 offen offset:1024 lds
buffer_load_dwordx4 v1, s[4:7], s23 offen offset:2048 lds
buffer_load_dwordx4 v1, s[4:7], s23 offen offset:3072 lds
s_add_u32 m0, s22, 12288
s_add_u32 s23, s21, 12288
buffer_load_dwordx4 v1, s[4:7], s23 offen offset:0 lds
buffer_load_dwordx4 v1, s[4:7], s23 offen offset:1024 lds
buffer_load_dwordx4 v1, s[4:7], s23 offen offset:2048 lds
buffer_load_dwordx4 v1, s[4:7], s23 offen offset:3072 lds
s_add_u32 m0, s22, 16384
s_add_u32 s23, s21, 16384
buffer_load_dwordx4 v1, s[4:7], s23 offen offset:0 lds
buffer_load_dwordx4 v1, s[4:7], s23 offen offset:1024 lds
buffer_load_dwordx4 v1, s[4:7], s23 offen offset:2048 lds
buffer_load_dwordx4 v1, s[4:7], s23 offen offset:3072 lds
s_waitcnt vmcnt(25)
s_barrier
buffer_load_dwordx4 v[120:123], v1, s[4:7], s30 offen offset:3072
buffer_load_dwordx4 v[124:127], v1, s[4:7], s31 offen offset:3072
buffer_load_dwordx4 v[128:131], v1, s[4:7], s32 offen offset:3072
ds_read_b128 v[136:139], v6 offset:0
ds_read_b128 v[140:143], v6 offset:20480
ds_read_b128 v[144:147], v7 offset:0
ds_read_b128 v[148:151], v7 offset:20480
s_waitcnt vmcnt(25) lgkmcnt(0)
v_mfma_f32_16x16x32_bf16 v[8:11], v[136:139], v[72:75], 0
ds_read_b128 v[152:155], v6 offset:1024
v_mfma_f32_16x16x32_bf16 v[12:15], v[140:143], v[72:75], 0
ds_read_b128 v[156:159], v6 offset:21504
v_mfma_f32_16x16x32_bf16 v[16:19], v[144:147], v[72:75], 0
ds_read_b128 v[160:163], v7 offset:1024
v_mfma_f32_16x16x32_bf16 v[20:23], v[148:151], v[72:75], 0
ds_read_b128 v[164:167], v7 offset:21504
s_add_u32 s30, s30, 4096
buffer_load_dwordx4 v[72:75], v1, s[4:7], s30 offen offset:0
v_mfma_f32_16x16x32_bf16 v[24:27], v[136:139], v[76:79], 0
v_mfma_f32_16x16x32_bf16 v[28:31], v[140:143], v[76:79], 0
v_mfma_f32_16x16x32_bf16 v[32:35], v[144:147], v[76:79], 0
v_mfma_f32_16x16x32_bf16 v[36:39], v[148:151], v[76:79], 0
s_add_u32 s31, s31, 4096
buffer_load_dwordx4 v[76:79], v1, s[4:7], s31 offen offset:0
v_mfma_f32_16x16x32_bf16 v[40:43], v[136:139], v[80:83], 0
v_mfma_f32_16x16x32_bf16 v[44:47], v[140:143], v[80:83], 0
v_mfma_f32_16x16x32_bf16 v[48:51], v[144:147], v[80:83], 0
v_mfma_f32_16x16x32_bf16 v[52:55], v[148:151], v[80:83], 0
s_add_u32 s32, s32, 4096
buffer_load_dwordx4 v[80:83], v1, s[4:7], s32 offen offset:0
s_waitcnt vmcnt(25) lgkmcnt(0)
v_mfma_f32_16x16x32_bf16 v[8:11], v[152:155], v[88:91], v[8:11]
ds_read_b128 v[136:139], v6 offset:2048
v_mfma_f32_16x16x32_bf16 v[12:15], v[156:159], v[88:91], v[12:15]
ds_read_b128 v[140:143], v6 offset:22528
v_mfma_f32_16x16x32_bf16 v[16:19], v[160:163], v[88:91], v[16:19]
ds_read_b128 v[144:147], v7 offset:2048
v_mfma_f32_16x16x32_bf16 v[20:23], v[164:167], v[88:91], v[20:23]
ds_read_b128 v[148:151], v7 offset:22528
buffer_load_dwordx4 v[88:91], v1, s[4:7], s30 offen offset:1024
v_mfma_f32_16x16x32_bf16 v[24:27], v[152:155], v[92:95], v[24:27]
v_mfma_f32_16x16x32_bf16 v[28:31], v[156:159], v[92:95], v[28:31]
v_mfma_f32_16x16x32_bf16 v[32:35], v[160:163], v[92:95], v[32:35]
v_mfma_f32_16x16x32_bf16 v[36:39], v[164:167], v[92:95], v[36:39]
buffer_load_dwordx4 v[92:95], v1, s[4:7], s31 offen offset:1024
v_mfma_f32_16x16x32_bf16 v[40:43], v[152:155], v[96:99], v[40:43]
v_mfma_f32_16x16x32_bf16 v[44:47], v[156:159], v[96:99], v[44:47]
v_mfma_f32_16x16x32_bf16 v[48:51], v[160:163], v[96:99], v[48:51]
v_mfma_f32_16x16x32_bf16 v[52:55], v[164:167], v[96:99], v[52:55]
buffer_load_dwordx4 v[96:99], v1, s[4:7], s32 offen offset:1024
s_waitcnt vmcnt(25) lgkmcnt(0)
v_mfma_f32_16x16x32_bf16 v[8:11], v[136:139], v[104:107], v[8:11]
ds_read_b128 v[152:155], v6 offset:3072
v_mfma_f32_16x16x32_bf16 v[12:15], v[140:143], v[104:107], v[12:15]
ds_read_b128 v[156:159], v6 offset:23552
v_mfma_f32_16x16x32_bf16 v[16:19], v[144:147], v[104:107], v[16:19]
ds_read_b128 v[160:163], v7 offset:3072
v_mfma_f32_16x16x32_bf16 v[20:23], v[148:151], v[104:107], v[20:23]
ds_read_b128 v[164:167], v7 offset:23552
buffer_load_dwordx4 v[104:107], v1, s[4:7], s30 offen offset:2048
v_mfma_f32_16x16x32_bf16 v[24:27], v[136:139], v[108:111], v[24:27]
v_mfma_f32_16x16x32_bf16 v[28:31], v[140:143], v[108:111], v[28:31]
v_mfma_f32_16x16x32_bf16 v[32:35], v[144:147], v[108:111], v[32:35]
v_mfma_f32_16x16x32_bf16 v[36:39], v[148:151], v[108:111], v[36:39]
buffer_load_dwordx4 v[108:111], v1, s[4:7], s31 offen offset:2048
v_mfma_f32_16x16x32_bf16 v[40:43], v[136:139], v[112:115], v[40:43]
v_mfma_f32_16x16x32_bf16 v[44:47], v[140:143], v[112:115], v[44:47]
v_mfma_f32_16x16x32_bf16 v[48:51], v[144:147], v[112:115], v[48:51]
v_mfma_f32_16x16x32_bf16 v[52:55], v[148:151], v[112:115], v[52:55]
buffer_load_dwordx4 v[112:115], v1, s[4:7], s32 offen offset:2048
s_waitcnt vmcnt(9) lgkmcnt(0)
s_barrier
v_mfma_f32_16x16x32_bf16 v[8:11], v[152:155], v[120:123], v[8:11]
ds_read_b128 v[136:139], v6 offset:4096
v_mfma_f32_16x16x32_bf16 v[12:15], v[156:159], v[120:123], v[12:15]
ds_read_b128 v[140:143], v6 offset:24576
v_mfma_f32_16x16x32_bf16 v[16:19], v[160:163], v[120:123], v[16:19]
ds_read_b128 v[144:147], v7 offset:4096
v_mfma_f32_16x16x32_bf16 v[20:23], v[164:167], v[120:123], v[20:23]
ds_read_b128 v[148:151], v7 offset:24576
buffer_load_dwordx4 v[120:123], v1, s[4:7], s30 offen offset:3072
v_mfma_f32_16x16x32_bf16 v[24:27], v[152:155], v[124:127], v[24:27]
v_mfma_f32_16x16x32_bf16 v[28:31], v[156:159], v[124:127], v[28:31]
v_mfma_f32_16x16x32_bf16 v[32:35], v[160:163], v[124:127], v[32:35]
v_mfma_f32_16x16x32_bf16 v[36:39], v[164:167], v[124:127], v[36:39]
buffer_load_dwordx4 v[124:127], v1, s[4:7], s31 offen offset:3072
v_mfma_f32_16x16x32_bf16 v[40:43], v[152:155], v[128:131], v[40:43]
v_mfma_f32_16x16x32_bf16 v[44:47], v[156:159], v[128:131], v[44:47]
v_mfma_f32_16x16x32_bf16 v[48:51], v[160:163], v[128:131], v[48:51]
v_mfma_f32_16x16x32_bf16 v[52:55], v[164:167], v[128:131], v[52:55]
buffer_load_dwordx4 v[128:131], v1, s[4:7], s32 offen offset:3072
s_mov_b32 s40, 0
v_add_u32 v6, 4096, v6
v_add_u32 v7, 4096, v7
qkvb_loop9:
s_waitcnt vmcnt(9) lgkmcnt(0)
v_mfma_f32_16x16x32_bf16 v[8:11], v[136:139], v[72:75], v[8:11]
ds_read_b128 v[152:155], v6 offset:1024
v_mfma_f32_16x16x32_bf16 v[12:15], v[140:143], v[72:75], v[12:15]
ds_read_b128 v[156:159], v6 offset:21504
v_mfma_f32_16x16x32_bf16 v[16:19], v[144:147], v[72:75], v[16:19]
ds_read_b128 v[160:163], v7 offset:1024
v_mfma_f32_16x16x32_bf16 v[20:23], v[148:151], v[72:75], v[20:23]
ds_read_b128 v[164:167], v7 offset:21504
s_add_u32 s30, s30, 4096
buffer_load_dwordx4 v[72:75], v1, s[4:7], s30 offen offset:0
v_mfma_f32_16x16x32_bf16 v[24:27], v[136:139], v[76:79], v[24:27]
v_mfma_f32_16x16x32_bf16 v[28:31], v[140:143], v[76:79], v[28:31]
v_mfma_f32_16x16x32_bf16 v[32:35], v[144:147], v[76:79], v[32:35]
v_mfma_f32_16x16x32_bf16 v[36:39], v[148:151], v[76:79], v[36:39]
s_add_u32 s31, s31, 4096
buffer_load_dwordx4 v[76:79], v1, s[4:7], s31 offen offset:0
v_mfma_f32_16x16x32_bf16 v[40:43], v[136:139], v[80:83], v[40:43]
v_mfma_f32_16x16x32_bf16 v[44:47], v[140:143], v[80:83], v[44:47]
v_mfma_f32_16x16x32_bf16 v[48:51], v[144:147], v[80:83], v[48:51]
v_mfma_f32_16x16x32_bf16 v[52:55], v[148:151], v[80:83], v[52:55]
s_add_u32 s32, s32, 4096
buffer_load_dwordx4 v[80:83], v1, s[4:7], s32 offen offset:0
s_waitcnt vmcnt(9) lgkmcnt(0)
v_mfma_f32_16x16x32_bf16 v[8:11], v[152:155], v[88:91], v[8:11]
ds_read_b128 v[136:139], v6 offset:2048
v_mfma_f32_16x16x32_bf16 v[12:15], v[156:159], v[88:91], v[12:15]
ds_read_b128 v[140:143], v6 offset:22528
v_mfma_f32_16x16x32_bf16 v[16:19], v[160:163], v[88:91], v[16:19]
ds_read_b128 v[144:147], v7 offset:2048
v_mfma_f32_16x16x32_bf16 v[20:23], v[164:167], v[88:91], v[20:23]
ds_read_b128 v[148:151], v7 offset:22528
buffer_load_dwordx4 v[88:91], v1, s[4:7], s30 offen offset:1024
v_mfma_f32_16x16x32_bf16 v[24:27], v[152:155], v[92:95], v[24:27]
v_mfma_f32_16x16x32_bf16 v[28:31], v[156:159], v[92:95], v[28:31]
v_mfma_f32_16x16x32_bf16 v[32:35], v[160:163], v[92:95], v[32:35]
v_mfma_f32_16x16x32_bf16 v[36:39], v[164:167], v[92:95], v[36:39]
buffer_load_dwordx4 v[92:95], v1, s[4:7], s31 offen offset:1024
v_mfma_f32_16x16x32_bf16 v[40:43], v[152:155], v[96:99], v[40:43]
v_mfma_f32_16x16x32_bf16 v[44:47], v[156:159], v[96:99], v[44:47]
v_mfma_f32_16x16x32_bf16 v[48:51], v[160:163], v[96:99], v[48:51]
v_mfma_f32_16x16x32_bf16 v[52:55], v[164:167], v[96:99], v[52:55]
buffer_load_dwordx4 v[96:99], v1, s[4:7], s32 offen offset:1024
s_waitcnt vmcnt(9) lgkmcnt(0)
v_mfma_f32_16x16x32_bf16 v[8:11], v[136:139], v[104:107], v[8:11]
ds_read_b128 v[152:155], v6 offset:3072
v_mfma_f32_16x16x32_bf16 v[12:15], v[140:143], v[104:107], v[12:15]
ds_read_b128 v[156:159], v6 offset:23552
v_mfma_f32_16x16x32_bf16 v[16:19], v[144:147], v[104:107], v[16:19]
ds_read_b128 v[160:163], v7 offset:3072
v_mfma_f32_16x16x32_bf16 v[20:23], v[148:151], v[104:107], v[20:23]
ds_read_b128 v[164:167], v7 offset:23552
buffer_load_dwordx4 v[104:107], v1, s[4:7], s30 offen offset:2048
v_mfma_f32_16x16x32_bf16 v[24:27], v[136:139], v[108:111], v[24:27]
v_mfma_f32_16x16x32_bf16 v[28:31], v[140:143], v[108:111], v[28:31]
v_mfma_f32_16x16x32_bf16 v[32:35], v[144:147], v[108:111], v[32:35]
v_mfma_f32_16x16x32_bf16 v[36:39], v[148:151], v[108:111], v[36:39]
buffer_load_dwordx4 v[108:111], v1, s[4:7], s31 offen offset:2048
v_mfma_f32_16x16x32_bf16 v[40:43], v[136:139], v[112:115], v[40:43]
v_mfma_f32_16x16x32_bf16 v[44:47], v[140:143], v[112:115], v[44:47]
v_mfma_f32_16x16x32_bf16 v[48:51], v[144:147], v[112:115], v[48:51]
v_mfma_f32_16x16x32_bf16 v[52:55], v[148:151], v[112:115], v[52:55]
buffer_load_dwordx4 v[112:115], v1, s[4:7], s32 offen offset:2048
s_waitcnt vmcnt(9) lgkmcnt(0)
v_mfma_f32_16x16x32_bf16 v[8:11], v[152:155], v[120:123], v[8:11]
ds_read_b128 v[136:139], v6 offset:4096
v_mfma_f32_16x16x32_bf16 v[12:15], v[156:159], v[120:123], v[12:15]
ds_read_b128 v[140:143], v6 offset:24576
v_mfma_f32_16x16x32_bf16 v[16:19], v[160:163], v[120:123], v[16:19]
ds_read_b128 v[144:147], v7 offset:4096
v_mfma_f32_16x16x32_bf16 v[20:23], v[164:167], v[120:123], v[20:23]
ds_read_b128 v[148:151], v7 offset:24576
buffer_load_dwordx4 v[120:123], v1, s[4:7], s30 offen offset:3072
v_mfma_f32_16x16x32_bf16 v[24:27], v[152:155], v[124:127], v[24:27]
v_mfma_f32_16x16x32_bf16 v[28:31], v[156:159], v[124:127], v[28:31]
v_mfma_f32_16x16x32_bf16 v[32:35], v[160:163], v[124:127], v[32:35]
v_mfma_f32_16x16x32_bf16 v[36:39], v[164:167], v[124:127], v[36:39]
buffer_load_dwordx4 v[124:127], v1, s[4:7], s31 offen offset:3072
v_mfma_f32_16x16x32_bf16 v[40:43], v[152:155], v[128:131], v[40:43]
v_mfma_f32_16x16x32_bf16 v[44:47], v[156:159], v[128:131], v[44:47]
v_mfma_f32_16x16x32_bf16 v[48:51], v[160:163], v[128:131], v[48:51]
v_mfma_f32_16x16x32_bf16 v[52:55], v[164:167], v[128:131], v[52:55]
buffer_load_dwordx4 v[128:131], v1, s[4:7], s32 offen offset:3072
v_add_u32 v6, 4096, v6
v_add_u32 v7, 4096, v7
s_add_u32 s40, s40, 1
s_cmp_lt_u32 s40, 4
s_cbranch_scc1 qkvb_loop9
s_waitcnt vmcnt(0) lgkmcnt(0)
v_and_b32 v2, 63, v0
v_and_b32 v3, 15, v2
v_lshrrev_b32 v4, 4, v2
s_lshl_b32 s41, s17, 19
s_lshl_b32 s42, s18, 12
s_add_u32 s41, s41, s42
s_mov_b32 s46, 0x3ea52b5c
s_mov_b32 s47, 0x3ea52b5c
v_add_u32 v5, 32, v3
v_mul_u32_u24 v168, 205, v5
v_lshrrev_b32 v168, 12, v168
v_mul_u32_u24 v6, 20, v168
v_sub_u32 v5, v5, v6
v_lshlrev_b32 v168, 17, v168
v_lshl_add_u32 v168, v5, 4, v168
v_and_b32 v6, 1, v4
v_lshl_add_u32 v168, v6, 9, v168
v_lshrrev_b32 v6, 1, v4
v_lshl_add_u32 v168, v6, 3, v168
v_add_u32 v5, 48, v3
v_mul_u32_u24 v169, 205, v5
v_lshrrev_b32 v169, 12, v169
v_mul_u32_u24 v6, 20, v169
v_sub_u32 v5, v5, v6
v_lshlrev_b32 v169, 17, v169
v_lshl_add_u32 v169, v5, 4, v169
v_and_b32 v6, 1, v4
v_lshl_add_u32 v169, v6, 9, v169
v_lshrrev_b32 v6, 1, v4
v_lshl_add_u32 v169, v6, 3, v169
v_add_u32 v5, 64, v3
v_mul_u32_u24 v170, 205, v5
v_lshrrev_b32 v170, 12, v170
v_mul_u32_u24 v6, 20, v170
v_sub_u32 v5, v5, v6
v_lshlrev_b32 v170, 17, v170
v_lshl_add_u32 v170, v5, 4, v170
v_and_b32 v6, 1, v4
v_lshl_add_u32 v170, v6, 9, v170
v_lshrrev_b32 v6, 1, v4
v_lshl_add_u32 v170, v6, 3, v170
v_cvt_pk_bf16_f32 v136, v8, v9
v_cvt_pk_bf16_f32 v137, v10, v11
s_add_u32 s43, s41, 46137344
buffer_store_dwordx2 v[136:137], v168, s[4:7], s43 offen sc1
v_cvt_pk_bf16_f32 v138, v12, v13
v_cvt_pk_bf16_f32 v139, v14, v15
s_add_u32 s43, s41, 46138368
buffer_store_dwordx2 v[138:139], v168, s[4:7], s43 offen sc1
v_cvt_pk_bf16_f32 v140, v16, v17
v_cvt_pk_bf16_f32 v141, v18, v19
s_add_u32 s43, s41, 46139392
buffer_store_dwordx2 v[140:141], v168, s[4:7], s43 offen sc1
v_cvt_pk_bf16_f32 v142, v20, v21
v_cvt_pk_bf16_f32 v143, v22, v23
s_add_u32 s43, s41, 46140416
buffer_store_dwordx2 v[142:143], v168, s[4:7], s43 offen sc1
v_cvt_pk_bf16_f32 v144, v24, v25
v_cvt_pk_bf16_f32 v145, v26, v27
s_add_u32 s43, s41, 46137344
buffer_store_dwordx2 v[144:145], v169, s[4:7], s43 offen sc1
v_cvt_pk_bf16_f32 v146, v28, v29
v_cvt_pk_bf16_f32 v147, v30, v31
s_add_u32 s43, s41, 46138368
buffer_store_dwordx2 v[146:147], v169, s[4:7], s43 offen sc1
v_cvt_pk_bf16_f32 v148, v32, v33
v_cvt_pk_bf16_f32 v149, v34, v35
s_add_u32 s43, s41, 46139392
buffer_store_dwordx2 v[148:149], v169, s[4:7], s43 offen sc1
v_cvt_pk_bf16_f32 v150, v36, v37
v_cvt_pk_bf16_f32 v151, v38, v39
s_add_u32 s43, s41, 46140416
buffer_store_dwordx2 v[150:151], v169, s[4:7], s43 offen sc1
v_cvt_pk_bf16_f32 v136, v40, v41
v_cvt_pk_bf16_f32 v137, v42, v43
s_add_u32 s43, s41, 46137344
buffer_store_dwordx2 v[136:137], v170, s[4:7], s43 offen sc1
v_cvt_pk_bf16_f32 v138, v44, v45
v_cvt_pk_bf16_f32 v139, v46, v47
s_add_u32 s43, s41, 46138368
buffer_store_dwordx2 v[138:139], v170, s[4:7], s43 offen sc1
v_cvt_pk_bf16_f32 v140, v48, v49
v_cvt_pk_bf16_f32 v141, v50, v51
s_add_u32 s43, s41, 46139392
buffer_store_dwordx2 v[140:141], v170, s[4:7], s43 offen sc1
v_cvt_pk_bf16_f32 v142, v52, v53
v_cvt_pk_bf16_f32 v143, v54, v55
s_add_u32 s43, s41, 46140416
buffer_store_dwordx2 v[142:143], v170, s[4:7], s43 offen sc1
v_mov_b32 v72, 0
v_mov_b32 v73, 0
v_mov_b32 v74, 0
v_mov_b32 v75, 0
v_lshlrev_b32 v5, 17, v4
v_lshl_add_u32 v5, v3, 4, v5
v_add_u32 v6, 1032, v5
v_add_u32 v7, 1536, v5
s_add_u32 s43, s41, 37748736
buffer_store_dwordx2 v[72:73], v6, s[4:7], s43 offen sc1
buffer_store_dwordx4 v[72:75], v7, s[4:7], s43 offen sc1
s_add_u32 s43, s41, 37748992
buffer_store_dwordx2 v[72:73], v6, s[4:7], s43 offen sc1
buffer_store_dwordx4 v[72:75], v7, s[4:7], s43 offen sc1
s_add_u32 s43, s41, 37750784
buffer_store_dwordx2 v[72:73], v6, s[4:7], s43 offen sc1
buffer_store_dwordx4 v[72:75], v7, s[4:7], s43 offen sc1
s_add_u32 s43, s41, 37751040
buffer_store_dwordx2 v[72:73], v6, s[4:7], s43 offen sc1
buffer_store_dwordx4 v[72:75], v7, s[4:7], s43 offen sc1
s_add_u32 s43, s41, 41943040
buffer_store_dwordx2 v[72:73], v6, s[4:7], s43 offen sc1
buffer_store_dwordx4 v[72:75], v7, s[4:7], s43 offen sc1
s_add_u32 s43, s41, 41943296
buffer_store_dwordx2 v[72:73], v6, s[4:7], s43 offen sc1
buffer_store_dwordx4 v[72:75], v7, s[4:7], s43 offen sc1
s_add_u32 s43, s41, 41945088
buffer_store_dwordx2 v[72:73], v6, s[4:7], s43 offen sc1
buffer_store_dwordx4 v[72:75], v7, s[4:7], s43 offen sc1
s_add_u32 s43, s41, 41945344
buffer_store_dwordx2 v[72:73], v6, s[4:7], s43 offen sc1
buffer_store_dwordx4 v[72:75], v7, s[4:7], s43 offen sc1
v_and_b32 v6, 1, v4
v_lshlrev_b32 v6, 9, v6
v_add_u32 v5, 20, v3
v_lshl_add_u32 v6, v5, 4, v6
v_lshrrev_b32 v5, 1, v4
v_lshl_add_u32 v6, v5, 17, v6
v_mov_b32 v5, 0x80000000
v_cmp_gt_u32 vcc, 12, v3
s_nop 1
v_cndmask_b32 v6, v5, v6, vcc
v_cmp_eq_u32 vcc, 0, v3
v_mov_b32 v5, 0x3f803f80
s_nop 0
v_cndmask_b32 v76, 0, v5, vcc
v_mov_b32 v77, v76
v_mov_b32 v78, v76
v_mov_b32 v79, v76
s_add_u32 s43, s41, 46137344
buffer_store_dwordx4 v[76:79], v6, s[4:7], s43 offen sc1
s_add_u32 s43, s41, 46138368
buffer_store_dwordx4 v[76:79], v6, s[4:7], s43 offen sc1
s_add_u32 s43, s41, 46139392
buffer_store_dwordx4 v[76:79], v6, s[4:7], s43 offen sc1
s_add_u32 s43, s41, 46140416
buffer_store_dwordx4 v[76:79], v6, s[4:7], s43 offen sc1
s_add_u32 s43, s41, 46399488
buffer_store_dwordx4 v[76:79], v6, s[4:7], s43 offen sc1
s_add_u32 s43, s41, 46400512
buffer_store_dwordx4 v[76:79], v6, s[4:7], s43 offen sc1
s_add_u32 s43, s41, 46401536
buffer_store_dwordx4 v[76:79], v6, s[4:7], s43 offen sc1
s_add_u32 s43, s41, 46402560
buffer_store_dwordx4 v[76:79], v6, s[4:7], s43 offen sc1
s_branch qkvb_exit1
qkvb_exit1:
s_endpgm
.globl attnb_kernel
.p2align 8
.type attnb_kernel,@function
attnb_kernel:
s_cmp_ge_u32 s2, 256
s_cbranch_scc1 attnb_exit1
s_load_dwordx2 s[12:13], s[0:1], 96
v_lshrrev_b32 v2, 6, v0
v_and_b32 v3, 63, v0
s_nop 0
v_readfirstlane_b32 s16, v2
v_lshlrev_b32 v1, 4, v3
s_and_b32 s17, s2, 7
s_lshl_b32 s17, s17, 2
s_lshr_b32 s18, s2, 3
s_and_b32 s19, s18, 3
s_add_u32 s17, s17, s19
s_lshr_b32 s18, s18, 2
s_waitcnt lgkmcnt(0)
s_mov_b32 s4, s12
s_mov_b32 s5, s13
s_mov_b32 s6, 0x10000000
s_mov_b32 s7, 0x20000
s_lshl_b32 s20, s17, 17
s_add_u32 s21, s20, 41943040
s_add_u32 s22, s20, 46137344
s_lshl_b32 s23, s18, 3
s_lshl_b32 s24, s16, 1
s_add_u32 s23, s23, s24
s_lshl_b32 s24, s23, 11
s_add_u32 s24, s24, s20
s_add_u32 s24, s24, 37748736
buffer_load_dwordx4 v[8:11], v1, s[4:7], s24 offen offset:0
buffer_load_dwordx4 v[12:15], v1, s[4:7], s24 offen offset:1024
buffer_load_dwordx4 v[16:19], v1, s[4:7], s24 offen offset:2048
buffer_load_dwordx4 v[20:23], v1, s[4:7], s24 offen offset:3072
s_mov_b32 s25, s21
s_mov_b32 s26, s22
buffer_load_dwordx4 v[136:139], v1, s[4:7], s25 offen
buffer_load_dwordx4 v[140:143], v1, s[4:7], s25 offen offset:1024
buffer_load_dwordx4 v[144:147], v1, s[4:7], s26 offen
buffer_load_dwordx4 v[148:151], v1, s[4:7], s26 offen offset:1024
s_add_u32 s25, s25, 2048
s_add_u32 s26, s26, 2048
s_waitcnt vmcnt(0)
v_mfma_f32_32x32x16_bf16 v[88:103], v[136:139], v[8:11], 0
v_mfma_f32_32x32x16_bf16 v[88:103], v[140:143], v[12:15], v[88:103]
v_mfma_f32_32x32x16_bf16 v[104:119], v[136:139], v[16:19], 0
v_mfma_f32_32x32x16_bf16 v[104:119], v[140:143], v[20:23], v[104:119]
s_nop 9
v_max3_f32 v2, v88, v89, v90
v_max3_f32 v2, v2, v91, v92
v_max3_f32 v2, v2, v93, v94
v_max3_f32 v2, v2, v95, v96
v_max3_f32 v2, v2, v97, v98
v_max3_f32 v2, v2, v99, v100
v_max3_f32 v2, v2, v101, v102
v_max_f32 v2, v2, v103
v_mov_b32 v4, v2
s_nop 1
v_permlane32_swap_b32 v2, v4
v_max_f32 v2, v2, v4
v_sub_f32 v24, 0, v2
v_sub_f32 v25, 0, v2
v_sub_f32 v26, 0, v2
v_sub_f32 v27, 0, v2
v_sub_f32 v28, 0, v2
v_sub_f32 v29, 0, v2
v_sub_f32 v30, 0, v2
v_sub_f32 v31, 0, v2
v_sub_f32 v32, 0, v2
v_sub_f32 v33, 0, v2
v_sub_f32 v34, 0, v2
v_sub_f32 v35, 0, v2
v_sub_f32 v36, 0, v2
v_sub_f32 v37, 0, v2
v_sub_f32 v38, 0, v2
v_sub_f32 v39, 0, v2
v_max3_f32 v3, v104, v105, v106
v_max3_f32 v3, v3, v107, v108
v_max3_f32 v3, v3, v109, v110
v_max3_f32 v3, v3, v111, v112
v_max3_f32 v3, v3, v113, v114
v_max3_f32 v3, v3, v115, v116
v_max3_f32 v3, v3, v117, v118
v_max_f32 v3, v3, v119
v_mov_b32 v4, v3
s_nop 1
v_permlane32_swap_b32 v3, v4
v_max_f32 v3, v3, v4
v_sub_f32 v40, 0, v3
v_sub_f32 v41, 0, v3
v_sub_f32 v42, 0, v3
v_sub_f32 v43, 0, v3
v_sub_f32 v44, 0, v3
v_sub_f32 v45, 0, v3
v_sub_f32 v46, 0, v3
v_sub_f32 v47, 0, v3
v_sub_f32 v48, 0, v3
v_sub_f32 v49, 0, v3
v_sub_f32 v50, 0, v3
v_sub_f32 v51, 0, v3
v_sub_f32 v52, 0, v3
v_sub_f32 v53, 0, v3
v_sub_f32 v54, 0, v3
v_sub_f32 v55, 0, v3
s_mov_b32 s28, 0
attnb_main2:
s_mov_b32 s25, s21
s_mov_b32 s26, s22
buffer_load_dwordx4 v[136:139], v1, s[4:7], s25 offen
buffer_load_dwordx4 v[140:143], v1, s[4:7], s25 offen offset:1024
buffer_load_dwordx4 v[144:147], v1, s[4:7], s26 offen
buffer_load_dwordx4 v[148:151], v1, s[4:7], s26 offen offset:1024
s_add_u32 s25, s25, 2048
s_add_u32 s26, s26, 2048
buffer_load_dwordx4 v[152:155], v1, s[4:7], s25 offen
buffer_load_dwordx4 v[156:159], v1, s[4:7], s25 offen offset:1024
buffer_load_dwordx4 v[160:163], v1, s[4:7], s26 offen
buffer_load_dwordx4 v[164:167], v1, s[4:7], s26 offen offset:1024
s_add_u32 s25, s25, 2048
s_add_u32 s26, s26, 2048
v_mov_b32 v56, 0
v_mov_b32 v57, 0
v_mov_b32 v58, 0
v_mov_b32 v59, 0
v_mov_b32 v60, 0
v_mov_b32 v61, 0
v_mov_b32 v62, 0
v_mov_b32 v63, 0
v_mov_b32 v64, 0
v_mov_b32 v65, 0
v_mov_b32 v66, 0
v_mov_b32 v67, 0
v_mov_b32 v68, 0
v_mov_b32 v69, 0
v_mov_b32 v70, 0
v_mov_b32 v71, 0
v_mov_b32 v72, 0
v_mov_b32 v73, 0
v_mov_b32 v74, 0
v_mov_b32 v75, 0
v_mov_b32 v76, 0
v_mov_b32 v77, 0
v_mov_b32 v78, 0
v_mov_b32 v79, 0
v_mov_b32 v80, 0
v_mov_b32 v81, 0
v_mov_b32 v82, 0
v_mov_b32 v83, 0
v_mov_b32 v84, 0
v_mov_b32 v85, 0
v_mov_b32 v86, 0
v_mov_b32 v87, 0
s_waitcnt vmcnt(4)
v_mfma_f32_32x32x16_bf16 v[88:103], v[136:139], v[8:11], v[24:39]
v_mfma_f32_32x32x8_bf16 v[88:103], v[140:141], v[12:13], v[88:103]
s_waitcnt vmcnt(4)
s_nop 10
v_exp_f32 v88, v88
v_exp_f32 v89, v89
v_exp_f32 v90, v90
v_exp_f32 v91, v91
v_exp_f32 v92, v92
v_exp_f32 v93, v93
buffer_load_dwordx4 v[168:171], v1, s[4:7], s25 offen
v_exp_f32 v94, v94
v_exp_f32 v95, v95
v_mfma_f32_32x32x16_bf16 v[104:119], v[136:139], v[16:19], v[40:55]
v_cvt_pk_bf16_f32 v120, v88, v89
v_cvt_pk_bf16_f32 v121, v90, v91
v_cvt_pk_bf16_f32 v122, v92, v93
v_cvt_pk_bf16_f32 v123, v94, v95
v_exp_f32 v96, v96
v_exp_f32 v97, v97
v_mfma_f32_32x32x8_bf16 v[104:119], v[140:141], v[20:21], v[104:119]
v_exp_f32 v98, v98
v_exp_f32 v99, v99
buffer_load_dwordx2 v[172:173], v1, s[4:7], s25 offen offset:1024
s_add_u32 s25, s25, 2048
v_exp_f32 v100, v100
v_exp_f32 v101, v101
v_mfma_f32_32x32x16_bf16 v[56:71], v[144:147], v[120:123], v[56:71]
v_exp_f32 v102, v102
v_exp_f32 v103, v103
v_cvt_pk_bf16_f32 v124, v96, v97
v_cvt_pk_bf16_f32 v125, v98, v99
v_cvt_pk_bf16_f32 v126, v100, v101
v_cvt_pk_bf16_f32 v127, v102, v103
s_waitcnt vmcnt(4)
v_exp_f32 v104, v104
v_exp_f32 v105, v105
v_exp_f32 v106, v106
v_exp_f32 v107, v107
v_mfma_f32_32x32x16_bf16 v[56:71], v[148:151], v[124:127], v[56:71]
v_exp_f32 v108, v108
v_exp_f32 v109, v109
buffer_load_dwordx4 v[176:179], v1, s[4:7], s26 offen
v_exp_f32 v110, v110
v_exp_f32 v111, v111
v_mfma_f32_32x32x16_bf16 v[88:103], v[152:155], v[8:11], v[24:39]
v_cvt_pk_bf16_f32 v128, v104, v105
v_cvt_pk_bf16_f32 v129, v106, v107
v_cvt_pk_bf16_f32 v130, v108, v109
v_cvt_pk_bf16_f32 v131, v110, v111
v_exp_f32 v112, v112
v_exp_f32 v113, v113
v_mfma_f32_32x32x8_bf16 v[88:103], v[156:157], v[12:13], v[88:103]
v_exp_f32 v114, v114
v_exp_f32 v115, v115
buffer_load_dwordx4 v[180:183], v1, s[4:7], s26 offen offset:1024
s_add_u32 s26, s26, 2048
v_exp_f32 v116, v116
v_exp_f32 v117, v117
v_mfma_f32_32x32x16_bf16 v[72:87], v[144:147], v[128:131], v[72:87]
v_exp_f32 v118, v118
v_exp_f32 v119, v119
v_cvt_pk_bf16_f32 v132, v112, v113
v_cvt_pk_bf16_f32 v133, v114, v115
v_cvt_pk_bf16_f32 v134, v116, v117
v_cvt_pk_bf16_f32 v135, v118, v119
s_mov_b32 s27, 0
attnb_loop3:
s_waitcnt vmcnt(4)
v_exp_f32 v88, v88
v_exp_f32 v89, v89
v_exp_f32 v90, v90
v_exp_f32 v91, v91
v_mfma_f32_32x32x16_bf16 v[72:87], v[148:151], v[132:135], v[72:87]
v_exp_f32 v92, v92
v_exp_f32 v93, v93
buffer_load_dwordx4 v[136:139], v1, s[4:7], s25 offen
v_exp_f32 v94, v94
v_exp_f32 v95, v95
v_mfma_f32_32x32x16_bf16 v[104:119], v[152:155], v[16:19], v[40:55]
v_cvt_pk_bf16_f32 v120, v88, v89
v_cvt_pk_bf16_f32 v121, v90, v91
v_cvt_pk_bf16_f32 v122, v92, v93
v_cvt_pk_bf16_f32 v123, v94, v95
v_exp_f32 v96, v96
v_exp_f32 v97, v97
v_mfma_f32_32x32x8_bf16 v[104:119], v[156:157], v[20:21], v[104:119]
v_exp_f32 v98, v98
v_exp_f32 v99, v99
buffer_load_dwordx2 v[140:141], v1, s[4:7], s25 offen offset:1024
s_add_u32 s25, s25, 2048
v_exp_f32 v100, v100
v_exp_f32 v101, v101
v_mfma_f32_32x32x16_bf16 v[56:71], v[160:163], v[120:123], v[56:71]
v_exp_f32 v102, v102
v_exp_f32 v103, v103
v_cvt_pk_bf16_f32 v124, v96, v97
v_cvt_pk_bf16_f32 v125, v98, v99
v_cvt_pk_bf16_f32 v126, v100, v101
v_cvt_pk_bf16_f32 v127, v102, v103
s_waitcnt vmcnt(4)
v_exp_f32 v104, v104
v_exp_f32 v105, v105
v_exp_f32 v106, v106
v_exp_f32 v107, v107
v_mfma_f32_32x32x16_bf16 v[56:71], v[164:167], v[124:127], v[56:71]
v_exp_f32 v108, v108
v_exp_f32 v109, v109
buffer_load_dwordx4 v[144:147], v1, s[4:7], s26 offen
v_exp_f32 v110, v110
v_exp_f32 v111, v111
v_mfma_f32_32x32x16_bf16 v[88:103], v[168:171], v[8:11], v[24:39]
v_cvt_pk_bf16_f32 v128, v104, v105
v_cvt_pk_bf16_f32 v129, v106, v107
v_cvt_pk_bf16_f32 v130, v108, v109
v_cvt_pk_bf16_f32 v131, v110, v111
v_exp_f32 v112, v112
v_exp_f32 v113, v113
v_mfma_f32_32x32x8_bf16 v[88:103], v[172:173], v[12:13], v[88:103]
v_exp_f32 v114, v114
v_exp_f32 v115, v115
buffer_load_dwordx4 v[148:151], v1, s[4:7], s26 offen offset:1024
s_add_u32 s26, s26, 2048
v_exp_f32 v116, v116
v_exp_f32 v117, v117
v_mfma_f32_32x32x16_bf16 v[72:87], v[160:163], v[128:131], v[72:87]
v_exp_f32 v118, v118
v_exp_f32 v119, v119
v_cvt_pk_bf16_f32 v132, v112, v113
v_cvt_pk_bf16_f32 v133, v114, v115
v_cvt_pk_bf16_f32 v134, v116, v117
v_cvt_pk_bf16_f32 v135, v118, v119
s_waitcnt vmcnt(4)
v_exp_f32 v88, v88
v_exp_f32 v89, v89
v_exp_f32 v90, v90
v_exp_f32 v91, v91
v_mfma_f32_32x32x16_bf16 v[72:87], v[164:167], v[132:135], v[72:87]
v_exp_f32 v92, v92
v_exp_f32 v93, v93
buffer_load_dwordx4 v[152:155], v1, s[4:7], s25 offen
v_exp_f32 v94, v94
v_exp_f32 v95, v95
v_mfma_f32_32x32x16_bf16 v[104:119], v[168:171], v[16:19], v[40:55]
v_cvt_pk_bf16_f32 v120, v88, v89
v_cvt_pk_bf16_f32 v121, v90, v91
v_cvt_pk_bf16_f32 v122, v92, v93
v_cvt_pk_bf16_f32 v123, v94, v95
v_exp_f32 v96, v96
v_exp_f32 v97, v97
v_mfma_f32_32x32x8_bf16 v[104:119], v[172:173], v[20:21], v[104:119]
v_exp_f32 v98, v98
v_exp_f32 v99, v99
buffer_load_dwordx2 v[156:157], v1, s[4:7], s25 offen offset:1024
s_add_u32 s25, s25, 2048
v_exp_f32 v100, v100
v_exp_f32 v101, v101
v_mfma_f32_32x32x16_bf16 v[56:71], v[176:179], v[120:123], v[56:71]
v_exp_f32 v102, v102
v_exp_f32 v103, v103
v_cvt_pk_bf16_f32 v124, v96, v97
v_cvt_pk_bf16_f32 v125, v98, v99
v_cvt_pk_bf16_f32 v126, v100, v101
v_cvt_pk_bf16_f32 v127, v102, v103
s_waitcnt vmcnt(4)
v_exp_f32 v104, v104
v_exp_f32 v105, v105
v_exp_f32 v106, v106
v_exp_f32 v107, v107
v_mfma_f32_32x32x16_bf16 v[56:71], v[180:183], v[124:127], v[56:71]
v_exp_f32 v108, v108
v_exp_f32 v109, v109
buffer_load_dwordx4 v[160:163], v1, s[4:7], s26 offen
v_exp_f32 v110, v110
v_exp_f32 v111, v111
v_mfma_f32_32x32x16_bf16 v[88:103], v[136:139], v[8:11], v[24:39]
v_cvt_pk_bf16_f32 v128, v104, v105
v_cvt_pk_bf16_f32 v129, v106, v107
v_cvt_pk_bf16_f32 v130, v108, v109
v_cvt_pk_bf16_f32 v131, v110, v111
v_exp_f32 v112, v112
v_exp_f32 v113, v113
v_mfma_f32_32x32x8_bf16 v[88:103], v[140:141], v[12:13], v[88:103]
v_exp_f32 v114, v114
v_exp_f32 v115, v115
buffer_load_dwordx4 v[164:167], v1, s[4:7], s26 offen offset:1024
s_add_u32 s26, s26, 2048
v_exp_f32 v116, v116
v_exp_f32 v117, v117
v_mfma_f32_32x32x16_bf16 v[72:87], v[176:179], v[128:131], v[72:87]
v_exp_f32 v118, v118
v_exp_f32 v119, v119
v_cvt_pk_bf16_f32 v132, v112, v113
v_cvt_pk_bf16_f32 v133, v114, v115
v_cvt_pk_bf16_f32 v134, v116, v117
v_cvt_pk_bf16_f32 v135, v118, v119
s_waitcnt vmcnt(4)
v_exp_f32 v88, v88
v_exp_f32 v89, v89
v_exp_f32 v90, v90
v_exp_f32 v91, v91
v_mfma_f32_32x32x16_bf16 v[72:87], v[180:183], v[132:135], v[72:87]
v_exp_f32 v92, v92
v_exp_f32 v93, v93
buffer_load_dwordx4 v[168:171], v1, s[4:7], s25 offen
v_exp_f32 v94, v94
v_exp_f32 v95, v95
v_mfma_f32_32x32x16_bf16 v[104:119], v[136:139], v[16:19], v[40:55]
v_cvt_pk_bf16_f32 v120, v88, v89
v_cvt_pk_bf16_f32 v121, v90, v91
v_cvt_pk_bf16_f32 v122, v92, v93
v_cvt_pk_bf16_f32 v123, v94, v95
v_exp_f32 v96, v96
v_exp_f32 v97, v97
v_mfma_f32_32x32x8_bf16 v[104:119], v[140:141], v[20:21], v[104:119]
v_exp_f32 v98, v98
v_exp_f32 v99, v99
buffer_load_dwordx2 v[172:173], v1, s[4:7], s25 offen offset:1024
s_add_u32 s25, s25, 2048
v_exp_f32 v100, v100
v_exp_f32 v101, v101
v_mfma_f32_32x32x16_bf16 v[56:71], v[144:147], v[120:123], v[56:71]
v_exp_f32 v102, v102
v_exp_f32 v103, v103
v_cvt_pk_bf16_f32 v124, v96, v97
v_cvt_pk_bf16_f32 v125, v98, v99
v_cvt_pk_bf16_f32 v126, v100, v101
v_cvt_pk_bf16_f32 v127, v102, v103
s_waitcnt vmcnt(4)
v_exp_f32 v104, v104
v_exp_f32 v105, v105
v_exp_f32 v106, v106
v_exp_f32 v107, v107
v_mfma_f32_32x32x16_bf16 v[56:71], v[148:151], v[124:127], v[56:71]
v_exp_f32 v108, v108
v_exp_f32 v109, v109
buffer_load_dwordx4 v[176:179], v1, s[4:7], s26 offen
v_exp_f32 v110, v110
v_exp_f32 v111, v111
v_mfma_f32_32x32x16_bf16 v[88:103], v[152:155], v[8:11], v[24:39]
v_cvt_pk_bf16_f32 v128, v104, v105
v_cvt_pk_bf16_f32 v129, v106, v107
v_cvt_pk_bf16_f32 v130, v108, v109
v_cvt_pk_bf16_f32 v131, v110, v111
v_exp_f32 v112, v112
v_exp_f32 v113, v113
v_mfma_f32_32x32x8_bf16 v[88:103], v[156:157], v[12:13], v[88:103]
v_exp_f32 v114, v114
v_exp_f32 v115, v115
buffer_load_dwordx4 v[180:183], v1, s[4:7], s26 offen offset:1024
s_add_u32 s26, s26, 2048
v_exp_f32 v116, v116
v_exp_f32 v117, v117
v_mfma_f32_32x32x16_bf16 v[72:87], v[144:147], v[128:131], v[72:87]
v_exp_f32 v118, v118
v_exp_f32 v119, v119
v_cvt_pk_bf16_f32 v132, v112, v113
v_cvt_pk_bf16_f32 v133, v114, v115
v_cvt_pk_bf16_f32 v134, v116, v117
v_cvt_pk_bf16_f32 v135, v118, v119
s_add_u32 s27, s27, 1
s_cmp_lt_u32 s27, 20
s_cbranch_scc1 attnb_loop3
s_waitcnt vmcnt(4)
v_exp_f32 v88, v88
v_exp_f32 v89, v89
v_exp_f32 v90, v90
v_exp_f32 v91, v91
v_mfma_f32_32x32x16_bf16 v[72:87], v[148:151], v[132:135], v[72:87]
v_exp_f32 v92, v92
v_exp_f32 v93, v93
buffer_load_dwordx4 v[136:139], v1, s[4:7], s25 offen
v_exp_f32 v94, v94
v_exp_f32 v95, v95
v_mfma_f32_32x32x16_bf16 v[104:119], v[152:155], v[16:19], v[40:55]
v_cvt_pk_bf16_f32 v120, v88, v89
v_cvt_pk_bf16_f32 v121, v90, v91
v_cvt_pk_bf16_f32 v122, v92, v93
v_cvt_pk_bf16_f32 v123, v94, v95
v_exp_f32 v96, v96
v_exp_f32 v97, v97
v_mfma_f32_32x32x8_bf16 v[104:119], v[156:157], v[20:21], v[104:119]
v_exp_f32 v98, v98
v_exp_f32 v99, v99
buffer_load_dwordx2 v[140:141], v1, s[4:7], s25 offen offset:1024
s_add_u32 s25, s25, 2048
v_exp_f32 v100, v100
v_exp_f32 v101, v101
v_mfma_f32_32x32x16_bf16 v[56:71], v[160:163], v[120:123], v[56:71]
v_exp_f32 v102, v102
v_exp_f32 v103, v103
v_cvt_pk_bf16_f32 v124, v96, v97
v_cvt_pk_bf16_f32 v125, v98, v99
v_cvt_pk_bf16_f32 v126, v100, v101
v_cvt_pk_bf16_f32 v127, v102, v103
s_waitcnt vmcnt(4)
v_exp_f32 v104, v104
v_exp_f32 v105, v105
v_exp_f32 v106, v106
v_exp_f32 v107, v107
v_mfma_f32_32x32x16_bf16 v[56:71], v[164:167], v[124:127], v[56:71]
v_exp_f32 v108, v108
v_exp_f32 v109, v109
buffer_load_dwordx4 v[144:147], v1, s[4:7], s26 offen
v_exp_f32 v110, v110
v_exp_f32 v111, v111
v_mfma_f32_32x32x16_bf16 v[88:103], v[168:171], v[8:11], v[24:39]
v_cvt_pk_bf16_f32 v128, v104, v105
v_cvt_pk_bf16_f32 v129, v106, v107
v_cvt_pk_bf16_f32 v130, v108, v109
v_cvt_pk_bf16_f32 v131, v110, v111
v_exp_f32 v112, v112
v_exp_f32 v113, v113
v_mfma_f32_32x32x8_bf16 v[88:103], v[172:173], v[12:13], v[88:103]
v_exp_f32 v114, v114
v_exp_f32 v115, v115
buffer_load_dwordx4 v[148:151], v1, s[4:7], s26 offen offset:1024
s_add_u32 s26, s26, 2048
v_exp_f32 v116, v116
v_exp_f32 v117, v117
v_mfma_f32_32x32x16_bf16 v[72:87], v[160:163], v[128:131], v[72:87]
v_exp_f32 v118, v118
v_exp_f32 v119, v119
v_cvt_pk_bf16_f32 v132, v112, v113
v_cvt_pk_bf16_f32 v133, v114, v115
v_cvt_pk_bf16_f32 v134, v116, v117
v_cvt_pk_bf16_f32 v135, v118, v119
s_waitcnt vmcnt(4)
v_exp_f32 v88, v88
v_exp_f32 v89, v89
v_exp_f32 v90, v90
v_exp_f32 v91, v91
v_mfma_f32_32x32x16_bf16 v[72:87], v[164:167], v[132:135], v[72:87]
v_exp_f32 v92, v92
v_exp_f32 v93, v93
v_exp_f32 v94, v94
v_exp_f32 v95, v95
v_mfma_f32_32x32x16_bf16 v[104:119], v[168:171], v[16:19], v[40:55]
v_cvt_pk_bf16_f32 v120, v88, v89
v_cvt_pk_bf16_f32 v121, v90, v91
v_cvt_pk_bf16_f32 v122, v92, v93
v_cvt_pk_bf16_f32 v123, v94, v95
v_exp_f32 v96, v96
v_exp_f32 v97, v97
v_mfma_f32_32x32x8_bf16 v[104:119], v[172:173], v[20:21], v[104:119]
v_exp_f32 v98, v98
v_exp_f32 v99, v99
v_exp_f32 v100, v100
v_exp_f32 v101, v101
v_mfma_f32_32x32x16_bf16 v[56:71], v[176:179], v[120:123], v[56:71]
v_exp_f32 v102, v102
v_exp_f32 v103, v103
v_cvt_pk_bf16_f32 v124, v96, v97
v_cvt_pk_bf16_f32 v125, v98, v99
v_cvt_pk_bf16_f32 v126, v100, v101
v_cvt_pk_bf16_f32 v127, v102, v103
s_waitcnt vmcnt(2)
v_exp_f32 v104, v104
v_exp_f32 v105, v105
v_exp_f32 v106, v106
v_exp_f32 v107, v107
v_mfma_f32_32x32x16_bf16 v[56:71], v[180:183], v[124:127], v[56:71]
v_exp_f32 v108, v108
v_exp_f32 v109, v109
v_exp_f32 v110, v110
v_exp_f32 v111, v111
v_mfma_f32_32x32x16_bf16 v[88:103], v[136:139], v[8:11], v[24:39]
v_cvt_pk_bf16_f32 v128, v104, v105
v_cvt_pk_bf16_f32 v129, v106, v107
v_cvt_pk_bf16_f32 v130, v108, v109
v_cvt_pk_bf16_f32 v131, v110, v111
v_exp_f32 v112, v112
v_exp_f32 v113, v113
v_mfma_f32_32x32x8_bf16 v[88:103], v[140:141], v[12:13], v[88:103]
v_exp_f32 v114, v114
v_exp_f32 v115, v115
v_exp_f32 v116, v116
v_exp_f32 v117, v117
v_mfma_f32_32x32x16_bf16 v[72:87], v[176:179], v[128:131], v[72:87]
v_exp_f32 v118, v118
v_exp_f32 v119, v119
v_cvt_pk_bf16_f32 v132, v112, v113
v_cvt_pk_bf16_f32 v133, v114, v115
v_cvt_pk_bf16_f32 v134, v116, v117
v_cvt_pk_bf16_f32 v135, v118, v119
s_waitcnt vmcnt(0)
v_exp_f32 v88, v88
v_exp_f32 v89, v89
v_exp_f32 v90, v90
v_exp_f32 v91, v91
v_mfma_f32_32x32x16_bf16 v[72:87], v[180:183], v[132:135], v[72:87]
v_exp_f32 v92, v92
v_exp_f32 v93, v93
v_exp_f32 v94, v94
v_exp_f32 v95, v95
v_mfma_f32_32x32x16_bf16 v[104:119], v[136:139], v[16:19], v[40:55]
v_cvt_pk_bf16_f32 v120, v88, v89
v_cvt_pk_bf16_f32 v121, v90, v91
v_cvt_pk_bf16_f32 v122, v92, v93
v_cvt_pk_bf16_f32 v123, v94, v95
v_exp_f32 v96, v96
v_exp_f32 v97, v97
v_mfma_f32_32x32x8_bf16 v[104:119], v[140:141], v[20:21], v[104:119]
v_exp_f32 v98, v98
v_exp_f32 v99, v99
v_exp_f32 v100, v100
v_exp_f32 v101, v101
v_mfma_f32_32x32x16_bf16 v[56:71], v[144:147], v[120:123], v[56:71]
v_exp_f32 v102, v102
v_exp_f32 v103, v103
v_cvt_pk_bf16_f32 v124, v96, v97
v_cvt_pk_bf16_f32 v125, v98, v99
v_cvt_pk_bf16_f32 v126, v100, v101
v_cvt_pk_bf16_f32 v127, v102, v103
s_nop 0
v_exp_f32 v104, v104
v_exp_f32 v105, v105
v_exp_f32 v106, v106
v_exp_f32 v107, v107
v_mfma_f32_32x32x16_bf16 v[56:71], v[148:151], v[124:127], v[56:71]
v_exp_f32 v108, v108
v_exp_f32 v109, v109
v_exp_f32 v110, v110
v_exp_f32 v111, v111
v_cvt_pk_bf16_f32 v128, v104, v105
v_cvt_pk_bf16_f32 v129, v106, v107
v_cvt_pk_bf16_f32 v130, v108, v109
v_cvt_pk_bf16_f32 v131, v110, v111
v_exp_f32 v112, v112
v_exp_f32 v113, v113
v_exp_f32 v114, v114
v_exp_f32 v115, v115
v_exp_f32 v116, v116
v_exp_f32 v117, v117
v_mfma_f32_32x32x16_bf16 v[72:87], v[144:147], v[128:131], v[72:87]
v_exp_f32 v118, v118
v_exp_f32 v119, v119
v_cvt_pk_bf16_f32 v132, v112, v113
v_cvt_pk_bf16_f32 v133, v114, v115
v_cvt_pk_bf16_f32 v134, v116, v117
v_cvt_pk_bf16_f32 v135, v118, v119
s_nop 1
v_mfma_f32_32x32x16_bf16 v[72:87], v[148:151], v[132:135], v[72:87]
v_mov_b32 v2, v64
v_mov_b32 v4, v2
s_nop 1
v_permlane32_swap_b32 v4, v2
s_nop 6
v_mov_b32 v3, v80
v_mov_b32 v4, v3
s_nop 1
v_permlane32_swap_b32 v4, v3
s_cmp_eq_u32 s28, 1
s_cbranch_scc1 attnb_done5
v_max_f32 v4, v2, v3
v_cmp_nge_f32 vcc, 0x4e800000, v4
v_cmp_u_f32 s[30:31], v2, v3
s_nop 3
s_or_b64 s[32:33], vcc, s[30:31]
s_movk_i32 s34, 0x207
v_cmp_class_f32 vcc, v56, s34
s_nop 3
s_or_b64 s[32:33], s[32:33], vcc
v_cmp_class_f32 vcc, v57, s34
s_nop 3
s_or_b64 s[32:33], s[32:33], vcc
v_cmp_class_f32 vcc, v58, s34
s_nop 3
s_or_b64 s[32:33], s[32:33], vcc
v_cmp_class_f32 vcc, v59, s34
s_nop 3
s_or_b64 s[32:33], s[32:33], vcc
v_cmp_class_f32 vcc, v60, s34
s_nop 3
s_or_b64 s[32:33], s[32:33], vcc
v_cmp_class_f32 vcc, v61, s34
s_nop 3
s_or_b64 s[32:33], s[32:33], vcc
v_cmp_class_f32 vcc, v62, s34
s_nop 3
s_or_b64 s[32:33], s[32:33], vcc
v_cmp_class_f32 vcc, v63, s34
s_nop 3
s_or_b64 s[32:33], s[32:33], vcc
v_cmp_class_f32 vcc, v64, s34
s_nop 3
s_or_b64 s[32:33], s[32:33], vcc
v_cmp_class_f32 vcc, v65, s34
s_nop 3
s_or_b64 s[32:33], s[32:33], vcc
v_cmp_class_f32 vcc, v66, s34
s_nop 3
s_or_b64 s[32:33], s[32:33], vcc
v_cmp_class_f32 vcc, v67, s34
s_nop 3
s_or_b64 s[32:33], s[32:33], vcc
v_cmp_class_f32 vcc, v68, s34
s_nop 3
s_or_b64 s[32:33], s[32:33], vcc
v_cmp_class_f32 vcc, v69, s34
s_nop 3
s_or_b64 s[32:33], s[32:33], vcc
v_cmp_class_f32 vcc, v70, s34
s_nop 3
s_or_b64 s[32:33], s[32:33], vcc
v_cmp_class_f32 vcc, v71, s34
s_nop 3
s_or_b64 s[32:33], s[32:33], vcc
v_cmp_class_f32 vcc, v72, s34
s_nop 3
s_or_b64 s[32:33], s[32:33], vcc
v_cmp_class_f32 vcc, v73, s34
s_nop 3
s_or_b64 s[32:33], s[32:33], vcc
v_cmp_class_f32 vcc, v74, s34
s_nop 3
s_or_b64 s[32:33], s[32:33], vcc
v_cmp_class_f32 vcc, v75, s34
s_nop 3
s_or_b64 s[32:33], s[32:33], vcc
v_cmp_class_f32 vcc, v76, s34
s_nop 3
s_or_b64 s[32:33], s[32:33], vcc
v_cmp_class_f32 vcc, v77, s34
s_nop 3
s_or_b64 s[32:33], s[32:33], vcc
v_cmp_class_f32 vcc, v78, s34
s_nop 3
s_or_b64 s[32:33], s[32:33], vcc
v_cmp_class_f32 vcc, v79, s34
s_nop 3
s_or_b64 s[32:33], s[32:33], vcc
v_cmp_class_f32 vcc, v80, s34
s_nop 3
s_or_b64 s[32:33], s[32:33], vcc
v_cmp_class_f32 vcc, v81, s34
s_nop 3
s_or_b64 s[32:33], s[32:33], vcc
v_cmp_class_f32 vcc, v82, s34
s_nop 3
s_or_b64 s[32:33], s[32:33], vcc
v_cmp_class_f32 vcc, v83, s34
s_nop 3
s_or_b64 s[32:33], s[32:33], vcc
v_cmp_class_f32 vcc, v84, s34
s_nop 3
s_or_b64 s[32:33], s[32:33], vcc
v_cmp_class_f32 vcc, v85, s34
s_nop 3
s_or_b64 s[32:33], s[32:33], vcc
v_cmp_class_f32 vcc, v86, s34
s_nop 3
s_or_b64 s[32:33], s[32:33], vcc
v_cmp_class_f32 vcc, v87, s34
s_nop 3
s_or_b64 s[32:33], s[32:33], vcc
s_mov_b64 vcc, s[32:33]
s_cbranch_vccz attnb_done5
s_mov_b32 s25, s21
s_mov_b32 s27, 0
v_mov_b32 v120, 0xff800000
v_mov_b32 v121, 0xff800000
attnb_fb4:
buffer_load_dwordx4 v[136:139], v1, s[4:7], s25 offen
buffer_load_dwordx4 v[140:143], v1, s[4:7], s25 offen offset:1024
s_add_u32 s25, s25, 2048
s_waitcnt vmcnt(0)
v_mfma_f32_32x32x16_bf16 v[88:103], v[136:139], v[8:11], 0
v_mfma_f32_32x32x16_bf16 v[88:103], v[140:143], v[12:15], v[88:103]
v_mfma_f32_32x32x16_bf16 v[104:119], v[136:139], v[16:19], 0
v_mfma_f32_32x32x16_bf16 v[104:119], v[140:143], v[20:23], v[104:119]
s_nop 9
v_max3_f32 v2, v88, v89, v90
v_max3_f32 v2, v2, v91, v92
v_max3_f32 v2, v2, v93, v94
v_max3_f32 v2, v2, v95, v96
v_max3_f32 v2, v2, v97, v98
v_max3_f32 v2, v2, v99, v100
v_max3_f32 v2, v2, v101, v102
v_max_f32 v2, v2, v103
v_max_f32 v120, v120, v2
s_nop 2
v_max3_f32 v3, v104, v105, v106
v_max3_f32 v3, v3, v107, v108
v_max3_f32 v3, v3, v109, v110
v_max3_f32 v3, v3, v111, v112
v_max3_f32 v3, v3, v113, v114
v_max3_f32 v3, v3, v115, v116
v_max3_f32 v3, v3, v117, v118
v_max_f32 v3, v3, v119
v_max_f32 v121, v121, v3
s_add_u32 s27, s27, 1
s_cmp_lt_u32 s27, 64
s_cbranch_scc1 attnb_fb4
v_mov_b32 v4, v120
s_nop 1
v_permlane32_swap_b32 v120, v4
v_max_f32 v120, v120, v4
v_sub_f32 v24, 0, v120
v_sub_f32 v25, 0, v120
v_sub_f32 v26, 0, v120
v_sub_f32 v27, 0, v120
v_sub_f32 v28, 0, v120
v_sub_f32 v29, 0, v120
v_sub_f32 v30, 0, v120
v_sub_f32 v31, 0, v120
v_sub_f32 v32, 0, v120
v_sub_f32 v33, 0, v120
v_sub_f32 v34, 0, v120
v_sub_f32 v35, 0, v120
v_sub_f32 v36, 0, v120
v_sub_f32 v37, 0, v120
v_sub_f32 v38, 0, v120
v_sub_f32 v39, 0, v120
v_mov_b32 v4, v121
s_nop 1
v_permlane32_swap_b32 v121, v4
v_max_f32 v121, v121, v4
v_sub_f32 v40, 0, v121
v_sub_f32 v41, 0, v121
v_sub_f32 v42, 0, v121
v_sub_f32 v43, 0, v121
v_sub_f32 v44, 0, v121
v_sub_f32 v45, 0, v121
v_sub_f32 v46, 0, v121
v_sub_f32 v47, 0, v121
v_sub_f32 v48, 0, v121
v_sub_f32 v49, 0, v121
v_sub_f32 v50, 0, v121
v_sub_f32 v51, 0, v121
v_sub_f32 v52, 0, v121
v_sub_f32 v53, 0, v121
v_sub_f32 v54, 0, v121
v_sub_f32 v55, 0, v121
s_mov_b32 s28, 1
s_branch attnb_main2
attnb_done5:
v_and_b32 v139, 63, v0
v_lshrrev_b32 v140, 5, v139
v_and_b32 v142, 15, v139
v_lshlrev_b32 v142, 4, v142
v_bfe_u32 v141, v139, 4, 1
v_mul_u32_u24 v141, 20480, v141
v_add_u32 v142, v142, v141
s_mul_i32 s25, s17, 20
v_lshlrev_b32 v140, 2, v140
v_add_u32 v141, s25, v140
v_add_u32 v141, 0, v141
v_lshrrev_b32 v136, 5, v141
v_lshlrev_b32 v136, 10, v136
v_bfe_u32 v139, v141, 3, 2
v_lshl_add_u32 v136, v139, 8, v136
v_bfe_u32 v139, v141, 2, 1
v_lshl_add_u32 v136, v139, 3, v136
v_add_u32 v136, v136, v142
v_add_u32 v141, s25, v140
v_add_u32 v141, 8, v141
v_lshrrev_b32 v137, 5, v141
v_lshlrev_b32 v137, 10, v137
v_bfe_u32 v139, v141, 3, 2
v_lshl_add_u32 v137, v139, 8, v137
v_bfe_u32 v139, v141, 2, 1
v_lshl_add_u32 v137, v139, 3, v137
v_add_u32 v137, v137, v142
v_add_u32 v141, s25, v140
v_add_u32 v141, 16, v141
v_lshrrev_b32 v138, 5, v141
v_lshlrev_b32 v138, 10, v138
v_bfe_u32 v139, v141, 3, 2
v_lshl_add_u32 v138, v139, 8, v138
v_bfe_u32 v139, v141, 2, 1
v_lshl_add_u32 v138, v139, 3, v138
v_add_u32 v138, v138, v142
v_cmp_eq_u32 vcc, 0, v140
v_mov_b32 v139, 0x80000000
s_nop 0
v_cndmask_b32 v138, v139, v138, vcc
s_mul_i32 s24, s23, 40960
s_add_u32 s24, s24, 50331648
v_rcp_f32 v4, v2
s_nop 0
v_mul_f32 v56, v56, v4
v_mul_f32 v57, v57, v4
v_mul_f32 v58, v58, v4
v_mul_f32 v59, v59, v4
v_mul_f32 v60, v60, v4
v_mul_f32 v61, v61, v4
v_mul_f32 v62, v62, v4
v_mul_f32 v63, v63, v4
v_mul_f32 v64, v64, v4
v_mul_f32 v65, v65, v4
v_mul_f32 v66, v66, v4
v_mul_f32 v67, v67, v4
v_cvt_pk_bf16_f32 v120, v56, v57
v_cvt_pk_bf16_f32 v121, v58, v59
v_cvt_pk_bf16_f32 v122, v60, v61
v_cvt_pk_bf16_f32 v123, v62, v63
v_cvt_pk_bf16_f32 v124, v64, v65
v_cvt_pk_bf16_f32 v125, v66, v67
buffer_store_dwordx2 v[120:121], v136, s[4:7], s24 offen sc1
buffer_store_dwordx2 v[122:123], v137, s[4:7], s24 offen sc1
buffer_store_dwordx2 v[124:125], v138, s[4:7], s24 offen sc1
v_rcp_f32 v4, v3
s_nop 0
v_mul_f32 v72, v72, v4
v_mul_f32 v73, v73, v4
v_mul_f32 v74, v74, v4
v_mul_f32 v75, v75, v4
v_mul_f32 v76, v76, v4
v_mul_f32 v77, v77, v4
v_mul_f32 v78, v78, v4
v_mul_f32 v79, v79, v4
v_mul_f32 v80, v80, v4
v_mul_f32 v81, v81, v4
v_mul_f32 v82, v82, v4
v_mul_f32 v83, v83, v4
v_cvt_pk_bf16_f32 v128, v72, v73
v_cvt_pk_bf16_f32 v129, v74, v75
v_cvt_pk_bf16_f32 v130, v76, v77
v_cvt_pk_bf16_f32 v131, v78, v79
v_cvt_pk_bf16_f32 v132, v80, v81
v_cvt_pk_bf16_f32 v133, v82, v83
s_add_u32 s24, s24, 40960
buffer_store_dwordx2 v[128:129], v136, s[4:7], s24 offen sc1
buffer_store_dwordx2 v[130:131], v137, s[4:7], s24 offen sc1
buffer_store_dwordx2 v[132:133], v138, s[4:7], s24 offen sc1
attnb_exit1:
s_endpgm
.globl outb1_kernel
.p2align 8
.type outb1_kernel,@function
outb1_kernel:
s_cmp_ge_u32 s2, 256
s_cbranch_scc1 outb1_exit1
s_load_dwordx2 s[12:13], s[0:1], 96
s_load_dwordx2 s[14:15], s[0:1], 0
s_load_dwordx2 s[48:49], s[0:1], 80
v_lshrrev_b32 v3, 6, v0
v_and_b32 v4, 63, v0
s_nop 0
v_readfirstlane_b32 s16, v3
v_lshlrev_b32 v1, 4, v4
s_and_b32 s17, s2, 7
s_lshl_b32 s17, s17, 2
s_lshr_b32 s18, s2, 3
s_and_b32 s19, s18, 3
s_add_u32 s17, s17, s19
s_lshr_b32 s18, s18, 2
s_waitcnt lgkmcnt(0)
s_mov_b32 s4, s12
s_mov_b32 s5, s13
s_mov_b32 s6, 0x10000000
s_mov_b32 s7, 0x20000
s_mov_b32 s8, s12
s_mov_b32 s9, s13
s_mov_b32 s10, 0x10000000
s_mov_b32 s11, 0x20000
s_mov_b32 s20, 82313216
s_mov_b32 s52, s48
s_mov_b32 s53, s49
s_mov_b32 s54, 2621440
s_mov_b32 s55, 0x20000
s_mul_i32 s21, s18, 5
s_mul_i32 s21, s21, 20480
s_add_u32 s24, s21, 90013696
s_add_u32 s25, s24, 20480
s_add_u32 s26, s25, 20480
s_add_u32 s27, s26, 20480
s_add_u32 s28, s27, 20480
s_lshl_b32 s21, s17, 2
s_add_u32 s21, s21, s16
s_mul_i32 s22, s21, 20480
s_add_u32 s22, s22, 50331648
s_lshl_b32 s23, s16, 10
v_add_u32 v2, s23, v1
s_mul_i32 s29, s16, 5120
s_add_u32 m0, s29, 0
s_nop 0
buffer_load_dwordx4 v2, s[4:7], s24 offen lds
s_add_u32 m0, s29, 1024
s_nop 0
buffer_load_dwordx4 v2, s[4:7], s25 offen lds
s_add_u32 m0, s29, 2048
s_nop 0
buffer_load_dwordx4 v2, s[4:7], s26 offen lds
s_add_u32 m0, s29, 3072
s_nop 0
buffer_load_dwordx4 v2, s[4:7], s27 offen lds
s_add_u32 m0, s29, 4096
s_nop 0
buffer_load_dwordx4 v2, s[4:7], s28 offen lds
buffer_load_dwordx4 v[32:35], v1, s[4:7], s22 offen offset:0
buffer_load_dwordx4 v[36:39], v1, s[4:7], s22 offen offset:1024
buffer_load_dwordx4 v[40:43], v1, s[4:7], s22 offen offset:2048
buffer_load_dwordx4 v[44:47], v1, s[4:7], s22 offen offset:3072
v_add_u32 v2, 0x1000, v2
s_add_u32 s22, s22, 4096
s_add_u32 m0, s29, 20480
s_nop 0
buffer_load_dwordx4 v2, s[4:7], s24 offen lds
s_add_u32 m0, s29, 21504
s_nop 0
buffer_load_dwordx4 v2, s[4:7], s25 offen lds
s_add_u32 m0, s29, 22528
s_nop 0
buffer_load_dwordx4 v2, s[4:7], s26 offen lds
s_add_u32 m0, s29, 23552
s_nop 0
buffer_load_dwordx4 v2, s[4:7], s27 offen lds
s_add_u32 m0, s29, 24576
s_nop 0
buffer_load_dwordx4 v2, s[4:7], s28 offen lds
buffer_load_dwordx4 v[48:51], v1, s[4:7], s22 offen offset:0
buffer_load_dwordx4 v[52:55], v1, s[4:7], s22 offen offset:1024
buffer_load_dwordx4 v[56:59], v1, s[4:7], s22 offen offset:2048
buffer_load_dwordx4 v[60:63], v1, s[4:7], s22 offen offset:3072
v_add_u32 v2, 0x1000, v2
s_add_u32 s22, s22, 4096
s_waitcnt vmcnt(9)
s_barrier
s_add_u32 m0, s29, 40960
s_nop 0
buffer_load_dwordx4 v2, s[4:7], s24 offen lds
s_add_u32 m0, s29, 41984
s_nop 0
buffer_load_dwordx4 v2, s[4:7], s25 offen lds
s_add_u32 m0, s29, 43008
s_nop 0
buffer_load_dwordx4 v2, s[4:7], s26 offen lds
s_add_u32 m0, s29, 44032
s_nop 0
buffer_load_dwordx4 v2, s[4:7], s27 offen lds
s_add_u32 m0, s29, 45056
s_nop 0
buffer_load_dwordx4 v2, s[4:7], s28 offen lds
buffer_load_dwordx4 v[64:67], v1, s[4:7], s22 offen offset:0
buffer_load_dwordx4 v[68:71], v1, s[4:7], s22 offen offset:1024
buffer_load_dwordx4 v[72:75], v1, s[4:7], s22 offen offset:2048
buffer_load_dwordx4 v[76:79], v1, s[4:7], s22 offen offset:3072
v_add_u32 v2, 0x1000, v2
s_add_u32 s22, s22, 4096
ds_read_b128 v[80:83], v1 offset:0
ds_read_b128 v[84:87], v1 offset:1024
ds_read_b128 v[88:91], v1 offset:2048
ds_read_b128 v[92:95], v1 offset:3072
ds_read_b128 v[96:99], v1 offset:4096
ds_read_b128 v[100:103], v1 offset:5120
ds_read_b128 v[104:107], v1 offset:6144
ds_read_b128 v[108:111], v1 offset:7168
ds_read_b128 v[112:115], v1 offset:8192
ds_read_b128 v[116:119], v1 offset:9216
s_waitcnt lgkmcnt(5)
v_mfma_f32_16x16x32_bf16 v[8:11], v[80:83], v[32:35], 0
v_mfma_f32_16x16x32_bf16 v[12:15], v[84:87], v[32:35], 0
v_mfma_f32_16x16x32_bf16 v[16:19], v[88:91], v[32:35], 0
v_mfma_f32_16x16x32_bf16 v[20:23], v[92:95], v[32:35], 0
v_mfma_f32_16x16x32_bf16 v[24:27], v[96:99], v[32:35], 0
ds_read_b128 v[80:83], v1 offset:10240
ds_read_b128 v[84:87], v1 offset:11264
ds_read_b128 v[88:91], v1 offset:12288
ds_read_b128 v[92:95], v1 offset:13312
ds_read_b128 v[96:99], v1 offset:14336
s_waitcnt lgkmcnt(5)
v_mfma_f32_16x16x32_bf16 v[8:11], v[100:103], v[36:39], v[8:11]
v_mfma_f32_16x16x32_bf16 v[12:15], v[104:107], v[36:39], v[12:15]
v_mfma_f32_16x16x32_bf16 v[16:19], v[108:111], v[36:39], v[16:19]
v_mfma_f32_16x16x32_bf16 v[20:23], v[112:115], v[36:39], v[20:23]
v_mfma_f32_16x16x32_bf16 v[24:27], v[116:119], v[36:39], v[24:27]
ds_read_b128 v[100:103], v1 offset:15360
ds_read_b128 v[104:107], v1 offset:16384
ds_read_b128 v[108:111], v1 offset:17408
ds_read_b128 v[112:115], v1 offset:18432
ds_read_b128 v[116:119], v1 offset:19456
s_waitcnt lgkmcnt(5)
v_mfma_f32_16x16x32_bf16 v[8:11], v[80:83], v[40:43], v[8:11]
v_mfma_f32_16x16x32_bf16 v[12:15], v[84:87], v[40:43], v[12:15]
v_mfma_f32_16x16x32_bf16 v[16:19], v[88:91], v[40:43], v[16:19]
v_mfma_f32_16x16x32_bf16 v[20:23], v[92:95], v[40:43], v[20:23]
v_mfma_f32_16x16x32_bf16 v[24:27], v[96:99], v[40:43], v[24:27]
s_waitcnt lgkmcnt(0)
v_mfma_f32_16x16x32_bf16 v[8:11], v[100:103], v[44:47], v[8:11]
v_mfma_f32_16x16x32_bf16 v[12:15], v[104:107], v[44:47], v[12:15]
v_mfma_f32_16x16x32_bf16 v[16:19], v[108:111], v[44:47], v[16:19]
v_mfma_f32_16x16x32_bf16 v[20:23], v[112:115], v[44:47], v[20:23]
v_mfma_f32_16x16x32_bf16 v[24:27], v[116:119], v[44:47], v[24:27]
s_waitcnt vmcnt(9)
s_barrier
s_add_u32 m0, s29, 0
s_nop 0
buffer_load_dwordx4 v2, s[4:7], s24 offen lds
s_add_u32 m0, s29, 1024
s_nop 0
buffer_load_dwordx4 v2, s[4:7], s25 offen lds
s_add_u32 m0, s29, 2048
s_nop 0
buffer_load_dwordx4 v2, s[4:7], s26 offen lds
s_add_u32 m0, s29, 3072
s_nop 0
buffer_load_dwordx4 v2, s[4:7], s27 offen lds
s_add_u32 m0, s29, 4096
s_nop 0
buffer_load_dwordx4 v2, s[4:7], s28 offen lds
buffer_load_dwordx4 v[32:35], v1, s[4:7], s22 offen offset:0
buffer_load_dwordx4 v[36:39], v1, s[4:7], s22 offen offset:1024
buffer_load_dwordx4 v[40:43], v1, s[4:7], s22 offen offset:2048
buffer_load_dwordx4 v[44:47], v1, s[4:7], s22 offen offset:3072
v_add_u32 v2, 0x1000, v2
s_add_u32 s22, s22, 4096
ds_read_b128 v[80:83], v1 offset:20480
ds_read_b128 v[84:87], v1 offset:21504
ds_read_b128 v[88:91], v1 offset:22528
ds_read_b128 v[92:95], v1 offset:23552
ds_read_b128 v[96:99], v1 offset:24576
ds_read_b128 v[100:103], v1 offset:25600
ds_read_b128 v[104:107], v1 offset:26624
ds_read_b128 v[108:111], v1 offset:27648
ds_read_b128 v[112:115], v1 offset:28672
ds_read_b128 v[116:119], v1 offset:29696
s_waitcnt lgkmcnt(5)
v_mfma_f32_16x16x32_bf16 v[8:11], v[80:83], v[48:51], v[8:11]
v_mfma_f32_16x16x32_bf16 v[12:15], v[84:87], v[48:51], v[12:15]
v_mfma_f32_16x16x32_bf16 v[16:19], v[88:91], v[48:51], v[16:19]
v_mfma_f32_16x16x32_bf16 v[20:23], v[92:95], v[48:51], v[20:23]
v_mfma_f32_16x16x32_bf16 v[24:27], v[96:99], v[48:51], v[24:27]
ds_read_b128 v[80:83], v1 offset:30720
ds_read_b128 v[84:87], v1 offset:31744
ds_read_b128 v[88:91], v1 offset:32768
ds_read_b128 v[92:95], v1 offset:33792
ds_read_b128 v[96:99], v1 offset:34816
s_waitcnt lgkmcnt(5)
v_mfma_f32_16x16x32_bf16 v[8:11], v[100:103], v[52:55], v[8:11]
v_mfma_f32_16x16x32_bf16 v[12:15], v[104:107], v[52:55], v[12:15]
v_mfma_f32_16x16x32_bf16 v[16:19], v[108:111], v[52:55], v[16:19]
v_mfma_f32_16x16x32_bf16 v[20:23], v[112:115], v[52:55], v[20:23]
v_mfma_f32_16x16x32_bf16 v[24:27], v[116:119], v[52:55], v[24:27]
ds_read_b128 v[100:103], v1 offset:35840
ds_read_b128 v[104:107], v1 offset:36864
ds_read_b128 v[108:111], v1 offset:37888
ds_read_b128 v[112:115], v1 offset:38912
ds_read_b128 v[116:119], v1 offset:39936
s_waitcnt lgkmcnt(5)
v_mfma_f32_16x16x32_bf16 v[8:11], v[80:83], v[56:59], v[8:11]
v_mfma_f32_16x16x32_bf16 v[12:15], v[84:87], v[56:59], v[12:15]
v_mfma_f32_16x16x32_bf16 v[16:19], v[88:91], v[56:59], v[16:19]
v_mfma_f32_16x16x32_bf16 v[20:23], v[92:95], v[56:59], v[20:23]
v_mfma_f32_16x16x32_bf16 v[24:27], v[96:99], v[56:59], v[24:27]
s_waitcnt lgkmcnt(0)
v_mfma_f32_16x16x32_bf16 v[8:11], v[100:103], v[60:63], v[8:11]
v_mfma_f32_16x16x32_bf16 v[12:15], v[104:107], v[60:63], v[12:15]
v_mfma_f32_16x16x32_bf16 v[16:19], v[108:111], v[60:63], v[16:19]
v_mfma_f32_16x16x32_bf16 v[20:23], v[112:115], v[60:63], v[20:23]
v_mfma_f32_16x16x32_bf16 v[24:27], v[116:119], v[60:63], v[24:27]
s_waitcnt vmcnt(9)
s_barrier
s_add_u32 m0, s29, 20480
s_nop 0
buffer_load_dwordx4 v2, s[4:7], s24 offen lds
s_add_u32 m0, s29, 21504
s_nop 0
buffer_load_dwordx4 v2, s[4:7], s25 offen lds
s_add_u32 m0, s29, 22528
s_nop 0
buffer_load_dwordx4 v2, s[4:7], s26 offen lds
s_add_u32 m0, s29, 23552
s_nop 0
buffer_load_dwordx4 v2, s[4:7], s27 offen lds
s_add_u32 m0, s29, 24576
s_nop 0
buffer_load_dwordx4 v2, s[4:7], s28 offen lds
buffer_load_dwordx4 v[48:51], v1, s[4:7], s22 offen offset:0
buffer_load_dwordx4 v[52:55], v1, s[4:7], s22 offen offset:1024
buffer_load_dwordx4 v[56:59], v1, s[4:7], s22 offen offset:2048
buffer_load_dwordx4 v[60:63], v1, s[4:7], s22 offen offset:3072
v_add_u32 v2, 0x1000, v2
s_add_u32 s22, s22, 4096
ds_read_b128 v[80:83], v1 offset:40960
ds_read_b128 v[84:87], v1 offset:41984
ds_read_b128 v[88:91], v1 offset:43008
ds_read_b128 v[92:95], v1 offset:44032
ds_read_b128 v[96:99], v1 offset:45056
ds_read_b128 v[100:103], v1 offset:46080
ds_read_b128 v[104:107], v1 offset:47104
ds_read_b128 v[108:111], v1 offset:48128
ds_read_b128 v[112:115], v1 offset:49152
ds_read_b128 v[116:119], v1 offset:50176
s_waitcnt lgkmcnt(5)
v_mfma_f32_16x16x32_bf16 v[8:11], v[80:83], v[64:67], v[8:11]
v_mfma_f32_16x16x32_bf16 v[12:15], v[84:87], v[64:67], v[12:15]
v_mfma_f32_16x16x32_bf16 v[16:19], v[88:91], v[64:67], v[16:19]
v_mfma_f32_16x16x32_bf16 v[20:23], v[92:95], v[64:67], v[20:23]
v_mfma_f32_16x16x32_bf16 v[24:27], v[96:99], v[64:67], v[24:27]
ds_read_b128 v[80:83], v1 offset:51200
ds_read_b128 v[84:87], v1 offset:52224
ds_read_b128 v[88:91], v1 offset:53248
ds_read_b128 v[92:95], v1 offset:54272
ds_read_b128 v[96:99], v1 offset:55296
s_waitcnt lgkmcnt(5)
v_mfma_f32_16x16x32_bf16 v[8:11], v[100:103], v[68:71], v[8:11]
v_mfma_f32_16x16x32_bf16 v[12:15], v[104:107], v[68:71], v[12:15]
v_mfma_f32_16x16x32_bf16 v[16:19], v[108:111], v[68:71], v[16:19]
v_mfma_f32_16x16x32_bf16 v[20:23], v[112:115], v[68:71], v[20:23]
v_mfma_f32_16x16x32_bf16 v[24:27], v[116:119], v[68:71], v[24:27]
ds_read_b128 v[100:103], v1 offset:56320
ds_read_b128 v[104:107], v1 offset:57344
ds_read_b128 v[108:111], v1 offset:58368
ds_read_b128 v[112:115], v1 offset:59392
ds_read_b128 v[116:119], v1 offset:60416
s_waitcnt lgkmcnt(5)
v_mfma_f32_16x16x32_bf16 v[8:11], v[80:83], v[72:75], v[8:11]
v_mfma_f32_16x16x32_bf16 v[12:15], v[84:87], v[72:75], v[12:15]
v_mfma_f32_16x16x32_bf16 v[16:19], v[88:91], v[72:75], v[16:19]
v_mfma_f32_16x16x32_bf16 v[20:23], v[92:95], v[72:75], v[20:23]
v_mfma_f32_16x16x32_bf16 v[24:27], v[96:99], v[72:75], v[24:27]
s_waitcnt lgkmcnt(0)
v_mfma_f32_16x16x32_bf16 v[8:11], v[100:103], v[76:79], v[8:11]
v_mfma_f32_16x16x32_bf16 v[12:15], v[104:107], v[76:79], v[12:15]
v_mfma_f32_16x16x32_bf16 v[16:19], v[108:111], v[76:79], v[16:19]
v_mfma_f32_16x16x32_bf16 v[20:23], v[112:115], v[76:79], v[20:23]
v_mfma_f32_16x16x32_bf16 v[24:27], v[116:119], v[76:79], v[24:27]
s_waitcnt vmcnt(9)
s_barrier
ds_read_b128 v[80:83], v1 offset:0
ds_read_b128 v[84:87], v1 offset:1024
ds_read_b128 v[88:91], v1 offset:2048
ds_read_b128 v[92:95], v1 offset:3072
ds_read_b128 v[96:99], v1 offset:4096
ds_read_b128 v[100:103], v1 offset:5120
ds_read_b128 v[104:107], v1 offset:6144
ds_read_b128 v[108:111], v1 offset:7168
ds_read_b128 v[112:115], v1 offset:8192
ds_read_b128 v[116:119], v1 offset:9216
s_waitcnt lgkmcnt(5)
v_mfma_f32_16x16x32_bf16 v[8:11], v[80:83], v[32:35], v[8:11]
v_mfma_f32_16x16x32_bf16 v[12:15], v[84:87], v[32:35], v[12:15]
v_mfma_f32_16x16x32_bf16 v[16:19], v[88:91], v[32:35], v[16:19]
v_mfma_f32_16x16x32_bf16 v[20:23], v[92:95], v[32:35], v[20:23]
v_mfma_f32_16x16x32_bf16 v[24:27], v[96:99], v[32:35], v[24:27]
ds_read_b128 v[80:83], v1 offset:10240
ds_read_b128 v[84:87], v1 offset:11264
ds_read_b128 v[88:91], v1 offset:12288
ds_read_b128 v[92:95], v1 offset:13312
ds_read_b128 v[96:99], v1 offset:14336
s_waitcnt lgkmcnt(5)
v_mfma_f32_16x16x32_bf16 v[8:11], v[100:103], v[36:39], v[8:11]
v_mfma_f32_16x16x32_bf16 v[12:15], v[104:107], v[36:39], v[12:15]
v_mfma_f32_16x16x32_bf16 v[16:19], v[108:111], v[36:39], v[16:19]
v_mfma_f32_16x16x32_bf16 v[20:23], v[112:115], v[36:39], v[20:23]
v_mfma_f32_16x16x32_bf16 v[24:27], v[116:119], v[36:39], v[24:27]
ds_read_b128 v[100:103], v1 offset:15360
ds_read_b128 v[104:107], v1 offset:16384
ds_read_b128 v[108:111], v1 offset:17408
ds_read_b128 v[112:115], v1 offset:18432
ds_read_b128 v[116:119], v1 offset:19456
s_waitcnt lgkmcnt(5)
v_mfma_f32_16x16x32_bf16 v[8:11], v[80:83], v[40:43], v[8:11]
v_mfma_f32_16x16x32_bf16 v[12:15], v[84:87], v[40:43], v[12:15]
v_mfma_f32_16x16x32_bf16 v[16:19], v[88:91], v[40:43], v[16:19]
v_mfma_f32_16x16x32_bf16 v[20:23], v[92:95], v[40:43], v[20:23]
v_mfma_f32_16x16x32_bf16 v[24:27], v[96:99], v[40:43], v[24:27]
s_waitcnt lgkmcnt(0)
v_mfma_f32_16x16x32_bf16 v[8:11], v[100:103], v[44:47], v[8:11]
v_mfma_f32_16x16x32_bf16 v[12:15], v[104:107], v[44:47], v[12:15]
v_mfma_f32_16x16x32_bf16 v[16:19], v[108:111], v[44:47], v[16:19]
v_mfma_f32_16x16x32_bf16 v[20:23], v[112:115], v[44:47], v[20:23]
v_mfma_f32_16x16x32_bf16 v[24:27], v[116:119], v[44:47], v[24:27]
s_waitcnt vmcnt(0)
s_barrier
ds_read_b128 v[80:83], v1 offset:20480
ds_read_b128 v[84:87], v1 offset:21504
ds_read_b128 v[88:91], v1 offset:22528
ds_read_b128 v[92:95], v1 offset:23552
ds_read_b128 v[96:99], v1 offset:24576
ds_read_b128 v[100:103], v1 offset:25600
ds_read_b128 v[104:107], v1 offset:26624
ds_read_b128 v[108:111], v1 offset:27648
ds_read_b128 v[112:115], v1 offset:28672
ds_read_b128 v[116:119], v1 offset:29696
s_waitcnt lgkmcnt(5)
v_mfma_f32_16x16x32_bf16 v[8:11], v[80:83], v[48:51], v[8:11]
v_mfma_f32_16x16x32_bf16 v[12:15], v[84:87], v[48:51], v[12:15]
v_mfma_f32_16x16x32_bf16 v[16:19], v[88:91], v[48:51], v[16:19]
v_mfma_f32_16x16x32_bf16 v[20:23], v[92:95], v[48:51], v[20:23]
v_mfma_f32_16x16x32_bf16 v[24:27], v[96:99], v[48:51], v[24:27]
ds_read_b128 v[80:83], v1 offset:30720
ds_read_b128 v[84:87], v1 offset:31744
ds_read_b128 v[88:91], v1 offset:32768
ds_read_b128 v[92:95], v1 offset:33792
ds_read_b128 v[96:99], v1 offset:34816
s_waitcnt lgkmcnt(5)
v_mfma_f32_16x16x32_bf16 v[8:11], v[100:103], v[52:55], v[8:11]
v_mfma_f32_16x16x32_bf16 v[12:15], v[104:107], v[52:55], v[12:15]
v_mfma_f32_16x16x32_bf16 v[16:19], v[108:111], v[52:55], v[16:19]
v_mfma_f32_16x16x32_bf16 v[20:23], v[112:115], v[52:55], v[20:23]
v_mfma_f32_16x16x32_bf16 v[24:27], v[116:119], v[52:55], v[24:27]
ds_read_b128 v[100:103], v1 offset:35840
ds_read_b128 v[104:107], v1 offset:36864
ds_read_b128 v[108:111], v1 offset:37888
ds_read_b128 v[112:115], v1 offset:38912
ds_read_b128 v[116:119], v1 offset:39936
s_waitcnt lgkmcnt(5)
v_mfma_f32_16x16x32_bf16 v[8:11], v[80:83], v[56:59], v[8:11]
v_mfma_f32_16x16x32_bf16 v[12:15], v[84:87], v[56:59], v[12:15]
v_mfma_f32_16x16x32_bf16 v[16:19], v[88:91], v[56:59], v[16:19]
v_mfma_f32_16x16x32_bf16 v[20:23], v[92:95], v[56:59], v[20:23]
v_mfma_f32_16x16x32_bf16 v[24:27], v[96:99], v[56:59], v[24:27]
s_waitcnt lgkmcnt(0)
v_mfma_f32_16x16x32_bf16 v[8:11], v[100:103], v[60:63], v[8:11]
v_mfma_f32_16x16x32_bf16 v[12:15], v[104:107], v[60:63], v[12:15]
v_mfma_f32_16x16x32_bf16 v[16:19], v[108:111], v[60:63], v[16:19]
v_mfma_f32_16x16x32_bf16 v[20:23], v[112:115], v[60:63], v[20:23]
v_mfma_f32_16x16x32_bf16 v[24:27], v[116:119], v[60:63], v[24:27]
v_and_b32 v3, 63, v0
v_and_b32 v4, 15, v3
v_lshrrev_b32 v3, 4, v3
s_lshl_b32 s21, s17, 6
s_lshl_b32 s23, s16, 4
s_add_u32 s21, s21, s23
v_add_u32 v4, s21, v4
v_mul_u32_u24 v6, 1280, v4
v_lshl_add_u32 v6, v3, 4, v6
s_mul_i32 s21, s18, 5
s_add_u32 s23, s21, 0
s_lshr_b32 s31, s23, 1
s_lshl_b32 s31, s31, 6
s_and_b32 s23, s23, 1
s_lshl_b32 s23, s23, 3
s_add_u32 s32, s31, s23
s_add_u32 s40, s32, s20
buffer_load_dwordx2 v[32:33], v6, s[8:11], s40 offen
s_add_u32 s23, s21, 1
s_lshr_b32 s31, s23, 1
s_lshl_b32 s31, s31, 6
s_and_b32 s23, s23, 1
s_lshl_b32 s23, s23, 3
s_add_u32 s33, s31, s23
s_add_u32 s41, s33, s20
buffer_load_dwordx2 v[34:35], v6, s[8:11], s41 offen
s_add_u32 s23, s21, 2
s_lshr_b32 s31, s23, 1
s_lshl_b32 s31, s31, 6
s_and_b32 s23, s23, 1
s_lshl_b32 s23, s23, 3
s_add_u32 s34, s31, s23
s_add_u32 s42, s34, s20
buffer_load_dwordx2 v[36:37], v6, s[8:11], s42 offen
s_add_u32 s23, s21, 3
s_lshr_b32 s31, s23, 1
s_lshl_b32 s31, s31, 6
s_and_b32 s23, s23, 1
s_lshl_b32 s23, s23, 3
s_add_u32 s35, s31, s23
s_add_u32 s43, s35, s20
buffer_load_dwordx2 v[38:39], v6, s[8:11], s43 offen
s_add_u32 s23, s21, 4
s_lshr_b32 s31, s23, 1
s_lshl_b32 s31, s31, 6
s_and_b32 s23, s23, 1
s_lshl_b32 s23, s23, 3
s_add_u32 s36, s31, s23
s_add_u32 s44, s36, s20
buffer_load_dwordx2 v[40:41], v6, s[8:11], s44 offen
s_waitcnt vmcnt(0)
v_cvt_pk_bf16_f32 v80, v8, v9
v_cvt_pk_bf16_f32 v81, v10, v11
v_lshlrev_b32 v8, 16, v80
v_and_b32 v9, 0xffff0000, v80
v_lshlrev_b32 v10, 16, v81
v_and_b32 v11, 0xffff0000, v81
v_lshlrev_b32 v82, 16, v32
v_and_b32 v83, 0xffff0000, v32
v_lshlrev_b32 v84, 16, v33
v_and_b32 v85, 0xffff0000, v33
v_add_f32 v8, v8, v82
v_add_f32 v9, v9, v83
v_add_f32 v10, v10, v84
v_add_f32 v11, v11, v85
v_cvt_pk_bf16_f32 v32, v8, v9
v_cvt_pk_bf16_f32 v33, v10, v11
s_add_u32 s23, s32, 82313216
buffer_store_dwordx2 v[32:33], v6, s[4:7], s23 offen sc1
v_cvt_pk_bf16_f32 v80, v12, v13
v_cvt_pk_bf16_f32 v81, v14, v15
v_lshlrev_b32 v12, 16, v80
v_and_b32 v13, 0xffff0000, v80
v_lshlrev_b32 v14, 16, v81
v_and_b32 v15, 0xffff0000, v81
v_lshlrev_b32 v82, 16, v34
v_and_b32 v83, 0xffff0000, v34
v_lshlrev_b32 v84, 16, v35
v_and_b32 v85, 0xffff0000, v35
v_add_f32 v12, v12, v82
v_add_f32 v13, v13, v83
v_add_f32 v14, v14, v84
v_add_f32 v15, v15, v85
v_cvt_pk_bf16_f32 v34, v12, v13
v_cvt_pk_bf16_f32 v35, v14, v15
s_add_u32 s23, s33, 82313216
buffer_store_dwordx2 v[34:35], v6, s[4:7], s23 offen sc1
v_cvt_pk_bf16_f32 v80, v16, v17
v_cvt_pk_bf16_f32 v81, v18, v19
v_lshlrev_b32 v16, 16, v80
v_and_b32 v17, 0xffff0000, v80
v_lshlrev_b32 v18, 16, v81
v_and_b32 v19, 0xffff0000, v81
v_lshlrev_b32 v82, 16, v36
v_and_b32 v83, 0xffff0000, v36
v_lshlrev_b32 v84, 16, v37
v_and_b32 v85, 0xffff0000, v37
v_add_f32 v16, v16, v82
v_add_f32 v17, v17, v83
v_add_f32 v18, v18, v84
v_add_f32 v19, v19, v85
v_cvt_pk_bf16_f32 v36, v16, v17
v_cvt_pk_bf16_f32 v37, v18, v19
s_add_u32 s23, s34, 82313216
buffer_store_dwordx2 v[36:37], v6, s[4:7], s23 offen sc1
v_cvt_pk_bf16_f32 v80, v20, v21
v_cvt_pk_bf16_f32 v81, v22, v23
v_lshlrev_b32 v20, 16, v80
v_and_b32 v21, 0xffff0000, v80
v_lshlrev_b32 v22, 16, v81
v_and_b32 v23, 0xffff0000, v81
v_lshlrev_b32 v82, 16, v38
v_and_b32 v83, 0xffff0000, v38
v_lshlrev_b32 v84, 16, v39
v_and_b32 v85, 0xffff0000, v39
v_add_f32 v20, v20, v82
v_add_f32 v21, v21, v83
v_add_f32 v22, v22, v84
v_add_f32 v23, v23, v85
v_cvt_pk_bf16_f32 v38, v20, v21
v_cvt_pk_bf16_f32 v39, v22, v23
s_add_u32 s23, s35, 82313216
buffer_store_dwordx2 v[38:39], v6, s[4:7], s23 offen sc1
v_cvt_pk_bf16_f32 v80, v24, v25
v_cvt_pk_bf16_f32 v81, v26, v27
v_lshlrev_b32 v24, 16, v80
v_and_b32 v25, 0xffff0000, v80
v_lshlrev_b32 v26, 16, v81
v_and_b32 v27, 0xffff0000, v81
v_lshlrev_b32 v82, 16, v40
v_and_b32 v83, 0xffff0000, v40
v_lshlrev_b32 v84, 16, v41
v_and_b32 v85, 0xffff0000, v41
v_add_f32 v24, v24, v82
v_add_f32 v25, v25, v83
v_add_f32 v26, v26, v84
v_add_f32 v27, v27, v85
v_cvt_pk_bf16_f32 v40, v24, v25
v_cvt_pk_bf16_f32 v41, v26, v27
s_add_u32 s23, s36, 82313216
buffer_store_dwordx2 v[40:41], v6, s[4:7], s23 offen sc1
outb1_exit1:
s_endpgm
.globl outb2_kernel
.p2align 8
.type outb2_kernel,@function
outb2_kernel:
s_cmp_ge_u32 s2, 256
s_cbranch_scc1 outb2_exit1
s_load_dwordx2 s[12:13], s[0:1], 96
s_load_dwordx2 s[14:15], s[0:1], 0
s_load_dwordx2 s[48:49], s[0:1], 80
v_lshrrev_b32 v3, 6, v0
v_and_b32 v4, 63, v0
s_nop 0
v_readfirstlane_b32 s16, v3
v_lshlrev_b32 v1, 4, v4
s_and_b32 s17, s2, 7
s_lshl_b32 s17, s17, 2
s_lshr_b32 s18, s2, 3
s_and_b32 s19, s18, 3
s_add_u32 s17, s17, s19
s_lshr_b32 s18, s18, 2
s_waitcnt lgkmcnt(0)
s_mov_b32 s4, s12
s_mov_b32 s5, s13
s_mov_b32 s6, 0x10000000
s_mov_b32 s7, 0x20000
s_mov_b32 s8, s12
s_mov_b32 s9, s13
s_mov_b32 s10, 0x10000000
s_mov_b32 s11, 0x20000
s_mov_b32 s20, 82313216
s_mov_b32 s52, s48
s_mov_b32 s53, s49
s_mov_b32 s54, 2621440
s_mov_b32 s55, 0x20000
s_mul_i32 s21, s18, 5
s_mul_i32 s21, s21, 20480
s_add_u32 s24, s21, 90013696
s_add_u32 s25, s24, 20480
s_add_u32 s26, s25, 20480
s_add_u32 s27, s26, 20480
s_add_u32 s28, s27, 20480
s_lshl_b32 s21, s17, 2
s_add_u32 s21, s21, s16
s_mul_i32 s22, s21, 20480
s_add_u32 s22, s22, 50331648
s_lshl_b32 s23, s16, 10
v_add_u32 v2, s23, v1
s_mul_i32 s29, s16, 5120
s_add_u32 m0, s29, 0
s_nop 0
buffer_load_dwordx4 v2, s[4:7], s24 offen lds
s_add_u32 m0, s29, 1024
s_nop 0
buffer_load_dwordx4 v2, s[4:7], s25 offen lds
s_add_u32 m0, s29, 2048
s_nop 0
buffer_load_dwordx4 v2, s[4:7], s26 offen lds
s_add_u32 m0, s29, 3072
s_nop 0
buffer_load_dwordx4 v2, s[4:7], s27 offen lds
s_add_u32 m0, s29, 4096
s_nop 0
buffer_load_dwordx4 v2, s[4:7], s28 offen lds
buffer_load_dwordx4 v[32:35], v1, s[4:7], s22 offen offset:0
buffer_load_dwordx4 v[36:39], v1, s[4:7], s22 offen offset:1024
buffer_load_dwordx4 v[40:43], v1, s[4:7], s22 offen offset:2048
buffer_load_dwordx4 v[44:47], v1, s[4:7], s22 offen offset:3072
v_add_u32 v2, 0x1000, v2
s_add_u32 s22, s22, 4096
s_add_u32 m0, s29, 20480
s_nop 0
buffer_load_dwordx4 v2, s[4:7], s24 offen lds
s_add_u32 m0, s29, 21504
s_nop 0
buffer_load_dwordx4 v2, s[4:7], s25 offen lds
s_add_u32 m0, s29, 22528
s_nop 0
buffer_load_dwordx4 v2, s[4:7], s26 offen lds
s_add_u32 m0, s29, 23552
s_nop 0
buffer_load_dwordx4 v2, s[4:7], s27 offen lds
s_add_u32 m0, s29, 24576
s_nop 0
buffer_load_dwordx4 v2, s[4:7], s28 offen lds
buffer_load_dwordx4 v[48:51], v1, s[4:7], s22 offen offset:0
buffer_load_dwordx4 v[52:55], v1, s[4:7], s22 offen offset:1024
buffer_load_dwordx4 v[56:59], v1, s[4:7], s22 offen offset:2048
buffer_load_dwordx4 v[60:63], v1, s[4:7], s22 offen offset:3072
v_add_u32 v2, 0x1000, v2
s_add_u32 s22, s22, 4096
s_waitcnt vmcnt(9)
s_barrier
s_add_u32 m0, s29, 40960
s_nop 0
buffer_load_dwordx4 v2, s[4:7], s24 offen lds
s_add_u32 m0, s29, 41984
s_nop 0
buffer_load_dwordx4 v2, s[4:7], s25 offen lds
s_add_u32 m0, s29, 43008
s_nop 0
buffer_load_dwordx4 v2, s[4:7], s26 offen lds
s_add_u32 m0, s29, 44032
s_nop 0
buffer_load_dwordx4 v2, s[4:7], s27 offen lds
s_add_u32 m0, s29, 45056
s_nop 0
buffer_load_dwordx4 v2, s[4:7], s28 offen lds
buffer_load_dwordx4 v[64:67], v1, s[4:7], s22 offen offset:0
buffer_load_dwordx4 v[68:71], v1, s[4:7], s22 offen offset:1024
buffer_load_dwordx4 v[72:75], v1, s[4:7], s22 offen offset:2048
buffer_load_dwordx4 v[76:79], v1, s[4:7], s22 offen offset:3072
v_add_u32 v2, 0x1000, v2
s_add_u32 s22, s22, 4096
ds_read_b128 v[80:83], v1 offset:0
ds_read_b128 v[84:87], v1 offset:1024
ds_read_b128 v[88:91], v1 offset:2048
ds_read_b128 v[92:95], v1 offset:3072
ds_read_b128 v[96:99], v1 offset:4096
ds_read_b128 v[100:103], v1 offset:5120
ds_read_b128 v[104:107], v1 offset:6144
ds_read_b128 v[108:111], v1 offset:7168
ds_read_b128 v[112:115], v1 offset:8192
ds_read_b128 v[116:119], v1 offset:9216
s_waitcnt lgkmcnt(5)
v_mfma_f32_16x16x32_bf16 v[8:11], v[80:83], v[32:35], 0
v_mfma_f32_16x16x32_bf16 v[12:15], v[84:87], v[32:35], 0
v_mfma_f32_16x16x32_bf16 v[16:19], v[88:91], v[32:35], 0
v_mfma_f32_16x16x32_bf16 v[20:23], v[92:95], v[32:35], 0
v_mfma_f32_16x16x32_bf16 v[24:27], v[96:99], v[32:35], 0
ds_read_b128 v[80:83], v1 offset:10240
ds_read_b128 v[84:87], v1 offset:11264
ds_read_b128 v[88:91], v1 offset:12288
ds_read_b128 v[92:95], v1 offset:13312
ds_read_b128 v[96:99], v1 offset:14336
s_waitcnt lgkmcnt(5)
v_mfma_f32_16x16x32_bf16 v[8:11], v[100:103], v[36:39], v[8:11]
v_mfma_f32_16x16x32_bf16 v[12:15], v[104:107], v[36:39], v[12:15]
v_mfma_f32_16x16x32_bf16 v[16:19], v[108:111], v[36:39], v[16:19]
v_mfma_f32_16x16x32_bf16 v[20:23], v[112:115], v[36:39], v[20:23]
v_mfma_f32_16x16x32_bf16 v[24:27], v[116:119], v[36:39], v[24:27]
ds_read_b128 v[100:103], v1 offset:15360
ds_read_b128 v[104:107], v1 offset:16384
ds_read_b128 v[108:111], v1 offset:17408
ds_read_b128 v[112:115], v1 offset:18432
ds_read_b128 v[116:119], v1 offset:19456
s_waitcnt lgkmcnt(5)
v_mfma_f32_16x16x32_bf16 v[8:11], v[80:83], v[40:43], v[8:11]
v_mfma_f32_16x16x32_bf16 v[12:15], v[84:87], v[40:43], v[12:15]
v_mfma_f32_16x16x32_bf16 v[16:19], v[88:91], v[40:43], v[16:19]
v_mfma_f32_16x16x32_bf16 v[20:23], v[92:95], v[40:43], v[20:23]
v_mfma_f32_16x16x32_bf16 v[24:27], v[96:99], v[40:43], v[24:27]
s_waitcnt lgkmcnt(0)
v_mfma_f32_16x16x32_bf16 v[8:11], v[100:103], v[44:47], v[8:11]
v_mfma_f32_16x16x32_bf16 v[12:15], v[104:107], v[44:47], v[12:15]
v_mfma_f32_16x16x32_bf16 v[16:19], v[108:111], v[44:47], v[16:19]
v_mfma_f32_16x16x32_bf16 v[20:23], v[112:115], v[44:47], v[20:23]
v_mfma_f32_16x16x32_bf16 v[24:27], v[116:119], v[44:47], v[24:27]
s_waitcnt vmcnt(9)
s_barrier
s_add_u32 m0, s29, 0
s_nop 0
buffer_load_dwordx4 v2, s[4:7], s24 offen lds
s_add_u32 m0, s29, 1024
s_nop 0
buffer_load_dwordx4 v2, s[4:7], s25 offen lds
s_add_u32 m0, s29, 2048
s_nop 0
buffer_load_dwordx4 v2, s[4:7], s26 offen lds
s_add_u32 m0, s29, 3072
s_nop 0
buffer_load_dwordx4 v2, s[4:7], s27 offen lds
s_add_u32 m0, s29, 4096
s_nop 0
buffer_load_dwordx4 v2, s[4:7], s28 offen lds
buffer_load_dwordx4 v[32:35], v1, s[4:7], s22 offen offset:0
buffer_load_dwordx4 v[36:39], v1, s[4:7], s22 offen offset:1024
buffer_load_dwordx4 v[40:43], v1, s[4:7], s22 offen offset:2048
buffer_load_dwordx4 v[44:47], v1, s[4:7], s22 offen offset:3072
v_add_u32 v2, 0x1000, v2
s_add_u32 s22, s22, 4096
ds_read_b128 v[80:83], v1 offset:20480
ds_read_b128 v[84:87], v1 offset:21504
ds_read_b128 v[88:91], v1 offset:22528
ds_read_b128 v[92:95], v1 offset:23552
ds_read_b128 v[96:99], v1 offset:24576
ds_read_b128 v[100:103], v1 offset:25600
ds_read_b128 v[104:107], v1 offset:26624
ds_read_b128 v[108:111], v1 offset:27648
ds_read_b128 v[112:115], v1 offset:28672
ds_read_b128 v[116:119], v1 offset:29696
s_waitcnt lgkmcnt(5)
v_mfma_f32_16x16x32_bf16 v[8:11], v[80:83], v[48:51], v[8:11]
v_mfma_f32_16x16x32_bf16 v[12:15], v[84:87], v[48:51], v[12:15]
v_mfma_f32_16x16x32_bf16 v[16:19], v[88:91], v[48:51], v[16:19]
v_mfma_f32_16x16x32_bf16 v[20:23], v[92:95], v[48:51], v[20:23]
v_mfma_f32_16x16x32_bf16 v[24:27], v[96:99], v[48:51], v[24:27]
ds_read_b128 v[80:83], v1 offset:30720
ds_read_b128 v[84:87], v1 offset:31744
ds_read_b128 v[88:91], v1 offset:32768
ds_read_b128 v[92:95], v1 offset:33792
ds_read_b128 v[96:99], v1 offset:34816
s_waitcnt lgkmcnt(5)
v_mfma_f32_16x16x32_bf16 v[8:11], v[100:103], v[52:55], v[8:11]
v_mfma_f32_16x16x32_bf16 v[12:15], v[104:107], v[52:55], v[12:15]
v_mfma_f32_16x16x32_bf16 v[16:19], v[108:111], v[52:55], v[16:19]
v_mfma_f32_16x16x32_bf16 v[20:23], v[112:115], v[52:55], v[20:23]
v_mfma_f32_16x16x32_bf16 v[24:27], v[116:119], v[52:55], v[24:27]
ds_read_b128 v[100:103], v1 offset:35840
ds_read_b128 v[104:107], v1 offset:36864
ds_read_b128 v[108:111], v1 offset:37888
ds_read_b128 v[112:115], v1 offset:38912
ds_read_b128 v[116:119], v1 offset:39936
s_waitcnt lgkmcnt(5)
v_mfma_f32_16x16x32_bf16 v[8:11], v[80:83], v[56:59], v[8:11]
v_mfma_f32_16x16x32_bf16 v[12:15], v[84:87], v[56:59], v[12:15]
v_mfma_f32_16x16x32_bf16 v[16:19], v[88:91], v[56:59], v[16:19]
v_mfma_f32_16x16x32_bf16 v[20:23], v[92:95], v[56:59], v[20:23]
v_mfma_f32_16x16x32_bf16 v[24:27], v[96:99], v[56:59], v[24:27]
s_waitcnt lgkmcnt(0)
v_mfma_f32_16x16x32_bf16 v[8:11], v[100:103], v[60:63], v[8:11]
v_mfma_f32_16x16x32_bf16 v[12:15], v[104:107], v[60:63], v[12:15]
v_mfma_f32_16x16x32_bf16 v[16:19], v[108:111], v[60:63], v[16:19]
v_mfma_f32_16x16x32_bf16 v[20:23], v[112:115], v[60:63], v[20:23]
v_mfma_f32_16x16x32_bf16 v[24:27], v[116:119], v[60:63], v[24:27]
s_waitcnt vmcnt(9)
s_barrier
s_add_u32 m0, s29, 20480
s_nop 0
buffer_load_dwordx4 v2, s[4:7], s24 offen lds
s_add_u32 m0, s29, 21504
s_nop 0
buffer_load_dwordx4 v2, s[4:7], s25 offen lds
s_add_u32 m0, s29, 22528
s_nop 0
buffer_load_dwordx4 v2, s[4:7], s26 offen lds
s_add_u32 m0, s29, 23552
s_nop 0
buffer_load_dwordx4 v2, s[4:7], s27 offen lds
s_add_u32 m0, s29, 24576
s_nop 0
buffer_load_dwordx4 v2, s[4:7], s28 offen lds
buffer_load_dwordx4 v[48:51], v1, s[4:7], s22 offen offset:0
buffer_load_dwordx4 v[52:55], v1, s[4:7], s22 offen offset:1024
buffer_load_dwordx4 v[56:59], v1, s[4:7], s22 offen offset:2048
buffer_load_dwordx4 v[60:63], v1, s[4:7], s22 offen offset:3072
v_add_u32 v2, 0x1000, v2
s_add_u32 s22, s22, 4096
ds_read_b128 v[80:83], v1 offset:40960
ds_read_b128 v[84:87], v1 offset:41984
ds_read_b128 v[88:91], v1 offset:43008
ds_read_b128 v[92:95], v1 offset:44032
ds_read_b128 v[96:99], v1 offset:45056
ds_read_b128 v[100:103], v1 offset:46080
ds_read_b128 v[104:107], v1 offset:47104
ds_read_b128 v[108:111], v1 offset:48128
ds_read_b128 v[112:115], v1 offset:49152
ds_read_b128 v[116:119], v1 offset:50176
s_waitcnt lgkmcnt(5)
v_mfma_f32_16x16x32_bf16 v[8:11], v[80:83], v[64:67], v[8:11]
v_mfma_f32_16x16x32_bf16 v[12:15], v[84:87], v[64:67], v[12:15]
v_mfma_f32_16x16x32_bf16 v[16:19], v[88:91], v[64:67], v[16:19]
v_mfma_f32_16x16x32_bf16 v[20:23], v[92:95], v[64:67], v[20:23]
v_mfma_f32_16x16x32_bf16 v[24:27], v[96:99], v[64:67], v[24:27]
ds_read_b128 v[80:83], v1 offset:51200
ds_read_b128 v[84:87], v1 offset:52224
ds_read_b128 v[88:91], v1 offset:53248
ds_read_b128 v[92:95], v1 offset:54272
ds_read_b128 v[96:99], v1 offset:55296
s_waitcnt lgkmcnt(5)
v_mfma_f32_16x16x32_bf16 v[8:11], v[100:103], v[68:71], v[8:11]
v_mfma_f32_16x16x32_bf16 v[12:15], v[104:107], v[68:71], v[12:15]
v_mfma_f32_16x16x32_bf16 v[16:19], v[108:111], v[68:71], v[16:19]
v_mfma_f32_16x16x32_bf16 v[20:23], v[112:115], v[68:71], v[20:23]
v_mfma_f32_16x16x32_bf16 v[24:27], v[116:119], v[68:71], v[24:27]
ds_read_b128 v[100:103], v1 offset:56320
ds_read_b128 v[104:107], v1 offset:57344
ds_read_b128 v[108:111], v1 offset:58368
ds_read_b128 v[112:115], v1 offset:59392
ds_read_b128 v[116:119], v1 offset:60416
s_waitcnt lgkmcnt(5)
v_mfma_f32_16x16x32_bf16 v[8:11], v[80:83], v[72:75], v[8:11]
v_mfma_f32_16x16x32_bf16 v[12:15], v[84:87], v[72:75], v[12:15]
v_mfma_f32_16x16x32_bf16 v[16:19], v[88:91], v[72:75], v[16:19]
v_mfma_f32_16x16x32_bf16 v[20:23], v[92:95], v[72:75], v[20:23]
v_mfma_f32_16x16x32_bf16 v[24:27], v[96:99], v[72:75], v[24:27]
s_waitcnt lgkmcnt(0)
v_mfma_f32_16x16x32_bf16 v[8:11], v[100:103], v[76:79], v[8:11]
v_mfma_f32_16x16x32_bf16 v[12:15], v[104:107], v[76:79], v[12:15]
v_mfma_f32_16x16x32_bf16 v[16:19], v[108:111], v[76:79], v[16:19]
v_mfma_f32_16x16x32_bf16 v[20:23], v[112:115], v[76:79], v[20:23]
v_mfma_f32_16x16x32_bf16 v[24:27], v[116:119], v[76:79], v[24:27]
s_waitcnt vmcnt(9)
s_barrier
ds_read_b128 v[80:83], v1 offset:0
ds_read_b128 v[84:87], v1 offset:1024
ds_read_b128 v[88:91], v1 offset:2048
ds_read_b128 v[92:95], v1 offset:3072
ds_read_b128 v[96:99], v1 offset:4096
ds_read_b128 v[100:103], v1 offset:5120
ds_read_b128 v[104:107], v1 offset:6144
ds_read_b128 v[108:111], v1 offset:7168
ds_read_b128 v[112:115], v1 offset:8192
ds_read_b128 v[116:119], v1 offset:9216
s_waitcnt lgkmcnt(5)
v_mfma_f32_16x16x32_bf16 v[8:11], v[80:83], v[32:35], v[8:11]
v_mfma_f32_16x16x32_bf16 v[12:15], v[84:87], v[32:35], v[12:15]
v_mfma_f32_16x16x32_bf16 v[16:19], v[88:91], v[32:35], v[16:19]
v_mfma_f32_16x16x32_bf16 v[20:23], v[92:95], v[32:35], v[20:23]
v_mfma_f32_16x16x32_bf16 v[24:27], v[96:99], v[32:35], v[24:27]
ds_read_b128 v[80:83], v1 offset:10240
ds_read_b128 v[84:87], v1 offset:11264
ds_read_b128 v[88:91], v1 offset:12288
ds_read_b128 v[92:95], v1 offset:13312
ds_read_b128 v[96:99], v1 offset:14336
s_waitcnt lgkmcnt(5)
v_mfma_f32_16x16x32_bf16 v[8:11], v[100:103], v[36:39], v[8:11]
v_mfma_f32_16x16x32_bf16 v[12:15], v[104:107], v[36:39], v[12:15]
v_mfma_f32_16x16x32_bf16 v[16:19], v[108:111], v[36:39], v[16:19]
v_mfma_f32_16x16x32_bf16 v[20:23], v[112:115], v[36:39], v[20:23]
v_mfma_f32_16x16x32_bf16 v[24:27], v[116:119], v[36:39], v[24:27]
ds_read_b128 v[100:103], v1 offset:15360
ds_read_b128 v[104:107], v1 offset:16384
ds_read_b128 v[108:111], v1 offset:17408
ds_read_b128 v[112:115], v1 offset:18432
ds_read_b128 v[116:119], v1 offset:19456
s_waitcnt lgkmcnt(5)
v_mfma_f32_16x16x32_bf16 v[8:11], v[80:83], v[40:43], v[8:11]
v_mfma_f32_16x16x32_bf16 v[12:15], v[84:87], v[40:43], v[12:15]
v_mfma_f32_16x16x32_bf16 v[16:19], v[88:91], v[40:43], v[16:19]
v_mfma_f32_16x16x32_bf16 v[20:23], v[92:95], v[40:43], v[20:23]
v_mfma_f32_16x16x32_bf16 v[24:27], v[96:99], v[40:43], v[24:27]
s_waitcnt lgkmcnt(0)
v_mfma_f32_16x16x32_bf16 v[8:11], v[100:103], v[44:47], v[8:11]
v_mfma_f32_16x16x32_bf16 v[12:15], v[104:107], v[44:47], v[12:15]
v_mfma_f32_16x16x32_bf16 v[16:19], v[108:111], v[44:47], v[16:19]
v_mfma_f32_16x16x32_bf16 v[20:23], v[112:115], v[44:47], v[20:23]
v_mfma_f32_16x16x32_bf16 v[24:27], v[116:119], v[44:47], v[24:27]
s_waitcnt vmcnt(0)
s_barrier
ds_read_b128 v[80:83], v1 offset:20480
ds_read_b128 v[84:87], v1 offset:21504
ds_read_b128 v[88:91], v1 offset:22528
ds_read_b128 v[92:95], v1 offset:23552
ds_read_b128 v[96:99], v1 offset:24576
ds_read_b128 v[100:103], v1 offset:25600
ds_read_b128 v[104:107], v1 offset:26624
ds_read_b128 v[108:111], v1 offset:27648
ds_read_b128 v[112:115], v1 offset:28672
ds_read_b128 v[116:119], v1 offset:29696
s_waitcnt lgkmcnt(5)
v_mfma_f32_16x16x32_bf16 v[8:11], v[80:83], v[48:51], v[8:11]
v_mfma_f32_16x16x32_bf16 v[12:15], v[84:87], v[48:51], v[12:15]
v_mfma_f32_16x16x32_bf16 v[16:19], v[88:91], v[48:51], v[16:19]
v_mfma_f32_16x16x32_bf16 v[20:23], v[92:95], v[48:51], v[20:23]
v_mfma_f32_16x16x32_bf16 v[24:27], v[96:99], v[48:51], v[24:27]
ds_read_b128 v[80:83], v1 offset:30720
ds_read_b128 v[84:87], v1 offset:31744
ds_read_b128 v[88:91], v1 offset:32768
ds_read_b128 v[92:95], v1 offset:33792
ds_read_b128 v[96:99], v1 offset:34816
s_waitcnt lgkmcnt(5)
v_mfma_f32_16x16x32_bf16 v[8:11], v[100:103], v[52:55], v[8:11]
v_mfma_f32_16x16x32_bf16 v[12:15], v[104:107], v[52:55], v[12:15]
v_mfma_f32_16x16x32_bf16 v[16:19], v[108:111], v[52:55], v[16:19]
v_mfma_f32_16x16x32_bf16 v[20:23], v[112:115], v[52:55], v[20:23]
v_mfma_f32_16x16x32_bf16 v[24:27], v[116:119], v[52:55], v[24:27]
ds_read_b128 v[100:103], v1 offset:35840
ds_read_b128 v[104:107], v1 offset:36864
ds_read_b128 v[108:111], v1 offset:37888
ds_read_b128 v[112:115], v1 offset:38912
ds_read_b128 v[116:119], v1 offset:39936
s_waitcnt lgkmcnt(5)
v_mfma_f32_16x16x32_bf16 v[8:11], v[80:83], v[56:59], v[8:11]
v_mfma_f32_16x16x32_bf16 v[12:15], v[84:87], v[56:59], v[12:15]
v_mfma_f32_16x16x32_bf16 v[16:19], v[88:91], v[56:59], v[16:19]
v_mfma_f32_16x16x32_bf16 v[20:23], v[92:95], v[56:59], v[20:23]
v_mfma_f32_16x16x32_bf16 v[24:27], v[96:99], v[56:59], v[24:27]
s_waitcnt lgkmcnt(0)
v_mfma_f32_16x16x32_bf16 v[8:11], v[100:103], v[60:63], v[8:11]
v_mfma_f32_16x16x32_bf16 v[12:15], v[104:107], v[60:63], v[12:15]
v_mfma_f32_16x16x32_bf16 v[16:19], v[108:111], v[60:63], v[16:19]
v_mfma_f32_16x16x32_bf16 v[20:23], v[112:115], v[60:63], v[20:23]
v_mfma_f32_16x16x32_bf16 v[24:27], v[116:119], v[60:63], v[24:27]
v_and_b32 v3, 63, v0
v_and_b32 v4, 15, v3
v_lshrrev_b32 v3, 4, v3
s_lshl_b32 s21, s17, 6
s_lshl_b32 s23, s16, 4
s_add_u32 s21, s21, s23
v_add_u32 v4, s21, v4
v_mul_u32_u24 v6, 1280, v4
v_lshl_add_u32 v6, v3, 4, v6
s_mul_i32 s21, s18, 5
s_add_u32 s23, s21, 0
s_lshr_b32 s31, s23, 1
s_lshl_b32 s31, s31, 6
s_and_b32 s23, s23, 1
s_lshl_b32 s23, s23, 3
s_add_u32 s32, s31, s23
s_add_u32 s40, s32, s20
buffer_load_dwordx2 v[32:33], v6, s[8:11], s40 offen
s_add_u32 s23, s21, 1
s_lshr_b32 s31, s23, 1
s_lshl_b32 s31, s31, 6
s_and_b32 s23, s23, 1
s_lshl_b32 s23, s23, 3
s_add_u32 s33, s31, s23
s_add_u32 s41, s33, s20
buffer_load_dwordx2 v[34:35], v6, s[8:11], s41 offen
s_add_u32 s23, s21, 2
s_lshr_b32 s31, s23, 1
s_lshl_b32 s31, s31, 6
s_and_b32 s23, s23, 1
s_lshl_b32 s23, s23, 3
s_add_u32 s34, s31, s23
s_add_u32 s42, s34, s20
buffer_load_dwordx2 v[36:37], v6, s[8:11], s42 offen
s_add_u32 s23, s21, 3
s_lshr_b32 s31, s23, 1
s_lshl_b32 s31, s31, 6
s_and_b32 s23, s23, 1
s_lshl_b32 s23, s23, 3
s_add_u32 s35, s31, s23
s_add_u32 s43, s35, s20
buffer_load_dwordx2 v[38:39], v6, s[8:11], s43 offen
s_add_u32 s23, s21, 4
s_lshr_b32 s31, s23, 1
s_lshl_b32 s31, s31, 6
s_and_b32 s23, s23, 1
s_lshl_b32 s23, s23, 3
s_add_u32 s36, s31, s23
s_add_u32 s44, s36, s20
buffer_load_dwordx2 v[40:41], v6, s[8:11], s44 offen
s_waitcnt vmcnt(0)
v_cvt_pk_bf16_f32 v80, v8, v9
v_cvt_pk_bf16_f32 v81, v10, v11
v_lshlrev_b32 v8, 16, v80
v_and_b32 v9, 0xffff0000, v80
v_lshlrev_b32 v10, 16, v81
v_and_b32 v11, 0xffff0000, v81
v_lshlrev_b32 v82, 16, v32
v_and_b32 v83, 0xffff0000, v32
v_lshlrev_b32 v84, 16, v33
v_and_b32 v85, 0xffff0000, v33
v_add_f32 v8, v8, v82
v_add_f32 v9, v9, v83
v_add_f32 v10, v10, v84
v_add_f32 v11, v11, v85
v_cvt_pk_bf16_f32 v32, v8, v9
v_cvt_pk_bf16_f32 v33, v10, v11
buffer_store_dwordx2 v[32:33], v6, s[52:55], s32 offen sc1
v_cvt_pk_bf16_f32 v80, v12, v13
v_cvt_pk_bf16_f32 v81, v14, v15
v_lshlrev_b32 v12, 16, v80
v_and_b32 v13, 0xffff0000, v80
v_lshlrev_b32 v14, 16, v81
v_and_b32 v15, 0xffff0000, v81
v_lshlrev_b32 v82, 16, v34
v_and_b32 v83, 0xffff0000, v34
v_lshlrev_b32 v84, 16, v35
v_and_b32 v85, 0xffff0000, v35
v_add_f32 v12, v12, v82
v_add_f32 v13, v13, v83
v_add_f32 v14, v14, v84
v_add_f32 v15, v15, v85
v_cvt_pk_bf16_f32 v34, v12, v13
v_cvt_pk_bf16_f32 v35, v14, v15
buffer_store_dwordx2 v[34:35], v6, s[52:55], s33 offen sc1
v_cvt_pk_bf16_f32 v80, v16, v17
v_cvt_pk_bf16_f32 v81, v18, v19
v_lshlrev_b32 v16, 16, v80
v_and_b32 v17, 0xffff0000, v80
v_lshlrev_b32 v18, 16, v81
v_and_b32 v19, 0xffff0000, v81
v_lshlrev_b32 v82, 16, v36
v_and_b32 v83, 0xffff0000, v36
v_lshlrev_b32 v84, 16, v37
v_and_b32 v85, 0xffff0000, v37
v_add_f32 v16, v16, v82
v_add_f32 v17, v17, v83
v_add_f32 v18, v18, v84
v_add_f32 v19, v19, v85
v_cvt_pk_bf16_f32 v36, v16, v17
v_cvt_pk_bf16_f32 v37, v18, v19
buffer_store_dwordx2 v[36:37], v6, s[52:55], s34 offen sc1
v_cvt_pk_bf16_f32 v80, v20, v21
v_cvt_pk_bf16_f32 v81, v22, v23
v_lshlrev_b32 v20, 16, v80
v_and_b32 v21, 0xffff0000, v80
v_lshlrev_b32 v22, 16, v81
v_and_b32 v23, 0xffff0000, v81
v_lshlrev_b32 v82, 16, v38
v_and_b32 v83, 0xffff0000, v38
v_lshlrev_b32 v84, 16, v39
v_and_b32 v85, 0xffff0000, v39
v_add_f32 v20, v20, v82
v_add_f32 v21, v21, v83
v_add_f32 v22, v22, v84
v_add_f32 v23, v23, v85
v_cvt_pk_bf16_f32 v38, v20, v21
v_cvt_pk_bf16_f32 v39, v22, v23
buffer_store_dwordx2 v[38:39], v6, s[52:55], s35 offen sc1
v_cvt_pk_bf16_f32 v80, v24, v25
v_cvt_pk_bf16_f32 v81, v26, v27
v_lshlrev_b32 v24, 16, v80
v_and_b32 v25, 0xffff0000, v80
v_lshlrev_b32 v26, 16, v81
v_and_b32 v27, 0xffff0000, v81
v_lshlrev_b32 v82, 16, v40
v_and_b32 v83, 0xffff0000, v40
v_lshlrev_b32 v84, 16, v41
v_and_b32 v85, 0xffff0000, v41
v_add_f32 v24, v24, v82
v_add_f32 v25, v25, v83
v_add_f32 v26, v26, v84
v_add_f32 v27, v27, v85
v_cvt_pk_bf16_f32 v40, v24, v25
v_cvt_pk_bf16_f32 v41, v26, v27
buffer_store_dwordx2 v[40:41], v6, s[52:55], s36 offen sc1
outb2_exit1:
s_endpgm
.section .rodata,"a"
.p2align 6
.amdhsa_kernel prep_kernel
  .amdhsa_next_free_vgpr 80
  .amdhsa_next_free_sgpr 64
  .amdhsa_accum_offset 80
  .amdhsa_group_segment_fixed_size 0
  .amdhsa_kernarg_size 104
  .amdhsa_user_sgpr_count 2
  .amdhsa_user_sgpr_kernarg_segment_ptr 1
  .amdhsa_system_sgpr_workgroup_id_x 1
  .amdhsa_float_denorm_mode_32 3
.end_amdhsa_kernel
.p2align 6
.amdhsa_kernel ln2_kernel
  .amdhsa_next_free_vgpr 80
  .amdhsa_next_free_sgpr 40
  .amdhsa_accum_offset 80
  .amdhsa_group_segment_fixed_size 0
  .amdhsa_kernarg_size 104
  .amdhsa_user_sgpr_count 2
  .amdhsa_user_sgpr_kernarg_segment_ptr 1
  .amdhsa_system_sgpr_workgroup_id_x 1
  .amdhsa_float_denorm_mode_32 3
.end_amdhsa_kernel
.p2align 6
.amdhsa_kernel reca_kernel
  .amdhsa_next_free_vgpr 512
  .amdhsa_next_free_sgpr 102
  .amdhsa_accum_offset 256
  .amdhsa_group_segment_fixed_size 0
  .amdhsa_kernarg_size 104
  .amdhsa_user_sgpr_count 2
  .amdhsa_user_sgpr_kernarg_segment_ptr 1
  .amdhsa_system_sgpr_workgroup_id_x 1
  .amdhsa_float_denorm_mode_32 3
.end_amdhsa_kernel
.p2align 6
.amdhsa_kernel fin_kernel
  .amdhsa_next_free_vgpr 496
  .amdhsa_next_free_sgpr 64
  .amdhsa_accum_offset 256
  .amdhsa_group_segment_fixed_size 0
  .amdhsa_kernarg_size 104
  .amdhsa_user_sgpr_count 2
  .amdhsa_user_sgpr_kernarg_segment_ptr 1
  .amdhsa_system_sgpr_workgroup_id_x 1
  .amdhsa_float_denorm_mode_32 3
.end_amdhsa_kernel
.p2align 6
.amdhsa_kernel redln1_kernel
  .amdhsa_next_free_vgpr 248
  .amdhsa_next_free_sgpr 48
  .amdhsa_accum_offset 248
  .amdhsa_group_segment_fixed_size 0
  .amdhsa_kernarg_size 104
  .amdhsa_user_sgpr_count 2
  .amdhsa_user_sgpr_kernarg_segment_ptr 1
  .amdhsa_system_sgpr_workgroup_id_x 1
  .amdhsa_float_denorm_mode_32 3
.end_amdhsa_kernel
.p2align 6
.amdhsa_kernel redln2_kernel
  .amdhsa_next_free_vgpr 248
  .amdhsa_next_free_sgpr 48
  .amdhsa_accum_offset 248
  .amdhsa_group_segment_fixed_size 0
  .amdhsa_kernarg_size 104
  .amdhsa_user_sgpr_count 2
  .amdhsa_user_sgpr_kernarg_segment_ptr 1
  .amdhsa_system_sgpr_workgroup_id_x 1
  .amdhsa_float_denorm_mode_32 3
.end_amdhsa_kernel
.p2align 6
.amdhsa_kernel qkvb_kernel
  .amdhsa_next_free_vgpr 176
  .amdhsa_next_free_sgpr 64
  .amdhsa_accum_offset 176
  .amdhsa_group_segment_fixed_size 0
  .amdhsa_kernarg_size 104
  .amdhsa_user_sgpr_count 2
  .amdhsa_user_sgpr_kernarg_segment_ptr 1
  .amdhsa_system_sgpr_workgroup_id_x 1
  .amdhsa_float_denorm_mode_32 3
.end_amdhsa_kernel
.p2align 6
.amdhsa_kernel attnb_kernel
  .amdhsa_next_free_vgpr 200
  .amdhsa_next_free_sgpr 48
  .amdhsa_accum_offset 200
  .amdhsa_group_segment_fixed_size 0
  .amdhsa_kernarg_size 104
  .amdhsa_user_sgpr_count 2
  .amdhsa_user_sgpr_kernarg_segment_ptr 1
  .amdhsa_system_sgpr_workgroup_id_x 1
  .amdhsa_float_denorm_mode_32 3
.end_amdhsa_kernel
.p2align 6
.amdhsa_kernel outb1_kernel
  .amdhsa_next_free_vgpr 128
  .amdhsa_next_free_sgpr 64
  .amdhsa_accum_offset 128
  .amdhsa_group_segment_fixed_size 0
  .amdhsa_kernarg_size 104
  .amdhsa_user_sgpr_count 2
  .amdhsa_user_sgpr_kernarg_segment_ptr 1
  .amdhsa_system_sgpr_workgroup_id_x 1
  .amdhsa_float_denorm_mode_32 3
.end_amdhsa_kernel
.p2align 6
.amdhsa_kernel outb2_kernel
  .amdhsa_next_free_vgpr 128
  .amdhsa_next_free_sgpr 64
  .amdhsa_accum_offset 128
  .amdhsa_group_segment_fixed_size 0
  .amdhsa_kernarg_size 104
  .amdhsa_user_sgpr_count 2
  .amdhsa_user_sgpr_kernarg_segment_ptr 1
  .amdhsa_system_sgpr_workgroup_id_x 1
  .amdhsa_float_denorm_mode_32 3
.end_amdhsa_kernel
```
